```python
import torch

def _softmax(x, axis=-1):
    return torch.softmax(x, dim=axis)

def _gelu(x):
    return torch.nn.functional.gelu(x, approximate='tanh')

def _silu(x):
    return torch.nn.functional.silu(x)

def _sigmoid(x):
    return torch.sigmoid(x)

def _layernorm(x, axis=-1, eps=1e-05):
    m = x.mean(dim=axis, keepdim=True)
    v = x.var(dim=axis, keepdim=True, unbiased=False)
    return (x - m) / torch.sqrt(v + eps)

def _scatter_add(tgt, idx, src, axis=0):
    return tgt.clone().index_add_(axis, idx, src)

def _segment_sum(src, seg, n):
    out = torch.zeros((n,) + src.shape[1:], dtype=src.dtype)
    return out.index_add_(0, seg, src)

def _pad(x, pw):
    flat = tuple((v for pair in reversed(pw) for v in pair))
    return torch.nn.functional.pad(x, flat)
kernel_name = 'standalone__tensor_product_equiv_equiformer__graph'

def setup_inputs():

    _w = lambda a: (lambda t: t.to(torch.bfloat16) if t.is_floating_point() else t)(torch.as_tensor(a))
    N, deg, C, De = (10000, 32, 128, max(16, 1))
    E = N * deg
    src = (lambda lo, hi, *s: torch.randint(lo, hi, s))(0, N, E).to(torch.int64)
    dst = (lambda lo, hi, *s: torch.randint(lo, hi, s))(0, N, E).to(torch.int64)
    rvec = (lambda *s: torch.randn(*s, dtype=torch.bfloat16) * 0.05)(E, 3).to(float)
    rn = (torch.linalg.norm(rvec, dim=-1, keepdim=True) + 1e-06).to(float)
    rhat = (rvec / rn).to(float)
    eps = torch.zeros((3, 3, 3), dtype=float)
    eps[0, 1, 2] = eps[1, 2, 0] = eps[2, 0, 1] = 1.0
    eps[0, 2, 1] = eps[2, 1, 0] = eps[1, 0, 2] = -1.0
    return {'x': _w((lambda *s: torch.randn(*s, dtype=torch.bfloat16) * 0.2)(N, 4 * C).to(float)), 'rhat': _w(rhat), 'e_attr': _w((lambda *s: torch.randn(*s, dtype=torch.bfloat16) * 0.2)(E, De).to(float)), 'src': _w(src), 'dst': _w(dst), 'w_rad': _w((lambda *s: torch.randn(*s, dtype=torch.bfloat16) * 0.2)(De, 5 * C).to(float)), 'w_si0': _w((lambda *s: torch.randn(*s, dtype=torch.bfloat16) * 0.2)(2 * C, C).to(float)), 'w_si1': _w((lambda *s: torch.randn(*s, dtype=torch.bfloat16) * 0.05)(3 * C, C).to(float)), 'cg_eps': _w(eps)}

def reference(x, rhat, e_attr, src, dst, w_rad, w_si0, w_si1, cg_eps):
    N = x.shape[0]
    C = w_si0.shape[1]
    E = rhat.shape[0]
    x0 = x[:, :C].clone()
    x1 = x[:, C:].reshape(N, 3, C)
    R = (e_attr @ w_rad).reshape(E, 5, C)
    f0 = x0[src]
    f1 = x1[src]
    Y1 = rhat
    p00_0 = f0 * R[:, 0, :]
    p11_0 = torch.einsum('ejc,ej->ec', f1, Y1) * R[:, 1, :]
    p01_1 = torch.einsum('ec,ej->ejc', f0, Y1) * R[:, 2, :][:, None, :]
    p10_1 = f1 * R[:, 3, :][:, None, :]
    p11_1 = torch.einsum('ijk,ekc,ej->eic', cg_eps, f1, Y1) * R[:, 4, :][:, None, :]
    m0 = torch.concatenate([p00_0, p11_0], axis=-1) @ w_si0
    m1 = torch.einsum('ejp,pc->ejc', torch.concatenate([p01_1, p10_1, p11_1], axis=-1), w_si1)
    agg0 = _segment_sum(m0, dst, N)
    agg1 = _segment_sum(m1.reshape(E, 3 * C), dst, N).reshape(N, 3, C)
    gate = _sigmoid(agg0)
    out1 = agg1 * gate[:, None, :]
    return torch.concatenate([agg0, out1.reshape(N, 3 * C)], axis=-1)
```

```asm
; @launch kernel=tp_sort_kernel grid=(256,1,1) block=(640,1,1) lds=62048
; @launch kernel=tp_main_kernel grid=(256,1,1) block=(512,1,1) lds=162112
.amdgcn_target "amdgcn-amd-amdhsa--gfx950"
.text
.globl tp_sort_kernel
.p2align 8
.type tp_sort_kernel,@function
tp_sort_kernel:
    s_cmp_ge_u32 s2, 256
    s_cbranch_scc1 K1_END
    s_load_dwordx4 s[36:39], s[0:1], 8
    s_load_dwordx4 s[40:43], s[0:1], 24
    s_load_dwordx4 s[44:47], s[0:1], 40
    s_load_dwordx2 s[48:49], s[0:1], 56
    s_load_dwordx2 s[50:51], s[0:1], 88
    v_lshrrev_b32 v1, 6, v0
    v_lshlrev_b32 v2, 2, v0
    v_readfirstlane_b32 s3, v1
    v_and_b32 v3, 1, v0
    v_mul_u32_u24 v4, 6, v0
    v_lshlrev_b32 v5, 1, v3
    v_sub_u32 v4, v4, v5
    v_lshlrev_b32 v5, 5, v0
    v_lshlrev_b32 v3, 4, v3
    v_mov_b32 v6, 0
    s_mul_i32 s52, s2, 5000
    s_mul_i32 s53, s2, 7500
    s_mul_i32 s54, s2, 40000
    s_add_u32 s55, s54, 20480
    s_waitcnt lgkmcnt(0)
    s_mov_b32 s4, s42
    s_and_b32 s5, s43, 0xffff
    s_mov_b32 s6, 1280000
    s_mov_b32 s7, 0x20000
    s_mov_b32 s8, s40
    s_and_b32 s9, s41, 0xffff
    s_mov_b32 s10, 1280000
    s_mov_b32 s11, 0x20000
    s_mov_b32 s12, s36
    s_and_b32 s13, s37, 0xffff
    s_mov_b32 s14, 1920000
    s_mov_b32 s15, 0x20000
    s_mov_b32 s16, s38
    s_and_b32 s17, s39, 0xffff
    s_mov_b32 s18, 10240000
    s_mov_b32 s19, 0x20000
    s_mov_b32 s20, s50
    s_and_b32 s21, s51, 0xffff
    s_mov_b32 s22, 50331648
    s_mov_b32 s23, 0x20000
    buffer_load_dword v10, v2, s[4:7], s52 offen
    buffer_load_dword v11, v2, s[4:7], s52 offen offset:2560
    buffer_load_dword v12, v2, s[8:11], s52 offen
    buffer_load_dword v13, v2, s[8:11], s52 offen offset:2560
    buffer_load_dwordx2 v[14:15], v4, s[12:15], s53 offen
    buffer_load_dwordx2 v[16:17], v4, s[12:15], s53 offen offset:3840
    buffer_load_dwordx4 v[20:23], v5, s[16:19], s54 offen
    buffer_load_dwordx4 v[24:27], v5, s[16:19], s54 offen offset:16
    buffer_load_dwordx4 v[32:35], v5, s[16:19], s55 offen
    buffer_load_dwordx4 v[36:39], v5, s[16:19], s55 offen offset:16
    v_cmp_gt_u32 vcc, 256, v0
    s_nop 0
    s_and_saveexec_b64 s[56:57], vcc
    s_cbranch_execz K1_NOCLR
    ds_write_b32 v2, v6
K1_NOCLR:
    s_mov_b64 exec, s[56:57]
    s_mov_b32 s58, 429497
    v_mov_b32 v7, 1
    s_waitcnt lgkmcnt(0)
    s_barrier
    s_waitcnt vmcnt(8)
    v_mul_u32_u24 v40, s58, v10
    v_mul_u32_u24 v41, s58, v11
    v_lshrrev_b32 v40, 24, v40
    v_lshrrev_b32 v41, 24, v41
    v_lshlrev_b32 v42, 2, v40
    v_lshlrev_b32 v43, 2, v41
    ds_add_rtn_u32 v44, v42, v7
    v_cmp_gt_u32 vcc, 610, v0
    s_nop 0
    s_mov_b64 s[60:61], vcc
    s_and_saveexec_b64 s[56:57], vcc
    ds_add_rtn_u32 v45, v43, v7
    s_mov_b64 exec, s[56:57]
    s_movk_i32 s59, 625
    v_mad_u32_u24 v46, v40, s59, 15
    v_mad_u32_u24 v47, v41, s59, 15
    v_lshrrev_b32 v46, 4, v46
    v_lshrrev_b32 v47, 4, v47
    v_sub_u32 v46, v10, v46
    v_sub_u32 v47, v11, v47
    v_and_b32 v8, 63, v0
    v_lshlrev_b32 v9, 4, v8
    s_waitcnt lgkmcnt(0)
    s_barrier
    ds_read_b128 v[48:51], v9
    s_waitcnt lgkmcnt(0)
    v_add_u32 v53, v48, v49
    v_add_u32 v54, v53, v50
    v_add_u32 v55, v54, v51
    v_mov_b32 v56, v55
    s_nop 1
    v_add_u32_dpp v56, v56, v56 row_shr:1 row_mask:0xf bank_mask:0xf bound_ctrl:0
    s_nop 1
    v_add_u32_dpp v56, v56, v56 row_shr:2 row_mask:0xf bank_mask:0xf bound_ctrl:0
    s_nop 1
    v_add_u32_dpp v56, v56, v56 row_shr:4 row_mask:0xf bank_mask:0xf bound_ctrl:0
    s_nop 1
    v_add_u32_dpp v56, v56, v56 row_shr:8 row_mask:0xf bank_mask:0xf bound_ctrl:0
    s_nop 1
    v_add_u32_dpp v56, v56, v56 row_bcast:15 row_mask:0xa bank_mask:0xf
    s_nop 1
    v_add_u32_dpp v56, v56, v56 row_bcast:31 row_mask:0xc bank_mask:0xf
    v_sub_u32 v56, v56, v55
    v_add_u32 v57, v56, v48
    v_add_u32 v58, v56, v53
    v_add_u32 v59, v56, v54
    ds_write_b128 v9, v[56:59] offset:1024
    s_cmp_lg_u32 s3, 0
    s_cbranch_scc1 K1_NOTBL
    v_lshl_or_b32 v60, v48, 16, v56
    v_lshl_or_b32 v61, v49, 16, v57
    v_lshl_or_b32 v62, v50, 16, v58
    v_lshl_or_b32 v63, v51, 16, v59
    s_lshl_b32 s62, s2, 10
    s_add_u32 s62, s62, 15728640
    buffer_store_dwordx4 v[60:63], v9, s[20:23], s62 offen
K1_NOTBL:
    s_waitcnt lgkmcnt(0)
    ds_read_b32 v52, v42 offset:1024
    ds_read_b32 v53, v43 offset:1024
    s_waitcnt vmcnt(4)
    v_lshl_or_b32 v31, v46, 16, v12
    v_lshl_or_b32 v43, v47, 16, v13
    v_lshrrev_b64 v[14:15], v3, v[14:15]
    v_lshrrev_b64 v[16:17], v3, v[16:17]
    v_lshlrev_b32 v28, 16, v14
    v_and_b32 v29, 0xffff0000, v14
    v_lshlrev_b32 v30, 16, v15
    v_lshlrev_b32 v40, 16, v16
    v_and_b32 v41, 0xffff0000, v16
    v_lshlrev_b32 v42, 16, v17
    s_waitcnt lgkmcnt(0)
    v_add_u32 v52, v52, v44
    v_add_u32 v53, v53, v45
    v_mul_u32_u24 v52, 48, v52
    v_mul_u32_u24 v53, 48, v53
    ds_write_b128 v52, v[28:31] offset:2080
    s_mov_b64 exec, s[60:61]
    ds_write_b128 v53, v[40:43] offset:2080
    s_mov_b64 exec, -1
    s_waitcnt vmcnt(0)
    ds_write_b128 v52, v[20:23] offset:2048
    ds_write_b128 v52, v[24:27] offset:2064
    s_mov_b64 exec, s[60:61]
    ds_write_b128 v53, v[32:35] offset:2048
    ds_write_b128 v53, v[36:39] offset:2064
    s_mov_b64 exec, -1
    v_lshlrev_b32 v5, 4, v0
    s_mul_i32 s52, s2, 60000
    s_waitcnt lgkmcnt(0)
    s_barrier
    ds_read_b128 v[12:15], v5 offset:2048
    ds_read_b128 v[16:19], v5 offset:12288
    ds_read_b128 v[20:23], v5 offset:22528
    ds_read_b128 v[24:27], v5 offset:32768
    ds_read_b128 v[28:31], v5 offset:43008
    ds_read_b128 v[32:35], v5 offset:53248
    s_waitcnt lgkmcnt(5)
    buffer_store_dwordx4 v[12:15], v5, s[20:23], s52 offen
    s_add_u32 s52, s52, 10240
    s_waitcnt lgkmcnt(4)
    buffer_store_dwordx4 v[16:19], v5, s[20:23], s52 offen
    s_add_u32 s52, s52, 10240
    s_waitcnt lgkmcnt(3)
    buffer_store_dwordx4 v[20:23], v5, s[20:23], s52 offen
    s_add_u32 s52, s52, 10240
    s_waitcnt lgkmcnt(2)
    buffer_store_dwordx4 v[24:27], v5, s[20:23], s52 offen
    s_add_u32 s52, s52, 10240
    s_waitcnt lgkmcnt(1)
    buffer_store_dwordx4 v[28:31], v5, s[20:23], s52 offen
    s_add_u32 s52, s52, 10240
    s_waitcnt lgkmcnt(0)
    v_cmp_gt_u32 vcc, 550, v0
    s_nop 0
    s_and_saveexec_b64 s[56:57], vcc
    s_cbranch_execz K1_STD
    buffer_store_dwordx4 v[32:35], v5, s[20:23], s52 offen
K1_STD:
    s_mov_b64 exec, -1
    s_cmp_lg_u32 s3, 9
    s_cbranch_scc1 K1_END
    s_cmp_ge_u32 s2, 180
    s_cbranch_scc1 K1_END
    v_and_b32 v1, 15, v8
    v_lshrrev_b32 v2, 4, v8
    s_cmp_ge_u32 s2, 160
    s_cbranch_scc1 K1_WT
    s_cmp_ge_u32 s2, 64
    s_cbranch_scc1 K1_S1
    s_lshr_b32 s24, s2, 3
    s_and_b32 s25, s2, 7
    s_lshr_b32 s26, s25, 2
    s_bfe_u32 s27, s25, 0x10001
    s_and_b32 s28, s25, 1
    s_mov_b32 s4, s46
    s_and_b32 s5, s47, 0xffff
    s_mov_b32 s6, 65536
    s_mov_b32 s7, 0x20000
    s_branch K1_SC
K1_S1:
    s_sub_u32 s29, s2, 64
    s_mul_i32 s24, s29, 43
    s_lshr_b32 s24, s24, 9
    s_mul_i32 s25, s24, 12
    s_sub_u32 s25, s29, s25
    s_cmp_ge_u32 s25, 6
    s_cselect_b32 s26, 1, 0
    s_mul_i32 s27, s26, 6
    s_sub_u32 s27, s25, s27
    s_lshr_b32 s27, s27, 1
    s_and_b32 s28, s25, 1
    s_add_u32 s25, s25, 8
    s_mov_b32 s4, s48
    s_and_b32 s5, s49, 0xffff
    s_mov_b32 s6, 98304
    s_mov_b32 s7, 0x20000
K1_SC:
    s_lshl_b32 s27, s27, 7
    s_lshl_b32 s26, s26, 6
    s_lshl_b32 s28, s28, 5
    s_add_u32 s27, s27, s26
    s_add_u32 s27, s27, s28
    s_lshl_b32 s27, s27, 8
    s_lshl_b32 s26, s24, 5
    s_add_u32 s27, s27, s26
    v_lshlrev_b32 v2, 11, v2
    v_lshl_add_u32 v2, v1, 1, v2
    buffer_load_ushort v12, v2, s[4:7], s27 offen offset:0
    buffer_load_ushort v13, v2, s[4:7], s27 offen offset:256
    buffer_load_ushort v14, v2, s[4:7], s27 offen offset:512
    buffer_load_ushort v15, v2, s[4:7], s27 offen offset:768
    buffer_load_ushort v16, v2, s[4:7], s27 offen offset:1024
    buffer_load_ushort v17, v2, s[4:7], s27 offen offset:1280
    buffer_load_ushort v18, v2, s[4:7], s27 offen offset:1536
    buffer_load_ushort v19, v2, s[4:7], s27 offen offset:1792
    s_mul_i32 s24, s24, 20
    s_add_u32 s24, s24, s25
    s_lshl_b32 s24, s24, 10
    s_add_u32 s24, s24, 15990784
    s_branch K1_PACK
K1_WT:
    s_sub_u32 s24, s2, 160
    s_cmp_ge_u32 s24, 10
    s_cselect_b32 s26, 1, 0
    s_mul_i32 s25, s26, 10
    s_sub_u32 s25, s24, s25
    s_lshr_b32 s27, s25, 1
    s_and_b32 s28, s25, 1
    s_lshl_b32 s27, s27, 8
    s_lshl_b32 s26, s26, 7
    s_lshl_b32 s28, s28, 6
    s_add_u32 s27, s27, s26
    s_add_u32 s27, s27, s28
    s_add_u32 s28, s27, 10240
    s_mov_b32 s4, s44
    s_and_b32 s5, s45, 0xffff
    s_mov_b32 s6, 20480
    s_mov_b32 s7, 0x20000
    v_and_b32 v1, 31, v8
    v_lshrrev_b32 v2, 5, v8
    v_mul_u32_u24 v2, 5120, v2
    v_lshl_add_u32 v2, v1, 1, v2
    buffer_load_ushort v12, v2, s[4:7], s27 offen offset:0
    buffer_load_ushort v13, v2, s[4:7], s27 offen offset:1280
    buffer_load_ushort v14, v2, s[4:7], s27 offen offset:2560
    buffer_load_ushort v15, v2, s[4:7], s27 offen offset:3840
    buffer_load_ushort v16, v2, s[4:7], s28 offen offset:0
    buffer_load_ushort v17, v2, s[4:7], s28 offen offset:1280
    buffer_load_ushort v18, v2, s[4:7], s28 offen offset:2560
    buffer_load_ushort v19, v2, s[4:7], s28 offen offset:3840
    s_lshl_b32 s24, s24, 10
    s_add_u32 s24, s24, 16154624
K1_PACK:
    s_waitcnt vmcnt(0)
    v_lshl_or_b32 v20, v13, 16, v12
    v_lshl_or_b32 v21, v15, 16, v14
    v_lshl_or_b32 v22, v17, 16, v16
    v_lshl_or_b32 v23, v19, 16, v18
    buffer_store_dwordx4 v[20:23], v9, s[20:23], s24 offen
K1_END:
    s_endpgm
.globl tp_main_kernel
.p2align 8
.type tp_main_kernel,@function
tp_main_kernel:
    s_cmp_ge_u32 s2, 256
    s_cbranch_scc1 K2_END
    s_load_dwordx2 s[46:47], s[0:1], 0
    s_load_dwordx2 s[48:49], s[0:1], 72
    s_load_dwordx2 s[50:51], s[0:1], 88
    v_lshrrev_b32 v1, 6, v0
    s_mov_b32 s64, s2
    v_readfirstlane_b32 s16, v1
    s_mul_i32 s17, s2, 625
    s_add_u32 s18, s17, 640
    s_add_u32 s17, s17, 15
    s_lshr_b32 s17, s17, 4
    s_lshr_b32 s18, s18, 4
    s_sub_u32 s18, s18, s17
    s_mov_b32 s19, 0
    s_mov_b32 s24, 1
    s_movk_i32 s44, 1024
    s_lshl_b32 s34, s16, 13
    s_waitcnt lgkmcnt(0)
    s_mov_b32 s4, s46
    s_and_b32 s5, s47, 0xffff
    s_mov_b32 s6, 10240000
    s_mov_b32 s7, 0x20000
    s_mov_b32 s8, s50
    s_and_b32 s9, s51, 0xffff
    s_mov_b32 s10, 50331648
    s_mov_b32 s11, 0x20000
    s_mov_b32 s12, s48
    s_and_b32 s13, s49, 0xffff
    s_mov_b32 s14, 10240000
    s_mov_b32 s15, 0x20000
K2_WINDOW:
    s_mov_b32 s20, 0
    s_mov_b32 s21, 1
    s_mov_b32 s22, 64
K2_LOAD:
    v_mbcnt_lo_u32_b32 v176, -1, 0
    v_mbcnt_hi_u32_b32 v176, -1, v176
    s_lshl_b32 s45, s16, 6
    v_add_u32 v177, s45, v176
    v_lshrrev_b32 v178, 1, v177
    v_lshlrev_b32 v1, 10, v178
    s_lshl_b32 s45, s64, 2
    s_add_u32 s45, s45, 15728640
    buffer_load_dword v179, v1, s[8:11], s45 offen
    v_lshlrev_b32 v2, 4, v176
    s_mov_b32 s45, 16154624
    buffer_load_dwordx4 v[136:139], v2, s[8:11], s45 offen offset:0
    buffer_load_dwordx4 v[140:143], v2, s[8:11], s45 offen offset:1024
    buffer_load_dwordx4 v[144:147], v2, s[8:11], s45 offen offset:2048
    buffer_load_dwordx4 v[148:151], v2, s[8:11], s45 offen offset:3072
    s_mov_b32 s45, 16158720
    buffer_load_dwordx4 v[152:155], v2, s[8:11], s45 offen offset:0
    buffer_load_dwordx4 v[156:159], v2, s[8:11], s45 offen offset:1024
    buffer_load_dwordx4 v[160:163], v2, s[8:11], s45 offen offset:2048
    buffer_load_dwordx4 v[164:167], v2, s[8:11], s45 offen offset:3072
    s_mov_b32 s45, 16162816
    buffer_load_dwordx4 v[168:171], v2, s[8:11], s45 offen offset:0
    buffer_load_dwordx4 v[172:175], v2, s[8:11], s45 offen offset:1024
    v_mul_u32_u24 v3, 1311, v177
    v_lshrrev_b32 v3, 16, v3
    v_mul_u32_u24 v3, 50, v3
    v_sub_u32 v3, v177, v3
    v_subrev_u32 v4, 32, v3
    v_mov_b32 v8, 0
    v_mov_b32 v5, 1.0
    v_cmp_gt_u32 vcc, 4, v4
    s_nop 1
    v_cndmask_b32 v8, v8, v5, vcc
    v_cmp_le_u32 vcc, 48, v3
    s_nop 1
    v_cndmask_b32 v8, v8, -1, vcc
    v_lshlrev_b32 v6, 4, v177
    v_add_u32 v6, 65536, v6
    v_add_u32 v7, 64000, v6
    v_mov_b32 v9, v8
    v_mov_b32 v10, v8
    v_mov_b32 v11, v8
    v_cmp_gt_u32 vcc, 500, v177
    s_nop 0
    s_and_saveexec_b64 s[60:61], vcc
    ds_write_b128 v6, v[8:11] offset:0
    ds_write_b128 v6, v[8:11] offset:8000
    ds_write_b128 v6, v[8:11] offset:16000
    ds_write_b128 v6, v[8:11] offset:24000
    ds_write_b128 v6, v[8:11] offset:32000
    ds_write_b128 v6, v[8:11] offset:40000
    ds_write_b128 v6, v[8:11] offset:48000
    ds_write_b128 v6, v[8:11] offset:56000
    ds_write_b128 v7, v[8:11] offset:0
    ds_write_b128 v7, v[8:11] offset:8000
    ds_write_b128 v7, v[8:11] offset:16000
    ds_write_b128 v7, v[8:11] offset:24000
    s_mov_b64 exec, s[60:61]
    s_cmp_lg_u32 s16, 0
    s_cbranch_scc1 K2_NOH
    v_mov_b32 v3, 0
    v_mov_b32 v4, 162048
    ds_write_b32 v4, v3
    ds_write_b32 v4, v3 offset:8
    s_cmp_lg_u32 s20, 0
    s_cbranch_scc1 K2_NOH
    v_lshlrev_b32 v4, 2, v176
    v_add_u32 v4, 161536, v4
    ds_write_b32 v4, v3
    v_mov_b32 v4, 162052
    ds_write_b32 v4, v3
K2_NOH:
    s_waitcnt vmcnt(10)
    v_and_b32 v1, 1, v177
    v_add_u32 v1, s19, v1
    v_lshrrev_b32 v180, 16, v179
    v_sub_u32 v180, v180, v1
    v_and_b32 v179, 0xffff, v179
    v_add_u32 v179, v179, v1
    v_mul_u32_u24 v178, 1250, v178
    v_add_u32 v179, v179, v178
    v_mul_u32_u24 v181, 48, v179
    v_cmp_lt_i32 vcc, 0, v180
    s_nop 0
    s_cbranch_vccz K2_LD_DONE
    s_mov_b64 exec, vcc
    buffer_load_dwordx4 v[8:11], v181, s[8:11], 0 offen offset:32
    buffer_load_dwordx4 v[0:3], v181, s[8:11], 0 offen offset:0
    buffer_load_dwordx4 v[4:7], v181, s[8:11], 0 offen offset:16
    v_cmp_lt_i32 vcc, 2, v180
    s_nop 0
    s_cbranch_vccz K2_LD_DONE
    s_mov_b64 exec, vcc
    buffer_load_dwordx4 v[20:23], v181, s[8:11], 0 offen offset:128
    buffer_load_dwordx4 v[12:15], v181, s[8:11], 0 offen offset:96
    buffer_load_dwordx4 v[16:19], v181, s[8:11], 0 offen offset:112
    v_cmp_lt_i32 vcc, 4, v180
    s_nop 0
    s_cbranch_vccz K2_LD_DONE
    s_mov_b64 exec, vcc
    buffer_load_dwordx4 v[32:35], v181, s[8:11], 0 offen offset:224
    buffer_load_dwordx4 v[24:27], v181, s[8:11], 0 offen offset:192
    buffer_load_dwordx4 v[28:31], v181, s[8:11], 0 offen offset:208
    v_cmp_lt_i32 vcc, 6, v180
    s_nop 0
    s_cbranch_vccz K2_LD_DONE
    s_mov_b64 exec, vcc
    buffer_load_dwordx4 v[44:47], v181, s[8:11], 0 offen offset:320
    buffer_load_dwordx4 v[36:39], v181, s[8:11], 0 offen offset:288
    buffer_load_dwordx4 v[40:43], v181, s[8:11], 0 offen offset:304
    v_cmp_lt_i32 vcc, 8, v180
    s_nop 0
    s_cbranch_vccz K2_LD_DONE
    s_mov_b64 exec, vcc
    buffer_load_dwordx4 v[56:59], v181, s[8:11], 0 offen offset:416
    buffer_load_dwordx4 v[48:51], v181, s[8:11], 0 offen offset:384
    buffer_load_dwordx4 v[52:55], v181, s[8:11], 0 offen offset:400
    v_cmp_lt_i32 vcc, 10, v180
    s_nop 0
    s_cbranch_vccz K2_LD_DONE
    s_mov_b64 exec, vcc
    buffer_load_dwordx4 v[68:71], v181, s[8:11], 0 offen offset:512
    buffer_load_dwordx4 v[60:63], v181, s[8:11], 0 offen offset:480
    buffer_load_dwordx4 v[64:67], v181, s[8:11], 0 offen offset:496
    v_cmp_lt_i32 vcc, 12, v180
    s_nop 0
    s_cbranch_vccz K2_LD_DONE
    s_mov_b64 exec, vcc
    buffer_load_dwordx4 v[80:83], v181, s[8:11], 0 offen offset:608
    buffer_load_dwordx4 v[72:75], v181, s[8:11], 0 offen offset:576
    buffer_load_dwordx4 v[76:79], v181, s[8:11], 0 offen offset:592
    v_cmp_lt_i32 vcc, 14, v180
    s_nop 0
    s_cbranch_vccz K2_LD_DONE
    s_mov_b64 exec, vcc
    buffer_load_dwordx4 v[92:95], v181, s[8:11], 0 offen offset:704
    buffer_load_dwordx4 v[84:87], v181, s[8:11], 0 offen offset:672
    buffer_load_dwordx4 v[88:91], v181, s[8:11], 0 offen offset:688
    v_cmp_lt_i32 vcc, 16, v180
    s_nop 0
    s_cbranch_vccz K2_LD_DONE
    s_mov_b64 exec, vcc
    buffer_load_dwordx4 v[104:107], v181, s[8:11], 0 offen offset:800
    buffer_load_dwordx4 v[96:99], v181, s[8:11], 0 offen offset:768
    buffer_load_dwordx4 v[100:103], v181, s[8:11], 0 offen offset:784
    v_cmp_lt_i32 vcc, 18, v180
    s_nop 0
    s_cbranch_vccz K2_LD_DONE
    s_mov_b64 exec, vcc
    buffer_load_dwordx4 v[116:119], v181, s[8:11], 0 offen offset:896
    buffer_load_dwordx4 v[108:111], v181, s[8:11], 0 offen offset:864
    buffer_load_dwordx4 v[112:115], v181, s[8:11], 0 offen offset:880
K2_LD_DONE:
    s_mov_b64 exec, -1
    v_lshlrev_b32 v179, 2, v179
    s_mov_b32 s53, 16777216
    s_waitcnt lgkmcnt(0)
    s_barrier
    s_cmp_lg_u32 s20, 0
    s_cbranch_scc1 K2_RK_LOAD
    v_mov_b32 v178, 1
    v_cmp_lt_i32 vcc, 20, v180
    s_nop 0
    s_cbranch_vccz K2_NOMORE
    v_mov_b32 v177, 162052
    ds_write_b32 v177, v178
K2_NOMORE:
    s_waitcnt vmcnt(0)
    v_cmp_lt_i32 vcc, 0, v180
    s_nop 0
    s_cbranch_vccz K2_RK_DONE
    s_mov_b64 exec, vcc
    v_lshrrev_b32 v182, 16, v11
    v_lshlrev_b32 v182, 2, v182
    v_add_u32 v182, 161536, v182
    ds_add_rtn_u32 v120, v182, v178
    v_cmp_lt_i32 vcc, 2, v180
    s_nop 0
    s_cbranch_vccz K2_RK_DONE
    s_mov_b64 exec, vcc
    v_lshrrev_b32 v183, 16, v23
    v_lshlrev_b32 v183, 2, v183
    v_add_u32 v183, 161536, v183
    ds_add_rtn_u32 v121, v183, v178
    v_cmp_lt_i32 vcc, 4, v180
    s_nop 0
    s_cbranch_vccz K2_RK_DONE
    s_mov_b64 exec, vcc
    v_lshrrev_b32 v184, 16, v35
    v_lshlrev_b32 v184, 2, v184
    v_add_u32 v184, 161536, v184
    ds_add_rtn_u32 v122, v184, v178
    v_cmp_lt_i32 vcc, 6, v180
    s_nop 0
    s_cbranch_vccz K2_RK_DONE
    s_mov_b64 exec, vcc
    v_lshrrev_b32 v185, 16, v47
    v_lshlrev_b32 v185, 2, v185
    v_add_u32 v185, 161536, v185
    ds_add_rtn_u32 v123, v185, v178
    v_cmp_lt_i32 vcc, 8, v180
    s_nop 0
    s_cbranch_vccz K2_RK_DONE
    s_mov_b64 exec, vcc
    v_lshrrev_b32 v186, 16, v59
    v_lshlrev_b32 v186, 2, v186
    v_add_u32 v186, 161536, v186
    ds_add_rtn_u32 v124, v186, v178
    v_cmp_lt_i32 vcc, 10, v180
    s_nop 0
    s_cbranch_vccz K2_RK_DONE
    s_mov_b64 exec, vcc
    v_lshrrev_b32 v187, 16, v71
    v_lshlrev_b32 v187, 2, v187
    v_add_u32 v187, 161536, v187
    ds_add_rtn_u32 v125, v187, v178
    v_cmp_lt_i32 vcc, 12, v180
    s_nop 0
    s_cbranch_vccz K2_RK_DONE
    s_mov_b64 exec, vcc
    v_lshrrev_b32 v188, 16, v83
    v_lshlrev_b32 v188, 2, v188
    v_add_u32 v188, 161536, v188
    ds_add_rtn_u32 v126, v188, v178
    v_cmp_lt_i32 vcc, 14, v180
    s_nop 0
    s_cbranch_vccz K2_RK_DONE
    s_mov_b64 exec, vcc
    v_lshrrev_b32 v189, 16, v95
    v_lshlrev_b32 v189, 2, v189
    v_add_u32 v189, 161536, v189
    ds_add_rtn_u32 v127, v189, v178
    v_cmp_lt_i32 vcc, 16, v180
    s_nop 0
    s_cbranch_vccz K2_RK_DONE
    s_mov_b64 exec, vcc
    v_lshrrev_b32 v190, 16, v107
    v_lshlrev_b32 v190, 2, v190
    v_add_u32 v190, 161536, v190
    ds_add_rtn_u32 v128, v190, v178
    v_cmp_lt_i32 vcc, 18, v180
    s_nop 0
    s_cbranch_vccz K2_RK_DONE
    s_mov_b64 exec, vcc
    v_lshrrev_b32 v191, 16, v119
    v_lshlrev_b32 v191, 2, v191
    v_add_u32 v191, 161536, v191
    ds_add_rtn_u32 v129, v191, v178
    s_branch K2_RK_DONE
K2_RK_LOAD:
    s_waitcnt vmcnt(0)
    v_cmp_lt_i32 vcc, 0, v180
    s_nop 0
    s_cbranch_vccz K2_RK_DONE
    s_mov_b64 exec, vcc
    v_lshrrev_b32 v182, 16, v11
    v_lshlrev_b32 v182, 2, v182
    v_add_u32 v182, 161536, v182
    buffer_load_dword v120, v179, s[8:11], s53 offen offset:0
    v_cmp_lt_i32 vcc, 2, v180
    s_nop 0
    s_cbranch_vccz K2_RK_DONE
    s_mov_b64 exec, vcc
    v_lshrrev_b32 v183, 16, v23
    v_lshlrev_b32 v183, 2, v183
    v_add_u32 v183, 161536, v183
    buffer_load_dword v121, v179, s[8:11], s53 offen offset:8
    v_cmp_lt_i32 vcc, 4, v180
    s_nop 0
    s_cbranch_vccz K2_RK_DONE
    s_mov_b64 exec, vcc
    v_lshrrev_b32 v184, 16, v35
    v_lshlrev_b32 v184, 2, v184
    v_add_u32 v184, 161536, v184
    buffer_load_dword v122, v179, s[8:11], s53 offen offset:16
    v_cmp_lt_i32 vcc, 6, v180
    s_nop 0
    s_cbranch_vccz K2_RK_DONE
    s_mov_b64 exec, vcc
    v_lshrrev_b32 v185, 16, v47
    v_lshlrev_b32 v185, 2, v185
    v_add_u32 v185, 161536, v185
    buffer_load_dword v123, v179, s[8:11], s53 offen offset:24
    v_cmp_lt_i32 vcc, 8, v180
    s_nop 0
    s_cbranch_vccz K2_RK_DONE
    s_mov_b64 exec, vcc
    v_lshrrev_b32 v186, 16, v59
    v_lshlrev_b32 v186, 2, v186
    v_add_u32 v186, 161536, v186
    buffer_load_dword v124, v179, s[8:11], s53 offen offset:32
    v_cmp_lt_i32 vcc, 10, v180
    s_nop 0
    s_cbranch_vccz K2_RK_DONE
    s_mov_b64 exec, vcc
    v_lshrrev_b32 v187, 16, v71
    v_lshlrev_b32 v187, 2, v187
    v_add_u32 v187, 161536, v187
    buffer_load_dword v125, v179, s[8:11], s53 offen offset:40
    v_cmp_lt_i32 vcc, 12, v180
    s_nop 0
    s_cbranch_vccz K2_RK_DONE
    s_mov_b64 exec, vcc
    v_lshrrev_b32 v188, 16, v83
    v_lshlrev_b32 v188, 2, v188
    v_add_u32 v188, 161536, v188
    buffer_load_dword v126, v179, s[8:11], s53 offen offset:48
    v_cmp_lt_i32 vcc, 14, v180
    s_nop 0
    s_cbranch_vccz K2_RK_DONE
    s_mov_b64 exec, vcc
    v_lshrrev_b32 v189, 16, v95
    v_lshlrev_b32 v189, 2, v189
    v_add_u32 v189, 161536, v189
    buffer_load_dword v127, v179, s[8:11], s53 offen offset:56
    v_cmp_lt_i32 vcc, 16, v180
    s_nop 0
    s_cbranch_vccz K2_RK_DONE
    s_mov_b64 exec, vcc
    v_lshrrev_b32 v190, 16, v107
    v_lshlrev_b32 v190, 2, v190
    v_add_u32 v190, 161536, v190
    buffer_load_dword v128, v179, s[8:11], s53 offen offset:64
    v_cmp_lt_i32 vcc, 18, v180
    s_nop 0
    s_cbranch_vccz K2_RK_DONE
    s_mov_b64 exec, vcc
    v_lshrrev_b32 v191, 16, v119
    v_lshlrev_b32 v191, 2, v191
    v_add_u32 v191, 161536, v191
    buffer_load_dword v129, v179, s[8:11], s53 offen offset:72
K2_RK_DONE:
    s_mov_b64 exec, -1
    v_lshlrev_b32 v192, 2, v176
    v_add_u32 v192, 161536, v192
    v_mov_b32 v200, 162052
    s_waitcnt vmcnt(0) lgkmcnt(0)
    s_barrier
    ds_read_b32 v193, v192
    ds_read_b32 v200, v200
    s_waitcnt lgkmcnt(0)
    v_readfirstlane_b32 s23, v200
K2_TCALC:
    s_mul_i32 s54, s20, s22
    v_subrev_u32 v194, s54, v193
    v_max_i32 v194, 0, v194
    v_min_i32 v194, s22, v194
    v_add_u32 v194, 15, v194
    v_lshrrev_b32 v194, 4, v194
    v_max_u32 v194, 1, v194
    v_max_u32 v195, 2, v194
    v_cmp_gt_u32 vcc, s18, v176
    s_nop 1
    v_cndmask_b32 v195, 0, v195, vcc
    v_mov_b32 v196, v195
    s_nop 1
    v_add_u32_dpp v196, v196, v196 row_shr:1 row_mask:0xf bank_mask:0xf bound_ctrl:0
    s_nop 1
    v_add_u32_dpp v196, v196, v196 row_shr:2 row_mask:0xf bank_mask:0xf bound_ctrl:0
    s_nop 1
    v_add_u32_dpp v196, v196, v196 row_shr:4 row_mask:0xf bank_mask:0xf bound_ctrl:0
    s_nop 1
    v_add_u32_dpp v196, v196, v196 row_shr:8 row_mask:0xf bank_mask:0xf bound_ctrl:0
    s_nop 1
    v_add_u32_dpp v196, v196, v196 row_bcast:15 row_mask:0xa bank_mask:0xf
    s_nop 1
    v_add_u32_dpp v196, v196, v196 row_bcast:31 row_mask:0xc bank_mask:0xf
    s_cmp_lg_u32 s22, 64
    s_cbranch_scc1 K2_TOK
    v_readlane_b32 s45, v196, 63
    v_cmp_lt_u32 vcc, 64, v193
    s_cmp_gt_u32 s45, 119
    s_cbranch_scc1 K2_SLOW
    s_cbranch_vccz K2_TOK
K2_SLOW:
    v_mov_b32 v197, v193
    s_nop 1
    v_max_u32_dpp v197, v197, v197 row_shr:1 row_mask:0xf bank_mask:0xf bound_ctrl:0
    s_nop 1
    v_max_u32_dpp v197, v197, v197 row_shr:2 row_mask:0xf bank_mask:0xf bound_ctrl:0
    s_nop 1
    v_max_u32_dpp v197, v197, v197 row_shr:4 row_mask:0xf bank_mask:0xf bound_ctrl:0
    s_nop 1
    v_max_u32_dpp v197, v197, v197 row_shr:8 row_mask:0xf bank_mask:0xf bound_ctrl:0
    s_nop 1
    v_max_u32_dpp v197, v197, v197 row_bcast:15 row_mask:0xa bank_mask:0xf
    s_nop 1
    v_max_u32_dpp v197, v197, v197 row_bcast:31 row_mask:0xc bank_mask:0xf
    s_nop 0
    v_readlane_b32 s21, v197, 63
    s_nop 0
    s_add_u32 s21, s21, 31
    s_lshr_b32 s21, s21, 5
    s_mov_b32 s22, 32
    v_cmp_lt_i32 vcc, 0, v180
    s_nop 0
    s_cbranch_vccz K2_SV_DONE
    s_mov_b64 exec, vcc
    buffer_store_dword v120, v179, s[8:11], s53 offen offset:0
    v_cmp_lt_i32 vcc, 2, v180
    s_nop 0
    s_cbranch_vccz K2_SV_DONE
    s_mov_b64 exec, vcc
    buffer_store_dword v121, v179, s[8:11], s53 offen offset:8
    v_cmp_lt_i32 vcc, 4, v180
    s_nop 0
    s_cbranch_vccz K2_SV_DONE
    s_mov_b64 exec, vcc
    buffer_store_dword v122, v179, s[8:11], s53 offen offset:16
    v_cmp_lt_i32 vcc, 6, v180
    s_nop 0
    s_cbranch_vccz K2_SV_DONE
    s_mov_b64 exec, vcc
    buffer_store_dword v123, v179, s[8:11], s53 offen offset:24
    v_cmp_lt_i32 vcc, 8, v180
    s_nop 0
    s_cbranch_vccz K2_SV_DONE
    s_mov_b64 exec, vcc
    buffer_store_dword v124, v179, s[8:11], s53 offen offset:32
    v_cmp_lt_i32 vcc, 10, v180
    s_nop 0
    s_cbranch_vccz K2_SV_DONE
    s_mov_b64 exec, vcc
    buffer_store_dword v125, v179, s[8:11], s53 offen offset:40
    v_cmp_lt_i32 vcc, 12, v180
    s_nop 0
    s_cbranch_vccz K2_SV_DONE
    s_mov_b64 exec, vcc
    buffer_store_dword v126, v179, s[8:11], s53 offen offset:48
    v_cmp_lt_i32 vcc, 14, v180
    s_nop 0
    s_cbranch_vccz K2_SV_DONE
    s_mov_b64 exec, vcc
    buffer_store_dword v127, v179, s[8:11], s53 offen offset:56
    v_cmp_lt_i32 vcc, 16, v180
    s_nop 0
    s_cbranch_vccz K2_SV_DONE
    s_mov_b64 exec, vcc
    buffer_store_dword v128, v179, s[8:11], s53 offen offset:64
    v_cmp_lt_i32 vcc, 18, v180
    s_nop 0
    s_cbranch_vccz K2_SV_DONE
    s_mov_b64 exec, vcc
    buffer_store_dword v129, v179, s[8:11], s53 offen offset:72
K2_SV_DONE:
    s_mov_b64 exec, -1
    s_branch K2_TCALC
K2_TOK:
    v_sub_u32 v196, v196, v195
    s_movk_i32 s45, 800
    v_mov_b32 v197, 65536
    v_mad_u32_u24 v196, v196, s45, v197
    v_lshlrev_b32 v197, 5, v176
    v_sub_u32 v197, v197, v196
    v_and_b32 v197, 0xff, v197
    v_cmp_lt_u32 vcc, 192, v197
    v_cmp_gt_u32 s[60:61], 3, v194
    s_nop 0
    s_and_b64 vcc, vcc, s[60:61]
    v_cndmask_b32 v197, v197, 0, vcc
    v_lshl_or_b32 v253, v194, 18, v196
    v_lshl_or_b32 v253, v197, 21, v253
    v_mov_b32 v197, 422880
    v_cmp_gt_u32 vcc, s18, v176
    s_nop 1
    v_cndmask_b32 v253, v197, v253, vcc
    ds_write_b32 v192, v196 offset:256
    s_waitcnt lgkmcnt(0)
    v_cmp_lt_i32 vcc, 0, v180
    s_nop 0
    s_cbranch_vccz K2_TB_DONE
    s_mov_b64 exec, vcc
    ds_read_b32 v182, v182 offset:256
    v_cmp_lt_i32 vcc, 2, v180
    s_nop 0
    s_cbranch_vccz K2_TB_DONE
    s_mov_b64 exec, vcc
    ds_read_b32 v183, v183 offset:256
    v_cmp_lt_i32 vcc, 4, v180
    s_nop 0
    s_cbranch_vccz K2_TB_DONE
    s_mov_b64 exec, vcc
    ds_read_b32 v184, v184 offset:256
    v_cmp_lt_i32 vcc, 6, v180
    s_nop 0
    s_cbranch_vccz K2_TB_DONE
    s_mov_b64 exec, vcc
    ds_read_b32 v185, v185 offset:256
    v_cmp_lt_i32 vcc, 8, v180
    s_nop 0
    s_cbranch_vccz K2_TB_DONE
    s_mov_b64 exec, vcc
    ds_read_b32 v186, v186 offset:256
    v_cmp_lt_i32 vcc, 10, v180
    s_nop 0
    s_cbranch_vccz K2_TB_DONE
    s_mov_b64 exec, vcc
    ds_read_b32 v187, v187 offset:256
    v_cmp_lt_i32 vcc, 12, v180
    s_nop 0
    s_cbranch_vccz K2_TB_DONE
    s_mov_b64 exec, vcc
    ds_read_b32 v188, v188 offset:256
    v_cmp_lt_i32 vcc, 14, v180
    s_nop 0
    s_cbranch_vccz K2_TB_DONE
    s_mov_b64 exec, vcc
    ds_read_b32 v189, v189 offset:256
    v_cmp_lt_i32 vcc, 16, v180
    s_nop 0
    s_cbranch_vccz K2_TB_DONE
    s_mov_b64 exec, vcc
    ds_read_b32 v190, v190 offset:256
    v_cmp_lt_i32 vcc, 18, v180
    s_nop 0
    s_cbranch_vccz K2_TB_DONE
    s_mov_b64 exec, vcc
    ds_read_b32 v191, v191 offset:256
K2_TB_DONE:
    s_mov_b64 exec, -1
    s_movk_i32 s45, 800
    s_waitcnt lgkmcnt(0)
    v_cmp_lt_i32 vcc, 0, v180
    s_nop 0
    s_cbranch_vccz K2_SC_DONE
    v_subrev_u32 v120, s54, v120
    v_cmp_gt_u32 s[60:61], s22, v120
    s_nop 0
    s_and_b64 exec, vcc, s[60:61]
    s_cbranch_execz K2_sc_1
    v_lshrrev_b32 v192, 4, v120
    v_mad_u32_u24 v192, v192, s45, v182
    v_and_b32 v193, 15, v120
    v_lshl_add_u32 v194, v193, 5, v192
    v_lshl_add_u32 v195, v193, 2, v192
    v_and_b32 v196, 7, v193
    v_lshrrev_b32 v193, 3, v193
    v_lshl_add_u32 v196, v196, 2, v192
    v_lshl_add_u32 v196, v193, 1, v196
    ds_write_b128 v194, v[0:3]
    ds_write_b128 v194, v[4:7] offset:16
    ds_write2_b32 v195, v8, v9 offset0:144 offset1:160
    ds_write_b32 v195, v10 offset:704
    ds_write_b16 v196, v11 offset:768
K2_sc_1:
    s_mov_b64 exec, -1
    v_cmp_lt_i32 vcc, 2, v180
    s_nop 0
    s_cbranch_vccz K2_SC_DONE
    v_subrev_u32 v121, s54, v121
    v_cmp_gt_u32 s[60:61], s22, v121
    s_nop 0
    s_and_b64 exec, vcc, s[60:61]
    s_cbranch_execz K2_sc_2
    v_lshrrev_b32 v192, 4, v121
    v_mad_u32_u24 v192, v192, s45, v183
    v_and_b32 v193, 15, v121
    v_lshl_add_u32 v194, v193, 5, v192
    v_lshl_add_u32 v195, v193, 2, v192
    v_and_b32 v196, 7, v193
    v_lshrrev_b32 v193, 3, v193
    v_lshl_add_u32 v196, v196, 2, v192
    v_lshl_add_u32 v196, v193, 1, v196
    ds_write_b128 v194, v[12:15]
    ds_write_b128 v194, v[16:19] offset:16
    ds_write2_b32 v195, v20, v21 offset0:144 offset1:160
    ds_write_b32 v195, v22 offset:704
    ds_write_b16 v196, v23 offset:768
K2_sc_2:
    s_mov_b64 exec, -1
    v_cmp_lt_i32 vcc, 4, v180
    s_nop 0
    s_cbranch_vccz K2_SC_DONE
    v_subrev_u32 v122, s54, v122
    v_cmp_gt_u32 s[60:61], s22, v122
    s_nop 0
    s_and_b64 exec, vcc, s[60:61]
    s_cbranch_execz K2_sc_3
    v_lshrrev_b32 v192, 4, v122
    v_mad_u32_u24 v192, v192, s45, v184
    v_and_b32 v193, 15, v122
    v_lshl_add_u32 v194, v193, 5, v192
    v_lshl_add_u32 v195, v193, 2, v192
    v_and_b32 v196, 7, v193
    v_lshrrev_b32 v193, 3, v193
    v_lshl_add_u32 v196, v196, 2, v192
    v_lshl_add_u32 v196, v193, 1, v196
    ds_write_b128 v194, v[24:27]
    ds_write_b128 v194, v[28:31] offset:16
    ds_write2_b32 v195, v32, v33 offset0:144 offset1:160
    ds_write_b32 v195, v34 offset:704
    ds_write_b16 v196, v35 offset:768
K2_sc_3:
    s_mov_b64 exec, -1
    v_cmp_lt_i32 vcc, 6, v180
    s_nop 0
    s_cbranch_vccz K2_SC_DONE
    v_subrev_u32 v123, s54, v123
    v_cmp_gt_u32 s[60:61], s22, v123
    s_nop 0
    s_and_b64 exec, vcc, s[60:61]
    s_cbranch_execz K2_sc_4
    v_lshrrev_b32 v192, 4, v123
    v_mad_u32_u24 v192, v192, s45, v185
    v_and_b32 v193, 15, v123
    v_lshl_add_u32 v194, v193, 5, v192
    v_lshl_add_u32 v195, v193, 2, v192
    v_and_b32 v196, 7, v193
    v_lshrrev_b32 v193, 3, v193
    v_lshl_add_u32 v196, v196, 2, v192
    v_lshl_add_u32 v196, v193, 1, v196
    ds_write_b128 v194, v[36:39]
    ds_write_b128 v194, v[40:43] offset:16
    ds_write2_b32 v195, v44, v45 offset0:144 offset1:160
    ds_write_b32 v195, v46 offset:704
    ds_write_b16 v196, v47 offset:768
K2_sc_4:
    s_mov_b64 exec, -1
    v_cmp_lt_i32 vcc, 8, v180
    s_nop 0
    s_cbranch_vccz K2_SC_DONE
    v_subrev_u32 v124, s54, v124
    v_cmp_gt_u32 s[60:61], s22, v124
    s_nop 0
    s_and_b64 exec, vcc, s[60:61]
    s_cbranch_execz K2_sc_5
    v_lshrrev_b32 v192, 4, v124
    v_mad_u32_u24 v192, v192, s45, v186
    v_and_b32 v193, 15, v124
    v_lshl_add_u32 v194, v193, 5, v192
    v_lshl_add_u32 v195, v193, 2, v192
    v_and_b32 v196, 7, v193
    v_lshrrev_b32 v193, 3, v193
    v_lshl_add_u32 v196, v196, 2, v192
    v_lshl_add_u32 v196, v193, 1, v196
    ds_write_b128 v194, v[48:51]
    ds_write_b128 v194, v[52:55] offset:16
    ds_write2_b32 v195, v56, v57 offset0:144 offset1:160
    ds_write_b32 v195, v58 offset:704
    ds_write_b16 v196, v59 offset:768
K2_sc_5:
    s_mov_b64 exec, -1
    v_cmp_lt_i32 vcc, 10, v180
    s_nop 0
    s_cbranch_vccz K2_SC_DONE
    v_subrev_u32 v125, s54, v125
    v_cmp_gt_u32 s[60:61], s22, v125
    s_nop 0
    s_and_b64 exec, vcc, s[60:61]
    s_cbranch_execz K2_sc_6
    v_lshrrev_b32 v192, 4, v125
    v_mad_u32_u24 v192, v192, s45, v187
    v_and_b32 v193, 15, v125
    v_lshl_add_u32 v194, v193, 5, v192
    v_lshl_add_u32 v195, v193, 2, v192
    v_and_b32 v196, 7, v193
    v_lshrrev_b32 v193, 3, v193
    v_lshl_add_u32 v196, v196, 2, v192
    v_lshl_add_u32 v196, v193, 1, v196
    ds_write_b128 v194, v[60:63]
    ds_write_b128 v194, v[64:67] offset:16
    ds_write2_b32 v195, v68, v69 offset0:144 offset1:160
    ds_write_b32 v195, v70 offset:704
    ds_write_b16 v196, v71 offset:768
K2_sc_6:
    s_mov_b64 exec, -1
    v_cmp_lt_i32 vcc, 12, v180
    s_nop 0
    s_cbranch_vccz K2_SC_DONE
    v_subrev_u32 v126, s54, v126
    v_cmp_gt_u32 s[60:61], s22, v126
    s_nop 0
    s_and_b64 exec, vcc, s[60:61]
    s_cbranch_execz K2_sc_7
    v_lshrrev_b32 v192, 4, v126
    v_mad_u32_u24 v192, v192, s45, v188
    v_and_b32 v193, 15, v126
    v_lshl_add_u32 v194, v193, 5, v192
    v_lshl_add_u32 v195, v193, 2, v192
    v_and_b32 v196, 7, v193
    v_lshrrev_b32 v193, 3, v193
    v_lshl_add_u32 v196, v196, 2, v192
    v_lshl_add_u32 v196, v193, 1, v196
    ds_write_b128 v194, v[72:75]
    ds_write_b128 v194, v[76:79] offset:16
    ds_write2_b32 v195, v80, v81 offset0:144 offset1:160
    ds_write_b32 v195, v82 offset:704
    ds_write_b16 v196, v83 offset:768
K2_sc_7:
    s_mov_b64 exec, -1
    v_cmp_lt_i32 vcc, 14, v180
    s_nop 0
    s_cbranch_vccz K2_SC_DONE
    v_subrev_u32 v127, s54, v127
    v_cmp_gt_u32 s[60:61], s22, v127
    s_nop 0
    s_and_b64 exec, vcc, s[60:61]
    s_cbranch_execz K2_sc_8
    v_lshrrev_b32 v192, 4, v127
    v_mad_u32_u24 v192, v192, s45, v189
    v_and_b32 v193, 15, v127
    v_lshl_add_u32 v194, v193, 5, v192
    v_lshl_add_u32 v195, v193, 2, v192
    v_and_b32 v196, 7, v193
    v_lshrrev_b32 v193, 3, v193
    v_lshl_add_u32 v196, v196, 2, v192
    v_lshl_add_u32 v196, v193, 1, v196
    ds_write_b128 v194, v[84:87]
    ds_write_b128 v194, v[88:91] offset:16
    ds_write2_b32 v195, v92, v93 offset0:144 offset1:160
    ds_write_b32 v195, v94 offset:704
    ds_write_b16 v196, v95 offset:768
K2_sc_8:
    s_mov_b64 exec, -1
    v_cmp_lt_i32 vcc, 16, v180
    s_nop 0
    s_cbranch_vccz K2_SC_DONE
    v_subrev_u32 v128, s54, v128
    v_cmp_gt_u32 s[60:61], s22, v128
    s_nop 0
    s_and_b64 exec, vcc, s[60:61]
    s_cbranch_execz K2_sc_9
    v_lshrrev_b32 v192, 4, v128
    v_mad_u32_u24 v192, v192, s45, v190
    v_and_b32 v193, 15, v128
    v_lshl_add_u32 v194, v193, 5, v192
    v_lshl_add_u32 v195, v193, 2, v192
    v_and_b32 v196, 7, v193
    v_lshrrev_b32 v193, 3, v193
    v_lshl_add_u32 v196, v196, 2, v192
    v_lshl_add_u32 v196, v193, 1, v196
    ds_write_b128 v194, v[96:99]
    ds_write_b128 v194, v[100:103] offset:16
    ds_write2_b32 v195, v104, v105 offset0:144 offset1:160
    ds_write_b32 v195, v106 offset:704
    ds_write_b16 v196, v107 offset:768
K2_sc_9:
    s_mov_b64 exec, -1
    v_cmp_lt_i32 vcc, 18, v180
    s_nop 0
    s_cbranch_vccz K2_SC_DONE
    v_subrev_u32 v129, s54, v129
    v_cmp_gt_u32 s[60:61], s22, v129
    s_nop 0
    s_and_b64 exec, vcc, s[60:61]
    s_cbranch_execz K2_sc_10
    v_lshrrev_b32 v192, 4, v129
    v_mad_u32_u24 v192, v192, s45, v191
    v_and_b32 v193, 15, v129
    v_lshl_add_u32 v194, v193, 5, v192
    v_lshl_add_u32 v195, v193, 2, v192
    v_and_b32 v196, 7, v193
    v_lshrrev_b32 v193, 3, v193
    v_lshl_add_u32 v196, v196, 2, v192
    v_lshl_add_u32 v196, v193, 1, v196
    ds_write_b128 v194, v[108:111]
    ds_write_b128 v194, v[112:115] offset:16
    ds_write2_b32 v195, v116, v117 offset0:144 offset1:160
    ds_write_b32 v195, v118 offset:704
    ds_write_b16 v196, v119 offset:768
K2_sc_10:
    s_mov_b64 exec, -1
K2_SC_DONE:
    s_mov_b64 exec, -1
    v_and_b32 v0, 15, v176
    v_lshrrev_b32 v1, 5, v176
    v_bfe_u32 v2, v176, 4, 1
    v_lshrrev_b32 v3, 2, v0
    v_and_b32 v4, 3, v0
    v_lshl_add_u32 v5, v1, 3, v3
    v_lshlrev_b32 v249, 5, v5
    v_lshl_add_u32 v249, v4, 3, v249
    v_lshlrev_b32 v250, 6, v2
    v_lshl_add_u32 v250, v1, 5, v250
    v_add_u32 v250, 512, v250
    v_lshrrev_b32 v6, 1, v4
    v_lshl_add_u32 v6, v2, 1, v6
    v_bfe_u32 v7, v3, 1, 1
    v_lshlrev_b32 v7, 2, v7
    v_xor_b32 v6, v6, v7
    v_lshlrev_b32 v6, 4, v6
    v_lshl_add_u32 v6, v5, 7, v6
    v_and_b32 v7, 1, v4
    v_lshl_add_u32 v6, v7, 3, v6
    v_add_u32 v246, s34, v6
    v_xor_b32 v247, 64, v246
    v_lshrrev_b32 v6, 3, v176
    v_lshlrev_b32 v251, 2, v6
    v_add_u32 v251, 768, v251
    v_bfe_u32 v6, v6, 1, 1
    v_lshlrev_b32 v6, 2, v6
    v_and_b32 v7, 7, v176
    v_xor_b32 v6, v6, v7
    v_lshlrev_b32 v248, 4, v6
    v_lshlrev_b32 v252, 1, v176
    v_lshlrev_b32 v96, 16, v136
    v_and_b32 v97, 0xffff0000, v136
    v_lshlrev_b32 v98, 16, v137
    v_and_b32 v99, 0xffff0000, v137
    v_lshlrev_b32 v100, 16, v138
    v_and_b32 v101, 0xffff0000, v138
    v_lshlrev_b32 v102, 16, v139
    v_and_b32 v103, 0xffff0000, v139
    v_lshlrev_b32 v104, 16, v140
    v_and_b32 v105, 0xffff0000, v140
    v_lshlrev_b32 v106, 16, v141
    v_and_b32 v107, 0xffff0000, v141
    v_lshlrev_b32 v108, 16, v142
    v_and_b32 v109, 0xffff0000, v142
    v_lshlrev_b32 v110, 16, v143
    v_and_b32 v111, 0xffff0000, v143
    v_lshlrev_b32 v112, 16, v144
    v_and_b32 v113, 0xffff0000, v144
    v_lshlrev_b32 v114, 16, v145
    v_and_b32 v115, 0xffff0000, v145
    v_lshlrev_b32 v116, 16, v146
    v_and_b32 v117, 0xffff0000, v146
    v_lshlrev_b32 v118, 16, v147
    v_and_b32 v119, 0xffff0000, v147
    v_lshlrev_b32 v120, 16, v148
    v_and_b32 v121, 0xffff0000, v148
    v_lshlrev_b32 v122, 16, v149
    v_and_b32 v123, 0xffff0000, v149
    v_lshlrev_b32 v124, 16, v150
    v_and_b32 v125, 0xffff0000, v150
    v_lshlrev_b32 v126, 16, v151
    v_and_b32 v127, 0xffff0000, v151
    v_lshlrev_b32 v128, 16, v152
    v_and_b32 v129, 0xffff0000, v152
    v_lshlrev_b32 v130, 16, v153
    v_and_b32 v131, 0xffff0000, v153
    v_lshlrev_b32 v132, 16, v154
    v_and_b32 v133, 0xffff0000, v154
    v_lshlrev_b32 v134, 16, v155
    v_and_b32 v135, 0xffff0000, v155
    v_lshlrev_b32 v136, 16, v156
    v_and_b32 v137, 0xffff0000, v156
    v_lshlrev_b32 v138, 16, v157
    v_and_b32 v139, 0xffff0000, v157
    v_lshlrev_b32 v140, 16, v158
    v_and_b32 v141, 0xffff0000, v158
    v_lshlrev_b32 v142, 16, v159
    v_and_b32 v143, 0xffff0000, v159
    v_lshlrev_b32 v144, 16, v160
    v_and_b32 v145, 0xffff0000, v160
    v_lshlrev_b32 v146, 16, v161
    v_and_b32 v147, 0xffff0000, v161
    v_lshlrev_b32 v148, 16, v162
    v_and_b32 v149, 0xffff0000, v162
    v_lshlrev_b32 v150, 16, v163
    v_and_b32 v151, 0xffff0000, v163
    v_lshlrev_b32 v152, 16, v164
    v_and_b32 v153, 0xffff0000, v164
    v_lshlrev_b32 v154, 16, v165
    v_and_b32 v155, 0xffff0000, v165
    v_lshlrev_b32 v156, 16, v166
    v_and_b32 v157, 0xffff0000, v166
    v_lshlrev_b32 v158, 16, v167
    v_and_b32 v159, 0xffff0000, v167
    v_lshlrev_b32 v160, 16, v168
    v_and_b32 v161, 0xffff0000, v168
    v_lshlrev_b32 v162, 16, v169
    v_and_b32 v163, 0xffff0000, v169
    v_lshlrev_b32 v164, 16, v170
    v_and_b32 v165, 0xffff0000, v170
    v_lshlrev_b32 v166, 16, v171
    v_and_b32 v167, 0xffff0000, v171
    v_lshlrev_b32 v168, 16, v172
    v_and_b32 v169, 0xffff0000, v172
    v_lshlrev_b32 v170, 16, v173
    v_and_b32 v171, 0xffff0000, v173
    v_lshlrev_b32 v172, 16, v174
    v_and_b32 v173, 0xffff0000, v174
    v_lshlrev_b32 v174, 16, v175
    v_and_b32 v175, 0xffff0000, v175
    s_movk_i32 s36, 0
    s_movk_i32 s37, 256
    s_movk_i32 s38, 512
    s_movk_i32 s39, 768
    s_mov_b32 s35, 0
    s_mov_b32 s31, 0
    s_mov_b32 s32, 0
    s_mov_b32 s33, 1
    s_mov_b32 s27, 0
    s_mov_b32 s45, s16
    s_waitcnt lgkmcnt(0)
    s_barrier
    v_readlane_b32 s46, v253, s45
    s_nop 0
    s_and_b32 s29, s46, 0x3ffff
    s_bfe_u32 s30, s46, 0x30012
    s_cmp_eq_u32 s31, 0
    s_cbranch_scc1 K2_p1_11
    s_lshr_b32 s32, s46, 21
    s_add_u32 s32, s32, s29
K2_p1_11:
    s_lshl_b32 s47, s30, 3
    s_sub_u32 s47, s47, 8
    s_lshr_b32 s48, 0x4050e4, s47
    s_lshr_b32 s49, 0xe4244400, s47
    s_lshl_b32 s50, s31, 7
    s_mov_b32 s40, s50
    v_add_u32 v230, s29, v251
    s_bfe_u32 s51, s48, 0x20002
    s_lshl_b32 s51, s51, 8
    s_add_u32 s41, s51, s50
    s_bfe_u32 s51, s49, 0x20002
    s_mul_i32 s51, s51, 800
    s_add_u32 s51, s51, s29
    v_add_u32 v231, s51, v251
    s_bfe_u32 s51, s48, 0x20004
    s_lshl_b32 s51, s51, 8
    s_add_u32 s42, s51, s50
    s_bfe_u32 s51, s49, 0x20004
    s_mul_i32 s51, s51, 800
    s_add_u32 s51, s51, s29
    v_add_u32 v232, s51, v251
    s_bfe_u32 s51, s48, 0x20006
    s_lshl_b32 s51, s51, 8
    s_add_u32 s43, s51, s50
    s_bfe_u32 s51, s49, 0x20006
    s_mul_i32 s51, s51, 800
    s_add_u32 s51, s51, s29
    v_add_u32 v233, s51, v251
    ds_read_b32 v230, v230
    ds_read_b32 v231, v231
    ds_read_b32 v232, v232
    ds_read_b32 v233, v233
    s_waitcnt lgkmcnt(0)
    v_mad_u32_u16 v222, v230, s44, v248
    v_mad_u32_u16 v223, v230, s44, v248 op_sel:[1,0,0,0]
    v_mad_u32_u16 v224, v231, s44, v248
    v_mad_u32_u16 v225, v231, s44, v248 op_sel:[1,0,0,0]
    v_mad_u32_u16 v226, v232, s44, v248
    v_mad_u32_u16 v227, v232, s44, v248 op_sel:[1,0,0,0]
    v_mad_u32_u16 v228, v233, s44, v248
    v_mad_u32_u16 v229, v233, s44, v248 op_sel:[1,0,0,0]
    s_add_u32 m0, s34, 0
    s_nop 0
    buffer_load_dwordx4 v222, s[4:7], s40 offen lds
    s_add_u32 m0, s34, 1024
    s_nop 0
    buffer_load_dwordx4 v223, s[4:7], s40 offen lds
    s_add_u32 m0, s34, 2048
    s_nop 0
    buffer_load_dwordx4 v224, s[4:7], s41 offen lds
    s_add_u32 m0, s34, 3072
    s_nop 0
    buffer_load_dwordx4 v225, s[4:7], s41 offen lds
    s_add_u32 m0, s34, 4096
    s_nop 0
    buffer_load_dwordx4 v226, s[4:7], s42 offen lds
    s_add_u32 m0, s34, 5120
    s_nop 0
    buffer_load_dwordx4 v227, s[4:7], s42 offen lds
    s_add_u32 m0, s34, 6144
    s_nop 0
    buffer_load_dwordx4 v228, s[4:7], s43 offen lds
    s_add_u32 m0, s34, 7168
    s_nop 0
    buffer_load_dwordx4 v229, s[4:7], s43 offen lds
    s_waitcnt vmcnt(6)
    ds_read_b64_tr_b16 v[176:177], v246 offset:0
    ds_read_b64_tr_b16 v[178:179], v246 offset:512
    ds_read_b64_tr_b16 v[180:181], v247 offset:0
    ds_read_b64_tr_b16 v[182:183], v247 offset:512
K2_NEXT:
    s_cmp_eq_u32 s33, 0
    s_cbranch_scc1 K2_TAIL
    s_cmp_eq_u32 s31, s27
    s_cbranch_scc1 K2_SAMEPH
    v_lshlrev_b32 v0, 3, v252
    s_mov_b32 s45, 16164864
    buffer_load_dwordx4 v[136:139], v0, s[8:11], s45 offen offset:0
    buffer_load_dwordx4 v[140:143], v0, s[8:11], s45 offen offset:1024
    buffer_load_dwordx4 v[144:147], v0, s[8:11], s45 offen offset:2048
    buffer_load_dwordx4 v[148:151], v0, s[8:11], s45 offen offset:3072
    s_mov_b32 s45, 16168960
    buffer_load_dwordx4 v[152:155], v0, s[8:11], s45 offen offset:0
    buffer_load_dwordx4 v[156:159], v0, s[8:11], s45 offen offset:1024
    buffer_load_dwordx4 v[160:163], v0, s[8:11], s45 offen offset:2048
    buffer_load_dwordx4 v[164:167], v0, s[8:11], s45 offen offset:3072
    s_mov_b32 s45, 16173056
    buffer_load_dwordx4 v[168:171], v0, s[8:11], s45 offen offset:0
    buffer_load_dwordx4 v[172:175], v0, s[8:11], s45 offen offset:1024
    s_movk_i32 s36, 128
    s_movk_i32 s37, 384
    s_movk_i32 s38, 640
    s_movk_i32 s39, 896
    v_mov_b32 v1, 162056
K2_SPIN:
    ds_read_b32 v2, v1
    s_waitcnt lgkmcnt(0)
    v_readfirstlane_b32 s45, v2
    s_nop 0
    s_cmp_lt_u32 s45, 8
    s_cbranch_scc1 K2_SPIN
    s_waitcnt vmcnt(0)
    v_lshlrev_b32 v96, 16, v136
    v_and_b32 v97, 0xffff0000, v136
    v_lshlrev_b32 v98, 16, v137
    v_and_b32 v99, 0xffff0000, v137
    v_lshlrev_b32 v100, 16, v138
    v_and_b32 v101, 0xffff0000, v138
    v_lshlrev_b32 v102, 16, v139
    v_and_b32 v103, 0xffff0000, v139
    v_lshlrev_b32 v104, 16, v140
    v_and_b32 v105, 0xffff0000, v140
    v_lshlrev_b32 v106, 16, v141
    v_and_b32 v107, 0xffff0000, v141
    v_lshlrev_b32 v108, 16, v142
    v_and_b32 v109, 0xffff0000, v142
    v_lshlrev_b32 v110, 16, v143
    v_and_b32 v111, 0xffff0000, v143
    v_lshlrev_b32 v112, 16, v144
    v_and_b32 v113, 0xffff0000, v144
    v_lshlrev_b32 v114, 16, v145
    v_and_b32 v115, 0xffff0000, v145
    v_lshlrev_b32 v116, 16, v146
    v_and_b32 v117, 0xffff0000, v146
    v_lshlrev_b32 v118, 16, v147
    v_and_b32 v119, 0xffff0000, v147
    v_lshlrev_b32 v120, 16, v148
    v_and_b32 v121, 0xffff0000, v148
    v_lshlrev_b32 v122, 16, v149
    v_and_b32 v123, 0xffff0000, v149
    v_lshlrev_b32 v124, 16, v150
    v_and_b32 v125, 0xffff0000, v150
    v_lshlrev_b32 v126, 16, v151
    v_and_b32 v127, 0xffff0000, v151
    v_lshlrev_b32 v128, 16, v152
    v_and_b32 v129, 0xffff0000, v152
    v_lshlrev_b32 v130, 16, v153
    v_and_b32 v131, 0xffff0000, v153
    v_lshlrev_b32 v132, 16, v154
    v_and_b32 v133, 0xffff0000, v154
    v_lshlrev_b32 v134, 16, v155
    v_and_b32 v135, 0xffff0000, v155
    v_lshlrev_b32 v136, 16, v156
    v_and_b32 v137, 0xffff0000, v156
    v_lshlrev_b32 v138, 16, v157
    v_and_b32 v139, 0xffff0000, v157
    v_lshlrev_b32 v140, 16, v158
    v_and_b32 v141, 0xffff0000, v158
    v_lshlrev_b32 v142, 16, v159
    v_and_b32 v143, 0xffff0000, v159
    v_lshlrev_b32 v144, 16, v160
    v_and_b32 v145, 0xffff0000, v160
    v_lshlrev_b32 v146, 16, v161
    v_and_b32 v147, 0xffff0000, v161
    v_lshlrev_b32 v148, 16, v162
    v_and_b32 v149, 0xffff0000, v162
    v_lshlrev_b32 v150, 16, v163
    v_and_b32 v151, 0xffff0000, v163
    v_lshlrev_b32 v152, 16, v164
    v_and_b32 v153, 0xffff0000, v164
    v_lshlrev_b32 v154, 16, v165
    v_and_b32 v155, 0xffff0000, v165
    v_lshlrev_b32 v156, 16, v166
    v_and_b32 v157, 0xffff0000, v166
    v_lshlrev_b32 v158, 16, v167
    v_and_b32 v159, 0xffff0000, v167
    v_lshlrev_b32 v160, 16, v168
    v_and_b32 v161, 0xffff0000, v168
    v_lshlrev_b32 v162, 16, v169
    v_and_b32 v163, 0xffff0000, v169
    v_lshlrev_b32 v164, 16, v170
    v_and_b32 v165, 0xffff0000, v170
    v_lshlrev_b32 v166, 16, v171
    v_and_b32 v167, 0xffff0000, v171
    v_lshlrev_b32 v168, 16, v172
    v_and_b32 v169, 0xffff0000, v172
    v_lshlrev_b32 v170, 16, v173
    v_and_b32 v171, 0xffff0000, v173
    v_lshlrev_b32 v172, 16, v174
    v_and_b32 v173, 0xffff0000, v174
    v_lshlrev_b32 v174, 16, v175
    v_and_b32 v175, 0xffff0000, v175
K2_SAMEPH:
    s_mov_b32 s25, s29
    s_mov_b32 s27, s31
    s_mov_b32 s28, s32
    s_cmp_eq_u32 s30, 2
    s_cbranch_scc1 K2_UNIT2
    s_cmp_eq_u32 s30, 3
    s_cbranch_scc1 K2_UNIT3
    s_cmp_eq_u32 s30, 1
    s_cbranch_scc1 K2_UNIT1
K2_UNIT4:
    v_add_u32 v62, s25, v249
    v_add_u32 v63, s25, v250
    ds_read_b64_tr_b16 v[0:1], v62 offset:0
    ds_read_b64_tr_b16 v[2:3], v62 offset:128
    ds_read_b128 v[4:7], v63 offset:0
    ds_read_b128 v[8:11], v63 offset:16
    ds_read_b128 v[12:15], v63 offset:128
    ds_read_b128 v[16:19], v63 offset:144
    ds_read_b64_tr_b16 v[28:29], v62 offset:800
    ds_read_b64_tr_b16 v[30:31], v62 offset:928
    ds_read_b128 v[32:35], v63 offset:800
    ds_read_b128 v[36:39], v63 offset:816
    ds_read_b128 v[40:43], v63 offset:928
    ds_read_b128 v[44:47], v63 offset:944
    s_waitcnt lgkmcnt(10)
    v_lshlrev_b32 v20, 16, v0
    v_and_b32 v21, 0xffff0000, v0
    v_lshlrev_b32 v22, 16, v1
    v_and_b32 v23, 0xffff0000, v1
    v_lshlrev_b32 v24, 16, v2
    v_and_b32 v25, 0xffff0000, v2
    v_lshlrev_b32 v26, 16, v3
    v_and_b32 v27, 0xffff0000, v3
    s_waitcnt lgkmcnt(8)
    v_mul_f32 v4, v20, v4
    v_mul_f32 v5, v21, v5
    v_mul_f32 v6, v22, v6
    v_mul_f32 v7, v23, v7
    v_mul_f32 v8, v24, v8
    v_mul_f32 v9, v25, v9
    v_mul_f32 v10, v26, v10
    v_mul_f32 v11, v27, v11
    v_cvt_pk_bf16_f32 v64, v4, v5
    v_cvt_pk_bf16_f32 v65, v6, v7
    v_cvt_pk_bf16_f32 v66, v8, v9
    v_cvt_pk_bf16_f32 v67, v10, v11
    s_waitcnt lgkmcnt(6)
    v_mul_f32 v12, v20, v12
    v_mul_f32 v13, v21, v13
    v_mul_f32 v14, v22, v14
    v_mul_f32 v15, v23, v15
    v_mul_f32 v16, v24, v16
    v_mul_f32 v17, v25, v17
    v_mul_f32 v18, v26, v18
    v_mul_f32 v19, v27, v19
    v_cvt_pk_bf16_f32 v68, v12, v13
    v_cvt_pk_bf16_f32 v69, v14, v15
    v_cvt_pk_bf16_f32 v70, v16, v17
    v_cvt_pk_bf16_f32 v71, v18, v19
    ds_read_b64_tr_b16 v[0:1], v62 offset:1600
    ds_read_b64_tr_b16 v[2:3], v62 offset:1728
    ds_read_b128 v[4:7], v63 offset:1600
    ds_read_b128 v[8:11], v63 offset:1616
    ds_read_b128 v[12:15], v63 offset:1728
    ds_read_b128 v[16:19], v63 offset:1744
    s_waitcnt lgkmcnt(10)
    v_lshlrev_b32 v48, 16, v28
    v_and_b32 v49, 0xffff0000, v28
    v_lshlrev_b32 v50, 16, v29
    v_and_b32 v51, 0xffff0000, v29
    v_lshlrev_b32 v52, 16, v30
    v_and_b32 v53, 0xffff0000, v30
    v_lshlrev_b32 v54, 16, v31
    v_and_b32 v55, 0xffff0000, v31
    s_waitcnt lgkmcnt(8)
    v_mul_f32 v32, v48, v32
    v_mul_f32 v33, v49, v33
    v_mul_f32 v34, v50, v34
    v_mul_f32 v35, v51, v35
    v_mul_f32 v36, v52, v36
    v_mul_f32 v37, v53, v37
    v_mul_f32 v38, v54, v38
    v_mul_f32 v39, v55, v39
    v_cvt_pk_bf16_f32 v72, v32, v33
    v_cvt_pk_bf16_f32 v73, v34, v35
    v_cvt_pk_bf16_f32 v74, v36, v37
    v_cvt_pk_bf16_f32 v75, v38, v39
    s_waitcnt lgkmcnt(6)
    v_mul_f32 v40, v48, v40
    v_mul_f32 v41, v49, v41
    v_mul_f32 v42, v50, v42
    v_mul_f32 v43, v51, v43
    v_mul_f32 v44, v52, v44
    v_mul_f32 v45, v53, v45
    v_mul_f32 v46, v54, v46
    v_mul_f32 v47, v55, v47
    v_cvt_pk_bf16_f32 v76, v40, v41
    v_cvt_pk_bf16_f32 v77, v42, v43
    v_cvt_pk_bf16_f32 v78, v44, v45
    v_cvt_pk_bf16_f32 v79, v46, v47
    ds_read_b64_tr_b16 v[28:29], v62 offset:2400
    ds_read_b64_tr_b16 v[30:31], v62 offset:2528
    ds_read_b128 v[32:35], v63 offset:2400
    ds_read_b128 v[36:39], v63 offset:2416
    ds_read_b128 v[40:43], v63 offset:2528
    ds_read_b128 v[44:47], v63 offset:2544
    s_waitcnt lgkmcnt(10)
    v_lshlrev_b32 v20, 16, v0
    v_and_b32 v21, 0xffff0000, v0
    v_lshlrev_b32 v22, 16, v1
    v_and_b32 v23, 0xffff0000, v1
    v_lshlrev_b32 v24, 16, v2
    v_and_b32 v25, 0xffff0000, v2
    v_lshlrev_b32 v26, 16, v3
    v_and_b32 v27, 0xffff0000, v3
    s_waitcnt lgkmcnt(8)
    v_mul_f32 v4, v20, v4
    v_mul_f32 v5, v21, v5
    v_mul_f32 v6, v22, v6
    v_mul_f32 v7, v23, v7
    v_mul_f32 v8, v24, v8
    v_mul_f32 v9, v25, v9
    v_mul_f32 v10, v26, v10
    v_mul_f32 v11, v27, v11
    v_cvt_pk_bf16_f32 v80, v4, v5
    v_cvt_pk_bf16_f32 v81, v6, v7
    v_cvt_pk_bf16_f32 v82, v8, v9
    v_cvt_pk_bf16_f32 v83, v10, v11
    s_waitcnt lgkmcnt(6)
    v_mul_f32 v12, v20, v12
    v_mul_f32 v13, v21, v13
    v_mul_f32 v14, v22, v14
    v_mul_f32 v15, v23, v15
    v_mul_f32 v16, v24, v16
    v_mul_f32 v17, v25, v17
    v_mul_f32 v18, v26, v18
    v_mul_f32 v19, v27, v19
    v_cvt_pk_bf16_f32 v84, v12, v13
    v_cvt_pk_bf16_f32 v85, v14, v15
    v_cvt_pk_bf16_f32 v86, v16, v17
    v_cvt_pk_bf16_f32 v87, v18, v19
    s_waitcnt lgkmcnt(4)
    v_lshlrev_b32 v48, 16, v28
    v_and_b32 v49, 0xffff0000, v28
    v_lshlrev_b32 v50, 16, v29
    v_and_b32 v51, 0xffff0000, v29
    v_lshlrev_b32 v52, 16, v30
    v_and_b32 v53, 0xffff0000, v30
    v_lshlrev_b32 v54, 16, v31
    v_and_b32 v55, 0xffff0000, v31
    s_waitcnt lgkmcnt(2)
    v_mul_f32 v32, v48, v32
    v_mul_f32 v33, v49, v33
    v_mul_f32 v34, v50, v34
    v_mul_f32 v35, v51, v35
    v_mul_f32 v36, v52, v36
    v_mul_f32 v37, v53, v37
    v_mul_f32 v38, v54, v38
    v_mul_f32 v39, v55, v39
    v_cvt_pk_bf16_f32 v88, v32, v33
    v_cvt_pk_bf16_f32 v89, v34, v35
    v_cvt_pk_bf16_f32 v90, v36, v37
    v_cvt_pk_bf16_f32 v91, v38, v39
    s_waitcnt lgkmcnt(0)
    v_mul_f32 v40, v48, v40
    v_mul_f32 v41, v49, v41
    v_mul_f32 v42, v50, v42
    v_mul_f32 v43, v51, v43
    v_mul_f32 v44, v52, v44
    v_mul_f32 v45, v53, v45
    v_mul_f32 v46, v54, v46
    v_mul_f32 v47, v55, v47
    v_cvt_pk_bf16_f32 v92, v40, v41
    v_cvt_pk_bf16_f32 v93, v42, v43
    v_cvt_pk_bf16_f32 v94, v44, v45
    v_cvt_pk_bf16_f32 v95, v46, v47
    s_setprio 2
    s_waitcnt lgkmcnt(0)
    v_mfma_f32_32x32x16_bf16 v[0:15], v[64:67], v[176:179], 0
    s_add_u32 m0, s34, 0
    s_nop 0
    buffer_load_dwordx4 v222, s[4:7], s37 offen lds
    s_add_u32 m0, s34, 1024
    s_nop 0
    buffer_load_dwordx4 v223, s[4:7], s37 offen lds
    v_mfma_f32_32x32x16_bf16 v[16:31], v[68:71], v[176:179], 0
    s_waitcnt vmcnt(6)
    ds_read_b64_tr_b16 v[184:185], v246 offset:2048
    ds_read_b64_tr_b16 v[186:187], v246 offset:2560
    v_mfma_f32_32x32x16_bf16 v[32:47], v[64:67], v[180:183], 0
    ds_read_b64_tr_b16 v[188:189], v247 offset:2048
    ds_read_b64_tr_b16 v[190:191], v247 offset:2560
    v_mfma_f32_32x32x16_bf16 v[48:63], v[68:71], v[180:183], 0
    s_waitcnt lgkmcnt(0)
    v_mfma_f32_32x32x16_bf16 v[0:15], v[72:75], v[184:187], v[0:15]
    s_add_u32 m0, s34, 2048
    s_nop 0
    buffer_load_dwordx4 v224, s[4:7], s37 offen lds
    s_add_u32 m0, s34, 3072
    s_nop 0
    buffer_load_dwordx4 v225, s[4:7], s37 offen lds
    v_mfma_f32_32x32x16_bf16 v[16:31], v[76:79], v[184:187], v[16:31]
    s_waitcnt vmcnt(6)
    ds_read_b64_tr_b16 v[176:177], v246 offset:4096
    ds_read_b64_tr_b16 v[178:179], v246 offset:4608
    v_mfma_f32_32x32x16_bf16 v[32:47], v[72:75], v[188:191], v[32:47]
    ds_read_b64_tr_b16 v[180:181], v247 offset:4096
    ds_read_b64_tr_b16 v[182:183], v247 offset:4608
    v_mfma_f32_32x32x16_bf16 v[48:63], v[76:79], v[188:191], v[48:63]
    s_waitcnt lgkmcnt(0)
    v_mfma_f32_32x32x16_bf16 v[0:15], v[80:83], v[176:179], v[0:15]
    s_add_u32 m0, s34, 4096
    s_nop 0
    buffer_load_dwordx4 v226, s[4:7], s37 offen lds
    s_add_u32 m0, s34, 5120
    s_nop 0
    buffer_load_dwordx4 v227, s[4:7], s37 offen lds
    v_mfma_f32_32x32x16_bf16 v[16:31], v[84:87], v[176:179], v[16:31]
    s_waitcnt vmcnt(6)
    ds_read_b64_tr_b16 v[184:185], v246 offset:6144
    ds_read_b64_tr_b16 v[186:187], v246 offset:6656
    v_mfma_f32_32x32x16_bf16 v[32:47], v[80:83], v[180:183], v[32:47]
    ds_read_b64_tr_b16 v[188:189], v247 offset:6144
    ds_read_b64_tr_b16 v[190:191], v247 offset:6656
    v_mfma_f32_32x32x16_bf16 v[48:63], v[84:87], v[180:183], v[48:63]
    s_waitcnt lgkmcnt(0)
    v_mfma_f32_32x32x16_bf16 v[0:15], v[88:91], v[184:187], v[0:15]
    s_add_u32 m0, s34, 6144
    s_nop 0
    buffer_load_dwordx4 v228, s[4:7], s37 offen lds
    s_add_u32 m0, s34, 7168
    s_nop 0
    buffer_load_dwordx4 v229, s[4:7], s37 offen lds
    v_mfma_f32_32x32x16_bf16 v[16:31], v[92:95], v[184:187], v[16:31]
    s_waitcnt vmcnt(6)
    ds_read_b64_tr_b16 v[176:177], v246 offset:0
    ds_read_b64_tr_b16 v[178:179], v246 offset:512
    v_mfma_f32_32x32x16_bf16 v[32:47], v[88:91], v[188:191], v[32:47]
    ds_read_b64_tr_b16 v[180:181], v247 offset:0
    ds_read_b64_tr_b16 v[182:183], v247 offset:512
    v_mfma_f32_32x32x16_bf16 v[48:63], v[92:95], v[188:191], v[48:63]
    s_setprio 0
    s_add_u32 s35, s35, 1
    s_lshl_b32 s45, s35, 3
    s_add_u32 s45, s45, s16
    s_cmp_lt_u32 s45, s18
    s_cbranch_scc1 K2_cl_13
    s_mov_b32 s35, 8
    s_mov_b32 s45, -1
    v_mov_b32 v231, 162048
    v_mov_b32 v232, 1
    s_mov_b64 exec, 1
    ds_add_rtn_u32 v230, v231, v232
    s_mov_b64 exec, -1
K2_cl_13:
    v_mul_f32 v234, v0, v96
    v_mul_f32 v236, v8, v128
    v_mul_f32 v238, v16, v128
    v_mul_f32 v240, v24, v128
    v_fmac_f32 v234, v1, v97
    v_fmac_f32 v236, v9, v129
    v_fmac_f32 v238, v17, v129
    v_fmac_f32 v240, v25, v129
    v_fmac_f32 v234, v2, v98
    v_fmac_f32 v236, v10, v130
    v_fmac_f32 v238, v18, v130
    v_fmac_f32 v240, v26, v130
    v_fmac_f32 v234, v3, v99
    v_fmac_f32 v236, v11, v131
    v_fmac_f32 v238, v19, v131
    v_fmac_f32 v240, v27, v131
    v_fmac_f32 v234, v4, v100
    v_fmac_f32 v236, v12, v132
    v_fmac_f32 v238, v20, v132
    v_fmac_f32 v240, v28, v132
    v_fmac_f32 v234, v5, v101
    v_fmac_f32 v236, v13, v133
    v_fmac_f32 v238, v21, v133
    v_fmac_f32 v240, v29, v133
    v_fmac_f32 v234, v6, v102
    v_fmac_f32 v236, v14, v134
    v_fmac_f32 v238, v22, v134
    v_fmac_f32 v240, v30, v134
    v_fmac_f32 v234, v7, v103
    v_fmac_f32 v236, v15, v135
    v_fmac_f32 v238, v23, v135
    v_fmac_f32 v240, v31, v135
    v_mul_f32 v235, v32, v104
    v_mul_f32 v237, v40, v136
    v_mul_f32 v239, v48, v136
    v_mul_f32 v241, v56, v136
    v_fmac_f32 v235, v33, v105
    v_fmac_f32 v237, v41, v137
    v_fmac_f32 v239, v49, v137
    v_fmac_f32 v241, v57, v137
    v_fmac_f32 v235, v34, v106
    v_fmac_f32 v237, v42, v138
    v_fmac_f32 v239, v50, v138
    v_fmac_f32 v241, v58, v138
    v_fmac_f32 v235, v35, v107
    v_fmac_f32 v237, v43, v139
    v_fmac_f32 v239, v51, v139
    v_fmac_f32 v241, v59, v139
    v_fmac_f32 v235, v36, v108
    v_fmac_f32 v237, v44, v140
    v_fmac_f32 v239, v52, v140
    v_fmac_f32 v241, v60, v140
    v_fmac_f32 v235, v37, v109
    v_fmac_f32 v237, v45, v141
    v_fmac_f32 v239, v53, v141
    v_fmac_f32 v241, v61, v141
    v_fmac_f32 v235, v38, v110
    v_fmac_f32 v237, v46, v142
    v_fmac_f32 v239, v54, v142
    v_fmac_f32 v241, v62, v142
    v_fmac_f32 v235, v39, v111
    v_fmac_f32 v237, v47, v143
    v_fmac_f32 v239, v55, v143
    v_fmac_f32 v241, v63, v143
    v_permlane32_swap_b32 v234, v235
    v_permlane32_swap_b32 v236, v237
    v_permlane32_swap_b32 v238, v239
    v_permlane32_swap_b32 v240, v241
    v_add_f32 v234, v234, v235
    v_add_f32 v236, v236, v237
    v_add_f32 v238, v238, v239
    v_add_f32 v240, v240, v241
    s_cmp_lg_u32 s27, 0
    s_cbranch_scc1 K2_fl1_14
    s_set_gpr_idx_on s28, gpr_idx(DST)
    s_nop 0
    v_cvt_pk_bf16_f32 v192, v234, v236
    v_cvt_pk_bf16_f32 v193, v238, v240
    s_set_gpr_idx_off
    s_branch K2_fld_15
K2_fl1_14:
    v_add_u32 v254, s28, v252
    v_cvt_pk_bf16_f32 v234, v234, v236
    v_cvt_pk_bf16_f32 v238, v238, v240
    ds_write_b16 v254, v234 offset:0
    ds_write_b16_d16_hi v254, v234 offset:256
    ds_write_b16 v254, v238 offset:640
    ds_write_b16_d16_hi v254, v238 offset:1024
K2_fld_15:
    s_mov_b32 s31, 0
    s_mul_i32 s32, s35, 6
    s_mov_b32 s33, 1
    s_cmp_lg_u32 s45, -1
    s_cbranch_scc1 K2_st_16
    s_cmp_lg_u32 s27, 0
    s_cbranch_scc1 K2_nd_17
    s_mov_b64 exec, 1
    ds_add_u32 v231, v232 offset:8
    s_mov_b64 exec, -1
K2_nd_17:
    s_waitcnt lgkmcnt(0)
    v_readfirstlane_b32 s45, v230
    s_mov_b32 s31, 1
    s_cmp_lt_u32 s45, s18
    s_cselect_b32 s33, 1, 0
    s_cselect_b32 s45, s45, 63
K2_st_16:
    v_readlane_b32 s46, v253, s45
    s_nop 0
    s_and_b32 s29, s46, 0x3ffff
    s_bfe_u32 s30, s46, 0x30012
    s_cmp_eq_u32 s31, 0
    s_cbranch_scc1 K2_p1_18
    s_lshr_b32 s32, s46, 21
    s_add_u32 s32, s32, s29
K2_p1_18:
    s_lshl_b32 s47, s30, 3
    s_sub_u32 s47, s47, 8
    s_lshr_b32 s48, 0x4050e4, s47
    s_lshr_b32 s49, 0xe4244400, s47
    s_lshl_b32 s50, s31, 7
    s_mov_b32 s40, s50
    v_add_u32 v230, s29, v251
    s_bfe_u32 s51, s48, 0x20002
    s_lshl_b32 s51, s51, 8
    s_add_u32 s41, s51, s50
    s_bfe_u32 s51, s49, 0x20002
    s_mul_i32 s51, s51, 800
    s_add_u32 s51, s51, s29
    v_add_u32 v231, s51, v251
    s_bfe_u32 s51, s48, 0x20004
    s_lshl_b32 s51, s51, 8
    s_add_u32 s42, s51, s50
    s_bfe_u32 s51, s49, 0x20004
    s_mul_i32 s51, s51, 800
    s_add_u32 s51, s51, s29
    v_add_u32 v232, s51, v251
    s_bfe_u32 s51, s48, 0x20006
    s_lshl_b32 s51, s51, 8
    s_add_u32 s43, s51, s50
    s_bfe_u32 s51, s49, 0x20006
    s_mul_i32 s51, s51, 800
    s_add_u32 s51, s51, s29
    v_add_u32 v233, s51, v251
    ds_read_b32 v230, v230
    ds_read_b32 v231, v231
    ds_read_b32 v232, v232
    ds_read_b32 v233, v233
    s_setprio 2
    s_waitcnt lgkmcnt(4)
    v_mfma_f32_32x32x16_bf16 v[0:15], v[64:67], v[176:179], 0
    s_add_u32 m0, s34, 0
    s_nop 0
    buffer_load_dwordx4 v222, s[4:7], s38 offen lds
    s_add_u32 m0, s34, 1024
    s_nop 0
    buffer_load_dwordx4 v223, s[4:7], s38 offen lds
    v_mfma_f32_32x32x16_bf16 v[16:31], v[68:71], v[176:179], 0
    s_waitcnt vmcnt(6)
    ds_read_b64_tr_b16 v[184:185], v246 offset:2048
    ds_read_b64_tr_b16 v[186:187], v246 offset:2560
    v_mfma_f32_32x32x16_bf16 v[32:47], v[64:67], v[180:183], 0
    ds_read_b64_tr_b16 v[188:189], v247 offset:2048
    ds_read_b64_tr_b16 v[190:191], v247 offset:2560
    v_mfma_f32_32x32x16_bf16 v[48:63], v[68:71], v[180:183], 0
    s_waitcnt lgkmcnt(0)
    v_mfma_f32_32x32x16_bf16 v[0:15], v[72:75], v[184:187], v[0:15]
    s_add_u32 m0, s34, 2048
    s_nop 0
    buffer_load_dwordx4 v224, s[4:7], s38 offen lds
    s_add_u32 m0, s34, 3072
    s_nop 0
    buffer_load_dwordx4 v225, s[4:7], s38 offen lds
    v_mfma_f32_32x32x16_bf16 v[16:31], v[76:79], v[184:187], v[16:31]
    s_waitcnt vmcnt(6)
    ds_read_b64_tr_b16 v[176:177], v246 offset:4096
    ds_read_b64_tr_b16 v[178:179], v246 offset:4608
    v_mfma_f32_32x32x16_bf16 v[32:47], v[72:75], v[188:191], v[32:47]
    ds_read_b64_tr_b16 v[180:181], v247 offset:4096
    ds_read_b64_tr_b16 v[182:183], v247 offset:4608
    v_mfma_f32_32x32x16_bf16 v[48:63], v[76:79], v[188:191], v[48:63]
    s_waitcnt lgkmcnt(0)
    v_mfma_f32_32x32x16_bf16 v[0:15], v[80:83], v[176:179], v[0:15]
    s_add_u32 m0, s34, 4096
    s_nop 0
    buffer_load_dwordx4 v226, s[4:7], s38 offen lds
    s_add_u32 m0, s34, 5120
    s_nop 0
    buffer_load_dwordx4 v227, s[4:7], s38 offen lds
    v_mfma_f32_32x32x16_bf16 v[16:31], v[84:87], v[176:179], v[16:31]
    s_waitcnt vmcnt(6)
    ds_read_b64_tr_b16 v[184:185], v246 offset:6144
    ds_read_b64_tr_b16 v[186:187], v246 offset:6656
    v_mfma_f32_32x32x16_bf16 v[32:47], v[80:83], v[180:183], v[32:47]
    ds_read_b64_tr_b16 v[188:189], v247 offset:6144
    ds_read_b64_tr_b16 v[190:191], v247 offset:6656
    v_mfma_f32_32x32x16_bf16 v[48:63], v[84:87], v[180:183], v[48:63]
    s_waitcnt lgkmcnt(0)
    v_mfma_f32_32x32x16_bf16 v[0:15], v[88:91], v[184:187], v[0:15]
    s_add_u32 m0, s34, 6144
    s_nop 0
    buffer_load_dwordx4 v228, s[4:7], s38 offen lds
    s_add_u32 m0, s34, 7168
    s_nop 0
    buffer_load_dwordx4 v229, s[4:7], s38 offen lds
    v_mfma_f32_32x32x16_bf16 v[16:31], v[92:95], v[184:187], v[16:31]
    s_waitcnt vmcnt(6)
    ds_read_b64_tr_b16 v[176:177], v246 offset:0
    ds_read_b64_tr_b16 v[178:179], v246 offset:512
    v_mfma_f32_32x32x16_bf16 v[32:47], v[88:91], v[188:191], v[32:47]
    ds_read_b64_tr_b16 v[180:181], v247 offset:0
    ds_read_b64_tr_b16 v[182:183], v247 offset:512
    v_mfma_f32_32x32x16_bf16 v[48:63], v[92:95], v[188:191], v[48:63]
    s_setprio 0
    v_mul_f32 v234, v0, v144
    v_mul_f32 v236, v8, v112
    s_nop 1
    v_mul_f32 v238, v16, v160
    s_nop 0
    v_mul_f32 v240, v24, v160
    v_fmac_f32 v234, v1, v145
    v_fmac_f32 v236, v9, v113
    v_fmac_f32 v238, v17, v161
    v_fmac_f32 v240, v25, v161
    v_fmac_f32 v234, v2, v146
    v_fmac_f32 v236, v10, v114
    v_fmac_f32 v238, v18, v162
    v_fmac_f32 v240, v26, v162
    v_fmac_f32 v234, v3, v147
    v_fmac_f32 v236, v11, v115
    v_fmac_f32 v238, v19, v163
    v_fmac_f32 v240, v27, v163
    v_fmac_f32 v234, v4, v148
    v_fmac_f32 v236, v12, v116
    v_fmac_f32 v238, v20, v164
    v_fmac_f32 v240, v28, v164
    v_fmac_f32 v234, v5, v149
    v_fmac_f32 v236, v13, v117
    v_fmac_f32 v238, v21, v165
    v_fmac_f32 v240, v29, v165
    v_fmac_f32 v234, v6, v150
    v_fmac_f32 v236, v14, v118
    v_fmac_f32 v238, v22, v166
    v_fmac_f32 v240, v30, v166
    v_fmac_f32 v234, v7, v151
    v_fmac_f32 v236, v15, v119
    v_fmac_f32 v238, v23, v167
    v_fmac_f32 v240, v31, v167
    v_mul_f32 v235, v32, v152
    v_mul_f32 v237, v40, v120
    v_mul_f32 v239, v48, v168
    v_mul_f32 v241, v56, v168
    v_fmac_f32 v235, v33, v153
    v_fmac_f32 v237, v41, v121
    v_fmac_f32 v239, v49, v169
    v_fmac_f32 v241, v57, v169
    v_fmac_f32 v235, v34, v154
    v_fmac_f32 v237, v42, v122
    v_fmac_f32 v239, v50, v170
    v_fmac_f32 v241, v58, v170
    v_fmac_f32 v235, v35, v155
    v_fmac_f32 v237, v43, v123
    v_fmac_f32 v239, v51, v171
    v_fmac_f32 v241, v59, v171
    v_fmac_f32 v235, v36, v156
    v_fmac_f32 v237, v44, v124
    v_fmac_f32 v239, v52, v172
    v_fmac_f32 v241, v60, v172
    v_fmac_f32 v235, v37, v157
    v_fmac_f32 v237, v45, v125
    v_fmac_f32 v239, v53, v173
    v_fmac_f32 v241, v61, v173
    v_fmac_f32 v235, v38, v158
    v_fmac_f32 v237, v46, v126
    v_fmac_f32 v239, v54, v174
    v_fmac_f32 v241, v62, v174
    v_fmac_f32 v235, v39, v159
    v_fmac_f32 v237, v47, v127
    v_fmac_f32 v239, v55, v175
    v_fmac_f32 v241, v63, v175
    v_permlane32_swap_b32 v234, v235
    v_add_f32 v234, v234, v235
    s_setprio 2
    s_waitcnt lgkmcnt(0)
    v_mfma_f32_32x32x16_bf16 v[0:15], v[64:67], v[176:179], 0
    s_add_u32 m0, s34, 0
    s_nop 0
    buffer_load_dwordx4 v222, s[4:7], s39 offen lds
    s_add_u32 m0, s34, 1024
    s_nop 0
    buffer_load_dwordx4 v223, s[4:7], s39 offen lds
    v_mfma_f32_32x32x16_bf16 v[16:31], v[68:71], v[176:179], 0
    s_waitcnt vmcnt(6)
    ds_read_b64_tr_b16 v[184:185], v246 offset:2048
    ds_read_b64_tr_b16 v[186:187], v246 offset:2560
    v_mfma_f32_32x32x16_bf16 v[32:47], v[64:67], v[180:183], 0
    ds_read_b64_tr_b16 v[188:189], v247 offset:2048
    ds_read_b64_tr_b16 v[190:191], v247 offset:2560
    v_mfma_f32_32x32x16_bf16 v[48:63], v[68:71], v[180:183], 0
    s_waitcnt lgkmcnt(0)
    v_mfma_f32_32x32x16_bf16 v[0:15], v[72:75], v[184:187], v[0:15]
    s_add_u32 m0, s34, 2048
    s_nop 0
    buffer_load_dwordx4 v224, s[4:7], s39 offen lds
    s_add_u32 m0, s34, 3072
    s_nop 0
    buffer_load_dwordx4 v225, s[4:7], s39 offen lds
    v_mfma_f32_32x32x16_bf16 v[16:31], v[76:79], v[184:187], v[16:31]
    s_waitcnt vmcnt(6)
    ds_read_b64_tr_b16 v[176:177], v246 offset:4096
    ds_read_b64_tr_b16 v[178:179], v246 offset:4608
    v_mfma_f32_32x32x16_bf16 v[32:47], v[72:75], v[188:191], v[32:47]
    ds_read_b64_tr_b16 v[180:181], v247 offset:4096
    ds_read_b64_tr_b16 v[182:183], v247 offset:4608
    v_mfma_f32_32x32x16_bf16 v[48:63], v[76:79], v[188:191], v[48:63]
    s_waitcnt lgkmcnt(0)
    v_mfma_f32_32x32x16_bf16 v[0:15], v[80:83], v[176:179], v[0:15]
    s_add_u32 m0, s34, 4096
    s_nop 0
    buffer_load_dwordx4 v226, s[4:7], s39 offen lds
    s_add_u32 m0, s34, 5120
    s_nop 0
    buffer_load_dwordx4 v227, s[4:7], s39 offen lds
    v_mfma_f32_32x32x16_bf16 v[16:31], v[84:87], v[176:179], v[16:31]
    s_waitcnt vmcnt(6)
    ds_read_b64_tr_b16 v[184:185], v246 offset:6144
    ds_read_b64_tr_b16 v[186:187], v246 offset:6656
    v_mfma_f32_32x32x16_bf16 v[32:47], v[80:83], v[180:183], v[32:47]
    ds_read_b64_tr_b16 v[188:189], v247 offset:6144
    ds_read_b64_tr_b16 v[190:191], v247 offset:6656
    v_mfma_f32_32x32x16_bf16 v[48:63], v[84:87], v[180:183], v[48:63]
    s_waitcnt lgkmcnt(0)
    v_mfma_f32_32x32x16_bf16 v[0:15], v[88:91], v[184:187], v[0:15]
    s_add_u32 m0, s34, 6144
    s_nop 0
    buffer_load_dwordx4 v228, s[4:7], s39 offen lds
    s_add_u32 m0, s34, 7168
    s_nop 0
    buffer_load_dwordx4 v229, s[4:7], s39 offen lds
    v_mfma_f32_32x32x16_bf16 v[16:31], v[92:95], v[184:187], v[16:31]
    s_waitcnt vmcnt(6)
    ds_read_b64_tr_b16 v[176:177], v246 offset:0
    ds_read_b64_tr_b16 v[178:179], v246 offset:512
    v_mfma_f32_32x32x16_bf16 v[32:47], v[88:91], v[188:191], v[32:47]
    ds_read_b64_tr_b16 v[180:181], v247 offset:0
    ds_read_b64_tr_b16 v[182:183], v247 offset:512
    v_mfma_f32_32x32x16_bf16 v[48:63], v[92:95], v[188:191], v[48:63]
    s_setprio 0
    v_mul_f32 v242, v0, v144
    v_fma_f32 v238, v8, v160, -v238
    s_nop 1
    v_fmac_f32 v236, v16, v112
    s_nop 0
    v_mul_f32 v244, v24, v160
    v_fmac_f32 v242, v1, v145
    v_fmac_f32 v238, v9, v161
    v_fmac_f32 v236, v17, v113
    v_fmac_f32 v244, v25, v161
    v_fmac_f32 v242, v2, v146
    v_fmac_f32 v238, v10, v162
    v_fmac_f32 v236, v18, v114
    v_fmac_f32 v244, v26, v162
    v_fmac_f32 v242, v3, v147
    v_fmac_f32 v238, v11, v163
    v_fmac_f32 v236, v19, v115
    v_fmac_f32 v244, v27, v163
    v_fmac_f32 v242, v4, v148
    v_fmac_f32 v238, v12, v164
    v_fmac_f32 v236, v20, v116
    v_fmac_f32 v244, v28, v164
    v_fmac_f32 v242, v5, v149
    v_fmac_f32 v238, v13, v165
    v_fmac_f32 v236, v21, v117
    v_fmac_f32 v244, v29, v165
    v_fmac_f32 v242, v6, v150
    v_fmac_f32 v238, v14, v166
    v_fmac_f32 v236, v22, v118
    v_fmac_f32 v244, v30, v166
    v_fmac_f32 v242, v7, v151
    v_fmac_f32 v238, v15, v167
    v_fmac_f32 v236, v23, v119
    v_fmac_f32 v244, v31, v167
    v_mul_f32 v243, v32, v152
    v_fma_f32 v239, v40, v168, -v239
    v_fmac_f32 v237, v48, v120
    v_mul_f32 v245, v56, v168
    v_fmac_f32 v243, v33, v153
    v_fmac_f32 v239, v41, v169
    v_fmac_f32 v237, v49, v121
    v_fmac_f32 v245, v57, v169
    v_fmac_f32 v243, v34, v154
    v_fmac_f32 v239, v42, v170
    v_fmac_f32 v237, v50, v122
    v_fmac_f32 v245, v58, v170
    v_fmac_f32 v243, v35, v155
    v_fmac_f32 v239, v43, v171
    v_fmac_f32 v237, v51, v123
    v_fmac_f32 v245, v59, v171
    v_fmac_f32 v243, v36, v156
    v_fmac_f32 v239, v44, v172
    v_fmac_f32 v237, v52, v124
    v_fmac_f32 v245, v60, v172
    v_fmac_f32 v243, v37, v157
    v_fmac_f32 v239, v45, v173
    v_fmac_f32 v237, v53, v125
    v_fmac_f32 v245, v61, v173
    v_fmac_f32 v243, v38, v158
    v_fmac_f32 v239, v46, v174
    v_fmac_f32 v237, v54, v126
    v_fmac_f32 v245, v62, v174
    v_fmac_f32 v243, v39, v159
    v_fmac_f32 v239, v47, v175
    v_fmac_f32 v237, v55, v127
    v_fmac_f32 v245, v63, v175
    v_permlane32_swap_b32 v242, v243
    v_permlane32_swap_b32 v238, v239
    v_add_f32 v242, v242, v243
    v_add_f32 v238, v238, v239
    s_cmp_lg_u32 s27, 0
    s_cbranch_scc1 K2_fl1_19
    s_set_gpr_idx_on s28, gpr_idx(DST)
    s_nop 0
    v_cvt_pk_bf16_f32 v194, v234, v242
    s_set_gpr_idx_off
    s_branch K2_fld_20
K2_fl1_19:
    v_add_u32 v254, s28, v252
    v_cvt_pk_bf16_f32 v234, v234, v242
    ds_write_b16 v254, v234 offset:384
    ds_write_b16_d16_hi v254, v234 offset:768
K2_fld_20:
    s_setprio 2
    s_waitcnt lgkmcnt(0)
    v_mfma_f32_32x32x16_bf16 v[0:15], v[64:67], v[176:179], 0
    v_mad_u32_u16 v222, v230, s44, v248
    v_mad_u32_u16 v223, v230, s44, v248 op_sel:[1,0,0,0]
    v_mad_u32_u16 v224, v231, s44, v248
    v_mad_u32_u16 v225, v231, s44, v248 op_sel:[1,0,0,0]
    v_mad_u32_u16 v226, v232, s44, v248
    v_mad_u32_u16 v227, v232, s44, v248 op_sel:[1,0,0,0]
    v_mad_u32_u16 v228, v233, s44, v248
    v_mad_u32_u16 v229, v233, s44, v248 op_sel:[1,0,0,0]
    s_add_u32 m0, s34, 0
    s_nop 0
    buffer_load_dwordx4 v222, s[4:7], s40 offen lds
    s_add_u32 m0, s34, 1024
    s_nop 0
    buffer_load_dwordx4 v223, s[4:7], s40 offen lds
    v_mfma_f32_32x32x16_bf16 v[16:31], v[68:71], v[176:179], 0
    s_waitcnt vmcnt(6)
    ds_read_b64_tr_b16 v[184:185], v246 offset:2048
    ds_read_b64_tr_b16 v[186:187], v246 offset:2560
    v_mfma_f32_32x32x16_bf16 v[32:47], v[64:67], v[180:183], 0
    ds_read_b64_tr_b16 v[188:189], v247 offset:2048
    ds_read_b64_tr_b16 v[190:191], v247 offset:2560
    v_mfma_f32_32x32x16_bf16 v[48:63], v[68:71], v[180:183], 0
    s_waitcnt lgkmcnt(0)
    v_mfma_f32_32x32x16_bf16 v[0:15], v[72:75], v[184:187], v[0:15]
    s_add_u32 m0, s34, 2048
    s_nop 0
    buffer_load_dwordx4 v224, s[4:7], s41 offen lds
    s_add_u32 m0, s34, 3072
    s_nop 0
    buffer_load_dwordx4 v225, s[4:7], s41 offen lds
    v_mfma_f32_32x32x16_bf16 v[16:31], v[76:79], v[184:187], v[16:31]
    s_waitcnt vmcnt(6)
    ds_read_b64_tr_b16 v[176:177], v246 offset:4096
    ds_read_b64_tr_b16 v[178:179], v246 offset:4608
    v_mfma_f32_32x32x16_bf16 v[32:47], v[72:75], v[188:191], v[32:47]
    ds_read_b64_tr_b16 v[180:181], v247 offset:4096
    ds_read_b64_tr_b16 v[182:183], v247 offset:4608
    v_mfma_f32_32x32x16_bf16 v[48:63], v[76:79], v[188:191], v[48:63]
    s_waitcnt lgkmcnt(0)
    v_mfma_f32_32x32x16_bf16 v[0:15], v[80:83], v[176:179], v[0:15]
    s_add_u32 m0, s34, 4096
    s_nop 0
    buffer_load_dwordx4 v226, s[4:7], s42 offen lds
    s_add_u32 m0, s34, 5120
    s_nop 0
    buffer_load_dwordx4 v227, s[4:7], s42 offen lds
    v_mfma_f32_32x32x16_bf16 v[16:31], v[84:87], v[176:179], v[16:31]
    s_waitcnt vmcnt(6)
    ds_read_b64_tr_b16 v[184:185], v246 offset:6144
    ds_read_b64_tr_b16 v[186:187], v246 offset:6656
    v_mfma_f32_32x32x16_bf16 v[32:47], v[80:83], v[180:183], v[32:47]
    ds_read_b64_tr_b16 v[188:189], v247 offset:6144
    ds_read_b64_tr_b16 v[190:191], v247 offset:6656
    v_mfma_f32_32x32x16_bf16 v[48:63], v[84:87], v[180:183], v[48:63]
    s_waitcnt lgkmcnt(0)
    v_mfma_f32_32x32x16_bf16 v[0:15], v[88:91], v[184:187], v[0:15]
    s_add_u32 m0, s34, 6144
    s_nop 0
    buffer_load_dwordx4 v228, s[4:7], s43 offen lds
    s_add_u32 m0, s34, 7168
    s_nop 0
    buffer_load_dwordx4 v229, s[4:7], s43 offen lds
    v_mfma_f32_32x32x16_bf16 v[16:31], v[92:95], v[184:187], v[16:31]
    s_waitcnt vmcnt(6)
    ds_read_b64_tr_b16 v[176:177], v246 offset:0
    ds_read_b64_tr_b16 v[178:179], v246 offset:512
    v_mfma_f32_32x32x16_bf16 v[32:47], v[88:91], v[188:191], v[32:47]
    ds_read_b64_tr_b16 v[180:181], v247 offset:0
    ds_read_b64_tr_b16 v[182:183], v247 offset:512
    v_mfma_f32_32x32x16_bf16 v[48:63], v[92:95], v[188:191], v[48:63]
    s_setprio 0
    v_mul_f32 v242, v0, v144
    v_fma_f32 v240, v8, v160, -v240
    s_nop 1
    v_fma_f32 v244, v16, v160, -v244
    s_nop 0
    v_fmac_f32 v236, v24, v112
    v_fmac_f32 v242, v1, v145
    v_fmac_f32 v240, v9, v161
    v_fmac_f32 v244, v17, v161
    v_fmac_f32 v236, v25, v113
    v_fmac_f32 v242, v2, v146
    v_fmac_f32 v240, v10, v162
    v_fmac_f32 v244, v18, v162
    v_fmac_f32 v236, v26, v114
    v_fmac_f32 v242, v3, v147
    v_fmac_f32 v240, v11, v163
    v_fmac_f32 v244, v19, v163
    v_fmac_f32 v236, v27, v115
    v_fmac_f32 v242, v4, v148
    v_fmac_f32 v240, v12, v164
    v_fmac_f32 v244, v20, v164
    v_fmac_f32 v236, v28, v116
    v_fmac_f32 v242, v5, v149
    v_fmac_f32 v240, v13, v165
    v_fmac_f32 v244, v21, v165
    v_fmac_f32 v236, v29, v117
    v_fmac_f32 v242, v6, v150
    v_fmac_f32 v240, v14, v166
    v_fmac_f32 v244, v22, v166
    v_fmac_f32 v236, v30, v118
    v_fmac_f32 v242, v7, v151
    v_fmac_f32 v240, v15, v167
    v_fmac_f32 v244, v23, v167
    v_fmac_f32 v236, v31, v119
    v_mul_f32 v243, v32, v152
    v_fma_f32 v241, v40, v168, -v241
    v_fma_f32 v245, v48, v168, -v245
    v_fmac_f32 v237, v56, v120
    v_fmac_f32 v243, v33, v153
    v_fmac_f32 v241, v41, v169
    v_fmac_f32 v245, v49, v169
    v_fmac_f32 v237, v57, v121
    v_fmac_f32 v243, v34, v154
    v_fmac_f32 v241, v42, v170
    v_fmac_f32 v245, v50, v170
    v_fmac_f32 v237, v58, v122
    v_fmac_f32 v243, v35, v155
    v_fmac_f32 v241, v43, v171
    v_fmac_f32 v245, v51, v171
    v_fmac_f32 v237, v59, v123
    v_fmac_f32 v243, v36, v156
    v_fmac_f32 v241, v44, v172
    v_fmac_f32 v245, v52, v172
    v_fmac_f32 v237, v60, v124
    v_fmac_f32 v243, v37, v157
    v_fmac_f32 v241, v45, v173
    v_fmac_f32 v245, v53, v173
    v_fmac_f32 v237, v61, v125
    v_fmac_f32 v243, v38, v158
    v_fmac_f32 v241, v46, v174
    v_fmac_f32 v245, v54, v174
    v_fmac_f32 v237, v62, v126
    v_fmac_f32 v243, v39, v159
    v_fmac_f32 v241, v47, v175
    v_fmac_f32 v245, v55, v175
    v_fmac_f32 v237, v63, v127
    v_permlane32_swap_b32 v242, v243
    s_nop 0
    v_permlane32_swap_b32 v236, v237
    v_permlane32_swap_b32 v240, v241
    v_permlane32_swap_b32 v244, v245
    v_add_f32 v242, v242, v243
    v_add_f32 v236, v236, v237
    v_add_f32 v240, -v240, -v241
    v_add_f32 v244, v244, v245
    s_cmp_lg_u32 s27, 0
    s_cbranch_scc1 K2_fl1_21
    s_set_gpr_idx_on s28, gpr_idx(DST)
    s_nop 0
    v_cvt_pk_bf16_f32 v195, v242, v236
    v_cvt_pk_bf16_f32 v196, v244, v240
    v_cvt_pk_bf16_f32 v197, v238, v238
    s_set_gpr_idx_off
    s_branch K2_fld_22
K2_fl1_21:
    v_add_u32 v254, s28, v252
    v_cvt_pk_bf16_f32 v242, v242, v236
    v_cvt_pk_bf16_f32 v244, v244, v240
    v_cvt_pk_bf16_f32 v238, v238, v238
    ds_write_b16 v254, v242 offset:1152
    ds_write_b16_d16_hi v254, v242 offset:128
    ds_write_b16 v254, v244 offset:512
    ds_write_b16_d16_hi v254, v244 offset:896
    ds_write_b16 v254, v238 offset:1280
K2_fld_22:
    s_branch K2_NEXT
K2_UNIT2:
    v_add_u32 v62, s25, v249
    v_add_u32 v63, s25, v250
    ds_read_b64_tr_b16 v[0:1], v62 offset:0
    ds_read_b64_tr_b16 v[2:3], v62 offset:128
    ds_read_b128 v[4:7], v63 offset:0
    ds_read_b128 v[8:11], v63 offset:16
    ds_read_b128 v[12:15], v63 offset:128
    ds_read_b128 v[16:19], v63 offset:144
    ds_read_b64_tr_b16 v[28:29], v62 offset:800
    ds_read_b64_tr_b16 v[30:31], v62 offset:928
    ds_read_b128 v[32:35], v63 offset:800
    ds_read_b128 v[36:39], v63 offset:816
    ds_read_b128 v[40:43], v63 offset:928
    ds_read_b128 v[44:47], v63 offset:944
    s_waitcnt lgkmcnt(10)
    v_lshlrev_b32 v20, 16, v0
    v_and_b32 v21, 0xffff0000, v0
    v_lshlrev_b32 v22, 16, v1
    v_and_b32 v23, 0xffff0000, v1
    v_lshlrev_b32 v24, 16, v2
    v_and_b32 v25, 0xffff0000, v2
    v_lshlrev_b32 v26, 16, v3
    v_and_b32 v27, 0xffff0000, v3
    s_waitcnt lgkmcnt(8)
    v_mul_f32 v4, v20, v4
    v_mul_f32 v5, v21, v5
    v_mul_f32 v6, v22, v6
    v_mul_f32 v7, v23, v7
    v_mul_f32 v8, v24, v8
    v_mul_f32 v9, v25, v9
    v_mul_f32 v10, v26, v10
    v_mul_f32 v11, v27, v11
    v_cvt_pk_bf16_f32 v64, v4, v5
    v_cvt_pk_bf16_f32 v65, v6, v7
    v_cvt_pk_bf16_f32 v66, v8, v9
    v_cvt_pk_bf16_f32 v67, v10, v11
    s_waitcnt lgkmcnt(6)
    v_mul_f32 v12, v20, v12
    v_mul_f32 v13, v21, v13
    v_mul_f32 v14, v22, v14
    v_mul_f32 v15, v23, v15
    v_mul_f32 v16, v24, v16
    v_mul_f32 v17, v25, v17
    v_mul_f32 v18, v26, v18
    v_mul_f32 v19, v27, v19
    v_cvt_pk_bf16_f32 v68, v12, v13
    v_cvt_pk_bf16_f32 v69, v14, v15
    v_cvt_pk_bf16_f32 v70, v16, v17
    v_cvt_pk_bf16_f32 v71, v18, v19
    s_waitcnt lgkmcnt(4)
    v_lshlrev_b32 v48, 16, v28
    v_and_b32 v49, 0xffff0000, v28
    v_lshlrev_b32 v50, 16, v29
    v_and_b32 v51, 0xffff0000, v29
    v_lshlrev_b32 v52, 16, v30
    v_and_b32 v53, 0xffff0000, v30
    v_lshlrev_b32 v54, 16, v31
    v_and_b32 v55, 0xffff0000, v31
    s_waitcnt lgkmcnt(2)
    v_mul_f32 v32, v48, v32
    v_mul_f32 v33, v49, v33
    v_mul_f32 v34, v50, v34
    v_mul_f32 v35, v51, v35
    v_mul_f32 v36, v52, v36
    v_mul_f32 v37, v53, v37
    v_mul_f32 v38, v54, v38
    v_mul_f32 v39, v55, v39
    v_cvt_pk_bf16_f32 v72, v32, v33
    v_cvt_pk_bf16_f32 v73, v34, v35
    v_cvt_pk_bf16_f32 v74, v36, v37
    v_cvt_pk_bf16_f32 v75, v38, v39
    s_waitcnt lgkmcnt(0)
    v_mul_f32 v40, v48, v40
    v_mul_f32 v41, v49, v41
    v_mul_f32 v42, v50, v42
    v_mul_f32 v43, v51, v43
    v_mul_f32 v44, v52, v44
    v_mul_f32 v45, v53, v45
    v_mul_f32 v46, v54, v46
    v_mul_f32 v47, v55, v47
    v_cvt_pk_bf16_f32 v76, v40, v41
    v_cvt_pk_bf16_f32 v77, v42, v43
    v_cvt_pk_bf16_f32 v78, v44, v45
    v_cvt_pk_bf16_f32 v79, v46, v47
    s_setprio 2
    s_waitcnt lgkmcnt(0)
    v_mfma_f32_32x32x16_bf16 v[0:15], v[64:67], v[176:179], 0
    s_add_u32 m0, s34, 0
    s_nop 0
    buffer_load_dwordx4 v222, s[4:7], s38 offen lds
    s_add_u32 m0, s34, 1024
    s_nop 0
    buffer_load_dwordx4 v223, s[4:7], s38 offen lds
    v_mfma_f32_32x32x16_bf16 v[16:31], v[68:71], v[176:179], 0
    s_waitcnt vmcnt(6)
    ds_read_b64_tr_b16 v[184:185], v246 offset:2048
    ds_read_b64_tr_b16 v[186:187], v246 offset:2560
    v_mfma_f32_32x32x16_bf16 v[32:47], v[64:67], v[180:183], 0
    ds_read_b64_tr_b16 v[188:189], v247 offset:2048
    ds_read_b64_tr_b16 v[190:191], v247 offset:2560
    v_mfma_f32_32x32x16_bf16 v[48:63], v[68:71], v[180:183], 0
    s_waitcnt lgkmcnt(0)
    v_mfma_f32_32x32x16_bf16 v[0:15], v[72:75], v[184:187], v[0:15]
    s_add_u32 m0, s34, 2048
    s_nop 0
    buffer_load_dwordx4 v224, s[4:7], s38 offen lds
    s_add_u32 m0, s34, 3072
    s_nop 0
    buffer_load_dwordx4 v225, s[4:7], s38 offen lds
    v_mfma_f32_32x32x16_bf16 v[16:31], v[76:79], v[184:187], v[16:31]
    s_waitcnt vmcnt(6)
    ds_read_b64_tr_b16 v[176:177], v246 offset:4096
    ds_read_b64_tr_b16 v[178:179], v246 offset:4608
    v_mfma_f32_32x32x16_bf16 v[32:47], v[72:75], v[188:191], v[32:47]
    ds_read_b64_tr_b16 v[180:181], v247 offset:4096
    ds_read_b64_tr_b16 v[182:183], v247 offset:4608
    v_mfma_f32_32x32x16_bf16 v[48:63], v[76:79], v[188:191], v[48:63]
    s_setprio 0
    s_add_u32 s35, s35, 1
    s_lshl_b32 s45, s35, 3
    s_add_u32 s45, s45, s16
    s_cmp_lt_u32 s45, s18
    s_cbranch_scc1 K2_cl_24
    s_mov_b32 s35, 8
    s_mov_b32 s45, -1
    v_mov_b32 v231, 162048
    v_mov_b32 v232, 1
    s_mov_b64 exec, 1
    ds_add_rtn_u32 v230, v231, v232
    s_mov_b64 exec, -1
K2_cl_24:
    v_mul_f32 v234, v0, v96
    v_mul_f32 v236, v8, v128
    v_mul_f32 v238, v16, v128
    v_mul_f32 v240, v24, v128
    v_fmac_f32 v234, v1, v97
    v_fmac_f32 v236, v9, v129
    v_fmac_f32 v238, v17, v129
    v_fmac_f32 v240, v25, v129
    v_fmac_f32 v234, v2, v98
    v_fmac_f32 v236, v10, v130
    v_fmac_f32 v238, v18, v130
    v_fmac_f32 v240, v26, v130
    v_fmac_f32 v234, v3, v99
    v_fmac_f32 v236, v11, v131
    v_fmac_f32 v238, v19, v131
    v_fmac_f32 v240, v27, v131
    v_fmac_f32 v234, v4, v100
    v_fmac_f32 v236, v12, v132
    v_fmac_f32 v238, v20, v132
    v_fmac_f32 v240, v28, v132
    v_fmac_f32 v234, v5, v101
    v_fmac_f32 v236, v13, v133
    v_fmac_f32 v238, v21, v133
    v_fmac_f32 v240, v29, v133
    v_fmac_f32 v234, v6, v102
    v_fmac_f32 v236, v14, v134
    v_fmac_f32 v238, v22, v134
    v_fmac_f32 v240, v30, v134
    v_fmac_f32 v234, v7, v103
    v_fmac_f32 v236, v15, v135
    v_fmac_f32 v238, v23, v135
    v_fmac_f32 v240, v31, v135
    v_mul_f32 v235, v32, v104
    v_mul_f32 v237, v40, v136
    v_mul_f32 v239, v48, v136
    v_mul_f32 v241, v56, v136
    v_fmac_f32 v235, v33, v105
    v_fmac_f32 v237, v41, v137
    v_fmac_f32 v239, v49, v137
    v_fmac_f32 v241, v57, v137
    v_fmac_f32 v235, v34, v106
    v_fmac_f32 v237, v42, v138
    v_fmac_f32 v239, v50, v138
    v_fmac_f32 v241, v58, v138
    v_fmac_f32 v235, v35, v107
    v_fmac_f32 v237, v43, v139
    v_fmac_f32 v239, v51, v139
    v_fmac_f32 v241, v59, v139
    v_fmac_f32 v235, v36, v108
    v_fmac_f32 v237, v44, v140
    v_fmac_f32 v239, v52, v140
    v_fmac_f32 v241, v60, v140
    v_fmac_f32 v235, v37, v109
    v_fmac_f32 v237, v45, v141
    v_fmac_f32 v239, v53, v141
    v_fmac_f32 v241, v61, v141
    v_fmac_f32 v235, v38, v110
    v_fmac_f32 v237, v46, v142
    v_fmac_f32 v239, v54, v142
    v_fmac_f32 v241, v62, v142
    v_fmac_f32 v235, v39, v111
    v_fmac_f32 v237, v47, v143
    v_fmac_f32 v239, v55, v143
    v_fmac_f32 v241, v63, v143
    v_permlane32_swap_b32 v234, v235
    v_permlane32_swap_b32 v236, v237
    v_permlane32_swap_b32 v238, v239
    v_permlane32_swap_b32 v240, v241
    v_add_f32 v234, v234, v235
    v_add_f32 v236, v236, v237
    v_add_f32 v238, v238, v239
    v_add_f32 v240, v240, v241
    s_cmp_lg_u32 s27, 0
    s_cbranch_scc1 K2_fl1_25
    s_set_gpr_idx_on s28, gpr_idx(DST)
    s_nop 0
    v_cvt_pk_bf16_f32 v192, v234, v236
    v_cvt_pk_bf16_f32 v193, v238, v240
    s_set_gpr_idx_off
    s_branch K2_fld_26
K2_fl1_25:
    v_add_u32 v254, s28, v252
    v_cvt_pk_bf16_f32 v234, v234, v236
    v_cvt_pk_bf16_f32 v238, v238, v240
    ds_write_b16 v254, v234 offset:0
    ds_write_b16_d16_hi v254, v234 offset:256
    ds_write_b16 v254, v238 offset:640
    ds_write_b16_d16_hi v254, v238 offset:1024
K2_fld_26:
    s_mov_b32 s31, 0
    s_mul_i32 s32, s35, 6
    s_mov_b32 s33, 1
    s_cmp_lg_u32 s45, -1
    s_cbranch_scc1 K2_st_27
    s_cmp_lg_u32 s27, 0
    s_cbranch_scc1 K2_nd_28
    s_mov_b64 exec, 1
    ds_add_u32 v231, v232 offset:8
    s_mov_b64 exec, -1
K2_nd_28:
    s_waitcnt lgkmcnt(0)
    v_readfirstlane_b32 s45, v230
    s_mov_b32 s31, 1
    s_cmp_lt_u32 s45, s18
    s_cselect_b32 s33, 1, 0
    s_cselect_b32 s45, s45, 63
K2_st_27:
    v_readlane_b32 s46, v253, s45
    s_nop 0
    s_and_b32 s29, s46, 0x3ffff
    s_bfe_u32 s30, s46, 0x30012
    s_cmp_eq_u32 s31, 0
    s_cbranch_scc1 K2_p1_29
    s_lshr_b32 s32, s46, 21
    s_add_u32 s32, s32, s29
K2_p1_29:
    s_lshl_b32 s47, s30, 3
    s_sub_u32 s47, s47, 8
    s_lshr_b32 s48, 0x4050e4, s47
    s_lshr_b32 s49, 0xe4244400, s47
    s_lshl_b32 s50, s31, 7
    s_mov_b32 s40, s50
    v_add_u32 v230, s29, v251
    s_bfe_u32 s51, s48, 0x20002
    s_lshl_b32 s51, s51, 8
    s_add_u32 s41, s51, s50
    s_bfe_u32 s51, s49, 0x20002
    s_mul_i32 s51, s51, 800
    s_add_u32 s51, s51, s29
    v_add_u32 v231, s51, v251
    s_bfe_u32 s51, s48, 0x20004
    s_lshl_b32 s51, s51, 8
    s_add_u32 s42, s51, s50
    s_bfe_u32 s51, s49, 0x20004
    s_mul_i32 s51, s51, 800
    s_add_u32 s51, s51, s29
    v_add_u32 v232, s51, v251
    s_bfe_u32 s51, s48, 0x20006
    s_lshl_b32 s51, s51, 8
    s_add_u32 s43, s51, s50
    s_bfe_u32 s51, s49, 0x20006
    s_mul_i32 s51, s51, 800
    s_add_u32 s51, s51, s29
    v_add_u32 v233, s51, v251
    ds_read_b32 v230, v230
    ds_read_b32 v231, v231
    ds_read_b32 v232, v232
    ds_read_b32 v233, v233
    s_setprio 2
    s_waitcnt lgkmcnt(4)
    v_mfma_f32_32x32x16_bf16 v[0:15], v[64:67], v[176:179], 0
    s_add_u32 m0, s34, 4096
    s_nop 0
    buffer_load_dwordx4 v222, s[4:7], s39 offen lds
    s_add_u32 m0, s34, 5120
    s_nop 0
    buffer_load_dwordx4 v223, s[4:7], s39 offen lds
    v_mfma_f32_32x32x16_bf16 v[16:31], v[68:71], v[176:179], 0
    s_waitcnt vmcnt(6)
    ds_read_b64_tr_b16 v[184:185], v246 offset:6144
    ds_read_b64_tr_b16 v[186:187], v246 offset:6656
    v_mfma_f32_32x32x16_bf16 v[32:47], v[64:67], v[180:183], 0
    ds_read_b64_tr_b16 v[188:189], v247 offset:6144
    ds_read_b64_tr_b16 v[190:191], v247 offset:6656
    v_mfma_f32_32x32x16_bf16 v[48:63], v[68:71], v[180:183], 0
    s_waitcnt lgkmcnt(0)
    v_mfma_f32_32x32x16_bf16 v[0:15], v[72:75], v[184:187], v[0:15]
    s_add_u32 m0, s34, 6144
    s_nop 0
    buffer_load_dwordx4 v224, s[4:7], s39 offen lds
    s_add_u32 m0, s34, 7168
    s_nop 0
    buffer_load_dwordx4 v225, s[4:7], s39 offen lds
    v_mfma_f32_32x32x16_bf16 v[16:31], v[76:79], v[184:187], v[16:31]
    s_waitcnt vmcnt(6)
    ds_read_b64_tr_b16 v[176:177], v246 offset:0
    ds_read_b64_tr_b16 v[178:179], v246 offset:512
    v_mfma_f32_32x32x16_bf16 v[32:47], v[72:75], v[188:191], v[32:47]
    ds_read_b64_tr_b16 v[180:181], v247 offset:0
    ds_read_b64_tr_b16 v[182:183], v247 offset:512
    v_mfma_f32_32x32x16_bf16 v[48:63], v[76:79], v[188:191], v[48:63]
    s_setprio 0
    v_mul_f32 v234, v0, v144
    v_mul_f32 v236, v8, v112
    s_nop 1
    v_mul_f32 v238, v16, v160
    v_mul_f32 v240, v24, v160
    v_fmac_f32 v234, v1, v145
    v_fmac_f32 v236, v9, v113
    v_fmac_f32 v238, v17, v161
    v_fmac_f32 v240, v25, v161
    v_fmac_f32 v234, v2, v146
    v_fmac_f32 v236, v10, v114
    v_fmac_f32 v238, v18, v162
    v_fmac_f32 v240, v26, v162
    v_fmac_f32 v234, v3, v147
    v_fmac_f32 v236, v11, v115
    v_fmac_f32 v238, v19, v163
    v_fmac_f32 v240, v27, v163
    v_fmac_f32 v234, v4, v148
    v_fmac_f32 v236, v12, v116
    v_fmac_f32 v238, v20, v164
    v_fmac_f32 v240, v28, v164
    v_fmac_f32 v234, v5, v149
    v_fmac_f32 v236, v13, v117
    v_fmac_f32 v238, v21, v165
    v_fmac_f32 v240, v29, v165
    v_fmac_f32 v234, v6, v150
    v_fmac_f32 v236, v14, v118
    v_fmac_f32 v238, v22, v166
    v_fmac_f32 v240, v30, v166
    v_fmac_f32 v234, v7, v151
    v_fmac_f32 v236, v15, v119
    v_fmac_f32 v238, v23, v167
    v_fmac_f32 v240, v31, v167
    v_mul_f32 v235, v32, v152
    v_mul_f32 v237, v40, v120
    v_mul_f32 v239, v48, v168
    v_mul_f32 v241, v56, v168
    v_fmac_f32 v235, v33, v153
    v_fmac_f32 v237, v41, v121
    v_fmac_f32 v239, v49, v169
    v_fmac_f32 v241, v57, v169
    v_fmac_f32 v235, v34, v154
    v_fmac_f32 v237, v42, v122
    v_fmac_f32 v239, v50, v170
    v_fmac_f32 v241, v58, v170
    v_fmac_f32 v235, v35, v155
    v_fmac_f32 v237, v43, v123
    v_fmac_f32 v239, v51, v171
    v_fmac_f32 v241, v59, v171
    v_fmac_f32 v235, v36, v156
    v_fmac_f32 v237, v44, v124
    v_fmac_f32 v239, v52, v172
    v_fmac_f32 v241, v60, v172
    v_fmac_f32 v235, v37, v157
    v_fmac_f32 v237, v45, v125
    v_fmac_f32 v239, v53, v173
    v_fmac_f32 v241, v61, v173
    v_fmac_f32 v235, v38, v158
    v_fmac_f32 v237, v46, v126
    v_fmac_f32 v239, v54, v174
    v_fmac_f32 v241, v62, v174
    v_fmac_f32 v235, v39, v159
    v_fmac_f32 v237, v47, v127
    v_fmac_f32 v239, v55, v175
    v_fmac_f32 v241, v63, v175
    v_permlane32_swap_b32 v234, v235
    v_add_f32 v234, v234, v235
    s_setprio 2
    s_waitcnt lgkmcnt(0)
    v_mfma_f32_32x32x16_bf16 v[0:15], v[64:67], v[176:179], 0
    v_mad_u32_u16 v222, v230, s44, v248
    v_mad_u32_u16 v223, v230, s44, v248 op_sel:[1,0,0,0]
    v_mad_u32_u16 v224, v231, s44, v248
    v_mad_u32_u16 v225, v231, s44, v248 op_sel:[1,0,0,0]
    v_mad_u32_u16 v226, v232, s44, v248
    v_mad_u32_u16 v227, v232, s44, v248 op_sel:[1,0,0,0]
    v_mad_u32_u16 v228, v233, s44, v248
    v_mad_u32_u16 v229, v233, s44, v248 op_sel:[1,0,0,0]
    s_add_u32 m0, s34, 0
    s_nop 0
    buffer_load_dwordx4 v222, s[4:7], s40 offen lds
    s_add_u32 m0, s34, 1024
    s_nop 0
    buffer_load_dwordx4 v223, s[4:7], s40 offen lds
    v_mfma_f32_32x32x16_bf16 v[16:31], v[68:71], v[176:179], 0
    s_waitcnt vmcnt(6)
    ds_read_b64_tr_b16 v[184:185], v246 offset:2048
    ds_read_b64_tr_b16 v[186:187], v246 offset:2560
    v_mfma_f32_32x32x16_bf16 v[32:47], v[64:67], v[180:183], 0
    ds_read_b64_tr_b16 v[188:189], v247 offset:2048
    ds_read_b64_tr_b16 v[190:191], v247 offset:2560
    v_mfma_f32_32x32x16_bf16 v[48:63], v[68:71], v[180:183], 0
    s_waitcnt lgkmcnt(0)
    v_mfma_f32_32x32x16_bf16 v[0:15], v[72:75], v[184:187], v[0:15]
    s_add_u32 m0, s34, 2048
    s_nop 0
    buffer_load_dwordx4 v224, s[4:7], s41 offen lds
    s_add_u32 m0, s34, 3072
    s_nop 0
    buffer_load_dwordx4 v225, s[4:7], s41 offen lds
    v_mfma_f32_32x32x16_bf16 v[16:31], v[76:79], v[184:187], v[16:31]
    s_waitcnt vmcnt(6)
    ds_read_b64_tr_b16 v[176:177], v246 offset:4096
    ds_read_b64_tr_b16 v[178:179], v246 offset:4608
    v_mfma_f32_32x32x16_bf16 v[32:47], v[72:75], v[188:191], v[32:47]
    ds_read_b64_tr_b16 v[180:181], v247 offset:4096
    ds_read_b64_tr_b16 v[182:183], v247 offset:4608
    v_mfma_f32_32x32x16_bf16 v[48:63], v[76:79], v[188:191], v[48:63]
    s_setprio 0
    v_mul_f32 v242, v0, v144
    v_fma_f32 v238, v8, v160, -v238
    s_nop 1
    v_fmac_f32 v236, v16, v112
    v_mul_f32 v244, v24, v160
    v_fmac_f32 v242, v1, v145
    v_fmac_f32 v238, v9, v161
    v_fmac_f32 v236, v17, v113
    v_fmac_f32 v244, v25, v161
    v_fmac_f32 v242, v2, v146
    v_fmac_f32 v238, v10, v162
    v_fmac_f32 v236, v18, v114
    v_fmac_f32 v244, v26, v162
    v_fmac_f32 v242, v3, v147
    v_fmac_f32 v238, v11, v163
    v_fmac_f32 v236, v19, v115
    v_fmac_f32 v244, v27, v163
    v_fmac_f32 v242, v4, v148
    v_fmac_f32 v238, v12, v164
    v_fmac_f32 v236, v20, v116
    v_fmac_f32 v244, v28, v164
    v_fmac_f32 v242, v5, v149
    v_fmac_f32 v238, v13, v165
    v_fmac_f32 v236, v21, v117
    v_fmac_f32 v244, v29, v165
    v_fmac_f32 v242, v6, v150
    v_fmac_f32 v238, v14, v166
    v_fmac_f32 v236, v22, v118
    v_fmac_f32 v244, v30, v166
    v_fmac_f32 v242, v7, v151
    v_fmac_f32 v238, v15, v167
    v_fmac_f32 v236, v23, v119
    v_fmac_f32 v244, v31, v167
    v_mul_f32 v243, v32, v152
    v_fma_f32 v239, v40, v168, -v239
    v_fmac_f32 v237, v48, v120
    v_mul_f32 v245, v56, v168
    v_fmac_f32 v243, v33, v153
    v_fmac_f32 v239, v41, v169
    v_fmac_f32 v237, v49, v121
    v_fmac_f32 v245, v57, v169
    v_fmac_f32 v243, v34, v154
    v_fmac_f32 v239, v42, v170
    v_fmac_f32 v237, v50, v122
    v_fmac_f32 v245, v58, v170
    v_fmac_f32 v243, v35, v155
    v_fmac_f32 v239, v43, v171
    v_fmac_f32 v237, v51, v123
    v_fmac_f32 v245, v59, v171
    v_fmac_f32 v243, v36, v156
    v_fmac_f32 v239, v44, v172
    v_fmac_f32 v237, v52, v124
    v_fmac_f32 v245, v60, v172
    v_fmac_f32 v243, v37, v157
    v_fmac_f32 v239, v45, v173
    v_fmac_f32 v237, v53, v125
    v_fmac_f32 v245, v61, v173
    v_fmac_f32 v243, v38, v158
    v_fmac_f32 v239, v46, v174
    v_fmac_f32 v237, v54, v126
    v_fmac_f32 v245, v62, v174
    v_fmac_f32 v243, v39, v159
    v_fmac_f32 v239, v47, v175
    v_fmac_f32 v237, v55, v127
    v_fmac_f32 v245, v63, v175
    v_permlane32_swap_b32 v242, v243
    v_permlane32_swap_b32 v238, v239
    v_add_f32 v242, v242, v243
    v_add_f32 v238, v238, v239
    s_cmp_lg_u32 s27, 0
    s_cbranch_scc1 K2_fl1_30
    s_set_gpr_idx_on s28, gpr_idx(DST)
    s_nop 0
    v_cvt_pk_bf16_f32 v194, v234, v242
    s_set_gpr_idx_off
    s_branch K2_fld_31
K2_fl1_30:
    v_add_u32 v254, s28, v252
    v_cvt_pk_bf16_f32 v234, v234, v242
    ds_write_b16 v254, v234 offset:384
    ds_write_b16_d16_hi v254, v234 offset:768
K2_fld_31:
    s_setprio 2
    s_waitcnt lgkmcnt(0)
    v_mfma_f32_32x32x16_bf16 v[0:15], v[64:67], v[176:179], 0
    s_add_u32 m0, s34, 4096
    s_nop 0
    buffer_load_dwordx4 v226, s[4:7], s42 offen lds
    s_add_u32 m0, s34, 5120
    s_nop 0
    buffer_load_dwordx4 v227, s[4:7], s42 offen lds
    v_mfma_f32_32x32x16_bf16 v[16:31], v[68:71], v[176:179], 0
    s_waitcnt vmcnt(6)
    ds_read_b64_tr_b16 v[184:185], v246 offset:6144
    ds_read_b64_tr_b16 v[186:187], v246 offset:6656
    v_mfma_f32_32x32x16_bf16 v[32:47], v[64:67], v[180:183], 0
    ds_read_b64_tr_b16 v[188:189], v247 offset:6144
    ds_read_b64_tr_b16 v[190:191], v247 offset:6656
    v_mfma_f32_32x32x16_bf16 v[48:63], v[68:71], v[180:183], 0
    s_waitcnt lgkmcnt(0)
    v_mfma_f32_32x32x16_bf16 v[0:15], v[72:75], v[184:187], v[0:15]
    s_add_u32 m0, s34, 6144
    s_nop 0
    buffer_load_dwordx4 v228, s[4:7], s43 offen lds
    s_add_u32 m0, s34, 7168
    s_nop 0
    buffer_load_dwordx4 v229, s[4:7], s43 offen lds
    v_mfma_f32_32x32x16_bf16 v[16:31], v[76:79], v[184:187], v[16:31]
    s_waitcnt vmcnt(6)
    ds_read_b64_tr_b16 v[176:177], v246 offset:0
    ds_read_b64_tr_b16 v[178:179], v246 offset:512
    v_mfma_f32_32x32x16_bf16 v[32:47], v[72:75], v[188:191], v[32:47]
    ds_read_b64_tr_b16 v[180:181], v247 offset:0
    ds_read_b64_tr_b16 v[182:183], v247 offset:512
    v_mfma_f32_32x32x16_bf16 v[48:63], v[76:79], v[188:191], v[48:63]
    s_setprio 0
    v_mul_f32 v242, v0, v144
    v_fma_f32 v240, v8, v160, -v240
    s_nop 1
    v_fma_f32 v244, v16, v160, -v244
    v_fmac_f32 v236, v24, v112
    v_fmac_f32 v242, v1, v145
    v_fmac_f32 v240, v9, v161
    v_fmac_f32 v244, v17, v161
    v_fmac_f32 v236, v25, v113
    v_fmac_f32 v242, v2, v146
    v_fmac_f32 v240, v10, v162
    v_fmac_f32 v244, v18, v162
    v_fmac_f32 v236, v26, v114
    v_fmac_f32 v242, v3, v147
    v_fmac_f32 v240, v11, v163
    v_fmac_f32 v244, v19, v163
    v_fmac_f32 v236, v27, v115
    v_fmac_f32 v242, v4, v148
    v_fmac_f32 v240, v12, v164
    v_fmac_f32 v244, v20, v164
    v_fmac_f32 v236, v28, v116
    v_fmac_f32 v242, v5, v149
    v_fmac_f32 v240, v13, v165
    v_fmac_f32 v244, v21, v165
    v_fmac_f32 v236, v29, v117
    v_fmac_f32 v242, v6, v150
    v_fmac_f32 v240, v14, v166
    v_fmac_f32 v244, v22, v166
    v_fmac_f32 v236, v30, v118
    v_fmac_f32 v242, v7, v151
    v_fmac_f32 v240, v15, v167
    v_fmac_f32 v244, v23, v167
    v_fmac_f32 v236, v31, v119
    v_mul_f32 v243, v32, v152
    v_fma_f32 v241, v40, v168, -v241
    v_fma_f32 v245, v48, v168, -v245
    v_fmac_f32 v237, v56, v120
    v_fmac_f32 v243, v33, v153
    v_fmac_f32 v241, v41, v169
    v_fmac_f32 v245, v49, v169
    v_fmac_f32 v237, v57, v121
    v_fmac_f32 v243, v34, v154
    v_fmac_f32 v241, v42, v170
    v_fmac_f32 v245, v50, v170
    v_fmac_f32 v237, v58, v122
    v_fmac_f32 v243, v35, v155
    v_fmac_f32 v241, v43, v171
    v_fmac_f32 v245, v51, v171
    v_fmac_f32 v237, v59, v123
    v_fmac_f32 v243, v36, v156
    v_fmac_f32 v241, v44, v172
    v_fmac_f32 v245, v52, v172
    v_fmac_f32 v237, v60, v124
    v_fmac_f32 v243, v37, v157
    v_fmac_f32 v241, v45, v173
    v_fmac_f32 v245, v53, v173
    v_fmac_f32 v237, v61, v125
    v_fmac_f32 v243, v38, v158
    v_fmac_f32 v241, v46, v174
    v_fmac_f32 v245, v54, v174
    v_fmac_f32 v237, v62, v126
    v_fmac_f32 v243, v39, v159
    v_fmac_f32 v241, v47, v175
    v_fmac_f32 v245, v55, v175
    v_fmac_f32 v237, v63, v127
    v_permlane32_swap_b32 v242, v243
    s_nop 0
    v_permlane32_swap_b32 v236, v237
    v_permlane32_swap_b32 v240, v241
    v_permlane32_swap_b32 v244, v245
    v_add_f32 v242, v242, v243
    v_add_f32 v236, v236, v237
    v_add_f32 v240, -v240, -v241
    v_add_f32 v244, v244, v245
    s_cmp_lg_u32 s27, 0
    s_cbranch_scc1 K2_fl1_32
    s_set_gpr_idx_on s28, gpr_idx(DST)
    s_nop 0
    v_cvt_pk_bf16_f32 v195, v242, v236
    v_cvt_pk_bf16_f32 v196, v244, v240
    v_cvt_pk_bf16_f32 v197, v238, v238
    s_set_gpr_idx_off
    s_branch K2_fld_33
K2_fl1_32:
    v_add_u32 v254, s28, v252
    v_cvt_pk_bf16_f32 v242, v242, v236
    v_cvt_pk_bf16_f32 v244, v244, v240
    v_cvt_pk_bf16_f32 v238, v238, v238
    ds_write_b16 v254, v242 offset:1152
    ds_write_b16_d16_hi v254, v242 offset:128
    ds_write_b16 v254, v244 offset:512
    ds_write_b16_d16_hi v254, v244 offset:896
    ds_write_b16 v254, v238 offset:1280
K2_fld_33:
    s_branch K2_NEXT
K2_UNIT3:
    v_add_u32 v62, s25, v249
    v_add_u32 v63, s25, v250
    ds_read_b64_tr_b16 v[0:1], v62 offset:0
    ds_read_b64_tr_b16 v[2:3], v62 offset:128
    ds_read_b128 v[4:7], v63 offset:0
    ds_read_b128 v[8:11], v63 offset:16
    ds_read_b128 v[12:15], v63 offset:128
    ds_read_b128 v[16:19], v63 offset:144
    ds_read_b64_tr_b16 v[28:29], v62 offset:800
    ds_read_b64_tr_b16 v[30:31], v62 offset:928
    ds_read_b128 v[32:35], v63 offset:800
    ds_read_b128 v[36:39], v63 offset:816
    ds_read_b128 v[40:43], v63 offset:928
    ds_read_b128 v[44:47], v63 offset:944
    s_waitcnt lgkmcnt(10)
    v_lshlrev_b32 v20, 16, v0
    v_and_b32 v21, 0xffff0000, v0
    v_lshlrev_b32 v22, 16, v1
    v_and_b32 v23, 0xffff0000, v1
    v_lshlrev_b32 v24, 16, v2
    v_and_b32 v25, 0xffff0000, v2
    v_lshlrev_b32 v26, 16, v3
    v_and_b32 v27, 0xffff0000, v3
    s_waitcnt lgkmcnt(8)
    v_mul_f32 v4, v20, v4
    v_mul_f32 v5, v21, v5
    v_mul_f32 v6, v22, v6
    v_mul_f32 v7, v23, v7
    v_mul_f32 v8, v24, v8
    v_mul_f32 v9, v25, v9
    v_mul_f32 v10, v26, v10
    v_mul_f32 v11, v27, v11
    v_cvt_pk_bf16_f32 v64, v4, v5
    v_cvt_pk_bf16_f32 v65, v6, v7
    v_cvt_pk_bf16_f32 v66, v8, v9
    v_cvt_pk_bf16_f32 v67, v10, v11
    s_waitcnt lgkmcnt(6)
    v_mul_f32 v12, v20, v12
    v_mul_f32 v13, v21, v13
    v_mul_f32 v14, v22, v14
    v_mul_f32 v15, v23, v15
    v_mul_f32 v16, v24, v16
    v_mul_f32 v17, v25, v17
    v_mul_f32 v18, v26, v18
    v_mul_f32 v19, v27, v19
    v_cvt_pk_bf16_f32 v68, v12, v13
    v_cvt_pk_bf16_f32 v69, v14, v15
    v_cvt_pk_bf16_f32 v70, v16, v17
    v_cvt_pk_bf16_f32 v71, v18, v19
    ds_read_b64_tr_b16 v[0:1], v62 offset:1600
    ds_read_b64_tr_b16 v[2:3], v62 offset:1728
    ds_read_b128 v[4:7], v63 offset:1600
    ds_read_b128 v[8:11], v63 offset:1616
    ds_read_b128 v[12:15], v63 offset:1728
    ds_read_b128 v[16:19], v63 offset:1744
    s_waitcnt lgkmcnt(10)
    v_lshlrev_b32 v48, 16, v28
    v_and_b32 v49, 0xffff0000, v28
    v_lshlrev_b32 v50, 16, v29
    v_and_b32 v51, 0xffff0000, v29
    v_lshlrev_b32 v52, 16, v30
    v_and_b32 v53, 0xffff0000, v30
    v_lshlrev_b32 v54, 16, v31
    v_and_b32 v55, 0xffff0000, v31
    s_waitcnt lgkmcnt(8)
    v_mul_f32 v32, v48, v32
    v_mul_f32 v33, v49, v33
    v_mul_f32 v34, v50, v34
    v_mul_f32 v35, v51, v35
    v_mul_f32 v36, v52, v36
    v_mul_f32 v37, v53, v37
    v_mul_f32 v38, v54, v38
    v_mul_f32 v39, v55, v39
    v_cvt_pk_bf16_f32 v72, v32, v33
    v_cvt_pk_bf16_f32 v73, v34, v35
    v_cvt_pk_bf16_f32 v74, v36, v37
    v_cvt_pk_bf16_f32 v75, v38, v39
    s_waitcnt lgkmcnt(6)
    v_mul_f32 v40, v48, v40
    v_mul_f32 v41, v49, v41
    v_mul_f32 v42, v50, v42
    v_mul_f32 v43, v51, v43
    v_mul_f32 v44, v52, v44
    v_mul_f32 v45, v53, v45
    v_mul_f32 v46, v54, v46
    v_mul_f32 v47, v55, v47
    v_cvt_pk_bf16_f32 v76, v40, v41
    v_cvt_pk_bf16_f32 v77, v42, v43
    v_cvt_pk_bf16_f32 v78, v44, v45
    v_cvt_pk_bf16_f32 v79, v46, v47
    s_waitcnt lgkmcnt(4)
    v_lshlrev_b32 v20, 16, v0
    v_and_b32 v21, 0xffff0000, v0
    v_lshlrev_b32 v22, 16, v1
    v_and_b32 v23, 0xffff0000, v1
    v_lshlrev_b32 v24, 16, v2
    v_and_b32 v25, 0xffff0000, v2
    v_lshlrev_b32 v26, 16, v3
    v_and_b32 v27, 0xffff0000, v3
    s_waitcnt lgkmcnt(2)
    v_mul_f32 v4, v20, v4
    v_mul_f32 v5, v21, v5
    v_mul_f32 v6, v22, v6
    v_mul_f32 v7, v23, v7
    v_mul_f32 v8, v24, v8
    v_mul_f32 v9, v25, v9
    v_mul_f32 v10, v26, v10
    v_mul_f32 v11, v27, v11
    v_cvt_pk_bf16_f32 v80, v4, v5
    v_cvt_pk_bf16_f32 v81, v6, v7
    v_cvt_pk_bf16_f32 v82, v8, v9
    v_cvt_pk_bf16_f32 v83, v10, v11
    s_waitcnt lgkmcnt(0)
    v_mul_f32 v12, v20, v12
    v_mul_f32 v13, v21, v13
    v_mul_f32 v14, v22, v14
    v_mul_f32 v15, v23, v15
    v_mul_f32 v16, v24, v16
    v_mul_f32 v17, v25, v17
    v_mul_f32 v18, v26, v18
    v_mul_f32 v19, v27, v19
    v_cvt_pk_bf16_f32 v84, v12, v13
    v_cvt_pk_bf16_f32 v85, v14, v15
    v_cvt_pk_bf16_f32 v86, v16, v17
    v_cvt_pk_bf16_f32 v87, v18, v19
    s_setprio 2
    s_waitcnt lgkmcnt(0)
    v_mfma_f32_32x32x16_bf16 v[0:15], v[64:67], v[176:179], 0
    s_add_u32 m0, s34, 0
    s_nop 0
    buffer_load_dwordx4 v224, s[4:7], s37 offen lds
    s_add_u32 m0, s34, 1024
    s_nop 0
    buffer_load_dwordx4 v225, s[4:7], s37 offen lds
    v_mfma_f32_32x32x16_bf16 v[16:31], v[68:71], v[176:179], 0
    s_waitcnt vmcnt(6)
    ds_read_b64_tr_b16 v[184:185], v246 offset:2048
    ds_read_b64_tr_b16 v[186:187], v246 offset:2560
    v_mfma_f32_32x32x16_bf16 v[32:47], v[64:67], v[180:183], 0
    ds_read_b64_tr_b16 v[188:189], v247 offset:2048
    ds_read_b64_tr_b16 v[190:191], v247 offset:2560
    v_mfma_f32_32x32x16_bf16 v[48:63], v[68:71], v[180:183], 0
    s_waitcnt lgkmcnt(0)
    v_mfma_f32_32x32x16_bf16 v[0:15], v[72:75], v[184:187], v[0:15]
    s_add_u32 m0, s34, 2048
    s_nop 0
    buffer_load_dwordx4 v226, s[4:7], s37 offen lds
    s_add_u32 m0, s34, 3072
    s_nop 0
    buffer_load_dwordx4 v227, s[4:7], s37 offen lds
    v_mfma_f32_32x32x16_bf16 v[16:31], v[76:79], v[184:187], v[16:31]
    s_waitcnt vmcnt(6)
    ds_read_b64_tr_b16 v[176:177], v246 offset:4096
    ds_read_b64_tr_b16 v[178:179], v246 offset:4608
    v_mfma_f32_32x32x16_bf16 v[32:47], v[72:75], v[188:191], v[32:47]
    ds_read_b64_tr_b16 v[180:181], v247 offset:4096
    ds_read_b64_tr_b16 v[182:183], v247 offset:4608
    v_mfma_f32_32x32x16_bf16 v[48:63], v[76:79], v[188:191], v[48:63]
    s_waitcnt lgkmcnt(0)
    v_mfma_f32_32x32x16_bf16 v[0:15], v[80:83], v[176:179], v[0:15]
    s_add_u32 m0, s34, 4096
    s_nop 0
    buffer_load_dwordx4 v222, s[4:7], s38 offen lds
    s_add_u32 m0, s34, 5120
    s_nop 0
    buffer_load_dwordx4 v223, s[4:7], s38 offen lds
    v_mfma_f32_32x32x16_bf16 v[16:31], v[84:87], v[176:179], v[16:31]
    s_waitcnt vmcnt(6)
    ds_read_b64_tr_b16 v[184:185], v246 offset:6144
    ds_read_b64_tr_b16 v[186:187], v246 offset:6656
    v_mfma_f32_32x32x16_bf16 v[32:47], v[80:83], v[180:183], v[32:47]
    ds_read_b64_tr_b16 v[188:189], v247 offset:6144
    ds_read_b64_tr_b16 v[190:191], v247 offset:6656
    v_mfma_f32_32x32x16_bf16 v[48:63], v[84:87], v[180:183], v[48:63]
    s_setprio 0
    s_add_u32 s35, s35, 1
    s_lshl_b32 s45, s35, 3
    s_add_u32 s45, s45, s16
    s_cmp_lt_u32 s45, s18
    s_cbranch_scc1 K2_cl_35
    s_mov_b32 s35, 8
    s_mov_b32 s45, -1
    v_mov_b32 v231, 162048
    v_mov_b32 v232, 1
    s_mov_b64 exec, 1
    ds_add_rtn_u32 v230, v231, v232
    s_mov_b64 exec, -1
K2_cl_35:
    v_mul_f32 v234, v0, v96
    v_mul_f32 v236, v8, v128
    v_mul_f32 v238, v16, v128
    v_mul_f32 v240, v24, v128
    v_fmac_f32 v234, v1, v97
    v_fmac_f32 v236, v9, v129
    v_fmac_f32 v238, v17, v129
    v_fmac_f32 v240, v25, v129
    v_fmac_f32 v234, v2, v98
    v_fmac_f32 v236, v10, v130
    v_fmac_f32 v238, v18, v130
    v_fmac_f32 v240, v26, v130
    v_fmac_f32 v234, v3, v99
    v_fmac_f32 v236, v11, v131
    v_fmac_f32 v238, v19, v131
    v_fmac_f32 v240, v27, v131
    v_fmac_f32 v234, v4, v100
    v_fmac_f32 v236, v12, v132
    v_fmac_f32 v238, v20, v132
    v_fmac_f32 v240, v28, v132
    v_fmac_f32 v234, v5, v101
    v_fmac_f32 v236, v13, v133
    v_fmac_f32 v238, v21, v133
    v_fmac_f32 v240, v29, v133
    v_fmac_f32 v234, v6, v102
    v_fmac_f32 v236, v14, v134
    v_fmac_f32 v238, v22, v134
    v_fmac_f32 v240, v30, v134
    v_fmac_f32 v234, v7, v103
    v_fmac_f32 v236, v15, v135
    v_fmac_f32 v238, v23, v135
    v_fmac_f32 v240, v31, v135
    v_mul_f32 v235, v32, v104
    v_mul_f32 v237, v40, v136
    v_mul_f32 v239, v48, v136
    v_mul_f32 v241, v56, v136
    v_fmac_f32 v235, v33, v105
    v_fmac_f32 v237, v41, v137
    v_fmac_f32 v239, v49, v137
    v_fmac_f32 v241, v57, v137
    v_fmac_f32 v235, v34, v106
    v_fmac_f32 v237, v42, v138
    v_fmac_f32 v239, v50, v138
    v_fmac_f32 v241, v58, v138
    v_fmac_f32 v235, v35, v107
    v_fmac_f32 v237, v43, v139
    v_fmac_f32 v239, v51, v139
    v_fmac_f32 v241, v59, v139
    v_fmac_f32 v235, v36, v108
    v_fmac_f32 v237, v44, v140
    v_fmac_f32 v239, v52, v140
    v_fmac_f32 v241, v60, v140
    v_fmac_f32 v235, v37, v109
    v_fmac_f32 v237, v45, v141
    v_fmac_f32 v239, v53, v141
    v_fmac_f32 v241, v61, v141
    v_fmac_f32 v235, v38, v110
    v_fmac_f32 v237, v46, v142
    v_fmac_f32 v239, v54, v142
    v_fmac_f32 v241, v62, v142
    v_fmac_f32 v235, v39, v111
    v_fmac_f32 v237, v47, v143
    v_fmac_f32 v239, v55, v143
    v_fmac_f32 v241, v63, v143
    v_permlane32_swap_b32 v234, v235
    v_permlane32_swap_b32 v236, v237
    v_permlane32_swap_b32 v238, v239
    v_permlane32_swap_b32 v240, v241
    v_add_f32 v234, v234, v235
    v_add_f32 v236, v236, v237
    v_add_f32 v238, v238, v239
    v_add_f32 v240, v240, v241
    s_cmp_lg_u32 s27, 0
    s_cbranch_scc1 K2_fl1_36
    s_set_gpr_idx_on s28, gpr_idx(DST)
    s_nop 0
    v_cvt_pk_bf16_f32 v192, v234, v236
    v_cvt_pk_bf16_f32 v193, v238, v240
    s_set_gpr_idx_off
    s_branch K2_fld_37
K2_fl1_36:
    v_add_u32 v254, s28, v252
    v_cvt_pk_bf16_f32 v234, v234, v236
    v_cvt_pk_bf16_f32 v238, v238, v240
    ds_write_b16 v254, v234 offset:0
    ds_write_b16_d16_hi v254, v234 offset:256
    ds_write_b16 v254, v238 offset:640
    ds_write_b16_d16_hi v254, v238 offset:1024
K2_fld_37:
    s_mov_b32 s31, 0
    s_mul_i32 s32, s35, 6
    s_mov_b32 s33, 1
    s_cmp_lg_u32 s45, -1
    s_cbranch_scc1 K2_st_38
    s_cmp_lg_u32 s27, 0
    s_cbranch_scc1 K2_nd_39
    s_mov_b64 exec, 1
    ds_add_u32 v231, v232 offset:8
    s_mov_b64 exec, -1
K2_nd_39:
    s_waitcnt lgkmcnt(0)
    v_readfirstlane_b32 s45, v230
    s_mov_b32 s31, 1
    s_cmp_lt_u32 s45, s18
    s_cselect_b32 s33, 1, 0
    s_cselect_b32 s45, s45, 63
K2_st_38:
    v_readlane_b32 s46, v253, s45
    s_nop 0
    s_and_b32 s29, s46, 0x3ffff
    s_bfe_u32 s30, s46, 0x30012
    s_cmp_eq_u32 s31, 0
    s_cbranch_scc1 K2_p1_40
    s_lshr_b32 s32, s46, 21
    s_add_u32 s32, s32, s29
K2_p1_40:
    s_lshl_b32 s47, s30, 3
    s_sub_u32 s47, s47, 8
    s_lshr_b32 s48, 0x4050e4, s47
    s_lshr_b32 s49, 0xe4244400, s47
    s_lshl_b32 s50, s31, 7
    s_mov_b32 s40, s50
    v_add_u32 v230, s29, v251
    s_bfe_u32 s51, s48, 0x20002
    s_lshl_b32 s51, s51, 8
    s_add_u32 s41, s51, s50
    s_bfe_u32 s51, s49, 0x20002
    s_mul_i32 s51, s51, 800
    s_add_u32 s51, s51, s29
    v_add_u32 v231, s51, v251
    s_bfe_u32 s51, s48, 0x20004
    s_lshl_b32 s51, s51, 8
    s_add_u32 s42, s51, s50
    s_bfe_u32 s51, s49, 0x20004
    s_mul_i32 s51, s51, 800
    s_add_u32 s51, s51, s29
    v_add_u32 v232, s51, v251
    s_bfe_u32 s51, s48, 0x20006
    s_lshl_b32 s51, s51, 8
    s_add_u32 s43, s51, s50
    s_bfe_u32 s51, s49, 0x20006
    s_mul_i32 s51, s51, 800
    s_add_u32 s51, s51, s29
    v_add_u32 v233, s51, v251
    ds_read_b32 v230, v230
    ds_read_b32 v231, v231
    ds_read_b32 v232, v232
    ds_read_b32 v233, v233
    s_setprio 2
    s_waitcnt lgkmcnt(4)
    v_mfma_f32_32x32x16_bf16 v[0:15], v[64:67], v[184:187], 0
    s_add_u32 m0, s34, 6144
    s_nop 0
    buffer_load_dwordx4 v224, s[4:7], s38 offen lds
    s_add_u32 m0, s34, 7168
    s_nop 0
    buffer_load_dwordx4 v225, s[4:7], s38 offen lds
    v_mfma_f32_32x32x16_bf16 v[16:31], v[68:71], v[184:187], 0
    s_waitcnt vmcnt(6)
    ds_read_b64_tr_b16 v[176:177], v246 offset:0
    ds_read_b64_tr_b16 v[178:179], v246 offset:512
    v_mfma_f32_32x32x16_bf16 v[32:47], v[64:67], v[188:191], 0
    ds_read_b64_tr_b16 v[180:181], v247 offset:0
    ds_read_b64_tr_b16 v[182:183], v247 offset:512
    v_mfma_f32_32x32x16_bf16 v[48:63], v[68:71], v[188:191], 0
    s_waitcnt lgkmcnt(0)
    v_mfma_f32_32x32x16_bf16 v[0:15], v[72:75], v[176:179], v[0:15]
    s_add_u32 m0, s34, 0
    s_nop 0
    buffer_load_dwordx4 v226, s[4:7], s38 offen lds
    s_add_u32 m0, s34, 1024
    s_nop 0
    buffer_load_dwordx4 v227, s[4:7], s38 offen lds
    v_mfma_f32_32x32x16_bf16 v[16:31], v[76:79], v[176:179], v[16:31]
    s_waitcnt vmcnt(6)
    ds_read_b64_tr_b16 v[184:185], v246 offset:2048
    ds_read_b64_tr_b16 v[186:187], v246 offset:2560
    v_mfma_f32_32x32x16_bf16 v[32:47], v[72:75], v[180:183], v[32:47]
    ds_read_b64_tr_b16 v[188:189], v247 offset:2048
    ds_read_b64_tr_b16 v[190:191], v247 offset:2560
    v_mfma_f32_32x32x16_bf16 v[48:63], v[76:79], v[180:183], v[48:63]
    s_waitcnt lgkmcnt(0)
    v_mfma_f32_32x32x16_bf16 v[0:15], v[80:83], v[184:187], v[0:15]
    s_add_u32 m0, s34, 2048
    s_nop 0
    buffer_load_dwordx4 v222, s[4:7], s39 offen lds
    s_add_u32 m0, s34, 3072
    s_nop 0
    buffer_load_dwordx4 v223, s[4:7], s39 offen lds
    v_mfma_f32_32x32x16_bf16 v[16:31], v[84:87], v[184:187], v[16:31]
    s_waitcnt vmcnt(6)
    ds_read_b64_tr_b16 v[176:177], v246 offset:4096
    ds_read_b64_tr_b16 v[178:179], v246 offset:4608
    v_mfma_f32_32x32x16_bf16 v[32:47], v[80:83], v[188:191], v[32:47]
    ds_read_b64_tr_b16 v[180:181], v247 offset:4096
    ds_read_b64_tr_b16 v[182:183], v247 offset:4608
    v_mfma_f32_32x32x16_bf16 v[48:63], v[84:87], v[188:191], v[48:63]
    s_setprio 0
    v_mul_f32 v234, v0, v144
    v_mul_f32 v236, v8, v112
    s_nop 1
    v_mul_f32 v238, v16, v160
    v_mul_f32 v240, v24, v160
    v_fmac_f32 v234, v1, v145
    v_fmac_f32 v236, v9, v113
    v_fmac_f32 v238, v17, v161
    v_fmac_f32 v240, v25, v161
    v_fmac_f32 v234, v2, v146
    v_fmac_f32 v236, v10, v114
    v_fmac_f32 v238, v18, v162
    v_fmac_f32 v240, v26, v162
    v_fmac_f32 v234, v3, v147
    v_fmac_f32 v236, v11, v115
    v_fmac_f32 v238, v19, v163
    v_fmac_f32 v240, v27, v163
    v_fmac_f32 v234, v4, v148
    v_fmac_f32 v236, v12, v116
    v_fmac_f32 v238, v20, v164
    v_fmac_f32 v240, v28, v164
    v_fmac_f32 v234, v5, v149
    v_fmac_f32 v236, v13, v117
    v_fmac_f32 v238, v21, v165
    v_fmac_f32 v240, v29, v165
    v_fmac_f32 v234, v6, v150
    v_fmac_f32 v236, v14, v118
    v_fmac_f32 v238, v22, v166
    v_fmac_f32 v240, v30, v166
    v_fmac_f32 v234, v7, v151
    v_fmac_f32 v236, v15, v119
    v_fmac_f32 v238, v23, v167
    v_fmac_f32 v240, v31, v167
    v_mul_f32 v235, v32, v152
    v_mul_f32 v237, v40, v120
    v_mul_f32 v239, v48, v168
    v_mul_f32 v241, v56, v168
    v_fmac_f32 v235, v33, v153
    v_fmac_f32 v237, v41, v121
    v_fmac_f32 v239, v49, v169
    v_fmac_f32 v241, v57, v169
    v_fmac_f32 v235, v34, v154
    v_fmac_f32 v237, v42, v122
    v_fmac_f32 v239, v50, v170
    v_fmac_f32 v241, v58, v170
    v_fmac_f32 v235, v35, v155
    v_fmac_f32 v237, v43, v123
    v_fmac_f32 v239, v51, v171
    v_fmac_f32 v241, v59, v171
    v_fmac_f32 v235, v36, v156
    v_fmac_f32 v237, v44, v124
    v_fmac_f32 v239, v52, v172
    v_fmac_f32 v241, v60, v172
    v_fmac_f32 v235, v37, v157
    v_fmac_f32 v237, v45, v125
    v_fmac_f32 v239, v53, v173
    v_fmac_f32 v241, v61, v173
    v_fmac_f32 v235, v38, v158
    v_fmac_f32 v237, v46, v126
    v_fmac_f32 v239, v54, v174
    v_fmac_f32 v241, v62, v174
    v_fmac_f32 v235, v39, v159
    v_fmac_f32 v237, v47, v127
    v_fmac_f32 v239, v55, v175
    v_fmac_f32 v241, v63, v175
    v_permlane32_swap_b32 v234, v235
    v_add_f32 v234, v234, v235
    s_setprio 2
    s_waitcnt lgkmcnt(0)
    v_mfma_f32_32x32x16_bf16 v[0:15], v[64:67], v[176:179], 0
    s_add_u32 m0, s34, 4096
    s_nop 0
    buffer_load_dwordx4 v224, s[4:7], s39 offen lds
    s_add_u32 m0, s34, 5120
    s_nop 0
    buffer_load_dwordx4 v225, s[4:7], s39 offen lds
    v_mfma_f32_32x32x16_bf16 v[16:31], v[68:71], v[176:179], 0
    s_waitcnt vmcnt(6)
    ds_read_b64_tr_b16 v[184:185], v246 offset:6144
    ds_read_b64_tr_b16 v[186:187], v246 offset:6656
    v_mfma_f32_32x32x16_bf16 v[32:47], v[64:67], v[180:183], 0
    ds_read_b64_tr_b16 v[188:189], v247 offset:6144
    ds_read_b64_tr_b16 v[190:191], v247 offset:6656
    v_mfma_f32_32x32x16_bf16 v[48:63], v[68:71], v[180:183], 0
    s_waitcnt lgkmcnt(0)
    v_mfma_f32_32x32x16_bf16 v[0:15], v[72:75], v[184:187], v[0:15]
    s_add_u32 m0, s34, 6144
    s_nop 0
    buffer_load_dwordx4 v226, s[4:7], s39 offen lds
    s_add_u32 m0, s34, 7168
    s_nop 0
    buffer_load_dwordx4 v227, s[4:7], s39 offen lds
    v_mfma_f32_32x32x16_bf16 v[16:31], v[76:79], v[184:187], v[16:31]
    s_waitcnt vmcnt(6)
    ds_read_b64_tr_b16 v[176:177], v246 offset:0
    ds_read_b64_tr_b16 v[178:179], v246 offset:512
    v_mfma_f32_32x32x16_bf16 v[32:47], v[72:75], v[188:191], v[32:47]
    ds_read_b64_tr_b16 v[180:181], v247 offset:0
    ds_read_b64_tr_b16 v[182:183], v247 offset:512
    v_mfma_f32_32x32x16_bf16 v[48:63], v[76:79], v[188:191], v[48:63]
    s_waitcnt lgkmcnt(0)
    v_mfma_f32_32x32x16_bf16 v[0:15], v[80:83], v[176:179], v[0:15]
    v_mad_u32_u16 v222, v230, s44, v248
    v_mad_u32_u16 v223, v230, s44, v248 op_sel:[1,0,0,0]
    v_mad_u32_u16 v224, v231, s44, v248
    v_mad_u32_u16 v225, v231, s44, v248 op_sel:[1,0,0,0]
    v_mad_u32_u16 v226, v232, s44, v248
    v_mad_u32_u16 v227, v232, s44, v248 op_sel:[1,0,0,0]
    v_mad_u32_u16 v228, v233, s44, v248
    v_mad_u32_u16 v229, v233, s44, v248 op_sel:[1,0,0,0]
    s_add_u32 m0, s34, 0
    s_nop 0
    buffer_load_dwordx4 v222, s[4:7], s40 offen lds
    s_add_u32 m0, s34, 1024
    s_nop 0
    buffer_load_dwordx4 v223, s[4:7], s40 offen lds
    v_mfma_f32_32x32x16_bf16 v[16:31], v[84:87], v[176:179], v[16:31]
    s_waitcnt vmcnt(6)
    ds_read_b64_tr_b16 v[184:185], v246 offset:2048
    ds_read_b64_tr_b16 v[186:187], v246 offset:2560
    v_mfma_f32_32x32x16_bf16 v[32:47], v[80:83], v[180:183], v[32:47]
    ds_read_b64_tr_b16 v[188:189], v247 offset:2048
    ds_read_b64_tr_b16 v[190:191], v247 offset:2560
    v_mfma_f32_32x32x16_bf16 v[48:63], v[84:87], v[180:183], v[48:63]
    s_setprio 0
    v_mul_f32 v242, v0, v144
    v_fma_f32 v238, v8, v160, -v238
    s_nop 1
    v_fmac_f32 v236, v16, v112
    s_nop 0
    v_mul_f32 v244, v24, v160
    v_fmac_f32 v242, v1, v145
    v_fmac_f32 v238, v9, v161
    v_fmac_f32 v236, v17, v113
    v_fmac_f32 v244, v25, v161
    v_fmac_f32 v242, v2, v146
    v_fmac_f32 v238, v10, v162
    v_fmac_f32 v236, v18, v114
    v_fmac_f32 v244, v26, v162
    v_fmac_f32 v242, v3, v147
    v_fmac_f32 v238, v11, v163
    v_fmac_f32 v236, v19, v115
    v_fmac_f32 v244, v27, v163
    v_fmac_f32 v242, v4, v148
    v_fmac_f32 v238, v12, v164
    v_fmac_f32 v236, v20, v116
    v_fmac_f32 v244, v28, v164
    v_fmac_f32 v242, v5, v149
    v_fmac_f32 v238, v13, v165
    v_fmac_f32 v236, v21, v117
    v_fmac_f32 v244, v29, v165
    v_fmac_f32 v242, v6, v150
    v_fmac_f32 v238, v14, v166
    v_fmac_f32 v236, v22, v118
    v_fmac_f32 v244, v30, v166
    v_fmac_f32 v242, v7, v151
    v_fmac_f32 v238, v15, v167
    v_fmac_f32 v236, v23, v119
    v_fmac_f32 v244, v31, v167
    v_mul_f32 v243, v32, v152
    v_fma_f32 v239, v40, v168, -v239
    v_fmac_f32 v237, v48, v120
    v_mul_f32 v245, v56, v168
    v_fmac_f32 v243, v33, v153
    v_fmac_f32 v239, v41, v169
    v_fmac_f32 v237, v49, v121
    v_fmac_f32 v245, v57, v169
    v_fmac_f32 v243, v34, v154
    v_fmac_f32 v239, v42, v170
    v_fmac_f32 v237, v50, v122
    v_fmac_f32 v245, v58, v170
    v_fmac_f32 v243, v35, v155
    v_fmac_f32 v239, v43, v171
    v_fmac_f32 v237, v51, v123
    v_fmac_f32 v245, v59, v171
    v_fmac_f32 v243, v36, v156
    v_fmac_f32 v239, v44, v172
    v_fmac_f32 v237, v52, v124
    v_fmac_f32 v245, v60, v172
    v_fmac_f32 v243, v37, v157
    v_fmac_f32 v239, v45, v173
    v_fmac_f32 v237, v53, v125
    v_fmac_f32 v245, v61, v173
    v_fmac_f32 v243, v38, v158
    v_fmac_f32 v239, v46, v174
    v_fmac_f32 v237, v54, v126
    v_fmac_f32 v245, v62, v174
    v_fmac_f32 v243, v39, v159
    v_fmac_f32 v239, v47, v175
    v_fmac_f32 v237, v55, v127
    v_fmac_f32 v245, v63, v175
    v_permlane32_swap_b32 v242, v243
    v_permlane32_swap_b32 v238, v239
    v_add_f32 v242, v242, v243
    v_add_f32 v238, v238, v239
    s_cmp_lg_u32 s27, 0
    s_cbranch_scc1 K2_fl1_41
    s_set_gpr_idx_on s28, gpr_idx(DST)
    s_nop 0
    v_cvt_pk_bf16_f32 v194, v234, v242
    s_set_gpr_idx_off
    s_branch K2_fld_42
K2_fl1_41:
    v_add_u32 v254, s28, v252
    v_cvt_pk_bf16_f32 v234, v234, v242
    ds_write_b16 v254, v234 offset:384
    ds_write_b16_d16_hi v254, v234 offset:768
K2_fld_42:
    s_setprio 2
    s_waitcnt lgkmcnt(0)
    v_mfma_f32_32x32x16_bf16 v[0:15], v[64:67], v[184:187], 0
    s_add_u32 m0, s34, 2048
    s_nop 0
    buffer_load_dwordx4 v224, s[4:7], s41 offen lds
    s_add_u32 m0, s34, 3072
    s_nop 0
    buffer_load_dwordx4 v225, s[4:7], s41 offen lds
    v_mfma_f32_32x32x16_bf16 v[16:31], v[68:71], v[184:187], 0
    s_waitcnt vmcnt(6)
    ds_read_b64_tr_b16 v[176:177], v246 offset:4096
    ds_read_b64_tr_b16 v[178:179], v246 offset:4608
    v_mfma_f32_32x32x16_bf16 v[32:47], v[64:67], v[188:191], 0
    ds_read_b64_tr_b16 v[180:181], v247 offset:4096
    ds_read_b64_tr_b16 v[182:183], v247 offset:4608
    v_mfma_f32_32x32x16_bf16 v[48:63], v[68:71], v[188:191], 0
    s_waitcnt lgkmcnt(0)
    v_mfma_f32_32x32x16_bf16 v[0:15], v[72:75], v[176:179], v[0:15]
    s_add_u32 m0, s34, 4096
    s_nop 0
    buffer_load_dwordx4 v226, s[4:7], s42 offen lds
    s_add_u32 m0, s34, 5120
    s_nop 0
    buffer_load_dwordx4 v227, s[4:7], s42 offen lds
    v_mfma_f32_32x32x16_bf16 v[16:31], v[76:79], v[176:179], v[16:31]
    s_waitcnt vmcnt(6)
    ds_read_b64_tr_b16 v[184:185], v246 offset:6144
    ds_read_b64_tr_b16 v[186:187], v246 offset:6656
    v_mfma_f32_32x32x16_bf16 v[32:47], v[72:75], v[180:183], v[32:47]
    ds_read_b64_tr_b16 v[188:189], v247 offset:6144
    ds_read_b64_tr_b16 v[190:191], v247 offset:6656
    v_mfma_f32_32x32x16_bf16 v[48:63], v[76:79], v[180:183], v[48:63]
    s_waitcnt lgkmcnt(0)
    v_mfma_f32_32x32x16_bf16 v[0:15], v[80:83], v[184:187], v[0:15]
    s_add_u32 m0, s34, 6144
    s_nop 0
    buffer_load_dwordx4 v228, s[4:7], s43 offen lds
    s_add_u32 m0, s34, 7168
    s_nop 0
    buffer_load_dwordx4 v229, s[4:7], s43 offen lds
    v_mfma_f32_32x32x16_bf16 v[16:31], v[84:87], v[184:187], v[16:31]
    s_waitcnt vmcnt(6)
    ds_read_b64_tr_b16 v[176:177], v246 offset:0
    ds_read_b64_tr_b16 v[178:179], v246 offset:512
    v_mfma_f32_32x32x16_bf16 v[32:47], v[80:83], v[188:191], v[32:47]
    ds_read_b64_tr_b16 v[180:181], v247 offset:0
    ds_read_b64_tr_b16 v[182:183], v247 offset:512
    v_mfma_f32_32x32x16_bf16 v[48:63], v[84:87], v[188:191], v[48:63]
    s_setprio 0
    v_mul_f32 v242, v0, v144
    v_fma_f32 v240, v8, v160, -v240
    s_nop 1
    v_fma_f32 v244, v16, v160, -v244
    s_nop 0
    v_fmac_f32 v236, v24, v112
    v_fmac_f32 v242, v1, v145
    v_fmac_f32 v240, v9, v161
    v_fmac_f32 v244, v17, v161
    v_fmac_f32 v236, v25, v113
    v_fmac_f32 v242, v2, v146
    v_fmac_f32 v240, v10, v162
    v_fmac_f32 v244, v18, v162
    v_fmac_f32 v236, v26, v114
    v_fmac_f32 v242, v3, v147
    v_fmac_f32 v240, v11, v163
    v_fmac_f32 v244, v19, v163
    v_fmac_f32 v236, v27, v115
    v_fmac_f32 v242, v4, v148
    v_fmac_f32 v240, v12, v164
    v_fmac_f32 v244, v20, v164
    v_fmac_f32 v236, v28, v116
    v_fmac_f32 v242, v5, v149
    v_fmac_f32 v240, v13, v165
    v_fmac_f32 v244, v21, v165
    v_fmac_f32 v236, v29, v117
    v_fmac_f32 v242, v6, v150
    v_fmac_f32 v240, v14, v166
    v_fmac_f32 v244, v22, v166
    v_fmac_f32 v236, v30, v118
    v_fmac_f32 v242, v7, v151
    v_fmac_f32 v240, v15, v167
    v_fmac_f32 v244, v23, v167
    v_fmac_f32 v236, v31, v119
    v_mul_f32 v243, v32, v152
    v_fma_f32 v241, v40, v168, -v241
    v_fma_f32 v245, v48, v168, -v245
    v_fmac_f32 v237, v56, v120
    v_fmac_f32 v243, v33, v153
    v_fmac_f32 v241, v41, v169
    v_fmac_f32 v245, v49, v169
    v_fmac_f32 v237, v57, v121
    v_fmac_f32 v243, v34, v154
    v_fmac_f32 v241, v42, v170
    v_fmac_f32 v245, v50, v170
    v_fmac_f32 v237, v58, v122
    v_fmac_f32 v243, v35, v155
    v_fmac_f32 v241, v43, v171
    v_fmac_f32 v245, v51, v171
    v_fmac_f32 v237, v59, v123
    v_fmac_f32 v243, v36, v156
    v_fmac_f32 v241, v44, v172
    v_fmac_f32 v245, v52, v172
    v_fmac_f32 v237, v60, v124
    v_fmac_f32 v243, v37, v157
    v_fmac_f32 v241, v45, v173
    v_fmac_f32 v245, v53, v173
    v_fmac_f32 v237, v61, v125
    v_fmac_f32 v243, v38, v158
    v_fmac_f32 v241, v46, v174
    v_fmac_f32 v245, v54, v174
    v_fmac_f32 v237, v62, v126
    v_fmac_f32 v243, v39, v159
    v_fmac_f32 v241, v47, v175
    v_fmac_f32 v245, v55, v175
    v_fmac_f32 v237, v63, v127
    v_permlane32_swap_b32 v242, v243
    s_nop 0
    v_permlane32_swap_b32 v236, v237
    v_permlane32_swap_b32 v240, v241
    v_permlane32_swap_b32 v244, v245
    v_add_f32 v242, v242, v243
    v_add_f32 v236, v236, v237
    v_add_f32 v240, -v240, -v241
    v_add_f32 v244, v244, v245
    s_cmp_lg_u32 s27, 0
    s_cbranch_scc1 K2_fl1_43
    s_set_gpr_idx_on s28, gpr_idx(DST)
    s_nop 0
    v_cvt_pk_bf16_f32 v195, v242, v236
    v_cvt_pk_bf16_f32 v196, v244, v240
    v_cvt_pk_bf16_f32 v197, v238, v238
    s_set_gpr_idx_off
    s_branch K2_fld_44
K2_fl1_43:
    v_add_u32 v254, s28, v252
    v_cvt_pk_bf16_f32 v242, v242, v236
    v_cvt_pk_bf16_f32 v244, v244, v240
    v_cvt_pk_bf16_f32 v238, v238, v238
    ds_write_b16 v254, v242 offset:1152
    ds_write_b16_d16_hi v254, v242 offset:128
    ds_write_b16 v254, v244 offset:512
    ds_write_b16_d16_hi v254, v244 offset:896
    ds_write_b16 v254, v238 offset:1280
K2_fld_44:
    s_branch K2_NEXT
K2_UNIT1:
    s_add_u32 s35, s35, 1
    s_lshl_b32 s45, s35, 3
    s_add_u32 s45, s45, s16
    s_cmp_lt_u32 s45, s18
    s_cbranch_scc1 K2_cl_46
    s_mov_b32 s35, 8
    s_mov_b32 s45, -1
    v_mov_b32 v231, 162048
    v_mov_b32 v232, 1
    s_mov_b64 exec, 1
    ds_add_rtn_u32 v230, v231, v232
    s_mov_b64 exec, -1
K2_cl_46:
    v_add_u32 v62, s25, v249
    v_add_u32 v63, s25, v250
    ds_read_b64_tr_b16 v[0:1], v62 offset:0
    ds_read_b64_tr_b16 v[2:3], v62 offset:128
    ds_read_b128 v[4:7], v63 offset:0
    ds_read_b128 v[8:11], v63 offset:16
    ds_read_b128 v[12:15], v63 offset:128
    ds_read_b128 v[16:19], v63 offset:144
    s_waitcnt lgkmcnt(4)
    v_lshlrev_b32 v20, 16, v0
    v_and_b32 v21, 0xffff0000, v0
    v_lshlrev_b32 v22, 16, v1
    v_and_b32 v23, 0xffff0000, v1
    v_lshlrev_b32 v24, 16, v2
    v_and_b32 v25, 0xffff0000, v2
    v_lshlrev_b32 v26, 16, v3
    v_and_b32 v27, 0xffff0000, v3
    s_waitcnt lgkmcnt(2)
    v_mul_f32 v4, v20, v4
    v_mul_f32 v5, v21, v5
    v_mul_f32 v6, v22, v6
    v_mul_f32 v7, v23, v7
    v_mul_f32 v8, v24, v8
    v_mul_f32 v9, v25, v9
    v_mul_f32 v10, v26, v10
    v_mul_f32 v11, v27, v11
    v_cvt_pk_bf16_f32 v64, v4, v5
    v_cvt_pk_bf16_f32 v65, v6, v7
    v_cvt_pk_bf16_f32 v66, v8, v9
    v_cvt_pk_bf16_f32 v67, v10, v11
    s_waitcnt lgkmcnt(0)
    v_mul_f32 v12, v20, v12
    v_mul_f32 v13, v21, v13
    v_mul_f32 v14, v22, v14
    v_mul_f32 v15, v23, v15
    v_mul_f32 v16, v24, v16
    v_mul_f32 v17, v25, v17
    v_mul_f32 v18, v26, v18
    v_mul_f32 v19, v27, v19
    v_cvt_pk_bf16_f32 v68, v12, v13
    v_cvt_pk_bf16_f32 v69, v14, v15
    v_cvt_pk_bf16_f32 v70, v16, v17
    v_cvt_pk_bf16_f32 v71, v18, v19
    s_mov_b32 s31, 0
    s_mul_i32 s32, s35, 6
    s_mov_b32 s33, 1
    s_cmp_lg_u32 s45, -1
    s_cbranch_scc1 K2_st_47
    s_cmp_lg_u32 s27, 0
    s_cbranch_scc1 K2_nd_48
    s_mov_b64 exec, 1
    ds_add_u32 v231, v232 offset:8
    s_mov_b64 exec, -1
K2_nd_48:
    s_waitcnt lgkmcnt(0)
    v_readfirstlane_b32 s45, v230
    s_mov_b32 s31, 1
    s_cmp_lt_u32 s45, s18
    s_cselect_b32 s33, 1, 0
    s_cselect_b32 s45, s45, 63
K2_st_47:
    v_readlane_b32 s46, v253, s45
    s_nop 0
    s_and_b32 s29, s46, 0x3ffff
    s_bfe_u32 s30, s46, 0x30012
    s_cmp_eq_u32 s31, 0
    s_cbranch_scc1 K2_p1_49
    s_lshr_b32 s32, s46, 21
    s_add_u32 s32, s32, s29
K2_p1_49:
    s_lshl_b32 s47, s30, 3
    s_sub_u32 s47, s47, 8
    s_lshr_b32 s48, 0x4050e4, s47
    s_lshr_b32 s49, 0xe4244400, s47
    s_lshl_b32 s50, s31, 7
    s_mov_b32 s40, s50
    v_add_u32 v230, s29, v251
    s_bfe_u32 s51, s48, 0x20002
    s_lshl_b32 s51, s51, 8
    s_add_u32 s41, s51, s50
    s_bfe_u32 s51, s49, 0x20002
    s_mul_i32 s51, s51, 800
    s_add_u32 s51, s51, s29
    v_add_u32 v231, s51, v251
    s_bfe_u32 s51, s48, 0x20004
    s_lshl_b32 s51, s51, 8
    s_add_u32 s42, s51, s50
    s_bfe_u32 s51, s49, 0x20004
    s_mul_i32 s51, s51, 800
    s_add_u32 s51, s51, s29
    v_add_u32 v232, s51, v251
    s_bfe_u32 s51, s48, 0x20006
    s_lshl_b32 s51, s51, 8
    s_add_u32 s43, s51, s50
    s_bfe_u32 s51, s49, 0x20006
    s_mul_i32 s51, s51, 800
    s_add_u32 s51, s51, s29
    v_add_u32 v233, s51, v251
    ds_read_b32 v230, v230
    ds_read_b32 v231, v231
    ds_read_b32 v232, v232
    ds_read_b32 v233, v233
    s_setprio 2
    s_waitcnt lgkmcnt(0)
    v_mfma_f32_32x32x16_bf16 v[0:15], v[64:67], v[176:179], 0
    v_mad_u32_u16 v222, v230, s44, v248
    v_mad_u32_u16 v223, v230, s44, v248 op_sel:[1,0,0,0]
    v_mad_u32_u16 v224, v231, s44, v248
    v_mad_u32_u16 v225, v231, s44, v248 op_sel:[1,0,0,0]
    v_mad_u32_u16 v226, v232, s44, v248
    v_mad_u32_u16 v227, v232, s44, v248 op_sel:[1,0,0,0]
    v_mad_u32_u16 v228, v233, s44, v248
    v_mad_u32_u16 v229, v233, s44, v248 op_sel:[1,0,0,0]
    s_add_u32 m0, s34, 0
    s_nop 0
    buffer_load_dwordx4 v222, s[4:7], s40 offen lds
    s_add_u32 m0, s34, 1024
    s_nop 0
    buffer_load_dwordx4 v223, s[4:7], s40 offen lds
    v_mfma_f32_32x32x16_bf16 v[16:31], v[68:71], v[176:179], 0
    s_waitcnt vmcnt(6)
    ds_read_b64_tr_b16 v[184:185], v246 offset:2048
    ds_read_b64_tr_b16 v[186:187], v246 offset:2560
    v_mfma_f32_32x32x16_bf16 v[32:47], v[64:67], v[180:183], 0
    ds_read_b64_tr_b16 v[188:189], v247 offset:2048
    ds_read_b64_tr_b16 v[190:191], v247 offset:2560
    v_mfma_f32_32x32x16_bf16 v[48:63], v[68:71], v[180:183], 0
    s_setprio 0
    v_mul_f32 v234, v0, v96
    v_mul_f32 v236, v8, v128
    s_nop 1
    v_mul_f32 v238, v16, v128
    s_nop 0
    v_mul_f32 v240, v24, v128
    v_fmac_f32 v234, v1, v97
    v_fmac_f32 v236, v9, v129
    v_fmac_f32 v238, v17, v129
    v_fmac_f32 v240, v25, v129
    v_fmac_f32 v234, v2, v98
    v_fmac_f32 v236, v10, v130
    v_fmac_f32 v238, v18, v130
    v_fmac_f32 v240, v26, v130
    v_fmac_f32 v234, v3, v99
    v_fmac_f32 v236, v11, v131
    v_fmac_f32 v238, v19, v131
    v_fmac_f32 v240, v27, v131
    v_fmac_f32 v234, v4, v100
    v_fmac_f32 v236, v12, v132
    v_fmac_f32 v238, v20, v132
    v_fmac_f32 v240, v28, v132
    v_fmac_f32 v234, v5, v101
    v_fmac_f32 v236, v13, v133
    v_fmac_f32 v238, v21, v133
    v_fmac_f32 v240, v29, v133
    v_fmac_f32 v234, v6, v102
    v_fmac_f32 v236, v14, v134
    v_fmac_f32 v238, v22, v134
    v_fmac_f32 v240, v30, v134
    v_fmac_f32 v234, v7, v103
    v_fmac_f32 v236, v15, v135
    v_fmac_f32 v238, v23, v135
    v_fmac_f32 v240, v31, v135
    v_mul_f32 v235, v32, v104
    v_mul_f32 v237, v40, v136
    v_mul_f32 v239, v48, v136
    v_mul_f32 v241, v56, v136
    v_fmac_f32 v235, v33, v105
    v_fmac_f32 v237, v41, v137
    v_fmac_f32 v239, v49, v137
    v_fmac_f32 v241, v57, v137
    v_fmac_f32 v235, v34, v106
    v_fmac_f32 v237, v42, v138
    v_fmac_f32 v239, v50, v138
    v_fmac_f32 v241, v58, v138
    v_fmac_f32 v235, v35, v107
    v_fmac_f32 v237, v43, v139
    v_fmac_f32 v239, v51, v139
    v_fmac_f32 v241, v59, v139
    v_fmac_f32 v235, v36, v108
    v_fmac_f32 v237, v44, v140
    v_fmac_f32 v239, v52, v140
    v_fmac_f32 v241, v60, v140
    v_fmac_f32 v235, v37, v109
    v_fmac_f32 v237, v45, v141
    v_fmac_f32 v239, v53, v141
    v_fmac_f32 v241, v61, v141
    v_fmac_f32 v235, v38, v110
    v_fmac_f32 v237, v46, v142
    v_fmac_f32 v239, v54, v142
    v_fmac_f32 v241, v62, v142
    v_fmac_f32 v235, v39, v111
    v_fmac_f32 v237, v47, v143
    v_fmac_f32 v239, v55, v143
    v_fmac_f32 v241, v63, v143
    v_permlane32_swap_b32 v234, v235
    v_permlane32_swap_b32 v236, v237
    v_permlane32_swap_b32 v238, v239
    v_permlane32_swap_b32 v240, v241
    v_add_f32 v234, v234, v235
    v_add_f32 v236, v236, v237
    v_add_f32 v238, v238, v239
    v_add_f32 v240, v240, v241
    s_cmp_lg_u32 s27, 0
    s_cbranch_scc1 K2_fl1_50
    s_set_gpr_idx_on s28, gpr_idx(DST)
    s_nop 0
    v_cvt_pk_bf16_f32 v192, v234, v236
    v_cvt_pk_bf16_f32 v193, v238, v240
    s_set_gpr_idx_off
    s_branch K2_fld_51
K2_fl1_50:
    v_add_u32 v254, s28, v252
    v_cvt_pk_bf16_f32 v234, v234, v236
    v_cvt_pk_bf16_f32 v238, v238, v240
    ds_write_b16 v254, v234 offset:0
    ds_write_b16_d16_hi v254, v234 offset:256
    ds_write_b16 v254, v238 offset:640
    ds_write_b16_d16_hi v254, v238 offset:1024
K2_fld_51:
    s_setprio 2
    s_waitcnt lgkmcnt(0)
    v_mfma_f32_32x32x16_bf16 v[0:15], v[64:67], v[184:187], 0
    s_add_u32 m0, s34, 2048
    s_nop 0
    buffer_load_dwordx4 v224, s[4:7], s41 offen lds
    s_add_u32 m0, s34, 3072
    s_nop 0
    buffer_load_dwordx4 v225, s[4:7], s41 offen lds
    v_mfma_f32_32x32x16_bf16 v[16:31], v[68:71], v[184:187], 0
    s_waitcnt vmcnt(6)
    ds_read_b64_tr_b16 v[176:177], v246 offset:4096
    ds_read_b64_tr_b16 v[178:179], v246 offset:4608
    v_mfma_f32_32x32x16_bf16 v[32:47], v[64:67], v[188:191], 0
    ds_read_b64_tr_b16 v[180:181], v247 offset:4096
    ds_read_b64_tr_b16 v[182:183], v247 offset:4608
    v_mfma_f32_32x32x16_bf16 v[48:63], v[68:71], v[188:191], 0
    s_setprio 0
    v_mul_f32 v234, v0, v144
    v_mul_f32 v236, v8, v112
    s_nop 1
    v_mul_f32 v238, v16, v160
    s_nop 0
    v_mul_f32 v240, v24, v160
    v_fmac_f32 v234, v1, v145
    v_fmac_f32 v236, v9, v113
    v_fmac_f32 v238, v17, v161
    v_fmac_f32 v240, v25, v161
    v_fmac_f32 v234, v2, v146
    v_fmac_f32 v236, v10, v114
    v_fmac_f32 v238, v18, v162
    v_fmac_f32 v240, v26, v162
    v_fmac_f32 v234, v3, v147
    v_fmac_f32 v236, v11, v115
    v_fmac_f32 v238, v19, v163
    v_fmac_f32 v240, v27, v163
    v_fmac_f32 v234, v4, v148
    v_fmac_f32 v236, v12, v116
    v_fmac_f32 v238, v20, v164
    v_fmac_f32 v240, v28, v164
    v_fmac_f32 v234, v5, v149
    v_fmac_f32 v236, v13, v117
    v_fmac_f32 v238, v21, v165
    v_fmac_f32 v240, v29, v165
    v_fmac_f32 v234, v6, v150
    v_fmac_f32 v236, v14, v118
    v_fmac_f32 v238, v22, v166
    v_fmac_f32 v240, v30, v166
    v_fmac_f32 v234, v7, v151
    v_fmac_f32 v236, v15, v119
    v_fmac_f32 v238, v23, v167
    v_fmac_f32 v240, v31, v167
    v_mul_f32 v235, v32, v152
    v_mul_f32 v237, v40, v120
    v_mul_f32 v239, v48, v168
    v_mul_f32 v241, v56, v168
    v_fmac_f32 v235, v33, v153
    v_fmac_f32 v237, v41, v121
    v_fmac_f32 v239, v49, v169
    v_fmac_f32 v241, v57, v169
    v_fmac_f32 v235, v34, v154
    v_fmac_f32 v237, v42, v122
    v_fmac_f32 v239, v50, v170
    v_fmac_f32 v241, v58, v170
    v_fmac_f32 v235, v35, v155
    v_fmac_f32 v237, v43, v123
    v_fmac_f32 v239, v51, v171
    v_fmac_f32 v241, v59, v171
    v_fmac_f32 v235, v36, v156
    v_fmac_f32 v237, v44, v124
    v_fmac_f32 v239, v52, v172
    v_fmac_f32 v241, v60, v172
    v_fmac_f32 v235, v37, v157
    v_fmac_f32 v237, v45, v125
    v_fmac_f32 v239, v53, v173
    v_fmac_f32 v241, v61, v173
    v_fmac_f32 v235, v38, v158
    v_fmac_f32 v237, v46, v126
    v_fmac_f32 v239, v54, v174
    v_fmac_f32 v241, v62, v174
    v_fmac_f32 v235, v39, v159
    v_fmac_f32 v237, v47, v127
    v_fmac_f32 v239, v55, v175
    v_fmac_f32 v241, v63, v175
    v_permlane32_swap_b32 v234, v235
    v_add_f32 v234, v234, v235
    s_setprio 2
    s_waitcnt lgkmcnt(0)
    v_mfma_f32_32x32x16_bf16 v[0:15], v[64:67], v[176:179], 0
    s_add_u32 m0, s34, 4096
    s_nop 0
    buffer_load_dwordx4 v226, s[4:7], s42 offen lds
    s_add_u32 m0, s34, 5120
    s_nop 0
    buffer_load_dwordx4 v227, s[4:7], s42 offen lds
    v_mfma_f32_32x32x16_bf16 v[16:31], v[68:71], v[176:179], 0
    s_waitcnt vmcnt(6)
    ds_read_b64_tr_b16 v[184:185], v246 offset:6144
    ds_read_b64_tr_b16 v[186:187], v246 offset:6656
    v_mfma_f32_32x32x16_bf16 v[32:47], v[64:67], v[180:183], 0
    ds_read_b64_tr_b16 v[188:189], v247 offset:6144
    ds_read_b64_tr_b16 v[190:191], v247 offset:6656
    v_mfma_f32_32x32x16_bf16 v[48:63], v[68:71], v[180:183], 0
    s_setprio 0
    v_mul_f32 v242, v0, v144
    v_fma_f32 v238, v8, v160, -v238
    s_nop 1
    v_fmac_f32 v236, v16, v112
    s_nop 0
    v_mul_f32 v244, v24, v160
    v_fmac_f32 v242, v1, v145
    v_fmac_f32 v238, v9, v161
    v_fmac_f32 v236, v17, v113
    v_fmac_f32 v244, v25, v161
    v_fmac_f32 v242, v2, v146
    v_fmac_f32 v238, v10, v162
    v_fmac_f32 v236, v18, v114
    v_fmac_f32 v244, v26, v162
    v_fmac_f32 v242, v3, v147
    v_fmac_f32 v238, v11, v163
    v_fmac_f32 v236, v19, v115
    v_fmac_f32 v244, v27, v163
    v_fmac_f32 v242, v4, v148
    v_fmac_f32 v238, v12, v164
    v_fmac_f32 v236, v20, v116
    v_fmac_f32 v244, v28, v164
    v_fmac_f32 v242, v5, v149
    v_fmac_f32 v238, v13, v165
    v_fmac_f32 v236, v21, v117
    v_fmac_f32 v244, v29, v165
    v_fmac_f32 v242, v6, v150
    v_fmac_f32 v238, v14, v166
    v_fmac_f32 v236, v22, v118
    v_fmac_f32 v244, v30, v166
    v_fmac_f32 v242, v7, v151
    v_fmac_f32 v238, v15, v167
    v_fmac_f32 v236, v23, v119
    v_fmac_f32 v244, v31, v167
    v_mul_f32 v243, v32, v152
    v_fma_f32 v239, v40, v168, -v239
    v_fmac_f32 v237, v48, v120
    v_mul_f32 v245, v56, v168
    v_fmac_f32 v243, v33, v153
    v_fmac_f32 v239, v41, v169
    v_fmac_f32 v237, v49, v121
    v_fmac_f32 v245, v57, v169
    v_fmac_f32 v243, v34, v154
    v_fmac_f32 v239, v42, v170
    v_fmac_f32 v237, v50, v122
    v_fmac_f32 v245, v58, v170
    v_fmac_f32 v243, v35, v155
    v_fmac_f32 v239, v43, v171
    v_fmac_f32 v237, v51, v123
    v_fmac_f32 v245, v59, v171
    v_fmac_f32 v243, v36, v156
    v_fmac_f32 v239, v44, v172
    v_fmac_f32 v237, v52, v124
    v_fmac_f32 v245, v60, v172
    v_fmac_f32 v243, v37, v157
    v_fmac_f32 v239, v45, v173
    v_fmac_f32 v237, v53, v125
    v_fmac_f32 v245, v61, v173
    v_fmac_f32 v243, v38, v158
    v_fmac_f32 v239, v46, v174
    v_fmac_f32 v237, v54, v126
    v_fmac_f32 v245, v62, v174
    v_fmac_f32 v243, v39, v159
    v_fmac_f32 v239, v47, v175
    v_fmac_f32 v237, v55, v127
    v_fmac_f32 v245, v63, v175
    v_permlane32_swap_b32 v242, v243
    v_permlane32_swap_b32 v238, v239
    v_add_f32 v242, v242, v243
    v_add_f32 v238, v238, v239
    s_cmp_lg_u32 s27, 0
    s_cbranch_scc1 K2_fl1_52
    s_set_gpr_idx_on s28, gpr_idx(DST)
    s_nop 0
    v_cvt_pk_bf16_f32 v194, v234, v242
    s_set_gpr_idx_off
    s_branch K2_fld_53
K2_fl1_52:
    v_add_u32 v254, s28, v252
    v_cvt_pk_bf16_f32 v234, v234, v242
    ds_write_b16 v254, v234 offset:384
    ds_write_b16_d16_hi v254, v234 offset:768
K2_fld_53:
    s_setprio 2
    s_waitcnt lgkmcnt(0)
    v_mfma_f32_32x32x16_bf16 v[0:15], v[64:67], v[184:187], 0
    s_add_u32 m0, s34, 6144
    s_nop 0
    buffer_load_dwordx4 v228, s[4:7], s43 offen lds
    s_add_u32 m0, s34, 7168
    s_nop 0
    buffer_load_dwordx4 v229, s[4:7], s43 offen lds
    v_mfma_f32_32x32x16_bf16 v[16:31], v[68:71], v[184:187], 0
    s_waitcnt vmcnt(6)
    ds_read_b64_tr_b16 v[176:177], v246 offset:0
    ds_read_b64_tr_b16 v[178:179], v246 offset:512
    v_mfma_f32_32x32x16_bf16 v[32:47], v[64:67], v[188:191], 0
    ds_read_b64_tr_b16 v[180:181], v247 offset:0
    ds_read_b64_tr_b16 v[182:183], v247 offset:512
    v_mfma_f32_32x32x16_bf16 v[48:63], v[68:71], v[188:191], 0
    s_setprio 0
    v_mul_f32 v242, v0, v144
    v_fma_f32 v240, v8, v160, -v240
    s_nop 1
    v_fma_f32 v244, v16, v160, -v244
    v_fmac_f32 v236, v24, v112
    v_fmac_f32 v242, v1, v145
    v_fmac_f32 v240, v9, v161
    v_fmac_f32 v244, v17, v161
    v_fmac_f32 v236, v25, v113
    v_fmac_f32 v242, v2, v146
    v_fmac_f32 v240, v10, v162
    v_fmac_f32 v244, v18, v162
    v_fmac_f32 v236, v26, v114
    v_fmac_f32 v242, v3, v147
    v_fmac_f32 v240, v11, v163
    v_fmac_f32 v244, v19, v163
    v_fmac_f32 v236, v27, v115
    v_fmac_f32 v242, v4, v148
    v_fmac_f32 v240, v12, v164
    v_fmac_f32 v244, v20, v164
    v_fmac_f32 v236, v28, v116
    v_fmac_f32 v242, v5, v149
    v_fmac_f32 v240, v13, v165
    v_fmac_f32 v244, v21, v165
    v_fmac_f32 v236, v29, v117
    v_fmac_f32 v242, v6, v150
    v_fmac_f32 v240, v14, v166
    v_fmac_f32 v244, v22, v166
    v_fmac_f32 v236, v30, v118
    v_fmac_f32 v242, v7, v151
    v_fmac_f32 v240, v15, v167
    v_fmac_f32 v244, v23, v167
    v_fmac_f32 v236, v31, v119
    v_mul_f32 v243, v32, v152
    v_fma_f32 v241, v40, v168, -v241
    v_fma_f32 v245, v48, v168, -v245
    v_fmac_f32 v237, v56, v120
    v_fmac_f32 v243, v33, v153
    v_fmac_f32 v241, v41, v169
    v_fmac_f32 v245, v49, v169
    v_fmac_f32 v237, v57, v121
    v_fmac_f32 v243, v34, v154
    v_fmac_f32 v241, v42, v170
    v_fmac_f32 v245, v50, v170
    v_fmac_f32 v237, v58, v122
    v_fmac_f32 v243, v35, v155
    v_fmac_f32 v241, v43, v171
    v_fmac_f32 v245, v51, v171
    v_fmac_f32 v237, v59, v123
    v_fmac_f32 v243, v36, v156
    v_fmac_f32 v241, v44, v172
    v_fmac_f32 v245, v52, v172
    v_fmac_f32 v237, v60, v124
    v_fmac_f32 v243, v37, v157
    v_fmac_f32 v241, v45, v173
    v_fmac_f32 v245, v53, v173
    v_fmac_f32 v237, v61, v125
    v_fmac_f32 v243, v38, v158
    v_fmac_f32 v241, v46, v174
    v_fmac_f32 v245, v54, v174
    v_fmac_f32 v237, v62, v126
    v_fmac_f32 v243, v39, v159
    v_fmac_f32 v241, v47, v175
    v_fmac_f32 v245, v55, v175
    v_fmac_f32 v237, v63, v127
    v_permlane32_swap_b32 v242, v243
    s_nop 0
    v_permlane32_swap_b32 v236, v237
    v_permlane32_swap_b32 v240, v241
    v_permlane32_swap_b32 v244, v245
    v_add_f32 v242, v242, v243
    v_add_f32 v236, v236, v237
    v_add_f32 v240, -v240, -v241
    v_add_f32 v244, v244, v245
    s_cmp_lg_u32 s27, 0
    s_cbranch_scc1 K2_fl1_54
    s_set_gpr_idx_on s28, gpr_idx(DST)
    s_nop 0
    v_cvt_pk_bf16_f32 v195, v242, v236
    v_cvt_pk_bf16_f32 v196, v244, v240
    v_cvt_pk_bf16_f32 v197, v238, v238
    s_set_gpr_idx_off
    s_branch K2_fld_55
K2_fl1_54:
    v_add_u32 v254, s28, v252
    v_cvt_pk_bf16_f32 v242, v242, v236
    v_cvt_pk_bf16_f32 v244, v244, v240
    v_cvt_pk_bf16_f32 v238, v238, v238
    ds_write_b16 v254, v242 offset:1152
    ds_write_b16_d16_hi v254, v242 offset:128
    ds_write_b16 v254, v244 offset:512
    ds_write_b16_d16_hi v254, v244 offset:896
    ds_write_b16 v254, v238 offset:1280
K2_fld_55:
    s_branch K2_NEXT
K2_TAIL:
    v_lshlrev_b32 v0, 3, v252
    s_mul_i32 s45, s16, 20480
    s_add_u32 s45, s45, 15990784
    s_waitcnt vmcnt(0) lgkmcnt(0)
    buffer_load_dwordx4 v[96:99], v0, s[8:11], s45 offen offset:0
    buffer_load_dwordx4 v[100:103], v0, s[8:11], s45 offen offset:1024
    buffer_load_dwordx4 v[104:107], v0, s[8:11], s45 offen offset:2048
    buffer_load_dwordx4 v[108:111], v0, s[8:11], s45 offen offset:3072
    s_add_u32 s45, s45, 4096
    buffer_load_dwordx4 v[112:115], v0, s[8:11], s45 offen offset:0
    buffer_load_dwordx4 v[116:119], v0, s[8:11], s45 offen offset:1024
    buffer_load_dwordx4 v[120:123], v0, s[8:11], s45 offen offset:2048
    buffer_load_dwordx4 v[124:127], v0, s[8:11], s45 offen offset:3072
    s_add_u32 s45, s45, 4096
    buffer_load_dwordx4 v[128:131], v0, s[8:11], s45 offen offset:0
    buffer_load_dwordx4 v[132:135], v0, s[8:11], s45 offen offset:1024
    buffer_load_dwordx4 v[136:139], v0, s[8:11], s45 offen offset:2048
    buffer_load_dwordx4 v[140:143], v0, s[8:11], s45 offen offset:3072
    s_add_u32 s45, s45, 4096
    buffer_load_dwordx4 v[144:147], v0, s[8:11], s45 offen offset:0
    buffer_load_dwordx4 v[148:151], v0, s[8:11], s45 offen offset:1024
    buffer_load_dwordx4 v[152:155], v0, s[8:11], s45 offen offset:2048
    buffer_load_dwordx4 v[156:159], v0, s[8:11], s45 offen offset:3072
    s_add_u32 s45, s45, 4096
    buffer_load_dwordx4 v[160:163], v0, s[8:11], s45 offen offset:0
    buffer_load_dwordx4 v[164:167], v0, s[8:11], s45 offen offset:1024
    buffer_load_dwordx4 v[168:171], v0, s[8:11], s45 offen offset:2048
    buffer_load_dwordx4 v[172:175], v0, s[8:11], s45 offen offset:3072
    s_lshl_b32 s46, s16, 5
    s_add_u32 s46, s46, s34
    v_add_u32 v1, s46, v252
    ds_write_b16 v1, v192 offset:0
    ds_write_b16_d16_hi v1, v192 offset:256
    ds_write_b16 v1, v193 offset:640
    ds_write_b16_d16_hi v1, v193 offset:1024
    ds_write_b16 v1, v194 offset:384
    ds_write_b16_d16_hi v1, v194 offset:768
    ds_write_b16 v1, v195 offset:1152
    ds_write_b16_d16_hi v1, v195 offset:128
    ds_write_b16 v1, v196 offset:512
    ds_write_b16_d16_hi v1, v196 offset:896
    ds_write_b16 v1, v197 offset:1280
    s_waitcnt lgkmcnt(4)
    ds_write_b16 v1, v198 offset:1536
    ds_write_b16_d16_hi v1, v198 offset:1792
    ds_write_b16 v1, v199 offset:2176
    ds_write_b16_d16_hi v1, v199 offset:2560
    ds_write_b16 v1, v200 offset:1920
    ds_write_b16_d16_hi v1, v200 offset:2304
    ds_write_b16 v1, v201 offset:2688
    ds_write_b16_d16_hi v1, v201 offset:1664
    ds_write_b16 v1, v202 offset:2048
    ds_write_b16_d16_hi v1, v202 offset:2432
    ds_write_b16 v1, v203 offset:2816
    s_waitcnt lgkmcnt(4)
    ds_write_b16 v1, v204 offset:3072
    ds_write_b16_d16_hi v1, v204 offset:3328
    ds_write_b16 v1, v205 offset:3712
    ds_write_b16_d16_hi v1, v205 offset:4096
    ds_write_b16 v1, v206 offset:3456
    ds_write_b16_d16_hi v1, v206 offset:3840
    ds_write_b16 v1, v207 offset:4224
    ds_write_b16_d16_hi v1, v207 offset:3200
    ds_write_b16 v1, v208 offset:3584
    ds_write_b16_d16_hi v1, v208 offset:3968
    ds_write_b16 v1, v209 offset:4352
    s_waitcnt lgkmcnt(4)
    ds_write_b16 v1, v210 offset:4608
    ds_write_b16_d16_hi v1, v210 offset:4864
    ds_write_b16 v1, v211 offset:5248
    ds_write_b16_d16_hi v1, v211 offset:5632
    ds_write_b16 v1, v212 offset:4992
    ds_write_b16_d16_hi v1, v212 offset:5376
    ds_write_b16 v1, v213 offset:5760
    ds_write_b16_d16_hi v1, v213 offset:4736
    ds_write_b16 v1, v214 offset:5120
    ds_write_b16_d16_hi v1, v214 offset:5504
    ds_write_b16 v1, v215 offset:5888
    s_waitcnt lgkmcnt(4)
    ds_write_b16 v1, v216 offset:6144
    ds_write_b16_d16_hi v1, v216 offset:6400
    ds_write_b16 v1, v217 offset:6784
    ds_write_b16_d16_hi v1, v217 offset:7168
    ds_write_b16 v1, v218 offset:6528
    ds_write_b16_d16_hi v1, v218 offset:6912
    ds_write_b16 v1, v219 offset:7296
    ds_write_b16_d16_hi v1, v219 offset:6272
    ds_write_b16 v1, v220 offset:6656
    ds_write_b16_d16_hi v1, v220 offset:7040
    ds_write_b16 v1, v221 offset:7424
    s_waitcnt lgkmcnt(4)
    v_lshrrev_b32 v2, 1, v252
    v_and_b32 v3, 15, v2
    v_lshrrev_b32 v4, 4, v2
    v_lshlrev_b32 v5, 4, v4
    v_add_u32 v6, 0, v3
    v_cmp_gt_u32 vcc, s18, v6
    s_nop 1
    v_cndmask_b32 v6, 0, v6, vcc
    v_lshlrev_b32 v7, 2, v6
    ds_bpermute_b32 v225, v7, v253
    v_and_b32 v7, 7, v6
    v_mul_u32_u24 v7, 8224, v7
    v_lshrrev_b32 v6, 3, v6
    v_mul_u32_u24 v6, 1536, v6
    v_add3_u32 v222, v6, v7, v5
    v_add_u32 v6, 16, v3
    v_cmp_gt_u32 vcc, s18, v6
    s_nop 1
    v_cndmask_b32 v6, 0, v6, vcc
    v_lshlrev_b32 v7, 2, v6
    ds_bpermute_b32 v226, v7, v253
    v_and_b32 v7, 7, v6
    v_mul_u32_u24 v7, 8224, v7
    v_lshrrev_b32 v6, 3, v6
    v_mul_u32_u24 v6, 1536, v6
    v_add3_u32 v223, v6, v7, v5
    v_add_u32 v6, 32, v3
    v_cmp_gt_u32 vcc, s18, v6
    s_nop 1
    v_cndmask_b32 v6, 0, v6, vcc
    v_lshlrev_b32 v7, 2, v6
    ds_bpermute_b32 v227, v7, v253
    v_and_b32 v7, 7, v6
    v_mul_u32_u24 v7, 8224, v7
    v_lshrrev_b32 v6, 3, v6
    v_mul_u32_u24 v6, 1536, v6
    v_add3_u32 v224, v6, v7, v5
    s_waitcnt lgkmcnt(0)
    v_lshrrev_b32 v6, 21, v225
    v_and_b32 v7, 0x3ffff, v225
    v_add3_u32 v225, v6, v7, v5
    v_lshrrev_b32 v6, 21, v226
    v_and_b32 v7, 0x3ffff, v226
    v_add3_u32 v226, v6, v7, v5
    v_lshrrev_b32 v6, 21, v227
    v_and_b32 v7, 0x3ffff, v227
    v_add3_u32 v227, v6, v7, v5
    s_lshl_b32 s47, s64, 9
    s_lshl_b32 s48, s16, 6
    s_add_u32 s47, s47, s48
    s_mul_i32 s47, s47, 192
    s_add_u32 s47, s47, 18874368
    v_mul_u32_u24 v228, 96, v252
    s_cmp_eq_u32 s24, 0
    s_cbranch_scc1 K2_ACCLD
    v_mov_b32 v0, 0
    v_mov_b32 v1, 0
    v_mov_b32 v2, 0
    v_mov_b32 v3, 0
    v_mov_b32 v4, 0
    v_mov_b32 v5, 0
    v_mov_b32 v6, 0
    v_mov_b32 v7, 0
    v_mov_b32 v8, 0
    v_mov_b32 v9, 0
    v_mov_b32 v10, 0
    v_mov_b32 v11, 0
    v_mov_b32 v12, 0
    v_mov_b32 v13, 0
    v_mov_b32 v14, 0
    v_mov_b32 v15, 0
    v_mov_b32 v16, 0
    v_mov_b32 v17, 0
    v_mov_b32 v18, 0
    v_mov_b32 v19, 0
    v_mov_b32 v20, 0
    v_mov_b32 v21, 0
    v_mov_b32 v22, 0
    v_mov_b32 v23, 0
    v_mov_b32 v24, 0
    v_mov_b32 v25, 0
    v_mov_b32 v26, 0
    v_mov_b32 v27, 0
    v_mov_b32 v28, 0
    v_mov_b32 v29, 0
    v_mov_b32 v30, 0
    v_mov_b32 v31, 0
    v_mov_b32 v32, 0
    v_mov_b32 v33, 0
    v_mov_b32 v34, 0
    v_mov_b32 v35, 0
    v_mov_b32 v36, 0
    v_mov_b32 v37, 0
    v_mov_b32 v38, 0
    v_mov_b32 v39, 0
    v_mov_b32 v40, 0
    v_mov_b32 v41, 0
    v_mov_b32 v42, 0
    v_mov_b32 v43, 0
    v_mov_b32 v44, 0
    v_mov_b32 v45, 0
    v_mov_b32 v46, 0
    v_mov_b32 v47, 0
    s_branch K2_ACCOK
K2_ACCLD:
    buffer_load_dwordx4 v[0:3], v228, s[8:11], s47 offen offset:0
    buffer_load_dwordx4 v[4:7], v228, s[8:11], s47 offen offset:16
    buffer_load_dwordx4 v[8:11], v228, s[8:11], s47 offen offset:32
    buffer_load_dwordx4 v[12:15], v228, s[8:11], s47 offen offset:48
    buffer_load_dwordx4 v[16:19], v228, s[8:11], s47 offen offset:64
    buffer_load_dwordx4 v[20:23], v228, s[8:11], s47 offen offset:80
    buffer_load_dwordx4 v[24:27], v228, s[8:11], s47 offen offset:96
    buffer_load_dwordx4 v[28:31], v228, s[8:11], s47 offen offset:112
    buffer_load_dwordx4 v[32:35], v228, s[8:11], s47 offen offset:128
    buffer_load_dwordx4 v[36:39], v228, s[8:11], s47 offen offset:144
    buffer_load_dwordx4 v[40:43], v228, s[8:11], s47 offen offset:160
    buffer_load_dwordx4 v[44:47], v228, s[8:11], s47 offen offset:176
K2_ACCOK:
    s_waitcnt vmcnt(0)
    s_barrier
    ds_read_b128 v[48:51], v222 offset:0
    ds_read_b128 v[52:55], v222 offset:64
    ds_read_b128 v[56:59], v222 offset:128
    ds_read_b128 v[60:63], v222 offset:192
    ds_read_b128 v[64:67], v225 offset:0
    ds_read_b128 v[68:71], v225 offset:64
    ds_read_b128 v[72:75], v225 offset:128
    ds_read_b128 v[76:79], v225 offset:192
    ds_read_b128 v[80:83], v222 offset:256
    ds_read_b128 v[84:87], v222 offset:640
    ds_read_b128 v[88:91], v222 offset:1024
    s_waitcnt lgkmcnt(10)
    v_mfma_f32_16x16x32_bf16 v[0:3], v[96:99], v[48:51], v[0:3]
    ds_read_b128 v[92:95], v222 offset:320
    s_waitcnt lgkmcnt(10)
    v_mfma_f32_16x16x32_bf16 v[0:3], v[100:103], v[52:55], v[0:3]
    ds_read_b128 v[48:51], v222 offset:704
    s_waitcnt lgkmcnt(10)
    v_mfma_f32_16x16x32_bf16 v[0:3], v[104:107], v[56:59], v[0:3]
    ds_read_b128 v[52:55], v222 offset:1088
    s_waitcnt lgkmcnt(10)
    v_mfma_f32_16x16x32_bf16 v[0:3], v[108:111], v[60:63], v[0:3]
    ds_read_b128 v[56:59], v222 offset:384
    s_waitcnt lgkmcnt(10)
    v_mfma_f32_16x16x32_bf16 v[0:3], v[112:115], v[64:67], v[0:3]
    ds_read_b128 v[60:63], v222 offset:768
    s_waitcnt lgkmcnt(10)
    v_mfma_f32_16x16x32_bf16 v[0:3], v[116:119], v[68:71], v[0:3]
    ds_read_b128 v[64:67], v222 offset:1152
    s_waitcnt lgkmcnt(10)
    v_mfma_f32_16x16x32_bf16 v[0:3], v[120:123], v[72:75], v[0:3]
    ds_read_b128 v[68:71], v222 offset:448
    s_waitcnt lgkmcnt(10)
    v_mfma_f32_16x16x32_bf16 v[0:3], v[124:127], v[76:79], v[0:3]
    ds_read_b128 v[72:75], v222 offset:832
    s_waitcnt lgkmcnt(10)
    v_mfma_f32_16x16x32_bf16 v[4:7], v[128:131], v[80:83], v[4:7]
    ds_read_b128 v[76:79], v222 offset:1216
    s_waitcnt lgkmcnt(10)
    v_mfma_f32_16x16x32_bf16 v[8:11], v[128:131], v[84:87], v[8:11]
    ds_read_b128 v[80:83], v222 offset:512
    s_waitcnt lgkmcnt(10)
    v_mfma_f32_16x16x32_bf16 v[12:15], v[128:131], v[88:91], v[12:15]
    ds_read_b128 v[84:87], v222 offset:896
    s_waitcnt lgkmcnt(10)
    v_mfma_f32_16x16x32_bf16 v[4:7], v[132:135], v[92:95], v[4:7]
    ds_read_b128 v[88:91], v222 offset:1280
    s_waitcnt lgkmcnt(10)
    v_mfma_f32_16x16x32_bf16 v[8:11], v[132:135], v[48:51], v[8:11]
    ds_read_b128 v[92:95], v222 offset:576
    s_waitcnt lgkmcnt(10)
    v_mfma_f32_16x16x32_bf16 v[12:15], v[132:135], v[52:55], v[12:15]
    ds_read_b128 v[48:51], v222 offset:960
    s_waitcnt lgkmcnt(10)
    v_mfma_f32_16x16x32_bf16 v[4:7], v[136:139], v[56:59], v[4:7]
    ds_read_b128 v[52:55], v222 offset:1344
    s_waitcnt lgkmcnt(10)
    v_mfma_f32_16x16x32_bf16 v[8:11], v[136:139], v[60:63], v[8:11]
    ds_read_b128 v[56:59], v225 offset:256
    s_waitcnt lgkmcnt(10)
    v_mfma_f32_16x16x32_bf16 v[12:15], v[136:139], v[64:67], v[12:15]
    ds_read_b128 v[60:63], v225 offset:640
    s_waitcnt lgkmcnt(10)
    v_mfma_f32_16x16x32_bf16 v[4:7], v[140:143], v[68:71], v[4:7]
    ds_read_b128 v[64:67], v225 offset:1024
    s_waitcnt lgkmcnt(10)
    v_mfma_f32_16x16x32_bf16 v[8:11], v[140:143], v[72:75], v[8:11]
    ds_read_b128 v[68:71], v225 offset:320
    s_waitcnt lgkmcnt(10)
    v_mfma_f32_16x16x32_bf16 v[12:15], v[140:143], v[76:79], v[12:15]
    ds_read_b128 v[72:75], v225 offset:704
    s_waitcnt lgkmcnt(10)
    v_mfma_f32_16x16x32_bf16 v[4:7], v[144:147], v[80:83], v[4:7]
    ds_read_b128 v[76:79], v225 offset:1088
    s_waitcnt lgkmcnt(10)
    v_mfma_f32_16x16x32_bf16 v[8:11], v[144:147], v[84:87], v[8:11]
    ds_read_b128 v[80:83], v225 offset:384
    s_waitcnt lgkmcnt(10)
    v_mfma_f32_16x16x32_bf16 v[12:15], v[144:147], v[88:91], v[12:15]
    ds_read_b128 v[84:87], v225 offset:768
    s_waitcnt lgkmcnt(10)
    v_mfma_f32_16x16x32_bf16 v[4:7], v[148:151], v[92:95], v[4:7]
    ds_read_b128 v[88:91], v225 offset:1152
    s_waitcnt lgkmcnt(10)
    v_mfma_f32_16x16x32_bf16 v[8:11], v[148:151], v[48:51], v[8:11]
    ds_read_b128 v[92:95], v225 offset:448
    s_waitcnt lgkmcnt(10)
    v_mfma_f32_16x16x32_bf16 v[12:15], v[148:151], v[52:55], v[12:15]
    ds_read_b128 v[48:51], v225 offset:832
    s_waitcnt lgkmcnt(10)
    v_mfma_f32_16x16x32_bf16 v[4:7], v[152:155], v[56:59], v[4:7]
    ds_read_b128 v[52:55], v225 offset:1216
    s_waitcnt lgkmcnt(10)
    v_mfma_f32_16x16x32_bf16 v[8:11], v[152:155], v[60:63], v[8:11]
    ds_read_b128 v[56:59], v225 offset:512
    s_waitcnt lgkmcnt(10)
    v_mfma_f32_16x16x32_bf16 v[12:15], v[152:155], v[64:67], v[12:15]
    ds_read_b128 v[60:63], v225 offset:896
    s_waitcnt lgkmcnt(10)
    v_mfma_f32_16x16x32_bf16 v[4:7], v[156:159], v[68:71], v[4:7]
    ds_read_b128 v[64:67], v225 offset:1280
    s_waitcnt lgkmcnt(10)
    v_mfma_f32_16x16x32_bf16 v[8:11], v[156:159], v[72:75], v[8:11]
    ds_read_b128 v[68:71], v225 offset:576
    s_waitcnt lgkmcnt(10)
    v_mfma_f32_16x16x32_bf16 v[12:15], v[156:159], v[76:79], v[12:15]
    ds_read_b128 v[72:75], v225 offset:960
    s_waitcnt lgkmcnt(10)
    v_mfma_f32_16x16x32_bf16 v[4:7], v[160:163], v[80:83], v[4:7]
    ds_read_b128 v[76:79], v225 offset:1344
    s_waitcnt lgkmcnt(10)
    v_mfma_f32_16x16x32_bf16 v[8:11], v[160:163], v[84:87], v[8:11]
    ds_read_b128 v[80:83], v223 offset:0
    s_waitcnt lgkmcnt(10)
    v_mfma_f32_16x16x32_bf16 v[12:15], v[160:163], v[88:91], v[12:15]
    ds_read_b128 v[84:87], v223 offset:64
    s_waitcnt lgkmcnt(10)
    v_mfma_f32_16x16x32_bf16 v[4:7], v[164:167], v[92:95], v[4:7]
    ds_read_b128 v[88:91], v223 offset:128
    s_waitcnt lgkmcnt(10)
    v_mfma_f32_16x16x32_bf16 v[8:11], v[164:167], v[48:51], v[8:11]
    ds_read_b128 v[92:95], v223 offset:192
    s_waitcnt lgkmcnt(10)
    v_mfma_f32_16x16x32_bf16 v[12:15], v[164:167], v[52:55], v[12:15]
    ds_read_b128 v[48:51], v226 offset:0
    s_waitcnt lgkmcnt(10)
    v_mfma_f32_16x16x32_bf16 v[4:7], v[168:171], v[56:59], v[4:7]
    ds_read_b128 v[52:55], v226 offset:64
    s_waitcnt lgkmcnt(10)
    v_mfma_f32_16x16x32_bf16 v[8:11], v[168:171], v[60:63], v[8:11]
    ds_read_b128 v[56:59], v226 offset:128
    s_waitcnt lgkmcnt(10)
    v_mfma_f32_16x16x32_bf16 v[12:15], v[168:171], v[64:67], v[12:15]
    ds_read_b128 v[60:63], v226 offset:192
    s_waitcnt lgkmcnt(10)
    v_mfma_f32_16x16x32_bf16 v[4:7], v[172:175], v[68:71], v[4:7]
    ds_read_b128 v[64:67], v223 offset:256
    s_waitcnt lgkmcnt(10)
    v_mfma_f32_16x16x32_bf16 v[8:11], v[172:175], v[72:75], v[8:11]
    ds_read_b128 v[68:71], v223 offset:640
    s_waitcnt lgkmcnt(10)
    v_mfma_f32_16x16x32_bf16 v[12:15], v[172:175], v[76:79], v[12:15]
    ds_read_b128 v[72:75], v223 offset:1024
    s_waitcnt lgkmcnt(10)
    v_mfma_f32_16x16x32_bf16 v[16:19], v[96:99], v[80:83], v[16:19]
    ds_read_b128 v[76:79], v223 offset:320
    s_waitcnt lgkmcnt(10)
    v_mfma_f32_16x16x32_bf16 v[16:19], v[100:103], v[84:87], v[16:19]
    ds_read_b128 v[80:83], v223 offset:704
    s_waitcnt lgkmcnt(10)
    v_mfma_f32_16x16x32_bf16 v[16:19], v[104:107], v[88:91], v[16:19]
    ds_read_b128 v[84:87], v223 offset:1088
    s_waitcnt lgkmcnt(10)
    v_mfma_f32_16x16x32_bf16 v[16:19], v[108:111], v[92:95], v[16:19]
    ds_read_b128 v[88:91], v223 offset:384
    s_waitcnt lgkmcnt(10)
    v_mfma_f32_16x16x32_bf16 v[16:19], v[112:115], v[48:51], v[16:19]
    ds_read_b128 v[92:95], v223 offset:768
    s_waitcnt lgkmcnt(10)
    v_mfma_f32_16x16x32_bf16 v[16:19], v[116:119], v[52:55], v[16:19]
    ds_read_b128 v[48:51], v223 offset:1152
    s_waitcnt lgkmcnt(10)
    v_mfma_f32_16x16x32_bf16 v[16:19], v[120:123], v[56:59], v[16:19]
    ds_read_b128 v[52:55], v223 offset:448
    s_waitcnt lgkmcnt(10)
    v_mfma_f32_16x16x32_bf16 v[16:19], v[124:127], v[60:63], v[16:19]
    ds_read_b128 v[56:59], v223 offset:832
    s_waitcnt lgkmcnt(10)
    v_mfma_f32_16x16x32_bf16 v[20:23], v[128:131], v[64:67], v[20:23]
    ds_read_b128 v[60:63], v223 offset:1216
    s_waitcnt lgkmcnt(10)
    v_mfma_f32_16x16x32_bf16 v[24:27], v[128:131], v[68:71], v[24:27]
    ds_read_b128 v[64:67], v223 offset:512
    s_waitcnt lgkmcnt(10)
    v_mfma_f32_16x16x32_bf16 v[28:31], v[128:131], v[72:75], v[28:31]
    ds_read_b128 v[68:71], v223 offset:896
    s_waitcnt lgkmcnt(10)
    v_mfma_f32_16x16x32_bf16 v[20:23], v[132:135], v[76:79], v[20:23]
    ds_read_b128 v[72:75], v223 offset:1280
    s_waitcnt lgkmcnt(10)
    v_mfma_f32_16x16x32_bf16 v[24:27], v[132:135], v[80:83], v[24:27]
    ds_read_b128 v[76:79], v223 offset:576
    s_waitcnt lgkmcnt(10)
    v_mfma_f32_16x16x32_bf16 v[28:31], v[132:135], v[84:87], v[28:31]
    ds_read_b128 v[80:83], v223 offset:960
    s_waitcnt lgkmcnt(10)
    v_mfma_f32_16x16x32_bf16 v[20:23], v[136:139], v[88:91], v[20:23]
    ds_read_b128 v[84:87], v223 offset:1344
    s_waitcnt lgkmcnt(10)
    v_mfma_f32_16x16x32_bf16 v[24:27], v[136:139], v[92:95], v[24:27]
    ds_read_b128 v[88:91], v226 offset:256
    s_waitcnt lgkmcnt(10)
    v_mfma_f32_16x16x32_bf16 v[28:31], v[136:139], v[48:51], v[28:31]
    ds_read_b128 v[92:95], v226 offset:640
    s_waitcnt lgkmcnt(10)
    v_mfma_f32_16x16x32_bf16 v[20:23], v[140:143], v[52:55], v[20:23]
    ds_read_b128 v[48:51], v226 offset:1024
    s_waitcnt lgkmcnt(10)
    v_mfma_f32_16x16x32_bf16 v[24:27], v[140:143], v[56:59], v[24:27]
    ds_read_b128 v[52:55], v226 offset:320
    s_waitcnt lgkmcnt(10)
    v_mfma_f32_16x16x32_bf16 v[28:31], v[140:143], v[60:63], v[28:31]
    ds_read_b128 v[56:59], v226 offset:704
    s_waitcnt lgkmcnt(10)
    v_mfma_f32_16x16x32_bf16 v[20:23], v[144:147], v[64:67], v[20:23]
    ds_read_b128 v[60:63], v226 offset:1088
    s_waitcnt lgkmcnt(10)
    v_mfma_f32_16x16x32_bf16 v[24:27], v[144:147], v[68:71], v[24:27]
    ds_read_b128 v[64:67], v226 offset:384
    s_waitcnt lgkmcnt(10)
    v_mfma_f32_16x16x32_bf16 v[28:31], v[144:147], v[72:75], v[28:31]
    ds_read_b128 v[68:71], v226 offset:768
    s_waitcnt lgkmcnt(10)
    v_mfma_f32_16x16x32_bf16 v[20:23], v[148:151], v[76:79], v[20:23]
    ds_read_b128 v[72:75], v226 offset:1152
    s_waitcnt lgkmcnt(10)
    v_mfma_f32_16x16x32_bf16 v[24:27], v[148:151], v[80:83], v[24:27]
    ds_read_b128 v[76:79], v226 offset:448
    s_waitcnt lgkmcnt(10)
    v_mfma_f32_16x16x32_bf16 v[28:31], v[148:151], v[84:87], v[28:31]
    ds_read_b128 v[80:83], v226 offset:832
    s_waitcnt lgkmcnt(10)
    v_mfma_f32_16x16x32_bf16 v[20:23], v[152:155], v[88:91], v[20:23]
    ds_read_b128 v[84:87], v226 offset:1216
    s_waitcnt lgkmcnt(10)
    v_mfma_f32_16x16x32_bf16 v[24:27], v[152:155], v[92:95], v[24:27]
    ds_read_b128 v[88:91], v226 offset:512
    s_waitcnt lgkmcnt(10)
    v_mfma_f32_16x16x32_bf16 v[28:31], v[152:155], v[48:51], v[28:31]
    ds_read_b128 v[92:95], v226 offset:896
    s_waitcnt lgkmcnt(10)
    v_mfma_f32_16x16x32_bf16 v[20:23], v[156:159], v[52:55], v[20:23]
    ds_read_b128 v[48:51], v226 offset:1280
    s_waitcnt lgkmcnt(10)
    v_mfma_f32_16x16x32_bf16 v[24:27], v[156:159], v[56:59], v[24:27]
    ds_read_b128 v[52:55], v226 offset:576
    s_waitcnt lgkmcnt(10)
    v_mfma_f32_16x16x32_bf16 v[28:31], v[156:159], v[60:63], v[28:31]
    ds_read_b128 v[56:59], v226 offset:960
    s_waitcnt lgkmcnt(10)
    v_mfma_f32_16x16x32_bf16 v[20:23], v[160:163], v[64:67], v[20:23]
    ds_read_b128 v[60:63], v226 offset:1344
    s_waitcnt lgkmcnt(10)
    v_mfma_f32_16x16x32_bf16 v[24:27], v[160:163], v[68:71], v[24:27]
    ds_read_b128 v[64:67], v224 offset:0
    s_waitcnt lgkmcnt(10)
    v_mfma_f32_16x16x32_bf16 v[28:31], v[160:163], v[72:75], v[28:31]
    ds_read_b128 v[68:71], v224 offset:64
    s_waitcnt lgkmcnt(10)
    v_mfma_f32_16x16x32_bf16 v[20:23], v[164:167], v[76:79], v[20:23]
    ds_read_b128 v[72:75], v224 offset:128
    s_waitcnt lgkmcnt(10)
    v_mfma_f32_16x16x32_bf16 v[24:27], v[164:167], v[80:83], v[24:27]
    ds_read_b128 v[76:79], v224 offset:192
    s_waitcnt lgkmcnt(10)
    v_mfma_f32_16x16x32_bf16 v[28:31], v[164:167], v[84:87], v[28:31]
    ds_read_b128 v[80:83], v227 offset:0
    s_waitcnt lgkmcnt(10)
    v_mfma_f32_16x16x32_bf16 v[20:23], v[168:171], v[88:91], v[20:23]
    ds_read_b128 v[84:87], v227 offset:64
    s_waitcnt lgkmcnt(10)
    v_mfma_f32_16x16x32_bf16 v[24:27], v[168:171], v[92:95], v[24:27]
    ds_read_b128 v[88:91], v227 offset:128
    s_waitcnt lgkmcnt(10)
    v_mfma_f32_16x16x32_bf16 v[28:31], v[168:171], v[48:51], v[28:31]
    ds_read_b128 v[92:95], v227 offset:192
    s_waitcnt lgkmcnt(10)
    v_mfma_f32_16x16x32_bf16 v[20:23], v[172:175], v[52:55], v[20:23]
    ds_read_b128 v[48:51], v224 offset:256
    s_waitcnt lgkmcnt(10)
    v_mfma_f32_16x16x32_bf16 v[24:27], v[172:175], v[56:59], v[24:27]
    ds_read_b128 v[52:55], v224 offset:640
    s_waitcnt lgkmcnt(10)
    v_mfma_f32_16x16x32_bf16 v[28:31], v[172:175], v[60:63], v[28:31]
    ds_read_b128 v[56:59], v224 offset:1024
    s_waitcnt lgkmcnt(10)
    v_mfma_f32_16x16x32_bf16 v[32:35], v[96:99], v[64:67], v[32:35]
    ds_read_b128 v[60:63], v224 offset:320
    s_waitcnt lgkmcnt(10)
    v_mfma_f32_16x16x32_bf16 v[32:35], v[100:103], v[68:71], v[32:35]
    ds_read_b128 v[64:67], v224 offset:704
    s_waitcnt lgkmcnt(10)
    v_mfma_f32_16x16x32_bf16 v[32:35], v[104:107], v[72:75], v[32:35]
    ds_read_b128 v[68:71], v224 offset:1088
    s_waitcnt lgkmcnt(10)
    v_mfma_f32_16x16x32_bf16 v[32:35], v[108:111], v[76:79], v[32:35]
    ds_read_b128 v[72:75], v224 offset:384
    s_waitcnt lgkmcnt(10)
    v_mfma_f32_16x16x32_bf16 v[32:35], v[112:115], v[80:83], v[32:35]
    ds_read_b128 v[76:79], v224 offset:768
    s_waitcnt lgkmcnt(10)
    v_mfma_f32_16x16x32_bf16 v[32:35], v[116:119], v[84:87], v[32:35]
    ds_read_b128 v[80:83], v224 offset:1152
    s_waitcnt lgkmcnt(10)
    v_mfma_f32_16x16x32_bf16 v[32:35], v[120:123], v[88:91], v[32:35]
    ds_read_b128 v[84:87], v224 offset:448
    s_waitcnt lgkmcnt(10)
    v_mfma_f32_16x16x32_bf16 v[32:35], v[124:127], v[92:95], v[32:35]
    ds_read_b128 v[88:91], v224 offset:832
    s_waitcnt lgkmcnt(10)
    v_mfma_f32_16x16x32_bf16 v[36:39], v[128:131], v[48:51], v[36:39]
    ds_read_b128 v[92:95], v224 offset:1216
    s_waitcnt lgkmcnt(10)
    v_mfma_f32_16x16x32_bf16 v[40:43], v[128:131], v[52:55], v[40:43]
    ds_read_b128 v[48:51], v224 offset:512
    s_waitcnt lgkmcnt(10)
    v_mfma_f32_16x16x32_bf16 v[44:47], v[128:131], v[56:59], v[44:47]
    ds_read_b128 v[52:55], v224 offset:896
    s_waitcnt lgkmcnt(10)
    v_mfma_f32_16x16x32_bf16 v[36:39], v[132:135], v[60:63], v[36:39]
    ds_read_b128 v[56:59], v224 offset:1280
    s_waitcnt lgkmcnt(10)
    v_mfma_f32_16x16x32_bf16 v[40:43], v[132:135], v[64:67], v[40:43]
    ds_read_b128 v[60:63], v224 offset:576
    s_waitcnt lgkmcnt(10)
    v_mfma_f32_16x16x32_bf16 v[44:47], v[132:135], v[68:71], v[44:47]
    ds_read_b128 v[64:67], v224 offset:960
    s_waitcnt lgkmcnt(10)
    v_mfma_f32_16x16x32_bf16 v[36:39], v[136:139], v[72:75], v[36:39]
    ds_read_b128 v[68:71], v224 offset:1344
    s_waitcnt lgkmcnt(10)
    v_mfma_f32_16x16x32_bf16 v[40:43], v[136:139], v[76:79], v[40:43]
    ds_read_b128 v[72:75], v227 offset:256
    s_waitcnt lgkmcnt(10)
    v_mfma_f32_16x16x32_bf16 v[44:47], v[136:139], v[80:83], v[44:47]
    ds_read_b128 v[76:79], v227 offset:640
    s_waitcnt lgkmcnt(10)
    v_mfma_f32_16x16x32_bf16 v[36:39], v[140:143], v[84:87], v[36:39]
    ds_read_b128 v[80:83], v227 offset:1024
    s_waitcnt lgkmcnt(10)
    v_mfma_f32_16x16x32_bf16 v[40:43], v[140:143], v[88:91], v[40:43]
    ds_read_b128 v[84:87], v227 offset:320
    s_waitcnt lgkmcnt(10)
    v_mfma_f32_16x16x32_bf16 v[44:47], v[140:143], v[92:95], v[44:47]
    ds_read_b128 v[88:91], v227 offset:704
    s_waitcnt lgkmcnt(10)
    v_mfma_f32_16x16x32_bf16 v[36:39], v[144:147], v[48:51], v[36:39]
    ds_read_b128 v[92:95], v227 offset:1088
    s_waitcnt lgkmcnt(10)
    v_mfma_f32_16x16x32_bf16 v[40:43], v[144:147], v[52:55], v[40:43]
    ds_read_b128 v[48:51], v227 offset:384
    s_waitcnt lgkmcnt(10)
    v_mfma_f32_16x16x32_bf16 v[44:47], v[144:147], v[56:59], v[44:47]
    ds_read_b128 v[52:55], v227 offset:768
    s_waitcnt lgkmcnt(10)
    v_mfma_f32_16x16x32_bf16 v[36:39], v[148:151], v[60:63], v[36:39]
    ds_read_b128 v[56:59], v227 offset:1152
    s_waitcnt lgkmcnt(10)
    v_mfma_f32_16x16x32_bf16 v[40:43], v[148:151], v[64:67], v[40:43]
    ds_read_b128 v[60:63], v227 offset:448
    s_waitcnt lgkmcnt(10)
    v_mfma_f32_16x16x32_bf16 v[44:47], v[148:151], v[68:71], v[44:47]
    ds_read_b128 v[64:67], v227 offset:832
    s_waitcnt lgkmcnt(10)
    v_mfma_f32_16x16x32_bf16 v[36:39], v[152:155], v[72:75], v[36:39]
    ds_read_b128 v[68:71], v227 offset:1216
    s_waitcnt lgkmcnt(10)
    v_mfma_f32_16x16x32_bf16 v[40:43], v[152:155], v[76:79], v[40:43]
    ds_read_b128 v[72:75], v227 offset:512
    s_waitcnt lgkmcnt(10)
    v_mfma_f32_16x16x32_bf16 v[44:47], v[152:155], v[80:83], v[44:47]
    ds_read_b128 v[76:79], v227 offset:896
    s_waitcnt lgkmcnt(10)
    v_mfma_f32_16x16x32_bf16 v[36:39], v[156:159], v[84:87], v[36:39]
    ds_read_b128 v[80:83], v227 offset:1280
    s_waitcnt lgkmcnt(10)
    v_mfma_f32_16x16x32_bf16 v[40:43], v[156:159], v[88:91], v[40:43]
    ds_read_b128 v[84:87], v227 offset:576
    s_waitcnt lgkmcnt(10)
    v_mfma_f32_16x16x32_bf16 v[44:47], v[156:159], v[92:95], v[44:47]
    ds_read_b128 v[88:91], v227 offset:960
    s_waitcnt lgkmcnt(10)
    v_mfma_f32_16x16x32_bf16 v[36:39], v[160:163], v[48:51], v[36:39]
    ds_read_b128 v[92:95], v227 offset:1344
    s_waitcnt lgkmcnt(10)
    v_mfma_f32_16x16x32_bf16 v[40:43], v[160:163], v[52:55], v[40:43]
    s_waitcnt lgkmcnt(9)
    v_mfma_f32_16x16x32_bf16 v[44:47], v[160:163], v[56:59], v[44:47]
    s_waitcnt lgkmcnt(8)
    v_mfma_f32_16x16x32_bf16 v[36:39], v[164:167], v[60:63], v[36:39]
    s_waitcnt lgkmcnt(7)
    v_mfma_f32_16x16x32_bf16 v[40:43], v[164:167], v[64:67], v[40:43]
    s_waitcnt lgkmcnt(6)
    v_mfma_f32_16x16x32_bf16 v[44:47], v[164:167], v[68:71], v[44:47]
    s_waitcnt lgkmcnt(5)
    v_mfma_f32_16x16x32_bf16 v[36:39], v[168:171], v[72:75], v[36:39]
    s_waitcnt lgkmcnt(4)
    v_mfma_f32_16x16x32_bf16 v[40:43], v[168:171], v[76:79], v[40:43]
    s_waitcnt lgkmcnt(3)
    v_mfma_f32_16x16x32_bf16 v[44:47], v[168:171], v[80:83], v[44:47]
    s_waitcnt lgkmcnt(2)
    v_mfma_f32_16x16x32_bf16 v[36:39], v[172:175], v[84:87], v[36:39]
    s_waitcnt lgkmcnt(1)
    v_mfma_f32_16x16x32_bf16 v[40:43], v[172:175], v[88:91], v[40:43]
    s_waitcnt lgkmcnt(0)
    v_mfma_f32_16x16x32_bf16 v[44:47], v[172:175], v[92:95], v[44:47]
    s_add_u32 s20, s20, 1
    s_cmp_lt_u32 s20, s21
    s_cbranch_scc1 K2_SPILL
    s_cmp_lg_u32 s23, 0
    s_cbranch_scc1 K2_SPILL
    s_mov_b32 s45, 0xbfb8aa3b
    v_mul_f32 v48, s45, v0
    v_mul_f32 v49, s45, v1
    v_mul_f32 v50, s45, v2
    v_mul_f32 v51, s45, v3
    v_exp_f32 v48, v48
    v_exp_f32 v49, v49
    v_exp_f32 v50, v50
    v_exp_f32 v51, v51
    v_add_f32 v48, 1.0, v48
    v_add_f32 v49, 1.0, v49
    v_add_f32 v50, 1.0, v50
    v_add_f32 v51, 1.0, v51
    v_rcp_f32 v48, v48
    v_rcp_f32 v49, v49
    v_rcp_f32 v50, v50
    v_rcp_f32 v51, v51
    v_cvt_pk_bf16_f32 v64, v0, v1
    v_cvt_pk_bf16_f32 v65, v2, v3
    v_mul_f32 v4, v4, v48
    v_mul_f32 v5, v5, v49
    v_mul_f32 v6, v6, v50
    v_mul_f32 v7, v7, v51
    v_cvt_pk_bf16_f32 v66, v4, v5
    v_cvt_pk_bf16_f32 v67, v6, v7
    v_mul_f32 v8, v8, v48
    v_mul_f32 v9, v9, v49
    v_mul_f32 v10, v10, v50
    v_mul_f32 v11, v11, v51
    v_cvt_pk_bf16_f32 v68, v8, v9
    v_cvt_pk_bf16_f32 v69, v10, v11
    v_mul_f32 v12, v12, v48
    v_mul_f32 v13, v13, v49
    v_mul_f32 v14, v14, v50
    v_mul_f32 v15, v15, v51
    v_cvt_pk_bf16_f32 v70, v12, v13
    v_cvt_pk_bf16_f32 v71, v14, v15
    v_mul_f32 v48, s45, v16
    v_mul_f32 v49, s45, v17
    v_mul_f32 v50, s45, v18
    v_mul_f32 v51, s45, v19
    v_exp_f32 v48, v48
    v_exp_f32 v49, v49
    v_exp_f32 v50, v50
    v_exp_f32 v51, v51
    v_add_f32 v48, 1.0, v48
    v_add_f32 v49, 1.0, v49
    v_add_f32 v50, 1.0, v50
    v_add_f32 v51, 1.0, v51
    v_rcp_f32 v48, v48
    v_rcp_f32 v49, v49
    v_rcp_f32 v50, v50
    v_rcp_f32 v51, v51
    v_cvt_pk_bf16_f32 v72, v16, v17
    v_cvt_pk_bf16_f32 v73, v18, v19
    v_mul_f32 v20, v20, v48
    v_mul_f32 v21, v21, v49
    v_mul_f32 v22, v22, v50
    v_mul_f32 v23, v23, v51
    v_cvt_pk_bf16_f32 v74, v20, v21
    v_cvt_pk_bf16_f32 v75, v22, v23
    v_mul_f32 v24, v24, v48
    v_mul_f32 v25, v25, v49
    v_mul_f32 v26, v26, v50
    v_mul_f32 v27, v27, v51
    v_cvt_pk_bf16_f32 v76, v24, v25
    v_cvt_pk_bf16_f32 v77, v26, v27
    v_mul_f32 v28, v28, v48
    v_mul_f32 v29, v29, v49
    v_mul_f32 v30, v30, v50
    v_mul_f32 v31, v31, v51
    v_cvt_pk_bf16_f32 v78, v28, v29
    v_cvt_pk_bf16_f32 v79, v30, v31
    v_mul_f32 v48, s45, v32
    v_mul_f32 v49, s45, v33
    v_mul_f32 v50, s45, v34
    v_mul_f32 v51, s45, v35
    v_exp_f32 v48, v48
    v_exp_f32 v49, v49
    v_exp_f32 v50, v50
    v_exp_f32 v51, v51
    v_add_f32 v48, 1.0, v48
    v_add_f32 v49, 1.0, v49
    v_add_f32 v50, 1.0, v50
    v_add_f32 v51, 1.0, v51
    v_rcp_f32 v48, v48
    v_rcp_f32 v49, v49
    v_rcp_f32 v50, v50
    v_rcp_f32 v51, v51
    v_cvt_pk_bf16_f32 v80, v32, v33
    v_cvt_pk_bf16_f32 v81, v34, v35
    v_mul_f32 v36, v36, v48
    v_mul_f32 v37, v37, v49
    v_mul_f32 v38, v38, v50
    v_mul_f32 v39, v39, v51
    v_cvt_pk_bf16_f32 v82, v36, v37
    v_cvt_pk_bf16_f32 v83, v38, v39
    v_mul_f32 v40, v40, v48
    v_mul_f32 v41, v41, v49
    v_mul_f32 v42, v42, v50
    v_mul_f32 v43, v43, v51
    v_cvt_pk_bf16_f32 v84, v40, v41
    v_cvt_pk_bf16_f32 v85, v42, v43
    v_mul_f32 v44, v44, v48
    v_mul_f32 v45, v45, v49
    v_mul_f32 v46, v46, v50
    v_mul_f32 v47, v47, v51
    v_cvt_pk_bf16_f32 v86, v44, v45
    v_cvt_pk_bf16_f32 v87, v46, v47
    v_lshrrev_b32 v2, 1, v252
    v_and_b32 v3, 15, v2
    v_lshrrev_b32 v4, 4, v2
    v_mul_u32_u24 v3, 1040, v3
    v_lshl_add_u32 v3, v4, 3, v3
    s_lshl_b32 s45, s16, 5
    v_add_u32 v3, s45, v3
    v_lshlrev_b32 v0, 3, v252
    s_mul_i32 s45, s16, 1040
    v_add_u32 v1, s45, v0
    s_barrier
    ds_write_b64 v3, v[64:65] offset:0
    ds_write_b64 v3, v[66:67] offset:256
    ds_write_b64 v3, v[68:69] offset:512
    ds_write_b64 v3, v[70:71] offset:768
    ds_write_b64 v3, v[72:73] offset:16640
    ds_write_b64 v3, v[74:75] offset:16896
    ds_write_b64 v3, v[76:77] offset:17152
    ds_write_b64 v3, v[78:79] offset:17408
    ds_write_b64 v3, v[80:81] offset:33280
    ds_write_b64 v3, v[82:83] offset:33536
    ds_write_b64 v3, v[84:85] offset:33792
    ds_write_b64 v3, v[86:87] offset:34048
    s_add_u32 s45, s17, s16
    s_lshl_b32 s45, s45, 10
    s_waitcnt lgkmcnt(0)
    s_barrier
    ds_read_b128 v[4:7], v1 offset:0
    ds_read_b128 v[8:11], v1 offset:8320
    ds_read_b128 v[12:15], v1 offset:16640
    ds_read_b128 v[16:19], v1 offset:24960
    ds_read_b128 v[20:23], v1 offset:33280
    s_waitcnt lgkmcnt(4)
    buffer_store_dwordx4 v[4:7], v0, s[12:15], s45 offen
    s_add_u32 s45, s45, 8192
    s_waitcnt lgkmcnt(3)
    buffer_store_dwordx4 v[8:11], v0, s[12:15], s45 offen
    s_add_u32 s45, s45, 8192
    s_waitcnt lgkmcnt(2)
    buffer_store_dwordx4 v[12:15], v0, s[12:15], s45 offen
    s_add_u32 s45, s45, 8192
    s_waitcnt lgkmcnt(1)
    buffer_store_dwordx4 v[16:19], v0, s[12:15], s45 offen
    s_add_u32 s45, s45, 8192
    s_add_u32 s46, s16, 32
    s_cmp_ge_u32 s46, s18
    s_cbranch_scc1 K2_END
    s_waitcnt lgkmcnt(0)
    buffer_store_dwordx4 v[20:23], v0, s[12:15], s45 offen
    s_add_u32 s45, s45, 8192
    s_branch K2_END
K2_SPILL:
    buffer_store_dwordx4 v[0:3], v228, s[8:11], s47 offen offset:0
    buffer_store_dwordx4 v[4:7], v228, s[8:11], s47 offen offset:16
    buffer_store_dwordx4 v[8:11], v228, s[8:11], s47 offen offset:32
    buffer_store_dwordx4 v[12:15], v228, s[8:11], s47 offen offset:48
    buffer_store_dwordx4 v[16:19], v228, s[8:11], s47 offen offset:64
    buffer_store_dwordx4 v[20:23], v228, s[8:11], s47 offen offset:80
    buffer_store_dwordx4 v[24:27], v228, s[8:11], s47 offen offset:96
    buffer_store_dwordx4 v[28:31], v228, s[8:11], s47 offen offset:112
    buffer_store_dwordx4 v[32:35], v228, s[8:11], s47 offen offset:128
    buffer_store_dwordx4 v[36:39], v228, s[8:11], s47 offen offset:144
    buffer_store_dwordx4 v[40:43], v228, s[8:11], s47 offen offset:160
    buffer_store_dwordx4 v[44:47], v228, s[8:11], s47 offen offset:176
    s_mov_b32 s24, 0
    s_waitcnt vmcnt(0)
    s_barrier
    s_cmp_lt_u32 s20, s21
    s_cbranch_scc1 K2_LOAD
    s_add_u32 s19, s19, 20
    s_branch K2_WINDOW
K2_END:
    s_endpgm
.section .rodata,"a"
.p2align 6
.amdhsa_kernel tp_sort_kernel
  .amdhsa_next_free_vgpr 64
  .amdhsa_next_free_sgpr 96
  .amdhsa_accum_offset 64
  .amdhsa_group_segment_fixed_size 0
  .amdhsa_kernarg_size 96
  .amdhsa_user_sgpr_count 2
  .amdhsa_user_sgpr_kernarg_segment_ptr 1
  .amdhsa_system_sgpr_workgroup_id_x 1
  .amdhsa_float_denorm_mode_32 3
.end_amdhsa_kernel
.p2align 6
.amdhsa_kernel tp_main_kernel
  .amdhsa_next_free_vgpr 256
  .amdhsa_next_free_sgpr 96
  .amdhsa_accum_offset 256
  .amdhsa_group_segment_fixed_size 0
  .amdhsa_kernarg_size 96
  .amdhsa_user_sgpr_count 2
  .amdhsa_user_sgpr_kernarg_segment_ptr 1
  .amdhsa_system_sgpr_workgroup_id_x 1
  .amdhsa_float_denorm_mode_32 3
.end_amdhsa_kernel
```

```asm
; @launch kernel=tp_sort_kernel grid=(256,1,1) block=(640,1,1) lds=62048
; @launch kernel=tp_main_kernel grid=(256,1,1) block=(512,1,1) lds=162112
.amdgcn_target "amdgcn-amd-amdhsa--gfx950"
.text
.globl tp_sort_kernel
.p2align 8
.type tp_sort_kernel,@function
tp_sort_kernel:
    s_cmp_ge_u32 s2, 256
    s_cbranch_scc1 K1_END
    s_load_dwordx4 s[36:39], s[0:1], 8
    s_load_dwordx4 s[40:43], s[0:1], 24
    s_load_dwordx4 s[44:47], s[0:1], 40
    s_load_dwordx2 s[48:49], s[0:1], 56
    s_load_dwordx2 s[50:51], s[0:1], 88
    v_lshrrev_b32 v1, 6, v0
    v_lshlrev_b32 v2, 2, v0
    v_readfirstlane_b32 s3, v1
    v_and_b32 v3, 1, v0
    v_mul_u32_u24 v4, 6, v0
    v_lshlrev_b32 v5, 1, v3
    v_sub_u32 v4, v4, v5
    v_lshlrev_b32 v5, 5, v0
    v_lshlrev_b32 v3, 4, v3
    v_mov_b32 v6, 0
    s_mul_i32 s52, s2, 5000
    s_mul_i32 s53, s2, 7500
    s_mul_i32 s54, s2, 40000
    s_add_u32 s55, s54, 20480
    s_waitcnt lgkmcnt(0)
    s_mov_b32 s4, s42
    s_and_b32 s5, s43, 0xffff
    s_mov_b32 s6, 1280000
    s_mov_b32 s7, 0x20000
    s_mov_b32 s8, s40
    s_and_b32 s9, s41, 0xffff
    s_mov_b32 s10, 1280000
    s_mov_b32 s11, 0x20000
    s_mov_b32 s12, s36
    s_and_b32 s13, s37, 0xffff
    s_mov_b32 s14, 1920000
    s_mov_b32 s15, 0x20000
    s_mov_b32 s16, s38
    s_and_b32 s17, s39, 0xffff
    s_mov_b32 s18, 10240000
    s_mov_b32 s19, 0x20000
    s_mov_b32 s20, s50
    s_and_b32 s21, s51, 0xffff
    s_mov_b32 s22, 50331648
    s_mov_b32 s23, 0x20000
    buffer_load_dword v10, v2, s[4:7], s52 offen
    buffer_load_dword v11, v2, s[4:7], s52 offen offset:2560
    buffer_load_dword v12, v2, s[8:11], s52 offen
    buffer_load_dword v13, v2, s[8:11], s52 offen offset:2560
    buffer_load_dwordx2 v[14:15], v4, s[12:15], s53 offen
    buffer_load_dwordx2 v[16:17], v4, s[12:15], s53 offen offset:3840
    buffer_load_dwordx4 v[20:23], v5, s[16:19], s54 offen
    buffer_load_dwordx4 v[24:27], v5, s[16:19], s54 offen offset:16
    buffer_load_dwordx4 v[32:35], v5, s[16:19], s55 offen
    buffer_load_dwordx4 v[36:39], v5, s[16:19], s55 offen offset:16
    v_cmp_gt_u32 vcc, 256, v0
    s_nop 0
    s_and_saveexec_b64 s[56:57], vcc
    s_cbranch_execz K1_NOCLR
    ds_write_b32 v2, v6
K1_NOCLR:
    s_mov_b64 exec, s[56:57]
    s_mov_b32 s58, 429497
    v_mov_b32 v7, 1
    s_waitcnt lgkmcnt(0)
    s_barrier
    s_waitcnt vmcnt(8)
    v_mul_u32_u24 v40, s58, v10
    v_mul_u32_u24 v41, s58, v11
    v_lshrrev_b32 v40, 24, v40
    v_lshrrev_b32 v41, 24, v41
    v_lshlrev_b32 v42, 2, v40
    v_lshlrev_b32 v43, 2, v41
    ds_add_rtn_u32 v44, v42, v7
    v_cmp_gt_u32 vcc, 610, v0
    s_nop 0
    s_mov_b64 s[60:61], vcc
    s_and_saveexec_b64 s[56:57], vcc
    ds_add_rtn_u32 v45, v43, v7
    s_mov_b64 exec, s[56:57]
    s_movk_i32 s59, 625
    v_mad_u32_u24 v46, v40, s59, 15
    v_mad_u32_u24 v47, v41, s59, 15
    v_lshrrev_b32 v46, 4, v46
    v_lshrrev_b32 v47, 4, v47
    v_sub_u32 v46, v10, v46
    v_sub_u32 v47, v11, v47
    v_and_b32 v8, 63, v0
    v_lshlrev_b32 v9, 4, v8
    s_waitcnt lgkmcnt(0)
    s_barrier
    ds_read_b128 v[48:51], v9
    s_waitcnt lgkmcnt(0)
    v_add_u32 v53, v48, v49
    v_add_u32 v54, v53, v50
    v_add_u32 v55, v54, v51
    v_mov_b32 v56, v55
    s_nop 1
    v_add_u32_dpp v56, v56, v56 row_shr:1 row_mask:0xf bank_mask:0xf bound_ctrl:0
    s_nop 1
    v_add_u32_dpp v56, v56, v56 row_shr:2 row_mask:0xf bank_mask:0xf bound_ctrl:0
    s_nop 1
    v_add_u32_dpp v56, v56, v56 row_shr:4 row_mask:0xf bank_mask:0xf bound_ctrl:0
    s_nop 1
    v_add_u32_dpp v56, v56, v56 row_shr:8 row_mask:0xf bank_mask:0xf bound_ctrl:0
    s_nop 1
    v_add_u32_dpp v56, v56, v56 row_bcast:15 row_mask:0xa bank_mask:0xf
    s_nop 1
    v_add_u32_dpp v56, v56, v56 row_bcast:31 row_mask:0xc bank_mask:0xf
    v_sub_u32 v56, v56, v55
    v_add_u32 v57, v56, v48
    v_add_u32 v58, v56, v53
    v_add_u32 v59, v56, v54
    ds_write_b128 v9, v[56:59] offset:1024
    s_cmp_lg_u32 s3, 0
    s_cbranch_scc1 K1_NOTBL
    v_lshl_or_b32 v60, v48, 16, v56
    v_lshl_or_b32 v61, v49, 16, v57
    v_lshl_or_b32 v62, v50, 16, v58
    v_lshl_or_b32 v63, v51, 16, v59
    s_lshl_b32 s62, s2, 10
    s_add_u32 s62, s62, 15728640
    buffer_store_dwordx4 v[60:63], v9, s[20:23], s62 offen
K1_NOTBL:
    s_waitcnt lgkmcnt(0)
    ds_read_b32 v52, v42 offset:1024
    ds_read_b32 v53, v43 offset:1024
    s_waitcnt vmcnt(4)
    v_lshl_or_b32 v31, v46, 16, v12
    v_lshl_or_b32 v43, v47, 16, v13
    v_lshrrev_b64 v[14:15], v3, v[14:15]
    v_lshrrev_b64 v[16:17], v3, v[16:17]
    v_lshlrev_b32 v28, 16, v14
    v_and_b32 v29, 0xffff0000, v14
    v_lshlrev_b32 v30, 16, v15
    v_lshlrev_b32 v40, 16, v16
    v_and_b32 v41, 0xffff0000, v16
    v_lshlrev_b32 v42, 16, v17
    s_waitcnt lgkmcnt(0)
    v_add_u32 v52, v52, v44
    v_add_u32 v53, v53, v45
    v_mul_u32_u24 v52, 48, v52
    v_mul_u32_u24 v53, 48, v53
    ds_write_b128 v52, v[28:31] offset:2080
    s_mov_b64 exec, s[60:61]
    ds_write_b128 v53, v[40:43] offset:2080
    s_mov_b64 exec, -1
    s_waitcnt vmcnt(0)
    ds_write_b128 v52, v[20:23] offset:2048
    ds_write_b128 v52, v[24:27] offset:2064
    s_mov_b64 exec, s[60:61]
    ds_write_b128 v53, v[32:35] offset:2048
    ds_write_b128 v53, v[36:39] offset:2064
    s_mov_b64 exec, -1
    v_lshlrev_b32 v5, 4, v0
    s_mul_i32 s52, s2, 60000
    s_waitcnt lgkmcnt(0)
    s_barrier
    ds_read_b128 v[12:15], v5 offset:2048
    ds_read_b128 v[16:19], v5 offset:12288
    ds_read_b128 v[20:23], v5 offset:22528
    ds_read_b128 v[24:27], v5 offset:32768
    ds_read_b128 v[28:31], v5 offset:43008
    ds_read_b128 v[32:35], v5 offset:53248
    s_waitcnt lgkmcnt(5)
    buffer_store_dwordx4 v[12:15], v5, s[20:23], s52 offen
    s_add_u32 s52, s52, 10240
    s_waitcnt lgkmcnt(4)
    buffer_store_dwordx4 v[16:19], v5, s[20:23], s52 offen
    s_add_u32 s52, s52, 10240
    s_waitcnt lgkmcnt(3)
    buffer_store_dwordx4 v[20:23], v5, s[20:23], s52 offen
    s_add_u32 s52, s52, 10240
    s_waitcnt lgkmcnt(2)
    buffer_store_dwordx4 v[24:27], v5, s[20:23], s52 offen
    s_add_u32 s52, s52, 10240
    s_waitcnt lgkmcnt(1)
    buffer_store_dwordx4 v[28:31], v5, s[20:23], s52 offen
    s_add_u32 s52, s52, 10240
    s_waitcnt lgkmcnt(0)
    v_cmp_gt_u32 vcc, 550, v0
    s_nop 0
    s_and_saveexec_b64 s[56:57], vcc
    s_cbranch_execz K1_STD
    buffer_store_dwordx4 v[32:35], v5, s[20:23], s52 offen
K1_STD:
    s_mov_b64 exec, -1
    s_cmp_lg_u32 s3, 9
    s_cbranch_scc1 K1_END
    s_cmp_ge_u32 s2, 180
    s_cbranch_scc1 K1_END
    v_and_b32 v1, 15, v8
    v_lshrrev_b32 v2, 4, v8
    s_cmp_ge_u32 s2, 160
    s_cbranch_scc1 K1_WT
    s_cmp_ge_u32 s2, 64
    s_cbranch_scc1 K1_S1
    s_lshr_b32 s24, s2, 3
    s_and_b32 s25, s2, 7
    s_lshr_b32 s26, s25, 2
    s_bfe_u32 s27, s25, 0x10001
    s_and_b32 s28, s25, 1
    s_mov_b32 s4, s46
    s_and_b32 s5, s47, 0xffff
    s_mov_b32 s6, 65536
    s_mov_b32 s7, 0x20000
    s_branch K1_SC
K1_S1:
    s_sub_u32 s29, s2, 64
    s_mul_i32 s24, s29, 43
    s_lshr_b32 s24, s24, 9
    s_mul_i32 s25, s24, 12
    s_sub_u32 s25, s29, s25
    s_cmp_ge_u32 s25, 6
    s_cselect_b32 s26, 1, 0
    s_mul_i32 s27, s26, 6
    s_sub_u32 s27, s25, s27
    s_lshr_b32 s27, s27, 1
    s_and_b32 s28, s25, 1
    s_add_u32 s25, s25, 8
    s_mov_b32 s4, s48
    s_and_b32 s5, s49, 0xffff
    s_mov_b32 s6, 98304
    s_mov_b32 s7, 0x20000
K1_SC:
    s_lshl_b32 s27, s27, 7
    s_lshl_b32 s26, s26, 6
    s_lshl_b32 s28, s28, 5
    s_add_u32 s27, s27, s26
    s_add_u32 s27, s27, s28
    s_lshl_b32 s27, s27, 8
    s_lshl_b32 s26, s24, 5
    s_add_u32 s27, s27, s26
    v_lshlrev_b32 v2, 11, v2
    v_lshl_add_u32 v2, v1, 1, v2
    buffer_load_ushort v12, v2, s[4:7], s27 offen offset:0
    buffer_load_ushort v13, v2, s[4:7], s27 offen offset:256
    buffer_load_ushort v14, v2, s[4:7], s27 offen offset:512
    buffer_load_ushort v15, v2, s[4:7], s27 offen offset:768
    buffer_load_ushort v16, v2, s[4:7], s27 offen offset:1024
    buffer_load_ushort v17, v2, s[4:7], s27 offen offset:1280
    buffer_load_ushort v18, v2, s[4:7], s27 offen offset:1536
    buffer_load_ushort v19, v2, s[4:7], s27 offen offset:1792
    s_mul_i32 s24, s24, 20
    s_add_u32 s24, s24, s25
    s_lshl_b32 s24, s24, 10
    s_add_u32 s24, s24, 15990784
    s_branch K1_PACK
K1_WT:
    s_sub_u32 s24, s2, 160
    s_cmp_ge_u32 s24, 10
    s_cselect_b32 s26, 1, 0
    s_mul_i32 s25, s26, 10
    s_sub_u32 s25, s24, s25
    s_lshr_b32 s27, s25, 1
    s_and_b32 s28, s25, 1
    s_lshl_b32 s27, s27, 8
    s_lshl_b32 s26, s26, 7
    s_lshl_b32 s28, s28, 6
    s_add_u32 s27, s27, s26
    s_add_u32 s27, s27, s28
    s_add_u32 s28, s27, 10240
    s_mov_b32 s4, s44
    s_and_b32 s5, s45, 0xffff
    s_mov_b32 s6, 20480
    s_mov_b32 s7, 0x20000
    v_and_b32 v1, 31, v8
    v_lshrrev_b32 v2, 5, v8
    v_mul_u32_u24 v2, 5120, v2
    v_lshl_add_u32 v2, v1, 1, v2
    buffer_load_ushort v12, v2, s[4:7], s27 offen offset:0
    buffer_load_ushort v13, v2, s[4:7], s27 offen offset:1280
    buffer_load_ushort v14, v2, s[4:7], s27 offen offset:2560
    buffer_load_ushort v15, v2, s[4:7], s27 offen offset:3840
    buffer_load_ushort v16, v2, s[4:7], s28 offen offset:0
    buffer_load_ushort v17, v2, s[4:7], s28 offen offset:1280
    buffer_load_ushort v18, v2, s[4:7], s28 offen offset:2560
    buffer_load_ushort v19, v2, s[4:7], s28 offen offset:3840
    s_lshl_b32 s24, s24, 10
    s_add_u32 s24, s24, 16154624
K1_PACK:
    s_waitcnt vmcnt(0)
    v_lshl_or_b32 v20, v13, 16, v12
    v_lshl_or_b32 v21, v15, 16, v14
    v_lshl_or_b32 v22, v17, 16, v16
    v_lshl_or_b32 v23, v19, 16, v18
    buffer_store_dwordx4 v[20:23], v9, s[20:23], s24 offen
K1_END:
    s_endpgm
.globl tp_main_kernel
.p2align 8
.type tp_main_kernel,@function
tp_main_kernel:
    s_cmp_ge_u32 s2, 256
    s_cbranch_scc1 K2_END
    s_load_dwordx2 s[46:47], s[0:1], 0
    s_load_dwordx2 s[48:49], s[0:1], 72
    s_load_dwordx2 s[50:51], s[0:1], 88
    v_lshrrev_b32 v1, 6, v0
    s_mov_b32 s64, s2
    v_readfirstlane_b32 s16, v1
    s_mul_i32 s17, s2, 625
    s_add_u32 s18, s17, 640
    s_add_u32 s17, s17, 15
    s_lshr_b32 s17, s17, 4
    s_lshr_b32 s18, s18, 4
    s_sub_u32 s18, s18, s17
    s_mov_b32 s19, 0
    s_mov_b32 s24, 1
    s_movk_i32 s44, 1024
    s_lshl_b32 s34, s16, 13
    s_waitcnt lgkmcnt(0)
    s_mov_b32 s4, s46
    s_and_b32 s5, s47, 0xffff
    s_mov_b32 s6, 10240000
    s_mov_b32 s7, 0x20000
    s_mov_b32 s8, s50
    s_and_b32 s9, s51, 0xffff
    s_mov_b32 s10, 50331648
    s_mov_b32 s11, 0x20000
    s_mov_b32 s12, s48
    s_and_b32 s13, s49, 0xffff
    s_mov_b32 s14, 10240000
    s_mov_b32 s15, 0x20000
K2_WINDOW:
    s_mov_b32 s20, 0
    s_mov_b32 s21, 1
    s_mov_b32 s22, 64
K2_LOAD:
    v_mbcnt_lo_u32_b32 v176, -1, 0
    v_mbcnt_hi_u32_b32 v176, -1, v176
    s_lshl_b32 s45, s16, 6
    v_add_u32 v177, s45, v176
    v_lshrrev_b32 v178, 1, v177
    v_lshlrev_b32 v1, 10, v178
    s_lshl_b32 s45, s64, 2
    s_add_u32 s45, s45, 15728640
    buffer_load_dword v179, v1, s[8:11], s45 offen
    v_lshlrev_b32 v2, 4, v176
    s_mov_b32 s45, 16154624
    buffer_load_dwordx4 v[136:139], v2, s[8:11], s45 offen offset:0
    buffer_load_dwordx4 v[140:143], v2, s[8:11], s45 offen offset:1024
    buffer_load_dwordx4 v[144:147], v2, s[8:11], s45 offen offset:2048
    buffer_load_dwordx4 v[148:151], v2, s[8:11], s45 offen offset:3072
    s_mov_b32 s45, 16158720
    buffer_load_dwordx4 v[152:155], v2, s[8:11], s45 offen offset:0
    buffer_load_dwordx4 v[156:159], v2, s[8:11], s45 offen offset:1024
    buffer_load_dwordx4 v[160:163], v2, s[8:11], s45 offen offset:2048
    buffer_load_dwordx4 v[164:167], v2, s[8:11], s45 offen offset:3072
    s_mov_b32 s45, 16162816
    buffer_load_dwordx4 v[168:171], v2, s[8:11], s45 offen offset:0
    buffer_load_dwordx4 v[172:175], v2, s[8:11], s45 offen offset:1024
    v_mul_u32_u24 v3, 1311, v177
    v_lshrrev_b32 v3, 16, v3
    v_mul_u32_u24 v3, 50, v3
    v_sub_u32 v3, v177, v3
    v_subrev_u32 v4, 32, v3
    v_mov_b32 v8, 0
    v_mov_b32 v5, 1.0
    v_cmp_gt_u32 vcc, 4, v4
    s_nop 1
    v_cndmask_b32 v8, v8, v5, vcc
    v_cmp_le_u32 vcc, 48, v3
    s_nop 1
    v_cndmask_b32 v8, v8, -1, vcc
    v_lshlrev_b32 v6, 4, v177
    v_add_u32 v6, 65536, v6
    v_add_u32 v7, 64000, v6
    v_mov_b32 v9, v8
    v_mov_b32 v10, v8
    v_mov_b32 v11, v8
    v_cmp_gt_u32 vcc, 500, v177
    s_nop 0
    s_and_saveexec_b64 s[60:61], vcc
    ds_write_b128 v6, v[8:11] offset:0
    ds_write_b128 v6, v[8:11] offset:8000
    ds_write_b128 v6, v[8:11] offset:16000
    ds_write_b128 v6, v[8:11] offset:24000
    ds_write_b128 v6, v[8:11] offset:32000
    ds_write_b128 v6, v[8:11] offset:40000
    ds_write_b128 v6, v[8:11] offset:48000
    ds_write_b128 v6, v[8:11] offset:56000
    ds_write_b128 v7, v[8:11] offset:0
    ds_write_b128 v7, v[8:11] offset:8000
    ds_write_b128 v7, v[8:11] offset:16000
    ds_write_b128 v7, v[8:11] offset:24000
    s_mov_b64 exec, s[60:61]
    s_cmp_lg_u32 s16, 0
    s_cbranch_scc1 K2_NOH
    v_mov_b32 v3, 0
    v_mov_b32 v4, 162048
    ds_write_b32 v4, v3
    ds_write_b32 v4, v3 offset:8
    s_cmp_lg_u32 s20, 0
    s_cbranch_scc1 K2_NOH
    v_lshlrev_b32 v4, 2, v176
    v_add_u32 v4, 161536, v4
    ds_write_b32 v4, v3
    v_mov_b32 v4, 162052
    ds_write_b32 v4, v3
K2_NOH:
    s_waitcnt vmcnt(10)
    v_and_b32 v1, 1, v177
    v_add_u32 v1, s19, v1
    v_lshrrev_b32 v180, 16, v179
    v_sub_u32 v180, v180, v1
    v_and_b32 v179, 0xffff, v179
    v_add_u32 v179, v179, v1
    v_mul_u32_u24 v178, 1250, v178
    v_add_u32 v179, v179, v178
    v_mul_u32_u24 v181, 48, v179
    v_cmp_lt_i32 vcc, 0, v180
    s_nop 0
    s_cbranch_vccz K2_LD_DONE
    s_mov_b64 exec, vcc
    buffer_load_dwordx4 v[8:11], v181, s[8:11], 0 offen offset:32
    buffer_load_dwordx4 v[0:3], v181, s[8:11], 0 offen offset:0
    buffer_load_dwordx4 v[4:7], v181, s[8:11], 0 offen offset:16
    v_cmp_lt_i32 vcc, 2, v180
    s_nop 0
    s_cbranch_vccz K2_LD_DONE
    s_mov_b64 exec, vcc
    buffer_load_dwordx4 v[20:23], v181, s[8:11], 0 offen offset:128
    buffer_load_dwordx4 v[12:15], v181, s[8:11], 0 offen offset:96
    buffer_load_dwordx4 v[16:19], v181, s[8:11], 0 offen offset:112
    v_cmp_lt_i32 vcc, 4, v180
    s_nop 0
    s_cbranch_vccz K2_LD_DONE
    s_mov_b64 exec, vcc
    buffer_load_dwordx4 v[32:35], v181, s[8:11], 0 offen offset:224
    buffer_load_dwordx4 v[24:27], v181, s[8:11], 0 offen offset:192
    buffer_load_dwordx4 v[28:31], v181, s[8:11], 0 offen offset:208
    v_cmp_lt_i32 vcc, 6, v180
    s_nop 0
    s_cbranch_vccz K2_LD_DONE
    s_mov_b64 exec, vcc
    buffer_load_dwordx4 v[44:47], v181, s[8:11], 0 offen offset:320
    buffer_load_dwordx4 v[36:39], v181, s[8:11], 0 offen offset:288
    buffer_load_dwordx4 v[40:43], v181, s[8:11], 0 offen offset:304
    v_cmp_lt_i32 vcc, 8, v180
    s_nop 0
    s_cbranch_vccz K2_LD_DONE
    s_mov_b64 exec, vcc
    buffer_load_dwordx4 v[56:59], v181, s[8:11], 0 offen offset:416
    buffer_load_dwordx4 v[48:51], v181, s[8:11], 0 offen offset:384
    buffer_load_dwordx4 v[52:55], v181, s[8:11], 0 offen offset:400
    v_cmp_lt_i32 vcc, 10, v180
    s_nop 0
    s_cbranch_vccz K2_LD_DONE
    s_mov_b64 exec, vcc
    buffer_load_dwordx4 v[68:71], v181, s[8:11], 0 offen offset:512
    buffer_load_dwordx4 v[60:63], v181, s[8:11], 0 offen offset:480
    buffer_load_dwordx4 v[64:67], v181, s[8:11], 0 offen offset:496
    v_cmp_lt_i32 vcc, 12, v180
    s_nop 0
    s_cbranch_vccz K2_LD_DONE
    s_mov_b64 exec, vcc
    buffer_load_dwordx4 v[80:83], v181, s[8:11], 0 offen offset:608
    buffer_load_dwordx4 v[72:75], v181, s[8:11], 0 offen offset:576
    buffer_load_dwordx4 v[76:79], v181, s[8:11], 0 offen offset:592
    v_cmp_lt_i32 vcc, 14, v180
    s_nop 0
    s_cbranch_vccz K2_LD_DONE
    s_mov_b64 exec, vcc
    buffer_load_dwordx4 v[92:95], v181, s[8:11], 0 offen offset:704
    buffer_load_dwordx4 v[84:87], v181, s[8:11], 0 offen offset:672
    buffer_load_dwordx4 v[88:91], v181, s[8:11], 0 offen offset:688
    v_cmp_lt_i32 vcc, 16, v180
    s_nop 0
    s_cbranch_vccz K2_LD_DONE
    s_mov_b64 exec, vcc
    buffer_load_dwordx4 v[104:107], v181, s[8:11], 0 offen offset:800
    buffer_load_dwordx4 v[96:99], v181, s[8:11], 0 offen offset:768
    buffer_load_dwordx4 v[100:103], v181, s[8:11], 0 offen offset:784
    v_cmp_lt_i32 vcc, 18, v180
    s_nop 0
    s_cbranch_vccz K2_LD_DONE
    s_mov_b64 exec, vcc
    buffer_load_dwordx4 v[116:119], v181, s[8:11], 0 offen offset:896
    buffer_load_dwordx4 v[108:111], v181, s[8:11], 0 offen offset:864
    buffer_load_dwordx4 v[112:115], v181, s[8:11], 0 offen offset:880
K2_LD_DONE:
    s_mov_b64 exec, -1
    v_lshlrev_b32 v179, 2, v179
    s_mov_b32 s53, 16777216
    s_waitcnt lgkmcnt(0)
    s_barrier
    s_cmp_lg_u32 s20, 0
    s_cbranch_scc1 K2_RK_LOAD
    v_mov_b32 v178, 1
    v_cmp_lt_i32 vcc, 20, v180
    s_nop 0
    s_cbranch_vccz K2_NOMORE
    v_mov_b32 v177, 162052
    ds_write_b32 v177, v178
K2_NOMORE:
    s_waitcnt vmcnt(0)
    v_cmp_lt_i32 vcc, 0, v180
    s_nop 0
    s_cbranch_vccz K2_RK_DONE
    s_mov_b64 exec, vcc
    v_lshrrev_b32 v182, 16, v11
    v_lshlrev_b32 v182, 2, v182
    v_add_u32 v182, 161536, v182
    ds_add_rtn_u32 v120, v182, v178
    v_cmp_lt_i32 vcc, 2, v180
    s_nop 0
    s_cbranch_vccz K2_RK_DONE
    s_mov_b64 exec, vcc
    v_lshrrev_b32 v183, 16, v23
    v_lshlrev_b32 v183, 2, v183
    v_add_u32 v183, 161536, v183
    ds_add_rtn_u32 v121, v183, v178
    v_cmp_lt_i32 vcc, 4, v180
    s_nop 0
    s_cbranch_vccz K2_RK_DONE
    s_mov_b64 exec, vcc
    v_lshrrev_b32 v184, 16, v35
    v_lshlrev_b32 v184, 2, v184
    v_add_u32 v184, 161536, v184
    ds_add_rtn_u32 v122, v184, v178
    v_cmp_lt_i32 vcc, 6, v180
    s_nop 0
    s_cbranch_vccz K2_RK_DONE
    s_mov_b64 exec, vcc
    v_lshrrev_b32 v185, 16, v47
    v_lshlrev_b32 v185, 2, v185
    v_add_u32 v185, 161536, v185
    ds_add_rtn_u32 v123, v185, v178
    v_cmp_lt_i32 vcc, 8, v180
    s_nop 0
    s_cbranch_vccz K2_RK_DONE
    s_mov_b64 exec, vcc
    v_lshrrev_b32 v186, 16, v59
    v_lshlrev_b32 v186, 2, v186
    v_add_u32 v186, 161536, v186
    ds_add_rtn_u32 v124, v186, v178
    v_cmp_lt_i32 vcc, 10, v180
    s_nop 0
    s_cbranch_vccz K2_RK_DONE
    s_mov_b64 exec, vcc
    v_lshrrev_b32 v187, 16, v71
    v_lshlrev_b32 v187, 2, v187
    v_add_u32 v187, 161536, v187
    ds_add_rtn_u32 v125, v187, v178
    v_cmp_lt_i32 vcc, 12, v180
    s_nop 0
    s_cbranch_vccz K2_RK_DONE
    s_mov_b64 exec, vcc
    v_lshrrev_b32 v188, 16, v83
    v_lshlrev_b32 v188, 2, v188
    v_add_u32 v188, 161536, v188
    ds_add_rtn_u32 v126, v188, v178
    v_cmp_lt_i32 vcc, 14, v180
    s_nop 0
    s_cbranch_vccz K2_RK_DONE
    s_mov_b64 exec, vcc
    v_lshrrev_b32 v189, 16, v95
    v_lshlrev_b32 v189, 2, v189
    v_add_u32 v189, 161536, v189
    ds_add_rtn_u32 v127, v189, v178
    v_cmp_lt_i32 vcc, 16, v180
    s_nop 0
    s_cbranch_vccz K2_RK_DONE
    s_mov_b64 exec, vcc
    v_lshrrev_b32 v190, 16, v107
    v_lshlrev_b32 v190, 2, v190
    v_add_u32 v190, 161536, v190
    ds_add_rtn_u32 v128, v190, v178
    v_cmp_lt_i32 vcc, 18, v180
    s_nop 0
    s_cbranch_vccz K2_RK_DONE
    s_mov_b64 exec, vcc
    v_lshrrev_b32 v191, 16, v119
    v_lshlrev_b32 v191, 2, v191
    v_add_u32 v191, 161536, v191
    ds_add_rtn_u32 v129, v191, v178
    s_branch K2_RK_DONE
K2_RK_LOAD:
    s_waitcnt vmcnt(0)
    v_cmp_lt_i32 vcc, 0, v180
    s_nop 0
    s_cbranch_vccz K2_RK_DONE
    s_mov_b64 exec, vcc
    v_lshrrev_b32 v182, 16, v11
    v_lshlrev_b32 v182, 2, v182
    v_add_u32 v182, 161536, v182
    buffer_load_dword v120, v179, s[8:11], s53 offen offset:0
    v_cmp_lt_i32 vcc, 2, v180
    s_nop 0
    s_cbranch_vccz K2_RK_DONE
    s_mov_b64 exec, vcc
    v_lshrrev_b32 v183, 16, v23
    v_lshlrev_b32 v183, 2, v183
    v_add_u32 v183, 161536, v183
    buffer_load_dword v121, v179, s[8:11], s53 offen offset:8
    v_cmp_lt_i32 vcc, 4, v180
    s_nop 0
    s_cbranch_vccz K2_RK_DONE
    s_mov_b64 exec, vcc
    v_lshrrev_b32 v184, 16, v35
    v_lshlrev_b32 v184, 2, v184
    v_add_u32 v184, 161536, v184
    buffer_load_dword v122, v179, s[8:11], s53 offen offset:16
    v_cmp_lt_i32 vcc, 6, v180
    s_nop 0
    s_cbranch_vccz K2_RK_DONE
    s_mov_b64 exec, vcc
    v_lshrrev_b32 v185, 16, v47
    v_lshlrev_b32 v185, 2, v185
    v_add_u32 v185, 161536, v185
    buffer_load_dword v123, v179, s[8:11], s53 offen offset:24
    v_cmp_lt_i32 vcc, 8, v180
    s_nop 0
    s_cbranch_vccz K2_RK_DONE
    s_mov_b64 exec, vcc
    v_lshrrev_b32 v186, 16, v59
    v_lshlrev_b32 v186, 2, v186
    v_add_u32 v186, 161536, v186
    buffer_load_dword v124, v179, s[8:11], s53 offen offset:32
    v_cmp_lt_i32 vcc, 10, v180
    s_nop 0
    s_cbranch_vccz K2_RK_DONE
    s_mov_b64 exec, vcc
    v_lshrrev_b32 v187, 16, v71
    v_lshlrev_b32 v187, 2, v187
    v_add_u32 v187, 161536, v187
    buffer_load_dword v125, v179, s[8:11], s53 offen offset:40
    v_cmp_lt_i32 vcc, 12, v180
    s_nop 0
    s_cbranch_vccz K2_RK_DONE
    s_mov_b64 exec, vcc
    v_lshrrev_b32 v188, 16, v83
    v_lshlrev_b32 v188, 2, v188
    v_add_u32 v188, 161536, v188
    buffer_load_dword v126, v179, s[8:11], s53 offen offset:48
    v_cmp_lt_i32 vcc, 14, v180
    s_nop 0
    s_cbranch_vccz K2_RK_DONE
    s_mov_b64 exec, vcc
    v_lshrrev_b32 v189, 16, v95
    v_lshlrev_b32 v189, 2, v189
    v_add_u32 v189, 161536, v189
    buffer_load_dword v127, v179, s[8:11], s53 offen offset:56
    v_cmp_lt_i32 vcc, 16, v180
    s_nop 0
    s_cbranch_vccz K2_RK_DONE
    s_mov_b64 exec, vcc
    v_lshrrev_b32 v190, 16, v107
    v_lshlrev_b32 v190, 2, v190
    v_add_u32 v190, 161536, v190
    buffer_load_dword v128, v179, s[8:11], s53 offen offset:64
    v_cmp_lt_i32 vcc, 18, v180
    s_nop 0
    s_cbranch_vccz K2_RK_DONE
    s_mov_b64 exec, vcc
    v_lshrrev_b32 v191, 16, v119
    v_lshlrev_b32 v191, 2, v191
    v_add_u32 v191, 161536, v191
    buffer_load_dword v129, v179, s[8:11], s53 offen offset:72
K2_RK_DONE:
    s_mov_b64 exec, -1
    v_lshlrev_b32 v192, 2, v176
    v_add_u32 v192, 161536, v192
    v_mov_b32 v200, 162052
    s_waitcnt vmcnt(0) lgkmcnt(0)
    s_barrier
    ds_read_b32 v193, v192
    ds_read_b32 v200, v200
    s_waitcnt lgkmcnt(0)
    v_readfirstlane_b32 s23, v200
K2_TCALC:
    s_mul_i32 s54, s20, s22
    v_subrev_u32 v194, s54, v193
    v_max_i32 v194, 0, v194
    v_min_i32 v194, s22, v194
    v_add_u32 v194, 15, v194
    v_lshrrev_b32 v194, 4, v194
    v_max_u32 v194, 1, v194
    v_max_u32 v195, 2, v194
    v_cmp_gt_u32 vcc, s18, v176
    s_nop 1
    v_cndmask_b32 v195, 0, v195, vcc
    v_mov_b32 v196, v195
    s_nop 1
    v_add_u32_dpp v196, v196, v196 row_shr:1 row_mask:0xf bank_mask:0xf bound_ctrl:0
    s_nop 1
    v_add_u32_dpp v196, v196, v196 row_shr:2 row_mask:0xf bank_mask:0xf bound_ctrl:0
    s_nop 1
    v_add_u32_dpp v196, v196, v196 row_shr:4 row_mask:0xf bank_mask:0xf bound_ctrl:0
    s_nop 1
    v_add_u32_dpp v196, v196, v196 row_shr:8 row_mask:0xf bank_mask:0xf bound_ctrl:0
    s_nop 1
    v_add_u32_dpp v196, v196, v196 row_bcast:15 row_mask:0xa bank_mask:0xf
    s_nop 1
    v_add_u32_dpp v196, v196, v196 row_bcast:31 row_mask:0xc bank_mask:0xf
    s_cmp_lg_u32 s22, 64
    s_cbranch_scc1 K2_TOK
    v_readlane_b32 s45, v196, 63
    v_cmp_lt_u32 vcc, 64, v193
    s_cmp_gt_u32 s45, 119
    s_cbranch_scc1 K2_SLOW
    s_cbranch_vccz K2_TOK
K2_SLOW:
    v_mov_b32 v197, v193
    s_nop 1
    v_max_u32_dpp v197, v197, v197 row_shr:1 row_mask:0xf bank_mask:0xf bound_ctrl:0
    s_nop 1
    v_max_u32_dpp v197, v197, v197 row_shr:2 row_mask:0xf bank_mask:0xf bound_ctrl:0
    s_nop 1
    v_max_u32_dpp v197, v197, v197 row_shr:4 row_mask:0xf bank_mask:0xf bound_ctrl:0
    s_nop 1
    v_max_u32_dpp v197, v197, v197 row_shr:8 row_mask:0xf bank_mask:0xf bound_ctrl:0
    s_nop 1
    v_max_u32_dpp v197, v197, v197 row_bcast:15 row_mask:0xa bank_mask:0xf
    s_nop 1
    v_max_u32_dpp v197, v197, v197 row_bcast:31 row_mask:0xc bank_mask:0xf
    s_nop 0
    v_readlane_b32 s21, v197, 63
    s_nop 0
    s_add_u32 s21, s21, 31
    s_lshr_b32 s21, s21, 5
    s_mov_b32 s22, 32
    v_cmp_lt_i32 vcc, 0, v180
    s_nop 0
    s_cbranch_vccz K2_SV_DONE
    s_mov_b64 exec, vcc
    buffer_store_dword v120, v179, s[8:11], s53 offen offset:0
    v_cmp_lt_i32 vcc, 2, v180
    s_nop 0
    s_cbranch_vccz K2_SV_DONE
    s_mov_b64 exec, vcc
    buffer_store_dword v121, v179, s[8:11], s53 offen offset:8
    v_cmp_lt_i32 vcc, 4, v180
    s_nop 0
    s_cbranch_vccz K2_SV_DONE
    s_mov_b64 exec, vcc
    buffer_store_dword v122, v179, s[8:11], s53 offen offset:16
    v_cmp_lt_i32 vcc, 6, v180
    s_nop 0
    s_cbranch_vccz K2_SV_DONE
    s_mov_b64 exec, vcc
    buffer_store_dword v123, v179, s[8:11], s53 offen offset:24
    v_cmp_lt_i32 vcc, 8, v180
    s_nop 0
    s_cbranch_vccz K2_SV_DONE
    s_mov_b64 exec, vcc
    buffer_store_dword v124, v179, s[8:11], s53 offen offset:32
    v_cmp_lt_i32 vcc, 10, v180
    s_nop 0
    s_cbranch_vccz K2_SV_DONE
    s_mov_b64 exec, vcc
    buffer_store_dword v125, v179, s[8:11], s53 offen offset:40
    v_cmp_lt_i32 vcc, 12, v180
    s_nop 0
    s_cbranch_vccz K2_SV_DONE
    s_mov_b64 exec, vcc
    buffer_store_dword v126, v179, s[8:11], s53 offen offset:48
    v_cmp_lt_i32 vcc, 14, v180
    s_nop 0
    s_cbranch_vccz K2_SV_DONE
    s_mov_b64 exec, vcc
    buffer_store_dword v127, v179, s[8:11], s53 offen offset:56
    v_cmp_lt_i32 vcc, 16, v180
    s_nop 0
    s_cbranch_vccz K2_SV_DONE
    s_mov_b64 exec, vcc
    buffer_store_dword v128, v179, s[8:11], s53 offen offset:64
    v_cmp_lt_i32 vcc, 18, v180
    s_nop 0
    s_cbranch_vccz K2_SV_DONE
    s_mov_b64 exec, vcc
    buffer_store_dword v129, v179, s[8:11], s53 offen offset:72
K2_SV_DONE:
    s_mov_b64 exec, -1
    s_branch K2_TCALC
K2_TOK:
    v_sub_u32 v196, v196, v195
    s_movk_i32 s45, 800
    v_mov_b32 v197, 65536
    v_mad_u32_u24 v196, v196, s45, v197
    v_lshlrev_b32 v197, 5, v176
    v_sub_u32 v197, v197, v196
    v_and_b32 v197, 0xff, v197
    v_cmp_lt_u32 vcc, 192, v197
    v_cmp_gt_u32 s[60:61], 3, v194
    s_nop 0
    s_and_b64 vcc, vcc, s[60:61]
    v_cndmask_b32 v197, v197, 0, vcc
    v_lshl_or_b32 v253, v194, 18, v196
    v_lshl_or_b32 v253, v197, 21, v253
    v_mov_b32 v197, 422880
    v_cmp_gt_u32 vcc, s18, v176
    s_nop 1
    v_cndmask_b32 v253, v197, v253, vcc
    ds_write_b32 v192, v196 offset:256
    s_waitcnt lgkmcnt(0)
    v_cmp_lt_i32 vcc, 0, v180
    s_nop 0
    s_cbranch_vccz K2_TB_DONE
    s_mov_b64 exec, vcc
    ds_read_b32 v182, v182 offset:256
    v_cmp_lt_i32 vcc, 2, v180
    s_nop 0
    s_cbranch_vccz K2_TB_DONE
    s_mov_b64 exec, vcc
    ds_read_b32 v183, v183 offset:256
    v_cmp_lt_i32 vcc, 4, v180
    s_nop 0
    s_cbranch_vccz K2_TB_DONE
    s_mov_b64 exec, vcc
    ds_read_b32 v184, v184 offset:256
    v_cmp_lt_i32 vcc, 6, v180
    s_nop 0
    s_cbranch_vccz K2_TB_DONE
    s_mov_b64 exec, vcc
    ds_read_b32 v185, v185 offset:256
    v_cmp_lt_i32 vcc, 8, v180
    s_nop 0
    s_cbranch_vccz K2_TB_DONE
    s_mov_b64 exec, vcc
    ds_read_b32 v186, v186 offset:256
    v_cmp_lt_i32 vcc, 10, v180
    s_nop 0
    s_cbranch_vccz K2_TB_DONE
    s_mov_b64 exec, vcc
    ds_read_b32 v187, v187 offset:256
    v_cmp_lt_i32 vcc, 12, v180
    s_nop 0
    s_cbranch_vccz K2_TB_DONE
    s_mov_b64 exec, vcc
    ds_read_b32 v188, v188 offset:256
    v_cmp_lt_i32 vcc, 14, v180
    s_nop 0
    s_cbranch_vccz K2_TB_DONE
    s_mov_b64 exec, vcc
    ds_read_b32 v189, v189 offset:256
    v_cmp_lt_i32 vcc, 16, v180
    s_nop 0
    s_cbranch_vccz K2_TB_DONE
    s_mov_b64 exec, vcc
    ds_read_b32 v190, v190 offset:256
    v_cmp_lt_i32 vcc, 18, v180
    s_nop 0
    s_cbranch_vccz K2_TB_DONE
    s_mov_b64 exec, vcc
    ds_read_b32 v191, v191 offset:256
K2_TB_DONE:
    s_mov_b64 exec, -1
    s_movk_i32 s45, 800
    s_waitcnt lgkmcnt(0)
    v_cmp_lt_i32 vcc, 0, v180
    s_nop 0
    s_cbranch_vccz K2_SC_DONE
    v_subrev_u32 v120, s54, v120
    v_cmp_gt_u32 s[60:61], s22, v120
    s_nop 0
    s_and_b64 exec, vcc, s[60:61]
    s_cbranch_execz K2_sc_1
    v_lshrrev_b32 v192, 4, v120
    v_mad_u32_u24 v192, v192, s45, v182
    v_and_b32 v193, 15, v120
    v_lshl_add_u32 v194, v193, 5, v192
    v_lshl_add_u32 v195, v193, 2, v192
    v_and_b32 v196, 7, v193
    v_lshrrev_b32 v193, 3, v193
    v_lshl_add_u32 v196, v196, 2, v192
    v_lshl_add_u32 v196, v193, 1, v196
    ds_write_b128 v194, v[0:3]
    ds_write_b128 v194, v[4:7] offset:16
    ds_write2_b32 v195, v8, v9 offset0:144 offset1:160
    ds_write_b32 v195, v10 offset:704
    ds_write_b16 v196, v11 offset:768
K2_sc_1:
    s_mov_b64 exec, -1
    v_cmp_lt_i32 vcc, 2, v180
    s_nop 0
    s_cbranch_vccz K2_SC_DONE
    v_subrev_u32 v121, s54, v121
    v_cmp_gt_u32 s[60:61], s22, v121
    s_nop 0
    s_and_b64 exec, vcc, s[60:61]
    s_cbranch_execz K2_sc_2
    v_lshrrev_b32 v192, 4, v121
    v_mad_u32_u24 v192, v192, s45, v183
    v_and_b32 v193, 15, v121
    v_lshl_add_u32 v194, v193, 5, v192
    v_lshl_add_u32 v195, v193, 2, v192
    v_and_b32 v196, 7, v193
    v_lshrrev_b32 v193, 3, v193
    v_lshl_add_u32 v196, v196, 2, v192
    v_lshl_add_u32 v196, v193, 1, v196
    ds_write_b128 v194, v[12:15]
    ds_write_b128 v194, v[16:19] offset:16
    ds_write2_b32 v195, v20, v21 offset0:144 offset1:160
    ds_write_b32 v195, v22 offset:704
    ds_write_b16 v196, v23 offset:768
K2_sc_2:
    s_mov_b64 exec, -1
    v_cmp_lt_i32 vcc, 4, v180
    s_nop 0
    s_cbranch_vccz K2_SC_DONE
    v_subrev_u32 v122, s54, v122
    v_cmp_gt_u32 s[60:61], s22, v122
    s_nop 0
    s_and_b64 exec, vcc, s[60:61]
    s_cbranch_execz K2_sc_3
    v_lshrrev_b32 v192, 4, v122
    v_mad_u32_u24 v192, v192, s45, v184
    v_and_b32 v193, 15, v122
    v_lshl_add_u32 v194, v193, 5, v192
    v_lshl_add_u32 v195, v193, 2, v192
    v_and_b32 v196, 7, v193
    v_lshrrev_b32 v193, 3, v193
    v_lshl_add_u32 v196, v196, 2, v192
    v_lshl_add_u32 v196, v193, 1, v196
    ds_write_b128 v194, v[24:27]
    ds_write_b128 v194, v[28:31] offset:16
    ds_write2_b32 v195, v32, v33 offset0:144 offset1:160
    ds_write_b32 v195, v34 offset:704
    ds_write_b16 v196, v35 offset:768
K2_sc_3:
    s_mov_b64 exec, -1
    v_cmp_lt_i32 vcc, 6, v180
    s_nop 0
    s_cbranch_vccz K2_SC_DONE
    v_subrev_u32 v123, s54, v123
    v_cmp_gt_u32 s[60:61], s22, v123
    s_nop 0
    s_and_b64 exec, vcc, s[60:61]
    s_cbranch_execz K2_sc_4
    v_lshrrev_b32 v192, 4, v123
    v_mad_u32_u24 v192, v192, s45, v185
    v_and_b32 v193, 15, v123
    v_lshl_add_u32 v194, v193, 5, v192
    v_lshl_add_u32 v195, v193, 2, v192
    v_and_b32 v196, 7, v193
    v_lshrrev_b32 v193, 3, v193
    v_lshl_add_u32 v196, v196, 2, v192
    v_lshl_add_u32 v196, v193, 1, v196
    ds_write_b128 v194, v[36:39]
    ds_write_b128 v194, v[40:43] offset:16
    ds_write2_b32 v195, v44, v45 offset0:144 offset1:160
    ds_write_b32 v195, v46 offset:704
    ds_write_b16 v196, v47 offset:768
K2_sc_4:
    s_mov_b64 exec, -1
    v_cmp_lt_i32 vcc, 8, v180
    s_nop 0
    s_cbranch_vccz K2_SC_DONE
    v_subrev_u32 v124, s54, v124
    v_cmp_gt_u32 s[60:61], s22, v124
    s_nop 0
    s_and_b64 exec, vcc, s[60:61]
    s_cbranch_execz K2_sc_5
    v_lshrrev_b32 v192, 4, v124
    v_mad_u32_u24 v192, v192, s45, v186
    v_and_b32 v193, 15, v124
    v_lshl_add_u32 v194, v193, 5, v192
    v_lshl_add_u32 v195, v193, 2, v192
    v_and_b32 v196, 7, v193
    v_lshrrev_b32 v193, 3, v193
    v_lshl_add_u32 v196, v196, 2, v192
    v_lshl_add_u32 v196, v193, 1, v196
    ds_write_b128 v194, v[48:51]
    ds_write_b128 v194, v[52:55] offset:16
    ds_write2_b32 v195, v56, v57 offset0:144 offset1:160
    ds_write_b32 v195, v58 offset:704
    ds_write_b16 v196, v59 offset:768
K2_sc_5:
    s_mov_b64 exec, -1
    v_cmp_lt_i32 vcc, 10, v180
    s_nop 0
    s_cbranch_vccz K2_SC_DONE
    v_subrev_u32 v125, s54, v125
    v_cmp_gt_u32 s[60:61], s22, v125
    s_nop 0
    s_and_b64 exec, vcc, s[60:61]
    s_cbranch_execz K2_sc_6
    v_lshrrev_b32 v192, 4, v125
    v_mad_u32_u24 v192, v192, s45, v187
    v_and_b32 v193, 15, v125
    v_lshl_add_u32 v194, v193, 5, v192
    v_lshl_add_u32 v195, v193, 2, v192
    v_and_b32 v196, 7, v193
    v_lshrrev_b32 v193, 3, v193
    v_lshl_add_u32 v196, v196, 2, v192
    v_lshl_add_u32 v196, v193, 1, v196
    ds_write_b128 v194, v[60:63]
    ds_write_b128 v194, v[64:67] offset:16
    ds_write2_b32 v195, v68, v69 offset0:144 offset1:160
    ds_write_b32 v195, v70 offset:704
    ds_write_b16 v196, v71 offset:768
K2_sc_6:
    s_mov_b64 exec, -1
    v_cmp_lt_i32 vcc, 12, v180
    s_nop 0
    s_cbranch_vccz K2_SC_DONE
    v_subrev_u32 v126, s54, v126
    v_cmp_gt_u32 s[60:61], s22, v126
    s_nop 0
    s_and_b64 exec, vcc, s[60:61]
    s_cbranch_execz K2_sc_7
    v_lshrrev_b32 v192, 4, v126
    v_mad_u32_u24 v192, v192, s45, v188
    v_and_b32 v193, 15, v126
    v_lshl_add_u32 v194, v193, 5, v192
    v_lshl_add_u32 v195, v193, 2, v192
    v_and_b32 v196, 7, v193
    v_lshrrev_b32 v193, 3, v193
    v_lshl_add_u32 v196, v196, 2, v192
    v_lshl_add_u32 v196, v193, 1, v196
    ds_write_b128 v194, v[72:75]
    ds_write_b128 v194, v[76:79] offset:16
    ds_write2_b32 v195, v80, v81 offset0:144 offset1:160
    ds_write_b32 v195, v82 offset:704
    ds_write_b16 v196, v83 offset:768
K2_sc_7:
    s_mov_b64 exec, -1
    v_cmp_lt_i32 vcc, 14, v180
    s_nop 0
    s_cbranch_vccz K2_SC_DONE
    v_subrev_u32 v127, s54, v127
    v_cmp_gt_u32 s[60:61], s22, v127
    s_nop 0
    s_and_b64 exec, vcc, s[60:61]
    s_cbranch_execz K2_sc_8
    v_lshrrev_b32 v192, 4, v127
    v_mad_u32_u24 v192, v192, s45, v189
    v_and_b32 v193, 15, v127
    v_lshl_add_u32 v194, v193, 5, v192
    v_lshl_add_u32 v195, v193, 2, v192
    v_and_b32 v196, 7, v193
    v_lshrrev_b32 v193, 3, v193
    v_lshl_add_u32 v196, v196, 2, v192
    v_lshl_add_u32 v196, v193, 1, v196
    ds_write_b128 v194, v[84:87]
    ds_write_b128 v194, v[88:91] offset:16
    ds_write2_b32 v195, v92, v93 offset0:144 offset1:160
    ds_write_b32 v195, v94 offset:704
    ds_write_b16 v196, v95 offset:768
K2_sc_8:
    s_mov_b64 exec, -1
    v_cmp_lt_i32 vcc, 16, v180
    s_nop 0
    s_cbranch_vccz K2_SC_DONE
    v_subrev_u32 v128, s54, v128
    v_cmp_gt_u32 s[60:61], s22, v128
    s_nop 0
    s_and_b64 exec, vcc, s[60:61]
    s_cbranch_execz K2_sc_9
    v_lshrrev_b32 v192, 4, v128
    v_mad_u32_u24 v192, v192, s45, v190
    v_and_b32 v193, 15, v128
    v_lshl_add_u32 v194, v193, 5, v192
    v_lshl_add_u32 v195, v193, 2, v192
    v_and_b32 v196, 7, v193
    v_lshrrev_b32 v193, 3, v193
    v_lshl_add_u32 v196, v196, 2, v192
    v_lshl_add_u32 v196, v193, 1, v196
    ds_write_b128 v194, v[96:99]
    ds_write_b128 v194, v[100:103] offset:16
    ds_write2_b32 v195, v104, v105 offset0:144 offset1:160
    ds_write_b32 v195, v106 offset:704
    ds_write_b16 v196, v107 offset:768
K2_sc_9:
    s_mov_b64 exec, -1
    v_cmp_lt_i32 vcc, 18, v180
    s_nop 0
    s_cbranch_vccz K2_SC_DONE
    v_subrev_u32 v129, s54, v129
    v_cmp_gt_u32 s[60:61], s22, v129
    s_nop 0
    s_and_b64 exec, vcc, s[60:61]
    s_cbranch_execz K2_sc_10
    v_lshrrev_b32 v192, 4, v129
    v_mad_u32_u24 v192, v192, s45, v191
    v_and_b32 v193, 15, v129
    v_lshl_add_u32 v194, v193, 5, v192
    v_lshl_add_u32 v195, v193, 2, v192
    v_and_b32 v196, 7, v193
    v_lshrrev_b32 v193, 3, v193
    v_lshl_add_u32 v196, v196, 2, v192
    v_lshl_add_u32 v196, v193, 1, v196
    ds_write_b128 v194, v[108:111]
    ds_write_b128 v194, v[112:115] offset:16
    ds_write2_b32 v195, v116, v117 offset0:144 offset1:160
    ds_write_b32 v195, v118 offset:704
    ds_write_b16 v196, v119 offset:768
K2_sc_10:
    s_mov_b64 exec, -1
K2_SC_DONE:
    s_mov_b64 exec, -1
    v_and_b32 v0, 15, v176
    v_lshrrev_b32 v1, 5, v176
    v_bfe_u32 v2, v176, 4, 1
    v_lshrrev_b32 v3, 2, v0
    v_and_b32 v4, 3, v0
    v_lshl_add_u32 v5, v1, 3, v3
    v_lshlrev_b32 v249, 5, v5
    v_lshl_add_u32 v249, v4, 3, v249
    v_lshlrev_b32 v250, 6, v2
    v_lshl_add_u32 v250, v1, 5, v250
    v_add_u32 v250, 512, v250
    v_lshrrev_b32 v6, 1, v4
    v_lshl_add_u32 v6, v2, 1, v6
    v_bfe_u32 v7, v3, 1, 1
    v_lshlrev_b32 v7, 2, v7
    v_xor_b32 v6, v6, v7
    v_lshlrev_b32 v6, 4, v6
    v_lshl_add_u32 v6, v5, 7, v6
    v_and_b32 v7, 1, v4
    v_lshl_add_u32 v6, v7, 3, v6
    v_add_u32 v246, s34, v6
    v_xor_b32 v247, 64, v246
    v_lshrrev_b32 v6, 3, v176
    v_lshlrev_b32 v251, 2, v6
    v_add_u32 v251, 768, v251
    v_bfe_u32 v6, v6, 1, 1
    v_lshlrev_b32 v6, 2, v6
    v_and_b32 v7, 7, v176
    v_xor_b32 v6, v6, v7
    v_lshlrev_b32 v248, 4, v6
    v_lshlrev_b32 v252, 1, v176
    v_lshlrev_b32 v96, 16, v136
    v_and_b32 v97, 0xffff0000, v136
    v_lshlrev_b32 v98, 16, v137
    v_and_b32 v99, 0xffff0000, v137
    v_lshlrev_b32 v100, 16, v138
    v_and_b32 v101, 0xffff0000, v138
    v_lshlrev_b32 v102, 16, v139
    v_and_b32 v103, 0xffff0000, v139
    v_lshlrev_b32 v104, 16, v140
    v_and_b32 v105, 0xffff0000, v140
    v_lshlrev_b32 v106, 16, v141
    v_and_b32 v107, 0xffff0000, v141
    v_lshlrev_b32 v108, 16, v142
    v_and_b32 v109, 0xffff0000, v142
    v_lshlrev_b32 v110, 16, v143
    v_and_b32 v111, 0xffff0000, v143
    v_lshlrev_b32 v112, 16, v144
    v_and_b32 v113, 0xffff0000, v144
    v_lshlrev_b32 v114, 16, v145
    v_and_b32 v115, 0xffff0000, v145
    v_lshlrev_b32 v116, 16, v146
    v_and_b32 v117, 0xffff0000, v146
    v_lshlrev_b32 v118, 16, v147
    v_and_b32 v119, 0xffff0000, v147
    v_lshlrev_b32 v120, 16, v148
    v_and_b32 v121, 0xffff0000, v148
    v_lshlrev_b32 v122, 16, v149
    v_and_b32 v123, 0xffff0000, v149
    v_lshlrev_b32 v124, 16, v150
    v_and_b32 v125, 0xffff0000, v150
    v_lshlrev_b32 v126, 16, v151
    v_and_b32 v127, 0xffff0000, v151
    v_lshlrev_b32 v128, 16, v152
    v_and_b32 v129, 0xffff0000, v152
    v_lshlrev_b32 v130, 16, v153
    v_and_b32 v131, 0xffff0000, v153
    v_lshlrev_b32 v132, 16, v154
    v_and_b32 v133, 0xffff0000, v154
    v_lshlrev_b32 v134, 16, v155
    v_and_b32 v135, 0xffff0000, v155
    v_lshlrev_b32 v136, 16, v156
    v_and_b32 v137, 0xffff0000, v156
    v_lshlrev_b32 v138, 16, v157
    v_and_b32 v139, 0xffff0000, v157
    v_lshlrev_b32 v140, 16, v158
    v_and_b32 v141, 0xffff0000, v158
    v_lshlrev_b32 v142, 16, v159
    v_and_b32 v143, 0xffff0000, v159
    v_lshlrev_b32 v144, 16, v160
    v_and_b32 v145, 0xffff0000, v160
    v_lshlrev_b32 v146, 16, v161
    v_and_b32 v147, 0xffff0000, v161
    v_lshlrev_b32 v148, 16, v162
    v_and_b32 v149, 0xffff0000, v162
    v_lshlrev_b32 v150, 16, v163
    v_and_b32 v151, 0xffff0000, v163
    v_lshlrev_b32 v152, 16, v164
    v_and_b32 v153, 0xffff0000, v164
    v_lshlrev_b32 v154, 16, v165
    v_and_b32 v155, 0xffff0000, v165
    v_lshlrev_b32 v156, 16, v166
    v_and_b32 v157, 0xffff0000, v166
    v_lshlrev_b32 v158, 16, v167
    v_and_b32 v159, 0xffff0000, v167
    v_lshlrev_b32 v160, 16, v168
    v_and_b32 v161, 0xffff0000, v168
    v_lshlrev_b32 v162, 16, v169
    v_and_b32 v163, 0xffff0000, v169
    v_lshlrev_b32 v164, 16, v170
    v_and_b32 v165, 0xffff0000, v170
    v_lshlrev_b32 v166, 16, v171
    v_and_b32 v167, 0xffff0000, v171
    v_lshlrev_b32 v168, 16, v172
    v_and_b32 v169, 0xffff0000, v172
    v_lshlrev_b32 v170, 16, v173
    v_and_b32 v171, 0xffff0000, v173
    v_lshlrev_b32 v172, 16, v174
    v_and_b32 v173, 0xffff0000, v174
    v_lshlrev_b32 v174, 16, v175
    v_and_b32 v175, 0xffff0000, v175
    s_movk_i32 s36, 0
    s_movk_i32 s37, 256
    s_movk_i32 s38, 512
    s_movk_i32 s39, 768
    s_mov_b32 s35, 0
    s_mov_b32 s31, 0
    s_mov_b32 s32, 0
    s_mov_b32 s33, 1
    s_mov_b32 s27, 0
    s_mov_b32 s45, s16
    s_waitcnt lgkmcnt(0)
    s_barrier
    v_readlane_b32 s46, v253, s45
    s_nop 0
    s_and_b32 s29, s46, 0x3ffff
    s_bfe_u32 s30, s46, 0x30012
    s_cmp_eq_u32 s31, 0
    s_cbranch_scc1 K2_p1_11
    s_lshr_b32 s32, s46, 21
    s_add_u32 s32, s32, s29
K2_p1_11:
    s_lshl_b32 s47, s30, 3
    s_sub_u32 s47, s47, 8
    s_lshr_b32 s48, 0x4050e4, s47
    s_lshr_b32 s49, 0xe4244400, s47
    s_lshl_b32 s50, s31, 7
    s_mov_b32 s40, s50
    v_add_u32 v230, s29, v251
    s_bfe_u32 s51, s48, 0x20002
    s_lshl_b32 s51, s51, 8
    s_add_u32 s41, s51, s50
    s_bfe_u32 s51, s49, 0x20002
    s_mul_i32 s51, s51, 800
    s_add_u32 s51, s51, s29
    v_add_u32 v231, s51, v251
    s_bfe_u32 s51, s48, 0x20004
    s_lshl_b32 s51, s51, 8
    s_add_u32 s42, s51, s50
    s_bfe_u32 s51, s49, 0x20004
    s_mul_i32 s51, s51, 800
    s_add_u32 s51, s51, s29
    v_add_u32 v232, s51, v251
    s_bfe_u32 s51, s48, 0x20006
    s_lshl_b32 s51, s51, 8
    s_add_u32 s43, s51, s50
    s_bfe_u32 s51, s49, 0x20006
    s_mul_i32 s51, s51, 800
    s_add_u32 s51, s51, s29
    v_add_u32 v233, s51, v251
    ds_read_b32 v230, v230
    ds_read_b32 v231, v231
    ds_read_b32 v232, v232
    ds_read_b32 v233, v233
    s_waitcnt lgkmcnt(0)
    v_mad_u32_u16 v222, v230, s44, v248
    v_mad_u32_u16 v223, v230, s44, v248 op_sel:[1,0,0,0]
    v_mad_u32_u16 v224, v231, s44, v248
    v_mad_u32_u16 v225, v231, s44, v248 op_sel:[1,0,0,0]
    v_mad_u32_u16 v226, v232, s44, v248
    v_mad_u32_u16 v227, v232, s44, v248 op_sel:[1,0,0,0]
    v_mad_u32_u16 v228, v233, s44, v248
    v_mad_u32_u16 v229, v233, s44, v248 op_sel:[1,0,0,0]
    s_add_u32 m0, s34, 0
    s_nop 0
    buffer_load_dwordx4 v222, s[4:7], s40 offen lds
    s_add_u32 m0, s34, 1024
    s_nop 0
    buffer_load_dwordx4 v223, s[4:7], s40 offen lds
    s_add_u32 m0, s34, 2048
    s_nop 0
    buffer_load_dwordx4 v224, s[4:7], s41 offen lds
    s_add_u32 m0, s34, 3072
    s_nop 0
    buffer_load_dwordx4 v225, s[4:7], s41 offen lds
    s_add_u32 m0, s34, 4096
    s_nop 0
    buffer_load_dwordx4 v226, s[4:7], s42 offen lds
    s_add_u32 m0, s34, 5120
    s_nop 0
    buffer_load_dwordx4 v227, s[4:7], s42 offen lds
    s_add_u32 m0, s34, 6144
    s_nop 0
    buffer_load_dwordx4 v228, s[4:7], s43 offen lds
    s_add_u32 m0, s34, 7168
    s_nop 0
    buffer_load_dwordx4 v229, s[4:7], s43 offen lds
    s_waitcnt vmcnt(6)
    ds_read_b64_tr_b16 v[176:177], v246 offset:0
    ds_read_b64_tr_b16 v[178:179], v246 offset:512
    ds_read_b64_tr_b16 v[180:181], v247 offset:0
    ds_read_b64_tr_b16 v[182:183], v247 offset:512
K2_NEXT:
    s_cmp_eq_u32 s33, 0
    s_cbranch_scc1 K2_TAIL
    s_cmp_eq_u32 s31, s27
    s_cbranch_scc1 K2_SAMEPH
    v_lshlrev_b32 v0, 3, v252
    s_mov_b32 s45, 16164864
    buffer_load_dwordx4 v[136:139], v0, s[8:11], s45 offen offset:0
    buffer_load_dwordx4 v[140:143], v0, s[8:11], s45 offen offset:1024
    buffer_load_dwordx4 v[144:147], v0, s[8:11], s45 offen offset:2048
    buffer_load_dwordx4 v[148:151], v0, s[8:11], s45 offen offset:3072
    s_mov_b32 s45, 16168960
    buffer_load_dwordx4 v[152:155], v0, s[8:11], s45 offen offset:0
    buffer_load_dwordx4 v[156:159], v0, s[8:11], s45 offen offset:1024
    buffer_load_dwordx4 v[160:163], v0, s[8:11], s45 offen offset:2048
    buffer_load_dwordx4 v[164:167], v0, s[8:11], s45 offen offset:3072
    s_mov_b32 s45, 16173056
    buffer_load_dwordx4 v[168:171], v0, s[8:11], s45 offen offset:0
    buffer_load_dwordx4 v[172:175], v0, s[8:11], s45 offen offset:1024
    s_movk_i32 s36, 128
    s_movk_i32 s37, 384
    s_movk_i32 s38, 640
    s_movk_i32 s39, 896
    v_mov_b32 v1, 162056
K2_SPIN:
    ds_read_b32 v2, v1
    s_waitcnt lgkmcnt(0)
    v_readfirstlane_b32 s45, v2
    s_nop 0
    s_cmp_lt_u32 s45, 8
    s_cbranch_scc1 K2_SPIN
    s_waitcnt vmcnt(0)
    v_lshlrev_b32 v96, 16, v136
    v_and_b32 v97, 0xffff0000, v136
    v_lshlrev_b32 v98, 16, v137
    v_and_b32 v99, 0xffff0000, v137
    v_lshlrev_b32 v100, 16, v138
    v_and_b32 v101, 0xffff0000, v138
    v_lshlrev_b32 v102, 16, v139
    v_and_b32 v103, 0xffff0000, v139
    v_lshlrev_b32 v104, 16, v140
    v_and_b32 v105, 0xffff0000, v140
    v_lshlrev_b32 v106, 16, v141
    v_and_b32 v107, 0xffff0000, v141
    v_lshlrev_b32 v108, 16, v142
    v_and_b32 v109, 0xffff0000, v142
    v_lshlrev_b32 v110, 16, v143
    v_and_b32 v111, 0xffff0000, v143
    v_lshlrev_b32 v112, 16, v144
    v_and_b32 v113, 0xffff0000, v144
    v_lshlrev_b32 v114, 16, v145
    v_and_b32 v115, 0xffff0000, v145
    v_lshlrev_b32 v116, 16, v146
    v_and_b32 v117, 0xffff0000, v146
    v_lshlrev_b32 v118, 16, v147
    v_and_b32 v119, 0xffff0000, v147
    v_lshlrev_b32 v120, 16, v148
    v_and_b32 v121, 0xffff0000, v148
    v_lshlrev_b32 v122, 16, v149
    v_and_b32 v123, 0xffff0000, v149
    v_lshlrev_b32 v124, 16, v150
    v_and_b32 v125, 0xffff0000, v150
    v_lshlrev_b32 v126, 16, v151
    v_and_b32 v127, 0xffff0000, v151
    v_lshlrev_b32 v128, 16, v152
    v_and_b32 v129, 0xffff0000, v152
    v_lshlrev_b32 v130, 16, v153
    v_and_b32 v131, 0xffff0000, v153
    v_lshlrev_b32 v132, 16, v154
    v_and_b32 v133, 0xffff0000, v154
    v_lshlrev_b32 v134, 16, v155
    v_and_b32 v135, 0xffff0000, v155
    v_lshlrev_b32 v136, 16, v156
    v_and_b32 v137, 0xffff0000, v156
    v_lshlrev_b32 v138, 16, v157
    v_and_b32 v139, 0xffff0000, v157
    v_lshlrev_b32 v140, 16, v158
    v_and_b32 v141, 0xffff0000, v158
    v_lshlrev_b32 v142, 16, v159
    v_and_b32 v143, 0xffff0000, v159
    v_lshlrev_b32 v144, 16, v160
    v_and_b32 v145, 0xffff0000, v160
    v_lshlrev_b32 v146, 16, v161
    v_and_b32 v147, 0xffff0000, v161
    v_lshlrev_b32 v148, 16, v162
    v_and_b32 v149, 0xffff0000, v162
    v_lshlrev_b32 v150, 16, v163
    v_and_b32 v151, 0xffff0000, v163
    v_lshlrev_b32 v152, 16, v164
    v_and_b32 v153, 0xffff0000, v164
    v_lshlrev_b32 v154, 16, v165
    v_and_b32 v155, 0xffff0000, v165
    v_lshlrev_b32 v156, 16, v166
    v_and_b32 v157, 0xffff0000, v166
    v_lshlrev_b32 v158, 16, v167
    v_and_b32 v159, 0xffff0000, v167
    v_lshlrev_b32 v160, 16, v168
    v_and_b32 v161, 0xffff0000, v168
    v_lshlrev_b32 v162, 16, v169
    v_and_b32 v163, 0xffff0000, v169
    v_lshlrev_b32 v164, 16, v170
    v_and_b32 v165, 0xffff0000, v170
    v_lshlrev_b32 v166, 16, v171
    v_and_b32 v167, 0xffff0000, v171
    v_lshlrev_b32 v168, 16, v172
    v_and_b32 v169, 0xffff0000, v172
    v_lshlrev_b32 v170, 16, v173
    v_and_b32 v171, 0xffff0000, v173
    v_lshlrev_b32 v172, 16, v174
    v_and_b32 v173, 0xffff0000, v174
    v_lshlrev_b32 v174, 16, v175
    v_and_b32 v175, 0xffff0000, v175
K2_SAMEPH:
    s_mov_b32 s25, s29
    s_mov_b32 s27, s31
    s_mov_b32 s28, s32
    s_cmp_eq_u32 s30, 2
    s_cbranch_scc1 K2_UNIT2
    s_cmp_eq_u32 s30, 3
    s_cbranch_scc1 K2_UNIT3
    s_cmp_eq_u32 s30, 1
    s_cbranch_scc1 K2_UNIT1
K2_UNIT4:
    v_add_u32 v62, s25, v249
    v_add_u32 v63, s25, v250
    ds_read_b64_tr_b16 v[0:1], v62 offset:0
    ds_read_b64_tr_b16 v[2:3], v62 offset:128
    ds_read_b128 v[4:7], v63 offset:0
    ds_read_b128 v[8:11], v63 offset:16
    ds_read_b128 v[12:15], v63 offset:128
    ds_read_b128 v[16:19], v63 offset:144
    ds_read_b64_tr_b16 v[28:29], v62 offset:800
    ds_read_b64_tr_b16 v[30:31], v62 offset:928
    ds_read_b128 v[32:35], v63 offset:800
    ds_read_b128 v[36:39], v63 offset:816
    ds_read_b128 v[40:43], v63 offset:928
    ds_read_b128 v[44:47], v63 offset:944
    s_waitcnt lgkmcnt(10)
    v_lshlrev_b32 v20, 16, v0
    v_and_b32 v21, 0xffff0000, v0
    v_lshlrev_b32 v22, 16, v1
    v_and_b32 v23, 0xffff0000, v1
    v_lshlrev_b32 v24, 16, v2
    v_and_b32 v25, 0xffff0000, v2
    v_lshlrev_b32 v26, 16, v3
    v_and_b32 v27, 0xffff0000, v3
    s_waitcnt lgkmcnt(8)
    v_mul_f32 v4, v20, v4
    v_mul_f32 v5, v21, v5
    v_mul_f32 v6, v22, v6
    v_mul_f32 v7, v23, v7
    v_mul_f32 v8, v24, v8
    v_mul_f32 v9, v25, v9
    v_mul_f32 v10, v26, v10
    v_mul_f32 v11, v27, v11
    v_cvt_pk_bf16_f32 v64, v4, v5
    v_cvt_pk_bf16_f32 v65, v6, v7
    v_cvt_pk_bf16_f32 v66, v8, v9
    v_cvt_pk_bf16_f32 v67, v10, v11
    s_waitcnt lgkmcnt(6)
    v_mul_f32 v12, v20, v12
    v_mul_f32 v13, v21, v13
    v_mul_f32 v14, v22, v14
    v_mul_f32 v15, v23, v15
    v_mul_f32 v16, v24, v16
    v_mul_f32 v17, v25, v17
    v_mul_f32 v18, v26, v18
    v_mul_f32 v19, v27, v19
    v_cvt_pk_bf16_f32 v68, v12, v13
    v_cvt_pk_bf16_f32 v69, v14, v15
    v_cvt_pk_bf16_f32 v70, v16, v17
    v_cvt_pk_bf16_f32 v71, v18, v19
    ds_read_b64_tr_b16 v[0:1], v62 offset:1600
    ds_read_b64_tr_b16 v[2:3], v62 offset:1728
    ds_read_b128 v[4:7], v63 offset:1600
    ds_read_b128 v[8:11], v63 offset:1616
    ds_read_b128 v[12:15], v63 offset:1728
    ds_read_b128 v[16:19], v63 offset:1744
    s_waitcnt lgkmcnt(10)
    v_lshlrev_b32 v48, 16, v28
    v_and_b32 v49, 0xffff0000, v28
    v_lshlrev_b32 v50, 16, v29
    v_and_b32 v51, 0xffff0000, v29
    v_lshlrev_b32 v52, 16, v30
    v_and_b32 v53, 0xffff0000, v30
    v_lshlrev_b32 v54, 16, v31
    v_and_b32 v55, 0xffff0000, v31
    s_waitcnt lgkmcnt(8)
    v_mul_f32 v32, v48, v32
    v_mul_f32 v33, v49, v33
    v_mul_f32 v34, v50, v34
    v_mul_f32 v35, v51, v35
    v_mul_f32 v36, v52, v36
    v_mul_f32 v37, v53, v37
    v_mul_f32 v38, v54, v38
    v_mul_f32 v39, v55, v39
    v_cvt_pk_bf16_f32 v72, v32, v33
    v_cvt_pk_bf16_f32 v73, v34, v35
    v_cvt_pk_bf16_f32 v74, v36, v37
    v_cvt_pk_bf16_f32 v75, v38, v39
    s_waitcnt lgkmcnt(6)
    v_mul_f32 v40, v48, v40
    v_mul_f32 v41, v49, v41
    v_mul_f32 v42, v50, v42
    v_mul_f32 v43, v51, v43
    v_mul_f32 v44, v52, v44
    v_mul_f32 v45, v53, v45
    v_mul_f32 v46, v54, v46
    v_mul_f32 v47, v55, v47
    v_cvt_pk_bf16_f32 v76, v40, v41
    v_cvt_pk_bf16_f32 v77, v42, v43
    v_cvt_pk_bf16_f32 v78, v44, v45
    v_cvt_pk_bf16_f32 v79, v46, v47
    ds_read_b64_tr_b16 v[28:29], v62 offset:2400
    ds_read_b64_tr_b16 v[30:31], v62 offset:2528
    ds_read_b128 v[32:35], v63 offset:2400
    ds_read_b128 v[36:39], v63 offset:2416
    ds_read_b128 v[40:43], v63 offset:2528
    ds_read_b128 v[44:47], v63 offset:2544
    s_waitcnt lgkmcnt(10)
    v_lshlrev_b32 v20, 16, v0
    v_and_b32 v21, 0xffff0000, v0
    v_lshlrev_b32 v22, 16, v1
    v_and_b32 v23, 0xffff0000, v1
    v_lshlrev_b32 v24, 16, v2
    v_and_b32 v25, 0xffff0000, v2
    v_lshlrev_b32 v26, 16, v3
    v_and_b32 v27, 0xffff0000, v3
    s_waitcnt lgkmcnt(8)
    v_mul_f32 v4, v20, v4
    v_mul_f32 v5, v21, v5
    v_mul_f32 v6, v22, v6
    v_mul_f32 v7, v23, v7
    v_mul_f32 v8, v24, v8
    v_mul_f32 v9, v25, v9
    v_mul_f32 v10, v26, v10
    v_mul_f32 v11, v27, v11
    v_cvt_pk_bf16_f32 v80, v4, v5
    v_cvt_pk_bf16_f32 v81, v6, v7
    v_cvt_pk_bf16_f32 v82, v8, v9
    v_cvt_pk_bf16_f32 v83, v10, v11
    s_waitcnt lgkmcnt(6)
    v_mul_f32 v12, v20, v12
    v_mul_f32 v13, v21, v13
    v_mul_f32 v14, v22, v14
    v_mul_f32 v15, v23, v15
    v_mul_f32 v16, v24, v16
    v_mul_f32 v17, v25, v17
    v_mul_f32 v18, v26, v18
    v_mul_f32 v19, v27, v19
    v_cvt_pk_bf16_f32 v84, v12, v13
    v_cvt_pk_bf16_f32 v85, v14, v15
    v_cvt_pk_bf16_f32 v86, v16, v17
    v_cvt_pk_bf16_f32 v87, v18, v19
    s_waitcnt lgkmcnt(4)
    v_lshlrev_b32 v48, 16, v28
    v_and_b32 v49, 0xffff0000, v28
    v_lshlrev_b32 v50, 16, v29
    v_and_b32 v51, 0xffff0000, v29
    v_lshlrev_b32 v52, 16, v30
    v_and_b32 v53, 0xffff0000, v30
    v_lshlrev_b32 v54, 16, v31
    v_and_b32 v55, 0xffff0000, v31
    s_waitcnt lgkmcnt(2)
    v_mul_f32 v32, v48, v32
    v_mul_f32 v33, v49, v33
    v_mul_f32 v34, v50, v34
    v_mul_f32 v35, v51, v35
    v_mul_f32 v36, v52, v36
    v_mul_f32 v37, v53, v37
    v_mul_f32 v38, v54, v38
    v_mul_f32 v39, v55, v39
    v_cvt_pk_bf16_f32 v88, v32, v33
    v_cvt_pk_bf16_f32 v89, v34, v35
    v_cvt_pk_bf16_f32 v90, v36, v37
    v_cvt_pk_bf16_f32 v91, v38, v39
    s_waitcnt lgkmcnt(0)
    v_mul_f32 v40, v48, v40
    v_mul_f32 v41, v49, v41
    v_mul_f32 v42, v50, v42
    v_mul_f32 v43, v51, v43
    v_mul_f32 v44, v52, v44
    v_mul_f32 v45, v53, v45
    v_mul_f32 v46, v54, v46
    v_mul_f32 v47, v55, v47
    v_cvt_pk_bf16_f32 v92, v40, v41
    v_cvt_pk_bf16_f32 v93, v42, v43
    v_cvt_pk_bf16_f32 v94, v44, v45
    v_cvt_pk_bf16_f32 v95, v46, v47
    s_setprio 2
    s_waitcnt lgkmcnt(0)
    v_mfma_f32_32x32x16_bf16 v[0:15], v[64:67], v[176:179], 0
    s_add_u32 m0, s34, 0
    s_nop 0
    buffer_load_dwordx4 v222, s[4:7], s37 offen lds
    s_add_u32 m0, s34, 1024
    s_nop 0
    buffer_load_dwordx4 v223, s[4:7], s37 offen lds
    v_mfma_f32_32x32x16_bf16 v[16:31], v[68:71], v[176:179], 0
    s_waitcnt vmcnt(6)
    ds_read_b64_tr_b16 v[184:185], v246 offset:2048
    ds_read_b64_tr_b16 v[186:187], v246 offset:2560
    v_mfma_f32_32x32x16_bf16 v[32:47], v[64:67], v[180:183], 0
    ds_read_b64_tr_b16 v[188:189], v247 offset:2048
    ds_read_b64_tr_b16 v[190:191], v247 offset:2560
    v_mfma_f32_32x32x16_bf16 v[48:63], v[68:71], v[180:183], 0
    s_waitcnt lgkmcnt(0)
    v_mfma_f32_32x32x16_bf16 v[0:15], v[72:75], v[184:187], v[0:15]
    s_add_u32 m0, s34, 2048
    s_nop 0
    buffer_load_dwordx4 v224, s[4:7], s37 offen lds
    s_add_u32 m0, s34, 3072
    s_nop 0
    buffer_load_dwordx4 v225, s[4:7], s37 offen lds
    v_mfma_f32_32x32x16_bf16 v[16:31], v[76:79], v[184:187], v[16:31]
    s_waitcnt vmcnt(6)
    ds_read_b64_tr_b16 v[176:177], v246 offset:4096
    ds_read_b64_tr_b16 v[178:179], v246 offset:4608
    v_mfma_f32_32x32x16_bf16 v[32:47], v[72:75], v[188:191], v[32:47]
    ds_read_b64_tr_b16 v[180:181], v247 offset:4096
    ds_read_b64_tr_b16 v[182:183], v247 offset:4608
    v_mfma_f32_32x32x16_bf16 v[48:63], v[76:79], v[188:191], v[48:63]
    s_waitcnt lgkmcnt(0)
    v_mfma_f32_32x32x16_bf16 v[0:15], v[80:83], v[176:179], v[0:15]
    s_add_u32 m0, s34, 4096
    s_nop 0
    buffer_load_dwordx4 v226, s[4:7], s37 offen lds
    s_add_u32 m0, s34, 5120
    s_nop 0
    buffer_load_dwordx4 v227, s[4:7], s37 offen lds
    v_mfma_f32_32x32x16_bf16 v[16:31], v[84:87], v[176:179], v[16:31]
    s_waitcnt vmcnt(6)
    ds_read_b64_tr_b16 v[184:185], v246 offset:6144
    ds_read_b64_tr_b16 v[186:187], v246 offset:6656
    v_mfma_f32_32x32x16_bf16 v[32:47], v[80:83], v[180:183], v[32:47]
    ds_read_b64_tr_b16 v[188:189], v247 offset:6144
    ds_read_b64_tr_b16 v[190:191], v247 offset:6656
    v_mfma_f32_32x32x16_bf16 v[48:63], v[84:87], v[180:183], v[48:63]
    s_waitcnt lgkmcnt(0)
    v_mfma_f32_32x32x16_bf16 v[0:15], v[88:91], v[184:187], v[0:15]
    s_add_u32 m0, s34, 6144
    s_nop 0
    buffer_load_dwordx4 v228, s[4:7], s37 offen lds
    s_add_u32 m0, s34, 7168
    s_nop 0
    buffer_load_dwordx4 v229, s[4:7], s37 offen lds
    v_mfma_f32_32x32x16_bf16 v[16:31], v[92:95], v[184:187], v[16:31]
    s_waitcnt vmcnt(6)
    ds_read_b64_tr_b16 v[176:177], v246 offset:0
    ds_read_b64_tr_b16 v[178:179], v246 offset:512
    v_mfma_f32_32x32x16_bf16 v[32:47], v[88:91], v[188:191], v[32:47]
    ds_read_b64_tr_b16 v[180:181], v247 offset:0
    ds_read_b64_tr_b16 v[182:183], v247 offset:512
    v_mfma_f32_32x32x16_bf16 v[48:63], v[92:95], v[188:191], v[48:63]
    s_setprio 0
    s_add_u32 s35, s35, 1
    s_lshl_b32 s45, s35, 3
    s_add_u32 s45, s45, s16
    s_cmp_lt_u32 s45, s18
    s_cbranch_scc1 K2_cl_13
    s_mov_b32 s35, 8
    s_mov_b32 s45, -1
    v_mov_b32 v231, 162048
    v_mov_b32 v232, 1
    s_mov_b64 exec, 1
    ds_add_rtn_u32 v230, v231, v232
    s_mov_b64 exec, -1
K2_cl_13:
    v_mul_f32 v234, v0, v96
    v_mul_f32 v236, v8, v128
    v_mul_f32 v238, v16, v128
    v_mul_f32 v240, v24, v128
    v_fmac_f32 v234, v1, v97
    v_fmac_f32 v236, v9, v129
    v_fmac_f32 v238, v17, v129
    v_fmac_f32 v240, v25, v129
    v_fmac_f32 v234, v2, v98
    v_fmac_f32 v236, v10, v130
    v_fmac_f32 v238, v18, v130
    v_fmac_f32 v240, v26, v130
    v_fmac_f32 v234, v3, v99
    v_fmac_f32 v236, v11, v131
    v_fmac_f32 v238, v19, v131
    v_fmac_f32 v240, v27, v131
    v_fmac_f32 v234, v4, v100
    v_fmac_f32 v236, v12, v132
    v_fmac_f32 v238, v20, v132
    v_fmac_f32 v240, v28, v132
    v_fmac_f32 v234, v5, v101
    v_fmac_f32 v236, v13, v133
    v_fmac_f32 v238, v21, v133
    v_fmac_f32 v240, v29, v133
    v_fmac_f32 v234, v6, v102
    v_fmac_f32 v236, v14, v134
    v_fmac_f32 v238, v22, v134
    v_fmac_f32 v240, v30, v134
    v_fmac_f32 v234, v7, v103
    v_fmac_f32 v236, v15, v135
    v_fmac_f32 v238, v23, v135
    v_fmac_f32 v240, v31, v135
    v_mul_f32 v235, v32, v104
    v_mul_f32 v237, v40, v136
    v_mul_f32 v239, v48, v136
    v_mul_f32 v241, v56, v136
    v_fmac_f32 v235, v33, v105
    v_fmac_f32 v237, v41, v137
    v_fmac_f32 v239, v49, v137
    v_fmac_f32 v241, v57, v137
    v_fmac_f32 v235, v34, v106
    v_fmac_f32 v237, v42, v138
    v_fmac_f32 v239, v50, v138
    v_fmac_f32 v241, v58, v138
    v_fmac_f32 v235, v35, v107
    v_fmac_f32 v237, v43, v139
    v_fmac_f32 v239, v51, v139
    v_fmac_f32 v241, v59, v139
    v_fmac_f32 v235, v36, v108
    v_fmac_f32 v237, v44, v140
    v_fmac_f32 v239, v52, v140
    v_fmac_f32 v241, v60, v140
    v_fmac_f32 v235, v37, v109
    v_fmac_f32 v237, v45, v141
    v_fmac_f32 v239, v53, v141
    v_fmac_f32 v241, v61, v141
    v_fmac_f32 v235, v38, v110
    v_fmac_f32 v237, v46, v142
    v_fmac_f32 v239, v54, v142
    v_fmac_f32 v241, v62, v142
    v_fmac_f32 v235, v39, v111
    v_fmac_f32 v237, v47, v143
    v_fmac_f32 v239, v55, v143
    v_fmac_f32 v241, v63, v143
    v_permlane32_swap_b32 v234, v235
    v_permlane32_swap_b32 v236, v237
    v_permlane32_swap_b32 v238, v239
    v_permlane32_swap_b32 v240, v241
    v_add_f32 v234, v234, v235
    v_add_f32 v236, v236, v237
    v_add_f32 v238, v238, v239
    v_add_f32 v240, v240, v241
    s_cmp_lg_u32 s27, 0
    s_cbranch_scc1 K2_fl1_14
    s_set_gpr_idx_on s28, gpr_idx(DST)
    s_nop 0
    v_cvt_pk_bf16_f32 v192, v234, v236
    v_cvt_pk_bf16_f32 v193, v238, v240
    s_set_gpr_idx_off
    s_branch K2_fld_15
K2_fl1_14:
    v_add_u32 v254, s28, v252
    v_cvt_pk_bf16_f32 v234, v234, v236
    v_cvt_pk_bf16_f32 v238, v238, v240
    ds_write_b16 v254, v234 offset:0
    ds_write_b16_d16_hi v254, v234 offset:256
    ds_write_b16 v254, v238 offset:640
    ds_write_b16_d16_hi v254, v238 offset:1024
K2_fld_15:
    s_mov_b32 s31, 0
    s_mul_i32 s32, s35, 6
    s_mov_b32 s33, 1
    s_cmp_lg_u32 s45, -1
    s_cbranch_scc1 K2_st_16
    s_cmp_lg_u32 s27, 0
    s_cbranch_scc1 K2_nd_17
    s_mov_b64 exec, 1
    ds_add_u32 v231, v232 offset:8
    s_mov_b64 exec, -1
K2_nd_17:
    s_waitcnt lgkmcnt(0)
    v_readfirstlane_b32 s45, v230
    s_mov_b32 s31, 1
    s_cmp_lt_u32 s45, s18
    s_cselect_b32 s33, 1, 0
    s_cselect_b32 s45, s45, 63
K2_st_16:
    v_readlane_b32 s46, v253, s45
    s_nop 0
    s_and_b32 s29, s46, 0x3ffff
    s_bfe_u32 s30, s46, 0x30012
    s_cmp_eq_u32 s31, 0
    s_cbranch_scc1 K2_p1_18
    s_lshr_b32 s32, s46, 21
    s_add_u32 s32, s32, s29
K2_p1_18:
    s_lshl_b32 s47, s30, 3
    s_sub_u32 s47, s47, 8
    s_lshr_b32 s48, 0x4050e4, s47
    s_lshr_b32 s49, 0xe4244400, s47
    s_lshl_b32 s50, s31, 7
    s_mov_b32 s40, s50
    v_add_u32 v230, s29, v251
    s_bfe_u32 s51, s48, 0x20002
    s_lshl_b32 s51, s51, 8
    s_add_u32 s41, s51, s50
    s_bfe_u32 s51, s49, 0x20002
    s_mul_i32 s51, s51, 800
    s_add_u32 s51, s51, s29
    v_add_u32 v231, s51, v251
    s_bfe_u32 s51, s48, 0x20004
    s_lshl_b32 s51, s51, 8
    s_add_u32 s42, s51, s50
    s_bfe_u32 s51, s49, 0x20004
    s_mul_i32 s51, s51, 800
    s_add_u32 s51, s51, s29
    v_add_u32 v232, s51, v251
    s_bfe_u32 s51, s48, 0x20006
    s_lshl_b32 s51, s51, 8
    s_add_u32 s43, s51, s50
    s_bfe_u32 s51, s49, 0x20006
    s_mul_i32 s51, s51, 800
    s_add_u32 s51, s51, s29
    v_add_u32 v233, s51, v251
    ds_read_b32 v230, v230
    ds_read_b32 v231, v231
    ds_read_b32 v232, v232
    ds_read_b32 v233, v233
    s_setprio 2
    s_waitcnt lgkmcnt(4)
    v_mfma_f32_32x32x16_bf16 v[0:15], v[64:67], v[176:179], 0
    s_add_u32 m0, s34, 0
    s_nop 0
    buffer_load_dwordx4 v222, s[4:7], s38 offen lds
    s_add_u32 m0, s34, 1024
    s_nop 0
    buffer_load_dwordx4 v223, s[4:7], s38 offen lds
    v_mfma_f32_32x32x16_bf16 v[16:31], v[68:71], v[176:179], 0
    s_waitcnt vmcnt(6)
    ds_read_b64_tr_b16 v[184:185], v246 offset:2048
    ds_read_b64_tr_b16 v[186:187], v246 offset:2560
    v_mfma_f32_32x32x16_bf16 v[32:47], v[64:67], v[180:183], 0
    ds_read_b64_tr_b16 v[188:189], v247 offset:2048
    ds_read_b64_tr_b16 v[190:191], v247 offset:2560
    v_mfma_f32_32x32x16_bf16 v[48:63], v[68:71], v[180:183], 0
    s_waitcnt lgkmcnt(0)
    v_mfma_f32_32x32x16_bf16 v[0:15], v[72:75], v[184:187], v[0:15]
    s_add_u32 m0, s34, 2048
    s_nop 0
    buffer_load_dwordx4 v224, s[4:7], s38 offen lds
    s_add_u32 m0, s34, 3072
    s_nop 0
    buffer_load_dwordx4 v225, s[4:7], s38 offen lds
    v_mfma_f32_32x32x16_bf16 v[16:31], v[76:79], v[184:187], v[16:31]
    s_waitcnt vmcnt(6)
    ds_read_b64_tr_b16 v[176:177], v246 offset:4096
    ds_read_b64_tr_b16 v[178:179], v246 offset:4608
    v_mfma_f32_32x32x16_bf16 v[32:47], v[72:75], v[188:191], v[32:47]
    ds_read_b64_tr_b16 v[180:181], v247 offset:4096
    ds_read_b64_tr_b16 v[182:183], v247 offset:4608
    v_mfma_f32_32x32x16_bf16 v[48:63], v[76:79], v[188:191], v[48:63]
    s_waitcnt lgkmcnt(0)
    v_mfma_f32_32x32x16_bf16 v[0:15], v[80:83], v[176:179], v[0:15]
    s_add_u32 m0, s34, 4096
    s_nop 0
    buffer_load_dwordx4 v226, s[4:7], s38 offen lds
    s_add_u32 m0, s34, 5120
    s_nop 0
    buffer_load_dwordx4 v227, s[4:7], s38 offen lds
    v_mfma_f32_32x32x16_bf16 v[16:31], v[84:87], v[176:179], v[16:31]
    s_waitcnt vmcnt(6)
    ds_read_b64_tr_b16 v[184:185], v246 offset:6144
    ds_read_b64_tr_b16 v[186:187], v246 offset:6656
    v_mfma_f32_32x32x16_bf16 v[32:47], v[80:83], v[180:183], v[32:47]
    ds_read_b64_tr_b16 v[188:189], v247 offset:6144
    ds_read_b64_tr_b16 v[190:191], v247 offset:6656
    v_mfma_f32_32x32x16_bf16 v[48:63], v[84:87], v[180:183], v[48:63]
    s_waitcnt lgkmcnt(0)
    v_mfma_f32_32x32x16_bf16 v[0:15], v[88:91], v[184:187], v[0:15]
    s_add_u32 m0, s34, 6144
    s_nop 0
    buffer_load_dwordx4 v228, s[4:7], s38 offen lds
    s_add_u32 m0, s34, 7168
    s_nop 0
    buffer_load_dwordx4 v229, s[4:7], s38 offen lds
    v_mfma_f32_32x32x16_bf16 v[16:31], v[92:95], v[184:187], v[16:31]
    s_waitcnt vmcnt(6)
    ds_read_b64_tr_b16 v[176:177], v246 offset:0
    ds_read_b64_tr_b16 v[178:179], v246 offset:512
    v_mfma_f32_32x32x16_bf16 v[32:47], v[88:91], v[188:191], v[32:47]
    ds_read_b64_tr_b16 v[180:181], v247 offset:0
    ds_read_b64_tr_b16 v[182:183], v247 offset:512
    v_mfma_f32_32x32x16_bf16 v[48:63], v[92:95], v[188:191], v[48:63]
    s_setprio 0
    v_mul_f32 v234, v0, v144
    v_mul_f32 v236, v8, v112
    s_nop 1
    v_mul_f32 v238, v16, v160
    s_nop 0
    v_mul_f32 v240, v24, v160
    v_fmac_f32 v234, v1, v145
    v_fmac_f32 v236, v9, v113
    v_fmac_f32 v238, v17, v161
    v_fmac_f32 v240, v25, v161
    v_fmac_f32 v234, v2, v146
    v_fmac_f32 v236, v10, v114
    v_fmac_f32 v238, v18, v162
    v_fmac_f32 v240, v26, v162
    v_fmac_f32 v234, v3, v147
    v_fmac_f32 v236, v11, v115
    v_fmac_f32 v238, v19, v163
    v_fmac_f32 v240, v27, v163
    v_fmac_f32 v234, v4, v148
    v_fmac_f32 v236, v12, v116
    v_fmac_f32 v238, v20, v164
    v_fmac_f32 v240, v28, v164
    v_fmac_f32 v234, v5, v149
    v_fmac_f32 v236, v13, v117
    v_fmac_f32 v238, v21, v165
    v_fmac_f32 v240, v29, v165
    v_fmac_f32 v234, v6, v150
    v_fmac_f32 v236, v14, v118
    v_fmac_f32 v238, v22, v166
    v_fmac_f32 v240, v30, v166
    v_fmac_f32 v234, v7, v151
    v_fmac_f32 v236, v15, v119
    v_fmac_f32 v238, v23, v167
    v_fmac_f32 v240, v31, v167
    v_mul_f32 v235, v32, v152
    v_mul_f32 v237, v40, v120
    v_mul_f32 v239, v48, v168
    v_mul_f32 v241, v56, v168
    v_fmac_f32 v235, v33, v153
    v_fmac_f32 v237, v41, v121
    v_fmac_f32 v239, v49, v169
    v_fmac_f32 v241, v57, v169
    v_fmac_f32 v235, v34, v154
    v_fmac_f32 v237, v42, v122
    v_fmac_f32 v239, v50, v170
    v_fmac_f32 v241, v58, v170
    v_fmac_f32 v235, v35, v155
    v_fmac_f32 v237, v43, v123
    v_fmac_f32 v239, v51, v171
    v_fmac_f32 v241, v59, v171
    v_fmac_f32 v235, v36, v156
    v_fmac_f32 v237, v44, v124
    v_fmac_f32 v239, v52, v172
    v_fmac_f32 v241, v60, v172
    v_fmac_f32 v235, v37, v157
    v_fmac_f32 v237, v45, v125
    v_fmac_f32 v239, v53, v173
    v_fmac_f32 v241, v61, v173
    v_fmac_f32 v235, v38, v158
    v_fmac_f32 v237, v46, v126
    v_fmac_f32 v239, v54, v174
    v_fmac_f32 v241, v62, v174
    v_fmac_f32 v235, v39, v159
    v_fmac_f32 v237, v47, v127
    v_fmac_f32 v239, v55, v175
    v_fmac_f32 v241, v63, v175
    v_permlane32_swap_b32 v234, v235
    v_add_f32 v234, v234, v235
    s_setprio 2
    s_waitcnt lgkmcnt(0)
    v_mfma_f32_32x32x16_bf16 v[0:15], v[64:67], v[176:179], 0
    s_add_u32 m0, s34, 0
    s_nop 0
    buffer_load_dwordx4 v222, s[4:7], s39 offen lds
    s_add_u32 m0, s34, 1024
    s_nop 0
    buffer_load_dwordx4 v223, s[4:7], s39 offen lds
    v_mfma_f32_32x32x16_bf16 v[16:31], v[68:71], v[176:179], 0
    s_waitcnt vmcnt(6)
    ds_read_b64_tr_b16 v[184:185], v246 offset:2048
    ds_read_b64_tr_b16 v[186:187], v246 offset:2560
    v_mfma_f32_32x32x16_bf16 v[32:47], v[64:67], v[180:183], 0
    ds_read_b64_tr_b16 v[188:189], v247 offset:2048
    ds_read_b64_tr_b16 v[190:191], v247 offset:2560
    v_mfma_f32_32x32x16_bf16 v[48:63], v[68:71], v[180:183], 0
    s_waitcnt lgkmcnt(0)
    v_mfma_f32_32x32x16_bf16 v[0:15], v[72:75], v[184:187], v[0:15]
    s_add_u32 m0, s34, 2048
    s_nop 0
    buffer_load_dwordx4 v224, s[4:7], s39 offen lds
    s_add_u32 m0, s34, 3072
    s_nop 0
    buffer_load_dwordx4 v225, s[4:7], s39 offen lds
    v_mfma_f32_32x32x16_bf16 v[16:31], v[76:79], v[184:187], v[16:31]
    s_waitcnt vmcnt(6)
    ds_read_b64_tr_b16 v[176:177], v246 offset:4096
    ds_read_b64_tr_b16 v[178:179], v246 offset:4608
    v_mfma_f32_32x32x16_bf16 v[32:47], v[72:75], v[188:191], v[32:47]
    ds_read_b64_tr_b16 v[180:181], v247 offset:4096
    ds_read_b64_tr_b16 v[182:183], v247 offset:4608
    v_mfma_f32_32x32x16_bf16 v[48:63], v[76:79], v[188:191], v[48:63]
    s_waitcnt lgkmcnt(0)
    v_mfma_f32_32x32x16_bf16 v[0:15], v[80:83], v[176:179], v[0:15]
    s_add_u32 m0, s34, 4096
    s_nop 0
    buffer_load_dwordx4 v226, s[4:7], s39 offen lds
    s_add_u32 m0, s34, 5120
    s_nop 0
    buffer_load_dwordx4 v227, s[4:7], s39 offen lds
    v_mfma_f32_32x32x16_bf16 v[16:31], v[84:87], v[176:179], v[16:31]
    s_waitcnt vmcnt(6)
    ds_read_b64_tr_b16 v[184:185], v246 offset:6144
    ds_read_b64_tr_b16 v[186:187], v246 offset:6656
    v_mfma_f32_32x32x16_bf16 v[32:47], v[80:83], v[180:183], v[32:47]
    ds_read_b64_tr_b16 v[188:189], v247 offset:6144
    ds_read_b64_tr_b16 v[190:191], v247 offset:6656
    v_mfma_f32_32x32x16_bf16 v[48:63], v[84:87], v[180:183], v[48:63]
    s_waitcnt lgkmcnt(0)
    v_mfma_f32_32x32x16_bf16 v[0:15], v[88:91], v[184:187], v[0:15]
    s_add_u32 m0, s34, 6144
    s_nop 0
    buffer_load_dwordx4 v228, s[4:7], s39 offen lds
    s_add_u32 m0, s34, 7168
    s_nop 0
    buffer_load_dwordx4 v229, s[4:7], s39 offen lds
    v_mfma_f32_32x32x16_bf16 v[16:31], v[92:95], v[184:187], v[16:31]
    s_waitcnt vmcnt(6)
    ds_read_b64_tr_b16 v[176:177], v246 offset:0
    ds_read_b64_tr_b16 v[178:179], v246 offset:512
    v_mfma_f32_32x32x16_bf16 v[32:47], v[88:91], v[188:191], v[32:47]
    ds_read_b64_tr_b16 v[180:181], v247 offset:0
    ds_read_b64_tr_b16 v[182:183], v247 offset:512
    v_mfma_f32_32x32x16_bf16 v[48:63], v[92:95], v[188:191], v[48:63]
    s_setprio 0
    v_mul_f32 v242, v0, v144
    v_fma_f32 v238, v8, v160, -v238
    s_nop 1
    v_fmac_f32 v236, v16, v112
    s_nop 0
    v_mul_f32 v244, v24, v160
    v_fmac_f32 v242, v1, v145
    v_fmac_f32 v238, v9, v161
    v_fmac_f32 v236, v17, v113
    v_fmac_f32 v244, v25, v161
    v_fmac_f32 v242, v2, v146
    v_fmac_f32 v238, v10, v162
    v_fmac_f32 v236, v18, v114
    v_fmac_f32 v244, v26, v162
    v_fmac_f32 v242, v3, v147
    v_fmac_f32 v238, v11, v163
    v_fmac_f32 v236, v19, v115
    v_fmac_f32 v244, v27, v163
    v_fmac_f32 v242, v4, v148
    v_fmac_f32 v238, v12, v164
    v_fmac_f32 v236, v20, v116
    v_fmac_f32 v244, v28, v164
    v_fmac_f32 v242, v5, v149
    v_fmac_f32 v238, v13, v165
    v_fmac_f32 v236, v21, v117
    v_fmac_f32 v244, v29, v165
    v_fmac_f32 v242, v6, v150
    v_fmac_f32 v238, v14, v166
    v_fmac_f32 v236, v22, v118
    v_fmac_f32 v244, v30, v166
    v_fmac_f32 v242, v7, v151
    v_fmac_f32 v238, v15, v167
    v_fmac_f32 v236, v23, v119
    v_fmac_f32 v244, v31, v167
    v_mul_f32 v243, v32, v152
    v_fma_f32 v239, v40, v168, -v239
    v_fmac_f32 v237, v48, v120
    v_mul_f32 v245, v56, v168
    v_fmac_f32 v243, v33, v153
    v_fmac_f32 v239, v41, v169
    v_fmac_f32 v237, v49, v121
    v_fmac_f32 v245, v57, v169
    v_fmac_f32 v243, v34, v154
    v_fmac_f32 v239, v42, v170
    v_fmac_f32 v237, v50, v122
    v_fmac_f32 v245, v58, v170
    v_fmac_f32 v243, v35, v155
    v_fmac_f32 v239, v43, v171
    v_fmac_f32 v237, v51, v123
    v_fmac_f32 v245, v59, v171
    v_fmac_f32 v243, v36, v156
    v_fmac_f32 v239, v44, v172
    v_fmac_f32 v237, v52, v124
    v_fmac_f32 v245, v60, v172
    v_fmac_f32 v243, v37, v157
    v_fmac_f32 v239, v45, v173
    v_fmac_f32 v237, v53, v125
    v_fmac_f32 v245, v61, v173
    v_fmac_f32 v243, v38, v158
    v_fmac_f32 v239, v46, v174
    v_fmac_f32 v237, v54, v126
    v_fmac_f32 v245, v62, v174
    v_fmac_f32 v243, v39, v159
    v_fmac_f32 v239, v47, v175
    v_fmac_f32 v237, v55, v127
    v_fmac_f32 v245, v63, v175
    v_permlane32_swap_b32 v242, v243
    v_permlane32_swap_b32 v238, v239
    v_add_f32 v242, v242, v243
    v_add_f32 v238, v238, v239
    s_cmp_lg_u32 s27, 0
    s_cbranch_scc1 K2_fl1_19
    s_set_gpr_idx_on s28, gpr_idx(DST)
    s_nop 0
    v_cvt_pk_bf16_f32 v194, v234, v242
    s_set_gpr_idx_off
    s_branch K2_fld_20
K2_fl1_19:
    v_add_u32 v254, s28, v252
    v_cvt_pk_bf16_f32 v234, v234, v242
    ds_write_b16 v254, v234 offset:384
    ds_write_b16_d16_hi v254, v234 offset:768
K2_fld_20:
    s_setprio 2
    s_waitcnt lgkmcnt(0)
    v_mfma_f32_32x32x16_bf16 v[0:15], v[64:67], v[176:179], 0
    v_mad_u32_u16 v222, v230, s44, v248
    v_mad_u32_u16 v223, v230, s44, v248 op_sel:[1,0,0,0]
    v_mad_u32_u16 v224, v231, s44, v248
    v_mad_u32_u16 v225, v231, s44, v248 op_sel:[1,0,0,0]
    v_mad_u32_u16 v226, v232, s44, v248
    v_mad_u32_u16 v227, v232, s44, v248 op_sel:[1,0,0,0]
    v_mad_u32_u16 v228, v233, s44, v248
    v_mad_u32_u16 v229, v233, s44, v248 op_sel:[1,0,0,0]
    s_add_u32 m0, s34, 0
    s_nop 0
    buffer_load_dwordx4 v222, s[4:7], s40 offen lds
    s_add_u32 m0, s34, 1024
    s_nop 0
    buffer_load_dwordx4 v223, s[4:7], s40 offen lds
    v_mfma_f32_32x32x16_bf16 v[16:31], v[68:71], v[176:179], 0
    s_waitcnt vmcnt(6)
    ds_read_b64_tr_b16 v[184:185], v246 offset:2048
    ds_read_b64_tr_b16 v[186:187], v246 offset:2560
    v_mfma_f32_32x32x16_bf16 v[32:47], v[64:67], v[180:183], 0
    ds_read_b64_tr_b16 v[188:189], v247 offset:2048
    ds_read_b64_tr_b16 v[190:191], v247 offset:2560
    v_mfma_f32_32x32x16_bf16 v[48:63], v[68:71], v[180:183], 0
    s_waitcnt lgkmcnt(0)
    v_mfma_f32_32x32x16_bf16 v[0:15], v[72:75], v[184:187], v[0:15]
    s_add_u32 m0, s34, 2048
    s_nop 0
    buffer_load_dwordx4 v224, s[4:7], s41 offen lds
    s_add_u32 m0, s34, 3072
    s_nop 0
    buffer_load_dwordx4 v225, s[4:7], s41 offen lds
    v_mfma_f32_32x32x16_bf16 v[16:31], v[76:79], v[184:187], v[16:31]
    s_waitcnt vmcnt(6)
    ds_read_b64_tr_b16 v[176:177], v246 offset:4096
    ds_read_b64_tr_b16 v[178:179], v246 offset:4608
    v_mfma_f32_32x32x16_bf16 v[32:47], v[72:75], v[188:191], v[32:47]
    ds_read_b64_tr_b16 v[180:181], v247 offset:4096
    ds_read_b64_tr_b16 v[182:183], v247 offset:4608
    v_mfma_f32_32x32x16_bf16 v[48:63], v[76:79], v[188:191], v[48:63]
    s_waitcnt lgkmcnt(0)
    v_mfma_f32_32x32x16_bf16 v[0:15], v[80:83], v[176:179], v[0:15]
    s_add_u32 m0, s34, 4096
    s_nop 0
    buffer_load_dwordx4 v226, s[4:7], s42 offen lds
    s_add_u32 m0, s34, 5120
    s_nop 0
    buffer_load_dwordx4 v227, s[4:7], s42 offen lds
    v_mfma_f32_32x32x16_bf16 v[16:31], v[84:87], v[176:179], v[16:31]
    s_waitcnt vmcnt(6)
    ds_read_b64_tr_b16 v[184:185], v246 offset:6144
    ds_read_b64_tr_b16 v[186:187], v246 offset:6656
    v_mfma_f32_32x32x16_bf16 v[32:47], v[80:83], v[180:183], v[32:47]
    ds_read_b64_tr_b16 v[188:189], v247 offset:6144
    ds_read_b64_tr_b16 v[190:191], v247 offset:6656
    v_mfma_f32_32x32x16_bf16 v[48:63], v[84:87], v[180:183], v[48:63]
    s_waitcnt lgkmcnt(0)
    v_mfma_f32_32x32x16_bf16 v[0:15], v[88:91], v[184:187], v[0:15]
    s_add_u32 m0, s34, 6144
    s_nop 0
    buffer_load_dwordx4 v228, s[4:7], s43 offen lds
    s_add_u32 m0, s34, 7168
    s_nop 0
    buffer_load_dwordx4 v229, s[4:7], s43 offen lds
    v_mfma_f32_32x32x16_bf16 v[16:31], v[92:95], v[184:187], v[16:31]
    s_waitcnt vmcnt(6)
    ds_read_b64_tr_b16 v[176:177], v246 offset:0
    ds_read_b64_tr_b16 v[178:179], v246 offset:512
    v_mfma_f32_32x32x16_bf16 v[32:47], v[88:91], v[188:191], v[32:47]
    ds_read_b64_tr_b16 v[180:181], v247 offset:0
    ds_read_b64_tr_b16 v[182:183], v247 offset:512
    v_mfma_f32_32x32x16_bf16 v[48:63], v[92:95], v[188:191], v[48:63]
    s_setprio 0
    v_mul_f32 v242, v0, v144
    v_fma_f32 v240, v8, v160, -v240
    s_nop 1
    v_fma_f32 v244, v16, v160, -v244
    s_nop 0
    v_fmac_f32 v236, v24, v112
    v_fmac_f32 v242, v1, v145
    v_fmac_f32 v240, v9, v161
    v_fmac_f32 v244, v17, v161
    v_fmac_f32 v236, v25, v113
    v_fmac_f32 v242, v2, v146
    v_fmac_f32 v240, v10, v162
    v_fmac_f32 v244, v18, v162
    v_fmac_f32 v236, v26, v114
    v_fmac_f32 v242, v3, v147
    v_fmac_f32 v240, v11, v163
    v_fmac_f32 v244, v19, v163
    v_fmac_f32 v236, v27, v115
    v_fmac_f32 v242, v4, v148
    v_fmac_f32 v240, v12, v164
    v_fmac_f32 v244, v20, v164
    v_fmac_f32 v236, v28, v116
    v_fmac_f32 v242, v5, v149
    v_fmac_f32 v240, v13, v165
    v_fmac_f32 v244, v21, v165
    v_fmac_f32 v236, v29, v117
    v_fmac_f32 v242, v6, v150
    v_fmac_f32 v240, v14, v166
    v_fmac_f32 v244, v22, v166
    v_fmac_f32 v236, v30, v118
    v_fmac_f32 v242, v7, v151
    v_fmac_f32 v240, v15, v167
    v_fmac_f32 v244, v23, v167
    v_fmac_f32 v236, v31, v119
    v_mul_f32 v243, v32, v152
    v_fma_f32 v241, v40, v168, -v241
    v_fma_f32 v245, v48, v168, -v245
    v_fmac_f32 v237, v56, v120
    v_fmac_f32 v243, v33, v153
    v_fmac_f32 v241, v41, v169
    v_fmac_f32 v245, v49, v169
    v_fmac_f32 v237, v57, v121
    v_fmac_f32 v243, v34, v154
    v_fmac_f32 v241, v42, v170
    v_fmac_f32 v245, v50, v170
    v_fmac_f32 v237, v58, v122
    v_fmac_f32 v243, v35, v155
    v_fmac_f32 v241, v43, v171
    v_fmac_f32 v245, v51, v171
    v_fmac_f32 v237, v59, v123
    v_fmac_f32 v243, v36, v156
    v_fmac_f32 v241, v44, v172
    v_fmac_f32 v245, v52, v172
    v_fmac_f32 v237, v60, v124
    v_fmac_f32 v243, v37, v157
    v_fmac_f32 v241, v45, v173
    v_fmac_f32 v245, v53, v173
    v_fmac_f32 v237, v61, v125
    v_fmac_f32 v243, v38, v158
    v_fmac_f32 v241, v46, v174
    v_fmac_f32 v245, v54, v174
    v_fmac_f32 v237, v62, v126
    v_fmac_f32 v243, v39, v159
    v_fmac_f32 v241, v47, v175
    v_fmac_f32 v245, v55, v175
    v_fmac_f32 v237, v63, v127
    v_permlane32_swap_b32 v242, v243
    s_nop 0
    v_permlane32_swap_b32 v236, v237
    v_permlane32_swap_b32 v240, v241
    v_permlane32_swap_b32 v244, v245
    v_add_f32 v242, v242, v243
    v_add_f32 v236, v236, v237
    v_add_f32 v240, -v240, -v241
    v_add_f32 v244, v244, v245
    s_cmp_lg_u32 s27, 0
    s_cbranch_scc1 K2_fl1_21
    s_set_gpr_idx_on s28, gpr_idx(DST)
    s_nop 0
    v_cvt_pk_bf16_f32 v195, v242, v236
    v_cvt_pk_bf16_f32 v196, v244, v240
    v_cvt_pk_bf16_f32 v197, v238, v238
    s_set_gpr_idx_off
    s_branch K2_fld_22
K2_fl1_21:
    v_add_u32 v254, s28, v252
    v_cvt_pk_bf16_f32 v242, v242, v236
    v_cvt_pk_bf16_f32 v244, v244, v240
    v_cvt_pk_bf16_f32 v238, v238, v238
    ds_write_b16 v254, v242 offset:1152
    ds_write_b16_d16_hi v254, v242 offset:128
    ds_write_b16 v254, v244 offset:512
    ds_write_b16_d16_hi v254, v244 offset:896
    ds_write_b16 v254, v238 offset:1280
K2_fld_22:
    s_branch K2_NEXT
K2_UNIT2:
    v_add_u32 v62, s25, v249
    v_add_u32 v63, s25, v250
    ds_read_b64_tr_b16 v[0:1], v62 offset:0
    ds_read_b64_tr_b16 v[2:3], v62 offset:128
    ds_read_b128 v[4:7], v63 offset:0
    ds_read_b128 v[8:11], v63 offset:16
    ds_read_b128 v[12:15], v63 offset:128
    ds_read_b128 v[16:19], v63 offset:144
    ds_read_b64_tr_b16 v[28:29], v62 offset:800
    ds_read_b64_tr_b16 v[30:31], v62 offset:928
    ds_read_b128 v[32:35], v63 offset:800
    ds_read_b128 v[36:39], v63 offset:816
    ds_read_b128 v[40:43], v63 offset:928
    ds_read_b128 v[44:47], v63 offset:944
    s_waitcnt lgkmcnt(10)
    v_lshlrev_b32 v20, 16, v0
    v_and_b32 v21, 0xffff0000, v0
    v_lshlrev_b32 v22, 16, v1
    v_and_b32 v23, 0xffff0000, v1
    v_lshlrev_b32 v24, 16, v2
    v_and_b32 v25, 0xffff0000, v2
    v_lshlrev_b32 v26, 16, v3
    v_and_b32 v27, 0xffff0000, v3
    s_waitcnt lgkmcnt(8)
    v_mul_f32 v4, v20, v4
    v_mul_f32 v5, v21, v5
    v_mul_f32 v6, v22, v6
    v_mul_f32 v7, v23, v7
    v_mul_f32 v8, v24, v8
    v_mul_f32 v9, v25, v9
    v_mul_f32 v10, v26, v10
    v_mul_f32 v11, v27, v11
    v_cvt_pk_bf16_f32 v64, v4, v5
    v_cvt_pk_bf16_f32 v65, v6, v7
    v_cvt_pk_bf16_f32 v66, v8, v9
    v_cvt_pk_bf16_f32 v67, v10, v11
    s_waitcnt lgkmcnt(6)
    v_mul_f32 v12, v20, v12
    v_mul_f32 v13, v21, v13
    v_mul_f32 v14, v22, v14
    v_mul_f32 v15, v23, v15
    v_mul_f32 v16, v24, v16
    v_mul_f32 v17, v25, v17
    v_mul_f32 v18, v26, v18
    v_mul_f32 v19, v27, v19
    v_cvt_pk_bf16_f32 v68, v12, v13
    v_cvt_pk_bf16_f32 v69, v14, v15
    v_cvt_pk_bf16_f32 v70, v16, v17
    v_cvt_pk_bf16_f32 v71, v18, v19
    s_waitcnt lgkmcnt(4)
    v_lshlrev_b32 v48, 16, v28
    v_and_b32 v49, 0xffff0000, v28
    v_lshlrev_b32 v50, 16, v29
    v_and_b32 v51, 0xffff0000, v29
    v_lshlrev_b32 v52, 16, v30
    v_and_b32 v53, 0xffff0000, v30
    v_lshlrev_b32 v54, 16, v31
    v_and_b32 v55, 0xffff0000, v31
    s_waitcnt lgkmcnt(2)
    v_mul_f32 v32, v48, v32
    v_mul_f32 v33, v49, v33
    v_mul_f32 v34, v50, v34
    v_mul_f32 v35, v51, v35
    v_mul_f32 v36, v52, v36
    v_mul_f32 v37, v53, v37
    v_mul_f32 v38, v54, v38
    v_mul_f32 v39, v55, v39
    v_cvt_pk_bf16_f32 v72, v32, v33
    v_cvt_pk_bf16_f32 v73, v34, v35
    v_cvt_pk_bf16_f32 v74, v36, v37
    v_cvt_pk_bf16_f32 v75, v38, v39
    s_waitcnt lgkmcnt(0)
    v_mul_f32 v40, v48, v40
    v_mul_f32 v41, v49, v41
    v_mul_f32 v42, v50, v42
    v_mul_f32 v43, v51, v43
    v_mul_f32 v44, v52, v44
    v_mul_f32 v45, v53, v45
    v_mul_f32 v46, v54, v46
    v_mul_f32 v47, v55, v47
    v_cvt_pk_bf16_f32 v76, v40, v41
    v_cvt_pk_bf16_f32 v77, v42, v43
    v_cvt_pk_bf16_f32 v78, v44, v45
    v_cvt_pk_bf16_f32 v79, v46, v47
    s_setprio 2
    s_waitcnt lgkmcnt(0)
    v_mfma_f32_32x32x16_bf16 v[0:15], v[64:67], v[176:179], 0
    s_add_u32 m0, s34, 0
    s_nop 0
    buffer_load_dwordx4 v222, s[4:7], s38 offen lds
    s_add_u32 m0, s34, 1024
    s_nop 0
    buffer_load_dwordx4 v223, s[4:7], s38 offen lds
    v_mfma_f32_32x32x16_bf16 v[16:31], v[68:71], v[176:179], 0
    s_waitcnt vmcnt(6)
    ds_read_b64_tr_b16 v[184:185], v246 offset:2048
    ds_read_b64_tr_b16 v[186:187], v246 offset:2560
    v_mfma_f32_32x32x16_bf16 v[32:47], v[64:67], v[180:183], 0
    ds_read_b64_tr_b16 v[188:189], v247 offset:2048
    ds_read_b64_tr_b16 v[190:191], v247 offset:2560
    v_mfma_f32_32x32x16_bf16 v[48:63], v[68:71], v[180:183], 0
    s_waitcnt lgkmcnt(0)
    v_mfma_f32_32x32x16_bf16 v[0:15], v[72:75], v[184:187], v[0:15]
    s_add_u32 m0, s34, 2048
    s_nop 0
    buffer_load_dwordx4 v224, s[4:7], s38 offen lds
    s_add_u32 m0, s34, 3072
    s_nop 0
    buffer_load_dwordx4 v225, s[4:7], s38 offen lds
    v_mfma_f32_32x32x16_bf16 v[16:31], v[76:79], v[184:187], v[16:31]
    s_waitcnt vmcnt(6)
    ds_read_b64_tr_b16 v[176:177], v246 offset:4096
    ds_read_b64_tr_b16 v[178:179], v246 offset:4608
    v_mfma_f32_32x32x16_bf16 v[32:47], v[72:75], v[188:191], v[32:47]
    ds_read_b64_tr_b16 v[180:181], v247 offset:4096
    ds_read_b64_tr_b16 v[182:183], v247 offset:4608
    v_mfma_f32_32x32x16_bf16 v[48:63], v[76:79], v[188:191], v[48:63]
    s_setprio 0
    s_add_u32 s35, s35, 1
    s_lshl_b32 s45, s35, 3
    s_add_u32 s45, s45, s16
    s_cmp_lt_u32 s45, s18
    s_cbranch_scc1 K2_cl_24
    s_mov_b32 s35, 8
    s_mov_b32 s45, -1
    v_mov_b32 v231, 162048
    v_mov_b32 v232, 1
    s_mov_b64 exec, 1
    ds_add_rtn_u32 v230, v231, v232
    s_mov_b64 exec, -1
K2_cl_24:
    v_mul_f32 v234, v0, v96
    v_mul_f32 v236, v8, v128
    v_mul_f32 v238, v16, v128
    v_mul_f32 v240, v24, v128
    v_fmac_f32 v234, v1, v97
    v_fmac_f32 v236, v9, v129
    v_fmac_f32 v238, v17, v129
    v_fmac_f32 v240, v25, v129
    v_fmac_f32 v234, v2, v98
    v_fmac_f32 v236, v10, v130
    v_fmac_f32 v238, v18, v130
    v_fmac_f32 v240, v26, v130
    v_fmac_f32 v234, v3, v99
    v_fmac_f32 v236, v11, v131
    v_fmac_f32 v238, v19, v131
    v_fmac_f32 v240, v27, v131
    v_fmac_f32 v234, v4, v100
    v_fmac_f32 v236, v12, v132
    v_fmac_f32 v238, v20, v132
    v_fmac_f32 v240, v28, v132
    v_fmac_f32 v234, v5, v101
    v_fmac_f32 v236, v13, v133
    v_fmac_f32 v238, v21, v133
    v_fmac_f32 v240, v29, v133
    v_fmac_f32 v234, v6, v102
    v_fmac_f32 v236, v14, v134
    v_fmac_f32 v238, v22, v134
    v_fmac_f32 v240, v30, v134
    v_fmac_f32 v234, v7, v103
    v_fmac_f32 v236, v15, v135
    v_fmac_f32 v238, v23, v135
    v_fmac_f32 v240, v31, v135
    v_mul_f32 v235, v32, v104
    v_mul_f32 v237, v40, v136
    v_mul_f32 v239, v48, v136
    v_mul_f32 v241, v56, v136
    v_fmac_f32 v235, v33, v105
    v_fmac_f32 v237, v41, v137
    v_fmac_f32 v239, v49, v137
    v_fmac_f32 v241, v57, v137
    v_fmac_f32 v235, v34, v106
    v_fmac_f32 v237, v42, v138
    v_fmac_f32 v239, v50, v138
    v_fmac_f32 v241, v58, v138
    v_fmac_f32 v235, v35, v107
    v_fmac_f32 v237, v43, v139
    v_fmac_f32 v239, v51, v139
    v_fmac_f32 v241, v59, v139
    v_fmac_f32 v235, v36, v108
    v_fmac_f32 v237, v44, v140
    v_fmac_f32 v239, v52, v140
    v_fmac_f32 v241, v60, v140
    v_fmac_f32 v235, v37, v109
    v_fmac_f32 v237, v45, v141
    v_fmac_f32 v239, v53, v141
    v_fmac_f32 v241, v61, v141
    v_fmac_f32 v235, v38, v110
    v_fmac_f32 v237, v46, v142
    v_fmac_f32 v239, v54, v142
    v_fmac_f32 v241, v62, v142
    v_fmac_f32 v235, v39, v111
    v_fmac_f32 v237, v47, v143
    v_fmac_f32 v239, v55, v143
    v_fmac_f32 v241, v63, v143
    v_permlane32_swap_b32 v234, v235
    v_permlane32_swap_b32 v236, v237
    v_permlane32_swap_b32 v238, v239
    v_permlane32_swap_b32 v240, v241
    v_add_f32 v234, v234, v235
    v_add_f32 v236, v236, v237
    v_add_f32 v238, v238, v239
    v_add_f32 v240, v240, v241
    s_cmp_lg_u32 s27, 0
    s_cbranch_scc1 K2_fl1_25
    s_set_gpr_idx_on s28, gpr_idx(DST)
    s_nop 0
    v_cvt_pk_bf16_f32 v192, v234, v236
    v_cvt_pk_bf16_f32 v193, v238, v240
    s_set_gpr_idx_off
    s_branch K2_fld_26
K2_fl1_25:
    v_add_u32 v254, s28, v252
    v_cvt_pk_bf16_f32 v234, v234, v236
    v_cvt_pk_bf16_f32 v238, v238, v240
    ds_write_b16 v254, v234 offset:0
    ds_write_b16_d16_hi v254, v234 offset:256
    ds_write_b16 v254, v238 offset:640
    ds_write_b16_d16_hi v254, v238 offset:1024
K2_fld_26:
    s_mov_b32 s31, 0
    s_mul_i32 s32, s35, 6
    s_mov_b32 s33, 1
    s_cmp_lg_u32 s45, -1
    s_cbranch_scc1 K2_st_27
    s_cmp_lg_u32 s27, 0
    s_cbranch_scc1 K2_nd_28
    s_mov_b64 exec, 1
    ds_add_u32 v231, v232 offset:8
    s_mov_b64 exec, -1
K2_nd_28:
    s_waitcnt lgkmcnt(0)
    v_readfirstlane_b32 s45, v230
    s_mov_b32 s31, 1
    s_cmp_lt_u32 s45, s18
    s_cselect_b32 s33, 1, 0
    s_cselect_b32 s45, s45, 63
K2_st_27:
    v_readlane_b32 s46, v253, s45
    s_nop 0
    s_and_b32 s29, s46, 0x3ffff
    s_bfe_u32 s30, s46, 0x30012
    s_cmp_eq_u32 s31, 0
    s_cbranch_scc1 K2_p1_29
    s_lshr_b32 s32, s46, 21
    s_add_u32 s32, s32, s29
K2_p1_29:
    s_lshl_b32 s47, s30, 3
    s_sub_u32 s47, s47, 8
    s_lshr_b32 s48, 0x4050e4, s47
    s_lshr_b32 s49, 0xe4244400, s47
    s_lshl_b32 s50, s31, 7
    s_mov_b32 s40, s50
    v_add_u32 v230, s29, v251
    s_bfe_u32 s51, s48, 0x20002
    s_lshl_b32 s51, s51, 8
    s_add_u32 s41, s51, s50
    s_bfe_u32 s51, s49, 0x20002
    s_mul_i32 s51, s51, 800
    s_add_u32 s51, s51, s29
    v_add_u32 v231, s51, v251
    s_bfe_u32 s51, s48, 0x20004
    s_lshl_b32 s51, s51, 8
    s_add_u32 s42, s51, s50
    s_bfe_u32 s51, s49, 0x20004
    s_mul_i32 s51, s51, 800
    s_add_u32 s51, s51, s29
    v_add_u32 v232, s51, v251
    s_bfe_u32 s51, s48, 0x20006
    s_lshl_b32 s51, s51, 8
    s_add_u32 s43, s51, s50
    s_bfe_u32 s51, s49, 0x20006
    s_mul_i32 s51, s51, 800
    s_add_u32 s51, s51, s29
    v_add_u32 v233, s51, v251
    ds_read_b32 v230, v230
    ds_read_b32 v231, v231
    ds_read_b32 v232, v232
    ds_read_b32 v233, v233
    s_setprio 2
    s_waitcnt lgkmcnt(4)
    v_mfma_f32_32x32x16_bf16 v[0:15], v[64:67], v[176:179], 0
    s_add_u32 m0, s34, 4096
    s_nop 0
    buffer_load_dwordx4 v222, s[4:7], s39 offen lds
    s_add_u32 m0, s34, 5120
    s_nop 0
    buffer_load_dwordx4 v223, s[4:7], s39 offen lds
    v_mfma_f32_32x32x16_bf16 v[16:31], v[68:71], v[176:179], 0
    s_waitcnt vmcnt(6)
    ds_read_b64_tr_b16 v[184:185], v246 offset:6144
    ds_read_b64_tr_b16 v[186:187], v246 offset:6656
    v_mfma_f32_32x32x16_bf16 v[32:47], v[64:67], v[180:183], 0
    ds_read_b64_tr_b16 v[188:189], v247 offset:6144
    ds_read_b64_tr_b16 v[190:191], v247 offset:6656
    v_mfma_f32_32x32x16_bf16 v[48:63], v[68:71], v[180:183], 0
    s_waitcnt lgkmcnt(0)
    v_mfma_f32_32x32x16_bf16 v[0:15], v[72:75], v[184:187], v[0:15]
    s_add_u32 m0, s34, 6144
    s_nop 0
    buffer_load_dwordx4 v224, s[4:7], s39 offen lds
    s_add_u32 m0, s34, 7168
    s_nop 0
    buffer_load_dwordx4 v225, s[4:7], s39 offen lds
    v_mfma_f32_32x32x16_bf16 v[16:31], v[76:79], v[184:187], v[16:31]
    s_waitcnt vmcnt(6)
    ds_read_b64_tr_b16 v[176:177], v246 offset:0
    ds_read_b64_tr_b16 v[178:179], v246 offset:512
    v_mfma_f32_32x32x16_bf16 v[32:47], v[72:75], v[188:191], v[32:47]
    ds_read_b64_tr_b16 v[180:181], v247 offset:0
    ds_read_b64_tr_b16 v[182:183], v247 offset:512
    v_mfma_f32_32x32x16_bf16 v[48:63], v[76:79], v[188:191], v[48:63]
    s_setprio 0
    v_mul_f32 v234, v0, v144
    v_mul_f32 v236, v8, v112
    s_nop 1
    v_mul_f32 v238, v16, v160
    v_mul_f32 v240, v24, v160
    v_fmac_f32 v234, v1, v145
    v_fmac_f32 v236, v9, v113
    v_fmac_f32 v238, v17, v161
    v_fmac_f32 v240, v25, v161
    v_fmac_f32 v234, v2, v146
    v_fmac_f32 v236, v10, v114
    v_fmac_f32 v238, v18, v162
    v_fmac_f32 v240, v26, v162
    v_fmac_f32 v234, v3, v147
    v_fmac_f32 v236, v11, v115
    v_fmac_f32 v238, v19, v163
    v_fmac_f32 v240, v27, v163
    v_fmac_f32 v234, v4, v148
    v_fmac_f32 v236, v12, v116
    v_fmac_f32 v238, v20, v164
    v_fmac_f32 v240, v28, v164
    v_fmac_f32 v234, v5, v149
    v_fmac_f32 v236, v13, v117
    v_fmac_f32 v238, v21, v165
    v_fmac_f32 v240, v29, v165
    v_fmac_f32 v234, v6, v150
    v_fmac_f32 v236, v14, v118
    v_fmac_f32 v238, v22, v166
    v_fmac_f32 v240, v30, v166
    v_fmac_f32 v234, v7, v151
    v_fmac_f32 v236, v15, v119
    v_fmac_f32 v238, v23, v167
    v_fmac_f32 v240, v31, v167
    v_mul_f32 v235, v32, v152
    v_mul_f32 v237, v40, v120
    v_mul_f32 v239, v48, v168
    v_mul_f32 v241, v56, v168
    v_fmac_f32 v235, v33, v153
    v_fmac_f32 v237, v41, v121
    v_fmac_f32 v239, v49, v169
    v_fmac_f32 v241, v57, v169
    v_fmac_f32 v235, v34, v154
    v_fmac_f32 v237, v42, v122
    v_fmac_f32 v239, v50, v170
    v_fmac_f32 v241, v58, v170
    v_fmac_f32 v235, v35, v155
    v_fmac_f32 v237, v43, v123
    v_fmac_f32 v239, v51, v171
    v_fmac_f32 v241, v59, v171
    v_fmac_f32 v235, v36, v156
    v_fmac_f32 v237, v44, v124
    v_fmac_f32 v239, v52, v172
    v_fmac_f32 v241, v60, v172
    v_fmac_f32 v235, v37, v157
    v_fmac_f32 v237, v45, v125
    v_fmac_f32 v239, v53, v173
    v_fmac_f32 v241, v61, v173
    v_fmac_f32 v235, v38, v158
    v_fmac_f32 v237, v46, v126
    v_fmac_f32 v239, v54, v174
    v_fmac_f32 v241, v62, v174
    v_fmac_f32 v235, v39, v159
    v_fmac_f32 v237, v47, v127
    v_fmac_f32 v239, v55, v175
    v_fmac_f32 v241, v63, v175
    v_permlane32_swap_b32 v234, v235
    v_add_f32 v234, v234, v235
    s_setprio 2
    s_waitcnt lgkmcnt(0)
    v_mfma_f32_32x32x16_bf16 v[0:15], v[64:67], v[176:179], 0
    v_mad_u32_u16 v222, v230, s44, v248
    v_mad_u32_u16 v223, v230, s44, v248 op_sel:[1,0,0,0]
    v_mad_u32_u16 v224, v231, s44, v248
    v_mad_u32_u16 v225, v231, s44, v248 op_sel:[1,0,0,0]
    v_mad_u32_u16 v226, v232, s44, v248
    v_mad_u32_u16 v227, v232, s44, v248 op_sel:[1,0,0,0]
    v_mad_u32_u16 v228, v233, s44, v248
    v_mad_u32_u16 v229, v233, s44, v248 op_sel:[1,0,0,0]
    s_add_u32 m0, s34, 0
    s_nop 0
    buffer_load_dwordx4 v222, s[4:7], s40 offen lds
    s_add_u32 m0, s34, 1024
    s_nop 0
    buffer_load_dwordx4 v223, s[4:7], s40 offen lds
    v_mfma_f32_32x32x16_bf16 v[16:31], v[68:71], v[176:179], 0
    s_waitcnt vmcnt(6)
    ds_read_b64_tr_b16 v[184:185], v246 offset:2048
    ds_read_b64_tr_b16 v[186:187], v246 offset:2560
    v_mfma_f32_32x32x16_bf16 v[32:47], v[64:67], v[180:183], 0
    ds_read_b64_tr_b16 v[188:189], v247 offset:2048
    ds_read_b64_tr_b16 v[190:191], v247 offset:2560
    v_mfma_f32_32x32x16_bf16 v[48:63], v[68:71], v[180:183], 0
    s_waitcnt lgkmcnt(0)
    v_mfma_f32_32x32x16_bf16 v[0:15], v[72:75], v[184:187], v[0:15]
    s_add_u32 m0, s34, 2048
    s_nop 0
    buffer_load_dwordx4 v224, s[4:7], s41 offen lds
    s_add_u32 m0, s34, 3072
    s_nop 0
    buffer_load_dwordx4 v225, s[4:7], s41 offen lds
    v_mfma_f32_32x32x16_bf16 v[16:31], v[76:79], v[184:187], v[16:31]
    s_waitcnt vmcnt(6)
    ds_read_b64_tr_b16 v[176:177], v246 offset:4096
    ds_read_b64_tr_b16 v[178:179], v246 offset:4608
    v_mfma_f32_32x32x16_bf16 v[32:47], v[72:75], v[188:191], v[32:47]
    ds_read_b64_tr_b16 v[180:181], v247 offset:4096
    ds_read_b64_tr_b16 v[182:183], v247 offset:4608
    v_mfma_f32_32x32x16_bf16 v[48:63], v[76:79], v[188:191], v[48:63]
    s_setprio 0
    v_mul_f32 v242, v0, v144
    v_fma_f32 v238, v8, v160, -v238
    s_nop 1
    v_fmac_f32 v236, v16, v112
    v_mul_f32 v244, v24, v160
    v_fmac_f32 v242, v1, v145
    v_fmac_f32 v238, v9, v161
    v_fmac_f32 v236, v17, v113
    v_fmac_f32 v244, v25, v161
    v_fmac_f32 v242, v2, v146
    v_fmac_f32 v238, v10, v162
    v_fmac_f32 v236, v18, v114
    v_fmac_f32 v244, v26, v162
    v_fmac_f32 v242, v3, v147
    v_fmac_f32 v238, v11, v163
    v_fmac_f32 v236, v19, v115
    v_fmac_f32 v244, v27, v163
    v_fmac_f32 v242, v4, v148
    v_fmac_f32 v238, v12, v164
    v_fmac_f32 v236, v20, v116
    v_fmac_f32 v244, v28, v164
    v_fmac_f32 v242, v5, v149
    v_fmac_f32 v238, v13, v165
    v_fmac_f32 v236, v21, v117
    v_fmac_f32 v244, v29, v165
    v_fmac_f32 v242, v6, v150
    v_fmac_f32 v238, v14, v166
    v_fmac_f32 v236, v22, v118
    v_fmac_f32 v244, v30, v166
    v_fmac_f32 v242, v7, v151
    v_fmac_f32 v238, v15, v167
    v_fmac_f32 v236, v23, v119
    v_fmac_f32 v244, v31, v167
    v_mul_f32 v243, v32, v152
    v_fma_f32 v239, v40, v168, -v239
    v_fmac_f32 v237, v48, v120
    v_mul_f32 v245, v56, v168
    v_fmac_f32 v243, v33, v153
    v_fmac_f32 v239, v41, v169
    v_fmac_f32 v237, v49, v121
    v_fmac_f32 v245, v57, v169
    v_fmac_f32 v243, v34, v154
    v_fmac_f32 v239, v42, v170
    v_fmac_f32 v237, v50, v122
    v_fmac_f32 v245, v58, v170
    v_fmac_f32 v243, v35, v155
    v_fmac_f32 v239, v43, v171
    v_fmac_f32 v237, v51, v123
    v_fmac_f32 v245, v59, v171
    v_fmac_f32 v243, v36, v156
    v_fmac_f32 v239, v44, v172
    v_fmac_f32 v237, v52, v124
    v_fmac_f32 v245, v60, v172
    v_fmac_f32 v243, v37, v157
    v_fmac_f32 v239, v45, v173
    v_fmac_f32 v237, v53, v125
    v_fmac_f32 v245, v61, v173
    v_fmac_f32 v243, v38, v158
    v_fmac_f32 v239, v46, v174
    v_fmac_f32 v237, v54, v126
    v_fmac_f32 v245, v62, v174
    v_fmac_f32 v243, v39, v159
    v_fmac_f32 v239, v47, v175
    v_fmac_f32 v237, v55, v127
    v_fmac_f32 v245, v63, v175
    v_permlane32_swap_b32 v242, v243
    v_permlane32_swap_b32 v238, v239
    v_add_f32 v242, v242, v243
    v_add_f32 v238, v238, v239
    s_cmp_lg_u32 s27, 0
    s_cbranch_scc1 K2_fl1_30
    s_set_gpr_idx_on s28, gpr_idx(DST)
    s_nop 0
    v_cvt_pk_bf16_f32 v194, v234, v242
    s_set_gpr_idx_off
    s_branch K2_fld_31
K2_fl1_30:
    v_add_u32 v254, s28, v252
    v_cvt_pk_bf16_f32 v234, v234, v242
    ds_write_b16 v254, v234 offset:384
    ds_write_b16_d16_hi v254, v234 offset:768
K2_fld_31:
    s_setprio 2
    s_waitcnt lgkmcnt(0)
    v_mfma_f32_32x32x16_bf16 v[0:15], v[64:67], v[176:179], 0
    s_add_u32 m0, s34, 4096
    s_nop 0
    buffer_load_dwordx4 v226, s[4:7], s42 offen lds
    s_add_u32 m0, s34, 5120
    s_nop 0
    buffer_load_dwordx4 v227, s[4:7], s42 offen lds
    v_mfma_f32_32x32x16_bf16 v[16:31], v[68:71], v[176:179], 0
    s_waitcnt vmcnt(6)
    ds_read_b64_tr_b16 v[184:185], v246 offset:6144
    ds_read_b64_tr_b16 v[186:187], v246 offset:6656
    v_mfma_f32_32x32x16_bf16 v[32:47], v[64:67], v[180:183], 0
    ds_read_b64_tr_b16 v[188:189], v247 offset:6144
    ds_read_b64_tr_b16 v[190:191], v247 offset:6656
    v_mfma_f32_32x32x16_bf16 v[48:63], v[68:71], v[180:183], 0
    s_waitcnt lgkmcnt(0)
    v_mfma_f32_32x32x16_bf16 v[0:15], v[72:75], v[184:187], v[0:15]
    s_add_u32 m0, s34, 6144
    s_nop 0
    buffer_load_dwordx4 v228, s[4:7], s43 offen lds
    s_add_u32 m0, s34, 7168
    s_nop 0
    buffer_load_dwordx4 v229, s[4:7], s43 offen lds
    v_mfma_f32_32x32x16_bf16 v[16:31], v[76:79], v[184:187], v[16:31]
    s_waitcnt vmcnt(6)
    ds_read_b64_tr_b16 v[176:177], v246 offset:0
    ds_read_b64_tr_b16 v[178:179], v246 offset:512
    v_mfma_f32_32x32x16_bf16 v[32:47], v[72:75], v[188:191], v[32:47]
    ds_read_b64_tr_b16 v[180:181], v247 offset:0
    ds_read_b64_tr_b16 v[182:183], v247 offset:512
    v_mfma_f32_32x32x16_bf16 v[48:63], v[76:79], v[188:191], v[48:63]
    s_setprio 0
    v_mul_f32 v242, v0, v144
    v_fma_f32 v240, v8, v160, -v240
    s_nop 1
    v_fma_f32 v244, v16, v160, -v244
    v_fmac_f32 v236, v24, v112
    v_fmac_f32 v242, v1, v145
    v_fmac_f32 v240, v9, v161
    v_fmac_f32 v244, v17, v161
    v_fmac_f32 v236, v25, v113
    v_fmac_f32 v242, v2, v146
    v_fmac_f32 v240, v10, v162
    v_fmac_f32 v244, v18, v162
    v_fmac_f32 v236, v26, v114
    v_fmac_f32 v242, v3, v147
    v_fmac_f32 v240, v11, v163
    v_fmac_f32 v244, v19, v163
    v_fmac_f32 v236, v27, v115
    v_fmac_f32 v242, v4, v148
    v_fmac_f32 v240, v12, v164
    v_fmac_f32 v244, v20, v164
    v_fmac_f32 v236, v28, v116
    v_fmac_f32 v242, v5, v149
    v_fmac_f32 v240, v13, v165
    v_fmac_f32 v244, v21, v165
    v_fmac_f32 v236, v29, v117
    v_fmac_f32 v242, v6, v150
    v_fmac_f32 v240, v14, v166
    v_fmac_f32 v244, v22, v166
    v_fmac_f32 v236, v30, v118
    v_fmac_f32 v242, v7, v151
    v_fmac_f32 v240, v15, v167
    v_fmac_f32 v244, v23, v167
    v_fmac_f32 v236, v31, v119
    v_mul_f32 v243, v32, v152
    v_fma_f32 v241, v40, v168, -v241
    v_fma_f32 v245, v48, v168, -v245
    v_fmac_f32 v237, v56, v120
    v_fmac_f32 v243, v33, v153
    v_fmac_f32 v241, v41, v169
    v_fmac_f32 v245, v49, v169
    v_fmac_f32 v237, v57, v121
    v_fmac_f32 v243, v34, v154
    v_fmac_f32 v241, v42, v170
    v_fmac_f32 v245, v50, v170
    v_fmac_f32 v237, v58, v122
    v_fmac_f32 v243, v35, v155
    v_fmac_f32 v241, v43, v171
    v_fmac_f32 v245, v51, v171
    v_fmac_f32 v237, v59, v123
    v_fmac_f32 v243, v36, v156
    v_fmac_f32 v241, v44, v172
    v_fmac_f32 v245, v52, v172
    v_fmac_f32 v237, v60, v124
    v_fmac_f32 v243, v37, v157
    v_fmac_f32 v241, v45, v173
    v_fmac_f32 v245, v53, v173
    v_fmac_f32 v237, v61, v125
    v_fmac_f32 v243, v38, v158
    v_fmac_f32 v241, v46, v174
    v_fmac_f32 v245, v54, v174
    v_fmac_f32 v237, v62, v126
    v_fmac_f32 v243, v39, v159
    v_fmac_f32 v241, v47, v175
    v_fmac_f32 v245, v55, v175
    v_fmac_f32 v237, v63, v127
    v_permlane32_swap_b32 v242, v243
    s_nop 0
    v_permlane32_swap_b32 v236, v237
    v_permlane32_swap_b32 v240, v241
    v_permlane32_swap_b32 v244, v245
    v_add_f32 v242, v242, v243
    v_add_f32 v236, v236, v237
    v_add_f32 v240, -v240, -v241
    v_add_f32 v244, v244, v245
    s_cmp_lg_u32 s27, 0
    s_cbranch_scc1 K2_fl1_32
    s_set_gpr_idx_on s28, gpr_idx(DST)
    s_nop 0
    v_cvt_pk_bf16_f32 v195, v242, v236
    v_cvt_pk_bf16_f32 v196, v244, v240
    v_cvt_pk_bf16_f32 v197, v238, v238
    s_set_gpr_idx_off
    s_branch K2_fld_33
K2_fl1_32:
    v_add_u32 v254, s28, v252
    v_cvt_pk_bf16_f32 v242, v242, v236
    v_cvt_pk_bf16_f32 v244, v244, v240
    v_cvt_pk_bf16_f32 v238, v238, v238
    ds_write_b16 v254, v242 offset:1152
    ds_write_b16_d16_hi v254, v242 offset:128
    ds_write_b16 v254, v244 offset:512
    ds_write_b16_d16_hi v254, v244 offset:896
    ds_write_b16 v254, v238 offset:1280
K2_fld_33:
    s_branch K2_NEXT
K2_UNIT3:
    v_add_u32 v62, s25, v249
    v_add_u32 v63, s25, v250
    ds_read_b64_tr_b16 v[0:1], v62 offset:0
    ds_read_b64_tr_b16 v[2:3], v62 offset:128
    ds_read_b128 v[4:7], v63 offset:0
    ds_read_b128 v[8:11], v63 offset:16
    ds_read_b128 v[12:15], v63 offset:128
    ds_read_b128 v[16:19], v63 offset:144
    ds_read_b64_tr_b16 v[28:29], v62 offset:800
    ds_read_b64_tr_b16 v[30:31], v62 offset:928
    ds_read_b128 v[32:35], v63 offset:800
    ds_read_b128 v[36:39], v63 offset:816
    ds_read_b128 v[40:43], v63 offset:928
    ds_read_b128 v[44:47], v63 offset:944
    s_waitcnt lgkmcnt(10)
    v_lshlrev_b32 v20, 16, v0
    v_and_b32 v21, 0xffff0000, v0
    v_lshlrev_b32 v22, 16, v1
    v_and_b32 v23, 0xffff0000, v1
    v_lshlrev_b32 v24, 16, v2
    v_and_b32 v25, 0xffff0000, v2
    v_lshlrev_b32 v26, 16, v3
    v_and_b32 v27, 0xffff0000, v3
    s_waitcnt lgkmcnt(8)
    v_mul_f32 v4, v20, v4
    v_mul_f32 v5, v21, v5
    v_mul_f32 v6, v22, v6
    v_mul_f32 v7, v23, v7
    v_mul_f32 v8, v24, v8
    v_mul_f32 v9, v25, v9
    v_mul_f32 v10, v26, v10
    v_mul_f32 v11, v27, v11
    v_cvt_pk_bf16_f32 v64, v4, v5
    v_cvt_pk_bf16_f32 v65, v6, v7
    v_cvt_pk_bf16_f32 v66, v8, v9
    v_cvt_pk_bf16_f32 v67, v10, v11
    s_waitcnt lgkmcnt(6)
    v_mul_f32 v12, v20, v12
    v_mul_f32 v13, v21, v13
    v_mul_f32 v14, v22, v14
    v_mul_f32 v15, v23, v15
    v_mul_f32 v16, v24, v16
    v_mul_f32 v17, v25, v17
    v_mul_f32 v18, v26, v18
    v_mul_f32 v19, v27, v19
    v_cvt_pk_bf16_f32 v68, v12, v13
    v_cvt_pk_bf16_f32 v69, v14, v15
    v_cvt_pk_bf16_f32 v70, v16, v17
    v_cvt_pk_bf16_f32 v71, v18, v19
    ds_read_b64_tr_b16 v[0:1], v62 offset:1600
    ds_read_b64_tr_b16 v[2:3], v62 offset:1728
    ds_read_b128 v[4:7], v63 offset:1600
    ds_read_b128 v[8:11], v63 offset:1616
    ds_read_b128 v[12:15], v63 offset:1728
    ds_read_b128 v[16:19], v63 offset:1744
    s_waitcnt lgkmcnt(10)
    v_lshlrev_b32 v48, 16, v28
    v_and_b32 v49, 0xffff0000, v28
    v_lshlrev_b32 v50, 16, v29
    v_and_b32 v51, 0xffff0000, v29
    v_lshlrev_b32 v52, 16, v30
    v_and_b32 v53, 0xffff0000, v30
    v_lshlrev_b32 v54, 16, v31
    v_and_b32 v55, 0xffff0000, v31
    s_waitcnt lgkmcnt(8)
    v_mul_f32 v32, v48, v32
    v_mul_f32 v33, v49, v33
    v_mul_f32 v34, v50, v34
    v_mul_f32 v35, v51, v35
    v_mul_f32 v36, v52, v36
    v_mul_f32 v37, v53, v37
    v_mul_f32 v38, v54, v38
    v_mul_f32 v39, v55, v39
    v_cvt_pk_bf16_f32 v72, v32, v33
    v_cvt_pk_bf16_f32 v73, v34, v35
    v_cvt_pk_bf16_f32 v74, v36, v37
    v_cvt_pk_bf16_f32 v75, v38, v39
    s_waitcnt lgkmcnt(6)
    v_mul_f32 v40, v48, v40
    v_mul_f32 v41, v49, v41
    v_mul_f32 v42, v50, v42
    v_mul_f32 v43, v51, v43
    v_mul_f32 v44, v52, v44
    v_mul_f32 v45, v53, v45
    v_mul_f32 v46, v54, v46
    v_mul_f32 v47, v55, v47
    v_cvt_pk_bf16_f32 v76, v40, v41
    v_cvt_pk_bf16_f32 v77, v42, v43
    v_cvt_pk_bf16_f32 v78, v44, v45
    v_cvt_pk_bf16_f32 v79, v46, v47
    s_waitcnt lgkmcnt(4)
    v_lshlrev_b32 v20, 16, v0
    v_and_b32 v21, 0xffff0000, v0
    v_lshlrev_b32 v22, 16, v1
    v_and_b32 v23, 0xffff0000, v1
    v_lshlrev_b32 v24, 16, v2
    v_and_b32 v25, 0xffff0000, v2
    v_lshlrev_b32 v26, 16, v3
    v_and_b32 v27, 0xffff0000, v3
    s_waitcnt lgkmcnt(2)
    v_mul_f32 v4, v20, v4
    v_mul_f32 v5, v21, v5
    v_mul_f32 v6, v22, v6
    v_mul_f32 v7, v23, v7
    v_mul_f32 v8, v24, v8
    v_mul_f32 v9, v25, v9
    v_mul_f32 v10, v26, v10
    v_mul_f32 v11, v27, v11
    v_cvt_pk_bf16_f32 v80, v4, v5
    v_cvt_pk_bf16_f32 v81, v6, v7
    v_cvt_pk_bf16_f32 v82, v8, v9
    v_cvt_pk_bf16_f32 v83, v10, v11
    s_waitcnt lgkmcnt(0)
    v_mul_f32 v12, v20, v12
    v_mul_f32 v13, v21, v13
    v_mul_f32 v14, v22, v14
    v_mul_f32 v15, v23, v15
    v_mul_f32 v16, v24, v16
    v_mul_f32 v17, v25, v17
    v_mul_f32 v18, v26, v18
    v_mul_f32 v19, v27, v19
    v_cvt_pk_bf16_f32 v84, v12, v13
    v_cvt_pk_bf16_f32 v85, v14, v15
    v_cvt_pk_bf16_f32 v86, v16, v17
    v_cvt_pk_bf16_f32 v87, v18, v19
    s_setprio 2
    s_waitcnt lgkmcnt(0)
    v_mfma_f32_32x32x16_bf16 v[0:15], v[64:67], v[176:179], 0
    s_add_u32 m0, s34, 0
    s_nop 0
    buffer_load_dwordx4 v224, s[4:7], s37 offen lds
    s_add_u32 m0, s34, 1024
    s_nop 0
    buffer_load_dwordx4 v225, s[4:7], s37 offen lds
    v_mfma_f32_32x32x16_bf16 v[16:31], v[68:71], v[176:179], 0
    s_waitcnt vmcnt(6)
    ds_read_b64_tr_b16 v[184:185], v246 offset:2048
    ds_read_b64_tr_b16 v[186:187], v246 offset:2560
    v_mfma_f32_32x32x16_bf16 v[32:47], v[64:67], v[180:183], 0
    ds_read_b64_tr_b16 v[188:189], v247 offset:2048
    ds_read_b64_tr_b16 v[190:191], v247 offset:2560
    v_mfma_f32_32x32x16_bf16 v[48:63], v[68:71], v[180:183], 0
    s_waitcnt lgkmcnt(0)
    v_mfma_f32_32x32x16_bf16 v[0:15], v[72:75], v[184:187], v[0:15]
    s_add_u32 m0, s34, 2048
    s_nop 0
    buffer_load_dwordx4 v226, s[4:7], s37 offen lds
    s_add_u32 m0, s34, 3072
    s_nop 0
    buffer_load_dwordx4 v227, s[4:7], s37 offen lds
    v_mfma_f32_32x32x16_bf16 v[16:31], v[76:79], v[184:187], v[16:31]
    s_waitcnt vmcnt(6)
    ds_read_b64_tr_b16 v[176:177], v246 offset:4096
    ds_read_b64_tr_b16 v[178:179], v246 offset:4608
    v_mfma_f32_32x32x16_bf16 v[32:47], v[72:75], v[188:191], v[32:47]
    ds_read_b64_tr_b16 v[180:181], v247 offset:4096
    ds_read_b64_tr_b16 v[182:183], v247 offset:4608
    v_mfma_f32_32x32x16_bf16 v[48:63], v[76:79], v[188:191], v[48:63]
    s_waitcnt lgkmcnt(0)
    v_mfma_f32_32x32x16_bf16 v[0:15], v[80:83], v[176:179], v[0:15]
    s_add_u32 m0, s34, 4096
    s_nop 0
    buffer_load_dwordx4 v222, s[4:7], s38 offen lds
    s_add_u32 m0, s34, 5120
    s_nop 0
    buffer_load_dwordx4 v223, s[4:7], s38 offen lds
    v_mfma_f32_32x32x16_bf16 v[16:31], v[84:87], v[176:179], v[16:31]
    s_waitcnt vmcnt(6)
    ds_read_b64_tr_b16 v[184:185], v246 offset:6144
    ds_read_b64_tr_b16 v[186:187], v246 offset:6656
    v_mfma_f32_32x32x16_bf16 v[32:47], v[80:83], v[180:183], v[32:47]
    ds_read_b64_tr_b16 v[188:189], v247 offset:6144
    ds_read_b64_tr_b16 v[190:191], v247 offset:6656
    v_mfma_f32_32x32x16_bf16 v[48:63], v[84:87], v[180:183], v[48:63]
    s_setprio 0
    s_add_u32 s35, s35, 1
    s_lshl_b32 s45, s35, 3
    s_add_u32 s45, s45, s16
    s_cmp_lt_u32 s45, s18
    s_cbranch_scc1 K2_cl_35
    s_mov_b32 s35, 8
    s_mov_b32 s45, -1
    v_mov_b32 v231, 162048
    v_mov_b32 v232, 1
    s_mov_b64 exec, 1
    ds_add_rtn_u32 v230, v231, v232
    s_mov_b64 exec, -1
K2_cl_35:
    v_mul_f32 v234, v0, v96
    v_mul_f32 v236, v8, v128
    v_mul_f32 v238, v16, v128
    v_mul_f32 v240, v24, v128
    v_fmac_f32 v234, v1, v97
    v_fmac_f32 v236, v9, v129
    v_fmac_f32 v238, v17, v129
    v_fmac_f32 v240, v25, v129
    v_fmac_f32 v234, v2, v98
    v_fmac_f32 v236, v10, v130
    v_fmac_f32 v238, v18, v130
    v_fmac_f32 v240, v26, v130
    v_fmac_f32 v234, v3, v99
    v_fmac_f32 v236, v11, v131
    v_fmac_f32 v238, v19, v131
    v_fmac_f32 v240, v27, v131
    v_fmac_f32 v234, v4, v100
    v_fmac_f32 v236, v12, v132
    v_fmac_f32 v238, v20, v132
    v_fmac_f32 v240, v28, v132
    v_fmac_f32 v234, v5, v101
    v_fmac_f32 v236, v13, v133
    v_fmac_f32 v238, v21, v133
    v_fmac_f32 v240, v29, v133
    v_fmac_f32 v234, v6, v102
    v_fmac_f32 v236, v14, v134
    v_fmac_f32 v238, v22, v134
    v_fmac_f32 v240, v30, v134
    v_fmac_f32 v234, v7, v103
    v_fmac_f32 v236, v15, v135
    v_fmac_f32 v238, v23, v135
    v_fmac_f32 v240, v31, v135
    v_mul_f32 v235, v32, v104
    v_mul_f32 v237, v40, v136
    v_mul_f32 v239, v48, v136
    v_mul_f32 v241, v56, v136
    v_fmac_f32 v235, v33, v105
    v_fmac_f32 v237, v41, v137
    v_fmac_f32 v239, v49, v137
    v_fmac_f32 v241, v57, v137
    v_fmac_f32 v235, v34, v106
    v_fmac_f32 v237, v42, v138
    v_fmac_f32 v239, v50, v138
    v_fmac_f32 v241, v58, v138
    v_fmac_f32 v235, v35, v107
    v_fmac_f32 v237, v43, v139
    v_fmac_f32 v239, v51, v139
    v_fmac_f32 v241, v59, v139
    v_fmac_f32 v235, v36, v108
    v_fmac_f32 v237, v44, v140
    v_fmac_f32 v239, v52, v140
    v_fmac_f32 v241, v60, v140
    v_fmac_f32 v235, v37, v109
    v_fmac_f32 v237, v45, v141
    v_fmac_f32 v239, v53, v141
    v_fmac_f32 v241, v61, v141
    v_fmac_f32 v235, v38, v110
    v_fmac_f32 v237, v46, v142
    v_fmac_f32 v239, v54, v142
    v_fmac_f32 v241, v62, v142
    v_fmac_f32 v235, v39, v111
    v_fmac_f32 v237, v47, v143
    v_fmac_f32 v239, v55, v143
    v_fmac_f32 v241, v63, v143
    v_permlane32_swap_b32 v234, v235
    v_permlane32_swap_b32 v236, v237
    v_permlane32_swap_b32 v238, v239
    v_permlane32_swap_b32 v240, v241
    v_add_f32 v234, v234, v235
    v_add_f32 v236, v236, v237
    v_add_f32 v238, v238, v239
    v_add_f32 v240, v240, v241
    s_cmp_lg_u32 s27, 0
    s_cbranch_scc1 K2_fl1_36
    s_set_gpr_idx_on s28, gpr_idx(DST)
    s_nop 0
    v_cvt_pk_bf16_f32 v192, v234, v236
    v_cvt_pk_bf16_f32 v193, v238, v240
    s_set_gpr_idx_off
    s_branch K2_fld_37
K2_fl1_36:
    v_add_u32 v254, s28, v252
    v_cvt_pk_bf16_f32 v234, v234, v236
    v_cvt_pk_bf16_f32 v238, v238, v240
    ds_write_b16 v254, v234 offset:0
    ds_write_b16_d16_hi v254, v234 offset:256
    ds_write_b16 v254, v238 offset:640
    ds_write_b16_d16_hi v254, v238 offset:1024
K2_fld_37:
    s_mov_b32 s31, 0
    s_mul_i32 s32, s35, 6
    s_mov_b32 s33, 1
    s_cmp_lg_u32 s45, -1
    s_cbranch_scc1 K2_st_38
    s_cmp_lg_u32 s27, 0
    s_cbranch_scc1 K2_nd_39
    s_mov_b64 exec, 1
    ds_add_u32 v231, v232 offset:8
    s_mov_b64 exec, -1
K2_nd_39:
    s_waitcnt lgkmcnt(0)
    v_readfirstlane_b32 s45, v230
    s_mov_b32 s31, 1
    s_cmp_lt_u32 s45, s18
    s_cselect_b32 s33, 1, 0
    s_cselect_b32 s45, s45, 63
K2_st_38:
    v_readlane_b32 s46, v253, s45
    s_nop 0
    s_and_b32 s29, s46, 0x3ffff
    s_bfe_u32 s30, s46, 0x30012
    s_cmp_eq_u32 s31, 0
    s_cbranch_scc1 K2_p1_40
    s_lshr_b32 s32, s46, 21
    s_add_u32 s32, s32, s29
K2_p1_40:
    s_lshl_b32 s47, s30, 3
    s_sub_u32 s47, s47, 8
    s_lshr_b32 s48, 0x4050e4, s47
    s_lshr_b32 s49, 0xe4244400, s47
    s_lshl_b32 s50, s31, 7
    s_mov_b32 s40, s50
    v_add_u32 v230, s29, v251
    s_bfe_u32 s51, s48, 0x20002
    s_lshl_b32 s51, s51, 8
    s_add_u32 s41, s51, s50
    s_bfe_u32 s51, s49, 0x20002
    s_mul_i32 s51, s51, 800
    s_add_u32 s51, s51, s29
    v_add_u32 v231, s51, v251
    s_bfe_u32 s51, s48, 0x20004
    s_lshl_b32 s51, s51, 8
    s_add_u32 s42, s51, s50
    s_bfe_u32 s51, s49, 0x20004
    s_mul_i32 s51, s51, 800
    s_add_u32 s51, s51, s29
    v_add_u32 v232, s51, v251
    s_bfe_u32 s51, s48, 0x20006
    s_lshl_b32 s51, s51, 8
    s_add_u32 s43, s51, s50
    s_bfe_u32 s51, s49, 0x20006
    s_mul_i32 s51, s51, 800
    s_add_u32 s51, s51, s29
    v_add_u32 v233, s51, v251
    ds_read_b32 v230, v230
    ds_read_b32 v231, v231
    ds_read_b32 v232, v232
    ds_read_b32 v233, v233
    s_setprio 2
    s_waitcnt lgkmcnt(4)
    v_mfma_f32_32x32x16_bf16 v[0:15], v[64:67], v[184:187], 0
    s_add_u32 m0, s34, 6144
    s_nop 0
    buffer_load_dwordx4 v224, s[4:7], s38 offen lds
    s_add_u32 m0, s34, 7168
    s_nop 0
    buffer_load_dwordx4 v225, s[4:7], s38 offen lds
    v_mfma_f32_32x32x16_bf16 v[16:31], v[68:71], v[184:187], 0
    s_waitcnt vmcnt(6)
    ds_read_b64_tr_b16 v[176:177], v246 offset:0
    ds_read_b64_tr_b16 v[178:179], v246 offset:512
    v_mfma_f32_32x32x16_bf16 v[32:47], v[64:67], v[188:191], 0
    ds_read_b64_tr_b16 v[180:181], v247 offset:0
    ds_read_b64_tr_b16 v[182:183], v247 offset:512
    v_mfma_f32_32x32x16_bf16 v[48:63], v[68:71], v[188:191], 0
    s_waitcnt lgkmcnt(0)
    v_mfma_f32_32x32x16_bf16 v[0:15], v[72:75], v[176:179], v[0:15]
    s_add_u32 m0, s34, 0
    s_nop 0
    buffer_load_dwordx4 v226, s[4:7], s38 offen lds
    s_add_u32 m0, s34, 1024
    s_nop 0
    buffer_load_dwordx4 v227, s[4:7], s38 offen lds
    v_mfma_f32_32x32x16_bf16 v[16:31], v[76:79], v[176:179], v[16:31]
    s_waitcnt vmcnt(6)
    ds_read_b64_tr_b16 v[184:185], v246 offset:2048
    ds_read_b64_tr_b16 v[186:187], v246 offset:2560
    v_mfma_f32_32x32x16_bf16 v[32:47], v[72:75], v[180:183], v[32:47]
    ds_read_b64_tr_b16 v[188:189], v247 offset:2048
    ds_read_b64_tr_b16 v[190:191], v247 offset:2560
    v_mfma_f32_32x32x16_bf16 v[48:63], v[76:79], v[180:183], v[48:63]
    s_waitcnt lgkmcnt(0)
    v_mfma_f32_32x32x16_bf16 v[0:15], v[80:83], v[184:187], v[0:15]
    s_add_u32 m0, s34, 2048
    s_nop 0
    buffer_load_dwordx4 v222, s[4:7], s39 offen lds
    s_add_u32 m0, s34, 3072
    s_nop 0
    buffer_load_dwordx4 v223, s[4:7], s39 offen lds
    v_mfma_f32_32x32x16_bf16 v[16:31], v[84:87], v[184:187], v[16:31]
    s_waitcnt vmcnt(6)
    ds_read_b64_tr_b16 v[176:177], v246 offset:4096
    ds_read_b64_tr_b16 v[178:179], v246 offset:4608
    v_mfma_f32_32x32x16_bf16 v[32:47], v[80:83], v[188:191], v[32:47]
    ds_read_b64_tr_b16 v[180:181], v247 offset:4096
    ds_read_b64_tr_b16 v[182:183], v247 offset:4608
    v_mfma_f32_32x32x16_bf16 v[48:63], v[84:87], v[188:191], v[48:63]
    s_setprio 0
    v_mul_f32 v234, v0, v144
    v_mul_f32 v236, v8, v112
    s_nop 1
    v_mul_f32 v238, v16, v160
    v_mul_f32 v240, v24, v160
    v_fmac_f32 v234, v1, v145
    v_fmac_f32 v236, v9, v113
    v_fmac_f32 v238, v17, v161
    v_fmac_f32 v240, v25, v161
    v_fmac_f32 v234, v2, v146
    v_fmac_f32 v236, v10, v114
    v_fmac_f32 v238, v18, v162
    v_fmac_f32 v240, v26, v162
    v_fmac_f32 v234, v3, v147
    v_fmac_f32 v236, v11, v115
    v_fmac_f32 v238, v19, v163
    v_fmac_f32 v240, v27, v163
    v_fmac_f32 v234, v4, v148
    v_fmac_f32 v236, v12, v116
    v_fmac_f32 v238, v20, v164
    v_fmac_f32 v240, v28, v164
    v_fmac_f32 v234, v5, v149
    v_fmac_f32 v236, v13, v117
    v_fmac_f32 v238, v21, v165
    v_fmac_f32 v240, v29, v165
    v_fmac_f32 v234, v6, v150
    v_fmac_f32 v236, v14, v118
    v_fmac_f32 v238, v22, v166
    v_fmac_f32 v240, v30, v166
    v_fmac_f32 v234, v7, v151
    v_fmac_f32 v236, v15, v119
    v_fmac_f32 v238, v23, v167
    v_fmac_f32 v240, v31, v167
    v_mul_f32 v235, v32, v152
    v_mul_f32 v237, v40, v120
    v_mul_f32 v239, v48, v168
    v_mul_f32 v241, v56, v168
    v_fmac_f32 v235, v33, v153
    v_fmac_f32 v237, v41, v121
    v_fmac_f32 v239, v49, v169
    v_fmac_f32 v241, v57, v169
    v_fmac_f32 v235, v34, v154
    v_fmac_f32 v237, v42, v122
    v_fmac_f32 v239, v50, v170
    v_fmac_f32 v241, v58, v170
    v_fmac_f32 v235, v35, v155
    v_fmac_f32 v237, v43, v123
    v_fmac_f32 v239, v51, v171
    v_fmac_f32 v241, v59, v171
    v_fmac_f32 v235, v36, v156
    v_fmac_f32 v237, v44, v124
    v_fmac_f32 v239, v52, v172
    v_fmac_f32 v241, v60, v172
    v_fmac_f32 v235, v37, v157
    v_fmac_f32 v237, v45, v125
    v_fmac_f32 v239, v53, v173
    v_fmac_f32 v241, v61, v173
    v_fmac_f32 v235, v38, v158
    v_fmac_f32 v237, v46, v126
    v_fmac_f32 v239, v54, v174
    v_fmac_f32 v241, v62, v174
    v_fmac_f32 v235, v39, v159
    v_fmac_f32 v237, v47, v127
    v_fmac_f32 v239, v55, v175
    v_fmac_f32 v241, v63, v175
    v_permlane32_swap_b32 v234, v235
    v_add_f32 v234, v234, v235
    s_setprio 2
    s_waitcnt lgkmcnt(0)
    v_mfma_f32_32x32x16_bf16 v[0:15], v[64:67], v[176:179], 0
    s_add_u32 m0, s34, 4096
    s_nop 0
    buffer_load_dwordx4 v224, s[4:7], s39 offen lds
    s_add_u32 m0, s34, 5120
    s_nop 0
    buffer_load_dwordx4 v225, s[4:7], s39 offen lds
    v_mfma_f32_32x32x16_bf16 v[16:31], v[68:71], v[176:179], 0
    s_waitcnt vmcnt(6)
    ds_read_b64_tr_b16 v[184:185], v246 offset:6144
    ds_read_b64_tr_b16 v[186:187], v246 offset:6656
    v_mfma_f32_32x32x16_bf16 v[32:47], v[64:67], v[180:183], 0
    ds_read_b64_tr_b16 v[188:189], v247 offset:6144
    ds_read_b64_tr_b16 v[190:191], v247 offset:6656
    v_mfma_f32_32x32x16_bf16 v[48:63], v[68:71], v[180:183], 0
    s_waitcnt lgkmcnt(0)
    v_mfma_f32_32x32x16_bf16 v[0:15], v[72:75], v[184:187], v[0:15]
    s_add_u32 m0, s34, 6144
    s_nop 0
    buffer_load_dwordx4 v226, s[4:7], s39 offen lds
    s_add_u32 m0, s34, 7168
    s_nop 0
    buffer_load_dwordx4 v227, s[4:7], s39 offen lds
    v_mfma_f32_32x32x16_bf16 v[16:31], v[76:79], v[184:187], v[16:31]
    s_waitcnt vmcnt(6)
    ds_read_b64_tr_b16 v[176:177], v246 offset:0
    ds_read_b64_tr_b16 v[178:179], v246 offset:512
    v_mfma_f32_32x32x16_bf16 v[32:47], v[72:75], v[188:191], v[32:47]
    ds_read_b64_tr_b16 v[180:181], v247 offset:0
    ds_read_b64_tr_b16 v[182:183], v247 offset:512
    v_mfma_f32_32x32x16_bf16 v[48:63], v[76:79], v[188:191], v[48:63]
    s_waitcnt lgkmcnt(0)
    v_mfma_f32_32x32x16_bf16 v[0:15], v[80:83], v[176:179], v[0:15]
    v_mad_u32_u16 v222, v230, s44, v248
    v_mad_u32_u16 v223, v230, s44, v248 op_sel:[1,0,0,0]
    v_mad_u32_u16 v224, v231, s44, v248
    v_mad_u32_u16 v225, v231, s44, v248 op_sel:[1,0,0,0]
    v_mad_u32_u16 v226, v232, s44, v248
    v_mad_u32_u16 v227, v232, s44, v248 op_sel:[1,0,0,0]
    v_mad_u32_u16 v228, v233, s44, v248
    v_mad_u32_u16 v229, v233, s44, v248 op_sel:[1,0,0,0]
    s_add_u32 m0, s34, 0
    s_nop 0
    buffer_load_dwordx4 v222, s[4:7], s40 offen lds
    s_add_u32 m0, s34, 1024
    s_nop 0
    buffer_load_dwordx4 v223, s[4:7], s40 offen lds
    v_mfma_f32_32x32x16_bf16 v[16:31], v[84:87], v[176:179], v[16:31]
    s_waitcnt vmcnt(6)
    ds_read_b64_tr_b16 v[184:185], v246 offset:2048
    ds_read_b64_tr_b16 v[186:187], v246 offset:2560
    v_mfma_f32_32x32x16_bf16 v[32:47], v[80:83], v[180:183], v[32:47]
    ds_read_b64_tr_b16 v[188:189], v247 offset:2048
    ds_read_b64_tr_b16 v[190:191], v247 offset:2560
    v_mfma_f32_32x32x16_bf16 v[48:63], v[84:87], v[180:183], v[48:63]
    s_setprio 0
    v_mul_f32 v242, v0, v144
    v_fma_f32 v238, v8, v160, -v238
    s_nop 1
    v_fmac_f32 v236, v16, v112
    s_nop 0
    v_mul_f32 v244, v24, v160
    v_fmac_f32 v242, v1, v145
    v_fmac_f32 v238, v9, v161
    v_fmac_f32 v236, v17, v113
    v_fmac_f32 v244, v25, v161
    v_fmac_f32 v242, v2, v146
    v_fmac_f32 v238, v10, v162
    v_fmac_f32 v236, v18, v114
    v_fmac_f32 v244, v26, v162
    v_fmac_f32 v242, v3, v147
    v_fmac_f32 v238, v11, v163
    v_fmac_f32 v236, v19, v115
    v_fmac_f32 v244, v27, v163
    v_fmac_f32 v242, v4, v148
    v_fmac_f32 v238, v12, v164
    v_fmac_f32 v236, v20, v116
    v_fmac_f32 v244, v28, v164
    v_fmac_f32 v242, v5, v149
    v_fmac_f32 v238, v13, v165
    v_fmac_f32 v236, v21, v117
    v_fmac_f32 v244, v29, v165
    v_fmac_f32 v242, v6, v150
    v_fmac_f32 v238, v14, v166
    v_fmac_f32 v236, v22, v118
    v_fmac_f32 v244, v30, v166
    v_fmac_f32 v242, v7, v151
    v_fmac_f32 v238, v15, v167
    v_fmac_f32 v236, v23, v119
    v_fmac_f32 v244, v31, v167
    v_mul_f32 v243, v32, v152
    v_fma_f32 v239, v40, v168, -v239
    v_fmac_f32 v237, v48, v120
    v_mul_f32 v245, v56, v168
    v_fmac_f32 v243, v33, v153
    v_fmac_f32 v239, v41, v169
    v_fmac_f32 v237, v49, v121
    v_fmac_f32 v245, v57, v169
    v_fmac_f32 v243, v34, v154
    v_fmac_f32 v239, v42, v170
    v_fmac_f32 v237, v50, v122
    v_fmac_f32 v245, v58, v170
    v_fmac_f32 v243, v35, v155
    v_fmac_f32 v239, v43, v171
    v_fmac_f32 v237, v51, v123
    v_fmac_f32 v245, v59, v171
    v_fmac_f32 v243, v36, v156
    v_fmac_f32 v239, v44, v172
    v_fmac_f32 v237, v52, v124
    v_fmac_f32 v245, v60, v172
    v_fmac_f32 v243, v37, v157
    v_fmac_f32 v239, v45, v173
    v_fmac_f32 v237, v53, v125
    v_fmac_f32 v245, v61, v173
    v_fmac_f32 v243, v38, v158
    v_fmac_f32 v239, v46, v174
    v_fmac_f32 v237, v54, v126
    v_fmac_f32 v245, v62, v174
    v_fmac_f32 v243, v39, v159
    v_fmac_f32 v239, v47, v175
    v_fmac_f32 v237, v55, v127
    v_fmac_f32 v245, v63, v175
    v_permlane32_swap_b32 v242, v243
    v_permlane32_swap_b32 v238, v239
    v_add_f32 v242, v242, v243
    v_add_f32 v238, v238, v239
    s_cmp_lg_u32 s27, 0
    s_cbranch_scc1 K2_fl1_41
    s_set_gpr_idx_on s28, gpr_idx(DST)
    s_nop 0
    v_cvt_pk_bf16_f32 v194, v234, v242
    s_set_gpr_idx_off
    s_branch K2_fld_42
K2_fl1_41:
    v_add_u32 v254, s28, v252
    v_cvt_pk_bf16_f32 v234, v234, v242
    ds_write_b16 v254, v234 offset:384
    ds_write_b16_d16_hi v254, v234 offset:768
K2_fld_42:
    s_setprio 2
    s_waitcnt lgkmcnt(0)
    v_mfma_f32_32x32x16_bf16 v[0:15], v[64:67], v[184:187], 0
    s_add_u32 m0, s34, 2048
    s_nop 0
    buffer_load_dwordx4 v224, s[4:7], s41 offen lds
    s_add_u32 m0, s34, 3072
    s_nop 0
    buffer_load_dwordx4 v225, s[4:7], s41 offen lds
    v_mfma_f32_32x32x16_bf16 v[16:31], v[68:71], v[184:187], 0
    s_waitcnt vmcnt(6)
    ds_read_b64_tr_b16 v[176:177], v246 offset:4096
    ds_read_b64_tr_b16 v[178:179], v246 offset:4608
    v_mfma_f32_32x32x16_bf16 v[32:47], v[64:67], v[188:191], 0
    ds_read_b64_tr_b16 v[180:181], v247 offset:4096
    ds_read_b64_tr_b16 v[182:183], v247 offset:4608
    v_mfma_f32_32x32x16_bf16 v[48:63], v[68:71], v[188:191], 0
    s_waitcnt lgkmcnt(0)
    v_mfma_f32_32x32x16_bf16 v[0:15], v[72:75], v[176:179], v[0:15]
    s_add_u32 m0, s34, 4096
    s_nop 0
    buffer_load_dwordx4 v226, s[4:7], s42 offen lds
    s_add_u32 m0, s34, 5120
    s_nop 0
    buffer_load_dwordx4 v227, s[4:7], s42 offen lds
    v_mfma_f32_32x32x16_bf16 v[16:31], v[76:79], v[176:179], v[16:31]
    s_waitcnt vmcnt(6)
    ds_read_b64_tr_b16 v[184:185], v246 offset:6144
    ds_read_b64_tr_b16 v[186:187], v246 offset:6656
    v_mfma_f32_32x32x16_bf16 v[32:47], v[72:75], v[180:183], v[32:47]
    ds_read_b64_tr_b16 v[188:189], v247 offset:6144
    ds_read_b64_tr_b16 v[190:191], v247 offset:6656
    v_mfma_f32_32x32x16_bf16 v[48:63], v[76:79], v[180:183], v[48:63]
    s_waitcnt lgkmcnt(0)
    v_mfma_f32_32x32x16_bf16 v[0:15], v[80:83], v[184:187], v[0:15]
    s_add_u32 m0, s34, 6144
    s_nop 0
    buffer_load_dwordx4 v228, s[4:7], s43 offen lds
    s_add_u32 m0, s34, 7168
    s_nop 0
    buffer_load_dwordx4 v229, s[4:7], s43 offen lds
    v_mfma_f32_32x32x16_bf16 v[16:31], v[84:87], v[184:187], v[16:31]
    s_waitcnt vmcnt(6)
    ds_read_b64_tr_b16 v[176:177], v246 offset:0
    ds_read_b64_tr_b16 v[178:179], v246 offset:512
    v_mfma_f32_32x32x16_bf16 v[32:47], v[80:83], v[188:191], v[32:47]
    ds_read_b64_tr_b16 v[180:181], v247 offset:0
    ds_read_b64_tr_b16 v[182:183], v247 offset:512
    v_mfma_f32_32x32x16_bf16 v[48:63], v[84:87], v[188:191], v[48:63]
    s_setprio 0
    v_mul_f32 v242, v0, v144
    v_fma_f32 v240, v8, v160, -v240
    s_nop 1
    v_fma_f32 v244, v16, v160, -v244
    s_nop 0
    v_fmac_f32 v236, v24, v112
    v_fmac_f32 v242, v1, v145
    v_fmac_f32 v240, v9, v161
    v_fmac_f32 v244, v17, v161
    v_fmac_f32 v236, v25, v113
    v_fmac_f32 v242, v2, v146
    v_fmac_f32 v240, v10, v162
    v_fmac_f32 v244, v18, v162
    v_fmac_f32 v236, v26, v114
    v_fmac_f32 v242, v3, v147
    v_fmac_f32 v240, v11, v163
    v_fmac_f32 v244, v19, v163
    v_fmac_f32 v236, v27, v115
    v_fmac_f32 v242, v4, v148
    v_fmac_f32 v240, v12, v164
    v_fmac_f32 v244, v20, v164
    v_fmac_f32 v236, v28, v116
    v_fmac_f32 v242, v5, v149
    v_fmac_f32 v240, v13, v165
    v_fmac_f32 v244, v21, v165
    v_fmac_f32 v236, v29, v117
    v_fmac_f32 v242, v6, v150
    v_fmac_f32 v240, v14, v166
    v_fmac_f32 v244, v22, v166
    v_fmac_f32 v236, v30, v118
    v_fmac_f32 v242, v7, v151
    v_fmac_f32 v240, v15, v167
    v_fmac_f32 v244, v23, v167
    v_fmac_f32 v236, v31, v119
    v_mul_f32 v243, v32, v152
    v_fma_f32 v241, v40, v168, -v241
    v_fma_f32 v245, v48, v168, -v245
    v_fmac_f32 v237, v56, v120
    v_fmac_f32 v243, v33, v153
    v_fmac_f32 v241, v41, v169
    v_fmac_f32 v245, v49, v169
    v_fmac_f32 v237, v57, v121
    v_fmac_f32 v243, v34, v154
    v_fmac_f32 v241, v42, v170
    v_fmac_f32 v245, v50, v170
    v_fmac_f32 v237, v58, v122
    v_fmac_f32 v243, v35, v155
    v_fmac_f32 v241, v43, v171
    v_fmac_f32 v245, v51, v171
    v_fmac_f32 v237, v59, v123
    v_fmac_f32 v243, v36, v156
    v_fmac_f32 v241, v44, v172
    v_fmac_f32 v245, v52, v172
    v_fmac_f32 v237, v60, v124
    v_fmac_f32 v243, v37, v157
    v_fmac_f32 v241, v45, v173
    v_fmac_f32 v245, v53, v173
    v_fmac_f32 v237, v61, v125
    v_fmac_f32 v243, v38, v158
    v_fmac_f32 v241, v46, v174
    v_fmac_f32 v245, v54, v174
    v_fmac_f32 v237, v62, v126
    v_fmac_f32 v243, v39, v159
    v_fmac_f32 v241, v47, v175
    v_fmac_f32 v245, v55, v175
    v_fmac_f32 v237, v63, v127
    v_permlane32_swap_b32 v242, v243
    s_nop 0
    v_permlane32_swap_b32 v236, v237
    v_permlane32_swap_b32 v240, v241
    v_permlane32_swap_b32 v244, v245
    v_add_f32 v242, v242, v243
    v_add_f32 v236, v236, v237
    v_add_f32 v240, -v240, -v241
    v_add_f32 v244, v244, v245
    s_cmp_lg_u32 s27, 0
    s_cbranch_scc1 K2_fl1_43
    s_set_gpr_idx_on s28, gpr_idx(DST)
    s_nop 0
    v_cvt_pk_bf16_f32 v195, v242, v236
    v_cvt_pk_bf16_f32 v196, v244, v240
    v_cvt_pk_bf16_f32 v197, v238, v238
    s_set_gpr_idx_off
    s_branch K2_fld_44
K2_fl1_43:
    v_add_u32 v254, s28, v252
    v_cvt_pk_bf16_f32 v242, v242, v236
    v_cvt_pk_bf16_f32 v244, v244, v240
    v_cvt_pk_bf16_f32 v238, v238, v238
    ds_write_b16 v254, v242 offset:1152
    ds_write_b16_d16_hi v254, v242 offset:128
    ds_write_b16 v254, v244 offset:512
    ds_write_b16_d16_hi v254, v244 offset:896
    ds_write_b16 v254, v238 offset:1280
K2_fld_44:
    s_branch K2_NEXT
K2_UNIT1:
    s_add_u32 s35, s35, 1
    s_lshl_b32 s45, s35, 3
    s_add_u32 s45, s45, s16
    s_cmp_lt_u32 s45, s18
    s_cbranch_scc1 K2_cl_46
    s_mov_b32 s35, 8
    s_mov_b32 s45, -1
    v_mov_b32 v231, 162048
    v_mov_b32 v232, 1
    s_mov_b64 exec, 1
    ds_add_rtn_u32 v230, v231, v232
    s_mov_b64 exec, -1
K2_cl_46:
    v_add_u32 v62, s25, v249
    v_add_u32 v63, s25, v250
    ds_read_b64_tr_b16 v[0:1], v62 offset:0
    ds_read_b64_tr_b16 v[2:3], v62 offset:128
    ds_read_b128 v[4:7], v63 offset:0
    ds_read_b128 v[8:11], v63 offset:16
    ds_read_b128 v[12:15], v63 offset:128
    ds_read_b128 v[16:19], v63 offset:144
    s_waitcnt lgkmcnt(4)
    v_lshlrev_b32 v20, 16, v0
    v_and_b32 v21, 0xffff0000, v0
    v_lshlrev_b32 v22, 16, v1
    v_and_b32 v23, 0xffff0000, v1
    v_lshlrev_b32 v24, 16, v2
    v_and_b32 v25, 0xffff0000, v2
    v_lshlrev_b32 v26, 16, v3
    v_and_b32 v27, 0xffff0000, v3
    s_waitcnt lgkmcnt(2)
    v_mul_f32 v4, v20, v4
    v_mul_f32 v5, v21, v5
    v_mul_f32 v6, v22, v6
    v_mul_f32 v7, v23, v7
    v_mul_f32 v8, v24, v8
    v_mul_f32 v9, v25, v9
    v_mul_f32 v10, v26, v10
    v_mul_f32 v11, v27, v11
    v_cvt_pk_bf16_f32 v64, v4, v5
    v_cvt_pk_bf16_f32 v65, v6, v7
    v_cvt_pk_bf16_f32 v66, v8, v9
    v_cvt_pk_bf16_f32 v67, v10, v11
    s_waitcnt lgkmcnt(0)
    v_mul_f32 v12, v20, v12
    v_mul_f32 v13, v21, v13
    v_mul_f32 v14, v22, v14
    v_mul_f32 v15, v23, v15
    v_mul_f32 v16, v24, v16
    v_mul_f32 v17, v25, v17
    v_mul_f32 v18, v26, v18
    v_mul_f32 v19, v27, v19
    v_cvt_pk_bf16_f32 v68, v12, v13
    v_cvt_pk_bf16_f32 v69, v14, v15
    v_cvt_pk_bf16_f32 v70, v16, v17
    v_cvt_pk_bf16_f32 v71, v18, v19
    s_mov_b32 s31, 0
    s_mul_i32 s32, s35, 6
    s_mov_b32 s33, 1
    s_cmp_lg_u32 s45, -1
    s_cbranch_scc1 K2_st_47
    s_cmp_lg_u32 s27, 0
    s_cbranch_scc1 K2_nd_48
    s_mov_b64 exec, 1
    ds_add_u32 v231, v232 offset:8
    s_mov_b64 exec, -1
K2_nd_48:
    s_waitcnt lgkmcnt(0)
    v_readfirstlane_b32 s45, v230
    s_mov_b32 s31, 1
    s_cmp_lt_u32 s45, s18
    s_cselect_b32 s33, 1, 0
    s_cselect_b32 s45, s45, 63
K2_st_47:
    v_readlane_b32 s46, v253, s45
    s_nop 0
    s_and_b32 s29, s46, 0x3ffff
    s_bfe_u32 s30, s46, 0x30012
    s_cmp_eq_u32 s31, 0
    s_cbranch_scc1 K2_p1_49
    s_lshr_b32 s32, s46, 21
    s_add_u32 s32, s32, s29
K2_p1_49:
    s_lshl_b32 s47, s30, 3
    s_sub_u32 s47, s47, 8
    s_lshr_b32 s48, 0x4050e4, s47
    s_lshr_b32 s49, 0xe4244400, s47
    s_lshl_b32 s50, s31, 7
    s_mov_b32 s40, s50
    v_add_u32 v230, s29, v251
    s_bfe_u32 s51, s48, 0x20002
    s_lshl_b32 s51, s51, 8
    s_add_u32 s41, s51, s50
    s_bfe_u32 s51, s49, 0x20002
    s_mul_i32 s51, s51, 800
    s_add_u32 s51, s51, s29
    v_add_u32 v231, s51, v251
    s_bfe_u32 s51, s48, 0x20004
    s_lshl_b32 s51, s51, 8
    s_add_u32 s42, s51, s50
    s_bfe_u32 s51, s49, 0x20004
    s_mul_i32 s51, s51, 800
    s_add_u32 s51, s51, s29
    v_add_u32 v232, s51, v251
    s_bfe_u32 s51, s48, 0x20006
    s_lshl_b32 s51, s51, 8
    s_add_u32 s43, s51, s50
    s_bfe_u32 s51, s49, 0x20006
    s_mul_i32 s51, s51, 800
    s_add_u32 s51, s51, s29
    v_add_u32 v233, s51, v251
    ds_read_b32 v230, v230
    ds_read_b32 v231, v231
    ds_read_b32 v232, v232
    ds_read_b32 v233, v233
    s_setprio 2
    s_waitcnt lgkmcnt(0)
    v_mfma_f32_32x32x16_bf16 v[0:15], v[64:67], v[176:179], 0
    v_mad_u32_u16 v222, v230, s44, v248
    v_mad_u32_u16 v223, v230, s44, v248 op_sel:[1,0,0,0]
    v_mad_u32_u16 v224, v231, s44, v248
    v_mad_u32_u16 v225, v231, s44, v248 op_sel:[1,0,0,0]
    v_mad_u32_u16 v226, v232, s44, v248
    v_mad_u32_u16 v227, v232, s44, v248 op_sel:[1,0,0,0]
    v_mad_u32_u16 v228, v233, s44, v248
    v_mad_u32_u16 v229, v233, s44, v248 op_sel:[1,0,0,0]
    s_add_u32 m0, s34, 0
    s_nop 0
    buffer_load_dwordx4 v222, s[4:7], s40 offen lds
    s_add_u32 m0, s34, 1024
    s_nop 0
    buffer_load_dwordx4 v223, s[4:7], s40 offen lds
    v_mfma_f32_32x32x16_bf16 v[16:31], v[68:71], v[176:179], 0
    s_waitcnt vmcnt(6)
    ds_read_b64_tr_b16 v[184:185], v246 offset:2048
    ds_read_b64_tr_b16 v[186:187], v246 offset:2560
    v_mfma_f32_32x32x16_bf16 v[32:47], v[64:67], v[180:183], 0
    ds_read_b64_tr_b16 v[188:189], v247 offset:2048
    ds_read_b64_tr_b16 v[190:191], v247 offset:2560
    v_mfma_f32_32x32x16_bf16 v[48:63], v[68:71], v[180:183], 0
    s_setprio 0
    v_mul_f32 v234, v0, v96
    v_mul_f32 v236, v8, v128
    s_nop 1
    v_mul_f32 v238, v16, v128
    s_nop 0
    v_mul_f32 v240, v24, v128
    v_fmac_f32 v234, v1, v97
    v_fmac_f32 v236, v9, v129
    v_fmac_f32 v238, v17, v129
    v_fmac_f32 v240, v25, v129
    v_fmac_f32 v234, v2, v98
    v_fmac_f32 v236, v10, v130
    v_fmac_f32 v238, v18, v130
    v_fmac_f32 v240, v26, v130
    v_fmac_f32 v234, v3, v99
    v_fmac_f32 v236, v11, v131
    v_fmac_f32 v238, v19, v131
    v_fmac_f32 v240, v27, v131
    v_fmac_f32 v234, v4, v100
    v_fmac_f32 v236, v12, v132
    v_fmac_f32 v238, v20, v132
    v_fmac_f32 v240, v28, v132
    v_fmac_f32 v234, v5, v101
    v_fmac_f32 v236, v13, v133
    v_fmac_f32 v238, v21, v133
    v_fmac_f32 v240, v29, v133
    v_fmac_f32 v234, v6, v102
    v_fmac_f32 v236, v14, v134
    v_fmac_f32 v238, v22, v134
    v_fmac_f32 v240, v30, v134
    v_fmac_f32 v234, v7, v103
    v_fmac_f32 v236, v15, v135
    v_fmac_f32 v238, v23, v135
    v_fmac_f32 v240, v31, v135
    v_mul_f32 v235, v32, v104
    v_mul_f32 v237, v40, v136
    v_mul_f32 v239, v48, v136
    v_mul_f32 v241, v56, v136
    v_fmac_f32 v235, v33, v105
    v_fmac_f32 v237, v41, v137
    v_fmac_f32 v239, v49, v137
    v_fmac_f32 v241, v57, v137
    v_fmac_f32 v235, v34, v106
    v_fmac_f32 v237, v42, v138
    v_fmac_f32 v239, v50, v138
    v_fmac_f32 v241, v58, v138
    v_fmac_f32 v235, v35, v107
    v_fmac_f32 v237, v43, v139
    v_fmac_f32 v239, v51, v139
    v_fmac_f32 v241, v59, v139
    v_fmac_f32 v235, v36, v108
    v_fmac_f32 v237, v44, v140
    v_fmac_f32 v239, v52, v140
    v_fmac_f32 v241, v60, v140
    v_fmac_f32 v235, v37, v109
    v_fmac_f32 v237, v45, v141
    v_fmac_f32 v239, v53, v141
    v_fmac_f32 v241, v61, v141
    v_fmac_f32 v235, v38, v110
    v_fmac_f32 v237, v46, v142
    v_fmac_f32 v239, v54, v142
    v_fmac_f32 v241, v62, v142
    v_fmac_f32 v235, v39, v111
    v_fmac_f32 v237, v47, v143
    v_fmac_f32 v239, v55, v143
    v_fmac_f32 v241, v63, v143
    v_permlane32_swap_b32 v234, v235
    v_permlane32_swap_b32 v236, v237
    v_permlane32_swap_b32 v238, v239
    v_permlane32_swap_b32 v240, v241
    v_add_f32 v234, v234, v235
    v_add_f32 v236, v236, v237
    v_add_f32 v238, v238, v239
    v_add_f32 v240, v240, v241
    s_cmp_lg_u32 s27, 0
    s_cbranch_scc1 K2_fl1_50
    s_set_gpr_idx_on s28, gpr_idx(DST)
    s_nop 0
    v_cvt_pk_bf16_f32 v192, v234, v236
    v_cvt_pk_bf16_f32 v193, v238, v240
    s_set_gpr_idx_off
    s_branch K2_fld_51
K2_fl1_50:
    v_add_u32 v254, s28, v252
    v_cvt_pk_bf16_f32 v234, v234, v236
    v_cvt_pk_bf16_f32 v238, v238, v240
    ds_write_b16 v254, v234 offset:0
    ds_write_b16_d16_hi v254, v234 offset:256
    ds_write_b16 v254, v238 offset:640
    ds_write_b16_d16_hi v254, v238 offset:1024
K2_fld_51:
    s_setprio 2
    s_waitcnt lgkmcnt(0)
    v_mfma_f32_32x32x16_bf16 v[0:15], v[64:67], v[184:187], 0
    s_add_u32 m0, s34, 2048
    s_nop 0
    buffer_load_dwordx4 v224, s[4:7], s41 offen lds
    s_add_u32 m0, s34, 3072
    s_nop 0
    buffer_load_dwordx4 v225, s[4:7], s41 offen lds
    v_mfma_f32_32x32x16_bf16 v[16:31], v[68:71], v[184:187], 0
    s_waitcnt vmcnt(6)
    ds_read_b64_tr_b16 v[176:177], v246 offset:4096
    ds_read_b64_tr_b16 v[178:179], v246 offset:4608
    v_mfma_f32_32x32x16_bf16 v[32:47], v[64:67], v[188:191], 0
    ds_read_b64_tr_b16 v[180:181], v247 offset:4096
    ds_read_b64_tr_b16 v[182:183], v247 offset:4608
    v_mfma_f32_32x32x16_bf16 v[48:63], v[68:71], v[188:191], 0
    s_setprio 0
    v_mul_f32 v234, v0, v144
    v_mul_f32 v236, v8, v112
    s_nop 1
    v_mul_f32 v238, v16, v160
    s_nop 0
    v_mul_f32 v240, v24, v160
    v_fmac_f32 v234, v1, v145
    v_fmac_f32 v236, v9, v113
    v_fmac_f32 v238, v17, v161
    v_fmac_f32 v240, v25, v161
    v_fmac_f32 v234, v2, v146
    v_fmac_f32 v236, v10, v114
    v_fmac_f32 v238, v18, v162
    v_fmac_f32 v240, v26, v162
    v_fmac_f32 v234, v3, v147
    v_fmac_f32 v236, v11, v115
    v_fmac_f32 v238, v19, v163
    v_fmac_f32 v240, v27, v163
    v_fmac_f32 v234, v4, v148
    v_fmac_f32 v236, v12, v116
    v_fmac_f32 v238, v20, v164
    v_fmac_f32 v240, v28, v164
    v_fmac_f32 v234, v5, v149
    v_fmac_f32 v236, v13, v117
    v_fmac_f32 v238, v21, v165
    v_fmac_f32 v240, v29, v165
    v_fmac_f32 v234, v6, v150
    v_fmac_f32 v236, v14, v118
    v_fmac_f32 v238, v22, v166
    v_fmac_f32 v240, v30, v166
    v_fmac_f32 v234, v7, v151
    v_fmac_f32 v236, v15, v119
    v_fmac_f32 v238, v23, v167
    v_fmac_f32 v240, v31, v167
    v_mul_f32 v235, v32, v152
    v_mul_f32 v237, v40, v120
    v_mul_f32 v239, v48, v168
    v_mul_f32 v241, v56, v168
    v_fmac_f32 v235, v33, v153
    v_fmac_f32 v237, v41, v121
    v_fmac_f32 v239, v49, v169
    v_fmac_f32 v241, v57, v169
    v_fmac_f32 v235, v34, v154
    v_fmac_f32 v237, v42, v122
    v_fmac_f32 v239, v50, v170
    v_fmac_f32 v241, v58, v170
    v_fmac_f32 v235, v35, v155
    v_fmac_f32 v237, v43, v123
    v_fmac_f32 v239, v51, v171
    v_fmac_f32 v241, v59, v171
    v_fmac_f32 v235, v36, v156
    v_fmac_f32 v237, v44, v124
    v_fmac_f32 v239, v52, v172
    v_fmac_f32 v241, v60, v172
    v_fmac_f32 v235, v37, v157
    v_fmac_f32 v237, v45, v125
    v_fmac_f32 v239, v53, v173
    v_fmac_f32 v241, v61, v173
    v_fmac_f32 v235, v38, v158
    v_fmac_f32 v237, v46, v126
    v_fmac_f32 v239, v54, v174
    v_fmac_f32 v241, v62, v174
    v_fmac_f32 v235, v39, v159
    v_fmac_f32 v237, v47, v127
    v_fmac_f32 v239, v55, v175
    v_fmac_f32 v241, v63, v175
    v_permlane32_swap_b32 v234, v235
    v_add_f32 v234, v234, v235
    s_setprio 2
    s_waitcnt lgkmcnt(0)
    v_mfma_f32_32x32x16_bf16 v[0:15], v[64:67], v[176:179], 0
    s_add_u32 m0, s34, 4096
    s_nop 0
    buffer_load_dwordx4 v226, s[4:7], s42 offen lds
    s_add_u32 m0, s34, 5120
    s_nop 0
    buffer_load_dwordx4 v227, s[4:7], s42 offen lds
    v_mfma_f32_32x32x16_bf16 v[16:31], v[68:71], v[176:179], 0
    s_waitcnt vmcnt(6)
    ds_read_b64_tr_b16 v[184:185], v246 offset:6144
    ds_read_b64_tr_b16 v[186:187], v246 offset:6656
    v_mfma_f32_32x32x16_bf16 v[32:47], v[64:67], v[180:183], 0
    ds_read_b64_tr_b16 v[188:189], v247 offset:6144
    ds_read_b64_tr_b16 v[190:191], v247 offset:6656
    v_mfma_f32_32x32x16_bf16 v[48:63], v[68:71], v[180:183], 0
    s_setprio 0
    v_mul_f32 v242, v0, v144
    v_fma_f32 v238, v8, v160, -v238
    s_nop 1
    v_fmac_f32 v236, v16, v112
    s_nop 0
    v_mul_f32 v244, v24, v160
    v_fmac_f32 v242, v1, v145
    v_fmac_f32 v238, v9, v161
    v_fmac_f32 v236, v17, v113
    v_fmac_f32 v244, v25, v161
    v_fmac_f32 v242, v2, v146
    v_fmac_f32 v238, v10, v162
    v_fmac_f32 v236, v18, v114
    v_fmac_f32 v244, v26, v162
    v_fmac_f32 v242, v3, v147
    v_fmac_f32 v238, v11, v163
    v_fmac_f32 v236, v19, v115
    v_fmac_f32 v244, v27, v163
    v_fmac_f32 v242, v4, v148
    v_fmac_f32 v238, v12, v164
    v_fmac_f32 v236, v20, v116
    v_fmac_f32 v244, v28, v164
    v_fmac_f32 v242, v5, v149
    v_fmac_f32 v238, v13, v165
    v_fmac_f32 v236, v21, v117
    v_fmac_f32 v244, v29, v165
    v_fmac_f32 v242, v6, v150
    v_fmac_f32 v238, v14, v166
    v_fmac_f32 v236, v22, v118
    v_fmac_f32 v244, v30, v166
    v_fmac_f32 v242, v7, v151
    v_fmac_f32 v238, v15, v167
    v_fmac_f32 v236, v23, v119
    v_fmac_f32 v244, v31, v167
    v_mul_f32 v243, v32, v152
    v_fma_f32 v239, v40, v168, -v239
    v_fmac_f32 v237, v48, v120
    v_mul_f32 v245, v56, v168
    v_fmac_f32 v243, v33, v153
    v_fmac_f32 v239, v41, v169
    v_fmac_f32 v237, v49, v121
    v_fmac_f32 v245, v57, v169
    v_fmac_f32 v243, v34, v154
    v_fmac_f32 v239, v42, v170
    v_fmac_f32 v237, v50, v122
    v_fmac_f32 v245, v58, v170
    v_fmac_f32 v243, v35, v155
    v_fmac_f32 v239, v43, v171
    v_fmac_f32 v237, v51, v123
    v_fmac_f32 v245, v59, v171
    v_fmac_f32 v243, v36, v156
    v_fmac_f32 v239, v44, v172
    v_fmac_f32 v237, v52, v124
    v_fmac_f32 v245, v60, v172
    v_fmac_f32 v243, v37, v157
    v_fmac_f32 v239, v45, v173
    v_fmac_f32 v237, v53, v125
    v_fmac_f32 v245, v61, v173
    v_fmac_f32 v243, v38, v158
    v_fmac_f32 v239, v46, v174
    v_fmac_f32 v237, v54, v126
    v_fmac_f32 v245, v62, v174
    v_fmac_f32 v243, v39, v159
    v_fmac_f32 v239, v47, v175
    v_fmac_f32 v237, v55, v127
    v_fmac_f32 v245, v63, v175
    v_permlane32_swap_b32 v242, v243
    v_permlane32_swap_b32 v238, v239
    v_add_f32 v242, v242, v243
    v_add_f32 v238, v238, v239
    s_cmp_lg_u32 s27, 0
    s_cbranch_scc1 K2_fl1_52
    s_set_gpr_idx_on s28, gpr_idx(DST)
    s_nop 0
    v_cvt_pk_bf16_f32 v194, v234, v242
    s_set_gpr_idx_off
    s_branch K2_fld_53
K2_fl1_52:
    v_add_u32 v254, s28, v252
    v_cvt_pk_bf16_f32 v234, v234, v242
    ds_write_b16 v254, v234 offset:384
    ds_write_b16_d16_hi v254, v234 offset:768
K2_fld_53:
    s_setprio 2
    s_waitcnt lgkmcnt(0)
    v_mfma_f32_32x32x16_bf16 v[0:15], v[64:67], v[184:187], 0
    s_add_u32 m0, s34, 6144
    s_nop 0
    buffer_load_dwordx4 v228, s[4:7], s43 offen lds
    s_add_u32 m0, s34, 7168
    s_nop 0
    buffer_load_dwordx4 v229, s[4:7], s43 offen lds
    v_mfma_f32_32x32x16_bf16 v[16:31], v[68:71], v[184:187], 0
    s_waitcnt vmcnt(6)
    ds_read_b64_tr_b16 v[176:177], v246 offset:0
    ds_read_b64_tr_b16 v[178:179], v246 offset:512
    v_mfma_f32_32x32x16_bf16 v[32:47], v[64:67], v[188:191], 0
    ds_read_b64_tr_b16 v[180:181], v247 offset:0
    ds_read_b64_tr_b16 v[182:183], v247 offset:512
    v_mfma_f32_32x32x16_bf16 v[48:63], v[68:71], v[188:191], 0
    s_setprio 0
    v_mul_f32 v242, v0, v144
    v_fma_f32 v240, v8, v160, -v240
    s_nop 1
    v_fma_f32 v244, v16, v160, -v244
    v_fmac_f32 v236, v24, v112
    v_fmac_f32 v242, v1, v145
    v_fmac_f32 v240, v9, v161
    v_fmac_f32 v244, v17, v161
    v_fmac_f32 v236, v25, v113
    v_fmac_f32 v242, v2, v146
    v_fmac_f32 v240, v10, v162
    v_fmac_f32 v244, v18, v162
    v_fmac_f32 v236, v26, v114
    v_fmac_f32 v242, v3, v147
    v_fmac_f32 v240, v11, v163
    v_fmac_f32 v244, v19, v163
    v_fmac_f32 v236, v27, v115
    v_fmac_f32 v242, v4, v148
    v_fmac_f32 v240, v12, v164
    v_fmac_f32 v244, v20, v164
    v_fmac_f32 v236, v28, v116
    v_fmac_f32 v242, v5, v149
    v_fmac_f32 v240, v13, v165
    v_fmac_f32 v244, v21, v165
    v_fmac_f32 v236, v29, v117
    v_fmac_f32 v242, v6, v150
    v_fmac_f32 v240, v14, v166
    v_fmac_f32 v244, v22, v166
    v_fmac_f32 v236, v30, v118
    v_fmac_f32 v242, v7, v151
    v_fmac_f32 v240, v15, v167
    v_fmac_f32 v244, v23, v167
    v_fmac_f32 v236, v31, v119
    v_mul_f32 v243, v32, v152
    v_fma_f32 v241, v40, v168, -v241
    v_fma_f32 v245, v48, v168, -v245
    v_fmac_f32 v237, v56, v120
    v_fmac_f32 v243, v33, v153
    v_fmac_f32 v241, v41, v169
    v_fmac_f32 v245, v49, v169
    v_fmac_f32 v237, v57, v121
    v_fmac_f32 v243, v34, v154
    v_fmac_f32 v241, v42, v170
    v_fmac_f32 v245, v50, v170
    v_fmac_f32 v237, v58, v122
    v_fmac_f32 v243, v35, v155
    v_fmac_f32 v241, v43, v171
    v_fmac_f32 v245, v51, v171
    v_fmac_f32 v237, v59, v123
    v_fmac_f32 v243, v36, v156
    v_fmac_f32 v241, v44, v172
    v_fmac_f32 v245, v52, v172
    v_fmac_f32 v237, v60, v124
    v_fmac_f32 v243, v37, v157
    v_fmac_f32 v241, v45, v173
    v_fmac_f32 v245, v53, v173
    v_fmac_f32 v237, v61, v125
    v_fmac_f32 v243, v38, v158
    v_fmac_f32 v241, v46, v174
    v_fmac_f32 v245, v54, v174
    v_fmac_f32 v237, v62, v126
    v_fmac_f32 v243, v39, v159
    v_fmac_f32 v241, v47, v175
    v_fmac_f32 v245, v55, v175
    v_fmac_f32 v237, v63, v127
    v_permlane32_swap_b32 v242, v243
    s_nop 0
    v_permlane32_swap_b32 v236, v237
    v_permlane32_swap_b32 v240, v241
    v_permlane32_swap_b32 v244, v245
    v_add_f32 v242, v242, v243
    v_add_f32 v236, v236, v237
    v_add_f32 v240, -v240, -v241
    v_add_f32 v244, v244, v245
    s_cmp_lg_u32 s27, 0
    s_cbranch_scc1 K2_fl1_54
    s_set_gpr_idx_on s28, gpr_idx(DST)
    s_nop 0
    v_cvt_pk_bf16_f32 v195, v242, v236
    v_cvt_pk_bf16_f32 v196, v244, v240
    v_cvt_pk_bf16_f32 v197, v238, v238
    s_set_gpr_idx_off
    s_branch K2_fld_55
K2_fl1_54:
    v_add_u32 v254, s28, v252
    v_cvt_pk_bf16_f32 v242, v242, v236
    v_cvt_pk_bf16_f32 v244, v244, v240
    v_cvt_pk_bf16_f32 v238, v238, v238
    ds_write_b16 v254, v242 offset:1152
    ds_write_b16_d16_hi v254, v242 offset:128
    ds_write_b16 v254, v244 offset:512
    ds_write_b16_d16_hi v254, v244 offset:896
    ds_write_b16 v254, v238 offset:1280
K2_fld_55:
    s_branch K2_NEXT
K2_TAIL:
    v_lshlrev_b32 v0, 3, v252
    s_mul_i32 s45, s16, 20480
    s_add_u32 s45, s45, 15990784
    s_waitcnt vmcnt(0) lgkmcnt(0)
    buffer_load_dwordx4 v[96:99], v0, s[8:11], s45 offen offset:0
    buffer_load_dwordx4 v[100:103], v0, s[8:11], s45 offen offset:1024
    buffer_load_dwordx4 v[104:107], v0, s[8:11], s45 offen offset:2048
    buffer_load_dwordx4 v[108:111], v0, s[8:11], s45 offen offset:3072
    s_add_u32 s45, s45, 4096
    buffer_load_dwordx4 v[112:115], v0, s[8:11], s45 offen offset:0
    buffer_load_dwordx4 v[116:119], v0, s[8:11], s45 offen offset:1024
    buffer_load_dwordx4 v[120:123], v0, s[8:11], s45 offen offset:2048
    buffer_load_dwordx4 v[124:127], v0, s[8:11], s45 offen offset:3072
    s_add_u32 s45, s45, 4096
    buffer_load_dwordx4 v[128:131], v0, s[8:11], s45 offen offset:0
    buffer_load_dwordx4 v[132:135], v0, s[8:11], s45 offen offset:1024
    buffer_load_dwordx4 v[136:139], v0, s[8:11], s45 offen offset:2048
    buffer_load_dwordx4 v[140:143], v0, s[8:11], s45 offen offset:3072
    s_add_u32 s45, s45, 4096
    buffer_load_dwordx4 v[144:147], v0, s[8:11], s45 offen offset:0
    buffer_load_dwordx4 v[148:151], v0, s[8:11], s45 offen offset:1024
    buffer_load_dwordx4 v[152:155], v0, s[8:11], s45 offen offset:2048
    buffer_load_dwordx4 v[156:159], v0, s[8:11], s45 offen offset:3072
    s_add_u32 s45, s45, 4096
    buffer_load_dwordx4 v[160:163], v0, s[8:11], s45 offen offset:0
    buffer_load_dwordx4 v[164:167], v0, s[8:11], s45 offen offset:1024
    buffer_load_dwordx4 v[168:171], v0, s[8:11], s45 offen offset:2048
    buffer_load_dwordx4 v[172:175], v0, s[8:11], s45 offen offset:3072
    s_lshl_b32 s46, s16, 5
    s_add_u32 s46, s46, s34
    v_add_u32 v1, s46, v252
    ds_write_b16 v1, v192 offset:0
    ds_write_b16_d16_hi v1, v192 offset:256
    ds_write_b16 v1, v193 offset:640
    ds_write_b16_d16_hi v1, v193 offset:1024
    ds_write_b16 v1, v194 offset:384
    ds_write_b16_d16_hi v1, v194 offset:768
    ds_write_b16 v1, v195 offset:1152
    ds_write_b16_d16_hi v1, v195 offset:128
    ds_write_b16 v1, v196 offset:512
    ds_write_b16_d16_hi v1, v196 offset:896
    ds_write_b16 v1, v197 offset:1280
    s_waitcnt lgkmcnt(4)
    ds_write_b16 v1, v198 offset:1536
    ds_write_b16_d16_hi v1, v198 offset:1792
    ds_write_b16 v1, v199 offset:2176
    ds_write_b16_d16_hi v1, v199 offset:2560
    ds_write_b16 v1, v200 offset:1920
    ds_write_b16_d16_hi v1, v200 offset:2304
    ds_write_b16 v1, v201 offset:2688
    ds_write_b16_d16_hi v1, v201 offset:1664
    ds_write_b16 v1, v202 offset:2048
    ds_write_b16_d16_hi v1, v202 offset:2432
    ds_write_b16 v1, v203 offset:2816
    s_waitcnt lgkmcnt(4)
    ds_write_b16 v1, v204 offset:3072
    ds_write_b16_d16_hi v1, v204 offset:3328
    ds_write_b16 v1, v205 offset:3712
    ds_write_b16_d16_hi v1, v205 offset:4096
    ds_write_b16 v1, v206 offset:3456
    ds_write_b16_d16_hi v1, v206 offset:3840
    ds_write_b16 v1, v207 offset:4224
    ds_write_b16_d16_hi v1, v207 offset:3200
    ds_write_b16 v1, v208 offset:3584
    ds_write_b16_d16_hi v1, v208 offset:3968
    ds_write_b16 v1, v209 offset:4352
    s_waitcnt lgkmcnt(4)
    ds_write_b16 v1, v210 offset:4608
    ds_write_b16_d16_hi v1, v210 offset:4864
    ds_write_b16 v1, v211 offset:5248
    ds_write_b16_d16_hi v1, v211 offset:5632
    ds_write_b16 v1, v212 offset:4992
    ds_write_b16_d16_hi v1, v212 offset:5376
    ds_write_b16 v1, v213 offset:5760
    ds_write_b16_d16_hi v1, v213 offset:4736
    ds_write_b16 v1, v214 offset:5120
    ds_write_b16_d16_hi v1, v214 offset:5504
    ds_write_b16 v1, v215 offset:5888
    s_waitcnt lgkmcnt(4)
    ds_write_b16 v1, v216 offset:6144
    ds_write_b16_d16_hi v1, v216 offset:6400
    ds_write_b16 v1, v217 offset:6784
    ds_write_b16_d16_hi v1, v217 offset:7168
    ds_write_b16 v1, v218 offset:6528
    ds_write_b16_d16_hi v1, v218 offset:6912
    ds_write_b16 v1, v219 offset:7296
    ds_write_b16_d16_hi v1, v219 offset:6272
    ds_write_b16 v1, v220 offset:6656
    ds_write_b16_d16_hi v1, v220 offset:7040
    ds_write_b16 v1, v221 offset:7424
    s_waitcnt lgkmcnt(4)
    v_lshrrev_b32 v2, 1, v252
    v_and_b32 v3, 15, v2
    v_lshrrev_b32 v4, 4, v2
    v_lshlrev_b32 v5, 4, v4
    v_add_u32 v6, 0, v3
    v_cmp_gt_u32 vcc, s18, v6
    s_nop 1
    v_cndmask_b32 v6, 0, v6, vcc
    v_lshlrev_b32 v7, 2, v6
    ds_bpermute_b32 v225, v7, v253
    v_and_b32 v7, 7, v6
    v_mul_u32_u24 v7, 8224, v7
    v_lshrrev_b32 v6, 3, v6
    v_mul_u32_u24 v6, 1536, v6
    v_add3_u32 v222, v6, v7, v5
    v_add_u32 v6, 16, v3
    v_cmp_gt_u32 vcc, s18, v6
    s_nop 1
    v_cndmask_b32 v6, 0, v6, vcc
    v_lshlrev_b32 v7, 2, v6
    ds_bpermute_b32 v226, v7, v253
    v_and_b32 v7, 7, v6
    v_mul_u32_u24 v7, 8224, v7
    v_lshrrev_b32 v6, 3, v6
    v_mul_u32_u24 v6, 1536, v6
    v_add3_u32 v223, v6, v7, v5
    v_add_u32 v6, 32, v3
    v_cmp_gt_u32 vcc, s18, v6
    s_nop 1
    v_cndmask_b32 v6, 0, v6, vcc
    v_lshlrev_b32 v7, 2, v6
    ds_bpermute_b32 v227, v7, v253
    v_and_b32 v7, 7, v6
    v_mul_u32_u24 v7, 8224, v7
    v_lshrrev_b32 v6, 3, v6
    v_mul_u32_u24 v6, 1536, v6
    v_add3_u32 v224, v6, v7, v5
    s_waitcnt lgkmcnt(0)
    v_lshrrev_b32 v6, 21, v225
    v_and_b32 v7, 0x3ffff, v225
    v_add3_u32 v225, v6, v7, v5
    v_lshrrev_b32 v6, 21, v226
    v_and_b32 v7, 0x3ffff, v226
    v_add3_u32 v226, v6, v7, v5
    v_lshrrev_b32 v6, 21, v227
    v_and_b32 v7, 0x3ffff, v227
    v_add3_u32 v227, v6, v7, v5
    s_lshl_b32 s47, s64, 9
    s_lshl_b32 s48, s16, 6
    s_add_u32 s47, s47, s48
    s_mul_i32 s47, s47, 192
    s_add_u32 s47, s47, 18874368
    v_mul_u32_u24 v228, 96, v252
    s_cmp_eq_u32 s24, 0
    s_cbranch_scc1 K2_ACCLD
    v_mov_b32 v0, 0
    v_mov_b32 v1, 0
    v_mov_b32 v2, 0
    v_mov_b32 v3, 0
    v_mov_b32 v4, 0
    v_mov_b32 v5, 0
    v_mov_b32 v6, 0
    v_mov_b32 v7, 0
    v_mov_b32 v8, 0
    v_mov_b32 v9, 0
    v_mov_b32 v10, 0
    v_mov_b32 v11, 0
    v_mov_b32 v12, 0
    v_mov_b32 v13, 0
    v_mov_b32 v14, 0
    v_mov_b32 v15, 0
    v_mov_b32 v16, 0
    v_mov_b32 v17, 0
    v_mov_b32 v18, 0
    v_mov_b32 v19, 0
    v_mov_b32 v20, 0
    v_mov_b32 v21, 0
    v_mov_b32 v22, 0
    v_mov_b32 v23, 0
    v_mov_b32 v24, 0
    v_mov_b32 v25, 0
    v_mov_b32 v26, 0
    v_mov_b32 v27, 0
    v_mov_b32 v28, 0
    v_mov_b32 v29, 0
    v_mov_b32 v30, 0
    v_mov_b32 v31, 0
    v_mov_b32 v32, 0
    v_mov_b32 v33, 0
    v_mov_b32 v34, 0
    v_mov_b32 v35, 0
    v_mov_b32 v36, 0
    v_mov_b32 v37, 0
    v_mov_b32 v38, 0
    v_mov_b32 v39, 0
    v_mov_b32 v40, 0
    v_mov_b32 v41, 0
    v_mov_b32 v42, 0
    v_mov_b32 v43, 0
    v_mov_b32 v44, 0
    v_mov_b32 v45, 0
    v_mov_b32 v46, 0
    v_mov_b32 v47, 0
    s_branch K2_ACCOK
K2_ACCLD:
    buffer_load_dwordx4 v[0:3], v228, s[8:11], s47 offen offset:0
    buffer_load_dwordx4 v[4:7], v228, s[8:11], s47 offen offset:16
    buffer_load_dwordx4 v[8:11], v228, s[8:11], s47 offen offset:32
    buffer_load_dwordx4 v[12:15], v228, s[8:11], s47 offen offset:48
    buffer_load_dwordx4 v[16:19], v228, s[8:11], s47 offen offset:64
    buffer_load_dwordx4 v[20:23], v228, s[8:11], s47 offen offset:80
    buffer_load_dwordx4 v[24:27], v228, s[8:11], s47 offen offset:96
    buffer_load_dwordx4 v[28:31], v228, s[8:11], s47 offen offset:112
    buffer_load_dwordx4 v[32:35], v228, s[8:11], s47 offen offset:128
    buffer_load_dwordx4 v[36:39], v228, s[8:11], s47 offen offset:144
    buffer_load_dwordx4 v[40:43], v228, s[8:11], s47 offen offset:160
    buffer_load_dwordx4 v[44:47], v228, s[8:11], s47 offen offset:176
K2_ACCOK:
    s_waitcnt vmcnt(0)
    s_barrier
    ds_read_b128 v[48:51], v222 offset:0
    ds_read_b128 v[52:55], v222 offset:64
    ds_read_b128 v[56:59], v222 offset:128
    ds_read_b128 v[60:63], v222 offset:192
    ds_read_b128 v[64:67], v225 offset:0
    ds_read_b128 v[68:71], v225 offset:64
    ds_read_b128 v[72:75], v225 offset:128
    ds_read_b128 v[76:79], v225 offset:192
    ds_read_b128 v[80:83], v222 offset:256
    ds_read_b128 v[84:87], v222 offset:640
    ds_read_b128 v[88:91], v222 offset:1024
    s_waitcnt lgkmcnt(10)
    v_mfma_f32_16x16x32_bf16 v[0:3], v[96:99], v[48:51], v[0:3]
    ds_read_b128 v[92:95], v222 offset:320
    s_waitcnt lgkmcnt(10)
    v_mfma_f32_16x16x32_bf16 v[0:3], v[100:103], v[52:55], v[0:3]
    ds_read_b128 v[48:51], v222 offset:704
    s_waitcnt lgkmcnt(10)
    v_mfma_f32_16x16x32_bf16 v[0:3], v[104:107], v[56:59], v[0:3]
    ds_read_b128 v[52:55], v222 offset:1088
    s_waitcnt lgkmcnt(10)
    v_mfma_f32_16x16x32_bf16 v[0:3], v[108:111], v[60:63], v[0:3]
    ds_read_b128 v[56:59], v222 offset:384
    s_waitcnt lgkmcnt(10)
    v_mfma_f32_16x16x32_bf16 v[0:3], v[112:115], v[64:67], v[0:3]
    ds_read_b128 v[60:63], v222 offset:768
    s_waitcnt lgkmcnt(10)
    v_mfma_f32_16x16x32_bf16 v[0:3], v[116:119], v[68:71], v[0:3]
    ds_read_b128 v[64:67], v222 offset:1152
    s_waitcnt lgkmcnt(10)
    v_mfma_f32_16x16x32_bf16 v[0:3], v[120:123], v[72:75], v[0:3]
    ds_read_b128 v[68:71], v222 offset:448
    s_waitcnt lgkmcnt(10)
    v_mfma_f32_16x16x32_bf16 v[0:3], v[124:127], v[76:79], v[0:3]
    ds_read_b128 v[72:75], v222 offset:832
    s_waitcnt lgkmcnt(10)
    v_mfma_f32_16x16x32_bf16 v[4:7], v[128:131], v[80:83], v[4:7]
    ds_read_b128 v[76:79], v222 offset:1216
    s_waitcnt lgkmcnt(10)
    v_mfma_f32_16x16x32_bf16 v[8:11], v[128:131], v[84:87], v[8:11]
    ds_read_b128 v[80:83], v222 offset:512
    s_waitcnt lgkmcnt(10)
    v_mfma_f32_16x16x32_bf16 v[12:15], v[128:131], v[88:91], v[12:15]
    ds_read_b128 v[84:87], v222 offset:896
    s_waitcnt lgkmcnt(10)
    v_mfma_f32_16x16x32_bf16 v[4:7], v[132:135], v[92:95], v[4:7]
    ds_read_b128 v[88:91], v222 offset:1280
    s_waitcnt lgkmcnt(10)
    v_mfma_f32_16x16x32_bf16 v[8:11], v[132:135], v[48:51], v[8:11]
    ds_read_b128 v[92:95], v222 offset:576
    s_waitcnt lgkmcnt(10)
    v_mfma_f32_16x16x32_bf16 v[12:15], v[132:135], v[52:55], v[12:15]
    ds_read_b128 v[48:51], v222 offset:960
    s_waitcnt lgkmcnt(10)
    v_mfma_f32_16x16x32_bf16 v[4:7], v[136:139], v[56:59], v[4:7]
    ds_read_b128 v[52:55], v222 offset:1344
    s_waitcnt lgkmcnt(10)
    v_mfma_f32_16x16x32_bf16 v[8:11], v[136:139], v[60:63], v[8:11]
    ds_read_b128 v[56:59], v225 offset:256
    s_waitcnt lgkmcnt(10)
    v_mfma_f32_16x16x32_bf16 v[12:15], v[136:139], v[64:67], v[12:15]
    ds_read_b128 v[60:63], v225 offset:640
    s_waitcnt lgkmcnt(10)
    v_mfma_f32_16x16x32_bf16 v[4:7], v[140:143], v[68:71], v[4:7]
    ds_read_b128 v[64:67], v225 offset:1024
    s_waitcnt lgkmcnt(10)
    v_mfma_f32_16x16x32_bf16 v[8:11], v[140:143], v[72:75], v[8:11]
    ds_read_b128 v[68:71], v225 offset:320
    s_waitcnt lgkmcnt(10)
    v_mfma_f32_16x16x32_bf16 v[12:15], v[140:143], v[76:79], v[12:15]
    ds_read_b128 v[72:75], v225 offset:704
    s_waitcnt lgkmcnt(10)
    v_mfma_f32_16x16x32_bf16 v[4:7], v[144:147], v[80:83], v[4:7]
    ds_read_b128 v[76:79], v225 offset:1088
    s_waitcnt lgkmcnt(10)
    v_mfma_f32_16x16x32_bf16 v[8:11], v[144:147], v[84:87], v[8:11]
    ds_read_b128 v[80:83], v225 offset:384
    s_waitcnt lgkmcnt(10)
    v_mfma_f32_16x16x32_bf16 v[12:15], v[144:147], v[88:91], v[12:15]
    ds_read_b128 v[84:87], v225 offset:768
    s_waitcnt lgkmcnt(10)
    v_mfma_f32_16x16x32_bf16 v[4:7], v[148:151], v[92:95], v[4:7]
    ds_read_b128 v[88:91], v225 offset:1152
    s_waitcnt lgkmcnt(10)
    v_mfma_f32_16x16x32_bf16 v[8:11], v[148:151], v[48:51], v[8:11]
    ds_read_b128 v[92:95], v225 offset:448
    s_waitcnt lgkmcnt(10)
    v_mfma_f32_16x16x32_bf16 v[12:15], v[148:151], v[52:55], v[12:15]
    ds_read_b128 v[48:51], v225 offset:832
    s_waitcnt lgkmcnt(10)
    v_mfma_f32_16x16x32_bf16 v[4:7], v[152:155], v[56:59], v[4:7]
    ds_read_b128 v[52:55], v225 offset:1216
    s_waitcnt lgkmcnt(10)
    v_mfma_f32_16x16x32_bf16 v[8:11], v[152:155], v[60:63], v[8:11]
    ds_read_b128 v[56:59], v225 offset:512
    s_waitcnt lgkmcnt(10)
    v_mfma_f32_16x16x32_bf16 v[12:15], v[152:155], v[64:67], v[12:15]
    ds_read_b128 v[60:63], v225 offset:896
    s_waitcnt lgkmcnt(10)
    v_mfma_f32_16x16x32_bf16 v[4:7], v[156:159], v[68:71], v[4:7]
    ds_read_b128 v[64:67], v225 offset:1280
    s_waitcnt lgkmcnt(10)
    v_mfma_f32_16x16x32_bf16 v[8:11], v[156:159], v[72:75], v[8:11]
    ds_read_b128 v[68:71], v225 offset:576
    s_waitcnt lgkmcnt(10)
    v_mfma_f32_16x16x32_bf16 v[12:15], v[156:159], v[76:79], v[12:15]
    ds_read_b128 v[72:75], v225 offset:960
    s_waitcnt lgkmcnt(10)
    v_mfma_f32_16x16x32_bf16 v[4:7], v[160:163], v[80:83], v[4:7]
    ds_read_b128 v[76:79], v225 offset:1344
    s_waitcnt lgkmcnt(10)
    v_mfma_f32_16x16x32_bf16 v[8:11], v[160:163], v[84:87], v[8:11]
    ds_read_b128 v[80:83], v223 offset:0
    s_waitcnt lgkmcnt(10)
    v_mfma_f32_16x16x32_bf16 v[12:15], v[160:163], v[88:91], v[12:15]
    ds_read_b128 v[84:87], v223 offset:64
    s_waitcnt lgkmcnt(10)
    v_mfma_f32_16x16x32_bf16 v[4:7], v[164:167], v[92:95], v[4:7]
    ds_read_b128 v[88:91], v223 offset:128
    s_waitcnt lgkmcnt(10)
    v_mfma_f32_16x16x32_bf16 v[8:11], v[164:167], v[48:51], v[8:11]
    ds_read_b128 v[92:95], v223 offset:192
    s_waitcnt lgkmcnt(10)
    v_mfma_f32_16x16x32_bf16 v[12:15], v[164:167], v[52:55], v[12:15]
    ds_read_b128 v[48:51], v226 offset:0
    s_waitcnt lgkmcnt(10)
    v_mfma_f32_16x16x32_bf16 v[4:7], v[168:171], v[56:59], v[4:7]
    ds_read_b128 v[52:55], v226 offset:64
    s_waitcnt lgkmcnt(10)
    v_mfma_f32_16x16x32_bf16 v[8:11], v[168:171], v[60:63], v[8:11]
    ds_read_b128 v[56:59], v226 offset:128
    s_waitcnt lgkmcnt(10)
    v_mfma_f32_16x16x32_bf16 v[12:15], v[168:171], v[64:67], v[12:15]
    ds_read_b128 v[60:63], v226 offset:192
    s_waitcnt lgkmcnt(10)
    v_mfma_f32_16x16x32_bf16 v[4:7], v[172:175], v[68:71], v[4:7]
    ds_read_b128 v[64:67], v223 offset:256
    s_waitcnt lgkmcnt(10)
    v_mfma_f32_16x16x32_bf16 v[8:11], v[172:175], v[72:75], v[8:11]
    ds_read_b128 v[68:71], v223 offset:640
    s_waitcnt lgkmcnt(10)
    v_mfma_f32_16x16x32_bf16 v[12:15], v[172:175], v[76:79], v[12:15]
    ds_read_b128 v[72:75], v223 offset:1024
    s_waitcnt lgkmcnt(10)
    v_mfma_f32_16x16x32_bf16 v[16:19], v[96:99], v[80:83], v[16:19]
    ds_read_b128 v[76:79], v223 offset:320
    s_waitcnt lgkmcnt(10)
    v_mfma_f32_16x16x32_bf16 v[16:19], v[100:103], v[84:87], v[16:19]
    ds_read_b128 v[80:83], v223 offset:704
    s_waitcnt lgkmcnt(10)
    v_mfma_f32_16x16x32_bf16 v[16:19], v[104:107], v[88:91], v[16:19]
    ds_read_b128 v[84:87], v223 offset:1088
    s_waitcnt lgkmcnt(10)
    v_mfma_f32_16x16x32_bf16 v[16:19], v[108:111], v[92:95], v[16:19]
    ds_read_b128 v[88:91], v223 offset:384
    s_waitcnt lgkmcnt(10)
    v_mfma_f32_16x16x32_bf16 v[16:19], v[112:115], v[48:51], v[16:19]
    ds_read_b128 v[92:95], v223 offset:768
    s_waitcnt lgkmcnt(10)
    v_mfma_f32_16x16x32_bf16 v[16:19], v[116:119], v[52:55], v[16:19]
    ds_read_b128 v[48:51], v223 offset:1152
    s_waitcnt lgkmcnt(10)
    v_mfma_f32_16x16x32_bf16 v[16:19], v[120:123], v[56:59], v[16:19]
    ds_read_b128 v[52:55], v223 offset:448
    s_waitcnt lgkmcnt(10)
    v_mfma_f32_16x16x32_bf16 v[16:19], v[124:127], v[60:63], v[16:19]
    ds_read_b128 v[56:59], v223 offset:832
    s_waitcnt lgkmcnt(10)
    v_mfma_f32_16x16x32_bf16 v[20:23], v[128:131], v[64:67], v[20:23]
    ds_read_b128 v[60:63], v223 offset:1216
    s_waitcnt lgkmcnt(10)
    v_mfma_f32_16x16x32_bf16 v[24:27], v[128:131], v[68:71], v[24:27]
    ds_read_b128 v[64:67], v223 offset:512
    s_waitcnt lgkmcnt(10)
    v_mfma_f32_16x16x32_bf16 v[28:31], v[128:131], v[72:75], v[28:31]
    ds_read_b128 v[68:71], v223 offset:896
    s_waitcnt lgkmcnt(10)
    v_mfma_f32_16x16x32_bf16 v[20:23], v[132:135], v[76:79], v[20:23]
    ds_read_b128 v[72:75], v223 offset:1280
    s_waitcnt lgkmcnt(10)
    v_mfma_f32_16x16x32_bf16 v[24:27], v[132:135], v[80:83], v[24:27]
    ds_read_b128 v[76:79], v223 offset:576
    s_waitcnt lgkmcnt(10)
    v_mfma_f32_16x16x32_bf16 v[28:31], v[132:135], v[84:87], v[28:31]
    ds_read_b128 v[80:83], v223 offset:960
    s_waitcnt lgkmcnt(10)
    v_mfma_f32_16x16x32_bf16 v[20:23], v[136:139], v[88:91], v[20:23]
    ds_read_b128 v[84:87], v223 offset:1344
    s_waitcnt lgkmcnt(10)
    v_mfma_f32_16x16x32_bf16 v[24:27], v[136:139], v[92:95], v[24:27]
    ds_read_b128 v[88:91], v226 offset:256
    s_waitcnt lgkmcnt(10)
    v_mfma_f32_16x16x32_bf16 v[28:31], v[136:139], v[48:51], v[28:31]
    ds_read_b128 v[92:95], v226 offset:640
    s_waitcnt lgkmcnt(10)
    v_mfma_f32_16x16x32_bf16 v[20:23], v[140:143], v[52:55], v[20:23]
    ds_read_b128 v[48:51], v226 offset:1024
    s_waitcnt lgkmcnt(10)
    v_mfma_f32_16x16x32_bf16 v[24:27], v[140:143], v[56:59], v[24:27]
    ds_read_b128 v[52:55], v226 offset:320
    s_waitcnt lgkmcnt(10)
    v_mfma_f32_16x16x32_bf16 v[28:31], v[140:143], v[60:63], v[28:31]
    ds_read_b128 v[56:59], v226 offset:704
    s_waitcnt lgkmcnt(10)
    v_mfma_f32_16x16x32_bf16 v[20:23], v[144:147], v[64:67], v[20:23]
    ds_read_b128 v[60:63], v226 offset:1088
    s_waitcnt lgkmcnt(10)
    v_mfma_f32_16x16x32_bf16 v[24:27], v[144:147], v[68:71], v[24:27]
    ds_read_b128 v[64:67], v226 offset:384
    s_waitcnt lgkmcnt(10)
    v_mfma_f32_16x16x32_bf16 v[28:31], v[144:147], v[72:75], v[28:31]
    ds_read_b128 v[68:71], v226 offset:768
    s_waitcnt lgkmcnt(10)
    v_mfma_f32_16x16x32_bf16 v[20:23], v[148:151], v[76:79], v[20:23]
    ds_read_b128 v[72:75], v226 offset:1152
    s_waitcnt lgkmcnt(10)
    v_mfma_f32_16x16x32_bf16 v[24:27], v[148:151], v[80:83], v[24:27]
    ds_read_b128 v[76:79], v226 offset:448
    s_waitcnt lgkmcnt(10)
    v_mfma_f32_16x16x32_bf16 v[28:31], v[148:151], v[84:87], v[28:31]
    ds_read_b128 v[80:83], v226 offset:832
    s_waitcnt lgkmcnt(10)
    v_mfma_f32_16x16x32_bf16 v[20:23], v[152:155], v[88:91], v[20:23]
    ds_read_b128 v[84:87], v226 offset:1216
    s_waitcnt lgkmcnt(10)
    v_mfma_f32_16x16x32_bf16 v[24:27], v[152:155], v[92:95], v[24:27]
    ds_read_b128 v[88:91], v226 offset:512
    s_waitcnt lgkmcnt(10)
    v_mfma_f32_16x16x32_bf16 v[28:31], v[152:155], v[48:51], v[28:31]
    ds_read_b128 v[92:95], v226 offset:896
    s_waitcnt lgkmcnt(10)
    v_mfma_f32_16x16x32_bf16 v[20:23], v[156:159], v[52:55], v[20:23]
    ds_read_b128 v[48:51], v226 offset:1280
    s_waitcnt lgkmcnt(10)
    v_mfma_f32_16x16x32_bf16 v[24:27], v[156:159], v[56:59], v[24:27]
    ds_read_b128 v[52:55], v226 offset:576
    s_waitcnt lgkmcnt(10)
    v_mfma_f32_16x16x32_bf16 v[28:31], v[156:159], v[60:63], v[28:31]
    ds_read_b128 v[56:59], v226 offset:960
    s_waitcnt lgkmcnt(10)
    v_mfma_f32_16x16x32_bf16 v[20:23], v[160:163], v[64:67], v[20:23]
    ds_read_b128 v[60:63], v226 offset:1344
    s_waitcnt lgkmcnt(10)
    v_mfma_f32_16x16x32_bf16 v[24:27], v[160:163], v[68:71], v[24:27]
    ds_read_b128 v[64:67], v224 offset:0
    s_waitcnt lgkmcnt(10)
    v_mfma_f32_16x16x32_bf16 v[28:31], v[160:163], v[72:75], v[28:31]
    ds_read_b128 v[68:71], v224 offset:64
    s_waitcnt lgkmcnt(10)
    v_mfma_f32_16x16x32_bf16 v[20:23], v[164:167], v[76:79], v[20:23]
    ds_read_b128 v[72:75], v224 offset:128
    s_waitcnt lgkmcnt(10)
    v_mfma_f32_16x16x32_bf16 v[24:27], v[164:167], v[80:83], v[24:27]
    ds_read_b128 v[76:79], v224 offset:192
    s_waitcnt lgkmcnt(10)
    v_mfma_f32_16x16x32_bf16 v[28:31], v[164:167], v[84:87], v[28:31]
    ds_read_b128 v[80:83], v227 offset:0
    s_waitcnt lgkmcnt(10)
    v_mfma_f32_16x16x32_bf16 v[20:23], v[168:171], v[88:91], v[20:23]
    ds_read_b128 v[84:87], v227 offset:64
    s_waitcnt lgkmcnt(10)
    v_mfma_f32_16x16x32_bf16 v[24:27], v[168:171], v[92:95], v[24:27]
    ds_read_b128 v[88:91], v227 offset:128
    s_waitcnt lgkmcnt(10)
    v_mfma_f32_16x16x32_bf16 v[28:31], v[168:171], v[48:51], v[28:31]
    ds_read_b128 v[92:95], v227 offset:192
    s_waitcnt lgkmcnt(10)
    v_mfma_f32_16x16x32_bf16 v[20:23], v[172:175], v[52:55], v[20:23]
    ds_read_b128 v[48:51], v224 offset:256
    s_waitcnt lgkmcnt(10)
    v_mfma_f32_16x16x32_bf16 v[24:27], v[172:175], v[56:59], v[24:27]
    ds_read_b128 v[52:55], v224 offset:640
    s_waitcnt lgkmcnt(10)
    v_mfma_f32_16x16x32_bf16 v[28:31], v[172:175], v[60:63], v[28:31]
    ds_read_b128 v[56:59], v224 offset:1024
    s_waitcnt lgkmcnt(10)
    v_mfma_f32_16x16x32_bf16 v[32:35], v[96:99], v[64:67], v[32:35]
    ds_read_b128 v[60:63], v224 offset:320
    s_waitcnt lgkmcnt(10)
    v_mfma_f32_16x16x32_bf16 v[32:35], v[100:103], v[68:71], v[32:35]
    ds_read_b128 v[64:67], v224 offset:704
    s_waitcnt lgkmcnt(10)
    v_mfma_f32_16x16x32_bf16 v[32:35], v[104:107], v[72:75], v[32:35]
    ds_read_b128 v[68:71], v224 offset:1088
    s_waitcnt lgkmcnt(10)
    v_mfma_f32_16x16x32_bf16 v[32:35], v[108:111], v[76:79], v[32:35]
    ds_read_b128 v[72:75], v224 offset:384
    s_waitcnt lgkmcnt(10)
    v_mfma_f32_16x16x32_bf16 v[32:35], v[112:115], v[80:83], v[32:35]
    ds_read_b128 v[76:79], v224 offset:768
    s_waitcnt lgkmcnt(10)
    v_mfma_f32_16x16x32_bf16 v[32:35], v[116:119], v[84:87], v[32:35]
    ds_read_b128 v[80:83], v224 offset:1152
    s_waitcnt lgkmcnt(10)
    v_mfma_f32_16x16x32_bf16 v[32:35], v[120:123], v[88:91], v[32:35]
    ds_read_b128 v[84:87], v224 offset:448
    s_waitcnt lgkmcnt(10)
    v_mfma_f32_16x16x32_bf16 v[32:35], v[124:127], v[92:95], v[32:35]
    ds_read_b128 v[88:91], v224 offset:832
    s_waitcnt lgkmcnt(10)
    v_mfma_f32_16x16x32_bf16 v[36:39], v[128:131], v[48:51], v[36:39]
    ds_read_b128 v[92:95], v224 offset:1216
    s_waitcnt lgkmcnt(10)
    v_mfma_f32_16x16x32_bf16 v[40:43], v[128:131], v[52:55], v[40:43]
    ds_read_b128 v[48:51], v224 offset:512
    s_waitcnt lgkmcnt(10)
    v_mfma_f32_16x16x32_bf16 v[44:47], v[128:131], v[56:59], v[44:47]
    ds_read_b128 v[52:55], v224 offset:896
    s_waitcnt lgkmcnt(10)
    v_mfma_f32_16x16x32_bf16 v[36:39], v[132:135], v[60:63], v[36:39]
    ds_read_b128 v[56:59], v224 offset:1280
    s_waitcnt lgkmcnt(10)
    v_mfma_f32_16x16x32_bf16 v[40:43], v[132:135], v[64:67], v[40:43]
    ds_read_b128 v[60:63], v224 offset:576
    s_waitcnt lgkmcnt(10)
    v_mfma_f32_16x16x32_bf16 v[44:47], v[132:135], v[68:71], v[44:47]
    ds_read_b128 v[64:67], v224 offset:960
    s_waitcnt lgkmcnt(10)
    v_mfma_f32_16x16x32_bf16 v[36:39], v[136:139], v[72:75], v[36:39]
    ds_read_b128 v[68:71], v224 offset:1344
    s_waitcnt lgkmcnt(10)
    v_mfma_f32_16x16x32_bf16 v[40:43], v[136:139], v[76:79], v[40:43]
    ds_read_b128 v[72:75], v227 offset:256
    s_waitcnt lgkmcnt(10)
    v_mfma_f32_16x16x32_bf16 v[44:47], v[136:139], v[80:83], v[44:47]
    ds_read_b128 v[76:79], v227 offset:640
    s_waitcnt lgkmcnt(10)
    v_mfma_f32_16x16x32_bf16 v[36:39], v[140:143], v[84:87], v[36:39]
    ds_read_b128 v[80:83], v227 offset:1024
    s_waitcnt lgkmcnt(10)
    v_mfma_f32_16x16x32_bf16 v[40:43], v[140:143], v[88:91], v[40:43]
    ds_read_b128 v[84:87], v227 offset:320
    s_waitcnt lgkmcnt(10)
    v_mfma_f32_16x16x32_bf16 v[44:47], v[140:143], v[92:95], v[44:47]
    ds_read_b128 v[88:91], v227 offset:704
    s_waitcnt lgkmcnt(10)
    v_mfma_f32_16x16x32_bf16 v[36:39], v[144:147], v[48:51], v[36:39]
    ds_read_b128 v[92:95], v227 offset:1088
    s_waitcnt lgkmcnt(10)
    v_mfma_f32_16x16x32_bf16 v[40:43], v[144:147], v[52:55], v[40:43]
    ds_read_b128 v[48:51], v227 offset:384
    s_waitcnt lgkmcnt(10)
    v_mfma_f32_16x16x32_bf16 v[44:47], v[144:147], v[56:59], v[44:47]
    ds_read_b128 v[52:55], v227 offset:768
    s_waitcnt lgkmcnt(10)
    v_mfma_f32_16x16x32_bf16 v[36:39], v[148:151], v[60:63], v[36:39]
    ds_read_b128 v[56:59], v227 offset:1152
    s_waitcnt lgkmcnt(10)
    v_mfma_f32_16x16x32_bf16 v[40:43], v[148:151], v[64:67], v[40:43]
    ds_read_b128 v[60:63], v227 offset:448
    s_waitcnt lgkmcnt(10)
    v_mfma_f32_16x16x32_bf16 v[44:47], v[148:151], v[68:71], v[44:47]
    ds_read_b128 v[64:67], v227 offset:832
    s_waitcnt lgkmcnt(10)
    v_mfma_f32_16x16x32_bf16 v[36:39], v[152:155], v[72:75], v[36:39]
    ds_read_b128 v[68:71], v227 offset:1216
    s_waitcnt lgkmcnt(10)
    v_mfma_f32_16x16x32_bf16 v[40:43], v[152:155], v[76:79], v[40:43]
    ds_read_b128 v[72:75], v227 offset:512
    s_waitcnt lgkmcnt(10)
    v_mfma_f32_16x16x32_bf16 v[44:47], v[152:155], v[80:83], v[44:47]
    ds_read_b128 v[76:79], v227 offset:896
    s_waitcnt lgkmcnt(10)
    v_mfma_f32_16x16x32_bf16 v[36:39], v[156:159], v[84:87], v[36:39]
    ds_read_b128 v[80:83], v227 offset:1280
    s_waitcnt lgkmcnt(10)
    v_mfma_f32_16x16x32_bf16 v[40:43], v[156:159], v[88:91], v[40:43]
    ds_read_b128 v[84:87], v227 offset:576
    s_waitcnt lgkmcnt(10)
    v_mfma_f32_16x16x32_bf16 v[44:47], v[156:159], v[92:95], v[44:47]
    ds_read_b128 v[88:91], v227 offset:960
    s_waitcnt lgkmcnt(10)
    v_mfma_f32_16x16x32_bf16 v[36:39], v[160:163], v[48:51], v[36:39]
    ds_read_b128 v[92:95], v227 offset:1344
    s_waitcnt lgkmcnt(10)
    v_mfma_f32_16x16x32_bf16 v[40:43], v[160:163], v[52:55], v[40:43]
    s_waitcnt lgkmcnt(9)
    v_mfma_f32_16x16x32_bf16 v[44:47], v[160:163], v[56:59], v[44:47]
    s_waitcnt lgkmcnt(8)
    v_mfma_f32_16x16x32_bf16 v[36:39], v[164:167], v[60:63], v[36:39]
    s_waitcnt lgkmcnt(7)
    v_mfma_f32_16x16x32_bf16 v[40:43], v[164:167], v[64:67], v[40:43]
    s_waitcnt lgkmcnt(6)
    v_mfma_f32_16x16x32_bf16 v[44:47], v[164:167], v[68:71], v[44:47]
    s_waitcnt lgkmcnt(5)
    v_mfma_f32_16x16x32_bf16 v[36:39], v[168:171], v[72:75], v[36:39]
    s_waitcnt lgkmcnt(4)
    v_mfma_f32_16x16x32_bf16 v[40:43], v[168:171], v[76:79], v[40:43]
    s_waitcnt lgkmcnt(3)
    v_mfma_f32_16x16x32_bf16 v[44:47], v[168:171], v[80:83], v[44:47]
    s_waitcnt lgkmcnt(2)
    v_mfma_f32_16x16x32_bf16 v[36:39], v[172:175], v[84:87], v[36:39]
    s_waitcnt lgkmcnt(1)
    v_mfma_f32_16x16x32_bf16 v[40:43], v[172:175], v[88:91], v[40:43]
    s_waitcnt lgkmcnt(0)
    v_mfma_f32_16x16x32_bf16 v[44:47], v[172:175], v[92:95], v[44:47]
    s_add_u32 s20, s20, 1
    s_cmp_lt_u32 s20, s21
    s_cbranch_scc1 K2_SPILL
    s_cmp_lg_u32 s23, 0
    s_cbranch_scc1 K2_SPILL
    s_mov_b32 s45, 0xbfb8aa3b
    v_mul_f32 v48, s45, v0
    v_mul_f32 v49, s45, v1
    v_mul_f32 v50, s45, v2
    v_mul_f32 v51, s45, v3
    v_exp_f32 v48, v48
    v_exp_f32 v49, v49
    v_exp_f32 v50, v50
    v_exp_f32 v51, v51
    v_add_f32 v48, 1.0, v48
    v_add_f32 v49, 1.0, v49
    v_add_f32 v50, 1.0, v50
    v_add_f32 v51, 1.0, v51
    v_rcp_f32 v48, v48
    v_rcp_f32 v49, v49
    v_rcp_f32 v50, v50
    v_rcp_f32 v51, v51
    v_cvt_pk_bf16_f32 v64, v0, v1
    v_cvt_pk_bf16_f32 v65, v2, v3
    v_mul_f32 v4, v4, v48
    v_mul_f32 v5, v5, v49
    v_mul_f32 v6, v6, v50
    v_mul_f32 v7, v7, v51
    v_cvt_pk_bf16_f32 v66, v4, v5
    v_cvt_pk_bf16_f32 v67, v6, v7
    v_mul_f32 v8, v8, v48
    v_mul_f32 v9, v9, v49
    v_mul_f32 v10, v10, v50
    v_mul_f32 v11, v11, v51
    v_cvt_pk_bf16_f32 v68, v8, v9
    v_cvt_pk_bf16_f32 v69, v10, v11
    v_mul_f32 v12, v12, v48
    v_mul_f32 v13, v13, v49
    v_mul_f32 v14, v14, v50
    v_mul_f32 v15, v15, v51
    v_cvt_pk_bf16_f32 v70, v12, v13
    v_cvt_pk_bf16_f32 v71, v14, v15
    v_mul_f32 v48, s45, v16
    v_mul_f32 v49, s45, v17
    v_mul_f32 v50, s45, v18
    v_mul_f32 v51, s45, v19
    v_exp_f32 v48, v48
    v_exp_f32 v49, v49
    v_exp_f32 v50, v50
    v_exp_f32 v51, v51
    v_add_f32 v48, 1.0, v48
    v_add_f32 v49, 1.0, v49
    v_add_f32 v50, 1.0, v50
    v_add_f32 v51, 1.0, v51
    v_rcp_f32 v48, v48
    v_rcp_f32 v49, v49
    v_rcp_f32 v50, v50
    v_rcp_f32 v51, v51
    v_cvt_pk_bf16_f32 v72, v16, v17
    v_cvt_pk_bf16_f32 v73, v18, v19
    v_mul_f32 v20, v20, v48
    v_mul_f32 v21, v21, v49
    v_mul_f32 v22, v22, v50
    v_mul_f32 v23, v23, v51
    v_cvt_pk_bf16_f32 v74, v20, v21
    v_cvt_pk_bf16_f32 v75, v22, v23
    v_mul_f32 v24, v24, v48
    v_mul_f32 v25, v25, v49
    v_mul_f32 v26, v26, v50
    v_mul_f32 v27, v27, v51
    v_cvt_pk_bf16_f32 v76, v24, v25
    v_cvt_pk_bf16_f32 v77, v26, v27
    v_mul_f32 v28, v28, v48
    v_mul_f32 v29, v29, v49
    v_mul_f32 v30, v30, v50
    v_mul_f32 v31, v31, v51
    v_cvt_pk_bf16_f32 v78, v28, v29
    v_cvt_pk_bf16_f32 v79, v30, v31
    v_mul_f32 v48, s45, v32
    v_mul_f32 v49, s45, v33
    v_mul_f32 v50, s45, v34
    v_mul_f32 v51, s45, v35
    v_exp_f32 v48, v48
    v_exp_f32 v49, v49
    v_exp_f32 v50, v50
    v_exp_f32 v51, v51
    v_add_f32 v48, 1.0, v48
    v_add_f32 v49, 1.0, v49
    v_add_f32 v50, 1.0, v50
    v_add_f32 v51, 1.0, v51
    v_rcp_f32 v48, v48
    v_rcp_f32 v49, v49
    v_rcp_f32 v50, v50
    v_rcp_f32 v51, v51
    v_cvt_pk_bf16_f32 v80, v32, v33
    v_cvt_pk_bf16_f32 v81, v34, v35
    v_mul_f32 v36, v36, v48
    v_mul_f32 v37, v37, v49
    v_mul_f32 v38, v38, v50
    v_mul_f32 v39, v39, v51
    v_cvt_pk_bf16_f32 v82, v36, v37
    v_cvt_pk_bf16_f32 v83, v38, v39
    v_mul_f32 v40, v40, v48
    v_mul_f32 v41, v41, v49
    v_mul_f32 v42, v42, v50
    v_mul_f32 v43, v43, v51
    v_cvt_pk_bf16_f32 v84, v40, v41
    v_cvt_pk_bf16_f32 v85, v42, v43
    v_mul_f32 v44, v44, v48
    v_mul_f32 v45, v45, v49
    v_mul_f32 v46, v46, v50
    v_mul_f32 v47, v47, v51
    v_cvt_pk_bf16_f32 v86, v44, v45
    v_cvt_pk_bf16_f32 v87, v46, v47
    v_lshrrev_b32 v2, 1, v252
    v_and_b32 v3, 15, v2
    v_lshrrev_b32 v4, 4, v2
    v_mul_u32_u24 v3, 1040, v3
    v_lshl_add_u32 v3, v4, 3, v3
    s_lshl_b32 s45, s16, 5
    v_add_u32 v3, s45, v3
    v_lshlrev_b32 v0, 3, v252
    s_mul_i32 s45, s16, 1040
    v_add_u32 v1, s45, v0
    s_barrier
    ds_write_b64 v3, v[64:65] offset:0
    ds_write_b64 v3, v[66:67] offset:256
    ds_write_b64 v3, v[68:69] offset:512
    ds_write_b64 v3, v[70:71] offset:768
    ds_write_b64 v3, v[72:73] offset:16640
    ds_write_b64 v3, v[74:75] offset:16896
    ds_write_b64 v3, v[76:77] offset:17152
    ds_write_b64 v3, v[78:79] offset:17408
    ds_write_b64 v3, v[80:81] offset:33280
    ds_write_b64 v3, v[82:83] offset:33536
    ds_write_b64 v3, v[84:85] offset:33792
    ds_write_b64 v3, v[86:87] offset:34048
    s_add_u32 s45, s17, s16
    s_lshl_b32 s45, s45, 10
    s_waitcnt lgkmcnt(0)
    s_barrier
    ds_read_b128 v[4:7], v1 offset:0
    ds_read_b128 v[8:11], v1 offset:8320
    ds_read_b128 v[12:15], v1 offset:16640
    ds_read_b128 v[16:19], v1 offset:24960
    ds_read_b128 v[20:23], v1 offset:33280
    s_waitcnt lgkmcnt(4)
    buffer_store_dwordx4 v[4:7], v0, s[12:15], s45 offen
    s_add_u32 s45, s45, 8192
    s_waitcnt lgkmcnt(3)
    buffer_store_dwordx4 v[8:11], v0, s[12:15], s45 offen
    s_add_u32 s45, s45, 8192
    s_waitcnt lgkmcnt(2)
    buffer_store_dwordx4 v[12:15], v0, s[12:15], s45 offen
    s_add_u32 s45, s45, 8192
    s_waitcnt lgkmcnt(1)
    buffer_store_dwordx4 v[16:19], v0, s[12:15], s45 offen
    s_add_u32 s45, s45, 8192
    s_add_u32 s46, s16, 32
    s_cmp_ge_u32 s46, s18
    s_cbranch_scc1 K2_FIN
    s_waitcnt lgkmcnt(0)
    buffer_store_dwordx4 v[20:23], v0, s[12:15], s45 offen
    s_add_u32 s45, s45, 8192
K2_FIN:
    s_branch K2_END
K2_SPILL:
    buffer_store_dwordx4 v[0:3], v228, s[8:11], s47 offen offset:0
    buffer_store_dwordx4 v[4:7], v228, s[8:11], s47 offen offset:16
    buffer_store_dwordx4 v[8:11], v228, s[8:11], s47 offen offset:32
    buffer_store_dwordx4 v[12:15], v228, s[8:11], s47 offen offset:48
    buffer_store_dwordx4 v[16:19], v228, s[8:11], s47 offen offset:64
    buffer_store_dwordx4 v[20:23], v228, s[8:11], s47 offen offset:80
    buffer_store_dwordx4 v[24:27], v228, s[8:11], s47 offen offset:96
    buffer_store_dwordx4 v[28:31], v228, s[8:11], s47 offen offset:112
    buffer_store_dwordx4 v[32:35], v228, s[8:11], s47 offen offset:128
    buffer_store_dwordx4 v[36:39], v228, s[8:11], s47 offen offset:144
    buffer_store_dwordx4 v[40:43], v228, s[8:11], s47 offen offset:160
    buffer_store_dwordx4 v[44:47], v228, s[8:11], s47 offen offset:176
    s_mov_b32 s24, 0
    s_waitcnt vmcnt(0)
    s_barrier
    s_cmp_lt_u32 s20, s21
    s_cbranch_scc1 K2_LOAD
    s_add_u32 s19, s19, 20
    s_branch K2_WINDOW
K2_END:
    s_endpgm
.section .rodata,"a"
.p2align 6
.amdhsa_kernel tp_sort_kernel
  .amdhsa_next_free_vgpr 64
  .amdhsa_next_free_sgpr 100
  .amdhsa_accum_offset 64
  .amdhsa_group_segment_fixed_size 0
  .amdhsa_kernarg_size 96
  .amdhsa_user_sgpr_count 2
  .amdhsa_user_sgpr_kernarg_segment_ptr 1
  .amdhsa_system_sgpr_workgroup_id_x 1
  .amdhsa_float_denorm_mode_32 3
.end_amdhsa_kernel
.p2align 6
.amdhsa_kernel tp_main_kernel
  .amdhsa_next_free_vgpr 256
  .amdhsa_next_free_sgpr 100
  .amdhsa_accum_offset 256
  .amdhsa_group_segment_fixed_size 0
  .amdhsa_kernarg_size 96
  .amdhsa_user_sgpr_count 2
  .amdhsa_user_sgpr_kernarg_segment_ptr 1
  .amdhsa_system_sgpr_workgroup_id_x 1
  .amdhsa_float_denorm_mode_32 3
.end_amdhsa_kernel
```

```asm
; @launch kernel=tp_sort_kernel grid=(250,1,1) block=(320,1,1) lds=22528
; @launch kernel=tp_main_kernel grid=(256,1,1) block=(512,1,1) lds=162560
.amdgcn_target "amdgcn-amd-amdhsa--gfx950"
.text
.globl tp_sort_kernel
.p2align 8
.type tp_sort_kernel,@function
tp_sort_kernel:
    s_cmp_ge_u32 s2, 250
    s_cbranch_scc1 K1_END
    s_load_dwordx2 s[36:37], s[0:1], 8
    s_load_dwordx4 s[40:43], s[0:1], 24
    s_load_dwordx4 s[44:47], s[0:1], 40
    s_load_dwordx2 s[48:49], s[0:1], 56
    s_load_dwordx2 s[50:51], s[0:1], 88
    s_load_dwordx2 s[30:31], s[0:1], 0
    s_load_dwordx2 s[32:33], s[0:1], 16
    v_lshrrev_b32 v1, 6, v0
    v_lshlrev_b32 v5, 4, v0
    v_readfirstlane_b32 s3, v1
    v_mul_u32_u24 v4, 24, v0
    v_lshlrev_b32 v2, 2, v0
    v_and_b32 v8, 63, v0
    v_lshlrev_b32 v9, 4, v8
    v_mov_b32 v6, 0
    v_mov_b32 v7, 1
    s_mul_i32 s52, s2, 5120
    s_mul_i32 s53, s2, 7680
    s_waitcnt lgkmcnt(0)
    s_mov_b32 s4, s42
    s_and_b32 s5, s43, 0xffff
    s_mov_b32 s6, 1280000
    s_mov_b32 s7, 0x20000
    s_mov_b32 s8, s40
    s_and_b32 s9, s41, 0xffff
    s_mov_b32 s10, 1280000
    s_mov_b32 s11, 0x20000
    s_mov_b32 s12, s36
    s_and_b32 s13, s37, 0xffff
    s_mov_b32 s14, 1920000
    s_mov_b32 s15, 0x20000
    s_mov_b32 s20, s50
    s_and_b32 s21, s51, 0xffff
    s_mov_b32 s22, 37748736
    s_mov_b32 s23, 0x20000
    buffer_load_dwordx4 v[12:15], v5, s[4:7], s52 offen
    buffer_load_dwordx4 v[16:19], v5, s[8:11], s52 offen
    buffer_load_dwordx4 v[20:23], v4, s[12:15], s53 offen
    buffer_load_dwordx2 v[24:25], v4, s[12:15], s53 offen offset:16
    s_cmp_eq_u32 s3, 4
    s_cbranch_scc1 K1_PREP
    ds_write_b32 v2, v6
    s_branch K1_GO
K1_PREP:
    s_cmp_ge_u32 s2, 180
    s_cbranch_scc1 K1_GO
    v_and_b32 v1, 15, v8
    v_lshrrev_b32 v3, 4, v8
    s_cmp_ge_u32 s2, 160
    s_cbranch_scc1 K1_WT
    s_cmp_ge_u32 s2, 64
    s_cbranch_scc1 K1_S1
    s_lshr_b32 s24, s2, 3
    s_and_b32 s25, s2, 7
    s_lshr_b32 s26, s25, 2
    s_bfe_u32 s27, s25, 0x10001
    s_and_b32 s28, s25, 1
    s_mov_b32 s16, s46
    s_and_b32 s17, s47, 0xffff
    s_mov_b32 s18, 65536
    s_mov_b32 s19, 0x20000
    s_branch K1_SC
K1_S1:
    s_sub_u32 s29, s2, 64
    s_mul_i32 s24, s29, 43
    s_lshr_b32 s24, s24, 9
    s_mul_i32 s25, s24, 12
    s_sub_u32 s25, s29, s25
    s_cmp_ge_u32 s25, 6
    s_cselect_b32 s26, 1, 0
    s_mul_i32 s27, s26, 6
    s_sub_u32 s27, s25, s27
    s_lshr_b32 s27, s27, 1
    s_and_b32 s28, s25, 1
    s_add_u32 s25, s25, 8
    s_mov_b32 s16, s48
    s_and_b32 s17, s49, 0xffff
    s_mov_b32 s18, 98304
    s_mov_b32 s19, 0x20000
K1_SC:
    s_lshl_b32 s27, s27, 7
    s_lshl_b32 s26, s26, 6
    s_lshl_b32 s28, s28, 5
    s_add_u32 s27, s27, s26
    s_add_u32 s27, s27, s28
    s_lshl_b32 s27, s27, 8
    s_lshl_b32 s26, s24, 5
    s_add_u32 s27, s27, s26
    v_lshlrev_b32 v3, 11, v3
    v_lshl_add_u32 v3, v1, 1, v3
    buffer_load_ushort v64, v3, s[16:19], s27 offen offset:0
    buffer_load_ushort v65, v3, s[16:19], s27 offen offset:256
    buffer_load_ushort v66, v3, s[16:19], s27 offen offset:512
    buffer_load_ushort v67, v3, s[16:19], s27 offen offset:768
    buffer_load_ushort v68, v3, s[16:19], s27 offen offset:1024
    buffer_load_ushort v69, v3, s[16:19], s27 offen offset:1280
    buffer_load_ushort v70, v3, s[16:19], s27 offen offset:1536
    buffer_load_ushort v71, v3, s[16:19], s27 offen offset:1792
    s_mul_i32 s24, s24, 20
    s_add_u32 s24, s24, s25
    s_lshl_b32 s24, s24, 10
    s_add_u32 s24, s24, 6815744
    s_branch K1_GO
K1_WT:
    s_sub_u32 s24, s2, 160
    s_cmp_ge_u32 s24, 10
    s_cselect_b32 s26, 1, 0
    s_mul_i32 s25, s26, 10
    s_sub_u32 s25, s24, s25
    s_lshr_b32 s27, s25, 1
    s_and_b32 s28, s25, 1
    s_lshl_b32 s27, s27, 8
    s_lshl_b32 s26, s26, 7
    s_lshl_b32 s28, s28, 6
    s_add_u32 s27, s27, s26
    s_add_u32 s27, s27, s28
    s_add_u32 s28, s27, 10240
    s_mov_b32 s16, s44
    s_and_b32 s17, s45, 0xffff
    s_mov_b32 s18, 20480
    s_mov_b32 s19, 0x20000
    v_and_b32 v1, 31, v8
    v_lshrrev_b32 v3, 5, v8
    v_mul_u32_u24 v3, 5120, v3
    v_lshl_add_u32 v3, v1, 1, v3
    buffer_load_ushort v64, v3, s[16:19], s27 offen offset:0
    buffer_load_ushort v65, v3, s[16:19], s27 offen offset:1280
    buffer_load_ushort v66, v3, s[16:19], s27 offen offset:2560
    buffer_load_ushort v67, v3, s[16:19], s27 offen offset:3840
    buffer_load_ushort v68, v3, s[16:19], s28 offen offset:0
    buffer_load_ushort v69, v3, s[16:19], s28 offen offset:1280
    buffer_load_ushort v70, v3, s[16:19], s28 offen offset:2560
    buffer_load_ushort v71, v3, s[16:19], s28 offen offset:3840
    s_lshl_b32 s24, s24, 10
    s_add_u32 s24, s24, 6979584
K1_GO:
    s_mov_b32 s58, 429497
    s_movk_i32 s59, 625
    s_waitcnt lgkmcnt(0)
    s_barrier
    s_cmp_eq_u32 s3, 4
    s_cbranch_scc1 K1_W4
    s_waitcnt vmcnt(3)
    s_branch K1_W4D
K1_W4:
    s_waitcnt vmcnt(0)
K1_W4D:
    v_mul_u32_u24 v28, s58, v12
    v_lshrrev_b32 v28, 24, v28
    v_lshlrev_b32 v32, 2, v28
    ds_add_rtn_u32 v36, v32, v7
    v_mul_u32_u24 v29, s58, v13
    v_lshrrev_b32 v29, 24, v29
    v_lshlrev_b32 v33, 2, v29
    ds_add_rtn_u32 v37, v33, v7
    v_mul_u32_u24 v30, s58, v14
    v_lshrrev_b32 v30, 24, v30
    v_lshlrev_b32 v34, 2, v30
    ds_add_rtn_u32 v38, v34, v7
    v_mul_u32_u24 v31, s58, v15
    v_lshrrev_b32 v31, 24, v31
    v_lshlrev_b32 v35, 2, v31
    ds_add_rtn_u32 v39, v35, v7
    v_mad_u32_u24 v28, v28, s59, 15
    v_lshrrev_b32 v28, 4, v28
    v_sub_u32 v28, v12, v28
    v_add_u32 v12, 0, v2
    v_lshlrev_b32 v12, 14, v12
    v_lshl_or_b32 v28, v28, 25, v12
    v_mad_u32_u24 v29, v29, s59, 15
    v_lshrrev_b32 v29, 4, v29
    v_sub_u32 v29, v13, v29
    v_add_u32 v13, 1, v2
    v_lshlrev_b32 v13, 14, v13
    v_lshl_or_b32 v29, v29, 25, v13
    v_mad_u32_u24 v30, v30, s59, 15
    v_lshrrev_b32 v30, 4, v30
    v_sub_u32 v30, v14, v30
    v_add_u32 v14, 2, v2
    v_lshlrev_b32 v14, 14, v14
    v_lshl_or_b32 v30, v30, 25, v14
    v_mad_u32_u24 v31, v31, s59, 15
    v_lshrrev_b32 v31, 4, v31
    v_sub_u32 v31, v15, v31
    v_add_u32 v15, 3, v2
    v_lshlrev_b32 v15, 14, v15
    v_lshl_or_b32 v31, v31, 25, v15
    s_waitcnt lgkmcnt(0)
    s_barrier
    ds_read_b128 v[40:43], v9
    s_waitcnt lgkmcnt(0)
    v_add_u32 v45, v40, v41
    v_add_u32 v46, v45, v42
    v_add_u32 v47, v46, v43
    v_mov_b32 v48, v47
    s_nop 1
    v_add_u32_dpp v48, v48, v48 row_shr:1 row_mask:0xf bank_mask:0xf bound_ctrl:0
    s_nop 1
    v_add_u32_dpp v48, v48, v48 row_shr:2 row_mask:0xf bank_mask:0xf bound_ctrl:0
    s_nop 1
    v_add_u32_dpp v48, v48, v48 row_shr:4 row_mask:0xf bank_mask:0xf bound_ctrl:0
    s_nop 1
    v_add_u32_dpp v48, v48, v48 row_shr:8 row_mask:0xf bank_mask:0xf bound_ctrl:0
    s_nop 1
    v_add_u32_dpp v48, v48, v48 row_bcast:15 row_mask:0xa bank_mask:0xf
    s_nop 1
    v_add_u32_dpp v48, v48, v48 row_bcast:31 row_mask:0xc bank_mask:0xf
    v_sub_u32 v48, v48, v47
    v_add_u32 v49, v48, v40
    v_add_u32 v50, v48, v45
    v_add_u32 v51, v48, v46
    ds_write_b128 v9, v[48:51] offset:1024
    s_cmp_lg_u32 s3, 0
    s_cbranch_scc1 K1_NOTBL
    v_lshl_or_b32 v52, v40, 16, v48
    v_lshl_or_b32 v53, v41, 16, v49
    v_lshl_or_b32 v54, v42, 16, v50
    v_lshl_or_b32 v55, v43, 16, v51
    s_mul_i32 s62, s2, 1152
    s_add_u32 s62, s62, 6291456
    buffer_store_dwordx4 v[52:55], v9, s[20:23], s62 offen sc1
K1_NOTBL:
    s_waitcnt lgkmcnt(0)
    ds_read_b32 v32, v32 offset:1024
    ds_read_b32 v33, v33 offset:1024
    ds_read_b32 v34, v34 offset:1024
    ds_read_b32 v35, v35 offset:1024
    s_cmp_lg_u32 s3, 0
    s_cbranch_scc1 K1_W0
    s_waitcnt vmcnt(1)
    s_branch K1_W0D
K1_W0:
    s_waitcnt vmcnt(0)
K1_W0D:
    v_lshlrev_b32 v40, 16, v20
    v_and_b32 v41, 0xffff0000, v20
    v_lshlrev_b32 v42, 16, v21
    v_or_b32 v43, v28, v16
    v_and_b32 v44, 0xffff0000, v21
    v_lshlrev_b32 v45, 16, v22
    v_and_b32 v46, 0xffff0000, v22
    v_or_b32 v47, v29, v17
    v_lshlrev_b32 v48, 16, v23
    v_and_b32 v49, 0xffff0000, v23
    v_lshlrev_b32 v50, 16, v24
    v_or_b32 v51, v30, v18
    v_and_b32 v52, 0xffff0000, v24
    v_lshlrev_b32 v53, 16, v25
    v_and_b32 v54, 0xffff0000, v25
    v_or_b32 v55, v31, v19
    s_waitcnt lgkmcnt(0)
    v_add_lshl_u32 v32, v32, v36, 4
    ds_write_b128 v32, v[40:43] offset:2048
    v_add_lshl_u32 v33, v33, v37, 4
    ds_write_b128 v33, v[44:47] offset:2048
    v_add_lshl_u32 v34, v34, v38, 4
    ds_write_b128 v34, v[48:51] offset:2048
    v_add_lshl_u32 v35, v35, v39, 4
    ds_write_b128 v35, v[52:55] offset:2048
    s_mul_i32 s52, s2, 20608
    s_waitcnt lgkmcnt(0)
    s_barrier
    ds_read_b128 v[12:15], v5 offset:2048
    ds_read_b128 v[16:19], v5 offset:7168
    ds_read_b128 v[20:23], v5 offset:12288
    ds_read_b128 v[24:27], v5 offset:17408
    s_waitcnt lgkmcnt(3)
    buffer_store_dwordx4 v[12:15], v5, s[20:23], s52 offen sc1
    s_add_u32 s52, s52, 5120
    s_waitcnt lgkmcnt(2)
    buffer_store_dwordx4 v[16:19], v5, s[20:23], s52 offen sc1
    s_add_u32 s52, s52, 5120
    s_waitcnt lgkmcnt(1)
    buffer_store_dwordx4 v[20:23], v5, s[20:23], s52 offen sc1
    s_add_u32 s52, s52, 5120
    s_waitcnt lgkmcnt(0)
    buffer_store_dwordx4 v[24:27], v5, s[20:23], s52 offen sc1
    s_cmp_lg_u32 s3, 4
    s_cbranch_scc1 K1_FIN
    s_cmp_ge_u32 s2, 180
    s_cbranch_scc1 K1_FIN
    v_lshl_or_b32 v40, v65, 16, v64
    v_lshl_or_b32 v41, v67, 16, v66
    v_lshl_or_b32 v42, v69, 16, v68
    v_lshl_or_b32 v43, v71, 16, v70
    buffer_store_dwordx4 v[40:43], v9, s[20:23], s24 offen sc1
K1_FIN:
K1_END:
    s_endpgm
.globl tp_main_kernel
.p2align 8
.type tp_main_kernel,@function
tp_main_kernel:
    s_cmp_ge_u32 s2, 256
    s_cbranch_scc1 K2_END
    s_load_dwordx2 s[58:59], s[0:1], 0
    s_load_dwordx2 s[60:61], s[0:1], 72
    s_load_dwordx2 s[62:63], s[0:1], 88
    s_load_dwordx2 s[64:65], s[0:1], 16
    v_lshrrev_b32 v1, 6, v0
    s_mov_b32 s54, s2
    v_readfirstlane_b32 s20, v1
    s_mul_i32 s21, s2, 625
    s_add_u32 s22, s21, 640
    s_add_u32 s21, s21, 15
    s_lshr_b32 s21, s21, 4
    s_lshr_b32 s22, s22, 4
    s_sub_u32 s22, s22, s21
    s_mov_b32 s23, 0
    s_mov_b32 s28, 1
    s_movk_i32 s39, 1024
    s_lshl_b32 s37, s20, 13
    s_mov_b32 s53, 162080
    s_lshl_b32 s52, s20, 2
    s_add_u32 s52, s52, s53
    s_add_u32 s68, s37, 0
    s_add_u32 s69, s37, 2048
    s_add_u32 s70, s37, 4096
    s_add_u32 s71, s37, 6144
    s_waitcnt lgkmcnt(0)
    s_mov_b32 s8, s62
    s_and_b32 s9, s63, 0xffff
    s_mov_b32 s10, 37748736
    s_mov_b32 s11, 0x20000
    s_mov_b32 s4, s58
    s_and_b32 s5, s59, 0xffff
    s_mov_b32 s6, 10240000
    s_mov_b32 s7, 0x20000
    s_mov_b32 s12, s60
    s_and_b32 s13, s61, 0xffff
    s_mov_b32 s14, 10240000
    s_mov_b32 s15, 0x20000
    s_mov_b32 s16, s64
    s_and_b32 s17, s65, 0xffff
    s_mov_b32 s18, 10240000
    s_mov_b32 s19, 0x20000
    s_sub_u32 s58, s58, 1024
    s_subb_u32 s59, s59, 0
    s_mov_b32 s72, s58
    s_and_b32 s73, s59, 0xffff
    s_mov_b32 s74, 10241024
    s_mov_b32 s75, 0x20000
K2_WINDOW:
    s_mov_b32 s24, 0
    s_mov_b32 s25, 1
    s_mov_b32 s26, 64
K2_LOAD:
    v_mbcnt_lo_u32_b32 v176, -1, 0
    v_mbcnt_hi_u32_b32 v176, -1, v176
    s_lshl_b32 s58, s20, 6
    v_add_u32 v177, s58, v176
    v_lshrrev_b32 v178, 1, v177
    v_min_u32 v178, 249, v178
    v_mul_u32_u24 v1, 1152, v178
    s_lshl_b32 s58, s54, 2
    s_add_u32 s58, s58, 6291456
    buffer_load_dword v179, v1, s[8:11], s58 offen
    v_lshlrev_b32 v2, 4, v176
    s_mov_b32 s58, 6979584
    buffer_load_dwordx4 v[136:139], v2, s[8:11], s58 offen offset:0
    buffer_load_dwordx4 v[140:143], v2, s[8:11], s58 offen offset:1024
    buffer_load_dwordx4 v[144:147], v2, s[8:11], s58 offen offset:2048
    buffer_load_dwordx4 v[148:151], v2, s[8:11], s58 offen offset:3072
    s_mov_b32 s58, 6983680
    buffer_load_dwordx4 v[152:155], v2, s[8:11], s58 offen offset:0
    buffer_load_dwordx4 v[156:159], v2, s[8:11], s58 offen offset:1024
    buffer_load_dwordx4 v[160:163], v2, s[8:11], s58 offen offset:2048
    buffer_load_dwordx4 v[164:167], v2, s[8:11], s58 offen offset:3072
    s_mov_b32 s58, 6987776
    buffer_load_dwordx4 v[168:171], v2, s[8:11], s58 offen offset:0
    buffer_load_dwordx4 v[172:175], v2, s[8:11], s58 offen offset:1024
    v_mul_u32_u24 v3, 1311, v177
    v_lshrrev_b32 v3, 16, v3
    v_mul_u32_u24 v3, 50, v3
    v_sub_u32 v3, v177, v3
    v_subrev_u32 v4, 32, v3
    v_mov_b32 v8, -1
    v_mov_b32 v5, 1.0
    v_cmp_gt_u32 vcc, 16, v4
    s_nop 1
    v_cndmask_b32 v8, v8, 0, vcc
    v_cmp_gt_u32 vcc, 4, v4
    s_nop 1
    v_cndmask_b32 v8, v8, v5, vcc
    v_lshlrev_b32 v6, 4, v177
    v_add_u32 v6, 65536, v6
    v_add_u32 v7, 64000, v6
    v_mov_b32 v9, v8
    v_mov_b32 v10, v8
    v_mov_b32 v11, v8
    v_cmp_gt_u32 vcc, 500, v177
    s_nop 0
    s_mov_b64 s[56:57], vcc
    s_mov_b64 exec, vcc
    ds_write_b128 v6, v[8:11] offset:0
    ds_write_b128 v6, v[8:11] offset:8000
    ds_write_b128 v6, v[8:11] offset:16000
    ds_write_b128 v6, v[8:11] offset:24000
    ds_write_b128 v6, v[8:11] offset:32000
    ds_write_b128 v6, v[8:11] offset:40000
    ds_write_b128 v6, v[8:11] offset:48000
    ds_write_b128 v6, v[8:11] offset:56000
    ds_write_b128 v7, v[8:11] offset:0
    ds_write_b128 v7, v[8:11] offset:8000
    ds_write_b128 v7, v[8:11] offset:16000
    ds_write_b128 v7, v[8:11] offset:24000
    s_mov_b64 exec, -1
    s_cmp_lg_u32 s20, 0
    s_cbranch_scc1 K2_NOH
    v_mov_b32 v3, 0
    v_lshlrev_b32 v4, 2, v176
    v_add_u32 v4, 161536, v4
    ds_write_b32 v4, v3 offset:544
    v_mov_b32 v5, 162048
    ds_write_b32 v5, v3
    s_cmp_lg_u32 s24, 0
    s_cbranch_scc1 K2_NOH
    ds_write_b32 v4, v3
    ds_write_b32 v5, v3 offset:4
K2_NOH:
    s_waitcnt vmcnt(0)
    v_cndmask_b32 v179, 0, v179, s[56:57]
    v_and_b32 v1, 1, v177
    v_add_u32 v1, s23, v1
    v_lshrrev_b32 v180, 16, v179
    v_sub_u32 v180, v180, v1
    v_and_b32 v179, 0xffff, v179
    v_add_u32 v179, v179, v1
    v_mul_u32_u24 v181, 20608, v178
    v_lshl_add_u32 v181, v179, 4, v181
    v_mul_u32_u24 v178, 1280, v178
    v_cmp_lt_i32 vcc, 0, v180
    s_nop 0
    s_cbranch_vccz K2_LD_DONE
    s_mov_b64 exec, vcc
    buffer_load_dwordx4 v[0:3], v181, s[8:11], 0 offen offset:0
    v_cmp_lt_i32 vcc, 2, v180
    s_nop 0
    s_cbranch_vccz K2_LD_DONE
    s_mov_b64 exec, vcc
    buffer_load_dwordx4 v[4:7], v181, s[8:11], 0 offen offset:32
    v_cmp_lt_i32 vcc, 4, v180
    s_nop 0
    s_cbranch_vccz K2_LD_DONE
    s_mov_b64 exec, vcc
    buffer_load_dwordx4 v[8:11], v181, s[8:11], 0 offen offset:64
    v_cmp_lt_i32 vcc, 6, v180
    s_nop 0
    s_cbranch_vccz K2_LD_DONE
    s_mov_b64 exec, vcc
    buffer_load_dwordx4 v[12:15], v181, s[8:11], 0 offen offset:96
    v_cmp_lt_i32 vcc, 8, v180
    s_nop 0
    s_cbranch_vccz K2_LD_DONE
    s_mov_b64 exec, vcc
    buffer_load_dwordx4 v[16:19], v181, s[8:11], 0 offen offset:128
    v_cmp_lt_i32 vcc, 10, v180
    s_nop 0
    s_cbranch_vccz K2_LD_DONE
    s_mov_b64 exec, vcc
    buffer_load_dwordx4 v[20:23], v181, s[8:11], 0 offen offset:160
    v_cmp_lt_i32 vcc, 12, v180
    s_nop 0
    s_cbranch_vccz K2_LD_DONE
    s_mov_b64 exec, vcc
    buffer_load_dwordx4 v[24:27], v181, s[8:11], 0 offen offset:192
    v_cmp_lt_i32 vcc, 14, v180
    s_nop 0
    s_cbranch_vccz K2_LD_DONE
    s_mov_b64 exec, vcc
    buffer_load_dwordx4 v[28:31], v181, s[8:11], 0 offen offset:224
    v_cmp_lt_i32 vcc, 16, v180
    s_nop 0
    s_cbranch_vccz K2_LD_DONE
    s_mov_b64 exec, vcc
    buffer_load_dwordx4 v[32:35], v181, s[8:11], 0 offen offset:256
    v_cmp_lt_i32 vcc, 18, v180
    s_nop 0
    s_cbranch_vccz K2_LD_DONE
    s_mov_b64 exec, vcc
    buffer_load_dwordx4 v[36:39], v181, s[8:11], 0 offen offset:288
K2_LD_DONE:
    s_mov_b64 exec, -1
    v_add_lshl_u32 v179, v179, v178, 2
    s_mov_b32 s66, 7340032
    v_and_b32 v60, 15, v176
    v_lshrrev_b32 v61, 5, v176
    v_bfe_u32 v62, v176, 4, 1
    v_lshrrev_b32 v63, 2, v60
    v_and_b32 v64, 3, v60
    v_lshl_add_u32 v65, v61, 3, v63
    v_lshlrev_b32 v249, 5, v65
    v_lshl_add_u32 v249, v64, 3, v249
    v_lshlrev_b32 v250, 6, v62
    v_lshl_add_u32 v250, v61, 5, v250
    v_add_u32 v250, 512, v250
    v_lshrrev_b32 v66, 1, v64
    v_lshl_add_u32 v66, v62, 1, v66
    v_bfe_u32 v67, v63, 1, 1
    v_lshlrev_b32 v67, 2, v67
    v_xor_b32 v66, v66, v67
    v_lshlrev_b32 v66, 4, v66
    v_lshl_add_u32 v66, v65, 7, v66
    v_and_b32 v67, 1, v64
    v_lshl_add_u32 v66, v67, 3, v66
    v_add_u32 v246, s37, v66
    v_xor_b32 v247, 64, v246
    v_lshrrev_b32 v66, 3, v176
    v_lshlrev_b32 v251, 2, v66
    v_add_u32 v251, 768, v251
    v_bfe_u32 v66, v66, 1, 1
    v_lshlrev_b32 v66, 2, v66
    v_and_b32 v67, 7, v176
    v_xor_b32 v66, v66, v67
    v_lshlrev_b32 v248, 4, v66
    v_lshlrev_b32 v252, 1, v176
    v_and_b32 v231, 1, v176
    v_lshlrev_b32 v231, 4, v231
    v_bfe_u32 v66, v176, 1, 4
    v_lshlrev_b32 v66, 5, v66
    v_mul_u32_u24 v230, 800, v61
    v_add_u32 v230, v230, v66
    v_mov_b32 v60, 1
    v_lshlrev_b32 v96, 16, v136
    v_and_b32 v97, 0xffff0000, v136
    v_lshlrev_b32 v98, 16, v137
    v_and_b32 v99, 0xffff0000, v137
    v_lshlrev_b32 v100, 16, v138
    v_and_b32 v101, 0xffff0000, v138
    v_lshlrev_b32 v102, 16, v139
    v_and_b32 v103, 0xffff0000, v139
    v_lshlrev_b32 v104, 16, v140
    v_and_b32 v105, 0xffff0000, v140
    v_lshlrev_b32 v106, 16, v141
    v_and_b32 v107, 0xffff0000, v141
    v_lshlrev_b32 v108, 16, v142
    v_and_b32 v109, 0xffff0000, v142
    v_lshlrev_b32 v110, 16, v143
    v_and_b32 v111, 0xffff0000, v143
    v_lshlrev_b32 v112, 16, v144
    v_and_b32 v113, 0xffff0000, v144
    v_lshlrev_b32 v114, 16, v145
    v_and_b32 v115, 0xffff0000, v145
    v_lshlrev_b32 v116, 16, v146
    v_and_b32 v117, 0xffff0000, v146
    v_lshlrev_b32 v118, 16, v147
    v_and_b32 v119, 0xffff0000, v147
    v_lshlrev_b32 v120, 16, v148
    v_and_b32 v121, 0xffff0000, v148
    v_lshlrev_b32 v122, 16, v149
    v_and_b32 v123, 0xffff0000, v149
    v_lshlrev_b32 v124, 16, v150
    v_and_b32 v125, 0xffff0000, v150
    v_lshlrev_b32 v126, 16, v151
    v_and_b32 v127, 0xffff0000, v151
    v_lshlrev_b32 v128, 16, v152
    v_and_b32 v129, 0xffff0000, v152
    v_lshlrev_b32 v130, 16, v153
    v_and_b32 v131, 0xffff0000, v153
    v_lshlrev_b32 v132, 16, v154
    v_and_b32 v133, 0xffff0000, v154
    v_lshlrev_b32 v134, 16, v155
    v_and_b32 v135, 0xffff0000, v155
    v_lshlrev_b32 v136, 16, v156
    v_and_b32 v137, 0xffff0000, v156
    v_lshlrev_b32 v138, 16, v157
    v_and_b32 v139, 0xffff0000, v157
    v_lshlrev_b32 v140, 16, v158
    v_and_b32 v141, 0xffff0000, v158
    v_lshlrev_b32 v142, 16, v159
    v_and_b32 v143, 0xffff0000, v159
    v_lshlrev_b32 v144, 16, v160
    v_and_b32 v145, 0xffff0000, v160
    v_lshlrev_b32 v146, 16, v161
    v_and_b32 v147, 0xffff0000, v161
    v_lshlrev_b32 v148, 16, v162
    v_and_b32 v149, 0xffff0000, v162
    v_lshlrev_b32 v150, 16, v163
    v_and_b32 v151, 0xffff0000, v163
    v_lshlrev_b32 v152, 16, v164
    v_and_b32 v153, 0xffff0000, v164
    v_lshlrev_b32 v154, 16, v165
    v_and_b32 v155, 0xffff0000, v165
    v_lshlrev_b32 v156, 16, v166
    v_and_b32 v157, 0xffff0000, v166
    v_lshlrev_b32 v158, 16, v167
    v_and_b32 v159, 0xffff0000, v167
    v_lshlrev_b32 v160, 16, v168
    v_and_b32 v161, 0xffff0000, v168
    v_lshlrev_b32 v162, 16, v169
    v_and_b32 v163, 0xffff0000, v169
    v_lshlrev_b32 v164, 16, v170
    v_and_b32 v165, 0xffff0000, v170
    v_lshlrev_b32 v166, 16, v171
    v_and_b32 v167, 0xffff0000, v171
    v_lshlrev_b32 v168, 16, v172
    v_and_b32 v169, 0xffff0000, v172
    v_lshlrev_b32 v170, 16, v173
    v_and_b32 v171, 0xffff0000, v173
    v_lshlrev_b32 v172, 16, v174
    v_and_b32 v173, 0xffff0000, v174
    v_lshlrev_b32 v174, 16, v175
    v_and_b32 v175, 0xffff0000, v175
    s_waitcnt lgkmcnt(0)
    s_barrier
    s_cmp_lg_u32 s24, 0
    s_cbranch_scc1 K2_RK_LOAD
    v_cmp_lt_i32 vcc, 20, v180
    s_nop 0
    s_cbranch_vccz K2_NOMORE
    v_mov_b32 v61, 162052
    ds_write_b32 v61, v60
K2_NOMORE:
    s_mov_b32 s58, 161536
    s_waitcnt vmcnt(0)
    v_cmp_lt_i32 vcc, 0, v180
    s_nop 0
    s_cbranch_vccz K2_RK_A
    s_mov_b64 exec, vcc
    v_lshrrev_b32 v50, 25, v3
    v_lshl_add_u32 v50, v50, 2, s58
    ds_add_rtn_u32 v40, v50, v60
    v_cmp_lt_i32 vcc, 2, v180
    s_nop 0
    s_cbranch_vccz K2_RK_A
    s_mov_b64 exec, vcc
    v_lshrrev_b32 v51, 25, v7
    v_lshl_add_u32 v51, v51, 2, s58
    ds_add_rtn_u32 v41, v51, v60
    v_cmp_lt_i32 vcc, 4, v180
    s_nop 0
    s_cbranch_vccz K2_RK_A
    s_mov_b64 exec, vcc
    v_lshrrev_b32 v52, 25, v11
    v_lshl_add_u32 v52, v52, 2, s58
    ds_add_rtn_u32 v42, v52, v60
    v_cmp_lt_i32 vcc, 6, v180
    s_nop 0
    s_cbranch_vccz K2_RK_A
    s_mov_b64 exec, vcc
    v_lshrrev_b32 v53, 25, v15
    v_lshl_add_u32 v53, v53, 2, s58
    ds_add_rtn_u32 v43, v53, v60
    v_cmp_lt_i32 vcc, 8, v180
    s_nop 0
    s_cbranch_vccz K2_RK_A
    s_mov_b64 exec, vcc
    v_lshrrev_b32 v54, 25, v19
    v_lshl_add_u32 v54, v54, 2, s58
    ds_add_rtn_u32 v44, v54, v60
    v_cmp_lt_i32 vcc, 10, v180
    s_nop 0
    s_cbranch_vccz K2_RK_A
    s_mov_b64 exec, vcc
    v_lshrrev_b32 v55, 25, v23
    v_lshl_add_u32 v55, v55, 2, s58
    ds_add_rtn_u32 v45, v55, v60
    v_cmp_lt_i32 vcc, 12, v180
    s_nop 0
    s_cbranch_vccz K2_RK_A
    s_mov_b64 exec, vcc
    v_lshrrev_b32 v56, 25, v27
    v_lshl_add_u32 v56, v56, 2, s58
    ds_add_rtn_u32 v46, v56, v60
    v_cmp_lt_i32 vcc, 14, v180
    s_nop 0
    s_cbranch_vccz K2_RK_A
    s_mov_b64 exec, vcc
    v_lshrrev_b32 v57, 25, v31
    v_lshl_add_u32 v57, v57, 2, s58
    ds_add_rtn_u32 v47, v57, v60
    v_cmp_lt_i32 vcc, 16, v180
    s_nop 0
    s_cbranch_vccz K2_RK_A
    s_mov_b64 exec, vcc
    v_lshrrev_b32 v58, 25, v35
    v_lshl_add_u32 v58, v58, 2, s58
    ds_add_rtn_u32 v48, v58, v60
    v_cmp_lt_i32 vcc, 18, v180
    s_nop 0
    s_cbranch_vccz K2_RK_A
    s_mov_b64 exec, vcc
    v_lshrrev_b32 v59, 25, v39
    v_lshl_add_u32 v59, v59, 2, s58
    ds_add_rtn_u32 v49, v59, v60
K2_RK_A:
    s_mov_b64 exec, -1
    s_branch K2_RK_DONE2
K2_RK_LOAD:
    s_mov_b32 s58, 161536
    s_waitcnt vmcnt(0)
    v_cmp_lt_i32 vcc, 0, v180
    s_nop 0
    s_cbranch_vccz K2_RK_B
    s_mov_b64 exec, vcc
    v_lshrrev_b32 v50, 25, v3
    v_lshl_add_u32 v50, v50, 2, s58
    buffer_load_dword v40, v179, s[8:11], s66 offen offset:0
    v_cmp_lt_i32 vcc, 2, v180
    s_nop 0
    s_cbranch_vccz K2_RK_B
    s_mov_b64 exec, vcc
    v_lshrrev_b32 v51, 25, v7
    v_lshl_add_u32 v51, v51, 2, s58
    buffer_load_dword v41, v179, s[8:11], s66 offen offset:8
    v_cmp_lt_i32 vcc, 4, v180
    s_nop 0
    s_cbranch_vccz K2_RK_B
    s_mov_b64 exec, vcc
    v_lshrrev_b32 v52, 25, v11
    v_lshl_add_u32 v52, v52, 2, s58
    buffer_load_dword v42, v179, s[8:11], s66 offen offset:16
    v_cmp_lt_i32 vcc, 6, v180
    s_nop 0
    s_cbranch_vccz K2_RK_B
    s_mov_b64 exec, vcc
    v_lshrrev_b32 v53, 25, v15
    v_lshl_add_u32 v53, v53, 2, s58
    buffer_load_dword v43, v179, s[8:11], s66 offen offset:24
    v_cmp_lt_i32 vcc, 8, v180
    s_nop 0
    s_cbranch_vccz K2_RK_B
    s_mov_b64 exec, vcc
    v_lshrrev_b32 v54, 25, v19
    v_lshl_add_u32 v54, v54, 2, s58
    buffer_load_dword v44, v179, s[8:11], s66 offen offset:32
    v_cmp_lt_i32 vcc, 10, v180
    s_nop 0
    s_cbranch_vccz K2_RK_B
    s_mov_b64 exec, vcc
    v_lshrrev_b32 v55, 25, v23
    v_lshl_add_u32 v55, v55, 2, s58
    buffer_load_dword v45, v179, s[8:11], s66 offen offset:40
    v_cmp_lt_i32 vcc, 12, v180
    s_nop 0
    s_cbranch_vccz K2_RK_B
    s_mov_b64 exec, vcc
    v_lshrrev_b32 v56, 25, v27
    v_lshl_add_u32 v56, v56, 2, s58
    buffer_load_dword v46, v179, s[8:11], s66 offen offset:48
    v_cmp_lt_i32 vcc, 14, v180
    s_nop 0
    s_cbranch_vccz K2_RK_B
    s_mov_b64 exec, vcc
    v_lshrrev_b32 v57, 25, v31
    v_lshl_add_u32 v57, v57, 2, s58
    buffer_load_dword v47, v179, s[8:11], s66 offen offset:56
    v_cmp_lt_i32 vcc, 16, v180
    s_nop 0
    s_cbranch_vccz K2_RK_B
    s_mov_b64 exec, vcc
    v_lshrrev_b32 v58, 25, v35
    v_lshl_add_u32 v58, v58, 2, s58
    buffer_load_dword v48, v179, s[8:11], s66 offen offset:64
    v_cmp_lt_i32 vcc, 18, v180
    s_nop 0
    s_cbranch_vccz K2_RK_B
    s_mov_b64 exec, vcc
    v_lshrrev_b32 v59, 25, v39
    v_lshl_add_u32 v59, v59, 2, s58
    buffer_load_dword v49, v179, s[8:11], s66 offen offset:72
K2_RK_B:
    s_mov_b64 exec, -1
    s_waitcnt vmcnt(0)
K2_RK_DONE2:
    v_lshlrev_b32 v192, 2, v176
    v_add_u32 v192, 161536, v192
    v_mov_b32 v200, 162052
    s_waitcnt lgkmcnt(0)
    s_barrier
    ds_read_b32 v193, v192
    ds_read_b32 v200, v200
    s_waitcnt lgkmcnt(0)
    v_readfirstlane_b32 s27, v200
K2_TCALC:
    s_mul_i32 s67, s24, s26
    v_subrev_u32 v194, s67, v193
    v_max_i32 v194, 0, v194
    v_min_i32 v194, s26, v194
    v_add_u32 v194, 15, v194
    v_lshrrev_b32 v194, 4, v194
    v_max_u32 v194, 1, v194
    v_max_u32 v195, 2, v194
    v_cmp_gt_u32 vcc, s22, v176
    s_nop 1
    v_cndmask_b32 v195, 0, v195, vcc
    v_mov_b32 v196, v195
    s_nop 1
    v_add_u32_dpp v196, v196, v196 row_shr:1 row_mask:0xf bank_mask:0xf bound_ctrl:0
    s_nop 1
    v_add_u32_dpp v196, v196, v196 row_shr:2 row_mask:0xf bank_mask:0xf bound_ctrl:0
    s_nop 1
    v_add_u32_dpp v196, v196, v196 row_shr:4 row_mask:0xf bank_mask:0xf bound_ctrl:0
    s_nop 1
    v_add_u32_dpp v196, v196, v196 row_shr:8 row_mask:0xf bank_mask:0xf bound_ctrl:0
    s_nop 1
    v_add_u32_dpp v196, v196, v196 row_bcast:15 row_mask:0xa bank_mask:0xf
    s_nop 1
    v_add_u32_dpp v196, v196, v196 row_bcast:31 row_mask:0xc bank_mask:0xf
    s_cmp_lg_u32 s26, 64
    s_cbranch_scc1 K2_TOK
    v_readlane_b32 s58, v196, 63
    v_cmp_lt_u32 vcc, 64, v193
    s_cmp_gt_u32 s58, 119
    s_cbranch_scc1 K2_SLOW
    s_cbranch_vccz K2_TOK
K2_SLOW:
    v_mov_b32 v197, v193
    s_nop 1
    v_max_u32_dpp v197, v197, v197 row_shr:1 row_mask:0xf bank_mask:0xf bound_ctrl:0
    s_nop 1
    v_max_u32_dpp v197, v197, v197 row_shr:2 row_mask:0xf bank_mask:0xf bound_ctrl:0
    s_nop 1
    v_max_u32_dpp v197, v197, v197 row_shr:4 row_mask:0xf bank_mask:0xf bound_ctrl:0
    s_nop 1
    v_max_u32_dpp v197, v197, v197 row_shr:8 row_mask:0xf bank_mask:0xf bound_ctrl:0
    s_nop 1
    v_max_u32_dpp v197, v197, v197 row_bcast:15 row_mask:0xa bank_mask:0xf
    s_nop 1
    v_max_u32_dpp v197, v197, v197 row_bcast:31 row_mask:0xc bank_mask:0xf
    s_nop 0
    v_readlane_b32 s25, v197, 63
    s_nop 0
    s_add_u32 s25, s25, 31
    s_lshr_b32 s25, s25, 5
    s_mov_b32 s26, 32
    v_cmp_lt_i32 vcc, 0, v180
    s_nop 0
    s_cbranch_vccz K2_SV_DONE
    s_mov_b64 exec, vcc
    buffer_store_dword v40, v179, s[8:11], s66 offen offset:0
    v_cmp_lt_i32 vcc, 2, v180
    s_nop 0
    s_cbranch_vccz K2_SV_DONE
    s_mov_b64 exec, vcc
    buffer_store_dword v41, v179, s[8:11], s66 offen offset:8
    v_cmp_lt_i32 vcc, 4, v180
    s_nop 0
    s_cbranch_vccz K2_SV_DONE
    s_mov_b64 exec, vcc
    buffer_store_dword v42, v179, s[8:11], s66 offen offset:16
    v_cmp_lt_i32 vcc, 6, v180
    s_nop 0
    s_cbranch_vccz K2_SV_DONE
    s_mov_b64 exec, vcc
    buffer_store_dword v43, v179, s[8:11], s66 offen offset:24
    v_cmp_lt_i32 vcc, 8, v180
    s_nop 0
    s_cbranch_vccz K2_SV_DONE
    s_mov_b64 exec, vcc
    buffer_store_dword v44, v179, s[8:11], s66 offen offset:32
    v_cmp_lt_i32 vcc, 10, v180
    s_nop 0
    s_cbranch_vccz K2_SV_DONE
    s_mov_b64 exec, vcc
    buffer_store_dword v45, v179, s[8:11], s66 offen offset:40
    v_cmp_lt_i32 vcc, 12, v180
    s_nop 0
    s_cbranch_vccz K2_SV_DONE
    s_mov_b64 exec, vcc
    buffer_store_dword v46, v179, s[8:11], s66 offen offset:48
    v_cmp_lt_i32 vcc, 14, v180
    s_nop 0
    s_cbranch_vccz K2_SV_DONE
    s_mov_b64 exec, vcc
    buffer_store_dword v47, v179, s[8:11], s66 offen offset:56
    v_cmp_lt_i32 vcc, 16, v180
    s_nop 0
    s_cbranch_vccz K2_SV_DONE
    s_mov_b64 exec, vcc
    buffer_store_dword v48, v179, s[8:11], s66 offen offset:64
    v_cmp_lt_i32 vcc, 18, v180
    s_nop 0
    s_cbranch_vccz K2_SV_DONE
    s_mov_b64 exec, vcc
    buffer_store_dword v49, v179, s[8:11], s66 offen offset:72
K2_SV_DONE:
    s_mov_b64 exec, -1
    s_branch K2_TCALC
K2_TOK:
    v_sub_u32 v196, v196, v195
    s_movk_i32 s58, 800
    v_mov_b32 v197, 65536
    v_mad_u32_u24 v196, v196, s58, v197
    ds_write_b32 v192, v196 offset:256
    v_lshlrev_b32 v197, 5, v176
    v_sub_u32 v197, v197, v196
    v_and_b32 v197, 0xff, v197
    v_cmp_lt_u32 vcc, 192, v197
    v_cmp_gt_u32 s[56:57], 3, v194
    s_nop 0
    s_and_b64 vcc, vcc, s[56:57]
    v_cndmask_b32 v197, v197, 0, vcc
    v_lshl_or_b32 v253, v194, 18, v196
    v_lshl_or_b32 v253, v197, 21, v253
    v_mov_b32 v197, 422880
    v_cmp_gt_u32 vcc, s22, v176
    s_nop 1
    v_cndmask_b32 v253, v197, v253, vcc
    s_waitcnt lgkmcnt(0)
    v_cmp_lt_i32 vcc, 0, v180
    s_nop 0
    s_cbranch_vccz K2_TB_DONE
    s_mov_b64 exec, vcc
    ds_read_b32 v50, v50 offset:256
    v_bfe_u32 v60, v3, 14, 11
    v_add_lshl_u32 v60, v60, v178, 5
    v_and_b32 v3, 0x3fff, v3
    v_subrev_u32 v40, s67, v40
    v_cmp_lt_i32 vcc, 2, v180
    s_nop 0
    s_cbranch_vccz K2_TB_DONE
    s_mov_b64 exec, vcc
    ds_read_b32 v51, v51 offset:256
    v_bfe_u32 v61, v7, 14, 11
    v_add_lshl_u32 v61, v61, v178, 5
    v_and_b32 v7, 0x3fff, v7
    v_subrev_u32 v41, s67, v41
    v_cmp_lt_i32 vcc, 4, v180
    s_nop 0
    s_cbranch_vccz K2_TB_DONE
    s_mov_b64 exec, vcc
    ds_read_b32 v52, v52 offset:256
    v_bfe_u32 v62, v11, 14, 11
    v_add_lshl_u32 v62, v62, v178, 5
    v_and_b32 v11, 0x3fff, v11
    v_subrev_u32 v42, s67, v42
    v_cmp_lt_i32 vcc, 6, v180
    s_nop 0
    s_cbranch_vccz K2_TB_DONE
    s_mov_b64 exec, vcc
    ds_read_b32 v53, v53 offset:256
    v_bfe_u32 v63, v15, 14, 11
    v_add_lshl_u32 v63, v63, v178, 5
    v_and_b32 v15, 0x3fff, v15
    v_subrev_u32 v43, s67, v43
    v_cmp_lt_i32 vcc, 8, v180
    s_nop 0
    s_cbranch_vccz K2_TB_DONE
    s_mov_b64 exec, vcc
    ds_read_b32 v54, v54 offset:256
    v_bfe_u32 v64, v19, 14, 11
    v_add_lshl_u32 v64, v64, v178, 5
    v_and_b32 v19, 0x3fff, v19
    v_subrev_u32 v44, s67, v44
    v_cmp_lt_i32 vcc, 10, v180
    s_nop 0
    s_cbranch_vccz K2_TB_DONE
    s_mov_b64 exec, vcc
    ds_read_b32 v55, v55 offset:256
    v_bfe_u32 v65, v23, 14, 11
    v_add_lshl_u32 v65, v65, v178, 5
    v_and_b32 v23, 0x3fff, v23
    v_subrev_u32 v45, s67, v45
    v_cmp_lt_i32 vcc, 12, v180
    s_nop 0
    s_cbranch_vccz K2_TB_DONE
    s_mov_b64 exec, vcc
    ds_read_b32 v56, v56 offset:256
    v_bfe_u32 v66, v27, 14, 11
    v_add_lshl_u32 v66, v66, v178, 5
    v_and_b32 v27, 0x3fff, v27
    v_subrev_u32 v46, s67, v46
    v_cmp_lt_i32 vcc, 14, v180
    s_nop 0
    s_cbranch_vccz K2_TB_DONE
    s_mov_b64 exec, vcc
    ds_read_b32 v57, v57 offset:256
    v_bfe_u32 v67, v31, 14, 11
    v_add_lshl_u32 v67, v67, v178, 5
    v_and_b32 v31, 0x3fff, v31
    v_subrev_u32 v47, s67, v47
    v_cmp_lt_i32 vcc, 16, v180
    s_nop 0
    s_cbranch_vccz K2_TB_DONE
    s_mov_b64 exec, vcc
    ds_read_b32 v58, v58 offset:256
    v_bfe_u32 v68, v35, 14, 11
    v_add_lshl_u32 v68, v68, v178, 5
    v_and_b32 v35, 0x3fff, v35
    v_subrev_u32 v48, s67, v48
    v_cmp_lt_i32 vcc, 18, v180
    s_nop 0
    s_cbranch_vccz K2_TB_DONE
    s_mov_b64 exec, vcc
    ds_read_b32 v59, v59 offset:256
    v_bfe_u32 v69, v39, 14, 11
    v_add_lshl_u32 v69, v69, v178, 5
    v_and_b32 v39, 0x3fff, v39
    v_subrev_u32 v49, s67, v49
K2_TB_DONE:
    s_mov_b64 exec, -1
    s_waitcnt lgkmcnt(0)
    v_cmp_lt_i32 vcc, 0, v180
    s_nop 0
    s_cbranch_vccz K2_SC_DONE
    v_cmp_gt_u32 s[56:57], s26, v40
    v_lshrrev_b32 v192, 4, v40
    v_mad_u32_u24 v192, v192, s58, v50
    v_and_b32 v193, 15, v40
    s_and_b64 exec, vcc, s[56:57]
    s_cbranch_execz K2_sc_1
    v_lshl_add_u32 v194, v193, 5, v192
    v_lshl_add_u32 v195, v193, 2, v192
    v_and_b32 v196, 7, v193
    v_lshrrev_b32 v193, 3, v193
    v_lshl_add_u32 v196, v196, 2, v192
    v_lshl_add_u32 v196, v193, 1, v196
    ds_write_b32 v194, v60
    ds_write2_b32 v195, v0, v1 offset0:144 offset1:160
    ds_write_b32 v195, v2 offset:704
    ds_write_b16 v196, v3 offset:768
K2_sc_1:
    s_mov_b64 exec, -1
    v_cmp_lt_i32 vcc, 2, v180
    s_nop 0
    s_cbranch_vccz K2_SC_DONE
    v_cmp_gt_u32 s[56:57], s26, v41
    v_lshrrev_b32 v192, 4, v41
    v_mad_u32_u24 v192, v192, s58, v51
    v_and_b32 v193, 15, v41
    s_and_b64 exec, vcc, s[56:57]
    s_cbranch_execz K2_sc_2
    v_lshl_add_u32 v194, v193, 5, v192
    v_lshl_add_u32 v195, v193, 2, v192
    v_and_b32 v196, 7, v193
    v_lshrrev_b32 v193, 3, v193
    v_lshl_add_u32 v196, v196, 2, v192
    v_lshl_add_u32 v196, v193, 1, v196
    ds_write_b32 v194, v61
    ds_write2_b32 v195, v4, v5 offset0:144 offset1:160
    ds_write_b32 v195, v6 offset:704
    ds_write_b16 v196, v7 offset:768
K2_sc_2:
    s_mov_b64 exec, -1
    v_cmp_lt_i32 vcc, 4, v180
    s_nop 0
    s_cbranch_vccz K2_SC_DONE
    v_cmp_gt_u32 s[56:57], s26, v42
    v_lshrrev_b32 v192, 4, v42
    v_mad_u32_u24 v192, v192, s58, v52
    v_and_b32 v193, 15, v42
    s_and_b64 exec, vcc, s[56:57]
    s_cbranch_execz K2_sc_3
    v_lshl_add_u32 v194, v193, 5, v192
    v_lshl_add_u32 v195, v193, 2, v192
    v_and_b32 v196, 7, v193
    v_lshrrev_b32 v193, 3, v193
    v_lshl_add_u32 v196, v196, 2, v192
    v_lshl_add_u32 v196, v193, 1, v196
    ds_write_b32 v194, v62
    ds_write2_b32 v195, v8, v9 offset0:144 offset1:160
    ds_write_b32 v195, v10 offset:704
    ds_write_b16 v196, v11 offset:768
K2_sc_3:
    s_mov_b64 exec, -1
    v_cmp_lt_i32 vcc, 6, v180
    s_nop 0
    s_cbranch_vccz K2_SC_DONE
    v_cmp_gt_u32 s[56:57], s26, v43
    v_lshrrev_b32 v192, 4, v43
    v_mad_u32_u24 v192, v192, s58, v53
    v_and_b32 v193, 15, v43
    s_and_b64 exec, vcc, s[56:57]
    s_cbranch_execz K2_sc_4
    v_lshl_add_u32 v194, v193, 5, v192
    v_lshl_add_u32 v195, v193, 2, v192
    v_and_b32 v196, 7, v193
    v_lshrrev_b32 v193, 3, v193
    v_lshl_add_u32 v196, v196, 2, v192
    v_lshl_add_u32 v196, v193, 1, v196
    ds_write_b32 v194, v63
    ds_write2_b32 v195, v12, v13 offset0:144 offset1:160
    ds_write_b32 v195, v14 offset:704
    ds_write_b16 v196, v15 offset:768
K2_sc_4:
    s_mov_b64 exec, -1
    v_cmp_lt_i32 vcc, 8, v180
    s_nop 0
    s_cbranch_vccz K2_SC_DONE
    v_cmp_gt_u32 s[56:57], s26, v44
    v_lshrrev_b32 v192, 4, v44
    v_mad_u32_u24 v192, v192, s58, v54
    v_and_b32 v193, 15, v44
    s_and_b64 exec, vcc, s[56:57]
    s_cbranch_execz K2_sc_5
    v_lshl_add_u32 v194, v193, 5, v192
    v_lshl_add_u32 v195, v193, 2, v192
    v_and_b32 v196, 7, v193
    v_lshrrev_b32 v193, 3, v193
    v_lshl_add_u32 v196, v196, 2, v192
    v_lshl_add_u32 v196, v193, 1, v196
    ds_write_b32 v194, v64
    ds_write2_b32 v195, v16, v17 offset0:144 offset1:160
    ds_write_b32 v195, v18 offset:704
    ds_write_b16 v196, v19 offset:768
K2_sc_5:
    s_mov_b64 exec, -1
    v_cmp_lt_i32 vcc, 10, v180
    s_nop 0
    s_cbranch_vccz K2_SC_DONE
    v_cmp_gt_u32 s[56:57], s26, v45
    v_lshrrev_b32 v192, 4, v45
    v_mad_u32_u24 v192, v192, s58, v55
    v_and_b32 v193, 15, v45
    s_and_b64 exec, vcc, s[56:57]
    s_cbranch_execz K2_sc_6
    v_lshl_add_u32 v194, v193, 5, v192
    v_lshl_add_u32 v195, v193, 2, v192
    v_and_b32 v196, 7, v193
    v_lshrrev_b32 v193, 3, v193
    v_lshl_add_u32 v196, v196, 2, v192
    v_lshl_add_u32 v196, v193, 1, v196
    ds_write_b32 v194, v65
    ds_write2_b32 v195, v20, v21 offset0:144 offset1:160
    ds_write_b32 v195, v22 offset:704
    ds_write_b16 v196, v23 offset:768
K2_sc_6:
    s_mov_b64 exec, -1
    v_cmp_lt_i32 vcc, 12, v180
    s_nop 0
    s_cbranch_vccz K2_SC_DONE
    v_cmp_gt_u32 s[56:57], s26, v46
    v_lshrrev_b32 v192, 4, v46
    v_mad_u32_u24 v192, v192, s58, v56
    v_and_b32 v193, 15, v46
    s_and_b64 exec, vcc, s[56:57]
    s_cbranch_execz K2_sc_7
    v_lshl_add_u32 v194, v193, 5, v192
    v_lshl_add_u32 v195, v193, 2, v192
    v_and_b32 v196, 7, v193
    v_lshrrev_b32 v193, 3, v193
    v_lshl_add_u32 v196, v196, 2, v192
    v_lshl_add_u32 v196, v193, 1, v196
    ds_write_b32 v194, v66
    ds_write2_b32 v195, v24, v25 offset0:144 offset1:160
    ds_write_b32 v195, v26 offset:704
    ds_write_b16 v196, v27 offset:768
K2_sc_7:
    s_mov_b64 exec, -1
    v_cmp_lt_i32 vcc, 14, v180
    s_nop 0
    s_cbranch_vccz K2_SC_DONE
    v_cmp_gt_u32 s[56:57], s26, v47
    v_lshrrev_b32 v192, 4, v47
    v_mad_u32_u24 v192, v192, s58, v57
    v_and_b32 v193, 15, v47
    s_and_b64 exec, vcc, s[56:57]
    s_cbranch_execz K2_sc_8
    v_lshl_add_u32 v194, v193, 5, v192
    v_lshl_add_u32 v195, v193, 2, v192
    v_and_b32 v196, 7, v193
    v_lshrrev_b32 v193, 3, v193
    v_lshl_add_u32 v196, v196, 2, v192
    v_lshl_add_u32 v196, v193, 1, v196
    ds_write_b32 v194, v67
    ds_write2_b32 v195, v28, v29 offset0:144 offset1:160
    ds_write_b32 v195, v30 offset:704
    ds_write_b16 v196, v31 offset:768
K2_sc_8:
    s_mov_b64 exec, -1
    v_cmp_lt_i32 vcc, 16, v180
    s_nop 0
    s_cbranch_vccz K2_SC_DONE
    v_cmp_gt_u32 s[56:57], s26, v48
    v_lshrrev_b32 v192, 4, v48
    v_mad_u32_u24 v192, v192, s58, v58
    v_and_b32 v193, 15, v48
    s_and_b64 exec, vcc, s[56:57]
    s_cbranch_execz K2_sc_9
    v_lshl_add_u32 v194, v193, 5, v192
    v_lshl_add_u32 v195, v193, 2, v192
    v_and_b32 v196, 7, v193
    v_lshrrev_b32 v193, 3, v193
    v_lshl_add_u32 v196, v196, 2, v192
    v_lshl_add_u32 v196, v193, 1, v196
    ds_write_b32 v194, v68
    ds_write2_b32 v195, v32, v33 offset0:144 offset1:160
    ds_write_b32 v195, v34 offset:704
    ds_write_b16 v196, v35 offset:768
K2_sc_9:
    s_mov_b64 exec, -1
    v_cmp_lt_i32 vcc, 18, v180
    s_nop 0
    s_cbranch_vccz K2_SC_DONE
    v_cmp_gt_u32 s[56:57], s26, v49
    v_lshrrev_b32 v192, 4, v49
    v_mad_u32_u24 v192, v192, s58, v59
    v_and_b32 v193, 15, v49
    s_and_b64 exec, vcc, s[56:57]
    s_cbranch_execz K2_sc_10
    v_lshl_add_u32 v194, v193, 5, v192
    v_lshl_add_u32 v195, v193, 2, v192
    v_and_b32 v196, 7, v193
    v_lshrrev_b32 v193, 3, v193
    v_lshl_add_u32 v196, v196, 2, v192
    v_lshl_add_u32 v196, v193, 1, v196
    ds_write_b32 v194, v69
    ds_write2_b32 v195, v36, v37 offset0:144 offset1:160
    ds_write_b32 v195, v38 offset:704
    ds_write_b16 v196, v39 offset:768
K2_sc_10:
    s_mov_b64 exec, -1
K2_SC_DONE:
    s_movk_i32 s40, 0
    s_movk_i32 s41, 256
    s_movk_i32 s42, 512
    s_movk_i32 s43, 768
    s_mov_b32 s38, 0
    s_mov_b32 s34, 0
    s_mov_b32 s35, 0
    s_mov_b32 s36, 1
    s_mov_b32 s31, 0
    s_mov_b32 s58, s20
    v_readlane_b32 s59, v253, s58
    s_lshl_b32 s44, s34, 7
    s_and_b32 s48, s59, 0x3ffff
    s_bfe_u32 s33, s59, 0x30012
    s_lshr_b32 s60, s59, 21
    s_add_u32 s60, s60, s48
    s_mul_i32 s35, s38, 6
    s_cmp_eq_u32 s34, 0
    s_cselect_b32 s35, s35, s60
    s_mov_b32 s45, s44
    s_add_u32 s47, s44, 256
    s_add_u32 s49, s48, 800
    s_add_u32 s60, s48, 1600
    s_cmp_eq_u32 s33, 3
    s_cselect_b32 s46, s44, s47
    s_cselect_b32 s50, s60, s48
    s_cselect_b32 s51, s48, s49
    s_sub_u32 s60, s33, 2
    s_cmp_lt_u32 s60, 2
    s_cbranch_scc0 K2_rare_11
K2_back_12:
    s_waitcnt lgkmcnt(0)
    s_barrier
    v_add_u32 v232, s48, v230
    v_add_u32 v233, s50, v230
    ds_read_b32 v232, v232
    ds_read_b32 v233, v233
    v_add_u32 v222, s48, v251
    ds_read_b32 v222, v222
    v_add_u32 v224, s49, v251
    ds_read_b32 v224, v224
    v_add_u32 v226, s50, v251
    ds_read_b32 v226, v226
    v_add_u32 v228, s51, v251
    ds_read_b32 v228, v228
    s_waitcnt lgkmcnt(4)
    v_or_b32 v232, v232, v231
    v_or_b32 v233, v233, v231
    s_cmp_lg_u32 s34, 0
    s_cbranch_scc1 K2_dum_14
    s_mov_b32 m0, s48
    s_mov_b32 exec_hi, 0
    buffer_load_dwordx4 v232, s[16:19], 0 offen  lds
    s_mov_b32 m0, s50
    s_add_u32 s65, s48, 288
    buffer_load_dwordx4 v233, s[16:19], 0 offen  lds
    s_not_b64 exec, exec
    s_mov_b32 m0, s65
    s_cmp_eq_u32 s33, 4
    buffer_load_dwordx4 v232, s[16:19], 0 offen  lds
    s_cbranch_scc1 K2_a4_15
K2_b4_17:
    s_mov_b32 exec_lo, -1
K2_back_16:
    s_waitcnt lgkmcnt(3)
    v_mad_u32_u16 v223, v222, s39, v248 op_sel:[1,0,0,0]
    v_mad_u32_u16 v222, v222, s39, v248
    s_waitcnt lgkmcnt(2)
    v_mad_u32_u16 v225, v224, s39, v248 op_sel:[1,0,0,0]
    v_mad_u32_u16 v224, v224, s39, v248
    s_waitcnt lgkmcnt(1)
    v_mad_u32_u16 v227, v226, s39, v248 op_sel:[1,0,0,0]
    v_mad_u32_u16 v226, v226, s39, v248
    s_waitcnt lgkmcnt(0)
    v_mad_u32_u16 v229, v228, s39, v248 op_sel:[1,0,0,0]
    v_mad_u32_u16 v228, v228, s39, v248
    s_mov_b32 m0, s68
    s_nop 0
    buffer_load_dwordx4 v222, s[4:7], s44 offen lds
    buffer_load_dwordx4 v223, s[72:75], s44 offen offset:1024 lds
    s_mov_b32 m0, s69
    s_nop 0
    buffer_load_dwordx4 v224, s[4:7], s45 offen lds
    buffer_load_dwordx4 v225, s[72:75], s45 offen offset:1024 lds
    s_mov_b32 m0, s70
    s_nop 0
    buffer_load_dwordx4 v226, s[4:7], s46 offen lds
    buffer_load_dwordx4 v227, s[72:75], s46 offen offset:1024 lds
    s_mov_b32 m0, s71
    s_nop 0
    buffer_load_dwordx4 v228, s[4:7], s47 offen lds
    buffer_load_dwordx4 v229, s[72:75], s47 offen offset:1024 lds
    v_add_u32 v249, s48, v249
    v_add_u32 v250, s48, v250
    s_waitcnt vmcnt(6)
    ds_read_b64_tr_b16 v[176:177], v246 offset:0
    ds_read_b64_tr_b16 v[178:179], v246 offset:512
    ds_read_b64_tr_b16 v[180:181], v247 offset:0
    ds_read_b64_tr_b16 v[182:183], v247 offset:512
    ds_read_b64_tr_b16 v[0:1], v249 offset:0
    ds_read_b64_tr_b16 v[2:3], v249 offset:128
    ds_read_b128 v[4:7], v250 offset:0
    ds_read_b128 v[8:11], v250 offset:16
    ds_read_b128 v[12:15], v250 offset:128
    ds_read_b128 v[16:19], v250 offset:144
    ds_read_b64_tr_b16 v[20:21], v249 offset:800
    ds_read_b64_tr_b16 v[22:23], v249 offset:928
    ds_read_b128 v[24:27], v250 offset:800
    ds_read_b128 v[28:31], v250 offset:816
    ds_read_b128 v[32:35], v250 offset:928
    ds_read_b128 v[36:39], v250 offset:944
    s_mov_b32 s29, s48
    s_mov_b32 s32, s31
    s_mov_b32 s31, s35
    s_cmp_eq_u32 s33, 2
    s_cbranch_scc1 K2_U20
    s_cmp_eq_u32 s33, 3
    s_cbranch_scc1 K2_U30
    s_cmp_eq_u32 s33, 1
    s_cbranch_scc1 K2_U10
    s_branch K2_U40
K2_U20:
    s_setprio 1
    s_waitcnt lgkmcnt(10)
    v_lshlrev_b32 v40, 16, v0
    v_and_b32 v41, 0xffff0000, v0
    v_lshlrev_b32 v42, 16, v1
    v_and_b32 v43, 0xffff0000, v1
    v_lshlrev_b32 v44, 16, v2
    v_and_b32 v45, 0xffff0000, v2
    v_lshlrev_b32 v46, 16, v3
    v_and_b32 v47, 0xffff0000, v3
    s_waitcnt lgkmcnt(8)
    v_mul_f32 v4, v40, v4
    v_mul_f32 v5, v41, v5
    v_mul_f32 v6, v42, v6
    v_mul_f32 v7, v43, v7
    v_mul_f32 v8, v44, v8
    v_mul_f32 v9, v45, v9
    v_mul_f32 v10, v46, v10
    v_mul_f32 v11, v47, v11
    v_cvt_pk_bf16_f32 v64, v4, v5
    v_cvt_pk_bf16_f32 v65, v6, v7
    v_cvt_pk_bf16_f32 v66, v8, v9
    v_cvt_pk_bf16_f32 v67, v10, v11
    s_waitcnt lgkmcnt(6)
    v_mul_f32 v12, v40, v12
    v_mul_f32 v13, v41, v13
    v_mul_f32 v14, v42, v14
    v_mul_f32 v15, v43, v15
    v_mul_f32 v16, v44, v16
    v_mul_f32 v17, v45, v17
    v_mul_f32 v18, v46, v18
    v_mul_f32 v19, v47, v19
    v_cvt_pk_bf16_f32 v68, v12, v13
    v_cvt_pk_bf16_f32 v69, v14, v15
    v_cvt_pk_bf16_f32 v70, v16, v17
    v_cvt_pk_bf16_f32 v71, v18, v19
    s_waitcnt lgkmcnt(4)
    v_lshlrev_b32 v48, 16, v20
    v_and_b32 v49, 0xffff0000, v20
    v_lshlrev_b32 v50, 16, v21
    v_and_b32 v51, 0xffff0000, v21
    v_lshlrev_b32 v52, 16, v22
    v_and_b32 v53, 0xffff0000, v22
    v_lshlrev_b32 v54, 16, v23
    v_and_b32 v55, 0xffff0000, v23
    s_waitcnt lgkmcnt(2)
    v_mul_f32 v24, v48, v24
    v_mul_f32 v25, v49, v25
    v_mul_f32 v26, v50, v26
    v_mul_f32 v27, v51, v27
    v_mul_f32 v28, v52, v28
    v_mul_f32 v29, v53, v29
    v_mul_f32 v30, v54, v30
    v_mul_f32 v31, v55, v31
    v_cvt_pk_bf16_f32 v72, v24, v25
    v_cvt_pk_bf16_f32 v73, v26, v27
    v_cvt_pk_bf16_f32 v74, v28, v29
    v_cvt_pk_bf16_f32 v75, v30, v31
    s_waitcnt lgkmcnt(0)
    v_mul_f32 v32, v48, v32
    v_mul_f32 v33, v49, v33
    v_mul_f32 v34, v50, v34
    v_mul_f32 v35, v51, v35
    v_mul_f32 v36, v52, v36
    v_mul_f32 v37, v53, v37
    v_mul_f32 v38, v54, v38
    v_mul_f32 v39, v55, v39
    v_cvt_pk_bf16_f32 v76, v32, v33
    v_cvt_pk_bf16_f32 v77, v34, v35
    v_cvt_pk_bf16_f32 v78, v36, v37
    v_cvt_pk_bf16_f32 v79, v38, v39
    s_waitcnt vmcnt(4)
    v_mfma_f32_32x32x16_bf16 v[0:15], v[64:67], v[176:179], 0
    ds_read_b64_tr_b16 v[184:185], v246 offset:2048
    ds_read_b64_tr_b16 v[186:187], v246 offset:2560
    ds_read_b64_tr_b16 v[188:189], v247 offset:2048
    ds_read_b64_tr_b16 v[190:191], v247 offset:2560
    s_mov_b32 m0, s68
    v_mfma_f32_32x32x16_bf16 v[16:31], v[68:71], v[176:179], 0
    buffer_load_dwordx4 v222, s[4:7], s42 offen lds
    buffer_load_dwordx4 v223, s[72:75], s42 offen offset:1024 lds
    v_permlane32_swap_b32 v242, v243
    v_permlane32_swap_b32 v240, v241
    s_add_u32 s38, s38, 1
    v_mfma_f32_32x32x16_bf16 v[32:47], v[64:67], v[180:183], 0
    v_permlane32_swap_b32 v236, v237
    v_permlane32_swap_b32 v244, v245
    v_add_f32 v242, v242, v243
    v_add_f32 v240, -v240, -v241
    v_add_f32 v236, v236, v237
    v_mfma_f32_32x32x16_bf16 v[48:63], v[68:71], v[180:183], 0
    v_add_f32 v244, v244, v245
    s_set_gpr_idx_on s32, gpr_idx(DST)
    s_nop 0
    v_cvt_pk_bf16_f32 v195, v242, v236
    v_cvt_pk_bf16_f32 v196, v244, v240
    v_cvt_pk_bf16_f32 v197, v238, v238
    s_set_gpr_idx_off
    s_waitcnt vmcnt(4) lgkmcnt(0)
    v_mfma_f32_32x32x16_bf16 v[0:15], v[72:75], v[184:187], v[0:15]
    ds_read_b64_tr_b16 v[176:177], v246 offset:4096
    ds_read_b64_tr_b16 v[178:179], v246 offset:4608
    ds_read_b64_tr_b16 v[180:181], v247 offset:4096
    ds_read_b64_tr_b16 v[182:183], v247 offset:4608
    v_mov_b32 v254, s52
    v_mov_b32 v255, s38
    s_mov_b32 m0, s69
    v_mfma_f32_32x32x16_bf16 v[16:31], v[76:79], v[184:187], v[16:31]
    buffer_load_dwordx4 v224, s[4:7], s42 offen lds
    buffer_load_dwordx4 v225, s[72:75], s42 offen offset:1024 lds
    s_lshl_b32 s58, s38, 3
    s_add_u32 s58, s58, s20
    s_mov_b64 exec, 1
    ds_write_b32 v254, v255
    s_mov_b64 exec, -1
    s_cmp_lt_u32 s58, s22
    s_cbranch_scc0 K2_dyn_18
K2_back_19:
    v_readlane_b32 s59, v253, s58
    s_lshl_b32 s44, s34, 7
    s_and_b32 s48, s59, 0x3ffff
    s_bfe_u32 s33, s59, 0x30012
    s_lshr_b32 s60, s59, 21
    s_add_u32 s60, s60, s48
    s_mul_i32 s35, s38, 6
    s_cmp_eq_u32 s34, 0
    s_cselect_b32 s35, s35, s60
    s_mov_b32 s45, s44
    s_add_u32 s47, s44, 256
    s_add_u32 s49, s48, 800
    s_add_u32 s60, s48, 1600
    s_cmp_eq_u32 s33, 3
    s_cselect_b32 s46, s44, s47
    s_cselect_b32 s50, s60, s48
    s_cselect_b32 s51, s48, s49
    s_sub_u32 s60, s33, 2
    s_cmp_lt_u32 s60, 2
    s_cbranch_scc0 K2_rare_24
K2_back_25:
    v_mfma_f32_32x32x16_bf16 v[32:47], v[72:75], v[188:191], v[32:47]
    v_add_u32 v232, s48, v230
    v_add_u32 v233, s50, v230
    ds_read_b32 v232, v232
    ds_read_b32 v233, v233
    v_mul_f32 v234, v0, v96
    v_mul_f32 v236, v8, v128
    v_fmac_f32 v234, v1, v97
    v_mfma_f32_32x32x16_bf16 v[48:63], v[76:79], v[188:191], v[48:63]
    s_setprio 0
    v_fmac_f32 v236, v9, v129
    v_fmac_f32 v234, v2, v98
    v_fmac_f32 v236, v10, v130
    v_fmac_f32 v234, v3, v99
    v_fmac_f32 v236, v11, v131
    v_fmac_f32 v234, v4, v100
    v_fmac_f32 v236, v12, v132
    v_fmac_f32 v234, v5, v101
    v_fmac_f32 v236, v13, v133
    v_fmac_f32 v234, v6, v102
    v_fmac_f32 v236, v14, v134
    v_fmac_f32 v234, v7, v103
    v_fmac_f32 v236, v15, v135
    v_mul_f32 v238, v16, v128
    v_mul_f32 v240, v24, v128
    v_fmac_f32 v238, v17, v129
    v_fmac_f32 v240, v25, v129
    v_fmac_f32 v238, v18, v130
    v_fmac_f32 v240, v26, v130
    v_fmac_f32 v238, v19, v131
    v_fmac_f32 v240, v27, v131
    v_fmac_f32 v238, v20, v132
    v_fmac_f32 v240, v28, v132
    v_fmac_f32 v238, v21, v133
    v_fmac_f32 v240, v29, v133
    v_fmac_f32 v238, v22, v134
    v_fmac_f32 v240, v30, v134
    v_fmac_f32 v238, v23, v135
    v_fmac_f32 v240, v31, v135
    v_mul_f32 v235, v32, v104
    v_mul_f32 v237, v40, v136
    v_fmac_f32 v235, v33, v105
    v_fmac_f32 v237, v41, v137
    v_fmac_f32 v235, v34, v106
    v_fmac_f32 v237, v42, v138
    v_fmac_f32 v235, v35, v107
    v_fmac_f32 v237, v43, v139
    v_fmac_f32 v235, v36, v108
    v_fmac_f32 v237, v44, v140
    v_fmac_f32 v235, v37, v109
    v_fmac_f32 v237, v45, v141
    v_fmac_f32 v235, v38, v110
    v_fmac_f32 v237, v46, v142
    v_fmac_f32 v235, v39, v111
    v_fmac_f32 v237, v47, v143
    v_mul_f32 v239, v48, v136
    v_mul_f32 v241, v56, v136
    v_fmac_f32 v239, v49, v137
    v_fmac_f32 v241, v57, v137
    s_setprio 1
    s_waitcnt vmcnt(4) lgkmcnt(3)
    v_mfma_f32_32x32x16_bf16 v[0:15], v[64:67], v[176:179], 0
    ds_read_b64_tr_b16 v[184:185], v246 offset:6144
    ds_read_b64_tr_b16 v[186:187], v246 offset:6656
    ds_read_b64_tr_b16 v[188:189], v247 offset:6144
    ds_read_b64_tr_b16 v[190:191], v247 offset:6656
    v_fmac_f32 v239, v50, v138
    v_fmac_f32 v241, v58, v138
    s_mov_b32 m0, s70
    v_mfma_f32_32x32x16_bf16 v[16:31], v[68:71], v[176:179], 0
    buffer_load_dwordx4 v222, s[4:7], s43 offen lds
    buffer_load_dwordx4 v223, s[72:75], s43 offen offset:1024 lds
    v_fmac_f32 v239, v51, v139
    v_fmac_f32 v241, v59, v139
    v_fmac_f32 v239, v52, v140
    v_fmac_f32 v241, v60, v140
    v_fmac_f32 v239, v53, v141
    v_mfma_f32_32x32x16_bf16 v[32:47], v[64:67], v[180:183], 0
    v_add_u32 v222, s48, v251
    ds_read_b32 v222, v222
    v_fmac_f32 v241, v61, v141
    v_fmac_f32 v239, v54, v142
    v_fmac_f32 v241, v62, v142
    v_fmac_f32 v239, v55, v143
    v_fmac_f32 v241, v63, v143
    v_mfma_f32_32x32x16_bf16 v[48:63], v[68:71], v[180:183], 0
    v_permlane32_swap_b32 v234, v235
    v_permlane32_swap_b32 v236, v237
    v_permlane32_swap_b32 v238, v239
    s_waitcnt lgkmcnt(5)
    v_or_b32 v232, v232, v231
    v_or_b32 v233, v233, v231
    s_cmp_lg_u32 s34, 0
    s_cbranch_scc1 K2_dum_27
    s_mov_b32 m0, s48
    s_mov_b32 exec_hi, 0
    buffer_load_dwordx4 v232, s[16:19], 0 offen  lds
    s_mov_b32 m0, s50
    s_add_u32 s65, s48, 288
    buffer_load_dwordx4 v233, s[16:19], 0 offen  lds
    s_not_b64 exec, exec
    s_mov_b32 m0, s65
    s_cmp_eq_u32 s33, 4
    buffer_load_dwordx4 v232, s[16:19], 0 offen  lds
    s_cbranch_scc1 K2_a4_28
K2_b4_30:
    s_mov_b32 exec_lo, -1
K2_back_29:
    s_waitcnt vmcnt(7) lgkmcnt(1)
    v_mfma_f32_32x32x16_bf16 v[0:15], v[72:75], v[184:187], v[0:15]
    ds_read_b64_tr_b16 v[176:177], v246 offset:0
    ds_read_b64_tr_b16 v[178:179], v246 offset:512
    ds_read_b64_tr_b16 v[180:181], v247 offset:0
    ds_read_b64_tr_b16 v[182:183], v247 offset:512
    v_permlane32_swap_b32 v240, v241
    s_mov_b32 m0, s71
    v_mfma_f32_32x32x16_bf16 v[16:31], v[76:79], v[184:187], v[16:31]
    buffer_load_dwordx4 v224, s[4:7], s43 offen lds
    buffer_load_dwordx4 v225, s[72:75], s43 offen offset:1024 lds
    s_waitcnt lgkmcnt(4)
    v_mad_u32_u16 v223, v222, s39, v248 op_sel:[1,0,0,0]
    v_mad_u32_u16 v222, v222, s39, v248
    v_add_f32 v234, v234, v235
    v_add_f32 v236, v236, v237
    v_add_f32 v238, v238, v239
    v_add_f32 v240, v240, v241
    s_set_gpr_idx_on s31, gpr_idx(DST)
    s_nop 0
    v_cvt_pk_bf16_f32 v192, v234, v236
    v_cvt_pk_bf16_f32 v193, v238, v240
    s_set_gpr_idx_off
    v_mfma_f32_32x32x16_bf16 v[32:47], v[72:75], v[188:191], v[32:47]
    v_add_u32 v224, s49, v251
    ds_read_b32 v224, v224
    v_mul_f32 v234, v0, v144
    v_mul_f32 v236, v8, v112
    v_fmac_f32 v234, v1, v145
    v_fmac_f32 v236, v9, v113
    v_fmac_f32 v234, v2, v146
    v_mfma_f32_32x32x16_bf16 v[48:63], v[76:79], v[188:191], v[48:63]
    s_setprio 0
    v_fmac_f32 v236, v10, v114
    v_fmac_f32 v234, v3, v147
    v_fmac_f32 v236, v11, v115
    v_fmac_f32 v234, v4, v148
    v_fmac_f32 v236, v12, v116
    v_fmac_f32 v234, v5, v149
    v_fmac_f32 v236, v13, v117
    v_fmac_f32 v234, v6, v150
    v_fmac_f32 v236, v14, v118
    v_fmac_f32 v234, v7, v151
    v_fmac_f32 v236, v15, v119
    v_mul_f32 v238, v16, v160
    v_mul_f32 v240, v24, v160
    v_fmac_f32 v238, v17, v161
    v_fmac_f32 v240, v25, v161
    v_fmac_f32 v238, v18, v162
    v_fmac_f32 v240, v26, v162
    v_fmac_f32 v238, v19, v163
    v_fmac_f32 v240, v27, v163
    v_fmac_f32 v238, v20, v164
    v_fmac_f32 v240, v28, v164
    v_fmac_f32 v238, v21, v165
    v_fmac_f32 v240, v29, v165
    v_fmac_f32 v238, v22, v166
    v_fmac_f32 v240, v30, v166
    v_fmac_f32 v238, v23, v167
    v_fmac_f32 v240, v31, v167
    v_mul_f32 v235, v32, v152
    v_mul_f32 v237, v40, v120
    v_fmac_f32 v235, v33, v153
    v_fmac_f32 v237, v41, v121
    v_fmac_f32 v235, v34, v154
    v_fmac_f32 v237, v42, v122
    v_fmac_f32 v235, v35, v155
    v_fmac_f32 v237, v43, v123
    v_fmac_f32 v235, v36, v156
    v_fmac_f32 v237, v44, v124
    v_fmac_f32 v235, v37, v157
    v_fmac_f32 v237, v45, v125
    v_fmac_f32 v235, v38, v158
    v_fmac_f32 v237, v46, v126
    v_fmac_f32 v235, v39, v159
    v_fmac_f32 v237, v47, v127
    v_mul_f32 v239, v48, v168
    v_mul_f32 v241, v56, v168
    v_fmac_f32 v239, v49, v169
    v_fmac_f32 v241, v57, v169
    v_fmac_f32 v239, v50, v170
    v_fmac_f32 v241, v58, v170
    v_fmac_f32 v239, v51, v171
    s_setprio 1
    s_waitcnt vmcnt(7) lgkmcnt(1)
    v_mfma_f32_32x32x16_bf16 v[0:15], v[64:67], v[176:179], 0
    ds_read_b64_tr_b16 v[184:185], v246 offset:2048
    ds_read_b64_tr_b16 v[186:187], v246 offset:2560
    ds_read_b64_tr_b16 v[188:189], v247 offset:2048
    ds_read_b64_tr_b16 v[190:191], v247 offset:2560
    v_fmac_f32 v241, v59, v171
    v_fmac_f32 v239, v52, v172
    s_mov_b32 m0, s68
    v_mfma_f32_32x32x16_bf16 v[16:31], v[68:71], v[176:179], 0
    buffer_load_dwordx4 v222, s[4:7], s44 offen lds
    buffer_load_dwordx4 v223, s[72:75], s44 offen offset:1024 lds
    s_waitcnt lgkmcnt(4)
    v_mad_u32_u16 v225, v224, s39, v248 op_sel:[1,0,0,0]
    v_mad_u32_u16 v224, v224, s39, v248
    v_fmac_f32 v241, v60, v172
    v_fmac_f32 v239, v53, v173
    v_mfma_f32_32x32x16_bf16 v[32:47], v[64:67], v[180:183], 0
    v_add_u32 v226, s50, v251
    ds_read_b32 v226, v226
    v_fmac_f32 v241, v61, v173
    v_fmac_f32 v239, v54, v174
    v_fmac_f32 v241, v62, v174
    v_fmac_f32 v239, v55, v175
    v_fmac_f32 v241, v63, v175
    v_mfma_f32_32x32x16_bf16 v[48:63], v[68:71], v[180:183], 0
    v_permlane32_swap_b32 v234, v235
    v_add_f32 v234, v234, v235
    s_waitcnt vmcnt(7) lgkmcnt(1)
    v_mfma_f32_32x32x16_bf16 v[0:15], v[72:75], v[184:187], v[0:15]
    ds_read_b64_tr_b16 v[176:177], v246 offset:4096
    ds_read_b64_tr_b16 v[178:179], v246 offset:4608
    ds_read_b64_tr_b16 v[180:181], v247 offset:4096
    ds_read_b64_tr_b16 v[182:183], v247 offset:4608
    s_mov_b32 m0, s69
    v_mfma_f32_32x32x16_bf16 v[16:31], v[76:79], v[184:187], v[16:31]
    buffer_load_dwordx4 v224, s[4:7], s45 offen lds
    buffer_load_dwordx4 v225, s[72:75], s45 offen offset:1024 lds
    s_waitcnt lgkmcnt(4)
    v_mad_u32_u16 v227, v226, s39, v248 op_sel:[1,0,0,0]
    v_mad_u32_u16 v226, v226, s39, v248
    v_mfma_f32_32x32x16_bf16 v[32:47], v[72:75], v[188:191], v[32:47]
    v_add_u32 v228, s51, v251
    ds_read_b32 v228, v228
    v_mul_f32 v242, v0, v144
    v_fma_f32 v238, v8, v160, -v238
    v_fmac_f32 v242, v1, v145
    v_fmac_f32 v238, v9, v161
    v_fmac_f32 v242, v2, v146
    v_mfma_f32_32x32x16_bf16 v[48:63], v[76:79], v[188:191], v[48:63]
    s_setprio 0
    v_fmac_f32 v238, v10, v162
    v_fmac_f32 v242, v3, v147
    v_fmac_f32 v238, v11, v163
    v_fmac_f32 v242, v4, v148
    v_fmac_f32 v238, v12, v164
    v_fmac_f32 v242, v5, v149
    v_fmac_f32 v238, v13, v165
    v_fmac_f32 v242, v6, v150
    v_fmac_f32 v238, v14, v166
    v_fmac_f32 v242, v7, v151
    v_fmac_f32 v238, v15, v167
    v_fmac_f32 v236, v16, v112
    v_mul_f32 v244, v24, v160
    v_fmac_f32 v236, v17, v113
    v_fmac_f32 v244, v25, v161
    v_fmac_f32 v236, v18, v114
    v_fmac_f32 v244, v26, v162
    v_fmac_f32 v236, v19, v115
    v_fmac_f32 v244, v27, v163
    v_fmac_f32 v236, v20, v116
    v_fmac_f32 v244, v28, v164
    v_fmac_f32 v236, v21, v117
    v_fmac_f32 v244, v29, v165
    v_fmac_f32 v236, v22, v118
    v_fmac_f32 v244, v30, v166
    v_fmac_f32 v236, v23, v119
    v_fmac_f32 v244, v31, v167
    v_mul_f32 v243, v32, v152
    v_fma_f32 v239, v40, v168, -v239
    v_fmac_f32 v243, v33, v153
    v_fmac_f32 v239, v41, v169
    v_fmac_f32 v243, v34, v154
    v_fmac_f32 v239, v42, v170
    v_fmac_f32 v243, v35, v155
    v_fmac_f32 v239, v43, v171
    v_fmac_f32 v243, v36, v156
    v_fmac_f32 v239, v44, v172
    v_fmac_f32 v243, v37, v157
    v_fmac_f32 v239, v45, v173
    v_fmac_f32 v243, v38, v158
    v_fmac_f32 v239, v46, v174
    v_fmac_f32 v243, v39, v159
    v_fmac_f32 v239, v47, v175
    v_fmac_f32 v237, v48, v120
    v_mul_f32 v245, v56, v168
    v_fmac_f32 v237, v49, v121
    v_fmac_f32 v245, v57, v169
    v_fmac_f32 v237, v50, v122
    s_setprio 1
    s_waitcnt vmcnt(4) lgkmcnt(1)
    v_mfma_f32_32x32x16_bf16 v[0:15], v[64:67], v[176:179], 0
    ds_read_b64_tr_b16 v[184:185], v246 offset:6144
    ds_read_b64_tr_b16 v[186:187], v246 offset:6656
    ds_read_b64_tr_b16 v[188:189], v247 offset:6144
    ds_read_b64_tr_b16 v[190:191], v247 offset:6656
    v_fmac_f32 v245, v58, v170
    v_fmac_f32 v237, v51, v123
    s_mov_b32 m0, s70
    v_mfma_f32_32x32x16_bf16 v[16:31], v[68:71], v[176:179], 0
    buffer_load_dwordx4 v226, s[4:7], s46 offen lds
    buffer_load_dwordx4 v227, s[72:75], s46 offen offset:1024 lds
    s_waitcnt lgkmcnt(4)
    v_mad_u32_u16 v229, v228, s39, v248 op_sel:[1,0,0,0]
    v_mad_u32_u16 v228, v228, s39, v248
    v_fmac_f32 v245, v59, v171
    v_fmac_f32 v237, v52, v124
    v_mfma_f32_32x32x16_bf16 v[32:47], v[64:67], v[180:183], 0
    v_fmac_f32 v245, v60, v172
    v_fmac_f32 v237, v53, v125
    v_fmac_f32 v245, v61, v173
    v_fmac_f32 v237, v54, v126
    v_fmac_f32 v245, v62, v174
    v_fmac_f32 v237, v55, v127
    v_fmac_f32 v245, v63, v175
    v_mfma_f32_32x32x16_bf16 v[48:63], v[68:71], v[180:183], 0
    v_permlane32_swap_b32 v238, v239
    v_permlane32_swap_b32 v242, v243
    v_add_f32 v238, v238, v239
    v_add_f32 v242, v242, v243
    s_waitcnt vmcnt(4) lgkmcnt(0)
    v_mfma_f32_32x32x16_bf16 v[0:15], v[72:75], v[184:187], v[0:15]
    ds_read_b64_tr_b16 v[176:177], v246 offset:0
    ds_read_b64_tr_b16 v[178:179], v246 offset:512
    ds_read_b64_tr_b16 v[180:181], v247 offset:0
    ds_read_b64_tr_b16 v[182:183], v247 offset:512
    s_mov_b32 m0, s71
    v_mfma_f32_32x32x16_bf16 v[16:31], v[76:79], v[184:187], v[16:31]
    buffer_load_dwordx4 v228, s[4:7], s47 offen lds
    buffer_load_dwordx4 v229, s[72:75], s47 offen offset:1024 lds
    s_set_gpr_idx_on s31, gpr_idx(DST)
    s_nop 0
    v_cvt_pk_bf16_f32 v194, v234, v242
    s_set_gpr_idx_off
    v_mfma_f32_32x32x16_bf16 v[32:47], v[72:75], v[188:191], v[32:47]
    v_mul_f32 v242, v0, v144
    v_fma_f32 v240, v8, v160, -v240
    v_fmac_f32 v242, v1, v145
    v_fmac_f32 v240, v9, v161
    v_fmac_f32 v242, v2, v146
    v_fmac_f32 v240, v10, v162
    v_fmac_f32 v242, v3, v147
    v_mfma_f32_32x32x16_bf16 v[48:63], v[76:79], v[188:191], v[48:63]
    s_setprio 0
    v_fmac_f32 v240, v11, v163
    v_fmac_f32 v242, v4, v148
    v_fmac_f32 v240, v12, v164
    v_fmac_f32 v242, v5, v149
    v_fmac_f32 v240, v13, v165
    v_fmac_f32 v242, v6, v150
    v_fmac_f32 v240, v14, v166
    v_fmac_f32 v242, v7, v151
    v_fmac_f32 v240, v15, v167
    s_sub_u32 s58, s48, s29
    v_add_u32 v249, s58, v249
    v_add_u32 v250, s58, v250
    v_fma_f32 v244, v16, v160, -v244
    v_fmac_f32 v236, v24, v112
    v_fmac_f32 v244, v17, v161
    v_fmac_f32 v236, v25, v113
    v_fmac_f32 v244, v18, v162
    v_fmac_f32 v236, v26, v114
    v_fmac_f32 v244, v19, v163
    v_fmac_f32 v236, v27, v115
    v_fmac_f32 v244, v20, v164
    v_fmac_f32 v236, v28, v116
    v_fmac_f32 v244, v21, v165
    v_fmac_f32 v236, v29, v117
    v_fmac_f32 v244, v22, v166
    v_fmac_f32 v236, v30, v118
    v_fmac_f32 v244, v23, v167
    v_fmac_f32 v236, v31, v119
    ds_read_b64_tr_b16 v[0:1], v249 offset:0
    ds_read_b64_tr_b16 v[2:3], v249 offset:128
    ds_read_b128 v[4:7], v250 offset:0
    ds_read_b128 v[8:11], v250 offset:16
    ds_read_b128 v[12:15], v250 offset:128
    ds_read_b128 v[16:19], v250 offset:144
    v_mul_f32 v243, v32, v152
    v_fma_f32 v241, v40, v168, -v241
    v_fmac_f32 v243, v33, v153
    v_fmac_f32 v241, v41, v169
    v_fmac_f32 v243, v34, v154
    v_fmac_f32 v241, v42, v170
    v_fmac_f32 v243, v35, v155
    v_fmac_f32 v241, v43, v171
    v_fmac_f32 v243, v36, v156
    v_fmac_f32 v241, v44, v172
    v_fmac_f32 v243, v37, v157
    v_fmac_f32 v241, v45, v173
    v_fmac_f32 v243, v38, v158
    v_fmac_f32 v241, v46, v174
    v_fmac_f32 v243, v39, v159
    v_fmac_f32 v241, v47, v175
    ds_read_b64_tr_b16 v[20:21], v249 offset:800
    ds_read_b64_tr_b16 v[22:23], v249 offset:928
    ds_read_b128 v[24:27], v250 offset:800
    ds_read_b128 v[28:31], v250 offset:816
    ds_read_b128 v[32:35], v250 offset:928
    ds_read_b128 v[36:39], v250 offset:944
    v_fma_f32 v245, v48, v168, -v245
    v_fmac_f32 v237, v56, v120
    v_fmac_f32 v245, v49, v169
    v_fmac_f32 v237, v57, v121
    v_fmac_f32 v245, v50, v170
    v_fmac_f32 v237, v58, v122
    v_fmac_f32 v245, v51, v171
    v_fmac_f32 v237, v59, v123
    v_fmac_f32 v245, v52, v172
    v_fmac_f32 v237, v60, v124
    v_fmac_f32 v245, v53, v173
    v_fmac_f32 v237, v61, v125
    v_fmac_f32 v245, v54, v174
    v_fmac_f32 v237, v62, v126
    v_fmac_f32 v245, v55, v175
    v_fmac_f32 v237, v63, v127
    s_cmp_lg_u32 s34, 0
    s_cbranch_scc1 K2_SWITCH
    s_mov_b32 s29, s48
    s_mov_b32 s32, s31
    s_mov_b32 s31, s35
    s_cmp_eq_u32 s33, 2
    s_cbranch_scc1 K2_U20
    s_cmp_eq_u32 s33, 3
    s_cbranch_scc1 K2_U30
    s_cmp_eq_u32 s33, 1
    s_cbranch_scc1 K2_U10
    s_branch K2_U40
K2_U30:
    s_setprio 1
    s_waitcnt lgkmcnt(10)
    v_lshlrev_b32 v40, 16, v0
    v_and_b32 v41, 0xffff0000, v0
    v_lshlrev_b32 v42, 16, v1
    v_and_b32 v43, 0xffff0000, v1
    v_lshlrev_b32 v44, 16, v2
    v_and_b32 v45, 0xffff0000, v2
    v_lshlrev_b32 v46, 16, v3
    v_and_b32 v47, 0xffff0000, v3
    s_waitcnt lgkmcnt(8)
    v_mul_f32 v4, v40, v4
    v_mul_f32 v5, v41, v5
    v_mul_f32 v6, v42, v6
    v_mul_f32 v7, v43, v7
    v_mul_f32 v8, v44, v8
    v_mul_f32 v9, v45, v9
    v_mul_f32 v10, v46, v10
    v_mul_f32 v11, v47, v11
    v_cvt_pk_bf16_f32 v64, v4, v5
    v_cvt_pk_bf16_f32 v65, v6, v7
    v_cvt_pk_bf16_f32 v66, v8, v9
    v_cvt_pk_bf16_f32 v67, v10, v11
    s_waitcnt lgkmcnt(6)
    v_mul_f32 v12, v40, v12
    v_mul_f32 v13, v41, v13
    v_mul_f32 v14, v42, v14
    v_mul_f32 v15, v43, v15
    v_mul_f32 v16, v44, v16
    v_mul_f32 v17, v45, v17
    v_mul_f32 v18, v46, v18
    v_mul_f32 v19, v47, v19
    v_cvt_pk_bf16_f32 v68, v12, v13
    v_cvt_pk_bf16_f32 v69, v14, v15
    v_cvt_pk_bf16_f32 v70, v16, v17
    v_cvt_pk_bf16_f32 v71, v18, v19
    ds_read_b64_tr_b16 v[0:1], v249 offset:1600
    ds_read_b64_tr_b16 v[2:3], v249 offset:1728
    ds_read_b128 v[4:7], v250 offset:1600
    ds_read_b128 v[8:11], v250 offset:1616
    ds_read_b128 v[12:15], v250 offset:1728
    ds_read_b128 v[16:19], v250 offset:1744
    s_waitcnt lgkmcnt(10)
    v_lshlrev_b32 v48, 16, v20
    v_and_b32 v49, 0xffff0000, v20
    v_lshlrev_b32 v50, 16, v21
    v_and_b32 v51, 0xffff0000, v21
    v_lshlrev_b32 v52, 16, v22
    v_and_b32 v53, 0xffff0000, v22
    v_lshlrev_b32 v54, 16, v23
    v_and_b32 v55, 0xffff0000, v23
    s_waitcnt lgkmcnt(8)
    v_mul_f32 v24, v48, v24
    v_mul_f32 v25, v49, v25
    v_mul_f32 v26, v50, v26
    v_mul_f32 v27, v51, v27
    v_mul_f32 v28, v52, v28
    v_mul_f32 v29, v53, v29
    v_mul_f32 v30, v54, v30
    v_mul_f32 v31, v55, v31
    v_cvt_pk_bf16_f32 v72, v24, v25
    v_cvt_pk_bf16_f32 v73, v26, v27
    v_cvt_pk_bf16_f32 v74, v28, v29
    v_cvt_pk_bf16_f32 v75, v30, v31
    s_waitcnt lgkmcnt(6)
    v_mul_f32 v32, v48, v32
    v_mul_f32 v33, v49, v33
    v_mul_f32 v34, v50, v34
    v_mul_f32 v35, v51, v35
    v_mul_f32 v36, v52, v36
    v_mul_f32 v37, v53, v37
    v_mul_f32 v38, v54, v38
    v_mul_f32 v39, v55, v39
    v_cvt_pk_bf16_f32 v76, v32, v33
    v_cvt_pk_bf16_f32 v77, v34, v35
    v_cvt_pk_bf16_f32 v78, v36, v37
    v_cvt_pk_bf16_f32 v79, v38, v39
    s_waitcnt lgkmcnt(4)
    v_lshlrev_b32 v40, 16, v0
    v_and_b32 v41, 0xffff0000, v0
    v_lshlrev_b32 v42, 16, v1
    v_and_b32 v43, 0xffff0000, v1
    v_lshlrev_b32 v44, 16, v2
    v_and_b32 v45, 0xffff0000, v2
    v_lshlrev_b32 v46, 16, v3
    v_and_b32 v47, 0xffff0000, v3
    s_waitcnt lgkmcnt(2)
    v_mul_f32 v4, v40, v4
    v_mul_f32 v5, v41, v5
    v_mul_f32 v6, v42, v6
    v_mul_f32 v7, v43, v7
    v_mul_f32 v8, v44, v8
    v_mul_f32 v9, v45, v9
    v_mul_f32 v10, v46, v10
    v_mul_f32 v11, v47, v11
    v_cvt_pk_bf16_f32 v80, v4, v5
    v_cvt_pk_bf16_f32 v81, v6, v7
    v_cvt_pk_bf16_f32 v82, v8, v9
    v_cvt_pk_bf16_f32 v83, v10, v11
    s_waitcnt lgkmcnt(0)
    v_mul_f32 v12, v40, v12
    v_mul_f32 v13, v41, v13
    v_mul_f32 v14, v42, v14
    v_mul_f32 v15, v43, v15
    v_mul_f32 v16, v44, v16
    v_mul_f32 v17, v45, v17
    v_mul_f32 v18, v46, v18
    v_mul_f32 v19, v47, v19
    v_cvt_pk_bf16_f32 v84, v12, v13
    v_cvt_pk_bf16_f32 v85, v14, v15
    v_cvt_pk_bf16_f32 v86, v16, v17
    v_cvt_pk_bf16_f32 v87, v18, v19
    s_waitcnt vmcnt(4)
    v_mfma_f32_32x32x16_bf16 v[0:15], v[64:67], v[176:179], 0
    ds_read_b64_tr_b16 v[184:185], v246 offset:2048
    ds_read_b64_tr_b16 v[186:187], v246 offset:2560
    ds_read_b64_tr_b16 v[188:189], v247 offset:2048
    ds_read_b64_tr_b16 v[190:191], v247 offset:2560
    s_mov_b32 m0, s68
    v_mfma_f32_32x32x16_bf16 v[16:31], v[68:71], v[176:179], 0
    buffer_load_dwordx4 v224, s[4:7], s41 offen lds
    buffer_load_dwordx4 v225, s[72:75], s41 offen offset:1024 lds
    v_permlane32_swap_b32 v242, v243
    v_permlane32_swap_b32 v240, v241
    s_add_u32 s38, s38, 1
    v_mfma_f32_32x32x16_bf16 v[32:47], v[64:67], v[180:183], 0
    v_permlane32_swap_b32 v236, v237
    v_permlane32_swap_b32 v244, v245
    v_add_f32 v242, v242, v243
    v_add_f32 v240, -v240, -v241
    v_add_f32 v236, v236, v237
    v_mfma_f32_32x32x16_bf16 v[48:63], v[68:71], v[180:183], 0
    v_add_f32 v244, v244, v245
    s_set_gpr_idx_on s32, gpr_idx(DST)
    s_nop 0
    v_cvt_pk_bf16_f32 v195, v242, v236
    v_cvt_pk_bf16_f32 v196, v244, v240
    v_cvt_pk_bf16_f32 v197, v238, v238
    s_set_gpr_idx_off
    s_waitcnt vmcnt(4) lgkmcnt(0)
    v_mfma_f32_32x32x16_bf16 v[0:15], v[72:75], v[184:187], v[0:15]
    ds_read_b64_tr_b16 v[176:177], v246 offset:4096
    ds_read_b64_tr_b16 v[178:179], v246 offset:4608
    ds_read_b64_tr_b16 v[180:181], v247 offset:4096
    ds_read_b64_tr_b16 v[182:183], v247 offset:4608
    v_mov_b32 v254, s52
    v_mov_b32 v255, s38
    s_mov_b32 m0, s69
    v_mfma_f32_32x32x16_bf16 v[16:31], v[76:79], v[184:187], v[16:31]
    buffer_load_dwordx4 v226, s[4:7], s41 offen lds
    buffer_load_dwordx4 v227, s[72:75], s41 offen offset:1024 lds
    s_lshl_b32 s58, s38, 3
    s_add_u32 s58, s58, s20
    s_mov_b64 exec, 1
    ds_write_b32 v254, v255
    s_mov_b64 exec, -1
    s_cmp_lt_u32 s58, s22
    s_cbranch_scc0 K2_dyn_31
K2_back_32:
    v_readlane_b32 s59, v253, s58
    s_lshl_b32 s44, s34, 7
    s_and_b32 s48, s59, 0x3ffff
    s_bfe_u32 s33, s59, 0x30012
    s_lshr_b32 s60, s59, 21
    s_add_u32 s60, s60, s48
    s_mul_i32 s35, s38, 6
    s_cmp_eq_u32 s34, 0
    s_cselect_b32 s35, s35, s60
    s_mov_b32 s45, s44
    s_add_u32 s47, s44, 256
    s_add_u32 s49, s48, 800
    s_add_u32 s60, s48, 1600
    s_cmp_eq_u32 s33, 3
    s_cselect_b32 s46, s44, s47
    s_cselect_b32 s50, s60, s48
    s_cselect_b32 s51, s48, s49
    s_sub_u32 s60, s33, 2
    s_cmp_lt_u32 s60, 2
    s_cbranch_scc0 K2_rare_37
K2_back_38:
    v_mfma_f32_32x32x16_bf16 v[32:47], v[72:75], v[188:191], v[32:47]
    v_add_u32 v232, s48, v230
    v_add_u32 v233, s50, v230
    ds_read_b32 v232, v232
    ds_read_b32 v233, v233
    v_mfma_f32_32x32x16_bf16 v[48:63], v[76:79], v[188:191], v[48:63]
    s_waitcnt vmcnt(4) lgkmcnt(3)
    v_mfma_f32_32x32x16_bf16 v[0:15], v[80:83], v[176:179], v[0:15]
    ds_read_b64_tr_b16 v[184:185], v246 offset:6144
    ds_read_b64_tr_b16 v[186:187], v246 offset:6656
    ds_read_b64_tr_b16 v[188:189], v247 offset:6144
    ds_read_b64_tr_b16 v[190:191], v247 offset:6656
    s_mov_b32 m0, s70
    v_mfma_f32_32x32x16_bf16 v[16:31], v[84:87], v[176:179], v[16:31]
    buffer_load_dwordx4 v222, s[4:7], s42 offen lds
    buffer_load_dwordx4 v223, s[72:75], s42 offen offset:1024 lds
    v_mfma_f32_32x32x16_bf16 v[32:47], v[80:83], v[180:183], v[32:47]
    s_nop 2
    v_mul_f32 v234, v0, v96
    v_mul_f32 v236, v8, v128
    v_fmac_f32 v234, v1, v97
    v_fmac_f32 v236, v9, v129
    v_fmac_f32 v234, v2, v98
    v_fmac_f32 v236, v10, v130
    v_fmac_f32 v234, v3, v99
    v_mfma_f32_32x32x16_bf16 v[48:63], v[84:87], v[180:183], v[48:63]
    s_setprio 0
    s_waitcnt lgkmcnt(4)
    v_or_b32 v232, v232, v231
    v_or_b32 v233, v233, v231
    s_cmp_lg_u32 s34, 0
    s_cbranch_scc1 K2_dum_40
    s_mov_b32 m0, s48
    s_mov_b32 exec_hi, 0
    buffer_load_dwordx4 v232, s[16:19], 0 offen  lds
    s_mov_b32 m0, s50
    s_add_u32 s65, s48, 288
    buffer_load_dwordx4 v233, s[16:19], 0 offen  lds
    s_not_b64 exec, exec
    s_mov_b32 m0, s65
    s_cmp_eq_u32 s33, 4
    buffer_load_dwordx4 v232, s[16:19], 0 offen  lds
    s_cbranch_scc1 K2_a4_41
K2_b4_43:
    s_mov_b32 exec_lo, -1
K2_back_42:
    v_fmac_f32 v236, v11, v131
    v_fmac_f32 v234, v4, v100
    v_fmac_f32 v236, v12, v132
    v_fmac_f32 v234, v5, v101
    v_fmac_f32 v236, v13, v133
    v_fmac_f32 v234, v6, v102
    v_fmac_f32 v236, v14, v134
    v_fmac_f32 v234, v7, v103
    v_fmac_f32 v236, v15, v135
    v_mul_f32 v238, v16, v128
    v_mul_f32 v240, v24, v128
    v_fmac_f32 v238, v17, v129
    v_fmac_f32 v240, v25, v129
    v_fmac_f32 v238, v18, v130
    v_fmac_f32 v240, v26, v130
    v_fmac_f32 v238, v19, v131
    v_fmac_f32 v240, v27, v131
    v_fmac_f32 v238, v20, v132
    v_fmac_f32 v240, v28, v132
    v_fmac_f32 v238, v21, v133
    v_fmac_f32 v240, v29, v133
    v_fmac_f32 v238, v22, v134
    v_fmac_f32 v240, v30, v134
    v_fmac_f32 v238, v23, v135
    v_fmac_f32 v240, v31, v135
    v_mul_f32 v235, v32, v104
    v_mul_f32 v237, v40, v136
    v_fmac_f32 v235, v33, v105
    v_fmac_f32 v237, v41, v137
    v_fmac_f32 v235, v34, v106
    v_fmac_f32 v237, v42, v138
    v_fmac_f32 v235, v35, v107
    v_fmac_f32 v237, v43, v139
    v_fmac_f32 v235, v36, v108
    v_fmac_f32 v237, v44, v140
    v_fmac_f32 v235, v37, v109
    v_fmac_f32 v237, v45, v141
    v_fmac_f32 v235, v38, v110
    v_fmac_f32 v237, v46, v142
    v_fmac_f32 v235, v39, v111
    v_fmac_f32 v237, v47, v143
    v_mul_f32 v239, v48, v136
    v_mul_f32 v241, v56, v136
    s_setprio 1
    s_waitcnt vmcnt(7) lgkmcnt(0)
    v_mfma_f32_32x32x16_bf16 v[0:15], v[64:67], v[184:187], 0
    ds_read_b64_tr_b16 v[176:177], v246 offset:0
    ds_read_b64_tr_b16 v[178:179], v246 offset:512
    ds_read_b64_tr_b16 v[180:181], v247 offset:0
    ds_read_b64_tr_b16 v[182:183], v247 offset:512
    v_fmac_f32 v239, v49, v137
    v_fmac_f32 v241, v57, v137
    s_mov_b32 m0, s71
    v_mfma_f32_32x32x16_bf16 v[16:31], v[68:71], v[184:187], 0
    buffer_load_dwordx4 v224, s[4:7], s42 offen lds
    buffer_load_dwordx4 v225, s[72:75], s42 offen offset:1024 lds
    v_fmac_f32 v239, v50, v138
    v_fmac_f32 v241, v58, v138
    v_fmac_f32 v239, v51, v139
    v_fmac_f32 v241, v59, v139
    v_fmac_f32 v239, v52, v140
    v_mfma_f32_32x32x16_bf16 v[32:47], v[64:67], v[188:191], 0
    v_fmac_f32 v241, v60, v140
    v_fmac_f32 v239, v53, v141
    v_fmac_f32 v241, v61, v141
    v_fmac_f32 v239, v54, v142
    v_fmac_f32 v241, v62, v142
    v_fmac_f32 v239, v55, v143
    v_fmac_f32 v241, v63, v143
    v_mfma_f32_32x32x16_bf16 v[48:63], v[68:71], v[188:191], 0
    v_permlane32_swap_b32 v234, v235
    v_permlane32_swap_b32 v236, v237
    v_permlane32_swap_b32 v238, v239
    s_waitcnt vmcnt(7) lgkmcnt(0)
    v_mfma_f32_32x32x16_bf16 v[0:15], v[72:75], v[176:179], v[0:15]
    ds_read_b64_tr_b16 v[184:185], v246 offset:2048
    ds_read_b64_tr_b16 v[186:187], v246 offset:2560
    ds_read_b64_tr_b16 v[188:189], v247 offset:2048
    ds_read_b64_tr_b16 v[190:191], v247 offset:2560
    v_permlane32_swap_b32 v240, v241
    s_mov_b32 m0, s68
    v_mfma_f32_32x32x16_bf16 v[16:31], v[76:79], v[176:179], v[16:31]
    buffer_load_dwordx4 v226, s[4:7], s42 offen lds
    buffer_load_dwordx4 v227, s[72:75], s42 offen offset:1024 lds
    v_add_f32 v234, v234, v235
    v_add_f32 v236, v236, v237
    v_add_f32 v238, v238, v239
    v_add_f32 v240, v240, v241
    v_mfma_f32_32x32x16_bf16 v[32:47], v[72:75], v[180:183], v[32:47]
    s_set_gpr_idx_on s31, gpr_idx(DST)
    s_nop 0
    v_cvt_pk_bf16_f32 v192, v234, v236
    v_cvt_pk_bf16_f32 v193, v238, v240
    s_set_gpr_idx_off
    v_mfma_f32_32x32x16_bf16 v[48:63], v[76:79], v[180:183], v[48:63]
    s_waitcnt vmcnt(7) lgkmcnt(0)
    v_mfma_f32_32x32x16_bf16 v[0:15], v[80:83], v[184:187], v[0:15]
    ds_read_b64_tr_b16 v[176:177], v246 offset:4096
    ds_read_b64_tr_b16 v[178:179], v246 offset:4608
    ds_read_b64_tr_b16 v[180:181], v247 offset:4096
    ds_read_b64_tr_b16 v[182:183], v247 offset:4608
    s_mov_b32 m0, s69
    v_mfma_f32_32x32x16_bf16 v[16:31], v[84:87], v[184:187], v[16:31]
    buffer_load_dwordx4 v222, s[4:7], s43 offen lds
    buffer_load_dwordx4 v223, s[72:75], s43 offen offset:1024 lds
    v_mfma_f32_32x32x16_bf16 v[32:47], v[80:83], v[188:191], v[32:47]
    s_nop 2
    v_mul_f32 v234, v0, v144
    v_mul_f32 v236, v8, v112
    v_fmac_f32 v234, v1, v145
    v_fmac_f32 v236, v9, v113
    v_fmac_f32 v234, v2, v146
    v_fmac_f32 v236, v10, v114
    v_fmac_f32 v234, v3, v147
    v_mfma_f32_32x32x16_bf16 v[48:63], v[84:87], v[188:191], v[48:63]
    s_setprio 0
    v_fmac_f32 v236, v11, v115
    v_fmac_f32 v234, v4, v148
    v_fmac_f32 v236, v12, v116
    v_fmac_f32 v234, v5, v149
    v_fmac_f32 v236, v13, v117
    v_fmac_f32 v234, v6, v150
    v_fmac_f32 v236, v14, v118
    v_fmac_f32 v234, v7, v151
    v_fmac_f32 v236, v15, v119
    v_mul_f32 v238, v16, v160
    v_mul_f32 v240, v24, v160
    v_fmac_f32 v238, v17, v161
    v_fmac_f32 v240, v25, v161
    v_fmac_f32 v238, v18, v162
    v_fmac_f32 v240, v26, v162
    v_fmac_f32 v238, v19, v163
    v_fmac_f32 v240, v27, v163
    v_fmac_f32 v238, v20, v164
    v_fmac_f32 v240, v28, v164
    v_fmac_f32 v238, v21, v165
    v_fmac_f32 v240, v29, v165
    v_fmac_f32 v238, v22, v166
    v_fmac_f32 v240, v30, v166
    v_fmac_f32 v238, v23, v167
    v_fmac_f32 v240, v31, v167
    v_mul_f32 v235, v32, v152
    v_mul_f32 v237, v40, v120
    v_fmac_f32 v235, v33, v153
    v_fmac_f32 v237, v41, v121
    v_fmac_f32 v235, v34, v154
    v_fmac_f32 v237, v42, v122
    v_fmac_f32 v235, v35, v155
    v_fmac_f32 v237, v43, v123
    v_fmac_f32 v235, v36, v156
    v_fmac_f32 v237, v44, v124
    v_fmac_f32 v235, v37, v157
    v_fmac_f32 v237, v45, v125
    v_fmac_f32 v235, v38, v158
    v_fmac_f32 v237, v46, v126
    v_fmac_f32 v235, v39, v159
    v_fmac_f32 v237, v47, v127
    v_mul_f32 v239, v48, v168
    v_mul_f32 v241, v56, v168
    v_fmac_f32 v239, v49, v169
    v_fmac_f32 v241, v57, v169
    s_setprio 1
    s_waitcnt vmcnt(4) lgkmcnt(0)
    v_mfma_f32_32x32x16_bf16 v[0:15], v[64:67], v[176:179], 0
    ds_read_b64_tr_b16 v[184:185], v246 offset:6144
    ds_read_b64_tr_b16 v[186:187], v246 offset:6656
    ds_read_b64_tr_b16 v[188:189], v247 offset:6144
    ds_read_b64_tr_b16 v[190:191], v247 offset:6656
    v_fmac_f32 v239, v50, v170
    v_fmac_f32 v241, v58, v170
    s_mov_b32 m0, s70
    v_mfma_f32_32x32x16_bf16 v[16:31], v[68:71], v[176:179], 0
    buffer_load_dwordx4 v224, s[4:7], s43 offen lds
    buffer_load_dwordx4 v225, s[72:75], s43 offen offset:1024 lds
    v_fmac_f32 v239, v51, v171
    v_fmac_f32 v241, v59, v171
    v_fmac_f32 v239, v52, v172
    v_fmac_f32 v241, v60, v172
    v_fmac_f32 v239, v53, v173
    v_mfma_f32_32x32x16_bf16 v[32:47], v[64:67], v[180:183], 0
    v_add_u32 v222, s48, v251
    ds_read_b32 v222, v222
    v_fmac_f32 v241, v61, v173
    v_fmac_f32 v239, v54, v174
    v_fmac_f32 v241, v62, v174
    v_fmac_f32 v239, v55, v175
    v_fmac_f32 v241, v63, v175
    v_mfma_f32_32x32x16_bf16 v[48:63], v[68:71], v[180:183], 0
    v_permlane32_swap_b32 v234, v235
    v_add_f32 v234, v234, v235
    s_waitcnt vmcnt(4) lgkmcnt(1)
    v_mfma_f32_32x32x16_bf16 v[0:15], v[72:75], v[184:187], v[0:15]
    ds_read_b64_tr_b16 v[176:177], v246 offset:0
    ds_read_b64_tr_b16 v[178:179], v246 offset:512
    ds_read_b64_tr_b16 v[180:181], v247 offset:0
    ds_read_b64_tr_b16 v[182:183], v247 offset:512
    s_mov_b32 m0, s71
    v_mfma_f32_32x32x16_bf16 v[16:31], v[76:79], v[184:187], v[16:31]
    buffer_load_dwordx4 v226, s[4:7], s43 offen lds
    buffer_load_dwordx4 v227, s[72:75], s43 offen offset:1024 lds
    s_waitcnt lgkmcnt(4)
    v_mad_u32_u16 v223, v222, s39, v248 op_sel:[1,0,0,0]
    v_mad_u32_u16 v222, v222, s39, v248
    v_mfma_f32_32x32x16_bf16 v[32:47], v[72:75], v[188:191], v[32:47]
    v_add_u32 v224, s49, v251
    ds_read_b32 v224, v224
    v_mfma_f32_32x32x16_bf16 v[48:63], v[76:79], v[188:191], v[48:63]
    s_waitcnt vmcnt(4) lgkmcnt(1)
    v_mfma_f32_32x32x16_bf16 v[0:15], v[80:83], v[176:179], v[0:15]
    ds_read_b64_tr_b16 v[184:185], v246 offset:2048
    ds_read_b64_tr_b16 v[186:187], v246 offset:2560
    ds_read_b64_tr_b16 v[188:189], v247 offset:2048
    ds_read_b64_tr_b16 v[190:191], v247 offset:2560
    s_mov_b32 m0, s68
    v_mfma_f32_32x32x16_bf16 v[16:31], v[84:87], v[176:179], v[16:31]
    buffer_load_dwordx4 v222, s[4:7], s44 offen lds
    buffer_load_dwordx4 v223, s[72:75], s44 offen offset:1024 lds
    s_waitcnt lgkmcnt(4)
    v_mad_u32_u16 v225, v224, s39, v248 op_sel:[1,0,0,0]
    v_mad_u32_u16 v224, v224, s39, v248
    v_mfma_f32_32x32x16_bf16 v[32:47], v[80:83], v[180:183], v[32:47]
    v_add_u32 v226, s50, v251
    ds_read_b32 v226, v226
    v_mul_f32 v242, v0, v144
    v_fma_f32 v238, v8, v160, -v238
    v_fmac_f32 v242, v1, v145
    v_fmac_f32 v238, v9, v161
    v_fmac_f32 v242, v2, v146
    v_mfma_f32_32x32x16_bf16 v[48:63], v[84:87], v[180:183], v[48:63]
    s_setprio 0
    v_fmac_f32 v238, v10, v162
    v_fmac_f32 v242, v3, v147
    v_fmac_f32 v238, v11, v163
    v_fmac_f32 v242, v4, v148
    v_fmac_f32 v238, v12, v164
    v_fmac_f32 v242, v5, v149
    v_fmac_f32 v238, v13, v165
    v_fmac_f32 v242, v6, v150
    v_fmac_f32 v238, v14, v166
    v_fmac_f32 v242, v7, v151
    v_fmac_f32 v238, v15, v167
    v_fmac_f32 v236, v16, v112
    v_mul_f32 v244, v24, v160
    v_fmac_f32 v236, v17, v113
    v_fmac_f32 v244, v25, v161
    v_fmac_f32 v236, v18, v114
    v_fmac_f32 v244, v26, v162
    v_fmac_f32 v236, v19, v115
    v_fmac_f32 v244, v27, v163
    v_fmac_f32 v236, v20, v116
    v_fmac_f32 v244, v28, v164
    v_fmac_f32 v236, v21, v117
    v_fmac_f32 v244, v29, v165
    v_fmac_f32 v236, v22, v118
    v_fmac_f32 v244, v30, v166
    v_fmac_f32 v236, v23, v119
    v_fmac_f32 v244, v31, v167
    v_mul_f32 v243, v32, v152
    v_fma_f32 v239, v40, v168, -v239
    v_fmac_f32 v243, v33, v153
    v_fmac_f32 v239, v41, v169
    v_fmac_f32 v243, v34, v154
    v_fmac_f32 v239, v42, v170
    v_fmac_f32 v243, v35, v155
    v_fmac_f32 v239, v43, v171
    v_fmac_f32 v243, v36, v156
    v_fmac_f32 v239, v44, v172
    v_fmac_f32 v243, v37, v157
    v_fmac_f32 v239, v45, v173
    v_fmac_f32 v243, v38, v158
    v_fmac_f32 v239, v46, v174
    v_fmac_f32 v243, v39, v159
    v_fmac_f32 v239, v47, v175
    v_fmac_f32 v237, v48, v120
    v_mul_f32 v245, v56, v168
    v_fmac_f32 v237, v49, v121
    v_fmac_f32 v245, v57, v169
    v_fmac_f32 v237, v50, v122
    v_fmac_f32 v245, v58, v170
    v_fmac_f32 v237, v51, v123
    s_setprio 1
    s_waitcnt vmcnt(4) lgkmcnt(1)
    v_mfma_f32_32x32x16_bf16 v[0:15], v[64:67], v[184:187], 0
    ds_read_b64_tr_b16 v[176:177], v246 offset:4096
    ds_read_b64_tr_b16 v[178:179], v246 offset:4608
    ds_read_b64_tr_b16 v[180:181], v247 offset:4096
    ds_read_b64_tr_b16 v[182:183], v247 offset:4608
    v_fmac_f32 v245, v59, v171
    v_fmac_f32 v237, v52, v124
    s_mov_b32 m0, s69
    v_mfma_f32_32x32x16_bf16 v[16:31], v[68:71], v[184:187], 0
    buffer_load_dwordx4 v224, s[4:7], s45 offen lds
    buffer_load_dwordx4 v225, s[72:75], s45 offen offset:1024 lds
    s_waitcnt lgkmcnt(4)
    v_mad_u32_u16 v227, v226, s39, v248 op_sel:[1,0,0,0]
    v_mad_u32_u16 v226, v226, s39, v248
    v_fmac_f32 v245, v60, v172
    v_fmac_f32 v237, v53, v125
    v_mfma_f32_32x32x16_bf16 v[32:47], v[64:67], v[188:191], 0
    v_add_u32 v228, s51, v251
    ds_read_b32 v228, v228
    v_fmac_f32 v245, v61, v173
    v_fmac_f32 v237, v54, v126
    v_fmac_f32 v245, v62, v174
    v_fmac_f32 v237, v55, v127
    v_fmac_f32 v245, v63, v175
    v_mfma_f32_32x32x16_bf16 v[48:63], v[68:71], v[188:191], 0
    v_permlane32_swap_b32 v238, v239
    v_permlane32_swap_b32 v242, v243
    v_add_f32 v238, v238, v239
    v_add_f32 v242, v242, v243
    s_waitcnt vmcnt(4) lgkmcnt(1)
    v_mfma_f32_32x32x16_bf16 v[0:15], v[72:75], v[176:179], v[0:15]
    ds_read_b64_tr_b16 v[184:185], v246 offset:6144
    ds_read_b64_tr_b16 v[186:187], v246 offset:6656
    ds_read_b64_tr_b16 v[188:189], v247 offset:6144
    ds_read_b64_tr_b16 v[190:191], v247 offset:6656
    s_mov_b32 m0, s70
    v_mfma_f32_32x32x16_bf16 v[16:31], v[76:79], v[176:179], v[16:31]
    buffer_load_dwordx4 v226, s[4:7], s46 offen lds
    buffer_load_dwordx4 v227, s[72:75], s46 offen offset:1024 lds
    s_waitcnt lgkmcnt(4)
    v_mad_u32_u16 v229, v228, s39, v248 op_sel:[1,0,0,0]
    v_mad_u32_u16 v228, v228, s39, v248
    v_mfma_f32_32x32x16_bf16 v[32:47], v[72:75], v[180:183], v[32:47]
    s_set_gpr_idx_on s31, gpr_idx(DST)
    s_nop 0
    v_cvt_pk_bf16_f32 v194, v234, v242
    s_set_gpr_idx_off
    v_mfma_f32_32x32x16_bf16 v[48:63], v[76:79], v[180:183], v[48:63]
    s_waitcnt vmcnt(4) lgkmcnt(0)
    v_mfma_f32_32x32x16_bf16 v[0:15], v[80:83], v[184:187], v[0:15]
    ds_read_b64_tr_b16 v[176:177], v246 offset:0
    ds_read_b64_tr_b16 v[178:179], v246 offset:512
    ds_read_b64_tr_b16 v[180:181], v247 offset:0
    ds_read_b64_tr_b16 v[182:183], v247 offset:512
    s_mov_b32 m0, s71
    v_mfma_f32_32x32x16_bf16 v[16:31], v[84:87], v[184:187], v[16:31]
    buffer_load_dwordx4 v228, s[4:7], s47 offen lds
    buffer_load_dwordx4 v229, s[72:75], s47 offen offset:1024 lds
    v_mfma_f32_32x32x16_bf16 v[32:47], v[80:83], v[188:191], v[32:47]
    s_nop 2
    v_mul_f32 v242, v0, v144
    s_nop 1
    v_fma_f32 v240, v8, v160, -v240
    v_fmac_f32 v242, v1, v145
    v_fmac_f32 v240, v9, v161
    v_fmac_f32 v242, v2, v146
    v_fmac_f32 v240, v10, v162
    v_fmac_f32 v242, v3, v147
    v_mfma_f32_32x32x16_bf16 v[48:63], v[84:87], v[188:191], v[48:63]
    s_setprio 0
    v_fmac_f32 v240, v11, v163
    v_fmac_f32 v242, v4, v148
    v_fmac_f32 v240, v12, v164
    v_fmac_f32 v242, v5, v149
    v_fmac_f32 v240, v13, v165
    v_fmac_f32 v242, v6, v150
    v_fmac_f32 v240, v14, v166
    v_fmac_f32 v242, v7, v151
    v_fmac_f32 v240, v15, v167
    s_sub_u32 s58, s48, s29
    v_add_u32 v249, s58, v249
    v_add_u32 v250, s58, v250
    v_fma_f32 v244, v16, v160, -v244
    v_fmac_f32 v236, v24, v112
    v_fmac_f32 v244, v17, v161
    v_fmac_f32 v236, v25, v113
    v_fmac_f32 v244, v18, v162
    v_fmac_f32 v236, v26, v114
    v_fmac_f32 v244, v19, v163
    v_fmac_f32 v236, v27, v115
    v_fmac_f32 v244, v20, v164
    v_fmac_f32 v236, v28, v116
    v_fmac_f32 v244, v21, v165
    v_fmac_f32 v236, v29, v117
    v_fmac_f32 v244, v22, v166
    v_fmac_f32 v236, v30, v118
    v_fmac_f32 v244, v23, v167
    v_fmac_f32 v236, v31, v119
    ds_read_b64_tr_b16 v[0:1], v249 offset:0
    ds_read_b64_tr_b16 v[2:3], v249 offset:128
    ds_read_b128 v[4:7], v250 offset:0
    ds_read_b128 v[8:11], v250 offset:16
    ds_read_b128 v[12:15], v250 offset:128
    ds_read_b128 v[16:19], v250 offset:144
    v_mul_f32 v243, v32, v152
    v_fma_f32 v241, v40, v168, -v241
    v_fmac_f32 v243, v33, v153
    v_fmac_f32 v241, v41, v169
    v_fmac_f32 v243, v34, v154
    v_fmac_f32 v241, v42, v170
    v_fmac_f32 v243, v35, v155
    v_fmac_f32 v241, v43, v171
    v_fmac_f32 v243, v36, v156
    v_fmac_f32 v241, v44, v172
    v_fmac_f32 v243, v37, v157
    v_fmac_f32 v241, v45, v173
    v_fmac_f32 v243, v38, v158
    v_fmac_f32 v241, v46, v174
    v_fmac_f32 v243, v39, v159
    v_fmac_f32 v241, v47, v175
    ds_read_b64_tr_b16 v[20:21], v249 offset:800
    ds_read_b64_tr_b16 v[22:23], v249 offset:928
    ds_read_b128 v[24:27], v250 offset:800
    ds_read_b128 v[28:31], v250 offset:816
    ds_read_b128 v[32:35], v250 offset:928
    ds_read_b128 v[36:39], v250 offset:944
    v_fma_f32 v245, v48, v168, -v245
    v_fmac_f32 v237, v56, v120
    v_fmac_f32 v245, v49, v169
    v_fmac_f32 v237, v57, v121
    v_fmac_f32 v245, v50, v170
    v_fmac_f32 v237, v58, v122
    v_fmac_f32 v245, v51, v171
    v_fmac_f32 v237, v59, v123
    v_fmac_f32 v245, v52, v172
    v_fmac_f32 v237, v60, v124
    v_fmac_f32 v245, v53, v173
    v_fmac_f32 v237, v61, v125
    v_fmac_f32 v245, v54, v174
    v_fmac_f32 v237, v62, v126
    v_fmac_f32 v245, v55, v175
    v_fmac_f32 v237, v63, v127
    s_cmp_lg_u32 s34, 0
    s_cbranch_scc1 K2_SWITCH
    s_mov_b32 s29, s48
    s_mov_b32 s32, s31
    s_mov_b32 s31, s35
    s_cmp_eq_u32 s33, 2
    s_cbranch_scc1 K2_U20
    s_cmp_eq_u32 s33, 3
    s_cbranch_scc1 K2_U30
    s_cmp_eq_u32 s33, 1
    s_cbranch_scc1 K2_U10
    s_branch K2_U40
K2_U21:
    s_setprio 1
    s_waitcnt lgkmcnt(10)
    v_lshlrev_b32 v40, 16, v0
    v_and_b32 v41, 0xffff0000, v0
    v_lshlrev_b32 v42, 16, v1
    v_and_b32 v43, 0xffff0000, v1
    v_lshlrev_b32 v44, 16, v2
    v_and_b32 v45, 0xffff0000, v2
    v_lshlrev_b32 v46, 16, v3
    v_and_b32 v47, 0xffff0000, v3
    s_waitcnt lgkmcnt(8)
    v_mul_f32 v4, v40, v4
    v_mul_f32 v5, v41, v5
    v_mul_f32 v6, v42, v6
    v_mul_f32 v7, v43, v7
    v_mul_f32 v8, v44, v8
    v_mul_f32 v9, v45, v9
    v_mul_f32 v10, v46, v10
    v_mul_f32 v11, v47, v11
    v_cvt_pk_bf16_f32 v64, v4, v5
    v_cvt_pk_bf16_f32 v65, v6, v7
    v_cvt_pk_bf16_f32 v66, v8, v9
    v_cvt_pk_bf16_f32 v67, v10, v11
    s_waitcnt lgkmcnt(6)
    v_mul_f32 v12, v40, v12
    v_mul_f32 v13, v41, v13
    v_mul_f32 v14, v42, v14
    v_mul_f32 v15, v43, v15
    v_mul_f32 v16, v44, v16
    v_mul_f32 v17, v45, v17
    v_mul_f32 v18, v46, v18
    v_mul_f32 v19, v47, v19
    v_cvt_pk_bf16_f32 v68, v12, v13
    v_cvt_pk_bf16_f32 v69, v14, v15
    v_cvt_pk_bf16_f32 v70, v16, v17
    v_cvt_pk_bf16_f32 v71, v18, v19
    s_waitcnt lgkmcnt(4)
    v_lshlrev_b32 v48, 16, v20
    v_and_b32 v49, 0xffff0000, v20
    v_lshlrev_b32 v50, 16, v21
    v_and_b32 v51, 0xffff0000, v21
    v_lshlrev_b32 v52, 16, v22
    v_and_b32 v53, 0xffff0000, v22
    v_lshlrev_b32 v54, 16, v23
    v_and_b32 v55, 0xffff0000, v23
    s_waitcnt lgkmcnt(2)
    v_mul_f32 v24, v48, v24
    v_mul_f32 v25, v49, v25
    v_mul_f32 v26, v50, v26
    v_mul_f32 v27, v51, v27
    v_mul_f32 v28, v52, v28
    v_mul_f32 v29, v53, v29
    v_mul_f32 v30, v54, v30
    v_mul_f32 v31, v55, v31
    v_cvt_pk_bf16_f32 v72, v24, v25
    v_cvt_pk_bf16_f32 v73, v26, v27
    v_cvt_pk_bf16_f32 v74, v28, v29
    v_cvt_pk_bf16_f32 v75, v30, v31
    s_waitcnt lgkmcnt(0)
    v_mul_f32 v32, v48, v32
    v_mul_f32 v33, v49, v33
    v_mul_f32 v34, v50, v34
    v_mul_f32 v35, v51, v35
    v_mul_f32 v36, v52, v36
    v_mul_f32 v37, v53, v37
    v_mul_f32 v38, v54, v38
    v_mul_f32 v39, v55, v39
    v_cvt_pk_bf16_f32 v76, v32, v33
    v_cvt_pk_bf16_f32 v77, v34, v35
    v_cvt_pk_bf16_f32 v78, v36, v37
    v_cvt_pk_bf16_f32 v79, v38, v39
    s_waitcnt vmcnt(4)
    v_mfma_f32_32x32x16_bf16 v[0:15], v[64:67], v[176:179], 0
    ds_read_b64_tr_b16 v[184:185], v246 offset:2048
    ds_read_b64_tr_b16 v[186:187], v246 offset:2560
    ds_read_b64_tr_b16 v[188:189], v247 offset:2048
    ds_read_b64_tr_b16 v[190:191], v247 offset:2560
    s_mov_b32 m0, s68
    v_mfma_f32_32x32x16_bf16 v[16:31], v[68:71], v[176:179], 0
    buffer_load_dwordx4 v222, s[4:7], s42 offen lds
    buffer_load_dwordx4 v223, s[72:75], s42 offen offset:1024 lds
    v_permlane32_swap_b32 v242, v243
    v_permlane32_swap_b32 v240, v241
    v_mov_b32 v254, 162048
    v_mfma_f32_32x32x16_bf16 v[32:47], v[64:67], v[180:183], 0
    v_permlane32_swap_b32 v236, v237
    v_permlane32_swap_b32 v244, v245
    v_add_f32 v242, v242, v243
    v_add_f32 v240, -v240, -v241
    v_add_f32 v236, v236, v237
    v_mfma_f32_32x32x16_bf16 v[48:63], v[68:71], v[180:183], 0
    v_add_f32 v244, v244, v245
    v_cvt_pk_bf16_f32 v242, v242, v236
    v_cvt_pk_bf16_f32 v244, v244, v240
    v_cvt_pk_bf16_f32 v238, v238, v238
    ds_write_b16 v230, v242 offset:1152
    ds_write_b16_d16_hi v230, v242 offset:128
    v_mov_b32 v255, 1
    v_lshl_add_u32 v233, v252, 1, s53
    s_mov_b64 exec, 1
    ds_add_rtn_u32 v232, v254, v255
    s_mov_b64 exec, -1
    ds_read_b32 v233, v233
    s_waitcnt vmcnt(4) lgkmcnt(4)
    v_mfma_f32_32x32x16_bf16 v[0:15], v[72:75], v[184:187], v[0:15]
    ds_read_b64_tr_b16 v[176:177], v246 offset:4096
    ds_read_b64_tr_b16 v[178:179], v246 offset:4608
    ds_read_b64_tr_b16 v[180:181], v247 offset:4096
    ds_read_b64_tr_b16 v[182:183], v247 offset:4608
    ds_write_b16 v230, v244 offset:512
    ds_write_b16_d16_hi v230, v244 offset:896
    s_mov_b32 m0, s69
    v_mfma_f32_32x32x16_bf16 v[16:31], v[76:79], v[184:187], v[16:31]
    buffer_load_dwordx4 v224, s[4:7], s42 offen lds
    buffer_load_dwordx4 v225, s[72:75], s42 offen offset:1024 lds
    ds_write_b16 v230, v238 offset:1280
    s_waitcnt lgkmcnt(7)
    v_readfirstlane_b32 s58, v232
    v_mfma_f32_32x32x16_bf16 v[32:47], v[72:75], v[188:191], v[32:47]
    s_cmp_lt_u32 s58, s22
    s_cbranch_scc0 K2_nul_44
    s_and_b32 s59, s58, 7
    s_lshr_b32 s60, s58, 3
K2_chk_46:
    v_readlane_b32 s61, v233, s59
    s_nop 0
    s_cmp_gt_u32 s61, s60
    s_cbranch_scc0 K2_spin_45
K2_back_47:
    v_mfma_f32_32x32x16_bf16 v[48:63], v[76:79], v[188:191], v[48:63]
    s_setprio 0
    v_readlane_b32 s59, v253, s58
    s_lshl_b32 s44, s34, 7
    s_and_b32 s48, s59, 0x3ffff
    s_bfe_u32 s33, s59, 0x30012
    s_lshr_b32 s60, s59, 21
    s_add_u32 s35, s60, s48
    v_mul_f32 v234, v0, v96
    v_mul_f32 v236, v8, v128
    v_fmac_f32 v234, v1, v97
    v_fmac_f32 v236, v9, v129
    v_fmac_f32 v234, v2, v98
    v_fmac_f32 v236, v10, v130
    v_fmac_f32 v234, v3, v99
    v_fmac_f32 v236, v11, v131
    v_fmac_f32 v234, v4, v100
    v_fmac_f32 v236, v12, v132
    v_fmac_f32 v234, v5, v101
    v_fmac_f32 v236, v13, v133
    v_fmac_f32 v234, v6, v102
    v_fmac_f32 v236, v14, v134
    v_fmac_f32 v234, v7, v103
    v_fmac_f32 v236, v15, v135
    v_mul_f32 v238, v16, v128
    v_mul_f32 v240, v24, v128
    v_fmac_f32 v238, v17, v129
    v_fmac_f32 v240, v25, v129
    v_fmac_f32 v238, v18, v130
    v_fmac_f32 v240, v26, v130
    v_fmac_f32 v238, v19, v131
    v_fmac_f32 v240, v27, v131
    v_fmac_f32 v238, v20, v132
    v_fmac_f32 v240, v28, v132
    v_fmac_f32 v238, v21, v133
    v_fmac_f32 v240, v29, v133
    v_fmac_f32 v238, v22, v134
    v_fmac_f32 v240, v30, v134
    v_fmac_f32 v238, v23, v135
    v_fmac_f32 v240, v31, v135
    v_mul_f32 v235, v32, v104
    v_mul_f32 v237, v40, v136
    v_fmac_f32 v235, v33, v105
    v_fmac_f32 v237, v41, v137
    v_fmac_f32 v235, v34, v106
    v_fmac_f32 v237, v42, v138
    v_fmac_f32 v235, v35, v107
    v_fmac_f32 v237, v43, v139
    v_fmac_f32 v235, v36, v108
    v_fmac_f32 v237, v44, v140
    v_fmac_f32 v235, v37, v109
    v_fmac_f32 v237, v45, v141
    v_fmac_f32 v235, v38, v110
    v_fmac_f32 v237, v46, v142
    v_fmac_f32 v235, v39, v111
    v_fmac_f32 v237, v47, v143
    v_mul_f32 v239, v48, v136
    v_mul_f32 v241, v56, v136
    v_fmac_f32 v239, v49, v137
    v_fmac_f32 v241, v57, v137
    s_setprio 1
    s_waitcnt vmcnt(4) lgkmcnt(3)
    v_mfma_f32_32x32x16_bf16 v[0:15], v[64:67], v[176:179], 0
    ds_read_b64_tr_b16 v[184:185], v246 offset:6144
    ds_read_b64_tr_b16 v[186:187], v246 offset:6656
    ds_read_b64_tr_b16 v[188:189], v247 offset:6144
    ds_read_b64_tr_b16 v[190:191], v247 offset:6656
    v_fmac_f32 v239, v50, v138
    v_fmac_f32 v241, v58, v138
    s_mov_b32 m0, s70
    v_mfma_f32_32x32x16_bf16 v[16:31], v[68:71], v[176:179], 0
    buffer_load_dwordx4 v222, s[4:7], s43 offen lds
    buffer_load_dwordx4 v223, s[72:75], s43 offen offset:1024 lds
    v_fmac_f32 v239, v51, v139
    v_fmac_f32 v241, v59, v139
    v_fmac_f32 v239, v52, v140
    v_fmac_f32 v241, v60, v140
    v_fmac_f32 v239, v53, v141
    v_mfma_f32_32x32x16_bf16 v[32:47], v[64:67], v[180:183], 0
    s_mov_b32 s45, s44
    s_add_u32 s47, s44, 256
    s_add_u32 s49, s48, 800
    s_add_u32 s60, s48, 1600
    s_cmp_eq_u32 s33, 3
    s_cselect_b32 s46, s44, s47
    s_cselect_b32 s50, s60, s48
    s_cselect_b32 s51, s48, s49
    s_sub_u32 s60, s33, 2
    s_cmp_lt_u32 s60, 2
    s_cbranch_scc0 K2_rare_48
K2_back_49:
    v_add_u32 v222, s48, v251
    ds_read_b32 v222, v222
    v_fmac_f32 v241, v61, v141
    v_fmac_f32 v239, v54, v142
    v_fmac_f32 v241, v62, v142
    v_fmac_f32 v239, v55, v143
    v_fmac_f32 v241, v63, v143
    v_mfma_f32_32x32x16_bf16 v[48:63], v[68:71], v[180:183], 0
    v_permlane32_swap_b32 v234, v235
    v_permlane32_swap_b32 v236, v237
    v_permlane32_swap_b32 v238, v239
    s_waitcnt vmcnt(4) lgkmcnt(1)
    v_mfma_f32_32x32x16_bf16 v[0:15], v[72:75], v[184:187], v[0:15]
    ds_read_b64_tr_b16 v[176:177], v246 offset:0
    ds_read_b64_tr_b16 v[178:179], v246 offset:512
    ds_read_b64_tr_b16 v[180:181], v247 offset:0
    ds_read_b64_tr_b16 v[182:183], v247 offset:512
    v_permlane32_swap_b32 v240, v241
    s_mov_b32 m0, s71
    v_mfma_f32_32x32x16_bf16 v[16:31], v[76:79], v[184:187], v[16:31]
    buffer_load_dwordx4 v224, s[4:7], s43 offen lds
    buffer_load_dwordx4 v225, s[72:75], s43 offen offset:1024 lds
    s_waitcnt lgkmcnt(4)
    v_mad_u32_u16 v223, v222, s39, v248 op_sel:[1,0,0,0]
    v_mad_u32_u16 v222, v222, s39, v248
    v_add_u32 v230, s31, v252
    v_add_f32 v234, v234, v235
    v_add_f32 v236, v236, v237
    v_add_f32 v238, v238, v239
    v_add_f32 v240, v240, v241
    v_cvt_pk_bf16_f32 v234, v234, v236
    v_cvt_pk_bf16_f32 v238, v238, v240
    ds_write_b16 v230, v234 offset:0
    ds_write_b16_d16_hi v230, v234 offset:256
    ds_write_b16 v230, v238 offset:640
    ds_write_b16_d16_hi v230, v238 offset:1024
    v_mfma_f32_32x32x16_bf16 v[32:47], v[72:75], v[188:191], v[32:47]
    v_add_u32 v224, s49, v251
    ds_read_b32 v224, v224
    v_mul_f32 v234, v0, v144
    v_mul_f32 v236, v8, v112
    v_fmac_f32 v234, v1, v145
    v_fmac_f32 v236, v9, v113
    v_fmac_f32 v234, v2, v146
    v_mfma_f32_32x32x16_bf16 v[48:63], v[76:79], v[188:191], v[48:63]
    s_setprio 0
    v_fmac_f32 v236, v10, v114
    v_fmac_f32 v234, v3, v147
    v_fmac_f32 v236, v11, v115
    v_fmac_f32 v234, v4, v148
    v_fmac_f32 v236, v12, v116
    v_fmac_f32 v234, v5, v149
    v_fmac_f32 v236, v13, v117
    v_fmac_f32 v234, v6, v150
    v_fmac_f32 v236, v14, v118
    v_fmac_f32 v234, v7, v151
    v_fmac_f32 v236, v15, v119
    v_mul_f32 v238, v16, v160
    v_mul_f32 v240, v24, v160
    v_fmac_f32 v238, v17, v161
    v_fmac_f32 v240, v25, v161
    v_fmac_f32 v238, v18, v162
    v_fmac_f32 v240, v26, v162
    v_fmac_f32 v238, v19, v163
    v_fmac_f32 v240, v27, v163
    v_fmac_f32 v238, v20, v164
    v_fmac_f32 v240, v28, v164
    v_fmac_f32 v238, v21, v165
    v_fmac_f32 v240, v29, v165
    v_fmac_f32 v238, v22, v166
    v_fmac_f32 v240, v30, v166
    v_fmac_f32 v238, v23, v167
    v_fmac_f32 v240, v31, v167
    v_mul_f32 v235, v32, v152
    v_mul_f32 v237, v40, v120
    v_fmac_f32 v235, v33, v153
    v_fmac_f32 v237, v41, v121
    v_fmac_f32 v235, v34, v154
    v_fmac_f32 v237, v42, v122
    v_fmac_f32 v235, v35, v155
    v_fmac_f32 v237, v43, v123
    v_fmac_f32 v235, v36, v156
    v_fmac_f32 v237, v44, v124
    v_fmac_f32 v235, v37, v157
    v_fmac_f32 v237, v45, v125
    v_fmac_f32 v235, v38, v158
    v_fmac_f32 v237, v46, v126
    v_fmac_f32 v235, v39, v159
    v_fmac_f32 v237, v47, v127
    v_mul_f32 v239, v48, v168
    v_mul_f32 v241, v56, v168
    v_fmac_f32 v239, v49, v169
    v_fmac_f32 v241, v57, v169
    v_fmac_f32 v239, v50, v170
    v_fmac_f32 v241, v58, v170
    v_fmac_f32 v239, v51, v171
    s_setprio 1
    s_waitcnt vmcnt(4) lgkmcnt(5)
    v_mfma_f32_32x32x16_bf16 v[0:15], v[64:67], v[176:179], 0
    ds_read_b64_tr_b16 v[184:185], v246 offset:2048
    ds_read_b64_tr_b16 v[186:187], v246 offset:2560
    ds_read_b64_tr_b16 v[188:189], v247 offset:2048
    ds_read_b64_tr_b16 v[190:191], v247 offset:2560
    v_fmac_f32 v241, v59, v171
    v_fmac_f32 v239, v52, v172
    s_mov_b32 m0, s68
    v_mfma_f32_32x32x16_bf16 v[16:31], v[68:71], v[176:179], 0
    buffer_load_dwordx4 v222, s[4:7], s44 offen lds
    buffer_load_dwordx4 v223, s[72:75], s44 offen offset:1024 lds
    s_waitcnt lgkmcnt(4)
    v_mad_u32_u16 v225, v224, s39, v248 op_sel:[1,0,0,0]
    v_mad_u32_u16 v224, v224, s39, v248
    v_fmac_f32 v241, v60, v172
    v_fmac_f32 v239, v53, v173
    v_mfma_f32_32x32x16_bf16 v[32:47], v[64:67], v[180:183], 0
    v_add_u32 v226, s50, v251
    ds_read_b32 v226, v226
    v_fmac_f32 v241, v61, v173
    v_fmac_f32 v239, v54, v174
    v_fmac_f32 v241, v62, v174
    v_fmac_f32 v239, v55, v175
    v_fmac_f32 v241, v63, v175
    v_mfma_f32_32x32x16_bf16 v[48:63], v[68:71], v[180:183], 0
    v_permlane32_swap_b32 v234, v235
    v_add_f32 v234, v234, v235
    s_waitcnt vmcnt(4) lgkmcnt(1)
    v_mfma_f32_32x32x16_bf16 v[0:15], v[72:75], v[184:187], v[0:15]
    ds_read_b64_tr_b16 v[176:177], v246 offset:4096
    ds_read_b64_tr_b16 v[178:179], v246 offset:4608
    ds_read_b64_tr_b16 v[180:181], v247 offset:4096
    ds_read_b64_tr_b16 v[182:183], v247 offset:4608
    s_mov_b32 m0, s69
    v_mfma_f32_32x32x16_bf16 v[16:31], v[76:79], v[184:187], v[16:31]
    buffer_load_dwordx4 v224, s[4:7], s45 offen lds
    buffer_load_dwordx4 v225, s[72:75], s45 offen offset:1024 lds
    s_waitcnt lgkmcnt(4)
    v_mad_u32_u16 v227, v226, s39, v248 op_sel:[1,0,0,0]
    v_mad_u32_u16 v226, v226, s39, v248
    v_mfma_f32_32x32x16_bf16 v[32:47], v[72:75], v[188:191], v[32:47]
    v_add_u32 v228, s51, v251
    ds_read_b32 v228, v228
    v_mul_f32 v242, v0, v144
    v_fma_f32 v238, v8, v160, -v238
    v_fmac_f32 v242, v1, v145
    v_fmac_f32 v238, v9, v161
    v_fmac_f32 v242, v2, v146
    v_mfma_f32_32x32x16_bf16 v[48:63], v[76:79], v[188:191], v[48:63]
    s_setprio 0
    v_fmac_f32 v238, v10, v162
    v_fmac_f32 v242, v3, v147
    v_fmac_f32 v238, v11, v163
    v_fmac_f32 v242, v4, v148
    v_fmac_f32 v238, v12, v164
    v_fmac_f32 v242, v5, v149
    v_fmac_f32 v238, v13, v165
    v_fmac_f32 v242, v6, v150
    v_fmac_f32 v238, v14, v166
    v_fmac_f32 v242, v7, v151
    v_fmac_f32 v238, v15, v167
    v_fmac_f32 v236, v16, v112
    v_mul_f32 v244, v24, v160
    v_fmac_f32 v236, v17, v113
    v_fmac_f32 v244, v25, v161
    v_fmac_f32 v236, v18, v114
    v_fmac_f32 v244, v26, v162
    v_fmac_f32 v236, v19, v115
    v_fmac_f32 v244, v27, v163
    v_fmac_f32 v236, v20, v116
    v_fmac_f32 v244, v28, v164
    v_fmac_f32 v236, v21, v117
    v_fmac_f32 v244, v29, v165
    v_fmac_f32 v236, v22, v118
    v_fmac_f32 v244, v30, v166
    v_fmac_f32 v236, v23, v119
    v_fmac_f32 v244, v31, v167
    v_mul_f32 v243, v32, v152
    v_fma_f32 v239, v40, v168, -v239
    v_fmac_f32 v243, v33, v153
    v_fmac_f32 v239, v41, v169
    v_fmac_f32 v243, v34, v154
    v_fmac_f32 v239, v42, v170
    v_fmac_f32 v243, v35, v155
    v_fmac_f32 v239, v43, v171
    v_fmac_f32 v243, v36, v156
    v_fmac_f32 v239, v44, v172
    v_fmac_f32 v243, v37, v157
    v_fmac_f32 v239, v45, v173
    v_fmac_f32 v243, v38, v158
    v_fmac_f32 v239, v46, v174
    v_fmac_f32 v243, v39, v159
    v_fmac_f32 v239, v47, v175
    v_fmac_f32 v237, v48, v120
    v_mul_f32 v245, v56, v168
    v_fmac_f32 v237, v49, v121
    v_fmac_f32 v245, v57, v169
    v_fmac_f32 v237, v50, v122
    s_setprio 1
    s_waitcnt vmcnt(4) lgkmcnt(1)
    v_mfma_f32_32x32x16_bf16 v[0:15], v[64:67], v[176:179], 0
    ds_read_b64_tr_b16 v[184:185], v246 offset:6144
    ds_read_b64_tr_b16 v[186:187], v246 offset:6656
    ds_read_b64_tr_b16 v[188:189], v247 offset:6144
    ds_read_b64_tr_b16 v[190:191], v247 offset:6656
    v_fmac_f32 v245, v58, v170
    v_fmac_f32 v237, v51, v123
    s_mov_b32 m0, s70
    v_mfma_f32_32x32x16_bf16 v[16:31], v[68:71], v[176:179], 0
    buffer_load_dwordx4 v226, s[4:7], s46 offen lds
    buffer_load_dwordx4 v227, s[72:75], s46 offen offset:1024 lds
    s_waitcnt lgkmcnt(4)
    v_mad_u32_u16 v229, v228, s39, v248 op_sel:[1,0,0,0]
    v_mad_u32_u16 v228, v228, s39, v248
    v_fmac_f32 v245, v59, v171
    v_fmac_f32 v237, v52, v124
    v_mfma_f32_32x32x16_bf16 v[32:47], v[64:67], v[180:183], 0
    v_fmac_f32 v245, v60, v172
    v_fmac_f32 v237, v53, v125
    v_fmac_f32 v245, v61, v173
    v_fmac_f32 v237, v54, v126
    v_fmac_f32 v245, v62, v174
    v_fmac_f32 v237, v55, v127
    v_fmac_f32 v245, v63, v175
    v_mfma_f32_32x32x16_bf16 v[48:63], v[68:71], v[180:183], 0
    v_permlane32_swap_b32 v238, v239
    v_permlane32_swap_b32 v242, v243
    v_add_f32 v238, v238, v239
    v_add_f32 v242, v242, v243
    s_waitcnt vmcnt(4) lgkmcnt(0)
    v_mfma_f32_32x32x16_bf16 v[0:15], v[72:75], v[184:187], v[0:15]
    ds_read_b64_tr_b16 v[176:177], v246 offset:0
    ds_read_b64_tr_b16 v[178:179], v246 offset:512
    ds_read_b64_tr_b16 v[180:181], v247 offset:0
    ds_read_b64_tr_b16 v[182:183], v247 offset:512
    v_cvt_pk_bf16_f32 v234, v234, v242
    ds_write_b16 v230, v234 offset:384
    s_mov_b32 m0, s71
    v_mfma_f32_32x32x16_bf16 v[16:31], v[76:79], v[184:187], v[16:31]
    buffer_load_dwordx4 v228, s[4:7], s47 offen lds
    buffer_load_dwordx4 v229, s[72:75], s47 offen offset:1024 lds
    ds_write_b16_d16_hi v230, v234 offset:768
    v_mfma_f32_32x32x16_bf16 v[32:47], v[72:75], v[188:191], v[32:47]
    v_mul_f32 v242, v0, v144
    v_fma_f32 v240, v8, v160, -v240
    v_fmac_f32 v242, v1, v145
    v_fmac_f32 v240, v9, v161
    v_fmac_f32 v242, v2, v146
    v_fmac_f32 v240, v10, v162
    v_fmac_f32 v242, v3, v147
    v_mfma_f32_32x32x16_bf16 v[48:63], v[76:79], v[188:191], v[48:63]
    s_setprio 0
    v_fmac_f32 v240, v11, v163
    v_fmac_f32 v242, v4, v148
    v_fmac_f32 v240, v12, v164
    v_fmac_f32 v242, v5, v149
    v_fmac_f32 v240, v13, v165
    v_fmac_f32 v242, v6, v150
    v_fmac_f32 v240, v14, v166
    v_fmac_f32 v242, v7, v151
    v_fmac_f32 v240, v15, v167
    s_sub_u32 s58, s48, s29
    v_add_u32 v249, s58, v249
    v_add_u32 v250, s58, v250
    v_fma_f32 v244, v16, v160, -v244
    v_fmac_f32 v236, v24, v112
    v_fmac_f32 v244, v17, v161
    v_fmac_f32 v236, v25, v113
    v_fmac_f32 v244, v18, v162
    v_fmac_f32 v236, v26, v114
    v_fmac_f32 v244, v19, v163
    v_fmac_f32 v236, v27, v115
    v_fmac_f32 v244, v20, v164
    v_fmac_f32 v236, v28, v116
    v_fmac_f32 v244, v21, v165
    v_fmac_f32 v236, v29, v117
    v_fmac_f32 v244, v22, v166
    v_fmac_f32 v236, v30, v118
    v_fmac_f32 v244, v23, v167
    v_fmac_f32 v236, v31, v119
    ds_read_b64_tr_b16 v[0:1], v249 offset:0
    ds_read_b64_tr_b16 v[2:3], v249 offset:128
    ds_read_b128 v[4:7], v250 offset:0
    ds_read_b128 v[8:11], v250 offset:16
    ds_read_b128 v[12:15], v250 offset:128
    ds_read_b128 v[16:19], v250 offset:144
    v_mul_f32 v243, v32, v152
    v_fma_f32 v241, v40, v168, -v241
    v_fmac_f32 v243, v33, v153
    v_fmac_f32 v241, v41, v169
    v_fmac_f32 v243, v34, v154
    v_fmac_f32 v241, v42, v170
    v_fmac_f32 v243, v35, v155
    v_fmac_f32 v241, v43, v171
    v_fmac_f32 v243, v36, v156
    v_fmac_f32 v241, v44, v172
    v_fmac_f32 v243, v37, v157
    v_fmac_f32 v241, v45, v173
    v_fmac_f32 v243, v38, v158
    v_fmac_f32 v241, v46, v174
    v_fmac_f32 v243, v39, v159
    v_fmac_f32 v241, v47, v175
    ds_read_b64_tr_b16 v[20:21], v249 offset:800
    ds_read_b64_tr_b16 v[22:23], v249 offset:928
    ds_read_b128 v[24:27], v250 offset:800
    ds_read_b128 v[28:31], v250 offset:816
    ds_read_b128 v[32:35], v250 offset:928
    ds_read_b128 v[36:39], v250 offset:944
    v_fma_f32 v245, v48, v168, -v245
    v_fmac_f32 v237, v56, v120
    v_fmac_f32 v245, v49, v169
    v_fmac_f32 v237, v57, v121
    v_fmac_f32 v245, v50, v170
    v_fmac_f32 v237, v58, v122
    v_fmac_f32 v245, v51, v171
    v_fmac_f32 v237, v59, v123
    v_fmac_f32 v245, v52, v172
    v_fmac_f32 v237, v60, v124
    v_fmac_f32 v245, v53, v173
    v_fmac_f32 v237, v61, v125
    v_fmac_f32 v245, v54, v174
    v_fmac_f32 v237, v62, v126
    v_fmac_f32 v245, v55, v175
    v_fmac_f32 v237, v63, v127
    s_cmp_eq_u32 s36, 0
    s_cbranch_scc1 K2_TAIL
    s_mov_b32 s29, s48
    s_mov_b32 s32, s31
    s_mov_b32 s31, s35
    s_cmp_eq_u32 s33, 2
    s_cbranch_scc1 K2_U21
    s_cmp_eq_u32 s33, 3
    s_cbranch_scc1 K2_U31
    s_cmp_eq_u32 s33, 1
    s_cbranch_scc1 K2_U11
    s_branch K2_U41
K2_U31:
    s_setprio 1
    s_waitcnt lgkmcnt(10)
    v_lshlrev_b32 v40, 16, v0
    v_and_b32 v41, 0xffff0000, v0
    v_lshlrev_b32 v42, 16, v1
    v_and_b32 v43, 0xffff0000, v1
    v_lshlrev_b32 v44, 16, v2
    v_and_b32 v45, 0xffff0000, v2
    v_lshlrev_b32 v46, 16, v3
    v_and_b32 v47, 0xffff0000, v3
    s_waitcnt lgkmcnt(8)
    v_mul_f32 v4, v40, v4
    v_mul_f32 v5, v41, v5
    v_mul_f32 v6, v42, v6
    v_mul_f32 v7, v43, v7
    v_mul_f32 v8, v44, v8
    v_mul_f32 v9, v45, v9
    v_mul_f32 v10, v46, v10
    v_mul_f32 v11, v47, v11
    v_cvt_pk_bf16_f32 v64, v4, v5
    v_cvt_pk_bf16_f32 v65, v6, v7
    v_cvt_pk_bf16_f32 v66, v8, v9
    v_cvt_pk_bf16_f32 v67, v10, v11
    s_waitcnt lgkmcnt(6)
    v_mul_f32 v12, v40, v12
    v_mul_f32 v13, v41, v13
    v_mul_f32 v14, v42, v14
    v_mul_f32 v15, v43, v15
    v_mul_f32 v16, v44, v16
    v_mul_f32 v17, v45, v17
    v_mul_f32 v18, v46, v18
    v_mul_f32 v19, v47, v19
    v_cvt_pk_bf16_f32 v68, v12, v13
    v_cvt_pk_bf16_f32 v69, v14, v15
    v_cvt_pk_bf16_f32 v70, v16, v17
    v_cvt_pk_bf16_f32 v71, v18, v19
    ds_read_b64_tr_b16 v[0:1], v249 offset:1600
    ds_read_b64_tr_b16 v[2:3], v249 offset:1728
    ds_read_b128 v[4:7], v250 offset:1600
    ds_read_b128 v[8:11], v250 offset:1616
    ds_read_b128 v[12:15], v250 offset:1728
    ds_read_b128 v[16:19], v250 offset:1744
    s_waitcnt lgkmcnt(10)
    v_lshlrev_b32 v48, 16, v20
    v_and_b32 v49, 0xffff0000, v20
    v_lshlrev_b32 v50, 16, v21
    v_and_b32 v51, 0xffff0000, v21
    v_lshlrev_b32 v52, 16, v22
    v_and_b32 v53, 0xffff0000, v22
    v_lshlrev_b32 v54, 16, v23
    v_and_b32 v55, 0xffff0000, v23
    s_waitcnt lgkmcnt(8)
    v_mul_f32 v24, v48, v24
    v_mul_f32 v25, v49, v25
    v_mul_f32 v26, v50, v26
    v_mul_f32 v27, v51, v27
    v_mul_f32 v28, v52, v28
    v_mul_f32 v29, v53, v29
    v_mul_f32 v30, v54, v30
    v_mul_f32 v31, v55, v31
    v_cvt_pk_bf16_f32 v72, v24, v25
    v_cvt_pk_bf16_f32 v73, v26, v27
    v_cvt_pk_bf16_f32 v74, v28, v29
    v_cvt_pk_bf16_f32 v75, v30, v31
    s_waitcnt lgkmcnt(6)
    v_mul_f32 v32, v48, v32
    v_mul_f32 v33, v49, v33
    v_mul_f32 v34, v50, v34
    v_mul_f32 v35, v51, v35
    v_mul_f32 v36, v52, v36
    v_mul_f32 v37, v53, v37
    v_mul_f32 v38, v54, v38
    v_mul_f32 v39, v55, v39
    v_cvt_pk_bf16_f32 v76, v32, v33
    v_cvt_pk_bf16_f32 v77, v34, v35
    v_cvt_pk_bf16_f32 v78, v36, v37
    v_cvt_pk_bf16_f32 v79, v38, v39
    s_waitcnt lgkmcnt(4)
    v_lshlrev_b32 v40, 16, v0
    v_and_b32 v41, 0xffff0000, v0
    v_lshlrev_b32 v42, 16, v1
    v_and_b32 v43, 0xffff0000, v1
    v_lshlrev_b32 v44, 16, v2
    v_and_b32 v45, 0xffff0000, v2
    v_lshlrev_b32 v46, 16, v3
    v_and_b32 v47, 0xffff0000, v3
    s_waitcnt lgkmcnt(2)
    v_mul_f32 v4, v40, v4
    v_mul_f32 v5, v41, v5
    v_mul_f32 v6, v42, v6
    v_mul_f32 v7, v43, v7
    v_mul_f32 v8, v44, v8
    v_mul_f32 v9, v45, v9
    v_mul_f32 v10, v46, v10
    v_mul_f32 v11, v47, v11
    v_cvt_pk_bf16_f32 v80, v4, v5
    v_cvt_pk_bf16_f32 v81, v6, v7
    v_cvt_pk_bf16_f32 v82, v8, v9
    v_cvt_pk_bf16_f32 v83, v10, v11
    s_waitcnt lgkmcnt(0)
    v_mul_f32 v12, v40, v12
    v_mul_f32 v13, v41, v13
    v_mul_f32 v14, v42, v14
    v_mul_f32 v15, v43, v15
    v_mul_f32 v16, v44, v16
    v_mul_f32 v17, v45, v17
    v_mul_f32 v18, v46, v18
    v_mul_f32 v19, v47, v19
    v_cvt_pk_bf16_f32 v84, v12, v13
    v_cvt_pk_bf16_f32 v85, v14, v15
    v_cvt_pk_bf16_f32 v86, v16, v17
    v_cvt_pk_bf16_f32 v87, v18, v19
    s_waitcnt vmcnt(4)
    v_mfma_f32_32x32x16_bf16 v[0:15], v[64:67], v[176:179], 0
    ds_read_b64_tr_b16 v[184:185], v246 offset:2048
    ds_read_b64_tr_b16 v[186:187], v246 offset:2560
    ds_read_b64_tr_b16 v[188:189], v247 offset:2048
    ds_read_b64_tr_b16 v[190:191], v247 offset:2560
    s_mov_b32 m0, s68
    v_mfma_f32_32x32x16_bf16 v[16:31], v[68:71], v[176:179], 0
    buffer_load_dwordx4 v224, s[4:7], s41 offen lds
    buffer_load_dwordx4 v225, s[72:75], s41 offen offset:1024 lds
    v_permlane32_swap_b32 v242, v243
    v_permlane32_swap_b32 v240, v241
    v_mov_b32 v254, 162048
    v_mfma_f32_32x32x16_bf16 v[32:47], v[64:67], v[180:183], 0
    v_permlane32_swap_b32 v236, v237
    v_permlane32_swap_b32 v244, v245
    v_add_f32 v242, v242, v243
    v_add_f32 v240, -v240, -v241
    v_add_f32 v236, v236, v237
    v_mfma_f32_32x32x16_bf16 v[48:63], v[68:71], v[180:183], 0
    v_add_f32 v244, v244, v245
    v_cvt_pk_bf16_f32 v242, v242, v236
    v_cvt_pk_bf16_f32 v244, v244, v240
    v_cvt_pk_bf16_f32 v238, v238, v238
    ds_write_b16 v230, v242 offset:1152
    ds_write_b16_d16_hi v230, v242 offset:128
    v_mov_b32 v255, 1
    v_lshl_add_u32 v233, v252, 1, s53
    s_mov_b64 exec, 1
    ds_add_rtn_u32 v232, v254, v255
    s_mov_b64 exec, -1
    ds_read_b32 v233, v233
    s_waitcnt vmcnt(4) lgkmcnt(4)
    v_mfma_f32_32x32x16_bf16 v[0:15], v[72:75], v[184:187], v[0:15]
    ds_read_b64_tr_b16 v[176:177], v246 offset:4096
    ds_read_b64_tr_b16 v[178:179], v246 offset:4608
    ds_read_b64_tr_b16 v[180:181], v247 offset:4096
    ds_read_b64_tr_b16 v[182:183], v247 offset:4608
    ds_write_b16 v230, v244 offset:512
    ds_write_b16_d16_hi v230, v244 offset:896
    s_mov_b32 m0, s69
    v_mfma_f32_32x32x16_bf16 v[16:31], v[76:79], v[184:187], v[16:31]
    buffer_load_dwordx4 v226, s[4:7], s41 offen lds
    buffer_load_dwordx4 v227, s[72:75], s41 offen offset:1024 lds
    ds_write_b16 v230, v238 offset:1280
    s_waitcnt lgkmcnt(7)
    v_readfirstlane_b32 s58, v232
    v_mfma_f32_32x32x16_bf16 v[32:47], v[72:75], v[188:191], v[32:47]
    s_cmp_lt_u32 s58, s22
    s_cbranch_scc0 K2_nul_51
    s_and_b32 s59, s58, 7
    s_lshr_b32 s60, s58, 3
K2_chk_53:
    v_readlane_b32 s61, v233, s59
    s_nop 0
    s_cmp_gt_u32 s61, s60
    s_cbranch_scc0 K2_spin_52
K2_back_54:
    v_mfma_f32_32x32x16_bf16 v[48:63], v[76:79], v[188:191], v[48:63]
    v_readlane_b32 s59, v253, s58
    s_lshl_b32 s44, s34, 7
    s_and_b32 s48, s59, 0x3ffff
    s_bfe_u32 s33, s59, 0x30012
    s_lshr_b32 s60, s59, 21
    s_add_u32 s35, s60, s48
    s_waitcnt vmcnt(4) lgkmcnt(3)
    v_mfma_f32_32x32x16_bf16 v[0:15], v[80:83], v[176:179], v[0:15]
    ds_read_b64_tr_b16 v[184:185], v246 offset:6144
    ds_read_b64_tr_b16 v[186:187], v246 offset:6656
    ds_read_b64_tr_b16 v[188:189], v247 offset:6144
    ds_read_b64_tr_b16 v[190:191], v247 offset:6656
    s_mov_b32 s45, s44
    s_add_u32 s47, s44, 256
    s_mov_b32 m0, s70
    v_mfma_f32_32x32x16_bf16 v[16:31], v[84:87], v[176:179], v[16:31]
    buffer_load_dwordx4 v222, s[4:7], s42 offen lds
    buffer_load_dwordx4 v223, s[72:75], s42 offen offset:1024 lds
    s_add_u32 s49, s48, 800
    s_add_u32 s60, s48, 1600
    v_mfma_f32_32x32x16_bf16 v[32:47], v[80:83], v[180:183], v[32:47]
    s_cmp_eq_u32 s33, 3
    s_cselect_b32 s46, s44, s47
    s_cselect_b32 s50, s60, s48
    s_cselect_b32 s51, s48, s49
    s_sub_u32 s60, s33, 2
    s_cmp_lt_u32 s60, 2
    s_cbranch_scc0 K2_rare_55
K2_back_56:
    v_mfma_f32_32x32x16_bf16 v[48:63], v[84:87], v[180:183], v[48:63]
    s_setprio 0
    v_mul_f32 v234, v0, v96
    v_mul_f32 v236, v8, v128
    v_fmac_f32 v234, v1, v97
    v_fmac_f32 v236, v9, v129
    v_fmac_f32 v234, v2, v98
    v_fmac_f32 v236, v10, v130
    v_fmac_f32 v234, v3, v99
    v_fmac_f32 v236, v11, v131
    v_fmac_f32 v234, v4, v100
    v_fmac_f32 v236, v12, v132
    v_fmac_f32 v234, v5, v101
    v_fmac_f32 v236, v13, v133
    v_fmac_f32 v234, v6, v102
    v_fmac_f32 v236, v14, v134
    v_fmac_f32 v234, v7, v103
    v_fmac_f32 v236, v15, v135
    v_mul_f32 v238, v16, v128
    v_mul_f32 v240, v24, v128
    v_fmac_f32 v238, v17, v129
    v_fmac_f32 v240, v25, v129
    v_fmac_f32 v238, v18, v130
    v_fmac_f32 v240, v26, v130
    v_fmac_f32 v238, v19, v131
    v_fmac_f32 v240, v27, v131
    v_fmac_f32 v238, v20, v132
    v_fmac_f32 v240, v28, v132
    v_fmac_f32 v238, v21, v133
    v_fmac_f32 v240, v29, v133
    v_fmac_f32 v238, v22, v134
    v_fmac_f32 v240, v30, v134
    v_fmac_f32 v238, v23, v135
    v_fmac_f32 v240, v31, v135
    v_mul_f32 v235, v32, v104
    v_mul_f32 v237, v40, v136
    v_fmac_f32 v235, v33, v105
    v_fmac_f32 v237, v41, v137
    v_fmac_f32 v235, v34, v106
    v_fmac_f32 v237, v42, v138
    v_fmac_f32 v235, v35, v107
    v_fmac_f32 v237, v43, v139
    v_fmac_f32 v235, v36, v108
    v_fmac_f32 v237, v44, v140
    v_fmac_f32 v235, v37, v109
    v_fmac_f32 v237, v45, v141
    v_fmac_f32 v235, v38, v110
    v_fmac_f32 v237, v46, v142
    v_fmac_f32 v235, v39, v111
    v_fmac_f32 v237, v47, v143
    v_mul_f32 v239, v48, v136
    v_mul_f32 v241, v56, v136
    s_setprio 1
    s_waitcnt vmcnt(4) lgkmcnt(0)
    v_mfma_f32_32x32x16_bf16 v[0:15], v[64:67], v[184:187], 0
    ds_read_b64_tr_b16 v[176:177], v246 offset:0
    ds_read_b64_tr_b16 v[178:179], v246 offset:512
    ds_read_b64_tr_b16 v[180:181], v247 offset:0
    ds_read_b64_tr_b16 v[182:183], v247 offset:512
    v_fmac_f32 v239, v49, v137
    v_fmac_f32 v241, v57, v137
    s_mov_b32 m0, s71
    v_mfma_f32_32x32x16_bf16 v[16:31], v[68:71], v[184:187], 0
    buffer_load_dwordx4 v224, s[4:7], s42 offen lds
    buffer_load_dwordx4 v225, s[72:75], s42 offen offset:1024 lds
    v_fmac_f32 v239, v50, v138
    v_fmac_f32 v241, v58, v138
    v_fmac_f32 v239, v51, v139
    v_fmac_f32 v241, v59, v139
    v_fmac_f32 v239, v52, v140
    v_mfma_f32_32x32x16_bf16 v[32:47], v[64:67], v[188:191], 0
    v_fmac_f32 v241, v60, v140
    v_fmac_f32 v239, v53, v141
    v_fmac_f32 v241, v61, v141
    v_fmac_f32 v239, v54, v142
    v_fmac_f32 v241, v62, v142
    v_fmac_f32 v239, v55, v143
    v_fmac_f32 v241, v63, v143
    v_mfma_f32_32x32x16_bf16 v[48:63], v[68:71], v[188:191], 0
    v_permlane32_swap_b32 v234, v235
    v_permlane32_swap_b32 v236, v237
    v_permlane32_swap_b32 v238, v239
    s_waitcnt vmcnt(4) lgkmcnt(0)
    v_mfma_f32_32x32x16_bf16 v[0:15], v[72:75], v[176:179], v[0:15]
    ds_read_b64_tr_b16 v[184:185], v246 offset:2048
    ds_read_b64_tr_b16 v[186:187], v246 offset:2560
    ds_read_b64_tr_b16 v[188:189], v247 offset:2048
    ds_read_b64_tr_b16 v[190:191], v247 offset:2560
    v_permlane32_swap_b32 v240, v241
    s_mov_b32 m0, s68
    v_mfma_f32_32x32x16_bf16 v[16:31], v[76:79], v[176:179], v[16:31]
    buffer_load_dwordx4 v226, s[4:7], s42 offen lds
    buffer_load_dwordx4 v227, s[72:75], s42 offen offset:1024 lds
    v_add_u32 v230, s31, v252
    v_add_f32 v234, v234, v235
    v_add_f32 v236, v236, v237
    v_add_f32 v238, v238, v239
    v_add_f32 v240, v240, v241
    v_mfma_f32_32x32x16_bf16 v[32:47], v[72:75], v[180:183], v[32:47]
    v_cvt_pk_bf16_f32 v234, v234, v236
    v_cvt_pk_bf16_f32 v238, v238, v240
    ds_write_b16 v230, v234 offset:0
    ds_write_b16_d16_hi v230, v234 offset:256
    ds_write_b16 v230, v238 offset:640
    ds_write_b16_d16_hi v230, v238 offset:1024
    v_mfma_f32_32x32x16_bf16 v[48:63], v[76:79], v[180:183], v[48:63]
    s_waitcnt vmcnt(4) lgkmcnt(4)
    v_mfma_f32_32x32x16_bf16 v[0:15], v[80:83], v[184:187], v[0:15]
    ds_read_b64_tr_b16 v[176:177], v246 offset:4096
    ds_read_b64_tr_b16 v[178:179], v246 offset:4608
    ds_read_b64_tr_b16 v[180:181], v247 offset:4096
    ds_read_b64_tr_b16 v[182:183], v247 offset:4608
    s_mov_b32 m0, s69
    v_mfma_f32_32x32x16_bf16 v[16:31], v[84:87], v[184:187], v[16:31]
    buffer_load_dwordx4 v222, s[4:7], s43 offen lds
    buffer_load_dwordx4 v223, s[72:75], s43 offen offset:1024 lds
    v_mfma_f32_32x32x16_bf16 v[32:47], v[80:83], v[188:191], v[32:47]
    s_nop 2
    v_mul_f32 v234, v0, v144
    v_mul_f32 v236, v8, v112
    v_fmac_f32 v234, v1, v145
    v_fmac_f32 v236, v9, v113
    v_fmac_f32 v234, v2, v146
    v_fmac_f32 v236, v10, v114
    v_fmac_f32 v234, v3, v147
    v_mfma_f32_32x32x16_bf16 v[48:63], v[84:87], v[188:191], v[48:63]
    s_setprio 0
    v_fmac_f32 v236, v11, v115
    v_fmac_f32 v234, v4, v148
    v_fmac_f32 v236, v12, v116
    v_fmac_f32 v234, v5, v149
    v_fmac_f32 v236, v13, v117
    v_fmac_f32 v234, v6, v150
    v_fmac_f32 v236, v14, v118
    v_fmac_f32 v234, v7, v151
    v_fmac_f32 v236, v15, v119
    v_mul_f32 v238, v16, v160
    v_mul_f32 v240, v24, v160
    v_fmac_f32 v238, v17, v161
    v_fmac_f32 v240, v25, v161
    v_fmac_f32 v238, v18, v162
    v_fmac_f32 v240, v26, v162
    v_fmac_f32 v238, v19, v163
    v_fmac_f32 v240, v27, v163
    v_fmac_f32 v238, v20, v164
    v_fmac_f32 v240, v28, v164
    v_fmac_f32 v238, v21, v165
    v_fmac_f32 v240, v29, v165
    v_fmac_f32 v238, v22, v166
    v_fmac_f32 v240, v30, v166
    v_fmac_f32 v238, v23, v167
    v_fmac_f32 v240, v31, v167
    v_mul_f32 v235, v32, v152
    v_mul_f32 v237, v40, v120
    v_fmac_f32 v235, v33, v153
    v_fmac_f32 v237, v41, v121
    v_fmac_f32 v235, v34, v154
    v_fmac_f32 v237, v42, v122
    v_fmac_f32 v235, v35, v155
    v_fmac_f32 v237, v43, v123
    v_fmac_f32 v235, v36, v156
    v_fmac_f32 v237, v44, v124
    v_fmac_f32 v235, v37, v157
    v_fmac_f32 v237, v45, v125
    v_fmac_f32 v235, v38, v158
    v_fmac_f32 v237, v46, v126
    v_fmac_f32 v235, v39, v159
    v_fmac_f32 v237, v47, v127
    v_mul_f32 v239, v48, v168
    v_mul_f32 v241, v56, v168
    v_fmac_f32 v239, v49, v169
    v_fmac_f32 v241, v57, v169
    s_setprio 1
    s_waitcnt vmcnt(4) lgkmcnt(0)
    v_mfma_f32_32x32x16_bf16 v[0:15], v[64:67], v[176:179], 0
    ds_read_b64_tr_b16 v[184:185], v246 offset:6144
    ds_read_b64_tr_b16 v[186:187], v246 offset:6656
    ds_read_b64_tr_b16 v[188:189], v247 offset:6144
    ds_read_b64_tr_b16 v[190:191], v247 offset:6656
    v_fmac_f32 v239, v50, v170
    v_fmac_f32 v241, v58, v170
    s_mov_b32 m0, s70
    v_mfma_f32_32x32x16_bf16 v[16:31], v[68:71], v[176:179], 0
    buffer_load_dwordx4 v224, s[4:7], s43 offen lds
    buffer_load_dwordx4 v225, s[72:75], s43 offen offset:1024 lds
    v_fmac_f32 v239, v51, v171
    v_fmac_f32 v241, v59, v171
    v_fmac_f32 v239, v52, v172
    v_fmac_f32 v241, v60, v172
    v_fmac_f32 v239, v53, v173
    v_mfma_f32_32x32x16_bf16 v[32:47], v[64:67], v[180:183], 0
    v_add_u32 v222, s48, v251
    ds_read_b32 v222, v222
    v_fmac_f32 v241, v61, v173
    v_fmac_f32 v239, v54, v174
    v_fmac_f32 v241, v62, v174
    v_fmac_f32 v239, v55, v175
    v_fmac_f32 v241, v63, v175
    v_mfma_f32_32x32x16_bf16 v[48:63], v[68:71], v[180:183], 0
    v_permlane32_swap_b32 v234, v235
    v_add_f32 v234, v234, v235
    s_waitcnt vmcnt(4) lgkmcnt(1)
    v_mfma_f32_32x32x16_bf16 v[0:15], v[72:75], v[184:187], v[0:15]
    ds_read_b64_tr_b16 v[176:177], v246 offset:0
    ds_read_b64_tr_b16 v[178:179], v246 offset:512
    ds_read_b64_tr_b16 v[180:181], v247 offset:0
    ds_read_b64_tr_b16 v[182:183], v247 offset:512
    s_mov_b32 m0, s71
    v_mfma_f32_32x32x16_bf16 v[16:31], v[76:79], v[184:187], v[16:31]
    buffer_load_dwordx4 v226, s[4:7], s43 offen lds
    buffer_load_dwordx4 v227, s[72:75], s43 offen offset:1024 lds
    s_waitcnt lgkmcnt(4)
    v_mad_u32_u16 v223, v222, s39, v248 op_sel:[1,0,0,0]
    v_mad_u32_u16 v222, v222, s39, v248
    v_mfma_f32_32x32x16_bf16 v[32:47], v[72:75], v[188:191], v[32:47]
    v_add_u32 v224, s49, v251
    ds_read_b32 v224, v224
    v_mfma_f32_32x32x16_bf16 v[48:63], v[76:79], v[188:191], v[48:63]
    s_waitcnt vmcnt(4) lgkmcnt(1)
    v_mfma_f32_32x32x16_bf16 v[0:15], v[80:83], v[176:179], v[0:15]
    ds_read_b64_tr_b16 v[184:185], v246 offset:2048
    ds_read_b64_tr_b16 v[186:187], v246 offset:2560
    ds_read_b64_tr_b16 v[188:189], v247 offset:2048
    ds_read_b64_tr_b16 v[190:191], v247 offset:2560
    s_mov_b32 m0, s68
    v_mfma_f32_32x32x16_bf16 v[16:31], v[84:87], v[176:179], v[16:31]
    buffer_load_dwordx4 v222, s[4:7], s44 offen lds
    buffer_load_dwordx4 v223, s[72:75], s44 offen offset:1024 lds
    s_waitcnt lgkmcnt(4)
    v_mad_u32_u16 v225, v224, s39, v248 op_sel:[1,0,0,0]
    v_mad_u32_u16 v224, v224, s39, v248
    v_mfma_f32_32x32x16_bf16 v[32:47], v[80:83], v[180:183], v[32:47]
    v_add_u32 v226, s50, v251
    ds_read_b32 v226, v226
    v_mul_f32 v242, v0, v144
    v_fma_f32 v238, v8, v160, -v238
    v_fmac_f32 v242, v1, v145
    v_fmac_f32 v238, v9, v161
    v_fmac_f32 v242, v2, v146
    v_mfma_f32_32x32x16_bf16 v[48:63], v[84:87], v[180:183], v[48:63]
    s_setprio 0
    v_fmac_f32 v238, v10, v162
    v_fmac_f32 v242, v3, v147
    v_fmac_f32 v238, v11, v163
    v_fmac_f32 v242, v4, v148
    v_fmac_f32 v238, v12, v164
    v_fmac_f32 v242, v5, v149
    v_fmac_f32 v238, v13, v165
    v_fmac_f32 v242, v6, v150
    v_fmac_f32 v238, v14, v166
    v_fmac_f32 v242, v7, v151
    v_fmac_f32 v238, v15, v167
    v_fmac_f32 v236, v16, v112
    v_mul_f32 v244, v24, v160
    v_fmac_f32 v236, v17, v113
    v_fmac_f32 v244, v25, v161
    v_fmac_f32 v236, v18, v114
    v_fmac_f32 v244, v26, v162
    v_fmac_f32 v236, v19, v115
    v_fmac_f32 v244, v27, v163
    v_fmac_f32 v236, v20, v116
    v_fmac_f32 v244, v28, v164
    v_fmac_f32 v236, v21, v117
    v_fmac_f32 v244, v29, v165
    v_fmac_f32 v236, v22, v118
    v_fmac_f32 v244, v30, v166
    v_fmac_f32 v236, v23, v119
    v_fmac_f32 v244, v31, v167
    v_mul_f32 v243, v32, v152
    v_fma_f32 v239, v40, v168, -v239
    v_fmac_f32 v243, v33, v153
    v_fmac_f32 v239, v41, v169
    v_fmac_f32 v243, v34, v154
    v_fmac_f32 v239, v42, v170
    v_fmac_f32 v243, v35, v155
    v_fmac_f32 v239, v43, v171
    v_fmac_f32 v243, v36, v156
    v_fmac_f32 v239, v44, v172
    v_fmac_f32 v243, v37, v157
    v_fmac_f32 v239, v45, v173
    v_fmac_f32 v243, v38, v158
    v_fmac_f32 v239, v46, v174
    v_fmac_f32 v243, v39, v159
    v_fmac_f32 v239, v47, v175
    v_fmac_f32 v237, v48, v120
    v_mul_f32 v245, v56, v168
    v_fmac_f32 v237, v49, v121
    v_fmac_f32 v245, v57, v169
    v_fmac_f32 v237, v50, v122
    v_fmac_f32 v245, v58, v170
    v_fmac_f32 v237, v51, v123
    s_setprio 1
    s_waitcnt vmcnt(4) lgkmcnt(1)
    v_mfma_f32_32x32x16_bf16 v[0:15], v[64:67], v[184:187], 0
    ds_read_b64_tr_b16 v[176:177], v246 offset:4096
    ds_read_b64_tr_b16 v[178:179], v246 offset:4608
    ds_read_b64_tr_b16 v[180:181], v247 offset:4096
    ds_read_b64_tr_b16 v[182:183], v247 offset:4608
    v_fmac_f32 v245, v59, v171
    v_fmac_f32 v237, v52, v124
    s_mov_b32 m0, s69
    v_mfma_f32_32x32x16_bf16 v[16:31], v[68:71], v[184:187], 0
    buffer_load_dwordx4 v224, s[4:7], s45 offen lds
    buffer_load_dwordx4 v225, s[72:75], s45 offen offset:1024 lds
    s_waitcnt lgkmcnt(4)
    v_mad_u32_u16 v227, v226, s39, v248 op_sel:[1,0,0,0]
    v_mad_u32_u16 v226, v226, s39, v248
    v_fmac_f32 v245, v60, v172
    v_fmac_f32 v237, v53, v125
    v_mfma_f32_32x32x16_bf16 v[32:47], v[64:67], v[188:191], 0
    v_add_u32 v228, s51, v251
    ds_read_b32 v228, v228
    v_fmac_f32 v245, v61, v173
    v_fmac_f32 v237, v54, v126
    v_fmac_f32 v245, v62, v174
    v_fmac_f32 v237, v55, v127
    v_fmac_f32 v245, v63, v175
    v_mfma_f32_32x32x16_bf16 v[48:63], v[68:71], v[188:191], 0
    v_permlane32_swap_b32 v238, v239
    v_permlane32_swap_b32 v242, v243
    v_add_f32 v238, v238, v239
    v_add_f32 v242, v242, v243
    s_waitcnt vmcnt(4) lgkmcnt(1)
    v_mfma_f32_32x32x16_bf16 v[0:15], v[72:75], v[176:179], v[0:15]
    ds_read_b64_tr_b16 v[184:185], v246 offset:6144
    ds_read_b64_tr_b16 v[186:187], v246 offset:6656
    ds_read_b64_tr_b16 v[188:189], v247 offset:6144
    ds_read_b64_tr_b16 v[190:191], v247 offset:6656
    v_cvt_pk_bf16_f32 v234, v234, v242
    ds_write_b16 v230, v234 offset:384
    s_mov_b32 m0, s70
    v_mfma_f32_32x32x16_bf16 v[16:31], v[76:79], v[176:179], v[16:31]
    buffer_load_dwordx4 v226, s[4:7], s46 offen lds
    buffer_load_dwordx4 v227, s[72:75], s46 offen offset:1024 lds
    s_waitcnt lgkmcnt(5)
    v_mad_u32_u16 v229, v228, s39, v248 op_sel:[1,0,0,0]
    v_mad_u32_u16 v228, v228, s39, v248
    ds_write_b16_d16_hi v230, v234 offset:768
    v_mfma_f32_32x32x16_bf16 v[32:47], v[72:75], v[180:183], v[32:47]
    v_mfma_f32_32x32x16_bf16 v[48:63], v[76:79], v[180:183], v[48:63]
    s_waitcnt vmcnt(4) lgkmcnt(2)
    v_mfma_f32_32x32x16_bf16 v[0:15], v[80:83], v[184:187], v[0:15]
    ds_read_b64_tr_b16 v[176:177], v246 offset:0
    ds_read_b64_tr_b16 v[178:179], v246 offset:512
    ds_read_b64_tr_b16 v[180:181], v247 offset:0
    ds_read_b64_tr_b16 v[182:183], v247 offset:512
    s_mov_b32 m0, s71
    v_mfma_f32_32x32x16_bf16 v[16:31], v[84:87], v[184:187], v[16:31]
    buffer_load_dwordx4 v228, s[4:7], s47 offen lds
    buffer_load_dwordx4 v229, s[72:75], s47 offen offset:1024 lds
    v_mfma_f32_32x32x16_bf16 v[32:47], v[80:83], v[188:191], v[32:47]
    s_nop 2
    v_mul_f32 v242, v0, v144
    v_fma_f32 v240, v8, v160, -v240
    v_fmac_f32 v242, v1, v145
    v_fmac_f32 v240, v9, v161
    v_fmac_f32 v242, v2, v146
    v_fmac_f32 v240, v10, v162
    v_fmac_f32 v242, v3, v147
    v_mfma_f32_32x32x16_bf16 v[48:63], v[84:87], v[188:191], v[48:63]
    s_setprio 0
    v_fmac_f32 v240, v11, v163
    v_fmac_f32 v242, v4, v148
    v_fmac_f32 v240, v12, v164
    v_fmac_f32 v242, v5, v149
    v_fmac_f32 v240, v13, v165
    v_fmac_f32 v242, v6, v150
    v_fmac_f32 v240, v14, v166
    v_fmac_f32 v242, v7, v151
    v_fmac_f32 v240, v15, v167
    s_sub_u32 s58, s48, s29
    v_add_u32 v249, s58, v249
    v_add_u32 v250, s58, v250
    v_fma_f32 v244, v16, v160, -v244
    v_fmac_f32 v236, v24, v112
    v_fmac_f32 v244, v17, v161
    v_fmac_f32 v236, v25, v113
    v_fmac_f32 v244, v18, v162
    v_fmac_f32 v236, v26, v114
    v_fmac_f32 v244, v19, v163
    v_fmac_f32 v236, v27, v115
    v_fmac_f32 v244, v20, v164
    v_fmac_f32 v236, v28, v116
    v_fmac_f32 v244, v21, v165
    v_fmac_f32 v236, v29, v117
    v_fmac_f32 v244, v22, v166
    v_fmac_f32 v236, v30, v118
    v_fmac_f32 v244, v23, v167
    v_fmac_f32 v236, v31, v119
    ds_read_b64_tr_b16 v[0:1], v249 offset:0
    ds_read_b64_tr_b16 v[2:3], v249 offset:128
    ds_read_b128 v[4:7], v250 offset:0
    ds_read_b128 v[8:11], v250 offset:16
    ds_read_b128 v[12:15], v250 offset:128
    ds_read_b128 v[16:19], v250 offset:144
    v_mul_f32 v243, v32, v152
    v_fma_f32 v241, v40, v168, -v241
    v_fmac_f32 v243, v33, v153
    v_fmac_f32 v241, v41, v169
    v_fmac_f32 v243, v34, v154
    v_fmac_f32 v241, v42, v170
    v_fmac_f32 v243, v35, v155
    v_fmac_f32 v241, v43, v171
    v_fmac_f32 v243, v36, v156
    v_fmac_f32 v241, v44, v172
    v_fmac_f32 v243, v37, v157
    v_fmac_f32 v241, v45, v173
    v_fmac_f32 v243, v38, v158
    v_fmac_f32 v241, v46, v174
    v_fmac_f32 v243, v39, v159
    v_fmac_f32 v241, v47, v175
    ds_read_b64_tr_b16 v[20:21], v249 offset:800
    ds_read_b64_tr_b16 v[22:23], v249 offset:928
    ds_read_b128 v[24:27], v250 offset:800
    ds_read_b128 v[28:31], v250 offset:816
    ds_read_b128 v[32:35], v250 offset:928
    ds_read_b128 v[36:39], v250 offset:944
    v_fma_f32 v245, v48, v168, -v245
    v_fmac_f32 v237, v56, v120
    v_fmac_f32 v245, v49, v169
    v_fmac_f32 v237, v57, v121
    v_fmac_f32 v245, v50, v170
    v_fmac_f32 v237, v58, v122
    v_fmac_f32 v245, v51, v171
    v_fmac_f32 v237, v59, v123
    v_fmac_f32 v245, v52, v172
    v_fmac_f32 v237, v60, v124
    v_fmac_f32 v245, v53, v173
    v_fmac_f32 v237, v61, v125
    v_fmac_f32 v245, v54, v174
    v_fmac_f32 v237, v62, v126
    v_fmac_f32 v245, v55, v175
    v_fmac_f32 v237, v63, v127
    s_cmp_eq_u32 s36, 0
    s_cbranch_scc1 K2_TAIL
    s_mov_b32 s29, s48
    s_mov_b32 s32, s31
    s_mov_b32 s31, s35
    s_cmp_eq_u32 s33, 2
    s_cbranch_scc1 K2_U21
    s_cmp_eq_u32 s33, 3
    s_cbranch_scc1 K2_U31
    s_cmp_eq_u32 s33, 1
    s_cbranch_scc1 K2_U11
    s_branch K2_U41
K2_U10:
    s_setprio 1
    s_add_u32 s38, s38, 1
    v_mov_b32 v254, s52
    v_mov_b32 v255, s38
    s_lshl_b32 s58, s38, 3
    s_add_u32 s58, s58, s20
    s_mov_b64 exec, 1
    ds_write_b32 v254, v255
    s_mov_b64 exec, -1
    s_cmp_lt_u32 s58, s22
    s_cbranch_scc0 K2_dyn_58
K2_back_59:
    s_waitcnt lgkmcnt(11)
    v_lshlrev_b32 v40, 16, v0
    v_and_b32 v41, 0xffff0000, v0
    v_lshlrev_b32 v42, 16, v1
    v_and_b32 v43, 0xffff0000, v1
    v_lshlrev_b32 v44, 16, v2
    v_and_b32 v45, 0xffff0000, v2
    v_lshlrev_b32 v46, 16, v3
    v_and_b32 v47, 0xffff0000, v3
    s_waitcnt lgkmcnt(9)
    v_mul_f32 v4, v40, v4
    v_mul_f32 v5, v41, v5
    v_mul_f32 v6, v42, v6
    v_mul_f32 v7, v43, v7
    v_mul_f32 v8, v44, v8
    v_mul_f32 v9, v45, v9
    v_mul_f32 v10, v46, v10
    v_mul_f32 v11, v47, v11
    v_cvt_pk_bf16_f32 v64, v4, v5
    v_cvt_pk_bf16_f32 v65, v6, v7
    v_cvt_pk_bf16_f32 v66, v8, v9
    v_cvt_pk_bf16_f32 v67, v10, v11
    s_waitcnt lgkmcnt(7)
    v_mul_f32 v12, v40, v12
    v_mul_f32 v13, v41, v13
    v_mul_f32 v14, v42, v14
    v_mul_f32 v15, v43, v15
    v_mul_f32 v16, v44, v16
    v_mul_f32 v17, v45, v17
    v_mul_f32 v18, v46, v18
    v_mul_f32 v19, v47, v19
    v_cvt_pk_bf16_f32 v68, v12, v13
    v_cvt_pk_bf16_f32 v69, v14, v15
    v_cvt_pk_bf16_f32 v70, v16, v17
    v_cvt_pk_bf16_f32 v71, v18, v19
    v_readlane_b32 s59, v253, s58
    s_lshl_b32 s44, s34, 7
    s_and_b32 s48, s59, 0x3ffff
    s_bfe_u32 s33, s59, 0x30012
    s_lshr_b32 s60, s59, 21
    s_add_u32 s60, s60, s48
    s_mul_i32 s35, s38, 6
    s_cmp_eq_u32 s34, 0
    s_cselect_b32 s35, s35, s60
    s_mov_b32 s45, s44
    s_add_u32 s47, s44, 256
    s_add_u32 s49, s48, 800
    s_add_u32 s60, s48, 1600
    s_cmp_eq_u32 s33, 3
    s_cselect_b32 s46, s44, s47
    s_cselect_b32 s50, s60, s48
    s_cselect_b32 s51, s48, s49
    s_sub_u32 s60, s33, 2
    s_cmp_lt_u32 s60, 2
    s_cbranch_scc0 K2_rare_64
K2_back_65:
    v_add_u32 v232, s48, v230
    v_add_u32 v233, s50, v230
    ds_read_b32 v232, v232
    ds_read_b32 v233, v233
    v_add_u32 v222, s48, v251
    ds_read_b32 v222, v222
    v_add_u32 v224, s49, v251
    ds_read_b32 v224, v224
    v_add_u32 v226, s50, v251
    ds_read_b32 v226, v226
    v_add_u32 v228, s51, v251
    ds_read_b32 v228, v228
    s_waitcnt lgkmcnt(4)
    v_or_b32 v232, v232, v231
    v_or_b32 v233, v233, v231
    s_cmp_lg_u32 s34, 0
    s_cbranch_scc1 K2_dum_67
    s_mov_b32 m0, s48
    s_mov_b32 exec_hi, 0
    buffer_load_dwordx4 v232, s[16:19], 0 offen  lds
    s_mov_b32 m0, s50
    s_add_u32 s65, s48, 288
    buffer_load_dwordx4 v233, s[16:19], 0 offen  lds
    s_not_b64 exec, exec
    s_mov_b32 m0, s65
    s_cmp_eq_u32 s33, 4
    buffer_load_dwordx4 v232, s[16:19], 0 offen  lds
    s_cbranch_scc1 K2_a4_68
K2_b4_70:
    s_mov_b32 exec_lo, -1
K2_back_69:
    s_waitcnt lgkmcnt(3)
    v_mad_u32_u16 v223, v222, s39, v248 op_sel:[1,0,0,0]
    v_mad_u32_u16 v222, v222, s39, v248
    s_waitcnt lgkmcnt(2)
    v_mad_u32_u16 v225, v224, s39, v248 op_sel:[1,0,0,0]
    v_mad_u32_u16 v224, v224, s39, v248
    s_waitcnt lgkmcnt(1)
    v_mad_u32_u16 v227, v226, s39, v248 op_sel:[1,0,0,0]
    v_mad_u32_u16 v226, v226, s39, v248
    s_waitcnt lgkmcnt(0)
    v_mad_u32_u16 v229, v228, s39, v248 op_sel:[1,0,0,0]
    v_mad_u32_u16 v228, v228, s39, v248
    s_waitcnt vmcnt(7)
    v_mfma_f32_32x32x16_bf16 v[0:15], v[64:67], v[176:179], 0
    ds_read_b64_tr_b16 v[184:185], v246 offset:2048
    ds_read_b64_tr_b16 v[186:187], v246 offset:2560
    ds_read_b64_tr_b16 v[188:189], v247 offset:2048
    ds_read_b64_tr_b16 v[190:191], v247 offset:2560
    s_mov_b32 m0, s68
    v_mfma_f32_32x32x16_bf16 v[16:31], v[68:71], v[176:179], 0
    buffer_load_dwordx4 v222, s[4:7], s44 offen lds
    buffer_load_dwordx4 v223, s[72:75], s44 offen offset:1024 lds
    v_permlane32_swap_b32 v242, v243
    v_permlane32_swap_b32 v240, v241
    v_mfma_f32_32x32x16_bf16 v[32:47], v[64:67], v[180:183], 0
    v_permlane32_swap_b32 v236, v237
    v_permlane32_swap_b32 v244, v245
    v_add_f32 v242, v242, v243
    v_add_f32 v240, -v240, -v241
    v_add_f32 v236, v236, v237
    v_mfma_f32_32x32x16_bf16 v[48:63], v[68:71], v[180:183], 0
    s_setprio 0
    v_add_f32 v244, v244, v245
    s_set_gpr_idx_on s32, gpr_idx(DST)
    s_nop 0
    v_cvt_pk_bf16_f32 v195, v242, v236
    v_cvt_pk_bf16_f32 v196, v244, v240
    v_cvt_pk_bf16_f32 v197, v238, v238
    s_set_gpr_idx_off
    v_mul_f32 v234, v0, v96
    v_mul_f32 v236, v8, v128
    v_fmac_f32 v234, v1, v97
    v_fmac_f32 v236, v9, v129
    v_fmac_f32 v234, v2, v98
    v_fmac_f32 v236, v10, v130
    v_fmac_f32 v234, v3, v99
    v_fmac_f32 v236, v11, v131
    v_fmac_f32 v234, v4, v100
    v_fmac_f32 v236, v12, v132
    v_fmac_f32 v234, v5, v101
    v_fmac_f32 v236, v13, v133
    v_fmac_f32 v234, v6, v102
    v_fmac_f32 v236, v14, v134
    v_fmac_f32 v234, v7, v103
    v_fmac_f32 v236, v15, v135
    v_mul_f32 v238, v16, v128
    v_mul_f32 v240, v24, v128
    v_fmac_f32 v238, v17, v129
    v_fmac_f32 v240, v25, v129
    v_fmac_f32 v238, v18, v130
    v_fmac_f32 v240, v26, v130
    v_fmac_f32 v238, v19, v131
    v_fmac_f32 v240, v27, v131
    v_fmac_f32 v238, v20, v132
    v_fmac_f32 v240, v28, v132
    v_fmac_f32 v238, v21, v133
    v_fmac_f32 v240, v29, v133
    v_fmac_f32 v238, v22, v134
    v_fmac_f32 v240, v30, v134
    v_fmac_f32 v238, v23, v135
    v_fmac_f32 v240, v31, v135
    v_mul_f32 v235, v32, v104
    v_mul_f32 v237, v40, v136
    v_fmac_f32 v235, v33, v105
    v_fmac_f32 v237, v41, v137
    v_fmac_f32 v235, v34, v106
    v_fmac_f32 v237, v42, v138
    v_fmac_f32 v235, v35, v107
    v_fmac_f32 v237, v43, v139
    v_fmac_f32 v235, v36, v108
    v_fmac_f32 v237, v44, v140
    v_fmac_f32 v235, v37, v109
    v_fmac_f32 v237, v45, v141
    v_fmac_f32 v235, v38, v110
    v_fmac_f32 v237, v46, v142
    v_fmac_f32 v235, v39, v111
    v_fmac_f32 v237, v47, v143
    v_mul_f32 v239, v48, v136
    v_mul_f32 v241, v56, v136
    v_fmac_f32 v239, v49, v137
    v_fmac_f32 v241, v57, v137
    v_fmac_f32 v239, v50, v138
    v_fmac_f32 v241, v58, v138
    v_fmac_f32 v239, v51, v139
    v_fmac_f32 v241, v59, v139
    v_fmac_f32 v239, v52, v140
    v_fmac_f32 v241, v60, v140
    v_fmac_f32 v239, v53, v141
    v_fmac_f32 v241, v61, v141
    v_fmac_f32 v239, v54, v142
    v_fmac_f32 v241, v62, v142
    v_fmac_f32 v239, v55, v143
    v_fmac_f32 v241, v63, v143
    s_setprio 1
    s_waitcnt vmcnt(7) lgkmcnt(0)
    v_mfma_f32_32x32x16_bf16 v[0:15], v[64:67], v[184:187], 0
    ds_read_b64_tr_b16 v[176:177], v246 offset:4096
    ds_read_b64_tr_b16 v[178:179], v246 offset:4608
    ds_read_b64_tr_b16 v[180:181], v247 offset:4096
    ds_read_b64_tr_b16 v[182:183], v247 offset:4608
    s_mov_b32 m0, s69
    v_mfma_f32_32x32x16_bf16 v[16:31], v[68:71], v[184:187], 0
    buffer_load_dwordx4 v224, s[4:7], s45 offen lds
    buffer_load_dwordx4 v225, s[72:75], s45 offen offset:1024 lds
    v_permlane32_swap_b32 v234, v235
    v_permlane32_swap_b32 v236, v237
    v_mfma_f32_32x32x16_bf16 v[32:47], v[64:67], v[188:191], 0
    v_permlane32_swap_b32 v238, v239
    v_permlane32_swap_b32 v240, v241
    v_add_f32 v234, v234, v235
    v_add_f32 v236, v236, v237
    v_add_f32 v238, v238, v239
    v_mfma_f32_32x32x16_bf16 v[48:63], v[68:71], v[188:191], 0
    s_setprio 0
    v_add_f32 v240, v240, v241
    s_set_gpr_idx_on s31, gpr_idx(DST)
    s_nop 0
    v_cvt_pk_bf16_f32 v192, v234, v236
    v_cvt_pk_bf16_f32 v193, v238, v240
    s_set_gpr_idx_off
    v_mul_f32 v234, v0, v144
    v_mul_f32 v236, v8, v112
    v_fmac_f32 v234, v1, v145
    v_fmac_f32 v236, v9, v113
    v_fmac_f32 v234, v2, v146
    v_fmac_f32 v236, v10, v114
    v_fmac_f32 v234, v3, v147
    v_fmac_f32 v236, v11, v115
    v_fmac_f32 v234, v4, v148
    v_fmac_f32 v236, v12, v116
    v_fmac_f32 v234, v5, v149
    v_fmac_f32 v236, v13, v117
    v_fmac_f32 v234, v6, v150
    v_fmac_f32 v236, v14, v118
    v_fmac_f32 v234, v7, v151
    v_fmac_f32 v236, v15, v119
    v_mul_f32 v238, v16, v160
    v_mul_f32 v240, v24, v160
    v_fmac_f32 v238, v17, v161
    v_fmac_f32 v240, v25, v161
    v_fmac_f32 v238, v18, v162
    v_fmac_f32 v240, v26, v162
    v_fmac_f32 v238, v19, v163
    v_fmac_f32 v240, v27, v163
    v_fmac_f32 v238, v20, v164
    v_fmac_f32 v240, v28, v164
    v_fmac_f32 v238, v21, v165
    v_fmac_f32 v240, v29, v165
    v_fmac_f32 v238, v22, v166
    v_fmac_f32 v240, v30, v166
    v_fmac_f32 v238, v23, v167
    v_fmac_f32 v240, v31, v167
    v_mul_f32 v235, v32, v152
    v_mul_f32 v237, v40, v120
    v_fmac_f32 v235, v33, v153
    v_fmac_f32 v237, v41, v121
    v_fmac_f32 v235, v34, v154
    v_fmac_f32 v237, v42, v122
    v_fmac_f32 v235, v35, v155
    v_fmac_f32 v237, v43, v123
    v_fmac_f32 v235, v36, v156
    v_fmac_f32 v237, v44, v124
    v_fmac_f32 v235, v37, v157
    v_fmac_f32 v237, v45, v125
    v_fmac_f32 v235, v38, v158
    v_fmac_f32 v237, v46, v126
    v_fmac_f32 v235, v39, v159
    v_fmac_f32 v237, v47, v127
    v_mul_f32 v239, v48, v168
    v_mul_f32 v241, v56, v168
    v_fmac_f32 v239, v49, v169
    v_fmac_f32 v241, v57, v169
    v_fmac_f32 v239, v50, v170
    v_fmac_f32 v241, v58, v170
    v_fmac_f32 v239, v51, v171
    v_fmac_f32 v241, v59, v171
    v_fmac_f32 v239, v52, v172
    v_fmac_f32 v241, v60, v172
    v_fmac_f32 v239, v53, v173
    v_fmac_f32 v241, v61, v173
    v_fmac_f32 v239, v54, v174
    v_fmac_f32 v241, v62, v174
    v_fmac_f32 v239, v55, v175
    v_fmac_f32 v241, v63, v175
    s_setprio 1
    s_waitcnt vmcnt(7) lgkmcnt(0)
    v_mfma_f32_32x32x16_bf16 v[0:15], v[64:67], v[176:179], 0
    ds_read_b64_tr_b16 v[184:185], v246 offset:6144
    ds_read_b64_tr_b16 v[186:187], v246 offset:6656
    ds_read_b64_tr_b16 v[188:189], v247 offset:6144
    ds_read_b64_tr_b16 v[190:191], v247 offset:6656
    s_mov_b32 m0, s70
    v_mfma_f32_32x32x16_bf16 v[16:31], v[68:71], v[176:179], 0
    buffer_load_dwordx4 v226, s[4:7], s46 offen lds
    buffer_load_dwordx4 v227, s[72:75], s46 offen offset:1024 lds
    v_permlane32_swap_b32 v234, v235
    v_add_f32 v234, v234, v235
    v_mfma_f32_32x32x16_bf16 v[32:47], v[64:67], v[180:183], 0
    v_mfma_f32_32x32x16_bf16 v[48:63], v[68:71], v[180:183], 0
    s_setprio 0
    v_mul_f32 v242, v0, v144
    v_fma_f32 v238, v8, v160, -v238
    v_fmac_f32 v242, v1, v145
    v_fmac_f32 v238, v9, v161
    v_fmac_f32 v242, v2, v146
    v_fmac_f32 v238, v10, v162
    v_fmac_f32 v242, v3, v147
    v_fmac_f32 v238, v11, v163
    v_fmac_f32 v242, v4, v148
    v_fmac_f32 v238, v12, v164
    v_fmac_f32 v242, v5, v149
    v_fmac_f32 v238, v13, v165
    v_fmac_f32 v242, v6, v150
    v_fmac_f32 v238, v14, v166
    v_fmac_f32 v242, v7, v151
    v_fmac_f32 v238, v15, v167
    v_fmac_f32 v236, v16, v112
    v_mul_f32 v244, v24, v160
    v_fmac_f32 v236, v17, v113
    v_fmac_f32 v244, v25, v161
    v_fmac_f32 v236, v18, v114
    v_fmac_f32 v244, v26, v162
    v_fmac_f32 v236, v19, v115
    v_fmac_f32 v244, v27, v163
    v_fmac_f32 v236, v20, v116
    v_fmac_f32 v244, v28, v164
    v_fmac_f32 v236, v21, v117
    v_fmac_f32 v244, v29, v165
    v_fmac_f32 v236, v22, v118
    v_fmac_f32 v244, v30, v166
    v_fmac_f32 v236, v23, v119
    v_fmac_f32 v244, v31, v167
    v_mul_f32 v243, v32, v152
    v_fma_f32 v239, v40, v168, -v239
    v_fmac_f32 v243, v33, v153
    v_fmac_f32 v239, v41, v169
    v_fmac_f32 v243, v34, v154
    v_fmac_f32 v239, v42, v170
    v_fmac_f32 v243, v35, v155
    v_fmac_f32 v239, v43, v171
    v_fmac_f32 v243, v36, v156
    v_fmac_f32 v239, v44, v172
    v_fmac_f32 v243, v37, v157
    v_fmac_f32 v239, v45, v173
    v_fmac_f32 v243, v38, v158
    v_fmac_f32 v239, v46, v174
    v_fmac_f32 v243, v39, v159
    v_fmac_f32 v239, v47, v175
    v_fmac_f32 v237, v48, v120
    v_mul_f32 v245, v56, v168
    v_fmac_f32 v237, v49, v121
    v_fmac_f32 v245, v57, v169
    v_fmac_f32 v237, v50, v122
    v_fmac_f32 v245, v58, v170
    v_fmac_f32 v237, v51, v123
    v_fmac_f32 v245, v59, v171
    v_fmac_f32 v237, v52, v124
    v_fmac_f32 v245, v60, v172
    v_fmac_f32 v237, v53, v125
    v_fmac_f32 v245, v61, v173
    v_fmac_f32 v237, v54, v126
    v_fmac_f32 v245, v62, v174
    v_fmac_f32 v237, v55, v127
    v_fmac_f32 v245, v63, v175
    s_setprio 1
    s_waitcnt vmcnt(4) lgkmcnt(0)
    v_mfma_f32_32x32x16_bf16 v[0:15], v[64:67], v[184:187], 0
    ds_read_b64_tr_b16 v[176:177], v246 offset:0
    ds_read_b64_tr_b16 v[178:179], v246 offset:512
    ds_read_b64_tr_b16 v[180:181], v247 offset:0
    ds_read_b64_tr_b16 v[182:183], v247 offset:512
    s_mov_b32 m0, s71
    v_mfma_f32_32x32x16_bf16 v[16:31], v[68:71], v[184:187], 0
    buffer_load_dwordx4 v228, s[4:7], s47 offen lds
    buffer_load_dwordx4 v229, s[72:75], s47 offen offset:1024 lds
    v_permlane32_swap_b32 v238, v239
    v_permlane32_swap_b32 v242, v243
    v_add_f32 v238, v238, v239
    v_mfma_f32_32x32x16_bf16 v[32:47], v[64:67], v[188:191], 0
    v_add_f32 v242, v242, v243
    s_set_gpr_idx_on s31, gpr_idx(DST)
    s_nop 0
    v_cvt_pk_bf16_f32 v194, v234, v242
    s_set_gpr_idx_off
    v_mfma_f32_32x32x16_bf16 v[48:63], v[68:71], v[188:191], 0
    s_setprio 0
    v_mul_f32 v242, v0, v144
    v_fma_f32 v240, v8, v160, -v240
    v_fmac_f32 v242, v1, v145
    v_fmac_f32 v240, v9, v161
    v_fmac_f32 v242, v2, v146
    v_fmac_f32 v240, v10, v162
    v_fmac_f32 v242, v3, v147
    v_fmac_f32 v240, v11, v163
    v_fmac_f32 v242, v4, v148
    v_fmac_f32 v240, v12, v164
    v_fmac_f32 v242, v5, v149
    v_fmac_f32 v240, v13, v165
    v_fmac_f32 v242, v6, v150
    v_fmac_f32 v240, v14, v166
    v_fmac_f32 v242, v7, v151
    v_fmac_f32 v240, v15, v167
    s_sub_u32 s58, s48, s29
    v_add_u32 v249, s58, v249
    v_add_u32 v250, s58, v250
    v_fma_f32 v244, v16, v160, -v244
    v_fmac_f32 v236, v24, v112
    v_fmac_f32 v244, v17, v161
    v_fmac_f32 v236, v25, v113
    v_fmac_f32 v244, v18, v162
    v_fmac_f32 v236, v26, v114
    v_fmac_f32 v244, v19, v163
    v_fmac_f32 v236, v27, v115
    v_fmac_f32 v244, v20, v164
    v_fmac_f32 v236, v28, v116
    v_fmac_f32 v244, v21, v165
    v_fmac_f32 v236, v29, v117
    v_fmac_f32 v244, v22, v166
    v_fmac_f32 v236, v30, v118
    v_fmac_f32 v244, v23, v167
    v_fmac_f32 v236, v31, v119
    ds_read_b64_tr_b16 v[0:1], v249 offset:0
    ds_read_b64_tr_b16 v[2:3], v249 offset:128
    ds_read_b128 v[4:7], v250 offset:0
    ds_read_b128 v[8:11], v250 offset:16
    ds_read_b128 v[12:15], v250 offset:128
    ds_read_b128 v[16:19], v250 offset:144
    v_mul_f32 v243, v32, v152
    v_fma_f32 v241, v40, v168, -v241
    v_fmac_f32 v243, v33, v153
    v_fmac_f32 v241, v41, v169
    v_fmac_f32 v243, v34, v154
    v_fmac_f32 v241, v42, v170
    v_fmac_f32 v243, v35, v155
    v_fmac_f32 v241, v43, v171
    v_fmac_f32 v243, v36, v156
    v_fmac_f32 v241, v44, v172
    v_fmac_f32 v243, v37, v157
    v_fmac_f32 v241, v45, v173
    v_fmac_f32 v243, v38, v158
    v_fmac_f32 v241, v46, v174
    v_fmac_f32 v243, v39, v159
    v_fmac_f32 v241, v47, v175
    ds_read_b64_tr_b16 v[20:21], v249 offset:800
    ds_read_b64_tr_b16 v[22:23], v249 offset:928
    ds_read_b128 v[24:27], v250 offset:800
    ds_read_b128 v[28:31], v250 offset:816
    ds_read_b128 v[32:35], v250 offset:928
    ds_read_b128 v[36:39], v250 offset:944
    v_fma_f32 v245, v48, v168, -v245
    v_fmac_f32 v237, v56, v120
    v_fmac_f32 v245, v49, v169
    v_fmac_f32 v237, v57, v121
    v_fmac_f32 v245, v50, v170
    v_fmac_f32 v237, v58, v122
    v_fmac_f32 v245, v51, v171
    v_fmac_f32 v237, v59, v123
    v_fmac_f32 v245, v52, v172
    v_fmac_f32 v237, v60, v124
    v_fmac_f32 v245, v53, v173
    v_fmac_f32 v237, v61, v125
    v_fmac_f32 v245, v54, v174
    v_fmac_f32 v237, v62, v126
    v_fmac_f32 v245, v55, v175
    v_fmac_f32 v237, v63, v127
    s_cmp_lg_u32 s34, 0
    s_cbranch_scc1 K2_SWITCH
    s_mov_b32 s29, s48
    s_mov_b32 s32, s31
    s_mov_b32 s31, s35
    s_cmp_eq_u32 s33, 2
    s_cbranch_scc1 K2_U20
    s_cmp_eq_u32 s33, 3
    s_cbranch_scc1 K2_U30
    s_cmp_eq_u32 s33, 1
    s_cbranch_scc1 K2_U10
    s_branch K2_U40
K2_U40:
    s_setprio 1
    s_waitcnt lgkmcnt(10)
    v_lshlrev_b32 v40, 16, v0
    v_and_b32 v41, 0xffff0000, v0
    v_lshlrev_b32 v42, 16, v1
    v_and_b32 v43, 0xffff0000, v1
    v_lshlrev_b32 v44, 16, v2
    v_and_b32 v45, 0xffff0000, v2
    v_lshlrev_b32 v46, 16, v3
    v_and_b32 v47, 0xffff0000, v3
    s_waitcnt lgkmcnt(8)
    v_mul_f32 v4, v40, v4
    v_mul_f32 v5, v41, v5
    v_mul_f32 v6, v42, v6
    v_mul_f32 v7, v43, v7
    v_mul_f32 v8, v44, v8
    v_mul_f32 v9, v45, v9
    v_mul_f32 v10, v46, v10
    v_mul_f32 v11, v47, v11
    v_cvt_pk_bf16_f32 v64, v4, v5
    v_cvt_pk_bf16_f32 v65, v6, v7
    v_cvt_pk_bf16_f32 v66, v8, v9
    v_cvt_pk_bf16_f32 v67, v10, v11
    s_waitcnt lgkmcnt(6)
    v_mul_f32 v12, v40, v12
    v_mul_f32 v13, v41, v13
    v_mul_f32 v14, v42, v14
    v_mul_f32 v15, v43, v15
    v_mul_f32 v16, v44, v16
    v_mul_f32 v17, v45, v17
    v_mul_f32 v18, v46, v18
    v_mul_f32 v19, v47, v19
    v_cvt_pk_bf16_f32 v68, v12, v13
    v_cvt_pk_bf16_f32 v69, v14, v15
    v_cvt_pk_bf16_f32 v70, v16, v17
    v_cvt_pk_bf16_f32 v71, v18, v19
    ds_read_b64_tr_b16 v[0:1], v249 offset:1600
    ds_read_b64_tr_b16 v[2:3], v249 offset:1728
    ds_read_b128 v[4:7], v250 offset:1600
    ds_read_b128 v[8:11], v250 offset:1616
    ds_read_b128 v[12:15], v250 offset:1728
    ds_read_b128 v[16:19], v250 offset:1744
    s_waitcnt lgkmcnt(10)
    v_lshlrev_b32 v48, 16, v20
    v_and_b32 v49, 0xffff0000, v20
    v_lshlrev_b32 v50, 16, v21
    v_and_b32 v51, 0xffff0000, v21
    v_lshlrev_b32 v52, 16, v22
    v_and_b32 v53, 0xffff0000, v22
    v_lshlrev_b32 v54, 16, v23
    v_and_b32 v55, 0xffff0000, v23
    s_waitcnt lgkmcnt(8)
    v_mul_f32 v24, v48, v24
    v_mul_f32 v25, v49, v25
    v_mul_f32 v26, v50, v26
    v_mul_f32 v27, v51, v27
    v_mul_f32 v28, v52, v28
    v_mul_f32 v29, v53, v29
    v_mul_f32 v30, v54, v30
    v_mul_f32 v31, v55, v31
    v_cvt_pk_bf16_f32 v72, v24, v25
    v_cvt_pk_bf16_f32 v73, v26, v27
    v_cvt_pk_bf16_f32 v74, v28, v29
    v_cvt_pk_bf16_f32 v75, v30, v31
    s_waitcnt lgkmcnt(6)
    v_mul_f32 v32, v48, v32
    v_mul_f32 v33, v49, v33
    v_mul_f32 v34, v50, v34
    v_mul_f32 v35, v51, v35
    v_mul_f32 v36, v52, v36
    v_mul_f32 v37, v53, v37
    v_mul_f32 v38, v54, v38
    v_mul_f32 v39, v55, v39
    v_cvt_pk_bf16_f32 v76, v32, v33
    v_cvt_pk_bf16_f32 v77, v34, v35
    v_cvt_pk_bf16_f32 v78, v36, v37
    v_cvt_pk_bf16_f32 v79, v38, v39
    ds_read_b64_tr_b16 v[20:21], v249 offset:2400
    ds_read_b64_tr_b16 v[22:23], v249 offset:2528
    ds_read_b128 v[24:27], v250 offset:2400
    ds_read_b128 v[28:31], v250 offset:2416
    ds_read_b128 v[32:35], v250 offset:2528
    ds_read_b128 v[36:39], v250 offset:2544
    s_waitcnt lgkmcnt(10)
    v_lshlrev_b32 v40, 16, v0
    v_and_b32 v41, 0xffff0000, v0
    v_lshlrev_b32 v42, 16, v1
    v_and_b32 v43, 0xffff0000, v1
    v_lshlrev_b32 v44, 16, v2
    v_and_b32 v45, 0xffff0000, v2
    v_lshlrev_b32 v46, 16, v3
    v_and_b32 v47, 0xffff0000, v3
    s_waitcnt lgkmcnt(8)
    v_mul_f32 v4, v40, v4
    v_mul_f32 v5, v41, v5
    v_mul_f32 v6, v42, v6
    v_mul_f32 v7, v43, v7
    v_mul_f32 v8, v44, v8
    v_mul_f32 v9, v45, v9
    v_mul_f32 v10, v46, v10
    v_mul_f32 v11, v47, v11
    v_cvt_pk_bf16_f32 v80, v4, v5
    v_cvt_pk_bf16_f32 v81, v6, v7
    v_cvt_pk_bf16_f32 v82, v8, v9
    v_cvt_pk_bf16_f32 v83, v10, v11
    s_waitcnt lgkmcnt(6)
    v_mul_f32 v12, v40, v12
    v_mul_f32 v13, v41, v13
    v_mul_f32 v14, v42, v14
    v_mul_f32 v15, v43, v15
    v_mul_f32 v16, v44, v16
    v_mul_f32 v17, v45, v17
    v_mul_f32 v18, v46, v18
    v_mul_f32 v19, v47, v19
    v_cvt_pk_bf16_f32 v84, v12, v13
    v_cvt_pk_bf16_f32 v85, v14, v15
    v_cvt_pk_bf16_f32 v86, v16, v17
    v_cvt_pk_bf16_f32 v87, v18, v19
    s_waitcnt lgkmcnt(4)
    v_lshlrev_b32 v48, 16, v20
    v_and_b32 v49, 0xffff0000, v20
    v_lshlrev_b32 v50, 16, v21
    v_and_b32 v51, 0xffff0000, v21
    v_lshlrev_b32 v52, 16, v22
    v_and_b32 v53, 0xffff0000, v22
    v_lshlrev_b32 v54, 16, v23
    v_and_b32 v55, 0xffff0000, v23
    s_waitcnt lgkmcnt(2)
    v_mul_f32 v24, v48, v24
    v_mul_f32 v25, v49, v25
    v_mul_f32 v26, v50, v26
    v_mul_f32 v27, v51, v27
    v_mul_f32 v28, v52, v28
    v_mul_f32 v29, v53, v29
    v_mul_f32 v30, v54, v30
    v_mul_f32 v31, v55, v31
    v_cvt_pk_bf16_f32 v88, v24, v25
    v_cvt_pk_bf16_f32 v89, v26, v27
    v_cvt_pk_bf16_f32 v90, v28, v29
    v_cvt_pk_bf16_f32 v91, v30, v31
    s_waitcnt lgkmcnt(0)
    v_mul_f32 v32, v48, v32
    v_mul_f32 v33, v49, v33
    v_mul_f32 v34, v50, v34
    v_mul_f32 v35, v51, v35
    v_mul_f32 v36, v52, v36
    v_mul_f32 v37, v53, v37
    v_mul_f32 v38, v54, v38
    v_mul_f32 v39, v55, v39
    v_cvt_pk_bf16_f32 v92, v32, v33
    v_cvt_pk_bf16_f32 v93, v34, v35
    v_cvt_pk_bf16_f32 v94, v36, v37
    v_cvt_pk_bf16_f32 v95, v38, v39
    s_waitcnt vmcnt(4)
    v_mfma_f32_32x32x16_bf16 v[0:15], v[64:67], v[176:179], 0
    ds_read_b64_tr_b16 v[184:185], v246 offset:2048
    ds_read_b64_tr_b16 v[186:187], v246 offset:2560
    ds_read_b64_tr_b16 v[188:189], v247 offset:2048
    ds_read_b64_tr_b16 v[190:191], v247 offset:2560
    s_mov_b32 m0, s68
    v_mfma_f32_32x32x16_bf16 v[16:31], v[68:71], v[176:179], 0
    buffer_load_dwordx4 v222, s[4:7], s41 offen lds
    buffer_load_dwordx4 v223, s[72:75], s41 offen offset:1024 lds
    v_permlane32_swap_b32 v242, v243
    v_permlane32_swap_b32 v240, v241
    s_add_u32 s38, s38, 1
    v_mfma_f32_32x32x16_bf16 v[32:47], v[64:67], v[180:183], 0
    v_permlane32_swap_b32 v236, v237
    v_permlane32_swap_b32 v244, v245
    v_add_f32 v242, v242, v243
    v_add_f32 v240, -v240, -v241
    v_add_f32 v236, v236, v237
    v_mfma_f32_32x32x16_bf16 v[48:63], v[68:71], v[180:183], 0
    v_add_f32 v244, v244, v245
    s_set_gpr_idx_on s32, gpr_idx(DST)
    s_nop 0
    v_cvt_pk_bf16_f32 v195, v242, v236
    v_cvt_pk_bf16_f32 v196, v244, v240
    v_cvt_pk_bf16_f32 v197, v238, v238
    s_set_gpr_idx_off
    s_waitcnt vmcnt(4) lgkmcnt(0)
    v_mfma_f32_32x32x16_bf16 v[0:15], v[72:75], v[184:187], v[0:15]
    ds_read_b64_tr_b16 v[176:177], v246 offset:4096
    ds_read_b64_tr_b16 v[178:179], v246 offset:4608
    ds_read_b64_tr_b16 v[180:181], v247 offset:4096
    ds_read_b64_tr_b16 v[182:183], v247 offset:4608
    v_mov_b32 v254, s52
    v_mov_b32 v255, s38
    s_mov_b32 m0, s69
    v_mfma_f32_32x32x16_bf16 v[16:31], v[76:79], v[184:187], v[16:31]
    buffer_load_dwordx4 v224, s[4:7], s41 offen lds
    buffer_load_dwordx4 v225, s[72:75], s41 offen offset:1024 lds
    s_lshl_b32 s58, s38, 3
    s_add_u32 s58, s58, s20
    s_mov_b64 exec, 1
    ds_write_b32 v254, v255
    s_mov_b64 exec, -1
    s_cmp_lt_u32 s58, s22
    s_cbranch_scc0 K2_dyn_71
K2_back_72:
    v_readlane_b32 s59, v253, s58
    s_lshl_b32 s44, s34, 7
    s_and_b32 s48, s59, 0x3ffff
    s_bfe_u32 s33, s59, 0x30012
    s_lshr_b32 s60, s59, 21
    s_add_u32 s60, s60, s48
    s_mul_i32 s35, s38, 6
    s_cmp_eq_u32 s34, 0
    s_cselect_b32 s35, s35, s60
    s_mov_b32 s45, s44
    s_add_u32 s47, s44, 256
    s_add_u32 s49, s48, 800
    s_add_u32 s60, s48, 1600
    s_cmp_eq_u32 s33, 3
    s_cselect_b32 s46, s44, s47
    s_cselect_b32 s50, s60, s48
    s_cselect_b32 s51, s48, s49
    s_sub_u32 s60, s33, 2
    s_cmp_lt_u32 s60, 2
    s_cbranch_scc0 K2_rare_77
K2_back_78:
    v_mfma_f32_32x32x16_bf16 v[32:47], v[72:75], v[188:191], v[32:47]
    v_add_u32 v232, s48, v230
    v_add_u32 v233, s50, v230
    ds_read_b32 v232, v232
    ds_read_b32 v233, v233
    v_mfma_f32_32x32x16_bf16 v[48:63], v[76:79], v[188:191], v[48:63]
    s_waitcnt vmcnt(4) lgkmcnt(3)
    v_mfma_f32_32x32x16_bf16 v[0:15], v[80:83], v[176:179], v[0:15]
    ds_read_b64_tr_b16 v[184:185], v246 offset:6144
    ds_read_b64_tr_b16 v[186:187], v246 offset:6656
    ds_read_b64_tr_b16 v[188:189], v247 offset:6144
    ds_read_b64_tr_b16 v[190:191], v247 offset:6656
    s_mov_b32 m0, s70
    v_mfma_f32_32x32x16_bf16 v[16:31], v[84:87], v[176:179], v[16:31]
    buffer_load_dwordx4 v226, s[4:7], s41 offen lds
    buffer_load_dwordx4 v227, s[72:75], s41 offen offset:1024 lds
    v_mfma_f32_32x32x16_bf16 v[32:47], v[80:83], v[180:183], v[32:47]
    v_mfma_f32_32x32x16_bf16 v[48:63], v[84:87], v[180:183], v[48:63]
    s_waitcnt lgkmcnt(4)
    v_or_b32 v232, v232, v231
    v_or_b32 v233, v233, v231
    s_cmp_lg_u32 s34, 0
    s_cbranch_scc1 K2_dum_80
    s_mov_b32 m0, s48
    s_mov_b32 exec_hi, 0
    buffer_load_dwordx4 v232, s[16:19], 0 offen  lds
    s_mov_b32 m0, s50
    s_add_u32 s65, s48, 288
    buffer_load_dwordx4 v233, s[16:19], 0 offen  lds
    s_not_b64 exec, exec
    s_mov_b32 m0, s65
    s_cmp_eq_u32 s33, 4
    buffer_load_dwordx4 v232, s[16:19], 0 offen  lds
    s_cbranch_scc1 K2_a4_81
K2_b4_83:
    s_mov_b32 exec_lo, -1
K2_back_82:
    s_waitcnt vmcnt(7) lgkmcnt(0)
    v_mfma_f32_32x32x16_bf16 v[0:15], v[88:91], v[184:187], v[0:15]
    ds_read_b64_tr_b16 v[176:177], v246 offset:0
    ds_read_b64_tr_b16 v[178:179], v246 offset:512
    ds_read_b64_tr_b16 v[180:181], v247 offset:0
    ds_read_b64_tr_b16 v[182:183], v247 offset:512
    s_mov_b32 m0, s71
    v_mfma_f32_32x32x16_bf16 v[16:31], v[92:95], v[184:187], v[16:31]
    buffer_load_dwordx4 v228, s[4:7], s41 offen lds
    buffer_load_dwordx4 v229, s[72:75], s41 offen offset:1024 lds
    v_mfma_f32_32x32x16_bf16 v[32:47], v[88:91], v[188:191], v[32:47]
    s_nop 2
    v_mul_f32 v234, v0, v96
    v_mul_f32 v236, v8, v128
    v_fmac_f32 v234, v1, v97
    v_fmac_f32 v236, v9, v129
    v_fmac_f32 v234, v2, v98
    v_fmac_f32 v236, v10, v130
    v_fmac_f32 v234, v3, v99
    v_mfma_f32_32x32x16_bf16 v[48:63], v[92:95], v[188:191], v[48:63]
    s_setprio 0
    v_fmac_f32 v236, v11, v131
    v_fmac_f32 v234, v4, v100
    v_fmac_f32 v236, v12, v132
    v_fmac_f32 v234, v5, v101
    v_fmac_f32 v236, v13, v133
    v_fmac_f32 v234, v6, v102
    v_fmac_f32 v236, v14, v134
    v_fmac_f32 v234, v7, v103
    v_fmac_f32 v236, v15, v135
    v_mul_f32 v238, v16, v128
    v_mul_f32 v240, v24, v128
    v_fmac_f32 v238, v17, v129
    v_fmac_f32 v240, v25, v129
    v_fmac_f32 v238, v18, v130
    v_fmac_f32 v240, v26, v130
    v_fmac_f32 v238, v19, v131
    v_fmac_f32 v240, v27, v131
    v_fmac_f32 v238, v20, v132
    v_fmac_f32 v240, v28, v132
    v_fmac_f32 v238, v21, v133
    v_fmac_f32 v240, v29, v133
    v_fmac_f32 v238, v22, v134
    v_fmac_f32 v240, v30, v134
    v_fmac_f32 v238, v23, v135
    v_fmac_f32 v240, v31, v135
    v_mul_f32 v235, v32, v104
    v_mul_f32 v237, v40, v136
    v_fmac_f32 v235, v33, v105
    v_fmac_f32 v237, v41, v137
    v_fmac_f32 v235, v34, v106
    v_fmac_f32 v237, v42, v138
    v_fmac_f32 v235, v35, v107
    v_fmac_f32 v237, v43, v139
    v_fmac_f32 v235, v36, v108
    v_fmac_f32 v237, v44, v140
    v_fmac_f32 v235, v37, v109
    v_fmac_f32 v237, v45, v141
    v_fmac_f32 v235, v38, v110
    v_fmac_f32 v237, v46, v142
    v_fmac_f32 v235, v39, v111
    v_fmac_f32 v237, v47, v143
    v_mul_f32 v239, v48, v136
    v_mul_f32 v241, v56, v136
    s_setprio 1
    s_waitcnt vmcnt(7) lgkmcnt(0)
    v_mfma_f32_32x32x16_bf16 v[0:15], v[64:67], v[176:179], 0
    ds_read_b64_tr_b16 v[184:185], v246 offset:2048
    ds_read_b64_tr_b16 v[186:187], v246 offset:2560
    ds_read_b64_tr_b16 v[188:189], v247 offset:2048
    ds_read_b64_tr_b16 v[190:191], v247 offset:2560
    v_fmac_f32 v239, v49, v137
    v_fmac_f32 v241, v57, v137
    s_mov_b32 m0, s68
    v_mfma_f32_32x32x16_bf16 v[16:31], v[68:71], v[176:179], 0
    buffer_load_dwordx4 v222, s[4:7], s42 offen lds
    buffer_load_dwordx4 v223, s[72:75], s42 offen offset:1024 lds
    v_fmac_f32 v239, v50, v138
    v_fmac_f32 v241, v58, v138
    v_fmac_f32 v239, v51, v139
    v_fmac_f32 v241, v59, v139
    v_fmac_f32 v239, v52, v140
    v_mfma_f32_32x32x16_bf16 v[32:47], v[64:67], v[180:183], 0
    v_fmac_f32 v241, v60, v140
    v_fmac_f32 v239, v53, v141
    v_fmac_f32 v241, v61, v141
    v_fmac_f32 v239, v54, v142
    v_fmac_f32 v241, v62, v142
    v_fmac_f32 v239, v55, v143
    v_fmac_f32 v241, v63, v143
    v_mfma_f32_32x32x16_bf16 v[48:63], v[68:71], v[180:183], 0
    v_permlane32_swap_b32 v234, v235
    v_permlane32_swap_b32 v236, v237
    v_permlane32_swap_b32 v238, v239
    s_waitcnt vmcnt(7) lgkmcnt(0)
    v_mfma_f32_32x32x16_bf16 v[0:15], v[72:75], v[184:187], v[0:15]
    ds_read_b64_tr_b16 v[176:177], v246 offset:4096
    ds_read_b64_tr_b16 v[178:179], v246 offset:4608
    ds_read_b64_tr_b16 v[180:181], v247 offset:4096
    ds_read_b64_tr_b16 v[182:183], v247 offset:4608
    v_permlane32_swap_b32 v240, v241
    s_mov_b32 m0, s69
    v_mfma_f32_32x32x16_bf16 v[16:31], v[76:79], v[184:187], v[16:31]
    buffer_load_dwordx4 v224, s[4:7], s42 offen lds
    buffer_load_dwordx4 v225, s[72:75], s42 offen offset:1024 lds
    v_add_f32 v234, v234, v235
    v_add_f32 v236, v236, v237
    v_add_f32 v238, v238, v239
    v_add_f32 v240, v240, v241
    v_mfma_f32_32x32x16_bf16 v[32:47], v[72:75], v[188:191], v[32:47]
    s_set_gpr_idx_on s31, gpr_idx(DST)
    s_nop 0
    v_cvt_pk_bf16_f32 v192, v234, v236
    v_cvt_pk_bf16_f32 v193, v238, v240
    s_set_gpr_idx_off
    v_mfma_f32_32x32x16_bf16 v[48:63], v[76:79], v[188:191], v[48:63]
    s_waitcnt vmcnt(4) lgkmcnt(0)
    v_mfma_f32_32x32x16_bf16 v[0:15], v[80:83], v[176:179], v[0:15]
    ds_read_b64_tr_b16 v[184:185], v246 offset:6144
    ds_read_b64_tr_b16 v[186:187], v246 offset:6656
    ds_read_b64_tr_b16 v[188:189], v247 offset:6144
    ds_read_b64_tr_b16 v[190:191], v247 offset:6656
    s_mov_b32 m0, s70
    v_mfma_f32_32x32x16_bf16 v[16:31], v[84:87], v[176:179], v[16:31]
    buffer_load_dwordx4 v226, s[4:7], s42 offen lds
    buffer_load_dwordx4 v227, s[72:75], s42 offen offset:1024 lds
    v_mfma_f32_32x32x16_bf16 v[32:47], v[80:83], v[180:183], v[32:47]
    v_mfma_f32_32x32x16_bf16 v[48:63], v[84:87], v[180:183], v[48:63]
    s_waitcnt vmcnt(4) lgkmcnt(0)
    v_mfma_f32_32x32x16_bf16 v[0:15], v[88:91], v[184:187], v[0:15]
    ds_read_b64_tr_b16 v[176:177], v246 offset:0
    ds_read_b64_tr_b16 v[178:179], v246 offset:512
    ds_read_b64_tr_b16 v[180:181], v247 offset:0
    ds_read_b64_tr_b16 v[182:183], v247 offset:512
    s_mov_b32 m0, s71
    v_mfma_f32_32x32x16_bf16 v[16:31], v[92:95], v[184:187], v[16:31]
    buffer_load_dwordx4 v228, s[4:7], s42 offen lds
    buffer_load_dwordx4 v229, s[72:75], s42 offen offset:1024 lds
    v_mfma_f32_32x32x16_bf16 v[32:47], v[88:91], v[188:191], v[32:47]
    s_nop 2
    v_mul_f32 v234, v0, v144
    v_mul_f32 v236, v8, v112
    v_fmac_f32 v234, v1, v145
    v_fmac_f32 v236, v9, v113
    v_fmac_f32 v234, v2, v146
    v_fmac_f32 v236, v10, v114
    v_fmac_f32 v234, v3, v147
    v_mfma_f32_32x32x16_bf16 v[48:63], v[92:95], v[188:191], v[48:63]
    s_setprio 0
    v_fmac_f32 v236, v11, v115
    v_fmac_f32 v234, v4, v148
    v_fmac_f32 v236, v12, v116
    v_fmac_f32 v234, v5, v149
    v_fmac_f32 v236, v13, v117
    v_fmac_f32 v234, v6, v150
    v_fmac_f32 v236, v14, v118
    v_fmac_f32 v234, v7, v151
    v_fmac_f32 v236, v15, v119
    v_mul_f32 v238, v16, v160
    v_mul_f32 v240, v24, v160
    v_fmac_f32 v238, v17, v161
    v_fmac_f32 v240, v25, v161
    v_fmac_f32 v238, v18, v162
    v_fmac_f32 v240, v26, v162
    v_fmac_f32 v238, v19, v163
    v_fmac_f32 v240, v27, v163
    v_fmac_f32 v238, v20, v164
    v_fmac_f32 v240, v28, v164
    v_fmac_f32 v238, v21, v165
    v_fmac_f32 v240, v29, v165
    v_fmac_f32 v238, v22, v166
    v_fmac_f32 v240, v30, v166
    v_fmac_f32 v238, v23, v167
    v_fmac_f32 v240, v31, v167
    v_mul_f32 v235, v32, v152
    v_mul_f32 v237, v40, v120
    v_fmac_f32 v235, v33, v153
    v_fmac_f32 v237, v41, v121
    v_fmac_f32 v235, v34, v154
    v_fmac_f32 v237, v42, v122
    v_fmac_f32 v235, v35, v155
    v_fmac_f32 v237, v43, v123
    v_fmac_f32 v235, v36, v156
    v_fmac_f32 v237, v44, v124
    v_fmac_f32 v235, v37, v157
    v_fmac_f32 v237, v45, v125
    v_fmac_f32 v235, v38, v158
    v_fmac_f32 v237, v46, v126
    v_fmac_f32 v235, v39, v159
    v_fmac_f32 v237, v47, v127
    v_mul_f32 v239, v48, v168
    v_mul_f32 v241, v56, v168
    s_setprio 1
    s_waitcnt vmcnt(4) lgkmcnt(0)
    v_mfma_f32_32x32x16_bf16 v[0:15], v[64:67], v[176:179], 0
    ds_read_b64_tr_b16 v[184:185], v246 offset:2048
    ds_read_b64_tr_b16 v[186:187], v246 offset:2560
    ds_read_b64_tr_b16 v[188:189], v247 offset:2048
    ds_read_b64_tr_b16 v[190:191], v247 offset:2560
    v_fmac_f32 v239, v49, v169
    v_fmac_f32 v241, v57, v169
    s_mov_b32 m0, s68
    v_mfma_f32_32x32x16_bf16 v[16:31], v[68:71], v[176:179], 0
    buffer_load_dwordx4 v222, s[4:7], s43 offen lds
    buffer_load_dwordx4 v223, s[72:75], s43 offen offset:1024 lds
    v_fmac_f32 v239, v50, v170
    v_fmac_f32 v241, v58, v170
    v_fmac_f32 v239, v51, v171
    v_fmac_f32 v241, v59, v171
    v_fmac_f32 v239, v52, v172
    v_mfma_f32_32x32x16_bf16 v[32:47], v[64:67], v[180:183], 0
    v_fmac_f32 v241, v60, v172
    v_fmac_f32 v239, v53, v173
    v_fmac_f32 v241, v61, v173
    v_fmac_f32 v239, v54, v174
    v_fmac_f32 v241, v62, v174
    v_fmac_f32 v239, v55, v175
    v_fmac_f32 v241, v63, v175
    v_mfma_f32_32x32x16_bf16 v[48:63], v[68:71], v[180:183], 0
    v_permlane32_swap_b32 v234, v235
    v_add_f32 v234, v234, v235
    s_waitcnt vmcnt(4) lgkmcnt(0)
    v_mfma_f32_32x32x16_bf16 v[0:15], v[72:75], v[184:187], v[0:15]
    ds_read_b64_tr_b16 v[176:177], v246 offset:4096
    ds_read_b64_tr_b16 v[178:179], v246 offset:4608
    ds_read_b64_tr_b16 v[180:181], v247 offset:4096
    ds_read_b64_tr_b16 v[182:183], v247 offset:4608
    s_mov_b32 m0, s69
    v_mfma_f32_32x32x16_bf16 v[16:31], v[76:79], v[184:187], v[16:31]
    buffer_load_dwordx4 v224, s[4:7], s43 offen lds
    buffer_load_dwordx4 v225, s[72:75], s43 offen offset:1024 lds
    v_mfma_f32_32x32x16_bf16 v[32:47], v[72:75], v[188:191], v[32:47]
    v_mfma_f32_32x32x16_bf16 v[48:63], v[76:79], v[188:191], v[48:63]
    s_waitcnt vmcnt(4) lgkmcnt(0)
    v_mfma_f32_32x32x16_bf16 v[0:15], v[80:83], v[176:179], v[0:15]
    ds_read_b64_tr_b16 v[184:185], v246 offset:6144
    ds_read_b64_tr_b16 v[186:187], v246 offset:6656
    ds_read_b64_tr_b16 v[188:189], v247 offset:6144
    ds_read_b64_tr_b16 v[190:191], v247 offset:6656
    s_mov_b32 m0, s70
    v_mfma_f32_32x32x16_bf16 v[16:31], v[84:87], v[176:179], v[16:31]
    buffer_load_dwordx4 v226, s[4:7], s43 offen lds
    buffer_load_dwordx4 v227, s[72:75], s43 offen offset:1024 lds
    v_mfma_f32_32x32x16_bf16 v[32:47], v[80:83], v[180:183], v[32:47]
    v_add_u32 v222, s48, v251
    ds_read_b32 v222, v222
    v_mfma_f32_32x32x16_bf16 v[48:63], v[84:87], v[180:183], v[48:63]
    s_waitcnt vmcnt(4) lgkmcnt(1)
    v_mfma_f32_32x32x16_bf16 v[0:15], v[88:91], v[184:187], v[0:15]
    ds_read_b64_tr_b16 v[176:177], v246 offset:0
    ds_read_b64_tr_b16 v[178:179], v246 offset:512
    ds_read_b64_tr_b16 v[180:181], v247 offset:0
    ds_read_b64_tr_b16 v[182:183], v247 offset:512
    s_mov_b32 m0, s71
    v_mfma_f32_32x32x16_bf16 v[16:31], v[92:95], v[184:187], v[16:31]
    buffer_load_dwordx4 v228, s[4:7], s43 offen lds
    buffer_load_dwordx4 v229, s[72:75], s43 offen offset:1024 lds
    s_waitcnt lgkmcnt(4)
    v_mad_u32_u16 v223, v222, s39, v248 op_sel:[1,0,0,0]
    v_mad_u32_u16 v222, v222, s39, v248
    v_mfma_f32_32x32x16_bf16 v[32:47], v[88:91], v[188:191], v[32:47]
    v_add_u32 v224, s49, v251
    ds_read_b32 v224, v224
    v_mul_f32 v242, v0, v144
    v_fma_f32 v238, v8, v160, -v238
    v_fmac_f32 v242, v1, v145
    v_fmac_f32 v238, v9, v161
    v_fmac_f32 v242, v2, v146
    v_mfma_f32_32x32x16_bf16 v[48:63], v[92:95], v[188:191], v[48:63]
    s_setprio 0
    v_fmac_f32 v238, v10, v162
    v_fmac_f32 v242, v3, v147
    v_fmac_f32 v238, v11, v163
    v_fmac_f32 v242, v4, v148
    v_fmac_f32 v238, v12, v164
    v_fmac_f32 v242, v5, v149
    v_fmac_f32 v238, v13, v165
    v_fmac_f32 v242, v6, v150
    v_fmac_f32 v238, v14, v166
    v_fmac_f32 v242, v7, v151
    v_fmac_f32 v238, v15, v167
    v_fmac_f32 v236, v16, v112
    v_mul_f32 v244, v24, v160
    v_fmac_f32 v236, v17, v113
    v_fmac_f32 v244, v25, v161
    v_fmac_f32 v236, v18, v114
    v_fmac_f32 v244, v26, v162
    v_fmac_f32 v236, v19, v115
    v_fmac_f32 v244, v27, v163
    v_fmac_f32 v236, v20, v116
    v_fmac_f32 v244, v28, v164
    v_fmac_f32 v236, v21, v117
    v_fmac_f32 v244, v29, v165
    v_fmac_f32 v236, v22, v118
    v_fmac_f32 v244, v30, v166
    v_fmac_f32 v236, v23, v119
    v_fmac_f32 v244, v31, v167
    v_mul_f32 v243, v32, v152
    v_fma_f32 v239, v40, v168, -v239
    v_fmac_f32 v243, v33, v153
    v_fmac_f32 v239, v41, v169
    v_fmac_f32 v243, v34, v154
    v_fmac_f32 v239, v42, v170
    v_fmac_f32 v243, v35, v155
    v_fmac_f32 v239, v43, v171
    v_fmac_f32 v243, v36, v156
    v_fmac_f32 v239, v44, v172
    v_fmac_f32 v243, v37, v157
    v_fmac_f32 v239, v45, v173
    v_fmac_f32 v243, v38, v158
    v_fmac_f32 v239, v46, v174
    v_fmac_f32 v243, v39, v159
    v_fmac_f32 v239, v47, v175
    v_fmac_f32 v237, v48, v120
    v_mul_f32 v245, v56, v168
    v_fmac_f32 v237, v49, v121
    v_fmac_f32 v245, v57, v169
    v_fmac_f32 v237, v50, v122
    v_fmac_f32 v245, v58, v170
    v_fmac_f32 v237, v51, v123
    s_setprio 1
    s_waitcnt vmcnt(4) lgkmcnt(1)
    v_mfma_f32_32x32x16_bf16 v[0:15], v[64:67], v[176:179], 0
    ds_read_b64_tr_b16 v[184:185], v246 offset:2048
    ds_read_b64_tr_b16 v[186:187], v246 offset:2560
    ds_read_b64_tr_b16 v[188:189], v247 offset:2048
    ds_read_b64_tr_b16 v[190:191], v247 offset:2560
    v_fmac_f32 v245, v59, v171
    v_fmac_f32 v237, v52, v124
    s_mov_b32 m0, s68
    v_mfma_f32_32x32x16_bf16 v[16:31], v[68:71], v[176:179], 0
    buffer_load_dwordx4 v222, s[4:7], s44 offen lds
    buffer_load_dwordx4 v223, s[72:75], s44 offen offset:1024 lds
    s_waitcnt lgkmcnt(4)
    v_mad_u32_u16 v225, v224, s39, v248 op_sel:[1,0,0,0]
    v_mad_u32_u16 v224, v224, s39, v248
    v_fmac_f32 v245, v60, v172
    v_fmac_f32 v237, v53, v125
    v_mfma_f32_32x32x16_bf16 v[32:47], v[64:67], v[180:183], 0
    v_add_u32 v226, s50, v251
    ds_read_b32 v226, v226
    v_fmac_f32 v245, v61, v173
    v_fmac_f32 v237, v54, v126
    v_fmac_f32 v245, v62, v174
    v_fmac_f32 v237, v55, v127
    v_fmac_f32 v245, v63, v175
    v_mfma_f32_32x32x16_bf16 v[48:63], v[68:71], v[180:183], 0
    v_permlane32_swap_b32 v238, v239
    v_permlane32_swap_b32 v242, v243
    v_add_f32 v238, v238, v239
    v_add_f32 v242, v242, v243
    s_waitcnt vmcnt(4) lgkmcnt(1)
    v_mfma_f32_32x32x16_bf16 v[0:15], v[72:75], v[184:187], v[0:15]
    ds_read_b64_tr_b16 v[176:177], v246 offset:4096
    ds_read_b64_tr_b16 v[178:179], v246 offset:4608
    ds_read_b64_tr_b16 v[180:181], v247 offset:4096
    ds_read_b64_tr_b16 v[182:183], v247 offset:4608
    s_mov_b32 m0, s69
    v_mfma_f32_32x32x16_bf16 v[16:31], v[76:79], v[184:187], v[16:31]
    buffer_load_dwordx4 v224, s[4:7], s45 offen lds
    buffer_load_dwordx4 v225, s[72:75], s45 offen offset:1024 lds
    s_waitcnt lgkmcnt(4)
    v_mad_u32_u16 v227, v226, s39, v248 op_sel:[1,0,0,0]
    v_mad_u32_u16 v226, v226, s39, v248
    v_mfma_f32_32x32x16_bf16 v[32:47], v[72:75], v[188:191], v[32:47]
    v_add_u32 v228, s51, v251
    ds_read_b32 v228, v228
    s_set_gpr_idx_on s31, gpr_idx(DST)
    s_nop 0
    v_cvt_pk_bf16_f32 v194, v234, v242
    s_set_gpr_idx_off
    v_mfma_f32_32x32x16_bf16 v[48:63], v[76:79], v[188:191], v[48:63]
    s_waitcnt vmcnt(4) lgkmcnt(1)
    v_mfma_f32_32x32x16_bf16 v[0:15], v[80:83], v[176:179], v[0:15]
    ds_read_b64_tr_b16 v[184:185], v246 offset:6144
    ds_read_b64_tr_b16 v[186:187], v246 offset:6656
    ds_read_b64_tr_b16 v[188:189], v247 offset:6144
    ds_read_b64_tr_b16 v[190:191], v247 offset:6656
    s_mov_b32 m0, s70
    v_mfma_f32_32x32x16_bf16 v[16:31], v[84:87], v[176:179], v[16:31]
    buffer_load_dwordx4 v226, s[4:7], s46 offen lds
    buffer_load_dwordx4 v227, s[72:75], s46 offen offset:1024 lds
    s_waitcnt lgkmcnt(4)
    v_mad_u32_u16 v229, v228, s39, v248 op_sel:[1,0,0,0]
    v_mad_u32_u16 v228, v228, s39, v248
    v_mfma_f32_32x32x16_bf16 v[32:47], v[80:83], v[180:183], v[32:47]
    v_mfma_f32_32x32x16_bf16 v[48:63], v[84:87], v[180:183], v[48:63]
    s_waitcnt vmcnt(4) lgkmcnt(0)
    v_mfma_f32_32x32x16_bf16 v[0:15], v[88:91], v[184:187], v[0:15]
    ds_read_b64_tr_b16 v[176:177], v246 offset:0
    ds_read_b64_tr_b16 v[178:179], v246 offset:512
    ds_read_b64_tr_b16 v[180:181], v247 offset:0
    ds_read_b64_tr_b16 v[182:183], v247 offset:512
    s_mov_b32 m0, s71
    v_mfma_f32_32x32x16_bf16 v[16:31], v[92:95], v[184:187], v[16:31]
    buffer_load_dwordx4 v228, s[4:7], s47 offen lds
    buffer_load_dwordx4 v229, s[72:75], s47 offen offset:1024 lds
    v_mfma_f32_32x32x16_bf16 v[32:47], v[88:91], v[188:191], v[32:47]
    s_nop 2
    v_mul_f32 v242, v0, v144
    v_fma_f32 v240, v8, v160, -v240
    v_fmac_f32 v242, v1, v145
    v_fmac_f32 v240, v9, v161
    v_fmac_f32 v242, v2, v146
    v_fmac_f32 v240, v10, v162
    v_fmac_f32 v242, v3, v147
    v_mfma_f32_32x32x16_bf16 v[48:63], v[92:95], v[188:191], v[48:63]
    s_setprio 0
    v_fmac_f32 v240, v11, v163
    v_fmac_f32 v242, v4, v148
    v_fmac_f32 v240, v12, v164
    v_fmac_f32 v242, v5, v149
    v_fmac_f32 v240, v13, v165
    v_fmac_f32 v242, v6, v150
    v_fmac_f32 v240, v14, v166
    v_fmac_f32 v242, v7, v151
    v_fmac_f32 v240, v15, v167
    s_sub_u32 s58, s48, s29
    v_add_u32 v249, s58, v249
    v_add_u32 v250, s58, v250
    v_fma_f32 v244, v16, v160, -v244
    v_fmac_f32 v236, v24, v112
    v_fmac_f32 v244, v17, v161
    v_fmac_f32 v236, v25, v113
    v_fmac_f32 v244, v18, v162
    v_fmac_f32 v236, v26, v114
    v_fmac_f32 v244, v19, v163
    v_fmac_f32 v236, v27, v115
    v_fmac_f32 v244, v20, v164
    v_fmac_f32 v236, v28, v116
    v_fmac_f32 v244, v21, v165
    v_fmac_f32 v236, v29, v117
    v_fmac_f32 v244, v22, v166
    v_fmac_f32 v236, v30, v118
    v_fmac_f32 v244, v23, v167
    v_fmac_f32 v236, v31, v119
    ds_read_b64_tr_b16 v[0:1], v249 offset:0
    ds_read_b64_tr_b16 v[2:3], v249 offset:128
    ds_read_b128 v[4:7], v250 offset:0
    ds_read_b128 v[8:11], v250 offset:16
    ds_read_b128 v[12:15], v250 offset:128
    ds_read_b128 v[16:19], v250 offset:144
    v_mul_f32 v243, v32, v152
    v_fma_f32 v241, v40, v168, -v241
    v_fmac_f32 v243, v33, v153
    v_fmac_f32 v241, v41, v169
    v_fmac_f32 v243, v34, v154
    v_fmac_f32 v241, v42, v170
    v_fmac_f32 v243, v35, v155
    v_fmac_f32 v241, v43, v171
    v_fmac_f32 v243, v36, v156
    v_fmac_f32 v241, v44, v172
    v_fmac_f32 v243, v37, v157
    v_fmac_f32 v241, v45, v173
    v_fmac_f32 v243, v38, v158
    v_fmac_f32 v241, v46, v174
    v_fmac_f32 v243, v39, v159
    v_fmac_f32 v241, v47, v175
    ds_read_b64_tr_b16 v[20:21], v249 offset:800
    ds_read_b64_tr_b16 v[22:23], v249 offset:928
    ds_read_b128 v[24:27], v250 offset:800
    ds_read_b128 v[28:31], v250 offset:816
    ds_read_b128 v[32:35], v250 offset:928
    ds_read_b128 v[36:39], v250 offset:944
    v_fma_f32 v245, v48, v168, -v245
    v_fmac_f32 v237, v56, v120
    v_fmac_f32 v245, v49, v169
    v_fmac_f32 v237, v57, v121
    v_fmac_f32 v245, v50, v170
    v_fmac_f32 v237, v58, v122
    v_fmac_f32 v245, v51, v171
    v_fmac_f32 v237, v59, v123
    v_fmac_f32 v245, v52, v172
    v_fmac_f32 v237, v60, v124
    v_fmac_f32 v245, v53, v173
    v_fmac_f32 v237, v61, v125
    v_fmac_f32 v245, v54, v174
    v_fmac_f32 v237, v62, v126
    v_fmac_f32 v245, v55, v175
    v_fmac_f32 v237, v63, v127
    s_cmp_lg_u32 s34, 0
    s_cbranch_scc1 K2_SWITCH
    s_mov_b32 s29, s48
    s_mov_b32 s32, s31
    s_mov_b32 s31, s35
    s_cmp_eq_u32 s33, 2
    s_cbranch_scc1 K2_U20
    s_cmp_eq_u32 s33, 3
    s_cbranch_scc1 K2_U30
    s_cmp_eq_u32 s33, 1
    s_cbranch_scc1 K2_U10
    s_branch K2_U40
K2_U11:
    s_setprio 1
    v_mov_b32 v254, 162048
    v_mov_b32 v255, 1
    v_lshl_add_u32 v233, v252, 1, s53
    s_mov_b64 exec, 1
    ds_add_rtn_u32 v232, v254, v255
    s_mov_b64 exec, -1
    ds_read_b32 v233, v233
    s_waitcnt lgkmcnt(12)
    v_lshlrev_b32 v40, 16, v0
    v_and_b32 v41, 0xffff0000, v0
    v_lshlrev_b32 v42, 16, v1
    v_and_b32 v43, 0xffff0000, v1
    v_lshlrev_b32 v44, 16, v2
    v_and_b32 v45, 0xffff0000, v2
    v_lshlrev_b32 v46, 16, v3
    v_and_b32 v47, 0xffff0000, v3
    s_waitcnt lgkmcnt(10)
    v_mul_f32 v4, v40, v4
    v_mul_f32 v5, v41, v5
    v_mul_f32 v6, v42, v6
    v_mul_f32 v7, v43, v7
    v_mul_f32 v8, v44, v8
    v_mul_f32 v9, v45, v9
    v_mul_f32 v10, v46, v10
    v_mul_f32 v11, v47, v11
    v_cvt_pk_bf16_f32 v64, v4, v5
    v_cvt_pk_bf16_f32 v65, v6, v7
    v_cvt_pk_bf16_f32 v66, v8, v9
    v_cvt_pk_bf16_f32 v67, v10, v11
    s_waitcnt lgkmcnt(8)
    v_mul_f32 v12, v40, v12
    v_mul_f32 v13, v41, v13
    v_mul_f32 v14, v42, v14
    v_mul_f32 v15, v43, v15
    v_mul_f32 v16, v44, v16
    v_mul_f32 v17, v45, v17
    v_mul_f32 v18, v46, v18
    v_mul_f32 v19, v47, v19
    v_cvt_pk_bf16_f32 v68, v12, v13
    v_cvt_pk_bf16_f32 v69, v14, v15
    v_cvt_pk_bf16_f32 v70, v16, v17
    v_cvt_pk_bf16_f32 v71, v18, v19
    s_waitcnt lgkmcnt(0)
    v_readfirstlane_b32 s58, v232
    s_nop 0
    s_cmp_lt_u32 s58, s22
    s_cbranch_scc0 K2_nul_84
    s_and_b32 s59, s58, 7
    s_lshr_b32 s60, s58, 3
K2_chk_86:
    v_readlane_b32 s61, v233, s59
    s_nop 0
    s_cmp_gt_u32 s61, s60
    s_cbranch_scc0 K2_spin_85
K2_back_87:
    v_readlane_b32 s59, v253, s58
    s_lshl_b32 s44, s34, 7
    s_and_b32 s48, s59, 0x3ffff
    s_bfe_u32 s33, s59, 0x30012
    s_lshr_b32 s60, s59, 21
    s_add_u32 s35, s60, s48
    s_mov_b32 s45, s44
    s_add_u32 s47, s44, 256
    s_add_u32 s49, s48, 800
    s_add_u32 s60, s48, 1600
    s_cmp_eq_u32 s33, 3
    s_cselect_b32 s46, s44, s47
    s_cselect_b32 s50, s60, s48
    s_cselect_b32 s51, s48, s49
    s_sub_u32 s60, s33, 2
    s_cmp_lt_u32 s60, 2
    s_cbranch_scc0 K2_rare_88
K2_back_89:
    v_add_u32 v222, s48, v251
    ds_read_b32 v222, v222
    v_add_u32 v224, s49, v251
    ds_read_b32 v224, v224
    v_add_u32 v226, s50, v251
    ds_read_b32 v226, v226
    v_add_u32 v228, s51, v251
    ds_read_b32 v228, v228
    s_waitcnt lgkmcnt(3)
    v_mad_u32_u16 v223, v222, s39, v248 op_sel:[1,0,0,0]
    v_mad_u32_u16 v222, v222, s39, v248
    s_waitcnt lgkmcnt(2)
    v_mad_u32_u16 v225, v224, s39, v248 op_sel:[1,0,0,0]
    v_mad_u32_u16 v224, v224, s39, v248
    s_waitcnt lgkmcnt(1)
    v_mad_u32_u16 v227, v226, s39, v248 op_sel:[1,0,0,0]
    v_mad_u32_u16 v226, v226, s39, v248
    s_waitcnt lgkmcnt(0)
    v_mad_u32_u16 v229, v228, s39, v248 op_sel:[1,0,0,0]
    v_mad_u32_u16 v228, v228, s39, v248
    s_waitcnt vmcnt(4)
    v_mfma_f32_32x32x16_bf16 v[0:15], v[64:67], v[176:179], 0
    ds_read_b64_tr_b16 v[184:185], v246 offset:2048
    ds_read_b64_tr_b16 v[186:187], v246 offset:2560
    ds_read_b64_tr_b16 v[188:189], v247 offset:2048
    ds_read_b64_tr_b16 v[190:191], v247 offset:2560
    s_mov_b32 m0, s68
    v_mfma_f32_32x32x16_bf16 v[16:31], v[68:71], v[176:179], 0
    buffer_load_dwordx4 v222, s[4:7], s44 offen lds
    buffer_load_dwordx4 v223, s[72:75], s44 offen offset:1024 lds
    v_permlane32_swap_b32 v242, v243
    v_permlane32_swap_b32 v240, v241
    v_mfma_f32_32x32x16_bf16 v[32:47], v[64:67], v[180:183], 0
    v_permlane32_swap_b32 v236, v237
    v_permlane32_swap_b32 v244, v245
    v_add_f32 v242, v242, v243
    v_add_f32 v240, -v240, -v241
    v_add_f32 v236, v236, v237
    v_mfma_f32_32x32x16_bf16 v[48:63], v[68:71], v[180:183], 0
    s_setprio 0
    v_add_f32 v244, v244, v245
    v_cvt_pk_bf16_f32 v242, v242, v236
    v_cvt_pk_bf16_f32 v244, v244, v240
    v_cvt_pk_bf16_f32 v238, v238, v238
    ds_write_b16 v230, v242 offset:1152
    ds_write_b16_d16_hi v230, v242 offset:128
    ds_write_b16 v230, v244 offset:512
    ds_write_b16_d16_hi v230, v244 offset:896
    ds_write_b16 v230, v238 offset:1280
    v_mul_f32 v234, v0, v96
    v_mul_f32 v236, v8, v128
    v_fmac_f32 v234, v1, v97
    v_fmac_f32 v236, v9, v129
    v_fmac_f32 v234, v2, v98
    v_fmac_f32 v236, v10, v130
    v_fmac_f32 v234, v3, v99
    v_fmac_f32 v236, v11, v131
    v_fmac_f32 v234, v4, v100
    v_fmac_f32 v236, v12, v132
    v_fmac_f32 v234, v5, v101
    v_fmac_f32 v236, v13, v133
    v_fmac_f32 v234, v6, v102
    v_fmac_f32 v236, v14, v134
    v_fmac_f32 v234, v7, v103
    v_fmac_f32 v236, v15, v135
    v_mul_f32 v238, v16, v128
    v_mul_f32 v240, v24, v128
    v_fmac_f32 v238, v17, v129
    v_fmac_f32 v240, v25, v129
    v_fmac_f32 v238, v18, v130
    v_fmac_f32 v240, v26, v130
    v_fmac_f32 v238, v19, v131
    v_fmac_f32 v240, v27, v131
    v_fmac_f32 v238, v20, v132
    v_fmac_f32 v240, v28, v132
    v_fmac_f32 v238, v21, v133
    v_fmac_f32 v240, v29, v133
    v_fmac_f32 v238, v22, v134
    v_fmac_f32 v240, v30, v134
    v_fmac_f32 v238, v23, v135
    v_fmac_f32 v240, v31, v135
    v_mul_f32 v235, v32, v104
    v_mul_f32 v237, v40, v136
    v_fmac_f32 v235, v33, v105
    v_fmac_f32 v237, v41, v137
    v_fmac_f32 v235, v34, v106
    v_fmac_f32 v237, v42, v138
    v_fmac_f32 v235, v35, v107
    v_fmac_f32 v237, v43, v139
    v_fmac_f32 v235, v36, v108
    v_fmac_f32 v237, v44, v140
    v_fmac_f32 v235, v37, v109
    v_fmac_f32 v237, v45, v141
    v_fmac_f32 v235, v38, v110
    v_fmac_f32 v237, v46, v142
    v_fmac_f32 v235, v39, v111
    v_fmac_f32 v237, v47, v143
    v_mul_f32 v239, v48, v136
    v_mul_f32 v241, v56, v136
    v_fmac_f32 v239, v49, v137
    v_fmac_f32 v241, v57, v137
    v_fmac_f32 v239, v50, v138
    v_fmac_f32 v241, v58, v138
    v_fmac_f32 v239, v51, v139
    v_fmac_f32 v241, v59, v139
    v_fmac_f32 v239, v52, v140
    v_fmac_f32 v241, v60, v140
    v_fmac_f32 v239, v53, v141
    v_fmac_f32 v241, v61, v141
    v_fmac_f32 v239, v54, v142
    v_fmac_f32 v241, v62, v142
    v_fmac_f32 v239, v55, v143
    v_fmac_f32 v241, v63, v143
    s_setprio 1
    s_waitcnt vmcnt(4) lgkmcnt(5)
    v_mfma_f32_32x32x16_bf16 v[0:15], v[64:67], v[184:187], 0
    ds_read_b64_tr_b16 v[176:177], v246 offset:4096
    ds_read_b64_tr_b16 v[178:179], v246 offset:4608
    ds_read_b64_tr_b16 v[180:181], v247 offset:4096
    ds_read_b64_tr_b16 v[182:183], v247 offset:4608
    s_mov_b32 m0, s69
    v_mfma_f32_32x32x16_bf16 v[16:31], v[68:71], v[184:187], 0
    buffer_load_dwordx4 v224, s[4:7], s45 offen lds
    buffer_load_dwordx4 v225, s[72:75], s45 offen offset:1024 lds
    v_permlane32_swap_b32 v234, v235
    v_permlane32_swap_b32 v236, v237
    v_mfma_f32_32x32x16_bf16 v[32:47], v[64:67], v[188:191], 0
    v_permlane32_swap_b32 v238, v239
    v_permlane32_swap_b32 v240, v241
    v_add_u32 v230, s31, v252
    v_add_f32 v234, v234, v235
    v_add_f32 v236, v236, v237
    v_mfma_f32_32x32x16_bf16 v[48:63], v[68:71], v[188:191], 0
    s_setprio 0
    v_add_f32 v238, v238, v239
    v_add_f32 v240, v240, v241
    v_cvt_pk_bf16_f32 v234, v234, v236
    v_cvt_pk_bf16_f32 v238, v238, v240
    ds_write_b16 v230, v234 offset:0
    ds_write_b16_d16_hi v230, v234 offset:256
    ds_write_b16 v230, v238 offset:640
    ds_write_b16_d16_hi v230, v238 offset:1024
    v_mul_f32 v234, v0, v144
    v_mul_f32 v236, v8, v112
    v_fmac_f32 v234, v1, v145
    v_fmac_f32 v236, v9, v113
    v_fmac_f32 v234, v2, v146
    v_fmac_f32 v236, v10, v114
    v_fmac_f32 v234, v3, v147
    v_fmac_f32 v236, v11, v115
    v_fmac_f32 v234, v4, v148
    v_fmac_f32 v236, v12, v116
    v_fmac_f32 v234, v5, v149
    v_fmac_f32 v236, v13, v117
    v_fmac_f32 v234, v6, v150
    v_fmac_f32 v236, v14, v118
    v_fmac_f32 v234, v7, v151
    v_fmac_f32 v236, v15, v119
    v_mul_f32 v238, v16, v160
    v_mul_f32 v240, v24, v160
    v_fmac_f32 v238, v17, v161
    v_fmac_f32 v240, v25, v161
    v_fmac_f32 v238, v18, v162
    v_fmac_f32 v240, v26, v162
    v_fmac_f32 v238, v19, v163
    v_fmac_f32 v240, v27, v163
    v_fmac_f32 v238, v20, v164
    v_fmac_f32 v240, v28, v164
    v_fmac_f32 v238, v21, v165
    v_fmac_f32 v240, v29, v165
    v_fmac_f32 v238, v22, v166
    v_fmac_f32 v240, v30, v166
    v_fmac_f32 v238, v23, v167
    v_fmac_f32 v240, v31, v167
    v_mul_f32 v235, v32, v152
    v_mul_f32 v237, v40, v120
    v_fmac_f32 v235, v33, v153
    v_fmac_f32 v237, v41, v121
    v_fmac_f32 v235, v34, v154
    v_fmac_f32 v237, v42, v122
    v_fmac_f32 v235, v35, v155
    v_fmac_f32 v237, v43, v123
    v_fmac_f32 v235, v36, v156
    v_fmac_f32 v237, v44, v124
    v_fmac_f32 v235, v37, v157
    v_fmac_f32 v237, v45, v125
    v_fmac_f32 v235, v38, v158
    v_fmac_f32 v237, v46, v126
    v_fmac_f32 v235, v39, v159
    v_fmac_f32 v237, v47, v127
    v_mul_f32 v239, v48, v168
    v_mul_f32 v241, v56, v168
    v_fmac_f32 v239, v49, v169
    v_fmac_f32 v241, v57, v169
    v_fmac_f32 v239, v50, v170
    v_fmac_f32 v241, v58, v170
    v_fmac_f32 v239, v51, v171
    v_fmac_f32 v241, v59, v171
    v_fmac_f32 v239, v52, v172
    v_fmac_f32 v241, v60, v172
    v_fmac_f32 v239, v53, v173
    v_fmac_f32 v241, v61, v173
    v_fmac_f32 v239, v54, v174
    v_fmac_f32 v241, v62, v174
    v_fmac_f32 v239, v55, v175
    v_fmac_f32 v241, v63, v175
    s_setprio 1
    s_waitcnt vmcnt(4) lgkmcnt(4)
    v_mfma_f32_32x32x16_bf16 v[0:15], v[64:67], v[176:179], 0
    ds_read_b64_tr_b16 v[184:185], v246 offset:6144
    ds_read_b64_tr_b16 v[186:187], v246 offset:6656
    ds_read_b64_tr_b16 v[188:189], v247 offset:6144
    ds_read_b64_tr_b16 v[190:191], v247 offset:6656
    s_mov_b32 m0, s70
    v_mfma_f32_32x32x16_bf16 v[16:31], v[68:71], v[176:179], 0
    buffer_load_dwordx4 v226, s[4:7], s46 offen lds
    buffer_load_dwordx4 v227, s[72:75], s46 offen offset:1024 lds
    v_permlane32_swap_b32 v234, v235
    v_add_f32 v234, v234, v235
    v_mfma_f32_32x32x16_bf16 v[32:47], v[64:67], v[180:183], 0
    v_mfma_f32_32x32x16_bf16 v[48:63], v[68:71], v[180:183], 0
    s_setprio 0
    v_mul_f32 v242, v0, v144
    v_fma_f32 v238, v8, v160, -v238
    v_fmac_f32 v242, v1, v145
    v_fmac_f32 v238, v9, v161
    v_fmac_f32 v242, v2, v146
    v_fmac_f32 v238, v10, v162
    v_fmac_f32 v242, v3, v147
    v_fmac_f32 v238, v11, v163
    v_fmac_f32 v242, v4, v148
    v_fmac_f32 v238, v12, v164
    v_fmac_f32 v242, v5, v149
    v_fmac_f32 v238, v13, v165
    v_fmac_f32 v242, v6, v150
    v_fmac_f32 v238, v14, v166
    v_fmac_f32 v242, v7, v151
    v_fmac_f32 v238, v15, v167
    v_fmac_f32 v236, v16, v112
    v_mul_f32 v244, v24, v160
    v_fmac_f32 v236, v17, v113
    v_fmac_f32 v244, v25, v161
    v_fmac_f32 v236, v18, v114
    v_fmac_f32 v244, v26, v162
    v_fmac_f32 v236, v19, v115
    v_fmac_f32 v244, v27, v163
    v_fmac_f32 v236, v20, v116
    v_fmac_f32 v244, v28, v164
    v_fmac_f32 v236, v21, v117
    v_fmac_f32 v244, v29, v165
    v_fmac_f32 v236, v22, v118
    v_fmac_f32 v244, v30, v166
    v_fmac_f32 v236, v23, v119
    v_fmac_f32 v244, v31, v167
    v_mul_f32 v243, v32, v152
    v_fma_f32 v239, v40, v168, -v239
    v_fmac_f32 v243, v33, v153
    v_fmac_f32 v239, v41, v169
    v_fmac_f32 v243, v34, v154
    v_fmac_f32 v239, v42, v170
    v_fmac_f32 v243, v35, v155
    v_fmac_f32 v239, v43, v171
    v_fmac_f32 v243, v36, v156
    v_fmac_f32 v239, v44, v172
    v_fmac_f32 v243, v37, v157
    v_fmac_f32 v239, v45, v173
    v_fmac_f32 v243, v38, v158
    v_fmac_f32 v239, v46, v174
    v_fmac_f32 v243, v39, v159
    v_fmac_f32 v239, v47, v175
    v_fmac_f32 v237, v48, v120
    v_mul_f32 v245, v56, v168
    v_fmac_f32 v237, v49, v121
    v_fmac_f32 v245, v57, v169
    v_fmac_f32 v237, v50, v122
    v_fmac_f32 v245, v58, v170
    v_fmac_f32 v237, v51, v123
    v_fmac_f32 v245, v59, v171
    v_fmac_f32 v237, v52, v124
    v_fmac_f32 v245, v60, v172
    v_fmac_f32 v237, v53, v125
    v_fmac_f32 v245, v61, v173
    v_fmac_f32 v237, v54, v126
    v_fmac_f32 v245, v62, v174
    v_fmac_f32 v237, v55, v127
    v_fmac_f32 v245, v63, v175
    s_setprio 1
    s_waitcnt vmcnt(4) lgkmcnt(0)
    v_mfma_f32_32x32x16_bf16 v[0:15], v[64:67], v[184:187], 0
    ds_read_b64_tr_b16 v[176:177], v246 offset:0
    ds_read_b64_tr_b16 v[178:179], v246 offset:512
    ds_read_b64_tr_b16 v[180:181], v247 offset:0
    ds_read_b64_tr_b16 v[182:183], v247 offset:512
    s_mov_b32 m0, s71
    v_mfma_f32_32x32x16_bf16 v[16:31], v[68:71], v[184:187], 0
    buffer_load_dwordx4 v228, s[4:7], s47 offen lds
    buffer_load_dwordx4 v229, s[72:75], s47 offen offset:1024 lds
    v_permlane32_swap_b32 v238, v239
    v_permlane32_swap_b32 v242, v243
    v_add_f32 v238, v238, v239
    v_mfma_f32_32x32x16_bf16 v[32:47], v[64:67], v[188:191], 0
    v_add_f32 v242, v242, v243
    v_cvt_pk_bf16_f32 v234, v234, v242
    ds_write_b16 v230, v234 offset:384
    ds_write_b16_d16_hi v230, v234 offset:768
    v_mfma_f32_32x32x16_bf16 v[48:63], v[68:71], v[188:191], 0
    s_setprio 0
    v_mul_f32 v242, v0, v144
    v_fma_f32 v240, v8, v160, -v240
    v_fmac_f32 v242, v1, v145
    v_fmac_f32 v240, v9, v161
    v_fmac_f32 v242, v2, v146
    v_fmac_f32 v240, v10, v162
    v_fmac_f32 v242, v3, v147
    v_fmac_f32 v240, v11, v163
    v_fmac_f32 v242, v4, v148
    v_fmac_f32 v240, v12, v164
    v_fmac_f32 v242, v5, v149
    v_fmac_f32 v240, v13, v165
    v_fmac_f32 v242, v6, v150
    v_fmac_f32 v240, v14, v166
    v_fmac_f32 v242, v7, v151
    v_fmac_f32 v240, v15, v167
    s_sub_u32 s58, s48, s29
    v_add_u32 v249, s58, v249
    v_add_u32 v250, s58, v250
    v_fma_f32 v244, v16, v160, -v244
    v_fmac_f32 v236, v24, v112
    v_fmac_f32 v244, v17, v161
    v_fmac_f32 v236, v25, v113
    v_fmac_f32 v244, v18, v162
    v_fmac_f32 v236, v26, v114
    v_fmac_f32 v244, v19, v163
    v_fmac_f32 v236, v27, v115
    v_fmac_f32 v244, v20, v164
    v_fmac_f32 v236, v28, v116
    v_fmac_f32 v244, v21, v165
    v_fmac_f32 v236, v29, v117
    v_fmac_f32 v244, v22, v166
    v_fmac_f32 v236, v30, v118
    v_fmac_f32 v244, v23, v167
    v_fmac_f32 v236, v31, v119
    ds_read_b64_tr_b16 v[0:1], v249 offset:0
    ds_read_b64_tr_b16 v[2:3], v249 offset:128
    ds_read_b128 v[4:7], v250 offset:0
    ds_read_b128 v[8:11], v250 offset:16
    ds_read_b128 v[12:15], v250 offset:128
    ds_read_b128 v[16:19], v250 offset:144
    v_mul_f32 v243, v32, v152
    v_fma_f32 v241, v40, v168, -v241
    v_fmac_f32 v243, v33, v153
    v_fmac_f32 v241, v41, v169
    v_fmac_f32 v243, v34, v154
    v_fmac_f32 v241, v42, v170
    v_fmac_f32 v243, v35, v155
    v_fmac_f32 v241, v43, v171
    v_fmac_f32 v243, v36, v156
    v_fmac_f32 v241, v44, v172
    v_fmac_f32 v243, v37, v157
    v_fmac_f32 v241, v45, v173
    v_fmac_f32 v243, v38, v158
    v_fmac_f32 v241, v46, v174
    v_fmac_f32 v243, v39, v159
    v_fmac_f32 v241, v47, v175
    ds_read_b64_tr_b16 v[20:21], v249 offset:800
    ds_read_b64_tr_b16 v[22:23], v249 offset:928
    ds_read_b128 v[24:27], v250 offset:800
    ds_read_b128 v[28:31], v250 offset:816
    ds_read_b128 v[32:35], v250 offset:928
    ds_read_b128 v[36:39], v250 offset:944
    v_fma_f32 v245, v48, v168, -v245
    v_fmac_f32 v237, v56, v120
    v_fmac_f32 v245, v49, v169
    v_fmac_f32 v237, v57, v121
    v_fmac_f32 v245, v50, v170
    v_fmac_f32 v237, v58, v122
    v_fmac_f32 v245, v51, v171
    v_fmac_f32 v237, v59, v123
    v_fmac_f32 v245, v52, v172
    v_fmac_f32 v237, v60, v124
    v_fmac_f32 v245, v53, v173
    v_fmac_f32 v237, v61, v125
    v_fmac_f32 v245, v54, v174
    v_fmac_f32 v237, v62, v126
    v_fmac_f32 v245, v55, v175
    v_fmac_f32 v237, v63, v127
    s_cmp_eq_u32 s36, 0
    s_cbranch_scc1 K2_TAIL
    s_mov_b32 s29, s48
    s_mov_b32 s32, s31
    s_mov_b32 s31, s35
    s_cmp_eq_u32 s33, 2
    s_cbranch_scc1 K2_U21
    s_cmp_eq_u32 s33, 3
    s_cbranch_scc1 K2_U31
    s_cmp_eq_u32 s33, 1
    s_cbranch_scc1 K2_U11
    s_branch K2_U41
K2_U41:
    s_setprio 1
    s_waitcnt lgkmcnt(10)
    v_lshlrev_b32 v40, 16, v0
    v_and_b32 v41, 0xffff0000, v0
    v_lshlrev_b32 v42, 16, v1
    v_and_b32 v43, 0xffff0000, v1
    v_lshlrev_b32 v44, 16, v2
    v_and_b32 v45, 0xffff0000, v2
    v_lshlrev_b32 v46, 16, v3
    v_and_b32 v47, 0xffff0000, v3
    s_waitcnt lgkmcnt(8)
    v_mul_f32 v4, v40, v4
    v_mul_f32 v5, v41, v5
    v_mul_f32 v6, v42, v6
    v_mul_f32 v7, v43, v7
    v_mul_f32 v8, v44, v8
    v_mul_f32 v9, v45, v9
    v_mul_f32 v10, v46, v10
    v_mul_f32 v11, v47, v11
    v_cvt_pk_bf16_f32 v64, v4, v5
    v_cvt_pk_bf16_f32 v65, v6, v7
    v_cvt_pk_bf16_f32 v66, v8, v9
    v_cvt_pk_bf16_f32 v67, v10, v11
    s_waitcnt lgkmcnt(6)
    v_mul_f32 v12, v40, v12
    v_mul_f32 v13, v41, v13
    v_mul_f32 v14, v42, v14
    v_mul_f32 v15, v43, v15
    v_mul_f32 v16, v44, v16
    v_mul_f32 v17, v45, v17
    v_mul_f32 v18, v46, v18
    v_mul_f32 v19, v47, v19
    v_cvt_pk_bf16_f32 v68, v12, v13
    v_cvt_pk_bf16_f32 v69, v14, v15
    v_cvt_pk_bf16_f32 v70, v16, v17
    v_cvt_pk_bf16_f32 v71, v18, v19
    ds_read_b64_tr_b16 v[0:1], v249 offset:1600
    ds_read_b64_tr_b16 v[2:3], v249 offset:1728
    ds_read_b128 v[4:7], v250 offset:1600
    ds_read_b128 v[8:11], v250 offset:1616
    ds_read_b128 v[12:15], v250 offset:1728
    ds_read_b128 v[16:19], v250 offset:1744
    s_waitcnt lgkmcnt(10)
    v_lshlrev_b32 v48, 16, v20
    v_and_b32 v49, 0xffff0000, v20
    v_lshlrev_b32 v50, 16, v21
    v_and_b32 v51, 0xffff0000, v21
    v_lshlrev_b32 v52, 16, v22
    v_and_b32 v53, 0xffff0000, v22
    v_lshlrev_b32 v54, 16, v23
    v_and_b32 v55, 0xffff0000, v23
    s_waitcnt lgkmcnt(8)
    v_mul_f32 v24, v48, v24
    v_mul_f32 v25, v49, v25
    v_mul_f32 v26, v50, v26
    v_mul_f32 v27, v51, v27
    v_mul_f32 v28, v52, v28
    v_mul_f32 v29, v53, v29
    v_mul_f32 v30, v54, v30
    v_mul_f32 v31, v55, v31
    v_cvt_pk_bf16_f32 v72, v24, v25
    v_cvt_pk_bf16_f32 v73, v26, v27
    v_cvt_pk_bf16_f32 v74, v28, v29
    v_cvt_pk_bf16_f32 v75, v30, v31
    s_waitcnt lgkmcnt(6)
    v_mul_f32 v32, v48, v32
    v_mul_f32 v33, v49, v33
    v_mul_f32 v34, v50, v34
    v_mul_f32 v35, v51, v35
    v_mul_f32 v36, v52, v36
    v_mul_f32 v37, v53, v37
    v_mul_f32 v38, v54, v38
    v_mul_f32 v39, v55, v39
    v_cvt_pk_bf16_f32 v76, v32, v33
    v_cvt_pk_bf16_f32 v77, v34, v35
    v_cvt_pk_bf16_f32 v78, v36, v37
    v_cvt_pk_bf16_f32 v79, v38, v39
    ds_read_b64_tr_b16 v[20:21], v249 offset:2400
    ds_read_b64_tr_b16 v[22:23], v249 offset:2528
    ds_read_b128 v[24:27], v250 offset:2400
    ds_read_b128 v[28:31], v250 offset:2416
    ds_read_b128 v[32:35], v250 offset:2528
    ds_read_b128 v[36:39], v250 offset:2544
    s_waitcnt lgkmcnt(10)
    v_lshlrev_b32 v40, 16, v0
    v_and_b32 v41, 0xffff0000, v0
    v_lshlrev_b32 v42, 16, v1
    v_and_b32 v43, 0xffff0000, v1
    v_lshlrev_b32 v44, 16, v2
    v_and_b32 v45, 0xffff0000, v2
    v_lshlrev_b32 v46, 16, v3
    v_and_b32 v47, 0xffff0000, v3
    s_waitcnt lgkmcnt(8)
    v_mul_f32 v4, v40, v4
    v_mul_f32 v5, v41, v5
    v_mul_f32 v6, v42, v6
    v_mul_f32 v7, v43, v7
    v_mul_f32 v8, v44, v8
    v_mul_f32 v9, v45, v9
    v_mul_f32 v10, v46, v10
    v_mul_f32 v11, v47, v11
    v_cvt_pk_bf16_f32 v80, v4, v5
    v_cvt_pk_bf16_f32 v81, v6, v7
    v_cvt_pk_bf16_f32 v82, v8, v9
    v_cvt_pk_bf16_f32 v83, v10, v11
    s_waitcnt lgkmcnt(6)
    v_mul_f32 v12, v40, v12
    v_mul_f32 v13, v41, v13
    v_mul_f32 v14, v42, v14
    v_mul_f32 v15, v43, v15
    v_mul_f32 v16, v44, v16
    v_mul_f32 v17, v45, v17
    v_mul_f32 v18, v46, v18
    v_mul_f32 v19, v47, v19
    v_cvt_pk_bf16_f32 v84, v12, v13
    v_cvt_pk_bf16_f32 v85, v14, v15
    v_cvt_pk_bf16_f32 v86, v16, v17
    v_cvt_pk_bf16_f32 v87, v18, v19
    s_waitcnt lgkmcnt(4)
    v_lshlrev_b32 v48, 16, v20
    v_and_b32 v49, 0xffff0000, v20
    v_lshlrev_b32 v50, 16, v21
    v_and_b32 v51, 0xffff0000, v21
    v_lshlrev_b32 v52, 16, v22
    v_and_b32 v53, 0xffff0000, v22
    v_lshlrev_b32 v54, 16, v23
    v_and_b32 v55, 0xffff0000, v23
    s_waitcnt lgkmcnt(2)
    v_mul_f32 v24, v48, v24
    v_mul_f32 v25, v49, v25
    v_mul_f32 v26, v50, v26
    v_mul_f32 v27, v51, v27
    v_mul_f32 v28, v52, v28
    v_mul_f32 v29, v53, v29
    v_mul_f32 v30, v54, v30
    v_mul_f32 v31, v55, v31
    v_cvt_pk_bf16_f32 v88, v24, v25
    v_cvt_pk_bf16_f32 v89, v26, v27
    v_cvt_pk_bf16_f32 v90, v28, v29
    v_cvt_pk_bf16_f32 v91, v30, v31
    s_waitcnt lgkmcnt(0)
    v_mul_f32 v32, v48, v32
    v_mul_f32 v33, v49, v33
    v_mul_f32 v34, v50, v34
    v_mul_f32 v35, v51, v35
    v_mul_f32 v36, v52, v36
    v_mul_f32 v37, v53, v37
    v_mul_f32 v38, v54, v38
    v_mul_f32 v39, v55, v39
    v_cvt_pk_bf16_f32 v92, v32, v33
    v_cvt_pk_bf16_f32 v93, v34, v35
    v_cvt_pk_bf16_f32 v94, v36, v37
    v_cvt_pk_bf16_f32 v95, v38, v39
    s_waitcnt vmcnt(4)
    v_mfma_f32_32x32x16_bf16 v[0:15], v[64:67], v[176:179], 0
    ds_read_b64_tr_b16 v[184:185], v246 offset:2048
    ds_read_b64_tr_b16 v[186:187], v246 offset:2560
    ds_read_b64_tr_b16 v[188:189], v247 offset:2048
    ds_read_b64_tr_b16 v[190:191], v247 offset:2560
    s_mov_b32 m0, s68
    v_mfma_f32_32x32x16_bf16 v[16:31], v[68:71], v[176:179], 0
    buffer_load_dwordx4 v222, s[4:7], s41 offen lds
    buffer_load_dwordx4 v223, s[72:75], s41 offen offset:1024 lds
    v_permlane32_swap_b32 v242, v243
    v_permlane32_swap_b32 v240, v241
    v_mov_b32 v254, 162048
    v_mfma_f32_32x32x16_bf16 v[32:47], v[64:67], v[180:183], 0
    v_permlane32_swap_b32 v236, v237
    v_permlane32_swap_b32 v244, v245
    v_add_f32 v242, v242, v243
    v_add_f32 v240, -v240, -v241
    v_add_f32 v236, v236, v237
    v_mfma_f32_32x32x16_bf16 v[48:63], v[68:71], v[180:183], 0
    v_add_f32 v244, v244, v245
    v_cvt_pk_bf16_f32 v242, v242, v236
    v_cvt_pk_bf16_f32 v244, v244, v240
    v_cvt_pk_bf16_f32 v238, v238, v238
    ds_write_b16 v230, v242 offset:1152
    ds_write_b16_d16_hi v230, v242 offset:128
    v_mov_b32 v255, 1
    v_lshl_add_u32 v233, v252, 1, s53
    s_mov_b64 exec, 1
    ds_add_rtn_u32 v232, v254, v255
    s_mov_b64 exec, -1
    ds_read_b32 v233, v233
    s_waitcnt vmcnt(4) lgkmcnt(4)
    v_mfma_f32_32x32x16_bf16 v[0:15], v[72:75], v[184:187], v[0:15]
    ds_read_b64_tr_b16 v[176:177], v246 offset:4096
    ds_read_b64_tr_b16 v[178:179], v246 offset:4608
    ds_read_b64_tr_b16 v[180:181], v247 offset:4096
    ds_read_b64_tr_b16 v[182:183], v247 offset:4608
    ds_write_b16 v230, v244 offset:512
    ds_write_b16_d16_hi v230, v244 offset:896
    s_mov_b32 m0, s69
    v_mfma_f32_32x32x16_bf16 v[16:31], v[76:79], v[184:187], v[16:31]
    buffer_load_dwordx4 v224, s[4:7], s41 offen lds
    buffer_load_dwordx4 v225, s[72:75], s41 offen offset:1024 lds
    ds_write_b16 v230, v238 offset:1280
    s_waitcnt lgkmcnt(7)
    v_readfirstlane_b32 s58, v232
    v_mfma_f32_32x32x16_bf16 v[32:47], v[72:75], v[188:191], v[32:47]
    s_cmp_lt_u32 s58, s22
    s_cbranch_scc0 K2_nul_91
    s_and_b32 s59, s58, 7
    s_lshr_b32 s60, s58, 3
K2_chk_93:
    v_readlane_b32 s61, v233, s59
    s_nop 0
    s_cmp_gt_u32 s61, s60
    s_cbranch_scc0 K2_spin_92
K2_back_94:
    v_mfma_f32_32x32x16_bf16 v[48:63], v[76:79], v[188:191], v[48:63]
    v_readlane_b32 s59, v253, s58
    s_lshl_b32 s44, s34, 7
    s_and_b32 s48, s59, 0x3ffff
    s_bfe_u32 s33, s59, 0x30012
    s_lshr_b32 s60, s59, 21
    s_add_u32 s35, s60, s48
    s_waitcnt vmcnt(4) lgkmcnt(3)
    v_mfma_f32_32x32x16_bf16 v[0:15], v[80:83], v[176:179], v[0:15]
    ds_read_b64_tr_b16 v[184:185], v246 offset:6144
    ds_read_b64_tr_b16 v[186:187], v246 offset:6656
    ds_read_b64_tr_b16 v[188:189], v247 offset:6144
    ds_read_b64_tr_b16 v[190:191], v247 offset:6656
    s_mov_b32 s45, s44
    s_add_u32 s47, s44, 256
    s_mov_b32 m0, s70
    v_mfma_f32_32x32x16_bf16 v[16:31], v[84:87], v[176:179], v[16:31]
    buffer_load_dwordx4 v226, s[4:7], s41 offen lds
    buffer_load_dwordx4 v227, s[72:75], s41 offen offset:1024 lds
    s_add_u32 s49, s48, 800
    s_add_u32 s60, s48, 1600
    v_mfma_f32_32x32x16_bf16 v[32:47], v[80:83], v[180:183], v[32:47]
    s_cmp_eq_u32 s33, 3
    s_cselect_b32 s46, s44, s47
    s_cselect_b32 s50, s60, s48
    s_cselect_b32 s51, s48, s49
    s_sub_u32 s60, s33, 2
    s_cmp_lt_u32 s60, 2
    s_cbranch_scc0 K2_rare_95
K2_back_96:
    v_mfma_f32_32x32x16_bf16 v[48:63], v[84:87], v[180:183], v[48:63]
    s_waitcnt vmcnt(4) lgkmcnt(0)
    v_mfma_f32_32x32x16_bf16 v[0:15], v[88:91], v[184:187], v[0:15]
    ds_read_b64_tr_b16 v[176:177], v246 offset:0
    ds_read_b64_tr_b16 v[178:179], v246 offset:512
    ds_read_b64_tr_b16 v[180:181], v247 offset:0
    ds_read_b64_tr_b16 v[182:183], v247 offset:512
    s_mov_b32 m0, s71
    v_mfma_f32_32x32x16_bf16 v[16:31], v[92:95], v[184:187], v[16:31]
    buffer_load_dwordx4 v228, s[4:7], s41 offen lds
    buffer_load_dwordx4 v229, s[72:75], s41 offen offset:1024 lds
    v_mfma_f32_32x32x16_bf16 v[32:47], v[88:91], v[188:191], v[32:47]
    s_nop 2
    v_mul_f32 v234, v0, v96
    v_mul_f32 v236, v8, v128
    v_fmac_f32 v234, v1, v97
    v_fmac_f32 v236, v9, v129
    v_fmac_f32 v234, v2, v98
    v_fmac_f32 v236, v10, v130
    v_fmac_f32 v234, v3, v99
    v_mfma_f32_32x32x16_bf16 v[48:63], v[92:95], v[188:191], v[48:63]
    s_setprio 0
    v_fmac_f32 v236, v11, v131
    v_fmac_f32 v234, v4, v100
    v_fmac_f32 v236, v12, v132
    v_fmac_f32 v234, v5, v101
    v_fmac_f32 v236, v13, v133
    v_fmac_f32 v234, v6, v102
    v_fmac_f32 v236, v14, v134
    v_fmac_f32 v234, v7, v103
    v_fmac_f32 v236, v15, v135
    v_mul_f32 v238, v16, v128
    v_mul_f32 v240, v24, v128
    v_fmac_f32 v238, v17, v129
    v_fmac_f32 v240, v25, v129
    v_fmac_f32 v238, v18, v130
    v_fmac_f32 v240, v26, v130
    v_fmac_f32 v238, v19, v131
    v_fmac_f32 v240, v27, v131
    v_fmac_f32 v238, v20, v132
    v_fmac_f32 v240, v28, v132
    v_fmac_f32 v238, v21, v133
    v_fmac_f32 v240, v29, v133
    v_fmac_f32 v238, v22, v134
    v_fmac_f32 v240, v30, v134
    v_fmac_f32 v238, v23, v135
    v_fmac_f32 v240, v31, v135
    v_mul_f32 v235, v32, v104
    v_mul_f32 v237, v40, v136
    v_fmac_f32 v235, v33, v105
    v_fmac_f32 v237, v41, v137
    v_fmac_f32 v235, v34, v106
    v_fmac_f32 v237, v42, v138
    v_fmac_f32 v235, v35, v107
    v_fmac_f32 v237, v43, v139
    v_fmac_f32 v235, v36, v108
    v_fmac_f32 v237, v44, v140
    v_fmac_f32 v235, v37, v109
    v_fmac_f32 v237, v45, v141
    v_fmac_f32 v235, v38, v110
    v_fmac_f32 v237, v46, v142
    v_fmac_f32 v235, v39, v111
    v_fmac_f32 v237, v47, v143
    v_mul_f32 v239, v48, v136
    v_mul_f32 v241, v56, v136
    s_setprio 1
    s_waitcnt vmcnt(4) lgkmcnt(0)
    v_mfma_f32_32x32x16_bf16 v[0:15], v[64:67], v[176:179], 0
    ds_read_b64_tr_b16 v[184:185], v246 offset:2048
    ds_read_b64_tr_b16 v[186:187], v246 offset:2560
    ds_read_b64_tr_b16 v[188:189], v247 offset:2048
    ds_read_b64_tr_b16 v[190:191], v247 offset:2560
    v_fmac_f32 v239, v49, v137
    v_fmac_f32 v241, v57, v137
    s_mov_b32 m0, s68
    v_mfma_f32_32x32x16_bf16 v[16:31], v[68:71], v[176:179], 0
    buffer_load_dwordx4 v222, s[4:7], s42 offen lds
    buffer_load_dwordx4 v223, s[72:75], s42 offen offset:1024 lds
    v_fmac_f32 v239, v50, v138
    v_fmac_f32 v241, v58, v138
    v_fmac_f32 v239, v51, v139
    v_fmac_f32 v241, v59, v139
    v_fmac_f32 v239, v52, v140
    v_mfma_f32_32x32x16_bf16 v[32:47], v[64:67], v[180:183], 0
    v_fmac_f32 v241, v60, v140
    v_fmac_f32 v239, v53, v141
    v_fmac_f32 v241, v61, v141
    v_fmac_f32 v239, v54, v142
    v_fmac_f32 v241, v62, v142
    v_fmac_f32 v239, v55, v143
    v_fmac_f32 v241, v63, v143
    v_mfma_f32_32x32x16_bf16 v[48:63], v[68:71], v[180:183], 0
    v_permlane32_swap_b32 v234, v235
    v_permlane32_swap_b32 v236, v237
    v_permlane32_swap_b32 v238, v239
    s_waitcnt vmcnt(4) lgkmcnt(0)
    v_mfma_f32_32x32x16_bf16 v[0:15], v[72:75], v[184:187], v[0:15]
    ds_read_b64_tr_b16 v[176:177], v246 offset:4096
    ds_read_b64_tr_b16 v[178:179], v246 offset:4608
    ds_read_b64_tr_b16 v[180:181], v247 offset:4096
    ds_read_b64_tr_b16 v[182:183], v247 offset:4608
    v_permlane32_swap_b32 v240, v241
    s_mov_b32 m0, s69
    v_mfma_f32_32x32x16_bf16 v[16:31], v[76:79], v[184:187], v[16:31]
    buffer_load_dwordx4 v224, s[4:7], s42 offen lds
    buffer_load_dwordx4 v225, s[72:75], s42 offen offset:1024 lds
    v_add_u32 v230, s31, v252
    v_add_f32 v234, v234, v235
    v_add_f32 v236, v236, v237
    v_add_f32 v238, v238, v239
    v_add_f32 v240, v240, v241
    v_mfma_f32_32x32x16_bf16 v[32:47], v[72:75], v[188:191], v[32:47]
    v_cvt_pk_bf16_f32 v234, v234, v236
    v_cvt_pk_bf16_f32 v238, v238, v240
    ds_write_b16 v230, v234 offset:0
    ds_write_b16_d16_hi v230, v234 offset:256
    ds_write_b16 v230, v238 offset:640
    ds_write_b16_d16_hi v230, v238 offset:1024
    v_mfma_f32_32x32x16_bf16 v[48:63], v[76:79], v[188:191], v[48:63]
    s_waitcnt vmcnt(4) lgkmcnt(4)
    v_mfma_f32_32x32x16_bf16 v[0:15], v[80:83], v[176:179], v[0:15]
    ds_read_b64_tr_b16 v[184:185], v246 offset:6144
    ds_read_b64_tr_b16 v[186:187], v246 offset:6656
    ds_read_b64_tr_b16 v[188:189], v247 offset:6144
    ds_read_b64_tr_b16 v[190:191], v247 offset:6656
    s_mov_b32 m0, s70
    v_mfma_f32_32x32x16_bf16 v[16:31], v[84:87], v[176:179], v[16:31]
    buffer_load_dwordx4 v226, s[4:7], s42 offen lds
    buffer_load_dwordx4 v227, s[72:75], s42 offen offset:1024 lds
    v_mfma_f32_32x32x16_bf16 v[32:47], v[80:83], v[180:183], v[32:47]
    v_mfma_f32_32x32x16_bf16 v[48:63], v[84:87], v[180:183], v[48:63]
    s_waitcnt vmcnt(4) lgkmcnt(0)
    v_mfma_f32_32x32x16_bf16 v[0:15], v[88:91], v[184:187], v[0:15]
    ds_read_b64_tr_b16 v[176:177], v246 offset:0
    ds_read_b64_tr_b16 v[178:179], v246 offset:512
    ds_read_b64_tr_b16 v[180:181], v247 offset:0
    ds_read_b64_tr_b16 v[182:183], v247 offset:512
    s_mov_b32 m0, s71
    v_mfma_f32_32x32x16_bf16 v[16:31], v[92:95], v[184:187], v[16:31]
    buffer_load_dwordx4 v228, s[4:7], s42 offen lds
    buffer_load_dwordx4 v229, s[72:75], s42 offen offset:1024 lds
    v_mfma_f32_32x32x16_bf16 v[32:47], v[88:91], v[188:191], v[32:47]
    s_nop 2
    v_mul_f32 v234, v0, v144
    v_mul_f32 v236, v8, v112
    v_fmac_f32 v234, v1, v145
    v_fmac_f32 v236, v9, v113
    v_fmac_f32 v234, v2, v146
    v_fmac_f32 v236, v10, v114
    v_fmac_f32 v234, v3, v147
    v_mfma_f32_32x32x16_bf16 v[48:63], v[92:95], v[188:191], v[48:63]
    s_setprio 0
    v_fmac_f32 v236, v11, v115
    v_fmac_f32 v234, v4, v148
    v_fmac_f32 v236, v12, v116
    v_fmac_f32 v234, v5, v149
    v_fmac_f32 v236, v13, v117
    v_fmac_f32 v234, v6, v150
    v_fmac_f32 v236, v14, v118
    v_fmac_f32 v234, v7, v151
    v_fmac_f32 v236, v15, v119
    v_mul_f32 v238, v16, v160
    v_mul_f32 v240, v24, v160
    v_fmac_f32 v238, v17, v161
    v_fmac_f32 v240, v25, v161
    v_fmac_f32 v238, v18, v162
    v_fmac_f32 v240, v26, v162
    v_fmac_f32 v238, v19, v163
    v_fmac_f32 v240, v27, v163
    v_fmac_f32 v238, v20, v164
    v_fmac_f32 v240, v28, v164
    v_fmac_f32 v238, v21, v165
    v_fmac_f32 v240, v29, v165
    v_fmac_f32 v238, v22, v166
    v_fmac_f32 v240, v30, v166
    v_fmac_f32 v238, v23, v167
    v_fmac_f32 v240, v31, v167
    v_mul_f32 v235, v32, v152
    v_mul_f32 v237, v40, v120
    v_fmac_f32 v235, v33, v153
    v_fmac_f32 v237, v41, v121
    v_fmac_f32 v235, v34, v154
    v_fmac_f32 v237, v42, v122
    v_fmac_f32 v235, v35, v155
    v_fmac_f32 v237, v43, v123
    v_fmac_f32 v235, v36, v156
    v_fmac_f32 v237, v44, v124
    v_fmac_f32 v235, v37, v157
    v_fmac_f32 v237, v45, v125
    v_fmac_f32 v235, v38, v158
    v_fmac_f32 v237, v46, v126
    v_fmac_f32 v235, v39, v159
    v_fmac_f32 v237, v47, v127
    v_mul_f32 v239, v48, v168
    v_mul_f32 v241, v56, v168
    s_setprio 1
    s_waitcnt vmcnt(4) lgkmcnt(0)
    v_mfma_f32_32x32x16_bf16 v[0:15], v[64:67], v[176:179], 0
    ds_read_b64_tr_b16 v[184:185], v246 offset:2048
    ds_read_b64_tr_b16 v[186:187], v246 offset:2560
    ds_read_b64_tr_b16 v[188:189], v247 offset:2048
    ds_read_b64_tr_b16 v[190:191], v247 offset:2560
    v_fmac_f32 v239, v49, v169
    v_fmac_f32 v241, v57, v169
    s_mov_b32 m0, s68
    v_mfma_f32_32x32x16_bf16 v[16:31], v[68:71], v[176:179], 0
    buffer_load_dwordx4 v222, s[4:7], s43 offen lds
    buffer_load_dwordx4 v223, s[72:75], s43 offen offset:1024 lds
    v_fmac_f32 v239, v50, v170
    v_fmac_f32 v241, v58, v170
    v_fmac_f32 v239, v51, v171
    v_fmac_f32 v241, v59, v171
    v_fmac_f32 v239, v52, v172
    v_mfma_f32_32x32x16_bf16 v[32:47], v[64:67], v[180:183], 0
    v_fmac_f32 v241, v60, v172
    v_fmac_f32 v239, v53, v173
    v_fmac_f32 v241, v61, v173
    v_fmac_f32 v239, v54, v174
    v_fmac_f32 v241, v62, v174
    v_fmac_f32 v239, v55, v175
    v_fmac_f32 v241, v63, v175
    v_mfma_f32_32x32x16_bf16 v[48:63], v[68:71], v[180:183], 0
    v_permlane32_swap_b32 v234, v235
    v_add_f32 v234, v234, v235
    s_waitcnt vmcnt(4) lgkmcnt(0)
    v_mfma_f32_32x32x16_bf16 v[0:15], v[72:75], v[184:187], v[0:15]
    ds_read_b64_tr_b16 v[176:177], v246 offset:4096
    ds_read_b64_tr_b16 v[178:179], v246 offset:4608
    ds_read_b64_tr_b16 v[180:181], v247 offset:4096
    ds_read_b64_tr_b16 v[182:183], v247 offset:4608
    s_mov_b32 m0, s69
    v_mfma_f32_32x32x16_bf16 v[16:31], v[76:79], v[184:187], v[16:31]
    buffer_load_dwordx4 v224, s[4:7], s43 offen lds
    buffer_load_dwordx4 v225, s[72:75], s43 offen offset:1024 lds
    v_mfma_f32_32x32x16_bf16 v[32:47], v[72:75], v[188:191], v[32:47]
    v_mfma_f32_32x32x16_bf16 v[48:63], v[76:79], v[188:191], v[48:63]
    s_waitcnt vmcnt(4) lgkmcnt(0)
    v_mfma_f32_32x32x16_bf16 v[0:15], v[80:83], v[176:179], v[0:15]
    ds_read_b64_tr_b16 v[184:185], v246 offset:6144
    ds_read_b64_tr_b16 v[186:187], v246 offset:6656
    ds_read_b64_tr_b16 v[188:189], v247 offset:6144
    ds_read_b64_tr_b16 v[190:191], v247 offset:6656
    s_mov_b32 m0, s70
    v_mfma_f32_32x32x16_bf16 v[16:31], v[84:87], v[176:179], v[16:31]
    buffer_load_dwordx4 v226, s[4:7], s43 offen lds
    buffer_load_dwordx4 v227, s[72:75], s43 offen offset:1024 lds
    v_mfma_f32_32x32x16_bf16 v[32:47], v[80:83], v[180:183], v[32:47]
    v_add_u32 v222, s48, v251
    ds_read_b32 v222, v222
    v_mfma_f32_32x32x16_bf16 v[48:63], v[84:87], v[180:183], v[48:63]
    s_waitcnt vmcnt(4) lgkmcnt(1)
    v_mfma_f32_32x32x16_bf16 v[0:15], v[88:91], v[184:187], v[0:15]
    ds_read_b64_tr_b16 v[176:177], v246 offset:0
    ds_read_b64_tr_b16 v[178:179], v246 offset:512
    ds_read_b64_tr_b16 v[180:181], v247 offset:0
    ds_read_b64_tr_b16 v[182:183], v247 offset:512
    s_mov_b32 m0, s71
    v_mfma_f32_32x32x16_bf16 v[16:31], v[92:95], v[184:187], v[16:31]
    buffer_load_dwordx4 v228, s[4:7], s43 offen lds
    buffer_load_dwordx4 v229, s[72:75], s43 offen offset:1024 lds
    s_waitcnt lgkmcnt(4)
    v_mad_u32_u16 v223, v222, s39, v248 op_sel:[1,0,0,0]
    v_mad_u32_u16 v222, v222, s39, v248
    v_mfma_f32_32x32x16_bf16 v[32:47], v[88:91], v[188:191], v[32:47]
    v_add_u32 v224, s49, v251
    ds_read_b32 v224, v224
    v_mul_f32 v242, v0, v144
    v_fma_f32 v238, v8, v160, -v238
    v_fmac_f32 v242, v1, v145
    v_fmac_f32 v238, v9, v161
    v_fmac_f32 v242, v2, v146
    v_mfma_f32_32x32x16_bf16 v[48:63], v[92:95], v[188:191], v[48:63]
    s_setprio 0
    v_fmac_f32 v238, v10, v162
    v_fmac_f32 v242, v3, v147
    v_fmac_f32 v238, v11, v163
    v_fmac_f32 v242, v4, v148
    v_fmac_f32 v238, v12, v164
    v_fmac_f32 v242, v5, v149
    v_fmac_f32 v238, v13, v165
    v_fmac_f32 v242, v6, v150
    v_fmac_f32 v238, v14, v166
    v_fmac_f32 v242, v7, v151
    v_fmac_f32 v238, v15, v167
    v_fmac_f32 v236, v16, v112
    v_mul_f32 v244, v24, v160
    v_fmac_f32 v236, v17, v113
    v_fmac_f32 v244, v25, v161
    v_fmac_f32 v236, v18, v114
    v_fmac_f32 v244, v26, v162
    v_fmac_f32 v236, v19, v115
    v_fmac_f32 v244, v27, v163
    v_fmac_f32 v236, v20, v116
    v_fmac_f32 v244, v28, v164
    v_fmac_f32 v236, v21, v117
    v_fmac_f32 v244, v29, v165
    v_fmac_f32 v236, v22, v118
    v_fmac_f32 v244, v30, v166
    v_fmac_f32 v236, v23, v119
    v_fmac_f32 v244, v31, v167
    v_mul_f32 v243, v32, v152
    v_fma_f32 v239, v40, v168, -v239
    v_fmac_f32 v243, v33, v153
    v_fmac_f32 v239, v41, v169
    v_fmac_f32 v243, v34, v154
    v_fmac_f32 v239, v42, v170
    v_fmac_f32 v243, v35, v155
    v_fmac_f32 v239, v43, v171
    v_fmac_f32 v243, v36, v156
    v_fmac_f32 v239, v44, v172
    v_fmac_f32 v243, v37, v157
    v_fmac_f32 v239, v45, v173
    v_fmac_f32 v243, v38, v158
    v_fmac_f32 v239, v46, v174
    v_fmac_f32 v243, v39, v159
    v_fmac_f32 v239, v47, v175
    v_fmac_f32 v237, v48, v120
    v_mul_f32 v245, v56, v168
    v_fmac_f32 v237, v49, v121
    v_fmac_f32 v245, v57, v169
    v_fmac_f32 v237, v50, v122
    v_fmac_f32 v245, v58, v170
    v_fmac_f32 v237, v51, v123
    s_setprio 1
    s_waitcnt vmcnt(4) lgkmcnt(1)
    v_mfma_f32_32x32x16_bf16 v[0:15], v[64:67], v[176:179], 0
    ds_read_b64_tr_b16 v[184:185], v246 offset:2048
    ds_read_b64_tr_b16 v[186:187], v246 offset:2560
    ds_read_b64_tr_b16 v[188:189], v247 offset:2048
    ds_read_b64_tr_b16 v[190:191], v247 offset:2560
    v_fmac_f32 v245, v59, v171
    v_fmac_f32 v237, v52, v124
    s_mov_b32 m0, s68
    v_mfma_f32_32x32x16_bf16 v[16:31], v[68:71], v[176:179], 0
    buffer_load_dwordx4 v222, s[4:7], s44 offen lds
    buffer_load_dwordx4 v223, s[72:75], s44 offen offset:1024 lds
    s_waitcnt lgkmcnt(4)
    v_mad_u32_u16 v225, v224, s39, v248 op_sel:[1,0,0,0]
    v_mad_u32_u16 v224, v224, s39, v248
    v_fmac_f32 v245, v60, v172
    v_fmac_f32 v237, v53, v125
    v_mfma_f32_32x32x16_bf16 v[32:47], v[64:67], v[180:183], 0
    v_add_u32 v226, s50, v251
    ds_read_b32 v226, v226
    v_fmac_f32 v245, v61, v173
    v_fmac_f32 v237, v54, v126
    v_fmac_f32 v245, v62, v174
    v_fmac_f32 v237, v55, v127
    v_fmac_f32 v245, v63, v175
    v_mfma_f32_32x32x16_bf16 v[48:63], v[68:71], v[180:183], 0
    v_permlane32_swap_b32 v238, v239
    v_permlane32_swap_b32 v242, v243
    v_add_f32 v238, v238, v239
    v_add_f32 v242, v242, v243
    s_waitcnt vmcnt(4) lgkmcnt(1)
    v_mfma_f32_32x32x16_bf16 v[0:15], v[72:75], v[184:187], v[0:15]
    ds_read_b64_tr_b16 v[176:177], v246 offset:4096
    ds_read_b64_tr_b16 v[178:179], v246 offset:4608
    ds_read_b64_tr_b16 v[180:181], v247 offset:4096
    ds_read_b64_tr_b16 v[182:183], v247 offset:4608
    v_cvt_pk_bf16_f32 v234, v234, v242
    ds_write_b16 v230, v234 offset:384
    s_mov_b32 m0, s69
    v_mfma_f32_32x32x16_bf16 v[16:31], v[76:79], v[184:187], v[16:31]
    buffer_load_dwordx4 v224, s[4:7], s45 offen lds
    buffer_load_dwordx4 v225, s[72:75], s45 offen offset:1024 lds
    s_waitcnt lgkmcnt(5)
    v_mad_u32_u16 v227, v226, s39, v248 op_sel:[1,0,0,0]
    v_mad_u32_u16 v226, v226, s39, v248
    ds_write_b16_d16_hi v230, v234 offset:768
    v_mfma_f32_32x32x16_bf16 v[32:47], v[72:75], v[188:191], v[32:47]
    v_add_u32 v228, s51, v251
    ds_read_b32 v228, v228
    v_mfma_f32_32x32x16_bf16 v[48:63], v[76:79], v[188:191], v[48:63]
    s_waitcnt vmcnt(4) lgkmcnt(3)
    v_mfma_f32_32x32x16_bf16 v[0:15], v[80:83], v[176:179], v[0:15]
    ds_read_b64_tr_b16 v[184:185], v246 offset:6144
    ds_read_b64_tr_b16 v[186:187], v246 offset:6656
    ds_read_b64_tr_b16 v[188:189], v247 offset:6144
    ds_read_b64_tr_b16 v[190:191], v247 offset:6656
    s_mov_b32 m0, s70
    v_mfma_f32_32x32x16_bf16 v[16:31], v[84:87], v[176:179], v[16:31]
    buffer_load_dwordx4 v226, s[4:7], s46 offen lds
    buffer_load_dwordx4 v227, s[72:75], s46 offen offset:1024 lds
    s_waitcnt lgkmcnt(4)
    v_mad_u32_u16 v229, v228, s39, v248 op_sel:[1,0,0,0]
    v_mad_u32_u16 v228, v228, s39, v248
    v_mfma_f32_32x32x16_bf16 v[32:47], v[80:83], v[180:183], v[32:47]
    v_mfma_f32_32x32x16_bf16 v[48:63], v[84:87], v[180:183], v[48:63]
    s_waitcnt vmcnt(4) lgkmcnt(0)
    v_mfma_f32_32x32x16_bf16 v[0:15], v[88:91], v[184:187], v[0:15]
    ds_read_b64_tr_b16 v[176:177], v246 offset:0
    ds_read_b64_tr_b16 v[178:179], v246 offset:512
    ds_read_b64_tr_b16 v[180:181], v247 offset:0
    ds_read_b64_tr_b16 v[182:183], v247 offset:512
    s_mov_b32 m0, s71
    v_mfma_f32_32x32x16_bf16 v[16:31], v[92:95], v[184:187], v[16:31]
    buffer_load_dwordx4 v228, s[4:7], s47 offen lds
    buffer_load_dwordx4 v229, s[72:75], s47 offen offset:1024 lds
    v_mfma_f32_32x32x16_bf16 v[32:47], v[88:91], v[188:191], v[32:47]
    s_nop 2
    v_mul_f32 v242, v0, v144
    v_fma_f32 v240, v8, v160, -v240
    v_fmac_f32 v242, v1, v145
    v_fmac_f32 v240, v9, v161
    v_fmac_f32 v242, v2, v146
    v_fmac_f32 v240, v10, v162
    v_fmac_f32 v242, v3, v147
    v_mfma_f32_32x32x16_bf16 v[48:63], v[92:95], v[188:191], v[48:63]
    s_setprio 0
    v_fmac_f32 v240, v11, v163
    v_fmac_f32 v242, v4, v148
    v_fmac_f32 v240, v12, v164
    v_fmac_f32 v242, v5, v149
    v_fmac_f32 v240, v13, v165
    v_fmac_f32 v242, v6, v150
    v_fmac_f32 v240, v14, v166
    v_fmac_f32 v242, v7, v151
    v_fmac_f32 v240, v15, v167
    s_sub_u32 s58, s48, s29
    v_add_u32 v249, s58, v249
    v_add_u32 v250, s58, v250
    v_fma_f32 v244, v16, v160, -v244
    v_fmac_f32 v236, v24, v112
    v_fmac_f32 v244, v17, v161
    v_fmac_f32 v236, v25, v113
    v_fmac_f32 v244, v18, v162
    v_fmac_f32 v236, v26, v114
    v_fmac_f32 v244, v19, v163
    v_fmac_f32 v236, v27, v115
    v_fmac_f32 v244, v20, v164
    v_fmac_f32 v236, v28, v116
    v_fmac_f32 v244, v21, v165
    v_fmac_f32 v236, v29, v117
    v_fmac_f32 v244, v22, v166
    v_fmac_f32 v236, v30, v118
    v_fmac_f32 v244, v23, v167
    v_fmac_f32 v236, v31, v119
    ds_read_b64_tr_b16 v[0:1], v249 offset:0
    ds_read_b64_tr_b16 v[2:3], v249 offset:128
    ds_read_b128 v[4:7], v250 offset:0
    ds_read_b128 v[8:11], v250 offset:16
    ds_read_b128 v[12:15], v250 offset:128
    ds_read_b128 v[16:19], v250 offset:144
    v_mul_f32 v243, v32, v152
    v_fma_f32 v241, v40, v168, -v241
    v_fmac_f32 v243, v33, v153
    v_fmac_f32 v241, v41, v169
    v_fmac_f32 v243, v34, v154
    v_fmac_f32 v241, v42, v170
    v_fmac_f32 v243, v35, v155
    v_fmac_f32 v241, v43, v171
    v_fmac_f32 v243, v36, v156
    v_fmac_f32 v241, v44, v172
    v_fmac_f32 v243, v37, v157
    v_fmac_f32 v241, v45, v173
    v_fmac_f32 v243, v38, v158
    v_fmac_f32 v241, v46, v174
    v_fmac_f32 v243, v39, v159
    v_fmac_f32 v241, v47, v175
    ds_read_b64_tr_b16 v[20:21], v249 offset:800
    ds_read_b64_tr_b16 v[22:23], v249 offset:928
    ds_read_b128 v[24:27], v250 offset:800
    ds_read_b128 v[28:31], v250 offset:816
    ds_read_b128 v[32:35], v250 offset:928
    ds_read_b128 v[36:39], v250 offset:944
    v_fma_f32 v245, v48, v168, -v245
    v_fmac_f32 v237, v56, v120
    v_fmac_f32 v245, v49, v169
    v_fmac_f32 v237, v57, v121
    v_fmac_f32 v245, v50, v170
    v_fmac_f32 v237, v58, v122
    v_fmac_f32 v245, v51, v171
    v_fmac_f32 v237, v59, v123
    v_fmac_f32 v245, v52, v172
    v_fmac_f32 v237, v60, v124
    v_fmac_f32 v245, v53, v173
    v_fmac_f32 v237, v61, v125
    v_fmac_f32 v245, v54, v174
    v_fmac_f32 v237, v62, v126
    v_fmac_f32 v245, v55, v175
    v_fmac_f32 v237, v63, v127
    s_cmp_eq_u32 s36, 0
    s_cbranch_scc1 K2_TAIL
    s_mov_b32 s29, s48
    s_mov_b32 s32, s31
    s_mov_b32 s31, s35
    s_cmp_eq_u32 s33, 2
    s_cbranch_scc1 K2_U21
    s_cmp_eq_u32 s33, 3
    s_cbranch_scc1 K2_U31
    s_cmp_eq_u32 s33, 1
    s_cbranch_scc1 K2_U11
    s_branch K2_U41
K2_SWITCH:
    v_permlane32_swap_b32 v242, v243
    v_permlane32_swap_b32 v240, v241
    v_permlane32_swap_b32 v236, v237
    v_permlane32_swap_b32 v244, v245
    v_add_f32 v242, v242, v243
    v_add_f32 v240, -v240, -v241
    v_add_f32 v236, v236, v237
    v_add_f32 v244, v244, v245
    s_set_gpr_idx_on s31, gpr_idx(DST)
    s_nop 0
    v_cvt_pk_bf16_f32 v195, v242, v236
    v_cvt_pk_bf16_f32 v196, v244, v240
    v_cvt_pk_bf16_f32 v197, v238, v238
    s_set_gpr_idx_off
    s_cmp_eq_u32 s36, 0
    s_cbranch_scc1 K2_TAIL2
    v_lshlrev_b32 v254, 3, v252
    v_add_u32 v230, s35, v252
    s_mov_b32 s58, 6989824
    buffer_load_dwordx4 v[136:139], v254, s[8:11], s58 offen offset:0
    buffer_load_dwordx4 v[140:143], v254, s[8:11], s58 offen offset:1024
    buffer_load_dwordx4 v[144:147], v254, s[8:11], s58 offen offset:2048
    buffer_load_dwordx4 v[148:151], v254, s[8:11], s58 offen offset:3072
    s_mov_b32 s58, 6993920
    buffer_load_dwordx4 v[152:155], v254, s[8:11], s58 offen offset:0
    buffer_load_dwordx4 v[156:159], v254, s[8:11], s58 offen offset:1024
    buffer_load_dwordx4 v[160:163], v254, s[8:11], s58 offen offset:2048
    buffer_load_dwordx4 v[164:167], v254, s[8:11], s58 offen offset:3072
    s_mov_b32 s58, 6998016
    buffer_load_dwordx4 v[168:171], v254, s[8:11], s58 offen offset:0
    buffer_load_dwordx4 v[172:175], v254, s[8:11], s58 offen offset:1024
    s_movk_i32 s40, 128
    s_movk_i32 s41, 384
    s_movk_i32 s42, 640
    s_movk_i32 s43, 896
    s_waitcnt vmcnt(0)
    v_lshlrev_b32 v96, 16, v136
    v_and_b32 v97, 0xffff0000, v136
    v_lshlrev_b32 v98, 16, v137
    v_and_b32 v99, 0xffff0000, v137
    v_lshlrev_b32 v100, 16, v138
    v_and_b32 v101, 0xffff0000, v138
    v_lshlrev_b32 v102, 16, v139
    v_and_b32 v103, 0xffff0000, v139
    v_lshlrev_b32 v104, 16, v140
    v_and_b32 v105, 0xffff0000, v140
    v_lshlrev_b32 v106, 16, v141
    v_and_b32 v107, 0xffff0000, v141
    v_lshlrev_b32 v108, 16, v142
    v_and_b32 v109, 0xffff0000, v142
    v_lshlrev_b32 v110, 16, v143
    v_and_b32 v111, 0xffff0000, v143
    v_lshlrev_b32 v112, 16, v144
    v_and_b32 v113, 0xffff0000, v144
    v_lshlrev_b32 v114, 16, v145
    v_and_b32 v115, 0xffff0000, v145
    v_lshlrev_b32 v116, 16, v146
    v_and_b32 v117, 0xffff0000, v146
    v_lshlrev_b32 v118, 16, v147
    v_and_b32 v119, 0xffff0000, v147
    v_lshlrev_b32 v120, 16, v148
    v_and_b32 v121, 0xffff0000, v148
    v_lshlrev_b32 v122, 16, v149
    v_and_b32 v123, 0xffff0000, v149
    v_lshlrev_b32 v124, 16, v150
    v_and_b32 v125, 0xffff0000, v150
    v_lshlrev_b32 v126, 16, v151
    v_and_b32 v127, 0xffff0000, v151
    v_lshlrev_b32 v128, 16, v152
    v_and_b32 v129, 0xffff0000, v152
    v_lshlrev_b32 v130, 16, v153
    v_and_b32 v131, 0xffff0000, v153
    v_lshlrev_b32 v132, 16, v154
    v_and_b32 v133, 0xffff0000, v154
    v_lshlrev_b32 v134, 16, v155
    v_and_b32 v135, 0xffff0000, v155
    v_lshlrev_b32 v136, 16, v156
    v_and_b32 v137, 0xffff0000, v156
    v_lshlrev_b32 v138, 16, v157
    v_and_b32 v139, 0xffff0000, v157
    v_lshlrev_b32 v140, 16, v158
    v_and_b32 v141, 0xffff0000, v158
    v_lshlrev_b32 v142, 16, v159
    v_and_b32 v143, 0xffff0000, v159
    v_lshlrev_b32 v144, 16, v160
    v_and_b32 v145, 0xffff0000, v160
    v_lshlrev_b32 v146, 16, v161
    v_and_b32 v147, 0xffff0000, v161
    v_lshlrev_b32 v148, 16, v162
    v_and_b32 v149, 0xffff0000, v162
    v_lshlrev_b32 v150, 16, v163
    v_and_b32 v151, 0xffff0000, v163
    v_lshlrev_b32 v152, 16, v164
    v_and_b32 v153, 0xffff0000, v164
    v_lshlrev_b32 v154, 16, v165
    v_and_b32 v155, 0xffff0000, v165
    v_lshlrev_b32 v156, 16, v166
    v_and_b32 v157, 0xffff0000, v166
    v_lshlrev_b32 v158, 16, v167
    v_and_b32 v159, 0xffff0000, v167
    v_lshlrev_b32 v160, 16, v168
    v_and_b32 v161, 0xffff0000, v168
    v_lshlrev_b32 v162, 16, v169
    v_and_b32 v163, 0xffff0000, v169
    v_lshlrev_b32 v164, 16, v170
    v_and_b32 v165, 0xffff0000, v170
    v_lshlrev_b32 v166, 16, v171
    v_and_b32 v167, 0xffff0000, v171
    v_lshlrev_b32 v168, 16, v172
    v_and_b32 v169, 0xffff0000, v172
    v_lshlrev_b32 v170, 16, v173
    v_and_b32 v171, 0xffff0000, v173
    v_lshlrev_b32 v172, 16, v174
    v_and_b32 v173, 0xffff0000, v174
    v_lshlrev_b32 v174, 16, v175
    v_and_b32 v175, 0xffff0000, v175
    s_mov_b32 s29, s48
    s_mov_b32 s32, s31
    s_mov_b32 s31, s35
    s_cmp_eq_u32 s33, 2
    s_cbranch_scc1 K2_U21
    s_cmp_eq_u32 s33, 3
    s_cbranch_scc1 K2_U31
    s_cmp_eq_u32 s33, 1
    s_cbranch_scc1 K2_U11
    s_branch K2_U41
K2_rare_11:
    s_cmp_eq_u32 s33, 4
    s_cbranch_scc1 K2_four_13
    s_mov_b32 s49, s48
    s_mov_b32 s51, s48
    s_add_u32 s45, s44, 256
    s_add_u32 s46, s44, 512
    s_add_u32 s47, s44, 768
    s_branch K2_back_12
K2_four_13:
    s_add_u32 s50, s48, 1600
    s_add_u32 s51, s48, 2400
    s_mov_b32 s46, s44
    s_mov_b32 s47, s44
    s_branch K2_back_12
K2_dum_14:
    v_mov_b32 v232, -1
    s_mov_b32 m0, 162432
    s_mov_b64 exec, 1
    buffer_load_dwordx4 v232, s[16:19], 0 offen lds
    buffer_load_dwordx4 v232, s[16:19], 0 offen lds
    buffer_load_dwordx4 v232, s[16:19], 0 offen lds
    s_mov_b64 exec, -1
    s_branch K2_back_16
K2_a4_15:
    s_add_u32 m0, s50, 288
    s_nop 0
    buffer_load_dwordx4 v233, s[16:19], 0 offen  lds
    s_branch K2_b4_17
K2_nul_20:
    s_mov_b32 s58, 63
    s_mov_b32 s36, 0
    s_branch K2_back_23
K2_spin_21:
    v_lshl_add_u32 v233, v252, 1, s53
    ds_read_b32 v233, v233
    s_waitcnt lgkmcnt(0)
    s_branch K2_chk_22
K2_dyn_18:
    v_mov_b32 v254, 162048
    v_mov_b32 v255, 1
    v_lshl_add_u32 v233, v252, 1, s53
    s_mov_b64 exec, 1
    ds_add_rtn_u32 v232, v254, v255
    s_mov_b64 exec, -1
    ds_read_b32 v233, v233
    s_waitcnt lgkmcnt(0)
    v_readfirstlane_b32 s58, v232
    s_nop 0
    s_cmp_lt_u32 s58, s22
    s_cbranch_scc0 K2_nul_20
    s_and_b32 s59, s58, 7
    s_lshr_b32 s60, s58, 3
K2_chk_22:
    v_readlane_b32 s61, v233, s59
    s_nop 0
    s_cmp_gt_u32 s61, s60
    s_cbranch_scc0 K2_spin_21
K2_back_23:
    s_mov_b32 s34, 1
    s_branch K2_back_19
K2_rare_24:
    s_cmp_eq_u32 s33, 4
    s_cbranch_scc1 K2_four_26
    s_mov_b32 s49, s48
    s_mov_b32 s51, s48
    s_add_u32 s45, s44, 256
    s_add_u32 s46, s44, 512
    s_add_u32 s47, s44, 768
    s_branch K2_back_25
K2_four_26:
    s_add_u32 s50, s48, 1600
    s_add_u32 s51, s48, 2400
    s_mov_b32 s46, s44
    s_mov_b32 s47, s44
    s_branch K2_back_25
K2_dum_27:
    v_mov_b32 v232, -1
    s_mov_b32 m0, 162432
    s_mov_b64 exec, 1
    buffer_load_dwordx4 v232, s[16:19], 0 offen lds
    buffer_load_dwordx4 v232, s[16:19], 0 offen lds
    buffer_load_dwordx4 v232, s[16:19], 0 offen lds
    s_mov_b64 exec, -1
    s_branch K2_back_29
K2_a4_28:
    s_add_u32 m0, s50, 288
    s_nop 0
    buffer_load_dwordx4 v233, s[16:19], 0 offen  lds
    s_branch K2_b4_30
K2_nul_33:
    s_mov_b32 s58, 63
    s_mov_b32 s36, 0
    s_branch K2_back_36
K2_spin_34:
    v_lshl_add_u32 v233, v252, 1, s53
    ds_read_b32 v233, v233
    s_waitcnt lgkmcnt(0)
    s_branch K2_chk_35
K2_dyn_31:
    v_mov_b32 v254, 162048
    v_mov_b32 v255, 1
    v_lshl_add_u32 v233, v252, 1, s53
    s_mov_b64 exec, 1
    ds_add_rtn_u32 v232, v254, v255
    s_mov_b64 exec, -1
    ds_read_b32 v233, v233
    s_waitcnt lgkmcnt(0)
    v_readfirstlane_b32 s58, v232
    s_nop 0
    s_cmp_lt_u32 s58, s22
    s_cbranch_scc0 K2_nul_33
    s_and_b32 s59, s58, 7
    s_lshr_b32 s60, s58, 3
K2_chk_35:
    v_readlane_b32 s61, v233, s59
    s_nop 0
    s_cmp_gt_u32 s61, s60
    s_cbranch_scc0 K2_spin_34
K2_back_36:
    s_mov_b32 s34, 1
    s_branch K2_back_32
K2_rare_37:
    s_cmp_eq_u32 s33, 4
    s_cbranch_scc1 K2_four_39
    s_mov_b32 s49, s48
    s_mov_b32 s51, s48
    s_add_u32 s45, s44, 256
    s_add_u32 s46, s44, 512
    s_add_u32 s47, s44, 768
    s_branch K2_back_38
K2_four_39:
    s_add_u32 s50, s48, 1600
    s_add_u32 s51, s48, 2400
    s_mov_b32 s46, s44
    s_mov_b32 s47, s44
    s_branch K2_back_38
K2_dum_40:
    v_mov_b32 v232, -1
    s_mov_b32 m0, 162432
    s_mov_b64 exec, 1
    buffer_load_dwordx4 v232, s[16:19], 0 offen lds
    buffer_load_dwordx4 v232, s[16:19], 0 offen lds
    buffer_load_dwordx4 v232, s[16:19], 0 offen lds
    s_mov_b64 exec, -1
    s_branch K2_back_42
K2_a4_41:
    s_add_u32 m0, s50, 288
    s_nop 0
    buffer_load_dwordx4 v233, s[16:19], 0 offen  lds
    s_branch K2_b4_43
K2_nul_44:
    s_mov_b32 s58, 63
    s_mov_b32 s36, 0
    s_branch K2_back_47
K2_spin_45:
    v_lshl_add_u32 v233, v252, 1, s53
    ds_read_b32 v233, v233
    s_waitcnt lgkmcnt(0)
    s_branch K2_chk_46
K2_rare_48:
    s_cmp_eq_u32 s33, 4
    s_cbranch_scc1 K2_four_50
    s_mov_b32 s49, s48
    s_mov_b32 s51, s48
    s_add_u32 s45, s44, 256
    s_add_u32 s46, s44, 512
    s_add_u32 s47, s44, 768
    s_branch K2_back_49
K2_four_50:
    s_add_u32 s50, s48, 1600
    s_add_u32 s51, s48, 2400
    s_mov_b32 s46, s44
    s_mov_b32 s47, s44
    s_branch K2_back_49
K2_nul_51:
    s_mov_b32 s58, 63
    s_mov_b32 s36, 0
    s_branch K2_back_54
K2_spin_52:
    v_lshl_add_u32 v233, v252, 1, s53
    ds_read_b32 v233, v233
    s_waitcnt lgkmcnt(0)
    s_branch K2_chk_53
K2_rare_55:
    s_cmp_eq_u32 s33, 4
    s_cbranch_scc1 K2_four_57
    s_mov_b32 s49, s48
    s_mov_b32 s51, s48
    s_add_u32 s45, s44, 256
    s_add_u32 s46, s44, 512
    s_add_u32 s47, s44, 768
    s_branch K2_back_56
K2_four_57:
    s_add_u32 s50, s48, 1600
    s_add_u32 s51, s48, 2400
    s_mov_b32 s46, s44
    s_mov_b32 s47, s44
    s_branch K2_back_56
K2_nul_60:
    s_mov_b32 s58, 63
    s_mov_b32 s36, 0
    s_branch K2_back_63
K2_spin_61:
    v_lshl_add_u32 v233, v252, 1, s53
    ds_read_b32 v233, v233
    s_waitcnt lgkmcnt(0)
    s_branch K2_chk_62
K2_dyn_58:
    v_mov_b32 v254, 162048
    v_mov_b32 v255, 1
    v_lshl_add_u32 v233, v252, 1, s53
    s_mov_b64 exec, 1
    ds_add_rtn_u32 v232, v254, v255
    s_mov_b64 exec, -1
    ds_read_b32 v233, v233
    s_waitcnt lgkmcnt(0)
    v_readfirstlane_b32 s58, v232
    s_nop 0
    s_cmp_lt_u32 s58, s22
    s_cbranch_scc0 K2_nul_60
    s_and_b32 s59, s58, 7
    s_lshr_b32 s60, s58, 3
K2_chk_62:
    v_readlane_b32 s61, v233, s59
    s_nop 0
    s_cmp_gt_u32 s61, s60
    s_cbranch_scc0 K2_spin_61
K2_back_63:
    s_mov_b32 s34, 1
    s_branch K2_back_59
K2_rare_64:
    s_cmp_eq_u32 s33, 4
    s_cbranch_scc1 K2_four_66
    s_mov_b32 s49, s48
    s_mov_b32 s51, s48
    s_add_u32 s45, s44, 256
    s_add_u32 s46, s44, 512
    s_add_u32 s47, s44, 768
    s_branch K2_back_65
K2_four_66:
    s_add_u32 s50, s48, 1600
    s_add_u32 s51, s48, 2400
    s_mov_b32 s46, s44
    s_mov_b32 s47, s44
    s_branch K2_back_65
K2_dum_67:
    v_mov_b32 v232, -1
    s_mov_b32 m0, 162432
    s_mov_b64 exec, 1
    buffer_load_dwordx4 v232, s[16:19], 0 offen lds
    buffer_load_dwordx4 v232, s[16:19], 0 offen lds
    buffer_load_dwordx4 v232, s[16:19], 0 offen lds
    s_mov_b64 exec, -1
    s_branch K2_back_69
K2_a4_68:
    s_add_u32 m0, s50, 288
    s_nop 0
    buffer_load_dwordx4 v233, s[16:19], 0 offen  lds
    s_branch K2_b4_70
K2_nul_73:
    s_mov_b32 s58, 63
    s_mov_b32 s36, 0
    s_branch K2_back_76
K2_spin_74:
    v_lshl_add_u32 v233, v252, 1, s53
    ds_read_b32 v233, v233
    s_waitcnt lgkmcnt(0)
    s_branch K2_chk_75
K2_dyn_71:
    v_mov_b32 v254, 162048
    v_mov_b32 v255, 1
    v_lshl_add_u32 v233, v252, 1, s53
    s_mov_b64 exec, 1
    ds_add_rtn_u32 v232, v254, v255
    s_mov_b64 exec, -1
    ds_read_b32 v233, v233
    s_waitcnt lgkmcnt(0)
    v_readfirstlane_b32 s58, v232
    s_nop 0
    s_cmp_lt_u32 s58, s22
    s_cbranch_scc0 K2_nul_73
    s_and_b32 s59, s58, 7
    s_lshr_b32 s60, s58, 3
K2_chk_75:
    v_readlane_b32 s61, v233, s59
    s_nop 0
    s_cmp_gt_u32 s61, s60
    s_cbranch_scc0 K2_spin_74
K2_back_76:
    s_mov_b32 s34, 1
    s_branch K2_back_72
K2_rare_77:
    s_cmp_eq_u32 s33, 4
    s_cbranch_scc1 K2_four_79
    s_mov_b32 s49, s48
    s_mov_b32 s51, s48
    s_add_u32 s45, s44, 256
    s_add_u32 s46, s44, 512
    s_add_u32 s47, s44, 768
    s_branch K2_back_78
K2_four_79:
    s_add_u32 s50, s48, 1600
    s_add_u32 s51, s48, 2400
    s_mov_b32 s46, s44
    s_mov_b32 s47, s44
    s_branch K2_back_78
K2_dum_80:
    v_mov_b32 v232, -1
    s_mov_b32 m0, 162432
    s_mov_b64 exec, 1
    buffer_load_dwordx4 v232, s[16:19], 0 offen lds
    buffer_load_dwordx4 v232, s[16:19], 0 offen lds
    buffer_load_dwordx4 v232, s[16:19], 0 offen lds
    s_mov_b64 exec, -1
    s_branch K2_back_82
K2_a4_81:
    s_add_u32 m0, s50, 288
    s_nop 0
    buffer_load_dwordx4 v233, s[16:19], 0 offen  lds
    s_branch K2_b4_83
K2_nul_84:
    s_mov_b32 s58, 63
    s_mov_b32 s36, 0
    s_branch K2_back_87
K2_spin_85:
    v_lshl_add_u32 v233, v252, 1, s53
    ds_read_b32 v233, v233
    s_waitcnt lgkmcnt(0)
    s_branch K2_chk_86
K2_rare_88:
    s_cmp_eq_u32 s33, 4
    s_cbranch_scc1 K2_four_90
    s_mov_b32 s49, s48
    s_mov_b32 s51, s48
    s_add_u32 s45, s44, 256
    s_add_u32 s46, s44, 512
    s_add_u32 s47, s44, 768
    s_branch K2_back_89
K2_four_90:
    s_add_u32 s50, s48, 1600
    s_add_u32 s51, s48, 2400
    s_mov_b32 s46, s44
    s_mov_b32 s47, s44
    s_branch K2_back_89
K2_nul_91:
    s_mov_b32 s58, 63
    s_mov_b32 s36, 0
    s_branch K2_back_94
K2_spin_92:
    v_lshl_add_u32 v233, v252, 1, s53
    ds_read_b32 v233, v233
    s_waitcnt lgkmcnt(0)
    s_branch K2_chk_93
K2_rare_95:
    s_cmp_eq_u32 s33, 4
    s_cbranch_scc1 K2_four_97
    s_mov_b32 s49, s48
    s_mov_b32 s51, s48
    s_add_u32 s45, s44, 256
    s_add_u32 s46, s44, 512
    s_add_u32 s47, s44, 768
    s_branch K2_back_96
K2_four_97:
    s_add_u32 s50, s48, 1600
    s_add_u32 s51, s48, 2400
    s_mov_b32 s46, s44
    s_mov_b32 s47, s44
    s_branch K2_back_96
K2_TAIL:
    v_permlane32_swap_b32 v242, v243
    v_permlane32_swap_b32 v240, v241
    v_permlane32_swap_b32 v236, v237
    v_permlane32_swap_b32 v244, v245
    v_add_f32 v242, v242, v243
    v_add_f32 v240, -v240, -v241
    v_add_f32 v236, v236, v237
    v_add_f32 v244, v244, v245
    v_cvt_pk_bf16_f32 v242, v242, v236
    v_cvt_pk_bf16_f32 v244, v244, v240
    v_cvt_pk_bf16_f32 v238, v238, v238
    ds_write_b16 v230, v242 offset:1152
    ds_write_b16_d16_hi v230, v242 offset:128
    ds_write_b16 v230, v244 offset:512
    ds_write_b16_d16_hi v230, v244 offset:896
    ds_write_b16 v230, v238 offset:1280
K2_TAIL2:
    v_lshlrev_b32 v229, 3, v252
    s_mul_i32 s58, s20, 20480
    s_add_u32 s58, s58, 6815744
    s_mul_i32 s59, s20, 8224
    v_add_u32 v228, s59, v252
    s_waitcnt vmcnt(0)
    buffer_load_dwordx4 v[96:99], v229, s[8:11], s58 offen offset:0
    ds_write_b16 v228, v192 offset:0
    ds_write_b16_d16_hi v228, v192 offset:256
    ds_write_b16 v228, v193 offset:640
    buffer_load_dwordx4 v[100:103], v229, s[8:11], s58 offen offset:1024
    ds_write_b16_d16_hi v228, v193 offset:1024
    ds_write_b16 v228, v194 offset:384
    ds_write_b16_d16_hi v228, v194 offset:768
    buffer_load_dwordx4 v[104:107], v229, s[8:11], s58 offen offset:2048
    ds_write_b16 v228, v195 offset:1152
    ds_write_b16_d16_hi v228, v195 offset:128
    ds_write_b16 v228, v196 offset:512
    buffer_load_dwordx4 v[108:111], v229, s[8:11], s58 offen offset:3072
    s_add_u32 s58, s58, 4096
    ds_write_b16_d16_hi v228, v196 offset:896
    ds_write_b16 v228, v197 offset:1280
    ds_write_b16 v228, v198 offset:1536
    buffer_load_dwordx4 v[112:115], v229, s[8:11], s58 offen offset:0
    ds_write_b16_d16_hi v228, v198 offset:1792
    ds_write_b16 v228, v199 offset:2176
    ds_write_b16_d16_hi v228, v199 offset:2560
    buffer_load_dwordx4 v[116:119], v229, s[8:11], s58 offen offset:1024
    ds_write_b16 v228, v200 offset:1920
    ds_write_b16_d16_hi v228, v200 offset:2304
    ds_write_b16 v228, v201 offset:2688
    buffer_load_dwordx4 v[120:123], v229, s[8:11], s58 offen offset:2048
    ds_write_b16_d16_hi v228, v201 offset:1664
    ds_write_b16 v228, v202 offset:2048
    ds_write_b16_d16_hi v228, v202 offset:2432
    buffer_load_dwordx4 v[124:127], v229, s[8:11], s58 offen offset:3072
    s_add_u32 s58, s58, 4096
    ds_write_b16 v228, v203 offset:2816
    ds_write_b16 v228, v204 offset:3072
    ds_write_b16_d16_hi v228, v204 offset:3328
    buffer_load_dwordx4 v[128:131], v229, s[8:11], s58 offen offset:0
    ds_write_b16 v228, v205 offset:3712
    ds_write_b16_d16_hi v228, v205 offset:4096
    ds_write_b16 v228, v206 offset:3456
    buffer_load_dwordx4 v[132:135], v229, s[8:11], s58 offen offset:1024
    ds_write_b16_d16_hi v228, v206 offset:3840
    ds_write_b16 v228, v207 offset:4224
    ds_write_b16_d16_hi v228, v207 offset:3200
    buffer_load_dwordx4 v[136:139], v229, s[8:11], s58 offen offset:2048
    ds_write_b16 v228, v208 offset:3584
    ds_write_b16_d16_hi v228, v208 offset:3968
    ds_write_b16 v228, v209 offset:4352
    buffer_load_dwordx4 v[140:143], v229, s[8:11], s58 offen offset:3072
    s_add_u32 s58, s58, 4096
    ds_write_b16 v228, v210 offset:4608
    ds_write_b16_d16_hi v228, v210 offset:4864
    ds_write_b16 v228, v211 offset:5248
    buffer_load_dwordx4 v[144:147], v229, s[8:11], s58 offen offset:0
    ds_write_b16_d16_hi v228, v211 offset:5632
    ds_write_b16 v228, v212 offset:4992
    ds_write_b16_d16_hi v228, v212 offset:5376
    buffer_load_dwordx4 v[148:151], v229, s[8:11], s58 offen offset:1024
    ds_write_b16 v228, v213 offset:5760
    ds_write_b16_d16_hi v228, v213 offset:4736
    ds_write_b16 v228, v214 offset:5120
    buffer_load_dwordx4 v[152:155], v229, s[8:11], s58 offen offset:2048
    ds_write_b16_d16_hi v228, v214 offset:5504
    ds_write_b16 v228, v215 offset:5888
    ds_write_b16 v228, v216 offset:6144
    buffer_load_dwordx4 v[156:159], v229, s[8:11], s58 offen offset:3072
    s_add_u32 s58, s58, 4096
    ds_write_b16_d16_hi v228, v216 offset:6400
    ds_write_b16 v228, v217 offset:6784
    ds_write_b16_d16_hi v228, v217 offset:7168
    buffer_load_dwordx4 v[160:163], v229, s[8:11], s58 offen offset:0
    ds_write_b16 v228, v218 offset:6528
    ds_write_b16_d16_hi v228, v218 offset:6912
    ds_write_b16 v228, v219 offset:7296
    buffer_load_dwordx4 v[164:167], v229, s[8:11], s58 offen offset:1024
    ds_write_b16_d16_hi v228, v219 offset:6272
    ds_write_b16 v228, v220 offset:6656
    ds_write_b16_d16_hi v228, v220 offset:7040
    buffer_load_dwordx4 v[168:171], v229, s[8:11], s58 offen offset:2048
    ds_write_b16 v228, v221 offset:7424
    buffer_load_dwordx4 v[172:175], v229, s[8:11], s58 offen offset:3072
    v_bfe_u32 v48, v252, 1, 4
    v_lshlrev_b32 v49, 2, v48
    v_add_u32 v50, 64, v49
    v_add_u32 v51, 128, v49
    ds_bpermute_b32 v223, v49, v253
    ds_bpermute_b32 v224, v50, v253
    ds_bpermute_b32 v225, v51, v253
    v_lshrrev_b32 v49, 5, v252
    v_and_b32 v50, 7, v48
    v_mul_u32_u24 v50, 8224, v50
    v_lshrrev_b32 v51, 3, v48
    v_mul_u32_u24 v51, 1536, v51
    v_add_u32 v50, v50, v51
    v_lshlrev_b32 v52, 4, v49
    v_add_u32 v222, v50, v52
    s_lshl_b32 s60, s20, 5
    v_lshl_add_u32 v51, v49, 3, s60
    v_bfe_u32 v53, v48, 2, 1
    v_lshl_add_u32 v51, v53, 4, v51
    v_add_u32 v226, v50, v51
    s_sub_u32 s60, s22, 32
    v_cmp_gt_u32 s[56:57], s60, v48
    s_bfe_u32 s60, s20, 0x10002
    s_lshl_b32 s60, s60, 4
    s_add_u32 s59, s59, s60
    s_add_u32 s24, s24, 1
    s_cmp_ge_u32 s24, s25
    s_cselect_b32 s55, 1, 0
    s_cmp_eq_u32 s27, 0
    s_cselect_b32 s55, s55, 0
    s_and_b32 s64, s55, s28
    s_add_u32 s62, s21, s20
    s_lshl_b32 s62, s62, 10
    s_mov_b32 s63, 0xbfb8aa3b
    s_waitcnt lgkmcnt(0)
    v_add_u32 v228, s59, v229
    v_lshrrev_b32 v50, 21, v223
    v_and_b32 v51, 0x3ffff, v223
    v_add3_u32 v223, v50, v51, v52
    v_lshrrev_b32 v50, 21, v224
    v_and_b32 v51, 0x3ffff, v224
    v_add3_u32 v224, v50, v51, v52
    v_lshrrev_b32 v50, 21, v225
    v_and_b32 v51, 0x3ffff, v225
    v_add3_u32 v225, v50, v51, v52
    s_barrier
    s_cmp_eq_u32 s64, 0
    s_cbranch_scc1 K2_MULTI
    ds_read_b128 v[48:51], v222 offset:0
    ds_read_b128 v[52:55], v222 offset:64
    ds_read_b128 v[56:59], v222 offset:128
    ds_read_b128 v[60:63], v222 offset:192
    ds_read_b128 v[64:67], v223 offset:0
    ds_read_b128 v[68:71], v223 offset:64
    ds_read_b128 v[72:75], v223 offset:128
    ds_read_b128 v[76:79], v223 offset:192
    ds_read_b128 v[80:83], v222 offset:256
    ds_read_b128 v[84:87], v222 offset:640
    ds_read_b128 v[88:91], v222 offset:1024
    s_waitcnt vmcnt(19) lgkmcnt(10)
    v_mfma_f32_16x16x32_bf16 v[0:3], v[96:99], v[48:51], 0
    ds_read_b128 v[92:95], v222 offset:320
    s_waitcnt vmcnt(18) lgkmcnt(10)
    v_mfma_f32_16x16x32_bf16 v[0:3], v[100:103], v[52:55], v[0:3]
    ds_read_b128 v[48:51], v222 offset:704
    s_waitcnt vmcnt(17) lgkmcnt(10)
    v_mfma_f32_16x16x32_bf16 v[0:3], v[104:107], v[56:59], v[0:3]
    ds_read_b128 v[52:55], v222 offset:1088
    s_waitcnt vmcnt(16) lgkmcnt(10)
    v_mfma_f32_16x16x32_bf16 v[0:3], v[108:111], v[60:63], v[0:3]
    ds_read_b128 v[56:59], v222 offset:384
    s_waitcnt vmcnt(15) lgkmcnt(10)
    v_mfma_f32_16x16x32_bf16 v[0:3], v[112:115], v[64:67], v[0:3]
    ds_read_b128 v[60:63], v222 offset:768
    s_waitcnt vmcnt(14) lgkmcnt(10)
    v_mfma_f32_16x16x32_bf16 v[0:3], v[116:119], v[68:71], v[0:3]
    ds_read_b128 v[64:67], v222 offset:1152
    s_waitcnt vmcnt(13) lgkmcnt(10)
    v_mfma_f32_16x16x32_bf16 v[0:3], v[120:123], v[72:75], v[0:3]
    ds_read_b128 v[68:71], v222 offset:448
    s_waitcnt vmcnt(12) lgkmcnt(10)
    v_mfma_f32_16x16x32_bf16 v[0:3], v[124:127], v[76:79], v[0:3]
    ds_read_b128 v[72:75], v222 offset:832
    s_waitcnt vmcnt(11) lgkmcnt(10)
    v_mfma_f32_16x16x32_bf16 v[4:7], v[128:131], v[80:83], 0
    ds_read_b128 v[76:79], v222 offset:1216
    s_waitcnt lgkmcnt(10)
    v_mfma_f32_16x16x32_bf16 v[8:11], v[128:131], v[84:87], 0
    ds_read_b128 v[80:83], v222 offset:512
    s_waitcnt lgkmcnt(10)
    v_mfma_f32_16x16x32_bf16 v[12:15], v[128:131], v[88:91], 0
    ds_read_b128 v[84:87], v222 offset:896
    s_waitcnt vmcnt(10) lgkmcnt(10)
    v_mfma_f32_16x16x32_bf16 v[4:7], v[132:135], v[92:95], v[4:7]
    ds_read_b128 v[88:91], v222 offset:1280
    s_waitcnt lgkmcnt(10)
    v_mfma_f32_16x16x32_bf16 v[8:11], v[132:135], v[48:51], v[8:11]
    ds_read_b128 v[92:95], v222 offset:576
    s_waitcnt lgkmcnt(10)
    v_mfma_f32_16x16x32_bf16 v[12:15], v[132:135], v[52:55], v[12:15]
    ds_read_b128 v[48:51], v222 offset:960
    s_waitcnt vmcnt(9) lgkmcnt(10)
    v_mfma_f32_16x16x32_bf16 v[4:7], v[136:139], v[56:59], v[4:7]
    ds_read_b128 v[52:55], v222 offset:1344
    s_waitcnt lgkmcnt(10)
    v_mfma_f32_16x16x32_bf16 v[8:11], v[136:139], v[60:63], v[8:11]
    ds_read_b128 v[56:59], v223 offset:256
    s_waitcnt lgkmcnt(10)
    v_mfma_f32_16x16x32_bf16 v[12:15], v[136:139], v[64:67], v[12:15]
    ds_read_b128 v[60:63], v223 offset:640
    s_waitcnt vmcnt(8) lgkmcnt(10)
    v_mfma_f32_16x16x32_bf16 v[4:7], v[140:143], v[68:71], v[4:7]
    ds_read_b128 v[64:67], v223 offset:1024
    s_waitcnt lgkmcnt(10)
    v_mfma_f32_16x16x32_bf16 v[8:11], v[140:143], v[72:75], v[8:11]
    ds_read_b128 v[68:71], v223 offset:320
    s_waitcnt lgkmcnt(10)
    v_mfma_f32_16x16x32_bf16 v[12:15], v[140:143], v[76:79], v[12:15]
    ds_read_b128 v[72:75], v223 offset:704
    s_waitcnt vmcnt(7) lgkmcnt(10)
    v_mfma_f32_16x16x32_bf16 v[4:7], v[144:147], v[80:83], v[4:7]
    ds_read_b128 v[76:79], v223 offset:1088
    s_waitcnt lgkmcnt(10)
    v_mfma_f32_16x16x32_bf16 v[8:11], v[144:147], v[84:87], v[8:11]
    ds_read_b128 v[80:83], v223 offset:384
    s_waitcnt lgkmcnt(10)
    v_mfma_f32_16x16x32_bf16 v[12:15], v[144:147], v[88:91], v[12:15]
    ds_read_b128 v[84:87], v223 offset:768
    s_waitcnt vmcnt(6) lgkmcnt(10)
    v_mfma_f32_16x16x32_bf16 v[4:7], v[148:151], v[92:95], v[4:7]
    ds_read_b128 v[88:91], v223 offset:1152
    s_waitcnt lgkmcnt(10)
    v_mfma_f32_16x16x32_bf16 v[8:11], v[148:151], v[48:51], v[8:11]
    ds_read_b128 v[92:95], v223 offset:448
    s_waitcnt lgkmcnt(10)
    v_mfma_f32_16x16x32_bf16 v[12:15], v[148:151], v[52:55], v[12:15]
    ds_read_b128 v[48:51], v223 offset:832
    s_waitcnt vmcnt(5) lgkmcnt(10)
    v_mfma_f32_16x16x32_bf16 v[4:7], v[152:155], v[56:59], v[4:7]
    ds_read_b128 v[52:55], v223 offset:1216
    s_waitcnt lgkmcnt(10)
    v_mfma_f32_16x16x32_bf16 v[8:11], v[152:155], v[60:63], v[8:11]
    ds_read_b128 v[56:59], v223 offset:512
    s_waitcnt lgkmcnt(10)
    v_mfma_f32_16x16x32_bf16 v[12:15], v[152:155], v[64:67], v[12:15]
    ds_read_b128 v[60:63], v223 offset:896
    s_waitcnt vmcnt(4) lgkmcnt(10)
    v_mfma_f32_16x16x32_bf16 v[4:7], v[156:159], v[68:71], v[4:7]
    ds_read_b128 v[64:67], v223 offset:1280
    s_waitcnt lgkmcnt(10)
    v_mfma_f32_16x16x32_bf16 v[8:11], v[156:159], v[72:75], v[8:11]
    ds_read_b128 v[68:71], v223 offset:576
    s_waitcnt lgkmcnt(10)
    v_mfma_f32_16x16x32_bf16 v[12:15], v[156:159], v[76:79], v[12:15]
    ds_read_b128 v[72:75], v223 offset:960
    s_waitcnt vmcnt(3) lgkmcnt(10)
    v_mfma_f32_16x16x32_bf16 v[4:7], v[160:163], v[80:83], v[4:7]
    ds_read_b128 v[76:79], v223 offset:1344
    s_waitcnt lgkmcnt(10)
    v_mfma_f32_16x16x32_bf16 v[8:11], v[160:163], v[84:87], v[8:11]
    ds_read_b128 v[80:83], v222 offset:3072
    s_waitcnt lgkmcnt(10)
    v_mfma_f32_16x16x32_bf16 v[12:15], v[160:163], v[88:91], v[12:15]
    ds_read_b128 v[84:87], v222 offset:3136
    s_waitcnt vmcnt(2) lgkmcnt(10)
    v_mfma_f32_16x16x32_bf16 v[4:7], v[164:167], v[92:95], v[4:7]
    ds_read_b128 v[88:91], v222 offset:3200
    s_waitcnt lgkmcnt(10)
    v_mfma_f32_16x16x32_bf16 v[8:11], v[164:167], v[48:51], v[8:11]
    ds_read_b128 v[92:95], v222 offset:3264
    s_waitcnt lgkmcnt(10)
    v_mfma_f32_16x16x32_bf16 v[12:15], v[164:167], v[52:55], v[12:15]
    ds_read_b128 v[48:51], v224 offset:0
    s_waitcnt vmcnt(1) lgkmcnt(10)
    v_mfma_f32_16x16x32_bf16 v[4:7], v[168:171], v[56:59], v[4:7]
    ds_read_b128 v[52:55], v224 offset:64
    s_waitcnt lgkmcnt(10)
    v_mfma_f32_16x16x32_bf16 v[8:11], v[168:171], v[60:63], v[8:11]
    ds_read_b128 v[56:59], v224 offset:128
    s_waitcnt lgkmcnt(10)
    v_mfma_f32_16x16x32_bf16 v[12:15], v[168:171], v[64:67], v[12:15]
    ds_read_b128 v[60:63], v224 offset:192
    s_waitcnt vmcnt(0) lgkmcnt(10)
    v_mfma_f32_16x16x32_bf16 v[4:7], v[172:175], v[68:71], v[4:7]
    ds_read_b128 v[64:67], v222 offset:3328
    s_waitcnt lgkmcnt(10)
    v_mfma_f32_16x16x32_bf16 v[8:11], v[172:175], v[72:75], v[8:11]
    ds_read_b128 v[68:71], v222 offset:3712
    s_waitcnt lgkmcnt(10)
    v_mfma_f32_16x16x32_bf16 v[12:15], v[172:175], v[76:79], v[12:15]
    ds_read_b128 v[72:75], v222 offset:4096
    s_waitcnt lgkmcnt(10)
    v_mfma_f32_16x16x32_bf16 v[16:19], v[96:99], v[80:83], 0
    ds_read_b128 v[76:79], v222 offset:3392
    s_waitcnt lgkmcnt(10)
    v_mfma_f32_16x16x32_bf16 v[16:19], v[100:103], v[84:87], v[16:19]
    ds_read_b128 v[80:83], v222 offset:3776
    s_waitcnt lgkmcnt(10)
    v_mfma_f32_16x16x32_bf16 v[16:19], v[104:107], v[88:91], v[16:19]
    s_barrier
    ds_read_b128 v[84:87], v222 offset:4160
    s_waitcnt lgkmcnt(10)
    v_mfma_f32_16x16x32_bf16 v[16:19], v[108:111], v[92:95], v[16:19]
    v_mul_f32 v200, s63, v0
    ds_read_b128 v[88:91], v222 offset:3456
    s_waitcnt lgkmcnt(10)
    v_mfma_f32_16x16x32_bf16 v[16:19], v[112:115], v[48:51], v[16:19]
    v_mul_f32 v201, s63, v1
    ds_read_b128 v[92:95], v222 offset:3840
    s_waitcnt lgkmcnt(10)
    v_mfma_f32_16x16x32_bf16 v[16:19], v[116:119], v[52:55], v[16:19]
    v_mul_f32 v202, s63, v2
    ds_read_b128 v[48:51], v222 offset:4224
    s_waitcnt lgkmcnt(10)
    v_mfma_f32_16x16x32_bf16 v[16:19], v[120:123], v[56:59], v[16:19]
    v_mul_f32 v203, s63, v3
    ds_read_b128 v[52:55], v222 offset:3520
    s_waitcnt lgkmcnt(10)
    v_mfma_f32_16x16x32_bf16 v[16:19], v[124:127], v[60:63], v[16:19]
    v_exp_f32 v200, v200
    ds_read_b128 v[56:59], v222 offset:3904
    s_waitcnt lgkmcnt(10)
    v_mfma_f32_16x16x32_bf16 v[20:23], v[128:131], v[64:67], 0
    v_exp_f32 v201, v201
    ds_read_b128 v[60:63], v222 offset:4288
    s_waitcnt lgkmcnt(10)
    v_mfma_f32_16x16x32_bf16 v[24:27], v[128:131], v[68:71], 0
    v_exp_f32 v202, v202
    ds_read_b128 v[64:67], v222 offset:3584
    s_waitcnt lgkmcnt(10)
    v_mfma_f32_16x16x32_bf16 v[28:31], v[128:131], v[72:75], 0
    v_exp_f32 v203, v203
    ds_read_b128 v[68:71], v222 offset:3968
    s_waitcnt lgkmcnt(10)
    v_mfma_f32_16x16x32_bf16 v[20:23], v[132:135], v[76:79], v[20:23]
    v_add_f32 v200, 1.0, v200
    ds_read_b128 v[72:75], v222 offset:4352
    s_waitcnt lgkmcnt(10)
    v_mfma_f32_16x16x32_bf16 v[24:27], v[132:135], v[80:83], v[24:27]
    v_add_f32 v201, 1.0, v201
    ds_read_b128 v[76:79], v222 offset:3648
    s_waitcnt lgkmcnt(10)
    v_mfma_f32_16x16x32_bf16 v[28:31], v[132:135], v[84:87], v[28:31]
    v_add_f32 v202, 1.0, v202
    ds_read_b128 v[80:83], v222 offset:4032
    s_waitcnt lgkmcnt(10)
    v_mfma_f32_16x16x32_bf16 v[20:23], v[136:139], v[88:91], v[20:23]
    v_add_f32 v203, 1.0, v203
    ds_read_b128 v[84:87], v222 offset:4416
    s_waitcnt lgkmcnt(10)
    v_mfma_f32_16x16x32_bf16 v[24:27], v[136:139], v[92:95], v[24:27]
    v_rcp_f32 v200, v200
    ds_read_b128 v[88:91], v224 offset:256
    s_waitcnt lgkmcnt(10)
    v_mfma_f32_16x16x32_bf16 v[28:31], v[136:139], v[48:51], v[28:31]
    v_rcp_f32 v201, v201
    ds_read_b128 v[92:95], v224 offset:640
    s_waitcnt lgkmcnt(10)
    v_mfma_f32_16x16x32_bf16 v[20:23], v[140:143], v[52:55], v[20:23]
    v_rcp_f32 v202, v202
    ds_read_b128 v[48:51], v224 offset:1024
    s_waitcnt lgkmcnt(10)
    v_mfma_f32_16x16x32_bf16 v[24:27], v[140:143], v[56:59], v[24:27]
    v_rcp_f32 v203, v203
    ds_read_b128 v[52:55], v224 offset:320
    s_waitcnt lgkmcnt(10)
    v_mfma_f32_16x16x32_bf16 v[28:31], v[140:143], v[60:63], v[28:31]
    v_cvt_pk_bf16_f32 v176, v0, v1
    ds_read_b128 v[56:59], v224 offset:704
    s_waitcnt lgkmcnt(10)
    v_mfma_f32_16x16x32_bf16 v[20:23], v[144:147], v[64:67], v[20:23]
    v_cvt_pk_bf16_f32 v177, v2, v3
    ds_read_b128 v[60:63], v224 offset:1088
    s_waitcnt lgkmcnt(10)
    v_mfma_f32_16x16x32_bf16 v[24:27], v[144:147], v[68:71], v[24:27]
    v_mul_f32 v4, v4, v200
    ds_read_b128 v[64:67], v224 offset:384
    s_waitcnt lgkmcnt(10)
    v_mfma_f32_16x16x32_bf16 v[28:31], v[144:147], v[72:75], v[28:31]
    v_mul_f32 v5, v5, v201
    ds_read_b128 v[68:71], v224 offset:768
    s_waitcnt lgkmcnt(10)
    v_mfma_f32_16x16x32_bf16 v[20:23], v[148:151], v[76:79], v[20:23]
    v_mul_f32 v6, v6, v202
    ds_read_b128 v[72:75], v224 offset:1152
    s_waitcnt lgkmcnt(10)
    v_mfma_f32_16x16x32_bf16 v[24:27], v[148:151], v[80:83], v[24:27]
    v_mul_f32 v7, v7, v203
    ds_read_b128 v[76:79], v224 offset:448
    s_waitcnt lgkmcnt(10)
    v_mfma_f32_16x16x32_bf16 v[28:31], v[148:151], v[84:87], v[28:31]
    v_cvt_pk_bf16_f32 v178, v4, v5
    ds_read_b128 v[80:83], v224 offset:832
    s_waitcnt lgkmcnt(10)
    v_mfma_f32_16x16x32_bf16 v[20:23], v[152:155], v[88:91], v[20:23]
    v_cvt_pk_bf16_f32 v179, v6, v7
    ds_read_b128 v[84:87], v224 offset:1216
    s_waitcnt lgkmcnt(10)
    v_mfma_f32_16x16x32_bf16 v[24:27], v[152:155], v[92:95], v[24:27]
    v_mul_f32 v8, v8, v200
    ds_read_b128 v[88:91], v224 offset:512
    s_waitcnt lgkmcnt(10)
    v_mfma_f32_16x16x32_bf16 v[28:31], v[152:155], v[48:51], v[28:31]
    v_mul_f32 v9, v9, v201
    ds_read_b128 v[92:95], v224 offset:896
    s_waitcnt lgkmcnt(10)
    v_mfma_f32_16x16x32_bf16 v[20:23], v[156:159], v[52:55], v[20:23]
    v_mul_f32 v10, v10, v202
    ds_read_b128 v[48:51], v224 offset:1280
    s_waitcnt lgkmcnt(10)
    v_mfma_f32_16x16x32_bf16 v[24:27], v[156:159], v[56:59], v[24:27]
    v_mul_f32 v11, v11, v203
    ds_read_b128 v[52:55], v224 offset:576
    s_waitcnt lgkmcnt(10)
    v_mfma_f32_16x16x32_bf16 v[28:31], v[156:159], v[60:63], v[28:31]
    v_cvt_pk_bf16_f32 v180, v8, v9
    ds_read_b128 v[56:59], v224 offset:960
    s_waitcnt lgkmcnt(10)
    v_mfma_f32_16x16x32_bf16 v[20:23], v[160:163], v[64:67], v[20:23]
    v_cvt_pk_bf16_f32 v181, v10, v11
    ds_read_b128 v[60:63], v224 offset:1344
    s_waitcnt lgkmcnt(10)
    v_mfma_f32_16x16x32_bf16 v[24:27], v[160:163], v[68:71], v[24:27]
    v_mul_f32 v12, v12, v200
    ds_read_b128 v[64:67], v222 offset:6144
    s_waitcnt lgkmcnt(10)
    v_mfma_f32_16x16x32_bf16 v[28:31], v[160:163], v[72:75], v[28:31]
    v_mul_f32 v13, v13, v201
    ds_read_b128 v[68:71], v222 offset:6208
    s_waitcnt lgkmcnt(10)
    v_mfma_f32_16x16x32_bf16 v[20:23], v[164:167], v[76:79], v[20:23]
    v_mul_f32 v14, v14, v202
    ds_read_b128 v[72:75], v222 offset:6272
    s_waitcnt lgkmcnt(10)
    v_mfma_f32_16x16x32_bf16 v[24:27], v[164:167], v[80:83], v[24:27]
    v_mul_f32 v15, v15, v203
    ds_read_b128 v[76:79], v222 offset:6336
    s_waitcnt lgkmcnt(10)
    v_mfma_f32_16x16x32_bf16 v[28:31], v[164:167], v[84:87], v[28:31]
    v_cvt_pk_bf16_f32 v182, v12, v13
    ds_read_b128 v[80:83], v225 offset:0
    s_waitcnt lgkmcnt(10)
    v_mfma_f32_16x16x32_bf16 v[20:23], v[168:171], v[88:91], v[20:23]
    v_cvt_pk_bf16_f32 v183, v14, v15
    ds_read_b128 v[84:87], v225 offset:64
    s_waitcnt lgkmcnt(10)
    v_mfma_f32_16x16x32_bf16 v[24:27], v[168:171], v[92:95], v[24:27]
    ds_write_b64 v226, v[176:177] offset:0
    ds_write_b64 v226, v[178:179] offset:256
    ds_write_b64 v226, v[180:181] offset:512
    ds_write_b64 v226, v[182:183] offset:768
    ds_read_b128 v[88:91], v225 offset:128
    s_waitcnt lgkmcnt(14)
    v_mfma_f32_16x16x32_bf16 v[28:31], v[168:171], v[48:51], v[28:31]
    ds_read_b128 v[92:95], v225 offset:192
    s_waitcnt lgkmcnt(14)
    v_mfma_f32_16x16x32_bf16 v[20:23], v[172:175], v[52:55], v[20:23]
    ds_read_b128 v[48:51], v222 offset:6400
    s_waitcnt lgkmcnt(14)
    v_mfma_f32_16x16x32_bf16 v[24:27], v[172:175], v[56:59], v[24:27]
    ds_read_b128 v[52:55], v222 offset:6784
    s_waitcnt lgkmcnt(14)
    v_mfma_f32_16x16x32_bf16 v[28:31], v[172:175], v[60:63], v[28:31]
    ds_read_b128 v[56:59], v222 offset:7168
    s_waitcnt lgkmcnt(14)
    v_mfma_f32_16x16x32_bf16 v[32:35], v[96:99], v[64:67], 0
    ds_read_b128 v[60:63], v222 offset:6464
    s_waitcnt lgkmcnt(14)
    v_mfma_f32_16x16x32_bf16 v[32:35], v[100:103], v[68:71], v[32:35]
    ds_read_b128 v[64:67], v222 offset:6848
    s_waitcnt lgkmcnt(14)
    v_mfma_f32_16x16x32_bf16 v[32:35], v[104:107], v[72:75], v[32:35]
    ds_read_b128 v[68:71], v222 offset:7232
    s_waitcnt lgkmcnt(14)
    v_mfma_f32_16x16x32_bf16 v[32:35], v[108:111], v[76:79], v[32:35]
    v_mul_f32 v200, s63, v16
    ds_read_b128 v[72:75], v222 offset:6528
    s_waitcnt lgkmcnt(14)
    v_mfma_f32_16x16x32_bf16 v[32:35], v[112:115], v[80:83], v[32:35]
    v_mul_f32 v201, s63, v17
    ds_read_b128 v[76:79], v222 offset:6912
    s_waitcnt lgkmcnt(14)
    v_mfma_f32_16x16x32_bf16 v[32:35], v[116:119], v[84:87], v[32:35]
    v_mul_f32 v202, s63, v18
    ds_read_b128 v[80:83], v222 offset:7296
    s_waitcnt lgkmcnt(10)
    v_mfma_f32_16x16x32_bf16 v[32:35], v[120:123], v[88:91], v[32:35]
    v_mul_f32 v203, s63, v19
    ds_read_b128 v[84:87], v222 offset:6592
    s_waitcnt lgkmcnt(10)
    v_mfma_f32_16x16x32_bf16 v[32:35], v[124:127], v[92:95], v[32:35]
    s_barrier
    ds_read_b128 v[192:195], v228 offset:0
    ds_read_b128 v[196:199], v228 offset:1536
    v_exp_f32 v200, v200
    ds_read_b128 v[88:91], v222 offset:6976
    s_waitcnt lgkmcnt(12)
    v_mfma_f32_16x16x32_bf16 v[36:39], v[128:131], v[48:51], 0
    v_exp_f32 v201, v201
    ds_read_b128 v[92:95], v222 offset:7360
    s_waitcnt lgkmcnt(12)
    v_mfma_f32_16x16x32_bf16 v[40:43], v[128:131], v[52:55], 0
    v_exp_f32 v202, v202
    ds_read_b128 v[48:51], v222 offset:6656
    s_waitcnt lgkmcnt(12)
    v_mfma_f32_16x16x32_bf16 v[44:47], v[128:131], v[56:59], 0
    v_exp_f32 v203, v203
    ds_read_b128 v[52:55], v222 offset:7040
    s_waitcnt lgkmcnt(12)
    v_mfma_f32_16x16x32_bf16 v[36:39], v[132:135], v[60:63], v[36:39]
    v_add_f32 v200, 1.0, v200
    ds_read_b128 v[56:59], v222 offset:7424
    s_waitcnt lgkmcnt(12)
    v_mfma_f32_16x16x32_bf16 v[40:43], v[132:135], v[64:67], v[40:43]
    v_add_f32 v201, 1.0, v201
    ds_read_b128 v[60:63], v222 offset:6720
    s_waitcnt lgkmcnt(12)
    v_mfma_f32_16x16x32_bf16 v[44:47], v[132:135], v[68:71], v[44:47]
    v_add_f32 v202, 1.0, v202
    ds_read_b128 v[64:67], v222 offset:7104
    s_waitcnt lgkmcnt(12)
    v_mfma_f32_16x16x32_bf16 v[36:39], v[136:139], v[72:75], v[36:39]
    v_add_f32 v203, 1.0, v203
    ds_read_b128 v[68:71], v222 offset:7488
    s_waitcnt lgkmcnt(12)
    v_mfma_f32_16x16x32_bf16 v[40:43], v[136:139], v[76:79], v[40:43]
    v_rcp_f32 v200, v200
    ds_read_b128 v[72:75], v225 offset:256
    s_waitcnt lgkmcnt(12)
    v_mfma_f32_16x16x32_bf16 v[44:47], v[136:139], v[80:83], v[44:47]
    v_rcp_f32 v201, v201
    ds_read_b128 v[76:79], v225 offset:640
    s_waitcnt lgkmcnt(12)
    v_mfma_f32_16x16x32_bf16 v[36:39], v[140:143], v[84:87], v[36:39]
    v_rcp_f32 v202, v202
    ds_read_b128 v[80:83], v225 offset:1024
    s_waitcnt lgkmcnt(10)
    v_mfma_f32_16x16x32_bf16 v[40:43], v[140:143], v[88:91], v[40:43]
    v_rcp_f32 v203, v203
    ds_read_b128 v[84:87], v225 offset:320
    s_waitcnt lgkmcnt(10)
    v_mfma_f32_16x16x32_bf16 v[44:47], v[140:143], v[92:95], v[44:47]
    v_cvt_pk_bf16_f32 v184, v16, v17
    buffer_store_dwordx4 v[192:195], v229, s[12:15], s62 offen sc1
    s_add_u32 s62, s62, 8192
    buffer_store_dwordx4 v[196:199], v229, s[12:15], s62 offen sc1
    s_add_u32 s62, s62, 8192
    ds_read_b128 v[88:91], v225 offset:704
    s_waitcnt lgkmcnt(10)
    v_mfma_f32_16x16x32_bf16 v[36:39], v[144:147], v[48:51], v[36:39]
    v_cvt_pk_bf16_f32 v185, v18, v19
    ds_read_b128 v[92:95], v225 offset:1088
    s_waitcnt lgkmcnt(10)
    v_mfma_f32_16x16x32_bf16 v[40:43], v[144:147], v[52:55], v[40:43]
    v_mul_f32 v20, v20, v200
    ds_read_b128 v[48:51], v225 offset:384
    s_waitcnt lgkmcnt(10)
    v_mfma_f32_16x16x32_bf16 v[44:47], v[144:147], v[56:59], v[44:47]
    v_mul_f32 v21, v21, v201
    ds_read_b128 v[52:55], v225 offset:768
    s_waitcnt lgkmcnt(10)
    v_mfma_f32_16x16x32_bf16 v[36:39], v[148:151], v[60:63], v[36:39]
    v_mul_f32 v22, v22, v202
    ds_read_b128 v[56:59], v225 offset:1152
    s_waitcnt lgkmcnt(10)
    v_mfma_f32_16x16x32_bf16 v[40:43], v[148:151], v[64:67], v[40:43]
    v_mul_f32 v23, v23, v203
    ds_read_b128 v[60:63], v225 offset:448
    s_waitcnt lgkmcnt(10)
    v_mfma_f32_16x16x32_bf16 v[44:47], v[148:151], v[68:71], v[44:47]
    v_cvt_pk_bf16_f32 v186, v20, v21
    ds_read_b128 v[64:67], v225 offset:832
    s_waitcnt lgkmcnt(10)
    v_mfma_f32_16x16x32_bf16 v[36:39], v[152:155], v[72:75], v[36:39]
    v_cvt_pk_bf16_f32 v187, v22, v23
    ds_read_b128 v[68:71], v225 offset:1216
    s_waitcnt lgkmcnt(10)
    v_mfma_f32_16x16x32_bf16 v[40:43], v[152:155], v[76:79], v[40:43]
    v_mul_f32 v24, v24, v200
    ds_read_b128 v[72:75], v225 offset:512
    s_waitcnt lgkmcnt(10)
    v_mfma_f32_16x16x32_bf16 v[44:47], v[152:155], v[80:83], v[44:47]
    v_mul_f32 v25, v25, v201
    ds_read_b128 v[76:79], v225 offset:896
    s_waitcnt lgkmcnt(10)
    v_mfma_f32_16x16x32_bf16 v[36:39], v[156:159], v[84:87], v[36:39]
    v_mul_f32 v26, v26, v202
    ds_read_b128 v[80:83], v225 offset:1280
    s_waitcnt lgkmcnt(10)
    v_mfma_f32_16x16x32_bf16 v[40:43], v[156:159], v[88:91], v[40:43]
    v_mul_f32 v27, v27, v203
    ds_read_b128 v[84:87], v225 offset:576
    s_waitcnt lgkmcnt(10)
    v_mfma_f32_16x16x32_bf16 v[44:47], v[156:159], v[92:95], v[44:47]
    v_cvt_pk_bf16_f32 v188, v24, v25
    ds_read_b128 v[88:91], v225 offset:960
    s_waitcnt lgkmcnt(10)
    v_mfma_f32_16x16x32_bf16 v[36:39], v[160:163], v[48:51], v[36:39]
    v_cvt_pk_bf16_f32 v189, v26, v27
    ds_read_b128 v[92:95], v225 offset:1344
    s_waitcnt lgkmcnt(10)
    v_mfma_f32_16x16x32_bf16 v[40:43], v[160:163], v[52:55], v[40:43]
    v_mul_f32 v28, v28, v200
    s_waitcnt lgkmcnt(9)
    v_mfma_f32_16x16x32_bf16 v[44:47], v[160:163], v[56:59], v[44:47]
    v_mul_f32 v29, v29, v201
    s_waitcnt lgkmcnt(8)
    v_mfma_f32_16x16x32_bf16 v[36:39], v[164:167], v[60:63], v[36:39]
    v_mul_f32 v30, v30, v202
    s_waitcnt lgkmcnt(7)
    v_mfma_f32_16x16x32_bf16 v[40:43], v[164:167], v[64:67], v[40:43]
    v_mul_f32 v31, v31, v203
    s_waitcnt lgkmcnt(6)
    v_mfma_f32_16x16x32_bf16 v[44:47], v[164:167], v[68:71], v[44:47]
    v_cvt_pk_bf16_f32 v190, v28, v29
    s_waitcnt lgkmcnt(5)
    v_mfma_f32_16x16x32_bf16 v[36:39], v[168:171], v[72:75], v[36:39]
    v_cvt_pk_bf16_f32 v191, v30, v31
    s_waitcnt lgkmcnt(4)
    v_mfma_f32_16x16x32_bf16 v[40:43], v[168:171], v[76:79], v[40:43]
    ds_write_b64 v226, v[184:185] offset:3072
    ds_write_b64 v226, v[186:187] offset:3328
    ds_write_b64 v226, v[188:189] offset:3584
    ds_write_b64 v226, v[190:191] offset:3840
    s_waitcnt lgkmcnt(7)
    v_mfma_f32_16x16x32_bf16 v[44:47], v[168:171], v[80:83], v[44:47]
    s_waitcnt lgkmcnt(6)
    v_mfma_f32_16x16x32_bf16 v[36:39], v[172:175], v[84:87], v[36:39]
    s_waitcnt lgkmcnt(5)
    v_mfma_f32_16x16x32_bf16 v[40:43], v[172:175], v[88:91], v[40:43]
    s_waitcnt lgkmcnt(4)
    v_mfma_f32_16x16x32_bf16 v[44:47], v[172:175], v[92:95], v[44:47]
    v_mul_f32 v200, s63, v32
    v_mul_f32 v201, s63, v33
    v_mul_f32 v202, s63, v34
    v_mul_f32 v203, s63, v35
    v_exp_f32 v200, v200
    v_exp_f32 v201, v201
    v_exp_f32 v202, v202
    v_exp_f32 v203, v203
    v_add_f32 v200, 1.0, v200
    v_add_f32 v201, 1.0, v201
    v_add_f32 v202, 1.0, v202
    v_add_f32 v203, 1.0, v203
    v_rcp_f32 v200, v200
    v_rcp_f32 v201, v201
    v_rcp_f32 v202, v202
    v_rcp_f32 v203, v203
    v_cvt_pk_bf16_f32 v176, v32, v33
    v_cvt_pk_bf16_f32 v177, v34, v35
    v_mul_f32 v36, v36, v200
    v_mul_f32 v37, v37, v201
    v_mul_f32 v38, v38, v202
    v_mul_f32 v39, v39, v203
    v_cvt_pk_bf16_f32 v178, v36, v37
    v_cvt_pk_bf16_f32 v179, v38, v39
    v_mul_f32 v40, v40, v200
    v_mul_f32 v41, v41, v201
    v_mul_f32 v42, v42, v202
    v_mul_f32 v43, v43, v203
    v_cvt_pk_bf16_f32 v180, v40, v41
    v_cvt_pk_bf16_f32 v181, v42, v43
    v_mul_f32 v44, v44, v200
    v_mul_f32 v45, v45, v201
    v_mul_f32 v46, v46, v202
    v_mul_f32 v47, v47, v203
    v_cvt_pk_bf16_f32 v182, v44, v45
    v_cvt_pk_bf16_f32 v183, v46, v47
    s_waitcnt lgkmcnt(0)
    s_barrier
    ds_read_b128 v[192:195], v228 offset:3072
    ds_read_b128 v[196:199], v228 offset:4608
    s_mov_b64 exec, s[56:57]
    ds_write_b64 v226, v[176:177] offset:6144
    ds_write_b64 v226, v[178:179] offset:6400
    ds_write_b64 v226, v[180:181] offset:6656
    ds_write_b64 v226, v[182:183] offset:6912
    s_mov_b64 exec, -1
    s_waitcnt lgkmcnt(4)
    buffer_store_dwordx4 v[192:195], v229, s[12:15], s62 offen sc1
    s_add_u32 s62, s62, 8192
    buffer_store_dwordx4 v[196:199], v229, s[12:15], s62 offen sc1
    s_add_u32 s62, s62, 8192
    s_waitcnt lgkmcnt(0)
    s_barrier
K2_LASTROW:
    s_add_u32 s59, s20, 32
    s_cmp_ge_u32 s59, s22
    s_cbranch_scc1 K2_FIN
    ds_read_b128 v[192:195], v228 offset:6144
    s_waitcnt lgkmcnt(0)
    buffer_store_dwordx4 v[192:195], v229, s[12:15], s62 offen sc1
    s_add_u32 s62, s62, 8192
K2_FIN:
    s_branch K2_END
K2_MULTI:
    ds_read_b128 v[48:51], v222 offset:0
    ds_read_b128 v[52:55], v222 offset:64
    ds_read_b128 v[56:59], v222 offset:128
    ds_read_b128 v[60:63], v222 offset:192
    ds_read_b128 v[64:67], v223 offset:0
    ds_read_b128 v[68:71], v223 offset:64
    ds_read_b128 v[72:75], v223 offset:128
    ds_read_b128 v[76:79], v223 offset:192
    ds_read_b128 v[80:83], v222 offset:256
    ds_read_b128 v[84:87], v222 offset:640
    ds_read_b128 v[88:91], v222 offset:1024
    s_waitcnt vmcnt(19) lgkmcnt(10)
    v_mfma_f32_16x16x32_bf16 v[0:3], v[96:99], v[48:51], 0
    ds_read_b128 v[92:95], v222 offset:320
    s_waitcnt vmcnt(18) lgkmcnt(10)
    v_mfma_f32_16x16x32_bf16 v[0:3], v[100:103], v[52:55], v[0:3]
    ds_read_b128 v[48:51], v222 offset:704
    s_waitcnt vmcnt(17) lgkmcnt(10)
    v_mfma_f32_16x16x32_bf16 v[0:3], v[104:107], v[56:59], v[0:3]
    ds_read_b128 v[52:55], v222 offset:1088
    s_waitcnt vmcnt(16) lgkmcnt(10)
    v_mfma_f32_16x16x32_bf16 v[0:3], v[108:111], v[60:63], v[0:3]
    ds_read_b128 v[56:59], v222 offset:384
    s_waitcnt vmcnt(15) lgkmcnt(10)
    v_mfma_f32_16x16x32_bf16 v[0:3], v[112:115], v[64:67], v[0:3]
    ds_read_b128 v[60:63], v222 offset:768
    s_waitcnt vmcnt(14) lgkmcnt(10)
    v_mfma_f32_16x16x32_bf16 v[0:3], v[116:119], v[68:71], v[0:3]
    ds_read_b128 v[64:67], v222 offset:1152
    s_waitcnt vmcnt(13) lgkmcnt(10)
    v_mfma_f32_16x16x32_bf16 v[0:3], v[120:123], v[72:75], v[0:3]
    ds_read_b128 v[68:71], v222 offset:448
    s_waitcnt vmcnt(12) lgkmcnt(10)
    v_mfma_f32_16x16x32_bf16 v[0:3], v[124:127], v[76:79], v[0:3]
    ds_read_b128 v[72:75], v222 offset:832
    s_waitcnt vmcnt(11) lgkmcnt(10)
    v_mfma_f32_16x16x32_bf16 v[4:7], v[128:131], v[80:83], 0
    ds_read_b128 v[76:79], v222 offset:1216
    s_waitcnt lgkmcnt(10)
    v_mfma_f32_16x16x32_bf16 v[8:11], v[128:131], v[84:87], 0
    ds_read_b128 v[80:83], v222 offset:512
    s_waitcnt lgkmcnt(10)
    v_mfma_f32_16x16x32_bf16 v[12:15], v[128:131], v[88:91], 0
    ds_read_b128 v[84:87], v222 offset:896
    s_waitcnt vmcnt(10) lgkmcnt(10)
    v_mfma_f32_16x16x32_bf16 v[4:7], v[132:135], v[92:95], v[4:7]
    ds_read_b128 v[88:91], v222 offset:1280
    s_waitcnt lgkmcnt(10)
    v_mfma_f32_16x16x32_bf16 v[8:11], v[132:135], v[48:51], v[8:11]
    ds_read_b128 v[92:95], v222 offset:576
    s_waitcnt lgkmcnt(10)
    v_mfma_f32_16x16x32_bf16 v[12:15], v[132:135], v[52:55], v[12:15]
    ds_read_b128 v[48:51], v222 offset:960
    s_waitcnt vmcnt(9) lgkmcnt(10)
    v_mfma_f32_16x16x32_bf16 v[4:7], v[136:139], v[56:59], v[4:7]
    ds_read_b128 v[52:55], v222 offset:1344
    s_waitcnt lgkmcnt(10)
    v_mfma_f32_16x16x32_bf16 v[8:11], v[136:139], v[60:63], v[8:11]
    ds_read_b128 v[56:59], v223 offset:256
    s_waitcnt lgkmcnt(10)
    v_mfma_f32_16x16x32_bf16 v[12:15], v[136:139], v[64:67], v[12:15]
    ds_read_b128 v[60:63], v223 offset:640
    s_waitcnt vmcnt(8) lgkmcnt(10)
    v_mfma_f32_16x16x32_bf16 v[4:7], v[140:143], v[68:71], v[4:7]
    ds_read_b128 v[64:67], v223 offset:1024
    s_waitcnt lgkmcnt(10)
    v_mfma_f32_16x16x32_bf16 v[8:11], v[140:143], v[72:75], v[8:11]
    ds_read_b128 v[68:71], v223 offset:320
    s_waitcnt lgkmcnt(10)
    v_mfma_f32_16x16x32_bf16 v[12:15], v[140:143], v[76:79], v[12:15]
    ds_read_b128 v[72:75], v223 offset:704
    s_waitcnt vmcnt(7) lgkmcnt(10)
    v_mfma_f32_16x16x32_bf16 v[4:7], v[144:147], v[80:83], v[4:7]
    ds_read_b128 v[76:79], v223 offset:1088
    s_waitcnt lgkmcnt(10)
    v_mfma_f32_16x16x32_bf16 v[8:11], v[144:147], v[84:87], v[8:11]
    ds_read_b128 v[80:83], v223 offset:384
    s_waitcnt lgkmcnt(10)
    v_mfma_f32_16x16x32_bf16 v[12:15], v[144:147], v[88:91], v[12:15]
    ds_read_b128 v[84:87], v223 offset:768
    s_waitcnt vmcnt(6) lgkmcnt(10)
    v_mfma_f32_16x16x32_bf16 v[4:7], v[148:151], v[92:95], v[4:7]
    ds_read_b128 v[88:91], v223 offset:1152
    s_waitcnt lgkmcnt(10)
    v_mfma_f32_16x16x32_bf16 v[8:11], v[148:151], v[48:51], v[8:11]
    ds_read_b128 v[92:95], v223 offset:448
    s_waitcnt lgkmcnt(10)
    v_mfma_f32_16x16x32_bf16 v[12:15], v[148:151], v[52:55], v[12:15]
    ds_read_b128 v[48:51], v223 offset:832
    s_waitcnt vmcnt(5) lgkmcnt(10)
    v_mfma_f32_16x16x32_bf16 v[4:7], v[152:155], v[56:59], v[4:7]
    ds_read_b128 v[52:55], v223 offset:1216
    s_waitcnt lgkmcnt(10)
    v_mfma_f32_16x16x32_bf16 v[8:11], v[152:155], v[60:63], v[8:11]
    ds_read_b128 v[56:59], v223 offset:512
    s_waitcnt lgkmcnt(10)
    v_mfma_f32_16x16x32_bf16 v[12:15], v[152:155], v[64:67], v[12:15]
    ds_read_b128 v[60:63], v223 offset:896
    s_waitcnt vmcnt(4) lgkmcnt(10)
    v_mfma_f32_16x16x32_bf16 v[4:7], v[156:159], v[68:71], v[4:7]
    ds_read_b128 v[64:67], v223 offset:1280
    s_waitcnt lgkmcnt(10)
    v_mfma_f32_16x16x32_bf16 v[8:11], v[156:159], v[72:75], v[8:11]
    ds_read_b128 v[68:71], v223 offset:576
    s_waitcnt lgkmcnt(10)
    v_mfma_f32_16x16x32_bf16 v[12:15], v[156:159], v[76:79], v[12:15]
    ds_read_b128 v[72:75], v223 offset:960
    s_waitcnt vmcnt(3) lgkmcnt(10)
    v_mfma_f32_16x16x32_bf16 v[4:7], v[160:163], v[80:83], v[4:7]
    ds_read_b128 v[76:79], v223 offset:1344
    s_waitcnt lgkmcnt(10)
    v_mfma_f32_16x16x32_bf16 v[8:11], v[160:163], v[84:87], v[8:11]
    ds_read_b128 v[80:83], v222 offset:3072
    s_waitcnt lgkmcnt(10)
    v_mfma_f32_16x16x32_bf16 v[12:15], v[160:163], v[88:91], v[12:15]
    ds_read_b128 v[84:87], v222 offset:3136
    s_waitcnt vmcnt(2) lgkmcnt(10)
    v_mfma_f32_16x16x32_bf16 v[4:7], v[164:167], v[92:95], v[4:7]
    ds_read_b128 v[88:91], v222 offset:3200
    s_waitcnt lgkmcnt(10)
    v_mfma_f32_16x16x32_bf16 v[8:11], v[164:167], v[48:51], v[8:11]
    ds_read_b128 v[92:95], v222 offset:3264
    s_waitcnt lgkmcnt(10)
    v_mfma_f32_16x16x32_bf16 v[12:15], v[164:167], v[52:55], v[12:15]
    ds_read_b128 v[48:51], v224 offset:0
    s_waitcnt vmcnt(1) lgkmcnt(10)
    v_mfma_f32_16x16x32_bf16 v[4:7], v[168:171], v[56:59], v[4:7]
    ds_read_b128 v[52:55], v224 offset:64
    s_waitcnt lgkmcnt(10)
    v_mfma_f32_16x16x32_bf16 v[8:11], v[168:171], v[60:63], v[8:11]
    ds_read_b128 v[56:59], v224 offset:128
    s_waitcnt lgkmcnt(10)
    v_mfma_f32_16x16x32_bf16 v[12:15], v[168:171], v[64:67], v[12:15]
    ds_read_b128 v[60:63], v224 offset:192
    s_waitcnt vmcnt(0) lgkmcnt(10)
    v_mfma_f32_16x16x32_bf16 v[4:7], v[172:175], v[68:71], v[4:7]
    ds_read_b128 v[64:67], v222 offset:3328
    s_waitcnt lgkmcnt(10)
    v_mfma_f32_16x16x32_bf16 v[8:11], v[172:175], v[72:75], v[8:11]
    ds_read_b128 v[68:71], v222 offset:3712
    s_waitcnt lgkmcnt(10)
    v_mfma_f32_16x16x32_bf16 v[12:15], v[172:175], v[76:79], v[12:15]
    ds_read_b128 v[72:75], v222 offset:4096
    s_waitcnt lgkmcnt(10)
    v_mfma_f32_16x16x32_bf16 v[16:19], v[96:99], v[80:83], 0
    ds_read_b128 v[76:79], v222 offset:3392
    s_waitcnt lgkmcnt(10)
    v_mfma_f32_16x16x32_bf16 v[16:19], v[100:103], v[84:87], v[16:19]
    ds_read_b128 v[80:83], v222 offset:3776
    s_waitcnt lgkmcnt(10)
    v_mfma_f32_16x16x32_bf16 v[16:19], v[104:107], v[88:91], v[16:19]
    ds_read_b128 v[84:87], v222 offset:4160
    s_waitcnt lgkmcnt(10)
    v_mfma_f32_16x16x32_bf16 v[16:19], v[108:111], v[92:95], v[16:19]
    ds_read_b128 v[88:91], v222 offset:3456
    s_waitcnt lgkmcnt(10)
    v_mfma_f32_16x16x32_bf16 v[16:19], v[112:115], v[48:51], v[16:19]
    ds_read_b128 v[92:95], v222 offset:3840
    s_waitcnt lgkmcnt(10)
    v_mfma_f32_16x16x32_bf16 v[16:19], v[116:119], v[52:55], v[16:19]
    ds_read_b128 v[48:51], v222 offset:4224
    s_waitcnt lgkmcnt(10)
    v_mfma_f32_16x16x32_bf16 v[16:19], v[120:123], v[56:59], v[16:19]
    ds_read_b128 v[52:55], v222 offset:3520
    s_waitcnt lgkmcnt(10)
    v_mfma_f32_16x16x32_bf16 v[16:19], v[124:127], v[60:63], v[16:19]
    ds_read_b128 v[56:59], v222 offset:3904
    s_waitcnt lgkmcnt(10)
    v_mfma_f32_16x16x32_bf16 v[20:23], v[128:131], v[64:67], 0
    ds_read_b128 v[60:63], v222 offset:4288
    s_waitcnt lgkmcnt(10)
    v_mfma_f32_16x16x32_bf16 v[24:27], v[128:131], v[68:71], 0
    ds_read_b128 v[64:67], v222 offset:3584
    s_waitcnt lgkmcnt(10)
    v_mfma_f32_16x16x32_bf16 v[28:31], v[128:131], v[72:75], 0
    ds_read_b128 v[68:71], v222 offset:3968
    s_waitcnt lgkmcnt(10)
    v_mfma_f32_16x16x32_bf16 v[20:23], v[132:135], v[76:79], v[20:23]
    ds_read_b128 v[72:75], v222 offset:4352
    s_waitcnt lgkmcnt(10)
    v_mfma_f32_16x16x32_bf16 v[24:27], v[132:135], v[80:83], v[24:27]
    ds_read_b128 v[76:79], v222 offset:3648
    s_waitcnt lgkmcnt(10)
    v_mfma_f32_16x16x32_bf16 v[28:31], v[132:135], v[84:87], v[28:31]
    ds_read_b128 v[80:83], v222 offset:4032
    s_waitcnt lgkmcnt(10)
    v_mfma_f32_16x16x32_bf16 v[20:23], v[136:139], v[88:91], v[20:23]
    ds_read_b128 v[84:87], v222 offset:4416
    s_waitcnt lgkmcnt(10)
    v_mfma_f32_16x16x32_bf16 v[24:27], v[136:139], v[92:95], v[24:27]
    ds_read_b128 v[88:91], v224 offset:256
    s_waitcnt lgkmcnt(10)
    v_mfma_f32_16x16x32_bf16 v[28:31], v[136:139], v[48:51], v[28:31]
    ds_read_b128 v[92:95], v224 offset:640
    s_waitcnt lgkmcnt(10)
    v_mfma_f32_16x16x32_bf16 v[20:23], v[140:143], v[52:55], v[20:23]
    ds_read_b128 v[48:51], v224 offset:1024
    s_waitcnt lgkmcnt(10)
    v_mfma_f32_16x16x32_bf16 v[24:27], v[140:143], v[56:59], v[24:27]
    ds_read_b128 v[52:55], v224 offset:320
    s_waitcnt lgkmcnt(10)
    v_mfma_f32_16x16x32_bf16 v[28:31], v[140:143], v[60:63], v[28:31]
    ds_read_b128 v[56:59], v224 offset:704
    s_waitcnt lgkmcnt(10)
    v_mfma_f32_16x16x32_bf16 v[20:23], v[144:147], v[64:67], v[20:23]
    ds_read_b128 v[60:63], v224 offset:1088
    s_waitcnt lgkmcnt(10)
    v_mfma_f32_16x16x32_bf16 v[24:27], v[144:147], v[68:71], v[24:27]
    ds_read_b128 v[64:67], v224 offset:384
    s_waitcnt lgkmcnt(10)
    v_mfma_f32_16x16x32_bf16 v[28:31], v[144:147], v[72:75], v[28:31]
    ds_read_b128 v[68:71], v224 offset:768
    s_waitcnt lgkmcnt(10)
    v_mfma_f32_16x16x32_bf16 v[20:23], v[148:151], v[76:79], v[20:23]
    ds_read_b128 v[72:75], v224 offset:1152
    s_waitcnt lgkmcnt(10)
    v_mfma_f32_16x16x32_bf16 v[24:27], v[148:151], v[80:83], v[24:27]
    ds_read_b128 v[76:79], v224 offset:448
    s_waitcnt lgkmcnt(10)
    v_mfma_f32_16x16x32_bf16 v[28:31], v[148:151], v[84:87], v[28:31]
    ds_read_b128 v[80:83], v224 offset:832
    s_waitcnt lgkmcnt(10)
    v_mfma_f32_16x16x32_bf16 v[20:23], v[152:155], v[88:91], v[20:23]
    ds_read_b128 v[84:87], v224 offset:1216
    s_waitcnt lgkmcnt(10)
    v_mfma_f32_16x16x32_bf16 v[24:27], v[152:155], v[92:95], v[24:27]
    ds_read_b128 v[88:91], v224 offset:512
    s_waitcnt lgkmcnt(10)
    v_mfma_f32_16x16x32_bf16 v[28:31], v[152:155], v[48:51], v[28:31]
    ds_read_b128 v[92:95], v224 offset:896
    s_waitcnt lgkmcnt(10)
    v_mfma_f32_16x16x32_bf16 v[20:23], v[156:159], v[52:55], v[20:23]
    ds_read_b128 v[48:51], v224 offset:1280
    s_waitcnt lgkmcnt(10)
    v_mfma_f32_16x16x32_bf16 v[24:27], v[156:159], v[56:59], v[24:27]
    ds_read_b128 v[52:55], v224 offset:576
    s_waitcnt lgkmcnt(10)
    v_mfma_f32_16x16x32_bf16 v[28:31], v[156:159], v[60:63], v[28:31]
    ds_read_b128 v[56:59], v224 offset:960
    s_waitcnt lgkmcnt(10)
    v_mfma_f32_16x16x32_bf16 v[20:23], v[160:163], v[64:67], v[20:23]
    ds_read_b128 v[60:63], v224 offset:1344
    s_waitcnt lgkmcnt(10)
    v_mfma_f32_16x16x32_bf16 v[24:27], v[160:163], v[68:71], v[24:27]
    ds_read_b128 v[64:67], v222 offset:6144
    s_waitcnt lgkmcnt(10)
    v_mfma_f32_16x16x32_bf16 v[28:31], v[160:163], v[72:75], v[28:31]
    ds_read_b128 v[68:71], v222 offset:6208
    s_waitcnt lgkmcnt(10)
    v_mfma_f32_16x16x32_bf16 v[20:23], v[164:167], v[76:79], v[20:23]
    ds_read_b128 v[72:75], v222 offset:6272
    s_waitcnt lgkmcnt(10)
    v_mfma_f32_16x16x32_bf16 v[24:27], v[164:167], v[80:83], v[24:27]
    ds_read_b128 v[76:79], v222 offset:6336
    s_waitcnt lgkmcnt(10)
    v_mfma_f32_16x16x32_bf16 v[28:31], v[164:167], v[84:87], v[28:31]
    ds_read_b128 v[80:83], v225 offset:0
    s_waitcnt lgkmcnt(10)
    v_mfma_f32_16x16x32_bf16 v[20:23], v[168:171], v[88:91], v[20:23]
    ds_read_b128 v[84:87], v225 offset:64
    s_waitcnt lgkmcnt(10)
    v_mfma_f32_16x16x32_bf16 v[24:27], v[168:171], v[92:95], v[24:27]
    ds_read_b128 v[88:91], v225 offset:128
    s_waitcnt lgkmcnt(10)
    v_mfma_f32_16x16x32_bf16 v[28:31], v[168:171], v[48:51], v[28:31]
    ds_read_b128 v[92:95], v225 offset:192
    s_waitcnt lgkmcnt(10)
    v_mfma_f32_16x16x32_bf16 v[20:23], v[172:175], v[52:55], v[20:23]
    ds_read_b128 v[48:51], v222 offset:6400
    s_waitcnt lgkmcnt(10)
    v_mfma_f32_16x16x32_bf16 v[24:27], v[172:175], v[56:59], v[24:27]
    ds_read_b128 v[52:55], v222 offset:6784
    s_waitcnt lgkmcnt(10)
    v_mfma_f32_16x16x32_bf16 v[28:31], v[172:175], v[60:63], v[28:31]
    ds_read_b128 v[56:59], v222 offset:7168
    s_waitcnt lgkmcnt(10)
    v_mfma_f32_16x16x32_bf16 v[32:35], v[96:99], v[64:67], 0
    ds_read_b128 v[60:63], v222 offset:6464
    s_waitcnt lgkmcnt(10)
    v_mfma_f32_16x16x32_bf16 v[32:35], v[100:103], v[68:71], v[32:35]
    ds_read_b128 v[64:67], v222 offset:6848
    s_waitcnt lgkmcnt(10)
    v_mfma_f32_16x16x32_bf16 v[32:35], v[104:107], v[72:75], v[32:35]
    ds_read_b128 v[68:71], v222 offset:7232
    s_waitcnt lgkmcnt(10)
    v_mfma_f32_16x16x32_bf16 v[32:35], v[108:111], v[76:79], v[32:35]
    ds_read_b128 v[72:75], v222 offset:6528
    s_waitcnt lgkmcnt(10)
    v_mfma_f32_16x16x32_bf16 v[32:35], v[112:115], v[80:83], v[32:35]
    ds_read_b128 v[76:79], v222 offset:6912
    s_waitcnt lgkmcnt(10)
    v_mfma_f32_16x16x32_bf16 v[32:35], v[116:119], v[84:87], v[32:35]
    ds_read_b128 v[80:83], v222 offset:7296
    s_waitcnt lgkmcnt(10)
    v_mfma_f32_16x16x32_bf16 v[32:35], v[120:123], v[88:91], v[32:35]
    ds_read_b128 v[84:87], v222 offset:6592
    s_waitcnt lgkmcnt(10)
    v_mfma_f32_16x16x32_bf16 v[32:35], v[124:127], v[92:95], v[32:35]
    ds_read_b128 v[88:91], v222 offset:6976
    s_waitcnt lgkmcnt(10)
    v_mfma_f32_16x16x32_bf16 v[36:39], v[128:131], v[48:51], 0
    ds_read_b128 v[92:95], v222 offset:7360
    s_waitcnt lgkmcnt(10)
    v_mfma_f32_16x16x32_bf16 v[40:43], v[128:131], v[52:55], 0
    ds_read_b128 v[48:51], v222 offset:6656
    s_waitcnt lgkmcnt(10)
    v_mfma_f32_16x16x32_bf16 v[44:47], v[128:131], v[56:59], 0
    ds_read_b128 v[52:55], v222 offset:7040
    s_waitcnt lgkmcnt(10)
    v_mfma_f32_16x16x32_bf16 v[36:39], v[132:135], v[60:63], v[36:39]
    ds_read_b128 v[56:59], v222 offset:7424
    s_waitcnt lgkmcnt(10)
    v_mfma_f32_16x16x32_bf16 v[40:43], v[132:135], v[64:67], v[40:43]
    ds_read_b128 v[60:63], v222 offset:6720
    s_waitcnt lgkmcnt(10)
    v_mfma_f32_16x16x32_bf16 v[44:47], v[132:135], v[68:71], v[44:47]
    ds_read_b128 v[64:67], v222 offset:7104
    s_waitcnt lgkmcnt(10)
    v_mfma_f32_16x16x32_bf16 v[36:39], v[136:139], v[72:75], v[36:39]
    ds_read_b128 v[68:71], v222 offset:7488
    s_waitcnt lgkmcnt(10)
    v_mfma_f32_16x16x32_bf16 v[40:43], v[136:139], v[76:79], v[40:43]
    ds_read_b128 v[72:75], v225 offset:256
    s_waitcnt lgkmcnt(10)
    v_mfma_f32_16x16x32_bf16 v[44:47], v[136:139], v[80:83], v[44:47]
    ds_read_b128 v[76:79], v225 offset:640
    s_waitcnt lgkmcnt(10)
    v_mfma_f32_16x16x32_bf16 v[36:39], v[140:143], v[84:87], v[36:39]
    ds_read_b128 v[80:83], v225 offset:1024
    s_waitcnt lgkmcnt(10)
    v_mfma_f32_16x16x32_bf16 v[40:43], v[140:143], v[88:91], v[40:43]
    ds_read_b128 v[84:87], v225 offset:320
    s_waitcnt lgkmcnt(10)
    v_mfma_f32_16x16x32_bf16 v[44:47], v[140:143], v[92:95], v[44:47]
    ds_read_b128 v[88:91], v225 offset:704
    s_waitcnt lgkmcnt(10)
    v_mfma_f32_16x16x32_bf16 v[36:39], v[144:147], v[48:51], v[36:39]
    ds_read_b128 v[92:95], v225 offset:1088
    s_waitcnt lgkmcnt(10)
    v_mfma_f32_16x16x32_bf16 v[40:43], v[144:147], v[52:55], v[40:43]
    ds_read_b128 v[48:51], v225 offset:384
    s_waitcnt lgkmcnt(10)
    v_mfma_f32_16x16x32_bf16 v[44:47], v[144:147], v[56:59], v[44:47]
    ds_read_b128 v[52:55], v225 offset:768
    s_waitcnt lgkmcnt(10)
    v_mfma_f32_16x16x32_bf16 v[36:39], v[148:151], v[60:63], v[36:39]
    ds_read_b128 v[56:59], v225 offset:1152
    s_waitcnt lgkmcnt(10)
    v_mfma_f32_16x16x32_bf16 v[40:43], v[148:151], v[64:67], v[40:43]
    ds_read_b128 v[60:63], v225 offset:448
    s_waitcnt lgkmcnt(10)
    v_mfma_f32_16x16x32_bf16 v[44:47], v[148:151], v[68:71], v[44:47]
    ds_read_b128 v[64:67], v225 offset:832
    s_waitcnt lgkmcnt(10)
    v_mfma_f32_16x16x32_bf16 v[36:39], v[152:155], v[72:75], v[36:39]
    ds_read_b128 v[68:71], v225 offset:1216
    s_waitcnt lgkmcnt(10)
    v_mfma_f32_16x16x32_bf16 v[40:43], v[152:155], v[76:79], v[40:43]
    ds_read_b128 v[72:75], v225 offset:512
    s_waitcnt lgkmcnt(10)
    v_mfma_f32_16x16x32_bf16 v[44:47], v[152:155], v[80:83], v[44:47]
    ds_read_b128 v[76:79], v225 offset:896
    s_waitcnt lgkmcnt(10)
    v_mfma_f32_16x16x32_bf16 v[36:39], v[156:159], v[84:87], v[36:39]
    ds_read_b128 v[80:83], v225 offset:1280
    s_waitcnt lgkmcnt(10)
    v_mfma_f32_16x16x32_bf16 v[40:43], v[156:159], v[88:91], v[40:43]
    ds_read_b128 v[84:87], v225 offset:576
    s_waitcnt lgkmcnt(10)
    v_mfma_f32_16x16x32_bf16 v[44:47], v[156:159], v[92:95], v[44:47]
    ds_read_b128 v[88:91], v225 offset:960
    s_waitcnt lgkmcnt(10)
    v_mfma_f32_16x16x32_bf16 v[36:39], v[160:163], v[48:51], v[36:39]
    ds_read_b128 v[92:95], v225 offset:1344
    s_waitcnt lgkmcnt(10)
    v_mfma_f32_16x16x32_bf16 v[40:43], v[160:163], v[52:55], v[40:43]
    s_waitcnt lgkmcnt(9)
    v_mfma_f32_16x16x32_bf16 v[44:47], v[160:163], v[56:59], v[44:47]
    s_waitcnt lgkmcnt(8)
    v_mfma_f32_16x16x32_bf16 v[36:39], v[164:167], v[60:63], v[36:39]
    s_waitcnt lgkmcnt(7)
    v_mfma_f32_16x16x32_bf16 v[40:43], v[164:167], v[64:67], v[40:43]
    s_waitcnt lgkmcnt(6)
    v_mfma_f32_16x16x32_bf16 v[44:47], v[164:167], v[68:71], v[44:47]
    s_waitcnt lgkmcnt(5)
    v_mfma_f32_16x16x32_bf16 v[36:39], v[168:171], v[72:75], v[36:39]
    s_waitcnt lgkmcnt(4)
    v_mfma_f32_16x16x32_bf16 v[40:43], v[168:171], v[76:79], v[40:43]
    s_waitcnt lgkmcnt(3)
    v_mfma_f32_16x16x32_bf16 v[44:47], v[168:171], v[80:83], v[44:47]
    s_waitcnt lgkmcnt(2)
    v_mfma_f32_16x16x32_bf16 v[36:39], v[172:175], v[84:87], v[36:39]
    s_waitcnt lgkmcnt(1)
    v_mfma_f32_16x16x32_bf16 v[40:43], v[172:175], v[88:91], v[40:43]
    s_waitcnt lgkmcnt(0)
    v_mfma_f32_16x16x32_bf16 v[44:47], v[172:175], v[92:95], v[44:47]
    s_lshl_b32 s60, s54, 9
    s_lshl_b32 s61, s20, 6
    s_add_u32 s60, s60, s61
    s_mul_i32 s60, s60, 192
    s_add_u32 s60, s60, 10485760
    v_mul_u32_u24 v227, 96, v252
    s_cmp_lg_u32 s28, 0
    s_cbranch_scc1 K2_NOACC
    buffer_load_dwordx4 v[48:51], v227, s[8:11], s60 offen offset:0
    buffer_load_dwordx4 v[52:55], v227, s[8:11], s60 offen offset:16
    buffer_load_dwordx4 v[56:59], v227, s[8:11], s60 offen offset:32
    buffer_load_dwordx4 v[60:63], v227, s[8:11], s60 offen offset:48
    buffer_load_dwordx4 v[64:67], v227, s[8:11], s60 offen offset:64
    buffer_load_dwordx4 v[68:71], v227, s[8:11], s60 offen offset:80
    buffer_load_dwordx4 v[72:75], v227, s[8:11], s60 offen offset:96
    buffer_load_dwordx4 v[76:79], v227, s[8:11], s60 offen offset:112
    buffer_load_dwordx4 v[80:83], v227, s[8:11], s60 offen offset:128
    buffer_load_dwordx4 v[84:87], v227, s[8:11], s60 offen offset:144
    buffer_load_dwordx4 v[88:91], v227, s[8:11], s60 offen offset:160
    buffer_load_dwordx4 v[92:95], v227, s[8:11], s60 offen offset:176
    s_waitcnt vmcnt(0)
    v_add_f32 v0, v0, v48
    v_add_f32 v1, v1, v49
    v_add_f32 v2, v2, v50
    v_add_f32 v3, v3, v51
    v_add_f32 v4, v4, v52
    v_add_f32 v5, v5, v53
    v_add_f32 v6, v6, v54
    v_add_f32 v7, v7, v55
    v_add_f32 v8, v8, v56
    v_add_f32 v9, v9, v57
    v_add_f32 v10, v10, v58
    v_add_f32 v11, v11, v59
    v_add_f32 v12, v12, v60
    v_add_f32 v13, v13, v61
    v_add_f32 v14, v14, v62
    v_add_f32 v15, v15, v63
    v_add_f32 v16, v16, v64
    v_add_f32 v17, v17, v65
    v_add_f32 v18, v18, v66
    v_add_f32 v19, v19, v67
    v_add_f32 v20, v20, v68
    v_add_f32 v21, v21, v69
    v_add_f32 v22, v22, v70
    v_add_f32 v23, v23, v71
    v_add_f32 v24, v24, v72
    v_add_f32 v25, v25, v73
    v_add_f32 v26, v26, v74
    v_add_f32 v27, v27, v75
    v_add_f32 v28, v28, v76
    v_add_f32 v29, v29, v77
    v_add_f32 v30, v30, v78
    v_add_f32 v31, v31, v79
    v_add_f32 v32, v32, v80
    v_add_f32 v33, v33, v81
    v_add_f32 v34, v34, v82
    v_add_f32 v35, v35, v83
    v_add_f32 v36, v36, v84
    v_add_f32 v37, v37, v85
    v_add_f32 v38, v38, v86
    v_add_f32 v39, v39, v87
    v_add_f32 v40, v40, v88
    v_add_f32 v41, v41, v89
    v_add_f32 v42, v42, v90
    v_add_f32 v43, v43, v91
    v_add_f32 v44, v44, v92
    v_add_f32 v45, v45, v93
    v_add_f32 v46, v46, v94
    v_add_f32 v47, v47, v95
K2_NOACC:
    s_barrier
    s_cmp_eq_u32 s55, 0
    s_cbranch_scc1 K2_SPILL
    v_mul_f32 v200, s63, v0
    v_mul_f32 v201, s63, v1
    v_mul_f32 v202, s63, v2
    v_mul_f32 v203, s63, v3
    v_exp_f32 v200, v200
    v_exp_f32 v201, v201
    v_exp_f32 v202, v202
    v_exp_f32 v203, v203
    v_add_f32 v200, 1.0, v200
    v_add_f32 v201, 1.0, v201
    v_add_f32 v202, 1.0, v202
    v_add_f32 v203, 1.0, v203
    v_rcp_f32 v200, v200
    v_rcp_f32 v201, v201
    v_rcp_f32 v202, v202
    v_rcp_f32 v203, v203
    v_cvt_pk_bf16_f32 v176, v0, v1
    v_cvt_pk_bf16_f32 v177, v2, v3
    v_mul_f32 v4, v4, v200
    v_mul_f32 v5, v5, v201
    v_mul_f32 v6, v6, v202
    v_mul_f32 v7, v7, v203
    v_cvt_pk_bf16_f32 v178, v4, v5
    v_cvt_pk_bf16_f32 v179, v6, v7
    v_mul_f32 v8, v8, v200
    v_mul_f32 v9, v9, v201
    v_mul_f32 v10, v10, v202
    v_mul_f32 v11, v11, v203
    v_cvt_pk_bf16_f32 v180, v8, v9
    v_cvt_pk_bf16_f32 v181, v10, v11
    v_mul_f32 v12, v12, v200
    v_mul_f32 v13, v13, v201
    v_mul_f32 v14, v14, v202
    v_mul_f32 v15, v15, v203
    v_cvt_pk_bf16_f32 v182, v12, v13
    v_cvt_pk_bf16_f32 v183, v14, v15
    ds_write_b64 v226, v[176:177] offset:0
    ds_write_b64 v226, v[178:179] offset:256
    ds_write_b64 v226, v[180:181] offset:512
    ds_write_b64 v226, v[182:183] offset:768
    s_waitcnt lgkmcnt(0)
    s_barrier
    ds_read_b128 v[192:195], v228 offset:0
    ds_read_b128 v[196:199], v228 offset:1536
    s_waitcnt lgkmcnt(0)
    buffer_store_dwordx4 v[192:195], v229, s[12:15], s62 offen sc1
    s_add_u32 s62, s62, 8192
    buffer_store_dwordx4 v[196:199], v229, s[12:15], s62 offen sc1
    s_add_u32 s62, s62, 8192
    v_mul_f32 v200, s63, v16
    v_mul_f32 v201, s63, v17
    v_mul_f32 v202, s63, v18
    v_mul_f32 v203, s63, v19
    v_exp_f32 v200, v200
    v_exp_f32 v201, v201
    v_exp_f32 v202, v202
    v_exp_f32 v203, v203
    v_add_f32 v200, 1.0, v200
    v_add_f32 v201, 1.0, v201
    v_add_f32 v202, 1.0, v202
    v_add_f32 v203, 1.0, v203
    v_rcp_f32 v200, v200
    v_rcp_f32 v201, v201
    v_rcp_f32 v202, v202
    v_rcp_f32 v203, v203
    v_cvt_pk_bf16_f32 v184, v16, v17
    v_cvt_pk_bf16_f32 v185, v18, v19
    v_mul_f32 v20, v20, v200
    v_mul_f32 v21, v21, v201
    v_mul_f32 v22, v22, v202
    v_mul_f32 v23, v23, v203
    v_cvt_pk_bf16_f32 v186, v20, v21
    v_cvt_pk_bf16_f32 v187, v22, v23
    v_mul_f32 v24, v24, v200
    v_mul_f32 v25, v25, v201
    v_mul_f32 v26, v26, v202
    v_mul_f32 v27, v27, v203
    v_cvt_pk_bf16_f32 v188, v24, v25
    v_cvt_pk_bf16_f32 v189, v26, v27
    v_mul_f32 v28, v28, v200
    v_mul_f32 v29, v29, v201
    v_mul_f32 v30, v30, v202
    v_mul_f32 v31, v31, v203
    v_cvt_pk_bf16_f32 v190, v28, v29
    v_cvt_pk_bf16_f32 v191, v30, v31
    ds_write_b64 v226, v[184:185] offset:3072
    ds_write_b64 v226, v[186:187] offset:3328
    ds_write_b64 v226, v[188:189] offset:3584
    ds_write_b64 v226, v[190:191] offset:3840
    s_waitcnt lgkmcnt(0)
    s_barrier
    ds_read_b128 v[192:195], v228 offset:3072
    ds_read_b128 v[196:199], v228 offset:4608
    s_waitcnt lgkmcnt(0)
    buffer_store_dwordx4 v[192:195], v229, s[12:15], s62 offen sc1
    s_add_u32 s62, s62, 8192
    buffer_store_dwordx4 v[196:199], v229, s[12:15], s62 offen sc1
    s_add_u32 s62, s62, 8192
    v_mul_f32 v200, s63, v32
    v_mul_f32 v201, s63, v33
    v_mul_f32 v202, s63, v34
    v_mul_f32 v203, s63, v35
    v_exp_f32 v200, v200
    v_exp_f32 v201, v201
    v_exp_f32 v202, v202
    v_exp_f32 v203, v203
    v_add_f32 v200, 1.0, v200
    v_add_f32 v201, 1.0, v201
    v_add_f32 v202, 1.0, v202
    v_add_f32 v203, 1.0, v203
    v_rcp_f32 v200, v200
    v_rcp_f32 v201, v201
    v_rcp_f32 v202, v202
    v_rcp_f32 v203, v203
    v_cvt_pk_bf16_f32 v176, v32, v33
    v_cvt_pk_bf16_f32 v177, v34, v35
    v_mul_f32 v36, v36, v200
    v_mul_f32 v37, v37, v201
    v_mul_f32 v38, v38, v202
    v_mul_f32 v39, v39, v203
    v_cvt_pk_bf16_f32 v178, v36, v37
    v_cvt_pk_bf16_f32 v179, v38, v39
    v_mul_f32 v40, v40, v200
    v_mul_f32 v41, v41, v201
    v_mul_f32 v42, v42, v202
    v_mul_f32 v43, v43, v203
    v_cvt_pk_bf16_f32 v180, v40, v41
    v_cvt_pk_bf16_f32 v181, v42, v43
    v_mul_f32 v44, v44, v200
    v_mul_f32 v45, v45, v201
    v_mul_f32 v46, v46, v202
    v_mul_f32 v47, v47, v203
    v_cvt_pk_bf16_f32 v182, v44, v45
    v_cvt_pk_bf16_f32 v183, v46, v47
    s_mov_b64 exec, s[56:57]
    ds_write_b64 v226, v[176:177] offset:6144
    ds_write_b64 v226, v[178:179] offset:6400
    ds_write_b64 v226, v[180:181] offset:6656
    ds_write_b64 v226, v[182:183] offset:6912
    s_mov_b64 exec, -1
    s_waitcnt lgkmcnt(0)
    s_barrier
    s_branch K2_LASTROW
K2_SPILL:
    buffer_store_dwordx4 v[0:3], v227, s[8:11], s60 offen offset:0
    buffer_store_dwordx4 v[4:7], v227, s[8:11], s60 offen offset:16
    buffer_store_dwordx4 v[8:11], v227, s[8:11], s60 offen offset:32
    buffer_store_dwordx4 v[12:15], v227, s[8:11], s60 offen offset:48
    buffer_store_dwordx4 v[16:19], v227, s[8:11], s60 offen offset:64
    buffer_store_dwordx4 v[20:23], v227, s[8:11], s60 offen offset:80
    buffer_store_dwordx4 v[24:27], v227, s[8:11], s60 offen offset:96
    buffer_store_dwordx4 v[28:31], v227, s[8:11], s60 offen offset:112
    buffer_store_dwordx4 v[32:35], v227, s[8:11], s60 offen offset:128
    buffer_store_dwordx4 v[36:39], v227, s[8:11], s60 offen offset:144
    buffer_store_dwordx4 v[40:43], v227, s[8:11], s60 offen offset:160
    buffer_store_dwordx4 v[44:47], v227, s[8:11], s60 offen offset:176
    s_mov_b32 s28, 0
    s_waitcnt vmcnt(0)
    s_cmp_lt_u32 s24, s25
    s_cbranch_scc1 K2_LOAD
    s_add_u32 s23, s23, 20
    s_branch K2_WINDOW
K2_END:
    s_endpgm
.section .rodata,"a"
.p2align 6
.amdhsa_kernel tp_sort_kernel
  .amdhsa_next_free_vgpr 72
  .amdhsa_next_free_sgpr 76
  .amdhsa_accum_offset 72
  .amdhsa_group_segment_fixed_size 0
  .amdhsa_kernarg_size 96
  .amdhsa_user_sgpr_count 2
  .amdhsa_user_sgpr_kernarg_segment_ptr 1
  .amdhsa_system_sgpr_workgroup_id_x 1
  .amdhsa_float_denorm_mode_32 3
.end_amdhsa_kernel
.p2align 6
.amdhsa_kernel tp_main_kernel
  .amdhsa_next_free_vgpr 256
  .amdhsa_next_free_sgpr 76
  .amdhsa_accum_offset 256
  .amdhsa_group_segment_fixed_size 0
  .amdhsa_kernarg_size 96
  .amdhsa_user_sgpr_count 2
  .amdhsa_user_sgpr_kernarg_segment_ptr 1
  .amdhsa_system_sgpr_workgroup_id_x 1
  .amdhsa_float_denorm_mode_32 3
.end_amdhsa_kernel
```

```asm
; @launch kernel=tp_sort_kernel grid=(250,1,1) block=(320,1,1) lds=22528
; @launch kernel=tp_main_kernel grid=(256,1,1) block=(512,1,1) lds=163840
.amdgcn_target "amdgcn-amd-amdhsa--gfx950"
.text
.globl tp_sort_kernel
.p2align 8
.type tp_sort_kernel,@function
tp_sort_kernel:
    s_cmp_ge_u32 s2, 250
    s_cbranch_scc1 K1_END
    s_load_dwordx2 s[36:37], s[0:1], 8
    s_load_dwordx4 s[40:43], s[0:1], 24
    s_load_dwordx4 s[44:47], s[0:1], 40
    s_load_dwordx2 s[48:49], s[0:1], 56
    s_load_dwordx2 s[50:51], s[0:1], 88
    s_load_dwordx2 s[30:31], s[0:1], 0
    s_load_dwordx2 s[32:33], s[0:1], 16
    v_lshrrev_b32 v1, 6, v0
    v_lshlrev_b32 v5, 4, v0
    v_readfirstlane_b32 s3, v1
    v_mul_u32_u24 v4, 24, v0
    v_lshlrev_b32 v2, 2, v0
    v_and_b32 v8, 63, v0
    v_lshlrev_b32 v9, 4, v8
    v_mov_b32 v6, 0
    v_mov_b32 v7, 1
    s_mul_i32 s52, s2, 5120
    s_mul_i32 s53, s2, 7680
    s_waitcnt lgkmcnt(0)
    s_mov_b32 s4, s42
    s_and_b32 s5, s43, 0xffff
    s_mov_b32 s6, 1280000
    s_mov_b32 s7, 0x20000
    s_mov_b32 s8, s40
    s_and_b32 s9, s41, 0xffff
    s_mov_b32 s10, 1280000
    s_mov_b32 s11, 0x20000
    s_mov_b32 s12, s36
    s_and_b32 s13, s37, 0xffff
    s_mov_b32 s14, 1920000
    s_mov_b32 s15, 0x20000
    s_mov_b32 s20, s50
    s_and_b32 s21, s51, 0xffff
    s_mov_b32 s22, 37748736
    s_mov_b32 s23, 0x20000
    buffer_load_dwordx4 v[12:15], v5, s[4:7], s52 offen
    buffer_load_dwordx4 v[16:19], v5, s[8:11], s52 offen
    buffer_load_dwordx4 v[20:23], v4, s[12:15], s53 offen
    buffer_load_dwordx2 v[24:25], v4, s[12:15], s53 offen offset:16
    s_cmp_eq_u32 s3, 4
    s_cbranch_scc1 K1_PREP
    ds_write_b32 v2, v6
    s_branch K1_GO
K1_PREP:
    s_cmp_ge_u32 s2, 200
    s_cbranch_scc1 K1_GO
    v_and_b32 v1, 15, v8
    v_lshrrev_b32 v3, 4, v8
    s_cmp_ge_u32 s2, 160
    s_cbranch_scc1 K1_WT
    s_cmp_ge_u32 s2, 64
    s_cbranch_scc1 K1_S1
    s_lshr_b32 s24, s2, 3
    s_and_b32 s25, s2, 7
    s_lshr_b32 s26, s25, 2
    s_bfe_u32 s27, s25, 0x10001
    s_and_b32 s28, s25, 1
    s_mov_b32 s16, s46
    s_and_b32 s17, s47, 0xffff
    s_mov_b32 s18, 65536
    s_mov_b32 s19, 0x20000
    s_branch K1_SC
K1_S1:
    s_sub_u32 s29, s2, 64
    s_mul_i32 s24, s29, 43
    s_lshr_b32 s24, s24, 9
    s_mul_i32 s25, s24, 12
    s_sub_u32 s25, s29, s25
    s_cmp_ge_u32 s25, 6
    s_cselect_b32 s26, 1, 0
    s_mul_i32 s27, s26, 6
    s_sub_u32 s27, s25, s27
    s_lshr_b32 s27, s27, 1
    s_and_b32 s28, s25, 1
    s_add_u32 s25, s25, 8
    s_mov_b32 s16, s48
    s_and_b32 s17, s49, 0xffff
    s_mov_b32 s18, 98304
    s_mov_b32 s19, 0x20000
K1_SC:
    s_lshl_b32 s27, s27, 7
    s_lshl_b32 s26, s26, 6
    s_lshl_b32 s28, s28, 5
    s_add_u32 s27, s27, s26
    s_add_u32 s27, s27, s28
    s_lshl_b32 s27, s27, 8
    s_lshl_b32 s26, s24, 5
    s_add_u32 s27, s27, s26
    v_lshlrev_b32 v3, 11, v3
    v_lshl_add_u32 v3, v1, 1, v3
    buffer_load_ushort v64, v3, s[16:19], s27 offen offset:0
    buffer_load_ushort v65, v3, s[16:19], s27 offen offset:256
    buffer_load_ushort v66, v3, s[16:19], s27 offen offset:512
    buffer_load_ushort v67, v3, s[16:19], s27 offen offset:768
    buffer_load_ushort v68, v3, s[16:19], s27 offen offset:1024
    buffer_load_ushort v69, v3, s[16:19], s27 offen offset:1280
    buffer_load_ushort v70, v3, s[16:19], s27 offen offset:1536
    buffer_load_ushort v71, v3, s[16:19], s27 offen offset:1792
    s_mul_i32 s24, s24, 20
    s_add_u32 s24, s24, s25
    s_lshl_b32 s24, s24, 10
    s_add_u32 s24, s24, 6815744
    s_branch K1_GO
K1_WT:
    s_sub_u32 s24, s2, 160
    s_cmp_ge_u32 s24, 20
    s_cselect_b32 s26, 1, 0
    s_mul_i32 s25, s26, 20
    s_sub_u32 s25, s24, s25
    s_lshr_b32 s27, s25, 2
    s_bfe_u32 s28, s25, 0x10001
    s_and_b32 s25, s25, 1
    s_mul_i32 s25, s25, 10240
    s_lshl_b32 s27, s27, 8
    s_lshl_b32 s26, s26, 7
    s_lshl_b32 s28, s28, 6
    s_add_u32 s27, s27, s26
    s_add_u32 s27, s27, s28
    s_add_u32 s27, s27, s25
    s_mov_b32 s16, s44
    s_and_b32 s17, s45, 0xffff
    s_mov_b32 s18, 20480
    s_mov_b32 s19, 0x20000
    v_and_b32 v1, 31, v8
    v_lshrrev_b32 v3, 5, v8
    v_mul_u32_u24 v3, 5120, v3
    v_lshl_add_u32 v3, v1, 1, v3
    v_mov_b32 v64, 0
    v_mov_b32 v66, 0
    v_mov_b32 v68, 0
    v_mov_b32 v70, 0
    buffer_load_ushort v65, v3, s[16:19], s27 offen offset:0
    buffer_load_ushort v67, v3, s[16:19], s27 offen offset:1280
    buffer_load_ushort v69, v3, s[16:19], s27 offen offset:2560
    buffer_load_ushort v71, v3, s[16:19], s27 offen offset:3840
    s_lshl_b32 s24, s24, 10
    s_add_u32 s24, s24, 6979584
K1_GO:
    s_mov_b32 s58, 429497
    s_movk_i32 s59, 625
    s_waitcnt lgkmcnt(0)
    s_barrier
    s_cmp_eq_u32 s3, 4
    s_cbranch_scc1 K1_W4
    s_waitcnt vmcnt(3)
    s_branch K1_W4D
K1_W4:
    s_waitcnt vmcnt(0)
K1_W4D:
    v_mul_u32_u24 v28, s58, v12
    v_lshrrev_b32 v28, 24, v28
    v_lshlrev_b32 v32, 2, v28
    ds_add_rtn_u32 v36, v32, v7
    v_mul_u32_u24 v29, s58, v13
    v_lshrrev_b32 v29, 24, v29
    v_lshlrev_b32 v33, 2, v29
    ds_add_rtn_u32 v37, v33, v7
    v_mul_u32_u24 v30, s58, v14
    v_lshrrev_b32 v30, 24, v30
    v_lshlrev_b32 v34, 2, v30
    ds_add_rtn_u32 v38, v34, v7
    v_mul_u32_u24 v31, s58, v15
    v_lshrrev_b32 v31, 24, v31
    v_lshlrev_b32 v35, 2, v31
    ds_add_rtn_u32 v39, v35, v7
    v_mad_u32_u24 v28, v28, s59, 15
    v_lshrrev_b32 v28, 4, v28
    v_sub_u32 v28, v12, v28
    v_add_u32 v12, 0, v2
    v_lshlrev_b32 v12, 14, v12
    v_lshl_or_b32 v28, v28, 25, v12
    v_mad_u32_u24 v29, v29, s59, 15
    v_lshrrev_b32 v29, 4, v29
    v_sub_u32 v29, v13, v29
    v_add_u32 v13, 1, v2
    v_lshlrev_b32 v13, 14, v13
    v_lshl_or_b32 v29, v29, 25, v13
    v_mad_u32_u24 v30, v30, s59, 15
    v_lshrrev_b32 v30, 4, v30
    v_sub_u32 v30, v14, v30
    v_add_u32 v14, 2, v2
    v_lshlrev_b32 v14, 14, v14
    v_lshl_or_b32 v30, v30, 25, v14
    v_mad_u32_u24 v31, v31, s59, 15
    v_lshrrev_b32 v31, 4, v31
    v_sub_u32 v31, v15, v31
    v_add_u32 v15, 3, v2
    v_lshlrev_b32 v15, 14, v15
    v_lshl_or_b32 v31, v31, 25, v15
    s_waitcnt lgkmcnt(0)
    s_barrier
    ds_read_b128 v[40:43], v9
    s_waitcnt lgkmcnt(0)
    v_add_u32 v45, v40, v41
    v_add_u32 v46, v45, v42
    v_add_u32 v47, v46, v43
    v_mov_b32 v48, v47
    s_nop 1
    v_add_u32_dpp v48, v48, v48 row_shr:1 row_mask:0xf bank_mask:0xf bound_ctrl:0
    s_nop 1
    v_add_u32_dpp v48, v48, v48 row_shr:2 row_mask:0xf bank_mask:0xf bound_ctrl:0
    s_nop 1
    v_add_u32_dpp v48, v48, v48 row_shr:4 row_mask:0xf bank_mask:0xf bound_ctrl:0
    s_nop 1
    v_add_u32_dpp v48, v48, v48 row_shr:8 row_mask:0xf bank_mask:0xf bound_ctrl:0
    s_nop 1
    v_add_u32_dpp v48, v48, v48 row_bcast:15 row_mask:0xa bank_mask:0xf
    s_nop 1
    v_add_u32_dpp v48, v48, v48 row_bcast:31 row_mask:0xc bank_mask:0xf
    v_sub_u32 v48, v48, v47
    v_add_u32 v49, v48, v40
    v_add_u32 v50, v48, v45
    v_add_u32 v51, v48, v46
    ds_write_b128 v9, v[48:51] offset:1024
    s_cmp_lg_u32 s3, 0
    s_cbranch_scc1 K1_NOTBL
    v_lshl_or_b32 v52, v40, 16, v48
    v_lshl_or_b32 v53, v41, 16, v49
    v_lshl_or_b32 v54, v42, 16, v50
    v_lshl_or_b32 v55, v43, 16, v51
    s_mul_i32 s62, s2, 1152
    s_add_u32 s62, s62, 6291456
    buffer_store_dwordx4 v[52:55], v9, s[20:23], s62 offen sc1
K1_NOTBL:
    s_waitcnt lgkmcnt(0)
    ds_read_b32 v32, v32 offset:1024
    ds_read_b32 v33, v33 offset:1024
    ds_read_b32 v34, v34 offset:1024
    ds_read_b32 v35, v35 offset:1024
    s_cmp_lg_u32 s3, 0
    s_cbranch_scc1 K1_W0
    s_waitcnt vmcnt(1)
    s_branch K1_W0D
K1_W0:
    s_waitcnt vmcnt(0)
K1_W0D:
    v_lshlrev_b32 v40, 16, v20
    v_and_b32 v41, 0xffff0000, v20
    v_lshlrev_b32 v42, 16, v21
    v_or_b32 v43, v28, v16
    v_and_b32 v44, 0xffff0000, v21
    v_lshlrev_b32 v45, 16, v22
    v_and_b32 v46, 0xffff0000, v22
    v_or_b32 v47, v29, v17
    v_lshlrev_b32 v48, 16, v23
    v_and_b32 v49, 0xffff0000, v23
    v_lshlrev_b32 v50, 16, v24
    v_or_b32 v51, v30, v18
    v_and_b32 v52, 0xffff0000, v24
    v_lshlrev_b32 v53, 16, v25
    v_and_b32 v54, 0xffff0000, v25
    v_or_b32 v55, v31, v19
    s_waitcnt lgkmcnt(0)
    v_add_lshl_u32 v32, v32, v36, 4
    ds_write_b128 v32, v[40:43] offset:2048
    v_add_lshl_u32 v33, v33, v37, 4
    ds_write_b128 v33, v[44:47] offset:2048
    v_add_lshl_u32 v34, v34, v38, 4
    ds_write_b128 v34, v[48:51] offset:2048
    v_add_lshl_u32 v35, v35, v39, 4
    ds_write_b128 v35, v[52:55] offset:2048
    s_mul_i32 s52, s2, 20608
    s_waitcnt lgkmcnt(0)
    s_barrier
    ds_read_b128 v[12:15], v5 offset:2048
    ds_read_b128 v[16:19], v5 offset:7168
    ds_read_b128 v[20:23], v5 offset:12288
    ds_read_b128 v[24:27], v5 offset:17408
    s_waitcnt lgkmcnt(3)
    buffer_store_dwordx4 v[12:15], v5, s[20:23], s52 offen sc1
    s_add_u32 s52, s52, 5120
    s_waitcnt lgkmcnt(2)
    buffer_store_dwordx4 v[16:19], v5, s[20:23], s52 offen sc1
    s_add_u32 s52, s52, 5120
    s_waitcnt lgkmcnt(1)
    buffer_store_dwordx4 v[20:23], v5, s[20:23], s52 offen sc1
    s_add_u32 s52, s52, 5120
    s_waitcnt lgkmcnt(0)
    buffer_store_dwordx4 v[24:27], v5, s[20:23], s52 offen sc1
    s_cmp_lg_u32 s3, 4
    s_cbranch_scc1 K1_FIN
    s_cmp_ge_u32 s2, 200
    s_cbranch_scc1 K1_FIN
    v_lshl_or_b32 v40, v65, 16, v64
    v_lshl_or_b32 v41, v67, 16, v66
    v_lshl_or_b32 v42, v69, 16, v68
    v_lshl_or_b32 v43, v71, 16, v70
    buffer_store_dwordx4 v[40:43], v9, s[20:23], s24 offen sc1
K1_FIN:
K1_END:
    s_endpgm
.globl tp_main_kernel
.p2align 8
.type tp_main_kernel,@function
tp_main_kernel:
    s_cmp_ge_u32 s2, 256
    s_cbranch_scc1 K2_END
    s_load_dwordx2 s[58:59], s[0:1], 0
    s_load_dwordx2 s[60:61], s[0:1], 72
    s_load_dwordx2 s[62:63], s[0:1], 88
    s_load_dwordx2 s[64:65], s[0:1], 16
    v_lshrrev_b32 v1, 6, v0
    s_mov_b32 s54, s2
    v_readfirstlane_b32 s20, v1
    s_mul_i32 s21, s2, 625
    s_add_u32 s22, s21, 640
    s_add_u32 s21, s21, 15
    s_lshr_b32 s21, s21, 4
    s_lshr_b32 s22, s22, 4
    s_sub_u32 s22, s22, s21
    s_mov_b32 s23, 0
    s_mov_b32 s28, 1
    s_movk_i32 s39, 1024
    s_lshl_b32 s37, s20, 13
    s_mov_b32 s53, 163616
    s_lshl_b32 s52, s20, 2
    s_add_u32 s52, s52, s53
    s_add_u32 s68, s37, 0
    s_add_u32 s69, s37, 2048
    s_add_u32 s70, s37, 4096
    s_add_u32 s71, s37, 6144
    s_waitcnt lgkmcnt(0)
    s_mov_b32 s8, s62
    s_and_b32 s9, s63, 0xffff
    s_mov_b32 s10, 37748736
    s_mov_b32 s11, 0x20000
    s_mov_b32 s4, s58
    s_and_b32 s5, s59, 0xffff
    s_mov_b32 s6, 10240000
    s_mov_b32 s7, 0x20000
    s_mov_b32 s12, s60
    s_and_b32 s13, s61, 0xffff
    s_mov_b32 s14, 10240000
    s_mov_b32 s15, 0x20000
    s_mov_b32 s16, s64
    s_and_b32 s17, s65, 0xffff
    s_mov_b32 s18, 10240000
    s_mov_b32 s19, 0x20000
    s_sub_u32 s58, s58, 1024
    s_subb_u32 s59, s59, 0
    s_mov_b32 s72, s58
    s_and_b32 s73, s59, 0xffff
    s_mov_b32 s74, 10241024
    s_mov_b32 s75, 0x20000
K2_WINDOW:
    s_mov_b32 s24, 0
    s_mov_b32 s25, 1
K2_LOAD:
    v_mbcnt_lo_u32_b32 v176, -1, 0
    v_mbcnt_hi_u32_b32 v176, -1, v176
    s_lshl_b32 s58, s20, 6
    v_add_u32 v177, s58, v176
    v_lshrrev_b32 v178, 1, v177
    v_min_u32 v178, 249, v178
    v_mul_u32_u24 v1, 1152, v178
    s_lshl_b32 s58, s54, 2
    s_add_u32 s58, s58, 6291456
    buffer_load_dword v179, v1, s[8:11], s58 offen
    v_lshlrev_b32 v70, 4, v176
    s_cmp_ge_u32 s20, 5
    s_cbranch_scc1 K2_NOW
    s_lshl_b32 s58, s20, 12
    s_mov_b32 m0, s58
    s_add_u32 s58, s58, 6979584
    buffer_load_dwordx4 v70, s[8:11], s58 offen offset:0 lds
    buffer_load_dwordx4 v70, s[8:11], s58 offen offset:1024 lds
    buffer_load_dwordx4 v70, s[8:11], s58 offen offset:2048 lds
    buffer_load_dwordx4 v70, s[8:11], s58 offen offset:3072 lds
K2_NOW:
    v_mul_u32_u24 v3, 437, v177
    v_lshrrev_b32 v3, 16, v3
    v_mul_u32_u24 v3, 150, v3
    v_sub_u32 v3, v177, v3
    v_mov_b32 v8, -1
    v_mov_b32 v5, 1.0
    v_cmp_gt_u32 vcc, 48, v3
    s_nop 1
    v_cndmask_b32 v8, v8, 0, vcc
    v_cmp_gt_u32 vcc, 12, v3
    s_nop 1
    v_cndmask_b32 v8, v8, v5, vcc
    v_lshlrev_b32 v6, 4, v177
    v_add_u32 v6, 65536, v6
    v_add_u32 v7, 64800, v6
    v_mov_b32 v9, v8
    v_mov_b32 v10, v8
    v_mov_b32 v11, v8
    v_cmp_gt_u32 vcc, 500, v177
    s_nop 0
    s_mov_b64 s[56:57], vcc
    v_cmp_gt_u32 vcc, 450, v177
    s_nop 0
    s_mov_b64 exec, vcc
    ds_write_b128 v6, v[8:11] offset:0
    ds_write_b128 v6, v[8:11] offset:7200
    ds_write_b128 v6, v[8:11] offset:14400
    ds_write_b128 v6, v[8:11] offset:21600
    ds_write_b128 v6, v[8:11] offset:28800
    ds_write_b128 v6, v[8:11] offset:36000
    ds_write_b128 v6, v[8:11] offset:43200
    ds_write_b128 v6, v[8:11] offset:50400
    ds_write_b128 v6, v[8:11] offset:57600
    ds_write_b128 v7, v[8:11] offset:0
    ds_write_b128 v7, v[8:11] offset:7200
    ds_write_b128 v7, v[8:11] offset:14400
    ds_write_b128 v7, v[8:11] offset:21600
    v_cmp_gt_u32 vcc, 268, v177
    s_nop 0
    s_cbranch_vccz K2_NOCL
    s_mov_b64 exec, vcc
    ds_write_b128 v7, v[8:11] offset:28800
K2_NOCL:
    s_mov_b64 exec, -1
    s_cmp_lg_u32 s20, 0
    s_cbranch_scc1 K2_NOH
    v_mov_b32 v3, 0
    v_mov_b32 v5, -1
    v_lshlrev_b32 v4, 2, v176
    v_add_u32 v4, 163424, v4
    s_mov_b64 exec, 0x1ff
    ds_write_b32 v4, v3 offset:192
    s_mov_b64 exec, 0xff
    ds_write_b32 v4, v5 offset:256
    s_mov_b64 exec, -1
    s_cmp_lg_u32 s24, 0
    s_cbranch_scc1 K2_NOH
    s_mov_b32 exec_hi, 0xffff
    ds_write_b32 v4, v3
    s_mov_b64 exec, 1
    ds_write_b32 v4, v3 offset:228
    s_mov_b64 exec, -1
K2_NOH:
    s_waitcnt vmcnt(0)
    v_cndmask_b32 v179, 0, v179, s[56:57]
    v_and_b32 v1, 1, v177
    v_add_u32 v1, s23, v1
    v_lshrrev_b32 v180, 16, v179
    v_sub_u32 v180, v180, v1
    v_and_b32 v179, 0xffff, v179
    v_add_u32 v179, v179, v1
    v_mul_u32_u24 v181, 20608, v178
    v_lshl_add_u32 v181, v179, 4, v181
    v_mul_u32_u24 v178, 1280, v178
    v_cmp_lt_i32 vcc, 0, v180
    s_nop 0
    s_cbranch_vccz K2_LD_DONE
    s_mov_b64 exec, vcc
    buffer_load_dwordx4 v[0:3], v181, s[8:11], 0 offen offset:0
    v_cmp_lt_i32 vcc, 2, v180
    s_nop 0
    s_cbranch_vccz K2_LD_DONE
    s_mov_b64 exec, vcc
    buffer_load_dwordx4 v[4:7], v181, s[8:11], 0 offen offset:32
    v_cmp_lt_i32 vcc, 4, v180
    s_nop 0
    s_cbranch_vccz K2_LD_DONE
    s_mov_b64 exec, vcc
    buffer_load_dwordx4 v[8:11], v181, s[8:11], 0 offen offset:64
    v_cmp_lt_i32 vcc, 6, v180
    s_nop 0
    s_cbranch_vccz K2_LD_DONE
    s_mov_b64 exec, vcc
    buffer_load_dwordx4 v[12:15], v181, s[8:11], 0 offen offset:96
    v_cmp_lt_i32 vcc, 8, v180
    s_nop 0
    s_cbranch_vccz K2_LD_DONE
    s_mov_b64 exec, vcc
    buffer_load_dwordx4 v[16:19], v181, s[8:11], 0 offen offset:128
    v_cmp_lt_i32 vcc, 10, v180
    s_nop 0
    s_cbranch_vccz K2_LD_DONE
    s_mov_b64 exec, vcc
    buffer_load_dwordx4 v[20:23], v181, s[8:11], 0 offen offset:160
    v_cmp_lt_i32 vcc, 12, v180
    s_nop 0
    s_cbranch_vccz K2_LD_DONE
    s_mov_b64 exec, vcc
    buffer_load_dwordx4 v[24:27], v181, s[8:11], 0 offen offset:192
    v_cmp_lt_i32 vcc, 14, v180
    s_nop 0
    s_cbranch_vccz K2_LD_DONE
    s_mov_b64 exec, vcc
    buffer_load_dwordx4 v[28:31], v181, s[8:11], 0 offen offset:224
    v_cmp_lt_i32 vcc, 16, v180
    s_nop 0
    s_cbranch_vccz K2_LD_DONE
    s_mov_b64 exec, vcc
    buffer_load_dwordx4 v[32:35], v181, s[8:11], 0 offen offset:256
    v_cmp_lt_i32 vcc, 18, v180
    s_nop 0
    s_cbranch_vccz K2_LD_DONE
    s_mov_b64 exec, vcc
    buffer_load_dwordx4 v[36:39], v181, s[8:11], 0 offen offset:288
K2_LD_DONE:
    s_mov_b64 exec, -1
    v_add_lshl_u32 v179, v179, v178, 2
    s_mov_b32 s66, 7340032
    v_and_b32 v60, 15, v176
    v_lshrrev_b32 v61, 5, v176
    v_bfe_u32 v62, v176, 4, 1
    v_lshrrev_b32 v63, 2, v60
    v_and_b32 v64, 3, v60
    v_lshl_add_u32 v65, v61, 3, v63
    v_lshlrev_b32 v249, 5, v65
    v_lshl_add_u32 v249, v64, 3, v249
    v_add_u32 v249, 864, v249
    v_mul_u32_u24 v250, 192, v62
    v_lshl_add_u32 v250, v61, 5, v250
    v_lshrrev_b32 v66, 1, v64
    v_lshl_add_u32 v66, v62, 1, v66
    v_bfe_u32 v67, v63, 1, 1
    v_lshlrev_b32 v67, 2, v67
    v_xor_b32 v66, v66, v67
    v_lshlrev_b32 v66, 4, v66
    v_lshl_add_u32 v66, v65, 7, v66
    v_and_b32 v67, 1, v64
    v_lshl_add_u32 v66, v67, 3, v66
    v_add_u32 v246, s37, v66
    v_xor_b32 v247, 64, v246
    v_lshrrev_b32 v66, 3, v176
    v_lshlrev_b32 v251, 2, v66
    v_add_u32 v251, 768, v251
    v_bfe_u32 v66, v66, 1, 1
    v_lshlrev_b32 v66, 2, v66
    v_and_b32 v67, 7, v176
    v_xor_b32 v66, v66, v67
    v_lshlrev_b32 v248, 4, v66
    v_lshlrev_b32 v252, 1, v176
    v_and_b32 v231, 1, v176
    v_lshlrev_b32 v231, 4, v231
    v_lshrrev_b32 v66, 1, v176
    v_lshlrev_b32 v66, 5, v66
    v_add_u32 v230, 864, v66
    v_mov_b32 v201, 1
    s_waitcnt lgkmcnt(0)
    s_barrier
    ds_read_b128 v[96:99], v70 offset:0
    ds_read_b128 v[100:103], v70 offset:1024
    ds_read_b128 v[104:107], v70 offset:2048
    ds_read_b128 v[108:111], v70 offset:3072
    ds_read_b128 v[112:115], v70 offset:4096
    ds_read_b128 v[116:119], v70 offset:5120
    ds_read_b128 v[120:123], v70 offset:6144
    ds_read_b128 v[124:127], v70 offset:7168
    ds_read_b128 v[128:131], v70 offset:8192
    ds_read_b128 v[132:135], v70 offset:9216
    ds_read_b128 v[136:139], v70 offset:10240
    ds_read_b128 v[140:143], v70 offset:11264
    ds_read_b128 v[144:147], v70 offset:12288
    ds_read_b128 v[148:151], v70 offset:13312
    ds_read_b128 v[152:155], v70 offset:14336
    ds_read_b128 v[156:159], v70 offset:15360
    ds_read_b128 v[160:163], v70 offset:16384
    ds_read_b128 v[164:167], v70 offset:17408
    ds_read_b128 v[168:171], v70 offset:18432
    ds_read_b128 v[172:175], v70 offset:19456
    s_cmp_lg_u32 s24, 0
    s_cbranch_scc1 K2_RK_LOAD
    v_cmp_lt_i32 vcc, 20, v180
    s_nop 0
    s_cbranch_vccz K2_NOMORE
    v_mov_b32 v61, 163652
    ds_write_b32 v61, v201
K2_NOMORE:
    s_mov_b32 s58, 163424
    s_movk_i32 s59, 2400
    v_mov_b32 v202, 65536
    s_waitcnt vmcnt(0)
    v_cmp_lt_i32 vcc, 0, v180
    s_nop 0
    s_cbranch_vccz K2_RK_A
    s_mov_b64 exec, vcc
    v_lshrrev_b32 v50, 25, v3
    v_lshl_add_u32 v40, v50, 2, s58
    ds_add_rtn_u32 v40, v40, v201
    v_mad_u32_u24 v50, v50, s59, v202
    v_bfe_u32 v60, v3, 14, 11
    v_add_lshl_u32 v60, v60, v178, 5
    v_and_b32 v3, 0x3fff, v3
    v_cmp_lt_i32 vcc, 2, v180
    s_nop 0
    s_cbranch_vccz K2_RK_A
    s_mov_b64 exec, vcc
    v_lshrrev_b32 v51, 25, v7
    v_lshl_add_u32 v41, v51, 2, s58
    ds_add_rtn_u32 v41, v41, v201
    v_mad_u32_u24 v51, v51, s59, v202
    v_bfe_u32 v61, v7, 14, 11
    v_add_lshl_u32 v61, v61, v178, 5
    v_and_b32 v7, 0x3fff, v7
    v_cmp_lt_i32 vcc, 4, v180
    s_nop 0
    s_cbranch_vccz K2_RK_A
    s_mov_b64 exec, vcc
    v_lshrrev_b32 v52, 25, v11
    v_lshl_add_u32 v42, v52, 2, s58
    ds_add_rtn_u32 v42, v42, v201
    v_mad_u32_u24 v52, v52, s59, v202
    v_bfe_u32 v62, v11, 14, 11
    v_add_lshl_u32 v62, v62, v178, 5
    v_and_b32 v11, 0x3fff, v11
    v_cmp_lt_i32 vcc, 6, v180
    s_nop 0
    s_cbranch_vccz K2_RK_A
    s_mov_b64 exec, vcc
    v_lshrrev_b32 v53, 25, v15
    v_lshl_add_u32 v43, v53, 2, s58
    ds_add_rtn_u32 v43, v43, v201
    v_mad_u32_u24 v53, v53, s59, v202
    v_bfe_u32 v63, v15, 14, 11
    v_add_lshl_u32 v63, v63, v178, 5
    v_and_b32 v15, 0x3fff, v15
    v_cmp_lt_i32 vcc, 8, v180
    s_nop 0
    s_cbranch_vccz K2_RK_A
    s_mov_b64 exec, vcc
    v_lshrrev_b32 v54, 25, v19
    v_lshl_add_u32 v44, v54, 2, s58
    ds_add_rtn_u32 v44, v44, v201
    v_mad_u32_u24 v54, v54, s59, v202
    v_bfe_u32 v64, v19, 14, 11
    v_add_lshl_u32 v64, v64, v178, 5
    v_and_b32 v19, 0x3fff, v19
    v_cmp_lt_i32 vcc, 10, v180
    s_nop 0
    s_cbranch_vccz K2_RK_A
    s_mov_b64 exec, vcc
    v_lshrrev_b32 v55, 25, v23
    v_lshl_add_u32 v45, v55, 2, s58
    ds_add_rtn_u32 v45, v45, v201
    v_mad_u32_u24 v55, v55, s59, v202
    v_bfe_u32 v65, v23, 14, 11
    v_add_lshl_u32 v65, v65, v178, 5
    v_and_b32 v23, 0x3fff, v23
    v_cmp_lt_i32 vcc, 12, v180
    s_nop 0
    s_cbranch_vccz K2_RK_A
    s_mov_b64 exec, vcc
    v_lshrrev_b32 v56, 25, v27
    v_lshl_add_u32 v46, v56, 2, s58
    ds_add_rtn_u32 v46, v46, v201
    v_mad_u32_u24 v56, v56, s59, v202
    v_bfe_u32 v66, v27, 14, 11
    v_add_lshl_u32 v66, v66, v178, 5
    v_and_b32 v27, 0x3fff, v27
    v_cmp_lt_i32 vcc, 14, v180
    s_nop 0
    s_cbranch_vccz K2_RK_A
    s_mov_b64 exec, vcc
    v_lshrrev_b32 v57, 25, v31
    v_lshl_add_u32 v47, v57, 2, s58
    ds_add_rtn_u32 v47, v47, v201
    v_mad_u32_u24 v57, v57, s59, v202
    v_bfe_u32 v67, v31, 14, 11
    v_add_lshl_u32 v67, v67, v178, 5
    v_and_b32 v31, 0x3fff, v31
    v_cmp_lt_i32 vcc, 16, v180
    s_nop 0
    s_cbranch_vccz K2_RK_A
    s_mov_b64 exec, vcc
    v_lshrrev_b32 v58, 25, v35
    v_lshl_add_u32 v48, v58, 2, s58
    ds_add_rtn_u32 v48, v48, v201
    v_mad_u32_u24 v58, v58, s59, v202
    v_bfe_u32 v68, v35, 14, 11
    v_add_lshl_u32 v68, v68, v178, 5
    v_and_b32 v35, 0x3fff, v35
    v_cmp_lt_i32 vcc, 18, v180
    s_nop 0
    s_cbranch_vccz K2_RK_A
    s_mov_b64 exec, vcc
    v_lshrrev_b32 v59, 25, v39
    v_lshl_add_u32 v49, v59, 2, s58
    ds_add_rtn_u32 v49, v49, v201
    v_mad_u32_u24 v59, v59, s59, v202
    v_bfe_u32 v69, v39, 14, 11
    v_add_lshl_u32 v69, v69, v178, 5
    v_and_b32 v39, 0x3fff, v39
K2_RK_A:
    s_mov_b64 exec, -1
    s_branch K2_RK_DONE
K2_RK_LOAD:
    s_movk_i32 s59, 2400
    v_mov_b32 v202, 65536
    s_waitcnt vmcnt(0)
    v_cmp_lt_i32 vcc, 0, v180
    s_nop 0
    s_cbranch_vccz K2_RK_B
    s_mov_b64 exec, vcc
    v_lshrrev_b32 v50, 25, v3
    buffer_load_dword v40, v179, s[8:11], s66 offen offset:0
    v_mad_u32_u24 v50, v50, s59, v202
    v_bfe_u32 v60, v3, 14, 11
    v_add_lshl_u32 v60, v60, v178, 5
    v_and_b32 v3, 0x3fff, v3
    v_cmp_lt_i32 vcc, 2, v180
    s_nop 0
    s_cbranch_vccz K2_RK_B
    s_mov_b64 exec, vcc
    v_lshrrev_b32 v51, 25, v7
    buffer_load_dword v41, v179, s[8:11], s66 offen offset:8
    v_mad_u32_u24 v51, v51, s59, v202
    v_bfe_u32 v61, v7, 14, 11
    v_add_lshl_u32 v61, v61, v178, 5
    v_and_b32 v7, 0x3fff, v7
    v_cmp_lt_i32 vcc, 4, v180
    s_nop 0
    s_cbranch_vccz K2_RK_B
    s_mov_b64 exec, vcc
    v_lshrrev_b32 v52, 25, v11
    buffer_load_dword v42, v179, s[8:11], s66 offen offset:16
    v_mad_u32_u24 v52, v52, s59, v202
    v_bfe_u32 v62, v11, 14, 11
    v_add_lshl_u32 v62, v62, v178, 5
    v_and_b32 v11, 0x3fff, v11
    v_cmp_lt_i32 vcc, 6, v180
    s_nop 0
    s_cbranch_vccz K2_RK_B
    s_mov_b64 exec, vcc
    v_lshrrev_b32 v53, 25, v15
    buffer_load_dword v43, v179, s[8:11], s66 offen offset:24
    v_mad_u32_u24 v53, v53, s59, v202
    v_bfe_u32 v63, v15, 14, 11
    v_add_lshl_u32 v63, v63, v178, 5
    v_and_b32 v15, 0x3fff, v15
    v_cmp_lt_i32 vcc, 8, v180
    s_nop 0
    s_cbranch_vccz K2_RK_B
    s_mov_b64 exec, vcc
    v_lshrrev_b32 v54, 25, v19
    buffer_load_dword v44, v179, s[8:11], s66 offen offset:32
    v_mad_u32_u24 v54, v54, s59, v202
    v_bfe_u32 v64, v19, 14, 11
    v_add_lshl_u32 v64, v64, v178, 5
    v_and_b32 v19, 0x3fff, v19
    v_cmp_lt_i32 vcc, 10, v180
    s_nop 0
    s_cbranch_vccz K2_RK_B
    s_mov_b64 exec, vcc
    v_lshrrev_b32 v55, 25, v23
    buffer_load_dword v45, v179, s[8:11], s66 offen offset:40
    v_mad_u32_u24 v55, v55, s59, v202
    v_bfe_u32 v65, v23, 14, 11
    v_add_lshl_u32 v65, v65, v178, 5
    v_and_b32 v23, 0x3fff, v23
    v_cmp_lt_i32 vcc, 12, v180
    s_nop 0
    s_cbranch_vccz K2_RK_B
    s_mov_b64 exec, vcc
    v_lshrrev_b32 v56, 25, v27
    buffer_load_dword v46, v179, s[8:11], s66 offen offset:48
    v_mad_u32_u24 v56, v56, s59, v202
    v_bfe_u32 v66, v27, 14, 11
    v_add_lshl_u32 v66, v66, v178, 5
    v_and_b32 v27, 0x3fff, v27
    v_cmp_lt_i32 vcc, 14, v180
    s_nop 0
    s_cbranch_vccz K2_RK_B
    s_mov_b64 exec, vcc
    v_lshrrev_b32 v57, 25, v31
    buffer_load_dword v47, v179, s[8:11], s66 offen offset:56
    v_mad_u32_u24 v57, v57, s59, v202
    v_bfe_u32 v67, v31, 14, 11
    v_add_lshl_u32 v67, v67, v178, 5
    v_and_b32 v31, 0x3fff, v31
    v_cmp_lt_i32 vcc, 16, v180
    s_nop 0
    s_cbranch_vccz K2_RK_B
    s_mov_b64 exec, vcc
    v_lshrrev_b32 v58, 25, v35
    buffer_load_dword v48, v179, s[8:11], s66 offen offset:64
    v_mad_u32_u24 v58, v58, s59, v202
    v_bfe_u32 v68, v35, 14, 11
    v_add_lshl_u32 v68, v68, v178, 5
    v_and_b32 v35, 0x3fff, v35
    v_cmp_lt_i32 vcc, 18, v180
    s_nop 0
    s_cbranch_vccz K2_RK_B
    s_mov_b64 exec, vcc
    v_lshrrev_b32 v59, 25, v39
    buffer_load_dword v49, v179, s[8:11], s66 offen offset:72
    v_mad_u32_u24 v59, v59, s59, v202
    v_bfe_u32 v69, v39, 14, 11
    v_add_lshl_u32 v69, v69, v178, 5
    v_and_b32 v39, 0x3fff, v39
K2_RK_B:
    s_mov_b64 exec, -1
    s_waitcnt vmcnt(0)
K2_RK_DONE:
    s_mul_i32 s67, s24, 48
    s_waitcnt lgkmcnt(0)
    v_cmp_lt_i32 vcc, 0, v180
    s_nop 0
    s_cbranch_vccz K2_SC_DONE
    v_subrev_u32 v192, s67, v40
    v_cmp_gt_u32 s[56:57], 48, v192
    s_nop 0
    s_and_b64 exec, vcc, s[56:57]
    s_cbranch_execz K2_sc_1
    v_lshl_add_u32 v194, v192, 5, v50
    v_lshl_add_u32 v195, v192, 2, v50
    v_and_b32 v196, 7, v192
    v_add_lshl_u32 v196, v196, v192, 1
    v_bfe_u32 v193, v192, 3, 1
    v_mad_i32_i24 v196, v193, -14, v196
    v_add_u32 v196, v196, v50
    ds_write_b32 v194, v60 offset:864
    ds_write2_b32 v195, v0, v1 offset0:48 offset1:96
    ds_write_b32 v195, v2 offset:576
    ds_write_b16 v196, v3 offset:768
K2_sc_1:
    s_mov_b64 exec, -1
    v_cmp_lt_i32 vcc, 2, v180
    s_nop 0
    s_cbranch_vccz K2_SC_DONE
    v_subrev_u32 v192, s67, v41
    v_cmp_gt_u32 s[56:57], 48, v192
    s_nop 0
    s_and_b64 exec, vcc, s[56:57]
    s_cbranch_execz K2_sc_2
    v_lshl_add_u32 v194, v192, 5, v51
    v_lshl_add_u32 v195, v192, 2, v51
    v_and_b32 v196, 7, v192
    v_add_lshl_u32 v196, v196, v192, 1
    v_bfe_u32 v193, v192, 3, 1
    v_mad_i32_i24 v196, v193, -14, v196
    v_add_u32 v196, v196, v51
    ds_write_b32 v194, v61 offset:864
    ds_write2_b32 v195, v4, v5 offset0:48 offset1:96
    ds_write_b32 v195, v6 offset:576
    ds_write_b16 v196, v7 offset:768
K2_sc_2:
    s_mov_b64 exec, -1
    v_cmp_lt_i32 vcc, 4, v180
    s_nop 0
    s_cbranch_vccz K2_SC_DONE
    v_subrev_u32 v192, s67, v42
    v_cmp_gt_u32 s[56:57], 48, v192
    s_nop 0
    s_and_b64 exec, vcc, s[56:57]
    s_cbranch_execz K2_sc_3
    v_lshl_add_u32 v194, v192, 5, v52
    v_lshl_add_u32 v195, v192, 2, v52
    v_and_b32 v196, 7, v192
    v_add_lshl_u32 v196, v196, v192, 1
    v_bfe_u32 v193, v192, 3, 1
    v_mad_i32_i24 v196, v193, -14, v196
    v_add_u32 v196, v196, v52
    ds_write_b32 v194, v62 offset:864
    ds_write2_b32 v195, v8, v9 offset0:48 offset1:96
    ds_write_b32 v195, v10 offset:576
    ds_write_b16 v196, v11 offset:768
K2_sc_3:
    s_mov_b64 exec, -1
    v_cmp_lt_i32 vcc, 6, v180
    s_nop 0
    s_cbranch_vccz K2_SC_DONE
    v_subrev_u32 v192, s67, v43
    v_cmp_gt_u32 s[56:57], 48, v192
    s_nop 0
    s_and_b64 exec, vcc, s[56:57]
    s_cbranch_execz K2_sc_4
    v_lshl_add_u32 v194, v192, 5, v53
    v_lshl_add_u32 v195, v192, 2, v53
    v_and_b32 v196, 7, v192
    v_add_lshl_u32 v196, v196, v192, 1
    v_bfe_u32 v193, v192, 3, 1
    v_mad_i32_i24 v196, v193, -14, v196
    v_add_u32 v196, v196, v53
    ds_write_b32 v194, v63 offset:864
    ds_write2_b32 v195, v12, v13 offset0:48 offset1:96
    ds_write_b32 v195, v14 offset:576
    ds_write_b16 v196, v15 offset:768
K2_sc_4:
    s_mov_b64 exec, -1
    v_cmp_lt_i32 vcc, 8, v180
    s_nop 0
    s_cbranch_vccz K2_SC_DONE
    v_subrev_u32 v192, s67, v44
    v_cmp_gt_u32 s[56:57], 48, v192
    s_nop 0
    s_and_b64 exec, vcc, s[56:57]
    s_cbranch_execz K2_sc_5
    v_lshl_add_u32 v194, v192, 5, v54
    v_lshl_add_u32 v195, v192, 2, v54
    v_and_b32 v196, 7, v192
    v_add_lshl_u32 v196, v196, v192, 1
    v_bfe_u32 v193, v192, 3, 1
    v_mad_i32_i24 v196, v193, -14, v196
    v_add_u32 v196, v196, v54
    ds_write_b32 v194, v64 offset:864
    ds_write2_b32 v195, v16, v17 offset0:48 offset1:96
    ds_write_b32 v195, v18 offset:576
    ds_write_b16 v196, v19 offset:768
K2_sc_5:
    s_mov_b64 exec, -1
    v_cmp_lt_i32 vcc, 10, v180
    s_nop 0
    s_cbranch_vccz K2_SC_DONE
    v_subrev_u32 v192, s67, v45
    v_cmp_gt_u32 s[56:57], 48, v192
    s_nop 0
    s_and_b64 exec, vcc, s[56:57]
    s_cbranch_execz K2_sc_6
    v_lshl_add_u32 v194, v192, 5, v55
    v_lshl_add_u32 v195, v192, 2, v55
    v_and_b32 v196, 7, v192
    v_add_lshl_u32 v196, v196, v192, 1
    v_bfe_u32 v193, v192, 3, 1
    v_mad_i32_i24 v196, v193, -14, v196
    v_add_u32 v196, v196, v55
    ds_write_b32 v194, v65 offset:864
    ds_write2_b32 v195, v20, v21 offset0:48 offset1:96
    ds_write_b32 v195, v22 offset:576
    ds_write_b16 v196, v23 offset:768
K2_sc_6:
    s_mov_b64 exec, -1
    v_cmp_lt_i32 vcc, 12, v180
    s_nop 0
    s_cbranch_vccz K2_SC_DONE
    v_subrev_u32 v192, s67, v46
    v_cmp_gt_u32 s[56:57], 48, v192
    s_nop 0
    s_and_b64 exec, vcc, s[56:57]
    s_cbranch_execz K2_sc_7
    v_lshl_add_u32 v194, v192, 5, v56
    v_lshl_add_u32 v195, v192, 2, v56
    v_and_b32 v196, 7, v192
    v_add_lshl_u32 v196, v196, v192, 1
    v_bfe_u32 v193, v192, 3, 1
    v_mad_i32_i24 v196, v193, -14, v196
    v_add_u32 v196, v196, v56
    ds_write_b32 v194, v66 offset:864
    ds_write2_b32 v195, v24, v25 offset0:48 offset1:96
    ds_write_b32 v195, v26 offset:576
    ds_write_b16 v196, v27 offset:768
K2_sc_7:
    s_mov_b64 exec, -1
    v_cmp_lt_i32 vcc, 14, v180
    s_nop 0
    s_cbranch_vccz K2_SC_DONE
    v_subrev_u32 v192, s67, v47
    v_cmp_gt_u32 s[56:57], 48, v192
    s_nop 0
    s_and_b64 exec, vcc, s[56:57]
    s_cbranch_execz K2_sc_8
    v_lshl_add_u32 v194, v192, 5, v57
    v_lshl_add_u32 v195, v192, 2, v57
    v_and_b32 v196, 7, v192
    v_add_lshl_u32 v196, v196, v192, 1
    v_bfe_u32 v193, v192, 3, 1
    v_mad_i32_i24 v196, v193, -14, v196
    v_add_u32 v196, v196, v57
    ds_write_b32 v194, v67 offset:864
    ds_write2_b32 v195, v28, v29 offset0:48 offset1:96
    ds_write_b32 v195, v30 offset:576
    ds_write_b16 v196, v31 offset:768
K2_sc_8:
    s_mov_b64 exec, -1
    v_cmp_lt_i32 vcc, 16, v180
    s_nop 0
    s_cbranch_vccz K2_SC_DONE
    v_subrev_u32 v192, s67, v48
    v_cmp_gt_u32 s[56:57], 48, v192
    s_nop 0
    s_and_b64 exec, vcc, s[56:57]
    s_cbranch_execz K2_sc_9
    v_lshl_add_u32 v194, v192, 5, v58
    v_lshl_add_u32 v195, v192, 2, v58
    v_and_b32 v196, 7, v192
    v_add_lshl_u32 v196, v196, v192, 1
    v_bfe_u32 v193, v192, 3, 1
    v_mad_i32_i24 v196, v193, -14, v196
    v_add_u32 v196, v196, v58
    ds_write_b32 v194, v68 offset:864
    ds_write2_b32 v195, v32, v33 offset0:48 offset1:96
    ds_write_b32 v195, v34 offset:576
    ds_write_b16 v196, v35 offset:768
K2_sc_9:
    s_mov_b64 exec, -1
    v_cmp_lt_i32 vcc, 18, v180
    s_nop 0
    s_cbranch_vccz K2_SC_DONE
    v_subrev_u32 v192, s67, v49
    v_cmp_gt_u32 s[56:57], 48, v192
    s_nop 0
    s_and_b64 exec, vcc, s[56:57]
    s_cbranch_execz K2_sc_10
    v_lshl_add_u32 v194, v192, 5, v59
    v_lshl_add_u32 v195, v192, 2, v59
    v_and_b32 v196, 7, v192
    v_add_lshl_u32 v196, v196, v192, 1
    v_bfe_u32 v193, v192, 3, 1
    v_mad_i32_i24 v196, v193, -14, v196
    v_add_u32 v196, v196, v59
    ds_write_b32 v194, v69 offset:864
    ds_write2_b32 v195, v36, v37 offset0:48 offset1:96
    ds_write_b32 v195, v38 offset:576
    ds_write_b16 v196, v39 offset:768
K2_sc_10:
    s_mov_b64 exec, -1
K2_SC_DONE:
    v_lshlrev_b32 v192, 2, v176
    v_add_u32 v192, 163424, v192
    v_mov_b32 v200, 163652
    v_mov_b32 v198, 0
    s_movk_i32 s26, 48
    s_waitcnt lgkmcnt(0)
    s_barrier
    ds_read_b32 v193, v192
    ds_read_b32 v200, v200
    v_cmp_gt_u32 s[56:57], s22, v176
    v_mad_u32_u24 v195, v176, s59, v202
    v_lshl_or_b32 v195, v176, 21, v195
    s_waitcnt lgkmcnt(0)
    v_cndmask_b32 v193, 0, v193, s[56:57]
    v_readfirstlane_b32 s27, v200
    v_cmp_lt_u32 vcc, 48, v193
    s_nop 0
    s_cbranch_vccnz K2_BIG
K2_TOK:
    v_subrev_u32 v194, s67, v193
    v_max_i32 v194, 1, v194
    v_min_i32 v194, s26, v194
    v_add_u32 v194, 15, v194
    v_lshrrev_b32 v194, 4, v194
    v_lshl_or_b32 v195, v194, 18, v195
    v_or_b32 v195, v195, v198
    v_mov_b32 v197, 425056
    v_cndmask_b32 v253, v197, v195, s[56:57]
    s_movk_i32 s40, 0
    s_movk_i32 s41, 256
    s_movk_i32 s42, 512
    s_movk_i32 s43, 768
    s_mov_b32 s38, 0
    s_mov_b32 s34, 0
    s_mov_b32 s35, 0
    s_mov_b32 s36, 1
    s_mov_b32 s31, 0
    s_mov_b32 s58, s20
    v_readlane_b32 s3, v253, s58
    s_lshl_b32 s44, s34, 7
    s_lshl_b32 s60, s58, 5
    s_and_b32 s48, s3, 0x3ffff
    s_bfe_u32 s33, s3, 0x30012
    s_sub_u32 s60, s60, s48
    s_and_b32 s60, s60, 0xff
    s_add_u32 s60, s60, s48
    s_mul_i32 s35, s38, 6
    s_cmp_eq_u32 s34, 0
    s_cselect_b32 s35, s35, s60
    s_mov_b32 s45, s44
    s_add_u32 s47, s44, 256
    s_add_u32 s49, s48, 32
    s_add_u32 s60, s48, 64
    s_cmp_eq_u32 s33, 3
    s_cselect_b32 s46, s44, s47
    s_cselect_b32 s50, s60, s48
    s_cselect_b32 s51, s48, s49
    s_sub_u32 s60, s33, 2
    s_cmp_lt_u32 s60, 2
    s_cbranch_scc0 K2_rare_21
K2_back_22:
    v_add_u32 v233, s48, v230
    ds_read_b32 v232, v233
    ds_read_b32 v233, v233 offset:1024
    v_add_u32 v222, s48, v251
    ds_read_b32 v222, v222
    v_add_u32 v224, s49, v251
    ds_read_b32 v224, v224
    v_add_u32 v226, s50, v251
    ds_read_b32 v226, v226
    v_add_u32 v228, s51, v251
    ds_read_b32 v228, v228
    s_waitcnt lgkmcnt(4)
    v_or_b32 v232, v232, v231
    v_or_b32 v233, v233, v231
    s_cmp_lg_u32 s34, 0
    s_cbranch_scc1 K2_dum_24
    s_add_u32 m0, s48, 864
    s_add_u32 s65, s48, 1888
    buffer_load_dwordx4 v232, s[16:19], 0 offen  lds
    s_mov_b32 m0, s65
    s_mov_b32 exec_hi, 0
    buffer_load_dwordx4 v233, s[16:19], 0 offen  lds
    s_cmp_eq_u32 s33, 4
    s_cbranch_scc1 K2_a4_25
K2_b4_27:
    s_mov_b32 exec_hi, -1
K2_back_26:
    s_waitcnt lgkmcnt(3)
    v_mad_u32_u16 v223, v222, s39, v248 op_sel:[1,0,0,0]
    v_mad_u32_u16 v222, v222, s39, v248
    s_waitcnt lgkmcnt(2)
    v_mad_u32_u16 v225, v224, s39, v248 op_sel:[1,0,0,0]
    v_mad_u32_u16 v224, v224, s39, v248
    s_waitcnt lgkmcnt(1)
    v_mad_u32_u16 v227, v226, s39, v248 op_sel:[1,0,0,0]
    v_mad_u32_u16 v226, v226, s39, v248
    s_waitcnt lgkmcnt(0)
    v_mad_u32_u16 v229, v228, s39, v248 op_sel:[1,0,0,0]
    v_mad_u32_u16 v228, v228, s39, v248
    s_mov_b32 m0, s68
    s_nop 0
    buffer_load_dwordx4 v222, s[4:7], s44 offen lds
    buffer_load_dwordx4 v223, s[72:75], s44 offen offset:1024 lds
    s_mov_b32 m0, s69
    s_nop 0
    buffer_load_dwordx4 v224, s[4:7], s45 offen lds
    buffer_load_dwordx4 v225, s[72:75], s45 offen offset:1024 lds
    s_mov_b32 m0, s70
    s_nop 0
    buffer_load_dwordx4 v226, s[4:7], s46 offen lds
    buffer_load_dwordx4 v227, s[72:75], s46 offen offset:1024 lds
    s_mov_b32 m0, s71
    s_nop 0
    buffer_load_dwordx4 v228, s[4:7], s47 offen lds
    buffer_load_dwordx4 v229, s[72:75], s47 offen offset:1024 lds
    v_add_u32 v249, s48, v249
    v_add_u32 v250, s48, v250
    s_waitcnt vmcnt(6)
    ds_read_b64_tr_b16 v[176:177], v246 offset:0
    ds_read_b64_tr_b16 v[178:179], v246 offset:512
    ds_read_b64_tr_b16 v[180:181], v247 offset:0
    ds_read_b64_tr_b16 v[182:183], v247 offset:512
    ds_read_b64_tr_b16 v[0:1], v249 offset:0
    ds_read_b64_tr_b16 v[2:3], v249 offset:128
    ds_read_b128 v[4:7], v250 offset:0
    ds_read_b128 v[8:11], v250 offset:16
    ds_read_b128 v[12:15], v250 offset:384
    ds_read_b128 v[16:19], v250 offset:400
    ds_read_b64_tr_b16 v[20:21], v249 offset:512
    ds_read_b64_tr_b16 v[22:23], v249 offset:640
    ds_read_b128 v[24:27], v250 offset:64
    ds_read_b128 v[28:31], v250 offset:80
    ds_read_b128 v[32:35], v250 offset:448
    ds_read_b128 v[36:39], v250 offset:464
    s_mov_b32 s29, s48
    s_mov_b32 s32, s31
    s_mov_b32 s30, s3
    s_mov_b32 s31, s35
    s_cmp_eq_u32 s33, 2
    s_cbranch_scc1 K2_U20
    s_cmp_eq_u32 s33, 3
    s_cbranch_scc1 K2_U30
    s_cmp_eq_u32 s33, 1
    s_cbranch_scc1 K2_U10
    s_branch K2_U40
K2_U20:
    s_setprio 1
    s_waitcnt lgkmcnt(10)
    v_lshlrev_b32 v40, 16, v0
    v_and_b32 v41, 0xffff0000, v0
    v_lshlrev_b32 v42, 16, v1
    v_and_b32 v43, 0xffff0000, v1
    v_lshlrev_b32 v44, 16, v2
    v_and_b32 v45, 0xffff0000, v2
    v_lshlrev_b32 v46, 16, v3
    v_and_b32 v47, 0xffff0000, v3
    s_waitcnt lgkmcnt(8)
    v_mul_f32 v4, v40, v4
    v_mul_f32 v5, v41, v5
    v_mul_f32 v6, v42, v6
    v_mul_f32 v7, v43, v7
    v_mul_f32 v8, v44, v8
    v_mul_f32 v9, v45, v9
    v_mul_f32 v10, v46, v10
    v_mul_f32 v11, v47, v11
    v_cvt_pk_bf16_f32 v64, v4, v5
    v_cvt_pk_bf16_f32 v65, v6, v7
    v_cvt_pk_bf16_f32 v66, v8, v9
    v_cvt_pk_bf16_f32 v67, v10, v11
    s_waitcnt lgkmcnt(6)
    v_mul_f32 v12, v40, v12
    v_mul_f32 v13, v41, v13
    v_mul_f32 v14, v42, v14
    v_mul_f32 v15, v43, v15
    v_mul_f32 v16, v44, v16
    v_mul_f32 v17, v45, v17
    v_mul_f32 v18, v46, v18
    v_mul_f32 v19, v47, v19
    v_cvt_pk_bf16_f32 v68, v12, v13
    v_cvt_pk_bf16_f32 v69, v14, v15
    v_cvt_pk_bf16_f32 v70, v16, v17
    v_cvt_pk_bf16_f32 v71, v18, v19
    s_waitcnt lgkmcnt(4)
    v_lshlrev_b32 v48, 16, v20
    v_and_b32 v49, 0xffff0000, v20
    v_lshlrev_b32 v50, 16, v21
    v_and_b32 v51, 0xffff0000, v21
    v_lshlrev_b32 v52, 16, v22
    v_and_b32 v53, 0xffff0000, v22
    v_lshlrev_b32 v54, 16, v23
    v_and_b32 v55, 0xffff0000, v23
    s_waitcnt lgkmcnt(2)
    v_mul_f32 v24, v48, v24
    v_mul_f32 v25, v49, v25
    v_mul_f32 v26, v50, v26
    v_mul_f32 v27, v51, v27
    v_mul_f32 v28, v52, v28
    v_mul_f32 v29, v53, v29
    v_mul_f32 v30, v54, v30
    v_mul_f32 v31, v55, v31
    v_cvt_pk_bf16_f32 v72, v24, v25
    v_cvt_pk_bf16_f32 v73, v26, v27
    v_cvt_pk_bf16_f32 v74, v28, v29
    v_cvt_pk_bf16_f32 v75, v30, v31
    s_waitcnt lgkmcnt(0)
    v_mul_f32 v32, v48, v32
    v_mul_f32 v33, v49, v33
    v_mul_f32 v34, v50, v34
    v_mul_f32 v35, v51, v35
    v_mul_f32 v36, v52, v36
    v_mul_f32 v37, v53, v37
    v_mul_f32 v38, v54, v38
    v_mul_f32 v39, v55, v39
    v_cvt_pk_bf16_f32 v76, v32, v33
    v_cvt_pk_bf16_f32 v77, v34, v35
    v_cvt_pk_bf16_f32 v78, v36, v37
    v_cvt_pk_bf16_f32 v79, v38, v39
    s_waitcnt vmcnt(4)
    v_mfma_f32_32x32x16_bf16 v[0:15], v[64:67], v[176:179], 0
    ds_read_b64_tr_b16 v[184:185], v246 offset:2048
    ds_read_b64_tr_b16 v[186:187], v246 offset:2560
    ds_read_b64_tr_b16 v[188:189], v247 offset:2048
    ds_read_b64_tr_b16 v[190:191], v247 offset:2560
    s_mov_b32 m0, s68
    v_mfma_f32_32x32x16_bf16 v[16:31], v[68:71], v[176:179], 0
    buffer_load_dwordx4 v222, s[4:7], s42 offen lds
    buffer_load_dwordx4 v223, s[72:75], s42 offen offset:1024 lds
    v_permlane32_swap_b32 v242, v243
    v_permlane32_swap_b32 v240, v241
    s_add_u32 s38, s38, 1
    v_mfma_f32_32x32x16_bf16 v[32:47], v[64:67], v[180:183], 0
    v_permlane32_swap_b32 v236, v237
    v_permlane32_swap_b32 v244, v245
    v_add_f32 v242, v242, v243
    v_add_f32 v240, -v240, -v241
    v_add_f32 v236, v236, v237
    v_mfma_f32_32x32x16_bf16 v[48:63], v[68:71], v[180:183], 0
    v_add_f32 v244, v244, v245
    s_set_gpr_idx_on s32, gpr_idx(DST)
    s_nop 0
    v_cvt_pk_bf16_f32 v195, v242, v236
    v_cvt_pk_bf16_f32 v196, v244, v240
    v_cvt_pk_bf16_f32 v197, v238, v238
    s_set_gpr_idx_off
    s_waitcnt vmcnt(4) lgkmcnt(0)
    v_mfma_f32_32x32x16_bf16 v[0:15], v[72:75], v[184:187], v[0:15]
    ds_read_b64_tr_b16 v[176:177], v246 offset:4096
    ds_read_b64_tr_b16 v[178:179], v246 offset:4608
    ds_read_b64_tr_b16 v[180:181], v247 offset:4096
    ds_read_b64_tr_b16 v[182:183], v247 offset:4608
    v_mov_b32 v254, s52
    v_mov_b32 v255, s38
    s_mov_b32 m0, s69
    v_mfma_f32_32x32x16_bf16 v[16:31], v[76:79], v[184:187], v[16:31]
    buffer_load_dwordx4 v224, s[4:7], s42 offen lds
    buffer_load_dwordx4 v225, s[72:75], s42 offen offset:1024 lds
    s_lshl_b32 s58, s38, 3
    s_add_u32 s58, s58, s20
    s_mov_b64 exec, 1
    ds_write_b32 v254, v255
    s_mov_b64 exec, -1
    s_cmp_lt_u32 s58, s22
    s_cbranch_scc0 K2_dyn_28
K2_back_29:
    v_readlane_b32 s3, v253, s58
    s_lshl_b32 s44, s34, 7
    s_lshl_b32 s60, s58, 5
    s_and_b32 s48, s3, 0x3ffff
    s_bfe_u32 s33, s3, 0x30012
    s_sub_u32 s60, s60, s48
    s_and_b32 s60, s60, 0xff
    s_add_u32 s60, s60, s48
    s_mul_i32 s35, s38, 6
    s_cmp_eq_u32 s34, 0
    s_cselect_b32 s35, s35, s60
    s_mov_b32 s45, s44
    s_add_u32 s47, s44, 256
    s_add_u32 s49, s48, 32
    s_add_u32 s60, s48, 64
    s_cmp_eq_u32 s33, 3
    s_cselect_b32 s46, s44, s47
    s_cselect_b32 s50, s60, s48
    s_cselect_b32 s51, s48, s49
    s_sub_u32 s60, s33, 2
    s_cmp_lt_u32 s60, 2
    s_cbranch_scc0 K2_rare_34
K2_back_35:
    v_mfma_f32_32x32x16_bf16 v[32:47], v[72:75], v[188:191], v[32:47]
    v_add_u32 v233, s48, v230
    ds_read_b32 v232, v233
    ds_read_b32 v233, v233 offset:1024
    v_mul_f32 v234, v0, v96
    v_mul_f32 v236, v8, v128
    v_fmac_f32 v234, v1, v97
    v_fmac_f32 v236, v9, v129
    v_mfma_f32_32x32x16_bf16 v[48:63], v[76:79], v[188:191], v[48:63]
    s_setprio 0
    v_fmac_f32 v234, v2, v98
    v_fmac_f32 v236, v10, v130
    v_fmac_f32 v234, v3, v99
    v_fmac_f32 v236, v11, v131
    v_fmac_f32 v234, v4, v100
    v_fmac_f32 v236, v12, v132
    v_fmac_f32 v234, v5, v101
    v_fmac_f32 v236, v13, v133
    v_fmac_f32 v234, v6, v102
    v_fmac_f32 v236, v14, v134
    v_fmac_f32 v234, v7, v103
    v_fmac_f32 v236, v15, v135
    v_mul_f32 v238, v16, v128
    v_mul_f32 v240, v24, v128
    v_fmac_f32 v238, v17, v129
    v_fmac_f32 v240, v25, v129
    v_fmac_f32 v238, v18, v130
    v_fmac_f32 v240, v26, v130
    v_fmac_f32 v238, v19, v131
    v_fmac_f32 v240, v27, v131
    v_fmac_f32 v238, v20, v132
    v_fmac_f32 v240, v28, v132
    v_fmac_f32 v238, v21, v133
    v_fmac_f32 v240, v29, v133
    v_fmac_f32 v238, v22, v134
    v_fmac_f32 v240, v30, v134
    v_fmac_f32 v238, v23, v135
    v_fmac_f32 v240, v31, v135
    v_mul_f32 v235, v32, v104
    v_mul_f32 v237, v40, v136
    v_fmac_f32 v235, v33, v105
    v_fmac_f32 v237, v41, v137
    v_fmac_f32 v235, v34, v106
    v_fmac_f32 v237, v42, v138
    v_fmac_f32 v235, v35, v107
    v_fmac_f32 v237, v43, v139
    v_fmac_f32 v235, v36, v108
    v_fmac_f32 v237, v44, v140
    v_fmac_f32 v235, v37, v109
    v_fmac_f32 v237, v45, v141
    v_fmac_f32 v235, v38, v110
    v_fmac_f32 v237, v46, v142
    v_fmac_f32 v235, v39, v111
    v_fmac_f32 v237, v47, v143
    v_mul_f32 v239, v48, v136
    v_mul_f32 v241, v56, v136
    v_fmac_f32 v239, v49, v137
    v_fmac_f32 v241, v57, v137
    s_setprio 1
    s_waitcnt vmcnt(4) lgkmcnt(3)
    v_mfma_f32_32x32x16_bf16 v[0:15], v[64:67], v[176:179], 0
    ds_read_b64_tr_b16 v[184:185], v246 offset:6144
    ds_read_b64_tr_b16 v[186:187], v246 offset:6656
    ds_read_b64_tr_b16 v[188:189], v247 offset:6144
    ds_read_b64_tr_b16 v[190:191], v247 offset:6656
    v_fmac_f32 v239, v50, v138
    v_fmac_f32 v241, v58, v138
    s_mov_b32 m0, s70
    v_mfma_f32_32x32x16_bf16 v[16:31], v[68:71], v[176:179], 0
    buffer_load_dwordx4 v222, s[4:7], s43 offen lds
    buffer_load_dwordx4 v223, s[72:75], s43 offen offset:1024 lds
    v_fmac_f32 v239, v51, v139
    v_fmac_f32 v241, v59, v139
    v_fmac_f32 v239, v52, v140
    v_fmac_f32 v241, v60, v140
    v_fmac_f32 v239, v53, v141
    v_mfma_f32_32x32x16_bf16 v[32:47], v[64:67], v[180:183], 0
    v_add_u32 v222, s48, v251
    ds_read_b32 v222, v222
    v_fmac_f32 v241, v61, v141
    v_fmac_f32 v239, v54, v142
    v_fmac_f32 v241, v62, v142
    v_fmac_f32 v239, v55, v143
    v_fmac_f32 v241, v63, v143
    v_mfma_f32_32x32x16_bf16 v[48:63], v[68:71], v[180:183], 0
    v_permlane32_swap_b32 v234, v235
    v_permlane32_swap_b32 v236, v237
    v_permlane32_swap_b32 v238, v239
    s_waitcnt lgkmcnt(5)
    v_or_b32 v232, v232, v231
    v_or_b32 v233, v233, v231
    s_cmp_lg_u32 s34, 0
    s_cbranch_scc1 K2_dum_37
    s_add_u32 m0, s48, 864
    s_add_u32 s65, s48, 1888
    buffer_load_dwordx4 v232, s[16:19], 0 offen  lds
    s_mov_b32 m0, s65
    s_mov_b32 exec_hi, 0
    buffer_load_dwordx4 v233, s[16:19], 0 offen  lds
    s_cmp_eq_u32 s33, 4
    s_cbranch_scc1 K2_a4_38
K2_b4_40:
    s_mov_b32 exec_hi, -1
K2_back_39:
    s_waitcnt vmcnt(6) lgkmcnt(1)
    v_mfma_f32_32x32x16_bf16 v[0:15], v[72:75], v[184:187], v[0:15]
    ds_read_b64_tr_b16 v[176:177], v246 offset:0
    ds_read_b64_tr_b16 v[178:179], v246 offset:512
    ds_read_b64_tr_b16 v[180:181], v247 offset:0
    ds_read_b64_tr_b16 v[182:183], v247 offset:512
    v_permlane32_swap_b32 v240, v241
    s_mov_b32 m0, s71
    v_mfma_f32_32x32x16_bf16 v[16:31], v[76:79], v[184:187], v[16:31]
    buffer_load_dwordx4 v224, s[4:7], s43 offen lds
    buffer_load_dwordx4 v225, s[72:75], s43 offen offset:1024 lds
    s_waitcnt lgkmcnt(4)
    v_mad_u32_u16 v223, v222, s39, v248 op_sel:[1,0,0,0]
    v_mad_u32_u16 v222, v222, s39, v248
    v_add_f32 v234, v234, v235
    v_add_f32 v236, v236, v237
    v_add_f32 v238, v238, v239
    v_add_f32 v240, v240, v241
    s_set_gpr_idx_on s31, gpr_idx(DST)
    s_nop 0
    v_cvt_pk_bf16_f32 v192, v234, v236
    v_cvt_pk_bf16_f32 v193, v238, v240
    s_set_gpr_idx_off
    v_mfma_f32_32x32x16_bf16 v[32:47], v[72:75], v[188:191], v[32:47]
    v_add_u32 v224, s49, v251
    ds_read_b32 v224, v224
    v_mul_f32 v234, v0, v144
    v_mul_f32 v236, v8, v112
    v_fmac_f32 v234, v1, v145
    v_fmac_f32 v236, v9, v113
    v_fmac_f32 v234, v2, v146
    v_mfma_f32_32x32x16_bf16 v[48:63], v[76:79], v[188:191], v[48:63]
    s_setprio 0
    v_fmac_f32 v236, v10, v114
    v_fmac_f32 v234, v3, v147
    v_fmac_f32 v236, v11, v115
    v_fmac_f32 v234, v4, v148
    v_fmac_f32 v236, v12, v116
    v_fmac_f32 v234, v5, v149
    v_fmac_f32 v236, v13, v117
    v_fmac_f32 v234, v6, v150
    v_fmac_f32 v236, v14, v118
    v_fmac_f32 v234, v7, v151
    v_fmac_f32 v236, v15, v119
    v_mul_f32 v238, v16, v160
    v_mul_f32 v240, v24, v160
    v_fmac_f32 v238, v17, v161
    v_fmac_f32 v240, v25, v161
    v_fmac_f32 v238, v18, v162
    v_fmac_f32 v240, v26, v162
    v_fmac_f32 v238, v19, v163
    v_fmac_f32 v240, v27, v163
    v_fmac_f32 v238, v20, v164
    v_fmac_f32 v240, v28, v164
    v_fmac_f32 v238, v21, v165
    v_fmac_f32 v240, v29, v165
    v_fmac_f32 v238, v22, v166
    v_fmac_f32 v240, v30, v166
    v_fmac_f32 v238, v23, v167
    v_fmac_f32 v240, v31, v167
    v_mul_f32 v235, v32, v152
    v_mul_f32 v237, v40, v120
    v_fmac_f32 v235, v33, v153
    v_fmac_f32 v237, v41, v121
    v_fmac_f32 v235, v34, v154
    v_fmac_f32 v237, v42, v122
    v_fmac_f32 v235, v35, v155
    v_fmac_f32 v237, v43, v123
    v_fmac_f32 v235, v36, v156
    v_fmac_f32 v237, v44, v124
    v_fmac_f32 v235, v37, v157
    v_fmac_f32 v237, v45, v125
    v_fmac_f32 v235, v38, v158
    v_fmac_f32 v237, v46, v126
    v_fmac_f32 v235, v39, v159
    v_fmac_f32 v237, v47, v127
    v_mul_f32 v239, v48, v168
    v_mul_f32 v241, v56, v168
    v_fmac_f32 v239, v49, v169
    v_fmac_f32 v241, v57, v169
    v_fmac_f32 v239, v50, v170
    v_fmac_f32 v241, v58, v170
    v_fmac_f32 v239, v51, v171
    s_setprio 1
    s_waitcnt vmcnt(6) lgkmcnt(1)
    v_mfma_f32_32x32x16_bf16 v[0:15], v[64:67], v[176:179], 0
    ds_read_b64_tr_b16 v[184:185], v246 offset:2048
    ds_read_b64_tr_b16 v[186:187], v246 offset:2560
    ds_read_b64_tr_b16 v[188:189], v247 offset:2048
    ds_read_b64_tr_b16 v[190:191], v247 offset:2560
    v_fmac_f32 v241, v59, v171
    v_fmac_f32 v239, v52, v172
    s_mov_b32 m0, s68
    v_mfma_f32_32x32x16_bf16 v[16:31], v[68:71], v[176:179], 0
    buffer_load_dwordx4 v222, s[4:7], s44 offen lds
    buffer_load_dwordx4 v223, s[72:75], s44 offen offset:1024 lds
    s_waitcnt lgkmcnt(4)
    v_mad_u32_u16 v225, v224, s39, v248 op_sel:[1,0,0,0]
    v_mad_u32_u16 v224, v224, s39, v248
    v_fmac_f32 v241, v60, v172
    v_fmac_f32 v239, v53, v173
    v_mfma_f32_32x32x16_bf16 v[32:47], v[64:67], v[180:183], 0
    v_add_u32 v226, s50, v251
    ds_read_b32 v226, v226
    v_fmac_f32 v241, v61, v173
    v_fmac_f32 v239, v54, v174
    v_fmac_f32 v241, v62, v174
    v_fmac_f32 v239, v55, v175
    v_fmac_f32 v241, v63, v175
    v_mfma_f32_32x32x16_bf16 v[48:63], v[68:71], v[180:183], 0
    v_permlane32_swap_b32 v234, v235
    v_add_f32 v234, v234, v235
    s_waitcnt vmcnt(6) lgkmcnt(1)
    v_mfma_f32_32x32x16_bf16 v[0:15], v[72:75], v[184:187], v[0:15]
    ds_read_b64_tr_b16 v[176:177], v246 offset:4096
    ds_read_b64_tr_b16 v[178:179], v246 offset:4608
    ds_read_b64_tr_b16 v[180:181], v247 offset:4096
    ds_read_b64_tr_b16 v[182:183], v247 offset:4608
    s_mov_b32 m0, s69
    v_mfma_f32_32x32x16_bf16 v[16:31], v[76:79], v[184:187], v[16:31]
    buffer_load_dwordx4 v224, s[4:7], s45 offen lds
    buffer_load_dwordx4 v225, s[72:75], s45 offen offset:1024 lds
    s_waitcnt lgkmcnt(4)
    v_mad_u32_u16 v227, v226, s39, v248 op_sel:[1,0,0,0]
    v_mad_u32_u16 v226, v226, s39, v248
    v_mfma_f32_32x32x16_bf16 v[32:47], v[72:75], v[188:191], v[32:47]
    v_add_u32 v228, s51, v251
    ds_read_b32 v228, v228
    v_mul_f32 v242, v0, v144
    v_fma_f32 v238, v8, v160, -v238
    v_fmac_f32 v242, v1, v145
    v_fmac_f32 v238, v9, v161
    v_fmac_f32 v242, v2, v146
    v_mfma_f32_32x32x16_bf16 v[48:63], v[76:79], v[188:191], v[48:63]
    s_setprio 0
    v_fmac_f32 v238, v10, v162
    v_fmac_f32 v242, v3, v147
    v_fmac_f32 v238, v11, v163
    v_fmac_f32 v242, v4, v148
    v_fmac_f32 v238, v12, v164
    v_fmac_f32 v242, v5, v149
    v_fmac_f32 v238, v13, v165
    v_fmac_f32 v242, v6, v150
    v_fmac_f32 v238, v14, v166
    v_fmac_f32 v242, v7, v151
    v_fmac_f32 v238, v15, v167
    v_fmac_f32 v236, v16, v112
    v_mul_f32 v244, v24, v160
    v_fmac_f32 v236, v17, v113
    v_fmac_f32 v244, v25, v161
    v_fmac_f32 v236, v18, v114
    v_fmac_f32 v244, v26, v162
    v_fmac_f32 v236, v19, v115
    v_fmac_f32 v244, v27, v163
    v_fmac_f32 v236, v20, v116
    v_fmac_f32 v244, v28, v164
    v_fmac_f32 v236, v21, v117
    v_fmac_f32 v244, v29, v165
    v_fmac_f32 v236, v22, v118
    v_fmac_f32 v244, v30, v166
    v_fmac_f32 v236, v23, v119
    v_fmac_f32 v244, v31, v167
    v_mul_f32 v243, v32, v152
    v_fma_f32 v239, v40, v168, -v239
    v_fmac_f32 v243, v33, v153
    v_fmac_f32 v239, v41, v169
    v_fmac_f32 v243, v34, v154
    v_fmac_f32 v239, v42, v170
    v_fmac_f32 v243, v35, v155
    v_fmac_f32 v239, v43, v171
    v_fmac_f32 v243, v36, v156
    v_fmac_f32 v239, v44, v172
    v_fmac_f32 v243, v37, v157
    v_fmac_f32 v239, v45, v173
    v_fmac_f32 v243, v38, v158
    v_fmac_f32 v239, v46, v174
    v_fmac_f32 v243, v39, v159
    v_fmac_f32 v239, v47, v175
    v_fmac_f32 v237, v48, v120
    v_mul_f32 v245, v56, v168
    v_fmac_f32 v237, v49, v121
    v_fmac_f32 v245, v57, v169
    v_fmac_f32 v237, v50, v122
    s_setprio 1
    s_waitcnt vmcnt(4) lgkmcnt(1)
    v_mfma_f32_32x32x16_bf16 v[0:15], v[64:67], v[176:179], 0
    ds_read_b64_tr_b16 v[184:185], v246 offset:6144
    ds_read_b64_tr_b16 v[186:187], v246 offset:6656
    ds_read_b64_tr_b16 v[188:189], v247 offset:6144
    ds_read_b64_tr_b16 v[190:191], v247 offset:6656
    v_fmac_f32 v245, v58, v170
    v_fmac_f32 v237, v51, v123
    s_mov_b32 m0, s70
    v_mfma_f32_32x32x16_bf16 v[16:31], v[68:71], v[176:179], 0
    buffer_load_dwordx4 v226, s[4:7], s46 offen lds
    buffer_load_dwordx4 v227, s[72:75], s46 offen offset:1024 lds
    s_waitcnt lgkmcnt(4)
    v_mad_u32_u16 v229, v228, s39, v248 op_sel:[1,0,0,0]
    v_mad_u32_u16 v228, v228, s39, v248
    v_fmac_f32 v245, v59, v171
    v_fmac_f32 v237, v52, v124
    v_mfma_f32_32x32x16_bf16 v[32:47], v[64:67], v[180:183], 0
    v_fmac_f32 v245, v60, v172
    v_fmac_f32 v237, v53, v125
    v_fmac_f32 v245, v61, v173
    v_fmac_f32 v237, v54, v126
    v_fmac_f32 v245, v62, v174
    v_fmac_f32 v237, v55, v127
    v_fmac_f32 v245, v63, v175
    v_mfma_f32_32x32x16_bf16 v[48:63], v[68:71], v[180:183], 0
    v_permlane32_swap_b32 v238, v239
    v_permlane32_swap_b32 v242, v243
    v_add_f32 v238, v238, v239
    v_add_f32 v242, v242, v243
    s_waitcnt vmcnt(4) lgkmcnt(0)
    v_mfma_f32_32x32x16_bf16 v[0:15], v[72:75], v[184:187], v[0:15]
    ds_read_b64_tr_b16 v[176:177], v246 offset:0
    ds_read_b64_tr_b16 v[178:179], v246 offset:512
    ds_read_b64_tr_b16 v[180:181], v247 offset:0
    ds_read_b64_tr_b16 v[182:183], v247 offset:512
    s_mov_b32 m0, s71
    v_mfma_f32_32x32x16_bf16 v[16:31], v[76:79], v[184:187], v[16:31]
    buffer_load_dwordx4 v228, s[4:7], s47 offen lds
    buffer_load_dwordx4 v229, s[72:75], s47 offen offset:1024 lds
    s_set_gpr_idx_on s31, gpr_idx(DST)
    s_nop 0
    v_cvt_pk_bf16_f32 v194, v234, v242
    s_set_gpr_idx_off
    v_mfma_f32_32x32x16_bf16 v[32:47], v[72:75], v[188:191], v[32:47]
    v_mul_f32 v242, v0, v144
    v_fma_f32 v240, v8, v160, -v240
    v_fmac_f32 v242, v1, v145
    v_fmac_f32 v240, v9, v161
    v_fmac_f32 v242, v2, v146
    v_fmac_f32 v240, v10, v162
    v_fmac_f32 v242, v3, v147
    v_mfma_f32_32x32x16_bf16 v[48:63], v[76:79], v[188:191], v[48:63]
    s_setprio 0
    v_fmac_f32 v240, v11, v163
    v_fmac_f32 v242, v4, v148
    v_fmac_f32 v240, v12, v164
    v_fmac_f32 v242, v5, v149
    v_fmac_f32 v240, v13, v165
    v_fmac_f32 v242, v6, v150
    v_fmac_f32 v240, v14, v166
    v_fmac_f32 v242, v7, v151
    v_fmac_f32 v240, v15, v167
    s_sub_u32 s58, s48, s29
    v_add_u32 v249, s58, v249
    v_add_u32 v250, s58, v250
    v_fma_f32 v244, v16, v160, -v244
    v_fmac_f32 v236, v24, v112
    v_fmac_f32 v244, v17, v161
    v_fmac_f32 v236, v25, v113
    v_fmac_f32 v244, v18, v162
    v_fmac_f32 v236, v26, v114
    v_fmac_f32 v244, v19, v163
    v_fmac_f32 v236, v27, v115
    v_fmac_f32 v244, v20, v164
    v_fmac_f32 v236, v28, v116
    v_fmac_f32 v244, v21, v165
    v_fmac_f32 v236, v29, v117
    v_fmac_f32 v244, v22, v166
    v_fmac_f32 v236, v30, v118
    v_fmac_f32 v244, v23, v167
    v_fmac_f32 v236, v31, v119
    ds_read_b64_tr_b16 v[0:1], v249 offset:0
    ds_read_b64_tr_b16 v[2:3], v249 offset:128
    ds_read_b128 v[4:7], v250 offset:0
    ds_read_b128 v[8:11], v250 offset:16
    ds_read_b128 v[12:15], v250 offset:384
    ds_read_b128 v[16:19], v250 offset:400
    v_mul_f32 v243, v32, v152
    v_fma_f32 v241, v40, v168, -v241
    v_fmac_f32 v243, v33, v153
    v_fmac_f32 v241, v41, v169
    v_fmac_f32 v243, v34, v154
    v_fmac_f32 v241, v42, v170
    v_fmac_f32 v243, v35, v155
    v_fmac_f32 v241, v43, v171
    v_fmac_f32 v243, v36, v156
    v_fmac_f32 v241, v44, v172
    v_fmac_f32 v243, v37, v157
    v_fmac_f32 v241, v45, v173
    v_fmac_f32 v243, v38, v158
    v_fmac_f32 v241, v46, v174
    v_fmac_f32 v243, v39, v159
    v_fmac_f32 v241, v47, v175
    ds_read_b64_tr_b16 v[20:21], v249 offset:512
    ds_read_b64_tr_b16 v[22:23], v249 offset:640
    ds_read_b128 v[24:27], v250 offset:64
    ds_read_b128 v[28:31], v250 offset:80
    ds_read_b128 v[32:35], v250 offset:448
    ds_read_b128 v[36:39], v250 offset:464
    v_fma_f32 v245, v48, v168, -v245
    v_fmac_f32 v237, v56, v120
    v_fmac_f32 v245, v49, v169
    v_fmac_f32 v237, v57, v121
    v_fmac_f32 v245, v50, v170
    v_fmac_f32 v237, v58, v122
    v_fmac_f32 v245, v51, v171
    v_fmac_f32 v237, v59, v123
    v_fmac_f32 v245, v52, v172
    v_fmac_f32 v237, v60, v124
    v_fmac_f32 v245, v53, v173
    v_fmac_f32 v237, v61, v125
    v_fmac_f32 v245, v54, v174
    v_fmac_f32 v237, v62, v126
    v_fmac_f32 v245, v55, v175
    v_fmac_f32 v237, v63, v127
    s_cmp_lg_u32 s34, 0
    s_cbranch_scc1 K2_SWITCH
    s_mov_b32 s29, s48
    s_mov_b32 s32, s31
    s_mov_b32 s30, s3
    s_mov_b32 s31, s35
    s_cmp_eq_u32 s33, 2
    s_cbranch_scc1 K2_U20
    s_cmp_eq_u32 s33, 3
    s_cbranch_scc1 K2_U30
    s_cmp_eq_u32 s33, 1
    s_cbranch_scc1 K2_U10
    s_branch K2_U40
K2_U30:
    s_setprio 1
    s_waitcnt lgkmcnt(10)
    v_lshlrev_b32 v40, 16, v0
    v_and_b32 v41, 0xffff0000, v0
    v_lshlrev_b32 v42, 16, v1
    v_and_b32 v43, 0xffff0000, v1
    v_lshlrev_b32 v44, 16, v2
    v_and_b32 v45, 0xffff0000, v2
    v_lshlrev_b32 v46, 16, v3
    v_and_b32 v47, 0xffff0000, v3
    s_waitcnt lgkmcnt(8)
    v_mul_f32 v4, v40, v4
    v_mul_f32 v5, v41, v5
    v_mul_f32 v6, v42, v6
    v_mul_f32 v7, v43, v7
    v_mul_f32 v8, v44, v8
    v_mul_f32 v9, v45, v9
    v_mul_f32 v10, v46, v10
    v_mul_f32 v11, v47, v11
    v_cvt_pk_bf16_f32 v64, v4, v5
    v_cvt_pk_bf16_f32 v65, v6, v7
    v_cvt_pk_bf16_f32 v66, v8, v9
    v_cvt_pk_bf16_f32 v67, v10, v11
    s_waitcnt lgkmcnt(6)
    v_mul_f32 v12, v40, v12
    v_mul_f32 v13, v41, v13
    v_mul_f32 v14, v42, v14
    v_mul_f32 v15, v43, v15
    v_mul_f32 v16, v44, v16
    v_mul_f32 v17, v45, v17
    v_mul_f32 v18, v46, v18
    v_mul_f32 v19, v47, v19
    v_cvt_pk_bf16_f32 v68, v12, v13
    v_cvt_pk_bf16_f32 v69, v14, v15
    v_cvt_pk_bf16_f32 v70, v16, v17
    v_cvt_pk_bf16_f32 v71, v18, v19
    ds_read_b64_tr_b16 v[0:1], v249 offset:1024
    ds_read_b64_tr_b16 v[2:3], v249 offset:1152
    ds_read_b128 v[4:7], v250 offset:128
    ds_read_b128 v[8:11], v250 offset:144
    ds_read_b128 v[12:15], v250 offset:512
    ds_read_b128 v[16:19], v250 offset:528
    s_waitcnt lgkmcnt(10)
    v_lshlrev_b32 v48, 16, v20
    v_and_b32 v49, 0xffff0000, v20
    v_lshlrev_b32 v50, 16, v21
    v_and_b32 v51, 0xffff0000, v21
    v_lshlrev_b32 v52, 16, v22
    v_and_b32 v53, 0xffff0000, v22
    v_lshlrev_b32 v54, 16, v23
    v_and_b32 v55, 0xffff0000, v23
    s_waitcnt lgkmcnt(8)
    v_mul_f32 v24, v48, v24
    v_mul_f32 v25, v49, v25
    v_mul_f32 v26, v50, v26
    v_mul_f32 v27, v51, v27
    v_mul_f32 v28, v52, v28
    v_mul_f32 v29, v53, v29
    v_mul_f32 v30, v54, v30
    v_mul_f32 v31, v55, v31
    v_cvt_pk_bf16_f32 v72, v24, v25
    v_cvt_pk_bf16_f32 v73, v26, v27
    v_cvt_pk_bf16_f32 v74, v28, v29
    v_cvt_pk_bf16_f32 v75, v30, v31
    s_waitcnt lgkmcnt(6)
    v_mul_f32 v32, v48, v32
    v_mul_f32 v33, v49, v33
    v_mul_f32 v34, v50, v34
    v_mul_f32 v35, v51, v35
    v_mul_f32 v36, v52, v36
    v_mul_f32 v37, v53, v37
    v_mul_f32 v38, v54, v38
    v_mul_f32 v39, v55, v39
    v_cvt_pk_bf16_f32 v76, v32, v33
    v_cvt_pk_bf16_f32 v77, v34, v35
    v_cvt_pk_bf16_f32 v78, v36, v37
    v_cvt_pk_bf16_f32 v79, v38, v39
    s_waitcnt lgkmcnt(4)
    v_lshlrev_b32 v40, 16, v0
    v_and_b32 v41, 0xffff0000, v0
    v_lshlrev_b32 v42, 16, v1
    v_and_b32 v43, 0xffff0000, v1
    v_lshlrev_b32 v44, 16, v2
    v_and_b32 v45, 0xffff0000, v2
    v_lshlrev_b32 v46, 16, v3
    v_and_b32 v47, 0xffff0000, v3
    s_waitcnt lgkmcnt(2)
    v_mul_f32 v4, v40, v4
    v_mul_f32 v5, v41, v5
    v_mul_f32 v6, v42, v6
    v_mul_f32 v7, v43, v7
    v_mul_f32 v8, v44, v8
    v_mul_f32 v9, v45, v9
    v_mul_f32 v10, v46, v10
    v_mul_f32 v11, v47, v11
    v_cvt_pk_bf16_f32 v80, v4, v5
    v_cvt_pk_bf16_f32 v81, v6, v7
    v_cvt_pk_bf16_f32 v82, v8, v9
    v_cvt_pk_bf16_f32 v83, v10, v11
    s_waitcnt lgkmcnt(0)
    v_mul_f32 v12, v40, v12
    v_mul_f32 v13, v41, v13
    v_mul_f32 v14, v42, v14
    v_mul_f32 v15, v43, v15
    v_mul_f32 v16, v44, v16
    v_mul_f32 v17, v45, v17
    v_mul_f32 v18, v46, v18
    v_mul_f32 v19, v47, v19
    v_cvt_pk_bf16_f32 v84, v12, v13
    v_cvt_pk_bf16_f32 v85, v14, v15
    v_cvt_pk_bf16_f32 v86, v16, v17
    v_cvt_pk_bf16_f32 v87, v18, v19
    s_waitcnt vmcnt(4)
    v_mfma_f32_32x32x16_bf16 v[0:15], v[64:67], v[176:179], 0
    ds_read_b64_tr_b16 v[184:185], v246 offset:2048
    ds_read_b64_tr_b16 v[186:187], v246 offset:2560
    ds_read_b64_tr_b16 v[188:189], v247 offset:2048
    ds_read_b64_tr_b16 v[190:191], v247 offset:2560
    s_mov_b32 m0, s68
    v_mfma_f32_32x32x16_bf16 v[16:31], v[68:71], v[176:179], 0
    buffer_load_dwordx4 v224, s[4:7], s41 offen lds
    buffer_load_dwordx4 v225, s[72:75], s41 offen offset:1024 lds
    v_permlane32_swap_b32 v242, v243
    v_permlane32_swap_b32 v240, v241
    s_add_u32 s38, s38, 1
    v_mfma_f32_32x32x16_bf16 v[32:47], v[64:67], v[180:183], 0
    v_permlane32_swap_b32 v236, v237
    v_permlane32_swap_b32 v244, v245
    v_add_f32 v242, v242, v243
    v_add_f32 v240, -v240, -v241
    v_add_f32 v236, v236, v237
    v_mfma_f32_32x32x16_bf16 v[48:63], v[68:71], v[180:183], 0
    v_add_f32 v244, v244, v245
    s_set_gpr_idx_on s32, gpr_idx(DST)
    s_nop 0
    v_cvt_pk_bf16_f32 v195, v242, v236
    v_cvt_pk_bf16_f32 v196, v244, v240
    v_cvt_pk_bf16_f32 v197, v238, v238
    s_set_gpr_idx_off
    s_waitcnt vmcnt(4) lgkmcnt(0)
    v_mfma_f32_32x32x16_bf16 v[0:15], v[72:75], v[184:187], v[0:15]
    ds_read_b64_tr_b16 v[176:177], v246 offset:4096
    ds_read_b64_tr_b16 v[178:179], v246 offset:4608
    ds_read_b64_tr_b16 v[180:181], v247 offset:4096
    ds_read_b64_tr_b16 v[182:183], v247 offset:4608
    v_mov_b32 v254, s52
    v_mov_b32 v255, s38
    s_mov_b32 m0, s69
    v_mfma_f32_32x32x16_bf16 v[16:31], v[76:79], v[184:187], v[16:31]
    buffer_load_dwordx4 v226, s[4:7], s41 offen lds
    buffer_load_dwordx4 v227, s[72:75], s41 offen offset:1024 lds
    s_lshl_b32 s58, s38, 3
    s_add_u32 s58, s58, s20
    s_mov_b64 exec, 1
    ds_write_b32 v254, v255
    s_mov_b64 exec, -1
    s_cmp_lt_u32 s58, s22
    s_cbranch_scc0 K2_dyn_41
K2_back_42:
    v_readlane_b32 s3, v253, s58
    s_lshl_b32 s44, s34, 7
    s_lshl_b32 s60, s58, 5
    s_and_b32 s48, s3, 0x3ffff
    s_bfe_u32 s33, s3, 0x30012
    s_sub_u32 s60, s60, s48
    s_and_b32 s60, s60, 0xff
    s_add_u32 s60, s60, s48
    s_mul_i32 s35, s38, 6
    s_cmp_eq_u32 s34, 0
    s_cselect_b32 s35, s35, s60
    s_mov_b32 s45, s44
    s_add_u32 s47, s44, 256
    s_add_u32 s49, s48, 32
    s_add_u32 s60, s48, 64
    s_cmp_eq_u32 s33, 3
    s_cselect_b32 s46, s44, s47
    s_cselect_b32 s50, s60, s48
    s_cselect_b32 s51, s48, s49
    s_sub_u32 s60, s33, 2
    s_cmp_lt_u32 s60, 2
    s_cbranch_scc0 K2_rare_47
K2_back_48:
    v_mfma_f32_32x32x16_bf16 v[32:47], v[72:75], v[188:191], v[32:47]
    v_add_u32 v233, s48, v230
    ds_read_b32 v232, v233
    ds_read_b32 v233, v233 offset:1024
    v_mfma_f32_32x32x16_bf16 v[48:63], v[76:79], v[188:191], v[48:63]
    s_waitcnt vmcnt(4) lgkmcnt(3)
    v_mfma_f32_32x32x16_bf16 v[0:15], v[80:83], v[176:179], v[0:15]
    ds_read_b64_tr_b16 v[184:185], v246 offset:6144
    ds_read_b64_tr_b16 v[186:187], v246 offset:6656
    ds_read_b64_tr_b16 v[188:189], v247 offset:6144
    ds_read_b64_tr_b16 v[190:191], v247 offset:6656
    s_mov_b32 m0, s70
    v_mfma_f32_32x32x16_bf16 v[16:31], v[84:87], v[176:179], v[16:31]
    buffer_load_dwordx4 v222, s[4:7], s42 offen lds
    buffer_load_dwordx4 v223, s[72:75], s42 offen offset:1024 lds
    v_mfma_f32_32x32x16_bf16 v[32:47], v[80:83], v[180:183], v[32:47]
    s_nop 2
    v_mul_f32 v234, v0, v96
    v_mul_f32 v236, v8, v128
    v_fmac_f32 v234, v1, v97
    v_fmac_f32 v236, v9, v129
    v_fmac_f32 v234, v2, v98
    v_fmac_f32 v236, v10, v130
    v_fmac_f32 v234, v3, v99
    v_mfma_f32_32x32x16_bf16 v[48:63], v[84:87], v[180:183], v[48:63]
    s_setprio 0
    s_waitcnt lgkmcnt(4)
    v_or_b32 v232, v232, v231
    v_or_b32 v233, v233, v231
    s_cmp_lg_u32 s34, 0
    s_cbranch_scc1 K2_dum_50
    s_add_u32 m0, s48, 864
    s_add_u32 s65, s48, 1888
    buffer_load_dwordx4 v232, s[16:19], 0 offen  lds
    s_mov_b32 m0, s65
    s_mov_b32 exec_hi, 0
    buffer_load_dwordx4 v233, s[16:19], 0 offen  lds
    s_cmp_eq_u32 s33, 4
    s_cbranch_scc1 K2_a4_51
K2_b4_53:
    s_mov_b32 exec_hi, -1
K2_back_52:
    v_fmac_f32 v236, v11, v131
    v_fmac_f32 v234, v4, v100
    v_fmac_f32 v236, v12, v132
    v_fmac_f32 v234, v5, v101
    v_fmac_f32 v236, v13, v133
    v_fmac_f32 v234, v6, v102
    v_fmac_f32 v236, v14, v134
    v_fmac_f32 v234, v7, v103
    v_fmac_f32 v236, v15, v135
    v_mul_f32 v238, v16, v128
    v_mul_f32 v240, v24, v128
    v_fmac_f32 v238, v17, v129
    v_fmac_f32 v240, v25, v129
    v_fmac_f32 v238, v18, v130
    v_fmac_f32 v240, v26, v130
    v_fmac_f32 v238, v19, v131
    v_fmac_f32 v240, v27, v131
    v_fmac_f32 v238, v20, v132
    v_fmac_f32 v240, v28, v132
    v_fmac_f32 v238, v21, v133
    v_fmac_f32 v240, v29, v133
    v_fmac_f32 v238, v22, v134
    v_fmac_f32 v240, v30, v134
    v_fmac_f32 v238, v23, v135
    v_fmac_f32 v240, v31, v135
    v_mul_f32 v235, v32, v104
    v_mul_f32 v237, v40, v136
    v_fmac_f32 v235, v33, v105
    v_fmac_f32 v237, v41, v137
    v_fmac_f32 v235, v34, v106
    v_fmac_f32 v237, v42, v138
    v_fmac_f32 v235, v35, v107
    v_fmac_f32 v237, v43, v139
    v_fmac_f32 v235, v36, v108
    v_fmac_f32 v237, v44, v140
    v_fmac_f32 v235, v37, v109
    v_fmac_f32 v237, v45, v141
    v_fmac_f32 v235, v38, v110
    v_fmac_f32 v237, v46, v142
    v_fmac_f32 v235, v39, v111
    v_fmac_f32 v237, v47, v143
    v_mul_f32 v239, v48, v136
    v_mul_f32 v241, v56, v136
    s_setprio 1
    s_waitcnt vmcnt(6) lgkmcnt(0)
    v_mfma_f32_32x32x16_bf16 v[0:15], v[64:67], v[184:187], 0
    ds_read_b64_tr_b16 v[176:177], v246 offset:0
    ds_read_b64_tr_b16 v[178:179], v246 offset:512
    ds_read_b64_tr_b16 v[180:181], v247 offset:0
    ds_read_b64_tr_b16 v[182:183], v247 offset:512
    v_fmac_f32 v239, v49, v137
    v_fmac_f32 v241, v57, v137
    s_mov_b32 m0, s71
    v_mfma_f32_32x32x16_bf16 v[16:31], v[68:71], v[184:187], 0
    buffer_load_dwordx4 v224, s[4:7], s42 offen lds
    buffer_load_dwordx4 v225, s[72:75], s42 offen offset:1024 lds
    v_fmac_f32 v239, v50, v138
    v_fmac_f32 v241, v58, v138
    v_fmac_f32 v239, v51, v139
    v_fmac_f32 v241, v59, v139
    v_fmac_f32 v239, v52, v140
    v_mfma_f32_32x32x16_bf16 v[32:47], v[64:67], v[188:191], 0
    v_fmac_f32 v241, v60, v140
    v_fmac_f32 v239, v53, v141
    v_fmac_f32 v241, v61, v141
    v_fmac_f32 v239, v54, v142
    v_fmac_f32 v241, v62, v142
    v_fmac_f32 v239, v55, v143
    v_fmac_f32 v241, v63, v143
    v_mfma_f32_32x32x16_bf16 v[48:63], v[68:71], v[188:191], 0
    v_permlane32_swap_b32 v234, v235
    v_permlane32_swap_b32 v236, v237
    v_permlane32_swap_b32 v238, v239
    s_waitcnt vmcnt(6) lgkmcnt(0)
    v_mfma_f32_32x32x16_bf16 v[0:15], v[72:75], v[176:179], v[0:15]
    ds_read_b64_tr_b16 v[184:185], v246 offset:2048
    ds_read_b64_tr_b16 v[186:187], v246 offset:2560
    ds_read_b64_tr_b16 v[188:189], v247 offset:2048
    ds_read_b64_tr_b16 v[190:191], v247 offset:2560
    v_permlane32_swap_b32 v240, v241
    s_mov_b32 m0, s68
    v_mfma_f32_32x32x16_bf16 v[16:31], v[76:79], v[176:179], v[16:31]
    buffer_load_dwordx4 v226, s[4:7], s42 offen lds
    buffer_load_dwordx4 v227, s[72:75], s42 offen offset:1024 lds
    v_add_f32 v234, v234, v235
    v_add_f32 v236, v236, v237
    v_add_f32 v238, v238, v239
    v_add_f32 v240, v240, v241
    v_mfma_f32_32x32x16_bf16 v[32:47], v[72:75], v[180:183], v[32:47]
    s_set_gpr_idx_on s31, gpr_idx(DST)
    s_nop 0
    v_cvt_pk_bf16_f32 v192, v234, v236
    v_cvt_pk_bf16_f32 v193, v238, v240
    s_set_gpr_idx_off
    v_mfma_f32_32x32x16_bf16 v[48:63], v[76:79], v[180:183], v[48:63]
    s_waitcnt vmcnt(6) lgkmcnt(0)
    v_mfma_f32_32x32x16_bf16 v[0:15], v[80:83], v[184:187], v[0:15]
    ds_read_b64_tr_b16 v[176:177], v246 offset:4096
    ds_read_b64_tr_b16 v[178:179], v246 offset:4608
    ds_read_b64_tr_b16 v[180:181], v247 offset:4096
    ds_read_b64_tr_b16 v[182:183], v247 offset:4608
    s_mov_b32 m0, s69
    v_mfma_f32_32x32x16_bf16 v[16:31], v[84:87], v[184:187], v[16:31]
    buffer_load_dwordx4 v222, s[4:7], s43 offen lds
    buffer_load_dwordx4 v223, s[72:75], s43 offen offset:1024 lds
    v_mfma_f32_32x32x16_bf16 v[32:47], v[80:83], v[188:191], v[32:47]
    s_nop 2
    v_mul_f32 v234, v0, v144
    v_mul_f32 v236, v8, v112
    v_fmac_f32 v234, v1, v145
    v_fmac_f32 v236, v9, v113
    v_fmac_f32 v234, v2, v146
    v_fmac_f32 v236, v10, v114
    v_fmac_f32 v234, v3, v147
    v_mfma_f32_32x32x16_bf16 v[48:63], v[84:87], v[188:191], v[48:63]
    s_setprio 0
    v_fmac_f32 v236, v11, v115
    v_fmac_f32 v234, v4, v148
    v_fmac_f32 v236, v12, v116
    v_fmac_f32 v234, v5, v149
    v_fmac_f32 v236, v13, v117
    v_fmac_f32 v234, v6, v150
    v_fmac_f32 v236, v14, v118
    v_fmac_f32 v234, v7, v151
    v_fmac_f32 v236, v15, v119
    v_mul_f32 v238, v16, v160
    v_mul_f32 v240, v24, v160
    v_fmac_f32 v238, v17, v161
    v_fmac_f32 v240, v25, v161
    v_fmac_f32 v238, v18, v162
    v_fmac_f32 v240, v26, v162
    v_fmac_f32 v238, v19, v163
    v_fmac_f32 v240, v27, v163
    v_fmac_f32 v238, v20, v164
    v_fmac_f32 v240, v28, v164
    v_fmac_f32 v238, v21, v165
    v_fmac_f32 v240, v29, v165
    v_fmac_f32 v238, v22, v166
    v_fmac_f32 v240, v30, v166
    v_fmac_f32 v238, v23, v167
    v_fmac_f32 v240, v31, v167
    v_mul_f32 v235, v32, v152
    v_mul_f32 v237, v40, v120
    v_fmac_f32 v235, v33, v153
    v_fmac_f32 v237, v41, v121
    v_fmac_f32 v235, v34, v154
    v_fmac_f32 v237, v42, v122
    v_fmac_f32 v235, v35, v155
    v_fmac_f32 v237, v43, v123
    v_fmac_f32 v235, v36, v156
    v_fmac_f32 v237, v44, v124
    v_fmac_f32 v235, v37, v157
    v_fmac_f32 v237, v45, v125
    v_fmac_f32 v235, v38, v158
    v_fmac_f32 v237, v46, v126
    v_fmac_f32 v235, v39, v159
    v_fmac_f32 v237, v47, v127
    v_mul_f32 v239, v48, v168
    v_mul_f32 v241, v56, v168
    v_fmac_f32 v239, v49, v169
    v_fmac_f32 v241, v57, v169
    s_setprio 1
    s_waitcnt vmcnt(4) lgkmcnt(0)
    v_mfma_f32_32x32x16_bf16 v[0:15], v[64:67], v[176:179], 0
    ds_read_b64_tr_b16 v[184:185], v246 offset:6144
    ds_read_b64_tr_b16 v[186:187], v246 offset:6656
    ds_read_b64_tr_b16 v[188:189], v247 offset:6144
    ds_read_b64_tr_b16 v[190:191], v247 offset:6656
    v_fmac_f32 v239, v50, v170
    v_fmac_f32 v241, v58, v170
    s_mov_b32 m0, s70
    v_mfma_f32_32x32x16_bf16 v[16:31], v[68:71], v[176:179], 0
    buffer_load_dwordx4 v224, s[4:7], s43 offen lds
    buffer_load_dwordx4 v225, s[72:75], s43 offen offset:1024 lds
    v_fmac_f32 v239, v51, v171
    v_fmac_f32 v241, v59, v171
    v_fmac_f32 v239, v52, v172
    v_fmac_f32 v241, v60, v172
    v_fmac_f32 v239, v53, v173
    v_mfma_f32_32x32x16_bf16 v[32:47], v[64:67], v[180:183], 0
    v_add_u32 v222, s48, v251
    ds_read_b32 v222, v222
    v_fmac_f32 v241, v61, v173
    v_fmac_f32 v239, v54, v174
    v_fmac_f32 v241, v62, v174
    v_fmac_f32 v239, v55, v175
    v_fmac_f32 v241, v63, v175
    v_mfma_f32_32x32x16_bf16 v[48:63], v[68:71], v[180:183], 0
    v_permlane32_swap_b32 v234, v235
    v_add_f32 v234, v234, v235
    s_waitcnt vmcnt(4) lgkmcnt(1)
    v_mfma_f32_32x32x16_bf16 v[0:15], v[72:75], v[184:187], v[0:15]
    ds_read_b64_tr_b16 v[176:177], v246 offset:0
    ds_read_b64_tr_b16 v[178:179], v246 offset:512
    ds_read_b64_tr_b16 v[180:181], v247 offset:0
    ds_read_b64_tr_b16 v[182:183], v247 offset:512
    s_mov_b32 m0, s71
    v_mfma_f32_32x32x16_bf16 v[16:31], v[76:79], v[184:187], v[16:31]
    buffer_load_dwordx4 v226, s[4:7], s43 offen lds
    buffer_load_dwordx4 v227, s[72:75], s43 offen offset:1024 lds
    s_waitcnt lgkmcnt(4)
    v_mad_u32_u16 v223, v222, s39, v248 op_sel:[1,0,0,0]
    v_mad_u32_u16 v222, v222, s39, v248
    v_mfma_f32_32x32x16_bf16 v[32:47], v[72:75], v[188:191], v[32:47]
    v_add_u32 v224, s49, v251
    ds_read_b32 v224, v224
    v_mfma_f32_32x32x16_bf16 v[48:63], v[76:79], v[188:191], v[48:63]
    s_waitcnt vmcnt(4) lgkmcnt(1)
    v_mfma_f32_32x32x16_bf16 v[0:15], v[80:83], v[176:179], v[0:15]
    ds_read_b64_tr_b16 v[184:185], v246 offset:2048
    ds_read_b64_tr_b16 v[186:187], v246 offset:2560
    ds_read_b64_tr_b16 v[188:189], v247 offset:2048
    ds_read_b64_tr_b16 v[190:191], v247 offset:2560
    s_mov_b32 m0, s68
    v_mfma_f32_32x32x16_bf16 v[16:31], v[84:87], v[176:179], v[16:31]
    buffer_load_dwordx4 v222, s[4:7], s44 offen lds
    buffer_load_dwordx4 v223, s[72:75], s44 offen offset:1024 lds
    s_waitcnt lgkmcnt(4)
    v_mad_u32_u16 v225, v224, s39, v248 op_sel:[1,0,0,0]
    v_mad_u32_u16 v224, v224, s39, v248
    v_mfma_f32_32x32x16_bf16 v[32:47], v[80:83], v[180:183], v[32:47]
    v_add_u32 v226, s50, v251
    ds_read_b32 v226, v226
    v_mul_f32 v242, v0, v144
    v_fma_f32 v238, v8, v160, -v238
    v_fmac_f32 v242, v1, v145
    v_fmac_f32 v238, v9, v161
    v_fmac_f32 v242, v2, v146
    v_mfma_f32_32x32x16_bf16 v[48:63], v[84:87], v[180:183], v[48:63]
    s_setprio 0
    v_fmac_f32 v238, v10, v162
    v_fmac_f32 v242, v3, v147
    v_fmac_f32 v238, v11, v163
    v_fmac_f32 v242, v4, v148
    v_fmac_f32 v238, v12, v164
    v_fmac_f32 v242, v5, v149
    v_fmac_f32 v238, v13, v165
    v_fmac_f32 v242, v6, v150
    v_fmac_f32 v238, v14, v166
    v_fmac_f32 v242, v7, v151
    v_fmac_f32 v238, v15, v167
    v_fmac_f32 v236, v16, v112
    v_mul_f32 v244, v24, v160
    v_fmac_f32 v236, v17, v113
    v_fmac_f32 v244, v25, v161
    v_fmac_f32 v236, v18, v114
    v_fmac_f32 v244, v26, v162
    v_fmac_f32 v236, v19, v115
    v_fmac_f32 v244, v27, v163
    v_fmac_f32 v236, v20, v116
    v_fmac_f32 v244, v28, v164
    v_fmac_f32 v236, v21, v117
    v_fmac_f32 v244, v29, v165
    v_fmac_f32 v236, v22, v118
    v_fmac_f32 v244, v30, v166
    v_fmac_f32 v236, v23, v119
    v_fmac_f32 v244, v31, v167
    v_mul_f32 v243, v32, v152
    v_fma_f32 v239, v40, v168, -v239
    v_fmac_f32 v243, v33, v153
    v_fmac_f32 v239, v41, v169
    v_fmac_f32 v243, v34, v154
    v_fmac_f32 v239, v42, v170
    v_fmac_f32 v243, v35, v155
    v_fmac_f32 v239, v43, v171
    v_fmac_f32 v243, v36, v156
    v_fmac_f32 v239, v44, v172
    v_fmac_f32 v243, v37, v157
    v_fmac_f32 v239, v45, v173
    v_fmac_f32 v243, v38, v158
    v_fmac_f32 v239, v46, v174
    v_fmac_f32 v243, v39, v159
    v_fmac_f32 v239, v47, v175
    v_fmac_f32 v237, v48, v120
    v_mul_f32 v245, v56, v168
    v_fmac_f32 v237, v49, v121
    v_fmac_f32 v245, v57, v169
    v_fmac_f32 v237, v50, v122
    v_fmac_f32 v245, v58, v170
    v_fmac_f32 v237, v51, v123
    s_setprio 1
    s_waitcnt vmcnt(4) lgkmcnt(1)
    v_mfma_f32_32x32x16_bf16 v[0:15], v[64:67], v[184:187], 0
    ds_read_b64_tr_b16 v[176:177], v246 offset:4096
    ds_read_b64_tr_b16 v[178:179], v246 offset:4608
    ds_read_b64_tr_b16 v[180:181], v247 offset:4096
    ds_read_b64_tr_b16 v[182:183], v247 offset:4608
    v_fmac_f32 v245, v59, v171
    v_fmac_f32 v237, v52, v124
    s_mov_b32 m0, s69
    v_mfma_f32_32x32x16_bf16 v[16:31], v[68:71], v[184:187], 0
    buffer_load_dwordx4 v224, s[4:7], s45 offen lds
    buffer_load_dwordx4 v225, s[72:75], s45 offen offset:1024 lds
    s_waitcnt lgkmcnt(4)
    v_mad_u32_u16 v227, v226, s39, v248 op_sel:[1,0,0,0]
    v_mad_u32_u16 v226, v226, s39, v248
    v_fmac_f32 v245, v60, v172
    v_fmac_f32 v237, v53, v125
    v_mfma_f32_32x32x16_bf16 v[32:47], v[64:67], v[188:191], 0
    v_add_u32 v228, s51, v251
    ds_read_b32 v228, v228
    v_fmac_f32 v245, v61, v173
    v_fmac_f32 v237, v54, v126
    v_fmac_f32 v245, v62, v174
    v_fmac_f32 v237, v55, v127
    v_fmac_f32 v245, v63, v175
    v_mfma_f32_32x32x16_bf16 v[48:63], v[68:71], v[188:191], 0
    v_permlane32_swap_b32 v238, v239
    v_permlane32_swap_b32 v242, v243
    v_add_f32 v238, v238, v239
    v_add_f32 v242, v242, v243
    s_waitcnt vmcnt(4) lgkmcnt(1)
    v_mfma_f32_32x32x16_bf16 v[0:15], v[72:75], v[176:179], v[0:15]
    ds_read_b64_tr_b16 v[184:185], v246 offset:6144
    ds_read_b64_tr_b16 v[186:187], v246 offset:6656
    ds_read_b64_tr_b16 v[188:189], v247 offset:6144
    ds_read_b64_tr_b16 v[190:191], v247 offset:6656
    s_mov_b32 m0, s70
    v_mfma_f32_32x32x16_bf16 v[16:31], v[76:79], v[176:179], v[16:31]
    buffer_load_dwordx4 v226, s[4:7], s46 offen lds
    buffer_load_dwordx4 v227, s[72:75], s46 offen offset:1024 lds
    s_waitcnt lgkmcnt(4)
    v_mad_u32_u16 v229, v228, s39, v248 op_sel:[1,0,0,0]
    v_mad_u32_u16 v228, v228, s39, v248
    v_mfma_f32_32x32x16_bf16 v[32:47], v[72:75], v[180:183], v[32:47]
    s_set_gpr_idx_on s31, gpr_idx(DST)
    s_nop 0
    v_cvt_pk_bf16_f32 v194, v234, v242
    s_set_gpr_idx_off
    v_mfma_f32_32x32x16_bf16 v[48:63], v[76:79], v[180:183], v[48:63]
    s_waitcnt vmcnt(4) lgkmcnt(0)
    v_mfma_f32_32x32x16_bf16 v[0:15], v[80:83], v[184:187], v[0:15]
    ds_read_b64_tr_b16 v[176:177], v246 offset:0
    ds_read_b64_tr_b16 v[178:179], v246 offset:512
    ds_read_b64_tr_b16 v[180:181], v247 offset:0
    ds_read_b64_tr_b16 v[182:183], v247 offset:512
    s_mov_b32 m0, s71
    v_mfma_f32_32x32x16_bf16 v[16:31], v[84:87], v[184:187], v[16:31]
    buffer_load_dwordx4 v228, s[4:7], s47 offen lds
    buffer_load_dwordx4 v229, s[72:75], s47 offen offset:1024 lds
    v_mfma_f32_32x32x16_bf16 v[32:47], v[80:83], v[188:191], v[32:47]
    s_nop 2
    v_mul_f32 v242, v0, v144
    s_nop 1
    v_fma_f32 v240, v8, v160, -v240
    v_fmac_f32 v242, v1, v145
    v_fmac_f32 v240, v9, v161
    v_fmac_f32 v242, v2, v146
    v_fmac_f32 v240, v10, v162
    v_fmac_f32 v242, v3, v147
    v_mfma_f32_32x32x16_bf16 v[48:63], v[84:87], v[188:191], v[48:63]
    s_setprio 0
    v_fmac_f32 v240, v11, v163
    v_fmac_f32 v242, v4, v148
    v_fmac_f32 v240, v12, v164
    v_fmac_f32 v242, v5, v149
    v_fmac_f32 v240, v13, v165
    v_fmac_f32 v242, v6, v150
    v_fmac_f32 v240, v14, v166
    v_fmac_f32 v242, v7, v151
    v_fmac_f32 v240, v15, v167
    s_sub_u32 s58, s48, s29
    v_add_u32 v249, s58, v249
    v_add_u32 v250, s58, v250
    v_fma_f32 v244, v16, v160, -v244
    v_fmac_f32 v236, v24, v112
    v_fmac_f32 v244, v17, v161
    v_fmac_f32 v236, v25, v113
    v_fmac_f32 v244, v18, v162
    v_fmac_f32 v236, v26, v114
    v_fmac_f32 v244, v19, v163
    v_fmac_f32 v236, v27, v115
    v_fmac_f32 v244, v20, v164
    v_fmac_f32 v236, v28, v116
    v_fmac_f32 v244, v21, v165
    v_fmac_f32 v236, v29, v117
    v_fmac_f32 v244, v22, v166
    v_fmac_f32 v236, v30, v118
    v_fmac_f32 v244, v23, v167
    v_fmac_f32 v236, v31, v119
    ds_read_b64_tr_b16 v[0:1], v249 offset:0
    ds_read_b64_tr_b16 v[2:3], v249 offset:128
    ds_read_b128 v[4:7], v250 offset:0
    ds_read_b128 v[8:11], v250 offset:16
    ds_read_b128 v[12:15], v250 offset:384
    ds_read_b128 v[16:19], v250 offset:400
    v_mul_f32 v243, v32, v152
    v_fma_f32 v241, v40, v168, -v241
    v_fmac_f32 v243, v33, v153
    v_fmac_f32 v241, v41, v169
    v_fmac_f32 v243, v34, v154
    v_fmac_f32 v241, v42, v170
    v_fmac_f32 v243, v35, v155
    v_fmac_f32 v241, v43, v171
    v_fmac_f32 v243, v36, v156
    v_fmac_f32 v241, v44, v172
    v_fmac_f32 v243, v37, v157
    v_fmac_f32 v241, v45, v173
    v_fmac_f32 v243, v38, v158
    v_fmac_f32 v241, v46, v174
    v_fmac_f32 v243, v39, v159
    v_fmac_f32 v241, v47, v175
    ds_read_b64_tr_b16 v[20:21], v249 offset:512
    ds_read_b64_tr_b16 v[22:23], v249 offset:640
    ds_read_b128 v[24:27], v250 offset:64
    ds_read_b128 v[28:31], v250 offset:80
    ds_read_b128 v[32:35], v250 offset:448
    ds_read_b128 v[36:39], v250 offset:464
    v_fma_f32 v245, v48, v168, -v245
    v_fmac_f32 v237, v56, v120
    v_fmac_f32 v245, v49, v169
    v_fmac_f32 v237, v57, v121
    v_fmac_f32 v245, v50, v170
    v_fmac_f32 v237, v58, v122
    v_fmac_f32 v245, v51, v171
    v_fmac_f32 v237, v59, v123
    v_fmac_f32 v245, v52, v172
    v_fmac_f32 v237, v60, v124
    v_fmac_f32 v245, v53, v173
    v_fmac_f32 v237, v61, v125
    v_fmac_f32 v245, v54, v174
    v_fmac_f32 v237, v62, v126
    v_fmac_f32 v245, v55, v175
    v_fmac_f32 v237, v63, v127
    s_cmp_lg_u32 s34, 0
    s_cbranch_scc1 K2_SWITCH
    s_mov_b32 s29, s48
    s_mov_b32 s32, s31
    s_mov_b32 s30, s3
    s_mov_b32 s31, s35
    s_cmp_eq_u32 s33, 2
    s_cbranch_scc1 K2_U20
    s_cmp_eq_u32 s33, 3
    s_cbranch_scc1 K2_U30
    s_cmp_eq_u32 s33, 1
    s_cbranch_scc1 K2_U10
    s_branch K2_U40
K2_U21:
    s_setprio 1
    s_waitcnt lgkmcnt(10)
    v_lshlrev_b32 v40, 16, v0
    v_and_b32 v41, 0xffff0000, v0
    v_lshlrev_b32 v42, 16, v1
    v_and_b32 v43, 0xffff0000, v1
    v_lshlrev_b32 v44, 16, v2
    v_and_b32 v45, 0xffff0000, v2
    v_lshlrev_b32 v46, 16, v3
    v_and_b32 v47, 0xffff0000, v3
    s_waitcnt lgkmcnt(8)
    v_mul_f32 v4, v40, v4
    v_mul_f32 v5, v41, v5
    v_mul_f32 v6, v42, v6
    v_mul_f32 v7, v43, v7
    v_mul_f32 v8, v44, v8
    v_mul_f32 v9, v45, v9
    v_mul_f32 v10, v46, v10
    v_mul_f32 v11, v47, v11
    v_cvt_pk_bf16_f32 v64, v4, v5
    v_cvt_pk_bf16_f32 v65, v6, v7
    v_cvt_pk_bf16_f32 v66, v8, v9
    v_cvt_pk_bf16_f32 v67, v10, v11
    s_waitcnt lgkmcnt(6)
    v_mul_f32 v12, v40, v12
    v_mul_f32 v13, v41, v13
    v_mul_f32 v14, v42, v14
    v_mul_f32 v15, v43, v15
    v_mul_f32 v16, v44, v16
    v_mul_f32 v17, v45, v17
    v_mul_f32 v18, v46, v18
    v_mul_f32 v19, v47, v19
    v_cvt_pk_bf16_f32 v68, v12, v13
    v_cvt_pk_bf16_f32 v69, v14, v15
    v_cvt_pk_bf16_f32 v70, v16, v17
    v_cvt_pk_bf16_f32 v71, v18, v19
    s_waitcnt lgkmcnt(4)
    v_lshlrev_b32 v48, 16, v20
    v_and_b32 v49, 0xffff0000, v20
    v_lshlrev_b32 v50, 16, v21
    v_and_b32 v51, 0xffff0000, v21
    v_lshlrev_b32 v52, 16, v22
    v_and_b32 v53, 0xffff0000, v22
    v_lshlrev_b32 v54, 16, v23
    v_and_b32 v55, 0xffff0000, v23
    s_waitcnt lgkmcnt(2)
    v_mul_f32 v24, v48, v24
    v_mul_f32 v25, v49, v25
    v_mul_f32 v26, v50, v26
    v_mul_f32 v27, v51, v27
    v_mul_f32 v28, v52, v28
    v_mul_f32 v29, v53, v29
    v_mul_f32 v30, v54, v30
    v_mul_f32 v31, v55, v31
    v_cvt_pk_bf16_f32 v72, v24, v25
    v_cvt_pk_bf16_f32 v73, v26, v27
    v_cvt_pk_bf16_f32 v74, v28, v29
    v_cvt_pk_bf16_f32 v75, v30, v31
    s_waitcnt lgkmcnt(0)
    v_mul_f32 v32, v48, v32
    v_mul_f32 v33, v49, v33
    v_mul_f32 v34, v50, v34
    v_mul_f32 v35, v51, v35
    v_mul_f32 v36, v52, v36
    v_mul_f32 v37, v53, v37
    v_mul_f32 v38, v54, v38
    v_mul_f32 v39, v55, v39
    v_cvt_pk_bf16_f32 v76, v32, v33
    v_cvt_pk_bf16_f32 v77, v34, v35
    v_cvt_pk_bf16_f32 v78, v36, v37
    v_cvt_pk_bf16_f32 v79, v38, v39
    s_waitcnt vmcnt(4)
    v_mfma_f32_32x32x16_bf16 v[0:15], v[64:67], v[176:179], 0
    ds_read_b64_tr_b16 v[184:185], v246 offset:2048
    ds_read_b64_tr_b16 v[186:187], v246 offset:2560
    ds_read_b64_tr_b16 v[188:189], v247 offset:2048
    ds_read_b64_tr_b16 v[190:191], v247 offset:2560
    s_mov_b32 m0, s68
    v_mfma_f32_32x32x16_bf16 v[16:31], v[68:71], v[176:179], 0
    buffer_load_dwordx4 v222, s[4:7], s42 offen lds
    buffer_load_dwordx4 v223, s[72:75], s42 offen offset:1024 lds
    v_permlane32_swap_b32 v242, v243
    v_permlane32_swap_b32 v240, v241
    v_mov_b32 v254, 163648
    v_mfma_f32_32x32x16_bf16 v[32:47], v[64:67], v[180:183], 0
    v_permlane32_swap_b32 v236, v237
    v_permlane32_swap_b32 v244, v245
    v_add_f32 v242, v242, v243
    v_add_f32 v240, -v240, -v241
    v_add_f32 v236, v236, v237
    v_mfma_f32_32x32x16_bf16 v[48:63], v[68:71], v[180:183], 0
    v_add_f32 v244, v244, v245
    v_cvt_pk_bf16_f32 v242, v242, v236
    v_cvt_pk_bf16_f32 v244, v244, v240
    v_cvt_pk_bf16_f32 v238, v238, v238
    ds_write_b16 v230, v242 offset:1152
    ds_write_b16_d16_hi v230, v242 offset:128
    v_mov_b32 v255, 1
    v_lshl_add_u32 v233, v252, 1, s53
    s_mov_b64 exec, 1
    ds_add_rtn_u32 v232, v254, v255
    s_mov_b64 exec, -1
    ds_read_b32 v233, v233
    s_waitcnt vmcnt(4) lgkmcnt(4)
    v_mfma_f32_32x32x16_bf16 v[0:15], v[72:75], v[184:187], v[0:15]
    ds_read_b64_tr_b16 v[176:177], v246 offset:4096
    ds_read_b64_tr_b16 v[178:179], v246 offset:4608
    ds_read_b64_tr_b16 v[180:181], v247 offset:4096
    ds_read_b64_tr_b16 v[182:183], v247 offset:4608
    ds_write_b16 v230, v244 offset:512
    ds_write_b16_d16_hi v230, v244 offset:896
    s_mov_b32 m0, s69
    v_mfma_f32_32x32x16_bf16 v[16:31], v[76:79], v[184:187], v[16:31]
    buffer_load_dwordx4 v224, s[4:7], s42 offen lds
    buffer_load_dwordx4 v225, s[72:75], s42 offen offset:1024 lds
    ds_write_b16 v230, v238 offset:1280
    s_waitcnt lgkmcnt(7)
    v_readfirstlane_b32 s58, v232
    v_mfma_f32_32x32x16_bf16 v[32:47], v[72:75], v[188:191], v[32:47]
    s_cmp_lt_u32 s58, s22
    s_cbranch_scc0 K2_nul_54
    s_and_b32 s59, s58, 7
    s_lshr_b32 s60, s58, 3
K2_chk_56:
    v_readlane_b32 s61, v233, s59
    s_nop 0
    s_cmp_gt_u32 s61, s60
    s_cbranch_scc0 K2_spin_55
K2_back_57:
    v_mfma_f32_32x32x16_bf16 v[48:63], v[76:79], v[188:191], v[48:63]
    s_setprio 0
    v_readlane_b32 s3, v253, s58
    s_lshl_b32 s44, s34, 7
    s_lshl_b32 s60, s58, 5
    s_and_b32 s48, s3, 0x3ffff
    s_bfe_u32 s33, s3, 0x30012
    s_sub_u32 s60, s60, s48
    v_mul_f32 v234, v0, v96
    v_mul_f32 v236, v8, v128
    v_fmac_f32 v234, v1, v97
    v_fmac_f32 v236, v9, v129
    v_fmac_f32 v234, v2, v98
    v_fmac_f32 v236, v10, v130
    v_fmac_f32 v234, v3, v99
    v_fmac_f32 v236, v11, v131
    v_fmac_f32 v234, v4, v100
    v_fmac_f32 v236, v12, v132
    v_fmac_f32 v234, v5, v101
    v_fmac_f32 v236, v13, v133
    v_fmac_f32 v234, v6, v102
    v_fmac_f32 v236, v14, v134
    v_fmac_f32 v234, v7, v103
    v_fmac_f32 v236, v15, v135
    v_mul_f32 v238, v16, v128
    v_mul_f32 v240, v24, v128
    v_fmac_f32 v238, v17, v129
    v_fmac_f32 v240, v25, v129
    v_fmac_f32 v238, v18, v130
    v_fmac_f32 v240, v26, v130
    v_fmac_f32 v238, v19, v131
    v_fmac_f32 v240, v27, v131
    v_fmac_f32 v238, v20, v132
    v_fmac_f32 v240, v28, v132
    v_fmac_f32 v238, v21, v133
    v_fmac_f32 v240, v29, v133
    v_fmac_f32 v238, v22, v134
    v_fmac_f32 v240, v30, v134
    v_fmac_f32 v238, v23, v135
    v_fmac_f32 v240, v31, v135
    v_mul_f32 v235, v32, v104
    v_mul_f32 v237, v40, v136
    v_fmac_f32 v235, v33, v105
    v_fmac_f32 v237, v41, v137
    v_fmac_f32 v235, v34, v106
    v_fmac_f32 v237, v42, v138
    v_fmac_f32 v235, v35, v107
    v_fmac_f32 v237, v43, v139
    v_fmac_f32 v235, v36, v108
    v_fmac_f32 v237, v44, v140
    v_fmac_f32 v235, v37, v109
    v_fmac_f32 v237, v45, v141
    v_fmac_f32 v235, v38, v110
    v_fmac_f32 v237, v46, v142
    v_fmac_f32 v235, v39, v111
    v_fmac_f32 v237, v47, v143
    v_mul_f32 v239, v48, v136
    v_mul_f32 v241, v56, v136
    v_fmac_f32 v239, v49, v137
    v_fmac_f32 v241, v57, v137
    s_setprio 1
    s_waitcnt vmcnt(4) lgkmcnt(3)
    v_mfma_f32_32x32x16_bf16 v[0:15], v[64:67], v[176:179], 0
    ds_read_b64_tr_b16 v[184:185], v246 offset:6144
    ds_read_b64_tr_b16 v[186:187], v246 offset:6656
    ds_read_b64_tr_b16 v[188:189], v247 offset:6144
    ds_read_b64_tr_b16 v[190:191], v247 offset:6656
    v_fmac_f32 v239, v50, v138
    v_fmac_f32 v241, v58, v138
    s_mov_b32 m0, s70
    v_mfma_f32_32x32x16_bf16 v[16:31], v[68:71], v[176:179], 0
    buffer_load_dwordx4 v222, s[4:7], s43 offen lds
    buffer_load_dwordx4 v223, s[72:75], s43 offen offset:1024 lds
    v_fmac_f32 v239, v51, v139
    v_fmac_f32 v241, v59, v139
    v_fmac_f32 v239, v52, v140
    v_fmac_f32 v241, v60, v140
    v_fmac_f32 v239, v53, v141
    v_mfma_f32_32x32x16_bf16 v[32:47], v[64:67], v[180:183], 0
    s_and_b32 s60, s60, 0xff
    s_add_u32 s35, s60, s48
    s_mov_b32 s45, s44
    s_add_u32 s47, s44, 256
    s_add_u32 s49, s48, 32
    s_add_u32 s60, s48, 64
    s_cmp_eq_u32 s33, 3
    s_cselect_b32 s46, s44, s47
    s_cselect_b32 s50, s60, s48
    s_cselect_b32 s51, s48, s49
    s_sub_u32 s60, s33, 2
    s_cmp_lt_u32 s60, 2
    s_cbranch_scc0 K2_rare_58
K2_back_59:
    v_add_u32 v222, s48, v251
    ds_read_b32 v222, v222
    v_fmac_f32 v241, v61, v141
    v_fmac_f32 v239, v54, v142
    v_fmac_f32 v241, v62, v142
    v_fmac_f32 v239, v55, v143
    v_fmac_f32 v241, v63, v143
    v_mfma_f32_32x32x16_bf16 v[48:63], v[68:71], v[180:183], 0
    v_permlane32_swap_b32 v234, v235
    v_permlane32_swap_b32 v236, v237
    v_permlane32_swap_b32 v238, v239
    s_waitcnt vmcnt(4) lgkmcnt(1)
    v_mfma_f32_32x32x16_bf16 v[0:15], v[72:75], v[184:187], v[0:15]
    ds_read_b64_tr_b16 v[176:177], v246 offset:0
    ds_read_b64_tr_b16 v[178:179], v246 offset:512
    ds_read_b64_tr_b16 v[180:181], v247 offset:0
    ds_read_b64_tr_b16 v[182:183], v247 offset:512
    v_permlane32_swap_b32 v240, v241
    s_mov_b32 m0, s71
    v_mfma_f32_32x32x16_bf16 v[16:31], v[76:79], v[184:187], v[16:31]
    buffer_load_dwordx4 v224, s[4:7], s43 offen lds
    buffer_load_dwordx4 v225, s[72:75], s43 offen offset:1024 lds
    s_waitcnt lgkmcnt(4)
    v_mad_u32_u16 v223, v222, s39, v248 op_sel:[1,0,0,0]
    v_mad_u32_u16 v222, v222, s39, v248
    v_add_u32 v230, s31, v252
    v_add_f32 v234, v234, v235
    v_add_f32 v236, v236, v237
    v_add_f32 v238, v238, v239
    v_add_f32 v240, v240, v241
    v_cvt_pk_bf16_f32 v234, v234, v236
    v_cvt_pk_bf16_f32 v238, v238, v240
    ds_write_b16 v230, v234 offset:0
    ds_write_b16_d16_hi v230, v234 offset:256
    ds_write_b16 v230, v238 offset:640
    ds_write_b16_d16_hi v230, v238 offset:1024
    v_mfma_f32_32x32x16_bf16 v[32:47], v[72:75], v[188:191], v[32:47]
    v_add_u32 v224, s49, v251
    ds_read_b32 v224, v224
    v_mul_f32 v234, v0, v144
    v_mul_f32 v236, v8, v112
    v_fmac_f32 v234, v1, v145
    v_fmac_f32 v236, v9, v113
    v_fmac_f32 v234, v2, v146
    v_mfma_f32_32x32x16_bf16 v[48:63], v[76:79], v[188:191], v[48:63]
    s_setprio 0
    v_fmac_f32 v236, v10, v114
    v_fmac_f32 v234, v3, v147
    v_fmac_f32 v236, v11, v115
    v_fmac_f32 v234, v4, v148
    v_fmac_f32 v236, v12, v116
    v_fmac_f32 v234, v5, v149
    v_fmac_f32 v236, v13, v117
    v_fmac_f32 v234, v6, v150
    v_fmac_f32 v236, v14, v118
    v_fmac_f32 v234, v7, v151
    v_fmac_f32 v236, v15, v119
    v_mul_f32 v238, v16, v160
    v_mul_f32 v240, v24, v160
    v_fmac_f32 v238, v17, v161
    v_fmac_f32 v240, v25, v161
    v_fmac_f32 v238, v18, v162
    v_fmac_f32 v240, v26, v162
    v_fmac_f32 v238, v19, v163
    v_fmac_f32 v240, v27, v163
    v_fmac_f32 v238, v20, v164
    v_fmac_f32 v240, v28, v164
    v_fmac_f32 v238, v21, v165
    v_fmac_f32 v240, v29, v165
    v_fmac_f32 v238, v22, v166
    v_fmac_f32 v240, v30, v166
    v_fmac_f32 v238, v23, v167
    v_fmac_f32 v240, v31, v167
    v_mul_f32 v235, v32, v152
    v_mul_f32 v237, v40, v120
    v_fmac_f32 v235, v33, v153
    v_fmac_f32 v237, v41, v121
    v_fmac_f32 v235, v34, v154
    v_fmac_f32 v237, v42, v122
    v_fmac_f32 v235, v35, v155
    v_fmac_f32 v237, v43, v123
    v_fmac_f32 v235, v36, v156
    v_fmac_f32 v237, v44, v124
    v_fmac_f32 v235, v37, v157
    v_fmac_f32 v237, v45, v125
    v_fmac_f32 v235, v38, v158
    v_fmac_f32 v237, v46, v126
    v_fmac_f32 v235, v39, v159
    v_fmac_f32 v237, v47, v127
    v_mul_f32 v239, v48, v168
    v_mul_f32 v241, v56, v168
    v_fmac_f32 v239, v49, v169
    v_fmac_f32 v241, v57, v169
    v_fmac_f32 v239, v50, v170
    v_fmac_f32 v241, v58, v170
    v_fmac_f32 v239, v51, v171
    s_setprio 1
    s_waitcnt vmcnt(4) lgkmcnt(5)
    v_mfma_f32_32x32x16_bf16 v[0:15], v[64:67], v[176:179], 0
    ds_read_b64_tr_b16 v[184:185], v246 offset:2048
    ds_read_b64_tr_b16 v[186:187], v246 offset:2560
    ds_read_b64_tr_b16 v[188:189], v247 offset:2048
    ds_read_b64_tr_b16 v[190:191], v247 offset:2560
    v_fmac_f32 v241, v59, v171
    v_fmac_f32 v239, v52, v172
    s_mov_b32 m0, s68
    v_mfma_f32_32x32x16_bf16 v[16:31], v[68:71], v[176:179], 0
    buffer_load_dwordx4 v222, s[4:7], s44 offen lds
    buffer_load_dwordx4 v223, s[72:75], s44 offen offset:1024 lds
    s_waitcnt lgkmcnt(4)
    v_mad_u32_u16 v225, v224, s39, v248 op_sel:[1,0,0,0]
    v_mad_u32_u16 v224, v224, s39, v248
    v_fmac_f32 v241, v60, v172
    v_fmac_f32 v239, v53, v173
    v_mfma_f32_32x32x16_bf16 v[32:47], v[64:67], v[180:183], 0
    v_add_u32 v226, s50, v251
    ds_read_b32 v226, v226
    v_fmac_f32 v241, v61, v173
    v_fmac_f32 v239, v54, v174
    v_fmac_f32 v241, v62, v174
    v_fmac_f32 v239, v55, v175
    v_fmac_f32 v241, v63, v175
    v_mfma_f32_32x32x16_bf16 v[48:63], v[68:71], v[180:183], 0
    v_permlane32_swap_b32 v234, v235
    v_add_f32 v234, v234, v235
    s_waitcnt vmcnt(4) lgkmcnt(1)
    v_mfma_f32_32x32x16_bf16 v[0:15], v[72:75], v[184:187], v[0:15]
    ds_read_b64_tr_b16 v[176:177], v246 offset:4096
    ds_read_b64_tr_b16 v[178:179], v246 offset:4608
    ds_read_b64_tr_b16 v[180:181], v247 offset:4096
    ds_read_b64_tr_b16 v[182:183], v247 offset:4608
    s_mov_b32 m0, s69
    v_mfma_f32_32x32x16_bf16 v[16:31], v[76:79], v[184:187], v[16:31]
    buffer_load_dwordx4 v224, s[4:7], s45 offen lds
    buffer_load_dwordx4 v225, s[72:75], s45 offen offset:1024 lds
    s_waitcnt lgkmcnt(4)
    v_mad_u32_u16 v227, v226, s39, v248 op_sel:[1,0,0,0]
    v_mad_u32_u16 v226, v226, s39, v248
    v_mfma_f32_32x32x16_bf16 v[32:47], v[72:75], v[188:191], v[32:47]
    v_add_u32 v228, s51, v251
    ds_read_b32 v228, v228
    v_mul_f32 v242, v0, v144
    v_fma_f32 v238, v8, v160, -v238
    v_fmac_f32 v242, v1, v145
    v_fmac_f32 v238, v9, v161
    v_fmac_f32 v242, v2, v146
    v_mfma_f32_32x32x16_bf16 v[48:63], v[76:79], v[188:191], v[48:63]
    s_setprio 0
    v_fmac_f32 v238, v10, v162
    v_fmac_f32 v242, v3, v147
    v_fmac_f32 v238, v11, v163
    v_fmac_f32 v242, v4, v148
    v_fmac_f32 v238, v12, v164
    v_fmac_f32 v242, v5, v149
    v_fmac_f32 v238, v13, v165
    v_fmac_f32 v242, v6, v150
    v_fmac_f32 v238, v14, v166
    v_fmac_f32 v242, v7, v151
    v_fmac_f32 v238, v15, v167
    v_fmac_f32 v236, v16, v112
    v_mul_f32 v244, v24, v160
    v_fmac_f32 v236, v17, v113
    v_fmac_f32 v244, v25, v161
    v_fmac_f32 v236, v18, v114
    v_fmac_f32 v244, v26, v162
    v_fmac_f32 v236, v19, v115
    v_fmac_f32 v244, v27, v163
    v_fmac_f32 v236, v20, v116
    v_fmac_f32 v244, v28, v164
    v_fmac_f32 v236, v21, v117
    v_fmac_f32 v244, v29, v165
    v_fmac_f32 v236, v22, v118
    v_fmac_f32 v244, v30, v166
    v_fmac_f32 v236, v23, v119
    v_fmac_f32 v244, v31, v167
    v_mul_f32 v243, v32, v152
    v_fma_f32 v239, v40, v168, -v239
    v_fmac_f32 v243, v33, v153
    v_fmac_f32 v239, v41, v169
    v_fmac_f32 v243, v34, v154
    v_fmac_f32 v239, v42, v170
    v_fmac_f32 v243, v35, v155
    v_fmac_f32 v239, v43, v171
    v_fmac_f32 v243, v36, v156
    v_fmac_f32 v239, v44, v172
    v_fmac_f32 v243, v37, v157
    v_fmac_f32 v239, v45, v173
    v_fmac_f32 v243, v38, v158
    v_fmac_f32 v239, v46, v174
    v_fmac_f32 v243, v39, v159
    v_fmac_f32 v239, v47, v175
    v_fmac_f32 v237, v48, v120
    v_mul_f32 v245, v56, v168
    v_fmac_f32 v237, v49, v121
    v_fmac_f32 v245, v57, v169
    v_fmac_f32 v237, v50, v122
    s_setprio 1
    s_waitcnt vmcnt(4) lgkmcnt(1)
    v_mfma_f32_32x32x16_bf16 v[0:15], v[64:67], v[176:179], 0
    ds_read_b64_tr_b16 v[184:185], v246 offset:6144
    ds_read_b64_tr_b16 v[186:187], v246 offset:6656
    ds_read_b64_tr_b16 v[188:189], v247 offset:6144
    ds_read_b64_tr_b16 v[190:191], v247 offset:6656
    v_fmac_f32 v245, v58, v170
    v_fmac_f32 v237, v51, v123
    s_mov_b32 m0, s70
    v_mfma_f32_32x32x16_bf16 v[16:31], v[68:71], v[176:179], 0
    buffer_load_dwordx4 v226, s[4:7], s46 offen lds
    buffer_load_dwordx4 v227, s[72:75], s46 offen offset:1024 lds
    s_waitcnt lgkmcnt(4)
    v_mad_u32_u16 v229, v228, s39, v248 op_sel:[1,0,0,0]
    v_mad_u32_u16 v228, v228, s39, v248
    v_fmac_f32 v245, v59, v171
    v_fmac_f32 v237, v52, v124
    v_mfma_f32_32x32x16_bf16 v[32:47], v[64:67], v[180:183], 0
    v_fmac_f32 v245, v60, v172
    v_fmac_f32 v237, v53, v125
    v_fmac_f32 v245, v61, v173
    v_fmac_f32 v237, v54, v126
    v_fmac_f32 v245, v62, v174
    v_fmac_f32 v237, v55, v127
    v_fmac_f32 v245, v63, v175
    v_mfma_f32_32x32x16_bf16 v[48:63], v[68:71], v[180:183], 0
    v_permlane32_swap_b32 v238, v239
    v_permlane32_swap_b32 v242, v243
    v_add_f32 v238, v238, v239
    v_add_f32 v242, v242, v243
    s_waitcnt vmcnt(4) lgkmcnt(0)
    v_mfma_f32_32x32x16_bf16 v[0:15], v[72:75], v[184:187], v[0:15]
    ds_read_b64_tr_b16 v[176:177], v246 offset:0
    ds_read_b64_tr_b16 v[178:179], v246 offset:512
    ds_read_b64_tr_b16 v[180:181], v247 offset:0
    ds_read_b64_tr_b16 v[182:183], v247 offset:512
    v_cvt_pk_bf16_f32 v234, v234, v242
    ds_write_b16 v230, v234 offset:384
    s_mov_b32 m0, s71
    v_mfma_f32_32x32x16_bf16 v[16:31], v[76:79], v[184:187], v[16:31]
    buffer_load_dwordx4 v228, s[4:7], s47 offen lds
    buffer_load_dwordx4 v229, s[72:75], s47 offen offset:1024 lds
    ds_write_b16_d16_hi v230, v234 offset:768
    v_mfma_f32_32x32x16_bf16 v[32:47], v[72:75], v[188:191], v[32:47]
    v_mul_f32 v242, v0, v144
    v_fma_f32 v240, v8, v160, -v240
    v_fmac_f32 v242, v1, v145
    v_fmac_f32 v240, v9, v161
    v_fmac_f32 v242, v2, v146
    v_fmac_f32 v240, v10, v162
    v_fmac_f32 v242, v3, v147
    v_mfma_f32_32x32x16_bf16 v[48:63], v[76:79], v[188:191], v[48:63]
    s_setprio 0
    v_fmac_f32 v240, v11, v163
    v_fmac_f32 v242, v4, v148
    v_fmac_f32 v240, v12, v164
    v_fmac_f32 v242, v5, v149
    v_fmac_f32 v240, v13, v165
    v_fmac_f32 v242, v6, v150
    v_fmac_f32 v240, v14, v166
    v_fmac_f32 v242, v7, v151
    v_fmac_f32 v240, v15, v167
    s_sub_u32 s58, s48, s29
    v_add_u32 v249, s58, v249
    v_add_u32 v250, s58, v250
    v_fma_f32 v244, v16, v160, -v244
    v_fmac_f32 v236, v24, v112
    v_fmac_f32 v244, v17, v161
    v_fmac_f32 v236, v25, v113
    v_fmac_f32 v244, v18, v162
    v_fmac_f32 v236, v26, v114
    v_fmac_f32 v244, v19, v163
    v_fmac_f32 v236, v27, v115
    v_fmac_f32 v244, v20, v164
    v_fmac_f32 v236, v28, v116
    v_fmac_f32 v244, v21, v165
    v_fmac_f32 v236, v29, v117
    v_fmac_f32 v244, v22, v166
    v_fmac_f32 v236, v30, v118
    v_fmac_f32 v244, v23, v167
    v_fmac_f32 v236, v31, v119
    ds_read_b64_tr_b16 v[0:1], v249 offset:0
    ds_read_b64_tr_b16 v[2:3], v249 offset:128
    ds_read_b128 v[4:7], v250 offset:0
    ds_read_b128 v[8:11], v250 offset:16
    ds_read_b128 v[12:15], v250 offset:384
    ds_read_b128 v[16:19], v250 offset:400
    v_mul_f32 v243, v32, v152
    v_fma_f32 v241, v40, v168, -v241
    v_fmac_f32 v243, v33, v153
    v_fmac_f32 v241, v41, v169
    v_fmac_f32 v243, v34, v154
    v_fmac_f32 v241, v42, v170
    v_fmac_f32 v243, v35, v155
    v_fmac_f32 v241, v43, v171
    v_fmac_f32 v243, v36, v156
    v_fmac_f32 v241, v44, v172
    v_fmac_f32 v243, v37, v157
    v_fmac_f32 v241, v45, v173
    v_fmac_f32 v243, v38, v158
    v_fmac_f32 v241, v46, v174
    v_fmac_f32 v243, v39, v159
    v_fmac_f32 v241, v47, v175
    ds_read_b64_tr_b16 v[20:21], v249 offset:512
    ds_read_b64_tr_b16 v[22:23], v249 offset:640
    ds_read_b128 v[24:27], v250 offset:64
    ds_read_b128 v[28:31], v250 offset:80
    ds_read_b128 v[32:35], v250 offset:448
    ds_read_b128 v[36:39], v250 offset:464
    v_fma_f32 v245, v48, v168, -v245
    v_fmac_f32 v237, v56, v120
    v_fmac_f32 v245, v49, v169
    v_fmac_f32 v237, v57, v121
    v_fmac_f32 v245, v50, v170
    v_fmac_f32 v237, v58, v122
    v_fmac_f32 v245, v51, v171
    v_fmac_f32 v237, v59, v123
    v_fmac_f32 v245, v52, v172
    v_fmac_f32 v237, v60, v124
    v_fmac_f32 v245, v53, v173
    v_fmac_f32 v237, v61, v125
    v_fmac_f32 v245, v54, v174
    v_fmac_f32 v237, v62, v126
    v_fmac_f32 v245, v55, v175
    v_fmac_f32 v237, v63, v127
    s_cmp_eq_u32 s36, 0
    s_cbranch_scc1 K2_TAIL
    s_mov_b32 s29, s48
    s_mov_b32 s32, s31
    s_mov_b32 s30, s3
    s_mov_b32 s31, s35
    s_cmp_eq_u32 s33, 2
    s_cbranch_scc1 K2_U21
    s_cmp_eq_u32 s33, 3
    s_cbranch_scc1 K2_U31
    s_cmp_eq_u32 s33, 1
    s_cbranch_scc1 K2_U11
    s_branch K2_U41
K2_U31:
    s_setprio 1
    s_waitcnt lgkmcnt(10)
    v_lshlrev_b32 v40, 16, v0
    v_and_b32 v41, 0xffff0000, v0
    v_lshlrev_b32 v42, 16, v1
    v_and_b32 v43, 0xffff0000, v1
    v_lshlrev_b32 v44, 16, v2
    v_and_b32 v45, 0xffff0000, v2
    v_lshlrev_b32 v46, 16, v3
    v_and_b32 v47, 0xffff0000, v3
    s_waitcnt lgkmcnt(8)
    v_mul_f32 v4, v40, v4
    v_mul_f32 v5, v41, v5
    v_mul_f32 v6, v42, v6
    v_mul_f32 v7, v43, v7
    v_mul_f32 v8, v44, v8
    v_mul_f32 v9, v45, v9
    v_mul_f32 v10, v46, v10
    v_mul_f32 v11, v47, v11
    v_cvt_pk_bf16_f32 v64, v4, v5
    v_cvt_pk_bf16_f32 v65, v6, v7
    v_cvt_pk_bf16_f32 v66, v8, v9
    v_cvt_pk_bf16_f32 v67, v10, v11
    s_waitcnt lgkmcnt(6)
    v_mul_f32 v12, v40, v12
    v_mul_f32 v13, v41, v13
    v_mul_f32 v14, v42, v14
    v_mul_f32 v15, v43, v15
    v_mul_f32 v16, v44, v16
    v_mul_f32 v17, v45, v17
    v_mul_f32 v18, v46, v18
    v_mul_f32 v19, v47, v19
    v_cvt_pk_bf16_f32 v68, v12, v13
    v_cvt_pk_bf16_f32 v69, v14, v15
    v_cvt_pk_bf16_f32 v70, v16, v17
    v_cvt_pk_bf16_f32 v71, v18, v19
    ds_read_b64_tr_b16 v[0:1], v249 offset:1024
    ds_read_b64_tr_b16 v[2:3], v249 offset:1152
    ds_read_b128 v[4:7], v250 offset:128
    ds_read_b128 v[8:11], v250 offset:144
    ds_read_b128 v[12:15], v250 offset:512
    ds_read_b128 v[16:19], v250 offset:528
    s_waitcnt lgkmcnt(10)
    v_lshlrev_b32 v48, 16, v20
    v_and_b32 v49, 0xffff0000, v20
    v_lshlrev_b32 v50, 16, v21
    v_and_b32 v51, 0xffff0000, v21
    v_lshlrev_b32 v52, 16, v22
    v_and_b32 v53, 0xffff0000, v22
    v_lshlrev_b32 v54, 16, v23
    v_and_b32 v55, 0xffff0000, v23
    s_waitcnt lgkmcnt(8)
    v_mul_f32 v24, v48, v24
    v_mul_f32 v25, v49, v25
    v_mul_f32 v26, v50, v26
    v_mul_f32 v27, v51, v27
    v_mul_f32 v28, v52, v28
    v_mul_f32 v29, v53, v29
    v_mul_f32 v30, v54, v30
    v_mul_f32 v31, v55, v31
    v_cvt_pk_bf16_f32 v72, v24, v25
    v_cvt_pk_bf16_f32 v73, v26, v27
    v_cvt_pk_bf16_f32 v74, v28, v29
    v_cvt_pk_bf16_f32 v75, v30, v31
    s_waitcnt lgkmcnt(6)
    v_mul_f32 v32, v48, v32
    v_mul_f32 v33, v49, v33
    v_mul_f32 v34, v50, v34
    v_mul_f32 v35, v51, v35
    v_mul_f32 v36, v52, v36
    v_mul_f32 v37, v53, v37
    v_mul_f32 v38, v54, v38
    v_mul_f32 v39, v55, v39
    v_cvt_pk_bf16_f32 v76, v32, v33
    v_cvt_pk_bf16_f32 v77, v34, v35
    v_cvt_pk_bf16_f32 v78, v36, v37
    v_cvt_pk_bf16_f32 v79, v38, v39
    s_waitcnt lgkmcnt(4)
    v_lshlrev_b32 v40, 16, v0
    v_and_b32 v41, 0xffff0000, v0
    v_lshlrev_b32 v42, 16, v1
    v_and_b32 v43, 0xffff0000, v1
    v_lshlrev_b32 v44, 16, v2
    v_and_b32 v45, 0xffff0000, v2
    v_lshlrev_b32 v46, 16, v3
    v_and_b32 v47, 0xffff0000, v3
    s_waitcnt lgkmcnt(2)
    v_mul_f32 v4, v40, v4
    v_mul_f32 v5, v41, v5
    v_mul_f32 v6, v42, v6
    v_mul_f32 v7, v43, v7
    v_mul_f32 v8, v44, v8
    v_mul_f32 v9, v45, v9
    v_mul_f32 v10, v46, v10
    v_mul_f32 v11, v47, v11
    v_cvt_pk_bf16_f32 v80, v4, v5
    v_cvt_pk_bf16_f32 v81, v6, v7
    v_cvt_pk_bf16_f32 v82, v8, v9
    v_cvt_pk_bf16_f32 v83, v10, v11
    s_waitcnt lgkmcnt(0)
    v_mul_f32 v12, v40, v12
    v_mul_f32 v13, v41, v13
    v_mul_f32 v14, v42, v14
    v_mul_f32 v15, v43, v15
    v_mul_f32 v16, v44, v16
    v_mul_f32 v17, v45, v17
    v_mul_f32 v18, v46, v18
    v_mul_f32 v19, v47, v19
    v_cvt_pk_bf16_f32 v84, v12, v13
    v_cvt_pk_bf16_f32 v85, v14, v15
    v_cvt_pk_bf16_f32 v86, v16, v17
    v_cvt_pk_bf16_f32 v87, v18, v19
    s_waitcnt vmcnt(4)
    v_mfma_f32_32x32x16_bf16 v[0:15], v[64:67], v[176:179], 0
    ds_read_b64_tr_b16 v[184:185], v246 offset:2048
    ds_read_b64_tr_b16 v[186:187], v246 offset:2560
    ds_read_b64_tr_b16 v[188:189], v247 offset:2048
    ds_read_b64_tr_b16 v[190:191], v247 offset:2560
    s_mov_b32 m0, s68
    v_mfma_f32_32x32x16_bf16 v[16:31], v[68:71], v[176:179], 0
    buffer_load_dwordx4 v224, s[4:7], s41 offen lds
    buffer_load_dwordx4 v225, s[72:75], s41 offen offset:1024 lds
    v_permlane32_swap_b32 v242, v243
    v_permlane32_swap_b32 v240, v241
    v_mov_b32 v254, 163648
    v_mfma_f32_32x32x16_bf16 v[32:47], v[64:67], v[180:183], 0
    v_permlane32_swap_b32 v236, v237
    v_permlane32_swap_b32 v244, v245
    v_add_f32 v242, v242, v243
    v_add_f32 v240, -v240, -v241
    v_add_f32 v236, v236, v237
    v_mfma_f32_32x32x16_bf16 v[48:63], v[68:71], v[180:183], 0
    v_add_f32 v244, v244, v245
    v_cvt_pk_bf16_f32 v242, v242, v236
    v_cvt_pk_bf16_f32 v244, v244, v240
    v_cvt_pk_bf16_f32 v238, v238, v238
    ds_write_b16 v230, v242 offset:1152
    ds_write_b16_d16_hi v230, v242 offset:128
    v_mov_b32 v255, 1
    v_lshl_add_u32 v233, v252, 1, s53
    s_mov_b64 exec, 1
    ds_add_rtn_u32 v232, v254, v255
    s_mov_b64 exec, -1
    ds_read_b32 v233, v233
    s_waitcnt vmcnt(4) lgkmcnt(4)
    v_mfma_f32_32x32x16_bf16 v[0:15], v[72:75], v[184:187], v[0:15]
    ds_read_b64_tr_b16 v[176:177], v246 offset:4096
    ds_read_b64_tr_b16 v[178:179], v246 offset:4608
    ds_read_b64_tr_b16 v[180:181], v247 offset:4096
    ds_read_b64_tr_b16 v[182:183], v247 offset:4608
    ds_write_b16 v230, v244 offset:512
    ds_write_b16_d16_hi v230, v244 offset:896
    s_mov_b32 m0, s69
    v_mfma_f32_32x32x16_bf16 v[16:31], v[76:79], v[184:187], v[16:31]
    buffer_load_dwordx4 v226, s[4:7], s41 offen lds
    buffer_load_dwordx4 v227, s[72:75], s41 offen offset:1024 lds
    ds_write_b16 v230, v238 offset:1280
    s_waitcnt lgkmcnt(7)
    v_readfirstlane_b32 s58, v232
    v_mfma_f32_32x32x16_bf16 v[32:47], v[72:75], v[188:191], v[32:47]
    s_cmp_lt_u32 s58, s22
    s_cbranch_scc0 K2_nul_61
    s_and_b32 s59, s58, 7
    s_lshr_b32 s60, s58, 3
K2_chk_63:
    v_readlane_b32 s61, v233, s59
    s_nop 0
    s_cmp_gt_u32 s61, s60
    s_cbranch_scc0 K2_spin_62
K2_back_64:
    v_mfma_f32_32x32x16_bf16 v[48:63], v[76:79], v[188:191], v[48:63]
    v_readlane_b32 s3, v253, s58
    s_lshl_b32 s44, s34, 7
    s_lshl_b32 s60, s58, 5
    s_and_b32 s48, s3, 0x3ffff
    s_bfe_u32 s33, s3, 0x30012
    s_sub_u32 s60, s60, s48
    s_waitcnt vmcnt(4) lgkmcnt(3)
    v_mfma_f32_32x32x16_bf16 v[0:15], v[80:83], v[176:179], v[0:15]
    ds_read_b64_tr_b16 v[184:185], v246 offset:6144
    ds_read_b64_tr_b16 v[186:187], v246 offset:6656
    ds_read_b64_tr_b16 v[188:189], v247 offset:6144
    ds_read_b64_tr_b16 v[190:191], v247 offset:6656
    s_and_b32 s60, s60, 0xff
    s_add_u32 s35, s60, s48
    s_mov_b32 m0, s70
    v_mfma_f32_32x32x16_bf16 v[16:31], v[84:87], v[176:179], v[16:31]
    buffer_load_dwordx4 v222, s[4:7], s42 offen lds
    buffer_load_dwordx4 v223, s[72:75], s42 offen offset:1024 lds
    s_mov_b32 s45, s44
    s_add_u32 s47, s44, 256
    s_add_u32 s49, s48, 32
    s_add_u32 s60, s48, 64
    v_mfma_f32_32x32x16_bf16 v[32:47], v[80:83], v[180:183], v[32:47]
    s_cmp_eq_u32 s33, 3
    s_cselect_b32 s46, s44, s47
    s_cselect_b32 s50, s60, s48
    s_cselect_b32 s51, s48, s49
    s_sub_u32 s60, s33, 2
    s_cmp_lt_u32 s60, 2
    s_cbranch_scc0 K2_rare_65
K2_back_66:
    v_mfma_f32_32x32x16_bf16 v[48:63], v[84:87], v[180:183], v[48:63]
    s_setprio 0
    v_mul_f32 v234, v0, v96
    v_mul_f32 v236, v8, v128
    v_fmac_f32 v234, v1, v97
    v_fmac_f32 v236, v9, v129
    v_fmac_f32 v234, v2, v98
    v_fmac_f32 v236, v10, v130
    v_fmac_f32 v234, v3, v99
    v_fmac_f32 v236, v11, v131
    v_fmac_f32 v234, v4, v100
    v_fmac_f32 v236, v12, v132
    v_fmac_f32 v234, v5, v101
    v_fmac_f32 v236, v13, v133
    v_fmac_f32 v234, v6, v102
    v_fmac_f32 v236, v14, v134
    v_fmac_f32 v234, v7, v103
    v_fmac_f32 v236, v15, v135
    v_mul_f32 v238, v16, v128
    v_mul_f32 v240, v24, v128
    v_fmac_f32 v238, v17, v129
    v_fmac_f32 v240, v25, v129
    v_fmac_f32 v238, v18, v130
    v_fmac_f32 v240, v26, v130
    v_fmac_f32 v238, v19, v131
    v_fmac_f32 v240, v27, v131
    v_fmac_f32 v238, v20, v132
    v_fmac_f32 v240, v28, v132
    v_fmac_f32 v238, v21, v133
    v_fmac_f32 v240, v29, v133
    v_fmac_f32 v238, v22, v134
    v_fmac_f32 v240, v30, v134
    v_fmac_f32 v238, v23, v135
    v_fmac_f32 v240, v31, v135
    v_mul_f32 v235, v32, v104
    v_mul_f32 v237, v40, v136
    v_fmac_f32 v235, v33, v105
    v_fmac_f32 v237, v41, v137
    v_fmac_f32 v235, v34, v106
    v_fmac_f32 v237, v42, v138
    v_fmac_f32 v235, v35, v107
    v_fmac_f32 v237, v43, v139
    v_fmac_f32 v235, v36, v108
    v_fmac_f32 v237, v44, v140
    v_fmac_f32 v235, v37, v109
    v_fmac_f32 v237, v45, v141
    v_fmac_f32 v235, v38, v110
    v_fmac_f32 v237, v46, v142
    v_fmac_f32 v235, v39, v111
    v_fmac_f32 v237, v47, v143
    v_mul_f32 v239, v48, v136
    v_mul_f32 v241, v56, v136
    s_setprio 1
    s_waitcnt vmcnt(4) lgkmcnt(0)
    v_mfma_f32_32x32x16_bf16 v[0:15], v[64:67], v[184:187], 0
    ds_read_b64_tr_b16 v[176:177], v246 offset:0
    ds_read_b64_tr_b16 v[178:179], v246 offset:512
    ds_read_b64_tr_b16 v[180:181], v247 offset:0
    ds_read_b64_tr_b16 v[182:183], v247 offset:512
    v_fmac_f32 v239, v49, v137
    v_fmac_f32 v241, v57, v137
    s_mov_b32 m0, s71
    v_mfma_f32_32x32x16_bf16 v[16:31], v[68:71], v[184:187], 0
    buffer_load_dwordx4 v224, s[4:7], s42 offen lds
    buffer_load_dwordx4 v225, s[72:75], s42 offen offset:1024 lds
    v_fmac_f32 v239, v50, v138
    v_fmac_f32 v241, v58, v138
    v_fmac_f32 v239, v51, v139
    v_fmac_f32 v241, v59, v139
    v_fmac_f32 v239, v52, v140
    v_mfma_f32_32x32x16_bf16 v[32:47], v[64:67], v[188:191], 0
    v_fmac_f32 v241, v60, v140
    v_fmac_f32 v239, v53, v141
    v_fmac_f32 v241, v61, v141
    v_fmac_f32 v239, v54, v142
    v_fmac_f32 v241, v62, v142
    v_fmac_f32 v239, v55, v143
    v_fmac_f32 v241, v63, v143
    v_mfma_f32_32x32x16_bf16 v[48:63], v[68:71], v[188:191], 0
    v_permlane32_swap_b32 v234, v235
    v_permlane32_swap_b32 v236, v237
    v_permlane32_swap_b32 v238, v239
    s_waitcnt vmcnt(4) lgkmcnt(0)
    v_mfma_f32_32x32x16_bf16 v[0:15], v[72:75], v[176:179], v[0:15]
    ds_read_b64_tr_b16 v[184:185], v246 offset:2048
    ds_read_b64_tr_b16 v[186:187], v246 offset:2560
    ds_read_b64_tr_b16 v[188:189], v247 offset:2048
    ds_read_b64_tr_b16 v[190:191], v247 offset:2560
    v_permlane32_swap_b32 v240, v241
    s_mov_b32 m0, s68
    v_mfma_f32_32x32x16_bf16 v[16:31], v[76:79], v[176:179], v[16:31]
    buffer_load_dwordx4 v226, s[4:7], s42 offen lds
    buffer_load_dwordx4 v227, s[72:75], s42 offen offset:1024 lds
    v_add_u32 v230, s31, v252
    v_add_f32 v234, v234, v235
    v_add_f32 v236, v236, v237
    v_add_f32 v238, v238, v239
    v_add_f32 v240, v240, v241
    v_mfma_f32_32x32x16_bf16 v[32:47], v[72:75], v[180:183], v[32:47]
    v_cvt_pk_bf16_f32 v234, v234, v236
    v_cvt_pk_bf16_f32 v238, v238, v240
    ds_write_b16 v230, v234 offset:0
    ds_write_b16_d16_hi v230, v234 offset:256
    ds_write_b16 v230, v238 offset:640
    ds_write_b16_d16_hi v230, v238 offset:1024
    v_mfma_f32_32x32x16_bf16 v[48:63], v[76:79], v[180:183], v[48:63]
    s_waitcnt vmcnt(4) lgkmcnt(4)
    v_mfma_f32_32x32x16_bf16 v[0:15], v[80:83], v[184:187], v[0:15]
    ds_read_b64_tr_b16 v[176:177], v246 offset:4096
    ds_read_b64_tr_b16 v[178:179], v246 offset:4608
    ds_read_b64_tr_b16 v[180:181], v247 offset:4096
    ds_read_b64_tr_b16 v[182:183], v247 offset:4608
    s_mov_b32 m0, s69
    v_mfma_f32_32x32x16_bf16 v[16:31], v[84:87], v[184:187], v[16:31]
    buffer_load_dwordx4 v222, s[4:7], s43 offen lds
    buffer_load_dwordx4 v223, s[72:75], s43 offen offset:1024 lds
    v_mfma_f32_32x32x16_bf16 v[32:47], v[80:83], v[188:191], v[32:47]
    s_nop 2
    v_mul_f32 v234, v0, v144
    v_mul_f32 v236, v8, v112
    v_fmac_f32 v234, v1, v145
    v_fmac_f32 v236, v9, v113
    v_fmac_f32 v234, v2, v146
    v_fmac_f32 v236, v10, v114
    v_fmac_f32 v234, v3, v147
    v_mfma_f32_32x32x16_bf16 v[48:63], v[84:87], v[188:191], v[48:63]
    s_setprio 0
    v_fmac_f32 v236, v11, v115
    v_fmac_f32 v234, v4, v148
    v_fmac_f32 v236, v12, v116
    v_fmac_f32 v234, v5, v149
    v_fmac_f32 v236, v13, v117
    v_fmac_f32 v234, v6, v150
    v_fmac_f32 v236, v14, v118
    v_fmac_f32 v234, v7, v151
    v_fmac_f32 v236, v15, v119
    v_mul_f32 v238, v16, v160
    v_mul_f32 v240, v24, v160
    v_fmac_f32 v238, v17, v161
    v_fmac_f32 v240, v25, v161
    v_fmac_f32 v238, v18, v162
    v_fmac_f32 v240, v26, v162
    v_fmac_f32 v238, v19, v163
    v_fmac_f32 v240, v27, v163
    v_fmac_f32 v238, v20, v164
    v_fmac_f32 v240, v28, v164
    v_fmac_f32 v238, v21, v165
    v_fmac_f32 v240, v29, v165
    v_fmac_f32 v238, v22, v166
    v_fmac_f32 v240, v30, v166
    v_fmac_f32 v238, v23, v167
    v_fmac_f32 v240, v31, v167
    v_mul_f32 v235, v32, v152
    v_mul_f32 v237, v40, v120
    v_fmac_f32 v235, v33, v153
    v_fmac_f32 v237, v41, v121
    v_fmac_f32 v235, v34, v154
    v_fmac_f32 v237, v42, v122
    v_fmac_f32 v235, v35, v155
    v_fmac_f32 v237, v43, v123
    v_fmac_f32 v235, v36, v156
    v_fmac_f32 v237, v44, v124
    v_fmac_f32 v235, v37, v157
    v_fmac_f32 v237, v45, v125
    v_fmac_f32 v235, v38, v158
    v_fmac_f32 v237, v46, v126
    v_fmac_f32 v235, v39, v159
    v_fmac_f32 v237, v47, v127
    v_mul_f32 v239, v48, v168
    v_mul_f32 v241, v56, v168
    v_fmac_f32 v239, v49, v169
    v_fmac_f32 v241, v57, v169
    s_setprio 1
    s_waitcnt vmcnt(4) lgkmcnt(0)
    v_mfma_f32_32x32x16_bf16 v[0:15], v[64:67], v[176:179], 0
    ds_read_b64_tr_b16 v[184:185], v246 offset:6144
    ds_read_b64_tr_b16 v[186:187], v246 offset:6656
    ds_read_b64_tr_b16 v[188:189], v247 offset:6144
    ds_read_b64_tr_b16 v[190:191], v247 offset:6656
    v_fmac_f32 v239, v50, v170
    v_fmac_f32 v241, v58, v170
    s_mov_b32 m0, s70
    v_mfma_f32_32x32x16_bf16 v[16:31], v[68:71], v[176:179], 0
    buffer_load_dwordx4 v224, s[4:7], s43 offen lds
    buffer_load_dwordx4 v225, s[72:75], s43 offen offset:1024 lds
    v_fmac_f32 v239, v51, v171
    v_fmac_f32 v241, v59, v171
    v_fmac_f32 v239, v52, v172
    v_fmac_f32 v241, v60, v172
    v_fmac_f32 v239, v53, v173
    v_mfma_f32_32x32x16_bf16 v[32:47], v[64:67], v[180:183], 0
    v_add_u32 v222, s48, v251
    ds_read_b32 v222, v222
    v_fmac_f32 v241, v61, v173
    v_fmac_f32 v239, v54, v174
    v_fmac_f32 v241, v62, v174
    v_fmac_f32 v239, v55, v175
    v_fmac_f32 v241, v63, v175
    v_mfma_f32_32x32x16_bf16 v[48:63], v[68:71], v[180:183], 0
    v_permlane32_swap_b32 v234, v235
    v_add_f32 v234, v234, v235
    s_waitcnt vmcnt(4) lgkmcnt(1)
    v_mfma_f32_32x32x16_bf16 v[0:15], v[72:75], v[184:187], v[0:15]
    ds_read_b64_tr_b16 v[176:177], v246 offset:0
    ds_read_b64_tr_b16 v[178:179], v246 offset:512
    ds_read_b64_tr_b16 v[180:181], v247 offset:0
    ds_read_b64_tr_b16 v[182:183], v247 offset:512
    s_mov_b32 m0, s71
    v_mfma_f32_32x32x16_bf16 v[16:31], v[76:79], v[184:187], v[16:31]
    buffer_load_dwordx4 v226, s[4:7], s43 offen lds
    buffer_load_dwordx4 v227, s[72:75], s43 offen offset:1024 lds
    s_waitcnt lgkmcnt(4)
    v_mad_u32_u16 v223, v222, s39, v248 op_sel:[1,0,0,0]
    v_mad_u32_u16 v222, v222, s39, v248
    v_mfma_f32_32x32x16_bf16 v[32:47], v[72:75], v[188:191], v[32:47]
    v_add_u32 v224, s49, v251
    ds_read_b32 v224, v224
    v_mfma_f32_32x32x16_bf16 v[48:63], v[76:79], v[188:191], v[48:63]
    s_waitcnt vmcnt(4) lgkmcnt(1)
    v_mfma_f32_32x32x16_bf16 v[0:15], v[80:83], v[176:179], v[0:15]
    ds_read_b64_tr_b16 v[184:185], v246 offset:2048
    ds_read_b64_tr_b16 v[186:187], v246 offset:2560
    ds_read_b64_tr_b16 v[188:189], v247 offset:2048
    ds_read_b64_tr_b16 v[190:191], v247 offset:2560
    s_mov_b32 m0, s68
    v_mfma_f32_32x32x16_bf16 v[16:31], v[84:87], v[176:179], v[16:31]
    buffer_load_dwordx4 v222, s[4:7], s44 offen lds
    buffer_load_dwordx4 v223, s[72:75], s44 offen offset:1024 lds
    s_waitcnt lgkmcnt(4)
    v_mad_u32_u16 v225, v224, s39, v248 op_sel:[1,0,0,0]
    v_mad_u32_u16 v224, v224, s39, v248
    v_mfma_f32_32x32x16_bf16 v[32:47], v[80:83], v[180:183], v[32:47]
    v_add_u32 v226, s50, v251
    ds_read_b32 v226, v226
    v_mul_f32 v242, v0, v144
    v_fma_f32 v238, v8, v160, -v238
    v_fmac_f32 v242, v1, v145
    v_fmac_f32 v238, v9, v161
    v_fmac_f32 v242, v2, v146
    v_mfma_f32_32x32x16_bf16 v[48:63], v[84:87], v[180:183], v[48:63]
    s_setprio 0
    v_fmac_f32 v238, v10, v162
    v_fmac_f32 v242, v3, v147
    v_fmac_f32 v238, v11, v163
    v_fmac_f32 v242, v4, v148
    v_fmac_f32 v238, v12, v164
    v_fmac_f32 v242, v5, v149
    v_fmac_f32 v238, v13, v165
    v_fmac_f32 v242, v6, v150
    v_fmac_f32 v238, v14, v166
    v_fmac_f32 v242, v7, v151
    v_fmac_f32 v238, v15, v167
    v_fmac_f32 v236, v16, v112
    v_mul_f32 v244, v24, v160
    v_fmac_f32 v236, v17, v113
    v_fmac_f32 v244, v25, v161
    v_fmac_f32 v236, v18, v114
    v_fmac_f32 v244, v26, v162
    v_fmac_f32 v236, v19, v115
    v_fmac_f32 v244, v27, v163
    v_fmac_f32 v236, v20, v116
    v_fmac_f32 v244, v28, v164
    v_fmac_f32 v236, v21, v117
    v_fmac_f32 v244, v29, v165
    v_fmac_f32 v236, v22, v118
    v_fmac_f32 v244, v30, v166
    v_fmac_f32 v236, v23, v119
    v_fmac_f32 v244, v31, v167
    v_mul_f32 v243, v32, v152
    v_fma_f32 v239, v40, v168, -v239
    v_fmac_f32 v243, v33, v153
    v_fmac_f32 v239, v41, v169
    v_fmac_f32 v243, v34, v154
    v_fmac_f32 v239, v42, v170
    v_fmac_f32 v243, v35, v155
    v_fmac_f32 v239, v43, v171
    v_fmac_f32 v243, v36, v156
    v_fmac_f32 v239, v44, v172
    v_fmac_f32 v243, v37, v157
    v_fmac_f32 v239, v45, v173
    v_fmac_f32 v243, v38, v158
    v_fmac_f32 v239, v46, v174
    v_fmac_f32 v243, v39, v159
    v_fmac_f32 v239, v47, v175
    v_fmac_f32 v237, v48, v120
    v_mul_f32 v245, v56, v168
    v_fmac_f32 v237, v49, v121
    v_fmac_f32 v245, v57, v169
    v_fmac_f32 v237, v50, v122
    v_fmac_f32 v245, v58, v170
    v_fmac_f32 v237, v51, v123
    s_setprio 1
    s_waitcnt vmcnt(4) lgkmcnt(1)
    v_mfma_f32_32x32x16_bf16 v[0:15], v[64:67], v[184:187], 0
    ds_read_b64_tr_b16 v[176:177], v246 offset:4096
    ds_read_b64_tr_b16 v[178:179], v246 offset:4608
    ds_read_b64_tr_b16 v[180:181], v247 offset:4096
    ds_read_b64_tr_b16 v[182:183], v247 offset:4608
    v_fmac_f32 v245, v59, v171
    v_fmac_f32 v237, v52, v124
    s_mov_b32 m0, s69
    v_mfma_f32_32x32x16_bf16 v[16:31], v[68:71], v[184:187], 0
    buffer_load_dwordx4 v224, s[4:7], s45 offen lds
    buffer_load_dwordx4 v225, s[72:75], s45 offen offset:1024 lds
    s_waitcnt lgkmcnt(4)
    v_mad_u32_u16 v227, v226, s39, v248 op_sel:[1,0,0,0]
    v_mad_u32_u16 v226, v226, s39, v248
    v_fmac_f32 v245, v60, v172
    v_fmac_f32 v237, v53, v125
    v_mfma_f32_32x32x16_bf16 v[32:47], v[64:67], v[188:191], 0
    v_add_u32 v228, s51, v251
    ds_read_b32 v228, v228
    v_fmac_f32 v245, v61, v173
    v_fmac_f32 v237, v54, v126
    v_fmac_f32 v245, v62, v174
    v_fmac_f32 v237, v55, v127
    v_fmac_f32 v245, v63, v175
    v_mfma_f32_32x32x16_bf16 v[48:63], v[68:71], v[188:191], 0
    v_permlane32_swap_b32 v238, v239
    v_permlane32_swap_b32 v242, v243
    v_add_f32 v238, v238, v239
    v_add_f32 v242, v242, v243
    s_waitcnt vmcnt(4) lgkmcnt(1)
    v_mfma_f32_32x32x16_bf16 v[0:15], v[72:75], v[176:179], v[0:15]
    ds_read_b64_tr_b16 v[184:185], v246 offset:6144
    ds_read_b64_tr_b16 v[186:187], v246 offset:6656
    ds_read_b64_tr_b16 v[188:189], v247 offset:6144
    ds_read_b64_tr_b16 v[190:191], v247 offset:6656
    v_cvt_pk_bf16_f32 v234, v234, v242
    ds_write_b16 v230, v234 offset:384
    s_mov_b32 m0, s70
    v_mfma_f32_32x32x16_bf16 v[16:31], v[76:79], v[176:179], v[16:31]
    buffer_load_dwordx4 v226, s[4:7], s46 offen lds
    buffer_load_dwordx4 v227, s[72:75], s46 offen offset:1024 lds
    s_waitcnt lgkmcnt(5)
    v_mad_u32_u16 v229, v228, s39, v248 op_sel:[1,0,0,0]
    v_mad_u32_u16 v228, v228, s39, v248
    ds_write_b16_d16_hi v230, v234 offset:768
    v_mfma_f32_32x32x16_bf16 v[32:47], v[72:75], v[180:183], v[32:47]
    v_mfma_f32_32x32x16_bf16 v[48:63], v[76:79], v[180:183], v[48:63]
    s_waitcnt vmcnt(4) lgkmcnt(2)
    v_mfma_f32_32x32x16_bf16 v[0:15], v[80:83], v[184:187], v[0:15]
    ds_read_b64_tr_b16 v[176:177], v246 offset:0
    ds_read_b64_tr_b16 v[178:179], v246 offset:512
    ds_read_b64_tr_b16 v[180:181], v247 offset:0
    ds_read_b64_tr_b16 v[182:183], v247 offset:512
    s_mov_b32 m0, s71
    v_mfma_f32_32x32x16_bf16 v[16:31], v[84:87], v[184:187], v[16:31]
    buffer_load_dwordx4 v228, s[4:7], s47 offen lds
    buffer_load_dwordx4 v229, s[72:75], s47 offen offset:1024 lds
    v_mfma_f32_32x32x16_bf16 v[32:47], v[80:83], v[188:191], v[32:47]
    s_nop 2
    v_mul_f32 v242, v0, v144
    v_fma_f32 v240, v8, v160, -v240
    v_fmac_f32 v242, v1, v145
    v_fmac_f32 v240, v9, v161
    v_fmac_f32 v242, v2, v146
    v_fmac_f32 v240, v10, v162
    v_fmac_f32 v242, v3, v147
    v_mfma_f32_32x32x16_bf16 v[48:63], v[84:87], v[188:191], v[48:63]
    s_setprio 0
    v_fmac_f32 v240, v11, v163
    v_fmac_f32 v242, v4, v148
    v_fmac_f32 v240, v12, v164
    v_fmac_f32 v242, v5, v149
    v_fmac_f32 v240, v13, v165
    v_fmac_f32 v242, v6, v150
    v_fmac_f32 v240, v14, v166
    v_fmac_f32 v242, v7, v151
    v_fmac_f32 v240, v15, v167
    s_sub_u32 s58, s48, s29
    v_add_u32 v249, s58, v249
    v_add_u32 v250, s58, v250
    v_fma_f32 v244, v16, v160, -v244
    v_fmac_f32 v236, v24, v112
    v_fmac_f32 v244, v17, v161
    v_fmac_f32 v236, v25, v113
    v_fmac_f32 v244, v18, v162
    v_fmac_f32 v236, v26, v114
    v_fmac_f32 v244, v19, v163
    v_fmac_f32 v236, v27, v115
    v_fmac_f32 v244, v20, v164
    v_fmac_f32 v236, v28, v116
    v_fmac_f32 v244, v21, v165
    v_fmac_f32 v236, v29, v117
    v_fmac_f32 v244, v22, v166
    v_fmac_f32 v236, v30, v118
    v_fmac_f32 v244, v23, v167
    v_fmac_f32 v236, v31, v119
    ds_read_b64_tr_b16 v[0:1], v249 offset:0
    ds_read_b64_tr_b16 v[2:3], v249 offset:128
    ds_read_b128 v[4:7], v250 offset:0
    ds_read_b128 v[8:11], v250 offset:16
    ds_read_b128 v[12:15], v250 offset:384
    ds_read_b128 v[16:19], v250 offset:400
    v_mul_f32 v243, v32, v152
    v_fma_f32 v241, v40, v168, -v241
    v_fmac_f32 v243, v33, v153
    v_fmac_f32 v241, v41, v169
    v_fmac_f32 v243, v34, v154
    v_fmac_f32 v241, v42, v170
    v_fmac_f32 v243, v35, v155
    v_fmac_f32 v241, v43, v171
    v_fmac_f32 v243, v36, v156
    v_fmac_f32 v241, v44, v172
    v_fmac_f32 v243, v37, v157
    v_fmac_f32 v241, v45, v173
    v_fmac_f32 v243, v38, v158
    v_fmac_f32 v241, v46, v174
    v_fmac_f32 v243, v39, v159
    v_fmac_f32 v241, v47, v175
    ds_read_b64_tr_b16 v[20:21], v249 offset:512
    ds_read_b64_tr_b16 v[22:23], v249 offset:640
    ds_read_b128 v[24:27], v250 offset:64
    ds_read_b128 v[28:31], v250 offset:80
    ds_read_b128 v[32:35], v250 offset:448
    ds_read_b128 v[36:39], v250 offset:464
    v_fma_f32 v245, v48, v168, -v245
    v_fmac_f32 v237, v56, v120
    v_fmac_f32 v245, v49, v169
    v_fmac_f32 v237, v57, v121
    v_fmac_f32 v245, v50, v170
    v_fmac_f32 v237, v58, v122
    v_fmac_f32 v245, v51, v171
    v_fmac_f32 v237, v59, v123
    v_fmac_f32 v245, v52, v172
    v_fmac_f32 v237, v60, v124
    v_fmac_f32 v245, v53, v173
    v_fmac_f32 v237, v61, v125
    v_fmac_f32 v245, v54, v174
    v_fmac_f32 v237, v62, v126
    v_fmac_f32 v245, v55, v175
    v_fmac_f32 v237, v63, v127
    s_cmp_eq_u32 s36, 0
    s_cbranch_scc1 K2_TAIL
    s_mov_b32 s29, s48
    s_mov_b32 s32, s31
    s_mov_b32 s30, s3
    s_mov_b32 s31, s35
    s_cmp_eq_u32 s33, 2
    s_cbranch_scc1 K2_U21
    s_cmp_eq_u32 s33, 3
    s_cbranch_scc1 K2_U31
    s_cmp_eq_u32 s33, 1
    s_cbranch_scc1 K2_U11
    s_branch K2_U41
K2_U10:
    s_setprio 1
    s_add_u32 s38, s38, 1
    v_mov_b32 v254, s52
    v_mov_b32 v255, s38
    s_lshl_b32 s58, s38, 3
    s_add_u32 s58, s58, s20
    s_mov_b64 exec, 1
    ds_write_b32 v254, v255
    s_mov_b64 exec, -1
    s_cmp_lt_u32 s58, s22
    s_cbranch_scc0 K2_dyn_68
K2_back_69:
    s_waitcnt lgkmcnt(11)
    v_lshlrev_b32 v40, 16, v0
    v_and_b32 v41, 0xffff0000, v0
    v_lshlrev_b32 v42, 16, v1
    v_and_b32 v43, 0xffff0000, v1
    v_lshlrev_b32 v44, 16, v2
    v_and_b32 v45, 0xffff0000, v2
    v_lshlrev_b32 v46, 16, v3
    v_and_b32 v47, 0xffff0000, v3
    s_waitcnt lgkmcnt(9)
    v_mul_f32 v4, v40, v4
    v_mul_f32 v5, v41, v5
    v_mul_f32 v6, v42, v6
    v_mul_f32 v7, v43, v7
    v_mul_f32 v8, v44, v8
    v_mul_f32 v9, v45, v9
    v_mul_f32 v10, v46, v10
    v_mul_f32 v11, v47, v11
    v_cvt_pk_bf16_f32 v64, v4, v5
    v_cvt_pk_bf16_f32 v65, v6, v7
    v_cvt_pk_bf16_f32 v66, v8, v9
    v_cvt_pk_bf16_f32 v67, v10, v11
    s_waitcnt lgkmcnt(7)
    v_mul_f32 v12, v40, v12
    v_mul_f32 v13, v41, v13
    v_mul_f32 v14, v42, v14
    v_mul_f32 v15, v43, v15
    v_mul_f32 v16, v44, v16
    v_mul_f32 v17, v45, v17
    v_mul_f32 v18, v46, v18
    v_mul_f32 v19, v47, v19
    v_cvt_pk_bf16_f32 v68, v12, v13
    v_cvt_pk_bf16_f32 v69, v14, v15
    v_cvt_pk_bf16_f32 v70, v16, v17
    v_cvt_pk_bf16_f32 v71, v18, v19
    v_readlane_b32 s3, v253, s58
    s_lshl_b32 s44, s34, 7
    s_lshl_b32 s60, s58, 5
    s_and_b32 s48, s3, 0x3ffff
    s_bfe_u32 s33, s3, 0x30012
    s_sub_u32 s60, s60, s48
    s_and_b32 s60, s60, 0xff
    s_add_u32 s60, s60, s48
    s_mul_i32 s35, s38, 6
    s_cmp_eq_u32 s34, 0
    s_cselect_b32 s35, s35, s60
    s_mov_b32 s45, s44
    s_add_u32 s47, s44, 256
    s_add_u32 s49, s48, 32
    s_add_u32 s60, s48, 64
    s_cmp_eq_u32 s33, 3
    s_cselect_b32 s46, s44, s47
    s_cselect_b32 s50, s60, s48
    s_cselect_b32 s51, s48, s49
    s_sub_u32 s60, s33, 2
    s_cmp_lt_u32 s60, 2
    s_cbranch_scc0 K2_rare_74
K2_back_75:
    v_add_u32 v233, s48, v230
    ds_read_b32 v232, v233
    ds_read_b32 v233, v233 offset:1024
    v_add_u32 v222, s48, v251
    ds_read_b32 v222, v222
    v_add_u32 v224, s49, v251
    ds_read_b32 v224, v224
    v_add_u32 v226, s50, v251
    ds_read_b32 v226, v226
    v_add_u32 v228, s51, v251
    ds_read_b32 v228, v228
    s_waitcnt lgkmcnt(4)
    v_or_b32 v232, v232, v231
    v_or_b32 v233, v233, v231
    s_cmp_lg_u32 s34, 0
    s_cbranch_scc1 K2_dum_77
    s_add_u32 m0, s48, 864
    s_add_u32 s65, s48, 1888
    buffer_load_dwordx4 v232, s[16:19], 0 offen  lds
    s_mov_b32 m0, s65
    s_mov_b32 exec_hi, 0
    buffer_load_dwordx4 v233, s[16:19], 0 offen  lds
    s_cmp_eq_u32 s33, 4
    s_cbranch_scc1 K2_a4_78
K2_b4_80:
    s_mov_b32 exec_hi, -1
K2_back_79:
    s_waitcnt lgkmcnt(3)
    v_mad_u32_u16 v223, v222, s39, v248 op_sel:[1,0,0,0]
    v_mad_u32_u16 v222, v222, s39, v248
    s_waitcnt lgkmcnt(2)
    v_mad_u32_u16 v225, v224, s39, v248 op_sel:[1,0,0,0]
    v_mad_u32_u16 v224, v224, s39, v248
    s_waitcnt lgkmcnt(1)
    v_mad_u32_u16 v227, v226, s39, v248 op_sel:[1,0,0,0]
    v_mad_u32_u16 v226, v226, s39, v248
    s_waitcnt lgkmcnt(0)
    v_mad_u32_u16 v229, v228, s39, v248 op_sel:[1,0,0,0]
    v_mad_u32_u16 v228, v228, s39, v248
    s_waitcnt vmcnt(6)
    v_mfma_f32_32x32x16_bf16 v[0:15], v[64:67], v[176:179], 0
    ds_read_b64_tr_b16 v[184:185], v246 offset:2048
    ds_read_b64_tr_b16 v[186:187], v246 offset:2560
    ds_read_b64_tr_b16 v[188:189], v247 offset:2048
    ds_read_b64_tr_b16 v[190:191], v247 offset:2560
    s_mov_b32 m0, s68
    v_mfma_f32_32x32x16_bf16 v[16:31], v[68:71], v[176:179], 0
    buffer_load_dwordx4 v222, s[4:7], s44 offen lds
    buffer_load_dwordx4 v223, s[72:75], s44 offen offset:1024 lds
    v_permlane32_swap_b32 v242, v243
    v_permlane32_swap_b32 v240, v241
    v_mfma_f32_32x32x16_bf16 v[32:47], v[64:67], v[180:183], 0
    v_permlane32_swap_b32 v236, v237
    v_permlane32_swap_b32 v244, v245
    v_add_f32 v242, v242, v243
    v_add_f32 v240, -v240, -v241
    v_add_f32 v236, v236, v237
    v_mfma_f32_32x32x16_bf16 v[48:63], v[68:71], v[180:183], 0
    s_setprio 0
    v_add_f32 v244, v244, v245
    s_set_gpr_idx_on s32, gpr_idx(DST)
    s_nop 0
    v_cvt_pk_bf16_f32 v195, v242, v236
    v_cvt_pk_bf16_f32 v196, v244, v240
    v_cvt_pk_bf16_f32 v197, v238, v238
    s_set_gpr_idx_off
    v_mul_f32 v234, v0, v96
    v_mul_f32 v236, v8, v128
    v_fmac_f32 v234, v1, v97
    v_fmac_f32 v236, v9, v129
    v_fmac_f32 v234, v2, v98
    v_fmac_f32 v236, v10, v130
    v_fmac_f32 v234, v3, v99
    v_fmac_f32 v236, v11, v131
    v_fmac_f32 v234, v4, v100
    v_fmac_f32 v236, v12, v132
    v_fmac_f32 v234, v5, v101
    v_fmac_f32 v236, v13, v133
    v_fmac_f32 v234, v6, v102
    v_fmac_f32 v236, v14, v134
    v_fmac_f32 v234, v7, v103
    v_fmac_f32 v236, v15, v135
    v_mul_f32 v238, v16, v128
    v_mul_f32 v240, v24, v128
    v_fmac_f32 v238, v17, v129
    v_fmac_f32 v240, v25, v129
    v_fmac_f32 v238, v18, v130
    v_fmac_f32 v240, v26, v130
    v_fmac_f32 v238, v19, v131
    v_fmac_f32 v240, v27, v131
    v_fmac_f32 v238, v20, v132
    v_fmac_f32 v240, v28, v132
    v_fmac_f32 v238, v21, v133
    v_fmac_f32 v240, v29, v133
    v_fmac_f32 v238, v22, v134
    v_fmac_f32 v240, v30, v134
    v_fmac_f32 v238, v23, v135
    v_fmac_f32 v240, v31, v135
    v_mul_f32 v235, v32, v104
    v_mul_f32 v237, v40, v136
    v_fmac_f32 v235, v33, v105
    v_fmac_f32 v237, v41, v137
    v_fmac_f32 v235, v34, v106
    v_fmac_f32 v237, v42, v138
    v_fmac_f32 v235, v35, v107
    v_fmac_f32 v237, v43, v139
    v_fmac_f32 v235, v36, v108
    v_fmac_f32 v237, v44, v140
    v_fmac_f32 v235, v37, v109
    v_fmac_f32 v237, v45, v141
    v_fmac_f32 v235, v38, v110
    v_fmac_f32 v237, v46, v142
    v_fmac_f32 v235, v39, v111
    v_fmac_f32 v237, v47, v143
    v_mul_f32 v239, v48, v136
    v_mul_f32 v241, v56, v136
    v_fmac_f32 v239, v49, v137
    v_fmac_f32 v241, v57, v137
    v_fmac_f32 v239, v50, v138
    v_fmac_f32 v241, v58, v138
    v_fmac_f32 v239, v51, v139
    v_fmac_f32 v241, v59, v139
    v_fmac_f32 v239, v52, v140
    v_fmac_f32 v241, v60, v140
    v_fmac_f32 v239, v53, v141
    v_fmac_f32 v241, v61, v141
    v_fmac_f32 v239, v54, v142
    v_fmac_f32 v241, v62, v142
    v_fmac_f32 v239, v55, v143
    v_fmac_f32 v241, v63, v143
    s_setprio 1
    s_waitcnt vmcnt(6) lgkmcnt(0)
    v_mfma_f32_32x32x16_bf16 v[0:15], v[64:67], v[184:187], 0
    ds_read_b64_tr_b16 v[176:177], v246 offset:4096
    ds_read_b64_tr_b16 v[178:179], v246 offset:4608
    ds_read_b64_tr_b16 v[180:181], v247 offset:4096
    ds_read_b64_tr_b16 v[182:183], v247 offset:4608
    s_mov_b32 m0, s69
    v_mfma_f32_32x32x16_bf16 v[16:31], v[68:71], v[184:187], 0
    buffer_load_dwordx4 v224, s[4:7], s45 offen lds
    buffer_load_dwordx4 v225, s[72:75], s45 offen offset:1024 lds
    v_permlane32_swap_b32 v234, v235
    v_permlane32_swap_b32 v236, v237
    v_mfma_f32_32x32x16_bf16 v[32:47], v[64:67], v[188:191], 0
    v_permlane32_swap_b32 v238, v239
    v_permlane32_swap_b32 v240, v241
    v_add_f32 v234, v234, v235
    v_add_f32 v236, v236, v237
    v_add_f32 v238, v238, v239
    v_mfma_f32_32x32x16_bf16 v[48:63], v[68:71], v[188:191], 0
    s_setprio 0
    v_add_f32 v240, v240, v241
    s_set_gpr_idx_on s31, gpr_idx(DST)
    s_nop 0
    v_cvt_pk_bf16_f32 v192, v234, v236
    v_cvt_pk_bf16_f32 v193, v238, v240
    s_set_gpr_idx_off
    v_mul_f32 v234, v0, v144
    v_mul_f32 v236, v8, v112
    v_fmac_f32 v234, v1, v145
    v_fmac_f32 v236, v9, v113
    v_fmac_f32 v234, v2, v146
    v_fmac_f32 v236, v10, v114
    v_fmac_f32 v234, v3, v147
    v_fmac_f32 v236, v11, v115
    v_fmac_f32 v234, v4, v148
    v_fmac_f32 v236, v12, v116
    v_fmac_f32 v234, v5, v149
    v_fmac_f32 v236, v13, v117
    v_fmac_f32 v234, v6, v150
    v_fmac_f32 v236, v14, v118
    v_fmac_f32 v234, v7, v151
    v_fmac_f32 v236, v15, v119
    v_mul_f32 v238, v16, v160
    v_mul_f32 v240, v24, v160
    v_fmac_f32 v238, v17, v161
    v_fmac_f32 v240, v25, v161
    v_fmac_f32 v238, v18, v162
    v_fmac_f32 v240, v26, v162
    v_fmac_f32 v238, v19, v163
    v_fmac_f32 v240, v27, v163
    v_fmac_f32 v238, v20, v164
    v_fmac_f32 v240, v28, v164
    v_fmac_f32 v238, v21, v165
    v_fmac_f32 v240, v29, v165
    v_fmac_f32 v238, v22, v166
    v_fmac_f32 v240, v30, v166
    v_fmac_f32 v238, v23, v167
    v_fmac_f32 v240, v31, v167
    v_mul_f32 v235, v32, v152
    v_mul_f32 v237, v40, v120
    v_fmac_f32 v235, v33, v153
    v_fmac_f32 v237, v41, v121
    v_fmac_f32 v235, v34, v154
    v_fmac_f32 v237, v42, v122
    v_fmac_f32 v235, v35, v155
    v_fmac_f32 v237, v43, v123
    v_fmac_f32 v235, v36, v156
    v_fmac_f32 v237, v44, v124
    v_fmac_f32 v235, v37, v157
    v_fmac_f32 v237, v45, v125
    v_fmac_f32 v235, v38, v158
    v_fmac_f32 v237, v46, v126
    v_fmac_f32 v235, v39, v159
    v_fmac_f32 v237, v47, v127
    v_mul_f32 v239, v48, v168
    v_mul_f32 v241, v56, v168
    v_fmac_f32 v239, v49, v169
    v_fmac_f32 v241, v57, v169
    v_fmac_f32 v239, v50, v170
    v_fmac_f32 v241, v58, v170
    v_fmac_f32 v239, v51, v171
    v_fmac_f32 v241, v59, v171
    v_fmac_f32 v239, v52, v172
    v_fmac_f32 v241, v60, v172
    v_fmac_f32 v239, v53, v173
    v_fmac_f32 v241, v61, v173
    v_fmac_f32 v239, v54, v174
    v_fmac_f32 v241, v62, v174
    v_fmac_f32 v239, v55, v175
    v_fmac_f32 v241, v63, v175
    s_setprio 1
    s_waitcnt vmcnt(6) lgkmcnt(0)
    v_mfma_f32_32x32x16_bf16 v[0:15], v[64:67], v[176:179], 0
    ds_read_b64_tr_b16 v[184:185], v246 offset:6144
    ds_read_b64_tr_b16 v[186:187], v246 offset:6656
    ds_read_b64_tr_b16 v[188:189], v247 offset:6144
    ds_read_b64_tr_b16 v[190:191], v247 offset:6656
    s_mov_b32 m0, s70
    v_mfma_f32_32x32x16_bf16 v[16:31], v[68:71], v[176:179], 0
    buffer_load_dwordx4 v226, s[4:7], s46 offen lds
    buffer_load_dwordx4 v227, s[72:75], s46 offen offset:1024 lds
    v_permlane32_swap_b32 v234, v235
    v_add_f32 v234, v234, v235
    v_mfma_f32_32x32x16_bf16 v[32:47], v[64:67], v[180:183], 0
    v_mfma_f32_32x32x16_bf16 v[48:63], v[68:71], v[180:183], 0
    s_setprio 0
    v_mul_f32 v242, v0, v144
    v_fma_f32 v238, v8, v160, -v238
    v_fmac_f32 v242, v1, v145
    v_fmac_f32 v238, v9, v161
    v_fmac_f32 v242, v2, v146
    v_fmac_f32 v238, v10, v162
    v_fmac_f32 v242, v3, v147
    v_fmac_f32 v238, v11, v163
    v_fmac_f32 v242, v4, v148
    v_fmac_f32 v238, v12, v164
    v_fmac_f32 v242, v5, v149
    v_fmac_f32 v238, v13, v165
    v_fmac_f32 v242, v6, v150
    v_fmac_f32 v238, v14, v166
    v_fmac_f32 v242, v7, v151
    v_fmac_f32 v238, v15, v167
    v_fmac_f32 v236, v16, v112
    v_mul_f32 v244, v24, v160
    v_fmac_f32 v236, v17, v113
    v_fmac_f32 v244, v25, v161
    v_fmac_f32 v236, v18, v114
    v_fmac_f32 v244, v26, v162
    v_fmac_f32 v236, v19, v115
    v_fmac_f32 v244, v27, v163
    v_fmac_f32 v236, v20, v116
    v_fmac_f32 v244, v28, v164
    v_fmac_f32 v236, v21, v117
    v_fmac_f32 v244, v29, v165
    v_fmac_f32 v236, v22, v118
    v_fmac_f32 v244, v30, v166
    v_fmac_f32 v236, v23, v119
    v_fmac_f32 v244, v31, v167
    v_mul_f32 v243, v32, v152
    v_fma_f32 v239, v40, v168, -v239
    v_fmac_f32 v243, v33, v153
    v_fmac_f32 v239, v41, v169
    v_fmac_f32 v243, v34, v154
    v_fmac_f32 v239, v42, v170
    v_fmac_f32 v243, v35, v155
    v_fmac_f32 v239, v43, v171
    v_fmac_f32 v243, v36, v156
    v_fmac_f32 v239, v44, v172
    v_fmac_f32 v243, v37, v157
    v_fmac_f32 v239, v45, v173
    v_fmac_f32 v243, v38, v158
    v_fmac_f32 v239, v46, v174
    v_fmac_f32 v243, v39, v159
    v_fmac_f32 v239, v47, v175
    v_fmac_f32 v237, v48, v120
    v_mul_f32 v245, v56, v168
    v_fmac_f32 v237, v49, v121
    v_fmac_f32 v245, v57, v169
    v_fmac_f32 v237, v50, v122
    v_fmac_f32 v245, v58, v170
    v_fmac_f32 v237, v51, v123
    v_fmac_f32 v245, v59, v171
    v_fmac_f32 v237, v52, v124
    v_fmac_f32 v245, v60, v172
    v_fmac_f32 v237, v53, v125
    v_fmac_f32 v245, v61, v173
    v_fmac_f32 v237, v54, v126
    v_fmac_f32 v245, v62, v174
    v_fmac_f32 v237, v55, v127
    v_fmac_f32 v245, v63, v175
    s_setprio 1
    s_waitcnt vmcnt(4) lgkmcnt(0)
    v_mfma_f32_32x32x16_bf16 v[0:15], v[64:67], v[184:187], 0
    ds_read_b64_tr_b16 v[176:177], v246 offset:0
    ds_read_b64_tr_b16 v[178:179], v246 offset:512
    ds_read_b64_tr_b16 v[180:181], v247 offset:0
    ds_read_b64_tr_b16 v[182:183], v247 offset:512
    s_mov_b32 m0, s71
    v_mfma_f32_32x32x16_bf16 v[16:31], v[68:71], v[184:187], 0
    buffer_load_dwordx4 v228, s[4:7], s47 offen lds
    buffer_load_dwordx4 v229, s[72:75], s47 offen offset:1024 lds
    v_permlane32_swap_b32 v238, v239
    v_permlane32_swap_b32 v242, v243
    v_add_f32 v238, v238, v239
    v_mfma_f32_32x32x16_bf16 v[32:47], v[64:67], v[188:191], 0
    v_add_f32 v242, v242, v243
    s_set_gpr_idx_on s31, gpr_idx(DST)
    s_nop 0
    v_cvt_pk_bf16_f32 v194, v234, v242
    s_set_gpr_idx_off
    v_mfma_f32_32x32x16_bf16 v[48:63], v[68:71], v[188:191], 0
    s_setprio 0
    v_mul_f32 v242, v0, v144
    v_fma_f32 v240, v8, v160, -v240
    v_fmac_f32 v242, v1, v145
    v_fmac_f32 v240, v9, v161
    v_fmac_f32 v242, v2, v146
    v_fmac_f32 v240, v10, v162
    v_fmac_f32 v242, v3, v147
    v_fmac_f32 v240, v11, v163
    v_fmac_f32 v242, v4, v148
    v_fmac_f32 v240, v12, v164
    v_fmac_f32 v242, v5, v149
    v_fmac_f32 v240, v13, v165
    v_fmac_f32 v242, v6, v150
    v_fmac_f32 v240, v14, v166
    v_fmac_f32 v242, v7, v151
    v_fmac_f32 v240, v15, v167
    s_sub_u32 s58, s48, s29
    v_add_u32 v249, s58, v249
    v_add_u32 v250, s58, v250
    v_fma_f32 v244, v16, v160, -v244
    v_fmac_f32 v236, v24, v112
    v_fmac_f32 v244, v17, v161
    v_fmac_f32 v236, v25, v113
    v_fmac_f32 v244, v18, v162
    v_fmac_f32 v236, v26, v114
    v_fmac_f32 v244, v19, v163
    v_fmac_f32 v236, v27, v115
    v_fmac_f32 v244, v20, v164
    v_fmac_f32 v236, v28, v116
    v_fmac_f32 v244, v21, v165
    v_fmac_f32 v236, v29, v117
    v_fmac_f32 v244, v22, v166
    v_fmac_f32 v236, v30, v118
    v_fmac_f32 v244, v23, v167
    v_fmac_f32 v236, v31, v119
    ds_read_b64_tr_b16 v[0:1], v249 offset:0
    ds_read_b64_tr_b16 v[2:3], v249 offset:128
    ds_read_b128 v[4:7], v250 offset:0
    ds_read_b128 v[8:11], v250 offset:16
    ds_read_b128 v[12:15], v250 offset:384
    ds_read_b128 v[16:19], v250 offset:400
    v_mul_f32 v243, v32, v152
    v_fma_f32 v241, v40, v168, -v241
    v_fmac_f32 v243, v33, v153
    v_fmac_f32 v241, v41, v169
    v_fmac_f32 v243, v34, v154
    v_fmac_f32 v241, v42, v170
    v_fmac_f32 v243, v35, v155
    v_fmac_f32 v241, v43, v171
    v_fmac_f32 v243, v36, v156
    v_fmac_f32 v241, v44, v172
    v_fmac_f32 v243, v37, v157
    v_fmac_f32 v241, v45, v173
    v_fmac_f32 v243, v38, v158
    v_fmac_f32 v241, v46, v174
    v_fmac_f32 v243, v39, v159
    v_fmac_f32 v241, v47, v175
    ds_read_b64_tr_b16 v[20:21], v249 offset:512
    ds_read_b64_tr_b16 v[22:23], v249 offset:640
    ds_read_b128 v[24:27], v250 offset:64
    ds_read_b128 v[28:31], v250 offset:80
    ds_read_b128 v[32:35], v250 offset:448
    ds_read_b128 v[36:39], v250 offset:464
    v_fma_f32 v245, v48, v168, -v245
    v_fmac_f32 v237, v56, v120
    v_fmac_f32 v245, v49, v169
    v_fmac_f32 v237, v57, v121
    v_fmac_f32 v245, v50, v170
    v_fmac_f32 v237, v58, v122
    v_fmac_f32 v245, v51, v171
    v_fmac_f32 v237, v59, v123
    v_fmac_f32 v245, v52, v172
    v_fmac_f32 v237, v60, v124
    v_fmac_f32 v245, v53, v173
    v_fmac_f32 v237, v61, v125
    v_fmac_f32 v245, v54, v174
    v_fmac_f32 v237, v62, v126
    v_fmac_f32 v245, v55, v175
    v_fmac_f32 v237, v63, v127
    s_cmp_lg_u32 s34, 0
    s_cbranch_scc1 K2_SWITCH
    s_mov_b32 s29, s48
    s_mov_b32 s32, s31
    s_mov_b32 s30, s3
    s_mov_b32 s31, s35
    s_cmp_eq_u32 s33, 2
    s_cbranch_scc1 K2_U20
    s_cmp_eq_u32 s33, 3
    s_cbranch_scc1 K2_U30
    s_cmp_eq_u32 s33, 1
    s_cbranch_scc1 K2_U10
    s_branch K2_U40
K2_U40:
    s_setprio 1
    s_waitcnt lgkmcnt(10)
    v_lshlrev_b32 v40, 16, v0
    v_and_b32 v41, 0xffff0000, v0
    v_lshlrev_b32 v42, 16, v1
    v_and_b32 v43, 0xffff0000, v1
    v_lshlrev_b32 v44, 16, v2
    v_and_b32 v45, 0xffff0000, v2
    v_lshlrev_b32 v46, 16, v3
    v_and_b32 v47, 0xffff0000, v3
    s_waitcnt lgkmcnt(8)
    v_mul_f32 v4, v40, v4
    v_mul_f32 v5, v41, v5
    v_mul_f32 v6, v42, v6
    v_mul_f32 v7, v43, v7
    v_mul_f32 v8, v44, v8
    v_mul_f32 v9, v45, v9
    v_mul_f32 v10, v46, v10
    v_mul_f32 v11, v47, v11
    v_cvt_pk_bf16_f32 v64, v4, v5
    v_cvt_pk_bf16_f32 v65, v6, v7
    v_cvt_pk_bf16_f32 v66, v8, v9
    v_cvt_pk_bf16_f32 v67, v10, v11
    s_waitcnt lgkmcnt(6)
    v_mul_f32 v12, v40, v12
    v_mul_f32 v13, v41, v13
    v_mul_f32 v14, v42, v14
    v_mul_f32 v15, v43, v15
    v_mul_f32 v16, v44, v16
    v_mul_f32 v17, v45, v17
    v_mul_f32 v18, v46, v18
    v_mul_f32 v19, v47, v19
    v_cvt_pk_bf16_f32 v68, v12, v13
    v_cvt_pk_bf16_f32 v69, v14, v15
    v_cvt_pk_bf16_f32 v70, v16, v17
    v_cvt_pk_bf16_f32 v71, v18, v19
    ds_read_b64_tr_b16 v[0:1], v249 offset:1024
    ds_read_b64_tr_b16 v[2:3], v249 offset:1152
    ds_read_b128 v[4:7], v250 offset:128
    ds_read_b128 v[8:11], v250 offset:144
    ds_read_b128 v[12:15], v250 offset:512
    ds_read_b128 v[16:19], v250 offset:528
    s_waitcnt lgkmcnt(10)
    v_lshlrev_b32 v48, 16, v20
    v_and_b32 v49, 0xffff0000, v20
    v_lshlrev_b32 v50, 16, v21
    v_and_b32 v51, 0xffff0000, v21
    v_lshlrev_b32 v52, 16, v22
    v_and_b32 v53, 0xffff0000, v22
    v_lshlrev_b32 v54, 16, v23
    v_and_b32 v55, 0xffff0000, v23
    s_waitcnt lgkmcnt(8)
    v_mul_f32 v24, v48, v24
    v_mul_f32 v25, v49, v25
    v_mul_f32 v26, v50, v26
    v_mul_f32 v27, v51, v27
    v_mul_f32 v28, v52, v28
    v_mul_f32 v29, v53, v29
    v_mul_f32 v30, v54, v30
    v_mul_f32 v31, v55, v31
    v_cvt_pk_bf16_f32 v72, v24, v25
    v_cvt_pk_bf16_f32 v73, v26, v27
    v_cvt_pk_bf16_f32 v74, v28, v29
    v_cvt_pk_bf16_f32 v75, v30, v31
    s_waitcnt lgkmcnt(6)
    v_mul_f32 v32, v48, v32
    v_mul_f32 v33, v49, v33
    v_mul_f32 v34, v50, v34
    v_mul_f32 v35, v51, v35
    v_mul_f32 v36, v52, v36
    v_mul_f32 v37, v53, v37
    v_mul_f32 v38, v54, v38
    v_mul_f32 v39, v55, v39
    v_cvt_pk_bf16_f32 v76, v32, v33
    v_cvt_pk_bf16_f32 v77, v34, v35
    v_cvt_pk_bf16_f32 v78, v36, v37
    v_cvt_pk_bf16_f32 v79, v38, v39
    s_lshr_b32 s65, s30, 27
    s_mov_b32 s66, 161536
    s_cmp_ge_u32 s65, 2
    s_cselect_b32 s66, 158112, s66
    s_mul_i32 s65, s65, 512
    s_add_u32 s65, s65, s66
    s_sub_u32 s65, s65, s29
    v_add_u32 v56, s65, v249
    s_lshr_b32 s65, s30, 27
    s_mov_b32 s66, 161536
    s_cmp_ge_u32 s65, 2
    s_cselect_b32 s66, 159008, s66
    s_mul_i32 s65, s65, 64
    s_add_u32 s65, s65, s66
    s_sub_u32 s65, s65, s29
    v_add_u32 v57, s65, v250
    ds_read_b64_tr_b16 v[20:21], v56 offset:0
    ds_read_b64_tr_b16 v[22:23], v56 offset:128
    ds_read_b128 v[24:27], v57 offset:0
    ds_read_b128 v[28:31], v57 offset:16
    ds_read_b128 v[32:35], v57 offset:384
    ds_read_b128 v[36:39], v57 offset:400
    s_waitcnt lgkmcnt(10)
    v_lshlrev_b32 v40, 16, v0
    v_and_b32 v41, 0xffff0000, v0
    v_lshlrev_b32 v42, 16, v1
    v_and_b32 v43, 0xffff0000, v1
    v_lshlrev_b32 v44, 16, v2
    v_and_b32 v45, 0xffff0000, v2
    v_lshlrev_b32 v46, 16, v3
    v_and_b32 v47, 0xffff0000, v3
    s_waitcnt lgkmcnt(8)
    v_mul_f32 v4, v40, v4
    v_mul_f32 v5, v41, v5
    v_mul_f32 v6, v42, v6
    v_mul_f32 v7, v43, v7
    v_mul_f32 v8, v44, v8
    v_mul_f32 v9, v45, v9
    v_mul_f32 v10, v46, v10
    v_mul_f32 v11, v47, v11
    v_cvt_pk_bf16_f32 v80, v4, v5
    v_cvt_pk_bf16_f32 v81, v6, v7
    v_cvt_pk_bf16_f32 v82, v8, v9
    v_cvt_pk_bf16_f32 v83, v10, v11
    s_waitcnt lgkmcnt(6)
    v_mul_f32 v12, v40, v12
    v_mul_f32 v13, v41, v13
    v_mul_f32 v14, v42, v14
    v_mul_f32 v15, v43, v15
    v_mul_f32 v16, v44, v16
    v_mul_f32 v17, v45, v17
    v_mul_f32 v18, v46, v18
    v_mul_f32 v19, v47, v19
    v_cvt_pk_bf16_f32 v84, v12, v13
    v_cvt_pk_bf16_f32 v85, v14, v15
    v_cvt_pk_bf16_f32 v86, v16, v17
    v_cvt_pk_bf16_f32 v87, v18, v19
    s_waitcnt lgkmcnt(4)
    v_lshlrev_b32 v48, 16, v20
    v_and_b32 v49, 0xffff0000, v20
    v_lshlrev_b32 v50, 16, v21
    v_and_b32 v51, 0xffff0000, v21
    v_lshlrev_b32 v52, 16, v22
    v_and_b32 v53, 0xffff0000, v22
    v_lshlrev_b32 v54, 16, v23
    v_and_b32 v55, 0xffff0000, v23
    s_waitcnt lgkmcnt(2)
    v_mul_f32 v24, v48, v24
    v_mul_f32 v25, v49, v25
    v_mul_f32 v26, v50, v26
    v_mul_f32 v27, v51, v27
    v_mul_f32 v28, v52, v28
    v_mul_f32 v29, v53, v29
    v_mul_f32 v30, v54, v30
    v_mul_f32 v31, v55, v31
    v_cvt_pk_bf16_f32 v88, v24, v25
    v_cvt_pk_bf16_f32 v89, v26, v27
    v_cvt_pk_bf16_f32 v90, v28, v29
    v_cvt_pk_bf16_f32 v91, v30, v31
    s_waitcnt lgkmcnt(0)
    v_mul_f32 v32, v48, v32
    v_mul_f32 v33, v49, v33
    v_mul_f32 v34, v50, v34
    v_mul_f32 v35, v51, v35
    v_mul_f32 v36, v52, v36
    v_mul_f32 v37, v53, v37
    v_mul_f32 v38, v54, v38
    v_mul_f32 v39, v55, v39
    v_cvt_pk_bf16_f32 v92, v32, v33
    v_cvt_pk_bf16_f32 v93, v34, v35
    v_cvt_pk_bf16_f32 v94, v36, v37
    v_cvt_pk_bf16_f32 v95, v38, v39
    s_waitcnt vmcnt(4)
    v_mfma_f32_32x32x16_bf16 v[0:15], v[64:67], v[176:179], 0
    ds_read_b64_tr_b16 v[184:185], v246 offset:2048
    ds_read_b64_tr_b16 v[186:187], v246 offset:2560
    ds_read_b64_tr_b16 v[188:189], v247 offset:2048
    ds_read_b64_tr_b16 v[190:191], v247 offset:2560
    s_mov_b32 m0, s68
    v_mfma_f32_32x32x16_bf16 v[16:31], v[68:71], v[176:179], 0
    buffer_load_dwordx4 v222, s[4:7], s41 offen lds
    buffer_load_dwordx4 v223, s[72:75], s41 offen offset:1024 lds
    v_permlane32_swap_b32 v242, v243
    v_permlane32_swap_b32 v240, v241
    s_add_u32 s38, s38, 1
    v_mfma_f32_32x32x16_bf16 v[32:47], v[64:67], v[180:183], 0
    v_permlane32_swap_b32 v236, v237
    v_permlane32_swap_b32 v244, v245
    v_add_f32 v242, v242, v243
    v_add_f32 v240, -v240, -v241
    v_add_f32 v236, v236, v237
    v_mfma_f32_32x32x16_bf16 v[48:63], v[68:71], v[180:183], 0
    v_add_f32 v244, v244, v245
    s_set_gpr_idx_on s32, gpr_idx(DST)
    s_nop 0
    v_cvt_pk_bf16_f32 v195, v242, v236
    v_cvt_pk_bf16_f32 v196, v244, v240
    v_cvt_pk_bf16_f32 v197, v238, v238
    s_set_gpr_idx_off
    s_waitcnt vmcnt(4) lgkmcnt(0)
    v_mfma_f32_32x32x16_bf16 v[0:15], v[72:75], v[184:187], v[0:15]
    ds_read_b64_tr_b16 v[176:177], v246 offset:4096
    ds_read_b64_tr_b16 v[178:179], v246 offset:4608
    ds_read_b64_tr_b16 v[180:181], v247 offset:4096
    ds_read_b64_tr_b16 v[182:183], v247 offset:4608
    v_mov_b32 v254, s52
    v_mov_b32 v255, s38
    s_mov_b32 m0, s69
    v_mfma_f32_32x32x16_bf16 v[16:31], v[76:79], v[184:187], v[16:31]
    buffer_load_dwordx4 v224, s[4:7], s41 offen lds
    buffer_load_dwordx4 v225, s[72:75], s41 offen offset:1024 lds
    s_lshl_b32 s58, s38, 3
    s_add_u32 s58, s58, s20
    s_mov_b64 exec, 1
    ds_write_b32 v254, v255
    s_mov_b64 exec, -1
    s_cmp_lt_u32 s58, s22
    s_cbranch_scc0 K2_dyn_81
K2_back_82:
    v_readlane_b32 s3, v253, s58
    s_lshl_b32 s44, s34, 7
    s_lshl_b32 s60, s58, 5
    s_and_b32 s48, s3, 0x3ffff
    s_bfe_u32 s33, s3, 0x30012
    s_sub_u32 s60, s60, s48
    s_and_b32 s60, s60, 0xff
    s_add_u32 s60, s60, s48
    s_mul_i32 s35, s38, 6
    s_cmp_eq_u32 s34, 0
    s_cselect_b32 s35, s35, s60
    s_mov_b32 s45, s44
    s_add_u32 s47, s44, 256
    s_add_u32 s49, s48, 32
    s_add_u32 s60, s48, 64
    s_cmp_eq_u32 s33, 3
    s_cselect_b32 s46, s44, s47
    s_cselect_b32 s50, s60, s48
    s_cselect_b32 s51, s48, s49
    s_sub_u32 s60, s33, 2
    s_cmp_lt_u32 s60, 2
    s_cbranch_scc0 K2_rare_87
K2_back_88:
    v_mfma_f32_32x32x16_bf16 v[32:47], v[72:75], v[188:191], v[32:47]
    v_add_u32 v233, s48, v230
    ds_read_b32 v232, v233
    ds_read_b32 v233, v233 offset:1024
    v_mfma_f32_32x32x16_bf16 v[48:63], v[76:79], v[188:191], v[48:63]
    s_waitcnt vmcnt(4) lgkmcnt(3)
    v_mfma_f32_32x32x16_bf16 v[0:15], v[80:83], v[176:179], v[0:15]
    ds_read_b64_tr_b16 v[184:185], v246 offset:6144
    ds_read_b64_tr_b16 v[186:187], v246 offset:6656
    ds_read_b64_tr_b16 v[188:189], v247 offset:6144
    ds_read_b64_tr_b16 v[190:191], v247 offset:6656
    s_mov_b32 m0, s70
    v_mfma_f32_32x32x16_bf16 v[16:31], v[84:87], v[176:179], v[16:31]
    buffer_load_dwordx4 v226, s[4:7], s41 offen lds
    buffer_load_dwordx4 v227, s[72:75], s41 offen offset:1024 lds
    v_mfma_f32_32x32x16_bf16 v[32:47], v[80:83], v[180:183], v[32:47]
    v_mfma_f32_32x32x16_bf16 v[48:63], v[84:87], v[180:183], v[48:63]
    s_waitcnt lgkmcnt(4)
    v_or_b32 v232, v232, v231
    v_or_b32 v233, v233, v231
    s_cmp_lg_u32 s34, 0
    s_cbranch_scc1 K2_dum_90
    s_add_u32 m0, s48, 864
    s_add_u32 s65, s48, 1888
    buffer_load_dwordx4 v232, s[16:19], 0 offen  lds
    s_mov_b32 m0, s65
    s_mov_b32 exec_hi, 0
    buffer_load_dwordx4 v233, s[16:19], 0 offen  lds
    s_cmp_eq_u32 s33, 4
    s_cbranch_scc1 K2_a4_91
K2_b4_93:
    s_mov_b32 exec_hi, -1
K2_back_92:
    s_waitcnt vmcnt(6) lgkmcnt(0)
    v_mfma_f32_32x32x16_bf16 v[0:15], v[88:91], v[184:187], v[0:15]
    ds_read_b64_tr_b16 v[176:177], v246 offset:0
    ds_read_b64_tr_b16 v[178:179], v246 offset:512
    ds_read_b64_tr_b16 v[180:181], v247 offset:0
    ds_read_b64_tr_b16 v[182:183], v247 offset:512
    s_mov_b32 m0, s71
    v_mfma_f32_32x32x16_bf16 v[16:31], v[92:95], v[184:187], v[16:31]
    buffer_load_dwordx4 v228, s[4:7], s41 offen lds
    buffer_load_dwordx4 v229, s[72:75], s41 offen offset:1024 lds
    v_mfma_f32_32x32x16_bf16 v[32:47], v[88:91], v[188:191], v[32:47]
    s_nop 2
    v_mul_f32 v234, v0, v96
    v_mul_f32 v236, v8, v128
    v_fmac_f32 v234, v1, v97
    v_fmac_f32 v236, v9, v129
    v_fmac_f32 v234, v2, v98
    v_fmac_f32 v236, v10, v130
    v_fmac_f32 v234, v3, v99
    v_mfma_f32_32x32x16_bf16 v[48:63], v[92:95], v[188:191], v[48:63]
    s_setprio 0
    v_fmac_f32 v236, v11, v131
    v_fmac_f32 v234, v4, v100
    v_fmac_f32 v236, v12, v132
    v_fmac_f32 v234, v5, v101
    v_fmac_f32 v236, v13, v133
    v_fmac_f32 v234, v6, v102
    v_fmac_f32 v236, v14, v134
    v_fmac_f32 v234, v7, v103
    v_fmac_f32 v236, v15, v135
    v_mul_f32 v238, v16, v128
    v_mul_f32 v240, v24, v128
    v_fmac_f32 v238, v17, v129
    v_fmac_f32 v240, v25, v129
    v_fmac_f32 v238, v18, v130
    v_fmac_f32 v240, v26, v130
    v_fmac_f32 v238, v19, v131
    v_fmac_f32 v240, v27, v131
    v_fmac_f32 v238, v20, v132
    v_fmac_f32 v240, v28, v132
    v_fmac_f32 v238, v21, v133
    v_fmac_f32 v240, v29, v133
    v_fmac_f32 v238, v22, v134
    v_fmac_f32 v240, v30, v134
    v_fmac_f32 v238, v23, v135
    v_fmac_f32 v240, v31, v135
    v_mul_f32 v235, v32, v104
    v_mul_f32 v237, v40, v136
    v_fmac_f32 v235, v33, v105
    v_fmac_f32 v237, v41, v137
    v_fmac_f32 v235, v34, v106
    v_fmac_f32 v237, v42, v138
    v_fmac_f32 v235, v35, v107
    v_fmac_f32 v237, v43, v139
    v_fmac_f32 v235, v36, v108
    v_fmac_f32 v237, v44, v140
    v_fmac_f32 v235, v37, v109
    v_fmac_f32 v237, v45, v141
    v_fmac_f32 v235, v38, v110
    v_fmac_f32 v237, v46, v142
    v_fmac_f32 v235, v39, v111
    v_fmac_f32 v237, v47, v143
    v_mul_f32 v239, v48, v136
    v_mul_f32 v241, v56, v136
    s_setprio 1
    s_waitcnt vmcnt(6) lgkmcnt(0)
    v_mfma_f32_32x32x16_bf16 v[0:15], v[64:67], v[176:179], 0
    ds_read_b64_tr_b16 v[184:185], v246 offset:2048
    ds_read_b64_tr_b16 v[186:187], v246 offset:2560
    ds_read_b64_tr_b16 v[188:189], v247 offset:2048
    ds_read_b64_tr_b16 v[190:191], v247 offset:2560
    v_fmac_f32 v239, v49, v137
    v_fmac_f32 v241, v57, v137
    s_mov_b32 m0, s68
    v_mfma_f32_32x32x16_bf16 v[16:31], v[68:71], v[176:179], 0
    buffer_load_dwordx4 v222, s[4:7], s42 offen lds
    buffer_load_dwordx4 v223, s[72:75], s42 offen offset:1024 lds
    v_fmac_f32 v239, v50, v138
    v_fmac_f32 v241, v58, v138
    v_fmac_f32 v239, v51, v139
    v_fmac_f32 v241, v59, v139
    v_fmac_f32 v239, v52, v140
    v_mfma_f32_32x32x16_bf16 v[32:47], v[64:67], v[180:183], 0
    v_fmac_f32 v241, v60, v140
    v_fmac_f32 v239, v53, v141
    v_fmac_f32 v241, v61, v141
    v_fmac_f32 v239, v54, v142
    v_fmac_f32 v241, v62, v142
    v_fmac_f32 v239, v55, v143
    v_fmac_f32 v241, v63, v143
    v_mfma_f32_32x32x16_bf16 v[48:63], v[68:71], v[180:183], 0
    v_permlane32_swap_b32 v234, v235
    v_permlane32_swap_b32 v236, v237
    v_permlane32_swap_b32 v238, v239
    s_waitcnt vmcnt(6) lgkmcnt(0)
    v_mfma_f32_32x32x16_bf16 v[0:15], v[72:75], v[184:187], v[0:15]
    ds_read_b64_tr_b16 v[176:177], v246 offset:4096
    ds_read_b64_tr_b16 v[178:179], v246 offset:4608
    ds_read_b64_tr_b16 v[180:181], v247 offset:4096
    ds_read_b64_tr_b16 v[182:183], v247 offset:4608
    v_permlane32_swap_b32 v240, v241
    s_mov_b32 m0, s69
    v_mfma_f32_32x32x16_bf16 v[16:31], v[76:79], v[184:187], v[16:31]
    buffer_load_dwordx4 v224, s[4:7], s42 offen lds
    buffer_load_dwordx4 v225, s[72:75], s42 offen offset:1024 lds
    v_add_f32 v234, v234, v235
    v_add_f32 v236, v236, v237
    v_add_f32 v238, v238, v239
    v_add_f32 v240, v240, v241
    v_mfma_f32_32x32x16_bf16 v[32:47], v[72:75], v[188:191], v[32:47]
    s_set_gpr_idx_on s31, gpr_idx(DST)
    s_nop 0
    v_cvt_pk_bf16_f32 v192, v234, v236
    v_cvt_pk_bf16_f32 v193, v238, v240
    s_set_gpr_idx_off
    v_mfma_f32_32x32x16_bf16 v[48:63], v[76:79], v[188:191], v[48:63]
    s_waitcnt vmcnt(4) lgkmcnt(0)
    v_mfma_f32_32x32x16_bf16 v[0:15], v[80:83], v[176:179], v[0:15]
    ds_read_b64_tr_b16 v[184:185], v246 offset:6144
    ds_read_b64_tr_b16 v[186:187], v246 offset:6656
    ds_read_b64_tr_b16 v[188:189], v247 offset:6144
    ds_read_b64_tr_b16 v[190:191], v247 offset:6656
    s_mov_b32 m0, s70
    v_mfma_f32_32x32x16_bf16 v[16:31], v[84:87], v[176:179], v[16:31]
    buffer_load_dwordx4 v226, s[4:7], s42 offen lds
    buffer_load_dwordx4 v227, s[72:75], s42 offen offset:1024 lds
    v_mfma_f32_32x32x16_bf16 v[32:47], v[80:83], v[180:183], v[32:47]
    v_mfma_f32_32x32x16_bf16 v[48:63], v[84:87], v[180:183], v[48:63]
    s_waitcnt vmcnt(4) lgkmcnt(0)
    v_mfma_f32_32x32x16_bf16 v[0:15], v[88:91], v[184:187], v[0:15]
    ds_read_b64_tr_b16 v[176:177], v246 offset:0
    ds_read_b64_tr_b16 v[178:179], v246 offset:512
    ds_read_b64_tr_b16 v[180:181], v247 offset:0
    ds_read_b64_tr_b16 v[182:183], v247 offset:512
    s_mov_b32 m0, s71
    v_mfma_f32_32x32x16_bf16 v[16:31], v[92:95], v[184:187], v[16:31]
    buffer_load_dwordx4 v228, s[4:7], s42 offen lds
    buffer_load_dwordx4 v229, s[72:75], s42 offen offset:1024 lds
    v_mfma_f32_32x32x16_bf16 v[32:47], v[88:91], v[188:191], v[32:47]
    s_nop 2
    v_mul_f32 v234, v0, v144
    v_mul_f32 v236, v8, v112
    v_fmac_f32 v234, v1, v145
    v_fmac_f32 v236, v9, v113
    v_fmac_f32 v234, v2, v146
    v_fmac_f32 v236, v10, v114
    v_fmac_f32 v234, v3, v147
    v_mfma_f32_32x32x16_bf16 v[48:63], v[92:95], v[188:191], v[48:63]
    s_setprio 0
    v_fmac_f32 v236, v11, v115
    v_fmac_f32 v234, v4, v148
    v_fmac_f32 v236, v12, v116
    v_fmac_f32 v234, v5, v149
    v_fmac_f32 v236, v13, v117
    v_fmac_f32 v234, v6, v150
    v_fmac_f32 v236, v14, v118
    v_fmac_f32 v234, v7, v151
    v_fmac_f32 v236, v15, v119
    v_mul_f32 v238, v16, v160
    v_mul_f32 v240, v24, v160
    v_fmac_f32 v238, v17, v161
    v_fmac_f32 v240, v25, v161
    v_fmac_f32 v238, v18, v162
    v_fmac_f32 v240, v26, v162
    v_fmac_f32 v238, v19, v163
    v_fmac_f32 v240, v27, v163
    v_fmac_f32 v238, v20, v164
    v_fmac_f32 v240, v28, v164
    v_fmac_f32 v238, v21, v165
    v_fmac_f32 v240, v29, v165
    v_fmac_f32 v238, v22, v166
    v_fmac_f32 v240, v30, v166
    v_fmac_f32 v238, v23, v167
    v_fmac_f32 v240, v31, v167
    v_mul_f32 v235, v32, v152
    v_mul_f32 v237, v40, v120
    v_fmac_f32 v235, v33, v153
    v_fmac_f32 v237, v41, v121
    v_fmac_f32 v235, v34, v154
    v_fmac_f32 v237, v42, v122
    v_fmac_f32 v235, v35, v155
    v_fmac_f32 v237, v43, v123
    v_fmac_f32 v235, v36, v156
    v_fmac_f32 v237, v44, v124
    v_fmac_f32 v235, v37, v157
    v_fmac_f32 v237, v45, v125
    v_fmac_f32 v235, v38, v158
    v_fmac_f32 v237, v46, v126
    v_fmac_f32 v235, v39, v159
    v_fmac_f32 v237, v47, v127
    v_mul_f32 v239, v48, v168
    v_mul_f32 v241, v56, v168
    s_setprio 1
    s_waitcnt vmcnt(4) lgkmcnt(0)
    v_mfma_f32_32x32x16_bf16 v[0:15], v[64:67], v[176:179], 0
    ds_read_b64_tr_b16 v[184:185], v246 offset:2048
    ds_read_b64_tr_b16 v[186:187], v246 offset:2560
    ds_read_b64_tr_b16 v[188:189], v247 offset:2048
    ds_read_b64_tr_b16 v[190:191], v247 offset:2560
    v_fmac_f32 v239, v49, v169
    v_fmac_f32 v241, v57, v169
    s_mov_b32 m0, s68
    v_mfma_f32_32x32x16_bf16 v[16:31], v[68:71], v[176:179], 0
    buffer_load_dwordx4 v222, s[4:7], s43 offen lds
    buffer_load_dwordx4 v223, s[72:75], s43 offen offset:1024 lds
    v_fmac_f32 v239, v50, v170
    v_fmac_f32 v241, v58, v170
    v_fmac_f32 v239, v51, v171
    v_fmac_f32 v241, v59, v171
    v_fmac_f32 v239, v52, v172
    v_mfma_f32_32x32x16_bf16 v[32:47], v[64:67], v[180:183], 0
    v_fmac_f32 v241, v60, v172
    v_fmac_f32 v239, v53, v173
    v_fmac_f32 v241, v61, v173
    v_fmac_f32 v239, v54, v174
    v_fmac_f32 v241, v62, v174
    v_fmac_f32 v239, v55, v175
    v_fmac_f32 v241, v63, v175
    v_mfma_f32_32x32x16_bf16 v[48:63], v[68:71], v[180:183], 0
    v_permlane32_swap_b32 v234, v235
    v_add_f32 v234, v234, v235
    s_waitcnt vmcnt(4) lgkmcnt(0)
    v_mfma_f32_32x32x16_bf16 v[0:15], v[72:75], v[184:187], v[0:15]
    ds_read_b64_tr_b16 v[176:177], v246 offset:4096
    ds_read_b64_tr_b16 v[178:179], v246 offset:4608
    ds_read_b64_tr_b16 v[180:181], v247 offset:4096
    ds_read_b64_tr_b16 v[182:183], v247 offset:4608
    s_mov_b32 m0, s69
    v_mfma_f32_32x32x16_bf16 v[16:31], v[76:79], v[184:187], v[16:31]
    buffer_load_dwordx4 v224, s[4:7], s43 offen lds
    buffer_load_dwordx4 v225, s[72:75], s43 offen offset:1024 lds
    v_mfma_f32_32x32x16_bf16 v[32:47], v[72:75], v[188:191], v[32:47]
    v_mfma_f32_32x32x16_bf16 v[48:63], v[76:79], v[188:191], v[48:63]
    s_waitcnt vmcnt(4) lgkmcnt(0)
    v_mfma_f32_32x32x16_bf16 v[0:15], v[80:83], v[176:179], v[0:15]
    ds_read_b64_tr_b16 v[184:185], v246 offset:6144
    ds_read_b64_tr_b16 v[186:187], v246 offset:6656
    ds_read_b64_tr_b16 v[188:189], v247 offset:6144
    ds_read_b64_tr_b16 v[190:191], v247 offset:6656
    s_mov_b32 m0, s70
    v_mfma_f32_32x32x16_bf16 v[16:31], v[84:87], v[176:179], v[16:31]
    buffer_load_dwordx4 v226, s[4:7], s43 offen lds
    buffer_load_dwordx4 v227, s[72:75], s43 offen offset:1024 lds
    v_mfma_f32_32x32x16_bf16 v[32:47], v[80:83], v[180:183], v[32:47]
    v_add_u32 v222, s48, v251
    ds_read_b32 v222, v222
    v_mfma_f32_32x32x16_bf16 v[48:63], v[84:87], v[180:183], v[48:63]
    s_waitcnt vmcnt(4) lgkmcnt(1)
    v_mfma_f32_32x32x16_bf16 v[0:15], v[88:91], v[184:187], v[0:15]
    ds_read_b64_tr_b16 v[176:177], v246 offset:0
    ds_read_b64_tr_b16 v[178:179], v246 offset:512
    ds_read_b64_tr_b16 v[180:181], v247 offset:0
    ds_read_b64_tr_b16 v[182:183], v247 offset:512
    s_mov_b32 m0, s71
    v_mfma_f32_32x32x16_bf16 v[16:31], v[92:95], v[184:187], v[16:31]
    buffer_load_dwordx4 v228, s[4:7], s43 offen lds
    buffer_load_dwordx4 v229, s[72:75], s43 offen offset:1024 lds
    s_waitcnt lgkmcnt(4)
    v_mad_u32_u16 v223, v222, s39, v248 op_sel:[1,0,0,0]
    v_mad_u32_u16 v222, v222, s39, v248
    v_mfma_f32_32x32x16_bf16 v[32:47], v[88:91], v[188:191], v[32:47]
    v_add_u32 v224, s49, v251
    ds_read_b32 v224, v224
    v_mul_f32 v242, v0, v144
    v_fma_f32 v238, v8, v160, -v238
    v_fmac_f32 v242, v1, v145
    v_fmac_f32 v238, v9, v161
    v_fmac_f32 v242, v2, v146
    v_mfma_f32_32x32x16_bf16 v[48:63], v[92:95], v[188:191], v[48:63]
    s_setprio 0
    v_fmac_f32 v238, v10, v162
    v_fmac_f32 v242, v3, v147
    v_fmac_f32 v238, v11, v163
    v_fmac_f32 v242, v4, v148
    v_fmac_f32 v238, v12, v164
    v_fmac_f32 v242, v5, v149
    v_fmac_f32 v238, v13, v165
    v_fmac_f32 v242, v6, v150
    v_fmac_f32 v238, v14, v166
    v_fmac_f32 v242, v7, v151
    v_fmac_f32 v238, v15, v167
    v_fmac_f32 v236, v16, v112
    v_mul_f32 v244, v24, v160
    v_fmac_f32 v236, v17, v113
    v_fmac_f32 v244, v25, v161
    v_fmac_f32 v236, v18, v114
    v_fmac_f32 v244, v26, v162
    v_fmac_f32 v236, v19, v115
    v_fmac_f32 v244, v27, v163
    v_fmac_f32 v236, v20, v116
    v_fmac_f32 v244, v28, v164
    v_fmac_f32 v236, v21, v117
    v_fmac_f32 v244, v29, v165
    v_fmac_f32 v236, v22, v118
    v_fmac_f32 v244, v30, v166
    v_fmac_f32 v236, v23, v119
    v_fmac_f32 v244, v31, v167
    v_mul_f32 v243, v32, v152
    v_fma_f32 v239, v40, v168, -v239
    v_fmac_f32 v243, v33, v153
    v_fmac_f32 v239, v41, v169
    v_fmac_f32 v243, v34, v154
    v_fmac_f32 v239, v42, v170
    v_fmac_f32 v243, v35, v155
    v_fmac_f32 v239, v43, v171
    v_fmac_f32 v243, v36, v156
    v_fmac_f32 v239, v44, v172
    v_fmac_f32 v243, v37, v157
    v_fmac_f32 v239, v45, v173
    v_fmac_f32 v243, v38, v158
    v_fmac_f32 v239, v46, v174
    v_fmac_f32 v243, v39, v159
    v_fmac_f32 v239, v47, v175
    v_fmac_f32 v237, v48, v120
    v_mul_f32 v245, v56, v168
    v_fmac_f32 v237, v49, v121
    v_fmac_f32 v245, v57, v169
    v_fmac_f32 v237, v50, v122
    v_fmac_f32 v245, v58, v170
    v_fmac_f32 v237, v51, v123
    s_setprio 1
    s_waitcnt vmcnt(4) lgkmcnt(1)
    v_mfma_f32_32x32x16_bf16 v[0:15], v[64:67], v[176:179], 0
    ds_read_b64_tr_b16 v[184:185], v246 offset:2048
    ds_read_b64_tr_b16 v[186:187], v246 offset:2560
    ds_read_b64_tr_b16 v[188:189], v247 offset:2048
    ds_read_b64_tr_b16 v[190:191], v247 offset:2560
    v_fmac_f32 v245, v59, v171
    v_fmac_f32 v237, v52, v124
    s_mov_b32 m0, s68
    v_mfma_f32_32x32x16_bf16 v[16:31], v[68:71], v[176:179], 0
    buffer_load_dwordx4 v222, s[4:7], s44 offen lds
    buffer_load_dwordx4 v223, s[72:75], s44 offen offset:1024 lds
    s_waitcnt lgkmcnt(4)
    v_mad_u32_u16 v225, v224, s39, v248 op_sel:[1,0,0,0]
    v_mad_u32_u16 v224, v224, s39, v248
    v_fmac_f32 v245, v60, v172
    v_fmac_f32 v237, v53, v125
    v_mfma_f32_32x32x16_bf16 v[32:47], v[64:67], v[180:183], 0
    v_add_u32 v226, s50, v251
    ds_read_b32 v226, v226
    v_fmac_f32 v245, v61, v173
    v_fmac_f32 v237, v54, v126
    v_fmac_f32 v245, v62, v174
    v_fmac_f32 v237, v55, v127
    v_fmac_f32 v245, v63, v175
    v_mfma_f32_32x32x16_bf16 v[48:63], v[68:71], v[180:183], 0
    v_permlane32_swap_b32 v238, v239
    v_permlane32_swap_b32 v242, v243
    v_add_f32 v238, v238, v239
    v_add_f32 v242, v242, v243
    s_waitcnt vmcnt(4) lgkmcnt(1)
    v_mfma_f32_32x32x16_bf16 v[0:15], v[72:75], v[184:187], v[0:15]
    ds_read_b64_tr_b16 v[176:177], v246 offset:4096
    ds_read_b64_tr_b16 v[178:179], v246 offset:4608
    ds_read_b64_tr_b16 v[180:181], v247 offset:4096
    ds_read_b64_tr_b16 v[182:183], v247 offset:4608
    s_mov_b32 m0, s69
    v_mfma_f32_32x32x16_bf16 v[16:31], v[76:79], v[184:187], v[16:31]
    buffer_load_dwordx4 v224, s[4:7], s45 offen lds
    buffer_load_dwordx4 v225, s[72:75], s45 offen offset:1024 lds
    s_waitcnt lgkmcnt(4)
    v_mad_u32_u16 v227, v226, s39, v248 op_sel:[1,0,0,0]
    v_mad_u32_u16 v226, v226, s39, v248
    v_mfma_f32_32x32x16_bf16 v[32:47], v[72:75], v[188:191], v[32:47]
    v_add_u32 v228, s51, v251
    ds_read_b32 v228, v228
    s_set_gpr_idx_on s31, gpr_idx(DST)
    s_nop 0
    v_cvt_pk_bf16_f32 v194, v234, v242
    s_set_gpr_idx_off
    v_mfma_f32_32x32x16_bf16 v[48:63], v[76:79], v[188:191], v[48:63]
    s_waitcnt vmcnt(4) lgkmcnt(1)
    v_mfma_f32_32x32x16_bf16 v[0:15], v[80:83], v[176:179], v[0:15]
    ds_read_b64_tr_b16 v[184:185], v246 offset:6144
    ds_read_b64_tr_b16 v[186:187], v246 offset:6656
    ds_read_b64_tr_b16 v[188:189], v247 offset:6144
    ds_read_b64_tr_b16 v[190:191], v247 offset:6656
    s_mov_b32 m0, s70
    v_mfma_f32_32x32x16_bf16 v[16:31], v[84:87], v[176:179], v[16:31]
    buffer_load_dwordx4 v226, s[4:7], s46 offen lds
    buffer_load_dwordx4 v227, s[72:75], s46 offen offset:1024 lds
    s_waitcnt lgkmcnt(4)
    v_mad_u32_u16 v229, v228, s39, v248 op_sel:[1,0,0,0]
    v_mad_u32_u16 v228, v228, s39, v248
    v_mfma_f32_32x32x16_bf16 v[32:47], v[80:83], v[180:183], v[32:47]
    v_mfma_f32_32x32x16_bf16 v[48:63], v[84:87], v[180:183], v[48:63]
    s_waitcnt vmcnt(4) lgkmcnt(0)
    v_mfma_f32_32x32x16_bf16 v[0:15], v[88:91], v[184:187], v[0:15]
    ds_read_b64_tr_b16 v[176:177], v246 offset:0
    ds_read_b64_tr_b16 v[178:179], v246 offset:512
    ds_read_b64_tr_b16 v[180:181], v247 offset:0
    ds_read_b64_tr_b16 v[182:183], v247 offset:512
    s_mov_b32 m0, s71
    v_mfma_f32_32x32x16_bf16 v[16:31], v[92:95], v[184:187], v[16:31]
    buffer_load_dwordx4 v228, s[4:7], s47 offen lds
    buffer_load_dwordx4 v229, s[72:75], s47 offen offset:1024 lds
    v_mfma_f32_32x32x16_bf16 v[32:47], v[88:91], v[188:191], v[32:47]
    s_nop 2
    v_mul_f32 v242, v0, v144
    v_fma_f32 v240, v8, v160, -v240
    v_fmac_f32 v242, v1, v145
    v_fmac_f32 v240, v9, v161
    v_fmac_f32 v242, v2, v146
    v_fmac_f32 v240, v10, v162
    v_fmac_f32 v242, v3, v147
    v_mfma_f32_32x32x16_bf16 v[48:63], v[92:95], v[188:191], v[48:63]
    s_setprio 0
    v_fmac_f32 v240, v11, v163
    v_fmac_f32 v242, v4, v148
    v_fmac_f32 v240, v12, v164
    v_fmac_f32 v242, v5, v149
    v_fmac_f32 v240, v13, v165
    v_fmac_f32 v242, v6, v150
    v_fmac_f32 v240, v14, v166
    v_fmac_f32 v242, v7, v151
    v_fmac_f32 v240, v15, v167
    s_sub_u32 s58, s48, s29
    v_add_u32 v249, s58, v249
    v_add_u32 v250, s58, v250
    v_fma_f32 v244, v16, v160, -v244
    v_fmac_f32 v236, v24, v112
    v_fmac_f32 v244, v17, v161
    v_fmac_f32 v236, v25, v113
    v_fmac_f32 v244, v18, v162
    v_fmac_f32 v236, v26, v114
    v_fmac_f32 v244, v19, v163
    v_fmac_f32 v236, v27, v115
    v_fmac_f32 v244, v20, v164
    v_fmac_f32 v236, v28, v116
    v_fmac_f32 v244, v21, v165
    v_fmac_f32 v236, v29, v117
    v_fmac_f32 v244, v22, v166
    v_fmac_f32 v236, v30, v118
    v_fmac_f32 v244, v23, v167
    v_fmac_f32 v236, v31, v119
    ds_read_b64_tr_b16 v[0:1], v249 offset:0
    ds_read_b64_tr_b16 v[2:3], v249 offset:128
    ds_read_b128 v[4:7], v250 offset:0
    ds_read_b128 v[8:11], v250 offset:16
    ds_read_b128 v[12:15], v250 offset:384
    ds_read_b128 v[16:19], v250 offset:400
    v_mul_f32 v243, v32, v152
    v_fma_f32 v241, v40, v168, -v241
    v_fmac_f32 v243, v33, v153
    v_fmac_f32 v241, v41, v169
    v_fmac_f32 v243, v34, v154
    v_fmac_f32 v241, v42, v170
    v_fmac_f32 v243, v35, v155
    v_fmac_f32 v241, v43, v171
    v_fmac_f32 v243, v36, v156
    v_fmac_f32 v241, v44, v172
    v_fmac_f32 v243, v37, v157
    v_fmac_f32 v241, v45, v173
    v_fmac_f32 v243, v38, v158
    v_fmac_f32 v241, v46, v174
    v_fmac_f32 v243, v39, v159
    v_fmac_f32 v241, v47, v175
    ds_read_b64_tr_b16 v[20:21], v249 offset:512
    ds_read_b64_tr_b16 v[22:23], v249 offset:640
    ds_read_b128 v[24:27], v250 offset:64
    ds_read_b128 v[28:31], v250 offset:80
    ds_read_b128 v[32:35], v250 offset:448
    ds_read_b128 v[36:39], v250 offset:464
    v_fma_f32 v245, v48, v168, -v245
    v_fmac_f32 v237, v56, v120
    v_fmac_f32 v245, v49, v169
    v_fmac_f32 v237, v57, v121
    v_fmac_f32 v245, v50, v170
    v_fmac_f32 v237, v58, v122
    v_fmac_f32 v245, v51, v171
    v_fmac_f32 v237, v59, v123
    v_fmac_f32 v245, v52, v172
    v_fmac_f32 v237, v60, v124
    v_fmac_f32 v245, v53, v173
    v_fmac_f32 v237, v61, v125
    v_fmac_f32 v245, v54, v174
    v_fmac_f32 v237, v62, v126
    v_fmac_f32 v245, v55, v175
    v_fmac_f32 v237, v63, v127
    s_cmp_lg_u32 s34, 0
    s_cbranch_scc1 K2_SWITCH
    s_mov_b32 s29, s48
    s_mov_b32 s32, s31
    s_mov_b32 s30, s3
    s_mov_b32 s31, s35
    s_cmp_eq_u32 s33, 2
    s_cbranch_scc1 K2_U20
    s_cmp_eq_u32 s33, 3
    s_cbranch_scc1 K2_U30
    s_cmp_eq_u32 s33, 1
    s_cbranch_scc1 K2_U10
    s_branch K2_U40
K2_U11:
    s_setprio 1
    v_mov_b32 v254, 163648
    v_mov_b32 v255, 1
    v_lshl_add_u32 v233, v252, 1, s53
    s_mov_b64 exec, 1
    ds_add_rtn_u32 v232, v254, v255
    s_mov_b64 exec, -1
    ds_read_b32 v233, v233
    s_waitcnt lgkmcnt(12)
    v_lshlrev_b32 v40, 16, v0
    v_and_b32 v41, 0xffff0000, v0
    v_lshlrev_b32 v42, 16, v1
    v_and_b32 v43, 0xffff0000, v1
    v_lshlrev_b32 v44, 16, v2
    v_and_b32 v45, 0xffff0000, v2
    v_lshlrev_b32 v46, 16, v3
    v_and_b32 v47, 0xffff0000, v3
    s_waitcnt lgkmcnt(10)
    v_mul_f32 v4, v40, v4
    v_mul_f32 v5, v41, v5
    v_mul_f32 v6, v42, v6
    v_mul_f32 v7, v43, v7
    v_mul_f32 v8, v44, v8
    v_mul_f32 v9, v45, v9
    v_mul_f32 v10, v46, v10
    v_mul_f32 v11, v47, v11
    v_cvt_pk_bf16_f32 v64, v4, v5
    v_cvt_pk_bf16_f32 v65, v6, v7
    v_cvt_pk_bf16_f32 v66, v8, v9
    v_cvt_pk_bf16_f32 v67, v10, v11
    s_waitcnt lgkmcnt(8)
    v_mul_f32 v12, v40, v12
    v_mul_f32 v13, v41, v13
    v_mul_f32 v14, v42, v14
    v_mul_f32 v15, v43, v15
    v_mul_f32 v16, v44, v16
    v_mul_f32 v17, v45, v17
    v_mul_f32 v18, v46, v18
    v_mul_f32 v19, v47, v19
    v_cvt_pk_bf16_f32 v68, v12, v13
    v_cvt_pk_bf16_f32 v69, v14, v15
    v_cvt_pk_bf16_f32 v70, v16, v17
    v_cvt_pk_bf16_f32 v71, v18, v19
    s_waitcnt lgkmcnt(0)
    v_readfirstlane_b32 s58, v232
    s_nop 0
    s_cmp_lt_u32 s58, s22
    s_cbranch_scc0 K2_nul_94
    s_and_b32 s59, s58, 7
    s_lshr_b32 s60, s58, 3
K2_chk_96:
    v_readlane_b32 s61, v233, s59
    s_nop 0
    s_cmp_gt_u32 s61, s60
    s_cbranch_scc0 K2_spin_95
K2_back_97:
    v_readlane_b32 s3, v253, s58
    s_lshl_b32 s44, s34, 7
    s_lshl_b32 s60, s58, 5
    s_and_b32 s48, s3, 0x3ffff
    s_bfe_u32 s33, s3, 0x30012
    s_sub_u32 s60, s60, s48
    s_and_b32 s60, s60, 0xff
    s_add_u32 s35, s60, s48
    s_mov_b32 s45, s44
    s_add_u32 s47, s44, 256
    s_add_u32 s49, s48, 32
    s_add_u32 s60, s48, 64
    s_cmp_eq_u32 s33, 3
    s_cselect_b32 s46, s44, s47
    s_cselect_b32 s50, s60, s48
    s_cselect_b32 s51, s48, s49
    s_sub_u32 s60, s33, 2
    s_cmp_lt_u32 s60, 2
    s_cbranch_scc0 K2_rare_98
K2_back_99:
    v_add_u32 v222, s48, v251
    ds_read_b32 v222, v222
    v_add_u32 v224, s49, v251
    ds_read_b32 v224, v224
    v_add_u32 v226, s50, v251
    ds_read_b32 v226, v226
    v_add_u32 v228, s51, v251
    ds_read_b32 v228, v228
    s_waitcnt lgkmcnt(3)
    v_mad_u32_u16 v223, v222, s39, v248 op_sel:[1,0,0,0]
    v_mad_u32_u16 v222, v222, s39, v248
    s_waitcnt lgkmcnt(2)
    v_mad_u32_u16 v225, v224, s39, v248 op_sel:[1,0,0,0]
    v_mad_u32_u16 v224, v224, s39, v248
    s_waitcnt lgkmcnt(1)
    v_mad_u32_u16 v227, v226, s39, v248 op_sel:[1,0,0,0]
    v_mad_u32_u16 v226, v226, s39, v248
    s_waitcnt lgkmcnt(0)
    v_mad_u32_u16 v229, v228, s39, v248 op_sel:[1,0,0,0]
    v_mad_u32_u16 v228, v228, s39, v248
    s_waitcnt vmcnt(4)
    v_mfma_f32_32x32x16_bf16 v[0:15], v[64:67], v[176:179], 0
    ds_read_b64_tr_b16 v[184:185], v246 offset:2048
    ds_read_b64_tr_b16 v[186:187], v246 offset:2560
    ds_read_b64_tr_b16 v[188:189], v247 offset:2048
    ds_read_b64_tr_b16 v[190:191], v247 offset:2560
    s_mov_b32 m0, s68
    v_mfma_f32_32x32x16_bf16 v[16:31], v[68:71], v[176:179], 0
    buffer_load_dwordx4 v222, s[4:7], s44 offen lds
    buffer_load_dwordx4 v223, s[72:75], s44 offen offset:1024 lds
    v_permlane32_swap_b32 v242, v243
    v_permlane32_swap_b32 v240, v241
    v_mfma_f32_32x32x16_bf16 v[32:47], v[64:67], v[180:183], 0
    v_permlane32_swap_b32 v236, v237
    v_permlane32_swap_b32 v244, v245
    v_add_f32 v242, v242, v243
    v_add_f32 v240, -v240, -v241
    v_add_f32 v236, v236, v237
    v_mfma_f32_32x32x16_bf16 v[48:63], v[68:71], v[180:183], 0
    s_setprio 0
    v_add_f32 v244, v244, v245
    v_cvt_pk_bf16_f32 v242, v242, v236
    v_cvt_pk_bf16_f32 v244, v244, v240
    v_cvt_pk_bf16_f32 v238, v238, v238
    ds_write_b16 v230, v242 offset:1152
    ds_write_b16_d16_hi v230, v242 offset:128
    ds_write_b16 v230, v244 offset:512
    ds_write_b16_d16_hi v230, v244 offset:896
    ds_write_b16 v230, v238 offset:1280
    v_mul_f32 v234, v0, v96
    v_mul_f32 v236, v8, v128
    v_fmac_f32 v234, v1, v97
    v_fmac_f32 v236, v9, v129
    v_fmac_f32 v234, v2, v98
    v_fmac_f32 v236, v10, v130
    v_fmac_f32 v234, v3, v99
    v_fmac_f32 v236, v11, v131
    v_fmac_f32 v234, v4, v100
    v_fmac_f32 v236, v12, v132
    v_fmac_f32 v234, v5, v101
    v_fmac_f32 v236, v13, v133
    v_fmac_f32 v234, v6, v102
    v_fmac_f32 v236, v14, v134
    v_fmac_f32 v234, v7, v103
    v_fmac_f32 v236, v15, v135
    v_mul_f32 v238, v16, v128
    v_mul_f32 v240, v24, v128
    v_fmac_f32 v238, v17, v129
    v_fmac_f32 v240, v25, v129
    v_fmac_f32 v238, v18, v130
    v_fmac_f32 v240, v26, v130
    v_fmac_f32 v238, v19, v131
    v_fmac_f32 v240, v27, v131
    v_fmac_f32 v238, v20, v132
    v_fmac_f32 v240, v28, v132
    v_fmac_f32 v238, v21, v133
    v_fmac_f32 v240, v29, v133
    v_fmac_f32 v238, v22, v134
    v_fmac_f32 v240, v30, v134
    v_fmac_f32 v238, v23, v135
    v_fmac_f32 v240, v31, v135
    v_mul_f32 v235, v32, v104
    v_mul_f32 v237, v40, v136
    v_fmac_f32 v235, v33, v105
    v_fmac_f32 v237, v41, v137
    v_fmac_f32 v235, v34, v106
    v_fmac_f32 v237, v42, v138
    v_fmac_f32 v235, v35, v107
    v_fmac_f32 v237, v43, v139
    v_fmac_f32 v235, v36, v108
    v_fmac_f32 v237, v44, v140
    v_fmac_f32 v235, v37, v109
    v_fmac_f32 v237, v45, v141
    v_fmac_f32 v235, v38, v110
    v_fmac_f32 v237, v46, v142
    v_fmac_f32 v235, v39, v111
    v_fmac_f32 v237, v47, v143
    v_mul_f32 v239, v48, v136
    v_mul_f32 v241, v56, v136
    v_fmac_f32 v239, v49, v137
    v_fmac_f32 v241, v57, v137
    v_fmac_f32 v239, v50, v138
    v_fmac_f32 v241, v58, v138
    v_fmac_f32 v239, v51, v139
    v_fmac_f32 v241, v59, v139
    v_fmac_f32 v239, v52, v140
    v_fmac_f32 v241, v60, v140
    v_fmac_f32 v239, v53, v141
    v_fmac_f32 v241, v61, v141
    v_fmac_f32 v239, v54, v142
    v_fmac_f32 v241, v62, v142
    v_fmac_f32 v239, v55, v143
    v_fmac_f32 v241, v63, v143
    s_setprio 1
    s_waitcnt vmcnt(4) lgkmcnt(5)
    v_mfma_f32_32x32x16_bf16 v[0:15], v[64:67], v[184:187], 0
    ds_read_b64_tr_b16 v[176:177], v246 offset:4096
    ds_read_b64_tr_b16 v[178:179], v246 offset:4608
    ds_read_b64_tr_b16 v[180:181], v247 offset:4096
    ds_read_b64_tr_b16 v[182:183], v247 offset:4608
    s_mov_b32 m0, s69
    v_mfma_f32_32x32x16_bf16 v[16:31], v[68:71], v[184:187], 0
    buffer_load_dwordx4 v224, s[4:7], s45 offen lds
    buffer_load_dwordx4 v225, s[72:75], s45 offen offset:1024 lds
    v_permlane32_swap_b32 v234, v235
    v_permlane32_swap_b32 v236, v237
    v_mfma_f32_32x32x16_bf16 v[32:47], v[64:67], v[188:191], 0
    v_permlane32_swap_b32 v238, v239
    v_permlane32_swap_b32 v240, v241
    v_add_u32 v230, s31, v252
    v_add_f32 v234, v234, v235
    v_add_f32 v236, v236, v237
    v_mfma_f32_32x32x16_bf16 v[48:63], v[68:71], v[188:191], 0
    s_setprio 0
    v_add_f32 v238, v238, v239
    v_add_f32 v240, v240, v241
    v_cvt_pk_bf16_f32 v234, v234, v236
    v_cvt_pk_bf16_f32 v238, v238, v240
    ds_write_b16 v230, v234 offset:0
    ds_write_b16_d16_hi v230, v234 offset:256
    ds_write_b16 v230, v238 offset:640
    ds_write_b16_d16_hi v230, v238 offset:1024
    v_mul_f32 v234, v0, v144
    v_mul_f32 v236, v8, v112
    v_fmac_f32 v234, v1, v145
    v_fmac_f32 v236, v9, v113
    v_fmac_f32 v234, v2, v146
    v_fmac_f32 v236, v10, v114
    v_fmac_f32 v234, v3, v147
    v_fmac_f32 v236, v11, v115
    v_fmac_f32 v234, v4, v148
    v_fmac_f32 v236, v12, v116
    v_fmac_f32 v234, v5, v149
    v_fmac_f32 v236, v13, v117
    v_fmac_f32 v234, v6, v150
    v_fmac_f32 v236, v14, v118
    v_fmac_f32 v234, v7, v151
    v_fmac_f32 v236, v15, v119
    v_mul_f32 v238, v16, v160
    v_mul_f32 v240, v24, v160
    v_fmac_f32 v238, v17, v161
    v_fmac_f32 v240, v25, v161
    v_fmac_f32 v238, v18, v162
    v_fmac_f32 v240, v26, v162
    v_fmac_f32 v238, v19, v163
    v_fmac_f32 v240, v27, v163
    v_fmac_f32 v238, v20, v164
    v_fmac_f32 v240, v28, v164
    v_fmac_f32 v238, v21, v165
    v_fmac_f32 v240, v29, v165
    v_fmac_f32 v238, v22, v166
    v_fmac_f32 v240, v30, v166
    v_fmac_f32 v238, v23, v167
    v_fmac_f32 v240, v31, v167
    v_mul_f32 v235, v32, v152
    v_mul_f32 v237, v40, v120
    v_fmac_f32 v235, v33, v153
    v_fmac_f32 v237, v41, v121
    v_fmac_f32 v235, v34, v154
    v_fmac_f32 v237, v42, v122
    v_fmac_f32 v235, v35, v155
    v_fmac_f32 v237, v43, v123
    v_fmac_f32 v235, v36, v156
    v_fmac_f32 v237, v44, v124
    v_fmac_f32 v235, v37, v157
    v_fmac_f32 v237, v45, v125
    v_fmac_f32 v235, v38, v158
    v_fmac_f32 v237, v46, v126
    v_fmac_f32 v235, v39, v159
    v_fmac_f32 v237, v47, v127
    v_mul_f32 v239, v48, v168
    v_mul_f32 v241, v56, v168
    v_fmac_f32 v239, v49, v169
    v_fmac_f32 v241, v57, v169
    v_fmac_f32 v239, v50, v170
    v_fmac_f32 v241, v58, v170
    v_fmac_f32 v239, v51, v171
    v_fmac_f32 v241, v59, v171
    v_fmac_f32 v239, v52, v172
    v_fmac_f32 v241, v60, v172
    v_fmac_f32 v239, v53, v173
    v_fmac_f32 v241, v61, v173
    v_fmac_f32 v239, v54, v174
    v_fmac_f32 v241, v62, v174
    v_fmac_f32 v239, v55, v175
    v_fmac_f32 v241, v63, v175
    s_setprio 1
    s_waitcnt vmcnt(4) lgkmcnt(4)
    v_mfma_f32_32x32x16_bf16 v[0:15], v[64:67], v[176:179], 0
    ds_read_b64_tr_b16 v[184:185], v246 offset:6144
    ds_read_b64_tr_b16 v[186:187], v246 offset:6656
    ds_read_b64_tr_b16 v[188:189], v247 offset:6144
    ds_read_b64_tr_b16 v[190:191], v247 offset:6656
    s_mov_b32 m0, s70
    v_mfma_f32_32x32x16_bf16 v[16:31], v[68:71], v[176:179], 0
    buffer_load_dwordx4 v226, s[4:7], s46 offen lds
    buffer_load_dwordx4 v227, s[72:75], s46 offen offset:1024 lds
    v_permlane32_swap_b32 v234, v235
    v_add_f32 v234, v234, v235
    v_mfma_f32_32x32x16_bf16 v[32:47], v[64:67], v[180:183], 0
    v_mfma_f32_32x32x16_bf16 v[48:63], v[68:71], v[180:183], 0
    s_setprio 0
    v_mul_f32 v242, v0, v144
    v_fma_f32 v238, v8, v160, -v238
    v_fmac_f32 v242, v1, v145
    v_fmac_f32 v238, v9, v161
    v_fmac_f32 v242, v2, v146
    v_fmac_f32 v238, v10, v162
    v_fmac_f32 v242, v3, v147
    v_fmac_f32 v238, v11, v163
    v_fmac_f32 v242, v4, v148
    v_fmac_f32 v238, v12, v164
    v_fmac_f32 v242, v5, v149
    v_fmac_f32 v238, v13, v165
    v_fmac_f32 v242, v6, v150
    v_fmac_f32 v238, v14, v166
    v_fmac_f32 v242, v7, v151
    v_fmac_f32 v238, v15, v167
    v_fmac_f32 v236, v16, v112
    v_mul_f32 v244, v24, v160
    v_fmac_f32 v236, v17, v113
    v_fmac_f32 v244, v25, v161
    v_fmac_f32 v236, v18, v114
    v_fmac_f32 v244, v26, v162
    v_fmac_f32 v236, v19, v115
    v_fmac_f32 v244, v27, v163
    v_fmac_f32 v236, v20, v116
    v_fmac_f32 v244, v28, v164
    v_fmac_f32 v236, v21, v117
    v_fmac_f32 v244, v29, v165
    v_fmac_f32 v236, v22, v118
    v_fmac_f32 v244, v30, v166
    v_fmac_f32 v236, v23, v119
    v_fmac_f32 v244, v31, v167
    v_mul_f32 v243, v32, v152
    v_fma_f32 v239, v40, v168, -v239
    v_fmac_f32 v243, v33, v153
    v_fmac_f32 v239, v41, v169
    v_fmac_f32 v243, v34, v154
    v_fmac_f32 v239, v42, v170
    v_fmac_f32 v243, v35, v155
    v_fmac_f32 v239, v43, v171
    v_fmac_f32 v243, v36, v156
    v_fmac_f32 v239, v44, v172
    v_fmac_f32 v243, v37, v157
    v_fmac_f32 v239, v45, v173
    v_fmac_f32 v243, v38, v158
    v_fmac_f32 v239, v46, v174
    v_fmac_f32 v243, v39, v159
    v_fmac_f32 v239, v47, v175
    v_fmac_f32 v237, v48, v120
    v_mul_f32 v245, v56, v168
    v_fmac_f32 v237, v49, v121
    v_fmac_f32 v245, v57, v169
    v_fmac_f32 v237, v50, v122
    v_fmac_f32 v245, v58, v170
    v_fmac_f32 v237, v51, v123
    v_fmac_f32 v245, v59, v171
    v_fmac_f32 v237, v52, v124
    v_fmac_f32 v245, v60, v172
    v_fmac_f32 v237, v53, v125
    v_fmac_f32 v245, v61, v173
    v_fmac_f32 v237, v54, v126
    v_fmac_f32 v245, v62, v174
    v_fmac_f32 v237, v55, v127
    v_fmac_f32 v245, v63, v175
    s_setprio 1
    s_waitcnt vmcnt(4) lgkmcnt(0)
    v_mfma_f32_32x32x16_bf16 v[0:15], v[64:67], v[184:187], 0
    ds_read_b64_tr_b16 v[176:177], v246 offset:0
    ds_read_b64_tr_b16 v[178:179], v246 offset:512
    ds_read_b64_tr_b16 v[180:181], v247 offset:0
    ds_read_b64_tr_b16 v[182:183], v247 offset:512
    s_mov_b32 m0, s71
    v_mfma_f32_32x32x16_bf16 v[16:31], v[68:71], v[184:187], 0
    buffer_load_dwordx4 v228, s[4:7], s47 offen lds
    buffer_load_dwordx4 v229, s[72:75], s47 offen offset:1024 lds
    v_permlane32_swap_b32 v238, v239
    v_permlane32_swap_b32 v242, v243
    v_add_f32 v238, v238, v239
    v_mfma_f32_32x32x16_bf16 v[32:47], v[64:67], v[188:191], 0
    v_add_f32 v242, v242, v243
    v_cvt_pk_bf16_f32 v234, v234, v242
    ds_write_b16 v230, v234 offset:384
    ds_write_b16_d16_hi v230, v234 offset:768
    v_mfma_f32_32x32x16_bf16 v[48:63], v[68:71], v[188:191], 0
    s_setprio 0
    v_mul_f32 v242, v0, v144
    v_fma_f32 v240, v8, v160, -v240
    v_fmac_f32 v242, v1, v145
    v_fmac_f32 v240, v9, v161
    v_fmac_f32 v242, v2, v146
    v_fmac_f32 v240, v10, v162
    v_fmac_f32 v242, v3, v147
    v_fmac_f32 v240, v11, v163
    v_fmac_f32 v242, v4, v148
    v_fmac_f32 v240, v12, v164
    v_fmac_f32 v242, v5, v149
    v_fmac_f32 v240, v13, v165
    v_fmac_f32 v242, v6, v150
    v_fmac_f32 v240, v14, v166
    v_fmac_f32 v242, v7, v151
    v_fmac_f32 v240, v15, v167
    s_sub_u32 s58, s48, s29
    v_add_u32 v249, s58, v249
    v_add_u32 v250, s58, v250
    v_fma_f32 v244, v16, v160, -v244
    v_fmac_f32 v236, v24, v112
    v_fmac_f32 v244, v17, v161
    v_fmac_f32 v236, v25, v113
    v_fmac_f32 v244, v18, v162
    v_fmac_f32 v236, v26, v114
    v_fmac_f32 v244, v19, v163
    v_fmac_f32 v236, v27, v115
    v_fmac_f32 v244, v20, v164
    v_fmac_f32 v236, v28, v116
    v_fmac_f32 v244, v21, v165
    v_fmac_f32 v236, v29, v117
    v_fmac_f32 v244, v22, v166
    v_fmac_f32 v236, v30, v118
    v_fmac_f32 v244, v23, v167
    v_fmac_f32 v236, v31, v119
    ds_read_b64_tr_b16 v[0:1], v249 offset:0
    ds_read_b64_tr_b16 v[2:3], v249 offset:128
    ds_read_b128 v[4:7], v250 offset:0
    ds_read_b128 v[8:11], v250 offset:16
    ds_read_b128 v[12:15], v250 offset:384
    ds_read_b128 v[16:19], v250 offset:400
    v_mul_f32 v243, v32, v152
    v_fma_f32 v241, v40, v168, -v241
    v_fmac_f32 v243, v33, v153
    v_fmac_f32 v241, v41, v169
    v_fmac_f32 v243, v34, v154
    v_fmac_f32 v241, v42, v170
    v_fmac_f32 v243, v35, v155
    v_fmac_f32 v241, v43, v171
    v_fmac_f32 v243, v36, v156
    v_fmac_f32 v241, v44, v172
    v_fmac_f32 v243, v37, v157
    v_fmac_f32 v241, v45, v173
    v_fmac_f32 v243, v38, v158
    v_fmac_f32 v241, v46, v174
    v_fmac_f32 v243, v39, v159
    v_fmac_f32 v241, v47, v175
    ds_read_b64_tr_b16 v[20:21], v249 offset:512
    ds_read_b64_tr_b16 v[22:23], v249 offset:640
    ds_read_b128 v[24:27], v250 offset:64
    ds_read_b128 v[28:31], v250 offset:80
    ds_read_b128 v[32:35], v250 offset:448
    ds_read_b128 v[36:39], v250 offset:464
    v_fma_f32 v245, v48, v168, -v245
    v_fmac_f32 v237, v56, v120
    v_fmac_f32 v245, v49, v169
    v_fmac_f32 v237, v57, v121
    v_fmac_f32 v245, v50, v170
    v_fmac_f32 v237, v58, v122
    v_fmac_f32 v245, v51, v171
    v_fmac_f32 v237, v59, v123
    v_fmac_f32 v245, v52, v172
    v_fmac_f32 v237, v60, v124
    v_fmac_f32 v245, v53, v173
    v_fmac_f32 v237, v61, v125
    v_fmac_f32 v245, v54, v174
    v_fmac_f32 v237, v62, v126
    v_fmac_f32 v245, v55, v175
    v_fmac_f32 v237, v63, v127
    s_cmp_eq_u32 s36, 0
    s_cbranch_scc1 K2_TAIL
    s_mov_b32 s29, s48
    s_mov_b32 s32, s31
    s_mov_b32 s30, s3
    s_mov_b32 s31, s35
    s_cmp_eq_u32 s33, 2
    s_cbranch_scc1 K2_U21
    s_cmp_eq_u32 s33, 3
    s_cbranch_scc1 K2_U31
    s_cmp_eq_u32 s33, 1
    s_cbranch_scc1 K2_U11
    s_branch K2_U41
K2_U41:
    s_setprio 1
    s_waitcnt lgkmcnt(10)
    v_lshlrev_b32 v40, 16, v0
    v_and_b32 v41, 0xffff0000, v0
    v_lshlrev_b32 v42, 16, v1
    v_and_b32 v43, 0xffff0000, v1
    v_lshlrev_b32 v44, 16, v2
    v_and_b32 v45, 0xffff0000, v2
    v_lshlrev_b32 v46, 16, v3
    v_and_b32 v47, 0xffff0000, v3
    s_waitcnt lgkmcnt(8)
    v_mul_f32 v4, v40, v4
    v_mul_f32 v5, v41, v5
    v_mul_f32 v6, v42, v6
    v_mul_f32 v7, v43, v7
    v_mul_f32 v8, v44, v8
    v_mul_f32 v9, v45, v9
    v_mul_f32 v10, v46, v10
    v_mul_f32 v11, v47, v11
    v_cvt_pk_bf16_f32 v64, v4, v5
    v_cvt_pk_bf16_f32 v65, v6, v7
    v_cvt_pk_bf16_f32 v66, v8, v9
    v_cvt_pk_bf16_f32 v67, v10, v11
    s_waitcnt lgkmcnt(6)
    v_mul_f32 v12, v40, v12
    v_mul_f32 v13, v41, v13
    v_mul_f32 v14, v42, v14
    v_mul_f32 v15, v43, v15
    v_mul_f32 v16, v44, v16
    v_mul_f32 v17, v45, v17
    v_mul_f32 v18, v46, v18
    v_mul_f32 v19, v47, v19
    v_cvt_pk_bf16_f32 v68, v12, v13
    v_cvt_pk_bf16_f32 v69, v14, v15
    v_cvt_pk_bf16_f32 v70, v16, v17
    v_cvt_pk_bf16_f32 v71, v18, v19
    ds_read_b64_tr_b16 v[0:1], v249 offset:1024
    ds_read_b64_tr_b16 v[2:3], v249 offset:1152
    ds_read_b128 v[4:7], v250 offset:128
    ds_read_b128 v[8:11], v250 offset:144
    ds_read_b128 v[12:15], v250 offset:512
    ds_read_b128 v[16:19], v250 offset:528
    s_waitcnt lgkmcnt(10)
    v_lshlrev_b32 v48, 16, v20
    v_and_b32 v49, 0xffff0000, v20
    v_lshlrev_b32 v50, 16, v21
    v_and_b32 v51, 0xffff0000, v21
    v_lshlrev_b32 v52, 16, v22
    v_and_b32 v53, 0xffff0000, v22
    v_lshlrev_b32 v54, 16, v23
    v_and_b32 v55, 0xffff0000, v23
    s_waitcnt lgkmcnt(8)
    v_mul_f32 v24, v48, v24
    v_mul_f32 v25, v49, v25
    v_mul_f32 v26, v50, v26
    v_mul_f32 v27, v51, v27
    v_mul_f32 v28, v52, v28
    v_mul_f32 v29, v53, v29
    v_mul_f32 v30, v54, v30
    v_mul_f32 v31, v55, v31
    v_cvt_pk_bf16_f32 v72, v24, v25
    v_cvt_pk_bf16_f32 v73, v26, v27
    v_cvt_pk_bf16_f32 v74, v28, v29
    v_cvt_pk_bf16_f32 v75, v30, v31
    s_waitcnt lgkmcnt(6)
    v_mul_f32 v32, v48, v32
    v_mul_f32 v33, v49, v33
    v_mul_f32 v34, v50, v34
    v_mul_f32 v35, v51, v35
    v_mul_f32 v36, v52, v36
    v_mul_f32 v37, v53, v37
    v_mul_f32 v38, v54, v38
    v_mul_f32 v39, v55, v39
    v_cvt_pk_bf16_f32 v76, v32, v33
    v_cvt_pk_bf16_f32 v77, v34, v35
    v_cvt_pk_bf16_f32 v78, v36, v37
    v_cvt_pk_bf16_f32 v79, v38, v39
    s_lshr_b32 s65, s30, 27
    s_mov_b32 s66, 161536
    s_cmp_ge_u32 s65, 2
    s_cselect_b32 s66, 158112, s66
    s_mul_i32 s65, s65, 512
    s_add_u32 s65, s65, s66
    s_sub_u32 s65, s65, s29
    v_add_u32 v56, s65, v249
    s_lshr_b32 s65, s30, 27
    s_mov_b32 s66, 161536
    s_cmp_ge_u32 s65, 2
    s_cselect_b32 s66, 159008, s66
    s_mul_i32 s65, s65, 64
    s_add_u32 s65, s65, s66
    s_sub_u32 s65, s65, s29
    v_add_u32 v57, s65, v250
    ds_read_b64_tr_b16 v[20:21], v56 offset:0
    ds_read_b64_tr_b16 v[22:23], v56 offset:128
    ds_read_b128 v[24:27], v57 offset:0
    ds_read_b128 v[28:31], v57 offset:16
    ds_read_b128 v[32:35], v57 offset:384
    ds_read_b128 v[36:39], v57 offset:400
    s_waitcnt lgkmcnt(10)
    v_lshlrev_b32 v40, 16, v0
    v_and_b32 v41, 0xffff0000, v0
    v_lshlrev_b32 v42, 16, v1
    v_and_b32 v43, 0xffff0000, v1
    v_lshlrev_b32 v44, 16, v2
    v_and_b32 v45, 0xffff0000, v2
    v_lshlrev_b32 v46, 16, v3
    v_and_b32 v47, 0xffff0000, v3
    s_waitcnt lgkmcnt(8)
    v_mul_f32 v4, v40, v4
    v_mul_f32 v5, v41, v5
    v_mul_f32 v6, v42, v6
    v_mul_f32 v7, v43, v7
    v_mul_f32 v8, v44, v8
    v_mul_f32 v9, v45, v9
    v_mul_f32 v10, v46, v10
    v_mul_f32 v11, v47, v11
    v_cvt_pk_bf16_f32 v80, v4, v5
    v_cvt_pk_bf16_f32 v81, v6, v7
    v_cvt_pk_bf16_f32 v82, v8, v9
    v_cvt_pk_bf16_f32 v83, v10, v11
    s_waitcnt lgkmcnt(6)
    v_mul_f32 v12, v40, v12
    v_mul_f32 v13, v41, v13
    v_mul_f32 v14, v42, v14
    v_mul_f32 v15, v43, v15
    v_mul_f32 v16, v44, v16
    v_mul_f32 v17, v45, v17
    v_mul_f32 v18, v46, v18
    v_mul_f32 v19, v47, v19
    v_cvt_pk_bf16_f32 v84, v12, v13
    v_cvt_pk_bf16_f32 v85, v14, v15
    v_cvt_pk_bf16_f32 v86, v16, v17
    v_cvt_pk_bf16_f32 v87, v18, v19
    s_waitcnt lgkmcnt(4)
    v_lshlrev_b32 v48, 16, v20
    v_and_b32 v49, 0xffff0000, v20
    v_lshlrev_b32 v50, 16, v21
    v_and_b32 v51, 0xffff0000, v21
    v_lshlrev_b32 v52, 16, v22
    v_and_b32 v53, 0xffff0000, v22
    v_lshlrev_b32 v54, 16, v23
    v_and_b32 v55, 0xffff0000, v23
    s_waitcnt lgkmcnt(2)
    v_mul_f32 v24, v48, v24
    v_mul_f32 v25, v49, v25
    v_mul_f32 v26, v50, v26
    v_mul_f32 v27, v51, v27
    v_mul_f32 v28, v52, v28
    v_mul_f32 v29, v53, v29
    v_mul_f32 v30, v54, v30
    v_mul_f32 v31, v55, v31
    v_cvt_pk_bf16_f32 v88, v24, v25
    v_cvt_pk_bf16_f32 v89, v26, v27
    v_cvt_pk_bf16_f32 v90, v28, v29
    v_cvt_pk_bf16_f32 v91, v30, v31
    s_waitcnt lgkmcnt(0)
    v_mul_f32 v32, v48, v32
    v_mul_f32 v33, v49, v33
    v_mul_f32 v34, v50, v34
    v_mul_f32 v35, v51, v35
    v_mul_f32 v36, v52, v36
    v_mul_f32 v37, v53, v37
    v_mul_f32 v38, v54, v38
    v_mul_f32 v39, v55, v39
    v_cvt_pk_bf16_f32 v92, v32, v33
    v_cvt_pk_bf16_f32 v93, v34, v35
    v_cvt_pk_bf16_f32 v94, v36, v37
    v_cvt_pk_bf16_f32 v95, v38, v39
    s_waitcnt vmcnt(4)
    v_mfma_f32_32x32x16_bf16 v[0:15], v[64:67], v[176:179], 0
    ds_read_b64_tr_b16 v[184:185], v246 offset:2048
    ds_read_b64_tr_b16 v[186:187], v246 offset:2560
    ds_read_b64_tr_b16 v[188:189], v247 offset:2048
    ds_read_b64_tr_b16 v[190:191], v247 offset:2560
    s_mov_b32 m0, s68
    v_mfma_f32_32x32x16_bf16 v[16:31], v[68:71], v[176:179], 0
    buffer_load_dwordx4 v222, s[4:7], s41 offen lds
    buffer_load_dwordx4 v223, s[72:75], s41 offen offset:1024 lds
    v_permlane32_swap_b32 v242, v243
    v_permlane32_swap_b32 v240, v241
    v_mov_b32 v254, 163648
    v_mfma_f32_32x32x16_bf16 v[32:47], v[64:67], v[180:183], 0
    v_permlane32_swap_b32 v236, v237
    v_permlane32_swap_b32 v244, v245
    v_add_f32 v242, v242, v243
    v_add_f32 v240, -v240, -v241
    v_add_f32 v236, v236, v237
    v_mfma_f32_32x32x16_bf16 v[48:63], v[68:71], v[180:183], 0
    v_add_f32 v244, v244, v245
    v_cvt_pk_bf16_f32 v242, v242, v236
    v_cvt_pk_bf16_f32 v244, v244, v240
    v_cvt_pk_bf16_f32 v238, v238, v238
    ds_write_b16 v230, v242 offset:1152
    ds_write_b16_d16_hi v230, v242 offset:128
    v_mov_b32 v255, 1
    v_lshl_add_u32 v233, v252, 1, s53
    s_mov_b64 exec, 1
    ds_add_rtn_u32 v232, v254, v255
    s_mov_b64 exec, -1
    ds_read_b32 v233, v233
    s_waitcnt vmcnt(4) lgkmcnt(4)
    v_mfma_f32_32x32x16_bf16 v[0:15], v[72:75], v[184:187], v[0:15]
    ds_read_b64_tr_b16 v[176:177], v246 offset:4096
    ds_read_b64_tr_b16 v[178:179], v246 offset:4608
    ds_read_b64_tr_b16 v[180:181], v247 offset:4096
    ds_read_b64_tr_b16 v[182:183], v247 offset:4608
    ds_write_b16 v230, v244 offset:512
    ds_write_b16_d16_hi v230, v244 offset:896
    s_mov_b32 m0, s69
    v_mfma_f32_32x32x16_bf16 v[16:31], v[76:79], v[184:187], v[16:31]
    buffer_load_dwordx4 v224, s[4:7], s41 offen lds
    buffer_load_dwordx4 v225, s[72:75], s41 offen offset:1024 lds
    ds_write_b16 v230, v238 offset:1280
    s_waitcnt lgkmcnt(7)
    v_readfirstlane_b32 s58, v232
    v_mfma_f32_32x32x16_bf16 v[32:47], v[72:75], v[188:191], v[32:47]
    s_cmp_lt_u32 s58, s22
    s_cbranch_scc0 K2_nul_101
    s_and_b32 s59, s58, 7
    s_lshr_b32 s60, s58, 3
K2_chk_103:
    v_readlane_b32 s61, v233, s59
    s_nop 0
    s_cmp_gt_u32 s61, s60
    s_cbranch_scc0 K2_spin_102
K2_back_104:
    v_mfma_f32_32x32x16_bf16 v[48:63], v[76:79], v[188:191], v[48:63]
    v_readlane_b32 s3, v253, s58
    s_lshl_b32 s44, s34, 7
    s_lshl_b32 s60, s58, 5
    s_and_b32 s48, s3, 0x3ffff
    s_bfe_u32 s33, s3, 0x30012
    s_sub_u32 s60, s60, s48
    s_waitcnt vmcnt(4) lgkmcnt(3)
    v_mfma_f32_32x32x16_bf16 v[0:15], v[80:83], v[176:179], v[0:15]
    ds_read_b64_tr_b16 v[184:185], v246 offset:6144
    ds_read_b64_tr_b16 v[186:187], v246 offset:6656
    ds_read_b64_tr_b16 v[188:189], v247 offset:6144
    ds_read_b64_tr_b16 v[190:191], v247 offset:6656
    s_and_b32 s60, s60, 0xff
    s_add_u32 s35, s60, s48
    s_mov_b32 m0, s70
    v_mfma_f32_32x32x16_bf16 v[16:31], v[84:87], v[176:179], v[16:31]
    buffer_load_dwordx4 v226, s[4:7], s41 offen lds
    buffer_load_dwordx4 v227, s[72:75], s41 offen offset:1024 lds
    s_mov_b32 s45, s44
    s_add_u32 s47, s44, 256
    s_add_u32 s49, s48, 32
    s_add_u32 s60, s48, 64
    v_mfma_f32_32x32x16_bf16 v[32:47], v[80:83], v[180:183], v[32:47]
    s_cmp_eq_u32 s33, 3
    s_cselect_b32 s46, s44, s47
    s_cselect_b32 s50, s60, s48
    s_cselect_b32 s51, s48, s49
    s_sub_u32 s60, s33, 2
    s_cmp_lt_u32 s60, 2
    s_cbranch_scc0 K2_rare_105
K2_back_106:
    v_mfma_f32_32x32x16_bf16 v[48:63], v[84:87], v[180:183], v[48:63]
    s_waitcnt vmcnt(4) lgkmcnt(0)
    v_mfma_f32_32x32x16_bf16 v[0:15], v[88:91], v[184:187], v[0:15]
    ds_read_b64_tr_b16 v[176:177], v246 offset:0
    ds_read_b64_tr_b16 v[178:179], v246 offset:512
    ds_read_b64_tr_b16 v[180:181], v247 offset:0
    ds_read_b64_tr_b16 v[182:183], v247 offset:512
    s_mov_b32 m0, s71
    v_mfma_f32_32x32x16_bf16 v[16:31], v[92:95], v[184:187], v[16:31]
    buffer_load_dwordx4 v228, s[4:7], s41 offen lds
    buffer_load_dwordx4 v229, s[72:75], s41 offen offset:1024 lds
    v_mfma_f32_32x32x16_bf16 v[32:47], v[88:91], v[188:191], v[32:47]
    s_nop 2
    v_mul_f32 v234, v0, v96
    v_mul_f32 v236, v8, v128
    v_fmac_f32 v234, v1, v97
    v_fmac_f32 v236, v9, v129
    v_fmac_f32 v234, v2, v98
    v_fmac_f32 v236, v10, v130
    v_fmac_f32 v234, v3, v99
    v_mfma_f32_32x32x16_bf16 v[48:63], v[92:95], v[188:191], v[48:63]
    s_setprio 0
    v_fmac_f32 v236, v11, v131
    v_fmac_f32 v234, v4, v100
    v_fmac_f32 v236, v12, v132
    v_fmac_f32 v234, v5, v101
    v_fmac_f32 v236, v13, v133
    v_fmac_f32 v234, v6, v102
    v_fmac_f32 v236, v14, v134
    v_fmac_f32 v234, v7, v103
    v_fmac_f32 v236, v15, v135
    v_mul_f32 v238, v16, v128
    v_mul_f32 v240, v24, v128
    v_fmac_f32 v238, v17, v129
    v_fmac_f32 v240, v25, v129
    v_fmac_f32 v238, v18, v130
    v_fmac_f32 v240, v26, v130
    v_fmac_f32 v238, v19, v131
    v_fmac_f32 v240, v27, v131
    v_fmac_f32 v238, v20, v132
    v_fmac_f32 v240, v28, v132
    v_fmac_f32 v238, v21, v133
    v_fmac_f32 v240, v29, v133
    v_fmac_f32 v238, v22, v134
    v_fmac_f32 v240, v30, v134
    v_fmac_f32 v238, v23, v135
    v_fmac_f32 v240, v31, v135
    v_mul_f32 v235, v32, v104
    v_mul_f32 v237, v40, v136
    v_fmac_f32 v235, v33, v105
    v_fmac_f32 v237, v41, v137
    v_fmac_f32 v235, v34, v106
    v_fmac_f32 v237, v42, v138
    v_fmac_f32 v235, v35, v107
    v_fmac_f32 v237, v43, v139
    v_fmac_f32 v235, v36, v108
    v_fmac_f32 v237, v44, v140
    v_fmac_f32 v235, v37, v109
    v_fmac_f32 v237, v45, v141
    v_fmac_f32 v235, v38, v110
    v_fmac_f32 v237, v46, v142
    v_fmac_f32 v235, v39, v111
    v_fmac_f32 v237, v47, v143
    v_mul_f32 v239, v48, v136
    v_mul_f32 v241, v56, v136
    s_setprio 1
    s_waitcnt vmcnt(4) lgkmcnt(0)
    v_mfma_f32_32x32x16_bf16 v[0:15], v[64:67], v[176:179], 0
    ds_read_b64_tr_b16 v[184:185], v246 offset:2048
    ds_read_b64_tr_b16 v[186:187], v246 offset:2560
    ds_read_b64_tr_b16 v[188:189], v247 offset:2048
    ds_read_b64_tr_b16 v[190:191], v247 offset:2560
    v_fmac_f32 v239, v49, v137
    v_fmac_f32 v241, v57, v137
    s_mov_b32 m0, s68
    v_mfma_f32_32x32x16_bf16 v[16:31], v[68:71], v[176:179], 0
    buffer_load_dwordx4 v222, s[4:7], s42 offen lds
    buffer_load_dwordx4 v223, s[72:75], s42 offen offset:1024 lds
    v_fmac_f32 v239, v50, v138
    v_fmac_f32 v241, v58, v138
    v_fmac_f32 v239, v51, v139
    v_fmac_f32 v241, v59, v139
    v_fmac_f32 v239, v52, v140
    v_mfma_f32_32x32x16_bf16 v[32:47], v[64:67], v[180:183], 0
    v_fmac_f32 v241, v60, v140
    v_fmac_f32 v239, v53, v141
    v_fmac_f32 v241, v61, v141
    v_fmac_f32 v239, v54, v142
    v_fmac_f32 v241, v62, v142
    v_fmac_f32 v239, v55, v143
    v_fmac_f32 v241, v63, v143
    v_mfma_f32_32x32x16_bf16 v[48:63], v[68:71], v[180:183], 0
    v_permlane32_swap_b32 v234, v235
    v_permlane32_swap_b32 v236, v237
    v_permlane32_swap_b32 v238, v239
    s_waitcnt vmcnt(4) lgkmcnt(0)
    v_mfma_f32_32x32x16_bf16 v[0:15], v[72:75], v[184:187], v[0:15]
    ds_read_b64_tr_b16 v[176:177], v246 offset:4096
    ds_read_b64_tr_b16 v[178:179], v246 offset:4608
    ds_read_b64_tr_b16 v[180:181], v247 offset:4096
    ds_read_b64_tr_b16 v[182:183], v247 offset:4608
    v_permlane32_swap_b32 v240, v241
    s_mov_b32 m0, s69
    v_mfma_f32_32x32x16_bf16 v[16:31], v[76:79], v[184:187], v[16:31]
    buffer_load_dwordx4 v224, s[4:7], s42 offen lds
    buffer_load_dwordx4 v225, s[72:75], s42 offen offset:1024 lds
    v_add_u32 v230, s31, v252
    v_add_f32 v234, v234, v235
    v_add_f32 v236, v236, v237
    v_add_f32 v238, v238, v239
    v_add_f32 v240, v240, v241
    v_mfma_f32_32x32x16_bf16 v[32:47], v[72:75], v[188:191], v[32:47]
    v_cvt_pk_bf16_f32 v234, v234, v236
    v_cvt_pk_bf16_f32 v238, v238, v240
    ds_write_b16 v230, v234 offset:0
    ds_write_b16_d16_hi v230, v234 offset:256
    ds_write_b16 v230, v238 offset:640
    ds_write_b16_d16_hi v230, v238 offset:1024
    v_mfma_f32_32x32x16_bf16 v[48:63], v[76:79], v[188:191], v[48:63]
    s_waitcnt vmcnt(4) lgkmcnt(4)
    v_mfma_f32_32x32x16_bf16 v[0:15], v[80:83], v[176:179], v[0:15]
    ds_read_b64_tr_b16 v[184:185], v246 offset:6144
    ds_read_b64_tr_b16 v[186:187], v246 offset:6656
    ds_read_b64_tr_b16 v[188:189], v247 offset:6144
    ds_read_b64_tr_b16 v[190:191], v247 offset:6656
    s_mov_b32 m0, s70
    v_mfma_f32_32x32x16_bf16 v[16:31], v[84:87], v[176:179], v[16:31]
    buffer_load_dwordx4 v226, s[4:7], s42 offen lds
    buffer_load_dwordx4 v227, s[72:75], s42 offen offset:1024 lds
    v_mfma_f32_32x32x16_bf16 v[32:47], v[80:83], v[180:183], v[32:47]
    v_mfma_f32_32x32x16_bf16 v[48:63], v[84:87], v[180:183], v[48:63]
    s_waitcnt vmcnt(4) lgkmcnt(0)
    v_mfma_f32_32x32x16_bf16 v[0:15], v[88:91], v[184:187], v[0:15]
    ds_read_b64_tr_b16 v[176:177], v246 offset:0
    ds_read_b64_tr_b16 v[178:179], v246 offset:512
    ds_read_b64_tr_b16 v[180:181], v247 offset:0
    ds_read_b64_tr_b16 v[182:183], v247 offset:512
    s_mov_b32 m0, s71
    v_mfma_f32_32x32x16_bf16 v[16:31], v[92:95], v[184:187], v[16:31]
    buffer_load_dwordx4 v228, s[4:7], s42 offen lds
    buffer_load_dwordx4 v229, s[72:75], s42 offen offset:1024 lds
    v_mfma_f32_32x32x16_bf16 v[32:47], v[88:91], v[188:191], v[32:47]
    s_nop 2
    v_mul_f32 v234, v0, v144
    v_mul_f32 v236, v8, v112
    v_fmac_f32 v234, v1, v145
    v_fmac_f32 v236, v9, v113
    v_fmac_f32 v234, v2, v146
    v_fmac_f32 v236, v10, v114
    v_fmac_f32 v234, v3, v147
    v_mfma_f32_32x32x16_bf16 v[48:63], v[92:95], v[188:191], v[48:63]
    s_setprio 0
    v_fmac_f32 v236, v11, v115
    v_fmac_f32 v234, v4, v148
    v_fmac_f32 v236, v12, v116
    v_fmac_f32 v234, v5, v149
    v_fmac_f32 v236, v13, v117
    v_fmac_f32 v234, v6, v150
    v_fmac_f32 v236, v14, v118
    v_fmac_f32 v234, v7, v151
    v_fmac_f32 v236, v15, v119
    v_mul_f32 v238, v16, v160
    v_mul_f32 v240, v24, v160
    v_fmac_f32 v238, v17, v161
    v_fmac_f32 v240, v25, v161
    v_fmac_f32 v238, v18, v162
    v_fmac_f32 v240, v26, v162
    v_fmac_f32 v238, v19, v163
    v_fmac_f32 v240, v27, v163
    v_fmac_f32 v238, v20, v164
    v_fmac_f32 v240, v28, v164
    v_fmac_f32 v238, v21, v165
    v_fmac_f32 v240, v29, v165
    v_fmac_f32 v238, v22, v166
    v_fmac_f32 v240, v30, v166
    v_fmac_f32 v238, v23, v167
    v_fmac_f32 v240, v31, v167
    v_mul_f32 v235, v32, v152
    v_mul_f32 v237, v40, v120
    v_fmac_f32 v235, v33, v153
    v_fmac_f32 v237, v41, v121
    v_fmac_f32 v235, v34, v154
    v_fmac_f32 v237, v42, v122
    v_fmac_f32 v235, v35, v155
    v_fmac_f32 v237, v43, v123
    v_fmac_f32 v235, v36, v156
    v_fmac_f32 v237, v44, v124
    v_fmac_f32 v235, v37, v157
    v_fmac_f32 v237, v45, v125
    v_fmac_f32 v235, v38, v158
    v_fmac_f32 v237, v46, v126
    v_fmac_f32 v235, v39, v159
    v_fmac_f32 v237, v47, v127
    v_mul_f32 v239, v48, v168
    v_mul_f32 v241, v56, v168
    s_setprio 1
    s_waitcnt vmcnt(4) lgkmcnt(0)
    v_mfma_f32_32x32x16_bf16 v[0:15], v[64:67], v[176:179], 0
    ds_read_b64_tr_b16 v[184:185], v246 offset:2048
    ds_read_b64_tr_b16 v[186:187], v246 offset:2560
    ds_read_b64_tr_b16 v[188:189], v247 offset:2048
    ds_read_b64_tr_b16 v[190:191], v247 offset:2560
    v_fmac_f32 v239, v49, v169
    v_fmac_f32 v241, v57, v169
    s_mov_b32 m0, s68
    v_mfma_f32_32x32x16_bf16 v[16:31], v[68:71], v[176:179], 0
    buffer_load_dwordx4 v222, s[4:7], s43 offen lds
    buffer_load_dwordx4 v223, s[72:75], s43 offen offset:1024 lds
    v_fmac_f32 v239, v50, v170
    v_fmac_f32 v241, v58, v170
    v_fmac_f32 v239, v51, v171
    v_fmac_f32 v241, v59, v171
    v_fmac_f32 v239, v52, v172
    v_mfma_f32_32x32x16_bf16 v[32:47], v[64:67], v[180:183], 0
    v_fmac_f32 v241, v60, v172
    v_fmac_f32 v239, v53, v173
    v_fmac_f32 v241, v61, v173
    v_fmac_f32 v239, v54, v174
    v_fmac_f32 v241, v62, v174
    v_fmac_f32 v239, v55, v175
    v_fmac_f32 v241, v63, v175
    v_mfma_f32_32x32x16_bf16 v[48:63], v[68:71], v[180:183], 0
    v_permlane32_swap_b32 v234, v235
    v_add_f32 v234, v234, v235
    s_waitcnt vmcnt(4) lgkmcnt(0)
    v_mfma_f32_32x32x16_bf16 v[0:15], v[72:75], v[184:187], v[0:15]
    ds_read_b64_tr_b16 v[176:177], v246 offset:4096
    ds_read_b64_tr_b16 v[178:179], v246 offset:4608
    ds_read_b64_tr_b16 v[180:181], v247 offset:4096
    ds_read_b64_tr_b16 v[182:183], v247 offset:4608
    s_mov_b32 m0, s69
    v_mfma_f32_32x32x16_bf16 v[16:31], v[76:79], v[184:187], v[16:31]
    buffer_load_dwordx4 v224, s[4:7], s43 offen lds
    buffer_load_dwordx4 v225, s[72:75], s43 offen offset:1024 lds
    v_mfma_f32_32x32x16_bf16 v[32:47], v[72:75], v[188:191], v[32:47]
    v_mfma_f32_32x32x16_bf16 v[48:63], v[76:79], v[188:191], v[48:63]
    s_waitcnt vmcnt(4) lgkmcnt(0)
    v_mfma_f32_32x32x16_bf16 v[0:15], v[80:83], v[176:179], v[0:15]
    ds_read_b64_tr_b16 v[184:185], v246 offset:6144
    ds_read_b64_tr_b16 v[186:187], v246 offset:6656
    ds_read_b64_tr_b16 v[188:189], v247 offset:6144
    ds_read_b64_tr_b16 v[190:191], v247 offset:6656
    s_mov_b32 m0, s70
    v_mfma_f32_32x32x16_bf16 v[16:31], v[84:87], v[176:179], v[16:31]
    buffer_load_dwordx4 v226, s[4:7], s43 offen lds
    buffer_load_dwordx4 v227, s[72:75], s43 offen offset:1024 lds
    v_mfma_f32_32x32x16_bf16 v[32:47], v[80:83], v[180:183], v[32:47]
    v_add_u32 v222, s48, v251
    ds_read_b32 v222, v222
    v_mfma_f32_32x32x16_bf16 v[48:63], v[84:87], v[180:183], v[48:63]
    s_waitcnt vmcnt(4) lgkmcnt(1)
    v_mfma_f32_32x32x16_bf16 v[0:15], v[88:91], v[184:187], v[0:15]
    ds_read_b64_tr_b16 v[176:177], v246 offset:0
    ds_read_b64_tr_b16 v[178:179], v246 offset:512
    ds_read_b64_tr_b16 v[180:181], v247 offset:0
    ds_read_b64_tr_b16 v[182:183], v247 offset:512
    s_mov_b32 m0, s71
    v_mfma_f32_32x32x16_bf16 v[16:31], v[92:95], v[184:187], v[16:31]
    buffer_load_dwordx4 v228, s[4:7], s43 offen lds
    buffer_load_dwordx4 v229, s[72:75], s43 offen offset:1024 lds
    s_waitcnt lgkmcnt(4)
    v_mad_u32_u16 v223, v222, s39, v248 op_sel:[1,0,0,0]
    v_mad_u32_u16 v222, v222, s39, v248
    v_mfma_f32_32x32x16_bf16 v[32:47], v[88:91], v[188:191], v[32:47]
    v_add_u32 v224, s49, v251
    ds_read_b32 v224, v224
    v_mul_f32 v242, v0, v144
    v_fma_f32 v238, v8, v160, -v238
    v_fmac_f32 v242, v1, v145
    v_fmac_f32 v238, v9, v161
    v_fmac_f32 v242, v2, v146
    v_mfma_f32_32x32x16_bf16 v[48:63], v[92:95], v[188:191], v[48:63]
    s_setprio 0
    v_fmac_f32 v238, v10, v162
    v_fmac_f32 v242, v3, v147
    v_fmac_f32 v238, v11, v163
    v_fmac_f32 v242, v4, v148
    v_fmac_f32 v238, v12, v164
    v_fmac_f32 v242, v5, v149
    v_fmac_f32 v238, v13, v165
    v_fmac_f32 v242, v6, v150
    v_fmac_f32 v238, v14, v166
    v_fmac_f32 v242, v7, v151
    v_fmac_f32 v238, v15, v167
    v_fmac_f32 v236, v16, v112
    v_mul_f32 v244, v24, v160
    v_fmac_f32 v236, v17, v113
    v_fmac_f32 v244, v25, v161
    v_fmac_f32 v236, v18, v114
    v_fmac_f32 v244, v26, v162
    v_fmac_f32 v236, v19, v115
    v_fmac_f32 v244, v27, v163
    v_fmac_f32 v236, v20, v116
    v_fmac_f32 v244, v28, v164
    v_fmac_f32 v236, v21, v117
    v_fmac_f32 v244, v29, v165
    v_fmac_f32 v236, v22, v118
    v_fmac_f32 v244, v30, v166
    v_fmac_f32 v236, v23, v119
    v_fmac_f32 v244, v31, v167
    v_mul_f32 v243, v32, v152
    v_fma_f32 v239, v40, v168, -v239
    v_fmac_f32 v243, v33, v153
    v_fmac_f32 v239, v41, v169
    v_fmac_f32 v243, v34, v154
    v_fmac_f32 v239, v42, v170
    v_fmac_f32 v243, v35, v155
    v_fmac_f32 v239, v43, v171
    v_fmac_f32 v243, v36, v156
    v_fmac_f32 v239, v44, v172
    v_fmac_f32 v243, v37, v157
    v_fmac_f32 v239, v45, v173
    v_fmac_f32 v243, v38, v158
    v_fmac_f32 v239, v46, v174
    v_fmac_f32 v243, v39, v159
    v_fmac_f32 v239, v47, v175
    v_fmac_f32 v237, v48, v120
    v_mul_f32 v245, v56, v168
    v_fmac_f32 v237, v49, v121
    v_fmac_f32 v245, v57, v169
    v_fmac_f32 v237, v50, v122
    v_fmac_f32 v245, v58, v170
    v_fmac_f32 v237, v51, v123
    s_setprio 1
    s_waitcnt vmcnt(4) lgkmcnt(1)
    v_mfma_f32_32x32x16_bf16 v[0:15], v[64:67], v[176:179], 0
    ds_read_b64_tr_b16 v[184:185], v246 offset:2048
    ds_read_b64_tr_b16 v[186:187], v246 offset:2560
    ds_read_b64_tr_b16 v[188:189], v247 offset:2048
    ds_read_b64_tr_b16 v[190:191], v247 offset:2560
    v_fmac_f32 v245, v59, v171
    v_fmac_f32 v237, v52, v124
    s_mov_b32 m0, s68
    v_mfma_f32_32x32x16_bf16 v[16:31], v[68:71], v[176:179], 0
    buffer_load_dwordx4 v222, s[4:7], s44 offen lds
    buffer_load_dwordx4 v223, s[72:75], s44 offen offset:1024 lds
    s_waitcnt lgkmcnt(4)
    v_mad_u32_u16 v225, v224, s39, v248 op_sel:[1,0,0,0]
    v_mad_u32_u16 v224, v224, s39, v248
    v_fmac_f32 v245, v60, v172
    v_fmac_f32 v237, v53, v125
    v_mfma_f32_32x32x16_bf16 v[32:47], v[64:67], v[180:183], 0
    v_add_u32 v226, s50, v251
    ds_read_b32 v226, v226
    v_fmac_f32 v245, v61, v173
    v_fmac_f32 v237, v54, v126
    v_fmac_f32 v245, v62, v174
    v_fmac_f32 v237, v55, v127
    v_fmac_f32 v245, v63, v175
    v_mfma_f32_32x32x16_bf16 v[48:63], v[68:71], v[180:183], 0
    v_permlane32_swap_b32 v238, v239
    v_permlane32_swap_b32 v242, v243
    v_add_f32 v238, v238, v239
    v_add_f32 v242, v242, v243
    s_waitcnt vmcnt(4) lgkmcnt(1)
    v_mfma_f32_32x32x16_bf16 v[0:15], v[72:75], v[184:187], v[0:15]
    ds_read_b64_tr_b16 v[176:177], v246 offset:4096
    ds_read_b64_tr_b16 v[178:179], v246 offset:4608
    ds_read_b64_tr_b16 v[180:181], v247 offset:4096
    ds_read_b64_tr_b16 v[182:183], v247 offset:4608
    v_cvt_pk_bf16_f32 v234, v234, v242
    ds_write_b16 v230, v234 offset:384
    s_mov_b32 m0, s69
    v_mfma_f32_32x32x16_bf16 v[16:31], v[76:79], v[184:187], v[16:31]
    buffer_load_dwordx4 v224, s[4:7], s45 offen lds
    buffer_load_dwordx4 v225, s[72:75], s45 offen offset:1024 lds
    s_waitcnt lgkmcnt(5)
    v_mad_u32_u16 v227, v226, s39, v248 op_sel:[1,0,0,0]
    v_mad_u32_u16 v226, v226, s39, v248
    ds_write_b16_d16_hi v230, v234 offset:768
    v_mfma_f32_32x32x16_bf16 v[32:47], v[72:75], v[188:191], v[32:47]
    v_add_u32 v228, s51, v251
    ds_read_b32 v228, v228
    v_mfma_f32_32x32x16_bf16 v[48:63], v[76:79], v[188:191], v[48:63]
    s_waitcnt vmcnt(4) lgkmcnt(3)
    v_mfma_f32_32x32x16_bf16 v[0:15], v[80:83], v[176:179], v[0:15]
    ds_read_b64_tr_b16 v[184:185], v246 offset:6144
    ds_read_b64_tr_b16 v[186:187], v246 offset:6656
    ds_read_b64_tr_b16 v[188:189], v247 offset:6144
    ds_read_b64_tr_b16 v[190:191], v247 offset:6656
    s_mov_b32 m0, s70
    v_mfma_f32_32x32x16_bf16 v[16:31], v[84:87], v[176:179], v[16:31]
    buffer_load_dwordx4 v226, s[4:7], s46 offen lds
    buffer_load_dwordx4 v227, s[72:75], s46 offen offset:1024 lds
    s_waitcnt lgkmcnt(4)
    v_mad_u32_u16 v229, v228, s39, v248 op_sel:[1,0,0,0]
    v_mad_u32_u16 v228, v228, s39, v248
    v_mfma_f32_32x32x16_bf16 v[32:47], v[80:83], v[180:183], v[32:47]
    v_mfma_f32_32x32x16_bf16 v[48:63], v[84:87], v[180:183], v[48:63]
    s_waitcnt vmcnt(4) lgkmcnt(0)
    v_mfma_f32_32x32x16_bf16 v[0:15], v[88:91], v[184:187], v[0:15]
    ds_read_b64_tr_b16 v[176:177], v246 offset:0
    ds_read_b64_tr_b16 v[178:179], v246 offset:512
    ds_read_b64_tr_b16 v[180:181], v247 offset:0
    ds_read_b64_tr_b16 v[182:183], v247 offset:512
    s_mov_b32 m0, s71
    v_mfma_f32_32x32x16_bf16 v[16:31], v[92:95], v[184:187], v[16:31]
    buffer_load_dwordx4 v228, s[4:7], s47 offen lds
    buffer_load_dwordx4 v229, s[72:75], s47 offen offset:1024 lds
    v_mfma_f32_32x32x16_bf16 v[32:47], v[88:91], v[188:191], v[32:47]
    s_nop 2
    v_mul_f32 v242, v0, v144
    v_fma_f32 v240, v8, v160, -v240
    v_fmac_f32 v242, v1, v145
    v_fmac_f32 v240, v9, v161
    v_fmac_f32 v242, v2, v146
    v_fmac_f32 v240, v10, v162
    v_fmac_f32 v242, v3, v147
    v_mfma_f32_32x32x16_bf16 v[48:63], v[92:95], v[188:191], v[48:63]
    s_setprio 0
    v_fmac_f32 v240, v11, v163
    v_fmac_f32 v242, v4, v148
    v_fmac_f32 v240, v12, v164
    v_fmac_f32 v242, v5, v149
    v_fmac_f32 v240, v13, v165
    v_fmac_f32 v242, v6, v150
    v_fmac_f32 v240, v14, v166
    v_fmac_f32 v242, v7, v151
    v_fmac_f32 v240, v15, v167
    s_sub_u32 s58, s48, s29
    v_add_u32 v249, s58, v249
    v_add_u32 v250, s58, v250
    v_fma_f32 v244, v16, v160, -v244
    v_fmac_f32 v236, v24, v112
    v_fmac_f32 v244, v17, v161
    v_fmac_f32 v236, v25, v113
    v_fmac_f32 v244, v18, v162
    v_fmac_f32 v236, v26, v114
    v_fmac_f32 v244, v19, v163
    v_fmac_f32 v236, v27, v115
    v_fmac_f32 v244, v20, v164
    v_fmac_f32 v236, v28, v116
    v_fmac_f32 v244, v21, v165
    v_fmac_f32 v236, v29, v117
    v_fmac_f32 v244, v22, v166
    v_fmac_f32 v236, v30, v118
    v_fmac_f32 v244, v23, v167
    v_fmac_f32 v236, v31, v119
    ds_read_b64_tr_b16 v[0:1], v249 offset:0
    ds_read_b64_tr_b16 v[2:3], v249 offset:128
    ds_read_b128 v[4:7], v250 offset:0
    ds_read_b128 v[8:11], v250 offset:16
    ds_read_b128 v[12:15], v250 offset:384
    ds_read_b128 v[16:19], v250 offset:400
    v_mul_f32 v243, v32, v152
    v_fma_f32 v241, v40, v168, -v241
    v_fmac_f32 v243, v33, v153
    v_fmac_f32 v241, v41, v169
    v_fmac_f32 v243, v34, v154
    v_fmac_f32 v241, v42, v170
    v_fmac_f32 v243, v35, v155
    v_fmac_f32 v241, v43, v171
    v_fmac_f32 v243, v36, v156
    v_fmac_f32 v241, v44, v172
    v_fmac_f32 v243, v37, v157
    v_fmac_f32 v241, v45, v173
    v_fmac_f32 v243, v38, v158
    v_fmac_f32 v241, v46, v174
    v_fmac_f32 v243, v39, v159
    v_fmac_f32 v241, v47, v175
    ds_read_b64_tr_b16 v[20:21], v249 offset:512
    ds_read_b64_tr_b16 v[22:23], v249 offset:640
    ds_read_b128 v[24:27], v250 offset:64
    ds_read_b128 v[28:31], v250 offset:80
    ds_read_b128 v[32:35], v250 offset:448
    ds_read_b128 v[36:39], v250 offset:464
    v_fma_f32 v245, v48, v168, -v245
    v_fmac_f32 v237, v56, v120
    v_fmac_f32 v245, v49, v169
    v_fmac_f32 v237, v57, v121
    v_fmac_f32 v245, v50, v170
    v_fmac_f32 v237, v58, v122
    v_fmac_f32 v245, v51, v171
    v_fmac_f32 v237, v59, v123
    v_fmac_f32 v245, v52, v172
    v_fmac_f32 v237, v60, v124
    v_fmac_f32 v245, v53, v173
    v_fmac_f32 v237, v61, v125
    v_fmac_f32 v245, v54, v174
    v_fmac_f32 v237, v62, v126
    v_fmac_f32 v245, v55, v175
    v_fmac_f32 v237, v63, v127
    s_cmp_eq_u32 s36, 0
    s_cbranch_scc1 K2_TAIL
    s_mov_b32 s29, s48
    s_mov_b32 s32, s31
    s_mov_b32 s30, s3
    s_mov_b32 s31, s35
    s_cmp_eq_u32 s33, 2
    s_cbranch_scc1 K2_U21
    s_cmp_eq_u32 s33, 3
    s_cbranch_scc1 K2_U31
    s_cmp_eq_u32 s33, 1
    s_cbranch_scc1 K2_U11
    s_branch K2_U41
K2_SWITCH:
    v_permlane32_swap_b32 v242, v243
    v_permlane32_swap_b32 v240, v241
    v_permlane32_swap_b32 v236, v237
    v_permlane32_swap_b32 v244, v245
    v_add_f32 v242, v242, v243
    v_add_f32 v240, -v240, -v241
    v_add_f32 v236, v236, v237
    v_add_f32 v244, v244, v245
    s_set_gpr_idx_on s31, gpr_idx(DST)
    s_nop 0
    v_cvt_pk_bf16_f32 v195, v242, v236
    v_cvt_pk_bf16_f32 v196, v244, v240
    v_cvt_pk_bf16_f32 v197, v238, v238
    s_set_gpr_idx_off
    s_cmp_eq_u32 s36, 0
    s_cbranch_scc1 K2_TAIL2
    v_lshlrev_b32 v254, 3, v252
    v_add_u32 v230, s35, v252
    s_mov_b32 s58, 7000064
    buffer_load_dwordx4 v[96:99], v254, s[8:11], s58 offen offset:0
    buffer_load_dwordx4 v[100:103], v254, s[8:11], s58 offen offset:1024
    buffer_load_dwordx4 v[104:107], v254, s[8:11], s58 offen offset:2048
    buffer_load_dwordx4 v[108:111], v254, s[8:11], s58 offen offset:3072
    s_mov_b32 s58, 7004160
    buffer_load_dwordx4 v[112:115], v254, s[8:11], s58 offen offset:0
    buffer_load_dwordx4 v[116:119], v254, s[8:11], s58 offen offset:1024
    buffer_load_dwordx4 v[120:123], v254, s[8:11], s58 offen offset:2048
    buffer_load_dwordx4 v[124:127], v254, s[8:11], s58 offen offset:3072
    s_mov_b32 s58, 7008256
    buffer_load_dwordx4 v[128:131], v254, s[8:11], s58 offen offset:0
    buffer_load_dwordx4 v[132:135], v254, s[8:11], s58 offen offset:1024
    buffer_load_dwordx4 v[136:139], v254, s[8:11], s58 offen offset:2048
    buffer_load_dwordx4 v[140:143], v254, s[8:11], s58 offen offset:3072
    s_mov_b32 s58, 7012352
    buffer_load_dwordx4 v[144:147], v254, s[8:11], s58 offen offset:0
    buffer_load_dwordx4 v[148:151], v254, s[8:11], s58 offen offset:1024
    buffer_load_dwordx4 v[152:155], v254, s[8:11], s58 offen offset:2048
    buffer_load_dwordx4 v[156:159], v254, s[8:11], s58 offen offset:3072
    s_mov_b32 s58, 7016448
    buffer_load_dwordx4 v[160:163], v254, s[8:11], s58 offen offset:0
    buffer_load_dwordx4 v[164:167], v254, s[8:11], s58 offen offset:1024
    buffer_load_dwordx4 v[168:171], v254, s[8:11], s58 offen offset:2048
    buffer_load_dwordx4 v[172:175], v254, s[8:11], s58 offen offset:3072
    s_movk_i32 s40, 128
    s_movk_i32 s41, 384
    s_movk_i32 s42, 640
    s_movk_i32 s43, 896
    s_cmp_lg_u32 s33, 1
    s_cbranch_scc1 K2_SW2
    s_waitcnt vmcnt(0)
K2_SW2:
    s_mov_b32 s29, s48
    s_mov_b32 s32, s31
    s_mov_b32 s30, s3
    s_mov_b32 s31, s35
    s_cmp_eq_u32 s33, 2
    s_cbranch_scc1 K2_U21
    s_cmp_eq_u32 s33, 3
    s_cbranch_scc1 K2_U31
    s_cmp_eq_u32 s33, 1
    s_cbranch_scc1 K2_U11
    s_branch K2_U41
K2_BIG:
    s_cmp_lg_u32 s24, 0
    s_cbranch_scc1 K2_TOK
    s_mov_b64 s[62:63], vcc
    s_bcnt1_i32_b64 s60, vcc
    s_cmp_eq_u32 s22, 39
    s_cselect_b32 s61, 5, 2
    s_cmp_gt_u32 s60, s61
    s_cbranch_scc1 K2_SLOW
    v_cmp_lt_u32 vcc, 64, v193
    s_nop 0
    s_cbranch_vccnz K2_SLOW
    v_mbcnt_lo_u32_b32 v197, s62, 0
    v_mbcnt_hi_u32_b32 v197, s63, v197
    v_lshlrev_b32 v198, 27, v197
    v_cndmask_b32 v198, 0, v198, s[62:63]
    s_movk_i32 s26, 64
    v_cmp_le_u32 vcc, 2, v197
    v_mov_b32 v194, 161536
    v_mov_b32 v196, -8229472
    v_cndmask_b32 v194, v194, v196, vcc
    v_lshl_add_u32 v197, v197, 22, v194
    v_mov_b32 v203, v193
    v_mov_b32 v204, v195
    v_mov_b32 v205, v197
    s_mov_b32 s60, 6991
    v_cmp_lt_i32 vcc, 0, v180
    s_nop 0
    s_cbranch_vccz K2_OV_DONE
    v_subrev_u32 v192, 65536, v50
    v_mul_hi_u32_u24 v193, s60, v192
    v_mul_u32_u24 v192, s60, v192
    v_alignbit_b32 v192, v193, v192, 24
    v_lshlrev_b32 v192, 2, v192
    ds_bpermute_b32 v199, v192, v205
    v_subrev_u32 v192, 48, v40
    v_cmp_gt_u32 s[62:63], 16, v192
    s_waitcnt lgkmcnt(0)
    s_and_b64 exec, vcc, s[62:63]
    s_cbranch_execz K2_ov_11
    v_lshrrev_b32 v193, 18, v199
    v_add_u32 v192, v192, v193
    v_and_b32 v199, 0x3ffff, v199
    v_lshl_add_u32 v194, v192, 5, v199
    v_lshl_add_u32 v195, v192, 2, v199
    v_and_b32 v196, 7, v192
    v_add_lshl_u32 v196, v196, v192, 1
    v_bfe_u32 v193, v192, 3, 1
    v_mad_i32_i24 v196, v193, -14, v196
    v_add_u32 v196, v196, v199
    ds_write_b32 v194, v60 offset:864
    ds_write2_b32 v195, v0, v1 offset0:48 offset1:96
    ds_write_b32 v195, v2 offset:576
    ds_write_b16 v196, v3 offset:768
K2_ov_11:
    s_mov_b64 exec, -1
    v_cmp_lt_i32 vcc, 2, v180
    s_nop 0
    s_cbranch_vccz K2_OV_DONE
    v_subrev_u32 v192, 65536, v51
    v_mul_hi_u32_u24 v193, s60, v192
    v_mul_u32_u24 v192, s60, v192
    v_alignbit_b32 v192, v193, v192, 24
    v_lshlrev_b32 v192, 2, v192
    ds_bpermute_b32 v199, v192, v205
    v_subrev_u32 v192, 48, v41
    v_cmp_gt_u32 s[62:63], 16, v192
    s_waitcnt lgkmcnt(0)
    s_and_b64 exec, vcc, s[62:63]
    s_cbranch_execz K2_ov_12
    v_lshrrev_b32 v193, 18, v199
    v_add_u32 v192, v192, v193
    v_and_b32 v199, 0x3ffff, v199
    v_lshl_add_u32 v194, v192, 5, v199
    v_lshl_add_u32 v195, v192, 2, v199
    v_and_b32 v196, 7, v192
    v_add_lshl_u32 v196, v196, v192, 1
    v_bfe_u32 v193, v192, 3, 1
    v_mad_i32_i24 v196, v193, -14, v196
    v_add_u32 v196, v196, v199
    ds_write_b32 v194, v61 offset:864
    ds_write2_b32 v195, v4, v5 offset0:48 offset1:96
    ds_write_b32 v195, v6 offset:576
    ds_write_b16 v196, v7 offset:768
K2_ov_12:
    s_mov_b64 exec, -1
    v_cmp_lt_i32 vcc, 4, v180
    s_nop 0
    s_cbranch_vccz K2_OV_DONE
    v_subrev_u32 v192, 65536, v52
    v_mul_hi_u32_u24 v193, s60, v192
    v_mul_u32_u24 v192, s60, v192
    v_alignbit_b32 v192, v193, v192, 24
    v_lshlrev_b32 v192, 2, v192
    ds_bpermute_b32 v199, v192, v205
    v_subrev_u32 v192, 48, v42
    v_cmp_gt_u32 s[62:63], 16, v192
    s_waitcnt lgkmcnt(0)
    s_and_b64 exec, vcc, s[62:63]
    s_cbranch_execz K2_ov_13
    v_lshrrev_b32 v193, 18, v199
    v_add_u32 v192, v192, v193
    v_and_b32 v199, 0x3ffff, v199
    v_lshl_add_u32 v194, v192, 5, v199
    v_lshl_add_u32 v195, v192, 2, v199
    v_and_b32 v196, 7, v192
    v_add_lshl_u32 v196, v196, v192, 1
    v_bfe_u32 v193, v192, 3, 1
    v_mad_i32_i24 v196, v193, -14, v196
    v_add_u32 v196, v196, v199
    ds_write_b32 v194, v62 offset:864
    ds_write2_b32 v195, v8, v9 offset0:48 offset1:96
    ds_write_b32 v195, v10 offset:576
    ds_write_b16 v196, v11 offset:768
K2_ov_13:
    s_mov_b64 exec, -1
    v_cmp_lt_i32 vcc, 6, v180
    s_nop 0
    s_cbranch_vccz K2_OV_DONE
    v_subrev_u32 v192, 65536, v53
    v_mul_hi_u32_u24 v193, s60, v192
    v_mul_u32_u24 v192, s60, v192
    v_alignbit_b32 v192, v193, v192, 24
    v_lshlrev_b32 v192, 2, v192
    ds_bpermute_b32 v199, v192, v205
    v_subrev_u32 v192, 48, v43
    v_cmp_gt_u32 s[62:63], 16, v192
    s_waitcnt lgkmcnt(0)
    s_and_b64 exec, vcc, s[62:63]
    s_cbranch_execz K2_ov_14
    v_lshrrev_b32 v193, 18, v199
    v_add_u32 v192, v192, v193
    v_and_b32 v199, 0x3ffff, v199
    v_lshl_add_u32 v194, v192, 5, v199
    v_lshl_add_u32 v195, v192, 2, v199
    v_and_b32 v196, 7, v192
    v_add_lshl_u32 v196, v196, v192, 1
    v_bfe_u32 v193, v192, 3, 1
    v_mad_i32_i24 v196, v193, -14, v196
    v_add_u32 v196, v196, v199
    ds_write_b32 v194, v63 offset:864
    ds_write2_b32 v195, v12, v13 offset0:48 offset1:96
    ds_write_b32 v195, v14 offset:576
    ds_write_b16 v196, v15 offset:768
K2_ov_14:
    s_mov_b64 exec, -1
    v_cmp_lt_i32 vcc, 8, v180
    s_nop 0
    s_cbranch_vccz K2_OV_DONE
    v_subrev_u32 v192, 65536, v54
    v_mul_hi_u32_u24 v193, s60, v192
    v_mul_u32_u24 v192, s60, v192
    v_alignbit_b32 v192, v193, v192, 24
    v_lshlrev_b32 v192, 2, v192
    ds_bpermute_b32 v199, v192, v205
    v_subrev_u32 v192, 48, v44
    v_cmp_gt_u32 s[62:63], 16, v192
    s_waitcnt lgkmcnt(0)
    s_and_b64 exec, vcc, s[62:63]
    s_cbranch_execz K2_ov_15
    v_lshrrev_b32 v193, 18, v199
    v_add_u32 v192, v192, v193
    v_and_b32 v199, 0x3ffff, v199
    v_lshl_add_u32 v194, v192, 5, v199
    v_lshl_add_u32 v195, v192, 2, v199
    v_and_b32 v196, 7, v192
    v_add_lshl_u32 v196, v196, v192, 1
    v_bfe_u32 v193, v192, 3, 1
    v_mad_i32_i24 v196, v193, -14, v196
    v_add_u32 v196, v196, v199
    ds_write_b32 v194, v64 offset:864
    ds_write2_b32 v195, v16, v17 offset0:48 offset1:96
    ds_write_b32 v195, v18 offset:576
    ds_write_b16 v196, v19 offset:768
K2_ov_15:
    s_mov_b64 exec, -1
    v_cmp_lt_i32 vcc, 10, v180
    s_nop 0
    s_cbranch_vccz K2_OV_DONE
    v_subrev_u32 v192, 65536, v55
    v_mul_hi_u32_u24 v193, s60, v192
    v_mul_u32_u24 v192, s60, v192
    v_alignbit_b32 v192, v193, v192, 24
    v_lshlrev_b32 v192, 2, v192
    ds_bpermute_b32 v199, v192, v205
    v_subrev_u32 v192, 48, v45
    v_cmp_gt_u32 s[62:63], 16, v192
    s_waitcnt lgkmcnt(0)
    s_and_b64 exec, vcc, s[62:63]
    s_cbranch_execz K2_ov_16
    v_lshrrev_b32 v193, 18, v199
    v_add_u32 v192, v192, v193
    v_and_b32 v199, 0x3ffff, v199
    v_lshl_add_u32 v194, v192, 5, v199
    v_lshl_add_u32 v195, v192, 2, v199
    v_and_b32 v196, 7, v192
    v_add_lshl_u32 v196, v196, v192, 1
    v_bfe_u32 v193, v192, 3, 1
    v_mad_i32_i24 v196, v193, -14, v196
    v_add_u32 v196, v196, v199
    ds_write_b32 v194, v65 offset:864
    ds_write2_b32 v195, v20, v21 offset0:48 offset1:96
    ds_write_b32 v195, v22 offset:576
    ds_write_b16 v196, v23 offset:768
K2_ov_16:
    s_mov_b64 exec, -1
    v_cmp_lt_i32 vcc, 12, v180
    s_nop 0
    s_cbranch_vccz K2_OV_DONE
    v_subrev_u32 v192, 65536, v56
    v_mul_hi_u32_u24 v193, s60, v192
    v_mul_u32_u24 v192, s60, v192
    v_alignbit_b32 v192, v193, v192, 24
    v_lshlrev_b32 v192, 2, v192
    ds_bpermute_b32 v199, v192, v205
    v_subrev_u32 v192, 48, v46
    v_cmp_gt_u32 s[62:63], 16, v192
    s_waitcnt lgkmcnt(0)
    s_and_b64 exec, vcc, s[62:63]
    s_cbranch_execz K2_ov_17
    v_lshrrev_b32 v193, 18, v199
    v_add_u32 v192, v192, v193
    v_and_b32 v199, 0x3ffff, v199
    v_lshl_add_u32 v194, v192, 5, v199
    v_lshl_add_u32 v195, v192, 2, v199
    v_and_b32 v196, 7, v192
    v_add_lshl_u32 v196, v196, v192, 1
    v_bfe_u32 v193, v192, 3, 1
    v_mad_i32_i24 v196, v193, -14, v196
    v_add_u32 v196, v196, v199
    ds_write_b32 v194, v66 offset:864
    ds_write2_b32 v195, v24, v25 offset0:48 offset1:96
    ds_write_b32 v195, v26 offset:576
    ds_write_b16 v196, v27 offset:768
K2_ov_17:
    s_mov_b64 exec, -1
    v_cmp_lt_i32 vcc, 14, v180
    s_nop 0
    s_cbranch_vccz K2_OV_DONE
    v_subrev_u32 v192, 65536, v57
    v_mul_hi_u32_u24 v193, s60, v192
    v_mul_u32_u24 v192, s60, v192
    v_alignbit_b32 v192, v193, v192, 24
    v_lshlrev_b32 v192, 2, v192
    ds_bpermute_b32 v199, v192, v205
    v_subrev_u32 v192, 48, v47
    v_cmp_gt_u32 s[62:63], 16, v192
    s_waitcnt lgkmcnt(0)
    s_and_b64 exec, vcc, s[62:63]
    s_cbranch_execz K2_ov_18
    v_lshrrev_b32 v193, 18, v199
    v_add_u32 v192, v192, v193
    v_and_b32 v199, 0x3ffff, v199
    v_lshl_add_u32 v194, v192, 5, v199
    v_lshl_add_u32 v195, v192, 2, v199
    v_and_b32 v196, 7, v192
    v_add_lshl_u32 v196, v196, v192, 1
    v_bfe_u32 v193, v192, 3, 1
    v_mad_i32_i24 v196, v193, -14, v196
    v_add_u32 v196, v196, v199
    ds_write_b32 v194, v67 offset:864
    ds_write2_b32 v195, v28, v29 offset0:48 offset1:96
    ds_write_b32 v195, v30 offset:576
    ds_write_b16 v196, v31 offset:768
K2_ov_18:
    s_mov_b64 exec, -1
    v_cmp_lt_i32 vcc, 16, v180
    s_nop 0
    s_cbranch_vccz K2_OV_DONE
    v_subrev_u32 v192, 65536, v58
    v_mul_hi_u32_u24 v193, s60, v192
    v_mul_u32_u24 v192, s60, v192
    v_alignbit_b32 v192, v193, v192, 24
    v_lshlrev_b32 v192, 2, v192
    ds_bpermute_b32 v199, v192, v205
    v_subrev_u32 v192, 48, v48
    v_cmp_gt_u32 s[62:63], 16, v192
    s_waitcnt lgkmcnt(0)
    s_and_b64 exec, vcc, s[62:63]
    s_cbranch_execz K2_ov_19
    v_lshrrev_b32 v193, 18, v199
    v_add_u32 v192, v192, v193
    v_and_b32 v199, 0x3ffff, v199
    v_lshl_add_u32 v194, v192, 5, v199
    v_lshl_add_u32 v195, v192, 2, v199
    v_and_b32 v196, 7, v192
    v_add_lshl_u32 v196, v196, v192, 1
    v_bfe_u32 v193, v192, 3, 1
    v_mad_i32_i24 v196, v193, -14, v196
    v_add_u32 v196, v196, v199
    ds_write_b32 v194, v68 offset:864
    ds_write2_b32 v195, v32, v33 offset0:48 offset1:96
    ds_write_b32 v195, v34 offset:576
    ds_write_b16 v196, v35 offset:768
K2_ov_19:
    s_mov_b64 exec, -1
    v_cmp_lt_i32 vcc, 18, v180
    s_nop 0
    s_cbranch_vccz K2_OV_DONE
    v_subrev_u32 v192, 65536, v59
    v_mul_hi_u32_u24 v193, s60, v192
    v_mul_u32_u24 v192, s60, v192
    v_alignbit_b32 v192, v193, v192, 24
    v_lshlrev_b32 v192, 2, v192
    ds_bpermute_b32 v199, v192, v205
    v_subrev_u32 v192, 48, v49
    v_cmp_gt_u32 s[62:63], 16, v192
    s_waitcnt lgkmcnt(0)
    s_and_b64 exec, vcc, s[62:63]
    s_cbranch_execz K2_ov_20
    v_lshrrev_b32 v193, 18, v199
    v_add_u32 v192, v192, v193
    v_and_b32 v199, 0x3ffff, v199
    v_lshl_add_u32 v194, v192, 5, v199
    v_lshl_add_u32 v195, v192, 2, v199
    v_and_b32 v196, 7, v192
    v_add_lshl_u32 v196, v196, v192, 1
    v_bfe_u32 v193, v192, 3, 1
    v_mad_i32_i24 v196, v193, -14, v196
    v_add_u32 v196, v196, v199
    ds_write_b32 v194, v69 offset:864
    ds_write2_b32 v195, v36, v37 offset0:48 offset1:96
    ds_write_b32 v195, v38 offset:576
    ds_write_b16 v196, v39 offset:768
K2_ov_20:
    s_mov_b64 exec, -1
K2_OV_DONE:
    v_mov_b32 v193, v203
    v_mov_b32 v195, v204
    s_waitcnt lgkmcnt(0)
    s_barrier
    s_branch K2_TOK
K2_SLOW:
    v_mov_b32 v197, v193
    s_nop 1
    v_max_u32_dpp v197, v197, v197 row_shr:1 row_mask:0xf bank_mask:0xf bound_ctrl:0
    s_nop 1
    v_max_u32_dpp v197, v197, v197 row_shr:2 row_mask:0xf bank_mask:0xf bound_ctrl:0
    s_nop 1
    v_max_u32_dpp v197, v197, v197 row_shr:4 row_mask:0xf bank_mask:0xf bound_ctrl:0
    s_nop 1
    v_max_u32_dpp v197, v197, v197 row_shr:8 row_mask:0xf bank_mask:0xf bound_ctrl:0
    s_nop 1
    v_max_u32_dpp v197, v197, v197 row_bcast:15 row_mask:0xa bank_mask:0xf
    s_nop 1
    v_max_u32_dpp v197, v197, v197 row_bcast:31 row_mask:0xc bank_mask:0xf
    s_nop 0
    v_readlane_b32 s25, v197, 63
    s_nop 0
    s_add_u32 s25, s25, 47
    s_mul_i32 s25, s25, 43691
    s_lshr_b32 s25, s25, 21
    v_cmp_lt_i32 vcc, 0, v180
    s_nop 0
    s_cbranch_vccz K2_SV_DONE
    s_mov_b64 exec, vcc
    buffer_store_dword v40, v179, s[8:11], s66 offen offset:0
    v_cmp_lt_i32 vcc, 2, v180
    s_nop 0
    s_cbranch_vccz K2_SV_DONE
    s_mov_b64 exec, vcc
    buffer_store_dword v41, v179, s[8:11], s66 offen offset:8
    v_cmp_lt_i32 vcc, 4, v180
    s_nop 0
    s_cbranch_vccz K2_SV_DONE
    s_mov_b64 exec, vcc
    buffer_store_dword v42, v179, s[8:11], s66 offen offset:16
    v_cmp_lt_i32 vcc, 6, v180
    s_nop 0
    s_cbranch_vccz K2_SV_DONE
    s_mov_b64 exec, vcc
    buffer_store_dword v43, v179, s[8:11], s66 offen offset:24
    v_cmp_lt_i32 vcc, 8, v180
    s_nop 0
    s_cbranch_vccz K2_SV_DONE
    s_mov_b64 exec, vcc
    buffer_store_dword v44, v179, s[8:11], s66 offen offset:32
    v_cmp_lt_i32 vcc, 10, v180
    s_nop 0
    s_cbranch_vccz K2_SV_DONE
    s_mov_b64 exec, vcc
    buffer_store_dword v45, v179, s[8:11], s66 offen offset:40
    v_cmp_lt_i32 vcc, 12, v180
    s_nop 0
    s_cbranch_vccz K2_SV_DONE
    s_mov_b64 exec, vcc
    buffer_store_dword v46, v179, s[8:11], s66 offen offset:48
    v_cmp_lt_i32 vcc, 14, v180
    s_nop 0
    s_cbranch_vccz K2_SV_DONE
    s_mov_b64 exec, vcc
    buffer_store_dword v47, v179, s[8:11], s66 offen offset:56
    v_cmp_lt_i32 vcc, 16, v180
    s_nop 0
    s_cbranch_vccz K2_SV_DONE
    s_mov_b64 exec, vcc
    buffer_store_dword v48, v179, s[8:11], s66 offen offset:64
    v_cmp_lt_i32 vcc, 18, v180
    s_nop 0
    s_cbranch_vccz K2_SV_DONE
    s_mov_b64 exec, vcc
    buffer_store_dword v49, v179, s[8:11], s66 offen offset:72
K2_SV_DONE:
    s_mov_b64 exec, -1
    s_branch K2_TOK
K2_rare_21:
    s_cmp_eq_u32 s33, 4
    s_cbranch_scc1 K2_four_23
    s_mov_b32 s49, s48
    s_mov_b32 s51, s48
    s_add_u32 s45, s44, 256
    s_add_u32 s46, s44, 512
    s_add_u32 s47, s44, 768
    s_branch K2_back_22
K2_four_23:
    s_add_u32 s50, s48, 64
    s_lshr_b32 s51, s3, 27
    s_mov_b32 s66, 161536
    s_cmp_ge_u32 s51, 2
    s_cselect_b32 s66, 159072, s66
    s_mul_i32 s51, s51, 32
    s_add_u32 s51, s51, s66
    s_mov_b32 s46, s44
    s_mov_b32 s47, s44
    s_branch K2_back_22
K2_dum_24:
    v_mov_b32 v232, -1
    s_mov_b32 m0, 163712
    s_mov_b64 exec, 1
    buffer_load_dwordx4 v232, s[16:19], 0 offen lds
    buffer_load_dwordx4 v232, s[16:19], 0 offen lds
    s_mov_b64 exec, -1
    s_branch K2_back_26
K2_a4_25:
    s_lshr_b32 s65, s3, 27
    s_mov_b32 s66, 161536
    s_cmp_ge_u32 s65, 2
    s_cselect_b32 s66, 158112, s66
    s_mul_i32 s65, s65, 512
    s_add_u32 s65, s65, s66
    v_add_u32 v232, s65, v230
    ds_read_b32 v232, v232
    s_add_u32 m0, s65, 864
    s_waitcnt lgkmcnt(0)
    v_or_b32 v232, v232, v231
    buffer_load_dwordx4 v232, s[16:19], 0 offen  lds
    s_branch K2_b4_27
K2_nul_30:
    s_mov_b32 s58, 63
    s_mov_b32 s36, 0
    s_branch K2_back_33
K2_spin_31:
    v_lshl_add_u32 v233, v252, 1, s53
    ds_read_b32 v233, v233
    s_waitcnt lgkmcnt(0)
    s_branch K2_chk_32
K2_dyn_28:
    v_mov_b32 v254, 163648
    v_mov_b32 v255, 1
    v_lshl_add_u32 v233, v252, 1, s53
    s_mov_b64 exec, 1
    ds_add_rtn_u32 v232, v254, v255
    s_mov_b64 exec, -1
    ds_read_b32 v233, v233
    s_waitcnt lgkmcnt(0)
    v_readfirstlane_b32 s58, v232
    s_nop 0
    s_cmp_lt_u32 s58, s22
    s_cbranch_scc0 K2_nul_30
    s_and_b32 s59, s58, 7
    s_lshr_b32 s60, s58, 3
K2_chk_32:
    v_readlane_b32 s61, v233, s59
    s_nop 0
    s_cmp_gt_u32 s61, s60
    s_cbranch_scc0 K2_spin_31
K2_back_33:
    s_mov_b32 s34, 1
    s_branch K2_back_29
K2_rare_34:
    s_cmp_eq_u32 s33, 4
    s_cbranch_scc1 K2_four_36
    s_mov_b32 s49, s48
    s_mov_b32 s51, s48
    s_add_u32 s45, s44, 256
    s_add_u32 s46, s44, 512
    s_add_u32 s47, s44, 768
    s_branch K2_back_35
K2_four_36:
    s_add_u32 s50, s48, 64
    s_lshr_b32 s51, s3, 27
    s_mov_b32 s66, 161536
    s_cmp_ge_u32 s51, 2
    s_cselect_b32 s66, 159072, s66
    s_mul_i32 s51, s51, 32
    s_add_u32 s51, s51, s66
    s_mov_b32 s46, s44
    s_mov_b32 s47, s44
    s_branch K2_back_35
K2_dum_37:
    v_mov_b32 v232, -1
    s_mov_b32 m0, 163712
    s_mov_b64 exec, 1
    buffer_load_dwordx4 v232, s[16:19], 0 offen lds
    buffer_load_dwordx4 v232, s[16:19], 0 offen lds
    s_mov_b64 exec, -1
    s_branch K2_back_39
K2_a4_38:
    s_lshr_b32 s65, s3, 27
    s_mov_b32 s66, 161536
    s_cmp_ge_u32 s65, 2
    s_cselect_b32 s66, 158112, s66
    s_mul_i32 s65, s65, 512
    s_add_u32 s65, s65, s66
    v_add_u32 v232, s65, v230
    ds_read_b32 v232, v232
    s_add_u32 m0, s65, 864
    s_waitcnt lgkmcnt(0)
    v_or_b32 v232, v232, v231
    buffer_load_dwordx4 v232, s[16:19], 0 offen  lds
    s_branch K2_b4_40
K2_nul_43:
    s_mov_b32 s58, 63
    s_mov_b32 s36, 0
    s_branch K2_back_46
K2_spin_44:
    v_lshl_add_u32 v233, v252, 1, s53
    ds_read_b32 v233, v233
    s_waitcnt lgkmcnt(0)
    s_branch K2_chk_45
K2_dyn_41:
    v_mov_b32 v254, 163648
    v_mov_b32 v255, 1
    v_lshl_add_u32 v233, v252, 1, s53
    s_mov_b64 exec, 1
    ds_add_rtn_u32 v232, v254, v255
    s_mov_b64 exec, -1
    ds_read_b32 v233, v233
    s_waitcnt lgkmcnt(0)
    v_readfirstlane_b32 s58, v232
    s_nop 0
    s_cmp_lt_u32 s58, s22
    s_cbranch_scc0 K2_nul_43
    s_and_b32 s59, s58, 7
    s_lshr_b32 s60, s58, 3
K2_chk_45:
    v_readlane_b32 s61, v233, s59
    s_nop 0
    s_cmp_gt_u32 s61, s60
    s_cbranch_scc0 K2_spin_44
K2_back_46:
    s_mov_b32 s34, 1
    s_branch K2_back_42
K2_rare_47:
    s_cmp_eq_u32 s33, 4
    s_cbranch_scc1 K2_four_49
    s_mov_b32 s49, s48
    s_mov_b32 s51, s48
    s_add_u32 s45, s44, 256
    s_add_u32 s46, s44, 512
    s_add_u32 s47, s44, 768
    s_branch K2_back_48
K2_four_49:
    s_add_u32 s50, s48, 64
    s_lshr_b32 s51, s3, 27
    s_mov_b32 s66, 161536
    s_cmp_ge_u32 s51, 2
    s_cselect_b32 s66, 159072, s66
    s_mul_i32 s51, s51, 32
    s_add_u32 s51, s51, s66
    s_mov_b32 s46, s44
    s_mov_b32 s47, s44
    s_branch K2_back_48
K2_dum_50:
    v_mov_b32 v232, -1
    s_mov_b32 m0, 163712
    s_mov_b64 exec, 1
    buffer_load_dwordx4 v232, s[16:19], 0 offen lds
    buffer_load_dwordx4 v232, s[16:19], 0 offen lds
    s_mov_b64 exec, -1
    s_branch K2_back_52
K2_a4_51:
    s_lshr_b32 s65, s3, 27
    s_mov_b32 s66, 161536
    s_cmp_ge_u32 s65, 2
    s_cselect_b32 s66, 158112, s66
    s_mul_i32 s65, s65, 512
    s_add_u32 s65, s65, s66
    v_add_u32 v232, s65, v230
    ds_read_b32 v232, v232
    s_add_u32 m0, s65, 864
    s_waitcnt lgkmcnt(0)
    v_or_b32 v232, v232, v231
    buffer_load_dwordx4 v232, s[16:19], 0 offen  lds
    s_branch K2_b4_53
K2_nul_54:
    s_mov_b32 s58, 63
    s_mov_b32 s36, 0
    s_branch K2_back_57
K2_spin_55:
    v_lshl_add_u32 v233, v252, 1, s53
    ds_read_b32 v233, v233
    s_waitcnt lgkmcnt(0)
    s_branch K2_chk_56
K2_rare_58:
    s_cmp_eq_u32 s33, 4
    s_cbranch_scc1 K2_four_60
    s_mov_b32 s49, s48
    s_mov_b32 s51, s48
    s_add_u32 s45, s44, 256
    s_add_u32 s46, s44, 512
    s_add_u32 s47, s44, 768
    s_branch K2_back_59
K2_four_60:
    s_add_u32 s50, s48, 64
    s_lshr_b32 s51, s3, 27
    s_mov_b32 s66, 161536
    s_cmp_ge_u32 s51, 2
    s_cselect_b32 s66, 159072, s66
    s_mul_i32 s51, s51, 32
    s_add_u32 s51, s51, s66
    s_mov_b32 s46, s44
    s_mov_b32 s47, s44
    s_branch K2_back_59
K2_nul_61:
    s_mov_b32 s58, 63
    s_mov_b32 s36, 0
    s_branch K2_back_64
K2_spin_62:
    v_lshl_add_u32 v233, v252, 1, s53
    ds_read_b32 v233, v233
    s_waitcnt lgkmcnt(0)
    s_branch K2_chk_63
K2_rare_65:
    s_cmp_eq_u32 s33, 4
    s_cbranch_scc1 K2_four_67
    s_mov_b32 s49, s48
    s_mov_b32 s51, s48
    s_add_u32 s45, s44, 256
    s_add_u32 s46, s44, 512
    s_add_u32 s47, s44, 768
    s_branch K2_back_66
K2_four_67:
    s_add_u32 s50, s48, 64
    s_lshr_b32 s51, s3, 27
    s_mov_b32 s66, 161536
    s_cmp_ge_u32 s51, 2
    s_cselect_b32 s66, 159072, s66
    s_mul_i32 s51, s51, 32
    s_add_u32 s51, s51, s66
    s_mov_b32 s46, s44
    s_mov_b32 s47, s44
    s_branch K2_back_66
K2_nul_70:
    s_mov_b32 s58, 63
    s_mov_b32 s36, 0
    s_branch K2_back_73
K2_spin_71:
    v_lshl_add_u32 v233, v252, 1, s53
    ds_read_b32 v233, v233
    s_waitcnt lgkmcnt(0)
    s_branch K2_chk_72
K2_dyn_68:
    v_mov_b32 v254, 163648
    v_mov_b32 v255, 1
    v_lshl_add_u32 v233, v252, 1, s53
    s_mov_b64 exec, 1
    ds_add_rtn_u32 v232, v254, v255
    s_mov_b64 exec, -1
    ds_read_b32 v233, v233
    s_waitcnt lgkmcnt(0)
    v_readfirstlane_b32 s58, v232
    s_nop 0
    s_cmp_lt_u32 s58, s22
    s_cbranch_scc0 K2_nul_70
    s_and_b32 s59, s58, 7
    s_lshr_b32 s60, s58, 3
K2_chk_72:
    v_readlane_b32 s61, v233, s59
    s_nop 0
    s_cmp_gt_u32 s61, s60
    s_cbranch_scc0 K2_spin_71
K2_back_73:
    s_mov_b32 s34, 1
    s_branch K2_back_69
K2_rare_74:
    s_cmp_eq_u32 s33, 4
    s_cbranch_scc1 K2_four_76
    s_mov_b32 s49, s48
    s_mov_b32 s51, s48
    s_add_u32 s45, s44, 256
    s_add_u32 s46, s44, 512
    s_add_u32 s47, s44, 768
    s_branch K2_back_75
K2_four_76:
    s_add_u32 s50, s48, 64
    s_lshr_b32 s51, s3, 27
    s_mov_b32 s66, 161536
    s_cmp_ge_u32 s51, 2
    s_cselect_b32 s66, 159072, s66
    s_mul_i32 s51, s51, 32
    s_add_u32 s51, s51, s66
    s_mov_b32 s46, s44
    s_mov_b32 s47, s44
    s_branch K2_back_75
K2_dum_77:
    v_mov_b32 v232, -1
    s_mov_b32 m0, 163712
    s_mov_b64 exec, 1
    buffer_load_dwordx4 v232, s[16:19], 0 offen lds
    buffer_load_dwordx4 v232, s[16:19], 0 offen lds
    s_mov_b64 exec, -1
    s_branch K2_back_79
K2_a4_78:
    s_lshr_b32 s65, s3, 27
    s_mov_b32 s66, 161536
    s_cmp_ge_u32 s65, 2
    s_cselect_b32 s66, 158112, s66
    s_mul_i32 s65, s65, 512
    s_add_u32 s65, s65, s66
    v_add_u32 v232, s65, v230
    ds_read_b32 v232, v232
    s_add_u32 m0, s65, 864
    s_waitcnt lgkmcnt(0)
    v_or_b32 v232, v232, v231
    buffer_load_dwordx4 v232, s[16:19], 0 offen  lds
    s_branch K2_b4_80
K2_nul_83:
    s_mov_b32 s58, 63
    s_mov_b32 s36, 0
    s_branch K2_back_86
K2_spin_84:
    v_lshl_add_u32 v233, v252, 1, s53
    ds_read_b32 v233, v233
    s_waitcnt lgkmcnt(0)
    s_branch K2_chk_85
K2_dyn_81:
    v_mov_b32 v254, 163648
    v_mov_b32 v255, 1
    v_lshl_add_u32 v233, v252, 1, s53
    s_mov_b64 exec, 1
    ds_add_rtn_u32 v232, v254, v255
    s_mov_b64 exec, -1
    ds_read_b32 v233, v233
    s_waitcnt lgkmcnt(0)
    v_readfirstlane_b32 s58, v232
    s_nop 0
    s_cmp_lt_u32 s58, s22
    s_cbranch_scc0 K2_nul_83
    s_and_b32 s59, s58, 7
    s_lshr_b32 s60, s58, 3
K2_chk_85:
    v_readlane_b32 s61, v233, s59
    s_nop 0
    s_cmp_gt_u32 s61, s60
    s_cbranch_scc0 K2_spin_84
K2_back_86:
    s_mov_b32 s34, 1
    s_branch K2_back_82
K2_rare_87:
    s_cmp_eq_u32 s33, 4
    s_cbranch_scc1 K2_four_89
    s_mov_b32 s49, s48
    s_mov_b32 s51, s48
    s_add_u32 s45, s44, 256
    s_add_u32 s46, s44, 512
    s_add_u32 s47, s44, 768
    s_branch K2_back_88
K2_four_89:
    s_add_u32 s50, s48, 64
    s_lshr_b32 s51, s3, 27
    s_mov_b32 s66, 161536
    s_cmp_ge_u32 s51, 2
    s_cselect_b32 s66, 159072, s66
    s_mul_i32 s51, s51, 32
    s_add_u32 s51, s51, s66
    s_mov_b32 s46, s44
    s_mov_b32 s47, s44
    s_branch K2_back_88
K2_dum_90:
    v_mov_b32 v232, -1
    s_mov_b32 m0, 163712
    s_mov_b64 exec, 1
    buffer_load_dwordx4 v232, s[16:19], 0 offen lds
    buffer_load_dwordx4 v232, s[16:19], 0 offen lds
    s_mov_b64 exec, -1
    s_branch K2_back_92
K2_a4_91:
    s_lshr_b32 s65, s3, 27
    s_mov_b32 s66, 161536
    s_cmp_ge_u32 s65, 2
    s_cselect_b32 s66, 158112, s66
    s_mul_i32 s65, s65, 512
    s_add_u32 s65, s65, s66
    v_add_u32 v232, s65, v230
    ds_read_b32 v232, v232
    s_add_u32 m0, s65, 864
    s_waitcnt lgkmcnt(0)
    v_or_b32 v232, v232, v231
    buffer_load_dwordx4 v232, s[16:19], 0 offen  lds
    s_branch K2_b4_93
K2_nul_94:
    s_mov_b32 s58, 63
    s_mov_b32 s36, 0
    s_branch K2_back_97
K2_spin_95:
    v_lshl_add_u32 v233, v252, 1, s53
    ds_read_b32 v233, v233
    s_waitcnt lgkmcnt(0)
    s_branch K2_chk_96
K2_rare_98:
    s_cmp_eq_u32 s33, 4
    s_cbranch_scc1 K2_four_100
    s_mov_b32 s49, s48
    s_mov_b32 s51, s48
    s_add_u32 s45, s44, 256
    s_add_u32 s46, s44, 512
    s_add_u32 s47, s44, 768
    s_branch K2_back_99
K2_four_100:
    s_add_u32 s50, s48, 64
    s_lshr_b32 s51, s3, 27
    s_mov_b32 s66, 161536
    s_cmp_ge_u32 s51, 2
    s_cselect_b32 s66, 159072, s66
    s_mul_i32 s51, s51, 32
    s_add_u32 s51, s51, s66
    s_mov_b32 s46, s44
    s_mov_b32 s47, s44
    s_branch K2_back_99
K2_nul_101:
    s_mov_b32 s58, 63
    s_mov_b32 s36, 0
    s_branch K2_back_104
K2_spin_102:
    v_lshl_add_u32 v233, v252, 1, s53
    ds_read_b32 v233, v233
    s_waitcnt lgkmcnt(0)
    s_branch K2_chk_103
K2_rare_105:
    s_cmp_eq_u32 s33, 4
    s_cbranch_scc1 K2_four_107
    s_mov_b32 s49, s48
    s_mov_b32 s51, s48
    s_add_u32 s45, s44, 256
    s_add_u32 s46, s44, 512
    s_add_u32 s47, s44, 768
    s_branch K2_back_106
K2_four_107:
    s_add_u32 s50, s48, 64
    s_lshr_b32 s51, s3, 27
    s_mov_b32 s66, 161536
    s_cmp_ge_u32 s51, 2
    s_cselect_b32 s66, 159072, s66
    s_mul_i32 s51, s51, 32
    s_add_u32 s51, s51, s66
    s_mov_b32 s46, s44
    s_mov_b32 s47, s44
    s_branch K2_back_106
K2_TAIL2:
    v_lshlrev_b32 v229, 3, v252
    s_mul_i32 s58, s20, 20480
    s_add_u32 s58, s58, 6815744
    buffer_load_dwordx4 v[96:99], v229, s[8:11], s58 offen offset:0
    buffer_load_dwordx4 v[100:103], v229, s[8:11], s58 offen offset:1024
    buffer_load_dwordx4 v[104:107], v229, s[8:11], s58 offen offset:2048
    buffer_load_dwordx4 v[108:111], v229, s[8:11], s58 offen offset:3072
    s_add_u32 s58, s58, 4096
    buffer_load_dwordx4 v[112:115], v229, s[8:11], s58 offen offset:0
    buffer_load_dwordx4 v[116:119], v229, s[8:11], s58 offen offset:1024
    buffer_load_dwordx4 v[120:123], v229, s[8:11], s58 offen offset:2048
    buffer_load_dwordx4 v[124:127], v229, s[8:11], s58 offen offset:3072
    s_add_u32 s58, s58, 4096
    buffer_load_dwordx4 v[128:131], v229, s[8:11], s58 offen offset:0
    buffer_load_dwordx4 v[132:135], v229, s[8:11], s58 offen offset:1024
    buffer_load_dwordx4 v[136:139], v229, s[8:11], s58 offen offset:2048
    buffer_load_dwordx4 v[140:143], v229, s[8:11], s58 offen offset:3072
    s_add_u32 s58, s58, 4096
    buffer_load_dwordx4 v[144:147], v229, s[8:11], s58 offen offset:0
    buffer_load_dwordx4 v[148:151], v229, s[8:11], s58 offen offset:1024
    buffer_load_dwordx4 v[152:155], v229, s[8:11], s58 offen offset:2048
    buffer_load_dwordx4 v[156:159], v229, s[8:11], s58 offen offset:3072
    s_add_u32 s58, s58, 4096
    buffer_load_dwordx4 v[160:163], v229, s[8:11], s58 offen offset:0
    buffer_load_dwordx4 v[164:167], v229, s[8:11], s58 offen offset:1024
    buffer_load_dwordx4 v[168:171], v229, s[8:11], s58 offen offset:2048
    buffer_load_dwordx4 v[172:175], v229, s[8:11], s58 offen offset:3072
    s_branch K2_TAIL3
K2_TAIL:
    v_lshlrev_b32 v229, 3, v252
    s_mul_i32 s58, s20, 20480
    s_add_u32 s58, s58, 6815744
    buffer_load_dwordx4 v[96:99], v229, s[8:11], s58 offen offset:0
    buffer_load_dwordx4 v[100:103], v229, s[8:11], s58 offen offset:1024
    buffer_load_dwordx4 v[104:107], v229, s[8:11], s58 offen offset:2048
    buffer_load_dwordx4 v[108:111], v229, s[8:11], s58 offen offset:3072
    s_add_u32 s58, s58, 4096
    buffer_load_dwordx4 v[112:115], v229, s[8:11], s58 offen offset:0
    buffer_load_dwordx4 v[116:119], v229, s[8:11], s58 offen offset:1024
    buffer_load_dwordx4 v[120:123], v229, s[8:11], s58 offen offset:2048
    buffer_load_dwordx4 v[124:127], v229, s[8:11], s58 offen offset:3072
    s_add_u32 s58, s58, 4096
    buffer_load_dwordx4 v[128:131], v229, s[8:11], s58 offen offset:0
    buffer_load_dwordx4 v[132:135], v229, s[8:11], s58 offen offset:1024
    buffer_load_dwordx4 v[136:139], v229, s[8:11], s58 offen offset:2048
    buffer_load_dwordx4 v[140:143], v229, s[8:11], s58 offen offset:3072
    s_add_u32 s58, s58, 4096
    buffer_load_dwordx4 v[144:147], v229, s[8:11], s58 offen offset:0
    buffer_load_dwordx4 v[148:151], v229, s[8:11], s58 offen offset:1024
    buffer_load_dwordx4 v[152:155], v229, s[8:11], s58 offen offset:2048
    buffer_load_dwordx4 v[156:159], v229, s[8:11], s58 offen offset:3072
    s_add_u32 s58, s58, 4096
    buffer_load_dwordx4 v[160:163], v229, s[8:11], s58 offen offset:0
    buffer_load_dwordx4 v[164:167], v229, s[8:11], s58 offen offset:1024
    buffer_load_dwordx4 v[168:171], v229, s[8:11], s58 offen offset:2048
    buffer_load_dwordx4 v[172:175], v229, s[8:11], s58 offen offset:3072
    v_permlane32_swap_b32 v242, v243
    v_permlane32_swap_b32 v240, v241
    v_permlane32_swap_b32 v236, v237
    v_permlane32_swap_b32 v244, v245
    v_add_f32 v242, v242, v243
    v_add_f32 v240, -v240, -v241
    v_add_f32 v236, v236, v237
    v_add_f32 v244, v244, v245
    v_cvt_pk_bf16_f32 v242, v242, v236
    v_cvt_pk_bf16_f32 v244, v244, v240
    v_cvt_pk_bf16_f32 v238, v238, v238
    ds_write_b16 v230, v242 offset:1152
    ds_write_b16_d16_hi v230, v242 offset:128
    ds_write_b16 v230, v244 offset:512
    ds_write_b16_d16_hi v230, v244 offset:896
    ds_write_b16 v230, v238 offset:1280
K2_TAIL3:
    s_mul_i32 s59, s20, 8224
    v_add_u32 v228, s59, v252
    s_waitcnt vmcnt(20)
    ds_write_b16 v228, v192 offset:0
    ds_write_b16_d16_hi v228, v192 offset:256
    ds_write_b16 v228, v193 offset:640
    ds_write_b16_d16_hi v228, v193 offset:1024
    ds_write_b16 v228, v194 offset:384
    ds_write_b16_d16_hi v228, v194 offset:768
    ds_write_b16 v228, v195 offset:1152
    ds_write_b16_d16_hi v228, v195 offset:128
    ds_write_b16 v228, v196 offset:512
    ds_write_b16_d16_hi v228, v196 offset:896
    ds_write_b16 v228, v197 offset:1280
    ds_write_b16 v228, v198 offset:1536
    ds_write_b16_d16_hi v228, v198 offset:1792
    ds_write_b16 v228, v199 offset:2176
    ds_write_b16_d16_hi v228, v199 offset:2560
    ds_write_b16 v228, v200 offset:1920
    ds_write_b16_d16_hi v228, v200 offset:2304
    ds_write_b16 v228, v201 offset:2688
    ds_write_b16_d16_hi v228, v201 offset:1664
    ds_write_b16 v228, v202 offset:2048
    ds_write_b16_d16_hi v228, v202 offset:2432
    ds_write_b16 v228, v203 offset:2816
    ds_write_b16 v228, v204 offset:3072
    ds_write_b16_d16_hi v228, v204 offset:3328
    ds_write_b16 v228, v205 offset:3712
    ds_write_b16_d16_hi v228, v205 offset:4096
    ds_write_b16 v228, v206 offset:3456
    ds_write_b16_d16_hi v228, v206 offset:3840
    ds_write_b16 v228, v207 offset:4224
    ds_write_b16_d16_hi v228, v207 offset:3200
    ds_write_b16 v228, v208 offset:3584
    ds_write_b16_d16_hi v228, v208 offset:3968
    ds_write_b16 v228, v209 offset:4352
    ds_write_b16 v228, v210 offset:4608
    ds_write_b16_d16_hi v228, v210 offset:4864
    ds_write_b16 v228, v211 offset:5248
    ds_write_b16_d16_hi v228, v211 offset:5632
    ds_write_b16 v228, v212 offset:4992
    ds_write_b16_d16_hi v228, v212 offset:5376
    ds_write_b16 v228, v213 offset:5760
    ds_write_b16_d16_hi v228, v213 offset:4736
    ds_write_b16 v228, v214 offset:5120
    ds_write_b16_d16_hi v228, v214 offset:5504
    ds_write_b16 v228, v215 offset:5888
    ds_write_b16 v228, v216 offset:6144
    ds_write_b16_d16_hi v228, v216 offset:6400
    ds_write_b16 v228, v217 offset:6784
    ds_write_b16_d16_hi v228, v217 offset:7168
    ds_write_b16 v228, v218 offset:6528
    ds_write_b16_d16_hi v228, v218 offset:6912
    ds_write_b16 v228, v219 offset:7296
    ds_write_b16_d16_hi v228, v219 offset:6272
    ds_write_b16 v228, v220 offset:6656
    ds_write_b16_d16_hi v228, v220 offset:7040
    ds_write_b16 v228, v221 offset:7424
    v_bfe_u32 v48, v252, 1, 4
    v_lshlrev_b32 v49, 2, v48
    v_add_u32 v50, 64, v49
    v_add_u32 v51, 128, v49
    ds_bpermute_b32 v223, v49, v253
    ds_bpermute_b32 v224, v50, v253
    ds_bpermute_b32 v225, v51, v253
    v_lshrrev_b32 v49, 5, v252
    v_and_b32 v50, 7, v48
    v_mul_u32_u24 v50, 8224, v50
    v_lshrrev_b32 v51, 3, v48
    v_mul_u32_u24 v51, 1536, v51
    v_add_u32 v50, v50, v51
    v_lshlrev_b32 v52, 4, v49
    v_add_u32 v222, v50, v52
    s_lshl_b32 s60, s20, 5
    v_lshl_add_u32 v51, v49, 3, s60
    v_bfe_u32 v53, v48, 2, 1
    v_lshl_add_u32 v51, v53, 4, v51
    v_add_u32 v226, v50, v51
    s_sub_u32 s60, s22, 32
    v_cmp_gt_u32 s[56:57], s60, v48
    s_bfe_u32 s60, s20, 0x10002
    s_lshl_b32 s60, s60, 4
    s_add_u32 s59, s59, s60
    s_add_u32 s24, s24, 1
    s_cmp_ge_u32 s24, s25
    s_cselect_b32 s55, 1, 0
    s_cmp_eq_u32 s27, 0
    s_cselect_b32 s55, s55, 0
    s_and_b32 s64, s55, s28
    s_mov_b32 s63, 0xbfb8aa3b
    v_lshlrev_b32 v53, 5, v48
    s_waitcnt lgkmcnt(0)
    v_add_u32 v228, s59, v229
    v_and_b32 v51, 0x3ffff, v223
    v_sub_u32 v50, v53, v51
    v_and_b32 v50, 0xff, v50
    v_add3_u32 v223, v50, v51, v52
    v_and_b32 v51, 0x3ffff, v224
    v_sub_u32 v50, v53, v51
    v_and_b32 v50, 0xff, v50
    v_add3_u32 v224, v50, v51, v52
    v_and_b32 v51, 0x3ffff, v225
    v_sub_u32 v50, v53, v51
    v_and_b32 v50, 0xff, v50
    v_add3_u32 v225, v50, v51, v52
    s_barrier
    s_cmp_eq_u32 s64, 0
    s_cbranch_scc1 K2_MULTI
    ds_read_b128 v[48:51], v222 offset:0
    ds_read_b128 v[52:55], v222 offset:64
    ds_read_b128 v[56:59], v222 offset:128
    ds_read_b128 v[60:63], v222 offset:192
    ds_read_b128 v[64:67], v223 offset:0
    ds_read_b128 v[68:71], v223 offset:64
    ds_read_b128 v[72:75], v223 offset:128
    ds_read_b128 v[76:79], v223 offset:192
    ds_read_b128 v[80:83], v222 offset:256
    ds_read_b128 v[84:87], v222 offset:640
    ds_read_b128 v[88:91], v222 offset:1024
    s_waitcnt vmcnt(19) lgkmcnt(10)
    v_mfma_f32_16x16x32_bf16 v[0:3], v[96:99], v[48:51], 0
    ds_read_b128 v[92:95], v222 offset:320
    s_waitcnt vmcnt(18) lgkmcnt(10)
    v_mfma_f32_16x16x32_bf16 v[0:3], v[100:103], v[52:55], v[0:3]
    ds_read_b128 v[48:51], v222 offset:704
    s_waitcnt vmcnt(17) lgkmcnt(10)
    v_mfma_f32_16x16x32_bf16 v[0:3], v[104:107], v[56:59], v[0:3]
    ds_read_b128 v[52:55], v222 offset:1088
    s_waitcnt vmcnt(16) lgkmcnt(10)
    v_mfma_f32_16x16x32_bf16 v[0:3], v[108:111], v[60:63], v[0:3]
    ds_read_b128 v[56:59], v222 offset:384
    s_waitcnt vmcnt(15) lgkmcnt(10)
    v_mfma_f32_16x16x32_bf16 v[0:3], v[112:115], v[64:67], v[0:3]
    ds_read_b128 v[60:63], v222 offset:768
    s_waitcnt vmcnt(14) lgkmcnt(10)
    v_mfma_f32_16x16x32_bf16 v[0:3], v[116:119], v[68:71], v[0:3]
    ds_read_b128 v[64:67], v222 offset:1152
    s_waitcnt vmcnt(13) lgkmcnt(10)
    v_mfma_f32_16x16x32_bf16 v[0:3], v[120:123], v[72:75], v[0:3]
    ds_read_b128 v[68:71], v222 offset:448
    s_waitcnt vmcnt(12) lgkmcnt(10)
    v_mfma_f32_16x16x32_bf16 v[0:3], v[124:127], v[76:79], v[0:3]
    ds_read_b128 v[72:75], v222 offset:832
    s_waitcnt vmcnt(11) lgkmcnt(10)
    v_mfma_f32_16x16x32_bf16 v[4:7], v[128:131], v[80:83], 0
    ds_read_b128 v[76:79], v222 offset:1216
    s_waitcnt lgkmcnt(10)
    v_mfma_f32_16x16x32_bf16 v[8:11], v[128:131], v[84:87], 0
    ds_read_b128 v[80:83], v222 offset:512
    s_waitcnt lgkmcnt(10)
    v_mfma_f32_16x16x32_bf16 v[12:15], v[128:131], v[88:91], 0
    ds_read_b128 v[84:87], v222 offset:896
    s_waitcnt vmcnt(10) lgkmcnt(10)
    v_mfma_f32_16x16x32_bf16 v[4:7], v[132:135], v[92:95], v[4:7]
    ds_read_b128 v[88:91], v222 offset:1280
    s_waitcnt lgkmcnt(10)
    v_mfma_f32_16x16x32_bf16 v[8:11], v[132:135], v[48:51], v[8:11]
    ds_read_b128 v[92:95], v222 offset:576
    s_waitcnt lgkmcnt(10)
    v_mfma_f32_16x16x32_bf16 v[12:15], v[132:135], v[52:55], v[12:15]
    ds_read_b128 v[48:51], v222 offset:960
    s_waitcnt vmcnt(9) lgkmcnt(10)
    v_mfma_f32_16x16x32_bf16 v[4:7], v[136:139], v[56:59], v[4:7]
    ds_read_b128 v[52:55], v222 offset:1344
    s_waitcnt lgkmcnt(10)
    v_mfma_f32_16x16x32_bf16 v[8:11], v[136:139], v[60:63], v[8:11]
    ds_read_b128 v[56:59], v223 offset:256
    s_waitcnt lgkmcnt(10)
    v_mfma_f32_16x16x32_bf16 v[12:15], v[136:139], v[64:67], v[12:15]
    ds_read_b128 v[60:63], v223 offset:640
    s_waitcnt vmcnt(8) lgkmcnt(10)
    v_mfma_f32_16x16x32_bf16 v[4:7], v[140:143], v[68:71], v[4:7]
    ds_read_b128 v[64:67], v223 offset:1024
    s_waitcnt lgkmcnt(10)
    v_mfma_f32_16x16x32_bf16 v[8:11], v[140:143], v[72:75], v[8:11]
    ds_read_b128 v[68:71], v223 offset:320
    s_waitcnt lgkmcnt(10)
    v_mfma_f32_16x16x32_bf16 v[12:15], v[140:143], v[76:79], v[12:15]
    ds_read_b128 v[72:75], v223 offset:704
    s_waitcnt vmcnt(7) lgkmcnt(10)
    v_mfma_f32_16x16x32_bf16 v[4:7], v[144:147], v[80:83], v[4:7]
    ds_read_b128 v[76:79], v223 offset:1088
    s_waitcnt lgkmcnt(10)
    v_mfma_f32_16x16x32_bf16 v[8:11], v[144:147], v[84:87], v[8:11]
    ds_read_b128 v[80:83], v223 offset:384
    s_waitcnt lgkmcnt(10)
    v_mfma_f32_16x16x32_bf16 v[12:15], v[144:147], v[88:91], v[12:15]
    ds_read_b128 v[84:87], v223 offset:768
    s_waitcnt vmcnt(6) lgkmcnt(10)
    v_mfma_f32_16x16x32_bf16 v[4:7], v[148:151], v[92:95], v[4:7]
    ds_read_b128 v[88:91], v223 offset:1152
    s_waitcnt lgkmcnt(10)
    v_mfma_f32_16x16x32_bf16 v[8:11], v[148:151], v[48:51], v[8:11]
    ds_read_b128 v[92:95], v223 offset:448
    s_waitcnt lgkmcnt(10)
    v_mfma_f32_16x16x32_bf16 v[12:15], v[148:151], v[52:55], v[12:15]
    ds_read_b128 v[48:51], v223 offset:832
    s_waitcnt vmcnt(5) lgkmcnt(10)
    v_mfma_f32_16x16x32_bf16 v[4:7], v[152:155], v[56:59], v[4:7]
    ds_read_b128 v[52:55], v223 offset:1216
    s_waitcnt lgkmcnt(10)
    v_mfma_f32_16x16x32_bf16 v[8:11], v[152:155], v[60:63], v[8:11]
    ds_read_b128 v[56:59], v223 offset:512
    s_waitcnt lgkmcnt(10)
    v_mfma_f32_16x16x32_bf16 v[12:15], v[152:155], v[64:67], v[12:15]
    ds_read_b128 v[60:63], v223 offset:896
    s_waitcnt vmcnt(4) lgkmcnt(10)
    v_mfma_f32_16x16x32_bf16 v[4:7], v[156:159], v[68:71], v[4:7]
    ds_read_b128 v[64:67], v223 offset:1280
    s_waitcnt lgkmcnt(10)
    v_mfma_f32_16x16x32_bf16 v[8:11], v[156:159], v[72:75], v[8:11]
    ds_read_b128 v[68:71], v223 offset:576
    s_waitcnt lgkmcnt(10)
    v_mfma_f32_16x16x32_bf16 v[12:15], v[156:159], v[76:79], v[12:15]
    ds_read_b128 v[72:75], v223 offset:960
    s_waitcnt vmcnt(3) lgkmcnt(10)
    v_mfma_f32_16x16x32_bf16 v[4:7], v[160:163], v[80:83], v[4:7]
    ds_read_b128 v[76:79], v223 offset:1344
    s_waitcnt lgkmcnt(10)
    v_mfma_f32_16x16x32_bf16 v[8:11], v[160:163], v[84:87], v[8:11]
    ds_read_b128 v[80:83], v222 offset:3072
    s_waitcnt lgkmcnt(10)
    v_mfma_f32_16x16x32_bf16 v[12:15], v[160:163], v[88:91], v[12:15]
    ds_read_b128 v[84:87], v222 offset:3136
    s_waitcnt vmcnt(2) lgkmcnt(10)
    v_mfma_f32_16x16x32_bf16 v[4:7], v[164:167], v[92:95], v[4:7]
    ds_read_b128 v[88:91], v222 offset:3200
    s_waitcnt lgkmcnt(10)
    v_mfma_f32_16x16x32_bf16 v[8:11], v[164:167], v[48:51], v[8:11]
    ds_read_b128 v[92:95], v222 offset:3264
    s_waitcnt lgkmcnt(10)
    v_mfma_f32_16x16x32_bf16 v[12:15], v[164:167], v[52:55], v[12:15]
    ds_read_b128 v[48:51], v224 offset:0
    s_waitcnt vmcnt(1) lgkmcnt(10)
    v_mfma_f32_16x16x32_bf16 v[4:7], v[168:171], v[56:59], v[4:7]
    ds_read_b128 v[52:55], v224 offset:64
    s_waitcnt lgkmcnt(10)
    v_mfma_f32_16x16x32_bf16 v[8:11], v[168:171], v[60:63], v[8:11]
    ds_read_b128 v[56:59], v224 offset:128
    s_waitcnt lgkmcnt(10)
    v_mfma_f32_16x16x32_bf16 v[12:15], v[168:171], v[64:67], v[12:15]
    ds_read_b128 v[60:63], v224 offset:192
    s_waitcnt vmcnt(0) lgkmcnt(10)
    v_mfma_f32_16x16x32_bf16 v[4:7], v[172:175], v[68:71], v[4:7]
    ds_read_b128 v[64:67], v222 offset:3328
    s_waitcnt lgkmcnt(10)
    v_mfma_f32_16x16x32_bf16 v[8:11], v[172:175], v[72:75], v[8:11]
    ds_read_b128 v[68:71], v222 offset:3712
    s_waitcnt lgkmcnt(10)
    v_mfma_f32_16x16x32_bf16 v[12:15], v[172:175], v[76:79], v[12:15]
    ds_read_b128 v[72:75], v222 offset:4096
    s_waitcnt lgkmcnt(10)
    v_mfma_f32_16x16x32_bf16 v[16:19], v[96:99], v[80:83], 0
    ds_read_b128 v[76:79], v222 offset:3392
    s_waitcnt lgkmcnt(10)
    v_mfma_f32_16x16x32_bf16 v[16:19], v[100:103], v[84:87], v[16:19]
    ds_read_b128 v[80:83], v222 offset:3776
    s_waitcnt lgkmcnt(10)
    v_mfma_f32_16x16x32_bf16 v[16:19], v[104:107], v[88:91], v[16:19]
    s_barrier
    ds_read_b128 v[84:87], v222 offset:4160
    s_waitcnt lgkmcnt(10)
    v_mfma_f32_16x16x32_bf16 v[16:19], v[108:111], v[92:95], v[16:19]
    v_mul_f32 v200, s63, v0
    ds_read_b128 v[88:91], v222 offset:3456
    s_waitcnt lgkmcnt(10)
    v_mfma_f32_16x16x32_bf16 v[16:19], v[112:115], v[48:51], v[16:19]
    v_mul_f32 v201, s63, v1
    ds_read_b128 v[92:95], v222 offset:3840
    s_waitcnt lgkmcnt(10)
    v_mfma_f32_16x16x32_bf16 v[16:19], v[116:119], v[52:55], v[16:19]
    v_mul_f32 v202, s63, v2
    ds_read_b128 v[48:51], v222 offset:4224
    s_waitcnt lgkmcnt(10)
    v_mfma_f32_16x16x32_bf16 v[16:19], v[120:123], v[56:59], v[16:19]
    v_mul_f32 v203, s63, v3
    ds_read_b128 v[52:55], v222 offset:3520
    s_waitcnt lgkmcnt(10)
    v_mfma_f32_16x16x32_bf16 v[16:19], v[124:127], v[60:63], v[16:19]
    v_exp_f32 v200, v200
    ds_read_b128 v[56:59], v222 offset:3904
    s_waitcnt lgkmcnt(10)
    v_mfma_f32_16x16x32_bf16 v[20:23], v[128:131], v[64:67], 0
    v_exp_f32 v201, v201
    ds_read_b128 v[60:63], v222 offset:4288
    s_waitcnt lgkmcnt(10)
    v_mfma_f32_16x16x32_bf16 v[24:27], v[128:131], v[68:71], 0
    v_exp_f32 v202, v202
    ds_read_b128 v[64:67], v222 offset:3584
    s_waitcnt lgkmcnt(10)
    v_mfma_f32_16x16x32_bf16 v[28:31], v[128:131], v[72:75], 0
    v_exp_f32 v203, v203
    ds_read_b128 v[68:71], v222 offset:3968
    s_waitcnt lgkmcnt(10)
    v_mfma_f32_16x16x32_bf16 v[20:23], v[132:135], v[76:79], v[20:23]
    v_add_f32 v200, 1.0, v200
    ds_read_b128 v[72:75], v222 offset:4352
    s_waitcnt lgkmcnt(10)
    v_mfma_f32_16x16x32_bf16 v[24:27], v[132:135], v[80:83], v[24:27]
    v_add_f32 v201, 1.0, v201
    ds_read_b128 v[76:79], v222 offset:3648
    s_waitcnt lgkmcnt(10)
    v_mfma_f32_16x16x32_bf16 v[28:31], v[132:135], v[84:87], v[28:31]
    v_add_f32 v202, 1.0, v202
    ds_read_b128 v[80:83], v222 offset:4032
    s_waitcnt lgkmcnt(10)
    v_mfma_f32_16x16x32_bf16 v[20:23], v[136:139], v[88:91], v[20:23]
    v_add_f32 v203, 1.0, v203
    ds_read_b128 v[84:87], v222 offset:4416
    s_waitcnt lgkmcnt(10)
    v_mfma_f32_16x16x32_bf16 v[24:27], v[136:139], v[92:95], v[24:27]
    v_rcp_f32 v200, v200
    ds_read_b128 v[88:91], v224 offset:256
    s_waitcnt lgkmcnt(10)
    v_mfma_f32_16x16x32_bf16 v[28:31], v[136:139], v[48:51], v[28:31]
    v_rcp_f32 v201, v201
    ds_read_b128 v[92:95], v224 offset:640
    s_waitcnt lgkmcnt(10)
    v_mfma_f32_16x16x32_bf16 v[20:23], v[140:143], v[52:55], v[20:23]
    v_rcp_f32 v202, v202
    ds_read_b128 v[48:51], v224 offset:1024
    s_waitcnt lgkmcnt(10)
    v_mfma_f32_16x16x32_bf16 v[24:27], v[140:143], v[56:59], v[24:27]
    v_rcp_f32 v203, v203
    ds_read_b128 v[52:55], v224 offset:320
    s_waitcnt lgkmcnt(10)
    v_mfma_f32_16x16x32_bf16 v[28:31], v[140:143], v[60:63], v[28:31]
    v_cvt_pk_bf16_f32 v176, v0, v1
    ds_read_b128 v[56:59], v224 offset:704
    s_waitcnt lgkmcnt(10)
    v_mfma_f32_16x16x32_bf16 v[20:23], v[144:147], v[64:67], v[20:23]
    v_cvt_pk_bf16_f32 v177, v2, v3
    ds_read_b128 v[60:63], v224 offset:1088
    s_waitcnt lgkmcnt(10)
    v_mfma_f32_16x16x32_bf16 v[24:27], v[144:147], v[68:71], v[24:27]
    v_mul_f32 v4, v4, v200
    ds_read_b128 v[64:67], v224 offset:384
    s_waitcnt lgkmcnt(10)
    v_mfma_f32_16x16x32_bf16 v[28:31], v[144:147], v[72:75], v[28:31]
    v_mul_f32 v5, v5, v201
    ds_read_b128 v[68:71], v224 offset:768
    s_waitcnt lgkmcnt(10)
    v_mfma_f32_16x16x32_bf16 v[20:23], v[148:151], v[76:79], v[20:23]
    v_mul_f32 v6, v6, v202
    ds_read_b128 v[72:75], v224 offset:1152
    s_waitcnt lgkmcnt(10)
    v_mfma_f32_16x16x32_bf16 v[24:27], v[148:151], v[80:83], v[24:27]
    v_mul_f32 v7, v7, v203
    ds_read_b128 v[76:79], v224 offset:448
    s_waitcnt lgkmcnt(10)
    v_mfma_f32_16x16x32_bf16 v[28:31], v[148:151], v[84:87], v[28:31]
    v_cvt_pk_bf16_f32 v178, v4, v5
    ds_read_b128 v[80:83], v224 offset:832
    s_waitcnt lgkmcnt(10)
    v_mfma_f32_16x16x32_bf16 v[20:23], v[152:155], v[88:91], v[20:23]
    v_cvt_pk_bf16_f32 v179, v6, v7
    ds_read_b128 v[84:87], v224 offset:1216
    s_waitcnt lgkmcnt(10)
    v_mfma_f32_16x16x32_bf16 v[24:27], v[152:155], v[92:95], v[24:27]
    v_mul_f32 v8, v8, v200
    ds_read_b128 v[88:91], v224 offset:512
    s_waitcnt lgkmcnt(10)
    v_mfma_f32_16x16x32_bf16 v[28:31], v[152:155], v[48:51], v[28:31]
    v_mul_f32 v9, v9, v201
    ds_read_b128 v[92:95], v224 offset:896
    s_waitcnt lgkmcnt(10)
    v_mfma_f32_16x16x32_bf16 v[20:23], v[156:159], v[52:55], v[20:23]
    v_mul_f32 v10, v10, v202
    ds_read_b128 v[48:51], v224 offset:1280
    s_waitcnt lgkmcnt(10)
    v_mfma_f32_16x16x32_bf16 v[24:27], v[156:159], v[56:59], v[24:27]
    v_mul_f32 v11, v11, v203
    ds_read_b128 v[52:55], v224 offset:576
    s_waitcnt lgkmcnt(10)
    v_mfma_f32_16x16x32_bf16 v[28:31], v[156:159], v[60:63], v[28:31]
    v_cvt_pk_bf16_f32 v180, v8, v9
    ds_read_b128 v[56:59], v224 offset:960
    s_waitcnt lgkmcnt(10)
    v_mfma_f32_16x16x32_bf16 v[20:23], v[160:163], v[64:67], v[20:23]
    v_cvt_pk_bf16_f32 v181, v10, v11
    ds_read_b128 v[60:63], v224 offset:1344
    s_waitcnt lgkmcnt(10)
    v_mfma_f32_16x16x32_bf16 v[24:27], v[160:163], v[68:71], v[24:27]
    v_mul_f32 v12, v12, v200
    ds_read_b128 v[64:67], v222 offset:6144
    s_waitcnt lgkmcnt(10)
    v_mfma_f32_16x16x32_bf16 v[28:31], v[160:163], v[72:75], v[28:31]
    v_mul_f32 v13, v13, v201
    ds_read_b128 v[68:71], v222 offset:6208
    s_waitcnt lgkmcnt(10)
    v_mfma_f32_16x16x32_bf16 v[20:23], v[164:167], v[76:79], v[20:23]
    v_mul_f32 v14, v14, v202
    ds_read_b128 v[72:75], v222 offset:6272
    s_waitcnt lgkmcnt(10)
    v_mfma_f32_16x16x32_bf16 v[24:27], v[164:167], v[80:83], v[24:27]
    v_mul_f32 v15, v15, v203
    ds_read_b128 v[76:79], v222 offset:6336
    s_waitcnt lgkmcnt(10)
    v_mfma_f32_16x16x32_bf16 v[28:31], v[164:167], v[84:87], v[28:31]
    v_cvt_pk_bf16_f32 v182, v12, v13
    ds_read_b128 v[80:83], v225 offset:0
    s_waitcnt lgkmcnt(10)
    v_mfma_f32_16x16x32_bf16 v[20:23], v[168:171], v[88:91], v[20:23]
    v_cvt_pk_bf16_f32 v183, v14, v15
    ds_read_b128 v[84:87], v225 offset:64
    s_waitcnt lgkmcnt(10)
    v_mfma_f32_16x16x32_bf16 v[24:27], v[168:171], v[92:95], v[24:27]
    ds_write_b64 v226, v[176:177] offset:0
    ds_write_b64 v226, v[178:179] offset:256
    ds_write_b64 v226, v[180:181] offset:512
    ds_write_b64 v226, v[182:183] offset:768
    ds_read_b128 v[88:91], v225 offset:128
    s_waitcnt lgkmcnt(14)
    v_mfma_f32_16x16x32_bf16 v[28:31], v[168:171], v[48:51], v[28:31]
    ds_read_b128 v[92:95], v225 offset:192
    s_waitcnt lgkmcnt(14)
    v_mfma_f32_16x16x32_bf16 v[20:23], v[172:175], v[52:55], v[20:23]
    ds_read_b128 v[48:51], v222 offset:6400
    s_waitcnt lgkmcnt(14)
    v_mfma_f32_16x16x32_bf16 v[24:27], v[172:175], v[56:59], v[24:27]
    ds_read_b128 v[52:55], v222 offset:6784
    s_waitcnt lgkmcnt(14)
    v_mfma_f32_16x16x32_bf16 v[28:31], v[172:175], v[60:63], v[28:31]
    ds_read_b128 v[56:59], v222 offset:7168
    s_waitcnt lgkmcnt(14)
    v_mfma_f32_16x16x32_bf16 v[32:35], v[96:99], v[64:67], 0
    ds_read_b128 v[60:63], v222 offset:6464
    s_waitcnt lgkmcnt(14)
    v_mfma_f32_16x16x32_bf16 v[32:35], v[100:103], v[68:71], v[32:35]
    ds_read_b128 v[64:67], v222 offset:6848
    s_waitcnt lgkmcnt(14)
    v_mfma_f32_16x16x32_bf16 v[32:35], v[104:107], v[72:75], v[32:35]
    ds_read_b128 v[68:71], v222 offset:7232
    s_waitcnt lgkmcnt(14)
    v_mfma_f32_16x16x32_bf16 v[32:35], v[108:111], v[76:79], v[32:35]
    v_mul_f32 v200, s63, v16
    ds_read_b128 v[72:75], v222 offset:6528
    s_waitcnt lgkmcnt(14)
    v_mfma_f32_16x16x32_bf16 v[32:35], v[112:115], v[80:83], v[32:35]
    v_mul_f32 v201, s63, v17
    ds_read_b128 v[76:79], v222 offset:6912
    s_waitcnt lgkmcnt(14)
    v_mfma_f32_16x16x32_bf16 v[32:35], v[116:119], v[84:87], v[32:35]
    v_mul_f32 v202, s63, v18
    ds_read_b128 v[80:83], v222 offset:7296
    s_waitcnt lgkmcnt(10)
    v_mfma_f32_16x16x32_bf16 v[32:35], v[120:123], v[88:91], v[32:35]
    v_mul_f32 v203, s63, v19
    ds_read_b128 v[84:87], v222 offset:6592
    s_waitcnt lgkmcnt(10)
    v_mfma_f32_16x16x32_bf16 v[32:35], v[124:127], v[92:95], v[32:35]
    s_barrier
    ds_read_b128 v[192:195], v228 offset:0
    ds_read_b128 v[196:199], v228 offset:1536
    v_exp_f32 v200, v200
    ds_read_b128 v[88:91], v222 offset:6976
    s_waitcnt lgkmcnt(12)
    v_mfma_f32_16x16x32_bf16 v[36:39], v[128:131], v[48:51], 0
    v_exp_f32 v201, v201
    ds_read_b128 v[92:95], v222 offset:7360
    s_waitcnt lgkmcnt(12)
    v_mfma_f32_16x16x32_bf16 v[40:43], v[128:131], v[52:55], 0
    v_exp_f32 v202, v202
    ds_read_b128 v[48:51], v222 offset:6656
    s_waitcnt lgkmcnt(12)
    v_mfma_f32_16x16x32_bf16 v[44:47], v[128:131], v[56:59], 0
    v_exp_f32 v203, v203
    ds_read_b128 v[52:55], v222 offset:7040
    s_waitcnt lgkmcnt(12)
    v_mfma_f32_16x16x32_bf16 v[36:39], v[132:135], v[60:63], v[36:39]
    v_add_f32 v200, 1.0, v200
    ds_read_b128 v[56:59], v222 offset:7424
    s_waitcnt lgkmcnt(12)
    v_mfma_f32_16x16x32_bf16 v[40:43], v[132:135], v[64:67], v[40:43]
    v_add_f32 v201, 1.0, v201
    ds_read_b128 v[60:63], v222 offset:6720
    s_waitcnt lgkmcnt(12)
    v_mfma_f32_16x16x32_bf16 v[44:47], v[132:135], v[68:71], v[44:47]
    v_add_f32 v202, 1.0, v202
    ds_read_b128 v[64:67], v222 offset:7104
    s_waitcnt lgkmcnt(12)
    v_mfma_f32_16x16x32_bf16 v[36:39], v[136:139], v[72:75], v[36:39]
    v_add_f32 v203, 1.0, v203
    ds_read_b128 v[68:71], v222 offset:7488
    s_waitcnt lgkmcnt(12)
    v_mfma_f32_16x16x32_bf16 v[40:43], v[136:139], v[76:79], v[40:43]
    v_rcp_f32 v200, v200
    ds_read_b128 v[72:75], v225 offset:256
    s_waitcnt lgkmcnt(12)
    v_mfma_f32_16x16x32_bf16 v[44:47], v[136:139], v[80:83], v[44:47]
    v_rcp_f32 v201, v201
    ds_read_b128 v[76:79], v225 offset:640
    s_waitcnt lgkmcnt(12)
    v_mfma_f32_16x16x32_bf16 v[36:39], v[140:143], v[84:87], v[36:39]
    v_rcp_f32 v202, v202
    ds_read_b128 v[80:83], v225 offset:1024
    s_waitcnt lgkmcnt(10)
    v_mfma_f32_16x16x32_bf16 v[40:43], v[140:143], v[88:91], v[40:43]
    v_rcp_f32 v203, v203
    ds_read_b128 v[84:87], v225 offset:320
    s_waitcnt lgkmcnt(10)
    v_mfma_f32_16x16x32_bf16 v[44:47], v[140:143], v[92:95], v[44:47]
    v_cvt_pk_bf16_f32 v184, v16, v17
    s_add_u32 s61, s20, 8
    v_readlane_b32 s41, v253, s61
    s_nop 0
    s_bfe_u32 s41, s41, 0x60015
    s_add_u32 s41, s41, s21
    s_lshl_b32 s41, s41, 10
    s_add_u32 s61, s20, 0
    v_readlane_b32 s40, v253, s61
    s_nop 0
    s_bfe_u32 s40, s40, 0x60015
    s_add_u32 s40, s40, s21
    s_lshl_b32 s40, s40, 10
    s_nop 0
    buffer_store_dwordx4 v[192:195], v229, s[12:15], s40 offen sc1
    buffer_store_dwordx4 v[196:199], v229, s[12:15], s41 offen sc1
    ds_read_b128 v[88:91], v225 offset:704
    s_waitcnt lgkmcnt(10)
    v_mfma_f32_16x16x32_bf16 v[36:39], v[144:147], v[48:51], v[36:39]
    v_cvt_pk_bf16_f32 v185, v18, v19
    ds_read_b128 v[92:95], v225 offset:1088
    s_waitcnt lgkmcnt(10)
    v_mfma_f32_16x16x32_bf16 v[40:43], v[144:147], v[52:55], v[40:43]
    v_mul_f32 v20, v20, v200
    ds_read_b128 v[48:51], v225 offset:384
    s_waitcnt lgkmcnt(10)
    v_mfma_f32_16x16x32_bf16 v[44:47], v[144:147], v[56:59], v[44:47]
    v_mul_f32 v21, v21, v201
    ds_read_b128 v[52:55], v225 offset:768
    s_waitcnt lgkmcnt(10)
    v_mfma_f32_16x16x32_bf16 v[36:39], v[148:151], v[60:63], v[36:39]
    v_mul_f32 v22, v22, v202
    ds_read_b128 v[56:59], v225 offset:1152
    s_waitcnt lgkmcnt(10)
    v_mfma_f32_16x16x32_bf16 v[40:43], v[148:151], v[64:67], v[40:43]
    v_mul_f32 v23, v23, v203
    ds_read_b128 v[60:63], v225 offset:448
    s_waitcnt lgkmcnt(10)
    v_mfma_f32_16x16x32_bf16 v[44:47], v[148:151], v[68:71], v[44:47]
    v_cvt_pk_bf16_f32 v186, v20, v21
    ds_read_b128 v[64:67], v225 offset:832
    s_waitcnt lgkmcnt(10)
    v_mfma_f32_16x16x32_bf16 v[36:39], v[152:155], v[72:75], v[36:39]
    v_cvt_pk_bf16_f32 v187, v22, v23
    ds_read_b128 v[68:71], v225 offset:1216
    s_waitcnt lgkmcnt(10)
    v_mfma_f32_16x16x32_bf16 v[40:43], v[152:155], v[76:79], v[40:43]
    v_mul_f32 v24, v24, v200
    ds_read_b128 v[72:75], v225 offset:512
    s_waitcnt lgkmcnt(10)
    v_mfma_f32_16x16x32_bf16 v[44:47], v[152:155], v[80:83], v[44:47]
    v_mul_f32 v25, v25, v201
    ds_read_b128 v[76:79], v225 offset:896
    s_waitcnt lgkmcnt(10)
    v_mfma_f32_16x16x32_bf16 v[36:39], v[156:159], v[84:87], v[36:39]
    v_mul_f32 v26, v26, v202
    ds_read_b128 v[80:83], v225 offset:1280
    s_waitcnt lgkmcnt(10)
    v_mfma_f32_16x16x32_bf16 v[40:43], v[156:159], v[88:91], v[40:43]
    v_mul_f32 v27, v27, v203
    ds_read_b128 v[84:87], v225 offset:576
    s_waitcnt lgkmcnt(10)
    v_mfma_f32_16x16x32_bf16 v[44:47], v[156:159], v[92:95], v[44:47]
    v_cvt_pk_bf16_f32 v188, v24, v25
    ds_read_b128 v[88:91], v225 offset:960
    s_waitcnt lgkmcnt(10)
    v_mfma_f32_16x16x32_bf16 v[36:39], v[160:163], v[48:51], v[36:39]
    v_cvt_pk_bf16_f32 v189, v26, v27
    ds_read_b128 v[92:95], v225 offset:1344
    s_waitcnt lgkmcnt(10)
    v_mfma_f32_16x16x32_bf16 v[40:43], v[160:163], v[52:55], v[40:43]
    v_mul_f32 v28, v28, v200
    s_waitcnt lgkmcnt(9)
    v_mfma_f32_16x16x32_bf16 v[44:47], v[160:163], v[56:59], v[44:47]
    v_mul_f32 v29, v29, v201
    s_waitcnt lgkmcnt(8)
    v_mfma_f32_16x16x32_bf16 v[36:39], v[164:167], v[60:63], v[36:39]
    v_mul_f32 v30, v30, v202
    s_waitcnt lgkmcnt(7)
    v_mfma_f32_16x16x32_bf16 v[40:43], v[164:167], v[64:67], v[40:43]
    v_mul_f32 v31, v31, v203
    s_waitcnt lgkmcnt(6)
    v_mfma_f32_16x16x32_bf16 v[44:47], v[164:167], v[68:71], v[44:47]
    v_cvt_pk_bf16_f32 v190, v28, v29
    s_waitcnt lgkmcnt(5)
    v_mfma_f32_16x16x32_bf16 v[36:39], v[168:171], v[72:75], v[36:39]
    v_cvt_pk_bf16_f32 v191, v30, v31
    s_waitcnt lgkmcnt(4)
    v_mfma_f32_16x16x32_bf16 v[40:43], v[168:171], v[76:79], v[40:43]
    ds_write_b64 v226, v[184:185] offset:3072
    ds_write_b64 v226, v[186:187] offset:3328
    ds_write_b64 v226, v[188:189] offset:3584
    ds_write_b64 v226, v[190:191] offset:3840
    s_waitcnt lgkmcnt(7)
    v_mfma_f32_16x16x32_bf16 v[44:47], v[168:171], v[80:83], v[44:47]
    s_waitcnt lgkmcnt(6)
    v_mfma_f32_16x16x32_bf16 v[36:39], v[172:175], v[84:87], v[36:39]
    s_waitcnt lgkmcnt(5)
    v_mfma_f32_16x16x32_bf16 v[40:43], v[172:175], v[88:91], v[40:43]
    s_waitcnt lgkmcnt(4)
    v_mfma_f32_16x16x32_bf16 v[44:47], v[172:175], v[92:95], v[44:47]
    v_mul_f32 v200, s63, v32
    v_mul_f32 v201, s63, v33
    v_mul_f32 v202, s63, v34
    v_mul_f32 v203, s63, v35
    v_exp_f32 v200, v200
    v_exp_f32 v201, v201
    v_exp_f32 v202, v202
    v_exp_f32 v203, v203
    v_add_f32 v200, 1.0, v200
    v_add_f32 v201, 1.0, v201
    v_add_f32 v202, 1.0, v202
    v_add_f32 v203, 1.0, v203
    v_rcp_f32 v200, v200
    v_rcp_f32 v201, v201
    v_rcp_f32 v202, v202
    v_rcp_f32 v203, v203
    v_cvt_pk_bf16_f32 v176, v32, v33
    v_cvt_pk_bf16_f32 v177, v34, v35
    v_mul_f32 v36, v36, v200
    v_mul_f32 v37, v37, v201
    v_mul_f32 v38, v38, v202
    v_mul_f32 v39, v39, v203
    v_cvt_pk_bf16_f32 v178, v36, v37
    v_cvt_pk_bf16_f32 v179, v38, v39
    v_mul_f32 v40, v40, v200
    v_mul_f32 v41, v41, v201
    v_mul_f32 v42, v42, v202
    v_mul_f32 v43, v43, v203
    v_cvt_pk_bf16_f32 v180, v40, v41
    v_cvt_pk_bf16_f32 v181, v42, v43
    v_mul_f32 v44, v44, v200
    v_mul_f32 v45, v45, v201
    v_mul_f32 v46, v46, v202
    v_mul_f32 v47, v47, v203
    v_cvt_pk_bf16_f32 v182, v44, v45
    v_cvt_pk_bf16_f32 v183, v46, v47
    s_waitcnt lgkmcnt(0)
    s_barrier
    ds_read_b128 v[192:195], v228 offset:3072
    ds_read_b128 v[196:199], v228 offset:4608
    s_mov_b64 exec, s[56:57]
    ds_write_b64 v226, v[176:177] offset:6144
    ds_write_b64 v226, v[178:179] offset:6400
    ds_write_b64 v226, v[180:181] offset:6656
    ds_write_b64 v226, v[182:183] offset:6912
    s_mov_b64 exec, -1
    s_add_u32 s61, s20, 24
    v_readlane_b32 s43, v253, s61
    s_nop 0
    s_bfe_u32 s43, s43, 0x60015
    s_add_u32 s43, s43, s21
    s_lshl_b32 s43, s43, 10
    s_add_u32 s61, s20, 16
    v_readlane_b32 s42, v253, s61
    s_nop 0
    s_bfe_u32 s42, s42, 0x60015
    s_add_u32 s42, s42, s21
    s_lshl_b32 s42, s42, 10
    s_waitcnt lgkmcnt(4)
    buffer_store_dwordx4 v[192:195], v229, s[12:15], s42 offen sc1
    buffer_store_dwordx4 v[196:199], v229, s[12:15], s43 offen sc1
    s_waitcnt lgkmcnt(0)
    s_barrier
K2_LASTROW:
    s_add_u32 s59, s20, 32
    s_cmp_ge_u32 s59, s22
    s_cbranch_scc1 K2_FIN
    ds_read_b128 v[192:195], v228 offset:6144
    s_add_u32 s61, s20, 32
    v_readlane_b32 s44, v253, s61
    s_nop 0
    s_bfe_u32 s44, s44, 0x60015
    s_add_u32 s44, s44, s21
    s_lshl_b32 s44, s44, 10
    s_waitcnt lgkmcnt(0)
    buffer_store_dwordx4 v[192:195], v229, s[12:15], s44 offen sc1
K2_FIN:
    s_branch K2_END
K2_MULTI:
    ds_read_b128 v[48:51], v222 offset:0
    ds_read_b128 v[52:55], v222 offset:64
    ds_read_b128 v[56:59], v222 offset:128
    ds_read_b128 v[60:63], v222 offset:192
    ds_read_b128 v[64:67], v223 offset:0
    ds_read_b128 v[68:71], v223 offset:64
    ds_read_b128 v[72:75], v223 offset:128
    ds_read_b128 v[76:79], v223 offset:192
    ds_read_b128 v[80:83], v222 offset:256
    ds_read_b128 v[84:87], v222 offset:640
    ds_read_b128 v[88:91], v222 offset:1024
    s_waitcnt vmcnt(19) lgkmcnt(10)
    v_mfma_f32_16x16x32_bf16 v[0:3], v[96:99], v[48:51], 0
    ds_read_b128 v[92:95], v222 offset:320
    s_waitcnt vmcnt(18) lgkmcnt(10)
    v_mfma_f32_16x16x32_bf16 v[0:3], v[100:103], v[52:55], v[0:3]
    ds_read_b128 v[48:51], v222 offset:704
    s_waitcnt vmcnt(17) lgkmcnt(10)
    v_mfma_f32_16x16x32_bf16 v[0:3], v[104:107], v[56:59], v[0:3]
    ds_read_b128 v[52:55], v222 offset:1088
    s_waitcnt vmcnt(16) lgkmcnt(10)
    v_mfma_f32_16x16x32_bf16 v[0:3], v[108:111], v[60:63], v[0:3]
    ds_read_b128 v[56:59], v222 offset:384
    s_waitcnt vmcnt(15) lgkmcnt(10)
    v_mfma_f32_16x16x32_bf16 v[0:3], v[112:115], v[64:67], v[0:3]
    ds_read_b128 v[60:63], v222 offset:768
    s_waitcnt vmcnt(14) lgkmcnt(10)
    v_mfma_f32_16x16x32_bf16 v[0:3], v[116:119], v[68:71], v[0:3]
    ds_read_b128 v[64:67], v222 offset:1152
    s_waitcnt vmcnt(13) lgkmcnt(10)
    v_mfma_f32_16x16x32_bf16 v[0:3], v[120:123], v[72:75], v[0:3]
    ds_read_b128 v[68:71], v222 offset:448
    s_waitcnt vmcnt(12) lgkmcnt(10)
    v_mfma_f32_16x16x32_bf16 v[0:3], v[124:127], v[76:79], v[0:3]
    ds_read_b128 v[72:75], v222 offset:832
    s_waitcnt vmcnt(11) lgkmcnt(10)
    v_mfma_f32_16x16x32_bf16 v[4:7], v[128:131], v[80:83], 0
    ds_read_b128 v[76:79], v222 offset:1216
    s_waitcnt lgkmcnt(10)
    v_mfma_f32_16x16x32_bf16 v[8:11], v[128:131], v[84:87], 0
    ds_read_b128 v[80:83], v222 offset:512
    s_waitcnt lgkmcnt(10)
    v_mfma_f32_16x16x32_bf16 v[12:15], v[128:131], v[88:91], 0
    ds_read_b128 v[84:87], v222 offset:896
    s_waitcnt vmcnt(10) lgkmcnt(10)
    v_mfma_f32_16x16x32_bf16 v[4:7], v[132:135], v[92:95], v[4:7]
    ds_read_b128 v[88:91], v222 offset:1280
    s_waitcnt lgkmcnt(10)
    v_mfma_f32_16x16x32_bf16 v[8:11], v[132:135], v[48:51], v[8:11]
    ds_read_b128 v[92:95], v222 offset:576
    s_waitcnt lgkmcnt(10)
    v_mfma_f32_16x16x32_bf16 v[12:15], v[132:135], v[52:55], v[12:15]
    ds_read_b128 v[48:51], v222 offset:960
    s_waitcnt vmcnt(9) lgkmcnt(10)
    v_mfma_f32_16x16x32_bf16 v[4:7], v[136:139], v[56:59], v[4:7]
    ds_read_b128 v[52:55], v222 offset:1344
    s_waitcnt lgkmcnt(10)
    v_mfma_f32_16x16x32_bf16 v[8:11], v[136:139], v[60:63], v[8:11]
    ds_read_b128 v[56:59], v223 offset:256
    s_waitcnt lgkmcnt(10)
    v_mfma_f32_16x16x32_bf16 v[12:15], v[136:139], v[64:67], v[12:15]
    ds_read_b128 v[60:63], v223 offset:640
    s_waitcnt vmcnt(8) lgkmcnt(10)
    v_mfma_f32_16x16x32_bf16 v[4:7], v[140:143], v[68:71], v[4:7]
    ds_read_b128 v[64:67], v223 offset:1024
    s_waitcnt lgkmcnt(10)
    v_mfma_f32_16x16x32_bf16 v[8:11], v[140:143], v[72:75], v[8:11]
    ds_read_b128 v[68:71], v223 offset:320
    s_waitcnt lgkmcnt(10)
    v_mfma_f32_16x16x32_bf16 v[12:15], v[140:143], v[76:79], v[12:15]
    ds_read_b128 v[72:75], v223 offset:704
    s_waitcnt vmcnt(7) lgkmcnt(10)
    v_mfma_f32_16x16x32_bf16 v[4:7], v[144:147], v[80:83], v[4:7]
    ds_read_b128 v[76:79], v223 offset:1088
    s_waitcnt lgkmcnt(10)
    v_mfma_f32_16x16x32_bf16 v[8:11], v[144:147], v[84:87], v[8:11]
    ds_read_b128 v[80:83], v223 offset:384
    s_waitcnt lgkmcnt(10)
    v_mfma_f32_16x16x32_bf16 v[12:15], v[144:147], v[88:91], v[12:15]
    ds_read_b128 v[84:87], v223 offset:768
    s_waitcnt vmcnt(6) lgkmcnt(10)
    v_mfma_f32_16x16x32_bf16 v[4:7], v[148:151], v[92:95], v[4:7]
    ds_read_b128 v[88:91], v223 offset:1152
    s_waitcnt lgkmcnt(10)
    v_mfma_f32_16x16x32_bf16 v[8:11], v[148:151], v[48:51], v[8:11]
    ds_read_b128 v[92:95], v223 offset:448
    s_waitcnt lgkmcnt(10)
    v_mfma_f32_16x16x32_bf16 v[12:15], v[148:151], v[52:55], v[12:15]
    ds_read_b128 v[48:51], v223 offset:832
    s_waitcnt vmcnt(5) lgkmcnt(10)
    v_mfma_f32_16x16x32_bf16 v[4:7], v[152:155], v[56:59], v[4:7]
    ds_read_b128 v[52:55], v223 offset:1216
    s_waitcnt lgkmcnt(10)
    v_mfma_f32_16x16x32_bf16 v[8:11], v[152:155], v[60:63], v[8:11]
    ds_read_b128 v[56:59], v223 offset:512
    s_waitcnt lgkmcnt(10)
    v_mfma_f32_16x16x32_bf16 v[12:15], v[152:155], v[64:67], v[12:15]
    ds_read_b128 v[60:63], v223 offset:896
    s_waitcnt vmcnt(4) lgkmcnt(10)
    v_mfma_f32_16x16x32_bf16 v[4:7], v[156:159], v[68:71], v[4:7]
    ds_read_b128 v[64:67], v223 offset:1280
    s_waitcnt lgkmcnt(10)
    v_mfma_f32_16x16x32_bf16 v[8:11], v[156:159], v[72:75], v[8:11]
    ds_read_b128 v[68:71], v223 offset:576
    s_waitcnt lgkmcnt(10)
    v_mfma_f32_16x16x32_bf16 v[12:15], v[156:159], v[76:79], v[12:15]
    ds_read_b128 v[72:75], v223 offset:960
    s_waitcnt vmcnt(3) lgkmcnt(10)
    v_mfma_f32_16x16x32_bf16 v[4:7], v[160:163], v[80:83], v[4:7]
    ds_read_b128 v[76:79], v223 offset:1344
    s_waitcnt lgkmcnt(10)
    v_mfma_f32_16x16x32_bf16 v[8:11], v[160:163], v[84:87], v[8:11]
    ds_read_b128 v[80:83], v222 offset:3072
    s_waitcnt lgkmcnt(10)
    v_mfma_f32_16x16x32_bf16 v[12:15], v[160:163], v[88:91], v[12:15]
    ds_read_b128 v[84:87], v222 offset:3136
    s_waitcnt vmcnt(2) lgkmcnt(10)
    v_mfma_f32_16x16x32_bf16 v[4:7], v[164:167], v[92:95], v[4:7]
    ds_read_b128 v[88:91], v222 offset:3200
    s_waitcnt lgkmcnt(10)
    v_mfma_f32_16x16x32_bf16 v[8:11], v[164:167], v[48:51], v[8:11]
    ds_read_b128 v[92:95], v222 offset:3264
    s_waitcnt lgkmcnt(10)
    v_mfma_f32_16x16x32_bf16 v[12:15], v[164:167], v[52:55], v[12:15]
    ds_read_b128 v[48:51], v224 offset:0
    s_waitcnt vmcnt(1) lgkmcnt(10)
    v_mfma_f32_16x16x32_bf16 v[4:7], v[168:171], v[56:59], v[4:7]
    ds_read_b128 v[52:55], v224 offset:64
    s_waitcnt lgkmcnt(10)
    v_mfma_f32_16x16x32_bf16 v[8:11], v[168:171], v[60:63], v[8:11]
    ds_read_b128 v[56:59], v224 offset:128
    s_waitcnt lgkmcnt(10)
    v_mfma_f32_16x16x32_bf16 v[12:15], v[168:171], v[64:67], v[12:15]
    ds_read_b128 v[60:63], v224 offset:192
    s_waitcnt vmcnt(0) lgkmcnt(10)
    v_mfma_f32_16x16x32_bf16 v[4:7], v[172:175], v[68:71], v[4:7]
    ds_read_b128 v[64:67], v222 offset:3328
    s_waitcnt lgkmcnt(10)
    v_mfma_f32_16x16x32_bf16 v[8:11], v[172:175], v[72:75], v[8:11]
    ds_read_b128 v[68:71], v222 offset:3712
    s_waitcnt lgkmcnt(10)
    v_mfma_f32_16x16x32_bf16 v[12:15], v[172:175], v[76:79], v[12:15]
    ds_read_b128 v[72:75], v222 offset:4096
    s_waitcnt lgkmcnt(10)
    v_mfma_f32_16x16x32_bf16 v[16:19], v[96:99], v[80:83], 0
    ds_read_b128 v[76:79], v222 offset:3392
    s_waitcnt lgkmcnt(10)
    v_mfma_f32_16x16x32_bf16 v[16:19], v[100:103], v[84:87], v[16:19]
    ds_read_b128 v[80:83], v222 offset:3776
    s_waitcnt lgkmcnt(10)
    v_mfma_f32_16x16x32_bf16 v[16:19], v[104:107], v[88:91], v[16:19]
    ds_read_b128 v[84:87], v222 offset:4160
    s_waitcnt lgkmcnt(10)
    v_mfma_f32_16x16x32_bf16 v[16:19], v[108:111], v[92:95], v[16:19]
    ds_read_b128 v[88:91], v222 offset:3456
    s_waitcnt lgkmcnt(10)
    v_mfma_f32_16x16x32_bf16 v[16:19], v[112:115], v[48:51], v[16:19]
    ds_read_b128 v[92:95], v222 offset:3840
    s_waitcnt lgkmcnt(10)
    v_mfma_f32_16x16x32_bf16 v[16:19], v[116:119], v[52:55], v[16:19]
    ds_read_b128 v[48:51], v222 offset:4224
    s_waitcnt lgkmcnt(10)
    v_mfma_f32_16x16x32_bf16 v[16:19], v[120:123], v[56:59], v[16:19]
    ds_read_b128 v[52:55], v222 offset:3520
    s_waitcnt lgkmcnt(10)
    v_mfma_f32_16x16x32_bf16 v[16:19], v[124:127], v[60:63], v[16:19]
    ds_read_b128 v[56:59], v222 offset:3904
    s_waitcnt lgkmcnt(10)
    v_mfma_f32_16x16x32_bf16 v[20:23], v[128:131], v[64:67], 0
    ds_read_b128 v[60:63], v222 offset:4288
    s_waitcnt lgkmcnt(10)
    v_mfma_f32_16x16x32_bf16 v[24:27], v[128:131], v[68:71], 0
    ds_read_b128 v[64:67], v222 offset:3584
    s_waitcnt lgkmcnt(10)
    v_mfma_f32_16x16x32_bf16 v[28:31], v[128:131], v[72:75], 0
    ds_read_b128 v[68:71], v222 offset:3968
    s_waitcnt lgkmcnt(10)
    v_mfma_f32_16x16x32_bf16 v[20:23], v[132:135], v[76:79], v[20:23]
    ds_read_b128 v[72:75], v222 offset:4352
    s_waitcnt lgkmcnt(10)
    v_mfma_f32_16x16x32_bf16 v[24:27], v[132:135], v[80:83], v[24:27]
    ds_read_b128 v[76:79], v222 offset:3648
    s_waitcnt lgkmcnt(10)
    v_mfma_f32_16x16x32_bf16 v[28:31], v[132:135], v[84:87], v[28:31]
    ds_read_b128 v[80:83], v222 offset:4032
    s_waitcnt lgkmcnt(10)
    v_mfma_f32_16x16x32_bf16 v[20:23], v[136:139], v[88:91], v[20:23]
    ds_read_b128 v[84:87], v222 offset:4416
    s_waitcnt lgkmcnt(10)
    v_mfma_f32_16x16x32_bf16 v[24:27], v[136:139], v[92:95], v[24:27]
    ds_read_b128 v[88:91], v224 offset:256
    s_waitcnt lgkmcnt(10)
    v_mfma_f32_16x16x32_bf16 v[28:31], v[136:139], v[48:51], v[28:31]
    ds_read_b128 v[92:95], v224 offset:640
    s_waitcnt lgkmcnt(10)
    v_mfma_f32_16x16x32_bf16 v[20:23], v[140:143], v[52:55], v[20:23]
    ds_read_b128 v[48:51], v224 offset:1024
    s_waitcnt lgkmcnt(10)
    v_mfma_f32_16x16x32_bf16 v[24:27], v[140:143], v[56:59], v[24:27]
    ds_read_b128 v[52:55], v224 offset:320
    s_waitcnt lgkmcnt(10)
    v_mfma_f32_16x16x32_bf16 v[28:31], v[140:143], v[60:63], v[28:31]
    ds_read_b128 v[56:59], v224 offset:704
    s_waitcnt lgkmcnt(10)
    v_mfma_f32_16x16x32_bf16 v[20:23], v[144:147], v[64:67], v[20:23]
    ds_read_b128 v[60:63], v224 offset:1088
    s_waitcnt lgkmcnt(10)
    v_mfma_f32_16x16x32_bf16 v[24:27], v[144:147], v[68:71], v[24:27]
    ds_read_b128 v[64:67], v224 offset:384
    s_waitcnt lgkmcnt(10)
    v_mfma_f32_16x16x32_bf16 v[28:31], v[144:147], v[72:75], v[28:31]
    ds_read_b128 v[68:71], v224 offset:768
    s_waitcnt lgkmcnt(10)
    v_mfma_f32_16x16x32_bf16 v[20:23], v[148:151], v[76:79], v[20:23]
    ds_read_b128 v[72:75], v224 offset:1152
    s_waitcnt lgkmcnt(10)
    v_mfma_f32_16x16x32_bf16 v[24:27], v[148:151], v[80:83], v[24:27]
    ds_read_b128 v[76:79], v224 offset:448
    s_waitcnt lgkmcnt(10)
    v_mfma_f32_16x16x32_bf16 v[28:31], v[148:151], v[84:87], v[28:31]
    ds_read_b128 v[80:83], v224 offset:832
    s_waitcnt lgkmcnt(10)
    v_mfma_f32_16x16x32_bf16 v[20:23], v[152:155], v[88:91], v[20:23]
    ds_read_b128 v[84:87], v224 offset:1216
    s_waitcnt lgkmcnt(10)
    v_mfma_f32_16x16x32_bf16 v[24:27], v[152:155], v[92:95], v[24:27]
    ds_read_b128 v[88:91], v224 offset:512
    s_waitcnt lgkmcnt(10)
    v_mfma_f32_16x16x32_bf16 v[28:31], v[152:155], v[48:51], v[28:31]
    ds_read_b128 v[92:95], v224 offset:896
    s_waitcnt lgkmcnt(10)
    v_mfma_f32_16x16x32_bf16 v[20:23], v[156:159], v[52:55], v[20:23]
    ds_read_b128 v[48:51], v224 offset:1280
    s_waitcnt lgkmcnt(10)
    v_mfma_f32_16x16x32_bf16 v[24:27], v[156:159], v[56:59], v[24:27]
    ds_read_b128 v[52:55], v224 offset:576
    s_waitcnt lgkmcnt(10)
    v_mfma_f32_16x16x32_bf16 v[28:31], v[156:159], v[60:63], v[28:31]
    ds_read_b128 v[56:59], v224 offset:960
    s_waitcnt lgkmcnt(10)
    v_mfma_f32_16x16x32_bf16 v[20:23], v[160:163], v[64:67], v[20:23]
    ds_read_b128 v[60:63], v224 offset:1344
    s_waitcnt lgkmcnt(10)
    v_mfma_f32_16x16x32_bf16 v[24:27], v[160:163], v[68:71], v[24:27]
    ds_read_b128 v[64:67], v222 offset:6144
    s_waitcnt lgkmcnt(10)
    v_mfma_f32_16x16x32_bf16 v[28:31], v[160:163], v[72:75], v[28:31]
    ds_read_b128 v[68:71], v222 offset:6208
    s_waitcnt lgkmcnt(10)
    v_mfma_f32_16x16x32_bf16 v[20:23], v[164:167], v[76:79], v[20:23]
    ds_read_b128 v[72:75], v222 offset:6272
    s_waitcnt lgkmcnt(10)
    v_mfma_f32_16x16x32_bf16 v[24:27], v[164:167], v[80:83], v[24:27]
    ds_read_b128 v[76:79], v222 offset:6336
    s_waitcnt lgkmcnt(10)
    v_mfma_f32_16x16x32_bf16 v[28:31], v[164:167], v[84:87], v[28:31]
    ds_read_b128 v[80:83], v225 offset:0
    s_waitcnt lgkmcnt(10)
    v_mfma_f32_16x16x32_bf16 v[20:23], v[168:171], v[88:91], v[20:23]
    ds_read_b128 v[84:87], v225 offset:64
    s_waitcnt lgkmcnt(10)
    v_mfma_f32_16x16x32_bf16 v[24:27], v[168:171], v[92:95], v[24:27]
    ds_read_b128 v[88:91], v225 offset:128
    s_waitcnt lgkmcnt(10)
    v_mfma_f32_16x16x32_bf16 v[28:31], v[168:171], v[48:51], v[28:31]
    ds_read_b128 v[92:95], v225 offset:192
    s_waitcnt lgkmcnt(10)
    v_mfma_f32_16x16x32_bf16 v[20:23], v[172:175], v[52:55], v[20:23]
    ds_read_b128 v[48:51], v222 offset:6400
    s_waitcnt lgkmcnt(10)
    v_mfma_f32_16x16x32_bf16 v[24:27], v[172:175], v[56:59], v[24:27]
    ds_read_b128 v[52:55], v222 offset:6784
    s_waitcnt lgkmcnt(10)
    v_mfma_f32_16x16x32_bf16 v[28:31], v[172:175], v[60:63], v[28:31]
    ds_read_b128 v[56:59], v222 offset:7168
    s_waitcnt lgkmcnt(10)
    v_mfma_f32_16x16x32_bf16 v[32:35], v[96:99], v[64:67], 0
    ds_read_b128 v[60:63], v222 offset:6464
    s_waitcnt lgkmcnt(10)
    v_mfma_f32_16x16x32_bf16 v[32:35], v[100:103], v[68:71], v[32:35]
    ds_read_b128 v[64:67], v222 offset:6848
    s_waitcnt lgkmcnt(10)
    v_mfma_f32_16x16x32_bf16 v[32:35], v[104:107], v[72:75], v[32:35]
    ds_read_b128 v[68:71], v222 offset:7232
    s_waitcnt lgkmcnt(10)
    v_mfma_f32_16x16x32_bf16 v[32:35], v[108:111], v[76:79], v[32:35]
    ds_read_b128 v[72:75], v222 offset:6528
    s_waitcnt lgkmcnt(10)
    v_mfma_f32_16x16x32_bf16 v[32:35], v[112:115], v[80:83], v[32:35]
    ds_read_b128 v[76:79], v222 offset:6912
    s_waitcnt lgkmcnt(10)
    v_mfma_f32_16x16x32_bf16 v[32:35], v[116:119], v[84:87], v[32:35]
    ds_read_b128 v[80:83], v222 offset:7296
    s_waitcnt lgkmcnt(10)
    v_mfma_f32_16x16x32_bf16 v[32:35], v[120:123], v[88:91], v[32:35]
    ds_read_b128 v[84:87], v222 offset:6592
    s_waitcnt lgkmcnt(10)
    v_mfma_f32_16x16x32_bf16 v[32:35], v[124:127], v[92:95], v[32:35]
    ds_read_b128 v[88:91], v222 offset:6976
    s_waitcnt lgkmcnt(10)
    v_mfma_f32_16x16x32_bf16 v[36:39], v[128:131], v[48:51], 0
    ds_read_b128 v[92:95], v222 offset:7360
    s_waitcnt lgkmcnt(10)
    v_mfma_f32_16x16x32_bf16 v[40:43], v[128:131], v[52:55], 0
    ds_read_b128 v[48:51], v222 offset:6656
    s_waitcnt lgkmcnt(10)
    v_mfma_f32_16x16x32_bf16 v[44:47], v[128:131], v[56:59], 0
    ds_read_b128 v[52:55], v222 offset:7040
    s_waitcnt lgkmcnt(10)
    v_mfma_f32_16x16x32_bf16 v[36:39], v[132:135], v[60:63], v[36:39]
    ds_read_b128 v[56:59], v222 offset:7424
    s_waitcnt lgkmcnt(10)
    v_mfma_f32_16x16x32_bf16 v[40:43], v[132:135], v[64:67], v[40:43]
    ds_read_b128 v[60:63], v222 offset:6720
    s_waitcnt lgkmcnt(10)
    v_mfma_f32_16x16x32_bf16 v[44:47], v[132:135], v[68:71], v[44:47]
    ds_read_b128 v[64:67], v222 offset:7104
    s_waitcnt lgkmcnt(10)
    v_mfma_f32_16x16x32_bf16 v[36:39], v[136:139], v[72:75], v[36:39]
    ds_read_b128 v[68:71], v222 offset:7488
    s_waitcnt lgkmcnt(10)
    v_mfma_f32_16x16x32_bf16 v[40:43], v[136:139], v[76:79], v[40:43]
    ds_read_b128 v[72:75], v225 offset:256
    s_waitcnt lgkmcnt(10)
    v_mfma_f32_16x16x32_bf16 v[44:47], v[136:139], v[80:83], v[44:47]
    ds_read_b128 v[76:79], v225 offset:640
    s_waitcnt lgkmcnt(10)
    v_mfma_f32_16x16x32_bf16 v[36:39], v[140:143], v[84:87], v[36:39]
    ds_read_b128 v[80:83], v225 offset:1024
    s_waitcnt lgkmcnt(10)
    v_mfma_f32_16x16x32_bf16 v[40:43], v[140:143], v[88:91], v[40:43]
    ds_read_b128 v[84:87], v225 offset:320
    s_waitcnt lgkmcnt(10)
    v_mfma_f32_16x16x32_bf16 v[44:47], v[140:143], v[92:95], v[44:47]
    ds_read_b128 v[88:91], v225 offset:704
    s_waitcnt lgkmcnt(10)
    v_mfma_f32_16x16x32_bf16 v[36:39], v[144:147], v[48:51], v[36:39]
    ds_read_b128 v[92:95], v225 offset:1088
    s_waitcnt lgkmcnt(10)
    v_mfma_f32_16x16x32_bf16 v[40:43], v[144:147], v[52:55], v[40:43]
    ds_read_b128 v[48:51], v225 offset:384
    s_waitcnt lgkmcnt(10)
    v_mfma_f32_16x16x32_bf16 v[44:47], v[144:147], v[56:59], v[44:47]
    ds_read_b128 v[52:55], v225 offset:768
    s_waitcnt lgkmcnt(10)
    v_mfma_f32_16x16x32_bf16 v[36:39], v[148:151], v[60:63], v[36:39]
    ds_read_b128 v[56:59], v225 offset:1152
    s_waitcnt lgkmcnt(10)
    v_mfma_f32_16x16x32_bf16 v[40:43], v[148:151], v[64:67], v[40:43]
    ds_read_b128 v[60:63], v225 offset:448
    s_waitcnt lgkmcnt(10)
    v_mfma_f32_16x16x32_bf16 v[44:47], v[148:151], v[68:71], v[44:47]
    ds_read_b128 v[64:67], v225 offset:832
    s_waitcnt lgkmcnt(10)
    v_mfma_f32_16x16x32_bf16 v[36:39], v[152:155], v[72:75], v[36:39]
    ds_read_b128 v[68:71], v225 offset:1216
    s_waitcnt lgkmcnt(10)
    v_mfma_f32_16x16x32_bf16 v[40:43], v[152:155], v[76:79], v[40:43]
    ds_read_b128 v[72:75], v225 offset:512
    s_waitcnt lgkmcnt(10)
    v_mfma_f32_16x16x32_bf16 v[44:47], v[152:155], v[80:83], v[44:47]
    ds_read_b128 v[76:79], v225 offset:896
    s_waitcnt lgkmcnt(10)
    v_mfma_f32_16x16x32_bf16 v[36:39], v[156:159], v[84:87], v[36:39]
    ds_read_b128 v[80:83], v225 offset:1280
    s_waitcnt lgkmcnt(10)
    v_mfma_f32_16x16x32_bf16 v[40:43], v[156:159], v[88:91], v[40:43]
    ds_read_b128 v[84:87], v225 offset:576
    s_waitcnt lgkmcnt(10)
    v_mfma_f32_16x16x32_bf16 v[44:47], v[156:159], v[92:95], v[44:47]
    ds_read_b128 v[88:91], v225 offset:960
    s_waitcnt lgkmcnt(10)
    v_mfma_f32_16x16x32_bf16 v[36:39], v[160:163], v[48:51], v[36:39]
    ds_read_b128 v[92:95], v225 offset:1344
    s_waitcnt lgkmcnt(10)
    v_mfma_f32_16x16x32_bf16 v[40:43], v[160:163], v[52:55], v[40:43]
    s_waitcnt lgkmcnt(9)
    v_mfma_f32_16x16x32_bf16 v[44:47], v[160:163], v[56:59], v[44:47]
    s_waitcnt lgkmcnt(8)
    v_mfma_f32_16x16x32_bf16 v[36:39], v[164:167], v[60:63], v[36:39]
    s_waitcnt lgkmcnt(7)
    v_mfma_f32_16x16x32_bf16 v[40:43], v[164:167], v[64:67], v[40:43]
    s_waitcnt lgkmcnt(6)
    v_mfma_f32_16x16x32_bf16 v[44:47], v[164:167], v[68:71], v[44:47]
    s_waitcnt lgkmcnt(5)
    v_mfma_f32_16x16x32_bf16 v[36:39], v[168:171], v[72:75], v[36:39]
    s_waitcnt lgkmcnt(4)
    v_mfma_f32_16x16x32_bf16 v[40:43], v[168:171], v[76:79], v[40:43]
    s_waitcnt lgkmcnt(3)
    v_mfma_f32_16x16x32_bf16 v[44:47], v[168:171], v[80:83], v[44:47]
    s_waitcnt lgkmcnt(2)
    v_mfma_f32_16x16x32_bf16 v[36:39], v[172:175], v[84:87], v[36:39]
    s_waitcnt lgkmcnt(1)
    v_mfma_f32_16x16x32_bf16 v[40:43], v[172:175], v[88:91], v[40:43]
    s_waitcnt lgkmcnt(0)
    v_mfma_f32_16x16x32_bf16 v[44:47], v[172:175], v[92:95], v[44:47]
    s_lshl_b32 s60, s54, 9
    s_lshl_b32 s61, s20, 6
    s_add_u32 s60, s60, s61
    s_mul_i32 s60, s60, 192
    s_add_u32 s60, s60, 10485760
    v_mul_u32_u24 v227, 96, v252
    s_cmp_lg_u32 s28, 0
    s_cbranch_scc1 K2_NOACC
    buffer_load_dwordx4 v[48:51], v227, s[8:11], s60 offen offset:0
    buffer_load_dwordx4 v[52:55], v227, s[8:11], s60 offen offset:16
    buffer_load_dwordx4 v[56:59], v227, s[8:11], s60 offen offset:32
    buffer_load_dwordx4 v[60:63], v227, s[8:11], s60 offen offset:48
    buffer_load_dwordx4 v[64:67], v227, s[8:11], s60 offen offset:64
    buffer_load_dwordx4 v[68:71], v227, s[8:11], s60 offen offset:80
    buffer_load_dwordx4 v[72:75], v227, s[8:11], s60 offen offset:96
    buffer_load_dwordx4 v[76:79], v227, s[8:11], s60 offen offset:112
    buffer_load_dwordx4 v[80:83], v227, s[8:11], s60 offen offset:128
    buffer_load_dwordx4 v[84:87], v227, s[8:11], s60 offen offset:144
    buffer_load_dwordx4 v[88:91], v227, s[8:11], s60 offen offset:160
    buffer_load_dwordx4 v[92:95], v227, s[8:11], s60 offen offset:176
    s_waitcnt vmcnt(0)
    v_add_f32 v0, v0, v48
    v_add_f32 v1, v1, v49
    v_add_f32 v2, v2, v50
    v_add_f32 v3, v3, v51
    v_add_f32 v4, v4, v52
    v_add_f32 v5, v5, v53
    v_add_f32 v6, v6, v54
    v_add_f32 v7, v7, v55
    v_add_f32 v8, v8, v56
    v_add_f32 v9, v9, v57
    v_add_f32 v10, v10, v58
    v_add_f32 v11, v11, v59
    v_add_f32 v12, v12, v60
    v_add_f32 v13, v13, v61
    v_add_f32 v14, v14, v62
    v_add_f32 v15, v15, v63
    v_add_f32 v16, v16, v64
    v_add_f32 v17, v17, v65
    v_add_f32 v18, v18, v66
    v_add_f32 v19, v19, v67
    v_add_f32 v20, v20, v68
    v_add_f32 v21, v21, v69
    v_add_f32 v22, v22, v70
    v_add_f32 v23, v23, v71
    v_add_f32 v24, v24, v72
    v_add_f32 v25, v25, v73
    v_add_f32 v26, v26, v74
    v_add_f32 v27, v27, v75
    v_add_f32 v28, v28, v76
    v_add_f32 v29, v29, v77
    v_add_f32 v30, v30, v78
    v_add_f32 v31, v31, v79
    v_add_f32 v32, v32, v80
    v_add_f32 v33, v33, v81
    v_add_f32 v34, v34, v82
    v_add_f32 v35, v35, v83
    v_add_f32 v36, v36, v84
    v_add_f32 v37, v37, v85
    v_add_f32 v38, v38, v86
    v_add_f32 v39, v39, v87
    v_add_f32 v40, v40, v88
    v_add_f32 v41, v41, v89
    v_add_f32 v42, v42, v90
    v_add_f32 v43, v43, v91
    v_add_f32 v44, v44, v92
    v_add_f32 v45, v45, v93
    v_add_f32 v46, v46, v94
    v_add_f32 v47, v47, v95
K2_NOACC:
    s_barrier
    s_cmp_eq_u32 s55, 0
    s_cbranch_scc1 K2_SPILL
    v_mul_f32 v200, s63, v0
    v_mul_f32 v201, s63, v1
    v_mul_f32 v202, s63, v2
    v_mul_f32 v203, s63, v3
    v_exp_f32 v200, v200
    v_exp_f32 v201, v201
    v_exp_f32 v202, v202
    v_exp_f32 v203, v203
    v_add_f32 v200, 1.0, v200
    v_add_f32 v201, 1.0, v201
    v_add_f32 v202, 1.0, v202
    v_add_f32 v203, 1.0, v203
    v_rcp_f32 v200, v200
    v_rcp_f32 v201, v201
    v_rcp_f32 v202, v202
    v_rcp_f32 v203, v203
    v_cvt_pk_bf16_f32 v176, v0, v1
    v_cvt_pk_bf16_f32 v177, v2, v3
    v_mul_f32 v4, v4, v200
    v_mul_f32 v5, v5, v201
    v_mul_f32 v6, v6, v202
    v_mul_f32 v7, v7, v203
    v_cvt_pk_bf16_f32 v178, v4, v5
    v_cvt_pk_bf16_f32 v179, v6, v7
    v_mul_f32 v8, v8, v200
    v_mul_f32 v9, v9, v201
    v_mul_f32 v10, v10, v202
    v_mul_f32 v11, v11, v203
    v_cvt_pk_bf16_f32 v180, v8, v9
    v_cvt_pk_bf16_f32 v181, v10, v11
    v_mul_f32 v12, v12, v200
    v_mul_f32 v13, v13, v201
    v_mul_f32 v14, v14, v202
    v_mul_f32 v15, v15, v203
    v_cvt_pk_bf16_f32 v182, v12, v13
    v_cvt_pk_bf16_f32 v183, v14, v15
    ds_write_b64 v226, v[176:177] offset:0
    ds_write_b64 v226, v[178:179] offset:256
    ds_write_b64 v226, v[180:181] offset:512
    ds_write_b64 v226, v[182:183] offset:768
    s_waitcnt lgkmcnt(0)
    s_barrier
    ds_read_b128 v[192:195], v228 offset:0
    ds_read_b128 v[196:199], v228 offset:1536
    s_add_u32 s61, s20, 8
    v_readlane_b32 s41, v253, s61
    s_nop 0
    s_bfe_u32 s41, s41, 0x60015
    s_add_u32 s41, s41, s21
    s_lshl_b32 s41, s41, 10
    s_add_u32 s61, s20, 0
    v_readlane_b32 s40, v253, s61
    s_nop 0
    s_bfe_u32 s40, s40, 0x60015
    s_add_u32 s40, s40, s21
    s_lshl_b32 s40, s40, 10
    s_waitcnt lgkmcnt(0)
    buffer_store_dwordx4 v[192:195], v229, s[12:15], s40 offen sc1
    buffer_store_dwordx4 v[196:199], v229, s[12:15], s41 offen sc1
    v_mul_f32 v200, s63, v16
    v_mul_f32 v201, s63, v17
    v_mul_f32 v202, s63, v18
    v_mul_f32 v203, s63, v19
    v_exp_f32 v200, v200
    v_exp_f32 v201, v201
    v_exp_f32 v202, v202
    v_exp_f32 v203, v203
    v_add_f32 v200, 1.0, v200
    v_add_f32 v201, 1.0, v201
    v_add_f32 v202, 1.0, v202
    v_add_f32 v203, 1.0, v203
    v_rcp_f32 v200, v200
    v_rcp_f32 v201, v201
    v_rcp_f32 v202, v202
    v_rcp_f32 v203, v203
    v_cvt_pk_bf16_f32 v184, v16, v17
    v_cvt_pk_bf16_f32 v185, v18, v19
    v_mul_f32 v20, v20, v200
    v_mul_f32 v21, v21, v201
    v_mul_f32 v22, v22, v202
    v_mul_f32 v23, v23, v203
    v_cvt_pk_bf16_f32 v186, v20, v21
    v_cvt_pk_bf16_f32 v187, v22, v23
    v_mul_f32 v24, v24, v200
    v_mul_f32 v25, v25, v201
    v_mul_f32 v26, v26, v202
    v_mul_f32 v27, v27, v203
    v_cvt_pk_bf16_f32 v188, v24, v25
    v_cvt_pk_bf16_f32 v189, v26, v27
    v_mul_f32 v28, v28, v200
    v_mul_f32 v29, v29, v201
    v_mul_f32 v30, v30, v202
    v_mul_f32 v31, v31, v203
    v_cvt_pk_bf16_f32 v190, v28, v29
    v_cvt_pk_bf16_f32 v191, v30, v31
    ds_write_b64 v226, v[184:185] offset:3072
    ds_write_b64 v226, v[186:187] offset:3328
    ds_write_b64 v226, v[188:189] offset:3584
    ds_write_b64 v226, v[190:191] offset:3840
    s_waitcnt lgkmcnt(0)
    s_barrier
    ds_read_b128 v[192:195], v228 offset:3072
    ds_read_b128 v[196:199], v228 offset:4608
    s_add_u32 s61, s20, 24
    v_readlane_b32 s43, v253, s61
    s_nop 0
    s_bfe_u32 s43, s43, 0x60015
    s_add_u32 s43, s43, s21
    s_lshl_b32 s43, s43, 10
    s_add_u32 s61, s20, 16
    v_readlane_b32 s42, v253, s61
    s_nop 0
    s_bfe_u32 s42, s42, 0x60015
    s_add_u32 s42, s42, s21
    s_lshl_b32 s42, s42, 10
    s_waitcnt lgkmcnt(0)
    buffer_store_dwordx4 v[192:195], v229, s[12:15], s42 offen sc1
    buffer_store_dwordx4 v[196:199], v229, s[12:15], s43 offen sc1
    v_mul_f32 v200, s63, v32
    v_mul_f32 v201, s63, v33
    v_mul_f32 v202, s63, v34
    v_mul_f32 v203, s63, v35
    v_exp_f32 v200, v200
    v_exp_f32 v201, v201
    v_exp_f32 v202, v202
    v_exp_f32 v203, v203
    v_add_f32 v200, 1.0, v200
    v_add_f32 v201, 1.0, v201
    v_add_f32 v202, 1.0, v202
    v_add_f32 v203, 1.0, v203
    v_rcp_f32 v200, v200
    v_rcp_f32 v201, v201
    v_rcp_f32 v202, v202
    v_rcp_f32 v203, v203
    v_cvt_pk_bf16_f32 v176, v32, v33
    v_cvt_pk_bf16_f32 v177, v34, v35
    v_mul_f32 v36, v36, v200
    v_mul_f32 v37, v37, v201
    v_mul_f32 v38, v38, v202
    v_mul_f32 v39, v39, v203
    v_cvt_pk_bf16_f32 v178, v36, v37
    v_cvt_pk_bf16_f32 v179, v38, v39
    v_mul_f32 v40, v40, v200
    v_mul_f32 v41, v41, v201
    v_mul_f32 v42, v42, v202
    v_mul_f32 v43, v43, v203
    v_cvt_pk_bf16_f32 v180, v40, v41
    v_cvt_pk_bf16_f32 v181, v42, v43
    v_mul_f32 v44, v44, v200
    v_mul_f32 v45, v45, v201
    v_mul_f32 v46, v46, v202
    v_mul_f32 v47, v47, v203
    v_cvt_pk_bf16_f32 v182, v44, v45
    v_cvt_pk_bf16_f32 v183, v46, v47
    s_mov_b64 exec, s[56:57]
    ds_write_b64 v226, v[176:177] offset:6144
    ds_write_b64 v226, v[178:179] offset:6400
    ds_write_b64 v226, v[180:181] offset:6656
    ds_write_b64 v226, v[182:183] offset:6912
    s_mov_b64 exec, -1
    s_waitcnt lgkmcnt(0)
    s_barrier
    s_branch K2_LASTROW
K2_SPILL:
    buffer_store_dwordx4 v[0:3], v227, s[8:11], s60 offen offset:0
    buffer_store_dwordx4 v[4:7], v227, s[8:11], s60 offen offset:16
    buffer_store_dwordx4 v[8:11], v227, s[8:11], s60 offen offset:32
    buffer_store_dwordx4 v[12:15], v227, s[8:11], s60 offen offset:48
    buffer_store_dwordx4 v[16:19], v227, s[8:11], s60 offen offset:64
    buffer_store_dwordx4 v[20:23], v227, s[8:11], s60 offen offset:80
    buffer_store_dwordx4 v[24:27], v227, s[8:11], s60 offen offset:96
    buffer_store_dwordx4 v[28:31], v227, s[8:11], s60 offen offset:112
    buffer_store_dwordx4 v[32:35], v227, s[8:11], s60 offen offset:128
    buffer_store_dwordx4 v[36:39], v227, s[8:11], s60 offen offset:144
    buffer_store_dwordx4 v[40:43], v227, s[8:11], s60 offen offset:160
    buffer_store_dwordx4 v[44:47], v227, s[8:11], s60 offen offset:176
    s_mov_b32 s28, 0
    s_waitcnt vmcnt(0)
    s_cmp_lt_u32 s24, s25
    s_cbranch_scc1 K2_LOAD
    s_add_u32 s23, s23, 20
    s_branch K2_WINDOW
K2_END:
    s_endpgm
.section .rodata,"a"
.p2align 6
.amdhsa_kernel tp_sort_kernel
  .amdhsa_next_free_vgpr 72
  .amdhsa_next_free_sgpr 76
  .amdhsa_accum_offset 72
  .amdhsa_group_segment_fixed_size 0
  .amdhsa_kernarg_size 96
  .amdhsa_user_sgpr_count 2
  .amdhsa_user_sgpr_kernarg_segment_ptr 1
  .amdhsa_system_sgpr_workgroup_id_x 1
  .amdhsa_float_denorm_mode_32 3
.end_amdhsa_kernel
.p2align 6
.amdhsa_kernel tp_main_kernel
  .amdhsa_next_free_vgpr 256
  .amdhsa_next_free_sgpr 76
  .amdhsa_accum_offset 256
  .amdhsa_group_segment_fixed_size 0
  .amdhsa_kernarg_size 96
  .amdhsa_user_sgpr_count 2
  .amdhsa_user_sgpr_kernarg_segment_ptr 1
  .amdhsa_system_sgpr_workgroup_id_x 1
  .amdhsa_float_denorm_mode_32 3
.end_amdhsa_kernel
```

```asm
; @launch grid=(256,1,1) block=(512,1,1) lds=163840
.amdgcn_target "amdgcn-amd-amdhsa--gfx950"
.text
.globl standalone__tensor_product_equiv_equiformer__graph_kernel
.p2align 8
.type standalone__tensor_product_equiv_equiformer__graph_kernel,@function
standalone__tensor_product_equiv_equiformer__graph_kernel:
    s_cmp_ge_u32 s2, 256
    s_cbranch_scc1 K2_END
    s_load_dwordx16 s[80:95], s[0:1], 0
    s_load_dwordx4 s[96:99], s[0:1], 72
    s_load_dwordx2 s[100:101], s[0:1], 88
    v_lshrrev_b32 v1, 6, v0
    s_mov_b32 s54, s2
    v_readfirstlane_b32 s20, v1
    v_and_b32 v8, 63, v0
    v_lshlrev_b32 v9, 4, v8
    v_mov_b32 v6, 0
    v_mov_b32 v57, 0
    v_mov_b32 v58, 0
    v_mov_b32 v176, v8
    v_mov_b32 v177, v0
    s_mul_i32 s21, s2, 625
    s_add_u32 s22, s21, 640
    s_add_u32 s21, s21, 15
    s_lshr_b32 s21, s21, 4
    s_lshr_b32 s22, s22, 4
    s_sub_u32 s22, s22, s21
    s_movk_i32 s39, 1024
    s_lshl_b32 s37, s20, 13
    s_mov_b32 s53, 163616
    s_lshl_b32 s52, s20, 2
    s_add_u32 s52, s52, s53
    s_add_u32 s68, s37, 0
    s_add_u32 s69, s37, 2048
    s_add_u32 s70, s37, 4096
    s_add_u32 s71, s37, 6144
    s_waitcnt lgkmcnt(0)
    s_mov_b32 s8, s100
    s_and_b32 s9, s101, 0xffff
    s_mov_b32 s10, 37748736
    s_mov_b32 s11, 0x20000
    s_cmp_ge_u32 s20, 5
    s_cbranch_scc1 KS_HELP
    s_cmp_ge_u32 s2, 250
    s_cbranch_scc1 KS_IDLE
    v_lshlrev_b32 v5, 4, v0
    v_mul_u32_u24 v4, 24, v0
    s_mul_i32 s64, s2, 5120
    s_mul_i32 s65, s2, 7680
    s_mov_b32 s40, s88
    s_and_b32 s41, s89, 0xffff
    s_mov_b32 s42, 1280000
    s_mov_b32 s43, 0x20000
    s_mov_b32 s44, s86
    s_and_b32 s45, s87, 0xffff
    s_mov_b32 s46, 1280000
    s_mov_b32 s47, 0x20000
    s_mov_b32 s48, s82
    s_and_b32 s49, s83, 0xffff
    s_mov_b32 s50, 1920000
    s_mov_b32 s51, 0x20000
    buffer_load_dwordx4 v[12:15], v5, s[40:43], s64 offen
    buffer_load_dwordx4 v[16:19], v5, s[44:47], s64 offen
    buffer_load_dwordx4 v[20:23], v4, s[48:51], s65 offen
    buffer_load_dwordx2 v[24:25], v4, s[48:51], s65 offen offset:16
    v_lshlrev_b32 v2, 2, v0
    v_mov_b32 v7, 1
    s_cmp_eq_u32 s20, 4
    s_cbranch_scc1 KS_NOCLR
    ds_write_b32 v2, v6
KS_NOCLR:
    v_mul_u32_u24 v76, 437, v177
    v_lshrrev_b32 v76, 16, v76
    v_mul_u32_u24 v76, 150, v76
    v_sub_u32 v76, v177, v76
    v_mov_b32 v80, -1
    v_mov_b32 v77, 1.0
    v_cmp_gt_u32 vcc, 48, v76
    v_lshlrev_b32 v78, 4, v177
    v_add_u32 v78, 65536, v78
    v_cndmask_b32 v80, v80, 0, vcc
    v_cmp_gt_u32 vcc, 12, v76
    v_add_u32 v79, 64800, v78
    s_nop 0
    v_cndmask_b32 v80, v80, v77, vcc
    v_cmp_gt_u32 vcc, 450, v177
    v_mov_b32 v81, v80
    v_mov_b32 v82, v80
    v_mov_b32 v83, v80
    s_mov_b64 exec, vcc
    ds_write_b128 v78, v[80:83] offset:0
    ds_write_b128 v78, v[80:83] offset:7200
    ds_write_b128 v78, v[80:83] offset:14400
    ds_write_b128 v78, v[80:83] offset:21600
    ds_write_b128 v78, v[80:83] offset:28800
    ds_write_b128 v78, v[80:83] offset:36000
    ds_write_b128 v78, v[80:83] offset:43200
    ds_write_b128 v78, v[80:83] offset:50400
    ds_write_b128 v78, v[80:83] offset:57600
    ds_write_b128 v79, v[80:83] offset:0
    ds_write_b128 v79, v[80:83] offset:7200
    ds_write_b128 v79, v[80:83] offset:14400
    ds_write_b128 v79, v[80:83] offset:21600
    v_cmp_gt_u32 vcc, 268, v177
    s_nop 0
    s_cbranch_vccz K2_NOCLa
    s_mov_b64 exec, vcc
    ds_write_b128 v79, v[80:83] offset:28800
K2_NOCLa:
    s_mov_b64 exec, -1
    s_cmp_lg_u32 s20, 7
    s_cbranch_scc1 K2_NOHa
    v_mov_b32 v76, 0
    v_mov_b32 v77, -1
    v_lshlrev_b32 v78, 2, v176
    v_add_u32 v78, 163424, v78
    s_mov_b64 exec, 0x1ff
    ds_write_b32 v78, v76 offset:192
    s_mov_b64 exec, 0xff
    ds_write_b32 v78, v77 offset:256
    s_mov_b64 exec, -1
    s_mov_b32 exec_hi, 0xffff
    ds_write_b32 v78, v76
    s_mov_b64 exec, 1
    ds_write_b32 v78, v76 offset:228
    s_mov_b64 exec, -1
K2_NOHa:
    v_and_b32 v84, 15, v176
    v_lshrrev_b32 v85, 5, v176
    v_bfe_u32 v86, v176, 4, 1
    v_lshrrev_b32 v87, 2, v84
    v_and_b32 v88, 3, v84
    v_lshl_add_u32 v89, v85, 3, v87
    v_lshlrev_b32 v249, 5, v89
    v_lshl_add_u32 v249, v88, 3, v249
    v_add_u32 v249, 864, v249
    v_mul_u32_u24 v250, 192, v86
    v_lshl_add_u32 v250, v85, 5, v250
    v_lshrrev_b32 v90, 1, v88
    v_lshl_add_u32 v90, v86, 1, v90
    v_bfe_u32 v91, v87, 1, 1
    v_lshlrev_b32 v91, 2, v91
    v_xor_b32 v90, v90, v91
    v_lshlrev_b32 v90, 4, v90
    v_lshl_add_u32 v90, v89, 7, v90
    v_and_b32 v91, 1, v88
    v_lshl_add_u32 v90, v91, 3, v90
    v_add_u32 v246, s37, v90
    v_xor_b32 v247, 64, v246
    v_lshrrev_b32 v90, 3, v176
    v_lshlrev_b32 v251, 2, v90
    v_add_u32 v251, 768, v251
    v_bfe_u32 v90, v90, 1, 1
    v_lshlrev_b32 v90, 2, v90
    v_and_b32 v91, 7, v176
    v_xor_b32 v90, v90, v91
    v_lshlrev_b32 v248, 4, v90
    v_lshlrev_b32 v252, 1, v176
    v_and_b32 v231, 1, v176
    v_lshlrev_b32 v231, 4, v231
    v_lshrrev_b32 v90, 1, v176
    v_lshlrev_b32 v90, 5, v90
    v_add_u32 v230, 864, v90
    s_mov_b32 s58, 429497
    s_movk_i32 s59, 625
    s_waitcnt lgkmcnt(0)
    s_barrier
    s_waitcnt vmcnt(3)
    v_mul_u32_u24 v28, s58, v12
    v_lshrrev_b32 v28, 24, v28
    v_lshlrev_b32 v32, 2, v28
    ds_add_rtn_u32 v36, v32, v7
    v_mul_u32_u24 v29, s58, v13
    v_lshrrev_b32 v29, 24, v29
    v_lshlrev_b32 v33, 2, v29
    ds_add_rtn_u32 v37, v33, v7
    v_mul_u32_u24 v30, s58, v14
    v_lshrrev_b32 v30, 24, v30
    v_lshlrev_b32 v34, 2, v30
    ds_add_rtn_u32 v38, v34, v7
    v_mul_u32_u24 v31, s58, v15
    v_lshrrev_b32 v31, 24, v31
    v_lshlrev_b32 v35, 2, v31
    ds_add_rtn_u32 v39, v35, v7
    v_mad_u32_u24 v28, v28, s59, 15
    v_lshrrev_b32 v28, 4, v28
    v_sub_u32 v28, v12, v28
    v_add_u32 v12, 0, v2
    v_lshlrev_b32 v12, 14, v12
    v_lshl_or_b32 v28, v28, 25, v12
    v_mad_u32_u24 v29, v29, s59, 15
    v_lshrrev_b32 v29, 4, v29
    v_sub_u32 v29, v13, v29
    v_add_u32 v13, 1, v2
    v_lshlrev_b32 v13, 14, v13
    v_lshl_or_b32 v29, v29, 25, v13
    v_mad_u32_u24 v30, v30, s59, 15
    v_lshrrev_b32 v30, 4, v30
    v_sub_u32 v30, v14, v30
    v_add_u32 v14, 2, v2
    v_lshlrev_b32 v14, 14, v14
    v_lshl_or_b32 v30, v30, 25, v14
    v_mad_u32_u24 v31, v31, s59, 15
    v_lshrrev_b32 v31, 4, v31
    v_sub_u32 v31, v15, v31
    v_add_u32 v15, 3, v2
    v_lshlrev_b32 v15, 14, v15
    v_lshl_or_b32 v31, v31, 25, v15
    s_waitcnt lgkmcnt(0)
    s_barrier
    ds_read_b128 v[40:43], v9
    s_waitcnt lgkmcnt(0)
    v_add_u32 v45, v40, v41
    v_add_u32 v46, v45, v42
    v_add_u32 v47, v46, v43
    v_mov_b32 v48, v47
    s_nop 1
    v_add_u32_dpp v48, v48, v48 row_shr:1 row_mask:0xf bank_mask:0xf bound_ctrl:0
    s_nop 1
    v_add_u32_dpp v48, v48, v48 row_shr:2 row_mask:0xf bank_mask:0xf bound_ctrl:0
    s_nop 1
    v_add_u32_dpp v48, v48, v48 row_shr:4 row_mask:0xf bank_mask:0xf bound_ctrl:0
    s_nop 1
    v_add_u32_dpp v48, v48, v48 row_shr:8 row_mask:0xf bank_mask:0xf bound_ctrl:0
    s_nop 1
    v_add_u32_dpp v48, v48, v48 row_bcast:15 row_mask:0xa bank_mask:0xf
    s_nop 1
    v_add_u32_dpp v48, v48, v48 row_bcast:31 row_mask:0xc bank_mask:0xf
    v_sub_u32 v48, v48, v47
    v_add_u32 v49, v48, v40
    v_add_u32 v50, v48, v45
    v_add_u32 v51, v48, v46
    ds_write_b128 v9, v[48:51] offset:1024
    s_waitcnt lgkmcnt(0)
    ds_read_b32 v32, v32 offset:1024
    ds_read_b32 v33, v33 offset:1024
    ds_read_b32 v34, v34 offset:1024
    ds_read_b32 v35, v35 offset:1024
    ds_read_b32 v56, v2
    ds_read_b32 v57, v2 offset:1024
    s_waitcnt vmcnt(0)
    v_lshlrev_b32 v40, 16, v20
    v_and_b32 v41, 0xffff0000, v20
    v_lshlrev_b32 v42, 16, v21
    v_or_b32 v43, v28, v16
    v_and_b32 v44, 0xffff0000, v21
    v_lshlrev_b32 v45, 16, v22
    v_and_b32 v46, 0xffff0000, v22
    v_or_b32 v47, v29, v17
    v_lshlrev_b32 v48, 16, v23
    v_and_b32 v49, 0xffff0000, v23
    v_lshlrev_b32 v50, 16, v24
    v_or_b32 v51, v30, v18
    v_and_b32 v52, 0xffff0000, v24
    v_lshlrev_b32 v53, 16, v25
    v_and_b32 v54, 0xffff0000, v25
    v_or_b32 v55, v31, v19
    s_waitcnt lgkmcnt(0)
    v_add_lshl_u32 v32, v32, v36, 4
    ds_write_b128 v32, v[40:43] offset:2048
    v_add_lshl_u32 v33, v33, v37, 4
    ds_write_b128 v33, v[44:47] offset:2048
    v_add_lshl_u32 v34, v34, v38, 4
    ds_write_b128 v34, v[48:51] offset:2048
    v_add_lshl_u32 v35, v35, v39, 4
    ds_write_b128 v35, v[52:55] offset:2048
    s_mul_i32 s64, s2, 20608
    s_waitcnt lgkmcnt(0)
    s_barrier
    ds_read_b128 v[12:15], v5 offset:2048
    ds_read_b128 v[16:19], v5 offset:7168
    ds_read_b128 v[20:23], v5 offset:12288
    ds_read_b128 v[24:27], v5 offset:17408
    s_waitcnt lgkmcnt(3)
    buffer_store_dwordx4 v[12:15], v5, s[8:11], s64 offen sc1
    s_add_u32 s64, s64, 5120
    s_waitcnt lgkmcnt(2)
    buffer_store_dwordx4 v[16:19], v5, s[8:11], s64 offen sc1
    s_add_u32 s64, s64, 5120
    s_waitcnt lgkmcnt(1)
    buffer_store_dwordx4 v[20:23], v5, s[8:11], s64 offen sc1
    s_add_u32 s64, s64, 5120
    s_waitcnt lgkmcnt(0)
    buffer_store_dwordx4 v[24:27], v5, s[8:11], s64 offen sc1
    v_lshl_or_b32 v58, v56, 11, v57
    v_mul_u32_u24 v57, 2176, v0
    s_lshl_b32 s64, s2, 3
    s_add_u32 s64, s64, 6291456
    s_mov_b32 s65, 1
    s_cmp_eq_u32 s20, 4
    s_cselect_b32 s65, 0, s65
    s_branch KS_JOIN
KS_HELP:
    s_cmp_eq_u32 s20, 7
    s_cbranch_scc1 KS_TAG
    s_cmp_eq_u32 s20, 6
    s_cbranch_scc1 KS_RAW
    s_cmp_ge_u32 s2, 200
    s_cbranch_scc1 KS_IDLE
    v_and_b32 v1, 15, v8
    v_lshrrev_b32 v3, 4, v8
    s_cmp_ge_u32 s2, 160
    s_cbranch_scc1 K1_WT
    s_cmp_ge_u32 s2, 64
    s_cbranch_scc1 K1_S1
    s_lshr_b32 s24, s2, 3
    s_and_b32 s25, s2, 7
    s_lshr_b32 s26, s25, 2
    s_bfe_u32 s27, s25, 0x10001
    s_and_b32 s28, s25, 1
    s_mov_b32 s60, s92
    s_and_b32 s61, s93, 0xffff
    s_mov_b32 s62, 65536
    s_mov_b32 s63, 0x20000
    s_branch K1_SC
K1_S1:
    s_sub_u32 s29, s2, 64
    s_mul_i32 s24, s29, 43
    s_lshr_b32 s24, s24, 9
    s_mul_i32 s25, s24, 12
    s_sub_u32 s25, s29, s25
    s_cmp_ge_u32 s25, 6
    s_cselect_b32 s26, 1, 0
    s_mul_i32 s27, s26, 6
    s_sub_u32 s27, s25, s27
    s_lshr_b32 s27, s27, 1
    s_and_b32 s28, s25, 1
    s_add_u32 s25, s25, 8
    s_mov_b32 s60, s94
    s_and_b32 s61, s95, 0xffff
    s_mov_b32 s62, 98304
    s_mov_b32 s63, 0x20000
K1_SC:
    s_lshl_b32 s27, s27, 7
    s_lshl_b32 s26, s26, 6
    s_lshl_b32 s28, s28, 5
    s_add_u32 s27, s27, s26
    s_add_u32 s27, s27, s28
    s_lshl_b32 s27, s27, 8
    s_lshl_b32 s26, s24, 5
    s_add_u32 s27, s27, s26
    v_lshlrev_b32 v3, 11, v3
    v_lshl_add_u32 v3, v1, 1, v3
    buffer_load_ushort v64, v3, s[60:63], s27 offen offset:0
    buffer_load_ushort v65, v3, s[60:63], s27 offen offset:256
    buffer_load_ushort v66, v3, s[60:63], s27 offen offset:512
    buffer_load_ushort v67, v3, s[60:63], s27 offen offset:768
    buffer_load_ushort v68, v3, s[60:63], s27 offen offset:1024
    buffer_load_ushort v69, v3, s[60:63], s27 offen offset:1280
    buffer_load_ushort v70, v3, s[60:63], s27 offen offset:1536
    buffer_load_ushort v71, v3, s[60:63], s27 offen offset:1792
    s_mul_i32 s24, s24, 20
    s_add_u32 s24, s24, s25
    s_lshl_b32 s24, s24, 10
    s_add_u32 s24, s24, 6946816
    s_branch K1_GO
K1_WT:
    s_sub_u32 s24, s2, 160
    s_cmp_ge_u32 s24, 20
    s_cselect_b32 s26, 1, 0
    s_mul_i32 s25, s26, 20
    s_sub_u32 s25, s24, s25
    s_lshr_b32 s27, s25, 2
    s_bfe_u32 s28, s25, 0x10001
    s_and_b32 s25, s25, 1
    s_mul_i32 s25, s25, 10240
    s_lshl_b32 s27, s27, 8
    s_lshl_b32 s26, s26, 7
    s_lshl_b32 s28, s28, 6
    s_add_u32 s27, s27, s26
    s_add_u32 s27, s27, s28
    s_add_u32 s27, s27, s25
    s_mov_b32 s60, s90
    s_and_b32 s61, s91, 0xffff
    s_mov_b32 s62, 20480
    s_mov_b32 s63, 0x20000
    v_and_b32 v1, 31, v8
    v_lshrrev_b32 v3, 5, v8
    v_mul_u32_u24 v3, 5120, v3
    v_lshl_add_u32 v3, v1, 1, v3
    v_mov_b32 v64, 0
    v_mov_b32 v66, 0
    v_mov_b32 v68, 0
    v_mov_b32 v70, 0
    buffer_load_ushort v65, v3, s[60:63], s27 offen offset:0
    buffer_load_ushort v67, v3, s[60:63], s27 offen offset:1280
    buffer_load_ushort v69, v3, s[60:63], s27 offen offset:2560
    buffer_load_ushort v71, v3, s[60:63], s27 offen offset:3840
    s_lshl_b32 s24, s24, 10
    s_add_u32 s24, s24, 7110656
K1_GO:
    v_mul_u32_u24 v76, 437, v177
    v_lshrrev_b32 v76, 16, v76
    v_mul_u32_u24 v76, 150, v76
    v_sub_u32 v76, v177, v76
    v_mov_b32 v80, -1
    v_mov_b32 v77, 1.0
    v_cmp_gt_u32 vcc, 48, v76
    v_lshlrev_b32 v78, 4, v177
    v_add_u32 v78, 65536, v78
    v_cndmask_b32 v80, v80, 0, vcc
    v_cmp_gt_u32 vcc, 12, v76
    v_add_u32 v79, 64800, v78
    s_nop 0
    v_cndmask_b32 v80, v80, v77, vcc
    v_cmp_gt_u32 vcc, 450, v177
    v_mov_b32 v81, v80
    v_mov_b32 v82, v80
    v_mov_b32 v83, v80
    s_mov_b64 exec, vcc
    ds_write_b128 v78, v[80:83] offset:0
    ds_write_b128 v78, v[80:83] offset:7200
    ds_write_b128 v78, v[80:83] offset:14400
    ds_write_b128 v78, v[80:83] offset:21600
    ds_write_b128 v78, v[80:83] offset:28800
    ds_write_b128 v78, v[80:83] offset:36000
    ds_write_b128 v78, v[80:83] offset:43200
    ds_write_b128 v78, v[80:83] offset:50400
    ds_write_b128 v78, v[80:83] offset:57600
    ds_write_b128 v79, v[80:83] offset:0
    ds_write_b128 v79, v[80:83] offset:7200
    ds_write_b128 v79, v[80:83] offset:14400
    ds_write_b128 v79, v[80:83] offset:21600
    v_cmp_gt_u32 vcc, 268, v177
    s_nop 0
    s_cbranch_vccz K2_NOCLb
    s_mov_b64 exec, vcc
    ds_write_b128 v79, v[80:83] offset:28800
K2_NOCLb:
    s_mov_b64 exec, -1
    s_cmp_lg_u32 s20, 7
    s_cbranch_scc1 K2_NOHb
    v_mov_b32 v76, 0
    v_mov_b32 v77, -1
    v_lshlrev_b32 v78, 2, v176
    v_add_u32 v78, 163424, v78
    s_mov_b64 exec, 0x1ff
    ds_write_b32 v78, v76 offset:192
    s_mov_b64 exec, 0xff
    ds_write_b32 v78, v77 offset:256
    s_mov_b64 exec, -1
    s_mov_b32 exec_hi, 0xffff
    ds_write_b32 v78, v76
    s_mov_b64 exec, 1
    ds_write_b32 v78, v76 offset:228
    s_mov_b64 exec, -1
K2_NOHb:
    v_and_b32 v84, 15, v176
    v_lshrrev_b32 v85, 5, v176
    v_bfe_u32 v86, v176, 4, 1
    v_lshrrev_b32 v87, 2, v84
    v_and_b32 v88, 3, v84
    v_lshl_add_u32 v89, v85, 3, v87
    v_lshlrev_b32 v249, 5, v89
    v_lshl_add_u32 v249, v88, 3, v249
    v_add_u32 v249, 864, v249
    v_mul_u32_u24 v250, 192, v86
    v_lshl_add_u32 v250, v85, 5, v250
    v_lshrrev_b32 v90, 1, v88
    v_lshl_add_u32 v90, v86, 1, v90
    v_bfe_u32 v91, v87, 1, 1
    v_lshlrev_b32 v91, 2, v91
    v_xor_b32 v90, v90, v91
    v_lshlrev_b32 v90, 4, v90
    v_lshl_add_u32 v90, v89, 7, v90
    v_and_b32 v91, 1, v88
    v_lshl_add_u32 v90, v91, 3, v90
    v_add_u32 v246, s37, v90
    v_xor_b32 v247, 64, v246
    v_lshrrev_b32 v90, 3, v176
    v_lshlrev_b32 v251, 2, v90
    v_add_u32 v251, 768, v251
    v_bfe_u32 v90, v90, 1, 1
    v_lshlrev_b32 v90, 2, v90
    v_and_b32 v91, 7, v176
    v_xor_b32 v90, v90, v91
    v_lshlrev_b32 v248, 4, v90
    v_lshlrev_b32 v252, 1, v176
    v_and_b32 v231, 1, v176
    v_lshlrev_b32 v231, 4, v231
    v_lshrrev_b32 v90, 1, v176
    v_lshlrev_b32 v90, 5, v90
    v_add_u32 v230, 864, v90
    s_waitcnt lgkmcnt(0)
    s_barrier
    s_barrier
    s_waitcnt vmcnt(0)
    v_lshl_or_b32 v40, v65, 16, v64
    v_lshl_or_b32 v41, v67, 16, v66
    v_lshl_or_b32 v42, v69, 16, v68
    v_lshl_or_b32 v43, v71, 16, v70
    buffer_store_dwordx4 v[40:43], v9, s[8:11], s24 offen sc1
    s_branch KS_B3
KS_RAW:
    s_mov_b32 s60, s90
    s_and_b32 s61, s91, 0xffff
    s_mov_b32 s62, 20480
    s_mov_b32 s63, 0x20000
    s_mov_b32 m0, 24576
    s_movk_i32 s24, 0
    buffer_load_dwordx4 v9, s[60:63], s24 offen offset:0 lds
    buffer_load_dwordx4 v9, s[60:63], s24 offen offset:1024 lds
    buffer_load_dwordx4 v9, s[60:63], s24 offen offset:2048 lds
    buffer_load_dwordx4 v9, s[60:63], s24 offen offset:3072 lds
    s_mov_b32 m0, 28672
    s_movk_i32 s24, 4096
    buffer_load_dwordx4 v9, s[60:63], s24 offen offset:0 lds
    buffer_load_dwordx4 v9, s[60:63], s24 offen offset:1024 lds
    buffer_load_dwordx4 v9, s[60:63], s24 offen offset:2048 lds
    buffer_load_dwordx4 v9, s[60:63], s24 offen offset:3072 lds
    s_mov_b32 m0, 32768
    s_movk_i32 s24, 8192
    buffer_load_dwordx4 v9, s[60:63], s24 offen offset:0 lds
    buffer_load_dwordx4 v9, s[60:63], s24 offen offset:1024 lds
    buffer_load_dwordx4 v9, s[60:63], s24 offen offset:2048 lds
    buffer_load_dwordx4 v9, s[60:63], s24 offen offset:3072 lds
    s_mov_b32 m0, 36864
    s_movk_i32 s24, 12288
    buffer_load_dwordx4 v9, s[60:63], s24 offen offset:0 lds
    buffer_load_dwordx4 v9, s[60:63], s24 offen offset:1024 lds
    buffer_load_dwordx4 v9, s[60:63], s24 offen offset:2048 lds
    buffer_load_dwordx4 v9, s[60:63], s24 offen offset:3072 lds
    s_mov_b32 m0, 40960
    s_movk_i32 s24, 16384
    buffer_load_dwordx4 v9, s[60:63], s24 offen offset:0 lds
    buffer_load_dwordx4 v9, s[60:63], s24 offen offset:1024 lds
    buffer_load_dwordx4 v9, s[60:63], s24 offen offset:2048 lds
    buffer_load_dwordx4 v9, s[60:63], s24 offen offset:3072 lds
KS_IDLE:
    v_mul_u32_u24 v76, 437, v177
    v_lshrrev_b32 v76, 16, v76
    v_mul_u32_u24 v76, 150, v76
    v_sub_u32 v76, v177, v76
    v_mov_b32 v80, -1
    v_mov_b32 v77, 1.0
    v_cmp_gt_u32 vcc, 48, v76
    v_lshlrev_b32 v78, 4, v177
    v_add_u32 v78, 65536, v78
    v_cndmask_b32 v80, v80, 0, vcc
    v_cmp_gt_u32 vcc, 12, v76
    v_add_u32 v79, 64800, v78
    s_nop 0
    v_cndmask_b32 v80, v80, v77, vcc
    v_cmp_gt_u32 vcc, 450, v177
    v_mov_b32 v81, v80
    v_mov_b32 v82, v80
    v_mov_b32 v83, v80
    s_mov_b64 exec, vcc
    ds_write_b128 v78, v[80:83] offset:0
    ds_write_b128 v78, v[80:83] offset:7200
    ds_write_b128 v78, v[80:83] offset:14400
    ds_write_b128 v78, v[80:83] offset:21600
    ds_write_b128 v78, v[80:83] offset:28800
    ds_write_b128 v78, v[80:83] offset:36000
    ds_write_b128 v78, v[80:83] offset:43200
    ds_write_b128 v78, v[80:83] offset:50400
    ds_write_b128 v78, v[80:83] offset:57600
    ds_write_b128 v79, v[80:83] offset:0
    ds_write_b128 v79, v[80:83] offset:7200
    ds_write_b128 v79, v[80:83] offset:14400
    ds_write_b128 v79, v[80:83] offset:21600
    v_cmp_gt_u32 vcc, 268, v177
    s_nop 0
    s_cbranch_vccz K2_NOCLc
    s_mov_b64 exec, vcc
    ds_write_b128 v79, v[80:83] offset:28800
K2_NOCLc:
    s_mov_b64 exec, -1
    s_cmp_lg_u32 s20, 7
    s_cbranch_scc1 K2_NOHc
    v_mov_b32 v76, 0
    v_mov_b32 v77, -1
    v_lshlrev_b32 v78, 2, v176
    v_add_u32 v78, 163424, v78
    s_mov_b64 exec, 0x1ff
    ds_write_b32 v78, v76 offset:192
    s_mov_b64 exec, 0xff
    ds_write_b32 v78, v77 offset:256
    s_mov_b64 exec, -1
    s_mov_b32 exec_hi, 0xffff
    ds_write_b32 v78, v76
    s_mov_b64 exec, 1
    ds_write_b32 v78, v76 offset:228
    s_mov_b64 exec, -1
K2_NOHc:
    v_and_b32 v84, 15, v176
    v_lshrrev_b32 v85, 5, v176
    v_bfe_u32 v86, v176, 4, 1
    v_lshrrev_b32 v87, 2, v84
    v_and_b32 v88, 3, v84
    v_lshl_add_u32 v89, v85, 3, v87
    v_lshlrev_b32 v249, 5, v89
    v_lshl_add_u32 v249, v88, 3, v249
    v_add_u32 v249, 864, v249
    v_mul_u32_u24 v250, 192, v86
    v_lshl_add_u32 v250, v85, 5, v250
    v_lshrrev_b32 v90, 1, v88
    v_lshl_add_u32 v90, v86, 1, v90
    v_bfe_u32 v91, v87, 1, 1
    v_lshlrev_b32 v91, 2, v91
    v_xor_b32 v90, v90, v91
    v_lshlrev_b32 v90, 4, v90
    v_lshl_add_u32 v90, v89, 7, v90
    v_and_b32 v91, 1, v88
    v_lshl_add_u32 v90, v91, 3, v90
    v_add_u32 v246, s37, v90
    v_xor_b32 v247, 64, v246
    v_lshrrev_b32 v90, 3, v176
    v_lshlrev_b32 v251, 2, v90
    v_add_u32 v251, 768, v251
    v_bfe_u32 v90, v90, 1, 1
    v_lshlrev_b32 v90, 2, v90
    v_and_b32 v91, 7, v176
    v_xor_b32 v90, v90, v91
    v_lshlrev_b32 v248, 4, v90
    v_lshlrev_b32 v252, 1, v176
    v_and_b32 v231, 1, v176
    v_lshlrev_b32 v231, 4, v231
    v_lshrrev_b32 v90, 1, v176
    v_lshlrev_b32 v90, 5, v90
    v_add_u32 v230, 864, v90
    s_waitcnt lgkmcnt(0)
    s_barrier
    s_barrier
    s_waitcnt vmcnt(0)
    s_branch KS_B3
KS_TAG:
    s_mov_b32 s60, s98
    s_and_b32 s61, s99, 0xffff
    s_mov_b32 s62, 256
    s_mov_b32 s63, 0x20000
    s_mov_b64 exec, 1
    s_cmp_lg_u32 s2, 0
    s_cbranch_scc1 KS_TAGLD
    s_memrealtime s[24:25]
    s_waitcnt lgkmcnt(0)
    s_or_b32 s24, s24, 1
    v_mov_b32 v10, s24
    buffer_store_dword v10, v6, s[60:63], 0 offen sc1
KS_TAGLD:
    s_mov_b64 exec, -1
    v_mul_u32_u24 v76, 437, v177
    v_lshrrev_b32 v76, 16, v76
    v_mul_u32_u24 v76, 150, v76
    v_sub_u32 v76, v177, v76
    v_mov_b32 v80, -1
    v_mov_b32 v77, 1.0
    v_cmp_gt_u32 vcc, 48, v76
    v_lshlrev_b32 v78, 4, v177
    v_add_u32 v78, 65536, v78
    v_cndmask_b32 v80, v80, 0, vcc
    v_cmp_gt_u32 vcc, 12, v76
    v_add_u32 v79, 64800, v78
    s_nop 0
    v_cndmask_b32 v80, v80, v77, vcc
    v_cmp_gt_u32 vcc, 450, v177
    v_mov_b32 v81, v80
    v_mov_b32 v82, v80
    v_mov_b32 v83, v80
    s_mov_b64 exec, vcc
    ds_write_b128 v78, v[80:83] offset:0
    ds_write_b128 v78, v[80:83] offset:7200
    ds_write_b128 v78, v[80:83] offset:14400
    ds_write_b128 v78, v[80:83] offset:21600
    ds_write_b128 v78, v[80:83] offset:28800
    ds_write_b128 v78, v[80:83] offset:36000
    ds_write_b128 v78, v[80:83] offset:43200
    ds_write_b128 v78, v[80:83] offset:50400
    ds_write_b128 v78, v[80:83] offset:57600
    ds_write_b128 v79, v[80:83] offset:0
    ds_write_b128 v79, v[80:83] offset:7200
    ds_write_b128 v79, v[80:83] offset:14400
    ds_write_b128 v79, v[80:83] offset:21600
    v_cmp_gt_u32 vcc, 268, v177
    s_nop 0
    s_cbranch_vccz K2_NOCLd
    s_mov_b64 exec, vcc
    ds_write_b128 v79, v[80:83] offset:28800
K2_NOCLd:
    s_mov_b64 exec, -1
    s_cmp_lg_u32 s20, 7
    s_cbranch_scc1 K2_NOHd
    v_mov_b32 v76, 0
    v_mov_b32 v77, -1
    v_lshlrev_b32 v78, 2, v176
    v_add_u32 v78, 163424, v78
    s_mov_b64 exec, 0x1ff
    ds_write_b32 v78, v76 offset:192
    s_mov_b64 exec, 0xff
    ds_write_b32 v78, v77 offset:256
    s_mov_b64 exec, -1
    s_mov_b32 exec_hi, 0xffff
    ds_write_b32 v78, v76
    s_mov_b64 exec, 1
    ds_write_b32 v78, v76 offset:228
    s_mov_b64 exec, -1
K2_NOHd:
    v_and_b32 v84, 15, v176
    v_lshrrev_b32 v85, 5, v176
    v_bfe_u32 v86, v176, 4, 1
    v_lshrrev_b32 v87, 2, v84
    v_and_b32 v88, 3, v84
    v_lshl_add_u32 v89, v85, 3, v87
    v_lshlrev_b32 v249, 5, v89
    v_lshl_add_u32 v249, v88, 3, v249
    v_add_u32 v249, 864, v249
    v_mul_u32_u24 v250, 192, v86
    v_lshl_add_u32 v250, v85, 5, v250
    v_lshrrev_b32 v90, 1, v88
    v_lshl_add_u32 v90, v86, 1, v90
    v_bfe_u32 v91, v87, 1, 1
    v_lshlrev_b32 v91, 2, v91
    v_xor_b32 v90, v90, v91
    v_lshlrev_b32 v90, 4, v90
    v_lshl_add_u32 v90, v89, 7, v90
    v_and_b32 v91, 1, v88
    v_lshl_add_u32 v90, v91, 3, v90
    v_add_u32 v246, s37, v90
    v_xor_b32 v247, 64, v246
    v_lshrrev_b32 v90, 3, v176
    v_lshlrev_b32 v251, 2, v90
    v_add_u32 v251, 768, v251
    v_bfe_u32 v90, v90, 1, 1
    v_lshlrev_b32 v90, 2, v90
    v_and_b32 v91, 7, v176
    v_xor_b32 v90, v90, v91
    v_lshlrev_b32 v248, 4, v90
    v_lshlrev_b32 v252, 1, v176
    v_and_b32 v231, 1, v176
    v_lshlrev_b32 v231, 4, v231
    v_lshrrev_b32 v90, 1, v176
    v_lshlrev_b32 v90, 5, v90
    v_add_u32 v230, 864, v90
    s_mov_b64 exec, 1
    buffer_load_dword v10, v6, s[60:63], 0 offen sc1
    s_waitcnt lgkmcnt(0)
    s_barrier
    s_barrier
    s_mov_b32 s24, 0x100000
KS_TAGW:
    s_waitcnt vmcnt(0)
    v_cmp_ne_u32 vcc, 0, v10
    s_nop 0
    s_cbranch_vccnz KS_TAGOK
    s_sub_u32 s24, s24, 1
    s_cbranch_scc1 K2_END
    buffer_load_dword v10, v6, s[60:63], 0 offen sc1
    s_branch KS_TAGW
KS_TAGOK:
    v_mov_b32 v11, 163728
    ds_write_b32 v11, v10
    s_mov_b64 exec, -1
    s_waitcnt lgkmcnt(0)
KS_B3:
    s_mov_b32 s65, 0
    s_barrier
KS_JOIN:
    v_mov_b32 v59, 163728
    ds_read_b32 v59, v59
    v_lshrrev_b32 v60, 5, v176
    v_bfe_u32 v61, v176, 2, 2
    v_lshl_add_u32 v60, v60, 2, v61
    v_mul_u32_u24 v60, 1280, v60
    v_bfe_u32 v61, v176, 4, 1
    v_lshl_add_u32 v60, v61, 5, v60
    v_and_b32 v61, 3, v176
    v_lshl_add_u32 v60, v61, 3, v60
    ds_read_b64_tr_b16 v[136:137], v60 offset:24576
    ds_read_b64_tr_b16 v[138:139], v60 offset:34816
    ds_read_b64_tr_b16 v[140:141], v60 offset:24640
    ds_read_b64_tr_b16 v[142:143], v60 offset:34880
    ds_read_b64_tr_b16 v[144:145], v60 offset:24832
    ds_read_b64_tr_b16 v[146:147], v60 offset:35072
    ds_read_b64_tr_b16 v[148:149], v60 offset:24896
    ds_read_b64_tr_b16 v[150:151], v60 offset:35136
    ds_read_b64_tr_b16 v[152:153], v60 offset:25088
    ds_read_b64_tr_b16 v[154:155], v60 offset:35328
    ds_read_b64_tr_b16 v[156:157], v60 offset:25152
    ds_read_b64_tr_b16 v[158:159], v60 offset:35392
    ds_read_b64_tr_b16 v[160:161], v60 offset:25344
    ds_read_b64_tr_b16 v[162:163], v60 offset:35584
    ds_read_b64_tr_b16 v[164:165], v60 offset:25408
    ds_read_b64_tr_b16 v[166:167], v60 offset:35648
    ds_read_b64_tr_b16 v[168:169], v60 offset:25600
    ds_read_b64_tr_b16 v[170:171], v60 offset:35840
    ds_read_b64_tr_b16 v[172:173], v60 offset:25664
    ds_read_b64_tr_b16 v[174:175], v60 offset:35904
    s_waitcnt lgkmcnt(0)
    v_lshlrev_b32 v96, 16, v136
    v_and_b32 v97, 0xffff0000, v136
    v_lshlrev_b32 v98, 16, v137
    v_and_b32 v99, 0xffff0000, v137
    v_lshlrev_b32 v100, 16, v138
    v_and_b32 v101, 0xffff0000, v138
    v_lshlrev_b32 v102, 16, v139
    v_and_b32 v103, 0xffff0000, v139
    v_lshlrev_b32 v104, 16, v140
    v_and_b32 v105, 0xffff0000, v140
    v_lshlrev_b32 v106, 16, v141
    v_and_b32 v107, 0xffff0000, v141
    v_lshlrev_b32 v108, 16, v142
    v_and_b32 v109, 0xffff0000, v142
    v_lshlrev_b32 v110, 16, v143
    v_and_b32 v111, 0xffff0000, v143
    v_lshlrev_b32 v112, 16, v144
    v_and_b32 v113, 0xffff0000, v144
    v_lshlrev_b32 v114, 16, v145
    v_and_b32 v115, 0xffff0000, v145
    v_lshlrev_b32 v116, 16, v146
    v_and_b32 v117, 0xffff0000, v146
    v_lshlrev_b32 v118, 16, v147
    v_and_b32 v119, 0xffff0000, v147
    v_lshlrev_b32 v120, 16, v148
    v_and_b32 v121, 0xffff0000, v148
    v_lshlrev_b32 v122, 16, v149
    v_and_b32 v123, 0xffff0000, v149
    v_lshlrev_b32 v124, 16, v150
    v_and_b32 v125, 0xffff0000, v150
    v_lshlrev_b32 v126, 16, v151
    v_and_b32 v127, 0xffff0000, v151
    v_lshlrev_b32 v128, 16, v152
    v_and_b32 v129, 0xffff0000, v152
    v_lshlrev_b32 v130, 16, v153
    v_and_b32 v131, 0xffff0000, v153
    v_lshlrev_b32 v132, 16, v154
    v_and_b32 v133, 0xffff0000, v154
    v_lshlrev_b32 v134, 16, v155
    v_and_b32 v135, 0xffff0000, v155
    v_lshlrev_b32 v136, 16, v156
    v_and_b32 v137, 0xffff0000, v156
    v_lshlrev_b32 v138, 16, v157
    v_and_b32 v139, 0xffff0000, v157
    v_lshlrev_b32 v140, 16, v158
    v_and_b32 v141, 0xffff0000, v158
    v_lshlrev_b32 v142, 16, v159
    v_and_b32 v143, 0xffff0000, v159
    v_lshlrev_b32 v144, 16, v160
    v_and_b32 v145, 0xffff0000, v160
    v_lshlrev_b32 v146, 16, v161
    v_and_b32 v147, 0xffff0000, v161
    v_lshlrev_b32 v148, 16, v162
    v_and_b32 v149, 0xffff0000, v162
    v_lshlrev_b32 v150, 16, v163
    v_and_b32 v151, 0xffff0000, v163
    v_lshlrev_b32 v152, 16, v164
    v_and_b32 v153, 0xffff0000, v164
    v_lshlrev_b32 v154, 16, v165
    v_and_b32 v155, 0xffff0000, v165
    v_lshlrev_b32 v156, 16, v166
    v_and_b32 v157, 0xffff0000, v166
    v_lshlrev_b32 v158, 16, v167
    v_and_b32 v159, 0xffff0000, v167
    v_lshlrev_b32 v160, 16, v168
    v_and_b32 v161, 0xffff0000, v168
    v_lshlrev_b32 v162, 16, v169
    v_and_b32 v163, 0xffff0000, v169
    v_lshlrev_b32 v164, 16, v170
    v_and_b32 v165, 0xffff0000, v170
    v_lshlrev_b32 v166, 16, v171
    v_and_b32 v167, 0xffff0000, v171
    v_lshlrev_b32 v168, 16, v172
    v_and_b32 v169, 0xffff0000, v172
    v_lshlrev_b32 v170, 16, v173
    v_and_b32 v171, 0xffff0000, v173
    v_lshlrev_b32 v172, 16, v174
    v_and_b32 v173, 0xffff0000, v174
    v_lshlrev_b32 v174, 16, v175
    v_and_b32 v175, 0xffff0000, v175
    v_readfirstlane_b32 s2, v59
    v_lshl_or_b32 v58, v59, 22, v58
    s_cmp_eq_u32 s65, 0
    s_waitcnt vmcnt(0)
    s_barrier
    s_cbranch_scc1 KS_DONE
    buffer_store_dwordx2 v[58:59], v57, s[8:11], s64 offen sc1
KS_DONE:
    s_mov_b32 s4, s80
    s_and_b32 s5, s81, 0xffff
    s_mov_b32 s6, 10240000
    s_mov_b32 s7, 0x20000
    s_mov_b32 s12, s96
    s_and_b32 s13, s97, 0xffff
    s_mov_b32 s14, 10240000
    s_mov_b32 s15, 0x20000
    s_mov_b32 s16, s84
    s_and_b32 s17, s85, 0xffff
    s_mov_b32 s18, 10240000
    s_mov_b32 s19, 0x20000
    s_sub_u32 s80, s80, 1024
    s_subb_u32 s81, s81, 0
    s_mov_b32 s72, s80
    s_and_b32 s73, s81, 0xffff
    s_mov_b32 s74, 10241024
    s_mov_b32 s75, 0x20000
    s_mov_b32 s23, 0
    s_mov_b32 s28, 1
    s_mov_b32 s24, 0
    s_mov_b32 s25, 1
K2_CELLS:
    v_lshrrev_b32 v178, 1, v177
    v_min_u32 v178, 249, v178
    v_lshlrev_b32 v72, 3, v178
    s_mul_i32 s67, s54, 2176
    s_add_u32 s67, s67, 6291456
    s_and_b32 s59, s2, 0x3ff
    s_mov_b32 s60, 0x100000
    v_cmp_gt_u32 vcc, 500, v177
    s_nop 0
    s_mov_b64 s[56:57], vcc
K2_POLL:
    buffer_load_dwordx2 v[74:75], v72, s[8:11], s67 offen sc1
    s_mov_b64 exec, -1
    s_waitcnt vmcnt(0)
    v_lshrrev_b32 v73, 22, v74
    v_cmp_ne_u32 vcc, s2, v75
    v_cmp_ne_u32 s[62:63], s59, v73
    s_nop 0
    s_or_b64 vcc, vcc, s[62:63]
    s_cbranch_scc0 K2_POLLED
    s_mov_b64 exec, vcc
    s_sub_u32 s60, s60, 1
    s_cbranch_scc0 K2_POLL
    s_branch K2_END
K2_POLLED:
    v_bfe_u32 v73, v74, 11, 11
    v_and_b32 v74, 0x7ff, v74
    v_lshl_or_b32 v179, v73, 16, v74
    v_cndmask_b32 v179, 0, v179, s[56:57]
    v_and_b32 v1, 1, v177
    v_add_u32 v1, s23, v1
    v_lshrrev_b32 v180, 16, v179
    v_sub_u32 v180, v180, v1
    v_and_b32 v179, 0xffff, v179
    v_add_u32 v179, v179, v1
    v_mul_u32_u24 v181, 20608, v178
    v_lshl_add_u32 v181, v179, 4, v181
    v_mul_u32_u24 v178, 1280, v178
    v_cmp_lt_i32 vcc, 0, v180
    s_nop 0
    s_cbranch_vccz K2_LD_DONE
    s_mov_b64 exec, vcc
    buffer_load_dwordx4 v[0:3], v181, s[8:11], 0 offen offset:0 sc1
    v_cmp_lt_i32 vcc, 2, v180
    s_nop 0
    s_cbranch_vccz K2_LD_DONE
    s_mov_b64 exec, vcc
    buffer_load_dwordx4 v[4:7], v181, s[8:11], 0 offen offset:32 sc1
    v_cmp_lt_i32 vcc, 4, v180
    s_nop 0
    s_cbranch_vccz K2_LD_DONE
    s_mov_b64 exec, vcc
    buffer_load_dwordx4 v[8:11], v181, s[8:11], 0 offen offset:64 sc1
    v_cmp_lt_i32 vcc, 6, v180
    s_nop 0
    s_cbranch_vccz K2_LD_DONE
    s_mov_b64 exec, vcc
    buffer_load_dwordx4 v[12:15], v181, s[8:11], 0 offen offset:96 sc1
    v_cmp_lt_i32 vcc, 8, v180
    s_nop 0
    s_cbranch_vccz K2_LD_DONE
    s_mov_b64 exec, vcc
    buffer_load_dwordx4 v[16:19], v181, s[8:11], 0 offen offset:128 sc1
    v_cmp_lt_i32 vcc, 10, v180
    s_nop 0
    s_cbranch_vccz K2_LD_DONE
    s_mov_b64 exec, vcc
    buffer_load_dwordx4 v[20:23], v181, s[8:11], 0 offen offset:160 sc1
    v_cmp_lt_i32 vcc, 12, v180
    s_nop 0
    s_cbranch_vccz K2_LD_DONE
    s_mov_b64 exec, vcc
    buffer_load_dwordx4 v[24:27], v181, s[8:11], 0 offen offset:192 sc1
    v_cmp_lt_i32 vcc, 14, v180
    s_nop 0
    s_cbranch_vccz K2_LD_DONE
    s_mov_b64 exec, vcc
    buffer_load_dwordx4 v[28:31], v181, s[8:11], 0 offen offset:224 sc1
    v_cmp_lt_i32 vcc, 16, v180
    s_nop 0
    s_cbranch_vccz K2_LD_DONE
    s_mov_b64 exec, vcc
    buffer_load_dwordx4 v[32:35], v181, s[8:11], 0 offen offset:256 sc1
    v_cmp_lt_i32 vcc, 18, v180
    s_nop 0
    s_cbranch_vccz K2_LD_DONE
    s_mov_b64 exec, vcc
    buffer_load_dwordx4 v[36:39], v181, s[8:11], 0 offen offset:288 sc1
K2_LD_DONE:
    s_mov_b64 exec, -1
    v_add_lshl_u32 v179, v179, v178, 2
    s_mov_b32 s66, 7340032
    v_mov_b32 v201, 1
    s_waitcnt lgkmcnt(0)
    s_barrier
    s_cmp_lg_u32 s24, 0
    s_cbranch_scc1 K2_RK_LOAD
    v_cmp_lt_i32 vcc, 20, v180
    s_nop 0
    s_cbranch_vccz K2_NOMORE
    v_mov_b32 v61, 163652
    ds_write_b32 v61, v201
K2_NOMORE:
    s_mov_b32 s58, 163424
    s_movk_i32 s59, 2400
    v_mov_b32 v202, 65536
    s_waitcnt vmcnt(0)
    v_cmp_lt_i32 vcc, 0, v180
    s_nop 0
    s_cbranch_vccz K2_RK_A
    s_mov_b64 exec, vcc
    v_lshrrev_b32 v50, 25, v3
    v_lshl_add_u32 v40, v50, 2, s58
    ds_add_rtn_u32 v40, v40, v201
    v_mad_u32_u24 v50, v50, s59, v202
    v_bfe_u32 v60, v3, 14, 11
    v_add_lshl_u32 v60, v60, v178, 5
    v_and_b32 v3, 0x3fff, v3
    v_cmp_lt_i32 vcc, 2, v180
    s_nop 0
    s_cbranch_vccz K2_RK_A
    s_mov_b64 exec, vcc
    v_lshrrev_b32 v51, 25, v7
    v_lshl_add_u32 v41, v51, 2, s58
    ds_add_rtn_u32 v41, v41, v201
    v_mad_u32_u24 v51, v51, s59, v202
    v_bfe_u32 v61, v7, 14, 11
    v_add_lshl_u32 v61, v61, v178, 5
    v_and_b32 v7, 0x3fff, v7
    v_cmp_lt_i32 vcc, 4, v180
    s_nop 0
    s_cbranch_vccz K2_RK_A
    s_mov_b64 exec, vcc
    v_lshrrev_b32 v52, 25, v11
    v_lshl_add_u32 v42, v52, 2, s58
    ds_add_rtn_u32 v42, v42, v201
    v_mad_u32_u24 v52, v52, s59, v202
    v_bfe_u32 v62, v11, 14, 11
    v_add_lshl_u32 v62, v62, v178, 5
    v_and_b32 v11, 0x3fff, v11
    v_cmp_lt_i32 vcc, 6, v180
    s_nop 0
    s_cbranch_vccz K2_RK_A
    s_mov_b64 exec, vcc
    v_lshrrev_b32 v53, 25, v15
    v_lshl_add_u32 v43, v53, 2, s58
    ds_add_rtn_u32 v43, v43, v201
    v_mad_u32_u24 v53, v53, s59, v202
    v_bfe_u32 v63, v15, 14, 11
    v_add_lshl_u32 v63, v63, v178, 5
    v_and_b32 v15, 0x3fff, v15
    v_cmp_lt_i32 vcc, 8, v180
    s_nop 0
    s_cbranch_vccz K2_RK_A
    s_mov_b64 exec, vcc
    v_lshrrev_b32 v54, 25, v19
    v_lshl_add_u32 v44, v54, 2, s58
    ds_add_rtn_u32 v44, v44, v201
    v_mad_u32_u24 v54, v54, s59, v202
    v_bfe_u32 v64, v19, 14, 11
    v_add_lshl_u32 v64, v64, v178, 5
    v_and_b32 v19, 0x3fff, v19
    v_cmp_lt_i32 vcc, 10, v180
    s_nop 0
    s_cbranch_vccz K2_RK_A
    s_mov_b64 exec, vcc
    v_lshrrev_b32 v55, 25, v23
    v_lshl_add_u32 v45, v55, 2, s58
    ds_add_rtn_u32 v45, v45, v201
    v_mad_u32_u24 v55, v55, s59, v202
    v_bfe_u32 v65, v23, 14, 11
    v_add_lshl_u32 v65, v65, v178, 5
    v_and_b32 v23, 0x3fff, v23
    v_cmp_lt_i32 vcc, 12, v180
    s_nop 0
    s_cbranch_vccz K2_RK_A
    s_mov_b64 exec, vcc
    v_lshrrev_b32 v56, 25, v27
    v_lshl_add_u32 v46, v56, 2, s58
    ds_add_rtn_u32 v46, v46, v201
    v_mad_u32_u24 v56, v56, s59, v202
    v_bfe_u32 v66, v27, 14, 11
    v_add_lshl_u32 v66, v66, v178, 5
    v_and_b32 v27, 0x3fff, v27
    v_cmp_lt_i32 vcc, 14, v180
    s_nop 0
    s_cbranch_vccz K2_RK_A
    s_mov_b64 exec, vcc
    v_lshrrev_b32 v57, 25, v31
    v_lshl_add_u32 v47, v57, 2, s58
    ds_add_rtn_u32 v47, v47, v201
    v_mad_u32_u24 v57, v57, s59, v202
    v_bfe_u32 v67, v31, 14, 11
    v_add_lshl_u32 v67, v67, v178, 5
    v_and_b32 v31, 0x3fff, v31
    v_cmp_lt_i32 vcc, 16, v180
    s_nop 0
    s_cbranch_vccz K2_RK_A
    s_mov_b64 exec, vcc
    v_lshrrev_b32 v58, 25, v35
    v_lshl_add_u32 v48, v58, 2, s58
    ds_add_rtn_u32 v48, v48, v201
    v_mad_u32_u24 v58, v58, s59, v202
    v_bfe_u32 v68, v35, 14, 11
    v_add_lshl_u32 v68, v68, v178, 5
    v_and_b32 v35, 0x3fff, v35
    v_cmp_lt_i32 vcc, 18, v180
    s_nop 0
    s_cbranch_vccz K2_RK_A
    s_mov_b64 exec, vcc
    v_lshrrev_b32 v59, 25, v39
    v_lshl_add_u32 v49, v59, 2, s58
    ds_add_rtn_u32 v49, v49, v201
    v_mad_u32_u24 v59, v59, s59, v202
    v_bfe_u32 v69, v39, 14, 11
    v_add_lshl_u32 v69, v69, v178, 5
    v_and_b32 v39, 0x3fff, v39
K2_RK_A:
    s_mov_b64 exec, -1
    s_branch K2_RK_DONE
K2_RK_LOAD:
    s_movk_i32 s59, 2400
    v_mov_b32 v202, 65536
    s_waitcnt vmcnt(0)
    v_cmp_lt_i32 vcc, 0, v180
    s_nop 0
    s_cbranch_vccz K2_RK_B
    s_mov_b64 exec, vcc
    v_lshrrev_b32 v50, 25, v3
    buffer_load_dword v40, v179, s[8:11], s66 offen offset:0
    v_mad_u32_u24 v50, v50, s59, v202
    v_bfe_u32 v60, v3, 14, 11
    v_add_lshl_u32 v60, v60, v178, 5
    v_and_b32 v3, 0x3fff, v3
    v_cmp_lt_i32 vcc, 2, v180
    s_nop 0
    s_cbranch_vccz K2_RK_B
    s_mov_b64 exec, vcc
    v_lshrrev_b32 v51, 25, v7
    buffer_load_dword v41, v179, s[8:11], s66 offen offset:8
    v_mad_u32_u24 v51, v51, s59, v202
    v_bfe_u32 v61, v7, 14, 11
    v_add_lshl_u32 v61, v61, v178, 5
    v_and_b32 v7, 0x3fff, v7
    v_cmp_lt_i32 vcc, 4, v180
    s_nop 0
    s_cbranch_vccz K2_RK_B
    s_mov_b64 exec, vcc
    v_lshrrev_b32 v52, 25, v11
    buffer_load_dword v42, v179, s[8:11], s66 offen offset:16
    v_mad_u32_u24 v52, v52, s59, v202
    v_bfe_u32 v62, v11, 14, 11
    v_add_lshl_u32 v62, v62, v178, 5
    v_and_b32 v11, 0x3fff, v11
    v_cmp_lt_i32 vcc, 6, v180
    s_nop 0
    s_cbranch_vccz K2_RK_B
    s_mov_b64 exec, vcc
    v_lshrrev_b32 v53, 25, v15
    buffer_load_dword v43, v179, s[8:11], s66 offen offset:24
    v_mad_u32_u24 v53, v53, s59, v202
    v_bfe_u32 v63, v15, 14, 11
    v_add_lshl_u32 v63, v63, v178, 5
    v_and_b32 v15, 0x3fff, v15
    v_cmp_lt_i32 vcc, 8, v180
    s_nop 0
    s_cbranch_vccz K2_RK_B
    s_mov_b64 exec, vcc
    v_lshrrev_b32 v54, 25, v19
    buffer_load_dword v44, v179, s[8:11], s66 offen offset:32
    v_mad_u32_u24 v54, v54, s59, v202
    v_bfe_u32 v64, v19, 14, 11
    v_add_lshl_u32 v64, v64, v178, 5
    v_and_b32 v19, 0x3fff, v19
    v_cmp_lt_i32 vcc, 10, v180
    s_nop 0
    s_cbranch_vccz K2_RK_B
    s_mov_b64 exec, vcc
    v_lshrrev_b32 v55, 25, v23
    buffer_load_dword v45, v179, s[8:11], s66 offen offset:40
    v_mad_u32_u24 v55, v55, s59, v202
    v_bfe_u32 v65, v23, 14, 11
    v_add_lshl_u32 v65, v65, v178, 5
    v_and_b32 v23, 0x3fff, v23
    v_cmp_lt_i32 vcc, 12, v180
    s_nop 0
    s_cbranch_vccz K2_RK_B
    s_mov_b64 exec, vcc
    v_lshrrev_b32 v56, 25, v27
    buffer_load_dword v46, v179, s[8:11], s66 offen offset:48
    v_mad_u32_u24 v56, v56, s59, v202
    v_bfe_u32 v66, v27, 14, 11
    v_add_lshl_u32 v66, v66, v178, 5
    v_and_b32 v27, 0x3fff, v27
    v_cmp_lt_i32 vcc, 14, v180
    s_nop 0
    s_cbranch_vccz K2_RK_B
    s_mov_b64 exec, vcc
    v_lshrrev_b32 v57, 25, v31
    buffer_load_dword v47, v179, s[8:11], s66 offen offset:56
    v_mad_u32_u24 v57, v57, s59, v202
    v_bfe_u32 v67, v31, 14, 11
    v_add_lshl_u32 v67, v67, v178, 5
    v_and_b32 v31, 0x3fff, v31
    v_cmp_lt_i32 vcc, 16, v180
    s_nop 0
    s_cbranch_vccz K2_RK_B
    s_mov_b64 exec, vcc
    v_lshrrev_b32 v58, 25, v35
    buffer_load_dword v48, v179, s[8:11], s66 offen offset:64
    v_mad_u32_u24 v58, v58, s59, v202
    v_bfe_u32 v68, v35, 14, 11
    v_add_lshl_u32 v68, v68, v178, 5
    v_and_b32 v35, 0x3fff, v35
    v_cmp_lt_i32 vcc, 18, v180
    s_nop 0
    s_cbranch_vccz K2_RK_B
    s_mov_b64 exec, vcc
    v_lshrrev_b32 v59, 25, v39
    buffer_load_dword v49, v179, s[8:11], s66 offen offset:72
    v_mad_u32_u24 v59, v59, s59, v202
    v_bfe_u32 v69, v39, 14, 11
    v_add_lshl_u32 v69, v69, v178, 5
    v_and_b32 v39, 0x3fff, v39
K2_RK_B:
    s_mov_b64 exec, -1
    s_waitcnt vmcnt(0)
K2_RK_DONE:
    s_mul_i32 s67, s24, 48
    s_waitcnt lgkmcnt(0)
    v_cmp_lt_i32 vcc, 0, v180
    s_nop 0
    s_cbranch_vccz K2_SC_DONE
    v_subrev_u32 v192, s67, v40
    v_cmp_gt_u32 s[56:57], 48, v192
    s_nop 0
    s_and_b64 exec, vcc, s[56:57]
    s_cbranch_execz K2_sc_1
    v_lshl_add_u32 v194, v192, 5, v50
    v_lshl_add_u32 v195, v192, 2, v50
    v_and_b32 v196, 7, v192
    v_add_lshl_u32 v196, v196, v192, 1
    v_bfe_u32 v193, v192, 3, 1
    v_mad_i32_i24 v196, v193, -14, v196
    v_add_u32 v196, v196, v50
    ds_write_b32 v194, v60 offset:864
    ds_write2_b32 v195, v0, v1 offset0:48 offset1:96
    ds_write_b32 v195, v2 offset:576
    ds_write_b16 v196, v3 offset:768
K2_sc_1:
    s_mov_b64 exec, -1
    v_cmp_lt_i32 vcc, 2, v180
    s_nop 0
    s_cbranch_vccz K2_SC_DONE
    v_subrev_u32 v192, s67, v41
    v_cmp_gt_u32 s[56:57], 48, v192
    s_nop 0
    s_and_b64 exec, vcc, s[56:57]
    s_cbranch_execz K2_sc_2
    v_lshl_add_u32 v194, v192, 5, v51
    v_lshl_add_u32 v195, v192, 2, v51
    v_and_b32 v196, 7, v192
    v_add_lshl_u32 v196, v196, v192, 1
    v_bfe_u32 v193, v192, 3, 1
    v_mad_i32_i24 v196, v193, -14, v196
    v_add_u32 v196, v196, v51
    ds_write_b32 v194, v61 offset:864
    ds_write2_b32 v195, v4, v5 offset0:48 offset1:96
    ds_write_b32 v195, v6 offset:576
    ds_write_b16 v196, v7 offset:768
K2_sc_2:
    s_mov_b64 exec, -1
    v_cmp_lt_i32 vcc, 4, v180
    s_nop 0
    s_cbranch_vccz K2_SC_DONE
    v_subrev_u32 v192, s67, v42
    v_cmp_gt_u32 s[56:57], 48, v192
    s_nop 0
    s_and_b64 exec, vcc, s[56:57]
    s_cbranch_execz K2_sc_3
    v_lshl_add_u32 v194, v192, 5, v52
    v_lshl_add_u32 v195, v192, 2, v52
    v_and_b32 v196, 7, v192
    v_add_lshl_u32 v196, v196, v192, 1
    v_bfe_u32 v193, v192, 3, 1
    v_mad_i32_i24 v196, v193, -14, v196
    v_add_u32 v196, v196, v52
    ds_write_b32 v194, v62 offset:864
    ds_write2_b32 v195, v8, v9 offset0:48 offset1:96
    ds_write_b32 v195, v10 offset:576
    ds_write_b16 v196, v11 offset:768
K2_sc_3:
    s_mov_b64 exec, -1
    v_cmp_lt_i32 vcc, 6, v180
    s_nop 0
    s_cbranch_vccz K2_SC_DONE
    v_subrev_u32 v192, s67, v43
    v_cmp_gt_u32 s[56:57], 48, v192
    s_nop 0
    s_and_b64 exec, vcc, s[56:57]
    s_cbranch_execz K2_sc_4
    v_lshl_add_u32 v194, v192, 5, v53
    v_lshl_add_u32 v195, v192, 2, v53
    v_and_b32 v196, 7, v192
    v_add_lshl_u32 v196, v196, v192, 1
    v_bfe_u32 v193, v192, 3, 1
    v_mad_i32_i24 v196, v193, -14, v196
    v_add_u32 v196, v196, v53
    ds_write_b32 v194, v63 offset:864
    ds_write2_b32 v195, v12, v13 offset0:48 offset1:96
    ds_write_b32 v195, v14 offset:576
    ds_write_b16 v196, v15 offset:768
K2_sc_4:
    s_mov_b64 exec, -1
    v_cmp_lt_i32 vcc, 8, v180
    s_nop 0
    s_cbranch_vccz K2_SC_DONE
    v_subrev_u32 v192, s67, v44
    v_cmp_gt_u32 s[56:57], 48, v192
    s_nop 0
    s_and_b64 exec, vcc, s[56:57]
    s_cbranch_execz K2_sc_5
    v_lshl_add_u32 v194, v192, 5, v54
    v_lshl_add_u32 v195, v192, 2, v54
    v_and_b32 v196, 7, v192
    v_add_lshl_u32 v196, v196, v192, 1
    v_bfe_u32 v193, v192, 3, 1
    v_mad_i32_i24 v196, v193, -14, v196
    v_add_u32 v196, v196, v54
    ds_write_b32 v194, v64 offset:864
    ds_write2_b32 v195, v16, v17 offset0:48 offset1:96
    ds_write_b32 v195, v18 offset:576
    ds_write_b16 v196, v19 offset:768
K2_sc_5:
    s_mov_b64 exec, -1
    v_cmp_lt_i32 vcc, 10, v180
    s_nop 0
    s_cbranch_vccz K2_SC_DONE
    v_subrev_u32 v192, s67, v45
    v_cmp_gt_u32 s[56:57], 48, v192
    s_nop 0
    s_and_b64 exec, vcc, s[56:57]
    s_cbranch_execz K2_sc_6
    v_lshl_add_u32 v194, v192, 5, v55
    v_lshl_add_u32 v195, v192, 2, v55
    v_and_b32 v196, 7, v192
    v_add_lshl_u32 v196, v196, v192, 1
    v_bfe_u32 v193, v192, 3, 1
    v_mad_i32_i24 v196, v193, -14, v196
    v_add_u32 v196, v196, v55
    ds_write_b32 v194, v65 offset:864
    ds_write2_b32 v195, v20, v21 offset0:48 offset1:96
    ds_write_b32 v195, v22 offset:576
    ds_write_b16 v196, v23 offset:768
K2_sc_6:
    s_mov_b64 exec, -1
    v_cmp_lt_i32 vcc, 12, v180
    s_nop 0
    s_cbranch_vccz K2_SC_DONE
    v_subrev_u32 v192, s67, v46
    v_cmp_gt_u32 s[56:57], 48, v192
    s_nop 0
    s_and_b64 exec, vcc, s[56:57]
    s_cbranch_execz K2_sc_7
    v_lshl_add_u32 v194, v192, 5, v56
    v_lshl_add_u32 v195, v192, 2, v56
    v_and_b32 v196, 7, v192
    v_add_lshl_u32 v196, v196, v192, 1
    v_bfe_u32 v193, v192, 3, 1
    v_mad_i32_i24 v196, v193, -14, v196
    v_add_u32 v196, v196, v56
    ds_write_b32 v194, v66 offset:864
    ds_write2_b32 v195, v24, v25 offset0:48 offset1:96
    ds_write_b32 v195, v26 offset:576
    ds_write_b16 v196, v27 offset:768
K2_sc_7:
    s_mov_b64 exec, -1
    v_cmp_lt_i32 vcc, 14, v180
    s_nop 0
    s_cbranch_vccz K2_SC_DONE
    v_subrev_u32 v192, s67, v47
    v_cmp_gt_u32 s[56:57], 48, v192
    s_nop 0
    s_and_b64 exec, vcc, s[56:57]
    s_cbranch_execz K2_sc_8
    v_lshl_add_u32 v194, v192, 5, v57
    v_lshl_add_u32 v195, v192, 2, v57
    v_and_b32 v196, 7, v192
    v_add_lshl_u32 v196, v196, v192, 1
    v_bfe_u32 v193, v192, 3, 1
    v_mad_i32_i24 v196, v193, -14, v196
    v_add_u32 v196, v196, v57
    ds_write_b32 v194, v67 offset:864
    ds_write2_b32 v195, v28, v29 offset0:48 offset1:96
    ds_write_b32 v195, v30 offset:576
    ds_write_b16 v196, v31 offset:768
K2_sc_8:
    s_mov_b64 exec, -1
    v_cmp_lt_i32 vcc, 16, v180
    s_nop 0
    s_cbranch_vccz K2_SC_DONE
    v_subrev_u32 v192, s67, v48
    v_cmp_gt_u32 s[56:57], 48, v192
    s_nop 0
    s_and_b64 exec, vcc, s[56:57]
    s_cbranch_execz K2_sc_9
    v_lshl_add_u32 v194, v192, 5, v58
    v_lshl_add_u32 v195, v192, 2, v58
    v_and_b32 v196, 7, v192
    v_add_lshl_u32 v196, v196, v192, 1
    v_bfe_u32 v193, v192, 3, 1
    v_mad_i32_i24 v196, v193, -14, v196
    v_add_u32 v196, v196, v58
    ds_write_b32 v194, v68 offset:864
    ds_write2_b32 v195, v32, v33 offset0:48 offset1:96
    ds_write_b32 v195, v34 offset:576
    ds_write_b16 v196, v35 offset:768
K2_sc_9:
    s_mov_b64 exec, -1
    v_cmp_lt_i32 vcc, 18, v180
    s_nop 0
    s_cbranch_vccz K2_SC_DONE
    v_subrev_u32 v192, s67, v49
    v_cmp_gt_u32 s[56:57], 48, v192
    s_nop 0
    s_and_b64 exec, vcc, s[56:57]
    s_cbranch_execz K2_sc_10
    v_lshl_add_u32 v194, v192, 5, v59
    v_lshl_add_u32 v195, v192, 2, v59
    v_and_b32 v196, 7, v192
    v_add_lshl_u32 v196, v196, v192, 1
    v_bfe_u32 v193, v192, 3, 1
    v_mad_i32_i24 v196, v193, -14, v196
    v_add_u32 v196, v196, v59
    ds_write_b32 v194, v69 offset:864
    ds_write2_b32 v195, v36, v37 offset0:48 offset1:96
    ds_write_b32 v195, v38 offset:576
    ds_write_b16 v196, v39 offset:768
K2_sc_10:
    s_mov_b64 exec, -1
K2_SC_DONE:
    v_lshlrev_b32 v192, 2, v176
    v_add_u32 v192, 163424, v192
    v_mov_b32 v200, 163652
    v_mov_b32 v198, 0
    s_movk_i32 s26, 48
    s_waitcnt lgkmcnt(0)
    s_barrier
    ds_read_b32 v193, v192
    ds_read_b32 v200, v200
    v_cmp_gt_u32 s[56:57], s22, v176
    v_mad_u32_u24 v195, v176, s59, v202
    v_lshl_or_b32 v195, v176, 21, v195
    s_waitcnt lgkmcnt(0)
    v_cndmask_b32 v193, 0, v193, s[56:57]
    v_readfirstlane_b32 s27, v200
    v_cmp_lt_u32 vcc, 48, v193
    s_nop 0
    s_cbranch_vccnz K2_BIG
K2_TOK:
    v_subrev_u32 v194, s67, v193
    v_max_i32 v194, 1, v194
    v_min_i32 v194, s26, v194
    v_add_u32 v194, 15, v194
    v_lshrrev_b32 v194, 4, v194
    v_lshl_or_b32 v195, v194, 18, v195
    v_or_b32 v195, v195, v198
    v_mov_b32 v197, 425056
    v_cndmask_b32 v253, v197, v195, s[56:57]
    s_movk_i32 s40, 0
    s_movk_i32 s41, 256
    s_movk_i32 s42, 512
    s_movk_i32 s43, 768
    s_mov_b32 s38, 0
    s_mov_b32 s34, 0
    s_mov_b32 s35, 0
    s_mov_b32 s36, 1
    s_mov_b32 s31, 0
    s_mov_b32 s58, s20
    v_readlane_b32 s3, v253, s58
    s_lshl_b32 s44, s34, 7
    s_lshl_b32 s60, s58, 5
    s_and_b32 s48, s3, 0x3ffff
    s_bfe_u32 s33, s3, 0x30012
    s_sub_u32 s60, s60, s48
    s_and_b32 s60, s60, 0xff
    s_add_u32 s60, s60, s48
    s_mul_i32 s35, s38, 6
    s_cmp_eq_u32 s34, 0
    s_cselect_b32 s35, s35, s60
    s_mov_b32 s45, s44
    s_add_u32 s47, s44, 256
    s_add_u32 s49, s48, 32
    s_add_u32 s60, s48, 64
    s_cmp_eq_u32 s33, 3
    s_cselect_b32 s46, s44, s47
    s_cselect_b32 s50, s60, s48
    s_cselect_b32 s51, s48, s49
    s_sub_u32 s60, s33, 2
    s_cmp_lt_u32 s60, 2
    s_cbranch_scc0 K2_rare_21
K2_back_22:
    v_add_u32 v233, s48, v230
    ds_read_b32 v232, v233
    ds_read_b32 v233, v233 offset:1024
    v_add_u32 v222, s48, v251
    ds_read_b32 v222, v222
    v_add_u32 v224, s49, v251
    ds_read_b32 v224, v224
    v_add_u32 v226, s50, v251
    ds_read_b32 v226, v226
    v_add_u32 v228, s51, v251
    ds_read_b32 v228, v228
    s_waitcnt lgkmcnt(4)
    v_or_b32 v232, v232, v231
    v_or_b32 v233, v233, v231
    s_cmp_lg_u32 s34, 0
    s_cbranch_scc1 K2_dum_24
    s_add_u32 m0, s48, 864
    s_add_u32 s65, s48, 1888
    buffer_load_dwordx4 v232, s[16:19], 0 offen  lds
    s_mov_b32 m0, s65
    s_mov_b32 exec_hi, 0
    buffer_load_dwordx4 v233, s[16:19], 0 offen  lds
    s_cmp_eq_u32 s33, 4
    s_cbranch_scc1 K2_a4_25
K2_b4_27:
    s_mov_b32 exec_hi, -1
K2_back_26:
    s_waitcnt lgkmcnt(3)
    v_mad_u32_u16 v223, v222, s39, v248 op_sel:[1,0,0,0]
    v_mad_u32_u16 v222, v222, s39, v248
    s_waitcnt lgkmcnt(2)
    v_mad_u32_u16 v225, v224, s39, v248 op_sel:[1,0,0,0]
    v_mad_u32_u16 v224, v224, s39, v248
    s_waitcnt lgkmcnt(1)
    v_mad_u32_u16 v227, v226, s39, v248 op_sel:[1,0,0,0]
    v_mad_u32_u16 v226, v226, s39, v248
    s_waitcnt lgkmcnt(0)
    v_mad_u32_u16 v229, v228, s39, v248 op_sel:[1,0,0,0]
    v_mad_u32_u16 v228, v228, s39, v248
    s_mov_b32 m0, s68
    s_nop 0
    buffer_load_dwordx4 v222, s[4:7], s44 offen lds
    buffer_load_dwordx4 v223, s[72:75], s44 offen offset:1024 lds
    s_mov_b32 m0, s69
    s_nop 0
    buffer_load_dwordx4 v224, s[4:7], s45 offen lds
    buffer_load_dwordx4 v225, s[72:75], s45 offen offset:1024 lds
    s_mov_b32 m0, s70
    s_nop 0
    buffer_load_dwordx4 v226, s[4:7], s46 offen lds
    buffer_load_dwordx4 v227, s[72:75], s46 offen offset:1024 lds
    s_mov_b32 m0, s71
    s_nop 0
    buffer_load_dwordx4 v228, s[4:7], s47 offen lds
    buffer_load_dwordx4 v229, s[72:75], s47 offen offset:1024 lds
    v_add_u32 v249, s48, v249
    v_add_u32 v250, s48, v250
    s_waitcnt vmcnt(6)
    ds_read_b64_tr_b16 v[176:177], v246 offset:0
    ds_read_b64_tr_b16 v[178:179], v246 offset:512
    ds_read_b64_tr_b16 v[180:181], v247 offset:0
    ds_read_b64_tr_b16 v[182:183], v247 offset:512
    ds_read_b64_tr_b16 v[0:1], v249 offset:0
    ds_read_b64_tr_b16 v[2:3], v249 offset:128
    ds_read_b128 v[4:7], v250 offset:0
    ds_read_b128 v[8:11], v250 offset:16
    ds_read_b128 v[12:15], v250 offset:384
    ds_read_b128 v[16:19], v250 offset:400
    ds_read_b64_tr_b16 v[20:21], v249 offset:512
    ds_read_b64_tr_b16 v[22:23], v249 offset:640
    ds_read_b128 v[24:27], v250 offset:64
    ds_read_b128 v[28:31], v250 offset:80
    ds_read_b128 v[32:35], v250 offset:448
    ds_read_b128 v[36:39], v250 offset:464
    s_mov_b32 s29, s48
    s_mov_b32 s32, s31
    s_mov_b32 s30, s3
    s_mov_b32 s31, s35
    s_cmp_eq_u32 s33, 2
    s_cbranch_scc1 K2_U20
    s_cmp_eq_u32 s33, 3
    s_cbranch_scc1 K2_U30
    s_cmp_eq_u32 s33, 1
    s_cbranch_scc1 K2_U10
    s_branch K2_U40
K2_U20:
    s_setprio 1
    s_waitcnt lgkmcnt(10)
    v_lshlrev_b32 v40, 16, v0
    v_and_b32 v41, 0xffff0000, v0
    v_lshlrev_b32 v42, 16, v1
    v_and_b32 v43, 0xffff0000, v1
    v_lshlrev_b32 v44, 16, v2
    v_and_b32 v45, 0xffff0000, v2
    v_lshlrev_b32 v46, 16, v3
    v_and_b32 v47, 0xffff0000, v3
    s_waitcnt lgkmcnt(8)
    v_mul_f32 v4, v40, v4
    v_mul_f32 v5, v41, v5
    v_mul_f32 v6, v42, v6
    v_mul_f32 v7, v43, v7
    v_mul_f32 v8, v44, v8
    v_mul_f32 v9, v45, v9
    v_mul_f32 v10, v46, v10
    v_mul_f32 v11, v47, v11
    v_cvt_pk_bf16_f32 v64, v4, v5
    v_cvt_pk_bf16_f32 v65, v6, v7
    v_cvt_pk_bf16_f32 v66, v8, v9
    v_cvt_pk_bf16_f32 v67, v10, v11
    s_waitcnt lgkmcnt(6)
    v_mul_f32 v12, v40, v12
    v_mul_f32 v13, v41, v13
    v_mul_f32 v14, v42, v14
    v_mul_f32 v15, v43, v15
    v_mul_f32 v16, v44, v16
    v_mul_f32 v17, v45, v17
    v_mul_f32 v18, v46, v18
    v_mul_f32 v19, v47, v19
    v_cvt_pk_bf16_f32 v68, v12, v13
    v_cvt_pk_bf16_f32 v69, v14, v15
    v_cvt_pk_bf16_f32 v70, v16, v17
    v_cvt_pk_bf16_f32 v71, v18, v19
    s_waitcnt lgkmcnt(4)
    v_lshlrev_b32 v48, 16, v20
    v_and_b32 v49, 0xffff0000, v20
    v_lshlrev_b32 v50, 16, v21
    v_and_b32 v51, 0xffff0000, v21
    v_lshlrev_b32 v52, 16, v22
    v_and_b32 v53, 0xffff0000, v22
    v_lshlrev_b32 v54, 16, v23
    v_and_b32 v55, 0xffff0000, v23
    s_waitcnt lgkmcnt(2)
    v_mul_f32 v24, v48, v24
    v_mul_f32 v25, v49, v25
    v_mul_f32 v26, v50, v26
    v_mul_f32 v27, v51, v27
    v_mul_f32 v28, v52, v28
    v_mul_f32 v29, v53, v29
    v_mul_f32 v30, v54, v30
    v_mul_f32 v31, v55, v31
    v_cvt_pk_bf16_f32 v72, v24, v25
    v_cvt_pk_bf16_f32 v73, v26, v27
    v_cvt_pk_bf16_f32 v74, v28, v29
    v_cvt_pk_bf16_f32 v75, v30, v31
    s_waitcnt lgkmcnt(0)
    v_mul_f32 v32, v48, v32
    v_mul_f32 v33, v49, v33
    v_mul_f32 v34, v50, v34
    v_mul_f32 v35, v51, v35
    v_mul_f32 v36, v52, v36
    v_mul_f32 v37, v53, v37
    v_mul_f32 v38, v54, v38
    v_mul_f32 v39, v55, v39
    v_cvt_pk_bf16_f32 v76, v32, v33
    v_cvt_pk_bf16_f32 v77, v34, v35
    v_cvt_pk_bf16_f32 v78, v36, v37
    v_cvt_pk_bf16_f32 v79, v38, v39
    s_waitcnt vmcnt(4)
    v_mfma_f32_32x32x16_bf16 v[0:15], v[64:67], v[176:179], 0
    ds_read_b64_tr_b16 v[184:185], v246 offset:2048
    ds_read_b64_tr_b16 v[186:187], v246 offset:2560
    ds_read_b64_tr_b16 v[188:189], v247 offset:2048
    ds_read_b64_tr_b16 v[190:191], v247 offset:2560
    s_mov_b32 m0, s68
    v_mfma_f32_32x32x16_bf16 v[16:31], v[68:71], v[176:179], 0
    buffer_load_dwordx4 v222, s[4:7], s42 offen lds
    buffer_load_dwordx4 v223, s[72:75], s42 offen offset:1024 lds
    v_permlane32_swap_b32 v242, v243
    v_permlane32_swap_b32 v240, v241
    s_add_u32 s38, s38, 1
    v_mfma_f32_32x32x16_bf16 v[32:47], v[64:67], v[180:183], 0
    v_permlane32_swap_b32 v236, v237
    v_permlane32_swap_b32 v244, v245
    v_add_f32 v242, v242, v243
    v_add_f32 v240, -v240, -v241
    v_add_f32 v236, v236, v237
    v_mfma_f32_32x32x16_bf16 v[48:63], v[68:71], v[180:183], 0
    v_add_f32 v244, v244, v245
    s_set_gpr_idx_on s32, gpr_idx(DST)
    s_nop 0
    v_cvt_pk_bf16_f32 v195, v242, v236
    v_cvt_pk_bf16_f32 v196, v244, v240
    v_cvt_pk_bf16_f32 v197, v238, v238
    s_set_gpr_idx_off
    s_waitcnt vmcnt(4) lgkmcnt(0)
    v_mfma_f32_32x32x16_bf16 v[0:15], v[72:75], v[184:187], v[0:15]
    ds_read_b64_tr_b16 v[176:177], v246 offset:4096
    ds_read_b64_tr_b16 v[178:179], v246 offset:4608
    ds_read_b64_tr_b16 v[180:181], v247 offset:4096
    ds_read_b64_tr_b16 v[182:183], v247 offset:4608
    v_mov_b32 v254, s52
    v_mov_b32 v255, s38
    s_mov_b32 m0, s69
    v_mfma_f32_32x32x16_bf16 v[16:31], v[76:79], v[184:187], v[16:31]
    buffer_load_dwordx4 v224, s[4:7], s42 offen lds
    buffer_load_dwordx4 v225, s[72:75], s42 offen offset:1024 lds
    s_lshl_b32 s58, s38, 3
    s_add_u32 s58, s58, s20
    s_mov_b64 exec, 1
    ds_write_b32 v254, v255
    s_mov_b64 exec, -1
    s_cmp_lt_u32 s58, s22
    s_cbranch_scc0 K2_dyn_28
K2_back_29:
    v_readlane_b32 s3, v253, s58
    s_lshl_b32 s44, s34, 7
    s_lshl_b32 s60, s58, 5
    s_and_b32 s48, s3, 0x3ffff
    s_bfe_u32 s33, s3, 0x30012
    s_sub_u32 s60, s60, s48
    s_and_b32 s60, s60, 0xff
    s_add_u32 s60, s60, s48
    s_mul_i32 s35, s38, 6
    s_cmp_eq_u32 s34, 0
    s_cselect_b32 s35, s35, s60
    s_mov_b32 s45, s44
    s_add_u32 s47, s44, 256
    s_add_u32 s49, s48, 32
    s_add_u32 s60, s48, 64
    s_cmp_eq_u32 s33, 3
    s_cselect_b32 s46, s44, s47
    s_cselect_b32 s50, s60, s48
    s_cselect_b32 s51, s48, s49
    s_sub_u32 s60, s33, 2
    s_cmp_lt_u32 s60, 2
    s_cbranch_scc0 K2_rare_34
K2_back_35:
    v_mfma_f32_32x32x16_bf16 v[32:47], v[72:75], v[188:191], v[32:47]
    v_add_u32 v233, s48, v230
    ds_read_b32 v232, v233
    ds_read_b32 v233, v233 offset:1024
    v_mul_f32 v234, v0, v96
    v_mul_f32 v236, v8, v128
    v_fmac_f32 v234, v1, v97
    v_fmac_f32 v236, v9, v129
    v_mfma_f32_32x32x16_bf16 v[48:63], v[76:79], v[188:191], v[48:63]
    s_setprio 0
    v_fmac_f32 v234, v2, v98
    v_fmac_f32 v236, v10, v130
    v_fmac_f32 v234, v3, v99
    v_fmac_f32 v236, v11, v131
    v_fmac_f32 v234, v4, v100
    v_fmac_f32 v236, v12, v132
    v_fmac_f32 v234, v5, v101
    v_fmac_f32 v236, v13, v133
    v_fmac_f32 v234, v6, v102
    v_fmac_f32 v236, v14, v134
    v_fmac_f32 v234, v7, v103
    v_fmac_f32 v236, v15, v135
    v_mul_f32 v238, v16, v128
    v_mul_f32 v240, v24, v128
    v_fmac_f32 v238, v17, v129
    v_fmac_f32 v240, v25, v129
    v_fmac_f32 v238, v18, v130
    v_fmac_f32 v240, v26, v130
    v_fmac_f32 v238, v19, v131
    v_fmac_f32 v240, v27, v131
    v_fmac_f32 v238, v20, v132
    v_fmac_f32 v240, v28, v132
    v_fmac_f32 v238, v21, v133
    v_fmac_f32 v240, v29, v133
    v_fmac_f32 v238, v22, v134
    v_fmac_f32 v240, v30, v134
    v_fmac_f32 v238, v23, v135
    v_fmac_f32 v240, v31, v135
    v_mul_f32 v235, v32, v104
    v_mul_f32 v237, v40, v136
    v_fmac_f32 v235, v33, v105
    v_fmac_f32 v237, v41, v137
    v_fmac_f32 v235, v34, v106
    v_fmac_f32 v237, v42, v138
    v_fmac_f32 v235, v35, v107
    v_fmac_f32 v237, v43, v139
    v_fmac_f32 v235, v36, v108
    v_fmac_f32 v237, v44, v140
    v_fmac_f32 v235, v37, v109
    v_fmac_f32 v237, v45, v141
    v_fmac_f32 v235, v38, v110
    v_fmac_f32 v237, v46, v142
    v_fmac_f32 v235, v39, v111
    v_fmac_f32 v237, v47, v143
    v_mul_f32 v239, v48, v136
    v_mul_f32 v241, v56, v136
    v_fmac_f32 v239, v49, v137
    v_fmac_f32 v241, v57, v137
    s_setprio 1
    s_waitcnt vmcnt(4) lgkmcnt(3)
    v_mfma_f32_32x32x16_bf16 v[0:15], v[64:67], v[176:179], 0
    ds_read_b64_tr_b16 v[184:185], v246 offset:6144
    ds_read_b64_tr_b16 v[186:187], v246 offset:6656
    ds_read_b64_tr_b16 v[188:189], v247 offset:6144
    ds_read_b64_tr_b16 v[190:191], v247 offset:6656
    v_fmac_f32 v239, v50, v138
    v_fmac_f32 v241, v58, v138
    s_mov_b32 m0, s70
    v_mfma_f32_32x32x16_bf16 v[16:31], v[68:71], v[176:179], 0
    buffer_load_dwordx4 v222, s[4:7], s43 offen lds
    buffer_load_dwordx4 v223, s[72:75], s43 offen offset:1024 lds
    v_fmac_f32 v239, v51, v139
    v_fmac_f32 v241, v59, v139
    v_fmac_f32 v239, v52, v140
    v_fmac_f32 v241, v60, v140
    v_fmac_f32 v239, v53, v141
    v_mfma_f32_32x32x16_bf16 v[32:47], v[64:67], v[180:183], 0
    v_add_u32 v222, s48, v251
    ds_read_b32 v222, v222
    v_fmac_f32 v241, v61, v141
    v_fmac_f32 v239, v54, v142
    v_fmac_f32 v241, v62, v142
    v_fmac_f32 v239, v55, v143
    v_fmac_f32 v241, v63, v143
    v_mfma_f32_32x32x16_bf16 v[48:63], v[68:71], v[180:183], 0
    v_permlane32_swap_b32 v234, v235
    v_permlane32_swap_b32 v236, v237
    v_permlane32_swap_b32 v238, v239
    s_waitcnt lgkmcnt(5)
    v_or_b32 v232, v232, v231
    v_or_b32 v233, v233, v231
    s_cmp_lg_u32 s34, 0
    s_cbranch_scc1 K2_dum_37
    s_add_u32 m0, s48, 864
    s_add_u32 s65, s48, 1888
    buffer_load_dwordx4 v232, s[16:19], 0 offen  lds
    s_mov_b32 m0, s65
    s_mov_b32 exec_hi, 0
    buffer_load_dwordx4 v233, s[16:19], 0 offen  lds
    s_cmp_eq_u32 s33, 4
    s_cbranch_scc1 K2_a4_38
K2_b4_40:
    s_mov_b32 exec_hi, -1
K2_back_39:
    s_waitcnt vmcnt(6) lgkmcnt(1)
    v_mfma_f32_32x32x16_bf16 v[0:15], v[72:75], v[184:187], v[0:15]
    ds_read_b64_tr_b16 v[176:177], v246 offset:0
    ds_read_b64_tr_b16 v[178:179], v246 offset:512
    ds_read_b64_tr_b16 v[180:181], v247 offset:0
    ds_read_b64_tr_b16 v[182:183], v247 offset:512
    v_permlane32_swap_b32 v240, v241
    s_mov_b32 m0, s71
    v_mfma_f32_32x32x16_bf16 v[16:31], v[76:79], v[184:187], v[16:31]
    buffer_load_dwordx4 v224, s[4:7], s43 offen lds
    buffer_load_dwordx4 v225, s[72:75], s43 offen offset:1024 lds
    s_waitcnt lgkmcnt(4)
    v_mad_u32_u16 v223, v222, s39, v248 op_sel:[1,0,0,0]
    v_mad_u32_u16 v222, v222, s39, v248
    v_add_f32 v234, v234, v235
    v_add_f32 v236, v236, v237
    v_add_f32 v238, v238, v239
    v_add_f32 v240, v240, v241
    s_set_gpr_idx_on s31, gpr_idx(DST)
    s_nop 0
    v_cvt_pk_bf16_f32 v192, v234, v236
    v_cvt_pk_bf16_f32 v193, v238, v240
    s_set_gpr_idx_off
    v_mfma_f32_32x32x16_bf16 v[32:47], v[72:75], v[188:191], v[32:47]
    v_add_u32 v224, s49, v251
    ds_read_b32 v224, v224
    v_mul_f32 v234, v0, v144
    v_mul_f32 v236, v8, v112
    v_fmac_f32 v234, v1, v145
    v_fmac_f32 v236, v9, v113
    v_fmac_f32 v234, v2, v146
    v_mfma_f32_32x32x16_bf16 v[48:63], v[76:79], v[188:191], v[48:63]
    s_setprio 0
    v_fmac_f32 v236, v10, v114
    v_fmac_f32 v234, v3, v147
    v_fmac_f32 v236, v11, v115
    v_fmac_f32 v234, v4, v148
    v_fmac_f32 v236, v12, v116
    v_fmac_f32 v234, v5, v149
    v_fmac_f32 v236, v13, v117
    v_fmac_f32 v234, v6, v150
    v_fmac_f32 v236, v14, v118
    v_fmac_f32 v234, v7, v151
    v_fmac_f32 v236, v15, v119
    v_mul_f32 v238, v16, v160
    v_mul_f32 v240, v24, v160
    v_fmac_f32 v238, v17, v161
    v_fmac_f32 v240, v25, v161
    v_fmac_f32 v238, v18, v162
    v_fmac_f32 v240, v26, v162
    v_fmac_f32 v238, v19, v163
    v_fmac_f32 v240, v27, v163
    v_fmac_f32 v238, v20, v164
    v_fmac_f32 v240, v28, v164
    v_fmac_f32 v238, v21, v165
    v_fmac_f32 v240, v29, v165
    v_fmac_f32 v238, v22, v166
    v_fmac_f32 v240, v30, v166
    v_fmac_f32 v238, v23, v167
    v_fmac_f32 v240, v31, v167
    v_mul_f32 v235, v32, v152
    v_mul_f32 v237, v40, v120
    v_fmac_f32 v235, v33, v153
    v_fmac_f32 v237, v41, v121
    v_fmac_f32 v235, v34, v154
    v_fmac_f32 v237, v42, v122
    v_fmac_f32 v235, v35, v155
    v_fmac_f32 v237, v43, v123
    v_fmac_f32 v235, v36, v156
    v_fmac_f32 v237, v44, v124
    v_fmac_f32 v235, v37, v157
    v_fmac_f32 v237, v45, v125
    v_fmac_f32 v235, v38, v158
    v_fmac_f32 v237, v46, v126
    v_fmac_f32 v235, v39, v159
    v_fmac_f32 v237, v47, v127
    v_mul_f32 v239, v48, v168
    v_mul_f32 v241, v56, v168
    v_fmac_f32 v239, v49, v169
    v_fmac_f32 v241, v57, v169
    v_fmac_f32 v239, v50, v170
    v_fmac_f32 v241, v58, v170
    v_fmac_f32 v239, v51, v171
    s_setprio 1
    s_waitcnt vmcnt(6) lgkmcnt(1)
    v_mfma_f32_32x32x16_bf16 v[0:15], v[64:67], v[176:179], 0
    ds_read_b64_tr_b16 v[184:185], v246 offset:2048
    ds_read_b64_tr_b16 v[186:187], v246 offset:2560
    ds_read_b64_tr_b16 v[188:189], v247 offset:2048
    ds_read_b64_tr_b16 v[190:191], v247 offset:2560
    v_fmac_f32 v241, v59, v171
    v_fmac_f32 v239, v52, v172
    s_mov_b32 m0, s68
    v_mfma_f32_32x32x16_bf16 v[16:31], v[68:71], v[176:179], 0
    buffer_load_dwordx4 v222, s[4:7], s44 offen lds
    buffer_load_dwordx4 v223, s[72:75], s44 offen offset:1024 lds
    s_waitcnt lgkmcnt(4)
    v_mad_u32_u16 v225, v224, s39, v248 op_sel:[1,0,0,0]
    v_mad_u32_u16 v224, v224, s39, v248
    v_fmac_f32 v241, v60, v172
    v_fmac_f32 v239, v53, v173
    v_mfma_f32_32x32x16_bf16 v[32:47], v[64:67], v[180:183], 0
    v_add_u32 v226, s50, v251
    ds_read_b32 v226, v226
    v_fmac_f32 v241, v61, v173
    v_fmac_f32 v239, v54, v174
    v_fmac_f32 v241, v62, v174
    v_fmac_f32 v239, v55, v175
    v_fmac_f32 v241, v63, v175
    v_mfma_f32_32x32x16_bf16 v[48:63], v[68:71], v[180:183], 0
    v_permlane32_swap_b32 v234, v235
    v_add_f32 v234, v234, v235
    s_waitcnt vmcnt(6) lgkmcnt(1)
    v_mfma_f32_32x32x16_bf16 v[0:15], v[72:75], v[184:187], v[0:15]
    ds_read_b64_tr_b16 v[176:177], v246 offset:4096
    ds_read_b64_tr_b16 v[178:179], v246 offset:4608
    ds_read_b64_tr_b16 v[180:181], v247 offset:4096
    ds_read_b64_tr_b16 v[182:183], v247 offset:4608
    s_mov_b32 m0, s69
    v_mfma_f32_32x32x16_bf16 v[16:31], v[76:79], v[184:187], v[16:31]
    buffer_load_dwordx4 v224, s[4:7], s45 offen lds
    buffer_load_dwordx4 v225, s[72:75], s45 offen offset:1024 lds
    s_waitcnt lgkmcnt(4)
    v_mad_u32_u16 v227, v226, s39, v248 op_sel:[1,0,0,0]
    v_mad_u32_u16 v226, v226, s39, v248
    v_mfma_f32_32x32x16_bf16 v[32:47], v[72:75], v[188:191], v[32:47]
    v_add_u32 v228, s51, v251
    ds_read_b32 v228, v228
    v_mul_f32 v242, v0, v144
    v_fma_f32 v238, v8, v160, -v238
    v_fmac_f32 v242, v1, v145
    v_fmac_f32 v238, v9, v161
    v_fmac_f32 v242, v2, v146
    v_mfma_f32_32x32x16_bf16 v[48:63], v[76:79], v[188:191], v[48:63]
    s_setprio 0
    v_fmac_f32 v238, v10, v162
    v_fmac_f32 v242, v3, v147
    v_fmac_f32 v238, v11, v163
    v_fmac_f32 v242, v4, v148
    v_fmac_f32 v238, v12, v164
    v_fmac_f32 v242, v5, v149
    v_fmac_f32 v238, v13, v165
    v_fmac_f32 v242, v6, v150
    v_fmac_f32 v238, v14, v166
    v_fmac_f32 v242, v7, v151
    v_fmac_f32 v238, v15, v167
    v_fmac_f32 v236, v16, v112
    v_mul_f32 v244, v24, v160
    v_fmac_f32 v236, v17, v113
    v_fmac_f32 v244, v25, v161
    v_fmac_f32 v236, v18, v114
    v_fmac_f32 v244, v26, v162
    v_fmac_f32 v236, v19, v115
    v_fmac_f32 v244, v27, v163
    v_fmac_f32 v236, v20, v116
    v_fmac_f32 v244, v28, v164
    v_fmac_f32 v236, v21, v117
    v_fmac_f32 v244, v29, v165
    v_fmac_f32 v236, v22, v118
    v_fmac_f32 v244, v30, v166
    v_fmac_f32 v236, v23, v119
    v_fmac_f32 v244, v31, v167
    v_mul_f32 v243, v32, v152
    v_fma_f32 v239, v40, v168, -v239
    v_fmac_f32 v243, v33, v153
    v_fmac_f32 v239, v41, v169
    v_fmac_f32 v243, v34, v154
    v_fmac_f32 v239, v42, v170
    v_fmac_f32 v243, v35, v155
    v_fmac_f32 v239, v43, v171
    v_fmac_f32 v243, v36, v156
    v_fmac_f32 v239, v44, v172
    v_fmac_f32 v243, v37, v157
    v_fmac_f32 v239, v45, v173
    v_fmac_f32 v243, v38, v158
    v_fmac_f32 v239, v46, v174
    v_fmac_f32 v243, v39, v159
    v_fmac_f32 v239, v47, v175
    v_fmac_f32 v237, v48, v120
    v_mul_f32 v245, v56, v168
    v_fmac_f32 v237, v49, v121
    v_fmac_f32 v245, v57, v169
    v_fmac_f32 v237, v50, v122
    s_setprio 1
    s_waitcnt vmcnt(4) lgkmcnt(1)
    v_mfma_f32_32x32x16_bf16 v[0:15], v[64:67], v[176:179], 0
    ds_read_b64_tr_b16 v[184:185], v246 offset:6144
    ds_read_b64_tr_b16 v[186:187], v246 offset:6656
    ds_read_b64_tr_b16 v[188:189], v247 offset:6144
    ds_read_b64_tr_b16 v[190:191], v247 offset:6656
    v_fmac_f32 v245, v58, v170
    v_fmac_f32 v237, v51, v123
    s_mov_b32 m0, s70
    v_mfma_f32_32x32x16_bf16 v[16:31], v[68:71], v[176:179], 0
    buffer_load_dwordx4 v226, s[4:7], s46 offen lds
    buffer_load_dwordx4 v227, s[72:75], s46 offen offset:1024 lds
    s_waitcnt lgkmcnt(4)
    v_mad_u32_u16 v229, v228, s39, v248 op_sel:[1,0,0,0]
    v_mad_u32_u16 v228, v228, s39, v248
    v_fmac_f32 v245, v59, v171
    v_fmac_f32 v237, v52, v124
    v_mfma_f32_32x32x16_bf16 v[32:47], v[64:67], v[180:183], 0
    v_fmac_f32 v245, v60, v172
    v_fmac_f32 v237, v53, v125
    v_fmac_f32 v245, v61, v173
    v_fmac_f32 v237, v54, v126
    v_fmac_f32 v245, v62, v174
    v_fmac_f32 v237, v55, v127
    v_fmac_f32 v245, v63, v175
    v_mfma_f32_32x32x16_bf16 v[48:63], v[68:71], v[180:183], 0
    v_permlane32_swap_b32 v238, v239
    v_permlane32_swap_b32 v242, v243
    v_add_f32 v238, v238, v239
    v_add_f32 v242, v242, v243
    s_waitcnt vmcnt(4) lgkmcnt(0)
    v_mfma_f32_32x32x16_bf16 v[0:15], v[72:75], v[184:187], v[0:15]
    ds_read_b64_tr_b16 v[176:177], v246 offset:0
    ds_read_b64_tr_b16 v[178:179], v246 offset:512
    ds_read_b64_tr_b16 v[180:181], v247 offset:0
    ds_read_b64_tr_b16 v[182:183], v247 offset:512
    s_mov_b32 m0, s71
    v_mfma_f32_32x32x16_bf16 v[16:31], v[76:79], v[184:187], v[16:31]
    buffer_load_dwordx4 v228, s[4:7], s47 offen lds
    buffer_load_dwordx4 v229, s[72:75], s47 offen offset:1024 lds
    s_set_gpr_idx_on s31, gpr_idx(DST)
    s_nop 0
    v_cvt_pk_bf16_f32 v194, v234, v242
    s_set_gpr_idx_off
    v_mfma_f32_32x32x16_bf16 v[32:47], v[72:75], v[188:191], v[32:47]
    v_mul_f32 v242, v0, v144
    v_fma_f32 v240, v8, v160, -v240
    v_fmac_f32 v242, v1, v145
    v_fmac_f32 v240, v9, v161
    v_fmac_f32 v242, v2, v146
    v_fmac_f32 v240, v10, v162
    v_fmac_f32 v242, v3, v147
    v_mfma_f32_32x32x16_bf16 v[48:63], v[76:79], v[188:191], v[48:63]
    s_setprio 0
    v_fmac_f32 v240, v11, v163
    v_fmac_f32 v242, v4, v148
    v_fmac_f32 v240, v12, v164
    v_fmac_f32 v242, v5, v149
    v_fmac_f32 v240, v13, v165
    v_fmac_f32 v242, v6, v150
    v_fmac_f32 v240, v14, v166
    v_fmac_f32 v242, v7, v151
    v_fmac_f32 v240, v15, v167
    s_sub_u32 s58, s48, s29
    v_add_u32 v249, s58, v249
    v_add_u32 v250, s58, v250
    v_fma_f32 v244, v16, v160, -v244
    v_fmac_f32 v236, v24, v112
    v_fmac_f32 v244, v17, v161
    v_fmac_f32 v236, v25, v113
    v_fmac_f32 v244, v18, v162
    v_fmac_f32 v236, v26, v114
    v_fmac_f32 v244, v19, v163
    v_fmac_f32 v236, v27, v115
    v_fmac_f32 v244, v20, v164
    v_fmac_f32 v236, v28, v116
    v_fmac_f32 v244, v21, v165
    v_fmac_f32 v236, v29, v117
    v_fmac_f32 v244, v22, v166
    v_fmac_f32 v236, v30, v118
    v_fmac_f32 v244, v23, v167
    v_fmac_f32 v236, v31, v119
    ds_read_b64_tr_b16 v[0:1], v249 offset:0
    ds_read_b64_tr_b16 v[2:3], v249 offset:128
    ds_read_b128 v[4:7], v250 offset:0
    ds_read_b128 v[8:11], v250 offset:16
    ds_read_b128 v[12:15], v250 offset:384
    ds_read_b128 v[16:19], v250 offset:400
    v_mul_f32 v243, v32, v152
    v_fma_f32 v241, v40, v168, -v241
    v_fmac_f32 v243, v33, v153
    v_fmac_f32 v241, v41, v169
    v_fmac_f32 v243, v34, v154
    v_fmac_f32 v241, v42, v170
    v_fmac_f32 v243, v35, v155
    v_fmac_f32 v241, v43, v171
    v_fmac_f32 v243, v36, v156
    v_fmac_f32 v241, v44, v172
    v_fmac_f32 v243, v37, v157
    v_fmac_f32 v241, v45, v173
    v_fmac_f32 v243, v38, v158
    v_fmac_f32 v241, v46, v174
    v_fmac_f32 v243, v39, v159
    v_fmac_f32 v241, v47, v175
    ds_read_b64_tr_b16 v[20:21], v249 offset:512
    ds_read_b64_tr_b16 v[22:23], v249 offset:640
    ds_read_b128 v[24:27], v250 offset:64
    ds_read_b128 v[28:31], v250 offset:80
    ds_read_b128 v[32:35], v250 offset:448
    ds_read_b128 v[36:39], v250 offset:464
    v_fma_f32 v245, v48, v168, -v245
    v_fmac_f32 v237, v56, v120
    v_fmac_f32 v245, v49, v169
    v_fmac_f32 v237, v57, v121
    v_fmac_f32 v245, v50, v170
    v_fmac_f32 v237, v58, v122
    v_fmac_f32 v245, v51, v171
    v_fmac_f32 v237, v59, v123
    v_fmac_f32 v245, v52, v172
    v_fmac_f32 v237, v60, v124
    v_fmac_f32 v245, v53, v173
    v_fmac_f32 v237, v61, v125
    v_fmac_f32 v245, v54, v174
    v_fmac_f32 v237, v62, v126
    v_fmac_f32 v245, v55, v175
    v_fmac_f32 v237, v63, v127
    s_cmp_lg_u32 s34, 0
    s_cbranch_scc1 K2_SWITCH
    s_mov_b32 s29, s48
    s_mov_b32 s32, s31
    s_mov_b32 s30, s3
    s_mov_b32 s31, s35
    s_cmp_eq_u32 s33, 2
    s_cbranch_scc1 K2_U20
    s_cmp_eq_u32 s33, 3
    s_cbranch_scc1 K2_U30
    s_cmp_eq_u32 s33, 1
    s_cbranch_scc1 K2_U10
    s_branch K2_U40
K2_U30:
    s_setprio 1
    s_waitcnt lgkmcnt(10)
    v_lshlrev_b32 v40, 16, v0
    v_and_b32 v41, 0xffff0000, v0
    v_lshlrev_b32 v42, 16, v1
    v_and_b32 v43, 0xffff0000, v1
    v_lshlrev_b32 v44, 16, v2
    v_and_b32 v45, 0xffff0000, v2
    v_lshlrev_b32 v46, 16, v3
    v_and_b32 v47, 0xffff0000, v3
    s_waitcnt lgkmcnt(8)
    v_mul_f32 v4, v40, v4
    v_mul_f32 v5, v41, v5
    v_mul_f32 v6, v42, v6
    v_mul_f32 v7, v43, v7
    v_mul_f32 v8, v44, v8
    v_mul_f32 v9, v45, v9
    v_mul_f32 v10, v46, v10
    v_mul_f32 v11, v47, v11
    v_cvt_pk_bf16_f32 v64, v4, v5
    v_cvt_pk_bf16_f32 v65, v6, v7
    v_cvt_pk_bf16_f32 v66, v8, v9
    v_cvt_pk_bf16_f32 v67, v10, v11
    s_waitcnt lgkmcnt(6)
    v_mul_f32 v12, v40, v12
    v_mul_f32 v13, v41, v13
    v_mul_f32 v14, v42, v14
    v_mul_f32 v15, v43, v15
    v_mul_f32 v16, v44, v16
    v_mul_f32 v17, v45, v17
    v_mul_f32 v18, v46, v18
    v_mul_f32 v19, v47, v19
    v_cvt_pk_bf16_f32 v68, v12, v13
    v_cvt_pk_bf16_f32 v69, v14, v15
    v_cvt_pk_bf16_f32 v70, v16, v17
    v_cvt_pk_bf16_f32 v71, v18, v19
    ds_read_b64_tr_b16 v[0:1], v249 offset:1024
    ds_read_b64_tr_b16 v[2:3], v249 offset:1152
    ds_read_b128 v[4:7], v250 offset:128
    ds_read_b128 v[8:11], v250 offset:144
    ds_read_b128 v[12:15], v250 offset:512
    ds_read_b128 v[16:19], v250 offset:528
    s_waitcnt lgkmcnt(10)
    v_lshlrev_b32 v48, 16, v20
    v_and_b32 v49, 0xffff0000, v20
    v_lshlrev_b32 v50, 16, v21
    v_and_b32 v51, 0xffff0000, v21
    v_lshlrev_b32 v52, 16, v22
    v_and_b32 v53, 0xffff0000, v22
    v_lshlrev_b32 v54, 16, v23
    v_and_b32 v55, 0xffff0000, v23
    s_waitcnt lgkmcnt(8)
    v_mul_f32 v24, v48, v24
    v_mul_f32 v25, v49, v25
    v_mul_f32 v26, v50, v26
    v_mul_f32 v27, v51, v27
    v_mul_f32 v28, v52, v28
    v_mul_f32 v29, v53, v29
    v_mul_f32 v30, v54, v30
    v_mul_f32 v31, v55, v31
    v_cvt_pk_bf16_f32 v72, v24, v25
    v_cvt_pk_bf16_f32 v73, v26, v27
    v_cvt_pk_bf16_f32 v74, v28, v29
    v_cvt_pk_bf16_f32 v75, v30, v31
    s_waitcnt lgkmcnt(6)
    v_mul_f32 v32, v48, v32
    v_mul_f32 v33, v49, v33
    v_mul_f32 v34, v50, v34
    v_mul_f32 v35, v51, v35
    v_mul_f32 v36, v52, v36
    v_mul_f32 v37, v53, v37
    v_mul_f32 v38, v54, v38
    v_mul_f32 v39, v55, v39
    v_cvt_pk_bf16_f32 v76, v32, v33
    v_cvt_pk_bf16_f32 v77, v34, v35
    v_cvt_pk_bf16_f32 v78, v36, v37
    v_cvt_pk_bf16_f32 v79, v38, v39
    s_waitcnt lgkmcnt(4)
    v_lshlrev_b32 v40, 16, v0
    v_and_b32 v41, 0xffff0000, v0
    v_lshlrev_b32 v42, 16, v1
    v_and_b32 v43, 0xffff0000, v1
    v_lshlrev_b32 v44, 16, v2
    v_and_b32 v45, 0xffff0000, v2
    v_lshlrev_b32 v46, 16, v3
    v_and_b32 v47, 0xffff0000, v3
    s_waitcnt lgkmcnt(2)
    v_mul_f32 v4, v40, v4
    v_mul_f32 v5, v41, v5
    v_mul_f32 v6, v42, v6
    v_mul_f32 v7, v43, v7
    v_mul_f32 v8, v44, v8
    v_mul_f32 v9, v45, v9
    v_mul_f32 v10, v46, v10
    v_mul_f32 v11, v47, v11
    v_cvt_pk_bf16_f32 v80, v4, v5
    v_cvt_pk_bf16_f32 v81, v6, v7
    v_cvt_pk_bf16_f32 v82, v8, v9
    v_cvt_pk_bf16_f32 v83, v10, v11
    s_waitcnt lgkmcnt(0)
    v_mul_f32 v12, v40, v12
    v_mul_f32 v13, v41, v13
    v_mul_f32 v14, v42, v14
    v_mul_f32 v15, v43, v15
    v_mul_f32 v16, v44, v16
    v_mul_f32 v17, v45, v17
    v_mul_f32 v18, v46, v18
    v_mul_f32 v19, v47, v19
    v_cvt_pk_bf16_f32 v84, v12, v13
    v_cvt_pk_bf16_f32 v85, v14, v15
    v_cvt_pk_bf16_f32 v86, v16, v17
    v_cvt_pk_bf16_f32 v87, v18, v19
    s_waitcnt vmcnt(4)
    v_mfma_f32_32x32x16_bf16 v[0:15], v[64:67], v[176:179], 0
    ds_read_b64_tr_b16 v[184:185], v246 offset:2048
    ds_read_b64_tr_b16 v[186:187], v246 offset:2560
    ds_read_b64_tr_b16 v[188:189], v247 offset:2048
    ds_read_b64_tr_b16 v[190:191], v247 offset:2560
    s_mov_b32 m0, s68
    v_mfma_f32_32x32x16_bf16 v[16:31], v[68:71], v[176:179], 0
    buffer_load_dwordx4 v224, s[4:7], s41 offen lds
    buffer_load_dwordx4 v225, s[72:75], s41 offen offset:1024 lds
    v_permlane32_swap_b32 v242, v243
    v_permlane32_swap_b32 v240, v241
    s_add_u32 s38, s38, 1
    v_mfma_f32_32x32x16_bf16 v[32:47], v[64:67], v[180:183], 0
    v_permlane32_swap_b32 v236, v237
    v_permlane32_swap_b32 v244, v245
    v_add_f32 v242, v242, v243
    v_add_f32 v240, -v240, -v241
    v_add_f32 v236, v236, v237
    v_mfma_f32_32x32x16_bf16 v[48:63], v[68:71], v[180:183], 0
    v_add_f32 v244, v244, v245
    s_set_gpr_idx_on s32, gpr_idx(DST)
    s_nop 0
    v_cvt_pk_bf16_f32 v195, v242, v236
    v_cvt_pk_bf16_f32 v196, v244, v240
    v_cvt_pk_bf16_f32 v197, v238, v238
    s_set_gpr_idx_off
    s_waitcnt vmcnt(4) lgkmcnt(0)
    v_mfma_f32_32x32x16_bf16 v[0:15], v[72:75], v[184:187], v[0:15]
    ds_read_b64_tr_b16 v[176:177], v246 offset:4096
    ds_read_b64_tr_b16 v[178:179], v246 offset:4608
    ds_read_b64_tr_b16 v[180:181], v247 offset:4096
    ds_read_b64_tr_b16 v[182:183], v247 offset:4608
    v_mov_b32 v254, s52
    v_mov_b32 v255, s38
    s_mov_b32 m0, s69
    v_mfma_f32_32x32x16_bf16 v[16:31], v[76:79], v[184:187], v[16:31]
    buffer_load_dwordx4 v226, s[4:7], s41 offen lds
    buffer_load_dwordx4 v227, s[72:75], s41 offen offset:1024 lds
    s_lshl_b32 s58, s38, 3
    s_add_u32 s58, s58, s20
    s_mov_b64 exec, 1
    ds_write_b32 v254, v255
    s_mov_b64 exec, -1
    s_cmp_lt_u32 s58, s22
    s_cbranch_scc0 K2_dyn_41
K2_back_42:
    v_readlane_b32 s3, v253, s58
    s_lshl_b32 s44, s34, 7
    s_lshl_b32 s60, s58, 5
    s_and_b32 s48, s3, 0x3ffff
    s_bfe_u32 s33, s3, 0x30012
    s_sub_u32 s60, s60, s48
    s_and_b32 s60, s60, 0xff
    s_add_u32 s60, s60, s48
    s_mul_i32 s35, s38, 6
    s_cmp_eq_u32 s34, 0
    s_cselect_b32 s35, s35, s60
    s_mov_b32 s45, s44
    s_add_u32 s47, s44, 256
    s_add_u32 s49, s48, 32
    s_add_u32 s60, s48, 64
    s_cmp_eq_u32 s33, 3
    s_cselect_b32 s46, s44, s47
    s_cselect_b32 s50, s60, s48
    s_cselect_b32 s51, s48, s49
    s_sub_u32 s60, s33, 2
    s_cmp_lt_u32 s60, 2
    s_cbranch_scc0 K2_rare_47
K2_back_48:
    v_mfma_f32_32x32x16_bf16 v[32:47], v[72:75], v[188:191], v[32:47]
    v_add_u32 v233, s48, v230
    ds_read_b32 v232, v233
    ds_read_b32 v233, v233 offset:1024
    v_mfma_f32_32x32x16_bf16 v[48:63], v[76:79], v[188:191], v[48:63]
    s_waitcnt vmcnt(4) lgkmcnt(3)
    v_mfma_f32_32x32x16_bf16 v[0:15], v[80:83], v[176:179], v[0:15]
    ds_read_b64_tr_b16 v[184:185], v246 offset:6144
    ds_read_b64_tr_b16 v[186:187], v246 offset:6656
    ds_read_b64_tr_b16 v[188:189], v247 offset:6144
    ds_read_b64_tr_b16 v[190:191], v247 offset:6656
    s_mov_b32 m0, s70
    v_mfma_f32_32x32x16_bf16 v[16:31], v[84:87], v[176:179], v[16:31]
    buffer_load_dwordx4 v222, s[4:7], s42 offen lds
    buffer_load_dwordx4 v223, s[72:75], s42 offen offset:1024 lds
    v_mfma_f32_32x32x16_bf16 v[32:47], v[80:83], v[180:183], v[32:47]
    s_nop 2
    v_mul_f32 v234, v0, v96
    v_mul_f32 v236, v8, v128
    v_fmac_f32 v234, v1, v97
    v_fmac_f32 v236, v9, v129
    v_fmac_f32 v234, v2, v98
    v_fmac_f32 v236, v10, v130
    v_fmac_f32 v234, v3, v99
    v_mfma_f32_32x32x16_bf16 v[48:63], v[84:87], v[180:183], v[48:63]
    s_setprio 0
    s_waitcnt lgkmcnt(4)
    v_or_b32 v232, v232, v231
    v_or_b32 v233, v233, v231
    s_cmp_lg_u32 s34, 0
    s_cbranch_scc1 K2_dum_50
    s_add_u32 m0, s48, 864
    s_add_u32 s65, s48, 1888
    buffer_load_dwordx4 v232, s[16:19], 0 offen  lds
    s_mov_b32 m0, s65
    s_mov_b32 exec_hi, 0
    buffer_load_dwordx4 v233, s[16:19], 0 offen  lds
    s_cmp_eq_u32 s33, 4
    s_cbranch_scc1 K2_a4_51
K2_b4_53:
    s_mov_b32 exec_hi, -1
K2_back_52:
    v_fmac_f32 v236, v11, v131
    v_fmac_f32 v234, v4, v100
    v_fmac_f32 v236, v12, v132
    v_fmac_f32 v234, v5, v101
    v_fmac_f32 v236, v13, v133
    v_fmac_f32 v234, v6, v102
    v_fmac_f32 v236, v14, v134
    v_fmac_f32 v234, v7, v103
    v_fmac_f32 v236, v15, v135
    v_mul_f32 v238, v16, v128
    v_mul_f32 v240, v24, v128
    v_fmac_f32 v238, v17, v129
    v_fmac_f32 v240, v25, v129
    v_fmac_f32 v238, v18, v130
    v_fmac_f32 v240, v26, v130
    v_fmac_f32 v238, v19, v131
    v_fmac_f32 v240, v27, v131
    v_fmac_f32 v238, v20, v132
    v_fmac_f32 v240, v28, v132
    v_fmac_f32 v238, v21, v133
    v_fmac_f32 v240, v29, v133
    v_fmac_f32 v238, v22, v134
    v_fmac_f32 v240, v30, v134
    v_fmac_f32 v238, v23, v135
    v_fmac_f32 v240, v31, v135
    v_mul_f32 v235, v32, v104
    v_mul_f32 v237, v40, v136
    v_fmac_f32 v235, v33, v105
    v_fmac_f32 v237, v41, v137
    v_fmac_f32 v235, v34, v106
    v_fmac_f32 v237, v42, v138
    v_fmac_f32 v235, v35, v107
    v_fmac_f32 v237, v43, v139
    v_fmac_f32 v235, v36, v108
    v_fmac_f32 v237, v44, v140
    v_fmac_f32 v235, v37, v109
    v_fmac_f32 v237, v45, v141
    v_fmac_f32 v235, v38, v110
    v_fmac_f32 v237, v46, v142
    v_fmac_f32 v235, v39, v111
    v_fmac_f32 v237, v47, v143
    v_mul_f32 v239, v48, v136
    v_mul_f32 v241, v56, v136
    s_setprio 1
    s_waitcnt vmcnt(6) lgkmcnt(0)
    v_mfma_f32_32x32x16_bf16 v[0:15], v[64:67], v[184:187], 0
    ds_read_b64_tr_b16 v[176:177], v246 offset:0
    ds_read_b64_tr_b16 v[178:179], v246 offset:512
    ds_read_b64_tr_b16 v[180:181], v247 offset:0
    ds_read_b64_tr_b16 v[182:183], v247 offset:512
    v_fmac_f32 v239, v49, v137
    v_fmac_f32 v241, v57, v137
    s_mov_b32 m0, s71
    v_mfma_f32_32x32x16_bf16 v[16:31], v[68:71], v[184:187], 0
    buffer_load_dwordx4 v224, s[4:7], s42 offen lds
    buffer_load_dwordx4 v225, s[72:75], s42 offen offset:1024 lds
    v_fmac_f32 v239, v50, v138
    v_fmac_f32 v241, v58, v138
    v_fmac_f32 v239, v51, v139
    v_fmac_f32 v241, v59, v139
    v_fmac_f32 v239, v52, v140
    v_mfma_f32_32x32x16_bf16 v[32:47], v[64:67], v[188:191], 0
    v_fmac_f32 v241, v60, v140
    v_fmac_f32 v239, v53, v141
    v_fmac_f32 v241, v61, v141
    v_fmac_f32 v239, v54, v142
    v_fmac_f32 v241, v62, v142
    v_fmac_f32 v239, v55, v143
    v_fmac_f32 v241, v63, v143
    v_mfma_f32_32x32x16_bf16 v[48:63], v[68:71], v[188:191], 0
    v_permlane32_swap_b32 v234, v235
    v_permlane32_swap_b32 v236, v237
    v_permlane32_swap_b32 v238, v239
    s_waitcnt vmcnt(6) lgkmcnt(0)
    v_mfma_f32_32x32x16_bf16 v[0:15], v[72:75], v[176:179], v[0:15]
    ds_read_b64_tr_b16 v[184:185], v246 offset:2048
    ds_read_b64_tr_b16 v[186:187], v246 offset:2560
    ds_read_b64_tr_b16 v[188:189], v247 offset:2048
    ds_read_b64_tr_b16 v[190:191], v247 offset:2560
    v_permlane32_swap_b32 v240, v241
    s_mov_b32 m0, s68
    v_mfma_f32_32x32x16_bf16 v[16:31], v[76:79], v[176:179], v[16:31]
    buffer_load_dwordx4 v226, s[4:7], s42 offen lds
    buffer_load_dwordx4 v227, s[72:75], s42 offen offset:1024 lds
    v_add_f32 v234, v234, v235
    v_add_f32 v236, v236, v237
    v_add_f32 v238, v238, v239
    v_add_f32 v240, v240, v241
    v_mfma_f32_32x32x16_bf16 v[32:47], v[72:75], v[180:183], v[32:47]
    s_set_gpr_idx_on s31, gpr_idx(DST)
    s_nop 0
    v_cvt_pk_bf16_f32 v192, v234, v236
    v_cvt_pk_bf16_f32 v193, v238, v240
    s_set_gpr_idx_off
    v_mfma_f32_32x32x16_bf16 v[48:63], v[76:79], v[180:183], v[48:63]
    s_waitcnt vmcnt(6) lgkmcnt(0)
    v_mfma_f32_32x32x16_bf16 v[0:15], v[80:83], v[184:187], v[0:15]
    ds_read_b64_tr_b16 v[176:177], v246 offset:4096
    ds_read_b64_tr_b16 v[178:179], v246 offset:4608
    ds_read_b64_tr_b16 v[180:181], v247 offset:4096
    ds_read_b64_tr_b16 v[182:183], v247 offset:4608
    s_mov_b32 m0, s69
    v_mfma_f32_32x32x16_bf16 v[16:31], v[84:87], v[184:187], v[16:31]
    buffer_load_dwordx4 v222, s[4:7], s43 offen lds
    buffer_load_dwordx4 v223, s[72:75], s43 offen offset:1024 lds
    v_mfma_f32_32x32x16_bf16 v[32:47], v[80:83], v[188:191], v[32:47]
    s_nop 2
    v_mul_f32 v234, v0, v144
    v_mul_f32 v236, v8, v112
    v_fmac_f32 v234, v1, v145
    v_fmac_f32 v236, v9, v113
    v_fmac_f32 v234, v2, v146
    v_fmac_f32 v236, v10, v114
    v_fmac_f32 v234, v3, v147
    v_mfma_f32_32x32x16_bf16 v[48:63], v[84:87], v[188:191], v[48:63]
    s_setprio 0
    v_fmac_f32 v236, v11, v115
    v_fmac_f32 v234, v4, v148
    v_fmac_f32 v236, v12, v116
    v_fmac_f32 v234, v5, v149
    v_fmac_f32 v236, v13, v117
    v_fmac_f32 v234, v6, v150
    v_fmac_f32 v236, v14, v118
    v_fmac_f32 v234, v7, v151
    v_fmac_f32 v236, v15, v119
    v_mul_f32 v238, v16, v160
    v_mul_f32 v240, v24, v160
    v_fmac_f32 v238, v17, v161
    v_fmac_f32 v240, v25, v161
    v_fmac_f32 v238, v18, v162
    v_fmac_f32 v240, v26, v162
    v_fmac_f32 v238, v19, v163
    v_fmac_f32 v240, v27, v163
    v_fmac_f32 v238, v20, v164
    v_fmac_f32 v240, v28, v164
    v_fmac_f32 v238, v21, v165
    v_fmac_f32 v240, v29, v165
    v_fmac_f32 v238, v22, v166
    v_fmac_f32 v240, v30, v166
    v_fmac_f32 v238, v23, v167
    v_fmac_f32 v240, v31, v167
    v_mul_f32 v235, v32, v152
    v_mul_f32 v237, v40, v120
    v_fmac_f32 v235, v33, v153
    v_fmac_f32 v237, v41, v121
    v_fmac_f32 v235, v34, v154
    v_fmac_f32 v237, v42, v122
    v_fmac_f32 v235, v35, v155
    v_fmac_f32 v237, v43, v123
    v_fmac_f32 v235, v36, v156
    v_fmac_f32 v237, v44, v124
    v_fmac_f32 v235, v37, v157
    v_fmac_f32 v237, v45, v125
    v_fmac_f32 v235, v38, v158
    v_fmac_f32 v237, v46, v126
    v_fmac_f32 v235, v39, v159
    v_fmac_f32 v237, v47, v127
    v_mul_f32 v239, v48, v168
    v_mul_f32 v241, v56, v168
    v_fmac_f32 v239, v49, v169
    v_fmac_f32 v241, v57, v169
    s_setprio 1
    s_waitcnt vmcnt(4) lgkmcnt(0)
    v_mfma_f32_32x32x16_bf16 v[0:15], v[64:67], v[176:179], 0
    ds_read_b64_tr_b16 v[184:185], v246 offset:6144
    ds_read_b64_tr_b16 v[186:187], v246 offset:6656
    ds_read_b64_tr_b16 v[188:189], v247 offset:6144
    ds_read_b64_tr_b16 v[190:191], v247 offset:6656
    v_fmac_f32 v239, v50, v170
    v_fmac_f32 v241, v58, v170
    s_mov_b32 m0, s70
    v_mfma_f32_32x32x16_bf16 v[16:31], v[68:71], v[176:179], 0
    buffer_load_dwordx4 v224, s[4:7], s43 offen lds
    buffer_load_dwordx4 v225, s[72:75], s43 offen offset:1024 lds
    v_fmac_f32 v239, v51, v171
    v_fmac_f32 v241, v59, v171
    v_fmac_f32 v239, v52, v172
    v_fmac_f32 v241, v60, v172
    v_fmac_f32 v239, v53, v173
    v_mfma_f32_32x32x16_bf16 v[32:47], v[64:67], v[180:183], 0
    v_add_u32 v222, s48, v251
    ds_read_b32 v222, v222
    v_fmac_f32 v241, v61, v173
    v_fmac_f32 v239, v54, v174
    v_fmac_f32 v241, v62, v174
    v_fmac_f32 v239, v55, v175
    v_fmac_f32 v241, v63, v175
    v_mfma_f32_32x32x16_bf16 v[48:63], v[68:71], v[180:183], 0
    v_permlane32_swap_b32 v234, v235
    v_add_f32 v234, v234, v235
    s_waitcnt vmcnt(4) lgkmcnt(1)
    v_mfma_f32_32x32x16_bf16 v[0:15], v[72:75], v[184:187], v[0:15]
    ds_read_b64_tr_b16 v[176:177], v246 offset:0
    ds_read_b64_tr_b16 v[178:179], v246 offset:512
    ds_read_b64_tr_b16 v[180:181], v247 offset:0
    ds_read_b64_tr_b16 v[182:183], v247 offset:512
    s_mov_b32 m0, s71
    v_mfma_f32_32x32x16_bf16 v[16:31], v[76:79], v[184:187], v[16:31]
    buffer_load_dwordx4 v226, s[4:7], s43 offen lds
    buffer_load_dwordx4 v227, s[72:75], s43 offen offset:1024 lds
    s_waitcnt lgkmcnt(4)
    v_mad_u32_u16 v223, v222, s39, v248 op_sel:[1,0,0,0]
    v_mad_u32_u16 v222, v222, s39, v248
    v_mfma_f32_32x32x16_bf16 v[32:47], v[72:75], v[188:191], v[32:47]
    v_add_u32 v224, s49, v251
    ds_read_b32 v224, v224
    v_mfma_f32_32x32x16_bf16 v[48:63], v[76:79], v[188:191], v[48:63]
    s_waitcnt vmcnt(4) lgkmcnt(1)
    v_mfma_f32_32x32x16_bf16 v[0:15], v[80:83], v[176:179], v[0:15]
    ds_read_b64_tr_b16 v[184:185], v246 offset:2048
    ds_read_b64_tr_b16 v[186:187], v246 offset:2560
    ds_read_b64_tr_b16 v[188:189], v247 offset:2048
    ds_read_b64_tr_b16 v[190:191], v247 offset:2560
    s_mov_b32 m0, s68
    v_mfma_f32_32x32x16_bf16 v[16:31], v[84:87], v[176:179], v[16:31]
    buffer_load_dwordx4 v222, s[4:7], s44 offen lds
    buffer_load_dwordx4 v223, s[72:75], s44 offen offset:1024 lds
    s_waitcnt lgkmcnt(4)
    v_mad_u32_u16 v225, v224, s39, v248 op_sel:[1,0,0,0]
    v_mad_u32_u16 v224, v224, s39, v248
    v_mfma_f32_32x32x16_bf16 v[32:47], v[80:83], v[180:183], v[32:47]
    v_add_u32 v226, s50, v251
    ds_read_b32 v226, v226
    v_mul_f32 v242, v0, v144
    v_fma_f32 v238, v8, v160, -v238
    v_fmac_f32 v242, v1, v145
    v_fmac_f32 v238, v9, v161
    v_fmac_f32 v242, v2, v146
    v_mfma_f32_32x32x16_bf16 v[48:63], v[84:87], v[180:183], v[48:63]
    s_setprio 0
    v_fmac_f32 v238, v10, v162
    v_fmac_f32 v242, v3, v147
    v_fmac_f32 v238, v11, v163
    v_fmac_f32 v242, v4, v148
    v_fmac_f32 v238, v12, v164
    v_fmac_f32 v242, v5, v149
    v_fmac_f32 v238, v13, v165
    v_fmac_f32 v242, v6, v150
    v_fmac_f32 v238, v14, v166
    v_fmac_f32 v242, v7, v151
    v_fmac_f32 v238, v15, v167
    v_fmac_f32 v236, v16, v112
    v_mul_f32 v244, v24, v160
    v_fmac_f32 v236, v17, v113
    v_fmac_f32 v244, v25, v161
    v_fmac_f32 v236, v18, v114
    v_fmac_f32 v244, v26, v162
    v_fmac_f32 v236, v19, v115
    v_fmac_f32 v244, v27, v163
    v_fmac_f32 v236, v20, v116
    v_fmac_f32 v244, v28, v164
    v_fmac_f32 v236, v21, v117
    v_fmac_f32 v244, v29, v165
    v_fmac_f32 v236, v22, v118
    v_fmac_f32 v244, v30, v166
    v_fmac_f32 v236, v23, v119
    v_fmac_f32 v244, v31, v167
    v_mul_f32 v243, v32, v152
    v_fma_f32 v239, v40, v168, -v239
    v_fmac_f32 v243, v33, v153
    v_fmac_f32 v239, v41, v169
    v_fmac_f32 v243, v34, v154
    v_fmac_f32 v239, v42, v170
    v_fmac_f32 v243, v35, v155
    v_fmac_f32 v239, v43, v171
    v_fmac_f32 v243, v36, v156
    v_fmac_f32 v239, v44, v172
    v_fmac_f32 v243, v37, v157
    v_fmac_f32 v239, v45, v173
    v_fmac_f32 v243, v38, v158
    v_fmac_f32 v239, v46, v174
    v_fmac_f32 v243, v39, v159
    v_fmac_f32 v239, v47, v175
    v_fmac_f32 v237, v48, v120
    v_mul_f32 v245, v56, v168
    v_fmac_f32 v237, v49, v121
    v_fmac_f32 v245, v57, v169
    v_fmac_f32 v237, v50, v122
    v_fmac_f32 v245, v58, v170
    v_fmac_f32 v237, v51, v123
    s_setprio 1
    s_waitcnt vmcnt(4) lgkmcnt(1)
    v_mfma_f32_32x32x16_bf16 v[0:15], v[64:67], v[184:187], 0
    ds_read_b64_tr_b16 v[176:177], v246 offset:4096
    ds_read_b64_tr_b16 v[178:179], v246 offset:4608
    ds_read_b64_tr_b16 v[180:181], v247 offset:4096
    ds_read_b64_tr_b16 v[182:183], v247 offset:4608
    v_fmac_f32 v245, v59, v171
    v_fmac_f32 v237, v52, v124
    s_mov_b32 m0, s69
    v_mfma_f32_32x32x16_bf16 v[16:31], v[68:71], v[184:187], 0
    buffer_load_dwordx4 v224, s[4:7], s45 offen lds
    buffer_load_dwordx4 v225, s[72:75], s45 offen offset:1024 lds
    s_waitcnt lgkmcnt(4)
    v_mad_u32_u16 v227, v226, s39, v248 op_sel:[1,0,0,0]
    v_mad_u32_u16 v226, v226, s39, v248
    v_fmac_f32 v245, v60, v172
    v_fmac_f32 v237, v53, v125
    v_mfma_f32_32x32x16_bf16 v[32:47], v[64:67], v[188:191], 0
    v_add_u32 v228, s51, v251
    ds_read_b32 v228, v228
    v_fmac_f32 v245, v61, v173
    v_fmac_f32 v237, v54, v126
    v_fmac_f32 v245, v62, v174
    v_fmac_f32 v237, v55, v127
    v_fmac_f32 v245, v63, v175
    v_mfma_f32_32x32x16_bf16 v[48:63], v[68:71], v[188:191], 0
    v_permlane32_swap_b32 v238, v239
    v_permlane32_swap_b32 v242, v243
    v_add_f32 v238, v238, v239
    v_add_f32 v242, v242, v243
    s_waitcnt vmcnt(4) lgkmcnt(1)
    v_mfma_f32_32x32x16_bf16 v[0:15], v[72:75], v[176:179], v[0:15]
    ds_read_b64_tr_b16 v[184:185], v246 offset:6144
    ds_read_b64_tr_b16 v[186:187], v246 offset:6656
    ds_read_b64_tr_b16 v[188:189], v247 offset:6144
    ds_read_b64_tr_b16 v[190:191], v247 offset:6656
    s_mov_b32 m0, s70
    v_mfma_f32_32x32x16_bf16 v[16:31], v[76:79], v[176:179], v[16:31]
    buffer_load_dwordx4 v226, s[4:7], s46 offen lds
    buffer_load_dwordx4 v227, s[72:75], s46 offen offset:1024 lds
    s_waitcnt lgkmcnt(4)
    v_mad_u32_u16 v229, v228, s39, v248 op_sel:[1,0,0,0]
    v_mad_u32_u16 v228, v228, s39, v248
    v_mfma_f32_32x32x16_bf16 v[32:47], v[72:75], v[180:183], v[32:47]
    s_set_gpr_idx_on s31, gpr_idx(DST)
    s_nop 0
    v_cvt_pk_bf16_f32 v194, v234, v242
    s_set_gpr_idx_off
    v_mfma_f32_32x32x16_bf16 v[48:63], v[76:79], v[180:183], v[48:63]
    s_waitcnt vmcnt(4) lgkmcnt(0)
    v_mfma_f32_32x32x16_bf16 v[0:15], v[80:83], v[184:187], v[0:15]
    ds_read_b64_tr_b16 v[176:177], v246 offset:0
    ds_read_b64_tr_b16 v[178:179], v246 offset:512
    ds_read_b64_tr_b16 v[180:181], v247 offset:0
    ds_read_b64_tr_b16 v[182:183], v247 offset:512
    s_mov_b32 m0, s71
    v_mfma_f32_32x32x16_bf16 v[16:31], v[84:87], v[184:187], v[16:31]
    buffer_load_dwordx4 v228, s[4:7], s47 offen lds
    buffer_load_dwordx4 v229, s[72:75], s47 offen offset:1024 lds
    v_mfma_f32_32x32x16_bf16 v[32:47], v[80:83], v[188:191], v[32:47]
    s_nop 2
    v_mul_f32 v242, v0, v144
    s_nop 1
    v_fma_f32 v240, v8, v160, -v240
    v_fmac_f32 v242, v1, v145
    v_fmac_f32 v240, v9, v161
    v_fmac_f32 v242, v2, v146
    v_fmac_f32 v240, v10, v162
    v_fmac_f32 v242, v3, v147
    v_mfma_f32_32x32x16_bf16 v[48:63], v[84:87], v[188:191], v[48:63]
    s_setprio 0
    v_fmac_f32 v240, v11, v163
    v_fmac_f32 v242, v4, v148
    v_fmac_f32 v240, v12, v164
    v_fmac_f32 v242, v5, v149
    v_fmac_f32 v240, v13, v165
    v_fmac_f32 v242, v6, v150
    v_fmac_f32 v240, v14, v166
    v_fmac_f32 v242, v7, v151
    v_fmac_f32 v240, v15, v167
    s_sub_u32 s58, s48, s29
    v_add_u32 v249, s58, v249
    v_add_u32 v250, s58, v250
    v_fma_f32 v244, v16, v160, -v244
    v_fmac_f32 v236, v24, v112
    v_fmac_f32 v244, v17, v161
    v_fmac_f32 v236, v25, v113
    v_fmac_f32 v244, v18, v162
    v_fmac_f32 v236, v26, v114
    v_fmac_f32 v244, v19, v163
    v_fmac_f32 v236, v27, v115
    v_fmac_f32 v244, v20, v164
    v_fmac_f32 v236, v28, v116
    v_fmac_f32 v244, v21, v165
    v_fmac_f32 v236, v29, v117
    v_fmac_f32 v244, v22, v166
    v_fmac_f32 v236, v30, v118
    v_fmac_f32 v244, v23, v167
    v_fmac_f32 v236, v31, v119
    ds_read_b64_tr_b16 v[0:1], v249 offset:0
    ds_read_b64_tr_b16 v[2:3], v249 offset:128
    ds_read_b128 v[4:7], v250 offset:0
    ds_read_b128 v[8:11], v250 offset:16
    ds_read_b128 v[12:15], v250 offset:384
    ds_read_b128 v[16:19], v250 offset:400
    v_mul_f32 v243, v32, v152
    v_fma_f32 v241, v40, v168, -v241
    v_fmac_f32 v243, v33, v153
    v_fmac_f32 v241, v41, v169
    v_fmac_f32 v243, v34, v154
    v_fmac_f32 v241, v42, v170
    v_fmac_f32 v243, v35, v155
    v_fmac_f32 v241, v43, v171
    v_fmac_f32 v243, v36, v156
    v_fmac_f32 v241, v44, v172
    v_fmac_f32 v243, v37, v157
    v_fmac_f32 v241, v45, v173
    v_fmac_f32 v243, v38, v158
    v_fmac_f32 v241, v46, v174
    v_fmac_f32 v243, v39, v159
    v_fmac_f32 v241, v47, v175
    ds_read_b64_tr_b16 v[20:21], v249 offset:512
    ds_read_b64_tr_b16 v[22:23], v249 offset:640
    ds_read_b128 v[24:27], v250 offset:64
    ds_read_b128 v[28:31], v250 offset:80
    ds_read_b128 v[32:35], v250 offset:448
    ds_read_b128 v[36:39], v250 offset:464
    v_fma_f32 v245, v48, v168, -v245
    v_fmac_f32 v237, v56, v120
    v_fmac_f32 v245, v49, v169
    v_fmac_f32 v237, v57, v121
    v_fmac_f32 v245, v50, v170
    v_fmac_f32 v237, v58, v122
    v_fmac_f32 v245, v51, v171
    v_fmac_f32 v237, v59, v123
    v_fmac_f32 v245, v52, v172
    v_fmac_f32 v237, v60, v124
    v_fmac_f32 v245, v53, v173
    v_fmac_f32 v237, v61, v125
    v_fmac_f32 v245, v54, v174
    v_fmac_f32 v237, v62, v126
    v_fmac_f32 v245, v55, v175
    v_fmac_f32 v237, v63, v127
    s_cmp_lg_u32 s34, 0
    s_cbranch_scc1 K2_SWITCH
    s_mov_b32 s29, s48
    s_mov_b32 s32, s31
    s_mov_b32 s30, s3
    s_mov_b32 s31, s35
    s_cmp_eq_u32 s33, 2
    s_cbranch_scc1 K2_U20
    s_cmp_eq_u32 s33, 3
    s_cbranch_scc1 K2_U30
    s_cmp_eq_u32 s33, 1
    s_cbranch_scc1 K2_U10
    s_branch K2_U40
K2_U21:
    s_setprio 1
    s_waitcnt lgkmcnt(10)
    v_lshlrev_b32 v40, 16, v0
    v_and_b32 v41, 0xffff0000, v0
    v_lshlrev_b32 v42, 16, v1
    v_and_b32 v43, 0xffff0000, v1
    v_lshlrev_b32 v44, 16, v2
    v_and_b32 v45, 0xffff0000, v2
    v_lshlrev_b32 v46, 16, v3
    v_and_b32 v47, 0xffff0000, v3
    s_waitcnt lgkmcnt(8)
    v_mul_f32 v4, v40, v4
    v_mul_f32 v5, v41, v5
    v_mul_f32 v6, v42, v6
    v_mul_f32 v7, v43, v7
    v_mul_f32 v8, v44, v8
    v_mul_f32 v9, v45, v9
    v_mul_f32 v10, v46, v10
    v_mul_f32 v11, v47, v11
    v_cvt_pk_bf16_f32 v64, v4, v5
    v_cvt_pk_bf16_f32 v65, v6, v7
    v_cvt_pk_bf16_f32 v66, v8, v9
    v_cvt_pk_bf16_f32 v67, v10, v11
    s_waitcnt lgkmcnt(6)
    v_mul_f32 v12, v40, v12
    v_mul_f32 v13, v41, v13
    v_mul_f32 v14, v42, v14
    v_mul_f32 v15, v43, v15
    v_mul_f32 v16, v44, v16
    v_mul_f32 v17, v45, v17
    v_mul_f32 v18, v46, v18
    v_mul_f32 v19, v47, v19
    v_cvt_pk_bf16_f32 v68, v12, v13
    v_cvt_pk_bf16_f32 v69, v14, v15
    v_cvt_pk_bf16_f32 v70, v16, v17
    v_cvt_pk_bf16_f32 v71, v18, v19
    s_waitcnt lgkmcnt(4)
    v_lshlrev_b32 v48, 16, v20
    v_and_b32 v49, 0xffff0000, v20
    v_lshlrev_b32 v50, 16, v21
    v_and_b32 v51, 0xffff0000, v21
    v_lshlrev_b32 v52, 16, v22
    v_and_b32 v53, 0xffff0000, v22
    v_lshlrev_b32 v54, 16, v23
    v_and_b32 v55, 0xffff0000, v23
    s_waitcnt lgkmcnt(2)
    v_mul_f32 v24, v48, v24
    v_mul_f32 v25, v49, v25
    v_mul_f32 v26, v50, v26
    v_mul_f32 v27, v51, v27
    v_mul_f32 v28, v52, v28
    v_mul_f32 v29, v53, v29
    v_mul_f32 v30, v54, v30
    v_mul_f32 v31, v55, v31
    v_cvt_pk_bf16_f32 v72, v24, v25
    v_cvt_pk_bf16_f32 v73, v26, v27
    v_cvt_pk_bf16_f32 v74, v28, v29
    v_cvt_pk_bf16_f32 v75, v30, v31
    s_waitcnt lgkmcnt(0)
    v_mul_f32 v32, v48, v32
    v_mul_f32 v33, v49, v33
    v_mul_f32 v34, v50, v34
    v_mul_f32 v35, v51, v35
    v_mul_f32 v36, v52, v36
    v_mul_f32 v37, v53, v37
    v_mul_f32 v38, v54, v38
    v_mul_f32 v39, v55, v39
    v_cvt_pk_bf16_f32 v76, v32, v33
    v_cvt_pk_bf16_f32 v77, v34, v35
    v_cvt_pk_bf16_f32 v78, v36, v37
    v_cvt_pk_bf16_f32 v79, v38, v39
    s_waitcnt vmcnt(4)
    v_mfma_f32_32x32x16_bf16 v[0:15], v[64:67], v[176:179], 0
    ds_read_b64_tr_b16 v[184:185], v246 offset:2048
    ds_read_b64_tr_b16 v[186:187], v246 offset:2560
    ds_read_b64_tr_b16 v[188:189], v247 offset:2048
    ds_read_b64_tr_b16 v[190:191], v247 offset:2560
    s_mov_b32 m0, s68
    v_mfma_f32_32x32x16_bf16 v[16:31], v[68:71], v[176:179], 0
    buffer_load_dwordx4 v222, s[4:7], s42 offen lds
    buffer_load_dwordx4 v223, s[72:75], s42 offen offset:1024 lds
    v_permlane32_swap_b32 v242, v243
    v_permlane32_swap_b32 v240, v241
    v_mov_b32 v254, 163648
    v_mfma_f32_32x32x16_bf16 v[32:47], v[64:67], v[180:183], 0
    v_permlane32_swap_b32 v236, v237
    v_permlane32_swap_b32 v244, v245
    v_add_f32 v242, v242, v243
    v_add_f32 v240, -v240, -v241
    v_add_f32 v236, v236, v237
    v_mfma_f32_32x32x16_bf16 v[48:63], v[68:71], v[180:183], 0
    v_add_f32 v244, v244, v245
    v_cvt_pk_bf16_f32 v242, v242, v236
    v_cvt_pk_bf16_f32 v244, v244, v240
    v_cvt_pk_bf16_f32 v238, v238, v238
    ds_write_b16 v230, v242 offset:1152
    ds_write_b16_d16_hi v230, v242 offset:128
    v_mov_b32 v255, 1
    v_lshl_add_u32 v233, v252, 1, s53
    s_mov_b64 exec, 1
    ds_add_rtn_u32 v232, v254, v255
    s_mov_b64 exec, -1
    ds_read_b32 v233, v233
    s_waitcnt vmcnt(4) lgkmcnt(4)
    v_mfma_f32_32x32x16_bf16 v[0:15], v[72:75], v[184:187], v[0:15]
    ds_read_b64_tr_b16 v[176:177], v246 offset:4096
    ds_read_b64_tr_b16 v[178:179], v246 offset:4608
    ds_read_b64_tr_b16 v[180:181], v247 offset:4096
    ds_read_b64_tr_b16 v[182:183], v247 offset:4608
    ds_write_b16 v230, v244 offset:512
    ds_write_b16_d16_hi v230, v244 offset:896
    s_mov_b32 m0, s69
    v_mfma_f32_32x32x16_bf16 v[16:31], v[76:79], v[184:187], v[16:31]
    buffer_load_dwordx4 v224, s[4:7], s42 offen lds
    buffer_load_dwordx4 v225, s[72:75], s42 offen offset:1024 lds
    ds_write_b16 v230, v238 offset:1280
    s_waitcnt lgkmcnt(7)
    v_readfirstlane_b32 s58, v232
    v_mfma_f32_32x32x16_bf16 v[32:47], v[72:75], v[188:191], v[32:47]
    s_cmp_lt_u32 s58, s22
    s_cbranch_scc0 K2_nul_54
    s_and_b32 s59, s58, 7
    s_lshr_b32 s60, s58, 3
K2_chk_56:
    v_readlane_b32 s61, v233, s59
    s_nop 0
    s_cmp_gt_u32 s61, s60
    s_cbranch_scc0 K2_spin_55
K2_back_57:
    v_mfma_f32_32x32x16_bf16 v[48:63], v[76:79], v[188:191], v[48:63]
    s_setprio 0
    v_readlane_b32 s3, v253, s58
    s_lshl_b32 s44, s34, 7
    s_lshl_b32 s60, s58, 5
    s_and_b32 s48, s3, 0x3ffff
    s_bfe_u32 s33, s3, 0x30012
    s_sub_u32 s60, s60, s48
    v_mul_f32 v234, v0, v96
    v_mul_f32 v236, v8, v128
    v_fmac_f32 v234, v1, v97
    v_fmac_f32 v236, v9, v129
    v_fmac_f32 v234, v2, v98
    v_fmac_f32 v236, v10, v130
    v_fmac_f32 v234, v3, v99
    v_fmac_f32 v236, v11, v131
    v_fmac_f32 v234, v4, v100
    v_fmac_f32 v236, v12, v132
    v_fmac_f32 v234, v5, v101
    v_fmac_f32 v236, v13, v133
    v_fmac_f32 v234, v6, v102
    v_fmac_f32 v236, v14, v134
    v_fmac_f32 v234, v7, v103
    v_fmac_f32 v236, v15, v135
    v_mul_f32 v238, v16, v128
    v_mul_f32 v240, v24, v128
    v_fmac_f32 v238, v17, v129
    v_fmac_f32 v240, v25, v129
    v_fmac_f32 v238, v18, v130
    v_fmac_f32 v240, v26, v130
    v_fmac_f32 v238, v19, v131
    v_fmac_f32 v240, v27, v131
    v_fmac_f32 v238, v20, v132
    v_fmac_f32 v240, v28, v132
    v_fmac_f32 v238, v21, v133
    v_fmac_f32 v240, v29, v133
    v_fmac_f32 v238, v22, v134
    v_fmac_f32 v240, v30, v134
    v_fmac_f32 v238, v23, v135
    v_fmac_f32 v240, v31, v135
    v_mul_f32 v235, v32, v104
    v_mul_f32 v237, v40, v136
    v_fmac_f32 v235, v33, v105
    v_fmac_f32 v237, v41, v137
    v_fmac_f32 v235, v34, v106
    v_fmac_f32 v237, v42, v138
    v_fmac_f32 v235, v35, v107
    v_fmac_f32 v237, v43, v139
    v_fmac_f32 v235, v36, v108
    v_fmac_f32 v237, v44, v140
    v_fmac_f32 v235, v37, v109
    v_fmac_f32 v237, v45, v141
    v_fmac_f32 v235, v38, v110
    v_fmac_f32 v237, v46, v142
    v_fmac_f32 v235, v39, v111
    v_fmac_f32 v237, v47, v143
    v_mul_f32 v239, v48, v136
    v_mul_f32 v241, v56, v136
    v_fmac_f32 v239, v49, v137
    v_fmac_f32 v241, v57, v137
    s_setprio 1
    s_waitcnt vmcnt(4) lgkmcnt(3)
    v_mfma_f32_32x32x16_bf16 v[0:15], v[64:67], v[176:179], 0
    ds_read_b64_tr_b16 v[184:185], v246 offset:6144
    ds_read_b64_tr_b16 v[186:187], v246 offset:6656
    ds_read_b64_tr_b16 v[188:189], v247 offset:6144
    ds_read_b64_tr_b16 v[190:191], v247 offset:6656
    v_fmac_f32 v239, v50, v138
    v_fmac_f32 v241, v58, v138
    s_mov_b32 m0, s70
    v_mfma_f32_32x32x16_bf16 v[16:31], v[68:71], v[176:179], 0
    buffer_load_dwordx4 v222, s[4:7], s43 offen lds
    buffer_load_dwordx4 v223, s[72:75], s43 offen offset:1024 lds
    v_fmac_f32 v239, v51, v139
    v_fmac_f32 v241, v59, v139
    v_fmac_f32 v239, v52, v140
    v_fmac_f32 v241, v60, v140
    v_fmac_f32 v239, v53, v141
    v_mfma_f32_32x32x16_bf16 v[32:47], v[64:67], v[180:183], 0
    s_and_b32 s60, s60, 0xff
    s_add_u32 s35, s60, s48
    s_mov_b32 s45, s44
    s_add_u32 s47, s44, 256
    s_add_u32 s49, s48, 32
    s_add_u32 s60, s48, 64
    s_cmp_eq_u32 s33, 3
    s_cselect_b32 s46, s44, s47
    s_cselect_b32 s50, s60, s48
    s_cselect_b32 s51, s48, s49
    s_sub_u32 s60, s33, 2
    s_cmp_lt_u32 s60, 2
    s_cbranch_scc0 K2_rare_58
K2_back_59:
    v_add_u32 v222, s48, v251
    ds_read_b32 v222, v222
    v_fmac_f32 v241, v61, v141
    v_fmac_f32 v239, v54, v142
    v_fmac_f32 v241, v62, v142
    v_fmac_f32 v239, v55, v143
    v_fmac_f32 v241, v63, v143
    v_mfma_f32_32x32x16_bf16 v[48:63], v[68:71], v[180:183], 0
    v_permlane32_swap_b32 v234, v235
    v_permlane32_swap_b32 v236, v237
    v_permlane32_swap_b32 v238, v239
    s_waitcnt vmcnt(4) lgkmcnt(1)
    v_mfma_f32_32x32x16_bf16 v[0:15], v[72:75], v[184:187], v[0:15]
    ds_read_b64_tr_b16 v[176:177], v246 offset:0
    ds_read_b64_tr_b16 v[178:179], v246 offset:512
    ds_read_b64_tr_b16 v[180:181], v247 offset:0
    ds_read_b64_tr_b16 v[182:183], v247 offset:512
    v_permlane32_swap_b32 v240, v241
    s_mov_b32 m0, s71
    v_mfma_f32_32x32x16_bf16 v[16:31], v[76:79], v[184:187], v[16:31]
    buffer_load_dwordx4 v224, s[4:7], s43 offen lds
    buffer_load_dwordx4 v225, s[72:75], s43 offen offset:1024 lds
    s_waitcnt lgkmcnt(4)
    v_mad_u32_u16 v223, v222, s39, v248 op_sel:[1,0,0,0]
    v_mad_u32_u16 v222, v222, s39, v248
    v_add_u32 v230, s31, v252
    v_add_f32 v234, v234, v235
    v_add_f32 v236, v236, v237
    v_add_f32 v238, v238, v239
    v_add_f32 v240, v240, v241
    v_cvt_pk_bf16_f32 v234, v234, v236
    v_cvt_pk_bf16_f32 v238, v238, v240
    ds_write_b16 v230, v234 offset:0
    ds_write_b16_d16_hi v230, v234 offset:256
    ds_write_b16 v230, v238 offset:640
    ds_write_b16_d16_hi v230, v238 offset:1024
    v_mfma_f32_32x32x16_bf16 v[32:47], v[72:75], v[188:191], v[32:47]
    v_add_u32 v224, s49, v251
    ds_read_b32 v224, v224
    v_mul_f32 v234, v0, v144
    v_mul_f32 v236, v8, v112
    v_fmac_f32 v234, v1, v145
    v_fmac_f32 v236, v9, v113
    v_fmac_f32 v234, v2, v146
    v_mfma_f32_32x32x16_bf16 v[48:63], v[76:79], v[188:191], v[48:63]
    s_setprio 0
    v_fmac_f32 v236, v10, v114
    v_fmac_f32 v234, v3, v147
    v_fmac_f32 v236, v11, v115
    v_fmac_f32 v234, v4, v148
    v_fmac_f32 v236, v12, v116
    v_fmac_f32 v234, v5, v149
    v_fmac_f32 v236, v13, v117
    v_fmac_f32 v234, v6, v150
    v_fmac_f32 v236, v14, v118
    v_fmac_f32 v234, v7, v151
    v_fmac_f32 v236, v15, v119
    v_mul_f32 v238, v16, v160
    v_mul_f32 v240, v24, v160
    v_fmac_f32 v238, v17, v161
    v_fmac_f32 v240, v25, v161
    v_fmac_f32 v238, v18, v162
    v_fmac_f32 v240, v26, v162
    v_fmac_f32 v238, v19, v163
    v_fmac_f32 v240, v27, v163
    v_fmac_f32 v238, v20, v164
    v_fmac_f32 v240, v28, v164
    v_fmac_f32 v238, v21, v165
    v_fmac_f32 v240, v29, v165
    v_fmac_f32 v238, v22, v166
    v_fmac_f32 v240, v30, v166
    v_fmac_f32 v238, v23, v167
    v_fmac_f32 v240, v31, v167
    v_mul_f32 v235, v32, v152
    v_mul_f32 v237, v40, v120
    v_fmac_f32 v235, v33, v153
    v_fmac_f32 v237, v41, v121
    v_fmac_f32 v235, v34, v154
    v_fmac_f32 v237, v42, v122
    v_fmac_f32 v235, v35, v155
    v_fmac_f32 v237, v43, v123
    v_fmac_f32 v235, v36, v156
    v_fmac_f32 v237, v44, v124
    v_fmac_f32 v235, v37, v157
    v_fmac_f32 v237, v45, v125
    v_fmac_f32 v235, v38, v158
    v_fmac_f32 v237, v46, v126
    v_fmac_f32 v235, v39, v159
    v_fmac_f32 v237, v47, v127
    v_mul_f32 v239, v48, v168
    v_mul_f32 v241, v56, v168
    v_fmac_f32 v239, v49, v169
    v_fmac_f32 v241, v57, v169
    v_fmac_f32 v239, v50, v170
    v_fmac_f32 v241, v58, v170
    v_fmac_f32 v239, v51, v171
    s_setprio 1
    s_waitcnt vmcnt(4) lgkmcnt(5)
    v_mfma_f32_32x32x16_bf16 v[0:15], v[64:67], v[176:179], 0
    ds_read_b64_tr_b16 v[184:185], v246 offset:2048
    ds_read_b64_tr_b16 v[186:187], v246 offset:2560
    ds_read_b64_tr_b16 v[188:189], v247 offset:2048
    ds_read_b64_tr_b16 v[190:191], v247 offset:2560
    v_fmac_f32 v241, v59, v171
    v_fmac_f32 v239, v52, v172
    s_mov_b32 m0, s68
    v_mfma_f32_32x32x16_bf16 v[16:31], v[68:71], v[176:179], 0
    buffer_load_dwordx4 v222, s[4:7], s44 offen lds
    buffer_load_dwordx4 v223, s[72:75], s44 offen offset:1024 lds
    s_waitcnt lgkmcnt(4)
    v_mad_u32_u16 v225, v224, s39, v248 op_sel:[1,0,0,0]
    v_mad_u32_u16 v224, v224, s39, v248
    v_fmac_f32 v241, v60, v172
    v_fmac_f32 v239, v53, v173
    v_mfma_f32_32x32x16_bf16 v[32:47], v[64:67], v[180:183], 0
    v_add_u32 v226, s50, v251
    ds_read_b32 v226, v226
    v_fmac_f32 v241, v61, v173
    v_fmac_f32 v239, v54, v174
    v_fmac_f32 v241, v62, v174
    v_fmac_f32 v239, v55, v175
    v_fmac_f32 v241, v63, v175
    v_mfma_f32_32x32x16_bf16 v[48:63], v[68:71], v[180:183], 0
    v_permlane32_swap_b32 v234, v235
    v_add_f32 v234, v234, v235
    s_waitcnt vmcnt(4) lgkmcnt(1)
    v_mfma_f32_32x32x16_bf16 v[0:15], v[72:75], v[184:187], v[0:15]
    ds_read_b64_tr_b16 v[176:177], v246 offset:4096
    ds_read_b64_tr_b16 v[178:179], v246 offset:4608
    ds_read_b64_tr_b16 v[180:181], v247 offset:4096
    ds_read_b64_tr_b16 v[182:183], v247 offset:4608
    s_mov_b32 m0, s69
    v_mfma_f32_32x32x16_bf16 v[16:31], v[76:79], v[184:187], v[16:31]
    buffer_load_dwordx4 v224, s[4:7], s45 offen lds
    buffer_load_dwordx4 v225, s[72:75], s45 offen offset:1024 lds
    s_waitcnt lgkmcnt(4)
    v_mad_u32_u16 v227, v226, s39, v248 op_sel:[1,0,0,0]
    v_mad_u32_u16 v226, v226, s39, v248
    v_mfma_f32_32x32x16_bf16 v[32:47], v[72:75], v[188:191], v[32:47]
    v_add_u32 v228, s51, v251
    ds_read_b32 v228, v228
    v_mul_f32 v242, v0, v144
    v_fma_f32 v238, v8, v160, -v238
    v_fmac_f32 v242, v1, v145
    v_fmac_f32 v238, v9, v161
    v_fmac_f32 v242, v2, v146
    v_mfma_f32_32x32x16_bf16 v[48:63], v[76:79], v[188:191], v[48:63]
    s_setprio 0
    v_fmac_f32 v238, v10, v162
    v_fmac_f32 v242, v3, v147
    v_fmac_f32 v238, v11, v163
    v_fmac_f32 v242, v4, v148
    v_fmac_f32 v238, v12, v164
    v_fmac_f32 v242, v5, v149
    v_fmac_f32 v238, v13, v165
    v_fmac_f32 v242, v6, v150
    v_fmac_f32 v238, v14, v166
    v_fmac_f32 v242, v7, v151
    v_fmac_f32 v238, v15, v167
    v_fmac_f32 v236, v16, v112
    v_mul_f32 v244, v24, v160
    v_fmac_f32 v236, v17, v113
    v_fmac_f32 v244, v25, v161
    v_fmac_f32 v236, v18, v114
    v_fmac_f32 v244, v26, v162
    v_fmac_f32 v236, v19, v115
    v_fmac_f32 v244, v27, v163
    v_fmac_f32 v236, v20, v116
    v_fmac_f32 v244, v28, v164
    v_fmac_f32 v236, v21, v117
    v_fmac_f32 v244, v29, v165
    v_fmac_f32 v236, v22, v118
    v_fmac_f32 v244, v30, v166
    v_fmac_f32 v236, v23, v119
    v_fmac_f32 v244, v31, v167
    v_mul_f32 v243, v32, v152
    v_fma_f32 v239, v40, v168, -v239
    v_fmac_f32 v243, v33, v153
    v_fmac_f32 v239, v41, v169
    v_fmac_f32 v243, v34, v154
    v_fmac_f32 v239, v42, v170
    v_fmac_f32 v243, v35, v155
    v_fmac_f32 v239, v43, v171
    v_fmac_f32 v243, v36, v156
    v_fmac_f32 v239, v44, v172
    v_fmac_f32 v243, v37, v157
    v_fmac_f32 v239, v45, v173
    v_fmac_f32 v243, v38, v158
    v_fmac_f32 v239, v46, v174
    v_fmac_f32 v243, v39, v159
    v_fmac_f32 v239, v47, v175
    v_fmac_f32 v237, v48, v120
    v_mul_f32 v245, v56, v168
    v_fmac_f32 v237, v49, v121
    v_fmac_f32 v245, v57, v169
    v_fmac_f32 v237, v50, v122
    s_setprio 1
    s_waitcnt vmcnt(4) lgkmcnt(1)
    v_mfma_f32_32x32x16_bf16 v[0:15], v[64:67], v[176:179], 0
    ds_read_b64_tr_b16 v[184:185], v246 offset:6144
    ds_read_b64_tr_b16 v[186:187], v246 offset:6656
    ds_read_b64_tr_b16 v[188:189], v247 offset:6144
    ds_read_b64_tr_b16 v[190:191], v247 offset:6656
    v_fmac_f32 v245, v58, v170
    v_fmac_f32 v237, v51, v123
    s_mov_b32 m0, s70
    v_mfma_f32_32x32x16_bf16 v[16:31], v[68:71], v[176:179], 0
    buffer_load_dwordx4 v226, s[4:7], s46 offen lds
    buffer_load_dwordx4 v227, s[72:75], s46 offen offset:1024 lds
    s_waitcnt lgkmcnt(4)
    v_mad_u32_u16 v229, v228, s39, v248 op_sel:[1,0,0,0]
    v_mad_u32_u16 v228, v228, s39, v248
    v_fmac_f32 v245, v59, v171
    v_fmac_f32 v237, v52, v124
    v_mfma_f32_32x32x16_bf16 v[32:47], v[64:67], v[180:183], 0
    v_fmac_f32 v245, v60, v172
    v_fmac_f32 v237, v53, v125
    v_fmac_f32 v245, v61, v173
    v_fmac_f32 v237, v54, v126
    v_fmac_f32 v245, v62, v174
    v_fmac_f32 v237, v55, v127
    v_fmac_f32 v245, v63, v175
    v_mfma_f32_32x32x16_bf16 v[48:63], v[68:71], v[180:183], 0
    v_permlane32_swap_b32 v238, v239
    v_permlane32_swap_b32 v242, v243
    v_add_f32 v238, v238, v239
    v_add_f32 v242, v242, v243
    s_waitcnt vmcnt(4) lgkmcnt(0)
    v_mfma_f32_32x32x16_bf16 v[0:15], v[72:75], v[184:187], v[0:15]
    ds_read_b64_tr_b16 v[176:177], v246 offset:0
    ds_read_b64_tr_b16 v[178:179], v246 offset:512
    ds_read_b64_tr_b16 v[180:181], v247 offset:0
    ds_read_b64_tr_b16 v[182:183], v247 offset:512
    v_cvt_pk_bf16_f32 v234, v234, v242
    ds_write_b16 v230, v234 offset:384
    s_mov_b32 m0, s71
    v_mfma_f32_32x32x16_bf16 v[16:31], v[76:79], v[184:187], v[16:31]
    buffer_load_dwordx4 v228, s[4:7], s47 offen lds
    buffer_load_dwordx4 v229, s[72:75], s47 offen offset:1024 lds
    ds_write_b16_d16_hi v230, v234 offset:768
    v_mfma_f32_32x32x16_bf16 v[32:47], v[72:75], v[188:191], v[32:47]
    v_mul_f32 v242, v0, v144
    v_fma_f32 v240, v8, v160, -v240
    v_fmac_f32 v242, v1, v145
    v_fmac_f32 v240, v9, v161
    v_fmac_f32 v242, v2, v146
    v_fmac_f32 v240, v10, v162
    v_fmac_f32 v242, v3, v147
    v_mfma_f32_32x32x16_bf16 v[48:63], v[76:79], v[188:191], v[48:63]
    s_setprio 0
    v_fmac_f32 v240, v11, v163
    v_fmac_f32 v242, v4, v148
    v_fmac_f32 v240, v12, v164
    v_fmac_f32 v242, v5, v149
    v_fmac_f32 v240, v13, v165
    v_fmac_f32 v242, v6, v150
    v_fmac_f32 v240, v14, v166
    v_fmac_f32 v242, v7, v151
    v_fmac_f32 v240, v15, v167
    s_sub_u32 s58, s48, s29
    v_add_u32 v249, s58, v249
    v_add_u32 v250, s58, v250
    v_fma_f32 v244, v16, v160, -v244
    v_fmac_f32 v236, v24, v112
    v_fmac_f32 v244, v17, v161
    v_fmac_f32 v236, v25, v113
    v_fmac_f32 v244, v18, v162
    v_fmac_f32 v236, v26, v114
    v_fmac_f32 v244, v19, v163
    v_fmac_f32 v236, v27, v115
    v_fmac_f32 v244, v20, v164
    v_fmac_f32 v236, v28, v116
    v_fmac_f32 v244, v21, v165
    v_fmac_f32 v236, v29, v117
    v_fmac_f32 v244, v22, v166
    v_fmac_f32 v236, v30, v118
    v_fmac_f32 v244, v23, v167
    v_fmac_f32 v236, v31, v119
    ds_read_b64_tr_b16 v[0:1], v249 offset:0
    ds_read_b64_tr_b16 v[2:3], v249 offset:128
    ds_read_b128 v[4:7], v250 offset:0
    ds_read_b128 v[8:11], v250 offset:16
    ds_read_b128 v[12:15], v250 offset:384
    ds_read_b128 v[16:19], v250 offset:400
    v_mul_f32 v243, v32, v152
    v_fma_f32 v241, v40, v168, -v241
    v_fmac_f32 v243, v33, v153
    v_fmac_f32 v241, v41, v169
    v_fmac_f32 v243, v34, v154
    v_fmac_f32 v241, v42, v170
    v_fmac_f32 v243, v35, v155
    v_fmac_f32 v241, v43, v171
    v_fmac_f32 v243, v36, v156
    v_fmac_f32 v241, v44, v172
    v_fmac_f32 v243, v37, v157
    v_fmac_f32 v241, v45, v173
    v_fmac_f32 v243, v38, v158
    v_fmac_f32 v241, v46, v174
    v_fmac_f32 v243, v39, v159
    v_fmac_f32 v241, v47, v175
    ds_read_b64_tr_b16 v[20:21], v249 offset:512
    ds_read_b64_tr_b16 v[22:23], v249 offset:640
    ds_read_b128 v[24:27], v250 offset:64
    ds_read_b128 v[28:31], v250 offset:80
    ds_read_b128 v[32:35], v250 offset:448
    ds_read_b128 v[36:39], v250 offset:464
    v_fma_f32 v245, v48, v168, -v245
    v_fmac_f32 v237, v56, v120
    v_fmac_f32 v245, v49, v169
    v_fmac_f32 v237, v57, v121
    v_fmac_f32 v245, v50, v170
    v_fmac_f32 v237, v58, v122
    v_fmac_f32 v245, v51, v171
    v_fmac_f32 v237, v59, v123
    v_fmac_f32 v245, v52, v172
    v_fmac_f32 v237, v60, v124
    v_fmac_f32 v245, v53, v173
    v_fmac_f32 v237, v61, v125
    v_fmac_f32 v245, v54, v174
    v_fmac_f32 v237, v62, v126
    v_fmac_f32 v245, v55, v175
    v_fmac_f32 v237, v63, v127
    s_cmp_eq_u32 s36, 0
    s_cbranch_scc1 K2_TAIL
    s_mov_b32 s29, s48
    s_mov_b32 s32, s31
    s_mov_b32 s30, s3
    s_mov_b32 s31, s35
    s_cmp_eq_u32 s33, 2
    s_cbranch_scc1 K2_U21
    s_cmp_eq_u32 s33, 3
    s_cbranch_scc1 K2_U31
    s_cmp_eq_u32 s33, 1
    s_cbranch_scc1 K2_U11
    s_branch K2_U41
K2_U31:
    s_setprio 1
    s_waitcnt lgkmcnt(10)
    v_lshlrev_b32 v40, 16, v0
    v_and_b32 v41, 0xffff0000, v0
    v_lshlrev_b32 v42, 16, v1
    v_and_b32 v43, 0xffff0000, v1
    v_lshlrev_b32 v44, 16, v2
    v_and_b32 v45, 0xffff0000, v2
    v_lshlrev_b32 v46, 16, v3
    v_and_b32 v47, 0xffff0000, v3
    s_waitcnt lgkmcnt(8)
    v_mul_f32 v4, v40, v4
    v_mul_f32 v5, v41, v5
    v_mul_f32 v6, v42, v6
    v_mul_f32 v7, v43, v7
    v_mul_f32 v8, v44, v8
    v_mul_f32 v9, v45, v9
    v_mul_f32 v10, v46, v10
    v_mul_f32 v11, v47, v11
    v_cvt_pk_bf16_f32 v64, v4, v5
    v_cvt_pk_bf16_f32 v65, v6, v7
    v_cvt_pk_bf16_f32 v66, v8, v9
    v_cvt_pk_bf16_f32 v67, v10, v11
    s_waitcnt lgkmcnt(6)
    v_mul_f32 v12, v40, v12
    v_mul_f32 v13, v41, v13
    v_mul_f32 v14, v42, v14
    v_mul_f32 v15, v43, v15
    v_mul_f32 v16, v44, v16
    v_mul_f32 v17, v45, v17
    v_mul_f32 v18, v46, v18
    v_mul_f32 v19, v47, v19
    v_cvt_pk_bf16_f32 v68, v12, v13
    v_cvt_pk_bf16_f32 v69, v14, v15
    v_cvt_pk_bf16_f32 v70, v16, v17
    v_cvt_pk_bf16_f32 v71, v18, v19
    ds_read_b64_tr_b16 v[0:1], v249 offset:1024
    ds_read_b64_tr_b16 v[2:3], v249 offset:1152
    ds_read_b128 v[4:7], v250 offset:128
    ds_read_b128 v[8:11], v250 offset:144
    ds_read_b128 v[12:15], v250 offset:512
    ds_read_b128 v[16:19], v250 offset:528
    s_waitcnt lgkmcnt(10)
    v_lshlrev_b32 v48, 16, v20
    v_and_b32 v49, 0xffff0000, v20
    v_lshlrev_b32 v50, 16, v21
    v_and_b32 v51, 0xffff0000, v21
    v_lshlrev_b32 v52, 16, v22
    v_and_b32 v53, 0xffff0000, v22
    v_lshlrev_b32 v54, 16, v23
    v_and_b32 v55, 0xffff0000, v23
    s_waitcnt lgkmcnt(8)
    v_mul_f32 v24, v48, v24
    v_mul_f32 v25, v49, v25
    v_mul_f32 v26, v50, v26
    v_mul_f32 v27, v51, v27
    v_mul_f32 v28, v52, v28
    v_mul_f32 v29, v53, v29
    v_mul_f32 v30, v54, v30
    v_mul_f32 v31, v55, v31
    v_cvt_pk_bf16_f32 v72, v24, v25
    v_cvt_pk_bf16_f32 v73, v26, v27
    v_cvt_pk_bf16_f32 v74, v28, v29
    v_cvt_pk_bf16_f32 v75, v30, v31
    s_waitcnt lgkmcnt(6)
    v_mul_f32 v32, v48, v32
    v_mul_f32 v33, v49, v33
    v_mul_f32 v34, v50, v34
    v_mul_f32 v35, v51, v35
    v_mul_f32 v36, v52, v36
    v_mul_f32 v37, v53, v37
    v_mul_f32 v38, v54, v38
    v_mul_f32 v39, v55, v39
    v_cvt_pk_bf16_f32 v76, v32, v33
    v_cvt_pk_bf16_f32 v77, v34, v35
    v_cvt_pk_bf16_f32 v78, v36, v37
    v_cvt_pk_bf16_f32 v79, v38, v39
    s_waitcnt lgkmcnt(4)
    v_lshlrev_b32 v40, 16, v0
    v_and_b32 v41, 0xffff0000, v0
    v_lshlrev_b32 v42, 16, v1
    v_and_b32 v43, 0xffff0000, v1
    v_lshlrev_b32 v44, 16, v2
    v_and_b32 v45, 0xffff0000, v2
    v_lshlrev_b32 v46, 16, v3
    v_and_b32 v47, 0xffff0000, v3
    s_waitcnt lgkmcnt(2)
    v_mul_f32 v4, v40, v4
    v_mul_f32 v5, v41, v5
    v_mul_f32 v6, v42, v6
    v_mul_f32 v7, v43, v7
    v_mul_f32 v8, v44, v8
    v_mul_f32 v9, v45, v9
    v_mul_f32 v10, v46, v10
    v_mul_f32 v11, v47, v11
    v_cvt_pk_bf16_f32 v80, v4, v5
    v_cvt_pk_bf16_f32 v81, v6, v7
    v_cvt_pk_bf16_f32 v82, v8, v9
    v_cvt_pk_bf16_f32 v83, v10, v11
    s_waitcnt lgkmcnt(0)
    v_mul_f32 v12, v40, v12
    v_mul_f32 v13, v41, v13
    v_mul_f32 v14, v42, v14
    v_mul_f32 v15, v43, v15
    v_mul_f32 v16, v44, v16
    v_mul_f32 v17, v45, v17
    v_mul_f32 v18, v46, v18
    v_mul_f32 v19, v47, v19
    v_cvt_pk_bf16_f32 v84, v12, v13
    v_cvt_pk_bf16_f32 v85, v14, v15
    v_cvt_pk_bf16_f32 v86, v16, v17
    v_cvt_pk_bf16_f32 v87, v18, v19
    s_waitcnt vmcnt(4)
    v_mfma_f32_32x32x16_bf16 v[0:15], v[64:67], v[176:179], 0
    ds_read_b64_tr_b16 v[184:185], v246 offset:2048
    ds_read_b64_tr_b16 v[186:187], v246 offset:2560
    ds_read_b64_tr_b16 v[188:189], v247 offset:2048
    ds_read_b64_tr_b16 v[190:191], v247 offset:2560
    s_mov_b32 m0, s68
    v_mfma_f32_32x32x16_bf16 v[16:31], v[68:71], v[176:179], 0
    buffer_load_dwordx4 v224, s[4:7], s41 offen lds
    buffer_load_dwordx4 v225, s[72:75], s41 offen offset:1024 lds
    v_permlane32_swap_b32 v242, v243
    v_permlane32_swap_b32 v240, v241
    v_mov_b32 v254, 163648
    v_mfma_f32_32x32x16_bf16 v[32:47], v[64:67], v[180:183], 0
    v_permlane32_swap_b32 v236, v237
    v_permlane32_swap_b32 v244, v245
    v_add_f32 v242, v242, v243
    v_add_f32 v240, -v240, -v241
    v_add_f32 v236, v236, v237
    v_mfma_f32_32x32x16_bf16 v[48:63], v[68:71], v[180:183], 0
    v_add_f32 v244, v244, v245
    v_cvt_pk_bf16_f32 v242, v242, v236
    v_cvt_pk_bf16_f32 v244, v244, v240
    v_cvt_pk_bf16_f32 v238, v238, v238
    ds_write_b16 v230, v242 offset:1152
    ds_write_b16_d16_hi v230, v242 offset:128
    v_mov_b32 v255, 1
    v_lshl_add_u32 v233, v252, 1, s53
    s_mov_b64 exec, 1
    ds_add_rtn_u32 v232, v254, v255
    s_mov_b64 exec, -1
    ds_read_b32 v233, v233
    s_waitcnt vmcnt(4) lgkmcnt(4)
    v_mfma_f32_32x32x16_bf16 v[0:15], v[72:75], v[184:187], v[0:15]
    ds_read_b64_tr_b16 v[176:177], v246 offset:4096
    ds_read_b64_tr_b16 v[178:179], v246 offset:4608
    ds_read_b64_tr_b16 v[180:181], v247 offset:4096
    ds_read_b64_tr_b16 v[182:183], v247 offset:4608
    ds_write_b16 v230, v244 offset:512
    ds_write_b16_d16_hi v230, v244 offset:896
    s_mov_b32 m0, s69
    v_mfma_f32_32x32x16_bf16 v[16:31], v[76:79], v[184:187], v[16:31]
    buffer_load_dwordx4 v226, s[4:7], s41 offen lds
    buffer_load_dwordx4 v227, s[72:75], s41 offen offset:1024 lds
    ds_write_b16 v230, v238 offset:1280
    s_waitcnt lgkmcnt(7)
    v_readfirstlane_b32 s58, v232
    v_mfma_f32_32x32x16_bf16 v[32:47], v[72:75], v[188:191], v[32:47]
    s_cmp_lt_u32 s58, s22
    s_cbranch_scc0 K2_nul_61
    s_and_b32 s59, s58, 7
    s_lshr_b32 s60, s58, 3
K2_chk_63:
    v_readlane_b32 s61, v233, s59
    s_nop 0
    s_cmp_gt_u32 s61, s60
    s_cbranch_scc0 K2_spin_62
K2_back_64:
    v_mfma_f32_32x32x16_bf16 v[48:63], v[76:79], v[188:191], v[48:63]
    v_readlane_b32 s3, v253, s58
    s_lshl_b32 s44, s34, 7
    s_lshl_b32 s60, s58, 5
    s_and_b32 s48, s3, 0x3ffff
    s_bfe_u32 s33, s3, 0x30012
    s_sub_u32 s60, s60, s48
    s_waitcnt vmcnt(4) lgkmcnt(3)
    v_mfma_f32_32x32x16_bf16 v[0:15], v[80:83], v[176:179], v[0:15]
    ds_read_b64_tr_b16 v[184:185], v246 offset:6144
    ds_read_b64_tr_b16 v[186:187], v246 offset:6656
    ds_read_b64_tr_b16 v[188:189], v247 offset:6144
    ds_read_b64_tr_b16 v[190:191], v247 offset:6656
    s_and_b32 s60, s60, 0xff
    s_add_u32 s35, s60, s48
    s_mov_b32 m0, s70
    v_mfma_f32_32x32x16_bf16 v[16:31], v[84:87], v[176:179], v[16:31]
    buffer_load_dwordx4 v222, s[4:7], s42 offen lds
    buffer_load_dwordx4 v223, s[72:75], s42 offen offset:1024 lds
    s_mov_b32 s45, s44
    s_add_u32 s47, s44, 256
    s_add_u32 s49, s48, 32
    s_add_u32 s60, s48, 64
    v_mfma_f32_32x32x16_bf16 v[32:47], v[80:83], v[180:183], v[32:47]
    s_cmp_eq_u32 s33, 3
    s_cselect_b32 s46, s44, s47
    s_cselect_b32 s50, s60, s48
    s_cselect_b32 s51, s48, s49
    s_sub_u32 s60, s33, 2
    s_cmp_lt_u32 s60, 2
    s_cbranch_scc0 K2_rare_65
K2_back_66:
    v_mfma_f32_32x32x16_bf16 v[48:63], v[84:87], v[180:183], v[48:63]
    s_setprio 0
    v_mul_f32 v234, v0, v96
    v_mul_f32 v236, v8, v128
    v_fmac_f32 v234, v1, v97
    v_fmac_f32 v236, v9, v129
    v_fmac_f32 v234, v2, v98
    v_fmac_f32 v236, v10, v130
    v_fmac_f32 v234, v3, v99
    v_fmac_f32 v236, v11, v131
    v_fmac_f32 v234, v4, v100
    v_fmac_f32 v236, v12, v132
    v_fmac_f32 v234, v5, v101
    v_fmac_f32 v236, v13, v133
    v_fmac_f32 v234, v6, v102
    v_fmac_f32 v236, v14, v134
    v_fmac_f32 v234, v7, v103
    v_fmac_f32 v236, v15, v135
    v_mul_f32 v238, v16, v128
    v_mul_f32 v240, v24, v128
    v_fmac_f32 v238, v17, v129
    v_fmac_f32 v240, v25, v129
    v_fmac_f32 v238, v18, v130
    v_fmac_f32 v240, v26, v130
    v_fmac_f32 v238, v19, v131
    v_fmac_f32 v240, v27, v131
    v_fmac_f32 v238, v20, v132
    v_fmac_f32 v240, v28, v132
    v_fmac_f32 v238, v21, v133
    v_fmac_f32 v240, v29, v133
    v_fmac_f32 v238, v22, v134
    v_fmac_f32 v240, v30, v134
    v_fmac_f32 v238, v23, v135
    v_fmac_f32 v240, v31, v135
    v_mul_f32 v235, v32, v104
    v_mul_f32 v237, v40, v136
    v_fmac_f32 v235, v33, v105
    v_fmac_f32 v237, v41, v137
    v_fmac_f32 v235, v34, v106
    v_fmac_f32 v237, v42, v138
    v_fmac_f32 v235, v35, v107
    v_fmac_f32 v237, v43, v139
    v_fmac_f32 v235, v36, v108
    v_fmac_f32 v237, v44, v140
    v_fmac_f32 v235, v37, v109
    v_fmac_f32 v237, v45, v141
    v_fmac_f32 v235, v38, v110
    v_fmac_f32 v237, v46, v142
    v_fmac_f32 v235, v39, v111
    v_fmac_f32 v237, v47, v143
    v_mul_f32 v239, v48, v136
    v_mul_f32 v241, v56, v136
    s_setprio 1
    s_waitcnt vmcnt(4) lgkmcnt(0)
    v_mfma_f32_32x32x16_bf16 v[0:15], v[64:67], v[184:187], 0
    ds_read_b64_tr_b16 v[176:177], v246 offset:0
    ds_read_b64_tr_b16 v[178:179], v246 offset:512
    ds_read_b64_tr_b16 v[180:181], v247 offset:0
    ds_read_b64_tr_b16 v[182:183], v247 offset:512
    v_fmac_f32 v239, v49, v137
    v_fmac_f32 v241, v57, v137
    s_mov_b32 m0, s71
    v_mfma_f32_32x32x16_bf16 v[16:31], v[68:71], v[184:187], 0
    buffer_load_dwordx4 v224, s[4:7], s42 offen lds
    buffer_load_dwordx4 v225, s[72:75], s42 offen offset:1024 lds
    v_fmac_f32 v239, v50, v138
    v_fmac_f32 v241, v58, v138
    v_fmac_f32 v239, v51, v139
    v_fmac_f32 v241, v59, v139
    v_fmac_f32 v239, v52, v140
    v_mfma_f32_32x32x16_bf16 v[32:47], v[64:67], v[188:191], 0
    v_fmac_f32 v241, v60, v140
    v_fmac_f32 v239, v53, v141
    v_fmac_f32 v241, v61, v141
    v_fmac_f32 v239, v54, v142
    v_fmac_f32 v241, v62, v142
    v_fmac_f32 v239, v55, v143
    v_fmac_f32 v241, v63, v143
    v_mfma_f32_32x32x16_bf16 v[48:63], v[68:71], v[188:191], 0
    v_permlane32_swap_b32 v234, v235
    v_permlane32_swap_b32 v236, v237
    v_permlane32_swap_b32 v238, v239
    s_waitcnt vmcnt(4) lgkmcnt(0)
    v_mfma_f32_32x32x16_bf16 v[0:15], v[72:75], v[176:179], v[0:15]
    ds_read_b64_tr_b16 v[184:185], v246 offset:2048
    ds_read_b64_tr_b16 v[186:187], v246 offset:2560
    ds_read_b64_tr_b16 v[188:189], v247 offset:2048
    ds_read_b64_tr_b16 v[190:191], v247 offset:2560
    v_permlane32_swap_b32 v240, v241
    s_mov_b32 m0, s68
    v_mfma_f32_32x32x16_bf16 v[16:31], v[76:79], v[176:179], v[16:31]
    buffer_load_dwordx4 v226, s[4:7], s42 offen lds
    buffer_load_dwordx4 v227, s[72:75], s42 offen offset:1024 lds
    v_add_u32 v230, s31, v252
    v_add_f32 v234, v234, v235
    v_add_f32 v236, v236, v237
    v_add_f32 v238, v238, v239
    v_add_f32 v240, v240, v241
    v_mfma_f32_32x32x16_bf16 v[32:47], v[72:75], v[180:183], v[32:47]
    v_cvt_pk_bf16_f32 v234, v234, v236
    v_cvt_pk_bf16_f32 v238, v238, v240
    ds_write_b16 v230, v234 offset:0
    ds_write_b16_d16_hi v230, v234 offset:256
    ds_write_b16 v230, v238 offset:640
    ds_write_b16_d16_hi v230, v238 offset:1024
    v_mfma_f32_32x32x16_bf16 v[48:63], v[76:79], v[180:183], v[48:63]
    s_waitcnt vmcnt(4) lgkmcnt(4)
    v_mfma_f32_32x32x16_bf16 v[0:15], v[80:83], v[184:187], v[0:15]
    ds_read_b64_tr_b16 v[176:177], v246 offset:4096
    ds_read_b64_tr_b16 v[178:179], v246 offset:4608
    ds_read_b64_tr_b16 v[180:181], v247 offset:4096
    ds_read_b64_tr_b16 v[182:183], v247 offset:4608
    s_mov_b32 m0, s69
    v_mfma_f32_32x32x16_bf16 v[16:31], v[84:87], v[184:187], v[16:31]
    buffer_load_dwordx4 v222, s[4:7], s43 offen lds
    buffer_load_dwordx4 v223, s[72:75], s43 offen offset:1024 lds
    v_mfma_f32_32x32x16_bf16 v[32:47], v[80:83], v[188:191], v[32:47]
    s_nop 2
    v_mul_f32 v234, v0, v144
    v_mul_f32 v236, v8, v112
    v_fmac_f32 v234, v1, v145
    v_fmac_f32 v236, v9, v113
    v_fmac_f32 v234, v2, v146
    v_fmac_f32 v236, v10, v114
    v_fmac_f32 v234, v3, v147
    v_mfma_f32_32x32x16_bf16 v[48:63], v[84:87], v[188:191], v[48:63]
    s_setprio 0
    v_fmac_f32 v236, v11, v115
    v_fmac_f32 v234, v4, v148
    v_fmac_f32 v236, v12, v116
    v_fmac_f32 v234, v5, v149
    v_fmac_f32 v236, v13, v117
    v_fmac_f32 v234, v6, v150
    v_fmac_f32 v236, v14, v118
    v_fmac_f32 v234, v7, v151
    v_fmac_f32 v236, v15, v119
    v_mul_f32 v238, v16, v160
    v_mul_f32 v240, v24, v160
    v_fmac_f32 v238, v17, v161
    v_fmac_f32 v240, v25, v161
    v_fmac_f32 v238, v18, v162
    v_fmac_f32 v240, v26, v162
    v_fmac_f32 v238, v19, v163
    v_fmac_f32 v240, v27, v163
    v_fmac_f32 v238, v20, v164
    v_fmac_f32 v240, v28, v164
    v_fmac_f32 v238, v21, v165
    v_fmac_f32 v240, v29, v165
    v_fmac_f32 v238, v22, v166
    v_fmac_f32 v240, v30, v166
    v_fmac_f32 v238, v23, v167
    v_fmac_f32 v240, v31, v167
    v_mul_f32 v235, v32, v152
    v_mul_f32 v237, v40, v120
    v_fmac_f32 v235, v33, v153
    v_fmac_f32 v237, v41, v121
    v_fmac_f32 v235, v34, v154
    v_fmac_f32 v237, v42, v122
    v_fmac_f32 v235, v35, v155
    v_fmac_f32 v237, v43, v123
    v_fmac_f32 v235, v36, v156
    v_fmac_f32 v237, v44, v124
    v_fmac_f32 v235, v37, v157
    v_fmac_f32 v237, v45, v125
    v_fmac_f32 v235, v38, v158
    v_fmac_f32 v237, v46, v126
    v_fmac_f32 v235, v39, v159
    v_fmac_f32 v237, v47, v127
    v_mul_f32 v239, v48, v168
    v_mul_f32 v241, v56, v168
    v_fmac_f32 v239, v49, v169
    v_fmac_f32 v241, v57, v169
    s_setprio 1
    s_waitcnt vmcnt(4) lgkmcnt(0)
    v_mfma_f32_32x32x16_bf16 v[0:15], v[64:67], v[176:179], 0
    ds_read_b64_tr_b16 v[184:185], v246 offset:6144
    ds_read_b64_tr_b16 v[186:187], v246 offset:6656
    ds_read_b64_tr_b16 v[188:189], v247 offset:6144
    ds_read_b64_tr_b16 v[190:191], v247 offset:6656
    v_fmac_f32 v239, v50, v170
    v_fmac_f32 v241, v58, v170
    s_mov_b32 m0, s70
    v_mfma_f32_32x32x16_bf16 v[16:31], v[68:71], v[176:179], 0
    buffer_load_dwordx4 v224, s[4:7], s43 offen lds
    buffer_load_dwordx4 v225, s[72:75], s43 offen offset:1024 lds
    v_fmac_f32 v239, v51, v171
    v_fmac_f32 v241, v59, v171
    v_fmac_f32 v239, v52, v172
    v_fmac_f32 v241, v60, v172
    v_fmac_f32 v239, v53, v173
    v_mfma_f32_32x32x16_bf16 v[32:47], v[64:67], v[180:183], 0
    v_add_u32 v222, s48, v251
    ds_read_b32 v222, v222
    v_fmac_f32 v241, v61, v173
    v_fmac_f32 v239, v54, v174
    v_fmac_f32 v241, v62, v174
    v_fmac_f32 v239, v55, v175
    v_fmac_f32 v241, v63, v175
    v_mfma_f32_32x32x16_bf16 v[48:63], v[68:71], v[180:183], 0
    v_permlane32_swap_b32 v234, v235
    v_add_f32 v234, v234, v235
    s_waitcnt vmcnt(4) lgkmcnt(1)
    v_mfma_f32_32x32x16_bf16 v[0:15], v[72:75], v[184:187], v[0:15]
    ds_read_b64_tr_b16 v[176:177], v246 offset:0
    ds_read_b64_tr_b16 v[178:179], v246 offset:512
    ds_read_b64_tr_b16 v[180:181], v247 offset:0
    ds_read_b64_tr_b16 v[182:183], v247 offset:512
    s_mov_b32 m0, s71
    v_mfma_f32_32x32x16_bf16 v[16:31], v[76:79], v[184:187], v[16:31]
    buffer_load_dwordx4 v226, s[4:7], s43 offen lds
    buffer_load_dwordx4 v227, s[72:75], s43 offen offset:1024 lds
    s_waitcnt lgkmcnt(4)
    v_mad_u32_u16 v223, v222, s39, v248 op_sel:[1,0,0,0]
    v_mad_u32_u16 v222, v222, s39, v248
    v_mfma_f32_32x32x16_bf16 v[32:47], v[72:75], v[188:191], v[32:47]
    v_add_u32 v224, s49, v251
    ds_read_b32 v224, v224
    v_mfma_f32_32x32x16_bf16 v[48:63], v[76:79], v[188:191], v[48:63]
    s_waitcnt vmcnt(4) lgkmcnt(1)
    v_mfma_f32_32x32x16_bf16 v[0:15], v[80:83], v[176:179], v[0:15]
    ds_read_b64_tr_b16 v[184:185], v246 offset:2048
    ds_read_b64_tr_b16 v[186:187], v246 offset:2560
    ds_read_b64_tr_b16 v[188:189], v247 offset:2048
    ds_read_b64_tr_b16 v[190:191], v247 offset:2560
    s_mov_b32 m0, s68
    v_mfma_f32_32x32x16_bf16 v[16:31], v[84:87], v[176:179], v[16:31]
    buffer_load_dwordx4 v222, s[4:7], s44 offen lds
    buffer_load_dwordx4 v223, s[72:75], s44 offen offset:1024 lds
    s_waitcnt lgkmcnt(4)
    v_mad_u32_u16 v225, v224, s39, v248 op_sel:[1,0,0,0]
    v_mad_u32_u16 v224, v224, s39, v248
    v_mfma_f32_32x32x16_bf16 v[32:47], v[80:83], v[180:183], v[32:47]
    v_add_u32 v226, s50, v251
    ds_read_b32 v226, v226
    v_mul_f32 v242, v0, v144
    v_fma_f32 v238, v8, v160, -v238
    v_fmac_f32 v242, v1, v145
    v_fmac_f32 v238, v9, v161
    v_fmac_f32 v242, v2, v146
    v_mfma_f32_32x32x16_bf16 v[48:63], v[84:87], v[180:183], v[48:63]
    s_setprio 0
    v_fmac_f32 v238, v10, v162
    v_fmac_f32 v242, v3, v147
    v_fmac_f32 v238, v11, v163
    v_fmac_f32 v242, v4, v148
    v_fmac_f32 v238, v12, v164
    v_fmac_f32 v242, v5, v149
    v_fmac_f32 v238, v13, v165
    v_fmac_f32 v242, v6, v150
    v_fmac_f32 v238, v14, v166
    v_fmac_f32 v242, v7, v151
    v_fmac_f32 v238, v15, v167
    v_fmac_f32 v236, v16, v112
    v_mul_f32 v244, v24, v160
    v_fmac_f32 v236, v17, v113
    v_fmac_f32 v244, v25, v161
    v_fmac_f32 v236, v18, v114
    v_fmac_f32 v244, v26, v162
    v_fmac_f32 v236, v19, v115
    v_fmac_f32 v244, v27, v163
    v_fmac_f32 v236, v20, v116
    v_fmac_f32 v244, v28, v164
    v_fmac_f32 v236, v21, v117
    v_fmac_f32 v244, v29, v165
    v_fmac_f32 v236, v22, v118
    v_fmac_f32 v244, v30, v166
    v_fmac_f32 v236, v23, v119
    v_fmac_f32 v244, v31, v167
    v_mul_f32 v243, v32, v152
    v_fma_f32 v239, v40, v168, -v239
    v_fmac_f32 v243, v33, v153
    v_fmac_f32 v239, v41, v169
    v_fmac_f32 v243, v34, v154
    v_fmac_f32 v239, v42, v170
    v_fmac_f32 v243, v35, v155
    v_fmac_f32 v239, v43, v171
    v_fmac_f32 v243, v36, v156
    v_fmac_f32 v239, v44, v172
    v_fmac_f32 v243, v37, v157
    v_fmac_f32 v239, v45, v173
    v_fmac_f32 v243, v38, v158
    v_fmac_f32 v239, v46, v174
    v_fmac_f32 v243, v39, v159
    v_fmac_f32 v239, v47, v175
    v_fmac_f32 v237, v48, v120
    v_mul_f32 v245, v56, v168
    v_fmac_f32 v237, v49, v121
    v_fmac_f32 v245, v57, v169
    v_fmac_f32 v237, v50, v122
    v_fmac_f32 v245, v58, v170
    v_fmac_f32 v237, v51, v123
    s_setprio 1
    s_waitcnt vmcnt(4) lgkmcnt(1)
    v_mfma_f32_32x32x16_bf16 v[0:15], v[64:67], v[184:187], 0
    ds_read_b64_tr_b16 v[176:177], v246 offset:4096
    ds_read_b64_tr_b16 v[178:179], v246 offset:4608
    ds_read_b64_tr_b16 v[180:181], v247 offset:4096
    ds_read_b64_tr_b16 v[182:183], v247 offset:4608
    v_fmac_f32 v245, v59, v171
    v_fmac_f32 v237, v52, v124
    s_mov_b32 m0, s69
    v_mfma_f32_32x32x16_bf16 v[16:31], v[68:71], v[184:187], 0
    buffer_load_dwordx4 v224, s[4:7], s45 offen lds
    buffer_load_dwordx4 v225, s[72:75], s45 offen offset:1024 lds
    s_waitcnt lgkmcnt(4)
    v_mad_u32_u16 v227, v226, s39, v248 op_sel:[1,0,0,0]
    v_mad_u32_u16 v226, v226, s39, v248
    v_fmac_f32 v245, v60, v172
    v_fmac_f32 v237, v53, v125
    v_mfma_f32_32x32x16_bf16 v[32:47], v[64:67], v[188:191], 0
    v_add_u32 v228, s51, v251
    ds_read_b32 v228, v228
    v_fmac_f32 v245, v61, v173
    v_fmac_f32 v237, v54, v126
    v_fmac_f32 v245, v62, v174
    v_fmac_f32 v237, v55, v127
    v_fmac_f32 v245, v63, v175
    v_mfma_f32_32x32x16_bf16 v[48:63], v[68:71], v[188:191], 0
    v_permlane32_swap_b32 v238, v239
    v_permlane32_swap_b32 v242, v243
    v_add_f32 v238, v238, v239
    v_add_f32 v242, v242, v243
    s_waitcnt vmcnt(4) lgkmcnt(1)
    v_mfma_f32_32x32x16_bf16 v[0:15], v[72:75], v[176:179], v[0:15]
    ds_read_b64_tr_b16 v[184:185], v246 offset:6144
    ds_read_b64_tr_b16 v[186:187], v246 offset:6656
    ds_read_b64_tr_b16 v[188:189], v247 offset:6144
    ds_read_b64_tr_b16 v[190:191], v247 offset:6656
    v_cvt_pk_bf16_f32 v234, v234, v242
    ds_write_b16 v230, v234 offset:384
    s_mov_b32 m0, s70
    v_mfma_f32_32x32x16_bf16 v[16:31], v[76:79], v[176:179], v[16:31]
    buffer_load_dwordx4 v226, s[4:7], s46 offen lds
    buffer_load_dwordx4 v227, s[72:75], s46 offen offset:1024 lds
    s_waitcnt lgkmcnt(5)
    v_mad_u32_u16 v229, v228, s39, v248 op_sel:[1,0,0,0]
    v_mad_u32_u16 v228, v228, s39, v248
    ds_write_b16_d16_hi v230, v234 offset:768
    v_mfma_f32_32x32x16_bf16 v[32:47], v[72:75], v[180:183], v[32:47]
    v_mfma_f32_32x32x16_bf16 v[48:63], v[76:79], v[180:183], v[48:63]
    s_waitcnt vmcnt(4) lgkmcnt(2)
    v_mfma_f32_32x32x16_bf16 v[0:15], v[80:83], v[184:187], v[0:15]
    ds_read_b64_tr_b16 v[176:177], v246 offset:0
    ds_read_b64_tr_b16 v[178:179], v246 offset:512
    ds_read_b64_tr_b16 v[180:181], v247 offset:0
    ds_read_b64_tr_b16 v[182:183], v247 offset:512
    s_mov_b32 m0, s71
    v_mfma_f32_32x32x16_bf16 v[16:31], v[84:87], v[184:187], v[16:31]
    buffer_load_dwordx4 v228, s[4:7], s47 offen lds
    buffer_load_dwordx4 v229, s[72:75], s47 offen offset:1024 lds
    v_mfma_f32_32x32x16_bf16 v[32:47], v[80:83], v[188:191], v[32:47]
    s_nop 2
    v_mul_f32 v242, v0, v144
    v_fma_f32 v240, v8, v160, -v240
    v_fmac_f32 v242, v1, v145
    v_fmac_f32 v240, v9, v161
    v_fmac_f32 v242, v2, v146
    v_fmac_f32 v240, v10, v162
    v_fmac_f32 v242, v3, v147
    v_mfma_f32_32x32x16_bf16 v[48:63], v[84:87], v[188:191], v[48:63]
    s_setprio 0
    v_fmac_f32 v240, v11, v163
    v_fmac_f32 v242, v4, v148
    v_fmac_f32 v240, v12, v164
    v_fmac_f32 v242, v5, v149
    v_fmac_f32 v240, v13, v165
    v_fmac_f32 v242, v6, v150
    v_fmac_f32 v240, v14, v166
    v_fmac_f32 v242, v7, v151
    v_fmac_f32 v240, v15, v167
    s_sub_u32 s58, s48, s29
    v_add_u32 v249, s58, v249
    v_add_u32 v250, s58, v250
    v_fma_f32 v244, v16, v160, -v244
    v_fmac_f32 v236, v24, v112
    v_fmac_f32 v244, v17, v161
    v_fmac_f32 v236, v25, v113
    v_fmac_f32 v244, v18, v162
    v_fmac_f32 v236, v26, v114
    v_fmac_f32 v244, v19, v163
    v_fmac_f32 v236, v27, v115
    v_fmac_f32 v244, v20, v164
    v_fmac_f32 v236, v28, v116
    v_fmac_f32 v244, v21, v165
    v_fmac_f32 v236, v29, v117
    v_fmac_f32 v244, v22, v166
    v_fmac_f32 v236, v30, v118
    v_fmac_f32 v244, v23, v167
    v_fmac_f32 v236, v31, v119
    ds_read_b64_tr_b16 v[0:1], v249 offset:0
    ds_read_b64_tr_b16 v[2:3], v249 offset:128
    ds_read_b128 v[4:7], v250 offset:0
    ds_read_b128 v[8:11], v250 offset:16
    ds_read_b128 v[12:15], v250 offset:384
    ds_read_b128 v[16:19], v250 offset:400
    v_mul_f32 v243, v32, v152
    v_fma_f32 v241, v40, v168, -v241
    v_fmac_f32 v243, v33, v153
    v_fmac_f32 v241, v41, v169
    v_fmac_f32 v243, v34, v154
    v_fmac_f32 v241, v42, v170
    v_fmac_f32 v243, v35, v155
    v_fmac_f32 v241, v43, v171
    v_fmac_f32 v243, v36, v156
    v_fmac_f32 v241, v44, v172
    v_fmac_f32 v243, v37, v157
    v_fmac_f32 v241, v45, v173
    v_fmac_f32 v243, v38, v158
    v_fmac_f32 v241, v46, v174
    v_fmac_f32 v243, v39, v159
    v_fmac_f32 v241, v47, v175
    ds_read_b64_tr_b16 v[20:21], v249 offset:512
    ds_read_b64_tr_b16 v[22:23], v249 offset:640
    ds_read_b128 v[24:27], v250 offset:64
    ds_read_b128 v[28:31], v250 offset:80
    ds_read_b128 v[32:35], v250 offset:448
    ds_read_b128 v[36:39], v250 offset:464
    v_fma_f32 v245, v48, v168, -v245
    v_fmac_f32 v237, v56, v120
    v_fmac_f32 v245, v49, v169
    v_fmac_f32 v237, v57, v121
    v_fmac_f32 v245, v50, v170
    v_fmac_f32 v237, v58, v122
    v_fmac_f32 v245, v51, v171
    v_fmac_f32 v237, v59, v123
    v_fmac_f32 v245, v52, v172
    v_fmac_f32 v237, v60, v124
    v_fmac_f32 v245, v53, v173
    v_fmac_f32 v237, v61, v125
    v_fmac_f32 v245, v54, v174
    v_fmac_f32 v237, v62, v126
    v_fmac_f32 v245, v55, v175
    v_fmac_f32 v237, v63, v127
    s_cmp_eq_u32 s36, 0
    s_cbranch_scc1 K2_TAIL
    s_mov_b32 s29, s48
    s_mov_b32 s32, s31
    s_mov_b32 s30, s3
    s_mov_b32 s31, s35
    s_cmp_eq_u32 s33, 2
    s_cbranch_scc1 K2_U21
    s_cmp_eq_u32 s33, 3
    s_cbranch_scc1 K2_U31
    s_cmp_eq_u32 s33, 1
    s_cbranch_scc1 K2_U11
    s_branch K2_U41
K2_U10:
    s_setprio 1
    s_add_u32 s38, s38, 1
    v_mov_b32 v254, s52
    v_mov_b32 v255, s38
    s_lshl_b32 s58, s38, 3
    s_add_u32 s58, s58, s20
    s_mov_b64 exec, 1
    ds_write_b32 v254, v255
    s_mov_b64 exec, -1
    s_cmp_lt_u32 s58, s22
    s_cbranch_scc0 K2_dyn_68
K2_back_69:
    s_waitcnt lgkmcnt(11)
    v_lshlrev_b32 v40, 16, v0
    v_and_b32 v41, 0xffff0000, v0
    v_lshlrev_b32 v42, 16, v1
    v_and_b32 v43, 0xffff0000, v1
    v_lshlrev_b32 v44, 16, v2
    v_and_b32 v45, 0xffff0000, v2
    v_lshlrev_b32 v46, 16, v3
    v_and_b32 v47, 0xffff0000, v3
    s_waitcnt lgkmcnt(9)
    v_mul_f32 v4, v40, v4
    v_mul_f32 v5, v41, v5
    v_mul_f32 v6, v42, v6
    v_mul_f32 v7, v43, v7
    v_mul_f32 v8, v44, v8
    v_mul_f32 v9, v45, v9
    v_mul_f32 v10, v46, v10
    v_mul_f32 v11, v47, v11
    v_cvt_pk_bf16_f32 v64, v4, v5
    v_cvt_pk_bf16_f32 v65, v6, v7
    v_cvt_pk_bf16_f32 v66, v8, v9
    v_cvt_pk_bf16_f32 v67, v10, v11
    s_waitcnt lgkmcnt(7)
    v_mul_f32 v12, v40, v12
    v_mul_f32 v13, v41, v13
    v_mul_f32 v14, v42, v14
    v_mul_f32 v15, v43, v15
    v_mul_f32 v16, v44, v16
    v_mul_f32 v17, v45, v17
    v_mul_f32 v18, v46, v18
    v_mul_f32 v19, v47, v19
    v_cvt_pk_bf16_f32 v68, v12, v13
    v_cvt_pk_bf16_f32 v69, v14, v15
    v_cvt_pk_bf16_f32 v70, v16, v17
    v_cvt_pk_bf16_f32 v71, v18, v19
    v_readlane_b32 s3, v253, s58
    s_lshl_b32 s44, s34, 7
    s_lshl_b32 s60, s58, 5
    s_and_b32 s48, s3, 0x3ffff
    s_bfe_u32 s33, s3, 0x30012
    s_sub_u32 s60, s60, s48
    s_and_b32 s60, s60, 0xff
    s_add_u32 s60, s60, s48
    s_mul_i32 s35, s38, 6
    s_cmp_eq_u32 s34, 0
    s_cselect_b32 s35, s35, s60
    s_mov_b32 s45, s44
    s_add_u32 s47, s44, 256
    s_add_u32 s49, s48, 32
    s_add_u32 s60, s48, 64
    s_cmp_eq_u32 s33, 3
    s_cselect_b32 s46, s44, s47
    s_cselect_b32 s50, s60, s48
    s_cselect_b32 s51, s48, s49
    s_sub_u32 s60, s33, 2
    s_cmp_lt_u32 s60, 2
    s_cbranch_scc0 K2_rare_74
K2_back_75:
    v_add_u32 v233, s48, v230
    ds_read_b32 v232, v233
    ds_read_b32 v233, v233 offset:1024
    v_add_u32 v222, s48, v251
    ds_read_b32 v222, v222
    v_add_u32 v224, s49, v251
    ds_read_b32 v224, v224
    v_add_u32 v226, s50, v251
    ds_read_b32 v226, v226
    v_add_u32 v228, s51, v251
    ds_read_b32 v228, v228
    s_waitcnt lgkmcnt(4)
    v_or_b32 v232, v232, v231
    v_or_b32 v233, v233, v231
    s_cmp_lg_u32 s34, 0
    s_cbranch_scc1 K2_dum_77
    s_add_u32 m0, s48, 864
    s_add_u32 s65, s48, 1888
    buffer_load_dwordx4 v232, s[16:19], 0 offen  lds
    s_mov_b32 m0, s65
    s_mov_b32 exec_hi, 0
    buffer_load_dwordx4 v233, s[16:19], 0 offen  lds
    s_cmp_eq_u32 s33, 4
    s_cbranch_scc1 K2_a4_78
K2_b4_80:
    s_mov_b32 exec_hi, -1
K2_back_79:
    s_waitcnt lgkmcnt(3)
    v_mad_u32_u16 v223, v222, s39, v248 op_sel:[1,0,0,0]
    v_mad_u32_u16 v222, v222, s39, v248
    s_waitcnt lgkmcnt(2)
    v_mad_u32_u16 v225, v224, s39, v248 op_sel:[1,0,0,0]
    v_mad_u32_u16 v224, v224, s39, v248
    s_waitcnt lgkmcnt(1)
    v_mad_u32_u16 v227, v226, s39, v248 op_sel:[1,0,0,0]
    v_mad_u32_u16 v226, v226, s39, v248
    s_waitcnt lgkmcnt(0)
    v_mad_u32_u16 v229, v228, s39, v248 op_sel:[1,0,0,0]
    v_mad_u32_u16 v228, v228, s39, v248
    s_waitcnt vmcnt(6)
    v_mfma_f32_32x32x16_bf16 v[0:15], v[64:67], v[176:179], 0
    ds_read_b64_tr_b16 v[184:185], v246 offset:2048
    ds_read_b64_tr_b16 v[186:187], v246 offset:2560
    ds_read_b64_tr_b16 v[188:189], v247 offset:2048
    ds_read_b64_tr_b16 v[190:191], v247 offset:2560
    s_mov_b32 m0, s68
    v_mfma_f32_32x32x16_bf16 v[16:31], v[68:71], v[176:179], 0
    buffer_load_dwordx4 v222, s[4:7], s44 offen lds
    buffer_load_dwordx4 v223, s[72:75], s44 offen offset:1024 lds
    v_permlane32_swap_b32 v242, v243
    v_permlane32_swap_b32 v240, v241
    v_mfma_f32_32x32x16_bf16 v[32:47], v[64:67], v[180:183], 0
    v_permlane32_swap_b32 v236, v237
    v_permlane32_swap_b32 v244, v245
    v_add_f32 v242, v242, v243
    v_add_f32 v240, -v240, -v241
    v_add_f32 v236, v236, v237
    v_mfma_f32_32x32x16_bf16 v[48:63], v[68:71], v[180:183], 0
    s_setprio 0
    v_add_f32 v244, v244, v245
    s_set_gpr_idx_on s32, gpr_idx(DST)
    s_nop 0
    v_cvt_pk_bf16_f32 v195, v242, v236
    v_cvt_pk_bf16_f32 v196, v244, v240
    v_cvt_pk_bf16_f32 v197, v238, v238
    s_set_gpr_idx_off
    v_mul_f32 v234, v0, v96
    v_mul_f32 v236, v8, v128
    v_fmac_f32 v234, v1, v97
    v_fmac_f32 v236, v9, v129
    v_fmac_f32 v234, v2, v98
    v_fmac_f32 v236, v10, v130
    v_fmac_f32 v234, v3, v99
    v_fmac_f32 v236, v11, v131
    v_fmac_f32 v234, v4, v100
    v_fmac_f32 v236, v12, v132
    v_fmac_f32 v234, v5, v101
    v_fmac_f32 v236, v13, v133
    v_fmac_f32 v234, v6, v102
    v_fmac_f32 v236, v14, v134
    v_fmac_f32 v234, v7, v103
    v_fmac_f32 v236, v15, v135
    v_mul_f32 v238, v16, v128
    v_mul_f32 v240, v24, v128
    v_fmac_f32 v238, v17, v129
    v_fmac_f32 v240, v25, v129
    v_fmac_f32 v238, v18, v130
    v_fmac_f32 v240, v26, v130
    v_fmac_f32 v238, v19, v131
    v_fmac_f32 v240, v27, v131
    v_fmac_f32 v238, v20, v132
    v_fmac_f32 v240, v28, v132
    v_fmac_f32 v238, v21, v133
    v_fmac_f32 v240, v29, v133
    v_fmac_f32 v238, v22, v134
    v_fmac_f32 v240, v30, v134
    v_fmac_f32 v238, v23, v135
    v_fmac_f32 v240, v31, v135
    v_mul_f32 v235, v32, v104
    v_mul_f32 v237, v40, v136
    v_fmac_f32 v235, v33, v105
    v_fmac_f32 v237, v41, v137
    v_fmac_f32 v235, v34, v106
    v_fmac_f32 v237, v42, v138
    v_fmac_f32 v235, v35, v107
    v_fmac_f32 v237, v43, v139
    v_fmac_f32 v235, v36, v108
    v_fmac_f32 v237, v44, v140
    v_fmac_f32 v235, v37, v109
    v_fmac_f32 v237, v45, v141
    v_fmac_f32 v235, v38, v110
    v_fmac_f32 v237, v46, v142
    v_fmac_f32 v235, v39, v111
    v_fmac_f32 v237, v47, v143
    v_mul_f32 v239, v48, v136
    v_mul_f32 v241, v56, v136
    v_fmac_f32 v239, v49, v137
    v_fmac_f32 v241, v57, v137
    v_fmac_f32 v239, v50, v138
    v_fmac_f32 v241, v58, v138
    v_fmac_f32 v239, v51, v139
    v_fmac_f32 v241, v59, v139
    v_fmac_f32 v239, v52, v140
    v_fmac_f32 v241, v60, v140
    v_fmac_f32 v239, v53, v141
    v_fmac_f32 v241, v61, v141
    v_fmac_f32 v239, v54, v142
    v_fmac_f32 v241, v62, v142
    v_fmac_f32 v239, v55, v143
    v_fmac_f32 v241, v63, v143
    s_setprio 1
    s_waitcnt vmcnt(6) lgkmcnt(0)
    v_mfma_f32_32x32x16_bf16 v[0:15], v[64:67], v[184:187], 0
    ds_read_b64_tr_b16 v[176:177], v246 offset:4096
    ds_read_b64_tr_b16 v[178:179], v246 offset:4608
    ds_read_b64_tr_b16 v[180:181], v247 offset:4096
    ds_read_b64_tr_b16 v[182:183], v247 offset:4608
    s_mov_b32 m0, s69
    v_mfma_f32_32x32x16_bf16 v[16:31], v[68:71], v[184:187], 0
    buffer_load_dwordx4 v224, s[4:7], s45 offen lds
    buffer_load_dwordx4 v225, s[72:75], s45 offen offset:1024 lds
    v_permlane32_swap_b32 v234, v235
    v_permlane32_swap_b32 v236, v237
    v_mfma_f32_32x32x16_bf16 v[32:47], v[64:67], v[188:191], 0
    v_permlane32_swap_b32 v238, v239
    v_permlane32_swap_b32 v240, v241
    v_add_f32 v234, v234, v235
    v_add_f32 v236, v236, v237
    v_add_f32 v238, v238, v239
    v_mfma_f32_32x32x16_bf16 v[48:63], v[68:71], v[188:191], 0
    s_setprio 0
    v_add_f32 v240, v240, v241
    s_set_gpr_idx_on s31, gpr_idx(DST)
    s_nop 0
    v_cvt_pk_bf16_f32 v192, v234, v236
    v_cvt_pk_bf16_f32 v193, v238, v240
    s_set_gpr_idx_off
    v_mul_f32 v234, v0, v144
    v_mul_f32 v236, v8, v112
    v_fmac_f32 v234, v1, v145
    v_fmac_f32 v236, v9, v113
    v_fmac_f32 v234, v2, v146
    v_fmac_f32 v236, v10, v114
    v_fmac_f32 v234, v3, v147
    v_fmac_f32 v236, v11, v115
    v_fmac_f32 v234, v4, v148
    v_fmac_f32 v236, v12, v116
    v_fmac_f32 v234, v5, v149
    v_fmac_f32 v236, v13, v117
    v_fmac_f32 v234, v6, v150
    v_fmac_f32 v236, v14, v118
    v_fmac_f32 v234, v7, v151
    v_fmac_f32 v236, v15, v119
    v_mul_f32 v238, v16, v160
    v_mul_f32 v240, v24, v160
    v_fmac_f32 v238, v17, v161
    v_fmac_f32 v240, v25, v161
    v_fmac_f32 v238, v18, v162
    v_fmac_f32 v240, v26, v162
    v_fmac_f32 v238, v19, v163
    v_fmac_f32 v240, v27, v163
    v_fmac_f32 v238, v20, v164
    v_fmac_f32 v240, v28, v164
    v_fmac_f32 v238, v21, v165
    v_fmac_f32 v240, v29, v165
    v_fmac_f32 v238, v22, v166
    v_fmac_f32 v240, v30, v166
    v_fmac_f32 v238, v23, v167
    v_fmac_f32 v240, v31, v167
    v_mul_f32 v235, v32, v152
    v_mul_f32 v237, v40, v120
    v_fmac_f32 v235, v33, v153
    v_fmac_f32 v237, v41, v121
    v_fmac_f32 v235, v34, v154
    v_fmac_f32 v237, v42, v122
    v_fmac_f32 v235, v35, v155
    v_fmac_f32 v237, v43, v123
    v_fmac_f32 v235, v36, v156
    v_fmac_f32 v237, v44, v124
    v_fmac_f32 v235, v37, v157
    v_fmac_f32 v237, v45, v125
    v_fmac_f32 v235, v38, v158
    v_fmac_f32 v237, v46, v126
    v_fmac_f32 v235, v39, v159
    v_fmac_f32 v237, v47, v127
    v_mul_f32 v239, v48, v168
    v_mul_f32 v241, v56, v168
    v_fmac_f32 v239, v49, v169
    v_fmac_f32 v241, v57, v169
    v_fmac_f32 v239, v50, v170
    v_fmac_f32 v241, v58, v170
    v_fmac_f32 v239, v51, v171
    v_fmac_f32 v241, v59, v171
    v_fmac_f32 v239, v52, v172
    v_fmac_f32 v241, v60, v172
    v_fmac_f32 v239, v53, v173
    v_fmac_f32 v241, v61, v173
    v_fmac_f32 v239, v54, v174
    v_fmac_f32 v241, v62, v174
    v_fmac_f32 v239, v55, v175
    v_fmac_f32 v241, v63, v175
    s_setprio 1
    s_waitcnt vmcnt(6) lgkmcnt(0)
    v_mfma_f32_32x32x16_bf16 v[0:15], v[64:67], v[176:179], 0
    ds_read_b64_tr_b16 v[184:185], v246 offset:6144
    ds_read_b64_tr_b16 v[186:187], v246 offset:6656
    ds_read_b64_tr_b16 v[188:189], v247 offset:6144
    ds_read_b64_tr_b16 v[190:191], v247 offset:6656
    s_mov_b32 m0, s70
    v_mfma_f32_32x32x16_bf16 v[16:31], v[68:71], v[176:179], 0
    buffer_load_dwordx4 v226, s[4:7], s46 offen lds
    buffer_load_dwordx4 v227, s[72:75], s46 offen offset:1024 lds
    v_permlane32_swap_b32 v234, v235
    v_add_f32 v234, v234, v235
    v_mfma_f32_32x32x16_bf16 v[32:47], v[64:67], v[180:183], 0
    v_mfma_f32_32x32x16_bf16 v[48:63], v[68:71], v[180:183], 0
    s_setprio 0
    v_mul_f32 v242, v0, v144
    v_fma_f32 v238, v8, v160, -v238
    v_fmac_f32 v242, v1, v145
    v_fmac_f32 v238, v9, v161
    v_fmac_f32 v242, v2, v146
    v_fmac_f32 v238, v10, v162
    v_fmac_f32 v242, v3, v147
    v_fmac_f32 v238, v11, v163
    v_fmac_f32 v242, v4, v148
    v_fmac_f32 v238, v12, v164
    v_fmac_f32 v242, v5, v149
    v_fmac_f32 v238, v13, v165
    v_fmac_f32 v242, v6, v150
    v_fmac_f32 v238, v14, v166
    v_fmac_f32 v242, v7, v151
    v_fmac_f32 v238, v15, v167
    v_fmac_f32 v236, v16, v112
    v_mul_f32 v244, v24, v160
    v_fmac_f32 v236, v17, v113
    v_fmac_f32 v244, v25, v161
    v_fmac_f32 v236, v18, v114
    v_fmac_f32 v244, v26, v162
    v_fmac_f32 v236, v19, v115
    v_fmac_f32 v244, v27, v163
    v_fmac_f32 v236, v20, v116
    v_fmac_f32 v244, v28, v164
    v_fmac_f32 v236, v21, v117
    v_fmac_f32 v244, v29, v165
    v_fmac_f32 v236, v22, v118
    v_fmac_f32 v244, v30, v166
    v_fmac_f32 v236, v23, v119
    v_fmac_f32 v244, v31, v167
    v_mul_f32 v243, v32, v152
    v_fma_f32 v239, v40, v168, -v239
    v_fmac_f32 v243, v33, v153
    v_fmac_f32 v239, v41, v169
    v_fmac_f32 v243, v34, v154
    v_fmac_f32 v239, v42, v170
    v_fmac_f32 v243, v35, v155
    v_fmac_f32 v239, v43, v171
    v_fmac_f32 v243, v36, v156
    v_fmac_f32 v239, v44, v172
    v_fmac_f32 v243, v37, v157
    v_fmac_f32 v239, v45, v173
    v_fmac_f32 v243, v38, v158
    v_fmac_f32 v239, v46, v174
    v_fmac_f32 v243, v39, v159
    v_fmac_f32 v239, v47, v175
    v_fmac_f32 v237, v48, v120
    v_mul_f32 v245, v56, v168
    v_fmac_f32 v237, v49, v121
    v_fmac_f32 v245, v57, v169
    v_fmac_f32 v237, v50, v122
    v_fmac_f32 v245, v58, v170
    v_fmac_f32 v237, v51, v123
    v_fmac_f32 v245, v59, v171
    v_fmac_f32 v237, v52, v124
    v_fmac_f32 v245, v60, v172
    v_fmac_f32 v237, v53, v125
    v_fmac_f32 v245, v61, v173
    v_fmac_f32 v237, v54, v126
    v_fmac_f32 v245, v62, v174
    v_fmac_f32 v237, v55, v127
    v_fmac_f32 v245, v63, v175
    s_setprio 1
    s_waitcnt vmcnt(4) lgkmcnt(0)
    v_mfma_f32_32x32x16_bf16 v[0:15], v[64:67], v[184:187], 0
    ds_read_b64_tr_b16 v[176:177], v246 offset:0
    ds_read_b64_tr_b16 v[178:179], v246 offset:512
    ds_read_b64_tr_b16 v[180:181], v247 offset:0
    ds_read_b64_tr_b16 v[182:183], v247 offset:512
    s_mov_b32 m0, s71
    v_mfma_f32_32x32x16_bf16 v[16:31], v[68:71], v[184:187], 0
    buffer_load_dwordx4 v228, s[4:7], s47 offen lds
    buffer_load_dwordx4 v229, s[72:75], s47 offen offset:1024 lds
    v_permlane32_swap_b32 v238, v239
    v_permlane32_swap_b32 v242, v243
    v_add_f32 v238, v238, v239
    v_mfma_f32_32x32x16_bf16 v[32:47], v[64:67], v[188:191], 0
    v_add_f32 v242, v242, v243
    s_set_gpr_idx_on s31, gpr_idx(DST)
    s_nop 0
    v_cvt_pk_bf16_f32 v194, v234, v242
    s_set_gpr_idx_off
    v_mfma_f32_32x32x16_bf16 v[48:63], v[68:71], v[188:191], 0
    s_setprio 0
    v_mul_f32 v242, v0, v144
    v_fma_f32 v240, v8, v160, -v240
    v_fmac_f32 v242, v1, v145
    v_fmac_f32 v240, v9, v161
    v_fmac_f32 v242, v2, v146
    v_fmac_f32 v240, v10, v162
    v_fmac_f32 v242, v3, v147
    v_fmac_f32 v240, v11, v163
    v_fmac_f32 v242, v4, v148
    v_fmac_f32 v240, v12, v164
    v_fmac_f32 v242, v5, v149
    v_fmac_f32 v240, v13, v165
    v_fmac_f32 v242, v6, v150
    v_fmac_f32 v240, v14, v166
    v_fmac_f32 v242, v7, v151
    v_fmac_f32 v240, v15, v167
    s_sub_u32 s58, s48, s29
    v_add_u32 v249, s58, v249
    v_add_u32 v250, s58, v250
    v_fma_f32 v244, v16, v160, -v244
    v_fmac_f32 v236, v24, v112
    v_fmac_f32 v244, v17, v161
    v_fmac_f32 v236, v25, v113
    v_fmac_f32 v244, v18, v162
    v_fmac_f32 v236, v26, v114
    v_fmac_f32 v244, v19, v163
    v_fmac_f32 v236, v27, v115
    v_fmac_f32 v244, v20, v164
    v_fmac_f32 v236, v28, v116
    v_fmac_f32 v244, v21, v165
    v_fmac_f32 v236, v29, v117
    v_fmac_f32 v244, v22, v166
    v_fmac_f32 v236, v30, v118
    v_fmac_f32 v244, v23, v167
    v_fmac_f32 v236, v31, v119
    ds_read_b64_tr_b16 v[0:1], v249 offset:0
    ds_read_b64_tr_b16 v[2:3], v249 offset:128
    ds_read_b128 v[4:7], v250 offset:0
    ds_read_b128 v[8:11], v250 offset:16
    ds_read_b128 v[12:15], v250 offset:384
    ds_read_b128 v[16:19], v250 offset:400
    v_mul_f32 v243, v32, v152
    v_fma_f32 v241, v40, v168, -v241
    v_fmac_f32 v243, v33, v153
    v_fmac_f32 v241, v41, v169
    v_fmac_f32 v243, v34, v154
    v_fmac_f32 v241, v42, v170
    v_fmac_f32 v243, v35, v155
    v_fmac_f32 v241, v43, v171
    v_fmac_f32 v243, v36, v156
    v_fmac_f32 v241, v44, v172
    v_fmac_f32 v243, v37, v157
    v_fmac_f32 v241, v45, v173
    v_fmac_f32 v243, v38, v158
    v_fmac_f32 v241, v46, v174
    v_fmac_f32 v243, v39, v159
    v_fmac_f32 v241, v47, v175
    ds_read_b64_tr_b16 v[20:21], v249 offset:512
    ds_read_b64_tr_b16 v[22:23], v249 offset:640
    ds_read_b128 v[24:27], v250 offset:64
    ds_read_b128 v[28:31], v250 offset:80
    ds_read_b128 v[32:35], v250 offset:448
    ds_read_b128 v[36:39], v250 offset:464
    v_fma_f32 v245, v48, v168, -v245
    v_fmac_f32 v237, v56, v120
    v_fmac_f32 v245, v49, v169
    v_fmac_f32 v237, v57, v121
    v_fmac_f32 v245, v50, v170
    v_fmac_f32 v237, v58, v122
    v_fmac_f32 v245, v51, v171
    v_fmac_f32 v237, v59, v123
    v_fmac_f32 v245, v52, v172
    v_fmac_f32 v237, v60, v124
    v_fmac_f32 v245, v53, v173
    v_fmac_f32 v237, v61, v125
    v_fmac_f32 v245, v54, v174
    v_fmac_f32 v237, v62, v126
    v_fmac_f32 v245, v55, v175
    v_fmac_f32 v237, v63, v127
    s_cmp_lg_u32 s34, 0
    s_cbranch_scc1 K2_SWITCH
    s_mov_b32 s29, s48
    s_mov_b32 s32, s31
    s_mov_b32 s30, s3
    s_mov_b32 s31, s35
    s_cmp_eq_u32 s33, 2
    s_cbranch_scc1 K2_U20
    s_cmp_eq_u32 s33, 3
    s_cbranch_scc1 K2_U30
    s_cmp_eq_u32 s33, 1
    s_cbranch_scc1 K2_U10
    s_branch K2_U40
K2_U40:
    s_setprio 1
    s_waitcnt lgkmcnt(10)
    v_lshlrev_b32 v40, 16, v0
    v_and_b32 v41, 0xffff0000, v0
    v_lshlrev_b32 v42, 16, v1
    v_and_b32 v43, 0xffff0000, v1
    v_lshlrev_b32 v44, 16, v2
    v_and_b32 v45, 0xffff0000, v2
    v_lshlrev_b32 v46, 16, v3
    v_and_b32 v47, 0xffff0000, v3
    s_waitcnt lgkmcnt(8)
    v_mul_f32 v4, v40, v4
    v_mul_f32 v5, v41, v5
    v_mul_f32 v6, v42, v6
    v_mul_f32 v7, v43, v7
    v_mul_f32 v8, v44, v8
    v_mul_f32 v9, v45, v9
    v_mul_f32 v10, v46, v10
    v_mul_f32 v11, v47, v11
    v_cvt_pk_bf16_f32 v64, v4, v5
    v_cvt_pk_bf16_f32 v65, v6, v7
    v_cvt_pk_bf16_f32 v66, v8, v9
    v_cvt_pk_bf16_f32 v67, v10, v11
    s_waitcnt lgkmcnt(6)
    v_mul_f32 v12, v40, v12
    v_mul_f32 v13, v41, v13
    v_mul_f32 v14, v42, v14
    v_mul_f32 v15, v43, v15
    v_mul_f32 v16, v44, v16
    v_mul_f32 v17, v45, v17
    v_mul_f32 v18, v46, v18
    v_mul_f32 v19, v47, v19
    v_cvt_pk_bf16_f32 v68, v12, v13
    v_cvt_pk_bf16_f32 v69, v14, v15
    v_cvt_pk_bf16_f32 v70, v16, v17
    v_cvt_pk_bf16_f32 v71, v18, v19
    ds_read_b64_tr_b16 v[0:1], v249 offset:1024
    ds_read_b64_tr_b16 v[2:3], v249 offset:1152
    ds_read_b128 v[4:7], v250 offset:128
    ds_read_b128 v[8:11], v250 offset:144
    ds_read_b128 v[12:15], v250 offset:512
    ds_read_b128 v[16:19], v250 offset:528
    s_waitcnt lgkmcnt(10)
    v_lshlrev_b32 v48, 16, v20
    v_and_b32 v49, 0xffff0000, v20
    v_lshlrev_b32 v50, 16, v21
    v_and_b32 v51, 0xffff0000, v21
    v_lshlrev_b32 v52, 16, v22
    v_and_b32 v53, 0xffff0000, v22
    v_lshlrev_b32 v54, 16, v23
    v_and_b32 v55, 0xffff0000, v23
    s_waitcnt lgkmcnt(8)
    v_mul_f32 v24, v48, v24
    v_mul_f32 v25, v49, v25
    v_mul_f32 v26, v50, v26
    v_mul_f32 v27, v51, v27
    v_mul_f32 v28, v52, v28
    v_mul_f32 v29, v53, v29
    v_mul_f32 v30, v54, v30
    v_mul_f32 v31, v55, v31
    v_cvt_pk_bf16_f32 v72, v24, v25
    v_cvt_pk_bf16_f32 v73, v26, v27
    v_cvt_pk_bf16_f32 v74, v28, v29
    v_cvt_pk_bf16_f32 v75, v30, v31
    s_waitcnt lgkmcnt(6)
    v_mul_f32 v32, v48, v32
    v_mul_f32 v33, v49, v33
    v_mul_f32 v34, v50, v34
    v_mul_f32 v35, v51, v35
    v_mul_f32 v36, v52, v36
    v_mul_f32 v37, v53, v37
    v_mul_f32 v38, v54, v38
    v_mul_f32 v39, v55, v39
    v_cvt_pk_bf16_f32 v76, v32, v33
    v_cvt_pk_bf16_f32 v77, v34, v35
    v_cvt_pk_bf16_f32 v78, v36, v37
    v_cvt_pk_bf16_f32 v79, v38, v39
    s_lshr_b32 s65, s30, 27
    s_mov_b32 s66, 161536
    s_cmp_ge_u32 s65, 2
    s_cselect_b32 s66, 158112, s66
    s_mul_i32 s65, s65, 512
    s_add_u32 s65, s65, s66
    s_sub_u32 s65, s65, s29
    v_add_u32 v56, s65, v249
    s_lshr_b32 s65, s30, 27
    s_mov_b32 s66, 161536
    s_cmp_ge_u32 s65, 2
    s_cselect_b32 s66, 159008, s66
    s_mul_i32 s65, s65, 64
    s_add_u32 s65, s65, s66
    s_sub_u32 s65, s65, s29
    v_add_u32 v57, s65, v250
    ds_read_b64_tr_b16 v[20:21], v56 offset:0
    ds_read_b64_tr_b16 v[22:23], v56 offset:128
    ds_read_b128 v[24:27], v57 offset:0
    ds_read_b128 v[28:31], v57 offset:16
    ds_read_b128 v[32:35], v57 offset:384
    ds_read_b128 v[36:39], v57 offset:400
    s_waitcnt lgkmcnt(10)
    v_lshlrev_b32 v40, 16, v0
    v_and_b32 v41, 0xffff0000, v0
    v_lshlrev_b32 v42, 16, v1
    v_and_b32 v43, 0xffff0000, v1
    v_lshlrev_b32 v44, 16, v2
    v_and_b32 v45, 0xffff0000, v2
    v_lshlrev_b32 v46, 16, v3
    v_and_b32 v47, 0xffff0000, v3
    s_waitcnt lgkmcnt(8)
    v_mul_f32 v4, v40, v4
    v_mul_f32 v5, v41, v5
    v_mul_f32 v6, v42, v6
    v_mul_f32 v7, v43, v7
    v_mul_f32 v8, v44, v8
    v_mul_f32 v9, v45, v9
    v_mul_f32 v10, v46, v10
    v_mul_f32 v11, v47, v11
    v_cvt_pk_bf16_f32 v80, v4, v5
    v_cvt_pk_bf16_f32 v81, v6, v7
    v_cvt_pk_bf16_f32 v82, v8, v9
    v_cvt_pk_bf16_f32 v83, v10, v11
    s_waitcnt lgkmcnt(6)
    v_mul_f32 v12, v40, v12
    v_mul_f32 v13, v41, v13
    v_mul_f32 v14, v42, v14
    v_mul_f32 v15, v43, v15
    v_mul_f32 v16, v44, v16
    v_mul_f32 v17, v45, v17
    v_mul_f32 v18, v46, v18
    v_mul_f32 v19, v47, v19
    v_cvt_pk_bf16_f32 v84, v12, v13
    v_cvt_pk_bf16_f32 v85, v14, v15
    v_cvt_pk_bf16_f32 v86, v16, v17
    v_cvt_pk_bf16_f32 v87, v18, v19
    s_waitcnt lgkmcnt(4)
    v_lshlrev_b32 v48, 16, v20
    v_and_b32 v49, 0xffff0000, v20
    v_lshlrev_b32 v50, 16, v21
    v_and_b32 v51, 0xffff0000, v21
    v_lshlrev_b32 v52, 16, v22
    v_and_b32 v53, 0xffff0000, v22
    v_lshlrev_b32 v54, 16, v23
    v_and_b32 v55, 0xffff0000, v23
    s_waitcnt lgkmcnt(2)
    v_mul_f32 v24, v48, v24
    v_mul_f32 v25, v49, v25
    v_mul_f32 v26, v50, v26
    v_mul_f32 v27, v51, v27
    v_mul_f32 v28, v52, v28
    v_mul_f32 v29, v53, v29
    v_mul_f32 v30, v54, v30
    v_mul_f32 v31, v55, v31
    v_cvt_pk_bf16_f32 v88, v24, v25
    v_cvt_pk_bf16_f32 v89, v26, v27
    v_cvt_pk_bf16_f32 v90, v28, v29
    v_cvt_pk_bf16_f32 v91, v30, v31
    s_waitcnt lgkmcnt(0)
    v_mul_f32 v32, v48, v32
    v_mul_f32 v33, v49, v33
    v_mul_f32 v34, v50, v34
    v_mul_f32 v35, v51, v35
    v_mul_f32 v36, v52, v36
    v_mul_f32 v37, v53, v37
    v_mul_f32 v38, v54, v38
    v_mul_f32 v39, v55, v39
    v_cvt_pk_bf16_f32 v92, v32, v33
    v_cvt_pk_bf16_f32 v93, v34, v35
    v_cvt_pk_bf16_f32 v94, v36, v37
    v_cvt_pk_bf16_f32 v95, v38, v39
    s_waitcnt vmcnt(4)
    v_mfma_f32_32x32x16_bf16 v[0:15], v[64:67], v[176:179], 0
    ds_read_b64_tr_b16 v[184:185], v246 offset:2048
    ds_read_b64_tr_b16 v[186:187], v246 offset:2560
    ds_read_b64_tr_b16 v[188:189], v247 offset:2048
    ds_read_b64_tr_b16 v[190:191], v247 offset:2560
    s_mov_b32 m0, s68
    v_mfma_f32_32x32x16_bf16 v[16:31], v[68:71], v[176:179], 0
    buffer_load_dwordx4 v222, s[4:7], s41 offen lds
    buffer_load_dwordx4 v223, s[72:75], s41 offen offset:1024 lds
    v_permlane32_swap_b32 v242, v243
    v_permlane32_swap_b32 v240, v241
    s_add_u32 s38, s38, 1
    v_mfma_f32_32x32x16_bf16 v[32:47], v[64:67], v[180:183], 0
    v_permlane32_swap_b32 v236, v237
    v_permlane32_swap_b32 v244, v245
    v_add_f32 v242, v242, v243
    v_add_f32 v240, -v240, -v241
    v_add_f32 v236, v236, v237
    v_mfma_f32_32x32x16_bf16 v[48:63], v[68:71], v[180:183], 0
    v_add_f32 v244, v244, v245
    s_set_gpr_idx_on s32, gpr_idx(DST)
    s_nop 0
    v_cvt_pk_bf16_f32 v195, v242, v236
    v_cvt_pk_bf16_f32 v196, v244, v240
    v_cvt_pk_bf16_f32 v197, v238, v238
    s_set_gpr_idx_off
    s_waitcnt vmcnt(4) lgkmcnt(0)
    v_mfma_f32_32x32x16_bf16 v[0:15], v[72:75], v[184:187], v[0:15]
    ds_read_b64_tr_b16 v[176:177], v246 offset:4096
    ds_read_b64_tr_b16 v[178:179], v246 offset:4608
    ds_read_b64_tr_b16 v[180:181], v247 offset:4096
    ds_read_b64_tr_b16 v[182:183], v247 offset:4608
    v_mov_b32 v254, s52
    v_mov_b32 v255, s38
    s_mov_b32 m0, s69
    v_mfma_f32_32x32x16_bf16 v[16:31], v[76:79], v[184:187], v[16:31]
    buffer_load_dwordx4 v224, s[4:7], s41 offen lds
    buffer_load_dwordx4 v225, s[72:75], s41 offen offset:1024 lds
    s_lshl_b32 s58, s38, 3
    s_add_u32 s58, s58, s20
    s_mov_b64 exec, 1
    ds_write_b32 v254, v255
    s_mov_b64 exec, -1
    s_cmp_lt_u32 s58, s22
    s_cbranch_scc0 K2_dyn_81
K2_back_82:
    v_readlane_b32 s3, v253, s58
    s_lshl_b32 s44, s34, 7
    s_lshl_b32 s60, s58, 5
    s_and_b32 s48, s3, 0x3ffff
    s_bfe_u32 s33, s3, 0x30012
    s_sub_u32 s60, s60, s48
    s_and_b32 s60, s60, 0xff
    s_add_u32 s60, s60, s48
    s_mul_i32 s35, s38, 6
    s_cmp_eq_u32 s34, 0
    s_cselect_b32 s35, s35, s60
    s_mov_b32 s45, s44
    s_add_u32 s47, s44, 256
    s_add_u32 s49, s48, 32
    s_add_u32 s60, s48, 64
    s_cmp_eq_u32 s33, 3
    s_cselect_b32 s46, s44, s47
    s_cselect_b32 s50, s60, s48
    s_cselect_b32 s51, s48, s49
    s_sub_u32 s60, s33, 2
    s_cmp_lt_u32 s60, 2
    s_cbranch_scc0 K2_rare_87
K2_back_88:
    v_mfma_f32_32x32x16_bf16 v[32:47], v[72:75], v[188:191], v[32:47]
    v_add_u32 v233, s48, v230
    ds_read_b32 v232, v233
    ds_read_b32 v233, v233 offset:1024
    v_mfma_f32_32x32x16_bf16 v[48:63], v[76:79], v[188:191], v[48:63]
    s_waitcnt vmcnt(4) lgkmcnt(3)
    v_mfma_f32_32x32x16_bf16 v[0:15], v[80:83], v[176:179], v[0:15]
    ds_read_b64_tr_b16 v[184:185], v246 offset:6144
    ds_read_b64_tr_b16 v[186:187], v246 offset:6656
    ds_read_b64_tr_b16 v[188:189], v247 offset:6144
    ds_read_b64_tr_b16 v[190:191], v247 offset:6656
    s_mov_b32 m0, s70
    v_mfma_f32_32x32x16_bf16 v[16:31], v[84:87], v[176:179], v[16:31]
    buffer_load_dwordx4 v226, s[4:7], s41 offen lds
    buffer_load_dwordx4 v227, s[72:75], s41 offen offset:1024 lds
    v_mfma_f32_32x32x16_bf16 v[32:47], v[80:83], v[180:183], v[32:47]
    v_mfma_f32_32x32x16_bf16 v[48:63], v[84:87], v[180:183], v[48:63]
    s_waitcnt lgkmcnt(4)
    v_or_b32 v232, v232, v231
    v_or_b32 v233, v233, v231
    s_cmp_lg_u32 s34, 0
    s_cbranch_scc1 K2_dum_90
    s_add_u32 m0, s48, 864
    s_add_u32 s65, s48, 1888
    buffer_load_dwordx4 v232, s[16:19], 0 offen  lds
    s_mov_b32 m0, s65
    s_mov_b32 exec_hi, 0
    buffer_load_dwordx4 v233, s[16:19], 0 offen  lds
    s_cmp_eq_u32 s33, 4
    s_cbranch_scc1 K2_a4_91
K2_b4_93:
    s_mov_b32 exec_hi, -1
K2_back_92:
    s_waitcnt vmcnt(6) lgkmcnt(0)
    v_mfma_f32_32x32x16_bf16 v[0:15], v[88:91], v[184:187], v[0:15]
    ds_read_b64_tr_b16 v[176:177], v246 offset:0
    ds_read_b64_tr_b16 v[178:179], v246 offset:512
    ds_read_b64_tr_b16 v[180:181], v247 offset:0
    ds_read_b64_tr_b16 v[182:183], v247 offset:512
    s_mov_b32 m0, s71
    v_mfma_f32_32x32x16_bf16 v[16:31], v[92:95], v[184:187], v[16:31]
    buffer_load_dwordx4 v228, s[4:7], s41 offen lds
    buffer_load_dwordx4 v229, s[72:75], s41 offen offset:1024 lds
    v_mfma_f32_32x32x16_bf16 v[32:47], v[88:91], v[188:191], v[32:47]
    s_nop 2
    v_mul_f32 v234, v0, v96
    v_mul_f32 v236, v8, v128
    v_fmac_f32 v234, v1, v97
    v_fmac_f32 v236, v9, v129
    v_fmac_f32 v234, v2, v98
    v_fmac_f32 v236, v10, v130
    v_fmac_f32 v234, v3, v99
    v_mfma_f32_32x32x16_bf16 v[48:63], v[92:95], v[188:191], v[48:63]
    s_setprio 0
    v_fmac_f32 v236, v11, v131
    v_fmac_f32 v234, v4, v100
    v_fmac_f32 v236, v12, v132
    v_fmac_f32 v234, v5, v101
    v_fmac_f32 v236, v13, v133
    v_fmac_f32 v234, v6, v102
    v_fmac_f32 v236, v14, v134
    v_fmac_f32 v234, v7, v103
    v_fmac_f32 v236, v15, v135
    v_mul_f32 v238, v16, v128
    v_mul_f32 v240, v24, v128
    v_fmac_f32 v238, v17, v129
    v_fmac_f32 v240, v25, v129
    v_fmac_f32 v238, v18, v130
    v_fmac_f32 v240, v26, v130
    v_fmac_f32 v238, v19, v131
    v_fmac_f32 v240, v27, v131
    v_fmac_f32 v238, v20, v132
    v_fmac_f32 v240, v28, v132
    v_fmac_f32 v238, v21, v133
    v_fmac_f32 v240, v29, v133
    v_fmac_f32 v238, v22, v134
    v_fmac_f32 v240, v30, v134
    v_fmac_f32 v238, v23, v135
    v_fmac_f32 v240, v31, v135
    v_mul_f32 v235, v32, v104
    v_mul_f32 v237, v40, v136
    v_fmac_f32 v235, v33, v105
    v_fmac_f32 v237, v41, v137
    v_fmac_f32 v235, v34, v106
    v_fmac_f32 v237, v42, v138
    v_fmac_f32 v235, v35, v107
    v_fmac_f32 v237, v43, v139
    v_fmac_f32 v235, v36, v108
    v_fmac_f32 v237, v44, v140
    v_fmac_f32 v235, v37, v109
    v_fmac_f32 v237, v45, v141
    v_fmac_f32 v235, v38, v110
    v_fmac_f32 v237, v46, v142
    v_fmac_f32 v235, v39, v111
    v_fmac_f32 v237, v47, v143
    v_mul_f32 v239, v48, v136
    v_mul_f32 v241, v56, v136
    s_setprio 1
    s_waitcnt vmcnt(6) lgkmcnt(0)
    v_mfma_f32_32x32x16_bf16 v[0:15], v[64:67], v[176:179], 0
    ds_read_b64_tr_b16 v[184:185], v246 offset:2048
    ds_read_b64_tr_b16 v[186:187], v246 offset:2560
    ds_read_b64_tr_b16 v[188:189], v247 offset:2048
    ds_read_b64_tr_b16 v[190:191], v247 offset:2560
    v_fmac_f32 v239, v49, v137
    v_fmac_f32 v241, v57, v137
    s_mov_b32 m0, s68
    v_mfma_f32_32x32x16_bf16 v[16:31], v[68:71], v[176:179], 0
    buffer_load_dwordx4 v222, s[4:7], s42 offen lds
    buffer_load_dwordx4 v223, s[72:75], s42 offen offset:1024 lds
    v_fmac_f32 v239, v50, v138
    v_fmac_f32 v241, v58, v138
    v_fmac_f32 v239, v51, v139
    v_fmac_f32 v241, v59, v139
    v_fmac_f32 v239, v52, v140
    v_mfma_f32_32x32x16_bf16 v[32:47], v[64:67], v[180:183], 0
    v_fmac_f32 v241, v60, v140
    v_fmac_f32 v239, v53, v141
    v_fmac_f32 v241, v61, v141
    v_fmac_f32 v239, v54, v142
    v_fmac_f32 v241, v62, v142
    v_fmac_f32 v239, v55, v143
    v_fmac_f32 v241, v63, v143
    v_mfma_f32_32x32x16_bf16 v[48:63], v[68:71], v[180:183], 0
    v_permlane32_swap_b32 v234, v235
    v_permlane32_swap_b32 v236, v237
    v_permlane32_swap_b32 v238, v239
    s_waitcnt vmcnt(6) lgkmcnt(0)
    v_mfma_f32_32x32x16_bf16 v[0:15], v[72:75], v[184:187], v[0:15]
    ds_read_b64_tr_b16 v[176:177], v246 offset:4096
    ds_read_b64_tr_b16 v[178:179], v246 offset:4608
    ds_read_b64_tr_b16 v[180:181], v247 offset:4096
    ds_read_b64_tr_b16 v[182:183], v247 offset:4608
    v_permlane32_swap_b32 v240, v241
    s_mov_b32 m0, s69
    v_mfma_f32_32x32x16_bf16 v[16:31], v[76:79], v[184:187], v[16:31]
    buffer_load_dwordx4 v224, s[4:7], s42 offen lds
    buffer_load_dwordx4 v225, s[72:75], s42 offen offset:1024 lds
    v_add_f32 v234, v234, v235
    v_add_f32 v236, v236, v237
    v_add_f32 v238, v238, v239
    v_add_f32 v240, v240, v241
    v_mfma_f32_32x32x16_bf16 v[32:47], v[72:75], v[188:191], v[32:47]
    s_set_gpr_idx_on s31, gpr_idx(DST)
    s_nop 0
    v_cvt_pk_bf16_f32 v192, v234, v236
    v_cvt_pk_bf16_f32 v193, v238, v240
    s_set_gpr_idx_off
    v_mfma_f32_32x32x16_bf16 v[48:63], v[76:79], v[188:191], v[48:63]
    s_waitcnt vmcnt(4) lgkmcnt(0)
    v_mfma_f32_32x32x16_bf16 v[0:15], v[80:83], v[176:179], v[0:15]
    ds_read_b64_tr_b16 v[184:185], v246 offset:6144
    ds_read_b64_tr_b16 v[186:187], v246 offset:6656
    ds_read_b64_tr_b16 v[188:189], v247 offset:6144
    ds_read_b64_tr_b16 v[190:191], v247 offset:6656
    s_mov_b32 m0, s70
    v_mfma_f32_32x32x16_bf16 v[16:31], v[84:87], v[176:179], v[16:31]
    buffer_load_dwordx4 v226, s[4:7], s42 offen lds
    buffer_load_dwordx4 v227, s[72:75], s42 offen offset:1024 lds
    v_mfma_f32_32x32x16_bf16 v[32:47], v[80:83], v[180:183], v[32:47]
    v_mfma_f32_32x32x16_bf16 v[48:63], v[84:87], v[180:183], v[48:63]
    s_waitcnt vmcnt(4) lgkmcnt(0)
    v_mfma_f32_32x32x16_bf16 v[0:15], v[88:91], v[184:187], v[0:15]
    ds_read_b64_tr_b16 v[176:177], v246 offset:0
    ds_read_b64_tr_b16 v[178:179], v246 offset:512
    ds_read_b64_tr_b16 v[180:181], v247 offset:0
    ds_read_b64_tr_b16 v[182:183], v247 offset:512
    s_mov_b32 m0, s71
    v_mfma_f32_32x32x16_bf16 v[16:31], v[92:95], v[184:187], v[16:31]
    buffer_load_dwordx4 v228, s[4:7], s42 offen lds
    buffer_load_dwordx4 v229, s[72:75], s42 offen offset:1024 lds
    v_mfma_f32_32x32x16_bf16 v[32:47], v[88:91], v[188:191], v[32:47]
    s_nop 2
    v_mul_f32 v234, v0, v144
    v_mul_f32 v236, v8, v112
    v_fmac_f32 v234, v1, v145
    v_fmac_f32 v236, v9, v113
    v_fmac_f32 v234, v2, v146
    v_fmac_f32 v236, v10, v114
    v_fmac_f32 v234, v3, v147
    v_mfma_f32_32x32x16_bf16 v[48:63], v[92:95], v[188:191], v[48:63]
    s_setprio 0
    v_fmac_f32 v236, v11, v115
    v_fmac_f32 v234, v4, v148
    v_fmac_f32 v236, v12, v116
    v_fmac_f32 v234, v5, v149
    v_fmac_f32 v236, v13, v117
    v_fmac_f32 v234, v6, v150
    v_fmac_f32 v236, v14, v118
    v_fmac_f32 v234, v7, v151
    v_fmac_f32 v236, v15, v119
    v_mul_f32 v238, v16, v160
    v_mul_f32 v240, v24, v160
    v_fmac_f32 v238, v17, v161
    v_fmac_f32 v240, v25, v161
    v_fmac_f32 v238, v18, v162
    v_fmac_f32 v240, v26, v162
    v_fmac_f32 v238, v19, v163
    v_fmac_f32 v240, v27, v163
    v_fmac_f32 v238, v20, v164
    v_fmac_f32 v240, v28, v164
    v_fmac_f32 v238, v21, v165
    v_fmac_f32 v240, v29, v165
    v_fmac_f32 v238, v22, v166
    v_fmac_f32 v240, v30, v166
    v_fmac_f32 v238, v23, v167
    v_fmac_f32 v240, v31, v167
    v_mul_f32 v235, v32, v152
    v_mul_f32 v237, v40, v120
    v_fmac_f32 v235, v33, v153
    v_fmac_f32 v237, v41, v121
    v_fmac_f32 v235, v34, v154
    v_fmac_f32 v237, v42, v122
    v_fmac_f32 v235, v35, v155
    v_fmac_f32 v237, v43, v123
    v_fmac_f32 v235, v36, v156
    v_fmac_f32 v237, v44, v124
    v_fmac_f32 v235, v37, v157
    v_fmac_f32 v237, v45, v125
    v_fmac_f32 v235, v38, v158
    v_fmac_f32 v237, v46, v126
    v_fmac_f32 v235, v39, v159
    v_fmac_f32 v237, v47, v127
    v_mul_f32 v239, v48, v168
    v_mul_f32 v241, v56, v168
    s_setprio 1
    s_waitcnt vmcnt(4) lgkmcnt(0)
    v_mfma_f32_32x32x16_bf16 v[0:15], v[64:67], v[176:179], 0
    ds_read_b64_tr_b16 v[184:185], v246 offset:2048
    ds_read_b64_tr_b16 v[186:187], v246 offset:2560
    ds_read_b64_tr_b16 v[188:189], v247 offset:2048
    ds_read_b64_tr_b16 v[190:191], v247 offset:2560
    v_fmac_f32 v239, v49, v169
    v_fmac_f32 v241, v57, v169
    s_mov_b32 m0, s68
    v_mfma_f32_32x32x16_bf16 v[16:31], v[68:71], v[176:179], 0
    buffer_load_dwordx4 v222, s[4:7], s43 offen lds
    buffer_load_dwordx4 v223, s[72:75], s43 offen offset:1024 lds
    v_fmac_f32 v239, v50, v170
    v_fmac_f32 v241, v58, v170
    v_fmac_f32 v239, v51, v171
    v_fmac_f32 v241, v59, v171
    v_fmac_f32 v239, v52, v172
    v_mfma_f32_32x32x16_bf16 v[32:47], v[64:67], v[180:183], 0
    v_fmac_f32 v241, v60, v172
    v_fmac_f32 v239, v53, v173
    v_fmac_f32 v241, v61, v173
    v_fmac_f32 v239, v54, v174
    v_fmac_f32 v241, v62, v174
    v_fmac_f32 v239, v55, v175
    v_fmac_f32 v241, v63, v175
    v_mfma_f32_32x32x16_bf16 v[48:63], v[68:71], v[180:183], 0
    v_permlane32_swap_b32 v234, v235
    v_add_f32 v234, v234, v235
    s_waitcnt vmcnt(4) lgkmcnt(0)
    v_mfma_f32_32x32x16_bf16 v[0:15], v[72:75], v[184:187], v[0:15]
    ds_read_b64_tr_b16 v[176:177], v246 offset:4096
    ds_read_b64_tr_b16 v[178:179], v246 offset:4608
    ds_read_b64_tr_b16 v[180:181], v247 offset:4096
    ds_read_b64_tr_b16 v[182:183], v247 offset:4608
    s_mov_b32 m0, s69
    v_mfma_f32_32x32x16_bf16 v[16:31], v[76:79], v[184:187], v[16:31]
    buffer_load_dwordx4 v224, s[4:7], s43 offen lds
    buffer_load_dwordx4 v225, s[72:75], s43 offen offset:1024 lds
    v_mfma_f32_32x32x16_bf16 v[32:47], v[72:75], v[188:191], v[32:47]
    v_mfma_f32_32x32x16_bf16 v[48:63], v[76:79], v[188:191], v[48:63]
    s_waitcnt vmcnt(4) lgkmcnt(0)
    v_mfma_f32_32x32x16_bf16 v[0:15], v[80:83], v[176:179], v[0:15]
    ds_read_b64_tr_b16 v[184:185], v246 offset:6144
    ds_read_b64_tr_b16 v[186:187], v246 offset:6656
    ds_read_b64_tr_b16 v[188:189], v247 offset:6144
    ds_read_b64_tr_b16 v[190:191], v247 offset:6656
    s_mov_b32 m0, s70
    v_mfma_f32_32x32x16_bf16 v[16:31], v[84:87], v[176:179], v[16:31]
    buffer_load_dwordx4 v226, s[4:7], s43 offen lds
    buffer_load_dwordx4 v227, s[72:75], s43 offen offset:1024 lds
    v_mfma_f32_32x32x16_bf16 v[32:47], v[80:83], v[180:183], v[32:47]
    v_add_u32 v222, s48, v251
    ds_read_b32 v222, v222
    v_mfma_f32_32x32x16_bf16 v[48:63], v[84:87], v[180:183], v[48:63]
    s_waitcnt vmcnt(4) lgkmcnt(1)
    v_mfma_f32_32x32x16_bf16 v[0:15], v[88:91], v[184:187], v[0:15]
    ds_read_b64_tr_b16 v[176:177], v246 offset:0
    ds_read_b64_tr_b16 v[178:179], v246 offset:512
    ds_read_b64_tr_b16 v[180:181], v247 offset:0
    ds_read_b64_tr_b16 v[182:183], v247 offset:512
    s_mov_b32 m0, s71
    v_mfma_f32_32x32x16_bf16 v[16:31], v[92:95], v[184:187], v[16:31]
    buffer_load_dwordx4 v228, s[4:7], s43 offen lds
    buffer_load_dwordx4 v229, s[72:75], s43 offen offset:1024 lds
    s_waitcnt lgkmcnt(4)
    v_mad_u32_u16 v223, v222, s39, v248 op_sel:[1,0,0,0]
    v_mad_u32_u16 v222, v222, s39, v248
    v_mfma_f32_32x32x16_bf16 v[32:47], v[88:91], v[188:191], v[32:47]
    v_add_u32 v224, s49, v251
    ds_read_b32 v224, v224
    v_mul_f32 v242, v0, v144
    v_fma_f32 v238, v8, v160, -v238
    v_fmac_f32 v242, v1, v145
    v_fmac_f32 v238, v9, v161
    v_fmac_f32 v242, v2, v146
    v_mfma_f32_32x32x16_bf16 v[48:63], v[92:95], v[188:191], v[48:63]
    s_setprio 0
    v_fmac_f32 v238, v10, v162
    v_fmac_f32 v242, v3, v147
    v_fmac_f32 v238, v11, v163
    v_fmac_f32 v242, v4, v148
    v_fmac_f32 v238, v12, v164
    v_fmac_f32 v242, v5, v149
    v_fmac_f32 v238, v13, v165
    v_fmac_f32 v242, v6, v150
    v_fmac_f32 v238, v14, v166
    v_fmac_f32 v242, v7, v151
    v_fmac_f32 v238, v15, v167
    v_fmac_f32 v236, v16, v112
    v_mul_f32 v244, v24, v160
    v_fmac_f32 v236, v17, v113
    v_fmac_f32 v244, v25, v161
    v_fmac_f32 v236, v18, v114
    v_fmac_f32 v244, v26, v162
    v_fmac_f32 v236, v19, v115
    v_fmac_f32 v244, v27, v163
    v_fmac_f32 v236, v20, v116
    v_fmac_f32 v244, v28, v164
    v_fmac_f32 v236, v21, v117
    v_fmac_f32 v244, v29, v165
    v_fmac_f32 v236, v22, v118
    v_fmac_f32 v244, v30, v166
    v_fmac_f32 v236, v23, v119
    v_fmac_f32 v244, v31, v167
    v_mul_f32 v243, v32, v152
    v_fma_f32 v239, v40, v168, -v239
    v_fmac_f32 v243, v33, v153
    v_fmac_f32 v239, v41, v169
    v_fmac_f32 v243, v34, v154
    v_fmac_f32 v239, v42, v170
    v_fmac_f32 v243, v35, v155
    v_fmac_f32 v239, v43, v171
    v_fmac_f32 v243, v36, v156
    v_fmac_f32 v239, v44, v172
    v_fmac_f32 v243, v37, v157
    v_fmac_f32 v239, v45, v173
    v_fmac_f32 v243, v38, v158
    v_fmac_f32 v239, v46, v174
    v_fmac_f32 v243, v39, v159
    v_fmac_f32 v239, v47, v175
    v_fmac_f32 v237, v48, v120
    v_mul_f32 v245, v56, v168
    v_fmac_f32 v237, v49, v121
    v_fmac_f32 v245, v57, v169
    v_fmac_f32 v237, v50, v122
    v_fmac_f32 v245, v58, v170
    v_fmac_f32 v237, v51, v123
    s_setprio 1
    s_waitcnt vmcnt(4) lgkmcnt(1)
    v_mfma_f32_32x32x16_bf16 v[0:15], v[64:67], v[176:179], 0
    ds_read_b64_tr_b16 v[184:185], v246 offset:2048
    ds_read_b64_tr_b16 v[186:187], v246 offset:2560
    ds_read_b64_tr_b16 v[188:189], v247 offset:2048
    ds_read_b64_tr_b16 v[190:191], v247 offset:2560
    v_fmac_f32 v245, v59, v171
    v_fmac_f32 v237, v52, v124
    s_mov_b32 m0, s68
    v_mfma_f32_32x32x16_bf16 v[16:31], v[68:71], v[176:179], 0
    buffer_load_dwordx4 v222, s[4:7], s44 offen lds
    buffer_load_dwordx4 v223, s[72:75], s44 offen offset:1024 lds
    s_waitcnt lgkmcnt(4)
    v_mad_u32_u16 v225, v224, s39, v248 op_sel:[1,0,0,0]
    v_mad_u32_u16 v224, v224, s39, v248
    v_fmac_f32 v245, v60, v172
    v_fmac_f32 v237, v53, v125
    v_mfma_f32_32x32x16_bf16 v[32:47], v[64:67], v[180:183], 0
    v_add_u32 v226, s50, v251
    ds_read_b32 v226, v226
    v_fmac_f32 v245, v61, v173
    v_fmac_f32 v237, v54, v126
    v_fmac_f32 v245, v62, v174
    v_fmac_f32 v237, v55, v127
    v_fmac_f32 v245, v63, v175
    v_mfma_f32_32x32x16_bf16 v[48:63], v[68:71], v[180:183], 0
    v_permlane32_swap_b32 v238, v239
    v_permlane32_swap_b32 v242, v243
    v_add_f32 v238, v238, v239
    v_add_f32 v242, v242, v243
    s_waitcnt vmcnt(4) lgkmcnt(1)
    v_mfma_f32_32x32x16_bf16 v[0:15], v[72:75], v[184:187], v[0:15]
    ds_read_b64_tr_b16 v[176:177], v246 offset:4096
    ds_read_b64_tr_b16 v[178:179], v246 offset:4608
    ds_read_b64_tr_b16 v[180:181], v247 offset:4096
    ds_read_b64_tr_b16 v[182:183], v247 offset:4608
    s_mov_b32 m0, s69
    v_mfma_f32_32x32x16_bf16 v[16:31], v[76:79], v[184:187], v[16:31]
    buffer_load_dwordx4 v224, s[4:7], s45 offen lds
    buffer_load_dwordx4 v225, s[72:75], s45 offen offset:1024 lds
    s_waitcnt lgkmcnt(4)
    v_mad_u32_u16 v227, v226, s39, v248 op_sel:[1,0,0,0]
    v_mad_u32_u16 v226, v226, s39, v248
    v_mfma_f32_32x32x16_bf16 v[32:47], v[72:75], v[188:191], v[32:47]
    v_add_u32 v228, s51, v251
    ds_read_b32 v228, v228
    s_set_gpr_idx_on s31, gpr_idx(DST)
    s_nop 0
    v_cvt_pk_bf16_f32 v194, v234, v242
    s_set_gpr_idx_off
    v_mfma_f32_32x32x16_bf16 v[48:63], v[76:79], v[188:191], v[48:63]
    s_waitcnt vmcnt(4) lgkmcnt(1)
    v_mfma_f32_32x32x16_bf16 v[0:15], v[80:83], v[176:179], v[0:15]
    ds_read_b64_tr_b16 v[184:185], v246 offset:6144
    ds_read_b64_tr_b16 v[186:187], v246 offset:6656
    ds_read_b64_tr_b16 v[188:189], v247 offset:6144
    ds_read_b64_tr_b16 v[190:191], v247 offset:6656
    s_mov_b32 m0, s70
    v_mfma_f32_32x32x16_bf16 v[16:31], v[84:87], v[176:179], v[16:31]
    buffer_load_dwordx4 v226, s[4:7], s46 offen lds
    buffer_load_dwordx4 v227, s[72:75], s46 offen offset:1024 lds
    s_waitcnt lgkmcnt(4)
    v_mad_u32_u16 v229, v228, s39, v248 op_sel:[1,0,0,0]
    v_mad_u32_u16 v228, v228, s39, v248
    v_mfma_f32_32x32x16_bf16 v[32:47], v[80:83], v[180:183], v[32:47]
    v_mfma_f32_32x32x16_bf16 v[48:63], v[84:87], v[180:183], v[48:63]
    s_waitcnt vmcnt(4) lgkmcnt(0)
    v_mfma_f32_32x32x16_bf16 v[0:15], v[88:91], v[184:187], v[0:15]
    ds_read_b64_tr_b16 v[176:177], v246 offset:0
    ds_read_b64_tr_b16 v[178:179], v246 offset:512
    ds_read_b64_tr_b16 v[180:181], v247 offset:0
    ds_read_b64_tr_b16 v[182:183], v247 offset:512
    s_mov_b32 m0, s71
    v_mfma_f32_32x32x16_bf16 v[16:31], v[92:95], v[184:187], v[16:31]
    buffer_load_dwordx4 v228, s[4:7], s47 offen lds
    buffer_load_dwordx4 v229, s[72:75], s47 offen offset:1024 lds
    v_mfma_f32_32x32x16_bf16 v[32:47], v[88:91], v[188:191], v[32:47]
    s_nop 2
    v_mul_f32 v242, v0, v144
    v_fma_f32 v240, v8, v160, -v240
    v_fmac_f32 v242, v1, v145
    v_fmac_f32 v240, v9, v161
    v_fmac_f32 v242, v2, v146
    v_fmac_f32 v240, v10, v162
    v_fmac_f32 v242, v3, v147
    v_mfma_f32_32x32x16_bf16 v[48:63], v[92:95], v[188:191], v[48:63]
    s_setprio 0
    v_fmac_f32 v240, v11, v163
    v_fmac_f32 v242, v4, v148
    v_fmac_f32 v240, v12, v164
    v_fmac_f32 v242, v5, v149
    v_fmac_f32 v240, v13, v165
    v_fmac_f32 v242, v6, v150
    v_fmac_f32 v240, v14, v166
    v_fmac_f32 v242, v7, v151
    v_fmac_f32 v240, v15, v167
    s_sub_u32 s58, s48, s29
    v_add_u32 v249, s58, v249
    v_add_u32 v250, s58, v250
    v_fma_f32 v244, v16, v160, -v244
    v_fmac_f32 v236, v24, v112
    v_fmac_f32 v244, v17, v161
    v_fmac_f32 v236, v25, v113
    v_fmac_f32 v244, v18, v162
    v_fmac_f32 v236, v26, v114
    v_fmac_f32 v244, v19, v163
    v_fmac_f32 v236, v27, v115
    v_fmac_f32 v244, v20, v164
    v_fmac_f32 v236, v28, v116
    v_fmac_f32 v244, v21, v165
    v_fmac_f32 v236, v29, v117
    v_fmac_f32 v244, v22, v166
    v_fmac_f32 v236, v30, v118
    v_fmac_f32 v244, v23, v167
    v_fmac_f32 v236, v31, v119
    ds_read_b64_tr_b16 v[0:1], v249 offset:0
    ds_read_b64_tr_b16 v[2:3], v249 offset:128
    ds_read_b128 v[4:7], v250 offset:0
    ds_read_b128 v[8:11], v250 offset:16
    ds_read_b128 v[12:15], v250 offset:384
    ds_read_b128 v[16:19], v250 offset:400
    v_mul_f32 v243, v32, v152
    v_fma_f32 v241, v40, v168, -v241
    v_fmac_f32 v243, v33, v153
    v_fmac_f32 v241, v41, v169
    v_fmac_f32 v243, v34, v154
    v_fmac_f32 v241, v42, v170
    v_fmac_f32 v243, v35, v155
    v_fmac_f32 v241, v43, v171
    v_fmac_f32 v243, v36, v156
    v_fmac_f32 v241, v44, v172
    v_fmac_f32 v243, v37, v157
    v_fmac_f32 v241, v45, v173
    v_fmac_f32 v243, v38, v158
    v_fmac_f32 v241, v46, v174
    v_fmac_f32 v243, v39, v159
    v_fmac_f32 v241, v47, v175
    ds_read_b64_tr_b16 v[20:21], v249 offset:512
    ds_read_b64_tr_b16 v[22:23], v249 offset:640
    ds_read_b128 v[24:27], v250 offset:64
    ds_read_b128 v[28:31], v250 offset:80
    ds_read_b128 v[32:35], v250 offset:448
    ds_read_b128 v[36:39], v250 offset:464
    v_fma_f32 v245, v48, v168, -v245
    v_fmac_f32 v237, v56, v120
    v_fmac_f32 v245, v49, v169
    v_fmac_f32 v237, v57, v121
    v_fmac_f32 v245, v50, v170
    v_fmac_f32 v237, v58, v122
    v_fmac_f32 v245, v51, v171
    v_fmac_f32 v237, v59, v123
    v_fmac_f32 v245, v52, v172
    v_fmac_f32 v237, v60, v124
    v_fmac_f32 v245, v53, v173
    v_fmac_f32 v237, v61, v125
    v_fmac_f32 v245, v54, v174
    v_fmac_f32 v237, v62, v126
    v_fmac_f32 v245, v55, v175
    v_fmac_f32 v237, v63, v127
    s_cmp_lg_u32 s34, 0
    s_cbranch_scc1 K2_SWITCH
    s_mov_b32 s29, s48
    s_mov_b32 s32, s31
    s_mov_b32 s30, s3
    s_mov_b32 s31, s35
    s_cmp_eq_u32 s33, 2
    s_cbranch_scc1 K2_U20
    s_cmp_eq_u32 s33, 3
    s_cbranch_scc1 K2_U30
    s_cmp_eq_u32 s33, 1
    s_cbranch_scc1 K2_U10
    s_branch K2_U40
K2_U11:
    s_setprio 1
    v_mov_b32 v254, 163648
    v_mov_b32 v255, 1
    v_lshl_add_u32 v233, v252, 1, s53
    s_mov_b64 exec, 1
    ds_add_rtn_u32 v232, v254, v255
    s_mov_b64 exec, -1
    ds_read_b32 v233, v233
    s_waitcnt lgkmcnt(12)
    v_lshlrev_b32 v40, 16, v0
    v_and_b32 v41, 0xffff0000, v0
    v_lshlrev_b32 v42, 16, v1
    v_and_b32 v43, 0xffff0000, v1
    v_lshlrev_b32 v44, 16, v2
    v_and_b32 v45, 0xffff0000, v2
    v_lshlrev_b32 v46, 16, v3
    v_and_b32 v47, 0xffff0000, v3
    s_waitcnt lgkmcnt(10)
    v_mul_f32 v4, v40, v4
    v_mul_f32 v5, v41, v5
    v_mul_f32 v6, v42, v6
    v_mul_f32 v7, v43, v7
    v_mul_f32 v8, v44, v8
    v_mul_f32 v9, v45, v9
    v_mul_f32 v10, v46, v10
    v_mul_f32 v11, v47, v11
    v_cvt_pk_bf16_f32 v64, v4, v5
    v_cvt_pk_bf16_f32 v65, v6, v7
    v_cvt_pk_bf16_f32 v66, v8, v9
    v_cvt_pk_bf16_f32 v67, v10, v11
    s_waitcnt lgkmcnt(8)
    v_mul_f32 v12, v40, v12
    v_mul_f32 v13, v41, v13
    v_mul_f32 v14, v42, v14
    v_mul_f32 v15, v43, v15
    v_mul_f32 v16, v44, v16
    v_mul_f32 v17, v45, v17
    v_mul_f32 v18, v46, v18
    v_mul_f32 v19, v47, v19
    v_cvt_pk_bf16_f32 v68, v12, v13
    v_cvt_pk_bf16_f32 v69, v14, v15
    v_cvt_pk_bf16_f32 v70, v16, v17
    v_cvt_pk_bf16_f32 v71, v18, v19
    s_waitcnt lgkmcnt(0)
    v_readfirstlane_b32 s58, v232
    s_nop 0
    s_cmp_lt_u32 s58, s22
    s_cbranch_scc0 K2_nul_94
    s_and_b32 s59, s58, 7
    s_lshr_b32 s60, s58, 3
K2_chk_96:
    v_readlane_b32 s61, v233, s59
    s_nop 0
    s_cmp_gt_u32 s61, s60
    s_cbranch_scc0 K2_spin_95
K2_back_97:
    v_readlane_b32 s3, v253, s58
    s_lshl_b32 s44, s34, 7
    s_lshl_b32 s60, s58, 5
    s_and_b32 s48, s3, 0x3ffff
    s_bfe_u32 s33, s3, 0x30012
    s_sub_u32 s60, s60, s48
    s_and_b32 s60, s60, 0xff
    s_add_u32 s35, s60, s48
    s_mov_b32 s45, s44
    s_add_u32 s47, s44, 256
    s_add_u32 s49, s48, 32
    s_add_u32 s60, s48, 64
    s_cmp_eq_u32 s33, 3
    s_cselect_b32 s46, s44, s47
    s_cselect_b32 s50, s60, s48
    s_cselect_b32 s51, s48, s49
    s_sub_u32 s60, s33, 2
    s_cmp_lt_u32 s60, 2
    s_cbranch_scc0 K2_rare_98
K2_back_99:
    v_add_u32 v222, s48, v251
    ds_read_b32 v222, v222
    v_add_u32 v224, s49, v251
    ds_read_b32 v224, v224
    v_add_u32 v226, s50, v251
    ds_read_b32 v226, v226
    v_add_u32 v228, s51, v251
    ds_read_b32 v228, v228
    s_waitcnt lgkmcnt(3)
    v_mad_u32_u16 v223, v222, s39, v248 op_sel:[1,0,0,0]
    v_mad_u32_u16 v222, v222, s39, v248
    s_waitcnt lgkmcnt(2)
    v_mad_u32_u16 v225, v224, s39, v248 op_sel:[1,0,0,0]
    v_mad_u32_u16 v224, v224, s39, v248
    s_waitcnt lgkmcnt(1)
    v_mad_u32_u16 v227, v226, s39, v248 op_sel:[1,0,0,0]
    v_mad_u32_u16 v226, v226, s39, v248
    s_waitcnt lgkmcnt(0)
    v_mad_u32_u16 v229, v228, s39, v248 op_sel:[1,0,0,0]
    v_mad_u32_u16 v228, v228, s39, v248
    s_waitcnt vmcnt(4)
    v_mfma_f32_32x32x16_bf16 v[0:15], v[64:67], v[176:179], 0
    ds_read_b64_tr_b16 v[184:185], v246 offset:2048
    ds_read_b64_tr_b16 v[186:187], v246 offset:2560
    ds_read_b64_tr_b16 v[188:189], v247 offset:2048
    ds_read_b64_tr_b16 v[190:191], v247 offset:2560
    s_mov_b32 m0, s68
    v_mfma_f32_32x32x16_bf16 v[16:31], v[68:71], v[176:179], 0
    buffer_load_dwordx4 v222, s[4:7], s44 offen lds
    buffer_load_dwordx4 v223, s[72:75], s44 offen offset:1024 lds
    v_permlane32_swap_b32 v242, v243
    v_permlane32_swap_b32 v240, v241
    v_mfma_f32_32x32x16_bf16 v[32:47], v[64:67], v[180:183], 0
    v_permlane32_swap_b32 v236, v237
    v_permlane32_swap_b32 v244, v245
    v_add_f32 v242, v242, v243
    v_add_f32 v240, -v240, -v241
    v_add_f32 v236, v236, v237
    v_mfma_f32_32x32x16_bf16 v[48:63], v[68:71], v[180:183], 0
    s_setprio 0
    v_add_f32 v244, v244, v245
    v_cvt_pk_bf16_f32 v242, v242, v236
    v_cvt_pk_bf16_f32 v244, v244, v240
    v_cvt_pk_bf16_f32 v238, v238, v238
    ds_write_b16 v230, v242 offset:1152
    ds_write_b16_d16_hi v230, v242 offset:128
    ds_write_b16 v230, v244 offset:512
    ds_write_b16_d16_hi v230, v244 offset:896
    ds_write_b16 v230, v238 offset:1280
    v_mul_f32 v234, v0, v96
    v_mul_f32 v236, v8, v128
    v_fmac_f32 v234, v1, v97
    v_fmac_f32 v236, v9, v129
    v_fmac_f32 v234, v2, v98
    v_fmac_f32 v236, v10, v130
    v_fmac_f32 v234, v3, v99
    v_fmac_f32 v236, v11, v131
    v_fmac_f32 v234, v4, v100
    v_fmac_f32 v236, v12, v132
    v_fmac_f32 v234, v5, v101
    v_fmac_f32 v236, v13, v133
    v_fmac_f32 v234, v6, v102
    v_fmac_f32 v236, v14, v134
    v_fmac_f32 v234, v7, v103
    v_fmac_f32 v236, v15, v135
    v_mul_f32 v238, v16, v128
    v_mul_f32 v240, v24, v128
    v_fmac_f32 v238, v17, v129
    v_fmac_f32 v240, v25, v129
    v_fmac_f32 v238, v18, v130
    v_fmac_f32 v240, v26, v130
    v_fmac_f32 v238, v19, v131
    v_fmac_f32 v240, v27, v131
    v_fmac_f32 v238, v20, v132
    v_fmac_f32 v240, v28, v132
    v_fmac_f32 v238, v21, v133
    v_fmac_f32 v240, v29, v133
    v_fmac_f32 v238, v22, v134
    v_fmac_f32 v240, v30, v134
    v_fmac_f32 v238, v23, v135
    v_fmac_f32 v240, v31, v135
    v_mul_f32 v235, v32, v104
    v_mul_f32 v237, v40, v136
    v_fmac_f32 v235, v33, v105
    v_fmac_f32 v237, v41, v137
    v_fmac_f32 v235, v34, v106
    v_fmac_f32 v237, v42, v138
    v_fmac_f32 v235, v35, v107
    v_fmac_f32 v237, v43, v139
    v_fmac_f32 v235, v36, v108
    v_fmac_f32 v237, v44, v140
    v_fmac_f32 v235, v37, v109
    v_fmac_f32 v237, v45, v141
    v_fmac_f32 v235, v38, v110
    v_fmac_f32 v237, v46, v142
    v_fmac_f32 v235, v39, v111
    v_fmac_f32 v237, v47, v143
    v_mul_f32 v239, v48, v136
    v_mul_f32 v241, v56, v136
    v_fmac_f32 v239, v49, v137
    v_fmac_f32 v241, v57, v137
    v_fmac_f32 v239, v50, v138
    v_fmac_f32 v241, v58, v138
    v_fmac_f32 v239, v51, v139
    v_fmac_f32 v241, v59, v139
    v_fmac_f32 v239, v52, v140
    v_fmac_f32 v241, v60, v140
    v_fmac_f32 v239, v53, v141
    v_fmac_f32 v241, v61, v141
    v_fmac_f32 v239, v54, v142
    v_fmac_f32 v241, v62, v142
    v_fmac_f32 v239, v55, v143
    v_fmac_f32 v241, v63, v143
    s_setprio 1
    s_waitcnt vmcnt(4) lgkmcnt(5)
    v_mfma_f32_32x32x16_bf16 v[0:15], v[64:67], v[184:187], 0
    ds_read_b64_tr_b16 v[176:177], v246 offset:4096
    ds_read_b64_tr_b16 v[178:179], v246 offset:4608
    ds_read_b64_tr_b16 v[180:181], v247 offset:4096
    ds_read_b64_tr_b16 v[182:183], v247 offset:4608
    s_mov_b32 m0, s69
    v_mfma_f32_32x32x16_bf16 v[16:31], v[68:71], v[184:187], 0
    buffer_load_dwordx4 v224, s[4:7], s45 offen lds
    buffer_load_dwordx4 v225, s[72:75], s45 offen offset:1024 lds
    v_permlane32_swap_b32 v234, v235
    v_permlane32_swap_b32 v236, v237
    v_mfma_f32_32x32x16_bf16 v[32:47], v[64:67], v[188:191], 0
    v_permlane32_swap_b32 v238, v239
    v_permlane32_swap_b32 v240, v241
    v_add_u32 v230, s31, v252
    v_add_f32 v234, v234, v235
    v_add_f32 v236, v236, v237
    v_mfma_f32_32x32x16_bf16 v[48:63], v[68:71], v[188:191], 0
    s_setprio 0
    v_add_f32 v238, v238, v239
    v_add_f32 v240, v240, v241
    v_cvt_pk_bf16_f32 v234, v234, v236
    v_cvt_pk_bf16_f32 v238, v238, v240
    ds_write_b16 v230, v234 offset:0
    ds_write_b16_d16_hi v230, v234 offset:256
    ds_write_b16 v230, v238 offset:640
    ds_write_b16_d16_hi v230, v238 offset:1024
    v_mul_f32 v234, v0, v144
    v_mul_f32 v236, v8, v112
    v_fmac_f32 v234, v1, v145
    v_fmac_f32 v236, v9, v113
    v_fmac_f32 v234, v2, v146
    v_fmac_f32 v236, v10, v114
    v_fmac_f32 v234, v3, v147
    v_fmac_f32 v236, v11, v115
    v_fmac_f32 v234, v4, v148
    v_fmac_f32 v236, v12, v116
    v_fmac_f32 v234, v5, v149
    v_fmac_f32 v236, v13, v117
    v_fmac_f32 v234, v6, v150
    v_fmac_f32 v236, v14, v118
    v_fmac_f32 v234, v7, v151
    v_fmac_f32 v236, v15, v119
    v_mul_f32 v238, v16, v160
    v_mul_f32 v240, v24, v160
    v_fmac_f32 v238, v17, v161
    v_fmac_f32 v240, v25, v161
    v_fmac_f32 v238, v18, v162
    v_fmac_f32 v240, v26, v162
    v_fmac_f32 v238, v19, v163
    v_fmac_f32 v240, v27, v163
    v_fmac_f32 v238, v20, v164
    v_fmac_f32 v240, v28, v164
    v_fmac_f32 v238, v21, v165
    v_fmac_f32 v240, v29, v165
    v_fmac_f32 v238, v22, v166
    v_fmac_f32 v240, v30, v166
    v_fmac_f32 v238, v23, v167
    v_fmac_f32 v240, v31, v167
    v_mul_f32 v235, v32, v152
    v_mul_f32 v237, v40, v120
    v_fmac_f32 v235, v33, v153
    v_fmac_f32 v237, v41, v121
    v_fmac_f32 v235, v34, v154
    v_fmac_f32 v237, v42, v122
    v_fmac_f32 v235, v35, v155
    v_fmac_f32 v237, v43, v123
    v_fmac_f32 v235, v36, v156
    v_fmac_f32 v237, v44, v124
    v_fmac_f32 v235, v37, v157
    v_fmac_f32 v237, v45, v125
    v_fmac_f32 v235, v38, v158
    v_fmac_f32 v237, v46, v126
    v_fmac_f32 v235, v39, v159
    v_fmac_f32 v237, v47, v127
    v_mul_f32 v239, v48, v168
    v_mul_f32 v241, v56, v168
    v_fmac_f32 v239, v49, v169
    v_fmac_f32 v241, v57, v169
    v_fmac_f32 v239, v50, v170
    v_fmac_f32 v241, v58, v170
    v_fmac_f32 v239, v51, v171
    v_fmac_f32 v241, v59, v171
    v_fmac_f32 v239, v52, v172
    v_fmac_f32 v241, v60, v172
    v_fmac_f32 v239, v53, v173
    v_fmac_f32 v241, v61, v173
    v_fmac_f32 v239, v54, v174
    v_fmac_f32 v241, v62, v174
    v_fmac_f32 v239, v55, v175
    v_fmac_f32 v241, v63, v175
    s_setprio 1
    s_waitcnt vmcnt(4) lgkmcnt(4)
    v_mfma_f32_32x32x16_bf16 v[0:15], v[64:67], v[176:179], 0
    ds_read_b64_tr_b16 v[184:185], v246 offset:6144
    ds_read_b64_tr_b16 v[186:187], v246 offset:6656
    ds_read_b64_tr_b16 v[188:189], v247 offset:6144
    ds_read_b64_tr_b16 v[190:191], v247 offset:6656
    s_mov_b32 m0, s70
    v_mfma_f32_32x32x16_bf16 v[16:31], v[68:71], v[176:179], 0
    buffer_load_dwordx4 v226, s[4:7], s46 offen lds
    buffer_load_dwordx4 v227, s[72:75], s46 offen offset:1024 lds
    v_permlane32_swap_b32 v234, v235
    v_add_f32 v234, v234, v235
    v_mfma_f32_32x32x16_bf16 v[32:47], v[64:67], v[180:183], 0
    v_mfma_f32_32x32x16_bf16 v[48:63], v[68:71], v[180:183], 0
    s_setprio 0
    v_mul_f32 v242, v0, v144
    v_fma_f32 v238, v8, v160, -v238
    v_fmac_f32 v242, v1, v145
    v_fmac_f32 v238, v9, v161
    v_fmac_f32 v242, v2, v146
    v_fmac_f32 v238, v10, v162
    v_fmac_f32 v242, v3, v147
    v_fmac_f32 v238, v11, v163
    v_fmac_f32 v242, v4, v148
    v_fmac_f32 v238, v12, v164
    v_fmac_f32 v242, v5, v149
    v_fmac_f32 v238, v13, v165
    v_fmac_f32 v242, v6, v150
    v_fmac_f32 v238, v14, v166
    v_fmac_f32 v242, v7, v151
    v_fmac_f32 v238, v15, v167
    v_fmac_f32 v236, v16, v112
    v_mul_f32 v244, v24, v160
    v_fmac_f32 v236, v17, v113
    v_fmac_f32 v244, v25, v161
    v_fmac_f32 v236, v18, v114
    v_fmac_f32 v244, v26, v162
    v_fmac_f32 v236, v19, v115
    v_fmac_f32 v244, v27, v163
    v_fmac_f32 v236, v20, v116
    v_fmac_f32 v244, v28, v164
    v_fmac_f32 v236, v21, v117
    v_fmac_f32 v244, v29, v165
    v_fmac_f32 v236, v22, v118
    v_fmac_f32 v244, v30, v166
    v_fmac_f32 v236, v23, v119
    v_fmac_f32 v244, v31, v167
    v_mul_f32 v243, v32, v152
    v_fma_f32 v239, v40, v168, -v239
    v_fmac_f32 v243, v33, v153
    v_fmac_f32 v239, v41, v169
    v_fmac_f32 v243, v34, v154
    v_fmac_f32 v239, v42, v170
    v_fmac_f32 v243, v35, v155
    v_fmac_f32 v239, v43, v171
    v_fmac_f32 v243, v36, v156
    v_fmac_f32 v239, v44, v172
    v_fmac_f32 v243, v37, v157
    v_fmac_f32 v239, v45, v173
    v_fmac_f32 v243, v38, v158
    v_fmac_f32 v239, v46, v174
    v_fmac_f32 v243, v39, v159
    v_fmac_f32 v239, v47, v175
    v_fmac_f32 v237, v48, v120
    v_mul_f32 v245, v56, v168
    v_fmac_f32 v237, v49, v121
    v_fmac_f32 v245, v57, v169
    v_fmac_f32 v237, v50, v122
    v_fmac_f32 v245, v58, v170
    v_fmac_f32 v237, v51, v123
    v_fmac_f32 v245, v59, v171
    v_fmac_f32 v237, v52, v124
    v_fmac_f32 v245, v60, v172
    v_fmac_f32 v237, v53, v125
    v_fmac_f32 v245, v61, v173
    v_fmac_f32 v237, v54, v126
    v_fmac_f32 v245, v62, v174
    v_fmac_f32 v237, v55, v127
    v_fmac_f32 v245, v63, v175
    s_setprio 1
    s_waitcnt vmcnt(4) lgkmcnt(0)
    v_mfma_f32_32x32x16_bf16 v[0:15], v[64:67], v[184:187], 0
    ds_read_b64_tr_b16 v[176:177], v246 offset:0
    ds_read_b64_tr_b16 v[178:179], v246 offset:512
    ds_read_b64_tr_b16 v[180:181], v247 offset:0
    ds_read_b64_tr_b16 v[182:183], v247 offset:512
    s_mov_b32 m0, s71
    v_mfma_f32_32x32x16_bf16 v[16:31], v[68:71], v[184:187], 0
    buffer_load_dwordx4 v228, s[4:7], s47 offen lds
    buffer_load_dwordx4 v229, s[72:75], s47 offen offset:1024 lds
    v_permlane32_swap_b32 v238, v239
    v_permlane32_swap_b32 v242, v243
    v_add_f32 v238, v238, v239
    v_mfma_f32_32x32x16_bf16 v[32:47], v[64:67], v[188:191], 0
    v_add_f32 v242, v242, v243
    v_cvt_pk_bf16_f32 v234, v234, v242
    ds_write_b16 v230, v234 offset:384
    ds_write_b16_d16_hi v230, v234 offset:768
    v_mfma_f32_32x32x16_bf16 v[48:63], v[68:71], v[188:191], 0
    s_setprio 0
    v_mul_f32 v242, v0, v144
    v_fma_f32 v240, v8, v160, -v240
    v_fmac_f32 v242, v1, v145
    v_fmac_f32 v240, v9, v161
    v_fmac_f32 v242, v2, v146
    v_fmac_f32 v240, v10, v162
    v_fmac_f32 v242, v3, v147
    v_fmac_f32 v240, v11, v163
    v_fmac_f32 v242, v4, v148
    v_fmac_f32 v240, v12, v164
    v_fmac_f32 v242, v5, v149
    v_fmac_f32 v240, v13, v165
    v_fmac_f32 v242, v6, v150
    v_fmac_f32 v240, v14, v166
    v_fmac_f32 v242, v7, v151
    v_fmac_f32 v240, v15, v167
    s_sub_u32 s58, s48, s29
    v_add_u32 v249, s58, v249
    v_add_u32 v250, s58, v250
    v_fma_f32 v244, v16, v160, -v244
    v_fmac_f32 v236, v24, v112
    v_fmac_f32 v244, v17, v161
    v_fmac_f32 v236, v25, v113
    v_fmac_f32 v244, v18, v162
    v_fmac_f32 v236, v26, v114
    v_fmac_f32 v244, v19, v163
    v_fmac_f32 v236, v27, v115
    v_fmac_f32 v244, v20, v164
    v_fmac_f32 v236, v28, v116
    v_fmac_f32 v244, v21, v165
    v_fmac_f32 v236, v29, v117
    v_fmac_f32 v244, v22, v166
    v_fmac_f32 v236, v30, v118
    v_fmac_f32 v244, v23, v167
    v_fmac_f32 v236, v31, v119
    ds_read_b64_tr_b16 v[0:1], v249 offset:0
    ds_read_b64_tr_b16 v[2:3], v249 offset:128
    ds_read_b128 v[4:7], v250 offset:0
    ds_read_b128 v[8:11], v250 offset:16
    ds_read_b128 v[12:15], v250 offset:384
    ds_read_b128 v[16:19], v250 offset:400
    v_mul_f32 v243, v32, v152
    v_fma_f32 v241, v40, v168, -v241
    v_fmac_f32 v243, v33, v153
    v_fmac_f32 v241, v41, v169
    v_fmac_f32 v243, v34, v154
    v_fmac_f32 v241, v42, v170
    v_fmac_f32 v243, v35, v155
    v_fmac_f32 v241, v43, v171
    v_fmac_f32 v243, v36, v156
    v_fmac_f32 v241, v44, v172
    v_fmac_f32 v243, v37, v157
    v_fmac_f32 v241, v45, v173
    v_fmac_f32 v243, v38, v158
    v_fmac_f32 v241, v46, v174
    v_fmac_f32 v243, v39, v159
    v_fmac_f32 v241, v47, v175
    ds_read_b64_tr_b16 v[20:21], v249 offset:512
    ds_read_b64_tr_b16 v[22:23], v249 offset:640
    ds_read_b128 v[24:27], v250 offset:64
    ds_read_b128 v[28:31], v250 offset:80
    ds_read_b128 v[32:35], v250 offset:448
    ds_read_b128 v[36:39], v250 offset:464
    v_fma_f32 v245, v48, v168, -v245
    v_fmac_f32 v237, v56, v120
    v_fmac_f32 v245, v49, v169
    v_fmac_f32 v237, v57, v121
    v_fmac_f32 v245, v50, v170
    v_fmac_f32 v237, v58, v122
    v_fmac_f32 v245, v51, v171
    v_fmac_f32 v237, v59, v123
    v_fmac_f32 v245, v52, v172
    v_fmac_f32 v237, v60, v124
    v_fmac_f32 v245, v53, v173
    v_fmac_f32 v237, v61, v125
    v_fmac_f32 v245, v54, v174
    v_fmac_f32 v237, v62, v126
    v_fmac_f32 v245, v55, v175
    v_fmac_f32 v237, v63, v127
    s_cmp_eq_u32 s36, 0
    s_cbranch_scc1 K2_TAIL
    s_mov_b32 s29, s48
    s_mov_b32 s32, s31
    s_mov_b32 s30, s3
    s_mov_b32 s31, s35
    s_cmp_eq_u32 s33, 2
    s_cbranch_scc1 K2_U21
    s_cmp_eq_u32 s33, 3
    s_cbranch_scc1 K2_U31
    s_cmp_eq_u32 s33, 1
    s_cbranch_scc1 K2_U11
    s_branch K2_U41
K2_U41:
    s_setprio 1
    s_waitcnt lgkmcnt(10)
    v_lshlrev_b32 v40, 16, v0
    v_and_b32 v41, 0xffff0000, v0
    v_lshlrev_b32 v42, 16, v1
    v_and_b32 v43, 0xffff0000, v1
    v_lshlrev_b32 v44, 16, v2
    v_and_b32 v45, 0xffff0000, v2
    v_lshlrev_b32 v46, 16, v3
    v_and_b32 v47, 0xffff0000, v3
    s_waitcnt lgkmcnt(8)
    v_mul_f32 v4, v40, v4
    v_mul_f32 v5, v41, v5
    v_mul_f32 v6, v42, v6
    v_mul_f32 v7, v43, v7
    v_mul_f32 v8, v44, v8
    v_mul_f32 v9, v45, v9
    v_mul_f32 v10, v46, v10
    v_mul_f32 v11, v47, v11
    v_cvt_pk_bf16_f32 v64, v4, v5
    v_cvt_pk_bf16_f32 v65, v6, v7
    v_cvt_pk_bf16_f32 v66, v8, v9
    v_cvt_pk_bf16_f32 v67, v10, v11
    s_waitcnt lgkmcnt(6)
    v_mul_f32 v12, v40, v12
    v_mul_f32 v13, v41, v13
    v_mul_f32 v14, v42, v14
    v_mul_f32 v15, v43, v15
    v_mul_f32 v16, v44, v16
    v_mul_f32 v17, v45, v17
    v_mul_f32 v18, v46, v18
    v_mul_f32 v19, v47, v19
    v_cvt_pk_bf16_f32 v68, v12, v13
    v_cvt_pk_bf16_f32 v69, v14, v15
    v_cvt_pk_bf16_f32 v70, v16, v17
    v_cvt_pk_bf16_f32 v71, v18, v19
    ds_read_b64_tr_b16 v[0:1], v249 offset:1024
    ds_read_b64_tr_b16 v[2:3], v249 offset:1152
    ds_read_b128 v[4:7], v250 offset:128
    ds_read_b128 v[8:11], v250 offset:144
    ds_read_b128 v[12:15], v250 offset:512
    ds_read_b128 v[16:19], v250 offset:528
    s_waitcnt lgkmcnt(10)
    v_lshlrev_b32 v48, 16, v20
    v_and_b32 v49, 0xffff0000, v20
    v_lshlrev_b32 v50, 16, v21
    v_and_b32 v51, 0xffff0000, v21
    v_lshlrev_b32 v52, 16, v22
    v_and_b32 v53, 0xffff0000, v22
    v_lshlrev_b32 v54, 16, v23
    v_and_b32 v55, 0xffff0000, v23
    s_waitcnt lgkmcnt(8)
    v_mul_f32 v24, v48, v24
    v_mul_f32 v25, v49, v25
    v_mul_f32 v26, v50, v26
    v_mul_f32 v27, v51, v27
    v_mul_f32 v28, v52, v28
    v_mul_f32 v29, v53, v29
    v_mul_f32 v30, v54, v30
    v_mul_f32 v31, v55, v31
    v_cvt_pk_bf16_f32 v72, v24, v25
    v_cvt_pk_bf16_f32 v73, v26, v27
    v_cvt_pk_bf16_f32 v74, v28, v29
    v_cvt_pk_bf16_f32 v75, v30, v31
    s_waitcnt lgkmcnt(6)
    v_mul_f32 v32, v48, v32
    v_mul_f32 v33, v49, v33
    v_mul_f32 v34, v50, v34
    v_mul_f32 v35, v51, v35
    v_mul_f32 v36, v52, v36
    v_mul_f32 v37, v53, v37
    v_mul_f32 v38, v54, v38
    v_mul_f32 v39, v55, v39
    v_cvt_pk_bf16_f32 v76, v32, v33
    v_cvt_pk_bf16_f32 v77, v34, v35
    v_cvt_pk_bf16_f32 v78, v36, v37
    v_cvt_pk_bf16_f32 v79, v38, v39
    s_lshr_b32 s65, s30, 27
    s_mov_b32 s66, 161536
    s_cmp_ge_u32 s65, 2
    s_cselect_b32 s66, 158112, s66
    s_mul_i32 s65, s65, 512
    s_add_u32 s65, s65, s66
    s_sub_u32 s65, s65, s29
    v_add_u32 v56, s65, v249
    s_lshr_b32 s65, s30, 27
    s_mov_b32 s66, 161536
    s_cmp_ge_u32 s65, 2
    s_cselect_b32 s66, 159008, s66
    s_mul_i32 s65, s65, 64
    s_add_u32 s65, s65, s66
    s_sub_u32 s65, s65, s29
    v_add_u32 v57, s65, v250
    ds_read_b64_tr_b16 v[20:21], v56 offset:0
    ds_read_b64_tr_b16 v[22:23], v56 offset:128
    ds_read_b128 v[24:27], v57 offset:0
    ds_read_b128 v[28:31], v57 offset:16
    ds_read_b128 v[32:35], v57 offset:384
    ds_read_b128 v[36:39], v57 offset:400
    s_waitcnt lgkmcnt(10)
    v_lshlrev_b32 v40, 16, v0
    v_and_b32 v41, 0xffff0000, v0
    v_lshlrev_b32 v42, 16, v1
    v_and_b32 v43, 0xffff0000, v1
    v_lshlrev_b32 v44, 16, v2
    v_and_b32 v45, 0xffff0000, v2
    v_lshlrev_b32 v46, 16, v3
    v_and_b32 v47, 0xffff0000, v3
    s_waitcnt lgkmcnt(8)
    v_mul_f32 v4, v40, v4
    v_mul_f32 v5, v41, v5
    v_mul_f32 v6, v42, v6
    v_mul_f32 v7, v43, v7
    v_mul_f32 v8, v44, v8
    v_mul_f32 v9, v45, v9
    v_mul_f32 v10, v46, v10
    v_mul_f32 v11, v47, v11
    v_cvt_pk_bf16_f32 v80, v4, v5
    v_cvt_pk_bf16_f32 v81, v6, v7
    v_cvt_pk_bf16_f32 v82, v8, v9
    v_cvt_pk_bf16_f32 v83, v10, v11
    s_waitcnt lgkmcnt(6)
    v_mul_f32 v12, v40, v12
    v_mul_f32 v13, v41, v13
    v_mul_f32 v14, v42, v14
    v_mul_f32 v15, v43, v15
    v_mul_f32 v16, v44, v16
    v_mul_f32 v17, v45, v17
    v_mul_f32 v18, v46, v18
    v_mul_f32 v19, v47, v19
    v_cvt_pk_bf16_f32 v84, v12, v13
    v_cvt_pk_bf16_f32 v85, v14, v15
    v_cvt_pk_bf16_f32 v86, v16, v17
    v_cvt_pk_bf16_f32 v87, v18, v19
    s_waitcnt lgkmcnt(4)
    v_lshlrev_b32 v48, 16, v20
    v_and_b32 v49, 0xffff0000, v20
    v_lshlrev_b32 v50, 16, v21
    v_and_b32 v51, 0xffff0000, v21
    v_lshlrev_b32 v52, 16, v22
    v_and_b32 v53, 0xffff0000, v22
    v_lshlrev_b32 v54, 16, v23
    v_and_b32 v55, 0xffff0000, v23
    s_waitcnt lgkmcnt(2)
    v_mul_f32 v24, v48, v24
    v_mul_f32 v25, v49, v25
    v_mul_f32 v26, v50, v26
    v_mul_f32 v27, v51, v27
    v_mul_f32 v28, v52, v28
    v_mul_f32 v29, v53, v29
    v_mul_f32 v30, v54, v30
    v_mul_f32 v31, v55, v31
    v_cvt_pk_bf16_f32 v88, v24, v25
    v_cvt_pk_bf16_f32 v89, v26, v27
    v_cvt_pk_bf16_f32 v90, v28, v29
    v_cvt_pk_bf16_f32 v91, v30, v31
    s_waitcnt lgkmcnt(0)
    v_mul_f32 v32, v48, v32
    v_mul_f32 v33, v49, v33
    v_mul_f32 v34, v50, v34
    v_mul_f32 v35, v51, v35
    v_mul_f32 v36, v52, v36
    v_mul_f32 v37, v53, v37
    v_mul_f32 v38, v54, v38
    v_mul_f32 v39, v55, v39
    v_cvt_pk_bf16_f32 v92, v32, v33
    v_cvt_pk_bf16_f32 v93, v34, v35
    v_cvt_pk_bf16_f32 v94, v36, v37
    v_cvt_pk_bf16_f32 v95, v38, v39
    s_waitcnt vmcnt(4)
    v_mfma_f32_32x32x16_bf16 v[0:15], v[64:67], v[176:179], 0
    ds_read_b64_tr_b16 v[184:185], v246 offset:2048
    ds_read_b64_tr_b16 v[186:187], v246 offset:2560
    ds_read_b64_tr_b16 v[188:189], v247 offset:2048
    ds_read_b64_tr_b16 v[190:191], v247 offset:2560
    s_mov_b32 m0, s68
    v_mfma_f32_32x32x16_bf16 v[16:31], v[68:71], v[176:179], 0
    buffer_load_dwordx4 v222, s[4:7], s41 offen lds
    buffer_load_dwordx4 v223, s[72:75], s41 offen offset:1024 lds
    v_permlane32_swap_b32 v242, v243
    v_permlane32_swap_b32 v240, v241
    v_mov_b32 v254, 163648
    v_mfma_f32_32x32x16_bf16 v[32:47], v[64:67], v[180:183], 0
    v_permlane32_swap_b32 v236, v237
    v_permlane32_swap_b32 v244, v245
    v_add_f32 v242, v242, v243
    v_add_f32 v240, -v240, -v241
    v_add_f32 v236, v236, v237
    v_mfma_f32_32x32x16_bf16 v[48:63], v[68:71], v[180:183], 0
    v_add_f32 v244, v244, v245
    v_cvt_pk_bf16_f32 v242, v242, v236
    v_cvt_pk_bf16_f32 v244, v244, v240
    v_cvt_pk_bf16_f32 v238, v238, v238
    ds_write_b16 v230, v242 offset:1152
    ds_write_b16_d16_hi v230, v242 offset:128
    v_mov_b32 v255, 1
    v_lshl_add_u32 v233, v252, 1, s53
    s_mov_b64 exec, 1
    ds_add_rtn_u32 v232, v254, v255
    s_mov_b64 exec, -1
    ds_read_b32 v233, v233
    s_waitcnt vmcnt(4) lgkmcnt(4)
    v_mfma_f32_32x32x16_bf16 v[0:15], v[72:75], v[184:187], v[0:15]
    ds_read_b64_tr_b16 v[176:177], v246 offset:4096
    ds_read_b64_tr_b16 v[178:179], v246 offset:4608
    ds_read_b64_tr_b16 v[180:181], v247 offset:4096
    ds_read_b64_tr_b16 v[182:183], v247 offset:4608
    ds_write_b16 v230, v244 offset:512
    ds_write_b16_d16_hi v230, v244 offset:896
    s_mov_b32 m0, s69
    v_mfma_f32_32x32x16_bf16 v[16:31], v[76:79], v[184:187], v[16:31]
    buffer_load_dwordx4 v224, s[4:7], s41 offen lds
    buffer_load_dwordx4 v225, s[72:75], s41 offen offset:1024 lds
    ds_write_b16 v230, v238 offset:1280
    s_waitcnt lgkmcnt(7)
    v_readfirstlane_b32 s58, v232
    v_mfma_f32_32x32x16_bf16 v[32:47], v[72:75], v[188:191], v[32:47]
    s_cmp_lt_u32 s58, s22
    s_cbranch_scc0 K2_nul_101
    s_and_b32 s59, s58, 7
    s_lshr_b32 s60, s58, 3
K2_chk_103:
    v_readlane_b32 s61, v233, s59
    s_nop 0
    s_cmp_gt_u32 s61, s60
    s_cbranch_scc0 K2_spin_102
K2_back_104:
    v_mfma_f32_32x32x16_bf16 v[48:63], v[76:79], v[188:191], v[48:63]
    v_readlane_b32 s3, v253, s58
    s_lshl_b32 s44, s34, 7
    s_lshl_b32 s60, s58, 5
    s_and_b32 s48, s3, 0x3ffff
    s_bfe_u32 s33, s3, 0x30012
    s_sub_u32 s60, s60, s48
    s_waitcnt vmcnt(4) lgkmcnt(3)
    v_mfma_f32_32x32x16_bf16 v[0:15], v[80:83], v[176:179], v[0:15]
    ds_read_b64_tr_b16 v[184:185], v246 offset:6144
    ds_read_b64_tr_b16 v[186:187], v246 offset:6656
    ds_read_b64_tr_b16 v[188:189], v247 offset:6144
    ds_read_b64_tr_b16 v[190:191], v247 offset:6656
    s_and_b32 s60, s60, 0xff
    s_add_u32 s35, s60, s48
    s_mov_b32 m0, s70
    v_mfma_f32_32x32x16_bf16 v[16:31], v[84:87], v[176:179], v[16:31]
    buffer_load_dwordx4 v226, s[4:7], s41 offen lds
    buffer_load_dwordx4 v227, s[72:75], s41 offen offset:1024 lds
    s_mov_b32 s45, s44
    s_add_u32 s47, s44, 256
    s_add_u32 s49, s48, 32
    s_add_u32 s60, s48, 64
    v_mfma_f32_32x32x16_bf16 v[32:47], v[80:83], v[180:183], v[32:47]
    s_cmp_eq_u32 s33, 3
    s_cselect_b32 s46, s44, s47
    s_cselect_b32 s50, s60, s48
    s_cselect_b32 s51, s48, s49
    s_sub_u32 s60, s33, 2
    s_cmp_lt_u32 s60, 2
    s_cbranch_scc0 K2_rare_105
K2_back_106:
    v_mfma_f32_32x32x16_bf16 v[48:63], v[84:87], v[180:183], v[48:63]
    s_waitcnt vmcnt(4) lgkmcnt(0)
    v_mfma_f32_32x32x16_bf16 v[0:15], v[88:91], v[184:187], v[0:15]
    ds_read_b64_tr_b16 v[176:177], v246 offset:0
    ds_read_b64_tr_b16 v[178:179], v246 offset:512
    ds_read_b64_tr_b16 v[180:181], v247 offset:0
    ds_read_b64_tr_b16 v[182:183], v247 offset:512
    s_mov_b32 m0, s71
    v_mfma_f32_32x32x16_bf16 v[16:31], v[92:95], v[184:187], v[16:31]
    buffer_load_dwordx4 v228, s[4:7], s41 offen lds
    buffer_load_dwordx4 v229, s[72:75], s41 offen offset:1024 lds
    v_mfma_f32_32x32x16_bf16 v[32:47], v[88:91], v[188:191], v[32:47]
    s_nop 2
    v_mul_f32 v234, v0, v96
    v_mul_f32 v236, v8, v128
    v_fmac_f32 v234, v1, v97
    v_fmac_f32 v236, v9, v129
    v_fmac_f32 v234, v2, v98
    v_fmac_f32 v236, v10, v130
    v_fmac_f32 v234, v3, v99
    v_mfma_f32_32x32x16_bf16 v[48:63], v[92:95], v[188:191], v[48:63]
    s_setprio 0
    v_fmac_f32 v236, v11, v131
    v_fmac_f32 v234, v4, v100
    v_fmac_f32 v236, v12, v132
    v_fmac_f32 v234, v5, v101
    v_fmac_f32 v236, v13, v133
    v_fmac_f32 v234, v6, v102
    v_fmac_f32 v236, v14, v134
    v_fmac_f32 v234, v7, v103
    v_fmac_f32 v236, v15, v135
    v_mul_f32 v238, v16, v128
    v_mul_f32 v240, v24, v128
    v_fmac_f32 v238, v17, v129
    v_fmac_f32 v240, v25, v129
    v_fmac_f32 v238, v18, v130
    v_fmac_f32 v240, v26, v130
    v_fmac_f32 v238, v19, v131
    v_fmac_f32 v240, v27, v131
    v_fmac_f32 v238, v20, v132
    v_fmac_f32 v240, v28, v132
    v_fmac_f32 v238, v21, v133
    v_fmac_f32 v240, v29, v133
    v_fmac_f32 v238, v22, v134
    v_fmac_f32 v240, v30, v134
    v_fmac_f32 v238, v23, v135
    v_fmac_f32 v240, v31, v135
    v_mul_f32 v235, v32, v104
    v_mul_f32 v237, v40, v136
    v_fmac_f32 v235, v33, v105
    v_fmac_f32 v237, v41, v137
    v_fmac_f32 v235, v34, v106
    v_fmac_f32 v237, v42, v138
    v_fmac_f32 v235, v35, v107
    v_fmac_f32 v237, v43, v139
    v_fmac_f32 v235, v36, v108
    v_fmac_f32 v237, v44, v140
    v_fmac_f32 v235, v37, v109
    v_fmac_f32 v237, v45, v141
    v_fmac_f32 v235, v38, v110
    v_fmac_f32 v237, v46, v142
    v_fmac_f32 v235, v39, v111
    v_fmac_f32 v237, v47, v143
    v_mul_f32 v239, v48, v136
    v_mul_f32 v241, v56, v136
    s_setprio 1
    s_waitcnt vmcnt(4) lgkmcnt(0)
    v_mfma_f32_32x32x16_bf16 v[0:15], v[64:67], v[176:179], 0
    ds_read_b64_tr_b16 v[184:185], v246 offset:2048
    ds_read_b64_tr_b16 v[186:187], v246 offset:2560
    ds_read_b64_tr_b16 v[188:189], v247 offset:2048
    ds_read_b64_tr_b16 v[190:191], v247 offset:2560
    v_fmac_f32 v239, v49, v137
    v_fmac_f32 v241, v57, v137
    s_mov_b32 m0, s68
    v_mfma_f32_32x32x16_bf16 v[16:31], v[68:71], v[176:179], 0
    buffer_load_dwordx4 v222, s[4:7], s42 offen lds
    buffer_load_dwordx4 v223, s[72:75], s42 offen offset:1024 lds
    v_fmac_f32 v239, v50, v138
    v_fmac_f32 v241, v58, v138
    v_fmac_f32 v239, v51, v139
    v_fmac_f32 v241, v59, v139
    v_fmac_f32 v239, v52, v140
    v_mfma_f32_32x32x16_bf16 v[32:47], v[64:67], v[180:183], 0
    v_fmac_f32 v241, v60, v140
    v_fmac_f32 v239, v53, v141
    v_fmac_f32 v241, v61, v141
    v_fmac_f32 v239, v54, v142
    v_fmac_f32 v241, v62, v142
    v_fmac_f32 v239, v55, v143
    v_fmac_f32 v241, v63, v143
    v_mfma_f32_32x32x16_bf16 v[48:63], v[68:71], v[180:183], 0
    v_permlane32_swap_b32 v234, v235
    v_permlane32_swap_b32 v236, v237
    v_permlane32_swap_b32 v238, v239
    s_waitcnt vmcnt(4) lgkmcnt(0)
    v_mfma_f32_32x32x16_bf16 v[0:15], v[72:75], v[184:187], v[0:15]
    ds_read_b64_tr_b16 v[176:177], v246 offset:4096
    ds_read_b64_tr_b16 v[178:179], v246 offset:4608
    ds_read_b64_tr_b16 v[180:181], v247 offset:4096
    ds_read_b64_tr_b16 v[182:183], v247 offset:4608
    v_permlane32_swap_b32 v240, v241
    s_mov_b32 m0, s69
    v_mfma_f32_32x32x16_bf16 v[16:31], v[76:79], v[184:187], v[16:31]
    buffer_load_dwordx4 v224, s[4:7], s42 offen lds
    buffer_load_dwordx4 v225, s[72:75], s42 offen offset:1024 lds
    v_add_u32 v230, s31, v252
    v_add_f32 v234, v234, v235
    v_add_f32 v236, v236, v237
    v_add_f32 v238, v238, v239
    v_add_f32 v240, v240, v241
    v_mfma_f32_32x32x16_bf16 v[32:47], v[72:75], v[188:191], v[32:47]
    v_cvt_pk_bf16_f32 v234, v234, v236
    v_cvt_pk_bf16_f32 v238, v238, v240
    ds_write_b16 v230, v234 offset:0
    ds_write_b16_d16_hi v230, v234 offset:256
    ds_write_b16 v230, v238 offset:640
    ds_write_b16_d16_hi v230, v238 offset:1024
    v_mfma_f32_32x32x16_bf16 v[48:63], v[76:79], v[188:191], v[48:63]
    s_waitcnt vmcnt(4) lgkmcnt(4)
    v_mfma_f32_32x32x16_bf16 v[0:15], v[80:83], v[176:179], v[0:15]
    ds_read_b64_tr_b16 v[184:185], v246 offset:6144
    ds_read_b64_tr_b16 v[186:187], v246 offset:6656
    ds_read_b64_tr_b16 v[188:189], v247 offset:6144
    ds_read_b64_tr_b16 v[190:191], v247 offset:6656
    s_mov_b32 m0, s70
    v_mfma_f32_32x32x16_bf16 v[16:31], v[84:87], v[176:179], v[16:31]
    buffer_load_dwordx4 v226, s[4:7], s42 offen lds
    buffer_load_dwordx4 v227, s[72:75], s42 offen offset:1024 lds
    v_mfma_f32_32x32x16_bf16 v[32:47], v[80:83], v[180:183], v[32:47]
    v_mfma_f32_32x32x16_bf16 v[48:63], v[84:87], v[180:183], v[48:63]
    s_waitcnt vmcnt(4) lgkmcnt(0)
    v_mfma_f32_32x32x16_bf16 v[0:15], v[88:91], v[184:187], v[0:15]
    ds_read_b64_tr_b16 v[176:177], v246 offset:0
    ds_read_b64_tr_b16 v[178:179], v246 offset:512
    ds_read_b64_tr_b16 v[180:181], v247 offset:0
    ds_read_b64_tr_b16 v[182:183], v247 offset:512
    s_mov_b32 m0, s71
    v_mfma_f32_32x32x16_bf16 v[16:31], v[92:95], v[184:187], v[16:31]
    buffer_load_dwordx4 v228, s[4:7], s42 offen lds
    buffer_load_dwordx4 v229, s[72:75], s42 offen offset:1024 lds
    v_mfma_f32_32x32x16_bf16 v[32:47], v[88:91], v[188:191], v[32:47]
    s_nop 2
    v_mul_f32 v234, v0, v144
    v_mul_f32 v236, v8, v112
    v_fmac_f32 v234, v1, v145
    v_fmac_f32 v236, v9, v113
    v_fmac_f32 v234, v2, v146
    v_fmac_f32 v236, v10, v114
    v_fmac_f32 v234, v3, v147
    v_mfma_f32_32x32x16_bf16 v[48:63], v[92:95], v[188:191], v[48:63]
    s_setprio 0
    v_fmac_f32 v236, v11, v115
    v_fmac_f32 v234, v4, v148
    v_fmac_f32 v236, v12, v116
    v_fmac_f32 v234, v5, v149
    v_fmac_f32 v236, v13, v117
    v_fmac_f32 v234, v6, v150
    v_fmac_f32 v236, v14, v118
    v_fmac_f32 v234, v7, v151
    v_fmac_f32 v236, v15, v119
    v_mul_f32 v238, v16, v160
    v_mul_f32 v240, v24, v160
    v_fmac_f32 v238, v17, v161
    v_fmac_f32 v240, v25, v161
    v_fmac_f32 v238, v18, v162
    v_fmac_f32 v240, v26, v162
    v_fmac_f32 v238, v19, v163
    v_fmac_f32 v240, v27, v163
    v_fmac_f32 v238, v20, v164
    v_fmac_f32 v240, v28, v164
    v_fmac_f32 v238, v21, v165
    v_fmac_f32 v240, v29, v165
    v_fmac_f32 v238, v22, v166
    v_fmac_f32 v240, v30, v166
    v_fmac_f32 v238, v23, v167
    v_fmac_f32 v240, v31, v167
    v_mul_f32 v235, v32, v152
    v_mul_f32 v237, v40, v120
    v_fmac_f32 v235, v33, v153
    v_fmac_f32 v237, v41, v121
    v_fmac_f32 v235, v34, v154
    v_fmac_f32 v237, v42, v122
    v_fmac_f32 v235, v35, v155
    v_fmac_f32 v237, v43, v123
    v_fmac_f32 v235, v36, v156
    v_fmac_f32 v237, v44, v124
    v_fmac_f32 v235, v37, v157
    v_fmac_f32 v237, v45, v125
    v_fmac_f32 v235, v38, v158
    v_fmac_f32 v237, v46, v126
    v_fmac_f32 v235, v39, v159
    v_fmac_f32 v237, v47, v127
    v_mul_f32 v239, v48, v168
    v_mul_f32 v241, v56, v168
    s_setprio 1
    s_waitcnt vmcnt(4) lgkmcnt(0)
    v_mfma_f32_32x32x16_bf16 v[0:15], v[64:67], v[176:179], 0
    ds_read_b64_tr_b16 v[184:185], v246 offset:2048
    ds_read_b64_tr_b16 v[186:187], v246 offset:2560
    ds_read_b64_tr_b16 v[188:189], v247 offset:2048
    ds_read_b64_tr_b16 v[190:191], v247 offset:2560
    v_fmac_f32 v239, v49, v169
    v_fmac_f32 v241, v57, v169
    s_mov_b32 m0, s68
    v_mfma_f32_32x32x16_bf16 v[16:31], v[68:71], v[176:179], 0
    buffer_load_dwordx4 v222, s[4:7], s43 offen lds
    buffer_load_dwordx4 v223, s[72:75], s43 offen offset:1024 lds
    v_fmac_f32 v239, v50, v170
    v_fmac_f32 v241, v58, v170
    v_fmac_f32 v239, v51, v171
    v_fmac_f32 v241, v59, v171
    v_fmac_f32 v239, v52, v172
    v_mfma_f32_32x32x16_bf16 v[32:47], v[64:67], v[180:183], 0
    v_fmac_f32 v241, v60, v172
    v_fmac_f32 v239, v53, v173
    v_fmac_f32 v241, v61, v173
    v_fmac_f32 v239, v54, v174
    v_fmac_f32 v241, v62, v174
    v_fmac_f32 v239, v55, v175
    v_fmac_f32 v241, v63, v175
    v_mfma_f32_32x32x16_bf16 v[48:63], v[68:71], v[180:183], 0
    v_permlane32_swap_b32 v234, v235
    v_add_f32 v234, v234, v235
    s_waitcnt vmcnt(4) lgkmcnt(0)
    v_mfma_f32_32x32x16_bf16 v[0:15], v[72:75], v[184:187], v[0:15]
    ds_read_b64_tr_b16 v[176:177], v246 offset:4096
    ds_read_b64_tr_b16 v[178:179], v246 offset:4608
    ds_read_b64_tr_b16 v[180:181], v247 offset:4096
    ds_read_b64_tr_b16 v[182:183], v247 offset:4608
    s_mov_b32 m0, s69
    v_mfma_f32_32x32x16_bf16 v[16:31], v[76:79], v[184:187], v[16:31]
    buffer_load_dwordx4 v224, s[4:7], s43 offen lds
    buffer_load_dwordx4 v225, s[72:75], s43 offen offset:1024 lds
    v_mfma_f32_32x32x16_bf16 v[32:47], v[72:75], v[188:191], v[32:47]
    v_mfma_f32_32x32x16_bf16 v[48:63], v[76:79], v[188:191], v[48:63]
    s_waitcnt vmcnt(4) lgkmcnt(0)
    v_mfma_f32_32x32x16_bf16 v[0:15], v[80:83], v[176:179], v[0:15]
    ds_read_b64_tr_b16 v[184:185], v246 offset:6144
    ds_read_b64_tr_b16 v[186:187], v246 offset:6656
    ds_read_b64_tr_b16 v[188:189], v247 offset:6144
    ds_read_b64_tr_b16 v[190:191], v247 offset:6656
    s_mov_b32 m0, s70
    v_mfma_f32_32x32x16_bf16 v[16:31], v[84:87], v[176:179], v[16:31]
    buffer_load_dwordx4 v226, s[4:7], s43 offen lds
    buffer_load_dwordx4 v227, s[72:75], s43 offen offset:1024 lds
    v_mfma_f32_32x32x16_bf16 v[32:47], v[80:83], v[180:183], v[32:47]
    v_add_u32 v222, s48, v251
    ds_read_b32 v222, v222
    v_mfma_f32_32x32x16_bf16 v[48:63], v[84:87], v[180:183], v[48:63]
    s_waitcnt vmcnt(4) lgkmcnt(1)
    v_mfma_f32_32x32x16_bf16 v[0:15], v[88:91], v[184:187], v[0:15]
    ds_read_b64_tr_b16 v[176:177], v246 offset:0
    ds_read_b64_tr_b16 v[178:179], v246 offset:512
    ds_read_b64_tr_b16 v[180:181], v247 offset:0
    ds_read_b64_tr_b16 v[182:183], v247 offset:512
    s_mov_b32 m0, s71
    v_mfma_f32_32x32x16_bf16 v[16:31], v[92:95], v[184:187], v[16:31]
    buffer_load_dwordx4 v228, s[4:7], s43 offen lds
    buffer_load_dwordx4 v229, s[72:75], s43 offen offset:1024 lds
    s_waitcnt lgkmcnt(4)
    v_mad_u32_u16 v223, v222, s39, v248 op_sel:[1,0,0,0]
    v_mad_u32_u16 v222, v222, s39, v248
    v_mfma_f32_32x32x16_bf16 v[32:47], v[88:91], v[188:191], v[32:47]
    v_add_u32 v224, s49, v251
    ds_read_b32 v224, v224
    v_mul_f32 v242, v0, v144
    v_fma_f32 v238, v8, v160, -v238
    v_fmac_f32 v242, v1, v145
    v_fmac_f32 v238, v9, v161
    v_fmac_f32 v242, v2, v146
    v_mfma_f32_32x32x16_bf16 v[48:63], v[92:95], v[188:191], v[48:63]
    s_setprio 0
    v_fmac_f32 v238, v10, v162
    v_fmac_f32 v242, v3, v147
    v_fmac_f32 v238, v11, v163
    v_fmac_f32 v242, v4, v148
    v_fmac_f32 v238, v12, v164
    v_fmac_f32 v242, v5, v149
    v_fmac_f32 v238, v13, v165
    v_fmac_f32 v242, v6, v150
    v_fmac_f32 v238, v14, v166
    v_fmac_f32 v242, v7, v151
    v_fmac_f32 v238, v15, v167
    v_fmac_f32 v236, v16, v112
    v_mul_f32 v244, v24, v160
    v_fmac_f32 v236, v17, v113
    v_fmac_f32 v244, v25, v161
    v_fmac_f32 v236, v18, v114
    v_fmac_f32 v244, v26, v162
    v_fmac_f32 v236, v19, v115
    v_fmac_f32 v244, v27, v163
    v_fmac_f32 v236, v20, v116
    v_fmac_f32 v244, v28, v164
    v_fmac_f32 v236, v21, v117
    v_fmac_f32 v244, v29, v165
    v_fmac_f32 v236, v22, v118
    v_fmac_f32 v244, v30, v166
    v_fmac_f32 v236, v23, v119
    v_fmac_f32 v244, v31, v167
    v_mul_f32 v243, v32, v152
    v_fma_f32 v239, v40, v168, -v239
    v_fmac_f32 v243, v33, v153
    v_fmac_f32 v239, v41, v169
    v_fmac_f32 v243, v34, v154
    v_fmac_f32 v239, v42, v170
    v_fmac_f32 v243, v35, v155
    v_fmac_f32 v239, v43, v171
    v_fmac_f32 v243, v36, v156
    v_fmac_f32 v239, v44, v172
    v_fmac_f32 v243, v37, v157
    v_fmac_f32 v239, v45, v173
    v_fmac_f32 v243, v38, v158
    v_fmac_f32 v239, v46, v174
    v_fmac_f32 v243, v39, v159
    v_fmac_f32 v239, v47, v175
    v_fmac_f32 v237, v48, v120
    v_mul_f32 v245, v56, v168
    v_fmac_f32 v237, v49, v121
    v_fmac_f32 v245, v57, v169
    v_fmac_f32 v237, v50, v122
    v_fmac_f32 v245, v58, v170
    v_fmac_f32 v237, v51, v123
    s_setprio 1
    s_waitcnt vmcnt(4) lgkmcnt(1)
    v_mfma_f32_32x32x16_bf16 v[0:15], v[64:67], v[176:179], 0
    ds_read_b64_tr_b16 v[184:185], v246 offset:2048
    ds_read_b64_tr_b16 v[186:187], v246 offset:2560
    ds_read_b64_tr_b16 v[188:189], v247 offset:2048
    ds_read_b64_tr_b16 v[190:191], v247 offset:2560
    v_fmac_f32 v245, v59, v171
    v_fmac_f32 v237, v52, v124
    s_mov_b32 m0, s68
    v_mfma_f32_32x32x16_bf16 v[16:31], v[68:71], v[176:179], 0
    buffer_load_dwordx4 v222, s[4:7], s44 offen lds
    buffer_load_dwordx4 v223, s[72:75], s44 offen offset:1024 lds
    s_waitcnt lgkmcnt(4)
    v_mad_u32_u16 v225, v224, s39, v248 op_sel:[1,0,0,0]
    v_mad_u32_u16 v224, v224, s39, v248
    v_fmac_f32 v245, v60, v172
    v_fmac_f32 v237, v53, v125
    v_mfma_f32_32x32x16_bf16 v[32:47], v[64:67], v[180:183], 0
    v_add_u32 v226, s50, v251
    ds_read_b32 v226, v226
    v_fmac_f32 v245, v61, v173
    v_fmac_f32 v237, v54, v126
    v_fmac_f32 v245, v62, v174
    v_fmac_f32 v237, v55, v127
    v_fmac_f32 v245, v63, v175
    v_mfma_f32_32x32x16_bf16 v[48:63], v[68:71], v[180:183], 0
    v_permlane32_swap_b32 v238, v239
    v_permlane32_swap_b32 v242, v243
    v_add_f32 v238, v238, v239
    v_add_f32 v242, v242, v243
    s_waitcnt vmcnt(4) lgkmcnt(1)
    v_mfma_f32_32x32x16_bf16 v[0:15], v[72:75], v[184:187], v[0:15]
    ds_read_b64_tr_b16 v[176:177], v246 offset:4096
    ds_read_b64_tr_b16 v[178:179], v246 offset:4608
    ds_read_b64_tr_b16 v[180:181], v247 offset:4096
    ds_read_b64_tr_b16 v[182:183], v247 offset:4608
    v_cvt_pk_bf16_f32 v234, v234, v242
    ds_write_b16 v230, v234 offset:384
    s_mov_b32 m0, s69
    v_mfma_f32_32x32x16_bf16 v[16:31], v[76:79], v[184:187], v[16:31]
    buffer_load_dwordx4 v224, s[4:7], s45 offen lds
    buffer_load_dwordx4 v225, s[72:75], s45 offen offset:1024 lds
    s_waitcnt lgkmcnt(5)
    v_mad_u32_u16 v227, v226, s39, v248 op_sel:[1,0,0,0]
    v_mad_u32_u16 v226, v226, s39, v248
    ds_write_b16_d16_hi v230, v234 offset:768
    v_mfma_f32_32x32x16_bf16 v[32:47], v[72:75], v[188:191], v[32:47]
    v_add_u32 v228, s51, v251
    ds_read_b32 v228, v228
    v_mfma_f32_32x32x16_bf16 v[48:63], v[76:79], v[188:191], v[48:63]
    s_waitcnt vmcnt(4) lgkmcnt(3)
    v_mfma_f32_32x32x16_bf16 v[0:15], v[80:83], v[176:179], v[0:15]
    ds_read_b64_tr_b16 v[184:185], v246 offset:6144
    ds_read_b64_tr_b16 v[186:187], v246 offset:6656
    ds_read_b64_tr_b16 v[188:189], v247 offset:6144
    ds_read_b64_tr_b16 v[190:191], v247 offset:6656
    s_mov_b32 m0, s70
    v_mfma_f32_32x32x16_bf16 v[16:31], v[84:87], v[176:179], v[16:31]
    buffer_load_dwordx4 v226, s[4:7], s46 offen lds
    buffer_load_dwordx4 v227, s[72:75], s46 offen offset:1024 lds
    s_waitcnt lgkmcnt(4)
    v_mad_u32_u16 v229, v228, s39, v248 op_sel:[1,0,0,0]
    v_mad_u32_u16 v228, v228, s39, v248
    v_mfma_f32_32x32x16_bf16 v[32:47], v[80:83], v[180:183], v[32:47]
    v_mfma_f32_32x32x16_bf16 v[48:63], v[84:87], v[180:183], v[48:63]
    s_waitcnt vmcnt(4) lgkmcnt(0)
    v_mfma_f32_32x32x16_bf16 v[0:15], v[88:91], v[184:187], v[0:15]
    ds_read_b64_tr_b16 v[176:177], v246 offset:0
    ds_read_b64_tr_b16 v[178:179], v246 offset:512
    ds_read_b64_tr_b16 v[180:181], v247 offset:0
    ds_read_b64_tr_b16 v[182:183], v247 offset:512
    s_mov_b32 m0, s71
    v_mfma_f32_32x32x16_bf16 v[16:31], v[92:95], v[184:187], v[16:31]
    buffer_load_dwordx4 v228, s[4:7], s47 offen lds
    buffer_load_dwordx4 v229, s[72:75], s47 offen offset:1024 lds
    v_mfma_f32_32x32x16_bf16 v[32:47], v[88:91], v[188:191], v[32:47]
    s_nop 2
    v_mul_f32 v242, v0, v144
    v_fma_f32 v240, v8, v160, -v240
    v_fmac_f32 v242, v1, v145
    v_fmac_f32 v240, v9, v161
    v_fmac_f32 v242, v2, v146
    v_fmac_f32 v240, v10, v162
    v_fmac_f32 v242, v3, v147
    v_mfma_f32_32x32x16_bf16 v[48:63], v[92:95], v[188:191], v[48:63]
    s_setprio 0
    v_fmac_f32 v240, v11, v163
    v_fmac_f32 v242, v4, v148
    v_fmac_f32 v240, v12, v164
    v_fmac_f32 v242, v5, v149
    v_fmac_f32 v240, v13, v165
    v_fmac_f32 v242, v6, v150
    v_fmac_f32 v240, v14, v166
    v_fmac_f32 v242, v7, v151
    v_fmac_f32 v240, v15, v167
    s_sub_u32 s58, s48, s29
    v_add_u32 v249, s58, v249
    v_add_u32 v250, s58, v250
    v_fma_f32 v244, v16, v160, -v244
    v_fmac_f32 v236, v24, v112
    v_fmac_f32 v244, v17, v161
    v_fmac_f32 v236, v25, v113
    v_fmac_f32 v244, v18, v162
    v_fmac_f32 v236, v26, v114
    v_fmac_f32 v244, v19, v163
    v_fmac_f32 v236, v27, v115
    v_fmac_f32 v244, v20, v164
    v_fmac_f32 v236, v28, v116
    v_fmac_f32 v244, v21, v165
    v_fmac_f32 v236, v29, v117
    v_fmac_f32 v244, v22, v166
    v_fmac_f32 v236, v30, v118
    v_fmac_f32 v244, v23, v167
    v_fmac_f32 v236, v31, v119
    ds_read_b64_tr_b16 v[0:1], v249 offset:0
    ds_read_b64_tr_b16 v[2:3], v249 offset:128
    ds_read_b128 v[4:7], v250 offset:0
    ds_read_b128 v[8:11], v250 offset:16
    ds_read_b128 v[12:15], v250 offset:384
    ds_read_b128 v[16:19], v250 offset:400
    v_mul_f32 v243, v32, v152
    v_fma_f32 v241, v40, v168, -v241
    v_fmac_f32 v243, v33, v153
    v_fmac_f32 v241, v41, v169
    v_fmac_f32 v243, v34, v154
    v_fmac_f32 v241, v42, v170
    v_fmac_f32 v243, v35, v155
    v_fmac_f32 v241, v43, v171
    v_fmac_f32 v243, v36, v156
    v_fmac_f32 v241, v44, v172
    v_fmac_f32 v243, v37, v157
    v_fmac_f32 v241, v45, v173
    v_fmac_f32 v243, v38, v158
    v_fmac_f32 v241, v46, v174
    v_fmac_f32 v243, v39, v159
    v_fmac_f32 v241, v47, v175
    ds_read_b64_tr_b16 v[20:21], v249 offset:512
    ds_read_b64_tr_b16 v[22:23], v249 offset:640
    ds_read_b128 v[24:27], v250 offset:64
    ds_read_b128 v[28:31], v250 offset:80
    ds_read_b128 v[32:35], v250 offset:448
    ds_read_b128 v[36:39], v250 offset:464
    v_fma_f32 v245, v48, v168, -v245
    v_fmac_f32 v237, v56, v120
    v_fmac_f32 v245, v49, v169
    v_fmac_f32 v237, v57, v121
    v_fmac_f32 v245, v50, v170
    v_fmac_f32 v237, v58, v122
    v_fmac_f32 v245, v51, v171
    v_fmac_f32 v237, v59, v123
    v_fmac_f32 v245, v52, v172
    v_fmac_f32 v237, v60, v124
    v_fmac_f32 v245, v53, v173
    v_fmac_f32 v237, v61, v125
    v_fmac_f32 v245, v54, v174
    v_fmac_f32 v237, v62, v126
    v_fmac_f32 v245, v55, v175
    v_fmac_f32 v237, v63, v127
    s_cmp_eq_u32 s36, 0
    s_cbranch_scc1 K2_TAIL
    s_mov_b32 s29, s48
    s_mov_b32 s32, s31
    s_mov_b32 s30, s3
    s_mov_b32 s31, s35
    s_cmp_eq_u32 s33, 2
    s_cbranch_scc1 K2_U21
    s_cmp_eq_u32 s33, 3
    s_cbranch_scc1 K2_U31
    s_cmp_eq_u32 s33, 1
    s_cbranch_scc1 K2_U11
    s_branch K2_U41
K2_SWITCH:
    v_permlane32_swap_b32 v242, v243
    v_permlane32_swap_b32 v240, v241
    v_permlane32_swap_b32 v236, v237
    v_permlane32_swap_b32 v244, v245
    v_add_f32 v242, v242, v243
    v_add_f32 v240, -v240, -v241
    v_add_f32 v236, v236, v237
    v_add_f32 v244, v244, v245
    s_set_gpr_idx_on s31, gpr_idx(DST)
    s_nop 0
    v_cvt_pk_bf16_f32 v195, v242, v236
    v_cvt_pk_bf16_f32 v196, v244, v240
    v_cvt_pk_bf16_f32 v197, v238, v238
    s_set_gpr_idx_off
    s_cmp_eq_u32 s36, 0
    s_cbranch_scc1 K2_TAIL2
    v_lshlrev_b32 v254, 3, v252
    v_add_u32 v230, s35, v252
    s_mov_b32 s58, 7131136
    buffer_load_dwordx4 v[96:99], v254, s[8:11], s58 offen offset:0 sc1
    buffer_load_dwordx4 v[100:103], v254, s[8:11], s58 offen offset:1024 sc1
    buffer_load_dwordx4 v[104:107], v254, s[8:11], s58 offen offset:2048 sc1
    buffer_load_dwordx4 v[108:111], v254, s[8:11], s58 offen offset:3072 sc1
    s_mov_b32 s58, 7135232
    buffer_load_dwordx4 v[112:115], v254, s[8:11], s58 offen offset:0 sc1
    buffer_load_dwordx4 v[116:119], v254, s[8:11], s58 offen offset:1024 sc1
    buffer_load_dwordx4 v[120:123], v254, s[8:11], s58 offen offset:2048 sc1
    buffer_load_dwordx4 v[124:127], v254, s[8:11], s58 offen offset:3072 sc1
    s_mov_b32 s58, 7139328
    buffer_load_dwordx4 v[128:131], v254, s[8:11], s58 offen offset:0 sc1
    buffer_load_dwordx4 v[132:135], v254, s[8:11], s58 offen offset:1024 sc1
    buffer_load_dwordx4 v[136:139], v254, s[8:11], s58 offen offset:2048 sc1
    buffer_load_dwordx4 v[140:143], v254, s[8:11], s58 offen offset:3072 sc1
    s_mov_b32 s58, 7143424
    buffer_load_dwordx4 v[144:147], v254, s[8:11], s58 offen offset:0 sc1
    buffer_load_dwordx4 v[148:151], v254, s[8:11], s58 offen offset:1024 sc1
    buffer_load_dwordx4 v[152:155], v254, s[8:11], s58 offen offset:2048 sc1
    buffer_load_dwordx4 v[156:159], v254, s[8:11], s58 offen offset:3072 sc1
    s_mov_b32 s58, 7147520
    buffer_load_dwordx4 v[160:163], v254, s[8:11], s58 offen offset:0 sc1
    buffer_load_dwordx4 v[164:167], v254, s[8:11], s58 offen offset:1024 sc1
    buffer_load_dwordx4 v[168:171], v254, s[8:11], s58 offen offset:2048 sc1
    buffer_load_dwordx4 v[172:175], v254, s[8:11], s58 offen offset:3072 sc1
    s_movk_i32 s40, 128
    s_movk_i32 s41, 384
    s_movk_i32 s42, 640
    s_movk_i32 s43, 896
    s_cmp_lg_u32 s33, 1
    s_cbranch_scc1 K2_SW2
    s_waitcnt vmcnt(0)
K2_SW2:
    s_mov_b32 s29, s48
    s_mov_b32 s32, s31
    s_mov_b32 s30, s3
    s_mov_b32 s31, s35
    s_cmp_eq_u32 s33, 2
    s_cbranch_scc1 K2_U21
    s_cmp_eq_u32 s33, 3
    s_cbranch_scc1 K2_U31
    s_cmp_eq_u32 s33, 1
    s_cbranch_scc1 K2_U11
    s_branch K2_U41
K2_WINDOW:
    s_mov_b32 s24, 0
    s_mov_b32 s25, 1
K2_LOAD:
    v_mbcnt_lo_u32_b32 v176, -1, 0
    v_mbcnt_hi_u32_b32 v176, -1, v176
    s_lshl_b32 s58, s20, 6
    v_add_u32 v177, s58, v176
    v_lshlrev_b32 v70, 4, v176
    s_mov_b32 s58, 7110656
    buffer_load_dwordx4 v[96:99], v70, s[8:11], s58 offen offset:0 sc1
    buffer_load_dwordx4 v[100:103], v70, s[8:11], s58 offen offset:1024 sc1
    buffer_load_dwordx4 v[104:107], v70, s[8:11], s58 offen offset:2048 sc1
    buffer_load_dwordx4 v[108:111], v70, s[8:11], s58 offen offset:3072 sc1
    s_mov_b32 s58, 7114752
    buffer_load_dwordx4 v[112:115], v70, s[8:11], s58 offen offset:0 sc1
    buffer_load_dwordx4 v[116:119], v70, s[8:11], s58 offen offset:1024 sc1
    buffer_load_dwordx4 v[120:123], v70, s[8:11], s58 offen offset:2048 sc1
    buffer_load_dwordx4 v[124:127], v70, s[8:11], s58 offen offset:3072 sc1
    s_mov_b32 s58, 7118848
    buffer_load_dwordx4 v[128:131], v70, s[8:11], s58 offen offset:0 sc1
    buffer_load_dwordx4 v[132:135], v70, s[8:11], s58 offen offset:1024 sc1
    buffer_load_dwordx4 v[136:139], v70, s[8:11], s58 offen offset:2048 sc1
    buffer_load_dwordx4 v[140:143], v70, s[8:11], s58 offen offset:3072 sc1
    s_mov_b32 s58, 7122944
    buffer_load_dwordx4 v[144:147], v70, s[8:11], s58 offen offset:0 sc1
    buffer_load_dwordx4 v[148:151], v70, s[8:11], s58 offen offset:1024 sc1
    buffer_load_dwordx4 v[152:155], v70, s[8:11], s58 offen offset:2048 sc1
    buffer_load_dwordx4 v[156:159], v70, s[8:11], s58 offen offset:3072 sc1
    s_mov_b32 s58, 7127040
    buffer_load_dwordx4 v[160:163], v70, s[8:11], s58 offen offset:0 sc1
    buffer_load_dwordx4 v[164:167], v70, s[8:11], s58 offen offset:1024 sc1
    buffer_load_dwordx4 v[168:171], v70, s[8:11], s58 offen offset:2048 sc1
    buffer_load_dwordx4 v[172:175], v70, s[8:11], s58 offen offset:3072 sc1
    v_mul_u32_u24 v76, 437, v177
    v_lshrrev_b32 v76, 16, v76
    v_mul_u32_u24 v76, 150, v76
    v_sub_u32 v76, v177, v76
    v_mov_b32 v80, -1
    v_mov_b32 v77, 1.0
    v_cmp_gt_u32 vcc, 48, v76
    v_lshlrev_b32 v78, 4, v177
    v_add_u32 v78, 65536, v78
    v_cndmask_b32 v80, v80, 0, vcc
    v_cmp_gt_u32 vcc, 12, v76
    v_add_u32 v79, 64800, v78
    s_nop 0
    v_cndmask_b32 v80, v80, v77, vcc
    v_cmp_gt_u32 vcc, 450, v177
    v_mov_b32 v81, v80
    v_mov_b32 v82, v80
    v_mov_b32 v83, v80
    s_mov_b64 exec, vcc
    ds_write_b128 v78, v[80:83] offset:0
    ds_write_b128 v78, v[80:83] offset:7200
    ds_write_b128 v78, v[80:83] offset:14400
    ds_write_b128 v78, v[80:83] offset:21600
    ds_write_b128 v78, v[80:83] offset:28800
    ds_write_b128 v78, v[80:83] offset:36000
    ds_write_b128 v78, v[80:83] offset:43200
    ds_write_b128 v78, v[80:83] offset:50400
    ds_write_b128 v78, v[80:83] offset:57600
    ds_write_b128 v79, v[80:83] offset:0
    ds_write_b128 v79, v[80:83] offset:7200
    ds_write_b128 v79, v[80:83] offset:14400
    ds_write_b128 v79, v[80:83] offset:21600
    v_cmp_gt_u32 vcc, 268, v177
    s_nop 0
    s_cbranch_vccz K2_NOCLe
    s_mov_b64 exec, vcc
    ds_write_b128 v79, v[80:83] offset:28800
K2_NOCLe:
    s_mov_b64 exec, -1
    s_cmp_lg_u32 s20, 7
    s_cbranch_scc1 K2_NOHe
    v_mov_b32 v76, 0
    v_mov_b32 v77, -1
    v_lshlrev_b32 v78, 2, v176
    v_add_u32 v78, 163424, v78
    s_mov_b64 exec, 0x1ff
    ds_write_b32 v78, v76 offset:192
    s_mov_b64 exec, 0xff
    ds_write_b32 v78, v77 offset:256
    s_mov_b64 exec, -1
    s_cmp_lg_u32 s24, 0
    s_cbranch_scc1 K2_NOHe
    s_mov_b32 exec_hi, 0xffff
    ds_write_b32 v78, v76
    s_mov_b64 exec, 1
    ds_write_b32 v78, v76 offset:228
    s_mov_b64 exec, -1
K2_NOHe:
    v_and_b32 v84, 15, v176
    v_lshrrev_b32 v85, 5, v176
    v_bfe_u32 v86, v176, 4, 1
    v_lshrrev_b32 v87, 2, v84
    v_and_b32 v88, 3, v84
    v_lshl_add_u32 v89, v85, 3, v87
    v_lshlrev_b32 v249, 5, v89
    v_lshl_add_u32 v249, v88, 3, v249
    v_add_u32 v249, 864, v249
    v_mul_u32_u24 v250, 192, v86
    v_lshl_add_u32 v250, v85, 5, v250
    v_lshrrev_b32 v90, 1, v88
    v_lshl_add_u32 v90, v86, 1, v90
    v_bfe_u32 v91, v87, 1, 1
    v_lshlrev_b32 v91, 2, v91
    v_xor_b32 v90, v90, v91
    v_lshlrev_b32 v90, 4, v90
    v_lshl_add_u32 v90, v89, 7, v90
    v_and_b32 v91, 1, v88
    v_lshl_add_u32 v90, v91, 3, v90
    v_add_u32 v246, s37, v90
    v_xor_b32 v247, 64, v246
    v_lshrrev_b32 v90, 3, v176
    v_lshlrev_b32 v251, 2, v90
    v_add_u32 v251, 768, v251
    v_bfe_u32 v90, v90, 1, 1
    v_lshlrev_b32 v90, 2, v90
    v_and_b32 v91, 7, v176
    v_xor_b32 v90, v90, v91
    v_lshlrev_b32 v248, 4, v90
    v_lshlrev_b32 v252, 1, v176
    v_and_b32 v231, 1, v176
    v_lshlrev_b32 v231, 4, v231
    v_lshrrev_b32 v90, 1, v176
    v_lshlrev_b32 v90, 5, v90
    v_add_u32 v230, 864, v90
    s_branch K2_CELLS
K2_BIG:
    s_cmp_lg_u32 s24, 0
    s_cbranch_scc1 K2_TOK
    s_mov_b64 s[62:63], vcc
    s_bcnt1_i32_b64 s60, vcc
    s_cmp_eq_u32 s22, 39
    s_cselect_b32 s61, 5, 2
    s_cmp_gt_u32 s60, s61
    s_cbranch_scc1 K2_SLOW
    v_cmp_lt_u32 vcc, 64, v193
    s_nop 0
    s_cbranch_vccnz K2_SLOW
    v_mbcnt_lo_u32_b32 v197, s62, 0
    v_mbcnt_hi_u32_b32 v197, s63, v197
    v_lshlrev_b32 v198, 27, v197
    v_cndmask_b32 v198, 0, v198, s[62:63]
    s_movk_i32 s26, 64
    v_cmp_le_u32 vcc, 2, v197
    v_mov_b32 v194, 161536
    v_mov_b32 v196, -8229472
    v_cndmask_b32 v194, v194, v196, vcc
    v_lshl_add_u32 v197, v197, 22, v194
    v_mov_b32 v203, v193
    v_mov_b32 v204, v195
    v_mov_b32 v205, v197
    s_mov_b32 s60, 6991
    v_cmp_lt_i32 vcc, 0, v180
    s_nop 0
    s_cbranch_vccz K2_OV_DONE
    v_subrev_u32 v192, 65536, v50
    v_mul_hi_u32_u24 v193, s60, v192
    v_mul_u32_u24 v192, s60, v192
    v_alignbit_b32 v192, v193, v192, 24
    v_lshlrev_b32 v192, 2, v192
    ds_bpermute_b32 v199, v192, v205
    v_subrev_u32 v192, 48, v40
    v_cmp_gt_u32 s[62:63], 16, v192
    s_waitcnt lgkmcnt(0)
    s_and_b64 exec, vcc, s[62:63]
    s_cbranch_execz K2_ov_11
    v_lshrrev_b32 v193, 18, v199
    v_add_u32 v192, v192, v193
    v_and_b32 v199, 0x3ffff, v199
    v_lshl_add_u32 v194, v192, 5, v199
    v_lshl_add_u32 v195, v192, 2, v199
    v_and_b32 v196, 7, v192
    v_add_lshl_u32 v196, v196, v192, 1
    v_bfe_u32 v193, v192, 3, 1
    v_mad_i32_i24 v196, v193, -14, v196
    v_add_u32 v196, v196, v199
    ds_write_b32 v194, v60 offset:864
    ds_write2_b32 v195, v0, v1 offset0:48 offset1:96
    ds_write_b32 v195, v2 offset:576
    ds_write_b16 v196, v3 offset:768
K2_ov_11:
    s_mov_b64 exec, -1
    v_cmp_lt_i32 vcc, 2, v180
    s_nop 0
    s_cbranch_vccz K2_OV_DONE
    v_subrev_u32 v192, 65536, v51
    v_mul_hi_u32_u24 v193, s60, v192
    v_mul_u32_u24 v192, s60, v192
    v_alignbit_b32 v192, v193, v192, 24
    v_lshlrev_b32 v192, 2, v192
    ds_bpermute_b32 v199, v192, v205
    v_subrev_u32 v192, 48, v41
    v_cmp_gt_u32 s[62:63], 16, v192
    s_waitcnt lgkmcnt(0)
    s_and_b64 exec, vcc, s[62:63]
    s_cbranch_execz K2_ov_12
    v_lshrrev_b32 v193, 18, v199
    v_add_u32 v192, v192, v193
    v_and_b32 v199, 0x3ffff, v199
    v_lshl_add_u32 v194, v192, 5, v199
    v_lshl_add_u32 v195, v192, 2, v199
    v_and_b32 v196, 7, v192
    v_add_lshl_u32 v196, v196, v192, 1
    v_bfe_u32 v193, v192, 3, 1
    v_mad_i32_i24 v196, v193, -14, v196
    v_add_u32 v196, v196, v199
    ds_write_b32 v194, v61 offset:864
    ds_write2_b32 v195, v4, v5 offset0:48 offset1:96
    ds_write_b32 v195, v6 offset:576
    ds_write_b16 v196, v7 offset:768
K2_ov_12:
    s_mov_b64 exec, -1
    v_cmp_lt_i32 vcc, 4, v180
    s_nop 0
    s_cbranch_vccz K2_OV_DONE
    v_subrev_u32 v192, 65536, v52
    v_mul_hi_u32_u24 v193, s60, v192
    v_mul_u32_u24 v192, s60, v192
    v_alignbit_b32 v192, v193, v192, 24
    v_lshlrev_b32 v192, 2, v192
    ds_bpermute_b32 v199, v192, v205
    v_subrev_u32 v192, 48, v42
    v_cmp_gt_u32 s[62:63], 16, v192
    s_waitcnt lgkmcnt(0)
    s_and_b64 exec, vcc, s[62:63]
    s_cbranch_execz K2_ov_13
    v_lshrrev_b32 v193, 18, v199
    v_add_u32 v192, v192, v193
    v_and_b32 v199, 0x3ffff, v199
    v_lshl_add_u32 v194, v192, 5, v199
    v_lshl_add_u32 v195, v192, 2, v199
    v_and_b32 v196, 7, v192
    v_add_lshl_u32 v196, v196, v192, 1
    v_bfe_u32 v193, v192, 3, 1
    v_mad_i32_i24 v196, v193, -14, v196
    v_add_u32 v196, v196, v199
    ds_write_b32 v194, v62 offset:864
    ds_write2_b32 v195, v8, v9 offset0:48 offset1:96
    ds_write_b32 v195, v10 offset:576
    ds_write_b16 v196, v11 offset:768
K2_ov_13:
    s_mov_b64 exec, -1
    v_cmp_lt_i32 vcc, 6, v180
    s_nop 0
    s_cbranch_vccz K2_OV_DONE
    v_subrev_u32 v192, 65536, v53
    v_mul_hi_u32_u24 v193, s60, v192
    v_mul_u32_u24 v192, s60, v192
    v_alignbit_b32 v192, v193, v192, 24
    v_lshlrev_b32 v192, 2, v192
    ds_bpermute_b32 v199, v192, v205
    v_subrev_u32 v192, 48, v43
    v_cmp_gt_u32 s[62:63], 16, v192
    s_waitcnt lgkmcnt(0)
    s_and_b64 exec, vcc, s[62:63]
    s_cbranch_execz K2_ov_14
    v_lshrrev_b32 v193, 18, v199
    v_add_u32 v192, v192, v193
    v_and_b32 v199, 0x3ffff, v199
    v_lshl_add_u32 v194, v192, 5, v199
    v_lshl_add_u32 v195, v192, 2, v199
    v_and_b32 v196, 7, v192
    v_add_lshl_u32 v196, v196, v192, 1
    v_bfe_u32 v193, v192, 3, 1
    v_mad_i32_i24 v196, v193, -14, v196
    v_add_u32 v196, v196, v199
    ds_write_b32 v194, v63 offset:864
    ds_write2_b32 v195, v12, v13 offset0:48 offset1:96
    ds_write_b32 v195, v14 offset:576
    ds_write_b16 v196, v15 offset:768
K2_ov_14:
    s_mov_b64 exec, -1
    v_cmp_lt_i32 vcc, 8, v180
    s_nop 0
    s_cbranch_vccz K2_OV_DONE
    v_subrev_u32 v192, 65536, v54
    v_mul_hi_u32_u24 v193, s60, v192
    v_mul_u32_u24 v192, s60, v192
    v_alignbit_b32 v192, v193, v192, 24
    v_lshlrev_b32 v192, 2, v192
    ds_bpermute_b32 v199, v192, v205
    v_subrev_u32 v192, 48, v44
    v_cmp_gt_u32 s[62:63], 16, v192
    s_waitcnt lgkmcnt(0)
    s_and_b64 exec, vcc, s[62:63]
    s_cbranch_execz K2_ov_15
    v_lshrrev_b32 v193, 18, v199
    v_add_u32 v192, v192, v193
    v_and_b32 v199, 0x3ffff, v199
    v_lshl_add_u32 v194, v192, 5, v199
    v_lshl_add_u32 v195, v192, 2, v199
    v_and_b32 v196, 7, v192
    v_add_lshl_u32 v196, v196, v192, 1
    v_bfe_u32 v193, v192, 3, 1
    v_mad_i32_i24 v196, v193, -14, v196
    v_add_u32 v196, v196, v199
    ds_write_b32 v194, v64 offset:864
    ds_write2_b32 v195, v16, v17 offset0:48 offset1:96
    ds_write_b32 v195, v18 offset:576
    ds_write_b16 v196, v19 offset:768
K2_ov_15:
    s_mov_b64 exec, -1
    v_cmp_lt_i32 vcc, 10, v180
    s_nop 0
    s_cbranch_vccz K2_OV_DONE
    v_subrev_u32 v192, 65536, v55
    v_mul_hi_u32_u24 v193, s60, v192
    v_mul_u32_u24 v192, s60, v192
    v_alignbit_b32 v192, v193, v192, 24
    v_lshlrev_b32 v192, 2, v192
    ds_bpermute_b32 v199, v192, v205
    v_subrev_u32 v192, 48, v45
    v_cmp_gt_u32 s[62:63], 16, v192
    s_waitcnt lgkmcnt(0)
    s_and_b64 exec, vcc, s[62:63]
    s_cbranch_execz K2_ov_16
    v_lshrrev_b32 v193, 18, v199
    v_add_u32 v192, v192, v193
    v_and_b32 v199, 0x3ffff, v199
    v_lshl_add_u32 v194, v192, 5, v199
    v_lshl_add_u32 v195, v192, 2, v199
    v_and_b32 v196, 7, v192
    v_add_lshl_u32 v196, v196, v192, 1
    v_bfe_u32 v193, v192, 3, 1
    v_mad_i32_i24 v196, v193, -14, v196
    v_add_u32 v196, v196, v199
    ds_write_b32 v194, v65 offset:864
    ds_write2_b32 v195, v20, v21 offset0:48 offset1:96
    ds_write_b32 v195, v22 offset:576
    ds_write_b16 v196, v23 offset:768
K2_ov_16:
    s_mov_b64 exec, -1
    v_cmp_lt_i32 vcc, 12, v180
    s_nop 0
    s_cbranch_vccz K2_OV_DONE
    v_subrev_u32 v192, 65536, v56
    v_mul_hi_u32_u24 v193, s60, v192
    v_mul_u32_u24 v192, s60, v192
    v_alignbit_b32 v192, v193, v192, 24
    v_lshlrev_b32 v192, 2, v192
    ds_bpermute_b32 v199, v192, v205
    v_subrev_u32 v192, 48, v46
    v_cmp_gt_u32 s[62:63], 16, v192
    s_waitcnt lgkmcnt(0)
    s_and_b64 exec, vcc, s[62:63]
    s_cbranch_execz K2_ov_17
    v_lshrrev_b32 v193, 18, v199
    v_add_u32 v192, v192, v193
    v_and_b32 v199, 0x3ffff, v199
    v_lshl_add_u32 v194, v192, 5, v199
    v_lshl_add_u32 v195, v192, 2, v199
    v_and_b32 v196, 7, v192
    v_add_lshl_u32 v196, v196, v192, 1
    v_bfe_u32 v193, v192, 3, 1
    v_mad_i32_i24 v196, v193, -14, v196
    v_add_u32 v196, v196, v199
    ds_write_b32 v194, v66 offset:864
    ds_write2_b32 v195, v24, v25 offset0:48 offset1:96
    ds_write_b32 v195, v26 offset:576
    ds_write_b16 v196, v27 offset:768
K2_ov_17:
    s_mov_b64 exec, -1
    v_cmp_lt_i32 vcc, 14, v180
    s_nop 0
    s_cbranch_vccz K2_OV_DONE
    v_subrev_u32 v192, 65536, v57
    v_mul_hi_u32_u24 v193, s60, v192
    v_mul_u32_u24 v192, s60, v192
    v_alignbit_b32 v192, v193, v192, 24
    v_lshlrev_b32 v192, 2, v192
    ds_bpermute_b32 v199, v192, v205
    v_subrev_u32 v192, 48, v47
    v_cmp_gt_u32 s[62:63], 16, v192
    s_waitcnt lgkmcnt(0)
    s_and_b64 exec, vcc, s[62:63]
    s_cbranch_execz K2_ov_18
    v_lshrrev_b32 v193, 18, v199
    v_add_u32 v192, v192, v193
    v_and_b32 v199, 0x3ffff, v199
    v_lshl_add_u32 v194, v192, 5, v199
    v_lshl_add_u32 v195, v192, 2, v199
    v_and_b32 v196, 7, v192
    v_add_lshl_u32 v196, v196, v192, 1
    v_bfe_u32 v193, v192, 3, 1
    v_mad_i32_i24 v196, v193, -14, v196
    v_add_u32 v196, v196, v199
    ds_write_b32 v194, v67 offset:864
    ds_write2_b32 v195, v28, v29 offset0:48 offset1:96
    ds_write_b32 v195, v30 offset:576
    ds_write_b16 v196, v31 offset:768
K2_ov_18:
    s_mov_b64 exec, -1
    v_cmp_lt_i32 vcc, 16, v180
    s_nop 0
    s_cbranch_vccz K2_OV_DONE
    v_subrev_u32 v192, 65536, v58
    v_mul_hi_u32_u24 v193, s60, v192
    v_mul_u32_u24 v192, s60, v192
    v_alignbit_b32 v192, v193, v192, 24
    v_lshlrev_b32 v192, 2, v192
    ds_bpermute_b32 v199, v192, v205
    v_subrev_u32 v192, 48, v48
    v_cmp_gt_u32 s[62:63], 16, v192
    s_waitcnt lgkmcnt(0)
    s_and_b64 exec, vcc, s[62:63]
    s_cbranch_execz K2_ov_19
    v_lshrrev_b32 v193, 18, v199
    v_add_u32 v192, v192, v193
    v_and_b32 v199, 0x3ffff, v199
    v_lshl_add_u32 v194, v192, 5, v199
    v_lshl_add_u32 v195, v192, 2, v199
    v_and_b32 v196, 7, v192
    v_add_lshl_u32 v196, v196, v192, 1
    v_bfe_u32 v193, v192, 3, 1
    v_mad_i32_i24 v196, v193, -14, v196
    v_add_u32 v196, v196, v199
    ds_write_b32 v194, v68 offset:864
    ds_write2_b32 v195, v32, v33 offset0:48 offset1:96
    ds_write_b32 v195, v34 offset:576
    ds_write_b16 v196, v35 offset:768
K2_ov_19:
    s_mov_b64 exec, -1
    v_cmp_lt_i32 vcc, 18, v180
    s_nop 0
    s_cbranch_vccz K2_OV_DONE
    v_subrev_u32 v192, 65536, v59
    v_mul_hi_u32_u24 v193, s60, v192
    v_mul_u32_u24 v192, s60, v192
    v_alignbit_b32 v192, v193, v192, 24
    v_lshlrev_b32 v192, 2, v192
    ds_bpermute_b32 v199, v192, v205
    v_subrev_u32 v192, 48, v49
    v_cmp_gt_u32 s[62:63], 16, v192
    s_waitcnt lgkmcnt(0)
    s_and_b64 exec, vcc, s[62:63]
    s_cbranch_execz K2_ov_20
    v_lshrrev_b32 v193, 18, v199
    v_add_u32 v192, v192, v193
    v_and_b32 v199, 0x3ffff, v199
    v_lshl_add_u32 v194, v192, 5, v199
    v_lshl_add_u32 v195, v192, 2, v199
    v_and_b32 v196, 7, v192
    v_add_lshl_u32 v196, v196, v192, 1
    v_bfe_u32 v193, v192, 3, 1
    v_mad_i32_i24 v196, v193, -14, v196
    v_add_u32 v196, v196, v199
    ds_write_b32 v194, v69 offset:864
    ds_write2_b32 v195, v36, v37 offset0:48 offset1:96
    ds_write_b32 v195, v38 offset:576
    ds_write_b16 v196, v39 offset:768
K2_ov_20:
    s_mov_b64 exec, -1
K2_OV_DONE:
    v_mov_b32 v193, v203
    v_mov_b32 v195, v204
    s_waitcnt lgkmcnt(0)
    s_barrier
    s_branch K2_TOK
K2_SLOW:
    v_mov_b32 v197, v193
    s_nop 1
    v_max_u32_dpp v197, v197, v197 row_shr:1 row_mask:0xf bank_mask:0xf bound_ctrl:0
    s_nop 1
    v_max_u32_dpp v197, v197, v197 row_shr:2 row_mask:0xf bank_mask:0xf bound_ctrl:0
    s_nop 1
    v_max_u32_dpp v197, v197, v197 row_shr:4 row_mask:0xf bank_mask:0xf bound_ctrl:0
    s_nop 1
    v_max_u32_dpp v197, v197, v197 row_shr:8 row_mask:0xf bank_mask:0xf bound_ctrl:0
    s_nop 1
    v_max_u32_dpp v197, v197, v197 row_bcast:15 row_mask:0xa bank_mask:0xf
    s_nop 1
    v_max_u32_dpp v197, v197, v197 row_bcast:31 row_mask:0xc bank_mask:0xf
    s_nop 0
    v_readlane_b32 s25, v197, 63
    s_nop 0
    s_add_u32 s25, s25, 47
    s_mul_i32 s25, s25, 43691
    s_lshr_b32 s25, s25, 21
    v_cmp_lt_i32 vcc, 0, v180
    s_nop 0
    s_cbranch_vccz K2_SV_DONE
    s_mov_b64 exec, vcc
    buffer_store_dword v40, v179, s[8:11], s66 offen offset:0
    v_cmp_lt_i32 vcc, 2, v180
    s_nop 0
    s_cbranch_vccz K2_SV_DONE
    s_mov_b64 exec, vcc
    buffer_store_dword v41, v179, s[8:11], s66 offen offset:8
    v_cmp_lt_i32 vcc, 4, v180
    s_nop 0
    s_cbranch_vccz K2_SV_DONE
    s_mov_b64 exec, vcc
    buffer_store_dword v42, v179, s[8:11], s66 offen offset:16
    v_cmp_lt_i32 vcc, 6, v180
    s_nop 0
    s_cbranch_vccz K2_SV_DONE
    s_mov_b64 exec, vcc
    buffer_store_dword v43, v179, s[8:11], s66 offen offset:24
    v_cmp_lt_i32 vcc, 8, v180
    s_nop 0
    s_cbranch_vccz K2_SV_DONE
    s_mov_b64 exec, vcc
    buffer_store_dword v44, v179, s[8:11], s66 offen offset:32
    v_cmp_lt_i32 vcc, 10, v180
    s_nop 0
    s_cbranch_vccz K2_SV_DONE
    s_mov_b64 exec, vcc
    buffer_store_dword v45, v179, s[8:11], s66 offen offset:40
    v_cmp_lt_i32 vcc, 12, v180
    s_nop 0
    s_cbranch_vccz K2_SV_DONE
    s_mov_b64 exec, vcc
    buffer_store_dword v46, v179, s[8:11], s66 offen offset:48
    v_cmp_lt_i32 vcc, 14, v180
    s_nop 0
    s_cbranch_vccz K2_SV_DONE
    s_mov_b64 exec, vcc
    buffer_store_dword v47, v179, s[8:11], s66 offen offset:56
    v_cmp_lt_i32 vcc, 16, v180
    s_nop 0
    s_cbranch_vccz K2_SV_DONE
    s_mov_b64 exec, vcc
    buffer_store_dword v48, v179, s[8:11], s66 offen offset:64
    v_cmp_lt_i32 vcc, 18, v180
    s_nop 0
    s_cbranch_vccz K2_SV_DONE
    s_mov_b64 exec, vcc
    buffer_store_dword v49, v179, s[8:11], s66 offen offset:72
K2_SV_DONE:
    s_mov_b64 exec, -1
    s_branch K2_TOK
K2_rare_21:
    s_cmp_eq_u32 s33, 4
    s_cbranch_scc1 K2_four_23
    s_mov_b32 s49, s48
    s_mov_b32 s51, s48
    s_add_u32 s45, s44, 256
    s_add_u32 s46, s44, 512
    s_add_u32 s47, s44, 768
    s_branch K2_back_22
K2_four_23:
    s_add_u32 s50, s48, 64
    s_lshr_b32 s51, s3, 27
    s_mov_b32 s66, 161536
    s_cmp_ge_u32 s51, 2
    s_cselect_b32 s66, 159072, s66
    s_mul_i32 s51, s51, 32
    s_add_u32 s51, s51, s66
    s_mov_b32 s46, s44
    s_mov_b32 s47, s44
    s_branch K2_back_22
K2_dum_24:
    v_mov_b32 v232, -1
    s_mov_b32 m0, 163712
    s_mov_b64 exec, 1
    buffer_load_dwordx4 v232, s[16:19], 0 offen lds
    buffer_load_dwordx4 v232, s[16:19], 0 offen lds
    s_mov_b64 exec, -1
    s_branch K2_back_26
K2_a4_25:
    s_lshr_b32 s65, s3, 27
    s_mov_b32 s66, 161536
    s_cmp_ge_u32 s65, 2
    s_cselect_b32 s66, 158112, s66
    s_mul_i32 s65, s65, 512
    s_add_u32 s65, s65, s66
    v_add_u32 v232, s65, v230
    ds_read_b32 v232, v232
    s_add_u32 m0, s65, 864
    s_waitcnt lgkmcnt(0)
    v_or_b32 v232, v232, v231
    buffer_load_dwordx4 v232, s[16:19], 0 offen  lds
    s_branch K2_b4_27
K2_nul_30:
    s_mov_b32 s58, 63
    s_mov_b32 s36, 0
    s_branch K2_back_33
K2_spin_31:
    v_lshl_add_u32 v233, v252, 1, s53
    ds_read_b32 v233, v233
    s_waitcnt lgkmcnt(0)
    s_branch K2_chk_32
K2_dyn_28:
    v_mov_b32 v254, 163648
    v_mov_b32 v255, 1
    v_lshl_add_u32 v233, v252, 1, s53
    s_mov_b64 exec, 1
    ds_add_rtn_u32 v232, v254, v255
    s_mov_b64 exec, -1
    ds_read_b32 v233, v233
    s_waitcnt lgkmcnt(0)
    v_readfirstlane_b32 s58, v232
    s_nop 0
    s_cmp_lt_u32 s58, s22
    s_cbranch_scc0 K2_nul_30
    s_and_b32 s59, s58, 7
    s_lshr_b32 s60, s58, 3
K2_chk_32:
    v_readlane_b32 s61, v233, s59
    s_nop 0
    s_cmp_gt_u32 s61, s60
    s_cbranch_scc0 K2_spin_31
K2_back_33:
    s_mov_b32 s34, 1
    s_branch K2_back_29
K2_rare_34:
    s_cmp_eq_u32 s33, 4
    s_cbranch_scc1 K2_four_36
    s_mov_b32 s49, s48
    s_mov_b32 s51, s48
    s_add_u32 s45, s44, 256
    s_add_u32 s46, s44, 512
    s_add_u32 s47, s44, 768
    s_branch K2_back_35
K2_four_36:
    s_add_u32 s50, s48, 64
    s_lshr_b32 s51, s3, 27
    s_mov_b32 s66, 161536
    s_cmp_ge_u32 s51, 2
    s_cselect_b32 s66, 159072, s66
    s_mul_i32 s51, s51, 32
    s_add_u32 s51, s51, s66
    s_mov_b32 s46, s44
    s_mov_b32 s47, s44
    s_branch K2_back_35
K2_dum_37:
    v_mov_b32 v232, -1
    s_mov_b32 m0, 163712
    s_mov_b64 exec, 1
    buffer_load_dwordx4 v232, s[16:19], 0 offen lds
    buffer_load_dwordx4 v232, s[16:19], 0 offen lds
    s_mov_b64 exec, -1
    s_branch K2_back_39
K2_a4_38:
    s_lshr_b32 s65, s3, 27
    s_mov_b32 s66, 161536
    s_cmp_ge_u32 s65, 2
    s_cselect_b32 s66, 158112, s66
    s_mul_i32 s65, s65, 512
    s_add_u32 s65, s65, s66
    v_add_u32 v232, s65, v230
    ds_read_b32 v232, v232
    s_add_u32 m0, s65, 864
    s_waitcnt lgkmcnt(0)
    v_or_b32 v232, v232, v231
    buffer_load_dwordx4 v232, s[16:19], 0 offen  lds
    s_branch K2_b4_40
K2_nul_43:
    s_mov_b32 s58, 63
    s_mov_b32 s36, 0
    s_branch K2_back_46
K2_spin_44:
    v_lshl_add_u32 v233, v252, 1, s53
    ds_read_b32 v233, v233
    s_waitcnt lgkmcnt(0)
    s_branch K2_chk_45
K2_dyn_41:
    v_mov_b32 v254, 163648
    v_mov_b32 v255, 1
    v_lshl_add_u32 v233, v252, 1, s53
    s_mov_b64 exec, 1
    ds_add_rtn_u32 v232, v254, v255
    s_mov_b64 exec, -1
    ds_read_b32 v233, v233
    s_waitcnt lgkmcnt(0)
    v_readfirstlane_b32 s58, v232
    s_nop 0
    s_cmp_lt_u32 s58, s22
    s_cbranch_scc0 K2_nul_43
    s_and_b32 s59, s58, 7
    s_lshr_b32 s60, s58, 3
K2_chk_45:
    v_readlane_b32 s61, v233, s59
    s_nop 0
    s_cmp_gt_u32 s61, s60
    s_cbranch_scc0 K2_spin_44
K2_back_46:
    s_mov_b32 s34, 1
    s_branch K2_back_42
K2_rare_47:
    s_cmp_eq_u32 s33, 4
    s_cbranch_scc1 K2_four_49
    s_mov_b32 s49, s48
    s_mov_b32 s51, s48
    s_add_u32 s45, s44, 256
    s_add_u32 s46, s44, 512
    s_add_u32 s47, s44, 768
    s_branch K2_back_48
K2_four_49:
    s_add_u32 s50, s48, 64
    s_lshr_b32 s51, s3, 27
    s_mov_b32 s66, 161536
    s_cmp_ge_u32 s51, 2
    s_cselect_b32 s66, 159072, s66
    s_mul_i32 s51, s51, 32
    s_add_u32 s51, s51, s66
    s_mov_b32 s46, s44
    s_mov_b32 s47, s44
    s_branch K2_back_48
K2_dum_50:
    v_mov_b32 v232, -1
    s_mov_b32 m0, 163712
    s_mov_b64 exec, 1
    buffer_load_dwordx4 v232, s[16:19], 0 offen lds
    buffer_load_dwordx4 v232, s[16:19], 0 offen lds
    s_mov_b64 exec, -1
    s_branch K2_back_52
K2_a4_51:
    s_lshr_b32 s65, s3, 27
    s_mov_b32 s66, 161536
    s_cmp_ge_u32 s65, 2
    s_cselect_b32 s66, 158112, s66
    s_mul_i32 s65, s65, 512
    s_add_u32 s65, s65, s66
    v_add_u32 v232, s65, v230
    ds_read_b32 v232, v232
    s_add_u32 m0, s65, 864
    s_waitcnt lgkmcnt(0)
    v_or_b32 v232, v232, v231
    buffer_load_dwordx4 v232, s[16:19], 0 offen  lds
    s_branch K2_b4_53
K2_nul_54:
    s_mov_b32 s58, 63
    s_mov_b32 s36, 0
    s_branch K2_back_57
K2_spin_55:
    v_lshl_add_u32 v233, v252, 1, s53
    ds_read_b32 v233, v233
    s_waitcnt lgkmcnt(0)
    s_branch K2_chk_56
K2_rare_58:
    s_cmp_eq_u32 s33, 4
    s_cbranch_scc1 K2_four_60
    s_mov_b32 s49, s48
    s_mov_b32 s51, s48
    s_add_u32 s45, s44, 256
    s_add_u32 s46, s44, 512
    s_add_u32 s47, s44, 768
    s_branch K2_back_59
K2_four_60:
    s_add_u32 s50, s48, 64
    s_lshr_b32 s51, s3, 27
    s_mov_b32 s66, 161536
    s_cmp_ge_u32 s51, 2
    s_cselect_b32 s66, 159072, s66
    s_mul_i32 s51, s51, 32
    s_add_u32 s51, s51, s66
    s_mov_b32 s46, s44
    s_mov_b32 s47, s44
    s_branch K2_back_59
K2_nul_61:
    s_mov_b32 s58, 63
    s_mov_b32 s36, 0
    s_branch K2_back_64
K2_spin_62:
    v_lshl_add_u32 v233, v252, 1, s53
    ds_read_b32 v233, v233
    s_waitcnt lgkmcnt(0)
    s_branch K2_chk_63
K2_rare_65:
    s_cmp_eq_u32 s33, 4
    s_cbranch_scc1 K2_four_67
    s_mov_b32 s49, s48
    s_mov_b32 s51, s48
    s_add_u32 s45, s44, 256
    s_add_u32 s46, s44, 512
    s_add_u32 s47, s44, 768
    s_branch K2_back_66
K2_four_67:
    s_add_u32 s50, s48, 64
    s_lshr_b32 s51, s3, 27
    s_mov_b32 s66, 161536
    s_cmp_ge_u32 s51, 2
    s_cselect_b32 s66, 159072, s66
    s_mul_i32 s51, s51, 32
    s_add_u32 s51, s51, s66
    s_mov_b32 s46, s44
    s_mov_b32 s47, s44
    s_branch K2_back_66
K2_nul_70:
    s_mov_b32 s58, 63
    s_mov_b32 s36, 0
    s_branch K2_back_73
K2_spin_71:
    v_lshl_add_u32 v233, v252, 1, s53
    ds_read_b32 v233, v233
    s_waitcnt lgkmcnt(0)
    s_branch K2_chk_72
K2_dyn_68:
    v_mov_b32 v254, 163648
    v_mov_b32 v255, 1
    v_lshl_add_u32 v233, v252, 1, s53
    s_mov_b64 exec, 1
    ds_add_rtn_u32 v232, v254, v255
    s_mov_b64 exec, -1
    ds_read_b32 v233, v233
    s_waitcnt lgkmcnt(0)
    v_readfirstlane_b32 s58, v232
    s_nop 0
    s_cmp_lt_u32 s58, s22
    s_cbranch_scc0 K2_nul_70
    s_and_b32 s59, s58, 7
    s_lshr_b32 s60, s58, 3
K2_chk_72:
    v_readlane_b32 s61, v233, s59
    s_nop 0
    s_cmp_gt_u32 s61, s60
    s_cbranch_scc0 K2_spin_71
K2_back_73:
    s_mov_b32 s34, 1
    s_branch K2_back_69
K2_rare_74:
    s_cmp_eq_u32 s33, 4
    s_cbranch_scc1 K2_four_76
    s_mov_b32 s49, s48
    s_mov_b32 s51, s48
    s_add_u32 s45, s44, 256
    s_add_u32 s46, s44, 512
    s_add_u32 s47, s44, 768
    s_branch K2_back_75
K2_four_76:
    s_add_u32 s50, s48, 64
    s_lshr_b32 s51, s3, 27
    s_mov_b32 s66, 161536
    s_cmp_ge_u32 s51, 2
    s_cselect_b32 s66, 159072, s66
    s_mul_i32 s51, s51, 32
    s_add_u32 s51, s51, s66
    s_mov_b32 s46, s44
    s_mov_b32 s47, s44
    s_branch K2_back_75
K2_dum_77:
    v_mov_b32 v232, -1
    s_mov_b32 m0, 163712
    s_mov_b64 exec, 1
    buffer_load_dwordx4 v232, s[16:19], 0 offen lds
    buffer_load_dwordx4 v232, s[16:19], 0 offen lds
    s_mov_b64 exec, -1
    s_branch K2_back_79
K2_a4_78:
    s_lshr_b32 s65, s3, 27
    s_mov_b32 s66, 161536
    s_cmp_ge_u32 s65, 2
    s_cselect_b32 s66, 158112, s66
    s_mul_i32 s65, s65, 512
    s_add_u32 s65, s65, s66
    v_add_u32 v232, s65, v230
    ds_read_b32 v232, v232
    s_add_u32 m0, s65, 864
    s_waitcnt lgkmcnt(0)
    v_or_b32 v232, v232, v231
    buffer_load_dwordx4 v232, s[16:19], 0 offen  lds
    s_branch K2_b4_80
K2_nul_83:
    s_mov_b32 s58, 63
    s_mov_b32 s36, 0
    s_branch K2_back_86
K2_spin_84:
    v_lshl_add_u32 v233, v252, 1, s53
    ds_read_b32 v233, v233
    s_waitcnt lgkmcnt(0)
    s_branch K2_chk_85
K2_dyn_81:
    v_mov_b32 v254, 163648
    v_mov_b32 v255, 1
    v_lshl_add_u32 v233, v252, 1, s53
    s_mov_b64 exec, 1
    ds_add_rtn_u32 v232, v254, v255
    s_mov_b64 exec, -1
    ds_read_b32 v233, v233
    s_waitcnt lgkmcnt(0)
    v_readfirstlane_b32 s58, v232
    s_nop 0
    s_cmp_lt_u32 s58, s22
    s_cbranch_scc0 K2_nul_83
    s_and_b32 s59, s58, 7
    s_lshr_b32 s60, s58, 3
K2_chk_85:
    v_readlane_b32 s61, v233, s59
    s_nop 0
    s_cmp_gt_u32 s61, s60
    s_cbranch_scc0 K2_spin_84
K2_back_86:
    s_mov_b32 s34, 1
    s_branch K2_back_82
K2_rare_87:
    s_cmp_eq_u32 s33, 4
    s_cbranch_scc1 K2_four_89
    s_mov_b32 s49, s48
    s_mov_b32 s51, s48
    s_add_u32 s45, s44, 256
    s_add_u32 s46, s44, 512
    s_add_u32 s47, s44, 768
    s_branch K2_back_88
K2_four_89:
    s_add_u32 s50, s48, 64
    s_lshr_b32 s51, s3, 27
    s_mov_b32 s66, 161536
    s_cmp_ge_u32 s51, 2
    s_cselect_b32 s66, 159072, s66
    s_mul_i32 s51, s51, 32
    s_add_u32 s51, s51, s66
    s_mov_b32 s46, s44
    s_mov_b32 s47, s44
    s_branch K2_back_88
K2_dum_90:
    v_mov_b32 v232, -1
    s_mov_b32 m0, 163712
    s_mov_b64 exec, 1
    buffer_load_dwordx4 v232, s[16:19], 0 offen lds
    buffer_load_dwordx4 v232, s[16:19], 0 offen lds
    s_mov_b64 exec, -1
    s_branch K2_back_92
K2_a4_91:
    s_lshr_b32 s65, s3, 27
    s_mov_b32 s66, 161536
    s_cmp_ge_u32 s65, 2
    s_cselect_b32 s66, 158112, s66
    s_mul_i32 s65, s65, 512
    s_add_u32 s65, s65, s66
    v_add_u32 v232, s65, v230
    ds_read_b32 v232, v232
    s_add_u32 m0, s65, 864
    s_waitcnt lgkmcnt(0)
    v_or_b32 v232, v232, v231
    buffer_load_dwordx4 v232, s[16:19], 0 offen  lds
    s_branch K2_b4_93
K2_nul_94:
    s_mov_b32 s58, 63
    s_mov_b32 s36, 0
    s_branch K2_back_97
K2_spin_95:
    v_lshl_add_u32 v233, v252, 1, s53
    ds_read_b32 v233, v233
    s_waitcnt lgkmcnt(0)
    s_branch K2_chk_96
K2_rare_98:
    s_cmp_eq_u32 s33, 4
    s_cbranch_scc1 K2_four_100
    s_mov_b32 s49, s48
    s_mov_b32 s51, s48
    s_add_u32 s45, s44, 256
    s_add_u32 s46, s44, 512
    s_add_u32 s47, s44, 768
    s_branch K2_back_99
K2_four_100:
    s_add_u32 s50, s48, 64
    s_lshr_b32 s51, s3, 27
    s_mov_b32 s66, 161536
    s_cmp_ge_u32 s51, 2
    s_cselect_b32 s66, 159072, s66
    s_mul_i32 s51, s51, 32
    s_add_u32 s51, s51, s66
    s_mov_b32 s46, s44
    s_mov_b32 s47, s44
    s_branch K2_back_99
K2_nul_101:
    s_mov_b32 s58, 63
    s_mov_b32 s36, 0
    s_branch K2_back_104
K2_spin_102:
    v_lshl_add_u32 v233, v252, 1, s53
    ds_read_b32 v233, v233
    s_waitcnt lgkmcnt(0)
    s_branch K2_chk_103
K2_rare_105:
    s_cmp_eq_u32 s33, 4
    s_cbranch_scc1 K2_four_107
    s_mov_b32 s49, s48
    s_mov_b32 s51, s48
    s_add_u32 s45, s44, 256
    s_add_u32 s46, s44, 512
    s_add_u32 s47, s44, 768
    s_branch K2_back_106
K2_four_107:
    s_add_u32 s50, s48, 64
    s_lshr_b32 s51, s3, 27
    s_mov_b32 s66, 161536
    s_cmp_ge_u32 s51, 2
    s_cselect_b32 s66, 159072, s66
    s_mul_i32 s51, s51, 32
    s_add_u32 s51, s51, s66
    s_mov_b32 s46, s44
    s_mov_b32 s47, s44
    s_branch K2_back_106
K2_TAIL2:
    v_lshlrev_b32 v229, 3, v252
    s_mul_i32 s58, s20, 20480
    s_add_u32 s58, s58, 6946816
    buffer_load_dwordx4 v[96:99], v229, s[8:11], s58 offen offset:0 sc1
    buffer_load_dwordx4 v[100:103], v229, s[8:11], s58 offen offset:1024 sc1
    buffer_load_dwordx4 v[104:107], v229, s[8:11], s58 offen offset:2048 sc1
    buffer_load_dwordx4 v[108:111], v229, s[8:11], s58 offen offset:3072 sc1
    s_add_u32 s58, s58, 4096
    buffer_load_dwordx4 v[112:115], v229, s[8:11], s58 offen offset:0 sc1
    buffer_load_dwordx4 v[116:119], v229, s[8:11], s58 offen offset:1024 sc1
    buffer_load_dwordx4 v[120:123], v229, s[8:11], s58 offen offset:2048 sc1
    buffer_load_dwordx4 v[124:127], v229, s[8:11], s58 offen offset:3072 sc1
    s_add_u32 s58, s58, 4096
    buffer_load_dwordx4 v[128:131], v229, s[8:11], s58 offen offset:0 sc1
    buffer_load_dwordx4 v[132:135], v229, s[8:11], s58 offen offset:1024 sc1
    buffer_load_dwordx4 v[136:139], v229, s[8:11], s58 offen offset:2048 sc1
    buffer_load_dwordx4 v[140:143], v229, s[8:11], s58 offen offset:3072 sc1
    s_add_u32 s58, s58, 4096
    buffer_load_dwordx4 v[144:147], v229, s[8:11], s58 offen offset:0 sc1
    buffer_load_dwordx4 v[148:151], v229, s[8:11], s58 offen offset:1024 sc1
    buffer_load_dwordx4 v[152:155], v229, s[8:11], s58 offen offset:2048 sc1
    buffer_load_dwordx4 v[156:159], v229, s[8:11], s58 offen offset:3072 sc1
    s_add_u32 s58, s58, 4096
    buffer_load_dwordx4 v[160:163], v229, s[8:11], s58 offen offset:0 sc1
    buffer_load_dwordx4 v[164:167], v229, s[8:11], s58 offen offset:1024 sc1
    buffer_load_dwordx4 v[168:171], v229, s[8:11], s58 offen offset:2048 sc1
    buffer_load_dwordx4 v[172:175], v229, s[8:11], s58 offen offset:3072 sc1
    s_branch K2_TAIL3
K2_TAIL:
    v_lshlrev_b32 v229, 3, v252
    s_mul_i32 s58, s20, 20480
    s_add_u32 s58, s58, 6946816
    buffer_load_dwordx4 v[96:99], v229, s[8:11], s58 offen offset:0 sc1
    buffer_load_dwordx4 v[100:103], v229, s[8:11], s58 offen offset:1024 sc1
    buffer_load_dwordx4 v[104:107], v229, s[8:11], s58 offen offset:2048 sc1
    buffer_load_dwordx4 v[108:111], v229, s[8:11], s58 offen offset:3072 sc1
    s_add_u32 s58, s58, 4096
    buffer_load_dwordx4 v[112:115], v229, s[8:11], s58 offen offset:0 sc1
    buffer_load_dwordx4 v[116:119], v229, s[8:11], s58 offen offset:1024 sc1
    buffer_load_dwordx4 v[120:123], v229, s[8:11], s58 offen offset:2048 sc1
    buffer_load_dwordx4 v[124:127], v229, s[8:11], s58 offen offset:3072 sc1
    s_add_u32 s58, s58, 4096
    buffer_load_dwordx4 v[128:131], v229, s[8:11], s58 offen offset:0 sc1
    buffer_load_dwordx4 v[132:135], v229, s[8:11], s58 offen offset:1024 sc1
    buffer_load_dwordx4 v[136:139], v229, s[8:11], s58 offen offset:2048 sc1
    buffer_load_dwordx4 v[140:143], v229, s[8:11], s58 offen offset:3072 sc1
    s_add_u32 s58, s58, 4096
    buffer_load_dwordx4 v[144:147], v229, s[8:11], s58 offen offset:0 sc1
    buffer_load_dwordx4 v[148:151], v229, s[8:11], s58 offen offset:1024 sc1
    buffer_load_dwordx4 v[152:155], v229, s[8:11], s58 offen offset:2048 sc1
    buffer_load_dwordx4 v[156:159], v229, s[8:11], s58 offen offset:3072 sc1
    s_add_u32 s58, s58, 4096
    buffer_load_dwordx4 v[160:163], v229, s[8:11], s58 offen offset:0 sc1
    buffer_load_dwordx4 v[164:167], v229, s[8:11], s58 offen offset:1024 sc1
    buffer_load_dwordx4 v[168:171], v229, s[8:11], s58 offen offset:2048 sc1
    buffer_load_dwordx4 v[172:175], v229, s[8:11], s58 offen offset:3072 sc1
    v_permlane32_swap_b32 v242, v243
    v_permlane32_swap_b32 v240, v241
    v_permlane32_swap_b32 v236, v237
    v_permlane32_swap_b32 v244, v245
    v_add_f32 v242, v242, v243
    v_add_f32 v240, -v240, -v241
    v_add_f32 v236, v236, v237
    v_add_f32 v244, v244, v245
    v_cvt_pk_bf16_f32 v242, v242, v236
    v_cvt_pk_bf16_f32 v244, v244, v240
    v_cvt_pk_bf16_f32 v238, v238, v238
    ds_write_b16 v230, v242 offset:1152
    ds_write_b16_d16_hi v230, v242 offset:128
    ds_write_b16 v230, v244 offset:512
    ds_write_b16_d16_hi v230, v244 offset:896
    ds_write_b16 v230, v238 offset:1280
K2_TAIL3:
    s_mul_i32 s59, s20, 8224
    v_add_u32 v228, s59, v252
    s_waitcnt vmcnt(20)
    ds_write_b16 v228, v192 offset:0
    ds_write_b16_d16_hi v228, v192 offset:256
    ds_write_b16 v228, v193 offset:640
    ds_write_b16_d16_hi v228, v193 offset:1024
    ds_write_b16 v228, v194 offset:384
    ds_write_b16_d16_hi v228, v194 offset:768
    ds_write_b16 v228, v195 offset:1152
    ds_write_b16_d16_hi v228, v195 offset:128
    ds_write_b16 v228, v196 offset:512
    ds_write_b16_d16_hi v228, v196 offset:896
    ds_write_b16 v228, v197 offset:1280
    ds_write_b16 v228, v198 offset:1536
    ds_write_b16_d16_hi v228, v198 offset:1792
    ds_write_b16 v228, v199 offset:2176
    ds_write_b16_d16_hi v228, v199 offset:2560
    ds_write_b16 v228, v200 offset:1920
    ds_write_b16_d16_hi v228, v200 offset:2304
    ds_write_b16 v228, v201 offset:2688
    ds_write_b16_d16_hi v228, v201 offset:1664
    ds_write_b16 v228, v202 offset:2048
    ds_write_b16_d16_hi v228, v202 offset:2432
    ds_write_b16 v228, v203 offset:2816
    ds_write_b16 v228, v204 offset:3072
    ds_write_b16_d16_hi v228, v204 offset:3328
    ds_write_b16 v228, v205 offset:3712
    ds_write_b16_d16_hi v228, v205 offset:4096
    ds_write_b16 v228, v206 offset:3456
    ds_write_b16_d16_hi v228, v206 offset:3840
    ds_write_b16 v228, v207 offset:4224
    ds_write_b16_d16_hi v228, v207 offset:3200
    ds_write_b16 v228, v208 offset:3584
    ds_write_b16_d16_hi v228, v208 offset:3968
    ds_write_b16 v228, v209 offset:4352
    ds_write_b16 v228, v210 offset:4608
    ds_write_b16_d16_hi v228, v210 offset:4864
    ds_write_b16 v228, v211 offset:5248
    ds_write_b16_d16_hi v228, v211 offset:5632
    ds_write_b16 v228, v212 offset:4992
    ds_write_b16_d16_hi v228, v212 offset:5376
    ds_write_b16 v228, v213 offset:5760
    ds_write_b16_d16_hi v228, v213 offset:4736
    ds_write_b16 v228, v214 offset:5120
    ds_write_b16_d16_hi v228, v214 offset:5504
    ds_write_b16 v228, v215 offset:5888
    ds_write_b16 v228, v216 offset:6144
    ds_write_b16_d16_hi v228, v216 offset:6400
    ds_write_b16 v228, v217 offset:6784
    ds_write_b16_d16_hi v228, v217 offset:7168
    ds_write_b16 v228, v218 offset:6528
    ds_write_b16_d16_hi v228, v218 offset:6912
    ds_write_b16 v228, v219 offset:7296
    ds_write_b16_d16_hi v228, v219 offset:6272
    ds_write_b16 v228, v220 offset:6656
    ds_write_b16_d16_hi v228, v220 offset:7040
    ds_write_b16 v228, v221 offset:7424
    v_bfe_u32 v48, v252, 1, 4
    v_lshlrev_b32 v49, 2, v48
    v_add_u32 v50, 64, v49
    v_add_u32 v51, 128, v49
    ds_bpermute_b32 v223, v49, v253
    ds_bpermute_b32 v224, v50, v253
    ds_bpermute_b32 v225, v51, v253
    v_lshrrev_b32 v49, 5, v252
    v_and_b32 v50, 7, v48
    v_mul_u32_u24 v50, 8224, v50
    v_lshrrev_b32 v51, 3, v48
    v_mul_u32_u24 v51, 1536, v51
    v_add_u32 v50, v50, v51
    v_lshlrev_b32 v52, 4, v49
    v_add_u32 v222, v50, v52
    s_lshl_b32 s60, s20, 5
    v_lshl_add_u32 v51, v49, 3, s60
    v_bfe_u32 v53, v48, 2, 1
    v_lshl_add_u32 v51, v53, 4, v51
    v_add_u32 v226, v50, v51
    s_sub_u32 s60, s22, 32
    v_cmp_gt_u32 s[56:57], s60, v48
    s_bfe_u32 s60, s20, 0x10002
    s_lshl_b32 s60, s60, 4
    s_add_u32 s59, s59, s60
    s_add_u32 s24, s24, 1
    s_cmp_ge_u32 s24, s25
    s_cselect_b32 s55, 1, 0
    s_cmp_eq_u32 s27, 0
    s_cselect_b32 s55, s55, 0
    s_and_b32 s64, s55, s28
    s_mov_b32 s63, 0xbfb8aa3b
    v_lshlrev_b32 v53, 5, v48
    s_waitcnt lgkmcnt(0)
    v_add_u32 v228, s59, v229
    v_and_b32 v51, 0x3ffff, v223
    v_sub_u32 v50, v53, v51
    v_and_b32 v50, 0xff, v50
    v_add3_u32 v223, v50, v51, v52
    v_and_b32 v51, 0x3ffff, v224
    v_sub_u32 v50, v53, v51
    v_and_b32 v50, 0xff, v50
    v_add3_u32 v224, v50, v51, v52
    v_and_b32 v51, 0x3ffff, v225
    v_sub_u32 v50, v53, v51
    v_and_b32 v50, 0xff, v50
    v_add3_u32 v225, v50, v51, v52
    s_barrier
    s_cmp_eq_u32 s64, 0
    s_cbranch_scc1 K2_MULTI
    ds_read_b128 v[48:51], v222 offset:0
    ds_read_b128 v[52:55], v222 offset:64
    ds_read_b128 v[56:59], v222 offset:128
    ds_read_b128 v[60:63], v222 offset:192
    ds_read_b128 v[64:67], v223 offset:0
    ds_read_b128 v[68:71], v223 offset:64
    ds_read_b128 v[72:75], v223 offset:128
    ds_read_b128 v[76:79], v223 offset:192
    ds_read_b128 v[80:83], v222 offset:256
    ds_read_b128 v[84:87], v222 offset:640
    ds_read_b128 v[88:91], v222 offset:1024
    s_waitcnt vmcnt(19) lgkmcnt(10)
    v_mfma_f32_16x16x32_bf16 v[0:3], v[96:99], v[48:51], 0
    ds_read_b128 v[92:95], v222 offset:320
    s_waitcnt vmcnt(18) lgkmcnt(10)
    v_mfma_f32_16x16x32_bf16 v[0:3], v[100:103], v[52:55], v[0:3]
    ds_read_b128 v[48:51], v222 offset:704
    s_waitcnt vmcnt(17) lgkmcnt(10)
    v_mfma_f32_16x16x32_bf16 v[0:3], v[104:107], v[56:59], v[0:3]
    ds_read_b128 v[52:55], v222 offset:1088
    s_waitcnt vmcnt(16) lgkmcnt(10)
    v_mfma_f32_16x16x32_bf16 v[0:3], v[108:111], v[60:63], v[0:3]
    ds_read_b128 v[56:59], v222 offset:384
    s_waitcnt vmcnt(15) lgkmcnt(10)
    v_mfma_f32_16x16x32_bf16 v[0:3], v[112:115], v[64:67], v[0:3]
    ds_read_b128 v[60:63], v222 offset:768
    s_waitcnt vmcnt(14) lgkmcnt(10)
    v_mfma_f32_16x16x32_bf16 v[0:3], v[116:119], v[68:71], v[0:3]
    ds_read_b128 v[64:67], v222 offset:1152
    s_waitcnt vmcnt(13) lgkmcnt(10)
    v_mfma_f32_16x16x32_bf16 v[0:3], v[120:123], v[72:75], v[0:3]
    ds_read_b128 v[68:71], v222 offset:448
    s_waitcnt vmcnt(12) lgkmcnt(10)
    v_mfma_f32_16x16x32_bf16 v[0:3], v[124:127], v[76:79], v[0:3]
    ds_read_b128 v[72:75], v222 offset:832
    s_waitcnt vmcnt(11) lgkmcnt(10)
    v_mfma_f32_16x16x32_bf16 v[4:7], v[128:131], v[80:83], 0
    ds_read_b128 v[76:79], v222 offset:1216
    s_waitcnt lgkmcnt(10)
    v_mfma_f32_16x16x32_bf16 v[8:11], v[128:131], v[84:87], 0
    ds_read_b128 v[80:83], v222 offset:512
    s_waitcnt lgkmcnt(10)
    v_mfma_f32_16x16x32_bf16 v[12:15], v[128:131], v[88:91], 0
    ds_read_b128 v[84:87], v222 offset:896
    s_waitcnt vmcnt(10) lgkmcnt(10)
    v_mfma_f32_16x16x32_bf16 v[4:7], v[132:135], v[92:95], v[4:7]
    ds_read_b128 v[88:91], v222 offset:1280
    s_waitcnt lgkmcnt(10)
    v_mfma_f32_16x16x32_bf16 v[8:11], v[132:135], v[48:51], v[8:11]
    ds_read_b128 v[92:95], v222 offset:576
    s_waitcnt lgkmcnt(10)
    v_mfma_f32_16x16x32_bf16 v[12:15], v[132:135], v[52:55], v[12:15]
    ds_read_b128 v[48:51], v222 offset:960
    s_waitcnt vmcnt(9) lgkmcnt(10)
    v_mfma_f32_16x16x32_bf16 v[4:7], v[136:139], v[56:59], v[4:7]
    ds_read_b128 v[52:55], v222 offset:1344
    s_waitcnt lgkmcnt(10)
    v_mfma_f32_16x16x32_bf16 v[8:11], v[136:139], v[60:63], v[8:11]
    ds_read_b128 v[56:59], v223 offset:256
    s_waitcnt lgkmcnt(10)
    v_mfma_f32_16x16x32_bf16 v[12:15], v[136:139], v[64:67], v[12:15]
    ds_read_b128 v[60:63], v223 offset:640
    s_waitcnt vmcnt(8) lgkmcnt(10)
    v_mfma_f32_16x16x32_bf16 v[4:7], v[140:143], v[68:71], v[4:7]
    ds_read_b128 v[64:67], v223 offset:1024
    s_waitcnt lgkmcnt(10)
    v_mfma_f32_16x16x32_bf16 v[8:11], v[140:143], v[72:75], v[8:11]
    ds_read_b128 v[68:71], v223 offset:320
    s_waitcnt lgkmcnt(10)
    v_mfma_f32_16x16x32_bf16 v[12:15], v[140:143], v[76:79], v[12:15]
    ds_read_b128 v[72:75], v223 offset:704
    s_waitcnt vmcnt(7) lgkmcnt(10)
    v_mfma_f32_16x16x32_bf16 v[4:7], v[144:147], v[80:83], v[4:7]
    ds_read_b128 v[76:79], v223 offset:1088
    s_waitcnt lgkmcnt(10)
    v_mfma_f32_16x16x32_bf16 v[8:11], v[144:147], v[84:87], v[8:11]
    ds_read_b128 v[80:83], v223 offset:384
    s_waitcnt lgkmcnt(10)
    v_mfma_f32_16x16x32_bf16 v[12:15], v[144:147], v[88:91], v[12:15]
    ds_read_b128 v[84:87], v223 offset:768
    s_waitcnt vmcnt(6) lgkmcnt(10)
    v_mfma_f32_16x16x32_bf16 v[4:7], v[148:151], v[92:95], v[4:7]
    ds_read_b128 v[88:91], v223 offset:1152
    s_waitcnt lgkmcnt(10)
    v_mfma_f32_16x16x32_bf16 v[8:11], v[148:151], v[48:51], v[8:11]
    ds_read_b128 v[92:95], v223 offset:448
    s_waitcnt lgkmcnt(10)
    v_mfma_f32_16x16x32_bf16 v[12:15], v[148:151], v[52:55], v[12:15]
    ds_read_b128 v[48:51], v223 offset:832
    s_waitcnt vmcnt(5) lgkmcnt(10)
    v_mfma_f32_16x16x32_bf16 v[4:7], v[152:155], v[56:59], v[4:7]
    ds_read_b128 v[52:55], v223 offset:1216
    s_waitcnt lgkmcnt(10)
    v_mfma_f32_16x16x32_bf16 v[8:11], v[152:155], v[60:63], v[8:11]
    ds_read_b128 v[56:59], v223 offset:512
    s_waitcnt lgkmcnt(10)
    v_mfma_f32_16x16x32_bf16 v[12:15], v[152:155], v[64:67], v[12:15]
    ds_read_b128 v[60:63], v223 offset:896
    s_waitcnt vmcnt(4) lgkmcnt(10)
    v_mfma_f32_16x16x32_bf16 v[4:7], v[156:159], v[68:71], v[4:7]
    ds_read_b128 v[64:67], v223 offset:1280
    s_waitcnt lgkmcnt(10)
    v_mfma_f32_16x16x32_bf16 v[8:11], v[156:159], v[72:75], v[8:11]
    ds_read_b128 v[68:71], v223 offset:576
    s_waitcnt lgkmcnt(10)
    v_mfma_f32_16x16x32_bf16 v[12:15], v[156:159], v[76:79], v[12:15]
    ds_read_b128 v[72:75], v223 offset:960
    s_waitcnt vmcnt(3) lgkmcnt(10)
    v_mfma_f32_16x16x32_bf16 v[4:7], v[160:163], v[80:83], v[4:7]
    ds_read_b128 v[76:79], v223 offset:1344
    s_waitcnt lgkmcnt(10)
    v_mfma_f32_16x16x32_bf16 v[8:11], v[160:163], v[84:87], v[8:11]
    ds_read_b128 v[80:83], v222 offset:3072
    s_waitcnt lgkmcnt(10)
    v_mfma_f32_16x16x32_bf16 v[12:15], v[160:163], v[88:91], v[12:15]
    ds_read_b128 v[84:87], v222 offset:3136
    s_waitcnt vmcnt(2) lgkmcnt(10)
    v_mfma_f32_16x16x32_bf16 v[4:7], v[164:167], v[92:95], v[4:7]
    ds_read_b128 v[88:91], v222 offset:3200
    s_waitcnt lgkmcnt(10)
    v_mfma_f32_16x16x32_bf16 v[8:11], v[164:167], v[48:51], v[8:11]
    ds_read_b128 v[92:95], v222 offset:3264
    s_waitcnt lgkmcnt(10)
    v_mfma_f32_16x16x32_bf16 v[12:15], v[164:167], v[52:55], v[12:15]
    ds_read_b128 v[48:51], v224 offset:0
    s_waitcnt vmcnt(1) lgkmcnt(10)
    v_mfma_f32_16x16x32_bf16 v[4:7], v[168:171], v[56:59], v[4:7]
    ds_read_b128 v[52:55], v224 offset:64
    s_waitcnt lgkmcnt(10)
    v_mfma_f32_16x16x32_bf16 v[8:11], v[168:171], v[60:63], v[8:11]
    ds_read_b128 v[56:59], v224 offset:128
    s_waitcnt lgkmcnt(10)
    v_mfma_f32_16x16x32_bf16 v[12:15], v[168:171], v[64:67], v[12:15]
    ds_read_b128 v[60:63], v224 offset:192
    s_waitcnt vmcnt(0) lgkmcnt(10)
    v_mfma_f32_16x16x32_bf16 v[4:7], v[172:175], v[68:71], v[4:7]
    ds_read_b128 v[64:67], v222 offset:3328
    s_waitcnt lgkmcnt(10)
    v_mfma_f32_16x16x32_bf16 v[8:11], v[172:175], v[72:75], v[8:11]
    ds_read_b128 v[68:71], v222 offset:3712
    s_waitcnt lgkmcnt(10)
    v_mfma_f32_16x16x32_bf16 v[12:15], v[172:175], v[76:79], v[12:15]
    ds_read_b128 v[72:75], v222 offset:4096
    s_waitcnt lgkmcnt(10)
    v_mfma_f32_16x16x32_bf16 v[16:19], v[96:99], v[80:83], 0
    ds_read_b128 v[76:79], v222 offset:3392
    s_waitcnt lgkmcnt(10)
    v_mfma_f32_16x16x32_bf16 v[16:19], v[100:103], v[84:87], v[16:19]
    ds_read_b128 v[80:83], v222 offset:3776
    s_waitcnt lgkmcnt(10)
    v_mfma_f32_16x16x32_bf16 v[16:19], v[104:107], v[88:91], v[16:19]
    s_barrier
    ds_read_b128 v[84:87], v222 offset:4160
    s_waitcnt lgkmcnt(10)
    v_mfma_f32_16x16x32_bf16 v[16:19], v[108:111], v[92:95], v[16:19]
    v_mul_f32 v200, s63, v0
    ds_read_b128 v[88:91], v222 offset:3456
    s_waitcnt lgkmcnt(10)
    v_mfma_f32_16x16x32_bf16 v[16:19], v[112:115], v[48:51], v[16:19]
    v_mul_f32 v201, s63, v1
    ds_read_b128 v[92:95], v222 offset:3840
    s_waitcnt lgkmcnt(10)
    v_mfma_f32_16x16x32_bf16 v[16:19], v[116:119], v[52:55], v[16:19]
    v_mul_f32 v202, s63, v2
    ds_read_b128 v[48:51], v222 offset:4224
    s_waitcnt lgkmcnt(10)
    v_mfma_f32_16x16x32_bf16 v[16:19], v[120:123], v[56:59], v[16:19]
    v_mul_f32 v203, s63, v3
    ds_read_b128 v[52:55], v222 offset:3520
    s_waitcnt lgkmcnt(10)
    v_mfma_f32_16x16x32_bf16 v[16:19], v[124:127], v[60:63], v[16:19]
    v_exp_f32 v200, v200
    ds_read_b128 v[56:59], v222 offset:3904
    s_waitcnt lgkmcnt(10)
    v_mfma_f32_16x16x32_bf16 v[20:23], v[128:131], v[64:67], 0
    v_exp_f32 v201, v201
    ds_read_b128 v[60:63], v222 offset:4288
    s_waitcnt lgkmcnt(10)
    v_mfma_f32_16x16x32_bf16 v[24:27], v[128:131], v[68:71], 0
    v_exp_f32 v202, v202
    ds_read_b128 v[64:67], v222 offset:3584
    s_waitcnt lgkmcnt(10)
    v_mfma_f32_16x16x32_bf16 v[28:31], v[128:131], v[72:75], 0
    v_exp_f32 v203, v203
    ds_read_b128 v[68:71], v222 offset:3968
    s_waitcnt lgkmcnt(10)
    v_mfma_f32_16x16x32_bf16 v[20:23], v[132:135], v[76:79], v[20:23]
    v_add_f32 v200, 1.0, v200
    ds_read_b128 v[72:75], v222 offset:4352
    s_waitcnt lgkmcnt(10)
    v_mfma_f32_16x16x32_bf16 v[24:27], v[132:135], v[80:83], v[24:27]
    v_add_f32 v201, 1.0, v201
    ds_read_b128 v[76:79], v222 offset:3648
    s_waitcnt lgkmcnt(10)
    v_mfma_f32_16x16x32_bf16 v[28:31], v[132:135], v[84:87], v[28:31]
    v_add_f32 v202, 1.0, v202
    ds_read_b128 v[80:83], v222 offset:4032
    s_waitcnt lgkmcnt(10)
    v_mfma_f32_16x16x32_bf16 v[20:23], v[136:139], v[88:91], v[20:23]
    v_add_f32 v203, 1.0, v203
    ds_read_b128 v[84:87], v222 offset:4416
    s_waitcnt lgkmcnt(10)
    v_mfma_f32_16x16x32_bf16 v[24:27], v[136:139], v[92:95], v[24:27]
    v_rcp_f32 v200, v200
    ds_read_b128 v[88:91], v224 offset:256
    s_waitcnt lgkmcnt(10)
    v_mfma_f32_16x16x32_bf16 v[28:31], v[136:139], v[48:51], v[28:31]
    v_rcp_f32 v201, v201
    ds_read_b128 v[92:95], v224 offset:640
    s_waitcnt lgkmcnt(10)
    v_mfma_f32_16x16x32_bf16 v[20:23], v[140:143], v[52:55], v[20:23]
    v_rcp_f32 v202, v202
    ds_read_b128 v[48:51], v224 offset:1024
    s_waitcnt lgkmcnt(10)
    v_mfma_f32_16x16x32_bf16 v[24:27], v[140:143], v[56:59], v[24:27]
    v_rcp_f32 v203, v203
    ds_read_b128 v[52:55], v224 offset:320
    s_waitcnt lgkmcnt(10)
    v_mfma_f32_16x16x32_bf16 v[28:31], v[140:143], v[60:63], v[28:31]
    v_cvt_pk_bf16_f32 v176, v0, v1
    ds_read_b128 v[56:59], v224 offset:704
    s_waitcnt lgkmcnt(10)
    v_mfma_f32_16x16x32_bf16 v[20:23], v[144:147], v[64:67], v[20:23]
    v_cvt_pk_bf16_f32 v177, v2, v3
    ds_read_b128 v[60:63], v224 offset:1088
    s_waitcnt lgkmcnt(10)
    v_mfma_f32_16x16x32_bf16 v[24:27], v[144:147], v[68:71], v[24:27]
    v_mul_f32 v4, v4, v200
    ds_read_b128 v[64:67], v224 offset:384
    s_waitcnt lgkmcnt(10)
    v_mfma_f32_16x16x32_bf16 v[28:31], v[144:147], v[72:75], v[28:31]
    v_mul_f32 v5, v5, v201
    ds_read_b128 v[68:71], v224 offset:768
    s_waitcnt lgkmcnt(10)
    v_mfma_f32_16x16x32_bf16 v[20:23], v[148:151], v[76:79], v[20:23]
    v_mul_f32 v6, v6, v202
    ds_read_b128 v[72:75], v224 offset:1152
    s_waitcnt lgkmcnt(10)
    v_mfma_f32_16x16x32_bf16 v[24:27], v[148:151], v[80:83], v[24:27]
    v_mul_f32 v7, v7, v203
    ds_read_b128 v[76:79], v224 offset:448
    s_waitcnt lgkmcnt(10)
    v_mfma_f32_16x16x32_bf16 v[28:31], v[148:151], v[84:87], v[28:31]
    v_cvt_pk_bf16_f32 v178, v4, v5
    ds_read_b128 v[80:83], v224 offset:832
    s_waitcnt lgkmcnt(10)
    v_mfma_f32_16x16x32_bf16 v[20:23], v[152:155], v[88:91], v[20:23]
    v_cvt_pk_bf16_f32 v179, v6, v7
    ds_read_b128 v[84:87], v224 offset:1216
    s_waitcnt lgkmcnt(10)
    v_mfma_f32_16x16x32_bf16 v[24:27], v[152:155], v[92:95], v[24:27]
    v_mul_f32 v8, v8, v200
    ds_read_b128 v[88:91], v224 offset:512
    s_waitcnt lgkmcnt(10)
    v_mfma_f32_16x16x32_bf16 v[28:31], v[152:155], v[48:51], v[28:31]
    v_mul_f32 v9, v9, v201
    ds_read_b128 v[92:95], v224 offset:896
    s_waitcnt lgkmcnt(10)
    v_mfma_f32_16x16x32_bf16 v[20:23], v[156:159], v[52:55], v[20:23]
    v_mul_f32 v10, v10, v202
    ds_read_b128 v[48:51], v224 offset:1280
    s_waitcnt lgkmcnt(10)
    v_mfma_f32_16x16x32_bf16 v[24:27], v[156:159], v[56:59], v[24:27]
    v_mul_f32 v11, v11, v203
    ds_read_b128 v[52:55], v224 offset:576
    s_waitcnt lgkmcnt(10)
    v_mfma_f32_16x16x32_bf16 v[28:31], v[156:159], v[60:63], v[28:31]
    v_cvt_pk_bf16_f32 v180, v8, v9
    ds_read_b128 v[56:59], v224 offset:960
    s_waitcnt lgkmcnt(10)
    v_mfma_f32_16x16x32_bf16 v[20:23], v[160:163], v[64:67], v[20:23]
    v_cvt_pk_bf16_f32 v181, v10, v11
    ds_read_b128 v[60:63], v224 offset:1344
    s_waitcnt lgkmcnt(10)
    v_mfma_f32_16x16x32_bf16 v[24:27], v[160:163], v[68:71], v[24:27]
    v_mul_f32 v12, v12, v200
    ds_read_b128 v[64:67], v222 offset:6144
    s_waitcnt lgkmcnt(10)
    v_mfma_f32_16x16x32_bf16 v[28:31], v[160:163], v[72:75], v[28:31]
    v_mul_f32 v13, v13, v201
    ds_read_b128 v[68:71], v222 offset:6208
    s_waitcnt lgkmcnt(10)
    v_mfma_f32_16x16x32_bf16 v[20:23], v[164:167], v[76:79], v[20:23]
    v_mul_f32 v14, v14, v202
    ds_read_b128 v[72:75], v222 offset:6272
    s_waitcnt lgkmcnt(10)
    v_mfma_f32_16x16x32_bf16 v[24:27], v[164:167], v[80:83], v[24:27]
    v_mul_f32 v15, v15, v203
    ds_read_b128 v[76:79], v222 offset:6336
    s_waitcnt lgkmcnt(10)
    v_mfma_f32_16x16x32_bf16 v[28:31], v[164:167], v[84:87], v[28:31]
    v_cvt_pk_bf16_f32 v182, v12, v13
    ds_read_b128 v[80:83], v225 offset:0
    s_waitcnt lgkmcnt(10)
    v_mfma_f32_16x16x32_bf16 v[20:23], v[168:171], v[88:91], v[20:23]
    v_cvt_pk_bf16_f32 v183, v14, v15
    ds_read_b128 v[84:87], v225 offset:64
    s_waitcnt lgkmcnt(10)
    v_mfma_f32_16x16x32_bf16 v[24:27], v[168:171], v[92:95], v[24:27]
    ds_write_b64 v226, v[176:177] offset:0
    ds_write_b64 v226, v[178:179] offset:256
    ds_write_b64 v226, v[180:181] offset:512
    ds_write_b64 v226, v[182:183] offset:768
    ds_read_b128 v[88:91], v225 offset:128
    s_waitcnt lgkmcnt(14)
    v_mfma_f32_16x16x32_bf16 v[28:31], v[168:171], v[48:51], v[28:31]
    ds_read_b128 v[92:95], v225 offset:192
    s_waitcnt lgkmcnt(14)
    v_mfma_f32_16x16x32_bf16 v[20:23], v[172:175], v[52:55], v[20:23]
    ds_read_b128 v[48:51], v222 offset:6400
    s_waitcnt lgkmcnt(14)
    v_mfma_f32_16x16x32_bf16 v[24:27], v[172:175], v[56:59], v[24:27]
    ds_read_b128 v[52:55], v222 offset:6784
    s_waitcnt lgkmcnt(14)
    v_mfma_f32_16x16x32_bf16 v[28:31], v[172:175], v[60:63], v[28:31]
    ds_read_b128 v[56:59], v222 offset:7168
    s_waitcnt lgkmcnt(14)
    v_mfma_f32_16x16x32_bf16 v[32:35], v[96:99], v[64:67], 0
    ds_read_b128 v[60:63], v222 offset:6464
    s_waitcnt lgkmcnt(14)
    v_mfma_f32_16x16x32_bf16 v[32:35], v[100:103], v[68:71], v[32:35]
    ds_read_b128 v[64:67], v222 offset:6848
    s_waitcnt lgkmcnt(14)
    v_mfma_f32_16x16x32_bf16 v[32:35], v[104:107], v[72:75], v[32:35]
    ds_read_b128 v[68:71], v222 offset:7232
    s_waitcnt lgkmcnt(14)
    v_mfma_f32_16x16x32_bf16 v[32:35], v[108:111], v[76:79], v[32:35]
    v_mul_f32 v200, s63, v16
    ds_read_b128 v[72:75], v222 offset:6528
    s_waitcnt lgkmcnt(14)
    v_mfma_f32_16x16x32_bf16 v[32:35], v[112:115], v[80:83], v[32:35]
    v_mul_f32 v201, s63, v17
    ds_read_b128 v[76:79], v222 offset:6912
    s_waitcnt lgkmcnt(14)
    v_mfma_f32_16x16x32_bf16 v[32:35], v[116:119], v[84:87], v[32:35]
    v_mul_f32 v202, s63, v18
    ds_read_b128 v[80:83], v222 offset:7296
    s_waitcnt lgkmcnt(10)
    v_mfma_f32_16x16x32_bf16 v[32:35], v[120:123], v[88:91], v[32:35]
    v_mul_f32 v203, s63, v19
    ds_read_b128 v[84:87], v222 offset:6592
    s_waitcnt lgkmcnt(10)
    v_mfma_f32_16x16x32_bf16 v[32:35], v[124:127], v[92:95], v[32:35]
    s_barrier
    ds_read_b128 v[192:195], v228 offset:0
    ds_read_b128 v[196:199], v228 offset:1536
    v_exp_f32 v200, v200
    ds_read_b128 v[88:91], v222 offset:6976
    s_waitcnt lgkmcnt(12)
    v_mfma_f32_16x16x32_bf16 v[36:39], v[128:131], v[48:51], 0
    v_exp_f32 v201, v201
    ds_read_b128 v[92:95], v222 offset:7360
    s_waitcnt lgkmcnt(12)
    v_mfma_f32_16x16x32_bf16 v[40:43], v[128:131], v[52:55], 0
    v_exp_f32 v202, v202
    ds_read_b128 v[48:51], v222 offset:6656
    s_waitcnt lgkmcnt(12)
    v_mfma_f32_16x16x32_bf16 v[44:47], v[128:131], v[56:59], 0
    v_exp_f32 v203, v203
    ds_read_b128 v[52:55], v222 offset:7040
    s_waitcnt lgkmcnt(12)
    v_mfma_f32_16x16x32_bf16 v[36:39], v[132:135], v[60:63], v[36:39]
    v_add_f32 v200, 1.0, v200
    ds_read_b128 v[56:59], v222 offset:7424
    s_waitcnt lgkmcnt(12)
    v_mfma_f32_16x16x32_bf16 v[40:43], v[132:135], v[64:67], v[40:43]
    v_add_f32 v201, 1.0, v201
    ds_read_b128 v[60:63], v222 offset:6720
    s_waitcnt lgkmcnt(12)
    v_mfma_f32_16x16x32_bf16 v[44:47], v[132:135], v[68:71], v[44:47]
    v_add_f32 v202, 1.0, v202
    ds_read_b128 v[64:67], v222 offset:7104
    s_waitcnt lgkmcnt(12)
    v_mfma_f32_16x16x32_bf16 v[36:39], v[136:139], v[72:75], v[36:39]
    v_add_f32 v203, 1.0, v203
    ds_read_b128 v[68:71], v222 offset:7488
    s_waitcnt lgkmcnt(12)
    v_mfma_f32_16x16x32_bf16 v[40:43], v[136:139], v[76:79], v[40:43]
    v_rcp_f32 v200, v200
    ds_read_b128 v[72:75], v225 offset:256
    s_waitcnt lgkmcnt(12)
    v_mfma_f32_16x16x32_bf16 v[44:47], v[136:139], v[80:83], v[44:47]
    v_rcp_f32 v201, v201
    ds_read_b128 v[76:79], v225 offset:640
    s_waitcnt lgkmcnt(12)
    v_mfma_f32_16x16x32_bf16 v[36:39], v[140:143], v[84:87], v[36:39]
    v_rcp_f32 v202, v202
    ds_read_b128 v[80:83], v225 offset:1024
    s_waitcnt lgkmcnt(10)
    v_mfma_f32_16x16x32_bf16 v[40:43], v[140:143], v[88:91], v[40:43]
    v_rcp_f32 v203, v203
    ds_read_b128 v[84:87], v225 offset:320
    s_waitcnt lgkmcnt(10)
    v_mfma_f32_16x16x32_bf16 v[44:47], v[140:143], v[92:95], v[44:47]
    v_cvt_pk_bf16_f32 v184, v16, v17
    s_add_u32 s61, s20, 8
    v_readlane_b32 s41, v253, s61
    s_nop 0
    s_bfe_u32 s41, s41, 0x60015
    s_add_u32 s41, s41, s21
    s_lshl_b32 s41, s41, 10
    s_add_u32 s61, s20, 0
    v_readlane_b32 s40, v253, s61
    s_nop 0
    s_bfe_u32 s40, s40, 0x60015
    s_add_u32 s40, s40, s21
    s_lshl_b32 s40, s40, 10
    s_nop 0
    buffer_store_dwordx4 v[192:195], v229, s[12:15], s40 offen sc1
    buffer_store_dwordx4 v[196:199], v229, s[12:15], s41 offen sc1
    ds_read_b128 v[88:91], v225 offset:704
    s_waitcnt lgkmcnt(10)
    v_mfma_f32_16x16x32_bf16 v[36:39], v[144:147], v[48:51], v[36:39]
    v_cvt_pk_bf16_f32 v185, v18, v19
    ds_read_b128 v[92:95], v225 offset:1088
    s_waitcnt lgkmcnt(10)
    v_mfma_f32_16x16x32_bf16 v[40:43], v[144:147], v[52:55], v[40:43]
    v_mul_f32 v20, v20, v200
    ds_read_b128 v[48:51], v225 offset:384
    s_waitcnt lgkmcnt(10)
    v_mfma_f32_16x16x32_bf16 v[44:47], v[144:147], v[56:59], v[44:47]
    v_mul_f32 v21, v21, v201
    ds_read_b128 v[52:55], v225 offset:768
    s_waitcnt lgkmcnt(10)
    v_mfma_f32_16x16x32_bf16 v[36:39], v[148:151], v[60:63], v[36:39]
    v_mul_f32 v22, v22, v202
    ds_read_b128 v[56:59], v225 offset:1152
    s_waitcnt lgkmcnt(10)
    v_mfma_f32_16x16x32_bf16 v[40:43], v[148:151], v[64:67], v[40:43]
    v_mul_f32 v23, v23, v203
    ds_read_b128 v[60:63], v225 offset:448
    s_waitcnt lgkmcnt(10)
    v_mfma_f32_16x16x32_bf16 v[44:47], v[148:151], v[68:71], v[44:47]
    v_cvt_pk_bf16_f32 v186, v20, v21
    ds_read_b128 v[64:67], v225 offset:832
    s_waitcnt lgkmcnt(10)
    v_mfma_f32_16x16x32_bf16 v[36:39], v[152:155], v[72:75], v[36:39]
    v_cvt_pk_bf16_f32 v187, v22, v23
    ds_read_b128 v[68:71], v225 offset:1216
    s_waitcnt lgkmcnt(10)
    v_mfma_f32_16x16x32_bf16 v[40:43], v[152:155], v[76:79], v[40:43]
    v_mul_f32 v24, v24, v200
    ds_read_b128 v[72:75], v225 offset:512
    s_waitcnt lgkmcnt(10)
    v_mfma_f32_16x16x32_bf16 v[44:47], v[152:155], v[80:83], v[44:47]
    v_mul_f32 v25, v25, v201
    ds_read_b128 v[76:79], v225 offset:896
    s_waitcnt lgkmcnt(10)
    v_mfma_f32_16x16x32_bf16 v[36:39], v[156:159], v[84:87], v[36:39]
    v_mul_f32 v26, v26, v202
    ds_read_b128 v[80:83], v225 offset:1280
    s_waitcnt lgkmcnt(10)
    v_mfma_f32_16x16x32_bf16 v[40:43], v[156:159], v[88:91], v[40:43]
    v_mul_f32 v27, v27, v203
    ds_read_b128 v[84:87], v225 offset:576
    s_waitcnt lgkmcnt(10)
    v_mfma_f32_16x16x32_bf16 v[44:47], v[156:159], v[92:95], v[44:47]
    v_cvt_pk_bf16_f32 v188, v24, v25
    ds_read_b128 v[88:91], v225 offset:960
    s_waitcnt lgkmcnt(10)
    v_mfma_f32_16x16x32_bf16 v[36:39], v[160:163], v[48:51], v[36:39]
    v_cvt_pk_bf16_f32 v189, v26, v27
    ds_read_b128 v[92:95], v225 offset:1344
    s_waitcnt lgkmcnt(10)
    v_mfma_f32_16x16x32_bf16 v[40:43], v[160:163], v[52:55], v[40:43]
    v_mul_f32 v28, v28, v200
    s_waitcnt lgkmcnt(9)
    v_mfma_f32_16x16x32_bf16 v[44:47], v[160:163], v[56:59], v[44:47]
    v_mul_f32 v29, v29, v201
    s_waitcnt lgkmcnt(8)
    v_mfma_f32_16x16x32_bf16 v[36:39], v[164:167], v[60:63], v[36:39]
    v_mul_f32 v30, v30, v202
    s_waitcnt lgkmcnt(7)
    v_mfma_f32_16x16x32_bf16 v[40:43], v[164:167], v[64:67], v[40:43]
    v_mul_f32 v31, v31, v203
    s_waitcnt lgkmcnt(6)
    v_mfma_f32_16x16x32_bf16 v[44:47], v[164:167], v[68:71], v[44:47]
    v_cvt_pk_bf16_f32 v190, v28, v29
    s_waitcnt lgkmcnt(5)
    v_mfma_f32_16x16x32_bf16 v[36:39], v[168:171], v[72:75], v[36:39]
    v_cvt_pk_bf16_f32 v191, v30, v31
    s_waitcnt lgkmcnt(4)
    v_mfma_f32_16x16x32_bf16 v[40:43], v[168:171], v[76:79], v[40:43]
    ds_write_b64 v226, v[184:185] offset:3072
    ds_write_b64 v226, v[186:187] offset:3328
    ds_write_b64 v226, v[188:189] offset:3584
    ds_write_b64 v226, v[190:191] offset:3840
    s_waitcnt lgkmcnt(7)
    v_mfma_f32_16x16x32_bf16 v[44:47], v[168:171], v[80:83], v[44:47]
    s_waitcnt lgkmcnt(6)
    v_mfma_f32_16x16x32_bf16 v[36:39], v[172:175], v[84:87], v[36:39]
    s_waitcnt lgkmcnt(5)
    v_mfma_f32_16x16x32_bf16 v[40:43], v[172:175], v[88:91], v[40:43]
    s_waitcnt lgkmcnt(4)
    v_mfma_f32_16x16x32_bf16 v[44:47], v[172:175], v[92:95], v[44:47]
    v_mul_f32 v200, s63, v32
    v_mul_f32 v201, s63, v33
    v_mul_f32 v202, s63, v34
    v_mul_f32 v203, s63, v35
    v_exp_f32 v200, v200
    v_exp_f32 v201, v201
    v_exp_f32 v202, v202
    v_exp_f32 v203, v203
    v_add_f32 v200, 1.0, v200
    v_add_f32 v201, 1.0, v201
    v_add_f32 v202, 1.0, v202
    v_add_f32 v203, 1.0, v203
    v_rcp_f32 v200, v200
    v_rcp_f32 v201, v201
    v_rcp_f32 v202, v202
    v_rcp_f32 v203, v203
    v_cvt_pk_bf16_f32 v176, v32, v33
    v_cvt_pk_bf16_f32 v177, v34, v35
    v_mul_f32 v36, v36, v200
    v_mul_f32 v37, v37, v201
    v_mul_f32 v38, v38, v202
    v_mul_f32 v39, v39, v203
    v_cvt_pk_bf16_f32 v178, v36, v37
    v_cvt_pk_bf16_f32 v179, v38, v39
    v_mul_f32 v40, v40, v200
    v_mul_f32 v41, v41, v201
    v_mul_f32 v42, v42, v202
    v_mul_f32 v43, v43, v203
    v_cvt_pk_bf16_f32 v180, v40, v41
    v_cvt_pk_bf16_f32 v181, v42, v43
    v_mul_f32 v44, v44, v200
    v_mul_f32 v45, v45, v201
    v_mul_f32 v46, v46, v202
    v_mul_f32 v47, v47, v203
    v_cvt_pk_bf16_f32 v182, v44, v45
    v_cvt_pk_bf16_f32 v183, v46, v47
    s_waitcnt lgkmcnt(0)
    s_barrier
    ds_read_b128 v[192:195], v228 offset:3072
    ds_read_b128 v[196:199], v228 offset:4608
    s_mov_b64 exec, s[56:57]
    ds_write_b64 v226, v[176:177] offset:6144
    ds_write_b64 v226, v[178:179] offset:6400
    ds_write_b64 v226, v[180:181] offset:6656
    ds_write_b64 v226, v[182:183] offset:6912
    s_mov_b64 exec, -1
    s_add_u32 s61, s20, 24
    v_readlane_b32 s43, v253, s61
    s_nop 0
    s_bfe_u32 s43, s43, 0x60015
    s_add_u32 s43, s43, s21
    s_lshl_b32 s43, s43, 10
    s_add_u32 s61, s20, 16
    v_readlane_b32 s42, v253, s61
    s_nop 0
    s_bfe_u32 s42, s42, 0x60015
    s_add_u32 s42, s42, s21
    s_lshl_b32 s42, s42, 10
    s_waitcnt lgkmcnt(4)
    buffer_store_dwordx4 v[192:195], v229, s[12:15], s42 offen sc1
    buffer_store_dwordx4 v[196:199], v229, s[12:15], s43 offen sc1
    s_waitcnt lgkmcnt(0)
    s_barrier
K2_LASTROW:
    s_add_u32 s59, s20, 32
    s_cmp_ge_u32 s59, s22
    s_cbranch_scc1 K2_FIN
    ds_read_b128 v[192:195], v228 offset:6144
    s_add_u32 s61, s20, 32
    v_readlane_b32 s44, v253, s61
    s_nop 0
    s_bfe_u32 s44, s44, 0x60015
    s_add_u32 s44, s44, s21
    s_lshl_b32 s44, s44, 10
    s_waitcnt lgkmcnt(0)
    buffer_store_dwordx4 v[192:195], v229, s[12:15], s44 offen sc1
K2_FIN:
    s_branch K2_END
K2_MULTI:
    ds_read_b128 v[48:51], v222 offset:0
    ds_read_b128 v[52:55], v222 offset:64
    ds_read_b128 v[56:59], v222 offset:128
    ds_read_b128 v[60:63], v222 offset:192
    ds_read_b128 v[64:67], v223 offset:0
    ds_read_b128 v[68:71], v223 offset:64
    ds_read_b128 v[72:75], v223 offset:128
    ds_read_b128 v[76:79], v223 offset:192
    ds_read_b128 v[80:83], v222 offset:256
    ds_read_b128 v[84:87], v222 offset:640
    ds_read_b128 v[88:91], v222 offset:1024
    s_waitcnt vmcnt(19) lgkmcnt(10)
    v_mfma_f32_16x16x32_bf16 v[0:3], v[96:99], v[48:51], 0
    ds_read_b128 v[92:95], v222 offset:320
    s_waitcnt vmcnt(18) lgkmcnt(10)
    v_mfma_f32_16x16x32_bf16 v[0:3], v[100:103], v[52:55], v[0:3]
    ds_read_b128 v[48:51], v222 offset:704
    s_waitcnt vmcnt(17) lgkmcnt(10)
    v_mfma_f32_16x16x32_bf16 v[0:3], v[104:107], v[56:59], v[0:3]
    ds_read_b128 v[52:55], v222 offset:1088
    s_waitcnt vmcnt(16) lgkmcnt(10)
    v_mfma_f32_16x16x32_bf16 v[0:3], v[108:111], v[60:63], v[0:3]
    ds_read_b128 v[56:59], v222 offset:384
    s_waitcnt vmcnt(15) lgkmcnt(10)
    v_mfma_f32_16x16x32_bf16 v[0:3], v[112:115], v[64:67], v[0:3]
    ds_read_b128 v[60:63], v222 offset:768
    s_waitcnt vmcnt(14) lgkmcnt(10)
    v_mfma_f32_16x16x32_bf16 v[0:3], v[116:119], v[68:71], v[0:3]
    ds_read_b128 v[64:67], v222 offset:1152
    s_waitcnt vmcnt(13) lgkmcnt(10)
    v_mfma_f32_16x16x32_bf16 v[0:3], v[120:123], v[72:75], v[0:3]
    ds_read_b128 v[68:71], v222 offset:448
    s_waitcnt vmcnt(12) lgkmcnt(10)
    v_mfma_f32_16x16x32_bf16 v[0:3], v[124:127], v[76:79], v[0:3]
    ds_read_b128 v[72:75], v222 offset:832
    s_waitcnt vmcnt(11) lgkmcnt(10)
    v_mfma_f32_16x16x32_bf16 v[4:7], v[128:131], v[80:83], 0
    ds_read_b128 v[76:79], v222 offset:1216
    s_waitcnt lgkmcnt(10)
    v_mfma_f32_16x16x32_bf16 v[8:11], v[128:131], v[84:87], 0
    ds_read_b128 v[80:83], v222 offset:512
    s_waitcnt lgkmcnt(10)
    v_mfma_f32_16x16x32_bf16 v[12:15], v[128:131], v[88:91], 0
    ds_read_b128 v[84:87], v222 offset:896
    s_waitcnt vmcnt(10) lgkmcnt(10)
    v_mfma_f32_16x16x32_bf16 v[4:7], v[132:135], v[92:95], v[4:7]
    ds_read_b128 v[88:91], v222 offset:1280
    s_waitcnt lgkmcnt(10)
    v_mfma_f32_16x16x32_bf16 v[8:11], v[132:135], v[48:51], v[8:11]
    ds_read_b128 v[92:95], v222 offset:576
    s_waitcnt lgkmcnt(10)
    v_mfma_f32_16x16x32_bf16 v[12:15], v[132:135], v[52:55], v[12:15]
    ds_read_b128 v[48:51], v222 offset:960
    s_waitcnt vmcnt(9) lgkmcnt(10)
    v_mfma_f32_16x16x32_bf16 v[4:7], v[136:139], v[56:59], v[4:7]
    ds_read_b128 v[52:55], v222 offset:1344
    s_waitcnt lgkmcnt(10)
    v_mfma_f32_16x16x32_bf16 v[8:11], v[136:139], v[60:63], v[8:11]
    ds_read_b128 v[56:59], v223 offset:256
    s_waitcnt lgkmcnt(10)
    v_mfma_f32_16x16x32_bf16 v[12:15], v[136:139], v[64:67], v[12:15]
    ds_read_b128 v[60:63], v223 offset:640
    s_waitcnt vmcnt(8) lgkmcnt(10)
    v_mfma_f32_16x16x32_bf16 v[4:7], v[140:143], v[68:71], v[4:7]
    ds_read_b128 v[64:67], v223 offset:1024
    s_waitcnt lgkmcnt(10)
    v_mfma_f32_16x16x32_bf16 v[8:11], v[140:143], v[72:75], v[8:11]
    ds_read_b128 v[68:71], v223 offset:320
    s_waitcnt lgkmcnt(10)
    v_mfma_f32_16x16x32_bf16 v[12:15], v[140:143], v[76:79], v[12:15]
    ds_read_b128 v[72:75], v223 offset:704
    s_waitcnt vmcnt(7) lgkmcnt(10)
    v_mfma_f32_16x16x32_bf16 v[4:7], v[144:147], v[80:83], v[4:7]
    ds_read_b128 v[76:79], v223 offset:1088
    s_waitcnt lgkmcnt(10)
    v_mfma_f32_16x16x32_bf16 v[8:11], v[144:147], v[84:87], v[8:11]
    ds_read_b128 v[80:83], v223 offset:384
    s_waitcnt lgkmcnt(10)
    v_mfma_f32_16x16x32_bf16 v[12:15], v[144:147], v[88:91], v[12:15]
    ds_read_b128 v[84:87], v223 offset:768
    s_waitcnt vmcnt(6) lgkmcnt(10)
    v_mfma_f32_16x16x32_bf16 v[4:7], v[148:151], v[92:95], v[4:7]
    ds_read_b128 v[88:91], v223 offset:1152
    s_waitcnt lgkmcnt(10)
    v_mfma_f32_16x16x32_bf16 v[8:11], v[148:151], v[48:51], v[8:11]
    ds_read_b128 v[92:95], v223 offset:448
    s_waitcnt lgkmcnt(10)
    v_mfma_f32_16x16x32_bf16 v[12:15], v[148:151], v[52:55], v[12:15]
    ds_read_b128 v[48:51], v223 offset:832
    s_waitcnt vmcnt(5) lgkmcnt(10)
    v_mfma_f32_16x16x32_bf16 v[4:7], v[152:155], v[56:59], v[4:7]
    ds_read_b128 v[52:55], v223 offset:1216
    s_waitcnt lgkmcnt(10)
    v_mfma_f32_16x16x32_bf16 v[8:11], v[152:155], v[60:63], v[8:11]
    ds_read_b128 v[56:59], v223 offset:512
    s_waitcnt lgkmcnt(10)
    v_mfma_f32_16x16x32_bf16 v[12:15], v[152:155], v[64:67], v[12:15]
    ds_read_b128 v[60:63], v223 offset:896
    s_waitcnt vmcnt(4) lgkmcnt(10)
    v_mfma_f32_16x16x32_bf16 v[4:7], v[156:159], v[68:71], v[4:7]
    ds_read_b128 v[64:67], v223 offset:1280
    s_waitcnt lgkmcnt(10)
    v_mfma_f32_16x16x32_bf16 v[8:11], v[156:159], v[72:75], v[8:11]
    ds_read_b128 v[68:71], v223 offset:576
    s_waitcnt lgkmcnt(10)
    v_mfma_f32_16x16x32_bf16 v[12:15], v[156:159], v[76:79], v[12:15]
    ds_read_b128 v[72:75], v223 offset:960
    s_waitcnt vmcnt(3) lgkmcnt(10)
    v_mfma_f32_16x16x32_bf16 v[4:7], v[160:163], v[80:83], v[4:7]
    ds_read_b128 v[76:79], v223 offset:1344
    s_waitcnt lgkmcnt(10)
    v_mfma_f32_16x16x32_bf16 v[8:11], v[160:163], v[84:87], v[8:11]
    ds_read_b128 v[80:83], v222 offset:3072
    s_waitcnt lgkmcnt(10)
    v_mfma_f32_16x16x32_bf16 v[12:15], v[160:163], v[88:91], v[12:15]
    ds_read_b128 v[84:87], v222 offset:3136
    s_waitcnt vmcnt(2) lgkmcnt(10)
    v_mfma_f32_16x16x32_bf16 v[4:7], v[164:167], v[92:95], v[4:7]
    ds_read_b128 v[88:91], v222 offset:3200
    s_waitcnt lgkmcnt(10)
    v_mfma_f32_16x16x32_bf16 v[8:11], v[164:167], v[48:51], v[8:11]
    ds_read_b128 v[92:95], v222 offset:3264
    s_waitcnt lgkmcnt(10)
    v_mfma_f32_16x16x32_bf16 v[12:15], v[164:167], v[52:55], v[12:15]
    ds_read_b128 v[48:51], v224 offset:0
    s_waitcnt vmcnt(1) lgkmcnt(10)
    v_mfma_f32_16x16x32_bf16 v[4:7], v[168:171], v[56:59], v[4:7]
    ds_read_b128 v[52:55], v224 offset:64
    s_waitcnt lgkmcnt(10)
    v_mfma_f32_16x16x32_bf16 v[8:11], v[168:171], v[60:63], v[8:11]
    ds_read_b128 v[56:59], v224 offset:128
    s_waitcnt lgkmcnt(10)
    v_mfma_f32_16x16x32_bf16 v[12:15], v[168:171], v[64:67], v[12:15]
    ds_read_b128 v[60:63], v224 offset:192
    s_waitcnt vmcnt(0) lgkmcnt(10)
    v_mfma_f32_16x16x32_bf16 v[4:7], v[172:175], v[68:71], v[4:7]
    ds_read_b128 v[64:67], v222 offset:3328
    s_waitcnt lgkmcnt(10)
    v_mfma_f32_16x16x32_bf16 v[8:11], v[172:175], v[72:75], v[8:11]
    ds_read_b128 v[68:71], v222 offset:3712
    s_waitcnt lgkmcnt(10)
    v_mfma_f32_16x16x32_bf16 v[12:15], v[172:175], v[76:79], v[12:15]
    ds_read_b128 v[72:75], v222 offset:4096
    s_waitcnt lgkmcnt(10)
    v_mfma_f32_16x16x32_bf16 v[16:19], v[96:99], v[80:83], 0
    ds_read_b128 v[76:79], v222 offset:3392
    s_waitcnt lgkmcnt(10)
    v_mfma_f32_16x16x32_bf16 v[16:19], v[100:103], v[84:87], v[16:19]
    ds_read_b128 v[80:83], v222 offset:3776
    s_waitcnt lgkmcnt(10)
    v_mfma_f32_16x16x32_bf16 v[16:19], v[104:107], v[88:91], v[16:19]
    ds_read_b128 v[84:87], v222 offset:4160
    s_waitcnt lgkmcnt(10)
    v_mfma_f32_16x16x32_bf16 v[16:19], v[108:111], v[92:95], v[16:19]
    ds_read_b128 v[88:91], v222 offset:3456
    s_waitcnt lgkmcnt(10)
    v_mfma_f32_16x16x32_bf16 v[16:19], v[112:115], v[48:51], v[16:19]
    ds_read_b128 v[92:95], v222 offset:3840
    s_waitcnt lgkmcnt(10)
    v_mfma_f32_16x16x32_bf16 v[16:19], v[116:119], v[52:55], v[16:19]
    ds_read_b128 v[48:51], v222 offset:4224
    s_waitcnt lgkmcnt(10)
    v_mfma_f32_16x16x32_bf16 v[16:19], v[120:123], v[56:59], v[16:19]
    ds_read_b128 v[52:55], v222 offset:3520
    s_waitcnt lgkmcnt(10)
    v_mfma_f32_16x16x32_bf16 v[16:19], v[124:127], v[60:63], v[16:19]
    ds_read_b128 v[56:59], v222 offset:3904
    s_waitcnt lgkmcnt(10)
    v_mfma_f32_16x16x32_bf16 v[20:23], v[128:131], v[64:67], 0
    ds_read_b128 v[60:63], v222 offset:4288
    s_waitcnt lgkmcnt(10)
    v_mfma_f32_16x16x32_bf16 v[24:27], v[128:131], v[68:71], 0
    ds_read_b128 v[64:67], v222 offset:3584
    s_waitcnt lgkmcnt(10)
    v_mfma_f32_16x16x32_bf16 v[28:31], v[128:131], v[72:75], 0
    ds_read_b128 v[68:71], v222 offset:3968
    s_waitcnt lgkmcnt(10)
    v_mfma_f32_16x16x32_bf16 v[20:23], v[132:135], v[76:79], v[20:23]
    ds_read_b128 v[72:75], v222 offset:4352
    s_waitcnt lgkmcnt(10)
    v_mfma_f32_16x16x32_bf16 v[24:27], v[132:135], v[80:83], v[24:27]
    ds_read_b128 v[76:79], v222 offset:3648
    s_waitcnt lgkmcnt(10)
    v_mfma_f32_16x16x32_bf16 v[28:31], v[132:135], v[84:87], v[28:31]
    ds_read_b128 v[80:83], v222 offset:4032
    s_waitcnt lgkmcnt(10)
    v_mfma_f32_16x16x32_bf16 v[20:23], v[136:139], v[88:91], v[20:23]
    ds_read_b128 v[84:87], v222 offset:4416
    s_waitcnt lgkmcnt(10)
    v_mfma_f32_16x16x32_bf16 v[24:27], v[136:139], v[92:95], v[24:27]
    ds_read_b128 v[88:91], v224 offset:256
    s_waitcnt lgkmcnt(10)
    v_mfma_f32_16x16x32_bf16 v[28:31], v[136:139], v[48:51], v[28:31]
    ds_read_b128 v[92:95], v224 offset:640
    s_waitcnt lgkmcnt(10)
    v_mfma_f32_16x16x32_bf16 v[20:23], v[140:143], v[52:55], v[20:23]
    ds_read_b128 v[48:51], v224 offset:1024
    s_waitcnt lgkmcnt(10)
    v_mfma_f32_16x16x32_bf16 v[24:27], v[140:143], v[56:59], v[24:27]
    ds_read_b128 v[52:55], v224 offset:320
    s_waitcnt lgkmcnt(10)
    v_mfma_f32_16x16x32_bf16 v[28:31], v[140:143], v[60:63], v[28:31]
    ds_read_b128 v[56:59], v224 offset:704
    s_waitcnt lgkmcnt(10)
    v_mfma_f32_16x16x32_bf16 v[20:23], v[144:147], v[64:67], v[20:23]
    ds_read_b128 v[60:63], v224 offset:1088
    s_waitcnt lgkmcnt(10)
    v_mfma_f32_16x16x32_bf16 v[24:27], v[144:147], v[68:71], v[24:27]
    ds_read_b128 v[64:67], v224 offset:384
    s_waitcnt lgkmcnt(10)
    v_mfma_f32_16x16x32_bf16 v[28:31], v[144:147], v[72:75], v[28:31]
    ds_read_b128 v[68:71], v224 offset:768
    s_waitcnt lgkmcnt(10)
    v_mfma_f32_16x16x32_bf16 v[20:23], v[148:151], v[76:79], v[20:23]
    ds_read_b128 v[72:75], v224 offset:1152
    s_waitcnt lgkmcnt(10)
    v_mfma_f32_16x16x32_bf16 v[24:27], v[148:151], v[80:83], v[24:27]
    ds_read_b128 v[76:79], v224 offset:448
    s_waitcnt lgkmcnt(10)
    v_mfma_f32_16x16x32_bf16 v[28:31], v[148:151], v[84:87], v[28:31]
    ds_read_b128 v[80:83], v224 offset:832
    s_waitcnt lgkmcnt(10)
    v_mfma_f32_16x16x32_bf16 v[20:23], v[152:155], v[88:91], v[20:23]
    ds_read_b128 v[84:87], v224 offset:1216
    s_waitcnt lgkmcnt(10)
    v_mfma_f32_16x16x32_bf16 v[24:27], v[152:155], v[92:95], v[24:27]
    ds_read_b128 v[88:91], v224 offset:512
    s_waitcnt lgkmcnt(10)
    v_mfma_f32_16x16x32_bf16 v[28:31], v[152:155], v[48:51], v[28:31]
    ds_read_b128 v[92:95], v224 offset:896
    s_waitcnt lgkmcnt(10)
    v_mfma_f32_16x16x32_bf16 v[20:23], v[156:159], v[52:55], v[20:23]
    ds_read_b128 v[48:51], v224 offset:1280
    s_waitcnt lgkmcnt(10)
    v_mfma_f32_16x16x32_bf16 v[24:27], v[156:159], v[56:59], v[24:27]
    ds_read_b128 v[52:55], v224 offset:576
    s_waitcnt lgkmcnt(10)
    v_mfma_f32_16x16x32_bf16 v[28:31], v[156:159], v[60:63], v[28:31]
    ds_read_b128 v[56:59], v224 offset:960
    s_waitcnt lgkmcnt(10)
    v_mfma_f32_16x16x32_bf16 v[20:23], v[160:163], v[64:67], v[20:23]
    ds_read_b128 v[60:63], v224 offset:1344
    s_waitcnt lgkmcnt(10)
    v_mfma_f32_16x16x32_bf16 v[24:27], v[160:163], v[68:71], v[24:27]
    ds_read_b128 v[64:67], v222 offset:6144
    s_waitcnt lgkmcnt(10)
    v_mfma_f32_16x16x32_bf16 v[28:31], v[160:163], v[72:75], v[28:31]
    ds_read_b128 v[68:71], v222 offset:6208
    s_waitcnt lgkmcnt(10)
    v_mfma_f32_16x16x32_bf16 v[20:23], v[164:167], v[76:79], v[20:23]
    ds_read_b128 v[72:75], v222 offset:6272
    s_waitcnt lgkmcnt(10)
    v_mfma_f32_16x16x32_bf16 v[24:27], v[164:167], v[80:83], v[24:27]
    ds_read_b128 v[76:79], v222 offset:6336
    s_waitcnt lgkmcnt(10)
    v_mfma_f32_16x16x32_bf16 v[28:31], v[164:167], v[84:87], v[28:31]
    ds_read_b128 v[80:83], v225 offset:0
    s_waitcnt lgkmcnt(10)
    v_mfma_f32_16x16x32_bf16 v[20:23], v[168:171], v[88:91], v[20:23]
    ds_read_b128 v[84:87], v225 offset:64
    s_waitcnt lgkmcnt(10)
    v_mfma_f32_16x16x32_bf16 v[24:27], v[168:171], v[92:95], v[24:27]
    ds_read_b128 v[88:91], v225 offset:128
    s_waitcnt lgkmcnt(10)
    v_mfma_f32_16x16x32_bf16 v[28:31], v[168:171], v[48:51], v[28:31]
    ds_read_b128 v[92:95], v225 offset:192
    s_waitcnt lgkmcnt(10)
    v_mfma_f32_16x16x32_bf16 v[20:23], v[172:175], v[52:55], v[20:23]
    ds_read_b128 v[48:51], v222 offset:6400
    s_waitcnt lgkmcnt(10)
    v_mfma_f32_16x16x32_bf16 v[24:27], v[172:175], v[56:59], v[24:27]
    ds_read_b128 v[52:55], v222 offset:6784
    s_waitcnt lgkmcnt(10)
    v_mfma_f32_16x16x32_bf16 v[28:31], v[172:175], v[60:63], v[28:31]
    ds_read_b128 v[56:59], v222 offset:7168
    s_waitcnt lgkmcnt(10)
    v_mfma_f32_16x16x32_bf16 v[32:35], v[96:99], v[64:67], 0
    ds_read_b128 v[60:63], v222 offset:6464
    s_waitcnt lgkmcnt(10)
    v_mfma_f32_16x16x32_bf16 v[32:35], v[100:103], v[68:71], v[32:35]
    ds_read_b128 v[64:67], v222 offset:6848
    s_waitcnt lgkmcnt(10)
    v_mfma_f32_16x16x32_bf16 v[32:35], v[104:107], v[72:75], v[32:35]
    ds_read_b128 v[68:71], v222 offset:7232
    s_waitcnt lgkmcnt(10)
    v_mfma_f32_16x16x32_bf16 v[32:35], v[108:111], v[76:79], v[32:35]
    ds_read_b128 v[72:75], v222 offset:6528
    s_waitcnt lgkmcnt(10)
    v_mfma_f32_16x16x32_bf16 v[32:35], v[112:115], v[80:83], v[32:35]
    ds_read_b128 v[76:79], v222 offset:6912
    s_waitcnt lgkmcnt(10)
    v_mfma_f32_16x16x32_bf16 v[32:35], v[116:119], v[84:87], v[32:35]
    ds_read_b128 v[80:83], v222 offset:7296
    s_waitcnt lgkmcnt(10)
    v_mfma_f32_16x16x32_bf16 v[32:35], v[120:123], v[88:91], v[32:35]
    ds_read_b128 v[84:87], v222 offset:6592
    s_waitcnt lgkmcnt(10)
    v_mfma_f32_16x16x32_bf16 v[32:35], v[124:127], v[92:95], v[32:35]
    ds_read_b128 v[88:91], v222 offset:6976
    s_waitcnt lgkmcnt(10)
    v_mfma_f32_16x16x32_bf16 v[36:39], v[128:131], v[48:51], 0
    ds_read_b128 v[92:95], v222 offset:7360
    s_waitcnt lgkmcnt(10)
    v_mfma_f32_16x16x32_bf16 v[40:43], v[128:131], v[52:55], 0
    ds_read_b128 v[48:51], v222 offset:6656
    s_waitcnt lgkmcnt(10)
    v_mfma_f32_16x16x32_bf16 v[44:47], v[128:131], v[56:59], 0
    ds_read_b128 v[52:55], v222 offset:7040
    s_waitcnt lgkmcnt(10)
    v_mfma_f32_16x16x32_bf16 v[36:39], v[132:135], v[60:63], v[36:39]
    ds_read_b128 v[56:59], v222 offset:7424
    s_waitcnt lgkmcnt(10)
    v_mfma_f32_16x16x32_bf16 v[40:43], v[132:135], v[64:67], v[40:43]
    ds_read_b128 v[60:63], v222 offset:6720
    s_waitcnt lgkmcnt(10)
    v_mfma_f32_16x16x32_bf16 v[44:47], v[132:135], v[68:71], v[44:47]
    ds_read_b128 v[64:67], v222 offset:7104
    s_waitcnt lgkmcnt(10)
    v_mfma_f32_16x16x32_bf16 v[36:39], v[136:139], v[72:75], v[36:39]
    ds_read_b128 v[68:71], v222 offset:7488
    s_waitcnt lgkmcnt(10)
    v_mfma_f32_16x16x32_bf16 v[40:43], v[136:139], v[76:79], v[40:43]
    ds_read_b128 v[72:75], v225 offset:256
    s_waitcnt lgkmcnt(10)
    v_mfma_f32_16x16x32_bf16 v[44:47], v[136:139], v[80:83], v[44:47]
    ds_read_b128 v[76:79], v225 offset:640
    s_waitcnt lgkmcnt(10)
    v_mfma_f32_16x16x32_bf16 v[36:39], v[140:143], v[84:87], v[36:39]
    ds_read_b128 v[80:83], v225 offset:1024
    s_waitcnt lgkmcnt(10)
    v_mfma_f32_16x16x32_bf16 v[40:43], v[140:143], v[88:91], v[40:43]
    ds_read_b128 v[84:87], v225 offset:320
    s_waitcnt lgkmcnt(10)
    v_mfma_f32_16x16x32_bf16 v[44:47], v[140:143], v[92:95], v[44:47]
    ds_read_b128 v[88:91], v225 offset:704
    s_waitcnt lgkmcnt(10)
    v_mfma_f32_16x16x32_bf16 v[36:39], v[144:147], v[48:51], v[36:39]
    ds_read_b128 v[92:95], v225 offset:1088
    s_waitcnt lgkmcnt(10)
    v_mfma_f32_16x16x32_bf16 v[40:43], v[144:147], v[52:55], v[40:43]
    ds_read_b128 v[48:51], v225 offset:384
    s_waitcnt lgkmcnt(10)
    v_mfma_f32_16x16x32_bf16 v[44:47], v[144:147], v[56:59], v[44:47]
    ds_read_b128 v[52:55], v225 offset:768
    s_waitcnt lgkmcnt(10)
    v_mfma_f32_16x16x32_bf16 v[36:39], v[148:151], v[60:63], v[36:39]
    ds_read_b128 v[56:59], v225 offset:1152
    s_waitcnt lgkmcnt(10)
    v_mfma_f32_16x16x32_bf16 v[40:43], v[148:151], v[64:67], v[40:43]
    ds_read_b128 v[60:63], v225 offset:448
    s_waitcnt lgkmcnt(10)
    v_mfma_f32_16x16x32_bf16 v[44:47], v[148:151], v[68:71], v[44:47]
    ds_read_b128 v[64:67], v225 offset:832
    s_waitcnt lgkmcnt(10)
    v_mfma_f32_16x16x32_bf16 v[36:39], v[152:155], v[72:75], v[36:39]
    ds_read_b128 v[68:71], v225 offset:1216
    s_waitcnt lgkmcnt(10)
    v_mfma_f32_16x16x32_bf16 v[40:43], v[152:155], v[76:79], v[40:43]
    ds_read_b128 v[72:75], v225 offset:512
    s_waitcnt lgkmcnt(10)
    v_mfma_f32_16x16x32_bf16 v[44:47], v[152:155], v[80:83], v[44:47]
    ds_read_b128 v[76:79], v225 offset:896
    s_waitcnt lgkmcnt(10)
    v_mfma_f32_16x16x32_bf16 v[36:39], v[156:159], v[84:87], v[36:39]
    ds_read_b128 v[80:83], v225 offset:1280
    s_waitcnt lgkmcnt(10)
    v_mfma_f32_16x16x32_bf16 v[40:43], v[156:159], v[88:91], v[40:43]
    ds_read_b128 v[84:87], v225 offset:576
    s_waitcnt lgkmcnt(10)
    v_mfma_f32_16x16x32_bf16 v[44:47], v[156:159], v[92:95], v[44:47]
    ds_read_b128 v[88:91], v225 offset:960
    s_waitcnt lgkmcnt(10)
    v_mfma_f32_16x16x32_bf16 v[36:39], v[160:163], v[48:51], v[36:39]
    ds_read_b128 v[92:95], v225 offset:1344
    s_waitcnt lgkmcnt(10)
    v_mfma_f32_16x16x32_bf16 v[40:43], v[160:163], v[52:55], v[40:43]
    s_waitcnt lgkmcnt(9)
    v_mfma_f32_16x16x32_bf16 v[44:47], v[160:163], v[56:59], v[44:47]
    s_waitcnt lgkmcnt(8)
    v_mfma_f32_16x16x32_bf16 v[36:39], v[164:167], v[60:63], v[36:39]
    s_waitcnt lgkmcnt(7)
    v_mfma_f32_16x16x32_bf16 v[40:43], v[164:167], v[64:67], v[40:43]
    s_waitcnt lgkmcnt(6)
    v_mfma_f32_16x16x32_bf16 v[44:47], v[164:167], v[68:71], v[44:47]
    s_waitcnt lgkmcnt(5)
    v_mfma_f32_16x16x32_bf16 v[36:39], v[168:171], v[72:75], v[36:39]
    s_waitcnt lgkmcnt(4)
    v_mfma_f32_16x16x32_bf16 v[40:43], v[168:171], v[76:79], v[40:43]
    s_waitcnt lgkmcnt(3)
    v_mfma_f32_16x16x32_bf16 v[44:47], v[168:171], v[80:83], v[44:47]
    s_waitcnt lgkmcnt(2)
    v_mfma_f32_16x16x32_bf16 v[36:39], v[172:175], v[84:87], v[36:39]
    s_waitcnt lgkmcnt(1)
    v_mfma_f32_16x16x32_bf16 v[40:43], v[172:175], v[88:91], v[40:43]
    s_waitcnt lgkmcnt(0)
    v_mfma_f32_16x16x32_bf16 v[44:47], v[172:175], v[92:95], v[44:47]
    s_lshl_b32 s60, s54, 9
    s_lshl_b32 s61, s20, 6
    s_add_u32 s60, s60, s61
    s_mul_i32 s60, s60, 192
    s_add_u32 s60, s60, 10485760
    v_mul_u32_u24 v227, 96, v252
    s_cmp_lg_u32 s28, 0
    s_cbranch_scc1 K2_NOACC
    buffer_load_dwordx4 v[48:51], v227, s[8:11], s60 offen offset:0
    buffer_load_dwordx4 v[52:55], v227, s[8:11], s60 offen offset:16
    buffer_load_dwordx4 v[56:59], v227, s[8:11], s60 offen offset:32
    buffer_load_dwordx4 v[60:63], v227, s[8:11], s60 offen offset:48
    buffer_load_dwordx4 v[64:67], v227, s[8:11], s60 offen offset:64
    buffer_load_dwordx4 v[68:71], v227, s[8:11], s60 offen offset:80
    buffer_load_dwordx4 v[72:75], v227, s[8:11], s60 offen offset:96
    buffer_load_dwordx4 v[76:79], v227, s[8:11], s60 offen offset:112
    buffer_load_dwordx4 v[80:83], v227, s[8:11], s60 offen offset:128
    buffer_load_dwordx4 v[84:87], v227, s[8:11], s60 offen offset:144
    buffer_load_dwordx4 v[88:91], v227, s[8:11], s60 offen offset:160
    buffer_load_dwordx4 v[92:95], v227, s[8:11], s60 offen offset:176
    s_waitcnt vmcnt(0)
    v_add_f32 v0, v0, v48
    v_add_f32 v1, v1, v49
    v_add_f32 v2, v2, v50
    v_add_f32 v3, v3, v51
    v_add_f32 v4, v4, v52
    v_add_f32 v5, v5, v53
    v_add_f32 v6, v6, v54
    v_add_f32 v7, v7, v55
    v_add_f32 v8, v8, v56
    v_add_f32 v9, v9, v57
    v_add_f32 v10, v10, v58
    v_add_f32 v11, v11, v59
    v_add_f32 v12, v12, v60
    v_add_f32 v13, v13, v61
    v_add_f32 v14, v14, v62
    v_add_f32 v15, v15, v63
    v_add_f32 v16, v16, v64
    v_add_f32 v17, v17, v65
    v_add_f32 v18, v18, v66
    v_add_f32 v19, v19, v67
    v_add_f32 v20, v20, v68
    v_add_f32 v21, v21, v69
    v_add_f32 v22, v22, v70
    v_add_f32 v23, v23, v71
    v_add_f32 v24, v24, v72
    v_add_f32 v25, v25, v73
    v_add_f32 v26, v26, v74
    v_add_f32 v27, v27, v75
    v_add_f32 v28, v28, v76
    v_add_f32 v29, v29, v77
    v_add_f32 v30, v30, v78
    v_add_f32 v31, v31, v79
    v_add_f32 v32, v32, v80
    v_add_f32 v33, v33, v81
    v_add_f32 v34, v34, v82
    v_add_f32 v35, v35, v83
    v_add_f32 v36, v36, v84
    v_add_f32 v37, v37, v85
    v_add_f32 v38, v38, v86
    v_add_f32 v39, v39, v87
    v_add_f32 v40, v40, v88
    v_add_f32 v41, v41, v89
    v_add_f32 v42, v42, v90
    v_add_f32 v43, v43, v91
    v_add_f32 v44, v44, v92
    v_add_f32 v45, v45, v93
    v_add_f32 v46, v46, v94
    v_add_f32 v47, v47, v95
K2_NOACC:
    s_barrier
    s_cmp_eq_u32 s55, 0
    s_cbranch_scc1 K2_SPILL
    v_mul_f32 v200, s63, v0
    v_mul_f32 v201, s63, v1
    v_mul_f32 v202, s63, v2
    v_mul_f32 v203, s63, v3
    v_exp_f32 v200, v200
    v_exp_f32 v201, v201
    v_exp_f32 v202, v202
    v_exp_f32 v203, v203
    v_add_f32 v200, 1.0, v200
    v_add_f32 v201, 1.0, v201
    v_add_f32 v202, 1.0, v202
    v_add_f32 v203, 1.0, v203
    v_rcp_f32 v200, v200
    v_rcp_f32 v201, v201
    v_rcp_f32 v202, v202
    v_rcp_f32 v203, v203
    v_cvt_pk_bf16_f32 v176, v0, v1
    v_cvt_pk_bf16_f32 v177, v2, v3
    v_mul_f32 v4, v4, v200
    v_mul_f32 v5, v5, v201
    v_mul_f32 v6, v6, v202
    v_mul_f32 v7, v7, v203
    v_cvt_pk_bf16_f32 v178, v4, v5
    v_cvt_pk_bf16_f32 v179, v6, v7
    v_mul_f32 v8, v8, v200
    v_mul_f32 v9, v9, v201
    v_mul_f32 v10, v10, v202
    v_mul_f32 v11, v11, v203
    v_cvt_pk_bf16_f32 v180, v8, v9
    v_cvt_pk_bf16_f32 v181, v10, v11
    v_mul_f32 v12, v12, v200
    v_mul_f32 v13, v13, v201
    v_mul_f32 v14, v14, v202
    v_mul_f32 v15, v15, v203
    v_cvt_pk_bf16_f32 v182, v12, v13
    v_cvt_pk_bf16_f32 v183, v14, v15
    ds_write_b64 v226, v[176:177] offset:0
    ds_write_b64 v226, v[178:179] offset:256
    ds_write_b64 v226, v[180:181] offset:512
    ds_write_b64 v226, v[182:183] offset:768
    s_waitcnt lgkmcnt(0)
    s_barrier
    ds_read_b128 v[192:195], v228 offset:0
    ds_read_b128 v[196:199], v228 offset:1536
    s_add_u32 s61, s20, 8
    v_readlane_b32 s41, v253, s61
    s_nop 0
    s_bfe_u32 s41, s41, 0x60015
    s_add_u32 s41, s41, s21
    s_lshl_b32 s41, s41, 10
    s_add_u32 s61, s20, 0
    v_readlane_b32 s40, v253, s61
    s_nop 0
    s_bfe_u32 s40, s40, 0x60015
    s_add_u32 s40, s40, s21
    s_lshl_b32 s40, s40, 10
    s_waitcnt lgkmcnt(0)
    buffer_store_dwordx4 v[192:195], v229, s[12:15], s40 offen sc1
    buffer_store_dwordx4 v[196:199], v229, s[12:15], s41 offen sc1
    v_mul_f32 v200, s63, v16
    v_mul_f32 v201, s63, v17
    v_mul_f32 v202, s63, v18
    v_mul_f32 v203, s63, v19
    v_exp_f32 v200, v200
    v_exp_f32 v201, v201
    v_exp_f32 v202, v202
    v_exp_f32 v203, v203
    v_add_f32 v200, 1.0, v200
    v_add_f32 v201, 1.0, v201
    v_add_f32 v202, 1.0, v202
    v_add_f32 v203, 1.0, v203
    v_rcp_f32 v200, v200
    v_rcp_f32 v201, v201
    v_rcp_f32 v202, v202
    v_rcp_f32 v203, v203
    v_cvt_pk_bf16_f32 v184, v16, v17
    v_cvt_pk_bf16_f32 v185, v18, v19
    v_mul_f32 v20, v20, v200
    v_mul_f32 v21, v21, v201
    v_mul_f32 v22, v22, v202
    v_mul_f32 v23, v23, v203
    v_cvt_pk_bf16_f32 v186, v20, v21
    v_cvt_pk_bf16_f32 v187, v22, v23
    v_mul_f32 v24, v24, v200
    v_mul_f32 v25, v25, v201
    v_mul_f32 v26, v26, v202
    v_mul_f32 v27, v27, v203
    v_cvt_pk_bf16_f32 v188, v24, v25
    v_cvt_pk_bf16_f32 v189, v26, v27
    v_mul_f32 v28, v28, v200
    v_mul_f32 v29, v29, v201
    v_mul_f32 v30, v30, v202
    v_mul_f32 v31, v31, v203
    v_cvt_pk_bf16_f32 v190, v28, v29
    v_cvt_pk_bf16_f32 v191, v30, v31
    ds_write_b64 v226, v[184:185] offset:3072
    ds_write_b64 v226, v[186:187] offset:3328
    ds_write_b64 v226, v[188:189] offset:3584
    ds_write_b64 v226, v[190:191] offset:3840
    s_waitcnt lgkmcnt(0)
    s_barrier
    ds_read_b128 v[192:195], v228 offset:3072
    ds_read_b128 v[196:199], v228 offset:4608
    s_add_u32 s61, s20, 24
    v_readlane_b32 s43, v253, s61
    s_nop 0
    s_bfe_u32 s43, s43, 0x60015
    s_add_u32 s43, s43, s21
    s_lshl_b32 s43, s43, 10
    s_add_u32 s61, s20, 16
    v_readlane_b32 s42, v253, s61
    s_nop 0
    s_bfe_u32 s42, s42, 0x60015
    s_add_u32 s42, s42, s21
    s_lshl_b32 s42, s42, 10
    s_waitcnt lgkmcnt(0)
    buffer_store_dwordx4 v[192:195], v229, s[12:15], s42 offen sc1
    buffer_store_dwordx4 v[196:199], v229, s[12:15], s43 offen sc1
    v_mul_f32 v200, s63, v32
    v_mul_f32 v201, s63, v33
    v_mul_f32 v202, s63, v34
    v_mul_f32 v203, s63, v35
    v_exp_f32 v200, v200
    v_exp_f32 v201, v201
    v_exp_f32 v202, v202
    v_exp_f32 v203, v203
    v_add_f32 v200, 1.0, v200
    v_add_f32 v201, 1.0, v201
    v_add_f32 v202, 1.0, v202
    v_add_f32 v203, 1.0, v203
    v_rcp_f32 v200, v200
    v_rcp_f32 v201, v201
    v_rcp_f32 v202, v202
    v_rcp_f32 v203, v203
    v_cvt_pk_bf16_f32 v176, v32, v33
    v_cvt_pk_bf16_f32 v177, v34, v35
    v_mul_f32 v36, v36, v200
    v_mul_f32 v37, v37, v201
    v_mul_f32 v38, v38, v202
    v_mul_f32 v39, v39, v203
    v_cvt_pk_bf16_f32 v178, v36, v37
    v_cvt_pk_bf16_f32 v179, v38, v39
    v_mul_f32 v40, v40, v200
    v_mul_f32 v41, v41, v201
    v_mul_f32 v42, v42, v202
    v_mul_f32 v43, v43, v203
    v_cvt_pk_bf16_f32 v180, v40, v41
    v_cvt_pk_bf16_f32 v181, v42, v43
    v_mul_f32 v44, v44, v200
    v_mul_f32 v45, v45, v201
    v_mul_f32 v46, v46, v202
    v_mul_f32 v47, v47, v203
    v_cvt_pk_bf16_f32 v182, v44, v45
    v_cvt_pk_bf16_f32 v183, v46, v47
    s_mov_b64 exec, s[56:57]
    ds_write_b64 v226, v[176:177] offset:6144
    ds_write_b64 v226, v[178:179] offset:6400
    ds_write_b64 v226, v[180:181] offset:6656
    ds_write_b64 v226, v[182:183] offset:6912
    s_mov_b64 exec, -1
    s_waitcnt lgkmcnt(0)
    s_barrier
    s_branch K2_LASTROW
K2_SPILL:
    buffer_store_dwordx4 v[0:3], v227, s[8:11], s60 offen offset:0
    buffer_store_dwordx4 v[4:7], v227, s[8:11], s60 offen offset:16
    buffer_store_dwordx4 v[8:11], v227, s[8:11], s60 offen offset:32
    buffer_store_dwordx4 v[12:15], v227, s[8:11], s60 offen offset:48
    buffer_store_dwordx4 v[16:19], v227, s[8:11], s60 offen offset:64
    buffer_store_dwordx4 v[20:23], v227, s[8:11], s60 offen offset:80
    buffer_store_dwordx4 v[24:27], v227, s[8:11], s60 offen offset:96
    buffer_store_dwordx4 v[28:31], v227, s[8:11], s60 offen offset:112
    buffer_store_dwordx4 v[32:35], v227, s[8:11], s60 offen offset:128
    buffer_store_dwordx4 v[36:39], v227, s[8:11], s60 offen offset:144
    buffer_store_dwordx4 v[40:43], v227, s[8:11], s60 offen offset:160
    buffer_store_dwordx4 v[44:47], v227, s[8:11], s60 offen offset:176
    s_mov_b32 s28, 0
    s_waitcnt vmcnt(0)
    s_cmp_lt_u32 s24, s25
    s_cbranch_scc1 K2_LOAD
    s_add_u32 s23, s23, 20
    s_branch K2_WINDOW
K2_END:
    s_endpgm
.section .rodata,"a"
.p2align 6
.amdhsa_kernel standalone__tensor_product_equiv_equiformer__graph_kernel
  .amdhsa_next_free_vgpr 256
  .amdhsa_next_free_sgpr 102
  .amdhsa_accum_offset 256
  .amdhsa_group_segment_fixed_size 0
  .amdhsa_kernarg_size 96
  .amdhsa_user_sgpr_count 2
  .amdhsa_user_sgpr_kernarg_segment_ptr 1
  .amdhsa_system_sgpr_workgroup_id_x 1
  .amdhsa_float_denorm_mode_32 3
.end_amdhsa_kernel
```

```asm
; @launch grid=(256,1,1) block=(512,1,1) lds=163840
.amdgcn_target "amdgcn-amd-amdhsa--gfx950"
.text
.globl standalone__tensor_product_equiv_equiformer__graph_kernel
.p2align 8
.type standalone__tensor_product_equiv_equiformer__graph_kernel,@function
standalone__tensor_product_equiv_equiformer__graph_kernel:
    s_cmp_ge_u32 s2, 256
    s_cbranch_scc1 K2_END
    s_load_dwordx16 s[80:95], s[0:1], 0
    s_load_dwordx4 s[96:99], s[0:1], 72
    s_load_dwordx2 s[100:101], s[0:1], 88
    s_memrealtime s[74:75]
    v_lshrrev_b32 v1, 6, v0
    s_mov_b32 s54, s2
    v_readfirstlane_b32 s20, v1
    v_and_b32 v8, 63, v0
    v_lshlrev_b32 v9, 4, v8
    v_mov_b32 v6, 0
    v_lshlrev_b32 v5, 4, v0
    v_mul_u32_u24 v4, 24, v0
    s_mul_i32 s64, s2, 5120
    s_mul_i32 s65, s2, 7680
    v_mov_b32 v176, v8
    v_mov_b32 v177, v0
    s_mul_i32 s21, s2, 625
    s_add_u32 s22, s21, 640
    s_add_u32 s21, s21, 15
    s_lshr_b32 s21, s21, 4
    s_lshr_b32 s22, s22, 4
    s_sub_u32 s22, s22, s21
    s_movk_i32 s39, 1024
    s_lshl_b32 s37, s20, 13
    s_mov_b32 s53, 163616
    s_lshl_b32 s52, s20, 2
    s_add_u32 s52, s52, s53
    s_add_u32 s68, s37, 0
    s_add_u32 s69, s37, 2048
    s_add_u32 s70, s37, 4096
    s_add_u32 s71, s37, 6144
    s_waitcnt lgkmcnt(0)
    s_mov_b32 s8, s100
    s_and_b32 s9, s101, 0xffff
    s_mov_b32 s10, 37748736
    s_mov_b32 s11, 0x20000
    s_cmp_ge_u32 s20, 5
    s_cbranch_scc1 KS_HELP
    s_cmp_ge_u32 s2, 250
    s_cbranch_scc1 KS_IDLE
    s_mov_b32 s40, s88
    s_and_b32 s41, s89, 0xffff
    s_mov_b32 s42, 1280000
    s_mov_b32 s43, 0x20000
    buffer_load_dwordx4 v[12:15], v5, s[40:43], s64 offen
    s_mov_b32 s44, s86
    s_and_b32 s45, s87, 0xffff
    s_mov_b32 s46, 1280000
    s_mov_b32 s47, 0x20000
    s_mov_b32 s48, s82
    s_and_b32 s49, s83, 0xffff
    s_mov_b32 s50, 1920000
    s_mov_b32 s51, 0x20000
    buffer_load_dwordx4 v[16:19], v5, s[44:47], s64 offen
    buffer_load_dwordx4 v[20:23], v4, s[48:51], s65 offen
    buffer_load_dwordx2 v[24:25], v4, s[48:51], s65 offen offset:16
    v_lshlrev_b32 v2, 2, v0
    v_mov_b32 v7, 1
    s_cmp_eq_u32 s20, 4
    s_cbranch_scc1 KS_NOCLR
    ds_write_b32 v2, v6
KS_NOCLR:
    s_waitcnt lgkmcnt(0)
    s_barrier
    v_mul_u32_u24 v76, 2979, v0
    v_lshrrev_b32 v76, 16, v76
    v_mul_u32_u24 v77, 2048, v76
    v_lshl_add_u32 v78, v0, 4, v77
    v_add_u32 v78, 67584, v78
    v_add_u32 v79, 67200, v78
    v_mov_b32 v80, -1
    v_mov_b32 v81, -1
    v_cmp_gt_u32 vcc, 14, v76
    v_cmp_gt_u32 s[56:57], 12, v76
    v_mov_b32 v82, -1
    v_mov_b32 v83, -1
    s_mov_b64 exec, vcc
    ds_write_b128 v78, v[80:83]
    ds_write_b128 v78, v[80:83] offset:33600
    s_mov_b64 exec, s[56:57]
    ds_write_b128 v79, v[80:83]
    s_mov_b64 exec, -1
    s_mov_b32 s4, s80
    s_and_b32 s5, s81, 0xffff
    s_mov_b32 s6, 10240000
    s_mov_b32 s7, 0x20000
    s_mov_b32 s12, s96
    s_and_b32 s13, s97, 0xffff
    s_mov_b32 s14, 10240000
    s_mov_b32 s15, 0x20000
    s_mov_b32 s16, s84
    s_and_b32 s17, s85, 0xffff
    s_mov_b32 s18, 10240000
    s_mov_b32 s19, 0x20000
    s_sub_u32 s80, s80, 1024
    s_subb_u32 s81, s81, 0
    s_mov_b32 s72, s80
    s_and_b32 s73, s81, 0xffff
    s_mov_b32 s74, 10241024
    s_mov_b32 s75, 0x20000
    s_mov_b32 s58, 429497
    s_movk_i32 s59, 625
    s_waitcnt vmcnt(3)
    v_mul_u32_u24 v28, s58, v12
    v_lshrrev_b32 v32, 27, v28
    v_bfe_u32 v36, v28, 24, 3
    v_lshlrev_b32 v32, 2, v32
    v_lshl_or_b32 v32, v36, 7, v32
    ds_add_rtn_u32 v36, v32, v7
    v_mul_u32_u24 v29, s58, v13
    v_lshrrev_b32 v33, 27, v29
    v_bfe_u32 v37, v29, 24, 3
    v_lshlrev_b32 v33, 2, v33
    v_lshl_or_b32 v33, v37, 7, v33
    ds_add_rtn_u32 v37, v33, v7
    v_mul_u32_u24 v30, s58, v14
    v_lshrrev_b32 v34, 27, v30
    v_bfe_u32 v38, v30, 24, 3
    v_lshlrev_b32 v34, 2, v34
    v_lshl_or_b32 v34, v38, 7, v34
    ds_add_rtn_u32 v38, v34, v7
    v_mul_u32_u24 v31, s58, v15
    v_lshrrev_b32 v35, 27, v31
    v_bfe_u32 v39, v31, 24, 3
    v_lshlrev_b32 v35, 2, v35
    v_lshl_or_b32 v35, v39, 7, v35
    ds_add_rtn_u32 v39, v35, v7
    v_lshrrev_b32 v28, 24, v28
    v_mad_u32_u24 v28, v28, s59, 15
    v_lshrrev_b32 v28, 4, v28
    v_sub_u32 v28, v12, v28
    v_add_u32 v12, 0, v2
    v_lshlrev_b32 v12, 14, v12
    v_lshl_or_b32 v28, v28, 25, v12
    v_lshrrev_b32 v29, 24, v29
    v_mad_u32_u24 v29, v29, s59, 15
    v_lshrrev_b32 v29, 4, v29
    v_sub_u32 v29, v13, v29
    v_add_u32 v13, 1, v2
    v_lshlrev_b32 v13, 14, v13
    v_lshl_or_b32 v29, v29, 25, v13
    v_lshrrev_b32 v30, 24, v30
    v_mad_u32_u24 v30, v30, s59, 15
    v_lshrrev_b32 v30, 4, v30
    v_sub_u32 v30, v14, v30
    v_add_u32 v14, 2, v2
    v_lshlrev_b32 v14, 14, v14
    v_lshl_or_b32 v30, v30, 25, v14
    v_lshrrev_b32 v31, 24, v31
    v_mad_u32_u24 v31, v31, s59, 15
    v_lshrrev_b32 v31, 4, v31
    v_sub_u32 v31, v15, v31
    v_add_u32 v15, 3, v2
    v_lshlrev_b32 v15, 14, v15
    v_lshl_or_b32 v31, v31, 25, v15
    v_mov_b32 v59, 163728
    s_mul_i32 s65, s2, 1152
    s_add_u32 s65, s65, 6291456
    s_mul_i32 s64, s2, 20608
    s_waitcnt lgkmcnt(0)
    s_barrier
    ds_read_b128 v[40:43], v9
    ds_read_b32 v59, v59
    s_waitcnt lgkmcnt(1)
    v_add_u32 v45, v40, v41
    v_add_u32 v46, v45, v42
    v_add_u32 v47, v46, v43
    v_mov_b32 v58, v47
    s_nop 1
    v_add_u32_dpp v58, v58, v58 row_shr:1 row_mask:0xf bank_mask:0xf bound_ctrl:0
    s_nop 1
    v_add_u32_dpp v58, v58, v58 row_shr:2 row_mask:0xf bank_mask:0xf bound_ctrl:0
    s_nop 1
    v_add_u32_dpp v58, v58, v58 row_shr:4 row_mask:0xf bank_mask:0xf bound_ctrl:0
    s_nop 1
    v_add_u32_dpp v58, v58, v58 row_shr:8 row_mask:0xf bank_mask:0xf bound_ctrl:0
    s_nop 1
    v_add_u32_dpp v58, v58, v58 row_bcast:15 row_mask:0xa bank_mask:0xf
    s_nop 1
    v_add_u32_dpp v58, v58, v58 row_bcast:31 row_mask:0xc bank_mask:0xf
    v_sub_u32 v48, v58, v47
    v_add_u32 v49, v48, v40
    v_add_u32 v50, v48, v45
    v_add_u32 v51, v48, v46
    ds_write_b128 v9, v[48:51] offset:1024
    s_waitcnt vmcnt(0) lgkmcnt(1)
    s_cmp_lg_u32 s20, 4
    s_cbranch_scc1 KS_NOPUB
    v_lshl_or_b32 v56, v49, 11, v48
    v_lshl_or_b32 v57, v51, 11, v50
    v_lshl_or_b32 v56, v59, 22, v56
    v_lshl_or_b32 v57, v59, 22, v57
    buffer_store_dwordx4 v[56:59], v9, s[8:11], s65 offen sc1
KS_NOPUB:
    s_waitcnt lgkmcnt(0)
    ds_read_b32 v32, v32 offset:1024
    ds_read_b32 v33, v33 offset:1024
    ds_read_b32 v34, v34 offset:1024
    ds_read_b32 v35, v35 offset:1024
    v_and_b32 v60, 0xffff, v59
    s_mov_b32 s58, 0xffff0000
    v_mov_b32 v40, v20
    v_lshl_or_b32 v41, v21, 16, v60
    v_mov_b32 v42, v59
    v_or_b32 v43, v28, v16
    v_alignbit_b32 v44, v22, v21, 16
    v_and_or_b32 v45, v22, s58, v60
    v_mov_b32 v46, v59
    v_or_b32 v47, v29, v17
    v_mov_b32 v48, v23
    v_lshl_or_b32 v49, v24, 16, v60
    v_mov_b32 v50, v59
    v_or_b32 v51, v30, v18
    v_alignbit_b32 v52, v25, v24, 16
    v_and_or_b32 v53, v25, s58, v60
    v_mov_b32 v54, v59
    v_or_b32 v55, v31, v19
    s_waitcnt lgkmcnt(0)
    v_add_lshl_u32 v32, v32, v36, 4
    ds_write_b128 v32, v[40:43] offset:2048
    v_add_lshl_u32 v33, v33, v37, 4
    ds_write_b128 v33, v[44:47] offset:2048
    v_add_lshl_u32 v34, v34, v38, 4
    ds_write_b128 v34, v[48:51] offset:2048
    v_add_lshl_u32 v35, v35, v39, 4
    ds_write_b128 v35, v[52:55] offset:2048
    s_waitcnt lgkmcnt(0)
    s_barrier
    ds_read_b128 v[12:15], v5 offset:2048
    ds_read_b128 v[16:19], v5 offset:7168
    ds_read_b128 v[20:23], v5 offset:12288
    ds_read_b128 v[24:27], v5 offset:17408
    s_waitcnt lgkmcnt(3)
    buffer_store_dwordx4 v[12:15], v5, s[8:11], s64 offen sc1
    s_add_u32 s64, s64, 5120
    s_waitcnt lgkmcnt(2)
    buffer_store_dwordx4 v[16:19], v5, s[8:11], s64 offen sc1
    s_add_u32 s64, s64, 5120
    s_waitcnt lgkmcnt(1)
    buffer_store_dwordx4 v[20:23], v5, s[8:11], s64 offen sc1
    s_add_u32 s64, s64, 5120
    s_waitcnt lgkmcnt(0)
    buffer_store_dwordx4 v[24:27], v5, s[8:11], s64 offen sc1
    s_branch KS_JOIN
KS_IDLE:
    s_barrier
    v_mul_u32_u24 v76, 2979, v0
    v_lshrrev_b32 v76, 16, v76
    v_mul_u32_u24 v77, 2048, v76
    v_lshl_add_u32 v78, v0, 4, v77
    v_add_u32 v78, 67584, v78
    v_add_u32 v79, 67200, v78
    v_mov_b32 v80, -1
    v_mov_b32 v81, -1
    v_cmp_gt_u32 vcc, 14, v76
    v_cmp_gt_u32 s[56:57], 12, v76
    v_mov_b32 v82, -1
    v_mov_b32 v83, -1
    s_mov_b64 exec, vcc
    ds_write_b128 v78, v[80:83]
    ds_write_b128 v78, v[80:83] offset:33600
    s_mov_b64 exec, s[56:57]
    ds_write_b128 v79, v[80:83]
    s_mov_b64 exec, -1
    s_mov_b32 s4, s80
    s_and_b32 s5, s81, 0xffff
    s_mov_b32 s6, 10240000
    s_mov_b32 s7, 0x20000
    s_mov_b32 s12, s96
    s_and_b32 s13, s97, 0xffff
    s_mov_b32 s14, 10240000
    s_mov_b32 s15, 0x20000
    s_mov_b32 s16, s84
    s_and_b32 s17, s85, 0xffff
    s_mov_b32 s18, 10240000
    s_mov_b32 s19, 0x20000
    s_sub_u32 s80, s80, 1024
    s_subb_u32 s81, s81, 0
    s_mov_b32 s72, s80
    s_and_b32 s73, s81, 0xffff
    s_mov_b32 s74, 10241024
    s_mov_b32 s75, 0x20000
    s_barrier
    s_branch KS_B3
KS_HELP:
    s_cmp_eq_u32 s20, 7
    s_cbranch_scc1 KS_TAG
    s_cmp_eq_u32 s20, 6
    s_cbranch_scc1 KS_RAW
    s_cmp_ge_u32 s2, 200
    s_cbranch_scc1 KS_NOW
    v_and_b32 v1, 15, v8
    v_lshrrev_b32 v3, 4, v8
    s_cmp_ge_u32 s2, 160
    s_cbranch_scc1 K1_WT
    s_cmp_ge_u32 s2, 64
    s_cbranch_scc1 K1_S1
    s_lshr_b32 s24, s2, 3
    s_and_b32 s25, s2, 7
    s_lshr_b32 s26, s25, 2
    s_bfe_u32 s27, s25, 0x10001
    s_and_b32 s28, s25, 1
    s_mov_b32 s60, s92
    s_and_b32 s61, s93, 0xffff
    s_mov_b32 s62, 65536
    s_mov_b32 s63, 0x20000
    s_branch K1_SC
K1_S1:
    s_sub_u32 s29, s2, 64
    s_mul_i32 s24, s29, 43
    s_lshr_b32 s24, s24, 9
    s_mul_i32 s25, s24, 12
    s_sub_u32 s25, s29, s25
    s_cmp_ge_u32 s25, 6
    s_cselect_b32 s26, 1, 0
    s_mul_i32 s27, s26, 6
    s_sub_u32 s27, s25, s27
    s_lshr_b32 s27, s27, 1
    s_and_b32 s28, s25, 1
    s_add_u32 s25, s25, 8
    s_mov_b32 s60, s94
    s_and_b32 s61, s95, 0xffff
    s_mov_b32 s62, 98304
    s_mov_b32 s63, 0x20000
K1_SC:
    s_lshl_b32 s27, s27, 7
    s_lshl_b32 s26, s26, 6
    s_lshl_b32 s28, s28, 5
    s_add_u32 s27, s27, s26
    s_add_u32 s27, s27, s28
    s_lshl_b32 s27, s27, 8
    s_lshl_b32 s26, s24, 5
    s_add_u32 s27, s27, s26
    v_lshlrev_b32 v3, 11, v3
    v_lshl_add_u32 v3, v1, 1, v3
    buffer_load_ushort v64, v3, s[60:63], s27 offen offset:0
    buffer_load_ushort v65, v3, s[60:63], s27 offen offset:256
    buffer_load_ushort v66, v3, s[60:63], s27 offen offset:512
    buffer_load_ushort v67, v3, s[60:63], s27 offen offset:768
    buffer_load_ushort v68, v3, s[60:63], s27 offen offset:1024
    buffer_load_ushort v69, v3, s[60:63], s27 offen offset:1280
    buffer_load_ushort v70, v3, s[60:63], s27 offen offset:1536
    buffer_load_ushort v71, v3, s[60:63], s27 offen offset:1792
    s_mul_i32 s24, s24, 20
    s_add_u32 s24, s24, s25
    s_lshl_b32 s24, s24, 10
    s_add_u32 s24, s24, 6946816
    s_branch K1_GO
K1_WT:
    s_sub_u32 s24, s2, 160
    s_cmp_ge_u32 s24, 20
    s_cselect_b32 s26, 1, 0
    s_mul_i32 s25, s26, 20
    s_sub_u32 s25, s24, s25
    s_lshr_b32 s27, s25, 2
    s_bfe_u32 s28, s25, 0x10001
    s_and_b32 s25, s25, 1
    s_mul_i32 s25, s25, 10240
    s_lshl_b32 s27, s27, 8
    s_lshl_b32 s26, s26, 7
    s_lshl_b32 s28, s28, 6
    s_add_u32 s27, s27, s26
    s_add_u32 s27, s27, s28
    s_add_u32 s27, s27, s25
    s_mov_b32 s60, s90
    s_and_b32 s61, s91, 0xffff
    s_mov_b32 s62, 20480
    s_mov_b32 s63, 0x20000
    v_and_b32 v1, 31, v8
    v_lshrrev_b32 v3, 5, v8
    v_mul_u32_u24 v3, 5120, v3
    v_lshl_add_u32 v3, v1, 1, v3
    v_mov_b32 v64, 0
    v_mov_b32 v66, 0
    v_mov_b32 v68, 0
    v_mov_b32 v70, 0
    buffer_load_ushort v65, v3, s[60:63], s27 offen offset:0
    buffer_load_ushort v67, v3, s[60:63], s27 offen offset:1280
    buffer_load_ushort v69, v3, s[60:63], s27 offen offset:2560
    buffer_load_ushort v71, v3, s[60:63], s27 offen offset:3840
    s_lshl_b32 s24, s24, 10
    s_add_u32 s24, s24, 7110656
K1_GO:
    s_barrier
    v_subrev_u32 v76, 320, v0
    v_mov_b32 v80, -1
    v_mov_b32 v77, 1.0
    v_cmp_gt_u32 vcc, 48, v76
    v_lshlrev_b32 v78, 4, v76
    v_add_u32 v78, 65536, v78
    v_cndmask_b32 v80, v80, 0, vcc
    v_cmp_gt_u32 vcc, 12, v76
    v_add_u32 v79, 64800, v78
    s_nop 0
    v_cndmask_b32 v80, v80, v77, vcc
    v_cmp_gt_u32 s[56:57], 54, v8
    v_mov_b32 v81, v80
    v_mov_b32 v82, v80
    v_mov_b32 v83, v80
    ds_write_b128 v78, v[80:83] offset:0
    ds_write_b128 v78, v[80:83] offset:2400
    ds_write_b128 v78, v[80:83] offset:4800
    ds_write_b128 v78, v[80:83] offset:7200
    ds_write_b128 v78, v[80:83] offset:9600
    ds_write_b128 v78, v[80:83] offset:12000
    ds_write_b128 v78, v[80:83] offset:14400
    ds_write_b128 v78, v[80:83] offset:16800
    ds_write_b128 v78, v[80:83] offset:19200
    ds_write_b128 v78, v[80:83] offset:21600
    ds_write_b128 v78, v[80:83] offset:24000
    ds_write_b128 v78, v[80:83] offset:26400
    ds_write_b128 v78, v[80:83] offset:28800
    ds_write_b128 v78, v[80:83] offset:31200
    ds_write_b128 v78, v[80:83] offset:33600
    ds_write_b128 v78, v[80:83] offset:36000
    ds_write_b128 v78, v[80:83] offset:38400
    ds_write_b128 v78, v[80:83] offset:40800
    ds_write_b128 v78, v[80:83] offset:43200
    ds_write_b128 v78, v[80:83] offset:45600
    ds_write_b128 v78, v[80:83] offset:48000
    ds_write_b128 v78, v[80:83] offset:50400
    ds_write_b128 v78, v[80:83] offset:52800
    ds_write_b128 v78, v[80:83] offset:55200
    ds_write_b128 v78, v[80:83] offset:57600
    ds_write_b128 v78, v[80:83] offset:60000
    ds_write_b128 v78, v[80:83] offset:62400
    ds_write_b128 v79, v[80:83] offset:0
    ds_write_b128 v79, v[80:83] offset:2400
    ds_write_b128 v79, v[80:83] offset:4800
    ds_write_b128 v79, v[80:83] offset:7200
    ds_write_b128 v79, v[80:83] offset:9600
    ds_write_b128 v79, v[80:83] offset:12000
    ds_write_b128 v79, v[80:83] offset:14400
    ds_write_b128 v79, v[80:83] offset:16800
    ds_write_b128 v79, v[80:83] offset:19200
    ds_write_b128 v79, v[80:83] offset:21600
    ds_write_b128 v79, v[80:83] offset:24000
    ds_write_b128 v79, v[80:83] offset:26400
    ds_write_b128 v79, v[80:83] offset:28800
    v_mov_b32 v59, 163728
    s_barrier
    ds_read_b32 v59, v59
    s_cmp_eq_u32 s20, 6
    s_cselect_b64 exec, s[56:57], -1
    ds_write_b128 v79, v[80:83] offset:31200
    s_mov_b64 exec, -1
    s_mov_b32 s4, s80
    s_and_b32 s5, s81, 0xffff
    s_mov_b32 s6, 10240000
    s_mov_b32 s7, 0x20000
    s_mov_b32 s12, s96
    s_and_b32 s13, s97, 0xffff
    s_mov_b32 s14, 10240000
    s_mov_b32 s15, 0x20000
    s_mov_b32 s16, s84
    s_and_b32 s17, s85, 0xffff
    s_mov_b32 s18, 10240000
    s_mov_b32 s19, 0x20000
    s_sub_u32 s80, s80, 1024
    s_subb_u32 s81, s81, 0
    s_mov_b32 s72, s80
    s_and_b32 s73, s81, 0xffff
    s_mov_b32 s74, 10241024
    s_mov_b32 s75, 0x20000
    s_waitcnt vmcnt(0)
    v_lshl_or_b32 v40, v65, 16, v64
    v_lshl_or_b32 v41, v67, 16, v66
    v_lshl_or_b32 v42, v69, 16, v68
    v_lshl_or_b32 v43, v71, 16, v70
    buffer_store_dwordx4 v[40:43], v9, s[8:11], s24 offen sc1
    s_waitcnt lgkmcnt(0)
    s_barrier
    s_lshl_b32 s24, s2, 2
    s_add_u32 s24, s24, 7176192
    s_mov_b64 exec, 1
    s_waitcnt vmcnt(0)
    buffer_store_dword v59, v6, s[8:11], s24 offen sc1
    s_mov_b64 exec, -1
    s_branch KS_JOIN
KS_RAW:
    s_barrier
    s_mov_b32 s60, s90
    s_and_b32 s61, s91, 0xffff
    s_mov_b32 s62, 20480
    s_mov_b32 s63, 0x20000
    s_mov_b32 m0, 24576
    s_movk_i32 s24, 0
    buffer_load_dwordx4 v9, s[60:63], s24 offen offset:0 lds
    buffer_load_dwordx4 v9, s[60:63], s24 offen offset:1024 lds
    buffer_load_dwordx4 v9, s[60:63], s24 offen offset:2048 lds
    buffer_load_dwordx4 v9, s[60:63], s24 offen offset:3072 lds
    s_mov_b32 m0, 28672
    s_movk_i32 s24, 4096
    buffer_load_dwordx4 v9, s[60:63], s24 offen offset:0 lds
    buffer_load_dwordx4 v9, s[60:63], s24 offen offset:1024 lds
    buffer_load_dwordx4 v9, s[60:63], s24 offen offset:2048 lds
    buffer_load_dwordx4 v9, s[60:63], s24 offen offset:3072 lds
    s_mov_b32 m0, 32768
    s_movk_i32 s24, 8192
    buffer_load_dwordx4 v9, s[60:63], s24 offen offset:0 lds
    buffer_load_dwordx4 v9, s[60:63], s24 offen offset:1024 lds
    buffer_load_dwordx4 v9, s[60:63], s24 offen offset:2048 lds
    buffer_load_dwordx4 v9, s[60:63], s24 offen offset:3072 lds
    s_mov_b32 m0, 36864
    s_movk_i32 s24, 12288
    buffer_load_dwordx4 v9, s[60:63], s24 offen offset:0 lds
    buffer_load_dwordx4 v9, s[60:63], s24 offen offset:1024 lds
    buffer_load_dwordx4 v9, s[60:63], s24 offen offset:2048 lds
    buffer_load_dwordx4 v9, s[60:63], s24 offen offset:3072 lds
    s_mov_b32 m0, 40960
    s_movk_i32 s24, 16384
    buffer_load_dwordx4 v9, s[60:63], s24 offen offset:0 lds
    buffer_load_dwordx4 v9, s[60:63], s24 offen offset:1024 lds
    buffer_load_dwordx4 v9, s[60:63], s24 offen offset:2048 lds
    buffer_load_dwordx4 v9, s[60:63], s24 offen offset:3072 lds
    s_branch KS_FILL
KS_NOW:
    s_barrier
KS_FILL:
    v_subrev_u32 v76, 320, v0
    v_mov_b32 v80, -1
    v_mov_b32 v77, 1.0
    v_cmp_gt_u32 vcc, 48, v76
    v_lshlrev_b32 v78, 4, v76
    v_add_u32 v78, 65536, v78
    v_cndmask_b32 v80, v80, 0, vcc
    v_cmp_gt_u32 vcc, 12, v76
    v_add_u32 v79, 64800, v78
    s_nop 0
    v_cndmask_b32 v80, v80, v77, vcc
    v_cmp_gt_u32 s[56:57], 54, v8
    v_mov_b32 v81, v80
    v_mov_b32 v82, v80
    v_mov_b32 v83, v80
    ds_write_b128 v78, v[80:83] offset:0
    ds_write_b128 v78, v[80:83] offset:2400
    ds_write_b128 v78, v[80:83] offset:4800
    ds_write_b128 v78, v[80:83] offset:7200
    ds_write_b128 v78, v[80:83] offset:9600
    ds_write_b128 v78, v[80:83] offset:12000
    ds_write_b128 v78, v[80:83] offset:14400
    ds_write_b128 v78, v[80:83] offset:16800
    ds_write_b128 v78, v[80:83] offset:19200
    ds_write_b128 v78, v[80:83] offset:21600
    ds_write_b128 v78, v[80:83] offset:24000
    ds_write_b128 v78, v[80:83] offset:26400
    ds_write_b128 v78, v[80:83] offset:28800
    ds_write_b128 v78, v[80:83] offset:31200
    ds_write_b128 v78, v[80:83] offset:33600
    ds_write_b128 v78, v[80:83] offset:36000
    ds_write_b128 v78, v[80:83] offset:38400
    ds_write_b128 v78, v[80:83] offset:40800
    ds_write_b128 v78, v[80:83] offset:43200
    ds_write_b128 v78, v[80:83] offset:45600
    ds_write_b128 v78, v[80:83] offset:48000
    ds_write_b128 v78, v[80:83] offset:50400
    ds_write_b128 v78, v[80:83] offset:52800
    ds_write_b128 v78, v[80:83] offset:55200
    ds_write_b128 v78, v[80:83] offset:57600
    ds_write_b128 v78, v[80:83] offset:60000
    ds_write_b128 v78, v[80:83] offset:62400
    ds_write_b128 v79, v[80:83] offset:0
    ds_write_b128 v79, v[80:83] offset:2400
    ds_write_b128 v79, v[80:83] offset:4800
    ds_write_b128 v79, v[80:83] offset:7200
    ds_write_b128 v79, v[80:83] offset:9600
    ds_write_b128 v79, v[80:83] offset:12000
    ds_write_b128 v79, v[80:83] offset:14400
    ds_write_b128 v79, v[80:83] offset:16800
    ds_write_b128 v79, v[80:83] offset:19200
    ds_write_b128 v79, v[80:83] offset:21600
    ds_write_b128 v79, v[80:83] offset:24000
    ds_write_b128 v79, v[80:83] offset:26400
    ds_write_b128 v79, v[80:83] offset:28800
    s_barrier
    s_cmp_eq_u32 s20, 6
    s_cselect_b64 exec, s[56:57], -1
    ds_write_b128 v79, v[80:83] offset:31200
    s_mov_b64 exec, -1
    s_mov_b32 s4, s80
    s_and_b32 s5, s81, 0xffff
    s_mov_b32 s6, 10240000
    s_mov_b32 s7, 0x20000
    s_mov_b32 s12, s96
    s_and_b32 s13, s97, 0xffff
    s_mov_b32 s14, 10240000
    s_mov_b32 s15, 0x20000
    s_mov_b32 s16, s84
    s_and_b32 s17, s85, 0xffff
    s_mov_b32 s18, 10240000
    s_mov_b32 s19, 0x20000
    s_sub_u32 s80, s80, 1024
    s_subb_u32 s81, s81, 0
    s_mov_b32 s72, s80
    s_and_b32 s73, s81, 0xffff
    s_mov_b32 s74, 10241024
    s_mov_b32 s75, 0x20000
    s_waitcnt vmcnt(0)
    s_branch KS_B3
KS_TAG:
    s_mov_b32 s60, s98
    s_and_b32 s61, s99, 0xffff
    s_mov_b32 s62, 256
    s_mov_b32 s63, 0x20000
    s_cmp_lg_u32 s2, 0
    s_cbranch_scc1 KS_TAGLD
    s_or_b32 s24, s74, 1
    v_mov_b32 v10, s24
    v_mov_b32 v11, 0
    s_mov_b64 exec, 1
    buffer_atomic_cmpswap v[10:11], v6, s[60:63], 0 offen sc1
KS_TAGLD:
    s_mov_b64 exec, 1
    v_mov_b32 v14, 0
    s_mov_b64 exec, -1
    s_barrier
    v_mov_b32 v76, 0
    v_mov_b32 v77, -1
    v_lshlrev_b32 v78, 2, v8
    v_add_u32 v78, 163424, v78
    s_mov_b64 exec, 0x1ff
    ds_write_b32 v78, v76 offset:192
    s_mov_b64 exec, 0xff
    ds_write_b32 v78, v77 offset:256
    s_mov_b64 exec, -1
    s_mov_b32 exec_hi, 0xffff
    ds_write_b32 v78, v76
    s_mov_b64 exec, 1
    ds_write_b32 v78, v76 offset:228
    s_mov_b64 exec, -1
    s_mov_b32 s4, s80
    s_and_b32 s5, s81, 0xffff
    s_mov_b32 s6, 10240000
    s_mov_b32 s7, 0x20000
    s_mov_b32 s12, s96
    s_and_b32 s13, s97, 0xffff
    s_mov_b32 s14, 10240000
    s_mov_b32 s15, 0x20000
    s_mov_b32 s16, s84
    s_and_b32 s17, s85, 0xffff
    s_mov_b32 s18, 10240000
    s_mov_b32 s19, 0x20000
    s_sub_u32 s80, s80, 1024
    s_subb_u32 s81, s81, 0
    s_mov_b32 s72, s80
    s_and_b32 s73, s81, 0xffff
    s_mov_b32 s74, 10241024
    s_mov_b32 s75, 0x20000
    s_mov_b64 exec, 1
    s_mov_b32 s24, 0x100000
    v_mov_b32 v12, 163728
KS_TAGW:
    buffer_load_dword v15, v6, s[60:63], 0 offen sc1
    s_waitcnt vmcnt(1)
    v_cmp_ne_u32 vcc, 0, v14
    s_nop 0
    s_cbranch_vccnz KS_TAGOK
    s_sub_u32 s24, s24, 1
    s_cbranch_scc1 K2_END
    buffer_load_dword v14, v6, s[60:63], 0 offen sc1
    s_waitcnt vmcnt(1)
    v_cmp_ne_u32 vcc, 0, v15
    s_nop 0
    s_cbranch_vccz KS_TAGW
    ds_write_b32 v12, v15
    s_branch KS_TAGOK2
KS_TAGOK:
    ds_write_b32 v12, v14
KS_TAGOK2:
    s_mov_b64 exec, -1
    s_waitcnt lgkmcnt(0)
    s_barrier
KS_B3:
    v_mov_b32 v59, 163728
    ds_read_b32 v59, v59
    s_waitcnt lgkmcnt(0)
    s_barrier
KS_JOIN:
    v_readfirstlane_b32 s2, v59
    s_mov_b32 s23, 0
    s_mov_b32 s28, 1
    s_mov_b32 s24, 0
    s_mov_b32 s25, 1
K2_CELLS:
    v_lshrrev_b32 v178, 1, v177
    v_min_u32 v178, 249, v178
    v_mul_u32_u24 v72, 1152, v178
    s_and_b32 s58, s54, 7
    s_lshl_b32 s58, s58, 7
    s_lshr_b32 s59, s54, 5
    s_lshl_b32 s59, s59, 4
    s_add_u32 s67, s58, s59
    s_add_u32 s67, s67, 6291456
    buffer_load_dwordx4 v[76:79], v72, s[8:11], s67 offen sc1
    v_and_b32 v84, 15, v176
    v_lshrrev_b32 v85, 5, v176
    v_bfe_u32 v86, v176, 4, 1
    v_lshrrev_b32 v87, 2, v84
    v_and_b32 v88, 3, v84
    v_lshl_add_u32 v89, v85, 3, v87
    v_lshlrev_b32 v249, 5, v89
    v_lshl_add_u32 v249, v88, 3, v249
    v_add_u32 v249, 864, v249
    v_mul_u32_u24 v250, 192, v86
    v_lshl_add_u32 v250, v85, 5, v250
    v_lshrrev_b32 v90, 1, v88
    v_lshl_add_u32 v90, v86, 1, v90
    v_bfe_u32 v91, v87, 1, 1
    v_lshlrev_b32 v91, 2, v91
    v_xor_b32 v90, v90, v91
    v_lshlrev_b32 v90, 4, v90
    v_lshl_add_u32 v90, v89, 7, v90
    v_and_b32 v91, 1, v88
    v_lshl_add_u32 v90, v91, 3, v90
    v_add_u32 v246, s37, v90
    v_xor_b32 v247, 64, v246
    v_lshrrev_b32 v90, 3, v176
    v_lshlrev_b32 v251, 2, v90
    v_add_u32 v251, 768, v251
    v_bfe_u32 v90, v90, 1, 1
    v_lshlrev_b32 v90, 2, v90
    v_and_b32 v91, 7, v176
    v_xor_b32 v90, v90, v91
    v_lshlrev_b32 v248, 4, v90
    v_lshlrev_b32 v252, 1, v176
    v_and_b32 v231, 1, v176
    v_lshlrev_b32 v231, 4, v231
    v_lshrrev_b32 v90, 1, v176
    v_lshlrev_b32 v90, 5, v90
    v_add_u32 v230, 864, v90
    s_lshl_b32 s59, s2, 22
    s_mov_b32 s60, 0x100000
    s_bfe_u32 s61, s54, 0x10004
    s_bfe_u32 s62, s54, 0x10003
    s_add_u32 s63, s61, s62
    s_mul_i32 s62, s62, 11
    s_sub_u32 s64, 11, s62
    v_cmp_gt_u32 vcc, 500, v177
    s_nop 0
    s_mov_b64 s[56:57], vcc
K2_POLL:
    s_waitcnt vmcnt(0)
    v_xor_b32 v73, s59, v76
    v_xor_b32 v74, s59, v77
    v_or_b32 v73, v73, v74
    v_xor_b32 v74, s2, v79
    v_lshrrev_b32 v73, 22, v73
    v_or_b32 v73, v73, v74
    v_cmp_ne_u32 vcc, 0, v73
    s_nop 0
    s_cbranch_vccz K2_POLLED
    s_sub_u32 s60, s60, 1
    s_cbranch_scc1 K2_END
    s_mov_b64 exec, vcc
    buffer_load_dwordx4 v[76:79], v72, s[8:11], s67 offen sc1
    s_mov_b64 exec, -1
    s_branch K2_POLL
K2_POLLED:
    s_set_gpr_idx_on s61, gpr_idx(SRC0)
    s_nop 0
    v_bfe_u32 v179, v76, s62, 11
    s_set_gpr_idx_idx s63
    s_nop 0
    v_bfe_u32 v73, v76, s64, 11
    s_set_gpr_idx_off
    v_sub_u32 v73, v73, v179
    v_cndmask_b32 v73, 0, v73, s[56:57]
    v_and_b32 v1, 1, v177
    v_add_u32 v1, s23, v1
    v_sub_u32 v180, v73, v1
    v_add_u32 v179, v179, v1
    v_mul_u32_u24 v181, 20608, v178
    v_lshl_add_u32 v181, v179, 4, v181
    v_mul_u32_u24 v178, 1280, v178
    s_mov_b32 s60, 0x100000
K2_RELOAD:
    v_cmp_lt_i32 vcc, 0, v180
    s_nop 0
    s_cbranch_vccz K2_LD_DONE
    s_mov_b64 exec, vcc
    buffer_load_dwordx4 v[0:3], v181, s[8:11], 0 offen offset:0 sc1
    v_cmp_lt_i32 vcc, 2, v180
    s_nop 0
    s_cbranch_vccz K2_LD_DONE
    s_mov_b64 exec, vcc
    buffer_load_dwordx4 v[4:7], v181, s[8:11], 0 offen offset:32 sc1
    v_cmp_lt_i32 vcc, 4, v180
    s_nop 0
    s_cbranch_vccz K2_LD_DONE
    s_mov_b64 exec, vcc
    buffer_load_dwordx4 v[8:11], v181, s[8:11], 0 offen offset:64 sc1
    v_cmp_lt_i32 vcc, 6, v180
    s_nop 0
    s_cbranch_vccz K2_LD_DONE
    s_mov_b64 exec, vcc
    buffer_load_dwordx4 v[12:15], v181, s[8:11], 0 offen offset:96 sc1
    v_cmp_lt_i32 vcc, 8, v180
    s_nop 0
    s_cbranch_vccz K2_LD_DONE
    s_mov_b64 exec, vcc
    buffer_load_dwordx4 v[16:19], v181, s[8:11], 0 offen offset:128 sc1
    v_cmp_lt_i32 vcc, 10, v180
    s_nop 0
    s_cbranch_vccz K2_LD_DONE
    s_mov_b64 exec, vcc
    buffer_load_dwordx4 v[20:23], v181, s[8:11], 0 offen offset:160 sc1
    v_cmp_lt_i32 vcc, 12, v180
    s_nop 0
    s_cbranch_vccz K2_LD_DONE
    s_mov_b64 exec, vcc
    buffer_load_dwordx4 v[24:27], v181, s[8:11], 0 offen offset:192 sc1
    v_cmp_lt_i32 vcc, 14, v180
    s_nop 0
    s_cbranch_vccz K2_LD_DONE
    s_mov_b64 exec, vcc
    buffer_load_dwordx4 v[28:31], v181, s[8:11], 0 offen offset:224 sc1
    v_cmp_lt_i32 vcc, 16, v180
    s_nop 0
    s_cbranch_vccz K2_LD_DONE
    s_mov_b64 exec, vcc
    buffer_load_dwordx4 v[32:35], v181, s[8:11], 0 offen offset:256 sc1
    v_cmp_lt_i32 vcc, 18, v180
    s_nop 0
    s_cbranch_vccz K2_LD_DONE
    s_mov_b64 exec, vcc
    buffer_load_dwordx4 v[36:39], v181, s[8:11], 0 offen offset:288 sc1
K2_LD_DONE:
    s_mov_b64 exec, -1
    s_cmp_eq_u32 s28, 0
    s_cbranch_scc1 K2_NOWRAW
    s_cmp_lg_u32 s60, 0x100000
    s_cbranch_scc1 K2_NOWRAW
    s_cmp_lg_u32 s20, 7
    s_cbranch_scc1 K2_NOFLG
    v_lshlrev_b32 v72, 4, v176
    s_mov_b32 s67, 7176192
    buffer_load_dwordx4 v[84:87], v72, s[8:11], s67 offen sc1
K2_NOFLG:
    v_lshrrev_b32 v60, 5, v176
    v_bfe_u32 v61, v176, 2, 2
    v_lshl_add_u32 v60, v60, 2, v61
    v_mul_u32_u24 v60, 1280, v60
    v_bfe_u32 v61, v176, 4, 1
    v_lshl_add_u32 v60, v61, 5, v60
    v_and_b32 v61, 3, v176
    v_lshl_add_u32 v60, v61, 3, v60
    ds_read_b64_tr_b16 v[136:137], v60 offset:24576
    ds_read_b64_tr_b16 v[138:139], v60 offset:34816
    ds_read_b64_tr_b16 v[140:141], v60 offset:24640
    ds_read_b64_tr_b16 v[142:143], v60 offset:34880
    ds_read_b64_tr_b16 v[144:145], v60 offset:24832
    ds_read_b64_tr_b16 v[146:147], v60 offset:35072
    ds_read_b64_tr_b16 v[148:149], v60 offset:24896
    ds_read_b64_tr_b16 v[150:151], v60 offset:35136
    ds_read_b64_tr_b16 v[152:153], v60 offset:25088
    ds_read_b64_tr_b16 v[154:155], v60 offset:35328
    ds_read_b64_tr_b16 v[156:157], v60 offset:25152
    ds_read_b64_tr_b16 v[158:159], v60 offset:35392
    ds_read_b64_tr_b16 v[160:161], v60 offset:25344
    ds_read_b64_tr_b16 v[162:163], v60 offset:35584
    ds_read_b64_tr_b16 v[164:165], v60 offset:25408
    ds_read_b64_tr_b16 v[166:167], v60 offset:35648
    ds_read_b64_tr_b16 v[168:169], v60 offset:25600
    ds_read_b64_tr_b16 v[170:171], v60 offset:35840
    ds_read_b64_tr_b16 v[172:173], v60 offset:25664
    ds_read_b64_tr_b16 v[174:175], v60 offset:35904
    s_waitcnt lgkmcnt(0)
    v_lshlrev_b32 v96, 16, v136
    v_and_b32 v97, 0xffff0000, v136
    v_lshlrev_b32 v98, 16, v137
    v_and_b32 v99, 0xffff0000, v137
    v_lshlrev_b32 v100, 16, v138
    v_and_b32 v101, 0xffff0000, v138
    v_lshlrev_b32 v102, 16, v139
    v_and_b32 v103, 0xffff0000, v139
    v_lshlrev_b32 v104, 16, v140
    v_and_b32 v105, 0xffff0000, v140
    v_lshlrev_b32 v106, 16, v141
    v_and_b32 v107, 0xffff0000, v141
    v_lshlrev_b32 v108, 16, v142
    v_and_b32 v109, 0xffff0000, v142
    v_lshlrev_b32 v110, 16, v143
    v_and_b32 v111, 0xffff0000, v143
    v_lshlrev_b32 v112, 16, v144
    v_and_b32 v113, 0xffff0000, v144
    v_lshlrev_b32 v114, 16, v145
    v_and_b32 v115, 0xffff0000, v145
    v_lshlrev_b32 v116, 16, v146
    v_and_b32 v117, 0xffff0000, v146
    v_lshlrev_b32 v118, 16, v147
    v_and_b32 v119, 0xffff0000, v147
    v_lshlrev_b32 v120, 16, v148
    v_and_b32 v121, 0xffff0000, v148
    v_lshlrev_b32 v122, 16, v149
    v_and_b32 v123, 0xffff0000, v149
    v_lshlrev_b32 v124, 16, v150
    v_and_b32 v125, 0xffff0000, v150
    v_lshlrev_b32 v126, 16, v151
    v_and_b32 v127, 0xffff0000, v151
    v_lshlrev_b32 v128, 16, v152
    v_and_b32 v129, 0xffff0000, v152
    v_lshlrev_b32 v130, 16, v153
    v_and_b32 v131, 0xffff0000, v153
    v_lshlrev_b32 v132, 16, v154
    v_and_b32 v133, 0xffff0000, v154
    v_lshlrev_b32 v134, 16, v155
    v_and_b32 v135, 0xffff0000, v155
    v_lshlrev_b32 v136, 16, v156
    v_and_b32 v137, 0xffff0000, v156
    v_lshlrev_b32 v138, 16, v157
    v_and_b32 v139, 0xffff0000, v157
    v_lshlrev_b32 v140, 16, v158
    v_and_b32 v141, 0xffff0000, v158
    v_lshlrev_b32 v142, 16, v159
    v_and_b32 v143, 0xffff0000, v159
    v_lshlrev_b32 v144, 16, v160
    v_and_b32 v145, 0xffff0000, v160
    v_lshlrev_b32 v146, 16, v161
    v_and_b32 v147, 0xffff0000, v161
    v_lshlrev_b32 v148, 16, v162
    v_and_b32 v149, 0xffff0000, v162
    v_lshlrev_b32 v150, 16, v163
    v_and_b32 v151, 0xffff0000, v163
    v_lshlrev_b32 v152, 16, v164
    v_and_b32 v153, 0xffff0000, v164
    v_lshlrev_b32 v154, 16, v165
    v_and_b32 v155, 0xffff0000, v165
    v_lshlrev_b32 v156, 16, v166
    v_and_b32 v157, 0xffff0000, v166
    v_lshlrev_b32 v158, 16, v167
    v_and_b32 v159, 0xffff0000, v167
    v_lshlrev_b32 v160, 16, v168
    v_and_b32 v161, 0xffff0000, v168
    v_lshlrev_b32 v162, 16, v169
    v_and_b32 v163, 0xffff0000, v169
    v_lshlrev_b32 v164, 16, v170
    v_and_b32 v165, 0xffff0000, v170
    v_lshlrev_b32 v166, 16, v171
    v_and_b32 v167, 0xffff0000, v171
    v_lshlrev_b32 v168, 16, v172
    v_and_b32 v169, 0xffff0000, v172
    v_lshlrev_b32 v170, 16, v173
    v_and_b32 v171, 0xffff0000, v173
    v_lshlrev_b32 v172, 16, v174
    v_and_b32 v173, 0xffff0000, v174
    v_lshlrev_b32 v174, 16, v175
    v_and_b32 v175, 0xffff0000, v175
K2_NOWRAW:
    s_mov_b32 s61, 0xffff
    s_mov_b64 s[62:63], 0
    s_waitcnt vmcnt(0)
    v_cmp_lt_i32 vcc, 0, v180
    s_nop 0
    s_cbranch_vccz K2_CK_DONE
    s_mov_b64 exec, vcc
    v_bfi_b32 v192, s61, v1, v2
    v_cmp_ne_u32 vcc, s2, v192
    s_nop 0
    s_or_b64 s[62:63], s[62:63], vcc
    v_cmp_lt_i32 vcc, 2, v180
    s_nop 0
    s_cbranch_vccz K2_CK_DONE
    s_mov_b64 exec, vcc
    v_bfi_b32 v192, s61, v5, v6
    v_cmp_ne_u32 vcc, s2, v192
    s_nop 0
    s_or_b64 s[62:63], s[62:63], vcc
    v_cmp_lt_i32 vcc, 4, v180
    s_nop 0
    s_cbranch_vccz K2_CK_DONE
    s_mov_b64 exec, vcc
    v_bfi_b32 v192, s61, v9, v10
    v_cmp_ne_u32 vcc, s2, v192
    s_nop 0
    s_or_b64 s[62:63], s[62:63], vcc
    v_cmp_lt_i32 vcc, 6, v180
    s_nop 0
    s_cbranch_vccz K2_CK_DONE
    s_mov_b64 exec, vcc
    v_bfi_b32 v192, s61, v13, v14
    v_cmp_ne_u32 vcc, s2, v192
    s_nop 0
    s_or_b64 s[62:63], s[62:63], vcc
    v_cmp_lt_i32 vcc, 8, v180
    s_nop 0
    s_cbranch_vccz K2_CK_DONE
    s_mov_b64 exec, vcc
    v_bfi_b32 v192, s61, v17, v18
    v_cmp_ne_u32 vcc, s2, v192
    s_nop 0
    s_or_b64 s[62:63], s[62:63], vcc
    v_cmp_lt_i32 vcc, 10, v180
    s_nop 0
    s_cbranch_vccz K2_CK_DONE
    s_mov_b64 exec, vcc
    v_bfi_b32 v192, s61, v21, v22
    v_cmp_ne_u32 vcc, s2, v192
    s_nop 0
    s_or_b64 s[62:63], s[62:63], vcc
    v_cmp_lt_i32 vcc, 12, v180
    s_nop 0
    s_cbranch_vccz K2_CK_DONE
    s_mov_b64 exec, vcc
    v_bfi_b32 v192, s61, v25, v26
    v_cmp_ne_u32 vcc, s2, v192
    s_nop 0
    s_or_b64 s[62:63], s[62:63], vcc
    v_cmp_lt_i32 vcc, 14, v180
    s_nop 0
    s_cbranch_vccz K2_CK_DONE
    s_mov_b64 exec, vcc
    v_bfi_b32 v192, s61, v29, v30
    v_cmp_ne_u32 vcc, s2, v192
    s_nop 0
    s_or_b64 s[62:63], s[62:63], vcc
    v_cmp_lt_i32 vcc, 16, v180
    s_nop 0
    s_cbranch_vccz K2_CK_DONE
    s_mov_b64 exec, vcc
    v_bfi_b32 v192, s61, v33, v34
    v_cmp_ne_u32 vcc, s2, v192
    s_nop 0
    s_or_b64 s[62:63], s[62:63], vcc
    v_cmp_lt_i32 vcc, 18, v180
    s_nop 0
    s_cbranch_vccz K2_CK_DONE
    s_mov_b64 exec, vcc
    v_bfi_b32 v192, s61, v37, v38
    v_cmp_ne_u32 vcc, s2, v192
    s_nop 0
    s_or_b64 s[62:63], s[62:63], vcc
K2_CK_DONE:
    s_mov_b64 exec, -1
    s_cmp_lg_u64 s[62:63], 0
    s_cbranch_scc1 K2_RETRY
    s_cmp_eq_u32 s20, 7
    s_cbranch_scc1 K2_FLGCK
K2_FLGOK:
    v_add_lshl_u32 v179, v179, v178, 2
    s_mov_b32 s66, 7340032
    v_mov_b32 v201, 1
    s_cmp_lg_u32 s24, 0
    s_cbranch_scc1 K2_RK_LOAD
    v_cmp_lt_i32 vcc, 20, v180
    s_nop 0
    s_cbranch_vccz K2_NOMORE
    v_mov_b32 v61, 163652
    ds_write_b32 v61, v201
K2_NOMORE:
    s_mov_b32 s58, 163424
    s_movk_i32 s59, 2400
    v_mov_b32 v202, 65536
    v_cmp_lt_i32 vcc, 0, v180
    s_nop 0
    s_cbranch_vccz K2_RK_A
    s_mov_b64 exec, vcc
    v_lshrrev_b32 v50, 25, v3
    v_lshl_add_u32 v40, v50, 2, s58
    ds_add_rtn_u32 v40, v40, v201
    v_mad_u32_u24 v50, v50, s59, v202
    v_bfe_u32 v60, v3, 14, 11
    v_add_lshl_u32 v60, v60, v178, 5
    v_and_b32 v3, 0x3fff, v3
    v_and_b32 v2, 0xffff0000, v1
    v_and_b32 v1, 0xffff0000, v0
    v_lshlrev_b32 v0, 16, v0
    v_cmp_lt_i32 vcc, 2, v180
    s_nop 0
    s_cbranch_vccz K2_RK_A
    s_mov_b64 exec, vcc
    v_lshrrev_b32 v51, 25, v7
    v_lshl_add_u32 v41, v51, 2, s58
    ds_add_rtn_u32 v41, v41, v201
    v_mad_u32_u24 v51, v51, s59, v202
    v_bfe_u32 v61, v7, 14, 11
    v_add_lshl_u32 v61, v61, v178, 5
    v_and_b32 v7, 0x3fff, v7
    v_and_b32 v6, 0xffff0000, v5
    v_and_b32 v5, 0xffff0000, v4
    v_lshlrev_b32 v4, 16, v4
    v_cmp_lt_i32 vcc, 4, v180
    s_nop 0
    s_cbranch_vccz K2_RK_A
    s_mov_b64 exec, vcc
    v_lshrrev_b32 v52, 25, v11
    v_lshl_add_u32 v42, v52, 2, s58
    ds_add_rtn_u32 v42, v42, v201
    v_mad_u32_u24 v52, v52, s59, v202
    v_bfe_u32 v62, v11, 14, 11
    v_add_lshl_u32 v62, v62, v178, 5
    v_and_b32 v11, 0x3fff, v11
    v_and_b32 v10, 0xffff0000, v9
    v_and_b32 v9, 0xffff0000, v8
    v_lshlrev_b32 v8, 16, v8
    v_cmp_lt_i32 vcc, 6, v180
    s_nop 0
    s_cbranch_vccz K2_RK_A
    s_mov_b64 exec, vcc
    v_lshrrev_b32 v53, 25, v15
    v_lshl_add_u32 v43, v53, 2, s58
    ds_add_rtn_u32 v43, v43, v201
    v_mad_u32_u24 v53, v53, s59, v202
    v_bfe_u32 v63, v15, 14, 11
    v_add_lshl_u32 v63, v63, v178, 5
    v_and_b32 v15, 0x3fff, v15
    v_and_b32 v14, 0xffff0000, v13
    v_and_b32 v13, 0xffff0000, v12
    v_lshlrev_b32 v12, 16, v12
    v_cmp_lt_i32 vcc, 8, v180
    s_nop 0
    s_cbranch_vccz K2_RK_A
    s_mov_b64 exec, vcc
    v_lshrrev_b32 v54, 25, v19
    v_lshl_add_u32 v44, v54, 2, s58
    ds_add_rtn_u32 v44, v44, v201
    v_mad_u32_u24 v54, v54, s59, v202
    v_bfe_u32 v64, v19, 14, 11
    v_add_lshl_u32 v64, v64, v178, 5
    v_and_b32 v19, 0x3fff, v19
    v_and_b32 v18, 0xffff0000, v17
    v_and_b32 v17, 0xffff0000, v16
    v_lshlrev_b32 v16, 16, v16
    v_cmp_lt_i32 vcc, 10, v180
    s_nop 0
    s_cbranch_vccz K2_RK_A
    s_mov_b64 exec, vcc
    v_lshrrev_b32 v55, 25, v23
    v_lshl_add_u32 v45, v55, 2, s58
    ds_add_rtn_u32 v45, v45, v201
    v_mad_u32_u24 v55, v55, s59, v202
    v_bfe_u32 v65, v23, 14, 11
    v_add_lshl_u32 v65, v65, v178, 5
    v_and_b32 v23, 0x3fff, v23
    v_and_b32 v22, 0xffff0000, v21
    v_and_b32 v21, 0xffff0000, v20
    v_lshlrev_b32 v20, 16, v20
    v_cmp_lt_i32 vcc, 12, v180
    s_nop 0
    s_cbranch_vccz K2_RK_A
    s_mov_b64 exec, vcc
    v_lshrrev_b32 v56, 25, v27
    v_lshl_add_u32 v46, v56, 2, s58
    ds_add_rtn_u32 v46, v46, v201
    v_mad_u32_u24 v56, v56, s59, v202
    v_bfe_u32 v66, v27, 14, 11
    v_add_lshl_u32 v66, v66, v178, 5
    v_and_b32 v27, 0x3fff, v27
    v_and_b32 v26, 0xffff0000, v25
    v_and_b32 v25, 0xffff0000, v24
    v_lshlrev_b32 v24, 16, v24
    v_cmp_lt_i32 vcc, 14, v180
    s_nop 0
    s_cbranch_vccz K2_RK_A
    s_mov_b64 exec, vcc
    v_lshrrev_b32 v57, 25, v31
    v_lshl_add_u32 v47, v57, 2, s58
    ds_add_rtn_u32 v47, v47, v201
    v_mad_u32_u24 v57, v57, s59, v202
    v_bfe_u32 v67, v31, 14, 11
    v_add_lshl_u32 v67, v67, v178, 5
    v_and_b32 v31, 0x3fff, v31
    v_and_b32 v30, 0xffff0000, v29
    v_and_b32 v29, 0xffff0000, v28
    v_lshlrev_b32 v28, 16, v28
    v_cmp_lt_i32 vcc, 16, v180
    s_nop 0
    s_cbranch_vccz K2_RK_A
    s_mov_b64 exec, vcc
    v_lshrrev_b32 v58, 25, v35
    v_lshl_add_u32 v48, v58, 2, s58
    ds_add_rtn_u32 v48, v48, v201
    v_mad_u32_u24 v58, v58, s59, v202
    v_bfe_u32 v68, v35, 14, 11
    v_add_lshl_u32 v68, v68, v178, 5
    v_and_b32 v35, 0x3fff, v35
    v_and_b32 v34, 0xffff0000, v33
    v_and_b32 v33, 0xffff0000, v32
    v_lshlrev_b32 v32, 16, v32
    v_cmp_lt_i32 vcc, 18, v180
    s_nop 0
    s_cbranch_vccz K2_RK_A
    s_mov_b64 exec, vcc
    v_lshrrev_b32 v59, 25, v39
    v_lshl_add_u32 v49, v59, 2, s58
    ds_add_rtn_u32 v49, v49, v201
    v_mad_u32_u24 v59, v59, s59, v202
    v_bfe_u32 v69, v39, 14, 11
    v_add_lshl_u32 v69, v69, v178, 5
    v_and_b32 v39, 0x3fff, v39
    v_and_b32 v38, 0xffff0000, v37
    v_and_b32 v37, 0xffff0000, v36
    v_lshlrev_b32 v36, 16, v36
K2_RK_A:
    s_mov_b64 exec, -1
    s_branch K2_RK_DONE
K2_RK_LOAD:
    s_movk_i32 s59, 2400
    v_mov_b32 v202, 65536
    s_waitcnt vmcnt(0)
    v_cmp_lt_i32 vcc, 0, v180
    s_nop 0
    s_cbranch_vccz K2_RK_B
    s_mov_b64 exec, vcc
    v_lshrrev_b32 v50, 25, v3
    buffer_load_dword v40, v179, s[8:11], s66 offen offset:0
    v_mad_u32_u24 v50, v50, s59, v202
    v_bfe_u32 v60, v3, 14, 11
    v_add_lshl_u32 v60, v60, v178, 5
    v_and_b32 v3, 0x3fff, v3
    v_and_b32 v2, 0xffff0000, v1
    v_and_b32 v1, 0xffff0000, v0
    v_lshlrev_b32 v0, 16, v0
    v_cmp_lt_i32 vcc, 2, v180
    s_nop 0
    s_cbranch_vccz K2_RK_B
    s_mov_b64 exec, vcc
    v_lshrrev_b32 v51, 25, v7
    buffer_load_dword v41, v179, s[8:11], s66 offen offset:8
    v_mad_u32_u24 v51, v51, s59, v202
    v_bfe_u32 v61, v7, 14, 11
    v_add_lshl_u32 v61, v61, v178, 5
    v_and_b32 v7, 0x3fff, v7
    v_and_b32 v6, 0xffff0000, v5
    v_and_b32 v5, 0xffff0000, v4
    v_lshlrev_b32 v4, 16, v4
    v_cmp_lt_i32 vcc, 4, v180
    s_nop 0
    s_cbranch_vccz K2_RK_B
    s_mov_b64 exec, vcc
    v_lshrrev_b32 v52, 25, v11
    buffer_load_dword v42, v179, s[8:11], s66 offen offset:16
    v_mad_u32_u24 v52, v52, s59, v202
    v_bfe_u32 v62, v11, 14, 11
    v_add_lshl_u32 v62, v62, v178, 5
    v_and_b32 v11, 0x3fff, v11
    v_and_b32 v10, 0xffff0000, v9
    v_and_b32 v9, 0xffff0000, v8
    v_lshlrev_b32 v8, 16, v8
    v_cmp_lt_i32 vcc, 6, v180
    s_nop 0
    s_cbranch_vccz K2_RK_B
    s_mov_b64 exec, vcc
    v_lshrrev_b32 v53, 25, v15
    buffer_load_dword v43, v179, s[8:11], s66 offen offset:24
    v_mad_u32_u24 v53, v53, s59, v202
    v_bfe_u32 v63, v15, 14, 11
    v_add_lshl_u32 v63, v63, v178, 5
    v_and_b32 v15, 0x3fff, v15
    v_and_b32 v14, 0xffff0000, v13
    v_and_b32 v13, 0xffff0000, v12
    v_lshlrev_b32 v12, 16, v12
    v_cmp_lt_i32 vcc, 8, v180
    s_nop 0
    s_cbranch_vccz K2_RK_B
    s_mov_b64 exec, vcc
    v_lshrrev_b32 v54, 25, v19
    buffer_load_dword v44, v179, s[8:11], s66 offen offset:32
    v_mad_u32_u24 v54, v54, s59, v202
    v_bfe_u32 v64, v19, 14, 11
    v_add_lshl_u32 v64, v64, v178, 5
    v_and_b32 v19, 0x3fff, v19
    v_and_b32 v18, 0xffff0000, v17
    v_and_b32 v17, 0xffff0000, v16
    v_lshlrev_b32 v16, 16, v16
    v_cmp_lt_i32 vcc, 10, v180
    s_nop 0
    s_cbranch_vccz K2_RK_B
    s_mov_b64 exec, vcc
    v_lshrrev_b32 v55, 25, v23
    buffer_load_dword v45, v179, s[8:11], s66 offen offset:40
    v_mad_u32_u24 v55, v55, s59, v202
    v_bfe_u32 v65, v23, 14, 11
    v_add_lshl_u32 v65, v65, v178, 5
    v_and_b32 v23, 0x3fff, v23
    v_and_b32 v22, 0xffff0000, v21
    v_and_b32 v21, 0xffff0000, v20
    v_lshlrev_b32 v20, 16, v20
    v_cmp_lt_i32 vcc, 12, v180
    s_nop 0
    s_cbranch_vccz K2_RK_B
    s_mov_b64 exec, vcc
    v_lshrrev_b32 v56, 25, v27
    buffer_load_dword v46, v179, s[8:11], s66 offen offset:48
    v_mad_u32_u24 v56, v56, s59, v202
    v_bfe_u32 v66, v27, 14, 11
    v_add_lshl_u32 v66, v66, v178, 5
    v_and_b32 v27, 0x3fff, v27
    v_and_b32 v26, 0xffff0000, v25
    v_and_b32 v25, 0xffff0000, v24
    v_lshlrev_b32 v24, 16, v24
    v_cmp_lt_i32 vcc, 14, v180
    s_nop 0
    s_cbranch_vccz K2_RK_B
    s_mov_b64 exec, vcc
    v_lshrrev_b32 v57, 25, v31
    buffer_load_dword v47, v179, s[8:11], s66 offen offset:56
    v_mad_u32_u24 v57, v57, s59, v202
    v_bfe_u32 v67, v31, 14, 11
    v_add_lshl_u32 v67, v67, v178, 5
    v_and_b32 v31, 0x3fff, v31
    v_and_b32 v30, 0xffff0000, v29
    v_and_b32 v29, 0xffff0000, v28
    v_lshlrev_b32 v28, 16, v28
    v_cmp_lt_i32 vcc, 16, v180
    s_nop 0
    s_cbranch_vccz K2_RK_B
    s_mov_b64 exec, vcc
    v_lshrrev_b32 v58, 25, v35
    buffer_load_dword v48, v179, s[8:11], s66 offen offset:64
    v_mad_u32_u24 v58, v58, s59, v202
    v_bfe_u32 v68, v35, 14, 11
    v_add_lshl_u32 v68, v68, v178, 5
    v_and_b32 v35, 0x3fff, v35
    v_and_b32 v34, 0xffff0000, v33
    v_and_b32 v33, 0xffff0000, v32
    v_lshlrev_b32 v32, 16, v32
    v_cmp_lt_i32 vcc, 18, v180
    s_nop 0
    s_cbranch_vccz K2_RK_B
    s_mov_b64 exec, vcc
    v_lshrrev_b32 v59, 25, v39
    buffer_load_dword v49, v179, s[8:11], s66 offen offset:72
    v_mad_u32_u24 v59, v59, s59, v202
    v_bfe_u32 v69, v39, 14, 11
    v_add_lshl_u32 v69, v69, v178, 5
    v_and_b32 v39, 0x3fff, v39
    v_and_b32 v38, 0xffff0000, v37
    v_and_b32 v37, 0xffff0000, v36
    v_lshlrev_b32 v36, 16, v36
K2_RK_B:
    s_mov_b64 exec, -1
    s_waitcnt vmcnt(0)
K2_RK_DONE:
    s_mul_i32 s67, s24, 48
    s_waitcnt lgkmcnt(0)
    v_cmp_lt_i32 vcc, 0, v180
    s_nop 0
    s_cbranch_vccz K2_SC_DONE
    v_subrev_u32 v192, s67, v40
    v_cmp_gt_u32 s[56:57], 48, v192
    s_nop 0
    s_and_b64 exec, vcc, s[56:57]
    s_cbranch_execz K2_sc_1
    v_lshl_add_u32 v194, v192, 5, v50
    v_lshl_add_u32 v195, v192, 2, v50
    v_and_b32 v196, 7, v192
    v_add_lshl_u32 v196, v196, v192, 1
    v_bfe_u32 v193, v192, 3, 1
    v_mad_i32_i24 v196, v193, -14, v196
    v_add_u32 v196, v196, v50
    ds_write_b32 v194, v60 offset:864
    ds_write2_b32 v195, v0, v1 offset0:48 offset1:96
    ds_write_b32 v195, v2 offset:576
    ds_write_b16 v196, v3 offset:768
K2_sc_1:
    s_mov_b64 exec, -1
    v_cmp_lt_i32 vcc, 2, v180
    s_nop 0
    s_cbranch_vccz K2_SC_DONE
    v_subrev_u32 v192, s67, v41
    v_cmp_gt_u32 s[56:57], 48, v192
    s_nop 0
    s_and_b64 exec, vcc, s[56:57]
    s_cbranch_execz K2_sc_2
    v_lshl_add_u32 v194, v192, 5, v51
    v_lshl_add_u32 v195, v192, 2, v51
    v_and_b32 v196, 7, v192
    v_add_lshl_u32 v196, v196, v192, 1
    v_bfe_u32 v193, v192, 3, 1
    v_mad_i32_i24 v196, v193, -14, v196
    v_add_u32 v196, v196, v51
    ds_write_b32 v194, v61 offset:864
    ds_write2_b32 v195, v4, v5 offset0:48 offset1:96
    ds_write_b32 v195, v6 offset:576
    ds_write_b16 v196, v7 offset:768
K2_sc_2:
    s_mov_b64 exec, -1
    v_cmp_lt_i32 vcc, 4, v180
    s_nop 0
    s_cbranch_vccz K2_SC_DONE
    v_subrev_u32 v192, s67, v42
    v_cmp_gt_u32 s[56:57], 48, v192
    s_nop 0
    s_and_b64 exec, vcc, s[56:57]
    s_cbranch_execz K2_sc_3
    v_lshl_add_u32 v194, v192, 5, v52
    v_lshl_add_u32 v195, v192, 2, v52
    v_and_b32 v196, 7, v192
    v_add_lshl_u32 v196, v196, v192, 1
    v_bfe_u32 v193, v192, 3, 1
    v_mad_i32_i24 v196, v193, -14, v196
    v_add_u32 v196, v196, v52
    ds_write_b32 v194, v62 offset:864
    ds_write2_b32 v195, v8, v9 offset0:48 offset1:96
    ds_write_b32 v195, v10 offset:576
    ds_write_b16 v196, v11 offset:768
K2_sc_3:
    s_mov_b64 exec, -1
    v_cmp_lt_i32 vcc, 6, v180
    s_nop 0
    s_cbranch_vccz K2_SC_DONE
    v_subrev_u32 v192, s67, v43
    v_cmp_gt_u32 s[56:57], 48, v192
    s_nop 0
    s_and_b64 exec, vcc, s[56:57]
    s_cbranch_execz K2_sc_4
    v_lshl_add_u32 v194, v192, 5, v53
    v_lshl_add_u32 v195, v192, 2, v53
    v_and_b32 v196, 7, v192
    v_add_lshl_u32 v196, v196, v192, 1
    v_bfe_u32 v193, v192, 3, 1
    v_mad_i32_i24 v196, v193, -14, v196
    v_add_u32 v196, v196, v53
    ds_write_b32 v194, v63 offset:864
    ds_write2_b32 v195, v12, v13 offset0:48 offset1:96
    ds_write_b32 v195, v14 offset:576
    ds_write_b16 v196, v15 offset:768
K2_sc_4:
    s_mov_b64 exec, -1
    v_cmp_lt_i32 vcc, 8, v180
    s_nop 0
    s_cbranch_vccz K2_SC_DONE
    v_subrev_u32 v192, s67, v44
    v_cmp_gt_u32 s[56:57], 48, v192
    s_nop 0
    s_and_b64 exec, vcc, s[56:57]
    s_cbranch_execz K2_sc_5
    v_lshl_add_u32 v194, v192, 5, v54
    v_lshl_add_u32 v195, v192, 2, v54
    v_and_b32 v196, 7, v192
    v_add_lshl_u32 v196, v196, v192, 1
    v_bfe_u32 v193, v192, 3, 1
    v_mad_i32_i24 v196, v193, -14, v196
    v_add_u32 v196, v196, v54
    ds_write_b32 v194, v64 offset:864
    ds_write2_b32 v195, v16, v17 offset0:48 offset1:96
    ds_write_b32 v195, v18 offset:576
    ds_write_b16 v196, v19 offset:768
K2_sc_5:
    s_mov_b64 exec, -1
    v_cmp_lt_i32 vcc, 10, v180
    s_nop 0
    s_cbranch_vccz K2_SC_DONE
    v_subrev_u32 v192, s67, v45
    v_cmp_gt_u32 s[56:57], 48, v192
    s_nop 0
    s_and_b64 exec, vcc, s[56:57]
    s_cbranch_execz K2_sc_6
    v_lshl_add_u32 v194, v192, 5, v55
    v_lshl_add_u32 v195, v192, 2, v55
    v_and_b32 v196, 7, v192
    v_add_lshl_u32 v196, v196, v192, 1
    v_bfe_u32 v193, v192, 3, 1
    v_mad_i32_i24 v196, v193, -14, v196
    v_add_u32 v196, v196, v55
    ds_write_b32 v194, v65 offset:864
    ds_write2_b32 v195, v20, v21 offset0:48 offset1:96
    ds_write_b32 v195, v22 offset:576
    ds_write_b16 v196, v23 offset:768
K2_sc_6:
    s_mov_b64 exec, -1
    v_cmp_lt_i32 vcc, 12, v180
    s_nop 0
    s_cbranch_vccz K2_SC_DONE
    v_subrev_u32 v192, s67, v46
    v_cmp_gt_u32 s[56:57], 48, v192
    s_nop 0
    s_and_b64 exec, vcc, s[56:57]
    s_cbranch_execz K2_sc_7
    v_lshl_add_u32 v194, v192, 5, v56
    v_lshl_add_u32 v195, v192, 2, v56
    v_and_b32 v196, 7, v192
    v_add_lshl_u32 v196, v196, v192, 1
    v_bfe_u32 v193, v192, 3, 1
    v_mad_i32_i24 v196, v193, -14, v196
    v_add_u32 v196, v196, v56
    ds_write_b32 v194, v66 offset:864
    ds_write2_b32 v195, v24, v25 offset0:48 offset1:96
    ds_write_b32 v195, v26 offset:576
    ds_write_b16 v196, v27 offset:768
K2_sc_7:
    s_mov_b64 exec, -1
    v_cmp_lt_i32 vcc, 14, v180
    s_nop 0
    s_cbranch_vccz K2_SC_DONE
    v_subrev_u32 v192, s67, v47
    v_cmp_gt_u32 s[56:57], 48, v192
    s_nop 0
    s_and_b64 exec, vcc, s[56:57]
    s_cbranch_execz K2_sc_8
    v_lshl_add_u32 v194, v192, 5, v57
    v_lshl_add_u32 v195, v192, 2, v57
    v_and_b32 v196, 7, v192
    v_add_lshl_u32 v196, v196, v192, 1
    v_bfe_u32 v193, v192, 3, 1
    v_mad_i32_i24 v196, v193, -14, v196
    v_add_u32 v196, v196, v57
    ds_write_b32 v194, v67 offset:864
    ds_write2_b32 v195, v28, v29 offset0:48 offset1:96
    ds_write_b32 v195, v30 offset:576
    ds_write_b16 v196, v31 offset:768
K2_sc_8:
    s_mov_b64 exec, -1
    v_cmp_lt_i32 vcc, 16, v180
    s_nop 0
    s_cbranch_vccz K2_SC_DONE
    v_subrev_u32 v192, s67, v48
    v_cmp_gt_u32 s[56:57], 48, v192
    s_nop 0
    s_and_b64 exec, vcc, s[56:57]
    s_cbranch_execz K2_sc_9
    v_lshl_add_u32 v194, v192, 5, v58
    v_lshl_add_u32 v195, v192, 2, v58
    v_and_b32 v196, 7, v192
    v_add_lshl_u32 v196, v196, v192, 1
    v_bfe_u32 v193, v192, 3, 1
    v_mad_i32_i24 v196, v193, -14, v196
    v_add_u32 v196, v196, v58
    ds_write_b32 v194, v68 offset:864
    ds_write2_b32 v195, v32, v33 offset0:48 offset1:96
    ds_write_b32 v195, v34 offset:576
    ds_write_b16 v196, v35 offset:768
K2_sc_9:
    s_mov_b64 exec, -1
    v_cmp_lt_i32 vcc, 18, v180
    s_nop 0
    s_cbranch_vccz K2_SC_DONE
    v_subrev_u32 v192, s67, v49
    v_cmp_gt_u32 s[56:57], 48, v192
    s_nop 0
    s_and_b64 exec, vcc, s[56:57]
    s_cbranch_execz K2_sc_10
    v_lshl_add_u32 v194, v192, 5, v59
    v_lshl_add_u32 v195, v192, 2, v59
    v_and_b32 v196, 7, v192
    v_add_lshl_u32 v196, v196, v192, 1
    v_bfe_u32 v193, v192, 3, 1
    v_mad_i32_i24 v196, v193, -14, v196
    v_add_u32 v196, v196, v59
    ds_write_b32 v194, v69 offset:864
    ds_write2_b32 v195, v36, v37 offset0:48 offset1:96
    ds_write_b32 v195, v38 offset:576
    ds_write_b16 v196, v39 offset:768
K2_sc_10:
    s_mov_b64 exec, -1
K2_SC_DONE:
    v_lshlrev_b32 v192, 2, v176
    v_add_u32 v192, 163424, v192
    v_mov_b32 v200, 163652
    v_mov_b32 v198, 0
    s_movk_i32 s26, 48
    s_waitcnt lgkmcnt(0)
    s_barrier
    ds_read_b32 v193, v192
    ds_read_b32 v200, v200
    v_cmp_gt_u32 s[56:57], s22, v176
    v_mad_u32_u24 v195, v176, s59, v202
    v_lshl_or_b32 v195, v176, 21, v195
    s_waitcnt lgkmcnt(0)
    v_cndmask_b32 v193, 0, v193, s[56:57]
    v_readfirstlane_b32 s27, v200
    v_cmp_lt_u32 vcc, 48, v193
    s_nop 0
    s_cbranch_vccnz K2_BIG
K2_TOK:
    v_subrev_u32 v194, s67, v193
    v_max_i32 v194, 1, v194
    v_min_i32 v194, s26, v194
    v_add_u32 v194, 15, v194
    v_lshrrev_b32 v194, 4, v194
    v_lshl_or_b32 v195, v194, 18, v195
    v_or_b32 v195, v195, v198
    v_mov_b32 v197, 425056
    v_cndmask_b32 v253, v197, v195, s[56:57]
    s_movk_i32 s40, 0
    s_movk_i32 s41, 256
    s_movk_i32 s42, 512
    s_movk_i32 s43, 768
    s_mov_b32 s38, 0
    s_mov_b32 s34, 0
    s_mov_b32 s35, 0
    s_mov_b32 s36, 1
    s_mov_b32 s31, 0
    s_mov_b32 s58, s20
    v_readlane_b32 s3, v253, s58
    s_lshl_b32 s44, s34, 7
    s_lshl_b32 s60, s58, 5
    s_and_b32 s48, s3, 0x3ffff
    s_bfe_u32 s33, s3, 0x30012
    s_sub_u32 s60, s60, s48
    s_and_b32 s60, s60, 0xff
    s_add_u32 s60, s60, s48
    s_mul_i32 s35, s38, 6
    s_cmp_eq_u32 s34, 0
    s_cselect_b32 s35, s35, s60
    s_mov_b32 s45, s44
    s_add_u32 s47, s44, 256
    s_add_u32 s49, s48, 32
    s_add_u32 s60, s48, 64
    s_cmp_eq_u32 s33, 3
    s_cselect_b32 s46, s44, s47
    s_cselect_b32 s50, s60, s48
    s_cselect_b32 s51, s48, s49
    s_sub_u32 s60, s33, 2
    s_cmp_lt_u32 s60, 2
    s_cbranch_scc0 K2_rare_21
K2_back_22:
    v_add_u32 v233, s48, v230
    ds_read_b32 v232, v233
    ds_read_b32 v233, v233 offset:1024
    v_add_u32 v222, s48, v251
    ds_read_b32 v222, v222
    v_add_u32 v224, s49, v251
    ds_read_b32 v224, v224
    v_add_u32 v226, s50, v251
    ds_read_b32 v226, v226
    v_add_u32 v228, s51, v251
    ds_read_b32 v228, v228
    s_waitcnt lgkmcnt(4)
    v_or_b32 v232, v232, v231
    v_or_b32 v233, v233, v231
    s_cmp_lg_u32 s34, 0
    s_cbranch_scc1 K2_dum_24
    s_add_u32 m0, s48, 864
    s_add_u32 s65, s48, 1888
    buffer_load_dwordx4 v232, s[16:19], 0 offen  lds
    s_mov_b32 m0, s65
    s_mov_b32 exec_hi, 0
    buffer_load_dwordx4 v233, s[16:19], 0 offen  lds
    s_cmp_eq_u32 s33, 4
    s_cbranch_scc1 K2_a4_25
K2_b4_27:
    s_mov_b32 exec_hi, -1
K2_back_26:
    s_waitcnt lgkmcnt(3)
    v_mad_u32_u16 v223, v222, s39, v248 op_sel:[1,0,0,0]
    v_mad_u32_u16 v222, v222, s39, v248
    s_waitcnt lgkmcnt(2)
    v_mad_u32_u16 v225, v224, s39, v248 op_sel:[1,0,0,0]
    v_mad_u32_u16 v224, v224, s39, v248
    s_waitcnt lgkmcnt(1)
    v_mad_u32_u16 v227, v226, s39, v248 op_sel:[1,0,0,0]
    v_mad_u32_u16 v226, v226, s39, v248
    s_waitcnt lgkmcnt(0)
    v_mad_u32_u16 v229, v228, s39, v248 op_sel:[1,0,0,0]
    v_mad_u32_u16 v228, v228, s39, v248
    s_mov_b32 m0, s68
    s_nop 0
    buffer_load_dwordx4 v222, s[4:7], s44 offen lds
    buffer_load_dwordx4 v223, s[72:75], s44 offen offset:1024 lds
    s_barrier
    s_mov_b32 m0, s69
    s_nop 0
    buffer_load_dwordx4 v224, s[4:7], s45 offen lds
    buffer_load_dwordx4 v225, s[72:75], s45 offen offset:1024 lds
    s_mov_b32 m0, s70
    s_nop 0
    buffer_load_dwordx4 v226, s[4:7], s46 offen lds
    buffer_load_dwordx4 v227, s[72:75], s46 offen offset:1024 lds
    s_mov_b32 m0, s71
    s_nop 0
    buffer_load_dwordx4 v228, s[4:7], s47 offen lds
    buffer_load_dwordx4 v229, s[72:75], s47 offen offset:1024 lds
    v_add_u32 v249, s48, v249
    v_add_u32 v250, s48, v250
    s_waitcnt vmcnt(6)
    ds_read_b64_tr_b16 v[176:177], v246 offset:0
    ds_read_b64_tr_b16 v[178:179], v246 offset:512
    ds_read_b64_tr_b16 v[180:181], v247 offset:0
    ds_read_b64_tr_b16 v[182:183], v247 offset:512
    ds_read_b64_tr_b16 v[0:1], v249 offset:0
    ds_read_b64_tr_b16 v[2:3], v249 offset:128
    ds_read_b128 v[4:7], v250 offset:0
    ds_read_b128 v[8:11], v250 offset:16
    ds_read_b128 v[12:15], v250 offset:384
    ds_read_b128 v[16:19], v250 offset:400
    ds_read_b64_tr_b16 v[20:21], v249 offset:512
    ds_read_b64_tr_b16 v[22:23], v249 offset:640
    ds_read_b128 v[24:27], v250 offset:64
    ds_read_b128 v[28:31], v250 offset:80
    ds_read_b128 v[32:35], v250 offset:448
    ds_read_b128 v[36:39], v250 offset:464
    s_mov_b32 s29, s48
    s_mov_b32 s32, s31
    s_mov_b32 s30, s3
    s_mov_b32 s31, s35
    s_cmp_eq_u32 s33, 2
    s_cbranch_scc1 K2_U20
    s_cmp_eq_u32 s33, 3
    s_cbranch_scc1 K2_U30
    s_cmp_eq_u32 s33, 1
    s_cbranch_scc1 K2_U10
    s_branch K2_U40
K2_U20:
    s_setprio 1
    s_waitcnt lgkmcnt(10)
    v_lshlrev_b32 v40, 16, v0
    v_and_b32 v41, 0xffff0000, v0
    v_lshlrev_b32 v42, 16, v1
    v_and_b32 v43, 0xffff0000, v1
    v_lshlrev_b32 v44, 16, v2
    v_and_b32 v45, 0xffff0000, v2
    v_lshlrev_b32 v46, 16, v3
    v_and_b32 v47, 0xffff0000, v3
    s_waitcnt lgkmcnt(8)
    v_mul_f32 v4, v40, v4
    v_mul_f32 v5, v41, v5
    v_mul_f32 v6, v42, v6
    v_mul_f32 v7, v43, v7
    v_mul_f32 v8, v44, v8
    v_mul_f32 v9, v45, v9
    v_mul_f32 v10, v46, v10
    v_mul_f32 v11, v47, v11
    v_cvt_pk_bf16_f32 v64, v4, v5
    v_cvt_pk_bf16_f32 v65, v6, v7
    v_cvt_pk_bf16_f32 v66, v8, v9
    v_cvt_pk_bf16_f32 v67, v10, v11
    s_waitcnt lgkmcnt(6)
    v_mul_f32 v12, v40, v12
    v_mul_f32 v13, v41, v13
    v_mul_f32 v14, v42, v14
    v_mul_f32 v15, v43, v15
    v_mul_f32 v16, v44, v16
    v_mul_f32 v17, v45, v17
    v_mul_f32 v18, v46, v18
    v_mul_f32 v19, v47, v19
    v_cvt_pk_bf16_f32 v68, v12, v13
    v_cvt_pk_bf16_f32 v69, v14, v15
    v_cvt_pk_bf16_f32 v70, v16, v17
    v_cvt_pk_bf16_f32 v71, v18, v19
    s_waitcnt lgkmcnt(4)
    v_lshlrev_b32 v48, 16, v20
    v_and_b32 v49, 0xffff0000, v20
    v_lshlrev_b32 v50, 16, v21
    v_and_b32 v51, 0xffff0000, v21
    v_lshlrev_b32 v52, 16, v22
    v_and_b32 v53, 0xffff0000, v22
    v_lshlrev_b32 v54, 16, v23
    v_and_b32 v55, 0xffff0000, v23
    s_waitcnt lgkmcnt(2)
    v_mul_f32 v24, v48, v24
    v_mul_f32 v25, v49, v25
    v_mul_f32 v26, v50, v26
    v_mul_f32 v27, v51, v27
    v_mul_f32 v28, v52, v28
    v_mul_f32 v29, v53, v29
    v_mul_f32 v30, v54, v30
    v_mul_f32 v31, v55, v31
    v_cvt_pk_bf16_f32 v72, v24, v25
    v_cvt_pk_bf16_f32 v73, v26, v27
    v_cvt_pk_bf16_f32 v74, v28, v29
    v_cvt_pk_bf16_f32 v75, v30, v31
    s_waitcnt lgkmcnt(0)
    v_mul_f32 v32, v48, v32
    v_mul_f32 v33, v49, v33
    v_mul_f32 v34, v50, v34
    v_mul_f32 v35, v51, v35
    v_mul_f32 v36, v52, v36
    v_mul_f32 v37, v53, v37
    v_mul_f32 v38, v54, v38
    v_mul_f32 v39, v55, v39
    v_cvt_pk_bf16_f32 v76, v32, v33
    v_cvt_pk_bf16_f32 v77, v34, v35
    v_cvt_pk_bf16_f32 v78, v36, v37
    v_cvt_pk_bf16_f32 v79, v38, v39
    s_waitcnt vmcnt(4)
    v_mfma_f32_32x32x16_bf16 v[0:15], v[64:67], v[176:179], 0
    ds_read_b64_tr_b16 v[184:185], v246 offset:2048
    ds_read_b64_tr_b16 v[186:187], v246 offset:2560
    ds_read_b64_tr_b16 v[188:189], v247 offset:2048
    ds_read_b64_tr_b16 v[190:191], v247 offset:2560
    s_mov_b32 m0, s68
    v_mfma_f32_32x32x16_bf16 v[16:31], v[68:71], v[176:179], 0
    buffer_load_dwordx4 v222, s[4:7], s42 offen lds
    buffer_load_dwordx4 v223, s[72:75], s42 offen offset:1024 lds
    v_permlane32_swap_b32 v242, v243
    v_permlane32_swap_b32 v240, v241
    s_add_u32 s38, s38, 1
    v_mfma_f32_32x32x16_bf16 v[32:47], v[64:67], v[180:183], 0
    v_permlane32_swap_b32 v236, v237
    v_permlane32_swap_b32 v244, v245
    v_add_f32 v242, v242, v243
    v_add_f32 v240, -v240, -v241
    v_add_f32 v236, v236, v237
    v_mfma_f32_32x32x16_bf16 v[48:63], v[68:71], v[180:183], 0
    v_add_f32 v244, v244, v245
    s_set_gpr_idx_on s32, gpr_idx(DST)
    s_nop 0
    v_cvt_pk_bf16_f32 v195, v242, v236
    v_cvt_pk_bf16_f32 v196, v244, v240
    v_cvt_pk_bf16_f32 v197, v238, v238
    s_set_gpr_idx_off
    s_waitcnt vmcnt(4) lgkmcnt(0)
    v_mfma_f32_32x32x16_bf16 v[0:15], v[72:75], v[184:187], v[0:15]
    ds_read_b64_tr_b16 v[176:177], v246 offset:4096
    ds_read_b64_tr_b16 v[178:179], v246 offset:4608
    ds_read_b64_tr_b16 v[180:181], v247 offset:4096
    ds_read_b64_tr_b16 v[182:183], v247 offset:4608
    v_mov_b32 v254, s52
    v_mov_b32 v255, s38
    s_mov_b32 m0, s69
    v_mfma_f32_32x32x16_bf16 v[16:31], v[76:79], v[184:187], v[16:31]
    buffer_load_dwordx4 v224, s[4:7], s42 offen lds
    buffer_load_dwordx4 v225, s[72:75], s42 offen offset:1024 lds
    s_lshl_b32 s58, s38, 3
    s_add_u32 s58, s58, s20
    s_mov_b64 exec, 1
    ds_write_b32 v254, v255
    s_mov_b64 exec, -1
    s_cmp_lt_u32 s58, s22
    s_cbranch_scc0 K2_dyn_28
K2_back_29:
    v_readlane_b32 s3, v253, s58
    s_lshl_b32 s44, s34, 7
    s_lshl_b32 s60, s58, 5
    s_and_b32 s48, s3, 0x3ffff
    s_bfe_u32 s33, s3, 0x30012
    s_sub_u32 s60, s60, s48
    s_and_b32 s60, s60, 0xff
    s_add_u32 s60, s60, s48
    s_mul_i32 s35, s38, 6
    s_cmp_eq_u32 s34, 0
    s_cselect_b32 s35, s35, s60
    s_mov_b32 s45, s44
    s_add_u32 s47, s44, 256
    s_add_u32 s49, s48, 32
    s_add_u32 s60, s48, 64
    s_cmp_eq_u32 s33, 3
    s_cselect_b32 s46, s44, s47
    s_cselect_b32 s50, s60, s48
    s_cselect_b32 s51, s48, s49
    s_sub_u32 s60, s33, 2
    s_cmp_lt_u32 s60, 2
    s_cbranch_scc0 K2_rare_34
K2_back_35:
    v_mfma_f32_32x32x16_bf16 v[32:47], v[72:75], v[188:191], v[32:47]
    v_add_u32 v233, s48, v230
    ds_read_b32 v232, v233
    ds_read_b32 v233, v233 offset:1024
    v_mul_f32 v234, v0, v96
    v_mul_f32 v236, v8, v128
    v_fmac_f32 v234, v1, v97
    v_fmac_f32 v236, v9, v129
    v_mfma_f32_32x32x16_bf16 v[48:63], v[76:79], v[188:191], v[48:63]
    s_setprio 0
    v_fmac_f32 v234, v2, v98
    v_fmac_f32 v236, v10, v130
    v_fmac_f32 v234, v3, v99
    v_fmac_f32 v236, v11, v131
    v_fmac_f32 v234, v4, v100
    v_fmac_f32 v236, v12, v132
    v_fmac_f32 v234, v5, v101
    v_fmac_f32 v236, v13, v133
    v_fmac_f32 v234, v6, v102
    v_fmac_f32 v236, v14, v134
    v_fmac_f32 v234, v7, v103
    v_fmac_f32 v236, v15, v135
    v_mul_f32 v238, v16, v128
    v_mul_f32 v240, v24, v128
    v_fmac_f32 v238, v17, v129
    v_fmac_f32 v240, v25, v129
    v_fmac_f32 v238, v18, v130
    v_fmac_f32 v240, v26, v130
    v_fmac_f32 v238, v19, v131
    v_fmac_f32 v240, v27, v131
    v_fmac_f32 v238, v20, v132
    v_fmac_f32 v240, v28, v132
    v_fmac_f32 v238, v21, v133
    v_fmac_f32 v240, v29, v133
    v_fmac_f32 v238, v22, v134
    v_fmac_f32 v240, v30, v134
    v_fmac_f32 v238, v23, v135
    v_fmac_f32 v240, v31, v135
    v_mul_f32 v235, v32, v104
    v_mul_f32 v237, v40, v136
    v_fmac_f32 v235, v33, v105
    v_fmac_f32 v237, v41, v137
    v_fmac_f32 v235, v34, v106
    v_fmac_f32 v237, v42, v138
    v_fmac_f32 v235, v35, v107
    v_fmac_f32 v237, v43, v139
    v_fmac_f32 v235, v36, v108
    v_fmac_f32 v237, v44, v140
    v_fmac_f32 v235, v37, v109
    v_fmac_f32 v237, v45, v141
    v_fmac_f32 v235, v38, v110
    v_fmac_f32 v237, v46, v142
    v_fmac_f32 v235, v39, v111
    v_fmac_f32 v237, v47, v143
    v_mul_f32 v239, v48, v136
    v_mul_f32 v241, v56, v136
    v_fmac_f32 v239, v49, v137
    v_fmac_f32 v241, v57, v137
    s_setprio 1
    s_waitcnt vmcnt(4) lgkmcnt(3)
    v_mfma_f32_32x32x16_bf16 v[0:15], v[64:67], v[176:179], 0
    ds_read_b64_tr_b16 v[184:185], v246 offset:6144
    ds_read_b64_tr_b16 v[186:187], v246 offset:6656
    ds_read_b64_tr_b16 v[188:189], v247 offset:6144
    ds_read_b64_tr_b16 v[190:191], v247 offset:6656
    v_fmac_f32 v239, v50, v138
    v_fmac_f32 v241, v58, v138
    s_mov_b32 m0, s70
    v_mfma_f32_32x32x16_bf16 v[16:31], v[68:71], v[176:179], 0
    buffer_load_dwordx4 v222, s[4:7], s43 offen lds
    buffer_load_dwordx4 v223, s[72:75], s43 offen offset:1024 lds
    v_fmac_f32 v239, v51, v139
    v_fmac_f32 v241, v59, v139
    v_fmac_f32 v239, v52, v140
    v_fmac_f32 v241, v60, v140
    v_fmac_f32 v239, v53, v141
    v_mfma_f32_32x32x16_bf16 v[32:47], v[64:67], v[180:183], 0
    v_add_u32 v222, s48, v251
    ds_read_b32 v222, v222
    v_fmac_f32 v241, v61, v141
    v_fmac_f32 v239, v54, v142
    v_fmac_f32 v241, v62, v142
    v_fmac_f32 v239, v55, v143
    v_fmac_f32 v241, v63, v143
    v_mfma_f32_32x32x16_bf16 v[48:63], v[68:71], v[180:183], 0
    v_permlane32_swap_b32 v234, v235
    v_permlane32_swap_b32 v236, v237
    v_permlane32_swap_b32 v238, v239
    s_waitcnt lgkmcnt(5)
    v_or_b32 v232, v232, v231
    v_or_b32 v233, v233, v231
    s_cmp_lg_u32 s34, 0
    s_cbranch_scc1 K2_dum_37
    s_add_u32 m0, s48, 864
    s_add_u32 s65, s48, 1888
    buffer_load_dwordx4 v232, s[16:19], 0 offen  lds
    s_mov_b32 m0, s65
    s_mov_b32 exec_hi, 0
    buffer_load_dwordx4 v233, s[16:19], 0 offen  lds
    s_cmp_eq_u32 s33, 4
    s_cbranch_scc1 K2_a4_38
K2_b4_40:
    s_mov_b32 exec_hi, -1
K2_back_39:
    s_waitcnt vmcnt(6) lgkmcnt(1)
    v_mfma_f32_32x32x16_bf16 v[0:15], v[72:75], v[184:187], v[0:15]
    ds_read_b64_tr_b16 v[176:177], v246 offset:0
    ds_read_b64_tr_b16 v[178:179], v246 offset:512
    ds_read_b64_tr_b16 v[180:181], v247 offset:0
    ds_read_b64_tr_b16 v[182:183], v247 offset:512
    v_permlane32_swap_b32 v240, v241
    s_mov_b32 m0, s71
    v_mfma_f32_32x32x16_bf16 v[16:31], v[76:79], v[184:187], v[16:31]
    buffer_load_dwordx4 v224, s[4:7], s43 offen lds
    buffer_load_dwordx4 v225, s[72:75], s43 offen offset:1024 lds
    s_waitcnt lgkmcnt(4)
    v_mad_u32_u16 v223, v222, s39, v248 op_sel:[1,0,0,0]
    v_mad_u32_u16 v222, v222, s39, v248
    v_add_f32 v234, v234, v235
    v_add_f32 v236, v236, v237
    v_add_f32 v238, v238, v239
    v_add_f32 v240, v240, v241
    s_set_gpr_idx_on s31, gpr_idx(DST)
    s_nop 0
    v_cvt_pk_bf16_f32 v192, v234, v236
    v_cvt_pk_bf16_f32 v193, v238, v240
    s_set_gpr_idx_off
    v_mfma_f32_32x32x16_bf16 v[32:47], v[72:75], v[188:191], v[32:47]
    v_add_u32 v224, s49, v251
    ds_read_b32 v224, v224
    v_mul_f32 v234, v0, v144
    v_mul_f32 v236, v8, v112
    v_fmac_f32 v234, v1, v145
    v_fmac_f32 v236, v9, v113
    v_fmac_f32 v234, v2, v146
    v_mfma_f32_32x32x16_bf16 v[48:63], v[76:79], v[188:191], v[48:63]
    s_setprio 0
    v_fmac_f32 v236, v10, v114
    v_fmac_f32 v234, v3, v147
    v_fmac_f32 v236, v11, v115
    v_fmac_f32 v234, v4, v148
    v_fmac_f32 v236, v12, v116
    v_fmac_f32 v234, v5, v149
    v_fmac_f32 v236, v13, v117
    v_fmac_f32 v234, v6, v150
    v_fmac_f32 v236, v14, v118
    v_fmac_f32 v234, v7, v151
    v_fmac_f32 v236, v15, v119
    v_mul_f32 v238, v16, v160
    v_mul_f32 v240, v24, v160
    v_fmac_f32 v238, v17, v161
    v_fmac_f32 v240, v25, v161
    v_fmac_f32 v238, v18, v162
    v_fmac_f32 v240, v26, v162
    v_fmac_f32 v238, v19, v163
    v_fmac_f32 v240, v27, v163
    v_fmac_f32 v238, v20, v164
    v_fmac_f32 v240, v28, v164
    v_fmac_f32 v238, v21, v165
    v_fmac_f32 v240, v29, v165
    v_fmac_f32 v238, v22, v166
    v_fmac_f32 v240, v30, v166
    v_fmac_f32 v238, v23, v167
    v_fmac_f32 v240, v31, v167
    v_mul_f32 v235, v32, v152
    v_mul_f32 v237, v40, v120
    v_fmac_f32 v235, v33, v153
    v_fmac_f32 v237, v41, v121
    v_fmac_f32 v235, v34, v154
    v_fmac_f32 v237, v42, v122
    v_fmac_f32 v235, v35, v155
    v_fmac_f32 v237, v43, v123
    v_fmac_f32 v235, v36, v156
    v_fmac_f32 v237, v44, v124
    v_fmac_f32 v235, v37, v157
    v_fmac_f32 v237, v45, v125
    v_fmac_f32 v235, v38, v158
    v_fmac_f32 v237, v46, v126
    v_fmac_f32 v235, v39, v159
    v_fmac_f32 v237, v47, v127
    v_mul_f32 v239, v48, v168
    v_mul_f32 v241, v56, v168
    v_fmac_f32 v239, v49, v169
    v_fmac_f32 v241, v57, v169
    v_fmac_f32 v239, v50, v170
    v_fmac_f32 v241, v58, v170
    v_fmac_f32 v239, v51, v171
    s_setprio 1
    s_waitcnt vmcnt(6) lgkmcnt(1)
    v_mfma_f32_32x32x16_bf16 v[0:15], v[64:67], v[176:179], 0
    ds_read_b64_tr_b16 v[184:185], v246 offset:2048
    ds_read_b64_tr_b16 v[186:187], v246 offset:2560
    ds_read_b64_tr_b16 v[188:189], v247 offset:2048
    ds_read_b64_tr_b16 v[190:191], v247 offset:2560
    v_fmac_f32 v241, v59, v171
    v_fmac_f32 v239, v52, v172
    s_mov_b32 m0, s68
    v_mfma_f32_32x32x16_bf16 v[16:31], v[68:71], v[176:179], 0
    buffer_load_dwordx4 v222, s[4:7], s44 offen lds
    buffer_load_dwordx4 v223, s[72:75], s44 offen offset:1024 lds
    s_waitcnt lgkmcnt(4)
    v_mad_u32_u16 v225, v224, s39, v248 op_sel:[1,0,0,0]
    v_mad_u32_u16 v224, v224, s39, v248
    v_fmac_f32 v241, v60, v172
    v_fmac_f32 v239, v53, v173
    v_mfma_f32_32x32x16_bf16 v[32:47], v[64:67], v[180:183], 0
    v_add_u32 v226, s50, v251
    ds_read_b32 v226, v226
    v_fmac_f32 v241, v61, v173
    v_fmac_f32 v239, v54, v174
    v_fmac_f32 v241, v62, v174
    v_fmac_f32 v239, v55, v175
    v_fmac_f32 v241, v63, v175
    v_mfma_f32_32x32x16_bf16 v[48:63], v[68:71], v[180:183], 0
    v_permlane32_swap_b32 v234, v235
    v_add_f32 v234, v234, v235
    s_waitcnt vmcnt(6) lgkmcnt(1)
    v_mfma_f32_32x32x16_bf16 v[0:15], v[72:75], v[184:187], v[0:15]
    ds_read_b64_tr_b16 v[176:177], v246 offset:4096
    ds_read_b64_tr_b16 v[178:179], v246 offset:4608
    ds_read_b64_tr_b16 v[180:181], v247 offset:4096
    ds_read_b64_tr_b16 v[182:183], v247 offset:4608
    s_mov_b32 m0, s69
    v_mfma_f32_32x32x16_bf16 v[16:31], v[76:79], v[184:187], v[16:31]
    buffer_load_dwordx4 v224, s[4:7], s45 offen lds
    buffer_load_dwordx4 v225, s[72:75], s45 offen offset:1024 lds
    s_waitcnt lgkmcnt(4)
    v_mad_u32_u16 v227, v226, s39, v248 op_sel:[1,0,0,0]
    v_mad_u32_u16 v226, v226, s39, v248
    v_mfma_f32_32x32x16_bf16 v[32:47], v[72:75], v[188:191], v[32:47]
    v_add_u32 v228, s51, v251
    ds_read_b32 v228, v228
    v_mul_f32 v242, v0, v144
    v_fma_f32 v238, v8, v160, -v238
    v_fmac_f32 v242, v1, v145
    v_fmac_f32 v238, v9, v161
    v_fmac_f32 v242, v2, v146
    v_mfma_f32_32x32x16_bf16 v[48:63], v[76:79], v[188:191], v[48:63]
    s_setprio 0
    v_fmac_f32 v238, v10, v162
    v_fmac_f32 v242, v3, v147
    v_fmac_f32 v238, v11, v163
    v_fmac_f32 v242, v4, v148
    v_fmac_f32 v238, v12, v164
    v_fmac_f32 v242, v5, v149
    v_fmac_f32 v238, v13, v165
    v_fmac_f32 v242, v6, v150
    v_fmac_f32 v238, v14, v166
    v_fmac_f32 v242, v7, v151
    v_fmac_f32 v238, v15, v167
    v_fmac_f32 v236, v16, v112
    v_mul_f32 v244, v24, v160
    v_fmac_f32 v236, v17, v113
    v_fmac_f32 v244, v25, v161
    v_fmac_f32 v236, v18, v114
    v_fmac_f32 v244, v26, v162
    v_fmac_f32 v236, v19, v115
    v_fmac_f32 v244, v27, v163
    v_fmac_f32 v236, v20, v116
    v_fmac_f32 v244, v28, v164
    v_fmac_f32 v236, v21, v117
    v_fmac_f32 v244, v29, v165
    v_fmac_f32 v236, v22, v118
    v_fmac_f32 v244, v30, v166
    v_fmac_f32 v236, v23, v119
    v_fmac_f32 v244, v31, v167
    v_mul_f32 v243, v32, v152
    v_fma_f32 v239, v40, v168, -v239
    v_fmac_f32 v243, v33, v153
    v_fmac_f32 v239, v41, v169
    v_fmac_f32 v243, v34, v154
    v_fmac_f32 v239, v42, v170
    v_fmac_f32 v243, v35, v155
    v_fmac_f32 v239, v43, v171
    v_fmac_f32 v243, v36, v156
    v_fmac_f32 v239, v44, v172
    v_fmac_f32 v243, v37, v157
    v_fmac_f32 v239, v45, v173
    v_fmac_f32 v243, v38, v158
    v_fmac_f32 v239, v46, v174
    v_fmac_f32 v243, v39, v159
    v_fmac_f32 v239, v47, v175
    v_fmac_f32 v237, v48, v120
    v_mul_f32 v245, v56, v168
    v_fmac_f32 v237, v49, v121
    v_fmac_f32 v245, v57, v169
    v_fmac_f32 v237, v50, v122
    s_setprio 1
    s_waitcnt vmcnt(4) lgkmcnt(1)
    v_mfma_f32_32x32x16_bf16 v[0:15], v[64:67], v[176:179], 0
    ds_read_b64_tr_b16 v[184:185], v246 offset:6144
    ds_read_b64_tr_b16 v[186:187], v246 offset:6656
    ds_read_b64_tr_b16 v[188:189], v247 offset:6144
    ds_read_b64_tr_b16 v[190:191], v247 offset:6656
    v_fmac_f32 v245, v58, v170
    v_fmac_f32 v237, v51, v123
    s_mov_b32 m0, s70
    v_mfma_f32_32x32x16_bf16 v[16:31], v[68:71], v[176:179], 0
    buffer_load_dwordx4 v226, s[4:7], s46 offen lds
    buffer_load_dwordx4 v227, s[72:75], s46 offen offset:1024 lds
    s_waitcnt lgkmcnt(4)
    v_mad_u32_u16 v229, v228, s39, v248 op_sel:[1,0,0,0]
    v_mad_u32_u16 v228, v228, s39, v248
    v_fmac_f32 v245, v59, v171
    v_fmac_f32 v237, v52, v124
    v_mfma_f32_32x32x16_bf16 v[32:47], v[64:67], v[180:183], 0
    v_fmac_f32 v245, v60, v172
    v_fmac_f32 v237, v53, v125
    v_fmac_f32 v245, v61, v173
    v_fmac_f32 v237, v54, v126
    v_fmac_f32 v245, v62, v174
    v_fmac_f32 v237, v55, v127
    v_fmac_f32 v245, v63, v175
    v_mfma_f32_32x32x16_bf16 v[48:63], v[68:71], v[180:183], 0
    v_permlane32_swap_b32 v238, v239
    v_permlane32_swap_b32 v242, v243
    v_add_f32 v238, v238, v239
    v_add_f32 v242, v242, v243
    s_waitcnt vmcnt(4) lgkmcnt(0)
    v_mfma_f32_32x32x16_bf16 v[0:15], v[72:75], v[184:187], v[0:15]
    ds_read_b64_tr_b16 v[176:177], v246 offset:0
    ds_read_b64_tr_b16 v[178:179], v246 offset:512
    ds_read_b64_tr_b16 v[180:181], v247 offset:0
    ds_read_b64_tr_b16 v[182:183], v247 offset:512
    s_mov_b32 m0, s71
    v_mfma_f32_32x32x16_bf16 v[16:31], v[76:79], v[184:187], v[16:31]
    buffer_load_dwordx4 v228, s[4:7], s47 offen lds
    buffer_load_dwordx4 v229, s[72:75], s47 offen offset:1024 lds
    s_set_gpr_idx_on s31, gpr_idx(DST)
    s_nop 0
    v_cvt_pk_bf16_f32 v194, v234, v242
    s_set_gpr_idx_off
    v_mfma_f32_32x32x16_bf16 v[32:47], v[72:75], v[188:191], v[32:47]
    v_mul_f32 v242, v0, v144
    v_fma_f32 v240, v8, v160, -v240
    v_fmac_f32 v242, v1, v145
    v_fmac_f32 v240, v9, v161
    v_fmac_f32 v242, v2, v146
    v_fmac_f32 v240, v10, v162
    v_fmac_f32 v242, v3, v147
    v_mfma_f32_32x32x16_bf16 v[48:63], v[76:79], v[188:191], v[48:63]
    s_setprio 0
    v_fmac_f32 v240, v11, v163
    v_fmac_f32 v242, v4, v148
    v_fmac_f32 v240, v12, v164
    v_fmac_f32 v242, v5, v149
    v_fmac_f32 v240, v13, v165
    v_fmac_f32 v242, v6, v150
    v_fmac_f32 v240, v14, v166
    v_fmac_f32 v242, v7, v151
    v_fmac_f32 v240, v15, v167
    s_sub_u32 s58, s48, s29
    v_add_u32 v249, s58, v249
    v_add_u32 v250, s58, v250
    v_fma_f32 v244, v16, v160, -v244
    v_fmac_f32 v236, v24, v112
    v_fmac_f32 v244, v17, v161
    v_fmac_f32 v236, v25, v113
    v_fmac_f32 v244, v18, v162
    v_fmac_f32 v236, v26, v114
    v_fmac_f32 v244, v19, v163
    v_fmac_f32 v236, v27, v115
    v_fmac_f32 v244, v20, v164
    v_fmac_f32 v236, v28, v116
    v_fmac_f32 v244, v21, v165
    v_fmac_f32 v236, v29, v117
    v_fmac_f32 v244, v22, v166
    v_fmac_f32 v236, v30, v118
    v_fmac_f32 v244, v23, v167
    v_fmac_f32 v236, v31, v119
    ds_read_b64_tr_b16 v[0:1], v249 offset:0
    ds_read_b64_tr_b16 v[2:3], v249 offset:128
    ds_read_b128 v[4:7], v250 offset:0
    ds_read_b128 v[8:11], v250 offset:16
    ds_read_b128 v[12:15], v250 offset:384
    ds_read_b128 v[16:19], v250 offset:400
    v_mul_f32 v243, v32, v152
    v_fma_f32 v241, v40, v168, -v241
    v_fmac_f32 v243, v33, v153
    v_fmac_f32 v241, v41, v169
    v_fmac_f32 v243, v34, v154
    v_fmac_f32 v241, v42, v170
    v_fmac_f32 v243, v35, v155
    v_fmac_f32 v241, v43, v171
    v_fmac_f32 v243, v36, v156
    v_fmac_f32 v241, v44, v172
    v_fmac_f32 v243, v37, v157
    v_fmac_f32 v241, v45, v173
    v_fmac_f32 v243, v38, v158
    v_fmac_f32 v241, v46, v174
    v_fmac_f32 v243, v39, v159
    v_fmac_f32 v241, v47, v175
    ds_read_b64_tr_b16 v[20:21], v249 offset:512
    ds_read_b64_tr_b16 v[22:23], v249 offset:640
    ds_read_b128 v[24:27], v250 offset:64
    ds_read_b128 v[28:31], v250 offset:80
    ds_read_b128 v[32:35], v250 offset:448
    ds_read_b128 v[36:39], v250 offset:464
    v_fma_f32 v245, v48, v168, -v245
    v_fmac_f32 v237, v56, v120
    v_fmac_f32 v245, v49, v169
    v_fmac_f32 v237, v57, v121
    v_fmac_f32 v245, v50, v170
    v_fmac_f32 v237, v58, v122
    v_fmac_f32 v245, v51, v171
    v_fmac_f32 v237, v59, v123
    v_fmac_f32 v245, v52, v172
    v_fmac_f32 v237, v60, v124
    v_fmac_f32 v245, v53, v173
    v_fmac_f32 v237, v61, v125
    v_fmac_f32 v245, v54, v174
    v_fmac_f32 v237, v62, v126
    v_fmac_f32 v245, v55, v175
    v_fmac_f32 v237, v63, v127
    s_cmp_lg_u32 s34, 0
    s_cbranch_scc1 K2_SWITCH
    s_mov_b32 s29, s48
    s_mov_b32 s32, s31
    s_mov_b32 s30, s3
    s_mov_b32 s31, s35
    s_cmp_eq_u32 s33, 2
    s_cbranch_scc1 K2_U20
    s_cmp_eq_u32 s33, 3
    s_cbranch_scc1 K2_U30
    s_cmp_eq_u32 s33, 1
    s_cbranch_scc1 K2_U10
    s_branch K2_U40
K2_U30:
    s_setprio 1
    s_waitcnt lgkmcnt(10)
    v_lshlrev_b32 v40, 16, v0
    v_and_b32 v41, 0xffff0000, v0
    v_lshlrev_b32 v42, 16, v1
    v_and_b32 v43, 0xffff0000, v1
    v_lshlrev_b32 v44, 16, v2
    v_and_b32 v45, 0xffff0000, v2
    v_lshlrev_b32 v46, 16, v3
    v_and_b32 v47, 0xffff0000, v3
    s_waitcnt lgkmcnt(8)
    v_mul_f32 v4, v40, v4
    v_mul_f32 v5, v41, v5
    v_mul_f32 v6, v42, v6
    v_mul_f32 v7, v43, v7
    v_mul_f32 v8, v44, v8
    v_mul_f32 v9, v45, v9
    v_mul_f32 v10, v46, v10
    v_mul_f32 v11, v47, v11
    v_cvt_pk_bf16_f32 v64, v4, v5
    v_cvt_pk_bf16_f32 v65, v6, v7
    v_cvt_pk_bf16_f32 v66, v8, v9
    v_cvt_pk_bf16_f32 v67, v10, v11
    s_waitcnt lgkmcnt(6)
    v_mul_f32 v12, v40, v12
    v_mul_f32 v13, v41, v13
    v_mul_f32 v14, v42, v14
    v_mul_f32 v15, v43, v15
    v_mul_f32 v16, v44, v16
    v_mul_f32 v17, v45, v17
    v_mul_f32 v18, v46, v18
    v_mul_f32 v19, v47, v19
    v_cvt_pk_bf16_f32 v68, v12, v13
    v_cvt_pk_bf16_f32 v69, v14, v15
    v_cvt_pk_bf16_f32 v70, v16, v17
    v_cvt_pk_bf16_f32 v71, v18, v19
    ds_read_b64_tr_b16 v[0:1], v249 offset:1024
    ds_read_b64_tr_b16 v[2:3], v249 offset:1152
    ds_read_b128 v[4:7], v250 offset:128
    ds_read_b128 v[8:11], v250 offset:144
    ds_read_b128 v[12:15], v250 offset:512
    ds_read_b128 v[16:19], v250 offset:528
    s_waitcnt lgkmcnt(10)
    v_lshlrev_b32 v48, 16, v20
    v_and_b32 v49, 0xffff0000, v20
    v_lshlrev_b32 v50, 16, v21
    v_and_b32 v51, 0xffff0000, v21
    v_lshlrev_b32 v52, 16, v22
    v_and_b32 v53, 0xffff0000, v22
    v_lshlrev_b32 v54, 16, v23
    v_and_b32 v55, 0xffff0000, v23
    s_waitcnt lgkmcnt(8)
    v_mul_f32 v24, v48, v24
    v_mul_f32 v25, v49, v25
    v_mul_f32 v26, v50, v26
    v_mul_f32 v27, v51, v27
    v_mul_f32 v28, v52, v28
    v_mul_f32 v29, v53, v29
    v_mul_f32 v30, v54, v30
    v_mul_f32 v31, v55, v31
    v_cvt_pk_bf16_f32 v72, v24, v25
    v_cvt_pk_bf16_f32 v73, v26, v27
    v_cvt_pk_bf16_f32 v74, v28, v29
    v_cvt_pk_bf16_f32 v75, v30, v31
    s_waitcnt lgkmcnt(6)
    v_mul_f32 v32, v48, v32
    v_mul_f32 v33, v49, v33
    v_mul_f32 v34, v50, v34
    v_mul_f32 v35, v51, v35
    v_mul_f32 v36, v52, v36
    v_mul_f32 v37, v53, v37
    v_mul_f32 v38, v54, v38
    v_mul_f32 v39, v55, v39
    v_cvt_pk_bf16_f32 v76, v32, v33
    v_cvt_pk_bf16_f32 v77, v34, v35
    v_cvt_pk_bf16_f32 v78, v36, v37
    v_cvt_pk_bf16_f32 v79, v38, v39
    s_waitcnt lgkmcnt(4)
    v_lshlrev_b32 v40, 16, v0
    v_and_b32 v41, 0xffff0000, v0
    v_lshlrev_b32 v42, 16, v1
    v_and_b32 v43, 0xffff0000, v1
    v_lshlrev_b32 v44, 16, v2
    v_and_b32 v45, 0xffff0000, v2
    v_lshlrev_b32 v46, 16, v3
    v_and_b32 v47, 0xffff0000, v3
    s_waitcnt lgkmcnt(2)
    v_mul_f32 v4, v40, v4
    v_mul_f32 v5, v41, v5
    v_mul_f32 v6, v42, v6
    v_mul_f32 v7, v43, v7
    v_mul_f32 v8, v44, v8
    v_mul_f32 v9, v45, v9
    v_mul_f32 v10, v46, v10
    v_mul_f32 v11, v47, v11
    v_cvt_pk_bf16_f32 v80, v4, v5
    v_cvt_pk_bf16_f32 v81, v6, v7
    v_cvt_pk_bf16_f32 v82, v8, v9
    v_cvt_pk_bf16_f32 v83, v10, v11
    s_waitcnt lgkmcnt(0)
    v_mul_f32 v12, v40, v12
    v_mul_f32 v13, v41, v13
    v_mul_f32 v14, v42, v14
    v_mul_f32 v15, v43, v15
    v_mul_f32 v16, v44, v16
    v_mul_f32 v17, v45, v17
    v_mul_f32 v18, v46, v18
    v_mul_f32 v19, v47, v19
    v_cvt_pk_bf16_f32 v84, v12, v13
    v_cvt_pk_bf16_f32 v85, v14, v15
    v_cvt_pk_bf16_f32 v86, v16, v17
    v_cvt_pk_bf16_f32 v87, v18, v19
    s_waitcnt vmcnt(4)
    v_mfma_f32_32x32x16_bf16 v[0:15], v[64:67], v[176:179], 0
    ds_read_b64_tr_b16 v[184:185], v246 offset:2048
    ds_read_b64_tr_b16 v[186:187], v246 offset:2560
    ds_read_b64_tr_b16 v[188:189], v247 offset:2048
    ds_read_b64_tr_b16 v[190:191], v247 offset:2560
    s_mov_b32 m0, s68
    v_mfma_f32_32x32x16_bf16 v[16:31], v[68:71], v[176:179], 0
    buffer_load_dwordx4 v224, s[4:7], s41 offen lds
    buffer_load_dwordx4 v225, s[72:75], s41 offen offset:1024 lds
    v_permlane32_swap_b32 v242, v243
    v_permlane32_swap_b32 v240, v241
    s_add_u32 s38, s38, 1
    v_mfma_f32_32x32x16_bf16 v[32:47], v[64:67], v[180:183], 0
    v_permlane32_swap_b32 v236, v237
    v_permlane32_swap_b32 v244, v245
    v_add_f32 v242, v242, v243
    v_add_f32 v240, -v240, -v241
    v_add_f32 v236, v236, v237
    v_mfma_f32_32x32x16_bf16 v[48:63], v[68:71], v[180:183], 0
    v_add_f32 v244, v244, v245
    s_set_gpr_idx_on s32, gpr_idx(DST)
    s_nop 0
    v_cvt_pk_bf16_f32 v195, v242, v236
    v_cvt_pk_bf16_f32 v196, v244, v240
    v_cvt_pk_bf16_f32 v197, v238, v238
    s_set_gpr_idx_off
    s_waitcnt vmcnt(4) lgkmcnt(0)
    v_mfma_f32_32x32x16_bf16 v[0:15], v[72:75], v[184:187], v[0:15]
    ds_read_b64_tr_b16 v[176:177], v246 offset:4096
    ds_read_b64_tr_b16 v[178:179], v246 offset:4608
    ds_read_b64_tr_b16 v[180:181], v247 offset:4096
    ds_read_b64_tr_b16 v[182:183], v247 offset:4608
    v_mov_b32 v254, s52
    v_mov_b32 v255, s38
    s_mov_b32 m0, s69
    v_mfma_f32_32x32x16_bf16 v[16:31], v[76:79], v[184:187], v[16:31]
    buffer_load_dwordx4 v226, s[4:7], s41 offen lds
    buffer_load_dwordx4 v227, s[72:75], s41 offen offset:1024 lds
    s_lshl_b32 s58, s38, 3
    s_add_u32 s58, s58, s20
    s_mov_b64 exec, 1
    ds_write_b32 v254, v255
    s_mov_b64 exec, -1
    s_cmp_lt_u32 s58, s22
    s_cbranch_scc0 K2_dyn_41
K2_back_42:
    v_readlane_b32 s3, v253, s58
    s_lshl_b32 s44, s34, 7
    s_lshl_b32 s60, s58, 5
    s_and_b32 s48, s3, 0x3ffff
    s_bfe_u32 s33, s3, 0x30012
    s_sub_u32 s60, s60, s48
    s_and_b32 s60, s60, 0xff
    s_add_u32 s60, s60, s48
    s_mul_i32 s35, s38, 6
    s_cmp_eq_u32 s34, 0
    s_cselect_b32 s35, s35, s60
    s_mov_b32 s45, s44
    s_add_u32 s47, s44, 256
    s_add_u32 s49, s48, 32
    s_add_u32 s60, s48, 64
    s_cmp_eq_u32 s33, 3
    s_cselect_b32 s46, s44, s47
    s_cselect_b32 s50, s60, s48
    s_cselect_b32 s51, s48, s49
    s_sub_u32 s60, s33, 2
    s_cmp_lt_u32 s60, 2
    s_cbranch_scc0 K2_rare_47
K2_back_48:
    v_mfma_f32_32x32x16_bf16 v[32:47], v[72:75], v[188:191], v[32:47]
    v_add_u32 v233, s48, v230
    ds_read_b32 v232, v233
    ds_read_b32 v233, v233 offset:1024
    v_mfma_f32_32x32x16_bf16 v[48:63], v[76:79], v[188:191], v[48:63]
    s_waitcnt vmcnt(4) lgkmcnt(3)
    v_mfma_f32_32x32x16_bf16 v[0:15], v[80:83], v[176:179], v[0:15]
    ds_read_b64_tr_b16 v[184:185], v246 offset:6144
    ds_read_b64_tr_b16 v[186:187], v246 offset:6656
    ds_read_b64_tr_b16 v[188:189], v247 offset:6144
    ds_read_b64_tr_b16 v[190:191], v247 offset:6656
    s_mov_b32 m0, s70
    v_mfma_f32_32x32x16_bf16 v[16:31], v[84:87], v[176:179], v[16:31]
    buffer_load_dwordx4 v222, s[4:7], s42 offen lds
    buffer_load_dwordx4 v223, s[72:75], s42 offen offset:1024 lds
    v_mfma_f32_32x32x16_bf16 v[32:47], v[80:83], v[180:183], v[32:47]
    s_nop 2
    v_mul_f32 v234, v0, v96
    v_mul_f32 v236, v8, v128
    v_fmac_f32 v234, v1, v97
    v_fmac_f32 v236, v9, v129
    v_fmac_f32 v234, v2, v98
    v_fmac_f32 v236, v10, v130
    v_fmac_f32 v234, v3, v99
    v_mfma_f32_32x32x16_bf16 v[48:63], v[84:87], v[180:183], v[48:63]
    s_setprio 0
    s_waitcnt lgkmcnt(4)
    v_or_b32 v232, v232, v231
    v_or_b32 v233, v233, v231
    s_cmp_lg_u32 s34, 0
    s_cbranch_scc1 K2_dum_50
    s_add_u32 m0, s48, 864
    s_add_u32 s65, s48, 1888
    buffer_load_dwordx4 v232, s[16:19], 0 offen  lds
    s_mov_b32 m0, s65
    s_mov_b32 exec_hi, 0
    buffer_load_dwordx4 v233, s[16:19], 0 offen  lds
    s_cmp_eq_u32 s33, 4
    s_cbranch_scc1 K2_a4_51
K2_b4_53:
    s_mov_b32 exec_hi, -1
K2_back_52:
    v_fmac_f32 v236, v11, v131
    v_fmac_f32 v234, v4, v100
    v_fmac_f32 v236, v12, v132
    v_fmac_f32 v234, v5, v101
    v_fmac_f32 v236, v13, v133
    v_fmac_f32 v234, v6, v102
    v_fmac_f32 v236, v14, v134
    v_fmac_f32 v234, v7, v103
    v_fmac_f32 v236, v15, v135
    v_mul_f32 v238, v16, v128
    v_mul_f32 v240, v24, v128
    v_fmac_f32 v238, v17, v129
    v_fmac_f32 v240, v25, v129
    v_fmac_f32 v238, v18, v130
    v_fmac_f32 v240, v26, v130
    v_fmac_f32 v238, v19, v131
    v_fmac_f32 v240, v27, v131
    v_fmac_f32 v238, v20, v132
    v_fmac_f32 v240, v28, v132
    v_fmac_f32 v238, v21, v133
    v_fmac_f32 v240, v29, v133
    v_fmac_f32 v238, v22, v134
    v_fmac_f32 v240, v30, v134
    v_fmac_f32 v238, v23, v135
    v_fmac_f32 v240, v31, v135
    v_mul_f32 v235, v32, v104
    v_mul_f32 v237, v40, v136
    v_fmac_f32 v235, v33, v105
    v_fmac_f32 v237, v41, v137
    v_fmac_f32 v235, v34, v106
    v_fmac_f32 v237, v42, v138
    v_fmac_f32 v235, v35, v107
    v_fmac_f32 v237, v43, v139
    v_fmac_f32 v235, v36, v108
    v_fmac_f32 v237, v44, v140
    v_fmac_f32 v235, v37, v109
    v_fmac_f32 v237, v45, v141
    v_fmac_f32 v235, v38, v110
    v_fmac_f32 v237, v46, v142
    v_fmac_f32 v235, v39, v111
    v_fmac_f32 v237, v47, v143
    v_mul_f32 v239, v48, v136
    v_mul_f32 v241, v56, v136
    s_setprio 1
    s_waitcnt vmcnt(6) lgkmcnt(0)
    v_mfma_f32_32x32x16_bf16 v[0:15], v[64:67], v[184:187], 0
    ds_read_b64_tr_b16 v[176:177], v246 offset:0
    ds_read_b64_tr_b16 v[178:179], v246 offset:512
    ds_read_b64_tr_b16 v[180:181], v247 offset:0
    ds_read_b64_tr_b16 v[182:183], v247 offset:512
    v_fmac_f32 v239, v49, v137
    v_fmac_f32 v241, v57, v137
    s_mov_b32 m0, s71
    v_mfma_f32_32x32x16_bf16 v[16:31], v[68:71], v[184:187], 0
    buffer_load_dwordx4 v224, s[4:7], s42 offen lds
    buffer_load_dwordx4 v225, s[72:75], s42 offen offset:1024 lds
    v_fmac_f32 v239, v50, v138
    v_fmac_f32 v241, v58, v138
    v_fmac_f32 v239, v51, v139
    v_fmac_f32 v241, v59, v139
    v_fmac_f32 v239, v52, v140
    v_mfma_f32_32x32x16_bf16 v[32:47], v[64:67], v[188:191], 0
    v_fmac_f32 v241, v60, v140
    v_fmac_f32 v239, v53, v141
    v_fmac_f32 v241, v61, v141
    v_fmac_f32 v239, v54, v142
    v_fmac_f32 v241, v62, v142
    v_fmac_f32 v239, v55, v143
    v_fmac_f32 v241, v63, v143
    v_mfma_f32_32x32x16_bf16 v[48:63], v[68:71], v[188:191], 0
    v_permlane32_swap_b32 v234, v235
    v_permlane32_swap_b32 v236, v237
    v_permlane32_swap_b32 v238, v239
    s_waitcnt vmcnt(6) lgkmcnt(0)
    v_mfma_f32_32x32x16_bf16 v[0:15], v[72:75], v[176:179], v[0:15]
    ds_read_b64_tr_b16 v[184:185], v246 offset:2048
    ds_read_b64_tr_b16 v[186:187], v246 offset:2560
    ds_read_b64_tr_b16 v[188:189], v247 offset:2048
    ds_read_b64_tr_b16 v[190:191], v247 offset:2560
    v_permlane32_swap_b32 v240, v241
    s_mov_b32 m0, s68
    v_mfma_f32_32x32x16_bf16 v[16:31], v[76:79], v[176:179], v[16:31]
    buffer_load_dwordx4 v226, s[4:7], s42 offen lds
    buffer_load_dwordx4 v227, s[72:75], s42 offen offset:1024 lds
    v_add_f32 v234, v234, v235
    v_add_f32 v236, v236, v237
    v_add_f32 v238, v238, v239
    v_add_f32 v240, v240, v241
    v_mfma_f32_32x32x16_bf16 v[32:47], v[72:75], v[180:183], v[32:47]
    s_set_gpr_idx_on s31, gpr_idx(DST)
    s_nop 0
    v_cvt_pk_bf16_f32 v192, v234, v236
    v_cvt_pk_bf16_f32 v193, v238, v240
    s_set_gpr_idx_off
    v_mfma_f32_32x32x16_bf16 v[48:63], v[76:79], v[180:183], v[48:63]
    s_waitcnt vmcnt(6) lgkmcnt(0)
    v_mfma_f32_32x32x16_bf16 v[0:15], v[80:83], v[184:187], v[0:15]
    ds_read_b64_tr_b16 v[176:177], v246 offset:4096
    ds_read_b64_tr_b16 v[178:179], v246 offset:4608
    ds_read_b64_tr_b16 v[180:181], v247 offset:4096
    ds_read_b64_tr_b16 v[182:183], v247 offset:4608
    s_mov_b32 m0, s69
    v_mfma_f32_32x32x16_bf16 v[16:31], v[84:87], v[184:187], v[16:31]
    buffer_load_dwordx4 v222, s[4:7], s43 offen lds
    buffer_load_dwordx4 v223, s[72:75], s43 offen offset:1024 lds
    v_mfma_f32_32x32x16_bf16 v[32:47], v[80:83], v[188:191], v[32:47]
    s_nop 2
    v_mul_f32 v234, v0, v144
    v_mul_f32 v236, v8, v112
    v_fmac_f32 v234, v1, v145
    v_fmac_f32 v236, v9, v113
    v_fmac_f32 v234, v2, v146
    v_fmac_f32 v236, v10, v114
    v_fmac_f32 v234, v3, v147
    v_mfma_f32_32x32x16_bf16 v[48:63], v[84:87], v[188:191], v[48:63]
    s_setprio 0
    v_fmac_f32 v236, v11, v115
    v_fmac_f32 v234, v4, v148
    v_fmac_f32 v236, v12, v116
    v_fmac_f32 v234, v5, v149
    v_fmac_f32 v236, v13, v117
    v_fmac_f32 v234, v6, v150
    v_fmac_f32 v236, v14, v118
    v_fmac_f32 v234, v7, v151
    v_fmac_f32 v236, v15, v119
    v_mul_f32 v238, v16, v160
    v_mul_f32 v240, v24, v160
    v_fmac_f32 v238, v17, v161
    v_fmac_f32 v240, v25, v161
    v_fmac_f32 v238, v18, v162
    v_fmac_f32 v240, v26, v162
    v_fmac_f32 v238, v19, v163
    v_fmac_f32 v240, v27, v163
    v_fmac_f32 v238, v20, v164
    v_fmac_f32 v240, v28, v164
    v_fmac_f32 v238, v21, v165
    v_fmac_f32 v240, v29, v165
    v_fmac_f32 v238, v22, v166
    v_fmac_f32 v240, v30, v166
    v_fmac_f32 v238, v23, v167
    v_fmac_f32 v240, v31, v167
    v_mul_f32 v235, v32, v152
    v_mul_f32 v237, v40, v120
    v_fmac_f32 v235, v33, v153
    v_fmac_f32 v237, v41, v121
    v_fmac_f32 v235, v34, v154
    v_fmac_f32 v237, v42, v122
    v_fmac_f32 v235, v35, v155
    v_fmac_f32 v237, v43, v123
    v_fmac_f32 v235, v36, v156
    v_fmac_f32 v237, v44, v124
    v_fmac_f32 v235, v37, v157
    v_fmac_f32 v237, v45, v125
    v_fmac_f32 v235, v38, v158
    v_fmac_f32 v237, v46, v126
    v_fmac_f32 v235, v39, v159
    v_fmac_f32 v237, v47, v127
    v_mul_f32 v239, v48, v168
    v_mul_f32 v241, v56, v168
    v_fmac_f32 v239, v49, v169
    v_fmac_f32 v241, v57, v169
    s_setprio 1
    s_waitcnt vmcnt(4) lgkmcnt(0)
    v_mfma_f32_32x32x16_bf16 v[0:15], v[64:67], v[176:179], 0
    ds_read_b64_tr_b16 v[184:185], v246 offset:6144
    ds_read_b64_tr_b16 v[186:187], v246 offset:6656
    ds_read_b64_tr_b16 v[188:189], v247 offset:6144
    ds_read_b64_tr_b16 v[190:191], v247 offset:6656
    v_fmac_f32 v239, v50, v170
    v_fmac_f32 v241, v58, v170
    s_mov_b32 m0, s70
    v_mfma_f32_32x32x16_bf16 v[16:31], v[68:71], v[176:179], 0
    buffer_load_dwordx4 v224, s[4:7], s43 offen lds
    buffer_load_dwordx4 v225, s[72:75], s43 offen offset:1024 lds
    v_fmac_f32 v239, v51, v171
    v_fmac_f32 v241, v59, v171
    v_fmac_f32 v239, v52, v172
    v_fmac_f32 v241, v60, v172
    v_fmac_f32 v239, v53, v173
    v_mfma_f32_32x32x16_bf16 v[32:47], v[64:67], v[180:183], 0
    v_add_u32 v222, s48, v251
    ds_read_b32 v222, v222
    v_fmac_f32 v241, v61, v173
    v_fmac_f32 v239, v54, v174
    v_fmac_f32 v241, v62, v174
    v_fmac_f32 v239, v55, v175
    v_fmac_f32 v241, v63, v175
    v_mfma_f32_32x32x16_bf16 v[48:63], v[68:71], v[180:183], 0
    v_permlane32_swap_b32 v234, v235
    v_add_f32 v234, v234, v235
    s_waitcnt vmcnt(4) lgkmcnt(1)
    v_mfma_f32_32x32x16_bf16 v[0:15], v[72:75], v[184:187], v[0:15]
    ds_read_b64_tr_b16 v[176:177], v246 offset:0
    ds_read_b64_tr_b16 v[178:179], v246 offset:512
    ds_read_b64_tr_b16 v[180:181], v247 offset:0
    ds_read_b64_tr_b16 v[182:183], v247 offset:512
    s_mov_b32 m0, s71
    v_mfma_f32_32x32x16_bf16 v[16:31], v[76:79], v[184:187], v[16:31]
    buffer_load_dwordx4 v226, s[4:7], s43 offen lds
    buffer_load_dwordx4 v227, s[72:75], s43 offen offset:1024 lds
    s_waitcnt lgkmcnt(4)
    v_mad_u32_u16 v223, v222, s39, v248 op_sel:[1,0,0,0]
    v_mad_u32_u16 v222, v222, s39, v248
    v_mfma_f32_32x32x16_bf16 v[32:47], v[72:75], v[188:191], v[32:47]
    v_add_u32 v224, s49, v251
    ds_read_b32 v224, v224
    v_mfma_f32_32x32x16_bf16 v[48:63], v[76:79], v[188:191], v[48:63]
    s_waitcnt vmcnt(4) lgkmcnt(1)
    v_mfma_f32_32x32x16_bf16 v[0:15], v[80:83], v[176:179], v[0:15]
    ds_read_b64_tr_b16 v[184:185], v246 offset:2048
    ds_read_b64_tr_b16 v[186:187], v246 offset:2560
    ds_read_b64_tr_b16 v[188:189], v247 offset:2048
    ds_read_b64_tr_b16 v[190:191], v247 offset:2560
    s_mov_b32 m0, s68
    v_mfma_f32_32x32x16_bf16 v[16:31], v[84:87], v[176:179], v[16:31]
    buffer_load_dwordx4 v222, s[4:7], s44 offen lds
    buffer_load_dwordx4 v223, s[72:75], s44 offen offset:1024 lds
    s_waitcnt lgkmcnt(4)
    v_mad_u32_u16 v225, v224, s39, v248 op_sel:[1,0,0,0]
    v_mad_u32_u16 v224, v224, s39, v248
    v_mfma_f32_32x32x16_bf16 v[32:47], v[80:83], v[180:183], v[32:47]
    v_add_u32 v226, s50, v251
    ds_read_b32 v226, v226
    v_mul_f32 v242, v0, v144
    v_fma_f32 v238, v8, v160, -v238
    v_fmac_f32 v242, v1, v145
    v_fmac_f32 v238, v9, v161
    v_fmac_f32 v242, v2, v146
    v_mfma_f32_32x32x16_bf16 v[48:63], v[84:87], v[180:183], v[48:63]
    s_setprio 0
    v_fmac_f32 v238, v10, v162
    v_fmac_f32 v242, v3, v147
    v_fmac_f32 v238, v11, v163
    v_fmac_f32 v242, v4, v148
    v_fmac_f32 v238, v12, v164
    v_fmac_f32 v242, v5, v149
    v_fmac_f32 v238, v13, v165
    v_fmac_f32 v242, v6, v150
    v_fmac_f32 v238, v14, v166
    v_fmac_f32 v242, v7, v151
    v_fmac_f32 v238, v15, v167
    v_fmac_f32 v236, v16, v112
    v_mul_f32 v244, v24, v160
    v_fmac_f32 v236, v17, v113
    v_fmac_f32 v244, v25, v161
    v_fmac_f32 v236, v18, v114
    v_fmac_f32 v244, v26, v162
    v_fmac_f32 v236, v19, v115
    v_fmac_f32 v244, v27, v163
    v_fmac_f32 v236, v20, v116
    v_fmac_f32 v244, v28, v164
    v_fmac_f32 v236, v21, v117
    v_fmac_f32 v244, v29, v165
    v_fmac_f32 v236, v22, v118
    v_fmac_f32 v244, v30, v166
    v_fmac_f32 v236, v23, v119
    v_fmac_f32 v244, v31, v167
    v_mul_f32 v243, v32, v152
    v_fma_f32 v239, v40, v168, -v239
    v_fmac_f32 v243, v33, v153
    v_fmac_f32 v239, v41, v169
    v_fmac_f32 v243, v34, v154
    v_fmac_f32 v239, v42, v170
    v_fmac_f32 v243, v35, v155
    v_fmac_f32 v239, v43, v171
    v_fmac_f32 v243, v36, v156
    v_fmac_f32 v239, v44, v172
    v_fmac_f32 v243, v37, v157
    v_fmac_f32 v239, v45, v173
    v_fmac_f32 v243, v38, v158
    v_fmac_f32 v239, v46, v174
    v_fmac_f32 v243, v39, v159
    v_fmac_f32 v239, v47, v175
    v_fmac_f32 v237, v48, v120
    v_mul_f32 v245, v56, v168
    v_fmac_f32 v237, v49, v121
    v_fmac_f32 v245, v57, v169
    v_fmac_f32 v237, v50, v122
    v_fmac_f32 v245, v58, v170
    v_fmac_f32 v237, v51, v123
    s_setprio 1
    s_waitcnt vmcnt(4) lgkmcnt(1)
    v_mfma_f32_32x32x16_bf16 v[0:15], v[64:67], v[184:187], 0
    ds_read_b64_tr_b16 v[176:177], v246 offset:4096
    ds_read_b64_tr_b16 v[178:179], v246 offset:4608
    ds_read_b64_tr_b16 v[180:181], v247 offset:4096
    ds_read_b64_tr_b16 v[182:183], v247 offset:4608
    v_fmac_f32 v245, v59, v171
    v_fmac_f32 v237, v52, v124
    s_mov_b32 m0, s69
    v_mfma_f32_32x32x16_bf16 v[16:31], v[68:71], v[184:187], 0
    buffer_load_dwordx4 v224, s[4:7], s45 offen lds
    buffer_load_dwordx4 v225, s[72:75], s45 offen offset:1024 lds
    s_waitcnt lgkmcnt(4)
    v_mad_u32_u16 v227, v226, s39, v248 op_sel:[1,0,0,0]
    v_mad_u32_u16 v226, v226, s39, v248
    v_fmac_f32 v245, v60, v172
    v_fmac_f32 v237, v53, v125
    v_mfma_f32_32x32x16_bf16 v[32:47], v[64:67], v[188:191], 0
    v_add_u32 v228, s51, v251
    ds_read_b32 v228, v228
    v_fmac_f32 v245, v61, v173
    v_fmac_f32 v237, v54, v126
    v_fmac_f32 v245, v62, v174
    v_fmac_f32 v237, v55, v127
    v_fmac_f32 v245, v63, v175
    v_mfma_f32_32x32x16_bf16 v[48:63], v[68:71], v[188:191], 0
    v_permlane32_swap_b32 v238, v239
    v_permlane32_swap_b32 v242, v243
    v_add_f32 v238, v238, v239
    v_add_f32 v242, v242, v243
    s_waitcnt vmcnt(4) lgkmcnt(1)
    v_mfma_f32_32x32x16_bf16 v[0:15], v[72:75], v[176:179], v[0:15]
    ds_read_b64_tr_b16 v[184:185], v246 offset:6144
    ds_read_b64_tr_b16 v[186:187], v246 offset:6656
    ds_read_b64_tr_b16 v[188:189], v247 offset:6144
    ds_read_b64_tr_b16 v[190:191], v247 offset:6656
    s_mov_b32 m0, s70
    v_mfma_f32_32x32x16_bf16 v[16:31], v[76:79], v[176:179], v[16:31]
    buffer_load_dwordx4 v226, s[4:7], s46 offen lds
    buffer_load_dwordx4 v227, s[72:75], s46 offen offset:1024 lds
    s_waitcnt lgkmcnt(4)
    v_mad_u32_u16 v229, v228, s39, v248 op_sel:[1,0,0,0]
    v_mad_u32_u16 v228, v228, s39, v248
    v_mfma_f32_32x32x16_bf16 v[32:47], v[72:75], v[180:183], v[32:47]
    s_set_gpr_idx_on s31, gpr_idx(DST)
    s_nop 0
    v_cvt_pk_bf16_f32 v194, v234, v242
    s_set_gpr_idx_off
    v_mfma_f32_32x32x16_bf16 v[48:63], v[76:79], v[180:183], v[48:63]
    s_waitcnt vmcnt(4) lgkmcnt(0)
    v_mfma_f32_32x32x16_bf16 v[0:15], v[80:83], v[184:187], v[0:15]
    ds_read_b64_tr_b16 v[176:177], v246 offset:0
    ds_read_b64_tr_b16 v[178:179], v246 offset:512
    ds_read_b64_tr_b16 v[180:181], v247 offset:0
    ds_read_b64_tr_b16 v[182:183], v247 offset:512
    s_mov_b32 m0, s71
    v_mfma_f32_32x32x16_bf16 v[16:31], v[84:87], v[184:187], v[16:31]
    buffer_load_dwordx4 v228, s[4:7], s47 offen lds
    buffer_load_dwordx4 v229, s[72:75], s47 offen offset:1024 lds
    v_mfma_f32_32x32x16_bf16 v[32:47], v[80:83], v[188:191], v[32:47]
    s_nop 2
    v_mul_f32 v242, v0, v144
    s_nop 1
    v_fma_f32 v240, v8, v160, -v240
    v_fmac_f32 v242, v1, v145
    v_fmac_f32 v240, v9, v161
    v_fmac_f32 v242, v2, v146
    v_fmac_f32 v240, v10, v162
    v_fmac_f32 v242, v3, v147
    v_mfma_f32_32x32x16_bf16 v[48:63], v[84:87], v[188:191], v[48:63]
    s_setprio 0
    v_fmac_f32 v240, v11, v163
    v_fmac_f32 v242, v4, v148
    v_fmac_f32 v240, v12, v164
    v_fmac_f32 v242, v5, v149
    v_fmac_f32 v240, v13, v165
    v_fmac_f32 v242, v6, v150
    v_fmac_f32 v240, v14, v166
    v_fmac_f32 v242, v7, v151
    v_fmac_f32 v240, v15, v167
    s_sub_u32 s58, s48, s29
    v_add_u32 v249, s58, v249
    v_add_u32 v250, s58, v250
    v_fma_f32 v244, v16, v160, -v244
    v_fmac_f32 v236, v24, v112
    v_fmac_f32 v244, v17, v161
    v_fmac_f32 v236, v25, v113
    v_fmac_f32 v244, v18, v162
    v_fmac_f32 v236, v26, v114
    v_fmac_f32 v244, v19, v163
    v_fmac_f32 v236, v27, v115
    v_fmac_f32 v244, v20, v164
    v_fmac_f32 v236, v28, v116
    v_fmac_f32 v244, v21, v165
    v_fmac_f32 v236, v29, v117
    v_fmac_f32 v244, v22, v166
    v_fmac_f32 v236, v30, v118
    v_fmac_f32 v244, v23, v167
    v_fmac_f32 v236, v31, v119
    ds_read_b64_tr_b16 v[0:1], v249 offset:0
    ds_read_b64_tr_b16 v[2:3], v249 offset:128
    ds_read_b128 v[4:7], v250 offset:0
    ds_read_b128 v[8:11], v250 offset:16
    ds_read_b128 v[12:15], v250 offset:384
    ds_read_b128 v[16:19], v250 offset:400
    v_mul_f32 v243, v32, v152
    v_fma_f32 v241, v40, v168, -v241
    v_fmac_f32 v243, v33, v153
    v_fmac_f32 v241, v41, v169
    v_fmac_f32 v243, v34, v154
    v_fmac_f32 v241, v42, v170
    v_fmac_f32 v243, v35, v155
    v_fmac_f32 v241, v43, v171
    v_fmac_f32 v243, v36, v156
    v_fmac_f32 v241, v44, v172
    v_fmac_f32 v243, v37, v157
    v_fmac_f32 v241, v45, v173
    v_fmac_f32 v243, v38, v158
    v_fmac_f32 v241, v46, v174
    v_fmac_f32 v243, v39, v159
    v_fmac_f32 v241, v47, v175
    ds_read_b64_tr_b16 v[20:21], v249 offset:512
    ds_read_b64_tr_b16 v[22:23], v249 offset:640
    ds_read_b128 v[24:27], v250 offset:64
    ds_read_b128 v[28:31], v250 offset:80
    ds_read_b128 v[32:35], v250 offset:448
    ds_read_b128 v[36:39], v250 offset:464
    v_fma_f32 v245, v48, v168, -v245
    v_fmac_f32 v237, v56, v120
    v_fmac_f32 v245, v49, v169
    v_fmac_f32 v237, v57, v121
    v_fmac_f32 v245, v50, v170
    v_fmac_f32 v237, v58, v122
    v_fmac_f32 v245, v51, v171
    v_fmac_f32 v237, v59, v123
    v_fmac_f32 v245, v52, v172
    v_fmac_f32 v237, v60, v124
    v_fmac_f32 v245, v53, v173
    v_fmac_f32 v237, v61, v125
    v_fmac_f32 v245, v54, v174
    v_fmac_f32 v237, v62, v126
    v_fmac_f32 v245, v55, v175
    v_fmac_f32 v237, v63, v127
    s_cmp_lg_u32 s34, 0
    s_cbranch_scc1 K2_SWITCH
    s_mov_b32 s29, s48
    s_mov_b32 s32, s31
    s_mov_b32 s30, s3
    s_mov_b32 s31, s35
    s_cmp_eq_u32 s33, 2
    s_cbranch_scc1 K2_U20
    s_cmp_eq_u32 s33, 3
    s_cbranch_scc1 K2_U30
    s_cmp_eq_u32 s33, 1
    s_cbranch_scc1 K2_U10
    s_branch K2_U40
K2_U21:
    s_setprio 1
    s_waitcnt lgkmcnt(10)
    v_lshlrev_b32 v40, 16, v0
    v_and_b32 v41, 0xffff0000, v0
    v_lshlrev_b32 v42, 16, v1
    v_and_b32 v43, 0xffff0000, v1
    v_lshlrev_b32 v44, 16, v2
    v_and_b32 v45, 0xffff0000, v2
    v_lshlrev_b32 v46, 16, v3
    v_and_b32 v47, 0xffff0000, v3
    s_waitcnt lgkmcnt(8)
    v_mul_f32 v4, v40, v4
    v_mul_f32 v5, v41, v5
    v_mul_f32 v6, v42, v6
    v_mul_f32 v7, v43, v7
    v_mul_f32 v8, v44, v8
    v_mul_f32 v9, v45, v9
    v_mul_f32 v10, v46, v10
    v_mul_f32 v11, v47, v11
    v_cvt_pk_bf16_f32 v64, v4, v5
    v_cvt_pk_bf16_f32 v65, v6, v7
    v_cvt_pk_bf16_f32 v66, v8, v9
    v_cvt_pk_bf16_f32 v67, v10, v11
    s_waitcnt lgkmcnt(6)
    v_mul_f32 v12, v40, v12
    v_mul_f32 v13, v41, v13
    v_mul_f32 v14, v42, v14
    v_mul_f32 v15, v43, v15
    v_mul_f32 v16, v44, v16
    v_mul_f32 v17, v45, v17
    v_mul_f32 v18, v46, v18
    v_mul_f32 v19, v47, v19
    v_cvt_pk_bf16_f32 v68, v12, v13
    v_cvt_pk_bf16_f32 v69, v14, v15
    v_cvt_pk_bf16_f32 v70, v16, v17
    v_cvt_pk_bf16_f32 v71, v18, v19
    s_waitcnt lgkmcnt(4)
    v_lshlrev_b32 v48, 16, v20
    v_and_b32 v49, 0xffff0000, v20
    v_lshlrev_b32 v50, 16, v21
    v_and_b32 v51, 0xffff0000, v21
    v_lshlrev_b32 v52, 16, v22
    v_and_b32 v53, 0xffff0000, v22
    v_lshlrev_b32 v54, 16, v23
    v_and_b32 v55, 0xffff0000, v23
    s_waitcnt lgkmcnt(2)
    v_mul_f32 v24, v48, v24
    v_mul_f32 v25, v49, v25
    v_mul_f32 v26, v50, v26
    v_mul_f32 v27, v51, v27
    v_mul_f32 v28, v52, v28
    v_mul_f32 v29, v53, v29
    v_mul_f32 v30, v54, v30
    v_mul_f32 v31, v55, v31
    v_cvt_pk_bf16_f32 v72, v24, v25
    v_cvt_pk_bf16_f32 v73, v26, v27
    v_cvt_pk_bf16_f32 v74, v28, v29
    v_cvt_pk_bf16_f32 v75, v30, v31
    s_waitcnt lgkmcnt(0)
    v_mul_f32 v32, v48, v32
    v_mul_f32 v33, v49, v33
    v_mul_f32 v34, v50, v34
    v_mul_f32 v35, v51, v35
    v_mul_f32 v36, v52, v36
    v_mul_f32 v37, v53, v37
    v_mul_f32 v38, v54, v38
    v_mul_f32 v39, v55, v39
    v_cvt_pk_bf16_f32 v76, v32, v33
    v_cvt_pk_bf16_f32 v77, v34, v35
    v_cvt_pk_bf16_f32 v78, v36, v37
    v_cvt_pk_bf16_f32 v79, v38, v39
    s_waitcnt vmcnt(4)
    v_mfma_f32_32x32x16_bf16 v[0:15], v[64:67], v[176:179], 0
    ds_read_b64_tr_b16 v[184:185], v246 offset:2048
    ds_read_b64_tr_b16 v[186:187], v246 offset:2560
    ds_read_b64_tr_b16 v[188:189], v247 offset:2048
    ds_read_b64_tr_b16 v[190:191], v247 offset:2560
    s_mov_b32 m0, s68
    v_mfma_f32_32x32x16_bf16 v[16:31], v[68:71], v[176:179], 0
    buffer_load_dwordx4 v222, s[4:7], s42 offen lds
    buffer_load_dwordx4 v223, s[72:75], s42 offen offset:1024 lds
    v_permlane32_swap_b32 v242, v243
    v_permlane32_swap_b32 v240, v241
    v_mov_b32 v254, 163648
    v_mfma_f32_32x32x16_bf16 v[32:47], v[64:67], v[180:183], 0
    v_permlane32_swap_b32 v236, v237
    v_permlane32_swap_b32 v244, v245
    v_add_f32 v242, v242, v243
    v_add_f32 v240, -v240, -v241
    v_add_f32 v236, v236, v237
    v_mfma_f32_32x32x16_bf16 v[48:63], v[68:71], v[180:183], 0
    v_add_f32 v244, v244, v245
    v_cvt_pk_bf16_f32 v242, v242, v236
    v_cvt_pk_bf16_f32 v244, v244, v240
    v_cvt_pk_bf16_f32 v238, v238, v238
    ds_write_b16 v230, v242 offset:1152
    ds_write_b16_d16_hi v230, v242 offset:128
    v_mov_b32 v255, 1
    v_lshl_add_u32 v233, v252, 1, s53
    s_mov_b64 exec, 1
    ds_add_rtn_u32 v232, v254, v255
    s_mov_b64 exec, -1
    ds_read_b32 v233, v233
    s_waitcnt vmcnt(4) lgkmcnt(4)
    v_mfma_f32_32x32x16_bf16 v[0:15], v[72:75], v[184:187], v[0:15]
    ds_read_b64_tr_b16 v[176:177], v246 offset:4096
    ds_read_b64_tr_b16 v[178:179], v246 offset:4608
    ds_read_b64_tr_b16 v[180:181], v247 offset:4096
    ds_read_b64_tr_b16 v[182:183], v247 offset:4608
    ds_write_b16 v230, v244 offset:512
    ds_write_b16_d16_hi v230, v244 offset:896
    s_mov_b32 m0, s69
    v_mfma_f32_32x32x16_bf16 v[16:31], v[76:79], v[184:187], v[16:31]
    buffer_load_dwordx4 v224, s[4:7], s42 offen lds
    buffer_load_dwordx4 v225, s[72:75], s42 offen offset:1024 lds
    ds_write_b16 v230, v238 offset:1280
    s_waitcnt lgkmcnt(7)
    v_readfirstlane_b32 s58, v232
    v_mfma_f32_32x32x16_bf16 v[32:47], v[72:75], v[188:191], v[32:47]
    s_cmp_lt_u32 s58, s22
    s_cbranch_scc0 K2_nul_54
    s_and_b32 s59, s58, 7
    s_lshr_b32 s60, s58, 3
K2_chk_56:
    v_readlane_b32 s61, v233, s59
    s_nop 0
    s_cmp_gt_u32 s61, s60
    s_cbranch_scc0 K2_spin_55
K2_back_57:
    v_mfma_f32_32x32x16_bf16 v[48:63], v[76:79], v[188:191], v[48:63]
    s_setprio 0
    v_readlane_b32 s3, v253, s58
    s_lshl_b32 s44, s34, 7
    s_lshl_b32 s60, s58, 5
    s_and_b32 s48, s3, 0x3ffff
    s_bfe_u32 s33, s3, 0x30012
    s_sub_u32 s60, s60, s48
    v_mul_f32 v234, v0, v96
    v_mul_f32 v236, v8, v128
    v_fmac_f32 v234, v1, v97
    v_fmac_f32 v236, v9, v129
    v_fmac_f32 v234, v2, v98
    v_fmac_f32 v236, v10, v130
    v_fmac_f32 v234, v3, v99
    v_fmac_f32 v236, v11, v131
    v_fmac_f32 v234, v4, v100
    v_fmac_f32 v236, v12, v132
    v_fmac_f32 v234, v5, v101
    v_fmac_f32 v236, v13, v133
    v_fmac_f32 v234, v6, v102
    v_fmac_f32 v236, v14, v134
    v_fmac_f32 v234, v7, v103
    v_fmac_f32 v236, v15, v135
    v_mul_f32 v238, v16, v128
    v_mul_f32 v240, v24, v128
    v_fmac_f32 v238, v17, v129
    v_fmac_f32 v240, v25, v129
    v_fmac_f32 v238, v18, v130
    v_fmac_f32 v240, v26, v130
    v_fmac_f32 v238, v19, v131
    v_fmac_f32 v240, v27, v131
    v_fmac_f32 v238, v20, v132
    v_fmac_f32 v240, v28, v132
    v_fmac_f32 v238, v21, v133
    v_fmac_f32 v240, v29, v133
    v_fmac_f32 v238, v22, v134
    v_fmac_f32 v240, v30, v134
    v_fmac_f32 v238, v23, v135
    v_fmac_f32 v240, v31, v135
    v_mul_f32 v235, v32, v104
    v_mul_f32 v237, v40, v136
    v_fmac_f32 v235, v33, v105
    v_fmac_f32 v237, v41, v137
    v_fmac_f32 v235, v34, v106
    v_fmac_f32 v237, v42, v138
    v_fmac_f32 v235, v35, v107
    v_fmac_f32 v237, v43, v139
    v_fmac_f32 v235, v36, v108
    v_fmac_f32 v237, v44, v140
    v_fmac_f32 v235, v37, v109
    v_fmac_f32 v237, v45, v141
    v_fmac_f32 v235, v38, v110
    v_fmac_f32 v237, v46, v142
    v_fmac_f32 v235, v39, v111
    v_fmac_f32 v237, v47, v143
    v_mul_f32 v239, v48, v136
    v_mul_f32 v241, v56, v136
    v_fmac_f32 v239, v49, v137
    v_fmac_f32 v241, v57, v137
    s_setprio 1
    s_waitcnt vmcnt(4) lgkmcnt(3)
    v_mfma_f32_32x32x16_bf16 v[0:15], v[64:67], v[176:179], 0
    ds_read_b64_tr_b16 v[184:185], v246 offset:6144
    ds_read_b64_tr_b16 v[186:187], v246 offset:6656
    ds_read_b64_tr_b16 v[188:189], v247 offset:6144
    ds_read_b64_tr_b16 v[190:191], v247 offset:6656
    v_fmac_f32 v239, v50, v138
    v_fmac_f32 v241, v58, v138
    s_mov_b32 m0, s70
    v_mfma_f32_32x32x16_bf16 v[16:31], v[68:71], v[176:179], 0
    buffer_load_dwordx4 v222, s[4:7], s43 offen lds
    buffer_load_dwordx4 v223, s[72:75], s43 offen offset:1024 lds
    v_fmac_f32 v239, v51, v139
    v_fmac_f32 v241, v59, v139
    v_fmac_f32 v239, v52, v140
    v_fmac_f32 v241, v60, v140
    v_fmac_f32 v239, v53, v141
    v_mfma_f32_32x32x16_bf16 v[32:47], v[64:67], v[180:183], 0
    s_and_b32 s60, s60, 0xff
    s_add_u32 s35, s60, s48
    s_mov_b32 s45, s44
    s_add_u32 s47, s44, 256
    s_add_u32 s49, s48, 32
    s_add_u32 s60, s48, 64
    s_cmp_eq_u32 s33, 3
    s_cselect_b32 s46, s44, s47
    s_cselect_b32 s50, s60, s48
    s_cselect_b32 s51, s48, s49
    s_sub_u32 s60, s33, 2
    s_cmp_lt_u32 s60, 2
    s_cbranch_scc0 K2_rare_58
K2_back_59:
    v_add_u32 v222, s48, v251
    ds_read_b32 v222, v222
    v_fmac_f32 v241, v61, v141
    v_fmac_f32 v239, v54, v142
    v_fmac_f32 v241, v62, v142
    v_fmac_f32 v239, v55, v143
    v_fmac_f32 v241, v63, v143
    v_mfma_f32_32x32x16_bf16 v[48:63], v[68:71], v[180:183], 0
    v_permlane32_swap_b32 v234, v235
    v_permlane32_swap_b32 v236, v237
    v_permlane32_swap_b32 v238, v239
    s_waitcnt vmcnt(4) lgkmcnt(1)
    v_mfma_f32_32x32x16_bf16 v[0:15], v[72:75], v[184:187], v[0:15]
    ds_read_b64_tr_b16 v[176:177], v246 offset:0
    ds_read_b64_tr_b16 v[178:179], v246 offset:512
    ds_read_b64_tr_b16 v[180:181], v247 offset:0
    ds_read_b64_tr_b16 v[182:183], v247 offset:512
    v_permlane32_swap_b32 v240, v241
    s_mov_b32 m0, s71
    v_mfma_f32_32x32x16_bf16 v[16:31], v[76:79], v[184:187], v[16:31]
    buffer_load_dwordx4 v224, s[4:7], s43 offen lds
    buffer_load_dwordx4 v225, s[72:75], s43 offen offset:1024 lds
    s_waitcnt lgkmcnt(4)
    v_mad_u32_u16 v223, v222, s39, v248 op_sel:[1,0,0,0]
    v_mad_u32_u16 v222, v222, s39, v248
    v_add_u32 v230, s31, v252
    v_add_f32 v234, v234, v235
    v_add_f32 v236, v236, v237
    v_add_f32 v238, v238, v239
    v_add_f32 v240, v240, v241
    v_cvt_pk_bf16_f32 v234, v234, v236
    v_cvt_pk_bf16_f32 v238, v238, v240
    ds_write_b16 v230, v234 offset:0
    ds_write_b16_d16_hi v230, v234 offset:256
    ds_write_b16 v230, v238 offset:640
    ds_write_b16_d16_hi v230, v238 offset:1024
    v_mfma_f32_32x32x16_bf16 v[32:47], v[72:75], v[188:191], v[32:47]
    v_add_u32 v224, s49, v251
    ds_read_b32 v224, v224
    v_mul_f32 v234, v0, v144
    v_mul_f32 v236, v8, v112
    v_fmac_f32 v234, v1, v145
    v_fmac_f32 v236, v9, v113
    v_fmac_f32 v234, v2, v146
    v_mfma_f32_32x32x16_bf16 v[48:63], v[76:79], v[188:191], v[48:63]
    s_setprio 0
    v_fmac_f32 v236, v10, v114
    v_fmac_f32 v234, v3, v147
    v_fmac_f32 v236, v11, v115
    v_fmac_f32 v234, v4, v148
    v_fmac_f32 v236, v12, v116
    v_fmac_f32 v234, v5, v149
    v_fmac_f32 v236, v13, v117
    v_fmac_f32 v234, v6, v150
    v_fmac_f32 v236, v14, v118
    v_fmac_f32 v234, v7, v151
    v_fmac_f32 v236, v15, v119
    v_mul_f32 v238, v16, v160
    v_mul_f32 v240, v24, v160
    v_fmac_f32 v238, v17, v161
    v_fmac_f32 v240, v25, v161
    v_fmac_f32 v238, v18, v162
    v_fmac_f32 v240, v26, v162
    v_fmac_f32 v238, v19, v163
    v_fmac_f32 v240, v27, v163
    v_fmac_f32 v238, v20, v164
    v_fmac_f32 v240, v28, v164
    v_fmac_f32 v238, v21, v165
    v_fmac_f32 v240, v29, v165
    v_fmac_f32 v238, v22, v166
    v_fmac_f32 v240, v30, v166
    v_fmac_f32 v238, v23, v167
    v_fmac_f32 v240, v31, v167
    v_mul_f32 v235, v32, v152
    v_mul_f32 v237, v40, v120
    v_fmac_f32 v235, v33, v153
    v_fmac_f32 v237, v41, v121
    v_fmac_f32 v235, v34, v154
    v_fmac_f32 v237, v42, v122
    v_fmac_f32 v235, v35, v155
    v_fmac_f32 v237, v43, v123
    v_fmac_f32 v235, v36, v156
    v_fmac_f32 v237, v44, v124
    v_fmac_f32 v235, v37, v157
    v_fmac_f32 v237, v45, v125
    v_fmac_f32 v235, v38, v158
    v_fmac_f32 v237, v46, v126
    v_fmac_f32 v235, v39, v159
    v_fmac_f32 v237, v47, v127
    v_mul_f32 v239, v48, v168
    v_mul_f32 v241, v56, v168
    v_fmac_f32 v239, v49, v169
    v_fmac_f32 v241, v57, v169
    v_fmac_f32 v239, v50, v170
    v_fmac_f32 v241, v58, v170
    v_fmac_f32 v239, v51, v171
    s_setprio 1
    s_waitcnt vmcnt(4) lgkmcnt(5)
    v_mfma_f32_32x32x16_bf16 v[0:15], v[64:67], v[176:179], 0
    ds_read_b64_tr_b16 v[184:185], v246 offset:2048
    ds_read_b64_tr_b16 v[186:187], v246 offset:2560
    ds_read_b64_tr_b16 v[188:189], v247 offset:2048
    ds_read_b64_tr_b16 v[190:191], v247 offset:2560
    v_fmac_f32 v241, v59, v171
    v_fmac_f32 v239, v52, v172
    s_mov_b32 m0, s68
    v_mfma_f32_32x32x16_bf16 v[16:31], v[68:71], v[176:179], 0
    buffer_load_dwordx4 v222, s[4:7], s44 offen lds
    buffer_load_dwordx4 v223, s[72:75], s44 offen offset:1024 lds
    s_waitcnt lgkmcnt(4)
    v_mad_u32_u16 v225, v224, s39, v248 op_sel:[1,0,0,0]
    v_mad_u32_u16 v224, v224, s39, v248
    v_fmac_f32 v241, v60, v172
    v_fmac_f32 v239, v53, v173
    v_mfma_f32_32x32x16_bf16 v[32:47], v[64:67], v[180:183], 0
    v_add_u32 v226, s50, v251
    ds_read_b32 v226, v226
    v_fmac_f32 v241, v61, v173
    v_fmac_f32 v239, v54, v174
    v_fmac_f32 v241, v62, v174
    v_fmac_f32 v239, v55, v175
    v_fmac_f32 v241, v63, v175
    v_mfma_f32_32x32x16_bf16 v[48:63], v[68:71], v[180:183], 0
    v_permlane32_swap_b32 v234, v235
    v_add_f32 v234, v234, v235
    s_waitcnt vmcnt(4) lgkmcnt(1)
    v_mfma_f32_32x32x16_bf16 v[0:15], v[72:75], v[184:187], v[0:15]
    ds_read_b64_tr_b16 v[176:177], v246 offset:4096
    ds_read_b64_tr_b16 v[178:179], v246 offset:4608
    ds_read_b64_tr_b16 v[180:181], v247 offset:4096
    ds_read_b64_tr_b16 v[182:183], v247 offset:4608
    s_mov_b32 m0, s69
    v_mfma_f32_32x32x16_bf16 v[16:31], v[76:79], v[184:187], v[16:31]
    buffer_load_dwordx4 v224, s[4:7], s45 offen lds
    buffer_load_dwordx4 v225, s[72:75], s45 offen offset:1024 lds
    s_waitcnt lgkmcnt(4)
    v_mad_u32_u16 v227, v226, s39, v248 op_sel:[1,0,0,0]
    v_mad_u32_u16 v226, v226, s39, v248
    v_mfma_f32_32x32x16_bf16 v[32:47], v[72:75], v[188:191], v[32:47]
    v_add_u32 v228, s51, v251
    ds_read_b32 v228, v228
    v_mul_f32 v242, v0, v144
    v_fma_f32 v238, v8, v160, -v238
    v_fmac_f32 v242, v1, v145
    v_fmac_f32 v238, v9, v161
    v_fmac_f32 v242, v2, v146
    v_mfma_f32_32x32x16_bf16 v[48:63], v[76:79], v[188:191], v[48:63]
    s_setprio 0
    v_fmac_f32 v238, v10, v162
    v_fmac_f32 v242, v3, v147
    v_fmac_f32 v238, v11, v163
    v_fmac_f32 v242, v4, v148
    v_fmac_f32 v238, v12, v164
    v_fmac_f32 v242, v5, v149
    v_fmac_f32 v238, v13, v165
    v_fmac_f32 v242, v6, v150
    v_fmac_f32 v238, v14, v166
    v_fmac_f32 v242, v7, v151
    v_fmac_f32 v238, v15, v167
    v_fmac_f32 v236, v16, v112
    v_mul_f32 v244, v24, v160
    v_fmac_f32 v236, v17, v113
    v_fmac_f32 v244, v25, v161
    v_fmac_f32 v236, v18, v114
    v_fmac_f32 v244, v26, v162
    v_fmac_f32 v236, v19, v115
    v_fmac_f32 v244, v27, v163
    v_fmac_f32 v236, v20, v116
    v_fmac_f32 v244, v28, v164
    v_fmac_f32 v236, v21, v117
    v_fmac_f32 v244, v29, v165
    v_fmac_f32 v236, v22, v118
    v_fmac_f32 v244, v30, v166
    v_fmac_f32 v236, v23, v119
    v_fmac_f32 v244, v31, v167
    v_mul_f32 v243, v32, v152
    v_fma_f32 v239, v40, v168, -v239
    v_fmac_f32 v243, v33, v153
    v_fmac_f32 v239, v41, v169
    v_fmac_f32 v243, v34, v154
    v_fmac_f32 v239, v42, v170
    v_fmac_f32 v243, v35, v155
    v_fmac_f32 v239, v43, v171
    v_fmac_f32 v243, v36, v156
    v_fmac_f32 v239, v44, v172
    v_fmac_f32 v243, v37, v157
    v_fmac_f32 v239, v45, v173
    v_fmac_f32 v243, v38, v158
    v_fmac_f32 v239, v46, v174
    v_fmac_f32 v243, v39, v159
    v_fmac_f32 v239, v47, v175
    v_fmac_f32 v237, v48, v120
    v_mul_f32 v245, v56, v168
    v_fmac_f32 v237, v49, v121
    v_fmac_f32 v245, v57, v169
    v_fmac_f32 v237, v50, v122
    s_setprio 1
    s_waitcnt vmcnt(4) lgkmcnt(1)
    v_mfma_f32_32x32x16_bf16 v[0:15], v[64:67], v[176:179], 0
    ds_read_b64_tr_b16 v[184:185], v246 offset:6144
    ds_read_b64_tr_b16 v[186:187], v246 offset:6656
    ds_read_b64_tr_b16 v[188:189], v247 offset:6144
    ds_read_b64_tr_b16 v[190:191], v247 offset:6656
    v_fmac_f32 v245, v58, v170
    v_fmac_f32 v237, v51, v123
    s_mov_b32 m0, s70
    v_mfma_f32_32x32x16_bf16 v[16:31], v[68:71], v[176:179], 0
    buffer_load_dwordx4 v226, s[4:7], s46 offen lds
    buffer_load_dwordx4 v227, s[72:75], s46 offen offset:1024 lds
    s_waitcnt lgkmcnt(4)
    v_mad_u32_u16 v229, v228, s39, v248 op_sel:[1,0,0,0]
    v_mad_u32_u16 v228, v228, s39, v248
    v_fmac_f32 v245, v59, v171
    v_fmac_f32 v237, v52, v124
    v_mfma_f32_32x32x16_bf16 v[32:47], v[64:67], v[180:183], 0
    v_fmac_f32 v245, v60, v172
    v_fmac_f32 v237, v53, v125
    v_fmac_f32 v245, v61, v173
    v_fmac_f32 v237, v54, v126
    v_fmac_f32 v245, v62, v174
    v_fmac_f32 v237, v55, v127
    v_fmac_f32 v245, v63, v175
    v_mfma_f32_32x32x16_bf16 v[48:63], v[68:71], v[180:183], 0
    v_permlane32_swap_b32 v238, v239
    v_permlane32_swap_b32 v242, v243
    v_add_f32 v238, v238, v239
    v_add_f32 v242, v242, v243
    s_waitcnt vmcnt(4) lgkmcnt(0)
    v_mfma_f32_32x32x16_bf16 v[0:15], v[72:75], v[184:187], v[0:15]
    ds_read_b64_tr_b16 v[176:177], v246 offset:0
    ds_read_b64_tr_b16 v[178:179], v246 offset:512
    ds_read_b64_tr_b16 v[180:181], v247 offset:0
    ds_read_b64_tr_b16 v[182:183], v247 offset:512
    v_cvt_pk_bf16_f32 v234, v234, v242
    ds_write_b16 v230, v234 offset:384
    s_mov_b32 m0, s71
    v_mfma_f32_32x32x16_bf16 v[16:31], v[76:79], v[184:187], v[16:31]
    buffer_load_dwordx4 v228, s[4:7], s47 offen lds
    buffer_load_dwordx4 v229, s[72:75], s47 offen offset:1024 lds
    ds_write_b16_d16_hi v230, v234 offset:768
    v_mfma_f32_32x32x16_bf16 v[32:47], v[72:75], v[188:191], v[32:47]
    v_mul_f32 v242, v0, v144
    v_fma_f32 v240, v8, v160, -v240
    v_fmac_f32 v242, v1, v145
    v_fmac_f32 v240, v9, v161
    v_fmac_f32 v242, v2, v146
    v_fmac_f32 v240, v10, v162
    v_fmac_f32 v242, v3, v147
    v_mfma_f32_32x32x16_bf16 v[48:63], v[76:79], v[188:191], v[48:63]
    s_setprio 0
    v_fmac_f32 v240, v11, v163
    v_fmac_f32 v242, v4, v148
    v_fmac_f32 v240, v12, v164
    v_fmac_f32 v242, v5, v149
    v_fmac_f32 v240, v13, v165
    v_fmac_f32 v242, v6, v150
    v_fmac_f32 v240, v14, v166
    v_fmac_f32 v242, v7, v151
    v_fmac_f32 v240, v15, v167
    s_sub_u32 s58, s48, s29
    v_add_u32 v249, s58, v249
    v_add_u32 v250, s58, v250
    v_fma_f32 v244, v16, v160, -v244
    v_fmac_f32 v236, v24, v112
    v_fmac_f32 v244, v17, v161
    v_fmac_f32 v236, v25, v113
    v_fmac_f32 v244, v18, v162
    v_fmac_f32 v236, v26, v114
    v_fmac_f32 v244, v19, v163
    v_fmac_f32 v236, v27, v115
    v_fmac_f32 v244, v20, v164
    v_fmac_f32 v236, v28, v116
    v_fmac_f32 v244, v21, v165
    v_fmac_f32 v236, v29, v117
    v_fmac_f32 v244, v22, v166
    v_fmac_f32 v236, v30, v118
    v_fmac_f32 v244, v23, v167
    v_fmac_f32 v236, v31, v119
    ds_read_b64_tr_b16 v[0:1], v249 offset:0
    ds_read_b64_tr_b16 v[2:3], v249 offset:128
    ds_read_b128 v[4:7], v250 offset:0
    ds_read_b128 v[8:11], v250 offset:16
    ds_read_b128 v[12:15], v250 offset:384
    ds_read_b128 v[16:19], v250 offset:400
    v_mul_f32 v243, v32, v152
    v_fma_f32 v241, v40, v168, -v241
    v_fmac_f32 v243, v33, v153
    v_fmac_f32 v241, v41, v169
    v_fmac_f32 v243, v34, v154
    v_fmac_f32 v241, v42, v170
    v_fmac_f32 v243, v35, v155
    v_fmac_f32 v241, v43, v171
    v_fmac_f32 v243, v36, v156
    v_fmac_f32 v241, v44, v172
    v_fmac_f32 v243, v37, v157
    v_fmac_f32 v241, v45, v173
    v_fmac_f32 v243, v38, v158
    v_fmac_f32 v241, v46, v174
    v_fmac_f32 v243, v39, v159
    v_fmac_f32 v241, v47, v175
    ds_read_b64_tr_b16 v[20:21], v249 offset:512
    ds_read_b64_tr_b16 v[22:23], v249 offset:640
    ds_read_b128 v[24:27], v250 offset:64
    ds_read_b128 v[28:31], v250 offset:80
    ds_read_b128 v[32:35], v250 offset:448
    ds_read_b128 v[36:39], v250 offset:464
    v_fma_f32 v245, v48, v168, -v245
    v_fmac_f32 v237, v56, v120
    v_fmac_f32 v245, v49, v169
    v_fmac_f32 v237, v57, v121
    v_fmac_f32 v245, v50, v170
    v_fmac_f32 v237, v58, v122
    v_fmac_f32 v245, v51, v171
    v_fmac_f32 v237, v59, v123
    v_fmac_f32 v245, v52, v172
    v_fmac_f32 v237, v60, v124
    v_fmac_f32 v245, v53, v173
    v_fmac_f32 v237, v61, v125
    v_fmac_f32 v245, v54, v174
    v_fmac_f32 v237, v62, v126
    v_fmac_f32 v245, v55, v175
    v_fmac_f32 v237, v63, v127
    s_cmp_eq_u32 s36, 0
    s_cbranch_scc1 K2_TAIL
    s_mov_b32 s29, s48
    s_mov_b32 s32, s31
    s_mov_b32 s30, s3
    s_mov_b32 s31, s35
    s_cmp_eq_u32 s33, 2
    s_cbranch_scc1 K2_U21
    s_cmp_eq_u32 s33, 3
    s_cbranch_scc1 K2_U31
    s_cmp_eq_u32 s33, 1
    s_cbranch_scc1 K2_U11
    s_branch K2_U41
K2_U31:
    s_setprio 1
    s_waitcnt lgkmcnt(10)
    v_lshlrev_b32 v40, 16, v0
    v_and_b32 v41, 0xffff0000, v0
    v_lshlrev_b32 v42, 16, v1
    v_and_b32 v43, 0xffff0000, v1
    v_lshlrev_b32 v44, 16, v2
    v_and_b32 v45, 0xffff0000, v2
    v_lshlrev_b32 v46, 16, v3
    v_and_b32 v47, 0xffff0000, v3
    s_waitcnt lgkmcnt(8)
    v_mul_f32 v4, v40, v4
    v_mul_f32 v5, v41, v5
    v_mul_f32 v6, v42, v6
    v_mul_f32 v7, v43, v7
    v_mul_f32 v8, v44, v8
    v_mul_f32 v9, v45, v9
    v_mul_f32 v10, v46, v10
    v_mul_f32 v11, v47, v11
    v_cvt_pk_bf16_f32 v64, v4, v5
    v_cvt_pk_bf16_f32 v65, v6, v7
    v_cvt_pk_bf16_f32 v66, v8, v9
    v_cvt_pk_bf16_f32 v67, v10, v11
    s_waitcnt lgkmcnt(6)
    v_mul_f32 v12, v40, v12
    v_mul_f32 v13, v41, v13
    v_mul_f32 v14, v42, v14
    v_mul_f32 v15, v43, v15
    v_mul_f32 v16, v44, v16
    v_mul_f32 v17, v45, v17
    v_mul_f32 v18, v46, v18
    v_mul_f32 v19, v47, v19
    v_cvt_pk_bf16_f32 v68, v12, v13
    v_cvt_pk_bf16_f32 v69, v14, v15
    v_cvt_pk_bf16_f32 v70, v16, v17
    v_cvt_pk_bf16_f32 v71, v18, v19
    ds_read_b64_tr_b16 v[0:1], v249 offset:1024
    ds_read_b64_tr_b16 v[2:3], v249 offset:1152
    ds_read_b128 v[4:7], v250 offset:128
    ds_read_b128 v[8:11], v250 offset:144
    ds_read_b128 v[12:15], v250 offset:512
    ds_read_b128 v[16:19], v250 offset:528
    s_waitcnt lgkmcnt(10)
    v_lshlrev_b32 v48, 16, v20
    v_and_b32 v49, 0xffff0000, v20
    v_lshlrev_b32 v50, 16, v21
    v_and_b32 v51, 0xffff0000, v21
    v_lshlrev_b32 v52, 16, v22
    v_and_b32 v53, 0xffff0000, v22
    v_lshlrev_b32 v54, 16, v23
    v_and_b32 v55, 0xffff0000, v23
    s_waitcnt lgkmcnt(8)
    v_mul_f32 v24, v48, v24
    v_mul_f32 v25, v49, v25
    v_mul_f32 v26, v50, v26
    v_mul_f32 v27, v51, v27
    v_mul_f32 v28, v52, v28
    v_mul_f32 v29, v53, v29
    v_mul_f32 v30, v54, v30
    v_mul_f32 v31, v55, v31
    v_cvt_pk_bf16_f32 v72, v24, v25
    v_cvt_pk_bf16_f32 v73, v26, v27
    v_cvt_pk_bf16_f32 v74, v28, v29
    v_cvt_pk_bf16_f32 v75, v30, v31
    s_waitcnt lgkmcnt(6)
    v_mul_f32 v32, v48, v32
    v_mul_f32 v33, v49, v33
    v_mul_f32 v34, v50, v34
    v_mul_f32 v35, v51, v35
    v_mul_f32 v36, v52, v36
    v_mul_f32 v37, v53, v37
    v_mul_f32 v38, v54, v38
    v_mul_f32 v39, v55, v39
    v_cvt_pk_bf16_f32 v76, v32, v33
    v_cvt_pk_bf16_f32 v77, v34, v35
    v_cvt_pk_bf16_f32 v78, v36, v37
    v_cvt_pk_bf16_f32 v79, v38, v39
    s_waitcnt lgkmcnt(4)
    v_lshlrev_b32 v40, 16, v0
    v_and_b32 v41, 0xffff0000, v0
    v_lshlrev_b32 v42, 16, v1
    v_and_b32 v43, 0xffff0000, v1
    v_lshlrev_b32 v44, 16, v2
    v_and_b32 v45, 0xffff0000, v2
    v_lshlrev_b32 v46, 16, v3
    v_and_b32 v47, 0xffff0000, v3
    s_waitcnt lgkmcnt(2)
    v_mul_f32 v4, v40, v4
    v_mul_f32 v5, v41, v5
    v_mul_f32 v6, v42, v6
    v_mul_f32 v7, v43, v7
    v_mul_f32 v8, v44, v8
    v_mul_f32 v9, v45, v9
    v_mul_f32 v10, v46, v10
    v_mul_f32 v11, v47, v11
    v_cvt_pk_bf16_f32 v80, v4, v5
    v_cvt_pk_bf16_f32 v81, v6, v7
    v_cvt_pk_bf16_f32 v82, v8, v9
    v_cvt_pk_bf16_f32 v83, v10, v11
    s_waitcnt lgkmcnt(0)
    v_mul_f32 v12, v40, v12
    v_mul_f32 v13, v41, v13
    v_mul_f32 v14, v42, v14
    v_mul_f32 v15, v43, v15
    v_mul_f32 v16, v44, v16
    v_mul_f32 v17, v45, v17
    v_mul_f32 v18, v46, v18
    v_mul_f32 v19, v47, v19
    v_cvt_pk_bf16_f32 v84, v12, v13
    v_cvt_pk_bf16_f32 v85, v14, v15
    v_cvt_pk_bf16_f32 v86, v16, v17
    v_cvt_pk_bf16_f32 v87, v18, v19
    s_waitcnt vmcnt(4)
    v_mfma_f32_32x32x16_bf16 v[0:15], v[64:67], v[176:179], 0
    ds_read_b64_tr_b16 v[184:185], v246 offset:2048
    ds_read_b64_tr_b16 v[186:187], v246 offset:2560
    ds_read_b64_tr_b16 v[188:189], v247 offset:2048
    ds_read_b64_tr_b16 v[190:191], v247 offset:2560
    s_mov_b32 m0, s68
    v_mfma_f32_32x32x16_bf16 v[16:31], v[68:71], v[176:179], 0
    buffer_load_dwordx4 v224, s[4:7], s41 offen lds
    buffer_load_dwordx4 v225, s[72:75], s41 offen offset:1024 lds
    v_permlane32_swap_b32 v242, v243
    v_permlane32_swap_b32 v240, v241
    v_mov_b32 v254, 163648
    v_mfma_f32_32x32x16_bf16 v[32:47], v[64:67], v[180:183], 0
    v_permlane32_swap_b32 v236, v237
    v_permlane32_swap_b32 v244, v245
    v_add_f32 v242, v242, v243
    v_add_f32 v240, -v240, -v241
    v_add_f32 v236, v236, v237
    v_mfma_f32_32x32x16_bf16 v[48:63], v[68:71], v[180:183], 0
    v_add_f32 v244, v244, v245
    v_cvt_pk_bf16_f32 v242, v242, v236
    v_cvt_pk_bf16_f32 v244, v244, v240
    v_cvt_pk_bf16_f32 v238, v238, v238
    ds_write_b16 v230, v242 offset:1152
    ds_write_b16_d16_hi v230, v242 offset:128
    v_mov_b32 v255, 1
    v_lshl_add_u32 v233, v252, 1, s53
    s_mov_b64 exec, 1
    ds_add_rtn_u32 v232, v254, v255
    s_mov_b64 exec, -1
    ds_read_b32 v233, v233
    s_waitcnt vmcnt(4) lgkmcnt(4)
    v_mfma_f32_32x32x16_bf16 v[0:15], v[72:75], v[184:187], v[0:15]
    ds_read_b64_tr_b16 v[176:177], v246 offset:4096
    ds_read_b64_tr_b16 v[178:179], v246 offset:4608
    ds_read_b64_tr_b16 v[180:181], v247 offset:4096
    ds_read_b64_tr_b16 v[182:183], v247 offset:4608
    ds_write_b16 v230, v244 offset:512
    ds_write_b16_d16_hi v230, v244 offset:896
    s_mov_b32 m0, s69
    v_mfma_f32_32x32x16_bf16 v[16:31], v[76:79], v[184:187], v[16:31]
    buffer_load_dwordx4 v226, s[4:7], s41 offen lds
    buffer_load_dwordx4 v227, s[72:75], s41 offen offset:1024 lds
    ds_write_b16 v230, v238 offset:1280
    s_waitcnt lgkmcnt(7)
    v_readfirstlane_b32 s58, v232
    v_mfma_f32_32x32x16_bf16 v[32:47], v[72:75], v[188:191], v[32:47]
    s_cmp_lt_u32 s58, s22
    s_cbranch_scc0 K2_nul_61
    s_and_b32 s59, s58, 7
    s_lshr_b32 s60, s58, 3
K2_chk_63:
    v_readlane_b32 s61, v233, s59
    s_nop 0
    s_cmp_gt_u32 s61, s60
    s_cbranch_scc0 K2_spin_62
K2_back_64:
    v_mfma_f32_32x32x16_bf16 v[48:63], v[76:79], v[188:191], v[48:63]
    v_readlane_b32 s3, v253, s58
    s_lshl_b32 s44, s34, 7
    s_lshl_b32 s60, s58, 5
    s_and_b32 s48, s3, 0x3ffff
    s_bfe_u32 s33, s3, 0x30012
    s_sub_u32 s60, s60, s48
    s_waitcnt vmcnt(4) lgkmcnt(3)
    v_mfma_f32_32x32x16_bf16 v[0:15], v[80:83], v[176:179], v[0:15]
    ds_read_b64_tr_b16 v[184:185], v246 offset:6144
    ds_read_b64_tr_b16 v[186:187], v246 offset:6656
    ds_read_b64_tr_b16 v[188:189], v247 offset:6144
    ds_read_b64_tr_b16 v[190:191], v247 offset:6656
    s_and_b32 s60, s60, 0xff
    s_add_u32 s35, s60, s48
    s_mov_b32 m0, s70
    v_mfma_f32_32x32x16_bf16 v[16:31], v[84:87], v[176:179], v[16:31]
    buffer_load_dwordx4 v222, s[4:7], s42 offen lds
    buffer_load_dwordx4 v223, s[72:75], s42 offen offset:1024 lds
    s_mov_b32 s45, s44
    s_add_u32 s47, s44, 256
    s_add_u32 s49, s48, 32
    s_add_u32 s60, s48, 64
    v_mfma_f32_32x32x16_bf16 v[32:47], v[80:83], v[180:183], v[32:47]
    s_cmp_eq_u32 s33, 3
    s_cselect_b32 s46, s44, s47
    s_cselect_b32 s50, s60, s48
    s_cselect_b32 s51, s48, s49
    s_sub_u32 s60, s33, 2
    s_cmp_lt_u32 s60, 2
    s_cbranch_scc0 K2_rare_65
K2_back_66:
    v_mfma_f32_32x32x16_bf16 v[48:63], v[84:87], v[180:183], v[48:63]
    s_setprio 0
    v_mul_f32 v234, v0, v96
    v_mul_f32 v236, v8, v128
    v_fmac_f32 v234, v1, v97
    v_fmac_f32 v236, v9, v129
    v_fmac_f32 v234, v2, v98
    v_fmac_f32 v236, v10, v130
    v_fmac_f32 v234, v3, v99
    v_fmac_f32 v236, v11, v131
    v_fmac_f32 v234, v4, v100
    v_fmac_f32 v236, v12, v132
    v_fmac_f32 v234, v5, v101
    v_fmac_f32 v236, v13, v133
    v_fmac_f32 v234, v6, v102
    v_fmac_f32 v236, v14, v134
    v_fmac_f32 v234, v7, v103
    v_fmac_f32 v236, v15, v135
    v_mul_f32 v238, v16, v128
    v_mul_f32 v240, v24, v128
    v_fmac_f32 v238, v17, v129
    v_fmac_f32 v240, v25, v129
    v_fmac_f32 v238, v18, v130
    v_fmac_f32 v240, v26, v130
    v_fmac_f32 v238, v19, v131
    v_fmac_f32 v240, v27, v131
    v_fmac_f32 v238, v20, v132
    v_fmac_f32 v240, v28, v132
    v_fmac_f32 v238, v21, v133
    v_fmac_f32 v240, v29, v133
    v_fmac_f32 v238, v22, v134
    v_fmac_f32 v240, v30, v134
    v_fmac_f32 v238, v23, v135
    v_fmac_f32 v240, v31, v135
    v_mul_f32 v235, v32, v104
    v_mul_f32 v237, v40, v136
    v_fmac_f32 v235, v33, v105
    v_fmac_f32 v237, v41, v137
    v_fmac_f32 v235, v34, v106
    v_fmac_f32 v237, v42, v138
    v_fmac_f32 v235, v35, v107
    v_fmac_f32 v237, v43, v139
    v_fmac_f32 v235, v36, v108
    v_fmac_f32 v237, v44, v140
    v_fmac_f32 v235, v37, v109
    v_fmac_f32 v237, v45, v141
    v_fmac_f32 v235, v38, v110
    v_fmac_f32 v237, v46, v142
    v_fmac_f32 v235, v39, v111
    v_fmac_f32 v237, v47, v143
    v_mul_f32 v239, v48, v136
    v_mul_f32 v241, v56, v136
    s_setprio 1
    s_waitcnt vmcnt(4) lgkmcnt(0)
    v_mfma_f32_32x32x16_bf16 v[0:15], v[64:67], v[184:187], 0
    ds_read_b64_tr_b16 v[176:177], v246 offset:0
    ds_read_b64_tr_b16 v[178:179], v246 offset:512
    ds_read_b64_tr_b16 v[180:181], v247 offset:0
    ds_read_b64_tr_b16 v[182:183], v247 offset:512
    v_fmac_f32 v239, v49, v137
    v_fmac_f32 v241, v57, v137
    s_mov_b32 m0, s71
    v_mfma_f32_32x32x16_bf16 v[16:31], v[68:71], v[184:187], 0
    buffer_load_dwordx4 v224, s[4:7], s42 offen lds
    buffer_load_dwordx4 v225, s[72:75], s42 offen offset:1024 lds
    v_fmac_f32 v239, v50, v138
    v_fmac_f32 v241, v58, v138
    v_fmac_f32 v239, v51, v139
    v_fmac_f32 v241, v59, v139
    v_fmac_f32 v239, v52, v140
    v_mfma_f32_32x32x16_bf16 v[32:47], v[64:67], v[188:191], 0
    v_fmac_f32 v241, v60, v140
    v_fmac_f32 v239, v53, v141
    v_fmac_f32 v241, v61, v141
    v_fmac_f32 v239, v54, v142
    v_fmac_f32 v241, v62, v142
    v_fmac_f32 v239, v55, v143
    v_fmac_f32 v241, v63, v143
    v_mfma_f32_32x32x16_bf16 v[48:63], v[68:71], v[188:191], 0
    v_permlane32_swap_b32 v234, v235
    v_permlane32_swap_b32 v236, v237
    v_permlane32_swap_b32 v238, v239
    s_waitcnt vmcnt(4) lgkmcnt(0)
    v_mfma_f32_32x32x16_bf16 v[0:15], v[72:75], v[176:179], v[0:15]
    ds_read_b64_tr_b16 v[184:185], v246 offset:2048
    ds_read_b64_tr_b16 v[186:187], v246 offset:2560
    ds_read_b64_tr_b16 v[188:189], v247 offset:2048
    ds_read_b64_tr_b16 v[190:191], v247 offset:2560
    v_permlane32_swap_b32 v240, v241
    s_mov_b32 m0, s68
    v_mfma_f32_32x32x16_bf16 v[16:31], v[76:79], v[176:179], v[16:31]
    buffer_load_dwordx4 v226, s[4:7], s42 offen lds
    buffer_load_dwordx4 v227, s[72:75], s42 offen offset:1024 lds
    v_add_u32 v230, s31, v252
    v_add_f32 v234, v234, v235
    v_add_f32 v236, v236, v237
    v_add_f32 v238, v238, v239
    v_add_f32 v240, v240, v241
    v_mfma_f32_32x32x16_bf16 v[32:47], v[72:75], v[180:183], v[32:47]
    v_cvt_pk_bf16_f32 v234, v234, v236
    v_cvt_pk_bf16_f32 v238, v238, v240
    ds_write_b16 v230, v234 offset:0
    ds_write_b16_d16_hi v230, v234 offset:256
    ds_write_b16 v230, v238 offset:640
    ds_write_b16_d16_hi v230, v238 offset:1024
    v_mfma_f32_32x32x16_bf16 v[48:63], v[76:79], v[180:183], v[48:63]
    s_waitcnt vmcnt(4) lgkmcnt(4)
    v_mfma_f32_32x32x16_bf16 v[0:15], v[80:83], v[184:187], v[0:15]
    ds_read_b64_tr_b16 v[176:177], v246 offset:4096
    ds_read_b64_tr_b16 v[178:179], v246 offset:4608
    ds_read_b64_tr_b16 v[180:181], v247 offset:4096
    ds_read_b64_tr_b16 v[182:183], v247 offset:4608
    s_mov_b32 m0, s69
    v_mfma_f32_32x32x16_bf16 v[16:31], v[84:87], v[184:187], v[16:31]
    buffer_load_dwordx4 v222, s[4:7], s43 offen lds
    buffer_load_dwordx4 v223, s[72:75], s43 offen offset:1024 lds
    v_mfma_f32_32x32x16_bf16 v[32:47], v[80:83], v[188:191], v[32:47]
    s_nop 2
    v_mul_f32 v234, v0, v144
    v_mul_f32 v236, v8, v112
    v_fmac_f32 v234, v1, v145
    v_fmac_f32 v236, v9, v113
    v_fmac_f32 v234, v2, v146
    v_fmac_f32 v236, v10, v114
    v_fmac_f32 v234, v3, v147
    v_mfma_f32_32x32x16_bf16 v[48:63], v[84:87], v[188:191], v[48:63]
    s_setprio 0
    v_fmac_f32 v236, v11, v115
    v_fmac_f32 v234, v4, v148
    v_fmac_f32 v236, v12, v116
    v_fmac_f32 v234, v5, v149
    v_fmac_f32 v236, v13, v117
    v_fmac_f32 v234, v6, v150
    v_fmac_f32 v236, v14, v118
    v_fmac_f32 v234, v7, v151
    v_fmac_f32 v236, v15, v119
    v_mul_f32 v238, v16, v160
    v_mul_f32 v240, v24, v160
    v_fmac_f32 v238, v17, v161
    v_fmac_f32 v240, v25, v161
    v_fmac_f32 v238, v18, v162
    v_fmac_f32 v240, v26, v162
    v_fmac_f32 v238, v19, v163
    v_fmac_f32 v240, v27, v163
    v_fmac_f32 v238, v20, v164
    v_fmac_f32 v240, v28, v164
    v_fmac_f32 v238, v21, v165
    v_fmac_f32 v240, v29, v165
    v_fmac_f32 v238, v22, v166
    v_fmac_f32 v240, v30, v166
    v_fmac_f32 v238, v23, v167
    v_fmac_f32 v240, v31, v167
    v_mul_f32 v235, v32, v152
    v_mul_f32 v237, v40, v120
    v_fmac_f32 v235, v33, v153
    v_fmac_f32 v237, v41, v121
    v_fmac_f32 v235, v34, v154
    v_fmac_f32 v237, v42, v122
    v_fmac_f32 v235, v35, v155
    v_fmac_f32 v237, v43, v123
    v_fmac_f32 v235, v36, v156
    v_fmac_f32 v237, v44, v124
    v_fmac_f32 v235, v37, v157
    v_fmac_f32 v237, v45, v125
    v_fmac_f32 v235, v38, v158
    v_fmac_f32 v237, v46, v126
    v_fmac_f32 v235, v39, v159
    v_fmac_f32 v237, v47, v127
    v_mul_f32 v239, v48, v168
    v_mul_f32 v241, v56, v168
    v_fmac_f32 v239, v49, v169
    v_fmac_f32 v241, v57, v169
    s_setprio 1
    s_waitcnt vmcnt(4) lgkmcnt(0)
    v_mfma_f32_32x32x16_bf16 v[0:15], v[64:67], v[176:179], 0
    ds_read_b64_tr_b16 v[184:185], v246 offset:6144
    ds_read_b64_tr_b16 v[186:187], v246 offset:6656
    ds_read_b64_tr_b16 v[188:189], v247 offset:6144
    ds_read_b64_tr_b16 v[190:191], v247 offset:6656
    v_fmac_f32 v239, v50, v170
    v_fmac_f32 v241, v58, v170
    s_mov_b32 m0, s70
    v_mfma_f32_32x32x16_bf16 v[16:31], v[68:71], v[176:179], 0
    buffer_load_dwordx4 v224, s[4:7], s43 offen lds
    buffer_load_dwordx4 v225, s[72:75], s43 offen offset:1024 lds
    v_fmac_f32 v239, v51, v171
    v_fmac_f32 v241, v59, v171
    v_fmac_f32 v239, v52, v172
    v_fmac_f32 v241, v60, v172
    v_fmac_f32 v239, v53, v173
    v_mfma_f32_32x32x16_bf16 v[32:47], v[64:67], v[180:183], 0
    v_add_u32 v222, s48, v251
    ds_read_b32 v222, v222
    v_fmac_f32 v241, v61, v173
    v_fmac_f32 v239, v54, v174
    v_fmac_f32 v241, v62, v174
    v_fmac_f32 v239, v55, v175
    v_fmac_f32 v241, v63, v175
    v_mfma_f32_32x32x16_bf16 v[48:63], v[68:71], v[180:183], 0
    v_permlane32_swap_b32 v234, v235
    v_add_f32 v234, v234, v235
    s_waitcnt vmcnt(4) lgkmcnt(1)
    v_mfma_f32_32x32x16_bf16 v[0:15], v[72:75], v[184:187], v[0:15]
    ds_read_b64_tr_b16 v[176:177], v246 offset:0
    ds_read_b64_tr_b16 v[178:179], v246 offset:512
    ds_read_b64_tr_b16 v[180:181], v247 offset:0
    ds_read_b64_tr_b16 v[182:183], v247 offset:512
    s_mov_b32 m0, s71
    v_mfma_f32_32x32x16_bf16 v[16:31], v[76:79], v[184:187], v[16:31]
    buffer_load_dwordx4 v226, s[4:7], s43 offen lds
    buffer_load_dwordx4 v227, s[72:75], s43 offen offset:1024 lds
    s_waitcnt lgkmcnt(4)
    v_mad_u32_u16 v223, v222, s39, v248 op_sel:[1,0,0,0]
    v_mad_u32_u16 v222, v222, s39, v248
    v_mfma_f32_32x32x16_bf16 v[32:47], v[72:75], v[188:191], v[32:47]
    v_add_u32 v224, s49, v251
    ds_read_b32 v224, v224
    v_mfma_f32_32x32x16_bf16 v[48:63], v[76:79], v[188:191], v[48:63]
    s_waitcnt vmcnt(4) lgkmcnt(1)
    v_mfma_f32_32x32x16_bf16 v[0:15], v[80:83], v[176:179], v[0:15]
    ds_read_b64_tr_b16 v[184:185], v246 offset:2048
    ds_read_b64_tr_b16 v[186:187], v246 offset:2560
    ds_read_b64_tr_b16 v[188:189], v247 offset:2048
    ds_read_b64_tr_b16 v[190:191], v247 offset:2560
    s_mov_b32 m0, s68
    v_mfma_f32_32x32x16_bf16 v[16:31], v[84:87], v[176:179], v[16:31]
    buffer_load_dwordx4 v222, s[4:7], s44 offen lds
    buffer_load_dwordx4 v223, s[72:75], s44 offen offset:1024 lds
    s_waitcnt lgkmcnt(4)
    v_mad_u32_u16 v225, v224, s39, v248 op_sel:[1,0,0,0]
    v_mad_u32_u16 v224, v224, s39, v248
    v_mfma_f32_32x32x16_bf16 v[32:47], v[80:83], v[180:183], v[32:47]
    v_add_u32 v226, s50, v251
    ds_read_b32 v226, v226
    v_mul_f32 v242, v0, v144
    v_fma_f32 v238, v8, v160, -v238
    v_fmac_f32 v242, v1, v145
    v_fmac_f32 v238, v9, v161
    v_fmac_f32 v242, v2, v146
    v_mfma_f32_32x32x16_bf16 v[48:63], v[84:87], v[180:183], v[48:63]
    s_setprio 0
    v_fmac_f32 v238, v10, v162
    v_fmac_f32 v242, v3, v147
    v_fmac_f32 v238, v11, v163
    v_fmac_f32 v242, v4, v148
    v_fmac_f32 v238, v12, v164
    v_fmac_f32 v242, v5, v149
    v_fmac_f32 v238, v13, v165
    v_fmac_f32 v242, v6, v150
    v_fmac_f32 v238, v14, v166
    v_fmac_f32 v242, v7, v151
    v_fmac_f32 v238, v15, v167
    v_fmac_f32 v236, v16, v112
    v_mul_f32 v244, v24, v160
    v_fmac_f32 v236, v17, v113
    v_fmac_f32 v244, v25, v161
    v_fmac_f32 v236, v18, v114
    v_fmac_f32 v244, v26, v162
    v_fmac_f32 v236, v19, v115
    v_fmac_f32 v244, v27, v163
    v_fmac_f32 v236, v20, v116
    v_fmac_f32 v244, v28, v164
    v_fmac_f32 v236, v21, v117
    v_fmac_f32 v244, v29, v165
    v_fmac_f32 v236, v22, v118
    v_fmac_f32 v244, v30, v166
    v_fmac_f32 v236, v23, v119
    v_fmac_f32 v244, v31, v167
    v_mul_f32 v243, v32, v152
    v_fma_f32 v239, v40, v168, -v239
    v_fmac_f32 v243, v33, v153
    v_fmac_f32 v239, v41, v169
    v_fmac_f32 v243, v34, v154
    v_fmac_f32 v239, v42, v170
    v_fmac_f32 v243, v35, v155
    v_fmac_f32 v239, v43, v171
    v_fmac_f32 v243, v36, v156
    v_fmac_f32 v239, v44, v172
    v_fmac_f32 v243, v37, v157
    v_fmac_f32 v239, v45, v173
    v_fmac_f32 v243, v38, v158
    v_fmac_f32 v239, v46, v174
    v_fmac_f32 v243, v39, v159
    v_fmac_f32 v239, v47, v175
    v_fmac_f32 v237, v48, v120
    v_mul_f32 v245, v56, v168
    v_fmac_f32 v237, v49, v121
    v_fmac_f32 v245, v57, v169
    v_fmac_f32 v237, v50, v122
    v_fmac_f32 v245, v58, v170
    v_fmac_f32 v237, v51, v123
    s_setprio 1
    s_waitcnt vmcnt(4) lgkmcnt(1)
    v_mfma_f32_32x32x16_bf16 v[0:15], v[64:67], v[184:187], 0
    ds_read_b64_tr_b16 v[176:177], v246 offset:4096
    ds_read_b64_tr_b16 v[178:179], v246 offset:4608
    ds_read_b64_tr_b16 v[180:181], v247 offset:4096
    ds_read_b64_tr_b16 v[182:183], v247 offset:4608
    v_fmac_f32 v245, v59, v171
    v_fmac_f32 v237, v52, v124
    s_mov_b32 m0, s69
    v_mfma_f32_32x32x16_bf16 v[16:31], v[68:71], v[184:187], 0
    buffer_load_dwordx4 v224, s[4:7], s45 offen lds
    buffer_load_dwordx4 v225, s[72:75], s45 offen offset:1024 lds
    s_waitcnt lgkmcnt(4)
    v_mad_u32_u16 v227, v226, s39, v248 op_sel:[1,0,0,0]
    v_mad_u32_u16 v226, v226, s39, v248
    v_fmac_f32 v245, v60, v172
    v_fmac_f32 v237, v53, v125
    v_mfma_f32_32x32x16_bf16 v[32:47], v[64:67], v[188:191], 0
    v_add_u32 v228, s51, v251
    ds_read_b32 v228, v228
    v_fmac_f32 v245, v61, v173
    v_fmac_f32 v237, v54, v126
    v_fmac_f32 v245, v62, v174
    v_fmac_f32 v237, v55, v127
    v_fmac_f32 v245, v63, v175
    v_mfma_f32_32x32x16_bf16 v[48:63], v[68:71], v[188:191], 0
    v_permlane32_swap_b32 v238, v239
    v_permlane32_swap_b32 v242, v243
    v_add_f32 v238, v238, v239
    v_add_f32 v242, v242, v243
    s_waitcnt vmcnt(4) lgkmcnt(1)
    v_mfma_f32_32x32x16_bf16 v[0:15], v[72:75], v[176:179], v[0:15]
    ds_read_b64_tr_b16 v[184:185], v246 offset:6144
    ds_read_b64_tr_b16 v[186:187], v246 offset:6656
    ds_read_b64_tr_b16 v[188:189], v247 offset:6144
    ds_read_b64_tr_b16 v[190:191], v247 offset:6656
    v_cvt_pk_bf16_f32 v234, v234, v242
    ds_write_b16 v230, v234 offset:384
    s_mov_b32 m0, s70
    v_mfma_f32_32x32x16_bf16 v[16:31], v[76:79], v[176:179], v[16:31]
    buffer_load_dwordx4 v226, s[4:7], s46 offen lds
    buffer_load_dwordx4 v227, s[72:75], s46 offen offset:1024 lds
    s_waitcnt lgkmcnt(5)
    v_mad_u32_u16 v229, v228, s39, v248 op_sel:[1,0,0,0]
    v_mad_u32_u16 v228, v228, s39, v248
    ds_write_b16_d16_hi v230, v234 offset:768
    v_mfma_f32_32x32x16_bf16 v[32:47], v[72:75], v[180:183], v[32:47]
    v_mfma_f32_32x32x16_bf16 v[48:63], v[76:79], v[180:183], v[48:63]
    s_waitcnt vmcnt(4) lgkmcnt(2)
    v_mfma_f32_32x32x16_bf16 v[0:15], v[80:83], v[184:187], v[0:15]
    ds_read_b64_tr_b16 v[176:177], v246 offset:0
    ds_read_b64_tr_b16 v[178:179], v246 offset:512
    ds_read_b64_tr_b16 v[180:181], v247 offset:0
    ds_read_b64_tr_b16 v[182:183], v247 offset:512
    s_mov_b32 m0, s71
    v_mfma_f32_32x32x16_bf16 v[16:31], v[84:87], v[184:187], v[16:31]
    buffer_load_dwordx4 v228, s[4:7], s47 offen lds
    buffer_load_dwordx4 v229, s[72:75], s47 offen offset:1024 lds
    v_mfma_f32_32x32x16_bf16 v[32:47], v[80:83], v[188:191], v[32:47]
    s_nop 2
    v_mul_f32 v242, v0, v144
    v_fma_f32 v240, v8, v160, -v240
    v_fmac_f32 v242, v1, v145
    v_fmac_f32 v240, v9, v161
    v_fmac_f32 v242, v2, v146
    v_fmac_f32 v240, v10, v162
    v_fmac_f32 v242, v3, v147
    v_mfma_f32_32x32x16_bf16 v[48:63], v[84:87], v[188:191], v[48:63]
    s_setprio 0
    v_fmac_f32 v240, v11, v163
    v_fmac_f32 v242, v4, v148
    v_fmac_f32 v240, v12, v164
    v_fmac_f32 v242, v5, v149
    v_fmac_f32 v240, v13, v165
    v_fmac_f32 v242, v6, v150
    v_fmac_f32 v240, v14, v166
    v_fmac_f32 v242, v7, v151
    v_fmac_f32 v240, v15, v167
    s_sub_u32 s58, s48, s29
    v_add_u32 v249, s58, v249
    v_add_u32 v250, s58, v250
    v_fma_f32 v244, v16, v160, -v244
    v_fmac_f32 v236, v24, v112
    v_fmac_f32 v244, v17, v161
    v_fmac_f32 v236, v25, v113
    v_fmac_f32 v244, v18, v162
    v_fmac_f32 v236, v26, v114
    v_fmac_f32 v244, v19, v163
    v_fmac_f32 v236, v27, v115
    v_fmac_f32 v244, v20, v164
    v_fmac_f32 v236, v28, v116
    v_fmac_f32 v244, v21, v165
    v_fmac_f32 v236, v29, v117
    v_fmac_f32 v244, v22, v166
    v_fmac_f32 v236, v30, v118
    v_fmac_f32 v244, v23, v167
    v_fmac_f32 v236, v31, v119
    ds_read_b64_tr_b16 v[0:1], v249 offset:0
    ds_read_b64_tr_b16 v[2:3], v249 offset:128
    ds_read_b128 v[4:7], v250 offset:0
    ds_read_b128 v[8:11], v250 offset:16
    ds_read_b128 v[12:15], v250 offset:384
    ds_read_b128 v[16:19], v250 offset:400
    v_mul_f32 v243, v32, v152
    v_fma_f32 v241, v40, v168, -v241
    v_fmac_f32 v243, v33, v153
    v_fmac_f32 v241, v41, v169
    v_fmac_f32 v243, v34, v154
    v_fmac_f32 v241, v42, v170
    v_fmac_f32 v243, v35, v155
    v_fmac_f32 v241, v43, v171
    v_fmac_f32 v243, v36, v156
    v_fmac_f32 v241, v44, v172
    v_fmac_f32 v243, v37, v157
    v_fmac_f32 v241, v45, v173
    v_fmac_f32 v243, v38, v158
    v_fmac_f32 v241, v46, v174
    v_fmac_f32 v243, v39, v159
    v_fmac_f32 v241, v47, v175
    ds_read_b64_tr_b16 v[20:21], v249 offset:512
    ds_read_b64_tr_b16 v[22:23], v249 offset:640
    ds_read_b128 v[24:27], v250 offset:64
    ds_read_b128 v[28:31], v250 offset:80
    ds_read_b128 v[32:35], v250 offset:448
    ds_read_b128 v[36:39], v250 offset:464
    v_fma_f32 v245, v48, v168, -v245
    v_fmac_f32 v237, v56, v120
    v_fmac_f32 v245, v49, v169
    v_fmac_f32 v237, v57, v121
    v_fmac_f32 v245, v50, v170
    v_fmac_f32 v237, v58, v122
    v_fmac_f32 v245, v51, v171
    v_fmac_f32 v237, v59, v123
    v_fmac_f32 v245, v52, v172
    v_fmac_f32 v237, v60, v124
    v_fmac_f32 v245, v53, v173
    v_fmac_f32 v237, v61, v125
    v_fmac_f32 v245, v54, v174
    v_fmac_f32 v237, v62, v126
    v_fmac_f32 v245, v55, v175
    v_fmac_f32 v237, v63, v127
    s_cmp_eq_u32 s36, 0
    s_cbranch_scc1 K2_TAIL
    s_mov_b32 s29, s48
    s_mov_b32 s32, s31
    s_mov_b32 s30, s3
    s_mov_b32 s31, s35
    s_cmp_eq_u32 s33, 2
    s_cbranch_scc1 K2_U21
    s_cmp_eq_u32 s33, 3
    s_cbranch_scc1 K2_U31
    s_cmp_eq_u32 s33, 1
    s_cbranch_scc1 K2_U11
    s_branch K2_U41
K2_U10:
    s_setprio 1
    s_add_u32 s38, s38, 1
    v_mov_b32 v254, s52
    v_mov_b32 v255, s38
    s_lshl_b32 s58, s38, 3
    s_add_u32 s58, s58, s20
    s_mov_b64 exec, 1
    ds_write_b32 v254, v255
    s_mov_b64 exec, -1
    s_cmp_lt_u32 s58, s22
    s_cbranch_scc0 K2_dyn_68
K2_back_69:
    s_waitcnt lgkmcnt(11)
    v_lshlrev_b32 v40, 16, v0
    v_and_b32 v41, 0xffff0000, v0
    v_lshlrev_b32 v42, 16, v1
    v_and_b32 v43, 0xffff0000, v1
    v_lshlrev_b32 v44, 16, v2
    v_and_b32 v45, 0xffff0000, v2
    v_lshlrev_b32 v46, 16, v3
    v_and_b32 v47, 0xffff0000, v3
    s_waitcnt lgkmcnt(9)
    v_mul_f32 v4, v40, v4
    v_mul_f32 v5, v41, v5
    v_mul_f32 v6, v42, v6
    v_mul_f32 v7, v43, v7
    v_mul_f32 v8, v44, v8
    v_mul_f32 v9, v45, v9
    v_mul_f32 v10, v46, v10
    v_mul_f32 v11, v47, v11
    v_cvt_pk_bf16_f32 v64, v4, v5
    v_cvt_pk_bf16_f32 v65, v6, v7
    v_cvt_pk_bf16_f32 v66, v8, v9
    v_cvt_pk_bf16_f32 v67, v10, v11
    s_waitcnt lgkmcnt(7)
    v_mul_f32 v12, v40, v12
    v_mul_f32 v13, v41, v13
    v_mul_f32 v14, v42, v14
    v_mul_f32 v15, v43, v15
    v_mul_f32 v16, v44, v16
    v_mul_f32 v17, v45, v17
    v_mul_f32 v18, v46, v18
    v_mul_f32 v19, v47, v19
    v_cvt_pk_bf16_f32 v68, v12, v13
    v_cvt_pk_bf16_f32 v69, v14, v15
    v_cvt_pk_bf16_f32 v70, v16, v17
    v_cvt_pk_bf16_f32 v71, v18, v19
    v_readlane_b32 s3, v253, s58
    s_lshl_b32 s44, s34, 7
    s_lshl_b32 s60, s58, 5
    s_and_b32 s48, s3, 0x3ffff
    s_bfe_u32 s33, s3, 0x30012
    s_sub_u32 s60, s60, s48
    s_and_b32 s60, s60, 0xff
    s_add_u32 s60, s60, s48
    s_mul_i32 s35, s38, 6
    s_cmp_eq_u32 s34, 0
    s_cselect_b32 s35, s35, s60
    s_mov_b32 s45, s44
    s_add_u32 s47, s44, 256
    s_add_u32 s49, s48, 32
    s_add_u32 s60, s48, 64
    s_cmp_eq_u32 s33, 3
    s_cselect_b32 s46, s44, s47
    s_cselect_b32 s50, s60, s48
    s_cselect_b32 s51, s48, s49
    s_sub_u32 s60, s33, 2
    s_cmp_lt_u32 s60, 2
    s_cbranch_scc0 K2_rare_74
K2_back_75:
    v_add_u32 v233, s48, v230
    ds_read_b32 v232, v233
    ds_read_b32 v233, v233 offset:1024
    v_add_u32 v222, s48, v251
    ds_read_b32 v222, v222
    v_add_u32 v224, s49, v251
    ds_read_b32 v224, v224
    v_add_u32 v226, s50, v251
    ds_read_b32 v226, v226
    v_add_u32 v228, s51, v251
    ds_read_b32 v228, v228
    s_waitcnt lgkmcnt(4)
    v_or_b32 v232, v232, v231
    v_or_b32 v233, v233, v231
    s_cmp_lg_u32 s34, 0
    s_cbranch_scc1 K2_dum_77
    s_add_u32 m0, s48, 864
    s_add_u32 s65, s48, 1888
    buffer_load_dwordx4 v232, s[16:19], 0 offen  lds
    s_mov_b32 m0, s65
    s_mov_b32 exec_hi, 0
    buffer_load_dwordx4 v233, s[16:19], 0 offen  lds
    s_cmp_eq_u32 s33, 4
    s_cbranch_scc1 K2_a4_78
K2_b4_80:
    s_mov_b32 exec_hi, -1
K2_back_79:
    s_waitcnt lgkmcnt(3)
    v_mad_u32_u16 v223, v222, s39, v248 op_sel:[1,0,0,0]
    v_mad_u32_u16 v222, v222, s39, v248
    s_waitcnt lgkmcnt(2)
    v_mad_u32_u16 v225, v224, s39, v248 op_sel:[1,0,0,0]
    v_mad_u32_u16 v224, v224, s39, v248
    s_waitcnt lgkmcnt(1)
    v_mad_u32_u16 v227, v226, s39, v248 op_sel:[1,0,0,0]
    v_mad_u32_u16 v226, v226, s39, v248
    s_waitcnt lgkmcnt(0)
    v_mad_u32_u16 v229, v228, s39, v248 op_sel:[1,0,0,0]
    v_mad_u32_u16 v228, v228, s39, v248
    s_waitcnt vmcnt(6)
    v_mfma_f32_32x32x16_bf16 v[0:15], v[64:67], v[176:179], 0
    ds_read_b64_tr_b16 v[184:185], v246 offset:2048
    ds_read_b64_tr_b16 v[186:187], v246 offset:2560
    ds_read_b64_tr_b16 v[188:189], v247 offset:2048
    ds_read_b64_tr_b16 v[190:191], v247 offset:2560
    s_mov_b32 m0, s68
    v_mfma_f32_32x32x16_bf16 v[16:31], v[68:71], v[176:179], 0
    buffer_load_dwordx4 v222, s[4:7], s44 offen lds
    buffer_load_dwordx4 v223, s[72:75], s44 offen offset:1024 lds
    v_permlane32_swap_b32 v242, v243
    v_permlane32_swap_b32 v240, v241
    v_mfma_f32_32x32x16_bf16 v[32:47], v[64:67], v[180:183], 0
    v_permlane32_swap_b32 v236, v237
    v_permlane32_swap_b32 v244, v245
    v_add_f32 v242, v242, v243
    v_add_f32 v240, -v240, -v241
    v_add_f32 v236, v236, v237
    v_mfma_f32_32x32x16_bf16 v[48:63], v[68:71], v[180:183], 0
    s_setprio 0
    v_add_f32 v244, v244, v245
    s_set_gpr_idx_on s32, gpr_idx(DST)
    s_nop 0
    v_cvt_pk_bf16_f32 v195, v242, v236
    v_cvt_pk_bf16_f32 v196, v244, v240
    v_cvt_pk_bf16_f32 v197, v238, v238
    s_set_gpr_idx_off
    v_mul_f32 v234, v0, v96
    v_mul_f32 v236, v8, v128
    v_fmac_f32 v234, v1, v97
    v_fmac_f32 v236, v9, v129
    v_fmac_f32 v234, v2, v98
    v_fmac_f32 v236, v10, v130
    v_fmac_f32 v234, v3, v99
    v_fmac_f32 v236, v11, v131
    v_fmac_f32 v234, v4, v100
    v_fmac_f32 v236, v12, v132
    v_fmac_f32 v234, v5, v101
    v_fmac_f32 v236, v13, v133
    v_fmac_f32 v234, v6, v102
    v_fmac_f32 v236, v14, v134
    v_fmac_f32 v234, v7, v103
    v_fmac_f32 v236, v15, v135
    v_mul_f32 v238, v16, v128
    v_mul_f32 v240, v24, v128
    v_fmac_f32 v238, v17, v129
    v_fmac_f32 v240, v25, v129
    v_fmac_f32 v238, v18, v130
    v_fmac_f32 v240, v26, v130
    v_fmac_f32 v238, v19, v131
    v_fmac_f32 v240, v27, v131
    v_fmac_f32 v238, v20, v132
    v_fmac_f32 v240, v28, v132
    v_fmac_f32 v238, v21, v133
    v_fmac_f32 v240, v29, v133
    v_fmac_f32 v238, v22, v134
    v_fmac_f32 v240, v30, v134
    v_fmac_f32 v238, v23, v135
    v_fmac_f32 v240, v31, v135
    v_mul_f32 v235, v32, v104
    v_mul_f32 v237, v40, v136
    v_fmac_f32 v235, v33, v105
    v_fmac_f32 v237, v41, v137
    v_fmac_f32 v235, v34, v106
    v_fmac_f32 v237, v42, v138
    v_fmac_f32 v235, v35, v107
    v_fmac_f32 v237, v43, v139
    v_fmac_f32 v235, v36, v108
    v_fmac_f32 v237, v44, v140
    v_fmac_f32 v235, v37, v109
    v_fmac_f32 v237, v45, v141
    v_fmac_f32 v235, v38, v110
    v_fmac_f32 v237, v46, v142
    v_fmac_f32 v235, v39, v111
    v_fmac_f32 v237, v47, v143
    v_mul_f32 v239, v48, v136
    v_mul_f32 v241, v56, v136
    v_fmac_f32 v239, v49, v137
    v_fmac_f32 v241, v57, v137
    v_fmac_f32 v239, v50, v138
    v_fmac_f32 v241, v58, v138
    v_fmac_f32 v239, v51, v139
    v_fmac_f32 v241, v59, v139
    v_fmac_f32 v239, v52, v140
    v_fmac_f32 v241, v60, v140
    v_fmac_f32 v239, v53, v141
    v_fmac_f32 v241, v61, v141
    v_fmac_f32 v239, v54, v142
    v_fmac_f32 v241, v62, v142
    v_fmac_f32 v239, v55, v143
    v_fmac_f32 v241, v63, v143
    s_setprio 1
    s_waitcnt vmcnt(6) lgkmcnt(0)
    v_mfma_f32_32x32x16_bf16 v[0:15], v[64:67], v[184:187], 0
    ds_read_b64_tr_b16 v[176:177], v246 offset:4096
    ds_read_b64_tr_b16 v[178:179], v246 offset:4608
    ds_read_b64_tr_b16 v[180:181], v247 offset:4096
    ds_read_b64_tr_b16 v[182:183], v247 offset:4608
    s_mov_b32 m0, s69
    v_mfma_f32_32x32x16_bf16 v[16:31], v[68:71], v[184:187], 0
    buffer_load_dwordx4 v224, s[4:7], s45 offen lds
    buffer_load_dwordx4 v225, s[72:75], s45 offen offset:1024 lds
    v_permlane32_swap_b32 v234, v235
    v_permlane32_swap_b32 v236, v237
    v_mfma_f32_32x32x16_bf16 v[32:47], v[64:67], v[188:191], 0
    v_permlane32_swap_b32 v238, v239
    v_permlane32_swap_b32 v240, v241
    v_add_f32 v234, v234, v235
    v_add_f32 v236, v236, v237
    v_add_f32 v238, v238, v239
    v_mfma_f32_32x32x16_bf16 v[48:63], v[68:71], v[188:191], 0
    s_setprio 0
    v_add_f32 v240, v240, v241
    s_set_gpr_idx_on s31, gpr_idx(DST)
    s_nop 0
    v_cvt_pk_bf16_f32 v192, v234, v236
    v_cvt_pk_bf16_f32 v193, v238, v240
    s_set_gpr_idx_off
    v_mul_f32 v234, v0, v144
    v_mul_f32 v236, v8, v112
    v_fmac_f32 v234, v1, v145
    v_fmac_f32 v236, v9, v113
    v_fmac_f32 v234, v2, v146
    v_fmac_f32 v236, v10, v114
    v_fmac_f32 v234, v3, v147
    v_fmac_f32 v236, v11, v115
    v_fmac_f32 v234, v4, v148
    v_fmac_f32 v236, v12, v116
    v_fmac_f32 v234, v5, v149
    v_fmac_f32 v236, v13, v117
    v_fmac_f32 v234, v6, v150
    v_fmac_f32 v236, v14, v118
    v_fmac_f32 v234, v7, v151
    v_fmac_f32 v236, v15, v119
    v_mul_f32 v238, v16, v160
    v_mul_f32 v240, v24, v160
    v_fmac_f32 v238, v17, v161
    v_fmac_f32 v240, v25, v161
    v_fmac_f32 v238, v18, v162
    v_fmac_f32 v240, v26, v162
    v_fmac_f32 v238, v19, v163
    v_fmac_f32 v240, v27, v163
    v_fmac_f32 v238, v20, v164
    v_fmac_f32 v240, v28, v164
    v_fmac_f32 v238, v21, v165
    v_fmac_f32 v240, v29, v165
    v_fmac_f32 v238, v22, v166
    v_fmac_f32 v240, v30, v166
    v_fmac_f32 v238, v23, v167
    v_fmac_f32 v240, v31, v167
    v_mul_f32 v235, v32, v152
    v_mul_f32 v237, v40, v120
    v_fmac_f32 v235, v33, v153
    v_fmac_f32 v237, v41, v121
    v_fmac_f32 v235, v34, v154
    v_fmac_f32 v237, v42, v122
    v_fmac_f32 v235, v35, v155
    v_fmac_f32 v237, v43, v123
    v_fmac_f32 v235, v36, v156
    v_fmac_f32 v237, v44, v124
    v_fmac_f32 v235, v37, v157
    v_fmac_f32 v237, v45, v125
    v_fmac_f32 v235, v38, v158
    v_fmac_f32 v237, v46, v126
    v_fmac_f32 v235, v39, v159
    v_fmac_f32 v237, v47, v127
    v_mul_f32 v239, v48, v168
    v_mul_f32 v241, v56, v168
    v_fmac_f32 v239, v49, v169
    v_fmac_f32 v241, v57, v169
    v_fmac_f32 v239, v50, v170
    v_fmac_f32 v241, v58, v170
    v_fmac_f32 v239, v51, v171
    v_fmac_f32 v241, v59, v171
    v_fmac_f32 v239, v52, v172
    v_fmac_f32 v241, v60, v172
    v_fmac_f32 v239, v53, v173
    v_fmac_f32 v241, v61, v173
    v_fmac_f32 v239, v54, v174
    v_fmac_f32 v241, v62, v174
    v_fmac_f32 v239, v55, v175
    v_fmac_f32 v241, v63, v175
    s_setprio 1
    s_waitcnt vmcnt(6) lgkmcnt(0)
    v_mfma_f32_32x32x16_bf16 v[0:15], v[64:67], v[176:179], 0
    ds_read_b64_tr_b16 v[184:185], v246 offset:6144
    ds_read_b64_tr_b16 v[186:187], v246 offset:6656
    ds_read_b64_tr_b16 v[188:189], v247 offset:6144
    ds_read_b64_tr_b16 v[190:191], v247 offset:6656
    s_mov_b32 m0, s70
    v_mfma_f32_32x32x16_bf16 v[16:31], v[68:71], v[176:179], 0
    buffer_load_dwordx4 v226, s[4:7], s46 offen lds
    buffer_load_dwordx4 v227, s[72:75], s46 offen offset:1024 lds
    v_permlane32_swap_b32 v234, v235
    v_add_f32 v234, v234, v235
    v_mfma_f32_32x32x16_bf16 v[32:47], v[64:67], v[180:183], 0
    v_mfma_f32_32x32x16_bf16 v[48:63], v[68:71], v[180:183], 0
    s_setprio 0
    v_mul_f32 v242, v0, v144
    v_fma_f32 v238, v8, v160, -v238
    v_fmac_f32 v242, v1, v145
    v_fmac_f32 v238, v9, v161
    v_fmac_f32 v242, v2, v146
    v_fmac_f32 v238, v10, v162
    v_fmac_f32 v242, v3, v147
    v_fmac_f32 v238, v11, v163
    v_fmac_f32 v242, v4, v148
    v_fmac_f32 v238, v12, v164
    v_fmac_f32 v242, v5, v149
    v_fmac_f32 v238, v13, v165
    v_fmac_f32 v242, v6, v150
    v_fmac_f32 v238, v14, v166
    v_fmac_f32 v242, v7, v151
    v_fmac_f32 v238, v15, v167
    v_fmac_f32 v236, v16, v112
    v_mul_f32 v244, v24, v160
    v_fmac_f32 v236, v17, v113
    v_fmac_f32 v244, v25, v161
    v_fmac_f32 v236, v18, v114
    v_fmac_f32 v244, v26, v162
    v_fmac_f32 v236, v19, v115
    v_fmac_f32 v244, v27, v163
    v_fmac_f32 v236, v20, v116
    v_fmac_f32 v244, v28, v164
    v_fmac_f32 v236, v21, v117
    v_fmac_f32 v244, v29, v165
    v_fmac_f32 v236, v22, v118
    v_fmac_f32 v244, v30, v166
    v_fmac_f32 v236, v23, v119
    v_fmac_f32 v244, v31, v167
    v_mul_f32 v243, v32, v152
    v_fma_f32 v239, v40, v168, -v239
    v_fmac_f32 v243, v33, v153
    v_fmac_f32 v239, v41, v169
    v_fmac_f32 v243, v34, v154
    v_fmac_f32 v239, v42, v170
    v_fmac_f32 v243, v35, v155
    v_fmac_f32 v239, v43, v171
    v_fmac_f32 v243, v36, v156
    v_fmac_f32 v239, v44, v172
    v_fmac_f32 v243, v37, v157
    v_fmac_f32 v239, v45, v173
    v_fmac_f32 v243, v38, v158
    v_fmac_f32 v239, v46, v174
    v_fmac_f32 v243, v39, v159
    v_fmac_f32 v239, v47, v175
    v_fmac_f32 v237, v48, v120
    v_mul_f32 v245, v56, v168
    v_fmac_f32 v237, v49, v121
    v_fmac_f32 v245, v57, v169
    v_fmac_f32 v237, v50, v122
    v_fmac_f32 v245, v58, v170
    v_fmac_f32 v237, v51, v123
    v_fmac_f32 v245, v59, v171
    v_fmac_f32 v237, v52, v124
    v_fmac_f32 v245, v60, v172
    v_fmac_f32 v237, v53, v125
    v_fmac_f32 v245, v61, v173
    v_fmac_f32 v237, v54, v126
    v_fmac_f32 v245, v62, v174
    v_fmac_f32 v237, v55, v127
    v_fmac_f32 v245, v63, v175
    s_setprio 1
    s_waitcnt vmcnt(4) lgkmcnt(0)
    v_mfma_f32_32x32x16_bf16 v[0:15], v[64:67], v[184:187], 0
    ds_read_b64_tr_b16 v[176:177], v246 offset:0
    ds_read_b64_tr_b16 v[178:179], v246 offset:512
    ds_read_b64_tr_b16 v[180:181], v247 offset:0
    ds_read_b64_tr_b16 v[182:183], v247 offset:512
    s_mov_b32 m0, s71
    v_mfma_f32_32x32x16_bf16 v[16:31], v[68:71], v[184:187], 0
    buffer_load_dwordx4 v228, s[4:7], s47 offen lds
    buffer_load_dwordx4 v229, s[72:75], s47 offen offset:1024 lds
    v_permlane32_swap_b32 v238, v239
    v_permlane32_swap_b32 v242, v243
    v_add_f32 v238, v238, v239
    v_mfma_f32_32x32x16_bf16 v[32:47], v[64:67], v[188:191], 0
    v_add_f32 v242, v242, v243
    s_set_gpr_idx_on s31, gpr_idx(DST)
    s_nop 0
    v_cvt_pk_bf16_f32 v194, v234, v242
    s_set_gpr_idx_off
    v_mfma_f32_32x32x16_bf16 v[48:63], v[68:71], v[188:191], 0
    s_setprio 0
    v_mul_f32 v242, v0, v144
    v_fma_f32 v240, v8, v160, -v240
    v_fmac_f32 v242, v1, v145
    v_fmac_f32 v240, v9, v161
    v_fmac_f32 v242, v2, v146
    v_fmac_f32 v240, v10, v162
    v_fmac_f32 v242, v3, v147
    v_fmac_f32 v240, v11, v163
    v_fmac_f32 v242, v4, v148
    v_fmac_f32 v240, v12, v164
    v_fmac_f32 v242, v5, v149
    v_fmac_f32 v240, v13, v165
    v_fmac_f32 v242, v6, v150
    v_fmac_f32 v240, v14, v166
    v_fmac_f32 v242, v7, v151
    v_fmac_f32 v240, v15, v167
    s_sub_u32 s58, s48, s29
    v_add_u32 v249, s58, v249
    v_add_u32 v250, s58, v250
    v_fma_f32 v244, v16, v160, -v244
    v_fmac_f32 v236, v24, v112
    v_fmac_f32 v244, v17, v161
    v_fmac_f32 v236, v25, v113
    v_fmac_f32 v244, v18, v162
    v_fmac_f32 v236, v26, v114
    v_fmac_f32 v244, v19, v163
    v_fmac_f32 v236, v27, v115
    v_fmac_f32 v244, v20, v164
    v_fmac_f32 v236, v28, v116
    v_fmac_f32 v244, v21, v165
    v_fmac_f32 v236, v29, v117
    v_fmac_f32 v244, v22, v166
    v_fmac_f32 v236, v30, v118
    v_fmac_f32 v244, v23, v167
    v_fmac_f32 v236, v31, v119
    ds_read_b64_tr_b16 v[0:1], v249 offset:0
    ds_read_b64_tr_b16 v[2:3], v249 offset:128
    ds_read_b128 v[4:7], v250 offset:0
    ds_read_b128 v[8:11], v250 offset:16
    ds_read_b128 v[12:15], v250 offset:384
    ds_read_b128 v[16:19], v250 offset:400
    v_mul_f32 v243, v32, v152
    v_fma_f32 v241, v40, v168, -v241
    v_fmac_f32 v243, v33, v153
    v_fmac_f32 v241, v41, v169
    v_fmac_f32 v243, v34, v154
    v_fmac_f32 v241, v42, v170
    v_fmac_f32 v243, v35, v155
    v_fmac_f32 v241, v43, v171
    v_fmac_f32 v243, v36, v156
    v_fmac_f32 v241, v44, v172
    v_fmac_f32 v243, v37, v157
    v_fmac_f32 v241, v45, v173
    v_fmac_f32 v243, v38, v158
    v_fmac_f32 v241, v46, v174
    v_fmac_f32 v243, v39, v159
    v_fmac_f32 v241, v47, v175
    ds_read_b64_tr_b16 v[20:21], v249 offset:512
    ds_read_b64_tr_b16 v[22:23], v249 offset:640
    ds_read_b128 v[24:27], v250 offset:64
    ds_read_b128 v[28:31], v250 offset:80
    ds_read_b128 v[32:35], v250 offset:448
    ds_read_b128 v[36:39], v250 offset:464
    v_fma_f32 v245, v48, v168, -v245
    v_fmac_f32 v237, v56, v120
    v_fmac_f32 v245, v49, v169
    v_fmac_f32 v237, v57, v121
    v_fmac_f32 v245, v50, v170
    v_fmac_f32 v237, v58, v122
    v_fmac_f32 v245, v51, v171
    v_fmac_f32 v237, v59, v123
    v_fmac_f32 v245, v52, v172
    v_fmac_f32 v237, v60, v124
    v_fmac_f32 v245, v53, v173
    v_fmac_f32 v237, v61, v125
    v_fmac_f32 v245, v54, v174
    v_fmac_f32 v237, v62, v126
    v_fmac_f32 v245, v55, v175
    v_fmac_f32 v237, v63, v127
    s_cmp_lg_u32 s34, 0
    s_cbranch_scc1 K2_SWITCH
    s_mov_b32 s29, s48
    s_mov_b32 s32, s31
    s_mov_b32 s30, s3
    s_mov_b32 s31, s35
    s_cmp_eq_u32 s33, 2
    s_cbranch_scc1 K2_U20
    s_cmp_eq_u32 s33, 3
    s_cbranch_scc1 K2_U30
    s_cmp_eq_u32 s33, 1
    s_cbranch_scc1 K2_U10
    s_branch K2_U40
K2_U40:
    s_setprio 1
    s_waitcnt lgkmcnt(10)
    v_lshlrev_b32 v40, 16, v0
    v_and_b32 v41, 0xffff0000, v0
    v_lshlrev_b32 v42, 16, v1
    v_and_b32 v43, 0xffff0000, v1
    v_lshlrev_b32 v44, 16, v2
    v_and_b32 v45, 0xffff0000, v2
    v_lshlrev_b32 v46, 16, v3
    v_and_b32 v47, 0xffff0000, v3
    s_waitcnt lgkmcnt(8)
    v_mul_f32 v4, v40, v4
    v_mul_f32 v5, v41, v5
    v_mul_f32 v6, v42, v6
    v_mul_f32 v7, v43, v7
    v_mul_f32 v8, v44, v8
    v_mul_f32 v9, v45, v9
    v_mul_f32 v10, v46, v10
    v_mul_f32 v11, v47, v11
    v_cvt_pk_bf16_f32 v64, v4, v5
    v_cvt_pk_bf16_f32 v65, v6, v7
    v_cvt_pk_bf16_f32 v66, v8, v9
    v_cvt_pk_bf16_f32 v67, v10, v11
    s_waitcnt lgkmcnt(6)
    v_mul_f32 v12, v40, v12
    v_mul_f32 v13, v41, v13
    v_mul_f32 v14, v42, v14
    v_mul_f32 v15, v43, v15
    v_mul_f32 v16, v44, v16
    v_mul_f32 v17, v45, v17
    v_mul_f32 v18, v46, v18
    v_mul_f32 v19, v47, v19
    v_cvt_pk_bf16_f32 v68, v12, v13
    v_cvt_pk_bf16_f32 v69, v14, v15
    v_cvt_pk_bf16_f32 v70, v16, v17
    v_cvt_pk_bf16_f32 v71, v18, v19
    ds_read_b64_tr_b16 v[0:1], v249 offset:1024
    ds_read_b64_tr_b16 v[2:3], v249 offset:1152
    ds_read_b128 v[4:7], v250 offset:128
    ds_read_b128 v[8:11], v250 offset:144
    ds_read_b128 v[12:15], v250 offset:512
    ds_read_b128 v[16:19], v250 offset:528
    s_waitcnt lgkmcnt(10)
    v_lshlrev_b32 v48, 16, v20
    v_and_b32 v49, 0xffff0000, v20
    v_lshlrev_b32 v50, 16, v21
    v_and_b32 v51, 0xffff0000, v21
    v_lshlrev_b32 v52, 16, v22
    v_and_b32 v53, 0xffff0000, v22
    v_lshlrev_b32 v54, 16, v23
    v_and_b32 v55, 0xffff0000, v23
    s_waitcnt lgkmcnt(8)
    v_mul_f32 v24, v48, v24
    v_mul_f32 v25, v49, v25
    v_mul_f32 v26, v50, v26
    v_mul_f32 v27, v51, v27
    v_mul_f32 v28, v52, v28
    v_mul_f32 v29, v53, v29
    v_mul_f32 v30, v54, v30
    v_mul_f32 v31, v55, v31
    v_cvt_pk_bf16_f32 v72, v24, v25
    v_cvt_pk_bf16_f32 v73, v26, v27
    v_cvt_pk_bf16_f32 v74, v28, v29
    v_cvt_pk_bf16_f32 v75, v30, v31
    s_waitcnt lgkmcnt(6)
    v_mul_f32 v32, v48, v32
    v_mul_f32 v33, v49, v33
    v_mul_f32 v34, v50, v34
    v_mul_f32 v35, v51, v35
    v_mul_f32 v36, v52, v36
    v_mul_f32 v37, v53, v37
    v_mul_f32 v38, v54, v38
    v_mul_f32 v39, v55, v39
    v_cvt_pk_bf16_f32 v76, v32, v33
    v_cvt_pk_bf16_f32 v77, v34, v35
    v_cvt_pk_bf16_f32 v78, v36, v37
    v_cvt_pk_bf16_f32 v79, v38, v39
    s_lshr_b32 s65, s30, 27
    s_mov_b32 s66, 161536
    s_cmp_ge_u32 s65, 2
    s_cselect_b32 s66, 158112, s66
    s_mul_i32 s65, s65, 512
    s_add_u32 s65, s65, s66
    s_sub_u32 s65, s65, s29
    v_add_u32 v56, s65, v249
    s_lshr_b32 s65, s30, 27
    s_mov_b32 s66, 161536
    s_cmp_ge_u32 s65, 2
    s_cselect_b32 s66, 159008, s66
    s_mul_i32 s65, s65, 64
    s_add_u32 s65, s65, s66
    s_sub_u32 s65, s65, s29
    v_add_u32 v57, s65, v250
    ds_read_b64_tr_b16 v[20:21], v56 offset:0
    ds_read_b64_tr_b16 v[22:23], v56 offset:128
    ds_read_b128 v[24:27], v57 offset:0
    ds_read_b128 v[28:31], v57 offset:16
    ds_read_b128 v[32:35], v57 offset:384
    ds_read_b128 v[36:39], v57 offset:400
    s_waitcnt lgkmcnt(10)
    v_lshlrev_b32 v40, 16, v0
    v_and_b32 v41, 0xffff0000, v0
    v_lshlrev_b32 v42, 16, v1
    v_and_b32 v43, 0xffff0000, v1
    v_lshlrev_b32 v44, 16, v2
    v_and_b32 v45, 0xffff0000, v2
    v_lshlrev_b32 v46, 16, v3
    v_and_b32 v47, 0xffff0000, v3
    s_waitcnt lgkmcnt(8)
    v_mul_f32 v4, v40, v4
    v_mul_f32 v5, v41, v5
    v_mul_f32 v6, v42, v6
    v_mul_f32 v7, v43, v7
    v_mul_f32 v8, v44, v8
    v_mul_f32 v9, v45, v9
    v_mul_f32 v10, v46, v10
    v_mul_f32 v11, v47, v11
    v_cvt_pk_bf16_f32 v80, v4, v5
    v_cvt_pk_bf16_f32 v81, v6, v7
    v_cvt_pk_bf16_f32 v82, v8, v9
    v_cvt_pk_bf16_f32 v83, v10, v11
    s_waitcnt lgkmcnt(6)
    v_mul_f32 v12, v40, v12
    v_mul_f32 v13, v41, v13
    v_mul_f32 v14, v42, v14
    v_mul_f32 v15, v43, v15
    v_mul_f32 v16, v44, v16
    v_mul_f32 v17, v45, v17
    v_mul_f32 v18, v46, v18
    v_mul_f32 v19, v47, v19
    v_cvt_pk_bf16_f32 v84, v12, v13
    v_cvt_pk_bf16_f32 v85, v14, v15
    v_cvt_pk_bf16_f32 v86, v16, v17
    v_cvt_pk_bf16_f32 v87, v18, v19
    s_waitcnt lgkmcnt(4)
    v_lshlrev_b32 v48, 16, v20
    v_and_b32 v49, 0xffff0000, v20
    v_lshlrev_b32 v50, 16, v21
    v_and_b32 v51, 0xffff0000, v21
    v_lshlrev_b32 v52, 16, v22
    v_and_b32 v53, 0xffff0000, v22
    v_lshlrev_b32 v54, 16, v23
    v_and_b32 v55, 0xffff0000, v23
    s_waitcnt lgkmcnt(2)
    v_mul_f32 v24, v48, v24
    v_mul_f32 v25, v49, v25
    v_mul_f32 v26, v50, v26
    v_mul_f32 v27, v51, v27
    v_mul_f32 v28, v52, v28
    v_mul_f32 v29, v53, v29
    v_mul_f32 v30, v54, v30
    v_mul_f32 v31, v55, v31
    v_cvt_pk_bf16_f32 v88, v24, v25
    v_cvt_pk_bf16_f32 v89, v26, v27
    v_cvt_pk_bf16_f32 v90, v28, v29
    v_cvt_pk_bf16_f32 v91, v30, v31
    s_waitcnt lgkmcnt(0)
    v_mul_f32 v32, v48, v32
    v_mul_f32 v33, v49, v33
    v_mul_f32 v34, v50, v34
    v_mul_f32 v35, v51, v35
    v_mul_f32 v36, v52, v36
    v_mul_f32 v37, v53, v37
    v_mul_f32 v38, v54, v38
    v_mul_f32 v39, v55, v39
    v_cvt_pk_bf16_f32 v92, v32, v33
    v_cvt_pk_bf16_f32 v93, v34, v35
    v_cvt_pk_bf16_f32 v94, v36, v37
    v_cvt_pk_bf16_f32 v95, v38, v39
    s_waitcnt vmcnt(4)
    v_mfma_f32_32x32x16_bf16 v[0:15], v[64:67], v[176:179], 0
    ds_read_b64_tr_b16 v[184:185], v246 offset:2048
    ds_read_b64_tr_b16 v[186:187], v246 offset:2560
    ds_read_b64_tr_b16 v[188:189], v247 offset:2048
    ds_read_b64_tr_b16 v[190:191], v247 offset:2560
    s_mov_b32 m0, s68
    v_mfma_f32_32x32x16_bf16 v[16:31], v[68:71], v[176:179], 0
    buffer_load_dwordx4 v222, s[4:7], s41 offen lds
    buffer_load_dwordx4 v223, s[72:75], s41 offen offset:1024 lds
    v_permlane32_swap_b32 v242, v243
    v_permlane32_swap_b32 v240, v241
    s_add_u32 s38, s38, 1
    v_mfma_f32_32x32x16_bf16 v[32:47], v[64:67], v[180:183], 0
    v_permlane32_swap_b32 v236, v237
    v_permlane32_swap_b32 v244, v245
    v_add_f32 v242, v242, v243
    v_add_f32 v240, -v240, -v241
    v_add_f32 v236, v236, v237
    v_mfma_f32_32x32x16_bf16 v[48:63], v[68:71], v[180:183], 0
    v_add_f32 v244, v244, v245
    s_set_gpr_idx_on s32, gpr_idx(DST)
    s_nop 0
    v_cvt_pk_bf16_f32 v195, v242, v236
    v_cvt_pk_bf16_f32 v196, v244, v240
    v_cvt_pk_bf16_f32 v197, v238, v238
    s_set_gpr_idx_off
    s_waitcnt vmcnt(4) lgkmcnt(0)
    v_mfma_f32_32x32x16_bf16 v[0:15], v[72:75], v[184:187], v[0:15]
    ds_read_b64_tr_b16 v[176:177], v246 offset:4096
    ds_read_b64_tr_b16 v[178:179], v246 offset:4608
    ds_read_b64_tr_b16 v[180:181], v247 offset:4096
    ds_read_b64_tr_b16 v[182:183], v247 offset:4608
    v_mov_b32 v254, s52
    v_mov_b32 v255, s38
    s_mov_b32 m0, s69
    v_mfma_f32_32x32x16_bf16 v[16:31], v[76:79], v[184:187], v[16:31]
    buffer_load_dwordx4 v224, s[4:7], s41 offen lds
    buffer_load_dwordx4 v225, s[72:75], s41 offen offset:1024 lds
    s_lshl_b32 s58, s38, 3
    s_add_u32 s58, s58, s20
    s_mov_b64 exec, 1
    ds_write_b32 v254, v255
    s_mov_b64 exec, -1
    s_cmp_lt_u32 s58, s22
    s_cbranch_scc0 K2_dyn_81
K2_back_82:
    v_readlane_b32 s3, v253, s58
    s_lshl_b32 s44, s34, 7
    s_lshl_b32 s60, s58, 5
    s_and_b32 s48, s3, 0x3ffff
    s_bfe_u32 s33, s3, 0x30012
    s_sub_u32 s60, s60, s48
    s_and_b32 s60, s60, 0xff
    s_add_u32 s60, s60, s48
    s_mul_i32 s35, s38, 6
    s_cmp_eq_u32 s34, 0
    s_cselect_b32 s35, s35, s60
    s_mov_b32 s45, s44
    s_add_u32 s47, s44, 256
    s_add_u32 s49, s48, 32
    s_add_u32 s60, s48, 64
    s_cmp_eq_u32 s33, 3
    s_cselect_b32 s46, s44, s47
    s_cselect_b32 s50, s60, s48
    s_cselect_b32 s51, s48, s49
    s_sub_u32 s60, s33, 2
    s_cmp_lt_u32 s60, 2
    s_cbranch_scc0 K2_rare_87
K2_back_88:
    v_mfma_f32_32x32x16_bf16 v[32:47], v[72:75], v[188:191], v[32:47]
    v_add_u32 v233, s48, v230
    ds_read_b32 v232, v233
    ds_read_b32 v233, v233 offset:1024
    v_mfma_f32_32x32x16_bf16 v[48:63], v[76:79], v[188:191], v[48:63]
    s_waitcnt vmcnt(4) lgkmcnt(3)
    v_mfma_f32_32x32x16_bf16 v[0:15], v[80:83], v[176:179], v[0:15]
    ds_read_b64_tr_b16 v[184:185], v246 offset:6144
    ds_read_b64_tr_b16 v[186:187], v246 offset:6656
    ds_read_b64_tr_b16 v[188:189], v247 offset:6144
    ds_read_b64_tr_b16 v[190:191], v247 offset:6656
    s_mov_b32 m0, s70
    v_mfma_f32_32x32x16_bf16 v[16:31], v[84:87], v[176:179], v[16:31]
    buffer_load_dwordx4 v226, s[4:7], s41 offen lds
    buffer_load_dwordx4 v227, s[72:75], s41 offen offset:1024 lds
    v_mfma_f32_32x32x16_bf16 v[32:47], v[80:83], v[180:183], v[32:47]
    v_mfma_f32_32x32x16_bf16 v[48:63], v[84:87], v[180:183], v[48:63]
    s_waitcnt lgkmcnt(4)
    v_or_b32 v232, v232, v231
    v_or_b32 v233, v233, v231
    s_cmp_lg_u32 s34, 0
    s_cbranch_scc1 K2_dum_90
    s_add_u32 m0, s48, 864
    s_add_u32 s65, s48, 1888
    buffer_load_dwordx4 v232, s[16:19], 0 offen  lds
    s_mov_b32 m0, s65
    s_mov_b32 exec_hi, 0
    buffer_load_dwordx4 v233, s[16:19], 0 offen  lds
    s_cmp_eq_u32 s33, 4
    s_cbranch_scc1 K2_a4_91
K2_b4_93:
    s_mov_b32 exec_hi, -1
K2_back_92:
    s_waitcnt vmcnt(6) lgkmcnt(0)
    v_mfma_f32_32x32x16_bf16 v[0:15], v[88:91], v[184:187], v[0:15]
    ds_read_b64_tr_b16 v[176:177], v246 offset:0
    ds_read_b64_tr_b16 v[178:179], v246 offset:512
    ds_read_b64_tr_b16 v[180:181], v247 offset:0
    ds_read_b64_tr_b16 v[182:183], v247 offset:512
    s_mov_b32 m0, s71
    v_mfma_f32_32x32x16_bf16 v[16:31], v[92:95], v[184:187], v[16:31]
    buffer_load_dwordx4 v228, s[4:7], s41 offen lds
    buffer_load_dwordx4 v229, s[72:75], s41 offen offset:1024 lds
    v_mfma_f32_32x32x16_bf16 v[32:47], v[88:91], v[188:191], v[32:47]
    s_nop 2
    v_mul_f32 v234, v0, v96
    v_mul_f32 v236, v8, v128
    v_fmac_f32 v234, v1, v97
    v_fmac_f32 v236, v9, v129
    v_fmac_f32 v234, v2, v98
    v_fmac_f32 v236, v10, v130
    v_fmac_f32 v234, v3, v99
    v_mfma_f32_32x32x16_bf16 v[48:63], v[92:95], v[188:191], v[48:63]
    s_setprio 0
    v_fmac_f32 v236, v11, v131
    v_fmac_f32 v234, v4, v100
    v_fmac_f32 v236, v12, v132
    v_fmac_f32 v234, v5, v101
    v_fmac_f32 v236, v13, v133
    v_fmac_f32 v234, v6, v102
    v_fmac_f32 v236, v14, v134
    v_fmac_f32 v234, v7, v103
    v_fmac_f32 v236, v15, v135
    v_mul_f32 v238, v16, v128
    v_mul_f32 v240, v24, v128
    v_fmac_f32 v238, v17, v129
    v_fmac_f32 v240, v25, v129
    v_fmac_f32 v238, v18, v130
    v_fmac_f32 v240, v26, v130
    v_fmac_f32 v238, v19, v131
    v_fmac_f32 v240, v27, v131
    v_fmac_f32 v238, v20, v132
    v_fmac_f32 v240, v28, v132
    v_fmac_f32 v238, v21, v133
    v_fmac_f32 v240, v29, v133
    v_fmac_f32 v238, v22, v134
    v_fmac_f32 v240, v30, v134
    v_fmac_f32 v238, v23, v135
    v_fmac_f32 v240, v31, v135
    v_mul_f32 v235, v32, v104
    v_mul_f32 v237, v40, v136
    v_fmac_f32 v235, v33, v105
    v_fmac_f32 v237, v41, v137
    v_fmac_f32 v235, v34, v106
    v_fmac_f32 v237, v42, v138
    v_fmac_f32 v235, v35, v107
    v_fmac_f32 v237, v43, v139
    v_fmac_f32 v235, v36, v108
    v_fmac_f32 v237, v44, v140
    v_fmac_f32 v235, v37, v109
    v_fmac_f32 v237, v45, v141
    v_fmac_f32 v235, v38, v110
    v_fmac_f32 v237, v46, v142
    v_fmac_f32 v235, v39, v111
    v_fmac_f32 v237, v47, v143
    v_mul_f32 v239, v48, v136
    v_mul_f32 v241, v56, v136
    s_setprio 1
    s_waitcnt vmcnt(6) lgkmcnt(0)
    v_mfma_f32_32x32x16_bf16 v[0:15], v[64:67], v[176:179], 0
    ds_read_b64_tr_b16 v[184:185], v246 offset:2048
    ds_read_b64_tr_b16 v[186:187], v246 offset:2560
    ds_read_b64_tr_b16 v[188:189], v247 offset:2048
    ds_read_b64_tr_b16 v[190:191], v247 offset:2560
    v_fmac_f32 v239, v49, v137
    v_fmac_f32 v241, v57, v137
    s_mov_b32 m0, s68
    v_mfma_f32_32x32x16_bf16 v[16:31], v[68:71], v[176:179], 0
    buffer_load_dwordx4 v222, s[4:7], s42 offen lds
    buffer_load_dwordx4 v223, s[72:75], s42 offen offset:1024 lds
    v_fmac_f32 v239, v50, v138
    v_fmac_f32 v241, v58, v138
    v_fmac_f32 v239, v51, v139
    v_fmac_f32 v241, v59, v139
    v_fmac_f32 v239, v52, v140
    v_mfma_f32_32x32x16_bf16 v[32:47], v[64:67], v[180:183], 0
    v_fmac_f32 v241, v60, v140
    v_fmac_f32 v239, v53, v141
    v_fmac_f32 v241, v61, v141
    v_fmac_f32 v239, v54, v142
    v_fmac_f32 v241, v62, v142
    v_fmac_f32 v239, v55, v143
    v_fmac_f32 v241, v63, v143
    v_mfma_f32_32x32x16_bf16 v[48:63], v[68:71], v[180:183], 0
    v_permlane32_swap_b32 v234, v235
    v_permlane32_swap_b32 v236, v237
    v_permlane32_swap_b32 v238, v239
    s_waitcnt vmcnt(6) lgkmcnt(0)
    v_mfma_f32_32x32x16_bf16 v[0:15], v[72:75], v[184:187], v[0:15]
    ds_read_b64_tr_b16 v[176:177], v246 offset:4096
    ds_read_b64_tr_b16 v[178:179], v246 offset:4608
    ds_read_b64_tr_b16 v[180:181], v247 offset:4096
    ds_read_b64_tr_b16 v[182:183], v247 offset:4608
    v_permlane32_swap_b32 v240, v241
    s_mov_b32 m0, s69
    v_mfma_f32_32x32x16_bf16 v[16:31], v[76:79], v[184:187], v[16:31]
    buffer_load_dwordx4 v224, s[4:7], s42 offen lds
    buffer_load_dwordx4 v225, s[72:75], s42 offen offset:1024 lds
    v_add_f32 v234, v234, v235
    v_add_f32 v236, v236, v237
    v_add_f32 v238, v238, v239
    v_add_f32 v240, v240, v241
    v_mfma_f32_32x32x16_bf16 v[32:47], v[72:75], v[188:191], v[32:47]
    s_set_gpr_idx_on s31, gpr_idx(DST)
    s_nop 0
    v_cvt_pk_bf16_f32 v192, v234, v236
    v_cvt_pk_bf16_f32 v193, v238, v240
    s_set_gpr_idx_off
    v_mfma_f32_32x32x16_bf16 v[48:63], v[76:79], v[188:191], v[48:63]
    s_waitcnt vmcnt(4) lgkmcnt(0)
    v_mfma_f32_32x32x16_bf16 v[0:15], v[80:83], v[176:179], v[0:15]
    ds_read_b64_tr_b16 v[184:185], v246 offset:6144
    ds_read_b64_tr_b16 v[186:187], v246 offset:6656
    ds_read_b64_tr_b16 v[188:189], v247 offset:6144
    ds_read_b64_tr_b16 v[190:191], v247 offset:6656
    s_mov_b32 m0, s70
    v_mfma_f32_32x32x16_bf16 v[16:31], v[84:87], v[176:179], v[16:31]
    buffer_load_dwordx4 v226, s[4:7], s42 offen lds
    buffer_load_dwordx4 v227, s[72:75], s42 offen offset:1024 lds
    v_mfma_f32_32x32x16_bf16 v[32:47], v[80:83], v[180:183], v[32:47]
    v_mfma_f32_32x32x16_bf16 v[48:63], v[84:87], v[180:183], v[48:63]
    s_waitcnt vmcnt(4) lgkmcnt(0)
    v_mfma_f32_32x32x16_bf16 v[0:15], v[88:91], v[184:187], v[0:15]
    ds_read_b64_tr_b16 v[176:177], v246 offset:0
    ds_read_b64_tr_b16 v[178:179], v246 offset:512
    ds_read_b64_tr_b16 v[180:181], v247 offset:0
    ds_read_b64_tr_b16 v[182:183], v247 offset:512
    s_mov_b32 m0, s71
    v_mfma_f32_32x32x16_bf16 v[16:31], v[92:95], v[184:187], v[16:31]
    buffer_load_dwordx4 v228, s[4:7], s42 offen lds
    buffer_load_dwordx4 v229, s[72:75], s42 offen offset:1024 lds
    v_mfma_f32_32x32x16_bf16 v[32:47], v[88:91], v[188:191], v[32:47]
    s_nop 2
    v_mul_f32 v234, v0, v144
    v_mul_f32 v236, v8, v112
    v_fmac_f32 v234, v1, v145
    v_fmac_f32 v236, v9, v113
    v_fmac_f32 v234, v2, v146
    v_fmac_f32 v236, v10, v114
    v_fmac_f32 v234, v3, v147
    v_mfma_f32_32x32x16_bf16 v[48:63], v[92:95], v[188:191], v[48:63]
    s_setprio 0
    v_fmac_f32 v236, v11, v115
    v_fmac_f32 v234, v4, v148
    v_fmac_f32 v236, v12, v116
    v_fmac_f32 v234, v5, v149
    v_fmac_f32 v236, v13, v117
    v_fmac_f32 v234, v6, v150
    v_fmac_f32 v236, v14, v118
    v_fmac_f32 v234, v7, v151
    v_fmac_f32 v236, v15, v119
    v_mul_f32 v238, v16, v160
    v_mul_f32 v240, v24, v160
    v_fmac_f32 v238, v17, v161
    v_fmac_f32 v240, v25, v161
    v_fmac_f32 v238, v18, v162
    v_fmac_f32 v240, v26, v162
    v_fmac_f32 v238, v19, v163
    v_fmac_f32 v240, v27, v163
    v_fmac_f32 v238, v20, v164
    v_fmac_f32 v240, v28, v164
    v_fmac_f32 v238, v21, v165
    v_fmac_f32 v240, v29, v165
    v_fmac_f32 v238, v22, v166
    v_fmac_f32 v240, v30, v166
    v_fmac_f32 v238, v23, v167
    v_fmac_f32 v240, v31, v167
    v_mul_f32 v235, v32, v152
    v_mul_f32 v237, v40, v120
    v_fmac_f32 v235, v33, v153
    v_fmac_f32 v237, v41, v121
    v_fmac_f32 v235, v34, v154
    v_fmac_f32 v237, v42, v122
    v_fmac_f32 v235, v35, v155
    v_fmac_f32 v237, v43, v123
    v_fmac_f32 v235, v36, v156
    v_fmac_f32 v237, v44, v124
    v_fmac_f32 v235, v37, v157
    v_fmac_f32 v237, v45, v125
    v_fmac_f32 v235, v38, v158
    v_fmac_f32 v237, v46, v126
    v_fmac_f32 v235, v39, v159
    v_fmac_f32 v237, v47, v127
    v_mul_f32 v239, v48, v168
    v_mul_f32 v241, v56, v168
    s_setprio 1
    s_waitcnt vmcnt(4) lgkmcnt(0)
    v_mfma_f32_32x32x16_bf16 v[0:15], v[64:67], v[176:179], 0
    ds_read_b64_tr_b16 v[184:185], v246 offset:2048
    ds_read_b64_tr_b16 v[186:187], v246 offset:2560
    ds_read_b64_tr_b16 v[188:189], v247 offset:2048
    ds_read_b64_tr_b16 v[190:191], v247 offset:2560
    v_fmac_f32 v239, v49, v169
    v_fmac_f32 v241, v57, v169
    s_mov_b32 m0, s68
    v_mfma_f32_32x32x16_bf16 v[16:31], v[68:71], v[176:179], 0
    buffer_load_dwordx4 v222, s[4:7], s43 offen lds
    buffer_load_dwordx4 v223, s[72:75], s43 offen offset:1024 lds
    v_fmac_f32 v239, v50, v170
    v_fmac_f32 v241, v58, v170
    v_fmac_f32 v239, v51, v171
    v_fmac_f32 v241, v59, v171
    v_fmac_f32 v239, v52, v172
    v_mfma_f32_32x32x16_bf16 v[32:47], v[64:67], v[180:183], 0
    v_fmac_f32 v241, v60, v172
    v_fmac_f32 v239, v53, v173
    v_fmac_f32 v241, v61, v173
    v_fmac_f32 v239, v54, v174
    v_fmac_f32 v241, v62, v174
    v_fmac_f32 v239, v55, v175
    v_fmac_f32 v241, v63, v175
    v_mfma_f32_32x32x16_bf16 v[48:63], v[68:71], v[180:183], 0
    v_permlane32_swap_b32 v234, v235
    v_add_f32 v234, v234, v235
    s_waitcnt vmcnt(4) lgkmcnt(0)
    v_mfma_f32_32x32x16_bf16 v[0:15], v[72:75], v[184:187], v[0:15]
    ds_read_b64_tr_b16 v[176:177], v246 offset:4096
    ds_read_b64_tr_b16 v[178:179], v246 offset:4608
    ds_read_b64_tr_b16 v[180:181], v247 offset:4096
    ds_read_b64_tr_b16 v[182:183], v247 offset:4608
    s_mov_b32 m0, s69
    v_mfma_f32_32x32x16_bf16 v[16:31], v[76:79], v[184:187], v[16:31]
    buffer_load_dwordx4 v224, s[4:7], s43 offen lds
    buffer_load_dwordx4 v225, s[72:75], s43 offen offset:1024 lds
    v_mfma_f32_32x32x16_bf16 v[32:47], v[72:75], v[188:191], v[32:47]
    v_mfma_f32_32x32x16_bf16 v[48:63], v[76:79], v[188:191], v[48:63]
    s_waitcnt vmcnt(4) lgkmcnt(0)
    v_mfma_f32_32x32x16_bf16 v[0:15], v[80:83], v[176:179], v[0:15]
    ds_read_b64_tr_b16 v[184:185], v246 offset:6144
    ds_read_b64_tr_b16 v[186:187], v246 offset:6656
    ds_read_b64_tr_b16 v[188:189], v247 offset:6144
    ds_read_b64_tr_b16 v[190:191], v247 offset:6656
    s_mov_b32 m0, s70
    v_mfma_f32_32x32x16_bf16 v[16:31], v[84:87], v[176:179], v[16:31]
    buffer_load_dwordx4 v226, s[4:7], s43 offen lds
    buffer_load_dwordx4 v227, s[72:75], s43 offen offset:1024 lds
    v_mfma_f32_32x32x16_bf16 v[32:47], v[80:83], v[180:183], v[32:47]
    v_add_u32 v222, s48, v251
    ds_read_b32 v222, v222
    v_mfma_f32_32x32x16_bf16 v[48:63], v[84:87], v[180:183], v[48:63]
    s_waitcnt vmcnt(4) lgkmcnt(1)
    v_mfma_f32_32x32x16_bf16 v[0:15], v[88:91], v[184:187], v[0:15]
    ds_read_b64_tr_b16 v[176:177], v246 offset:0
    ds_read_b64_tr_b16 v[178:179], v246 offset:512
    ds_read_b64_tr_b16 v[180:181], v247 offset:0
    ds_read_b64_tr_b16 v[182:183], v247 offset:512
    s_mov_b32 m0, s71
    v_mfma_f32_32x32x16_bf16 v[16:31], v[92:95], v[184:187], v[16:31]
    buffer_load_dwordx4 v228, s[4:7], s43 offen lds
    buffer_load_dwordx4 v229, s[72:75], s43 offen offset:1024 lds
    s_waitcnt lgkmcnt(4)
    v_mad_u32_u16 v223, v222, s39, v248 op_sel:[1,0,0,0]
    v_mad_u32_u16 v222, v222, s39, v248
    v_mfma_f32_32x32x16_bf16 v[32:47], v[88:91], v[188:191], v[32:47]
    v_add_u32 v224, s49, v251
    ds_read_b32 v224, v224
    v_mul_f32 v242, v0, v144
    v_fma_f32 v238, v8, v160, -v238
    v_fmac_f32 v242, v1, v145
    v_fmac_f32 v238, v9, v161
    v_fmac_f32 v242, v2, v146
    v_mfma_f32_32x32x16_bf16 v[48:63], v[92:95], v[188:191], v[48:63]
    s_setprio 0
    v_fmac_f32 v238, v10, v162
    v_fmac_f32 v242, v3, v147
    v_fmac_f32 v238, v11, v163
    v_fmac_f32 v242, v4, v148
    v_fmac_f32 v238, v12, v164
    v_fmac_f32 v242, v5, v149
    v_fmac_f32 v238, v13, v165
    v_fmac_f32 v242, v6, v150
    v_fmac_f32 v238, v14, v166
    v_fmac_f32 v242, v7, v151
    v_fmac_f32 v238, v15, v167
    v_fmac_f32 v236, v16, v112
    v_mul_f32 v244, v24, v160
    v_fmac_f32 v236, v17, v113
    v_fmac_f32 v244, v25, v161
    v_fmac_f32 v236, v18, v114
    v_fmac_f32 v244, v26, v162
    v_fmac_f32 v236, v19, v115
    v_fmac_f32 v244, v27, v163
    v_fmac_f32 v236, v20, v116
    v_fmac_f32 v244, v28, v164
    v_fmac_f32 v236, v21, v117
    v_fmac_f32 v244, v29, v165
    v_fmac_f32 v236, v22, v118
    v_fmac_f32 v244, v30, v166
    v_fmac_f32 v236, v23, v119
    v_fmac_f32 v244, v31, v167
    v_mul_f32 v243, v32, v152
    v_fma_f32 v239, v40, v168, -v239
    v_fmac_f32 v243, v33, v153
    v_fmac_f32 v239, v41, v169
    v_fmac_f32 v243, v34, v154
    v_fmac_f32 v239, v42, v170
    v_fmac_f32 v243, v35, v155
    v_fmac_f32 v239, v43, v171
    v_fmac_f32 v243, v36, v156
    v_fmac_f32 v239, v44, v172
    v_fmac_f32 v243, v37, v157
    v_fmac_f32 v239, v45, v173
    v_fmac_f32 v243, v38, v158
    v_fmac_f32 v239, v46, v174
    v_fmac_f32 v243, v39, v159
    v_fmac_f32 v239, v47, v175
    v_fmac_f32 v237, v48, v120
    v_mul_f32 v245, v56, v168
    v_fmac_f32 v237, v49, v121
    v_fmac_f32 v245, v57, v169
    v_fmac_f32 v237, v50, v122
    v_fmac_f32 v245, v58, v170
    v_fmac_f32 v237, v51, v123
    s_setprio 1
    s_waitcnt vmcnt(4) lgkmcnt(1)
    v_mfma_f32_32x32x16_bf16 v[0:15], v[64:67], v[176:179], 0
    ds_read_b64_tr_b16 v[184:185], v246 offset:2048
    ds_read_b64_tr_b16 v[186:187], v246 offset:2560
    ds_read_b64_tr_b16 v[188:189], v247 offset:2048
    ds_read_b64_tr_b16 v[190:191], v247 offset:2560
    v_fmac_f32 v245, v59, v171
    v_fmac_f32 v237, v52, v124
    s_mov_b32 m0, s68
    v_mfma_f32_32x32x16_bf16 v[16:31], v[68:71], v[176:179], 0
    buffer_load_dwordx4 v222, s[4:7], s44 offen lds
    buffer_load_dwordx4 v223, s[72:75], s44 offen offset:1024 lds
    s_waitcnt lgkmcnt(4)
    v_mad_u32_u16 v225, v224, s39, v248 op_sel:[1,0,0,0]
    v_mad_u32_u16 v224, v224, s39, v248
    v_fmac_f32 v245, v60, v172
    v_fmac_f32 v237, v53, v125
    v_mfma_f32_32x32x16_bf16 v[32:47], v[64:67], v[180:183], 0
    v_add_u32 v226, s50, v251
    ds_read_b32 v226, v226
    v_fmac_f32 v245, v61, v173
    v_fmac_f32 v237, v54, v126
    v_fmac_f32 v245, v62, v174
    v_fmac_f32 v237, v55, v127
    v_fmac_f32 v245, v63, v175
    v_mfma_f32_32x32x16_bf16 v[48:63], v[68:71], v[180:183], 0
    v_permlane32_swap_b32 v238, v239
    v_permlane32_swap_b32 v242, v243
    v_add_f32 v238, v238, v239
    v_add_f32 v242, v242, v243
    s_waitcnt vmcnt(4) lgkmcnt(1)
    v_mfma_f32_32x32x16_bf16 v[0:15], v[72:75], v[184:187], v[0:15]
    ds_read_b64_tr_b16 v[176:177], v246 offset:4096
    ds_read_b64_tr_b16 v[178:179], v246 offset:4608
    ds_read_b64_tr_b16 v[180:181], v247 offset:4096
    ds_read_b64_tr_b16 v[182:183], v247 offset:4608
    s_mov_b32 m0, s69
    v_mfma_f32_32x32x16_bf16 v[16:31], v[76:79], v[184:187], v[16:31]
    buffer_load_dwordx4 v224, s[4:7], s45 offen lds
    buffer_load_dwordx4 v225, s[72:75], s45 offen offset:1024 lds
    s_waitcnt lgkmcnt(4)
    v_mad_u32_u16 v227, v226, s39, v248 op_sel:[1,0,0,0]
    v_mad_u32_u16 v226, v226, s39, v248
    v_mfma_f32_32x32x16_bf16 v[32:47], v[72:75], v[188:191], v[32:47]
    v_add_u32 v228, s51, v251
    ds_read_b32 v228, v228
    s_set_gpr_idx_on s31, gpr_idx(DST)
    s_nop 0
    v_cvt_pk_bf16_f32 v194, v234, v242
    s_set_gpr_idx_off
    v_mfma_f32_32x32x16_bf16 v[48:63], v[76:79], v[188:191], v[48:63]
    s_waitcnt vmcnt(4) lgkmcnt(1)
    v_mfma_f32_32x32x16_bf16 v[0:15], v[80:83], v[176:179], v[0:15]
    ds_read_b64_tr_b16 v[184:185], v246 offset:6144
    ds_read_b64_tr_b16 v[186:187], v246 offset:6656
    ds_read_b64_tr_b16 v[188:189], v247 offset:6144
    ds_read_b64_tr_b16 v[190:191], v247 offset:6656
    s_mov_b32 m0, s70
    v_mfma_f32_32x32x16_bf16 v[16:31], v[84:87], v[176:179], v[16:31]
    buffer_load_dwordx4 v226, s[4:7], s46 offen lds
    buffer_load_dwordx4 v227, s[72:75], s46 offen offset:1024 lds
    s_waitcnt lgkmcnt(4)
    v_mad_u32_u16 v229, v228, s39, v248 op_sel:[1,0,0,0]
    v_mad_u32_u16 v228, v228, s39, v248
    v_mfma_f32_32x32x16_bf16 v[32:47], v[80:83], v[180:183], v[32:47]
    v_mfma_f32_32x32x16_bf16 v[48:63], v[84:87], v[180:183], v[48:63]
    s_waitcnt vmcnt(4) lgkmcnt(0)
    v_mfma_f32_32x32x16_bf16 v[0:15], v[88:91], v[184:187], v[0:15]
    ds_read_b64_tr_b16 v[176:177], v246 offset:0
    ds_read_b64_tr_b16 v[178:179], v246 offset:512
    ds_read_b64_tr_b16 v[180:181], v247 offset:0
    ds_read_b64_tr_b16 v[182:183], v247 offset:512
    s_mov_b32 m0, s71
    v_mfma_f32_32x32x16_bf16 v[16:31], v[92:95], v[184:187], v[16:31]
    buffer_load_dwordx4 v228, s[4:7], s47 offen lds
    buffer_load_dwordx4 v229, s[72:75], s47 offen offset:1024 lds
    v_mfma_f32_32x32x16_bf16 v[32:47], v[88:91], v[188:191], v[32:47]
    s_nop 2
    v_mul_f32 v242, v0, v144
    v_fma_f32 v240, v8, v160, -v240
    v_fmac_f32 v242, v1, v145
    v_fmac_f32 v240, v9, v161
    v_fmac_f32 v242, v2, v146
    v_fmac_f32 v240, v10, v162
    v_fmac_f32 v242, v3, v147
    v_mfma_f32_32x32x16_bf16 v[48:63], v[92:95], v[188:191], v[48:63]
    s_setprio 0
    v_fmac_f32 v240, v11, v163
    v_fmac_f32 v242, v4, v148
    v_fmac_f32 v240, v12, v164
    v_fmac_f32 v242, v5, v149
    v_fmac_f32 v240, v13, v165
    v_fmac_f32 v242, v6, v150
    v_fmac_f32 v240, v14, v166
    v_fmac_f32 v242, v7, v151
    v_fmac_f32 v240, v15, v167
    s_sub_u32 s58, s48, s29
    v_add_u32 v249, s58, v249
    v_add_u32 v250, s58, v250
    v_fma_f32 v244, v16, v160, -v244
    v_fmac_f32 v236, v24, v112
    v_fmac_f32 v244, v17, v161
    v_fmac_f32 v236, v25, v113
    v_fmac_f32 v244, v18, v162
    v_fmac_f32 v236, v26, v114
    v_fmac_f32 v244, v19, v163
    v_fmac_f32 v236, v27, v115
    v_fmac_f32 v244, v20, v164
    v_fmac_f32 v236, v28, v116
    v_fmac_f32 v244, v21, v165
    v_fmac_f32 v236, v29, v117
    v_fmac_f32 v244, v22, v166
    v_fmac_f32 v236, v30, v118
    v_fmac_f32 v244, v23, v167
    v_fmac_f32 v236, v31, v119
    ds_read_b64_tr_b16 v[0:1], v249 offset:0
    ds_read_b64_tr_b16 v[2:3], v249 offset:128
    ds_read_b128 v[4:7], v250 offset:0
    ds_read_b128 v[8:11], v250 offset:16
    ds_read_b128 v[12:15], v250 offset:384
    ds_read_b128 v[16:19], v250 offset:400
    v_mul_f32 v243, v32, v152
    v_fma_f32 v241, v40, v168, -v241
    v_fmac_f32 v243, v33, v153
    v_fmac_f32 v241, v41, v169
    v_fmac_f32 v243, v34, v154
    v_fmac_f32 v241, v42, v170
    v_fmac_f32 v243, v35, v155
    v_fmac_f32 v241, v43, v171
    v_fmac_f32 v243, v36, v156
    v_fmac_f32 v241, v44, v172
    v_fmac_f32 v243, v37, v157
    v_fmac_f32 v241, v45, v173
    v_fmac_f32 v243, v38, v158
    v_fmac_f32 v241, v46, v174
    v_fmac_f32 v243, v39, v159
    v_fmac_f32 v241, v47, v175
    ds_read_b64_tr_b16 v[20:21], v249 offset:512
    ds_read_b64_tr_b16 v[22:23], v249 offset:640
    ds_read_b128 v[24:27], v250 offset:64
    ds_read_b128 v[28:31], v250 offset:80
    ds_read_b128 v[32:35], v250 offset:448
    ds_read_b128 v[36:39], v250 offset:464
    v_fma_f32 v245, v48, v168, -v245
    v_fmac_f32 v237, v56, v120
    v_fmac_f32 v245, v49, v169
    v_fmac_f32 v237, v57, v121
    v_fmac_f32 v245, v50, v170
    v_fmac_f32 v237, v58, v122
    v_fmac_f32 v245, v51, v171
    v_fmac_f32 v237, v59, v123
    v_fmac_f32 v245, v52, v172
    v_fmac_f32 v237, v60, v124
    v_fmac_f32 v245, v53, v173
    v_fmac_f32 v237, v61, v125
    v_fmac_f32 v245, v54, v174
    v_fmac_f32 v237, v62, v126
    v_fmac_f32 v245, v55, v175
    v_fmac_f32 v237, v63, v127
    s_cmp_lg_u32 s34, 0
    s_cbranch_scc1 K2_SWITCH
    s_mov_b32 s29, s48
    s_mov_b32 s32, s31
    s_mov_b32 s30, s3
    s_mov_b32 s31, s35
    s_cmp_eq_u32 s33, 2
    s_cbranch_scc1 K2_U20
    s_cmp_eq_u32 s33, 3
    s_cbranch_scc1 K2_U30
    s_cmp_eq_u32 s33, 1
    s_cbranch_scc1 K2_U10
    s_branch K2_U40
K2_U11:
    s_setprio 1
    v_mov_b32 v254, 163648
    v_mov_b32 v255, 1
    v_lshl_add_u32 v233, v252, 1, s53
    s_mov_b64 exec, 1
    ds_add_rtn_u32 v232, v254, v255
    s_mov_b64 exec, -1
    ds_read_b32 v233, v233
    s_waitcnt lgkmcnt(12)
    v_lshlrev_b32 v40, 16, v0
    v_and_b32 v41, 0xffff0000, v0
    v_lshlrev_b32 v42, 16, v1
    v_and_b32 v43, 0xffff0000, v1
    v_lshlrev_b32 v44, 16, v2
    v_and_b32 v45, 0xffff0000, v2
    v_lshlrev_b32 v46, 16, v3
    v_and_b32 v47, 0xffff0000, v3
    s_waitcnt lgkmcnt(10)
    v_mul_f32 v4, v40, v4
    v_mul_f32 v5, v41, v5
    v_mul_f32 v6, v42, v6
    v_mul_f32 v7, v43, v7
    v_mul_f32 v8, v44, v8
    v_mul_f32 v9, v45, v9
    v_mul_f32 v10, v46, v10
    v_mul_f32 v11, v47, v11
    v_cvt_pk_bf16_f32 v64, v4, v5
    v_cvt_pk_bf16_f32 v65, v6, v7
    v_cvt_pk_bf16_f32 v66, v8, v9
    v_cvt_pk_bf16_f32 v67, v10, v11
    s_waitcnt lgkmcnt(8)
    v_mul_f32 v12, v40, v12
    v_mul_f32 v13, v41, v13
    v_mul_f32 v14, v42, v14
    v_mul_f32 v15, v43, v15
    v_mul_f32 v16, v44, v16
    v_mul_f32 v17, v45, v17
    v_mul_f32 v18, v46, v18
    v_mul_f32 v19, v47, v19
    v_cvt_pk_bf16_f32 v68, v12, v13
    v_cvt_pk_bf16_f32 v69, v14, v15
    v_cvt_pk_bf16_f32 v70, v16, v17
    v_cvt_pk_bf16_f32 v71, v18, v19
    s_waitcnt lgkmcnt(0)
    v_readfirstlane_b32 s58, v232
    s_nop 0
    s_cmp_lt_u32 s58, s22
    s_cbranch_scc0 K2_nul_94
    s_and_b32 s59, s58, 7
    s_lshr_b32 s60, s58, 3
K2_chk_96:
    v_readlane_b32 s61, v233, s59
    s_nop 0
    s_cmp_gt_u32 s61, s60
    s_cbranch_scc0 K2_spin_95
K2_back_97:
    v_readlane_b32 s3, v253, s58
    s_lshl_b32 s44, s34, 7
    s_lshl_b32 s60, s58, 5
    s_and_b32 s48, s3, 0x3ffff
    s_bfe_u32 s33, s3, 0x30012
    s_sub_u32 s60, s60, s48
    s_and_b32 s60, s60, 0xff
    s_add_u32 s35, s60, s48
    s_mov_b32 s45, s44
    s_add_u32 s47, s44, 256
    s_add_u32 s49, s48, 32
    s_add_u32 s60, s48, 64
    s_cmp_eq_u32 s33, 3
    s_cselect_b32 s46, s44, s47
    s_cselect_b32 s50, s60, s48
    s_cselect_b32 s51, s48, s49
    s_sub_u32 s60, s33, 2
    s_cmp_lt_u32 s60, 2
    s_cbranch_scc0 K2_rare_98
K2_back_99:
    v_add_u32 v222, s48, v251
    ds_read_b32 v222, v222
    v_add_u32 v224, s49, v251
    ds_read_b32 v224, v224
    v_add_u32 v226, s50, v251
    ds_read_b32 v226, v226
    v_add_u32 v228, s51, v251
    ds_read_b32 v228, v228
    s_waitcnt lgkmcnt(3)
    v_mad_u32_u16 v223, v222, s39, v248 op_sel:[1,0,0,0]
    v_mad_u32_u16 v222, v222, s39, v248
    s_waitcnt lgkmcnt(2)
    v_mad_u32_u16 v225, v224, s39, v248 op_sel:[1,0,0,0]
    v_mad_u32_u16 v224, v224, s39, v248
    s_waitcnt lgkmcnt(1)
    v_mad_u32_u16 v227, v226, s39, v248 op_sel:[1,0,0,0]
    v_mad_u32_u16 v226, v226, s39, v248
    s_waitcnt lgkmcnt(0)
    v_mad_u32_u16 v229, v228, s39, v248 op_sel:[1,0,0,0]
    v_mad_u32_u16 v228, v228, s39, v248
    s_waitcnt vmcnt(4)
    v_mfma_f32_32x32x16_bf16 v[0:15], v[64:67], v[176:179], 0
    ds_read_b64_tr_b16 v[184:185], v246 offset:2048
    ds_read_b64_tr_b16 v[186:187], v246 offset:2560
    ds_read_b64_tr_b16 v[188:189], v247 offset:2048
    ds_read_b64_tr_b16 v[190:191], v247 offset:2560
    s_mov_b32 m0, s68
    v_mfma_f32_32x32x16_bf16 v[16:31], v[68:71], v[176:179], 0
    buffer_load_dwordx4 v222, s[4:7], s44 offen lds
    buffer_load_dwordx4 v223, s[72:75], s44 offen offset:1024 lds
    v_permlane32_swap_b32 v242, v243
    v_permlane32_swap_b32 v240, v241
    v_mfma_f32_32x32x16_bf16 v[32:47], v[64:67], v[180:183], 0
    v_permlane32_swap_b32 v236, v237
    v_permlane32_swap_b32 v244, v245
    v_add_f32 v242, v242, v243
    v_add_f32 v240, -v240, -v241
    v_add_f32 v236, v236, v237
    v_mfma_f32_32x32x16_bf16 v[48:63], v[68:71], v[180:183], 0
    s_setprio 0
    v_add_f32 v244, v244, v245
    v_cvt_pk_bf16_f32 v242, v242, v236
    v_cvt_pk_bf16_f32 v244, v244, v240
    v_cvt_pk_bf16_f32 v238, v238, v238
    ds_write_b16 v230, v242 offset:1152
    ds_write_b16_d16_hi v230, v242 offset:128
    ds_write_b16 v230, v244 offset:512
    ds_write_b16_d16_hi v230, v244 offset:896
    ds_write_b16 v230, v238 offset:1280
    v_mul_f32 v234, v0, v96
    v_mul_f32 v236, v8, v128
    v_fmac_f32 v234, v1, v97
    v_fmac_f32 v236, v9, v129
    v_fmac_f32 v234, v2, v98
    v_fmac_f32 v236, v10, v130
    v_fmac_f32 v234, v3, v99
    v_fmac_f32 v236, v11, v131
    v_fmac_f32 v234, v4, v100
    v_fmac_f32 v236, v12, v132
    v_fmac_f32 v234, v5, v101
    v_fmac_f32 v236, v13, v133
    v_fmac_f32 v234, v6, v102
    v_fmac_f32 v236, v14, v134
    v_fmac_f32 v234, v7, v103
    v_fmac_f32 v236, v15, v135
    v_mul_f32 v238, v16, v128
    v_mul_f32 v240, v24, v128
    v_fmac_f32 v238, v17, v129
    v_fmac_f32 v240, v25, v129
    v_fmac_f32 v238, v18, v130
    v_fmac_f32 v240, v26, v130
    v_fmac_f32 v238, v19, v131
    v_fmac_f32 v240, v27, v131
    v_fmac_f32 v238, v20, v132
    v_fmac_f32 v240, v28, v132
    v_fmac_f32 v238, v21, v133
    v_fmac_f32 v240, v29, v133
    v_fmac_f32 v238, v22, v134
    v_fmac_f32 v240, v30, v134
    v_fmac_f32 v238, v23, v135
    v_fmac_f32 v240, v31, v135
    v_mul_f32 v235, v32, v104
    v_mul_f32 v237, v40, v136
    v_fmac_f32 v235, v33, v105
    v_fmac_f32 v237, v41, v137
    v_fmac_f32 v235, v34, v106
    v_fmac_f32 v237, v42, v138
    v_fmac_f32 v235, v35, v107
    v_fmac_f32 v237, v43, v139
    v_fmac_f32 v235, v36, v108
    v_fmac_f32 v237, v44, v140
    v_fmac_f32 v235, v37, v109
    v_fmac_f32 v237, v45, v141
    v_fmac_f32 v235, v38, v110
    v_fmac_f32 v237, v46, v142
    v_fmac_f32 v235, v39, v111
    v_fmac_f32 v237, v47, v143
    v_mul_f32 v239, v48, v136
    v_mul_f32 v241, v56, v136
    v_fmac_f32 v239, v49, v137
    v_fmac_f32 v241, v57, v137
    v_fmac_f32 v239, v50, v138
    v_fmac_f32 v241, v58, v138
    v_fmac_f32 v239, v51, v139
    v_fmac_f32 v241, v59, v139
    v_fmac_f32 v239, v52, v140
    v_fmac_f32 v241, v60, v140
    v_fmac_f32 v239, v53, v141
    v_fmac_f32 v241, v61, v141
    v_fmac_f32 v239, v54, v142
    v_fmac_f32 v241, v62, v142
    v_fmac_f32 v239, v55, v143
    v_fmac_f32 v241, v63, v143
    s_setprio 1
    s_waitcnt vmcnt(4) lgkmcnt(5)
    v_mfma_f32_32x32x16_bf16 v[0:15], v[64:67], v[184:187], 0
    ds_read_b64_tr_b16 v[176:177], v246 offset:4096
    ds_read_b64_tr_b16 v[178:179], v246 offset:4608
    ds_read_b64_tr_b16 v[180:181], v247 offset:4096
    ds_read_b64_tr_b16 v[182:183], v247 offset:4608
    s_mov_b32 m0, s69
    v_mfma_f32_32x32x16_bf16 v[16:31], v[68:71], v[184:187], 0
    buffer_load_dwordx4 v224, s[4:7], s45 offen lds
    buffer_load_dwordx4 v225, s[72:75], s45 offen offset:1024 lds
    v_permlane32_swap_b32 v234, v235
    v_permlane32_swap_b32 v236, v237
    v_mfma_f32_32x32x16_bf16 v[32:47], v[64:67], v[188:191], 0
    v_permlane32_swap_b32 v238, v239
    v_permlane32_swap_b32 v240, v241
    v_add_u32 v230, s31, v252
    v_add_f32 v234, v234, v235
    v_add_f32 v236, v236, v237
    v_mfma_f32_32x32x16_bf16 v[48:63], v[68:71], v[188:191], 0
    s_setprio 0
    v_add_f32 v238, v238, v239
    v_add_f32 v240, v240, v241
    v_cvt_pk_bf16_f32 v234, v234, v236
    v_cvt_pk_bf16_f32 v238, v238, v240
    ds_write_b16 v230, v234 offset:0
    ds_write_b16_d16_hi v230, v234 offset:256
    ds_write_b16 v230, v238 offset:640
    ds_write_b16_d16_hi v230, v238 offset:1024
    v_mul_f32 v234, v0, v144
    v_mul_f32 v236, v8, v112
    v_fmac_f32 v234, v1, v145
    v_fmac_f32 v236, v9, v113
    v_fmac_f32 v234, v2, v146
    v_fmac_f32 v236, v10, v114
    v_fmac_f32 v234, v3, v147
    v_fmac_f32 v236, v11, v115
    v_fmac_f32 v234, v4, v148
    v_fmac_f32 v236, v12, v116
    v_fmac_f32 v234, v5, v149
    v_fmac_f32 v236, v13, v117
    v_fmac_f32 v234, v6, v150
    v_fmac_f32 v236, v14, v118
    v_fmac_f32 v234, v7, v151
    v_fmac_f32 v236, v15, v119
    v_mul_f32 v238, v16, v160
    v_mul_f32 v240, v24, v160
    v_fmac_f32 v238, v17, v161
    v_fmac_f32 v240, v25, v161
    v_fmac_f32 v238, v18, v162
    v_fmac_f32 v240, v26, v162
    v_fmac_f32 v238, v19, v163
    v_fmac_f32 v240, v27, v163
    v_fmac_f32 v238, v20, v164
    v_fmac_f32 v240, v28, v164
    v_fmac_f32 v238, v21, v165
    v_fmac_f32 v240, v29, v165
    v_fmac_f32 v238, v22, v166
    v_fmac_f32 v240, v30, v166
    v_fmac_f32 v238, v23, v167
    v_fmac_f32 v240, v31, v167
    v_mul_f32 v235, v32, v152
    v_mul_f32 v237, v40, v120
    v_fmac_f32 v235, v33, v153
    v_fmac_f32 v237, v41, v121
    v_fmac_f32 v235, v34, v154
    v_fmac_f32 v237, v42, v122
    v_fmac_f32 v235, v35, v155
    v_fmac_f32 v237, v43, v123
    v_fmac_f32 v235, v36, v156
    v_fmac_f32 v237, v44, v124
    v_fmac_f32 v235, v37, v157
    v_fmac_f32 v237, v45, v125
    v_fmac_f32 v235, v38, v158
    v_fmac_f32 v237, v46, v126
    v_fmac_f32 v235, v39, v159
    v_fmac_f32 v237, v47, v127
    v_mul_f32 v239, v48, v168
    v_mul_f32 v241, v56, v168
    v_fmac_f32 v239, v49, v169
    v_fmac_f32 v241, v57, v169
    v_fmac_f32 v239, v50, v170
    v_fmac_f32 v241, v58, v170
    v_fmac_f32 v239, v51, v171
    v_fmac_f32 v241, v59, v171
    v_fmac_f32 v239, v52, v172
    v_fmac_f32 v241, v60, v172
    v_fmac_f32 v239, v53, v173
    v_fmac_f32 v241, v61, v173
    v_fmac_f32 v239, v54, v174
    v_fmac_f32 v241, v62, v174
    v_fmac_f32 v239, v55, v175
    v_fmac_f32 v241, v63, v175
    s_setprio 1
    s_waitcnt vmcnt(4) lgkmcnt(4)
    v_mfma_f32_32x32x16_bf16 v[0:15], v[64:67], v[176:179], 0
    ds_read_b64_tr_b16 v[184:185], v246 offset:6144
    ds_read_b64_tr_b16 v[186:187], v246 offset:6656
    ds_read_b64_tr_b16 v[188:189], v247 offset:6144
    ds_read_b64_tr_b16 v[190:191], v247 offset:6656
    s_mov_b32 m0, s70
    v_mfma_f32_32x32x16_bf16 v[16:31], v[68:71], v[176:179], 0
    buffer_load_dwordx4 v226, s[4:7], s46 offen lds
    buffer_load_dwordx4 v227, s[72:75], s46 offen offset:1024 lds
    v_permlane32_swap_b32 v234, v235
    v_add_f32 v234, v234, v235
    v_mfma_f32_32x32x16_bf16 v[32:47], v[64:67], v[180:183], 0
    v_mfma_f32_32x32x16_bf16 v[48:63], v[68:71], v[180:183], 0
    s_setprio 0
    v_mul_f32 v242, v0, v144
    v_fma_f32 v238, v8, v160, -v238
    v_fmac_f32 v242, v1, v145
    v_fmac_f32 v238, v9, v161
    v_fmac_f32 v242, v2, v146
    v_fmac_f32 v238, v10, v162
    v_fmac_f32 v242, v3, v147
    v_fmac_f32 v238, v11, v163
    v_fmac_f32 v242, v4, v148
    v_fmac_f32 v238, v12, v164
    v_fmac_f32 v242, v5, v149
    v_fmac_f32 v238, v13, v165
    v_fmac_f32 v242, v6, v150
    v_fmac_f32 v238, v14, v166
    v_fmac_f32 v242, v7, v151
    v_fmac_f32 v238, v15, v167
    v_fmac_f32 v236, v16, v112
    v_mul_f32 v244, v24, v160
    v_fmac_f32 v236, v17, v113
    v_fmac_f32 v244, v25, v161
    v_fmac_f32 v236, v18, v114
    v_fmac_f32 v244, v26, v162
    v_fmac_f32 v236, v19, v115
    v_fmac_f32 v244, v27, v163
    v_fmac_f32 v236, v20, v116
    v_fmac_f32 v244, v28, v164
    v_fmac_f32 v236, v21, v117
    v_fmac_f32 v244, v29, v165
    v_fmac_f32 v236, v22, v118
    v_fmac_f32 v244, v30, v166
    v_fmac_f32 v236, v23, v119
    v_fmac_f32 v244, v31, v167
    v_mul_f32 v243, v32, v152
    v_fma_f32 v239, v40, v168, -v239
    v_fmac_f32 v243, v33, v153
    v_fmac_f32 v239, v41, v169
    v_fmac_f32 v243, v34, v154
    v_fmac_f32 v239, v42, v170
    v_fmac_f32 v243, v35, v155
    v_fmac_f32 v239, v43, v171
    v_fmac_f32 v243, v36, v156
    v_fmac_f32 v239, v44, v172
    v_fmac_f32 v243, v37, v157
    v_fmac_f32 v239, v45, v173
    v_fmac_f32 v243, v38, v158
    v_fmac_f32 v239, v46, v174
    v_fmac_f32 v243, v39, v159
    v_fmac_f32 v239, v47, v175
    v_fmac_f32 v237, v48, v120
    v_mul_f32 v245, v56, v168
    v_fmac_f32 v237, v49, v121
    v_fmac_f32 v245, v57, v169
    v_fmac_f32 v237, v50, v122
    v_fmac_f32 v245, v58, v170
    v_fmac_f32 v237, v51, v123
    v_fmac_f32 v245, v59, v171
    v_fmac_f32 v237, v52, v124
    v_fmac_f32 v245, v60, v172
    v_fmac_f32 v237, v53, v125
    v_fmac_f32 v245, v61, v173
    v_fmac_f32 v237, v54, v126
    v_fmac_f32 v245, v62, v174
    v_fmac_f32 v237, v55, v127
    v_fmac_f32 v245, v63, v175
    s_setprio 1
    s_waitcnt vmcnt(4) lgkmcnt(0)
    v_mfma_f32_32x32x16_bf16 v[0:15], v[64:67], v[184:187], 0
    ds_read_b64_tr_b16 v[176:177], v246 offset:0
    ds_read_b64_tr_b16 v[178:179], v246 offset:512
    ds_read_b64_tr_b16 v[180:181], v247 offset:0
    ds_read_b64_tr_b16 v[182:183], v247 offset:512
    s_mov_b32 m0, s71
    v_mfma_f32_32x32x16_bf16 v[16:31], v[68:71], v[184:187], 0
    buffer_load_dwordx4 v228, s[4:7], s47 offen lds
    buffer_load_dwordx4 v229, s[72:75], s47 offen offset:1024 lds
    v_permlane32_swap_b32 v238, v239
    v_permlane32_swap_b32 v242, v243
    v_add_f32 v238, v238, v239
    v_mfma_f32_32x32x16_bf16 v[32:47], v[64:67], v[188:191], 0
    v_add_f32 v242, v242, v243
    v_cvt_pk_bf16_f32 v234, v234, v242
    ds_write_b16 v230, v234 offset:384
    ds_write_b16_d16_hi v230, v234 offset:768
    v_mfma_f32_32x32x16_bf16 v[48:63], v[68:71], v[188:191], 0
    s_setprio 0
    v_mul_f32 v242, v0, v144
    v_fma_f32 v240, v8, v160, -v240
    v_fmac_f32 v242, v1, v145
    v_fmac_f32 v240, v9, v161
    v_fmac_f32 v242, v2, v146
    v_fmac_f32 v240, v10, v162
    v_fmac_f32 v242, v3, v147
    v_fmac_f32 v240, v11, v163
    v_fmac_f32 v242, v4, v148
    v_fmac_f32 v240, v12, v164
    v_fmac_f32 v242, v5, v149
    v_fmac_f32 v240, v13, v165
    v_fmac_f32 v242, v6, v150
    v_fmac_f32 v240, v14, v166
    v_fmac_f32 v242, v7, v151
    v_fmac_f32 v240, v15, v167
    s_sub_u32 s58, s48, s29
    v_add_u32 v249, s58, v249
    v_add_u32 v250, s58, v250
    v_fma_f32 v244, v16, v160, -v244
    v_fmac_f32 v236, v24, v112
    v_fmac_f32 v244, v17, v161
    v_fmac_f32 v236, v25, v113
    v_fmac_f32 v244, v18, v162
    v_fmac_f32 v236, v26, v114
    v_fmac_f32 v244, v19, v163
    v_fmac_f32 v236, v27, v115
    v_fmac_f32 v244, v20, v164
    v_fmac_f32 v236, v28, v116
    v_fmac_f32 v244, v21, v165
    v_fmac_f32 v236, v29, v117
    v_fmac_f32 v244, v22, v166
    v_fmac_f32 v236, v30, v118
    v_fmac_f32 v244, v23, v167
    v_fmac_f32 v236, v31, v119
    ds_read_b64_tr_b16 v[0:1], v249 offset:0
    ds_read_b64_tr_b16 v[2:3], v249 offset:128
    ds_read_b128 v[4:7], v250 offset:0
    ds_read_b128 v[8:11], v250 offset:16
    ds_read_b128 v[12:15], v250 offset:384
    ds_read_b128 v[16:19], v250 offset:400
    v_mul_f32 v243, v32, v152
    v_fma_f32 v241, v40, v168, -v241
    v_fmac_f32 v243, v33, v153
    v_fmac_f32 v241, v41, v169
    v_fmac_f32 v243, v34, v154
    v_fmac_f32 v241, v42, v170
    v_fmac_f32 v243, v35, v155
    v_fmac_f32 v241, v43, v171
    v_fmac_f32 v243, v36, v156
    v_fmac_f32 v241, v44, v172
    v_fmac_f32 v243, v37, v157
    v_fmac_f32 v241, v45, v173
    v_fmac_f32 v243, v38, v158
    v_fmac_f32 v241, v46, v174
    v_fmac_f32 v243, v39, v159
    v_fmac_f32 v241, v47, v175
    ds_read_b64_tr_b16 v[20:21], v249 offset:512
    ds_read_b64_tr_b16 v[22:23], v249 offset:640
    ds_read_b128 v[24:27], v250 offset:64
    ds_read_b128 v[28:31], v250 offset:80
    ds_read_b128 v[32:35], v250 offset:448
    ds_read_b128 v[36:39], v250 offset:464
    v_fma_f32 v245, v48, v168, -v245
    v_fmac_f32 v237, v56, v120
    v_fmac_f32 v245, v49, v169
    v_fmac_f32 v237, v57, v121
    v_fmac_f32 v245, v50, v170
    v_fmac_f32 v237, v58, v122
    v_fmac_f32 v245, v51, v171
    v_fmac_f32 v237, v59, v123
    v_fmac_f32 v245, v52, v172
    v_fmac_f32 v237, v60, v124
    v_fmac_f32 v245, v53, v173
    v_fmac_f32 v237, v61, v125
    v_fmac_f32 v245, v54, v174
    v_fmac_f32 v237, v62, v126
    v_fmac_f32 v245, v55, v175
    v_fmac_f32 v237, v63, v127
    s_cmp_eq_u32 s36, 0
    s_cbranch_scc1 K2_TAIL
    s_mov_b32 s29, s48
    s_mov_b32 s32, s31
    s_mov_b32 s30, s3
    s_mov_b32 s31, s35
    s_cmp_eq_u32 s33, 2
    s_cbranch_scc1 K2_U21
    s_cmp_eq_u32 s33, 3
    s_cbranch_scc1 K2_U31
    s_cmp_eq_u32 s33, 1
    s_cbranch_scc1 K2_U11
    s_branch K2_U41
K2_U41:
    s_setprio 1
    s_waitcnt lgkmcnt(10)
    v_lshlrev_b32 v40, 16, v0
    v_and_b32 v41, 0xffff0000, v0
    v_lshlrev_b32 v42, 16, v1
    v_and_b32 v43, 0xffff0000, v1
    v_lshlrev_b32 v44, 16, v2
    v_and_b32 v45, 0xffff0000, v2
    v_lshlrev_b32 v46, 16, v3
    v_and_b32 v47, 0xffff0000, v3
    s_waitcnt lgkmcnt(8)
    v_mul_f32 v4, v40, v4
    v_mul_f32 v5, v41, v5
    v_mul_f32 v6, v42, v6
    v_mul_f32 v7, v43, v7
    v_mul_f32 v8, v44, v8
    v_mul_f32 v9, v45, v9
    v_mul_f32 v10, v46, v10
    v_mul_f32 v11, v47, v11
    v_cvt_pk_bf16_f32 v64, v4, v5
    v_cvt_pk_bf16_f32 v65, v6, v7
    v_cvt_pk_bf16_f32 v66, v8, v9
    v_cvt_pk_bf16_f32 v67, v10, v11
    s_waitcnt lgkmcnt(6)
    v_mul_f32 v12, v40, v12
    v_mul_f32 v13, v41, v13
    v_mul_f32 v14, v42, v14
    v_mul_f32 v15, v43, v15
    v_mul_f32 v16, v44, v16
    v_mul_f32 v17, v45, v17
    v_mul_f32 v18, v46, v18
    v_mul_f32 v19, v47, v19
    v_cvt_pk_bf16_f32 v68, v12, v13
    v_cvt_pk_bf16_f32 v69, v14, v15
    v_cvt_pk_bf16_f32 v70, v16, v17
    v_cvt_pk_bf16_f32 v71, v18, v19
    ds_read_b64_tr_b16 v[0:1], v249 offset:1024
    ds_read_b64_tr_b16 v[2:3], v249 offset:1152
    ds_read_b128 v[4:7], v250 offset:128
    ds_read_b128 v[8:11], v250 offset:144
    ds_read_b128 v[12:15], v250 offset:512
    ds_read_b128 v[16:19], v250 offset:528
    s_waitcnt lgkmcnt(10)
    v_lshlrev_b32 v48, 16, v20
    v_and_b32 v49, 0xffff0000, v20
    v_lshlrev_b32 v50, 16, v21
    v_and_b32 v51, 0xffff0000, v21
    v_lshlrev_b32 v52, 16, v22
    v_and_b32 v53, 0xffff0000, v22
    v_lshlrev_b32 v54, 16, v23
    v_and_b32 v55, 0xffff0000, v23
    s_waitcnt lgkmcnt(8)
    v_mul_f32 v24, v48, v24
    v_mul_f32 v25, v49, v25
    v_mul_f32 v26, v50, v26
    v_mul_f32 v27, v51, v27
    v_mul_f32 v28, v52, v28
    v_mul_f32 v29, v53, v29
    v_mul_f32 v30, v54, v30
    v_mul_f32 v31, v55, v31
    v_cvt_pk_bf16_f32 v72, v24, v25
    v_cvt_pk_bf16_f32 v73, v26, v27
    v_cvt_pk_bf16_f32 v74, v28, v29
    v_cvt_pk_bf16_f32 v75, v30, v31
    s_waitcnt lgkmcnt(6)
    v_mul_f32 v32, v48, v32
    v_mul_f32 v33, v49, v33
    v_mul_f32 v34, v50, v34
    v_mul_f32 v35, v51, v35
    v_mul_f32 v36, v52, v36
    v_mul_f32 v37, v53, v37
    v_mul_f32 v38, v54, v38
    v_mul_f32 v39, v55, v39
    v_cvt_pk_bf16_f32 v76, v32, v33
    v_cvt_pk_bf16_f32 v77, v34, v35
    v_cvt_pk_bf16_f32 v78, v36, v37
    v_cvt_pk_bf16_f32 v79, v38, v39
    s_lshr_b32 s65, s30, 27
    s_mov_b32 s66, 161536
    s_cmp_ge_u32 s65, 2
    s_cselect_b32 s66, 158112, s66
    s_mul_i32 s65, s65, 512
    s_add_u32 s65, s65, s66
    s_sub_u32 s65, s65, s29
    v_add_u32 v56, s65, v249
    s_lshr_b32 s65, s30, 27
    s_mov_b32 s66, 161536
    s_cmp_ge_u32 s65, 2
    s_cselect_b32 s66, 159008, s66
    s_mul_i32 s65, s65, 64
    s_add_u32 s65, s65, s66
    s_sub_u32 s65, s65, s29
    v_add_u32 v57, s65, v250
    ds_read_b64_tr_b16 v[20:21], v56 offset:0
    ds_read_b64_tr_b16 v[22:23], v56 offset:128
    ds_read_b128 v[24:27], v57 offset:0
    ds_read_b128 v[28:31], v57 offset:16
    ds_read_b128 v[32:35], v57 offset:384
    ds_read_b128 v[36:39], v57 offset:400
    s_waitcnt lgkmcnt(10)
    v_lshlrev_b32 v40, 16, v0
    v_and_b32 v41, 0xffff0000, v0
    v_lshlrev_b32 v42, 16, v1
    v_and_b32 v43, 0xffff0000, v1
    v_lshlrev_b32 v44, 16, v2
    v_and_b32 v45, 0xffff0000, v2
    v_lshlrev_b32 v46, 16, v3
    v_and_b32 v47, 0xffff0000, v3
    s_waitcnt lgkmcnt(8)
    v_mul_f32 v4, v40, v4
    v_mul_f32 v5, v41, v5
    v_mul_f32 v6, v42, v6
    v_mul_f32 v7, v43, v7
    v_mul_f32 v8, v44, v8
    v_mul_f32 v9, v45, v9
    v_mul_f32 v10, v46, v10
    v_mul_f32 v11, v47, v11
    v_cvt_pk_bf16_f32 v80, v4, v5
    v_cvt_pk_bf16_f32 v81, v6, v7
    v_cvt_pk_bf16_f32 v82, v8, v9
    v_cvt_pk_bf16_f32 v83, v10, v11
    s_waitcnt lgkmcnt(6)
    v_mul_f32 v12, v40, v12
    v_mul_f32 v13, v41, v13
    v_mul_f32 v14, v42, v14
    v_mul_f32 v15, v43, v15
    v_mul_f32 v16, v44, v16
    v_mul_f32 v17, v45, v17
    v_mul_f32 v18, v46, v18
    v_mul_f32 v19, v47, v19
    v_cvt_pk_bf16_f32 v84, v12, v13
    v_cvt_pk_bf16_f32 v85, v14, v15
    v_cvt_pk_bf16_f32 v86, v16, v17
    v_cvt_pk_bf16_f32 v87, v18, v19
    s_waitcnt lgkmcnt(4)
    v_lshlrev_b32 v48, 16, v20
    v_and_b32 v49, 0xffff0000, v20
    v_lshlrev_b32 v50, 16, v21
    v_and_b32 v51, 0xffff0000, v21
    v_lshlrev_b32 v52, 16, v22
    v_and_b32 v53, 0xffff0000, v22
    v_lshlrev_b32 v54, 16, v23
    v_and_b32 v55, 0xffff0000, v23
    s_waitcnt lgkmcnt(2)
    v_mul_f32 v24, v48, v24
    v_mul_f32 v25, v49, v25
    v_mul_f32 v26, v50, v26
    v_mul_f32 v27, v51, v27
    v_mul_f32 v28, v52, v28
    v_mul_f32 v29, v53, v29
    v_mul_f32 v30, v54, v30
    v_mul_f32 v31, v55, v31
    v_cvt_pk_bf16_f32 v88, v24, v25
    v_cvt_pk_bf16_f32 v89, v26, v27
    v_cvt_pk_bf16_f32 v90, v28, v29
    v_cvt_pk_bf16_f32 v91, v30, v31
    s_waitcnt lgkmcnt(0)
    v_mul_f32 v32, v48, v32
    v_mul_f32 v33, v49, v33
    v_mul_f32 v34, v50, v34
    v_mul_f32 v35, v51, v35
    v_mul_f32 v36, v52, v36
    v_mul_f32 v37, v53, v37
    v_mul_f32 v38, v54, v38
    v_mul_f32 v39, v55, v39
    v_cvt_pk_bf16_f32 v92, v32, v33
    v_cvt_pk_bf16_f32 v93, v34, v35
    v_cvt_pk_bf16_f32 v94, v36, v37
    v_cvt_pk_bf16_f32 v95, v38, v39
    s_waitcnt vmcnt(4)
    v_mfma_f32_32x32x16_bf16 v[0:15], v[64:67], v[176:179], 0
    ds_read_b64_tr_b16 v[184:185], v246 offset:2048
    ds_read_b64_tr_b16 v[186:187], v246 offset:2560
    ds_read_b64_tr_b16 v[188:189], v247 offset:2048
    ds_read_b64_tr_b16 v[190:191], v247 offset:2560
    s_mov_b32 m0, s68
    v_mfma_f32_32x32x16_bf16 v[16:31], v[68:71], v[176:179], 0
    buffer_load_dwordx4 v222, s[4:7], s41 offen lds
    buffer_load_dwordx4 v223, s[72:75], s41 offen offset:1024 lds
    v_permlane32_swap_b32 v242, v243
    v_permlane32_swap_b32 v240, v241
    v_mov_b32 v254, 163648
    v_mfma_f32_32x32x16_bf16 v[32:47], v[64:67], v[180:183], 0
    v_permlane32_swap_b32 v236, v237
    v_permlane32_swap_b32 v244, v245
    v_add_f32 v242, v242, v243
    v_add_f32 v240, -v240, -v241
    v_add_f32 v236, v236, v237
    v_mfma_f32_32x32x16_bf16 v[48:63], v[68:71], v[180:183], 0
    v_add_f32 v244, v244, v245
    v_cvt_pk_bf16_f32 v242, v242, v236
    v_cvt_pk_bf16_f32 v244, v244, v240
    v_cvt_pk_bf16_f32 v238, v238, v238
    ds_write_b16 v230, v242 offset:1152
    ds_write_b16_d16_hi v230, v242 offset:128
    v_mov_b32 v255, 1
    v_lshl_add_u32 v233, v252, 1, s53
    s_mov_b64 exec, 1
    ds_add_rtn_u32 v232, v254, v255
    s_mov_b64 exec, -1
    ds_read_b32 v233, v233
    s_waitcnt vmcnt(4) lgkmcnt(4)
    v_mfma_f32_32x32x16_bf16 v[0:15], v[72:75], v[184:187], v[0:15]
    ds_read_b64_tr_b16 v[176:177], v246 offset:4096
    ds_read_b64_tr_b16 v[178:179], v246 offset:4608
    ds_read_b64_tr_b16 v[180:181], v247 offset:4096
    ds_read_b64_tr_b16 v[182:183], v247 offset:4608
    ds_write_b16 v230, v244 offset:512
    ds_write_b16_d16_hi v230, v244 offset:896
    s_mov_b32 m0, s69
    v_mfma_f32_32x32x16_bf16 v[16:31], v[76:79], v[184:187], v[16:31]
    buffer_load_dwordx4 v224, s[4:7], s41 offen lds
    buffer_load_dwordx4 v225, s[72:75], s41 offen offset:1024 lds
    ds_write_b16 v230, v238 offset:1280
    s_waitcnt lgkmcnt(7)
    v_readfirstlane_b32 s58, v232
    v_mfma_f32_32x32x16_bf16 v[32:47], v[72:75], v[188:191], v[32:47]
    s_cmp_lt_u32 s58, s22
    s_cbranch_scc0 K2_nul_101
    s_and_b32 s59, s58, 7
    s_lshr_b32 s60, s58, 3
K2_chk_103:
    v_readlane_b32 s61, v233, s59
    s_nop 0
    s_cmp_gt_u32 s61, s60
    s_cbranch_scc0 K2_spin_102
K2_back_104:
    v_mfma_f32_32x32x16_bf16 v[48:63], v[76:79], v[188:191], v[48:63]
    v_readlane_b32 s3, v253, s58
    s_lshl_b32 s44, s34, 7
    s_lshl_b32 s60, s58, 5
    s_and_b32 s48, s3, 0x3ffff
    s_bfe_u32 s33, s3, 0x30012
    s_sub_u32 s60, s60, s48
    s_waitcnt vmcnt(4) lgkmcnt(3)
    v_mfma_f32_32x32x16_bf16 v[0:15], v[80:83], v[176:179], v[0:15]
    ds_read_b64_tr_b16 v[184:185], v246 offset:6144
    ds_read_b64_tr_b16 v[186:187], v246 offset:6656
    ds_read_b64_tr_b16 v[188:189], v247 offset:6144
    ds_read_b64_tr_b16 v[190:191], v247 offset:6656
    s_and_b32 s60, s60, 0xff
    s_add_u32 s35, s60, s48
    s_mov_b32 m0, s70
    v_mfma_f32_32x32x16_bf16 v[16:31], v[84:87], v[176:179], v[16:31]
    buffer_load_dwordx4 v226, s[4:7], s41 offen lds
    buffer_load_dwordx4 v227, s[72:75], s41 offen offset:1024 lds
    s_mov_b32 s45, s44
    s_add_u32 s47, s44, 256
    s_add_u32 s49, s48, 32
    s_add_u32 s60, s48, 64
    v_mfma_f32_32x32x16_bf16 v[32:47], v[80:83], v[180:183], v[32:47]
    s_cmp_eq_u32 s33, 3
    s_cselect_b32 s46, s44, s47
    s_cselect_b32 s50, s60, s48
    s_cselect_b32 s51, s48, s49
    s_sub_u32 s60, s33, 2
    s_cmp_lt_u32 s60, 2
    s_cbranch_scc0 K2_rare_105
K2_back_106:
    v_mfma_f32_32x32x16_bf16 v[48:63], v[84:87], v[180:183], v[48:63]
    s_waitcnt vmcnt(4) lgkmcnt(0)
    v_mfma_f32_32x32x16_bf16 v[0:15], v[88:91], v[184:187], v[0:15]
    ds_read_b64_tr_b16 v[176:177], v246 offset:0
    ds_read_b64_tr_b16 v[178:179], v246 offset:512
    ds_read_b64_tr_b16 v[180:181], v247 offset:0
    ds_read_b64_tr_b16 v[182:183], v247 offset:512
    s_mov_b32 m0, s71
    v_mfma_f32_32x32x16_bf16 v[16:31], v[92:95], v[184:187], v[16:31]
    buffer_load_dwordx4 v228, s[4:7], s41 offen lds
    buffer_load_dwordx4 v229, s[72:75], s41 offen offset:1024 lds
    v_mfma_f32_32x32x16_bf16 v[32:47], v[88:91], v[188:191], v[32:47]
    s_nop 2
    v_mul_f32 v234, v0, v96
    v_mul_f32 v236, v8, v128
    v_fmac_f32 v234, v1, v97
    v_fmac_f32 v236, v9, v129
    v_fmac_f32 v234, v2, v98
    v_fmac_f32 v236, v10, v130
    v_fmac_f32 v234, v3, v99
    v_mfma_f32_32x32x16_bf16 v[48:63], v[92:95], v[188:191], v[48:63]
    s_setprio 0
    v_fmac_f32 v236, v11, v131
    v_fmac_f32 v234, v4, v100
    v_fmac_f32 v236, v12, v132
    v_fmac_f32 v234, v5, v101
    v_fmac_f32 v236, v13, v133
    v_fmac_f32 v234, v6, v102
    v_fmac_f32 v236, v14, v134
    v_fmac_f32 v234, v7, v103
    v_fmac_f32 v236, v15, v135
    v_mul_f32 v238, v16, v128
    v_mul_f32 v240, v24, v128
    v_fmac_f32 v238, v17, v129
    v_fmac_f32 v240, v25, v129
    v_fmac_f32 v238, v18, v130
    v_fmac_f32 v240, v26, v130
    v_fmac_f32 v238, v19, v131
    v_fmac_f32 v240, v27, v131
    v_fmac_f32 v238, v20, v132
    v_fmac_f32 v240, v28, v132
    v_fmac_f32 v238, v21, v133
    v_fmac_f32 v240, v29, v133
    v_fmac_f32 v238, v22, v134
    v_fmac_f32 v240, v30, v134
    v_fmac_f32 v238, v23, v135
    v_fmac_f32 v240, v31, v135
    v_mul_f32 v235, v32, v104
    v_mul_f32 v237, v40, v136
    v_fmac_f32 v235, v33, v105
    v_fmac_f32 v237, v41, v137
    v_fmac_f32 v235, v34, v106
    v_fmac_f32 v237, v42, v138
    v_fmac_f32 v235, v35, v107
    v_fmac_f32 v237, v43, v139
    v_fmac_f32 v235, v36, v108
    v_fmac_f32 v237, v44, v140
    v_fmac_f32 v235, v37, v109
    v_fmac_f32 v237, v45, v141
    v_fmac_f32 v235, v38, v110
    v_fmac_f32 v237, v46, v142
    v_fmac_f32 v235, v39, v111
    v_fmac_f32 v237, v47, v143
    v_mul_f32 v239, v48, v136
    v_mul_f32 v241, v56, v136
    s_setprio 1
    s_waitcnt vmcnt(4) lgkmcnt(0)
    v_mfma_f32_32x32x16_bf16 v[0:15], v[64:67], v[176:179], 0
    ds_read_b64_tr_b16 v[184:185], v246 offset:2048
    ds_read_b64_tr_b16 v[186:187], v246 offset:2560
    ds_read_b64_tr_b16 v[188:189], v247 offset:2048
    ds_read_b64_tr_b16 v[190:191], v247 offset:2560
    v_fmac_f32 v239, v49, v137
    v_fmac_f32 v241, v57, v137
    s_mov_b32 m0, s68
    v_mfma_f32_32x32x16_bf16 v[16:31], v[68:71], v[176:179], 0
    buffer_load_dwordx4 v222, s[4:7], s42 offen lds
    buffer_load_dwordx4 v223, s[72:75], s42 offen offset:1024 lds
    v_fmac_f32 v239, v50, v138
    v_fmac_f32 v241, v58, v138
    v_fmac_f32 v239, v51, v139
    v_fmac_f32 v241, v59, v139
    v_fmac_f32 v239, v52, v140
    v_mfma_f32_32x32x16_bf16 v[32:47], v[64:67], v[180:183], 0
    v_fmac_f32 v241, v60, v140
    v_fmac_f32 v239, v53, v141
    v_fmac_f32 v241, v61, v141
    v_fmac_f32 v239, v54, v142
    v_fmac_f32 v241, v62, v142
    v_fmac_f32 v239, v55, v143
    v_fmac_f32 v241, v63, v143
    v_mfma_f32_32x32x16_bf16 v[48:63], v[68:71], v[180:183], 0
    v_permlane32_swap_b32 v234, v235
    v_permlane32_swap_b32 v236, v237
    v_permlane32_swap_b32 v238, v239
    s_waitcnt vmcnt(4) lgkmcnt(0)
    v_mfma_f32_32x32x16_bf16 v[0:15], v[72:75], v[184:187], v[0:15]
    ds_read_b64_tr_b16 v[176:177], v246 offset:4096
    ds_read_b64_tr_b16 v[178:179], v246 offset:4608
    ds_read_b64_tr_b16 v[180:181], v247 offset:4096
    ds_read_b64_tr_b16 v[182:183], v247 offset:4608
    v_permlane32_swap_b32 v240, v241
    s_mov_b32 m0, s69
    v_mfma_f32_32x32x16_bf16 v[16:31], v[76:79], v[184:187], v[16:31]
    buffer_load_dwordx4 v224, s[4:7], s42 offen lds
    buffer_load_dwordx4 v225, s[72:75], s42 offen offset:1024 lds
    v_add_u32 v230, s31, v252
    v_add_f32 v234, v234, v235
    v_add_f32 v236, v236, v237
    v_add_f32 v238, v238, v239
    v_add_f32 v240, v240, v241
    v_mfma_f32_32x32x16_bf16 v[32:47], v[72:75], v[188:191], v[32:47]
    v_cvt_pk_bf16_f32 v234, v234, v236
    v_cvt_pk_bf16_f32 v238, v238, v240
    ds_write_b16 v230, v234 offset:0
    ds_write_b16_d16_hi v230, v234 offset:256
    ds_write_b16 v230, v238 offset:640
    ds_write_b16_d16_hi v230, v238 offset:1024
    v_mfma_f32_32x32x16_bf16 v[48:63], v[76:79], v[188:191], v[48:63]
    s_waitcnt vmcnt(4) lgkmcnt(4)
    v_mfma_f32_32x32x16_bf16 v[0:15], v[80:83], v[176:179], v[0:15]
    ds_read_b64_tr_b16 v[184:185], v246 offset:6144
    ds_read_b64_tr_b16 v[186:187], v246 offset:6656
    ds_read_b64_tr_b16 v[188:189], v247 offset:6144
    ds_read_b64_tr_b16 v[190:191], v247 offset:6656
    s_mov_b32 m0, s70
    v_mfma_f32_32x32x16_bf16 v[16:31], v[84:87], v[176:179], v[16:31]
    buffer_load_dwordx4 v226, s[4:7], s42 offen lds
    buffer_load_dwordx4 v227, s[72:75], s42 offen offset:1024 lds
    v_mfma_f32_32x32x16_bf16 v[32:47], v[80:83], v[180:183], v[32:47]
    v_mfma_f32_32x32x16_bf16 v[48:63], v[84:87], v[180:183], v[48:63]
    s_waitcnt vmcnt(4) lgkmcnt(0)
    v_mfma_f32_32x32x16_bf16 v[0:15], v[88:91], v[184:187], v[0:15]
    ds_read_b64_tr_b16 v[176:177], v246 offset:0
    ds_read_b64_tr_b16 v[178:179], v246 offset:512
    ds_read_b64_tr_b16 v[180:181], v247 offset:0
    ds_read_b64_tr_b16 v[182:183], v247 offset:512
    s_mov_b32 m0, s71
    v_mfma_f32_32x32x16_bf16 v[16:31], v[92:95], v[184:187], v[16:31]
    buffer_load_dwordx4 v228, s[4:7], s42 offen lds
    buffer_load_dwordx4 v229, s[72:75], s42 offen offset:1024 lds
    v_mfma_f32_32x32x16_bf16 v[32:47], v[88:91], v[188:191], v[32:47]
    s_nop 2
    v_mul_f32 v234, v0, v144
    v_mul_f32 v236, v8, v112
    v_fmac_f32 v234, v1, v145
    v_fmac_f32 v236, v9, v113
    v_fmac_f32 v234, v2, v146
    v_fmac_f32 v236, v10, v114
    v_fmac_f32 v234, v3, v147
    v_mfma_f32_32x32x16_bf16 v[48:63], v[92:95], v[188:191], v[48:63]
    s_setprio 0
    v_fmac_f32 v236, v11, v115
    v_fmac_f32 v234, v4, v148
    v_fmac_f32 v236, v12, v116
    v_fmac_f32 v234, v5, v149
    v_fmac_f32 v236, v13, v117
    v_fmac_f32 v234, v6, v150
    v_fmac_f32 v236, v14, v118
    v_fmac_f32 v234, v7, v151
    v_fmac_f32 v236, v15, v119
    v_mul_f32 v238, v16, v160
    v_mul_f32 v240, v24, v160
    v_fmac_f32 v238, v17, v161
    v_fmac_f32 v240, v25, v161
    v_fmac_f32 v238, v18, v162
    v_fmac_f32 v240, v26, v162
    v_fmac_f32 v238, v19, v163
    v_fmac_f32 v240, v27, v163
    v_fmac_f32 v238, v20, v164
    v_fmac_f32 v240, v28, v164
    v_fmac_f32 v238, v21, v165
    v_fmac_f32 v240, v29, v165
    v_fmac_f32 v238, v22, v166
    v_fmac_f32 v240, v30, v166
    v_fmac_f32 v238, v23, v167
    v_fmac_f32 v240, v31, v167
    v_mul_f32 v235, v32, v152
    v_mul_f32 v237, v40, v120
    v_fmac_f32 v235, v33, v153
    v_fmac_f32 v237, v41, v121
    v_fmac_f32 v235, v34, v154
    v_fmac_f32 v237, v42, v122
    v_fmac_f32 v235, v35, v155
    v_fmac_f32 v237, v43, v123
    v_fmac_f32 v235, v36, v156
    v_fmac_f32 v237, v44, v124
    v_fmac_f32 v235, v37, v157
    v_fmac_f32 v237, v45, v125
    v_fmac_f32 v235, v38, v158
    v_fmac_f32 v237, v46, v126
    v_fmac_f32 v235, v39, v159
    v_fmac_f32 v237, v47, v127
    v_mul_f32 v239, v48, v168
    v_mul_f32 v241, v56, v168
    s_setprio 1
    s_waitcnt vmcnt(4) lgkmcnt(0)
    v_mfma_f32_32x32x16_bf16 v[0:15], v[64:67], v[176:179], 0
    ds_read_b64_tr_b16 v[184:185], v246 offset:2048
    ds_read_b64_tr_b16 v[186:187], v246 offset:2560
    ds_read_b64_tr_b16 v[188:189], v247 offset:2048
    ds_read_b64_tr_b16 v[190:191], v247 offset:2560
    v_fmac_f32 v239, v49, v169
    v_fmac_f32 v241, v57, v169
    s_mov_b32 m0, s68
    v_mfma_f32_32x32x16_bf16 v[16:31], v[68:71], v[176:179], 0
    buffer_load_dwordx4 v222, s[4:7], s43 offen lds
    buffer_load_dwordx4 v223, s[72:75], s43 offen offset:1024 lds
    v_fmac_f32 v239, v50, v170
    v_fmac_f32 v241, v58, v170
    v_fmac_f32 v239, v51, v171
    v_fmac_f32 v241, v59, v171
    v_fmac_f32 v239, v52, v172
    v_mfma_f32_32x32x16_bf16 v[32:47], v[64:67], v[180:183], 0
    v_fmac_f32 v241, v60, v172
    v_fmac_f32 v239, v53, v173
    v_fmac_f32 v241, v61, v173
    v_fmac_f32 v239, v54, v174
    v_fmac_f32 v241, v62, v174
    v_fmac_f32 v239, v55, v175
    v_fmac_f32 v241, v63, v175
    v_mfma_f32_32x32x16_bf16 v[48:63], v[68:71], v[180:183], 0
    v_permlane32_swap_b32 v234, v235
    v_add_f32 v234, v234, v235
    s_waitcnt vmcnt(4) lgkmcnt(0)
    v_mfma_f32_32x32x16_bf16 v[0:15], v[72:75], v[184:187], v[0:15]
    ds_read_b64_tr_b16 v[176:177], v246 offset:4096
    ds_read_b64_tr_b16 v[178:179], v246 offset:4608
    ds_read_b64_tr_b16 v[180:181], v247 offset:4096
    ds_read_b64_tr_b16 v[182:183], v247 offset:4608
    s_mov_b32 m0, s69
    v_mfma_f32_32x32x16_bf16 v[16:31], v[76:79], v[184:187], v[16:31]
    buffer_load_dwordx4 v224, s[4:7], s43 offen lds
    buffer_load_dwordx4 v225, s[72:75], s43 offen offset:1024 lds
    v_mfma_f32_32x32x16_bf16 v[32:47], v[72:75], v[188:191], v[32:47]
    v_mfma_f32_32x32x16_bf16 v[48:63], v[76:79], v[188:191], v[48:63]
    s_waitcnt vmcnt(4) lgkmcnt(0)
    v_mfma_f32_32x32x16_bf16 v[0:15], v[80:83], v[176:179], v[0:15]
    ds_read_b64_tr_b16 v[184:185], v246 offset:6144
    ds_read_b64_tr_b16 v[186:187], v246 offset:6656
    ds_read_b64_tr_b16 v[188:189], v247 offset:6144
    ds_read_b64_tr_b16 v[190:191], v247 offset:6656
    s_mov_b32 m0, s70
    v_mfma_f32_32x32x16_bf16 v[16:31], v[84:87], v[176:179], v[16:31]
    buffer_load_dwordx4 v226, s[4:7], s43 offen lds
    buffer_load_dwordx4 v227, s[72:75], s43 offen offset:1024 lds
    v_mfma_f32_32x32x16_bf16 v[32:47], v[80:83], v[180:183], v[32:47]
    v_add_u32 v222, s48, v251
    ds_read_b32 v222, v222
    v_mfma_f32_32x32x16_bf16 v[48:63], v[84:87], v[180:183], v[48:63]
    s_waitcnt vmcnt(4) lgkmcnt(1)
    v_mfma_f32_32x32x16_bf16 v[0:15], v[88:91], v[184:187], v[0:15]
    ds_read_b64_tr_b16 v[176:177], v246 offset:0
    ds_read_b64_tr_b16 v[178:179], v246 offset:512
    ds_read_b64_tr_b16 v[180:181], v247 offset:0
    ds_read_b64_tr_b16 v[182:183], v247 offset:512
    s_mov_b32 m0, s71
    v_mfma_f32_32x32x16_bf16 v[16:31], v[92:95], v[184:187], v[16:31]
    buffer_load_dwordx4 v228, s[4:7], s43 offen lds
    buffer_load_dwordx4 v229, s[72:75], s43 offen offset:1024 lds
    s_waitcnt lgkmcnt(4)
    v_mad_u32_u16 v223, v222, s39, v248 op_sel:[1,0,0,0]
    v_mad_u32_u16 v222, v222, s39, v248
    v_mfma_f32_32x32x16_bf16 v[32:47], v[88:91], v[188:191], v[32:47]
    v_add_u32 v224, s49, v251
    ds_read_b32 v224, v224
    v_mul_f32 v242, v0, v144
    v_fma_f32 v238, v8, v160, -v238
    v_fmac_f32 v242, v1, v145
    v_fmac_f32 v238, v9, v161
    v_fmac_f32 v242, v2, v146
    v_mfma_f32_32x32x16_bf16 v[48:63], v[92:95], v[188:191], v[48:63]
    s_setprio 0
    v_fmac_f32 v238, v10, v162
    v_fmac_f32 v242, v3, v147
    v_fmac_f32 v238, v11, v163
    v_fmac_f32 v242, v4, v148
    v_fmac_f32 v238, v12, v164
    v_fmac_f32 v242, v5, v149
    v_fmac_f32 v238, v13, v165
    v_fmac_f32 v242, v6, v150
    v_fmac_f32 v238, v14, v166
    v_fmac_f32 v242, v7, v151
    v_fmac_f32 v238, v15, v167
    v_fmac_f32 v236, v16, v112
    v_mul_f32 v244, v24, v160
    v_fmac_f32 v236, v17, v113
    v_fmac_f32 v244, v25, v161
    v_fmac_f32 v236, v18, v114
    v_fmac_f32 v244, v26, v162
    v_fmac_f32 v236, v19, v115
    v_fmac_f32 v244, v27, v163
    v_fmac_f32 v236, v20, v116
    v_fmac_f32 v244, v28, v164
    v_fmac_f32 v236, v21, v117
    v_fmac_f32 v244, v29, v165
    v_fmac_f32 v236, v22, v118
    v_fmac_f32 v244, v30, v166
    v_fmac_f32 v236, v23, v119
    v_fmac_f32 v244, v31, v167
    v_mul_f32 v243, v32, v152
    v_fma_f32 v239, v40, v168, -v239
    v_fmac_f32 v243, v33, v153
    v_fmac_f32 v239, v41, v169
    v_fmac_f32 v243, v34, v154
    v_fmac_f32 v239, v42, v170
    v_fmac_f32 v243, v35, v155
    v_fmac_f32 v239, v43, v171
    v_fmac_f32 v243, v36, v156
    v_fmac_f32 v239, v44, v172
    v_fmac_f32 v243, v37, v157
    v_fmac_f32 v239, v45, v173
    v_fmac_f32 v243, v38, v158
    v_fmac_f32 v239, v46, v174
    v_fmac_f32 v243, v39, v159
    v_fmac_f32 v239, v47, v175
    v_fmac_f32 v237, v48, v120
    v_mul_f32 v245, v56, v168
    v_fmac_f32 v237, v49, v121
    v_fmac_f32 v245, v57, v169
    v_fmac_f32 v237, v50, v122
    v_fmac_f32 v245, v58, v170
    v_fmac_f32 v237, v51, v123
    s_setprio 1
    s_waitcnt vmcnt(4) lgkmcnt(1)
    v_mfma_f32_32x32x16_bf16 v[0:15], v[64:67], v[176:179], 0
    ds_read_b64_tr_b16 v[184:185], v246 offset:2048
    ds_read_b64_tr_b16 v[186:187], v246 offset:2560
    ds_read_b64_tr_b16 v[188:189], v247 offset:2048
    ds_read_b64_tr_b16 v[190:191], v247 offset:2560
    v_fmac_f32 v245, v59, v171
    v_fmac_f32 v237, v52, v124
    s_mov_b32 m0, s68
    v_mfma_f32_32x32x16_bf16 v[16:31], v[68:71], v[176:179], 0
    buffer_load_dwordx4 v222, s[4:7], s44 offen lds
    buffer_load_dwordx4 v223, s[72:75], s44 offen offset:1024 lds
    s_waitcnt lgkmcnt(4)
    v_mad_u32_u16 v225, v224, s39, v248 op_sel:[1,0,0,0]
    v_mad_u32_u16 v224, v224, s39, v248
    v_fmac_f32 v245, v60, v172
    v_fmac_f32 v237, v53, v125
    v_mfma_f32_32x32x16_bf16 v[32:47], v[64:67], v[180:183], 0
    v_add_u32 v226, s50, v251
    ds_read_b32 v226, v226
    v_fmac_f32 v245, v61, v173
    v_fmac_f32 v237, v54, v126
    v_fmac_f32 v245, v62, v174
    v_fmac_f32 v237, v55, v127
    v_fmac_f32 v245, v63, v175
    v_mfma_f32_32x32x16_bf16 v[48:63], v[68:71], v[180:183], 0
    v_permlane32_swap_b32 v238, v239
    v_permlane32_swap_b32 v242, v243
    v_add_f32 v238, v238, v239
    v_add_f32 v242, v242, v243
    s_waitcnt vmcnt(4) lgkmcnt(1)
    v_mfma_f32_32x32x16_bf16 v[0:15], v[72:75], v[184:187], v[0:15]
    ds_read_b64_tr_b16 v[176:177], v246 offset:4096
    ds_read_b64_tr_b16 v[178:179], v246 offset:4608
    ds_read_b64_tr_b16 v[180:181], v247 offset:4096
    ds_read_b64_tr_b16 v[182:183], v247 offset:4608
    v_cvt_pk_bf16_f32 v234, v234, v242
    ds_write_b16 v230, v234 offset:384
    s_mov_b32 m0, s69
    v_mfma_f32_32x32x16_bf16 v[16:31], v[76:79], v[184:187], v[16:31]
    buffer_load_dwordx4 v224, s[4:7], s45 offen lds
    buffer_load_dwordx4 v225, s[72:75], s45 offen offset:1024 lds
    s_waitcnt lgkmcnt(5)
    v_mad_u32_u16 v227, v226, s39, v248 op_sel:[1,0,0,0]
    v_mad_u32_u16 v226, v226, s39, v248
    ds_write_b16_d16_hi v230, v234 offset:768
    v_mfma_f32_32x32x16_bf16 v[32:47], v[72:75], v[188:191], v[32:47]
    v_add_u32 v228, s51, v251
    ds_read_b32 v228, v228
    v_mfma_f32_32x32x16_bf16 v[48:63], v[76:79], v[188:191], v[48:63]
    s_waitcnt vmcnt(4) lgkmcnt(3)
    v_mfma_f32_32x32x16_bf16 v[0:15], v[80:83], v[176:179], v[0:15]
    ds_read_b64_tr_b16 v[184:185], v246 offset:6144
    ds_read_b64_tr_b16 v[186:187], v246 offset:6656
    ds_read_b64_tr_b16 v[188:189], v247 offset:6144
    ds_read_b64_tr_b16 v[190:191], v247 offset:6656
    s_mov_b32 m0, s70
    v_mfma_f32_32x32x16_bf16 v[16:31], v[84:87], v[176:179], v[16:31]
    buffer_load_dwordx4 v226, s[4:7], s46 offen lds
    buffer_load_dwordx4 v227, s[72:75], s46 offen offset:1024 lds
    s_waitcnt lgkmcnt(4)
    v_mad_u32_u16 v229, v228, s39, v248 op_sel:[1,0,0,0]
    v_mad_u32_u16 v228, v228, s39, v248
    v_mfma_f32_32x32x16_bf16 v[32:47], v[80:83], v[180:183], v[32:47]
    v_mfma_f32_32x32x16_bf16 v[48:63], v[84:87], v[180:183], v[48:63]
    s_waitcnt vmcnt(4) lgkmcnt(0)
    v_mfma_f32_32x32x16_bf16 v[0:15], v[88:91], v[184:187], v[0:15]
    ds_read_b64_tr_b16 v[176:177], v246 offset:0
    ds_read_b64_tr_b16 v[178:179], v246 offset:512
    ds_read_b64_tr_b16 v[180:181], v247 offset:0
    ds_read_b64_tr_b16 v[182:183], v247 offset:512
    s_mov_b32 m0, s71
    v_mfma_f32_32x32x16_bf16 v[16:31], v[92:95], v[184:187], v[16:31]
    buffer_load_dwordx4 v228, s[4:7], s47 offen lds
    buffer_load_dwordx4 v229, s[72:75], s47 offen offset:1024 lds
    v_mfma_f32_32x32x16_bf16 v[32:47], v[88:91], v[188:191], v[32:47]
    s_nop 2
    v_mul_f32 v242, v0, v144
    v_fma_f32 v240, v8, v160, -v240
    v_fmac_f32 v242, v1, v145
    v_fmac_f32 v240, v9, v161
    v_fmac_f32 v242, v2, v146
    v_fmac_f32 v240, v10, v162
    v_fmac_f32 v242, v3, v147
    v_mfma_f32_32x32x16_bf16 v[48:63], v[92:95], v[188:191], v[48:63]
    s_setprio 0
    v_fmac_f32 v240, v11, v163
    v_fmac_f32 v242, v4, v148
    v_fmac_f32 v240, v12, v164
    v_fmac_f32 v242, v5, v149
    v_fmac_f32 v240, v13, v165
    v_fmac_f32 v242, v6, v150
    v_fmac_f32 v240, v14, v166
    v_fmac_f32 v242, v7, v151
    v_fmac_f32 v240, v15, v167
    s_sub_u32 s58, s48, s29
    v_add_u32 v249, s58, v249
    v_add_u32 v250, s58, v250
    v_fma_f32 v244, v16, v160, -v244
    v_fmac_f32 v236, v24, v112
    v_fmac_f32 v244, v17, v161
    v_fmac_f32 v236, v25, v113
    v_fmac_f32 v244, v18, v162
    v_fmac_f32 v236, v26, v114
    v_fmac_f32 v244, v19, v163
    v_fmac_f32 v236, v27, v115
    v_fmac_f32 v244, v20, v164
    v_fmac_f32 v236, v28, v116
    v_fmac_f32 v244, v21, v165
    v_fmac_f32 v236, v29, v117
    v_fmac_f32 v244, v22, v166
    v_fmac_f32 v236, v30, v118
    v_fmac_f32 v244, v23, v167
    v_fmac_f32 v236, v31, v119
    ds_read_b64_tr_b16 v[0:1], v249 offset:0
    ds_read_b64_tr_b16 v[2:3], v249 offset:128
    ds_read_b128 v[4:7], v250 offset:0
    ds_read_b128 v[8:11], v250 offset:16
    ds_read_b128 v[12:15], v250 offset:384
    ds_read_b128 v[16:19], v250 offset:400
    v_mul_f32 v243, v32, v152
    v_fma_f32 v241, v40, v168, -v241
    v_fmac_f32 v243, v33, v153
    v_fmac_f32 v241, v41, v169
    v_fmac_f32 v243, v34, v154
    v_fmac_f32 v241, v42, v170
    v_fmac_f32 v243, v35, v155
    v_fmac_f32 v241, v43, v171
    v_fmac_f32 v243, v36, v156
    v_fmac_f32 v241, v44, v172
    v_fmac_f32 v243, v37, v157
    v_fmac_f32 v241, v45, v173
    v_fmac_f32 v243, v38, v158
    v_fmac_f32 v241, v46, v174
    v_fmac_f32 v243, v39, v159
    v_fmac_f32 v241, v47, v175
    ds_read_b64_tr_b16 v[20:21], v249 offset:512
    ds_read_b64_tr_b16 v[22:23], v249 offset:640
    ds_read_b128 v[24:27], v250 offset:64
    ds_read_b128 v[28:31], v250 offset:80
    ds_read_b128 v[32:35], v250 offset:448
    ds_read_b128 v[36:39], v250 offset:464
    v_fma_f32 v245, v48, v168, -v245
    v_fmac_f32 v237, v56, v120
    v_fmac_f32 v245, v49, v169
    v_fmac_f32 v237, v57, v121
    v_fmac_f32 v245, v50, v170
    v_fmac_f32 v237, v58, v122
    v_fmac_f32 v245, v51, v171
    v_fmac_f32 v237, v59, v123
    v_fmac_f32 v245, v52, v172
    v_fmac_f32 v237, v60, v124
    v_fmac_f32 v245, v53, v173
    v_fmac_f32 v237, v61, v125
    v_fmac_f32 v245, v54, v174
    v_fmac_f32 v237, v62, v126
    v_fmac_f32 v245, v55, v175
    v_fmac_f32 v237, v63, v127
    s_cmp_eq_u32 s36, 0
    s_cbranch_scc1 K2_TAIL
    s_mov_b32 s29, s48
    s_mov_b32 s32, s31
    s_mov_b32 s30, s3
    s_mov_b32 s31, s35
    s_cmp_eq_u32 s33, 2
    s_cbranch_scc1 K2_U21
    s_cmp_eq_u32 s33, 3
    s_cbranch_scc1 K2_U31
    s_cmp_eq_u32 s33, 1
    s_cbranch_scc1 K2_U11
    s_branch K2_U41
K2_SWITCH:
    v_permlane32_swap_b32 v242, v243
    v_permlane32_swap_b32 v240, v241
    v_permlane32_swap_b32 v236, v237
    v_permlane32_swap_b32 v244, v245
    v_add_f32 v242, v242, v243
    v_add_f32 v240, -v240, -v241
    v_add_f32 v236, v236, v237
    v_add_f32 v244, v244, v245
    s_set_gpr_idx_on s31, gpr_idx(DST)
    s_nop 0
    v_cvt_pk_bf16_f32 v195, v242, v236
    v_cvt_pk_bf16_f32 v196, v244, v240
    v_cvt_pk_bf16_f32 v197, v238, v238
    s_set_gpr_idx_off
    s_cmp_eq_u32 s36, 0
    s_cbranch_scc1 K2_TAIL2
    v_lshlrev_b32 v254, 3, v252
    v_add_u32 v230, s35, v252
    s_mov_b32 s58, 7131136
    buffer_load_dwordx4 v[96:99], v254, s[8:11], s58 offen offset:0 sc1
    buffer_load_dwordx4 v[100:103], v254, s[8:11], s58 offen offset:1024 sc1
    buffer_load_dwordx4 v[104:107], v254, s[8:11], s58 offen offset:2048 sc1
    buffer_load_dwordx4 v[108:111], v254, s[8:11], s58 offen offset:3072 sc1
    s_mov_b32 s58, 7135232
    buffer_load_dwordx4 v[112:115], v254, s[8:11], s58 offen offset:0 sc1
    buffer_load_dwordx4 v[116:119], v254, s[8:11], s58 offen offset:1024 sc1
    buffer_load_dwordx4 v[120:123], v254, s[8:11], s58 offen offset:2048 sc1
    buffer_load_dwordx4 v[124:127], v254, s[8:11], s58 offen offset:3072 sc1
    s_mov_b32 s58, 7139328
    buffer_load_dwordx4 v[128:131], v254, s[8:11], s58 offen offset:0 sc1
    buffer_load_dwordx4 v[132:135], v254, s[8:11], s58 offen offset:1024 sc1
    buffer_load_dwordx4 v[136:139], v254, s[8:11], s58 offen offset:2048 sc1
    buffer_load_dwordx4 v[140:143], v254, s[8:11], s58 offen offset:3072 sc1
    s_mov_b32 s58, 7143424
    buffer_load_dwordx4 v[144:147], v254, s[8:11], s58 offen offset:0 sc1
    buffer_load_dwordx4 v[148:151], v254, s[8:11], s58 offen offset:1024 sc1
    buffer_load_dwordx4 v[152:155], v254, s[8:11], s58 offen offset:2048 sc1
    buffer_load_dwordx4 v[156:159], v254, s[8:11], s58 offen offset:3072 sc1
    s_mov_b32 s58, 7147520
    buffer_load_dwordx4 v[160:163], v254, s[8:11], s58 offen offset:0 sc1
    buffer_load_dwordx4 v[164:167], v254, s[8:11], s58 offen offset:1024 sc1
    buffer_load_dwordx4 v[168:171], v254, s[8:11], s58 offen offset:2048 sc1
    buffer_load_dwordx4 v[172:175], v254, s[8:11], s58 offen offset:3072 sc1
    s_movk_i32 s40, 128
    s_movk_i32 s41, 384
    s_movk_i32 s42, 640
    s_movk_i32 s43, 896
    s_cmp_lg_u32 s33, 1
    s_cbranch_scc1 K2_SW2
    s_waitcnt vmcnt(0)
K2_SW2:
    s_mov_b32 s29, s48
    s_mov_b32 s32, s31
    s_mov_b32 s30, s3
    s_mov_b32 s31, s35
    s_cmp_eq_u32 s33, 2
    s_cbranch_scc1 K2_U21
    s_cmp_eq_u32 s33, 3
    s_cbranch_scc1 K2_U31
    s_cmp_eq_u32 s33, 1
    s_cbranch_scc1 K2_U11
    s_branch K2_U41
K2_WINDOW:
    s_mov_b32 s24, 0
    s_mov_b32 s25, 1
K2_LOAD:
    v_mbcnt_lo_u32_b32 v176, -1, 0
    v_mbcnt_hi_u32_b32 v176, -1, v176
    s_lshl_b32 s58, s20, 6
    v_add_u32 v177, s58, v176
    v_lshlrev_b32 v70, 4, v176
    s_mov_b32 s58, 7110656
    buffer_load_dwordx4 v[96:99], v70, s[8:11], s58 offen offset:0 sc1
    buffer_load_dwordx4 v[100:103], v70, s[8:11], s58 offen offset:1024 sc1
    buffer_load_dwordx4 v[104:107], v70, s[8:11], s58 offen offset:2048 sc1
    buffer_load_dwordx4 v[108:111], v70, s[8:11], s58 offen offset:3072 sc1
    s_mov_b32 s58, 7114752
    buffer_load_dwordx4 v[112:115], v70, s[8:11], s58 offen offset:0 sc1
    buffer_load_dwordx4 v[116:119], v70, s[8:11], s58 offen offset:1024 sc1
    buffer_load_dwordx4 v[120:123], v70, s[8:11], s58 offen offset:2048 sc1
    buffer_load_dwordx4 v[124:127], v70, s[8:11], s58 offen offset:3072 sc1
    s_mov_b32 s58, 7118848
    buffer_load_dwordx4 v[128:131], v70, s[8:11], s58 offen offset:0 sc1
    buffer_load_dwordx4 v[132:135], v70, s[8:11], s58 offen offset:1024 sc1
    buffer_load_dwordx4 v[136:139], v70, s[8:11], s58 offen offset:2048 sc1
    buffer_load_dwordx4 v[140:143], v70, s[8:11], s58 offen offset:3072 sc1
    s_mov_b32 s58, 7122944
    buffer_load_dwordx4 v[144:147], v70, s[8:11], s58 offen offset:0 sc1
    buffer_load_dwordx4 v[148:151], v70, s[8:11], s58 offen offset:1024 sc1
    buffer_load_dwordx4 v[152:155], v70, s[8:11], s58 offen offset:2048 sc1
    buffer_load_dwordx4 v[156:159], v70, s[8:11], s58 offen offset:3072 sc1
    s_mov_b32 s58, 7127040
    buffer_load_dwordx4 v[160:163], v70, s[8:11], s58 offen offset:0 sc1
    buffer_load_dwordx4 v[164:167], v70, s[8:11], s58 offen offset:1024 sc1
    buffer_load_dwordx4 v[168:171], v70, s[8:11], s58 offen offset:2048 sc1
    buffer_load_dwordx4 v[172:175], v70, s[8:11], s58 offen offset:3072 sc1
    v_mul_u32_u24 v76, 437, v177
    v_lshrrev_b32 v76, 16, v76
    v_mul_u32_u24 v76, 150, v76
    v_sub_u32 v76, v177, v76
    v_mov_b32 v80, -1
    v_mov_b32 v77, 1.0
    v_cmp_gt_u32 vcc, 48, v76
    v_lshlrev_b32 v78, 4, v177
    v_add_u32 v78, 65536, v78
    v_cndmask_b32 v80, v80, 0, vcc
    v_cmp_gt_u32 vcc, 12, v76
    v_add_u32 v79, 64800, v78
    s_nop 0
    v_cndmask_b32 v80, v80, v77, vcc
    v_cmp_gt_u32 vcc, 450, v177
    v_mov_b32 v81, v80
    v_mov_b32 v82, v80
    v_mov_b32 v83, v80
    s_mov_b64 exec, vcc
    ds_write_b128 v78, v[80:83] offset:0
    ds_write_b128 v78, v[80:83] offset:7200
    ds_write_b128 v78, v[80:83] offset:14400
    ds_write_b128 v78, v[80:83] offset:21600
    ds_write_b128 v78, v[80:83] offset:28800
    ds_write_b128 v78, v[80:83] offset:36000
    ds_write_b128 v78, v[80:83] offset:43200
    ds_write_b128 v78, v[80:83] offset:50400
    ds_write_b128 v78, v[80:83] offset:57600
    ds_write_b128 v79, v[80:83] offset:0
    ds_write_b128 v79, v[80:83] offset:7200
    ds_write_b128 v79, v[80:83] offset:14400
    ds_write_b128 v79, v[80:83] offset:21600
    v_cmp_gt_u32 vcc, 268, v177
    s_nop 0
    s_cbranch_vccz K2_NOCL
    s_mov_b64 exec, vcc
    ds_write_b128 v79, v[80:83] offset:28800
K2_NOCL:
    s_mov_b64 exec, -1
    s_cmp_lg_u32 s20, 7
    s_cbranch_scc1 K2_NOH
    v_mov_b32 v76, 0
    v_mov_b32 v77, -1
    v_lshlrev_b32 v78, 2, v176
    v_add_u32 v78, 163424, v78
    s_mov_b64 exec, 0x1ff
    ds_write_b32 v78, v76 offset:192
    s_mov_b64 exec, 0xff
    ds_write_b32 v78, v77 offset:256
    s_mov_b64 exec, -1
    s_cmp_lg_u32 s24, 0
    s_cbranch_scc1 K2_NOH
    s_mov_b32 exec_hi, 0xffff
    ds_write_b32 v78, v76
    s_mov_b64 exec, 1
    ds_write_b32 v78, v76 offset:228
    s_mov_b64 exec, -1
K2_NOH:
    s_waitcnt lgkmcnt(0)
    s_barrier
    s_branch K2_CELLS
K2_RETRY:
    s_sub_u32 s60, s60, 1
    s_cbranch_scc1 K2_END
    s_branch K2_RELOAD
K2_FLGCK:
    s_cmp_eq_u32 s28, 0
    s_cbranch_scc1 K2_FLGOK
    s_mov_b32 s60, 0x100000
K2_FLGW:
    v_xor_b32 v84, s2, v84
    v_xor_b32 v85, s2, v85
    v_xor_b32 v86, s2, v86
    v_xor_b32 v87, s2, v87
    v_or3_b32 v84, v84, v85, v86
    v_or_b32 v84, v84, v87
    v_cmp_ne_u32 vcc, 0, v84
    s_nop 0
    s_and_b32 vcc_hi, vcc_hi, 0x3ffff
    s_cmp_eq_u64 vcc, 0
    s_cbranch_scc1 K2_FLGOK
    s_sub_u32 s60, s60, 1
    s_cbranch_scc1 K2_END
    buffer_load_dwordx4 v[84:87], v72, s[8:11], s67 offen sc1
    s_waitcnt vmcnt(0)
    s_branch K2_FLGW
K2_BIG:
    s_cmp_lg_u32 s24, 0
    s_cbranch_scc1 K2_TOK
    s_mov_b64 s[62:63], vcc
    s_bcnt1_i32_b64 s60, vcc
    s_cmp_eq_u32 s22, 39
    s_cselect_b32 s61, 5, 2
    s_cmp_gt_u32 s60, s61
    s_cbranch_scc1 K2_SLOW
    v_cmp_lt_u32 vcc, 64, v193
    s_nop 0
    s_cbranch_vccnz K2_SLOW
    v_mbcnt_lo_u32_b32 v197, s62, 0
    v_mbcnt_hi_u32_b32 v197, s63, v197
    v_lshlrev_b32 v198, 27, v197
    v_cndmask_b32 v198, 0, v198, s[62:63]
    s_movk_i32 s26, 64
    v_cmp_le_u32 vcc, 2, v197
    v_mov_b32 v194, 161536
    v_mov_b32 v196, -8229472
    v_cndmask_b32 v194, v194, v196, vcc
    v_lshl_add_u32 v197, v197, 22, v194
    v_mov_b32 v203, v193
    v_mov_b32 v204, v195
    v_mov_b32 v205, v197
    s_mov_b32 s60, 6991
    v_cmp_lt_i32 vcc, 0, v180
    s_nop 0
    s_cbranch_vccz K2_OV_DONE
    v_subrev_u32 v192, 65536, v50
    v_mul_hi_u32_u24 v193, s60, v192
    v_mul_u32_u24 v192, s60, v192
    v_alignbit_b32 v192, v193, v192, 24
    v_lshlrev_b32 v192, 2, v192
    ds_bpermute_b32 v199, v192, v205
    v_subrev_u32 v192, 48, v40
    v_cmp_gt_u32 s[62:63], 16, v192
    s_waitcnt lgkmcnt(0)
    s_and_b64 exec, vcc, s[62:63]
    s_cbranch_execz K2_ov_11
    v_lshrrev_b32 v193, 18, v199
    v_add_u32 v192, v192, v193
    v_and_b32 v199, 0x3ffff, v199
    v_lshl_add_u32 v194, v192, 5, v199
    v_lshl_add_u32 v195, v192, 2, v199
    v_and_b32 v196, 7, v192
    v_add_lshl_u32 v196, v196, v192, 1
    v_bfe_u32 v193, v192, 3, 1
    v_mad_i32_i24 v196, v193, -14, v196
    v_add_u32 v196, v196, v199
    ds_write_b32 v194, v60 offset:864
    ds_write2_b32 v195, v0, v1 offset0:48 offset1:96
    ds_write_b32 v195, v2 offset:576
    ds_write_b16 v196, v3 offset:768
K2_ov_11:
    s_mov_b64 exec, -1
    v_cmp_lt_i32 vcc, 2, v180
    s_nop 0
    s_cbranch_vccz K2_OV_DONE
    v_subrev_u32 v192, 65536, v51
    v_mul_hi_u32_u24 v193, s60, v192
    v_mul_u32_u24 v192, s60, v192
    v_alignbit_b32 v192, v193, v192, 24
    v_lshlrev_b32 v192, 2, v192
    ds_bpermute_b32 v199, v192, v205
    v_subrev_u32 v192, 48, v41
    v_cmp_gt_u32 s[62:63], 16, v192
    s_waitcnt lgkmcnt(0)
    s_and_b64 exec, vcc, s[62:63]
    s_cbranch_execz K2_ov_12
    v_lshrrev_b32 v193, 18, v199
    v_add_u32 v192, v192, v193
    v_and_b32 v199, 0x3ffff, v199
    v_lshl_add_u32 v194, v192, 5, v199
    v_lshl_add_u32 v195, v192, 2, v199
    v_and_b32 v196, 7, v192
    v_add_lshl_u32 v196, v196, v192, 1
    v_bfe_u32 v193, v192, 3, 1
    v_mad_i32_i24 v196, v193, -14, v196
    v_add_u32 v196, v196, v199
    ds_write_b32 v194, v61 offset:864
    ds_write2_b32 v195, v4, v5 offset0:48 offset1:96
    ds_write_b32 v195, v6 offset:576
    ds_write_b16 v196, v7 offset:768
K2_ov_12:
    s_mov_b64 exec, -1
    v_cmp_lt_i32 vcc, 4, v180
    s_nop 0
    s_cbranch_vccz K2_OV_DONE
    v_subrev_u32 v192, 65536, v52
    v_mul_hi_u32_u24 v193, s60, v192
    v_mul_u32_u24 v192, s60, v192
    v_alignbit_b32 v192, v193, v192, 24
    v_lshlrev_b32 v192, 2, v192
    ds_bpermute_b32 v199, v192, v205
    v_subrev_u32 v192, 48, v42
    v_cmp_gt_u32 s[62:63], 16, v192
    s_waitcnt lgkmcnt(0)
    s_and_b64 exec, vcc, s[62:63]
    s_cbranch_execz K2_ov_13
    v_lshrrev_b32 v193, 18, v199
    v_add_u32 v192, v192, v193
    v_and_b32 v199, 0x3ffff, v199
    v_lshl_add_u32 v194, v192, 5, v199
    v_lshl_add_u32 v195, v192, 2, v199
    v_and_b32 v196, 7, v192
    v_add_lshl_u32 v196, v196, v192, 1
    v_bfe_u32 v193, v192, 3, 1
    v_mad_i32_i24 v196, v193, -14, v196
    v_add_u32 v196, v196, v199
    ds_write_b32 v194, v62 offset:864
    ds_write2_b32 v195, v8, v9 offset0:48 offset1:96
    ds_write_b32 v195, v10 offset:576
    ds_write_b16 v196, v11 offset:768
K2_ov_13:
    s_mov_b64 exec, -1
    v_cmp_lt_i32 vcc, 6, v180
    s_nop 0
    s_cbranch_vccz K2_OV_DONE
    v_subrev_u32 v192, 65536, v53
    v_mul_hi_u32_u24 v193, s60, v192
    v_mul_u32_u24 v192, s60, v192
    v_alignbit_b32 v192, v193, v192, 24
    v_lshlrev_b32 v192, 2, v192
    ds_bpermute_b32 v199, v192, v205
    v_subrev_u32 v192, 48, v43
    v_cmp_gt_u32 s[62:63], 16, v192
    s_waitcnt lgkmcnt(0)
    s_and_b64 exec, vcc, s[62:63]
    s_cbranch_execz K2_ov_14
    v_lshrrev_b32 v193, 18, v199
    v_add_u32 v192, v192, v193
    v_and_b32 v199, 0x3ffff, v199
    v_lshl_add_u32 v194, v192, 5, v199
    v_lshl_add_u32 v195, v192, 2, v199
    v_and_b32 v196, 7, v192
    v_add_lshl_u32 v196, v196, v192, 1
    v_bfe_u32 v193, v192, 3, 1
    v_mad_i32_i24 v196, v193, -14, v196
    v_add_u32 v196, v196, v199
    ds_write_b32 v194, v63 offset:864
    ds_write2_b32 v195, v12, v13 offset0:48 offset1:96
    ds_write_b32 v195, v14 offset:576
    ds_write_b16 v196, v15 offset:768
K2_ov_14:
    s_mov_b64 exec, -1
    v_cmp_lt_i32 vcc, 8, v180
    s_nop 0
    s_cbranch_vccz K2_OV_DONE
    v_subrev_u32 v192, 65536, v54
    v_mul_hi_u32_u24 v193, s60, v192
    v_mul_u32_u24 v192, s60, v192
    v_alignbit_b32 v192, v193, v192, 24
    v_lshlrev_b32 v192, 2, v192
    ds_bpermute_b32 v199, v192, v205
    v_subrev_u32 v192, 48, v44
    v_cmp_gt_u32 s[62:63], 16, v192
    s_waitcnt lgkmcnt(0)
    s_and_b64 exec, vcc, s[62:63]
    s_cbranch_execz K2_ov_15
    v_lshrrev_b32 v193, 18, v199
    v_add_u32 v192, v192, v193
    v_and_b32 v199, 0x3ffff, v199
    v_lshl_add_u32 v194, v192, 5, v199
    v_lshl_add_u32 v195, v192, 2, v199
    v_and_b32 v196, 7, v192
    v_add_lshl_u32 v196, v196, v192, 1
    v_bfe_u32 v193, v192, 3, 1
    v_mad_i32_i24 v196, v193, -14, v196
    v_add_u32 v196, v196, v199
    ds_write_b32 v194, v64 offset:864
    ds_write2_b32 v195, v16, v17 offset0:48 offset1:96
    ds_write_b32 v195, v18 offset:576
    ds_write_b16 v196, v19 offset:768
K2_ov_15:
    s_mov_b64 exec, -1
    v_cmp_lt_i32 vcc, 10, v180
    s_nop 0
    s_cbranch_vccz K2_OV_DONE
    v_subrev_u32 v192, 65536, v55
    v_mul_hi_u32_u24 v193, s60, v192
    v_mul_u32_u24 v192, s60, v192
    v_alignbit_b32 v192, v193, v192, 24
    v_lshlrev_b32 v192, 2, v192
    ds_bpermute_b32 v199, v192, v205
    v_subrev_u32 v192, 48, v45
    v_cmp_gt_u32 s[62:63], 16, v192
    s_waitcnt lgkmcnt(0)
    s_and_b64 exec, vcc, s[62:63]
    s_cbranch_execz K2_ov_16
    v_lshrrev_b32 v193, 18, v199
    v_add_u32 v192, v192, v193
    v_and_b32 v199, 0x3ffff, v199
    v_lshl_add_u32 v194, v192, 5, v199
    v_lshl_add_u32 v195, v192, 2, v199
    v_and_b32 v196, 7, v192
    v_add_lshl_u32 v196, v196, v192, 1
    v_bfe_u32 v193, v192, 3, 1
    v_mad_i32_i24 v196, v193, -14, v196
    v_add_u32 v196, v196, v199
    ds_write_b32 v194, v65 offset:864
    ds_write2_b32 v195, v20, v21 offset0:48 offset1:96
    ds_write_b32 v195, v22 offset:576
    ds_write_b16 v196, v23 offset:768
K2_ov_16:
    s_mov_b64 exec, -1
    v_cmp_lt_i32 vcc, 12, v180
    s_nop 0
    s_cbranch_vccz K2_OV_DONE
    v_subrev_u32 v192, 65536, v56
    v_mul_hi_u32_u24 v193, s60, v192
    v_mul_u32_u24 v192, s60, v192
    v_alignbit_b32 v192, v193, v192, 24
    v_lshlrev_b32 v192, 2, v192
    ds_bpermute_b32 v199, v192, v205
    v_subrev_u32 v192, 48, v46
    v_cmp_gt_u32 s[62:63], 16, v192
    s_waitcnt lgkmcnt(0)
    s_and_b64 exec, vcc, s[62:63]
    s_cbranch_execz K2_ov_17
    v_lshrrev_b32 v193, 18, v199
    v_add_u32 v192, v192, v193
    v_and_b32 v199, 0x3ffff, v199
    v_lshl_add_u32 v194, v192, 5, v199
    v_lshl_add_u32 v195, v192, 2, v199
    v_and_b32 v196, 7, v192
    v_add_lshl_u32 v196, v196, v192, 1
    v_bfe_u32 v193, v192, 3, 1
    v_mad_i32_i24 v196, v193, -14, v196
    v_add_u32 v196, v196, v199
    ds_write_b32 v194, v66 offset:864
    ds_write2_b32 v195, v24, v25 offset0:48 offset1:96
    ds_write_b32 v195, v26 offset:576
    ds_write_b16 v196, v27 offset:768
K2_ov_17:
    s_mov_b64 exec, -1
    v_cmp_lt_i32 vcc, 14, v180
    s_nop 0
    s_cbranch_vccz K2_OV_DONE
    v_subrev_u32 v192, 65536, v57
    v_mul_hi_u32_u24 v193, s60, v192
    v_mul_u32_u24 v192, s60, v192
    v_alignbit_b32 v192, v193, v192, 24
    v_lshlrev_b32 v192, 2, v192
    ds_bpermute_b32 v199, v192, v205
    v_subrev_u32 v192, 48, v47
    v_cmp_gt_u32 s[62:63], 16, v192
    s_waitcnt lgkmcnt(0)
    s_and_b64 exec, vcc, s[62:63]
    s_cbranch_execz K2_ov_18
    v_lshrrev_b32 v193, 18, v199
    v_add_u32 v192, v192, v193
    v_and_b32 v199, 0x3ffff, v199
    v_lshl_add_u32 v194, v192, 5, v199
    v_lshl_add_u32 v195, v192, 2, v199
    v_and_b32 v196, 7, v192
    v_add_lshl_u32 v196, v196, v192, 1
    v_bfe_u32 v193, v192, 3, 1
    v_mad_i32_i24 v196, v193, -14, v196
    v_add_u32 v196, v196, v199
    ds_write_b32 v194, v67 offset:864
    ds_write2_b32 v195, v28, v29 offset0:48 offset1:96
    ds_write_b32 v195, v30 offset:576
    ds_write_b16 v196, v31 offset:768
K2_ov_18:
    s_mov_b64 exec, -1
    v_cmp_lt_i32 vcc, 16, v180
    s_nop 0
    s_cbranch_vccz K2_OV_DONE
    v_subrev_u32 v192, 65536, v58
    v_mul_hi_u32_u24 v193, s60, v192
    v_mul_u32_u24 v192, s60, v192
    v_alignbit_b32 v192, v193, v192, 24
    v_lshlrev_b32 v192, 2, v192
    ds_bpermute_b32 v199, v192, v205
    v_subrev_u32 v192, 48, v48
    v_cmp_gt_u32 s[62:63], 16, v192
    s_waitcnt lgkmcnt(0)
    s_and_b64 exec, vcc, s[62:63]
    s_cbranch_execz K2_ov_19
    v_lshrrev_b32 v193, 18, v199
    v_add_u32 v192, v192, v193
    v_and_b32 v199, 0x3ffff, v199
    v_lshl_add_u32 v194, v192, 5, v199
    v_lshl_add_u32 v195, v192, 2, v199
    v_and_b32 v196, 7, v192
    v_add_lshl_u32 v196, v196, v192, 1
    v_bfe_u32 v193, v192, 3, 1
    v_mad_i32_i24 v196, v193, -14, v196
    v_add_u32 v196, v196, v199
    ds_write_b32 v194, v68 offset:864
    ds_write2_b32 v195, v32, v33 offset0:48 offset1:96
    ds_write_b32 v195, v34 offset:576
    ds_write_b16 v196, v35 offset:768
K2_ov_19:
    s_mov_b64 exec, -1
    v_cmp_lt_i32 vcc, 18, v180
    s_nop 0
    s_cbranch_vccz K2_OV_DONE
    v_subrev_u32 v192, 65536, v59
    v_mul_hi_u32_u24 v193, s60, v192
    v_mul_u32_u24 v192, s60, v192
    v_alignbit_b32 v192, v193, v192, 24
    v_lshlrev_b32 v192, 2, v192
    ds_bpermute_b32 v199, v192, v205
    v_subrev_u32 v192, 48, v49
    v_cmp_gt_u32 s[62:63], 16, v192
    s_waitcnt lgkmcnt(0)
    s_and_b64 exec, vcc, s[62:63]
    s_cbranch_execz K2_ov_20
    v_lshrrev_b32 v193, 18, v199
    v_add_u32 v192, v192, v193
    v_and_b32 v199, 0x3ffff, v199
    v_lshl_add_u32 v194, v192, 5, v199
    v_lshl_add_u32 v195, v192, 2, v199
    v_and_b32 v196, 7, v192
    v_add_lshl_u32 v196, v196, v192, 1
    v_bfe_u32 v193, v192, 3, 1
    v_mad_i32_i24 v196, v193, -14, v196
    v_add_u32 v196, v196, v199
    ds_write_b32 v194, v69 offset:864
    ds_write2_b32 v195, v36, v37 offset0:48 offset1:96
    ds_write_b32 v195, v38 offset:576
    ds_write_b16 v196, v39 offset:768
K2_ov_20:
    s_mov_b64 exec, -1
K2_OV_DONE:
    v_mov_b32 v193, v203
    v_mov_b32 v195, v204
    s_waitcnt lgkmcnt(0)
    s_barrier
    s_branch K2_TOK
K2_SLOW:
    v_mov_b32 v197, v193
    s_nop 1
    v_max_u32_dpp v197, v197, v197 row_shr:1 row_mask:0xf bank_mask:0xf bound_ctrl:0
    s_nop 1
    v_max_u32_dpp v197, v197, v197 row_shr:2 row_mask:0xf bank_mask:0xf bound_ctrl:0
    s_nop 1
    v_max_u32_dpp v197, v197, v197 row_shr:4 row_mask:0xf bank_mask:0xf bound_ctrl:0
    s_nop 1
    v_max_u32_dpp v197, v197, v197 row_shr:8 row_mask:0xf bank_mask:0xf bound_ctrl:0
    s_nop 1
    v_max_u32_dpp v197, v197, v197 row_bcast:15 row_mask:0xa bank_mask:0xf
    s_nop 1
    v_max_u32_dpp v197, v197, v197 row_bcast:31 row_mask:0xc bank_mask:0xf
    s_nop 0
    v_readlane_b32 s25, v197, 63
    s_nop 0
    s_add_u32 s25, s25, 47
    s_mul_i32 s25, s25, 43691
    s_lshr_b32 s25, s25, 21
    v_cmp_lt_i32 vcc, 0, v180
    s_nop 0
    s_cbranch_vccz K2_SV_DONE
    s_mov_b64 exec, vcc
    buffer_store_dword v40, v179, s[8:11], s66 offen offset:0
    v_cmp_lt_i32 vcc, 2, v180
    s_nop 0
    s_cbranch_vccz K2_SV_DONE
    s_mov_b64 exec, vcc
    buffer_store_dword v41, v179, s[8:11], s66 offen offset:8
    v_cmp_lt_i32 vcc, 4, v180
    s_nop 0
    s_cbranch_vccz K2_SV_DONE
    s_mov_b64 exec, vcc
    buffer_store_dword v42, v179, s[8:11], s66 offen offset:16
    v_cmp_lt_i32 vcc, 6, v180
    s_nop 0
    s_cbranch_vccz K2_SV_DONE
    s_mov_b64 exec, vcc
    buffer_store_dword v43, v179, s[8:11], s66 offen offset:24
    v_cmp_lt_i32 vcc, 8, v180
    s_nop 0
    s_cbranch_vccz K2_SV_DONE
    s_mov_b64 exec, vcc
    buffer_store_dword v44, v179, s[8:11], s66 offen offset:32
    v_cmp_lt_i32 vcc, 10, v180
    s_nop 0
    s_cbranch_vccz K2_SV_DONE
    s_mov_b64 exec, vcc
    buffer_store_dword v45, v179, s[8:11], s66 offen offset:40
    v_cmp_lt_i32 vcc, 12, v180
    s_nop 0
    s_cbranch_vccz K2_SV_DONE
    s_mov_b64 exec, vcc
    buffer_store_dword v46, v179, s[8:11], s66 offen offset:48
    v_cmp_lt_i32 vcc, 14, v180
    s_nop 0
    s_cbranch_vccz K2_SV_DONE
    s_mov_b64 exec, vcc
    buffer_store_dword v47, v179, s[8:11], s66 offen offset:56
    v_cmp_lt_i32 vcc, 16, v180
    s_nop 0
    s_cbranch_vccz K2_SV_DONE
    s_mov_b64 exec, vcc
    buffer_store_dword v48, v179, s[8:11], s66 offen offset:64
    v_cmp_lt_i32 vcc, 18, v180
    s_nop 0
    s_cbranch_vccz K2_SV_DONE
    s_mov_b64 exec, vcc
    buffer_store_dword v49, v179, s[8:11], s66 offen offset:72
K2_SV_DONE:
    s_mov_b64 exec, -1
    s_branch K2_TOK
K2_rare_21:
    s_cmp_eq_u32 s33, 4
    s_cbranch_scc1 K2_four_23
    s_mov_b32 s49, s48
    s_mov_b32 s51, s48
    s_add_u32 s45, s44, 256
    s_add_u32 s46, s44, 512
    s_add_u32 s47, s44, 768
    s_branch K2_back_22
K2_four_23:
    s_add_u32 s50, s48, 64
    s_lshr_b32 s51, s3, 27
    s_mov_b32 s66, 161536
    s_cmp_ge_u32 s51, 2
    s_cselect_b32 s66, 159072, s66
    s_mul_i32 s51, s51, 32
    s_add_u32 s51, s51, s66
    s_mov_b32 s46, s44
    s_mov_b32 s47, s44
    s_branch K2_back_22
K2_dum_24:
    v_mov_b32 v232, -1
    s_mov_b32 m0, 163712
    s_mov_b64 exec, 1
    buffer_load_dwordx4 v232, s[16:19], 0 offen lds
    buffer_load_dwordx4 v232, s[16:19], 0 offen lds
    s_mov_b64 exec, -1
    s_branch K2_back_26
K2_a4_25:
    s_lshr_b32 s65, s3, 27
    s_mov_b32 s66, 161536
    s_cmp_ge_u32 s65, 2
    s_cselect_b32 s66, 158112, s66
    s_mul_i32 s65, s65, 512
    s_add_u32 s65, s65, s66
    v_add_u32 v232, s65, v230
    ds_read_b32 v232, v232
    s_add_u32 m0, s65, 864
    s_waitcnt lgkmcnt(0)
    v_or_b32 v232, v232, v231
    buffer_load_dwordx4 v232, s[16:19], 0 offen  lds
    s_branch K2_b4_27
K2_nul_30:
    s_mov_b32 s58, 63
    s_mov_b32 s36, 0
    s_branch K2_back_33
K2_spin_31:
    v_lshl_add_u32 v233, v252, 1, s53
    ds_read_b32 v233, v233
    s_waitcnt lgkmcnt(0)
    s_branch K2_chk_32
K2_dyn_28:
    v_mov_b32 v254, 163648
    v_mov_b32 v255, 1
    v_lshl_add_u32 v233, v252, 1, s53
    s_mov_b64 exec, 1
    ds_add_rtn_u32 v232, v254, v255
    s_mov_b64 exec, -1
    ds_read_b32 v233, v233
    s_waitcnt lgkmcnt(0)
    v_readfirstlane_b32 s58, v232
    s_nop 0
    s_cmp_lt_u32 s58, s22
    s_cbranch_scc0 K2_nul_30
    s_and_b32 s59, s58, 7
    s_lshr_b32 s60, s58, 3
K2_chk_32:
    v_readlane_b32 s61, v233, s59
    s_nop 0
    s_cmp_gt_u32 s61, s60
    s_cbranch_scc0 K2_spin_31
K2_back_33:
    s_mov_b32 s34, 1
    s_branch K2_back_29
K2_rare_34:
    s_cmp_eq_u32 s33, 4
    s_cbranch_scc1 K2_four_36
    s_mov_b32 s49, s48
    s_mov_b32 s51, s48
    s_add_u32 s45, s44, 256
    s_add_u32 s46, s44, 512
    s_add_u32 s47, s44, 768
    s_branch K2_back_35
K2_four_36:
    s_add_u32 s50, s48, 64
    s_lshr_b32 s51, s3, 27
    s_mov_b32 s66, 161536
    s_cmp_ge_u32 s51, 2
    s_cselect_b32 s66, 159072, s66
    s_mul_i32 s51, s51, 32
    s_add_u32 s51, s51, s66
    s_mov_b32 s46, s44
    s_mov_b32 s47, s44
    s_branch K2_back_35
K2_dum_37:
    v_mov_b32 v232, -1
    s_mov_b32 m0, 163712
    s_mov_b64 exec, 1
    buffer_load_dwordx4 v232, s[16:19], 0 offen lds
    buffer_load_dwordx4 v232, s[16:19], 0 offen lds
    s_mov_b64 exec, -1
    s_branch K2_back_39
K2_a4_38:
    s_lshr_b32 s65, s3, 27
    s_mov_b32 s66, 161536
    s_cmp_ge_u32 s65, 2
    s_cselect_b32 s66, 158112, s66
    s_mul_i32 s65, s65, 512
    s_add_u32 s65, s65, s66
    v_add_u32 v232, s65, v230
    ds_read_b32 v232, v232
    s_add_u32 m0, s65, 864
    s_waitcnt lgkmcnt(0)
    v_or_b32 v232, v232, v231
    buffer_load_dwordx4 v232, s[16:19], 0 offen  lds
    s_branch K2_b4_40
K2_nul_43:
    s_mov_b32 s58, 63
    s_mov_b32 s36, 0
    s_branch K2_back_46
K2_spin_44:
    v_lshl_add_u32 v233, v252, 1, s53
    ds_read_b32 v233, v233
    s_waitcnt lgkmcnt(0)
    s_branch K2_chk_45
K2_dyn_41:
    v_mov_b32 v254, 163648
    v_mov_b32 v255, 1
    v_lshl_add_u32 v233, v252, 1, s53
    s_mov_b64 exec, 1
    ds_add_rtn_u32 v232, v254, v255
    s_mov_b64 exec, -1
    ds_read_b32 v233, v233
    s_waitcnt lgkmcnt(0)
    v_readfirstlane_b32 s58, v232
    s_nop 0
    s_cmp_lt_u32 s58, s22
    s_cbranch_scc0 K2_nul_43
    s_and_b32 s59, s58, 7
    s_lshr_b32 s60, s58, 3
K2_chk_45:
    v_readlane_b32 s61, v233, s59
    s_nop 0
    s_cmp_gt_u32 s61, s60
    s_cbranch_scc0 K2_spin_44
K2_back_46:
    s_mov_b32 s34, 1
    s_branch K2_back_42
K2_rare_47:
    s_cmp_eq_u32 s33, 4
    s_cbranch_scc1 K2_four_49
    s_mov_b32 s49, s48
    s_mov_b32 s51, s48
    s_add_u32 s45, s44, 256
    s_add_u32 s46, s44, 512
    s_add_u32 s47, s44, 768
    s_branch K2_back_48
K2_four_49:
    s_add_u32 s50, s48, 64
    s_lshr_b32 s51, s3, 27
    s_mov_b32 s66, 161536
    s_cmp_ge_u32 s51, 2
    s_cselect_b32 s66, 159072, s66
    s_mul_i32 s51, s51, 32
    s_add_u32 s51, s51, s66
    s_mov_b32 s46, s44
    s_mov_b32 s47, s44
    s_branch K2_back_48
K2_dum_50:
    v_mov_b32 v232, -1
    s_mov_b32 m0, 163712
    s_mov_b64 exec, 1
    buffer_load_dwordx4 v232, s[16:19], 0 offen lds
    buffer_load_dwordx4 v232, s[16:19], 0 offen lds
    s_mov_b64 exec, -1
    s_branch K2_back_52
K2_a4_51:
    s_lshr_b32 s65, s3, 27
    s_mov_b32 s66, 161536
    s_cmp_ge_u32 s65, 2
    s_cselect_b32 s66, 158112, s66
    s_mul_i32 s65, s65, 512
    s_add_u32 s65, s65, s66
    v_add_u32 v232, s65, v230
    ds_read_b32 v232, v232
    s_add_u32 m0, s65, 864
    s_waitcnt lgkmcnt(0)
    v_or_b32 v232, v232, v231
    buffer_load_dwordx4 v232, s[16:19], 0 offen  lds
    s_branch K2_b4_53
K2_nul_54:
    s_mov_b32 s58, 63
    s_mov_b32 s36, 0
    s_branch K2_back_57
K2_spin_55:
    v_lshl_add_u32 v233, v252, 1, s53
    ds_read_b32 v233, v233
    s_waitcnt lgkmcnt(0)
    s_branch K2_chk_56
K2_rare_58:
    s_cmp_eq_u32 s33, 4
    s_cbranch_scc1 K2_four_60
    s_mov_b32 s49, s48
    s_mov_b32 s51, s48
    s_add_u32 s45, s44, 256
    s_add_u32 s46, s44, 512
    s_add_u32 s47, s44, 768
    s_branch K2_back_59
K2_four_60:
    s_add_u32 s50, s48, 64
    s_lshr_b32 s51, s3, 27
    s_mov_b32 s66, 161536
    s_cmp_ge_u32 s51, 2
    s_cselect_b32 s66, 159072, s66
    s_mul_i32 s51, s51, 32
    s_add_u32 s51, s51, s66
    s_mov_b32 s46, s44
    s_mov_b32 s47, s44
    s_branch K2_back_59
K2_nul_61:
    s_mov_b32 s58, 63
    s_mov_b32 s36, 0
    s_branch K2_back_64
K2_spin_62:
    v_lshl_add_u32 v233, v252, 1, s53
    ds_read_b32 v233, v233
    s_waitcnt lgkmcnt(0)
    s_branch K2_chk_63
K2_rare_65:
    s_cmp_eq_u32 s33, 4
    s_cbranch_scc1 K2_four_67
    s_mov_b32 s49, s48
    s_mov_b32 s51, s48
    s_add_u32 s45, s44, 256
    s_add_u32 s46, s44, 512
    s_add_u32 s47, s44, 768
    s_branch K2_back_66
K2_four_67:
    s_add_u32 s50, s48, 64
    s_lshr_b32 s51, s3, 27
    s_mov_b32 s66, 161536
    s_cmp_ge_u32 s51, 2
    s_cselect_b32 s66, 159072, s66
    s_mul_i32 s51, s51, 32
    s_add_u32 s51, s51, s66
    s_mov_b32 s46, s44
    s_mov_b32 s47, s44
    s_branch K2_back_66
K2_nul_70:
    s_mov_b32 s58, 63
    s_mov_b32 s36, 0
    s_branch K2_back_73
K2_spin_71:
    v_lshl_add_u32 v233, v252, 1, s53
    ds_read_b32 v233, v233
    s_waitcnt lgkmcnt(0)
    s_branch K2_chk_72
K2_dyn_68:
    v_mov_b32 v254, 163648
    v_mov_b32 v255, 1
    v_lshl_add_u32 v233, v252, 1, s53
    s_mov_b64 exec, 1
    ds_add_rtn_u32 v232, v254, v255
    s_mov_b64 exec, -1
    ds_read_b32 v233, v233
    s_waitcnt lgkmcnt(0)
    v_readfirstlane_b32 s58, v232
    s_nop 0
    s_cmp_lt_u32 s58, s22
    s_cbranch_scc0 K2_nul_70
    s_and_b32 s59, s58, 7
    s_lshr_b32 s60, s58, 3
K2_chk_72:
    v_readlane_b32 s61, v233, s59
    s_nop 0
    s_cmp_gt_u32 s61, s60
    s_cbranch_scc0 K2_spin_71
K2_back_73:
    s_mov_b32 s34, 1
    s_branch K2_back_69
K2_rare_74:
    s_cmp_eq_u32 s33, 4
    s_cbranch_scc1 K2_four_76
    s_mov_b32 s49, s48
    s_mov_b32 s51, s48
    s_add_u32 s45, s44, 256
    s_add_u32 s46, s44, 512
    s_add_u32 s47, s44, 768
    s_branch K2_back_75
K2_four_76:
    s_add_u32 s50, s48, 64
    s_lshr_b32 s51, s3, 27
    s_mov_b32 s66, 161536
    s_cmp_ge_u32 s51, 2
    s_cselect_b32 s66, 159072, s66
    s_mul_i32 s51, s51, 32
    s_add_u32 s51, s51, s66
    s_mov_b32 s46, s44
    s_mov_b32 s47, s44
    s_branch K2_back_75
K2_dum_77:
    v_mov_b32 v232, -1
    s_mov_b32 m0, 163712
    s_mov_b64 exec, 1
    buffer_load_dwordx4 v232, s[16:19], 0 offen lds
    buffer_load_dwordx4 v232, s[16:19], 0 offen lds
    s_mov_b64 exec, -1
    s_branch K2_back_79
K2_a4_78:
    s_lshr_b32 s65, s3, 27
    s_mov_b32 s66, 161536
    s_cmp_ge_u32 s65, 2
    s_cselect_b32 s66, 158112, s66
    s_mul_i32 s65, s65, 512
    s_add_u32 s65, s65, s66
    v_add_u32 v232, s65, v230
    ds_read_b32 v232, v232
    s_add_u32 m0, s65, 864
    s_waitcnt lgkmcnt(0)
    v_or_b32 v232, v232, v231
    buffer_load_dwordx4 v232, s[16:19], 0 offen  lds
    s_branch K2_b4_80
K2_nul_83:
    s_mov_b32 s58, 63
    s_mov_b32 s36, 0
    s_branch K2_back_86
K2_spin_84:
    v_lshl_add_u32 v233, v252, 1, s53
    ds_read_b32 v233, v233
    s_waitcnt lgkmcnt(0)
    s_branch K2_chk_85
K2_dyn_81:
    v_mov_b32 v254, 163648
    v_mov_b32 v255, 1
    v_lshl_add_u32 v233, v252, 1, s53
    s_mov_b64 exec, 1
    ds_add_rtn_u32 v232, v254, v255
    s_mov_b64 exec, -1
    ds_read_b32 v233, v233
    s_waitcnt lgkmcnt(0)
    v_readfirstlane_b32 s58, v232
    s_nop 0
    s_cmp_lt_u32 s58, s22
    s_cbranch_scc0 K2_nul_83
    s_and_b32 s59, s58, 7
    s_lshr_b32 s60, s58, 3
K2_chk_85:
    v_readlane_b32 s61, v233, s59
    s_nop 0
    s_cmp_gt_u32 s61, s60
    s_cbranch_scc0 K2_spin_84
K2_back_86:
    s_mov_b32 s34, 1
    s_branch K2_back_82
K2_rare_87:
    s_cmp_eq_u32 s33, 4
    s_cbranch_scc1 K2_four_89
    s_mov_b32 s49, s48
    s_mov_b32 s51, s48
    s_add_u32 s45, s44, 256
    s_add_u32 s46, s44, 512
    s_add_u32 s47, s44, 768
    s_branch K2_back_88
K2_four_89:
    s_add_u32 s50, s48, 64
    s_lshr_b32 s51, s3, 27
    s_mov_b32 s66, 161536
    s_cmp_ge_u32 s51, 2
    s_cselect_b32 s66, 159072, s66
    s_mul_i32 s51, s51, 32
    s_add_u32 s51, s51, s66
    s_mov_b32 s46, s44
    s_mov_b32 s47, s44
    s_branch K2_back_88
K2_dum_90:
    v_mov_b32 v232, -1
    s_mov_b32 m0, 163712
    s_mov_b64 exec, 1
    buffer_load_dwordx4 v232, s[16:19], 0 offen lds
    buffer_load_dwordx4 v232, s[16:19], 0 offen lds
    s_mov_b64 exec, -1
    s_branch K2_back_92
K2_a4_91:
    s_lshr_b32 s65, s3, 27
    s_mov_b32 s66, 161536
    s_cmp_ge_u32 s65, 2
    s_cselect_b32 s66, 158112, s66
    s_mul_i32 s65, s65, 512
    s_add_u32 s65, s65, s66
    v_add_u32 v232, s65, v230
    ds_read_b32 v232, v232
    s_add_u32 m0, s65, 864
    s_waitcnt lgkmcnt(0)
    v_or_b32 v232, v232, v231
    buffer_load_dwordx4 v232, s[16:19], 0 offen  lds
    s_branch K2_b4_93
K2_nul_94:
    s_mov_b32 s58, 63
    s_mov_b32 s36, 0
    s_branch K2_back_97
K2_spin_95:
    v_lshl_add_u32 v233, v252, 1, s53
    ds_read_b32 v233, v233
    s_waitcnt lgkmcnt(0)
    s_branch K2_chk_96
K2_rare_98:
    s_cmp_eq_u32 s33, 4
    s_cbranch_scc1 K2_four_100
    s_mov_b32 s49, s48
    s_mov_b32 s51, s48
    s_add_u32 s45, s44, 256
    s_add_u32 s46, s44, 512
    s_add_u32 s47, s44, 768
    s_branch K2_back_99
K2_four_100:
    s_add_u32 s50, s48, 64
    s_lshr_b32 s51, s3, 27
    s_mov_b32 s66, 161536
    s_cmp_ge_u32 s51, 2
    s_cselect_b32 s66, 159072, s66
    s_mul_i32 s51, s51, 32
    s_add_u32 s51, s51, s66
    s_mov_b32 s46, s44
    s_mov_b32 s47, s44
    s_branch K2_back_99
K2_nul_101:
    s_mov_b32 s58, 63
    s_mov_b32 s36, 0
    s_branch K2_back_104
K2_spin_102:
    v_lshl_add_u32 v233, v252, 1, s53
    ds_read_b32 v233, v233
    s_waitcnt lgkmcnt(0)
    s_branch K2_chk_103
K2_rare_105:
    s_cmp_eq_u32 s33, 4
    s_cbranch_scc1 K2_four_107
    s_mov_b32 s49, s48
    s_mov_b32 s51, s48
    s_add_u32 s45, s44, 256
    s_add_u32 s46, s44, 512
    s_add_u32 s47, s44, 768
    s_branch K2_back_106
K2_four_107:
    s_add_u32 s50, s48, 64
    s_lshr_b32 s51, s3, 27
    s_mov_b32 s66, 161536
    s_cmp_ge_u32 s51, 2
    s_cselect_b32 s66, 159072, s66
    s_mul_i32 s51, s51, 32
    s_add_u32 s51, s51, s66
    s_mov_b32 s46, s44
    s_mov_b32 s47, s44
    s_branch K2_back_106
K2_TAIL2:
    v_lshlrev_b32 v229, 3, v252
    s_mul_i32 s58, s20, 20480
    s_add_u32 s58, s58, 6946816
    buffer_load_dwordx4 v[96:99], v229, s[8:11], s58 offen offset:0 sc1
    buffer_load_dwordx4 v[100:103], v229, s[8:11], s58 offen offset:1024 sc1
    buffer_load_dwordx4 v[104:107], v229, s[8:11], s58 offen offset:2048 sc1
    buffer_load_dwordx4 v[108:111], v229, s[8:11], s58 offen offset:3072 sc1
    s_add_u32 s58, s58, 4096
    buffer_load_dwordx4 v[112:115], v229, s[8:11], s58 offen offset:0 sc1
    buffer_load_dwordx4 v[116:119], v229, s[8:11], s58 offen offset:1024 sc1
    buffer_load_dwordx4 v[120:123], v229, s[8:11], s58 offen offset:2048 sc1
    buffer_load_dwordx4 v[124:127], v229, s[8:11], s58 offen offset:3072 sc1
    s_add_u32 s58, s58, 4096
    buffer_load_dwordx4 v[128:131], v229, s[8:11], s58 offen offset:0 sc1
    buffer_load_dwordx4 v[132:135], v229, s[8:11], s58 offen offset:1024 sc1
    buffer_load_dwordx4 v[136:139], v229, s[8:11], s58 offen offset:2048 sc1
    buffer_load_dwordx4 v[140:143], v229, s[8:11], s58 offen offset:3072 sc1
    s_add_u32 s58, s58, 4096
    buffer_load_dwordx4 v[144:147], v229, s[8:11], s58 offen offset:0 sc1
    buffer_load_dwordx4 v[148:151], v229, s[8:11], s58 offen offset:1024 sc1
    buffer_load_dwordx4 v[152:155], v229, s[8:11], s58 offen offset:2048 sc1
    buffer_load_dwordx4 v[156:159], v229, s[8:11], s58 offen offset:3072 sc1
    s_add_u32 s58, s58, 4096
    buffer_load_dwordx4 v[160:163], v229, s[8:11], s58 offen offset:0 sc1
    buffer_load_dwordx4 v[164:167], v229, s[8:11], s58 offen offset:1024 sc1
    buffer_load_dwordx4 v[168:171], v229, s[8:11], s58 offen offset:2048 sc1
    buffer_load_dwordx4 v[172:175], v229, s[8:11], s58 offen offset:3072 sc1
    s_branch K2_TAIL3
K2_TAIL:
    v_lshlrev_b32 v229, 3, v252
    s_mul_i32 s58, s20, 20480
    s_add_u32 s58, s58, 6946816
    buffer_load_dwordx4 v[96:99], v229, s[8:11], s58 offen offset:0 sc1
    buffer_load_dwordx4 v[100:103], v229, s[8:11], s58 offen offset:1024 sc1
    buffer_load_dwordx4 v[104:107], v229, s[8:11], s58 offen offset:2048 sc1
    buffer_load_dwordx4 v[108:111], v229, s[8:11], s58 offen offset:3072 sc1
    s_add_u32 s58, s58, 4096
    buffer_load_dwordx4 v[112:115], v229, s[8:11], s58 offen offset:0 sc1
    buffer_load_dwordx4 v[116:119], v229, s[8:11], s58 offen offset:1024 sc1
    buffer_load_dwordx4 v[120:123], v229, s[8:11], s58 offen offset:2048 sc1
    buffer_load_dwordx4 v[124:127], v229, s[8:11], s58 offen offset:3072 sc1
    s_add_u32 s58, s58, 4096
    buffer_load_dwordx4 v[128:131], v229, s[8:11], s58 offen offset:0 sc1
    buffer_load_dwordx4 v[132:135], v229, s[8:11], s58 offen offset:1024 sc1
    buffer_load_dwordx4 v[136:139], v229, s[8:11], s58 offen offset:2048 sc1
    buffer_load_dwordx4 v[140:143], v229, s[8:11], s58 offen offset:3072 sc1
    s_add_u32 s58, s58, 4096
    buffer_load_dwordx4 v[144:147], v229, s[8:11], s58 offen offset:0 sc1
    buffer_load_dwordx4 v[148:151], v229, s[8:11], s58 offen offset:1024 sc1
    buffer_load_dwordx4 v[152:155], v229, s[8:11], s58 offen offset:2048 sc1
    buffer_load_dwordx4 v[156:159], v229, s[8:11], s58 offen offset:3072 sc1
    s_add_u32 s58, s58, 4096
    buffer_load_dwordx4 v[160:163], v229, s[8:11], s58 offen offset:0 sc1
    buffer_load_dwordx4 v[164:167], v229, s[8:11], s58 offen offset:1024 sc1
    buffer_load_dwordx4 v[168:171], v229, s[8:11], s58 offen offset:2048 sc1
    buffer_load_dwordx4 v[172:175], v229, s[8:11], s58 offen offset:3072 sc1
    v_permlane32_swap_b32 v242, v243
    v_permlane32_swap_b32 v240, v241
    v_permlane32_swap_b32 v236, v237
    v_permlane32_swap_b32 v244, v245
    v_add_f32 v242, v242, v243
    v_add_f32 v240, -v240, -v241
    v_add_f32 v236, v236, v237
    v_add_f32 v244, v244, v245
    v_cvt_pk_bf16_f32 v242, v242, v236
    v_cvt_pk_bf16_f32 v244, v244, v240
    v_cvt_pk_bf16_f32 v238, v238, v238
    ds_write_b16 v230, v242 offset:1152
    ds_write_b16_d16_hi v230, v242 offset:128
    ds_write_b16 v230, v244 offset:512
    ds_write_b16_d16_hi v230, v244 offset:896
    ds_write_b16 v230, v238 offset:1280
K2_TAIL3:
    s_mul_i32 s59, s20, 8224
    v_add_u32 v228, s59, v252
    s_waitcnt vmcnt(20)
    ds_write_b16 v228, v192 offset:0
    ds_write_b16_d16_hi v228, v192 offset:256
    ds_write_b16 v228, v193 offset:640
    ds_write_b16_d16_hi v228, v193 offset:1024
    ds_write_b16 v228, v194 offset:384
    ds_write_b16_d16_hi v228, v194 offset:768
    ds_write_b16 v228, v195 offset:1152
    ds_write_b16_d16_hi v228, v195 offset:128
    ds_write_b16 v228, v196 offset:512
    ds_write_b16_d16_hi v228, v196 offset:896
    ds_write_b16 v228, v197 offset:1280
    ds_write_b16 v228, v198 offset:1536
    ds_write_b16_d16_hi v228, v198 offset:1792
    ds_write_b16 v228, v199 offset:2176
    ds_write_b16_d16_hi v228, v199 offset:2560
    ds_write_b16 v228, v200 offset:1920
    ds_write_b16_d16_hi v228, v200 offset:2304
    ds_write_b16 v228, v201 offset:2688
    ds_write_b16_d16_hi v228, v201 offset:1664
    ds_write_b16 v228, v202 offset:2048
    ds_write_b16_d16_hi v228, v202 offset:2432
    ds_write_b16 v228, v203 offset:2816
    ds_write_b16 v228, v204 offset:3072
    ds_write_b16_d16_hi v228, v204 offset:3328
    ds_write_b16 v228, v205 offset:3712
    ds_write_b16_d16_hi v228, v205 offset:4096
    ds_write_b16 v228, v206 offset:3456
    ds_write_b16_d16_hi v228, v206 offset:3840
    ds_write_b16 v228, v207 offset:4224
    ds_write_b16_d16_hi v228, v207 offset:3200
    ds_write_b16 v228, v208 offset:3584
    ds_write_b16_d16_hi v228, v208 offset:3968
    ds_write_b16 v228, v209 offset:4352
    ds_write_b16 v228, v210 offset:4608
    ds_write_b16_d16_hi v228, v210 offset:4864
    ds_write_b16 v228, v211 offset:5248
    ds_write_b16_d16_hi v228, v211 offset:5632
    ds_write_b16 v228, v212 offset:4992
    ds_write_b16_d16_hi v228, v212 offset:5376
    ds_write_b16 v228, v213 offset:5760
    ds_write_b16_d16_hi v228, v213 offset:4736
    ds_write_b16 v228, v214 offset:5120
    ds_write_b16_d16_hi v228, v214 offset:5504
    ds_write_b16 v228, v215 offset:5888
    ds_write_b16 v228, v216 offset:6144
    ds_write_b16_d16_hi v228, v216 offset:6400
    ds_write_b16 v228, v217 offset:6784
    ds_write_b16_d16_hi v228, v217 offset:7168
    ds_write_b16 v228, v218 offset:6528
    ds_write_b16_d16_hi v228, v218 offset:6912
    ds_write_b16 v228, v219 offset:7296
    ds_write_b16_d16_hi v228, v219 offset:6272
    ds_write_b16 v228, v220 offset:6656
    ds_write_b16_d16_hi v228, v220 offset:7040
    ds_write_b16 v228, v221 offset:7424
    v_bfe_u32 v48, v252, 1, 4
    v_lshlrev_b32 v49, 2, v48
    v_add_u32 v50, 64, v49
    v_add_u32 v51, 128, v49
    ds_bpermute_b32 v223, v49, v253
    ds_bpermute_b32 v224, v50, v253
    ds_bpermute_b32 v225, v51, v253
    v_lshrrev_b32 v49, 5, v252
    v_and_b32 v50, 7, v48
    v_mul_u32_u24 v50, 8224, v50
    v_lshrrev_b32 v51, 3, v48
    v_mul_u32_u24 v51, 1536, v51
    v_add_u32 v50, v50, v51
    v_lshlrev_b32 v52, 4, v49
    v_add_u32 v222, v50, v52
    s_lshl_b32 s60, s20, 5
    v_lshl_add_u32 v51, v49, 3, s60
    v_bfe_u32 v53, v48, 2, 1
    v_lshl_add_u32 v51, v53, 4, v51
    v_add_u32 v226, v50, v51
    s_sub_u32 s60, s22, 32
    v_cmp_gt_u32 s[56:57], s60, v48
    s_bfe_u32 s60, s20, 0x10002
    s_lshl_b32 s60, s60, 4
    s_add_u32 s59, s59, s60
    s_add_u32 s24, s24, 1
    s_cmp_ge_u32 s24, s25
    s_cselect_b32 s55, 1, 0
    s_cmp_eq_u32 s27, 0
    s_cselect_b32 s55, s55, 0
    s_and_b32 s64, s55, s28
    s_mov_b32 s63, 0xbfb8aa3b
    v_lshlrev_b32 v53, 5, v48
    s_waitcnt lgkmcnt(0)
    v_add_u32 v228, s59, v229
    v_and_b32 v51, 0x3ffff, v223
    v_sub_u32 v50, v53, v51
    v_and_b32 v50, 0xff, v50
    v_add3_u32 v223, v50, v51, v52
    v_and_b32 v51, 0x3ffff, v224
    v_sub_u32 v50, v53, v51
    v_and_b32 v50, 0xff, v50
    v_add3_u32 v224, v50, v51, v52
    v_and_b32 v51, 0x3ffff, v225
    v_sub_u32 v50, v53, v51
    v_and_b32 v50, 0xff, v50
    v_add3_u32 v225, v50, v51, v52
    s_barrier
    s_cmp_eq_u32 s64, 0
    s_cbranch_scc1 K2_MULTI
    ds_read_b128 v[48:51], v222 offset:0
    ds_read_b128 v[52:55], v222 offset:64
    ds_read_b128 v[56:59], v222 offset:128
    ds_read_b128 v[60:63], v222 offset:192
    ds_read_b128 v[64:67], v223 offset:0
    ds_read_b128 v[68:71], v223 offset:64
    ds_read_b128 v[72:75], v223 offset:128
    ds_read_b128 v[76:79], v223 offset:192
    ds_read_b128 v[80:83], v222 offset:256
    ds_read_b128 v[84:87], v222 offset:640
    ds_read_b128 v[88:91], v222 offset:1024
    s_waitcnt vmcnt(19) lgkmcnt(10)
    v_mfma_f32_16x16x32_bf16 v[0:3], v[96:99], v[48:51], 0
    ds_read_b128 v[92:95], v222 offset:320
    s_waitcnt vmcnt(18) lgkmcnt(10)
    v_mfma_f32_16x16x32_bf16 v[0:3], v[100:103], v[52:55], v[0:3]
    ds_read_b128 v[48:51], v222 offset:704
    s_waitcnt vmcnt(17) lgkmcnt(10)
    v_mfma_f32_16x16x32_bf16 v[0:3], v[104:107], v[56:59], v[0:3]
    ds_read_b128 v[52:55], v222 offset:1088
    s_waitcnt vmcnt(16) lgkmcnt(10)
    v_mfma_f32_16x16x32_bf16 v[0:3], v[108:111], v[60:63], v[0:3]
    ds_read_b128 v[56:59], v222 offset:384
    s_waitcnt vmcnt(15) lgkmcnt(10)
    v_mfma_f32_16x16x32_bf16 v[0:3], v[112:115], v[64:67], v[0:3]
    ds_read_b128 v[60:63], v222 offset:768
    s_waitcnt vmcnt(14) lgkmcnt(10)
    v_mfma_f32_16x16x32_bf16 v[0:3], v[116:119], v[68:71], v[0:3]
    ds_read_b128 v[64:67], v222 offset:1152
    s_waitcnt vmcnt(13) lgkmcnt(10)
    v_mfma_f32_16x16x32_bf16 v[0:3], v[120:123], v[72:75], v[0:3]
    ds_read_b128 v[68:71], v222 offset:448
    s_waitcnt vmcnt(12) lgkmcnt(10)
    v_mfma_f32_16x16x32_bf16 v[0:3], v[124:127], v[76:79], v[0:3]
    ds_read_b128 v[72:75], v222 offset:832
    s_waitcnt vmcnt(11) lgkmcnt(10)
    v_mfma_f32_16x16x32_bf16 v[4:7], v[128:131], v[80:83], 0
    ds_read_b128 v[76:79], v222 offset:1216
    s_waitcnt lgkmcnt(10)
    v_mfma_f32_16x16x32_bf16 v[8:11], v[128:131], v[84:87], 0
    ds_read_b128 v[80:83], v222 offset:512
    s_waitcnt lgkmcnt(10)
    v_mfma_f32_16x16x32_bf16 v[12:15], v[128:131], v[88:91], 0
    ds_read_b128 v[84:87], v222 offset:896
    s_waitcnt vmcnt(10) lgkmcnt(10)
    v_mfma_f32_16x16x32_bf16 v[4:7], v[132:135], v[92:95], v[4:7]
    ds_read_b128 v[88:91], v222 offset:1280
    s_waitcnt lgkmcnt(10)
    v_mfma_f32_16x16x32_bf16 v[8:11], v[132:135], v[48:51], v[8:11]
    ds_read_b128 v[92:95], v222 offset:576
    s_waitcnt lgkmcnt(10)
    v_mfma_f32_16x16x32_bf16 v[12:15], v[132:135], v[52:55], v[12:15]
    ds_read_b128 v[48:51], v222 offset:960
    s_waitcnt vmcnt(9) lgkmcnt(10)
    v_mfma_f32_16x16x32_bf16 v[4:7], v[136:139], v[56:59], v[4:7]
    ds_read_b128 v[52:55], v222 offset:1344
    s_waitcnt lgkmcnt(10)
    v_mfma_f32_16x16x32_bf16 v[8:11], v[136:139], v[60:63], v[8:11]
    ds_read_b128 v[56:59], v223 offset:256
    s_waitcnt lgkmcnt(10)
    v_mfma_f32_16x16x32_bf16 v[12:15], v[136:139], v[64:67], v[12:15]
    ds_read_b128 v[60:63], v223 offset:640
    s_waitcnt vmcnt(8) lgkmcnt(10)
    v_mfma_f32_16x16x32_bf16 v[4:7], v[140:143], v[68:71], v[4:7]
    ds_read_b128 v[64:67], v223 offset:1024
    s_waitcnt lgkmcnt(10)
    v_mfma_f32_16x16x32_bf16 v[8:11], v[140:143], v[72:75], v[8:11]
    ds_read_b128 v[68:71], v223 offset:320
    s_waitcnt lgkmcnt(10)
    v_mfma_f32_16x16x32_bf16 v[12:15], v[140:143], v[76:79], v[12:15]
    ds_read_b128 v[72:75], v223 offset:704
    s_waitcnt vmcnt(7) lgkmcnt(10)
    v_mfma_f32_16x16x32_bf16 v[4:7], v[144:147], v[80:83], v[4:7]
    ds_read_b128 v[76:79], v223 offset:1088
    s_waitcnt lgkmcnt(10)
    v_mfma_f32_16x16x32_bf16 v[8:11], v[144:147], v[84:87], v[8:11]
    ds_read_b128 v[80:83], v223 offset:384
    s_waitcnt lgkmcnt(10)
    v_mfma_f32_16x16x32_bf16 v[12:15], v[144:147], v[88:91], v[12:15]
    ds_read_b128 v[84:87], v223 offset:768
    s_waitcnt vmcnt(6) lgkmcnt(10)
    v_mfma_f32_16x16x32_bf16 v[4:7], v[148:151], v[92:95], v[4:7]
    ds_read_b128 v[88:91], v223 offset:1152
    s_waitcnt lgkmcnt(10)
    v_mfma_f32_16x16x32_bf16 v[8:11], v[148:151], v[48:51], v[8:11]
    ds_read_b128 v[92:95], v223 offset:448
    s_waitcnt lgkmcnt(10)
    v_mfma_f32_16x16x32_bf16 v[12:15], v[148:151], v[52:55], v[12:15]
    ds_read_b128 v[48:51], v223 offset:832
    s_waitcnt vmcnt(5) lgkmcnt(10)
    v_mfma_f32_16x16x32_bf16 v[4:7], v[152:155], v[56:59], v[4:7]
    ds_read_b128 v[52:55], v223 offset:1216
    s_waitcnt lgkmcnt(10)
    v_mfma_f32_16x16x32_bf16 v[8:11], v[152:155], v[60:63], v[8:11]
    ds_read_b128 v[56:59], v223 offset:512
    s_waitcnt lgkmcnt(10)
    v_mfma_f32_16x16x32_bf16 v[12:15], v[152:155], v[64:67], v[12:15]
    ds_read_b128 v[60:63], v223 offset:896
    s_waitcnt vmcnt(4) lgkmcnt(10)
    v_mfma_f32_16x16x32_bf16 v[4:7], v[156:159], v[68:71], v[4:7]
    ds_read_b128 v[64:67], v223 offset:1280
    s_waitcnt lgkmcnt(10)
    v_mfma_f32_16x16x32_bf16 v[8:11], v[156:159], v[72:75], v[8:11]
    ds_read_b128 v[68:71], v223 offset:576
    s_waitcnt lgkmcnt(10)
    v_mfma_f32_16x16x32_bf16 v[12:15], v[156:159], v[76:79], v[12:15]
    ds_read_b128 v[72:75], v223 offset:960
    s_waitcnt vmcnt(3) lgkmcnt(10)
    v_mfma_f32_16x16x32_bf16 v[4:7], v[160:163], v[80:83], v[4:7]
    ds_read_b128 v[76:79], v223 offset:1344
    s_waitcnt lgkmcnt(10)
    v_mfma_f32_16x16x32_bf16 v[8:11], v[160:163], v[84:87], v[8:11]
    ds_read_b128 v[80:83], v222 offset:3072
    s_waitcnt lgkmcnt(10)
    v_mfma_f32_16x16x32_bf16 v[12:15], v[160:163], v[88:91], v[12:15]
    ds_read_b128 v[84:87], v222 offset:3136
    s_waitcnt vmcnt(2) lgkmcnt(10)
    v_mfma_f32_16x16x32_bf16 v[4:7], v[164:167], v[92:95], v[4:7]
    ds_read_b128 v[88:91], v222 offset:3200
    s_waitcnt lgkmcnt(10)
    v_mfma_f32_16x16x32_bf16 v[8:11], v[164:167], v[48:51], v[8:11]
    ds_read_b128 v[92:95], v222 offset:3264
    s_waitcnt lgkmcnt(10)
    v_mfma_f32_16x16x32_bf16 v[12:15], v[164:167], v[52:55], v[12:15]
    ds_read_b128 v[48:51], v224 offset:0
    s_waitcnt vmcnt(1) lgkmcnt(10)
    v_mfma_f32_16x16x32_bf16 v[4:7], v[168:171], v[56:59], v[4:7]
    ds_read_b128 v[52:55], v224 offset:64
    s_waitcnt lgkmcnt(10)
    v_mfma_f32_16x16x32_bf16 v[8:11], v[168:171], v[60:63], v[8:11]
    ds_read_b128 v[56:59], v224 offset:128
    s_waitcnt lgkmcnt(10)
    v_mfma_f32_16x16x32_bf16 v[12:15], v[168:171], v[64:67], v[12:15]
    ds_read_b128 v[60:63], v224 offset:192
    s_waitcnt vmcnt(0) lgkmcnt(10)
    v_mfma_f32_16x16x32_bf16 v[4:7], v[172:175], v[68:71], v[4:7]
    ds_read_b128 v[64:67], v222 offset:3328
    s_waitcnt lgkmcnt(10)
    v_mfma_f32_16x16x32_bf16 v[8:11], v[172:175], v[72:75], v[8:11]
    ds_read_b128 v[68:71], v222 offset:3712
    s_waitcnt lgkmcnt(10)
    v_mfma_f32_16x16x32_bf16 v[12:15], v[172:175], v[76:79], v[12:15]
    ds_read_b128 v[72:75], v222 offset:4096
    s_waitcnt lgkmcnt(10)
    v_mfma_f32_16x16x32_bf16 v[16:19], v[96:99], v[80:83], 0
    ds_read_b128 v[76:79], v222 offset:3392
    s_waitcnt lgkmcnt(10)
    v_mfma_f32_16x16x32_bf16 v[16:19], v[100:103], v[84:87], v[16:19]
    ds_read_b128 v[80:83], v222 offset:3776
    s_waitcnt lgkmcnt(10)
    v_mfma_f32_16x16x32_bf16 v[16:19], v[104:107], v[88:91], v[16:19]
    s_barrier
    ds_read_b128 v[84:87], v222 offset:4160
    s_waitcnt lgkmcnt(10)
    v_mfma_f32_16x16x32_bf16 v[16:19], v[108:111], v[92:95], v[16:19]
    v_mul_f32 v200, s63, v0
    ds_read_b128 v[88:91], v222 offset:3456
    s_waitcnt lgkmcnt(10)
    v_mfma_f32_16x16x32_bf16 v[16:19], v[112:115], v[48:51], v[16:19]
    v_mul_f32 v201, s63, v1
    ds_read_b128 v[92:95], v222 offset:3840
    s_waitcnt lgkmcnt(10)
    v_mfma_f32_16x16x32_bf16 v[16:19], v[116:119], v[52:55], v[16:19]
    v_mul_f32 v202, s63, v2
    ds_read_b128 v[48:51], v222 offset:4224
    s_waitcnt lgkmcnt(10)
    v_mfma_f32_16x16x32_bf16 v[16:19], v[120:123], v[56:59], v[16:19]
    v_mul_f32 v203, s63, v3
    ds_read_b128 v[52:55], v222 offset:3520
    s_waitcnt lgkmcnt(10)
    v_mfma_f32_16x16x32_bf16 v[16:19], v[124:127], v[60:63], v[16:19]
    v_exp_f32 v200, v200
    ds_read_b128 v[56:59], v222 offset:3904
    s_waitcnt lgkmcnt(10)
    v_mfma_f32_16x16x32_bf16 v[20:23], v[128:131], v[64:67], 0
    v_exp_f32 v201, v201
    ds_read_b128 v[60:63], v222 offset:4288
    s_waitcnt lgkmcnt(10)
    v_mfma_f32_16x16x32_bf16 v[24:27], v[128:131], v[68:71], 0
    v_exp_f32 v202, v202
    ds_read_b128 v[64:67], v222 offset:3584
    s_waitcnt lgkmcnt(10)
    v_mfma_f32_16x16x32_bf16 v[28:31], v[128:131], v[72:75], 0
    v_exp_f32 v203, v203
    ds_read_b128 v[68:71], v222 offset:3968
    s_waitcnt lgkmcnt(10)
    v_mfma_f32_16x16x32_bf16 v[20:23], v[132:135], v[76:79], v[20:23]
    v_add_f32 v200, 1.0, v200
    ds_read_b128 v[72:75], v222 offset:4352
    s_waitcnt lgkmcnt(10)
    v_mfma_f32_16x16x32_bf16 v[24:27], v[132:135], v[80:83], v[24:27]
    v_add_f32 v201, 1.0, v201
    ds_read_b128 v[76:79], v222 offset:3648
    s_waitcnt lgkmcnt(10)
    v_mfma_f32_16x16x32_bf16 v[28:31], v[132:135], v[84:87], v[28:31]
    v_add_f32 v202, 1.0, v202
    ds_read_b128 v[80:83], v222 offset:4032
    s_waitcnt lgkmcnt(10)
    v_mfma_f32_16x16x32_bf16 v[20:23], v[136:139], v[88:91], v[20:23]
    v_add_f32 v203, 1.0, v203
    ds_read_b128 v[84:87], v222 offset:4416
    s_waitcnt lgkmcnt(10)
    v_mfma_f32_16x16x32_bf16 v[24:27], v[136:139], v[92:95], v[24:27]
    v_rcp_f32 v200, v200
    ds_read_b128 v[88:91], v224 offset:256
    s_waitcnt lgkmcnt(10)
    v_mfma_f32_16x16x32_bf16 v[28:31], v[136:139], v[48:51], v[28:31]
    v_rcp_f32 v201, v201
    ds_read_b128 v[92:95], v224 offset:640
    s_waitcnt lgkmcnt(10)
    v_mfma_f32_16x16x32_bf16 v[20:23], v[140:143], v[52:55], v[20:23]
    v_rcp_f32 v202, v202
    ds_read_b128 v[48:51], v224 offset:1024
    s_waitcnt lgkmcnt(10)
    v_mfma_f32_16x16x32_bf16 v[24:27], v[140:143], v[56:59], v[24:27]
    v_rcp_f32 v203, v203
    ds_read_b128 v[52:55], v224 offset:320
    s_waitcnt lgkmcnt(10)
    v_mfma_f32_16x16x32_bf16 v[28:31], v[140:143], v[60:63], v[28:31]
    v_cvt_pk_bf16_f32 v176, v0, v1
    ds_read_b128 v[56:59], v224 offset:704
    s_waitcnt lgkmcnt(10)
    v_mfma_f32_16x16x32_bf16 v[20:23], v[144:147], v[64:67], v[20:23]
    v_cvt_pk_bf16_f32 v177, v2, v3
    ds_read_b128 v[60:63], v224 offset:1088
    s_waitcnt lgkmcnt(10)
    v_mfma_f32_16x16x32_bf16 v[24:27], v[144:147], v[68:71], v[24:27]
    v_mul_f32 v4, v4, v200
    ds_read_b128 v[64:67], v224 offset:384
    s_waitcnt lgkmcnt(10)
    v_mfma_f32_16x16x32_bf16 v[28:31], v[144:147], v[72:75], v[28:31]
    v_mul_f32 v5, v5, v201
    ds_read_b128 v[68:71], v224 offset:768
    s_waitcnt lgkmcnt(10)
    v_mfma_f32_16x16x32_bf16 v[20:23], v[148:151], v[76:79], v[20:23]
    v_mul_f32 v6, v6, v202
    ds_read_b128 v[72:75], v224 offset:1152
    s_waitcnt lgkmcnt(10)
    v_mfma_f32_16x16x32_bf16 v[24:27], v[148:151], v[80:83], v[24:27]
    v_mul_f32 v7, v7, v203
    ds_read_b128 v[76:79], v224 offset:448
    s_waitcnt lgkmcnt(10)
    v_mfma_f32_16x16x32_bf16 v[28:31], v[148:151], v[84:87], v[28:31]
    v_cvt_pk_bf16_f32 v178, v4, v5
    ds_read_b128 v[80:83], v224 offset:832
    s_waitcnt lgkmcnt(10)
    v_mfma_f32_16x16x32_bf16 v[20:23], v[152:155], v[88:91], v[20:23]
    v_cvt_pk_bf16_f32 v179, v6, v7
    ds_read_b128 v[84:87], v224 offset:1216
    s_waitcnt lgkmcnt(10)
    v_mfma_f32_16x16x32_bf16 v[24:27], v[152:155], v[92:95], v[24:27]
    v_mul_f32 v8, v8, v200
    ds_read_b128 v[88:91], v224 offset:512
    s_waitcnt lgkmcnt(10)
    v_mfma_f32_16x16x32_bf16 v[28:31], v[152:155], v[48:51], v[28:31]
    v_mul_f32 v9, v9, v201
    ds_read_b128 v[92:95], v224 offset:896
    s_waitcnt lgkmcnt(10)
    v_mfma_f32_16x16x32_bf16 v[20:23], v[156:159], v[52:55], v[20:23]
    v_mul_f32 v10, v10, v202
    ds_read_b128 v[48:51], v224 offset:1280
    s_waitcnt lgkmcnt(10)
    v_mfma_f32_16x16x32_bf16 v[24:27], v[156:159], v[56:59], v[24:27]
    v_mul_f32 v11, v11, v203
    ds_read_b128 v[52:55], v224 offset:576
    s_waitcnt lgkmcnt(10)
    v_mfma_f32_16x16x32_bf16 v[28:31], v[156:159], v[60:63], v[28:31]
    v_cvt_pk_bf16_f32 v180, v8, v9
    ds_read_b128 v[56:59], v224 offset:960
    s_waitcnt lgkmcnt(10)
    v_mfma_f32_16x16x32_bf16 v[20:23], v[160:163], v[64:67], v[20:23]
    v_cvt_pk_bf16_f32 v181, v10, v11
    ds_read_b128 v[60:63], v224 offset:1344
    s_waitcnt lgkmcnt(10)
    v_mfma_f32_16x16x32_bf16 v[24:27], v[160:163], v[68:71], v[24:27]
    v_mul_f32 v12, v12, v200
    ds_read_b128 v[64:67], v222 offset:6144
    s_waitcnt lgkmcnt(10)
    v_mfma_f32_16x16x32_bf16 v[28:31], v[160:163], v[72:75], v[28:31]
    v_mul_f32 v13, v13, v201
    ds_read_b128 v[68:71], v222 offset:6208
    s_waitcnt lgkmcnt(10)
    v_mfma_f32_16x16x32_bf16 v[20:23], v[164:167], v[76:79], v[20:23]
    v_mul_f32 v14, v14, v202
    ds_read_b128 v[72:75], v222 offset:6272
    s_waitcnt lgkmcnt(10)
    v_mfma_f32_16x16x32_bf16 v[24:27], v[164:167], v[80:83], v[24:27]
    v_mul_f32 v15, v15, v203
    ds_read_b128 v[76:79], v222 offset:6336
    s_waitcnt lgkmcnt(10)
    v_mfma_f32_16x16x32_bf16 v[28:31], v[164:167], v[84:87], v[28:31]
    v_cvt_pk_bf16_f32 v182, v12, v13
    ds_read_b128 v[80:83], v225 offset:0
    s_waitcnt lgkmcnt(10)
    v_mfma_f32_16x16x32_bf16 v[20:23], v[168:171], v[88:91], v[20:23]
    v_cvt_pk_bf16_f32 v183, v14, v15
    ds_read_b128 v[84:87], v225 offset:64
    s_waitcnt lgkmcnt(10)
    v_mfma_f32_16x16x32_bf16 v[24:27], v[168:171], v[92:95], v[24:27]
    ds_write_b64 v226, v[176:177] offset:0
    ds_write_b64 v226, v[178:179] offset:256
    ds_write_b64 v226, v[180:181] offset:512
    ds_write_b64 v226, v[182:183] offset:768
    ds_read_b128 v[88:91], v225 offset:128
    s_waitcnt lgkmcnt(14)
    v_mfma_f32_16x16x32_bf16 v[28:31], v[168:171], v[48:51], v[28:31]
    ds_read_b128 v[92:95], v225 offset:192
    s_waitcnt lgkmcnt(14)
    v_mfma_f32_16x16x32_bf16 v[20:23], v[172:175], v[52:55], v[20:23]
    ds_read_b128 v[48:51], v222 offset:6400
    s_waitcnt lgkmcnt(14)
    v_mfma_f32_16x16x32_bf16 v[24:27], v[172:175], v[56:59], v[24:27]
    ds_read_b128 v[52:55], v222 offset:6784
    s_waitcnt lgkmcnt(14)
    v_mfma_f32_16x16x32_bf16 v[28:31], v[172:175], v[60:63], v[28:31]
    ds_read_b128 v[56:59], v222 offset:7168
    s_waitcnt lgkmcnt(14)
    v_mfma_f32_16x16x32_bf16 v[32:35], v[96:99], v[64:67], 0
    ds_read_b128 v[60:63], v222 offset:6464
    s_waitcnt lgkmcnt(14)
    v_mfma_f32_16x16x32_bf16 v[32:35], v[100:103], v[68:71], v[32:35]
    ds_read_b128 v[64:67], v222 offset:6848
    s_waitcnt lgkmcnt(14)
    v_mfma_f32_16x16x32_bf16 v[32:35], v[104:107], v[72:75], v[32:35]
    ds_read_b128 v[68:71], v222 offset:7232
    s_waitcnt lgkmcnt(14)
    v_mfma_f32_16x16x32_bf16 v[32:35], v[108:111], v[76:79], v[32:35]
    v_mul_f32 v200, s63, v16
    ds_read_b128 v[72:75], v222 offset:6528
    s_waitcnt lgkmcnt(14)
    v_mfma_f32_16x16x32_bf16 v[32:35], v[112:115], v[80:83], v[32:35]
    v_mul_f32 v201, s63, v17
    ds_read_b128 v[76:79], v222 offset:6912
    s_waitcnt lgkmcnt(14)
    v_mfma_f32_16x16x32_bf16 v[32:35], v[116:119], v[84:87], v[32:35]
    v_mul_f32 v202, s63, v18
    ds_read_b128 v[80:83], v222 offset:7296
    s_waitcnt lgkmcnt(10)
    v_mfma_f32_16x16x32_bf16 v[32:35], v[120:123], v[88:91], v[32:35]
    v_mul_f32 v203, s63, v19
    ds_read_b128 v[84:87], v222 offset:6592
    s_waitcnt lgkmcnt(10)
    v_mfma_f32_16x16x32_bf16 v[32:35], v[124:127], v[92:95], v[32:35]
    s_barrier
    ds_read_b128 v[192:195], v228 offset:0
    ds_read_b128 v[196:199], v228 offset:1536
    v_exp_f32 v200, v200
    ds_read_b128 v[88:91], v222 offset:6976
    s_waitcnt lgkmcnt(12)
    v_mfma_f32_16x16x32_bf16 v[36:39], v[128:131], v[48:51], 0
    v_exp_f32 v201, v201
    ds_read_b128 v[92:95], v222 offset:7360
    s_waitcnt lgkmcnt(12)
    v_mfma_f32_16x16x32_bf16 v[40:43], v[128:131], v[52:55], 0
    v_exp_f32 v202, v202
    ds_read_b128 v[48:51], v222 offset:6656
    s_waitcnt lgkmcnt(12)
    v_mfma_f32_16x16x32_bf16 v[44:47], v[128:131], v[56:59], 0
    v_exp_f32 v203, v203
    ds_read_b128 v[52:55], v222 offset:7040
    s_waitcnt lgkmcnt(12)
    v_mfma_f32_16x16x32_bf16 v[36:39], v[132:135], v[60:63], v[36:39]
    v_add_f32 v200, 1.0, v200
    ds_read_b128 v[56:59], v222 offset:7424
    s_waitcnt lgkmcnt(12)
    v_mfma_f32_16x16x32_bf16 v[40:43], v[132:135], v[64:67], v[40:43]
    v_add_f32 v201, 1.0, v201
    ds_read_b128 v[60:63], v222 offset:6720
    s_waitcnt lgkmcnt(12)
    v_mfma_f32_16x16x32_bf16 v[44:47], v[132:135], v[68:71], v[44:47]
    v_add_f32 v202, 1.0, v202
    ds_read_b128 v[64:67], v222 offset:7104
    s_waitcnt lgkmcnt(12)
    v_mfma_f32_16x16x32_bf16 v[36:39], v[136:139], v[72:75], v[36:39]
    v_add_f32 v203, 1.0, v203
    ds_read_b128 v[68:71], v222 offset:7488
    s_waitcnt lgkmcnt(12)
    v_mfma_f32_16x16x32_bf16 v[40:43], v[136:139], v[76:79], v[40:43]
    v_rcp_f32 v200, v200
    ds_read_b128 v[72:75], v225 offset:256
    s_waitcnt lgkmcnt(12)
    v_mfma_f32_16x16x32_bf16 v[44:47], v[136:139], v[80:83], v[44:47]
    v_rcp_f32 v201, v201
    ds_read_b128 v[76:79], v225 offset:640
    s_waitcnt lgkmcnt(12)
    v_mfma_f32_16x16x32_bf16 v[36:39], v[140:143], v[84:87], v[36:39]
    v_rcp_f32 v202, v202
    ds_read_b128 v[80:83], v225 offset:1024
    s_waitcnt lgkmcnt(10)
    v_mfma_f32_16x16x32_bf16 v[40:43], v[140:143], v[88:91], v[40:43]
    v_rcp_f32 v203, v203
    ds_read_b128 v[84:87], v225 offset:320
    s_waitcnt lgkmcnt(10)
    v_mfma_f32_16x16x32_bf16 v[44:47], v[140:143], v[92:95], v[44:47]
    v_cvt_pk_bf16_f32 v184, v16, v17
    s_add_u32 s61, s20, 8
    v_readlane_b32 s41, v253, s61
    s_nop 0
    s_bfe_u32 s41, s41, 0x60015
    s_add_u32 s41, s41, s21
    s_lshl_b32 s41, s41, 10
    s_add_u32 s61, s20, 0
    v_readlane_b32 s40, v253, s61
    s_nop 0
    s_bfe_u32 s40, s40, 0x60015
    s_add_u32 s40, s40, s21
    s_lshl_b32 s40, s40, 10
    s_nop 0
    buffer_store_dwordx4 v[192:195], v229, s[12:15], s40 offen sc1
    buffer_store_dwordx4 v[196:199], v229, s[12:15], s41 offen sc1
    ds_read_b128 v[88:91], v225 offset:704
    s_waitcnt lgkmcnt(10)
    v_mfma_f32_16x16x32_bf16 v[36:39], v[144:147], v[48:51], v[36:39]
    v_cvt_pk_bf16_f32 v185, v18, v19
    ds_read_b128 v[92:95], v225 offset:1088
    s_waitcnt lgkmcnt(10)
    v_mfma_f32_16x16x32_bf16 v[40:43], v[144:147], v[52:55], v[40:43]
    v_mul_f32 v20, v20, v200
    ds_read_b128 v[48:51], v225 offset:384
    s_waitcnt lgkmcnt(10)
    v_mfma_f32_16x16x32_bf16 v[44:47], v[144:147], v[56:59], v[44:47]
    v_mul_f32 v21, v21, v201
    ds_read_b128 v[52:55], v225 offset:768
    s_waitcnt lgkmcnt(10)
    v_mfma_f32_16x16x32_bf16 v[36:39], v[148:151], v[60:63], v[36:39]
    v_mul_f32 v22, v22, v202
    ds_read_b128 v[56:59], v225 offset:1152
    s_waitcnt lgkmcnt(10)
    v_mfma_f32_16x16x32_bf16 v[40:43], v[148:151], v[64:67], v[40:43]
    v_mul_f32 v23, v23, v203
    ds_read_b128 v[60:63], v225 offset:448
    s_waitcnt lgkmcnt(10)
    v_mfma_f32_16x16x32_bf16 v[44:47], v[148:151], v[68:71], v[44:47]
    v_cvt_pk_bf16_f32 v186, v20, v21
    ds_read_b128 v[64:67], v225 offset:832
    s_waitcnt lgkmcnt(10)
    v_mfma_f32_16x16x32_bf16 v[36:39], v[152:155], v[72:75], v[36:39]
    v_cvt_pk_bf16_f32 v187, v22, v23
    ds_read_b128 v[68:71], v225 offset:1216
    s_waitcnt lgkmcnt(10)
    v_mfma_f32_16x16x32_bf16 v[40:43], v[152:155], v[76:79], v[40:43]
    v_mul_f32 v24, v24, v200
    ds_read_b128 v[72:75], v225 offset:512
    s_waitcnt lgkmcnt(10)
    v_mfma_f32_16x16x32_bf16 v[44:47], v[152:155], v[80:83], v[44:47]
    v_mul_f32 v25, v25, v201
    ds_read_b128 v[76:79], v225 offset:896
    s_waitcnt lgkmcnt(10)
    v_mfma_f32_16x16x32_bf16 v[36:39], v[156:159], v[84:87], v[36:39]
    v_mul_f32 v26, v26, v202
    ds_read_b128 v[80:83], v225 offset:1280
    s_waitcnt lgkmcnt(10)
    v_mfma_f32_16x16x32_bf16 v[40:43], v[156:159], v[88:91], v[40:43]
    v_mul_f32 v27, v27, v203
    ds_read_b128 v[84:87], v225 offset:576
    s_waitcnt lgkmcnt(10)
    v_mfma_f32_16x16x32_bf16 v[44:47], v[156:159], v[92:95], v[44:47]
    v_cvt_pk_bf16_f32 v188, v24, v25
    ds_read_b128 v[88:91], v225 offset:960
    s_waitcnt lgkmcnt(10)
    v_mfma_f32_16x16x32_bf16 v[36:39], v[160:163], v[48:51], v[36:39]
    v_cvt_pk_bf16_f32 v189, v26, v27
    ds_read_b128 v[92:95], v225 offset:1344
    s_waitcnt lgkmcnt(10)
    v_mfma_f32_16x16x32_bf16 v[40:43], v[160:163], v[52:55], v[40:43]
    v_mul_f32 v28, v28, v200
    s_waitcnt lgkmcnt(9)
    v_mfma_f32_16x16x32_bf16 v[44:47], v[160:163], v[56:59], v[44:47]
    v_mul_f32 v29, v29, v201
    s_waitcnt lgkmcnt(8)
    v_mfma_f32_16x16x32_bf16 v[36:39], v[164:167], v[60:63], v[36:39]
    v_mul_f32 v30, v30, v202
    s_waitcnt lgkmcnt(7)
    v_mfma_f32_16x16x32_bf16 v[40:43], v[164:167], v[64:67], v[40:43]
    v_mul_f32 v31, v31, v203
    s_waitcnt lgkmcnt(6)
    v_mfma_f32_16x16x32_bf16 v[44:47], v[164:167], v[68:71], v[44:47]
    v_cvt_pk_bf16_f32 v190, v28, v29
    s_waitcnt lgkmcnt(5)
    v_mfma_f32_16x16x32_bf16 v[36:39], v[168:171], v[72:75], v[36:39]
    v_cvt_pk_bf16_f32 v191, v30, v31
    s_waitcnt lgkmcnt(4)
    v_mfma_f32_16x16x32_bf16 v[40:43], v[168:171], v[76:79], v[40:43]
    ds_write_b64 v226, v[184:185] offset:3072
    ds_write_b64 v226, v[186:187] offset:3328
    ds_write_b64 v226, v[188:189] offset:3584
    ds_write_b64 v226, v[190:191] offset:3840
    s_waitcnt lgkmcnt(7)
    v_mfma_f32_16x16x32_bf16 v[44:47], v[168:171], v[80:83], v[44:47]
    s_waitcnt lgkmcnt(6)
    v_mfma_f32_16x16x32_bf16 v[36:39], v[172:175], v[84:87], v[36:39]
    s_waitcnt lgkmcnt(5)
    v_mfma_f32_16x16x32_bf16 v[40:43], v[172:175], v[88:91], v[40:43]
    s_waitcnt lgkmcnt(4)
    v_mfma_f32_16x16x32_bf16 v[44:47], v[172:175], v[92:95], v[44:47]
    v_mul_f32 v200, s63, v32
    v_mul_f32 v201, s63, v33
    v_mul_f32 v202, s63, v34
    v_mul_f32 v203, s63, v35
    v_exp_f32 v200, v200
    v_exp_f32 v201, v201
    v_exp_f32 v202, v202
    v_exp_f32 v203, v203
    v_add_f32 v200, 1.0, v200
    v_add_f32 v201, 1.0, v201
    v_add_f32 v202, 1.0, v202
    v_add_f32 v203, 1.0, v203
    v_rcp_f32 v200, v200
    v_rcp_f32 v201, v201
    v_rcp_f32 v202, v202
    v_rcp_f32 v203, v203
    v_cvt_pk_bf16_f32 v176, v32, v33
    v_cvt_pk_bf16_f32 v177, v34, v35
    v_mul_f32 v36, v36, v200
    v_mul_f32 v37, v37, v201
    v_mul_f32 v38, v38, v202
    v_mul_f32 v39, v39, v203
    v_cvt_pk_bf16_f32 v178, v36, v37
    v_cvt_pk_bf16_f32 v179, v38, v39
    v_mul_f32 v40, v40, v200
    v_mul_f32 v41, v41, v201
    v_mul_f32 v42, v42, v202
    v_mul_f32 v43, v43, v203
    v_cvt_pk_bf16_f32 v180, v40, v41
    v_cvt_pk_bf16_f32 v181, v42, v43
    v_mul_f32 v44, v44, v200
    v_mul_f32 v45, v45, v201
    v_mul_f32 v46, v46, v202
    v_mul_f32 v47, v47, v203
    v_cvt_pk_bf16_f32 v182, v44, v45
    v_cvt_pk_bf16_f32 v183, v46, v47
    s_waitcnt lgkmcnt(0)
    s_barrier
    ds_read_b128 v[192:195], v228 offset:3072
    ds_read_b128 v[196:199], v228 offset:4608
    s_mov_b64 exec, s[56:57]
    ds_write_b64 v226, v[176:177] offset:6144
    ds_write_b64 v226, v[178:179] offset:6400
    ds_write_b64 v226, v[180:181] offset:6656
    ds_write_b64 v226, v[182:183] offset:6912
    s_mov_b64 exec, -1
    s_add_u32 s61, s20, 24
    v_readlane_b32 s43, v253, s61
    s_nop 0
    s_bfe_u32 s43, s43, 0x60015
    s_add_u32 s43, s43, s21
    s_lshl_b32 s43, s43, 10
    s_add_u32 s61, s20, 16
    v_readlane_b32 s42, v253, s61
    s_nop 0
    s_bfe_u32 s42, s42, 0x60015
    s_add_u32 s42, s42, s21
    s_lshl_b32 s42, s42, 10
    s_waitcnt lgkmcnt(4)
    buffer_store_dwordx4 v[192:195], v229, s[12:15], s42 offen sc1
    buffer_store_dwordx4 v[196:199], v229, s[12:15], s43 offen sc1
    s_waitcnt lgkmcnt(0)
    s_barrier
K2_LASTROW:
    s_add_u32 s59, s20, 32
    s_cmp_ge_u32 s59, s22
    s_cbranch_scc1 K2_FIN
    ds_read_b128 v[192:195], v228 offset:6144
    s_add_u32 s61, s20, 32
    v_readlane_b32 s44, v253, s61
    s_nop 0
    s_bfe_u32 s44, s44, 0x60015
    s_add_u32 s44, s44, s21
    s_lshl_b32 s44, s44, 10
    s_waitcnt lgkmcnt(0)
    buffer_store_dwordx4 v[192:195], v229, s[12:15], s44 offen sc1
K2_FIN:
    s_branch K2_END
K2_MULTI:
    ds_read_b128 v[48:51], v222 offset:0
    ds_read_b128 v[52:55], v222 offset:64
    ds_read_b128 v[56:59], v222 offset:128
    ds_read_b128 v[60:63], v222 offset:192
    ds_read_b128 v[64:67], v223 offset:0
    ds_read_b128 v[68:71], v223 offset:64
    ds_read_b128 v[72:75], v223 offset:128
    ds_read_b128 v[76:79], v223 offset:192
    ds_read_b128 v[80:83], v222 offset:256
    ds_read_b128 v[84:87], v222 offset:640
    ds_read_b128 v[88:91], v222 offset:1024
    s_waitcnt vmcnt(19) lgkmcnt(10)
    v_mfma_f32_16x16x32_bf16 v[0:3], v[96:99], v[48:51], 0
    ds_read_b128 v[92:95], v222 offset:320
    s_waitcnt vmcnt(18) lgkmcnt(10)
    v_mfma_f32_16x16x32_bf16 v[0:3], v[100:103], v[52:55], v[0:3]
    ds_read_b128 v[48:51], v222 offset:704
    s_waitcnt vmcnt(17) lgkmcnt(10)
    v_mfma_f32_16x16x32_bf16 v[0:3], v[104:107], v[56:59], v[0:3]
    ds_read_b128 v[52:55], v222 offset:1088
    s_waitcnt vmcnt(16) lgkmcnt(10)
    v_mfma_f32_16x16x32_bf16 v[0:3], v[108:111], v[60:63], v[0:3]
    ds_read_b128 v[56:59], v222 offset:384
    s_waitcnt vmcnt(15) lgkmcnt(10)
    v_mfma_f32_16x16x32_bf16 v[0:3], v[112:115], v[64:67], v[0:3]
    ds_read_b128 v[60:63], v222 offset:768
    s_waitcnt vmcnt(14) lgkmcnt(10)
    v_mfma_f32_16x16x32_bf16 v[0:3], v[116:119], v[68:71], v[0:3]
    ds_read_b128 v[64:67], v222 offset:1152
    s_waitcnt vmcnt(13) lgkmcnt(10)
    v_mfma_f32_16x16x32_bf16 v[0:3], v[120:123], v[72:75], v[0:3]
    ds_read_b128 v[68:71], v222 offset:448
    s_waitcnt vmcnt(12) lgkmcnt(10)
    v_mfma_f32_16x16x32_bf16 v[0:3], v[124:127], v[76:79], v[0:3]
    ds_read_b128 v[72:75], v222 offset:832
    s_waitcnt vmcnt(11) lgkmcnt(10)
    v_mfma_f32_16x16x32_bf16 v[4:7], v[128:131], v[80:83], 0
    ds_read_b128 v[76:79], v222 offset:1216
    s_waitcnt lgkmcnt(10)
    v_mfma_f32_16x16x32_bf16 v[8:11], v[128:131], v[84:87], 0
    ds_read_b128 v[80:83], v222 offset:512
    s_waitcnt lgkmcnt(10)
    v_mfma_f32_16x16x32_bf16 v[12:15], v[128:131], v[88:91], 0
    ds_read_b128 v[84:87], v222 offset:896
    s_waitcnt vmcnt(10) lgkmcnt(10)
    v_mfma_f32_16x16x32_bf16 v[4:7], v[132:135], v[92:95], v[4:7]
    ds_read_b128 v[88:91], v222 offset:1280
    s_waitcnt lgkmcnt(10)
    v_mfma_f32_16x16x32_bf16 v[8:11], v[132:135], v[48:51], v[8:11]
    ds_read_b128 v[92:95], v222 offset:576
    s_waitcnt lgkmcnt(10)
    v_mfma_f32_16x16x32_bf16 v[12:15], v[132:135], v[52:55], v[12:15]
    ds_read_b128 v[48:51], v222 offset:960
    s_waitcnt vmcnt(9) lgkmcnt(10)
    v_mfma_f32_16x16x32_bf16 v[4:7], v[136:139], v[56:59], v[4:7]
    ds_read_b128 v[52:55], v222 offset:1344
    s_waitcnt lgkmcnt(10)
    v_mfma_f32_16x16x32_bf16 v[8:11], v[136:139], v[60:63], v[8:11]
    ds_read_b128 v[56:59], v223 offset:256
    s_waitcnt lgkmcnt(10)
    v_mfma_f32_16x16x32_bf16 v[12:15], v[136:139], v[64:67], v[12:15]
    ds_read_b128 v[60:63], v223 offset:640
    s_waitcnt vmcnt(8) lgkmcnt(10)
    v_mfma_f32_16x16x32_bf16 v[4:7], v[140:143], v[68:71], v[4:7]
    ds_read_b128 v[64:67], v223 offset:1024
    s_waitcnt lgkmcnt(10)
    v_mfma_f32_16x16x32_bf16 v[8:11], v[140:143], v[72:75], v[8:11]
    ds_read_b128 v[68:71], v223 offset:320
    s_waitcnt lgkmcnt(10)
    v_mfma_f32_16x16x32_bf16 v[12:15], v[140:143], v[76:79], v[12:15]
    ds_read_b128 v[72:75], v223 offset:704
    s_waitcnt vmcnt(7) lgkmcnt(10)
    v_mfma_f32_16x16x32_bf16 v[4:7], v[144:147], v[80:83], v[4:7]
    ds_read_b128 v[76:79], v223 offset:1088
    s_waitcnt lgkmcnt(10)
    v_mfma_f32_16x16x32_bf16 v[8:11], v[144:147], v[84:87], v[8:11]
    ds_read_b128 v[80:83], v223 offset:384
    s_waitcnt lgkmcnt(10)
    v_mfma_f32_16x16x32_bf16 v[12:15], v[144:147], v[88:91], v[12:15]
    ds_read_b128 v[84:87], v223 offset:768
    s_waitcnt vmcnt(6) lgkmcnt(10)
    v_mfma_f32_16x16x32_bf16 v[4:7], v[148:151], v[92:95], v[4:7]
    ds_read_b128 v[88:91], v223 offset:1152
    s_waitcnt lgkmcnt(10)
    v_mfma_f32_16x16x32_bf16 v[8:11], v[148:151], v[48:51], v[8:11]
    ds_read_b128 v[92:95], v223 offset:448
    s_waitcnt lgkmcnt(10)
    v_mfma_f32_16x16x32_bf16 v[12:15], v[148:151], v[52:55], v[12:15]
    ds_read_b128 v[48:51], v223 offset:832
    s_waitcnt vmcnt(5) lgkmcnt(10)
    v_mfma_f32_16x16x32_bf16 v[4:7], v[152:155], v[56:59], v[4:7]
    ds_read_b128 v[52:55], v223 offset:1216
    s_waitcnt lgkmcnt(10)
    v_mfma_f32_16x16x32_bf16 v[8:11], v[152:155], v[60:63], v[8:11]
    ds_read_b128 v[56:59], v223 offset:512
    s_waitcnt lgkmcnt(10)
    v_mfma_f32_16x16x32_bf16 v[12:15], v[152:155], v[64:67], v[12:15]
    ds_read_b128 v[60:63], v223 offset:896
    s_waitcnt vmcnt(4) lgkmcnt(10)
    v_mfma_f32_16x16x32_bf16 v[4:7], v[156:159], v[68:71], v[4:7]
    ds_read_b128 v[64:67], v223 offset:1280
    s_waitcnt lgkmcnt(10)
    v_mfma_f32_16x16x32_bf16 v[8:11], v[156:159], v[72:75], v[8:11]
    ds_read_b128 v[68:71], v223 offset:576
    s_waitcnt lgkmcnt(10)
    v_mfma_f32_16x16x32_bf16 v[12:15], v[156:159], v[76:79], v[12:15]
    ds_read_b128 v[72:75], v223 offset:960
    s_waitcnt vmcnt(3) lgkmcnt(10)
    v_mfma_f32_16x16x32_bf16 v[4:7], v[160:163], v[80:83], v[4:7]
    ds_read_b128 v[76:79], v223 offset:1344
    s_waitcnt lgkmcnt(10)
    v_mfma_f32_16x16x32_bf16 v[8:11], v[160:163], v[84:87], v[8:11]
    ds_read_b128 v[80:83], v222 offset:3072
    s_waitcnt lgkmcnt(10)
    v_mfma_f32_16x16x32_bf16 v[12:15], v[160:163], v[88:91], v[12:15]
    ds_read_b128 v[84:87], v222 offset:3136
    s_waitcnt vmcnt(2) lgkmcnt(10)
    v_mfma_f32_16x16x32_bf16 v[4:7], v[164:167], v[92:95], v[4:7]
    ds_read_b128 v[88:91], v222 offset:3200
    s_waitcnt lgkmcnt(10)
    v_mfma_f32_16x16x32_bf16 v[8:11], v[164:167], v[48:51], v[8:11]
    ds_read_b128 v[92:95], v222 offset:3264
    s_waitcnt lgkmcnt(10)
    v_mfma_f32_16x16x32_bf16 v[12:15], v[164:167], v[52:55], v[12:15]
    ds_read_b128 v[48:51], v224 offset:0
    s_waitcnt vmcnt(1) lgkmcnt(10)
    v_mfma_f32_16x16x32_bf16 v[4:7], v[168:171], v[56:59], v[4:7]
    ds_read_b128 v[52:55], v224 offset:64
    s_waitcnt lgkmcnt(10)
    v_mfma_f32_16x16x32_bf16 v[8:11], v[168:171], v[60:63], v[8:11]
    ds_read_b128 v[56:59], v224 offset:128
    s_waitcnt lgkmcnt(10)
    v_mfma_f32_16x16x32_bf16 v[12:15], v[168:171], v[64:67], v[12:15]
    ds_read_b128 v[60:63], v224 offset:192
    s_waitcnt vmcnt(0) lgkmcnt(10)
    v_mfma_f32_16x16x32_bf16 v[4:7], v[172:175], v[68:71], v[4:7]
    ds_read_b128 v[64:67], v222 offset:3328
    s_waitcnt lgkmcnt(10)
    v_mfma_f32_16x16x32_bf16 v[8:11], v[172:175], v[72:75], v[8:11]
    ds_read_b128 v[68:71], v222 offset:3712
    s_waitcnt lgkmcnt(10)
    v_mfma_f32_16x16x32_bf16 v[12:15], v[172:175], v[76:79], v[12:15]
    ds_read_b128 v[72:75], v222 offset:4096
    s_waitcnt lgkmcnt(10)
    v_mfma_f32_16x16x32_bf16 v[16:19], v[96:99], v[80:83], 0
    ds_read_b128 v[76:79], v222 offset:3392
    s_waitcnt lgkmcnt(10)
    v_mfma_f32_16x16x32_bf16 v[16:19], v[100:103], v[84:87], v[16:19]
    ds_read_b128 v[80:83], v222 offset:3776
    s_waitcnt lgkmcnt(10)
    v_mfma_f32_16x16x32_bf16 v[16:19], v[104:107], v[88:91], v[16:19]
    ds_read_b128 v[84:87], v222 offset:4160
    s_waitcnt lgkmcnt(10)
    v_mfma_f32_16x16x32_bf16 v[16:19], v[108:111], v[92:95], v[16:19]
    ds_read_b128 v[88:91], v222 offset:3456
    s_waitcnt lgkmcnt(10)
    v_mfma_f32_16x16x32_bf16 v[16:19], v[112:115], v[48:51], v[16:19]
    ds_read_b128 v[92:95], v222 offset:3840
    s_waitcnt lgkmcnt(10)
    v_mfma_f32_16x16x32_bf16 v[16:19], v[116:119], v[52:55], v[16:19]
    ds_read_b128 v[48:51], v222 offset:4224
    s_waitcnt lgkmcnt(10)
    v_mfma_f32_16x16x32_bf16 v[16:19], v[120:123], v[56:59], v[16:19]
    ds_read_b128 v[52:55], v222 offset:3520
    s_waitcnt lgkmcnt(10)
    v_mfma_f32_16x16x32_bf16 v[16:19], v[124:127], v[60:63], v[16:19]
    ds_read_b128 v[56:59], v222 offset:3904
    s_waitcnt lgkmcnt(10)
    v_mfma_f32_16x16x32_bf16 v[20:23], v[128:131], v[64:67], 0
    ds_read_b128 v[60:63], v222 offset:4288
    s_waitcnt lgkmcnt(10)
    v_mfma_f32_16x16x32_bf16 v[24:27], v[128:131], v[68:71], 0
    ds_read_b128 v[64:67], v222 offset:3584
    s_waitcnt lgkmcnt(10)
    v_mfma_f32_16x16x32_bf16 v[28:31], v[128:131], v[72:75], 0
    ds_read_b128 v[68:71], v222 offset:3968
    s_waitcnt lgkmcnt(10)
    v_mfma_f32_16x16x32_bf16 v[20:23], v[132:135], v[76:79], v[20:23]
    ds_read_b128 v[72:75], v222 offset:4352
    s_waitcnt lgkmcnt(10)
    v_mfma_f32_16x16x32_bf16 v[24:27], v[132:135], v[80:83], v[24:27]
    ds_read_b128 v[76:79], v222 offset:3648
    s_waitcnt lgkmcnt(10)
    v_mfma_f32_16x16x32_bf16 v[28:31], v[132:135], v[84:87], v[28:31]
    ds_read_b128 v[80:83], v222 offset:4032
    s_waitcnt lgkmcnt(10)
    v_mfma_f32_16x16x32_bf16 v[20:23], v[136:139], v[88:91], v[20:23]
    ds_read_b128 v[84:87], v222 offset:4416
    s_waitcnt lgkmcnt(10)
    v_mfma_f32_16x16x32_bf16 v[24:27], v[136:139], v[92:95], v[24:27]
    ds_read_b128 v[88:91], v224 offset:256
    s_waitcnt lgkmcnt(10)
    v_mfma_f32_16x16x32_bf16 v[28:31], v[136:139], v[48:51], v[28:31]
    ds_read_b128 v[92:95], v224 offset:640
    s_waitcnt lgkmcnt(10)
    v_mfma_f32_16x16x32_bf16 v[20:23], v[140:143], v[52:55], v[20:23]
    ds_read_b128 v[48:51], v224 offset:1024
    s_waitcnt lgkmcnt(10)
    v_mfma_f32_16x16x32_bf16 v[24:27], v[140:143], v[56:59], v[24:27]
    ds_read_b128 v[52:55], v224 offset:320
    s_waitcnt lgkmcnt(10)
    v_mfma_f32_16x16x32_bf16 v[28:31], v[140:143], v[60:63], v[28:31]
    ds_read_b128 v[56:59], v224 offset:704
    s_waitcnt lgkmcnt(10)
    v_mfma_f32_16x16x32_bf16 v[20:23], v[144:147], v[64:67], v[20:23]
    ds_read_b128 v[60:63], v224 offset:1088
    s_waitcnt lgkmcnt(10)
    v_mfma_f32_16x16x32_bf16 v[24:27], v[144:147], v[68:71], v[24:27]
    ds_read_b128 v[64:67], v224 offset:384
    s_waitcnt lgkmcnt(10)
    v_mfma_f32_16x16x32_bf16 v[28:31], v[144:147], v[72:75], v[28:31]
    ds_read_b128 v[68:71], v224 offset:768
    s_waitcnt lgkmcnt(10)
    v_mfma_f32_16x16x32_bf16 v[20:23], v[148:151], v[76:79], v[20:23]
    ds_read_b128 v[72:75], v224 offset:1152
    s_waitcnt lgkmcnt(10)
    v_mfma_f32_16x16x32_bf16 v[24:27], v[148:151], v[80:83], v[24:27]
    ds_read_b128 v[76:79], v224 offset:448
    s_waitcnt lgkmcnt(10)
    v_mfma_f32_16x16x32_bf16 v[28:31], v[148:151], v[84:87], v[28:31]
    ds_read_b128 v[80:83], v224 offset:832
    s_waitcnt lgkmcnt(10)
    v_mfma_f32_16x16x32_bf16 v[20:23], v[152:155], v[88:91], v[20:23]
    ds_read_b128 v[84:87], v224 offset:1216
    s_waitcnt lgkmcnt(10)
    v_mfma_f32_16x16x32_bf16 v[24:27], v[152:155], v[92:95], v[24:27]
    ds_read_b128 v[88:91], v224 offset:512
    s_waitcnt lgkmcnt(10)
    v_mfma_f32_16x16x32_bf16 v[28:31], v[152:155], v[48:51], v[28:31]
    ds_read_b128 v[92:95], v224 offset:896
    s_waitcnt lgkmcnt(10)
    v_mfma_f32_16x16x32_bf16 v[20:23], v[156:159], v[52:55], v[20:23]
    ds_read_b128 v[48:51], v224 offset:1280
    s_waitcnt lgkmcnt(10)
    v_mfma_f32_16x16x32_bf16 v[24:27], v[156:159], v[56:59], v[24:27]
    ds_read_b128 v[52:55], v224 offset:576
    s_waitcnt lgkmcnt(10)
    v_mfma_f32_16x16x32_bf16 v[28:31], v[156:159], v[60:63], v[28:31]
    ds_read_b128 v[56:59], v224 offset:960
    s_waitcnt lgkmcnt(10)
    v_mfma_f32_16x16x32_bf16 v[20:23], v[160:163], v[64:67], v[20:23]
    ds_read_b128 v[60:63], v224 offset:1344
    s_waitcnt lgkmcnt(10)
    v_mfma_f32_16x16x32_bf16 v[24:27], v[160:163], v[68:71], v[24:27]
    ds_read_b128 v[64:67], v222 offset:6144
    s_waitcnt lgkmcnt(10)
    v_mfma_f32_16x16x32_bf16 v[28:31], v[160:163], v[72:75], v[28:31]
    ds_read_b128 v[68:71], v222 offset:6208
    s_waitcnt lgkmcnt(10)
    v_mfma_f32_16x16x32_bf16 v[20:23], v[164:167], v[76:79], v[20:23]
    ds_read_b128 v[72:75], v222 offset:6272
    s_waitcnt lgkmcnt(10)
    v_mfma_f32_16x16x32_bf16 v[24:27], v[164:167], v[80:83], v[24:27]
    ds_read_b128 v[76:79], v222 offset:6336
    s_waitcnt lgkmcnt(10)
    v_mfma_f32_16x16x32_bf16 v[28:31], v[164:167], v[84:87], v[28:31]
    ds_read_b128 v[80:83], v225 offset:0
    s_waitcnt lgkmcnt(10)
    v_mfma_f32_16x16x32_bf16 v[20:23], v[168:171], v[88:91], v[20:23]
    ds_read_b128 v[84:87], v225 offset:64
    s_waitcnt lgkmcnt(10)
    v_mfma_f32_16x16x32_bf16 v[24:27], v[168:171], v[92:95], v[24:27]
    ds_read_b128 v[88:91], v225 offset:128
    s_waitcnt lgkmcnt(10)
    v_mfma_f32_16x16x32_bf16 v[28:31], v[168:171], v[48:51], v[28:31]
    ds_read_b128 v[92:95], v225 offset:192
    s_waitcnt lgkmcnt(10)
    v_mfma_f32_16x16x32_bf16 v[20:23], v[172:175], v[52:55], v[20:23]
    ds_read_b128 v[48:51], v222 offset:6400
    s_waitcnt lgkmcnt(10)
    v_mfma_f32_16x16x32_bf16 v[24:27], v[172:175], v[56:59], v[24:27]
    ds_read_b128 v[52:55], v222 offset:6784
    s_waitcnt lgkmcnt(10)
    v_mfma_f32_16x16x32_bf16 v[28:31], v[172:175], v[60:63], v[28:31]
    ds_read_b128 v[56:59], v222 offset:7168
    s_waitcnt lgkmcnt(10)
    v_mfma_f32_16x16x32_bf16 v[32:35], v[96:99], v[64:67], 0
    ds_read_b128 v[60:63], v222 offset:6464
    s_waitcnt lgkmcnt(10)
    v_mfma_f32_16x16x32_bf16 v[32:35], v[100:103], v[68:71], v[32:35]
    ds_read_b128 v[64:67], v222 offset:6848
    s_waitcnt lgkmcnt(10)
    v_mfma_f32_16x16x32_bf16 v[32:35], v[104:107], v[72:75], v[32:35]
    ds_read_b128 v[68:71], v222 offset:7232
    s_waitcnt lgkmcnt(10)
    v_mfma_f32_16x16x32_bf16 v[32:35], v[108:111], v[76:79], v[32:35]
    ds_read_b128 v[72:75], v222 offset:6528
    s_waitcnt lgkmcnt(10)
    v_mfma_f32_16x16x32_bf16 v[32:35], v[112:115], v[80:83], v[32:35]
    ds_read_b128 v[76:79], v222 offset:6912
    s_waitcnt lgkmcnt(10)
    v_mfma_f32_16x16x32_bf16 v[32:35], v[116:119], v[84:87], v[32:35]
    ds_read_b128 v[80:83], v222 offset:7296
    s_waitcnt lgkmcnt(10)
    v_mfma_f32_16x16x32_bf16 v[32:35], v[120:123], v[88:91], v[32:35]
    ds_read_b128 v[84:87], v222 offset:6592
    s_waitcnt lgkmcnt(10)
    v_mfma_f32_16x16x32_bf16 v[32:35], v[124:127], v[92:95], v[32:35]
    ds_read_b128 v[88:91], v222 offset:6976
    s_waitcnt lgkmcnt(10)
    v_mfma_f32_16x16x32_bf16 v[36:39], v[128:131], v[48:51], 0
    ds_read_b128 v[92:95], v222 offset:7360
    s_waitcnt lgkmcnt(10)
    v_mfma_f32_16x16x32_bf16 v[40:43], v[128:131], v[52:55], 0
    ds_read_b128 v[48:51], v222 offset:6656
    s_waitcnt lgkmcnt(10)
    v_mfma_f32_16x16x32_bf16 v[44:47], v[128:131], v[56:59], 0
    ds_read_b128 v[52:55], v222 offset:7040
    s_waitcnt lgkmcnt(10)
    v_mfma_f32_16x16x32_bf16 v[36:39], v[132:135], v[60:63], v[36:39]
    ds_read_b128 v[56:59], v222 offset:7424
    s_waitcnt lgkmcnt(10)
    v_mfma_f32_16x16x32_bf16 v[40:43], v[132:135], v[64:67], v[40:43]
    ds_read_b128 v[60:63], v222 offset:6720
    s_waitcnt lgkmcnt(10)
    v_mfma_f32_16x16x32_bf16 v[44:47], v[132:135], v[68:71], v[44:47]
    ds_read_b128 v[64:67], v222 offset:7104
    s_waitcnt lgkmcnt(10)
    v_mfma_f32_16x16x32_bf16 v[36:39], v[136:139], v[72:75], v[36:39]
    ds_read_b128 v[68:71], v222 offset:7488
    s_waitcnt lgkmcnt(10)
    v_mfma_f32_16x16x32_bf16 v[40:43], v[136:139], v[76:79], v[40:43]
    ds_read_b128 v[72:75], v225 offset:256
    s_waitcnt lgkmcnt(10)
    v_mfma_f32_16x16x32_bf16 v[44:47], v[136:139], v[80:83], v[44:47]
    ds_read_b128 v[76:79], v225 offset:640
    s_waitcnt lgkmcnt(10)
    v_mfma_f32_16x16x32_bf16 v[36:39], v[140:143], v[84:87], v[36:39]
    ds_read_b128 v[80:83], v225 offset:1024
    s_waitcnt lgkmcnt(10)
    v_mfma_f32_16x16x32_bf16 v[40:43], v[140:143], v[88:91], v[40:43]
    ds_read_b128 v[84:87], v225 offset:320
    s_waitcnt lgkmcnt(10)
    v_mfma_f32_16x16x32_bf16 v[44:47], v[140:143], v[92:95], v[44:47]
    ds_read_b128 v[88:91], v225 offset:704
    s_waitcnt lgkmcnt(10)
    v_mfma_f32_16x16x32_bf16 v[36:39], v[144:147], v[48:51], v[36:39]
    ds_read_b128 v[92:95], v225 offset:1088
    s_waitcnt lgkmcnt(10)
    v_mfma_f32_16x16x32_bf16 v[40:43], v[144:147], v[52:55], v[40:43]
    ds_read_b128 v[48:51], v225 offset:384
    s_waitcnt lgkmcnt(10)
    v_mfma_f32_16x16x32_bf16 v[44:47], v[144:147], v[56:59], v[44:47]
    ds_read_b128 v[52:55], v225 offset:768
    s_waitcnt lgkmcnt(10)
    v_mfma_f32_16x16x32_bf16 v[36:39], v[148:151], v[60:63], v[36:39]
    ds_read_b128 v[56:59], v225 offset:1152
    s_waitcnt lgkmcnt(10)
    v_mfma_f32_16x16x32_bf16 v[40:43], v[148:151], v[64:67], v[40:43]
    ds_read_b128 v[60:63], v225 offset:448
    s_waitcnt lgkmcnt(10)
    v_mfma_f32_16x16x32_bf16 v[44:47], v[148:151], v[68:71], v[44:47]
    ds_read_b128 v[64:67], v225 offset:832
    s_waitcnt lgkmcnt(10)
    v_mfma_f32_16x16x32_bf16 v[36:39], v[152:155], v[72:75], v[36:39]
    ds_read_b128 v[68:71], v225 offset:1216
    s_waitcnt lgkmcnt(10)
    v_mfma_f32_16x16x32_bf16 v[40:43], v[152:155], v[76:79], v[40:43]
    ds_read_b128 v[72:75], v225 offset:512
    s_waitcnt lgkmcnt(10)
    v_mfma_f32_16x16x32_bf16 v[44:47], v[152:155], v[80:83], v[44:47]
    ds_read_b128 v[76:79], v225 offset:896
    s_waitcnt lgkmcnt(10)
    v_mfma_f32_16x16x32_bf16 v[36:39], v[156:159], v[84:87], v[36:39]
    ds_read_b128 v[80:83], v225 offset:1280
    s_waitcnt lgkmcnt(10)
    v_mfma_f32_16x16x32_bf16 v[40:43], v[156:159], v[88:91], v[40:43]
    ds_read_b128 v[84:87], v225 offset:576
    s_waitcnt lgkmcnt(10)
    v_mfma_f32_16x16x32_bf16 v[44:47], v[156:159], v[92:95], v[44:47]
    ds_read_b128 v[88:91], v225 offset:960
    s_waitcnt lgkmcnt(10)
    v_mfma_f32_16x16x32_bf16 v[36:39], v[160:163], v[48:51], v[36:39]
    ds_read_b128 v[92:95], v225 offset:1344
    s_waitcnt lgkmcnt(10)
    v_mfma_f32_16x16x32_bf16 v[40:43], v[160:163], v[52:55], v[40:43]
    s_waitcnt lgkmcnt(9)
    v_mfma_f32_16x16x32_bf16 v[44:47], v[160:163], v[56:59], v[44:47]
    s_waitcnt lgkmcnt(8)
    v_mfma_f32_16x16x32_bf16 v[36:39], v[164:167], v[60:63], v[36:39]
    s_waitcnt lgkmcnt(7)
    v_mfma_f32_16x16x32_bf16 v[40:43], v[164:167], v[64:67], v[40:43]
    s_waitcnt lgkmcnt(6)
    v_mfma_f32_16x16x32_bf16 v[44:47], v[164:167], v[68:71], v[44:47]
    s_waitcnt lgkmcnt(5)
    v_mfma_f32_16x16x32_bf16 v[36:39], v[168:171], v[72:75], v[36:39]
    s_waitcnt lgkmcnt(4)
    v_mfma_f32_16x16x32_bf16 v[40:43], v[168:171], v[76:79], v[40:43]
    s_waitcnt lgkmcnt(3)
    v_mfma_f32_16x16x32_bf16 v[44:47], v[168:171], v[80:83], v[44:47]
    s_waitcnt lgkmcnt(2)
    v_mfma_f32_16x16x32_bf16 v[36:39], v[172:175], v[84:87], v[36:39]
    s_waitcnt lgkmcnt(1)
    v_mfma_f32_16x16x32_bf16 v[40:43], v[172:175], v[88:91], v[40:43]
    s_waitcnt lgkmcnt(0)
    v_mfma_f32_16x16x32_bf16 v[44:47], v[172:175], v[92:95], v[44:47]
    s_lshl_b32 s60, s54, 9
    s_lshl_b32 s61, s20, 6
    s_add_u32 s60, s60, s61
    s_mul_i32 s60, s60, 192
    s_add_u32 s60, s60, 10485760
    v_mul_u32_u24 v227, 96, v252
    s_cmp_lg_u32 s28, 0
    s_cbranch_scc1 K2_NOACC
    buffer_load_dwordx4 v[48:51], v227, s[8:11], s60 offen offset:0
    buffer_load_dwordx4 v[52:55], v227, s[8:11], s60 offen offset:16
    buffer_load_dwordx4 v[56:59], v227, s[8:11], s60 offen offset:32
    buffer_load_dwordx4 v[60:63], v227, s[8:11], s60 offen offset:48
    buffer_load_dwordx4 v[64:67], v227, s[8:11], s60 offen offset:64
    buffer_load_dwordx4 v[68:71], v227, s[8:11], s60 offen offset:80
    buffer_load_dwordx4 v[72:75], v227, s[8:11], s60 offen offset:96
    buffer_load_dwordx4 v[76:79], v227, s[8:11], s60 offen offset:112
    buffer_load_dwordx4 v[80:83], v227, s[8:11], s60 offen offset:128
    buffer_load_dwordx4 v[84:87], v227, s[8:11], s60 offen offset:144
    buffer_load_dwordx4 v[88:91], v227, s[8:11], s60 offen offset:160
    buffer_load_dwordx4 v[92:95], v227, s[8:11], s60 offen offset:176
    s_waitcnt vmcnt(0)
    v_add_f32 v0, v0, v48
    v_add_f32 v1, v1, v49
    v_add_f32 v2, v2, v50
    v_add_f32 v3, v3, v51
    v_add_f32 v4, v4, v52
    v_add_f32 v5, v5, v53
    v_add_f32 v6, v6, v54
    v_add_f32 v7, v7, v55
    v_add_f32 v8, v8, v56
    v_add_f32 v9, v9, v57
    v_add_f32 v10, v10, v58
    v_add_f32 v11, v11, v59
    v_add_f32 v12, v12, v60
    v_add_f32 v13, v13, v61
    v_add_f32 v14, v14, v62
    v_add_f32 v15, v15, v63
    v_add_f32 v16, v16, v64
    v_add_f32 v17, v17, v65
    v_add_f32 v18, v18, v66
    v_add_f32 v19, v19, v67
    v_add_f32 v20, v20, v68
    v_add_f32 v21, v21, v69
    v_add_f32 v22, v22, v70
    v_add_f32 v23, v23, v71
    v_add_f32 v24, v24, v72
    v_add_f32 v25, v25, v73
    v_add_f32 v26, v26, v74
    v_add_f32 v27, v27, v75
    v_add_f32 v28, v28, v76
    v_add_f32 v29, v29, v77
    v_add_f32 v30, v30, v78
    v_add_f32 v31, v31, v79
    v_add_f32 v32, v32, v80
    v_add_f32 v33, v33, v81
    v_add_f32 v34, v34, v82
    v_add_f32 v35, v35, v83
    v_add_f32 v36, v36, v84
    v_add_f32 v37, v37, v85
    v_add_f32 v38, v38, v86
    v_add_f32 v39, v39, v87
    v_add_f32 v40, v40, v88
    v_add_f32 v41, v41, v89
    v_add_f32 v42, v42, v90
    v_add_f32 v43, v43, v91
    v_add_f32 v44, v44, v92
    v_add_f32 v45, v45, v93
    v_add_f32 v46, v46, v94
    v_add_f32 v47, v47, v95
K2_NOACC:
    s_barrier
    s_cmp_eq_u32 s55, 0
    s_cbranch_scc1 K2_SPILL
    v_mul_f32 v200, s63, v0
    v_mul_f32 v201, s63, v1
    v_mul_f32 v202, s63, v2
    v_mul_f32 v203, s63, v3
    v_exp_f32 v200, v200
    v_exp_f32 v201, v201
    v_exp_f32 v202, v202
    v_exp_f32 v203, v203
    v_add_f32 v200, 1.0, v200
    v_add_f32 v201, 1.0, v201
    v_add_f32 v202, 1.0, v202
    v_add_f32 v203, 1.0, v203
    v_rcp_f32 v200, v200
    v_rcp_f32 v201, v201
    v_rcp_f32 v202, v202
    v_rcp_f32 v203, v203
    v_cvt_pk_bf16_f32 v176, v0, v1
    v_cvt_pk_bf16_f32 v177, v2, v3
    v_mul_f32 v4, v4, v200
    v_mul_f32 v5, v5, v201
    v_mul_f32 v6, v6, v202
    v_mul_f32 v7, v7, v203
    v_cvt_pk_bf16_f32 v178, v4, v5
    v_cvt_pk_bf16_f32 v179, v6, v7
    v_mul_f32 v8, v8, v200
    v_mul_f32 v9, v9, v201
    v_mul_f32 v10, v10, v202
    v_mul_f32 v11, v11, v203
    v_cvt_pk_bf16_f32 v180, v8, v9
    v_cvt_pk_bf16_f32 v181, v10, v11
    v_mul_f32 v12, v12, v200
    v_mul_f32 v13, v13, v201
    v_mul_f32 v14, v14, v202
    v_mul_f32 v15, v15, v203
    v_cvt_pk_bf16_f32 v182, v12, v13
    v_cvt_pk_bf16_f32 v183, v14, v15
    ds_write_b64 v226, v[176:177] offset:0
    ds_write_b64 v226, v[178:179] offset:256
    ds_write_b64 v226, v[180:181] offset:512
    ds_write_b64 v226, v[182:183] offset:768
    s_waitcnt lgkmcnt(0)
    s_barrier
    ds_read_b128 v[192:195], v228 offset:0
    ds_read_b128 v[196:199], v228 offset:1536
    s_add_u32 s61, s20, 8
    v_readlane_b32 s41, v253, s61
    s_nop 0
    s_bfe_u32 s41, s41, 0x60015
    s_add_u32 s41, s41, s21
    s_lshl_b32 s41, s41, 10
    s_add_u32 s61, s20, 0
    v_readlane_b32 s40, v253, s61
    s_nop 0
    s_bfe_u32 s40, s40, 0x60015
    s_add_u32 s40, s40, s21
    s_lshl_b32 s40, s40, 10
    s_waitcnt lgkmcnt(0)
    buffer_store_dwordx4 v[192:195], v229, s[12:15], s40 offen sc1
    buffer_store_dwordx4 v[196:199], v229, s[12:15], s41 offen sc1
    v_mul_f32 v200, s63, v16
    v_mul_f32 v201, s63, v17
    v_mul_f32 v202, s63, v18
    v_mul_f32 v203, s63, v19
    v_exp_f32 v200, v200
    v_exp_f32 v201, v201
    v_exp_f32 v202, v202
    v_exp_f32 v203, v203
    v_add_f32 v200, 1.0, v200
    v_add_f32 v201, 1.0, v201
    v_add_f32 v202, 1.0, v202
    v_add_f32 v203, 1.0, v203
    v_rcp_f32 v200, v200
    v_rcp_f32 v201, v201
    v_rcp_f32 v202, v202
    v_rcp_f32 v203, v203
    v_cvt_pk_bf16_f32 v184, v16, v17
    v_cvt_pk_bf16_f32 v185, v18, v19
    v_mul_f32 v20, v20, v200
    v_mul_f32 v21, v21, v201
    v_mul_f32 v22, v22, v202
    v_mul_f32 v23, v23, v203
    v_cvt_pk_bf16_f32 v186, v20, v21
    v_cvt_pk_bf16_f32 v187, v22, v23
    v_mul_f32 v24, v24, v200
    v_mul_f32 v25, v25, v201
    v_mul_f32 v26, v26, v202
    v_mul_f32 v27, v27, v203
    v_cvt_pk_bf16_f32 v188, v24, v25
    v_cvt_pk_bf16_f32 v189, v26, v27
    v_mul_f32 v28, v28, v200
    v_mul_f32 v29, v29, v201
    v_mul_f32 v30, v30, v202
    v_mul_f32 v31, v31, v203
    v_cvt_pk_bf16_f32 v190, v28, v29
    v_cvt_pk_bf16_f32 v191, v30, v31
    ds_write_b64 v226, v[184:185] offset:3072
    ds_write_b64 v226, v[186:187] offset:3328
    ds_write_b64 v226, v[188:189] offset:3584
    ds_write_b64 v226, v[190:191] offset:3840
    s_waitcnt lgkmcnt(0)
    s_barrier
    ds_read_b128 v[192:195], v228 offset:3072
    ds_read_b128 v[196:199], v228 offset:4608
    s_add_u32 s61, s20, 24
    v_readlane_b32 s43, v253, s61
    s_nop 0
    s_bfe_u32 s43, s43, 0x60015
    s_add_u32 s43, s43, s21
    s_lshl_b32 s43, s43, 10
    s_add_u32 s61, s20, 16
    v_readlane_b32 s42, v253, s61
    s_nop 0
    s_bfe_u32 s42, s42, 0x60015
    s_add_u32 s42, s42, s21
    s_lshl_b32 s42, s42, 10
    s_waitcnt lgkmcnt(0)
    buffer_store_dwordx4 v[192:195], v229, s[12:15], s42 offen sc1
    buffer_store_dwordx4 v[196:199], v229, s[12:15], s43 offen sc1
    v_mul_f32 v200, s63, v32
    v_mul_f32 v201, s63, v33
    v_mul_f32 v202, s63, v34
    v_mul_f32 v203, s63, v35
    v_exp_f32 v200, v200
    v_exp_f32 v201, v201
    v_exp_f32 v202, v202
    v_exp_f32 v203, v203
    v_add_f32 v200, 1.0, v200
    v_add_f32 v201, 1.0, v201
    v_add_f32 v202, 1.0, v202
    v_add_f32 v203, 1.0, v203
    v_rcp_f32 v200, v200
    v_rcp_f32 v201, v201
    v_rcp_f32 v202, v202
    v_rcp_f32 v203, v203
    v_cvt_pk_bf16_f32 v176, v32, v33
    v_cvt_pk_bf16_f32 v177, v34, v35
    v_mul_f32 v36, v36, v200
    v_mul_f32 v37, v37, v201
    v_mul_f32 v38, v38, v202
    v_mul_f32 v39, v39, v203
    v_cvt_pk_bf16_f32 v178, v36, v37
    v_cvt_pk_bf16_f32 v179, v38, v39
    v_mul_f32 v40, v40, v200
    v_mul_f32 v41, v41, v201
    v_mul_f32 v42, v42, v202
    v_mul_f32 v43, v43, v203
    v_cvt_pk_bf16_f32 v180, v40, v41
    v_cvt_pk_bf16_f32 v181, v42, v43
    v_mul_f32 v44, v44, v200
    v_mul_f32 v45, v45, v201
    v_mul_f32 v46, v46, v202
    v_mul_f32 v47, v47, v203
    v_cvt_pk_bf16_f32 v182, v44, v45
    v_cvt_pk_bf16_f32 v183, v46, v47
    s_mov_b64 exec, s[56:57]
    ds_write_b64 v226, v[176:177] offset:6144
    ds_write_b64 v226, v[178:179] offset:6400
    ds_write_b64 v226, v[180:181] offset:6656
    ds_write_b64 v226, v[182:183] offset:6912
    s_mov_b64 exec, -1
    s_waitcnt lgkmcnt(0)
    s_barrier
    s_branch K2_LASTROW
K2_SPILL:
    buffer_store_dwordx4 v[0:3], v227, s[8:11], s60 offen offset:0
    buffer_store_dwordx4 v[4:7], v227, s[8:11], s60 offen offset:16
    buffer_store_dwordx4 v[8:11], v227, s[8:11], s60 offen offset:32
    buffer_store_dwordx4 v[12:15], v227, s[8:11], s60 offen offset:48
    buffer_store_dwordx4 v[16:19], v227, s[8:11], s60 offen offset:64
    buffer_store_dwordx4 v[20:23], v227, s[8:11], s60 offen offset:80
    buffer_store_dwordx4 v[24:27], v227, s[8:11], s60 offen offset:96
    buffer_store_dwordx4 v[28:31], v227, s[8:11], s60 offen offset:112
    buffer_store_dwordx4 v[32:35], v227, s[8:11], s60 offen offset:128
    buffer_store_dwordx4 v[36:39], v227, s[8:11], s60 offen offset:144
    buffer_store_dwordx4 v[40:43], v227, s[8:11], s60 offen offset:160
    buffer_store_dwordx4 v[44:47], v227, s[8:11], s60 offen offset:176
    s_mov_b32 s28, 0
    s_waitcnt vmcnt(0)
    s_cmp_lt_u32 s24, s25
    s_cbranch_scc1 K2_LOAD
    s_add_u32 s23, s23, 20
    s_branch K2_WINDOW
K2_END:
    s_endpgm
.section .rodata,"a"
.p2align 6
.amdhsa_kernel standalone__tensor_product_equiv_equiformer__graph_kernel
  .amdhsa_next_free_vgpr 256
  .amdhsa_next_free_sgpr 102
  .amdhsa_accum_offset 256
  .amdhsa_group_segment_fixed_size 0
  .amdhsa_kernarg_size 96
  .amdhsa_user_sgpr_count 2
  .amdhsa_user_sgpr_kernarg_segment_ptr 1
  .amdhsa_system_sgpr_workgroup_id_x 1
  .amdhsa_float_denorm_mode_32 3
.end_amdhsa_kernel
```

```asm
; @launch grid=(256,1,1) block=(512,1,1) lds=163840
.amdgcn_target "amdgcn-amd-amdhsa--gfx950"
.text
.globl standalone__tensor_product_equiv_equiformer__graph_kernel
.p2align 8
.type standalone__tensor_product_equiv_equiformer__graph_kernel,@function
standalone__tensor_product_equiv_equiformer__graph_kernel:
    s_cmp_ge_u32 s2, 256
    s_cbranch_scc1 K2_END
    s_load_dwordx16 s[80:95], s[0:1], 0
    s_load_dwordx4 s[96:99], s[0:1], 72
    s_load_dwordx2 s[100:101], s[0:1], 88
    s_memrealtime s[74:75]
    v_lshrrev_b32 v1, 6, v0
    s_mov_b32 s54, s2
    v_readfirstlane_b32 s20, v1
    v_and_b32 v8, 63, v0
    v_lshlrev_b32 v9, 4, v8
    v_mov_b32 v6, 0
    v_lshlrev_b32 v5, 4, v0
    v_mul_u32_u24 v4, 24, v0
    s_mul_i32 s64, s2, 5120
    s_mul_i32 s65, s2, 7680
    v_mov_b32 v176, v8
    v_mov_b32 v177, v0
    s_mul_i32 s21, s2, 625
    s_add_u32 s22, s21, 640
    s_add_u32 s21, s21, 15
    s_lshr_b32 s21, s21, 4
    s_lshr_b32 s22, s22, 4
    s_sub_u32 s22, s22, s21
    s_movk_i32 s39, 1024
    s_lshl_b32 s37, s20, 13
    s_mov_b32 s53, 163616
    s_lshl_b32 s52, s20, 2
    s_add_u32 s52, s52, s53
    s_add_u32 s68, s37, 0
    s_add_u32 s69, s37, 2048
    s_add_u32 s70, s37, 4096
    s_add_u32 s71, s37, 6144
    s_waitcnt lgkmcnt(0)
    s_mov_b32 s8, s100
    s_and_b32 s9, s101, 0xffff
    s_mov_b32 s10, 37748736
    s_mov_b32 s11, 0x20000
    s_cmp_ge_u32 s20, 5
    s_cbranch_scc1 KS_HELP
    s_cmp_ge_u32 s2, 250
    s_cbranch_scc1 KS_IDLE
    s_mov_b32 s40, s88
    s_and_b32 s41, s89, 0xffff
    s_mov_b32 s42, 1280000
    s_mov_b32 s43, 0x20000
    buffer_load_dwordx4 v[12:15], v5, s[40:43], s64 offen
    s_mov_b32 s44, s86
    s_and_b32 s45, s87, 0xffff
    s_mov_b32 s46, 1280000
    s_mov_b32 s47, 0x20000
    s_mov_b32 s48, s82
    s_and_b32 s49, s83, 0xffff
    s_mov_b32 s50, 1920000
    s_mov_b32 s51, 0x20000
    buffer_load_dwordx4 v[16:19], v5, s[44:47], s64 offen
    buffer_load_dwordx4 v[20:23], v4, s[48:51], s65 offen
    buffer_load_dwordx2 v[24:25], v4, s[48:51], s65 offen offset:16
    v_lshlrev_b32 v2, 2, v0
    v_mov_b32 v7, 1
    s_cmp_eq_u32 s20, 4
    s_cbranch_scc1 KS_NOCLR
    ds_write_b32 v2, v6
KS_NOCLR:
    s_waitcnt lgkmcnt(0)
    s_barrier
    v_mul_u32_u24 v76, 2979, v0
    v_lshrrev_b32 v76, 16, v76
    v_mul_u32_u24 v77, 2048, v76
    v_lshl_add_u32 v78, v0, 4, v77
    v_add_u32 v78, 67584, v78
    v_add_u32 v79, 67200, v78
    v_mov_b32 v80, -1
    v_mov_b32 v81, -1
    v_cmp_gt_u32 vcc, 14, v76
    v_cmp_gt_u32 s[56:57], 12, v76
    v_mov_b32 v82, -1
    v_mov_b32 v83, -1
    s_mov_b64 exec, vcc
    ds_write_b128 v78, v[80:83]
    ds_write_b128 v78, v[80:83] offset:33600
    s_mov_b64 exec, s[56:57]
    ds_write_b128 v79, v[80:83]
    s_mov_b64 exec, -1
    s_mov_b32 s4, s80
    s_and_b32 s5, s81, 0xffff
    s_mov_b32 s6, 10240000
    s_mov_b32 s7, 0x20000
    s_mov_b32 s12, s96
    s_and_b32 s13, s97, 0xffff
    s_mov_b32 s14, 10240000
    s_mov_b32 s15, 0x20000
    s_mov_b32 s16, s84
    s_and_b32 s17, s85, 0xffff
    s_mov_b32 s18, 10240000
    s_mov_b32 s19, 0x20000
    s_sub_u32 s80, s80, 1024
    s_subb_u32 s81, s81, 0
    s_mov_b32 s72, s80
    s_and_b32 s73, s81, 0xffff
    s_mov_b32 s74, 10241024
    s_mov_b32 s75, 0x20000
    s_mov_b32 s58, 429497
    s_movk_i32 s59, 625
    s_waitcnt vmcnt(3)
    v_mul_u32_u24 v28, s58, v12
    v_lshrrev_b32 v32, 27, v28
    v_bfe_u32 v36, v28, 24, 3
    v_lshlrev_b32 v32, 2, v32
    v_lshl_or_b32 v32, v36, 7, v32
    ds_add_rtn_u32 v36, v32, v7
    v_mul_u32_u24 v29, s58, v13
    v_lshrrev_b32 v33, 27, v29
    v_bfe_u32 v37, v29, 24, 3
    v_lshlrev_b32 v33, 2, v33
    v_lshl_or_b32 v33, v37, 7, v33
    ds_add_rtn_u32 v37, v33, v7
    v_mul_u32_u24 v30, s58, v14
    v_lshrrev_b32 v34, 27, v30
    v_bfe_u32 v38, v30, 24, 3
    v_lshlrev_b32 v34, 2, v34
    v_lshl_or_b32 v34, v38, 7, v34
    ds_add_rtn_u32 v38, v34, v7
    v_mul_u32_u24 v31, s58, v15
    v_lshrrev_b32 v35, 27, v31
    v_bfe_u32 v39, v31, 24, 3
    v_lshlrev_b32 v35, 2, v35
    v_lshl_or_b32 v35, v39, 7, v35
    ds_add_rtn_u32 v39, v35, v7
    v_lshrrev_b32 v28, 24, v28
    v_mad_u32_u24 v28, v28, s59, 15
    v_lshrrev_b32 v28, 4, v28
    v_sub_u32 v28, v12, v28
    v_add_u32 v12, 0, v2
    v_lshlrev_b32 v12, 14, v12
    v_lshl_or_b32 v28, v28, 25, v12
    v_lshrrev_b32 v29, 24, v29
    v_mad_u32_u24 v29, v29, s59, 15
    v_lshrrev_b32 v29, 4, v29
    v_sub_u32 v29, v13, v29
    v_add_u32 v13, 1, v2
    v_lshlrev_b32 v13, 14, v13
    v_lshl_or_b32 v29, v29, 25, v13
    v_lshrrev_b32 v30, 24, v30
    v_mad_u32_u24 v30, v30, s59, 15
    v_lshrrev_b32 v30, 4, v30
    v_sub_u32 v30, v14, v30
    v_add_u32 v14, 2, v2
    v_lshlrev_b32 v14, 14, v14
    v_lshl_or_b32 v30, v30, 25, v14
    v_lshrrev_b32 v31, 24, v31
    v_mad_u32_u24 v31, v31, s59, 15
    v_lshrrev_b32 v31, 4, v31
    v_sub_u32 v31, v15, v31
    v_add_u32 v15, 3, v2
    v_lshlrev_b32 v15, 14, v15
    v_lshl_or_b32 v31, v31, 25, v15
    v_mov_b32 v59, 163728
    s_mul_i32 s65, s2, 1152
    s_add_u32 s65, s65, 6291456
    s_mul_i32 s64, s2, 20608
    s_waitcnt lgkmcnt(0)
    s_barrier
    ds_read_b128 v[40:43], v9
    ds_read_b32 v59, v59
    s_waitcnt lgkmcnt(1)
    v_add_u32 v45, v40, v41
    v_add_u32 v46, v45, v42
    v_add_u32 v47, v46, v43
    v_mov_b32 v58, v47
    s_nop 1
    v_add_u32_dpp v58, v58, v58 row_shr:1 row_mask:0xf bank_mask:0xf bound_ctrl:0
    s_nop 1
    v_add_u32_dpp v58, v58, v58 row_shr:2 row_mask:0xf bank_mask:0xf bound_ctrl:0
    s_nop 1
    v_add_u32_dpp v58, v58, v58 row_shr:4 row_mask:0xf bank_mask:0xf bound_ctrl:0
    s_nop 1
    v_add_u32_dpp v58, v58, v58 row_shr:8 row_mask:0xf bank_mask:0xf bound_ctrl:0
    s_nop 1
    v_add_u32_dpp v58, v58, v58 row_bcast:15 row_mask:0xa bank_mask:0xf
    s_nop 1
    v_add_u32_dpp v58, v58, v58 row_bcast:31 row_mask:0xc bank_mask:0xf
    v_sub_u32 v48, v58, v47
    v_add_u32 v49, v48, v40
    v_add_u32 v50, v48, v45
    v_add_u32 v51, v48, v46
    ds_write_b128 v9, v[48:51] offset:1024
    s_waitcnt vmcnt(0) lgkmcnt(1)
    s_cmp_lg_u32 s20, 4
    s_cbranch_scc1 KS_NOPUB
    v_lshl_or_b32 v56, v49, 11, v48
    v_lshl_or_b32 v57, v51, 11, v50
    v_lshl_or_b32 v56, v59, 22, v56
    v_lshl_or_b32 v57, v59, 22, v57
    buffer_store_dwordx4 v[56:59], v9, s[8:11], s65 offen sc1
KS_NOPUB:
    s_waitcnt lgkmcnt(0)
    ds_read_b32 v32, v32 offset:1024
    ds_read_b32 v33, v33 offset:1024
    ds_read_b32 v34, v34 offset:1024
    ds_read_b32 v35, v35 offset:1024
    v_and_b32 v60, 0xffff, v59
    s_mov_b32 s58, 0xffff0000
    v_mov_b32 v40, v20
    v_lshl_or_b32 v41, v21, 16, v60
    v_mov_b32 v42, v59
    v_or_b32 v43, v28, v16
    v_alignbit_b32 v44, v22, v21, 16
    v_and_or_b32 v45, v22, s58, v60
    v_mov_b32 v46, v59
    v_or_b32 v47, v29, v17
    v_mov_b32 v48, v23
    v_lshl_or_b32 v49, v24, 16, v60
    v_mov_b32 v50, v59
    v_or_b32 v51, v30, v18
    v_alignbit_b32 v52, v25, v24, 16
    v_and_or_b32 v53, v25, s58, v60
    v_mov_b32 v54, v59
    v_or_b32 v55, v31, v19
    s_waitcnt lgkmcnt(0)
    v_add_lshl_u32 v32, v32, v36, 4
    ds_write_b128 v32, v[40:43] offset:2048
    v_add_lshl_u32 v33, v33, v37, 4
    ds_write_b128 v33, v[44:47] offset:2048
    v_add_lshl_u32 v34, v34, v38, 4
    ds_write_b128 v34, v[48:51] offset:2048
    v_add_lshl_u32 v35, v35, v39, 4
    ds_write_b128 v35, v[52:55] offset:2048
    s_waitcnt lgkmcnt(0)
    s_barrier
    ds_read_b128 v[12:15], v5 offset:2048
    ds_read_b128 v[16:19], v5 offset:7168
    ds_read_b128 v[20:23], v5 offset:12288
    ds_read_b128 v[24:27], v5 offset:17408
    s_waitcnt lgkmcnt(3)
    buffer_store_dwordx4 v[12:15], v5, s[8:11], s64 offen sc1
    s_add_u32 s64, s64, 5120
    s_waitcnt lgkmcnt(2)
    buffer_store_dwordx4 v[16:19], v5, s[8:11], s64 offen sc1
    s_add_u32 s64, s64, 5120
    s_waitcnt lgkmcnt(1)
    buffer_store_dwordx4 v[20:23], v5, s[8:11], s64 offen sc1
    s_add_u32 s64, s64, 5120
    s_waitcnt lgkmcnt(0)
    buffer_store_dwordx4 v[24:27], v5, s[8:11], s64 offen sc1
    s_branch KS_JOIN
KS_IDLE:
    s_barrier
    v_mul_u32_u24 v76, 2979, v0
    v_lshrrev_b32 v76, 16, v76
    v_mul_u32_u24 v77, 2048, v76
    v_lshl_add_u32 v78, v0, 4, v77
    v_add_u32 v78, 67584, v78
    v_add_u32 v79, 67200, v78
    v_mov_b32 v80, -1
    v_mov_b32 v81, -1
    v_cmp_gt_u32 vcc, 14, v76
    v_cmp_gt_u32 s[56:57], 12, v76
    v_mov_b32 v82, -1
    v_mov_b32 v83, -1
    s_mov_b64 exec, vcc
    ds_write_b128 v78, v[80:83]
    ds_write_b128 v78, v[80:83] offset:33600
    s_mov_b64 exec, s[56:57]
    ds_write_b128 v79, v[80:83]
    s_mov_b64 exec, -1
    s_mov_b32 s4, s80
    s_and_b32 s5, s81, 0xffff
    s_mov_b32 s6, 10240000
    s_mov_b32 s7, 0x20000
    s_mov_b32 s12, s96
    s_and_b32 s13, s97, 0xffff
    s_mov_b32 s14, 10240000
    s_mov_b32 s15, 0x20000
    s_mov_b32 s16, s84
    s_and_b32 s17, s85, 0xffff
    s_mov_b32 s18, 10240000
    s_mov_b32 s19, 0x20000
    s_sub_u32 s80, s80, 1024
    s_subb_u32 s81, s81, 0
    s_mov_b32 s72, s80
    s_and_b32 s73, s81, 0xffff
    s_mov_b32 s74, 10241024
    s_mov_b32 s75, 0x20000
    s_barrier
    s_branch KS_B3
KS_HELP:
    s_cmp_eq_u32 s20, 7
    s_cbranch_scc1 KS_TAG
    s_cmp_eq_u32 s20, 6
    s_cbranch_scc1 KS_RAW
    s_cmp_ge_u32 s2, 200
    s_cbranch_scc1 KS_NOW
    v_and_b32 v1, 15, v8
    v_lshrrev_b32 v3, 4, v8
    s_cmp_ge_u32 s2, 160
    s_cbranch_scc1 K1_WT
    s_cmp_ge_u32 s2, 64
    s_cbranch_scc1 K1_S1
    s_lshr_b32 s24, s2, 3
    s_and_b32 s25, s2, 7
    s_lshr_b32 s26, s25, 2
    s_bfe_u32 s27, s25, 0x10001
    s_and_b32 s28, s25, 1
    s_mov_b32 s60, s92
    s_and_b32 s61, s93, 0xffff
    s_mov_b32 s62, 65536
    s_mov_b32 s63, 0x20000
    s_branch K1_SC
K1_S1:
    s_sub_u32 s29, s2, 64
    s_mul_i32 s24, s29, 43
    s_lshr_b32 s24, s24, 9
    s_mul_i32 s25, s24, 12
    s_sub_u32 s25, s29, s25
    s_cmp_ge_u32 s25, 6
    s_cselect_b32 s26, 1, 0
    s_mul_i32 s27, s26, 6
    s_sub_u32 s27, s25, s27
    s_lshr_b32 s27, s27, 1
    s_and_b32 s28, s25, 1
    s_add_u32 s25, s25, 8
    s_mov_b32 s60, s94
    s_and_b32 s61, s95, 0xffff
    s_mov_b32 s62, 98304
    s_mov_b32 s63, 0x20000
K1_SC:
    s_lshl_b32 s27, s27, 7
    s_lshl_b32 s26, s26, 6
    s_lshl_b32 s28, s28, 4
    s_add_u32 s27, s27, s26
    s_add_u32 s27, s27, s28
    s_lshl_b32 s27, s27, 8
    s_lshl_b32 s26, s24, 5
    s_add_u32 s27, s27, s26
    s_add_u32 s29, s27, 8192
    v_lshlrev_b32 v3, 10, v3
    v_lshl_add_u32 v3, v1, 1, v3
    buffer_load_ushort v64, v3, s[60:63], s27 offen offset:0
    buffer_load_ushort v65, v3, s[60:63], s29 offen offset:0
    buffer_load_ushort v66, v3, s[60:63], s27 offen offset:256
    buffer_load_ushort v67, v3, s[60:63], s29 offen offset:256
    buffer_load_ushort v68, v3, s[60:63], s27 offen offset:512
    buffer_load_ushort v69, v3, s[60:63], s29 offen offset:512
    buffer_load_ushort v70, v3, s[60:63], s27 offen offset:768
    buffer_load_ushort v71, v3, s[60:63], s29 offen offset:768
    s_mul_i32 s24, s24, 20
    s_add_u32 s24, s24, s25
    s_lshl_b32 s24, s24, 10
    s_add_u32 s24, s24, 6946816
    s_branch K1_GO
K1_WT:
    s_sub_u32 s24, s2, 160
    s_cmp_ge_u32 s24, 20
    s_cselect_b32 s26, 1, 0
    s_mul_i32 s25, s26, 20
    s_sub_u32 s25, s24, s25
    s_lshr_b32 s27, s25, 2
    s_bfe_u32 s28, s25, 0x10001
    s_and_b32 s25, s25, 1
    s_mul_i32 s25, s25, 10240
    s_lshl_b32 s27, s27, 8
    s_lshl_b32 s26, s26, 7
    s_lshl_b32 s28, s28, 6
    s_add_u32 s27, s27, s26
    s_add_u32 s27, s27, s28
    s_add_u32 s27, s27, s25
    s_mov_b32 s60, s90
    s_and_b32 s61, s91, 0xffff
    s_mov_b32 s62, 20480
    s_mov_b32 s63, 0x20000
    v_and_b32 v1, 31, v8
    v_lshrrev_b32 v3, 5, v8
    v_mul_u32_u24 v3, 5120, v3
    v_lshl_add_u32 v3, v1, 1, v3
    v_mov_b32 v64, 0
    v_mov_b32 v66, 0
    v_mov_b32 v68, 0
    v_mov_b32 v70, 0
    buffer_load_ushort v65, v3, s[60:63], s27 offen offset:0
    buffer_load_ushort v67, v3, s[60:63], s27 offen offset:1280
    buffer_load_ushort v69, v3, s[60:63], s27 offen offset:2560
    buffer_load_ushort v71, v3, s[60:63], s27 offen offset:3840
    s_lshl_b32 s24, s24, 10
    s_add_u32 s24, s24, 7110656
K1_GO:
    s_barrier
    v_subrev_u32 v76, 320, v0
    v_mov_b32 v80, -1
    v_mov_b32 v77, 1.0
    v_cmp_gt_u32 vcc, 48, v76
    v_lshlrev_b32 v78, 4, v76
    v_add_u32 v78, 65536, v78
    v_cndmask_b32 v80, v80, 0, vcc
    v_cmp_gt_u32 vcc, 12, v76
    v_add_u32 v79, 64800, v78
    s_nop 0
    v_cndmask_b32 v80, v80, v77, vcc
    v_cmp_gt_u32 s[56:57], 54, v8
    v_mov_b32 v81, v80
    v_mov_b32 v82, v80
    v_mov_b32 v83, v80
    ds_write_b128 v78, v[80:83] offset:0
    ds_write_b128 v78, v[80:83] offset:2400
    ds_write_b128 v78, v[80:83] offset:4800
    ds_write_b128 v78, v[80:83] offset:7200
    ds_write_b128 v78, v[80:83] offset:9600
    ds_write_b128 v78, v[80:83] offset:12000
    ds_write_b128 v78, v[80:83] offset:14400
    ds_write_b128 v78, v[80:83] offset:16800
    ds_write_b128 v78, v[80:83] offset:19200
    ds_write_b128 v78, v[80:83] offset:21600
    ds_write_b128 v78, v[80:83] offset:24000
    ds_write_b128 v78, v[80:83] offset:26400
    ds_write_b128 v78, v[80:83] offset:28800
    ds_write_b128 v78, v[80:83] offset:31200
    ds_write_b128 v78, v[80:83] offset:33600
    ds_write_b128 v78, v[80:83] offset:36000
    ds_write_b128 v78, v[80:83] offset:38400
    ds_write_b128 v78, v[80:83] offset:40800
    ds_write_b128 v78, v[80:83] offset:43200
    ds_write_b128 v78, v[80:83] offset:45600
    ds_write_b128 v78, v[80:83] offset:48000
    ds_write_b128 v78, v[80:83] offset:50400
    ds_write_b128 v78, v[80:83] offset:52800
    ds_write_b128 v78, v[80:83] offset:55200
    ds_write_b128 v78, v[80:83] offset:57600
    ds_write_b128 v78, v[80:83] offset:60000
    ds_write_b128 v78, v[80:83] offset:62400
    ds_write_b128 v79, v[80:83] offset:0
    ds_write_b128 v79, v[80:83] offset:2400
    ds_write_b128 v79, v[80:83] offset:4800
    ds_write_b128 v79, v[80:83] offset:7200
    ds_write_b128 v79, v[80:83] offset:9600
    ds_write_b128 v79, v[80:83] offset:12000
    ds_write_b128 v79, v[80:83] offset:14400
    ds_write_b128 v79, v[80:83] offset:16800
    ds_write_b128 v79, v[80:83] offset:19200
    ds_write_b128 v79, v[80:83] offset:21600
    ds_write_b128 v79, v[80:83] offset:24000
    ds_write_b128 v79, v[80:83] offset:26400
    ds_write_b128 v79, v[80:83] offset:28800
    v_mov_b32 v59, 163728
    s_barrier
    ds_read_b32 v59, v59
    s_cmp_eq_u32 s20, 6
    s_cselect_b64 exec, s[56:57], -1
    ds_write_b128 v79, v[80:83] offset:31200
    s_mov_b64 exec, -1
    s_mov_b32 s4, s80
    s_and_b32 s5, s81, 0xffff
    s_mov_b32 s6, 10240000
    s_mov_b32 s7, 0x20000
    s_mov_b32 s12, s96
    s_and_b32 s13, s97, 0xffff
    s_mov_b32 s14, 10240000
    s_mov_b32 s15, 0x20000
    s_mov_b32 s16, s84
    s_and_b32 s17, s85, 0xffff
    s_mov_b32 s18, 10240000
    s_mov_b32 s19, 0x20000
    s_sub_u32 s80, s80, 1024
    s_subb_u32 s81, s81, 0
    s_mov_b32 s72, s80
    s_and_b32 s73, s81, 0xffff
    s_mov_b32 s74, 10241024
    s_mov_b32 s75, 0x20000
    s_waitcnt vmcnt(0)
    v_lshl_or_b32 v40, v65, 16, v64
    v_lshl_or_b32 v41, v67, 16, v66
    v_lshl_or_b32 v42, v69, 16, v68
    v_lshl_or_b32 v43, v71, 16, v70
    buffer_store_dwordx4 v[40:43], v9, s[8:11], s24 offen sc1
    s_waitcnt lgkmcnt(0)
    s_barrier
    s_lshl_b32 s24, s2, 2
    s_add_u32 s24, s24, 7176192
    s_mov_b64 exec, 1
    s_waitcnt vmcnt(0)
    buffer_store_dword v59, v6, s[8:11], s24 offen sc1
    s_mov_b64 exec, -1
    s_branch KS_JOIN
KS_RAW:
    s_barrier
    s_mov_b32 s60, s90
    s_and_b32 s61, s91, 0xffff
    s_mov_b32 s62, 20480
    s_mov_b32 s63, 0x20000
    s_mov_b32 m0, 24576
    s_movk_i32 s24, 0
    buffer_load_dwordx4 v9, s[60:63], s24 offen offset:0 lds
    buffer_load_dwordx4 v9, s[60:63], s24 offen offset:1024 lds
    buffer_load_dwordx4 v9, s[60:63], s24 offen offset:2048 lds
    buffer_load_dwordx4 v9, s[60:63], s24 offen offset:3072 lds
    s_mov_b32 m0, 28672
    s_movk_i32 s24, 4096
    buffer_load_dwordx4 v9, s[60:63], s24 offen offset:0 lds
    buffer_load_dwordx4 v9, s[60:63], s24 offen offset:1024 lds
    buffer_load_dwordx4 v9, s[60:63], s24 offen offset:2048 lds
    buffer_load_dwordx4 v9, s[60:63], s24 offen offset:3072 lds
    s_mov_b32 m0, 32768
    s_movk_i32 s24, 8192
    buffer_load_dwordx4 v9, s[60:63], s24 offen offset:0 lds
    buffer_load_dwordx4 v9, s[60:63], s24 offen offset:1024 lds
    buffer_load_dwordx4 v9, s[60:63], s24 offen offset:2048 lds
    buffer_load_dwordx4 v9, s[60:63], s24 offen offset:3072 lds
    s_mov_b32 m0, 36864
    s_movk_i32 s24, 12288
    buffer_load_dwordx4 v9, s[60:63], s24 offen offset:0 lds
    buffer_load_dwordx4 v9, s[60:63], s24 offen offset:1024 lds
    buffer_load_dwordx4 v9, s[60:63], s24 offen offset:2048 lds
    buffer_load_dwordx4 v9, s[60:63], s24 offen offset:3072 lds
    s_mov_b32 m0, 40960
    s_movk_i32 s24, 16384
    buffer_load_dwordx4 v9, s[60:63], s24 offen offset:0 lds
    buffer_load_dwordx4 v9, s[60:63], s24 offen offset:1024 lds
    buffer_load_dwordx4 v9, s[60:63], s24 offen offset:2048 lds
    buffer_load_dwordx4 v9, s[60:63], s24 offen offset:3072 lds
    s_branch KS_FILL
KS_NOW:
    s_barrier
KS_FILL:
    v_subrev_u32 v76, 320, v0
    v_mov_b32 v80, -1
    v_mov_b32 v77, 1.0
    v_cmp_gt_u32 vcc, 48, v76
    v_lshlrev_b32 v78, 4, v76
    v_add_u32 v78, 65536, v78
    v_cndmask_b32 v80, v80, 0, vcc
    v_cmp_gt_u32 vcc, 12, v76
    v_add_u32 v79, 64800, v78
    s_nop 0
    v_cndmask_b32 v80, v80, v77, vcc
    v_cmp_gt_u32 s[56:57], 54, v8
    v_mov_b32 v81, v80
    v_mov_b32 v82, v80
    v_mov_b32 v83, v80
    ds_write_b128 v78, v[80:83] offset:0
    ds_write_b128 v78, v[80:83] offset:2400
    ds_write_b128 v78, v[80:83] offset:4800
    ds_write_b128 v78, v[80:83] offset:7200
    ds_write_b128 v78, v[80:83] offset:9600
    ds_write_b128 v78, v[80:83] offset:12000
    ds_write_b128 v78, v[80:83] offset:14400
    ds_write_b128 v78, v[80:83] offset:16800
    ds_write_b128 v78, v[80:83] offset:19200
    ds_write_b128 v78, v[80:83] offset:21600
    ds_write_b128 v78, v[80:83] offset:24000
    ds_write_b128 v78, v[80:83] offset:26400
    ds_write_b128 v78, v[80:83] offset:28800
    ds_write_b128 v78, v[80:83] offset:31200
    ds_write_b128 v78, v[80:83] offset:33600
    ds_write_b128 v78, v[80:83] offset:36000
    ds_write_b128 v78, v[80:83] offset:38400
    ds_write_b128 v78, v[80:83] offset:40800
    ds_write_b128 v78, v[80:83] offset:43200
    ds_write_b128 v78, v[80:83] offset:45600
    ds_write_b128 v78, v[80:83] offset:48000
    ds_write_b128 v78, v[80:83] offset:50400
    ds_write_b128 v78, v[80:83] offset:52800
    ds_write_b128 v78, v[80:83] offset:55200
    ds_write_b128 v78, v[80:83] offset:57600
    ds_write_b128 v78, v[80:83] offset:60000
    ds_write_b128 v78, v[80:83] offset:62400
    ds_write_b128 v79, v[80:83] offset:0
    ds_write_b128 v79, v[80:83] offset:2400
    ds_write_b128 v79, v[80:83] offset:4800
    ds_write_b128 v79, v[80:83] offset:7200
    ds_write_b128 v79, v[80:83] offset:9600
    ds_write_b128 v79, v[80:83] offset:12000
    ds_write_b128 v79, v[80:83] offset:14400
    ds_write_b128 v79, v[80:83] offset:16800
    ds_write_b128 v79, v[80:83] offset:19200
    ds_write_b128 v79, v[80:83] offset:21600
    ds_write_b128 v79, v[80:83] offset:24000
    ds_write_b128 v79, v[80:83] offset:26400
    ds_write_b128 v79, v[80:83] offset:28800
    s_barrier
    s_cmp_eq_u32 s20, 6
    s_cselect_b64 exec, s[56:57], -1
    ds_write_b128 v79, v[80:83] offset:31200
    s_mov_b64 exec, -1
    s_mov_b32 s4, s80
    s_and_b32 s5, s81, 0xffff
    s_mov_b32 s6, 10240000
    s_mov_b32 s7, 0x20000
    s_mov_b32 s12, s96
    s_and_b32 s13, s97, 0xffff
    s_mov_b32 s14, 10240000
    s_mov_b32 s15, 0x20000
    s_mov_b32 s16, s84
    s_and_b32 s17, s85, 0xffff
    s_mov_b32 s18, 10240000
    s_mov_b32 s19, 0x20000
    s_sub_u32 s80, s80, 1024
    s_subb_u32 s81, s81, 0
    s_mov_b32 s72, s80
    s_and_b32 s73, s81, 0xffff
    s_mov_b32 s74, 10241024
    s_mov_b32 s75, 0x20000
    s_waitcnt vmcnt(0)
    s_branch KS_B3
KS_TAG:
    s_mov_b32 s60, s98
    s_and_b32 s61, s99, 0xffff
    s_mov_b32 s62, 256
    s_mov_b32 s63, 0x20000
    s_cmp_lg_u32 s2, 0
    s_cbranch_scc1 KS_TAGLD
    s_or_b32 s24, s74, 1
    v_mov_b32 v10, s24
    v_mov_b32 v11, 0
    s_mov_b64 exec, 1
    buffer_atomic_cmpswap v[10:11], v6, s[60:63], 0 offen sc1
KS_TAGLD:
    s_mov_b64 exec, 1
    v_mov_b32 v14, 0
    s_mov_b64 exec, -1
    s_barrier
    v_mov_b32 v76, 0
    v_mov_b32 v77, -1
    v_lshlrev_b32 v78, 2, v8
    v_add_u32 v78, 163424, v78
    s_mov_b64 exec, 0x1ff
    ds_write_b32 v78, v76 offset:192
    s_mov_b64 exec, 0xff
    ds_write_b32 v78, v77 offset:256
    s_mov_b64 exec, -1
    s_mov_b32 exec_hi, 0xffff
    ds_write_b32 v78, v76
    s_mov_b64 exec, 1
    ds_write_b32 v78, v76 offset:228
    s_mov_b64 exec, -1
    s_mov_b32 s4, s80
    s_and_b32 s5, s81, 0xffff
    s_mov_b32 s6, 10240000
    s_mov_b32 s7, 0x20000
    s_mov_b32 s12, s96
    s_and_b32 s13, s97, 0xffff
    s_mov_b32 s14, 10240000
    s_mov_b32 s15, 0x20000
    s_mov_b32 s16, s84
    s_and_b32 s17, s85, 0xffff
    s_mov_b32 s18, 10240000
    s_mov_b32 s19, 0x20000
    s_sub_u32 s80, s80, 1024
    s_subb_u32 s81, s81, 0
    s_mov_b32 s72, s80
    s_and_b32 s73, s81, 0xffff
    s_mov_b32 s74, 10241024
    s_mov_b32 s75, 0x20000
    s_mov_b64 exec, 1
    s_mov_b32 s24, 0x100000
    v_mov_b32 v12, 163728
KS_TAGW:
    buffer_load_dword v15, v6, s[60:63], 0 offen sc1
    s_waitcnt vmcnt(1)
    v_cmp_ne_u32 vcc, 0, v14
    s_nop 0
    s_cbranch_vccnz KS_TAGOK
    s_sub_u32 s24, s24, 1
    s_cbranch_scc1 K2_END
    buffer_load_dword v14, v6, s[60:63], 0 offen sc1
    s_waitcnt vmcnt(1)
    v_cmp_ne_u32 vcc, 0, v15
    s_nop 0
    s_cbranch_vccz KS_TAGW
    ds_write_b32 v12, v15
    s_branch KS_TAGOK2
KS_TAGOK:
    ds_write_b32 v12, v14
KS_TAGOK2:
    s_mov_b64 exec, -1
    s_waitcnt lgkmcnt(0)
    s_barrier
KS_B3:
    v_mov_b32 v59, 163728
    ds_read_b32 v59, v59
    s_waitcnt lgkmcnt(0)
    s_barrier
KS_JOIN:
    v_readfirstlane_b32 s2, v59
    s_mov_b32 s23, 0
    s_mov_b32 s28, 1
    s_mov_b32 s24, 0
    s_mov_b32 s25, 1
K2_CELLS:
    v_lshrrev_b32 v178, 1, v177
    v_min_u32 v178, 249, v178
    v_mul_u32_u24 v72, 1152, v178
    s_and_b32 s58, s54, 7
    s_lshl_b32 s58, s58, 7
    s_lshr_b32 s59, s54, 5
    s_lshl_b32 s59, s59, 4
    s_add_u32 s67, s58, s59
    s_add_u32 s67, s67, 6291456
    buffer_load_dwordx4 v[76:79], v72, s[8:11], s67 offen sc1
    v_and_b32 v84, 15, v176
    v_lshrrev_b32 v85, 5, v176
    v_bfe_u32 v86, v176, 4, 1
    v_lshrrev_b32 v87, 2, v84
    v_and_b32 v88, 3, v84
    v_lshl_add_u32 v89, v85, 3, v87
    v_lshlrev_b32 v249, 5, v89
    v_lshl_add_u32 v249, v88, 3, v249
    v_add_u32 v249, 864, v249
    v_mul_u32_u24 v250, 192, v86
    v_lshl_add_u32 v250, v85, 5, v250
    v_lshrrev_b32 v90, 1, v88
    v_lshl_add_u32 v90, v86, 1, v90
    v_bfe_u32 v91, v87, 1, 1
    v_lshlrev_b32 v91, 2, v91
    v_xor_b32 v90, v90, v91
    v_lshlrev_b32 v90, 4, v90
    v_lshl_add_u32 v90, v89, 7, v90
    v_and_b32 v91, 1, v88
    v_lshl_add_u32 v90, v91, 3, v90
    v_add_u32 v246, s37, v90
    v_xor_b32 v247, 64, v246
    v_lshrrev_b32 v90, 3, v176
    v_lshlrev_b32 v251, 2, v90
    v_add_u32 v251, 768, v251
    v_bfe_u32 v90, v90, 1, 1
    v_lshlrev_b32 v90, 2, v90
    v_and_b32 v91, 7, v176
    v_xor_b32 v90, v90, v91
    v_lshlrev_b32 v248, 4, v90
    v_lshlrev_b32 v252, 1, v176
    v_and_b32 v231, 1, v176
    v_lshlrev_b32 v231, 4, v231
    v_lshrrev_b32 v90, 1, v176
    v_lshlrev_b32 v90, 5, v90
    v_add_u32 v230, 864, v90
    s_lshl_b32 s59, s2, 22
    s_mov_b32 s60, 0x100000
    s_bfe_u32 s61, s54, 0x10004
    s_bfe_u32 s62, s54, 0x10003
    s_add_u32 s63, s61, s62
    s_mul_i32 s62, s62, 11
    s_sub_u32 s64, 11, s62
    v_cmp_gt_u32 vcc, 500, v177
    s_nop 0
    s_mov_b64 s[56:57], vcc
K2_POLL:
    s_waitcnt vmcnt(0)
    v_xor_b32 v73, s59, v76
    v_xor_b32 v74, s59, v77
    v_or_b32 v73, v73, v74
    v_xor_b32 v74, s2, v79
    v_lshrrev_b32 v73, 22, v73
    v_or_b32 v73, v73, v74
    v_cmp_ne_u32 vcc, 0, v73
    s_nop 0
    s_cbranch_vccz K2_POLLED
    s_sub_u32 s60, s60, 1
    s_cbranch_scc1 K2_END
    s_mov_b64 exec, vcc
    buffer_load_dwordx4 v[76:79], v72, s[8:11], s67 offen sc1
    s_mov_b64 exec, -1
    s_branch K2_POLL
K2_POLLED:
    s_set_gpr_idx_on s61, gpr_idx(SRC0)
    s_nop 0
    v_bfe_u32 v179, v76, s62, 11
    s_set_gpr_idx_idx s63
    s_nop 0
    v_bfe_u32 v73, v76, s64, 11
    s_set_gpr_idx_off
    v_sub_u32 v73, v73, v179
    v_cndmask_b32 v73, 0, v73, s[56:57]
    v_and_b32 v1, 1, v177
    v_add_u32 v1, s23, v1
    v_sub_u32 v180, v73, v1
    v_add_u32 v179, v179, v1
    v_mul_u32_u24 v181, 20608, v178
    v_lshl_add_u32 v181, v179, 4, v181
    v_mul_u32_u24 v178, 1280, v178
    s_mov_b32 s60, 0x100000
K2_RELOAD:
    v_cmp_lt_i32 vcc, 0, v180
    s_nop 0
    s_cbranch_vccz K2_LD_DONE
    s_mov_b64 exec, vcc
    buffer_load_dwordx4 v[0:3], v181, s[8:11], 0 offen offset:0 sc1
    v_cmp_lt_i32 vcc, 2, v180
    s_nop 0
    s_cbranch_vccz K2_LD_DONE
    s_mov_b64 exec, vcc
    buffer_load_dwordx4 v[4:7], v181, s[8:11], 0 offen offset:32 sc1
    v_cmp_lt_i32 vcc, 4, v180
    s_nop 0
    s_cbranch_vccz K2_LD_DONE
    s_mov_b64 exec, vcc
    buffer_load_dwordx4 v[8:11], v181, s[8:11], 0 offen offset:64 sc1
    v_cmp_lt_i32 vcc, 6, v180
    s_nop 0
    s_cbranch_vccz K2_LD_DONE
    s_mov_b64 exec, vcc
    buffer_load_dwordx4 v[12:15], v181, s[8:11], 0 offen offset:96 sc1
    v_cmp_lt_i32 vcc, 8, v180
    s_nop 0
    s_cbranch_vccz K2_LD_DONE
    s_mov_b64 exec, vcc
    buffer_load_dwordx4 v[16:19], v181, s[8:11], 0 offen offset:128 sc1
    v_cmp_lt_i32 vcc, 10, v180
    s_nop 0
    s_cbranch_vccz K2_LD_DONE
    s_mov_b64 exec, vcc
    buffer_load_dwordx4 v[20:23], v181, s[8:11], 0 offen offset:160 sc1
    v_cmp_lt_i32 vcc, 12, v180
    s_nop 0
    s_cbranch_vccz K2_LD_DONE
    s_mov_b64 exec, vcc
    buffer_load_dwordx4 v[24:27], v181, s[8:11], 0 offen offset:192 sc1
    v_cmp_lt_i32 vcc, 14, v180
    s_nop 0
    s_cbranch_vccz K2_LD_DONE
    s_mov_b64 exec, vcc
    buffer_load_dwordx4 v[28:31], v181, s[8:11], 0 offen offset:224 sc1
    v_cmp_lt_i32 vcc, 16, v180
    s_nop 0
    s_cbranch_vccz K2_LD_DONE
    s_mov_b64 exec, vcc
    buffer_load_dwordx4 v[32:35], v181, s[8:11], 0 offen offset:256 sc1
    v_cmp_lt_i32 vcc, 18, v180
    s_nop 0
    s_cbranch_vccz K2_LD_DONE
    s_mov_b64 exec, vcc
    buffer_load_dwordx4 v[36:39], v181, s[8:11], 0 offen offset:288 sc1
K2_LD_DONE:
    s_mov_b64 exec, -1
    s_cmp_eq_u32 s28, 0
    s_cbranch_scc1 K2_NOWRAW
    s_cmp_lg_u32 s60, 0x100000
    s_cbranch_scc1 K2_NOWRAW
    s_cmp_lg_u32 s20, 7
    s_cbranch_scc1 K2_NOFLG
    v_lshlrev_b32 v72, 4, v176
    s_mov_b32 s67, 7176192
    buffer_load_dwordx4 v[84:87], v72, s[8:11], s67 offen sc1
K2_NOFLG:
    v_lshrrev_b32 v60, 5, v176
    v_bfe_u32 v61, v176, 2, 2
    v_lshl_add_u32 v60, v60, 2, v61
    v_mul_u32_u24 v60, 1280, v60
    v_bfe_u32 v61, v176, 4, 1
    v_lshl_add_u32 v60, v61, 5, v60
    v_and_b32 v61, 3, v176
    v_lshl_add_u32 v60, v61, 3, v60
    ds_read_b64_tr_b16 v[136:137], v60 offset:24576
    ds_read_b64_tr_b16 v[138:139], v60 offset:34816
    ds_read_b64_tr_b16 v[140:141], v60 offset:24640
    ds_read_b64_tr_b16 v[142:143], v60 offset:34880
    ds_read_b64_tr_b16 v[144:145], v60 offset:24832
    ds_read_b64_tr_b16 v[146:147], v60 offset:35072
    ds_read_b64_tr_b16 v[148:149], v60 offset:24896
    ds_read_b64_tr_b16 v[150:151], v60 offset:35136
    ds_read_b64_tr_b16 v[152:153], v60 offset:25088
    ds_read_b64_tr_b16 v[154:155], v60 offset:35328
    ds_read_b64_tr_b16 v[156:157], v60 offset:25152
    ds_read_b64_tr_b16 v[158:159], v60 offset:35392
    ds_read_b64_tr_b16 v[160:161], v60 offset:25344
    ds_read_b64_tr_b16 v[162:163], v60 offset:35584
    ds_read_b64_tr_b16 v[164:165], v60 offset:25408
    ds_read_b64_tr_b16 v[166:167], v60 offset:35648
    ds_read_b64_tr_b16 v[168:169], v60 offset:25600
    ds_read_b64_tr_b16 v[170:171], v60 offset:35840
    ds_read_b64_tr_b16 v[172:173], v60 offset:25664
    ds_read_b64_tr_b16 v[174:175], v60 offset:35904
    s_waitcnt lgkmcnt(0)
    v_lshlrev_b32 v96, 16, v136
    v_and_b32 v97, 0xffff0000, v136
    v_lshlrev_b32 v98, 16, v137
    v_and_b32 v99, 0xffff0000, v137
    v_lshlrev_b32 v100, 16, v138
    v_and_b32 v101, 0xffff0000, v138
    v_lshlrev_b32 v102, 16, v139
    v_and_b32 v103, 0xffff0000, v139
    v_lshlrev_b32 v104, 16, v140
    v_and_b32 v105, 0xffff0000, v140
    v_lshlrev_b32 v106, 16, v141
    v_and_b32 v107, 0xffff0000, v141
    v_lshlrev_b32 v108, 16, v142
    v_and_b32 v109, 0xffff0000, v142
    v_lshlrev_b32 v110, 16, v143
    v_and_b32 v111, 0xffff0000, v143
    v_lshlrev_b32 v112, 16, v144
    v_and_b32 v113, 0xffff0000, v144
    v_lshlrev_b32 v114, 16, v145
    v_and_b32 v115, 0xffff0000, v145
    v_lshlrev_b32 v116, 16, v146
    v_and_b32 v117, 0xffff0000, v146
    v_lshlrev_b32 v118, 16, v147
    v_and_b32 v119, 0xffff0000, v147
    v_lshlrev_b32 v120, 16, v148
    v_and_b32 v121, 0xffff0000, v148
    v_lshlrev_b32 v122, 16, v149
    v_and_b32 v123, 0xffff0000, v149
    v_lshlrev_b32 v124, 16, v150
    v_and_b32 v125, 0xffff0000, v150
    v_lshlrev_b32 v126, 16, v151
    v_and_b32 v127, 0xffff0000, v151
    v_lshlrev_b32 v128, 16, v152
    v_and_b32 v129, 0xffff0000, v152
    v_lshlrev_b32 v130, 16, v153
    v_and_b32 v131, 0xffff0000, v153
    v_lshlrev_b32 v132, 16, v154
    v_and_b32 v133, 0xffff0000, v154
    v_lshlrev_b32 v134, 16, v155
    v_and_b32 v135, 0xffff0000, v155
    v_lshlrev_b32 v136, 16, v156
    v_and_b32 v137, 0xffff0000, v156
    v_lshlrev_b32 v138, 16, v157
    v_and_b32 v139, 0xffff0000, v157
    v_lshlrev_b32 v140, 16, v158
    v_and_b32 v141, 0xffff0000, v158
    v_lshlrev_b32 v142, 16, v159
    v_and_b32 v143, 0xffff0000, v159
    v_lshlrev_b32 v144, 16, v160
    v_and_b32 v145, 0xffff0000, v160
    v_lshlrev_b32 v146, 16, v161
    v_and_b32 v147, 0xffff0000, v161
    v_lshlrev_b32 v148, 16, v162
    v_and_b32 v149, 0xffff0000, v162
    v_lshlrev_b32 v150, 16, v163
    v_and_b32 v151, 0xffff0000, v163
    v_lshlrev_b32 v152, 16, v164
    v_and_b32 v153, 0xffff0000, v164
    v_lshlrev_b32 v154, 16, v165
    v_and_b32 v155, 0xffff0000, v165
    v_lshlrev_b32 v156, 16, v166
    v_and_b32 v157, 0xffff0000, v166
    v_lshlrev_b32 v158, 16, v167
    v_and_b32 v159, 0xffff0000, v167
    v_lshlrev_b32 v160, 16, v168
    v_and_b32 v161, 0xffff0000, v168
    v_lshlrev_b32 v162, 16, v169
    v_and_b32 v163, 0xffff0000, v169
    v_lshlrev_b32 v164, 16, v170
    v_and_b32 v165, 0xffff0000, v170
    v_lshlrev_b32 v166, 16, v171
    v_and_b32 v167, 0xffff0000, v171
    v_lshlrev_b32 v168, 16, v172
    v_and_b32 v169, 0xffff0000, v172
    v_lshlrev_b32 v170, 16, v173
    v_and_b32 v171, 0xffff0000, v173
    v_lshlrev_b32 v172, 16, v174
    v_and_b32 v173, 0xffff0000, v174
    v_lshlrev_b32 v174, 16, v175
    v_and_b32 v175, 0xffff0000, v175
K2_NOWRAW:
    s_mov_b32 s61, 0xffff
    s_mov_b64 s[62:63], 0
    s_waitcnt vmcnt(0)
    v_cmp_lt_i32 vcc, 0, v180
    s_nop 0
    s_cbranch_vccz K2_CK_DONE
    s_mov_b64 exec, vcc
    v_bfi_b32 v192, s61, v1, v2
    v_cmp_ne_u32 vcc, s2, v192
    s_nop 0
    s_or_b64 s[62:63], s[62:63], vcc
    v_cmp_lt_i32 vcc, 2, v180
    s_nop 0
    s_cbranch_vccz K2_CK_DONE
    s_mov_b64 exec, vcc
    v_bfi_b32 v192, s61, v5, v6
    v_cmp_ne_u32 vcc, s2, v192
    s_nop 0
    s_or_b64 s[62:63], s[62:63], vcc
    v_cmp_lt_i32 vcc, 4, v180
    s_nop 0
    s_cbranch_vccz K2_CK_DONE
    s_mov_b64 exec, vcc
    v_bfi_b32 v192, s61, v9, v10
    v_cmp_ne_u32 vcc, s2, v192
    s_nop 0
    s_or_b64 s[62:63], s[62:63], vcc
    v_cmp_lt_i32 vcc, 6, v180
    s_nop 0
    s_cbranch_vccz K2_CK_DONE
    s_mov_b64 exec, vcc
    v_bfi_b32 v192, s61, v13, v14
    v_cmp_ne_u32 vcc, s2, v192
    s_nop 0
    s_or_b64 s[62:63], s[62:63], vcc
    v_cmp_lt_i32 vcc, 8, v180
    s_nop 0
    s_cbranch_vccz K2_CK_DONE
    s_mov_b64 exec, vcc
    v_bfi_b32 v192, s61, v17, v18
    v_cmp_ne_u32 vcc, s2, v192
    s_nop 0
    s_or_b64 s[62:63], s[62:63], vcc
    v_cmp_lt_i32 vcc, 10, v180
    s_nop 0
    s_cbranch_vccz K2_CK_DONE
    s_mov_b64 exec, vcc
    v_bfi_b32 v192, s61, v21, v22
    v_cmp_ne_u32 vcc, s2, v192
    s_nop 0
    s_or_b64 s[62:63], s[62:63], vcc
    v_cmp_lt_i32 vcc, 12, v180
    s_nop 0
    s_cbranch_vccz K2_CK_DONE
    s_mov_b64 exec, vcc
    v_bfi_b32 v192, s61, v25, v26
    v_cmp_ne_u32 vcc, s2, v192
    s_nop 0
    s_or_b64 s[62:63], s[62:63], vcc
    v_cmp_lt_i32 vcc, 14, v180
    s_nop 0
    s_cbranch_vccz K2_CK_DONE
    s_mov_b64 exec, vcc
    v_bfi_b32 v192, s61, v29, v30
    v_cmp_ne_u32 vcc, s2, v192
    s_nop 0
    s_or_b64 s[62:63], s[62:63], vcc
    v_cmp_lt_i32 vcc, 16, v180
    s_nop 0
    s_cbranch_vccz K2_CK_DONE
    s_mov_b64 exec, vcc
    v_bfi_b32 v192, s61, v33, v34
    v_cmp_ne_u32 vcc, s2, v192
    s_nop 0
    s_or_b64 s[62:63], s[62:63], vcc
    v_cmp_lt_i32 vcc, 18, v180
    s_nop 0
    s_cbranch_vccz K2_CK_DONE
    s_mov_b64 exec, vcc
    v_bfi_b32 v192, s61, v37, v38
    v_cmp_ne_u32 vcc, s2, v192
    s_nop 0
    s_or_b64 s[62:63], s[62:63], vcc
K2_CK_DONE:
    s_mov_b64 exec, -1
    s_cmp_lg_u64 s[62:63], 0
    s_cbranch_scc1 K2_RETRY
    s_cmp_eq_u32 s20, 7
    s_cbranch_scc1 K2_FLGCK
K2_FLGOK:
    v_add_lshl_u32 v179, v179, v178, 2
    s_mov_b32 s66, 7340032
    v_mov_b32 v201, 1
    s_cmp_lg_u32 s24, 0
    s_cbranch_scc1 K2_RK_LOAD
    v_cmp_lt_i32 vcc, 20, v180
    s_nop 0
    s_cbranch_vccz K2_NOMORE
    v_mov_b32 v61, 163652
    ds_write_b32 v61, v201
K2_NOMORE:
    s_mov_b32 s58, 163424
    s_movk_i32 s59, 2400
    v_mov_b32 v202, 65536
    v_cmp_lt_i32 vcc, 0, v180
    s_nop 0
    s_cbranch_vccz K2_RK_A
    s_mov_b64 exec, vcc
    v_lshrrev_b32 v50, 25, v3
    v_lshl_add_u32 v40, v50, 2, s58
    ds_add_rtn_u32 v40, v40, v201
    v_mad_u32_u24 v50, v50, s59, v202
    v_bfe_u32 v60, v3, 14, 11
    v_add_lshl_u32 v60, v60, v178, 5
    v_and_b32 v3, 0x3fff, v3
    v_and_b32 v2, 0xffff0000, v1
    v_and_b32 v1, 0xffff0000, v0
    v_lshlrev_b32 v0, 16, v0
    v_cmp_lt_i32 vcc, 2, v180
    s_nop 0
    s_cbranch_vccz K2_RK_A
    s_mov_b64 exec, vcc
    v_lshrrev_b32 v51, 25, v7
    v_lshl_add_u32 v41, v51, 2, s58
    ds_add_rtn_u32 v41, v41, v201
    v_mad_u32_u24 v51, v51, s59, v202
    v_bfe_u32 v61, v7, 14, 11
    v_add_lshl_u32 v61, v61, v178, 5
    v_and_b32 v7, 0x3fff, v7
    v_and_b32 v6, 0xffff0000, v5
    v_and_b32 v5, 0xffff0000, v4
    v_lshlrev_b32 v4, 16, v4
    v_cmp_lt_i32 vcc, 4, v180
    s_nop 0
    s_cbranch_vccz K2_RK_A
    s_mov_b64 exec, vcc
    v_lshrrev_b32 v52, 25, v11
    v_lshl_add_u32 v42, v52, 2, s58
    ds_add_rtn_u32 v42, v42, v201
    v_mad_u32_u24 v52, v52, s59, v202
    v_bfe_u32 v62, v11, 14, 11
    v_add_lshl_u32 v62, v62, v178, 5
    v_and_b32 v11, 0x3fff, v11
    v_and_b32 v10, 0xffff0000, v9
    v_and_b32 v9, 0xffff0000, v8
    v_lshlrev_b32 v8, 16, v8
    v_cmp_lt_i32 vcc, 6, v180
    s_nop 0
    s_cbranch_vccz K2_RK_A
    s_mov_b64 exec, vcc
    v_lshrrev_b32 v53, 25, v15
    v_lshl_add_u32 v43, v53, 2, s58
    ds_add_rtn_u32 v43, v43, v201
    v_mad_u32_u24 v53, v53, s59, v202
    v_bfe_u32 v63, v15, 14, 11
    v_add_lshl_u32 v63, v63, v178, 5
    v_and_b32 v15, 0x3fff, v15
    v_and_b32 v14, 0xffff0000, v13
    v_and_b32 v13, 0xffff0000, v12
    v_lshlrev_b32 v12, 16, v12
    v_cmp_lt_i32 vcc, 8, v180
    s_nop 0
    s_cbranch_vccz K2_RK_A
    s_mov_b64 exec, vcc
    v_lshrrev_b32 v54, 25, v19
    v_lshl_add_u32 v44, v54, 2, s58
    ds_add_rtn_u32 v44, v44, v201
    v_mad_u32_u24 v54, v54, s59, v202
    v_bfe_u32 v64, v19, 14, 11
    v_add_lshl_u32 v64, v64, v178, 5
    v_and_b32 v19, 0x3fff, v19
    v_and_b32 v18, 0xffff0000, v17
    v_and_b32 v17, 0xffff0000, v16
    v_lshlrev_b32 v16, 16, v16
    v_cmp_lt_i32 vcc, 10, v180
    s_nop 0
    s_cbranch_vccz K2_RK_A
    s_mov_b64 exec, vcc
    v_lshrrev_b32 v55, 25, v23
    v_lshl_add_u32 v45, v55, 2, s58
    ds_add_rtn_u32 v45, v45, v201
    v_mad_u32_u24 v55, v55, s59, v202
    v_bfe_u32 v65, v23, 14, 11
    v_add_lshl_u32 v65, v65, v178, 5
    v_and_b32 v23, 0x3fff, v23
    v_and_b32 v22, 0xffff0000, v21
    v_and_b32 v21, 0xffff0000, v20
    v_lshlrev_b32 v20, 16, v20
    v_cmp_lt_i32 vcc, 12, v180
    s_nop 0
    s_cbranch_vccz K2_RK_A
    s_mov_b64 exec, vcc
    v_lshrrev_b32 v56, 25, v27
    v_lshl_add_u32 v46, v56, 2, s58
    ds_add_rtn_u32 v46, v46, v201
    v_mad_u32_u24 v56, v56, s59, v202
    v_bfe_u32 v66, v27, 14, 11
    v_add_lshl_u32 v66, v66, v178, 5
    v_and_b32 v27, 0x3fff, v27
    v_and_b32 v26, 0xffff0000, v25
    v_and_b32 v25, 0xffff0000, v24
    v_lshlrev_b32 v24, 16, v24
    v_cmp_lt_i32 vcc, 14, v180
    s_nop 0
    s_cbranch_vccz K2_RK_A
    s_mov_b64 exec, vcc
    v_lshrrev_b32 v57, 25, v31
    v_lshl_add_u32 v47, v57, 2, s58
    ds_add_rtn_u32 v47, v47, v201
    v_mad_u32_u24 v57, v57, s59, v202
    v_bfe_u32 v67, v31, 14, 11
    v_add_lshl_u32 v67, v67, v178, 5
    v_and_b32 v31, 0x3fff, v31
    v_and_b32 v30, 0xffff0000, v29
    v_and_b32 v29, 0xffff0000, v28
    v_lshlrev_b32 v28, 16, v28
    v_cmp_lt_i32 vcc, 16, v180
    s_nop 0
    s_cbranch_vccz K2_RK_A
    s_mov_b64 exec, vcc
    v_lshrrev_b32 v58, 25, v35
    v_lshl_add_u32 v48, v58, 2, s58
    ds_add_rtn_u32 v48, v48, v201
    v_mad_u32_u24 v58, v58, s59, v202
    v_bfe_u32 v68, v35, 14, 11
    v_add_lshl_u32 v68, v68, v178, 5
    v_and_b32 v35, 0x3fff, v35
    v_and_b32 v34, 0xffff0000, v33
    v_and_b32 v33, 0xffff0000, v32
    v_lshlrev_b32 v32, 16, v32
    v_cmp_lt_i32 vcc, 18, v180
    s_nop 0
    s_cbranch_vccz K2_RK_A
    s_mov_b64 exec, vcc
    v_lshrrev_b32 v59, 25, v39
    v_lshl_add_u32 v49, v59, 2, s58
    ds_add_rtn_u32 v49, v49, v201
    v_mad_u32_u24 v59, v59, s59, v202
    v_bfe_u32 v69, v39, 14, 11
    v_add_lshl_u32 v69, v69, v178, 5
    v_and_b32 v39, 0x3fff, v39
    v_and_b32 v38, 0xffff0000, v37
    v_and_b32 v37, 0xffff0000, v36
    v_lshlrev_b32 v36, 16, v36
K2_RK_A:
    s_mov_b64 exec, -1
    s_branch K2_RK_DONE
K2_RK_LOAD:
    s_movk_i32 s59, 2400
    v_mov_b32 v202, 65536
    s_waitcnt vmcnt(0)
    v_cmp_lt_i32 vcc, 0, v180
    s_nop 0
    s_cbranch_vccz K2_RK_B
    s_mov_b64 exec, vcc
    v_lshrrev_b32 v50, 25, v3
    buffer_load_dword v40, v179, s[8:11], s66 offen offset:0
    v_mad_u32_u24 v50, v50, s59, v202
    v_bfe_u32 v60, v3, 14, 11
    v_add_lshl_u32 v60, v60, v178, 5
    v_and_b32 v3, 0x3fff, v3
    v_and_b32 v2, 0xffff0000, v1
    v_and_b32 v1, 0xffff0000, v0
    v_lshlrev_b32 v0, 16, v0
    v_cmp_lt_i32 vcc, 2, v180
    s_nop 0
    s_cbranch_vccz K2_RK_B
    s_mov_b64 exec, vcc
    v_lshrrev_b32 v51, 25, v7
    buffer_load_dword v41, v179, s[8:11], s66 offen offset:8
    v_mad_u32_u24 v51, v51, s59, v202
    v_bfe_u32 v61, v7, 14, 11
    v_add_lshl_u32 v61, v61, v178, 5
    v_and_b32 v7, 0x3fff, v7
    v_and_b32 v6, 0xffff0000, v5
    v_and_b32 v5, 0xffff0000, v4
    v_lshlrev_b32 v4, 16, v4
    v_cmp_lt_i32 vcc, 4, v180
    s_nop 0
    s_cbranch_vccz K2_RK_B
    s_mov_b64 exec, vcc
    v_lshrrev_b32 v52, 25, v11
    buffer_load_dword v42, v179, s[8:11], s66 offen offset:16
    v_mad_u32_u24 v52, v52, s59, v202
    v_bfe_u32 v62, v11, 14, 11
    v_add_lshl_u32 v62, v62, v178, 5
    v_and_b32 v11, 0x3fff, v11
    v_and_b32 v10, 0xffff0000, v9
    v_and_b32 v9, 0xffff0000, v8
    v_lshlrev_b32 v8, 16, v8
    v_cmp_lt_i32 vcc, 6, v180
    s_nop 0
    s_cbranch_vccz K2_RK_B
    s_mov_b64 exec, vcc
    v_lshrrev_b32 v53, 25, v15
    buffer_load_dword v43, v179, s[8:11], s66 offen offset:24
    v_mad_u32_u24 v53, v53, s59, v202
    v_bfe_u32 v63, v15, 14, 11
    v_add_lshl_u32 v63, v63, v178, 5
    v_and_b32 v15, 0x3fff, v15
    v_and_b32 v14, 0xffff0000, v13
    v_and_b32 v13, 0xffff0000, v12
    v_lshlrev_b32 v12, 16, v12
    v_cmp_lt_i32 vcc, 8, v180
    s_nop 0
    s_cbranch_vccz K2_RK_B
    s_mov_b64 exec, vcc
    v_lshrrev_b32 v54, 25, v19
    buffer_load_dword v44, v179, s[8:11], s66 offen offset:32
    v_mad_u32_u24 v54, v54, s59, v202
    v_bfe_u32 v64, v19, 14, 11
    v_add_lshl_u32 v64, v64, v178, 5
    v_and_b32 v19, 0x3fff, v19
    v_and_b32 v18, 0xffff0000, v17
    v_and_b32 v17, 0xffff0000, v16
    v_lshlrev_b32 v16, 16, v16
    v_cmp_lt_i32 vcc, 10, v180
    s_nop 0
    s_cbranch_vccz K2_RK_B
    s_mov_b64 exec, vcc
    v_lshrrev_b32 v55, 25, v23
    buffer_load_dword v45, v179, s[8:11], s66 offen offset:40
    v_mad_u32_u24 v55, v55, s59, v202
    v_bfe_u32 v65, v23, 14, 11
    v_add_lshl_u32 v65, v65, v178, 5
    v_and_b32 v23, 0x3fff, v23
    v_and_b32 v22, 0xffff0000, v21
    v_and_b32 v21, 0xffff0000, v20
    v_lshlrev_b32 v20, 16, v20
    v_cmp_lt_i32 vcc, 12, v180
    s_nop 0
    s_cbranch_vccz K2_RK_B
    s_mov_b64 exec, vcc
    v_lshrrev_b32 v56, 25, v27
    buffer_load_dword v46, v179, s[8:11], s66 offen offset:48
    v_mad_u32_u24 v56, v56, s59, v202
    v_bfe_u32 v66, v27, 14, 11
    v_add_lshl_u32 v66, v66, v178, 5
    v_and_b32 v27, 0x3fff, v27
    v_and_b32 v26, 0xffff0000, v25
    v_and_b32 v25, 0xffff0000, v24
    v_lshlrev_b32 v24, 16, v24
    v_cmp_lt_i32 vcc, 14, v180
    s_nop 0
    s_cbranch_vccz K2_RK_B
    s_mov_b64 exec, vcc
    v_lshrrev_b32 v57, 25, v31
    buffer_load_dword v47, v179, s[8:11], s66 offen offset:56
    v_mad_u32_u24 v57, v57, s59, v202
    v_bfe_u32 v67, v31, 14, 11
    v_add_lshl_u32 v67, v67, v178, 5
    v_and_b32 v31, 0x3fff, v31
    v_and_b32 v30, 0xffff0000, v29
    v_and_b32 v29, 0xffff0000, v28
    v_lshlrev_b32 v28, 16, v28
    v_cmp_lt_i32 vcc, 16, v180
    s_nop 0
    s_cbranch_vccz K2_RK_B
    s_mov_b64 exec, vcc
    v_lshrrev_b32 v58, 25, v35
    buffer_load_dword v48, v179, s[8:11], s66 offen offset:64
    v_mad_u32_u24 v58, v58, s59, v202
    v_bfe_u32 v68, v35, 14, 11
    v_add_lshl_u32 v68, v68, v178, 5
    v_and_b32 v35, 0x3fff, v35
    v_and_b32 v34, 0xffff0000, v33
    v_and_b32 v33, 0xffff0000, v32
    v_lshlrev_b32 v32, 16, v32
    v_cmp_lt_i32 vcc, 18, v180
    s_nop 0
    s_cbranch_vccz K2_RK_B
    s_mov_b64 exec, vcc
    v_lshrrev_b32 v59, 25, v39
    buffer_load_dword v49, v179, s[8:11], s66 offen offset:72
    v_mad_u32_u24 v59, v59, s59, v202
    v_bfe_u32 v69, v39, 14, 11
    v_add_lshl_u32 v69, v69, v178, 5
    v_and_b32 v39, 0x3fff, v39
    v_and_b32 v38, 0xffff0000, v37
    v_and_b32 v37, 0xffff0000, v36
    v_lshlrev_b32 v36, 16, v36
K2_RK_B:
    s_mov_b64 exec, -1
    s_waitcnt vmcnt(0)
K2_RK_DONE:
    s_mul_i32 s67, s24, 48
    s_waitcnt lgkmcnt(0)
    v_cmp_lt_i32 vcc, 0, v180
    s_nop 0
    s_cbranch_vccz K2_SC_DONE
    v_subrev_u32 v192, s67, v40
    v_cmp_gt_u32 s[56:57], 48, v192
    s_nop 0
    s_and_b64 exec, vcc, s[56:57]
    s_cbranch_execz K2_sc_1
    v_lshl_add_u32 v194, v192, 5, v50
    v_lshl_add_u32 v195, v192, 2, v50
    v_and_b32 v196, 7, v192
    v_add_lshl_u32 v196, v196, v192, 1
    v_bfe_u32 v193, v192, 3, 1
    v_mad_i32_i24 v196, v193, -14, v196
    v_add_u32 v196, v196, v50
    ds_write_b32 v194, v60 offset:864
    ds_write2_b32 v195, v0, v1 offset0:48 offset1:96
    ds_write_b32 v195, v2 offset:576
    ds_write_b16 v196, v3 offset:768
K2_sc_1:
    s_mov_b64 exec, -1
    v_cmp_lt_i32 vcc, 2, v180
    s_nop 0
    s_cbranch_vccz K2_SC_DONE
    v_subrev_u32 v192, s67, v41
    v_cmp_gt_u32 s[56:57], 48, v192
    s_nop 0
    s_and_b64 exec, vcc, s[56:57]
    s_cbranch_execz K2_sc_2
    v_lshl_add_u32 v194, v192, 5, v51
    v_lshl_add_u32 v195, v192, 2, v51
    v_and_b32 v196, 7, v192
    v_add_lshl_u32 v196, v196, v192, 1
    v_bfe_u32 v193, v192, 3, 1
    v_mad_i32_i24 v196, v193, -14, v196
    v_add_u32 v196, v196, v51
    ds_write_b32 v194, v61 offset:864
    ds_write2_b32 v195, v4, v5 offset0:48 offset1:96
    ds_write_b32 v195, v6 offset:576
    ds_write_b16 v196, v7 offset:768
K2_sc_2:
    s_mov_b64 exec, -1
    v_cmp_lt_i32 vcc, 4, v180
    s_nop 0
    s_cbranch_vccz K2_SC_DONE
    v_subrev_u32 v192, s67, v42
    v_cmp_gt_u32 s[56:57], 48, v192
    s_nop 0
    s_and_b64 exec, vcc, s[56:57]
    s_cbranch_execz K2_sc_3
    v_lshl_add_u32 v194, v192, 5, v52
    v_lshl_add_u32 v195, v192, 2, v52
    v_and_b32 v196, 7, v192
    v_add_lshl_u32 v196, v196, v192, 1
    v_bfe_u32 v193, v192, 3, 1
    v_mad_i32_i24 v196, v193, -14, v196
    v_add_u32 v196, v196, v52
    ds_write_b32 v194, v62 offset:864
    ds_write2_b32 v195, v8, v9 offset0:48 offset1:96
    ds_write_b32 v195, v10 offset:576
    ds_write_b16 v196, v11 offset:768
K2_sc_3:
    s_mov_b64 exec, -1
    v_cmp_lt_i32 vcc, 6, v180
    s_nop 0
    s_cbranch_vccz K2_SC_DONE
    v_subrev_u32 v192, s67, v43
    v_cmp_gt_u32 s[56:57], 48, v192
    s_nop 0
    s_and_b64 exec, vcc, s[56:57]
    s_cbranch_execz K2_sc_4
    v_lshl_add_u32 v194, v192, 5, v53
    v_lshl_add_u32 v195, v192, 2, v53
    v_and_b32 v196, 7, v192
    v_add_lshl_u32 v196, v196, v192, 1
    v_bfe_u32 v193, v192, 3, 1
    v_mad_i32_i24 v196, v193, -14, v196
    v_add_u32 v196, v196, v53
    ds_write_b32 v194, v63 offset:864
    ds_write2_b32 v195, v12, v13 offset0:48 offset1:96
    ds_write_b32 v195, v14 offset:576
    ds_write_b16 v196, v15 offset:768
K2_sc_4:
    s_mov_b64 exec, -1
    v_cmp_lt_i32 vcc, 8, v180
    s_nop 0
    s_cbranch_vccz K2_SC_DONE
    v_subrev_u32 v192, s67, v44
    v_cmp_gt_u32 s[56:57], 48, v192
    s_nop 0
    s_and_b64 exec, vcc, s[56:57]
    s_cbranch_execz K2_sc_5
    v_lshl_add_u32 v194, v192, 5, v54
    v_lshl_add_u32 v195, v192, 2, v54
    v_and_b32 v196, 7, v192
    v_add_lshl_u32 v196, v196, v192, 1
    v_bfe_u32 v193, v192, 3, 1
    v_mad_i32_i24 v196, v193, -14, v196
    v_add_u32 v196, v196, v54
    ds_write_b32 v194, v64 offset:864
    ds_write2_b32 v195, v16, v17 offset0:48 offset1:96
    ds_write_b32 v195, v18 offset:576
    ds_write_b16 v196, v19 offset:768
K2_sc_5:
    s_mov_b64 exec, -1
    v_cmp_lt_i32 vcc, 10, v180
    s_nop 0
    s_cbranch_vccz K2_SC_DONE
    v_subrev_u32 v192, s67, v45
    v_cmp_gt_u32 s[56:57], 48, v192
    s_nop 0
    s_and_b64 exec, vcc, s[56:57]
    s_cbranch_execz K2_sc_6
    v_lshl_add_u32 v194, v192, 5, v55
    v_lshl_add_u32 v195, v192, 2, v55
    v_and_b32 v196, 7, v192
    v_add_lshl_u32 v196, v196, v192, 1
    v_bfe_u32 v193, v192, 3, 1
    v_mad_i32_i24 v196, v193, -14, v196
    v_add_u32 v196, v196, v55
    ds_write_b32 v194, v65 offset:864
    ds_write2_b32 v195, v20, v21 offset0:48 offset1:96
    ds_write_b32 v195, v22 offset:576
    ds_write_b16 v196, v23 offset:768
K2_sc_6:
    s_mov_b64 exec, -1
    v_cmp_lt_i32 vcc, 12, v180
    s_nop 0
    s_cbranch_vccz K2_SC_DONE
    v_subrev_u32 v192, s67, v46
    v_cmp_gt_u32 s[56:57], 48, v192
    s_nop 0
    s_and_b64 exec, vcc, s[56:57]
    s_cbranch_execz K2_sc_7
    v_lshl_add_u32 v194, v192, 5, v56
    v_lshl_add_u32 v195, v192, 2, v56
    v_and_b32 v196, 7, v192
    v_add_lshl_u32 v196, v196, v192, 1
    v_bfe_u32 v193, v192, 3, 1
    v_mad_i32_i24 v196, v193, -14, v196
    v_add_u32 v196, v196, v56
    ds_write_b32 v194, v66 offset:864
    ds_write2_b32 v195, v24, v25 offset0:48 offset1:96
    ds_write_b32 v195, v26 offset:576
    ds_write_b16 v196, v27 offset:768
K2_sc_7:
    s_mov_b64 exec, -1
    v_cmp_lt_i32 vcc, 14, v180
    s_nop 0
    s_cbranch_vccz K2_SC_DONE
    v_subrev_u32 v192, s67, v47
    v_cmp_gt_u32 s[56:57], 48, v192
    s_nop 0
    s_and_b64 exec, vcc, s[56:57]
    s_cbranch_execz K2_sc_8
    v_lshl_add_u32 v194, v192, 5, v57
    v_lshl_add_u32 v195, v192, 2, v57
    v_and_b32 v196, 7, v192
    v_add_lshl_u32 v196, v196, v192, 1
    v_bfe_u32 v193, v192, 3, 1
    v_mad_i32_i24 v196, v193, -14, v196
    v_add_u32 v196, v196, v57
    ds_write_b32 v194, v67 offset:864
    ds_write2_b32 v195, v28, v29 offset0:48 offset1:96
    ds_write_b32 v195, v30 offset:576
    ds_write_b16 v196, v31 offset:768
K2_sc_8:
    s_mov_b64 exec, -1
    v_cmp_lt_i32 vcc, 16, v180
    s_nop 0
    s_cbranch_vccz K2_SC_DONE
    v_subrev_u32 v192, s67, v48
    v_cmp_gt_u32 s[56:57], 48, v192
    s_nop 0
    s_and_b64 exec, vcc, s[56:57]
    s_cbranch_execz K2_sc_9
    v_lshl_add_u32 v194, v192, 5, v58
    v_lshl_add_u32 v195, v192, 2, v58
    v_and_b32 v196, 7, v192
    v_add_lshl_u32 v196, v196, v192, 1
    v_bfe_u32 v193, v192, 3, 1
    v_mad_i32_i24 v196, v193, -14, v196
    v_add_u32 v196, v196, v58
    ds_write_b32 v194, v68 offset:864
    ds_write2_b32 v195, v32, v33 offset0:48 offset1:96
    ds_write_b32 v195, v34 offset:576
    ds_write_b16 v196, v35 offset:768
K2_sc_9:
    s_mov_b64 exec, -1
    v_cmp_lt_i32 vcc, 18, v180
    s_nop 0
    s_cbranch_vccz K2_SC_DONE
    v_subrev_u32 v192, s67, v49
    v_cmp_gt_u32 s[56:57], 48, v192
    s_nop 0
    s_and_b64 exec, vcc, s[56:57]
    s_cbranch_execz K2_sc_10
    v_lshl_add_u32 v194, v192, 5, v59
    v_lshl_add_u32 v195, v192, 2, v59
    v_and_b32 v196, 7, v192
    v_add_lshl_u32 v196, v196, v192, 1
    v_bfe_u32 v193, v192, 3, 1
    v_mad_i32_i24 v196, v193, -14, v196
    v_add_u32 v196, v196, v59
    ds_write_b32 v194, v69 offset:864
    ds_write2_b32 v195, v36, v37 offset0:48 offset1:96
    ds_write_b32 v195, v38 offset:576
    ds_write_b16 v196, v39 offset:768
K2_sc_10:
    s_mov_b64 exec, -1
K2_SC_DONE:
    v_lshlrev_b32 v192, 2, v176
    v_add_u32 v192, 163424, v192
    v_mov_b32 v200, 163652
    v_mov_b32 v198, 0
    s_movk_i32 s26, 48
    s_waitcnt lgkmcnt(0)
    s_barrier
    ds_read_b32 v193, v192
    ds_read_b32 v200, v200
    v_cmp_gt_u32 s[56:57], s22, v176
    v_mad_u32_u24 v195, v176, s59, v202
    v_lshl_or_b32 v195, v176, 21, v195
    s_waitcnt lgkmcnt(0)
    v_cndmask_b32 v193, 0, v193, s[56:57]
    v_readfirstlane_b32 s27, v200
    v_cmp_lt_u32 vcc, 48, v193
    s_nop 0
    s_cbranch_vccnz K2_BIG
K2_TOK:
    v_subrev_u32 v194, s67, v193
    v_max_i32 v194, 1, v194
    v_min_i32 v194, s26, v194
    v_add_u32 v194, 15, v194
    v_lshrrev_b32 v194, 4, v194
    v_lshl_or_b32 v195, v194, 18, v195
    v_or_b32 v195, v195, v198
    v_mov_b32 v197, 425056
    v_cndmask_b32 v253, v197, v195, s[56:57]
    s_movk_i32 s40, 0
    s_movk_i32 s41, 256
    s_movk_i32 s42, 512
    s_movk_i32 s43, 768
    s_add_u32 s24, s24, 1
    s_cmp_ge_u32 s24, s25
    s_cselect_b32 s55, 1, 0
    s_cmp_eq_u32 s27, 0
    s_cselect_b32 s55, s55, 0
    s_mov_b32 s38, 0
    s_mov_b32 s34, 0
    s_mov_b32 s35, 0
    s_mov_b32 s36, 1
    s_mov_b32 s31, 0
    s_mov_b32 s58, s20
    v_readlane_b32 s3, v253, s58
    s_lshl_b32 s44, s34, 7
    s_lshl_b32 s60, s58, 5
    s_and_b32 s48, s3, 0x3ffff
    s_bfe_u32 s33, s3, 0x30012
    s_sub_u32 s60, s60, s48
    s_and_b32 s60, s60, 0xff
    s_add_u32 s60, s60, s48
    s_mul_i32 s35, s38, 6
    s_cmp_eq_u32 s34, 0
    s_cselect_b32 s35, s35, s60
    s_mov_b32 s45, s44
    s_add_u32 s47, s44, 256
    s_add_u32 s49, s48, 32
    s_add_u32 s60, s48, 64
    s_cmp_eq_u32 s33, 3
    s_cselect_b32 s46, s44, s47
    s_cselect_b32 s50, s60, s48
    s_cselect_b32 s51, s48, s49
    s_sub_u32 s60, s33, 2
    s_cmp_lt_u32 s60, 2
    s_cbranch_scc0 K2_rare_21
K2_back_22:
    v_add_u32 v233, s48, v230
    ds_read_b32 v232, v233
    ds_read_b32 v233, v233 offset:1024
    v_add_u32 v222, s48, v251
    ds_read_b32 v222, v222
    v_add_u32 v224, s49, v251
    ds_read_b32 v224, v224
    v_add_u32 v226, s50, v251
    ds_read_b32 v226, v226
    v_add_u32 v228, s51, v251
    ds_read_b32 v228, v228
    s_waitcnt lgkmcnt(4)
    v_or_b32 v232, v232, v231
    v_or_b32 v233, v233, v231
    s_cmp_lg_u32 s34, 0
    s_cbranch_scc1 K2_dum_24
    s_add_u32 m0, s48, 864
    s_add_u32 s65, s48, 1888
    buffer_load_dwordx4 v232, s[16:19], 0 offen  lds
    s_mov_b32 m0, s65
    s_mov_b32 exec_hi, 0
    buffer_load_dwordx4 v233, s[16:19], 0 offen  lds
    s_cmp_eq_u32 s33, 4
    s_cbranch_scc1 K2_a4_25
K2_b4_27:
    s_mov_b32 exec_hi, -1
K2_back_26:
    s_waitcnt lgkmcnt(3)
    v_mad_u32_u16 v223, v222, s39, v248 op_sel:[1,0,0,0]
    v_mad_u32_u16 v222, v222, s39, v248
    s_waitcnt lgkmcnt(2)
    v_mad_u32_u16 v225, v224, s39, v248 op_sel:[1,0,0,0]
    v_mad_u32_u16 v224, v224, s39, v248
    s_waitcnt lgkmcnt(1)
    v_mad_u32_u16 v227, v226, s39, v248 op_sel:[1,0,0,0]
    v_mad_u32_u16 v226, v226, s39, v248
    s_waitcnt lgkmcnt(0)
    v_mad_u32_u16 v229, v228, s39, v248 op_sel:[1,0,0,0]
    v_mad_u32_u16 v228, v228, s39, v248
    s_mov_b32 m0, s68
    s_nop 0
    buffer_load_dwordx4 v222, s[4:7], s44 offen lds
    buffer_load_dwordx4 v223, s[72:75], s44 offen offset:1024 lds
    s_barrier
    s_mov_b32 m0, s69
    s_nop 0
    buffer_load_dwordx4 v224, s[4:7], s45 offen lds
    buffer_load_dwordx4 v225, s[72:75], s45 offen offset:1024 lds
    s_mov_b32 m0, s70
    s_nop 0
    buffer_load_dwordx4 v226, s[4:7], s46 offen lds
    buffer_load_dwordx4 v227, s[72:75], s46 offen offset:1024 lds
    s_mov_b32 m0, s71
    s_nop 0
    buffer_load_dwordx4 v228, s[4:7], s47 offen lds
    buffer_load_dwordx4 v229, s[72:75], s47 offen offset:1024 lds
    v_add_u32 v249, s48, v249
    v_add_u32 v250, s48, v250
    s_waitcnt vmcnt(6)
    ds_read_b64_tr_b16 v[176:177], v246 offset:0
    ds_read_b64_tr_b16 v[178:179], v246 offset:512
    ds_read_b64_tr_b16 v[180:181], v247 offset:0
    ds_read_b64_tr_b16 v[182:183], v247 offset:512
    ds_read_b64_tr_b16 v[0:1], v249 offset:0
    ds_read_b64_tr_b16 v[2:3], v249 offset:128
    ds_read_b128 v[4:7], v250 offset:0
    ds_read_b128 v[8:11], v250 offset:16
    ds_read_b128 v[12:15], v250 offset:384
    ds_read_b128 v[16:19], v250 offset:400
    ds_read_b64_tr_b16 v[20:21], v249 offset:512
    ds_read_b64_tr_b16 v[22:23], v249 offset:640
    ds_read_b128 v[24:27], v250 offset:64
    ds_read_b128 v[28:31], v250 offset:80
    ds_read_b128 v[32:35], v250 offset:448
    ds_read_b128 v[36:39], v250 offset:464
    s_mov_b32 s29, s48
    s_mov_b32 s32, s31
    s_mov_b32 s30, s3
    s_mov_b32 s31, s35
    s_cmp_eq_u32 s33, 2
    s_cbranch_scc1 K2_U20
    s_cmp_eq_u32 s33, 3
    s_cbranch_scc1 K2_U30
    s_cmp_eq_u32 s33, 1
    s_cbranch_scc1 K2_U10
    s_branch K2_U40
K2_U20:
    s_setprio 1
    s_waitcnt lgkmcnt(10)
    v_lshlrev_b32 v40, 16, v0
    v_and_b32 v41, 0xffff0000, v0
    v_lshlrev_b32 v42, 16, v1
    v_and_b32 v43, 0xffff0000, v1
    v_lshlrev_b32 v44, 16, v2
    v_and_b32 v45, 0xffff0000, v2
    v_lshlrev_b32 v46, 16, v3
    v_and_b32 v47, 0xffff0000, v3
    s_waitcnt lgkmcnt(8)
    v_mul_f32 v4, v40, v4
    v_mul_f32 v5, v41, v5
    v_mul_f32 v6, v42, v6
    v_mul_f32 v7, v43, v7
    v_mul_f32 v8, v44, v8
    v_mul_f32 v9, v45, v9
    v_mul_f32 v10, v46, v10
    v_mul_f32 v11, v47, v11
    v_cvt_pk_bf16_f32 v64, v4, v5
    v_cvt_pk_bf16_f32 v65, v6, v7
    v_cvt_pk_bf16_f32 v66, v8, v9
    v_cvt_pk_bf16_f32 v67, v10, v11
    s_waitcnt lgkmcnt(6)
    v_mul_f32 v12, v40, v12
    v_mul_f32 v13, v41, v13
    v_mul_f32 v14, v42, v14
    v_mul_f32 v15, v43, v15
    v_mul_f32 v16, v44, v16
    v_mul_f32 v17, v45, v17
    v_mul_f32 v18, v46, v18
    v_mul_f32 v19, v47, v19
    v_cvt_pk_bf16_f32 v68, v12, v13
    v_cvt_pk_bf16_f32 v69, v14, v15
    v_cvt_pk_bf16_f32 v70, v16, v17
    v_cvt_pk_bf16_f32 v71, v18, v19
    s_waitcnt lgkmcnt(4)
    v_lshlrev_b32 v48, 16, v20
    v_and_b32 v49, 0xffff0000, v20
    v_lshlrev_b32 v50, 16, v21
    v_and_b32 v51, 0xffff0000, v21
    v_lshlrev_b32 v52, 16, v22
    v_and_b32 v53, 0xffff0000, v22
    v_lshlrev_b32 v54, 16, v23
    v_and_b32 v55, 0xffff0000, v23
    s_waitcnt lgkmcnt(2)
    v_mul_f32 v24, v48, v24
    v_mul_f32 v25, v49, v25
    v_mul_f32 v26, v50, v26
    v_mul_f32 v27, v51, v27
    v_mul_f32 v28, v52, v28
    v_mul_f32 v29, v53, v29
    v_mul_f32 v30, v54, v30
    v_mul_f32 v31, v55, v31
    v_cvt_pk_bf16_f32 v72, v24, v25
    v_cvt_pk_bf16_f32 v73, v26, v27
    v_cvt_pk_bf16_f32 v74, v28, v29
    v_cvt_pk_bf16_f32 v75, v30, v31
    s_waitcnt lgkmcnt(0)
    v_mul_f32 v32, v48, v32
    v_mul_f32 v33, v49, v33
    v_mul_f32 v34, v50, v34
    v_mul_f32 v35, v51, v35
    v_mul_f32 v36, v52, v36
    v_mul_f32 v37, v53, v37
    v_mul_f32 v38, v54, v38
    v_mul_f32 v39, v55, v39
    v_cvt_pk_bf16_f32 v76, v32, v33
    v_cvt_pk_bf16_f32 v77, v34, v35
    v_cvt_pk_bf16_f32 v78, v36, v37
    v_cvt_pk_bf16_f32 v79, v38, v39
    s_waitcnt vmcnt(4)
    v_mfma_f32_32x32x16_bf16 v[0:15], v[64:67], v[176:179], 0
    ds_read_b64_tr_b16 v[184:185], v246 offset:2048
    ds_read_b64_tr_b16 v[186:187], v246 offset:2560
    ds_read_b64_tr_b16 v[188:189], v247 offset:2048
    ds_read_b64_tr_b16 v[190:191], v247 offset:2560
    s_mov_b32 m0, s68
    v_mfma_f32_32x32x16_bf16 v[16:31], v[68:71], v[176:179], 0
    buffer_load_dwordx4 v222, s[4:7], s42 offen lds
    buffer_load_dwordx4 v223, s[72:75], s42 offen offset:1024 lds
    v_permlane32_swap_b32 v242, v236
    v_permlane32_swap_b32 v243, v237
    s_add_u32 s38, s38, 1
    v_mfma_f32_32x32x16_bf16 v[32:47], v[64:67], v[180:183], 0
    v_permlane32_swap_b32 v244, v238
    v_permlane32_swap_b32 v245, v239
    v_permlane32_swap_b32 v240, v241
    v_add_f32 v242, v242, v236
    v_mfma_f32_32x32x16_bf16 v[48:63], v[68:71], v[180:183], 0
    v_add_f32 v243, v243, v237
    v_add_f32 v244, v244, v238
    v_add_f32 v245, v245, v239
    v_add_f32 v240, -v240, -v241
    v_mov_b32 v254, s52
    v_mov_b32 v255, s38
    s_waitcnt vmcnt(4) lgkmcnt(0)
    v_mfma_f32_32x32x16_bf16 v[0:15], v[72:75], v[184:187], v[0:15]
    ds_read_b64_tr_b16 v[176:177], v246 offset:4096
    ds_read_b64_tr_b16 v[178:179], v246 offset:4608
    ds_read_b64_tr_b16 v[180:181], v247 offset:4096
    ds_read_b64_tr_b16 v[182:183], v247 offset:4608
    s_lshl_b32 s58, s38, 3
    s_add_u32 s58, s58, s20
    s_mov_b32 m0, s69
    v_mfma_f32_32x32x16_bf16 v[16:31], v[76:79], v[184:187], v[16:31]
    buffer_load_dwordx4 v224, s[4:7], s42 offen lds
    buffer_load_dwordx4 v225, s[72:75], s42 offen offset:1024 lds
    s_set_gpr_idx_on s32, gpr_idx(DST)
    s_nop 0
    v_cvt_pk_bf16_f32 v195, v242, v243
    v_cvt_pk_bf16_f32 v196, v244, v245
    v_cvt_pk_bf16_f32 v197, v240, v240
    s_set_gpr_idx_off
    s_mov_b64 exec, 1
    ds_write_b32 v254, v255
    s_mov_b64 exec, -1
    s_cmp_lt_u32 s58, s22
    s_cbranch_scc0 K2_dyn_28
K2_back_29:
    v_readlane_b32 s3, v253, s58
    s_lshl_b32 s44, s34, 7
    s_lshl_b32 s60, s58, 5
    s_and_b32 s48, s3, 0x3ffff
    s_bfe_u32 s33, s3, 0x30012
    s_sub_u32 s60, s60, s48
    s_and_b32 s60, s60, 0xff
    s_add_u32 s60, s60, s48
    s_mul_i32 s35, s38, 6
    s_cmp_eq_u32 s34, 0
    s_cselect_b32 s35, s35, s60
    s_mov_b32 s45, s44
    s_add_u32 s47, s44, 256
    s_add_u32 s49, s48, 32
    s_add_u32 s60, s48, 64
    s_cmp_eq_u32 s33, 3
    s_cselect_b32 s46, s44, s47
    s_cselect_b32 s50, s60, s48
    s_cselect_b32 s51, s48, s49
    s_sub_u32 s60, s33, 2
    s_cmp_lt_u32 s60, 2
    s_cbranch_scc0 K2_rare_34
K2_back_35:
    v_mfma_f32_32x32x16_bf16 v[32:47], v[72:75], v[188:191], v[32:47]
    v_add_u32 v233, s48, v230
    ds_read_b32 v232, v233
    ds_read_b32 v233, v233 offset:1024
    v_mul_f32 v234, v0, v96
    v_mul_f32 v236, v8, v128
    v_fmac_f32 v234, v1, v97
    v_fmac_f32 v236, v9, v129
    v_mfma_f32_32x32x16_bf16 v[48:63], v[76:79], v[188:191], v[48:63]
    s_setprio 0
    v_fmac_f32 v234, v2, v98
    v_fmac_f32 v236, v10, v130
    v_fmac_f32 v234, v3, v99
    v_fmac_f32 v236, v11, v131
    v_fmac_f32 v234, v4, v100
    v_fmac_f32 v236, v12, v132
    v_fmac_f32 v234, v5, v101
    v_fmac_f32 v236, v13, v133
    v_fmac_f32 v234, v6, v102
    v_fmac_f32 v236, v14, v134
    v_fmac_f32 v234, v7, v103
    v_fmac_f32 v236, v15, v135
    v_mul_f32 v238, v16, v128
    v_mul_f32 v240, v24, v128
    v_fmac_f32 v238, v17, v129
    v_fmac_f32 v240, v25, v129
    v_fmac_f32 v238, v18, v130
    v_fmac_f32 v240, v26, v130
    v_fmac_f32 v238, v19, v131
    v_fmac_f32 v240, v27, v131
    v_fmac_f32 v238, v20, v132
    v_fmac_f32 v240, v28, v132
    v_fmac_f32 v238, v21, v133
    v_fmac_f32 v240, v29, v133
    v_fmac_f32 v238, v22, v134
    v_fmac_f32 v240, v30, v134
    v_fmac_f32 v238, v23, v135
    v_fmac_f32 v240, v31, v135
    v_mul_f32 v235, v32, v104
    v_mul_f32 v237, v40, v136
    v_fmac_f32 v235, v33, v105
    v_fmac_f32 v237, v41, v137
    v_fmac_f32 v235, v34, v106
    v_fmac_f32 v237, v42, v138
    v_fmac_f32 v235, v35, v107
    v_fmac_f32 v237, v43, v139
    v_fmac_f32 v235, v36, v108
    v_fmac_f32 v237, v44, v140
    v_fmac_f32 v235, v37, v109
    v_fmac_f32 v237, v45, v141
    v_fmac_f32 v235, v38, v110
    v_fmac_f32 v237, v46, v142
    v_fmac_f32 v235, v39, v111
    v_fmac_f32 v237, v47, v143
    v_mul_f32 v239, v48, v136
    v_mul_f32 v241, v56, v136
    v_fmac_f32 v239, v49, v137
    v_fmac_f32 v241, v57, v137
    s_setprio 1
    s_waitcnt vmcnt(4) lgkmcnt(3)
    v_mfma_f32_32x32x16_bf16 v[0:15], v[64:67], v[176:179], 0
    ds_read_b64_tr_b16 v[184:185], v246 offset:6144
    ds_read_b64_tr_b16 v[186:187], v246 offset:6656
    ds_read_b64_tr_b16 v[188:189], v247 offset:6144
    ds_read_b64_tr_b16 v[190:191], v247 offset:6656
    v_fmac_f32 v239, v50, v138
    v_fmac_f32 v241, v58, v138
    s_mov_b32 m0, s70
    v_mfma_f32_32x32x16_bf16 v[16:31], v[68:71], v[176:179], 0
    buffer_load_dwordx4 v222, s[4:7], s43 offen lds
    buffer_load_dwordx4 v223, s[72:75], s43 offen offset:1024 lds
    v_fmac_f32 v239, v51, v139
    v_fmac_f32 v241, v59, v139
    v_fmac_f32 v239, v52, v140
    v_fmac_f32 v241, v60, v140
    v_fmac_f32 v239, v53, v141
    v_mfma_f32_32x32x16_bf16 v[32:47], v[64:67], v[180:183], 0
    v_add_u32 v222, s48, v251
    ds_read_b32 v222, v222
    v_fmac_f32 v241, v61, v141
    v_fmac_f32 v239, v54, v142
    v_fmac_f32 v241, v62, v142
    v_fmac_f32 v239, v55, v143
    v_fmac_f32 v241, v63, v143
    v_mfma_f32_32x32x16_bf16 v[48:63], v[68:71], v[180:183], 0
    v_permlane32_swap_b32 v234, v236
    v_permlane32_swap_b32 v235, v237
    v_permlane32_swap_b32 v240, v238
    s_waitcnt lgkmcnt(5)
    v_or_b32 v232, v232, v231
    v_or_b32 v233, v233, v231
    s_cmp_lg_u32 s34, 0
    s_cbranch_scc1 K2_dum_37
    s_add_u32 m0, s48, 864
    s_add_u32 s65, s48, 1888
    buffer_load_dwordx4 v232, s[16:19], 0 offen  lds
    s_mov_b32 m0, s65
    s_mov_b32 exec_hi, 0
    buffer_load_dwordx4 v233, s[16:19], 0 offen  lds
    s_cmp_eq_u32 s33, 4
    s_cbranch_scc1 K2_a4_38
K2_b4_40:
    s_mov_b32 exec_hi, -1
K2_back_39:
    s_waitcnt vmcnt(6) lgkmcnt(1)
    v_mfma_f32_32x32x16_bf16 v[0:15], v[72:75], v[184:187], v[0:15]
    ds_read_b64_tr_b16 v[176:177], v246 offset:0
    ds_read_b64_tr_b16 v[178:179], v246 offset:512
    ds_read_b64_tr_b16 v[180:181], v247 offset:0
    ds_read_b64_tr_b16 v[182:183], v247 offset:512
    v_permlane32_swap_b32 v241, v239
    s_mov_b32 m0, s71
    v_mfma_f32_32x32x16_bf16 v[16:31], v[76:79], v[184:187], v[16:31]
    buffer_load_dwordx4 v224, s[4:7], s43 offen lds
    buffer_load_dwordx4 v225, s[72:75], s43 offen offset:1024 lds
    s_waitcnt lgkmcnt(4)
    v_mad_u32_u16 v223, v222, s39, v248 op_sel:[1,0,0,0]
    v_mad_u32_u16 v222, v222, s39, v248
    v_add_f32 v234, v234, v236
    v_add_f32 v235, v235, v237
    v_add_f32 v240, v240, v238
    v_add_f32 v241, v241, v239
    s_set_gpr_idx_on s31, gpr_idx(DST)
    s_nop 0
    v_cvt_pk_bf16_f32 v192, v234, v235
    v_cvt_pk_bf16_f32 v193, v240, v241
    s_set_gpr_idx_off
    v_mfma_f32_32x32x16_bf16 v[32:47], v[72:75], v[188:191], v[32:47]
    v_add_u32 v224, s49, v251
    ds_read_b32 v224, v224
    v_mul_f32 v234, v0, v144
    v_mul_f32 v236, v8, v112
    v_fmac_f32 v234, v1, v145
    v_fmac_f32 v236, v9, v113
    v_fmac_f32 v234, v2, v146
    v_mfma_f32_32x32x16_bf16 v[48:63], v[76:79], v[188:191], v[48:63]
    s_setprio 0
    v_fmac_f32 v236, v10, v114
    v_fmac_f32 v234, v3, v147
    v_fmac_f32 v236, v11, v115
    v_fmac_f32 v234, v4, v148
    v_fmac_f32 v236, v12, v116
    v_fmac_f32 v234, v5, v149
    v_fmac_f32 v236, v13, v117
    v_fmac_f32 v234, v6, v150
    v_fmac_f32 v236, v14, v118
    v_fmac_f32 v234, v7, v151
    v_fmac_f32 v236, v15, v119
    v_mul_f32 v238, v16, v160
    v_mul_f32 v240, v24, v160
    v_fmac_f32 v238, v17, v161
    v_fmac_f32 v240, v25, v161
    v_fmac_f32 v238, v18, v162
    v_fmac_f32 v240, v26, v162
    v_fmac_f32 v238, v19, v163
    v_fmac_f32 v240, v27, v163
    v_fmac_f32 v238, v20, v164
    v_fmac_f32 v240, v28, v164
    v_fmac_f32 v238, v21, v165
    v_fmac_f32 v240, v29, v165
    v_fmac_f32 v238, v22, v166
    v_fmac_f32 v240, v30, v166
    v_fmac_f32 v238, v23, v167
    v_fmac_f32 v240, v31, v167
    v_mul_f32 v235, v32, v152
    v_mul_f32 v237, v40, v120
    v_fmac_f32 v235, v33, v153
    v_fmac_f32 v237, v41, v121
    v_fmac_f32 v235, v34, v154
    v_fmac_f32 v237, v42, v122
    v_fmac_f32 v235, v35, v155
    v_fmac_f32 v237, v43, v123
    v_fmac_f32 v235, v36, v156
    v_fmac_f32 v237, v44, v124
    v_fmac_f32 v235, v37, v157
    v_fmac_f32 v237, v45, v125
    v_fmac_f32 v235, v38, v158
    v_fmac_f32 v237, v46, v126
    v_fmac_f32 v235, v39, v159
    v_fmac_f32 v237, v47, v127
    v_mul_f32 v239, v48, v168
    v_mul_f32 v241, v56, v168
    v_fmac_f32 v239, v49, v169
    v_fmac_f32 v241, v57, v169
    v_fmac_f32 v239, v50, v170
    v_fmac_f32 v241, v58, v170
    v_fmac_f32 v239, v51, v171
    s_setprio 1
    s_waitcnt vmcnt(6) lgkmcnt(1)
    v_mfma_f32_32x32x16_bf16 v[0:15], v[64:67], v[176:179], 0
    ds_read_b64_tr_b16 v[184:185], v246 offset:2048
    ds_read_b64_tr_b16 v[186:187], v246 offset:2560
    ds_read_b64_tr_b16 v[188:189], v247 offset:2048
    ds_read_b64_tr_b16 v[190:191], v247 offset:2560
    v_fmac_f32 v241, v59, v171
    v_fmac_f32 v239, v52, v172
    s_mov_b32 m0, s68
    v_mfma_f32_32x32x16_bf16 v[16:31], v[68:71], v[176:179], 0
    buffer_load_dwordx4 v222, s[4:7], s44 offen lds
    buffer_load_dwordx4 v223, s[72:75], s44 offen offset:1024 lds
    s_waitcnt lgkmcnt(4)
    v_mad_u32_u16 v225, v224, s39, v248 op_sel:[1,0,0,0]
    v_mad_u32_u16 v224, v224, s39, v248
    v_fmac_f32 v241, v60, v172
    v_fmac_f32 v239, v53, v173
    v_mfma_f32_32x32x16_bf16 v[32:47], v[64:67], v[180:183], 0
    v_add_u32 v226, s50, v251
    ds_read_b32 v226, v226
    v_fmac_f32 v241, v61, v173
    v_fmac_f32 v239, v54, v174
    v_fmac_f32 v241, v62, v174
    v_fmac_f32 v239, v55, v175
    v_fmac_f32 v241, v63, v175
    v_mfma_f32_32x32x16_bf16 v[48:63], v[68:71], v[180:183], 0
    s_waitcnt vmcnt(6) lgkmcnt(1)
    v_mfma_f32_32x32x16_bf16 v[0:15], v[72:75], v[184:187], v[0:15]
    ds_read_b64_tr_b16 v[176:177], v246 offset:4096
    ds_read_b64_tr_b16 v[178:179], v246 offset:4608
    ds_read_b64_tr_b16 v[180:181], v247 offset:4096
    ds_read_b64_tr_b16 v[182:183], v247 offset:4608
    s_mov_b32 m0, s69
    v_mfma_f32_32x32x16_bf16 v[16:31], v[76:79], v[184:187], v[16:31]
    buffer_load_dwordx4 v224, s[4:7], s45 offen lds
    buffer_load_dwordx4 v225, s[72:75], s45 offen offset:1024 lds
    s_waitcnt lgkmcnt(4)
    v_mad_u32_u16 v227, v226, s39, v248 op_sel:[1,0,0,0]
    v_mad_u32_u16 v226, v226, s39, v248
    v_mfma_f32_32x32x16_bf16 v[32:47], v[72:75], v[188:191], v[32:47]
    v_add_u32 v228, s51, v251
    ds_read_b32 v228, v228
    v_mul_f32 v242, v0, v144
    v_fma_f32 v238, v8, v160, -v238
    v_fmac_f32 v242, v1, v145
    v_fmac_f32 v238, v9, v161
    v_fmac_f32 v242, v2, v146
    v_mfma_f32_32x32x16_bf16 v[48:63], v[76:79], v[188:191], v[48:63]
    s_setprio 0
    v_fmac_f32 v238, v10, v162
    v_fmac_f32 v242, v3, v147
    v_fmac_f32 v238, v11, v163
    v_fmac_f32 v242, v4, v148
    v_fmac_f32 v238, v12, v164
    v_fmac_f32 v242, v5, v149
    v_fmac_f32 v238, v13, v165
    v_fmac_f32 v242, v6, v150
    v_fmac_f32 v238, v14, v166
    v_fmac_f32 v242, v7, v151
    v_fmac_f32 v238, v15, v167
    v_fmac_f32 v236, v16, v112
    v_mul_f32 v244, v24, v160
    v_fmac_f32 v236, v17, v113
    v_fmac_f32 v244, v25, v161
    v_fmac_f32 v236, v18, v114
    v_fmac_f32 v244, v26, v162
    v_fmac_f32 v236, v19, v115
    v_fmac_f32 v244, v27, v163
    v_fmac_f32 v236, v20, v116
    v_fmac_f32 v244, v28, v164
    v_fmac_f32 v236, v21, v117
    v_fmac_f32 v244, v29, v165
    v_fmac_f32 v236, v22, v118
    v_fmac_f32 v244, v30, v166
    v_fmac_f32 v236, v23, v119
    v_fmac_f32 v244, v31, v167
    v_mul_f32 v243, v32, v152
    v_fma_f32 v239, v40, v168, -v239
    v_fmac_f32 v243, v33, v153
    v_fmac_f32 v239, v41, v169
    v_fmac_f32 v243, v34, v154
    v_fmac_f32 v239, v42, v170
    v_fmac_f32 v243, v35, v155
    v_fmac_f32 v239, v43, v171
    v_fmac_f32 v243, v36, v156
    v_fmac_f32 v239, v44, v172
    v_fmac_f32 v243, v37, v157
    v_fmac_f32 v239, v45, v173
    v_fmac_f32 v243, v38, v158
    v_fmac_f32 v239, v46, v174
    v_fmac_f32 v243, v39, v159
    v_fmac_f32 v239, v47, v175
    v_fmac_f32 v237, v48, v120
    v_mul_f32 v245, v56, v168
    v_fmac_f32 v237, v49, v121
    v_fmac_f32 v245, v57, v169
    v_fmac_f32 v237, v50, v122
    s_setprio 1
    s_waitcnt vmcnt(4) lgkmcnt(1)
    v_mfma_f32_32x32x16_bf16 v[0:15], v[64:67], v[176:179], 0
    ds_read_b64_tr_b16 v[184:185], v246 offset:6144
    ds_read_b64_tr_b16 v[186:187], v246 offset:6656
    ds_read_b64_tr_b16 v[188:189], v247 offset:6144
    ds_read_b64_tr_b16 v[190:191], v247 offset:6656
    v_fmac_f32 v245, v58, v170
    v_fmac_f32 v237, v51, v123
    s_mov_b32 m0, s70
    v_mfma_f32_32x32x16_bf16 v[16:31], v[68:71], v[176:179], 0
    buffer_load_dwordx4 v226, s[4:7], s46 offen lds
    buffer_load_dwordx4 v227, s[72:75], s46 offen offset:1024 lds
    s_waitcnt lgkmcnt(4)
    v_mad_u32_u16 v229, v228, s39, v248 op_sel:[1,0,0,0]
    v_mad_u32_u16 v228, v228, s39, v248
    v_fmac_f32 v245, v59, v171
    v_fmac_f32 v237, v52, v124
    v_mfma_f32_32x32x16_bf16 v[32:47], v[64:67], v[180:183], 0
    v_fmac_f32 v245, v60, v172
    v_fmac_f32 v237, v53, v125
    v_fmac_f32 v245, v61, v173
    v_fmac_f32 v237, v54, v126
    v_fmac_f32 v245, v62, v174
    v_fmac_f32 v237, v55, v127
    v_fmac_f32 v245, v63, v175
    v_mfma_f32_32x32x16_bf16 v[48:63], v[68:71], v[180:183], 0
    v_permlane32_swap_b32 v242, v234
    v_permlane32_swap_b32 v243, v235
    v_add_f32 v242, v242, v234
    v_add_f32 v243, v243, v235
    s_waitcnt vmcnt(4) lgkmcnt(0)
    v_mfma_f32_32x32x16_bf16 v[0:15], v[72:75], v[184:187], v[0:15]
    ds_read_b64_tr_b16 v[176:177], v246 offset:0
    ds_read_b64_tr_b16 v[178:179], v246 offset:512
    ds_read_b64_tr_b16 v[180:181], v247 offset:0
    ds_read_b64_tr_b16 v[182:183], v247 offset:512
    s_mov_b32 m0, s71
    v_mfma_f32_32x32x16_bf16 v[16:31], v[76:79], v[184:187], v[16:31]
    buffer_load_dwordx4 v228, s[4:7], s47 offen lds
    buffer_load_dwordx4 v229, s[72:75], s47 offen offset:1024 lds
    s_set_gpr_idx_on s31, gpr_idx(DST)
    s_nop 0
    v_cvt_pk_bf16_f32 v194, v242, v243
    s_set_gpr_idx_off
    v_mfma_f32_32x32x16_bf16 v[32:47], v[72:75], v[188:191], v[32:47]
    v_mul_f32 v242, v0, v144
    v_fma_f32 v240, v8, v160, -v240
    v_fmac_f32 v242, v1, v145
    v_fmac_f32 v240, v9, v161
    v_fmac_f32 v242, v2, v146
    v_fmac_f32 v240, v10, v162
    v_fmac_f32 v242, v3, v147
    v_mfma_f32_32x32x16_bf16 v[48:63], v[76:79], v[188:191], v[48:63]
    s_setprio 0
    v_fmac_f32 v240, v11, v163
    v_fmac_f32 v242, v4, v148
    v_fmac_f32 v240, v12, v164
    v_fmac_f32 v242, v5, v149
    v_fmac_f32 v240, v13, v165
    v_fmac_f32 v242, v6, v150
    v_fmac_f32 v240, v14, v166
    v_fmac_f32 v242, v7, v151
    v_fmac_f32 v240, v15, v167
    s_sub_u32 s58, s48, s29
    v_add_u32 v249, s58, v249
    v_add_u32 v250, s58, v250
    v_fma_f32 v244, v16, v160, -v244
    v_fmac_f32 v236, v24, v112
    v_fmac_f32 v244, v17, v161
    v_fmac_f32 v236, v25, v113
    v_fmac_f32 v244, v18, v162
    v_fmac_f32 v236, v26, v114
    v_fmac_f32 v244, v19, v163
    v_fmac_f32 v236, v27, v115
    v_fmac_f32 v244, v20, v164
    v_fmac_f32 v236, v28, v116
    v_fmac_f32 v244, v21, v165
    v_fmac_f32 v236, v29, v117
    v_fmac_f32 v244, v22, v166
    v_fmac_f32 v236, v30, v118
    v_fmac_f32 v244, v23, v167
    v_fmac_f32 v236, v31, v119
    ds_read_b64_tr_b16 v[0:1], v249 offset:0
    ds_read_b64_tr_b16 v[2:3], v249 offset:128
    ds_read_b128 v[4:7], v250 offset:0
    ds_read_b128 v[8:11], v250 offset:16
    ds_read_b128 v[12:15], v250 offset:384
    ds_read_b128 v[16:19], v250 offset:400
    v_mul_f32 v243, v32, v152
    v_fma_f32 v241, v40, v168, -v241
    v_fmac_f32 v243, v33, v153
    v_fmac_f32 v241, v41, v169
    v_fmac_f32 v243, v34, v154
    v_fmac_f32 v241, v42, v170
    v_fmac_f32 v243, v35, v155
    v_fmac_f32 v241, v43, v171
    v_fmac_f32 v243, v36, v156
    v_fmac_f32 v241, v44, v172
    v_fmac_f32 v243, v37, v157
    v_fmac_f32 v241, v45, v173
    v_fmac_f32 v243, v38, v158
    v_fmac_f32 v241, v46, v174
    v_fmac_f32 v243, v39, v159
    v_fmac_f32 v241, v47, v175
    ds_read_b64_tr_b16 v[20:21], v249 offset:512
    ds_read_b64_tr_b16 v[22:23], v249 offset:640
    ds_read_b128 v[24:27], v250 offset:64
    ds_read_b128 v[28:31], v250 offset:80
    ds_read_b128 v[32:35], v250 offset:448
    ds_read_b128 v[36:39], v250 offset:464
    v_fma_f32 v245, v48, v168, -v245
    v_fmac_f32 v237, v56, v120
    v_fmac_f32 v245, v49, v169
    v_fmac_f32 v237, v57, v121
    v_fmac_f32 v245, v50, v170
    v_fmac_f32 v237, v58, v122
    v_fmac_f32 v245, v51, v171
    v_fmac_f32 v237, v59, v123
    v_fmac_f32 v245, v52, v172
    v_fmac_f32 v237, v60, v124
    v_fmac_f32 v245, v53, v173
    v_fmac_f32 v237, v61, v125
    v_fmac_f32 v245, v54, v174
    v_fmac_f32 v237, v62, v126
    v_fmac_f32 v245, v55, v175
    v_fmac_f32 v237, v63, v127
    s_cmp_lg_u32 s34, 0
    s_cbranch_scc1 K2_SWITCH
    s_mov_b32 s29, s48
    s_mov_b32 s32, s31
    s_mov_b32 s30, s3
    s_mov_b32 s31, s35
    s_cmp_eq_u32 s33, 2
    s_cbranch_scc1 K2_U20
    s_cmp_eq_u32 s33, 3
    s_cbranch_scc1 K2_U30
    s_cmp_eq_u32 s33, 1
    s_cbranch_scc1 K2_U10
    s_branch K2_U40
K2_U30:
    s_setprio 1
    s_waitcnt lgkmcnt(10)
    v_lshlrev_b32 v40, 16, v0
    v_and_b32 v41, 0xffff0000, v0
    v_lshlrev_b32 v42, 16, v1
    v_and_b32 v43, 0xffff0000, v1
    v_lshlrev_b32 v44, 16, v2
    v_and_b32 v45, 0xffff0000, v2
    v_lshlrev_b32 v46, 16, v3
    v_and_b32 v47, 0xffff0000, v3
    s_waitcnt lgkmcnt(8)
    v_mul_f32 v4, v40, v4
    v_mul_f32 v5, v41, v5
    v_mul_f32 v6, v42, v6
    v_mul_f32 v7, v43, v7
    v_mul_f32 v8, v44, v8
    v_mul_f32 v9, v45, v9
    v_mul_f32 v10, v46, v10
    v_mul_f32 v11, v47, v11
    v_cvt_pk_bf16_f32 v64, v4, v5
    v_cvt_pk_bf16_f32 v65, v6, v7
    v_cvt_pk_bf16_f32 v66, v8, v9
    v_cvt_pk_bf16_f32 v67, v10, v11
    s_waitcnt lgkmcnt(6)
    v_mul_f32 v12, v40, v12
    v_mul_f32 v13, v41, v13
    v_mul_f32 v14, v42, v14
    v_mul_f32 v15, v43, v15
    v_mul_f32 v16, v44, v16
    v_mul_f32 v17, v45, v17
    v_mul_f32 v18, v46, v18
    v_mul_f32 v19, v47, v19
    v_cvt_pk_bf16_f32 v68, v12, v13
    v_cvt_pk_bf16_f32 v69, v14, v15
    v_cvt_pk_bf16_f32 v70, v16, v17
    v_cvt_pk_bf16_f32 v71, v18, v19
    ds_read_b64_tr_b16 v[0:1], v249 offset:1024
    ds_read_b64_tr_b16 v[2:3], v249 offset:1152
    ds_read_b128 v[4:7], v250 offset:128
    ds_read_b128 v[8:11], v250 offset:144
    ds_read_b128 v[12:15], v250 offset:512
    ds_read_b128 v[16:19], v250 offset:528
    s_waitcnt lgkmcnt(10)
    v_lshlrev_b32 v48, 16, v20
    v_and_b32 v49, 0xffff0000, v20
    v_lshlrev_b32 v50, 16, v21
    v_and_b32 v51, 0xffff0000, v21
    v_lshlrev_b32 v52, 16, v22
    v_and_b32 v53, 0xffff0000, v22
    v_lshlrev_b32 v54, 16, v23
    v_and_b32 v55, 0xffff0000, v23
    s_waitcnt lgkmcnt(8)
    v_mul_f32 v24, v48, v24
    v_mul_f32 v25, v49, v25
    v_mul_f32 v26, v50, v26
    v_mul_f32 v27, v51, v27
    v_mul_f32 v28, v52, v28
    v_mul_f32 v29, v53, v29
    v_mul_f32 v30, v54, v30
    v_mul_f32 v31, v55, v31
    v_cvt_pk_bf16_f32 v72, v24, v25
    v_cvt_pk_bf16_f32 v73, v26, v27
    v_cvt_pk_bf16_f32 v74, v28, v29
    v_cvt_pk_bf16_f32 v75, v30, v31
    s_waitcnt lgkmcnt(6)
    v_mul_f32 v32, v48, v32
    v_mul_f32 v33, v49, v33
    v_mul_f32 v34, v50, v34
    v_mul_f32 v35, v51, v35
    v_mul_f32 v36, v52, v36
    v_mul_f32 v37, v53, v37
    v_mul_f32 v38, v54, v38
    v_mul_f32 v39, v55, v39
    v_cvt_pk_bf16_f32 v76, v32, v33
    v_cvt_pk_bf16_f32 v77, v34, v35
    v_cvt_pk_bf16_f32 v78, v36, v37
    v_cvt_pk_bf16_f32 v79, v38, v39
    s_waitcnt lgkmcnt(4)
    v_lshlrev_b32 v40, 16, v0
    v_and_b32 v41, 0xffff0000, v0
    v_lshlrev_b32 v42, 16, v1
    v_and_b32 v43, 0xffff0000, v1
    v_lshlrev_b32 v44, 16, v2
    v_and_b32 v45, 0xffff0000, v2
    v_lshlrev_b32 v46, 16, v3
    v_and_b32 v47, 0xffff0000, v3
    s_waitcnt lgkmcnt(2)
    v_mul_f32 v4, v40, v4
    v_mul_f32 v5, v41, v5
    v_mul_f32 v6, v42, v6
    v_mul_f32 v7, v43, v7
    v_mul_f32 v8, v44, v8
    v_mul_f32 v9, v45, v9
    v_mul_f32 v10, v46, v10
    v_mul_f32 v11, v47, v11
    v_cvt_pk_bf16_f32 v80, v4, v5
    v_cvt_pk_bf16_f32 v81, v6, v7
    v_cvt_pk_bf16_f32 v82, v8, v9
    v_cvt_pk_bf16_f32 v83, v10, v11
    s_waitcnt lgkmcnt(0)
    v_mul_f32 v12, v40, v12
    v_mul_f32 v13, v41, v13
    v_mul_f32 v14, v42, v14
    v_mul_f32 v15, v43, v15
    v_mul_f32 v16, v44, v16
    v_mul_f32 v17, v45, v17
    v_mul_f32 v18, v46, v18
    v_mul_f32 v19, v47, v19
    v_cvt_pk_bf16_f32 v84, v12, v13
    v_cvt_pk_bf16_f32 v85, v14, v15
    v_cvt_pk_bf16_f32 v86, v16, v17
    v_cvt_pk_bf16_f32 v87, v18, v19
    s_waitcnt vmcnt(4)
    v_mfma_f32_32x32x16_bf16 v[0:15], v[64:67], v[176:179], 0
    ds_read_b64_tr_b16 v[184:185], v246 offset:2048
    ds_read_b64_tr_b16 v[186:187], v246 offset:2560
    ds_read_b64_tr_b16 v[188:189], v247 offset:2048
    ds_read_b64_tr_b16 v[190:191], v247 offset:2560
    s_mov_b32 m0, s68
    v_mfma_f32_32x32x16_bf16 v[16:31], v[68:71], v[176:179], 0
    buffer_load_dwordx4 v224, s[4:7], s41 offen lds
    buffer_load_dwordx4 v225, s[72:75], s41 offen offset:1024 lds
    v_permlane32_swap_b32 v242, v236
    v_permlane32_swap_b32 v243, v237
    s_add_u32 s38, s38, 1
    v_mfma_f32_32x32x16_bf16 v[32:47], v[64:67], v[180:183], 0
    v_permlane32_swap_b32 v244, v238
    v_permlane32_swap_b32 v245, v239
    v_permlane32_swap_b32 v240, v241
    v_add_f32 v242, v242, v236
    v_mfma_f32_32x32x16_bf16 v[48:63], v[68:71], v[180:183], 0
    v_add_f32 v243, v243, v237
    v_add_f32 v244, v244, v238
    v_add_f32 v245, v245, v239
    v_add_f32 v240, -v240, -v241
    v_mov_b32 v254, s52
    v_mov_b32 v255, s38
    s_waitcnt vmcnt(4) lgkmcnt(0)
    v_mfma_f32_32x32x16_bf16 v[0:15], v[72:75], v[184:187], v[0:15]
    ds_read_b64_tr_b16 v[176:177], v246 offset:4096
    ds_read_b64_tr_b16 v[178:179], v246 offset:4608
    ds_read_b64_tr_b16 v[180:181], v247 offset:4096
    ds_read_b64_tr_b16 v[182:183], v247 offset:4608
    s_lshl_b32 s58, s38, 3
    s_add_u32 s58, s58, s20
    s_mov_b32 m0, s69
    v_mfma_f32_32x32x16_bf16 v[16:31], v[76:79], v[184:187], v[16:31]
    buffer_load_dwordx4 v226, s[4:7], s41 offen lds
    buffer_load_dwordx4 v227, s[72:75], s41 offen offset:1024 lds
    s_set_gpr_idx_on s32, gpr_idx(DST)
    s_nop 0
    v_cvt_pk_bf16_f32 v195, v242, v243
    v_cvt_pk_bf16_f32 v196, v244, v245
    v_cvt_pk_bf16_f32 v197, v240, v240
    s_set_gpr_idx_off
    s_mov_b64 exec, 1
    ds_write_b32 v254, v255
    s_mov_b64 exec, -1
    s_cmp_lt_u32 s58, s22
    s_cbranch_scc0 K2_dyn_41
K2_back_42:
    v_readlane_b32 s3, v253, s58
    s_lshl_b32 s44, s34, 7
    s_lshl_b32 s60, s58, 5
    s_and_b32 s48, s3, 0x3ffff
    s_bfe_u32 s33, s3, 0x30012
    s_sub_u32 s60, s60, s48
    s_and_b32 s60, s60, 0xff
    s_add_u32 s60, s60, s48
    s_mul_i32 s35, s38, 6
    s_cmp_eq_u32 s34, 0
    s_cselect_b32 s35, s35, s60
    s_mov_b32 s45, s44
    s_add_u32 s47, s44, 256
    s_add_u32 s49, s48, 32
    s_add_u32 s60, s48, 64
    s_cmp_eq_u32 s33, 3
    s_cselect_b32 s46, s44, s47
    s_cselect_b32 s50, s60, s48
    s_cselect_b32 s51, s48, s49
    s_sub_u32 s60, s33, 2
    s_cmp_lt_u32 s60, 2
    s_cbranch_scc0 K2_rare_47
K2_back_48:
    v_mfma_f32_32x32x16_bf16 v[32:47], v[72:75], v[188:191], v[32:47]
    v_add_u32 v233, s48, v230
    ds_read_b32 v232, v233
    ds_read_b32 v233, v233 offset:1024
    v_mfma_f32_32x32x16_bf16 v[48:63], v[76:79], v[188:191], v[48:63]
    s_waitcnt vmcnt(4) lgkmcnt(3)
    v_mfma_f32_32x32x16_bf16 v[0:15], v[80:83], v[176:179], v[0:15]
    ds_read_b64_tr_b16 v[184:185], v246 offset:6144
    ds_read_b64_tr_b16 v[186:187], v246 offset:6656
    ds_read_b64_tr_b16 v[188:189], v247 offset:6144
    ds_read_b64_tr_b16 v[190:191], v247 offset:6656
    s_mov_b32 m0, s70
    v_mfma_f32_32x32x16_bf16 v[16:31], v[84:87], v[176:179], v[16:31]
    buffer_load_dwordx4 v222, s[4:7], s42 offen lds
    buffer_load_dwordx4 v223, s[72:75], s42 offen offset:1024 lds
    v_mfma_f32_32x32x16_bf16 v[32:47], v[80:83], v[180:183], v[32:47]
    s_nop 2
    v_mul_f32 v234, v0, v96
    v_mul_f32 v236, v8, v128
    v_fmac_f32 v234, v1, v97
    v_fmac_f32 v236, v9, v129
    v_fmac_f32 v234, v2, v98
    v_fmac_f32 v236, v10, v130
    v_fmac_f32 v234, v3, v99
    v_mfma_f32_32x32x16_bf16 v[48:63], v[84:87], v[180:183], v[48:63]
    s_setprio 0
    s_waitcnt lgkmcnt(4)
    v_or_b32 v232, v232, v231
    v_or_b32 v233, v233, v231
    s_cmp_lg_u32 s34, 0
    s_cbranch_scc1 K2_dum_50
    s_add_u32 m0, s48, 864
    s_add_u32 s65, s48, 1888
    buffer_load_dwordx4 v232, s[16:19], 0 offen  lds
    s_mov_b32 m0, s65
    s_mov_b32 exec_hi, 0
    buffer_load_dwordx4 v233, s[16:19], 0 offen  lds
    s_cmp_eq_u32 s33, 4
    s_cbranch_scc1 K2_a4_51
K2_b4_53:
    s_mov_b32 exec_hi, -1
K2_back_52:
    v_fmac_f32 v236, v11, v131
    v_fmac_f32 v234, v4, v100
    v_fmac_f32 v236, v12, v132
    v_fmac_f32 v234, v5, v101
    v_fmac_f32 v236, v13, v133
    v_fmac_f32 v234, v6, v102
    v_fmac_f32 v236, v14, v134
    v_fmac_f32 v234, v7, v103
    v_fmac_f32 v236, v15, v135
    v_mul_f32 v238, v16, v128
    v_mul_f32 v240, v24, v128
    v_fmac_f32 v238, v17, v129
    v_fmac_f32 v240, v25, v129
    v_fmac_f32 v238, v18, v130
    v_fmac_f32 v240, v26, v130
    v_fmac_f32 v238, v19, v131
    v_fmac_f32 v240, v27, v131
    v_fmac_f32 v238, v20, v132
    v_fmac_f32 v240, v28, v132
    v_fmac_f32 v238, v21, v133
    v_fmac_f32 v240, v29, v133
    v_fmac_f32 v238, v22, v134
    v_fmac_f32 v240, v30, v134
    v_fmac_f32 v238, v23, v135
    v_fmac_f32 v240, v31, v135
    v_mul_f32 v235, v32, v104
    v_mul_f32 v237, v40, v136
    v_fmac_f32 v235, v33, v105
    v_fmac_f32 v237, v41, v137
    v_fmac_f32 v235, v34, v106
    v_fmac_f32 v237, v42, v138
    v_fmac_f32 v235, v35, v107
    v_fmac_f32 v237, v43, v139
    v_fmac_f32 v235, v36, v108
    v_fmac_f32 v237, v44, v140
    v_fmac_f32 v235, v37, v109
    v_fmac_f32 v237, v45, v141
    v_fmac_f32 v235, v38, v110
    v_fmac_f32 v237, v46, v142
    v_fmac_f32 v235, v39, v111
    v_fmac_f32 v237, v47, v143
    v_mul_f32 v239, v48, v136
    v_mul_f32 v241, v56, v136
    s_setprio 1
    s_waitcnt vmcnt(6) lgkmcnt(0)
    v_mfma_f32_32x32x16_bf16 v[0:15], v[64:67], v[184:187], 0
    ds_read_b64_tr_b16 v[176:177], v246 offset:0
    ds_read_b64_tr_b16 v[178:179], v246 offset:512
    ds_read_b64_tr_b16 v[180:181], v247 offset:0
    ds_read_b64_tr_b16 v[182:183], v247 offset:512
    v_fmac_f32 v239, v49, v137
    v_fmac_f32 v241, v57, v137
    s_mov_b32 m0, s71
    v_mfma_f32_32x32x16_bf16 v[16:31], v[68:71], v[184:187], 0
    buffer_load_dwordx4 v224, s[4:7], s42 offen lds
    buffer_load_dwordx4 v225, s[72:75], s42 offen offset:1024 lds
    v_fmac_f32 v239, v50, v138
    v_fmac_f32 v241, v58, v138
    v_fmac_f32 v239, v51, v139
    v_fmac_f32 v241, v59, v139
    v_fmac_f32 v239, v52, v140
    v_mfma_f32_32x32x16_bf16 v[32:47], v[64:67], v[188:191], 0
    v_fmac_f32 v241, v60, v140
    v_fmac_f32 v239, v53, v141
    v_fmac_f32 v241, v61, v141
    v_fmac_f32 v239, v54, v142
    v_fmac_f32 v241, v62, v142
    v_fmac_f32 v239, v55, v143
    v_fmac_f32 v241, v63, v143
    v_mfma_f32_32x32x16_bf16 v[48:63], v[68:71], v[188:191], 0
    v_permlane32_swap_b32 v234, v236
    v_permlane32_swap_b32 v235, v237
    v_permlane32_swap_b32 v240, v238
    s_waitcnt vmcnt(6) lgkmcnt(0)
    v_mfma_f32_32x32x16_bf16 v[0:15], v[72:75], v[176:179], v[0:15]
    ds_read_b64_tr_b16 v[184:185], v246 offset:2048
    ds_read_b64_tr_b16 v[186:187], v246 offset:2560
    ds_read_b64_tr_b16 v[188:189], v247 offset:2048
    ds_read_b64_tr_b16 v[190:191], v247 offset:2560
    v_permlane32_swap_b32 v241, v239
    s_mov_b32 m0, s68
    v_mfma_f32_32x32x16_bf16 v[16:31], v[76:79], v[176:179], v[16:31]
    buffer_load_dwordx4 v226, s[4:7], s42 offen lds
    buffer_load_dwordx4 v227, s[72:75], s42 offen offset:1024 lds
    v_add_f32 v234, v234, v236
    v_add_f32 v235, v235, v237
    v_add_f32 v240, v240, v238
    v_add_f32 v241, v241, v239
    v_mfma_f32_32x32x16_bf16 v[32:47], v[72:75], v[180:183], v[32:47]
    s_set_gpr_idx_on s31, gpr_idx(DST)
    s_nop 0
    v_cvt_pk_bf16_f32 v192, v234, v235
    v_cvt_pk_bf16_f32 v193, v240, v241
    s_set_gpr_idx_off
    v_mfma_f32_32x32x16_bf16 v[48:63], v[76:79], v[180:183], v[48:63]
    s_waitcnt vmcnt(6) lgkmcnt(0)
    v_mfma_f32_32x32x16_bf16 v[0:15], v[80:83], v[184:187], v[0:15]
    ds_read_b64_tr_b16 v[176:177], v246 offset:4096
    ds_read_b64_tr_b16 v[178:179], v246 offset:4608
    ds_read_b64_tr_b16 v[180:181], v247 offset:4096
    ds_read_b64_tr_b16 v[182:183], v247 offset:4608
    s_mov_b32 m0, s69
    v_mfma_f32_32x32x16_bf16 v[16:31], v[84:87], v[184:187], v[16:31]
    buffer_load_dwordx4 v222, s[4:7], s43 offen lds
    buffer_load_dwordx4 v223, s[72:75], s43 offen offset:1024 lds
    v_mfma_f32_32x32x16_bf16 v[32:47], v[80:83], v[188:191], v[32:47]
    s_nop 2
    v_mul_f32 v234, v0, v144
    v_mul_f32 v236, v8, v112
    v_fmac_f32 v234, v1, v145
    v_fmac_f32 v236, v9, v113
    v_fmac_f32 v234, v2, v146
    v_fmac_f32 v236, v10, v114
    v_fmac_f32 v234, v3, v147
    v_mfma_f32_32x32x16_bf16 v[48:63], v[84:87], v[188:191], v[48:63]
    s_setprio 0
    v_fmac_f32 v236, v11, v115
    v_fmac_f32 v234, v4, v148
    v_fmac_f32 v236, v12, v116
    v_fmac_f32 v234, v5, v149
    v_fmac_f32 v236, v13, v117
    v_fmac_f32 v234, v6, v150
    v_fmac_f32 v236, v14, v118
    v_fmac_f32 v234, v7, v151
    v_fmac_f32 v236, v15, v119
    v_mul_f32 v238, v16, v160
    v_mul_f32 v240, v24, v160
    v_fmac_f32 v238, v17, v161
    v_fmac_f32 v240, v25, v161
    v_fmac_f32 v238, v18, v162
    v_fmac_f32 v240, v26, v162
    v_fmac_f32 v238, v19, v163
    v_fmac_f32 v240, v27, v163
    v_fmac_f32 v238, v20, v164
    v_fmac_f32 v240, v28, v164
    v_fmac_f32 v238, v21, v165
    v_fmac_f32 v240, v29, v165
    v_fmac_f32 v238, v22, v166
    v_fmac_f32 v240, v30, v166
    v_fmac_f32 v238, v23, v167
    v_fmac_f32 v240, v31, v167
    v_mul_f32 v235, v32, v152
    v_mul_f32 v237, v40, v120
    v_fmac_f32 v235, v33, v153
    v_fmac_f32 v237, v41, v121
    v_fmac_f32 v235, v34, v154
    v_fmac_f32 v237, v42, v122
    v_fmac_f32 v235, v35, v155
    v_fmac_f32 v237, v43, v123
    v_fmac_f32 v235, v36, v156
    v_fmac_f32 v237, v44, v124
    v_fmac_f32 v235, v37, v157
    v_fmac_f32 v237, v45, v125
    v_fmac_f32 v235, v38, v158
    v_fmac_f32 v237, v46, v126
    v_fmac_f32 v235, v39, v159
    v_fmac_f32 v237, v47, v127
    v_mul_f32 v239, v48, v168
    v_mul_f32 v241, v56, v168
    v_fmac_f32 v239, v49, v169
    v_fmac_f32 v241, v57, v169
    s_setprio 1
    s_waitcnt vmcnt(4) lgkmcnt(0)
    v_mfma_f32_32x32x16_bf16 v[0:15], v[64:67], v[176:179], 0
    ds_read_b64_tr_b16 v[184:185], v246 offset:6144
    ds_read_b64_tr_b16 v[186:187], v246 offset:6656
    ds_read_b64_tr_b16 v[188:189], v247 offset:6144
    ds_read_b64_tr_b16 v[190:191], v247 offset:6656
    v_fmac_f32 v239, v50, v170
    v_fmac_f32 v241, v58, v170
    s_mov_b32 m0, s70
    v_mfma_f32_32x32x16_bf16 v[16:31], v[68:71], v[176:179], 0
    buffer_load_dwordx4 v224, s[4:7], s43 offen lds
    buffer_load_dwordx4 v225, s[72:75], s43 offen offset:1024 lds
    v_fmac_f32 v239, v51, v171
    v_fmac_f32 v241, v59, v171
    v_fmac_f32 v239, v52, v172
    v_fmac_f32 v241, v60, v172
    v_fmac_f32 v239, v53, v173
    v_mfma_f32_32x32x16_bf16 v[32:47], v[64:67], v[180:183], 0
    v_add_u32 v222, s48, v251
    ds_read_b32 v222, v222
    v_fmac_f32 v241, v61, v173
    v_fmac_f32 v239, v54, v174
    v_fmac_f32 v241, v62, v174
    v_fmac_f32 v239, v55, v175
    v_fmac_f32 v241, v63, v175
    v_mfma_f32_32x32x16_bf16 v[48:63], v[68:71], v[180:183], 0
    s_waitcnt vmcnt(4) lgkmcnt(1)
    v_mfma_f32_32x32x16_bf16 v[0:15], v[72:75], v[184:187], v[0:15]
    ds_read_b64_tr_b16 v[176:177], v246 offset:0
    ds_read_b64_tr_b16 v[178:179], v246 offset:512
    ds_read_b64_tr_b16 v[180:181], v247 offset:0
    ds_read_b64_tr_b16 v[182:183], v247 offset:512
    s_mov_b32 m0, s71
    v_mfma_f32_32x32x16_bf16 v[16:31], v[76:79], v[184:187], v[16:31]
    buffer_load_dwordx4 v226, s[4:7], s43 offen lds
    buffer_load_dwordx4 v227, s[72:75], s43 offen offset:1024 lds
    s_waitcnt lgkmcnt(4)
    v_mad_u32_u16 v223, v222, s39, v248 op_sel:[1,0,0,0]
    v_mad_u32_u16 v222, v222, s39, v248
    v_mfma_f32_32x32x16_bf16 v[32:47], v[72:75], v[188:191], v[32:47]
    v_add_u32 v224, s49, v251
    ds_read_b32 v224, v224
    v_mfma_f32_32x32x16_bf16 v[48:63], v[76:79], v[188:191], v[48:63]
    s_waitcnt vmcnt(4) lgkmcnt(1)
    v_mfma_f32_32x32x16_bf16 v[0:15], v[80:83], v[176:179], v[0:15]
    ds_read_b64_tr_b16 v[184:185], v246 offset:2048
    ds_read_b64_tr_b16 v[186:187], v246 offset:2560
    ds_read_b64_tr_b16 v[188:189], v247 offset:2048
    ds_read_b64_tr_b16 v[190:191], v247 offset:2560
    s_mov_b32 m0, s68
    v_mfma_f32_32x32x16_bf16 v[16:31], v[84:87], v[176:179], v[16:31]
    buffer_load_dwordx4 v222, s[4:7], s44 offen lds
    buffer_load_dwordx4 v223, s[72:75], s44 offen offset:1024 lds
    s_waitcnt lgkmcnt(4)
    v_mad_u32_u16 v225, v224, s39, v248 op_sel:[1,0,0,0]
    v_mad_u32_u16 v224, v224, s39, v248
    v_mfma_f32_32x32x16_bf16 v[32:47], v[80:83], v[180:183], v[32:47]
    v_add_u32 v226, s50, v251
    ds_read_b32 v226, v226
    v_mul_f32 v242, v0, v144
    v_fma_f32 v238, v8, v160, -v238
    v_fmac_f32 v242, v1, v145
    v_fmac_f32 v238, v9, v161
    v_fmac_f32 v242, v2, v146
    v_mfma_f32_32x32x16_bf16 v[48:63], v[84:87], v[180:183], v[48:63]
    s_setprio 0
    v_fmac_f32 v238, v10, v162
    v_fmac_f32 v242, v3, v147
    v_fmac_f32 v238, v11, v163
    v_fmac_f32 v242, v4, v148
    v_fmac_f32 v238, v12, v164
    v_fmac_f32 v242, v5, v149
    v_fmac_f32 v238, v13, v165
    v_fmac_f32 v242, v6, v150
    v_fmac_f32 v238, v14, v166
    v_fmac_f32 v242, v7, v151
    v_fmac_f32 v238, v15, v167
    v_fmac_f32 v236, v16, v112
    v_mul_f32 v244, v24, v160
    v_fmac_f32 v236, v17, v113
    v_fmac_f32 v244, v25, v161
    v_fmac_f32 v236, v18, v114
    v_fmac_f32 v244, v26, v162
    v_fmac_f32 v236, v19, v115
    v_fmac_f32 v244, v27, v163
    v_fmac_f32 v236, v20, v116
    v_fmac_f32 v244, v28, v164
    v_fmac_f32 v236, v21, v117
    v_fmac_f32 v244, v29, v165
    v_fmac_f32 v236, v22, v118
    v_fmac_f32 v244, v30, v166
    v_fmac_f32 v236, v23, v119
    v_fmac_f32 v244, v31, v167
    v_mul_f32 v243, v32, v152
    v_fma_f32 v239, v40, v168, -v239
    v_fmac_f32 v243, v33, v153
    v_fmac_f32 v239, v41, v169
    v_fmac_f32 v243, v34, v154
    v_fmac_f32 v239, v42, v170
    v_fmac_f32 v243, v35, v155
    v_fmac_f32 v239, v43, v171
    v_fmac_f32 v243, v36, v156
    v_fmac_f32 v239, v44, v172
    v_fmac_f32 v243, v37, v157
    v_fmac_f32 v239, v45, v173
    v_fmac_f32 v243, v38, v158
    v_fmac_f32 v239, v46, v174
    v_fmac_f32 v243, v39, v159
    v_fmac_f32 v239, v47, v175
    v_fmac_f32 v237, v48, v120
    v_mul_f32 v245, v56, v168
    v_fmac_f32 v237, v49, v121
    v_fmac_f32 v245, v57, v169
    v_fmac_f32 v237, v50, v122
    v_fmac_f32 v245, v58, v170
    v_fmac_f32 v237, v51, v123
    s_setprio 1
    s_waitcnt vmcnt(4) lgkmcnt(1)
    v_mfma_f32_32x32x16_bf16 v[0:15], v[64:67], v[184:187], 0
    ds_read_b64_tr_b16 v[176:177], v246 offset:4096
    ds_read_b64_tr_b16 v[178:179], v246 offset:4608
    ds_read_b64_tr_b16 v[180:181], v247 offset:4096
    ds_read_b64_tr_b16 v[182:183], v247 offset:4608
    v_fmac_f32 v245, v59, v171
    v_fmac_f32 v237, v52, v124
    s_mov_b32 m0, s69
    v_mfma_f32_32x32x16_bf16 v[16:31], v[68:71], v[184:187], 0
    buffer_load_dwordx4 v224, s[4:7], s45 offen lds
    buffer_load_dwordx4 v225, s[72:75], s45 offen offset:1024 lds
    s_waitcnt lgkmcnt(4)
    v_mad_u32_u16 v227, v226, s39, v248 op_sel:[1,0,0,0]
    v_mad_u32_u16 v226, v226, s39, v248
    v_fmac_f32 v245, v60, v172
    v_fmac_f32 v237, v53, v125
    v_mfma_f32_32x32x16_bf16 v[32:47], v[64:67], v[188:191], 0
    v_add_u32 v228, s51, v251
    ds_read_b32 v228, v228
    v_fmac_f32 v245, v61, v173
    v_fmac_f32 v237, v54, v126
    v_fmac_f32 v245, v62, v174
    v_fmac_f32 v237, v55, v127
    v_fmac_f32 v245, v63, v175
    v_mfma_f32_32x32x16_bf16 v[48:63], v[68:71], v[188:191], 0
    v_permlane32_swap_b32 v242, v234
    v_permlane32_swap_b32 v243, v235
    v_add_f32 v242, v242, v234
    v_add_f32 v243, v243, v235
    s_waitcnt vmcnt(4) lgkmcnt(1)
    v_mfma_f32_32x32x16_bf16 v[0:15], v[72:75], v[176:179], v[0:15]
    ds_read_b64_tr_b16 v[184:185], v246 offset:6144
    ds_read_b64_tr_b16 v[186:187], v246 offset:6656
    ds_read_b64_tr_b16 v[188:189], v247 offset:6144
    ds_read_b64_tr_b16 v[190:191], v247 offset:6656
    s_mov_b32 m0, s70
    v_mfma_f32_32x32x16_bf16 v[16:31], v[76:79], v[176:179], v[16:31]
    buffer_load_dwordx4 v226, s[4:7], s46 offen lds
    buffer_load_dwordx4 v227, s[72:75], s46 offen offset:1024 lds
    s_waitcnt lgkmcnt(4)
    v_mad_u32_u16 v229, v228, s39, v248 op_sel:[1,0,0,0]
    v_mad_u32_u16 v228, v228, s39, v248
    v_mfma_f32_32x32x16_bf16 v[32:47], v[72:75], v[180:183], v[32:47]
    s_set_gpr_idx_on s31, gpr_idx(DST)
    s_nop 0
    v_cvt_pk_bf16_f32 v194, v242, v243
    s_set_gpr_idx_off
    v_mfma_f32_32x32x16_bf16 v[48:63], v[76:79], v[180:183], v[48:63]
    s_waitcnt vmcnt(4) lgkmcnt(0)
    v_mfma_f32_32x32x16_bf16 v[0:15], v[80:83], v[184:187], v[0:15]
    ds_read_b64_tr_b16 v[176:177], v246 offset:0
    ds_read_b64_tr_b16 v[178:179], v246 offset:512
    ds_read_b64_tr_b16 v[180:181], v247 offset:0
    ds_read_b64_tr_b16 v[182:183], v247 offset:512
    s_mov_b32 m0, s71
    v_mfma_f32_32x32x16_bf16 v[16:31], v[84:87], v[184:187], v[16:31]
    buffer_load_dwordx4 v228, s[4:7], s47 offen lds
    buffer_load_dwordx4 v229, s[72:75], s47 offen offset:1024 lds
    v_mfma_f32_32x32x16_bf16 v[32:47], v[80:83], v[188:191], v[32:47]
    s_nop 2
    v_mul_f32 v242, v0, v144
    s_nop 1
    v_fma_f32 v240, v8, v160, -v240
    v_fmac_f32 v242, v1, v145
    v_fmac_f32 v240, v9, v161
    v_fmac_f32 v242, v2, v146
    v_fmac_f32 v240, v10, v162
    v_fmac_f32 v242, v3, v147
    v_mfma_f32_32x32x16_bf16 v[48:63], v[84:87], v[188:191], v[48:63]
    s_setprio 0
    v_fmac_f32 v240, v11, v163
    v_fmac_f32 v242, v4, v148
    v_fmac_f32 v240, v12, v164
    v_fmac_f32 v242, v5, v149
    v_fmac_f32 v240, v13, v165
    v_fmac_f32 v242, v6, v150
    v_fmac_f32 v240, v14, v166
    v_fmac_f32 v242, v7, v151
    v_fmac_f32 v240, v15, v167
    s_sub_u32 s58, s48, s29
    v_add_u32 v249, s58, v249
    v_add_u32 v250, s58, v250
    v_fma_f32 v244, v16, v160, -v244
    v_fmac_f32 v236, v24, v112
    v_fmac_f32 v244, v17, v161
    v_fmac_f32 v236, v25, v113
    v_fmac_f32 v244, v18, v162
    v_fmac_f32 v236, v26, v114
    v_fmac_f32 v244, v19, v163
    v_fmac_f32 v236, v27, v115
    v_fmac_f32 v244, v20, v164
    v_fmac_f32 v236, v28, v116
    v_fmac_f32 v244, v21, v165
    v_fmac_f32 v236, v29, v117
    v_fmac_f32 v244, v22, v166
    v_fmac_f32 v236, v30, v118
    v_fmac_f32 v244, v23, v167
    v_fmac_f32 v236, v31, v119
    ds_read_b64_tr_b16 v[0:1], v249 offset:0
    ds_read_b64_tr_b16 v[2:3], v249 offset:128
    ds_read_b128 v[4:7], v250 offset:0
    ds_read_b128 v[8:11], v250 offset:16
    ds_read_b128 v[12:15], v250 offset:384
    ds_read_b128 v[16:19], v250 offset:400
    v_mul_f32 v243, v32, v152
    v_fma_f32 v241, v40, v168, -v241
    v_fmac_f32 v243, v33, v153
    v_fmac_f32 v241, v41, v169
    v_fmac_f32 v243, v34, v154
    v_fmac_f32 v241, v42, v170
    v_fmac_f32 v243, v35, v155
    v_fmac_f32 v241, v43, v171
    v_fmac_f32 v243, v36, v156
    v_fmac_f32 v241, v44, v172
    v_fmac_f32 v243, v37, v157
    v_fmac_f32 v241, v45, v173
    v_fmac_f32 v243, v38, v158
    v_fmac_f32 v241, v46, v174
    v_fmac_f32 v243, v39, v159
    v_fmac_f32 v241, v47, v175
    ds_read_b64_tr_b16 v[20:21], v249 offset:512
    ds_read_b64_tr_b16 v[22:23], v249 offset:640
    ds_read_b128 v[24:27], v250 offset:64
    ds_read_b128 v[28:31], v250 offset:80
    ds_read_b128 v[32:35], v250 offset:448
    ds_read_b128 v[36:39], v250 offset:464
    v_fma_f32 v245, v48, v168, -v245
    v_fmac_f32 v237, v56, v120
    v_fmac_f32 v245, v49, v169
    v_fmac_f32 v237, v57, v121
    v_fmac_f32 v245, v50, v170
    v_fmac_f32 v237, v58, v122
    v_fmac_f32 v245, v51, v171
    v_fmac_f32 v237, v59, v123
    v_fmac_f32 v245, v52, v172
    v_fmac_f32 v237, v60, v124
    v_fmac_f32 v245, v53, v173
    v_fmac_f32 v237, v61, v125
    v_fmac_f32 v245, v54, v174
    v_fmac_f32 v237, v62, v126
    v_fmac_f32 v245, v55, v175
    v_fmac_f32 v237, v63, v127
    s_cmp_lg_u32 s34, 0
    s_cbranch_scc1 K2_SWITCH
    s_mov_b32 s29, s48
    s_mov_b32 s32, s31
    s_mov_b32 s30, s3
    s_mov_b32 s31, s35
    s_cmp_eq_u32 s33, 2
    s_cbranch_scc1 K2_U20
    s_cmp_eq_u32 s33, 3
    s_cbranch_scc1 K2_U30
    s_cmp_eq_u32 s33, 1
    s_cbranch_scc1 K2_U10
    s_branch K2_U40
K2_U21:
    s_setprio 1
    s_waitcnt lgkmcnt(10)
    v_lshlrev_b32 v40, 16, v0
    v_and_b32 v41, 0xffff0000, v0
    v_lshlrev_b32 v42, 16, v1
    v_and_b32 v43, 0xffff0000, v1
    v_lshlrev_b32 v44, 16, v2
    v_and_b32 v45, 0xffff0000, v2
    v_lshlrev_b32 v46, 16, v3
    v_and_b32 v47, 0xffff0000, v3
    s_waitcnt lgkmcnt(8)
    v_mul_f32 v4, v40, v4
    v_mul_f32 v5, v41, v5
    v_mul_f32 v6, v42, v6
    v_mul_f32 v7, v43, v7
    v_mul_f32 v8, v44, v8
    v_mul_f32 v9, v45, v9
    v_mul_f32 v10, v46, v10
    v_mul_f32 v11, v47, v11
    v_cvt_pk_bf16_f32 v64, v4, v5
    v_cvt_pk_bf16_f32 v65, v6, v7
    v_cvt_pk_bf16_f32 v66, v8, v9
    v_cvt_pk_bf16_f32 v67, v10, v11
    s_waitcnt lgkmcnt(6)
    v_mul_f32 v12, v40, v12
    v_mul_f32 v13, v41, v13
    v_mul_f32 v14, v42, v14
    v_mul_f32 v15, v43, v15
    v_mul_f32 v16, v44, v16
    v_mul_f32 v17, v45, v17
    v_mul_f32 v18, v46, v18
    v_mul_f32 v19, v47, v19
    v_cvt_pk_bf16_f32 v68, v12, v13
    v_cvt_pk_bf16_f32 v69, v14, v15
    v_cvt_pk_bf16_f32 v70, v16, v17
    v_cvt_pk_bf16_f32 v71, v18, v19
    s_waitcnt lgkmcnt(4)
    v_lshlrev_b32 v48, 16, v20
    v_and_b32 v49, 0xffff0000, v20
    v_lshlrev_b32 v50, 16, v21
    v_and_b32 v51, 0xffff0000, v21
    v_lshlrev_b32 v52, 16, v22
    v_and_b32 v53, 0xffff0000, v22
    v_lshlrev_b32 v54, 16, v23
    v_and_b32 v55, 0xffff0000, v23
    s_waitcnt lgkmcnt(2)
    v_mul_f32 v24, v48, v24
    v_mul_f32 v25, v49, v25
    v_mul_f32 v26, v50, v26
    v_mul_f32 v27, v51, v27
    v_mul_f32 v28, v52, v28
    v_mul_f32 v29, v53, v29
    v_mul_f32 v30, v54, v30
    v_mul_f32 v31, v55, v31
    v_cvt_pk_bf16_f32 v72, v24, v25
    v_cvt_pk_bf16_f32 v73, v26, v27
    v_cvt_pk_bf16_f32 v74, v28, v29
    v_cvt_pk_bf16_f32 v75, v30, v31
    s_waitcnt lgkmcnt(0)
    v_mul_f32 v32, v48, v32
    v_mul_f32 v33, v49, v33
    v_mul_f32 v34, v50, v34
    v_mul_f32 v35, v51, v35
    v_mul_f32 v36, v52, v36
    v_mul_f32 v37, v53, v37
    v_mul_f32 v38, v54, v38
    v_mul_f32 v39, v55, v39
    v_cvt_pk_bf16_f32 v76, v32, v33
    v_cvt_pk_bf16_f32 v77, v34, v35
    v_cvt_pk_bf16_f32 v78, v36, v37
    v_cvt_pk_bf16_f32 v79, v38, v39
    s_waitcnt vmcnt(4)
    v_mfma_f32_32x32x16_bf16 v[0:15], v[64:67], v[176:179], 0
    ds_read_b64_tr_b16 v[184:185], v246 offset:2048
    ds_read_b64_tr_b16 v[186:187], v246 offset:2560
    ds_read_b64_tr_b16 v[188:189], v247 offset:2048
    ds_read_b64_tr_b16 v[190:191], v247 offset:2560
    s_mov_b32 m0, s68
    v_mfma_f32_32x32x16_bf16 v[16:31], v[68:71], v[176:179], 0
    buffer_load_dwordx4 v222, s[4:7], s42 offen lds
    buffer_load_dwordx4 v223, s[72:75], s42 offen offset:1024 lds
    v_permlane32_swap_b32 v242, v236
    v_permlane32_swap_b32 v243, v237
    v_mov_b32 v254, 163648
    v_mfma_f32_32x32x16_bf16 v[32:47], v[64:67], v[180:183], 0
    v_permlane32_swap_b32 v244, v238
    v_permlane32_swap_b32 v245, v239
    v_permlane32_swap_b32 v240, v241
    v_add_f32 v242, v242, v236
    v_mfma_f32_32x32x16_bf16 v[48:63], v[68:71], v[180:183], 0
    v_add_f32 v243, v243, v237
    v_add_f32 v244, v244, v238
    v_add_f32 v245, v245, v239
    v_add_f32 v240, -v240, -v241
    v_sub_u32 v241, v230, v231
    v_cvt_pk_bf16_f32 v242, v242, v243
    v_mov_b32 v255, 1
    v_lshl_add_u32 v233, v252, 1, s53
    s_mov_b64 exec, 1
    ds_add_rtn_u32 v232, v254, v255
    s_mov_b64 exec, -1
    ds_read_b32 v233, v233
    s_waitcnt vmcnt(4) lgkmcnt(2)
    v_mfma_f32_32x32x16_bf16 v[0:15], v[72:75], v[184:187], v[0:15]
    ds_read_b64_tr_b16 v[176:177], v246 offset:4096
    ds_read_b64_tr_b16 v[178:179], v246 offset:4608
    ds_read_b64_tr_b16 v[180:181], v247 offset:4096
    ds_read_b64_tr_b16 v[182:183], v247 offset:4608
    v_cvt_pk_bf16_f32 v244, v244, v245
    v_cvt_pk_bf16_f32 v240, v240, v240
    s_mov_b32 m0, s69
    v_mfma_f32_32x32x16_bf16 v[16:31], v[76:79], v[184:187], v[16:31]
    buffer_load_dwordx4 v224, s[4:7], s42 offen lds
    buffer_load_dwordx4 v225, s[72:75], s42 offen offset:1024 lds
    ds_write_b32 v230, v242 offset:768
    ds_write_b32 v230, v244 offset:1024
    ds_write_b16 v241, v240 offset:1280
    s_waitcnt lgkmcnt(7)
    v_readfirstlane_b32 s58, v232
    v_mfma_f32_32x32x16_bf16 v[32:47], v[72:75], v[188:191], v[32:47]
    s_cmp_lt_u32 s58, s22
    s_cbranch_scc0 K2_nul_54
    s_and_b32 s59, s58, 7
    s_lshr_b32 s60, s58, 3
K2_chk_56:
    v_readlane_b32 s61, v233, s59
    s_nop 0
    s_cmp_gt_u32 s61, s60
    s_cbranch_scc0 K2_spin_55
K2_back_57:
    v_mfma_f32_32x32x16_bf16 v[48:63], v[76:79], v[188:191], v[48:63]
    s_setprio 0
    v_readlane_b32 s3, v253, s58
    s_lshl_b32 s44, s34, 7
    s_lshl_b32 s60, s58, 5
    s_and_b32 s48, s3, 0x3ffff
    s_bfe_u32 s33, s3, 0x30012
    s_sub_u32 s60, s60, s48
    v_mul_f32 v234, v0, v96
    v_mul_f32 v236, v8, v128
    v_fmac_f32 v234, v1, v97
    v_fmac_f32 v236, v9, v129
    v_fmac_f32 v234, v2, v98
    v_fmac_f32 v236, v10, v130
    v_fmac_f32 v234, v3, v99
    v_fmac_f32 v236, v11, v131
    v_fmac_f32 v234, v4, v100
    v_fmac_f32 v236, v12, v132
    v_fmac_f32 v234, v5, v101
    v_fmac_f32 v236, v13, v133
    v_fmac_f32 v234, v6, v102
    v_fmac_f32 v236, v14, v134
    v_fmac_f32 v234, v7, v103
    v_fmac_f32 v236, v15, v135
    v_mul_f32 v238, v16, v128
    v_mul_f32 v240, v24, v128
    v_fmac_f32 v238, v17, v129
    v_fmac_f32 v240, v25, v129
    v_fmac_f32 v238, v18, v130
    v_fmac_f32 v240, v26, v130
    v_fmac_f32 v238, v19, v131
    v_fmac_f32 v240, v27, v131
    v_fmac_f32 v238, v20, v132
    v_fmac_f32 v240, v28, v132
    v_fmac_f32 v238, v21, v133
    v_fmac_f32 v240, v29, v133
    v_fmac_f32 v238, v22, v134
    v_fmac_f32 v240, v30, v134
    v_fmac_f32 v238, v23, v135
    v_fmac_f32 v240, v31, v135
    v_mul_f32 v235, v32, v104
    v_mul_f32 v237, v40, v136
    v_fmac_f32 v235, v33, v105
    v_fmac_f32 v237, v41, v137
    v_fmac_f32 v235, v34, v106
    v_fmac_f32 v237, v42, v138
    v_fmac_f32 v235, v35, v107
    v_fmac_f32 v237, v43, v139
    v_fmac_f32 v235, v36, v108
    v_fmac_f32 v237, v44, v140
    v_fmac_f32 v235, v37, v109
    v_fmac_f32 v237, v45, v141
    v_fmac_f32 v235, v38, v110
    v_fmac_f32 v237, v46, v142
    v_fmac_f32 v235, v39, v111
    v_fmac_f32 v237, v47, v143
    v_mul_f32 v239, v48, v136
    v_mul_f32 v241, v56, v136
    v_fmac_f32 v239, v49, v137
    v_fmac_f32 v241, v57, v137
    s_setprio 1
    s_waitcnt vmcnt(4) lgkmcnt(3)
    v_mfma_f32_32x32x16_bf16 v[0:15], v[64:67], v[176:179], 0
    ds_read_b64_tr_b16 v[184:185], v246 offset:6144
    ds_read_b64_tr_b16 v[186:187], v246 offset:6656
    ds_read_b64_tr_b16 v[188:189], v247 offset:6144
    ds_read_b64_tr_b16 v[190:191], v247 offset:6656
    v_fmac_f32 v239, v50, v138
    v_fmac_f32 v241, v58, v138
    s_mov_b32 m0, s70
    v_mfma_f32_32x32x16_bf16 v[16:31], v[68:71], v[176:179], 0
    buffer_load_dwordx4 v222, s[4:7], s43 offen lds
    buffer_load_dwordx4 v223, s[72:75], s43 offen offset:1024 lds
    v_fmac_f32 v239, v51, v139
    v_fmac_f32 v241, v59, v139
    v_fmac_f32 v239, v52, v140
    v_fmac_f32 v241, v60, v140
    v_fmac_f32 v239, v53, v141
    v_mfma_f32_32x32x16_bf16 v[32:47], v[64:67], v[180:183], 0
    s_and_b32 s60, s60, 0xff
    s_add_u32 s35, s60, s48
    s_mov_b32 s45, s44
    s_add_u32 s47, s44, 256
    s_add_u32 s49, s48, 32
    s_add_u32 s60, s48, 64
    s_cmp_eq_u32 s33, 3
    s_cselect_b32 s46, s44, s47
    s_cselect_b32 s50, s60, s48
    s_cselect_b32 s51, s48, s49
    s_sub_u32 s60, s33, 2
    s_cmp_lt_u32 s60, 2
    s_cbranch_scc0 K2_rare_58
K2_back_59:
    v_add_u32 v222, s48, v251
    ds_read_b32 v222, v222
    v_fmac_f32 v241, v61, v141
    v_fmac_f32 v239, v54, v142
    v_fmac_f32 v241, v62, v142
    v_fmac_f32 v239, v55, v143
    v_fmac_f32 v241, v63, v143
    v_mfma_f32_32x32x16_bf16 v[48:63], v[68:71], v[180:183], 0
    v_permlane32_swap_b32 v234, v236
    v_permlane32_swap_b32 v235, v237
    v_permlane32_swap_b32 v240, v238
    s_waitcnt vmcnt(4) lgkmcnt(1)
    v_mfma_f32_32x32x16_bf16 v[0:15], v[72:75], v[184:187], v[0:15]
    ds_read_b64_tr_b16 v[176:177], v246 offset:0
    ds_read_b64_tr_b16 v[178:179], v246 offset:512
    ds_read_b64_tr_b16 v[180:181], v247 offset:0
    ds_read_b64_tr_b16 v[182:183], v247 offset:512
    v_permlane32_swap_b32 v241, v239
    s_mov_b32 m0, s71
    v_mfma_f32_32x32x16_bf16 v[16:31], v[76:79], v[184:187], v[16:31]
    buffer_load_dwordx4 v224, s[4:7], s43 offen lds
    buffer_load_dwordx4 v225, s[72:75], s43 offen offset:1024 lds
    s_waitcnt lgkmcnt(4)
    v_mad_u32_u16 v223, v222, s39, v248 op_sel:[1,0,0,0]
    v_mad_u32_u16 v222, v222, s39, v248
    v_lshl_add_u32 v230, v252, 1, s31
    v_add_f32 v234, v234, v236
    v_add_f32 v235, v235, v237
    v_add_f32 v240, v240, v238
    v_add_f32 v241, v241, v239
    v_cvt_pk_bf16_f32 v234, v234, v235
    v_cvt_pk_bf16_f32 v240, v240, v241
    ds_write_b32 v230, v234 offset:0
    ds_write_b32 v230, v240 offset:256
    v_mfma_f32_32x32x16_bf16 v[32:47], v[72:75], v[188:191], v[32:47]
    v_add_u32 v224, s49, v251
    ds_read_b32 v224, v224
    v_mul_f32 v234, v0, v144
    v_mul_f32 v236, v8, v112
    v_fmac_f32 v234, v1, v145
    v_fmac_f32 v236, v9, v113
    v_fmac_f32 v234, v2, v146
    v_mfma_f32_32x32x16_bf16 v[48:63], v[76:79], v[188:191], v[48:63]
    s_setprio 0
    v_fmac_f32 v236, v10, v114
    v_fmac_f32 v234, v3, v147
    v_fmac_f32 v236, v11, v115
    v_fmac_f32 v234, v4, v148
    v_fmac_f32 v236, v12, v116
    v_fmac_f32 v234, v5, v149
    v_fmac_f32 v236, v13, v117
    v_fmac_f32 v234, v6, v150
    v_fmac_f32 v236, v14, v118
    v_fmac_f32 v234, v7, v151
    v_fmac_f32 v236, v15, v119
    v_mul_f32 v238, v16, v160
    v_mul_f32 v240, v24, v160
    v_fmac_f32 v238, v17, v161
    v_fmac_f32 v240, v25, v161
    v_fmac_f32 v238, v18, v162
    v_fmac_f32 v240, v26, v162
    v_fmac_f32 v238, v19, v163
    v_fmac_f32 v240, v27, v163
    v_fmac_f32 v238, v20, v164
    v_fmac_f32 v240, v28, v164
    v_fmac_f32 v238, v21, v165
    v_fmac_f32 v240, v29, v165
    v_fmac_f32 v238, v22, v166
    v_fmac_f32 v240, v30, v166
    v_fmac_f32 v238, v23, v167
    v_fmac_f32 v240, v31, v167
    v_mul_f32 v235, v32, v152
    v_mul_f32 v237, v40, v120
    v_fmac_f32 v235, v33, v153
    v_fmac_f32 v237, v41, v121
    v_fmac_f32 v235, v34, v154
    v_fmac_f32 v237, v42, v122
    v_fmac_f32 v235, v35, v155
    v_fmac_f32 v237, v43, v123
    v_fmac_f32 v235, v36, v156
    v_fmac_f32 v237, v44, v124
    v_fmac_f32 v235, v37, v157
    v_fmac_f32 v237, v45, v125
    v_fmac_f32 v235, v38, v158
    v_fmac_f32 v237, v46, v126
    v_fmac_f32 v235, v39, v159
    v_fmac_f32 v237, v47, v127
    v_mul_f32 v239, v48, v168
    v_mul_f32 v241, v56, v168
    v_fmac_f32 v239, v49, v169
    v_fmac_f32 v241, v57, v169
    v_fmac_f32 v239, v50, v170
    v_fmac_f32 v241, v58, v170
    v_fmac_f32 v239, v51, v171
    s_setprio 1
    s_waitcnt vmcnt(4) lgkmcnt(3)
    v_mfma_f32_32x32x16_bf16 v[0:15], v[64:67], v[176:179], 0
    ds_read_b64_tr_b16 v[184:185], v246 offset:2048
    ds_read_b64_tr_b16 v[186:187], v246 offset:2560
    ds_read_b64_tr_b16 v[188:189], v247 offset:2048
    ds_read_b64_tr_b16 v[190:191], v247 offset:2560
    v_fmac_f32 v241, v59, v171
    v_fmac_f32 v239, v52, v172
    s_mov_b32 m0, s68
    v_mfma_f32_32x32x16_bf16 v[16:31], v[68:71], v[176:179], 0
    buffer_load_dwordx4 v222, s[4:7], s44 offen lds
    buffer_load_dwordx4 v223, s[72:75], s44 offen offset:1024 lds
    s_waitcnt lgkmcnt(4)
    v_mad_u32_u16 v225, v224, s39, v248 op_sel:[1,0,0,0]
    v_mad_u32_u16 v224, v224, s39, v248
    v_fmac_f32 v241, v60, v172
    v_fmac_f32 v239, v53, v173
    v_mfma_f32_32x32x16_bf16 v[32:47], v[64:67], v[180:183], 0
    v_add_u32 v226, s50, v251
    ds_read_b32 v226, v226
    v_fmac_f32 v241, v61, v173
    v_fmac_f32 v239, v54, v174
    v_fmac_f32 v241, v62, v174
    v_fmac_f32 v239, v55, v175
    v_fmac_f32 v241, v63, v175
    v_mfma_f32_32x32x16_bf16 v[48:63], v[68:71], v[180:183], 0
    s_waitcnt vmcnt(4) lgkmcnt(1)
    v_mfma_f32_32x32x16_bf16 v[0:15], v[72:75], v[184:187], v[0:15]
    ds_read_b64_tr_b16 v[176:177], v246 offset:4096
    ds_read_b64_tr_b16 v[178:179], v246 offset:4608
    ds_read_b64_tr_b16 v[180:181], v247 offset:4096
    ds_read_b64_tr_b16 v[182:183], v247 offset:4608
    s_mov_b32 m0, s69
    v_mfma_f32_32x32x16_bf16 v[16:31], v[76:79], v[184:187], v[16:31]
    buffer_load_dwordx4 v224, s[4:7], s45 offen lds
    buffer_load_dwordx4 v225, s[72:75], s45 offen offset:1024 lds
    s_waitcnt lgkmcnt(4)
    v_mad_u32_u16 v227, v226, s39, v248 op_sel:[1,0,0,0]
    v_mad_u32_u16 v226, v226, s39, v248
    v_mfma_f32_32x32x16_bf16 v[32:47], v[72:75], v[188:191], v[32:47]
    v_add_u32 v228, s51, v251
    ds_read_b32 v228, v228
    v_mul_f32 v242, v0, v144
    v_fma_f32 v238, v8, v160, -v238
    v_fmac_f32 v242, v1, v145
    v_fmac_f32 v238, v9, v161
    v_fmac_f32 v242, v2, v146
    v_mfma_f32_32x32x16_bf16 v[48:63], v[76:79], v[188:191], v[48:63]
    s_setprio 0
    v_fmac_f32 v238, v10, v162
    v_fmac_f32 v242, v3, v147
    v_fmac_f32 v238, v11, v163
    v_fmac_f32 v242, v4, v148
    v_fmac_f32 v238, v12, v164
    v_fmac_f32 v242, v5, v149
    v_fmac_f32 v238, v13, v165
    v_fmac_f32 v242, v6, v150
    v_fmac_f32 v238, v14, v166
    v_fmac_f32 v242, v7, v151
    v_fmac_f32 v238, v15, v167
    v_fmac_f32 v236, v16, v112
    v_mul_f32 v244, v24, v160
    v_fmac_f32 v236, v17, v113
    v_fmac_f32 v244, v25, v161
    v_fmac_f32 v236, v18, v114
    v_fmac_f32 v244, v26, v162
    v_fmac_f32 v236, v19, v115
    v_fmac_f32 v244, v27, v163
    v_fmac_f32 v236, v20, v116
    v_fmac_f32 v244, v28, v164
    v_fmac_f32 v236, v21, v117
    v_fmac_f32 v244, v29, v165
    v_fmac_f32 v236, v22, v118
    v_fmac_f32 v244, v30, v166
    v_fmac_f32 v236, v23, v119
    v_fmac_f32 v244, v31, v167
    v_mul_f32 v243, v32, v152
    v_fma_f32 v239, v40, v168, -v239
    v_fmac_f32 v243, v33, v153
    v_fmac_f32 v239, v41, v169
    v_fmac_f32 v243, v34, v154
    v_fmac_f32 v239, v42, v170
    v_fmac_f32 v243, v35, v155
    v_fmac_f32 v239, v43, v171
    v_fmac_f32 v243, v36, v156
    v_fmac_f32 v239, v44, v172
    v_fmac_f32 v243, v37, v157
    v_fmac_f32 v239, v45, v173
    v_fmac_f32 v243, v38, v158
    v_fmac_f32 v239, v46, v174
    v_fmac_f32 v243, v39, v159
    v_fmac_f32 v239, v47, v175
    v_fmac_f32 v237, v48, v120
    v_mul_f32 v245, v56, v168
    v_fmac_f32 v237, v49, v121
    v_fmac_f32 v245, v57, v169
    v_fmac_f32 v237, v50, v122
    s_setprio 1
    s_waitcnt vmcnt(4) lgkmcnt(1)
    v_mfma_f32_32x32x16_bf16 v[0:15], v[64:67], v[176:179], 0
    ds_read_b64_tr_b16 v[184:185], v246 offset:6144
    ds_read_b64_tr_b16 v[186:187], v246 offset:6656
    ds_read_b64_tr_b16 v[188:189], v247 offset:6144
    ds_read_b64_tr_b16 v[190:191], v247 offset:6656
    v_fmac_f32 v245, v58, v170
    v_fmac_f32 v237, v51, v123
    s_mov_b32 m0, s70
    v_mfma_f32_32x32x16_bf16 v[16:31], v[68:71], v[176:179], 0
    buffer_load_dwordx4 v226, s[4:7], s46 offen lds
    buffer_load_dwordx4 v227, s[72:75], s46 offen offset:1024 lds
    s_waitcnt lgkmcnt(4)
    v_mad_u32_u16 v229, v228, s39, v248 op_sel:[1,0,0,0]
    v_mad_u32_u16 v228, v228, s39, v248
    v_fmac_f32 v245, v59, v171
    v_fmac_f32 v237, v52, v124
    v_mfma_f32_32x32x16_bf16 v[32:47], v[64:67], v[180:183], 0
    v_fmac_f32 v245, v60, v172
    v_fmac_f32 v237, v53, v125
    v_fmac_f32 v245, v61, v173
    v_fmac_f32 v237, v54, v126
    v_fmac_f32 v245, v62, v174
    v_fmac_f32 v237, v55, v127
    v_fmac_f32 v245, v63, v175
    v_mfma_f32_32x32x16_bf16 v[48:63], v[68:71], v[180:183], 0
    v_permlane32_swap_b32 v242, v234
    v_permlane32_swap_b32 v243, v235
    v_add_f32 v242, v242, v234
    v_add_f32 v243, v243, v235
    s_waitcnt vmcnt(4) lgkmcnt(0)
    v_mfma_f32_32x32x16_bf16 v[0:15], v[72:75], v[184:187], v[0:15]
    ds_read_b64_tr_b16 v[176:177], v246 offset:0
    ds_read_b64_tr_b16 v[178:179], v246 offset:512
    ds_read_b64_tr_b16 v[180:181], v247 offset:0
    ds_read_b64_tr_b16 v[182:183], v247 offset:512
    v_cvt_pk_bf16_f32 v242, v242, v243
    ds_write_b32 v230, v242 offset:512
    s_mov_b32 m0, s71
    v_mfma_f32_32x32x16_bf16 v[16:31], v[76:79], v[184:187], v[16:31]
    buffer_load_dwordx4 v228, s[4:7], s47 offen lds
    buffer_load_dwordx4 v229, s[72:75], s47 offen offset:1024 lds
    v_mfma_f32_32x32x16_bf16 v[32:47], v[72:75], v[188:191], v[32:47]
    s_nop 0
    v_mul_f32 v242, v0, v144
    v_fma_f32 v240, v8, v160, -v240
    v_fmac_f32 v242, v1, v145
    v_fmac_f32 v240, v9, v161
    v_fmac_f32 v242, v2, v146
    v_fmac_f32 v240, v10, v162
    v_fmac_f32 v242, v3, v147
    v_mfma_f32_32x32x16_bf16 v[48:63], v[76:79], v[188:191], v[48:63]
    s_setprio 0
    v_fmac_f32 v240, v11, v163
    v_fmac_f32 v242, v4, v148
    v_fmac_f32 v240, v12, v164
    v_fmac_f32 v242, v5, v149
    v_fmac_f32 v240, v13, v165
    v_fmac_f32 v242, v6, v150
    v_fmac_f32 v240, v14, v166
    v_fmac_f32 v242, v7, v151
    v_fmac_f32 v240, v15, v167
    s_sub_u32 s58, s48, s29
    v_add_u32 v249, s58, v249
    v_add_u32 v250, s58, v250
    v_fma_f32 v244, v16, v160, -v244
    v_fmac_f32 v236, v24, v112
    v_fmac_f32 v244, v17, v161
    v_fmac_f32 v236, v25, v113
    v_fmac_f32 v244, v18, v162
    v_fmac_f32 v236, v26, v114
    v_fmac_f32 v244, v19, v163
    v_fmac_f32 v236, v27, v115
    v_fmac_f32 v244, v20, v164
    v_fmac_f32 v236, v28, v116
    v_fmac_f32 v244, v21, v165
    v_fmac_f32 v236, v29, v117
    v_fmac_f32 v244, v22, v166
    v_fmac_f32 v236, v30, v118
    v_fmac_f32 v244, v23, v167
    v_fmac_f32 v236, v31, v119
    ds_read_b64_tr_b16 v[0:1], v249 offset:0
    ds_read_b64_tr_b16 v[2:3], v249 offset:128
    ds_read_b128 v[4:7], v250 offset:0
    ds_read_b128 v[8:11], v250 offset:16
    ds_read_b128 v[12:15], v250 offset:384
    ds_read_b128 v[16:19], v250 offset:400
    v_mul_f32 v243, v32, v152
    v_fma_f32 v241, v40, v168, -v241
    v_fmac_f32 v243, v33, v153
    v_fmac_f32 v241, v41, v169
    v_fmac_f32 v243, v34, v154
    v_fmac_f32 v241, v42, v170
    v_fmac_f32 v243, v35, v155
    v_fmac_f32 v241, v43, v171
    v_fmac_f32 v243, v36, v156
    v_fmac_f32 v241, v44, v172
    v_fmac_f32 v243, v37, v157
    v_fmac_f32 v241, v45, v173
    v_fmac_f32 v243, v38, v158
    v_fmac_f32 v241, v46, v174
    v_fmac_f32 v243, v39, v159
    v_fmac_f32 v241, v47, v175
    ds_read_b64_tr_b16 v[20:21], v249 offset:512
    ds_read_b64_tr_b16 v[22:23], v249 offset:640
    ds_read_b128 v[24:27], v250 offset:64
    ds_read_b128 v[28:31], v250 offset:80
    ds_read_b128 v[32:35], v250 offset:448
    ds_read_b128 v[36:39], v250 offset:464
    v_fma_f32 v245, v48, v168, -v245
    v_fmac_f32 v237, v56, v120
    v_fmac_f32 v245, v49, v169
    v_fmac_f32 v237, v57, v121
    v_fmac_f32 v245, v50, v170
    v_fmac_f32 v237, v58, v122
    v_fmac_f32 v245, v51, v171
    v_fmac_f32 v237, v59, v123
    v_fmac_f32 v245, v52, v172
    v_fmac_f32 v237, v60, v124
    v_fmac_f32 v245, v53, v173
    v_fmac_f32 v237, v61, v125
    v_fmac_f32 v245, v54, v174
    v_fmac_f32 v237, v62, v126
    v_fmac_f32 v245, v55, v175
    v_fmac_f32 v237, v63, v127
    s_cmp_eq_u32 s36, 0
    s_cbranch_scc1 K2_TAIL
    s_mov_b32 s29, s48
    s_mov_b32 s32, s31
    s_mov_b32 s30, s3
    s_mov_b32 s31, s35
    s_cmp_eq_u32 s33, 2
    s_cbranch_scc1 K2_U21
    s_cmp_eq_u32 s33, 3
    s_cbranch_scc1 K2_U31
    s_cmp_eq_u32 s33, 1
    s_cbranch_scc1 K2_U11
    s_branch K2_U41
K2_U31:
    s_setprio 1
    s_waitcnt lgkmcnt(10)
    v_lshlrev_b32 v40, 16, v0
    v_and_b32 v41, 0xffff0000, v0
    v_lshlrev_b32 v42, 16, v1
    v_and_b32 v43, 0xffff0000, v1
    v_lshlrev_b32 v44, 16, v2
    v_and_b32 v45, 0xffff0000, v2
    v_lshlrev_b32 v46, 16, v3
    v_and_b32 v47, 0xffff0000, v3
    s_waitcnt lgkmcnt(8)
    v_mul_f32 v4, v40, v4
    v_mul_f32 v5, v41, v5
    v_mul_f32 v6, v42, v6
    v_mul_f32 v7, v43, v7
    v_mul_f32 v8, v44, v8
    v_mul_f32 v9, v45, v9
    v_mul_f32 v10, v46, v10
    v_mul_f32 v11, v47, v11
    v_cvt_pk_bf16_f32 v64, v4, v5
    v_cvt_pk_bf16_f32 v65, v6, v7
    v_cvt_pk_bf16_f32 v66, v8, v9
    v_cvt_pk_bf16_f32 v67, v10, v11
    s_waitcnt lgkmcnt(6)
    v_mul_f32 v12, v40, v12
    v_mul_f32 v13, v41, v13
    v_mul_f32 v14, v42, v14
    v_mul_f32 v15, v43, v15
    v_mul_f32 v16, v44, v16
    v_mul_f32 v17, v45, v17
    v_mul_f32 v18, v46, v18
    v_mul_f32 v19, v47, v19
    v_cvt_pk_bf16_f32 v68, v12, v13
    v_cvt_pk_bf16_f32 v69, v14, v15
    v_cvt_pk_bf16_f32 v70, v16, v17
    v_cvt_pk_bf16_f32 v71, v18, v19
    ds_read_b64_tr_b16 v[0:1], v249 offset:1024
    ds_read_b64_tr_b16 v[2:3], v249 offset:1152
    ds_read_b128 v[4:7], v250 offset:128
    ds_read_b128 v[8:11], v250 offset:144
    ds_read_b128 v[12:15], v250 offset:512
    ds_read_b128 v[16:19], v250 offset:528
    s_waitcnt lgkmcnt(10)
    v_lshlrev_b32 v48, 16, v20
    v_and_b32 v49, 0xffff0000, v20
    v_lshlrev_b32 v50, 16, v21
    v_and_b32 v51, 0xffff0000, v21
    v_lshlrev_b32 v52, 16, v22
    v_and_b32 v53, 0xffff0000, v22
    v_lshlrev_b32 v54, 16, v23
    v_and_b32 v55, 0xffff0000, v23
    s_waitcnt lgkmcnt(8)
    v_mul_f32 v24, v48, v24
    v_mul_f32 v25, v49, v25
    v_mul_f32 v26, v50, v26
    v_mul_f32 v27, v51, v27
    v_mul_f32 v28, v52, v28
    v_mul_f32 v29, v53, v29
    v_mul_f32 v30, v54, v30
    v_mul_f32 v31, v55, v31
    v_cvt_pk_bf16_f32 v72, v24, v25
    v_cvt_pk_bf16_f32 v73, v26, v27
    v_cvt_pk_bf16_f32 v74, v28, v29
    v_cvt_pk_bf16_f32 v75, v30, v31
    s_waitcnt lgkmcnt(6)
    v_mul_f32 v32, v48, v32
    v_mul_f32 v33, v49, v33
    v_mul_f32 v34, v50, v34
    v_mul_f32 v35, v51, v35
    v_mul_f32 v36, v52, v36
    v_mul_f32 v37, v53, v37
    v_mul_f32 v38, v54, v38
    v_mul_f32 v39, v55, v39
    v_cvt_pk_bf16_f32 v76, v32, v33
    v_cvt_pk_bf16_f32 v77, v34, v35
    v_cvt_pk_bf16_f32 v78, v36, v37
    v_cvt_pk_bf16_f32 v79, v38, v39
    s_waitcnt lgkmcnt(4)
    v_lshlrev_b32 v40, 16, v0
    v_and_b32 v41, 0xffff0000, v0
    v_lshlrev_b32 v42, 16, v1
    v_and_b32 v43, 0xffff0000, v1
    v_lshlrev_b32 v44, 16, v2
    v_and_b32 v45, 0xffff0000, v2
    v_lshlrev_b32 v46, 16, v3
    v_and_b32 v47, 0xffff0000, v3
    s_waitcnt lgkmcnt(2)
    v_mul_f32 v4, v40, v4
    v_mul_f32 v5, v41, v5
    v_mul_f32 v6, v42, v6
    v_mul_f32 v7, v43, v7
    v_mul_f32 v8, v44, v8
    v_mul_f32 v9, v45, v9
    v_mul_f32 v10, v46, v10
    v_mul_f32 v11, v47, v11
    v_cvt_pk_bf16_f32 v80, v4, v5
    v_cvt_pk_bf16_f32 v81, v6, v7
    v_cvt_pk_bf16_f32 v82, v8, v9
    v_cvt_pk_bf16_f32 v83, v10, v11
    s_waitcnt lgkmcnt(0)
    v_mul_f32 v12, v40, v12
    v_mul_f32 v13, v41, v13
    v_mul_f32 v14, v42, v14
    v_mul_f32 v15, v43, v15
    v_mul_f32 v16, v44, v16
    v_mul_f32 v17, v45, v17
    v_mul_f32 v18, v46, v18
    v_mul_f32 v19, v47, v19
    v_cvt_pk_bf16_f32 v84, v12, v13
    v_cvt_pk_bf16_f32 v85, v14, v15
    v_cvt_pk_bf16_f32 v86, v16, v17
    v_cvt_pk_bf16_f32 v87, v18, v19
    s_waitcnt vmcnt(4)
    v_mfma_f32_32x32x16_bf16 v[0:15], v[64:67], v[176:179], 0
    ds_read_b64_tr_b16 v[184:185], v246 offset:2048
    ds_read_b64_tr_b16 v[186:187], v246 offset:2560
    ds_read_b64_tr_b16 v[188:189], v247 offset:2048
    ds_read_b64_tr_b16 v[190:191], v247 offset:2560
    s_mov_b32 m0, s68
    v_mfma_f32_32x32x16_bf16 v[16:31], v[68:71], v[176:179], 0
    buffer_load_dwordx4 v224, s[4:7], s41 offen lds
    buffer_load_dwordx4 v225, s[72:75], s41 offen offset:1024 lds
    v_permlane32_swap_b32 v242, v236
    v_permlane32_swap_b32 v243, v237
    v_mov_b32 v254, 163648
    v_mfma_f32_32x32x16_bf16 v[32:47], v[64:67], v[180:183], 0
    v_permlane32_swap_b32 v244, v238
    v_permlane32_swap_b32 v245, v239
    v_permlane32_swap_b32 v240, v241
    v_add_f32 v242, v242, v236
    v_mfma_f32_32x32x16_bf16 v[48:63], v[68:71], v[180:183], 0
    v_add_f32 v243, v243, v237
    v_add_f32 v244, v244, v238
    v_add_f32 v245, v245, v239
    v_add_f32 v240, -v240, -v241
    v_sub_u32 v241, v230, v231
    v_cvt_pk_bf16_f32 v242, v242, v243
    v_mov_b32 v255, 1
    v_lshl_add_u32 v233, v252, 1, s53
    s_mov_b64 exec, 1
    ds_add_rtn_u32 v232, v254, v255
    s_mov_b64 exec, -1
    ds_read_b32 v233, v233
    s_waitcnt vmcnt(4) lgkmcnt(2)
    v_mfma_f32_32x32x16_bf16 v[0:15], v[72:75], v[184:187], v[0:15]
    ds_read_b64_tr_b16 v[176:177], v246 offset:4096
    ds_read_b64_tr_b16 v[178:179], v246 offset:4608
    ds_read_b64_tr_b16 v[180:181], v247 offset:4096
    ds_read_b64_tr_b16 v[182:183], v247 offset:4608
    v_cvt_pk_bf16_f32 v244, v244, v245
    v_cvt_pk_bf16_f32 v240, v240, v240
    s_mov_b32 m0, s69
    v_mfma_f32_32x32x16_bf16 v[16:31], v[76:79], v[184:187], v[16:31]
    buffer_load_dwordx4 v226, s[4:7], s41 offen lds
    buffer_load_dwordx4 v227, s[72:75], s41 offen offset:1024 lds
    ds_write_b32 v230, v242 offset:768
    ds_write_b32 v230, v244 offset:1024
    ds_write_b16 v241, v240 offset:1280
    s_waitcnt lgkmcnt(7)
    v_readfirstlane_b32 s58, v232
    v_mfma_f32_32x32x16_bf16 v[32:47], v[72:75], v[188:191], v[32:47]
    s_cmp_lt_u32 s58, s22
    s_cbranch_scc0 K2_nul_61
    s_and_b32 s59, s58, 7
    s_lshr_b32 s60, s58, 3
K2_chk_63:
    v_readlane_b32 s61, v233, s59
    s_nop 0
    s_cmp_gt_u32 s61, s60
    s_cbranch_scc0 K2_spin_62
K2_back_64:
    v_mfma_f32_32x32x16_bf16 v[48:63], v[76:79], v[188:191], v[48:63]
    v_readlane_b32 s3, v253, s58
    s_lshl_b32 s44, s34, 7
    s_lshl_b32 s60, s58, 5
    s_and_b32 s48, s3, 0x3ffff
    s_bfe_u32 s33, s3, 0x30012
    s_sub_u32 s60, s60, s48
    s_waitcnt vmcnt(4) lgkmcnt(3)
    v_mfma_f32_32x32x16_bf16 v[0:15], v[80:83], v[176:179], v[0:15]
    ds_read_b64_tr_b16 v[184:185], v246 offset:6144
    ds_read_b64_tr_b16 v[186:187], v246 offset:6656
    ds_read_b64_tr_b16 v[188:189], v247 offset:6144
    ds_read_b64_tr_b16 v[190:191], v247 offset:6656
    s_and_b32 s60, s60, 0xff
    s_add_u32 s35, s60, s48
    s_mov_b32 m0, s70
    v_mfma_f32_32x32x16_bf16 v[16:31], v[84:87], v[176:179], v[16:31]
    buffer_load_dwordx4 v222, s[4:7], s42 offen lds
    buffer_load_dwordx4 v223, s[72:75], s42 offen offset:1024 lds
    s_mov_b32 s45, s44
    s_add_u32 s47, s44, 256
    s_add_u32 s49, s48, 32
    s_add_u32 s60, s48, 64
    v_mfma_f32_32x32x16_bf16 v[32:47], v[80:83], v[180:183], v[32:47]
    s_cmp_eq_u32 s33, 3
    s_cselect_b32 s46, s44, s47
    s_cselect_b32 s50, s60, s48
    s_cselect_b32 s51, s48, s49
    s_sub_u32 s60, s33, 2
    s_cmp_lt_u32 s60, 2
    s_cbranch_scc0 K2_rare_65
K2_back_66:
    v_mfma_f32_32x32x16_bf16 v[48:63], v[84:87], v[180:183], v[48:63]
    s_setprio 0
    v_mul_f32 v234, v0, v96
    v_mul_f32 v236, v8, v128
    v_fmac_f32 v234, v1, v97
    v_fmac_f32 v236, v9, v129
    v_fmac_f32 v234, v2, v98
    v_fmac_f32 v236, v10, v130
    v_fmac_f32 v234, v3, v99
    v_fmac_f32 v236, v11, v131
    v_fmac_f32 v234, v4, v100
    v_fmac_f32 v236, v12, v132
    v_fmac_f32 v234, v5, v101
    v_fmac_f32 v236, v13, v133
    v_fmac_f32 v234, v6, v102
    v_fmac_f32 v236, v14, v134
    v_fmac_f32 v234, v7, v103
    v_fmac_f32 v236, v15, v135
    v_mul_f32 v238, v16, v128
    v_mul_f32 v240, v24, v128
    v_fmac_f32 v238, v17, v129
    v_fmac_f32 v240, v25, v129
    v_fmac_f32 v238, v18, v130
    v_fmac_f32 v240, v26, v130
    v_fmac_f32 v238, v19, v131
    v_fmac_f32 v240, v27, v131
    v_fmac_f32 v238, v20, v132
    v_fmac_f32 v240, v28, v132
    v_fmac_f32 v238, v21, v133
    v_fmac_f32 v240, v29, v133
    v_fmac_f32 v238, v22, v134
    v_fmac_f32 v240, v30, v134
    v_fmac_f32 v238, v23, v135
    v_fmac_f32 v240, v31, v135
    v_mul_f32 v235, v32, v104
    v_mul_f32 v237, v40, v136
    v_fmac_f32 v235, v33, v105
    v_fmac_f32 v237, v41, v137
    v_fmac_f32 v235, v34, v106
    v_fmac_f32 v237, v42, v138
    v_fmac_f32 v235, v35, v107
    v_fmac_f32 v237, v43, v139
    v_fmac_f32 v235, v36, v108
    v_fmac_f32 v237, v44, v140
    v_fmac_f32 v235, v37, v109
    v_fmac_f32 v237, v45, v141
    v_fmac_f32 v235, v38, v110
    v_fmac_f32 v237, v46, v142
    v_fmac_f32 v235, v39, v111
    v_fmac_f32 v237, v47, v143
    v_mul_f32 v239, v48, v136
    v_mul_f32 v241, v56, v136
    s_setprio 1
    s_waitcnt vmcnt(4) lgkmcnt(0)
    v_mfma_f32_32x32x16_bf16 v[0:15], v[64:67], v[184:187], 0
    ds_read_b64_tr_b16 v[176:177], v246 offset:0
    ds_read_b64_tr_b16 v[178:179], v246 offset:512
    ds_read_b64_tr_b16 v[180:181], v247 offset:0
    ds_read_b64_tr_b16 v[182:183], v247 offset:512
    v_fmac_f32 v239, v49, v137
    v_fmac_f32 v241, v57, v137
    s_mov_b32 m0, s71
    v_mfma_f32_32x32x16_bf16 v[16:31], v[68:71], v[184:187], 0
    buffer_load_dwordx4 v224, s[4:7], s42 offen lds
    buffer_load_dwordx4 v225, s[72:75], s42 offen offset:1024 lds
    v_fmac_f32 v239, v50, v138
    v_fmac_f32 v241, v58, v138
    v_fmac_f32 v239, v51, v139
    v_fmac_f32 v241, v59, v139
    v_fmac_f32 v239, v52, v140
    v_mfma_f32_32x32x16_bf16 v[32:47], v[64:67], v[188:191], 0
    v_fmac_f32 v241, v60, v140
    v_fmac_f32 v239, v53, v141
    v_fmac_f32 v241, v61, v141
    v_fmac_f32 v239, v54, v142
    v_fmac_f32 v241, v62, v142
    v_fmac_f32 v239, v55, v143
    v_fmac_f32 v241, v63, v143
    v_mfma_f32_32x32x16_bf16 v[48:63], v[68:71], v[188:191], 0
    v_permlane32_swap_b32 v234, v236
    v_permlane32_swap_b32 v235, v237
    v_permlane32_swap_b32 v240, v238
    s_waitcnt vmcnt(4) lgkmcnt(0)
    v_mfma_f32_32x32x16_bf16 v[0:15], v[72:75], v[176:179], v[0:15]
    ds_read_b64_tr_b16 v[184:185], v246 offset:2048
    ds_read_b64_tr_b16 v[186:187], v246 offset:2560
    ds_read_b64_tr_b16 v[188:189], v247 offset:2048
    ds_read_b64_tr_b16 v[190:191], v247 offset:2560
    v_permlane32_swap_b32 v241, v239
    s_mov_b32 m0, s68
    v_mfma_f32_32x32x16_bf16 v[16:31], v[76:79], v[176:179], v[16:31]
    buffer_load_dwordx4 v226, s[4:7], s42 offen lds
    buffer_load_dwordx4 v227, s[72:75], s42 offen offset:1024 lds
    v_lshl_add_u32 v230, v252, 1, s31
    v_add_f32 v234, v234, v236
    v_add_f32 v235, v235, v237
    v_add_f32 v240, v240, v238
    v_add_f32 v241, v241, v239
    v_mfma_f32_32x32x16_bf16 v[32:47], v[72:75], v[180:183], v[32:47]
    v_cvt_pk_bf16_f32 v234, v234, v235
    v_cvt_pk_bf16_f32 v240, v240, v241
    ds_write_b32 v230, v234 offset:0
    ds_write_b32 v230, v240 offset:256
    v_mfma_f32_32x32x16_bf16 v[48:63], v[76:79], v[180:183], v[48:63]
    s_waitcnt vmcnt(4) lgkmcnt(2)
    v_mfma_f32_32x32x16_bf16 v[0:15], v[80:83], v[184:187], v[0:15]
    ds_read_b64_tr_b16 v[176:177], v246 offset:4096
    ds_read_b64_tr_b16 v[178:179], v246 offset:4608
    ds_read_b64_tr_b16 v[180:181], v247 offset:4096
    ds_read_b64_tr_b16 v[182:183], v247 offset:4608
    s_mov_b32 m0, s69
    v_mfma_f32_32x32x16_bf16 v[16:31], v[84:87], v[184:187], v[16:31]
    buffer_load_dwordx4 v222, s[4:7], s43 offen lds
    buffer_load_dwordx4 v223, s[72:75], s43 offen offset:1024 lds
    v_mfma_f32_32x32x16_bf16 v[32:47], v[80:83], v[188:191], v[32:47]
    s_nop 2
    v_mul_f32 v234, v0, v144
    v_mul_f32 v236, v8, v112
    v_fmac_f32 v234, v1, v145
    v_fmac_f32 v236, v9, v113
    v_fmac_f32 v234, v2, v146
    v_fmac_f32 v236, v10, v114
    v_fmac_f32 v234, v3, v147
    v_mfma_f32_32x32x16_bf16 v[48:63], v[84:87], v[188:191], v[48:63]
    s_setprio 0
    v_fmac_f32 v236, v11, v115
    v_fmac_f32 v234, v4, v148
    v_fmac_f32 v236, v12, v116
    v_fmac_f32 v234, v5, v149
    v_fmac_f32 v236, v13, v117
    v_fmac_f32 v234, v6, v150
    v_fmac_f32 v236, v14, v118
    v_fmac_f32 v234, v7, v151
    v_fmac_f32 v236, v15, v119
    v_mul_f32 v238, v16, v160
    v_mul_f32 v240, v24, v160
    v_fmac_f32 v238, v17, v161
    v_fmac_f32 v240, v25, v161
    v_fmac_f32 v238, v18, v162
    v_fmac_f32 v240, v26, v162
    v_fmac_f32 v238, v19, v163
    v_fmac_f32 v240, v27, v163
    v_fmac_f32 v238, v20, v164
    v_fmac_f32 v240, v28, v164
    v_fmac_f32 v238, v21, v165
    v_fmac_f32 v240, v29, v165
    v_fmac_f32 v238, v22, v166
    v_fmac_f32 v240, v30, v166
    v_fmac_f32 v238, v23, v167
    v_fmac_f32 v240, v31, v167
    v_mul_f32 v235, v32, v152
    v_mul_f32 v237, v40, v120
    v_fmac_f32 v235, v33, v153
    v_fmac_f32 v237, v41, v121
    v_fmac_f32 v235, v34, v154
    v_fmac_f32 v237, v42, v122
    v_fmac_f32 v235, v35, v155
    v_fmac_f32 v237, v43, v123
    v_fmac_f32 v235, v36, v156
    v_fmac_f32 v237, v44, v124
    v_fmac_f32 v235, v37, v157
    v_fmac_f32 v237, v45, v125
    v_fmac_f32 v235, v38, v158
    v_fmac_f32 v237, v46, v126
    v_fmac_f32 v235, v39, v159
    v_fmac_f32 v237, v47, v127
    v_mul_f32 v239, v48, v168
    v_mul_f32 v241, v56, v168
    v_fmac_f32 v239, v49, v169
    v_fmac_f32 v241, v57, v169
    s_setprio 1
    s_waitcnt vmcnt(4) lgkmcnt(0)
    v_mfma_f32_32x32x16_bf16 v[0:15], v[64:67], v[176:179], 0
    ds_read_b64_tr_b16 v[184:185], v246 offset:6144
    ds_read_b64_tr_b16 v[186:187], v246 offset:6656
    ds_read_b64_tr_b16 v[188:189], v247 offset:6144
    ds_read_b64_tr_b16 v[190:191], v247 offset:6656
    v_fmac_f32 v239, v50, v170
    v_fmac_f32 v241, v58, v170
    s_mov_b32 m0, s70
    v_mfma_f32_32x32x16_bf16 v[16:31], v[68:71], v[176:179], 0
    buffer_load_dwordx4 v224, s[4:7], s43 offen lds
    buffer_load_dwordx4 v225, s[72:75], s43 offen offset:1024 lds
    v_fmac_f32 v239, v51, v171
    v_fmac_f32 v241, v59, v171
    v_fmac_f32 v239, v52, v172
    v_fmac_f32 v241, v60, v172
    v_fmac_f32 v239, v53, v173
    v_mfma_f32_32x32x16_bf16 v[32:47], v[64:67], v[180:183], 0
    v_add_u32 v222, s48, v251
    ds_read_b32 v222, v222
    v_fmac_f32 v241, v61, v173
    v_fmac_f32 v239, v54, v174
    v_fmac_f32 v241, v62, v174
    v_fmac_f32 v239, v55, v175
    v_fmac_f32 v241, v63, v175
    v_mfma_f32_32x32x16_bf16 v[48:63], v[68:71], v[180:183], 0
    s_waitcnt vmcnt(4) lgkmcnt(1)
    v_mfma_f32_32x32x16_bf16 v[0:15], v[72:75], v[184:187], v[0:15]
    ds_read_b64_tr_b16 v[176:177], v246 offset:0
    ds_read_b64_tr_b16 v[178:179], v246 offset:512
    ds_read_b64_tr_b16 v[180:181], v247 offset:0
    ds_read_b64_tr_b16 v[182:183], v247 offset:512
    s_mov_b32 m0, s71
    v_mfma_f32_32x32x16_bf16 v[16:31], v[76:79], v[184:187], v[16:31]
    buffer_load_dwordx4 v226, s[4:7], s43 offen lds
    buffer_load_dwordx4 v227, s[72:75], s43 offen offset:1024 lds
    s_waitcnt lgkmcnt(4)
    v_mad_u32_u16 v223, v222, s39, v248 op_sel:[1,0,0,0]
    v_mad_u32_u16 v222, v222, s39, v248
    v_mfma_f32_32x32x16_bf16 v[32:47], v[72:75], v[188:191], v[32:47]
    v_add_u32 v224, s49, v251
    ds_read_b32 v224, v224
    v_mfma_f32_32x32x16_bf16 v[48:63], v[76:79], v[188:191], v[48:63]
    s_waitcnt vmcnt(4) lgkmcnt(1)
    v_mfma_f32_32x32x16_bf16 v[0:15], v[80:83], v[176:179], v[0:15]
    ds_read_b64_tr_b16 v[184:185], v246 offset:2048
    ds_read_b64_tr_b16 v[186:187], v246 offset:2560
    ds_read_b64_tr_b16 v[188:189], v247 offset:2048
    ds_read_b64_tr_b16 v[190:191], v247 offset:2560
    s_mov_b32 m0, s68
    v_mfma_f32_32x32x16_bf16 v[16:31], v[84:87], v[176:179], v[16:31]
    buffer_load_dwordx4 v222, s[4:7], s44 offen lds
    buffer_load_dwordx4 v223, s[72:75], s44 offen offset:1024 lds
    s_waitcnt lgkmcnt(4)
    v_mad_u32_u16 v225, v224, s39, v248 op_sel:[1,0,0,0]
    v_mad_u32_u16 v224, v224, s39, v248
    v_mfma_f32_32x32x16_bf16 v[32:47], v[80:83], v[180:183], v[32:47]
    v_add_u32 v226, s50, v251
    ds_read_b32 v226, v226
    v_mul_f32 v242, v0, v144
    v_fma_f32 v238, v8, v160, -v238
    v_fmac_f32 v242, v1, v145
    v_fmac_f32 v238, v9, v161
    v_fmac_f32 v242, v2, v146
    v_mfma_f32_32x32x16_bf16 v[48:63], v[84:87], v[180:183], v[48:63]
    s_setprio 0
    v_fmac_f32 v238, v10, v162
    v_fmac_f32 v242, v3, v147
    v_fmac_f32 v238, v11, v163
    v_fmac_f32 v242, v4, v148
    v_fmac_f32 v238, v12, v164
    v_fmac_f32 v242, v5, v149
    v_fmac_f32 v238, v13, v165
    v_fmac_f32 v242, v6, v150
    v_fmac_f32 v238, v14, v166
    v_fmac_f32 v242, v7, v151
    v_fmac_f32 v238, v15, v167
    v_fmac_f32 v236, v16, v112
    v_mul_f32 v244, v24, v160
    v_fmac_f32 v236, v17, v113
    v_fmac_f32 v244, v25, v161
    v_fmac_f32 v236, v18, v114
    v_fmac_f32 v244, v26, v162
    v_fmac_f32 v236, v19, v115
    v_fmac_f32 v244, v27, v163
    v_fmac_f32 v236, v20, v116
    v_fmac_f32 v244, v28, v164
    v_fmac_f32 v236, v21, v117
    v_fmac_f32 v244, v29, v165
    v_fmac_f32 v236, v22, v118
    v_fmac_f32 v244, v30, v166
    v_fmac_f32 v236, v23, v119
    v_fmac_f32 v244, v31, v167
    v_mul_f32 v243, v32, v152
    v_fma_f32 v239, v40, v168, -v239
    v_fmac_f32 v243, v33, v153
    v_fmac_f32 v239, v41, v169
    v_fmac_f32 v243, v34, v154
    v_fmac_f32 v239, v42, v170
    v_fmac_f32 v243, v35, v155
    v_fmac_f32 v239, v43, v171
    v_fmac_f32 v243, v36, v156
    v_fmac_f32 v239, v44, v172
    v_fmac_f32 v243, v37, v157
    v_fmac_f32 v239, v45, v173
    v_fmac_f32 v243, v38, v158
    v_fmac_f32 v239, v46, v174
    v_fmac_f32 v243, v39, v159
    v_fmac_f32 v239, v47, v175
    v_fmac_f32 v237, v48, v120
    v_mul_f32 v245, v56, v168
    v_fmac_f32 v237, v49, v121
    v_fmac_f32 v245, v57, v169
    v_fmac_f32 v237, v50, v122
    v_fmac_f32 v245, v58, v170
    v_fmac_f32 v237, v51, v123
    s_setprio 1
    s_waitcnt vmcnt(4) lgkmcnt(1)
    v_mfma_f32_32x32x16_bf16 v[0:15], v[64:67], v[184:187], 0
    ds_read_b64_tr_b16 v[176:177], v246 offset:4096
    ds_read_b64_tr_b16 v[178:179], v246 offset:4608
    ds_read_b64_tr_b16 v[180:181], v247 offset:4096
    ds_read_b64_tr_b16 v[182:183], v247 offset:4608
    v_fmac_f32 v245, v59, v171
    v_fmac_f32 v237, v52, v124
    s_mov_b32 m0, s69
    v_mfma_f32_32x32x16_bf16 v[16:31], v[68:71], v[184:187], 0
    buffer_load_dwordx4 v224, s[4:7], s45 offen lds
    buffer_load_dwordx4 v225, s[72:75], s45 offen offset:1024 lds
    s_waitcnt lgkmcnt(4)
    v_mad_u32_u16 v227, v226, s39, v248 op_sel:[1,0,0,0]
    v_mad_u32_u16 v226, v226, s39, v248
    v_fmac_f32 v245, v60, v172
    v_fmac_f32 v237, v53, v125
    v_mfma_f32_32x32x16_bf16 v[32:47], v[64:67], v[188:191], 0
    v_add_u32 v228, s51, v251
    ds_read_b32 v228, v228
    v_fmac_f32 v245, v61, v173
    v_fmac_f32 v237, v54, v126
    v_fmac_f32 v245, v62, v174
    v_fmac_f32 v237, v55, v127
    v_fmac_f32 v245, v63, v175
    v_mfma_f32_32x32x16_bf16 v[48:63], v[68:71], v[188:191], 0
    v_permlane32_swap_b32 v242, v234
    v_permlane32_swap_b32 v243, v235
    v_add_f32 v242, v242, v234
    v_add_f32 v243, v243, v235
    s_waitcnt vmcnt(4) lgkmcnt(1)
    v_mfma_f32_32x32x16_bf16 v[0:15], v[72:75], v[176:179], v[0:15]
    ds_read_b64_tr_b16 v[184:185], v246 offset:6144
    ds_read_b64_tr_b16 v[186:187], v246 offset:6656
    ds_read_b64_tr_b16 v[188:189], v247 offset:6144
    ds_read_b64_tr_b16 v[190:191], v247 offset:6656
    v_cvt_pk_bf16_f32 v242, v242, v243
    ds_write_b32 v230, v242 offset:512
    s_mov_b32 m0, s70
    v_mfma_f32_32x32x16_bf16 v[16:31], v[76:79], v[176:179], v[16:31]
    buffer_load_dwordx4 v226, s[4:7], s46 offen lds
    buffer_load_dwordx4 v227, s[72:75], s46 offen offset:1024 lds
    s_waitcnt lgkmcnt(5)
    v_mad_u32_u16 v229, v228, s39, v248 op_sel:[1,0,0,0]
    v_mad_u32_u16 v228, v228, s39, v248
    v_mfma_f32_32x32x16_bf16 v[32:47], v[72:75], v[180:183], v[32:47]
    v_mfma_f32_32x32x16_bf16 v[48:63], v[76:79], v[180:183], v[48:63]
    s_waitcnt vmcnt(4) lgkmcnt(1)
    v_mfma_f32_32x32x16_bf16 v[0:15], v[80:83], v[184:187], v[0:15]
    ds_read_b64_tr_b16 v[176:177], v246 offset:0
    ds_read_b64_tr_b16 v[178:179], v246 offset:512
    ds_read_b64_tr_b16 v[180:181], v247 offset:0
    ds_read_b64_tr_b16 v[182:183], v247 offset:512
    s_mov_b32 m0, s71
    v_mfma_f32_32x32x16_bf16 v[16:31], v[84:87], v[184:187], v[16:31]
    buffer_load_dwordx4 v228, s[4:7], s47 offen lds
    buffer_load_dwordx4 v229, s[72:75], s47 offen offset:1024 lds
    v_mfma_f32_32x32x16_bf16 v[32:47], v[80:83], v[188:191], v[32:47]
    s_nop 2
    v_mul_f32 v242, v0, v144
    v_fma_f32 v240, v8, v160, -v240
    v_fmac_f32 v242, v1, v145
    v_fmac_f32 v240, v9, v161
    v_fmac_f32 v242, v2, v146
    v_fmac_f32 v240, v10, v162
    v_fmac_f32 v242, v3, v147
    v_mfma_f32_32x32x16_bf16 v[48:63], v[84:87], v[188:191], v[48:63]
    s_setprio 0
    v_fmac_f32 v240, v11, v163
    v_fmac_f32 v242, v4, v148
    v_fmac_f32 v240, v12, v164
    v_fmac_f32 v242, v5, v149
    v_fmac_f32 v240, v13, v165
    v_fmac_f32 v242, v6, v150
    v_fmac_f32 v240, v14, v166
    v_fmac_f32 v242, v7, v151
    v_fmac_f32 v240, v15, v167
    s_sub_u32 s58, s48, s29
    v_add_u32 v249, s58, v249
    v_add_u32 v250, s58, v250
    v_fma_f32 v244, v16, v160, -v244
    v_fmac_f32 v236, v24, v112
    v_fmac_f32 v244, v17, v161
    v_fmac_f32 v236, v25, v113
    v_fmac_f32 v244, v18, v162
    v_fmac_f32 v236, v26, v114
    v_fmac_f32 v244, v19, v163
    v_fmac_f32 v236, v27, v115
    v_fmac_f32 v244, v20, v164
    v_fmac_f32 v236, v28, v116
    v_fmac_f32 v244, v21, v165
    v_fmac_f32 v236, v29, v117
    v_fmac_f32 v244, v22, v166
    v_fmac_f32 v236, v30, v118
    v_fmac_f32 v244, v23, v167
    v_fmac_f32 v236, v31, v119
    ds_read_b64_tr_b16 v[0:1], v249 offset:0
    ds_read_b64_tr_b16 v[2:3], v249 offset:128
    ds_read_b128 v[4:7], v250 offset:0
    ds_read_b128 v[8:11], v250 offset:16
    ds_read_b128 v[12:15], v250 offset:384
    ds_read_b128 v[16:19], v250 offset:400
    v_mul_f32 v243, v32, v152
    v_fma_f32 v241, v40, v168, -v241
    v_fmac_f32 v243, v33, v153
    v_fmac_f32 v241, v41, v169
    v_fmac_f32 v243, v34, v154
    v_fmac_f32 v241, v42, v170
    v_fmac_f32 v243, v35, v155
    v_fmac_f32 v241, v43, v171
    v_fmac_f32 v243, v36, v156
    v_fmac_f32 v241, v44, v172
    v_fmac_f32 v243, v37, v157
    v_fmac_f32 v241, v45, v173
    v_fmac_f32 v243, v38, v158
    v_fmac_f32 v241, v46, v174
    v_fmac_f32 v243, v39, v159
    v_fmac_f32 v241, v47, v175
    ds_read_b64_tr_b16 v[20:21], v249 offset:512
    ds_read_b64_tr_b16 v[22:23], v249 offset:640
    ds_read_b128 v[24:27], v250 offset:64
    ds_read_b128 v[28:31], v250 offset:80
    ds_read_b128 v[32:35], v250 offset:448
    ds_read_b128 v[36:39], v250 offset:464
    v_fma_f32 v245, v48, v168, -v245
    v_fmac_f32 v237, v56, v120
    v_fmac_f32 v245, v49, v169
    v_fmac_f32 v237, v57, v121
    v_fmac_f32 v245, v50, v170
    v_fmac_f32 v237, v58, v122
    v_fmac_f32 v245, v51, v171
    v_fmac_f32 v237, v59, v123
    v_fmac_f32 v245, v52, v172
    v_fmac_f32 v237, v60, v124
    v_fmac_f32 v245, v53, v173
    v_fmac_f32 v237, v61, v125
    v_fmac_f32 v245, v54, v174
    v_fmac_f32 v237, v62, v126
    v_fmac_f32 v245, v55, v175
    v_fmac_f32 v237, v63, v127
    s_cmp_eq_u32 s36, 0
    s_cbranch_scc1 K2_TAIL
    s_mov_b32 s29, s48
    s_mov_b32 s32, s31
    s_mov_b32 s30, s3
    s_mov_b32 s31, s35
    s_cmp_eq_u32 s33, 2
    s_cbranch_scc1 K2_U21
    s_cmp_eq_u32 s33, 3
    s_cbranch_scc1 K2_U31
    s_cmp_eq_u32 s33, 1
    s_cbranch_scc1 K2_U11
    s_branch K2_U41
K2_U10:
    s_setprio 1
    s_add_u32 s38, s38, 1
    v_mov_b32 v254, s52
    v_mov_b32 v255, s38
    s_lshl_b32 s58, s38, 3
    s_add_u32 s58, s58, s20
    s_mov_b64 exec, 1
    ds_write_b32 v254, v255
    s_mov_b64 exec, -1
    s_cmp_lt_u32 s58, s22
    s_cbranch_scc0 K2_dyn_68
K2_back_69:
    s_waitcnt lgkmcnt(11)
    v_lshlrev_b32 v40, 16, v0
    v_and_b32 v41, 0xffff0000, v0
    v_lshlrev_b32 v42, 16, v1
    v_and_b32 v43, 0xffff0000, v1
    v_lshlrev_b32 v44, 16, v2
    v_and_b32 v45, 0xffff0000, v2
    v_lshlrev_b32 v46, 16, v3
    v_and_b32 v47, 0xffff0000, v3
    s_waitcnt lgkmcnt(9)
    v_mul_f32 v4, v40, v4
    v_mul_f32 v5, v41, v5
    v_mul_f32 v6, v42, v6
    v_mul_f32 v7, v43, v7
    v_mul_f32 v8, v44, v8
    v_mul_f32 v9, v45, v9
    v_mul_f32 v10, v46, v10
    v_mul_f32 v11, v47, v11
    v_cvt_pk_bf16_f32 v64, v4, v5
    v_cvt_pk_bf16_f32 v65, v6, v7
    v_cvt_pk_bf16_f32 v66, v8, v9
    v_cvt_pk_bf16_f32 v67, v10, v11
    s_waitcnt lgkmcnt(7)
    v_mul_f32 v12, v40, v12
    v_mul_f32 v13, v41, v13
    v_mul_f32 v14, v42, v14
    v_mul_f32 v15, v43, v15
    v_mul_f32 v16, v44, v16
    v_mul_f32 v17, v45, v17
    v_mul_f32 v18, v46, v18
    v_mul_f32 v19, v47, v19
    v_cvt_pk_bf16_f32 v68, v12, v13
    v_cvt_pk_bf16_f32 v69, v14, v15
    v_cvt_pk_bf16_f32 v70, v16, v17
    v_cvt_pk_bf16_f32 v71, v18, v19
    v_readlane_b32 s3, v253, s58
    s_lshl_b32 s44, s34, 7
    s_lshl_b32 s60, s58, 5
    s_and_b32 s48, s3, 0x3ffff
    s_bfe_u32 s33, s3, 0x30012
    s_sub_u32 s60, s60, s48
    s_and_b32 s60, s60, 0xff
    s_add_u32 s60, s60, s48
    s_mul_i32 s35, s38, 6
    s_cmp_eq_u32 s34, 0
    s_cselect_b32 s35, s35, s60
    s_mov_b32 s45, s44
    s_add_u32 s47, s44, 256
    s_add_u32 s49, s48, 32
    s_add_u32 s60, s48, 64
    s_cmp_eq_u32 s33, 3
    s_cselect_b32 s46, s44, s47
    s_cselect_b32 s50, s60, s48
    s_cselect_b32 s51, s48, s49
    s_sub_u32 s60, s33, 2
    s_cmp_lt_u32 s60, 2
    s_cbranch_scc0 K2_rare_74
K2_back_75:
    v_add_u32 v233, s48, v230
    ds_read_b32 v232, v233
    ds_read_b32 v233, v233 offset:1024
    v_add_u32 v222, s48, v251
    ds_read_b32 v222, v222
    v_add_u32 v224, s49, v251
    ds_read_b32 v224, v224
    v_add_u32 v226, s50, v251
    ds_read_b32 v226, v226
    v_add_u32 v228, s51, v251
    ds_read_b32 v228, v228
    s_waitcnt lgkmcnt(4)
    v_or_b32 v232, v232, v231
    v_or_b32 v233, v233, v231
    s_cmp_lg_u32 s34, 0
    s_cbranch_scc1 K2_dum_77
    s_add_u32 m0, s48, 864
    s_add_u32 s65, s48, 1888
    buffer_load_dwordx4 v232, s[16:19], 0 offen  lds
    s_mov_b32 m0, s65
    s_mov_b32 exec_hi, 0
    buffer_load_dwordx4 v233, s[16:19], 0 offen  lds
    s_cmp_eq_u32 s33, 4
    s_cbranch_scc1 K2_a4_78
K2_b4_80:
    s_mov_b32 exec_hi, -1
K2_back_79:
    s_waitcnt lgkmcnt(3)
    v_mad_u32_u16 v223, v222, s39, v248 op_sel:[1,0,0,0]
    v_mad_u32_u16 v222, v222, s39, v248
    s_waitcnt lgkmcnt(2)
    v_mad_u32_u16 v225, v224, s39, v248 op_sel:[1,0,0,0]
    v_mad_u32_u16 v224, v224, s39, v248
    s_waitcnt lgkmcnt(1)
    v_mad_u32_u16 v227, v226, s39, v248 op_sel:[1,0,0,0]
    v_mad_u32_u16 v226, v226, s39, v248
    s_waitcnt lgkmcnt(0)
    v_mad_u32_u16 v229, v228, s39, v248 op_sel:[1,0,0,0]
    v_mad_u32_u16 v228, v228, s39, v248
    s_waitcnt vmcnt(6)
    v_mfma_f32_32x32x16_bf16 v[0:15], v[64:67], v[176:179], 0
    ds_read_b64_tr_b16 v[184:185], v246 offset:2048
    ds_read_b64_tr_b16 v[186:187], v246 offset:2560
    ds_read_b64_tr_b16 v[188:189], v247 offset:2048
    ds_read_b64_tr_b16 v[190:191], v247 offset:2560
    s_mov_b32 m0, s68
    v_mfma_f32_32x32x16_bf16 v[16:31], v[68:71], v[176:179], 0
    buffer_load_dwordx4 v222, s[4:7], s44 offen lds
    buffer_load_dwordx4 v223, s[72:75], s44 offen offset:1024 lds
    v_permlane32_swap_b32 v242, v236
    v_permlane32_swap_b32 v243, v237
    v_mfma_f32_32x32x16_bf16 v[32:47], v[64:67], v[180:183], 0
    v_permlane32_swap_b32 v244, v238
    v_permlane32_swap_b32 v245, v239
    v_permlane32_swap_b32 v240, v241
    v_add_f32 v242, v242, v236
    v_mfma_f32_32x32x16_bf16 v[48:63], v[68:71], v[180:183], 0
    s_setprio 0
    v_add_f32 v243, v243, v237
    v_add_f32 v244, v244, v238
    v_add_f32 v245, v245, v239
    v_add_f32 v240, -v240, -v241
    s_set_gpr_idx_on s32, gpr_idx(DST)
    s_nop 0
    v_cvt_pk_bf16_f32 v195, v242, v243
    v_cvt_pk_bf16_f32 v196, v244, v245
    v_cvt_pk_bf16_f32 v197, v240, v240
    s_set_gpr_idx_off
    v_mul_f32 v234, v0, v96
    v_mul_f32 v236, v8, v128
    v_fmac_f32 v234, v1, v97
    v_fmac_f32 v236, v9, v129
    v_fmac_f32 v234, v2, v98
    v_fmac_f32 v236, v10, v130
    v_fmac_f32 v234, v3, v99
    v_fmac_f32 v236, v11, v131
    v_fmac_f32 v234, v4, v100
    v_fmac_f32 v236, v12, v132
    v_fmac_f32 v234, v5, v101
    v_fmac_f32 v236, v13, v133
    v_fmac_f32 v234, v6, v102
    v_fmac_f32 v236, v14, v134
    v_fmac_f32 v234, v7, v103
    v_fmac_f32 v236, v15, v135
    v_mul_f32 v238, v16, v128
    v_mul_f32 v240, v24, v128
    v_fmac_f32 v238, v17, v129
    v_fmac_f32 v240, v25, v129
    v_fmac_f32 v238, v18, v130
    v_fmac_f32 v240, v26, v130
    v_fmac_f32 v238, v19, v131
    v_fmac_f32 v240, v27, v131
    v_fmac_f32 v238, v20, v132
    v_fmac_f32 v240, v28, v132
    v_fmac_f32 v238, v21, v133
    v_fmac_f32 v240, v29, v133
    v_fmac_f32 v238, v22, v134
    v_fmac_f32 v240, v30, v134
    v_fmac_f32 v238, v23, v135
    v_fmac_f32 v240, v31, v135
    v_mul_f32 v235, v32, v104
    v_mul_f32 v237, v40, v136
    v_fmac_f32 v235, v33, v105
    v_fmac_f32 v237, v41, v137
    v_fmac_f32 v235, v34, v106
    v_fmac_f32 v237, v42, v138
    v_fmac_f32 v235, v35, v107
    v_fmac_f32 v237, v43, v139
    v_fmac_f32 v235, v36, v108
    v_fmac_f32 v237, v44, v140
    v_fmac_f32 v235, v37, v109
    v_fmac_f32 v237, v45, v141
    v_fmac_f32 v235, v38, v110
    v_fmac_f32 v237, v46, v142
    v_fmac_f32 v235, v39, v111
    v_fmac_f32 v237, v47, v143
    v_mul_f32 v239, v48, v136
    v_mul_f32 v241, v56, v136
    v_fmac_f32 v239, v49, v137
    v_fmac_f32 v241, v57, v137
    v_fmac_f32 v239, v50, v138
    v_fmac_f32 v241, v58, v138
    v_fmac_f32 v239, v51, v139
    v_fmac_f32 v241, v59, v139
    v_fmac_f32 v239, v52, v140
    v_fmac_f32 v241, v60, v140
    v_fmac_f32 v239, v53, v141
    v_fmac_f32 v241, v61, v141
    v_fmac_f32 v239, v54, v142
    v_fmac_f32 v241, v62, v142
    v_fmac_f32 v239, v55, v143
    v_fmac_f32 v241, v63, v143
    s_setprio 1
    s_waitcnt vmcnt(6) lgkmcnt(0)
    v_mfma_f32_32x32x16_bf16 v[0:15], v[64:67], v[184:187], 0
    ds_read_b64_tr_b16 v[176:177], v246 offset:4096
    ds_read_b64_tr_b16 v[178:179], v246 offset:4608
    ds_read_b64_tr_b16 v[180:181], v247 offset:4096
    ds_read_b64_tr_b16 v[182:183], v247 offset:4608
    s_mov_b32 m0, s69
    v_mfma_f32_32x32x16_bf16 v[16:31], v[68:71], v[184:187], 0
    buffer_load_dwordx4 v224, s[4:7], s45 offen lds
    buffer_load_dwordx4 v225, s[72:75], s45 offen offset:1024 lds
    v_permlane32_swap_b32 v234, v236
    v_permlane32_swap_b32 v235, v237
    v_mfma_f32_32x32x16_bf16 v[32:47], v[64:67], v[188:191], 0
    v_permlane32_swap_b32 v240, v238
    v_permlane32_swap_b32 v241, v239
    v_add_f32 v234, v234, v236
    v_add_f32 v235, v235, v237
    v_add_f32 v240, v240, v238
    v_mfma_f32_32x32x16_bf16 v[48:63], v[68:71], v[188:191], 0
    s_setprio 0
    v_add_f32 v241, v241, v239
    s_set_gpr_idx_on s31, gpr_idx(DST)
    s_nop 0
    v_cvt_pk_bf16_f32 v192, v234, v235
    v_cvt_pk_bf16_f32 v193, v240, v241
    s_set_gpr_idx_off
    v_mul_f32 v234, v0, v144
    v_mul_f32 v236, v8, v112
    v_fmac_f32 v234, v1, v145
    v_fmac_f32 v236, v9, v113
    v_fmac_f32 v234, v2, v146
    v_fmac_f32 v236, v10, v114
    v_fmac_f32 v234, v3, v147
    v_fmac_f32 v236, v11, v115
    v_fmac_f32 v234, v4, v148
    v_fmac_f32 v236, v12, v116
    v_fmac_f32 v234, v5, v149
    v_fmac_f32 v236, v13, v117
    v_fmac_f32 v234, v6, v150
    v_fmac_f32 v236, v14, v118
    v_fmac_f32 v234, v7, v151
    v_fmac_f32 v236, v15, v119
    v_mul_f32 v238, v16, v160
    v_mul_f32 v240, v24, v160
    v_fmac_f32 v238, v17, v161
    v_fmac_f32 v240, v25, v161
    v_fmac_f32 v238, v18, v162
    v_fmac_f32 v240, v26, v162
    v_fmac_f32 v238, v19, v163
    v_fmac_f32 v240, v27, v163
    v_fmac_f32 v238, v20, v164
    v_fmac_f32 v240, v28, v164
    v_fmac_f32 v238, v21, v165
    v_fmac_f32 v240, v29, v165
    v_fmac_f32 v238, v22, v166
    v_fmac_f32 v240, v30, v166
    v_fmac_f32 v238, v23, v167
    v_fmac_f32 v240, v31, v167
    v_mul_f32 v235, v32, v152
    v_mul_f32 v237, v40, v120
    v_fmac_f32 v235, v33, v153
    v_fmac_f32 v237, v41, v121
    v_fmac_f32 v235, v34, v154
    v_fmac_f32 v237, v42, v122
    v_fmac_f32 v235, v35, v155
    v_fmac_f32 v237, v43, v123
    v_fmac_f32 v235, v36, v156
    v_fmac_f32 v237, v44, v124
    v_fmac_f32 v235, v37, v157
    v_fmac_f32 v237, v45, v125
    v_fmac_f32 v235, v38, v158
    v_fmac_f32 v237, v46, v126
    v_fmac_f32 v235, v39, v159
    v_fmac_f32 v237, v47, v127
    v_mul_f32 v239, v48, v168
    v_mul_f32 v241, v56, v168
    v_fmac_f32 v239, v49, v169
    v_fmac_f32 v241, v57, v169
    v_fmac_f32 v239, v50, v170
    v_fmac_f32 v241, v58, v170
    v_fmac_f32 v239, v51, v171
    v_fmac_f32 v241, v59, v171
    v_fmac_f32 v239, v52, v172
    v_fmac_f32 v241, v60, v172
    v_fmac_f32 v239, v53, v173
    v_fmac_f32 v241, v61, v173
    v_fmac_f32 v239, v54, v174
    v_fmac_f32 v241, v62, v174
    v_fmac_f32 v239, v55, v175
    v_fmac_f32 v241, v63, v175
    s_setprio 1
    s_waitcnt vmcnt(6) lgkmcnt(0)
    v_mfma_f32_32x32x16_bf16 v[0:15], v[64:67], v[176:179], 0
    ds_read_b64_tr_b16 v[184:185], v246 offset:6144
    ds_read_b64_tr_b16 v[186:187], v246 offset:6656
    ds_read_b64_tr_b16 v[188:189], v247 offset:6144
    ds_read_b64_tr_b16 v[190:191], v247 offset:6656
    s_mov_b32 m0, s70
    v_mfma_f32_32x32x16_bf16 v[16:31], v[68:71], v[176:179], 0
    buffer_load_dwordx4 v226, s[4:7], s46 offen lds
    buffer_load_dwordx4 v227, s[72:75], s46 offen offset:1024 lds
    v_mfma_f32_32x32x16_bf16 v[32:47], v[64:67], v[180:183], 0
    v_mfma_f32_32x32x16_bf16 v[48:63], v[68:71], v[180:183], 0
    s_setprio 0
    s_nop 0
    v_mul_f32 v242, v0, v144
    v_fma_f32 v238, v8, v160, -v238
    v_fmac_f32 v242, v1, v145
    v_fmac_f32 v238, v9, v161
    v_fmac_f32 v242, v2, v146
    v_fmac_f32 v238, v10, v162
    v_fmac_f32 v242, v3, v147
    v_fmac_f32 v238, v11, v163
    v_fmac_f32 v242, v4, v148
    v_fmac_f32 v238, v12, v164
    v_fmac_f32 v242, v5, v149
    v_fmac_f32 v238, v13, v165
    v_fmac_f32 v242, v6, v150
    v_fmac_f32 v238, v14, v166
    v_fmac_f32 v242, v7, v151
    v_fmac_f32 v238, v15, v167
    v_fmac_f32 v236, v16, v112
    v_mul_f32 v244, v24, v160
    v_fmac_f32 v236, v17, v113
    v_fmac_f32 v244, v25, v161
    v_fmac_f32 v236, v18, v114
    v_fmac_f32 v244, v26, v162
    v_fmac_f32 v236, v19, v115
    v_fmac_f32 v244, v27, v163
    v_fmac_f32 v236, v20, v116
    v_fmac_f32 v244, v28, v164
    v_fmac_f32 v236, v21, v117
    v_fmac_f32 v244, v29, v165
    v_fmac_f32 v236, v22, v118
    v_fmac_f32 v244, v30, v166
    v_fmac_f32 v236, v23, v119
    v_fmac_f32 v244, v31, v167
    v_mul_f32 v243, v32, v152
    v_fma_f32 v239, v40, v168, -v239
    v_fmac_f32 v243, v33, v153
    v_fmac_f32 v239, v41, v169
    v_fmac_f32 v243, v34, v154
    v_fmac_f32 v239, v42, v170
    v_fmac_f32 v243, v35, v155
    v_fmac_f32 v239, v43, v171
    v_fmac_f32 v243, v36, v156
    v_fmac_f32 v239, v44, v172
    v_fmac_f32 v243, v37, v157
    v_fmac_f32 v239, v45, v173
    v_fmac_f32 v243, v38, v158
    v_fmac_f32 v239, v46, v174
    v_fmac_f32 v243, v39, v159
    v_fmac_f32 v239, v47, v175
    v_fmac_f32 v237, v48, v120
    v_mul_f32 v245, v56, v168
    v_fmac_f32 v237, v49, v121
    v_fmac_f32 v245, v57, v169
    v_fmac_f32 v237, v50, v122
    v_fmac_f32 v245, v58, v170
    v_fmac_f32 v237, v51, v123
    v_fmac_f32 v245, v59, v171
    v_fmac_f32 v237, v52, v124
    v_fmac_f32 v245, v60, v172
    v_fmac_f32 v237, v53, v125
    v_fmac_f32 v245, v61, v173
    v_fmac_f32 v237, v54, v126
    v_fmac_f32 v245, v62, v174
    v_fmac_f32 v237, v55, v127
    v_fmac_f32 v245, v63, v175
    s_setprio 1
    s_waitcnt vmcnt(4) lgkmcnt(0)
    v_mfma_f32_32x32x16_bf16 v[0:15], v[64:67], v[184:187], 0
    ds_read_b64_tr_b16 v[176:177], v246 offset:0
    ds_read_b64_tr_b16 v[178:179], v246 offset:512
    ds_read_b64_tr_b16 v[180:181], v247 offset:0
    ds_read_b64_tr_b16 v[182:183], v247 offset:512
    s_mov_b32 m0, s71
    v_mfma_f32_32x32x16_bf16 v[16:31], v[68:71], v[184:187], 0
    buffer_load_dwordx4 v228, s[4:7], s47 offen lds
    buffer_load_dwordx4 v229, s[72:75], s47 offen offset:1024 lds
    v_permlane32_swap_b32 v242, v234
    v_permlane32_swap_b32 v243, v235
    v_add_f32 v242, v242, v234
    v_mfma_f32_32x32x16_bf16 v[32:47], v[64:67], v[188:191], 0
    v_add_f32 v243, v243, v235
    s_set_gpr_idx_on s31, gpr_idx(DST)
    s_nop 0
    v_cvt_pk_bf16_f32 v194, v242, v243
    s_set_gpr_idx_off
    v_mfma_f32_32x32x16_bf16 v[48:63], v[68:71], v[188:191], 0
    s_setprio 0
    v_mul_f32 v242, v0, v144
    v_fma_f32 v240, v8, v160, -v240
    v_fmac_f32 v242, v1, v145
    v_fmac_f32 v240, v9, v161
    v_fmac_f32 v242, v2, v146
    v_fmac_f32 v240, v10, v162
    v_fmac_f32 v242, v3, v147
    v_fmac_f32 v240, v11, v163
    v_fmac_f32 v242, v4, v148
    v_fmac_f32 v240, v12, v164
    v_fmac_f32 v242, v5, v149
    v_fmac_f32 v240, v13, v165
    v_fmac_f32 v242, v6, v150
    v_fmac_f32 v240, v14, v166
    v_fmac_f32 v242, v7, v151
    v_fmac_f32 v240, v15, v167
    s_sub_u32 s58, s48, s29
    v_add_u32 v249, s58, v249
    v_add_u32 v250, s58, v250
    v_fma_f32 v244, v16, v160, -v244
    v_fmac_f32 v236, v24, v112
    v_fmac_f32 v244, v17, v161
    v_fmac_f32 v236, v25, v113
    v_fmac_f32 v244, v18, v162
    v_fmac_f32 v236, v26, v114
    v_fmac_f32 v244, v19, v163
    v_fmac_f32 v236, v27, v115
    v_fmac_f32 v244, v20, v164
    v_fmac_f32 v236, v28, v116
    v_fmac_f32 v244, v21, v165
    v_fmac_f32 v236, v29, v117
    v_fmac_f32 v244, v22, v166
    v_fmac_f32 v236, v30, v118
    v_fmac_f32 v244, v23, v167
    v_fmac_f32 v236, v31, v119
    ds_read_b64_tr_b16 v[0:1], v249 offset:0
    ds_read_b64_tr_b16 v[2:3], v249 offset:128
    ds_read_b128 v[4:7], v250 offset:0
    ds_read_b128 v[8:11], v250 offset:16
    ds_read_b128 v[12:15], v250 offset:384
    ds_read_b128 v[16:19], v250 offset:400
    v_mul_f32 v243, v32, v152
    v_fma_f32 v241, v40, v168, -v241
    v_fmac_f32 v243, v33, v153
    v_fmac_f32 v241, v41, v169
    v_fmac_f32 v243, v34, v154
    v_fmac_f32 v241, v42, v170
    v_fmac_f32 v243, v35, v155
    v_fmac_f32 v241, v43, v171
    v_fmac_f32 v243, v36, v156
    v_fmac_f32 v241, v44, v172
    v_fmac_f32 v243, v37, v157
    v_fmac_f32 v241, v45, v173
    v_fmac_f32 v243, v38, v158
    v_fmac_f32 v241, v46, v174
    v_fmac_f32 v243, v39, v159
    v_fmac_f32 v241, v47, v175
    ds_read_b64_tr_b16 v[20:21], v249 offset:512
    ds_read_b64_tr_b16 v[22:23], v249 offset:640
    ds_read_b128 v[24:27], v250 offset:64
    ds_read_b128 v[28:31], v250 offset:80
    ds_read_b128 v[32:35], v250 offset:448
    ds_read_b128 v[36:39], v250 offset:464
    v_fma_f32 v245, v48, v168, -v245
    v_fmac_f32 v237, v56, v120
    v_fmac_f32 v245, v49, v169
    v_fmac_f32 v237, v57, v121
    v_fmac_f32 v245, v50, v170
    v_fmac_f32 v237, v58, v122
    v_fmac_f32 v245, v51, v171
    v_fmac_f32 v237, v59, v123
    v_fmac_f32 v245, v52, v172
    v_fmac_f32 v237, v60, v124
    v_fmac_f32 v245, v53, v173
    v_fmac_f32 v237, v61, v125
    v_fmac_f32 v245, v54, v174
    v_fmac_f32 v237, v62, v126
    v_fmac_f32 v245, v55, v175
    v_fmac_f32 v237, v63, v127
    s_cmp_lg_u32 s34, 0
    s_cbranch_scc1 K2_SWITCH
    s_mov_b32 s29, s48
    s_mov_b32 s32, s31
    s_mov_b32 s30, s3
    s_mov_b32 s31, s35
    s_cmp_eq_u32 s33, 2
    s_cbranch_scc1 K2_U20
    s_cmp_eq_u32 s33, 3
    s_cbranch_scc1 K2_U30
    s_cmp_eq_u32 s33, 1
    s_cbranch_scc1 K2_U10
    s_branch K2_U40
K2_U40:
    s_setprio 1
    s_waitcnt lgkmcnt(10)
    v_lshlrev_b32 v40, 16, v0
    v_and_b32 v41, 0xffff0000, v0
    v_lshlrev_b32 v42, 16, v1
    v_and_b32 v43, 0xffff0000, v1
    v_lshlrev_b32 v44, 16, v2
    v_and_b32 v45, 0xffff0000, v2
    v_lshlrev_b32 v46, 16, v3
    v_and_b32 v47, 0xffff0000, v3
    s_waitcnt lgkmcnt(8)
    v_mul_f32 v4, v40, v4
    v_mul_f32 v5, v41, v5
    v_mul_f32 v6, v42, v6
    v_mul_f32 v7, v43, v7
    v_mul_f32 v8, v44, v8
    v_mul_f32 v9, v45, v9
    v_mul_f32 v10, v46, v10
    v_mul_f32 v11, v47, v11
    v_cvt_pk_bf16_f32 v64, v4, v5
    v_cvt_pk_bf16_f32 v65, v6, v7
    v_cvt_pk_bf16_f32 v66, v8, v9
    v_cvt_pk_bf16_f32 v67, v10, v11
    s_waitcnt lgkmcnt(6)
    v_mul_f32 v12, v40, v12
    v_mul_f32 v13, v41, v13
    v_mul_f32 v14, v42, v14
    v_mul_f32 v15, v43, v15
    v_mul_f32 v16, v44, v16
    v_mul_f32 v17, v45, v17
    v_mul_f32 v18, v46, v18
    v_mul_f32 v19, v47, v19
    v_cvt_pk_bf16_f32 v68, v12, v13
    v_cvt_pk_bf16_f32 v69, v14, v15
    v_cvt_pk_bf16_f32 v70, v16, v17
    v_cvt_pk_bf16_f32 v71, v18, v19
    ds_read_b64_tr_b16 v[0:1], v249 offset:1024
    ds_read_b64_tr_b16 v[2:3], v249 offset:1152
    ds_read_b128 v[4:7], v250 offset:128
    ds_read_b128 v[8:11], v250 offset:144
    ds_read_b128 v[12:15], v250 offset:512
    ds_read_b128 v[16:19], v250 offset:528
    s_waitcnt lgkmcnt(10)
    v_lshlrev_b32 v48, 16, v20
    v_and_b32 v49, 0xffff0000, v20
    v_lshlrev_b32 v50, 16, v21
    v_and_b32 v51, 0xffff0000, v21
    v_lshlrev_b32 v52, 16, v22
    v_and_b32 v53, 0xffff0000, v22
    v_lshlrev_b32 v54, 16, v23
    v_and_b32 v55, 0xffff0000, v23
    s_waitcnt lgkmcnt(8)
    v_mul_f32 v24, v48, v24
    v_mul_f32 v25, v49, v25
    v_mul_f32 v26, v50, v26
    v_mul_f32 v27, v51, v27
    v_mul_f32 v28, v52, v28
    v_mul_f32 v29, v53, v29
    v_mul_f32 v30, v54, v30
    v_mul_f32 v31, v55, v31
    v_cvt_pk_bf16_f32 v72, v24, v25
    v_cvt_pk_bf16_f32 v73, v26, v27
    v_cvt_pk_bf16_f32 v74, v28, v29
    v_cvt_pk_bf16_f32 v75, v30, v31
    s_waitcnt lgkmcnt(6)
    v_mul_f32 v32, v48, v32
    v_mul_f32 v33, v49, v33
    v_mul_f32 v34, v50, v34
    v_mul_f32 v35, v51, v35
    v_mul_f32 v36, v52, v36
    v_mul_f32 v37, v53, v37
    v_mul_f32 v38, v54, v38
    v_mul_f32 v39, v55, v39
    v_cvt_pk_bf16_f32 v76, v32, v33
    v_cvt_pk_bf16_f32 v77, v34, v35
    v_cvt_pk_bf16_f32 v78, v36, v37
    v_cvt_pk_bf16_f32 v79, v38, v39
    s_lshr_b32 s65, s30, 27
    s_mov_b32 s66, 161536
    s_cmp_ge_u32 s65, 2
    s_cselect_b32 s66, 158112, s66
    s_mul_i32 s65, s65, 512
    s_add_u32 s65, s65, s66
    s_sub_u32 s65, s65, s29
    v_add_u32 v56, s65, v249
    s_lshr_b32 s65, s30, 27
    s_mov_b32 s66, 161536
    s_cmp_ge_u32 s65, 2
    s_cselect_b32 s66, 159008, s66
    s_mul_i32 s65, s65, 64
    s_add_u32 s65, s65, s66
    s_sub_u32 s65, s65, s29
    v_add_u32 v57, s65, v250
    ds_read_b64_tr_b16 v[20:21], v56 offset:0
    ds_read_b64_tr_b16 v[22:23], v56 offset:128
    ds_read_b128 v[24:27], v57 offset:0
    ds_read_b128 v[28:31], v57 offset:16
    ds_read_b128 v[32:35], v57 offset:384
    ds_read_b128 v[36:39], v57 offset:400
    s_waitcnt lgkmcnt(10)
    v_lshlrev_b32 v40, 16, v0
    v_and_b32 v41, 0xffff0000, v0
    v_lshlrev_b32 v42, 16, v1
    v_and_b32 v43, 0xffff0000, v1
    v_lshlrev_b32 v44, 16, v2
    v_and_b32 v45, 0xffff0000, v2
    v_lshlrev_b32 v46, 16, v3
    v_and_b32 v47, 0xffff0000, v3
    s_waitcnt lgkmcnt(8)
    v_mul_f32 v4, v40, v4
    v_mul_f32 v5, v41, v5
    v_mul_f32 v6, v42, v6
    v_mul_f32 v7, v43, v7
    v_mul_f32 v8, v44, v8
    v_mul_f32 v9, v45, v9
    v_mul_f32 v10, v46, v10
    v_mul_f32 v11, v47, v11
    v_cvt_pk_bf16_f32 v80, v4, v5
    v_cvt_pk_bf16_f32 v81, v6, v7
    v_cvt_pk_bf16_f32 v82, v8, v9
    v_cvt_pk_bf16_f32 v83, v10, v11
    s_waitcnt lgkmcnt(6)
    v_mul_f32 v12, v40, v12
    v_mul_f32 v13, v41, v13
    v_mul_f32 v14, v42, v14
    v_mul_f32 v15, v43, v15
    v_mul_f32 v16, v44, v16
    v_mul_f32 v17, v45, v17
    v_mul_f32 v18, v46, v18
    v_mul_f32 v19, v47, v19
    v_cvt_pk_bf16_f32 v84, v12, v13
    v_cvt_pk_bf16_f32 v85, v14, v15
    v_cvt_pk_bf16_f32 v86, v16, v17
    v_cvt_pk_bf16_f32 v87, v18, v19
    s_waitcnt lgkmcnt(4)
    v_lshlrev_b32 v48, 16, v20
    v_and_b32 v49, 0xffff0000, v20
    v_lshlrev_b32 v50, 16, v21
    v_and_b32 v51, 0xffff0000, v21
    v_lshlrev_b32 v52, 16, v22
    v_and_b32 v53, 0xffff0000, v22
    v_lshlrev_b32 v54, 16, v23
    v_and_b32 v55, 0xffff0000, v23
    s_waitcnt lgkmcnt(2)
    v_mul_f32 v24, v48, v24
    v_mul_f32 v25, v49, v25
    v_mul_f32 v26, v50, v26
    v_mul_f32 v27, v51, v27
    v_mul_f32 v28, v52, v28
    v_mul_f32 v29, v53, v29
    v_mul_f32 v30, v54, v30
    v_mul_f32 v31, v55, v31
    v_cvt_pk_bf16_f32 v88, v24, v25
    v_cvt_pk_bf16_f32 v89, v26, v27
    v_cvt_pk_bf16_f32 v90, v28, v29
    v_cvt_pk_bf16_f32 v91, v30, v31
    s_waitcnt lgkmcnt(0)
    v_mul_f32 v32, v48, v32
    v_mul_f32 v33, v49, v33
    v_mul_f32 v34, v50, v34
    v_mul_f32 v35, v51, v35
    v_mul_f32 v36, v52, v36
    v_mul_f32 v37, v53, v37
    v_mul_f32 v38, v54, v38
    v_mul_f32 v39, v55, v39
    v_cvt_pk_bf16_f32 v92, v32, v33
    v_cvt_pk_bf16_f32 v93, v34, v35
    v_cvt_pk_bf16_f32 v94, v36, v37
    v_cvt_pk_bf16_f32 v95, v38, v39
    s_waitcnt vmcnt(4)
    v_mfma_f32_32x32x16_bf16 v[0:15], v[64:67], v[176:179], 0
    ds_read_b64_tr_b16 v[184:185], v246 offset:2048
    ds_read_b64_tr_b16 v[186:187], v246 offset:2560
    ds_read_b64_tr_b16 v[188:189], v247 offset:2048
    ds_read_b64_tr_b16 v[190:191], v247 offset:2560
    s_mov_b32 m0, s68
    v_mfma_f32_32x32x16_bf16 v[16:31], v[68:71], v[176:179], 0
    buffer_load_dwordx4 v222, s[4:7], s41 offen lds
    buffer_load_dwordx4 v223, s[72:75], s41 offen offset:1024 lds
    v_permlane32_swap_b32 v242, v236
    v_permlane32_swap_b32 v243, v237
    s_add_u32 s38, s38, 1
    v_mfma_f32_32x32x16_bf16 v[32:47], v[64:67], v[180:183], 0
    v_permlane32_swap_b32 v244, v238
    v_permlane32_swap_b32 v245, v239
    v_permlane32_swap_b32 v240, v241
    v_add_f32 v242, v242, v236
    v_mfma_f32_32x32x16_bf16 v[48:63], v[68:71], v[180:183], 0
    v_add_f32 v243, v243, v237
    v_add_f32 v244, v244, v238
    v_add_f32 v245, v245, v239
    v_add_f32 v240, -v240, -v241
    v_mov_b32 v254, s52
    v_mov_b32 v255, s38
    s_waitcnt vmcnt(4) lgkmcnt(0)
    v_mfma_f32_32x32x16_bf16 v[0:15], v[72:75], v[184:187], v[0:15]
    ds_read_b64_tr_b16 v[176:177], v246 offset:4096
    ds_read_b64_tr_b16 v[178:179], v246 offset:4608
    ds_read_b64_tr_b16 v[180:181], v247 offset:4096
    ds_read_b64_tr_b16 v[182:183], v247 offset:4608
    s_lshl_b32 s58, s38, 3
    s_add_u32 s58, s58, s20
    s_mov_b32 m0, s69
    v_mfma_f32_32x32x16_bf16 v[16:31], v[76:79], v[184:187], v[16:31]
    buffer_load_dwordx4 v224, s[4:7], s41 offen lds
    buffer_load_dwordx4 v225, s[72:75], s41 offen offset:1024 lds
    s_set_gpr_idx_on s32, gpr_idx(DST)
    s_nop 0
    v_cvt_pk_bf16_f32 v195, v242, v243
    v_cvt_pk_bf16_f32 v196, v244, v245
    v_cvt_pk_bf16_f32 v197, v240, v240
    s_set_gpr_idx_off
    s_mov_b64 exec, 1
    ds_write_b32 v254, v255
    s_mov_b64 exec, -1
    s_cmp_lt_u32 s58, s22
    s_cbranch_scc0 K2_dyn_81
K2_back_82:
    v_readlane_b32 s3, v253, s58
    s_lshl_b32 s44, s34, 7
    s_lshl_b32 s60, s58, 5
    s_and_b32 s48, s3, 0x3ffff
    s_bfe_u32 s33, s3, 0x30012
    s_sub_u32 s60, s60, s48
    s_and_b32 s60, s60, 0xff
    s_add_u32 s60, s60, s48
    s_mul_i32 s35, s38, 6
    s_cmp_eq_u32 s34, 0
    s_cselect_b32 s35, s35, s60
    s_mov_b32 s45, s44
    s_add_u32 s47, s44, 256
    s_add_u32 s49, s48, 32
    s_add_u32 s60, s48, 64
    s_cmp_eq_u32 s33, 3
    s_cselect_b32 s46, s44, s47
    s_cselect_b32 s50, s60, s48
    s_cselect_b32 s51, s48, s49
    s_sub_u32 s60, s33, 2
    s_cmp_lt_u32 s60, 2
    s_cbranch_scc0 K2_rare_87
K2_back_88:
    v_mfma_f32_32x32x16_bf16 v[32:47], v[72:75], v[188:191], v[32:47]
    v_add_u32 v233, s48, v230
    ds_read_b32 v232, v233
    ds_read_b32 v233, v233 offset:1024
    v_mfma_f32_32x32x16_bf16 v[48:63], v[76:79], v[188:191], v[48:63]
    s_waitcnt vmcnt(4) lgkmcnt(3)
    v_mfma_f32_32x32x16_bf16 v[0:15], v[80:83], v[176:179], v[0:15]
    ds_read_b64_tr_b16 v[184:185], v246 offset:6144
    ds_read_b64_tr_b16 v[186:187], v246 offset:6656
    ds_read_b64_tr_b16 v[188:189], v247 offset:6144
    ds_read_b64_tr_b16 v[190:191], v247 offset:6656
    s_mov_b32 m0, s70
    v_mfma_f32_32x32x16_bf16 v[16:31], v[84:87], v[176:179], v[16:31]
    buffer_load_dwordx4 v226, s[4:7], s41 offen lds
    buffer_load_dwordx4 v227, s[72:75], s41 offen offset:1024 lds
    v_mfma_f32_32x32x16_bf16 v[32:47], v[80:83], v[180:183], v[32:47]
    v_mfma_f32_32x32x16_bf16 v[48:63], v[84:87], v[180:183], v[48:63]
    s_waitcnt lgkmcnt(4)
    v_or_b32 v232, v232, v231
    v_or_b32 v233, v233, v231
    s_cmp_lg_u32 s34, 0
    s_cbranch_scc1 K2_dum_90
    s_add_u32 m0, s48, 864
    s_add_u32 s65, s48, 1888
    buffer_load_dwordx4 v232, s[16:19], 0 offen  lds
    s_mov_b32 m0, s65
    s_mov_b32 exec_hi, 0
    buffer_load_dwordx4 v233, s[16:19], 0 offen  lds
    s_cmp_eq_u32 s33, 4
    s_cbranch_scc1 K2_a4_91
K2_b4_93:
    s_mov_b32 exec_hi, -1
K2_back_92:
    s_waitcnt vmcnt(6) lgkmcnt(0)
    v_mfma_f32_32x32x16_bf16 v[0:15], v[88:91], v[184:187], v[0:15]
    ds_read_b64_tr_b16 v[176:177], v246 offset:0
    ds_read_b64_tr_b16 v[178:179], v246 offset:512
    ds_read_b64_tr_b16 v[180:181], v247 offset:0
    ds_read_b64_tr_b16 v[182:183], v247 offset:512
    s_mov_b32 m0, s71
    v_mfma_f32_32x32x16_bf16 v[16:31], v[92:95], v[184:187], v[16:31]
    buffer_load_dwordx4 v228, s[4:7], s41 offen lds
    buffer_load_dwordx4 v229, s[72:75], s41 offen offset:1024 lds
    v_mfma_f32_32x32x16_bf16 v[32:47], v[88:91], v[188:191], v[32:47]
    s_nop 2
    v_mul_f32 v234, v0, v96
    v_mul_f32 v236, v8, v128
    v_fmac_f32 v234, v1, v97
    v_fmac_f32 v236, v9, v129
    v_fmac_f32 v234, v2, v98
    v_fmac_f32 v236, v10, v130
    v_fmac_f32 v234, v3, v99
    v_mfma_f32_32x32x16_bf16 v[48:63], v[92:95], v[188:191], v[48:63]
    s_setprio 0
    v_fmac_f32 v236, v11, v131
    v_fmac_f32 v234, v4, v100
    v_fmac_f32 v236, v12, v132
    v_fmac_f32 v234, v5, v101
    v_fmac_f32 v236, v13, v133
    v_fmac_f32 v234, v6, v102
    v_fmac_f32 v236, v14, v134
    v_fmac_f32 v234, v7, v103
    v_fmac_f32 v236, v15, v135
    v_mul_f32 v238, v16, v128
    v_mul_f32 v240, v24, v128
    v_fmac_f32 v238, v17, v129
    v_fmac_f32 v240, v25, v129
    v_fmac_f32 v238, v18, v130
    v_fmac_f32 v240, v26, v130
    v_fmac_f32 v238, v19, v131
    v_fmac_f32 v240, v27, v131
    v_fmac_f32 v238, v20, v132
    v_fmac_f32 v240, v28, v132
    v_fmac_f32 v238, v21, v133
    v_fmac_f32 v240, v29, v133
    v_fmac_f32 v238, v22, v134
    v_fmac_f32 v240, v30, v134
    v_fmac_f32 v238, v23, v135
    v_fmac_f32 v240, v31, v135
    v_mul_f32 v235, v32, v104
    v_mul_f32 v237, v40, v136
    v_fmac_f32 v235, v33, v105
    v_fmac_f32 v237, v41, v137
    v_fmac_f32 v235, v34, v106
    v_fmac_f32 v237, v42, v138
    v_fmac_f32 v235, v35, v107
    v_fmac_f32 v237, v43, v139
    v_fmac_f32 v235, v36, v108
    v_fmac_f32 v237, v44, v140
    v_fmac_f32 v235, v37, v109
    v_fmac_f32 v237, v45, v141
    v_fmac_f32 v235, v38, v110
    v_fmac_f32 v237, v46, v142
    v_fmac_f32 v235, v39, v111
    v_fmac_f32 v237, v47, v143
    v_mul_f32 v239, v48, v136
    v_mul_f32 v241, v56, v136
    s_setprio 1
    s_waitcnt vmcnt(6) lgkmcnt(0)
    v_mfma_f32_32x32x16_bf16 v[0:15], v[64:67], v[176:179], 0
    ds_read_b64_tr_b16 v[184:185], v246 offset:2048
    ds_read_b64_tr_b16 v[186:187], v246 offset:2560
    ds_read_b64_tr_b16 v[188:189], v247 offset:2048
    ds_read_b64_tr_b16 v[190:191], v247 offset:2560
    v_fmac_f32 v239, v49, v137
    v_fmac_f32 v241, v57, v137
    s_mov_b32 m0, s68
    v_mfma_f32_32x32x16_bf16 v[16:31], v[68:71], v[176:179], 0
    buffer_load_dwordx4 v222, s[4:7], s42 offen lds
    buffer_load_dwordx4 v223, s[72:75], s42 offen offset:1024 lds
    v_fmac_f32 v239, v50, v138
    v_fmac_f32 v241, v58, v138
    v_fmac_f32 v239, v51, v139
    v_fmac_f32 v241, v59, v139
    v_fmac_f32 v239, v52, v140
    v_mfma_f32_32x32x16_bf16 v[32:47], v[64:67], v[180:183], 0
    v_fmac_f32 v241, v60, v140
    v_fmac_f32 v239, v53, v141
    v_fmac_f32 v241, v61, v141
    v_fmac_f32 v239, v54, v142
    v_fmac_f32 v241, v62, v142
    v_fmac_f32 v239, v55, v143
    v_fmac_f32 v241, v63, v143
    v_mfma_f32_32x32x16_bf16 v[48:63], v[68:71], v[180:183], 0
    v_permlane32_swap_b32 v234, v236
    v_permlane32_swap_b32 v235, v237
    v_permlane32_swap_b32 v240, v238
    s_waitcnt vmcnt(6) lgkmcnt(0)
    v_mfma_f32_32x32x16_bf16 v[0:15], v[72:75], v[184:187], v[0:15]
    ds_read_b64_tr_b16 v[176:177], v246 offset:4096
    ds_read_b64_tr_b16 v[178:179], v246 offset:4608
    ds_read_b64_tr_b16 v[180:181], v247 offset:4096
    ds_read_b64_tr_b16 v[182:183], v247 offset:4608
    v_permlane32_swap_b32 v241, v239
    s_mov_b32 m0, s69
    v_mfma_f32_32x32x16_bf16 v[16:31], v[76:79], v[184:187], v[16:31]
    buffer_load_dwordx4 v224, s[4:7], s42 offen lds
    buffer_load_dwordx4 v225, s[72:75], s42 offen offset:1024 lds
    v_add_f32 v234, v234, v236
    v_add_f32 v235, v235, v237
    v_add_f32 v240, v240, v238
    v_add_f32 v241, v241, v239
    v_mfma_f32_32x32x16_bf16 v[32:47], v[72:75], v[188:191], v[32:47]
    s_set_gpr_idx_on s31, gpr_idx(DST)
    s_nop 0
    v_cvt_pk_bf16_f32 v192, v234, v235
    v_cvt_pk_bf16_f32 v193, v240, v241
    s_set_gpr_idx_off
    v_mfma_f32_32x32x16_bf16 v[48:63], v[76:79], v[188:191], v[48:63]
    s_waitcnt vmcnt(4) lgkmcnt(0)
    v_mfma_f32_32x32x16_bf16 v[0:15], v[80:83], v[176:179], v[0:15]
    ds_read_b64_tr_b16 v[184:185], v246 offset:6144
    ds_read_b64_tr_b16 v[186:187], v246 offset:6656
    ds_read_b64_tr_b16 v[188:189], v247 offset:6144
    ds_read_b64_tr_b16 v[190:191], v247 offset:6656
    s_mov_b32 m0, s70
    v_mfma_f32_32x32x16_bf16 v[16:31], v[84:87], v[176:179], v[16:31]
    buffer_load_dwordx4 v226, s[4:7], s42 offen lds
    buffer_load_dwordx4 v227, s[72:75], s42 offen offset:1024 lds
    v_mfma_f32_32x32x16_bf16 v[32:47], v[80:83], v[180:183], v[32:47]
    v_mfma_f32_32x32x16_bf16 v[48:63], v[84:87], v[180:183], v[48:63]
    s_waitcnt vmcnt(4) lgkmcnt(0)
    v_mfma_f32_32x32x16_bf16 v[0:15], v[88:91], v[184:187], v[0:15]
    ds_read_b64_tr_b16 v[176:177], v246 offset:0
    ds_read_b64_tr_b16 v[178:179], v246 offset:512
    ds_read_b64_tr_b16 v[180:181], v247 offset:0
    ds_read_b64_tr_b16 v[182:183], v247 offset:512
    s_mov_b32 m0, s71
    v_mfma_f32_32x32x16_bf16 v[16:31], v[92:95], v[184:187], v[16:31]
    buffer_load_dwordx4 v228, s[4:7], s42 offen lds
    buffer_load_dwordx4 v229, s[72:75], s42 offen offset:1024 lds
    v_mfma_f32_32x32x16_bf16 v[32:47], v[88:91], v[188:191], v[32:47]
    s_nop 2
    v_mul_f32 v234, v0, v144
    v_mul_f32 v236, v8, v112
    v_fmac_f32 v234, v1, v145
    v_fmac_f32 v236, v9, v113
    v_fmac_f32 v234, v2, v146
    v_fmac_f32 v236, v10, v114
    v_fmac_f32 v234, v3, v147
    v_mfma_f32_32x32x16_bf16 v[48:63], v[92:95], v[188:191], v[48:63]
    s_setprio 0
    v_fmac_f32 v236, v11, v115
    v_fmac_f32 v234, v4, v148
    v_fmac_f32 v236, v12, v116
    v_fmac_f32 v234, v5, v149
    v_fmac_f32 v236, v13, v117
    v_fmac_f32 v234, v6, v150
    v_fmac_f32 v236, v14, v118
    v_fmac_f32 v234, v7, v151
    v_fmac_f32 v236, v15, v119
    v_mul_f32 v238, v16, v160
    v_mul_f32 v240, v24, v160
    v_fmac_f32 v238, v17, v161
    v_fmac_f32 v240, v25, v161
    v_fmac_f32 v238, v18, v162
    v_fmac_f32 v240, v26, v162
    v_fmac_f32 v238, v19, v163
    v_fmac_f32 v240, v27, v163
    v_fmac_f32 v238, v20, v164
    v_fmac_f32 v240, v28, v164
    v_fmac_f32 v238, v21, v165
    v_fmac_f32 v240, v29, v165
    v_fmac_f32 v238, v22, v166
    v_fmac_f32 v240, v30, v166
    v_fmac_f32 v238, v23, v167
    v_fmac_f32 v240, v31, v167
    v_mul_f32 v235, v32, v152
    v_mul_f32 v237, v40, v120
    v_fmac_f32 v235, v33, v153
    v_fmac_f32 v237, v41, v121
    v_fmac_f32 v235, v34, v154
    v_fmac_f32 v237, v42, v122
    v_fmac_f32 v235, v35, v155
    v_fmac_f32 v237, v43, v123
    v_fmac_f32 v235, v36, v156
    v_fmac_f32 v237, v44, v124
    v_fmac_f32 v235, v37, v157
    v_fmac_f32 v237, v45, v125
    v_fmac_f32 v235, v38, v158
    v_fmac_f32 v237, v46, v126
    v_fmac_f32 v235, v39, v159
    v_fmac_f32 v237, v47, v127
    v_mul_f32 v239, v48, v168
    v_mul_f32 v241, v56, v168
    s_setprio 1
    s_waitcnt vmcnt(4) lgkmcnt(0)
    v_mfma_f32_32x32x16_bf16 v[0:15], v[64:67], v[176:179], 0
    ds_read_b64_tr_b16 v[184:185], v246 offset:2048
    ds_read_b64_tr_b16 v[186:187], v246 offset:2560
    ds_read_b64_tr_b16 v[188:189], v247 offset:2048
    ds_read_b64_tr_b16 v[190:191], v247 offset:2560
    v_fmac_f32 v239, v49, v169
    v_fmac_f32 v241, v57, v169
    s_mov_b32 m0, s68
    v_mfma_f32_32x32x16_bf16 v[16:31], v[68:71], v[176:179], 0
    buffer_load_dwordx4 v222, s[4:7], s43 offen lds
    buffer_load_dwordx4 v223, s[72:75], s43 offen offset:1024 lds
    v_fmac_f32 v239, v50, v170
    v_fmac_f32 v241, v58, v170
    v_fmac_f32 v239, v51, v171
    v_fmac_f32 v241, v59, v171
    v_fmac_f32 v239, v52, v172
    v_mfma_f32_32x32x16_bf16 v[32:47], v[64:67], v[180:183], 0
    v_fmac_f32 v241, v60, v172
    v_fmac_f32 v239, v53, v173
    v_fmac_f32 v241, v61, v173
    v_fmac_f32 v239, v54, v174
    v_fmac_f32 v241, v62, v174
    v_fmac_f32 v239, v55, v175
    v_fmac_f32 v241, v63, v175
    v_mfma_f32_32x32x16_bf16 v[48:63], v[68:71], v[180:183], 0
    s_waitcnt vmcnt(4) lgkmcnt(0)
    v_mfma_f32_32x32x16_bf16 v[0:15], v[72:75], v[184:187], v[0:15]
    ds_read_b64_tr_b16 v[176:177], v246 offset:4096
    ds_read_b64_tr_b16 v[178:179], v246 offset:4608
    ds_read_b64_tr_b16 v[180:181], v247 offset:4096
    ds_read_b64_tr_b16 v[182:183], v247 offset:4608
    s_mov_b32 m0, s69
    v_mfma_f32_32x32x16_bf16 v[16:31], v[76:79], v[184:187], v[16:31]
    buffer_load_dwordx4 v224, s[4:7], s43 offen lds
    buffer_load_dwordx4 v225, s[72:75], s43 offen offset:1024 lds
    v_mfma_f32_32x32x16_bf16 v[32:47], v[72:75], v[188:191], v[32:47]
    v_mfma_f32_32x32x16_bf16 v[48:63], v[76:79], v[188:191], v[48:63]
    s_waitcnt vmcnt(4) lgkmcnt(0)
    v_mfma_f32_32x32x16_bf16 v[0:15], v[80:83], v[176:179], v[0:15]
    ds_read_b64_tr_b16 v[184:185], v246 offset:6144
    ds_read_b64_tr_b16 v[186:187], v246 offset:6656
    ds_read_b64_tr_b16 v[188:189], v247 offset:6144
    ds_read_b64_tr_b16 v[190:191], v247 offset:6656
    s_mov_b32 m0, s70
    v_mfma_f32_32x32x16_bf16 v[16:31], v[84:87], v[176:179], v[16:31]
    buffer_load_dwordx4 v226, s[4:7], s43 offen lds
    buffer_load_dwordx4 v227, s[72:75], s43 offen offset:1024 lds
    v_mfma_f32_32x32x16_bf16 v[32:47], v[80:83], v[180:183], v[32:47]
    v_add_u32 v222, s48, v251
    ds_read_b32 v222, v222
    v_mfma_f32_32x32x16_bf16 v[48:63], v[84:87], v[180:183], v[48:63]
    s_waitcnt vmcnt(4) lgkmcnt(1)
    v_mfma_f32_32x32x16_bf16 v[0:15], v[88:91], v[184:187], v[0:15]
    ds_read_b64_tr_b16 v[176:177], v246 offset:0
    ds_read_b64_tr_b16 v[178:179], v246 offset:512
    ds_read_b64_tr_b16 v[180:181], v247 offset:0
    ds_read_b64_tr_b16 v[182:183], v247 offset:512
    s_mov_b32 m0, s71
    v_mfma_f32_32x32x16_bf16 v[16:31], v[92:95], v[184:187], v[16:31]
    buffer_load_dwordx4 v228, s[4:7], s43 offen lds
    buffer_load_dwordx4 v229, s[72:75], s43 offen offset:1024 lds
    s_waitcnt lgkmcnt(4)
    v_mad_u32_u16 v223, v222, s39, v248 op_sel:[1,0,0,0]
    v_mad_u32_u16 v222, v222, s39, v248
    v_mfma_f32_32x32x16_bf16 v[32:47], v[88:91], v[188:191], v[32:47]
    v_add_u32 v224, s49, v251
    ds_read_b32 v224, v224
    v_mul_f32 v242, v0, v144
    v_fma_f32 v238, v8, v160, -v238
    v_fmac_f32 v242, v1, v145
    v_fmac_f32 v238, v9, v161
    v_fmac_f32 v242, v2, v146
    v_mfma_f32_32x32x16_bf16 v[48:63], v[92:95], v[188:191], v[48:63]
    s_setprio 0
    v_fmac_f32 v238, v10, v162
    v_fmac_f32 v242, v3, v147
    v_fmac_f32 v238, v11, v163
    v_fmac_f32 v242, v4, v148
    v_fmac_f32 v238, v12, v164
    v_fmac_f32 v242, v5, v149
    v_fmac_f32 v238, v13, v165
    v_fmac_f32 v242, v6, v150
    v_fmac_f32 v238, v14, v166
    v_fmac_f32 v242, v7, v151
    v_fmac_f32 v238, v15, v167
    v_fmac_f32 v236, v16, v112
    v_mul_f32 v244, v24, v160
    v_fmac_f32 v236, v17, v113
    v_fmac_f32 v244, v25, v161
    v_fmac_f32 v236, v18, v114
    v_fmac_f32 v244, v26, v162
    v_fmac_f32 v236, v19, v115
    v_fmac_f32 v244, v27, v163
    v_fmac_f32 v236, v20, v116
    v_fmac_f32 v244, v28, v164
    v_fmac_f32 v236, v21, v117
    v_fmac_f32 v244, v29, v165
    v_fmac_f32 v236, v22, v118
    v_fmac_f32 v244, v30, v166
    v_fmac_f32 v236, v23, v119
    v_fmac_f32 v244, v31, v167
    v_mul_f32 v243, v32, v152
    v_fma_f32 v239, v40, v168, -v239
    v_fmac_f32 v243, v33, v153
    v_fmac_f32 v239, v41, v169
    v_fmac_f32 v243, v34, v154
    v_fmac_f32 v239, v42, v170
    v_fmac_f32 v243, v35, v155
    v_fmac_f32 v239, v43, v171
    v_fmac_f32 v243, v36, v156
    v_fmac_f32 v239, v44, v172
    v_fmac_f32 v243, v37, v157
    v_fmac_f32 v239, v45, v173
    v_fmac_f32 v243, v38, v158
    v_fmac_f32 v239, v46, v174
    v_fmac_f32 v243, v39, v159
    v_fmac_f32 v239, v47, v175
    v_fmac_f32 v237, v48, v120
    v_mul_f32 v245, v56, v168
    v_fmac_f32 v237, v49, v121
    v_fmac_f32 v245, v57, v169
    v_fmac_f32 v237, v50, v122
    v_fmac_f32 v245, v58, v170
    v_fmac_f32 v237, v51, v123
    s_setprio 1
    s_waitcnt vmcnt(4) lgkmcnt(1)
    v_mfma_f32_32x32x16_bf16 v[0:15], v[64:67], v[176:179], 0
    ds_read_b64_tr_b16 v[184:185], v246 offset:2048
    ds_read_b64_tr_b16 v[186:187], v246 offset:2560
    ds_read_b64_tr_b16 v[188:189], v247 offset:2048
    ds_read_b64_tr_b16 v[190:191], v247 offset:2560
    v_fmac_f32 v245, v59, v171
    v_fmac_f32 v237, v52, v124
    s_mov_b32 m0, s68
    v_mfma_f32_32x32x16_bf16 v[16:31], v[68:71], v[176:179], 0
    buffer_load_dwordx4 v222, s[4:7], s44 offen lds
    buffer_load_dwordx4 v223, s[72:75], s44 offen offset:1024 lds
    s_waitcnt lgkmcnt(4)
    v_mad_u32_u16 v225, v224, s39, v248 op_sel:[1,0,0,0]
    v_mad_u32_u16 v224, v224, s39, v248
    v_fmac_f32 v245, v60, v172
    v_fmac_f32 v237, v53, v125
    v_mfma_f32_32x32x16_bf16 v[32:47], v[64:67], v[180:183], 0
    v_add_u32 v226, s50, v251
    ds_read_b32 v226, v226
    v_fmac_f32 v245, v61, v173
    v_fmac_f32 v237, v54, v126
    v_fmac_f32 v245, v62, v174
    v_fmac_f32 v237, v55, v127
    v_fmac_f32 v245, v63, v175
    v_mfma_f32_32x32x16_bf16 v[48:63], v[68:71], v[180:183], 0
    v_permlane32_swap_b32 v242, v234
    v_permlane32_swap_b32 v243, v235
    v_add_f32 v242, v242, v234
    v_add_f32 v243, v243, v235
    s_waitcnt vmcnt(4) lgkmcnt(1)
    v_mfma_f32_32x32x16_bf16 v[0:15], v[72:75], v[184:187], v[0:15]
    ds_read_b64_tr_b16 v[176:177], v246 offset:4096
    ds_read_b64_tr_b16 v[178:179], v246 offset:4608
    ds_read_b64_tr_b16 v[180:181], v247 offset:4096
    ds_read_b64_tr_b16 v[182:183], v247 offset:4608
    s_mov_b32 m0, s69
    v_mfma_f32_32x32x16_bf16 v[16:31], v[76:79], v[184:187], v[16:31]
    buffer_load_dwordx4 v224, s[4:7], s45 offen lds
    buffer_load_dwordx4 v225, s[72:75], s45 offen offset:1024 lds
    s_waitcnt lgkmcnt(4)
    v_mad_u32_u16 v227, v226, s39, v248 op_sel:[1,0,0,0]
    v_mad_u32_u16 v226, v226, s39, v248
    v_mfma_f32_32x32x16_bf16 v[32:47], v[72:75], v[188:191], v[32:47]
    v_add_u32 v228, s51, v251
    ds_read_b32 v228, v228
    s_set_gpr_idx_on s31, gpr_idx(DST)
    s_nop 0
    v_cvt_pk_bf16_f32 v194, v242, v243
    s_set_gpr_idx_off
    v_mfma_f32_32x32x16_bf16 v[48:63], v[76:79], v[188:191], v[48:63]
    s_waitcnt vmcnt(4) lgkmcnt(1)
    v_mfma_f32_32x32x16_bf16 v[0:15], v[80:83], v[176:179], v[0:15]
    ds_read_b64_tr_b16 v[184:185], v246 offset:6144
    ds_read_b64_tr_b16 v[186:187], v246 offset:6656
    ds_read_b64_tr_b16 v[188:189], v247 offset:6144
    ds_read_b64_tr_b16 v[190:191], v247 offset:6656
    s_mov_b32 m0, s70
    v_mfma_f32_32x32x16_bf16 v[16:31], v[84:87], v[176:179], v[16:31]
    buffer_load_dwordx4 v226, s[4:7], s46 offen lds
    buffer_load_dwordx4 v227, s[72:75], s46 offen offset:1024 lds
    s_waitcnt lgkmcnt(4)
    v_mad_u32_u16 v229, v228, s39, v248 op_sel:[1,0,0,0]
    v_mad_u32_u16 v228, v228, s39, v248
    v_mfma_f32_32x32x16_bf16 v[32:47], v[80:83], v[180:183], v[32:47]
    v_mfma_f32_32x32x16_bf16 v[48:63], v[84:87], v[180:183], v[48:63]
    s_waitcnt vmcnt(4) lgkmcnt(0)
    v_mfma_f32_32x32x16_bf16 v[0:15], v[88:91], v[184:187], v[0:15]
    ds_read_b64_tr_b16 v[176:177], v246 offset:0
    ds_read_b64_tr_b16 v[178:179], v246 offset:512
    ds_read_b64_tr_b16 v[180:181], v247 offset:0
    ds_read_b64_tr_b16 v[182:183], v247 offset:512
    s_mov_b32 m0, s71
    v_mfma_f32_32x32x16_bf16 v[16:31], v[92:95], v[184:187], v[16:31]
    buffer_load_dwordx4 v228, s[4:7], s47 offen lds
    buffer_load_dwordx4 v229, s[72:75], s47 offen offset:1024 lds
    v_mfma_f32_32x32x16_bf16 v[32:47], v[88:91], v[188:191], v[32:47]
    s_nop 2
    v_mul_f32 v242, v0, v144
    v_fma_f32 v240, v8, v160, -v240
    v_fmac_f32 v242, v1, v145
    v_fmac_f32 v240, v9, v161
    v_fmac_f32 v242, v2, v146
    v_fmac_f32 v240, v10, v162
    v_fmac_f32 v242, v3, v147
    v_mfma_f32_32x32x16_bf16 v[48:63], v[92:95], v[188:191], v[48:63]
    s_setprio 0
    v_fmac_f32 v240, v11, v163
    v_fmac_f32 v242, v4, v148
    v_fmac_f32 v240, v12, v164
    v_fmac_f32 v242, v5, v149
    v_fmac_f32 v240, v13, v165
    v_fmac_f32 v242, v6, v150
    v_fmac_f32 v240, v14, v166
    v_fmac_f32 v242, v7, v151
    v_fmac_f32 v240, v15, v167
    s_sub_u32 s58, s48, s29
    v_add_u32 v249, s58, v249
    v_add_u32 v250, s58, v250
    v_fma_f32 v244, v16, v160, -v244
    v_fmac_f32 v236, v24, v112
    v_fmac_f32 v244, v17, v161
    v_fmac_f32 v236, v25, v113
    v_fmac_f32 v244, v18, v162
    v_fmac_f32 v236, v26, v114
    v_fmac_f32 v244, v19, v163
    v_fmac_f32 v236, v27, v115
    v_fmac_f32 v244, v20, v164
    v_fmac_f32 v236, v28, v116
    v_fmac_f32 v244, v21, v165
    v_fmac_f32 v236, v29, v117
    v_fmac_f32 v244, v22, v166
    v_fmac_f32 v236, v30, v118
    v_fmac_f32 v244, v23, v167
    v_fmac_f32 v236, v31, v119
    ds_read_b64_tr_b16 v[0:1], v249 offset:0
    ds_read_b64_tr_b16 v[2:3], v249 offset:128
    ds_read_b128 v[4:7], v250 offset:0
    ds_read_b128 v[8:11], v250 offset:16
    ds_read_b128 v[12:15], v250 offset:384
    ds_read_b128 v[16:19], v250 offset:400
    v_mul_f32 v243, v32, v152
    v_fma_f32 v241, v40, v168, -v241
    v_fmac_f32 v243, v33, v153
    v_fmac_f32 v241, v41, v169
    v_fmac_f32 v243, v34, v154
    v_fmac_f32 v241, v42, v170
    v_fmac_f32 v243, v35, v155
    v_fmac_f32 v241, v43, v171
    v_fmac_f32 v243, v36, v156
    v_fmac_f32 v241, v44, v172
    v_fmac_f32 v243, v37, v157
    v_fmac_f32 v241, v45, v173
    v_fmac_f32 v243, v38, v158
    v_fmac_f32 v241, v46, v174
    v_fmac_f32 v243, v39, v159
    v_fmac_f32 v241, v47, v175
    ds_read_b64_tr_b16 v[20:21], v249 offset:512
    ds_read_b64_tr_b16 v[22:23], v249 offset:640
    ds_read_b128 v[24:27], v250 offset:64
    ds_read_b128 v[28:31], v250 offset:80
    ds_read_b128 v[32:35], v250 offset:448
    ds_read_b128 v[36:39], v250 offset:464
    v_fma_f32 v245, v48, v168, -v245
    v_fmac_f32 v237, v56, v120
    v_fmac_f32 v245, v49, v169
    v_fmac_f32 v237, v57, v121
    v_fmac_f32 v245, v50, v170
    v_fmac_f32 v237, v58, v122
    v_fmac_f32 v245, v51, v171
    v_fmac_f32 v237, v59, v123
    v_fmac_f32 v245, v52, v172
    v_fmac_f32 v237, v60, v124
    v_fmac_f32 v245, v53, v173
    v_fmac_f32 v237, v61, v125
    v_fmac_f32 v245, v54, v174
    v_fmac_f32 v237, v62, v126
    v_fmac_f32 v245, v55, v175
    v_fmac_f32 v237, v63, v127
    s_cmp_lg_u32 s34, 0
    s_cbranch_scc1 K2_SWITCH
    s_mov_b32 s29, s48
    s_mov_b32 s32, s31
    s_mov_b32 s30, s3
    s_mov_b32 s31, s35
    s_cmp_eq_u32 s33, 2
    s_cbranch_scc1 K2_U20
    s_cmp_eq_u32 s33, 3
    s_cbranch_scc1 K2_U30
    s_cmp_eq_u32 s33, 1
    s_cbranch_scc1 K2_U10
    s_branch K2_U40
K2_U11:
    s_setprio 1
    v_mov_b32 v254, 163648
    v_mov_b32 v255, 1
    v_lshl_add_u32 v233, v252, 1, s53
    s_mov_b64 exec, 1
    ds_add_rtn_u32 v232, v254, v255
    s_mov_b64 exec, -1
    ds_read_b32 v233, v233
    s_waitcnt lgkmcnt(12)
    v_lshlrev_b32 v40, 16, v0
    v_and_b32 v41, 0xffff0000, v0
    v_lshlrev_b32 v42, 16, v1
    v_and_b32 v43, 0xffff0000, v1
    v_lshlrev_b32 v44, 16, v2
    v_and_b32 v45, 0xffff0000, v2
    v_lshlrev_b32 v46, 16, v3
    v_and_b32 v47, 0xffff0000, v3
    s_waitcnt lgkmcnt(10)
    v_mul_f32 v4, v40, v4
    v_mul_f32 v5, v41, v5
    v_mul_f32 v6, v42, v6
    v_mul_f32 v7, v43, v7
    v_mul_f32 v8, v44, v8
    v_mul_f32 v9, v45, v9
    v_mul_f32 v10, v46, v10
    v_mul_f32 v11, v47, v11
    v_cvt_pk_bf16_f32 v64, v4, v5
    v_cvt_pk_bf16_f32 v65, v6, v7
    v_cvt_pk_bf16_f32 v66, v8, v9
    v_cvt_pk_bf16_f32 v67, v10, v11
    s_waitcnt lgkmcnt(8)
    v_mul_f32 v12, v40, v12
    v_mul_f32 v13, v41, v13
    v_mul_f32 v14, v42, v14
    v_mul_f32 v15, v43, v15
    v_mul_f32 v16, v44, v16
    v_mul_f32 v17, v45, v17
    v_mul_f32 v18, v46, v18
    v_mul_f32 v19, v47, v19
    v_cvt_pk_bf16_f32 v68, v12, v13
    v_cvt_pk_bf16_f32 v69, v14, v15
    v_cvt_pk_bf16_f32 v70, v16, v17
    v_cvt_pk_bf16_f32 v71, v18, v19
    s_waitcnt lgkmcnt(0)
    v_readfirstlane_b32 s58, v232
    s_nop 0
    s_cmp_lt_u32 s58, s22
    s_cbranch_scc0 K2_nul_94
    s_and_b32 s59, s58, 7
    s_lshr_b32 s60, s58, 3
K2_chk_96:
    v_readlane_b32 s61, v233, s59
    s_nop 0
    s_cmp_gt_u32 s61, s60
    s_cbranch_scc0 K2_spin_95
K2_back_97:
    v_readlane_b32 s3, v253, s58
    s_lshl_b32 s44, s34, 7
    s_lshl_b32 s60, s58, 5
    s_and_b32 s48, s3, 0x3ffff
    s_bfe_u32 s33, s3, 0x30012
    s_sub_u32 s60, s60, s48
    s_and_b32 s60, s60, 0xff
    s_add_u32 s35, s60, s48
    s_mov_b32 s45, s44
    s_add_u32 s47, s44, 256
    s_add_u32 s49, s48, 32
    s_add_u32 s60, s48, 64
    s_cmp_eq_u32 s33, 3
    s_cselect_b32 s46, s44, s47
    s_cselect_b32 s50, s60, s48
    s_cselect_b32 s51, s48, s49
    s_sub_u32 s60, s33, 2
    s_cmp_lt_u32 s60, 2
    s_cbranch_scc0 K2_rare_98
K2_back_99:
    v_add_u32 v222, s48, v251
    ds_read_b32 v222, v222
    v_add_u32 v224, s49, v251
    ds_read_b32 v224, v224
    v_add_u32 v226, s50, v251
    ds_read_b32 v226, v226
    v_add_u32 v228, s51, v251
    ds_read_b32 v228, v228
    s_waitcnt lgkmcnt(3)
    v_mad_u32_u16 v223, v222, s39, v248 op_sel:[1,0,0,0]
    v_mad_u32_u16 v222, v222, s39, v248
    s_waitcnt lgkmcnt(2)
    v_mad_u32_u16 v225, v224, s39, v248 op_sel:[1,0,0,0]
    v_mad_u32_u16 v224, v224, s39, v248
    s_waitcnt lgkmcnt(1)
    v_mad_u32_u16 v227, v226, s39, v248 op_sel:[1,0,0,0]
    v_mad_u32_u16 v226, v226, s39, v248
    s_waitcnt lgkmcnt(0)
    v_mad_u32_u16 v229, v228, s39, v248 op_sel:[1,0,0,0]
    v_mad_u32_u16 v228, v228, s39, v248
    s_waitcnt vmcnt(4)
    v_mfma_f32_32x32x16_bf16 v[0:15], v[64:67], v[176:179], 0
    ds_read_b64_tr_b16 v[184:185], v246 offset:2048
    ds_read_b64_tr_b16 v[186:187], v246 offset:2560
    ds_read_b64_tr_b16 v[188:189], v247 offset:2048
    ds_read_b64_tr_b16 v[190:191], v247 offset:2560
    s_mov_b32 m0, s68
    v_mfma_f32_32x32x16_bf16 v[16:31], v[68:71], v[176:179], 0
    buffer_load_dwordx4 v222, s[4:7], s44 offen lds
    buffer_load_dwordx4 v223, s[72:75], s44 offen offset:1024 lds
    v_permlane32_swap_b32 v242, v236
    v_permlane32_swap_b32 v243, v237
    v_mfma_f32_32x32x16_bf16 v[32:47], v[64:67], v[180:183], 0
    v_permlane32_swap_b32 v244, v238
    v_permlane32_swap_b32 v245, v239
    v_permlane32_swap_b32 v240, v241
    v_add_f32 v242, v242, v236
    v_mfma_f32_32x32x16_bf16 v[48:63], v[68:71], v[180:183], 0
    s_setprio 0
    v_add_f32 v243, v243, v237
    v_add_f32 v244, v244, v238
    v_add_f32 v245, v245, v239
    v_add_f32 v240, -v240, -v241
    v_sub_u32 v241, v230, v231
    v_cvt_pk_bf16_f32 v242, v242, v243
    v_cvt_pk_bf16_f32 v244, v244, v245
    v_cvt_pk_bf16_f32 v240, v240, v240
    ds_write_b32 v230, v242 offset:768
    ds_write_b32 v230, v244 offset:1024
    ds_write_b16 v241, v240 offset:1280
    v_mul_f32 v234, v0, v96
    v_mul_f32 v236, v8, v128
    v_fmac_f32 v234, v1, v97
    v_fmac_f32 v236, v9, v129
    v_fmac_f32 v234, v2, v98
    v_fmac_f32 v236, v10, v130
    v_fmac_f32 v234, v3, v99
    v_fmac_f32 v236, v11, v131
    v_fmac_f32 v234, v4, v100
    v_fmac_f32 v236, v12, v132
    v_fmac_f32 v234, v5, v101
    v_fmac_f32 v236, v13, v133
    v_fmac_f32 v234, v6, v102
    v_fmac_f32 v236, v14, v134
    v_fmac_f32 v234, v7, v103
    v_fmac_f32 v236, v15, v135
    v_mul_f32 v238, v16, v128
    v_mul_f32 v240, v24, v128
    v_fmac_f32 v238, v17, v129
    v_fmac_f32 v240, v25, v129
    v_fmac_f32 v238, v18, v130
    v_fmac_f32 v240, v26, v130
    v_fmac_f32 v238, v19, v131
    v_fmac_f32 v240, v27, v131
    v_fmac_f32 v238, v20, v132
    v_fmac_f32 v240, v28, v132
    v_fmac_f32 v238, v21, v133
    v_fmac_f32 v240, v29, v133
    v_fmac_f32 v238, v22, v134
    v_fmac_f32 v240, v30, v134
    v_fmac_f32 v238, v23, v135
    v_fmac_f32 v240, v31, v135
    v_mul_f32 v235, v32, v104
    v_mul_f32 v237, v40, v136
    v_fmac_f32 v235, v33, v105
    v_fmac_f32 v237, v41, v137
    v_fmac_f32 v235, v34, v106
    v_fmac_f32 v237, v42, v138
    v_fmac_f32 v235, v35, v107
    v_fmac_f32 v237, v43, v139
    v_fmac_f32 v235, v36, v108
    v_fmac_f32 v237, v44, v140
    v_fmac_f32 v235, v37, v109
    v_fmac_f32 v237, v45, v141
    v_fmac_f32 v235, v38, v110
    v_fmac_f32 v237, v46, v142
    v_fmac_f32 v235, v39, v111
    v_fmac_f32 v237, v47, v143
    v_mul_f32 v239, v48, v136
    v_mul_f32 v241, v56, v136
    v_fmac_f32 v239, v49, v137
    v_fmac_f32 v241, v57, v137
    v_fmac_f32 v239, v50, v138
    v_fmac_f32 v241, v58, v138
    v_fmac_f32 v239, v51, v139
    v_fmac_f32 v241, v59, v139
    v_fmac_f32 v239, v52, v140
    v_fmac_f32 v241, v60, v140
    v_fmac_f32 v239, v53, v141
    v_fmac_f32 v241, v61, v141
    v_fmac_f32 v239, v54, v142
    v_fmac_f32 v241, v62, v142
    v_fmac_f32 v239, v55, v143
    v_fmac_f32 v241, v63, v143
    s_setprio 1
    s_waitcnt vmcnt(4) lgkmcnt(3)
    v_mfma_f32_32x32x16_bf16 v[0:15], v[64:67], v[184:187], 0
    ds_read_b64_tr_b16 v[176:177], v246 offset:4096
    ds_read_b64_tr_b16 v[178:179], v246 offset:4608
    ds_read_b64_tr_b16 v[180:181], v247 offset:4096
    ds_read_b64_tr_b16 v[182:183], v247 offset:4608
    s_mov_b32 m0, s69
    v_mfma_f32_32x32x16_bf16 v[16:31], v[68:71], v[184:187], 0
    buffer_load_dwordx4 v224, s[4:7], s45 offen lds
    buffer_load_dwordx4 v225, s[72:75], s45 offen offset:1024 lds
    v_permlane32_swap_b32 v234, v236
    v_permlane32_swap_b32 v235, v237
    v_mfma_f32_32x32x16_bf16 v[32:47], v[64:67], v[188:191], 0
    v_permlane32_swap_b32 v240, v238
    v_permlane32_swap_b32 v241, v239
    v_lshl_add_u32 v230, v252, 1, s31
    v_add_f32 v234, v234, v236
    v_add_f32 v235, v235, v237
    v_mfma_f32_32x32x16_bf16 v[48:63], v[68:71], v[188:191], 0
    s_setprio 0
    v_add_f32 v240, v240, v238
    v_add_f32 v241, v241, v239
    v_cvt_pk_bf16_f32 v234, v234, v235
    v_cvt_pk_bf16_f32 v240, v240, v241
    ds_write_b32 v230, v234 offset:0
    ds_write_b32 v230, v240 offset:256
    v_mul_f32 v234, v0, v144
    v_mul_f32 v236, v8, v112
    v_fmac_f32 v234, v1, v145
    v_fmac_f32 v236, v9, v113
    v_fmac_f32 v234, v2, v146
    v_fmac_f32 v236, v10, v114
    v_fmac_f32 v234, v3, v147
    v_fmac_f32 v236, v11, v115
    v_fmac_f32 v234, v4, v148
    v_fmac_f32 v236, v12, v116
    v_fmac_f32 v234, v5, v149
    v_fmac_f32 v236, v13, v117
    v_fmac_f32 v234, v6, v150
    v_fmac_f32 v236, v14, v118
    v_fmac_f32 v234, v7, v151
    v_fmac_f32 v236, v15, v119
    v_mul_f32 v238, v16, v160
    v_mul_f32 v240, v24, v160
    v_fmac_f32 v238, v17, v161
    v_fmac_f32 v240, v25, v161
    v_fmac_f32 v238, v18, v162
    v_fmac_f32 v240, v26, v162
    v_fmac_f32 v238, v19, v163
    v_fmac_f32 v240, v27, v163
    v_fmac_f32 v238, v20, v164
    v_fmac_f32 v240, v28, v164
    v_fmac_f32 v238, v21, v165
    v_fmac_f32 v240, v29, v165
    v_fmac_f32 v238, v22, v166
    v_fmac_f32 v240, v30, v166
    v_fmac_f32 v238, v23, v167
    v_fmac_f32 v240, v31, v167
    v_mul_f32 v235, v32, v152
    v_mul_f32 v237, v40, v120
    v_fmac_f32 v235, v33, v153
    v_fmac_f32 v237, v41, v121
    v_fmac_f32 v235, v34, v154
    v_fmac_f32 v237, v42, v122
    v_fmac_f32 v235, v35, v155
    v_fmac_f32 v237, v43, v123
    v_fmac_f32 v235, v36, v156
    v_fmac_f32 v237, v44, v124
    v_fmac_f32 v235, v37, v157
    v_fmac_f32 v237, v45, v125
    v_fmac_f32 v235, v38, v158
    v_fmac_f32 v237, v46, v126
    v_fmac_f32 v235, v39, v159
    v_fmac_f32 v237, v47, v127
    v_mul_f32 v239, v48, v168
    v_mul_f32 v241, v56, v168
    v_fmac_f32 v239, v49, v169
    v_fmac_f32 v241, v57, v169
    v_fmac_f32 v239, v50, v170
    v_fmac_f32 v241, v58, v170
    v_fmac_f32 v239, v51, v171
    v_fmac_f32 v241, v59, v171
    v_fmac_f32 v239, v52, v172
    v_fmac_f32 v241, v60, v172
    v_fmac_f32 v239, v53, v173
    v_fmac_f32 v241, v61, v173
    v_fmac_f32 v239, v54, v174
    v_fmac_f32 v241, v62, v174
    v_fmac_f32 v239, v55, v175
    v_fmac_f32 v241, v63, v175
    s_setprio 1
    s_waitcnt vmcnt(4) lgkmcnt(2)
    v_mfma_f32_32x32x16_bf16 v[0:15], v[64:67], v[176:179], 0
    ds_read_b64_tr_b16 v[184:185], v246 offset:6144
    ds_read_b64_tr_b16 v[186:187], v246 offset:6656
    ds_read_b64_tr_b16 v[188:189], v247 offset:6144
    ds_read_b64_tr_b16 v[190:191], v247 offset:6656
    s_mov_b32 m0, s70
    v_mfma_f32_32x32x16_bf16 v[16:31], v[68:71], v[176:179], 0
    buffer_load_dwordx4 v226, s[4:7], s46 offen lds
    buffer_load_dwordx4 v227, s[72:75], s46 offen offset:1024 lds
    v_mfma_f32_32x32x16_bf16 v[32:47], v[64:67], v[180:183], 0
    v_mfma_f32_32x32x16_bf16 v[48:63], v[68:71], v[180:183], 0
    s_setprio 0
    s_nop 0
    v_mul_f32 v242, v0, v144
    v_fma_f32 v238, v8, v160, -v238
    v_fmac_f32 v242, v1, v145
    v_fmac_f32 v238, v9, v161
    v_fmac_f32 v242, v2, v146
    v_fmac_f32 v238, v10, v162
    v_fmac_f32 v242, v3, v147
    v_fmac_f32 v238, v11, v163
    v_fmac_f32 v242, v4, v148
    v_fmac_f32 v238, v12, v164
    v_fmac_f32 v242, v5, v149
    v_fmac_f32 v238, v13, v165
    v_fmac_f32 v242, v6, v150
    v_fmac_f32 v238, v14, v166
    v_fmac_f32 v242, v7, v151
    v_fmac_f32 v238, v15, v167
    v_fmac_f32 v236, v16, v112
    v_mul_f32 v244, v24, v160
    v_fmac_f32 v236, v17, v113
    v_fmac_f32 v244, v25, v161
    v_fmac_f32 v236, v18, v114
    v_fmac_f32 v244, v26, v162
    v_fmac_f32 v236, v19, v115
    v_fmac_f32 v244, v27, v163
    v_fmac_f32 v236, v20, v116
    v_fmac_f32 v244, v28, v164
    v_fmac_f32 v236, v21, v117
    v_fmac_f32 v244, v29, v165
    v_fmac_f32 v236, v22, v118
    v_fmac_f32 v244, v30, v166
    v_fmac_f32 v236, v23, v119
    v_fmac_f32 v244, v31, v167
    v_mul_f32 v243, v32, v152
    v_fma_f32 v239, v40, v168, -v239
    v_fmac_f32 v243, v33, v153
    v_fmac_f32 v239, v41, v169
    v_fmac_f32 v243, v34, v154
    v_fmac_f32 v239, v42, v170
    v_fmac_f32 v243, v35, v155
    v_fmac_f32 v239, v43, v171
    v_fmac_f32 v243, v36, v156
    v_fmac_f32 v239, v44, v172
    v_fmac_f32 v243, v37, v157
    v_fmac_f32 v239, v45, v173
    v_fmac_f32 v243, v38, v158
    v_fmac_f32 v239, v46, v174
    v_fmac_f32 v243, v39, v159
    v_fmac_f32 v239, v47, v175
    v_fmac_f32 v237, v48, v120
    v_mul_f32 v245, v56, v168
    v_fmac_f32 v237, v49, v121
    v_fmac_f32 v245, v57, v169
    v_fmac_f32 v237, v50, v122
    v_fmac_f32 v245, v58, v170
    v_fmac_f32 v237, v51, v123
    v_fmac_f32 v245, v59, v171
    v_fmac_f32 v237, v52, v124
    v_fmac_f32 v245, v60, v172
    v_fmac_f32 v237, v53, v125
    v_fmac_f32 v245, v61, v173
    v_fmac_f32 v237, v54, v126
    v_fmac_f32 v245, v62, v174
    v_fmac_f32 v237, v55, v127
    v_fmac_f32 v245, v63, v175
    s_setprio 1
    s_waitcnt vmcnt(4) lgkmcnt(0)
    v_mfma_f32_32x32x16_bf16 v[0:15], v[64:67], v[184:187], 0
    ds_read_b64_tr_b16 v[176:177], v246 offset:0
    ds_read_b64_tr_b16 v[178:179], v246 offset:512
    ds_read_b64_tr_b16 v[180:181], v247 offset:0
    ds_read_b64_tr_b16 v[182:183], v247 offset:512
    s_mov_b32 m0, s71
    v_mfma_f32_32x32x16_bf16 v[16:31], v[68:71], v[184:187], 0
    buffer_load_dwordx4 v228, s[4:7], s47 offen lds
    buffer_load_dwordx4 v229, s[72:75], s47 offen offset:1024 lds
    v_permlane32_swap_b32 v242, v234
    v_permlane32_swap_b32 v243, v235
    v_add_f32 v242, v242, v234
    v_mfma_f32_32x32x16_bf16 v[32:47], v[64:67], v[188:191], 0
    v_add_f32 v243, v243, v235
    v_cvt_pk_bf16_f32 v242, v242, v243
    ds_write_b32 v230, v242 offset:512
    v_mfma_f32_32x32x16_bf16 v[48:63], v[68:71], v[188:191], 0
    s_setprio 0
    v_mul_f32 v242, v0, v144
    v_fma_f32 v240, v8, v160, -v240
    v_fmac_f32 v242, v1, v145
    v_fmac_f32 v240, v9, v161
    v_fmac_f32 v242, v2, v146
    v_fmac_f32 v240, v10, v162
    v_fmac_f32 v242, v3, v147
    v_fmac_f32 v240, v11, v163
    v_fmac_f32 v242, v4, v148
    v_fmac_f32 v240, v12, v164
    v_fmac_f32 v242, v5, v149
    v_fmac_f32 v240, v13, v165
    v_fmac_f32 v242, v6, v150
    v_fmac_f32 v240, v14, v166
    v_fmac_f32 v242, v7, v151
    v_fmac_f32 v240, v15, v167
    s_sub_u32 s58, s48, s29
    v_add_u32 v249, s58, v249
    v_add_u32 v250, s58, v250
    v_fma_f32 v244, v16, v160, -v244
    v_fmac_f32 v236, v24, v112
    v_fmac_f32 v244, v17, v161
    v_fmac_f32 v236, v25, v113
    v_fmac_f32 v244, v18, v162
    v_fmac_f32 v236, v26, v114
    v_fmac_f32 v244, v19, v163
    v_fmac_f32 v236, v27, v115
    v_fmac_f32 v244, v20, v164
    v_fmac_f32 v236, v28, v116
    v_fmac_f32 v244, v21, v165
    v_fmac_f32 v236, v29, v117
    v_fmac_f32 v244, v22, v166
    v_fmac_f32 v236, v30, v118
    v_fmac_f32 v244, v23, v167
    v_fmac_f32 v236, v31, v119
    ds_read_b64_tr_b16 v[0:1], v249 offset:0
    ds_read_b64_tr_b16 v[2:3], v249 offset:128
    ds_read_b128 v[4:7], v250 offset:0
    ds_read_b128 v[8:11], v250 offset:16
    ds_read_b128 v[12:15], v250 offset:384
    ds_read_b128 v[16:19], v250 offset:400
    v_mul_f32 v243, v32, v152
    v_fma_f32 v241, v40, v168, -v241
    v_fmac_f32 v243, v33, v153
    v_fmac_f32 v241, v41, v169
    v_fmac_f32 v243, v34, v154
    v_fmac_f32 v241, v42, v170
    v_fmac_f32 v243, v35, v155
    v_fmac_f32 v241, v43, v171
    v_fmac_f32 v243, v36, v156
    v_fmac_f32 v241, v44, v172
    v_fmac_f32 v243, v37, v157
    v_fmac_f32 v241, v45, v173
    v_fmac_f32 v243, v38, v158
    v_fmac_f32 v241, v46, v174
    v_fmac_f32 v243, v39, v159
    v_fmac_f32 v241, v47, v175
    ds_read_b64_tr_b16 v[20:21], v249 offset:512
    ds_read_b64_tr_b16 v[22:23], v249 offset:640
    ds_read_b128 v[24:27], v250 offset:64
    ds_read_b128 v[28:31], v250 offset:80
    ds_read_b128 v[32:35], v250 offset:448
    ds_read_b128 v[36:39], v250 offset:464
    v_fma_f32 v245, v48, v168, -v245
    v_fmac_f32 v237, v56, v120
    v_fmac_f32 v245, v49, v169
    v_fmac_f32 v237, v57, v121
    v_fmac_f32 v245, v50, v170
    v_fmac_f32 v237, v58, v122
    v_fmac_f32 v245, v51, v171
    v_fmac_f32 v237, v59, v123
    v_fmac_f32 v245, v52, v172
    v_fmac_f32 v237, v60, v124
    v_fmac_f32 v245, v53, v173
    v_fmac_f32 v237, v61, v125
    v_fmac_f32 v245, v54, v174
    v_fmac_f32 v237, v62, v126
    v_fmac_f32 v245, v55, v175
    v_fmac_f32 v237, v63, v127
    s_cmp_eq_u32 s36, 0
    s_cbranch_scc1 K2_TAIL
    s_mov_b32 s29, s48
    s_mov_b32 s32, s31
    s_mov_b32 s30, s3
    s_mov_b32 s31, s35
    s_cmp_eq_u32 s33, 2
    s_cbranch_scc1 K2_U21
    s_cmp_eq_u32 s33, 3
    s_cbranch_scc1 K2_U31
    s_cmp_eq_u32 s33, 1
    s_cbranch_scc1 K2_U11
    s_branch K2_U41
K2_U41:
    s_setprio 1
    s_waitcnt lgkmcnt(10)
    v_lshlrev_b32 v40, 16, v0
    v_and_b32 v41, 0xffff0000, v0
    v_lshlrev_b32 v42, 16, v1
    v_and_b32 v43, 0xffff0000, v1
    v_lshlrev_b32 v44, 16, v2
    v_and_b32 v45, 0xffff0000, v2
    v_lshlrev_b32 v46, 16, v3
    v_and_b32 v47, 0xffff0000, v3
    s_waitcnt lgkmcnt(8)
    v_mul_f32 v4, v40, v4
    v_mul_f32 v5, v41, v5
    v_mul_f32 v6, v42, v6
    v_mul_f32 v7, v43, v7
    v_mul_f32 v8, v44, v8
    v_mul_f32 v9, v45, v9
    v_mul_f32 v10, v46, v10
    v_mul_f32 v11, v47, v11
    v_cvt_pk_bf16_f32 v64, v4, v5
    v_cvt_pk_bf16_f32 v65, v6, v7
    v_cvt_pk_bf16_f32 v66, v8, v9
    v_cvt_pk_bf16_f32 v67, v10, v11
    s_waitcnt lgkmcnt(6)
    v_mul_f32 v12, v40, v12
    v_mul_f32 v13, v41, v13
    v_mul_f32 v14, v42, v14
    v_mul_f32 v15, v43, v15
    v_mul_f32 v16, v44, v16
    v_mul_f32 v17, v45, v17
    v_mul_f32 v18, v46, v18
    v_mul_f32 v19, v47, v19
    v_cvt_pk_bf16_f32 v68, v12, v13
    v_cvt_pk_bf16_f32 v69, v14, v15
    v_cvt_pk_bf16_f32 v70, v16, v17
    v_cvt_pk_bf16_f32 v71, v18, v19
    ds_read_b64_tr_b16 v[0:1], v249 offset:1024
    ds_read_b64_tr_b16 v[2:3], v249 offset:1152
    ds_read_b128 v[4:7], v250 offset:128
    ds_read_b128 v[8:11], v250 offset:144
    ds_read_b128 v[12:15], v250 offset:512
    ds_read_b128 v[16:19], v250 offset:528
    s_waitcnt lgkmcnt(10)
    v_lshlrev_b32 v48, 16, v20
    v_and_b32 v49, 0xffff0000, v20
    v_lshlrev_b32 v50, 16, v21
    v_and_b32 v51, 0xffff0000, v21
    v_lshlrev_b32 v52, 16, v22
    v_and_b32 v53, 0xffff0000, v22
    v_lshlrev_b32 v54, 16, v23
    v_and_b32 v55, 0xffff0000, v23
    s_waitcnt lgkmcnt(8)
    v_mul_f32 v24, v48, v24
    v_mul_f32 v25, v49, v25
    v_mul_f32 v26, v50, v26
    v_mul_f32 v27, v51, v27
    v_mul_f32 v28, v52, v28
    v_mul_f32 v29, v53, v29
    v_mul_f32 v30, v54, v30
    v_mul_f32 v31, v55, v31
    v_cvt_pk_bf16_f32 v72, v24, v25
    v_cvt_pk_bf16_f32 v73, v26, v27
    v_cvt_pk_bf16_f32 v74, v28, v29
    v_cvt_pk_bf16_f32 v75, v30, v31
    s_waitcnt lgkmcnt(6)
    v_mul_f32 v32, v48, v32
    v_mul_f32 v33, v49, v33
    v_mul_f32 v34, v50, v34
    v_mul_f32 v35, v51, v35
    v_mul_f32 v36, v52, v36
    v_mul_f32 v37, v53, v37
    v_mul_f32 v38, v54, v38
    v_mul_f32 v39, v55, v39
    v_cvt_pk_bf16_f32 v76, v32, v33
    v_cvt_pk_bf16_f32 v77, v34, v35
    v_cvt_pk_bf16_f32 v78, v36, v37
    v_cvt_pk_bf16_f32 v79, v38, v39
    s_lshr_b32 s65, s30, 27
    s_mov_b32 s66, 161536
    s_cmp_ge_u32 s65, 2
    s_cselect_b32 s66, 158112, s66
    s_mul_i32 s65, s65, 512
    s_add_u32 s65, s65, s66
    s_sub_u32 s65, s65, s29
    v_add_u32 v56, s65, v249
    s_lshr_b32 s65, s30, 27
    s_mov_b32 s66, 161536
    s_cmp_ge_u32 s65, 2
    s_cselect_b32 s66, 159008, s66
    s_mul_i32 s65, s65, 64
    s_add_u32 s65, s65, s66
    s_sub_u32 s65, s65, s29
    v_add_u32 v57, s65, v250
    ds_read_b64_tr_b16 v[20:21], v56 offset:0
    ds_read_b64_tr_b16 v[22:23], v56 offset:128
    ds_read_b128 v[24:27], v57 offset:0
    ds_read_b128 v[28:31], v57 offset:16
    ds_read_b128 v[32:35], v57 offset:384
    ds_read_b128 v[36:39], v57 offset:400
    s_waitcnt lgkmcnt(10)
    v_lshlrev_b32 v40, 16, v0
    v_and_b32 v41, 0xffff0000, v0
    v_lshlrev_b32 v42, 16, v1
    v_and_b32 v43, 0xffff0000, v1
    v_lshlrev_b32 v44, 16, v2
    v_and_b32 v45, 0xffff0000, v2
    v_lshlrev_b32 v46, 16, v3
    v_and_b32 v47, 0xffff0000, v3
    s_waitcnt lgkmcnt(8)
    v_mul_f32 v4, v40, v4
    v_mul_f32 v5, v41, v5
    v_mul_f32 v6, v42, v6
    v_mul_f32 v7, v43, v7
    v_mul_f32 v8, v44, v8
    v_mul_f32 v9, v45, v9
    v_mul_f32 v10, v46, v10
    v_mul_f32 v11, v47, v11
    v_cvt_pk_bf16_f32 v80, v4, v5
    v_cvt_pk_bf16_f32 v81, v6, v7
    v_cvt_pk_bf16_f32 v82, v8, v9
    v_cvt_pk_bf16_f32 v83, v10, v11
    s_waitcnt lgkmcnt(6)
    v_mul_f32 v12, v40, v12
    v_mul_f32 v13, v41, v13
    v_mul_f32 v14, v42, v14
    v_mul_f32 v15, v43, v15
    v_mul_f32 v16, v44, v16
    v_mul_f32 v17, v45, v17
    v_mul_f32 v18, v46, v18
    v_mul_f32 v19, v47, v19
    v_cvt_pk_bf16_f32 v84, v12, v13
    v_cvt_pk_bf16_f32 v85, v14, v15
    v_cvt_pk_bf16_f32 v86, v16, v17
    v_cvt_pk_bf16_f32 v87, v18, v19
    s_waitcnt lgkmcnt(4)
    v_lshlrev_b32 v48, 16, v20
    v_and_b32 v49, 0xffff0000, v20
    v_lshlrev_b32 v50, 16, v21
    v_and_b32 v51, 0xffff0000, v21
    v_lshlrev_b32 v52, 16, v22
    v_and_b32 v53, 0xffff0000, v22
    v_lshlrev_b32 v54, 16, v23
    v_and_b32 v55, 0xffff0000, v23
    s_waitcnt lgkmcnt(2)
    v_mul_f32 v24, v48, v24
    v_mul_f32 v25, v49, v25
    v_mul_f32 v26, v50, v26
    v_mul_f32 v27, v51, v27
    v_mul_f32 v28, v52, v28
    v_mul_f32 v29, v53, v29
    v_mul_f32 v30, v54, v30
    v_mul_f32 v31, v55, v31
    v_cvt_pk_bf16_f32 v88, v24, v25
    v_cvt_pk_bf16_f32 v89, v26, v27
    v_cvt_pk_bf16_f32 v90, v28, v29
    v_cvt_pk_bf16_f32 v91, v30, v31
    s_waitcnt lgkmcnt(0)
    v_mul_f32 v32, v48, v32
    v_mul_f32 v33, v49, v33
    v_mul_f32 v34, v50, v34
    v_mul_f32 v35, v51, v35
    v_mul_f32 v36, v52, v36
    v_mul_f32 v37, v53, v37
    v_mul_f32 v38, v54, v38
    v_mul_f32 v39, v55, v39
    v_cvt_pk_bf16_f32 v92, v32, v33
    v_cvt_pk_bf16_f32 v93, v34, v35
    v_cvt_pk_bf16_f32 v94, v36, v37
    v_cvt_pk_bf16_f32 v95, v38, v39
    s_waitcnt vmcnt(4)
    v_mfma_f32_32x32x16_bf16 v[0:15], v[64:67], v[176:179], 0
    ds_read_b64_tr_b16 v[184:185], v246 offset:2048
    ds_read_b64_tr_b16 v[186:187], v246 offset:2560
    ds_read_b64_tr_b16 v[188:189], v247 offset:2048
    ds_read_b64_tr_b16 v[190:191], v247 offset:2560
    s_mov_b32 m0, s68
    v_mfma_f32_32x32x16_bf16 v[16:31], v[68:71], v[176:179], 0
    buffer_load_dwordx4 v222, s[4:7], s41 offen lds
    buffer_load_dwordx4 v223, s[72:75], s41 offen offset:1024 lds
    v_permlane32_swap_b32 v242, v236
    v_permlane32_swap_b32 v243, v237
    v_mov_b32 v254, 163648
    v_mfma_f32_32x32x16_bf16 v[32:47], v[64:67], v[180:183], 0
    v_permlane32_swap_b32 v244, v238
    v_permlane32_swap_b32 v245, v239
    v_permlane32_swap_b32 v240, v241
    v_add_f32 v242, v242, v236
    v_mfma_f32_32x32x16_bf16 v[48:63], v[68:71], v[180:183], 0
    v_add_f32 v243, v243, v237
    v_add_f32 v244, v244, v238
    v_add_f32 v245, v245, v239
    v_add_f32 v240, -v240, -v241
    v_sub_u32 v241, v230, v231
    v_cvt_pk_bf16_f32 v242, v242, v243
    v_mov_b32 v255, 1
    v_lshl_add_u32 v233, v252, 1, s53
    s_mov_b64 exec, 1
    ds_add_rtn_u32 v232, v254, v255
    s_mov_b64 exec, -1
    ds_read_b32 v233, v233
    s_waitcnt vmcnt(4) lgkmcnt(2)
    v_mfma_f32_32x32x16_bf16 v[0:15], v[72:75], v[184:187], v[0:15]
    ds_read_b64_tr_b16 v[176:177], v246 offset:4096
    ds_read_b64_tr_b16 v[178:179], v246 offset:4608
    ds_read_b64_tr_b16 v[180:181], v247 offset:4096
    ds_read_b64_tr_b16 v[182:183], v247 offset:4608
    v_cvt_pk_bf16_f32 v244, v244, v245
    v_cvt_pk_bf16_f32 v240, v240, v240
    s_mov_b32 m0, s69
    v_mfma_f32_32x32x16_bf16 v[16:31], v[76:79], v[184:187], v[16:31]
    buffer_load_dwordx4 v224, s[4:7], s41 offen lds
    buffer_load_dwordx4 v225, s[72:75], s41 offen offset:1024 lds
    ds_write_b32 v230, v242 offset:768
    ds_write_b32 v230, v244 offset:1024
    ds_write_b16 v241, v240 offset:1280
    s_waitcnt lgkmcnt(7)
    v_readfirstlane_b32 s58, v232
    v_mfma_f32_32x32x16_bf16 v[32:47], v[72:75], v[188:191], v[32:47]
    s_cmp_lt_u32 s58, s22
    s_cbranch_scc0 K2_nul_101
    s_and_b32 s59, s58, 7
    s_lshr_b32 s60, s58, 3
K2_chk_103:
    v_readlane_b32 s61, v233, s59
    s_nop 0
    s_cmp_gt_u32 s61, s60
    s_cbranch_scc0 K2_spin_102
K2_back_104:
    v_mfma_f32_32x32x16_bf16 v[48:63], v[76:79], v[188:191], v[48:63]
    v_readlane_b32 s3, v253, s58
    s_lshl_b32 s44, s34, 7
    s_lshl_b32 s60, s58, 5
    s_and_b32 s48, s3, 0x3ffff
    s_bfe_u32 s33, s3, 0x30012
    s_sub_u32 s60, s60, s48
    s_waitcnt vmcnt(4) lgkmcnt(3)
    v_mfma_f32_32x32x16_bf16 v[0:15], v[80:83], v[176:179], v[0:15]
    ds_read_b64_tr_b16 v[184:185], v246 offset:6144
    ds_read_b64_tr_b16 v[186:187], v246 offset:6656
    ds_read_b64_tr_b16 v[188:189], v247 offset:6144
    ds_read_b64_tr_b16 v[190:191], v247 offset:6656
    s_and_b32 s60, s60, 0xff
    s_add_u32 s35, s60, s48
    s_mov_b32 m0, s70
    v_mfma_f32_32x32x16_bf16 v[16:31], v[84:87], v[176:179], v[16:31]
    buffer_load_dwordx4 v226, s[4:7], s41 offen lds
    buffer_load_dwordx4 v227, s[72:75], s41 offen offset:1024 lds
    s_mov_b32 s45, s44
    s_add_u32 s47, s44, 256
    s_add_u32 s49, s48, 32
    s_add_u32 s60, s48, 64
    v_mfma_f32_32x32x16_bf16 v[32:47], v[80:83], v[180:183], v[32:47]
    s_cmp_eq_u32 s33, 3
    s_cselect_b32 s46, s44, s47
    s_cselect_b32 s50, s60, s48
    s_cselect_b32 s51, s48, s49
    s_sub_u32 s60, s33, 2
    s_cmp_lt_u32 s60, 2
    s_cbranch_scc0 K2_rare_105
K2_back_106:
    v_mfma_f32_32x32x16_bf16 v[48:63], v[84:87], v[180:183], v[48:63]
    s_waitcnt vmcnt(4) lgkmcnt(0)
    v_mfma_f32_32x32x16_bf16 v[0:15], v[88:91], v[184:187], v[0:15]
    ds_read_b64_tr_b16 v[176:177], v246 offset:0
    ds_read_b64_tr_b16 v[178:179], v246 offset:512
    ds_read_b64_tr_b16 v[180:181], v247 offset:0
    ds_read_b64_tr_b16 v[182:183], v247 offset:512
    s_mov_b32 m0, s71
    v_mfma_f32_32x32x16_bf16 v[16:31], v[92:95], v[184:187], v[16:31]
    buffer_load_dwordx4 v228, s[4:7], s41 offen lds
    buffer_load_dwordx4 v229, s[72:75], s41 offen offset:1024 lds
    v_mfma_f32_32x32x16_bf16 v[32:47], v[88:91], v[188:191], v[32:47]
    s_nop 2
    v_mul_f32 v234, v0, v96
    v_mul_f32 v236, v8, v128
    v_fmac_f32 v234, v1, v97
    v_fmac_f32 v236, v9, v129
    v_fmac_f32 v234, v2, v98
    v_fmac_f32 v236, v10, v130
    v_fmac_f32 v234, v3, v99
    v_mfma_f32_32x32x16_bf16 v[48:63], v[92:95], v[188:191], v[48:63]
    s_setprio 0
    v_fmac_f32 v236, v11, v131
    v_fmac_f32 v234, v4, v100
    v_fmac_f32 v236, v12, v132
    v_fmac_f32 v234, v5, v101
    v_fmac_f32 v236, v13, v133
    v_fmac_f32 v234, v6, v102
    v_fmac_f32 v236, v14, v134
    v_fmac_f32 v234, v7, v103
    v_fmac_f32 v236, v15, v135
    v_mul_f32 v238, v16, v128
    v_mul_f32 v240, v24, v128
    v_fmac_f32 v238, v17, v129
    v_fmac_f32 v240, v25, v129
    v_fmac_f32 v238, v18, v130
    v_fmac_f32 v240, v26, v130
    v_fmac_f32 v238, v19, v131
    v_fmac_f32 v240, v27, v131
    v_fmac_f32 v238, v20, v132
    v_fmac_f32 v240, v28, v132
    v_fmac_f32 v238, v21, v133
    v_fmac_f32 v240, v29, v133
    v_fmac_f32 v238, v22, v134
    v_fmac_f32 v240, v30, v134
    v_fmac_f32 v238, v23, v135
    v_fmac_f32 v240, v31, v135
    v_mul_f32 v235, v32, v104
    v_mul_f32 v237, v40, v136
    v_fmac_f32 v235, v33, v105
    v_fmac_f32 v237, v41, v137
    v_fmac_f32 v235, v34, v106
    v_fmac_f32 v237, v42, v138
    v_fmac_f32 v235, v35, v107
    v_fmac_f32 v237, v43, v139
    v_fmac_f32 v235, v36, v108
    v_fmac_f32 v237, v44, v140
    v_fmac_f32 v235, v37, v109
    v_fmac_f32 v237, v45, v141
    v_fmac_f32 v235, v38, v110
    v_fmac_f32 v237, v46, v142
    v_fmac_f32 v235, v39, v111
    v_fmac_f32 v237, v47, v143
    v_mul_f32 v239, v48, v136
    v_mul_f32 v241, v56, v136
    s_setprio 1
    s_waitcnt vmcnt(4) lgkmcnt(0)
    v_mfma_f32_32x32x16_bf16 v[0:15], v[64:67], v[176:179], 0
    ds_read_b64_tr_b16 v[184:185], v246 offset:2048
    ds_read_b64_tr_b16 v[186:187], v246 offset:2560
    ds_read_b64_tr_b16 v[188:189], v247 offset:2048
    ds_read_b64_tr_b16 v[190:191], v247 offset:2560
    v_fmac_f32 v239, v49, v137
    v_fmac_f32 v241, v57, v137
    s_mov_b32 m0, s68
    v_mfma_f32_32x32x16_bf16 v[16:31], v[68:71], v[176:179], 0
    buffer_load_dwordx4 v222, s[4:7], s42 offen lds
    buffer_load_dwordx4 v223, s[72:75], s42 offen offset:1024 lds
    v_fmac_f32 v239, v50, v138
    v_fmac_f32 v241, v58, v138
    v_fmac_f32 v239, v51, v139
    v_fmac_f32 v241, v59, v139
    v_fmac_f32 v239, v52, v140
    v_mfma_f32_32x32x16_bf16 v[32:47], v[64:67], v[180:183], 0
    v_fmac_f32 v241, v60, v140
    v_fmac_f32 v239, v53, v141
    v_fmac_f32 v241, v61, v141
    v_fmac_f32 v239, v54, v142
    v_fmac_f32 v241, v62, v142
    v_fmac_f32 v239, v55, v143
    v_fmac_f32 v241, v63, v143
    v_mfma_f32_32x32x16_bf16 v[48:63], v[68:71], v[180:183], 0
    v_permlane32_swap_b32 v234, v236
    v_permlane32_swap_b32 v235, v237
    v_permlane32_swap_b32 v240, v238
    s_waitcnt vmcnt(4) lgkmcnt(0)
    v_mfma_f32_32x32x16_bf16 v[0:15], v[72:75], v[184:187], v[0:15]
    ds_read_b64_tr_b16 v[176:177], v246 offset:4096
    ds_read_b64_tr_b16 v[178:179], v246 offset:4608
    ds_read_b64_tr_b16 v[180:181], v247 offset:4096
    ds_read_b64_tr_b16 v[182:183], v247 offset:4608
    v_permlane32_swap_b32 v241, v239
    s_mov_b32 m0, s69
    v_mfma_f32_32x32x16_bf16 v[16:31], v[76:79], v[184:187], v[16:31]
    buffer_load_dwordx4 v224, s[4:7], s42 offen lds
    buffer_load_dwordx4 v225, s[72:75], s42 offen offset:1024 lds
    v_lshl_add_u32 v230, v252, 1, s31
    v_add_f32 v234, v234, v236
    v_add_f32 v235, v235, v237
    v_add_f32 v240, v240, v238
    v_add_f32 v241, v241, v239
    v_mfma_f32_32x32x16_bf16 v[32:47], v[72:75], v[188:191], v[32:47]
    v_cvt_pk_bf16_f32 v234, v234, v235
    v_cvt_pk_bf16_f32 v240, v240, v241
    ds_write_b32 v230, v234 offset:0
    ds_write_b32 v230, v240 offset:256
    v_mfma_f32_32x32x16_bf16 v[48:63], v[76:79], v[188:191], v[48:63]
    s_waitcnt vmcnt(4) lgkmcnt(2)
    v_mfma_f32_32x32x16_bf16 v[0:15], v[80:83], v[176:179], v[0:15]
    ds_read_b64_tr_b16 v[184:185], v246 offset:6144
    ds_read_b64_tr_b16 v[186:187], v246 offset:6656
    ds_read_b64_tr_b16 v[188:189], v247 offset:6144
    ds_read_b64_tr_b16 v[190:191], v247 offset:6656
    s_mov_b32 m0, s70
    v_mfma_f32_32x32x16_bf16 v[16:31], v[84:87], v[176:179], v[16:31]
    buffer_load_dwordx4 v226, s[4:7], s42 offen lds
    buffer_load_dwordx4 v227, s[72:75], s42 offen offset:1024 lds
    v_mfma_f32_32x32x16_bf16 v[32:47], v[80:83], v[180:183], v[32:47]
    v_mfma_f32_32x32x16_bf16 v[48:63], v[84:87], v[180:183], v[48:63]
    s_waitcnt vmcnt(4) lgkmcnt(0)
    v_mfma_f32_32x32x16_bf16 v[0:15], v[88:91], v[184:187], v[0:15]
    ds_read_b64_tr_b16 v[176:177], v246 offset:0
    ds_read_b64_tr_b16 v[178:179], v246 offset:512
    ds_read_b64_tr_b16 v[180:181], v247 offset:0
    ds_read_b64_tr_b16 v[182:183], v247 offset:512
    s_mov_b32 m0, s71
    v_mfma_f32_32x32x16_bf16 v[16:31], v[92:95], v[184:187], v[16:31]
    buffer_load_dwordx4 v228, s[4:7], s42 offen lds
    buffer_load_dwordx4 v229, s[72:75], s42 offen offset:1024 lds
    v_mfma_f32_32x32x16_bf16 v[32:47], v[88:91], v[188:191], v[32:47]
    s_nop 2
    v_mul_f32 v234, v0, v144
    v_mul_f32 v236, v8, v112
    v_fmac_f32 v234, v1, v145
    v_fmac_f32 v236, v9, v113
    v_fmac_f32 v234, v2, v146
    v_fmac_f32 v236, v10, v114
    v_fmac_f32 v234, v3, v147
    v_mfma_f32_32x32x16_bf16 v[48:63], v[92:95], v[188:191], v[48:63]
    s_setprio 0
    v_fmac_f32 v236, v11, v115
    v_fmac_f32 v234, v4, v148
    v_fmac_f32 v236, v12, v116
    v_fmac_f32 v234, v5, v149
    v_fmac_f32 v236, v13, v117
    v_fmac_f32 v234, v6, v150
    v_fmac_f32 v236, v14, v118
    v_fmac_f32 v234, v7, v151
    v_fmac_f32 v236, v15, v119
    v_mul_f32 v238, v16, v160
    v_mul_f32 v240, v24, v160
    v_fmac_f32 v238, v17, v161
    v_fmac_f32 v240, v25, v161
    v_fmac_f32 v238, v18, v162
    v_fmac_f32 v240, v26, v162
    v_fmac_f32 v238, v19, v163
    v_fmac_f32 v240, v27, v163
    v_fmac_f32 v238, v20, v164
    v_fmac_f32 v240, v28, v164
    v_fmac_f32 v238, v21, v165
    v_fmac_f32 v240, v29, v165
    v_fmac_f32 v238, v22, v166
    v_fmac_f32 v240, v30, v166
    v_fmac_f32 v238, v23, v167
    v_fmac_f32 v240, v31, v167
    v_mul_f32 v235, v32, v152
    v_mul_f32 v237, v40, v120
    v_fmac_f32 v235, v33, v153
    v_fmac_f32 v237, v41, v121
    v_fmac_f32 v235, v34, v154
    v_fmac_f32 v237, v42, v122
    v_fmac_f32 v235, v35, v155
    v_fmac_f32 v237, v43, v123
    v_fmac_f32 v235, v36, v156
    v_fmac_f32 v237, v44, v124
    v_fmac_f32 v235, v37, v157
    v_fmac_f32 v237, v45, v125
    v_fmac_f32 v235, v38, v158
    v_fmac_f32 v237, v46, v126
    v_fmac_f32 v235, v39, v159
    v_fmac_f32 v237, v47, v127
    v_mul_f32 v239, v48, v168
    v_mul_f32 v241, v56, v168
    s_setprio 1
    s_waitcnt vmcnt(4) lgkmcnt(0)
    v_mfma_f32_32x32x16_bf16 v[0:15], v[64:67], v[176:179], 0
    ds_read_b64_tr_b16 v[184:185], v246 offset:2048
    ds_read_b64_tr_b16 v[186:187], v246 offset:2560
    ds_read_b64_tr_b16 v[188:189], v247 offset:2048
    ds_read_b64_tr_b16 v[190:191], v247 offset:2560
    v_fmac_f32 v239, v49, v169
    v_fmac_f32 v241, v57, v169
    s_mov_b32 m0, s68
    v_mfma_f32_32x32x16_bf16 v[16:31], v[68:71], v[176:179], 0
    buffer_load_dwordx4 v222, s[4:7], s43 offen lds
    buffer_load_dwordx4 v223, s[72:75], s43 offen offset:1024 lds
    v_fmac_f32 v239, v50, v170
    v_fmac_f32 v241, v58, v170
    v_fmac_f32 v239, v51, v171
    v_fmac_f32 v241, v59, v171
    v_fmac_f32 v239, v52, v172
    v_mfma_f32_32x32x16_bf16 v[32:47], v[64:67], v[180:183], 0
    v_fmac_f32 v241, v60, v172
    v_fmac_f32 v239, v53, v173
    v_fmac_f32 v241, v61, v173
    v_fmac_f32 v239, v54, v174
    v_fmac_f32 v241, v62, v174
    v_fmac_f32 v239, v55, v175
    v_fmac_f32 v241, v63, v175
    v_mfma_f32_32x32x16_bf16 v[48:63], v[68:71], v[180:183], 0
    s_waitcnt vmcnt(4) lgkmcnt(0)
    v_mfma_f32_32x32x16_bf16 v[0:15], v[72:75], v[184:187], v[0:15]
    ds_read_b64_tr_b16 v[176:177], v246 offset:4096
    ds_read_b64_tr_b16 v[178:179], v246 offset:4608
    ds_read_b64_tr_b16 v[180:181], v247 offset:4096
    ds_read_b64_tr_b16 v[182:183], v247 offset:4608
    s_mov_b32 m0, s69
    v_mfma_f32_32x32x16_bf16 v[16:31], v[76:79], v[184:187], v[16:31]
    buffer_load_dwordx4 v224, s[4:7], s43 offen lds
    buffer_load_dwordx4 v225, s[72:75], s43 offen offset:1024 lds
    v_mfma_f32_32x32x16_bf16 v[32:47], v[72:75], v[188:191], v[32:47]
    v_mfma_f32_32x32x16_bf16 v[48:63], v[76:79], v[188:191], v[48:63]
    s_waitcnt vmcnt(4) lgkmcnt(0)
    v_mfma_f32_32x32x16_bf16 v[0:15], v[80:83], v[176:179], v[0:15]
    ds_read_b64_tr_b16 v[184:185], v246 offset:6144
    ds_read_b64_tr_b16 v[186:187], v246 offset:6656
    ds_read_b64_tr_b16 v[188:189], v247 offset:6144
    ds_read_b64_tr_b16 v[190:191], v247 offset:6656
    s_mov_b32 m0, s70
    v_mfma_f32_32x32x16_bf16 v[16:31], v[84:87], v[176:179], v[16:31]
    buffer_load_dwordx4 v226, s[4:7], s43 offen lds
    buffer_load_dwordx4 v227, s[72:75], s43 offen offset:1024 lds
    v_mfma_f32_32x32x16_bf16 v[32:47], v[80:83], v[180:183], v[32:47]
    v_add_u32 v222, s48, v251
    ds_read_b32 v222, v222
    v_mfma_f32_32x32x16_bf16 v[48:63], v[84:87], v[180:183], v[48:63]
    s_waitcnt vmcnt(4) lgkmcnt(1)
    v_mfma_f32_32x32x16_bf16 v[0:15], v[88:91], v[184:187], v[0:15]
    ds_read_b64_tr_b16 v[176:177], v246 offset:0
    ds_read_b64_tr_b16 v[178:179], v246 offset:512
    ds_read_b64_tr_b16 v[180:181], v247 offset:0
    ds_read_b64_tr_b16 v[182:183], v247 offset:512
    s_mov_b32 m0, s71
    v_mfma_f32_32x32x16_bf16 v[16:31], v[92:95], v[184:187], v[16:31]
    buffer_load_dwordx4 v228, s[4:7], s43 offen lds
    buffer_load_dwordx4 v229, s[72:75], s43 offen offset:1024 lds
    s_waitcnt lgkmcnt(4)
    v_mad_u32_u16 v223, v222, s39, v248 op_sel:[1,0,0,0]
    v_mad_u32_u16 v222, v222, s39, v248
    v_mfma_f32_32x32x16_bf16 v[32:47], v[88:91], v[188:191], v[32:47]
    v_add_u32 v224, s49, v251
    ds_read_b32 v224, v224
    v_mul_f32 v242, v0, v144
    v_fma_f32 v238, v8, v160, -v238
    v_fmac_f32 v242, v1, v145
    v_fmac_f32 v238, v9, v161
    v_fmac_f32 v242, v2, v146
    v_mfma_f32_32x32x16_bf16 v[48:63], v[92:95], v[188:191], v[48:63]
    s_setprio 0
    v_fmac_f32 v238, v10, v162
    v_fmac_f32 v242, v3, v147
    v_fmac_f32 v238, v11, v163
    v_fmac_f32 v242, v4, v148
    v_fmac_f32 v238, v12, v164
    v_fmac_f32 v242, v5, v149
    v_fmac_f32 v238, v13, v165
    v_fmac_f32 v242, v6, v150
    v_fmac_f32 v238, v14, v166
    v_fmac_f32 v242, v7, v151
    v_fmac_f32 v238, v15, v167
    v_fmac_f32 v236, v16, v112
    v_mul_f32 v244, v24, v160
    v_fmac_f32 v236, v17, v113
    v_fmac_f32 v244, v25, v161
    v_fmac_f32 v236, v18, v114
    v_fmac_f32 v244, v26, v162
    v_fmac_f32 v236, v19, v115
    v_fmac_f32 v244, v27, v163
    v_fmac_f32 v236, v20, v116
    v_fmac_f32 v244, v28, v164
    v_fmac_f32 v236, v21, v117
    v_fmac_f32 v244, v29, v165
    v_fmac_f32 v236, v22, v118
    v_fmac_f32 v244, v30, v166
    v_fmac_f32 v236, v23, v119
    v_fmac_f32 v244, v31, v167
    v_mul_f32 v243, v32, v152
    v_fma_f32 v239, v40, v168, -v239
    v_fmac_f32 v243, v33, v153
    v_fmac_f32 v239, v41, v169
    v_fmac_f32 v243, v34, v154
    v_fmac_f32 v239, v42, v170
    v_fmac_f32 v243, v35, v155
    v_fmac_f32 v239, v43, v171
    v_fmac_f32 v243, v36, v156
    v_fmac_f32 v239, v44, v172
    v_fmac_f32 v243, v37, v157
    v_fmac_f32 v239, v45, v173
    v_fmac_f32 v243, v38, v158
    v_fmac_f32 v239, v46, v174
    v_fmac_f32 v243, v39, v159
    v_fmac_f32 v239, v47, v175
    v_fmac_f32 v237, v48, v120
    v_mul_f32 v245, v56, v168
    v_fmac_f32 v237, v49, v121
    v_fmac_f32 v245, v57, v169
    v_fmac_f32 v237, v50, v122
    v_fmac_f32 v245, v58, v170
    v_fmac_f32 v237, v51, v123
    s_setprio 1
    s_waitcnt vmcnt(4) lgkmcnt(1)
    v_mfma_f32_32x32x16_bf16 v[0:15], v[64:67], v[176:179], 0
    ds_read_b64_tr_b16 v[184:185], v246 offset:2048
    ds_read_b64_tr_b16 v[186:187], v246 offset:2560
    ds_read_b64_tr_b16 v[188:189], v247 offset:2048
    ds_read_b64_tr_b16 v[190:191], v247 offset:2560
    v_fmac_f32 v245, v59, v171
    v_fmac_f32 v237, v52, v124
    s_mov_b32 m0, s68
    v_mfma_f32_32x32x16_bf16 v[16:31], v[68:71], v[176:179], 0
    buffer_load_dwordx4 v222, s[4:7], s44 offen lds
    buffer_load_dwordx4 v223, s[72:75], s44 offen offset:1024 lds
    s_waitcnt lgkmcnt(4)
    v_mad_u32_u16 v225, v224, s39, v248 op_sel:[1,0,0,0]
    v_mad_u32_u16 v224, v224, s39, v248
    v_fmac_f32 v245, v60, v172
    v_fmac_f32 v237, v53, v125
    v_mfma_f32_32x32x16_bf16 v[32:47], v[64:67], v[180:183], 0
    v_add_u32 v226, s50, v251
    ds_read_b32 v226, v226
    v_fmac_f32 v245, v61, v173
    v_fmac_f32 v237, v54, v126
    v_fmac_f32 v245, v62, v174
    v_fmac_f32 v237, v55, v127
    v_fmac_f32 v245, v63, v175
    v_mfma_f32_32x32x16_bf16 v[48:63], v[68:71], v[180:183], 0
    v_permlane32_swap_b32 v242, v234
    v_permlane32_swap_b32 v243, v235
    v_add_f32 v242, v242, v234
    v_add_f32 v243, v243, v235
    s_waitcnt vmcnt(4) lgkmcnt(1)
    v_mfma_f32_32x32x16_bf16 v[0:15], v[72:75], v[184:187], v[0:15]
    ds_read_b64_tr_b16 v[176:177], v246 offset:4096
    ds_read_b64_tr_b16 v[178:179], v246 offset:4608
    ds_read_b64_tr_b16 v[180:181], v247 offset:4096
    ds_read_b64_tr_b16 v[182:183], v247 offset:4608
    v_cvt_pk_bf16_f32 v242, v242, v243
    ds_write_b32 v230, v242 offset:512
    s_mov_b32 m0, s69
    v_mfma_f32_32x32x16_bf16 v[16:31], v[76:79], v[184:187], v[16:31]
    buffer_load_dwordx4 v224, s[4:7], s45 offen lds
    buffer_load_dwordx4 v225, s[72:75], s45 offen offset:1024 lds
    s_waitcnt lgkmcnt(5)
    v_mad_u32_u16 v227, v226, s39, v248 op_sel:[1,0,0,0]
    v_mad_u32_u16 v226, v226, s39, v248
    v_mfma_f32_32x32x16_bf16 v[32:47], v[72:75], v[188:191], v[32:47]
    v_add_u32 v228, s51, v251
    ds_read_b32 v228, v228
    v_mfma_f32_32x32x16_bf16 v[48:63], v[76:79], v[188:191], v[48:63]
    s_waitcnt vmcnt(4) lgkmcnt(2)
    v_mfma_f32_32x32x16_bf16 v[0:15], v[80:83], v[176:179], v[0:15]
    ds_read_b64_tr_b16 v[184:185], v246 offset:6144
    ds_read_b64_tr_b16 v[186:187], v246 offset:6656
    ds_read_b64_tr_b16 v[188:189], v247 offset:6144
    ds_read_b64_tr_b16 v[190:191], v247 offset:6656
    s_mov_b32 m0, s70
    v_mfma_f32_32x32x16_bf16 v[16:31], v[84:87], v[176:179], v[16:31]
    buffer_load_dwordx4 v226, s[4:7], s46 offen lds
    buffer_load_dwordx4 v227, s[72:75], s46 offen offset:1024 lds
    s_waitcnt lgkmcnt(4)
    v_mad_u32_u16 v229, v228, s39, v248 op_sel:[1,0,0,0]
    v_mad_u32_u16 v228, v228, s39, v248
    v_mfma_f32_32x32x16_bf16 v[32:47], v[80:83], v[180:183], v[32:47]
    v_mfma_f32_32x32x16_bf16 v[48:63], v[84:87], v[180:183], v[48:63]
    s_waitcnt vmcnt(4) lgkmcnt(0)
    v_mfma_f32_32x32x16_bf16 v[0:15], v[88:91], v[184:187], v[0:15]
    ds_read_b64_tr_b16 v[176:177], v246 offset:0
    ds_read_b64_tr_b16 v[178:179], v246 offset:512
    ds_read_b64_tr_b16 v[180:181], v247 offset:0
    ds_read_b64_tr_b16 v[182:183], v247 offset:512
    s_mov_b32 m0, s71
    v_mfma_f32_32x32x16_bf16 v[16:31], v[92:95], v[184:187], v[16:31]
    buffer_load_dwordx4 v228, s[4:7], s47 offen lds
    buffer_load_dwordx4 v229, s[72:75], s47 offen offset:1024 lds
    v_mfma_f32_32x32x16_bf16 v[32:47], v[88:91], v[188:191], v[32:47]
    s_nop 2
    v_mul_f32 v242, v0, v144
    v_fma_f32 v240, v8, v160, -v240
    v_fmac_f32 v242, v1, v145
    v_fmac_f32 v240, v9, v161
    v_fmac_f32 v242, v2, v146
    v_fmac_f32 v240, v10, v162
    v_fmac_f32 v242, v3, v147
    v_mfma_f32_32x32x16_bf16 v[48:63], v[92:95], v[188:191], v[48:63]
    s_setprio 0
    v_fmac_f32 v240, v11, v163
    v_fmac_f32 v242, v4, v148
    v_fmac_f32 v240, v12, v164
    v_fmac_f32 v242, v5, v149
    v_fmac_f32 v240, v13, v165
    v_fmac_f32 v242, v6, v150
    v_fmac_f32 v240, v14, v166
    v_fmac_f32 v242, v7, v151
    v_fmac_f32 v240, v15, v167
    s_sub_u32 s58, s48, s29
    v_add_u32 v249, s58, v249
    v_add_u32 v250, s58, v250
    v_fma_f32 v244, v16, v160, -v244
    v_fmac_f32 v236, v24, v112
    v_fmac_f32 v244, v17, v161
    v_fmac_f32 v236, v25, v113
    v_fmac_f32 v244, v18, v162
    v_fmac_f32 v236, v26, v114
    v_fmac_f32 v244, v19, v163
    v_fmac_f32 v236, v27, v115
    v_fmac_f32 v244, v20, v164
    v_fmac_f32 v236, v28, v116
    v_fmac_f32 v244, v21, v165
    v_fmac_f32 v236, v29, v117
    v_fmac_f32 v244, v22, v166
    v_fmac_f32 v236, v30, v118
    v_fmac_f32 v244, v23, v167
    v_fmac_f32 v236, v31, v119
    ds_read_b64_tr_b16 v[0:1], v249 offset:0
    ds_read_b64_tr_b16 v[2:3], v249 offset:128
    ds_read_b128 v[4:7], v250 offset:0
    ds_read_b128 v[8:11], v250 offset:16
    ds_read_b128 v[12:15], v250 offset:384
    ds_read_b128 v[16:19], v250 offset:400
    v_mul_f32 v243, v32, v152
    v_fma_f32 v241, v40, v168, -v241
    v_fmac_f32 v243, v33, v153
    v_fmac_f32 v241, v41, v169
    v_fmac_f32 v243, v34, v154
    v_fmac_f32 v241, v42, v170
    v_fmac_f32 v243, v35, v155
    v_fmac_f32 v241, v43, v171
    v_fmac_f32 v243, v36, v156
    v_fmac_f32 v241, v44, v172
    v_fmac_f32 v243, v37, v157
    v_fmac_f32 v241, v45, v173
    v_fmac_f32 v243, v38, v158
    v_fmac_f32 v241, v46, v174
    v_fmac_f32 v243, v39, v159
    v_fmac_f32 v241, v47, v175
    ds_read_b64_tr_b16 v[20:21], v249 offset:512
    ds_read_b64_tr_b16 v[22:23], v249 offset:640
    ds_read_b128 v[24:27], v250 offset:64
    ds_read_b128 v[28:31], v250 offset:80
    ds_read_b128 v[32:35], v250 offset:448
    ds_read_b128 v[36:39], v250 offset:464
    v_fma_f32 v245, v48, v168, -v245
    v_fmac_f32 v237, v56, v120
    v_fmac_f32 v245, v49, v169
    v_fmac_f32 v237, v57, v121
    v_fmac_f32 v245, v50, v170
    v_fmac_f32 v237, v58, v122
    v_fmac_f32 v245, v51, v171
    v_fmac_f32 v237, v59, v123
    v_fmac_f32 v245, v52, v172
    v_fmac_f32 v237, v60, v124
    v_fmac_f32 v245, v53, v173
    v_fmac_f32 v237, v61, v125
    v_fmac_f32 v245, v54, v174
    v_fmac_f32 v237, v62, v126
    v_fmac_f32 v245, v55, v175
    v_fmac_f32 v237, v63, v127
    s_cmp_eq_u32 s36, 0
    s_cbranch_scc1 K2_TAIL
    s_mov_b32 s29, s48
    s_mov_b32 s32, s31
    s_mov_b32 s30, s3
    s_mov_b32 s31, s35
    s_cmp_eq_u32 s33, 2
    s_cbranch_scc1 K2_U21
    s_cmp_eq_u32 s33, 3
    s_cbranch_scc1 K2_U31
    s_cmp_eq_u32 s33, 1
    s_cbranch_scc1 K2_U11
    s_branch K2_U41
K2_SWITCH:
    v_permlane32_swap_b32 v242, v236
    v_permlane32_swap_b32 v243, v237
    v_permlane32_swap_b32 v244, v238
    v_permlane32_swap_b32 v245, v239
    v_permlane32_swap_b32 v240, v241
    v_add_f32 v242, v242, v236
    v_add_f32 v243, v243, v237
    v_add_f32 v244, v244, v238
    v_add_f32 v245, v245, v239
    v_add_f32 v240, -v240, -v241
    s_set_gpr_idx_on s31, gpr_idx(DST)
    s_nop 0
    v_cvt_pk_bf16_f32 v195, v242, v243
    v_cvt_pk_bf16_f32 v196, v244, v245
    v_cvt_pk_bf16_f32 v197, v240, v240
    s_set_gpr_idx_off
    s_cmp_eq_u32 s36, 0
    s_cbranch_scc1 K2_TAIL2
    v_lshlrev_b32 v254, 3, v252
    v_lshl_add_u32 v230, v252, 1, s35
    v_lshrrev_b32 v231, 6, v252
    v_mul_u32_u24 v231, 126, v231
    s_mov_b32 s58, 7131136
    buffer_load_dwordx4 v[96:99], v254, s[8:11], s58 offen offset:0 sc1
    buffer_load_dwordx4 v[100:103], v254, s[8:11], s58 offen offset:1024 sc1
    buffer_load_dwordx4 v[104:107], v254, s[8:11], s58 offen offset:2048 sc1
    buffer_load_dwordx4 v[108:111], v254, s[8:11], s58 offen offset:3072 sc1
    s_mov_b32 s58, 7135232
    buffer_load_dwordx4 v[112:115], v254, s[8:11], s58 offen offset:0 sc1
    buffer_load_dwordx4 v[116:119], v254, s[8:11], s58 offen offset:1024 sc1
    buffer_load_dwordx4 v[120:123], v254, s[8:11], s58 offen offset:2048 sc1
    buffer_load_dwordx4 v[124:127], v254, s[8:11], s58 offen offset:3072 sc1
    s_mov_b32 s58, 7139328
    buffer_load_dwordx4 v[128:131], v254, s[8:11], s58 offen offset:0 sc1
    buffer_load_dwordx4 v[132:135], v254, s[8:11], s58 offen offset:1024 sc1
    buffer_load_dwordx4 v[136:139], v254, s[8:11], s58 offen offset:2048 sc1
    buffer_load_dwordx4 v[140:143], v254, s[8:11], s58 offen offset:3072 sc1
    s_mov_b32 s58, 7143424
    buffer_load_dwordx4 v[144:147], v254, s[8:11], s58 offen offset:0 sc1
    buffer_load_dwordx4 v[148:151], v254, s[8:11], s58 offen offset:1024 sc1
    buffer_load_dwordx4 v[152:155], v254, s[8:11], s58 offen offset:2048 sc1
    buffer_load_dwordx4 v[156:159], v254, s[8:11], s58 offen offset:3072 sc1
    s_mov_b32 s58, 7147520
    buffer_load_dwordx4 v[160:163], v254, s[8:11], s58 offen offset:0 sc1
    buffer_load_dwordx4 v[164:167], v254, s[8:11], s58 offen offset:1024 sc1
    buffer_load_dwordx4 v[168:171], v254, s[8:11], s58 offen offset:2048 sc1
    buffer_load_dwordx4 v[172:175], v254, s[8:11], s58 offen offset:3072 sc1
    s_movk_i32 s40, 128
    s_movk_i32 s41, 384
    s_movk_i32 s42, 640
    s_movk_i32 s43, 896
    s_cmp_lg_u32 s33, 1
    s_cbranch_scc1 K2_SW2
    s_waitcnt vmcnt(0)
K2_SW2:
    s_mov_b32 s29, s48
    s_mov_b32 s32, s31
    s_mov_b32 s30, s3
    s_mov_b32 s31, s35
    s_cmp_eq_u32 s33, 2
    s_cbranch_scc1 K2_U21
    s_cmp_eq_u32 s33, 3
    s_cbranch_scc1 K2_U31
    s_cmp_eq_u32 s33, 1
    s_cbranch_scc1 K2_U11
    s_branch K2_U41
K2_WINDOW:
    s_mov_b32 s24, 0
    s_mov_b32 s25, 1
K2_LOAD:
    v_mbcnt_lo_u32_b32 v176, -1, 0
    v_mbcnt_hi_u32_b32 v176, -1, v176
    s_lshl_b32 s58, s20, 6
    v_add_u32 v177, s58, v176
    v_lshlrev_b32 v70, 4, v176
    s_mov_b32 s58, 7110656
    buffer_load_dwordx4 v[96:99], v70, s[8:11], s58 offen offset:0 sc1
    buffer_load_dwordx4 v[100:103], v70, s[8:11], s58 offen offset:1024 sc1
    buffer_load_dwordx4 v[104:107], v70, s[8:11], s58 offen offset:2048 sc1
    buffer_load_dwordx4 v[108:111], v70, s[8:11], s58 offen offset:3072 sc1
    s_mov_b32 s58, 7114752
    buffer_load_dwordx4 v[112:115], v70, s[8:11], s58 offen offset:0 sc1
    buffer_load_dwordx4 v[116:119], v70, s[8:11], s58 offen offset:1024 sc1
    buffer_load_dwordx4 v[120:123], v70, s[8:11], s58 offen offset:2048 sc1
    buffer_load_dwordx4 v[124:127], v70, s[8:11], s58 offen offset:3072 sc1
    s_mov_b32 s58, 7118848
    buffer_load_dwordx4 v[128:131], v70, s[8:11], s58 offen offset:0 sc1
    buffer_load_dwordx4 v[132:135], v70, s[8:11], s58 offen offset:1024 sc1
    buffer_load_dwordx4 v[136:139], v70, s[8:11], s58 offen offset:2048 sc1
    buffer_load_dwordx4 v[140:143], v70, s[8:11], s58 offen offset:3072 sc1
    s_mov_b32 s58, 7122944
    buffer_load_dwordx4 v[144:147], v70, s[8:11], s58 offen offset:0 sc1
    buffer_load_dwordx4 v[148:151], v70, s[8:11], s58 offen offset:1024 sc1
    buffer_load_dwordx4 v[152:155], v70, s[8:11], s58 offen offset:2048 sc1
    buffer_load_dwordx4 v[156:159], v70, s[8:11], s58 offen offset:3072 sc1
    s_mov_b32 s58, 7127040
    buffer_load_dwordx4 v[160:163], v70, s[8:11], s58 offen offset:0 sc1
    buffer_load_dwordx4 v[164:167], v70, s[8:11], s58 offen offset:1024 sc1
    buffer_load_dwordx4 v[168:171], v70, s[8:11], s58 offen offset:2048 sc1
    buffer_load_dwordx4 v[172:175], v70, s[8:11], s58 offen offset:3072 sc1
    v_mul_u32_u24 v76, 437, v177
    v_lshrrev_b32 v76, 16, v76
    v_mul_u32_u24 v76, 150, v76
    v_sub_u32 v76, v177, v76
    v_mov_b32 v80, -1
    v_mov_b32 v77, 1.0
    v_cmp_gt_u32 vcc, 48, v76
    v_lshlrev_b32 v78, 4, v177
    v_add_u32 v78, 65536, v78
    v_cndmask_b32 v80, v80, 0, vcc
    v_cmp_gt_u32 vcc, 12, v76
    v_add_u32 v79, 64800, v78
    s_nop 0
    v_cndmask_b32 v80, v80, v77, vcc
    v_cmp_gt_u32 vcc, 450, v177
    v_mov_b32 v81, v80
    v_mov_b32 v82, v80
    v_mov_b32 v83, v80
    s_mov_b64 exec, vcc
    ds_write_b128 v78, v[80:83] offset:0
    ds_write_b128 v78, v[80:83] offset:7200
    ds_write_b128 v78, v[80:83] offset:14400
    ds_write_b128 v78, v[80:83] offset:21600
    ds_write_b128 v78, v[80:83] offset:28800
    ds_write_b128 v78, v[80:83] offset:36000
    ds_write_b128 v78, v[80:83] offset:43200
    ds_write_b128 v78, v[80:83] offset:50400
    ds_write_b128 v78, v[80:83] offset:57600
    ds_write_b128 v79, v[80:83] offset:0
    ds_write_b128 v79, v[80:83] offset:7200
    ds_write_b128 v79, v[80:83] offset:14400
    ds_write_b128 v79, v[80:83] offset:21600
    v_cmp_gt_u32 vcc, 268, v177
    s_nop 0
    s_cbranch_vccz K2_NOCL
    s_mov_b64 exec, vcc
    ds_write_b128 v79, v[80:83] offset:28800
K2_NOCL:
    s_mov_b64 exec, -1
    s_cmp_lg_u32 s20, 7
    s_cbranch_scc1 K2_NOH
    v_mov_b32 v76, 0
    v_mov_b32 v77, -1
    v_lshlrev_b32 v78, 2, v176
    v_add_u32 v78, 163424, v78
    s_mov_b64 exec, 0x1ff
    ds_write_b32 v78, v76 offset:192
    s_mov_b64 exec, 0xff
    ds_write_b32 v78, v77 offset:256
    s_mov_b64 exec, -1
    s_cmp_lg_u32 s24, 0
    s_cbranch_scc1 K2_NOH
    s_mov_b32 exec_hi, 0xffff
    ds_write_b32 v78, v76
    s_mov_b64 exec, 1
    ds_write_b32 v78, v76 offset:228
    s_mov_b64 exec, -1
K2_NOH:
    s_waitcnt lgkmcnt(0)
    s_barrier
    s_branch K2_CELLS
K2_RETRY:
    s_sub_u32 s60, s60, 1
    s_cbranch_scc1 K2_END
    s_branch K2_RELOAD
K2_FLGCK:
    s_cmp_eq_u32 s28, 0
    s_cbranch_scc1 K2_FLGOK
    s_mov_b32 s60, 0x100000
K2_FLGW:
    v_xor_b32 v84, s2, v84
    v_xor_b32 v85, s2, v85
    v_xor_b32 v86, s2, v86
    v_xor_b32 v87, s2, v87
    v_or3_b32 v84, v84, v85, v86
    v_or_b32 v84, v84, v87
    v_cmp_ne_u32 vcc, 0, v84
    s_nop 0
    s_and_b32 vcc_hi, vcc_hi, 0x3ffff
    s_cmp_eq_u64 vcc, 0
    s_cbranch_scc1 K2_FLGOK
    s_sub_u32 s60, s60, 1
    s_cbranch_scc1 K2_END
    buffer_load_dwordx4 v[84:87], v72, s[8:11], s67 offen sc1
    s_waitcnt vmcnt(0)
    s_branch K2_FLGW
K2_BIG:
    s_cmp_lg_u32 s24, 0
    s_cbranch_scc1 K2_TOK
    s_mov_b64 s[62:63], vcc
    s_bcnt1_i32_b64 s60, vcc
    s_cmp_eq_u32 s22, 39
    s_cselect_b32 s61, 5, 2
    s_cmp_gt_u32 s60, s61
    s_cbranch_scc1 K2_SLOW
    v_cmp_lt_u32 vcc, 64, v193
    s_nop 0
    s_cbranch_vccnz K2_SLOW
    v_mbcnt_lo_u32_b32 v197, s62, 0
    v_mbcnt_hi_u32_b32 v197, s63, v197
    v_lshlrev_b32 v198, 27, v197
    v_cndmask_b32 v198, 0, v198, s[62:63]
    s_movk_i32 s26, 64
    v_cmp_le_u32 vcc, 2, v197
    v_mov_b32 v194, 161536
    v_mov_b32 v196, -8229472
    v_cndmask_b32 v194, v194, v196, vcc
    v_lshl_add_u32 v197, v197, 22, v194
    v_mov_b32 v203, v193
    v_mov_b32 v204, v195
    v_mov_b32 v205, v197
    s_mov_b32 s60, 6991
    v_cmp_lt_i32 vcc, 0, v180
    s_nop 0
    s_cbranch_vccz K2_OV_DONE
    v_subrev_u32 v192, 65536, v50
    v_mul_hi_u32_u24 v193, s60, v192
    v_mul_u32_u24 v192, s60, v192
    v_alignbit_b32 v192, v193, v192, 24
    v_lshlrev_b32 v192, 2, v192
    ds_bpermute_b32 v199, v192, v205
    v_subrev_u32 v192, 48, v40
    v_cmp_gt_u32 s[62:63], 16, v192
    s_waitcnt lgkmcnt(0)
    s_and_b64 exec, vcc, s[62:63]
    s_cbranch_execz K2_ov_11
    v_lshrrev_b32 v193, 18, v199
    v_add_u32 v192, v192, v193
    v_and_b32 v199, 0x3ffff, v199
    v_lshl_add_u32 v194, v192, 5, v199
    v_lshl_add_u32 v195, v192, 2, v199
    v_and_b32 v196, 7, v192
    v_add_lshl_u32 v196, v196, v192, 1
    v_bfe_u32 v193, v192, 3, 1
    v_mad_i32_i24 v196, v193, -14, v196
    v_add_u32 v196, v196, v199
    ds_write_b32 v194, v60 offset:864
    ds_write2_b32 v195, v0, v1 offset0:48 offset1:96
    ds_write_b32 v195, v2 offset:576
    ds_write_b16 v196, v3 offset:768
K2_ov_11:
    s_mov_b64 exec, -1
    v_cmp_lt_i32 vcc, 2, v180
    s_nop 0
    s_cbranch_vccz K2_OV_DONE
    v_subrev_u32 v192, 65536, v51
    v_mul_hi_u32_u24 v193, s60, v192
    v_mul_u32_u24 v192, s60, v192
    v_alignbit_b32 v192, v193, v192, 24
    v_lshlrev_b32 v192, 2, v192
    ds_bpermute_b32 v199, v192, v205
    v_subrev_u32 v192, 48, v41
    v_cmp_gt_u32 s[62:63], 16, v192
    s_waitcnt lgkmcnt(0)
    s_and_b64 exec, vcc, s[62:63]
    s_cbranch_execz K2_ov_12
    v_lshrrev_b32 v193, 18, v199
    v_add_u32 v192, v192, v193
    v_and_b32 v199, 0x3ffff, v199
    v_lshl_add_u32 v194, v192, 5, v199
    v_lshl_add_u32 v195, v192, 2, v199
    v_and_b32 v196, 7, v192
    v_add_lshl_u32 v196, v196, v192, 1
    v_bfe_u32 v193, v192, 3, 1
    v_mad_i32_i24 v196, v193, -14, v196
    v_add_u32 v196, v196, v199
    ds_write_b32 v194, v61 offset:864
    ds_write2_b32 v195, v4, v5 offset0:48 offset1:96
    ds_write_b32 v195, v6 offset:576
    ds_write_b16 v196, v7 offset:768
K2_ov_12:
    s_mov_b64 exec, -1
    v_cmp_lt_i32 vcc, 4, v180
    s_nop 0
    s_cbranch_vccz K2_OV_DONE
    v_subrev_u32 v192, 65536, v52
    v_mul_hi_u32_u24 v193, s60, v192
    v_mul_u32_u24 v192, s60, v192
    v_alignbit_b32 v192, v193, v192, 24
    v_lshlrev_b32 v192, 2, v192
    ds_bpermute_b32 v199, v192, v205
    v_subrev_u32 v192, 48, v42
    v_cmp_gt_u32 s[62:63], 16, v192
    s_waitcnt lgkmcnt(0)
    s_and_b64 exec, vcc, s[62:63]
    s_cbranch_execz K2_ov_13
    v_lshrrev_b32 v193, 18, v199
    v_add_u32 v192, v192, v193
    v_and_b32 v199, 0x3ffff, v199
    v_lshl_add_u32 v194, v192, 5, v199
    v_lshl_add_u32 v195, v192, 2, v199
    v_and_b32 v196, 7, v192
    v_add_lshl_u32 v196, v196, v192, 1
    v_bfe_u32 v193, v192, 3, 1
    v_mad_i32_i24 v196, v193, -14, v196
    v_add_u32 v196, v196, v199
    ds_write_b32 v194, v62 offset:864
    ds_write2_b32 v195, v8, v9 offset0:48 offset1:96
    ds_write_b32 v195, v10 offset:576
    ds_write_b16 v196, v11 offset:768
K2_ov_13:
    s_mov_b64 exec, -1
    v_cmp_lt_i32 vcc, 6, v180
    s_nop 0
    s_cbranch_vccz K2_OV_DONE
    v_subrev_u32 v192, 65536, v53
    v_mul_hi_u32_u24 v193, s60, v192
    v_mul_u32_u24 v192, s60, v192
    v_alignbit_b32 v192, v193, v192, 24
    v_lshlrev_b32 v192, 2, v192
    ds_bpermute_b32 v199, v192, v205
    v_subrev_u32 v192, 48, v43
    v_cmp_gt_u32 s[62:63], 16, v192
    s_waitcnt lgkmcnt(0)
    s_and_b64 exec, vcc, s[62:63]
    s_cbranch_execz K2_ov_14
    v_lshrrev_b32 v193, 18, v199
    v_add_u32 v192, v192, v193
    v_and_b32 v199, 0x3ffff, v199
    v_lshl_add_u32 v194, v192, 5, v199
    v_lshl_add_u32 v195, v192, 2, v199
    v_and_b32 v196, 7, v192
    v_add_lshl_u32 v196, v196, v192, 1
    v_bfe_u32 v193, v192, 3, 1
    v_mad_i32_i24 v196, v193, -14, v196
    v_add_u32 v196, v196, v199
    ds_write_b32 v194, v63 offset:864
    ds_write2_b32 v195, v12, v13 offset0:48 offset1:96
    ds_write_b32 v195, v14 offset:576
    ds_write_b16 v196, v15 offset:768
K2_ov_14:
    s_mov_b64 exec, -1
    v_cmp_lt_i32 vcc, 8, v180
    s_nop 0
    s_cbranch_vccz K2_OV_DONE
    v_subrev_u32 v192, 65536, v54
    v_mul_hi_u32_u24 v193, s60, v192
    v_mul_u32_u24 v192, s60, v192
    v_alignbit_b32 v192, v193, v192, 24
    v_lshlrev_b32 v192, 2, v192
    ds_bpermute_b32 v199, v192, v205
    v_subrev_u32 v192, 48, v44
    v_cmp_gt_u32 s[62:63], 16, v192
    s_waitcnt lgkmcnt(0)
    s_and_b64 exec, vcc, s[62:63]
    s_cbranch_execz K2_ov_15
    v_lshrrev_b32 v193, 18, v199
    v_add_u32 v192, v192, v193
    v_and_b32 v199, 0x3ffff, v199
    v_lshl_add_u32 v194, v192, 5, v199
    v_lshl_add_u32 v195, v192, 2, v199
    v_and_b32 v196, 7, v192
    v_add_lshl_u32 v196, v196, v192, 1
    v_bfe_u32 v193, v192, 3, 1
    v_mad_i32_i24 v196, v193, -14, v196
    v_add_u32 v196, v196, v199
    ds_write_b32 v194, v64 offset:864
    ds_write2_b32 v195, v16, v17 offset0:48 offset1:96
    ds_write_b32 v195, v18 offset:576
    ds_write_b16 v196, v19 offset:768
K2_ov_15:
    s_mov_b64 exec, -1
    v_cmp_lt_i32 vcc, 10, v180
    s_nop 0
    s_cbranch_vccz K2_OV_DONE
    v_subrev_u32 v192, 65536, v55
    v_mul_hi_u32_u24 v193, s60, v192
    v_mul_u32_u24 v192, s60, v192
    v_alignbit_b32 v192, v193, v192, 24
    v_lshlrev_b32 v192, 2, v192
    ds_bpermute_b32 v199, v192, v205
    v_subrev_u32 v192, 48, v45
    v_cmp_gt_u32 s[62:63], 16, v192
    s_waitcnt lgkmcnt(0)
    s_and_b64 exec, vcc, s[62:63]
    s_cbranch_execz K2_ov_16
    v_lshrrev_b32 v193, 18, v199
    v_add_u32 v192, v192, v193
    v_and_b32 v199, 0x3ffff, v199
    v_lshl_add_u32 v194, v192, 5, v199
    v_lshl_add_u32 v195, v192, 2, v199
    v_and_b32 v196, 7, v192
    v_add_lshl_u32 v196, v196, v192, 1
    v_bfe_u32 v193, v192, 3, 1
    v_mad_i32_i24 v196, v193, -14, v196
    v_add_u32 v196, v196, v199
    ds_write_b32 v194, v65 offset:864
    ds_write2_b32 v195, v20, v21 offset0:48 offset1:96
    ds_write_b32 v195, v22 offset:576
    ds_write_b16 v196, v23 offset:768
K2_ov_16:
    s_mov_b64 exec, -1
    v_cmp_lt_i32 vcc, 12, v180
    s_nop 0
    s_cbranch_vccz K2_OV_DONE
    v_subrev_u32 v192, 65536, v56
    v_mul_hi_u32_u24 v193, s60, v192
    v_mul_u32_u24 v192, s60, v192
    v_alignbit_b32 v192, v193, v192, 24
    v_lshlrev_b32 v192, 2, v192
    ds_bpermute_b32 v199, v192, v205
    v_subrev_u32 v192, 48, v46
    v_cmp_gt_u32 s[62:63], 16, v192
    s_waitcnt lgkmcnt(0)
    s_and_b64 exec, vcc, s[62:63]
    s_cbranch_execz K2_ov_17
    v_lshrrev_b32 v193, 18, v199
    v_add_u32 v192, v192, v193
    v_and_b32 v199, 0x3ffff, v199
    v_lshl_add_u32 v194, v192, 5, v199
    v_lshl_add_u32 v195, v192, 2, v199
    v_and_b32 v196, 7, v192
    v_add_lshl_u32 v196, v196, v192, 1
    v_bfe_u32 v193, v192, 3, 1
    v_mad_i32_i24 v196, v193, -14, v196
    v_add_u32 v196, v196, v199
    ds_write_b32 v194, v66 offset:864
    ds_write2_b32 v195, v24, v25 offset0:48 offset1:96
    ds_write_b32 v195, v26 offset:576
    ds_write_b16 v196, v27 offset:768
K2_ov_17:
    s_mov_b64 exec, -1
    v_cmp_lt_i32 vcc, 14, v180
    s_nop 0
    s_cbranch_vccz K2_OV_DONE
    v_subrev_u32 v192, 65536, v57
    v_mul_hi_u32_u24 v193, s60, v192
    v_mul_u32_u24 v192, s60, v192
    v_alignbit_b32 v192, v193, v192, 24
    v_lshlrev_b32 v192, 2, v192
    ds_bpermute_b32 v199, v192, v205
    v_subrev_u32 v192, 48, v47
    v_cmp_gt_u32 s[62:63], 16, v192
    s_waitcnt lgkmcnt(0)
    s_and_b64 exec, vcc, s[62:63]
    s_cbranch_execz K2_ov_18
    v_lshrrev_b32 v193, 18, v199
    v_add_u32 v192, v192, v193
    v_and_b32 v199, 0x3ffff, v199
    v_lshl_add_u32 v194, v192, 5, v199
    v_lshl_add_u32 v195, v192, 2, v199
    v_and_b32 v196, 7, v192
    v_add_lshl_u32 v196, v196, v192, 1
    v_bfe_u32 v193, v192, 3, 1
    v_mad_i32_i24 v196, v193, -14, v196
    v_add_u32 v196, v196, v199
    ds_write_b32 v194, v67 offset:864
    ds_write2_b32 v195, v28, v29 offset0:48 offset1:96
    ds_write_b32 v195, v30 offset:576
    ds_write_b16 v196, v31 offset:768
K2_ov_18:
    s_mov_b64 exec, -1
    v_cmp_lt_i32 vcc, 16, v180
    s_nop 0
    s_cbranch_vccz K2_OV_DONE
    v_subrev_u32 v192, 65536, v58
    v_mul_hi_u32_u24 v193, s60, v192
    v_mul_u32_u24 v192, s60, v192
    v_alignbit_b32 v192, v193, v192, 24
    v_lshlrev_b32 v192, 2, v192
    ds_bpermute_b32 v199, v192, v205
    v_subrev_u32 v192, 48, v48
    v_cmp_gt_u32 s[62:63], 16, v192
    s_waitcnt lgkmcnt(0)
    s_and_b64 exec, vcc, s[62:63]
    s_cbranch_execz K2_ov_19
    v_lshrrev_b32 v193, 18, v199
    v_add_u32 v192, v192, v193
    v_and_b32 v199, 0x3ffff, v199
    v_lshl_add_u32 v194, v192, 5, v199
    v_lshl_add_u32 v195, v192, 2, v199
    v_and_b32 v196, 7, v192
    v_add_lshl_u32 v196, v196, v192, 1
    v_bfe_u32 v193, v192, 3, 1
    v_mad_i32_i24 v196, v193, -14, v196
    v_add_u32 v196, v196, v199
    ds_write_b32 v194, v68 offset:864
    ds_write2_b32 v195, v32, v33 offset0:48 offset1:96
    ds_write_b32 v195, v34 offset:576
    ds_write_b16 v196, v35 offset:768
K2_ov_19:
    s_mov_b64 exec, -1
    v_cmp_lt_i32 vcc, 18, v180
    s_nop 0
    s_cbranch_vccz K2_OV_DONE
    v_subrev_u32 v192, 65536, v59
    v_mul_hi_u32_u24 v193, s60, v192
    v_mul_u32_u24 v192, s60, v192
    v_alignbit_b32 v192, v193, v192, 24
    v_lshlrev_b32 v192, 2, v192
    ds_bpermute_b32 v199, v192, v205
    v_subrev_u32 v192, 48, v49
    v_cmp_gt_u32 s[62:63], 16, v192
    s_waitcnt lgkmcnt(0)
    s_and_b64 exec, vcc, s[62:63]
    s_cbranch_execz K2_ov_20
    v_lshrrev_b32 v193, 18, v199
    v_add_u32 v192, v192, v193
    v_and_b32 v199, 0x3ffff, v199
    v_lshl_add_u32 v194, v192, 5, v199
    v_lshl_add_u32 v195, v192, 2, v199
    v_and_b32 v196, 7, v192
    v_add_lshl_u32 v196, v196, v192, 1
    v_bfe_u32 v193, v192, 3, 1
    v_mad_i32_i24 v196, v193, -14, v196
    v_add_u32 v196, v196, v199
    ds_write_b32 v194, v69 offset:864
    ds_write2_b32 v195, v36, v37 offset0:48 offset1:96
    ds_write_b32 v195, v38 offset:576
    ds_write_b16 v196, v39 offset:768
K2_ov_20:
    s_mov_b64 exec, -1
K2_OV_DONE:
    v_mov_b32 v193, v203
    v_mov_b32 v195, v204
    s_waitcnt lgkmcnt(0)
    s_barrier
    s_branch K2_TOK
K2_SLOW:
    v_mov_b32 v197, v193
    s_nop 1
    v_max_u32_dpp v197, v197, v197 row_shr:1 row_mask:0xf bank_mask:0xf bound_ctrl:0
    s_nop 1
    v_max_u32_dpp v197, v197, v197 row_shr:2 row_mask:0xf bank_mask:0xf bound_ctrl:0
    s_nop 1
    v_max_u32_dpp v197, v197, v197 row_shr:4 row_mask:0xf bank_mask:0xf bound_ctrl:0
    s_nop 1
    v_max_u32_dpp v197, v197, v197 row_shr:8 row_mask:0xf bank_mask:0xf bound_ctrl:0
    s_nop 1
    v_max_u32_dpp v197, v197, v197 row_bcast:15 row_mask:0xa bank_mask:0xf
    s_nop 1
    v_max_u32_dpp v197, v197, v197 row_bcast:31 row_mask:0xc bank_mask:0xf
    s_nop 0
    v_readlane_b32 s25, v197, 63
    s_nop 0
    s_add_u32 s25, s25, 47
    s_mul_i32 s25, s25, 43691
    s_lshr_b32 s25, s25, 21
    v_cmp_lt_i32 vcc, 0, v180
    s_nop 0
    s_cbranch_vccz K2_SV_DONE
    s_mov_b64 exec, vcc
    buffer_store_dword v40, v179, s[8:11], s66 offen offset:0
    v_cmp_lt_i32 vcc, 2, v180
    s_nop 0
    s_cbranch_vccz K2_SV_DONE
    s_mov_b64 exec, vcc
    buffer_store_dword v41, v179, s[8:11], s66 offen offset:8
    v_cmp_lt_i32 vcc, 4, v180
    s_nop 0
    s_cbranch_vccz K2_SV_DONE
    s_mov_b64 exec, vcc
    buffer_store_dword v42, v179, s[8:11], s66 offen offset:16
    v_cmp_lt_i32 vcc, 6, v180
    s_nop 0
    s_cbranch_vccz K2_SV_DONE
    s_mov_b64 exec, vcc
    buffer_store_dword v43, v179, s[8:11], s66 offen offset:24
    v_cmp_lt_i32 vcc, 8, v180
    s_nop 0
    s_cbranch_vccz K2_SV_DONE
    s_mov_b64 exec, vcc
    buffer_store_dword v44, v179, s[8:11], s66 offen offset:32
    v_cmp_lt_i32 vcc, 10, v180
    s_nop 0
    s_cbranch_vccz K2_SV_DONE
    s_mov_b64 exec, vcc
    buffer_store_dword v45, v179, s[8:11], s66 offen offset:40
    v_cmp_lt_i32 vcc, 12, v180
    s_nop 0
    s_cbranch_vccz K2_SV_DONE
    s_mov_b64 exec, vcc
    buffer_store_dword v46, v179, s[8:11], s66 offen offset:48
    v_cmp_lt_i32 vcc, 14, v180
    s_nop 0
    s_cbranch_vccz K2_SV_DONE
    s_mov_b64 exec, vcc
    buffer_store_dword v47, v179, s[8:11], s66 offen offset:56
    v_cmp_lt_i32 vcc, 16, v180
    s_nop 0
    s_cbranch_vccz K2_SV_DONE
    s_mov_b64 exec, vcc
    buffer_store_dword v48, v179, s[8:11], s66 offen offset:64
    v_cmp_lt_i32 vcc, 18, v180
    s_nop 0
    s_cbranch_vccz K2_SV_DONE
    s_mov_b64 exec, vcc
    buffer_store_dword v49, v179, s[8:11], s66 offen offset:72
K2_SV_DONE:
    s_mov_b64 exec, -1
    s_branch K2_TOK
K2_rare_21:
    s_cmp_eq_u32 s33, 4
    s_cbranch_scc1 K2_four_23
    s_mov_b32 s49, s48
    s_mov_b32 s51, s48
    s_add_u32 s45, s44, 256
    s_add_u32 s46, s44, 512
    s_add_u32 s47, s44, 768
    s_branch K2_back_22
K2_four_23:
    s_add_u32 s50, s48, 64
    s_lshr_b32 s51, s3, 27
    s_mov_b32 s66, 161536
    s_cmp_ge_u32 s51, 2
    s_cselect_b32 s66, 159072, s66
    s_mul_i32 s51, s51, 32
    s_add_u32 s51, s51, s66
    s_mov_b32 s46, s44
    s_mov_b32 s47, s44
    s_branch K2_back_22
K2_dum_24:
    v_mov_b32 v232, -1
    s_mov_b32 m0, 163712
    s_mov_b64 exec, 1
    buffer_load_dwordx4 v232, s[16:19], 0 offen lds
    buffer_load_dwordx4 v232, s[16:19], 0 offen lds
    s_mov_b64 exec, -1
    s_branch K2_back_26
K2_a4_25:
    s_lshr_b32 s65, s3, 27
    s_mov_b32 s66, 161536
    s_cmp_ge_u32 s65, 2
    s_cselect_b32 s66, 158112, s66
    s_mul_i32 s65, s65, 512
    s_add_u32 s65, s65, s66
    v_add_u32 v232, s65, v230
    ds_read_b32 v232, v232
    s_add_u32 m0, s65, 864
    s_waitcnt lgkmcnt(0)
    v_or_b32 v232, v232, v231
    buffer_load_dwordx4 v232, s[16:19], 0 offen  lds
    s_branch K2_b4_27
K2_nul_30:
    s_mov_b32 s58, 63
    s_mov_b32 s36, 0
    s_branch K2_back_33
K2_spin_31:
    v_lshl_add_u32 v233, v252, 1, s53
    ds_read_b32 v233, v233
    s_waitcnt lgkmcnt(0)
    s_branch K2_chk_32
K2_dyn_28:
    v_mov_b32 v254, 163648
    v_mov_b32 v255, 1
    v_lshl_add_u32 v233, v252, 1, s53
    s_mov_b64 exec, 1
    ds_add_rtn_u32 v232, v254, v255
    s_mov_b64 exec, -1
    ds_read_b32 v233, v233
    s_waitcnt lgkmcnt(0)
    v_readfirstlane_b32 s58, v232
    s_nop 0
    s_cmp_lt_u32 s58, s22
    s_cbranch_scc0 K2_nul_30
    s_and_b32 s59, s58, 7
    s_lshr_b32 s60, s58, 3
K2_chk_32:
    v_readlane_b32 s61, v233, s59
    s_nop 0
    s_cmp_gt_u32 s61, s60
    s_cbranch_scc0 K2_spin_31
K2_back_33:
    s_mov_b32 s34, 1
    s_branch K2_back_29
K2_rare_34:
    s_cmp_eq_u32 s33, 4
    s_cbranch_scc1 K2_four_36
    s_mov_b32 s49, s48
    s_mov_b32 s51, s48
    s_add_u32 s45, s44, 256
    s_add_u32 s46, s44, 512
    s_add_u32 s47, s44, 768
    s_branch K2_back_35
K2_four_36:
    s_add_u32 s50, s48, 64
    s_lshr_b32 s51, s3, 27
    s_mov_b32 s66, 161536
    s_cmp_ge_u32 s51, 2
    s_cselect_b32 s66, 159072, s66
    s_mul_i32 s51, s51, 32
    s_add_u32 s51, s51, s66
    s_mov_b32 s46, s44
    s_mov_b32 s47, s44
    s_branch K2_back_35
K2_dum_37:
    v_mov_b32 v232, -1
    s_mov_b32 m0, 163712
    s_mov_b64 exec, 1
    buffer_load_dwordx4 v232, s[16:19], 0 offen lds
    buffer_load_dwordx4 v232, s[16:19], 0 offen lds
    s_mov_b64 exec, -1
    s_branch K2_back_39
K2_a4_38:
    s_lshr_b32 s65, s3, 27
    s_mov_b32 s66, 161536
    s_cmp_ge_u32 s65, 2
    s_cselect_b32 s66, 158112, s66
    s_mul_i32 s65, s65, 512
    s_add_u32 s65, s65, s66
    v_add_u32 v232, s65, v230
    ds_read_b32 v232, v232
    s_add_u32 m0, s65, 864
    s_waitcnt lgkmcnt(0)
    v_or_b32 v232, v232, v231
    buffer_load_dwordx4 v232, s[16:19], 0 offen  lds
    s_branch K2_b4_40
K2_nul_43:
    s_mov_b32 s58, 63
    s_mov_b32 s36, 0
    s_branch K2_back_46
K2_spin_44:
    v_lshl_add_u32 v233, v252, 1, s53
    ds_read_b32 v233, v233
    s_waitcnt lgkmcnt(0)
    s_branch K2_chk_45
K2_dyn_41:
    v_mov_b32 v254, 163648
    v_mov_b32 v255, 1
    v_lshl_add_u32 v233, v252, 1, s53
    s_mov_b64 exec, 1
    ds_add_rtn_u32 v232, v254, v255
    s_mov_b64 exec, -1
    ds_read_b32 v233, v233
    s_waitcnt lgkmcnt(0)
    v_readfirstlane_b32 s58, v232
    s_nop 0
    s_cmp_lt_u32 s58, s22
    s_cbranch_scc0 K2_nul_43
    s_and_b32 s59, s58, 7
    s_lshr_b32 s60, s58, 3
K2_chk_45:
    v_readlane_b32 s61, v233, s59
    s_nop 0
    s_cmp_gt_u32 s61, s60
    s_cbranch_scc0 K2_spin_44
K2_back_46:
    s_mov_b32 s34, 1
    s_branch K2_back_42
K2_rare_47:
    s_cmp_eq_u32 s33, 4
    s_cbranch_scc1 K2_four_49
    s_mov_b32 s49, s48
    s_mov_b32 s51, s48
    s_add_u32 s45, s44, 256
    s_add_u32 s46, s44, 512
    s_add_u32 s47, s44, 768
    s_branch K2_back_48
K2_four_49:
    s_add_u32 s50, s48, 64
    s_lshr_b32 s51, s3, 27
    s_mov_b32 s66, 161536
    s_cmp_ge_u32 s51, 2
    s_cselect_b32 s66, 159072, s66
    s_mul_i32 s51, s51, 32
    s_add_u32 s51, s51, s66
    s_mov_b32 s46, s44
    s_mov_b32 s47, s44
    s_branch K2_back_48
K2_dum_50:
    v_mov_b32 v232, -1
    s_mov_b32 m0, 163712
    s_mov_b64 exec, 1
    buffer_load_dwordx4 v232, s[16:19], 0 offen lds
    buffer_load_dwordx4 v232, s[16:19], 0 offen lds
    s_mov_b64 exec, -1
    s_branch K2_back_52
K2_a4_51:
    s_lshr_b32 s65, s3, 27
    s_mov_b32 s66, 161536
    s_cmp_ge_u32 s65, 2
    s_cselect_b32 s66, 158112, s66
    s_mul_i32 s65, s65, 512
    s_add_u32 s65, s65, s66
    v_add_u32 v232, s65, v230
    ds_read_b32 v232, v232
    s_add_u32 m0, s65, 864
    s_waitcnt lgkmcnt(0)
    v_or_b32 v232, v232, v231
    buffer_load_dwordx4 v232, s[16:19], 0 offen  lds
    s_branch K2_b4_53
K2_nul_54:
    s_mov_b32 s58, 63
    s_mov_b32 s36, 0
    s_branch K2_back_57
K2_spin_55:
    v_lshl_add_u32 v233, v252, 1, s53
    ds_read_b32 v233, v233
    s_waitcnt lgkmcnt(0)
    s_branch K2_chk_56
K2_rare_58:
    s_cmp_eq_u32 s33, 4
    s_cbranch_scc1 K2_four_60
    s_mov_b32 s49, s48
    s_mov_b32 s51, s48
    s_add_u32 s45, s44, 256
    s_add_u32 s46, s44, 512
    s_add_u32 s47, s44, 768
    s_branch K2_back_59
K2_four_60:
    s_add_u32 s50, s48, 64
    s_lshr_b32 s51, s3, 27
    s_mov_b32 s66, 161536
    s_cmp_ge_u32 s51, 2
    s_cselect_b32 s66, 159072, s66
    s_mul_i32 s51, s51, 32
    s_add_u32 s51, s51, s66
    s_mov_b32 s46, s44
    s_mov_b32 s47, s44
    s_branch K2_back_59
K2_nul_61:
    s_mov_b32 s58, 63
    s_mov_b32 s36, 0
    s_branch K2_back_64
K2_spin_62:
    v_lshl_add_u32 v233, v252, 1, s53
    ds_read_b32 v233, v233
    s_waitcnt lgkmcnt(0)
    s_branch K2_chk_63
K2_rare_65:
    s_cmp_eq_u32 s33, 4
    s_cbranch_scc1 K2_four_67
    s_mov_b32 s49, s48
    s_mov_b32 s51, s48
    s_add_u32 s45, s44, 256
    s_add_u32 s46, s44, 512
    s_add_u32 s47, s44, 768
    s_branch K2_back_66
K2_four_67:
    s_add_u32 s50, s48, 64
    s_lshr_b32 s51, s3, 27
    s_mov_b32 s66, 161536
    s_cmp_ge_u32 s51, 2
    s_cselect_b32 s66, 159072, s66
    s_mul_i32 s51, s51, 32
    s_add_u32 s51, s51, s66
    s_mov_b32 s46, s44
    s_mov_b32 s47, s44
    s_branch K2_back_66
K2_nul_70:
    s_mov_b32 s58, 63
    s_mov_b32 s36, 0
    s_branch K2_back_73
K2_spin_71:
    v_lshl_add_u32 v233, v252, 1, s53
    ds_read_b32 v233, v233
    s_waitcnt lgkmcnt(0)
    s_branch K2_chk_72
K2_dyn_68:
    v_mov_b32 v254, 163648
    v_mov_b32 v255, 1
    v_lshl_add_u32 v233, v252, 1, s53
    s_mov_b64 exec, 1
    ds_add_rtn_u32 v232, v254, v255
    s_mov_b64 exec, -1
    ds_read_b32 v233, v233
    s_waitcnt lgkmcnt(0)
    v_readfirstlane_b32 s58, v232
    s_nop 0
    s_cmp_lt_u32 s58, s22
    s_cbranch_scc0 K2_nul_70
    s_and_b32 s59, s58, 7
    s_lshr_b32 s60, s58, 3
K2_chk_72:
    v_readlane_b32 s61, v233, s59
    s_nop 0
    s_cmp_gt_u32 s61, s60
    s_cbranch_scc0 K2_spin_71
K2_back_73:
    s_mov_b32 s34, 1
    s_branch K2_back_69
K2_rare_74:
    s_cmp_eq_u32 s33, 4
    s_cbranch_scc1 K2_four_76
    s_mov_b32 s49, s48
    s_mov_b32 s51, s48
    s_add_u32 s45, s44, 256
    s_add_u32 s46, s44, 512
    s_add_u32 s47, s44, 768
    s_branch K2_back_75
K2_four_76:
    s_add_u32 s50, s48, 64
    s_lshr_b32 s51, s3, 27
    s_mov_b32 s66, 161536
    s_cmp_ge_u32 s51, 2
    s_cselect_b32 s66, 159072, s66
    s_mul_i32 s51, s51, 32
    s_add_u32 s51, s51, s66
    s_mov_b32 s46, s44
    s_mov_b32 s47, s44
    s_branch K2_back_75
K2_dum_77:
    v_mov_b32 v232, -1
    s_mov_b32 m0, 163712
    s_mov_b64 exec, 1
    buffer_load_dwordx4 v232, s[16:19], 0 offen lds
    buffer_load_dwordx4 v232, s[16:19], 0 offen lds
    s_mov_b64 exec, -1
    s_branch K2_back_79
K2_a4_78:
    s_lshr_b32 s65, s3, 27
    s_mov_b32 s66, 161536
    s_cmp_ge_u32 s65, 2
    s_cselect_b32 s66, 158112, s66
    s_mul_i32 s65, s65, 512
    s_add_u32 s65, s65, s66
    v_add_u32 v232, s65, v230
    ds_read_b32 v232, v232
    s_add_u32 m0, s65, 864
    s_waitcnt lgkmcnt(0)
    v_or_b32 v232, v232, v231
    buffer_load_dwordx4 v232, s[16:19], 0 offen  lds
    s_branch K2_b4_80
K2_nul_83:
    s_mov_b32 s58, 63
    s_mov_b32 s36, 0
    s_branch K2_back_86
K2_spin_84:
    v_lshl_add_u32 v233, v252, 1, s53
    ds_read_b32 v233, v233
    s_waitcnt lgkmcnt(0)
    s_branch K2_chk_85
K2_dyn_81:
    v_mov_b32 v254, 163648
    v_mov_b32 v255, 1
    v_lshl_add_u32 v233, v252, 1, s53
    s_mov_b64 exec, 1
    ds_add_rtn_u32 v232, v254, v255
    s_mov_b64 exec, -1
    ds_read_b32 v233, v233
    s_waitcnt lgkmcnt(0)
    v_readfirstlane_b32 s58, v232
    s_nop 0
    s_cmp_lt_u32 s58, s22
    s_cbranch_scc0 K2_nul_83
    s_and_b32 s59, s58, 7
    s_lshr_b32 s60, s58, 3
K2_chk_85:
    v_readlane_b32 s61, v233, s59
    s_nop 0
    s_cmp_gt_u32 s61, s60
    s_cbranch_scc0 K2_spin_84
K2_back_86:
    s_mov_b32 s34, 1
    s_branch K2_back_82
K2_rare_87:
    s_cmp_eq_u32 s33, 4
    s_cbranch_scc1 K2_four_89
    s_mov_b32 s49, s48
    s_mov_b32 s51, s48
    s_add_u32 s45, s44, 256
    s_add_u32 s46, s44, 512
    s_add_u32 s47, s44, 768
    s_branch K2_back_88
K2_four_89:
    s_add_u32 s50, s48, 64
    s_lshr_b32 s51, s3, 27
    s_mov_b32 s66, 161536
    s_cmp_ge_u32 s51, 2
    s_cselect_b32 s66, 159072, s66
    s_mul_i32 s51, s51, 32
    s_add_u32 s51, s51, s66
    s_mov_b32 s46, s44
    s_mov_b32 s47, s44
    s_branch K2_back_88
K2_dum_90:
    v_mov_b32 v232, -1
    s_mov_b32 m0, 163712
    s_mov_b64 exec, 1
    buffer_load_dwordx4 v232, s[16:19], 0 offen lds
    buffer_load_dwordx4 v232, s[16:19], 0 offen lds
    s_mov_b64 exec, -1
    s_branch K2_back_92
K2_a4_91:
    s_lshr_b32 s65, s3, 27
    s_mov_b32 s66, 161536
    s_cmp_ge_u32 s65, 2
    s_cselect_b32 s66, 158112, s66
    s_mul_i32 s65, s65, 512
    s_add_u32 s65, s65, s66
    v_add_u32 v232, s65, v230
    ds_read_b32 v232, v232
    s_add_u32 m0, s65, 864
    s_waitcnt lgkmcnt(0)
    v_or_b32 v232, v232, v231
    buffer_load_dwordx4 v232, s[16:19], 0 offen  lds
    s_branch K2_b4_93
K2_nul_94:
    s_mov_b32 s58, 63
    s_mov_b32 s36, 0
    s_branch K2_back_97
K2_spin_95:
    v_lshl_add_u32 v233, v252, 1, s53
    ds_read_b32 v233, v233
    s_waitcnt lgkmcnt(0)
    s_branch K2_chk_96
K2_rare_98:
    s_cmp_eq_u32 s33, 4
    s_cbranch_scc1 K2_four_100
    s_mov_b32 s49, s48
    s_mov_b32 s51, s48
    s_add_u32 s45, s44, 256
    s_add_u32 s46, s44, 512
    s_add_u32 s47, s44, 768
    s_branch K2_back_99
K2_four_100:
    s_add_u32 s50, s48, 64
    s_lshr_b32 s51, s3, 27
    s_mov_b32 s66, 161536
    s_cmp_ge_u32 s51, 2
    s_cselect_b32 s66, 159072, s66
    s_mul_i32 s51, s51, 32
    s_add_u32 s51, s51, s66
    s_mov_b32 s46, s44
    s_mov_b32 s47, s44
    s_branch K2_back_99
K2_nul_101:
    s_mov_b32 s58, 63
    s_mov_b32 s36, 0
    s_branch K2_back_104
K2_spin_102:
    v_lshl_add_u32 v233, v252, 1, s53
    ds_read_b32 v233, v233
    s_waitcnt lgkmcnt(0)
    s_branch K2_chk_103
K2_rare_105:
    s_cmp_eq_u32 s33, 4
    s_cbranch_scc1 K2_four_107
    s_mov_b32 s49, s48
    s_mov_b32 s51, s48
    s_add_u32 s45, s44, 256
    s_add_u32 s46, s44, 512
    s_add_u32 s47, s44, 768
    s_branch K2_back_106
K2_four_107:
    s_add_u32 s50, s48, 64
    s_lshr_b32 s51, s3, 27
    s_mov_b32 s66, 161536
    s_cmp_ge_u32 s51, 2
    s_cselect_b32 s66, 159072, s66
    s_mul_i32 s51, s51, 32
    s_add_u32 s51, s51, s66
    s_mov_b32 s46, s44
    s_mov_b32 s47, s44
    s_branch K2_back_106
K2_TAIL2:
    v_lshlrev_b32 v229, 3, v252
    s_mul_i32 s58, s20, 20480
    s_add_u32 s58, s58, 6946816
    s_mul_i32 s59, s20, 8224
    buffer_load_dwordx4 v[96:99], v229, s[8:11], s58 offen offset:0 sc1
    buffer_load_dwordx4 v[100:103], v229, s[8:11], s58 offen offset:1024 sc1
    buffer_load_dwordx4 v[104:107], v229, s[8:11], s58 offen offset:2048 sc1
    buffer_load_dwordx4 v[108:111], v229, s[8:11], s58 offen offset:3072 sc1
    s_add_u32 s58, s58, 4096
    buffer_load_dwordx4 v[112:115], v229, s[8:11], s58 offen offset:0 sc1
    buffer_load_dwordx4 v[116:119], v229, s[8:11], s58 offen offset:1024 sc1
    buffer_load_dwordx4 v[120:123], v229, s[8:11], s58 offen offset:2048 sc1
    buffer_load_dwordx4 v[124:127], v229, s[8:11], s58 offen offset:3072 sc1
    s_add_u32 s58, s58, 4096
    v_lshl_add_u32 v228, v252, 1, s59
    v_lshrrev_b32 v226, 6, v252
    v_mul_u32_u24 v226, 126, v226
    v_sub_u32 v226, v228, v226
    s_branch K2_TAIL3
K2_TAIL:
    v_lshlrev_b32 v229, 3, v252
    s_mul_i32 s58, s20, 20480
    s_add_u32 s58, s58, 6946816
    s_mul_i32 s59, s20, 8224
    buffer_load_dwordx4 v[96:99], v229, s[8:11], s58 offen offset:0 sc1
    v_permlane32_swap_b32 v242, v236
    v_permlane32_swap_b32 v243, v237
    buffer_load_dwordx4 v[100:103], v229, s[8:11], s58 offen offset:1024 sc1
    v_permlane32_swap_b32 v244, v238
    v_permlane32_swap_b32 v245, v239
    buffer_load_dwordx4 v[104:107], v229, s[8:11], s58 offen offset:2048 sc1
    v_permlane32_swap_b32 v240, v241
    v_add_f32 v242, v242, v236
    buffer_load_dwordx4 v[108:111], v229, s[8:11], s58 offen offset:3072 sc1
    s_add_u32 s58, s58, 4096
    v_add_f32 v243, v243, v237
    v_add_f32 v244, v244, v238
    buffer_load_dwordx4 v[112:115], v229, s[8:11], s58 offen offset:0 sc1
    v_add_f32 v245, v245, v239
    v_add_f32 v240, -v240, -v241
    buffer_load_dwordx4 v[116:119], v229, s[8:11], s58 offen offset:1024 sc1
    v_sub_u32 v241, v230, v231
    v_cvt_pk_bf16_f32 v242, v242, v243
    buffer_load_dwordx4 v[120:123], v229, s[8:11], s58 offen offset:2048 sc1
    v_cvt_pk_bf16_f32 v244, v244, v245
    v_cvt_pk_bf16_f32 v240, v240, v240
    buffer_load_dwordx4 v[124:127], v229, s[8:11], s58 offen offset:3072 sc1
    s_add_u32 s58, s58, 4096
    ds_write_b32 v230, v242 offset:768
    ds_write_b32 v230, v244 offset:1024
    ds_write_b16 v241, v240 offset:1280
    v_lshl_add_u32 v228, v252, 1, s59
    v_lshrrev_b32 v226, 6, v252
    v_mul_u32_u24 v226, 126, v226
    v_sub_u32 v226, v228, v226
K2_TAIL3:
    s_waitcnt vmcnt(8)
    ds_write_b32 v228, v192 offset:0
    ds_write_b32 v228, v193 offset:256
    ds_write_b32 v228, v194 offset:512
    buffer_load_dwordx4 v[128:131], v229, s[8:11], s58 offen offset:0 sc1
    v_bfe_u32 v48, v252, 1, 4
    v_lshrrev_b32 v49, 5, v252
    ds_write_b32 v228, v195 offset:768
    ds_write_b32 v228, v196 offset:1024
    ds_write_b16 v226, v197 offset:1280
    buffer_load_dwordx4 v[132:135], v229, s[8:11], s58 offen offset:1024 sc1
    v_lshrrev_b32 v55, 3, v48
    v_lshlrev_b32 v52, 4, v49
    ds_write_b32 v228, v198 offset:1536
    ds_write_b32 v228, v199 offset:1792
    ds_write_b32 v228, v200 offset:2048
    buffer_load_dwordx4 v[136:139], v229, s[8:11], s58 offen offset:2048 sc1
    v_lshl_add_u32 v54, v55, 2, v48
    v_and_b32 v54, 7, v54
    ds_write_b32 v228, v201 offset:2304
    ds_write_b32 v228, v202 offset:2560
    ds_write_b16 v226, v203 offset:2816
    buffer_load_dwordx4 v[140:143], v229, s[8:11], s58 offen offset:3072 sc1
    s_add_u32 s58, s58, 4096
    v_and_b32 v50, 7, v48
    v_mul_u32_u24 v50, 8224, v50
    ds_write_b32 v228, v204 offset:3072
    ds_write_b32 v228, v205 offset:3328
    ds_write_b32 v228, v206 offset:3584
    buffer_load_dwordx4 v[144:147], v229, s[8:11], s58 offen offset:0 sc1
    v_mul_u32_u24 v51, 1536, v55
    v_add_u32 v50, v50, v51
    ds_write_b32 v228, v207 offset:3840
    ds_write_b32 v228, v208 offset:4096
    ds_write_b16 v226, v209 offset:4352
    buffer_load_dwordx4 v[148:151], v229, s[8:11], s58 offen offset:1024 sc1
    v_add_u32 v222, v50, v52
    v_mul_u32_u24 v51, 8224, v54
    ds_write_b32 v228, v210 offset:4608
    ds_write_b32 v228, v211 offset:4864
    ds_write_b32 v228, v212 offset:5120
    buffer_load_dwordx4 v[152:155], v229, s[8:11], s58 offen offset:2048 sc1
    v_add_u32 v232, v51, v52
    v_lshl_add_u32 v247, v55, 7, v232
    ds_write_b32 v228, v213 offset:5376
    ds_write_b32 v228, v214 offset:5632
    ds_write_b16 v226, v215 offset:5888
    buffer_load_dwordx4 v[156:159], v229, s[8:11], s58 offen offset:3072 sc1
    s_add_u32 s58, s58, 4096
    v_mul_u32_u24 v53, 192, v48
    v_and_b32 v53, 0xc0, v53
    ds_write_b32 v228, v216 offset:6144
    ds_write_b32 v228, v217 offset:6400
    ds_write_b32 v228, v218 offset:6656
    buffer_load_dwordx4 v[160:163], v229, s[8:11], s58 offen offset:0 sc1
    v_add_u32 v53, v53, v52
    v_mul_u32_u24 v51, 2400, v48
    ds_write_b32 v228, v219 offset:6912
    ds_write_b32 v228, v220 offset:7168
    ds_write_b16 v226, v221 offset:7424
    buffer_load_dwordx4 v[164:167], v229, s[8:11], s58 offen offset:1024 sc1
    s_mov_b32 s60, 65536
    v_add3_u32 v223, v51, v53, s60
    buffer_load_dwordx4 v[168:171], v229, s[8:11], s58 offen offset:2048 sc1
    v_mul_u32_u24 v51, 2400, v54
    s_mov_b32 s60, 142336
    buffer_load_dwordx4 v[172:175], v229, s[8:11], s58 offen offset:3072 sc1
    v_add3_u32 v225, v51, v53, s60
    v_lshl_add_u32 v248, v55, 7, v225
    s_lshl_b32 s60, s20, 5
    v_lshl_add_u32 v49, v49, 3, s60
    s_mov_b32 s60, 65536
    v_add3_u32 v255, v51, v49, s60
    v_lshl_add_u32 v246, v55, 9, v255
    v_bfe_u32 v53, v48, 2, 1
    v_lshl_add_u32 v49, v53, 4, v49
    v_add_u32 v254, v50, v49
    s_and_b32 s64, s55, s28
    s_waitcnt lgkmcnt(0)
    s_barrier
    s_cmp_eq_u32 s64, 0
    s_cbranch_scc1 K2_MULTI
    s_setprio 3
    ds_read_b128 v[48:51], v222 offset:0
    ds_read_b128 v[52:55], v222 offset:64
    ds_read_b128 v[56:59], v222 offset:896
    ds_read_b128 v[60:63], v222 offset:960
    ds_read_b128 v[64:67], v223 offset:0
    ds_read_b128 v[68:71], v223 offset:64
    ds_read_b128 v[72:75], v223 offset:896
    ds_read_b128 v[76:79], v223 offset:960
    ds_read_b128 v[80:83], v222 offset:128
    ds_read_b128 v[84:87], v222 offset:384
    ds_read_b128 v[88:91], v222 offset:256
    s_waitcnt vmcnt(19) lgkmcnt(9)
    v_mfma_f32_16x16x32_bf16 v[0:3], v[96:99], v[48:51], 0
    ds_read_b128 v[92:95], v222 offset:192
    s_waitcnt vmcnt(18)
    v_mfma_f32_16x16x32_bf16 v[0:3], v[100:103], v[52:55], v[0:3]
    ds_read_b128 v[48:51], v222 offset:448
    s_waitcnt vmcnt(17) lgkmcnt(9)
    v_mfma_f32_16x16x32_bf16 v[0:3], v[104:107], v[56:59], v[0:3]
    s_bfe_u32 s60, s20, 0x10002
    s_lshl_b32 s60, s60, 4
    ds_read_b128 v[52:55], v222 offset:320
    s_waitcnt vmcnt(16)
    v_mfma_f32_16x16x32_bf16 v[0:3], v[108:111], v[60:63], v[0:3]
    s_add_u32 s59, s59, s60
    v_add_u32 v228, s59, v229
    ds_read_b128 v[56:59], v222 offset:640
    s_waitcnt vmcnt(15) lgkmcnt(9)
    v_mfma_f32_16x16x32_bf16 v[0:3], v[112:115], v[64:67], v[0:3]
    s_mul_i32 s60, s20, 2400
    s_add_u32 s60, s60, 65536
    ds_read_b128 v[60:63], v222 offset:512
    s_waitcnt vmcnt(14)
    v_mfma_f32_16x16x32_bf16 v[0:3], v[116:119], v[68:71], v[0:3]
    v_add_u32 v249, s60, v229
    s_mov_b32 s63, 0xbfb8aa3b
    ds_read_b128 v[64:67], v222 offset:768
    s_waitcnt vmcnt(13) lgkmcnt(9)
    v_mfma_f32_16x16x32_bf16 v[0:3], v[120:123], v[72:75], v[0:3]
    s_add_u32 s40, s20, s21
    s_lshl_b32 s40, s40, 10
    ds_read_b128 v[68:71], v222 offset:704
    s_waitcnt vmcnt(12)
    v_mfma_f32_16x16x32_bf16 v[0:3], v[124:127], v[76:79], v[0:3]
    s_add_u32 s41, s40, 8192
    s_add_u32 s42, s40, 16384
    ds_read_b128 v[72:75], v222 offset:576
    s_waitcnt vmcnt(11) lgkmcnt(9)
    v_mfma_f32_16x16x32_bf16 v[4:7], v[128:131], v[80:83], 0
    s_add_u32 s43, s40, 24576
    s_add_u32 s44, s40, 32768
    ds_read_b128 v[76:79], v222 offset:832
    v_mfma_f32_16x16x32_bf16 v[8:11], v[128:131], v[84:87], 0
    ds_read_b128 v[80:83], v222 offset:1024
    s_waitcnt lgkmcnt(9)
    v_mfma_f32_16x16x32_bf16 v[12:15], v[128:131], v[88:91], 0
    ds_read_b128 v[84:87], v222 offset:1280
    s_waitcnt vmcnt(10)
    v_mfma_f32_16x16x32_bf16 v[4:7], v[132:135], v[92:95], v[4:7]
    ds_read_b128 v[88:91], v222 offset:1152
    s_waitcnt lgkmcnt(9)
    v_mfma_f32_16x16x32_bf16 v[8:11], v[132:135], v[48:51], v[8:11]
    v_mul_f32 v204, s63, v0
    ds_read_b128 v[92:95], v222 offset:1088
    v_mfma_f32_16x16x32_bf16 v[12:15], v[132:135], v[52:55], v[12:15]
    v_mul_f32 v205, s63, v1
    s_setprio 2
    ds_read_b128 v[48:51], v222 offset:1344
    s_waitcnt vmcnt(9) lgkmcnt(9)
    v_mfma_f32_16x16x32_bf16 v[4:7], v[136:139], v[56:59], v[4:7]
    ds_read_b128 v[52:55], v222 offset:1216
    v_mfma_f32_16x16x32_bf16 v[8:11], v[136:139], v[60:63], v[8:11]
    v_mul_f32 v206, s63, v2
    ds_read_b128 v[56:59], v223 offset:128
    s_waitcnt lgkmcnt(9)
    v_mfma_f32_16x16x32_bf16 v[12:15], v[136:139], v[64:67], v[12:15]
    v_mul_f32 v207, s63, v3
    ds_read_b128 v[60:63], v223 offset:384
    s_waitcnt vmcnt(8)
    v_mfma_f32_16x16x32_bf16 v[4:7], v[140:143], v[68:71], v[4:7]
    ds_read_b128 v[64:67], v223 offset:256
    s_waitcnt lgkmcnt(9)
    v_mfma_f32_16x16x32_bf16 v[8:11], v[140:143], v[72:75], v[8:11]
    v_exp_f32 v204, v204
    ds_read_b128 v[68:71], v223 offset:192
    v_mfma_f32_16x16x32_bf16 v[12:15], v[140:143], v[76:79], v[12:15]
    ds_read_b128 v[72:75], v223 offset:448
    s_waitcnt vmcnt(7) lgkmcnt(9)
    v_mfma_f32_16x16x32_bf16 v[4:7], v[144:147], v[80:83], v[4:7]
    v_exp_f32 v205, v205
    ds_read_b128 v[76:79], v223 offset:320
    v_mfma_f32_16x16x32_bf16 v[8:11], v[144:147], v[84:87], v[8:11]
    v_exp_f32 v206, v206
    ds_read_b128 v[80:83], v223 offset:640
    s_waitcnt lgkmcnt(9)
    v_mfma_f32_16x16x32_bf16 v[12:15], v[144:147], v[88:91], v[12:15]
    ds_read_b128 v[84:87], v223 offset:512
    s_waitcnt vmcnt(6)
    v_mfma_f32_16x16x32_bf16 v[4:7], v[148:151], v[92:95], v[4:7]
    v_exp_f32 v207, v207
    ds_read_b128 v[88:91], v223 offset:768
    s_waitcnt lgkmcnt(9)
    v_mfma_f32_16x16x32_bf16 v[8:11], v[148:151], v[48:51], v[8:11]
    v_add_f32 v204, 1.0, v204
    ds_read_b128 v[92:95], v223 offset:704
    v_mfma_f32_16x16x32_bf16 v[12:15], v[148:151], v[52:55], v[12:15]
    ds_read_b128 v[48:51], v223 offset:576
    s_waitcnt vmcnt(5) lgkmcnt(9)
    v_mfma_f32_16x16x32_bf16 v[4:7], v[152:155], v[56:59], v[4:7]
    v_add_f32 v205, 1.0, v205
    ds_read_b128 v[52:55], v223 offset:832
    v_mfma_f32_16x16x32_bf16 v[8:11], v[152:155], v[60:63], v[8:11]
    s_setprio 1
    ds_read_b128 v[56:59], v223 offset:1024
    s_waitcnt lgkmcnt(9)
    v_mfma_f32_16x16x32_bf16 v[12:15], v[152:155], v[64:67], v[12:15]
    v_add_f32 v206, 1.0, v206
    ds_read_b128 v[60:63], v223 offset:1280
    s_waitcnt vmcnt(4)
    v_mfma_f32_16x16x32_bf16 v[4:7], v[156:159], v[68:71], v[4:7]
    v_add_f32 v207, 1.0, v207
    ds_read_b128 v[64:67], v223 offset:1152
    s_waitcnt lgkmcnt(9)
    v_mfma_f32_16x16x32_bf16 v[8:11], v[156:159], v[72:75], v[8:11]
    ds_read_b128 v[68:71], v223 offset:1088
    v_mfma_f32_16x16x32_bf16 v[12:15], v[156:159], v[76:79], v[12:15]
    v_rcp_f32 v204, v204
    ds_read_b128 v[72:75], v223 offset:1344
    s_waitcnt vmcnt(3) lgkmcnt(9)
    v_mfma_f32_16x16x32_bf16 v[4:7], v[160:163], v[80:83], v[4:7]
    v_rcp_f32 v205, v205
    ds_read_b128 v[76:79], v223 offset:1216
    v_mfma_f32_16x16x32_bf16 v[8:11], v[160:163], v[84:87], v[8:11]
    ds_read_b128 v[80:83], v222 offset:3072
    s_waitcnt lgkmcnt(9)
    v_mfma_f32_16x16x32_bf16 v[12:15], v[160:163], v[88:91], v[12:15]
    v_rcp_f32 v206, v206
    ds_read_b128 v[84:87], v222 offset:3136
    s_waitcnt vmcnt(2)
    v_mfma_f32_16x16x32_bf16 v[4:7], v[164:167], v[92:95], v[4:7]
    ds_read_b128 v[88:91], v222 offset:3968
    s_waitcnt lgkmcnt(9)
    v_mfma_f32_16x16x32_bf16 v[8:11], v[164:167], v[48:51], v[8:11]
    v_rcp_f32 v207, v207
    ds_read_b128 v[92:95], v222 offset:4032
    v_mfma_f32_16x16x32_bf16 v[12:15], v[164:167], v[52:55], v[12:15]
    v_cvt_pk_bf16_f32 v176, v0, v1
    ds_read_b128 v[48:51], v223 offset:38400
    s_waitcnt vmcnt(1) lgkmcnt(9)
    v_mfma_f32_16x16x32_bf16 v[4:7], v[168:171], v[56:59], v[4:7]
    ds_read_b128 v[52:55], v223 offset:38464
    v_mfma_f32_16x16x32_bf16 v[8:11], v[168:171], v[60:63], v[8:11]
    v_cvt_pk_bf16_f32 v177, v2, v3
    s_setprio 0
    ds_read_b128 v[56:59], v223 offset:39296
    s_waitcnt lgkmcnt(9)
    v_mfma_f32_16x16x32_bf16 v[12:15], v[168:171], v[64:67], v[12:15]
    ds_read_b128 v[60:63], v223 offset:39360
    s_waitcnt vmcnt(0)
    v_mfma_f32_16x16x32_bf16 v[4:7], v[172:175], v[68:71], v[4:7]
    ds_read_b128 v[64:67], v222 offset:3200
    s_waitcnt lgkmcnt(9)
    v_mfma_f32_16x16x32_bf16 v[8:11], v[172:175], v[72:75], v[8:11]
    ds_read_b128 v[68:71], v222 offset:3456
    v_mfma_f32_16x16x32_bf16 v[12:15], v[172:175], v[76:79], v[12:15]
    ds_read_b128 v[72:75], v222 offset:3328
    s_waitcnt lgkmcnt(9)
    v_mfma_f32_16x16x32_bf16 v[16:19], v[96:99], v[80:83], 0
    ds_read_b128 v[76:79], v222 offset:3264
    v_mfma_f32_16x16x32_bf16 v[16:19], v[100:103], v[84:87], v[16:19]
    ds_read_b128 v[80:83], v222 offset:3520
    s_waitcnt lgkmcnt(9)
    v_mfma_f32_16x16x32_bf16 v[16:19], v[104:107], v[88:91], v[16:19]
    s_barrier
    s_setprio 3
    ds_read_b128 v[84:87], v222 offset:3392
    v_mfma_f32_16x16x32_bf16 v[16:19], v[108:111], v[92:95], v[16:19]
    v_mul_f32 v4, v4, v204
    ds_read_b128 v[88:91], v222 offset:3712
    s_waitcnt lgkmcnt(9)
    v_mfma_f32_16x16x32_bf16 v[16:19], v[112:115], v[48:51], v[16:19]
    v_mul_f32 v5, v5, v205
    ds_read_b128 v[92:95], v222 offset:3584
    v_mfma_f32_16x16x32_bf16 v[16:19], v[116:119], v[52:55], v[16:19]
    v_mul_f32 v6, v6, v206
    ds_read_b128 v[48:51], v222 offset:3840
    s_waitcnt lgkmcnt(9)
    v_mfma_f32_16x16x32_bf16 v[16:19], v[120:123], v[56:59], v[16:19]
    v_mul_f32 v7, v7, v207
    ds_read_b128 v[52:55], v222 offset:3776
    v_mfma_f32_16x16x32_bf16 v[16:19], v[124:127], v[60:63], v[16:19]
    v_cvt_pk_bf16_f32 v178, v4, v5
    ds_read_b128 v[56:59], v222 offset:3648
    s_waitcnt lgkmcnt(9)
    v_mfma_f32_16x16x32_bf16 v[20:23], v[128:131], v[64:67], 0
    v_cvt_pk_bf16_f32 v179, v6, v7
    ds_read_b128 v[60:63], v222 offset:3904
    v_mfma_f32_16x16x32_bf16 v[24:27], v[128:131], v[68:71], 0
    v_mul_f32 v8, v8, v204
    ds_read_b128 v[64:67], v222 offset:4096
    s_waitcnt lgkmcnt(9)
    v_mfma_f32_16x16x32_bf16 v[28:31], v[128:131], v[72:75], 0
    v_mul_f32 v9, v9, v205
    ds_read_b128 v[68:71], v222 offset:4352
    v_mfma_f32_16x16x32_bf16 v[20:23], v[132:135], v[76:79], v[20:23]
    v_mul_f32 v10, v10, v206
    ds_read_b128 v[72:75], v222 offset:4224
    s_waitcnt lgkmcnt(9)
    v_mfma_f32_16x16x32_bf16 v[24:27], v[132:135], v[80:83], v[24:27]
    v_mul_f32 v11, v11, v207
    ds_read_b128 v[76:79], v222 offset:4160
    v_mfma_f32_16x16x32_bf16 v[28:31], v[132:135], v[84:87], v[28:31]
    v_cvt_pk_bf16_f32 v180, v8, v9
    ds_read_b128 v[80:83], v222 offset:4416
    s_waitcnt lgkmcnt(9)
    v_mfma_f32_16x16x32_bf16 v[20:23], v[136:139], v[88:91], v[20:23]
    v_cvt_pk_bf16_f32 v181, v10, v11
    ds_read_b128 v[84:87], v222 offset:4288
    v_mfma_f32_16x16x32_bf16 v[24:27], v[136:139], v[92:95], v[24:27]
    v_mul_f32 v12, v12, v204
    s_setprio 2
    ds_read_b128 v[88:91], v223 offset:38528
    s_waitcnt lgkmcnt(9)
    v_mfma_f32_16x16x32_bf16 v[28:31], v[136:139], v[48:51], v[28:31]
    v_mul_f32 v13, v13, v205
    ds_read_b128 v[92:95], v223 offset:38784
    v_mfma_f32_16x16x32_bf16 v[20:23], v[140:143], v[52:55], v[20:23]
    v_mul_f32 v14, v14, v206
    ds_read_b128 v[48:51], v223 offset:38656
    s_waitcnt lgkmcnt(9)
    v_mfma_f32_16x16x32_bf16 v[24:27], v[140:143], v[56:59], v[24:27]
    v_mul_f32 v15, v15, v207
    ds_read_b128 v[52:55], v223 offset:38592
    v_mfma_f32_16x16x32_bf16 v[28:31], v[140:143], v[60:63], v[28:31]
    v_cvt_pk_bf16_f32 v182, v12, v13
    ds_read_b128 v[56:59], v223 offset:38848
    s_waitcnt lgkmcnt(9)
    v_mfma_f32_16x16x32_bf16 v[20:23], v[144:147], v[64:67], v[20:23]
    v_cvt_pk_bf16_f32 v183, v14, v15
    ds_read_b128 v[60:63], v223 offset:38720
    v_mfma_f32_16x16x32_bf16 v[24:27], v[144:147], v[68:71], v[24:27]
    ds_write_b64 v254, v[176:177] offset:0
    ds_write_b64 v254, v[178:179] offset:256
    ds_write_b64 v254, v[180:181] offset:512
    ds_write_b64 v254, v[182:183] offset:768
    ds_read_b128 v[64:67], v223 offset:39040
    s_waitcnt lgkmcnt(13)
    v_mfma_f32_16x16x32_bf16 v[28:31], v[144:147], v[72:75], v[28:31]
    v_mul_f32 v208, s63, v16
    ds_read_b128 v[68:71], v223 offset:38912
    v_mfma_f32_16x16x32_bf16 v[20:23], v[148:151], v[76:79], v[20:23]
    v_mul_f32 v209, s63, v17
    ds_read_b128 v[72:75], v223 offset:39168
    s_waitcnt lgkmcnt(13)
    v_mfma_f32_16x16x32_bf16 v[24:27], v[148:151], v[80:83], v[24:27]
    v_mul_f32 v210, s63, v18
    ds_read_b128 v[76:79], v223 offset:39104
    v_mfma_f32_16x16x32_bf16 v[28:31], v[148:151], v[84:87], v[28:31]
    v_mul_f32 v211, s63, v19
    ds_read_b128 v[80:83], v223 offset:38976
    s_waitcnt lgkmcnt(13)
    v_mfma_f32_16x16x32_bf16 v[20:23], v[152:155], v[88:91], v[20:23]
    v_exp_f32 v208, v208
    ds_read_b128 v[84:87], v223 offset:39232
    v_mfma_f32_16x16x32_bf16 v[24:27], v[152:155], v[92:95], v[24:27]
    v_exp_f32 v209, v209
    ds_read_b128 v[88:91], v223 offset:39424
    s_waitcnt lgkmcnt(13)
    v_mfma_f32_16x16x32_bf16 v[28:31], v[152:155], v[48:51], v[28:31]
    s_setprio 1
    ds_read_b128 v[92:95], v223 offset:39680
    v_mfma_f32_16x16x32_bf16 v[20:23], v[156:159], v[52:55], v[20:23]
    v_exp_f32 v210, v210
    ds_read_b128 v[48:51], v223 offset:39552
    s_waitcnt lgkmcnt(13)
    v_mfma_f32_16x16x32_bf16 v[24:27], v[156:159], v[56:59], v[24:27]
    v_exp_f32 v211, v211
    ds_read_b128 v[52:55], v223 offset:39488
    v_mfma_f32_16x16x32_bf16 v[28:31], v[156:159], v[60:63], v[28:31]
    v_add_f32 v208, 1.0, v208
    ds_read_b128 v[56:59], v223 offset:39744
    s_waitcnt lgkmcnt(9)
    v_mfma_f32_16x16x32_bf16 v[20:23], v[160:163], v[64:67], v[20:23]
    v_add_f32 v209, 1.0, v209
    ds_read_b128 v[60:63], v223 offset:39616
    v_mfma_f32_16x16x32_bf16 v[24:27], v[160:163], v[68:71], v[24:27]
    v_add_f32 v210, 1.0, v210
    ds_read_b128 v[64:67], v232 offset:6144
    s_waitcnt lgkmcnt(9)
    v_mfma_f32_16x16x32_bf16 v[28:31], v[160:163], v[72:75], v[28:31]
    v_add_f32 v211, 1.0, v211
    ds_read_b128 v[68:71], v232 offset:6208
    v_mfma_f32_16x16x32_bf16 v[20:23], v[164:167], v[76:79], v[20:23]
    ds_read_b128 v[72:75], v232 offset:7040
    s_waitcnt lgkmcnt(9)
    v_mfma_f32_16x16x32_bf16 v[24:27], v[164:167], v[80:83], v[24:27]
    v_rcp_f32 v208, v208
    ds_read_b128 v[76:79], v232 offset:7104
    v_mfma_f32_16x16x32_bf16 v[28:31], v[164:167], v[84:87], v[28:31]
    v_rcp_f32 v209, v209
    ds_read_b128 v[80:83], v225 offset:0
    s_waitcnt lgkmcnt(9)
    v_mfma_f32_16x16x32_bf16 v[20:23], v[168:171], v[88:91], v[20:23]
    v_rcp_f32 v210, v210
    ds_read_b128 v[84:87], v225 offset:64
    v_mfma_f32_16x16x32_bf16 v[24:27], v[168:171], v[92:95], v[24:27]
    v_rcp_f32 v211, v211
    ds_read_b128 v[88:91], v225 offset:896
    s_waitcnt lgkmcnt(9)
    v_mfma_f32_16x16x32_bf16 v[28:31], v[168:171], v[48:51], v[28:31]
    v_cvt_pk_bf16_f32 v184, v16, v17
    s_setprio 0
    ds_read_b128 v[92:95], v225 offset:960
    v_mfma_f32_16x16x32_bf16 v[20:23], v[172:175], v[52:55], v[20:23]
    v_cvt_pk_bf16_f32 v185, v18, v19
    ds_read_b128 v[48:51], v247 offset:6272
    s_waitcnt lgkmcnt(9)
    v_mfma_f32_16x16x32_bf16 v[24:27], v[172:175], v[56:59], v[24:27]
    ds_read_b128 v[52:55], v232 offset:6528
    v_mfma_f32_16x16x32_bf16 v[28:31], v[172:175], v[60:63], v[28:31]
    ds_read_b128 v[56:59], v247 offset:6336
    s_waitcnt lgkmcnt(9)
    v_mfma_f32_16x16x32_bf16 v[32:35], v[96:99], v[64:67], 0
    ds_read_b128 v[60:63], v232 offset:6592
    v_mfma_f32_16x16x32_bf16 v[32:35], v[100:103], v[68:71], v[32:35]
    ds_read_b128 v[64:67], v247 offset:6784
    s_waitcnt lgkmcnt(9)
    v_mfma_f32_16x16x32_bf16 v[32:35], v[104:107], v[72:75], v[32:35]
    s_barrier
    ds_read_b128 v[192:195], v228 offset:0
    ds_read_b128 v[196:199], v228 offset:1536
    s_setprio 3
    ds_read_b128 v[68:71], v232 offset:6656
    v_mfma_f32_16x16x32_bf16 v[32:35], v[108:111], v[76:79], v[32:35]
    v_mul_f32 v20, v20, v208
    ds_read_b128 v[72:75], v247 offset:6848
    s_waitcnt lgkmcnt(11)
    v_mfma_f32_16x16x32_bf16 v[32:35], v[112:115], v[80:83], v[32:35]
    v_mul_f32 v21, v21, v209
    ds_read_b128 v[76:79], v232 offset:6720
    v_mfma_f32_16x16x32_bf16 v[32:35], v[116:119], v[84:87], v[32:35]
    v_mul_f32 v22, v22, v210
    ds_read_b128 v[80:83], v247 offset:7168
    s_waitcnt lgkmcnt(11)
    v_mfma_f32_16x16x32_bf16 v[32:35], v[120:123], v[88:91], v[32:35]
    v_mul_f32 v23, v23, v211
    ds_read_b128 v[84:87], v232 offset:7424
    v_mfma_f32_16x16x32_bf16 v[32:35], v[124:127], v[92:95], v[32:35]
    v_cvt_pk_bf16_f32 v186, v20, v21
    ds_read_b128 v[88:91], v247 offset:7232
    s_waitcnt lgkmcnt(11)
    v_mfma_f32_16x16x32_bf16 v[36:39], v[128:131], v[48:51], 0
    v_cvt_pk_bf16_f32 v187, v22, v23
    ds_read_b128 v[92:95], v232 offset:7488
    v_mfma_f32_16x16x32_bf16 v[40:43], v[128:131], v[52:55], 0
    v_mul_f32 v24, v24, v208
    ds_read_b128 v[48:51], v248 offset:128
    s_waitcnt lgkmcnt(11)
    v_mfma_f32_16x16x32_bf16 v[36:39], v[132:135], v[56:59], v[36:39]
    v_mul_f32 v25, v25, v209
    s_waitcnt lgkmcnt(8)
    buffer_store_dwordx4 v[192:195], v229, s[12:15], s40 offen sc1
    buffer_store_dwordx4 v[196:199], v229, s[12:15], s41 offen sc1
    ds_read_b128 v[52:55], v225 offset:384
    v_mfma_f32_16x16x32_bf16 v[40:43], v[132:135], v[60:63], v[40:43]
    v_mul_f32 v26, v26, v210
    s_setprio 2
    ds_read_b128 v[56:59], v248 offset:192
    s_waitcnt lgkmcnt(9)
    v_mfma_f32_16x16x32_bf16 v[36:39], v[136:139], v[64:67], v[36:39]
    v_mul_f32 v27, v27, v211
    v_mul_f32 v204, s63, v32
    ds_read_b128 v[60:63], v225 offset:448
    v_mfma_f32_16x16x32_bf16 v[40:43], v[136:139], v[68:71], v[40:43]
    v_cvt_pk_bf16_f32 v188, v24, v25
    v_mul_f32 v205, s63, v33
    ds_read_b128 v[64:67], v248 offset:640
    s_waitcnt lgkmcnt(9)
    v_mfma_f32_16x16x32_bf16 v[36:39], v[140:143], v[72:75], v[36:39]
    v_cvt_pk_bf16_f32 v189, v26, v27
    v_mul_f32 v206, s63, v34
    ds_read_b128 v[68:71], v225 offset:512
    v_mfma_f32_16x16x32_bf16 v[40:43], v[140:143], v[76:79], v[40:43]
    v_mul_f32 v28, v28, v208
    v_mul_f32 v207, s63, v35
    ds_read_b128 v[72:75], v248 offset:704
    s_waitcnt lgkmcnt(9)
    v_mfma_f32_16x16x32_bf16 v[36:39], v[144:147], v[80:83], v[36:39]
    v_mul_f32 v29, v29, v209
    v_exp_f32 v204, v204
    ds_read_b128 v[76:79], v225 offset:576
    v_mfma_f32_16x16x32_bf16 v[40:43], v[144:147], v[84:87], v[40:43]
    v_mul_f32 v30, v30, v210
    v_exp_f32 v205, v205
    ds_read_b128 v[80:83], v248 offset:1024
    s_waitcnt lgkmcnt(9)
    v_mfma_f32_16x16x32_bf16 v[36:39], v[148:151], v[88:91], v[36:39]
    v_mul_f32 v31, v31, v211
    v_exp_f32 v206, v206
    ds_read_b128 v[84:87], v225 offset:1280
    v_mfma_f32_16x16x32_bf16 v[40:43], v[148:151], v[92:95], v[40:43]
    v_cvt_pk_bf16_f32 v190, v28, v29
    v_exp_f32 v207, v207
    ds_read_b128 v[88:91], v248 offset:1088
    s_waitcnt lgkmcnt(9)
    v_mfma_f32_16x16x32_bf16 v[36:39], v[152:155], v[48:51], v[36:39]
    v_cvt_pk_bf16_f32 v191, v30, v31
    v_add_f32 v204, 1.0, v204
    s_setprio 1
    ds_read_b128 v[92:95], v225 offset:1344
    v_mfma_f32_16x16x32_bf16 v[40:43], v[152:155], v[52:55], v[40:43]
    ds_write_b64 v254, v[184:185] offset:3072
    ds_write_b64 v254, v[186:187] offset:3328
    ds_write_b64 v254, v[188:189] offset:3584
    ds_write_b64 v254, v[190:191] offset:3840
    v_add_f32 v205, 1.0, v205
    s_waitcnt lgkmcnt(12)
    v_mfma_f32_16x16x32_bf16 v[36:39], v[156:159], v[56:59], v[36:39]
    v_add_f32 v206, 1.0, v206
    v_mfma_f32_16x16x32_bf16 v[40:43], v[156:159], v[60:63], v[40:43]
    v_add_f32 v207, 1.0, v207
    s_waitcnt lgkmcnt(10)
    v_mfma_f32_16x16x32_bf16 v[36:39], v[160:163], v[64:67], v[36:39]
    v_rcp_f32 v204, v204
    v_mfma_f32_16x16x32_bf16 v[40:43], v[160:163], v[68:71], v[40:43]
    v_rcp_f32 v205, v205
    s_waitcnt lgkmcnt(8)
    v_mfma_f32_16x16x32_bf16 v[36:39], v[164:167], v[72:75], v[36:39]
    v_rcp_f32 v206, v206
    v_mfma_f32_16x16x32_bf16 v[40:43], v[164:167], v[76:79], v[40:43]
    v_rcp_f32 v207, v207
    s_waitcnt lgkmcnt(6)
    v_mfma_f32_16x16x32_bf16 v[36:39], v[168:171], v[80:83], v[36:39]
    v_cvt_pk_bf16_f32 v176, v32, v33
    s_setprio 0
    v_mfma_f32_16x16x32_bf16 v[40:43], v[168:171], v[84:87], v[40:43]
    v_cvt_pk_bf16_f32 v177, v34, v35
    s_waitcnt lgkmcnt(4)
    v_mfma_f32_16x16x32_bf16 v[36:39], v[172:175], v[88:91], v[36:39]
    ds_write_b64 v255, v[176:177] offset:0
    v_mfma_f32_16x16x32_bf16 v[40:43], v[172:175], v[92:95], v[40:43]
    s_nop 5
    v_mul_f32 v36, v36, v204
    v_mul_f32 v37, v37, v205
    v_mul_f32 v38, v38, v206
    v_mul_f32 v39, v39, v207
    v_cvt_pk_bf16_f32 v178, v36, v37
    v_cvt_pk_bf16_f32 v179, v38, v39
    v_mul_f32 v40, v40, v204
    v_mul_f32 v41, v41, v205
    v_mul_f32 v42, v42, v206
    v_mul_f32 v43, v43, v207
    v_cvt_pk_bf16_f32 v180, v40, v41
    v_cvt_pk_bf16_f32 v181, v42, v43
    ds_write_b64 v246, v[178:179] offset:256
    ds_write_b64 v255, v[180:181] offset:512
    s_waitcnt lgkmcnt(0)
    s_barrier
    ds_read_b128 v[192:195], v228 offset:3072
    ds_read_b128 v[196:199], v228 offset:4608
    ds_read_b128 v[200:203], v249
    s_waitcnt lgkmcnt(1)
    buffer_store_dwordx4 v[192:195], v229, s[12:15], s42 offen sc1
    buffer_store_dwordx4 v[196:199], v229, s[12:15], s43 offen sc1
K2_LASTROW:
    s_add_u32 s59, s20, 32
    s_cmp_ge_u32 s59, s22
    s_cbranch_scc1 K2_FIN
    s_waitcnt lgkmcnt(0)
    buffer_store_dwordx4 v[200:203], v229, s[12:15], s44 offen sc1
K2_FIN:
    s_branch K2_END
K2_MULTI:
    ds_read_b128 v[48:51], v222 offset:0
    ds_read_b128 v[52:55], v222 offset:64
    ds_read_b128 v[56:59], v222 offset:896
    ds_read_b128 v[60:63], v222 offset:960
    ds_read_b128 v[64:67], v223 offset:0
    ds_read_b128 v[68:71], v223 offset:64
    ds_read_b128 v[72:75], v223 offset:896
    ds_read_b128 v[76:79], v223 offset:960
    ds_read_b128 v[80:83], v222 offset:128
    ds_read_b128 v[84:87], v222 offset:384
    ds_read_b128 v[88:91], v222 offset:256
    s_waitcnt vmcnt(19) lgkmcnt(9)
    v_mfma_f32_16x16x32_bf16 v[0:3], v[96:99], v[48:51], 0
    ds_read_b128 v[92:95], v222 offset:192
    s_waitcnt vmcnt(18)
    v_mfma_f32_16x16x32_bf16 v[0:3], v[100:103], v[52:55], v[0:3]
    ds_read_b128 v[48:51], v222 offset:448
    s_waitcnt vmcnt(17) lgkmcnt(9)
    v_mfma_f32_16x16x32_bf16 v[0:3], v[104:107], v[56:59], v[0:3]
    ds_read_b128 v[52:55], v222 offset:320
    s_waitcnt vmcnt(16)
    v_mfma_f32_16x16x32_bf16 v[0:3], v[108:111], v[60:63], v[0:3]
    ds_read_b128 v[56:59], v222 offset:640
    s_waitcnt vmcnt(15) lgkmcnt(9)
    v_mfma_f32_16x16x32_bf16 v[0:3], v[112:115], v[64:67], v[0:3]
    ds_read_b128 v[60:63], v222 offset:512
    s_waitcnt vmcnt(14)
    v_mfma_f32_16x16x32_bf16 v[0:3], v[116:119], v[68:71], v[0:3]
    ds_read_b128 v[64:67], v222 offset:768
    s_waitcnt vmcnt(13) lgkmcnt(9)
    v_mfma_f32_16x16x32_bf16 v[0:3], v[120:123], v[72:75], v[0:3]
    ds_read_b128 v[68:71], v222 offset:704
    s_waitcnt vmcnt(12)
    v_mfma_f32_16x16x32_bf16 v[0:3], v[124:127], v[76:79], v[0:3]
    ds_read_b128 v[72:75], v222 offset:576
    s_waitcnt vmcnt(11) lgkmcnt(9)
    v_mfma_f32_16x16x32_bf16 v[4:7], v[128:131], v[80:83], 0
    ds_read_b128 v[76:79], v222 offset:832
    v_mfma_f32_16x16x32_bf16 v[8:11], v[128:131], v[84:87], 0
    ds_read_b128 v[80:83], v222 offset:1024
    s_waitcnt lgkmcnt(9)
    v_mfma_f32_16x16x32_bf16 v[12:15], v[128:131], v[88:91], 0
    ds_read_b128 v[84:87], v222 offset:1280
    s_waitcnt vmcnt(10)
    v_mfma_f32_16x16x32_bf16 v[4:7], v[132:135], v[92:95], v[4:7]
    ds_read_b128 v[88:91], v222 offset:1152
    s_waitcnt lgkmcnt(9)
    v_mfma_f32_16x16x32_bf16 v[8:11], v[132:135], v[48:51], v[8:11]
    ds_read_b128 v[92:95], v222 offset:1088
    v_mfma_f32_16x16x32_bf16 v[12:15], v[132:135], v[52:55], v[12:15]
    ds_read_b128 v[48:51], v222 offset:1344
    s_waitcnt vmcnt(9) lgkmcnt(9)
    v_mfma_f32_16x16x32_bf16 v[4:7], v[136:139], v[56:59], v[4:7]
    ds_read_b128 v[52:55], v222 offset:1216
    v_mfma_f32_16x16x32_bf16 v[8:11], v[136:139], v[60:63], v[8:11]
    ds_read_b128 v[56:59], v223 offset:128
    s_waitcnt lgkmcnt(9)
    v_mfma_f32_16x16x32_bf16 v[12:15], v[136:139], v[64:67], v[12:15]
    ds_read_b128 v[60:63], v223 offset:384
    s_waitcnt vmcnt(8)
    v_mfma_f32_16x16x32_bf16 v[4:7], v[140:143], v[68:71], v[4:7]
    ds_read_b128 v[64:67], v223 offset:256
    s_waitcnt lgkmcnt(9)
    v_mfma_f32_16x16x32_bf16 v[8:11], v[140:143], v[72:75], v[8:11]
    ds_read_b128 v[68:71], v223 offset:192
    v_mfma_f32_16x16x32_bf16 v[12:15], v[140:143], v[76:79], v[12:15]
    ds_read_b128 v[72:75], v223 offset:448
    s_waitcnt vmcnt(7) lgkmcnt(9)
    v_mfma_f32_16x16x32_bf16 v[4:7], v[144:147], v[80:83], v[4:7]
    ds_read_b128 v[76:79], v223 offset:320
    v_mfma_f32_16x16x32_bf16 v[8:11], v[144:147], v[84:87], v[8:11]
    ds_read_b128 v[80:83], v223 offset:640
    s_waitcnt lgkmcnt(9)
    v_mfma_f32_16x16x32_bf16 v[12:15], v[144:147], v[88:91], v[12:15]
    ds_read_b128 v[84:87], v223 offset:512
    s_waitcnt vmcnt(6)
    v_mfma_f32_16x16x32_bf16 v[4:7], v[148:151], v[92:95], v[4:7]
    ds_read_b128 v[88:91], v223 offset:768
    s_waitcnt lgkmcnt(9)
    v_mfma_f32_16x16x32_bf16 v[8:11], v[148:151], v[48:51], v[8:11]
    ds_read_b128 v[92:95], v223 offset:704
    v_mfma_f32_16x16x32_bf16 v[12:15], v[148:151], v[52:55], v[12:15]
    ds_read_b128 v[48:51], v223 offset:576
    s_waitcnt vmcnt(5) lgkmcnt(9)
    v_mfma_f32_16x16x32_bf16 v[4:7], v[152:155], v[56:59], v[4:7]
    ds_read_b128 v[52:55], v223 offset:832
    v_mfma_f32_16x16x32_bf16 v[8:11], v[152:155], v[60:63], v[8:11]
    ds_read_b128 v[56:59], v223 offset:1024
    s_waitcnt lgkmcnt(9)
    v_mfma_f32_16x16x32_bf16 v[12:15], v[152:155], v[64:67], v[12:15]
    ds_read_b128 v[60:63], v223 offset:1280
    s_waitcnt vmcnt(4)
    v_mfma_f32_16x16x32_bf16 v[4:7], v[156:159], v[68:71], v[4:7]
    ds_read_b128 v[64:67], v223 offset:1152
    s_waitcnt lgkmcnt(9)
    v_mfma_f32_16x16x32_bf16 v[8:11], v[156:159], v[72:75], v[8:11]
    ds_read_b128 v[68:71], v223 offset:1088
    v_mfma_f32_16x16x32_bf16 v[12:15], v[156:159], v[76:79], v[12:15]
    ds_read_b128 v[72:75], v223 offset:1344
    s_waitcnt vmcnt(3) lgkmcnt(9)
    v_mfma_f32_16x16x32_bf16 v[4:7], v[160:163], v[80:83], v[4:7]
    ds_read_b128 v[76:79], v223 offset:1216
    v_mfma_f32_16x16x32_bf16 v[8:11], v[160:163], v[84:87], v[8:11]
    ds_read_b128 v[80:83], v222 offset:3072
    s_waitcnt lgkmcnt(9)
    v_mfma_f32_16x16x32_bf16 v[12:15], v[160:163], v[88:91], v[12:15]
    ds_read_b128 v[84:87], v222 offset:3136
    s_waitcnt vmcnt(2)
    v_mfma_f32_16x16x32_bf16 v[4:7], v[164:167], v[92:95], v[4:7]
    ds_read_b128 v[88:91], v222 offset:3968
    s_waitcnt lgkmcnt(9)
    v_mfma_f32_16x16x32_bf16 v[8:11], v[164:167], v[48:51], v[8:11]
    ds_read_b128 v[92:95], v222 offset:4032
    v_mfma_f32_16x16x32_bf16 v[12:15], v[164:167], v[52:55], v[12:15]
    ds_read_b128 v[48:51], v223 offset:38400
    s_waitcnt vmcnt(1) lgkmcnt(9)
    v_mfma_f32_16x16x32_bf16 v[4:7], v[168:171], v[56:59], v[4:7]
    ds_read_b128 v[52:55], v223 offset:38464
    v_mfma_f32_16x16x32_bf16 v[8:11], v[168:171], v[60:63], v[8:11]
    ds_read_b128 v[56:59], v223 offset:39296
    s_waitcnt lgkmcnt(9)
    v_mfma_f32_16x16x32_bf16 v[12:15], v[168:171], v[64:67], v[12:15]
    ds_read_b128 v[60:63], v223 offset:39360
    s_waitcnt vmcnt(0)
    v_mfma_f32_16x16x32_bf16 v[4:7], v[172:175], v[68:71], v[4:7]
    ds_read_b128 v[64:67], v222 offset:3200
    s_waitcnt lgkmcnt(9)
    v_mfma_f32_16x16x32_bf16 v[8:11], v[172:175], v[72:75], v[8:11]
    ds_read_b128 v[68:71], v222 offset:3456
    v_mfma_f32_16x16x32_bf16 v[12:15], v[172:175], v[76:79], v[12:15]
    ds_read_b128 v[72:75], v222 offset:3328
    s_waitcnt lgkmcnt(9)
    v_mfma_f32_16x16x32_bf16 v[16:19], v[96:99], v[80:83], 0
    ds_read_b128 v[76:79], v222 offset:3264
    v_mfma_f32_16x16x32_bf16 v[16:19], v[100:103], v[84:87], v[16:19]
    ds_read_b128 v[80:83], v222 offset:3520
    s_waitcnt lgkmcnt(9)
    v_mfma_f32_16x16x32_bf16 v[16:19], v[104:107], v[88:91], v[16:19]
    ds_read_b128 v[84:87], v222 offset:3392
    v_mfma_f32_16x16x32_bf16 v[16:19], v[108:111], v[92:95], v[16:19]
    ds_read_b128 v[88:91], v222 offset:3712
    s_waitcnt lgkmcnt(9)
    v_mfma_f32_16x16x32_bf16 v[16:19], v[112:115], v[48:51], v[16:19]
    ds_read_b128 v[92:95], v222 offset:3584
    v_mfma_f32_16x16x32_bf16 v[16:19], v[116:119], v[52:55], v[16:19]
    ds_read_b128 v[48:51], v222 offset:3840
    s_waitcnt lgkmcnt(9)
    v_mfma_f32_16x16x32_bf16 v[16:19], v[120:123], v[56:59], v[16:19]
    ds_read_b128 v[52:55], v222 offset:3776
    v_mfma_f32_16x16x32_bf16 v[16:19], v[124:127], v[60:63], v[16:19]
    ds_read_b128 v[56:59], v222 offset:3648
    s_waitcnt lgkmcnt(9)
    v_mfma_f32_16x16x32_bf16 v[20:23], v[128:131], v[64:67], 0
    ds_read_b128 v[60:63], v222 offset:3904
    v_mfma_f32_16x16x32_bf16 v[24:27], v[128:131], v[68:71], 0
    ds_read_b128 v[64:67], v222 offset:4096
    s_waitcnt lgkmcnt(9)
    v_mfma_f32_16x16x32_bf16 v[28:31], v[128:131], v[72:75], 0
    ds_read_b128 v[68:71], v222 offset:4352
    v_mfma_f32_16x16x32_bf16 v[20:23], v[132:135], v[76:79], v[20:23]
    ds_read_b128 v[72:75], v222 offset:4224
    s_waitcnt lgkmcnt(9)
    v_mfma_f32_16x16x32_bf16 v[24:27], v[132:135], v[80:83], v[24:27]
    ds_read_b128 v[76:79], v222 offset:4160
    v_mfma_f32_16x16x32_bf16 v[28:31], v[132:135], v[84:87], v[28:31]
    ds_read_b128 v[80:83], v222 offset:4416
    s_waitcnt lgkmcnt(9)
    v_mfma_f32_16x16x32_bf16 v[20:23], v[136:139], v[88:91], v[20:23]
    ds_read_b128 v[84:87], v222 offset:4288
    v_mfma_f32_16x16x32_bf16 v[24:27], v[136:139], v[92:95], v[24:27]
    ds_read_b128 v[88:91], v223 offset:38528
    s_waitcnt lgkmcnt(9)
    v_mfma_f32_16x16x32_bf16 v[28:31], v[136:139], v[48:51], v[28:31]
    ds_read_b128 v[92:95], v223 offset:38784
    v_mfma_f32_16x16x32_bf16 v[20:23], v[140:143], v[52:55], v[20:23]
    ds_read_b128 v[48:51], v223 offset:38656
    s_waitcnt lgkmcnt(9)
    v_mfma_f32_16x16x32_bf16 v[24:27], v[140:143], v[56:59], v[24:27]
    ds_read_b128 v[52:55], v223 offset:38592
    v_mfma_f32_16x16x32_bf16 v[28:31], v[140:143], v[60:63], v[28:31]
    ds_read_b128 v[56:59], v223 offset:38848
    s_waitcnt lgkmcnt(9)
    v_mfma_f32_16x16x32_bf16 v[20:23], v[144:147], v[64:67], v[20:23]
    ds_read_b128 v[60:63], v223 offset:38720
    v_mfma_f32_16x16x32_bf16 v[24:27], v[144:147], v[68:71], v[24:27]
    ds_read_b128 v[64:67], v223 offset:39040
    s_waitcnt lgkmcnt(9)
    v_mfma_f32_16x16x32_bf16 v[28:31], v[144:147], v[72:75], v[28:31]
    ds_read_b128 v[68:71], v223 offset:38912
    v_mfma_f32_16x16x32_bf16 v[20:23], v[148:151], v[76:79], v[20:23]
    ds_read_b128 v[72:75], v223 offset:39168
    s_waitcnt lgkmcnt(9)
    v_mfma_f32_16x16x32_bf16 v[24:27], v[148:151], v[80:83], v[24:27]
    ds_read_b128 v[76:79], v223 offset:39104
    v_mfma_f32_16x16x32_bf16 v[28:31], v[148:151], v[84:87], v[28:31]
    ds_read_b128 v[80:83], v223 offset:38976
    s_waitcnt lgkmcnt(9)
    v_mfma_f32_16x16x32_bf16 v[20:23], v[152:155], v[88:91], v[20:23]
    ds_read_b128 v[84:87], v223 offset:39232
    v_mfma_f32_16x16x32_bf16 v[24:27], v[152:155], v[92:95], v[24:27]
    ds_read_b128 v[88:91], v223 offset:39424
    s_waitcnt lgkmcnt(9)
    v_mfma_f32_16x16x32_bf16 v[28:31], v[152:155], v[48:51], v[28:31]
    ds_read_b128 v[92:95], v223 offset:39680
    v_mfma_f32_16x16x32_bf16 v[20:23], v[156:159], v[52:55], v[20:23]
    ds_read_b128 v[48:51], v223 offset:39552
    s_waitcnt lgkmcnt(9)
    v_mfma_f32_16x16x32_bf16 v[24:27], v[156:159], v[56:59], v[24:27]
    ds_read_b128 v[52:55], v223 offset:39488
    v_mfma_f32_16x16x32_bf16 v[28:31], v[156:159], v[60:63], v[28:31]
    ds_read_b128 v[56:59], v223 offset:39744
    s_waitcnt lgkmcnt(9)
    v_mfma_f32_16x16x32_bf16 v[20:23], v[160:163], v[64:67], v[20:23]
    ds_read_b128 v[60:63], v223 offset:39616
    v_mfma_f32_16x16x32_bf16 v[24:27], v[160:163], v[68:71], v[24:27]
    ds_read_b128 v[64:67], v232 offset:6144
    s_waitcnt lgkmcnt(9)
    v_mfma_f32_16x16x32_bf16 v[28:31], v[160:163], v[72:75], v[28:31]
    ds_read_b128 v[68:71], v232 offset:6208
    v_mfma_f32_16x16x32_bf16 v[20:23], v[164:167], v[76:79], v[20:23]
    ds_read_b128 v[72:75], v232 offset:7040
    s_waitcnt lgkmcnt(9)
    v_mfma_f32_16x16x32_bf16 v[24:27], v[164:167], v[80:83], v[24:27]
    ds_read_b128 v[76:79], v232 offset:7104
    v_mfma_f32_16x16x32_bf16 v[28:31], v[164:167], v[84:87], v[28:31]
    ds_read_b128 v[80:83], v225 offset:0
    s_waitcnt lgkmcnt(9)
    v_mfma_f32_16x16x32_bf16 v[20:23], v[168:171], v[88:91], v[20:23]
    ds_read_b128 v[84:87], v225 offset:64
    v_mfma_f32_16x16x32_bf16 v[24:27], v[168:171], v[92:95], v[24:27]
    ds_read_b128 v[88:91], v225 offset:896
    s_waitcnt lgkmcnt(9)
    v_mfma_f32_16x16x32_bf16 v[28:31], v[168:171], v[48:51], v[28:31]
    ds_read_b128 v[92:95], v225 offset:960
    v_mfma_f32_16x16x32_bf16 v[20:23], v[172:175], v[52:55], v[20:23]
    ds_read_b128 v[48:51], v247 offset:6272
    s_waitcnt lgkmcnt(9)
    v_mfma_f32_16x16x32_bf16 v[24:27], v[172:175], v[56:59], v[24:27]
    ds_read_b128 v[52:55], v232 offset:6528
    v_mfma_f32_16x16x32_bf16 v[28:31], v[172:175], v[60:63], v[28:31]
    ds_read_b128 v[56:59], v247 offset:6336
    s_waitcnt lgkmcnt(9)
    v_mfma_f32_16x16x32_bf16 v[32:35], v[96:99], v[64:67], 0
    ds_read_b128 v[60:63], v232 offset:6592
    v_mfma_f32_16x16x32_bf16 v[32:35], v[100:103], v[68:71], v[32:35]
    ds_read_b128 v[64:67], v247 offset:6784
    s_waitcnt lgkmcnt(9)
    v_mfma_f32_16x16x32_bf16 v[32:35], v[104:107], v[72:75], v[32:35]
    ds_read_b128 v[68:71], v232 offset:6656
    v_mfma_f32_16x16x32_bf16 v[32:35], v[108:111], v[76:79], v[32:35]
    ds_read_b128 v[72:75], v247 offset:6848
    s_waitcnt lgkmcnt(9)
    v_mfma_f32_16x16x32_bf16 v[32:35], v[112:115], v[80:83], v[32:35]
    ds_read_b128 v[76:79], v232 offset:6720
    v_mfma_f32_16x16x32_bf16 v[32:35], v[116:119], v[84:87], v[32:35]
    ds_read_b128 v[80:83], v247 offset:7168
    s_waitcnt lgkmcnt(9)
    v_mfma_f32_16x16x32_bf16 v[32:35], v[120:123], v[88:91], v[32:35]
    ds_read_b128 v[84:87], v232 offset:7424
    v_mfma_f32_16x16x32_bf16 v[32:35], v[124:127], v[92:95], v[32:35]
    ds_read_b128 v[88:91], v247 offset:7232
    s_waitcnt lgkmcnt(9)
    v_mfma_f32_16x16x32_bf16 v[36:39], v[128:131], v[48:51], 0
    ds_read_b128 v[92:95], v232 offset:7488
    v_mfma_f32_16x16x32_bf16 v[40:43], v[128:131], v[52:55], 0
    ds_read_b128 v[48:51], v248 offset:128
    s_waitcnt lgkmcnt(9)
    v_mfma_f32_16x16x32_bf16 v[36:39], v[132:135], v[56:59], v[36:39]
    ds_read_b128 v[52:55], v225 offset:384
    v_mfma_f32_16x16x32_bf16 v[40:43], v[132:135], v[60:63], v[40:43]
    ds_read_b128 v[56:59], v248 offset:192
    s_waitcnt lgkmcnt(9)
    v_mfma_f32_16x16x32_bf16 v[36:39], v[136:139], v[64:67], v[36:39]
    ds_read_b128 v[60:63], v225 offset:448
    v_mfma_f32_16x16x32_bf16 v[40:43], v[136:139], v[68:71], v[40:43]
    ds_read_b128 v[64:67], v248 offset:640
    s_waitcnt lgkmcnt(9)
    v_mfma_f32_16x16x32_bf16 v[36:39], v[140:143], v[72:75], v[36:39]
    ds_read_b128 v[68:71], v225 offset:512
    v_mfma_f32_16x16x32_bf16 v[40:43], v[140:143], v[76:79], v[40:43]
    ds_read_b128 v[72:75], v248 offset:704
    s_waitcnt lgkmcnt(9)
    v_mfma_f32_16x16x32_bf16 v[36:39], v[144:147], v[80:83], v[36:39]
    ds_read_b128 v[76:79], v225 offset:576
    v_mfma_f32_16x16x32_bf16 v[40:43], v[144:147], v[84:87], v[40:43]
    ds_read_b128 v[80:83], v248 offset:1024
    s_waitcnt lgkmcnt(9)
    v_mfma_f32_16x16x32_bf16 v[36:39], v[148:151], v[88:91], v[36:39]
    ds_read_b128 v[84:87], v225 offset:1280
    v_mfma_f32_16x16x32_bf16 v[40:43], v[148:151], v[92:95], v[40:43]
    ds_read_b128 v[88:91], v248 offset:1088
    s_waitcnt lgkmcnt(9)
    v_mfma_f32_16x16x32_bf16 v[36:39], v[152:155], v[48:51], v[36:39]
    ds_read_b128 v[92:95], v225 offset:1344
    v_mfma_f32_16x16x32_bf16 v[40:43], v[152:155], v[52:55], v[40:43]
    s_waitcnt lgkmcnt(8)
    v_mfma_f32_16x16x32_bf16 v[36:39], v[156:159], v[56:59], v[36:39]
    v_mfma_f32_16x16x32_bf16 v[40:43], v[156:159], v[60:63], v[40:43]
    s_waitcnt lgkmcnt(6)
    v_mfma_f32_16x16x32_bf16 v[36:39], v[160:163], v[64:67], v[36:39]
    v_mfma_f32_16x16x32_bf16 v[40:43], v[160:163], v[68:71], v[40:43]
    s_waitcnt lgkmcnt(4)
    v_mfma_f32_16x16x32_bf16 v[36:39], v[164:167], v[72:75], v[36:39]
    v_mfma_f32_16x16x32_bf16 v[40:43], v[164:167], v[76:79], v[40:43]
    s_waitcnt lgkmcnt(2)
    v_mfma_f32_16x16x32_bf16 v[36:39], v[168:171], v[80:83], v[36:39]
    v_mfma_f32_16x16x32_bf16 v[40:43], v[168:171], v[84:87], v[40:43]
    s_waitcnt lgkmcnt(0)
    v_mfma_f32_16x16x32_bf16 v[36:39], v[172:175], v[88:91], v[36:39]
    v_mfma_f32_16x16x32_bf16 v[40:43], v[172:175], v[92:95], v[40:43]
    s_lshl_b32 s60, s54, 9
    s_lshl_b32 s61, s20, 6
    s_add_u32 s60, s60, s61
    s_mul_i32 s60, s60, 192
    s_add_u32 s60, s60, 10485760
    v_mul_u32_u24 v227, 96, v252
    s_cmp_lg_u32 s28, 0
    s_cbranch_scc1 K2_NOACC
    buffer_load_dwordx4 v[48:51], v227, s[8:11], s60 offen offset:0
    buffer_load_dwordx4 v[52:55], v227, s[8:11], s60 offen offset:16
    buffer_load_dwordx4 v[56:59], v227, s[8:11], s60 offen offset:32
    buffer_load_dwordx4 v[60:63], v227, s[8:11], s60 offen offset:48
    buffer_load_dwordx4 v[64:67], v227, s[8:11], s60 offen offset:64
    buffer_load_dwordx4 v[68:71], v227, s[8:11], s60 offen offset:80
    buffer_load_dwordx4 v[72:75], v227, s[8:11], s60 offen offset:96
    buffer_load_dwordx4 v[76:79], v227, s[8:11], s60 offen offset:112
    buffer_load_dwordx4 v[80:83], v227, s[8:11], s60 offen offset:128
    buffer_load_dwordx4 v[84:87], v227, s[8:11], s60 offen offset:144
    buffer_load_dwordx4 v[88:91], v227, s[8:11], s60 offen offset:160
    s_waitcnt vmcnt(0)
    v_add_f32 v0, v0, v48
    v_add_f32 v1, v1, v49
    v_add_f32 v2, v2, v50
    v_add_f32 v3, v3, v51
    v_add_f32 v4, v4, v52
    v_add_f32 v5, v5, v53
    v_add_f32 v6, v6, v54
    v_add_f32 v7, v7, v55
    v_add_f32 v8, v8, v56
    v_add_f32 v9, v9, v57
    v_add_f32 v10, v10, v58
    v_add_f32 v11, v11, v59
    v_add_f32 v12, v12, v60
    v_add_f32 v13, v13, v61
    v_add_f32 v14, v14, v62
    v_add_f32 v15, v15, v63
    v_add_f32 v16, v16, v64
    v_add_f32 v17, v17, v65
    v_add_f32 v18, v18, v66
    v_add_f32 v19, v19, v67
    v_add_f32 v20, v20, v68
    v_add_f32 v21, v21, v69
    v_add_f32 v22, v22, v70
    v_add_f32 v23, v23, v71
    v_add_f32 v24, v24, v72
    v_add_f32 v25, v25, v73
    v_add_f32 v26, v26, v74
    v_add_f32 v27, v27, v75
    v_add_f32 v28, v28, v76
    v_add_f32 v29, v29, v77
    v_add_f32 v30, v30, v78
    v_add_f32 v31, v31, v79
    v_add_f32 v32, v32, v80
    v_add_f32 v33, v33, v81
    v_add_f32 v34, v34, v82
    v_add_f32 v35, v35, v83
    v_add_f32 v36, v36, v84
    v_add_f32 v37, v37, v85
    v_add_f32 v38, v38, v86
    v_add_f32 v39, v39, v87
    v_add_f32 v40, v40, v88
    v_add_f32 v41, v41, v89
    v_add_f32 v42, v42, v90
    v_add_f32 v43, v43, v91
K2_NOACC:
    s_barrier
    s_cmp_eq_u32 s55, 0
    s_cbranch_scc1 K2_SPILL
    s_bfe_u32 s60, s20, 0x10002
    s_lshl_b32 s60, s60, 4
    s_add_u32 s59, s59, s60
    v_add_u32 v228, s59, v229
    s_mul_i32 s60, s20, 2400
    s_add_u32 s60, s60, 65536
    v_add_u32 v249, s60, v229
    s_mov_b32 s63, 0xbfb8aa3b
    s_add_u32 s40, s20, s21
    s_lshl_b32 s40, s40, 10
    s_add_u32 s41, s40, 8192
    s_add_u32 s42, s40, 16384
    s_add_u32 s43, s40, 24576
    s_add_u32 s44, s40, 32768
    v_mul_f32 v204, s63, v0
    v_mul_f32 v205, s63, v1
    v_mul_f32 v206, s63, v2
    v_mul_f32 v207, s63, v3
    v_exp_f32 v204, v204
    v_exp_f32 v205, v205
    v_exp_f32 v206, v206
    v_exp_f32 v207, v207
    v_add_f32 v204, 1.0, v204
    v_add_f32 v205, 1.0, v205
    v_add_f32 v206, 1.0, v206
    v_add_f32 v207, 1.0, v207
    v_rcp_f32 v204, v204
    v_rcp_f32 v205, v205
    v_rcp_f32 v206, v206
    v_rcp_f32 v207, v207
    v_cvt_pk_bf16_f32 v176, v0, v1
    v_cvt_pk_bf16_f32 v177, v2, v3
    v_mul_f32 v4, v4, v204
    v_mul_f32 v5, v5, v205
    v_mul_f32 v6, v6, v206
    v_mul_f32 v7, v7, v207
    v_cvt_pk_bf16_f32 v178, v4, v5
    v_cvt_pk_bf16_f32 v179, v6, v7
    v_mul_f32 v8, v8, v204
    v_mul_f32 v9, v9, v205
    v_mul_f32 v10, v10, v206
    v_mul_f32 v11, v11, v207
    v_cvt_pk_bf16_f32 v180, v8, v9
    v_cvt_pk_bf16_f32 v181, v10, v11
    v_mul_f32 v12, v12, v204
    v_mul_f32 v13, v13, v205
    v_mul_f32 v14, v14, v206
    v_mul_f32 v15, v15, v207
    v_cvt_pk_bf16_f32 v182, v12, v13
    v_cvt_pk_bf16_f32 v183, v14, v15
    ds_write_b64 v254, v[176:177] offset:0
    ds_write_b64 v254, v[178:179] offset:256
    ds_write_b64 v254, v[180:181] offset:512
    ds_write_b64 v254, v[182:183] offset:768
    s_waitcnt lgkmcnt(0)
    s_barrier
    ds_read_b128 v[192:195], v228 offset:0
    ds_read_b128 v[196:199], v228 offset:1536
    s_waitcnt lgkmcnt(0)
    buffer_store_dwordx4 v[192:195], v229, s[12:15], s40 offen sc1
    buffer_store_dwordx4 v[196:199], v229, s[12:15], s41 offen sc1
    v_mul_f32 v208, s63, v16
    v_mul_f32 v209, s63, v17
    v_mul_f32 v210, s63, v18
    v_mul_f32 v211, s63, v19
    v_exp_f32 v208, v208
    v_exp_f32 v209, v209
    v_exp_f32 v210, v210
    v_exp_f32 v211, v211
    v_add_f32 v208, 1.0, v208
    v_add_f32 v209, 1.0, v209
    v_add_f32 v210, 1.0, v210
    v_add_f32 v211, 1.0, v211
    v_rcp_f32 v208, v208
    v_rcp_f32 v209, v209
    v_rcp_f32 v210, v210
    v_rcp_f32 v211, v211
    v_cvt_pk_bf16_f32 v184, v16, v17
    v_cvt_pk_bf16_f32 v185, v18, v19
    v_mul_f32 v20, v20, v208
    v_mul_f32 v21, v21, v209
    v_mul_f32 v22, v22, v210
    v_mul_f32 v23, v23, v211
    v_cvt_pk_bf16_f32 v186, v20, v21
    v_cvt_pk_bf16_f32 v187, v22, v23
    v_mul_f32 v24, v24, v208
    v_mul_f32 v25, v25, v209
    v_mul_f32 v26, v26, v210
    v_mul_f32 v27, v27, v211
    v_cvt_pk_bf16_f32 v188, v24, v25
    v_cvt_pk_bf16_f32 v189, v26, v27
    v_mul_f32 v28, v28, v208
    v_mul_f32 v29, v29, v209
    v_mul_f32 v30, v30, v210
    v_mul_f32 v31, v31, v211
    v_cvt_pk_bf16_f32 v190, v28, v29
    v_cvt_pk_bf16_f32 v191, v30, v31
    ds_write_b64 v254, v[184:185] offset:3072
    ds_write_b64 v254, v[186:187] offset:3328
    ds_write_b64 v254, v[188:189] offset:3584
    ds_write_b64 v254, v[190:191] offset:3840
    s_waitcnt lgkmcnt(0)
    s_barrier
    ds_read_b128 v[192:195], v228 offset:3072
    ds_read_b128 v[196:199], v228 offset:4608
    s_waitcnt lgkmcnt(0)
    buffer_store_dwordx4 v[192:195], v229, s[12:15], s42 offen sc1
    buffer_store_dwordx4 v[196:199], v229, s[12:15], s43 offen sc1
    v_mul_f32 v204, s63, v32
    v_mul_f32 v205, s63, v33
    v_mul_f32 v206, s63, v34
    v_mul_f32 v207, s63, v35
    v_exp_f32 v204, v204
    v_exp_f32 v205, v205
    v_exp_f32 v206, v206
    v_exp_f32 v207, v207
    v_add_f32 v204, 1.0, v204
    v_add_f32 v205, 1.0, v205
    v_add_f32 v206, 1.0, v206
    v_add_f32 v207, 1.0, v207
    v_rcp_f32 v204, v204
    v_rcp_f32 v205, v205
    v_rcp_f32 v206, v206
    v_rcp_f32 v207, v207
    v_cvt_pk_bf16_f32 v176, v32, v33
    v_cvt_pk_bf16_f32 v177, v34, v35
    v_mul_f32 v36, v36, v204
    v_mul_f32 v37, v37, v205
    v_mul_f32 v38, v38, v206
    v_mul_f32 v39, v39, v207
    v_cvt_pk_bf16_f32 v178, v36, v37
    v_cvt_pk_bf16_f32 v179, v38, v39
    v_mul_f32 v40, v40, v204
    v_mul_f32 v41, v41, v205
    v_mul_f32 v42, v42, v206
    v_mul_f32 v43, v43, v207
    v_cvt_pk_bf16_f32 v180, v40, v41
    v_cvt_pk_bf16_f32 v181, v42, v43
    ds_write_b64 v255, v[176:177] offset:0
    ds_write_b64 v246, v[178:179] offset:256
    ds_write_b64 v255, v[180:181] offset:512
    s_waitcnt lgkmcnt(0)
    s_barrier
    ds_read_b128 v[200:203], v249
    s_branch K2_LASTROW
K2_SPILL:
    buffer_store_dwordx4 v[0:3], v227, s[8:11], s60 offen offset:0
    buffer_store_dwordx4 v[4:7], v227, s[8:11], s60 offen offset:16
    buffer_store_dwordx4 v[8:11], v227, s[8:11], s60 offen offset:32
    buffer_store_dwordx4 v[12:15], v227, s[8:11], s60 offen offset:48
    buffer_store_dwordx4 v[16:19], v227, s[8:11], s60 offen offset:64
    buffer_store_dwordx4 v[20:23], v227, s[8:11], s60 offen offset:80
    buffer_store_dwordx4 v[24:27], v227, s[8:11], s60 offen offset:96
    buffer_store_dwordx4 v[28:31], v227, s[8:11], s60 offen offset:112
    buffer_store_dwordx4 v[32:35], v227, s[8:11], s60 offen offset:128
    buffer_store_dwordx4 v[36:39], v227, s[8:11], s60 offen offset:144
    buffer_store_dwordx4 v[40:43], v227, s[8:11], s60 offen offset:160
    s_mov_b32 s28, 0
    s_waitcnt vmcnt(0)
    s_cmp_lt_u32 s24, s25
    s_cbranch_scc1 K2_LOAD
    s_add_u32 s23, s23, 20
    s_branch K2_WINDOW
K2_END:
    s_endpgm
.section .rodata,"a"
.p2align 6
.amdhsa_kernel standalone__tensor_product_equiv_equiformer__graph_kernel
  .amdhsa_next_free_vgpr 256
  .amdhsa_next_free_sgpr 102
  .amdhsa_accum_offset 256
  .amdhsa_group_segment_fixed_size 0
  .amdhsa_kernarg_size 96
  .amdhsa_user_sgpr_count 2
  .amdhsa_user_sgpr_kernarg_segment_ptr 1
  .amdhsa_system_sgpr_workgroup_id_x 1
  .amdhsa_float_denorm_mode_32 3
.end_amdhsa_kernel
```

```asm
; @launch grid=(256,1,1) block=(512,1,1) lds=163840
.amdgcn_target "amdgcn-amd-amdhsa--gfx950"
.text
.globl standalone__tensor_product_equiv_equiformer__graph_kernel
.p2align 8
.type standalone__tensor_product_equiv_equiformer__graph_kernel,@function
standalone__tensor_product_equiv_equiformer__graph_kernel:
    s_cmp_ge_u32 s2, 256
    s_cbranch_scc1 K2_END
    s_load_dwordx16 s[80:95], s[0:1], 0
    s_load_dwordx4 s[96:99], s[0:1], 72
    s_load_dwordx2 s[100:101], s[0:1], 88
    s_memrealtime s[74:75]
    v_lshrrev_b32 v1, 6, v0
    s_mov_b32 s54, s2
    v_readfirstlane_b32 s20, v1
    v_and_b32 v8, 63, v0
    v_lshlrev_b32 v9, 4, v8
    v_mov_b32 v6, 0
    v_lshlrev_b32 v5, 4, v0
    v_mul_u32_u24 v4, 24, v0
    s_mul_i32 s64, s2, 5120
    s_mul_i32 s65, s2, 7680
    v_mov_b32 v176, v8
    v_mov_b32 v177, v0
    s_mul_i32 s21, s2, 625
    s_add_u32 s22, s21, 640
    s_add_u32 s21, s21, 15
    s_lshr_b32 s21, s21, 4
    s_lshr_b32 s22, s22, 4
    s_sub_u32 s22, s22, s21
    s_movk_i32 s39, 1024
    s_lshl_b32 s37, s20, 13
    s_mov_b32 s53, 163616
    s_lshl_b32 s52, s20, 2
    s_add_u32 s52, s52, s53
    s_add_u32 s68, s37, 0
    s_add_u32 s69, s37, 2048
    s_add_u32 s70, s37, 4096
    s_add_u32 s71, s37, 6144
    s_waitcnt lgkmcnt(0)
    s_mov_b32 s8, s100
    s_and_b32 s9, s101, 0xffff
    s_mov_b32 s10, 37748736
    s_mov_b32 s11, 0x20000
    s_cmp_ge_u32 s20, 5
    s_cbranch_scc1 KS_HELP
    s_cmp_ge_u32 s2, 250
    s_cbranch_scc1 KS_IDLE
    s_mov_b32 s40, s88
    s_and_b32 s41, s89, 0xffff
    s_mov_b32 s42, 1280000
    s_mov_b32 s43, 0x20000
    buffer_load_dwordx4 v[12:15], v5, s[40:43], s64 offen
    s_mov_b32 s44, s86
    s_and_b32 s45, s87, 0xffff
    s_mov_b32 s46, 1280000
    s_mov_b32 s47, 0x20000
    s_mov_b32 s48, s82
    s_and_b32 s49, s83, 0xffff
    s_mov_b32 s50, 1920000
    s_mov_b32 s51, 0x20000
    buffer_load_dwordx4 v[16:19], v5, s[44:47], s64 offen
    buffer_load_dwordx4 v[20:23], v4, s[48:51], s65 offen
    buffer_load_dwordx2 v[24:25], v4, s[48:51], s65 offen offset:16
    v_lshlrev_b32 v2, 2, v0
    s_lshl_b32 s64, s64, 3
    v_lshl_add_u32 v3, v0, 7, s64
    v_mov_b32 v7, 1
    s_cmp_eq_u32 s20, 4
    s_cbranch_scc1 KS_NOCLR
    ds_write_b32 v2, v6
KS_NOCLR:
    s_waitcnt lgkmcnt(0)
    s_barrier
    v_mul_u32_u24 v76, 2979, v0
    v_lshrrev_b32 v76, 16, v76
    v_mul_u32_u24 v77, 2048, v76
    v_lshl_add_u32 v78, v0, 4, v77
    v_add_u32 v78, 67584, v78
    v_add_u32 v79, 67200, v78
    v_mov_b32 v80, -1
    v_mov_b32 v81, -1
    v_cmp_gt_u32 vcc, 14, v76
    v_cmp_gt_u32 s[56:57], 12, v76
    v_mov_b32 v82, -1
    v_mov_b32 v83, -1
    s_mov_b64 exec, vcc
    ds_write_b128 v78, v[80:83]
    ds_write_b128 v78, v[80:83] offset:33600
    s_mov_b64 exec, s[56:57]
    ds_write_b128 v79, v[80:83]
    s_mov_b64 exec, -1
    s_mov_b32 s4, s80
    s_and_b32 s5, s81, 0xffff
    s_mov_b32 s6, 10240000
    s_mov_b32 s7, 0x20000
    s_mov_b32 s12, s96
    s_and_b32 s13, s97, 0xffff
    s_mov_b32 s14, 10240000
    s_mov_b32 s15, 0x20000
    s_mov_b32 s16, s84
    s_and_b32 s17, s85, 0xffff
    s_mov_b32 s18, 10240000
    s_mov_b32 s19, 0x20000
    s_sub_u32 s80, s80, 1024
    s_subb_u32 s81, s81, 0
    s_mov_b32 s72, s80
    s_and_b32 s73, s81, 0xffff
    s_mov_b32 s74, 10241024
    s_mov_b32 s75, 0x20000
    s_mov_b32 s58, 429497
    s_movk_i32 s59, 625
    s_waitcnt vmcnt(3)
    v_mul_u32_u24 v28, s58, v12
    v_lshrrev_b32 v32, 27, v28
    v_bfe_u32 v36, v28, 24, 3
    v_lshlrev_b32 v32, 2, v32
    v_lshl_or_b32 v32, v36, 7, v32
    ds_add_rtn_u32 v36, v32, v7
    v_mul_u32_u24 v29, s58, v13
    v_lshrrev_b32 v33, 27, v29
    v_bfe_u32 v37, v29, 24, 3
    v_lshlrev_b32 v33, 2, v33
    v_lshl_or_b32 v33, v37, 7, v33
    ds_add_rtn_u32 v37, v33, v7
    v_mul_u32_u24 v30, s58, v14
    v_lshrrev_b32 v34, 27, v30
    v_bfe_u32 v38, v30, 24, 3
    v_lshlrev_b32 v34, 2, v34
    v_lshl_or_b32 v34, v38, 7, v34
    ds_add_rtn_u32 v38, v34, v7
    v_mul_u32_u24 v31, s58, v15
    v_lshrrev_b32 v35, 27, v31
    v_bfe_u32 v39, v31, 24, 3
    v_lshlrev_b32 v35, 2, v35
    v_lshl_or_b32 v35, v39, 7, v35
    ds_add_rtn_u32 v39, v35, v7
    v_lshrrev_b32 v28, 24, v28
    v_mad_u32_u24 v28, v28, s59, 15
    v_lshrrev_b32 v28, 4, v28
    v_sub_u32 v28, v12, v28
    v_add_u32 v12, 0, v3
    v_lshl_or_b32 v28, v28, 26, v12
    v_lshrrev_b32 v29, 24, v29
    v_mad_u32_u24 v29, v29, s59, 15
    v_lshrrev_b32 v29, 4, v29
    v_sub_u32 v29, v13, v29
    v_add_u32 v13, 32, v3
    v_lshl_or_b32 v29, v29, 26, v13
    v_lshrrev_b32 v30, 24, v30
    v_mad_u32_u24 v30, v30, s59, 15
    v_lshrrev_b32 v30, 4, v30
    v_sub_u32 v30, v14, v30
    v_add_u32 v14, 64, v3
    v_lshl_or_b32 v30, v30, 26, v14
    v_lshrrev_b32 v31, 24, v31
    v_mad_u32_u24 v31, v31, s59, 15
    v_lshrrev_b32 v31, 4, v31
    v_sub_u32 v31, v15, v31
    v_add_u32 v15, 96, v3
    v_lshl_or_b32 v31, v31, 26, v15
    v_mov_b32 v59, 163728
    s_mul_i32 s65, s2, 1152
    s_add_u32 s65, s65, 6291456
    s_mul_i32 s64, s2, 20608
    s_waitcnt lgkmcnt(0)
    s_barrier
    ds_read_b128 v[40:43], v9
    ds_read_b32 v59, v59
    s_waitcnt lgkmcnt(1)
    v_add_u32 v45, v40, v41
    v_add_u32 v46, v45, v42
    v_add_u32 v47, v46, v43
    v_mov_b32 v58, v47
    s_nop 1
    v_add_u32_dpp v58, v58, v58 row_shr:1 row_mask:0xf bank_mask:0xf bound_ctrl:0
    s_nop 1
    v_add_u32_dpp v58, v58, v58 row_shr:2 row_mask:0xf bank_mask:0xf bound_ctrl:0
    s_nop 1
    v_add_u32_dpp v58, v58, v58 row_shr:4 row_mask:0xf bank_mask:0xf bound_ctrl:0
    s_nop 1
    v_add_u32_dpp v58, v58, v58 row_shr:8 row_mask:0xf bank_mask:0xf bound_ctrl:0
    s_nop 1
    v_add_u32_dpp v58, v58, v58 row_bcast:15 row_mask:0xa bank_mask:0xf
    s_nop 1
    v_add_u32_dpp v58, v58, v58 row_bcast:31 row_mask:0xc bank_mask:0xf
    v_sub_u32 v48, v58, v47
    v_add_u32 v49, v48, v40
    v_add_u32 v50, v48, v45
    v_add_u32 v51, v48, v46
    ds_write_b128 v9, v[48:51] offset:1024
    s_waitcnt vmcnt(0) lgkmcnt(1)
    s_cmp_lg_u32 s20, 4
    s_cbranch_scc1 KS_NOPUB
    v_lshl_or_b32 v56, v49, 11, v48
    v_lshl_or_b32 v57, v51, 11, v50
    v_lshl_or_b32 v56, v59, 22, v56
    v_lshl_or_b32 v57, v59, 22, v57
    buffer_store_dwordx4 v[56:59], v9, s[8:11], s65 offen sc1
KS_NOPUB:
    s_waitcnt lgkmcnt(0)
    ds_read_b32 v32, v32 offset:1024
    ds_read_b32 v33, v33 offset:1024
    ds_read_b32 v34, v34 offset:1024
    ds_read_b32 v35, v35 offset:1024
    v_and_b32 v60, 0xffff, v59
    v_and_b32 v61, 0xffff0000, v59
    s_mov_b32 s58, 0xffff0000
    v_mov_b32 v40, v20
    v_lshl_or_b32 v41, v21, 16, v60
    v_or_b32 v42, v61, v16
    v_mov_b32 v43, v28
    v_alignbit_b32 v44, v22, v21, 16
    v_and_or_b32 v45, v22, s58, v60
    v_or_b32 v46, v61, v17
    v_mov_b32 v47, v29
    v_mov_b32 v48, v23
    v_lshl_or_b32 v49, v24, 16, v60
    v_or_b32 v50, v61, v18
    v_mov_b32 v51, v30
    v_alignbit_b32 v52, v25, v24, 16
    v_and_or_b32 v53, v25, s58, v60
    v_or_b32 v54, v61, v19
    v_mov_b32 v55, v31
    s_waitcnt lgkmcnt(0)
    v_add_lshl_u32 v32, v32, v36, 4
    ds_write_b128 v32, v[40:43] offset:2048
    v_add_lshl_u32 v33, v33, v37, 4
    ds_write_b128 v33, v[44:47] offset:2048
    v_add_lshl_u32 v34, v34, v38, 4
    ds_write_b128 v34, v[48:51] offset:2048
    v_add_lshl_u32 v35, v35, v39, 4
    ds_write_b128 v35, v[52:55] offset:2048
    s_waitcnt lgkmcnt(0)
    s_barrier
    ds_read_b128 v[12:15], v5 offset:2048
    ds_read_b128 v[16:19], v5 offset:7168
    ds_read_b128 v[20:23], v5 offset:12288
    ds_read_b128 v[24:27], v5 offset:17408
    s_waitcnt lgkmcnt(3)
    buffer_store_dwordx4 v[12:15], v5, s[8:11], s64 offen sc1
    s_add_u32 s64, s64, 5120
    s_waitcnt lgkmcnt(2)
    buffer_store_dwordx4 v[16:19], v5, s[8:11], s64 offen sc1
    s_add_u32 s64, s64, 5120
    s_waitcnt lgkmcnt(1)
    buffer_store_dwordx4 v[20:23], v5, s[8:11], s64 offen sc1
    s_add_u32 s64, s64, 5120
    s_waitcnt lgkmcnt(0)
    buffer_store_dwordx4 v[24:27], v5, s[8:11], s64 offen sc1
    s_branch KS_JOIN
KS_IDLE:
    s_barrier
    v_mul_u32_u24 v76, 2979, v0
    v_lshrrev_b32 v76, 16, v76
    v_mul_u32_u24 v77, 2048, v76
    v_lshl_add_u32 v78, v0, 4, v77
    v_add_u32 v78, 67584, v78
    v_add_u32 v79, 67200, v78
    v_mov_b32 v80, -1
    v_mov_b32 v81, -1
    v_cmp_gt_u32 vcc, 14, v76
    v_cmp_gt_u32 s[56:57], 12, v76
    v_mov_b32 v82, -1
    v_mov_b32 v83, -1
    s_mov_b64 exec, vcc
    ds_write_b128 v78, v[80:83]
    ds_write_b128 v78, v[80:83] offset:33600
    s_mov_b64 exec, s[56:57]
    ds_write_b128 v79, v[80:83]
    s_mov_b64 exec, -1
    s_mov_b32 s4, s80
    s_and_b32 s5, s81, 0xffff
    s_mov_b32 s6, 10240000
    s_mov_b32 s7, 0x20000
    s_mov_b32 s12, s96
    s_and_b32 s13, s97, 0xffff
    s_mov_b32 s14, 10240000
    s_mov_b32 s15, 0x20000
    s_mov_b32 s16, s84
    s_and_b32 s17, s85, 0xffff
    s_mov_b32 s18, 10240000
    s_mov_b32 s19, 0x20000
    s_sub_u32 s80, s80, 1024
    s_subb_u32 s81, s81, 0
    s_mov_b32 s72, s80
    s_and_b32 s73, s81, 0xffff
    s_mov_b32 s74, 10241024
    s_mov_b32 s75, 0x20000
    s_barrier
    s_branch KS_B3
KS_HELP:
    s_cmp_eq_u32 s20, 7
    s_cbranch_scc1 KS_TAG
    s_cmp_eq_u32 s20, 6
    s_cbranch_scc1 KS_RAW
    s_cmp_ge_u32 s2, 200
    s_cbranch_scc1 KS_NOW
    v_and_b32 v1, 15, v8
    v_lshrrev_b32 v3, 4, v8
    s_cmp_ge_u32 s2, 160
    s_cbranch_scc1 K1_WT
    s_cmp_ge_u32 s2, 64
    s_cbranch_scc1 K1_S1
    s_lshr_b32 s24, s2, 3
    s_and_b32 s25, s2, 7
    s_lshr_b32 s26, s25, 2
    s_bfe_u32 s27, s25, 0x10001
    s_and_b32 s28, s25, 1
    s_mov_b32 s60, s92
    s_and_b32 s61, s93, 0xffff
    s_mov_b32 s62, 65536
    s_mov_b32 s63, 0x20000
    s_branch K1_SC
K1_S1:
    s_sub_u32 s29, s2, 64
    s_mul_i32 s24, s29, 43
    s_lshr_b32 s24, s24, 9
    s_mul_i32 s25, s24, 12
    s_sub_u32 s25, s29, s25
    s_cmp_ge_u32 s25, 6
    s_cselect_b32 s26, 1, 0
    s_mul_i32 s27, s26, 6
    s_sub_u32 s27, s25, s27
    s_lshr_b32 s27, s27, 1
    s_and_b32 s28, s25, 1
    s_add_u32 s25, s25, 8
    s_mov_b32 s60, s94
    s_and_b32 s61, s95, 0xffff
    s_mov_b32 s62, 98304
    s_mov_b32 s63, 0x20000
K1_SC:
    s_lshl_b32 s27, s27, 7
    s_lshl_b32 s26, s26, 6
    s_lshl_b32 s28, s28, 4
    s_add_u32 s27, s27, s26
    s_add_u32 s27, s27, s28
    s_lshl_b32 s27, s27, 8
    s_lshl_b32 s26, s24, 5
    s_add_u32 s27, s27, s26
    s_add_u32 s29, s27, 8192
    v_lshlrev_b32 v3, 10, v3
    v_lshl_add_u32 v3, v1, 1, v3
    buffer_load_ushort v64, v3, s[60:63], s27 offen offset:0
    buffer_load_ushort v65, v3, s[60:63], s29 offen offset:0
    buffer_load_ushort v66, v3, s[60:63], s27 offen offset:256
    buffer_load_ushort v67, v3, s[60:63], s29 offen offset:256
    buffer_load_ushort v68, v3, s[60:63], s27 offen offset:512
    buffer_load_ushort v69, v3, s[60:63], s29 offen offset:512
    buffer_load_ushort v70, v3, s[60:63], s27 offen offset:768
    buffer_load_ushort v71, v3, s[60:63], s29 offen offset:768
    s_mul_i32 s24, s24, 20
    s_add_u32 s24, s24, s25
    s_lshl_b32 s24, s24, 10
    s_add_u32 s24, s24, 6946816
    s_branch K1_GO
K1_WT:
    s_sub_u32 s24, s2, 160
    s_cmp_ge_u32 s24, 20
    s_cselect_b32 s26, 1, 0
    s_mul_i32 s25, s26, 20
    s_sub_u32 s25, s24, s25
    s_lshr_b32 s27, s25, 2
    s_bfe_u32 s28, s25, 0x10001
    s_and_b32 s25, s25, 1
    s_mul_i32 s25, s25, 10240
    s_lshl_b32 s27, s27, 8
    s_lshl_b32 s26, s26, 7
    s_lshl_b32 s28, s28, 6
    s_add_u32 s27, s27, s26
    s_add_u32 s27, s27, s28
    s_add_u32 s27, s27, s25
    s_mov_b32 s60, s90
    s_and_b32 s61, s91, 0xffff
    s_mov_b32 s62, 20480
    s_mov_b32 s63, 0x20000
    v_and_b32 v1, 31, v8
    v_lshrrev_b32 v3, 5, v8
    v_mul_u32_u24 v3, 5120, v3
    v_lshl_add_u32 v3, v1, 1, v3
    v_mov_b32 v64, 0
    v_mov_b32 v66, 0
    v_mov_b32 v68, 0
    v_mov_b32 v70, 0
    buffer_load_ushort v65, v3, s[60:63], s27 offen offset:0
    buffer_load_ushort v67, v3, s[60:63], s27 offen offset:1280
    buffer_load_ushort v69, v3, s[60:63], s27 offen offset:2560
    buffer_load_ushort v71, v3, s[60:63], s27 offen offset:3840
    s_lshl_b32 s24, s24, 10
    s_add_u32 s24, s24, 7110656
K1_GO:
    s_barrier
    v_subrev_u32 v76, 320, v0
    v_mov_b32 v80, -1
    v_mov_b32 v77, 1.0
    v_cmp_gt_u32 vcc, 48, v76
    v_lshlrev_b32 v78, 4, v76
    v_add_u32 v78, 65536, v78
    v_cndmask_b32 v80, v80, 0, vcc
    v_cmp_gt_u32 vcc, 12, v76
    v_add_u32 v79, 64800, v78
    s_nop 0
    v_cndmask_b32 v80, v80, v77, vcc
    v_cmp_gt_u32 s[56:57], 54, v8
    v_mov_b32 v81, v80
    v_mov_b32 v82, v80
    v_mov_b32 v83, v80
    ds_write_b128 v78, v[80:83] offset:0
    ds_write_b128 v78, v[80:83] offset:2400
    ds_write_b128 v78, v[80:83] offset:4800
    ds_write_b128 v78, v[80:83] offset:7200
    ds_write_b128 v78, v[80:83] offset:9600
    ds_write_b128 v78, v[80:83] offset:12000
    ds_write_b128 v78, v[80:83] offset:14400
    ds_write_b128 v78, v[80:83] offset:16800
    ds_write_b128 v78, v[80:83] offset:19200
    ds_write_b128 v78, v[80:83] offset:21600
    ds_write_b128 v78, v[80:83] offset:24000
    ds_write_b128 v78, v[80:83] offset:26400
    ds_write_b128 v78, v[80:83] offset:28800
    ds_write_b128 v78, v[80:83] offset:31200
    ds_write_b128 v78, v[80:83] offset:33600
    ds_write_b128 v78, v[80:83] offset:36000
    ds_write_b128 v78, v[80:83] offset:38400
    ds_write_b128 v78, v[80:83] offset:40800
    ds_write_b128 v78, v[80:83] offset:43200
    ds_write_b128 v78, v[80:83] offset:45600
    ds_write_b128 v78, v[80:83] offset:48000
    ds_write_b128 v78, v[80:83] offset:50400
    ds_write_b128 v78, v[80:83] offset:52800
    ds_write_b128 v78, v[80:83] offset:55200
    ds_write_b128 v78, v[80:83] offset:57600
    ds_write_b128 v78, v[80:83] offset:60000
    ds_write_b128 v78, v[80:83] offset:62400
    ds_write_b128 v79, v[80:83] offset:0
    ds_write_b128 v79, v[80:83] offset:2400
    ds_write_b128 v79, v[80:83] offset:4800
    ds_write_b128 v79, v[80:83] offset:7200
    ds_write_b128 v79, v[80:83] offset:9600
    ds_write_b128 v79, v[80:83] offset:12000
    ds_write_b128 v79, v[80:83] offset:14400
    ds_write_b128 v79, v[80:83] offset:16800
    ds_write_b128 v79, v[80:83] offset:19200
    ds_write_b128 v79, v[80:83] offset:21600
    ds_write_b128 v79, v[80:83] offset:24000
    ds_write_b128 v79, v[80:83] offset:26400
    ds_write_b128 v79, v[80:83] offset:28800
    v_mov_b32 v59, 163728
    s_barrier
    ds_read_b32 v59, v59
    s_cmp_eq_u32 s20, 6
    s_cselect_b64 exec, s[56:57], -1
    ds_write_b128 v79, v[80:83] offset:31200
    s_mov_b64 exec, -1
    s_mov_b32 s4, s80
    s_and_b32 s5, s81, 0xffff
    s_mov_b32 s6, 10240000
    s_mov_b32 s7, 0x20000
    s_mov_b32 s12, s96
    s_and_b32 s13, s97, 0xffff
    s_mov_b32 s14, 10240000
    s_mov_b32 s15, 0x20000
    s_mov_b32 s16, s84
    s_and_b32 s17, s85, 0xffff
    s_mov_b32 s18, 10240000
    s_mov_b32 s19, 0x20000
    s_sub_u32 s80, s80, 1024
    s_subb_u32 s81, s81, 0
    s_mov_b32 s72, s80
    s_and_b32 s73, s81, 0xffff
    s_mov_b32 s74, 10241024
    s_mov_b32 s75, 0x20000
    s_waitcnt vmcnt(0)
    v_lshl_or_b32 v40, v65, 16, v64
    v_lshl_or_b32 v41, v67, 16, v66
    v_lshl_or_b32 v42, v69, 16, v68
    v_lshl_or_b32 v43, v71, 16, v70
    buffer_store_dwordx4 v[40:43], v9, s[8:11], s24 offen sc1
    s_waitcnt lgkmcnt(0)
    s_barrier
    s_lshl_b32 s24, s2, 2
    s_add_u32 s24, s24, 7176192
    s_mov_b64 exec, 1
    s_waitcnt vmcnt(0)
    buffer_store_dword v59, v6, s[8:11], s24 offen sc1
    s_mov_b64 exec, -1
    s_branch KS_JOIN
KS_RAW:
    s_barrier
    s_mov_b32 s60, s90
    s_and_b32 s61, s91, 0xffff
    s_mov_b32 s62, 20480
    s_mov_b32 s63, 0x20000
    s_mov_b32 m0, 24576
    s_movk_i32 s24, 0
    buffer_load_dwordx4 v9, s[60:63], s24 offen offset:0 lds
    buffer_load_dwordx4 v9, s[60:63], s24 offen offset:1024 lds
    buffer_load_dwordx4 v9, s[60:63], s24 offen offset:2048 lds
    buffer_load_dwordx4 v9, s[60:63], s24 offen offset:3072 lds
    s_mov_b32 m0, 28672
    s_movk_i32 s24, 4096
    buffer_load_dwordx4 v9, s[60:63], s24 offen offset:0 lds
    buffer_load_dwordx4 v9, s[60:63], s24 offen offset:1024 lds
    buffer_load_dwordx4 v9, s[60:63], s24 offen offset:2048 lds
    buffer_load_dwordx4 v9, s[60:63], s24 offen offset:3072 lds
    s_mov_b32 m0, 32768
    s_movk_i32 s24, 8192
    buffer_load_dwordx4 v9, s[60:63], s24 offen offset:0 lds
    buffer_load_dwordx4 v9, s[60:63], s24 offen offset:1024 lds
    buffer_load_dwordx4 v9, s[60:63], s24 offen offset:2048 lds
    buffer_load_dwordx4 v9, s[60:63], s24 offen offset:3072 lds
    s_mov_b32 m0, 36864
    s_movk_i32 s24, 12288
    buffer_load_dwordx4 v9, s[60:63], s24 offen offset:0 lds
    buffer_load_dwordx4 v9, s[60:63], s24 offen offset:1024 lds
    buffer_load_dwordx4 v9, s[60:63], s24 offen offset:2048 lds
    buffer_load_dwordx4 v9, s[60:63], s24 offen offset:3072 lds
    s_mov_b32 m0, 40960
    s_movk_i32 s24, 16384
    buffer_load_dwordx4 v9, s[60:63], s24 offen offset:0 lds
    buffer_load_dwordx4 v9, s[60:63], s24 offen offset:1024 lds
    buffer_load_dwordx4 v9, s[60:63], s24 offen offset:2048 lds
    buffer_load_dwordx4 v9, s[60:63], s24 offen offset:3072 lds
    s_branch KS_FILL
KS_NOW:
    s_barrier
KS_FILL:
    v_subrev_u32 v76, 320, v0
    v_mov_b32 v80, -1
    v_mov_b32 v77, 1.0
    v_cmp_gt_u32 vcc, 48, v76
    v_lshlrev_b32 v78, 4, v76
    v_add_u32 v78, 65536, v78
    v_cndmask_b32 v80, v80, 0, vcc
    v_cmp_gt_u32 vcc, 12, v76
    v_add_u32 v79, 64800, v78
    s_nop 0
    v_cndmask_b32 v80, v80, v77, vcc
    v_cmp_gt_u32 s[56:57], 54, v8
    v_mov_b32 v81, v80
    v_mov_b32 v82, v80
    v_mov_b32 v83, v80
    ds_write_b128 v78, v[80:83] offset:0
    ds_write_b128 v78, v[80:83] offset:2400
    ds_write_b128 v78, v[80:83] offset:4800
    ds_write_b128 v78, v[80:83] offset:7200
    ds_write_b128 v78, v[80:83] offset:9600
    ds_write_b128 v78, v[80:83] offset:12000
    ds_write_b128 v78, v[80:83] offset:14400
    ds_write_b128 v78, v[80:83] offset:16800
    ds_write_b128 v78, v[80:83] offset:19200
    ds_write_b128 v78, v[80:83] offset:21600
    ds_write_b128 v78, v[80:83] offset:24000
    ds_write_b128 v78, v[80:83] offset:26400
    ds_write_b128 v78, v[80:83] offset:28800
    ds_write_b128 v78, v[80:83] offset:31200
    ds_write_b128 v78, v[80:83] offset:33600
    ds_write_b128 v78, v[80:83] offset:36000
    ds_write_b128 v78, v[80:83] offset:38400
    ds_write_b128 v78, v[80:83] offset:40800
    ds_write_b128 v78, v[80:83] offset:43200
    ds_write_b128 v78, v[80:83] offset:45600
    ds_write_b128 v78, v[80:83] offset:48000
    ds_write_b128 v78, v[80:83] offset:50400
    ds_write_b128 v78, v[80:83] offset:52800
    ds_write_b128 v78, v[80:83] offset:55200
    ds_write_b128 v78, v[80:83] offset:57600
    ds_write_b128 v78, v[80:83] offset:60000
    ds_write_b128 v78, v[80:83] offset:62400
    ds_write_b128 v79, v[80:83] offset:0
    ds_write_b128 v79, v[80:83] offset:2400
    ds_write_b128 v79, v[80:83] offset:4800
    ds_write_b128 v79, v[80:83] offset:7200
    ds_write_b128 v79, v[80:83] offset:9600
    ds_write_b128 v79, v[80:83] offset:12000
    ds_write_b128 v79, v[80:83] offset:14400
    ds_write_b128 v79, v[80:83] offset:16800
    ds_write_b128 v79, v[80:83] offset:19200
    ds_write_b128 v79, v[80:83] offset:21600
    ds_write_b128 v79, v[80:83] offset:24000
    ds_write_b128 v79, v[80:83] offset:26400
    ds_write_b128 v79, v[80:83] offset:28800
    s_barrier
    s_cmp_eq_u32 s20, 6
    s_cselect_b64 exec, s[56:57], -1
    ds_write_b128 v79, v[80:83] offset:31200
    s_mov_b64 exec, -1
    s_mov_b32 s4, s80
    s_and_b32 s5, s81, 0xffff
    s_mov_b32 s6, 10240000
    s_mov_b32 s7, 0x20000
    s_mov_b32 s12, s96
    s_and_b32 s13, s97, 0xffff
    s_mov_b32 s14, 10240000
    s_mov_b32 s15, 0x20000
    s_mov_b32 s16, s84
    s_and_b32 s17, s85, 0xffff
    s_mov_b32 s18, 10240000
    s_mov_b32 s19, 0x20000
    s_sub_u32 s80, s80, 1024
    s_subb_u32 s81, s81, 0
    s_mov_b32 s72, s80
    s_and_b32 s73, s81, 0xffff
    s_mov_b32 s74, 10241024
    s_mov_b32 s75, 0x20000
    s_waitcnt vmcnt(0)
    s_branch KS_B3
KS_TAG:
    s_mov_b32 s60, s98
    s_and_b32 s61, s99, 0xffff
    s_mov_b32 s62, 256
    s_mov_b32 s63, 0x20000
    s_cmp_lg_u32 s2, 0
    s_cbranch_scc1 KS_TAGLD
    s_or_b32 s24, s74, 1
    v_mov_b32 v10, s24
    v_mov_b32 v11, 0
    s_mov_b64 exec, 1
    buffer_atomic_cmpswap v[10:11], v6, s[60:63], 0 offen sc1
KS_TAGLD:
    s_mov_b64 exec, 1
    v_mov_b32 v14, 0
    s_mov_b64 exec, -1
    s_barrier
    v_mov_b32 v76, 0
    v_mov_b32 v77, -1
    v_lshlrev_b32 v78, 2, v8
    v_add_u32 v78, 163424, v78
    s_mov_b64 exec, 0x1ff
    ds_write_b32 v78, v76 offset:192
    s_mov_b64 exec, 0xff
    ds_write_b32 v78, v77 offset:256
    s_mov_b64 exec, -1
    s_mov_b32 exec_hi, 0xffff
    ds_write_b32 v78, v76
    s_mov_b64 exec, 1
    ds_write_b32 v78, v76 offset:228
    s_mov_b64 exec, -1
    s_mov_b32 s4, s80
    s_and_b32 s5, s81, 0xffff
    s_mov_b32 s6, 10240000
    s_mov_b32 s7, 0x20000
    s_mov_b32 s12, s96
    s_and_b32 s13, s97, 0xffff
    s_mov_b32 s14, 10240000
    s_mov_b32 s15, 0x20000
    s_mov_b32 s16, s84
    s_and_b32 s17, s85, 0xffff
    s_mov_b32 s18, 10240000
    s_mov_b32 s19, 0x20000
    s_sub_u32 s80, s80, 1024
    s_subb_u32 s81, s81, 0
    s_mov_b32 s72, s80
    s_and_b32 s73, s81, 0xffff
    s_mov_b32 s74, 10241024
    s_mov_b32 s75, 0x20000
    s_mov_b64 exec, 1
    s_mov_b32 s24, 0x100000
    v_mov_b32 v12, 163728
KS_TAGW:
    buffer_load_dword v15, v6, s[60:63], 0 offen sc1
    s_waitcnt vmcnt(1)
    v_cmp_ne_u32 vcc, 0, v14
    s_nop 0
    s_cbranch_vccnz KS_TAGOK
    s_sub_u32 s24, s24, 1
    s_cbranch_scc1 K2_END
    buffer_load_dword v14, v6, s[60:63], 0 offen sc1
    s_waitcnt vmcnt(1)
    v_cmp_ne_u32 vcc, 0, v15
    s_nop 0
    s_cbranch_vccz KS_TAGW
    ds_write_b32 v12, v15
    s_branch KS_TAGOK2
KS_TAGOK:
    ds_write_b32 v12, v14
KS_TAGOK2:
    s_mov_b64 exec, -1
    s_waitcnt lgkmcnt(0)
    s_barrier
KS_B3:
    v_mov_b32 v59, 163728
    ds_read_b32 v59, v59
    s_waitcnt lgkmcnt(0)
    s_barrier
KS_JOIN:
    v_readfirstlane_b32 s2, v59
    s_mov_b32 s23, 0
    s_mov_b32 s28, 1
    s_mov_b32 s24, 0
    s_mov_b32 s25, 1
K2_CELLS:
    v_lshrrev_b32 v178, 1, v177
    v_min_u32 v178, 249, v178
    v_mul_u32_u24 v72, 1152, v178
    s_and_b32 s58, s54, 7
    s_lshl_b32 s58, s58, 7
    s_lshr_b32 s59, s54, 5
    s_lshl_b32 s59, s59, 4
    s_add_u32 s67, s58, s59
    s_add_u32 s67, s67, 6291456
    buffer_load_dwordx4 v[76:79], v72, s[8:11], s67 offen sc1
    v_and_b32 v84, 15, v176
    v_lshrrev_b32 v85, 5, v176
    v_bfe_u32 v86, v176, 4, 1
    v_lshrrev_b32 v87, 2, v84
    v_and_b32 v88, 3, v84
    v_lshl_add_u32 v89, v85, 3, v87
    v_lshlrev_b32 v249, 5, v89
    v_lshl_add_u32 v249, v88, 3, v249
    v_add_u32 v249, 864, v249
    v_mul_u32_u24 v250, 192, v86
    v_lshl_add_u32 v250, v85, 5, v250
    v_lshrrev_b32 v90, 1, v88
    v_lshl_add_u32 v90, v86, 1, v90
    v_bfe_u32 v91, v87, 1, 1
    v_lshlrev_b32 v91, 2, v91
    v_xor_b32 v90, v90, v91
    v_lshlrev_b32 v90, 4, v90
    v_lshl_add_u32 v90, v89, 7, v90
    v_and_b32 v91, 1, v88
    v_lshl_add_u32 v90, v91, 3, v90
    v_add_u32 v246, s37, v90
    v_xor_b32 v247, 64, v246
    v_lshrrev_b32 v90, 3, v176
    v_lshlrev_b32 v251, 2, v90
    v_add_u32 v251, 768, v251
    v_bfe_u32 v90, v90, 1, 1
    v_lshlrev_b32 v90, 2, v90
    v_and_b32 v91, 7, v176
    v_xor_b32 v90, v90, v91
    v_lshlrev_b32 v248, 4, v90
    v_lshlrev_b32 v252, 1, v176
    v_and_b32 v231, 1, v176
    v_lshlrev_b32 v231, 4, v231
    v_lshrrev_b32 v90, 1, v176
    v_lshlrev_b32 v90, 5, v90
    v_add_u32 v230, 864, v90
    s_lshl_b32 s59, s2, 22
    s_mov_b32 s60, 0x100000
    s_bfe_u32 s61, s54, 0x10004
    s_bfe_u32 s62, s54, 0x10003
    s_add_u32 s63, s61, s62
    s_mul_i32 s62, s62, 11
    s_sub_u32 s64, 11, s62
    v_cmp_gt_u32 vcc, 500, v177
    s_nop 0
    s_mov_b64 s[56:57], vcc
K2_POLL:
    s_waitcnt vmcnt(0)
    v_xor_b32 v73, s59, v76
    v_xor_b32 v74, s59, v77
    v_or_b32 v73, v73, v74
    v_xor_b32 v74, s2, v79
    v_lshrrev_b32 v73, 22, v73
    v_or_b32 v73, v73, v74
    v_cmp_ne_u32 vcc, 0, v73
    s_nop 0
    s_cbranch_vccz K2_POLLED
    s_sub_u32 s60, s60, 1
    s_cbranch_scc1 K2_END
    s_mov_b64 exec, vcc
    buffer_load_dwordx4 v[76:79], v72, s[8:11], s67 offen sc1
    s_mov_b64 exec, -1
    s_branch K2_POLL
K2_POLLED:
    s_set_gpr_idx_on s61, gpr_idx(SRC0)
    s_nop 0
    v_bfe_u32 v179, v76, s62, 11
    s_set_gpr_idx_idx s63
    s_nop 0
    v_bfe_u32 v73, v76, s64, 11
    s_set_gpr_idx_off
    v_sub_u32 v73, v73, v179
    v_cndmask_b32 v73, 0, v73, s[56:57]
    v_and_b32 v1, 1, v177
    v_add_u32 v1, s23, v1
    v_sub_u32 v180, v73, v1
    v_add_u32 v179, v179, v1
    v_mul_u32_u24 v181, 20608, v178
    v_lshl_add_u32 v181, v179, 4, v181
    v_cmp_lt_i32 s[40:41], 0, v180
    v_cmp_lt_i32 s[42:43], 2, v180
    v_cmp_lt_i32 s[44:45], 4, v180
    v_cmp_lt_i32 s[46:47], 6, v180
    v_cmp_lt_i32 s[48:49], 8, v180
    v_cmp_lt_i32 s[50:51], 10, v180
    v_cmp_lt_i32 s[90:91], 12, v180
    v_cmp_lt_i32 s[92:93], 14, v180
    v_cmp_lt_i32 s[94:95], 16, v180
    v_cmp_lt_i32 s[96:97], 18, v180
    s_mov_b64 exec, s[40:41]
    s_cbranch_execz K2_LD_DONE
    buffer_load_dwordx4 v[0:3], v181, s[8:11], 0 offen offset:0 sc1
    s_mov_b64 exec, s[42:43]
    s_cbranch_execz K2_LD_DONE
    buffer_load_dwordx4 v[4:7], v181, s[8:11], 0 offen offset:32 sc1
    s_mov_b64 exec, s[44:45]
    s_cbranch_execz K2_LD_DONE
    buffer_load_dwordx4 v[8:11], v181, s[8:11], 0 offen offset:64 sc1
    s_mov_b64 exec, s[46:47]
    s_cbranch_execz K2_LD_DONE
    buffer_load_dwordx4 v[12:15], v181, s[8:11], 0 offen offset:96 sc1
    s_mov_b64 exec, s[48:49]
    s_cbranch_execz K2_LD_DONE
    buffer_load_dwordx4 v[16:19], v181, s[8:11], 0 offen offset:128 sc1
    s_mov_b64 exec, s[50:51]
    s_cbranch_execz K2_LD_DONE
    buffer_load_dwordx4 v[20:23], v181, s[8:11], 0 offen offset:160 sc1
    s_mov_b64 exec, s[90:91]
    s_cbranch_execz K2_LD_DONE
    buffer_load_dwordx4 v[24:27], v181, s[8:11], 0 offen offset:192 sc1
    s_mov_b64 exec, s[92:93]
    s_cbranch_execz K2_LD_DONE
    buffer_load_dwordx4 v[28:31], v181, s[8:11], 0 offen offset:224 sc1
    s_mov_b64 exec, s[94:95]
    s_cbranch_execz K2_LD_DONE
    buffer_load_dwordx4 v[32:35], v181, s[8:11], 0 offen offset:256 sc1
    s_mov_b64 exec, s[96:97]
    s_cbranch_execz K2_LD_DONE
    buffer_load_dwordx4 v[36:39], v181, s[8:11], 0 offen offset:288 sc1
K2_LD_DONE:
    s_mov_b64 exec, -1
    s_cmp_eq_u32 s28, 0
    s_cbranch_scc1 K2_NOWRAW
    s_cmp_lg_u32 s20, 7
    s_cbranch_scc1 K2_NOFLG
    v_lshlrev_b32 v72, 4, v176
    s_mov_b32 s67, 7176192
    buffer_load_dwordx4 v[84:87], v72, s[8:11], s67 offen sc1
K2_NOFLG:
    v_lshrrev_b32 v60, 5, v176
    v_bfe_u32 v61, v176, 2, 2
    v_lshl_add_u32 v60, v60, 2, v61
    v_mul_u32_u24 v60, 1280, v60
    v_bfe_u32 v61, v176, 4, 1
    v_lshl_add_u32 v60, v61, 5, v60
    v_and_b32 v61, 3, v176
    v_lshl_add_u32 v60, v61, 3, v60
    ds_read_b64_tr_b16 v[136:137], v60 offset:24576
    ds_read_b64_tr_b16 v[138:139], v60 offset:34816
    ds_read_b64_tr_b16 v[140:141], v60 offset:24640
    ds_read_b64_tr_b16 v[142:143], v60 offset:34880
    ds_read_b64_tr_b16 v[144:145], v60 offset:24832
    ds_read_b64_tr_b16 v[146:147], v60 offset:35072
    ds_read_b64_tr_b16 v[148:149], v60 offset:24896
    ds_read_b64_tr_b16 v[150:151], v60 offset:35136
    ds_read_b64_tr_b16 v[152:153], v60 offset:25088
    ds_read_b64_tr_b16 v[154:155], v60 offset:35328
    ds_read_b64_tr_b16 v[156:157], v60 offset:25152
    ds_read_b64_tr_b16 v[158:159], v60 offset:35392
    ds_read_b64_tr_b16 v[160:161], v60 offset:25344
    ds_read_b64_tr_b16 v[162:163], v60 offset:35584
    ds_read_b64_tr_b16 v[164:165], v60 offset:25408
    ds_read_b64_tr_b16 v[166:167], v60 offset:35648
    ds_read_b64_tr_b16 v[168:169], v60 offset:25600
    ds_read_b64_tr_b16 v[170:171], v60 offset:35840
    ds_read_b64_tr_b16 v[172:173], v60 offset:25664
    ds_read_b64_tr_b16 v[174:175], v60 offset:35904
    s_waitcnt lgkmcnt(0)
    v_lshlrev_b32 v96, 16, v136
    v_and_b32 v97, 0xffff0000, v136
    v_lshlrev_b32 v98, 16, v137
    v_and_b32 v99, 0xffff0000, v137
    v_lshlrev_b32 v100, 16, v138
    v_and_b32 v101, 0xffff0000, v138
    v_lshlrev_b32 v102, 16, v139
    v_and_b32 v103, 0xffff0000, v139
    v_lshlrev_b32 v104, 16, v140
    v_and_b32 v105, 0xffff0000, v140
    v_lshlrev_b32 v106, 16, v141
    v_and_b32 v107, 0xffff0000, v141
    v_lshlrev_b32 v108, 16, v142
    v_and_b32 v109, 0xffff0000, v142
    v_lshlrev_b32 v110, 16, v143
    v_and_b32 v111, 0xffff0000, v143
    v_lshlrev_b32 v112, 16, v144
    v_and_b32 v113, 0xffff0000, v144
    v_lshlrev_b32 v114, 16, v145
    v_and_b32 v115, 0xffff0000, v145
    v_lshlrev_b32 v116, 16, v146
    v_and_b32 v117, 0xffff0000, v146
    v_lshlrev_b32 v118, 16, v147
    v_and_b32 v119, 0xffff0000, v147
    v_lshlrev_b32 v120, 16, v148
    v_and_b32 v121, 0xffff0000, v148
    v_lshlrev_b32 v122, 16, v149
    v_and_b32 v123, 0xffff0000, v149
    v_lshlrev_b32 v124, 16, v150
    v_and_b32 v125, 0xffff0000, v150
    v_lshlrev_b32 v126, 16, v151
    v_and_b32 v127, 0xffff0000, v151
    v_lshlrev_b32 v128, 16, v152
    v_and_b32 v129, 0xffff0000, v152
    v_lshlrev_b32 v130, 16, v153
    v_and_b32 v131, 0xffff0000, v153
    v_lshlrev_b32 v132, 16, v154
    v_and_b32 v133, 0xffff0000, v154
    v_lshlrev_b32 v134, 16, v155
    v_and_b32 v135, 0xffff0000, v155
    v_lshlrev_b32 v136, 16, v156
    v_and_b32 v137, 0xffff0000, v156
    v_lshlrev_b32 v138, 16, v157
    v_and_b32 v139, 0xffff0000, v157
    v_lshlrev_b32 v140, 16, v158
    v_and_b32 v141, 0xffff0000, v158
    v_lshlrev_b32 v142, 16, v159
    v_and_b32 v143, 0xffff0000, v159
    v_lshlrev_b32 v144, 16, v160
    v_and_b32 v145, 0xffff0000, v160
    v_lshlrev_b32 v146, 16, v161
    v_and_b32 v147, 0xffff0000, v161
    v_lshlrev_b32 v148, 16, v162
    v_and_b32 v149, 0xffff0000, v162
    v_lshlrev_b32 v150, 16, v163
    v_and_b32 v151, 0xffff0000, v163
    v_lshlrev_b32 v152, 16, v164
    v_and_b32 v153, 0xffff0000, v164
    v_lshlrev_b32 v154, 16, v165
    v_and_b32 v155, 0xffff0000, v165
    v_lshlrev_b32 v156, 16, v166
    v_and_b32 v157, 0xffff0000, v166
    v_lshlrev_b32 v158, 16, v167
    v_and_b32 v159, 0xffff0000, v167
    v_lshlrev_b32 v160, 16, v168
    v_and_b32 v161, 0xffff0000, v168
    v_lshlrev_b32 v162, 16, v169
    v_and_b32 v163, 0xffff0000, v169
    v_lshlrev_b32 v164, 16, v170
    v_and_b32 v165, 0xffff0000, v170
    v_lshlrev_b32 v166, 16, v171
    v_and_b32 v167, 0xffff0000, v171
    v_lshlrev_b32 v168, 16, v172
    v_and_b32 v169, 0xffff0000, v172
    v_lshlrev_b32 v170, 16, v173
    v_and_b32 v171, 0xffff0000, v173
    v_lshlrev_b32 v172, 16, v174
    v_and_b32 v173, 0xffff0000, v174
    v_lshlrev_b32 v174, 16, v175
    v_and_b32 v175, 0xffff0000, v175
K2_NOWRAW:
    v_mul_u32_u24 v178, 1280, v178
    v_add_lshl_u32 v179, v179, v178, 2
    s_mov_b32 s66, 7340032
    v_mov_b32 v201, 1
    s_movk_i32 s58, 600
    s_movk_i32 s59, 2400
    s_mov_b32 s60, 0x100000
    s_mov_b32 s61, 0xffff
    v_mov_b32 v202, 65536
    s_cmp_lg_u32 s24, 0
    s_cbranch_scc1 K2_RK_LOAD
    v_cmp_lt_i32 vcc, 20, v180
    s_nop 0
    s_cbranch_vccz K2_NOMORE
    v_mov_b32 v61, 163652
    ds_write_b32 v61, v201
K2_NOMORE:
    s_waitcnt vmcnt(0)
    s_mov_b32 s62, 84736
    s_mov_b32 s63, 84736
    s_mov_b64 exec, s[40:41]
    s_cbranch_execz K2_RK_A
K2_CK0:
    v_bfi_b32 v192, s61, v1, v2
    v_lshrrev_b32 v50, 24, v3
    v_cmp_ne_u32 vcc, s2, v192
    v_add_u32 v40, 163424, v50
    s_cbranch_vccnz K2_RT0
    ds_add_rtn_u32 v40, v40, v201
    v_mad_u32_u24 v50, v50, s58, v202
    v_and_b32 v3, 0xffffff, v3
    v_cmpx_gt_u32 vcc, s62, v50
    buffer_load_dword v245, v3, s[16:19], 0 offen
    s_mov_b64 exec, s[42:43]
    s_cbranch_execz K2_RK_A
K2_CK1:
    v_bfi_b32 v192, s61, v5, v6
    v_lshrrev_b32 v51, 24, v7
    v_cmp_ne_u32 vcc, s2, v192
    v_add_u32 v41, 163424, v51
    s_cbranch_vccnz K2_RT1
    ds_add_rtn_u32 v41, v41, v201
    v_mad_u32_u24 v51, v51, s58, v202
    v_and_b32 v7, 0xffffff, v7
    v_cmpx_gt_u32 vcc, s62, v51
    buffer_load_dword v245, v7, s[16:19], 0 offen
    s_mov_b64 exec, s[44:45]
    s_cbranch_execz K2_RK_A
K2_CK2:
    v_bfi_b32 v192, s61, v9, v10
    v_lshrrev_b32 v52, 24, v11
    v_cmp_ne_u32 vcc, s2, v192
    v_add_u32 v42, 163424, v52
    s_cbranch_vccnz K2_RT2
    ds_add_rtn_u32 v42, v42, v201
    v_mad_u32_u24 v52, v52, s58, v202
    v_and_b32 v11, 0xffffff, v11
    v_cmpx_gt_u32 vcc, s62, v52
    buffer_load_dword v245, v11, s[16:19], 0 offen
    s_mov_b64 exec, s[46:47]
    s_cbranch_execz K2_RK_A
K2_CK3:
    v_bfi_b32 v192, s61, v13, v14
    v_lshrrev_b32 v53, 24, v15
    v_cmp_ne_u32 vcc, s2, v192
    v_add_u32 v43, 163424, v53
    s_cbranch_vccnz K2_RT3
    ds_add_rtn_u32 v43, v43, v201
    v_mad_u32_u24 v53, v53, s58, v202
    v_and_b32 v15, 0xffffff, v15
    v_cmpx_gt_u32 vcc, s62, v53
    buffer_load_dword v245, v15, s[16:19], 0 offen
    s_mov_b64 exec, s[48:49]
    s_cbranch_execz K2_RK_A
K2_CK4:
    v_bfi_b32 v192, s61, v17, v18
    v_lshrrev_b32 v54, 24, v19
    v_cmp_ne_u32 vcc, s2, v192
    v_add_u32 v44, 163424, v54
    s_cbranch_vccnz K2_RT4
    ds_add_rtn_u32 v44, v44, v201
    v_mad_u32_u24 v54, v54, s58, v202
    v_and_b32 v19, 0xffffff, v19
    v_cmpx_gt_u32 vcc, s62, v54
    buffer_load_dword v245, v19, s[16:19], 0 offen
    s_mov_b64 exec, s[50:51]
    s_cbranch_execz K2_RK_A
K2_CK5:
    v_bfi_b32 v192, s61, v21, v22
    v_lshrrev_b32 v55, 24, v23
    v_cmp_ne_u32 vcc, s2, v192
    v_add_u32 v45, 163424, v55
    s_cbranch_vccnz K2_RT5
    ds_add_rtn_u32 v45, v45, v201
    v_mad_u32_u24 v55, v55, s58, v202
    v_and_b32 v23, 0xffffff, v23
    v_cmpx_gt_u32 vcc, s62, v55
    buffer_load_dword v245, v23, s[16:19], 0 offen
    s_mov_b64 exec, s[90:91]
    s_cbranch_execz K2_RK_A
K2_CK6:
    v_bfi_b32 v192, s61, v25, v26
    v_lshrrev_b32 v56, 24, v27
    v_cmp_ne_u32 vcc, s2, v192
    v_add_u32 v46, 163424, v56
    s_cbranch_vccnz K2_RT6
    ds_add_rtn_u32 v46, v46, v201
    v_mad_u32_u24 v56, v56, s58, v202
    v_and_b32 v27, 0xffffff, v27
    v_cmpx_gt_u32 vcc, s62, v56
    buffer_load_dword v245, v27, s[16:19], 0 offen
    s_mov_b64 exec, s[92:93]
    s_cbranch_execz K2_RK_A
K2_CK7:
    v_bfi_b32 v192, s61, v29, v30
    v_lshrrev_b32 v57, 24, v31
    v_cmp_ne_u32 vcc, s2, v192
    v_add_u32 v47, 163424, v57
    s_cbranch_vccnz K2_RT7
    ds_add_rtn_u32 v47, v47, v201
    v_mad_u32_u24 v57, v57, s58, v202
    v_and_b32 v31, 0xffffff, v31
    v_cmpx_gt_u32 vcc, s62, v57
    buffer_load_dword v245, v31, s[16:19], 0 offen
    s_mov_b64 exec, s[94:95]
    s_cbranch_execz K2_RK_A
K2_CK8:
    v_bfi_b32 v192, s61, v33, v34
    v_lshrrev_b32 v58, 24, v35
    v_cmp_ne_u32 vcc, s2, v192
    v_add_u32 v48, 163424, v58
    s_cbranch_vccnz K2_RT8
    ds_add_rtn_u32 v48, v48, v201
    v_mad_u32_u24 v58, v58, s58, v202
    v_and_b32 v35, 0xffffff, v35
    v_cmpx_gt_u32 vcc, s62, v58
    buffer_load_dword v245, v35, s[16:19], 0 offen
    s_mov_b64 exec, s[96:97]
    s_cbranch_execz K2_RK_A
K2_CK9:
    v_bfi_b32 v192, s61, v37, v38
    v_lshrrev_b32 v59, 24, v39
    v_cmp_ne_u32 vcc, s2, v192
    v_add_u32 v49, 163424, v59
    s_cbranch_vccnz K2_RT9
    ds_add_rtn_u32 v49, v49, v201
    v_mad_u32_u24 v59, v59, s58, v202
    v_and_b32 v39, 0xffffff, v39
    v_cmpx_gt_u32 vcc, s62, v59
    buffer_load_dword v245, v39, s[16:19], 0 offen
K2_RK_A:
    s_mov_b64 exec, -1
    s_cmp_eq_u32 s20, 7
    s_cbranch_scc1 K2_FLGCK
K2_FLGOK:
K2_RK_DONE:
    s_mul_i32 s67, s24, 48
    s_waitcnt lgkmcnt(0)
    s_mov_b64 exec, s[40:41]
    s_cbranch_execz K2_SC_DONE
    v_cmpx_gt_u32 vcc, 48, v40
    v_lshl_add_u32 v194, v40, 5, v50
    v_lshl_add_u32 v195, v40, 2, v50
    v_lshrrev_b32 v193, 3, v40
    v_mad_i32_i24 v196, v193, -16, v195
    v_and_b32 v193, 1, v193
    v_mad_i32_i24 v196, v193, -14, v196
    ds_write_b32 v194, v3 offset:864
    ds_write_b16 v195, v0 offset:194
    ds_write_b16_d16_hi v195, v0 offset:386
    ds_write_b16_d16_hi v195, v1 offset:578
    ds_write_b16 v196, v2 offset:768
    s_mov_b64 exec, s[42:43]
    s_cbranch_execz K2_SC_DONE
    v_cmpx_gt_u32 vcc, 48, v41
    v_lshl_add_u32 v194, v41, 5, v51
    v_lshl_add_u32 v195, v41, 2, v51
    v_lshrrev_b32 v193, 3, v41
    v_mad_i32_i24 v196, v193, -16, v195
    v_and_b32 v193, 1, v193
    v_mad_i32_i24 v196, v193, -14, v196
    ds_write_b32 v194, v7 offset:864
    ds_write_b16 v195, v4 offset:194
    ds_write_b16_d16_hi v195, v4 offset:386
    ds_write_b16_d16_hi v195, v5 offset:578
    ds_write_b16 v196, v6 offset:768
    s_mov_b64 exec, s[44:45]
    s_cbranch_execz K2_SC_DONE
    v_cmpx_gt_u32 vcc, 48, v42
    v_lshl_add_u32 v194, v42, 5, v52
    v_lshl_add_u32 v195, v42, 2, v52
    v_lshrrev_b32 v193, 3, v42
    v_mad_i32_i24 v196, v193, -16, v195
    v_and_b32 v193, 1, v193
    v_mad_i32_i24 v196, v193, -14, v196
    ds_write_b32 v194, v11 offset:864
    ds_write_b16 v195, v8 offset:194
    ds_write_b16_d16_hi v195, v8 offset:386
    ds_write_b16_d16_hi v195, v9 offset:578
    ds_write_b16 v196, v10 offset:768
    s_mov_b64 exec, s[46:47]
    s_cbranch_execz K2_SC_DONE
    v_cmpx_gt_u32 vcc, 48, v43
    v_lshl_add_u32 v194, v43, 5, v53
    v_lshl_add_u32 v195, v43, 2, v53
    v_lshrrev_b32 v193, 3, v43
    v_mad_i32_i24 v196, v193, -16, v195
    v_and_b32 v193, 1, v193
    v_mad_i32_i24 v196, v193, -14, v196
    ds_write_b32 v194, v15 offset:864
    ds_write_b16 v195, v12 offset:194
    ds_write_b16_d16_hi v195, v12 offset:386
    ds_write_b16_d16_hi v195, v13 offset:578
    ds_write_b16 v196, v14 offset:768
    s_mov_b64 exec, s[48:49]
    s_cbranch_execz K2_SC_DONE
    v_cmpx_gt_u32 vcc, 48, v44
    v_lshl_add_u32 v194, v44, 5, v54
    v_lshl_add_u32 v195, v44, 2, v54
    v_lshrrev_b32 v193, 3, v44
    v_mad_i32_i24 v196, v193, -16, v195
    v_and_b32 v193, 1, v193
    v_mad_i32_i24 v196, v193, -14, v196
    ds_write_b32 v194, v19 offset:864
    ds_write_b16 v195, v16 offset:194
    ds_write_b16_d16_hi v195, v16 offset:386
    ds_write_b16_d16_hi v195, v17 offset:578
    ds_write_b16 v196, v18 offset:768
    s_mov_b64 exec, s[50:51]
    s_cbranch_execz K2_SC_DONE
    v_cmpx_gt_u32 vcc, 48, v45
    v_lshl_add_u32 v194, v45, 5, v55
    v_lshl_add_u32 v195, v45, 2, v55
    v_lshrrev_b32 v193, 3, v45
    v_mad_i32_i24 v196, v193, -16, v195
    v_and_b32 v193, 1, v193
    v_mad_i32_i24 v196, v193, -14, v196
    ds_write_b32 v194, v23 offset:864
    ds_write_b16 v195, v20 offset:194
    ds_write_b16_d16_hi v195, v20 offset:386
    ds_write_b16_d16_hi v195, v21 offset:578
    ds_write_b16 v196, v22 offset:768
    s_mov_b64 exec, s[90:91]
    s_cbranch_execz K2_SC_DONE
    v_cmpx_gt_u32 vcc, 48, v46
    v_lshl_add_u32 v194, v46, 5, v56
    v_lshl_add_u32 v195, v46, 2, v56
    v_lshrrev_b32 v193, 3, v46
    v_mad_i32_i24 v196, v193, -16, v195
    v_and_b32 v193, 1, v193
    v_mad_i32_i24 v196, v193, -14, v196
    ds_write_b32 v194, v27 offset:864
    ds_write_b16 v195, v24 offset:194
    ds_write_b16_d16_hi v195, v24 offset:386
    ds_write_b16_d16_hi v195, v25 offset:578
    ds_write_b16 v196, v26 offset:768
    s_mov_b64 exec, s[92:93]
    s_cbranch_execz K2_SC_DONE
    v_cmpx_gt_u32 vcc, 48, v47
    v_lshl_add_u32 v194, v47, 5, v57
    v_lshl_add_u32 v195, v47, 2, v57
    v_lshrrev_b32 v193, 3, v47
    v_mad_i32_i24 v196, v193, -16, v195
    v_and_b32 v193, 1, v193
    v_mad_i32_i24 v196, v193, -14, v196
    ds_write_b32 v194, v31 offset:864
    ds_write_b16 v195, v28 offset:194
    ds_write_b16_d16_hi v195, v28 offset:386
    ds_write_b16_d16_hi v195, v29 offset:578
    ds_write_b16 v196, v30 offset:768
    s_mov_b64 exec, s[94:95]
    s_cbranch_execz K2_SC_DONE
    v_cmpx_gt_u32 vcc, 48, v48
    v_lshl_add_u32 v194, v48, 5, v58
    v_lshl_add_u32 v195, v48, 2, v58
    v_lshrrev_b32 v193, 3, v48
    v_mad_i32_i24 v196, v193, -16, v195
    v_and_b32 v193, 1, v193
    v_mad_i32_i24 v196, v193, -14, v196
    ds_write_b32 v194, v35 offset:864
    ds_write_b16 v195, v32 offset:194
    ds_write_b16_d16_hi v195, v32 offset:386
    ds_write_b16_d16_hi v195, v33 offset:578
    ds_write_b16 v196, v34 offset:768
    s_mov_b64 exec, s[96:97]
    s_cbranch_execz K2_SC_DONE
    v_cmpx_gt_u32 vcc, 48, v49
    v_lshl_add_u32 v194, v49, 5, v59
    v_lshl_add_u32 v195, v49, 2, v59
    v_lshrrev_b32 v193, 3, v49
    v_mad_i32_i24 v196, v193, -16, v195
    v_and_b32 v193, 1, v193
    v_mad_i32_i24 v196, v193, -14, v196
    ds_write_b32 v194, v39 offset:864
    ds_write_b16 v195, v36 offset:194
    ds_write_b16_d16_hi v195, v36 offset:386
    ds_write_b16_d16_hi v195, v37 offset:578
    ds_write_b16 v196, v38 offset:768
K2_SC_DONE:
    s_mov_b64 exec, -1
    v_lshlrev_b32 v192, 2, v176
    v_add_u32 v192, 163424, v192
    v_mov_b32 v200, 163652
    v_mov_b32 v198, 0
    s_movk_i32 s26, 48
    s_waitcnt lgkmcnt(0)
    s_barrier
    ds_read_b32 v193, v192
    ds_read_b32 v200, v200
    v_cmp_gt_u32 s[56:57], s22, v176
    v_mad_u32_u24 v195, v176, s59, v202
    v_lshl_or_b32 v195, v176, 21, v195
    s_waitcnt lgkmcnt(0)
    v_cndmask_b32 v193, 0, v193, s[56:57]
    v_readfirstlane_b32 s27, v200
    v_cmp_lt_u32 vcc, 48, v193
    s_nop 0
    s_cbranch_vccnz K2_BIG
K2_TOK:
    v_subrev_u32 v194, s67, v193
    v_max_i32 v194, 1, v194
    v_min_i32 v194, s26, v194
    v_add_u32 v194, 15, v194
    v_lshrrev_b32 v194, 4, v194
    v_lshl_or_b32 v195, v194, 18, v195
    v_or_b32 v195, v195, v198
    v_mov_b32 v197, 425056
    v_cndmask_b32 v253, v197, v195, s[56:57]
    s_movk_i32 s40, 0
    s_movk_i32 s41, 256
    s_movk_i32 s42, 512
    s_movk_i32 s43, 768
    s_add_u32 s24, s24, 1
    s_cmp_ge_u32 s24, s25
    s_cselect_b32 s55, 1, 0
    s_cmp_eq_u32 s27, 0
    s_cselect_b32 s55, s55, 0
    s_mov_b32 s38, 0
    s_mov_b32 s34, 0
    s_mov_b32 s35, 0
    s_mov_b32 s36, 1
    s_mov_b32 s31, 0
    s_mov_b32 s58, s20
    v_readlane_b32 s3, v253, s58
    s_lshl_b32 s44, s34, 7
    s_lshl_b32 s60, s58, 5
    s_and_b32 s48, s3, 0x3ffff
    s_bfe_u32 s33, s3, 0x30012
    s_sub_u32 s60, s60, s48
    s_and_b32 s60, s60, 0xff
    s_add_u32 s60, s60, s48
    s_mul_i32 s35, s38, 6
    s_cmp_eq_u32 s34, 0
    s_cselect_b32 s35, s35, s60
    s_mov_b32 s45, s44
    s_add_u32 s47, s44, 256
    s_add_u32 s49, s48, 32
    s_add_u32 s60, s48, 64
    s_cmp_eq_u32 s33, 3
    s_cselect_b32 s46, s44, s47
    s_cselect_b32 s50, s60, s48
    s_cselect_b32 s51, s48, s49
    s_sub_u32 s60, s33, 2
    s_cmp_lt_u32 s60, 2
    s_cbranch_scc0 K2_rare_11
K2_back_12:
    v_add_u32 v233, s48, v230
    ds_read_b32 v232, v233
    ds_read_b32 v233, v233 offset:1024
    v_add_u32 v222, s48, v251
    ds_read_b32 v222, v222
    v_add_u32 v224, s49, v251
    ds_read_b32 v224, v224
    v_add_u32 v226, s50, v251
    ds_read_b32 v226, v226
    v_add_u32 v228, s51, v251
    ds_read_b32 v228, v228
    s_waitcnt lgkmcnt(4)
    v_or_b32 v232, v232, v231
    v_or_b32 v233, v233, v231
    s_cmp_lg_u32 s34, 0
    s_cbranch_scc1 K2_dum_14
    s_add_u32 m0, s48, 864
    s_add_u32 s65, s48, 1888
    buffer_load_dwordx4 v232, s[16:19], 0 offen  lds
    s_mov_b32 m0, s65
    s_mov_b32 exec_hi, 0
    buffer_load_dwordx4 v233, s[16:19], 0 offen  lds
    s_cmp_eq_u32 s33, 4
    s_cbranch_scc1 K2_a4_15
K2_b4_17:
    s_mov_b32 exec_hi, -1
K2_back_16:
    s_waitcnt lgkmcnt(3)
    v_mad_u32_u16 v223, v222, s39, v248 op_sel:[1,0,0,0]
    v_mad_u32_u16 v222, v222, s39, v248
    s_waitcnt lgkmcnt(2)
    v_mad_u32_u16 v225, v224, s39, v248 op_sel:[1,0,0,0]
    v_mad_u32_u16 v224, v224, s39, v248
    s_waitcnt lgkmcnt(1)
    v_mad_u32_u16 v227, v226, s39, v248 op_sel:[1,0,0,0]
    v_mad_u32_u16 v226, v226, s39, v248
    s_waitcnt lgkmcnt(0)
    v_mad_u32_u16 v229, v228, s39, v248 op_sel:[1,0,0,0]
    v_mad_u32_u16 v228, v228, s39, v248
    s_mov_b32 m0, s68
    s_nop 0
    buffer_load_dwordx4 v222, s[4:7], s44 offen lds
    buffer_load_dwordx4 v223, s[72:75], s44 offen offset:1024 lds
    s_barrier
    s_mov_b32 m0, s69
    s_nop 0
    buffer_load_dwordx4 v224, s[4:7], s45 offen lds
    buffer_load_dwordx4 v225, s[72:75], s45 offen offset:1024 lds
    s_mov_b32 m0, s70
    s_nop 0
    buffer_load_dwordx4 v226, s[4:7], s46 offen lds
    buffer_load_dwordx4 v227, s[72:75], s46 offen offset:1024 lds
    s_mov_b32 m0, s71
    s_nop 0
    buffer_load_dwordx4 v228, s[4:7], s47 offen lds
    buffer_load_dwordx4 v229, s[72:75], s47 offen offset:1024 lds
    v_add_u32 v249, s48, v249
    v_add_u32 v250, s48, v250
    s_waitcnt vmcnt(6)
    ds_read_b64_tr_b16 v[176:177], v246 offset:0
    ds_read_b64_tr_b16 v[178:179], v246 offset:512
    ds_read_b64_tr_b16 v[180:181], v247 offset:0
    ds_read_b64_tr_b16 v[182:183], v247 offset:512
    ds_read_b64_tr_b16 v[0:1], v249 offset:0
    ds_read_b64_tr_b16 v[2:3], v249 offset:128
    ds_read_b128 v[4:7], v250 offset:0
    ds_read_b128 v[8:11], v250 offset:16
    ds_read_b128 v[12:15], v250 offset:384
    ds_read_b128 v[16:19], v250 offset:400
    ds_read_b64_tr_b16 v[20:21], v249 offset:512
    ds_read_b64_tr_b16 v[22:23], v249 offset:640
    ds_read_b128 v[24:27], v250 offset:64
    ds_read_b128 v[28:31], v250 offset:80
    ds_read_b128 v[32:35], v250 offset:448
    ds_read_b128 v[36:39], v250 offset:464
    s_mov_b32 s29, s48
    s_mov_b32 s32, s31
    s_mov_b32 s30, s3
    s_mov_b32 s31, s35
    s_cmp_eq_u32 s33, 2
    s_cbranch_scc1 K2_U20
    s_cmp_eq_u32 s33, 3
    s_cbranch_scc1 K2_U30
    s_cmp_eq_u32 s33, 1
    s_cbranch_scc1 K2_U10
    s_branch K2_U40
K2_U20:
    s_setprio 1
    s_waitcnt lgkmcnt(6)
    v_lshlrev_b32 v40, 16, v0
    v_and_b32 v41, 0xffff0000, v0
    v_lshlrev_b32 v42, 16, v1
    v_and_b32 v43, 0xffff0000, v1
    v_lshlrev_b32 v44, 16, v2
    v_and_b32 v45, 0xffff0000, v2
    v_lshlrev_b32 v46, 16, v3
    v_and_b32 v47, 0xffff0000, v3
    v_mul_f32 v4, v40, v4
    v_mul_f32 v5, v41, v5
    v_mul_f32 v6, v42, v6
    v_mul_f32 v7, v43, v7
    v_mul_f32 v8, v44, v8
    v_mul_f32 v9, v45, v9
    v_mul_f32 v10, v46, v10
    v_mul_f32 v11, v47, v11
    v_cvt_pk_bf16_f32 v64, v4, v5
    v_cvt_pk_bf16_f32 v65, v6, v7
    v_cvt_pk_bf16_f32 v66, v8, v9
    v_cvt_pk_bf16_f32 v67, v10, v11
    v_mul_f32 v12, v40, v12
    v_mul_f32 v13, v41, v13
    v_mul_f32 v14, v42, v14
    v_mul_f32 v15, v43, v15
    v_mul_f32 v16, v44, v16
    v_mul_f32 v17, v45, v17
    v_mul_f32 v18, v46, v18
    v_mul_f32 v19, v47, v19
    v_cvt_pk_bf16_f32 v68, v12, v13
    v_cvt_pk_bf16_f32 v69, v14, v15
    v_cvt_pk_bf16_f32 v70, v16, v17
    v_cvt_pk_bf16_f32 v71, v18, v19
    s_waitcnt lgkmcnt(0)
    v_lshlrev_b32 v48, 16, v20
    v_and_b32 v49, 0xffff0000, v20
    v_lshlrev_b32 v50, 16, v21
    v_and_b32 v51, 0xffff0000, v21
    v_lshlrev_b32 v52, 16, v22
    v_and_b32 v53, 0xffff0000, v22
    v_lshlrev_b32 v54, 16, v23
    v_and_b32 v55, 0xffff0000, v23
    v_mul_f32 v24, v48, v24
    v_mul_f32 v25, v49, v25
    v_mul_f32 v26, v50, v26
    v_mul_f32 v27, v51, v27
    v_mul_f32 v28, v52, v28
    v_mul_f32 v29, v53, v29
    v_mul_f32 v30, v54, v30
    v_mul_f32 v31, v55, v31
    v_cvt_pk_bf16_f32 v72, v24, v25
    v_cvt_pk_bf16_f32 v73, v26, v27
    v_cvt_pk_bf16_f32 v74, v28, v29
    v_cvt_pk_bf16_f32 v75, v30, v31
    v_mul_f32 v32, v48, v32
    v_mul_f32 v33, v49, v33
    v_mul_f32 v34, v50, v34
    v_mul_f32 v35, v51, v35
    v_mul_f32 v36, v52, v36
    v_mul_f32 v37, v53, v37
    v_mul_f32 v38, v54, v38
    v_mul_f32 v39, v55, v39
    v_cvt_pk_bf16_f32 v76, v32, v33
    v_cvt_pk_bf16_f32 v77, v34, v35
    v_cvt_pk_bf16_f32 v78, v36, v37
    v_cvt_pk_bf16_f32 v79, v38, v39
    s_waitcnt vmcnt(4)
    v_mfma_f32_32x32x16_bf16 v[0:15], v[64:67], v[176:179], 0
    ds_read_b64_tr_b16 v[184:185], v246 offset:2048
    ds_read_b64_tr_b16 v[186:187], v246 offset:2560
    ds_read_b64_tr_b16 v[188:189], v247 offset:2048
    ds_read_b64_tr_b16 v[190:191], v247 offset:2560
    s_mov_b32 m0, s68
    v_mfma_f32_32x32x16_bf16 v[16:31], v[68:71], v[176:179], 0
    buffer_load_dwordx4 v222, s[4:7], s42 offen lds
    buffer_load_dwordx4 v223, s[72:75], s42 offen offset:1024 lds
    v_permlane32_swap_b32 v242, v236
    v_permlane32_swap_b32 v243, v237
    s_add_u32 s38, s38, 1
    v_mfma_f32_32x32x16_bf16 v[32:47], v[64:67], v[180:183], 0
    v_permlane32_swap_b32 v244, v238
    v_permlane32_swap_b32 v245, v239
    v_permlane32_swap_b32 v240, v241
    v_add_f32 v242, v242, v236
    v_mfma_f32_32x32x16_bf16 v[48:63], v[68:71], v[180:183], 0
    v_add_f32 v243, v243, v237
    v_add_f32 v244, v244, v238
    v_add_f32 v245, v245, v239
    v_add_f32 v240, -v240, -v241
    v_mov_b32 v254, s52
    v_mov_b32 v255, s38
    s_waitcnt vmcnt(4) lgkmcnt(0)
    v_mfma_f32_32x32x16_bf16 v[0:15], v[72:75], v[184:187], v[0:15]
    ds_read_b64_tr_b16 v[176:177], v246 offset:4096
    ds_read_b64_tr_b16 v[178:179], v246 offset:4608
    ds_read_b64_tr_b16 v[180:181], v247 offset:4096
    ds_read_b64_tr_b16 v[182:183], v247 offset:4608
    s_lshl_b32 s58, s38, 3
    s_add_u32 s58, s58, s20
    s_mov_b32 m0, s69
    v_mfma_f32_32x32x16_bf16 v[16:31], v[76:79], v[184:187], v[16:31]
    buffer_load_dwordx4 v224, s[4:7], s42 offen lds
    buffer_load_dwordx4 v225, s[72:75], s42 offen offset:1024 lds
    s_set_gpr_idx_on s32, gpr_idx(DST)
    s_nop 0
    v_cvt_pk_bf16_f32 v195, v242, v243
    v_cvt_pk_bf16_f32 v196, v244, v245
    v_cvt_pk_bf16_f32 v197, v240, v240
    s_set_gpr_idx_off
    s_mov_b64 exec, 1
    ds_write_b32 v254, v255
    s_mov_b64 exec, -1
    s_cmp_lt_u32 s58, s22
    s_cbranch_scc0 K2_dyn_18
K2_back_19:
    v_readlane_b32 s3, v253, s58
    s_lshl_b32 s44, s34, 7
    s_lshl_b32 s60, s58, 5
    s_and_b32 s48, s3, 0x3ffff
    s_bfe_u32 s33, s3, 0x30012
    s_sub_u32 s60, s60, s48
    s_and_b32 s60, s60, 0xff
    s_add_u32 s60, s60, s48
    s_mul_i32 s35, s38, 6
    s_cmp_eq_u32 s34, 0
    s_cselect_b32 s35, s35, s60
    s_mov_b32 s45, s44
    s_add_u32 s47, s44, 256
    s_add_u32 s49, s48, 32
    s_add_u32 s60, s48, 64
    s_cmp_eq_u32 s33, 3
    s_cselect_b32 s46, s44, s47
    s_cselect_b32 s50, s60, s48
    s_cselect_b32 s51, s48, s49
    s_sub_u32 s60, s33, 2
    s_cmp_lt_u32 s60, 2
    s_cbranch_scc0 K2_rare_24
K2_back_25:
    v_mfma_f32_32x32x16_bf16 v[32:47], v[72:75], v[188:191], v[32:47]
    v_add_u32 v233, s48, v230
    ds_read_b32 v232, v233
    ds_read_b32 v233, v233 offset:1024
    v_mul_f32 v234, v0, v96
    v_mul_f32 v236, v8, v128
    v_fmac_f32 v234, v1, v97
    v_fmac_f32 v236, v9, v129
    v_mfma_f32_32x32x16_bf16 v[48:63], v[76:79], v[188:191], v[48:63]
    s_setprio 0
    v_fmac_f32 v234, v2, v98
    v_fmac_f32 v236, v10, v130
    v_fmac_f32 v234, v3, v99
    v_fmac_f32 v236, v11, v131
    v_fmac_f32 v234, v4, v100
    v_fmac_f32 v236, v12, v132
    v_fmac_f32 v234, v5, v101
    v_fmac_f32 v236, v13, v133
    v_fmac_f32 v234, v6, v102
    v_fmac_f32 v236, v14, v134
    v_fmac_f32 v234, v7, v103
    v_fmac_f32 v236, v15, v135
    v_mul_f32 v238, v16, v128
    v_mul_f32 v240, v24, v128
    v_fmac_f32 v238, v17, v129
    v_fmac_f32 v240, v25, v129
    v_fmac_f32 v238, v18, v130
    v_fmac_f32 v240, v26, v130
    v_fmac_f32 v238, v19, v131
    v_fmac_f32 v240, v27, v131
    v_fmac_f32 v238, v20, v132
    v_fmac_f32 v240, v28, v132
    v_fmac_f32 v238, v21, v133
    v_fmac_f32 v240, v29, v133
    v_fmac_f32 v238, v22, v134
    v_fmac_f32 v240, v30, v134
    v_fmac_f32 v238, v23, v135
    v_fmac_f32 v240, v31, v135
    v_mul_f32 v235, v32, v104
    v_mul_f32 v237, v40, v136
    v_fmac_f32 v235, v33, v105
    v_fmac_f32 v237, v41, v137
    v_fmac_f32 v235, v34, v106
    v_fmac_f32 v237, v42, v138
    v_fmac_f32 v235, v35, v107
    v_fmac_f32 v237, v43, v139
    v_fmac_f32 v235, v36, v108
    v_fmac_f32 v237, v44, v140
    v_fmac_f32 v235, v37, v109
    v_fmac_f32 v237, v45, v141
    v_fmac_f32 v235, v38, v110
    v_fmac_f32 v237, v46, v142
    v_fmac_f32 v235, v39, v111
    v_fmac_f32 v237, v47, v143
    v_mul_f32 v239, v48, v136
    v_mul_f32 v241, v56, v136
    v_fmac_f32 v239, v49, v137
    v_fmac_f32 v241, v57, v137
    s_setprio 1
    s_waitcnt vmcnt(4) lgkmcnt(3)
    v_mfma_f32_32x32x16_bf16 v[0:15], v[64:67], v[176:179], 0
    ds_read_b64_tr_b16 v[184:185], v246 offset:6144
    ds_read_b64_tr_b16 v[186:187], v246 offset:6656
    ds_read_b64_tr_b16 v[188:189], v247 offset:6144
    ds_read_b64_tr_b16 v[190:191], v247 offset:6656
    v_fmac_f32 v239, v50, v138
    v_fmac_f32 v241, v58, v138
    s_mov_b32 m0, s70
    v_mfma_f32_32x32x16_bf16 v[16:31], v[68:71], v[176:179], 0
    buffer_load_dwordx4 v222, s[4:7], s43 offen lds
    buffer_load_dwordx4 v223, s[72:75], s43 offen offset:1024 lds
    v_fmac_f32 v239, v51, v139
    v_fmac_f32 v241, v59, v139
    v_fmac_f32 v239, v52, v140
    v_fmac_f32 v241, v60, v140
    v_fmac_f32 v239, v53, v141
    v_mfma_f32_32x32x16_bf16 v[32:47], v[64:67], v[180:183], 0
    v_add_u32 v222, s48, v251
    ds_read_b32 v222, v222
    v_fmac_f32 v241, v61, v141
    v_fmac_f32 v239, v54, v142
    v_fmac_f32 v241, v62, v142
    v_fmac_f32 v239, v55, v143
    v_fmac_f32 v241, v63, v143
    v_mfma_f32_32x32x16_bf16 v[48:63], v[68:71], v[180:183], 0
    v_permlane32_swap_b32 v234, v236
    v_permlane32_swap_b32 v235, v237
    v_permlane32_swap_b32 v240, v238
    s_waitcnt lgkmcnt(5)
    v_or_b32 v232, v232, v231
    v_or_b32 v233, v233, v231
    s_cmp_lg_u32 s34, 0
    s_cbranch_scc1 K2_dum_27
    s_add_u32 m0, s48, 864
    s_add_u32 s65, s48, 1888
    buffer_load_dwordx4 v232, s[16:19], 0 offen  lds
    s_mov_b32 m0, s65
    s_mov_b32 exec_hi, 0
    buffer_load_dwordx4 v233, s[16:19], 0 offen  lds
    s_cmp_eq_u32 s33, 4
    s_cbranch_scc1 K2_a4_28
K2_b4_30:
    s_mov_b32 exec_hi, -1
K2_back_29:
    s_waitcnt vmcnt(6) lgkmcnt(1)
    v_mfma_f32_32x32x16_bf16 v[0:15], v[72:75], v[184:187], v[0:15]
    ds_read_b64_tr_b16 v[176:177], v246 offset:0
    ds_read_b64_tr_b16 v[178:179], v246 offset:512
    ds_read_b64_tr_b16 v[180:181], v247 offset:0
    ds_read_b64_tr_b16 v[182:183], v247 offset:512
    v_permlane32_swap_b32 v241, v239
    s_mov_b32 m0, s71
    v_mfma_f32_32x32x16_bf16 v[16:31], v[76:79], v[184:187], v[16:31]
    buffer_load_dwordx4 v224, s[4:7], s43 offen lds
    buffer_load_dwordx4 v225, s[72:75], s43 offen offset:1024 lds
    s_waitcnt lgkmcnt(4)
    v_mad_u32_u16 v223, v222, s39, v248 op_sel:[1,0,0,0]
    v_mad_u32_u16 v222, v222, s39, v248
    v_add_f32 v234, v234, v236
    v_add_f32 v235, v235, v237
    v_add_f32 v240, v240, v238
    v_add_f32 v241, v241, v239
    s_set_gpr_idx_on s31, gpr_idx(DST)
    s_nop 0
    v_cvt_pk_bf16_f32 v192, v234, v235
    v_cvt_pk_bf16_f32 v193, v240, v241
    s_set_gpr_idx_off
    v_mfma_f32_32x32x16_bf16 v[32:47], v[72:75], v[188:191], v[32:47]
    v_add_u32 v224, s49, v251
    ds_read_b32 v224, v224
    v_mul_f32 v234, v0, v144
    v_mul_f32 v236, v8, v112
    v_fmac_f32 v234, v1, v145
    v_fmac_f32 v236, v9, v113
    v_fmac_f32 v234, v2, v146
    v_mfma_f32_32x32x16_bf16 v[48:63], v[76:79], v[188:191], v[48:63]
    s_setprio 0
    v_fmac_f32 v236, v10, v114
    v_fmac_f32 v234, v3, v147
    v_fmac_f32 v236, v11, v115
    v_fmac_f32 v234, v4, v148
    v_fmac_f32 v236, v12, v116
    v_fmac_f32 v234, v5, v149
    v_fmac_f32 v236, v13, v117
    v_fmac_f32 v234, v6, v150
    v_fmac_f32 v236, v14, v118
    v_fmac_f32 v234, v7, v151
    v_fmac_f32 v236, v15, v119
    v_mul_f32 v238, v16, v160
    v_mul_f32 v240, v24, v160
    v_fmac_f32 v238, v17, v161
    v_fmac_f32 v240, v25, v161
    v_fmac_f32 v238, v18, v162
    v_fmac_f32 v240, v26, v162
    v_fmac_f32 v238, v19, v163
    v_fmac_f32 v240, v27, v163
    v_fmac_f32 v238, v20, v164
    v_fmac_f32 v240, v28, v164
    v_fmac_f32 v238, v21, v165
    v_fmac_f32 v240, v29, v165
    v_fmac_f32 v238, v22, v166
    v_fmac_f32 v240, v30, v166
    v_fmac_f32 v238, v23, v167
    v_fmac_f32 v240, v31, v167
    v_mul_f32 v235, v32, v152
    v_mul_f32 v237, v40, v120
    v_fmac_f32 v235, v33, v153
    v_fmac_f32 v237, v41, v121
    v_fmac_f32 v235, v34, v154
    v_fmac_f32 v237, v42, v122
    v_fmac_f32 v235, v35, v155
    v_fmac_f32 v237, v43, v123
    v_fmac_f32 v235, v36, v156
    v_fmac_f32 v237, v44, v124
    v_fmac_f32 v235, v37, v157
    v_fmac_f32 v237, v45, v125
    v_fmac_f32 v235, v38, v158
    v_fmac_f32 v237, v46, v126
    v_fmac_f32 v235, v39, v159
    v_fmac_f32 v237, v47, v127
    v_mul_f32 v239, v48, v168
    v_mul_f32 v241, v56, v168
    v_fmac_f32 v239, v49, v169
    v_fmac_f32 v241, v57, v169
    v_fmac_f32 v239, v50, v170
    v_fmac_f32 v241, v58, v170
    v_fmac_f32 v239, v51, v171
    s_setprio 1
    s_waitcnt vmcnt(6) lgkmcnt(1)
    v_mfma_f32_32x32x16_bf16 v[0:15], v[64:67], v[176:179], 0
    ds_read_b64_tr_b16 v[184:185], v246 offset:2048
    ds_read_b64_tr_b16 v[186:187], v246 offset:2560
    ds_read_b64_tr_b16 v[188:189], v247 offset:2048
    ds_read_b64_tr_b16 v[190:191], v247 offset:2560
    v_fmac_f32 v241, v59, v171
    v_fmac_f32 v239, v52, v172
    s_mov_b32 m0, s68
    v_mfma_f32_32x32x16_bf16 v[16:31], v[68:71], v[176:179], 0
    buffer_load_dwordx4 v222, s[4:7], s44 offen lds
    buffer_load_dwordx4 v223, s[72:75], s44 offen offset:1024 lds
    s_waitcnt lgkmcnt(4)
    v_mad_u32_u16 v225, v224, s39, v248 op_sel:[1,0,0,0]
    v_mad_u32_u16 v224, v224, s39, v248
    v_fmac_f32 v241, v60, v172
    v_fmac_f32 v239, v53, v173
    v_mfma_f32_32x32x16_bf16 v[32:47], v[64:67], v[180:183], 0
    v_add_u32 v226, s50, v251
    ds_read_b32 v226, v226
    v_fmac_f32 v241, v61, v173
    v_fmac_f32 v239, v54, v174
    v_fmac_f32 v241, v62, v174
    v_fmac_f32 v239, v55, v175
    v_fmac_f32 v241, v63, v175
    v_mfma_f32_32x32x16_bf16 v[48:63], v[68:71], v[180:183], 0
    s_waitcnt vmcnt(6) lgkmcnt(1)
    v_mfma_f32_32x32x16_bf16 v[0:15], v[72:75], v[184:187], v[0:15]
    ds_read_b64_tr_b16 v[176:177], v246 offset:4096
    ds_read_b64_tr_b16 v[178:179], v246 offset:4608
    ds_read_b64_tr_b16 v[180:181], v247 offset:4096
    ds_read_b64_tr_b16 v[182:183], v247 offset:4608
    s_mov_b32 m0, s69
    v_mfma_f32_32x32x16_bf16 v[16:31], v[76:79], v[184:187], v[16:31]
    buffer_load_dwordx4 v224, s[4:7], s45 offen lds
    buffer_load_dwordx4 v225, s[72:75], s45 offen offset:1024 lds
    s_waitcnt lgkmcnt(4)
    v_mad_u32_u16 v227, v226, s39, v248 op_sel:[1,0,0,0]
    v_mad_u32_u16 v226, v226, s39, v248
    v_mfma_f32_32x32x16_bf16 v[32:47], v[72:75], v[188:191], v[32:47]
    v_add_u32 v228, s51, v251
    ds_read_b32 v228, v228
    v_mul_f32 v242, v0, v144
    v_fma_f32 v238, v8, v160, -v238
    v_fmac_f32 v242, v1, v145
    v_fmac_f32 v238, v9, v161
    v_fmac_f32 v242, v2, v146
    v_mfma_f32_32x32x16_bf16 v[48:63], v[76:79], v[188:191], v[48:63]
    s_setprio 0
    v_fmac_f32 v238, v10, v162
    v_fmac_f32 v242, v3, v147
    v_fmac_f32 v238, v11, v163
    v_fmac_f32 v242, v4, v148
    v_fmac_f32 v238, v12, v164
    v_fmac_f32 v242, v5, v149
    v_fmac_f32 v238, v13, v165
    v_fmac_f32 v242, v6, v150
    v_fmac_f32 v238, v14, v166
    v_fmac_f32 v242, v7, v151
    v_fmac_f32 v238, v15, v167
    v_fmac_f32 v236, v16, v112
    v_mul_f32 v244, v24, v160
    v_fmac_f32 v236, v17, v113
    v_fmac_f32 v244, v25, v161
    v_fmac_f32 v236, v18, v114
    v_fmac_f32 v244, v26, v162
    v_fmac_f32 v236, v19, v115
    v_fmac_f32 v244, v27, v163
    v_fmac_f32 v236, v20, v116
    v_fmac_f32 v244, v28, v164
    v_fmac_f32 v236, v21, v117
    v_fmac_f32 v244, v29, v165
    v_fmac_f32 v236, v22, v118
    v_fmac_f32 v244, v30, v166
    v_fmac_f32 v236, v23, v119
    v_fmac_f32 v244, v31, v167
    v_mul_f32 v243, v32, v152
    v_fma_f32 v239, v40, v168, -v239
    v_fmac_f32 v243, v33, v153
    v_fmac_f32 v239, v41, v169
    v_fmac_f32 v243, v34, v154
    v_fmac_f32 v239, v42, v170
    v_fmac_f32 v243, v35, v155
    v_fmac_f32 v239, v43, v171
    v_fmac_f32 v243, v36, v156
    v_fmac_f32 v239, v44, v172
    v_fmac_f32 v243, v37, v157
    v_fmac_f32 v239, v45, v173
    v_fmac_f32 v243, v38, v158
    v_fmac_f32 v239, v46, v174
    v_fmac_f32 v243, v39, v159
    v_fmac_f32 v239, v47, v175
    v_fmac_f32 v237, v48, v120
    v_mul_f32 v245, v56, v168
    v_fmac_f32 v237, v49, v121
    v_fmac_f32 v245, v57, v169
    v_fmac_f32 v237, v50, v122
    s_setprio 1
    s_waitcnt vmcnt(4) lgkmcnt(1)
    v_mfma_f32_32x32x16_bf16 v[0:15], v[64:67], v[176:179], 0
    ds_read_b64_tr_b16 v[184:185], v246 offset:6144
    ds_read_b64_tr_b16 v[186:187], v246 offset:6656
    ds_read_b64_tr_b16 v[188:189], v247 offset:6144
    ds_read_b64_tr_b16 v[190:191], v247 offset:6656
    v_fmac_f32 v245, v58, v170
    v_fmac_f32 v237, v51, v123
    s_mov_b32 m0, s70
    v_mfma_f32_32x32x16_bf16 v[16:31], v[68:71], v[176:179], 0
    buffer_load_dwordx4 v226, s[4:7], s46 offen lds
    buffer_load_dwordx4 v227, s[72:75], s46 offen offset:1024 lds
    s_waitcnt lgkmcnt(4)
    v_mad_u32_u16 v229, v228, s39, v248 op_sel:[1,0,0,0]
    v_mad_u32_u16 v228, v228, s39, v248
    v_fmac_f32 v245, v59, v171
    v_fmac_f32 v237, v52, v124
    v_mfma_f32_32x32x16_bf16 v[32:47], v[64:67], v[180:183], 0
    v_fmac_f32 v245, v60, v172
    v_fmac_f32 v237, v53, v125
    v_fmac_f32 v245, v61, v173
    v_fmac_f32 v237, v54, v126
    v_fmac_f32 v245, v62, v174
    v_fmac_f32 v237, v55, v127
    v_fmac_f32 v245, v63, v175
    v_mfma_f32_32x32x16_bf16 v[48:63], v[68:71], v[180:183], 0
    v_permlane32_swap_b32 v242, v234
    v_permlane32_swap_b32 v243, v235
    v_add_f32 v242, v242, v234
    v_add_f32 v243, v243, v235
    s_waitcnt vmcnt(4) lgkmcnt(0)
    v_mfma_f32_32x32x16_bf16 v[0:15], v[72:75], v[184:187], v[0:15]
    ds_read_b64_tr_b16 v[176:177], v246 offset:0
    ds_read_b64_tr_b16 v[178:179], v246 offset:512
    ds_read_b64_tr_b16 v[180:181], v247 offset:0
    ds_read_b64_tr_b16 v[182:183], v247 offset:512
    s_sub_u32 s26, s48, s29
    s_mov_b32 s29, s48
    s_mov_b32 m0, s71
    v_mfma_f32_32x32x16_bf16 v[16:31], v[76:79], v[184:187], v[16:31]
    buffer_load_dwordx4 v228, s[4:7], s47 offen lds
    buffer_load_dwordx4 v229, s[72:75], s47 offen offset:1024 lds
    s_set_gpr_idx_on s31, gpr_idx(DST)
    s_nop 0
    v_cvt_pk_bf16_f32 v194, v242, v243
    s_set_gpr_idx_off
    s_mov_b32 s30, s3
    s_cmp_eq_u32 s34, 0
    s_cselect_b32 s56, s33, 0
    v_mfma_f32_32x32x16_bf16 v[32:47], v[72:75], v[188:191], v[32:47]
    s_mov_b32 s32, s31
    s_mov_b32 s31, s35
    v_mul_f32 v242, v0, v144
    v_fma_f32 v240, v8, v160, -v240
    v_fmac_f32 v242, v1, v145
    v_fmac_f32 v240, v9, v161
    v_fmac_f32 v242, v2, v146
    v_mfma_f32_32x32x16_bf16 v[48:63], v[76:79], v[188:191], v[48:63]
    s_setprio 0
    v_fmac_f32 v240, v10, v162
    v_fmac_f32 v242, v3, v147
    v_fmac_f32 v240, v11, v163
    v_fmac_f32 v242, v4, v148
    v_fmac_f32 v240, v12, v164
    v_fmac_f32 v242, v5, v149
    v_fmac_f32 v240, v13, v165
    v_fmac_f32 v242, v6, v150
    v_fmac_f32 v240, v14, v166
    v_fmac_f32 v242, v7, v151
    v_fmac_f32 v240, v15, v167
    v_add_u32 v249, s26, v249
    v_add_u32 v250, s26, v250
    v_fma_f32 v244, v16, v160, -v244
    v_fmac_f32 v236, v24, v112
    v_fmac_f32 v244, v17, v161
    v_fmac_f32 v236, v25, v113
    v_fmac_f32 v244, v18, v162
    v_fmac_f32 v236, v26, v114
    v_fmac_f32 v244, v19, v163
    v_fmac_f32 v236, v27, v115
    v_fmac_f32 v244, v20, v164
    v_fmac_f32 v236, v28, v116
    v_fmac_f32 v244, v21, v165
    v_fmac_f32 v236, v29, v117
    v_fmac_f32 v244, v22, v166
    v_fmac_f32 v236, v30, v118
    v_fmac_f32 v244, v23, v167
    v_fmac_f32 v236, v31, v119
    ds_read_b64_tr_b16 v[0:1], v249 offset:0
    ds_read_b64_tr_b16 v[2:3], v249 offset:128
    ds_read_b128 v[4:7], v250 offset:0
    ds_read_b128 v[8:11], v250 offset:16
    ds_read_b128 v[12:15], v250 offset:384
    ds_read_b128 v[16:19], v250 offset:400
    v_mul_f32 v243, v32, v152
    v_fma_f32 v241, v40, v168, -v241
    v_fmac_f32 v243, v33, v153
    v_fmac_f32 v241, v41, v169
    v_fmac_f32 v243, v34, v154
    v_fmac_f32 v241, v42, v170
    v_fmac_f32 v243, v35, v155
    v_fmac_f32 v241, v43, v171
    v_fmac_f32 v243, v36, v156
    v_fmac_f32 v241, v44, v172
    v_fmac_f32 v243, v37, v157
    v_fmac_f32 v241, v45, v173
    v_fmac_f32 v243, v38, v158
    v_fmac_f32 v241, v46, v174
    v_fmac_f32 v243, v39, v159
    v_fmac_f32 v241, v47, v175
    ds_read_b64_tr_b16 v[20:21], v249 offset:512
    ds_read_b64_tr_b16 v[22:23], v249 offset:640
    ds_read_b128 v[24:27], v250 offset:64
    ds_read_b128 v[28:31], v250 offset:80
    ds_read_b128 v[32:35], v250 offset:448
    ds_read_b128 v[36:39], v250 offset:464
    v_fma_f32 v245, v48, v168, -v245
    v_fmac_f32 v237, v56, v120
    v_fmac_f32 v245, v49, v169
    v_fmac_f32 v237, v57, v121
    v_fmac_f32 v245, v50, v170
    v_fmac_f32 v237, v58, v122
    v_fmac_f32 v245, v51, v171
    v_fmac_f32 v237, v59, v123
    v_fmac_f32 v245, v52, v172
    v_fmac_f32 v237, v60, v124
    v_fmac_f32 v245, v53, v173
    v_fmac_f32 v237, v61, v125
    v_fmac_f32 v245, v54, v174
    v_fmac_f32 v237, v62, v126
    v_fmac_f32 v245, v55, v175
    v_fmac_f32 v237, v63, v127
    s_cmp_eq_u32 s56, 2
    s_cbranch_scc1 K2_U20
    s_cmp_eq_u32 s56, 3
    s_cbranch_scc1 K2_U30
    s_branch K2_DSP0
K2_U30:
    s_setprio 1
    s_waitcnt lgkmcnt(6)
    v_lshlrev_b32 v40, 16, v0
    v_and_b32 v41, 0xffff0000, v0
    v_lshlrev_b32 v42, 16, v1
    v_and_b32 v43, 0xffff0000, v1
    v_lshlrev_b32 v44, 16, v2
    v_and_b32 v45, 0xffff0000, v2
    v_lshlrev_b32 v46, 16, v3
    v_and_b32 v47, 0xffff0000, v3
    v_mul_f32 v4, v40, v4
    v_mul_f32 v5, v41, v5
    v_mul_f32 v6, v42, v6
    v_mul_f32 v7, v43, v7
    v_mul_f32 v8, v44, v8
    v_mul_f32 v9, v45, v9
    v_mul_f32 v10, v46, v10
    v_mul_f32 v11, v47, v11
    v_cvt_pk_bf16_f32 v64, v4, v5
    v_cvt_pk_bf16_f32 v65, v6, v7
    v_cvt_pk_bf16_f32 v66, v8, v9
    v_cvt_pk_bf16_f32 v67, v10, v11
    v_mul_f32 v12, v40, v12
    v_mul_f32 v13, v41, v13
    v_mul_f32 v14, v42, v14
    v_mul_f32 v15, v43, v15
    v_mul_f32 v16, v44, v16
    v_mul_f32 v17, v45, v17
    v_mul_f32 v18, v46, v18
    v_mul_f32 v19, v47, v19
    v_cvt_pk_bf16_f32 v68, v12, v13
    v_cvt_pk_bf16_f32 v69, v14, v15
    v_cvt_pk_bf16_f32 v70, v16, v17
    v_cvt_pk_bf16_f32 v71, v18, v19
    ds_read_b64_tr_b16 v[0:1], v249 offset:1024
    ds_read_b64_tr_b16 v[2:3], v249 offset:1152
    ds_read_b128 v[4:7], v250 offset:128
    ds_read_b128 v[8:11], v250 offset:144
    ds_read_b128 v[12:15], v250 offset:512
    ds_read_b128 v[16:19], v250 offset:528
    s_waitcnt lgkmcnt(6)
    v_lshlrev_b32 v48, 16, v20
    v_and_b32 v49, 0xffff0000, v20
    v_lshlrev_b32 v50, 16, v21
    v_and_b32 v51, 0xffff0000, v21
    v_lshlrev_b32 v52, 16, v22
    v_and_b32 v53, 0xffff0000, v22
    v_lshlrev_b32 v54, 16, v23
    v_and_b32 v55, 0xffff0000, v23
    v_mul_f32 v24, v48, v24
    v_mul_f32 v25, v49, v25
    v_mul_f32 v26, v50, v26
    v_mul_f32 v27, v51, v27
    v_mul_f32 v28, v52, v28
    v_mul_f32 v29, v53, v29
    v_mul_f32 v30, v54, v30
    v_mul_f32 v31, v55, v31
    v_cvt_pk_bf16_f32 v72, v24, v25
    v_cvt_pk_bf16_f32 v73, v26, v27
    v_cvt_pk_bf16_f32 v74, v28, v29
    v_cvt_pk_bf16_f32 v75, v30, v31
    v_mul_f32 v32, v48, v32
    v_mul_f32 v33, v49, v33
    v_mul_f32 v34, v50, v34
    v_mul_f32 v35, v51, v35
    v_mul_f32 v36, v52, v36
    v_mul_f32 v37, v53, v37
    v_mul_f32 v38, v54, v38
    v_mul_f32 v39, v55, v39
    v_cvt_pk_bf16_f32 v76, v32, v33
    v_cvt_pk_bf16_f32 v77, v34, v35
    v_cvt_pk_bf16_f32 v78, v36, v37
    v_cvt_pk_bf16_f32 v79, v38, v39
    s_waitcnt lgkmcnt(4)
    v_lshlrev_b32 v40, 16, v0
    v_and_b32 v41, 0xffff0000, v0
    v_lshlrev_b32 v42, 16, v1
    v_and_b32 v43, 0xffff0000, v1
    v_lshlrev_b32 v44, 16, v2
    v_and_b32 v45, 0xffff0000, v2
    v_lshlrev_b32 v46, 16, v3
    v_and_b32 v47, 0xffff0000, v3
    s_waitcnt lgkmcnt(2)
    v_mul_f32 v4, v40, v4
    v_mul_f32 v5, v41, v5
    v_mul_f32 v6, v42, v6
    v_mul_f32 v7, v43, v7
    v_mul_f32 v8, v44, v8
    v_mul_f32 v9, v45, v9
    v_mul_f32 v10, v46, v10
    v_mul_f32 v11, v47, v11
    v_cvt_pk_bf16_f32 v80, v4, v5
    v_cvt_pk_bf16_f32 v81, v6, v7
    v_cvt_pk_bf16_f32 v82, v8, v9
    v_cvt_pk_bf16_f32 v83, v10, v11
    s_waitcnt lgkmcnt(0)
    v_mul_f32 v12, v40, v12
    v_mul_f32 v13, v41, v13
    v_mul_f32 v14, v42, v14
    v_mul_f32 v15, v43, v15
    v_mul_f32 v16, v44, v16
    v_mul_f32 v17, v45, v17
    v_mul_f32 v18, v46, v18
    v_mul_f32 v19, v47, v19
    v_cvt_pk_bf16_f32 v84, v12, v13
    v_cvt_pk_bf16_f32 v85, v14, v15
    v_cvt_pk_bf16_f32 v86, v16, v17
    v_cvt_pk_bf16_f32 v87, v18, v19
    s_waitcnt vmcnt(4)
    v_mfma_f32_32x32x16_bf16 v[0:15], v[64:67], v[176:179], 0
    ds_read_b64_tr_b16 v[184:185], v246 offset:2048
    ds_read_b64_tr_b16 v[186:187], v246 offset:2560
    ds_read_b64_tr_b16 v[188:189], v247 offset:2048
    ds_read_b64_tr_b16 v[190:191], v247 offset:2560
    s_mov_b32 m0, s68
    v_mfma_f32_32x32x16_bf16 v[16:31], v[68:71], v[176:179], 0
    buffer_load_dwordx4 v224, s[4:7], s41 offen lds
    buffer_load_dwordx4 v225, s[72:75], s41 offen offset:1024 lds
    v_permlane32_swap_b32 v242, v236
    v_permlane32_swap_b32 v243, v237
    s_add_u32 s38, s38, 1
    v_mfma_f32_32x32x16_bf16 v[32:47], v[64:67], v[180:183], 0
    v_permlane32_swap_b32 v244, v238
    v_permlane32_swap_b32 v245, v239
    v_permlane32_swap_b32 v240, v241
    v_add_f32 v242, v242, v236
    v_mfma_f32_32x32x16_bf16 v[48:63], v[68:71], v[180:183], 0
    v_add_f32 v243, v243, v237
    v_add_f32 v244, v244, v238
    v_add_f32 v245, v245, v239
    v_add_f32 v240, -v240, -v241
    v_mov_b32 v254, s52
    v_mov_b32 v255, s38
    s_waitcnt vmcnt(4) lgkmcnt(0)
    v_mfma_f32_32x32x16_bf16 v[0:15], v[72:75], v[184:187], v[0:15]
    ds_read_b64_tr_b16 v[176:177], v246 offset:4096
    ds_read_b64_tr_b16 v[178:179], v246 offset:4608
    ds_read_b64_tr_b16 v[180:181], v247 offset:4096
    ds_read_b64_tr_b16 v[182:183], v247 offset:4608
    s_lshl_b32 s58, s38, 3
    s_add_u32 s58, s58, s20
    s_mov_b32 m0, s69
    v_mfma_f32_32x32x16_bf16 v[16:31], v[76:79], v[184:187], v[16:31]
    buffer_load_dwordx4 v226, s[4:7], s41 offen lds
    buffer_load_dwordx4 v227, s[72:75], s41 offen offset:1024 lds
    s_set_gpr_idx_on s32, gpr_idx(DST)
    s_nop 0
    v_cvt_pk_bf16_f32 v195, v242, v243
    v_cvt_pk_bf16_f32 v196, v244, v245
    v_cvt_pk_bf16_f32 v197, v240, v240
    s_set_gpr_idx_off
    s_mov_b64 exec, 1
    ds_write_b32 v254, v255
    s_mov_b64 exec, -1
    s_cmp_lt_u32 s58, s22
    s_cbranch_scc0 K2_dyn_31
K2_back_32:
    v_readlane_b32 s3, v253, s58
    s_lshl_b32 s44, s34, 7
    s_lshl_b32 s60, s58, 5
    s_and_b32 s48, s3, 0x3ffff
    s_bfe_u32 s33, s3, 0x30012
    s_sub_u32 s60, s60, s48
    s_and_b32 s60, s60, 0xff
    s_add_u32 s60, s60, s48
    s_mul_i32 s35, s38, 6
    s_cmp_eq_u32 s34, 0
    s_cselect_b32 s35, s35, s60
    s_mov_b32 s45, s44
    s_add_u32 s47, s44, 256
    s_add_u32 s49, s48, 32
    s_add_u32 s60, s48, 64
    s_cmp_eq_u32 s33, 3
    s_cselect_b32 s46, s44, s47
    s_cselect_b32 s50, s60, s48
    s_cselect_b32 s51, s48, s49
    s_sub_u32 s60, s33, 2
    s_cmp_lt_u32 s60, 2
    s_cbranch_scc0 K2_rare_37
K2_back_38:
    v_mfma_f32_32x32x16_bf16 v[32:47], v[72:75], v[188:191], v[32:47]
    v_add_u32 v233, s48, v230
    ds_read_b32 v232, v233
    ds_read_b32 v233, v233 offset:1024
    v_mfma_f32_32x32x16_bf16 v[48:63], v[76:79], v[188:191], v[48:63]
    s_waitcnt vmcnt(4) lgkmcnt(3)
    v_mfma_f32_32x32x16_bf16 v[0:15], v[80:83], v[176:179], v[0:15]
    ds_read_b64_tr_b16 v[184:185], v246 offset:6144
    ds_read_b64_tr_b16 v[186:187], v246 offset:6656
    ds_read_b64_tr_b16 v[188:189], v247 offset:6144
    ds_read_b64_tr_b16 v[190:191], v247 offset:6656
    s_mov_b32 m0, s70
    v_mfma_f32_32x32x16_bf16 v[16:31], v[84:87], v[176:179], v[16:31]
    buffer_load_dwordx4 v222, s[4:7], s42 offen lds
    buffer_load_dwordx4 v223, s[72:75], s42 offen offset:1024 lds
    v_mfma_f32_32x32x16_bf16 v[32:47], v[80:83], v[180:183], v[32:47]
    s_nop 2
    v_mul_f32 v234, v0, v96
    v_mul_f32 v236, v8, v128
    v_fmac_f32 v234, v1, v97
    v_fmac_f32 v236, v9, v129
    v_fmac_f32 v234, v2, v98
    v_fmac_f32 v236, v10, v130
    v_fmac_f32 v234, v3, v99
    v_mfma_f32_32x32x16_bf16 v[48:63], v[84:87], v[180:183], v[48:63]
    s_setprio 0
    s_waitcnt lgkmcnt(4)
    v_or_b32 v232, v232, v231
    v_or_b32 v233, v233, v231
    s_cmp_lg_u32 s34, 0
    s_cbranch_scc1 K2_dum_40
    s_add_u32 m0, s48, 864
    s_add_u32 s65, s48, 1888
    buffer_load_dwordx4 v232, s[16:19], 0 offen  lds
    s_mov_b32 m0, s65
    s_mov_b32 exec_hi, 0
    buffer_load_dwordx4 v233, s[16:19], 0 offen  lds
    s_cmp_eq_u32 s33, 4
    s_cbranch_scc1 K2_a4_41
K2_b4_43:
    s_mov_b32 exec_hi, -1
K2_back_42:
    v_fmac_f32 v236, v11, v131
    v_fmac_f32 v234, v4, v100
    v_fmac_f32 v236, v12, v132
    v_fmac_f32 v234, v5, v101
    v_fmac_f32 v236, v13, v133
    v_fmac_f32 v234, v6, v102
    v_fmac_f32 v236, v14, v134
    v_fmac_f32 v234, v7, v103
    v_fmac_f32 v236, v15, v135
    v_mul_f32 v238, v16, v128
    v_mul_f32 v240, v24, v128
    v_fmac_f32 v238, v17, v129
    v_fmac_f32 v240, v25, v129
    v_fmac_f32 v238, v18, v130
    v_fmac_f32 v240, v26, v130
    v_fmac_f32 v238, v19, v131
    v_fmac_f32 v240, v27, v131
    v_fmac_f32 v238, v20, v132
    v_fmac_f32 v240, v28, v132
    v_fmac_f32 v238, v21, v133
    v_fmac_f32 v240, v29, v133
    v_fmac_f32 v238, v22, v134
    v_fmac_f32 v240, v30, v134
    v_fmac_f32 v238, v23, v135
    v_fmac_f32 v240, v31, v135
    v_mul_f32 v235, v32, v104
    v_mul_f32 v237, v40, v136
    v_fmac_f32 v235, v33, v105
    v_fmac_f32 v237, v41, v137
    v_fmac_f32 v235, v34, v106
    v_fmac_f32 v237, v42, v138
    v_fmac_f32 v235, v35, v107
    v_fmac_f32 v237, v43, v139
    v_fmac_f32 v235, v36, v108
    v_fmac_f32 v237, v44, v140
    v_fmac_f32 v235, v37, v109
    v_fmac_f32 v237, v45, v141
    v_fmac_f32 v235, v38, v110
    v_fmac_f32 v237, v46, v142
    v_fmac_f32 v235, v39, v111
    v_fmac_f32 v237, v47, v143
    v_mul_f32 v239, v48, v136
    v_mul_f32 v241, v56, v136
    s_setprio 1
    s_waitcnt vmcnt(6) lgkmcnt(0)
    v_mfma_f32_32x32x16_bf16 v[0:15], v[64:67], v[184:187], 0
    ds_read_b64_tr_b16 v[176:177], v246 offset:0
    ds_read_b64_tr_b16 v[178:179], v246 offset:512
    ds_read_b64_tr_b16 v[180:181], v247 offset:0
    ds_read_b64_tr_b16 v[182:183], v247 offset:512
    v_fmac_f32 v239, v49, v137
    v_fmac_f32 v241, v57, v137
    s_mov_b32 m0, s71
    v_mfma_f32_32x32x16_bf16 v[16:31], v[68:71], v[184:187], 0
    buffer_load_dwordx4 v224, s[4:7], s42 offen lds
    buffer_load_dwordx4 v225, s[72:75], s42 offen offset:1024 lds
    v_fmac_f32 v239, v50, v138
    v_fmac_f32 v241, v58, v138
    v_fmac_f32 v239, v51, v139
    v_fmac_f32 v241, v59, v139
    v_fmac_f32 v239, v52, v140
    v_mfma_f32_32x32x16_bf16 v[32:47], v[64:67], v[188:191], 0
    v_fmac_f32 v241, v60, v140
    v_fmac_f32 v239, v53, v141
    v_fmac_f32 v241, v61, v141
    v_fmac_f32 v239, v54, v142
    v_fmac_f32 v241, v62, v142
    v_fmac_f32 v239, v55, v143
    v_fmac_f32 v241, v63, v143
    v_mfma_f32_32x32x16_bf16 v[48:63], v[68:71], v[188:191], 0
    v_permlane32_swap_b32 v234, v236
    v_permlane32_swap_b32 v235, v237
    v_permlane32_swap_b32 v240, v238
    s_waitcnt vmcnt(6) lgkmcnt(0)
    v_mfma_f32_32x32x16_bf16 v[0:15], v[72:75], v[176:179], v[0:15]
    ds_read_b64_tr_b16 v[184:185], v246 offset:2048
    ds_read_b64_tr_b16 v[186:187], v246 offset:2560
    ds_read_b64_tr_b16 v[188:189], v247 offset:2048
    ds_read_b64_tr_b16 v[190:191], v247 offset:2560
    v_permlane32_swap_b32 v241, v239
    s_mov_b32 m0, s68
    v_mfma_f32_32x32x16_bf16 v[16:31], v[76:79], v[176:179], v[16:31]
    buffer_load_dwordx4 v226, s[4:7], s42 offen lds
    buffer_load_dwordx4 v227, s[72:75], s42 offen offset:1024 lds
    v_add_f32 v234, v234, v236
    v_add_f32 v235, v235, v237
    v_add_f32 v240, v240, v238
    v_add_f32 v241, v241, v239
    v_mfma_f32_32x32x16_bf16 v[32:47], v[72:75], v[180:183], v[32:47]
    s_set_gpr_idx_on s31, gpr_idx(DST)
    s_nop 0
    v_cvt_pk_bf16_f32 v192, v234, v235
    v_cvt_pk_bf16_f32 v193, v240, v241
    s_set_gpr_idx_off
    v_mfma_f32_32x32x16_bf16 v[48:63], v[76:79], v[180:183], v[48:63]
    s_waitcnt vmcnt(6) lgkmcnt(0)
    v_mfma_f32_32x32x16_bf16 v[0:15], v[80:83], v[184:187], v[0:15]
    ds_read_b64_tr_b16 v[176:177], v246 offset:4096
    ds_read_b64_tr_b16 v[178:179], v246 offset:4608
    ds_read_b64_tr_b16 v[180:181], v247 offset:4096
    ds_read_b64_tr_b16 v[182:183], v247 offset:4608
    s_mov_b32 m0, s69
    v_mfma_f32_32x32x16_bf16 v[16:31], v[84:87], v[184:187], v[16:31]
    buffer_load_dwordx4 v222, s[4:7], s43 offen lds
    buffer_load_dwordx4 v223, s[72:75], s43 offen offset:1024 lds
    v_mfma_f32_32x32x16_bf16 v[32:47], v[80:83], v[188:191], v[32:47]
    s_nop 2
    v_mul_f32 v234, v0, v144
    v_mul_f32 v236, v8, v112
    v_fmac_f32 v234, v1, v145
    v_fmac_f32 v236, v9, v113
    v_fmac_f32 v234, v2, v146
    v_fmac_f32 v236, v10, v114
    v_fmac_f32 v234, v3, v147
    v_mfma_f32_32x32x16_bf16 v[48:63], v[84:87], v[188:191], v[48:63]
    s_setprio 0
    v_fmac_f32 v236, v11, v115
    v_fmac_f32 v234, v4, v148
    v_fmac_f32 v236, v12, v116
    v_fmac_f32 v234, v5, v149
    v_fmac_f32 v236, v13, v117
    v_fmac_f32 v234, v6, v150
    v_fmac_f32 v236, v14, v118
    v_fmac_f32 v234, v7, v151
    v_fmac_f32 v236, v15, v119
    v_mul_f32 v238, v16, v160
    v_mul_f32 v240, v24, v160
    v_fmac_f32 v238, v17, v161
    v_fmac_f32 v240, v25, v161
    v_fmac_f32 v238, v18, v162
    v_fmac_f32 v240, v26, v162
    v_fmac_f32 v238, v19, v163
    v_fmac_f32 v240, v27, v163
    v_fmac_f32 v238, v20, v164
    v_fmac_f32 v240, v28, v164
    v_fmac_f32 v238, v21, v165
    v_fmac_f32 v240, v29, v165
    v_fmac_f32 v238, v22, v166
    v_fmac_f32 v240, v30, v166
    v_fmac_f32 v238, v23, v167
    v_fmac_f32 v240, v31, v167
    v_mul_f32 v235, v32, v152
    v_mul_f32 v237, v40, v120
    v_fmac_f32 v235, v33, v153
    v_fmac_f32 v237, v41, v121
    v_fmac_f32 v235, v34, v154
    v_fmac_f32 v237, v42, v122
    v_fmac_f32 v235, v35, v155
    v_fmac_f32 v237, v43, v123
    v_fmac_f32 v235, v36, v156
    v_fmac_f32 v237, v44, v124
    v_fmac_f32 v235, v37, v157
    v_fmac_f32 v237, v45, v125
    v_fmac_f32 v235, v38, v158
    v_fmac_f32 v237, v46, v126
    v_fmac_f32 v235, v39, v159
    v_fmac_f32 v237, v47, v127
    v_mul_f32 v239, v48, v168
    v_mul_f32 v241, v56, v168
    v_fmac_f32 v239, v49, v169
    v_fmac_f32 v241, v57, v169
    s_setprio 1
    s_waitcnt vmcnt(4) lgkmcnt(0)
    v_mfma_f32_32x32x16_bf16 v[0:15], v[64:67], v[176:179], 0
    ds_read_b64_tr_b16 v[184:185], v246 offset:6144
    ds_read_b64_tr_b16 v[186:187], v246 offset:6656
    ds_read_b64_tr_b16 v[188:189], v247 offset:6144
    ds_read_b64_tr_b16 v[190:191], v247 offset:6656
    v_fmac_f32 v239, v50, v170
    v_fmac_f32 v241, v58, v170
    s_mov_b32 m0, s70
    v_mfma_f32_32x32x16_bf16 v[16:31], v[68:71], v[176:179], 0
    buffer_load_dwordx4 v224, s[4:7], s43 offen lds
    buffer_load_dwordx4 v225, s[72:75], s43 offen offset:1024 lds
    v_fmac_f32 v239, v51, v171
    v_fmac_f32 v241, v59, v171
    v_fmac_f32 v239, v52, v172
    v_fmac_f32 v241, v60, v172
    v_fmac_f32 v239, v53, v173
    v_mfma_f32_32x32x16_bf16 v[32:47], v[64:67], v[180:183], 0
    v_add_u32 v222, s48, v251
    ds_read_b32 v222, v222
    v_fmac_f32 v241, v61, v173
    v_fmac_f32 v239, v54, v174
    v_fmac_f32 v241, v62, v174
    v_fmac_f32 v239, v55, v175
    v_fmac_f32 v241, v63, v175
    v_mfma_f32_32x32x16_bf16 v[48:63], v[68:71], v[180:183], 0
    s_waitcnt vmcnt(4) lgkmcnt(1)
    v_mfma_f32_32x32x16_bf16 v[0:15], v[72:75], v[184:187], v[0:15]
    ds_read_b64_tr_b16 v[176:177], v246 offset:0
    ds_read_b64_tr_b16 v[178:179], v246 offset:512
    ds_read_b64_tr_b16 v[180:181], v247 offset:0
    ds_read_b64_tr_b16 v[182:183], v247 offset:512
    s_mov_b32 m0, s71
    v_mfma_f32_32x32x16_bf16 v[16:31], v[76:79], v[184:187], v[16:31]
    buffer_load_dwordx4 v226, s[4:7], s43 offen lds
    buffer_load_dwordx4 v227, s[72:75], s43 offen offset:1024 lds
    s_waitcnt lgkmcnt(4)
    v_mad_u32_u16 v223, v222, s39, v248 op_sel:[1,0,0,0]
    v_mad_u32_u16 v222, v222, s39, v248
    v_mfma_f32_32x32x16_bf16 v[32:47], v[72:75], v[188:191], v[32:47]
    v_add_u32 v224, s49, v251
    ds_read_b32 v224, v224
    v_mfma_f32_32x32x16_bf16 v[48:63], v[76:79], v[188:191], v[48:63]
    s_waitcnt vmcnt(4) lgkmcnt(1)
    v_mfma_f32_32x32x16_bf16 v[0:15], v[80:83], v[176:179], v[0:15]
    ds_read_b64_tr_b16 v[184:185], v246 offset:2048
    ds_read_b64_tr_b16 v[186:187], v246 offset:2560
    ds_read_b64_tr_b16 v[188:189], v247 offset:2048
    ds_read_b64_tr_b16 v[190:191], v247 offset:2560
    s_mov_b32 m0, s68
    v_mfma_f32_32x32x16_bf16 v[16:31], v[84:87], v[176:179], v[16:31]
    buffer_load_dwordx4 v222, s[4:7], s44 offen lds
    buffer_load_dwordx4 v223, s[72:75], s44 offen offset:1024 lds
    s_waitcnt lgkmcnt(4)
    v_mad_u32_u16 v225, v224, s39, v248 op_sel:[1,0,0,0]
    v_mad_u32_u16 v224, v224, s39, v248
    v_mfma_f32_32x32x16_bf16 v[32:47], v[80:83], v[180:183], v[32:47]
    v_add_u32 v226, s50, v251
    ds_read_b32 v226, v226
    v_mul_f32 v242, v0, v144
    v_fma_f32 v238, v8, v160, -v238
    v_fmac_f32 v242, v1, v145
    v_fmac_f32 v238, v9, v161
    v_fmac_f32 v242, v2, v146
    v_mfma_f32_32x32x16_bf16 v[48:63], v[84:87], v[180:183], v[48:63]
    s_setprio 0
    v_fmac_f32 v238, v10, v162
    v_fmac_f32 v242, v3, v147
    v_fmac_f32 v238, v11, v163
    v_fmac_f32 v242, v4, v148
    v_fmac_f32 v238, v12, v164
    v_fmac_f32 v242, v5, v149
    v_fmac_f32 v238, v13, v165
    v_fmac_f32 v242, v6, v150
    v_fmac_f32 v238, v14, v166
    v_fmac_f32 v242, v7, v151
    v_fmac_f32 v238, v15, v167
    v_fmac_f32 v236, v16, v112
    v_mul_f32 v244, v24, v160
    v_fmac_f32 v236, v17, v113
    v_fmac_f32 v244, v25, v161
    v_fmac_f32 v236, v18, v114
    v_fmac_f32 v244, v26, v162
    v_fmac_f32 v236, v19, v115
    v_fmac_f32 v244, v27, v163
    v_fmac_f32 v236, v20, v116
    v_fmac_f32 v244, v28, v164
    v_fmac_f32 v236, v21, v117
    v_fmac_f32 v244, v29, v165
    v_fmac_f32 v236, v22, v118
    v_fmac_f32 v244, v30, v166
    v_fmac_f32 v236, v23, v119
    v_fmac_f32 v244, v31, v167
    v_mul_f32 v243, v32, v152
    v_fma_f32 v239, v40, v168, -v239
    v_fmac_f32 v243, v33, v153
    v_fmac_f32 v239, v41, v169
    v_fmac_f32 v243, v34, v154
    v_fmac_f32 v239, v42, v170
    v_fmac_f32 v243, v35, v155
    v_fmac_f32 v239, v43, v171
    v_fmac_f32 v243, v36, v156
    v_fmac_f32 v239, v44, v172
    v_fmac_f32 v243, v37, v157
    v_fmac_f32 v239, v45, v173
    v_fmac_f32 v243, v38, v158
    v_fmac_f32 v239, v46, v174
    v_fmac_f32 v243, v39, v159
    v_fmac_f32 v239, v47, v175
    v_fmac_f32 v237, v48, v120
    v_mul_f32 v245, v56, v168
    v_fmac_f32 v237, v49, v121
    v_fmac_f32 v245, v57, v169
    v_fmac_f32 v237, v50, v122
    v_fmac_f32 v245, v58, v170
    v_fmac_f32 v237, v51, v123
    s_setprio 1
    s_waitcnt vmcnt(4) lgkmcnt(1)
    v_mfma_f32_32x32x16_bf16 v[0:15], v[64:67], v[184:187], 0
    ds_read_b64_tr_b16 v[176:177], v246 offset:4096
    ds_read_b64_tr_b16 v[178:179], v246 offset:4608
    ds_read_b64_tr_b16 v[180:181], v247 offset:4096
    ds_read_b64_tr_b16 v[182:183], v247 offset:4608
    v_fmac_f32 v245, v59, v171
    v_fmac_f32 v237, v52, v124
    s_mov_b32 m0, s69
    v_mfma_f32_32x32x16_bf16 v[16:31], v[68:71], v[184:187], 0
    buffer_load_dwordx4 v224, s[4:7], s45 offen lds
    buffer_load_dwordx4 v225, s[72:75], s45 offen offset:1024 lds
    s_waitcnt lgkmcnt(4)
    v_mad_u32_u16 v227, v226, s39, v248 op_sel:[1,0,0,0]
    v_mad_u32_u16 v226, v226, s39, v248
    v_fmac_f32 v245, v60, v172
    v_fmac_f32 v237, v53, v125
    v_mfma_f32_32x32x16_bf16 v[32:47], v[64:67], v[188:191], 0
    v_add_u32 v228, s51, v251
    ds_read_b32 v228, v228
    v_fmac_f32 v245, v61, v173
    v_fmac_f32 v237, v54, v126
    v_fmac_f32 v245, v62, v174
    v_fmac_f32 v237, v55, v127
    v_fmac_f32 v245, v63, v175
    v_mfma_f32_32x32x16_bf16 v[48:63], v[68:71], v[188:191], 0
    v_permlane32_swap_b32 v242, v234
    v_permlane32_swap_b32 v243, v235
    v_add_f32 v242, v242, v234
    v_add_f32 v243, v243, v235
    s_waitcnt vmcnt(4) lgkmcnt(1)
    v_mfma_f32_32x32x16_bf16 v[0:15], v[72:75], v[176:179], v[0:15]
    ds_read_b64_tr_b16 v[184:185], v246 offset:6144
    ds_read_b64_tr_b16 v[186:187], v246 offset:6656
    ds_read_b64_tr_b16 v[188:189], v247 offset:6144
    ds_read_b64_tr_b16 v[190:191], v247 offset:6656
    s_mov_b32 m0, s70
    v_mfma_f32_32x32x16_bf16 v[16:31], v[76:79], v[176:179], v[16:31]
    buffer_load_dwordx4 v226, s[4:7], s46 offen lds
    buffer_load_dwordx4 v227, s[72:75], s46 offen offset:1024 lds
    s_waitcnt lgkmcnt(4)
    v_mad_u32_u16 v229, v228, s39, v248 op_sel:[1,0,0,0]
    v_mad_u32_u16 v228, v228, s39, v248
    s_sub_u32 s26, s48, s29
    s_mov_b32 s29, s48
    v_mfma_f32_32x32x16_bf16 v[32:47], v[72:75], v[180:183], v[32:47]
    s_set_gpr_idx_on s31, gpr_idx(DST)
    s_nop 0
    v_cvt_pk_bf16_f32 v194, v242, v243
    s_set_gpr_idx_off
    s_mov_b32 s30, s3
    s_cmp_eq_u32 s34, 0
    s_cselect_b32 s56, s33, 0
    s_mov_b32 s32, s31
    v_mfma_f32_32x32x16_bf16 v[48:63], v[76:79], v[180:183], v[48:63]
    s_mov_b32 s31, s35
    s_waitcnt vmcnt(4) lgkmcnt(0)
    v_mfma_f32_32x32x16_bf16 v[0:15], v[80:83], v[184:187], v[0:15]
    ds_read_b64_tr_b16 v[176:177], v246 offset:0
    ds_read_b64_tr_b16 v[178:179], v246 offset:512
    ds_read_b64_tr_b16 v[180:181], v247 offset:0
    ds_read_b64_tr_b16 v[182:183], v247 offset:512
    s_mov_b32 m0, s71
    v_mfma_f32_32x32x16_bf16 v[16:31], v[84:87], v[184:187], v[16:31]
    buffer_load_dwordx4 v228, s[4:7], s47 offen lds
    buffer_load_dwordx4 v229, s[72:75], s47 offen offset:1024 lds
    v_mfma_f32_32x32x16_bf16 v[32:47], v[80:83], v[188:191], v[32:47]
    s_nop 2
    v_mul_f32 v242, v0, v144
    v_fma_f32 v240, v8, v160, -v240
    v_fmac_f32 v242, v1, v145
    v_fmac_f32 v240, v9, v161
    v_fmac_f32 v242, v2, v146
    v_fmac_f32 v240, v10, v162
    v_fmac_f32 v242, v3, v147
    v_mfma_f32_32x32x16_bf16 v[48:63], v[84:87], v[188:191], v[48:63]
    s_setprio 0
    v_fmac_f32 v240, v11, v163
    v_fmac_f32 v242, v4, v148
    v_fmac_f32 v240, v12, v164
    v_fmac_f32 v242, v5, v149
    v_fmac_f32 v240, v13, v165
    v_fmac_f32 v242, v6, v150
    v_fmac_f32 v240, v14, v166
    v_fmac_f32 v242, v7, v151
    v_fmac_f32 v240, v15, v167
    v_add_u32 v249, s26, v249
    v_add_u32 v250, s26, v250
    v_fma_f32 v244, v16, v160, -v244
    v_fmac_f32 v236, v24, v112
    v_fmac_f32 v244, v17, v161
    v_fmac_f32 v236, v25, v113
    v_fmac_f32 v244, v18, v162
    v_fmac_f32 v236, v26, v114
    v_fmac_f32 v244, v19, v163
    v_fmac_f32 v236, v27, v115
    v_fmac_f32 v244, v20, v164
    v_fmac_f32 v236, v28, v116
    v_fmac_f32 v244, v21, v165
    v_fmac_f32 v236, v29, v117
    v_fmac_f32 v244, v22, v166
    v_fmac_f32 v236, v30, v118
    v_fmac_f32 v244, v23, v167
    v_fmac_f32 v236, v31, v119
    ds_read_b64_tr_b16 v[0:1], v249 offset:0
    ds_read_b64_tr_b16 v[2:3], v249 offset:128
    ds_read_b128 v[4:7], v250 offset:0
    ds_read_b128 v[8:11], v250 offset:16
    ds_read_b128 v[12:15], v250 offset:384
    ds_read_b128 v[16:19], v250 offset:400
    v_mul_f32 v243, v32, v152
    v_fma_f32 v241, v40, v168, -v241
    v_fmac_f32 v243, v33, v153
    v_fmac_f32 v241, v41, v169
    v_fmac_f32 v243, v34, v154
    v_fmac_f32 v241, v42, v170
    v_fmac_f32 v243, v35, v155
    v_fmac_f32 v241, v43, v171
    v_fmac_f32 v243, v36, v156
    v_fmac_f32 v241, v44, v172
    v_fmac_f32 v243, v37, v157
    v_fmac_f32 v241, v45, v173
    v_fmac_f32 v243, v38, v158
    v_fmac_f32 v241, v46, v174
    v_fmac_f32 v243, v39, v159
    v_fmac_f32 v241, v47, v175
    ds_read_b64_tr_b16 v[20:21], v249 offset:512
    ds_read_b64_tr_b16 v[22:23], v249 offset:640
    ds_read_b128 v[24:27], v250 offset:64
    ds_read_b128 v[28:31], v250 offset:80
    ds_read_b128 v[32:35], v250 offset:448
    ds_read_b128 v[36:39], v250 offset:464
    v_fma_f32 v245, v48, v168, -v245
    v_fmac_f32 v237, v56, v120
    v_fmac_f32 v245, v49, v169
    v_fmac_f32 v237, v57, v121
    v_fmac_f32 v245, v50, v170
    v_fmac_f32 v237, v58, v122
    v_fmac_f32 v245, v51, v171
    v_fmac_f32 v237, v59, v123
    v_fmac_f32 v245, v52, v172
    v_fmac_f32 v237, v60, v124
    v_fmac_f32 v245, v53, v173
    v_fmac_f32 v237, v61, v125
    v_fmac_f32 v245, v54, v174
    v_fmac_f32 v237, v62, v126
    v_fmac_f32 v245, v55, v175
    v_fmac_f32 v237, v63, v127
    s_cmp_eq_u32 s56, 2
    s_cbranch_scc1 K2_U20
    s_cmp_eq_u32 s56, 3
    s_cbranch_scc1 K2_U30
    s_branch K2_DSP0
K2_U21:
    s_setprio 1
    s_waitcnt lgkmcnt(6)
    v_lshlrev_b32 v40, 16, v0
    v_and_b32 v41, 0xffff0000, v0
    v_lshlrev_b32 v42, 16, v1
    v_and_b32 v43, 0xffff0000, v1
    v_lshlrev_b32 v44, 16, v2
    v_and_b32 v45, 0xffff0000, v2
    v_lshlrev_b32 v46, 16, v3
    v_and_b32 v47, 0xffff0000, v3
    v_mul_f32 v4, v40, v4
    v_mul_f32 v5, v41, v5
    v_mul_f32 v6, v42, v6
    v_mul_f32 v7, v43, v7
    v_mul_f32 v8, v44, v8
    v_mul_f32 v9, v45, v9
    v_mul_f32 v10, v46, v10
    v_mul_f32 v11, v47, v11
    v_cvt_pk_bf16_f32 v64, v4, v5
    v_cvt_pk_bf16_f32 v65, v6, v7
    v_cvt_pk_bf16_f32 v66, v8, v9
    v_cvt_pk_bf16_f32 v67, v10, v11
    v_mul_f32 v12, v40, v12
    v_mul_f32 v13, v41, v13
    v_mul_f32 v14, v42, v14
    v_mul_f32 v15, v43, v15
    v_mul_f32 v16, v44, v16
    v_mul_f32 v17, v45, v17
    v_mul_f32 v18, v46, v18
    v_mul_f32 v19, v47, v19
    v_cvt_pk_bf16_f32 v68, v12, v13
    v_cvt_pk_bf16_f32 v69, v14, v15
    v_cvt_pk_bf16_f32 v70, v16, v17
    v_cvt_pk_bf16_f32 v71, v18, v19
    s_waitcnt lgkmcnt(0)
    v_lshlrev_b32 v48, 16, v20
    v_and_b32 v49, 0xffff0000, v20
    v_lshlrev_b32 v50, 16, v21
    v_and_b32 v51, 0xffff0000, v21
    v_lshlrev_b32 v52, 16, v22
    v_and_b32 v53, 0xffff0000, v22
    v_lshlrev_b32 v54, 16, v23
    v_and_b32 v55, 0xffff0000, v23
    v_mul_f32 v24, v48, v24
    v_mul_f32 v25, v49, v25
    v_mul_f32 v26, v50, v26
    v_mul_f32 v27, v51, v27
    v_mul_f32 v28, v52, v28
    v_mul_f32 v29, v53, v29
    v_mul_f32 v30, v54, v30
    v_mul_f32 v31, v55, v31
    v_cvt_pk_bf16_f32 v72, v24, v25
    v_cvt_pk_bf16_f32 v73, v26, v27
    v_cvt_pk_bf16_f32 v74, v28, v29
    v_cvt_pk_bf16_f32 v75, v30, v31
    v_mul_f32 v32, v48, v32
    v_mul_f32 v33, v49, v33
    v_mul_f32 v34, v50, v34
    v_mul_f32 v35, v51, v35
    v_mul_f32 v36, v52, v36
    v_mul_f32 v37, v53, v37
    v_mul_f32 v38, v54, v38
    v_mul_f32 v39, v55, v39
    v_cvt_pk_bf16_f32 v76, v32, v33
    v_cvt_pk_bf16_f32 v77, v34, v35
    v_cvt_pk_bf16_f32 v78, v36, v37
    v_cvt_pk_bf16_f32 v79, v38, v39
    s_waitcnt vmcnt(4)
    v_mfma_f32_32x32x16_bf16 v[0:15], v[64:67], v[176:179], 0
    ds_read_b64_tr_b16 v[184:185], v246 offset:2048
    ds_read_b64_tr_b16 v[186:187], v246 offset:2560
    ds_read_b64_tr_b16 v[188:189], v247 offset:2048
    ds_read_b64_tr_b16 v[190:191], v247 offset:2560
    s_mov_b32 m0, s68
    v_mfma_f32_32x32x16_bf16 v[16:31], v[68:71], v[176:179], 0
    buffer_load_dwordx4 v222, s[4:7], s42 offen lds
    buffer_load_dwordx4 v223, s[72:75], s42 offen offset:1024 lds
    v_permlane32_swap_b32 v242, v236
    v_permlane32_swap_b32 v243, v237
    v_mov_b32 v254, 163648
    v_mfma_f32_32x32x16_bf16 v[32:47], v[64:67], v[180:183], 0
    v_permlane32_swap_b32 v244, v238
    v_permlane32_swap_b32 v245, v239
    v_permlane32_swap_b32 v240, v241
    v_add_f32 v242, v242, v236
    v_mfma_f32_32x32x16_bf16 v[48:63], v[68:71], v[180:183], 0
    v_add_f32 v243, v243, v237
    v_add_f32 v244, v244, v238
    v_add_f32 v245, v245, v239
    v_add_f32 v240, -v240, -v241
    v_sub_u32 v241, v230, v231
    v_cvt_pk_bf16_f32 v242, v242, v243
    v_mov_b32 v255, 1
    v_lshl_add_u32 v233, v252, 1, s53
    s_mov_b64 exec, 1
    ds_add_rtn_u32 v232, v254, v255
    s_mov_b64 exec, -1
    ds_read_b32 v233, v233
    s_waitcnt vmcnt(4) lgkmcnt(2)
    v_mfma_f32_32x32x16_bf16 v[0:15], v[72:75], v[184:187], v[0:15]
    ds_read_b64_tr_b16 v[176:177], v246 offset:4096
    ds_read_b64_tr_b16 v[178:179], v246 offset:4608
    ds_read_b64_tr_b16 v[180:181], v247 offset:4096
    ds_read_b64_tr_b16 v[182:183], v247 offset:4608
    v_cvt_pk_bf16_f32 v244, v244, v245
    v_cvt_pk_bf16_f32 v240, v240, v240
    s_mov_b32 m0, s69
    v_mfma_f32_32x32x16_bf16 v[16:31], v[76:79], v[184:187], v[16:31]
    buffer_load_dwordx4 v224, s[4:7], s42 offen lds
    buffer_load_dwordx4 v225, s[72:75], s42 offen offset:1024 lds
    ds_write_b32 v230, v242 offset:768
    ds_write_b32 v230, v244 offset:1024
    ds_write_b16 v241, v240 offset:1280
    s_waitcnt lgkmcnt(7)
    v_readfirstlane_b32 s58, v232
    v_mfma_f32_32x32x16_bf16 v[32:47], v[72:75], v[188:191], v[32:47]
    s_cmp_lt_u32 s58, s22
    s_cbranch_scc0 K2_nul_44
    s_and_b32 s59, s58, 7
    s_lshr_b32 s60, s58, 3
K2_chk_46:
    v_readlane_b32 s61, v233, s59
    s_nop 0
    s_cmp_gt_u32 s61, s60
    s_cbranch_scc0 K2_spin_45
K2_back_47:
    v_mfma_f32_32x32x16_bf16 v[48:63], v[76:79], v[188:191], v[48:63]
    s_setprio 0
    v_readlane_b32 s3, v253, s58
    s_lshl_b32 s44, s34, 7
    s_lshl_b32 s60, s58, 5
    s_and_b32 s48, s3, 0x3ffff
    s_bfe_u32 s33, s3, 0x30012
    s_sub_u32 s60, s60, s48
    v_mul_f32 v234, v0, v96
    v_mul_f32 v236, v8, v128
    v_fmac_f32 v234, v1, v97
    v_fmac_f32 v236, v9, v129
    v_fmac_f32 v234, v2, v98
    v_fmac_f32 v236, v10, v130
    v_fmac_f32 v234, v3, v99
    v_fmac_f32 v236, v11, v131
    v_fmac_f32 v234, v4, v100
    v_fmac_f32 v236, v12, v132
    v_fmac_f32 v234, v5, v101
    v_fmac_f32 v236, v13, v133
    v_fmac_f32 v234, v6, v102
    v_fmac_f32 v236, v14, v134
    v_fmac_f32 v234, v7, v103
    v_fmac_f32 v236, v15, v135
    v_mul_f32 v238, v16, v128
    v_mul_f32 v240, v24, v128
    v_fmac_f32 v238, v17, v129
    v_fmac_f32 v240, v25, v129
    v_fmac_f32 v238, v18, v130
    v_fmac_f32 v240, v26, v130
    v_fmac_f32 v238, v19, v131
    v_fmac_f32 v240, v27, v131
    v_fmac_f32 v238, v20, v132
    v_fmac_f32 v240, v28, v132
    v_fmac_f32 v238, v21, v133
    v_fmac_f32 v240, v29, v133
    v_fmac_f32 v238, v22, v134
    v_fmac_f32 v240, v30, v134
    v_fmac_f32 v238, v23, v135
    v_fmac_f32 v240, v31, v135
    v_mul_f32 v235, v32, v104
    v_mul_f32 v237, v40, v136
    v_fmac_f32 v235, v33, v105
    v_fmac_f32 v237, v41, v137
    v_fmac_f32 v235, v34, v106
    v_fmac_f32 v237, v42, v138
    v_fmac_f32 v235, v35, v107
    v_fmac_f32 v237, v43, v139
    v_fmac_f32 v235, v36, v108
    v_fmac_f32 v237, v44, v140
    v_fmac_f32 v235, v37, v109
    v_fmac_f32 v237, v45, v141
    v_fmac_f32 v235, v38, v110
    v_fmac_f32 v237, v46, v142
    v_fmac_f32 v235, v39, v111
    v_fmac_f32 v237, v47, v143
    v_mul_f32 v239, v48, v136
    v_mul_f32 v241, v56, v136
    v_fmac_f32 v239, v49, v137
    v_fmac_f32 v241, v57, v137
    s_setprio 1
    s_waitcnt vmcnt(4) lgkmcnt(3)
    v_mfma_f32_32x32x16_bf16 v[0:15], v[64:67], v[176:179], 0
    ds_read_b64_tr_b16 v[184:185], v246 offset:6144
    ds_read_b64_tr_b16 v[186:187], v246 offset:6656
    ds_read_b64_tr_b16 v[188:189], v247 offset:6144
    ds_read_b64_tr_b16 v[190:191], v247 offset:6656
    v_fmac_f32 v239, v50, v138
    v_fmac_f32 v241, v58, v138
    s_mov_b32 m0, s70
    v_mfma_f32_32x32x16_bf16 v[16:31], v[68:71], v[176:179], 0
    buffer_load_dwordx4 v222, s[4:7], s43 offen lds
    buffer_load_dwordx4 v223, s[72:75], s43 offen offset:1024 lds
    v_fmac_f32 v239, v51, v139
    v_fmac_f32 v241, v59, v139
    v_fmac_f32 v239, v52, v140
    v_fmac_f32 v241, v60, v140
    v_fmac_f32 v239, v53, v141
    v_mfma_f32_32x32x16_bf16 v[32:47], v[64:67], v[180:183], 0
    s_and_b32 s60, s60, 0xff
    s_add_u32 s35, s60, s48
    s_mov_b32 s45, s44
    s_add_u32 s47, s44, 256
    s_add_u32 s49, s48, 32
    s_add_u32 s60, s48, 64
    s_cmp_eq_u32 s33, 3
    s_cselect_b32 s46, s44, s47
    s_cselect_b32 s50, s60, s48
    s_cselect_b32 s51, s48, s49
    s_sub_u32 s60, s33, 2
    s_cmp_lt_u32 s60, 2
    s_cbranch_scc0 K2_rare_48
K2_back_49:
    v_add_u32 v222, s48, v251
    ds_read_b32 v222, v222
    v_fmac_f32 v241, v61, v141
    v_fmac_f32 v239, v54, v142
    v_fmac_f32 v241, v62, v142
    v_fmac_f32 v239, v55, v143
    v_fmac_f32 v241, v63, v143
    v_mfma_f32_32x32x16_bf16 v[48:63], v[68:71], v[180:183], 0
    v_permlane32_swap_b32 v234, v236
    v_permlane32_swap_b32 v235, v237
    v_permlane32_swap_b32 v240, v238
    s_waitcnt vmcnt(4) lgkmcnt(1)
    v_mfma_f32_32x32x16_bf16 v[0:15], v[72:75], v[184:187], v[0:15]
    ds_read_b64_tr_b16 v[176:177], v246 offset:0
    ds_read_b64_tr_b16 v[178:179], v246 offset:512
    ds_read_b64_tr_b16 v[180:181], v247 offset:0
    ds_read_b64_tr_b16 v[182:183], v247 offset:512
    v_permlane32_swap_b32 v241, v239
    s_mov_b32 m0, s71
    v_mfma_f32_32x32x16_bf16 v[16:31], v[76:79], v[184:187], v[16:31]
    buffer_load_dwordx4 v224, s[4:7], s43 offen lds
    buffer_load_dwordx4 v225, s[72:75], s43 offen offset:1024 lds
    s_waitcnt lgkmcnt(4)
    v_mad_u32_u16 v223, v222, s39, v248 op_sel:[1,0,0,0]
    v_mad_u32_u16 v222, v222, s39, v248
    v_lshl_add_u32 v230, v252, 1, s31
    v_add_f32 v234, v234, v236
    v_add_f32 v235, v235, v237
    v_add_f32 v240, v240, v238
    v_add_f32 v241, v241, v239
    v_cvt_pk_bf16_f32 v234, v234, v235
    v_cvt_pk_bf16_f32 v240, v240, v241
    ds_write_b32 v230, v234 offset:0
    ds_write_b32 v230, v240 offset:256
    v_mfma_f32_32x32x16_bf16 v[32:47], v[72:75], v[188:191], v[32:47]
    v_add_u32 v224, s49, v251
    ds_read_b32 v224, v224
    v_mul_f32 v234, v0, v144
    v_mul_f32 v236, v8, v112
    v_fmac_f32 v234, v1, v145
    v_fmac_f32 v236, v9, v113
    v_fmac_f32 v234, v2, v146
    v_mfma_f32_32x32x16_bf16 v[48:63], v[76:79], v[188:191], v[48:63]
    s_setprio 0
    v_fmac_f32 v236, v10, v114
    v_fmac_f32 v234, v3, v147
    v_fmac_f32 v236, v11, v115
    v_fmac_f32 v234, v4, v148
    v_fmac_f32 v236, v12, v116
    v_fmac_f32 v234, v5, v149
    v_fmac_f32 v236, v13, v117
    v_fmac_f32 v234, v6, v150
    v_fmac_f32 v236, v14, v118
    v_fmac_f32 v234, v7, v151
    v_fmac_f32 v236, v15, v119
    v_mul_f32 v238, v16, v160
    v_mul_f32 v240, v24, v160
    v_fmac_f32 v238, v17, v161
    v_fmac_f32 v240, v25, v161
    v_fmac_f32 v238, v18, v162
    v_fmac_f32 v240, v26, v162
    v_fmac_f32 v238, v19, v163
    v_fmac_f32 v240, v27, v163
    v_fmac_f32 v238, v20, v164
    v_fmac_f32 v240, v28, v164
    v_fmac_f32 v238, v21, v165
    v_fmac_f32 v240, v29, v165
    v_fmac_f32 v238, v22, v166
    v_fmac_f32 v240, v30, v166
    v_fmac_f32 v238, v23, v167
    v_fmac_f32 v240, v31, v167
    v_mul_f32 v235, v32, v152
    v_mul_f32 v237, v40, v120
    v_fmac_f32 v235, v33, v153
    v_fmac_f32 v237, v41, v121
    v_fmac_f32 v235, v34, v154
    v_fmac_f32 v237, v42, v122
    v_fmac_f32 v235, v35, v155
    v_fmac_f32 v237, v43, v123
    v_fmac_f32 v235, v36, v156
    v_fmac_f32 v237, v44, v124
    v_fmac_f32 v235, v37, v157
    v_fmac_f32 v237, v45, v125
    v_fmac_f32 v235, v38, v158
    v_fmac_f32 v237, v46, v126
    v_fmac_f32 v235, v39, v159
    v_fmac_f32 v237, v47, v127
    v_mul_f32 v239, v48, v168
    v_mul_f32 v241, v56, v168
    v_fmac_f32 v239, v49, v169
    v_fmac_f32 v241, v57, v169
    v_fmac_f32 v239, v50, v170
    v_fmac_f32 v241, v58, v170
    v_fmac_f32 v239, v51, v171
    s_setprio 1
    s_waitcnt vmcnt(4) lgkmcnt(3)
    v_mfma_f32_32x32x16_bf16 v[0:15], v[64:67], v[176:179], 0
    ds_read_b64_tr_b16 v[184:185], v246 offset:2048
    ds_read_b64_tr_b16 v[186:187], v246 offset:2560
    ds_read_b64_tr_b16 v[188:189], v247 offset:2048
    ds_read_b64_tr_b16 v[190:191], v247 offset:2560
    v_fmac_f32 v241, v59, v171
    v_fmac_f32 v239, v52, v172
    s_mov_b32 m0, s68
    v_mfma_f32_32x32x16_bf16 v[16:31], v[68:71], v[176:179], 0
    buffer_load_dwordx4 v222, s[4:7], s44 offen lds
    buffer_load_dwordx4 v223, s[72:75], s44 offen offset:1024 lds
    s_waitcnt lgkmcnt(4)
    v_mad_u32_u16 v225, v224, s39, v248 op_sel:[1,0,0,0]
    v_mad_u32_u16 v224, v224, s39, v248
    v_fmac_f32 v241, v60, v172
    v_fmac_f32 v239, v53, v173
    v_mfma_f32_32x32x16_bf16 v[32:47], v[64:67], v[180:183], 0
    v_add_u32 v226, s50, v251
    ds_read_b32 v226, v226
    v_fmac_f32 v241, v61, v173
    v_fmac_f32 v239, v54, v174
    v_fmac_f32 v241, v62, v174
    v_fmac_f32 v239, v55, v175
    v_fmac_f32 v241, v63, v175
    v_mfma_f32_32x32x16_bf16 v[48:63], v[68:71], v[180:183], 0
    s_waitcnt vmcnt(4) lgkmcnt(1)
    v_mfma_f32_32x32x16_bf16 v[0:15], v[72:75], v[184:187], v[0:15]
    ds_read_b64_tr_b16 v[176:177], v246 offset:4096
    ds_read_b64_tr_b16 v[178:179], v246 offset:4608
    ds_read_b64_tr_b16 v[180:181], v247 offset:4096
    ds_read_b64_tr_b16 v[182:183], v247 offset:4608
    s_mov_b32 m0, s69
    v_mfma_f32_32x32x16_bf16 v[16:31], v[76:79], v[184:187], v[16:31]
    buffer_load_dwordx4 v224, s[4:7], s45 offen lds
    buffer_load_dwordx4 v225, s[72:75], s45 offen offset:1024 lds
    s_waitcnt lgkmcnt(4)
    v_mad_u32_u16 v227, v226, s39, v248 op_sel:[1,0,0,0]
    v_mad_u32_u16 v226, v226, s39, v248
    v_mfma_f32_32x32x16_bf16 v[32:47], v[72:75], v[188:191], v[32:47]
    v_add_u32 v228, s51, v251
    ds_read_b32 v228, v228
    v_mul_f32 v242, v0, v144
    v_fma_f32 v238, v8, v160, -v238
    v_fmac_f32 v242, v1, v145
    v_fmac_f32 v238, v9, v161
    v_fmac_f32 v242, v2, v146
    v_mfma_f32_32x32x16_bf16 v[48:63], v[76:79], v[188:191], v[48:63]
    s_setprio 0
    v_fmac_f32 v238, v10, v162
    v_fmac_f32 v242, v3, v147
    v_fmac_f32 v238, v11, v163
    v_fmac_f32 v242, v4, v148
    v_fmac_f32 v238, v12, v164
    v_fmac_f32 v242, v5, v149
    v_fmac_f32 v238, v13, v165
    v_fmac_f32 v242, v6, v150
    v_fmac_f32 v238, v14, v166
    v_fmac_f32 v242, v7, v151
    v_fmac_f32 v238, v15, v167
    v_fmac_f32 v236, v16, v112
    v_mul_f32 v244, v24, v160
    v_fmac_f32 v236, v17, v113
    v_fmac_f32 v244, v25, v161
    v_fmac_f32 v236, v18, v114
    v_fmac_f32 v244, v26, v162
    v_fmac_f32 v236, v19, v115
    v_fmac_f32 v244, v27, v163
    v_fmac_f32 v236, v20, v116
    v_fmac_f32 v244, v28, v164
    v_fmac_f32 v236, v21, v117
    v_fmac_f32 v244, v29, v165
    v_fmac_f32 v236, v22, v118
    v_fmac_f32 v244, v30, v166
    v_fmac_f32 v236, v23, v119
    v_fmac_f32 v244, v31, v167
    v_mul_f32 v243, v32, v152
    v_fma_f32 v239, v40, v168, -v239
    v_fmac_f32 v243, v33, v153
    v_fmac_f32 v239, v41, v169
    v_fmac_f32 v243, v34, v154
    v_fmac_f32 v239, v42, v170
    v_fmac_f32 v243, v35, v155
    v_fmac_f32 v239, v43, v171
    v_fmac_f32 v243, v36, v156
    v_fmac_f32 v239, v44, v172
    v_fmac_f32 v243, v37, v157
    v_fmac_f32 v239, v45, v173
    v_fmac_f32 v243, v38, v158
    v_fmac_f32 v239, v46, v174
    v_fmac_f32 v243, v39, v159
    v_fmac_f32 v239, v47, v175
    v_fmac_f32 v237, v48, v120
    v_mul_f32 v245, v56, v168
    v_fmac_f32 v237, v49, v121
    v_fmac_f32 v245, v57, v169
    v_fmac_f32 v237, v50, v122
    s_setprio 1
    s_waitcnt vmcnt(4) lgkmcnt(1)
    v_mfma_f32_32x32x16_bf16 v[0:15], v[64:67], v[176:179], 0
    ds_read_b64_tr_b16 v[184:185], v246 offset:6144
    ds_read_b64_tr_b16 v[186:187], v246 offset:6656
    ds_read_b64_tr_b16 v[188:189], v247 offset:6144
    ds_read_b64_tr_b16 v[190:191], v247 offset:6656
    v_fmac_f32 v245, v58, v170
    v_fmac_f32 v237, v51, v123
    s_mov_b32 m0, s70
    v_mfma_f32_32x32x16_bf16 v[16:31], v[68:71], v[176:179], 0
    buffer_load_dwordx4 v226, s[4:7], s46 offen lds
    buffer_load_dwordx4 v227, s[72:75], s46 offen offset:1024 lds
    s_waitcnt lgkmcnt(4)
    v_mad_u32_u16 v229, v228, s39, v248 op_sel:[1,0,0,0]
    v_mad_u32_u16 v228, v228, s39, v248
    v_fmac_f32 v245, v59, v171
    v_fmac_f32 v237, v52, v124
    v_mfma_f32_32x32x16_bf16 v[32:47], v[64:67], v[180:183], 0
    v_fmac_f32 v245, v60, v172
    v_fmac_f32 v237, v53, v125
    v_fmac_f32 v245, v61, v173
    v_fmac_f32 v237, v54, v126
    v_fmac_f32 v245, v62, v174
    v_fmac_f32 v237, v55, v127
    v_fmac_f32 v245, v63, v175
    v_mfma_f32_32x32x16_bf16 v[48:63], v[68:71], v[180:183], 0
    v_permlane32_swap_b32 v242, v234
    v_permlane32_swap_b32 v243, v235
    v_add_f32 v242, v242, v234
    v_add_f32 v243, v243, v235
    s_waitcnt vmcnt(4) lgkmcnt(0)
    v_mfma_f32_32x32x16_bf16 v[0:15], v[72:75], v[184:187], v[0:15]
    ds_read_b64_tr_b16 v[176:177], v246 offset:0
    ds_read_b64_tr_b16 v[178:179], v246 offset:512
    ds_read_b64_tr_b16 v[180:181], v247 offset:0
    ds_read_b64_tr_b16 v[182:183], v247 offset:512
    v_cvt_pk_bf16_f32 v242, v242, v243
    ds_write_b32 v230, v242 offset:512
    s_mov_b32 m0, s71
    v_mfma_f32_32x32x16_bf16 v[16:31], v[76:79], v[184:187], v[16:31]
    buffer_load_dwordx4 v228, s[4:7], s47 offen lds
    buffer_load_dwordx4 v229, s[72:75], s47 offen offset:1024 lds
    s_sub_u32 s26, s48, s29
    s_mov_b32 s29, s48
    s_mov_b32 s30, s3
    s_cmp_lg_u32 s36, 0
    s_cselect_b32 s56, s33, 0
    v_mfma_f32_32x32x16_bf16 v[32:47], v[72:75], v[188:191], v[32:47]
    s_mov_b32 s32, s31
    s_mov_b32 s31, s35
    v_mul_f32 v242, v0, v144
    v_fma_f32 v240, v8, v160, -v240
    v_fmac_f32 v242, v1, v145
    v_fmac_f32 v240, v9, v161
    v_fmac_f32 v242, v2, v146
    v_mfma_f32_32x32x16_bf16 v[48:63], v[76:79], v[188:191], v[48:63]
    s_setprio 0
    v_fmac_f32 v240, v10, v162
    v_fmac_f32 v242, v3, v147
    v_fmac_f32 v240, v11, v163
    v_fmac_f32 v242, v4, v148
    v_fmac_f32 v240, v12, v164
    v_fmac_f32 v242, v5, v149
    v_fmac_f32 v240, v13, v165
    v_fmac_f32 v242, v6, v150
    v_fmac_f32 v240, v14, v166
    v_fmac_f32 v242, v7, v151
    v_fmac_f32 v240, v15, v167
    v_add_u32 v249, s26, v249
    v_add_u32 v250, s26, v250
    v_fma_f32 v244, v16, v160, -v244
    v_fmac_f32 v236, v24, v112
    v_fmac_f32 v244, v17, v161
    v_fmac_f32 v236, v25, v113
    v_fmac_f32 v244, v18, v162
    v_fmac_f32 v236, v26, v114
    v_fmac_f32 v244, v19, v163
    v_fmac_f32 v236, v27, v115
    v_fmac_f32 v244, v20, v164
    v_fmac_f32 v236, v28, v116
    v_fmac_f32 v244, v21, v165
    v_fmac_f32 v236, v29, v117
    v_fmac_f32 v244, v22, v166
    v_fmac_f32 v236, v30, v118
    v_fmac_f32 v244, v23, v167
    v_fmac_f32 v236, v31, v119
    ds_read_b64_tr_b16 v[0:1], v249 offset:0
    ds_read_b64_tr_b16 v[2:3], v249 offset:128
    ds_read_b128 v[4:7], v250 offset:0
    ds_read_b128 v[8:11], v250 offset:16
    ds_read_b128 v[12:15], v250 offset:384
    ds_read_b128 v[16:19], v250 offset:400
    v_mul_f32 v243, v32, v152
    v_fma_f32 v241, v40, v168, -v241
    v_fmac_f32 v243, v33, v153
    v_fmac_f32 v241, v41, v169
    v_fmac_f32 v243, v34, v154
    v_fmac_f32 v241, v42, v170
    v_fmac_f32 v243, v35, v155
    v_fmac_f32 v241, v43, v171
    v_fmac_f32 v243, v36, v156
    v_fmac_f32 v241, v44, v172
    v_fmac_f32 v243, v37, v157
    v_fmac_f32 v241, v45, v173
    v_fmac_f32 v243, v38, v158
    v_fmac_f32 v241, v46, v174
    v_fmac_f32 v243, v39, v159
    v_fmac_f32 v241, v47, v175
    ds_read_b64_tr_b16 v[20:21], v249 offset:512
    ds_read_b64_tr_b16 v[22:23], v249 offset:640
    ds_read_b128 v[24:27], v250 offset:64
    ds_read_b128 v[28:31], v250 offset:80
    ds_read_b128 v[32:35], v250 offset:448
    ds_read_b128 v[36:39], v250 offset:464
    v_fma_f32 v245, v48, v168, -v245
    v_fmac_f32 v237, v56, v120
    v_fmac_f32 v245, v49, v169
    v_fmac_f32 v237, v57, v121
    v_fmac_f32 v245, v50, v170
    v_fmac_f32 v237, v58, v122
    v_fmac_f32 v245, v51, v171
    v_fmac_f32 v237, v59, v123
    v_fmac_f32 v245, v52, v172
    v_fmac_f32 v237, v60, v124
    v_fmac_f32 v245, v53, v173
    v_fmac_f32 v237, v61, v125
    v_fmac_f32 v245, v54, v174
    v_fmac_f32 v237, v62, v126
    v_fmac_f32 v245, v55, v175
    v_fmac_f32 v237, v63, v127
    s_cmp_eq_u32 s56, 2
    s_cbranch_scc1 K2_U21
    s_cmp_eq_u32 s56, 3
    s_cbranch_scc1 K2_U31
    s_branch K2_DSP1
K2_U31:
    s_setprio 1
    s_waitcnt lgkmcnt(6)
    v_lshlrev_b32 v40, 16, v0
    v_and_b32 v41, 0xffff0000, v0
    v_lshlrev_b32 v42, 16, v1
    v_and_b32 v43, 0xffff0000, v1
    v_lshlrev_b32 v44, 16, v2
    v_and_b32 v45, 0xffff0000, v2
    v_lshlrev_b32 v46, 16, v3
    v_and_b32 v47, 0xffff0000, v3
    v_mul_f32 v4, v40, v4
    v_mul_f32 v5, v41, v5
    v_mul_f32 v6, v42, v6
    v_mul_f32 v7, v43, v7
    v_mul_f32 v8, v44, v8
    v_mul_f32 v9, v45, v9
    v_mul_f32 v10, v46, v10
    v_mul_f32 v11, v47, v11
    v_cvt_pk_bf16_f32 v64, v4, v5
    v_cvt_pk_bf16_f32 v65, v6, v7
    v_cvt_pk_bf16_f32 v66, v8, v9
    v_cvt_pk_bf16_f32 v67, v10, v11
    v_mul_f32 v12, v40, v12
    v_mul_f32 v13, v41, v13
    v_mul_f32 v14, v42, v14
    v_mul_f32 v15, v43, v15
    v_mul_f32 v16, v44, v16
    v_mul_f32 v17, v45, v17
    v_mul_f32 v18, v46, v18
    v_mul_f32 v19, v47, v19
    v_cvt_pk_bf16_f32 v68, v12, v13
    v_cvt_pk_bf16_f32 v69, v14, v15
    v_cvt_pk_bf16_f32 v70, v16, v17
    v_cvt_pk_bf16_f32 v71, v18, v19
    ds_read_b64_tr_b16 v[0:1], v249 offset:1024
    ds_read_b64_tr_b16 v[2:3], v249 offset:1152
    ds_read_b128 v[4:7], v250 offset:128
    ds_read_b128 v[8:11], v250 offset:144
    ds_read_b128 v[12:15], v250 offset:512
    ds_read_b128 v[16:19], v250 offset:528
    s_waitcnt lgkmcnt(6)
    v_lshlrev_b32 v48, 16, v20
    v_and_b32 v49, 0xffff0000, v20
    v_lshlrev_b32 v50, 16, v21
    v_and_b32 v51, 0xffff0000, v21
    v_lshlrev_b32 v52, 16, v22
    v_and_b32 v53, 0xffff0000, v22
    v_lshlrev_b32 v54, 16, v23
    v_and_b32 v55, 0xffff0000, v23
    v_mul_f32 v24, v48, v24
    v_mul_f32 v25, v49, v25
    v_mul_f32 v26, v50, v26
    v_mul_f32 v27, v51, v27
    v_mul_f32 v28, v52, v28
    v_mul_f32 v29, v53, v29
    v_mul_f32 v30, v54, v30
    v_mul_f32 v31, v55, v31
    v_cvt_pk_bf16_f32 v72, v24, v25
    v_cvt_pk_bf16_f32 v73, v26, v27
    v_cvt_pk_bf16_f32 v74, v28, v29
    v_cvt_pk_bf16_f32 v75, v30, v31
    v_mul_f32 v32, v48, v32
    v_mul_f32 v33, v49, v33
    v_mul_f32 v34, v50, v34
    v_mul_f32 v35, v51, v35
    v_mul_f32 v36, v52, v36
    v_mul_f32 v37, v53, v37
    v_mul_f32 v38, v54, v38
    v_mul_f32 v39, v55, v39
    v_cvt_pk_bf16_f32 v76, v32, v33
    v_cvt_pk_bf16_f32 v77, v34, v35
    v_cvt_pk_bf16_f32 v78, v36, v37
    v_cvt_pk_bf16_f32 v79, v38, v39
    s_waitcnt lgkmcnt(4)
    v_lshlrev_b32 v40, 16, v0
    v_and_b32 v41, 0xffff0000, v0
    v_lshlrev_b32 v42, 16, v1
    v_and_b32 v43, 0xffff0000, v1
    v_lshlrev_b32 v44, 16, v2
    v_and_b32 v45, 0xffff0000, v2
    v_lshlrev_b32 v46, 16, v3
    v_and_b32 v47, 0xffff0000, v3
    s_waitcnt lgkmcnt(2)
    v_mul_f32 v4, v40, v4
    v_mul_f32 v5, v41, v5
    v_mul_f32 v6, v42, v6
    v_mul_f32 v7, v43, v7
    v_mul_f32 v8, v44, v8
    v_mul_f32 v9, v45, v9
    v_mul_f32 v10, v46, v10
    v_mul_f32 v11, v47, v11
    v_cvt_pk_bf16_f32 v80, v4, v5
    v_cvt_pk_bf16_f32 v81, v6, v7
    v_cvt_pk_bf16_f32 v82, v8, v9
    v_cvt_pk_bf16_f32 v83, v10, v11
    s_waitcnt lgkmcnt(0)
    v_mul_f32 v12, v40, v12
    v_mul_f32 v13, v41, v13
    v_mul_f32 v14, v42, v14
    v_mul_f32 v15, v43, v15
    v_mul_f32 v16, v44, v16
    v_mul_f32 v17, v45, v17
    v_mul_f32 v18, v46, v18
    v_mul_f32 v19, v47, v19
    v_cvt_pk_bf16_f32 v84, v12, v13
    v_cvt_pk_bf16_f32 v85, v14, v15
    v_cvt_pk_bf16_f32 v86, v16, v17
    v_cvt_pk_bf16_f32 v87, v18, v19
    s_waitcnt vmcnt(4)
    v_mfma_f32_32x32x16_bf16 v[0:15], v[64:67], v[176:179], 0
    ds_read_b64_tr_b16 v[184:185], v246 offset:2048
    ds_read_b64_tr_b16 v[186:187], v246 offset:2560
    ds_read_b64_tr_b16 v[188:189], v247 offset:2048
    ds_read_b64_tr_b16 v[190:191], v247 offset:2560
    s_mov_b32 m0, s68
    v_mfma_f32_32x32x16_bf16 v[16:31], v[68:71], v[176:179], 0
    buffer_load_dwordx4 v224, s[4:7], s41 offen lds
    buffer_load_dwordx4 v225, s[72:75], s41 offen offset:1024 lds
    v_permlane32_swap_b32 v242, v236
    v_permlane32_swap_b32 v243, v237
    v_mov_b32 v254, 163648
    v_mfma_f32_32x32x16_bf16 v[32:47], v[64:67], v[180:183], 0
    v_permlane32_swap_b32 v244, v238
    v_permlane32_swap_b32 v245, v239
    v_permlane32_swap_b32 v240, v241
    v_add_f32 v242, v242, v236
    v_mfma_f32_32x32x16_bf16 v[48:63], v[68:71], v[180:183], 0
    v_add_f32 v243, v243, v237
    v_add_f32 v244, v244, v238
    v_add_f32 v245, v245, v239
    v_add_f32 v240, -v240, -v241
    v_sub_u32 v241, v230, v231
    v_cvt_pk_bf16_f32 v242, v242, v243
    v_mov_b32 v255, 1
    v_lshl_add_u32 v233, v252, 1, s53
    s_mov_b64 exec, 1
    ds_add_rtn_u32 v232, v254, v255
    s_mov_b64 exec, -1
    ds_read_b32 v233, v233
    s_waitcnt vmcnt(4) lgkmcnt(2)
    v_mfma_f32_32x32x16_bf16 v[0:15], v[72:75], v[184:187], v[0:15]
    ds_read_b64_tr_b16 v[176:177], v246 offset:4096
    ds_read_b64_tr_b16 v[178:179], v246 offset:4608
    ds_read_b64_tr_b16 v[180:181], v247 offset:4096
    ds_read_b64_tr_b16 v[182:183], v247 offset:4608
    v_cvt_pk_bf16_f32 v244, v244, v245
    v_cvt_pk_bf16_f32 v240, v240, v240
    s_mov_b32 m0, s69
    v_mfma_f32_32x32x16_bf16 v[16:31], v[76:79], v[184:187], v[16:31]
    buffer_load_dwordx4 v226, s[4:7], s41 offen lds
    buffer_load_dwordx4 v227, s[72:75], s41 offen offset:1024 lds
    ds_write_b32 v230, v242 offset:768
    ds_write_b32 v230, v244 offset:1024
    ds_write_b16 v241, v240 offset:1280
    s_waitcnt lgkmcnt(7)
    v_readfirstlane_b32 s58, v232
    v_mfma_f32_32x32x16_bf16 v[32:47], v[72:75], v[188:191], v[32:47]
    s_cmp_lt_u32 s58, s22
    s_cbranch_scc0 K2_nul_51
    s_and_b32 s59, s58, 7
    s_lshr_b32 s60, s58, 3
K2_chk_53:
    v_readlane_b32 s61, v233, s59
    s_nop 0
    s_cmp_gt_u32 s61, s60
    s_cbranch_scc0 K2_spin_52
K2_back_54:
    v_mfma_f32_32x32x16_bf16 v[48:63], v[76:79], v[188:191], v[48:63]
    v_readlane_b32 s3, v253, s58
    s_lshl_b32 s44, s34, 7
    s_lshl_b32 s60, s58, 5
    s_and_b32 s48, s3, 0x3ffff
    s_bfe_u32 s33, s3, 0x30012
    s_sub_u32 s60, s60, s48
    s_waitcnt vmcnt(4) lgkmcnt(3)
    v_mfma_f32_32x32x16_bf16 v[0:15], v[80:83], v[176:179], v[0:15]
    ds_read_b64_tr_b16 v[184:185], v246 offset:6144
    ds_read_b64_tr_b16 v[186:187], v246 offset:6656
    ds_read_b64_tr_b16 v[188:189], v247 offset:6144
    ds_read_b64_tr_b16 v[190:191], v247 offset:6656
    s_and_b32 s60, s60, 0xff
    s_add_u32 s35, s60, s48
    s_mov_b32 m0, s70
    v_mfma_f32_32x32x16_bf16 v[16:31], v[84:87], v[176:179], v[16:31]
    buffer_load_dwordx4 v222, s[4:7], s42 offen lds
    buffer_load_dwordx4 v223, s[72:75], s42 offen offset:1024 lds
    s_mov_b32 s45, s44
    s_add_u32 s47, s44, 256
    s_add_u32 s49, s48, 32
    s_add_u32 s60, s48, 64
    v_mfma_f32_32x32x16_bf16 v[32:47], v[80:83], v[180:183], v[32:47]
    s_cmp_eq_u32 s33, 3
    s_cselect_b32 s46, s44, s47
    s_cselect_b32 s50, s60, s48
    s_cselect_b32 s51, s48, s49
    s_sub_u32 s60, s33, 2
    s_cmp_lt_u32 s60, 2
    s_cbranch_scc0 K2_rare_55
K2_back_56:
    v_mfma_f32_32x32x16_bf16 v[48:63], v[84:87], v[180:183], v[48:63]
    s_setprio 0
    v_mul_f32 v234, v0, v96
    v_mul_f32 v236, v8, v128
    v_fmac_f32 v234, v1, v97
    v_fmac_f32 v236, v9, v129
    v_fmac_f32 v234, v2, v98
    v_fmac_f32 v236, v10, v130
    v_fmac_f32 v234, v3, v99
    v_fmac_f32 v236, v11, v131
    v_fmac_f32 v234, v4, v100
    v_fmac_f32 v236, v12, v132
    v_fmac_f32 v234, v5, v101
    v_fmac_f32 v236, v13, v133
    v_fmac_f32 v234, v6, v102
    v_fmac_f32 v236, v14, v134
    v_fmac_f32 v234, v7, v103
    v_fmac_f32 v236, v15, v135
    v_mul_f32 v238, v16, v128
    v_mul_f32 v240, v24, v128
    v_fmac_f32 v238, v17, v129
    v_fmac_f32 v240, v25, v129
    v_fmac_f32 v238, v18, v130
    v_fmac_f32 v240, v26, v130
    v_fmac_f32 v238, v19, v131
    v_fmac_f32 v240, v27, v131
    v_fmac_f32 v238, v20, v132
    v_fmac_f32 v240, v28, v132
    v_fmac_f32 v238, v21, v133
    v_fmac_f32 v240, v29, v133
    v_fmac_f32 v238, v22, v134
    v_fmac_f32 v240, v30, v134
    v_fmac_f32 v238, v23, v135
    v_fmac_f32 v240, v31, v135
    v_mul_f32 v235, v32, v104
    v_mul_f32 v237, v40, v136
    v_fmac_f32 v235, v33, v105
    v_fmac_f32 v237, v41, v137
    v_fmac_f32 v235, v34, v106
    v_fmac_f32 v237, v42, v138
    v_fmac_f32 v235, v35, v107
    v_fmac_f32 v237, v43, v139
    v_fmac_f32 v235, v36, v108
    v_fmac_f32 v237, v44, v140
    v_fmac_f32 v235, v37, v109
    v_fmac_f32 v237, v45, v141
    v_fmac_f32 v235, v38, v110
    v_fmac_f32 v237, v46, v142
    v_fmac_f32 v235, v39, v111
    v_fmac_f32 v237, v47, v143
    v_mul_f32 v239, v48, v136
    v_mul_f32 v241, v56, v136
    s_setprio 1
    s_waitcnt vmcnt(4) lgkmcnt(0)
    v_mfma_f32_32x32x16_bf16 v[0:15], v[64:67], v[184:187], 0
    ds_read_b64_tr_b16 v[176:177], v246 offset:0
    ds_read_b64_tr_b16 v[178:179], v246 offset:512
    ds_read_b64_tr_b16 v[180:181], v247 offset:0
    ds_read_b64_tr_b16 v[182:183], v247 offset:512
    v_fmac_f32 v239, v49, v137
    v_fmac_f32 v241, v57, v137
    s_mov_b32 m0, s71
    v_mfma_f32_32x32x16_bf16 v[16:31], v[68:71], v[184:187], 0
    buffer_load_dwordx4 v224, s[4:7], s42 offen lds
    buffer_load_dwordx4 v225, s[72:75], s42 offen offset:1024 lds
    v_fmac_f32 v239, v50, v138
    v_fmac_f32 v241, v58, v138
    v_fmac_f32 v239, v51, v139
    v_fmac_f32 v241, v59, v139
    v_fmac_f32 v239, v52, v140
    v_mfma_f32_32x32x16_bf16 v[32:47], v[64:67], v[188:191], 0
    v_fmac_f32 v241, v60, v140
    v_fmac_f32 v239, v53, v141
    v_fmac_f32 v241, v61, v141
    v_fmac_f32 v239, v54, v142
    v_fmac_f32 v241, v62, v142
    v_fmac_f32 v239, v55, v143
    v_fmac_f32 v241, v63, v143
    v_mfma_f32_32x32x16_bf16 v[48:63], v[68:71], v[188:191], 0
    v_permlane32_swap_b32 v234, v236
    v_permlane32_swap_b32 v235, v237
    v_permlane32_swap_b32 v240, v238
    s_waitcnt vmcnt(4) lgkmcnt(0)
    v_mfma_f32_32x32x16_bf16 v[0:15], v[72:75], v[176:179], v[0:15]
    ds_read_b64_tr_b16 v[184:185], v246 offset:2048
    ds_read_b64_tr_b16 v[186:187], v246 offset:2560
    ds_read_b64_tr_b16 v[188:189], v247 offset:2048
    ds_read_b64_tr_b16 v[190:191], v247 offset:2560
    v_permlane32_swap_b32 v241, v239
    s_mov_b32 m0, s68
    v_mfma_f32_32x32x16_bf16 v[16:31], v[76:79], v[176:179], v[16:31]
    buffer_load_dwordx4 v226, s[4:7], s42 offen lds
    buffer_load_dwordx4 v227, s[72:75], s42 offen offset:1024 lds
    v_lshl_add_u32 v230, v252, 1, s31
    v_add_f32 v234, v234, v236
    v_add_f32 v235, v235, v237
    v_add_f32 v240, v240, v238
    v_add_f32 v241, v241, v239
    v_mfma_f32_32x32x16_bf16 v[32:47], v[72:75], v[180:183], v[32:47]
    v_cvt_pk_bf16_f32 v234, v234, v235
    v_cvt_pk_bf16_f32 v240, v240, v241
    ds_write_b32 v230, v234 offset:0
    ds_write_b32 v230, v240 offset:256
    v_mfma_f32_32x32x16_bf16 v[48:63], v[76:79], v[180:183], v[48:63]
    s_waitcnt vmcnt(4) lgkmcnt(2)
    v_mfma_f32_32x32x16_bf16 v[0:15], v[80:83], v[184:187], v[0:15]
    ds_read_b64_tr_b16 v[176:177], v246 offset:4096
    ds_read_b64_tr_b16 v[178:179], v246 offset:4608
    ds_read_b64_tr_b16 v[180:181], v247 offset:4096
    ds_read_b64_tr_b16 v[182:183], v247 offset:4608
    s_mov_b32 m0, s69
    v_mfma_f32_32x32x16_bf16 v[16:31], v[84:87], v[184:187], v[16:31]
    buffer_load_dwordx4 v222, s[4:7], s43 offen lds
    buffer_load_dwordx4 v223, s[72:75], s43 offen offset:1024 lds
    v_mfma_f32_32x32x16_bf16 v[32:47], v[80:83], v[188:191], v[32:47]
    s_nop 2
    v_mul_f32 v234, v0, v144
    v_mul_f32 v236, v8, v112
    v_fmac_f32 v234, v1, v145
    v_fmac_f32 v236, v9, v113
    v_fmac_f32 v234, v2, v146
    v_fmac_f32 v236, v10, v114
    v_fmac_f32 v234, v3, v147
    v_mfma_f32_32x32x16_bf16 v[48:63], v[84:87], v[188:191], v[48:63]
    s_setprio 0
    v_fmac_f32 v236, v11, v115
    v_fmac_f32 v234, v4, v148
    v_fmac_f32 v236, v12, v116
    v_fmac_f32 v234, v5, v149
    v_fmac_f32 v236, v13, v117
    v_fmac_f32 v234, v6, v150
    v_fmac_f32 v236, v14, v118
    v_fmac_f32 v234, v7, v151
    v_fmac_f32 v236, v15, v119
    v_mul_f32 v238, v16, v160
    v_mul_f32 v240, v24, v160
    v_fmac_f32 v238, v17, v161
    v_fmac_f32 v240, v25, v161
    v_fmac_f32 v238, v18, v162
    v_fmac_f32 v240, v26, v162
    v_fmac_f32 v238, v19, v163
    v_fmac_f32 v240, v27, v163
    v_fmac_f32 v238, v20, v164
    v_fmac_f32 v240, v28, v164
    v_fmac_f32 v238, v21, v165
    v_fmac_f32 v240, v29, v165
    v_fmac_f32 v238, v22, v166
    v_fmac_f32 v240, v30, v166
    v_fmac_f32 v238, v23, v167
    v_fmac_f32 v240, v31, v167
    v_mul_f32 v235, v32, v152
    v_mul_f32 v237, v40, v120
    v_fmac_f32 v235, v33, v153
    v_fmac_f32 v237, v41, v121
    v_fmac_f32 v235, v34, v154
    v_fmac_f32 v237, v42, v122
    v_fmac_f32 v235, v35, v155
    v_fmac_f32 v237, v43, v123
    v_fmac_f32 v235, v36, v156
    v_fmac_f32 v237, v44, v124
    v_fmac_f32 v235, v37, v157
    v_fmac_f32 v237, v45, v125
    v_fmac_f32 v235, v38, v158
    v_fmac_f32 v237, v46, v126
    v_fmac_f32 v235, v39, v159
    v_fmac_f32 v237, v47, v127
    v_mul_f32 v239, v48, v168
    v_mul_f32 v241, v56, v168
    v_fmac_f32 v239, v49, v169
    v_fmac_f32 v241, v57, v169
    s_setprio 1
    s_waitcnt vmcnt(4) lgkmcnt(0)
    v_mfma_f32_32x32x16_bf16 v[0:15], v[64:67], v[176:179], 0
    ds_read_b64_tr_b16 v[184:185], v246 offset:6144
    ds_read_b64_tr_b16 v[186:187], v246 offset:6656
    ds_read_b64_tr_b16 v[188:189], v247 offset:6144
    ds_read_b64_tr_b16 v[190:191], v247 offset:6656
    v_fmac_f32 v239, v50, v170
    v_fmac_f32 v241, v58, v170
    s_mov_b32 m0, s70
    v_mfma_f32_32x32x16_bf16 v[16:31], v[68:71], v[176:179], 0
    buffer_load_dwordx4 v224, s[4:7], s43 offen lds
    buffer_load_dwordx4 v225, s[72:75], s43 offen offset:1024 lds
    v_fmac_f32 v239, v51, v171
    v_fmac_f32 v241, v59, v171
    v_fmac_f32 v239, v52, v172
    v_fmac_f32 v241, v60, v172
    v_fmac_f32 v239, v53, v173
    v_mfma_f32_32x32x16_bf16 v[32:47], v[64:67], v[180:183], 0
    v_add_u32 v222, s48, v251
    ds_read_b32 v222, v222
    v_fmac_f32 v241, v61, v173
    v_fmac_f32 v239, v54, v174
    v_fmac_f32 v241, v62, v174
    v_fmac_f32 v239, v55, v175
    v_fmac_f32 v241, v63, v175
    v_mfma_f32_32x32x16_bf16 v[48:63], v[68:71], v[180:183], 0
    s_waitcnt vmcnt(4) lgkmcnt(1)
    v_mfma_f32_32x32x16_bf16 v[0:15], v[72:75], v[184:187], v[0:15]
    ds_read_b64_tr_b16 v[176:177], v246 offset:0
    ds_read_b64_tr_b16 v[178:179], v246 offset:512
    ds_read_b64_tr_b16 v[180:181], v247 offset:0
    ds_read_b64_tr_b16 v[182:183], v247 offset:512
    s_mov_b32 m0, s71
    v_mfma_f32_32x32x16_bf16 v[16:31], v[76:79], v[184:187], v[16:31]
    buffer_load_dwordx4 v226, s[4:7], s43 offen lds
    buffer_load_dwordx4 v227, s[72:75], s43 offen offset:1024 lds
    s_waitcnt lgkmcnt(4)
    v_mad_u32_u16 v223, v222, s39, v248 op_sel:[1,0,0,0]
    v_mad_u32_u16 v222, v222, s39, v248
    v_mfma_f32_32x32x16_bf16 v[32:47], v[72:75], v[188:191], v[32:47]
    v_add_u32 v224, s49, v251
    ds_read_b32 v224, v224
    v_mfma_f32_32x32x16_bf16 v[48:63], v[76:79], v[188:191], v[48:63]
    s_waitcnt vmcnt(4) lgkmcnt(1)
    v_mfma_f32_32x32x16_bf16 v[0:15], v[80:83], v[176:179], v[0:15]
    ds_read_b64_tr_b16 v[184:185], v246 offset:2048
    ds_read_b64_tr_b16 v[186:187], v246 offset:2560
    ds_read_b64_tr_b16 v[188:189], v247 offset:2048
    ds_read_b64_tr_b16 v[190:191], v247 offset:2560
    s_mov_b32 m0, s68
    v_mfma_f32_32x32x16_bf16 v[16:31], v[84:87], v[176:179], v[16:31]
    buffer_load_dwordx4 v222, s[4:7], s44 offen lds
    buffer_load_dwordx4 v223, s[72:75], s44 offen offset:1024 lds
    s_waitcnt lgkmcnt(4)
    v_mad_u32_u16 v225, v224, s39, v248 op_sel:[1,0,0,0]
    v_mad_u32_u16 v224, v224, s39, v248
    v_mfma_f32_32x32x16_bf16 v[32:47], v[80:83], v[180:183], v[32:47]
    v_add_u32 v226, s50, v251
    ds_read_b32 v226, v226
    v_mul_f32 v242, v0, v144
    v_fma_f32 v238, v8, v160, -v238
    v_fmac_f32 v242, v1, v145
    v_fmac_f32 v238, v9, v161
    v_fmac_f32 v242, v2, v146
    v_mfma_f32_32x32x16_bf16 v[48:63], v[84:87], v[180:183], v[48:63]
    s_setprio 0
    v_fmac_f32 v238, v10, v162
    v_fmac_f32 v242, v3, v147
    v_fmac_f32 v238, v11, v163
    v_fmac_f32 v242, v4, v148
    v_fmac_f32 v238, v12, v164
    v_fmac_f32 v242, v5, v149
    v_fmac_f32 v238, v13, v165
    v_fmac_f32 v242, v6, v150
    v_fmac_f32 v238, v14, v166
    v_fmac_f32 v242, v7, v151
    v_fmac_f32 v238, v15, v167
    v_fmac_f32 v236, v16, v112
    v_mul_f32 v244, v24, v160
    v_fmac_f32 v236, v17, v113
    v_fmac_f32 v244, v25, v161
    v_fmac_f32 v236, v18, v114
    v_fmac_f32 v244, v26, v162
    v_fmac_f32 v236, v19, v115
    v_fmac_f32 v244, v27, v163
    v_fmac_f32 v236, v20, v116
    v_fmac_f32 v244, v28, v164
    v_fmac_f32 v236, v21, v117
    v_fmac_f32 v244, v29, v165
    v_fmac_f32 v236, v22, v118
    v_fmac_f32 v244, v30, v166
    v_fmac_f32 v236, v23, v119
    v_fmac_f32 v244, v31, v167
    v_mul_f32 v243, v32, v152
    v_fma_f32 v239, v40, v168, -v239
    v_fmac_f32 v243, v33, v153
    v_fmac_f32 v239, v41, v169
    v_fmac_f32 v243, v34, v154
    v_fmac_f32 v239, v42, v170
    v_fmac_f32 v243, v35, v155
    v_fmac_f32 v239, v43, v171
    v_fmac_f32 v243, v36, v156
    v_fmac_f32 v239, v44, v172
    v_fmac_f32 v243, v37, v157
    v_fmac_f32 v239, v45, v173
    v_fmac_f32 v243, v38, v158
    v_fmac_f32 v239, v46, v174
    v_fmac_f32 v243, v39, v159
    v_fmac_f32 v239, v47, v175
    v_fmac_f32 v237, v48, v120
    v_mul_f32 v245, v56, v168
    v_fmac_f32 v237, v49, v121
    v_fmac_f32 v245, v57, v169
    v_fmac_f32 v237, v50, v122
    v_fmac_f32 v245, v58, v170
    v_fmac_f32 v237, v51, v123
    s_setprio 1
    s_waitcnt vmcnt(4) lgkmcnt(1)
    v_mfma_f32_32x32x16_bf16 v[0:15], v[64:67], v[184:187], 0
    ds_read_b64_tr_b16 v[176:177], v246 offset:4096
    ds_read_b64_tr_b16 v[178:179], v246 offset:4608
    ds_read_b64_tr_b16 v[180:181], v247 offset:4096
    ds_read_b64_tr_b16 v[182:183], v247 offset:4608
    v_fmac_f32 v245, v59, v171
    v_fmac_f32 v237, v52, v124
    s_mov_b32 m0, s69
    v_mfma_f32_32x32x16_bf16 v[16:31], v[68:71], v[184:187], 0
    buffer_load_dwordx4 v224, s[4:7], s45 offen lds
    buffer_load_dwordx4 v225, s[72:75], s45 offen offset:1024 lds
    s_waitcnt lgkmcnt(4)
    v_mad_u32_u16 v227, v226, s39, v248 op_sel:[1,0,0,0]
    v_mad_u32_u16 v226, v226, s39, v248
    v_fmac_f32 v245, v60, v172
    v_fmac_f32 v237, v53, v125
    v_mfma_f32_32x32x16_bf16 v[32:47], v[64:67], v[188:191], 0
    v_add_u32 v228, s51, v251
    ds_read_b32 v228, v228
    v_fmac_f32 v245, v61, v173
    v_fmac_f32 v237, v54, v126
    v_fmac_f32 v245, v62, v174
    v_fmac_f32 v237, v55, v127
    v_fmac_f32 v245, v63, v175
    v_mfma_f32_32x32x16_bf16 v[48:63], v[68:71], v[188:191], 0
    v_permlane32_swap_b32 v242, v234
    v_permlane32_swap_b32 v243, v235
    v_add_f32 v242, v242, v234
    v_add_f32 v243, v243, v235
    s_waitcnt vmcnt(4) lgkmcnt(1)
    v_mfma_f32_32x32x16_bf16 v[0:15], v[72:75], v[176:179], v[0:15]
    ds_read_b64_tr_b16 v[184:185], v246 offset:6144
    ds_read_b64_tr_b16 v[186:187], v246 offset:6656
    ds_read_b64_tr_b16 v[188:189], v247 offset:6144
    ds_read_b64_tr_b16 v[190:191], v247 offset:6656
    v_cvt_pk_bf16_f32 v242, v242, v243
    ds_write_b32 v230, v242 offset:512
    s_mov_b32 m0, s70
    v_mfma_f32_32x32x16_bf16 v[16:31], v[76:79], v[176:179], v[16:31]
    buffer_load_dwordx4 v226, s[4:7], s46 offen lds
    buffer_load_dwordx4 v227, s[72:75], s46 offen offset:1024 lds
    s_waitcnt lgkmcnt(5)
    v_mad_u32_u16 v229, v228, s39, v248 op_sel:[1,0,0,0]
    v_mad_u32_u16 v228, v228, s39, v248
    s_sub_u32 s26, s48, s29
    s_mov_b32 s29, s48
    v_mfma_f32_32x32x16_bf16 v[32:47], v[72:75], v[180:183], v[32:47]
    s_mov_b32 s30, s3
    s_cmp_lg_u32 s36, 0
    s_cselect_b32 s56, s33, 0
    s_mov_b32 s32, s31
    s_mov_b32 s31, s35
    v_mfma_f32_32x32x16_bf16 v[48:63], v[76:79], v[180:183], v[48:63]
    s_waitcnt vmcnt(4) lgkmcnt(1)
    v_mfma_f32_32x32x16_bf16 v[0:15], v[80:83], v[184:187], v[0:15]
    ds_read_b64_tr_b16 v[176:177], v246 offset:0
    ds_read_b64_tr_b16 v[178:179], v246 offset:512
    ds_read_b64_tr_b16 v[180:181], v247 offset:0
    ds_read_b64_tr_b16 v[182:183], v247 offset:512
    s_mov_b32 m0, s71
    v_mfma_f32_32x32x16_bf16 v[16:31], v[84:87], v[184:187], v[16:31]
    buffer_load_dwordx4 v228, s[4:7], s47 offen lds
    buffer_load_dwordx4 v229, s[72:75], s47 offen offset:1024 lds
    v_mfma_f32_32x32x16_bf16 v[32:47], v[80:83], v[188:191], v[32:47]
    s_nop 2
    v_mul_f32 v242, v0, v144
    v_fma_f32 v240, v8, v160, -v240
    v_fmac_f32 v242, v1, v145
    v_fmac_f32 v240, v9, v161
    v_fmac_f32 v242, v2, v146
    v_fmac_f32 v240, v10, v162
    v_fmac_f32 v242, v3, v147
    v_mfma_f32_32x32x16_bf16 v[48:63], v[84:87], v[188:191], v[48:63]
    s_setprio 0
    v_fmac_f32 v240, v11, v163
    v_fmac_f32 v242, v4, v148
    v_fmac_f32 v240, v12, v164
    v_fmac_f32 v242, v5, v149
    v_fmac_f32 v240, v13, v165
    v_fmac_f32 v242, v6, v150
    v_fmac_f32 v240, v14, v166
    v_fmac_f32 v242, v7, v151
    v_fmac_f32 v240, v15, v167
    v_add_u32 v249, s26, v249
    v_add_u32 v250, s26, v250
    v_fma_f32 v244, v16, v160, -v244
    v_fmac_f32 v236, v24, v112
    v_fmac_f32 v244, v17, v161
    v_fmac_f32 v236, v25, v113
    v_fmac_f32 v244, v18, v162
    v_fmac_f32 v236, v26, v114
    v_fmac_f32 v244, v19, v163
    v_fmac_f32 v236, v27, v115
    v_fmac_f32 v244, v20, v164
    v_fmac_f32 v236, v28, v116
    v_fmac_f32 v244, v21, v165
    v_fmac_f32 v236, v29, v117
    v_fmac_f32 v244, v22, v166
    v_fmac_f32 v236, v30, v118
    v_fmac_f32 v244, v23, v167
    v_fmac_f32 v236, v31, v119
    ds_read_b64_tr_b16 v[0:1], v249 offset:0
    ds_read_b64_tr_b16 v[2:3], v249 offset:128
    ds_read_b128 v[4:7], v250 offset:0
    ds_read_b128 v[8:11], v250 offset:16
    ds_read_b128 v[12:15], v250 offset:384
    ds_read_b128 v[16:19], v250 offset:400
    v_mul_f32 v243, v32, v152
    v_fma_f32 v241, v40, v168, -v241
    v_fmac_f32 v243, v33, v153
    v_fmac_f32 v241, v41, v169
    v_fmac_f32 v243, v34, v154
    v_fmac_f32 v241, v42, v170
    v_fmac_f32 v243, v35, v155
    v_fmac_f32 v241, v43, v171
    v_fmac_f32 v243, v36, v156
    v_fmac_f32 v241, v44, v172
    v_fmac_f32 v243, v37, v157
    v_fmac_f32 v241, v45, v173
    v_fmac_f32 v243, v38, v158
    v_fmac_f32 v241, v46, v174
    v_fmac_f32 v243, v39, v159
    v_fmac_f32 v241, v47, v175
    ds_read_b64_tr_b16 v[20:21], v249 offset:512
    ds_read_b64_tr_b16 v[22:23], v249 offset:640
    ds_read_b128 v[24:27], v250 offset:64
    ds_read_b128 v[28:31], v250 offset:80
    ds_read_b128 v[32:35], v250 offset:448
    ds_read_b128 v[36:39], v250 offset:464
    v_fma_f32 v245, v48, v168, -v245
    v_fmac_f32 v237, v56, v120
    v_fmac_f32 v245, v49, v169
    v_fmac_f32 v237, v57, v121
    v_fmac_f32 v245, v50, v170
    v_fmac_f32 v237, v58, v122
    v_fmac_f32 v245, v51, v171
    v_fmac_f32 v237, v59, v123
    v_fmac_f32 v245, v52, v172
    v_fmac_f32 v237, v60, v124
    v_fmac_f32 v245, v53, v173
    v_fmac_f32 v237, v61, v125
    v_fmac_f32 v245, v54, v174
    v_fmac_f32 v237, v62, v126
    v_fmac_f32 v245, v55, v175
    v_fmac_f32 v237, v63, v127
    s_cmp_eq_u32 s56, 2
    s_cbranch_scc1 K2_U21
    s_cmp_eq_u32 s56, 3
    s_cbranch_scc1 K2_U31
    s_branch K2_DSP1
K2_U10:
    s_setprio 1
    s_add_u32 s38, s38, 1
    v_mov_b32 v254, s52
    v_mov_b32 v255, s38
    s_lshl_b32 s58, s38, 3
    s_add_u32 s58, s58, s20
    s_mov_b64 exec, 1
    ds_write_b32 v254, v255
    s_mov_b64 exec, -1
    s_cmp_lt_u32 s58, s22
    s_cbranch_scc0 K2_dyn_58
K2_back_59:
    s_waitcnt lgkmcnt(7)
    v_lshlrev_b32 v40, 16, v0
    v_and_b32 v41, 0xffff0000, v0
    v_lshlrev_b32 v42, 16, v1
    v_and_b32 v43, 0xffff0000, v1
    v_lshlrev_b32 v44, 16, v2
    v_and_b32 v45, 0xffff0000, v2
    v_lshlrev_b32 v46, 16, v3
    v_and_b32 v47, 0xffff0000, v3
    v_mul_f32 v4, v40, v4
    v_mul_f32 v5, v41, v5
    v_mul_f32 v6, v42, v6
    v_mul_f32 v7, v43, v7
    v_mul_f32 v8, v44, v8
    v_mul_f32 v9, v45, v9
    v_mul_f32 v10, v46, v10
    v_mul_f32 v11, v47, v11
    v_cvt_pk_bf16_f32 v64, v4, v5
    v_cvt_pk_bf16_f32 v65, v6, v7
    v_cvt_pk_bf16_f32 v66, v8, v9
    v_cvt_pk_bf16_f32 v67, v10, v11
    v_mul_f32 v12, v40, v12
    v_mul_f32 v13, v41, v13
    v_mul_f32 v14, v42, v14
    v_mul_f32 v15, v43, v15
    v_mul_f32 v16, v44, v16
    v_mul_f32 v17, v45, v17
    v_mul_f32 v18, v46, v18
    v_mul_f32 v19, v47, v19
    v_cvt_pk_bf16_f32 v68, v12, v13
    v_cvt_pk_bf16_f32 v69, v14, v15
    v_cvt_pk_bf16_f32 v70, v16, v17
    v_cvt_pk_bf16_f32 v71, v18, v19
    v_readlane_b32 s3, v253, s58
    s_lshl_b32 s44, s34, 7
    s_lshl_b32 s60, s58, 5
    s_and_b32 s48, s3, 0x3ffff
    s_bfe_u32 s33, s3, 0x30012
    s_sub_u32 s60, s60, s48
    s_and_b32 s60, s60, 0xff
    s_add_u32 s60, s60, s48
    s_mul_i32 s35, s38, 6
    s_cmp_eq_u32 s34, 0
    s_cselect_b32 s35, s35, s60
    s_mov_b32 s45, s44
    s_add_u32 s47, s44, 256
    s_add_u32 s49, s48, 32
    s_add_u32 s60, s48, 64
    s_cmp_eq_u32 s33, 3
    s_cselect_b32 s46, s44, s47
    s_cselect_b32 s50, s60, s48
    s_cselect_b32 s51, s48, s49
    s_sub_u32 s60, s33, 2
    s_cmp_lt_u32 s60, 2
    s_cbranch_scc0 K2_rare_64
K2_back_65:
    v_add_u32 v233, s48, v230
    ds_read_b32 v232, v233
    ds_read_b32 v233, v233 offset:1024
    v_add_u32 v222, s48, v251
    ds_read_b32 v222, v222
    v_add_u32 v224, s49, v251
    ds_read_b32 v224, v224
    v_add_u32 v226, s50, v251
    ds_read_b32 v226, v226
    v_add_u32 v228, s51, v251
    ds_read_b32 v228, v228
    s_waitcnt lgkmcnt(4)
    v_or_b32 v232, v232, v231
    v_or_b32 v233, v233, v231
    s_cmp_lg_u32 s34, 0
    s_cbranch_scc1 K2_dum_67
    s_add_u32 m0, s48, 864
    s_add_u32 s65, s48, 1888
    buffer_load_dwordx4 v232, s[16:19], 0 offen  lds
    s_mov_b32 m0, s65
    s_mov_b32 exec_hi, 0
    buffer_load_dwordx4 v233, s[16:19], 0 offen  lds
    s_cmp_eq_u32 s33, 4
    s_cbranch_scc1 K2_a4_68
K2_b4_70:
    s_mov_b32 exec_hi, -1
K2_back_69:
    s_waitcnt lgkmcnt(3)
    v_mad_u32_u16 v223, v222, s39, v248 op_sel:[1,0,0,0]
    v_mad_u32_u16 v222, v222, s39, v248
    s_waitcnt lgkmcnt(2)
    v_mad_u32_u16 v225, v224, s39, v248 op_sel:[1,0,0,0]
    v_mad_u32_u16 v224, v224, s39, v248
    s_waitcnt lgkmcnt(1)
    v_mad_u32_u16 v227, v226, s39, v248 op_sel:[1,0,0,0]
    v_mad_u32_u16 v226, v226, s39, v248
    s_waitcnt lgkmcnt(0)
    v_mad_u32_u16 v229, v228, s39, v248 op_sel:[1,0,0,0]
    v_mad_u32_u16 v228, v228, s39, v248
    s_waitcnt vmcnt(6)
    v_mfma_f32_32x32x16_bf16 v[0:15], v[64:67], v[176:179], 0
    ds_read_b64_tr_b16 v[184:185], v246 offset:2048
    ds_read_b64_tr_b16 v[186:187], v246 offset:2560
    ds_read_b64_tr_b16 v[188:189], v247 offset:2048
    ds_read_b64_tr_b16 v[190:191], v247 offset:2560
    s_mov_b32 m0, s68
    v_mfma_f32_32x32x16_bf16 v[16:31], v[68:71], v[176:179], 0
    buffer_load_dwordx4 v222, s[4:7], s44 offen lds
    buffer_load_dwordx4 v223, s[72:75], s44 offen offset:1024 lds
    v_permlane32_swap_b32 v242, v236
    v_permlane32_swap_b32 v243, v237
    v_mfma_f32_32x32x16_bf16 v[32:47], v[64:67], v[180:183], 0
    v_permlane32_swap_b32 v244, v238
    v_permlane32_swap_b32 v245, v239
    v_permlane32_swap_b32 v240, v241
    v_add_f32 v242, v242, v236
    v_mfma_f32_32x32x16_bf16 v[48:63], v[68:71], v[180:183], 0
    s_setprio 0
    v_add_f32 v243, v243, v237
    v_add_f32 v244, v244, v238
    v_add_f32 v245, v245, v239
    v_add_f32 v240, -v240, -v241
    s_set_gpr_idx_on s32, gpr_idx(DST)
    s_nop 0
    v_cvt_pk_bf16_f32 v195, v242, v243
    v_cvt_pk_bf16_f32 v196, v244, v245
    v_cvt_pk_bf16_f32 v197, v240, v240
    s_set_gpr_idx_off
    v_mul_f32 v234, v0, v96
    v_mul_f32 v236, v8, v128
    v_fmac_f32 v234, v1, v97
    v_fmac_f32 v236, v9, v129
    v_fmac_f32 v234, v2, v98
    v_fmac_f32 v236, v10, v130
    v_fmac_f32 v234, v3, v99
    v_fmac_f32 v236, v11, v131
    v_fmac_f32 v234, v4, v100
    v_fmac_f32 v236, v12, v132
    v_fmac_f32 v234, v5, v101
    v_fmac_f32 v236, v13, v133
    v_fmac_f32 v234, v6, v102
    v_fmac_f32 v236, v14, v134
    v_fmac_f32 v234, v7, v103
    v_fmac_f32 v236, v15, v135
    v_mul_f32 v238, v16, v128
    v_mul_f32 v240, v24, v128
    v_fmac_f32 v238, v17, v129
    v_fmac_f32 v240, v25, v129
    v_fmac_f32 v238, v18, v130
    v_fmac_f32 v240, v26, v130
    v_fmac_f32 v238, v19, v131
    v_fmac_f32 v240, v27, v131
    v_fmac_f32 v238, v20, v132
    v_fmac_f32 v240, v28, v132
    v_fmac_f32 v238, v21, v133
    v_fmac_f32 v240, v29, v133
    v_fmac_f32 v238, v22, v134
    v_fmac_f32 v240, v30, v134
    v_fmac_f32 v238, v23, v135
    v_fmac_f32 v240, v31, v135
    v_mul_f32 v235, v32, v104
    v_mul_f32 v237, v40, v136
    v_fmac_f32 v235, v33, v105
    v_fmac_f32 v237, v41, v137
    v_fmac_f32 v235, v34, v106
    v_fmac_f32 v237, v42, v138
    v_fmac_f32 v235, v35, v107
    v_fmac_f32 v237, v43, v139
    v_fmac_f32 v235, v36, v108
    v_fmac_f32 v237, v44, v140
    v_fmac_f32 v235, v37, v109
    v_fmac_f32 v237, v45, v141
    v_fmac_f32 v235, v38, v110
    v_fmac_f32 v237, v46, v142
    v_fmac_f32 v235, v39, v111
    v_fmac_f32 v237, v47, v143
    v_mul_f32 v239, v48, v136
    v_mul_f32 v241, v56, v136
    v_fmac_f32 v239, v49, v137
    v_fmac_f32 v241, v57, v137
    v_fmac_f32 v239, v50, v138
    v_fmac_f32 v241, v58, v138
    v_fmac_f32 v239, v51, v139
    v_fmac_f32 v241, v59, v139
    v_fmac_f32 v239, v52, v140
    v_fmac_f32 v241, v60, v140
    v_fmac_f32 v239, v53, v141
    v_fmac_f32 v241, v61, v141
    v_fmac_f32 v239, v54, v142
    v_fmac_f32 v241, v62, v142
    v_fmac_f32 v239, v55, v143
    v_fmac_f32 v241, v63, v143
    s_setprio 1
    s_waitcnt vmcnt(6) lgkmcnt(0)
    v_mfma_f32_32x32x16_bf16 v[0:15], v[64:67], v[184:187], 0
    ds_read_b64_tr_b16 v[176:177], v246 offset:4096
    ds_read_b64_tr_b16 v[178:179], v246 offset:4608
    ds_read_b64_tr_b16 v[180:181], v247 offset:4096
    ds_read_b64_tr_b16 v[182:183], v247 offset:4608
    s_mov_b32 m0, s69
    v_mfma_f32_32x32x16_bf16 v[16:31], v[68:71], v[184:187], 0
    buffer_load_dwordx4 v224, s[4:7], s45 offen lds
    buffer_load_dwordx4 v225, s[72:75], s45 offen offset:1024 lds
    v_permlane32_swap_b32 v234, v236
    v_permlane32_swap_b32 v235, v237
    v_mfma_f32_32x32x16_bf16 v[32:47], v[64:67], v[188:191], 0
    v_permlane32_swap_b32 v240, v238
    v_permlane32_swap_b32 v241, v239
    v_add_f32 v234, v234, v236
    v_add_f32 v235, v235, v237
    v_add_f32 v240, v240, v238
    v_mfma_f32_32x32x16_bf16 v[48:63], v[68:71], v[188:191], 0
    s_setprio 0
    v_add_f32 v241, v241, v239
    s_set_gpr_idx_on s31, gpr_idx(DST)
    s_nop 0
    v_cvt_pk_bf16_f32 v192, v234, v235
    v_cvt_pk_bf16_f32 v193, v240, v241
    s_set_gpr_idx_off
    v_mul_f32 v234, v0, v144
    v_mul_f32 v236, v8, v112
    v_fmac_f32 v234, v1, v145
    v_fmac_f32 v236, v9, v113
    v_fmac_f32 v234, v2, v146
    v_fmac_f32 v236, v10, v114
    v_fmac_f32 v234, v3, v147
    v_fmac_f32 v236, v11, v115
    v_fmac_f32 v234, v4, v148
    v_fmac_f32 v236, v12, v116
    v_fmac_f32 v234, v5, v149
    v_fmac_f32 v236, v13, v117
    v_fmac_f32 v234, v6, v150
    v_fmac_f32 v236, v14, v118
    v_fmac_f32 v234, v7, v151
    v_fmac_f32 v236, v15, v119
    v_mul_f32 v238, v16, v160
    v_mul_f32 v240, v24, v160
    v_fmac_f32 v238, v17, v161
    v_fmac_f32 v240, v25, v161
    v_fmac_f32 v238, v18, v162
    v_fmac_f32 v240, v26, v162
    v_fmac_f32 v238, v19, v163
    v_fmac_f32 v240, v27, v163
    v_fmac_f32 v238, v20, v164
    v_fmac_f32 v240, v28, v164
    v_fmac_f32 v238, v21, v165
    v_fmac_f32 v240, v29, v165
    v_fmac_f32 v238, v22, v166
    v_fmac_f32 v240, v30, v166
    v_fmac_f32 v238, v23, v167
    v_fmac_f32 v240, v31, v167
    v_mul_f32 v235, v32, v152
    v_mul_f32 v237, v40, v120
    v_fmac_f32 v235, v33, v153
    v_fmac_f32 v237, v41, v121
    v_fmac_f32 v235, v34, v154
    v_fmac_f32 v237, v42, v122
    v_fmac_f32 v235, v35, v155
    v_fmac_f32 v237, v43, v123
    v_fmac_f32 v235, v36, v156
    v_fmac_f32 v237, v44, v124
    v_fmac_f32 v235, v37, v157
    v_fmac_f32 v237, v45, v125
    v_fmac_f32 v235, v38, v158
    v_fmac_f32 v237, v46, v126
    v_fmac_f32 v235, v39, v159
    v_fmac_f32 v237, v47, v127
    v_mul_f32 v239, v48, v168
    v_mul_f32 v241, v56, v168
    v_fmac_f32 v239, v49, v169
    v_fmac_f32 v241, v57, v169
    v_fmac_f32 v239, v50, v170
    v_fmac_f32 v241, v58, v170
    v_fmac_f32 v239, v51, v171
    v_fmac_f32 v241, v59, v171
    v_fmac_f32 v239, v52, v172
    v_fmac_f32 v241, v60, v172
    v_fmac_f32 v239, v53, v173
    v_fmac_f32 v241, v61, v173
    v_fmac_f32 v239, v54, v174
    v_fmac_f32 v241, v62, v174
    v_fmac_f32 v239, v55, v175
    v_fmac_f32 v241, v63, v175
    s_setprio 1
    s_waitcnt vmcnt(6) lgkmcnt(0)
    v_mfma_f32_32x32x16_bf16 v[0:15], v[64:67], v[176:179], 0
    ds_read_b64_tr_b16 v[184:185], v246 offset:6144
    ds_read_b64_tr_b16 v[186:187], v246 offset:6656
    ds_read_b64_tr_b16 v[188:189], v247 offset:6144
    ds_read_b64_tr_b16 v[190:191], v247 offset:6656
    s_mov_b32 m0, s70
    v_mfma_f32_32x32x16_bf16 v[16:31], v[68:71], v[176:179], 0
    buffer_load_dwordx4 v226, s[4:7], s46 offen lds
    buffer_load_dwordx4 v227, s[72:75], s46 offen offset:1024 lds
    s_sub_u32 s26, s48, s29
    s_mov_b32 s29, s48
    s_mov_b32 s30, s3
    s_cmp_eq_u32 s34, 0
    s_cselect_b32 s56, s33, 0
    v_mfma_f32_32x32x16_bf16 v[32:47], v[64:67], v[180:183], 0
    v_mfma_f32_32x32x16_bf16 v[48:63], v[68:71], v[180:183], 0
    s_setprio 0
    v_mul_f32 v242, v0, v144
    v_fma_f32 v238, v8, v160, -v238
    v_fmac_f32 v242, v1, v145
    v_fmac_f32 v238, v9, v161
    v_fmac_f32 v242, v2, v146
    v_fmac_f32 v238, v10, v162
    v_fmac_f32 v242, v3, v147
    v_fmac_f32 v238, v11, v163
    v_fmac_f32 v242, v4, v148
    v_fmac_f32 v238, v12, v164
    v_fmac_f32 v242, v5, v149
    v_fmac_f32 v238, v13, v165
    v_fmac_f32 v242, v6, v150
    v_fmac_f32 v238, v14, v166
    v_fmac_f32 v242, v7, v151
    v_fmac_f32 v238, v15, v167
    v_fmac_f32 v236, v16, v112
    v_mul_f32 v244, v24, v160
    v_fmac_f32 v236, v17, v113
    v_fmac_f32 v244, v25, v161
    v_fmac_f32 v236, v18, v114
    v_fmac_f32 v244, v26, v162
    v_fmac_f32 v236, v19, v115
    v_fmac_f32 v244, v27, v163
    v_fmac_f32 v236, v20, v116
    v_fmac_f32 v244, v28, v164
    v_fmac_f32 v236, v21, v117
    v_fmac_f32 v244, v29, v165
    v_fmac_f32 v236, v22, v118
    v_fmac_f32 v244, v30, v166
    v_fmac_f32 v236, v23, v119
    v_fmac_f32 v244, v31, v167
    v_mul_f32 v243, v32, v152
    v_fma_f32 v239, v40, v168, -v239
    v_fmac_f32 v243, v33, v153
    v_fmac_f32 v239, v41, v169
    v_fmac_f32 v243, v34, v154
    v_fmac_f32 v239, v42, v170
    v_fmac_f32 v243, v35, v155
    v_fmac_f32 v239, v43, v171
    v_fmac_f32 v243, v36, v156
    v_fmac_f32 v239, v44, v172
    v_fmac_f32 v243, v37, v157
    v_fmac_f32 v239, v45, v173
    v_fmac_f32 v243, v38, v158
    v_fmac_f32 v239, v46, v174
    v_fmac_f32 v243, v39, v159
    v_fmac_f32 v239, v47, v175
    v_fmac_f32 v237, v48, v120
    v_mul_f32 v245, v56, v168
    v_fmac_f32 v237, v49, v121
    v_fmac_f32 v245, v57, v169
    v_fmac_f32 v237, v50, v122
    v_fmac_f32 v245, v58, v170
    v_fmac_f32 v237, v51, v123
    v_fmac_f32 v245, v59, v171
    v_fmac_f32 v237, v52, v124
    v_fmac_f32 v245, v60, v172
    v_fmac_f32 v237, v53, v125
    v_fmac_f32 v245, v61, v173
    v_fmac_f32 v237, v54, v126
    v_fmac_f32 v245, v62, v174
    v_fmac_f32 v237, v55, v127
    v_fmac_f32 v245, v63, v175
    s_setprio 1
    s_waitcnt vmcnt(4) lgkmcnt(0)
    v_mfma_f32_32x32x16_bf16 v[0:15], v[64:67], v[184:187], 0
    ds_read_b64_tr_b16 v[176:177], v246 offset:0
    ds_read_b64_tr_b16 v[178:179], v246 offset:512
    ds_read_b64_tr_b16 v[180:181], v247 offset:0
    ds_read_b64_tr_b16 v[182:183], v247 offset:512
    s_mov_b32 m0, s71
    v_mfma_f32_32x32x16_bf16 v[16:31], v[68:71], v[184:187], 0
    buffer_load_dwordx4 v228, s[4:7], s47 offen lds
    buffer_load_dwordx4 v229, s[72:75], s47 offen offset:1024 lds
    v_permlane32_swap_b32 v242, v234
    v_permlane32_swap_b32 v243, v235
    v_add_f32 v242, v242, v234
    v_mfma_f32_32x32x16_bf16 v[32:47], v[64:67], v[188:191], 0
    v_add_f32 v243, v243, v235
    s_set_gpr_idx_on s31, gpr_idx(DST)
    s_nop 0
    v_cvt_pk_bf16_f32 v194, v242, v243
    s_set_gpr_idx_off
    s_mov_b32 s32, s31
    s_mov_b32 s31, s35
    v_mfma_f32_32x32x16_bf16 v[48:63], v[68:71], v[188:191], 0
    s_setprio 0
    v_mul_f32 v242, v0, v144
    v_fma_f32 v240, v8, v160, -v240
    v_fmac_f32 v242, v1, v145
    v_fmac_f32 v240, v9, v161
    v_fmac_f32 v242, v2, v146
    v_fmac_f32 v240, v10, v162
    v_fmac_f32 v242, v3, v147
    v_fmac_f32 v240, v11, v163
    v_fmac_f32 v242, v4, v148
    v_fmac_f32 v240, v12, v164
    v_fmac_f32 v242, v5, v149
    v_fmac_f32 v240, v13, v165
    v_fmac_f32 v242, v6, v150
    v_fmac_f32 v240, v14, v166
    v_fmac_f32 v242, v7, v151
    v_fmac_f32 v240, v15, v167
    v_add_u32 v249, s26, v249
    v_add_u32 v250, s26, v250
    v_fma_f32 v244, v16, v160, -v244
    v_fmac_f32 v236, v24, v112
    v_fmac_f32 v244, v17, v161
    v_fmac_f32 v236, v25, v113
    v_fmac_f32 v244, v18, v162
    v_fmac_f32 v236, v26, v114
    v_fmac_f32 v244, v19, v163
    v_fmac_f32 v236, v27, v115
    v_fmac_f32 v244, v20, v164
    v_fmac_f32 v236, v28, v116
    v_fmac_f32 v244, v21, v165
    v_fmac_f32 v236, v29, v117
    v_fmac_f32 v244, v22, v166
    v_fmac_f32 v236, v30, v118
    v_fmac_f32 v244, v23, v167
    v_fmac_f32 v236, v31, v119
    ds_read_b64_tr_b16 v[0:1], v249 offset:0
    ds_read_b64_tr_b16 v[2:3], v249 offset:128
    ds_read_b128 v[4:7], v250 offset:0
    ds_read_b128 v[8:11], v250 offset:16
    ds_read_b128 v[12:15], v250 offset:384
    ds_read_b128 v[16:19], v250 offset:400
    v_mul_f32 v243, v32, v152
    v_fma_f32 v241, v40, v168, -v241
    v_fmac_f32 v243, v33, v153
    v_fmac_f32 v241, v41, v169
    v_fmac_f32 v243, v34, v154
    v_fmac_f32 v241, v42, v170
    v_fmac_f32 v243, v35, v155
    v_fmac_f32 v241, v43, v171
    v_fmac_f32 v243, v36, v156
    v_fmac_f32 v241, v44, v172
    v_fmac_f32 v243, v37, v157
    v_fmac_f32 v241, v45, v173
    v_fmac_f32 v243, v38, v158
    v_fmac_f32 v241, v46, v174
    v_fmac_f32 v243, v39, v159
    v_fmac_f32 v241, v47, v175
    ds_read_b64_tr_b16 v[20:21], v249 offset:512
    ds_read_b64_tr_b16 v[22:23], v249 offset:640
    ds_read_b128 v[24:27], v250 offset:64
    ds_read_b128 v[28:31], v250 offset:80
    ds_read_b128 v[32:35], v250 offset:448
    ds_read_b128 v[36:39], v250 offset:464
    v_fma_f32 v245, v48, v168, -v245
    v_fmac_f32 v237, v56, v120
    v_fmac_f32 v245, v49, v169
    v_fmac_f32 v237, v57, v121
    v_fmac_f32 v245, v50, v170
    v_fmac_f32 v237, v58, v122
    v_fmac_f32 v245, v51, v171
    v_fmac_f32 v237, v59, v123
    v_fmac_f32 v245, v52, v172
    v_fmac_f32 v237, v60, v124
    v_fmac_f32 v245, v53, v173
    v_fmac_f32 v237, v61, v125
    v_fmac_f32 v245, v54, v174
    v_fmac_f32 v237, v62, v126
    v_fmac_f32 v245, v55, v175
    v_fmac_f32 v237, v63, v127
    s_cmp_eq_u32 s56, 2
    s_cbranch_scc1 K2_U20
    s_cmp_eq_u32 s56, 3
    s_cbranch_scc1 K2_U30
    s_branch K2_DSP0
K2_U40:
    s_setprio 1
    s_waitcnt lgkmcnt(6)
    v_lshlrev_b32 v40, 16, v0
    v_and_b32 v41, 0xffff0000, v0
    v_lshlrev_b32 v42, 16, v1
    v_and_b32 v43, 0xffff0000, v1
    v_lshlrev_b32 v44, 16, v2
    v_and_b32 v45, 0xffff0000, v2
    v_lshlrev_b32 v46, 16, v3
    v_and_b32 v47, 0xffff0000, v3
    v_mul_f32 v4, v40, v4
    v_mul_f32 v5, v41, v5
    v_mul_f32 v6, v42, v6
    v_mul_f32 v7, v43, v7
    v_mul_f32 v8, v44, v8
    v_mul_f32 v9, v45, v9
    v_mul_f32 v10, v46, v10
    v_mul_f32 v11, v47, v11
    v_cvt_pk_bf16_f32 v64, v4, v5
    v_cvt_pk_bf16_f32 v65, v6, v7
    v_cvt_pk_bf16_f32 v66, v8, v9
    v_cvt_pk_bf16_f32 v67, v10, v11
    v_mul_f32 v12, v40, v12
    v_mul_f32 v13, v41, v13
    v_mul_f32 v14, v42, v14
    v_mul_f32 v15, v43, v15
    v_mul_f32 v16, v44, v16
    v_mul_f32 v17, v45, v17
    v_mul_f32 v18, v46, v18
    v_mul_f32 v19, v47, v19
    v_cvt_pk_bf16_f32 v68, v12, v13
    v_cvt_pk_bf16_f32 v69, v14, v15
    v_cvt_pk_bf16_f32 v70, v16, v17
    v_cvt_pk_bf16_f32 v71, v18, v19
    ds_read_b64_tr_b16 v[0:1], v249 offset:1024
    ds_read_b64_tr_b16 v[2:3], v249 offset:1152
    ds_read_b128 v[4:7], v250 offset:128
    ds_read_b128 v[8:11], v250 offset:144
    ds_read_b128 v[12:15], v250 offset:512
    ds_read_b128 v[16:19], v250 offset:528
    s_waitcnt lgkmcnt(6)
    v_lshlrev_b32 v48, 16, v20
    v_and_b32 v49, 0xffff0000, v20
    v_lshlrev_b32 v50, 16, v21
    v_and_b32 v51, 0xffff0000, v21
    v_lshlrev_b32 v52, 16, v22
    v_and_b32 v53, 0xffff0000, v22
    v_lshlrev_b32 v54, 16, v23
    v_and_b32 v55, 0xffff0000, v23
    v_mul_f32 v24, v48, v24
    v_mul_f32 v25, v49, v25
    v_mul_f32 v26, v50, v26
    v_mul_f32 v27, v51, v27
    v_mul_f32 v28, v52, v28
    v_mul_f32 v29, v53, v29
    v_mul_f32 v30, v54, v30
    v_mul_f32 v31, v55, v31
    v_cvt_pk_bf16_f32 v72, v24, v25
    v_cvt_pk_bf16_f32 v73, v26, v27
    v_cvt_pk_bf16_f32 v74, v28, v29
    v_cvt_pk_bf16_f32 v75, v30, v31
    v_mul_f32 v32, v48, v32
    v_mul_f32 v33, v49, v33
    v_mul_f32 v34, v50, v34
    v_mul_f32 v35, v51, v35
    v_mul_f32 v36, v52, v36
    v_mul_f32 v37, v53, v37
    v_mul_f32 v38, v54, v38
    v_mul_f32 v39, v55, v39
    v_cvt_pk_bf16_f32 v76, v32, v33
    v_cvt_pk_bf16_f32 v77, v34, v35
    v_cvt_pk_bf16_f32 v78, v36, v37
    v_cvt_pk_bf16_f32 v79, v38, v39
    s_lshr_b32 s65, s30, 27
    s_mov_b32 s66, 161536
    s_cmp_ge_u32 s65, 2
    s_cselect_b32 s66, 158112, s66
    s_mul_i32 s65, s65, 512
    s_add_u32 s65, s65, s66
    s_sub_u32 s65, s65, s29
    v_add_u32 v56, s65, v249
    s_lshr_b32 s65, s30, 27
    s_mov_b32 s66, 161536
    s_cmp_ge_u32 s65, 2
    s_cselect_b32 s66, 159008, s66
    s_mul_i32 s65, s65, 64
    s_add_u32 s65, s65, s66
    s_sub_u32 s65, s65, s29
    v_add_u32 v57, s65, v250
    ds_read_b64_tr_b16 v[20:21], v56 offset:0
    ds_read_b64_tr_b16 v[22:23], v56 offset:128
    ds_read_b128 v[24:27], v57 offset:0
    ds_read_b128 v[28:31], v57 offset:16
    ds_read_b128 v[32:35], v57 offset:384
    ds_read_b128 v[36:39], v57 offset:400
    s_waitcnt lgkmcnt(10)
    v_lshlrev_b32 v40, 16, v0
    v_and_b32 v41, 0xffff0000, v0
    v_lshlrev_b32 v42, 16, v1
    v_and_b32 v43, 0xffff0000, v1
    v_lshlrev_b32 v44, 16, v2
    v_and_b32 v45, 0xffff0000, v2
    v_lshlrev_b32 v46, 16, v3
    v_and_b32 v47, 0xffff0000, v3
    s_waitcnt lgkmcnt(8)
    v_mul_f32 v4, v40, v4
    v_mul_f32 v5, v41, v5
    v_mul_f32 v6, v42, v6
    v_mul_f32 v7, v43, v7
    v_mul_f32 v8, v44, v8
    v_mul_f32 v9, v45, v9
    v_mul_f32 v10, v46, v10
    v_mul_f32 v11, v47, v11
    v_cvt_pk_bf16_f32 v80, v4, v5
    v_cvt_pk_bf16_f32 v81, v6, v7
    v_cvt_pk_bf16_f32 v82, v8, v9
    v_cvt_pk_bf16_f32 v83, v10, v11
    s_waitcnt lgkmcnt(6)
    v_mul_f32 v12, v40, v12
    v_mul_f32 v13, v41, v13
    v_mul_f32 v14, v42, v14
    v_mul_f32 v15, v43, v15
    v_mul_f32 v16, v44, v16
    v_mul_f32 v17, v45, v17
    v_mul_f32 v18, v46, v18
    v_mul_f32 v19, v47, v19
    v_cvt_pk_bf16_f32 v84, v12, v13
    v_cvt_pk_bf16_f32 v85, v14, v15
    v_cvt_pk_bf16_f32 v86, v16, v17
    v_cvt_pk_bf16_f32 v87, v18, v19
    s_waitcnt lgkmcnt(4)
    v_lshlrev_b32 v48, 16, v20
    v_and_b32 v49, 0xffff0000, v20
    v_lshlrev_b32 v50, 16, v21
    v_and_b32 v51, 0xffff0000, v21
    v_lshlrev_b32 v52, 16, v22
    v_and_b32 v53, 0xffff0000, v22
    v_lshlrev_b32 v54, 16, v23
    v_and_b32 v55, 0xffff0000, v23
    s_waitcnt lgkmcnt(2)
    v_mul_f32 v24, v48, v24
    v_mul_f32 v25, v49, v25
    v_mul_f32 v26, v50, v26
    v_mul_f32 v27, v51, v27
    v_mul_f32 v28, v52, v28
    v_mul_f32 v29, v53, v29
    v_mul_f32 v30, v54, v30
    v_mul_f32 v31, v55, v31
    v_cvt_pk_bf16_f32 v88, v24, v25
    v_cvt_pk_bf16_f32 v89, v26, v27
    v_cvt_pk_bf16_f32 v90, v28, v29
    v_cvt_pk_bf16_f32 v91, v30, v31
    s_waitcnt lgkmcnt(0)
    v_mul_f32 v32, v48, v32
    v_mul_f32 v33, v49, v33
    v_mul_f32 v34, v50, v34
    v_mul_f32 v35, v51, v35
    v_mul_f32 v36, v52, v36
    v_mul_f32 v37, v53, v37
    v_mul_f32 v38, v54, v38
    v_mul_f32 v39, v55, v39
    v_cvt_pk_bf16_f32 v92, v32, v33
    v_cvt_pk_bf16_f32 v93, v34, v35
    v_cvt_pk_bf16_f32 v94, v36, v37
    v_cvt_pk_bf16_f32 v95, v38, v39
    s_waitcnt vmcnt(4)
    v_mfma_f32_32x32x16_bf16 v[0:15], v[64:67], v[176:179], 0
    ds_read_b64_tr_b16 v[184:185], v246 offset:2048
    ds_read_b64_tr_b16 v[186:187], v246 offset:2560
    ds_read_b64_tr_b16 v[188:189], v247 offset:2048
    ds_read_b64_tr_b16 v[190:191], v247 offset:2560
    s_mov_b32 m0, s68
    v_mfma_f32_32x32x16_bf16 v[16:31], v[68:71], v[176:179], 0
    buffer_load_dwordx4 v222, s[4:7], s41 offen lds
    buffer_load_dwordx4 v223, s[72:75], s41 offen offset:1024 lds
    v_permlane32_swap_b32 v242, v236
    v_permlane32_swap_b32 v243, v237
    s_add_u32 s38, s38, 1
    v_mfma_f32_32x32x16_bf16 v[32:47], v[64:67], v[180:183], 0
    v_permlane32_swap_b32 v244, v238
    v_permlane32_swap_b32 v245, v239
    v_permlane32_swap_b32 v240, v241
    v_add_f32 v242, v242, v236
    v_mfma_f32_32x32x16_bf16 v[48:63], v[68:71], v[180:183], 0
    v_add_f32 v243, v243, v237
    v_add_f32 v244, v244, v238
    v_add_f32 v245, v245, v239
    v_add_f32 v240, -v240, -v241
    v_mov_b32 v254, s52
    v_mov_b32 v255, s38
    s_waitcnt vmcnt(4) lgkmcnt(0)
    v_mfma_f32_32x32x16_bf16 v[0:15], v[72:75], v[184:187], v[0:15]
    ds_read_b64_tr_b16 v[176:177], v246 offset:4096
    ds_read_b64_tr_b16 v[178:179], v246 offset:4608
    ds_read_b64_tr_b16 v[180:181], v247 offset:4096
    ds_read_b64_tr_b16 v[182:183], v247 offset:4608
    s_lshl_b32 s58, s38, 3
    s_add_u32 s58, s58, s20
    s_mov_b32 m0, s69
    v_mfma_f32_32x32x16_bf16 v[16:31], v[76:79], v[184:187], v[16:31]
    buffer_load_dwordx4 v224, s[4:7], s41 offen lds
    buffer_load_dwordx4 v225, s[72:75], s41 offen offset:1024 lds
    s_set_gpr_idx_on s32, gpr_idx(DST)
    s_nop 0
    v_cvt_pk_bf16_f32 v195, v242, v243
    v_cvt_pk_bf16_f32 v196, v244, v245
    v_cvt_pk_bf16_f32 v197, v240, v240
    s_set_gpr_idx_off
    s_mov_b64 exec, 1
    ds_write_b32 v254, v255
    s_mov_b64 exec, -1
    s_cmp_lt_u32 s58, s22
    s_cbranch_scc0 K2_dyn_71
K2_back_72:
    v_readlane_b32 s3, v253, s58
    s_lshl_b32 s44, s34, 7
    s_lshl_b32 s60, s58, 5
    s_and_b32 s48, s3, 0x3ffff
    s_bfe_u32 s33, s3, 0x30012
    s_sub_u32 s60, s60, s48
    s_and_b32 s60, s60, 0xff
    s_add_u32 s60, s60, s48
    s_mul_i32 s35, s38, 6
    s_cmp_eq_u32 s34, 0
    s_cselect_b32 s35, s35, s60
    s_mov_b32 s45, s44
    s_add_u32 s47, s44, 256
    s_add_u32 s49, s48, 32
    s_add_u32 s60, s48, 64
    s_cmp_eq_u32 s33, 3
    s_cselect_b32 s46, s44, s47
    s_cselect_b32 s50, s60, s48
    s_cselect_b32 s51, s48, s49
    s_sub_u32 s60, s33, 2
    s_cmp_lt_u32 s60, 2
    s_cbranch_scc0 K2_rare_77
K2_back_78:
    v_mfma_f32_32x32x16_bf16 v[32:47], v[72:75], v[188:191], v[32:47]
    v_add_u32 v233, s48, v230
    ds_read_b32 v232, v233
    ds_read_b32 v233, v233 offset:1024
    v_mfma_f32_32x32x16_bf16 v[48:63], v[76:79], v[188:191], v[48:63]
    s_waitcnt vmcnt(4) lgkmcnt(3)
    v_mfma_f32_32x32x16_bf16 v[0:15], v[80:83], v[176:179], v[0:15]
    ds_read_b64_tr_b16 v[184:185], v246 offset:6144
    ds_read_b64_tr_b16 v[186:187], v246 offset:6656
    ds_read_b64_tr_b16 v[188:189], v247 offset:6144
    ds_read_b64_tr_b16 v[190:191], v247 offset:6656
    s_mov_b32 m0, s70
    v_mfma_f32_32x32x16_bf16 v[16:31], v[84:87], v[176:179], v[16:31]
    buffer_load_dwordx4 v226, s[4:7], s41 offen lds
    buffer_load_dwordx4 v227, s[72:75], s41 offen offset:1024 lds
    v_mfma_f32_32x32x16_bf16 v[32:47], v[80:83], v[180:183], v[32:47]
    v_mfma_f32_32x32x16_bf16 v[48:63], v[84:87], v[180:183], v[48:63]
    s_waitcnt lgkmcnt(4)
    v_or_b32 v232, v232, v231
    v_or_b32 v233, v233, v231
    s_cmp_lg_u32 s34, 0
    s_cbranch_scc1 K2_dum_80
    s_add_u32 m0, s48, 864
    s_add_u32 s65, s48, 1888
    buffer_load_dwordx4 v232, s[16:19], 0 offen  lds
    s_mov_b32 m0, s65
    s_mov_b32 exec_hi, 0
    buffer_load_dwordx4 v233, s[16:19], 0 offen  lds
    s_cmp_eq_u32 s33, 4
    s_cbranch_scc1 K2_a4_81
K2_b4_83:
    s_mov_b32 exec_hi, -1
K2_back_82:
    s_waitcnt vmcnt(6) lgkmcnt(0)
    v_mfma_f32_32x32x16_bf16 v[0:15], v[88:91], v[184:187], v[0:15]
    ds_read_b64_tr_b16 v[176:177], v246 offset:0
    ds_read_b64_tr_b16 v[178:179], v246 offset:512
    ds_read_b64_tr_b16 v[180:181], v247 offset:0
    ds_read_b64_tr_b16 v[182:183], v247 offset:512
    s_mov_b32 m0, s71
    v_mfma_f32_32x32x16_bf16 v[16:31], v[92:95], v[184:187], v[16:31]
    buffer_load_dwordx4 v228, s[4:7], s41 offen lds
    buffer_load_dwordx4 v229, s[72:75], s41 offen offset:1024 lds
    v_mfma_f32_32x32x16_bf16 v[32:47], v[88:91], v[188:191], v[32:47]
    s_nop 2
    v_mul_f32 v234, v0, v96
    v_mul_f32 v236, v8, v128
    v_fmac_f32 v234, v1, v97
    v_fmac_f32 v236, v9, v129
    v_fmac_f32 v234, v2, v98
    v_fmac_f32 v236, v10, v130
    v_fmac_f32 v234, v3, v99
    v_mfma_f32_32x32x16_bf16 v[48:63], v[92:95], v[188:191], v[48:63]
    s_setprio 0
    v_fmac_f32 v236, v11, v131
    v_fmac_f32 v234, v4, v100
    v_fmac_f32 v236, v12, v132
    v_fmac_f32 v234, v5, v101
    v_fmac_f32 v236, v13, v133
    v_fmac_f32 v234, v6, v102
    v_fmac_f32 v236, v14, v134
    v_fmac_f32 v234, v7, v103
    v_fmac_f32 v236, v15, v135
    v_mul_f32 v238, v16, v128
    v_mul_f32 v240, v24, v128
    v_fmac_f32 v238, v17, v129
    v_fmac_f32 v240, v25, v129
    v_fmac_f32 v238, v18, v130
    v_fmac_f32 v240, v26, v130
    v_fmac_f32 v238, v19, v131
    v_fmac_f32 v240, v27, v131
    v_fmac_f32 v238, v20, v132
    v_fmac_f32 v240, v28, v132
    v_fmac_f32 v238, v21, v133
    v_fmac_f32 v240, v29, v133
    v_fmac_f32 v238, v22, v134
    v_fmac_f32 v240, v30, v134
    v_fmac_f32 v238, v23, v135
    v_fmac_f32 v240, v31, v135
    v_mul_f32 v235, v32, v104
    v_mul_f32 v237, v40, v136
    v_fmac_f32 v235, v33, v105
    v_fmac_f32 v237, v41, v137
    v_fmac_f32 v235, v34, v106
    v_fmac_f32 v237, v42, v138
    v_fmac_f32 v235, v35, v107
    v_fmac_f32 v237, v43, v139
    v_fmac_f32 v235, v36, v108
    v_fmac_f32 v237, v44, v140
    v_fmac_f32 v235, v37, v109
    v_fmac_f32 v237, v45, v141
    v_fmac_f32 v235, v38, v110
    v_fmac_f32 v237, v46, v142
    v_fmac_f32 v235, v39, v111
    v_fmac_f32 v237, v47, v143
    v_mul_f32 v239, v48, v136
    v_mul_f32 v241, v56, v136
    s_setprio 1
    s_waitcnt vmcnt(6) lgkmcnt(0)
    v_mfma_f32_32x32x16_bf16 v[0:15], v[64:67], v[176:179], 0
    ds_read_b64_tr_b16 v[184:185], v246 offset:2048
    ds_read_b64_tr_b16 v[186:187], v246 offset:2560
    ds_read_b64_tr_b16 v[188:189], v247 offset:2048
    ds_read_b64_tr_b16 v[190:191], v247 offset:2560
    v_fmac_f32 v239, v49, v137
    v_fmac_f32 v241, v57, v137
    s_mov_b32 m0, s68
    v_mfma_f32_32x32x16_bf16 v[16:31], v[68:71], v[176:179], 0
    buffer_load_dwordx4 v222, s[4:7], s42 offen lds
    buffer_load_dwordx4 v223, s[72:75], s42 offen offset:1024 lds
    v_fmac_f32 v239, v50, v138
    v_fmac_f32 v241, v58, v138
    v_fmac_f32 v239, v51, v139
    v_fmac_f32 v241, v59, v139
    v_fmac_f32 v239, v52, v140
    v_mfma_f32_32x32x16_bf16 v[32:47], v[64:67], v[180:183], 0
    v_fmac_f32 v241, v60, v140
    v_fmac_f32 v239, v53, v141
    v_fmac_f32 v241, v61, v141
    v_fmac_f32 v239, v54, v142
    v_fmac_f32 v241, v62, v142
    v_fmac_f32 v239, v55, v143
    v_fmac_f32 v241, v63, v143
    v_mfma_f32_32x32x16_bf16 v[48:63], v[68:71], v[180:183], 0
    v_permlane32_swap_b32 v234, v236
    v_permlane32_swap_b32 v235, v237
    v_permlane32_swap_b32 v240, v238
    s_waitcnt vmcnt(6) lgkmcnt(0)
    v_mfma_f32_32x32x16_bf16 v[0:15], v[72:75], v[184:187], v[0:15]
    ds_read_b64_tr_b16 v[176:177], v246 offset:4096
    ds_read_b64_tr_b16 v[178:179], v246 offset:4608
    ds_read_b64_tr_b16 v[180:181], v247 offset:4096
    ds_read_b64_tr_b16 v[182:183], v247 offset:4608
    v_permlane32_swap_b32 v241, v239
    s_mov_b32 m0, s69
    v_mfma_f32_32x32x16_bf16 v[16:31], v[76:79], v[184:187], v[16:31]
    buffer_load_dwordx4 v224, s[4:7], s42 offen lds
    buffer_load_dwordx4 v225, s[72:75], s42 offen offset:1024 lds
    v_add_f32 v234, v234, v236
    v_add_f32 v235, v235, v237
    v_add_f32 v240, v240, v238
    v_add_f32 v241, v241, v239
    v_mfma_f32_32x32x16_bf16 v[32:47], v[72:75], v[188:191], v[32:47]
    s_set_gpr_idx_on s31, gpr_idx(DST)
    s_nop 0
    v_cvt_pk_bf16_f32 v192, v234, v235
    v_cvt_pk_bf16_f32 v193, v240, v241
    s_set_gpr_idx_off
    v_mfma_f32_32x32x16_bf16 v[48:63], v[76:79], v[188:191], v[48:63]
    s_waitcnt vmcnt(4) lgkmcnt(0)
    v_mfma_f32_32x32x16_bf16 v[0:15], v[80:83], v[176:179], v[0:15]
    ds_read_b64_tr_b16 v[184:185], v246 offset:6144
    ds_read_b64_tr_b16 v[186:187], v246 offset:6656
    ds_read_b64_tr_b16 v[188:189], v247 offset:6144
    ds_read_b64_tr_b16 v[190:191], v247 offset:6656
    s_mov_b32 m0, s70
    v_mfma_f32_32x32x16_bf16 v[16:31], v[84:87], v[176:179], v[16:31]
    buffer_load_dwordx4 v226, s[4:7], s42 offen lds
    buffer_load_dwordx4 v227, s[72:75], s42 offen offset:1024 lds
    v_mfma_f32_32x32x16_bf16 v[32:47], v[80:83], v[180:183], v[32:47]
    v_mfma_f32_32x32x16_bf16 v[48:63], v[84:87], v[180:183], v[48:63]
    s_waitcnt vmcnt(4) lgkmcnt(0)
    v_mfma_f32_32x32x16_bf16 v[0:15], v[88:91], v[184:187], v[0:15]
    ds_read_b64_tr_b16 v[176:177], v246 offset:0
    ds_read_b64_tr_b16 v[178:179], v246 offset:512
    ds_read_b64_tr_b16 v[180:181], v247 offset:0
    ds_read_b64_tr_b16 v[182:183], v247 offset:512
    s_mov_b32 m0, s71
    v_mfma_f32_32x32x16_bf16 v[16:31], v[92:95], v[184:187], v[16:31]
    buffer_load_dwordx4 v228, s[4:7], s42 offen lds
    buffer_load_dwordx4 v229, s[72:75], s42 offen offset:1024 lds
    v_mfma_f32_32x32x16_bf16 v[32:47], v[88:91], v[188:191], v[32:47]
    s_nop 2
    v_mul_f32 v234, v0, v144
    v_mul_f32 v236, v8, v112
    v_fmac_f32 v234, v1, v145
    v_fmac_f32 v236, v9, v113
    v_fmac_f32 v234, v2, v146
    v_fmac_f32 v236, v10, v114
    v_fmac_f32 v234, v3, v147
    v_mfma_f32_32x32x16_bf16 v[48:63], v[92:95], v[188:191], v[48:63]
    s_setprio 0
    v_fmac_f32 v236, v11, v115
    v_fmac_f32 v234, v4, v148
    v_fmac_f32 v236, v12, v116
    v_fmac_f32 v234, v5, v149
    v_fmac_f32 v236, v13, v117
    v_fmac_f32 v234, v6, v150
    v_fmac_f32 v236, v14, v118
    v_fmac_f32 v234, v7, v151
    v_fmac_f32 v236, v15, v119
    v_mul_f32 v238, v16, v160
    v_mul_f32 v240, v24, v160
    v_fmac_f32 v238, v17, v161
    v_fmac_f32 v240, v25, v161
    v_fmac_f32 v238, v18, v162
    v_fmac_f32 v240, v26, v162
    v_fmac_f32 v238, v19, v163
    v_fmac_f32 v240, v27, v163
    v_fmac_f32 v238, v20, v164
    v_fmac_f32 v240, v28, v164
    v_fmac_f32 v238, v21, v165
    v_fmac_f32 v240, v29, v165
    v_fmac_f32 v238, v22, v166
    v_fmac_f32 v240, v30, v166
    v_fmac_f32 v238, v23, v167
    v_fmac_f32 v240, v31, v167
    v_mul_f32 v235, v32, v152
    v_mul_f32 v237, v40, v120
    v_fmac_f32 v235, v33, v153
    v_fmac_f32 v237, v41, v121
    v_fmac_f32 v235, v34, v154
    v_fmac_f32 v237, v42, v122
    v_fmac_f32 v235, v35, v155
    v_fmac_f32 v237, v43, v123
    v_fmac_f32 v235, v36, v156
    v_fmac_f32 v237, v44, v124
    v_fmac_f32 v235, v37, v157
    v_fmac_f32 v237, v45, v125
    v_fmac_f32 v235, v38, v158
    v_fmac_f32 v237, v46, v126
    v_fmac_f32 v235, v39, v159
    v_fmac_f32 v237, v47, v127
    v_mul_f32 v239, v48, v168
    v_mul_f32 v241, v56, v168
    s_setprio 1
    s_waitcnt vmcnt(4) lgkmcnt(0)
    v_mfma_f32_32x32x16_bf16 v[0:15], v[64:67], v[176:179], 0
    ds_read_b64_tr_b16 v[184:185], v246 offset:2048
    ds_read_b64_tr_b16 v[186:187], v246 offset:2560
    ds_read_b64_tr_b16 v[188:189], v247 offset:2048
    ds_read_b64_tr_b16 v[190:191], v247 offset:2560
    v_fmac_f32 v239, v49, v169
    v_fmac_f32 v241, v57, v169
    s_mov_b32 m0, s68
    v_mfma_f32_32x32x16_bf16 v[16:31], v[68:71], v[176:179], 0
    buffer_load_dwordx4 v222, s[4:7], s43 offen lds
    buffer_load_dwordx4 v223, s[72:75], s43 offen offset:1024 lds
    v_fmac_f32 v239, v50, v170
    v_fmac_f32 v241, v58, v170
    v_fmac_f32 v239, v51, v171
    v_fmac_f32 v241, v59, v171
    v_fmac_f32 v239, v52, v172
    v_mfma_f32_32x32x16_bf16 v[32:47], v[64:67], v[180:183], 0
    v_fmac_f32 v241, v60, v172
    v_fmac_f32 v239, v53, v173
    v_fmac_f32 v241, v61, v173
    v_fmac_f32 v239, v54, v174
    v_fmac_f32 v241, v62, v174
    v_fmac_f32 v239, v55, v175
    v_fmac_f32 v241, v63, v175
    v_mfma_f32_32x32x16_bf16 v[48:63], v[68:71], v[180:183], 0
    s_waitcnt vmcnt(4) lgkmcnt(0)
    v_mfma_f32_32x32x16_bf16 v[0:15], v[72:75], v[184:187], v[0:15]
    ds_read_b64_tr_b16 v[176:177], v246 offset:4096
    ds_read_b64_tr_b16 v[178:179], v246 offset:4608
    ds_read_b64_tr_b16 v[180:181], v247 offset:4096
    ds_read_b64_tr_b16 v[182:183], v247 offset:4608
    s_mov_b32 m0, s69
    v_mfma_f32_32x32x16_bf16 v[16:31], v[76:79], v[184:187], v[16:31]
    buffer_load_dwordx4 v224, s[4:7], s43 offen lds
    buffer_load_dwordx4 v225, s[72:75], s43 offen offset:1024 lds
    v_mfma_f32_32x32x16_bf16 v[32:47], v[72:75], v[188:191], v[32:47]
    v_mfma_f32_32x32x16_bf16 v[48:63], v[76:79], v[188:191], v[48:63]
    s_waitcnt vmcnt(4) lgkmcnt(0)
    v_mfma_f32_32x32x16_bf16 v[0:15], v[80:83], v[176:179], v[0:15]
    ds_read_b64_tr_b16 v[184:185], v246 offset:6144
    ds_read_b64_tr_b16 v[186:187], v246 offset:6656
    ds_read_b64_tr_b16 v[188:189], v247 offset:6144
    ds_read_b64_tr_b16 v[190:191], v247 offset:6656
    s_mov_b32 m0, s70
    v_mfma_f32_32x32x16_bf16 v[16:31], v[84:87], v[176:179], v[16:31]
    buffer_load_dwordx4 v226, s[4:7], s43 offen lds
    buffer_load_dwordx4 v227, s[72:75], s43 offen offset:1024 lds
    v_mfma_f32_32x32x16_bf16 v[32:47], v[80:83], v[180:183], v[32:47]
    v_add_u32 v222, s48, v251
    ds_read_b32 v222, v222
    v_mfma_f32_32x32x16_bf16 v[48:63], v[84:87], v[180:183], v[48:63]
    s_waitcnt vmcnt(4) lgkmcnt(1)
    v_mfma_f32_32x32x16_bf16 v[0:15], v[88:91], v[184:187], v[0:15]
    ds_read_b64_tr_b16 v[176:177], v246 offset:0
    ds_read_b64_tr_b16 v[178:179], v246 offset:512
    ds_read_b64_tr_b16 v[180:181], v247 offset:0
    ds_read_b64_tr_b16 v[182:183], v247 offset:512
    s_mov_b32 m0, s71
    v_mfma_f32_32x32x16_bf16 v[16:31], v[92:95], v[184:187], v[16:31]
    buffer_load_dwordx4 v228, s[4:7], s43 offen lds
    buffer_load_dwordx4 v229, s[72:75], s43 offen offset:1024 lds
    s_waitcnt lgkmcnt(4)
    v_mad_u32_u16 v223, v222, s39, v248 op_sel:[1,0,0,0]
    v_mad_u32_u16 v222, v222, s39, v248
    v_mfma_f32_32x32x16_bf16 v[32:47], v[88:91], v[188:191], v[32:47]
    v_add_u32 v224, s49, v251
    ds_read_b32 v224, v224
    v_mul_f32 v242, v0, v144
    v_fma_f32 v238, v8, v160, -v238
    v_fmac_f32 v242, v1, v145
    v_fmac_f32 v238, v9, v161
    v_fmac_f32 v242, v2, v146
    v_mfma_f32_32x32x16_bf16 v[48:63], v[92:95], v[188:191], v[48:63]
    s_setprio 0
    v_fmac_f32 v238, v10, v162
    v_fmac_f32 v242, v3, v147
    v_fmac_f32 v238, v11, v163
    v_fmac_f32 v242, v4, v148
    v_fmac_f32 v238, v12, v164
    v_fmac_f32 v242, v5, v149
    v_fmac_f32 v238, v13, v165
    v_fmac_f32 v242, v6, v150
    v_fmac_f32 v238, v14, v166
    v_fmac_f32 v242, v7, v151
    v_fmac_f32 v238, v15, v167
    v_fmac_f32 v236, v16, v112
    v_mul_f32 v244, v24, v160
    v_fmac_f32 v236, v17, v113
    v_fmac_f32 v244, v25, v161
    v_fmac_f32 v236, v18, v114
    v_fmac_f32 v244, v26, v162
    v_fmac_f32 v236, v19, v115
    v_fmac_f32 v244, v27, v163
    v_fmac_f32 v236, v20, v116
    v_fmac_f32 v244, v28, v164
    v_fmac_f32 v236, v21, v117
    v_fmac_f32 v244, v29, v165
    v_fmac_f32 v236, v22, v118
    v_fmac_f32 v244, v30, v166
    v_fmac_f32 v236, v23, v119
    v_fmac_f32 v244, v31, v167
    v_mul_f32 v243, v32, v152
    v_fma_f32 v239, v40, v168, -v239
    v_fmac_f32 v243, v33, v153
    v_fmac_f32 v239, v41, v169
    v_fmac_f32 v243, v34, v154
    v_fmac_f32 v239, v42, v170
    v_fmac_f32 v243, v35, v155
    v_fmac_f32 v239, v43, v171
    v_fmac_f32 v243, v36, v156
    v_fmac_f32 v239, v44, v172
    v_fmac_f32 v243, v37, v157
    v_fmac_f32 v239, v45, v173
    v_fmac_f32 v243, v38, v158
    v_fmac_f32 v239, v46, v174
    v_fmac_f32 v243, v39, v159
    v_fmac_f32 v239, v47, v175
    v_fmac_f32 v237, v48, v120
    v_mul_f32 v245, v56, v168
    v_fmac_f32 v237, v49, v121
    v_fmac_f32 v245, v57, v169
    v_fmac_f32 v237, v50, v122
    v_fmac_f32 v245, v58, v170
    v_fmac_f32 v237, v51, v123
    s_setprio 1
    s_waitcnt vmcnt(4) lgkmcnt(1)
    v_mfma_f32_32x32x16_bf16 v[0:15], v[64:67], v[176:179], 0
    ds_read_b64_tr_b16 v[184:185], v246 offset:2048
    ds_read_b64_tr_b16 v[186:187], v246 offset:2560
    ds_read_b64_tr_b16 v[188:189], v247 offset:2048
    ds_read_b64_tr_b16 v[190:191], v247 offset:2560
    v_fmac_f32 v245, v59, v171
    v_fmac_f32 v237, v52, v124
    s_mov_b32 m0, s68
    v_mfma_f32_32x32x16_bf16 v[16:31], v[68:71], v[176:179], 0
    buffer_load_dwordx4 v222, s[4:7], s44 offen lds
    buffer_load_dwordx4 v223, s[72:75], s44 offen offset:1024 lds
    s_waitcnt lgkmcnt(4)
    v_mad_u32_u16 v225, v224, s39, v248 op_sel:[1,0,0,0]
    v_mad_u32_u16 v224, v224, s39, v248
    v_fmac_f32 v245, v60, v172
    v_fmac_f32 v237, v53, v125
    v_mfma_f32_32x32x16_bf16 v[32:47], v[64:67], v[180:183], 0
    v_add_u32 v226, s50, v251
    ds_read_b32 v226, v226
    v_fmac_f32 v245, v61, v173
    v_fmac_f32 v237, v54, v126
    v_fmac_f32 v245, v62, v174
    v_fmac_f32 v237, v55, v127
    v_fmac_f32 v245, v63, v175
    v_mfma_f32_32x32x16_bf16 v[48:63], v[68:71], v[180:183], 0
    v_permlane32_swap_b32 v242, v234
    v_permlane32_swap_b32 v243, v235
    v_add_f32 v242, v242, v234
    v_add_f32 v243, v243, v235
    s_waitcnt vmcnt(4) lgkmcnt(1)
    v_mfma_f32_32x32x16_bf16 v[0:15], v[72:75], v[184:187], v[0:15]
    ds_read_b64_tr_b16 v[176:177], v246 offset:4096
    ds_read_b64_tr_b16 v[178:179], v246 offset:4608
    ds_read_b64_tr_b16 v[180:181], v247 offset:4096
    ds_read_b64_tr_b16 v[182:183], v247 offset:4608
    s_mov_b32 m0, s69
    v_mfma_f32_32x32x16_bf16 v[16:31], v[76:79], v[184:187], v[16:31]
    buffer_load_dwordx4 v224, s[4:7], s45 offen lds
    buffer_load_dwordx4 v225, s[72:75], s45 offen offset:1024 lds
    s_waitcnt lgkmcnt(4)
    v_mad_u32_u16 v227, v226, s39, v248 op_sel:[1,0,0,0]
    v_mad_u32_u16 v226, v226, s39, v248
    v_mfma_f32_32x32x16_bf16 v[32:47], v[72:75], v[188:191], v[32:47]
    v_add_u32 v228, s51, v251
    ds_read_b32 v228, v228
    s_set_gpr_idx_on s31, gpr_idx(DST)
    s_nop 0
    v_cvt_pk_bf16_f32 v194, v242, v243
    s_set_gpr_idx_off
    v_mfma_f32_32x32x16_bf16 v[48:63], v[76:79], v[188:191], v[48:63]
    s_waitcnt vmcnt(4) lgkmcnt(1)
    v_mfma_f32_32x32x16_bf16 v[0:15], v[80:83], v[176:179], v[0:15]
    ds_read_b64_tr_b16 v[184:185], v246 offset:6144
    ds_read_b64_tr_b16 v[186:187], v246 offset:6656
    ds_read_b64_tr_b16 v[188:189], v247 offset:6144
    ds_read_b64_tr_b16 v[190:191], v247 offset:6656
    s_mov_b32 s32, s31
    s_mov_b32 s31, s35
    s_mov_b32 m0, s70
    v_mfma_f32_32x32x16_bf16 v[16:31], v[84:87], v[176:179], v[16:31]
    buffer_load_dwordx4 v226, s[4:7], s46 offen lds
    buffer_load_dwordx4 v227, s[72:75], s46 offen offset:1024 lds
    s_waitcnt lgkmcnt(4)
    v_mad_u32_u16 v229, v228, s39, v248 op_sel:[1,0,0,0]
    v_mad_u32_u16 v228, v228, s39, v248
    s_sub_u32 s26, s48, s29
    s_mov_b32 s29, s48
    v_mfma_f32_32x32x16_bf16 v[32:47], v[80:83], v[180:183], v[32:47]
    s_mov_b32 s30, s3
    s_cmp_eq_u32 s34, 0
    s_cselect_b32 s56, s33, 0
    v_mfma_f32_32x32x16_bf16 v[48:63], v[84:87], v[180:183], v[48:63]
    s_waitcnt vmcnt(4) lgkmcnt(0)
    v_mfma_f32_32x32x16_bf16 v[0:15], v[88:91], v[184:187], v[0:15]
    ds_read_b64_tr_b16 v[176:177], v246 offset:0
    ds_read_b64_tr_b16 v[178:179], v246 offset:512
    ds_read_b64_tr_b16 v[180:181], v247 offset:0
    ds_read_b64_tr_b16 v[182:183], v247 offset:512
    s_mov_b32 m0, s71
    v_mfma_f32_32x32x16_bf16 v[16:31], v[92:95], v[184:187], v[16:31]
    buffer_load_dwordx4 v228, s[4:7], s47 offen lds
    buffer_load_dwordx4 v229, s[72:75], s47 offen offset:1024 lds
    v_mfma_f32_32x32x16_bf16 v[32:47], v[88:91], v[188:191], v[32:47]
    s_nop 2
    v_mul_f32 v242, v0, v144
    v_fma_f32 v240, v8, v160, -v240
    v_fmac_f32 v242, v1, v145
    v_fmac_f32 v240, v9, v161
    v_fmac_f32 v242, v2, v146
    v_fmac_f32 v240, v10, v162
    v_fmac_f32 v242, v3, v147
    v_mfma_f32_32x32x16_bf16 v[48:63], v[92:95], v[188:191], v[48:63]
    s_setprio 0
    v_fmac_f32 v240, v11, v163
    v_fmac_f32 v242, v4, v148
    v_fmac_f32 v240, v12, v164
    v_fmac_f32 v242, v5, v149
    v_fmac_f32 v240, v13, v165
    v_fmac_f32 v242, v6, v150
    v_fmac_f32 v240, v14, v166
    v_fmac_f32 v242, v7, v151
    v_fmac_f32 v240, v15, v167
    v_add_u32 v249, s26, v249
    v_add_u32 v250, s26, v250
    v_fma_f32 v244, v16, v160, -v244
    v_fmac_f32 v236, v24, v112
    v_fmac_f32 v244, v17, v161
    v_fmac_f32 v236, v25, v113
    v_fmac_f32 v244, v18, v162
    v_fmac_f32 v236, v26, v114
    v_fmac_f32 v244, v19, v163
    v_fmac_f32 v236, v27, v115
    v_fmac_f32 v244, v20, v164
    v_fmac_f32 v236, v28, v116
    v_fmac_f32 v244, v21, v165
    v_fmac_f32 v236, v29, v117
    v_fmac_f32 v244, v22, v166
    v_fmac_f32 v236, v30, v118
    v_fmac_f32 v244, v23, v167
    v_fmac_f32 v236, v31, v119
    ds_read_b64_tr_b16 v[0:1], v249 offset:0
    ds_read_b64_tr_b16 v[2:3], v249 offset:128
    ds_read_b128 v[4:7], v250 offset:0
    ds_read_b128 v[8:11], v250 offset:16
    ds_read_b128 v[12:15], v250 offset:384
    ds_read_b128 v[16:19], v250 offset:400
    v_mul_f32 v243, v32, v152
    v_fma_f32 v241, v40, v168, -v241
    v_fmac_f32 v243, v33, v153
    v_fmac_f32 v241, v41, v169
    v_fmac_f32 v243, v34, v154
    v_fmac_f32 v241, v42, v170
    v_fmac_f32 v243, v35, v155
    v_fmac_f32 v241, v43, v171
    v_fmac_f32 v243, v36, v156
    v_fmac_f32 v241, v44, v172
    v_fmac_f32 v243, v37, v157
    v_fmac_f32 v241, v45, v173
    v_fmac_f32 v243, v38, v158
    v_fmac_f32 v241, v46, v174
    v_fmac_f32 v243, v39, v159
    v_fmac_f32 v241, v47, v175
    ds_read_b64_tr_b16 v[20:21], v249 offset:512
    ds_read_b64_tr_b16 v[22:23], v249 offset:640
    ds_read_b128 v[24:27], v250 offset:64
    ds_read_b128 v[28:31], v250 offset:80
    ds_read_b128 v[32:35], v250 offset:448
    ds_read_b128 v[36:39], v250 offset:464
    v_fma_f32 v245, v48, v168, -v245
    v_fmac_f32 v237, v56, v120
    v_fmac_f32 v245, v49, v169
    v_fmac_f32 v237, v57, v121
    v_fmac_f32 v245, v50, v170
    v_fmac_f32 v237, v58, v122
    v_fmac_f32 v245, v51, v171
    v_fmac_f32 v237, v59, v123
    v_fmac_f32 v245, v52, v172
    v_fmac_f32 v237, v60, v124
    v_fmac_f32 v245, v53, v173
    v_fmac_f32 v237, v61, v125
    v_fmac_f32 v245, v54, v174
    v_fmac_f32 v237, v62, v126
    v_fmac_f32 v245, v55, v175
    v_fmac_f32 v237, v63, v127
    s_cmp_eq_u32 s56, 2
    s_cbranch_scc1 K2_U20
    s_cmp_eq_u32 s56, 3
    s_cbranch_scc1 K2_U30
    s_branch K2_DSP0
K2_U11:
    s_setprio 1
    v_mov_b32 v254, 163648
    v_mov_b32 v255, 1
    v_lshl_add_u32 v233, v252, 1, s53
    s_mov_b64 exec, 1
    ds_add_rtn_u32 v232, v254, v255
    s_mov_b64 exec, -1
    ds_read_b32 v233, v233
    s_waitcnt lgkmcnt(8)
    v_lshlrev_b32 v40, 16, v0
    v_and_b32 v41, 0xffff0000, v0
    v_lshlrev_b32 v42, 16, v1
    v_and_b32 v43, 0xffff0000, v1
    v_lshlrev_b32 v44, 16, v2
    v_and_b32 v45, 0xffff0000, v2
    v_lshlrev_b32 v46, 16, v3
    v_and_b32 v47, 0xffff0000, v3
    v_mul_f32 v4, v40, v4
    v_mul_f32 v5, v41, v5
    v_mul_f32 v6, v42, v6
    v_mul_f32 v7, v43, v7
    v_mul_f32 v8, v44, v8
    v_mul_f32 v9, v45, v9
    v_mul_f32 v10, v46, v10
    v_mul_f32 v11, v47, v11
    v_cvt_pk_bf16_f32 v64, v4, v5
    v_cvt_pk_bf16_f32 v65, v6, v7
    v_cvt_pk_bf16_f32 v66, v8, v9
    v_cvt_pk_bf16_f32 v67, v10, v11
    v_mul_f32 v12, v40, v12
    v_mul_f32 v13, v41, v13
    v_mul_f32 v14, v42, v14
    v_mul_f32 v15, v43, v15
    v_mul_f32 v16, v44, v16
    v_mul_f32 v17, v45, v17
    v_mul_f32 v18, v46, v18
    v_mul_f32 v19, v47, v19
    v_cvt_pk_bf16_f32 v68, v12, v13
    v_cvt_pk_bf16_f32 v69, v14, v15
    v_cvt_pk_bf16_f32 v70, v16, v17
    v_cvt_pk_bf16_f32 v71, v18, v19
    s_waitcnt lgkmcnt(0)
    v_readfirstlane_b32 s58, v232
    s_nop 0
    s_cmp_lt_u32 s58, s22
    s_cbranch_scc0 K2_nul_84
    s_and_b32 s59, s58, 7
    s_lshr_b32 s60, s58, 3
K2_chk_86:
    v_readlane_b32 s61, v233, s59
    s_nop 0
    s_cmp_gt_u32 s61, s60
    s_cbranch_scc0 K2_spin_85
K2_back_87:
    v_readlane_b32 s3, v253, s58
    s_lshl_b32 s44, s34, 7
    s_lshl_b32 s60, s58, 5
    s_and_b32 s48, s3, 0x3ffff
    s_bfe_u32 s33, s3, 0x30012
    s_sub_u32 s60, s60, s48
    s_and_b32 s60, s60, 0xff
    s_add_u32 s35, s60, s48
    s_mov_b32 s45, s44
    s_add_u32 s47, s44, 256
    s_add_u32 s49, s48, 32
    s_add_u32 s60, s48, 64
    s_cmp_eq_u32 s33, 3
    s_cselect_b32 s46, s44, s47
    s_cselect_b32 s50, s60, s48
    s_cselect_b32 s51, s48, s49
    s_sub_u32 s60, s33, 2
    s_cmp_lt_u32 s60, 2
    s_cbranch_scc0 K2_rare_88
K2_back_89:
    v_add_u32 v222, s48, v251
    ds_read_b32 v222, v222
    v_add_u32 v224, s49, v251
    ds_read_b32 v224, v224
    v_add_u32 v226, s50, v251
    ds_read_b32 v226, v226
    v_add_u32 v228, s51, v251
    ds_read_b32 v228, v228
    s_waitcnt lgkmcnt(3)
    v_mad_u32_u16 v223, v222, s39, v248 op_sel:[1,0,0,0]
    v_mad_u32_u16 v222, v222, s39, v248
    s_waitcnt lgkmcnt(2)
    v_mad_u32_u16 v225, v224, s39, v248 op_sel:[1,0,0,0]
    v_mad_u32_u16 v224, v224, s39, v248
    s_waitcnt lgkmcnt(1)
    v_mad_u32_u16 v227, v226, s39, v248 op_sel:[1,0,0,0]
    v_mad_u32_u16 v226, v226, s39, v248
    s_waitcnt lgkmcnt(0)
    v_mad_u32_u16 v229, v228, s39, v248 op_sel:[1,0,0,0]
    v_mad_u32_u16 v228, v228, s39, v248
    s_waitcnt vmcnt(4)
    v_mfma_f32_32x32x16_bf16 v[0:15], v[64:67], v[176:179], 0
    ds_read_b64_tr_b16 v[184:185], v246 offset:2048
    ds_read_b64_tr_b16 v[186:187], v246 offset:2560
    ds_read_b64_tr_b16 v[188:189], v247 offset:2048
    ds_read_b64_tr_b16 v[190:191], v247 offset:2560
    s_mov_b32 m0, s68
    v_mfma_f32_32x32x16_bf16 v[16:31], v[68:71], v[176:179], 0
    buffer_load_dwordx4 v222, s[4:7], s44 offen lds
    buffer_load_dwordx4 v223, s[72:75], s44 offen offset:1024 lds
    v_permlane32_swap_b32 v242, v236
    v_permlane32_swap_b32 v243, v237
    v_mfma_f32_32x32x16_bf16 v[32:47], v[64:67], v[180:183], 0
    v_permlane32_swap_b32 v244, v238
    v_permlane32_swap_b32 v245, v239
    v_permlane32_swap_b32 v240, v241
    v_add_f32 v242, v242, v236
    v_mfma_f32_32x32x16_bf16 v[48:63], v[68:71], v[180:183], 0
    s_setprio 0
    v_add_f32 v243, v243, v237
    v_add_f32 v244, v244, v238
    v_add_f32 v245, v245, v239
    v_add_f32 v240, -v240, -v241
    v_sub_u32 v241, v230, v231
    v_cvt_pk_bf16_f32 v242, v242, v243
    v_cvt_pk_bf16_f32 v244, v244, v245
    v_cvt_pk_bf16_f32 v240, v240, v240
    ds_write_b32 v230, v242 offset:768
    ds_write_b32 v230, v244 offset:1024
    ds_write_b16 v241, v240 offset:1280
    v_mul_f32 v234, v0, v96
    v_mul_f32 v236, v8, v128
    v_fmac_f32 v234, v1, v97
    v_fmac_f32 v236, v9, v129
    v_fmac_f32 v234, v2, v98
    v_fmac_f32 v236, v10, v130
    v_fmac_f32 v234, v3, v99
    v_fmac_f32 v236, v11, v131
    v_fmac_f32 v234, v4, v100
    v_fmac_f32 v236, v12, v132
    v_fmac_f32 v234, v5, v101
    v_fmac_f32 v236, v13, v133
    v_fmac_f32 v234, v6, v102
    v_fmac_f32 v236, v14, v134
    v_fmac_f32 v234, v7, v103
    v_fmac_f32 v236, v15, v135
    v_mul_f32 v238, v16, v128
    v_mul_f32 v240, v24, v128
    v_fmac_f32 v238, v17, v129
    v_fmac_f32 v240, v25, v129
    v_fmac_f32 v238, v18, v130
    v_fmac_f32 v240, v26, v130
    v_fmac_f32 v238, v19, v131
    v_fmac_f32 v240, v27, v131
    v_fmac_f32 v238, v20, v132
    v_fmac_f32 v240, v28, v132
    v_fmac_f32 v238, v21, v133
    v_fmac_f32 v240, v29, v133
    v_fmac_f32 v238, v22, v134
    v_fmac_f32 v240, v30, v134
    v_fmac_f32 v238, v23, v135
    v_fmac_f32 v240, v31, v135
    v_mul_f32 v235, v32, v104
    v_mul_f32 v237, v40, v136
    v_fmac_f32 v235, v33, v105
    v_fmac_f32 v237, v41, v137
    v_fmac_f32 v235, v34, v106
    v_fmac_f32 v237, v42, v138
    v_fmac_f32 v235, v35, v107
    v_fmac_f32 v237, v43, v139
    v_fmac_f32 v235, v36, v108
    v_fmac_f32 v237, v44, v140
    v_fmac_f32 v235, v37, v109
    v_fmac_f32 v237, v45, v141
    v_fmac_f32 v235, v38, v110
    v_fmac_f32 v237, v46, v142
    v_fmac_f32 v235, v39, v111
    v_fmac_f32 v237, v47, v143
    v_mul_f32 v239, v48, v136
    v_mul_f32 v241, v56, v136
    v_fmac_f32 v239, v49, v137
    v_fmac_f32 v241, v57, v137
    v_fmac_f32 v239, v50, v138
    v_fmac_f32 v241, v58, v138
    v_fmac_f32 v239, v51, v139
    v_fmac_f32 v241, v59, v139
    v_fmac_f32 v239, v52, v140
    v_fmac_f32 v241, v60, v140
    v_fmac_f32 v239, v53, v141
    v_fmac_f32 v241, v61, v141
    v_fmac_f32 v239, v54, v142
    v_fmac_f32 v241, v62, v142
    v_fmac_f32 v239, v55, v143
    v_fmac_f32 v241, v63, v143
    s_setprio 1
    s_waitcnt vmcnt(4) lgkmcnt(3)
    v_mfma_f32_32x32x16_bf16 v[0:15], v[64:67], v[184:187], 0
    ds_read_b64_tr_b16 v[176:177], v246 offset:4096
    ds_read_b64_tr_b16 v[178:179], v246 offset:4608
    ds_read_b64_tr_b16 v[180:181], v247 offset:4096
    ds_read_b64_tr_b16 v[182:183], v247 offset:4608
    s_mov_b32 m0, s69
    v_mfma_f32_32x32x16_bf16 v[16:31], v[68:71], v[184:187], 0
    buffer_load_dwordx4 v224, s[4:7], s45 offen lds
    buffer_load_dwordx4 v225, s[72:75], s45 offen offset:1024 lds
    v_permlane32_swap_b32 v234, v236
    v_permlane32_swap_b32 v235, v237
    v_mfma_f32_32x32x16_bf16 v[32:47], v[64:67], v[188:191], 0
    v_permlane32_swap_b32 v240, v238
    v_permlane32_swap_b32 v241, v239
    v_lshl_add_u32 v230, v252, 1, s31
    v_add_f32 v234, v234, v236
    v_add_f32 v235, v235, v237
    v_mfma_f32_32x32x16_bf16 v[48:63], v[68:71], v[188:191], 0
    s_setprio 0
    v_add_f32 v240, v240, v238
    v_add_f32 v241, v241, v239
    v_cvt_pk_bf16_f32 v234, v234, v235
    v_cvt_pk_bf16_f32 v240, v240, v241
    ds_write_b32 v230, v234 offset:0
    ds_write_b32 v230, v240 offset:256
    v_mul_f32 v234, v0, v144
    v_mul_f32 v236, v8, v112
    v_fmac_f32 v234, v1, v145
    v_fmac_f32 v236, v9, v113
    v_fmac_f32 v234, v2, v146
    v_fmac_f32 v236, v10, v114
    v_fmac_f32 v234, v3, v147
    v_fmac_f32 v236, v11, v115
    v_fmac_f32 v234, v4, v148
    v_fmac_f32 v236, v12, v116
    v_fmac_f32 v234, v5, v149
    v_fmac_f32 v236, v13, v117
    v_fmac_f32 v234, v6, v150
    v_fmac_f32 v236, v14, v118
    v_fmac_f32 v234, v7, v151
    v_fmac_f32 v236, v15, v119
    v_mul_f32 v238, v16, v160
    v_mul_f32 v240, v24, v160
    v_fmac_f32 v238, v17, v161
    v_fmac_f32 v240, v25, v161
    v_fmac_f32 v238, v18, v162
    v_fmac_f32 v240, v26, v162
    v_fmac_f32 v238, v19, v163
    v_fmac_f32 v240, v27, v163
    v_fmac_f32 v238, v20, v164
    v_fmac_f32 v240, v28, v164
    v_fmac_f32 v238, v21, v165
    v_fmac_f32 v240, v29, v165
    v_fmac_f32 v238, v22, v166
    v_fmac_f32 v240, v30, v166
    v_fmac_f32 v238, v23, v167
    v_fmac_f32 v240, v31, v167
    v_mul_f32 v235, v32, v152
    v_mul_f32 v237, v40, v120
    v_fmac_f32 v235, v33, v153
    v_fmac_f32 v237, v41, v121
    v_fmac_f32 v235, v34, v154
    v_fmac_f32 v237, v42, v122
    v_fmac_f32 v235, v35, v155
    v_fmac_f32 v237, v43, v123
    v_fmac_f32 v235, v36, v156
    v_fmac_f32 v237, v44, v124
    v_fmac_f32 v235, v37, v157
    v_fmac_f32 v237, v45, v125
    v_fmac_f32 v235, v38, v158
    v_fmac_f32 v237, v46, v126
    v_fmac_f32 v235, v39, v159
    v_fmac_f32 v237, v47, v127
    v_mul_f32 v239, v48, v168
    v_mul_f32 v241, v56, v168
    v_fmac_f32 v239, v49, v169
    v_fmac_f32 v241, v57, v169
    v_fmac_f32 v239, v50, v170
    v_fmac_f32 v241, v58, v170
    v_fmac_f32 v239, v51, v171
    v_fmac_f32 v241, v59, v171
    v_fmac_f32 v239, v52, v172
    v_fmac_f32 v241, v60, v172
    v_fmac_f32 v239, v53, v173
    v_fmac_f32 v241, v61, v173
    v_fmac_f32 v239, v54, v174
    v_fmac_f32 v241, v62, v174
    v_fmac_f32 v239, v55, v175
    v_fmac_f32 v241, v63, v175
    s_setprio 1
    s_waitcnt vmcnt(4) lgkmcnt(2)
    v_mfma_f32_32x32x16_bf16 v[0:15], v[64:67], v[176:179], 0
    ds_read_b64_tr_b16 v[184:185], v246 offset:6144
    ds_read_b64_tr_b16 v[186:187], v246 offset:6656
    ds_read_b64_tr_b16 v[188:189], v247 offset:6144
    ds_read_b64_tr_b16 v[190:191], v247 offset:6656
    s_mov_b32 s32, s31
    s_mov_b32 s31, s35
    s_mov_b32 m0, s70
    v_mfma_f32_32x32x16_bf16 v[16:31], v[68:71], v[176:179], 0
    buffer_load_dwordx4 v226, s[4:7], s46 offen lds
    buffer_load_dwordx4 v227, s[72:75], s46 offen offset:1024 lds
    s_sub_u32 s26, s48, s29
    s_mov_b32 s29, s48
    s_mov_b32 s30, s3
    s_cmp_lg_u32 s36, 0
    s_cselect_b32 s56, s33, 0
    v_mfma_f32_32x32x16_bf16 v[32:47], v[64:67], v[180:183], 0
    v_mfma_f32_32x32x16_bf16 v[48:63], v[68:71], v[180:183], 0
    s_setprio 0
    v_mul_f32 v242, v0, v144
    v_fma_f32 v238, v8, v160, -v238
    v_fmac_f32 v242, v1, v145
    v_fmac_f32 v238, v9, v161
    v_fmac_f32 v242, v2, v146
    v_fmac_f32 v238, v10, v162
    v_fmac_f32 v242, v3, v147
    v_fmac_f32 v238, v11, v163
    v_fmac_f32 v242, v4, v148
    v_fmac_f32 v238, v12, v164
    v_fmac_f32 v242, v5, v149
    v_fmac_f32 v238, v13, v165
    v_fmac_f32 v242, v6, v150
    v_fmac_f32 v238, v14, v166
    v_fmac_f32 v242, v7, v151
    v_fmac_f32 v238, v15, v167
    v_fmac_f32 v236, v16, v112
    v_mul_f32 v244, v24, v160
    v_fmac_f32 v236, v17, v113
    v_fmac_f32 v244, v25, v161
    v_fmac_f32 v236, v18, v114
    v_fmac_f32 v244, v26, v162
    v_fmac_f32 v236, v19, v115
    v_fmac_f32 v244, v27, v163
    v_fmac_f32 v236, v20, v116
    v_fmac_f32 v244, v28, v164
    v_fmac_f32 v236, v21, v117
    v_fmac_f32 v244, v29, v165
    v_fmac_f32 v236, v22, v118
    v_fmac_f32 v244, v30, v166
    v_fmac_f32 v236, v23, v119
    v_fmac_f32 v244, v31, v167
    v_mul_f32 v243, v32, v152
    v_fma_f32 v239, v40, v168, -v239
    v_fmac_f32 v243, v33, v153
    v_fmac_f32 v239, v41, v169
    v_fmac_f32 v243, v34, v154
    v_fmac_f32 v239, v42, v170
    v_fmac_f32 v243, v35, v155
    v_fmac_f32 v239, v43, v171
    v_fmac_f32 v243, v36, v156
    v_fmac_f32 v239, v44, v172
    v_fmac_f32 v243, v37, v157
    v_fmac_f32 v239, v45, v173
    v_fmac_f32 v243, v38, v158
    v_fmac_f32 v239, v46, v174
    v_fmac_f32 v243, v39, v159
    v_fmac_f32 v239, v47, v175
    v_fmac_f32 v237, v48, v120
    v_mul_f32 v245, v56, v168
    v_fmac_f32 v237, v49, v121
    v_fmac_f32 v245, v57, v169
    v_fmac_f32 v237, v50, v122
    v_fmac_f32 v245, v58, v170
    v_fmac_f32 v237, v51, v123
    v_fmac_f32 v245, v59, v171
    v_fmac_f32 v237, v52, v124
    v_fmac_f32 v245, v60, v172
    v_fmac_f32 v237, v53, v125
    v_fmac_f32 v245, v61, v173
    v_fmac_f32 v237, v54, v126
    v_fmac_f32 v245, v62, v174
    v_fmac_f32 v237, v55, v127
    v_fmac_f32 v245, v63, v175
    s_setprio 1
    s_waitcnt vmcnt(4) lgkmcnt(0)
    v_mfma_f32_32x32x16_bf16 v[0:15], v[64:67], v[184:187], 0
    ds_read_b64_tr_b16 v[176:177], v246 offset:0
    ds_read_b64_tr_b16 v[178:179], v246 offset:512
    ds_read_b64_tr_b16 v[180:181], v247 offset:0
    ds_read_b64_tr_b16 v[182:183], v247 offset:512
    s_mov_b32 m0, s71
    v_mfma_f32_32x32x16_bf16 v[16:31], v[68:71], v[184:187], 0
    buffer_load_dwordx4 v228, s[4:7], s47 offen lds
    buffer_load_dwordx4 v229, s[72:75], s47 offen offset:1024 lds
    v_permlane32_swap_b32 v242, v234
    v_permlane32_swap_b32 v243, v235
    v_add_f32 v242, v242, v234
    v_mfma_f32_32x32x16_bf16 v[32:47], v[64:67], v[188:191], 0
    v_add_f32 v243, v243, v235
    v_cvt_pk_bf16_f32 v242, v242, v243
    ds_write_b32 v230, v242 offset:512
    v_mfma_f32_32x32x16_bf16 v[48:63], v[68:71], v[188:191], 0
    s_setprio 0
    v_mul_f32 v242, v0, v144
    v_fma_f32 v240, v8, v160, -v240
    v_fmac_f32 v242, v1, v145
    v_fmac_f32 v240, v9, v161
    v_fmac_f32 v242, v2, v146
    v_fmac_f32 v240, v10, v162
    v_fmac_f32 v242, v3, v147
    v_fmac_f32 v240, v11, v163
    v_fmac_f32 v242, v4, v148
    v_fmac_f32 v240, v12, v164
    v_fmac_f32 v242, v5, v149
    v_fmac_f32 v240, v13, v165
    v_fmac_f32 v242, v6, v150
    v_fmac_f32 v240, v14, v166
    v_fmac_f32 v242, v7, v151
    v_fmac_f32 v240, v15, v167
    v_add_u32 v249, s26, v249
    v_add_u32 v250, s26, v250
    v_fma_f32 v244, v16, v160, -v244
    v_fmac_f32 v236, v24, v112
    v_fmac_f32 v244, v17, v161
    v_fmac_f32 v236, v25, v113
    v_fmac_f32 v244, v18, v162
    v_fmac_f32 v236, v26, v114
    v_fmac_f32 v244, v19, v163
    v_fmac_f32 v236, v27, v115
    v_fmac_f32 v244, v20, v164
    v_fmac_f32 v236, v28, v116
    v_fmac_f32 v244, v21, v165
    v_fmac_f32 v236, v29, v117
    v_fmac_f32 v244, v22, v166
    v_fmac_f32 v236, v30, v118
    v_fmac_f32 v244, v23, v167
    v_fmac_f32 v236, v31, v119
    ds_read_b64_tr_b16 v[0:1], v249 offset:0
    ds_read_b64_tr_b16 v[2:3], v249 offset:128
    ds_read_b128 v[4:7], v250 offset:0
    ds_read_b128 v[8:11], v250 offset:16
    ds_read_b128 v[12:15], v250 offset:384
    ds_read_b128 v[16:19], v250 offset:400
    v_mul_f32 v243, v32, v152
    v_fma_f32 v241, v40, v168, -v241
    v_fmac_f32 v243, v33, v153
    v_fmac_f32 v241, v41, v169
    v_fmac_f32 v243, v34, v154
    v_fmac_f32 v241, v42, v170
    v_fmac_f32 v243, v35, v155
    v_fmac_f32 v241, v43, v171
    v_fmac_f32 v243, v36, v156
    v_fmac_f32 v241, v44, v172
    v_fmac_f32 v243, v37, v157
    v_fmac_f32 v241, v45, v173
    v_fmac_f32 v243, v38, v158
    v_fmac_f32 v241, v46, v174
    v_fmac_f32 v243, v39, v159
    v_fmac_f32 v241, v47, v175
    ds_read_b64_tr_b16 v[20:21], v249 offset:512
    ds_read_b64_tr_b16 v[22:23], v249 offset:640
    ds_read_b128 v[24:27], v250 offset:64
    ds_read_b128 v[28:31], v250 offset:80
    ds_read_b128 v[32:35], v250 offset:448
    ds_read_b128 v[36:39], v250 offset:464
    v_fma_f32 v245, v48, v168, -v245
    v_fmac_f32 v237, v56, v120
    v_fmac_f32 v245, v49, v169
    v_fmac_f32 v237, v57, v121
    v_fmac_f32 v245, v50, v170
    v_fmac_f32 v237, v58, v122
    v_fmac_f32 v245, v51, v171
    v_fmac_f32 v237, v59, v123
    v_fmac_f32 v245, v52, v172
    v_fmac_f32 v237, v60, v124
    v_fmac_f32 v245, v53, v173
    v_fmac_f32 v237, v61, v125
    v_fmac_f32 v245, v54, v174
    v_fmac_f32 v237, v62, v126
    v_fmac_f32 v245, v55, v175
    v_fmac_f32 v237, v63, v127
    s_cmp_eq_u32 s56, 2
    s_cbranch_scc1 K2_U21
    s_cmp_eq_u32 s56, 3
    s_cbranch_scc1 K2_U31
    s_branch K2_DSP1
K2_U41:
    s_setprio 1
    s_waitcnt lgkmcnt(6)
    v_lshlrev_b32 v40, 16, v0
    v_and_b32 v41, 0xffff0000, v0
    v_lshlrev_b32 v42, 16, v1
    v_and_b32 v43, 0xffff0000, v1
    v_lshlrev_b32 v44, 16, v2
    v_and_b32 v45, 0xffff0000, v2
    v_lshlrev_b32 v46, 16, v3
    v_and_b32 v47, 0xffff0000, v3
    v_mul_f32 v4, v40, v4
    v_mul_f32 v5, v41, v5
    v_mul_f32 v6, v42, v6
    v_mul_f32 v7, v43, v7
    v_mul_f32 v8, v44, v8
    v_mul_f32 v9, v45, v9
    v_mul_f32 v10, v46, v10
    v_mul_f32 v11, v47, v11
    v_cvt_pk_bf16_f32 v64, v4, v5
    v_cvt_pk_bf16_f32 v65, v6, v7
    v_cvt_pk_bf16_f32 v66, v8, v9
    v_cvt_pk_bf16_f32 v67, v10, v11
    v_mul_f32 v12, v40, v12
    v_mul_f32 v13, v41, v13
    v_mul_f32 v14, v42, v14
    v_mul_f32 v15, v43, v15
    v_mul_f32 v16, v44, v16
    v_mul_f32 v17, v45, v17
    v_mul_f32 v18, v46, v18
    v_mul_f32 v19, v47, v19
    v_cvt_pk_bf16_f32 v68, v12, v13
    v_cvt_pk_bf16_f32 v69, v14, v15
    v_cvt_pk_bf16_f32 v70, v16, v17
    v_cvt_pk_bf16_f32 v71, v18, v19
    ds_read_b64_tr_b16 v[0:1], v249 offset:1024
    ds_read_b64_tr_b16 v[2:3], v249 offset:1152
    ds_read_b128 v[4:7], v250 offset:128
    ds_read_b128 v[8:11], v250 offset:144
    ds_read_b128 v[12:15], v250 offset:512
    ds_read_b128 v[16:19], v250 offset:528
    s_waitcnt lgkmcnt(6)
    v_lshlrev_b32 v48, 16, v20
    v_and_b32 v49, 0xffff0000, v20
    v_lshlrev_b32 v50, 16, v21
    v_and_b32 v51, 0xffff0000, v21
    v_lshlrev_b32 v52, 16, v22
    v_and_b32 v53, 0xffff0000, v22
    v_lshlrev_b32 v54, 16, v23
    v_and_b32 v55, 0xffff0000, v23
    v_mul_f32 v24, v48, v24
    v_mul_f32 v25, v49, v25
    v_mul_f32 v26, v50, v26
    v_mul_f32 v27, v51, v27
    v_mul_f32 v28, v52, v28
    v_mul_f32 v29, v53, v29
    v_mul_f32 v30, v54, v30
    v_mul_f32 v31, v55, v31
    v_cvt_pk_bf16_f32 v72, v24, v25
    v_cvt_pk_bf16_f32 v73, v26, v27
    v_cvt_pk_bf16_f32 v74, v28, v29
    v_cvt_pk_bf16_f32 v75, v30, v31
    v_mul_f32 v32, v48, v32
    v_mul_f32 v33, v49, v33
    v_mul_f32 v34, v50, v34
    v_mul_f32 v35, v51, v35
    v_mul_f32 v36, v52, v36
    v_mul_f32 v37, v53, v37
    v_mul_f32 v38, v54, v38
    v_mul_f32 v39, v55, v39
    v_cvt_pk_bf16_f32 v76, v32, v33
    v_cvt_pk_bf16_f32 v77, v34, v35
    v_cvt_pk_bf16_f32 v78, v36, v37
    v_cvt_pk_bf16_f32 v79, v38, v39
    s_lshr_b32 s65, s30, 27
    s_mov_b32 s66, 161536
    s_cmp_ge_u32 s65, 2
    s_cselect_b32 s66, 158112, s66
    s_mul_i32 s65, s65, 512
    s_add_u32 s65, s65, s66
    s_sub_u32 s65, s65, s29
    v_add_u32 v56, s65, v249
    s_lshr_b32 s65, s30, 27
    s_mov_b32 s66, 161536
    s_cmp_ge_u32 s65, 2
    s_cselect_b32 s66, 159008, s66
    s_mul_i32 s65, s65, 64
    s_add_u32 s65, s65, s66
    s_sub_u32 s65, s65, s29
    v_add_u32 v57, s65, v250
    ds_read_b64_tr_b16 v[20:21], v56 offset:0
    ds_read_b64_tr_b16 v[22:23], v56 offset:128
    ds_read_b128 v[24:27], v57 offset:0
    ds_read_b128 v[28:31], v57 offset:16
    ds_read_b128 v[32:35], v57 offset:384
    ds_read_b128 v[36:39], v57 offset:400
    s_waitcnt lgkmcnt(10)
    v_lshlrev_b32 v40, 16, v0
    v_and_b32 v41, 0xffff0000, v0
    v_lshlrev_b32 v42, 16, v1
    v_and_b32 v43, 0xffff0000, v1
    v_lshlrev_b32 v44, 16, v2
    v_and_b32 v45, 0xffff0000, v2
    v_lshlrev_b32 v46, 16, v3
    v_and_b32 v47, 0xffff0000, v3
    s_waitcnt lgkmcnt(8)
    v_mul_f32 v4, v40, v4
    v_mul_f32 v5, v41, v5
    v_mul_f32 v6, v42, v6
    v_mul_f32 v7, v43, v7
    v_mul_f32 v8, v44, v8
    v_mul_f32 v9, v45, v9
    v_mul_f32 v10, v46, v10
    v_mul_f32 v11, v47, v11
    v_cvt_pk_bf16_f32 v80, v4, v5
    v_cvt_pk_bf16_f32 v81, v6, v7
    v_cvt_pk_bf16_f32 v82, v8, v9
    v_cvt_pk_bf16_f32 v83, v10, v11
    s_waitcnt lgkmcnt(6)
    v_mul_f32 v12, v40, v12
    v_mul_f32 v13, v41, v13
    v_mul_f32 v14, v42, v14
    v_mul_f32 v15, v43, v15
    v_mul_f32 v16, v44, v16
    v_mul_f32 v17, v45, v17
    v_mul_f32 v18, v46, v18
    v_mul_f32 v19, v47, v19
    v_cvt_pk_bf16_f32 v84, v12, v13
    v_cvt_pk_bf16_f32 v85, v14, v15
    v_cvt_pk_bf16_f32 v86, v16, v17
    v_cvt_pk_bf16_f32 v87, v18, v19
    s_waitcnt lgkmcnt(4)
    v_lshlrev_b32 v48, 16, v20
    v_and_b32 v49, 0xffff0000, v20
    v_lshlrev_b32 v50, 16, v21
    v_and_b32 v51, 0xffff0000, v21
    v_lshlrev_b32 v52, 16, v22
    v_and_b32 v53, 0xffff0000, v22
    v_lshlrev_b32 v54, 16, v23
    v_and_b32 v55, 0xffff0000, v23
    s_waitcnt lgkmcnt(2)
    v_mul_f32 v24, v48, v24
    v_mul_f32 v25, v49, v25
    v_mul_f32 v26, v50, v26
    v_mul_f32 v27, v51, v27
    v_mul_f32 v28, v52, v28
    v_mul_f32 v29, v53, v29
    v_mul_f32 v30, v54, v30
    v_mul_f32 v31, v55, v31
    v_cvt_pk_bf16_f32 v88, v24, v25
    v_cvt_pk_bf16_f32 v89, v26, v27
    v_cvt_pk_bf16_f32 v90, v28, v29
    v_cvt_pk_bf16_f32 v91, v30, v31
    s_waitcnt lgkmcnt(0)
    v_mul_f32 v32, v48, v32
    v_mul_f32 v33, v49, v33
    v_mul_f32 v34, v50, v34
    v_mul_f32 v35, v51, v35
    v_mul_f32 v36, v52, v36
    v_mul_f32 v37, v53, v37
    v_mul_f32 v38, v54, v38
    v_mul_f32 v39, v55, v39
    v_cvt_pk_bf16_f32 v92, v32, v33
    v_cvt_pk_bf16_f32 v93, v34, v35
    v_cvt_pk_bf16_f32 v94, v36, v37
    v_cvt_pk_bf16_f32 v95, v38, v39
    s_waitcnt vmcnt(4)
    v_mfma_f32_32x32x16_bf16 v[0:15], v[64:67], v[176:179], 0
    ds_read_b64_tr_b16 v[184:185], v246 offset:2048
    ds_read_b64_tr_b16 v[186:187], v246 offset:2560
    ds_read_b64_tr_b16 v[188:189], v247 offset:2048
    ds_read_b64_tr_b16 v[190:191], v247 offset:2560
    s_mov_b32 m0, s68
    v_mfma_f32_32x32x16_bf16 v[16:31], v[68:71], v[176:179], 0
    buffer_load_dwordx4 v222, s[4:7], s41 offen lds
    buffer_load_dwordx4 v223, s[72:75], s41 offen offset:1024 lds
    v_permlane32_swap_b32 v242, v236
    v_permlane32_swap_b32 v243, v237
    v_mov_b32 v254, 163648
    v_mfma_f32_32x32x16_bf16 v[32:47], v[64:67], v[180:183], 0
    v_permlane32_swap_b32 v244, v238
    v_permlane32_swap_b32 v245, v239
    v_permlane32_swap_b32 v240, v241
    v_add_f32 v242, v242, v236
    v_mfma_f32_32x32x16_bf16 v[48:63], v[68:71], v[180:183], 0
    v_add_f32 v243, v243, v237
    v_add_f32 v244, v244, v238
    v_add_f32 v245, v245, v239
    v_add_f32 v240, -v240, -v241
    v_sub_u32 v241, v230, v231
    v_cvt_pk_bf16_f32 v242, v242, v243
    v_mov_b32 v255, 1
    v_lshl_add_u32 v233, v252, 1, s53
    s_mov_b64 exec, 1
    ds_add_rtn_u32 v232, v254, v255
    s_mov_b64 exec, -1
    ds_read_b32 v233, v233
    s_waitcnt vmcnt(4) lgkmcnt(2)
    v_mfma_f32_32x32x16_bf16 v[0:15], v[72:75], v[184:187], v[0:15]
    ds_read_b64_tr_b16 v[176:177], v246 offset:4096
    ds_read_b64_tr_b16 v[178:179], v246 offset:4608
    ds_read_b64_tr_b16 v[180:181], v247 offset:4096
    ds_read_b64_tr_b16 v[182:183], v247 offset:4608
    v_cvt_pk_bf16_f32 v244, v244, v245
    v_cvt_pk_bf16_f32 v240, v240, v240
    s_mov_b32 m0, s69
    v_mfma_f32_32x32x16_bf16 v[16:31], v[76:79], v[184:187], v[16:31]
    buffer_load_dwordx4 v224, s[4:7], s41 offen lds
    buffer_load_dwordx4 v225, s[72:75], s41 offen offset:1024 lds
    ds_write_b32 v230, v242 offset:768
    ds_write_b32 v230, v244 offset:1024
    ds_write_b16 v241, v240 offset:1280
    s_waitcnt lgkmcnt(7)
    v_readfirstlane_b32 s58, v232
    v_mfma_f32_32x32x16_bf16 v[32:47], v[72:75], v[188:191], v[32:47]
    s_cmp_lt_u32 s58, s22
    s_cbranch_scc0 K2_nul_91
    s_and_b32 s59, s58, 7
    s_lshr_b32 s60, s58, 3
K2_chk_93:
    v_readlane_b32 s61, v233, s59
    s_nop 0
    s_cmp_gt_u32 s61, s60
    s_cbranch_scc0 K2_spin_92
K2_back_94:
    v_mfma_f32_32x32x16_bf16 v[48:63], v[76:79], v[188:191], v[48:63]
    v_readlane_b32 s3, v253, s58
    s_lshl_b32 s44, s34, 7
    s_lshl_b32 s60, s58, 5
    s_and_b32 s48, s3, 0x3ffff
    s_bfe_u32 s33, s3, 0x30012
    s_sub_u32 s60, s60, s48
    s_waitcnt vmcnt(4) lgkmcnt(3)
    v_mfma_f32_32x32x16_bf16 v[0:15], v[80:83], v[176:179], v[0:15]
    ds_read_b64_tr_b16 v[184:185], v246 offset:6144
    ds_read_b64_tr_b16 v[186:187], v246 offset:6656
    ds_read_b64_tr_b16 v[188:189], v247 offset:6144
    ds_read_b64_tr_b16 v[190:191], v247 offset:6656
    s_and_b32 s60, s60, 0xff
    s_add_u32 s35, s60, s48
    s_mov_b32 m0, s70
    v_mfma_f32_32x32x16_bf16 v[16:31], v[84:87], v[176:179], v[16:31]
    buffer_load_dwordx4 v226, s[4:7], s41 offen lds
    buffer_load_dwordx4 v227, s[72:75], s41 offen offset:1024 lds
    s_mov_b32 s45, s44
    s_add_u32 s47, s44, 256
    s_add_u32 s49, s48, 32
    s_add_u32 s60, s48, 64
    v_mfma_f32_32x32x16_bf16 v[32:47], v[80:83], v[180:183], v[32:47]
    s_cmp_eq_u32 s33, 3
    s_cselect_b32 s46, s44, s47
    s_cselect_b32 s50, s60, s48
    s_cselect_b32 s51, s48, s49
    s_sub_u32 s60, s33, 2
    s_cmp_lt_u32 s60, 2
    s_cbranch_scc0 K2_rare_95
K2_back_96:
    v_mfma_f32_32x32x16_bf16 v[48:63], v[84:87], v[180:183], v[48:63]
    s_waitcnt vmcnt(4) lgkmcnt(0)
    v_mfma_f32_32x32x16_bf16 v[0:15], v[88:91], v[184:187], v[0:15]
    ds_read_b64_tr_b16 v[176:177], v246 offset:0
    ds_read_b64_tr_b16 v[178:179], v246 offset:512
    ds_read_b64_tr_b16 v[180:181], v247 offset:0
    ds_read_b64_tr_b16 v[182:183], v247 offset:512
    s_mov_b32 m0, s71
    v_mfma_f32_32x32x16_bf16 v[16:31], v[92:95], v[184:187], v[16:31]
    buffer_load_dwordx4 v228, s[4:7], s41 offen lds
    buffer_load_dwordx4 v229, s[72:75], s41 offen offset:1024 lds
    v_mfma_f32_32x32x16_bf16 v[32:47], v[88:91], v[188:191], v[32:47]
    s_nop 2
    v_mul_f32 v234, v0, v96
    v_mul_f32 v236, v8, v128
    v_fmac_f32 v234, v1, v97
    v_fmac_f32 v236, v9, v129
    v_fmac_f32 v234, v2, v98
    v_fmac_f32 v236, v10, v130
    v_fmac_f32 v234, v3, v99
    v_mfma_f32_32x32x16_bf16 v[48:63], v[92:95], v[188:191], v[48:63]
    s_setprio 0
    v_fmac_f32 v236, v11, v131
    v_fmac_f32 v234, v4, v100
    v_fmac_f32 v236, v12, v132
    v_fmac_f32 v234, v5, v101
    v_fmac_f32 v236, v13, v133
    v_fmac_f32 v234, v6, v102
    v_fmac_f32 v236, v14, v134
    v_fmac_f32 v234, v7, v103
    v_fmac_f32 v236, v15, v135
    v_mul_f32 v238, v16, v128
    v_mul_f32 v240, v24, v128
    v_fmac_f32 v238, v17, v129
    v_fmac_f32 v240, v25, v129
    v_fmac_f32 v238, v18, v130
    v_fmac_f32 v240, v26, v130
    v_fmac_f32 v238, v19, v131
    v_fmac_f32 v240, v27, v131
    v_fmac_f32 v238, v20, v132
    v_fmac_f32 v240, v28, v132
    v_fmac_f32 v238, v21, v133
    v_fmac_f32 v240, v29, v133
    v_fmac_f32 v238, v22, v134
    v_fmac_f32 v240, v30, v134
    v_fmac_f32 v238, v23, v135
    v_fmac_f32 v240, v31, v135
    v_mul_f32 v235, v32, v104
    v_mul_f32 v237, v40, v136
    v_fmac_f32 v235, v33, v105
    v_fmac_f32 v237, v41, v137
    v_fmac_f32 v235, v34, v106
    v_fmac_f32 v237, v42, v138
    v_fmac_f32 v235, v35, v107
    v_fmac_f32 v237, v43, v139
    v_fmac_f32 v235, v36, v108
    v_fmac_f32 v237, v44, v140
    v_fmac_f32 v235, v37, v109
    v_fmac_f32 v237, v45, v141
    v_fmac_f32 v235, v38, v110
    v_fmac_f32 v237, v46, v142
    v_fmac_f32 v235, v39, v111
    v_fmac_f32 v237, v47, v143
    v_mul_f32 v239, v48, v136
    v_mul_f32 v241, v56, v136
    s_setprio 1
    s_waitcnt vmcnt(4) lgkmcnt(0)
    v_mfma_f32_32x32x16_bf16 v[0:15], v[64:67], v[176:179], 0
    ds_read_b64_tr_b16 v[184:185], v246 offset:2048
    ds_read_b64_tr_b16 v[186:187], v246 offset:2560
    ds_read_b64_tr_b16 v[188:189], v247 offset:2048
    ds_read_b64_tr_b16 v[190:191], v247 offset:2560
    v_fmac_f32 v239, v49, v137
    v_fmac_f32 v241, v57, v137
    s_mov_b32 m0, s68
    v_mfma_f32_32x32x16_bf16 v[16:31], v[68:71], v[176:179], 0
    buffer_load_dwordx4 v222, s[4:7], s42 offen lds
    buffer_load_dwordx4 v223, s[72:75], s42 offen offset:1024 lds
    v_fmac_f32 v239, v50, v138
    v_fmac_f32 v241, v58, v138
    v_fmac_f32 v239, v51, v139
    v_fmac_f32 v241, v59, v139
    v_fmac_f32 v239, v52, v140
    v_mfma_f32_32x32x16_bf16 v[32:47], v[64:67], v[180:183], 0
    v_fmac_f32 v241, v60, v140
    v_fmac_f32 v239, v53, v141
    v_fmac_f32 v241, v61, v141
    v_fmac_f32 v239, v54, v142
    v_fmac_f32 v241, v62, v142
    v_fmac_f32 v239, v55, v143
    v_fmac_f32 v241, v63, v143
    v_mfma_f32_32x32x16_bf16 v[48:63], v[68:71], v[180:183], 0
    v_permlane32_swap_b32 v234, v236
    v_permlane32_swap_b32 v235, v237
    v_permlane32_swap_b32 v240, v238
    s_waitcnt vmcnt(4) lgkmcnt(0)
    v_mfma_f32_32x32x16_bf16 v[0:15], v[72:75], v[184:187], v[0:15]
    ds_read_b64_tr_b16 v[176:177], v246 offset:4096
    ds_read_b64_tr_b16 v[178:179], v246 offset:4608
    ds_read_b64_tr_b16 v[180:181], v247 offset:4096
    ds_read_b64_tr_b16 v[182:183], v247 offset:4608
    v_permlane32_swap_b32 v241, v239
    s_mov_b32 m0, s69
    v_mfma_f32_32x32x16_bf16 v[16:31], v[76:79], v[184:187], v[16:31]
    buffer_load_dwordx4 v224, s[4:7], s42 offen lds
    buffer_load_dwordx4 v225, s[72:75], s42 offen offset:1024 lds
    v_lshl_add_u32 v230, v252, 1, s31
    v_add_f32 v234, v234, v236
    v_add_f32 v235, v235, v237
    v_add_f32 v240, v240, v238
    v_add_f32 v241, v241, v239
    v_mfma_f32_32x32x16_bf16 v[32:47], v[72:75], v[188:191], v[32:47]
    v_cvt_pk_bf16_f32 v234, v234, v235
    v_cvt_pk_bf16_f32 v240, v240, v241
    ds_write_b32 v230, v234 offset:0
    ds_write_b32 v230, v240 offset:256
    v_mfma_f32_32x32x16_bf16 v[48:63], v[76:79], v[188:191], v[48:63]
    s_waitcnt vmcnt(4) lgkmcnt(2)
    v_mfma_f32_32x32x16_bf16 v[0:15], v[80:83], v[176:179], v[0:15]
    ds_read_b64_tr_b16 v[184:185], v246 offset:6144
    ds_read_b64_tr_b16 v[186:187], v246 offset:6656
    ds_read_b64_tr_b16 v[188:189], v247 offset:6144
    ds_read_b64_tr_b16 v[190:191], v247 offset:6656
    s_mov_b32 m0, s70
    v_mfma_f32_32x32x16_bf16 v[16:31], v[84:87], v[176:179], v[16:31]
    buffer_load_dwordx4 v226, s[4:7], s42 offen lds
    buffer_load_dwordx4 v227, s[72:75], s42 offen offset:1024 lds
    v_mfma_f32_32x32x16_bf16 v[32:47], v[80:83], v[180:183], v[32:47]
    v_mfma_f32_32x32x16_bf16 v[48:63], v[84:87], v[180:183], v[48:63]
    s_waitcnt vmcnt(4) lgkmcnt(0)
    v_mfma_f32_32x32x16_bf16 v[0:15], v[88:91], v[184:187], v[0:15]
    ds_read_b64_tr_b16 v[176:177], v246 offset:0
    ds_read_b64_tr_b16 v[178:179], v246 offset:512
    ds_read_b64_tr_b16 v[180:181], v247 offset:0
    ds_read_b64_tr_b16 v[182:183], v247 offset:512
    s_mov_b32 m0, s71
    v_mfma_f32_32x32x16_bf16 v[16:31], v[92:95], v[184:187], v[16:31]
    buffer_load_dwordx4 v228, s[4:7], s42 offen lds
    buffer_load_dwordx4 v229, s[72:75], s42 offen offset:1024 lds
    v_mfma_f32_32x32x16_bf16 v[32:47], v[88:91], v[188:191], v[32:47]
    s_nop 2
    v_mul_f32 v234, v0, v144
    v_mul_f32 v236, v8, v112
    v_fmac_f32 v234, v1, v145
    v_fmac_f32 v236, v9, v113
    v_fmac_f32 v234, v2, v146
    v_fmac_f32 v236, v10, v114
    v_fmac_f32 v234, v3, v147
    v_mfma_f32_32x32x16_bf16 v[48:63], v[92:95], v[188:191], v[48:63]
    s_setprio 0
    v_fmac_f32 v236, v11, v115
    v_fmac_f32 v234, v4, v148
    v_fmac_f32 v236, v12, v116
    v_fmac_f32 v234, v5, v149
    v_fmac_f32 v236, v13, v117
    v_fmac_f32 v234, v6, v150
    v_fmac_f32 v236, v14, v118
    v_fmac_f32 v234, v7, v151
    v_fmac_f32 v236, v15, v119
    v_mul_f32 v238, v16, v160
    v_mul_f32 v240, v24, v160
    v_fmac_f32 v238, v17, v161
    v_fmac_f32 v240, v25, v161
    v_fmac_f32 v238, v18, v162
    v_fmac_f32 v240, v26, v162
    v_fmac_f32 v238, v19, v163
    v_fmac_f32 v240, v27, v163
    v_fmac_f32 v238, v20, v164
    v_fmac_f32 v240, v28, v164
    v_fmac_f32 v238, v21, v165
    v_fmac_f32 v240, v29, v165
    v_fmac_f32 v238, v22, v166
    v_fmac_f32 v240, v30, v166
    v_fmac_f32 v238, v23, v167
    v_fmac_f32 v240, v31, v167
    v_mul_f32 v235, v32, v152
    v_mul_f32 v237, v40, v120
    v_fmac_f32 v235, v33, v153
    v_fmac_f32 v237, v41, v121
    v_fmac_f32 v235, v34, v154
    v_fmac_f32 v237, v42, v122
    v_fmac_f32 v235, v35, v155
    v_fmac_f32 v237, v43, v123
    v_fmac_f32 v235, v36, v156
    v_fmac_f32 v237, v44, v124
    v_fmac_f32 v235, v37, v157
    v_fmac_f32 v237, v45, v125
    v_fmac_f32 v235, v38, v158
    v_fmac_f32 v237, v46, v126
    v_fmac_f32 v235, v39, v159
    v_fmac_f32 v237, v47, v127
    v_mul_f32 v239, v48, v168
    v_mul_f32 v241, v56, v168
    s_setprio 1
    s_waitcnt vmcnt(4) lgkmcnt(0)
    v_mfma_f32_32x32x16_bf16 v[0:15], v[64:67], v[176:179], 0
    ds_read_b64_tr_b16 v[184:185], v246 offset:2048
    ds_read_b64_tr_b16 v[186:187], v246 offset:2560
    ds_read_b64_tr_b16 v[188:189], v247 offset:2048
    ds_read_b64_tr_b16 v[190:191], v247 offset:2560
    v_fmac_f32 v239, v49, v169
    v_fmac_f32 v241, v57, v169
    s_mov_b32 m0, s68
    v_mfma_f32_32x32x16_bf16 v[16:31], v[68:71], v[176:179], 0
    buffer_load_dwordx4 v222, s[4:7], s43 offen lds
    buffer_load_dwordx4 v223, s[72:75], s43 offen offset:1024 lds
    v_fmac_f32 v239, v50, v170
    v_fmac_f32 v241, v58, v170
    v_fmac_f32 v239, v51, v171
    v_fmac_f32 v241, v59, v171
    v_fmac_f32 v239, v52, v172
    v_mfma_f32_32x32x16_bf16 v[32:47], v[64:67], v[180:183], 0
    v_fmac_f32 v241, v60, v172
    v_fmac_f32 v239, v53, v173
    v_fmac_f32 v241, v61, v173
    v_fmac_f32 v239, v54, v174
    v_fmac_f32 v241, v62, v174
    v_fmac_f32 v239, v55, v175
    v_fmac_f32 v241, v63, v175
    v_mfma_f32_32x32x16_bf16 v[48:63], v[68:71], v[180:183], 0
    s_waitcnt vmcnt(4) lgkmcnt(0)
    v_mfma_f32_32x32x16_bf16 v[0:15], v[72:75], v[184:187], v[0:15]
    ds_read_b64_tr_b16 v[176:177], v246 offset:4096
    ds_read_b64_tr_b16 v[178:179], v246 offset:4608
    ds_read_b64_tr_b16 v[180:181], v247 offset:4096
    ds_read_b64_tr_b16 v[182:183], v247 offset:4608
    s_mov_b32 m0, s69
    v_mfma_f32_32x32x16_bf16 v[16:31], v[76:79], v[184:187], v[16:31]
    buffer_load_dwordx4 v224, s[4:7], s43 offen lds
    buffer_load_dwordx4 v225, s[72:75], s43 offen offset:1024 lds
    v_mfma_f32_32x32x16_bf16 v[32:47], v[72:75], v[188:191], v[32:47]
    v_mfma_f32_32x32x16_bf16 v[48:63], v[76:79], v[188:191], v[48:63]
    s_waitcnt vmcnt(4) lgkmcnt(0)
    v_mfma_f32_32x32x16_bf16 v[0:15], v[80:83], v[176:179], v[0:15]
    ds_read_b64_tr_b16 v[184:185], v246 offset:6144
    ds_read_b64_tr_b16 v[186:187], v246 offset:6656
    ds_read_b64_tr_b16 v[188:189], v247 offset:6144
    ds_read_b64_tr_b16 v[190:191], v247 offset:6656
    s_mov_b32 m0, s70
    v_mfma_f32_32x32x16_bf16 v[16:31], v[84:87], v[176:179], v[16:31]
    buffer_load_dwordx4 v226, s[4:7], s43 offen lds
    buffer_load_dwordx4 v227, s[72:75], s43 offen offset:1024 lds
    v_mfma_f32_32x32x16_bf16 v[32:47], v[80:83], v[180:183], v[32:47]
    v_add_u32 v222, s48, v251
    ds_read_b32 v222, v222
    v_mfma_f32_32x32x16_bf16 v[48:63], v[84:87], v[180:183], v[48:63]
    s_waitcnt vmcnt(4) lgkmcnt(1)
    v_mfma_f32_32x32x16_bf16 v[0:15], v[88:91], v[184:187], v[0:15]
    ds_read_b64_tr_b16 v[176:177], v246 offset:0
    ds_read_b64_tr_b16 v[178:179], v246 offset:512
    ds_read_b64_tr_b16 v[180:181], v247 offset:0
    ds_read_b64_tr_b16 v[182:183], v247 offset:512
    s_mov_b32 m0, s71
    v_mfma_f32_32x32x16_bf16 v[16:31], v[92:95], v[184:187], v[16:31]
    buffer_load_dwordx4 v228, s[4:7], s43 offen lds
    buffer_load_dwordx4 v229, s[72:75], s43 offen offset:1024 lds
    s_waitcnt lgkmcnt(4)
    v_mad_u32_u16 v223, v222, s39, v248 op_sel:[1,0,0,0]
    v_mad_u32_u16 v222, v222, s39, v248
    v_mfma_f32_32x32x16_bf16 v[32:47], v[88:91], v[188:191], v[32:47]
    v_add_u32 v224, s49, v251
    ds_read_b32 v224, v224
    v_mul_f32 v242, v0, v144
    v_fma_f32 v238, v8, v160, -v238
    v_fmac_f32 v242, v1, v145
    v_fmac_f32 v238, v9, v161
    v_fmac_f32 v242, v2, v146
    v_mfma_f32_32x32x16_bf16 v[48:63], v[92:95], v[188:191], v[48:63]
    s_setprio 0
    v_fmac_f32 v238, v10, v162
    v_fmac_f32 v242, v3, v147
    v_fmac_f32 v238, v11, v163
    v_fmac_f32 v242, v4, v148
    v_fmac_f32 v238, v12, v164
    v_fmac_f32 v242, v5, v149
    v_fmac_f32 v238, v13, v165
    v_fmac_f32 v242, v6, v150
    v_fmac_f32 v238, v14, v166
    v_fmac_f32 v242, v7, v151
    v_fmac_f32 v238, v15, v167
    v_fmac_f32 v236, v16, v112
    v_mul_f32 v244, v24, v160
    v_fmac_f32 v236, v17, v113
    v_fmac_f32 v244, v25, v161
    v_fmac_f32 v236, v18, v114
    v_fmac_f32 v244, v26, v162
    v_fmac_f32 v236, v19, v115
    v_fmac_f32 v244, v27, v163
    v_fmac_f32 v236, v20, v116
    v_fmac_f32 v244, v28, v164
    v_fmac_f32 v236, v21, v117
    v_fmac_f32 v244, v29, v165
    v_fmac_f32 v236, v22, v118
    v_fmac_f32 v244, v30, v166
    v_fmac_f32 v236, v23, v119
    v_fmac_f32 v244, v31, v167
    v_mul_f32 v243, v32, v152
    v_fma_f32 v239, v40, v168, -v239
    v_fmac_f32 v243, v33, v153
    v_fmac_f32 v239, v41, v169
    v_fmac_f32 v243, v34, v154
    v_fmac_f32 v239, v42, v170
    v_fmac_f32 v243, v35, v155
    v_fmac_f32 v239, v43, v171
    v_fmac_f32 v243, v36, v156
    v_fmac_f32 v239, v44, v172
    v_fmac_f32 v243, v37, v157
    v_fmac_f32 v239, v45, v173
    v_fmac_f32 v243, v38, v158
    v_fmac_f32 v239, v46, v174
    v_fmac_f32 v243, v39, v159
    v_fmac_f32 v239, v47, v175
    v_fmac_f32 v237, v48, v120
    v_mul_f32 v245, v56, v168
    v_fmac_f32 v237, v49, v121
    v_fmac_f32 v245, v57, v169
    v_fmac_f32 v237, v50, v122
    v_fmac_f32 v245, v58, v170
    v_fmac_f32 v237, v51, v123
    s_setprio 1
    s_waitcnt vmcnt(4) lgkmcnt(1)
    v_mfma_f32_32x32x16_bf16 v[0:15], v[64:67], v[176:179], 0
    ds_read_b64_tr_b16 v[184:185], v246 offset:2048
    ds_read_b64_tr_b16 v[186:187], v246 offset:2560
    ds_read_b64_tr_b16 v[188:189], v247 offset:2048
    ds_read_b64_tr_b16 v[190:191], v247 offset:2560
    v_fmac_f32 v245, v59, v171
    v_fmac_f32 v237, v52, v124
    s_mov_b32 m0, s68
    v_mfma_f32_32x32x16_bf16 v[16:31], v[68:71], v[176:179], 0
    buffer_load_dwordx4 v222, s[4:7], s44 offen lds
    buffer_load_dwordx4 v223, s[72:75], s44 offen offset:1024 lds
    s_waitcnt lgkmcnt(4)
    v_mad_u32_u16 v225, v224, s39, v248 op_sel:[1,0,0,0]
    v_mad_u32_u16 v224, v224, s39, v248
    v_fmac_f32 v245, v60, v172
    v_fmac_f32 v237, v53, v125
    v_mfma_f32_32x32x16_bf16 v[32:47], v[64:67], v[180:183], 0
    v_add_u32 v226, s50, v251
    ds_read_b32 v226, v226
    v_fmac_f32 v245, v61, v173
    v_fmac_f32 v237, v54, v126
    v_fmac_f32 v245, v62, v174
    v_fmac_f32 v237, v55, v127
    v_fmac_f32 v245, v63, v175
    v_mfma_f32_32x32x16_bf16 v[48:63], v[68:71], v[180:183], 0
    v_permlane32_swap_b32 v242, v234
    v_permlane32_swap_b32 v243, v235
    v_add_f32 v242, v242, v234
    v_add_f32 v243, v243, v235
    s_waitcnt vmcnt(4) lgkmcnt(1)
    v_mfma_f32_32x32x16_bf16 v[0:15], v[72:75], v[184:187], v[0:15]
    ds_read_b64_tr_b16 v[176:177], v246 offset:4096
    ds_read_b64_tr_b16 v[178:179], v246 offset:4608
    ds_read_b64_tr_b16 v[180:181], v247 offset:4096
    ds_read_b64_tr_b16 v[182:183], v247 offset:4608
    v_cvt_pk_bf16_f32 v242, v242, v243
    ds_write_b32 v230, v242 offset:512
    s_mov_b32 m0, s69
    v_mfma_f32_32x32x16_bf16 v[16:31], v[76:79], v[184:187], v[16:31]
    buffer_load_dwordx4 v224, s[4:7], s45 offen lds
    buffer_load_dwordx4 v225, s[72:75], s45 offen offset:1024 lds
    s_waitcnt lgkmcnt(5)
    v_mad_u32_u16 v227, v226, s39, v248 op_sel:[1,0,0,0]
    v_mad_u32_u16 v226, v226, s39, v248
    v_mfma_f32_32x32x16_bf16 v[32:47], v[72:75], v[188:191], v[32:47]
    v_add_u32 v228, s51, v251
    ds_read_b32 v228, v228
    v_mfma_f32_32x32x16_bf16 v[48:63], v[76:79], v[188:191], v[48:63]
    s_waitcnt vmcnt(4) lgkmcnt(2)
    v_mfma_f32_32x32x16_bf16 v[0:15], v[80:83], v[176:179], v[0:15]
    ds_read_b64_tr_b16 v[184:185], v246 offset:6144
    ds_read_b64_tr_b16 v[186:187], v246 offset:6656
    ds_read_b64_tr_b16 v[188:189], v247 offset:6144
    ds_read_b64_tr_b16 v[190:191], v247 offset:6656
    s_mov_b32 s32, s31
    s_mov_b32 s31, s35
    s_mov_b32 m0, s70
    v_mfma_f32_32x32x16_bf16 v[16:31], v[84:87], v[176:179], v[16:31]
    buffer_load_dwordx4 v226, s[4:7], s46 offen lds
    buffer_load_dwordx4 v227, s[72:75], s46 offen offset:1024 lds
    s_waitcnt lgkmcnt(4)
    v_mad_u32_u16 v229, v228, s39, v248 op_sel:[1,0,0,0]
    v_mad_u32_u16 v228, v228, s39, v248
    s_sub_u32 s26, s48, s29
    s_mov_b32 s29, s48
    v_mfma_f32_32x32x16_bf16 v[32:47], v[80:83], v[180:183], v[32:47]
    s_mov_b32 s30, s3
    s_cmp_lg_u32 s36, 0
    s_cselect_b32 s56, s33, 0
    v_mfma_f32_32x32x16_bf16 v[48:63], v[84:87], v[180:183], v[48:63]
    s_waitcnt vmcnt(4) lgkmcnt(0)
    v_mfma_f32_32x32x16_bf16 v[0:15], v[88:91], v[184:187], v[0:15]
    ds_read_b64_tr_b16 v[176:177], v246 offset:0
    ds_read_b64_tr_b16 v[178:179], v246 offset:512
    ds_read_b64_tr_b16 v[180:181], v247 offset:0
    ds_read_b64_tr_b16 v[182:183], v247 offset:512
    s_mov_b32 m0, s71
    v_mfma_f32_32x32x16_bf16 v[16:31], v[92:95], v[184:187], v[16:31]
    buffer_load_dwordx4 v228, s[4:7], s47 offen lds
    buffer_load_dwordx4 v229, s[72:75], s47 offen offset:1024 lds
    v_mfma_f32_32x32x16_bf16 v[32:47], v[88:91], v[188:191], v[32:47]
    s_nop 2
    v_mul_f32 v242, v0, v144
    v_fma_f32 v240, v8, v160, -v240
    v_fmac_f32 v242, v1, v145
    v_fmac_f32 v240, v9, v161
    v_fmac_f32 v242, v2, v146
    v_fmac_f32 v240, v10, v162
    v_fmac_f32 v242, v3, v147
    v_mfma_f32_32x32x16_bf16 v[48:63], v[92:95], v[188:191], v[48:63]
    s_setprio 0
    v_fmac_f32 v240, v11, v163
    v_fmac_f32 v242, v4, v148
    v_fmac_f32 v240, v12, v164
    v_fmac_f32 v242, v5, v149
    v_fmac_f32 v240, v13, v165
    v_fmac_f32 v242, v6, v150
    v_fmac_f32 v240, v14, v166
    v_fmac_f32 v242, v7, v151
    v_fmac_f32 v240, v15, v167
    v_add_u32 v249, s26, v249
    v_add_u32 v250, s26, v250
    v_fma_f32 v244, v16, v160, -v244
    v_fmac_f32 v236, v24, v112
    v_fmac_f32 v244, v17, v161
    v_fmac_f32 v236, v25, v113
    v_fmac_f32 v244, v18, v162
    v_fmac_f32 v236, v26, v114
    v_fmac_f32 v244, v19, v163
    v_fmac_f32 v236, v27, v115
    v_fmac_f32 v244, v20, v164
    v_fmac_f32 v236, v28, v116
    v_fmac_f32 v244, v21, v165
    v_fmac_f32 v236, v29, v117
    v_fmac_f32 v244, v22, v166
    v_fmac_f32 v236, v30, v118
    v_fmac_f32 v244, v23, v167
    v_fmac_f32 v236, v31, v119
    ds_read_b64_tr_b16 v[0:1], v249 offset:0
    ds_read_b64_tr_b16 v[2:3], v249 offset:128
    ds_read_b128 v[4:7], v250 offset:0
    ds_read_b128 v[8:11], v250 offset:16
    ds_read_b128 v[12:15], v250 offset:384
    ds_read_b128 v[16:19], v250 offset:400
    v_mul_f32 v243, v32, v152
    v_fma_f32 v241, v40, v168, -v241
    v_fmac_f32 v243, v33, v153
    v_fmac_f32 v241, v41, v169
    v_fmac_f32 v243, v34, v154
    v_fmac_f32 v241, v42, v170
    v_fmac_f32 v243, v35, v155
    v_fmac_f32 v241, v43, v171
    v_fmac_f32 v243, v36, v156
    v_fmac_f32 v241, v44, v172
    v_fmac_f32 v243, v37, v157
    v_fmac_f32 v241, v45, v173
    v_fmac_f32 v243, v38, v158
    v_fmac_f32 v241, v46, v174
    v_fmac_f32 v243, v39, v159
    v_fmac_f32 v241, v47, v175
    ds_read_b64_tr_b16 v[20:21], v249 offset:512
    ds_read_b64_tr_b16 v[22:23], v249 offset:640
    ds_read_b128 v[24:27], v250 offset:64
    ds_read_b128 v[28:31], v250 offset:80
    ds_read_b128 v[32:35], v250 offset:448
    ds_read_b128 v[36:39], v250 offset:464
    v_fma_f32 v245, v48, v168, -v245
    v_fmac_f32 v237, v56, v120
    v_fmac_f32 v245, v49, v169
    v_fmac_f32 v237, v57, v121
    v_fmac_f32 v245, v50, v170
    v_fmac_f32 v237, v58, v122
    v_fmac_f32 v245, v51, v171
    v_fmac_f32 v237, v59, v123
    v_fmac_f32 v245, v52, v172
    v_fmac_f32 v237, v60, v124
    v_fmac_f32 v245, v53, v173
    v_fmac_f32 v237, v61, v125
    v_fmac_f32 v245, v54, v174
    v_fmac_f32 v237, v62, v126
    v_fmac_f32 v245, v55, v175
    v_fmac_f32 v237, v63, v127
    s_cmp_eq_u32 s56, 2
    s_cbranch_scc1 K2_U21
    s_cmp_eq_u32 s56, 3
    s_cbranch_scc1 K2_U31
    s_branch K2_DSP1
K2_DSP0:
    s_cmp_eq_u32 s56, 1
    s_cbranch_scc1 K2_U10
    s_cmp_eq_u32 s56, 4
    s_cbranch_scc1 K2_U40
    s_branch K2_SWITCH
K2_DSP1:
    s_cmp_eq_u32 s56, 1
    s_cbranch_scc1 K2_U11
    s_cmp_eq_u32 s56, 4
    s_cbranch_scc1 K2_U41
    s_branch K2_TAIL
K2_SWITCH:
    v_permlane32_swap_b32 v242, v236
    v_permlane32_swap_b32 v243, v237
    v_permlane32_swap_b32 v244, v238
    v_permlane32_swap_b32 v245, v239
    v_permlane32_swap_b32 v240, v241
    v_add_f32 v242, v242, v236
    v_add_f32 v243, v243, v237
    v_add_f32 v244, v244, v238
    v_add_f32 v245, v245, v239
    v_add_f32 v240, -v240, -v241
    s_set_gpr_idx_on s32, gpr_idx(DST)
    s_nop 0
    v_cvt_pk_bf16_f32 v195, v242, v243
    v_cvt_pk_bf16_f32 v196, v244, v245
    v_cvt_pk_bf16_f32 v197, v240, v240
    s_set_gpr_idx_off
    s_cmp_eq_u32 s36, 0
    s_cbranch_scc1 K2_TAIL2
    v_lshlrev_b32 v254, 3, v252
    v_lshl_add_u32 v230, v252, 1, s35
    v_lshrrev_b32 v231, 6, v252
    v_mul_u32_u24 v231, 126, v231
    s_mov_b32 s58, 7131136
    buffer_load_dwordx4 v[96:99], v254, s[8:11], s58 offen offset:0 sc1
    buffer_load_dwordx4 v[100:103], v254, s[8:11], s58 offen offset:1024 sc1
    buffer_load_dwordx4 v[104:107], v254, s[8:11], s58 offen offset:2048 sc1
    buffer_load_dwordx4 v[108:111], v254, s[8:11], s58 offen offset:3072 sc1
    s_mov_b32 s58, 7135232
    buffer_load_dwordx4 v[112:115], v254, s[8:11], s58 offen offset:0 sc1
    buffer_load_dwordx4 v[116:119], v254, s[8:11], s58 offen offset:1024 sc1
    buffer_load_dwordx4 v[120:123], v254, s[8:11], s58 offen offset:2048 sc1
    buffer_load_dwordx4 v[124:127], v254, s[8:11], s58 offen offset:3072 sc1
    s_mov_b32 s58, 7139328
    buffer_load_dwordx4 v[128:131], v254, s[8:11], s58 offen offset:0 sc1
    buffer_load_dwordx4 v[132:135], v254, s[8:11], s58 offen offset:1024 sc1
    buffer_load_dwordx4 v[136:139], v254, s[8:11], s58 offen offset:2048 sc1
    buffer_load_dwordx4 v[140:143], v254, s[8:11], s58 offen offset:3072 sc1
    s_mov_b32 s58, 7143424
    buffer_load_dwordx4 v[144:147], v254, s[8:11], s58 offen offset:0 sc1
    buffer_load_dwordx4 v[148:151], v254, s[8:11], s58 offen offset:1024 sc1
    buffer_load_dwordx4 v[152:155], v254, s[8:11], s58 offen offset:2048 sc1
    buffer_load_dwordx4 v[156:159], v254, s[8:11], s58 offen offset:3072 sc1
    s_mov_b32 s58, 7147520
    buffer_load_dwordx4 v[160:163], v254, s[8:11], s58 offen offset:0 sc1
    buffer_load_dwordx4 v[164:167], v254, s[8:11], s58 offen offset:1024 sc1
    buffer_load_dwordx4 v[168:171], v254, s[8:11], s58 offen offset:2048 sc1
    buffer_load_dwordx4 v[172:175], v254, s[8:11], s58 offen offset:3072 sc1
    s_movk_i32 s40, 128
    s_movk_i32 s41, 384
    s_movk_i32 s42, 640
    s_movk_i32 s43, 896
    s_cmp_lg_u32 s33, 1
    s_cbranch_scc1 K2_SW2
    s_waitcnt vmcnt(0)
K2_SW2:
    s_mov_b32 s29, s48
    s_mov_b32 s32, s31
    s_mov_b32 s30, s3
    s_mov_b32 s31, s35
    s_cmp_eq_u32 s33, 2
    s_cbranch_scc1 K2_U21
    s_cmp_eq_u32 s33, 3
    s_cbranch_scc1 K2_U31
    s_cmp_eq_u32 s33, 1
    s_cbranch_scc1 K2_U11
    s_branch K2_U41
K2_WINDOW:
    s_mov_b32 s24, 0
    s_mov_b32 s25, 1
K2_LOAD:
    v_mbcnt_lo_u32_b32 v176, -1, 0
    v_mbcnt_hi_u32_b32 v176, -1, v176
    s_lshl_b32 s58, s20, 6
    v_add_u32 v177, s58, v176
    v_lshlrev_b32 v70, 4, v176
    s_mov_b32 s58, 7110656
    buffer_load_dwordx4 v[96:99], v70, s[8:11], s58 offen offset:0 sc1
    buffer_load_dwordx4 v[100:103], v70, s[8:11], s58 offen offset:1024 sc1
    buffer_load_dwordx4 v[104:107], v70, s[8:11], s58 offen offset:2048 sc1
    buffer_load_dwordx4 v[108:111], v70, s[8:11], s58 offen offset:3072 sc1
    s_mov_b32 s58, 7114752
    buffer_load_dwordx4 v[112:115], v70, s[8:11], s58 offen offset:0 sc1
    buffer_load_dwordx4 v[116:119], v70, s[8:11], s58 offen offset:1024 sc1
    buffer_load_dwordx4 v[120:123], v70, s[8:11], s58 offen offset:2048 sc1
    buffer_load_dwordx4 v[124:127], v70, s[8:11], s58 offen offset:3072 sc1
    s_mov_b32 s58, 7118848
    buffer_load_dwordx4 v[128:131], v70, s[8:11], s58 offen offset:0 sc1
    buffer_load_dwordx4 v[132:135], v70, s[8:11], s58 offen offset:1024 sc1
    buffer_load_dwordx4 v[136:139], v70, s[8:11], s58 offen offset:2048 sc1
    buffer_load_dwordx4 v[140:143], v70, s[8:11], s58 offen offset:3072 sc1
    s_mov_b32 s58, 7122944
    buffer_load_dwordx4 v[144:147], v70, s[8:11], s58 offen offset:0 sc1
    buffer_load_dwordx4 v[148:151], v70, s[8:11], s58 offen offset:1024 sc1
    buffer_load_dwordx4 v[152:155], v70, s[8:11], s58 offen offset:2048 sc1
    buffer_load_dwordx4 v[156:159], v70, s[8:11], s58 offen offset:3072 sc1
    s_mov_b32 s58, 7127040
    buffer_load_dwordx4 v[160:163], v70, s[8:11], s58 offen offset:0 sc1
    buffer_load_dwordx4 v[164:167], v70, s[8:11], s58 offen offset:1024 sc1
    buffer_load_dwordx4 v[168:171], v70, s[8:11], s58 offen offset:2048 sc1
    buffer_load_dwordx4 v[172:175], v70, s[8:11], s58 offen offset:3072 sc1
    v_mul_u32_u24 v76, 437, v177
    v_lshrrev_b32 v76, 16, v76
    v_mul_u32_u24 v76, 150, v76
    v_sub_u32 v76, v177, v76
    v_mov_b32 v80, -1
    v_mov_b32 v77, 1.0
    v_cmp_gt_u32 vcc, 48, v76
    v_lshlrev_b32 v78, 4, v177
    v_add_u32 v78, 65536, v78
    v_cndmask_b32 v80, v80, 0, vcc
    v_cmp_gt_u32 vcc, 12, v76
    v_add_u32 v79, 64800, v78
    s_nop 0
    v_cndmask_b32 v80, v80, v77, vcc
    v_cmp_gt_u32 vcc, 450, v177
    v_mov_b32 v81, v80
    v_mov_b32 v82, v80
    v_mov_b32 v83, v80
    s_mov_b64 exec, vcc
    ds_write_b128 v78, v[80:83] offset:0
    ds_write_b128 v78, v[80:83] offset:7200
    ds_write_b128 v78, v[80:83] offset:14400
    ds_write_b128 v78, v[80:83] offset:21600
    ds_write_b128 v78, v[80:83] offset:28800
    ds_write_b128 v78, v[80:83] offset:36000
    ds_write_b128 v78, v[80:83] offset:43200
    ds_write_b128 v78, v[80:83] offset:50400
    ds_write_b128 v78, v[80:83] offset:57600
    ds_write_b128 v79, v[80:83] offset:0
    ds_write_b128 v79, v[80:83] offset:7200
    ds_write_b128 v79, v[80:83] offset:14400
    ds_write_b128 v79, v[80:83] offset:21600
    v_cmp_gt_u32 vcc, 268, v177
    s_nop 0
    s_cbranch_vccz K2_NOCL
    s_mov_b64 exec, vcc
    ds_write_b128 v79, v[80:83] offset:28800
K2_NOCL:
    s_mov_b64 exec, -1
    s_cmp_lg_u32 s20, 7
    s_cbranch_scc1 K2_NOH
    v_mov_b32 v76, 0
    v_mov_b32 v77, -1
    v_lshlrev_b32 v78, 2, v176
    v_add_u32 v78, 163424, v78
    s_mov_b64 exec, 0x1ff
    ds_write_b32 v78, v76 offset:192
    s_mov_b64 exec, 0xff
    ds_write_b32 v78, v77 offset:256
    s_mov_b64 exec, -1
    s_cmp_lg_u32 s24, 0
    s_cbranch_scc1 K2_NOH
    s_mov_b32 exec_hi, 0xffff
    ds_write_b32 v78, v76
    s_mov_b64 exec, 1
    ds_write_b32 v78, v76 offset:228
    s_mov_b64 exec, -1
K2_NOH:
    s_waitcnt lgkmcnt(0)
    s_barrier
    s_branch K2_CELLS
K2_FLGCK:
    s_cmp_eq_u32 s28, 0
    s_cbranch_scc1 K2_FLGOK
K2_FLGW:
    v_xor_b32 v84, s2, v84
    v_xor_b32 v85, s2, v85
    v_xor_b32 v86, s2, v86
    v_xor_b32 v87, s2, v87
    v_or3_b32 v84, v84, v85, v86
    v_or_b32 v84, v84, v87
    v_cmp_ne_u32 vcc, 0, v84
    s_nop 0
    s_and_b32 vcc_hi, vcc_hi, 0x3ffff
    s_cmp_eq_u64 vcc, 0
    s_cbranch_scc1 K2_FLGOK
    s_sub_u32 s60, s60, 1
    s_cbranch_scc1 K2_END
    buffer_load_dwordx4 v[84:87], v72, s[8:11], s67 offen sc1
    s_waitcnt vmcnt(0)
    s_branch K2_FLGW
K2_RT0:
    s_sub_u32 s60, s60, 1
    s_cbranch_scc1 K2_END
    buffer_load_dwordx4 v[0:3], v181, s[8:11], 0 offen offset:0 sc1
    s_waitcnt vmcnt(0)
    s_branch K2_CK0
K2_RT1:
    s_sub_u32 s60, s60, 1
    s_cbranch_scc1 K2_END
    buffer_load_dwordx4 v[4:7], v181, s[8:11], 0 offen offset:32 sc1
    s_waitcnt vmcnt(0)
    s_branch K2_CK1
K2_RT2:
    s_sub_u32 s60, s60, 1
    s_cbranch_scc1 K2_END
    buffer_load_dwordx4 v[8:11], v181, s[8:11], 0 offen offset:64 sc1
    s_waitcnt vmcnt(0)
    s_branch K2_CK2
K2_RT3:
    s_sub_u32 s60, s60, 1
    s_cbranch_scc1 K2_END
    buffer_load_dwordx4 v[12:15], v181, s[8:11], 0 offen offset:96 sc1
    s_waitcnt vmcnt(0)
    s_branch K2_CK3
K2_RT4:
    s_sub_u32 s60, s60, 1
    s_cbranch_scc1 K2_END
    buffer_load_dwordx4 v[16:19], v181, s[8:11], 0 offen offset:128 sc1
    s_waitcnt vmcnt(0)
    s_branch K2_CK4
K2_RT5:
    s_sub_u32 s60, s60, 1
    s_cbranch_scc1 K2_END
    buffer_load_dwordx4 v[20:23], v181, s[8:11], 0 offen offset:160 sc1
    s_waitcnt vmcnt(0)
    s_branch K2_CK5
K2_RT6:
    s_sub_u32 s60, s60, 1
    s_cbranch_scc1 K2_END
    buffer_load_dwordx4 v[24:27], v181, s[8:11], 0 offen offset:192 sc1
    s_waitcnt vmcnt(0)
    s_branch K2_CK6
K2_RT7:
    s_sub_u32 s60, s60, 1
    s_cbranch_scc1 K2_END
    buffer_load_dwordx4 v[28:31], v181, s[8:11], 0 offen offset:224 sc1
    s_waitcnt vmcnt(0)
    s_branch K2_CK7
K2_RT8:
    s_sub_u32 s60, s60, 1
    s_cbranch_scc1 K2_END
    buffer_load_dwordx4 v[32:35], v181, s[8:11], 0 offen offset:256 sc1
    s_waitcnt vmcnt(0)
    s_branch K2_CK8
K2_RT9:
    s_sub_u32 s60, s60, 1
    s_cbranch_scc1 K2_END
    buffer_load_dwordx4 v[36:39], v181, s[8:11], 0 offen offset:288 sc1
    s_waitcnt vmcnt(0)
    s_branch K2_CK9
K2_RK_LOAD:
    s_waitcnt vmcnt(0)
    s_mov_b64 exec, s[40:41]
    s_cbranch_execz K2_RK_B
    v_lshrrev_b32 v50, 24, v3
    buffer_load_dword v40, v179, s[8:11], s66 offen offset:0
    v_mad_u32_u24 v50, v50, s58, v202
    v_and_b32 v3, 0xffffff, v3
    s_mov_b64 exec, s[42:43]
    s_cbranch_execz K2_RK_B
    v_lshrrev_b32 v51, 24, v7
    buffer_load_dword v41, v179, s[8:11], s66 offen offset:8
    v_mad_u32_u24 v51, v51, s58, v202
    v_and_b32 v7, 0xffffff, v7
    s_mov_b64 exec, s[44:45]
    s_cbranch_execz K2_RK_B
    v_lshrrev_b32 v52, 24, v11
    buffer_load_dword v42, v179, s[8:11], s66 offen offset:16
    v_mad_u32_u24 v52, v52, s58, v202
    v_and_b32 v11, 0xffffff, v11
    s_mov_b64 exec, s[46:47]
    s_cbranch_execz K2_RK_B
    v_lshrrev_b32 v53, 24, v15
    buffer_load_dword v43, v179, s[8:11], s66 offen offset:24
    v_mad_u32_u24 v53, v53, s58, v202
    v_and_b32 v15, 0xffffff, v15
    s_mov_b64 exec, s[48:49]
    s_cbranch_execz K2_RK_B
    v_lshrrev_b32 v54, 24, v19
    buffer_load_dword v44, v179, s[8:11], s66 offen offset:32
    v_mad_u32_u24 v54, v54, s58, v202
    v_and_b32 v19, 0xffffff, v19
    s_mov_b64 exec, s[50:51]
    s_cbranch_execz K2_RK_B
    v_lshrrev_b32 v55, 24, v23
    buffer_load_dword v45, v179, s[8:11], s66 offen offset:40
    v_mad_u32_u24 v55, v55, s58, v202
    v_and_b32 v23, 0xffffff, v23
    s_mov_b64 exec, s[90:91]
    s_cbranch_execz K2_RK_B
    v_lshrrev_b32 v56, 24, v27
    buffer_load_dword v46, v179, s[8:11], s66 offen offset:48
    v_mad_u32_u24 v56, v56, s58, v202
    v_and_b32 v27, 0xffffff, v27
    s_mov_b64 exec, s[92:93]
    s_cbranch_execz K2_RK_B
    v_lshrrev_b32 v57, 24, v31
    buffer_load_dword v47, v179, s[8:11], s66 offen offset:56
    v_mad_u32_u24 v57, v57, s58, v202
    v_and_b32 v31, 0xffffff, v31
    s_mov_b64 exec, s[94:95]
    s_cbranch_execz K2_RK_B
    v_lshrrev_b32 v58, 24, v35
    buffer_load_dword v48, v179, s[8:11], s66 offen offset:64
    v_mad_u32_u24 v58, v58, s58, v202
    v_and_b32 v35, 0xffffff, v35
    s_mov_b64 exec, s[96:97]
    s_cbranch_execz K2_RK_B
    v_lshrrev_b32 v59, 24, v39
    buffer_load_dword v49, v179, s[8:11], s66 offen offset:72
    v_mad_u32_u24 v59, v59, s58, v202
    v_and_b32 v39, 0xffffff, v39
K2_RK_B:
    s_mov_b64 exec, -1
    s_mul_i32 s62, s24, 48
    s_waitcnt vmcnt(0)
    v_subrev_u32 v40, s62, v40
    v_subrev_u32 v41, s62, v41
    v_subrev_u32 v42, s62, v42
    v_subrev_u32 v43, s62, v43
    v_subrev_u32 v44, s62, v44
    v_subrev_u32 v45, s62, v45
    v_subrev_u32 v46, s62, v46
    v_subrev_u32 v47, s62, v47
    v_subrev_u32 v48, s62, v48
    v_subrev_u32 v49, s62, v49
    s_branch K2_RK_DONE
K2_BIG:
    s_cmp_lg_u32 s24, 0
    s_cbranch_scc1 K2_TOK
    s_mov_b64 s[62:63], vcc
    s_bcnt1_i32_b64 s60, vcc
    s_cmp_eq_u32 s22, 39
    s_cselect_b32 s61, 5, 2
    s_cmp_gt_u32 s60, s61
    s_cbranch_scc1 K2_SLOW
    v_cmp_lt_u32 vcc, 64, v193
    s_nop 0
    s_cbranch_vccnz K2_SLOW
    v_mbcnt_lo_u32_b32 v197, s62, 0
    v_mbcnt_hi_u32_b32 v197, s63, v197
    v_lshlrev_b32 v198, 27, v197
    v_cndmask_b32 v198, 0, v198, s[62:63]
    s_movk_i32 s26, 64
    v_cmp_le_u32 vcc, 2, v197
    v_mov_b32 v194, 161536
    v_mov_b32 v196, -8229472
    v_cndmask_b32 v194, v194, v196, vcc
    v_lshl_add_u32 v197, v197, 22, v194
    v_mov_b32 v203, v193
    v_mov_b32 v204, v195
    v_mov_b32 v205, v197
    s_mov_b32 s60, 6991
    v_cmp_lt_i32 vcc, 0, v180
    s_nop 0
    s_cbranch_vccz K2_OV_DONE
    v_subrev_u32 v192, 65536, v50
    v_mul_hi_u32_u24 v193, s60, v192
    v_mul_u32_u24 v192, s60, v192
    v_alignbit_b32 v192, v193, v192, 24
    v_lshlrev_b32 v192, 2, v192
    ds_bpermute_b32 v199, v192, v205
    v_subrev_u32 v192, 48, v40
    v_cmp_gt_u32 s[62:63], 16, v192
    s_waitcnt lgkmcnt(0)
    s_and_b64 exec, vcc, s[62:63]
    s_cbranch_execz K2_ov_1
    v_lshrrev_b32 v193, 18, v199
    v_add_u32 v192, v192, v193
    v_and_b32 v199, 0x3ffff, v199
    v_lshl_add_u32 v194, v192, 5, v199
    v_lshl_add_u32 v195, v192, 2, v199
    v_lshrrev_b32 v193, 3, v192
    v_mad_i32_i24 v196, v193, -16, v195
    v_and_b32 v193, 1, v193
    v_mad_i32_i24 v196, v193, -14, v196
    ds_write_b32 v194, v3 offset:864
    ds_write_b16 v195, v0 offset:194
    ds_write_b16_d16_hi v195, v0 offset:386
    ds_write_b16_d16_hi v195, v1 offset:578
    ds_write_b16 v196, v2 offset:768
K2_ov_1:
    s_mov_b64 exec, -1
    v_cmp_lt_i32 vcc, 2, v180
    s_nop 0
    s_cbranch_vccz K2_OV_DONE
    v_subrev_u32 v192, 65536, v51
    v_mul_hi_u32_u24 v193, s60, v192
    v_mul_u32_u24 v192, s60, v192
    v_alignbit_b32 v192, v193, v192, 24
    v_lshlrev_b32 v192, 2, v192
    ds_bpermute_b32 v199, v192, v205
    v_subrev_u32 v192, 48, v41
    v_cmp_gt_u32 s[62:63], 16, v192
    s_waitcnt lgkmcnt(0)
    s_and_b64 exec, vcc, s[62:63]
    s_cbranch_execz K2_ov_2
    v_lshrrev_b32 v193, 18, v199
    v_add_u32 v192, v192, v193
    v_and_b32 v199, 0x3ffff, v199
    v_lshl_add_u32 v194, v192, 5, v199
    v_lshl_add_u32 v195, v192, 2, v199
    v_lshrrev_b32 v193, 3, v192
    v_mad_i32_i24 v196, v193, -16, v195
    v_and_b32 v193, 1, v193
    v_mad_i32_i24 v196, v193, -14, v196
    ds_write_b32 v194, v7 offset:864
    ds_write_b16 v195, v4 offset:194
    ds_write_b16_d16_hi v195, v4 offset:386
    ds_write_b16_d16_hi v195, v5 offset:578
    ds_write_b16 v196, v6 offset:768
K2_ov_2:
    s_mov_b64 exec, -1
    v_cmp_lt_i32 vcc, 4, v180
    s_nop 0
    s_cbranch_vccz K2_OV_DONE
    v_subrev_u32 v192, 65536, v52
    v_mul_hi_u32_u24 v193, s60, v192
    v_mul_u32_u24 v192, s60, v192
    v_alignbit_b32 v192, v193, v192, 24
    v_lshlrev_b32 v192, 2, v192
    ds_bpermute_b32 v199, v192, v205
    v_subrev_u32 v192, 48, v42
    v_cmp_gt_u32 s[62:63], 16, v192
    s_waitcnt lgkmcnt(0)
    s_and_b64 exec, vcc, s[62:63]
    s_cbranch_execz K2_ov_3
    v_lshrrev_b32 v193, 18, v199
    v_add_u32 v192, v192, v193
    v_and_b32 v199, 0x3ffff, v199
    v_lshl_add_u32 v194, v192, 5, v199
    v_lshl_add_u32 v195, v192, 2, v199
    v_lshrrev_b32 v193, 3, v192
    v_mad_i32_i24 v196, v193, -16, v195
    v_and_b32 v193, 1, v193
    v_mad_i32_i24 v196, v193, -14, v196
    ds_write_b32 v194, v11 offset:864
    ds_write_b16 v195, v8 offset:194
    ds_write_b16_d16_hi v195, v8 offset:386
    ds_write_b16_d16_hi v195, v9 offset:578
    ds_write_b16 v196, v10 offset:768
K2_ov_3:
    s_mov_b64 exec, -1
    v_cmp_lt_i32 vcc, 6, v180
    s_nop 0
    s_cbranch_vccz K2_OV_DONE
    v_subrev_u32 v192, 65536, v53
    v_mul_hi_u32_u24 v193, s60, v192
    v_mul_u32_u24 v192, s60, v192
    v_alignbit_b32 v192, v193, v192, 24
    v_lshlrev_b32 v192, 2, v192
    ds_bpermute_b32 v199, v192, v205
    v_subrev_u32 v192, 48, v43
    v_cmp_gt_u32 s[62:63], 16, v192
    s_waitcnt lgkmcnt(0)
    s_and_b64 exec, vcc, s[62:63]
    s_cbranch_execz K2_ov_4
    v_lshrrev_b32 v193, 18, v199
    v_add_u32 v192, v192, v193
    v_and_b32 v199, 0x3ffff, v199
    v_lshl_add_u32 v194, v192, 5, v199
    v_lshl_add_u32 v195, v192, 2, v199
    v_lshrrev_b32 v193, 3, v192
    v_mad_i32_i24 v196, v193, -16, v195
    v_and_b32 v193, 1, v193
    v_mad_i32_i24 v196, v193, -14, v196
    ds_write_b32 v194, v15 offset:864
    ds_write_b16 v195, v12 offset:194
    ds_write_b16_d16_hi v195, v12 offset:386
    ds_write_b16_d16_hi v195, v13 offset:578
    ds_write_b16 v196, v14 offset:768
K2_ov_4:
    s_mov_b64 exec, -1
    v_cmp_lt_i32 vcc, 8, v180
    s_nop 0
    s_cbranch_vccz K2_OV_DONE
    v_subrev_u32 v192, 65536, v54
    v_mul_hi_u32_u24 v193, s60, v192
    v_mul_u32_u24 v192, s60, v192
    v_alignbit_b32 v192, v193, v192, 24
    v_lshlrev_b32 v192, 2, v192
    ds_bpermute_b32 v199, v192, v205
    v_subrev_u32 v192, 48, v44
    v_cmp_gt_u32 s[62:63], 16, v192
    s_waitcnt lgkmcnt(0)
    s_and_b64 exec, vcc, s[62:63]
    s_cbranch_execz K2_ov_5
    v_lshrrev_b32 v193, 18, v199
    v_add_u32 v192, v192, v193
    v_and_b32 v199, 0x3ffff, v199
    v_lshl_add_u32 v194, v192, 5, v199
    v_lshl_add_u32 v195, v192, 2, v199
    v_lshrrev_b32 v193, 3, v192
    v_mad_i32_i24 v196, v193, -16, v195
    v_and_b32 v193, 1, v193
    v_mad_i32_i24 v196, v193, -14, v196
    ds_write_b32 v194, v19 offset:864
    ds_write_b16 v195, v16 offset:194
    ds_write_b16_d16_hi v195, v16 offset:386
    ds_write_b16_d16_hi v195, v17 offset:578
    ds_write_b16 v196, v18 offset:768
K2_ov_5:
    s_mov_b64 exec, -1
    v_cmp_lt_i32 vcc, 10, v180
    s_nop 0
    s_cbranch_vccz K2_OV_DONE
    v_subrev_u32 v192, 65536, v55
    v_mul_hi_u32_u24 v193, s60, v192
    v_mul_u32_u24 v192, s60, v192
    v_alignbit_b32 v192, v193, v192, 24
    v_lshlrev_b32 v192, 2, v192
    ds_bpermute_b32 v199, v192, v205
    v_subrev_u32 v192, 48, v45
    v_cmp_gt_u32 s[62:63], 16, v192
    s_waitcnt lgkmcnt(0)
    s_and_b64 exec, vcc, s[62:63]
    s_cbranch_execz K2_ov_6
    v_lshrrev_b32 v193, 18, v199
    v_add_u32 v192, v192, v193
    v_and_b32 v199, 0x3ffff, v199
    v_lshl_add_u32 v194, v192, 5, v199
    v_lshl_add_u32 v195, v192, 2, v199
    v_lshrrev_b32 v193, 3, v192
    v_mad_i32_i24 v196, v193, -16, v195
    v_and_b32 v193, 1, v193
    v_mad_i32_i24 v196, v193, -14, v196
    ds_write_b32 v194, v23 offset:864
    ds_write_b16 v195, v20 offset:194
    ds_write_b16_d16_hi v195, v20 offset:386
    ds_write_b16_d16_hi v195, v21 offset:578
    ds_write_b16 v196, v22 offset:768
K2_ov_6:
    s_mov_b64 exec, -1
    v_cmp_lt_i32 vcc, 12, v180
    s_nop 0
    s_cbranch_vccz K2_OV_DONE
    v_subrev_u32 v192, 65536, v56
    v_mul_hi_u32_u24 v193, s60, v192
    v_mul_u32_u24 v192, s60, v192
    v_alignbit_b32 v192, v193, v192, 24
    v_lshlrev_b32 v192, 2, v192
    ds_bpermute_b32 v199, v192, v205
    v_subrev_u32 v192, 48, v46
    v_cmp_gt_u32 s[62:63], 16, v192
    s_waitcnt lgkmcnt(0)
    s_and_b64 exec, vcc, s[62:63]
    s_cbranch_execz K2_ov_7
    v_lshrrev_b32 v193, 18, v199
    v_add_u32 v192, v192, v193
    v_and_b32 v199, 0x3ffff, v199
    v_lshl_add_u32 v194, v192, 5, v199
    v_lshl_add_u32 v195, v192, 2, v199
    v_lshrrev_b32 v193, 3, v192
    v_mad_i32_i24 v196, v193, -16, v195
    v_and_b32 v193, 1, v193
    v_mad_i32_i24 v196, v193, -14, v196
    ds_write_b32 v194, v27 offset:864
    ds_write_b16 v195, v24 offset:194
    ds_write_b16_d16_hi v195, v24 offset:386
    ds_write_b16_d16_hi v195, v25 offset:578
    ds_write_b16 v196, v26 offset:768
K2_ov_7:
    s_mov_b64 exec, -1
    v_cmp_lt_i32 vcc, 14, v180
    s_nop 0
    s_cbranch_vccz K2_OV_DONE
    v_subrev_u32 v192, 65536, v57
    v_mul_hi_u32_u24 v193, s60, v192
    v_mul_u32_u24 v192, s60, v192
    v_alignbit_b32 v192, v193, v192, 24
    v_lshlrev_b32 v192, 2, v192
    ds_bpermute_b32 v199, v192, v205
    v_subrev_u32 v192, 48, v47
    v_cmp_gt_u32 s[62:63], 16, v192
    s_waitcnt lgkmcnt(0)
    s_and_b64 exec, vcc, s[62:63]
    s_cbranch_execz K2_ov_8
    v_lshrrev_b32 v193, 18, v199
    v_add_u32 v192, v192, v193
    v_and_b32 v199, 0x3ffff, v199
    v_lshl_add_u32 v194, v192, 5, v199
    v_lshl_add_u32 v195, v192, 2, v199
    v_lshrrev_b32 v193, 3, v192
    v_mad_i32_i24 v196, v193, -16, v195
    v_and_b32 v193, 1, v193
    v_mad_i32_i24 v196, v193, -14, v196
    ds_write_b32 v194, v31 offset:864
    ds_write_b16 v195, v28 offset:194
    ds_write_b16_d16_hi v195, v28 offset:386
    ds_write_b16_d16_hi v195, v29 offset:578
    ds_write_b16 v196, v30 offset:768
K2_ov_8:
    s_mov_b64 exec, -1
    v_cmp_lt_i32 vcc, 16, v180
    s_nop 0
    s_cbranch_vccz K2_OV_DONE
    v_subrev_u32 v192, 65536, v58
    v_mul_hi_u32_u24 v193, s60, v192
    v_mul_u32_u24 v192, s60, v192
    v_alignbit_b32 v192, v193, v192, 24
    v_lshlrev_b32 v192, 2, v192
    ds_bpermute_b32 v199, v192, v205
    v_subrev_u32 v192, 48, v48
    v_cmp_gt_u32 s[62:63], 16, v192
    s_waitcnt lgkmcnt(0)
    s_and_b64 exec, vcc, s[62:63]
    s_cbranch_execz K2_ov_9
    v_lshrrev_b32 v193, 18, v199
    v_add_u32 v192, v192, v193
    v_and_b32 v199, 0x3ffff, v199
    v_lshl_add_u32 v194, v192, 5, v199
    v_lshl_add_u32 v195, v192, 2, v199
    v_lshrrev_b32 v193, 3, v192
    v_mad_i32_i24 v196, v193, -16, v195
    v_and_b32 v193, 1, v193
    v_mad_i32_i24 v196, v193, -14, v196
    ds_write_b32 v194, v35 offset:864
    ds_write_b16 v195, v32 offset:194
    ds_write_b16_d16_hi v195, v32 offset:386
    ds_write_b16_d16_hi v195, v33 offset:578
    ds_write_b16 v196, v34 offset:768
K2_ov_9:
    s_mov_b64 exec, -1
    v_cmp_lt_i32 vcc, 18, v180
    s_nop 0
    s_cbranch_vccz K2_OV_DONE
    v_subrev_u32 v192, 65536, v59
    v_mul_hi_u32_u24 v193, s60, v192
    v_mul_u32_u24 v192, s60, v192
    v_alignbit_b32 v192, v193, v192, 24
    v_lshlrev_b32 v192, 2, v192
    ds_bpermute_b32 v199, v192, v205
    v_subrev_u32 v192, 48, v49
    v_cmp_gt_u32 s[62:63], 16, v192
    s_waitcnt lgkmcnt(0)
    s_and_b64 exec, vcc, s[62:63]
    s_cbranch_execz K2_ov_10
    v_lshrrev_b32 v193, 18, v199
    v_add_u32 v192, v192, v193
    v_and_b32 v199, 0x3ffff, v199
    v_lshl_add_u32 v194, v192, 5, v199
    v_lshl_add_u32 v195, v192, 2, v199
    v_lshrrev_b32 v193, 3, v192
    v_mad_i32_i24 v196, v193, -16, v195
    v_and_b32 v193, 1, v193
    v_mad_i32_i24 v196, v193, -14, v196
    ds_write_b32 v194, v39 offset:864
    ds_write_b16 v195, v36 offset:194
    ds_write_b16_d16_hi v195, v36 offset:386
    ds_write_b16_d16_hi v195, v37 offset:578
    ds_write_b16 v196, v38 offset:768
K2_ov_10:
    s_mov_b64 exec, -1
K2_OV_DONE:
    v_mov_b32 v193, v203
    v_mov_b32 v195, v204
    s_waitcnt lgkmcnt(0)
    s_barrier
    s_branch K2_TOK
K2_SLOW:
    v_mov_b32 v197, v193
    s_nop 1
    v_max_u32_dpp v197, v197, v197 row_shr:1 row_mask:0xf bank_mask:0xf bound_ctrl:0
    s_nop 1
    v_max_u32_dpp v197, v197, v197 row_shr:2 row_mask:0xf bank_mask:0xf bound_ctrl:0
    s_nop 1
    v_max_u32_dpp v197, v197, v197 row_shr:4 row_mask:0xf bank_mask:0xf bound_ctrl:0
    s_nop 1
    v_max_u32_dpp v197, v197, v197 row_shr:8 row_mask:0xf bank_mask:0xf bound_ctrl:0
    s_nop 1
    v_max_u32_dpp v197, v197, v197 row_bcast:15 row_mask:0xa bank_mask:0xf
    s_nop 1
    v_max_u32_dpp v197, v197, v197 row_bcast:31 row_mask:0xc bank_mask:0xf
    s_nop 0
    v_readlane_b32 s25, v197, 63
    s_nop 0
    s_add_u32 s25, s25, 47
    s_mul_i32 s25, s25, 43691
    s_lshr_b32 s25, s25, 21
    v_cmp_lt_i32 vcc, 0, v180
    s_nop 0
    s_cbranch_vccz K2_SV_DONE
    s_mov_b64 exec, vcc
    buffer_store_dword v40, v179, s[8:11], s66 offen offset:0
    v_cmp_lt_i32 vcc, 2, v180
    s_nop 0
    s_cbranch_vccz K2_SV_DONE
    s_mov_b64 exec, vcc
    buffer_store_dword v41, v179, s[8:11], s66 offen offset:8
    v_cmp_lt_i32 vcc, 4, v180
    s_nop 0
    s_cbranch_vccz K2_SV_DONE
    s_mov_b64 exec, vcc
    buffer_store_dword v42, v179, s[8:11], s66 offen offset:16
    v_cmp_lt_i32 vcc, 6, v180
    s_nop 0
    s_cbranch_vccz K2_SV_DONE
    s_mov_b64 exec, vcc
    buffer_store_dword v43, v179, s[8:11], s66 offen offset:24
    v_cmp_lt_i32 vcc, 8, v180
    s_nop 0
    s_cbranch_vccz K2_SV_DONE
    s_mov_b64 exec, vcc
    buffer_store_dword v44, v179, s[8:11], s66 offen offset:32
    v_cmp_lt_i32 vcc, 10, v180
    s_nop 0
    s_cbranch_vccz K2_SV_DONE
    s_mov_b64 exec, vcc
    buffer_store_dword v45, v179, s[8:11], s66 offen offset:40
    v_cmp_lt_i32 vcc, 12, v180
    s_nop 0
    s_cbranch_vccz K2_SV_DONE
    s_mov_b64 exec, vcc
    buffer_store_dword v46, v179, s[8:11], s66 offen offset:48
    v_cmp_lt_i32 vcc, 14, v180
    s_nop 0
    s_cbranch_vccz K2_SV_DONE
    s_mov_b64 exec, vcc
    buffer_store_dword v47, v179, s[8:11], s66 offen offset:56
    v_cmp_lt_i32 vcc, 16, v180
    s_nop 0
    s_cbranch_vccz K2_SV_DONE
    s_mov_b64 exec, vcc
    buffer_store_dword v48, v179, s[8:11], s66 offen offset:64
    v_cmp_lt_i32 vcc, 18, v180
    s_nop 0
    s_cbranch_vccz K2_SV_DONE
    s_mov_b64 exec, vcc
    buffer_store_dword v49, v179, s[8:11], s66 offen offset:72
K2_SV_DONE:
    s_mov_b64 exec, -1
    s_branch K2_TOK
K2_rare_11:
    s_cmp_eq_u32 s33, 4
    s_cbranch_scc1 K2_four_13
    s_mov_b32 s49, s48
    s_mov_b32 s51, s48
    s_add_u32 s45, s44, 256
    s_add_u32 s46, s44, 512
    s_add_u32 s47, s44, 768
    s_branch K2_back_12
K2_four_13:
    s_add_u32 s50, s48, 64
    s_lshr_b32 s51, s3, 27
    s_mov_b32 s66, 161536
    s_cmp_ge_u32 s51, 2
    s_cselect_b32 s66, 159072, s66
    s_mul_i32 s51, s51, 32
    s_add_u32 s51, s51, s66
    s_mov_b32 s46, s44
    s_mov_b32 s47, s44
    s_branch K2_back_12
K2_dum_14:
    v_mov_b32 v232, -1
    s_mov_b32 m0, 163712
    s_mov_b64 exec, 1
    buffer_load_dwordx4 v232, s[16:19], 0 offen lds
    buffer_load_dwordx4 v232, s[16:19], 0 offen lds
    s_mov_b64 exec, -1
    s_branch K2_back_16
K2_a4_15:
    s_lshr_b32 s65, s3, 27
    s_mov_b32 s66, 161536
    s_cmp_ge_u32 s65, 2
    s_cselect_b32 s66, 158112, s66
    s_mul_i32 s65, s65, 512
    s_add_u32 s65, s65, s66
    v_add_u32 v232, s65, v230
    ds_read_b32 v232, v232
    s_add_u32 m0, s65, 864
    s_waitcnt lgkmcnt(0)
    v_or_b32 v232, v232, v231
    buffer_load_dwordx4 v232, s[16:19], 0 offen  lds
    s_branch K2_b4_17
K2_nul_20:
    s_mov_b32 s58, 63
    s_mov_b32 s36, 0
    s_branch K2_back_23
K2_spin_21:
    v_lshl_add_u32 v233, v252, 1, s53
    ds_read_b32 v233, v233
    s_waitcnt lgkmcnt(0)
    s_branch K2_chk_22
K2_dyn_18:
    v_mov_b32 v254, 163648
    v_mov_b32 v255, 1
    v_lshl_add_u32 v233, v252, 1, s53
    s_mov_b64 exec, 1
    ds_add_rtn_u32 v232, v254, v255
    s_mov_b64 exec, -1
    ds_read_b32 v233, v233
    s_waitcnt lgkmcnt(0)
    v_readfirstlane_b32 s58, v232
    s_nop 0
    s_cmp_lt_u32 s58, s22
    s_cbranch_scc0 K2_nul_20
    s_and_b32 s59, s58, 7
    s_lshr_b32 s60, s58, 3
K2_chk_22:
    v_readlane_b32 s61, v233, s59
    s_nop 0
    s_cmp_gt_u32 s61, s60
    s_cbranch_scc0 K2_spin_21
K2_back_23:
    s_mov_b32 s34, 1
    s_branch K2_back_19
K2_rare_24:
    s_cmp_eq_u32 s33, 4
    s_cbranch_scc1 K2_four_26
    s_mov_b32 s49, s48
    s_mov_b32 s51, s48
    s_add_u32 s45, s44, 256
    s_add_u32 s46, s44, 512
    s_add_u32 s47, s44, 768
    s_branch K2_back_25
K2_four_26:
    s_add_u32 s50, s48, 64
    s_lshr_b32 s51, s3, 27
    s_mov_b32 s66, 161536
    s_cmp_ge_u32 s51, 2
    s_cselect_b32 s66, 159072, s66
    s_mul_i32 s51, s51, 32
    s_add_u32 s51, s51, s66
    s_mov_b32 s46, s44
    s_mov_b32 s47, s44
    s_branch K2_back_25
K2_dum_27:
    v_mov_b32 v232, -1
    s_mov_b32 m0, 163712
    s_mov_b64 exec, 1
    buffer_load_dwordx4 v232, s[16:19], 0 offen lds
    buffer_load_dwordx4 v232, s[16:19], 0 offen lds
    s_mov_b64 exec, -1
    s_branch K2_back_29
K2_a4_28:
    s_lshr_b32 s65, s3, 27
    s_mov_b32 s66, 161536
    s_cmp_ge_u32 s65, 2
    s_cselect_b32 s66, 158112, s66
    s_mul_i32 s65, s65, 512
    s_add_u32 s65, s65, s66
    v_add_u32 v232, s65, v230
    ds_read_b32 v232, v232
    s_add_u32 m0, s65, 864
    s_waitcnt lgkmcnt(0)
    v_or_b32 v232, v232, v231
    buffer_load_dwordx4 v232, s[16:19], 0 offen  lds
    s_branch K2_b4_30
K2_nul_33:
    s_mov_b32 s58, 63
    s_mov_b32 s36, 0
    s_branch K2_back_36
K2_spin_34:
    v_lshl_add_u32 v233, v252, 1, s53
    ds_read_b32 v233, v233
    s_waitcnt lgkmcnt(0)
    s_branch K2_chk_35
K2_dyn_31:
    v_mov_b32 v254, 163648
    v_mov_b32 v255, 1
    v_lshl_add_u32 v233, v252, 1, s53
    s_mov_b64 exec, 1
    ds_add_rtn_u32 v232, v254, v255
    s_mov_b64 exec, -1
    ds_read_b32 v233, v233
    s_waitcnt lgkmcnt(0)
    v_readfirstlane_b32 s58, v232
    s_nop 0
    s_cmp_lt_u32 s58, s22
    s_cbranch_scc0 K2_nul_33
    s_and_b32 s59, s58, 7
    s_lshr_b32 s60, s58, 3
K2_chk_35:
    v_readlane_b32 s61, v233, s59
    s_nop 0
    s_cmp_gt_u32 s61, s60
    s_cbranch_scc0 K2_spin_34
K2_back_36:
    s_mov_b32 s34, 1
    s_branch K2_back_32
K2_rare_37:
    s_cmp_eq_u32 s33, 4
    s_cbranch_scc1 K2_four_39
    s_mov_b32 s49, s48
    s_mov_b32 s51, s48
    s_add_u32 s45, s44, 256
    s_add_u32 s46, s44, 512
    s_add_u32 s47, s44, 768
    s_branch K2_back_38
K2_four_39:
    s_add_u32 s50, s48, 64
    s_lshr_b32 s51, s3, 27
    s_mov_b32 s66, 161536
    s_cmp_ge_u32 s51, 2
    s_cselect_b32 s66, 159072, s66
    s_mul_i32 s51, s51, 32
    s_add_u32 s51, s51, s66
    s_mov_b32 s46, s44
    s_mov_b32 s47, s44
    s_branch K2_back_38
K2_dum_40:
    v_mov_b32 v232, -1
    s_mov_b32 m0, 163712
    s_mov_b64 exec, 1
    buffer_load_dwordx4 v232, s[16:19], 0 offen lds
    buffer_load_dwordx4 v232, s[16:19], 0 offen lds
    s_mov_b64 exec, -1
    s_branch K2_back_42
K2_a4_41:
    s_lshr_b32 s65, s3, 27
    s_mov_b32 s66, 161536
    s_cmp_ge_u32 s65, 2
    s_cselect_b32 s66, 158112, s66
    s_mul_i32 s65, s65, 512
    s_add_u32 s65, s65, s66
    v_add_u32 v232, s65, v230
    ds_read_b32 v232, v232
    s_add_u32 m0, s65, 864
    s_waitcnt lgkmcnt(0)
    v_or_b32 v232, v232, v231
    buffer_load_dwordx4 v232, s[16:19], 0 offen  lds
    s_branch K2_b4_43
K2_nul_44:
    s_mov_b32 s58, 63
    s_mov_b32 s36, 0
    s_branch K2_back_47
K2_spin_45:
    v_lshl_add_u32 v233, v252, 1, s53
    ds_read_b32 v233, v233
    s_waitcnt lgkmcnt(0)
    s_branch K2_chk_46
K2_rare_48:
    s_cmp_eq_u32 s33, 4
    s_cbranch_scc1 K2_four_50
    s_mov_b32 s49, s48
    s_mov_b32 s51, s48
    s_add_u32 s45, s44, 256
    s_add_u32 s46, s44, 512
    s_add_u32 s47, s44, 768
    s_branch K2_back_49
K2_four_50:
    s_add_u32 s50, s48, 64
    s_lshr_b32 s51, s3, 27
    s_mov_b32 s66, 161536
    s_cmp_ge_u32 s51, 2
    s_cselect_b32 s66, 159072, s66
    s_mul_i32 s51, s51, 32
    s_add_u32 s51, s51, s66
    s_mov_b32 s46, s44
    s_mov_b32 s47, s44
    s_branch K2_back_49
K2_nul_51:
    s_mov_b32 s58, 63
    s_mov_b32 s36, 0
    s_branch K2_back_54
K2_spin_52:
    v_lshl_add_u32 v233, v252, 1, s53
    ds_read_b32 v233, v233
    s_waitcnt lgkmcnt(0)
    s_branch K2_chk_53
K2_rare_55:
    s_cmp_eq_u32 s33, 4
    s_cbranch_scc1 K2_four_57
    s_mov_b32 s49, s48
    s_mov_b32 s51, s48
    s_add_u32 s45, s44, 256
    s_add_u32 s46, s44, 512
    s_add_u32 s47, s44, 768
    s_branch K2_back_56
K2_four_57:
    s_add_u32 s50, s48, 64
    s_lshr_b32 s51, s3, 27
    s_mov_b32 s66, 161536
    s_cmp_ge_u32 s51, 2
    s_cselect_b32 s66, 159072, s66
    s_mul_i32 s51, s51, 32
    s_add_u32 s51, s51, s66
    s_mov_b32 s46, s44
    s_mov_b32 s47, s44
    s_branch K2_back_56
K2_nul_60:
    s_mov_b32 s58, 63
    s_mov_b32 s36, 0
    s_branch K2_back_63
K2_spin_61:
    v_lshl_add_u32 v233, v252, 1, s53
    ds_read_b32 v233, v233
    s_waitcnt lgkmcnt(0)
    s_branch K2_chk_62
K2_dyn_58:
    v_mov_b32 v254, 163648
    v_mov_b32 v255, 1
    v_lshl_add_u32 v233, v252, 1, s53
    s_mov_b64 exec, 1
    ds_add_rtn_u32 v232, v254, v255
    s_mov_b64 exec, -1
    ds_read_b32 v233, v233
    s_waitcnt lgkmcnt(0)
    v_readfirstlane_b32 s58, v232
    s_nop 0
    s_cmp_lt_u32 s58, s22
    s_cbranch_scc0 K2_nul_60
    s_and_b32 s59, s58, 7
    s_lshr_b32 s60, s58, 3
K2_chk_62:
    v_readlane_b32 s61, v233, s59
    s_nop 0
    s_cmp_gt_u32 s61, s60
    s_cbranch_scc0 K2_spin_61
K2_back_63:
    s_mov_b32 s34, 1
    s_branch K2_back_59
K2_rare_64:
    s_cmp_eq_u32 s33, 4
    s_cbranch_scc1 K2_four_66
    s_mov_b32 s49, s48
    s_mov_b32 s51, s48
    s_add_u32 s45, s44, 256
    s_add_u32 s46, s44, 512
    s_add_u32 s47, s44, 768
    s_branch K2_back_65
K2_four_66:
    s_add_u32 s50, s48, 64
    s_lshr_b32 s51, s3, 27
    s_mov_b32 s66, 161536
    s_cmp_ge_u32 s51, 2
    s_cselect_b32 s66, 159072, s66
    s_mul_i32 s51, s51, 32
    s_add_u32 s51, s51, s66
    s_mov_b32 s46, s44
    s_mov_b32 s47, s44
    s_branch K2_back_65
K2_dum_67:
    v_mov_b32 v232, -1
    s_mov_b32 m0, 163712
    s_mov_b64 exec, 1
    buffer_load_dwordx4 v232, s[16:19], 0 offen lds
    buffer_load_dwordx4 v232, s[16:19], 0 offen lds
    s_mov_b64 exec, -1
    s_branch K2_back_69
K2_a4_68:
    s_lshr_b32 s65, s3, 27
    s_mov_b32 s66, 161536
    s_cmp_ge_u32 s65, 2
    s_cselect_b32 s66, 158112, s66
    s_mul_i32 s65, s65, 512
    s_add_u32 s65, s65, s66
    v_add_u32 v232, s65, v230
    ds_read_b32 v232, v232
    s_add_u32 m0, s65, 864
    s_waitcnt lgkmcnt(0)
    v_or_b32 v232, v232, v231
    buffer_load_dwordx4 v232, s[16:19], 0 offen  lds
    s_branch K2_b4_70
K2_nul_73:
    s_mov_b32 s58, 63
    s_mov_b32 s36, 0
    s_branch K2_back_76
K2_spin_74:
    v_lshl_add_u32 v233, v252, 1, s53
    ds_read_b32 v233, v233
    s_waitcnt lgkmcnt(0)
    s_branch K2_chk_75
K2_dyn_71:
    v_mov_b32 v254, 163648
    v_mov_b32 v255, 1
    v_lshl_add_u32 v233, v252, 1, s53
    s_mov_b64 exec, 1
    ds_add_rtn_u32 v232, v254, v255
    s_mov_b64 exec, -1
    ds_read_b32 v233, v233
    s_waitcnt lgkmcnt(0)
    v_readfirstlane_b32 s58, v232
    s_nop 0
    s_cmp_lt_u32 s58, s22
    s_cbranch_scc0 K2_nul_73
    s_and_b32 s59, s58, 7
    s_lshr_b32 s60, s58, 3
K2_chk_75:
    v_readlane_b32 s61, v233, s59
    s_nop 0
    s_cmp_gt_u32 s61, s60
    s_cbranch_scc0 K2_spin_74
K2_back_76:
    s_mov_b32 s34, 1
    s_branch K2_back_72
K2_rare_77:
    s_cmp_eq_u32 s33, 4
    s_cbranch_scc1 K2_four_79
    s_mov_b32 s49, s48
    s_mov_b32 s51, s48
    s_add_u32 s45, s44, 256
    s_add_u32 s46, s44, 512
    s_add_u32 s47, s44, 768
    s_branch K2_back_78
K2_four_79:
    s_add_u32 s50, s48, 64
    s_lshr_b32 s51, s3, 27
    s_mov_b32 s66, 161536
    s_cmp_ge_u32 s51, 2
    s_cselect_b32 s66, 159072, s66
    s_mul_i32 s51, s51, 32
    s_add_u32 s51, s51, s66
    s_mov_b32 s46, s44
    s_mov_b32 s47, s44
    s_branch K2_back_78
K2_dum_80:
    v_mov_b32 v232, -1
    s_mov_b32 m0, 163712
    s_mov_b64 exec, 1
    buffer_load_dwordx4 v232, s[16:19], 0 offen lds
    buffer_load_dwordx4 v232, s[16:19], 0 offen lds
    s_mov_b64 exec, -1
    s_branch K2_back_82
K2_a4_81:
    s_lshr_b32 s65, s3, 27
    s_mov_b32 s66, 161536
    s_cmp_ge_u32 s65, 2
    s_cselect_b32 s66, 158112, s66
    s_mul_i32 s65, s65, 512
    s_add_u32 s65, s65, s66
    v_add_u32 v232, s65, v230
    ds_read_b32 v232, v232
    s_add_u32 m0, s65, 864
    s_waitcnt lgkmcnt(0)
    v_or_b32 v232, v232, v231
    buffer_load_dwordx4 v232, s[16:19], 0 offen  lds
    s_branch K2_b4_83
K2_nul_84:
    s_mov_b32 s58, 63
    s_mov_b32 s36, 0
    s_branch K2_back_87
K2_spin_85:
    v_lshl_add_u32 v233, v252, 1, s53
    ds_read_b32 v233, v233
    s_waitcnt lgkmcnt(0)
    s_branch K2_chk_86
K2_rare_88:
    s_cmp_eq_u32 s33, 4
    s_cbranch_scc1 K2_four_90
    s_mov_b32 s49, s48
    s_mov_b32 s51, s48
    s_add_u32 s45, s44, 256
    s_add_u32 s46, s44, 512
    s_add_u32 s47, s44, 768
    s_branch K2_back_89
K2_four_90:
    s_add_u32 s50, s48, 64
    s_lshr_b32 s51, s3, 27
    s_mov_b32 s66, 161536
    s_cmp_ge_u32 s51, 2
    s_cselect_b32 s66, 159072, s66
    s_mul_i32 s51, s51, 32
    s_add_u32 s51, s51, s66
    s_mov_b32 s46, s44
    s_mov_b32 s47, s44
    s_branch K2_back_89
K2_nul_91:
    s_mov_b32 s58, 63
    s_mov_b32 s36, 0
    s_branch K2_back_94
K2_spin_92:
    v_lshl_add_u32 v233, v252, 1, s53
    ds_read_b32 v233, v233
    s_waitcnt lgkmcnt(0)
    s_branch K2_chk_93
K2_rare_95:
    s_cmp_eq_u32 s33, 4
    s_cbranch_scc1 K2_four_97
    s_mov_b32 s49, s48
    s_mov_b32 s51, s48
    s_add_u32 s45, s44, 256
    s_add_u32 s46, s44, 512
    s_add_u32 s47, s44, 768
    s_branch K2_back_96
K2_four_97:
    s_add_u32 s50, s48, 64
    s_lshr_b32 s51, s3, 27
    s_mov_b32 s66, 161536
    s_cmp_ge_u32 s51, 2
    s_cselect_b32 s66, 159072, s66
    s_mul_i32 s51, s51, 32
    s_add_u32 s51, s51, s66
    s_mov_b32 s46, s44
    s_mov_b32 s47, s44
    s_branch K2_back_96
K2_TAIL2:
    v_lshlrev_b32 v229, 3, v252
    s_mul_i32 s58, s20, 20480
    s_add_u32 s58, s58, 6946816
    s_mul_i32 s59, s20, 8224
    buffer_load_dwordx4 v[96:99], v229, s[8:11], s58 offen offset:0 sc1
    buffer_load_dwordx4 v[100:103], v229, s[8:11], s58 offen offset:1024 sc1
    buffer_load_dwordx4 v[104:107], v229, s[8:11], s58 offen offset:2048 sc1
    buffer_load_dwordx4 v[108:111], v229, s[8:11], s58 offen offset:3072 sc1
    s_add_u32 s58, s58, 4096
    buffer_load_dwordx4 v[112:115], v229, s[8:11], s58 offen offset:0 sc1
    buffer_load_dwordx4 v[116:119], v229, s[8:11], s58 offen offset:1024 sc1
    buffer_load_dwordx4 v[120:123], v229, s[8:11], s58 offen offset:2048 sc1
    buffer_load_dwordx4 v[124:127], v229, s[8:11], s58 offen offset:3072 sc1
    s_add_u32 s58, s58, 4096
    v_lshl_add_u32 v228, v252, 1, s59
    v_lshrrev_b32 v226, 6, v252
    v_mul_u32_u24 v226, 126, v226
    v_sub_u32 v226, v228, v226
    s_branch K2_TAIL3
K2_TAIL:
    v_lshlrev_b32 v229, 3, v252
    s_mul_i32 s58, s20, 20480
    s_add_u32 s58, s58, 6946816
    s_mul_i32 s59, s20, 8224
    buffer_load_dwordx4 v[96:99], v229, s[8:11], s58 offen offset:0 sc1
    v_permlane32_swap_b32 v242, v236
    v_permlane32_swap_b32 v243, v237
    buffer_load_dwordx4 v[100:103], v229, s[8:11], s58 offen offset:1024 sc1
    v_permlane32_swap_b32 v244, v238
    v_permlane32_swap_b32 v245, v239
    buffer_load_dwordx4 v[104:107], v229, s[8:11], s58 offen offset:2048 sc1
    v_permlane32_swap_b32 v240, v241
    v_add_f32 v242, v242, v236
    buffer_load_dwordx4 v[108:111], v229, s[8:11], s58 offen offset:3072 sc1
    s_add_u32 s58, s58, 4096
    v_add_f32 v243, v243, v237
    v_add_f32 v244, v244, v238
    buffer_load_dwordx4 v[112:115], v229, s[8:11], s58 offen offset:0 sc1
    v_add_f32 v245, v245, v239
    v_add_f32 v240, -v240, -v241
    buffer_load_dwordx4 v[116:119], v229, s[8:11], s58 offen offset:1024 sc1
    v_sub_u32 v241, v230, v231
    v_cvt_pk_bf16_f32 v242, v242, v243
    buffer_load_dwordx4 v[120:123], v229, s[8:11], s58 offen offset:2048 sc1
    v_cvt_pk_bf16_f32 v244, v244, v245
    v_cvt_pk_bf16_f32 v240, v240, v240
    buffer_load_dwordx4 v[124:127], v229, s[8:11], s58 offen offset:3072 sc1
    s_add_u32 s58, s58, 4096
    ds_write_b32 v230, v242 offset:768
    ds_write_b32 v230, v244 offset:1024
    ds_write_b16 v241, v240 offset:1280
    v_lshl_add_u32 v228, v252, 1, s59
    v_lshrrev_b32 v226, 6, v252
    v_mul_u32_u24 v226, 126, v226
    v_sub_u32 v226, v228, v226
K2_TAIL3:
    s_waitcnt vmcnt(8)
    ds_write_b32 v228, v192 offset:0
    ds_write_b32 v228, v193 offset:256
    ds_write_b32 v228, v194 offset:512
    buffer_load_dwordx4 v[128:131], v229, s[8:11], s58 offen offset:0 sc1
    v_bfe_u32 v48, v252, 1, 4
    v_lshrrev_b32 v49, 5, v252
    ds_write_b32 v228, v195 offset:768
    ds_write_b32 v228, v196 offset:1024
    ds_write_b16 v226, v197 offset:1280
    buffer_load_dwordx4 v[132:135], v229, s[8:11], s58 offen offset:1024 sc1
    v_lshrrev_b32 v55, 3, v48
    v_lshlrev_b32 v52, 4, v49
    ds_write_b32 v228, v198 offset:1536
    ds_write_b32 v228, v199 offset:1792
    ds_write_b32 v228, v200 offset:2048
    buffer_load_dwordx4 v[136:139], v229, s[8:11], s58 offen offset:2048 sc1
    v_lshl_add_u32 v54, v55, 2, v48
    v_and_b32 v54, 7, v54
    ds_write_b32 v228, v201 offset:2304
    ds_write_b32 v228, v202 offset:2560
    ds_write_b16 v226, v203 offset:2816
    buffer_load_dwordx4 v[140:143], v229, s[8:11], s58 offen offset:3072 sc1
    s_add_u32 s58, s58, 4096
    v_and_b32 v50, 7, v48
    v_mul_u32_u24 v50, 8224, v50
    ds_write_b32 v228, v204 offset:3072
    ds_write_b32 v228, v205 offset:3328
    ds_write_b32 v228, v206 offset:3584
    buffer_load_dwordx4 v[144:147], v229, s[8:11], s58 offen offset:0 sc1
    v_mul_u32_u24 v51, 1536, v55
    v_add_u32 v50, v50, v51
    ds_write_b32 v228, v207 offset:3840
    ds_write_b32 v228, v208 offset:4096
    ds_write_b16 v226, v209 offset:4352
    buffer_load_dwordx4 v[148:151], v229, s[8:11], s58 offen offset:1024 sc1
    v_add_u32 v222, v50, v52
    v_mul_u32_u24 v51, 8224, v54
    ds_write_b32 v228, v210 offset:4608
    ds_write_b32 v228, v211 offset:4864
    ds_write_b32 v228, v212 offset:5120
    buffer_load_dwordx4 v[152:155], v229, s[8:11], s58 offen offset:2048 sc1
    v_add_u32 v232, v51, v52
    v_lshl_add_u32 v247, v55, 7, v232
    ds_write_b32 v228, v213 offset:5376
    ds_write_b32 v228, v214 offset:5632
    ds_write_b16 v226, v215 offset:5888
    buffer_load_dwordx4 v[156:159], v229, s[8:11], s58 offen offset:3072 sc1
    s_add_u32 s58, s58, 4096
    v_mul_u32_u24 v53, 192, v48
    v_and_b32 v53, 0xc0, v53
    ds_write_b32 v228, v216 offset:6144
    ds_write_b32 v228, v217 offset:6400
    ds_write_b32 v228, v218 offset:6656
    buffer_load_dwordx4 v[160:163], v229, s[8:11], s58 offen offset:0 sc1
    v_add_u32 v53, v53, v52
    v_mul_u32_u24 v51, 2400, v48
    ds_write_b32 v228, v219 offset:6912
    ds_write_b32 v228, v220 offset:7168
    ds_write_b16 v226, v221 offset:7424
    buffer_load_dwordx4 v[164:167], v229, s[8:11], s58 offen offset:1024 sc1
    s_mov_b32 s60, 65536
    v_add3_u32 v223, v51, v53, s60
    buffer_load_dwordx4 v[168:171], v229, s[8:11], s58 offen offset:2048 sc1
    v_mul_u32_u24 v51, 2400, v54
    s_mov_b32 s60, 142336
    buffer_load_dwordx4 v[172:175], v229, s[8:11], s58 offen offset:3072 sc1
    v_add3_u32 v225, v51, v53, s60
    v_lshl_add_u32 v248, v55, 7, v225
    s_lshl_b32 s60, s20, 5
    v_lshl_add_u32 v49, v49, 3, s60
    s_mov_b32 s60, 65536
    v_add3_u32 v255, v51, v49, s60
    v_lshl_add_u32 v246, v55, 9, v255
    v_bfe_u32 v53, v48, 2, 1
    v_lshl_add_u32 v49, v53, 4, v49
    v_add_u32 v254, v50, v49
    s_and_b32 s64, s55, s28
    s_waitcnt lgkmcnt(0)
    s_barrier
    s_cmp_eq_u32 s64, 0
    s_cbranch_scc1 K2_MULTI
    s_setprio 3
    ds_read_b128 v[48:51], v222 offset:0
    ds_read_b128 v[52:55], v222 offset:64
    ds_read_b128 v[56:59], v222 offset:896
    ds_read_b128 v[60:63], v222 offset:960
    ds_read_b128 v[64:67], v223 offset:0
    ds_read_b128 v[68:71], v223 offset:64
    ds_read_b128 v[72:75], v223 offset:896
    ds_read_b128 v[76:79], v223 offset:960
    ds_read_b128 v[80:83], v222 offset:128
    ds_read_b128 v[84:87], v222 offset:384
    ds_read_b128 v[88:91], v222 offset:256
    s_waitcnt vmcnt(19) lgkmcnt(9)
    v_mfma_f32_16x16x32_bf16 v[0:3], v[96:99], v[48:51], 0
    ds_read_b128 v[92:95], v222 offset:192
    s_waitcnt vmcnt(18)
    v_mfma_f32_16x16x32_bf16 v[0:3], v[100:103], v[52:55], v[0:3]
    ds_read_b128 v[48:51], v222 offset:448
    s_waitcnt vmcnt(17) lgkmcnt(9)
    v_mfma_f32_16x16x32_bf16 v[0:3], v[104:107], v[56:59], v[0:3]
    s_bfe_u32 s60, s20, 0x10002
    s_lshl_b32 s60, s60, 4
    ds_read_b128 v[52:55], v222 offset:320
    s_waitcnt vmcnt(16)
    v_mfma_f32_16x16x32_bf16 v[0:3], v[108:111], v[60:63], v[0:3]
    s_add_u32 s59, s59, s60
    v_add_u32 v228, s59, v229
    ds_read_b128 v[56:59], v222 offset:640
    s_waitcnt vmcnt(15) lgkmcnt(9)
    v_mfma_f32_16x16x32_bf16 v[0:3], v[112:115], v[64:67], v[0:3]
    s_mul_i32 s60, s20, 2400
    s_add_u32 s60, s60, 65536
    ds_read_b128 v[60:63], v222 offset:512
    s_waitcnt vmcnt(14)
    v_mfma_f32_16x16x32_bf16 v[0:3], v[116:119], v[68:71], v[0:3]
    v_add_u32 v249, s60, v229
    s_mov_b32 s63, 0xbfb8aa3b
    ds_read_b128 v[64:67], v222 offset:768
    s_waitcnt vmcnt(13) lgkmcnt(9)
    v_mfma_f32_16x16x32_bf16 v[0:3], v[120:123], v[72:75], v[0:3]
    s_add_u32 s40, s20, s21
    s_lshl_b32 s40, s40, 10
    ds_read_b128 v[68:71], v222 offset:704
    s_waitcnt vmcnt(12)
    v_mfma_f32_16x16x32_bf16 v[0:3], v[124:127], v[76:79], v[0:3]
    s_add_u32 s41, s40, 8192
    s_add_u32 s42, s40, 16384
    ds_read_b128 v[72:75], v222 offset:576
    s_waitcnt vmcnt(11) lgkmcnt(9)
    v_mfma_f32_16x16x32_bf16 v[4:7], v[128:131], v[80:83], 0
    s_add_u32 s43, s40, 24576
    s_add_u32 s44, s40, 32768
    ds_read_b128 v[76:79], v222 offset:832
    v_mfma_f32_16x16x32_bf16 v[8:11], v[128:131], v[84:87], 0
    ds_read_b128 v[80:83], v222 offset:1024
    s_waitcnt lgkmcnt(9)
    v_mfma_f32_16x16x32_bf16 v[12:15], v[128:131], v[88:91], 0
    ds_read_b128 v[84:87], v222 offset:1280
    s_waitcnt vmcnt(10)
    v_mfma_f32_16x16x32_bf16 v[4:7], v[132:135], v[92:95], v[4:7]
    ds_read_b128 v[88:91], v222 offset:1152
    s_waitcnt lgkmcnt(9)
    v_mfma_f32_16x16x32_bf16 v[8:11], v[132:135], v[48:51], v[8:11]
    v_mul_f32 v204, s63, v0
    ds_read_b128 v[92:95], v222 offset:1088
    v_mfma_f32_16x16x32_bf16 v[12:15], v[132:135], v[52:55], v[12:15]
    v_mul_f32 v205, s63, v1
    s_setprio 2
    ds_read_b128 v[48:51], v222 offset:1344
    s_waitcnt vmcnt(9) lgkmcnt(9)
    v_mfma_f32_16x16x32_bf16 v[4:7], v[136:139], v[56:59], v[4:7]
    ds_read_b128 v[52:55], v222 offset:1216
    v_mfma_f32_16x16x32_bf16 v[8:11], v[136:139], v[60:63], v[8:11]
    v_mul_f32 v206, s63, v2
    ds_read_b128 v[56:59], v223 offset:128
    s_waitcnt lgkmcnt(9)
    v_mfma_f32_16x16x32_bf16 v[12:15], v[136:139], v[64:67], v[12:15]
    v_mul_f32 v207, s63, v3
    ds_read_b128 v[60:63], v223 offset:384
    s_waitcnt vmcnt(8)
    v_mfma_f32_16x16x32_bf16 v[4:7], v[140:143], v[68:71], v[4:7]
    ds_read_b128 v[64:67], v223 offset:256
    s_waitcnt lgkmcnt(9)
    v_mfma_f32_16x16x32_bf16 v[8:11], v[140:143], v[72:75], v[8:11]
    v_exp_f32 v204, v204
    ds_read_b128 v[68:71], v223 offset:192
    v_mfma_f32_16x16x32_bf16 v[12:15], v[140:143], v[76:79], v[12:15]
    ds_read_b128 v[72:75], v223 offset:448
    s_waitcnt vmcnt(7) lgkmcnt(9)
    v_mfma_f32_16x16x32_bf16 v[4:7], v[144:147], v[80:83], v[4:7]
    v_exp_f32 v205, v205
    ds_read_b128 v[76:79], v223 offset:320
    v_mfma_f32_16x16x32_bf16 v[8:11], v[144:147], v[84:87], v[8:11]
    v_exp_f32 v206, v206
    ds_read_b128 v[80:83], v223 offset:640
    s_waitcnt lgkmcnt(9)
    v_mfma_f32_16x16x32_bf16 v[12:15], v[144:147], v[88:91], v[12:15]
    ds_read_b128 v[84:87], v223 offset:512
    s_waitcnt vmcnt(6)
    v_mfma_f32_16x16x32_bf16 v[4:7], v[148:151], v[92:95], v[4:7]
    v_exp_f32 v207, v207
    ds_read_b128 v[88:91], v223 offset:768
    s_waitcnt lgkmcnt(9)
    v_mfma_f32_16x16x32_bf16 v[8:11], v[148:151], v[48:51], v[8:11]
    v_add_f32 v204, 1.0, v204
    ds_read_b128 v[92:95], v223 offset:704
    v_mfma_f32_16x16x32_bf16 v[12:15], v[148:151], v[52:55], v[12:15]
    ds_read_b128 v[48:51], v223 offset:576
    s_waitcnt vmcnt(5) lgkmcnt(9)
    v_mfma_f32_16x16x32_bf16 v[4:7], v[152:155], v[56:59], v[4:7]
    v_add_f32 v205, 1.0, v205
    ds_read_b128 v[52:55], v223 offset:832
    v_mfma_f32_16x16x32_bf16 v[8:11], v[152:155], v[60:63], v[8:11]
    s_setprio 1
    ds_read_b128 v[56:59], v223 offset:1024
    s_waitcnt lgkmcnt(9)
    v_mfma_f32_16x16x32_bf16 v[12:15], v[152:155], v[64:67], v[12:15]
    v_add_f32 v206, 1.0, v206
    ds_read_b128 v[60:63], v223 offset:1280
    s_waitcnt vmcnt(4)
    v_mfma_f32_16x16x32_bf16 v[4:7], v[156:159], v[68:71], v[4:7]
    v_add_f32 v207, 1.0, v207
    ds_read_b128 v[64:67], v223 offset:1152
    s_waitcnt lgkmcnt(9)
    v_mfma_f32_16x16x32_bf16 v[8:11], v[156:159], v[72:75], v[8:11]
    ds_read_b128 v[68:71], v223 offset:1088
    v_mfma_f32_16x16x32_bf16 v[12:15], v[156:159], v[76:79], v[12:15]
    v_rcp_f32 v204, v204
    ds_read_b128 v[72:75], v223 offset:1344
    s_waitcnt vmcnt(3) lgkmcnt(9)
    v_mfma_f32_16x16x32_bf16 v[4:7], v[160:163], v[80:83], v[4:7]
    v_rcp_f32 v205, v205
    ds_read_b128 v[76:79], v223 offset:1216
    v_mfma_f32_16x16x32_bf16 v[8:11], v[160:163], v[84:87], v[8:11]
    ds_read_b128 v[80:83], v222 offset:3072
    s_waitcnt lgkmcnt(9)
    v_mfma_f32_16x16x32_bf16 v[12:15], v[160:163], v[88:91], v[12:15]
    v_rcp_f32 v206, v206
    ds_read_b128 v[84:87], v222 offset:3136
    s_waitcnt vmcnt(2)
    v_mfma_f32_16x16x32_bf16 v[4:7], v[164:167], v[92:95], v[4:7]
    ds_read_b128 v[88:91], v222 offset:3968
    s_waitcnt lgkmcnt(9)
    v_mfma_f32_16x16x32_bf16 v[8:11], v[164:167], v[48:51], v[8:11]
    v_rcp_f32 v207, v207
    ds_read_b128 v[92:95], v222 offset:4032
    v_mfma_f32_16x16x32_bf16 v[12:15], v[164:167], v[52:55], v[12:15]
    v_cvt_pk_bf16_f32 v176, v0, v1
    ds_read_b128 v[48:51], v223 offset:38400
    s_waitcnt vmcnt(1) lgkmcnt(9)
    v_mfma_f32_16x16x32_bf16 v[4:7], v[168:171], v[56:59], v[4:7]
    ds_read_b128 v[52:55], v223 offset:38464
    v_mfma_f32_16x16x32_bf16 v[8:11], v[168:171], v[60:63], v[8:11]
    v_cvt_pk_bf16_f32 v177, v2, v3
    s_setprio 0
    ds_read_b128 v[56:59], v223 offset:39296
    s_waitcnt lgkmcnt(9)
    v_mfma_f32_16x16x32_bf16 v[12:15], v[168:171], v[64:67], v[12:15]
    ds_read_b128 v[60:63], v223 offset:39360
    s_waitcnt vmcnt(0)
    v_mfma_f32_16x16x32_bf16 v[4:7], v[172:175], v[68:71], v[4:7]
    ds_read_b128 v[64:67], v222 offset:3200
    s_waitcnt lgkmcnt(9)
    v_mfma_f32_16x16x32_bf16 v[8:11], v[172:175], v[72:75], v[8:11]
    ds_read_b128 v[68:71], v222 offset:3456
    v_mfma_f32_16x16x32_bf16 v[12:15], v[172:175], v[76:79], v[12:15]
    ds_read_b128 v[72:75], v222 offset:3328
    s_waitcnt lgkmcnt(9)
    v_mfma_f32_16x16x32_bf16 v[16:19], v[96:99], v[80:83], 0
    ds_read_b128 v[76:79], v222 offset:3264
    v_mfma_f32_16x16x32_bf16 v[16:19], v[100:103], v[84:87], v[16:19]
    ds_read_b128 v[80:83], v222 offset:3520
    s_waitcnt lgkmcnt(9)
    v_mfma_f32_16x16x32_bf16 v[16:19], v[104:107], v[88:91], v[16:19]
    s_barrier
    s_setprio 3
    ds_read_b128 v[84:87], v222 offset:3392
    v_mfma_f32_16x16x32_bf16 v[16:19], v[108:111], v[92:95], v[16:19]
    v_mul_f32 v4, v4, v204
    ds_read_b128 v[88:91], v222 offset:3712
    s_waitcnt lgkmcnt(9)
    v_mfma_f32_16x16x32_bf16 v[16:19], v[112:115], v[48:51], v[16:19]
    v_mul_f32 v5, v5, v205
    ds_read_b128 v[92:95], v222 offset:3584
    v_mfma_f32_16x16x32_bf16 v[16:19], v[116:119], v[52:55], v[16:19]
    v_mul_f32 v6, v6, v206
    ds_read_b128 v[48:51], v222 offset:3840
    s_waitcnt lgkmcnt(9)
    v_mfma_f32_16x16x32_bf16 v[16:19], v[120:123], v[56:59], v[16:19]
    v_mul_f32 v7, v7, v207
    ds_read_b128 v[52:55], v222 offset:3776
    v_mfma_f32_16x16x32_bf16 v[16:19], v[124:127], v[60:63], v[16:19]
    v_cvt_pk_bf16_f32 v178, v4, v5
    ds_read_b128 v[56:59], v222 offset:3648
    s_waitcnt lgkmcnt(9)
    v_mfma_f32_16x16x32_bf16 v[20:23], v[128:131], v[64:67], 0
    v_cvt_pk_bf16_f32 v179, v6, v7
    ds_read_b128 v[60:63], v222 offset:3904
    v_mfma_f32_16x16x32_bf16 v[24:27], v[128:131], v[68:71], 0
    v_mul_f32 v8, v8, v204
    ds_read_b128 v[64:67], v222 offset:4096
    s_waitcnt lgkmcnt(9)
    v_mfma_f32_16x16x32_bf16 v[28:31], v[128:131], v[72:75], 0
    v_mul_f32 v9, v9, v205
    ds_read_b128 v[68:71], v222 offset:4352
    v_mfma_f32_16x16x32_bf16 v[20:23], v[132:135], v[76:79], v[20:23]
    v_mul_f32 v10, v10, v206
    ds_read_b128 v[72:75], v222 offset:4224
    s_waitcnt lgkmcnt(9)
    v_mfma_f32_16x16x32_bf16 v[24:27], v[132:135], v[80:83], v[24:27]
    v_mul_f32 v11, v11, v207
    ds_read_b128 v[76:79], v222 offset:4160
    v_mfma_f32_16x16x32_bf16 v[28:31], v[132:135], v[84:87], v[28:31]
    v_cvt_pk_bf16_f32 v180, v8, v9
    ds_read_b128 v[80:83], v222 offset:4416
    s_waitcnt lgkmcnt(9)
    v_mfma_f32_16x16x32_bf16 v[20:23], v[136:139], v[88:91], v[20:23]
    v_cvt_pk_bf16_f32 v181, v10, v11
    ds_read_b128 v[84:87], v222 offset:4288
    v_mfma_f32_16x16x32_bf16 v[24:27], v[136:139], v[92:95], v[24:27]
    v_mul_f32 v12, v12, v204
    s_setprio 2
    ds_read_b128 v[88:91], v223 offset:38528
    s_waitcnt lgkmcnt(9)
    v_mfma_f32_16x16x32_bf16 v[28:31], v[136:139], v[48:51], v[28:31]
    v_mul_f32 v13, v13, v205
    ds_read_b128 v[92:95], v223 offset:38784
    v_mfma_f32_16x16x32_bf16 v[20:23], v[140:143], v[52:55], v[20:23]
    v_mul_f32 v14, v14, v206
    ds_read_b128 v[48:51], v223 offset:38656
    s_waitcnt lgkmcnt(9)
    v_mfma_f32_16x16x32_bf16 v[24:27], v[140:143], v[56:59], v[24:27]
    v_mul_f32 v15, v15, v207
    ds_read_b128 v[52:55], v223 offset:38592
    v_mfma_f32_16x16x32_bf16 v[28:31], v[140:143], v[60:63], v[28:31]
    v_cvt_pk_bf16_f32 v182, v12, v13
    ds_read_b128 v[56:59], v223 offset:38848
    s_waitcnt lgkmcnt(9)
    v_mfma_f32_16x16x32_bf16 v[20:23], v[144:147], v[64:67], v[20:23]
    v_cvt_pk_bf16_f32 v183, v14, v15
    ds_read_b128 v[60:63], v223 offset:38720
    v_mfma_f32_16x16x32_bf16 v[24:27], v[144:147], v[68:71], v[24:27]
    ds_write_b64 v254, v[176:177] offset:0
    ds_write_b64 v254, v[178:179] offset:256
    ds_write_b64 v254, v[180:181] offset:512
    ds_write_b64 v254, v[182:183] offset:768
    ds_read_b128 v[64:67], v223 offset:39040
    s_waitcnt lgkmcnt(13)
    v_mfma_f32_16x16x32_bf16 v[28:31], v[144:147], v[72:75], v[28:31]
    v_mul_f32 v208, s63, v16
    ds_read_b128 v[68:71], v223 offset:38912
    v_mfma_f32_16x16x32_bf16 v[20:23], v[148:151], v[76:79], v[20:23]
    v_mul_f32 v209, s63, v17
    ds_read_b128 v[72:75], v223 offset:39168
    s_waitcnt lgkmcnt(13)
    v_mfma_f32_16x16x32_bf16 v[24:27], v[148:151], v[80:83], v[24:27]
    v_mul_f32 v210, s63, v18
    ds_read_b128 v[76:79], v223 offset:39104
    v_mfma_f32_16x16x32_bf16 v[28:31], v[148:151], v[84:87], v[28:31]
    v_mul_f32 v211, s63, v19
    ds_read_b128 v[80:83], v223 offset:38976
    s_waitcnt lgkmcnt(13)
    v_mfma_f32_16x16x32_bf16 v[20:23], v[152:155], v[88:91], v[20:23]
    v_exp_f32 v208, v208
    ds_read_b128 v[84:87], v223 offset:39232
    v_mfma_f32_16x16x32_bf16 v[24:27], v[152:155], v[92:95], v[24:27]
    v_exp_f32 v209, v209
    ds_read_b128 v[88:91], v223 offset:39424
    s_waitcnt lgkmcnt(13)
    v_mfma_f32_16x16x32_bf16 v[28:31], v[152:155], v[48:51], v[28:31]
    s_setprio 1
    ds_read_b128 v[92:95], v223 offset:39680
    v_mfma_f32_16x16x32_bf16 v[20:23], v[156:159], v[52:55], v[20:23]
    v_exp_f32 v210, v210
    ds_read_b128 v[48:51], v223 offset:39552
    s_waitcnt lgkmcnt(13)
    v_mfma_f32_16x16x32_bf16 v[24:27], v[156:159], v[56:59], v[24:27]
    v_exp_f32 v211, v211
    ds_read_b128 v[52:55], v223 offset:39488
    v_mfma_f32_16x16x32_bf16 v[28:31], v[156:159], v[60:63], v[28:31]
    v_add_f32 v208, 1.0, v208
    ds_read_b128 v[56:59], v223 offset:39744
    s_waitcnt lgkmcnt(9)
    v_mfma_f32_16x16x32_bf16 v[20:23], v[160:163], v[64:67], v[20:23]
    v_add_f32 v209, 1.0, v209
    ds_read_b128 v[60:63], v223 offset:39616
    v_mfma_f32_16x16x32_bf16 v[24:27], v[160:163], v[68:71], v[24:27]
    v_add_f32 v210, 1.0, v210
    ds_read_b128 v[64:67], v232 offset:6144
    s_waitcnt lgkmcnt(9)
    v_mfma_f32_16x16x32_bf16 v[28:31], v[160:163], v[72:75], v[28:31]
    v_add_f32 v211, 1.0, v211
    ds_read_b128 v[68:71], v232 offset:6208
    v_mfma_f32_16x16x32_bf16 v[20:23], v[164:167], v[76:79], v[20:23]
    ds_read_b128 v[72:75], v232 offset:7040
    s_waitcnt lgkmcnt(9)
    v_mfma_f32_16x16x32_bf16 v[24:27], v[164:167], v[80:83], v[24:27]
    v_rcp_f32 v208, v208
    ds_read_b128 v[76:79], v232 offset:7104
    v_mfma_f32_16x16x32_bf16 v[28:31], v[164:167], v[84:87], v[28:31]
    v_rcp_f32 v209, v209
    ds_read_b128 v[80:83], v225 offset:0
    s_waitcnt lgkmcnt(9)
    v_mfma_f32_16x16x32_bf16 v[20:23], v[168:171], v[88:91], v[20:23]
    v_rcp_f32 v210, v210
    ds_read_b128 v[84:87], v225 offset:64
    v_mfma_f32_16x16x32_bf16 v[24:27], v[168:171], v[92:95], v[24:27]
    v_rcp_f32 v211, v211
    ds_read_b128 v[88:91], v225 offset:896
    s_waitcnt lgkmcnt(9)
    v_mfma_f32_16x16x32_bf16 v[28:31], v[168:171], v[48:51], v[28:31]
    v_cvt_pk_bf16_f32 v184, v16, v17
    s_setprio 0
    ds_read_b128 v[92:95], v225 offset:960
    v_mfma_f32_16x16x32_bf16 v[20:23], v[172:175], v[52:55], v[20:23]
    v_cvt_pk_bf16_f32 v185, v18, v19
    ds_read_b128 v[48:51], v247 offset:6272
    s_waitcnt lgkmcnt(9)
    v_mfma_f32_16x16x32_bf16 v[24:27], v[172:175], v[56:59], v[24:27]
    ds_read_b128 v[52:55], v232 offset:6528
    v_mfma_f32_16x16x32_bf16 v[28:31], v[172:175], v[60:63], v[28:31]
    ds_read_b128 v[56:59], v247 offset:6336
    s_waitcnt lgkmcnt(9)
    v_mfma_f32_16x16x32_bf16 v[32:35], v[96:99], v[64:67], 0
    ds_read_b128 v[60:63], v232 offset:6592
    v_mfma_f32_16x16x32_bf16 v[32:35], v[100:103], v[68:71], v[32:35]
    ds_read_b128 v[64:67], v247 offset:6784
    s_waitcnt lgkmcnt(9)
    v_mfma_f32_16x16x32_bf16 v[32:35], v[104:107], v[72:75], v[32:35]
    s_barrier
    ds_read_b128 v[192:195], v228 offset:0
    ds_read_b128 v[196:199], v228 offset:1536
    s_setprio 3
    ds_read_b128 v[68:71], v232 offset:6656
    v_mfma_f32_16x16x32_bf16 v[32:35], v[108:111], v[76:79], v[32:35]
    v_mul_f32 v20, v20, v208
    ds_read_b128 v[72:75], v247 offset:6848
    s_waitcnt lgkmcnt(11)
    v_mfma_f32_16x16x32_bf16 v[32:35], v[112:115], v[80:83], v[32:35]
    v_mul_f32 v21, v21, v209
    ds_read_b128 v[76:79], v232 offset:6720
    v_mfma_f32_16x16x32_bf16 v[32:35], v[116:119], v[84:87], v[32:35]
    v_mul_f32 v22, v22, v210
    ds_read_b128 v[80:83], v247 offset:7168
    s_waitcnt lgkmcnt(11)
    v_mfma_f32_16x16x32_bf16 v[32:35], v[120:123], v[88:91], v[32:35]
    v_mul_f32 v23, v23, v211
    ds_read_b128 v[84:87], v232 offset:7424
    v_mfma_f32_16x16x32_bf16 v[32:35], v[124:127], v[92:95], v[32:35]
    v_cvt_pk_bf16_f32 v186, v20, v21
    ds_read_b128 v[88:91], v247 offset:7232
    s_waitcnt lgkmcnt(11)
    v_mfma_f32_16x16x32_bf16 v[36:39], v[128:131], v[48:51], 0
    v_cvt_pk_bf16_f32 v187, v22, v23
    ds_read_b128 v[92:95], v232 offset:7488
    v_mfma_f32_16x16x32_bf16 v[40:43], v[128:131], v[52:55], 0
    v_mul_f32 v24, v24, v208
    ds_read_b128 v[48:51], v248 offset:128
    s_waitcnt lgkmcnt(11)
    v_mfma_f32_16x16x32_bf16 v[36:39], v[132:135], v[56:59], v[36:39]
    v_mul_f32 v25, v25, v209
    s_waitcnt lgkmcnt(8)
    buffer_store_dwordx4 v[192:195], v229, s[12:15], s40 offen sc1
    buffer_store_dwordx4 v[196:199], v229, s[12:15], s41 offen sc1
    ds_read_b128 v[52:55], v225 offset:384
    v_mfma_f32_16x16x32_bf16 v[40:43], v[132:135], v[60:63], v[40:43]
    v_mul_f32 v26, v26, v210
    s_setprio 2
    ds_read_b128 v[56:59], v248 offset:192
    s_waitcnt lgkmcnt(9)
    v_mfma_f32_16x16x32_bf16 v[36:39], v[136:139], v[64:67], v[36:39]
    v_mul_f32 v27, v27, v211
    v_mul_f32 v204, s63, v32
    ds_read_b128 v[60:63], v225 offset:448
    v_mfma_f32_16x16x32_bf16 v[40:43], v[136:139], v[68:71], v[40:43]
    v_cvt_pk_bf16_f32 v188, v24, v25
    v_mul_f32 v205, s63, v33
    ds_read_b128 v[64:67], v248 offset:640
    s_waitcnt lgkmcnt(9)
    v_mfma_f32_16x16x32_bf16 v[36:39], v[140:143], v[72:75], v[36:39]
    v_cvt_pk_bf16_f32 v189, v26, v27
    v_mul_f32 v206, s63, v34
    ds_read_b128 v[68:71], v225 offset:512
    v_mfma_f32_16x16x32_bf16 v[40:43], v[140:143], v[76:79], v[40:43]
    v_mul_f32 v28, v28, v208
    v_mul_f32 v207, s63, v35
    ds_read_b128 v[72:75], v248 offset:704
    s_waitcnt lgkmcnt(9)
    v_mfma_f32_16x16x32_bf16 v[36:39], v[144:147], v[80:83], v[36:39]
    v_mul_f32 v29, v29, v209
    v_exp_f32 v204, v204
    ds_read_b128 v[76:79], v225 offset:576
    v_mfma_f32_16x16x32_bf16 v[40:43], v[144:147], v[84:87], v[40:43]
    v_mul_f32 v30, v30, v210
    v_exp_f32 v205, v205
    ds_read_b128 v[80:83], v248 offset:1024
    s_waitcnt lgkmcnt(9)
    v_mfma_f32_16x16x32_bf16 v[36:39], v[148:151], v[88:91], v[36:39]
    v_mul_f32 v31, v31, v211
    v_exp_f32 v206, v206
    ds_read_b128 v[84:87], v225 offset:1280
    v_mfma_f32_16x16x32_bf16 v[40:43], v[148:151], v[92:95], v[40:43]
    v_cvt_pk_bf16_f32 v190, v28, v29
    v_exp_f32 v207, v207
    ds_read_b128 v[88:91], v248 offset:1088
    s_waitcnt lgkmcnt(9)
    v_mfma_f32_16x16x32_bf16 v[36:39], v[152:155], v[48:51], v[36:39]
    v_cvt_pk_bf16_f32 v191, v30, v31
    v_add_f32 v204, 1.0, v204
    s_setprio 1
    ds_read_b128 v[92:95], v225 offset:1344
    v_mfma_f32_16x16x32_bf16 v[40:43], v[152:155], v[52:55], v[40:43]
    ds_write_b64 v254, v[184:185] offset:3072
    ds_write_b64 v254, v[186:187] offset:3328
    ds_write_b64 v254, v[188:189] offset:3584
    ds_write_b64 v254, v[190:191] offset:3840
    v_add_f32 v205, 1.0, v205
    s_waitcnt lgkmcnt(12)
    v_mfma_f32_16x16x32_bf16 v[36:39], v[156:159], v[56:59], v[36:39]
    v_add_f32 v206, 1.0, v206
    v_mfma_f32_16x16x32_bf16 v[40:43], v[156:159], v[60:63], v[40:43]
    v_add_f32 v207, 1.0, v207
    s_waitcnt lgkmcnt(10)
    v_mfma_f32_16x16x32_bf16 v[36:39], v[160:163], v[64:67], v[36:39]
    v_rcp_f32 v204, v204
    v_mfma_f32_16x16x32_bf16 v[40:43], v[160:163], v[68:71], v[40:43]
    v_rcp_f32 v205, v205
    s_waitcnt lgkmcnt(8)
    v_mfma_f32_16x16x32_bf16 v[36:39], v[164:167], v[72:75], v[36:39]
    v_rcp_f32 v206, v206
    v_mfma_f32_16x16x32_bf16 v[40:43], v[164:167], v[76:79], v[40:43]
    v_rcp_f32 v207, v207
    s_waitcnt lgkmcnt(6)
    v_mfma_f32_16x16x32_bf16 v[36:39], v[168:171], v[80:83], v[36:39]
    v_cvt_pk_bf16_f32 v176, v32, v33
    s_setprio 0
    v_mfma_f32_16x16x32_bf16 v[40:43], v[168:171], v[84:87], v[40:43]
    v_cvt_pk_bf16_f32 v177, v34, v35
    s_waitcnt lgkmcnt(4)
    v_mfma_f32_16x16x32_bf16 v[36:39], v[172:175], v[88:91], v[36:39]
    ds_write_b64 v255, v[176:177] offset:0
    v_mfma_f32_16x16x32_bf16 v[40:43], v[172:175], v[92:95], v[40:43]
    s_nop 5
    v_mul_f32 v36, v36, v204
    v_mul_f32 v37, v37, v205
    v_mul_f32 v38, v38, v206
    v_mul_f32 v39, v39, v207
    v_cvt_pk_bf16_f32 v178, v36, v37
    v_cvt_pk_bf16_f32 v179, v38, v39
    v_mul_f32 v40, v40, v204
    v_mul_f32 v41, v41, v205
    v_mul_f32 v42, v42, v206
    v_mul_f32 v43, v43, v207
    v_cvt_pk_bf16_f32 v180, v40, v41
    v_cvt_pk_bf16_f32 v181, v42, v43
    ds_write_b64 v246, v[178:179] offset:256
    ds_write_b64 v255, v[180:181] offset:512
    s_waitcnt lgkmcnt(0)
    s_barrier
    ds_read_b128 v[192:195], v228 offset:3072
    ds_read_b128 v[196:199], v228 offset:4608
    ds_read_b128 v[200:203], v249
    s_waitcnt lgkmcnt(1)
    buffer_store_dwordx4 v[192:195], v229, s[12:15], s42 offen sc1
    buffer_store_dwordx4 v[196:199], v229, s[12:15], s43 offen sc1
K2_LASTROW:
    s_add_u32 s59, s20, 32
    s_cmp_ge_u32 s59, s22
    s_cbranch_scc1 K2_FIN
    s_waitcnt lgkmcnt(0)
    buffer_store_dwordx4 v[200:203], v229, s[12:15], s44 offen sc1
K2_FIN:
    s_branch K2_END
K2_MULTI:
    ds_read_b128 v[48:51], v222 offset:0
    ds_read_b128 v[52:55], v222 offset:64
    ds_read_b128 v[56:59], v222 offset:896
    ds_read_b128 v[60:63], v222 offset:960
    ds_read_b128 v[64:67], v223 offset:0
    ds_read_b128 v[68:71], v223 offset:64
    ds_read_b128 v[72:75], v223 offset:896
    ds_read_b128 v[76:79], v223 offset:960
    ds_read_b128 v[80:83], v222 offset:128
    ds_read_b128 v[84:87], v222 offset:384
    ds_read_b128 v[88:91], v222 offset:256
    s_waitcnt vmcnt(19) lgkmcnt(9)
    v_mfma_f32_16x16x32_bf16 v[0:3], v[96:99], v[48:51], 0
    ds_read_b128 v[92:95], v222 offset:192
    s_waitcnt vmcnt(18)
    v_mfma_f32_16x16x32_bf16 v[0:3], v[100:103], v[52:55], v[0:3]
    ds_read_b128 v[48:51], v222 offset:448
    s_waitcnt vmcnt(17) lgkmcnt(9)
    v_mfma_f32_16x16x32_bf16 v[0:3], v[104:107], v[56:59], v[0:3]
    ds_read_b128 v[52:55], v222 offset:320
    s_waitcnt vmcnt(16)
    v_mfma_f32_16x16x32_bf16 v[0:3], v[108:111], v[60:63], v[0:3]
    ds_read_b128 v[56:59], v222 offset:640
    s_waitcnt vmcnt(15) lgkmcnt(9)
    v_mfma_f32_16x16x32_bf16 v[0:3], v[112:115], v[64:67], v[0:3]
    ds_read_b128 v[60:63], v222 offset:512
    s_waitcnt vmcnt(14)
    v_mfma_f32_16x16x32_bf16 v[0:3], v[116:119], v[68:71], v[0:3]
    ds_read_b128 v[64:67], v222 offset:768
    s_waitcnt vmcnt(13) lgkmcnt(9)
    v_mfma_f32_16x16x32_bf16 v[0:3], v[120:123], v[72:75], v[0:3]
    ds_read_b128 v[68:71], v222 offset:704
    s_waitcnt vmcnt(12)
    v_mfma_f32_16x16x32_bf16 v[0:3], v[124:127], v[76:79], v[0:3]
    ds_read_b128 v[72:75], v222 offset:576
    s_waitcnt vmcnt(11) lgkmcnt(9)
    v_mfma_f32_16x16x32_bf16 v[4:7], v[128:131], v[80:83], 0
    ds_read_b128 v[76:79], v222 offset:832
    v_mfma_f32_16x16x32_bf16 v[8:11], v[128:131], v[84:87], 0
    ds_read_b128 v[80:83], v222 offset:1024
    s_waitcnt lgkmcnt(9)
    v_mfma_f32_16x16x32_bf16 v[12:15], v[128:131], v[88:91], 0
    ds_read_b128 v[84:87], v222 offset:1280
    s_waitcnt vmcnt(10)
    v_mfma_f32_16x16x32_bf16 v[4:7], v[132:135], v[92:95], v[4:7]
    ds_read_b128 v[88:91], v222 offset:1152
    s_waitcnt lgkmcnt(9)
    v_mfma_f32_16x16x32_bf16 v[8:11], v[132:135], v[48:51], v[8:11]
    ds_read_b128 v[92:95], v222 offset:1088
    v_mfma_f32_16x16x32_bf16 v[12:15], v[132:135], v[52:55], v[12:15]
    ds_read_b128 v[48:51], v222 offset:1344
    s_waitcnt vmcnt(9) lgkmcnt(9)
    v_mfma_f32_16x16x32_bf16 v[4:7], v[136:139], v[56:59], v[4:7]
    ds_read_b128 v[52:55], v222 offset:1216
    v_mfma_f32_16x16x32_bf16 v[8:11], v[136:139], v[60:63], v[8:11]
    ds_read_b128 v[56:59], v223 offset:128
    s_waitcnt lgkmcnt(9)
    v_mfma_f32_16x16x32_bf16 v[12:15], v[136:139], v[64:67], v[12:15]
    ds_read_b128 v[60:63], v223 offset:384
    s_waitcnt vmcnt(8)
    v_mfma_f32_16x16x32_bf16 v[4:7], v[140:143], v[68:71], v[4:7]
    ds_read_b128 v[64:67], v223 offset:256
    s_waitcnt lgkmcnt(9)
    v_mfma_f32_16x16x32_bf16 v[8:11], v[140:143], v[72:75], v[8:11]
    ds_read_b128 v[68:71], v223 offset:192
    v_mfma_f32_16x16x32_bf16 v[12:15], v[140:143], v[76:79], v[12:15]
    ds_read_b128 v[72:75], v223 offset:448
    s_waitcnt vmcnt(7) lgkmcnt(9)
    v_mfma_f32_16x16x32_bf16 v[4:7], v[144:147], v[80:83], v[4:7]
    ds_read_b128 v[76:79], v223 offset:320
    v_mfma_f32_16x16x32_bf16 v[8:11], v[144:147], v[84:87], v[8:11]
    ds_read_b128 v[80:83], v223 offset:640
    s_waitcnt lgkmcnt(9)
    v_mfma_f32_16x16x32_bf16 v[12:15], v[144:147], v[88:91], v[12:15]
    ds_read_b128 v[84:87], v223 offset:512
    s_waitcnt vmcnt(6)
    v_mfma_f32_16x16x32_bf16 v[4:7], v[148:151], v[92:95], v[4:7]
    ds_read_b128 v[88:91], v223 offset:768
    s_waitcnt lgkmcnt(9)
    v_mfma_f32_16x16x32_bf16 v[8:11], v[148:151], v[48:51], v[8:11]
    ds_read_b128 v[92:95], v223 offset:704
    v_mfma_f32_16x16x32_bf16 v[12:15], v[148:151], v[52:55], v[12:15]
    ds_read_b128 v[48:51], v223 offset:576
    s_waitcnt vmcnt(5) lgkmcnt(9)
    v_mfma_f32_16x16x32_bf16 v[4:7], v[152:155], v[56:59], v[4:7]
    ds_read_b128 v[52:55], v223 offset:832
    v_mfma_f32_16x16x32_bf16 v[8:11], v[152:155], v[60:63], v[8:11]
    ds_read_b128 v[56:59], v223 offset:1024
    s_waitcnt lgkmcnt(9)
    v_mfma_f32_16x16x32_bf16 v[12:15], v[152:155], v[64:67], v[12:15]
    ds_read_b128 v[60:63], v223 offset:1280
    s_waitcnt vmcnt(4)
    v_mfma_f32_16x16x32_bf16 v[4:7], v[156:159], v[68:71], v[4:7]
    ds_read_b128 v[64:67], v223 offset:1152
    s_waitcnt lgkmcnt(9)
    v_mfma_f32_16x16x32_bf16 v[8:11], v[156:159], v[72:75], v[8:11]
    ds_read_b128 v[68:71], v223 offset:1088
    v_mfma_f32_16x16x32_bf16 v[12:15], v[156:159], v[76:79], v[12:15]
    ds_read_b128 v[72:75], v223 offset:1344
    s_waitcnt vmcnt(3) lgkmcnt(9)
    v_mfma_f32_16x16x32_bf16 v[4:7], v[160:163], v[80:83], v[4:7]
    ds_read_b128 v[76:79], v223 offset:1216
    v_mfma_f32_16x16x32_bf16 v[8:11], v[160:163], v[84:87], v[8:11]
    ds_read_b128 v[80:83], v222 offset:3072
    s_waitcnt lgkmcnt(9)
    v_mfma_f32_16x16x32_bf16 v[12:15], v[160:163], v[88:91], v[12:15]
    ds_read_b128 v[84:87], v222 offset:3136
    s_waitcnt vmcnt(2)
    v_mfma_f32_16x16x32_bf16 v[4:7], v[164:167], v[92:95], v[4:7]
    ds_read_b128 v[88:91], v222 offset:3968
    s_waitcnt lgkmcnt(9)
    v_mfma_f32_16x16x32_bf16 v[8:11], v[164:167], v[48:51], v[8:11]
    ds_read_b128 v[92:95], v222 offset:4032
    v_mfma_f32_16x16x32_bf16 v[12:15], v[164:167], v[52:55], v[12:15]
    ds_read_b128 v[48:51], v223 offset:38400
    s_waitcnt vmcnt(1) lgkmcnt(9)
    v_mfma_f32_16x16x32_bf16 v[4:7], v[168:171], v[56:59], v[4:7]
    ds_read_b128 v[52:55], v223 offset:38464
    v_mfma_f32_16x16x32_bf16 v[8:11], v[168:171], v[60:63], v[8:11]
    ds_read_b128 v[56:59], v223 offset:39296
    s_waitcnt lgkmcnt(9)
    v_mfma_f32_16x16x32_bf16 v[12:15], v[168:171], v[64:67], v[12:15]
    ds_read_b128 v[60:63], v223 offset:39360
    s_waitcnt vmcnt(0)
    v_mfma_f32_16x16x32_bf16 v[4:7], v[172:175], v[68:71], v[4:7]
    ds_read_b128 v[64:67], v222 offset:3200
    s_waitcnt lgkmcnt(9)
    v_mfma_f32_16x16x32_bf16 v[8:11], v[172:175], v[72:75], v[8:11]
    ds_read_b128 v[68:71], v222 offset:3456
    v_mfma_f32_16x16x32_bf16 v[12:15], v[172:175], v[76:79], v[12:15]
    ds_read_b128 v[72:75], v222 offset:3328
    s_waitcnt lgkmcnt(9)
    v_mfma_f32_16x16x32_bf16 v[16:19], v[96:99], v[80:83], 0
    ds_read_b128 v[76:79], v222 offset:3264
    v_mfma_f32_16x16x32_bf16 v[16:19], v[100:103], v[84:87], v[16:19]
    ds_read_b128 v[80:83], v222 offset:3520
    s_waitcnt lgkmcnt(9)
    v_mfma_f32_16x16x32_bf16 v[16:19], v[104:107], v[88:91], v[16:19]
    ds_read_b128 v[84:87], v222 offset:3392
    v_mfma_f32_16x16x32_bf16 v[16:19], v[108:111], v[92:95], v[16:19]
    ds_read_b128 v[88:91], v222 offset:3712
    s_waitcnt lgkmcnt(9)
    v_mfma_f32_16x16x32_bf16 v[16:19], v[112:115], v[48:51], v[16:19]
    ds_read_b128 v[92:95], v222 offset:3584
    v_mfma_f32_16x16x32_bf16 v[16:19], v[116:119], v[52:55], v[16:19]
    ds_read_b128 v[48:51], v222 offset:3840
    s_waitcnt lgkmcnt(9)
    v_mfma_f32_16x16x32_bf16 v[16:19], v[120:123], v[56:59], v[16:19]
    ds_read_b128 v[52:55], v222 offset:3776
    v_mfma_f32_16x16x32_bf16 v[16:19], v[124:127], v[60:63], v[16:19]
    ds_read_b128 v[56:59], v222 offset:3648
    s_waitcnt lgkmcnt(9)
    v_mfma_f32_16x16x32_bf16 v[20:23], v[128:131], v[64:67], 0
    ds_read_b128 v[60:63], v222 offset:3904
    v_mfma_f32_16x16x32_bf16 v[24:27], v[128:131], v[68:71], 0
    ds_read_b128 v[64:67], v222 offset:4096
    s_waitcnt lgkmcnt(9)
    v_mfma_f32_16x16x32_bf16 v[28:31], v[128:131], v[72:75], 0
    ds_read_b128 v[68:71], v222 offset:4352
    v_mfma_f32_16x16x32_bf16 v[20:23], v[132:135], v[76:79], v[20:23]
    ds_read_b128 v[72:75], v222 offset:4224
    s_waitcnt lgkmcnt(9)
    v_mfma_f32_16x16x32_bf16 v[24:27], v[132:135], v[80:83], v[24:27]
    ds_read_b128 v[76:79], v222 offset:4160
    v_mfma_f32_16x16x32_bf16 v[28:31], v[132:135], v[84:87], v[28:31]
    ds_read_b128 v[80:83], v222 offset:4416
    s_waitcnt lgkmcnt(9)
    v_mfma_f32_16x16x32_bf16 v[20:23], v[136:139], v[88:91], v[20:23]
    ds_read_b128 v[84:87], v222 offset:4288
    v_mfma_f32_16x16x32_bf16 v[24:27], v[136:139], v[92:95], v[24:27]
    ds_read_b128 v[88:91], v223 offset:38528
    s_waitcnt lgkmcnt(9)
    v_mfma_f32_16x16x32_bf16 v[28:31], v[136:139], v[48:51], v[28:31]
    ds_read_b128 v[92:95], v223 offset:38784
    v_mfma_f32_16x16x32_bf16 v[20:23], v[140:143], v[52:55], v[20:23]
    ds_read_b128 v[48:51], v223 offset:38656
    s_waitcnt lgkmcnt(9)
    v_mfma_f32_16x16x32_bf16 v[24:27], v[140:143], v[56:59], v[24:27]
    ds_read_b128 v[52:55], v223 offset:38592
    v_mfma_f32_16x16x32_bf16 v[28:31], v[140:143], v[60:63], v[28:31]
    ds_read_b128 v[56:59], v223 offset:38848
    s_waitcnt lgkmcnt(9)
    v_mfma_f32_16x16x32_bf16 v[20:23], v[144:147], v[64:67], v[20:23]
    ds_read_b128 v[60:63], v223 offset:38720
    v_mfma_f32_16x16x32_bf16 v[24:27], v[144:147], v[68:71], v[24:27]
    ds_read_b128 v[64:67], v223 offset:39040
    s_waitcnt lgkmcnt(9)
    v_mfma_f32_16x16x32_bf16 v[28:31], v[144:147], v[72:75], v[28:31]
    ds_read_b128 v[68:71], v223 offset:38912
    v_mfma_f32_16x16x32_bf16 v[20:23], v[148:151], v[76:79], v[20:23]
    ds_read_b128 v[72:75], v223 offset:39168
    s_waitcnt lgkmcnt(9)
    v_mfma_f32_16x16x32_bf16 v[24:27], v[148:151], v[80:83], v[24:27]
    ds_read_b128 v[76:79], v223 offset:39104
    v_mfma_f32_16x16x32_bf16 v[28:31], v[148:151], v[84:87], v[28:31]
    ds_read_b128 v[80:83], v223 offset:38976
    s_waitcnt lgkmcnt(9)
    v_mfma_f32_16x16x32_bf16 v[20:23], v[152:155], v[88:91], v[20:23]
    ds_read_b128 v[84:87], v223 offset:39232
    v_mfma_f32_16x16x32_bf16 v[24:27], v[152:155], v[92:95], v[24:27]
    ds_read_b128 v[88:91], v223 offset:39424
    s_waitcnt lgkmcnt(9)
    v_mfma_f32_16x16x32_bf16 v[28:31], v[152:155], v[48:51], v[28:31]
    ds_read_b128 v[92:95], v223 offset:39680
    v_mfma_f32_16x16x32_bf16 v[20:23], v[156:159], v[52:55], v[20:23]
    ds_read_b128 v[48:51], v223 offset:39552
    s_waitcnt lgkmcnt(9)
    v_mfma_f32_16x16x32_bf16 v[24:27], v[156:159], v[56:59], v[24:27]
    ds_read_b128 v[52:55], v223 offset:39488
    v_mfma_f32_16x16x32_bf16 v[28:31], v[156:159], v[60:63], v[28:31]
    ds_read_b128 v[56:59], v223 offset:39744
    s_waitcnt lgkmcnt(9)
    v_mfma_f32_16x16x32_bf16 v[20:23], v[160:163], v[64:67], v[20:23]
    ds_read_b128 v[60:63], v223 offset:39616
    v_mfma_f32_16x16x32_bf16 v[24:27], v[160:163], v[68:71], v[24:27]
    ds_read_b128 v[64:67], v232 offset:6144
    s_waitcnt lgkmcnt(9)
    v_mfma_f32_16x16x32_bf16 v[28:31], v[160:163], v[72:75], v[28:31]
    ds_read_b128 v[68:71], v232 offset:6208
    v_mfma_f32_16x16x32_bf16 v[20:23], v[164:167], v[76:79], v[20:23]
    ds_read_b128 v[72:75], v232 offset:7040
    s_waitcnt lgkmcnt(9)
    v_mfma_f32_16x16x32_bf16 v[24:27], v[164:167], v[80:83], v[24:27]
    ds_read_b128 v[76:79], v232 offset:7104
    v_mfma_f32_16x16x32_bf16 v[28:31], v[164:167], v[84:87], v[28:31]
    ds_read_b128 v[80:83], v225 offset:0
    s_waitcnt lgkmcnt(9)
    v_mfma_f32_16x16x32_bf16 v[20:23], v[168:171], v[88:91], v[20:23]
    ds_read_b128 v[84:87], v225 offset:64
    v_mfma_f32_16x16x32_bf16 v[24:27], v[168:171], v[92:95], v[24:27]
    ds_read_b128 v[88:91], v225 offset:896
    s_waitcnt lgkmcnt(9)
    v_mfma_f32_16x16x32_bf16 v[28:31], v[168:171], v[48:51], v[28:31]
    ds_read_b128 v[92:95], v225 offset:960
    v_mfma_f32_16x16x32_bf16 v[20:23], v[172:175], v[52:55], v[20:23]
    ds_read_b128 v[48:51], v247 offset:6272
    s_waitcnt lgkmcnt(9)
    v_mfma_f32_16x16x32_bf16 v[24:27], v[172:175], v[56:59], v[24:27]
    ds_read_b128 v[52:55], v232 offset:6528
    v_mfma_f32_16x16x32_bf16 v[28:31], v[172:175], v[60:63], v[28:31]
    ds_read_b128 v[56:59], v247 offset:6336
    s_waitcnt lgkmcnt(9)
    v_mfma_f32_16x16x32_bf16 v[32:35], v[96:99], v[64:67], 0
    ds_read_b128 v[60:63], v232 offset:6592
    v_mfma_f32_16x16x32_bf16 v[32:35], v[100:103], v[68:71], v[32:35]
    ds_read_b128 v[64:67], v247 offset:6784
    s_waitcnt lgkmcnt(9)
    v_mfma_f32_16x16x32_bf16 v[32:35], v[104:107], v[72:75], v[32:35]
    ds_read_b128 v[68:71], v232 offset:6656
    v_mfma_f32_16x16x32_bf16 v[32:35], v[108:111], v[76:79], v[32:35]
    ds_read_b128 v[72:75], v247 offset:6848
    s_waitcnt lgkmcnt(9)
    v_mfma_f32_16x16x32_bf16 v[32:35], v[112:115], v[80:83], v[32:35]
    ds_read_b128 v[76:79], v232 offset:6720
    v_mfma_f32_16x16x32_bf16 v[32:35], v[116:119], v[84:87], v[32:35]
    ds_read_b128 v[80:83], v247 offset:7168
    s_waitcnt lgkmcnt(9)
    v_mfma_f32_16x16x32_bf16 v[32:35], v[120:123], v[88:91], v[32:35]
    ds_read_b128 v[84:87], v232 offset:7424
    v_mfma_f32_16x16x32_bf16 v[32:35], v[124:127], v[92:95], v[32:35]
    ds_read_b128 v[88:91], v247 offset:7232
    s_waitcnt lgkmcnt(9)
    v_mfma_f32_16x16x32_bf16 v[36:39], v[128:131], v[48:51], 0
    ds_read_b128 v[92:95], v232 offset:7488
    v_mfma_f32_16x16x32_bf16 v[40:43], v[128:131], v[52:55], 0
    ds_read_b128 v[48:51], v248 offset:128
    s_waitcnt lgkmcnt(9)
    v_mfma_f32_16x16x32_bf16 v[36:39], v[132:135], v[56:59], v[36:39]
    ds_read_b128 v[52:55], v225 offset:384
    v_mfma_f32_16x16x32_bf16 v[40:43], v[132:135], v[60:63], v[40:43]
    ds_read_b128 v[56:59], v248 offset:192
    s_waitcnt lgkmcnt(9)
    v_mfma_f32_16x16x32_bf16 v[36:39], v[136:139], v[64:67], v[36:39]
    ds_read_b128 v[60:63], v225 offset:448
    v_mfma_f32_16x16x32_bf16 v[40:43], v[136:139], v[68:71], v[40:43]
    ds_read_b128 v[64:67], v248 offset:640
    s_waitcnt lgkmcnt(9)
    v_mfma_f32_16x16x32_bf16 v[36:39], v[140:143], v[72:75], v[36:39]
    ds_read_b128 v[68:71], v225 offset:512
    v_mfma_f32_16x16x32_bf16 v[40:43], v[140:143], v[76:79], v[40:43]
    ds_read_b128 v[72:75], v248 offset:704
    s_waitcnt lgkmcnt(9)
    v_mfma_f32_16x16x32_bf16 v[36:39], v[144:147], v[80:83], v[36:39]
    ds_read_b128 v[76:79], v225 offset:576
    v_mfma_f32_16x16x32_bf16 v[40:43], v[144:147], v[84:87], v[40:43]
    ds_read_b128 v[80:83], v248 offset:1024
    s_waitcnt lgkmcnt(9)
    v_mfma_f32_16x16x32_bf16 v[36:39], v[148:151], v[88:91], v[36:39]
    ds_read_b128 v[84:87], v225 offset:1280
    v_mfma_f32_16x16x32_bf16 v[40:43], v[148:151], v[92:95], v[40:43]
    ds_read_b128 v[88:91], v248 offset:1088
    s_waitcnt lgkmcnt(9)
    v_mfma_f32_16x16x32_bf16 v[36:39], v[152:155], v[48:51], v[36:39]
    ds_read_b128 v[92:95], v225 offset:1344
    v_mfma_f32_16x16x32_bf16 v[40:43], v[152:155], v[52:55], v[40:43]
    s_waitcnt lgkmcnt(8)
    v_mfma_f32_16x16x32_bf16 v[36:39], v[156:159], v[56:59], v[36:39]
    v_mfma_f32_16x16x32_bf16 v[40:43], v[156:159], v[60:63], v[40:43]
    s_waitcnt lgkmcnt(6)
    v_mfma_f32_16x16x32_bf16 v[36:39], v[160:163], v[64:67], v[36:39]
    v_mfma_f32_16x16x32_bf16 v[40:43], v[160:163], v[68:71], v[40:43]
    s_waitcnt lgkmcnt(4)
    v_mfma_f32_16x16x32_bf16 v[36:39], v[164:167], v[72:75], v[36:39]
    v_mfma_f32_16x16x32_bf16 v[40:43], v[164:167], v[76:79], v[40:43]
    s_waitcnt lgkmcnt(2)
    v_mfma_f32_16x16x32_bf16 v[36:39], v[168:171], v[80:83], v[36:39]
    v_mfma_f32_16x16x32_bf16 v[40:43], v[168:171], v[84:87], v[40:43]
    s_waitcnt lgkmcnt(0)
    v_mfma_f32_16x16x32_bf16 v[36:39], v[172:175], v[88:91], v[36:39]
    v_mfma_f32_16x16x32_bf16 v[40:43], v[172:175], v[92:95], v[40:43]
    s_lshl_b32 s60, s54, 9
    s_lshl_b32 s61, s20, 6
    s_add_u32 s60, s60, s61
    s_mul_i32 s60, s60, 192
    s_add_u32 s60, s60, 10485760
    v_mul_u32_u24 v227, 96, v252
    s_cmp_lg_u32 s28, 0
    s_cbranch_scc1 K2_NOACC
    buffer_load_dwordx4 v[48:51], v227, s[8:11], s60 offen offset:0
    buffer_load_dwordx4 v[52:55], v227, s[8:11], s60 offen offset:16
    buffer_load_dwordx4 v[56:59], v227, s[8:11], s60 offen offset:32
    buffer_load_dwordx4 v[60:63], v227, s[8:11], s60 offen offset:48
    buffer_load_dwordx4 v[64:67], v227, s[8:11], s60 offen offset:64
    buffer_load_dwordx4 v[68:71], v227, s[8:11], s60 offen offset:80
    buffer_load_dwordx4 v[72:75], v227, s[8:11], s60 offen offset:96
    buffer_load_dwordx4 v[76:79], v227, s[8:11], s60 offen offset:112
    buffer_load_dwordx4 v[80:83], v227, s[8:11], s60 offen offset:128
    buffer_load_dwordx4 v[84:87], v227, s[8:11], s60 offen offset:144
    buffer_load_dwordx4 v[88:91], v227, s[8:11], s60 offen offset:160
    s_waitcnt vmcnt(0)
    v_add_f32 v0, v0, v48
    v_add_f32 v1, v1, v49
    v_add_f32 v2, v2, v50
    v_add_f32 v3, v3, v51
    v_add_f32 v4, v4, v52
    v_add_f32 v5, v5, v53
    v_add_f32 v6, v6, v54
    v_add_f32 v7, v7, v55
    v_add_f32 v8, v8, v56
    v_add_f32 v9, v9, v57
    v_add_f32 v10, v10, v58
    v_add_f32 v11, v11, v59
    v_add_f32 v12, v12, v60
    v_add_f32 v13, v13, v61
    v_add_f32 v14, v14, v62
    v_add_f32 v15, v15, v63
    v_add_f32 v16, v16, v64
    v_add_f32 v17, v17, v65
    v_add_f32 v18, v18, v66
    v_add_f32 v19, v19, v67
    v_add_f32 v20, v20, v68
    v_add_f32 v21, v21, v69
    v_add_f32 v22, v22, v70
    v_add_f32 v23, v23, v71
    v_add_f32 v24, v24, v72
    v_add_f32 v25, v25, v73
    v_add_f32 v26, v26, v74
    v_add_f32 v27, v27, v75
    v_add_f32 v28, v28, v76
    v_add_f32 v29, v29, v77
    v_add_f32 v30, v30, v78
    v_add_f32 v31, v31, v79
    v_add_f32 v32, v32, v80
    v_add_f32 v33, v33, v81
    v_add_f32 v34, v34, v82
    v_add_f32 v35, v35, v83
    v_add_f32 v36, v36, v84
    v_add_f32 v37, v37, v85
    v_add_f32 v38, v38, v86
    v_add_f32 v39, v39, v87
    v_add_f32 v40, v40, v88
    v_add_f32 v41, v41, v89
    v_add_f32 v42, v42, v90
    v_add_f32 v43, v43, v91
K2_NOACC:
    s_barrier
    s_cmp_eq_u32 s55, 0
    s_cbranch_scc1 K2_SPILL
    s_bfe_u32 s60, s20, 0x10002
    s_lshl_b32 s60, s60, 4
    s_add_u32 s59, s59, s60
    v_add_u32 v228, s59, v229
    s_mul_i32 s60, s20, 2400
    s_add_u32 s60, s60, 65536
    v_add_u32 v249, s60, v229
    s_mov_b32 s63, 0xbfb8aa3b
    s_add_u32 s40, s20, s21
    s_lshl_b32 s40, s40, 10
    s_add_u32 s41, s40, 8192
    s_add_u32 s42, s40, 16384
    s_add_u32 s43, s40, 24576
    s_add_u32 s44, s40, 32768
    v_mul_f32 v204, s63, v0
    v_mul_f32 v205, s63, v1
    v_mul_f32 v206, s63, v2
    v_mul_f32 v207, s63, v3
    v_exp_f32 v204, v204
    v_exp_f32 v205, v205
    v_exp_f32 v206, v206
    v_exp_f32 v207, v207
    v_add_f32 v204, 1.0, v204
    v_add_f32 v205, 1.0, v205
    v_add_f32 v206, 1.0, v206
    v_add_f32 v207, 1.0, v207
    v_rcp_f32 v204, v204
    v_rcp_f32 v205, v205
    v_rcp_f32 v206, v206
    v_rcp_f32 v207, v207
    v_cvt_pk_bf16_f32 v176, v0, v1
    v_cvt_pk_bf16_f32 v177, v2, v3
    v_mul_f32 v4, v4, v204
    v_mul_f32 v5, v5, v205
    v_mul_f32 v6, v6, v206
    v_mul_f32 v7, v7, v207
    v_cvt_pk_bf16_f32 v178, v4, v5
    v_cvt_pk_bf16_f32 v179, v6, v7
    v_mul_f32 v8, v8, v204
    v_mul_f32 v9, v9, v205
    v_mul_f32 v10, v10, v206
    v_mul_f32 v11, v11, v207
    v_cvt_pk_bf16_f32 v180, v8, v9
    v_cvt_pk_bf16_f32 v181, v10, v11
    v_mul_f32 v12, v12, v204
    v_mul_f32 v13, v13, v205
    v_mul_f32 v14, v14, v206
    v_mul_f32 v15, v15, v207
    v_cvt_pk_bf16_f32 v182, v12, v13
    v_cvt_pk_bf16_f32 v183, v14, v15
    ds_write_b64 v254, v[176:177] offset:0
    ds_write_b64 v254, v[178:179] offset:256
    ds_write_b64 v254, v[180:181] offset:512
    ds_write_b64 v254, v[182:183] offset:768
    s_waitcnt lgkmcnt(0)
    s_barrier
    ds_read_b128 v[192:195], v228 offset:0
    ds_read_b128 v[196:199], v228 offset:1536
    s_waitcnt lgkmcnt(0)
    buffer_store_dwordx4 v[192:195], v229, s[12:15], s40 offen sc1
    buffer_store_dwordx4 v[196:199], v229, s[12:15], s41 offen sc1
    v_mul_f32 v208, s63, v16
    v_mul_f32 v209, s63, v17
    v_mul_f32 v210, s63, v18
    v_mul_f32 v211, s63, v19
    v_exp_f32 v208, v208
    v_exp_f32 v209, v209
    v_exp_f32 v210, v210
    v_exp_f32 v211, v211
    v_add_f32 v208, 1.0, v208
    v_add_f32 v209, 1.0, v209
    v_add_f32 v210, 1.0, v210
    v_add_f32 v211, 1.0, v211
    v_rcp_f32 v208, v208
    v_rcp_f32 v209, v209
    v_rcp_f32 v210, v210
    v_rcp_f32 v211, v211
    v_cvt_pk_bf16_f32 v184, v16, v17
    v_cvt_pk_bf16_f32 v185, v18, v19
    v_mul_f32 v20, v20, v208
    v_mul_f32 v21, v21, v209
    v_mul_f32 v22, v22, v210
    v_mul_f32 v23, v23, v211
    v_cvt_pk_bf16_f32 v186, v20, v21
    v_cvt_pk_bf16_f32 v187, v22, v23
    v_mul_f32 v24, v24, v208
    v_mul_f32 v25, v25, v209
    v_mul_f32 v26, v26, v210
    v_mul_f32 v27, v27, v211
    v_cvt_pk_bf16_f32 v188, v24, v25
    v_cvt_pk_bf16_f32 v189, v26, v27
    v_mul_f32 v28, v28, v208
    v_mul_f32 v29, v29, v209
    v_mul_f32 v30, v30, v210
    v_mul_f32 v31, v31, v211
    v_cvt_pk_bf16_f32 v190, v28, v29
    v_cvt_pk_bf16_f32 v191, v30, v31
    ds_write_b64 v254, v[184:185] offset:3072
    ds_write_b64 v254, v[186:187] offset:3328
    ds_write_b64 v254, v[188:189] offset:3584
    ds_write_b64 v254, v[190:191] offset:3840
    s_waitcnt lgkmcnt(0)
    s_barrier
    ds_read_b128 v[192:195], v228 offset:3072
    ds_read_b128 v[196:199], v228 offset:4608
    s_waitcnt lgkmcnt(0)
    buffer_store_dwordx4 v[192:195], v229, s[12:15], s42 offen sc1
    buffer_store_dwordx4 v[196:199], v229, s[12:15], s43 offen sc1
    v_mul_f32 v204, s63, v32
    v_mul_f32 v205, s63, v33
    v_mul_f32 v206, s63, v34
    v_mul_f32 v207, s63, v35
    v_exp_f32 v204, v204
    v_exp_f32 v205, v205
    v_exp_f32 v206, v206
    v_exp_f32 v207, v207
    v_add_f32 v204, 1.0, v204
    v_add_f32 v205, 1.0, v205
    v_add_f32 v206, 1.0, v206
    v_add_f32 v207, 1.0, v207
    v_rcp_f32 v204, v204
    v_rcp_f32 v205, v205
    v_rcp_f32 v206, v206
    v_rcp_f32 v207, v207
    v_cvt_pk_bf16_f32 v176, v32, v33
    v_cvt_pk_bf16_f32 v177, v34, v35
    v_mul_f32 v36, v36, v204
    v_mul_f32 v37, v37, v205
    v_mul_f32 v38, v38, v206
    v_mul_f32 v39, v39, v207
    v_cvt_pk_bf16_f32 v178, v36, v37
    v_cvt_pk_bf16_f32 v179, v38, v39
    v_mul_f32 v40, v40, v204
    v_mul_f32 v41, v41, v205
    v_mul_f32 v42, v42, v206
    v_mul_f32 v43, v43, v207
    v_cvt_pk_bf16_f32 v180, v40, v41
    v_cvt_pk_bf16_f32 v181, v42, v43
    ds_write_b64 v255, v[176:177] offset:0
    ds_write_b64 v246, v[178:179] offset:256
    ds_write_b64 v255, v[180:181] offset:512
    s_waitcnt lgkmcnt(0)
    s_barrier
    ds_read_b128 v[200:203], v249
    s_branch K2_LASTROW
K2_SPILL:
    buffer_store_dwordx4 v[0:3], v227, s[8:11], s60 offen offset:0
    buffer_store_dwordx4 v[4:7], v227, s[8:11], s60 offen offset:16
    buffer_store_dwordx4 v[8:11], v227, s[8:11], s60 offen offset:32
    buffer_store_dwordx4 v[12:15], v227, s[8:11], s60 offen offset:48
    buffer_store_dwordx4 v[16:19], v227, s[8:11], s60 offen offset:64
    buffer_store_dwordx4 v[20:23], v227, s[8:11], s60 offen offset:80
    buffer_store_dwordx4 v[24:27], v227, s[8:11], s60 offen offset:96
    buffer_store_dwordx4 v[28:31], v227, s[8:11], s60 offen offset:112
    buffer_store_dwordx4 v[32:35], v227, s[8:11], s60 offen offset:128
    buffer_store_dwordx4 v[36:39], v227, s[8:11], s60 offen offset:144
    buffer_store_dwordx4 v[40:43], v227, s[8:11], s60 offen offset:160
    s_mov_b32 s28, 0
    s_waitcnt vmcnt(0)
    s_cmp_lt_u32 s24, s25
    s_cbranch_scc1 K2_LOAD
    s_add_u32 s23, s23, 20
    s_branch K2_WINDOW
K2_END:
    s_endpgm
.section .rodata,"a"
.p2align 6
.amdhsa_kernel standalone__tensor_product_equiv_equiformer__graph_kernel
  .amdhsa_next_free_vgpr 256
  .amdhsa_next_free_sgpr 102
  .amdhsa_accum_offset 256
  .amdhsa_group_segment_fixed_size 0
  .amdhsa_kernarg_size 96
  .amdhsa_user_sgpr_count 2
  .amdhsa_user_sgpr_kernarg_segment_ptr 1
  .amdhsa_system_sgpr_workgroup_id_x 1
  .amdhsa_float_denorm_mode_32 3
.end_amdhsa_kernel
```

```asm
; @launch grid=(256,1,1) block=(512,1,1) lds=163840
.amdgcn_target "amdgcn-amd-amdhsa--gfx950"
.text
.globl standalone__tensor_product_equiv_equiformer__graph_kernel
.p2align 8
.type standalone__tensor_product_equiv_equiformer__graph_kernel,@function
standalone__tensor_product_equiv_equiformer__graph_kernel:
    s_cmp_ge_u32 s2, 256
    s_cbranch_scc1 K2_END
    s_load_dwordx16 s[80:95], s[0:1], 0
    s_load_dwordx4 s[96:99], s[0:1], 72
    s_load_dwordx2 s[100:101], s[0:1], 88
    s_memrealtime s[74:75]
    v_lshrrev_b32 v1, 6, v0
    s_mov_b32 s54, s2
    v_readfirstlane_b32 s20, v1
    v_and_b32 v8, 63, v0
    v_lshlrev_b32 v9, 4, v8
    v_mov_b32 v6, 0
    v_lshlrev_b32 v5, 4, v0
    v_mul_u32_u24 v4, 24, v0
    s_mul_i32 s64, s2, 5120
    s_mul_i32 s65, s2, 7680
    v_mov_b32 v176, v8
    v_mov_b32 v177, v0
    s_mul_i32 s21, s2, 625
    s_add_u32 s22, s21, 640
    s_add_u32 s21, s21, 15
    s_lshr_b32 s21, s21, 4
    s_lshr_b32 s22, s22, 4
    s_sub_u32 s22, s22, s21
    s_movk_i32 s39, 1024
    s_lshl_b32 s37, s20, 13
    s_mov_b32 s53, 163616
    s_lshl_b32 s52, s20, 2
    s_add_u32 s52, s52, s53
    s_add_u32 s68, s37, 0
    s_add_u32 s69, s37, 2048
    s_add_u32 s70, s37, 4096
    s_add_u32 s71, s37, 6144
    s_waitcnt lgkmcnt(0)
    s_mov_b32 s8, s100
    s_and_b32 s9, s101, 0xffff
    s_mov_b32 s10, 37748736
    s_mov_b32 s11, 0x20000
    s_cmp_ge_u32 s20, 5
    s_cbranch_scc1 KS_HELP
    s_cmp_ge_u32 s2, 250
    s_cbranch_scc1 KS_IDLE
    s_mov_b32 s40, s88
    s_and_b32 s41, s89, 0xffff
    s_mov_b32 s42, 1280000
    s_mov_b32 s43, 0x20000
    buffer_load_dwordx4 v[12:15], v5, s[40:43], s64 offen
    s_mov_b32 s44, s86
    s_and_b32 s45, s87, 0xffff
    s_mov_b32 s46, 1280000
    s_mov_b32 s47, 0x20000
    s_mov_b32 s48, s82
    s_and_b32 s49, s83, 0xffff
    s_mov_b32 s50, 1920000
    s_mov_b32 s51, 0x20000
    buffer_load_dwordx4 v[16:19], v5, s[44:47], s64 offen
    buffer_load_dwordx4 v[20:23], v4, s[48:51], s65 offen
    buffer_load_dwordx2 v[24:25], v4, s[48:51], s65 offen offset:16
    v_lshlrev_b32 v2, 2, v0
    s_lshl_b32 s64, s64, 3
    v_lshl_add_u32 v3, v0, 7, s64
    v_mov_b32 v7, 1
    s_cmp_eq_u32 s20, 4
    s_cbranch_scc1 KS_NOCLR
    ds_write_b32 v2, v6
KS_NOCLR:
    s_waitcnt lgkmcnt(0)
    s_barrier
    v_mul_u32_u24 v76, 2979, v0
    v_lshrrev_b32 v76, 16, v76
    v_mul_u32_u24 v77, 2048, v76
    v_lshl_add_u32 v78, v0, 4, v77
    v_add_u32 v78, 67584, v78
    v_add_u32 v79, 67200, v78
    v_mov_b32 v80, -1
    v_mov_b32 v81, -1
    v_cmp_gt_u32 vcc, 14, v76
    v_cmp_gt_u32 s[56:57], 12, v76
    v_mov_b32 v82, -1
    v_mov_b32 v83, -1
    s_mov_b64 exec, vcc
    ds_write_b128 v78, v[80:83]
    ds_write_b128 v78, v[80:83] offset:33600
    s_mov_b64 exec, s[56:57]
    ds_write_b128 v79, v[80:83]
    s_mov_b64 exec, -1
    s_mov_b32 s4, s80
    s_and_b32 s5, s81, 0xffff
    s_mov_b32 s6, 10240000
    s_mov_b32 s7, 0x20000
    s_mov_b32 s12, s96
    s_and_b32 s13, s97, 0xffff
    s_mov_b32 s14, 10240000
    s_mov_b32 s15, 0x20000
    s_mov_b32 s16, s84
    s_and_b32 s17, s85, 0xffff
    s_mov_b32 s18, 10240000
    s_mov_b32 s19, 0x20000
    s_sub_u32 s80, s80, 1024
    s_subb_u32 s81, s81, 0
    s_mov_b32 s72, s80
    s_and_b32 s73, s81, 0xffff
    s_mov_b32 s74, 10241024
    s_mov_b32 s75, 0x20000
    s_mov_b32 s58, 429497
    s_movk_i32 s59, 625
    s_waitcnt vmcnt(3)
    v_mul_u32_u24 v28, s58, v12
    v_lshrrev_b32 v32, 27, v28
    v_bfe_u32 v36, v28, 24, 3
    v_lshlrev_b32 v32, 2, v32
    v_lshl_or_b32 v32, v36, 7, v32
    ds_add_rtn_u32 v36, v32, v7
    v_mul_u32_u24 v29, s58, v13
    v_lshrrev_b32 v33, 27, v29
    v_bfe_u32 v37, v29, 24, 3
    v_lshlrev_b32 v33, 2, v33
    v_lshl_or_b32 v33, v37, 7, v33
    ds_add_rtn_u32 v37, v33, v7
    v_mul_u32_u24 v30, s58, v14
    v_lshrrev_b32 v34, 27, v30
    v_bfe_u32 v38, v30, 24, 3
    v_lshlrev_b32 v34, 2, v34
    v_lshl_or_b32 v34, v38, 7, v34
    ds_add_rtn_u32 v38, v34, v7
    v_mul_u32_u24 v31, s58, v15
    v_lshrrev_b32 v35, 27, v31
    v_bfe_u32 v39, v31, 24, 3
    v_lshlrev_b32 v35, 2, v35
    v_lshl_or_b32 v35, v39, 7, v35
    ds_add_rtn_u32 v39, v35, v7
    v_lshrrev_b32 v28, 24, v28
    v_mad_u32_u24 v28, v28, s59, 15
    v_lshrrev_b32 v28, 4, v28
    v_sub_u32 v28, v12, v28
    v_add_u32 v12, 0, v3
    v_lshl_or_b32 v28, v28, 26, v12
    v_lshrrev_b32 v29, 24, v29
    v_mad_u32_u24 v29, v29, s59, 15
    v_lshrrev_b32 v29, 4, v29
    v_sub_u32 v29, v13, v29
    v_add_u32 v13, 32, v3
    v_lshl_or_b32 v29, v29, 26, v13
    v_lshrrev_b32 v30, 24, v30
    v_mad_u32_u24 v30, v30, s59, 15
    v_lshrrev_b32 v30, 4, v30
    v_sub_u32 v30, v14, v30
    v_add_u32 v14, 64, v3
    v_lshl_or_b32 v30, v30, 26, v14
    v_lshrrev_b32 v31, 24, v31
    v_mad_u32_u24 v31, v31, s59, 15
    v_lshrrev_b32 v31, 4, v31
    v_sub_u32 v31, v15, v31
    v_add_u32 v15, 96, v3
    v_lshl_or_b32 v31, v31, 26, v15
    v_mov_b32 v59, 163728
    s_mul_i32 s65, s2, 1152
    s_add_u32 s65, s65, 6291456
    s_mul_i32 s64, s2, 20608
    s_waitcnt lgkmcnt(0)
    s_barrier
    ds_read_b128 v[40:43], v9
    ds_read_b32 v59, v59
    s_waitcnt lgkmcnt(1)
    v_add_u32 v45, v40, v41
    v_add_u32 v46, v45, v42
    v_add_u32 v47, v46, v43
    v_mov_b32 v58, v47
    s_nop 1
    v_add_u32_dpp v58, v58, v58 row_shr:1 row_mask:0xf bank_mask:0xf bound_ctrl:0
    s_nop 1
    v_add_u32_dpp v58, v58, v58 row_shr:2 row_mask:0xf bank_mask:0xf bound_ctrl:0
    s_nop 1
    v_add_u32_dpp v58, v58, v58 row_shr:4 row_mask:0xf bank_mask:0xf bound_ctrl:0
    s_nop 1
    v_add_u32_dpp v58, v58, v58 row_shr:8 row_mask:0xf bank_mask:0xf bound_ctrl:0
    s_nop 1
    v_add_u32_dpp v58, v58, v58 row_bcast:15 row_mask:0xa bank_mask:0xf
    s_nop 1
    v_add_u32_dpp v58, v58, v58 row_bcast:31 row_mask:0xc bank_mask:0xf
    v_sub_u32 v48, v58, v47
    v_add_u32 v49, v48, v40
    v_add_u32 v50, v48, v45
    v_add_u32 v51, v48, v46
    ds_write_b128 v9, v[48:51] offset:1024
    s_waitcnt vmcnt(0) lgkmcnt(1)
    s_cmp_lg_u32 s20, 4
    s_cbranch_scc1 KS_NOPUB
    v_lshl_or_b32 v56, v49, 11, v48
    v_lshl_or_b32 v57, v51, 11, v50
    v_lshl_or_b32 v56, v59, 22, v56
    v_lshl_or_b32 v57, v59, 22, v57
    buffer_store_dwordx4 v[56:59], v9, s[8:11], s65 offen sc1
KS_NOPUB:
    s_waitcnt lgkmcnt(0)
    ds_read_b32 v32, v32 offset:1024
    ds_read_b32 v33, v33 offset:1024
    ds_read_b32 v34, v34 offset:1024
    ds_read_b32 v35, v35 offset:1024
    v_and_b32 v60, 0xffff, v59
    v_and_b32 v61, 0xffff0000, v59
    s_mov_b32 s58, 0xffff0000
    v_mov_b32 v40, v20
    v_lshl_or_b32 v41, v21, 16, v60
    v_or_b32 v42, v61, v16
    v_mov_b32 v43, v28
    v_alignbit_b32 v44, v22, v21, 16
    v_and_or_b32 v45, v22, s58, v60
    v_or_b32 v46, v61, v17
    v_mov_b32 v47, v29
    v_mov_b32 v48, v23
    v_lshl_or_b32 v49, v24, 16, v60
    v_or_b32 v50, v61, v18
    v_mov_b32 v51, v30
    v_alignbit_b32 v52, v25, v24, 16
    v_and_or_b32 v53, v25, s58, v60
    v_or_b32 v54, v61, v19
    v_mov_b32 v55, v31
    s_waitcnt lgkmcnt(0)
    v_add_lshl_u32 v32, v32, v36, 4
    ds_write_b128 v32, v[40:43] offset:2048
    v_add_lshl_u32 v33, v33, v37, 4
    ds_write_b128 v33, v[44:47] offset:2048
    v_add_lshl_u32 v34, v34, v38, 4
    ds_write_b128 v34, v[48:51] offset:2048
    v_add_lshl_u32 v35, v35, v39, 4
    ds_write_b128 v35, v[52:55] offset:2048
    s_waitcnt lgkmcnt(0)
    s_barrier
    ds_read_b128 v[12:15], v5 offset:2048
    ds_read_b128 v[16:19], v5 offset:7168
    ds_read_b128 v[20:23], v5 offset:12288
    ds_read_b128 v[24:27], v5 offset:17408
    s_waitcnt lgkmcnt(3)
    buffer_store_dwordx4 v[12:15], v5, s[8:11], s64 offen sc1
    s_add_u32 s64, s64, 5120
    s_waitcnt lgkmcnt(2)
    buffer_store_dwordx4 v[16:19], v5, s[8:11], s64 offen sc1
    s_add_u32 s64, s64, 5120
    s_waitcnt lgkmcnt(1)
    buffer_store_dwordx4 v[20:23], v5, s[8:11], s64 offen sc1
    s_add_u32 s64, s64, 5120
    s_waitcnt lgkmcnt(0)
    buffer_store_dwordx4 v[24:27], v5, s[8:11], s64 offen sc1
    s_branch KS_JOIN
KS_IDLE:
    s_barrier
    v_mul_u32_u24 v76, 2979, v0
    v_lshrrev_b32 v76, 16, v76
    v_mul_u32_u24 v77, 2048, v76
    v_lshl_add_u32 v78, v0, 4, v77
    v_add_u32 v78, 67584, v78
    v_add_u32 v79, 67200, v78
    v_mov_b32 v80, -1
    v_mov_b32 v81, -1
    v_cmp_gt_u32 vcc, 14, v76
    v_cmp_gt_u32 s[56:57], 12, v76
    v_mov_b32 v82, -1
    v_mov_b32 v83, -1
    s_mov_b64 exec, vcc
    ds_write_b128 v78, v[80:83]
    ds_write_b128 v78, v[80:83] offset:33600
    s_mov_b64 exec, s[56:57]
    ds_write_b128 v79, v[80:83]
    s_mov_b64 exec, -1
    s_mov_b32 s4, s80
    s_and_b32 s5, s81, 0xffff
    s_mov_b32 s6, 10240000
    s_mov_b32 s7, 0x20000
    s_mov_b32 s12, s96
    s_and_b32 s13, s97, 0xffff
    s_mov_b32 s14, 10240000
    s_mov_b32 s15, 0x20000
    s_mov_b32 s16, s84
    s_and_b32 s17, s85, 0xffff
    s_mov_b32 s18, 10240000
    s_mov_b32 s19, 0x20000
    s_sub_u32 s80, s80, 1024
    s_subb_u32 s81, s81, 0
    s_mov_b32 s72, s80
    s_and_b32 s73, s81, 0xffff
    s_mov_b32 s74, 10241024
    s_mov_b32 s75, 0x20000
    s_barrier
    s_branch KS_B3
KS_HELP:
    s_cmp_eq_u32 s20, 7
    s_cbranch_scc1 KS_TAG
    s_cmp_eq_u32 s20, 6
    s_cbranch_scc1 KS_RAW
    s_cmp_ge_u32 s2, 200
    s_cbranch_scc1 KS_NOW
    v_and_b32 v1, 15, v8
    v_lshrrev_b32 v3, 4, v8
    s_cmp_ge_u32 s2, 160
    s_cbranch_scc1 K1_WT
    s_cmp_ge_u32 s2, 64
    s_cbranch_scc1 K1_S1
    s_lshr_b32 s24, s2, 3
    s_and_b32 s25, s2, 7
    s_lshr_b32 s26, s25, 2
    s_bfe_u32 s27, s25, 0x10001
    s_and_b32 s28, s25, 1
    s_mov_b32 s60, s92
    s_and_b32 s61, s93, 0xffff
    s_mov_b32 s62, 65536
    s_mov_b32 s63, 0x20000
    s_branch K1_SC
K1_S1:
    s_sub_u32 s29, s2, 64
    s_mul_i32 s24, s29, 43
    s_lshr_b32 s24, s24, 9
    s_mul_i32 s25, s24, 12
    s_sub_u32 s25, s29, s25
    s_cmp_ge_u32 s25, 6
    s_cselect_b32 s26, 1, 0
    s_mul_i32 s27, s26, 6
    s_sub_u32 s27, s25, s27
    s_lshr_b32 s27, s27, 1
    s_and_b32 s28, s25, 1
    s_add_u32 s25, s25, 8
    s_mov_b32 s60, s94
    s_and_b32 s61, s95, 0xffff
    s_mov_b32 s62, 98304
    s_mov_b32 s63, 0x20000
K1_SC:
    s_lshl_b32 s27, s27, 7
    s_lshl_b32 s26, s26, 6
    s_lshl_b32 s28, s28, 4
    s_add_u32 s27, s27, s26
    s_add_u32 s27, s27, s28
    s_lshl_b32 s27, s27, 8
    s_lshl_b32 s26, s24, 5
    s_add_u32 s27, s27, s26
    s_add_u32 s29, s27, 8192
    v_lshlrev_b32 v3, 10, v3
    v_lshl_add_u32 v3, v1, 1, v3
    buffer_load_ushort v64, v3, s[60:63], s27 offen offset:0
    buffer_load_ushort v65, v3, s[60:63], s29 offen offset:0
    buffer_load_ushort v66, v3, s[60:63], s27 offen offset:256
    buffer_load_ushort v67, v3, s[60:63], s29 offen offset:256
    buffer_load_ushort v68, v3, s[60:63], s27 offen offset:512
    buffer_load_ushort v69, v3, s[60:63], s29 offen offset:512
    buffer_load_ushort v70, v3, s[60:63], s27 offen offset:768
    buffer_load_ushort v71, v3, s[60:63], s29 offen offset:768
    s_mul_i32 s24, s24, 20
    s_add_u32 s24, s24, s25
    s_lshl_b32 s24, s24, 10
    s_add_u32 s24, s24, 6946816
    s_branch K1_GO
K1_WT:
    s_sub_u32 s24, s2, 160
    s_cmp_ge_u32 s24, 20
    s_cselect_b32 s26, 1, 0
    s_mul_i32 s25, s26, 20
    s_sub_u32 s25, s24, s25
    s_lshr_b32 s27, s25, 2
    s_bfe_u32 s28, s25, 0x10001
    s_and_b32 s25, s25, 1
    s_mul_i32 s25, s25, 10240
    s_lshl_b32 s27, s27, 8
    s_lshl_b32 s26, s26, 7
    s_lshl_b32 s28, s28, 6
    s_add_u32 s27, s27, s26
    s_add_u32 s27, s27, s28
    s_add_u32 s27, s27, s25
    s_mov_b32 s60, s90
    s_and_b32 s61, s91, 0xffff
    s_mov_b32 s62, 20480
    s_mov_b32 s63, 0x20000
    v_and_b32 v1, 31, v8
    v_lshrrev_b32 v3, 5, v8
    v_mul_u32_u24 v3, 5120, v3
    v_lshl_add_u32 v3, v1, 1, v3
    v_mov_b32 v64, 0
    v_mov_b32 v66, 0
    v_mov_b32 v68, 0
    v_mov_b32 v70, 0
    buffer_load_ushort v65, v3, s[60:63], s27 offen offset:0
    buffer_load_ushort v67, v3, s[60:63], s27 offen offset:1280
    buffer_load_ushort v69, v3, s[60:63], s27 offen offset:2560
    buffer_load_ushort v71, v3, s[60:63], s27 offen offset:3840
    s_lshl_b32 s24, s24, 10
    s_add_u32 s24, s24, 7110656
K1_GO:
    s_barrier
    v_subrev_u32 v76, 320, v0
    v_mov_b32 v80, -1
    v_mov_b32 v77, 1.0
    v_cmp_gt_u32 vcc, 48, v76
    v_lshlrev_b32 v78, 4, v76
    v_add_u32 v78, 65536, v78
    v_cndmask_b32 v80, v80, 0, vcc
    v_cmp_gt_u32 vcc, 12, v76
    v_add_u32 v79, 64800, v78
    s_nop 0
    v_cndmask_b32 v80, v80, v77, vcc
    v_cmp_gt_u32 s[56:57], 54, v8
    v_mov_b32 v81, v80
    v_mov_b32 v82, v80
    v_mov_b32 v83, v80
    ds_write_b128 v78, v[80:83] offset:0
    ds_write_b128 v78, v[80:83] offset:2400
    ds_write_b128 v78, v[80:83] offset:4800
    ds_write_b128 v78, v[80:83] offset:7200
    ds_write_b128 v78, v[80:83] offset:9600
    ds_write_b128 v78, v[80:83] offset:12000
    ds_write_b128 v78, v[80:83] offset:14400
    ds_write_b128 v78, v[80:83] offset:16800
    ds_write_b128 v78, v[80:83] offset:19200
    ds_write_b128 v78, v[80:83] offset:21600
    ds_write_b128 v78, v[80:83] offset:24000
    ds_write_b128 v78, v[80:83] offset:26400
    ds_write_b128 v78, v[80:83] offset:28800
    ds_write_b128 v78, v[80:83] offset:31200
    ds_write_b128 v78, v[80:83] offset:33600
    ds_write_b128 v78, v[80:83] offset:36000
    ds_write_b128 v78, v[80:83] offset:38400
    ds_write_b128 v78, v[80:83] offset:40800
    ds_write_b128 v78, v[80:83] offset:43200
    ds_write_b128 v78, v[80:83] offset:45600
    ds_write_b128 v78, v[80:83] offset:48000
    ds_write_b128 v78, v[80:83] offset:50400
    ds_write_b128 v78, v[80:83] offset:52800
    ds_write_b128 v78, v[80:83] offset:55200
    ds_write_b128 v78, v[80:83] offset:57600
    ds_write_b128 v78, v[80:83] offset:60000
    ds_write_b128 v78, v[80:83] offset:62400
    ds_write_b128 v79, v[80:83] offset:0
    ds_write_b128 v79, v[80:83] offset:2400
    ds_write_b128 v79, v[80:83] offset:4800
    ds_write_b128 v79, v[80:83] offset:7200
    ds_write_b128 v79, v[80:83] offset:9600
    ds_write_b128 v79, v[80:83] offset:12000
    ds_write_b128 v79, v[80:83] offset:14400
    ds_write_b128 v79, v[80:83] offset:16800
    ds_write_b128 v79, v[80:83] offset:19200
    ds_write_b128 v79, v[80:83] offset:21600
    ds_write_b128 v79, v[80:83] offset:24000
    ds_write_b128 v79, v[80:83] offset:26400
    ds_write_b128 v79, v[80:83] offset:28800
    v_mov_b32 v59, 163728
    s_barrier
    ds_read_b32 v59, v59
    s_cmp_eq_u32 s20, 6
    s_cselect_b64 exec, s[56:57], -1
    ds_write_b128 v79, v[80:83] offset:31200
    s_mov_b64 exec, -1
    s_mov_b32 s4, s80
    s_and_b32 s5, s81, 0xffff
    s_mov_b32 s6, 10240000
    s_mov_b32 s7, 0x20000
    s_mov_b32 s12, s96
    s_and_b32 s13, s97, 0xffff
    s_mov_b32 s14, 10240000
    s_mov_b32 s15, 0x20000
    s_mov_b32 s16, s84
    s_and_b32 s17, s85, 0xffff
    s_mov_b32 s18, 10240000
    s_mov_b32 s19, 0x20000
    s_sub_u32 s80, s80, 1024
    s_subb_u32 s81, s81, 0
    s_mov_b32 s72, s80
    s_and_b32 s73, s81, 0xffff
    s_mov_b32 s74, 10241024
    s_mov_b32 s75, 0x20000
    s_waitcnt vmcnt(0)
    v_lshl_or_b32 v40, v65, 16, v64
    v_lshl_or_b32 v41, v67, 16, v66
    v_lshl_or_b32 v42, v69, 16, v68
    v_lshl_or_b32 v43, v71, 16, v70
    buffer_store_dwordx4 v[40:43], v9, s[8:11], s24 offen sc1
    s_waitcnt lgkmcnt(0)
    s_barrier
    s_lshl_b32 s24, s2, 2
    s_add_u32 s24, s24, 7176192
    s_mov_b64 exec, 1
    s_waitcnt vmcnt(0)
    buffer_store_dword v59, v6, s[8:11], s24 offen sc1
    s_mov_b64 exec, -1
    s_branch KS_JOIN
KS_RAW:
    s_barrier
    s_mov_b32 s60, s90
    s_and_b32 s61, s91, 0xffff
    s_mov_b32 s62, 20480
    s_mov_b32 s63, 0x20000
    s_mov_b32 m0, 24576
    s_movk_i32 s24, 0
    buffer_load_dwordx4 v9, s[60:63], s24 offen offset:0 lds
    buffer_load_dwordx4 v9, s[60:63], s24 offen offset:1024 lds
    buffer_load_dwordx4 v9, s[60:63], s24 offen offset:2048 lds
    buffer_load_dwordx4 v9, s[60:63], s24 offen offset:3072 lds
    s_mov_b32 m0, 28672
    s_movk_i32 s24, 4096
    buffer_load_dwordx4 v9, s[60:63], s24 offen offset:0 lds
    buffer_load_dwordx4 v9, s[60:63], s24 offen offset:1024 lds
    buffer_load_dwordx4 v9, s[60:63], s24 offen offset:2048 lds
    buffer_load_dwordx4 v9, s[60:63], s24 offen offset:3072 lds
    s_mov_b32 m0, 32768
    s_movk_i32 s24, 8192
    buffer_load_dwordx4 v9, s[60:63], s24 offen offset:0 lds
    buffer_load_dwordx4 v9, s[60:63], s24 offen offset:1024 lds
    buffer_load_dwordx4 v9, s[60:63], s24 offen offset:2048 lds
    buffer_load_dwordx4 v9, s[60:63], s24 offen offset:3072 lds
    s_mov_b32 m0, 36864
    s_movk_i32 s24, 12288
    buffer_load_dwordx4 v9, s[60:63], s24 offen offset:0 lds
    buffer_load_dwordx4 v9, s[60:63], s24 offen offset:1024 lds
    buffer_load_dwordx4 v9, s[60:63], s24 offen offset:2048 lds
    buffer_load_dwordx4 v9, s[60:63], s24 offen offset:3072 lds
    s_mov_b32 m0, 40960
    s_movk_i32 s24, 16384
    buffer_load_dwordx4 v9, s[60:63], s24 offen offset:0 lds
    buffer_load_dwordx4 v9, s[60:63], s24 offen offset:1024 lds
    buffer_load_dwordx4 v9, s[60:63], s24 offen offset:2048 lds
    buffer_load_dwordx4 v9, s[60:63], s24 offen offset:3072 lds
    s_branch KS_FILL
KS_NOW:
    s_barrier
KS_FILL:
    v_subrev_u32 v76, 320, v0
    v_mov_b32 v80, -1
    v_mov_b32 v77, 1.0
    v_cmp_gt_u32 vcc, 48, v76
    v_lshlrev_b32 v78, 4, v76
    v_add_u32 v78, 65536, v78
    v_cndmask_b32 v80, v80, 0, vcc
    v_cmp_gt_u32 vcc, 12, v76
    v_add_u32 v79, 64800, v78
    s_nop 0
    v_cndmask_b32 v80, v80, v77, vcc
    v_cmp_gt_u32 s[56:57], 54, v8
    v_mov_b32 v81, v80
    v_mov_b32 v82, v80
    v_mov_b32 v83, v80
    ds_write_b128 v78, v[80:83] offset:0
    ds_write_b128 v78, v[80:83] offset:2400
    ds_write_b128 v78, v[80:83] offset:4800
    ds_write_b128 v78, v[80:83] offset:7200
    ds_write_b128 v78, v[80:83] offset:9600
    ds_write_b128 v78, v[80:83] offset:12000
    ds_write_b128 v78, v[80:83] offset:14400
    ds_write_b128 v78, v[80:83] offset:16800
    ds_write_b128 v78, v[80:83] offset:19200
    ds_write_b128 v78, v[80:83] offset:21600
    ds_write_b128 v78, v[80:83] offset:24000
    ds_write_b128 v78, v[80:83] offset:26400
    ds_write_b128 v78, v[80:83] offset:28800
    ds_write_b128 v78, v[80:83] offset:31200
    ds_write_b128 v78, v[80:83] offset:33600
    ds_write_b128 v78, v[80:83] offset:36000
    ds_write_b128 v78, v[80:83] offset:38400
    ds_write_b128 v78, v[80:83] offset:40800
    ds_write_b128 v78, v[80:83] offset:43200
    ds_write_b128 v78, v[80:83] offset:45600
    ds_write_b128 v78, v[80:83] offset:48000
    ds_write_b128 v78, v[80:83] offset:50400
    ds_write_b128 v78, v[80:83] offset:52800
    ds_write_b128 v78, v[80:83] offset:55200
    ds_write_b128 v78, v[80:83] offset:57600
    ds_write_b128 v78, v[80:83] offset:60000
    ds_write_b128 v78, v[80:83] offset:62400
    ds_write_b128 v79, v[80:83] offset:0
    ds_write_b128 v79, v[80:83] offset:2400
    ds_write_b128 v79, v[80:83] offset:4800
    ds_write_b128 v79, v[80:83] offset:7200
    ds_write_b128 v79, v[80:83] offset:9600
    ds_write_b128 v79, v[80:83] offset:12000
    ds_write_b128 v79, v[80:83] offset:14400
    ds_write_b128 v79, v[80:83] offset:16800
    ds_write_b128 v79, v[80:83] offset:19200
    ds_write_b128 v79, v[80:83] offset:21600
    ds_write_b128 v79, v[80:83] offset:24000
    ds_write_b128 v79, v[80:83] offset:26400
    ds_write_b128 v79, v[80:83] offset:28800
    s_barrier
    s_cmp_eq_u32 s20, 6
    s_cselect_b64 exec, s[56:57], -1
    ds_write_b128 v79, v[80:83] offset:31200
    s_mov_b64 exec, -1
    s_mov_b32 s4, s80
    s_and_b32 s5, s81, 0xffff
    s_mov_b32 s6, 10240000
    s_mov_b32 s7, 0x20000
    s_mov_b32 s12, s96
    s_and_b32 s13, s97, 0xffff
    s_mov_b32 s14, 10240000
    s_mov_b32 s15, 0x20000
    s_mov_b32 s16, s84
    s_and_b32 s17, s85, 0xffff
    s_mov_b32 s18, 10240000
    s_mov_b32 s19, 0x20000
    s_sub_u32 s80, s80, 1024
    s_subb_u32 s81, s81, 0
    s_mov_b32 s72, s80
    s_and_b32 s73, s81, 0xffff
    s_mov_b32 s74, 10241024
    s_mov_b32 s75, 0x20000
    s_waitcnt vmcnt(0)
    s_branch KS_B3
KS_TAG:
    s_mov_b32 s60, s98
    s_and_b32 s61, s99, 0xffff
    s_mov_b32 s62, 256
    s_mov_b32 s63, 0x20000
    s_cmp_lg_u32 s2, 0
    s_cbranch_scc1 KS_TAGLD
    s_or_b32 s24, s74, 1
    v_mov_b32 v10, s24
    v_mov_b32 v11, 0
    s_mov_b64 exec, 1
    buffer_atomic_cmpswap v[10:11], v6, s[60:63], 0 offen sc1
KS_TAGLD:
    s_mov_b64 exec, 1
    v_mov_b32 v14, 0
    s_mov_b64 exec, -1
    s_barrier
    v_mov_b32 v76, 0
    v_mov_b32 v77, -1
    v_lshlrev_b32 v78, 2, v8
    v_add_u32 v78, 163424, v78
    s_mov_b64 exec, 0x1ff
    ds_write_b32 v78, v76 offset:192
    s_mov_b64 exec, 0xff
    ds_write_b32 v78, v77 offset:256
    s_mov_b64 exec, -1
    s_mov_b32 exec_hi, 0xffff
    ds_write_b32 v78, v76
    s_mov_b64 exec, 1
    ds_write_b32 v78, v76 offset:228
    s_mov_b64 exec, -1
    s_mov_b32 s4, s80
    s_and_b32 s5, s81, 0xffff
    s_mov_b32 s6, 10240000
    s_mov_b32 s7, 0x20000
    s_mov_b32 s12, s96
    s_and_b32 s13, s97, 0xffff
    s_mov_b32 s14, 10240000
    s_mov_b32 s15, 0x20000
    s_mov_b32 s16, s84
    s_and_b32 s17, s85, 0xffff
    s_mov_b32 s18, 10240000
    s_mov_b32 s19, 0x20000
    s_sub_u32 s80, s80, 1024
    s_subb_u32 s81, s81, 0
    s_mov_b32 s72, s80
    s_and_b32 s73, s81, 0xffff
    s_mov_b32 s74, 10241024
    s_mov_b32 s75, 0x20000
    s_mov_b64 exec, 1
    s_mov_b32 s24, 0x100000
    v_mov_b32 v12, 163728
KS_TAGW:
    buffer_load_dword v15, v6, s[60:63], 0 offen sc1
    s_waitcnt vmcnt(1)
    v_cmp_ne_u32 vcc, 0, v14
    s_nop 0
    s_cbranch_vccnz KS_TAGOK
    s_sub_u32 s24, s24, 1
    s_cbranch_scc1 K2_END
    buffer_load_dword v14, v6, s[60:63], 0 offen sc1
    s_waitcnt vmcnt(1)
    v_cmp_ne_u32 vcc, 0, v15
    s_nop 0
    s_cbranch_vccz KS_TAGW
    ds_write_b32 v12, v15
    s_branch KS_TAGOK2
KS_TAGOK:
    ds_write_b32 v12, v14
KS_TAGOK2:
    s_mov_b64 exec, -1
    s_waitcnt lgkmcnt(0)
    s_barrier
KS_B3:
    v_mov_b32 v59, 163728
    ds_read_b32 v59, v59
    s_waitcnt lgkmcnt(0)
    s_barrier
KS_JOIN:
    v_readfirstlane_b32 s2, v59
    s_mov_b32 s23, 0
    s_mov_b32 s28, 1
    s_mov_b32 s24, 0
    s_mov_b32 s25, 1
K2_CELLS:
    v_lshrrev_b32 v178, 1, v177
    v_min_u32 v178, 249, v178
    v_mul_u32_u24 v72, 1152, v178
    s_and_b32 s58, s54, 7
    s_lshl_b32 s58, s58, 7
    s_lshr_b32 s59, s54, 5
    s_lshl_b32 s59, s59, 4
    s_add_u32 s67, s58, s59
    s_add_u32 s67, s67, 6291456
    buffer_load_dwordx4 v[76:79], v72, s[8:11], s67 offen sc1
    v_and_b32 v84, 15, v176
    v_lshrrev_b32 v85, 5, v176
    v_bfe_u32 v86, v176, 4, 1
    v_lshrrev_b32 v87, 2, v84
    v_and_b32 v88, 3, v84
    v_lshl_add_u32 v89, v85, 3, v87
    v_lshlrev_b32 v249, 5, v89
    v_lshl_add_u32 v249, v88, 3, v249
    v_add_u32 v249, 864, v249
    v_mul_u32_u24 v250, 192, v86
    v_lshl_add_u32 v250, v85, 5, v250
    v_lshrrev_b32 v90, 1, v88
    v_lshl_add_u32 v90, v86, 1, v90
    v_bfe_u32 v91, v87, 1, 1
    v_lshlrev_b32 v91, 2, v91
    v_xor_b32 v90, v90, v91
    v_lshlrev_b32 v90, 4, v90
    v_lshl_add_u32 v90, v89, 7, v90
    v_and_b32 v91, 1, v88
    v_lshl_add_u32 v90, v91, 3, v90
    v_add_u32 v246, s37, v90
    v_xor_b32 v247, 64, v246
    v_lshrrev_b32 v90, 3, v176
    v_lshlrev_b32 v251, 2, v90
    v_add_u32 v251, 768, v251
    v_bfe_u32 v90, v90, 1, 1
    v_lshlrev_b32 v90, 2, v90
    v_and_b32 v91, 7, v176
    v_xor_b32 v90, v90, v91
    v_lshlrev_b32 v248, 4, v90
    v_lshlrev_b32 v252, 1, v176
    v_and_b32 v231, 1, v176
    v_lshlrev_b32 v231, 4, v231
    v_lshrrev_b32 v90, 1, v176
    v_lshlrev_b32 v90, 5, v90
    v_add_u32 v230, 864, v90
    s_lshl_b32 s59, s2, 22
    s_mov_b32 s60, 0x100000
    s_bfe_u32 s61, s54, 0x10004
    s_bfe_u32 s62, s54, 0x10003
    s_add_u32 s63, s61, s62
    s_mul_i32 s62, s62, 11
    s_sub_u32 s64, 11, s62
    v_cmp_gt_u32 vcc, 500, v177
    s_nop 0
    s_mov_b64 s[56:57], vcc
K2_POLL:
    s_waitcnt vmcnt(0)
    v_xor_b32 v73, s59, v76
    v_xor_b32 v74, s59, v77
    v_or_b32 v73, v73, v74
    v_xor_b32 v74, s2, v79
    v_lshrrev_b32 v73, 22, v73
    v_or_b32 v73, v73, v74
    v_cmp_ne_u32 vcc, 0, v73
    s_nop 0
    s_cbranch_vccz K2_POLLED
    s_sub_u32 s60, s60, 1
    s_cbranch_scc1 K2_END
    s_mov_b64 exec, vcc
    buffer_load_dwordx4 v[76:79], v72, s[8:11], s67 offen sc1
    s_mov_b64 exec, -1
    s_branch K2_POLL
K2_POLLED:
    s_set_gpr_idx_on s61, gpr_idx(SRC0)
    s_nop 0
    v_bfe_u32 v179, v76, s62, 11
    s_set_gpr_idx_idx s63
    s_nop 0
    v_bfe_u32 v73, v76, s64, 11
    s_set_gpr_idx_off
    v_sub_u32 v73, v73, v179
    v_cndmask_b32 v73, 0, v73, s[56:57]
    v_and_b32 v1, 1, v177
    v_add_u32 v1, s23, v1
    v_sub_u32 v180, v73, v1
    v_add_u32 v179, v179, v1
    v_mul_u32_u24 v181, 20608, v178
    v_lshl_add_u32 v181, v179, 4, v181
    v_cmp_lt_i32 s[40:41], 0, v180
    v_cmp_lt_i32 s[42:43], 2, v180
    v_cmp_lt_i32 s[44:45], 4, v180
    v_cmp_lt_i32 s[46:47], 6, v180
    v_cmp_lt_i32 s[48:49], 8, v180
    v_cmp_lt_i32 s[50:51], 10, v180
    v_cmp_lt_i32 s[90:91], 12, v180
    v_cmp_lt_i32 s[92:93], 14, v180
    v_cmp_lt_i32 s[94:95], 16, v180
    v_cmp_lt_i32 s[96:97], 18, v180
    s_mov_b64 exec, s[40:41]
    s_cbranch_execz K2_LD_DONE
    buffer_load_dwordx4 v[0:3], v181, s[8:11], 0 offen offset:0 sc1
    s_mov_b64 exec, s[42:43]
    s_cbranch_execz K2_LD_DONE
    buffer_load_dwordx4 v[4:7], v181, s[8:11], 0 offen offset:32 sc1
    s_mov_b64 exec, s[44:45]
    s_cbranch_execz K2_LD_DONE
    buffer_load_dwordx4 v[8:11], v181, s[8:11], 0 offen offset:64 sc1
    s_mov_b64 exec, s[46:47]
    s_cbranch_execz K2_LD_DONE
    buffer_load_dwordx4 v[12:15], v181, s[8:11], 0 offen offset:96 sc1
    s_mov_b64 exec, s[48:49]
    s_cbranch_execz K2_LD_DONE
    buffer_load_dwordx4 v[16:19], v181, s[8:11], 0 offen offset:128 sc1
    s_mov_b64 exec, s[50:51]
    s_cbranch_execz K2_LD_DONE
    buffer_load_dwordx4 v[20:23], v181, s[8:11], 0 offen offset:160 sc1
    s_mov_b64 exec, s[90:91]
    s_cbranch_execz K2_LD_DONE
    buffer_load_dwordx4 v[24:27], v181, s[8:11], 0 offen offset:192 sc1
    s_mov_b64 exec, s[92:93]
    s_cbranch_execz K2_LD_DONE
    buffer_load_dwordx4 v[28:31], v181, s[8:11], 0 offen offset:224 sc1
    s_mov_b64 exec, s[94:95]
    s_cbranch_execz K2_LD_DONE
    buffer_load_dwordx4 v[32:35], v181, s[8:11], 0 offen offset:256 sc1
    s_mov_b64 exec, s[96:97]
    s_cbranch_execz K2_LD_DONE
    buffer_load_dwordx4 v[36:39], v181, s[8:11], 0 offen offset:288 sc1
K2_LD_DONE:
    s_mov_b64 exec, -1
    s_cmp_eq_u32 s28, 0
    s_cbranch_scc1 K2_NOWRAW
    v_lshrrev_b32 v60, 5, v176
    v_bfe_u32 v61, v176, 2, 2
    v_lshl_add_u32 v60, v60, 2, v61
    v_mul_u32_u24 v60, 1280, v60
    v_bfe_u32 v61, v176, 4, 1
    v_lshl_add_u32 v60, v61, 5, v60
    v_and_b32 v61, 3, v176
    v_lshl_add_u32 v60, v61, 3, v60
    ds_read_b64_tr_b16 v[136:137], v60 offset:24576
    ds_read_b64_tr_b16 v[138:139], v60 offset:34816
    ds_read_b64_tr_b16 v[140:141], v60 offset:24640
    ds_read_b64_tr_b16 v[142:143], v60 offset:34880
    ds_read_b64_tr_b16 v[144:145], v60 offset:24832
    ds_read_b64_tr_b16 v[146:147], v60 offset:35072
    ds_read_b64_tr_b16 v[148:149], v60 offset:24896
    ds_read_b64_tr_b16 v[150:151], v60 offset:35136
    ds_read_b64_tr_b16 v[152:153], v60 offset:25088
    ds_read_b64_tr_b16 v[154:155], v60 offset:35328
    ds_read_b64_tr_b16 v[156:157], v60 offset:25152
    ds_read_b64_tr_b16 v[158:159], v60 offset:35392
    ds_read_b64_tr_b16 v[160:161], v60 offset:25344
    ds_read_b64_tr_b16 v[162:163], v60 offset:35584
    ds_read_b64_tr_b16 v[164:165], v60 offset:25408
    ds_read_b64_tr_b16 v[166:167], v60 offset:35648
    ds_read_b64_tr_b16 v[168:169], v60 offset:25600
    ds_read_b64_tr_b16 v[170:171], v60 offset:35840
    ds_read_b64_tr_b16 v[172:173], v60 offset:25664
    ds_read_b64_tr_b16 v[174:175], v60 offset:35904
    s_waitcnt lgkmcnt(0)
    v_lshlrev_b32 v96, 16, v136
    v_and_b32 v97, 0xffff0000, v136
    v_lshlrev_b32 v98, 16, v137
    v_and_b32 v99, 0xffff0000, v137
    v_lshlrev_b32 v100, 16, v138
    v_and_b32 v101, 0xffff0000, v138
    v_lshlrev_b32 v102, 16, v139
    v_and_b32 v103, 0xffff0000, v139
    v_lshlrev_b32 v104, 16, v140
    v_and_b32 v105, 0xffff0000, v140
    v_lshlrev_b32 v106, 16, v141
    v_and_b32 v107, 0xffff0000, v141
    v_lshlrev_b32 v108, 16, v142
    v_and_b32 v109, 0xffff0000, v142
    v_lshlrev_b32 v110, 16, v143
    v_and_b32 v111, 0xffff0000, v143
    v_lshlrev_b32 v112, 16, v144
    v_and_b32 v113, 0xffff0000, v144
    v_lshlrev_b32 v114, 16, v145
    v_and_b32 v115, 0xffff0000, v145
    v_lshlrev_b32 v116, 16, v146
    v_and_b32 v117, 0xffff0000, v146
    v_lshlrev_b32 v118, 16, v147
    v_and_b32 v119, 0xffff0000, v147
    v_lshlrev_b32 v120, 16, v148
    v_and_b32 v121, 0xffff0000, v148
    v_lshlrev_b32 v122, 16, v149
    v_and_b32 v123, 0xffff0000, v149
    v_lshlrev_b32 v124, 16, v150
    v_and_b32 v125, 0xffff0000, v150
    v_lshlrev_b32 v126, 16, v151
    v_and_b32 v127, 0xffff0000, v151
    v_lshlrev_b32 v128, 16, v152
    v_and_b32 v129, 0xffff0000, v152
    v_lshlrev_b32 v130, 16, v153
    v_and_b32 v131, 0xffff0000, v153
    v_lshlrev_b32 v132, 16, v154
    v_and_b32 v133, 0xffff0000, v154
    v_lshlrev_b32 v134, 16, v155
    v_and_b32 v135, 0xffff0000, v155
    v_lshlrev_b32 v136, 16, v156
    v_and_b32 v137, 0xffff0000, v156
    v_lshlrev_b32 v138, 16, v157
    v_and_b32 v139, 0xffff0000, v157
    v_lshlrev_b32 v140, 16, v158
    v_and_b32 v141, 0xffff0000, v158
    v_lshlrev_b32 v142, 16, v159
    v_and_b32 v143, 0xffff0000, v159
    v_lshlrev_b32 v144, 16, v160
    v_and_b32 v145, 0xffff0000, v160
    v_lshlrev_b32 v146, 16, v161
    v_and_b32 v147, 0xffff0000, v161
    v_lshlrev_b32 v148, 16, v162
    v_and_b32 v149, 0xffff0000, v162
    v_lshlrev_b32 v150, 16, v163
    v_and_b32 v151, 0xffff0000, v163
    v_lshlrev_b32 v152, 16, v164
    v_and_b32 v153, 0xffff0000, v164
    v_lshlrev_b32 v154, 16, v165
    v_and_b32 v155, 0xffff0000, v165
    v_lshlrev_b32 v156, 16, v166
    v_and_b32 v157, 0xffff0000, v166
    v_lshlrev_b32 v158, 16, v167
    v_and_b32 v159, 0xffff0000, v167
    v_lshlrev_b32 v160, 16, v168
    v_and_b32 v161, 0xffff0000, v168
    v_lshlrev_b32 v162, 16, v169
    v_and_b32 v163, 0xffff0000, v169
    v_lshlrev_b32 v164, 16, v170
    v_and_b32 v165, 0xffff0000, v170
    v_lshlrev_b32 v166, 16, v171
    v_and_b32 v167, 0xffff0000, v171
    v_lshlrev_b32 v168, 16, v172
    v_and_b32 v169, 0xffff0000, v172
    v_lshlrev_b32 v170, 16, v173
    v_and_b32 v171, 0xffff0000, v173
    v_lshlrev_b32 v172, 16, v174
    v_and_b32 v173, 0xffff0000, v174
    v_lshlrev_b32 v174, 16, v175
    v_and_b32 v175, 0xffff0000, v175
K2_NOWRAW:
    v_mul_u32_u24 v178, 1280, v178
    v_add_lshl_u32 v179, v179, v178, 2
    s_mov_b32 s66, 7340032
    v_mov_b32 v201, 1
    s_movk_i32 s58, 600
    s_movk_i32 s59, 2400
    s_mov_b32 s60, 0x100000
    s_mov_b32 s61, 0xffff
    v_mov_b32 v202, 65536
    s_cmp_lg_u32 s24, 0
    s_cbranch_scc1 K2_RK_LOAD
    v_cmp_lt_i32 vcc, 20, v180
    s_nop 0
    s_cbranch_vccz K2_NOMORE
    v_mov_b32 v61, 163652
    ds_write_b32 v61, v201
K2_NOMORE:
    v_lshlrev_b32 v72, 4, v176
    s_mov_b32 s64, 7176192
    s_mov_b32 s62, 84736
    s_cmp_eq_u32 s20, 7
    s_waitcnt vmcnt(0)
    s_cbranch_scc1 K2_FLGLD
K2_FLGL2:
    s_mov_b64 exec, s[40:41]
    s_cbranch_execz K2_RK_A
K2_CK0:
    v_bfi_b32 v192, s61, v1, v2
    v_lshrrev_b32 v50, 24, v3
    v_cmp_ne_u32 vcc, s2, v192
    v_add_u32 v40, 163424, v50
    s_cbranch_vccnz K2_RT0
    ds_add_rtn_u32 v40, v40, v201
    v_mad_u32_u24 v50, v50, s58, v202
    s_mov_b64 exec, s[42:43]
    s_cbranch_execz K2_RK_A
K2_CK1:
    v_bfi_b32 v192, s61, v5, v6
    v_lshrrev_b32 v51, 24, v7
    v_cmp_ne_u32 vcc, s2, v192
    v_add_u32 v41, 163424, v51
    s_cbranch_vccnz K2_RT1
    ds_add_rtn_u32 v41, v41, v201
    v_mad_u32_u24 v51, v51, s58, v202
    s_mov_b64 exec, s[44:45]
    s_cbranch_execz K2_RK_A
K2_CK2:
    v_bfi_b32 v192, s61, v9, v10
    v_lshrrev_b32 v52, 24, v11
    v_cmp_ne_u32 vcc, s2, v192
    v_add_u32 v42, 163424, v52
    s_cbranch_vccnz K2_RT2
    ds_add_rtn_u32 v42, v42, v201
    v_mad_u32_u24 v52, v52, s58, v202
    s_mov_b64 exec, s[46:47]
    s_cbranch_execz K2_RK_A
K2_CK3:
    v_bfi_b32 v192, s61, v13, v14
    v_lshrrev_b32 v53, 24, v15
    v_cmp_ne_u32 vcc, s2, v192
    v_add_u32 v43, 163424, v53
    s_cbranch_vccnz K2_RT3
    ds_add_rtn_u32 v43, v43, v201
    v_mad_u32_u24 v53, v53, s58, v202
    s_mov_b64 exec, s[48:49]
    s_cbranch_execz K2_RK_A
K2_CK4:
    v_bfi_b32 v192, s61, v17, v18
    v_lshrrev_b32 v54, 24, v19
    v_cmp_ne_u32 vcc, s2, v192
    v_add_u32 v44, 163424, v54
    s_cbranch_vccnz K2_RT4
    ds_add_rtn_u32 v44, v44, v201
    v_mad_u32_u24 v54, v54, s58, v202
    s_mov_b64 exec, s[50:51]
    s_cbranch_execz K2_RK_A
K2_CK5:
    v_bfi_b32 v192, s61, v21, v22
    v_lshrrev_b32 v55, 24, v23
    v_cmp_ne_u32 vcc, s2, v192
    v_add_u32 v45, 163424, v55
    s_cbranch_vccnz K2_RT5
    ds_add_rtn_u32 v45, v45, v201
    v_mad_u32_u24 v55, v55, s58, v202
    s_mov_b64 exec, s[90:91]
    s_cbranch_execz K2_RK_A
K2_CK6:
    v_bfi_b32 v192, s61, v25, v26
    v_lshrrev_b32 v56, 24, v27
    v_cmp_ne_u32 vcc, s2, v192
    v_add_u32 v46, 163424, v56
    s_cbranch_vccnz K2_RT6
    ds_add_rtn_u32 v46, v46, v201
    v_mad_u32_u24 v56, v56, s58, v202
    s_mov_b64 exec, s[92:93]
    s_cbranch_execz K2_RK_A
K2_CK7:
    v_bfi_b32 v192, s61, v29, v30
    v_lshrrev_b32 v57, 24, v31
    v_cmp_ne_u32 vcc, s2, v192
    v_add_u32 v47, 163424, v57
    s_cbranch_vccnz K2_RT7
    ds_add_rtn_u32 v47, v47, v201
    v_mad_u32_u24 v57, v57, s58, v202
    s_mov_b64 exec, s[94:95]
    s_cbranch_execz K2_RK_A
K2_CK8:
    v_bfi_b32 v192, s61, v33, v34
    v_lshrrev_b32 v58, 24, v35
    v_cmp_ne_u32 vcc, s2, v192
    v_add_u32 v48, 163424, v58
    s_cbranch_vccnz K2_RT8
    ds_add_rtn_u32 v48, v48, v201
    v_mad_u32_u24 v58, v58, s58, v202
    s_mov_b64 exec, s[96:97]
    s_cbranch_execz K2_RK_A
K2_CK9:
    v_bfi_b32 v192, s61, v37, v38
    v_lshrrev_b32 v59, 24, v39
    v_cmp_ne_u32 vcc, s2, v192
    v_add_u32 v49, 163424, v59
    s_cbranch_vccnz K2_RT9
    ds_add_rtn_u32 v49, v49, v201
    v_mad_u32_u24 v59, v59, s58, v202
K2_RK_A:
    s_mov_b64 exec, -1
    s_mov_b64 exec, s[40:41]
    s_cbranch_execz K2_TP
    v_and_b32 v3, 0xffffff, v3
    v_cmpx_gt_u32 vcc, s62, v50
    buffer_load_dword v245, v3, s[16:19], 0 offen
    s_mov_b64 exec, s[42:43]
    s_cbranch_execz K2_TP
    v_and_b32 v7, 0xffffff, v7
    v_cmpx_gt_u32 vcc, s62, v51
    buffer_load_dword v245, v7, s[16:19], 0 offen
    s_mov_b64 exec, s[44:45]
    s_cbranch_execz K2_TP
    v_and_b32 v11, 0xffffff, v11
    v_cmpx_gt_u32 vcc, s62, v52
    buffer_load_dword v245, v11, s[16:19], 0 offen
    s_mov_b64 exec, s[46:47]
    s_cbranch_execz K2_TP
    v_and_b32 v15, 0xffffff, v15
    v_cmpx_gt_u32 vcc, s62, v53
    buffer_load_dword v245, v15, s[16:19], 0 offen
    s_mov_b64 exec, s[48:49]
    s_cbranch_execz K2_TP
    v_and_b32 v19, 0xffffff, v19
    v_cmpx_gt_u32 vcc, s62, v54
    buffer_load_dword v245, v19, s[16:19], 0 offen
    s_mov_b64 exec, s[50:51]
    s_cbranch_execz K2_TP
    v_and_b32 v23, 0xffffff, v23
    v_cmpx_gt_u32 vcc, s62, v55
    buffer_load_dword v245, v23, s[16:19], 0 offen
    s_mov_b64 exec, s[90:91]
    s_cbranch_execz K2_TP
    v_and_b32 v27, 0xffffff, v27
    v_cmpx_gt_u32 vcc, s62, v56
    buffer_load_dword v245, v27, s[16:19], 0 offen
    s_mov_b64 exec, s[92:93]
    s_cbranch_execz K2_TP
    v_and_b32 v31, 0xffffff, v31
    v_cmpx_gt_u32 vcc, s62, v57
    buffer_load_dword v245, v31, s[16:19], 0 offen
    s_mov_b64 exec, s[94:95]
    s_cbranch_execz K2_TP
    v_and_b32 v35, 0xffffff, v35
    v_cmpx_gt_u32 vcc, s62, v58
    buffer_load_dword v245, v35, s[16:19], 0 offen
    s_mov_b64 exec, s[96:97]
    s_cbranch_execz K2_TP
    v_and_b32 v39, 0xffffff, v39
    v_cmpx_gt_u32 vcc, s62, v59
    buffer_load_dword v245, v39, s[16:19], 0 offen
K2_TP:
    s_mov_b64 exec, -1
K2_RK_DONE:
    s_mul_i32 s67, s24, 48
    s_waitcnt lgkmcnt(0)
    s_mov_b64 exec, s[40:41]
    s_cbranch_execz K2_SC_DONE
    v_cmpx_gt_u32 vcc, 48, v40
    v_lshl_add_u32 v194, v40, 5, v50
    v_lshl_add_u32 v195, v40, 2, v50
    v_lshrrev_b32 v193, 3, v40
    v_mad_i32_i24 v196, v193, -16, v195
    v_and_b32 v193, 1, v193
    v_mad_i32_i24 v196, v193, -14, v196
    ds_write_b32 v194, v3 offset:864
    ds_write_b16 v195, v0 offset:194
    ds_write_b16_d16_hi v195, v0 offset:386
    ds_write_b16_d16_hi v195, v1 offset:578
    ds_write_b16 v196, v2 offset:768
    s_mov_b64 exec, s[42:43]
    s_cbranch_execz K2_SC_DONE
    v_cmpx_gt_u32 vcc, 48, v41
    v_lshl_add_u32 v194, v41, 5, v51
    v_lshl_add_u32 v195, v41, 2, v51
    v_lshrrev_b32 v193, 3, v41
    v_mad_i32_i24 v196, v193, -16, v195
    v_and_b32 v193, 1, v193
    v_mad_i32_i24 v196, v193, -14, v196
    ds_write_b32 v194, v7 offset:864
    ds_write_b16 v195, v4 offset:194
    ds_write_b16_d16_hi v195, v4 offset:386
    ds_write_b16_d16_hi v195, v5 offset:578
    ds_write_b16 v196, v6 offset:768
    s_mov_b64 exec, s[44:45]
    s_cbranch_execz K2_SC_DONE
    v_cmpx_gt_u32 vcc, 48, v42
    v_lshl_add_u32 v194, v42, 5, v52
    v_lshl_add_u32 v195, v42, 2, v52
    v_lshrrev_b32 v193, 3, v42
    v_mad_i32_i24 v196, v193, -16, v195
    v_and_b32 v193, 1, v193
    v_mad_i32_i24 v196, v193, -14, v196
    ds_write_b32 v194, v11 offset:864
    ds_write_b16 v195, v8 offset:194
    ds_write_b16_d16_hi v195, v8 offset:386
    ds_write_b16_d16_hi v195, v9 offset:578
    ds_write_b16 v196, v10 offset:768
    s_mov_b64 exec, s[46:47]
    s_cbranch_execz K2_SC_DONE
    v_cmpx_gt_u32 vcc, 48, v43
    v_lshl_add_u32 v194, v43, 5, v53
    v_lshl_add_u32 v195, v43, 2, v53
    v_lshrrev_b32 v193, 3, v43
    v_mad_i32_i24 v196, v193, -16, v195
    v_and_b32 v193, 1, v193
    v_mad_i32_i24 v196, v193, -14, v196
    ds_write_b32 v194, v15 offset:864
    ds_write_b16 v195, v12 offset:194
    ds_write_b16_d16_hi v195, v12 offset:386
    ds_write_b16_d16_hi v195, v13 offset:578
    ds_write_b16 v196, v14 offset:768
    s_mov_b64 exec, s[48:49]
    s_cbranch_execz K2_SC_DONE
    v_cmpx_gt_u32 vcc, 48, v44
    v_lshl_add_u32 v194, v44, 5, v54
    v_lshl_add_u32 v195, v44, 2, v54
    v_lshrrev_b32 v193, 3, v44
    v_mad_i32_i24 v196, v193, -16, v195
    v_and_b32 v193, 1, v193
    v_mad_i32_i24 v196, v193, -14, v196
    ds_write_b32 v194, v19 offset:864
    ds_write_b16 v195, v16 offset:194
    ds_write_b16_d16_hi v195, v16 offset:386
    ds_write_b16_d16_hi v195, v17 offset:578
    ds_write_b16 v196, v18 offset:768
    s_mov_b64 exec, s[50:51]
    s_cbranch_execz K2_SC_DONE
    v_cmpx_gt_u32 vcc, 48, v45
    v_lshl_add_u32 v194, v45, 5, v55
    v_lshl_add_u32 v195, v45, 2, v55
    v_lshrrev_b32 v193, 3, v45
    v_mad_i32_i24 v196, v193, -16, v195
    v_and_b32 v193, 1, v193
    v_mad_i32_i24 v196, v193, -14, v196
    ds_write_b32 v194, v23 offset:864
    ds_write_b16 v195, v20 offset:194
    ds_write_b16_d16_hi v195, v20 offset:386
    ds_write_b16_d16_hi v195, v21 offset:578
    ds_write_b16 v196, v22 offset:768
    s_mov_b64 exec, s[90:91]
    s_cbranch_execz K2_SC_DONE
    v_cmpx_gt_u32 vcc, 48, v46
    v_lshl_add_u32 v194, v46, 5, v56
    v_lshl_add_u32 v195, v46, 2, v56
    v_lshrrev_b32 v193, 3, v46
    v_mad_i32_i24 v196, v193, -16, v195
    v_and_b32 v193, 1, v193
    v_mad_i32_i24 v196, v193, -14, v196
    ds_write_b32 v194, v27 offset:864
    ds_write_b16 v195, v24 offset:194
    ds_write_b16_d16_hi v195, v24 offset:386
    ds_write_b16_d16_hi v195, v25 offset:578
    ds_write_b16 v196, v26 offset:768
    s_mov_b64 exec, s[92:93]
    s_cbranch_execz K2_SC_DONE
    v_cmpx_gt_u32 vcc, 48, v47
    v_lshl_add_u32 v194, v47, 5, v57
    v_lshl_add_u32 v195, v47, 2, v57
    v_lshrrev_b32 v193, 3, v47
    v_mad_i32_i24 v196, v193, -16, v195
    v_and_b32 v193, 1, v193
    v_mad_i32_i24 v196, v193, -14, v196
    ds_write_b32 v194, v31 offset:864
    ds_write_b16 v195, v28 offset:194
    ds_write_b16_d16_hi v195, v28 offset:386
    ds_write_b16_d16_hi v195, v29 offset:578
    ds_write_b16 v196, v30 offset:768
    s_mov_b64 exec, s[94:95]
    s_cbranch_execz K2_SC_DONE
    v_cmpx_gt_u32 vcc, 48, v48
    v_lshl_add_u32 v194, v48, 5, v58
    v_lshl_add_u32 v195, v48, 2, v58
    v_lshrrev_b32 v193, 3, v48
    v_mad_i32_i24 v196, v193, -16, v195
    v_and_b32 v193, 1, v193
    v_mad_i32_i24 v196, v193, -14, v196
    ds_write_b32 v194, v35 offset:864
    ds_write_b16 v195, v32 offset:194
    ds_write_b16_d16_hi v195, v32 offset:386
    ds_write_b16_d16_hi v195, v33 offset:578
    ds_write_b16 v196, v34 offset:768
    s_mov_b64 exec, s[96:97]
    s_cbranch_execz K2_SC_DONE
    v_cmpx_gt_u32 vcc, 48, v49
    v_lshl_add_u32 v194, v49, 5, v59
    v_lshl_add_u32 v195, v49, 2, v59
    v_lshrrev_b32 v193, 3, v49
    v_mad_i32_i24 v196, v193, -16, v195
    v_and_b32 v193, 1, v193
    v_mad_i32_i24 v196, v193, -14, v196
    ds_write_b32 v194, v39 offset:864
    ds_write_b16 v195, v36 offset:194
    ds_write_b16_d16_hi v195, v36 offset:386
    ds_write_b16_d16_hi v195, v37 offset:578
    ds_write_b16 v196, v38 offset:768
K2_SC_DONE:
    s_mov_b64 exec, -1
    v_lshlrev_b32 v192, 2, v176
    v_add_u32 v192, 163424, v192
    v_mov_b32 v200, 163652
    v_mov_b32 v198, 0
    s_movk_i32 s26, 48
    s_cmp_eq_u32 s20, 7
    s_cbranch_scc1 K2_FLGCK
K2_FLGOK:
    s_waitcnt lgkmcnt(0)
    s_barrier
    ds_read_b32 v193, v192
    ds_read_b32 v200, v200
    v_cmp_gt_u32 s[56:57], s22, v176
    v_mad_u32_u24 v195, v176, s59, v202
    v_lshl_or_b32 v195, v176, 21, v195
    s_waitcnt lgkmcnt(0)
    v_cndmask_b32 v193, 0, v193, s[56:57]
    v_readfirstlane_b32 s27, v200
    v_cmp_lt_u32 vcc, 48, v193
    s_nop 0
    s_cbranch_vccnz K2_BIG
K2_TOK:
    v_subrev_u32 v194, s67, v193
    v_max_i32 v194, 1, v194
    v_min_i32 v194, s26, v194
    v_add_u32 v194, 15, v194
    v_lshrrev_b32 v194, 4, v194
    v_lshl_or_b32 v195, v194, 18, v195
    v_or_b32 v195, v195, v198
    v_mov_b32 v197, 425056
    v_cndmask_b32 v253, v197, v195, s[56:57]
    s_movk_i32 s40, 0
    s_movk_i32 s41, 256
    s_movk_i32 s42, 512
    s_movk_i32 s43, 768
    s_add_u32 s24, s24, 1
    s_cmp_ge_u32 s24, s25
    s_cselect_b32 s55, 1, 0
    s_cmp_eq_u32 s27, 0
    s_cselect_b32 s55, s55, 0
    s_mov_b32 s38, 0
    s_mov_b32 s34, 0
    s_mov_b32 s35, 0
    s_mov_b32 s36, 1
    s_mov_b32 s31, 0
    s_mov_b32 s58, s20
    v_readlane_b32 s3, v253, s58
    s_lshl_b32 s44, s34, 7
    s_lshl_b32 s60, s58, 5
    s_and_b32 s48, s3, 0x3ffff
    s_bfe_u32 s33, s3, 0x30012
    s_sub_u32 s60, s60, s48
    s_and_b32 s60, s60, 0xff
    s_add_u32 s60, s60, s48
    s_mul_i32 s35, s38, 6
    s_cmp_eq_u32 s34, 0
    s_cselect_b32 s35, s35, s60
    s_mov_b32 s45, s44
    s_add_u32 s47, s44, 256
    s_add_u32 s49, s48, 32
    s_add_u32 s60, s48, 64
    s_cmp_eq_u32 s33, 3
    s_cselect_b32 s46, s44, s47
    s_cselect_b32 s50, s60, s48
    s_cselect_b32 s51, s48, s49
    s_sub_u32 s60, s33, 2
    s_cmp_lt_u32 s60, 2
    s_cbranch_scc0 K2_rare_11
K2_back_12:
    v_add_u32 v233, s48, v230
    ds_read_b32 v232, v233
    ds_read_b32 v233, v233 offset:1024
    v_add_u32 v222, s48, v251
    ds_read_b32 v222, v222
    v_add_u32 v224, s49, v251
    ds_read_b32 v224, v224
    v_add_u32 v226, s50, v251
    ds_read_b32 v226, v226
    v_add_u32 v228, s51, v251
    ds_read_b32 v228, v228
    s_waitcnt lgkmcnt(4)
    v_or_b32 v232, v232, v231
    v_or_b32 v233, v233, v231
    s_cmp_lg_u32 s34, 0
    s_cbranch_scc1 K2_dum_14
    s_add_u32 m0, s48, 864
    s_add_u32 s65, s48, 1888
    buffer_load_dwordx4 v232, s[16:19], 0 offen  lds
    s_mov_b32 m0, s65
    s_mov_b32 exec_hi, 0
    buffer_load_dwordx4 v233, s[16:19], 0 offen  lds
    s_cmp_eq_u32 s33, 4
    s_cbranch_scc1 K2_a4_15
K2_b4_17:
    s_mov_b32 exec_hi, -1
K2_back_16:
    s_waitcnt lgkmcnt(3)
    v_mad_u32_u16 v223, v222, s39, v248 op_sel:[1,0,0,0]
    v_mad_u32_u16 v222, v222, s39, v248
    s_waitcnt lgkmcnt(2)
    v_mad_u32_u16 v225, v224, s39, v248 op_sel:[1,0,0,0]
    v_mad_u32_u16 v224, v224, s39, v248
    s_waitcnt lgkmcnt(1)
    v_mad_u32_u16 v227, v226, s39, v248 op_sel:[1,0,0,0]
    v_mad_u32_u16 v226, v226, s39, v248
    s_waitcnt lgkmcnt(0)
    v_mad_u32_u16 v229, v228, s39, v248 op_sel:[1,0,0,0]
    v_mad_u32_u16 v228, v228, s39, v248
    s_mov_b32 m0, s68
    s_nop 0
    buffer_load_dwordx4 v222, s[4:7], s44 offen lds
    buffer_load_dwordx4 v223, s[72:75], s44 offen offset:1024 lds
    s_mov_b32 m0, s69
    s_nop 0
    buffer_load_dwordx4 v224, s[4:7], s45 offen lds
    buffer_load_dwordx4 v225, s[72:75], s45 offen offset:1024 lds
    s_mov_b32 m0, s70
    s_nop 0
    buffer_load_dwordx4 v226, s[4:7], s46 offen lds
    buffer_load_dwordx4 v227, s[72:75], s46 offen offset:1024 lds
    s_mov_b32 m0, s71
    s_nop 0
    buffer_load_dwordx4 v228, s[4:7], s47 offen lds
    buffer_load_dwordx4 v229, s[72:75], s47 offen offset:1024 lds
    v_add_u32 v249, s48, v249
    v_add_u32 v250, s48, v250
    s_waitcnt vmcnt(6)
    ds_read_b64_tr_b16 v[176:177], v246 offset:0
    ds_read_b64_tr_b16 v[178:179], v246 offset:512
    ds_read_b64_tr_b16 v[180:181], v247 offset:0
    ds_read_b64_tr_b16 v[182:183], v247 offset:512
    ds_read_b64_tr_b16 v[0:1], v249 offset:0
    ds_read_b64_tr_b16 v[2:3], v249 offset:128
    ds_read_b128 v[4:7], v250 offset:0
    ds_read_b128 v[8:11], v250 offset:16
    ds_read_b128 v[12:15], v250 offset:384
    ds_read_b128 v[16:19], v250 offset:400
    ds_read_b64_tr_b16 v[20:21], v249 offset:512
    ds_read_b64_tr_b16 v[22:23], v249 offset:640
    ds_read_b128 v[24:27], v250 offset:64
    ds_read_b128 v[28:31], v250 offset:80
    ds_read_b128 v[32:35], v250 offset:448
    ds_read_b128 v[36:39], v250 offset:464
    s_mov_b32 s29, s48
    s_mov_b32 s32, s31
    s_mov_b32 s30, s3
    s_mov_b32 s31, s35
    s_cmp_eq_u32 s33, 2
    s_cbranch_scc1 K2_U20
    s_cmp_eq_u32 s33, 3
    s_cbranch_scc1 K2_U30
    s_cmp_eq_u32 s33, 1
    s_cbranch_scc1 K2_U10
    s_branch K2_U40
K2_U20:
    s_setprio 1
    s_waitcnt lgkmcnt(6)
    v_lshlrev_b32 v40, 16, v0
    v_and_b32 v41, 0xffff0000, v0
    v_lshlrev_b32 v42, 16, v1
    v_and_b32 v43, 0xffff0000, v1
    v_lshlrev_b32 v44, 16, v2
    v_and_b32 v45, 0xffff0000, v2
    v_lshlrev_b32 v46, 16, v3
    v_and_b32 v47, 0xffff0000, v3
    v_mul_f32 v4, v40, v4
    v_mul_f32 v5, v41, v5
    v_mul_f32 v6, v42, v6
    v_mul_f32 v7, v43, v7
    v_mul_f32 v8, v44, v8
    v_mul_f32 v9, v45, v9
    v_mul_f32 v10, v46, v10
    v_mul_f32 v11, v47, v11
    v_cvt_pk_bf16_f32 v64, v4, v5
    v_cvt_pk_bf16_f32 v65, v6, v7
    v_cvt_pk_bf16_f32 v66, v8, v9
    v_cvt_pk_bf16_f32 v67, v10, v11
    v_mul_f32 v12, v40, v12
    v_mul_f32 v13, v41, v13
    v_mul_f32 v14, v42, v14
    v_mul_f32 v15, v43, v15
    v_mul_f32 v16, v44, v16
    v_mul_f32 v17, v45, v17
    v_mul_f32 v18, v46, v18
    v_mul_f32 v19, v47, v19
    v_cvt_pk_bf16_f32 v68, v12, v13
    v_cvt_pk_bf16_f32 v69, v14, v15
    v_cvt_pk_bf16_f32 v70, v16, v17
    v_cvt_pk_bf16_f32 v71, v18, v19
    s_waitcnt lgkmcnt(0)
    v_lshlrev_b32 v48, 16, v20
    v_and_b32 v49, 0xffff0000, v20
    v_lshlrev_b32 v50, 16, v21
    v_and_b32 v51, 0xffff0000, v21
    v_lshlrev_b32 v52, 16, v22
    v_and_b32 v53, 0xffff0000, v22
    v_lshlrev_b32 v54, 16, v23
    v_and_b32 v55, 0xffff0000, v23
    v_mul_f32 v24, v48, v24
    v_mul_f32 v25, v49, v25
    v_mul_f32 v26, v50, v26
    v_mul_f32 v27, v51, v27
    v_mul_f32 v28, v52, v28
    v_mul_f32 v29, v53, v29
    v_mul_f32 v30, v54, v30
    v_mul_f32 v31, v55, v31
    v_cvt_pk_bf16_f32 v72, v24, v25
    v_cvt_pk_bf16_f32 v73, v26, v27
    v_cvt_pk_bf16_f32 v74, v28, v29
    v_cvt_pk_bf16_f32 v75, v30, v31
    v_mul_f32 v32, v48, v32
    v_mul_f32 v33, v49, v33
    v_mul_f32 v34, v50, v34
    v_mul_f32 v35, v51, v35
    v_mul_f32 v36, v52, v36
    v_mul_f32 v37, v53, v37
    v_mul_f32 v38, v54, v38
    v_mul_f32 v39, v55, v39
    v_cvt_pk_bf16_f32 v76, v32, v33
    v_cvt_pk_bf16_f32 v77, v34, v35
    v_cvt_pk_bf16_f32 v78, v36, v37
    v_cvt_pk_bf16_f32 v79, v38, v39
    s_waitcnt vmcnt(4)
    v_mfma_f32_32x32x16_bf16 v[0:15], v[64:67], v[176:179], 0
    ds_read_b64_tr_b16 v[184:185], v246 offset:2048
    ds_read_b64_tr_b16 v[186:187], v246 offset:2560
    ds_read_b64_tr_b16 v[188:189], v247 offset:2048
    ds_read_b64_tr_b16 v[190:191], v247 offset:2560
    s_mov_b32 m0, s68
    v_mfma_f32_32x32x16_bf16 v[16:31], v[68:71], v[176:179], 0
    buffer_load_dwordx4 v222, s[4:7], s42 offen lds
    buffer_load_dwordx4 v223, s[72:75], s42 offen offset:1024 lds
    v_permlane32_swap_b32 v242, v236
    v_permlane32_swap_b32 v243, v237
    s_add_u32 s38, s38, 1
    v_mfma_f32_32x32x16_bf16 v[32:47], v[64:67], v[180:183], 0
    v_permlane32_swap_b32 v244, v238
    v_permlane32_swap_b32 v245, v239
    v_permlane32_swap_b32 v240, v241
    v_add_f32 v242, v242, v236
    v_mfma_f32_32x32x16_bf16 v[48:63], v[68:71], v[180:183], 0
    v_add_f32 v243, v243, v237
    v_add_f32 v244, v244, v238
    v_add_f32 v245, v245, v239
    v_add_f32 v240, -v240, -v241
    v_mov_b32 v254, s52
    v_mov_b32 v255, s38
    s_waitcnt vmcnt(4) lgkmcnt(0)
    v_mfma_f32_32x32x16_bf16 v[0:15], v[72:75], v[184:187], v[0:15]
    ds_read_b64_tr_b16 v[176:177], v246 offset:4096
    ds_read_b64_tr_b16 v[178:179], v246 offset:4608
    ds_read_b64_tr_b16 v[180:181], v247 offset:4096
    ds_read_b64_tr_b16 v[182:183], v247 offset:4608
    s_lshl_b32 s58, s38, 3
    s_add_u32 s58, s58, s20
    s_mov_b32 m0, s69
    v_mfma_f32_32x32x16_bf16 v[16:31], v[76:79], v[184:187], v[16:31]
    buffer_load_dwordx4 v224, s[4:7], s42 offen lds
    buffer_load_dwordx4 v225, s[72:75], s42 offen offset:1024 lds
    s_set_gpr_idx_on s32, gpr_idx(DST)
    s_nop 0
    v_cvt_pk_bf16_f32 v195, v242, v243
    v_cvt_pk_bf16_f32 v196, v244, v245
    v_cvt_pk_bf16_f32 v197, v240, v240
    s_set_gpr_idx_off
    s_mov_b64 exec, 1
    ds_write_b32 v254, v255
    s_mov_b64 exec, -1
    s_cmp_lt_u32 s58, s22
    s_cbranch_scc0 K2_dyn_18
K2_back_19:
    v_readlane_b32 s3, v253, s58
    s_lshl_b32 s44, s34, 7
    s_lshl_b32 s60, s58, 5
    s_and_b32 s48, s3, 0x3ffff
    s_bfe_u32 s33, s3, 0x30012
    s_sub_u32 s60, s60, s48
    s_and_b32 s60, s60, 0xff
    s_add_u32 s60, s60, s48
    s_mul_i32 s35, s38, 6
    s_cmp_eq_u32 s34, 0
    s_cselect_b32 s35, s35, s60
    s_mov_b32 s45, s44
    s_add_u32 s47, s44, 256
    s_add_u32 s49, s48, 32
    s_add_u32 s60, s48, 64
    s_cmp_eq_u32 s33, 3
    s_cselect_b32 s46, s44, s47
    s_cselect_b32 s50, s60, s48
    s_cselect_b32 s51, s48, s49
    s_sub_u32 s60, s33, 2
    s_cmp_lt_u32 s60, 2
    s_cbranch_scc0 K2_rare_24
K2_back_25:
    v_mfma_f32_32x32x16_bf16 v[32:47], v[72:75], v[188:191], v[32:47]
    v_add_u32 v233, s48, v230
    ds_read_b32 v232, v233
    ds_read_b32 v233, v233 offset:1024
    v_mul_f32 v234, v0, v96
    v_mul_f32 v236, v8, v128
    v_fmac_f32 v234, v1, v97
    v_fmac_f32 v236, v9, v129
    v_mfma_f32_32x32x16_bf16 v[48:63], v[76:79], v[188:191], v[48:63]
    s_setprio 0
    v_fmac_f32 v234, v2, v98
    v_fmac_f32 v236, v10, v130
    v_fmac_f32 v234, v3, v99
    v_fmac_f32 v236, v11, v131
    v_fmac_f32 v234, v4, v100
    v_fmac_f32 v236, v12, v132
    v_fmac_f32 v234, v5, v101
    v_fmac_f32 v236, v13, v133
    v_fmac_f32 v234, v6, v102
    v_fmac_f32 v236, v14, v134
    v_fmac_f32 v234, v7, v103
    v_fmac_f32 v236, v15, v135
    v_mul_f32 v238, v16, v128
    v_mul_f32 v240, v24, v128
    v_fmac_f32 v238, v17, v129
    v_fmac_f32 v240, v25, v129
    v_fmac_f32 v238, v18, v130
    v_fmac_f32 v240, v26, v130
    v_fmac_f32 v238, v19, v131
    v_fmac_f32 v240, v27, v131
    v_fmac_f32 v238, v20, v132
    v_fmac_f32 v240, v28, v132
    v_fmac_f32 v238, v21, v133
    v_fmac_f32 v240, v29, v133
    v_fmac_f32 v238, v22, v134
    v_fmac_f32 v240, v30, v134
    v_fmac_f32 v238, v23, v135
    v_fmac_f32 v240, v31, v135
    v_mul_f32 v235, v32, v104
    v_mul_f32 v237, v40, v136
    v_fmac_f32 v235, v33, v105
    v_fmac_f32 v237, v41, v137
    v_fmac_f32 v235, v34, v106
    v_fmac_f32 v237, v42, v138
    v_fmac_f32 v235, v35, v107
    v_fmac_f32 v237, v43, v139
    v_fmac_f32 v235, v36, v108
    v_fmac_f32 v237, v44, v140
    v_fmac_f32 v235, v37, v109
    v_fmac_f32 v237, v45, v141
    v_fmac_f32 v235, v38, v110
    v_fmac_f32 v237, v46, v142
    v_fmac_f32 v235, v39, v111
    v_fmac_f32 v237, v47, v143
    v_mul_f32 v239, v48, v136
    v_mul_f32 v241, v56, v136
    v_fmac_f32 v239, v49, v137
    v_fmac_f32 v241, v57, v137
    s_setprio 1
    s_waitcnt vmcnt(4) lgkmcnt(3)
    v_mfma_f32_32x32x16_bf16 v[0:15], v[64:67], v[176:179], 0
    ds_read_b64_tr_b16 v[184:185], v246 offset:6144
    ds_read_b64_tr_b16 v[186:187], v246 offset:6656
    ds_read_b64_tr_b16 v[188:189], v247 offset:6144
    ds_read_b64_tr_b16 v[190:191], v247 offset:6656
    v_fmac_f32 v239, v50, v138
    v_fmac_f32 v241, v58, v138
    s_mov_b32 m0, s70
    v_mfma_f32_32x32x16_bf16 v[16:31], v[68:71], v[176:179], 0
    buffer_load_dwordx4 v222, s[4:7], s43 offen lds
    buffer_load_dwordx4 v223, s[72:75], s43 offen offset:1024 lds
    v_fmac_f32 v239, v51, v139
    v_fmac_f32 v241, v59, v139
    v_fmac_f32 v239, v52, v140
    v_fmac_f32 v241, v60, v140
    v_fmac_f32 v239, v53, v141
    v_mfma_f32_32x32x16_bf16 v[32:47], v[64:67], v[180:183], 0
    v_add_u32 v222, s48, v251
    ds_read_b32 v222, v222
    v_fmac_f32 v241, v61, v141
    v_fmac_f32 v239, v54, v142
    v_fmac_f32 v241, v62, v142
    v_fmac_f32 v239, v55, v143
    v_fmac_f32 v241, v63, v143
    v_mfma_f32_32x32x16_bf16 v[48:63], v[68:71], v[180:183], 0
    v_permlane32_swap_b32 v234, v236
    v_permlane32_swap_b32 v235, v237
    v_permlane32_swap_b32 v240, v238
    s_waitcnt lgkmcnt(5)
    v_or_b32 v232, v232, v231
    v_or_b32 v233, v233, v231
    s_cmp_lg_u32 s34, 0
    s_cbranch_scc1 K2_dum_27
    s_add_u32 m0, s48, 864
    s_add_u32 s65, s48, 1888
    buffer_load_dwordx4 v232, s[16:19], 0 offen  lds
    s_mov_b32 m0, s65
    s_mov_b32 exec_hi, 0
    buffer_load_dwordx4 v233, s[16:19], 0 offen  lds
    s_cmp_eq_u32 s33, 4
    s_cbranch_scc1 K2_a4_28
K2_b4_30:
    s_mov_b32 exec_hi, -1
K2_back_29:
    s_waitcnt vmcnt(6) lgkmcnt(1)
    v_mfma_f32_32x32x16_bf16 v[0:15], v[72:75], v[184:187], v[0:15]
    ds_read_b64_tr_b16 v[176:177], v246 offset:0
    ds_read_b64_tr_b16 v[178:179], v246 offset:512
    ds_read_b64_tr_b16 v[180:181], v247 offset:0
    ds_read_b64_tr_b16 v[182:183], v247 offset:512
    v_permlane32_swap_b32 v241, v239
    s_mov_b32 m0, s71
    v_mfma_f32_32x32x16_bf16 v[16:31], v[76:79], v[184:187], v[16:31]
    buffer_load_dwordx4 v224, s[4:7], s43 offen lds
    buffer_load_dwordx4 v225, s[72:75], s43 offen offset:1024 lds
    s_waitcnt lgkmcnt(4)
    v_mad_u32_u16 v223, v222, s39, v248 op_sel:[1,0,0,0]
    v_mad_u32_u16 v222, v222, s39, v248
    v_add_f32 v234, v234, v236
    v_add_f32 v235, v235, v237
    v_add_f32 v240, v240, v238
    v_add_f32 v241, v241, v239
    s_set_gpr_idx_on s31, gpr_idx(DST)
    s_nop 0
    v_cvt_pk_bf16_f32 v192, v234, v235
    v_cvt_pk_bf16_f32 v193, v240, v241
    s_set_gpr_idx_off
    v_mfma_f32_32x32x16_bf16 v[32:47], v[72:75], v[188:191], v[32:47]
    v_add_u32 v224, s49, v251
    ds_read_b32 v224, v224
    v_mul_f32 v234, v0, v144
    v_mul_f32 v236, v8, v112
    v_fmac_f32 v234, v1, v145
    v_fmac_f32 v236, v9, v113
    v_fmac_f32 v234, v2, v146
    v_mfma_f32_32x32x16_bf16 v[48:63], v[76:79], v[188:191], v[48:63]
    s_setprio 0
    v_fmac_f32 v236, v10, v114
    v_fmac_f32 v234, v3, v147
    v_fmac_f32 v236, v11, v115
    v_fmac_f32 v234, v4, v148
    v_fmac_f32 v236, v12, v116
    v_fmac_f32 v234, v5, v149
    v_fmac_f32 v236, v13, v117
    v_fmac_f32 v234, v6, v150
    v_fmac_f32 v236, v14, v118
    v_fmac_f32 v234, v7, v151
    v_fmac_f32 v236, v15, v119
    v_mul_f32 v238, v16, v160
    v_mul_f32 v240, v24, v160
    v_fmac_f32 v238, v17, v161
    v_fmac_f32 v240, v25, v161
    v_fmac_f32 v238, v18, v162
    v_fmac_f32 v240, v26, v162
    v_fmac_f32 v238, v19, v163
    v_fmac_f32 v240, v27, v163
    v_fmac_f32 v238, v20, v164
    v_fmac_f32 v240, v28, v164
    v_fmac_f32 v238, v21, v165
    v_fmac_f32 v240, v29, v165
    v_fmac_f32 v238, v22, v166
    v_fmac_f32 v240, v30, v166
    v_fmac_f32 v238, v23, v167
    v_fmac_f32 v240, v31, v167
    v_mul_f32 v235, v32, v152
    v_mul_f32 v237, v40, v120
    v_fmac_f32 v235, v33, v153
    v_fmac_f32 v237, v41, v121
    v_fmac_f32 v235, v34, v154
    v_fmac_f32 v237, v42, v122
    v_fmac_f32 v235, v35, v155
    v_fmac_f32 v237, v43, v123
    v_fmac_f32 v235, v36, v156
    v_fmac_f32 v237, v44, v124
    v_fmac_f32 v235, v37, v157
    v_fmac_f32 v237, v45, v125
    v_fmac_f32 v235, v38, v158
    v_fmac_f32 v237, v46, v126
    v_fmac_f32 v235, v39, v159
    v_fmac_f32 v237, v47, v127
    v_mul_f32 v239, v48, v168
    v_mul_f32 v241, v56, v168
    v_fmac_f32 v239, v49, v169
    v_fmac_f32 v241, v57, v169
    v_fmac_f32 v239, v50, v170
    v_fmac_f32 v241, v58, v170
    v_fmac_f32 v239, v51, v171
    s_setprio 1
    s_waitcnt vmcnt(6) lgkmcnt(1)
    v_mfma_f32_32x32x16_bf16 v[0:15], v[64:67], v[176:179], 0
    ds_read_b64_tr_b16 v[184:185], v246 offset:2048
    ds_read_b64_tr_b16 v[186:187], v246 offset:2560
    ds_read_b64_tr_b16 v[188:189], v247 offset:2048
    ds_read_b64_tr_b16 v[190:191], v247 offset:2560
    v_fmac_f32 v241, v59, v171
    v_fmac_f32 v239, v52, v172
    s_mov_b32 m0, s68
    v_mfma_f32_32x32x16_bf16 v[16:31], v[68:71], v[176:179], 0
    buffer_load_dwordx4 v222, s[4:7], s44 offen lds
    buffer_load_dwordx4 v223, s[72:75], s44 offen offset:1024 lds
    s_waitcnt lgkmcnt(4)
    v_mad_u32_u16 v225, v224, s39, v248 op_sel:[1,0,0,0]
    v_mad_u32_u16 v224, v224, s39, v248
    v_fmac_f32 v241, v60, v172
    v_fmac_f32 v239, v53, v173
    v_mfma_f32_32x32x16_bf16 v[32:47], v[64:67], v[180:183], 0
    v_add_u32 v226, s50, v251
    ds_read_b32 v226, v226
    v_fmac_f32 v241, v61, v173
    v_fmac_f32 v239, v54, v174
    v_fmac_f32 v241, v62, v174
    v_fmac_f32 v239, v55, v175
    v_fmac_f32 v241, v63, v175
    v_mfma_f32_32x32x16_bf16 v[48:63], v[68:71], v[180:183], 0
    s_waitcnt vmcnt(6) lgkmcnt(1)
    v_mfma_f32_32x32x16_bf16 v[0:15], v[72:75], v[184:187], v[0:15]
    ds_read_b64_tr_b16 v[176:177], v246 offset:4096
    ds_read_b64_tr_b16 v[178:179], v246 offset:4608
    ds_read_b64_tr_b16 v[180:181], v247 offset:4096
    ds_read_b64_tr_b16 v[182:183], v247 offset:4608
    s_mov_b32 m0, s69
    v_mfma_f32_32x32x16_bf16 v[16:31], v[76:79], v[184:187], v[16:31]
    buffer_load_dwordx4 v224, s[4:7], s45 offen lds
    buffer_load_dwordx4 v225, s[72:75], s45 offen offset:1024 lds
    s_waitcnt lgkmcnt(4)
    v_mad_u32_u16 v227, v226, s39, v248 op_sel:[1,0,0,0]
    v_mad_u32_u16 v226, v226, s39, v248
    v_mfma_f32_32x32x16_bf16 v[32:47], v[72:75], v[188:191], v[32:47]
    v_add_u32 v228, s51, v251
    ds_read_b32 v228, v228
    v_mul_f32 v242, v0, v144
    v_fma_f32 v238, v8, v160, -v238
    v_fmac_f32 v242, v1, v145
    v_fmac_f32 v238, v9, v161
    v_fmac_f32 v242, v2, v146
    v_mfma_f32_32x32x16_bf16 v[48:63], v[76:79], v[188:191], v[48:63]
    s_setprio 0
    v_fmac_f32 v238, v10, v162
    v_fmac_f32 v242, v3, v147
    v_fmac_f32 v238, v11, v163
    v_fmac_f32 v242, v4, v148
    v_fmac_f32 v238, v12, v164
    v_fmac_f32 v242, v5, v149
    v_fmac_f32 v238, v13, v165
    v_fmac_f32 v242, v6, v150
    v_fmac_f32 v238, v14, v166
    v_fmac_f32 v242, v7, v151
    v_fmac_f32 v238, v15, v167
    v_fmac_f32 v236, v16, v112
    v_mul_f32 v244, v24, v160
    v_fmac_f32 v236, v17, v113
    v_fmac_f32 v244, v25, v161
    v_fmac_f32 v236, v18, v114
    v_fmac_f32 v244, v26, v162
    v_fmac_f32 v236, v19, v115
    v_fmac_f32 v244, v27, v163
    v_fmac_f32 v236, v20, v116
    v_fmac_f32 v244, v28, v164
    v_fmac_f32 v236, v21, v117
    v_fmac_f32 v244, v29, v165
    v_fmac_f32 v236, v22, v118
    v_fmac_f32 v244, v30, v166
    v_fmac_f32 v236, v23, v119
    v_fmac_f32 v244, v31, v167
    v_mul_f32 v243, v32, v152
    v_fma_f32 v239, v40, v168, -v239
    v_fmac_f32 v243, v33, v153
    v_fmac_f32 v239, v41, v169
    v_fmac_f32 v243, v34, v154
    v_fmac_f32 v239, v42, v170
    v_fmac_f32 v243, v35, v155
    v_fmac_f32 v239, v43, v171
    v_fmac_f32 v243, v36, v156
    v_fmac_f32 v239, v44, v172
    v_fmac_f32 v243, v37, v157
    v_fmac_f32 v239, v45, v173
    v_fmac_f32 v243, v38, v158
    v_fmac_f32 v239, v46, v174
    v_fmac_f32 v243, v39, v159
    v_fmac_f32 v239, v47, v175
    v_fmac_f32 v237, v48, v120
    v_mul_f32 v245, v56, v168
    v_fmac_f32 v237, v49, v121
    v_fmac_f32 v245, v57, v169
    v_fmac_f32 v237, v50, v122
    s_setprio 1
    s_waitcnt vmcnt(4) lgkmcnt(1)
    v_mfma_f32_32x32x16_bf16 v[0:15], v[64:67], v[176:179], 0
    ds_read_b64_tr_b16 v[184:185], v246 offset:6144
    ds_read_b64_tr_b16 v[186:187], v246 offset:6656
    ds_read_b64_tr_b16 v[188:189], v247 offset:6144
    ds_read_b64_tr_b16 v[190:191], v247 offset:6656
    v_fmac_f32 v245, v58, v170
    v_fmac_f32 v237, v51, v123
    s_mov_b32 m0, s70
    v_mfma_f32_32x32x16_bf16 v[16:31], v[68:71], v[176:179], 0
    buffer_load_dwordx4 v226, s[4:7], s46 offen lds
    buffer_load_dwordx4 v227, s[72:75], s46 offen offset:1024 lds
    s_waitcnt lgkmcnt(4)
    v_mad_u32_u16 v229, v228, s39, v248 op_sel:[1,0,0,0]
    v_mad_u32_u16 v228, v228, s39, v248
    v_fmac_f32 v245, v59, v171
    v_fmac_f32 v237, v52, v124
    v_mfma_f32_32x32x16_bf16 v[32:47], v[64:67], v[180:183], 0
    v_fmac_f32 v245, v60, v172
    v_fmac_f32 v237, v53, v125
    v_fmac_f32 v245, v61, v173
    v_fmac_f32 v237, v54, v126
    v_fmac_f32 v245, v62, v174
    v_fmac_f32 v237, v55, v127
    v_fmac_f32 v245, v63, v175
    v_mfma_f32_32x32x16_bf16 v[48:63], v[68:71], v[180:183], 0
    v_permlane32_swap_b32 v242, v234
    v_permlane32_swap_b32 v243, v235
    v_add_f32 v242, v242, v234
    v_add_f32 v243, v243, v235
    s_waitcnt vmcnt(4) lgkmcnt(0)
    v_mfma_f32_32x32x16_bf16 v[0:15], v[72:75], v[184:187], v[0:15]
    ds_read_b64_tr_b16 v[176:177], v246 offset:0
    ds_read_b64_tr_b16 v[178:179], v246 offset:512
    ds_read_b64_tr_b16 v[180:181], v247 offset:0
    ds_read_b64_tr_b16 v[182:183], v247 offset:512
    s_sub_u32 s26, s48, s29
    s_mov_b32 s29, s48
    s_mov_b32 m0, s71
    v_mfma_f32_32x32x16_bf16 v[16:31], v[76:79], v[184:187], v[16:31]
    buffer_load_dwordx4 v228, s[4:7], s47 offen lds
    buffer_load_dwordx4 v229, s[72:75], s47 offen offset:1024 lds
    s_set_gpr_idx_on s31, gpr_idx(DST)
    s_nop 0
    v_cvt_pk_bf16_f32 v194, v242, v243
    s_set_gpr_idx_off
    s_mov_b32 s30, s3
    s_cmp_eq_u32 s34, 0
    s_cselect_b32 s56, s33, 0
    v_mfma_f32_32x32x16_bf16 v[32:47], v[72:75], v[188:191], v[32:47]
    s_mov_b32 s32, s31
    s_mov_b32 s31, s35
    v_mul_f32 v242, v0, v144
    v_fma_f32 v240, v8, v160, -v240
    v_fmac_f32 v242, v1, v145
    v_fmac_f32 v240, v9, v161
    v_fmac_f32 v242, v2, v146
    v_mfma_f32_32x32x16_bf16 v[48:63], v[76:79], v[188:191], v[48:63]
    s_setprio 0
    v_fmac_f32 v240, v10, v162
    v_fmac_f32 v242, v3, v147
    v_fmac_f32 v240, v11, v163
    v_fmac_f32 v242, v4, v148
    v_fmac_f32 v240, v12, v164
    v_fmac_f32 v242, v5, v149
    v_fmac_f32 v240, v13, v165
    v_fmac_f32 v242, v6, v150
    v_fmac_f32 v240, v14, v166
    v_fmac_f32 v242, v7, v151
    v_fmac_f32 v240, v15, v167
    v_add_u32 v249, s26, v249
    v_add_u32 v250, s26, v250
    v_fma_f32 v244, v16, v160, -v244
    v_fmac_f32 v236, v24, v112
    v_fmac_f32 v244, v17, v161
    v_fmac_f32 v236, v25, v113
    v_fmac_f32 v244, v18, v162
    v_fmac_f32 v236, v26, v114
    v_fmac_f32 v244, v19, v163
    v_fmac_f32 v236, v27, v115
    v_fmac_f32 v244, v20, v164
    v_fmac_f32 v236, v28, v116
    v_fmac_f32 v244, v21, v165
    v_fmac_f32 v236, v29, v117
    v_fmac_f32 v244, v22, v166
    v_fmac_f32 v236, v30, v118
    v_fmac_f32 v244, v23, v167
    v_fmac_f32 v236, v31, v119
    ds_read_b64_tr_b16 v[0:1], v249 offset:0
    ds_read_b64_tr_b16 v[2:3], v249 offset:128
    ds_read_b128 v[4:7], v250 offset:0
    ds_read_b128 v[8:11], v250 offset:16
    ds_read_b128 v[12:15], v250 offset:384
    ds_read_b128 v[16:19], v250 offset:400
    v_mul_f32 v243, v32, v152
    v_fma_f32 v241, v40, v168, -v241
    v_fmac_f32 v243, v33, v153
    v_fmac_f32 v241, v41, v169
    v_fmac_f32 v243, v34, v154
    v_fmac_f32 v241, v42, v170
    v_fmac_f32 v243, v35, v155
    v_fmac_f32 v241, v43, v171
    v_fmac_f32 v243, v36, v156
    v_fmac_f32 v241, v44, v172
    v_fmac_f32 v243, v37, v157
    v_fmac_f32 v241, v45, v173
    v_fmac_f32 v243, v38, v158
    v_fmac_f32 v241, v46, v174
    v_fmac_f32 v243, v39, v159
    v_fmac_f32 v241, v47, v175
    ds_read_b64_tr_b16 v[20:21], v249 offset:512
    ds_read_b64_tr_b16 v[22:23], v249 offset:640
    ds_read_b128 v[24:27], v250 offset:64
    ds_read_b128 v[28:31], v250 offset:80
    ds_read_b128 v[32:35], v250 offset:448
    ds_read_b128 v[36:39], v250 offset:464
    v_fma_f32 v245, v48, v168, -v245
    v_fmac_f32 v237, v56, v120
    v_fmac_f32 v245, v49, v169
    v_fmac_f32 v237, v57, v121
    v_fmac_f32 v245, v50, v170
    v_fmac_f32 v237, v58, v122
    v_fmac_f32 v245, v51, v171
    v_fmac_f32 v237, v59, v123
    v_fmac_f32 v245, v52, v172
    v_fmac_f32 v237, v60, v124
    v_fmac_f32 v245, v53, v173
    v_fmac_f32 v237, v61, v125
    v_fmac_f32 v245, v54, v174
    v_fmac_f32 v237, v62, v126
    v_fmac_f32 v245, v55, v175
    v_fmac_f32 v237, v63, v127
    s_cmp_eq_u32 s56, 2
    s_cbranch_scc1 K2_U20
    s_cmp_eq_u32 s56, 3
    s_cbranch_scc1 K2_U30
    s_branch K2_DSP0
K2_U30:
    s_setprio 1
    s_waitcnt lgkmcnt(6)
    v_lshlrev_b32 v40, 16, v0
    v_and_b32 v41, 0xffff0000, v0
    v_lshlrev_b32 v42, 16, v1
    v_and_b32 v43, 0xffff0000, v1
    v_lshlrev_b32 v44, 16, v2
    v_and_b32 v45, 0xffff0000, v2
    v_lshlrev_b32 v46, 16, v3
    v_and_b32 v47, 0xffff0000, v3
    v_mul_f32 v4, v40, v4
    v_mul_f32 v5, v41, v5
    v_mul_f32 v6, v42, v6
    v_mul_f32 v7, v43, v7
    v_mul_f32 v8, v44, v8
    v_mul_f32 v9, v45, v9
    v_mul_f32 v10, v46, v10
    v_mul_f32 v11, v47, v11
    v_cvt_pk_bf16_f32 v64, v4, v5
    v_cvt_pk_bf16_f32 v65, v6, v7
    v_cvt_pk_bf16_f32 v66, v8, v9
    v_cvt_pk_bf16_f32 v67, v10, v11
    v_mul_f32 v12, v40, v12
    v_mul_f32 v13, v41, v13
    v_mul_f32 v14, v42, v14
    v_mul_f32 v15, v43, v15
    v_mul_f32 v16, v44, v16
    v_mul_f32 v17, v45, v17
    v_mul_f32 v18, v46, v18
    v_mul_f32 v19, v47, v19
    v_cvt_pk_bf16_f32 v68, v12, v13
    v_cvt_pk_bf16_f32 v69, v14, v15
    v_cvt_pk_bf16_f32 v70, v16, v17
    v_cvt_pk_bf16_f32 v71, v18, v19
    ds_read_b64_tr_b16 v[0:1], v249 offset:1024
    ds_read_b64_tr_b16 v[2:3], v249 offset:1152
    ds_read_b128 v[4:7], v250 offset:128
    ds_read_b128 v[8:11], v250 offset:144
    ds_read_b128 v[12:15], v250 offset:512
    ds_read_b128 v[16:19], v250 offset:528
    s_waitcnt lgkmcnt(6)
    v_lshlrev_b32 v48, 16, v20
    v_and_b32 v49, 0xffff0000, v20
    v_lshlrev_b32 v50, 16, v21
    v_and_b32 v51, 0xffff0000, v21
    v_lshlrev_b32 v52, 16, v22
    v_and_b32 v53, 0xffff0000, v22
    v_lshlrev_b32 v54, 16, v23
    v_and_b32 v55, 0xffff0000, v23
    v_mul_f32 v24, v48, v24
    v_mul_f32 v25, v49, v25
    v_mul_f32 v26, v50, v26
    v_mul_f32 v27, v51, v27
    v_mul_f32 v28, v52, v28
    v_mul_f32 v29, v53, v29
    v_mul_f32 v30, v54, v30
    v_mul_f32 v31, v55, v31
    v_cvt_pk_bf16_f32 v72, v24, v25
    v_cvt_pk_bf16_f32 v73, v26, v27
    v_cvt_pk_bf16_f32 v74, v28, v29
    v_cvt_pk_bf16_f32 v75, v30, v31
    v_mul_f32 v32, v48, v32
    v_mul_f32 v33, v49, v33
    v_mul_f32 v34, v50, v34
    v_mul_f32 v35, v51, v35
    v_mul_f32 v36, v52, v36
    v_mul_f32 v37, v53, v37
    v_mul_f32 v38, v54, v38
    v_mul_f32 v39, v55, v39
    v_cvt_pk_bf16_f32 v76, v32, v33
    v_cvt_pk_bf16_f32 v77, v34, v35
    v_cvt_pk_bf16_f32 v78, v36, v37
    v_cvt_pk_bf16_f32 v79, v38, v39
    s_waitcnt lgkmcnt(4)
    v_lshlrev_b32 v40, 16, v0
    v_and_b32 v41, 0xffff0000, v0
    v_lshlrev_b32 v42, 16, v1
    v_and_b32 v43, 0xffff0000, v1
    v_lshlrev_b32 v44, 16, v2
    v_and_b32 v45, 0xffff0000, v2
    v_lshlrev_b32 v46, 16, v3
    v_and_b32 v47, 0xffff0000, v3
    s_waitcnt lgkmcnt(2)
    v_mul_f32 v4, v40, v4
    v_mul_f32 v5, v41, v5
    v_mul_f32 v6, v42, v6
    v_mul_f32 v7, v43, v7
    v_mul_f32 v8, v44, v8
    v_mul_f32 v9, v45, v9
    v_mul_f32 v10, v46, v10
    v_mul_f32 v11, v47, v11
    v_cvt_pk_bf16_f32 v80, v4, v5
    v_cvt_pk_bf16_f32 v81, v6, v7
    v_cvt_pk_bf16_f32 v82, v8, v9
    v_cvt_pk_bf16_f32 v83, v10, v11
    s_waitcnt lgkmcnt(0)
    v_mul_f32 v12, v40, v12
    v_mul_f32 v13, v41, v13
    v_mul_f32 v14, v42, v14
    v_mul_f32 v15, v43, v15
    v_mul_f32 v16, v44, v16
    v_mul_f32 v17, v45, v17
    v_mul_f32 v18, v46, v18
    v_mul_f32 v19, v47, v19
    v_cvt_pk_bf16_f32 v84, v12, v13
    v_cvt_pk_bf16_f32 v85, v14, v15
    v_cvt_pk_bf16_f32 v86, v16, v17
    v_cvt_pk_bf16_f32 v87, v18, v19
    s_waitcnt vmcnt(4)
    v_mfma_f32_32x32x16_bf16 v[0:15], v[64:67], v[176:179], 0
    ds_read_b64_tr_b16 v[184:185], v246 offset:2048
    ds_read_b64_tr_b16 v[186:187], v246 offset:2560
    ds_read_b64_tr_b16 v[188:189], v247 offset:2048
    ds_read_b64_tr_b16 v[190:191], v247 offset:2560
    s_mov_b32 m0, s68
    v_mfma_f32_32x32x16_bf16 v[16:31], v[68:71], v[176:179], 0
    buffer_load_dwordx4 v224, s[4:7], s41 offen lds
    buffer_load_dwordx4 v225, s[72:75], s41 offen offset:1024 lds
    v_permlane32_swap_b32 v242, v236
    v_permlane32_swap_b32 v243, v237
    s_add_u32 s38, s38, 1
    v_mfma_f32_32x32x16_bf16 v[32:47], v[64:67], v[180:183], 0
    v_permlane32_swap_b32 v244, v238
    v_permlane32_swap_b32 v245, v239
    v_permlane32_swap_b32 v240, v241
    v_add_f32 v242, v242, v236
    v_mfma_f32_32x32x16_bf16 v[48:63], v[68:71], v[180:183], 0
    v_add_f32 v243, v243, v237
    v_add_f32 v244, v244, v238
    v_add_f32 v245, v245, v239
    v_add_f32 v240, -v240, -v241
    v_mov_b32 v254, s52
    v_mov_b32 v255, s38
    s_waitcnt vmcnt(4) lgkmcnt(0)
    v_mfma_f32_32x32x16_bf16 v[0:15], v[72:75], v[184:187], v[0:15]
    ds_read_b64_tr_b16 v[176:177], v246 offset:4096
    ds_read_b64_tr_b16 v[178:179], v246 offset:4608
    ds_read_b64_tr_b16 v[180:181], v247 offset:4096
    ds_read_b64_tr_b16 v[182:183], v247 offset:4608
    s_lshl_b32 s58, s38, 3
    s_add_u32 s58, s58, s20
    s_mov_b32 m0, s69
    v_mfma_f32_32x32x16_bf16 v[16:31], v[76:79], v[184:187], v[16:31]
    buffer_load_dwordx4 v226, s[4:7], s41 offen lds
    buffer_load_dwordx4 v227, s[72:75], s41 offen offset:1024 lds
    s_set_gpr_idx_on s32, gpr_idx(DST)
    s_nop 0
    v_cvt_pk_bf16_f32 v195, v242, v243
    v_cvt_pk_bf16_f32 v196, v244, v245
    v_cvt_pk_bf16_f32 v197, v240, v240
    s_set_gpr_idx_off
    s_mov_b64 exec, 1
    ds_write_b32 v254, v255
    s_mov_b64 exec, -1
    s_cmp_lt_u32 s58, s22
    s_cbranch_scc0 K2_dyn_31
K2_back_32:
    v_readlane_b32 s3, v253, s58
    s_lshl_b32 s44, s34, 7
    s_lshl_b32 s60, s58, 5
    s_and_b32 s48, s3, 0x3ffff
    s_bfe_u32 s33, s3, 0x30012
    s_sub_u32 s60, s60, s48
    s_and_b32 s60, s60, 0xff
    s_add_u32 s60, s60, s48
    s_mul_i32 s35, s38, 6
    s_cmp_eq_u32 s34, 0
    s_cselect_b32 s35, s35, s60
    s_mov_b32 s45, s44
    s_add_u32 s47, s44, 256
    s_add_u32 s49, s48, 32
    s_add_u32 s60, s48, 64
    s_cmp_eq_u32 s33, 3
    s_cselect_b32 s46, s44, s47
    s_cselect_b32 s50, s60, s48
    s_cselect_b32 s51, s48, s49
    s_sub_u32 s60, s33, 2
    s_cmp_lt_u32 s60, 2
    s_cbranch_scc0 K2_rare_37
K2_back_38:
    v_mfma_f32_32x32x16_bf16 v[32:47], v[72:75], v[188:191], v[32:47]
    v_add_u32 v233, s48, v230
    ds_read_b32 v232, v233
    ds_read_b32 v233, v233 offset:1024
    v_mfma_f32_32x32x16_bf16 v[48:63], v[76:79], v[188:191], v[48:63]
    s_waitcnt vmcnt(4) lgkmcnt(3)
    v_mfma_f32_32x32x16_bf16 v[0:15], v[80:83], v[176:179], v[0:15]
    ds_read_b64_tr_b16 v[184:185], v246 offset:6144
    ds_read_b64_tr_b16 v[186:187], v246 offset:6656
    ds_read_b64_tr_b16 v[188:189], v247 offset:6144
    ds_read_b64_tr_b16 v[190:191], v247 offset:6656
    s_mov_b32 m0, s70
    v_mfma_f32_32x32x16_bf16 v[16:31], v[84:87], v[176:179], v[16:31]
    buffer_load_dwordx4 v222, s[4:7], s42 offen lds
    buffer_load_dwordx4 v223, s[72:75], s42 offen offset:1024 lds
    v_mfma_f32_32x32x16_bf16 v[32:47], v[80:83], v[180:183], v[32:47]
    s_nop 2
    v_mul_f32 v234, v0, v96
    v_mul_f32 v236, v8, v128
    v_fmac_f32 v234, v1, v97
    v_fmac_f32 v236, v9, v129
    v_fmac_f32 v234, v2, v98
    v_fmac_f32 v236, v10, v130
    v_fmac_f32 v234, v3, v99
    v_mfma_f32_32x32x16_bf16 v[48:63], v[84:87], v[180:183], v[48:63]
    s_setprio 0
    s_waitcnt lgkmcnt(4)
    v_or_b32 v232, v232, v231
    v_or_b32 v233, v233, v231
    s_cmp_lg_u32 s34, 0
    s_cbranch_scc1 K2_dum_40
    s_add_u32 m0, s48, 864
    s_add_u32 s65, s48, 1888
    buffer_load_dwordx4 v232, s[16:19], 0 offen  lds
    s_mov_b32 m0, s65
    s_mov_b32 exec_hi, 0
    buffer_load_dwordx4 v233, s[16:19], 0 offen  lds
    s_cmp_eq_u32 s33, 4
    s_cbranch_scc1 K2_a4_41
K2_b4_43:
    s_mov_b32 exec_hi, -1
K2_back_42:
    v_fmac_f32 v236, v11, v131
    v_fmac_f32 v234, v4, v100
    v_fmac_f32 v236, v12, v132
    v_fmac_f32 v234, v5, v101
    v_fmac_f32 v236, v13, v133
    v_fmac_f32 v234, v6, v102
    v_fmac_f32 v236, v14, v134
    v_fmac_f32 v234, v7, v103
    v_fmac_f32 v236, v15, v135
    v_mul_f32 v238, v16, v128
    v_mul_f32 v240, v24, v128
    v_fmac_f32 v238, v17, v129
    v_fmac_f32 v240, v25, v129
    v_fmac_f32 v238, v18, v130
    v_fmac_f32 v240, v26, v130
    v_fmac_f32 v238, v19, v131
    v_fmac_f32 v240, v27, v131
    v_fmac_f32 v238, v20, v132
    v_fmac_f32 v240, v28, v132
    v_fmac_f32 v238, v21, v133
    v_fmac_f32 v240, v29, v133
    v_fmac_f32 v238, v22, v134
    v_fmac_f32 v240, v30, v134
    v_fmac_f32 v238, v23, v135
    v_fmac_f32 v240, v31, v135
    v_mul_f32 v235, v32, v104
    v_mul_f32 v237, v40, v136
    v_fmac_f32 v235, v33, v105
    v_fmac_f32 v237, v41, v137
    v_fmac_f32 v235, v34, v106
    v_fmac_f32 v237, v42, v138
    v_fmac_f32 v235, v35, v107
    v_fmac_f32 v237, v43, v139
    v_fmac_f32 v235, v36, v108
    v_fmac_f32 v237, v44, v140
    v_fmac_f32 v235, v37, v109
    v_fmac_f32 v237, v45, v141
    v_fmac_f32 v235, v38, v110
    v_fmac_f32 v237, v46, v142
    v_fmac_f32 v235, v39, v111
    v_fmac_f32 v237, v47, v143
    v_mul_f32 v239, v48, v136
    v_mul_f32 v241, v56, v136
    s_setprio 1
    s_waitcnt vmcnt(6) lgkmcnt(0)
    v_mfma_f32_32x32x16_bf16 v[0:15], v[64:67], v[184:187], 0
    ds_read_b64_tr_b16 v[176:177], v246 offset:0
    ds_read_b64_tr_b16 v[178:179], v246 offset:512
    ds_read_b64_tr_b16 v[180:181], v247 offset:0
    ds_read_b64_tr_b16 v[182:183], v247 offset:512
    v_fmac_f32 v239, v49, v137
    v_fmac_f32 v241, v57, v137
    s_mov_b32 m0, s71
    v_mfma_f32_32x32x16_bf16 v[16:31], v[68:71], v[184:187], 0
    buffer_load_dwordx4 v224, s[4:7], s42 offen lds
    buffer_load_dwordx4 v225, s[72:75], s42 offen offset:1024 lds
    v_fmac_f32 v239, v50, v138
    v_fmac_f32 v241, v58, v138
    v_fmac_f32 v239, v51, v139
    v_fmac_f32 v241, v59, v139
    v_fmac_f32 v239, v52, v140
    v_mfma_f32_32x32x16_bf16 v[32:47], v[64:67], v[188:191], 0
    v_fmac_f32 v241, v60, v140
    v_fmac_f32 v239, v53, v141
    v_fmac_f32 v241, v61, v141
    v_fmac_f32 v239, v54, v142
    v_fmac_f32 v241, v62, v142
    v_fmac_f32 v239, v55, v143
    v_fmac_f32 v241, v63, v143
    v_mfma_f32_32x32x16_bf16 v[48:63], v[68:71], v[188:191], 0
    v_permlane32_swap_b32 v234, v236
    v_permlane32_swap_b32 v235, v237
    v_permlane32_swap_b32 v240, v238
    s_waitcnt vmcnt(6) lgkmcnt(0)
    v_mfma_f32_32x32x16_bf16 v[0:15], v[72:75], v[176:179], v[0:15]
    ds_read_b64_tr_b16 v[184:185], v246 offset:2048
    ds_read_b64_tr_b16 v[186:187], v246 offset:2560
    ds_read_b64_tr_b16 v[188:189], v247 offset:2048
    ds_read_b64_tr_b16 v[190:191], v247 offset:2560
    v_permlane32_swap_b32 v241, v239
    s_mov_b32 m0, s68
    v_mfma_f32_32x32x16_bf16 v[16:31], v[76:79], v[176:179], v[16:31]
    buffer_load_dwordx4 v226, s[4:7], s42 offen lds
    buffer_load_dwordx4 v227, s[72:75], s42 offen offset:1024 lds
    v_add_f32 v234, v234, v236
    v_add_f32 v235, v235, v237
    v_add_f32 v240, v240, v238
    v_add_f32 v241, v241, v239
    v_mfma_f32_32x32x16_bf16 v[32:47], v[72:75], v[180:183], v[32:47]
    s_set_gpr_idx_on s31, gpr_idx(DST)
    s_nop 0
    v_cvt_pk_bf16_f32 v192, v234, v235
    v_cvt_pk_bf16_f32 v193, v240, v241
    s_set_gpr_idx_off
    v_mfma_f32_32x32x16_bf16 v[48:63], v[76:79], v[180:183], v[48:63]
    s_waitcnt vmcnt(6) lgkmcnt(0)
    v_mfma_f32_32x32x16_bf16 v[0:15], v[80:83], v[184:187], v[0:15]
    ds_read_b64_tr_b16 v[176:177], v246 offset:4096
    ds_read_b64_tr_b16 v[178:179], v246 offset:4608
    ds_read_b64_tr_b16 v[180:181], v247 offset:4096
    ds_read_b64_tr_b16 v[182:183], v247 offset:4608
    s_mov_b32 m0, s69
    v_mfma_f32_32x32x16_bf16 v[16:31], v[84:87], v[184:187], v[16:31]
    buffer_load_dwordx4 v222, s[4:7], s43 offen lds
    buffer_load_dwordx4 v223, s[72:75], s43 offen offset:1024 lds
    v_mfma_f32_32x32x16_bf16 v[32:47], v[80:83], v[188:191], v[32:47]
    s_nop 2
    v_mul_f32 v234, v0, v144
    v_mul_f32 v236, v8, v112
    v_fmac_f32 v234, v1, v145
    v_fmac_f32 v236, v9, v113
    v_fmac_f32 v234, v2, v146
    v_fmac_f32 v236, v10, v114
    v_fmac_f32 v234, v3, v147
    v_mfma_f32_32x32x16_bf16 v[48:63], v[84:87], v[188:191], v[48:63]
    s_setprio 0
    v_fmac_f32 v236, v11, v115
    v_fmac_f32 v234, v4, v148
    v_fmac_f32 v236, v12, v116
    v_fmac_f32 v234, v5, v149
    v_fmac_f32 v236, v13, v117
    v_fmac_f32 v234, v6, v150
    v_fmac_f32 v236, v14, v118
    v_fmac_f32 v234, v7, v151
    v_fmac_f32 v236, v15, v119
    v_mul_f32 v238, v16, v160
    v_mul_f32 v240, v24, v160
    v_fmac_f32 v238, v17, v161
    v_fmac_f32 v240, v25, v161
    v_fmac_f32 v238, v18, v162
    v_fmac_f32 v240, v26, v162
    v_fmac_f32 v238, v19, v163
    v_fmac_f32 v240, v27, v163
    v_fmac_f32 v238, v20, v164
    v_fmac_f32 v240, v28, v164
    v_fmac_f32 v238, v21, v165
    v_fmac_f32 v240, v29, v165
    v_fmac_f32 v238, v22, v166
    v_fmac_f32 v240, v30, v166
    v_fmac_f32 v238, v23, v167
    v_fmac_f32 v240, v31, v167
    v_mul_f32 v235, v32, v152
    v_mul_f32 v237, v40, v120
    v_fmac_f32 v235, v33, v153
    v_fmac_f32 v237, v41, v121
    v_fmac_f32 v235, v34, v154
    v_fmac_f32 v237, v42, v122
    v_fmac_f32 v235, v35, v155
    v_fmac_f32 v237, v43, v123
    v_fmac_f32 v235, v36, v156
    v_fmac_f32 v237, v44, v124
    v_fmac_f32 v235, v37, v157
    v_fmac_f32 v237, v45, v125
    v_fmac_f32 v235, v38, v158
    v_fmac_f32 v237, v46, v126
    v_fmac_f32 v235, v39, v159
    v_fmac_f32 v237, v47, v127
    v_mul_f32 v239, v48, v168
    v_mul_f32 v241, v56, v168
    v_fmac_f32 v239, v49, v169
    v_fmac_f32 v241, v57, v169
    s_setprio 1
    s_waitcnt vmcnt(4) lgkmcnt(0)
    v_mfma_f32_32x32x16_bf16 v[0:15], v[64:67], v[176:179], 0
    ds_read_b64_tr_b16 v[184:185], v246 offset:6144
    ds_read_b64_tr_b16 v[186:187], v246 offset:6656
    ds_read_b64_tr_b16 v[188:189], v247 offset:6144
    ds_read_b64_tr_b16 v[190:191], v247 offset:6656
    v_fmac_f32 v239, v50, v170
    v_fmac_f32 v241, v58, v170
    s_mov_b32 m0, s70
    v_mfma_f32_32x32x16_bf16 v[16:31], v[68:71], v[176:179], 0
    buffer_load_dwordx4 v224, s[4:7], s43 offen lds
    buffer_load_dwordx4 v225, s[72:75], s43 offen offset:1024 lds
    v_fmac_f32 v239, v51, v171
    v_fmac_f32 v241, v59, v171
    v_fmac_f32 v239, v52, v172
    v_fmac_f32 v241, v60, v172
    v_fmac_f32 v239, v53, v173
    v_mfma_f32_32x32x16_bf16 v[32:47], v[64:67], v[180:183], 0
    v_add_u32 v222, s48, v251
    ds_read_b32 v222, v222
    v_fmac_f32 v241, v61, v173
    v_fmac_f32 v239, v54, v174
    v_fmac_f32 v241, v62, v174
    v_fmac_f32 v239, v55, v175
    v_fmac_f32 v241, v63, v175
    v_mfma_f32_32x32x16_bf16 v[48:63], v[68:71], v[180:183], 0
    s_waitcnt vmcnt(4) lgkmcnt(1)
    v_mfma_f32_32x32x16_bf16 v[0:15], v[72:75], v[184:187], v[0:15]
    ds_read_b64_tr_b16 v[176:177], v246 offset:0
    ds_read_b64_tr_b16 v[178:179], v246 offset:512
    ds_read_b64_tr_b16 v[180:181], v247 offset:0
    ds_read_b64_tr_b16 v[182:183], v247 offset:512
    s_mov_b32 m0, s71
    v_mfma_f32_32x32x16_bf16 v[16:31], v[76:79], v[184:187], v[16:31]
    buffer_load_dwordx4 v226, s[4:7], s43 offen lds
    buffer_load_dwordx4 v227, s[72:75], s43 offen offset:1024 lds
    s_waitcnt lgkmcnt(4)
    v_mad_u32_u16 v223, v222, s39, v248 op_sel:[1,0,0,0]
    v_mad_u32_u16 v222, v222, s39, v248
    v_mfma_f32_32x32x16_bf16 v[32:47], v[72:75], v[188:191], v[32:47]
    v_add_u32 v224, s49, v251
    ds_read_b32 v224, v224
    v_mfma_f32_32x32x16_bf16 v[48:63], v[76:79], v[188:191], v[48:63]
    s_waitcnt vmcnt(4) lgkmcnt(1)
    v_mfma_f32_32x32x16_bf16 v[0:15], v[80:83], v[176:179], v[0:15]
    ds_read_b64_tr_b16 v[184:185], v246 offset:2048
    ds_read_b64_tr_b16 v[186:187], v246 offset:2560
    ds_read_b64_tr_b16 v[188:189], v247 offset:2048
    ds_read_b64_tr_b16 v[190:191], v247 offset:2560
    s_mov_b32 m0, s68
    v_mfma_f32_32x32x16_bf16 v[16:31], v[84:87], v[176:179], v[16:31]
    buffer_load_dwordx4 v222, s[4:7], s44 offen lds
    buffer_load_dwordx4 v223, s[72:75], s44 offen offset:1024 lds
    s_waitcnt lgkmcnt(4)
    v_mad_u32_u16 v225, v224, s39, v248 op_sel:[1,0,0,0]
    v_mad_u32_u16 v224, v224, s39, v248
    v_mfma_f32_32x32x16_bf16 v[32:47], v[80:83], v[180:183], v[32:47]
    v_add_u32 v226, s50, v251
    ds_read_b32 v226, v226
    v_mul_f32 v242, v0, v144
    v_fma_f32 v238, v8, v160, -v238
    v_fmac_f32 v242, v1, v145
    v_fmac_f32 v238, v9, v161
    v_fmac_f32 v242, v2, v146
    v_mfma_f32_32x32x16_bf16 v[48:63], v[84:87], v[180:183], v[48:63]
    s_setprio 0
    v_fmac_f32 v238, v10, v162
    v_fmac_f32 v242, v3, v147
    v_fmac_f32 v238, v11, v163
    v_fmac_f32 v242, v4, v148
    v_fmac_f32 v238, v12, v164
    v_fmac_f32 v242, v5, v149
    v_fmac_f32 v238, v13, v165
    v_fmac_f32 v242, v6, v150
    v_fmac_f32 v238, v14, v166
    v_fmac_f32 v242, v7, v151
    v_fmac_f32 v238, v15, v167
    v_fmac_f32 v236, v16, v112
    v_mul_f32 v244, v24, v160
    v_fmac_f32 v236, v17, v113
    v_fmac_f32 v244, v25, v161
    v_fmac_f32 v236, v18, v114
    v_fmac_f32 v244, v26, v162
    v_fmac_f32 v236, v19, v115
    v_fmac_f32 v244, v27, v163
    v_fmac_f32 v236, v20, v116
    v_fmac_f32 v244, v28, v164
    v_fmac_f32 v236, v21, v117
    v_fmac_f32 v244, v29, v165
    v_fmac_f32 v236, v22, v118
    v_fmac_f32 v244, v30, v166
    v_fmac_f32 v236, v23, v119
    v_fmac_f32 v244, v31, v167
    v_mul_f32 v243, v32, v152
    v_fma_f32 v239, v40, v168, -v239
    v_fmac_f32 v243, v33, v153
    v_fmac_f32 v239, v41, v169
    v_fmac_f32 v243, v34, v154
    v_fmac_f32 v239, v42, v170
    v_fmac_f32 v243, v35, v155
    v_fmac_f32 v239, v43, v171
    v_fmac_f32 v243, v36, v156
    v_fmac_f32 v239, v44, v172
    v_fmac_f32 v243, v37, v157
    v_fmac_f32 v239, v45, v173
    v_fmac_f32 v243, v38, v158
    v_fmac_f32 v239, v46, v174
    v_fmac_f32 v243, v39, v159
    v_fmac_f32 v239, v47, v175
    v_fmac_f32 v237, v48, v120
    v_mul_f32 v245, v56, v168
    v_fmac_f32 v237, v49, v121
    v_fmac_f32 v245, v57, v169
    v_fmac_f32 v237, v50, v122
    v_fmac_f32 v245, v58, v170
    v_fmac_f32 v237, v51, v123
    s_setprio 1
    s_waitcnt vmcnt(4) lgkmcnt(1)
    v_mfma_f32_32x32x16_bf16 v[0:15], v[64:67], v[184:187], 0
    ds_read_b64_tr_b16 v[176:177], v246 offset:4096
    ds_read_b64_tr_b16 v[178:179], v246 offset:4608
    ds_read_b64_tr_b16 v[180:181], v247 offset:4096
    ds_read_b64_tr_b16 v[182:183], v247 offset:4608
    v_fmac_f32 v245, v59, v171
    v_fmac_f32 v237, v52, v124
    s_mov_b32 m0, s69
    v_mfma_f32_32x32x16_bf16 v[16:31], v[68:71], v[184:187], 0
    buffer_load_dwordx4 v224, s[4:7], s45 offen lds
    buffer_load_dwordx4 v225, s[72:75], s45 offen offset:1024 lds
    s_waitcnt lgkmcnt(4)
    v_mad_u32_u16 v227, v226, s39, v248 op_sel:[1,0,0,0]
    v_mad_u32_u16 v226, v226, s39, v248
    v_fmac_f32 v245, v60, v172
    v_fmac_f32 v237, v53, v125
    v_mfma_f32_32x32x16_bf16 v[32:47], v[64:67], v[188:191], 0
    v_add_u32 v228, s51, v251
    ds_read_b32 v228, v228
    v_fmac_f32 v245, v61, v173
    v_fmac_f32 v237, v54, v126
    v_fmac_f32 v245, v62, v174
    v_fmac_f32 v237, v55, v127
    v_fmac_f32 v245, v63, v175
    v_mfma_f32_32x32x16_bf16 v[48:63], v[68:71], v[188:191], 0
    v_permlane32_swap_b32 v242, v234
    v_permlane32_swap_b32 v243, v235
    v_add_f32 v242, v242, v234
    v_add_f32 v243, v243, v235
    s_waitcnt vmcnt(4) lgkmcnt(1)
    v_mfma_f32_32x32x16_bf16 v[0:15], v[72:75], v[176:179], v[0:15]
    ds_read_b64_tr_b16 v[184:185], v246 offset:6144
    ds_read_b64_tr_b16 v[186:187], v246 offset:6656
    ds_read_b64_tr_b16 v[188:189], v247 offset:6144
    ds_read_b64_tr_b16 v[190:191], v247 offset:6656
    s_mov_b32 m0, s70
    v_mfma_f32_32x32x16_bf16 v[16:31], v[76:79], v[176:179], v[16:31]
    buffer_load_dwordx4 v226, s[4:7], s46 offen lds
    buffer_load_dwordx4 v227, s[72:75], s46 offen offset:1024 lds
    s_waitcnt lgkmcnt(4)
    v_mad_u32_u16 v229, v228, s39, v248 op_sel:[1,0,0,0]
    v_mad_u32_u16 v228, v228, s39, v248
    s_sub_u32 s26, s48, s29
    s_mov_b32 s29, s48
    v_mfma_f32_32x32x16_bf16 v[32:47], v[72:75], v[180:183], v[32:47]
    s_set_gpr_idx_on s31, gpr_idx(DST)
    s_nop 0
    v_cvt_pk_bf16_f32 v194, v242, v243
    s_set_gpr_idx_off
    s_mov_b32 s30, s3
    s_cmp_eq_u32 s34, 0
    s_cselect_b32 s56, s33, 0
    s_mov_b32 s32, s31
    v_mfma_f32_32x32x16_bf16 v[48:63], v[76:79], v[180:183], v[48:63]
    s_mov_b32 s31, s35
    s_waitcnt vmcnt(4) lgkmcnt(0)
    v_mfma_f32_32x32x16_bf16 v[0:15], v[80:83], v[184:187], v[0:15]
    ds_read_b64_tr_b16 v[176:177], v246 offset:0
    ds_read_b64_tr_b16 v[178:179], v246 offset:512
    ds_read_b64_tr_b16 v[180:181], v247 offset:0
    ds_read_b64_tr_b16 v[182:183], v247 offset:512
    s_mov_b32 m0, s71
    v_mfma_f32_32x32x16_bf16 v[16:31], v[84:87], v[184:187], v[16:31]
    buffer_load_dwordx4 v228, s[4:7], s47 offen lds
    buffer_load_dwordx4 v229, s[72:75], s47 offen offset:1024 lds
    v_mfma_f32_32x32x16_bf16 v[32:47], v[80:83], v[188:191], v[32:47]
    s_nop 2
    v_mul_f32 v242, v0, v144
    v_fma_f32 v240, v8, v160, -v240
    v_fmac_f32 v242, v1, v145
    v_fmac_f32 v240, v9, v161
    v_fmac_f32 v242, v2, v146
    v_fmac_f32 v240, v10, v162
    v_fmac_f32 v242, v3, v147
    v_mfma_f32_32x32x16_bf16 v[48:63], v[84:87], v[188:191], v[48:63]
    s_setprio 0
    v_fmac_f32 v240, v11, v163
    v_fmac_f32 v242, v4, v148
    v_fmac_f32 v240, v12, v164
    v_fmac_f32 v242, v5, v149
    v_fmac_f32 v240, v13, v165
    v_fmac_f32 v242, v6, v150
    v_fmac_f32 v240, v14, v166
    v_fmac_f32 v242, v7, v151
    v_fmac_f32 v240, v15, v167
    v_add_u32 v249, s26, v249
    v_add_u32 v250, s26, v250
    v_fma_f32 v244, v16, v160, -v244
    v_fmac_f32 v236, v24, v112
    v_fmac_f32 v244, v17, v161
    v_fmac_f32 v236, v25, v113
    v_fmac_f32 v244, v18, v162
    v_fmac_f32 v236, v26, v114
    v_fmac_f32 v244, v19, v163
    v_fmac_f32 v236, v27, v115
    v_fmac_f32 v244, v20, v164
    v_fmac_f32 v236, v28, v116
    v_fmac_f32 v244, v21, v165
    v_fmac_f32 v236, v29, v117
    v_fmac_f32 v244, v22, v166
    v_fmac_f32 v236, v30, v118
    v_fmac_f32 v244, v23, v167
    v_fmac_f32 v236, v31, v119
    ds_read_b64_tr_b16 v[0:1], v249 offset:0
    ds_read_b64_tr_b16 v[2:3], v249 offset:128
    ds_read_b128 v[4:7], v250 offset:0
    ds_read_b128 v[8:11], v250 offset:16
    ds_read_b128 v[12:15], v250 offset:384
    ds_read_b128 v[16:19], v250 offset:400
    v_mul_f32 v243, v32, v152
    v_fma_f32 v241, v40, v168, -v241
    v_fmac_f32 v243, v33, v153
    v_fmac_f32 v241, v41, v169
    v_fmac_f32 v243, v34, v154
    v_fmac_f32 v241, v42, v170
    v_fmac_f32 v243, v35, v155
    v_fmac_f32 v241, v43, v171
    v_fmac_f32 v243, v36, v156
    v_fmac_f32 v241, v44, v172
    v_fmac_f32 v243, v37, v157
    v_fmac_f32 v241, v45, v173
    v_fmac_f32 v243, v38, v158
    v_fmac_f32 v241, v46, v174
    v_fmac_f32 v243, v39, v159
    v_fmac_f32 v241, v47, v175
    ds_read_b64_tr_b16 v[20:21], v249 offset:512
    ds_read_b64_tr_b16 v[22:23], v249 offset:640
    ds_read_b128 v[24:27], v250 offset:64
    ds_read_b128 v[28:31], v250 offset:80
    ds_read_b128 v[32:35], v250 offset:448
    ds_read_b128 v[36:39], v250 offset:464
    v_fma_f32 v245, v48, v168, -v245
    v_fmac_f32 v237, v56, v120
    v_fmac_f32 v245, v49, v169
    v_fmac_f32 v237, v57, v121
    v_fmac_f32 v245, v50, v170
    v_fmac_f32 v237, v58, v122
    v_fmac_f32 v245, v51, v171
    v_fmac_f32 v237, v59, v123
    v_fmac_f32 v245, v52, v172
    v_fmac_f32 v237, v60, v124
    v_fmac_f32 v245, v53, v173
    v_fmac_f32 v237, v61, v125
    v_fmac_f32 v245, v54, v174
    v_fmac_f32 v237, v62, v126
    v_fmac_f32 v245, v55, v175
    v_fmac_f32 v237, v63, v127
    s_cmp_eq_u32 s56, 2
    s_cbranch_scc1 K2_U20
    s_cmp_eq_u32 s56, 3
    s_cbranch_scc1 K2_U30
    s_branch K2_DSP0
K2_U21:
    s_setprio 1
    s_waitcnt lgkmcnt(6)
    v_lshlrev_b32 v40, 16, v0
    v_and_b32 v41, 0xffff0000, v0
    v_lshlrev_b32 v42, 16, v1
    v_and_b32 v43, 0xffff0000, v1
    v_lshlrev_b32 v44, 16, v2
    v_and_b32 v45, 0xffff0000, v2
    v_lshlrev_b32 v46, 16, v3
    v_and_b32 v47, 0xffff0000, v3
    v_mul_f32 v4, v40, v4
    v_mul_f32 v5, v41, v5
    v_mul_f32 v6, v42, v6
    v_mul_f32 v7, v43, v7
    v_mul_f32 v8, v44, v8
    v_mul_f32 v9, v45, v9
    v_mul_f32 v10, v46, v10
    v_mul_f32 v11, v47, v11
    v_cvt_pk_bf16_f32 v64, v4, v5
    v_cvt_pk_bf16_f32 v65, v6, v7
    v_cvt_pk_bf16_f32 v66, v8, v9
    v_cvt_pk_bf16_f32 v67, v10, v11
    v_mul_f32 v12, v40, v12
    v_mul_f32 v13, v41, v13
    v_mul_f32 v14, v42, v14
    v_mul_f32 v15, v43, v15
    v_mul_f32 v16, v44, v16
    v_mul_f32 v17, v45, v17
    v_mul_f32 v18, v46, v18
    v_mul_f32 v19, v47, v19
    v_cvt_pk_bf16_f32 v68, v12, v13
    v_cvt_pk_bf16_f32 v69, v14, v15
    v_cvt_pk_bf16_f32 v70, v16, v17
    v_cvt_pk_bf16_f32 v71, v18, v19
    s_waitcnt lgkmcnt(0)
    v_lshlrev_b32 v48, 16, v20
    v_and_b32 v49, 0xffff0000, v20
    v_lshlrev_b32 v50, 16, v21
    v_and_b32 v51, 0xffff0000, v21
    v_lshlrev_b32 v52, 16, v22
    v_and_b32 v53, 0xffff0000, v22
    v_lshlrev_b32 v54, 16, v23
    v_and_b32 v55, 0xffff0000, v23
    v_mul_f32 v24, v48, v24
    v_mul_f32 v25, v49, v25
    v_mul_f32 v26, v50, v26
    v_mul_f32 v27, v51, v27
    v_mul_f32 v28, v52, v28
    v_mul_f32 v29, v53, v29
    v_mul_f32 v30, v54, v30
    v_mul_f32 v31, v55, v31
    v_cvt_pk_bf16_f32 v72, v24, v25
    v_cvt_pk_bf16_f32 v73, v26, v27
    v_cvt_pk_bf16_f32 v74, v28, v29
    v_cvt_pk_bf16_f32 v75, v30, v31
    v_mul_f32 v32, v48, v32
    v_mul_f32 v33, v49, v33
    v_mul_f32 v34, v50, v34
    v_mul_f32 v35, v51, v35
    v_mul_f32 v36, v52, v36
    v_mul_f32 v37, v53, v37
    v_mul_f32 v38, v54, v38
    v_mul_f32 v39, v55, v39
    v_cvt_pk_bf16_f32 v76, v32, v33
    v_cvt_pk_bf16_f32 v77, v34, v35
    v_cvt_pk_bf16_f32 v78, v36, v37
    v_cvt_pk_bf16_f32 v79, v38, v39
    s_waitcnt vmcnt(4)
    v_mfma_f32_32x32x16_bf16 v[0:15], v[64:67], v[176:179], 0
    ds_read_b64_tr_b16 v[184:185], v246 offset:2048
    ds_read_b64_tr_b16 v[186:187], v246 offset:2560
    ds_read_b64_tr_b16 v[188:189], v247 offset:2048
    ds_read_b64_tr_b16 v[190:191], v247 offset:2560
    s_mov_b32 m0, s68
    v_mfma_f32_32x32x16_bf16 v[16:31], v[68:71], v[176:179], 0
    buffer_load_dwordx4 v222, s[4:7], s42 offen lds
    buffer_load_dwordx4 v223, s[72:75], s42 offen offset:1024 lds
    v_permlane32_swap_b32 v242, v236
    v_permlane32_swap_b32 v243, v237
    v_mov_b32 v254, 163648
    v_mfma_f32_32x32x16_bf16 v[32:47], v[64:67], v[180:183], 0
    v_permlane32_swap_b32 v244, v238
    v_permlane32_swap_b32 v245, v239
    v_permlane32_swap_b32 v240, v241
    v_add_f32 v242, v242, v236
    v_mfma_f32_32x32x16_bf16 v[48:63], v[68:71], v[180:183], 0
    v_add_f32 v243, v243, v237
    v_add_f32 v244, v244, v238
    v_add_f32 v245, v245, v239
    v_add_f32 v240, -v240, -v241
    v_sub_u32 v241, v230, v231
    v_cvt_pk_bf16_f32 v242, v242, v243
    v_mov_b32 v255, 1
    v_lshl_add_u32 v233, v252, 1, s53
    s_mov_b64 exec, 1
    ds_add_rtn_u32 v232, v254, v255
    s_mov_b64 exec, -1
    ds_read_b32 v233, v233
    s_waitcnt vmcnt(4) lgkmcnt(2)
    v_mfma_f32_32x32x16_bf16 v[0:15], v[72:75], v[184:187], v[0:15]
    ds_read_b64_tr_b16 v[176:177], v246 offset:4096
    ds_read_b64_tr_b16 v[178:179], v246 offset:4608
    ds_read_b64_tr_b16 v[180:181], v247 offset:4096
    ds_read_b64_tr_b16 v[182:183], v247 offset:4608
    v_cvt_pk_bf16_f32 v244, v244, v245
    v_cvt_pk_bf16_f32 v240, v240, v240
    s_mov_b32 m0, s69
    v_mfma_f32_32x32x16_bf16 v[16:31], v[76:79], v[184:187], v[16:31]
    buffer_load_dwordx4 v224, s[4:7], s42 offen lds
    buffer_load_dwordx4 v225, s[72:75], s42 offen offset:1024 lds
    ds_write_b32 v230, v242 offset:768
    ds_write_b32 v230, v244 offset:1024
    ds_write_b16 v241, v240 offset:1280
    s_waitcnt lgkmcnt(7)
    v_readfirstlane_b32 s58, v232
    v_mfma_f32_32x32x16_bf16 v[32:47], v[72:75], v[188:191], v[32:47]
    s_cmp_lt_u32 s58, s22
    s_cbranch_scc0 K2_nul_44
    s_and_b32 s59, s58, 7
    s_lshr_b32 s60, s58, 3
K2_chk_46:
    v_readlane_b32 s61, v233, s59
    s_nop 0
    s_cmp_gt_u32 s61, s60
    s_cbranch_scc0 K2_spin_45
K2_back_47:
    v_mfma_f32_32x32x16_bf16 v[48:63], v[76:79], v[188:191], v[48:63]
    s_setprio 0
    v_readlane_b32 s3, v253, s58
    s_lshl_b32 s44, s34, 7
    s_lshl_b32 s60, s58, 5
    s_and_b32 s48, s3, 0x3ffff
    s_bfe_u32 s33, s3, 0x30012
    s_sub_u32 s60, s60, s48
    v_mul_f32 v234, v0, v96
    v_mul_f32 v236, v8, v128
    v_fmac_f32 v234, v1, v97
    v_fmac_f32 v236, v9, v129
    v_fmac_f32 v234, v2, v98
    v_fmac_f32 v236, v10, v130
    v_fmac_f32 v234, v3, v99
    v_fmac_f32 v236, v11, v131
    v_fmac_f32 v234, v4, v100
    v_fmac_f32 v236, v12, v132
    v_fmac_f32 v234, v5, v101
    v_fmac_f32 v236, v13, v133
    v_fmac_f32 v234, v6, v102
    v_fmac_f32 v236, v14, v134
    v_fmac_f32 v234, v7, v103
    v_fmac_f32 v236, v15, v135
    v_mul_f32 v238, v16, v128
    v_mul_f32 v240, v24, v128
    v_fmac_f32 v238, v17, v129
    v_fmac_f32 v240, v25, v129
    v_fmac_f32 v238, v18, v130
    v_fmac_f32 v240, v26, v130
    v_fmac_f32 v238, v19, v131
    v_fmac_f32 v240, v27, v131
    v_fmac_f32 v238, v20, v132
    v_fmac_f32 v240, v28, v132
    v_fmac_f32 v238, v21, v133
    v_fmac_f32 v240, v29, v133
    v_fmac_f32 v238, v22, v134
    v_fmac_f32 v240, v30, v134
    v_fmac_f32 v238, v23, v135
    v_fmac_f32 v240, v31, v135
    v_mul_f32 v235, v32, v104
    v_mul_f32 v237, v40, v136
    v_fmac_f32 v235, v33, v105
    v_fmac_f32 v237, v41, v137
    v_fmac_f32 v235, v34, v106
    v_fmac_f32 v237, v42, v138
    v_fmac_f32 v235, v35, v107
    v_fmac_f32 v237, v43, v139
    v_fmac_f32 v235, v36, v108
    v_fmac_f32 v237, v44, v140
    v_fmac_f32 v235, v37, v109
    v_fmac_f32 v237, v45, v141
    v_fmac_f32 v235, v38, v110
    v_fmac_f32 v237, v46, v142
    v_fmac_f32 v235, v39, v111
    v_fmac_f32 v237, v47, v143
    v_mul_f32 v239, v48, v136
    v_mul_f32 v241, v56, v136
    v_fmac_f32 v239, v49, v137
    v_fmac_f32 v241, v57, v137
    s_setprio 1
    s_waitcnt vmcnt(4) lgkmcnt(3)
    v_mfma_f32_32x32x16_bf16 v[0:15], v[64:67], v[176:179], 0
    ds_read_b64_tr_b16 v[184:185], v246 offset:6144
    ds_read_b64_tr_b16 v[186:187], v246 offset:6656
    ds_read_b64_tr_b16 v[188:189], v247 offset:6144
    ds_read_b64_tr_b16 v[190:191], v247 offset:6656
    v_fmac_f32 v239, v50, v138
    v_fmac_f32 v241, v58, v138
    s_mov_b32 m0, s70
    v_mfma_f32_32x32x16_bf16 v[16:31], v[68:71], v[176:179], 0
    buffer_load_dwordx4 v222, s[4:7], s43 offen lds
    buffer_load_dwordx4 v223, s[72:75], s43 offen offset:1024 lds
    v_fmac_f32 v239, v51, v139
    v_fmac_f32 v241, v59, v139
    v_fmac_f32 v239, v52, v140
    v_fmac_f32 v241, v60, v140
    v_fmac_f32 v239, v53, v141
    v_mfma_f32_32x32x16_bf16 v[32:47], v[64:67], v[180:183], 0
    s_and_b32 s60, s60, 0xff
    s_add_u32 s35, s60, s48
    s_mov_b32 s45, s44
    s_add_u32 s47, s44, 256
    s_add_u32 s49, s48, 32
    s_add_u32 s60, s48, 64
    s_cmp_eq_u32 s33, 3
    s_cselect_b32 s46, s44, s47
    s_cselect_b32 s50, s60, s48
    s_cselect_b32 s51, s48, s49
    s_sub_u32 s60, s33, 2
    s_cmp_lt_u32 s60, 2
    s_cbranch_scc0 K2_rare_48
K2_back_49:
    v_add_u32 v222, s48, v251
    ds_read_b32 v222, v222
    v_fmac_f32 v241, v61, v141
    v_fmac_f32 v239, v54, v142
    v_fmac_f32 v241, v62, v142
    v_fmac_f32 v239, v55, v143
    v_fmac_f32 v241, v63, v143
    v_mfma_f32_32x32x16_bf16 v[48:63], v[68:71], v[180:183], 0
    v_permlane32_swap_b32 v234, v236
    v_permlane32_swap_b32 v235, v237
    v_permlane32_swap_b32 v240, v238
    s_waitcnt vmcnt(4) lgkmcnt(1)
    v_mfma_f32_32x32x16_bf16 v[0:15], v[72:75], v[184:187], v[0:15]
    ds_read_b64_tr_b16 v[176:177], v246 offset:0
    ds_read_b64_tr_b16 v[178:179], v246 offset:512
    ds_read_b64_tr_b16 v[180:181], v247 offset:0
    ds_read_b64_tr_b16 v[182:183], v247 offset:512
    v_permlane32_swap_b32 v241, v239
    s_mov_b32 m0, s71
    v_mfma_f32_32x32x16_bf16 v[16:31], v[76:79], v[184:187], v[16:31]
    buffer_load_dwordx4 v224, s[4:7], s43 offen lds
    buffer_load_dwordx4 v225, s[72:75], s43 offen offset:1024 lds
    s_waitcnt lgkmcnt(4)
    v_mad_u32_u16 v223, v222, s39, v248 op_sel:[1,0,0,0]
    v_mad_u32_u16 v222, v222, s39, v248
    v_lshl_add_u32 v230, v252, 1, s31
    v_add_f32 v234, v234, v236
    v_add_f32 v235, v235, v237
    v_add_f32 v240, v240, v238
    v_add_f32 v241, v241, v239
    v_cvt_pk_bf16_f32 v234, v234, v235
    v_cvt_pk_bf16_f32 v240, v240, v241
    ds_write_b32 v230, v234 offset:0
    ds_write_b32 v230, v240 offset:256
    v_mfma_f32_32x32x16_bf16 v[32:47], v[72:75], v[188:191], v[32:47]
    v_add_u32 v224, s49, v251
    ds_read_b32 v224, v224
    v_mul_f32 v234, v0, v144
    v_mul_f32 v236, v8, v112
    v_fmac_f32 v234, v1, v145
    v_fmac_f32 v236, v9, v113
    v_fmac_f32 v234, v2, v146
    v_mfma_f32_32x32x16_bf16 v[48:63], v[76:79], v[188:191], v[48:63]
    s_setprio 0
    v_fmac_f32 v236, v10, v114
    v_fmac_f32 v234, v3, v147
    v_fmac_f32 v236, v11, v115
    v_fmac_f32 v234, v4, v148
    v_fmac_f32 v236, v12, v116
    v_fmac_f32 v234, v5, v149
    v_fmac_f32 v236, v13, v117
    v_fmac_f32 v234, v6, v150
    v_fmac_f32 v236, v14, v118
    v_fmac_f32 v234, v7, v151
    v_fmac_f32 v236, v15, v119
    v_mul_f32 v238, v16, v160
    v_mul_f32 v240, v24, v160
    v_fmac_f32 v238, v17, v161
    v_fmac_f32 v240, v25, v161
    v_fmac_f32 v238, v18, v162
    v_fmac_f32 v240, v26, v162
    v_fmac_f32 v238, v19, v163
    v_fmac_f32 v240, v27, v163
    v_fmac_f32 v238, v20, v164
    v_fmac_f32 v240, v28, v164
    v_fmac_f32 v238, v21, v165
    v_fmac_f32 v240, v29, v165
    v_fmac_f32 v238, v22, v166
    v_fmac_f32 v240, v30, v166
    v_fmac_f32 v238, v23, v167
    v_fmac_f32 v240, v31, v167
    v_mul_f32 v235, v32, v152
    v_mul_f32 v237, v40, v120
    v_fmac_f32 v235, v33, v153
    v_fmac_f32 v237, v41, v121
    v_fmac_f32 v235, v34, v154
    v_fmac_f32 v237, v42, v122
    v_fmac_f32 v235, v35, v155
    v_fmac_f32 v237, v43, v123
    v_fmac_f32 v235, v36, v156
    v_fmac_f32 v237, v44, v124
    v_fmac_f32 v235, v37, v157
    v_fmac_f32 v237, v45, v125
    v_fmac_f32 v235, v38, v158
    v_fmac_f32 v237, v46, v126
    v_fmac_f32 v235, v39, v159
    v_fmac_f32 v237, v47, v127
    v_mul_f32 v239, v48, v168
    v_mul_f32 v241, v56, v168
    v_fmac_f32 v239, v49, v169
    v_fmac_f32 v241, v57, v169
    v_fmac_f32 v239, v50, v170
    v_fmac_f32 v241, v58, v170
    v_fmac_f32 v239, v51, v171
    s_setprio 1
    s_waitcnt vmcnt(4) lgkmcnt(3)
    v_mfma_f32_32x32x16_bf16 v[0:15], v[64:67], v[176:179], 0
    ds_read_b64_tr_b16 v[184:185], v246 offset:2048
    ds_read_b64_tr_b16 v[186:187], v246 offset:2560
    ds_read_b64_tr_b16 v[188:189], v247 offset:2048
    ds_read_b64_tr_b16 v[190:191], v247 offset:2560
    v_fmac_f32 v241, v59, v171
    v_fmac_f32 v239, v52, v172
    s_mov_b32 m0, s68
    v_mfma_f32_32x32x16_bf16 v[16:31], v[68:71], v[176:179], 0
    buffer_load_dwordx4 v222, s[4:7], s44 offen lds
    buffer_load_dwordx4 v223, s[72:75], s44 offen offset:1024 lds
    s_waitcnt lgkmcnt(4)
    v_mad_u32_u16 v225, v224, s39, v248 op_sel:[1,0,0,0]
    v_mad_u32_u16 v224, v224, s39, v248
    v_fmac_f32 v241, v60, v172
    v_fmac_f32 v239, v53, v173
    v_mfma_f32_32x32x16_bf16 v[32:47], v[64:67], v[180:183], 0
    v_add_u32 v226, s50, v251
    ds_read_b32 v226, v226
    v_fmac_f32 v241, v61, v173
    v_fmac_f32 v239, v54, v174
    v_fmac_f32 v241, v62, v174
    v_fmac_f32 v239, v55, v175
    v_fmac_f32 v241, v63, v175
    v_mfma_f32_32x32x16_bf16 v[48:63], v[68:71], v[180:183], 0
    s_waitcnt vmcnt(4) lgkmcnt(1)
    v_mfma_f32_32x32x16_bf16 v[0:15], v[72:75], v[184:187], v[0:15]
    ds_read_b64_tr_b16 v[176:177], v246 offset:4096
    ds_read_b64_tr_b16 v[178:179], v246 offset:4608
    ds_read_b64_tr_b16 v[180:181], v247 offset:4096
    ds_read_b64_tr_b16 v[182:183], v247 offset:4608
    s_mov_b32 m0, s69
    v_mfma_f32_32x32x16_bf16 v[16:31], v[76:79], v[184:187], v[16:31]
    buffer_load_dwordx4 v224, s[4:7], s45 offen lds
    buffer_load_dwordx4 v225, s[72:75], s45 offen offset:1024 lds
    s_waitcnt lgkmcnt(4)
    v_mad_u32_u16 v227, v226, s39, v248 op_sel:[1,0,0,0]
    v_mad_u32_u16 v226, v226, s39, v248
    v_mfma_f32_32x32x16_bf16 v[32:47], v[72:75], v[188:191], v[32:47]
    v_add_u32 v228, s51, v251
    ds_read_b32 v228, v228
    v_mul_f32 v242, v0, v144
    v_fma_f32 v238, v8, v160, -v238
    v_fmac_f32 v242, v1, v145
    v_fmac_f32 v238, v9, v161
    v_fmac_f32 v242, v2, v146
    v_mfma_f32_32x32x16_bf16 v[48:63], v[76:79], v[188:191], v[48:63]
    s_setprio 0
    v_fmac_f32 v238, v10, v162
    v_fmac_f32 v242, v3, v147
    v_fmac_f32 v238, v11, v163
    v_fmac_f32 v242, v4, v148
    v_fmac_f32 v238, v12, v164
    v_fmac_f32 v242, v5, v149
    v_fmac_f32 v238, v13, v165
    v_fmac_f32 v242, v6, v150
    v_fmac_f32 v238, v14, v166
    v_fmac_f32 v242, v7, v151
    v_fmac_f32 v238, v15, v167
    v_fmac_f32 v236, v16, v112
    v_mul_f32 v244, v24, v160
    v_fmac_f32 v236, v17, v113
    v_fmac_f32 v244, v25, v161
    v_fmac_f32 v236, v18, v114
    v_fmac_f32 v244, v26, v162
    v_fmac_f32 v236, v19, v115
    v_fmac_f32 v244, v27, v163
    v_fmac_f32 v236, v20, v116
    v_fmac_f32 v244, v28, v164
    v_fmac_f32 v236, v21, v117
    v_fmac_f32 v244, v29, v165
    v_fmac_f32 v236, v22, v118
    v_fmac_f32 v244, v30, v166
    v_fmac_f32 v236, v23, v119
    v_fmac_f32 v244, v31, v167
    v_mul_f32 v243, v32, v152
    v_fma_f32 v239, v40, v168, -v239
    v_fmac_f32 v243, v33, v153
    v_fmac_f32 v239, v41, v169
    v_fmac_f32 v243, v34, v154
    v_fmac_f32 v239, v42, v170
    v_fmac_f32 v243, v35, v155
    v_fmac_f32 v239, v43, v171
    v_fmac_f32 v243, v36, v156
    v_fmac_f32 v239, v44, v172
    v_fmac_f32 v243, v37, v157
    v_fmac_f32 v239, v45, v173
    v_fmac_f32 v243, v38, v158
    v_fmac_f32 v239, v46, v174
    v_fmac_f32 v243, v39, v159
    v_fmac_f32 v239, v47, v175
    v_fmac_f32 v237, v48, v120
    v_mul_f32 v245, v56, v168
    v_fmac_f32 v237, v49, v121
    v_fmac_f32 v245, v57, v169
    v_fmac_f32 v237, v50, v122
    s_setprio 1
    s_waitcnt vmcnt(4) lgkmcnt(1)
    v_mfma_f32_32x32x16_bf16 v[0:15], v[64:67], v[176:179], 0
    ds_read_b64_tr_b16 v[184:185], v246 offset:6144
    ds_read_b64_tr_b16 v[186:187], v246 offset:6656
    ds_read_b64_tr_b16 v[188:189], v247 offset:6144
    ds_read_b64_tr_b16 v[190:191], v247 offset:6656
    v_fmac_f32 v245, v58, v170
    v_fmac_f32 v237, v51, v123
    s_mov_b32 m0, s70
    v_mfma_f32_32x32x16_bf16 v[16:31], v[68:71], v[176:179], 0
    buffer_load_dwordx4 v226, s[4:7], s46 offen lds
    buffer_load_dwordx4 v227, s[72:75], s46 offen offset:1024 lds
    s_waitcnt lgkmcnt(4)
    v_mad_u32_u16 v229, v228, s39, v248 op_sel:[1,0,0,0]
    v_mad_u32_u16 v228, v228, s39, v248
    v_fmac_f32 v245, v59, v171
    v_fmac_f32 v237, v52, v124
    v_mfma_f32_32x32x16_bf16 v[32:47], v[64:67], v[180:183], 0
    v_fmac_f32 v245, v60, v172
    v_fmac_f32 v237, v53, v125
    v_fmac_f32 v245, v61, v173
    v_fmac_f32 v237, v54, v126
    v_fmac_f32 v245, v62, v174
    v_fmac_f32 v237, v55, v127
    v_fmac_f32 v245, v63, v175
    v_mfma_f32_32x32x16_bf16 v[48:63], v[68:71], v[180:183], 0
    v_permlane32_swap_b32 v242, v234
    v_permlane32_swap_b32 v243, v235
    v_add_f32 v242, v242, v234
    v_add_f32 v243, v243, v235
    s_waitcnt vmcnt(4) lgkmcnt(0)
    v_mfma_f32_32x32x16_bf16 v[0:15], v[72:75], v[184:187], v[0:15]
    ds_read_b64_tr_b16 v[176:177], v246 offset:0
    ds_read_b64_tr_b16 v[178:179], v246 offset:512
    ds_read_b64_tr_b16 v[180:181], v247 offset:0
    ds_read_b64_tr_b16 v[182:183], v247 offset:512
    v_cvt_pk_bf16_f32 v242, v242, v243
    ds_write_b32 v230, v242 offset:512
    s_mov_b32 m0, s71
    v_mfma_f32_32x32x16_bf16 v[16:31], v[76:79], v[184:187], v[16:31]
    buffer_load_dwordx4 v228, s[4:7], s47 offen lds
    buffer_load_dwordx4 v229, s[72:75], s47 offen offset:1024 lds
    s_sub_u32 s26, s48, s29
    s_mov_b32 s29, s48
    s_mov_b32 s30, s3
    s_cmp_lg_u32 s36, 0
    s_cselect_b32 s56, s33, 0
    v_mfma_f32_32x32x16_bf16 v[32:47], v[72:75], v[188:191], v[32:47]
    s_mov_b32 s32, s31
    s_mov_b32 s31, s35
    v_mul_f32 v242, v0, v144
    v_fma_f32 v240, v8, v160, -v240
    v_fmac_f32 v242, v1, v145
    v_fmac_f32 v240, v9, v161
    v_fmac_f32 v242, v2, v146
    v_mfma_f32_32x32x16_bf16 v[48:63], v[76:79], v[188:191], v[48:63]
    s_setprio 0
    v_fmac_f32 v240, v10, v162
    v_fmac_f32 v242, v3, v147
    v_fmac_f32 v240, v11, v163
    v_fmac_f32 v242, v4, v148
    v_fmac_f32 v240, v12, v164
    v_fmac_f32 v242, v5, v149
    v_fmac_f32 v240, v13, v165
    v_fmac_f32 v242, v6, v150
    v_fmac_f32 v240, v14, v166
    v_fmac_f32 v242, v7, v151
    v_fmac_f32 v240, v15, v167
    v_add_u32 v249, s26, v249
    v_add_u32 v250, s26, v250
    v_fma_f32 v244, v16, v160, -v244
    v_fmac_f32 v236, v24, v112
    v_fmac_f32 v244, v17, v161
    v_fmac_f32 v236, v25, v113
    v_fmac_f32 v244, v18, v162
    v_fmac_f32 v236, v26, v114
    v_fmac_f32 v244, v19, v163
    v_fmac_f32 v236, v27, v115
    v_fmac_f32 v244, v20, v164
    v_fmac_f32 v236, v28, v116
    v_fmac_f32 v244, v21, v165
    v_fmac_f32 v236, v29, v117
    v_fmac_f32 v244, v22, v166
    v_fmac_f32 v236, v30, v118
    v_fmac_f32 v244, v23, v167
    v_fmac_f32 v236, v31, v119
    ds_read_b64_tr_b16 v[0:1], v249 offset:0
    ds_read_b64_tr_b16 v[2:3], v249 offset:128
    ds_read_b128 v[4:7], v250 offset:0
    ds_read_b128 v[8:11], v250 offset:16
    ds_read_b128 v[12:15], v250 offset:384
    ds_read_b128 v[16:19], v250 offset:400
    v_mul_f32 v243, v32, v152
    v_fma_f32 v241, v40, v168, -v241
    v_fmac_f32 v243, v33, v153
    v_fmac_f32 v241, v41, v169
    v_fmac_f32 v243, v34, v154
    v_fmac_f32 v241, v42, v170
    v_fmac_f32 v243, v35, v155
    v_fmac_f32 v241, v43, v171
    v_fmac_f32 v243, v36, v156
    v_fmac_f32 v241, v44, v172
    v_fmac_f32 v243, v37, v157
    v_fmac_f32 v241, v45, v173
    v_fmac_f32 v243, v38, v158
    v_fmac_f32 v241, v46, v174
    v_fmac_f32 v243, v39, v159
    v_fmac_f32 v241, v47, v175
    ds_read_b64_tr_b16 v[20:21], v249 offset:512
    ds_read_b64_tr_b16 v[22:23], v249 offset:640
    ds_read_b128 v[24:27], v250 offset:64
    ds_read_b128 v[28:31], v250 offset:80
    ds_read_b128 v[32:35], v250 offset:448
    ds_read_b128 v[36:39], v250 offset:464
    v_fma_f32 v245, v48, v168, -v245
    v_fmac_f32 v237, v56, v120
    v_fmac_f32 v245, v49, v169
    v_fmac_f32 v237, v57, v121
    v_fmac_f32 v245, v50, v170
    v_fmac_f32 v237, v58, v122
    v_fmac_f32 v245, v51, v171
    v_fmac_f32 v237, v59, v123
    v_fmac_f32 v245, v52, v172
    v_fmac_f32 v237, v60, v124
    v_fmac_f32 v245, v53, v173
    v_fmac_f32 v237, v61, v125
    v_fmac_f32 v245, v54, v174
    v_fmac_f32 v237, v62, v126
    v_fmac_f32 v245, v55, v175
    v_fmac_f32 v237, v63, v127
    s_cmp_eq_u32 s56, 2
    s_cbranch_scc1 K2_U21
    s_cmp_eq_u32 s56, 3
    s_cbranch_scc1 K2_U31
    s_branch K2_DSP1
K2_U31:
    s_setprio 1
    s_waitcnt lgkmcnt(6)
    v_lshlrev_b32 v40, 16, v0
    v_and_b32 v41, 0xffff0000, v0
    v_lshlrev_b32 v42, 16, v1
    v_and_b32 v43, 0xffff0000, v1
    v_lshlrev_b32 v44, 16, v2
    v_and_b32 v45, 0xffff0000, v2
    v_lshlrev_b32 v46, 16, v3
    v_and_b32 v47, 0xffff0000, v3
    v_mul_f32 v4, v40, v4
    v_mul_f32 v5, v41, v5
    v_mul_f32 v6, v42, v6
    v_mul_f32 v7, v43, v7
    v_mul_f32 v8, v44, v8
    v_mul_f32 v9, v45, v9
    v_mul_f32 v10, v46, v10
    v_mul_f32 v11, v47, v11
    v_cvt_pk_bf16_f32 v64, v4, v5
    v_cvt_pk_bf16_f32 v65, v6, v7
    v_cvt_pk_bf16_f32 v66, v8, v9
    v_cvt_pk_bf16_f32 v67, v10, v11
    v_mul_f32 v12, v40, v12
    v_mul_f32 v13, v41, v13
    v_mul_f32 v14, v42, v14
    v_mul_f32 v15, v43, v15
    v_mul_f32 v16, v44, v16
    v_mul_f32 v17, v45, v17
    v_mul_f32 v18, v46, v18
    v_mul_f32 v19, v47, v19
    v_cvt_pk_bf16_f32 v68, v12, v13
    v_cvt_pk_bf16_f32 v69, v14, v15
    v_cvt_pk_bf16_f32 v70, v16, v17
    v_cvt_pk_bf16_f32 v71, v18, v19
    ds_read_b64_tr_b16 v[0:1], v249 offset:1024
    ds_read_b64_tr_b16 v[2:3], v249 offset:1152
    ds_read_b128 v[4:7], v250 offset:128
    ds_read_b128 v[8:11], v250 offset:144
    ds_read_b128 v[12:15], v250 offset:512
    ds_read_b128 v[16:19], v250 offset:528
    s_waitcnt lgkmcnt(6)
    v_lshlrev_b32 v48, 16, v20
    v_and_b32 v49, 0xffff0000, v20
    v_lshlrev_b32 v50, 16, v21
    v_and_b32 v51, 0xffff0000, v21
    v_lshlrev_b32 v52, 16, v22
    v_and_b32 v53, 0xffff0000, v22
    v_lshlrev_b32 v54, 16, v23
    v_and_b32 v55, 0xffff0000, v23
    v_mul_f32 v24, v48, v24
    v_mul_f32 v25, v49, v25
    v_mul_f32 v26, v50, v26
    v_mul_f32 v27, v51, v27
    v_mul_f32 v28, v52, v28
    v_mul_f32 v29, v53, v29
    v_mul_f32 v30, v54, v30
    v_mul_f32 v31, v55, v31
    v_cvt_pk_bf16_f32 v72, v24, v25
    v_cvt_pk_bf16_f32 v73, v26, v27
    v_cvt_pk_bf16_f32 v74, v28, v29
    v_cvt_pk_bf16_f32 v75, v30, v31
    v_mul_f32 v32, v48, v32
    v_mul_f32 v33, v49, v33
    v_mul_f32 v34, v50, v34
    v_mul_f32 v35, v51, v35
    v_mul_f32 v36, v52, v36
    v_mul_f32 v37, v53, v37
    v_mul_f32 v38, v54, v38
    v_mul_f32 v39, v55, v39
    v_cvt_pk_bf16_f32 v76, v32, v33
    v_cvt_pk_bf16_f32 v77, v34, v35
    v_cvt_pk_bf16_f32 v78, v36, v37
    v_cvt_pk_bf16_f32 v79, v38, v39
    s_waitcnt lgkmcnt(4)
    v_lshlrev_b32 v40, 16, v0
    v_and_b32 v41, 0xffff0000, v0
    v_lshlrev_b32 v42, 16, v1
    v_and_b32 v43, 0xffff0000, v1
    v_lshlrev_b32 v44, 16, v2
    v_and_b32 v45, 0xffff0000, v2
    v_lshlrev_b32 v46, 16, v3
    v_and_b32 v47, 0xffff0000, v3
    s_waitcnt lgkmcnt(2)
    v_mul_f32 v4, v40, v4
    v_mul_f32 v5, v41, v5
    v_mul_f32 v6, v42, v6
    v_mul_f32 v7, v43, v7
    v_mul_f32 v8, v44, v8
    v_mul_f32 v9, v45, v9
    v_mul_f32 v10, v46, v10
    v_mul_f32 v11, v47, v11
    v_cvt_pk_bf16_f32 v80, v4, v5
    v_cvt_pk_bf16_f32 v81, v6, v7
    v_cvt_pk_bf16_f32 v82, v8, v9
    v_cvt_pk_bf16_f32 v83, v10, v11
    s_waitcnt lgkmcnt(0)
    v_mul_f32 v12, v40, v12
    v_mul_f32 v13, v41, v13
    v_mul_f32 v14, v42, v14
    v_mul_f32 v15, v43, v15
    v_mul_f32 v16, v44, v16
    v_mul_f32 v17, v45, v17
    v_mul_f32 v18, v46, v18
    v_mul_f32 v19, v47, v19
    v_cvt_pk_bf16_f32 v84, v12, v13
    v_cvt_pk_bf16_f32 v85, v14, v15
    v_cvt_pk_bf16_f32 v86, v16, v17
    v_cvt_pk_bf16_f32 v87, v18, v19
    s_waitcnt vmcnt(4)
    v_mfma_f32_32x32x16_bf16 v[0:15], v[64:67], v[176:179], 0
    ds_read_b64_tr_b16 v[184:185], v246 offset:2048
    ds_read_b64_tr_b16 v[186:187], v246 offset:2560
    ds_read_b64_tr_b16 v[188:189], v247 offset:2048
    ds_read_b64_tr_b16 v[190:191], v247 offset:2560
    s_mov_b32 m0, s68
    v_mfma_f32_32x32x16_bf16 v[16:31], v[68:71], v[176:179], 0
    buffer_load_dwordx4 v224, s[4:7], s41 offen lds
    buffer_load_dwordx4 v225, s[72:75], s41 offen offset:1024 lds
    v_permlane32_swap_b32 v242, v236
    v_permlane32_swap_b32 v243, v237
    v_mov_b32 v254, 163648
    v_mfma_f32_32x32x16_bf16 v[32:47], v[64:67], v[180:183], 0
    v_permlane32_swap_b32 v244, v238
    v_permlane32_swap_b32 v245, v239
    v_permlane32_swap_b32 v240, v241
    v_add_f32 v242, v242, v236
    v_mfma_f32_32x32x16_bf16 v[48:63], v[68:71], v[180:183], 0
    v_add_f32 v243, v243, v237
    v_add_f32 v244, v244, v238
    v_add_f32 v245, v245, v239
    v_add_f32 v240, -v240, -v241
    v_sub_u32 v241, v230, v231
    v_cvt_pk_bf16_f32 v242, v242, v243
    v_mov_b32 v255, 1
    v_lshl_add_u32 v233, v252, 1, s53
    s_mov_b64 exec, 1
    ds_add_rtn_u32 v232, v254, v255
    s_mov_b64 exec, -1
    ds_read_b32 v233, v233
    s_waitcnt vmcnt(4) lgkmcnt(2)
    v_mfma_f32_32x32x16_bf16 v[0:15], v[72:75], v[184:187], v[0:15]
    ds_read_b64_tr_b16 v[176:177], v246 offset:4096
    ds_read_b64_tr_b16 v[178:179], v246 offset:4608
    ds_read_b64_tr_b16 v[180:181], v247 offset:4096
    ds_read_b64_tr_b16 v[182:183], v247 offset:4608
    v_cvt_pk_bf16_f32 v244, v244, v245
    v_cvt_pk_bf16_f32 v240, v240, v240
    s_mov_b32 m0, s69
    v_mfma_f32_32x32x16_bf16 v[16:31], v[76:79], v[184:187], v[16:31]
    buffer_load_dwordx4 v226, s[4:7], s41 offen lds
    buffer_load_dwordx4 v227, s[72:75], s41 offen offset:1024 lds
    ds_write_b32 v230, v242 offset:768
    ds_write_b32 v230, v244 offset:1024
    ds_write_b16 v241, v240 offset:1280
    s_waitcnt lgkmcnt(7)
    v_readfirstlane_b32 s58, v232
    v_mfma_f32_32x32x16_bf16 v[32:47], v[72:75], v[188:191], v[32:47]
    s_cmp_lt_u32 s58, s22
    s_cbranch_scc0 K2_nul_51
    s_and_b32 s59, s58, 7
    s_lshr_b32 s60, s58, 3
K2_chk_53:
    v_readlane_b32 s61, v233, s59
    s_nop 0
    s_cmp_gt_u32 s61, s60
    s_cbranch_scc0 K2_spin_52
K2_back_54:
    v_mfma_f32_32x32x16_bf16 v[48:63], v[76:79], v[188:191], v[48:63]
    v_readlane_b32 s3, v253, s58
    s_lshl_b32 s44, s34, 7
    s_lshl_b32 s60, s58, 5
    s_and_b32 s48, s3, 0x3ffff
    s_bfe_u32 s33, s3, 0x30012
    s_sub_u32 s60, s60, s48
    s_waitcnt vmcnt(4) lgkmcnt(3)
    v_mfma_f32_32x32x16_bf16 v[0:15], v[80:83], v[176:179], v[0:15]
    ds_read_b64_tr_b16 v[184:185], v246 offset:6144
    ds_read_b64_tr_b16 v[186:187], v246 offset:6656
    ds_read_b64_tr_b16 v[188:189], v247 offset:6144
    ds_read_b64_tr_b16 v[190:191], v247 offset:6656
    s_and_b32 s60, s60, 0xff
    s_add_u32 s35, s60, s48
    s_mov_b32 m0, s70
    v_mfma_f32_32x32x16_bf16 v[16:31], v[84:87], v[176:179], v[16:31]
    buffer_load_dwordx4 v222, s[4:7], s42 offen lds
    buffer_load_dwordx4 v223, s[72:75], s42 offen offset:1024 lds
    s_mov_b32 s45, s44
    s_add_u32 s47, s44, 256
    s_add_u32 s49, s48, 32
    s_add_u32 s60, s48, 64
    v_mfma_f32_32x32x16_bf16 v[32:47], v[80:83], v[180:183], v[32:47]
    s_cmp_eq_u32 s33, 3
    s_cselect_b32 s46, s44, s47
    s_cselect_b32 s50, s60, s48
    s_cselect_b32 s51, s48, s49
    s_sub_u32 s60, s33, 2
    s_cmp_lt_u32 s60, 2
    s_cbranch_scc0 K2_rare_55
K2_back_56:
    v_mfma_f32_32x32x16_bf16 v[48:63], v[84:87], v[180:183], v[48:63]
    s_setprio 0
    v_mul_f32 v234, v0, v96
    v_mul_f32 v236, v8, v128
    v_fmac_f32 v234, v1, v97
    v_fmac_f32 v236, v9, v129
    v_fmac_f32 v234, v2, v98
    v_fmac_f32 v236, v10, v130
    v_fmac_f32 v234, v3, v99
    v_fmac_f32 v236, v11, v131
    v_fmac_f32 v234, v4, v100
    v_fmac_f32 v236, v12, v132
    v_fmac_f32 v234, v5, v101
    v_fmac_f32 v236, v13, v133
    v_fmac_f32 v234, v6, v102
    v_fmac_f32 v236, v14, v134
    v_fmac_f32 v234, v7, v103
    v_fmac_f32 v236, v15, v135
    v_mul_f32 v238, v16, v128
    v_mul_f32 v240, v24, v128
    v_fmac_f32 v238, v17, v129
    v_fmac_f32 v240, v25, v129
    v_fmac_f32 v238, v18, v130
    v_fmac_f32 v240, v26, v130
    v_fmac_f32 v238, v19, v131
    v_fmac_f32 v240, v27, v131
    v_fmac_f32 v238, v20, v132
    v_fmac_f32 v240, v28, v132
    v_fmac_f32 v238, v21, v133
    v_fmac_f32 v240, v29, v133
    v_fmac_f32 v238, v22, v134
    v_fmac_f32 v240, v30, v134
    v_fmac_f32 v238, v23, v135
    v_fmac_f32 v240, v31, v135
    v_mul_f32 v235, v32, v104
    v_mul_f32 v237, v40, v136
    v_fmac_f32 v235, v33, v105
    v_fmac_f32 v237, v41, v137
    v_fmac_f32 v235, v34, v106
    v_fmac_f32 v237, v42, v138
    v_fmac_f32 v235, v35, v107
    v_fmac_f32 v237, v43, v139
    v_fmac_f32 v235, v36, v108
    v_fmac_f32 v237, v44, v140
    v_fmac_f32 v235, v37, v109
    v_fmac_f32 v237, v45, v141
    v_fmac_f32 v235, v38, v110
    v_fmac_f32 v237, v46, v142
    v_fmac_f32 v235, v39, v111
    v_fmac_f32 v237, v47, v143
    v_mul_f32 v239, v48, v136
    v_mul_f32 v241, v56, v136
    s_setprio 1
    s_waitcnt vmcnt(4) lgkmcnt(0)
    v_mfma_f32_32x32x16_bf16 v[0:15], v[64:67], v[184:187], 0
    ds_read_b64_tr_b16 v[176:177], v246 offset:0
    ds_read_b64_tr_b16 v[178:179], v246 offset:512
    ds_read_b64_tr_b16 v[180:181], v247 offset:0
    ds_read_b64_tr_b16 v[182:183], v247 offset:512
    v_fmac_f32 v239, v49, v137
    v_fmac_f32 v241, v57, v137
    s_mov_b32 m0, s71
    v_mfma_f32_32x32x16_bf16 v[16:31], v[68:71], v[184:187], 0
    buffer_load_dwordx4 v224, s[4:7], s42 offen lds
    buffer_load_dwordx4 v225, s[72:75], s42 offen offset:1024 lds
    v_fmac_f32 v239, v50, v138
    v_fmac_f32 v241, v58, v138
    v_fmac_f32 v239, v51, v139
    v_fmac_f32 v241, v59, v139
    v_fmac_f32 v239, v52, v140
    v_mfma_f32_32x32x16_bf16 v[32:47], v[64:67], v[188:191], 0
    v_fmac_f32 v241, v60, v140
    v_fmac_f32 v239, v53, v141
    v_fmac_f32 v241, v61, v141
    v_fmac_f32 v239, v54, v142
    v_fmac_f32 v241, v62, v142
    v_fmac_f32 v239, v55, v143
    v_fmac_f32 v241, v63, v143
    v_mfma_f32_32x32x16_bf16 v[48:63], v[68:71], v[188:191], 0
    v_permlane32_swap_b32 v234, v236
    v_permlane32_swap_b32 v235, v237
    v_permlane32_swap_b32 v240, v238
    s_waitcnt vmcnt(4) lgkmcnt(0)
    v_mfma_f32_32x32x16_bf16 v[0:15], v[72:75], v[176:179], v[0:15]
    ds_read_b64_tr_b16 v[184:185], v246 offset:2048
    ds_read_b64_tr_b16 v[186:187], v246 offset:2560
    ds_read_b64_tr_b16 v[188:189], v247 offset:2048
    ds_read_b64_tr_b16 v[190:191], v247 offset:2560
    v_permlane32_swap_b32 v241, v239
    s_mov_b32 m0, s68
    v_mfma_f32_32x32x16_bf16 v[16:31], v[76:79], v[176:179], v[16:31]
    buffer_load_dwordx4 v226, s[4:7], s42 offen lds
    buffer_load_dwordx4 v227, s[72:75], s42 offen offset:1024 lds
    v_lshl_add_u32 v230, v252, 1, s31
    v_add_f32 v234, v234, v236
    v_add_f32 v235, v235, v237
    v_add_f32 v240, v240, v238
    v_add_f32 v241, v241, v239
    v_mfma_f32_32x32x16_bf16 v[32:47], v[72:75], v[180:183], v[32:47]
    v_cvt_pk_bf16_f32 v234, v234, v235
    v_cvt_pk_bf16_f32 v240, v240, v241
    ds_write_b32 v230, v234 offset:0
    ds_write_b32 v230, v240 offset:256
    v_mfma_f32_32x32x16_bf16 v[48:63], v[76:79], v[180:183], v[48:63]
    s_waitcnt vmcnt(4) lgkmcnt(2)
    v_mfma_f32_32x32x16_bf16 v[0:15], v[80:83], v[184:187], v[0:15]
    ds_read_b64_tr_b16 v[176:177], v246 offset:4096
    ds_read_b64_tr_b16 v[178:179], v246 offset:4608
    ds_read_b64_tr_b16 v[180:181], v247 offset:4096
    ds_read_b64_tr_b16 v[182:183], v247 offset:4608
    s_mov_b32 m0, s69
    v_mfma_f32_32x32x16_bf16 v[16:31], v[84:87], v[184:187], v[16:31]
    buffer_load_dwordx4 v222, s[4:7], s43 offen lds
    buffer_load_dwordx4 v223, s[72:75], s43 offen offset:1024 lds
    v_mfma_f32_32x32x16_bf16 v[32:47], v[80:83], v[188:191], v[32:47]
    s_nop 2
    v_mul_f32 v234, v0, v144
    v_mul_f32 v236, v8, v112
    v_fmac_f32 v234, v1, v145
    v_fmac_f32 v236, v9, v113
    v_fmac_f32 v234, v2, v146
    v_fmac_f32 v236, v10, v114
    v_fmac_f32 v234, v3, v147
    v_mfma_f32_32x32x16_bf16 v[48:63], v[84:87], v[188:191], v[48:63]
    s_setprio 0
    v_fmac_f32 v236, v11, v115
    v_fmac_f32 v234, v4, v148
    v_fmac_f32 v236, v12, v116
    v_fmac_f32 v234, v5, v149
    v_fmac_f32 v236, v13, v117
    v_fmac_f32 v234, v6, v150
    v_fmac_f32 v236, v14, v118
    v_fmac_f32 v234, v7, v151
    v_fmac_f32 v236, v15, v119
    v_mul_f32 v238, v16, v160
    v_mul_f32 v240, v24, v160
    v_fmac_f32 v238, v17, v161
    v_fmac_f32 v240, v25, v161
    v_fmac_f32 v238, v18, v162
    v_fmac_f32 v240, v26, v162
    v_fmac_f32 v238, v19, v163
    v_fmac_f32 v240, v27, v163
    v_fmac_f32 v238, v20, v164
    v_fmac_f32 v240, v28, v164
    v_fmac_f32 v238, v21, v165
    v_fmac_f32 v240, v29, v165
    v_fmac_f32 v238, v22, v166
    v_fmac_f32 v240, v30, v166
    v_fmac_f32 v238, v23, v167
    v_fmac_f32 v240, v31, v167
    v_mul_f32 v235, v32, v152
    v_mul_f32 v237, v40, v120
    v_fmac_f32 v235, v33, v153
    v_fmac_f32 v237, v41, v121
    v_fmac_f32 v235, v34, v154
    v_fmac_f32 v237, v42, v122
    v_fmac_f32 v235, v35, v155
    v_fmac_f32 v237, v43, v123
    v_fmac_f32 v235, v36, v156
    v_fmac_f32 v237, v44, v124
    v_fmac_f32 v235, v37, v157
    v_fmac_f32 v237, v45, v125
    v_fmac_f32 v235, v38, v158
    v_fmac_f32 v237, v46, v126
    v_fmac_f32 v235, v39, v159
    v_fmac_f32 v237, v47, v127
    v_mul_f32 v239, v48, v168
    v_mul_f32 v241, v56, v168
    v_fmac_f32 v239, v49, v169
    v_fmac_f32 v241, v57, v169
    s_setprio 1
    s_waitcnt vmcnt(4) lgkmcnt(0)
    v_mfma_f32_32x32x16_bf16 v[0:15], v[64:67], v[176:179], 0
    ds_read_b64_tr_b16 v[184:185], v246 offset:6144
    ds_read_b64_tr_b16 v[186:187], v246 offset:6656
    ds_read_b64_tr_b16 v[188:189], v247 offset:6144
    ds_read_b64_tr_b16 v[190:191], v247 offset:6656
    v_fmac_f32 v239, v50, v170
    v_fmac_f32 v241, v58, v170
    s_mov_b32 m0, s70
    v_mfma_f32_32x32x16_bf16 v[16:31], v[68:71], v[176:179], 0
    buffer_load_dwordx4 v224, s[4:7], s43 offen lds
    buffer_load_dwordx4 v225, s[72:75], s43 offen offset:1024 lds
    v_fmac_f32 v239, v51, v171
    v_fmac_f32 v241, v59, v171
    v_fmac_f32 v239, v52, v172
    v_fmac_f32 v241, v60, v172
    v_fmac_f32 v239, v53, v173
    v_mfma_f32_32x32x16_bf16 v[32:47], v[64:67], v[180:183], 0
    v_add_u32 v222, s48, v251
    ds_read_b32 v222, v222
    v_fmac_f32 v241, v61, v173
    v_fmac_f32 v239, v54, v174
    v_fmac_f32 v241, v62, v174
    v_fmac_f32 v239, v55, v175
    v_fmac_f32 v241, v63, v175
    v_mfma_f32_32x32x16_bf16 v[48:63], v[68:71], v[180:183], 0
    s_waitcnt vmcnt(4) lgkmcnt(1)
    v_mfma_f32_32x32x16_bf16 v[0:15], v[72:75], v[184:187], v[0:15]
    ds_read_b64_tr_b16 v[176:177], v246 offset:0
    ds_read_b64_tr_b16 v[178:179], v246 offset:512
    ds_read_b64_tr_b16 v[180:181], v247 offset:0
    ds_read_b64_tr_b16 v[182:183], v247 offset:512
    s_mov_b32 m0, s71
    v_mfma_f32_32x32x16_bf16 v[16:31], v[76:79], v[184:187], v[16:31]
    buffer_load_dwordx4 v226, s[4:7], s43 offen lds
    buffer_load_dwordx4 v227, s[72:75], s43 offen offset:1024 lds
    s_waitcnt lgkmcnt(4)
    v_mad_u32_u16 v223, v222, s39, v248 op_sel:[1,0,0,0]
    v_mad_u32_u16 v222, v222, s39, v248
    v_mfma_f32_32x32x16_bf16 v[32:47], v[72:75], v[188:191], v[32:47]
    v_add_u32 v224, s49, v251
    ds_read_b32 v224, v224
    v_mfma_f32_32x32x16_bf16 v[48:63], v[76:79], v[188:191], v[48:63]
    s_waitcnt vmcnt(4) lgkmcnt(1)
    v_mfma_f32_32x32x16_bf16 v[0:15], v[80:83], v[176:179], v[0:15]
    ds_read_b64_tr_b16 v[184:185], v246 offset:2048
    ds_read_b64_tr_b16 v[186:187], v246 offset:2560
    ds_read_b64_tr_b16 v[188:189], v247 offset:2048
    ds_read_b64_tr_b16 v[190:191], v247 offset:2560
    s_mov_b32 m0, s68
    v_mfma_f32_32x32x16_bf16 v[16:31], v[84:87], v[176:179], v[16:31]
    buffer_load_dwordx4 v222, s[4:7], s44 offen lds
    buffer_load_dwordx4 v223, s[72:75], s44 offen offset:1024 lds
    s_waitcnt lgkmcnt(4)
    v_mad_u32_u16 v225, v224, s39, v248 op_sel:[1,0,0,0]
    v_mad_u32_u16 v224, v224, s39, v248
    v_mfma_f32_32x32x16_bf16 v[32:47], v[80:83], v[180:183], v[32:47]
    v_add_u32 v226, s50, v251
    ds_read_b32 v226, v226
    v_mul_f32 v242, v0, v144
    v_fma_f32 v238, v8, v160, -v238
    v_fmac_f32 v242, v1, v145
    v_fmac_f32 v238, v9, v161
    v_fmac_f32 v242, v2, v146
    v_mfma_f32_32x32x16_bf16 v[48:63], v[84:87], v[180:183], v[48:63]
    s_setprio 0
    v_fmac_f32 v238, v10, v162
    v_fmac_f32 v242, v3, v147
    v_fmac_f32 v238, v11, v163
    v_fmac_f32 v242, v4, v148
    v_fmac_f32 v238, v12, v164
    v_fmac_f32 v242, v5, v149
    v_fmac_f32 v238, v13, v165
    v_fmac_f32 v242, v6, v150
    v_fmac_f32 v238, v14, v166
    v_fmac_f32 v242, v7, v151
    v_fmac_f32 v238, v15, v167
    v_fmac_f32 v236, v16, v112
    v_mul_f32 v244, v24, v160
    v_fmac_f32 v236, v17, v113
    v_fmac_f32 v244, v25, v161
    v_fmac_f32 v236, v18, v114
    v_fmac_f32 v244, v26, v162
    v_fmac_f32 v236, v19, v115
    v_fmac_f32 v244, v27, v163
    v_fmac_f32 v236, v20, v116
    v_fmac_f32 v244, v28, v164
    v_fmac_f32 v236, v21, v117
    v_fmac_f32 v244, v29, v165
    v_fmac_f32 v236, v22, v118
    v_fmac_f32 v244, v30, v166
    v_fmac_f32 v236, v23, v119
    v_fmac_f32 v244, v31, v167
    v_mul_f32 v243, v32, v152
    v_fma_f32 v239, v40, v168, -v239
    v_fmac_f32 v243, v33, v153
    v_fmac_f32 v239, v41, v169
    v_fmac_f32 v243, v34, v154
    v_fmac_f32 v239, v42, v170
    v_fmac_f32 v243, v35, v155
    v_fmac_f32 v239, v43, v171
    v_fmac_f32 v243, v36, v156
    v_fmac_f32 v239, v44, v172
    v_fmac_f32 v243, v37, v157
    v_fmac_f32 v239, v45, v173
    v_fmac_f32 v243, v38, v158
    v_fmac_f32 v239, v46, v174
    v_fmac_f32 v243, v39, v159
    v_fmac_f32 v239, v47, v175
    v_fmac_f32 v237, v48, v120
    v_mul_f32 v245, v56, v168
    v_fmac_f32 v237, v49, v121
    v_fmac_f32 v245, v57, v169
    v_fmac_f32 v237, v50, v122
    v_fmac_f32 v245, v58, v170
    v_fmac_f32 v237, v51, v123
    s_setprio 1
    s_waitcnt vmcnt(4) lgkmcnt(1)
    v_mfma_f32_32x32x16_bf16 v[0:15], v[64:67], v[184:187], 0
    ds_read_b64_tr_b16 v[176:177], v246 offset:4096
    ds_read_b64_tr_b16 v[178:179], v246 offset:4608
    ds_read_b64_tr_b16 v[180:181], v247 offset:4096
    ds_read_b64_tr_b16 v[182:183], v247 offset:4608
    v_fmac_f32 v245, v59, v171
    v_fmac_f32 v237, v52, v124
    s_mov_b32 m0, s69
    v_mfma_f32_32x32x16_bf16 v[16:31], v[68:71], v[184:187], 0
    buffer_load_dwordx4 v224, s[4:7], s45 offen lds
    buffer_load_dwordx4 v225, s[72:75], s45 offen offset:1024 lds
    s_waitcnt lgkmcnt(4)
    v_mad_u32_u16 v227, v226, s39, v248 op_sel:[1,0,0,0]
    v_mad_u32_u16 v226, v226, s39, v248
    v_fmac_f32 v245, v60, v172
    v_fmac_f32 v237, v53, v125
    v_mfma_f32_32x32x16_bf16 v[32:47], v[64:67], v[188:191], 0
    v_add_u32 v228, s51, v251
    ds_read_b32 v228, v228
    v_fmac_f32 v245, v61, v173
    v_fmac_f32 v237, v54, v126
    v_fmac_f32 v245, v62, v174
    v_fmac_f32 v237, v55, v127
    v_fmac_f32 v245, v63, v175
    v_mfma_f32_32x32x16_bf16 v[48:63], v[68:71], v[188:191], 0
    v_permlane32_swap_b32 v242, v234
    v_permlane32_swap_b32 v243, v235
    v_add_f32 v242, v242, v234
    v_add_f32 v243, v243, v235
    s_waitcnt vmcnt(4) lgkmcnt(1)
    v_mfma_f32_32x32x16_bf16 v[0:15], v[72:75], v[176:179], v[0:15]
    ds_read_b64_tr_b16 v[184:185], v246 offset:6144
    ds_read_b64_tr_b16 v[186:187], v246 offset:6656
    ds_read_b64_tr_b16 v[188:189], v247 offset:6144
    ds_read_b64_tr_b16 v[190:191], v247 offset:6656
    v_cvt_pk_bf16_f32 v242, v242, v243
    ds_write_b32 v230, v242 offset:512
    s_mov_b32 m0, s70
    v_mfma_f32_32x32x16_bf16 v[16:31], v[76:79], v[176:179], v[16:31]
    buffer_load_dwordx4 v226, s[4:7], s46 offen lds
    buffer_load_dwordx4 v227, s[72:75], s46 offen offset:1024 lds
    s_waitcnt lgkmcnt(5)
    v_mad_u32_u16 v229, v228, s39, v248 op_sel:[1,0,0,0]
    v_mad_u32_u16 v228, v228, s39, v248
    s_sub_u32 s26, s48, s29
    s_mov_b32 s29, s48
    v_mfma_f32_32x32x16_bf16 v[32:47], v[72:75], v[180:183], v[32:47]
    s_mov_b32 s30, s3
    s_cmp_lg_u32 s36, 0
    s_cselect_b32 s56, s33, 0
    s_mov_b32 s32, s31
    s_mov_b32 s31, s35
    v_mfma_f32_32x32x16_bf16 v[48:63], v[76:79], v[180:183], v[48:63]
    s_waitcnt vmcnt(4) lgkmcnt(1)
    v_mfma_f32_32x32x16_bf16 v[0:15], v[80:83], v[184:187], v[0:15]
    ds_read_b64_tr_b16 v[176:177], v246 offset:0
    ds_read_b64_tr_b16 v[178:179], v246 offset:512
    ds_read_b64_tr_b16 v[180:181], v247 offset:0
    ds_read_b64_tr_b16 v[182:183], v247 offset:512
    s_mov_b32 m0, s71
    v_mfma_f32_32x32x16_bf16 v[16:31], v[84:87], v[184:187], v[16:31]
    buffer_load_dwordx4 v228, s[4:7], s47 offen lds
    buffer_load_dwordx4 v229, s[72:75], s47 offen offset:1024 lds
    v_mfma_f32_32x32x16_bf16 v[32:47], v[80:83], v[188:191], v[32:47]
    s_nop 2
    v_mul_f32 v242, v0, v144
    v_fma_f32 v240, v8, v160, -v240
    v_fmac_f32 v242, v1, v145
    v_fmac_f32 v240, v9, v161
    v_fmac_f32 v242, v2, v146
    v_fmac_f32 v240, v10, v162
    v_fmac_f32 v242, v3, v147
    v_mfma_f32_32x32x16_bf16 v[48:63], v[84:87], v[188:191], v[48:63]
    s_setprio 0
    v_fmac_f32 v240, v11, v163
    v_fmac_f32 v242, v4, v148
    v_fmac_f32 v240, v12, v164
    v_fmac_f32 v242, v5, v149
    v_fmac_f32 v240, v13, v165
    v_fmac_f32 v242, v6, v150
    v_fmac_f32 v240, v14, v166
    v_fmac_f32 v242, v7, v151
    v_fmac_f32 v240, v15, v167
    v_add_u32 v249, s26, v249
    v_add_u32 v250, s26, v250
    v_fma_f32 v244, v16, v160, -v244
    v_fmac_f32 v236, v24, v112
    v_fmac_f32 v244, v17, v161
    v_fmac_f32 v236, v25, v113
    v_fmac_f32 v244, v18, v162
    v_fmac_f32 v236, v26, v114
    v_fmac_f32 v244, v19, v163
    v_fmac_f32 v236, v27, v115
    v_fmac_f32 v244, v20, v164
    v_fmac_f32 v236, v28, v116
    v_fmac_f32 v244, v21, v165
    v_fmac_f32 v236, v29, v117
    v_fmac_f32 v244, v22, v166
    v_fmac_f32 v236, v30, v118
    v_fmac_f32 v244, v23, v167
    v_fmac_f32 v236, v31, v119
    ds_read_b64_tr_b16 v[0:1], v249 offset:0
    ds_read_b64_tr_b16 v[2:3], v249 offset:128
    ds_read_b128 v[4:7], v250 offset:0
    ds_read_b128 v[8:11], v250 offset:16
    ds_read_b128 v[12:15], v250 offset:384
    ds_read_b128 v[16:19], v250 offset:400
    v_mul_f32 v243, v32, v152
    v_fma_f32 v241, v40, v168, -v241
    v_fmac_f32 v243, v33, v153
    v_fmac_f32 v241, v41, v169
    v_fmac_f32 v243, v34, v154
    v_fmac_f32 v241, v42, v170
    v_fmac_f32 v243, v35, v155
    v_fmac_f32 v241, v43, v171
    v_fmac_f32 v243, v36, v156
    v_fmac_f32 v241, v44, v172
    v_fmac_f32 v243, v37, v157
    v_fmac_f32 v241, v45, v173
    v_fmac_f32 v243, v38, v158
    v_fmac_f32 v241, v46, v174
    v_fmac_f32 v243, v39, v159
    v_fmac_f32 v241, v47, v175
    ds_read_b64_tr_b16 v[20:21], v249 offset:512
    ds_read_b64_tr_b16 v[22:23], v249 offset:640
    ds_read_b128 v[24:27], v250 offset:64
    ds_read_b128 v[28:31], v250 offset:80
    ds_read_b128 v[32:35], v250 offset:448
    ds_read_b128 v[36:39], v250 offset:464
    v_fma_f32 v245, v48, v168, -v245
    v_fmac_f32 v237, v56, v120
    v_fmac_f32 v245, v49, v169
    v_fmac_f32 v237, v57, v121
    v_fmac_f32 v245, v50, v170
    v_fmac_f32 v237, v58, v122
    v_fmac_f32 v245, v51, v171
    v_fmac_f32 v237, v59, v123
    v_fmac_f32 v245, v52, v172
    v_fmac_f32 v237, v60, v124
    v_fmac_f32 v245, v53, v173
    v_fmac_f32 v237, v61, v125
    v_fmac_f32 v245, v54, v174
    v_fmac_f32 v237, v62, v126
    v_fmac_f32 v245, v55, v175
    v_fmac_f32 v237, v63, v127
    s_cmp_eq_u32 s56, 2
    s_cbranch_scc1 K2_U21
    s_cmp_eq_u32 s56, 3
    s_cbranch_scc1 K2_U31
    s_branch K2_DSP1
K2_U10:
    s_setprio 1
    s_add_u32 s38, s38, 1
    v_mov_b32 v254, s52
    v_mov_b32 v255, s38
    s_lshl_b32 s58, s38, 3
    s_add_u32 s58, s58, s20
    s_mov_b64 exec, 1
    ds_write_b32 v254, v255
    s_mov_b64 exec, -1
    s_cmp_lt_u32 s58, s22
    s_cbranch_scc0 K2_dyn_58
K2_back_59:
    s_waitcnt lgkmcnt(7)
    v_lshlrev_b32 v40, 16, v0
    v_and_b32 v41, 0xffff0000, v0
    v_lshlrev_b32 v42, 16, v1
    v_and_b32 v43, 0xffff0000, v1
    v_lshlrev_b32 v44, 16, v2
    v_and_b32 v45, 0xffff0000, v2
    v_lshlrev_b32 v46, 16, v3
    v_and_b32 v47, 0xffff0000, v3
    v_mul_f32 v4, v40, v4
    v_mul_f32 v5, v41, v5
    v_mul_f32 v6, v42, v6
    v_mul_f32 v7, v43, v7
    v_mul_f32 v8, v44, v8
    v_mul_f32 v9, v45, v9
    v_mul_f32 v10, v46, v10
    v_mul_f32 v11, v47, v11
    v_cvt_pk_bf16_f32 v64, v4, v5
    v_cvt_pk_bf16_f32 v65, v6, v7
    v_cvt_pk_bf16_f32 v66, v8, v9
    v_cvt_pk_bf16_f32 v67, v10, v11
    v_mul_f32 v12, v40, v12
    v_mul_f32 v13, v41, v13
    v_mul_f32 v14, v42, v14
    v_mul_f32 v15, v43, v15
    v_mul_f32 v16, v44, v16
    v_mul_f32 v17, v45, v17
    v_mul_f32 v18, v46, v18
    v_mul_f32 v19, v47, v19
    v_cvt_pk_bf16_f32 v68, v12, v13
    v_cvt_pk_bf16_f32 v69, v14, v15
    v_cvt_pk_bf16_f32 v70, v16, v17
    v_cvt_pk_bf16_f32 v71, v18, v19
    v_readlane_b32 s3, v253, s58
    s_lshl_b32 s44, s34, 7
    s_lshl_b32 s60, s58, 5
    s_and_b32 s48, s3, 0x3ffff
    s_bfe_u32 s33, s3, 0x30012
    s_sub_u32 s60, s60, s48
    s_and_b32 s60, s60, 0xff
    s_add_u32 s60, s60, s48
    s_mul_i32 s35, s38, 6
    s_cmp_eq_u32 s34, 0
    s_cselect_b32 s35, s35, s60
    s_mov_b32 s45, s44
    s_add_u32 s47, s44, 256
    s_add_u32 s49, s48, 32
    s_add_u32 s60, s48, 64
    s_cmp_eq_u32 s33, 3
    s_cselect_b32 s46, s44, s47
    s_cselect_b32 s50, s60, s48
    s_cselect_b32 s51, s48, s49
    s_sub_u32 s60, s33, 2
    s_cmp_lt_u32 s60, 2
    s_cbranch_scc0 K2_rare_64
K2_back_65:
    v_add_u32 v233, s48, v230
    ds_read_b32 v232, v233
    ds_read_b32 v233, v233 offset:1024
    v_add_u32 v222, s48, v251
    ds_read_b32 v222, v222
    v_add_u32 v224, s49, v251
    ds_read_b32 v224, v224
    v_add_u32 v226, s50, v251
    ds_read_b32 v226, v226
    v_add_u32 v228, s51, v251
    ds_read_b32 v228, v228
    s_waitcnt lgkmcnt(4)
    v_or_b32 v232, v232, v231
    v_or_b32 v233, v233, v231
    s_cmp_lg_u32 s34, 0
    s_cbranch_scc1 K2_dum_67
    s_add_u32 m0, s48, 864
    s_add_u32 s65, s48, 1888
    buffer_load_dwordx4 v232, s[16:19], 0 offen  lds
    s_mov_b32 m0, s65
    s_mov_b32 exec_hi, 0
    buffer_load_dwordx4 v233, s[16:19], 0 offen  lds
    s_cmp_eq_u32 s33, 4
    s_cbranch_scc1 K2_a4_68
K2_b4_70:
    s_mov_b32 exec_hi, -1
K2_back_69:
    s_waitcnt lgkmcnt(3)
    v_mad_u32_u16 v223, v222, s39, v248 op_sel:[1,0,0,0]
    v_mad_u32_u16 v222, v222, s39, v248
    s_waitcnt lgkmcnt(2)
    v_mad_u32_u16 v225, v224, s39, v248 op_sel:[1,0,0,0]
    v_mad_u32_u16 v224, v224, s39, v248
    s_waitcnt lgkmcnt(1)
    v_mad_u32_u16 v227, v226, s39, v248 op_sel:[1,0,0,0]
    v_mad_u32_u16 v226, v226, s39, v248
    s_waitcnt lgkmcnt(0)
    v_mad_u32_u16 v229, v228, s39, v248 op_sel:[1,0,0,0]
    v_mad_u32_u16 v228, v228, s39, v248
    s_waitcnt vmcnt(6)
    v_mfma_f32_32x32x16_bf16 v[0:15], v[64:67], v[176:179], 0
    ds_read_b64_tr_b16 v[184:185], v246 offset:2048
    ds_read_b64_tr_b16 v[186:187], v246 offset:2560
    ds_read_b64_tr_b16 v[188:189], v247 offset:2048
    ds_read_b64_tr_b16 v[190:191], v247 offset:2560
    s_mov_b32 m0, s68
    v_mfma_f32_32x32x16_bf16 v[16:31], v[68:71], v[176:179], 0
    buffer_load_dwordx4 v222, s[4:7], s44 offen lds
    buffer_load_dwordx4 v223, s[72:75], s44 offen offset:1024 lds
    v_permlane32_swap_b32 v242, v236
    v_permlane32_swap_b32 v243, v237
    v_mfma_f32_32x32x16_bf16 v[32:47], v[64:67], v[180:183], 0
    v_permlane32_swap_b32 v244, v238
    v_permlane32_swap_b32 v245, v239
    v_permlane32_swap_b32 v240, v241
    v_add_f32 v242, v242, v236
    v_mfma_f32_32x32x16_bf16 v[48:63], v[68:71], v[180:183], 0
    s_setprio 0
    v_add_f32 v243, v243, v237
    v_add_f32 v244, v244, v238
    v_add_f32 v245, v245, v239
    v_add_f32 v240, -v240, -v241
    s_set_gpr_idx_on s32, gpr_idx(DST)
    s_nop 0
    v_cvt_pk_bf16_f32 v195, v242, v243
    v_cvt_pk_bf16_f32 v196, v244, v245
    v_cvt_pk_bf16_f32 v197, v240, v240
    s_set_gpr_idx_off
    v_mul_f32 v234, v0, v96
    v_mul_f32 v236, v8, v128
    v_fmac_f32 v234, v1, v97
    v_fmac_f32 v236, v9, v129
    v_fmac_f32 v234, v2, v98
    v_fmac_f32 v236, v10, v130
    v_fmac_f32 v234, v3, v99
    v_fmac_f32 v236, v11, v131
    v_fmac_f32 v234, v4, v100
    v_fmac_f32 v236, v12, v132
    v_fmac_f32 v234, v5, v101
    v_fmac_f32 v236, v13, v133
    v_fmac_f32 v234, v6, v102
    v_fmac_f32 v236, v14, v134
    v_fmac_f32 v234, v7, v103
    v_fmac_f32 v236, v15, v135
    v_mul_f32 v238, v16, v128
    v_mul_f32 v240, v24, v128
    v_fmac_f32 v238, v17, v129
    v_fmac_f32 v240, v25, v129
    v_fmac_f32 v238, v18, v130
    v_fmac_f32 v240, v26, v130
    v_fmac_f32 v238, v19, v131
    v_fmac_f32 v240, v27, v131
    v_fmac_f32 v238, v20, v132
    v_fmac_f32 v240, v28, v132
    v_fmac_f32 v238, v21, v133
    v_fmac_f32 v240, v29, v133
    v_fmac_f32 v238, v22, v134
    v_fmac_f32 v240, v30, v134
    v_fmac_f32 v238, v23, v135
    v_fmac_f32 v240, v31, v135
    v_mul_f32 v235, v32, v104
    v_mul_f32 v237, v40, v136
    v_fmac_f32 v235, v33, v105
    v_fmac_f32 v237, v41, v137
    v_fmac_f32 v235, v34, v106
    v_fmac_f32 v237, v42, v138
    v_fmac_f32 v235, v35, v107
    v_fmac_f32 v237, v43, v139
    v_fmac_f32 v235, v36, v108
    v_fmac_f32 v237, v44, v140
    v_fmac_f32 v235, v37, v109
    v_fmac_f32 v237, v45, v141
    v_fmac_f32 v235, v38, v110
    v_fmac_f32 v237, v46, v142
    v_fmac_f32 v235, v39, v111
    v_fmac_f32 v237, v47, v143
    v_mul_f32 v239, v48, v136
    v_mul_f32 v241, v56, v136
    v_fmac_f32 v239, v49, v137
    v_fmac_f32 v241, v57, v137
    v_fmac_f32 v239, v50, v138
    v_fmac_f32 v241, v58, v138
    v_fmac_f32 v239, v51, v139
    v_fmac_f32 v241, v59, v139
    v_fmac_f32 v239, v52, v140
    v_fmac_f32 v241, v60, v140
    v_fmac_f32 v239, v53, v141
    v_fmac_f32 v241, v61, v141
    v_fmac_f32 v239, v54, v142
    v_fmac_f32 v241, v62, v142
    v_fmac_f32 v239, v55, v143
    v_fmac_f32 v241, v63, v143
    s_setprio 1
    s_waitcnt vmcnt(6) lgkmcnt(0)
    v_mfma_f32_32x32x16_bf16 v[0:15], v[64:67], v[184:187], 0
    ds_read_b64_tr_b16 v[176:177], v246 offset:4096
    ds_read_b64_tr_b16 v[178:179], v246 offset:4608
    ds_read_b64_tr_b16 v[180:181], v247 offset:4096
    ds_read_b64_tr_b16 v[182:183], v247 offset:4608
    s_mov_b32 m0, s69
    v_mfma_f32_32x32x16_bf16 v[16:31], v[68:71], v[184:187], 0
    buffer_load_dwordx4 v224, s[4:7], s45 offen lds
    buffer_load_dwordx4 v225, s[72:75], s45 offen offset:1024 lds
    v_permlane32_swap_b32 v234, v236
    v_permlane32_swap_b32 v235, v237
    v_mfma_f32_32x32x16_bf16 v[32:47], v[64:67], v[188:191], 0
    v_permlane32_swap_b32 v240, v238
    v_permlane32_swap_b32 v241, v239
    v_add_f32 v234, v234, v236
    v_add_f32 v235, v235, v237
    v_add_f32 v240, v240, v238
    v_mfma_f32_32x32x16_bf16 v[48:63], v[68:71], v[188:191], 0
    s_setprio 0
    v_add_f32 v241, v241, v239
    s_set_gpr_idx_on s31, gpr_idx(DST)
    s_nop 0
    v_cvt_pk_bf16_f32 v192, v234, v235
    v_cvt_pk_bf16_f32 v193, v240, v241
    s_set_gpr_idx_off
    v_mul_f32 v234, v0, v144
    v_mul_f32 v236, v8, v112
    v_fmac_f32 v234, v1, v145
    v_fmac_f32 v236, v9, v113
    v_fmac_f32 v234, v2, v146
    v_fmac_f32 v236, v10, v114
    v_fmac_f32 v234, v3, v147
    v_fmac_f32 v236, v11, v115
    v_fmac_f32 v234, v4, v148
    v_fmac_f32 v236, v12, v116
    v_fmac_f32 v234, v5, v149
    v_fmac_f32 v236, v13, v117
    v_fmac_f32 v234, v6, v150
    v_fmac_f32 v236, v14, v118
    v_fmac_f32 v234, v7, v151
    v_fmac_f32 v236, v15, v119
    v_mul_f32 v238, v16, v160
    v_mul_f32 v240, v24, v160
    v_fmac_f32 v238, v17, v161
    v_fmac_f32 v240, v25, v161
    v_fmac_f32 v238, v18, v162
    v_fmac_f32 v240, v26, v162
    v_fmac_f32 v238, v19, v163
    v_fmac_f32 v240, v27, v163
    v_fmac_f32 v238, v20, v164
    v_fmac_f32 v240, v28, v164
    v_fmac_f32 v238, v21, v165
    v_fmac_f32 v240, v29, v165
    v_fmac_f32 v238, v22, v166
    v_fmac_f32 v240, v30, v166
    v_fmac_f32 v238, v23, v167
    v_fmac_f32 v240, v31, v167
    v_mul_f32 v235, v32, v152
    v_mul_f32 v237, v40, v120
    v_fmac_f32 v235, v33, v153
    v_fmac_f32 v237, v41, v121
    v_fmac_f32 v235, v34, v154
    v_fmac_f32 v237, v42, v122
    v_fmac_f32 v235, v35, v155
    v_fmac_f32 v237, v43, v123
    v_fmac_f32 v235, v36, v156
    v_fmac_f32 v237, v44, v124
    v_fmac_f32 v235, v37, v157
    v_fmac_f32 v237, v45, v125
    v_fmac_f32 v235, v38, v158
    v_fmac_f32 v237, v46, v126
    v_fmac_f32 v235, v39, v159
    v_fmac_f32 v237, v47, v127
    v_mul_f32 v239, v48, v168
    v_mul_f32 v241, v56, v168
    v_fmac_f32 v239, v49, v169
    v_fmac_f32 v241, v57, v169
    v_fmac_f32 v239, v50, v170
    v_fmac_f32 v241, v58, v170
    v_fmac_f32 v239, v51, v171
    v_fmac_f32 v241, v59, v171
    v_fmac_f32 v239, v52, v172
    v_fmac_f32 v241, v60, v172
    v_fmac_f32 v239, v53, v173
    v_fmac_f32 v241, v61, v173
    v_fmac_f32 v239, v54, v174
    v_fmac_f32 v241, v62, v174
    v_fmac_f32 v239, v55, v175
    v_fmac_f32 v241, v63, v175
    s_setprio 1
    s_waitcnt vmcnt(6) lgkmcnt(0)
    v_mfma_f32_32x32x16_bf16 v[0:15], v[64:67], v[176:179], 0
    ds_read_b64_tr_b16 v[184:185], v246 offset:6144
    ds_read_b64_tr_b16 v[186:187], v246 offset:6656
    ds_read_b64_tr_b16 v[188:189], v247 offset:6144
    ds_read_b64_tr_b16 v[190:191], v247 offset:6656
    s_mov_b32 m0, s70
    v_mfma_f32_32x32x16_bf16 v[16:31], v[68:71], v[176:179], 0
    buffer_load_dwordx4 v226, s[4:7], s46 offen lds
    buffer_load_dwordx4 v227, s[72:75], s46 offen offset:1024 lds
    s_sub_u32 s26, s48, s29
    s_mov_b32 s29, s48
    s_mov_b32 s30, s3
    s_cmp_eq_u32 s34, 0
    s_cselect_b32 s56, s33, 0
    v_mfma_f32_32x32x16_bf16 v[32:47], v[64:67], v[180:183], 0
    v_mfma_f32_32x32x16_bf16 v[48:63], v[68:71], v[180:183], 0
    s_setprio 0
    v_mul_f32 v242, v0, v144
    v_fma_f32 v238, v8, v160, -v238
    v_fmac_f32 v242, v1, v145
    v_fmac_f32 v238, v9, v161
    v_fmac_f32 v242, v2, v146
    v_fmac_f32 v238, v10, v162
    v_fmac_f32 v242, v3, v147
    v_fmac_f32 v238, v11, v163
    v_fmac_f32 v242, v4, v148
    v_fmac_f32 v238, v12, v164
    v_fmac_f32 v242, v5, v149
    v_fmac_f32 v238, v13, v165
    v_fmac_f32 v242, v6, v150
    v_fmac_f32 v238, v14, v166
    v_fmac_f32 v242, v7, v151
    v_fmac_f32 v238, v15, v167
    v_fmac_f32 v236, v16, v112
    v_mul_f32 v244, v24, v160
    v_fmac_f32 v236, v17, v113
    v_fmac_f32 v244, v25, v161
    v_fmac_f32 v236, v18, v114
    v_fmac_f32 v244, v26, v162
    v_fmac_f32 v236, v19, v115
    v_fmac_f32 v244, v27, v163
    v_fmac_f32 v236, v20, v116
    v_fmac_f32 v244, v28, v164
    v_fmac_f32 v236, v21, v117
    v_fmac_f32 v244, v29, v165
    v_fmac_f32 v236, v22, v118
    v_fmac_f32 v244, v30, v166
    v_fmac_f32 v236, v23, v119
    v_fmac_f32 v244, v31, v167
    v_mul_f32 v243, v32, v152
    v_fma_f32 v239, v40, v168, -v239
    v_fmac_f32 v243, v33, v153
    v_fmac_f32 v239, v41, v169
    v_fmac_f32 v243, v34, v154
    v_fmac_f32 v239, v42, v170
    v_fmac_f32 v243, v35, v155
    v_fmac_f32 v239, v43, v171
    v_fmac_f32 v243, v36, v156
    v_fmac_f32 v239, v44, v172
    v_fmac_f32 v243, v37, v157
    v_fmac_f32 v239, v45, v173
    v_fmac_f32 v243, v38, v158
    v_fmac_f32 v239, v46, v174
    v_fmac_f32 v243, v39, v159
    v_fmac_f32 v239, v47, v175
    v_fmac_f32 v237, v48, v120
    v_mul_f32 v245, v56, v168
    v_fmac_f32 v237, v49, v121
    v_fmac_f32 v245, v57, v169
    v_fmac_f32 v237, v50, v122
    v_fmac_f32 v245, v58, v170
    v_fmac_f32 v237, v51, v123
    v_fmac_f32 v245, v59, v171
    v_fmac_f32 v237, v52, v124
    v_fmac_f32 v245, v60, v172
    v_fmac_f32 v237, v53, v125
    v_fmac_f32 v245, v61, v173
    v_fmac_f32 v237, v54, v126
    v_fmac_f32 v245, v62, v174
    v_fmac_f32 v237, v55, v127
    v_fmac_f32 v245, v63, v175
    s_setprio 1
    s_waitcnt vmcnt(4) lgkmcnt(0)
    v_mfma_f32_32x32x16_bf16 v[0:15], v[64:67], v[184:187], 0
    ds_read_b64_tr_b16 v[176:177], v246 offset:0
    ds_read_b64_tr_b16 v[178:179], v246 offset:512
    ds_read_b64_tr_b16 v[180:181], v247 offset:0
    ds_read_b64_tr_b16 v[182:183], v247 offset:512
    s_mov_b32 m0, s71
    v_mfma_f32_32x32x16_bf16 v[16:31], v[68:71], v[184:187], 0
    buffer_load_dwordx4 v228, s[4:7], s47 offen lds
    buffer_load_dwordx4 v229, s[72:75], s47 offen offset:1024 lds
    v_permlane32_swap_b32 v242, v234
    v_permlane32_swap_b32 v243, v235
    v_add_f32 v242, v242, v234
    v_mfma_f32_32x32x16_bf16 v[32:47], v[64:67], v[188:191], 0
    v_add_f32 v243, v243, v235
    s_set_gpr_idx_on s31, gpr_idx(DST)
    s_nop 0
    v_cvt_pk_bf16_f32 v194, v242, v243
    s_set_gpr_idx_off
    s_mov_b32 s32, s31
    s_mov_b32 s31, s35
    v_mfma_f32_32x32x16_bf16 v[48:63], v[68:71], v[188:191], 0
    s_setprio 0
    v_mul_f32 v242, v0, v144
    v_fma_f32 v240, v8, v160, -v240
    v_fmac_f32 v242, v1, v145
    v_fmac_f32 v240, v9, v161
    v_fmac_f32 v242, v2, v146
    v_fmac_f32 v240, v10, v162
    v_fmac_f32 v242, v3, v147
    v_fmac_f32 v240, v11, v163
    v_fmac_f32 v242, v4, v148
    v_fmac_f32 v240, v12, v164
    v_fmac_f32 v242, v5, v149
    v_fmac_f32 v240, v13, v165
    v_fmac_f32 v242, v6, v150
    v_fmac_f32 v240, v14, v166
    v_fmac_f32 v242, v7, v151
    v_fmac_f32 v240, v15, v167
    v_add_u32 v249, s26, v249
    v_add_u32 v250, s26, v250
    v_fma_f32 v244, v16, v160, -v244
    v_fmac_f32 v236, v24, v112
    v_fmac_f32 v244, v17, v161
    v_fmac_f32 v236, v25, v113
    v_fmac_f32 v244, v18, v162
    v_fmac_f32 v236, v26, v114
    v_fmac_f32 v244, v19, v163
    v_fmac_f32 v236, v27, v115
    v_fmac_f32 v244, v20, v164
    v_fmac_f32 v236, v28, v116
    v_fmac_f32 v244, v21, v165
    v_fmac_f32 v236, v29, v117
    v_fmac_f32 v244, v22, v166
    v_fmac_f32 v236, v30, v118
    v_fmac_f32 v244, v23, v167
    v_fmac_f32 v236, v31, v119
    ds_read_b64_tr_b16 v[0:1], v249 offset:0
    ds_read_b64_tr_b16 v[2:3], v249 offset:128
    ds_read_b128 v[4:7], v250 offset:0
    ds_read_b128 v[8:11], v250 offset:16
    ds_read_b128 v[12:15], v250 offset:384
    ds_read_b128 v[16:19], v250 offset:400
    v_mul_f32 v243, v32, v152
    v_fma_f32 v241, v40, v168, -v241
    v_fmac_f32 v243, v33, v153
    v_fmac_f32 v241, v41, v169
    v_fmac_f32 v243, v34, v154
    v_fmac_f32 v241, v42, v170
    v_fmac_f32 v243, v35, v155
    v_fmac_f32 v241, v43, v171
    v_fmac_f32 v243, v36, v156
    v_fmac_f32 v241, v44, v172
    v_fmac_f32 v243, v37, v157
    v_fmac_f32 v241, v45, v173
    v_fmac_f32 v243, v38, v158
    v_fmac_f32 v241, v46, v174
    v_fmac_f32 v243, v39, v159
    v_fmac_f32 v241, v47, v175
    ds_read_b64_tr_b16 v[20:21], v249 offset:512
    ds_read_b64_tr_b16 v[22:23], v249 offset:640
    ds_read_b128 v[24:27], v250 offset:64
    ds_read_b128 v[28:31], v250 offset:80
    ds_read_b128 v[32:35], v250 offset:448
    ds_read_b128 v[36:39], v250 offset:464
    v_fma_f32 v245, v48, v168, -v245
    v_fmac_f32 v237, v56, v120
    v_fmac_f32 v245, v49, v169
    v_fmac_f32 v237, v57, v121
    v_fmac_f32 v245, v50, v170
    v_fmac_f32 v237, v58, v122
    v_fmac_f32 v245, v51, v171
    v_fmac_f32 v237, v59, v123
    v_fmac_f32 v245, v52, v172
    v_fmac_f32 v237, v60, v124
    v_fmac_f32 v245, v53, v173
    v_fmac_f32 v237, v61, v125
    v_fmac_f32 v245, v54, v174
    v_fmac_f32 v237, v62, v126
    v_fmac_f32 v245, v55, v175
    v_fmac_f32 v237, v63, v127
    s_cmp_eq_u32 s56, 2
    s_cbranch_scc1 K2_U20
    s_cmp_eq_u32 s56, 3
    s_cbranch_scc1 K2_U30
    s_branch K2_DSP0
K2_U40:
    s_setprio 1
    s_waitcnt lgkmcnt(6)
    v_lshlrev_b32 v40, 16, v0
    v_and_b32 v41, 0xffff0000, v0
    v_lshlrev_b32 v42, 16, v1
    v_and_b32 v43, 0xffff0000, v1
    v_lshlrev_b32 v44, 16, v2
    v_and_b32 v45, 0xffff0000, v2
    v_lshlrev_b32 v46, 16, v3
    v_and_b32 v47, 0xffff0000, v3
    v_mul_f32 v4, v40, v4
    v_mul_f32 v5, v41, v5
    v_mul_f32 v6, v42, v6
    v_mul_f32 v7, v43, v7
    v_mul_f32 v8, v44, v8
    v_mul_f32 v9, v45, v9
    v_mul_f32 v10, v46, v10
    v_mul_f32 v11, v47, v11
    v_cvt_pk_bf16_f32 v64, v4, v5
    v_cvt_pk_bf16_f32 v65, v6, v7
    v_cvt_pk_bf16_f32 v66, v8, v9
    v_cvt_pk_bf16_f32 v67, v10, v11
    v_mul_f32 v12, v40, v12
    v_mul_f32 v13, v41, v13
    v_mul_f32 v14, v42, v14
    v_mul_f32 v15, v43, v15
    v_mul_f32 v16, v44, v16
    v_mul_f32 v17, v45, v17
    v_mul_f32 v18, v46, v18
    v_mul_f32 v19, v47, v19
    v_cvt_pk_bf16_f32 v68, v12, v13
    v_cvt_pk_bf16_f32 v69, v14, v15
    v_cvt_pk_bf16_f32 v70, v16, v17
    v_cvt_pk_bf16_f32 v71, v18, v19
    ds_read_b64_tr_b16 v[0:1], v249 offset:1024
    ds_read_b64_tr_b16 v[2:3], v249 offset:1152
    ds_read_b128 v[4:7], v250 offset:128
    ds_read_b128 v[8:11], v250 offset:144
    ds_read_b128 v[12:15], v250 offset:512
    ds_read_b128 v[16:19], v250 offset:528
    s_waitcnt lgkmcnt(6)
    v_lshlrev_b32 v48, 16, v20
    v_and_b32 v49, 0xffff0000, v20
    v_lshlrev_b32 v50, 16, v21
    v_and_b32 v51, 0xffff0000, v21
    v_lshlrev_b32 v52, 16, v22
    v_and_b32 v53, 0xffff0000, v22
    v_lshlrev_b32 v54, 16, v23
    v_and_b32 v55, 0xffff0000, v23
    v_mul_f32 v24, v48, v24
    v_mul_f32 v25, v49, v25
    v_mul_f32 v26, v50, v26
    v_mul_f32 v27, v51, v27
    v_mul_f32 v28, v52, v28
    v_mul_f32 v29, v53, v29
    v_mul_f32 v30, v54, v30
    v_mul_f32 v31, v55, v31
    v_cvt_pk_bf16_f32 v72, v24, v25
    v_cvt_pk_bf16_f32 v73, v26, v27
    v_cvt_pk_bf16_f32 v74, v28, v29
    v_cvt_pk_bf16_f32 v75, v30, v31
    v_mul_f32 v32, v48, v32
    v_mul_f32 v33, v49, v33
    v_mul_f32 v34, v50, v34
    v_mul_f32 v35, v51, v35
    v_mul_f32 v36, v52, v36
    v_mul_f32 v37, v53, v37
    v_mul_f32 v38, v54, v38
    v_mul_f32 v39, v55, v39
    v_cvt_pk_bf16_f32 v76, v32, v33
    v_cvt_pk_bf16_f32 v77, v34, v35
    v_cvt_pk_bf16_f32 v78, v36, v37
    v_cvt_pk_bf16_f32 v79, v38, v39
    s_lshr_b32 s65, s30, 27
    s_mov_b32 s66, 161536
    s_cmp_ge_u32 s65, 2
    s_cselect_b32 s66, 158112, s66
    s_mul_i32 s65, s65, 512
    s_add_u32 s65, s65, s66
    s_sub_u32 s65, s65, s29
    v_add_u32 v56, s65, v249
    s_lshr_b32 s65, s30, 27
    s_mov_b32 s66, 161536
    s_cmp_ge_u32 s65, 2
    s_cselect_b32 s66, 159008, s66
    s_mul_i32 s65, s65, 64
    s_add_u32 s65, s65, s66
    s_sub_u32 s65, s65, s29
    v_add_u32 v57, s65, v250
    ds_read_b64_tr_b16 v[20:21], v56 offset:0
    ds_read_b64_tr_b16 v[22:23], v56 offset:128
    ds_read_b128 v[24:27], v57 offset:0
    ds_read_b128 v[28:31], v57 offset:16
    ds_read_b128 v[32:35], v57 offset:384
    ds_read_b128 v[36:39], v57 offset:400
    s_waitcnt lgkmcnt(10)
    v_lshlrev_b32 v40, 16, v0
    v_and_b32 v41, 0xffff0000, v0
    v_lshlrev_b32 v42, 16, v1
    v_and_b32 v43, 0xffff0000, v1
    v_lshlrev_b32 v44, 16, v2
    v_and_b32 v45, 0xffff0000, v2
    v_lshlrev_b32 v46, 16, v3
    v_and_b32 v47, 0xffff0000, v3
    s_waitcnt lgkmcnt(8)
    v_mul_f32 v4, v40, v4
    v_mul_f32 v5, v41, v5
    v_mul_f32 v6, v42, v6
    v_mul_f32 v7, v43, v7
    v_mul_f32 v8, v44, v8
    v_mul_f32 v9, v45, v9
    v_mul_f32 v10, v46, v10
    v_mul_f32 v11, v47, v11
    v_cvt_pk_bf16_f32 v80, v4, v5
    v_cvt_pk_bf16_f32 v81, v6, v7
    v_cvt_pk_bf16_f32 v82, v8, v9
    v_cvt_pk_bf16_f32 v83, v10, v11
    s_waitcnt lgkmcnt(6)
    v_mul_f32 v12, v40, v12
    v_mul_f32 v13, v41, v13
    v_mul_f32 v14, v42, v14
    v_mul_f32 v15, v43, v15
    v_mul_f32 v16, v44, v16
    v_mul_f32 v17, v45, v17
    v_mul_f32 v18, v46, v18
    v_mul_f32 v19, v47, v19
    v_cvt_pk_bf16_f32 v84, v12, v13
    v_cvt_pk_bf16_f32 v85, v14, v15
    v_cvt_pk_bf16_f32 v86, v16, v17
    v_cvt_pk_bf16_f32 v87, v18, v19
    s_waitcnt lgkmcnt(4)
    v_lshlrev_b32 v48, 16, v20
    v_and_b32 v49, 0xffff0000, v20
    v_lshlrev_b32 v50, 16, v21
    v_and_b32 v51, 0xffff0000, v21
    v_lshlrev_b32 v52, 16, v22
    v_and_b32 v53, 0xffff0000, v22
    v_lshlrev_b32 v54, 16, v23
    v_and_b32 v55, 0xffff0000, v23
    s_waitcnt lgkmcnt(2)
    v_mul_f32 v24, v48, v24
    v_mul_f32 v25, v49, v25
    v_mul_f32 v26, v50, v26
    v_mul_f32 v27, v51, v27
    v_mul_f32 v28, v52, v28
    v_mul_f32 v29, v53, v29
    v_mul_f32 v30, v54, v30
    v_mul_f32 v31, v55, v31
    v_cvt_pk_bf16_f32 v88, v24, v25
    v_cvt_pk_bf16_f32 v89, v26, v27
    v_cvt_pk_bf16_f32 v90, v28, v29
    v_cvt_pk_bf16_f32 v91, v30, v31
    s_waitcnt lgkmcnt(0)
    v_mul_f32 v32, v48, v32
    v_mul_f32 v33, v49, v33
    v_mul_f32 v34, v50, v34
    v_mul_f32 v35, v51, v35
    v_mul_f32 v36, v52, v36
    v_mul_f32 v37, v53, v37
    v_mul_f32 v38, v54, v38
    v_mul_f32 v39, v55, v39
    v_cvt_pk_bf16_f32 v92, v32, v33
    v_cvt_pk_bf16_f32 v93, v34, v35
    v_cvt_pk_bf16_f32 v94, v36, v37
    v_cvt_pk_bf16_f32 v95, v38, v39
    s_waitcnt vmcnt(4)
    v_mfma_f32_32x32x16_bf16 v[0:15], v[64:67], v[176:179], 0
    ds_read_b64_tr_b16 v[184:185], v246 offset:2048
    ds_read_b64_tr_b16 v[186:187], v246 offset:2560
    ds_read_b64_tr_b16 v[188:189], v247 offset:2048
    ds_read_b64_tr_b16 v[190:191], v247 offset:2560
    s_mov_b32 m0, s68
    v_mfma_f32_32x32x16_bf16 v[16:31], v[68:71], v[176:179], 0
    buffer_load_dwordx4 v222, s[4:7], s41 offen lds
    buffer_load_dwordx4 v223, s[72:75], s41 offen offset:1024 lds
    v_permlane32_swap_b32 v242, v236
    v_permlane32_swap_b32 v243, v237
    s_add_u32 s38, s38, 1
    v_mfma_f32_32x32x16_bf16 v[32:47], v[64:67], v[180:183], 0
    v_permlane32_swap_b32 v244, v238
    v_permlane32_swap_b32 v245, v239
    v_permlane32_swap_b32 v240, v241
    v_add_f32 v242, v242, v236
    v_mfma_f32_32x32x16_bf16 v[48:63], v[68:71], v[180:183], 0
    v_add_f32 v243, v243, v237
    v_add_f32 v244, v244, v238
    v_add_f32 v245, v245, v239
    v_add_f32 v240, -v240, -v241
    v_mov_b32 v254, s52
    v_mov_b32 v255, s38
    s_waitcnt vmcnt(4) lgkmcnt(0)
    v_mfma_f32_32x32x16_bf16 v[0:15], v[72:75], v[184:187], v[0:15]
    ds_read_b64_tr_b16 v[176:177], v246 offset:4096
    ds_read_b64_tr_b16 v[178:179], v246 offset:4608
    ds_read_b64_tr_b16 v[180:181], v247 offset:4096
    ds_read_b64_tr_b16 v[182:183], v247 offset:4608
    s_lshl_b32 s58, s38, 3
    s_add_u32 s58, s58, s20
    s_mov_b32 m0, s69
    v_mfma_f32_32x32x16_bf16 v[16:31], v[76:79], v[184:187], v[16:31]
    buffer_load_dwordx4 v224, s[4:7], s41 offen lds
    buffer_load_dwordx4 v225, s[72:75], s41 offen offset:1024 lds
    s_set_gpr_idx_on s32, gpr_idx(DST)
    s_nop 0
    v_cvt_pk_bf16_f32 v195, v242, v243
    v_cvt_pk_bf16_f32 v196, v244, v245
    v_cvt_pk_bf16_f32 v197, v240, v240
    s_set_gpr_idx_off
    s_mov_b64 exec, 1
    ds_write_b32 v254, v255
    s_mov_b64 exec, -1
    s_cmp_lt_u32 s58, s22
    s_cbranch_scc0 K2_dyn_71
K2_back_72:
    v_readlane_b32 s3, v253, s58
    s_lshl_b32 s44, s34, 7
    s_lshl_b32 s60, s58, 5
    s_and_b32 s48, s3, 0x3ffff
    s_bfe_u32 s33, s3, 0x30012
    s_sub_u32 s60, s60, s48
    s_and_b32 s60, s60, 0xff
    s_add_u32 s60, s60, s48
    s_mul_i32 s35, s38, 6
    s_cmp_eq_u32 s34, 0
    s_cselect_b32 s35, s35, s60
    s_mov_b32 s45, s44
    s_add_u32 s47, s44, 256
    s_add_u32 s49, s48, 32
    s_add_u32 s60, s48, 64
    s_cmp_eq_u32 s33, 3
    s_cselect_b32 s46, s44, s47
    s_cselect_b32 s50, s60, s48
    s_cselect_b32 s51, s48, s49
    s_sub_u32 s60, s33, 2
    s_cmp_lt_u32 s60, 2
    s_cbranch_scc0 K2_rare_77
K2_back_78:
    v_mfma_f32_32x32x16_bf16 v[32:47], v[72:75], v[188:191], v[32:47]
    v_add_u32 v233, s48, v230
    ds_read_b32 v232, v233
    ds_read_b32 v233, v233 offset:1024
    v_mfma_f32_32x32x16_bf16 v[48:63], v[76:79], v[188:191], v[48:63]
    s_waitcnt vmcnt(4) lgkmcnt(3)
    v_mfma_f32_32x32x16_bf16 v[0:15], v[80:83], v[176:179], v[0:15]
    ds_read_b64_tr_b16 v[184:185], v246 offset:6144
    ds_read_b64_tr_b16 v[186:187], v246 offset:6656
    ds_read_b64_tr_b16 v[188:189], v247 offset:6144
    ds_read_b64_tr_b16 v[190:191], v247 offset:6656
    s_mov_b32 m0, s70
    v_mfma_f32_32x32x16_bf16 v[16:31], v[84:87], v[176:179], v[16:31]
    buffer_load_dwordx4 v226, s[4:7], s41 offen lds
    buffer_load_dwordx4 v227, s[72:75], s41 offen offset:1024 lds
    v_mfma_f32_32x32x16_bf16 v[32:47], v[80:83], v[180:183], v[32:47]
    v_mfma_f32_32x32x16_bf16 v[48:63], v[84:87], v[180:183], v[48:63]
    s_waitcnt lgkmcnt(4)
    v_or_b32 v232, v232, v231
    v_or_b32 v233, v233, v231
    s_cmp_lg_u32 s34, 0
    s_cbranch_scc1 K2_dum_80
    s_add_u32 m0, s48, 864
    s_add_u32 s65, s48, 1888
    buffer_load_dwordx4 v232, s[16:19], 0 offen  lds
    s_mov_b32 m0, s65
    s_mov_b32 exec_hi, 0
    buffer_load_dwordx4 v233, s[16:19], 0 offen  lds
    s_cmp_eq_u32 s33, 4
    s_cbranch_scc1 K2_a4_81
K2_b4_83:
    s_mov_b32 exec_hi, -1
K2_back_82:
    s_waitcnt vmcnt(6) lgkmcnt(0)
    v_mfma_f32_32x32x16_bf16 v[0:15], v[88:91], v[184:187], v[0:15]
    ds_read_b64_tr_b16 v[176:177], v246 offset:0
    ds_read_b64_tr_b16 v[178:179], v246 offset:512
    ds_read_b64_tr_b16 v[180:181], v247 offset:0
    ds_read_b64_tr_b16 v[182:183], v247 offset:512
    s_mov_b32 m0, s71
    v_mfma_f32_32x32x16_bf16 v[16:31], v[92:95], v[184:187], v[16:31]
    buffer_load_dwordx4 v228, s[4:7], s41 offen lds
    buffer_load_dwordx4 v229, s[72:75], s41 offen offset:1024 lds
    v_mfma_f32_32x32x16_bf16 v[32:47], v[88:91], v[188:191], v[32:47]
    s_nop 2
    v_mul_f32 v234, v0, v96
    v_mul_f32 v236, v8, v128
    v_fmac_f32 v234, v1, v97
    v_fmac_f32 v236, v9, v129
    v_fmac_f32 v234, v2, v98
    v_fmac_f32 v236, v10, v130
    v_fmac_f32 v234, v3, v99
    v_mfma_f32_32x32x16_bf16 v[48:63], v[92:95], v[188:191], v[48:63]
    s_setprio 0
    v_fmac_f32 v236, v11, v131
    v_fmac_f32 v234, v4, v100
    v_fmac_f32 v236, v12, v132
    v_fmac_f32 v234, v5, v101
    v_fmac_f32 v236, v13, v133
    v_fmac_f32 v234, v6, v102
    v_fmac_f32 v236, v14, v134
    v_fmac_f32 v234, v7, v103
    v_fmac_f32 v236, v15, v135
    v_mul_f32 v238, v16, v128
    v_mul_f32 v240, v24, v128
    v_fmac_f32 v238, v17, v129
    v_fmac_f32 v240, v25, v129
    v_fmac_f32 v238, v18, v130
    v_fmac_f32 v240, v26, v130
    v_fmac_f32 v238, v19, v131
    v_fmac_f32 v240, v27, v131
    v_fmac_f32 v238, v20, v132
    v_fmac_f32 v240, v28, v132
    v_fmac_f32 v238, v21, v133
    v_fmac_f32 v240, v29, v133
    v_fmac_f32 v238, v22, v134
    v_fmac_f32 v240, v30, v134
    v_fmac_f32 v238, v23, v135
    v_fmac_f32 v240, v31, v135
    v_mul_f32 v235, v32, v104
    v_mul_f32 v237, v40, v136
    v_fmac_f32 v235, v33, v105
    v_fmac_f32 v237, v41, v137
    v_fmac_f32 v235, v34, v106
    v_fmac_f32 v237, v42, v138
    v_fmac_f32 v235, v35, v107
    v_fmac_f32 v237, v43, v139
    v_fmac_f32 v235, v36, v108
    v_fmac_f32 v237, v44, v140
    v_fmac_f32 v235, v37, v109
    v_fmac_f32 v237, v45, v141
    v_fmac_f32 v235, v38, v110
    v_fmac_f32 v237, v46, v142
    v_fmac_f32 v235, v39, v111
    v_fmac_f32 v237, v47, v143
    v_mul_f32 v239, v48, v136
    v_mul_f32 v241, v56, v136
    s_setprio 1
    s_waitcnt vmcnt(6) lgkmcnt(0)
    v_mfma_f32_32x32x16_bf16 v[0:15], v[64:67], v[176:179], 0
    ds_read_b64_tr_b16 v[184:185], v246 offset:2048
    ds_read_b64_tr_b16 v[186:187], v246 offset:2560
    ds_read_b64_tr_b16 v[188:189], v247 offset:2048
    ds_read_b64_tr_b16 v[190:191], v247 offset:2560
    v_fmac_f32 v239, v49, v137
    v_fmac_f32 v241, v57, v137
    s_mov_b32 m0, s68
    v_mfma_f32_32x32x16_bf16 v[16:31], v[68:71], v[176:179], 0
    buffer_load_dwordx4 v222, s[4:7], s42 offen lds
    buffer_load_dwordx4 v223, s[72:75], s42 offen offset:1024 lds
    v_fmac_f32 v239, v50, v138
    v_fmac_f32 v241, v58, v138
    v_fmac_f32 v239, v51, v139
    v_fmac_f32 v241, v59, v139
    v_fmac_f32 v239, v52, v140
    v_mfma_f32_32x32x16_bf16 v[32:47], v[64:67], v[180:183], 0
    v_fmac_f32 v241, v60, v140
    v_fmac_f32 v239, v53, v141
    v_fmac_f32 v241, v61, v141
    v_fmac_f32 v239, v54, v142
    v_fmac_f32 v241, v62, v142
    v_fmac_f32 v239, v55, v143
    v_fmac_f32 v241, v63, v143
    v_mfma_f32_32x32x16_bf16 v[48:63], v[68:71], v[180:183], 0
    v_permlane32_swap_b32 v234, v236
    v_permlane32_swap_b32 v235, v237
    v_permlane32_swap_b32 v240, v238
    s_waitcnt vmcnt(6) lgkmcnt(0)
    v_mfma_f32_32x32x16_bf16 v[0:15], v[72:75], v[184:187], v[0:15]
    ds_read_b64_tr_b16 v[176:177], v246 offset:4096
    ds_read_b64_tr_b16 v[178:179], v246 offset:4608
    ds_read_b64_tr_b16 v[180:181], v247 offset:4096
    ds_read_b64_tr_b16 v[182:183], v247 offset:4608
    v_permlane32_swap_b32 v241, v239
    s_mov_b32 m0, s69
    v_mfma_f32_32x32x16_bf16 v[16:31], v[76:79], v[184:187], v[16:31]
    buffer_load_dwordx4 v224, s[4:7], s42 offen lds
    buffer_load_dwordx4 v225, s[72:75], s42 offen offset:1024 lds
    v_add_f32 v234, v234, v236
    v_add_f32 v235, v235, v237
    v_add_f32 v240, v240, v238
    v_add_f32 v241, v241, v239
    v_mfma_f32_32x32x16_bf16 v[32:47], v[72:75], v[188:191], v[32:47]
    s_set_gpr_idx_on s31, gpr_idx(DST)
    s_nop 0
    v_cvt_pk_bf16_f32 v192, v234, v235
    v_cvt_pk_bf16_f32 v193, v240, v241
    s_set_gpr_idx_off
    v_mfma_f32_32x32x16_bf16 v[48:63], v[76:79], v[188:191], v[48:63]
    s_waitcnt vmcnt(4) lgkmcnt(0)
    v_mfma_f32_32x32x16_bf16 v[0:15], v[80:83], v[176:179], v[0:15]
    ds_read_b64_tr_b16 v[184:185], v246 offset:6144
    ds_read_b64_tr_b16 v[186:187], v246 offset:6656
    ds_read_b64_tr_b16 v[188:189], v247 offset:6144
    ds_read_b64_tr_b16 v[190:191], v247 offset:6656
    s_mov_b32 m0, s70
    v_mfma_f32_32x32x16_bf16 v[16:31], v[84:87], v[176:179], v[16:31]
    buffer_load_dwordx4 v226, s[4:7], s42 offen lds
    buffer_load_dwordx4 v227, s[72:75], s42 offen offset:1024 lds
    v_mfma_f32_32x32x16_bf16 v[32:47], v[80:83], v[180:183], v[32:47]
    v_mfma_f32_32x32x16_bf16 v[48:63], v[84:87], v[180:183], v[48:63]
    s_waitcnt vmcnt(4) lgkmcnt(0)
    v_mfma_f32_32x32x16_bf16 v[0:15], v[88:91], v[184:187], v[0:15]
    ds_read_b64_tr_b16 v[176:177], v246 offset:0
    ds_read_b64_tr_b16 v[178:179], v246 offset:512
    ds_read_b64_tr_b16 v[180:181], v247 offset:0
    ds_read_b64_tr_b16 v[182:183], v247 offset:512
    s_mov_b32 m0, s71
    v_mfma_f32_32x32x16_bf16 v[16:31], v[92:95], v[184:187], v[16:31]
    buffer_load_dwordx4 v228, s[4:7], s42 offen lds
    buffer_load_dwordx4 v229, s[72:75], s42 offen offset:1024 lds
    v_mfma_f32_32x32x16_bf16 v[32:47], v[88:91], v[188:191], v[32:47]
    s_nop 2
    v_mul_f32 v234, v0, v144
    v_mul_f32 v236, v8, v112
    v_fmac_f32 v234, v1, v145
    v_fmac_f32 v236, v9, v113
    v_fmac_f32 v234, v2, v146
    v_fmac_f32 v236, v10, v114
    v_fmac_f32 v234, v3, v147
    v_mfma_f32_32x32x16_bf16 v[48:63], v[92:95], v[188:191], v[48:63]
    s_setprio 0
    v_fmac_f32 v236, v11, v115
    v_fmac_f32 v234, v4, v148
    v_fmac_f32 v236, v12, v116
    v_fmac_f32 v234, v5, v149
    v_fmac_f32 v236, v13, v117
    v_fmac_f32 v234, v6, v150
    v_fmac_f32 v236, v14, v118
    v_fmac_f32 v234, v7, v151
    v_fmac_f32 v236, v15, v119
    v_mul_f32 v238, v16, v160
    v_mul_f32 v240, v24, v160
    v_fmac_f32 v238, v17, v161
    v_fmac_f32 v240, v25, v161
    v_fmac_f32 v238, v18, v162
    v_fmac_f32 v240, v26, v162
    v_fmac_f32 v238, v19, v163
    v_fmac_f32 v240, v27, v163
    v_fmac_f32 v238, v20, v164
    v_fmac_f32 v240, v28, v164
    v_fmac_f32 v238, v21, v165
    v_fmac_f32 v240, v29, v165
    v_fmac_f32 v238, v22, v166
    v_fmac_f32 v240, v30, v166
    v_fmac_f32 v238, v23, v167
    v_fmac_f32 v240, v31, v167
    v_mul_f32 v235, v32, v152
    v_mul_f32 v237, v40, v120
    v_fmac_f32 v235, v33, v153
    v_fmac_f32 v237, v41, v121
    v_fmac_f32 v235, v34, v154
    v_fmac_f32 v237, v42, v122
    v_fmac_f32 v235, v35, v155
    v_fmac_f32 v237, v43, v123
    v_fmac_f32 v235, v36, v156
    v_fmac_f32 v237, v44, v124
    v_fmac_f32 v235, v37, v157
    v_fmac_f32 v237, v45, v125
    v_fmac_f32 v235, v38, v158
    v_fmac_f32 v237, v46, v126
    v_fmac_f32 v235, v39, v159
    v_fmac_f32 v237, v47, v127
    v_mul_f32 v239, v48, v168
    v_mul_f32 v241, v56, v168
    s_setprio 1
    s_waitcnt vmcnt(4) lgkmcnt(0)
    v_mfma_f32_32x32x16_bf16 v[0:15], v[64:67], v[176:179], 0
    ds_read_b64_tr_b16 v[184:185], v246 offset:2048
    ds_read_b64_tr_b16 v[186:187], v246 offset:2560
    ds_read_b64_tr_b16 v[188:189], v247 offset:2048
    ds_read_b64_tr_b16 v[190:191], v247 offset:2560
    v_fmac_f32 v239, v49, v169
    v_fmac_f32 v241, v57, v169
    s_mov_b32 m0, s68
    v_mfma_f32_32x32x16_bf16 v[16:31], v[68:71], v[176:179], 0
    buffer_load_dwordx4 v222, s[4:7], s43 offen lds
    buffer_load_dwordx4 v223, s[72:75], s43 offen offset:1024 lds
    v_fmac_f32 v239, v50, v170
    v_fmac_f32 v241, v58, v170
    v_fmac_f32 v239, v51, v171
    v_fmac_f32 v241, v59, v171
    v_fmac_f32 v239, v52, v172
    v_mfma_f32_32x32x16_bf16 v[32:47], v[64:67], v[180:183], 0
    v_fmac_f32 v241, v60, v172
    v_fmac_f32 v239, v53, v173
    v_fmac_f32 v241, v61, v173
    v_fmac_f32 v239, v54, v174
    v_fmac_f32 v241, v62, v174
    v_fmac_f32 v239, v55, v175
    v_fmac_f32 v241, v63, v175
    v_mfma_f32_32x32x16_bf16 v[48:63], v[68:71], v[180:183], 0
    s_waitcnt vmcnt(4) lgkmcnt(0)
    v_mfma_f32_32x32x16_bf16 v[0:15], v[72:75], v[184:187], v[0:15]
    ds_read_b64_tr_b16 v[176:177], v246 offset:4096
    ds_read_b64_tr_b16 v[178:179], v246 offset:4608
    ds_read_b64_tr_b16 v[180:181], v247 offset:4096
    ds_read_b64_tr_b16 v[182:183], v247 offset:4608
    s_mov_b32 m0, s69
    v_mfma_f32_32x32x16_bf16 v[16:31], v[76:79], v[184:187], v[16:31]
    buffer_load_dwordx4 v224, s[4:7], s43 offen lds
    buffer_load_dwordx4 v225, s[72:75], s43 offen offset:1024 lds
    v_mfma_f32_32x32x16_bf16 v[32:47], v[72:75], v[188:191], v[32:47]
    v_mfma_f32_32x32x16_bf16 v[48:63], v[76:79], v[188:191], v[48:63]
    s_waitcnt vmcnt(4) lgkmcnt(0)
    v_mfma_f32_32x32x16_bf16 v[0:15], v[80:83], v[176:179], v[0:15]
    ds_read_b64_tr_b16 v[184:185], v246 offset:6144
    ds_read_b64_tr_b16 v[186:187], v246 offset:6656
    ds_read_b64_tr_b16 v[188:189], v247 offset:6144
    ds_read_b64_tr_b16 v[190:191], v247 offset:6656
    s_mov_b32 m0, s70
    v_mfma_f32_32x32x16_bf16 v[16:31], v[84:87], v[176:179], v[16:31]
    buffer_load_dwordx4 v226, s[4:7], s43 offen lds
    buffer_load_dwordx4 v227, s[72:75], s43 offen offset:1024 lds
    v_mfma_f32_32x32x16_bf16 v[32:47], v[80:83], v[180:183], v[32:47]
    v_add_u32 v222, s48, v251
    ds_read_b32 v222, v222
    v_mfma_f32_32x32x16_bf16 v[48:63], v[84:87], v[180:183], v[48:63]
    s_waitcnt vmcnt(4) lgkmcnt(1)
    v_mfma_f32_32x32x16_bf16 v[0:15], v[88:91], v[184:187], v[0:15]
    ds_read_b64_tr_b16 v[176:177], v246 offset:0
    ds_read_b64_tr_b16 v[178:179], v246 offset:512
    ds_read_b64_tr_b16 v[180:181], v247 offset:0
    ds_read_b64_tr_b16 v[182:183], v247 offset:512
    s_mov_b32 m0, s71
    v_mfma_f32_32x32x16_bf16 v[16:31], v[92:95], v[184:187], v[16:31]
    buffer_load_dwordx4 v228, s[4:7], s43 offen lds
    buffer_load_dwordx4 v229, s[72:75], s43 offen offset:1024 lds
    s_waitcnt lgkmcnt(4)
    v_mad_u32_u16 v223, v222, s39, v248 op_sel:[1,0,0,0]
    v_mad_u32_u16 v222, v222, s39, v248
    v_mfma_f32_32x32x16_bf16 v[32:47], v[88:91], v[188:191], v[32:47]
    v_add_u32 v224, s49, v251
    ds_read_b32 v224, v224
    v_mul_f32 v242, v0, v144
    v_fma_f32 v238, v8, v160, -v238
    v_fmac_f32 v242, v1, v145
    v_fmac_f32 v238, v9, v161
    v_fmac_f32 v242, v2, v146
    v_mfma_f32_32x32x16_bf16 v[48:63], v[92:95], v[188:191], v[48:63]
    s_setprio 0
    v_fmac_f32 v238, v10, v162
    v_fmac_f32 v242, v3, v147
    v_fmac_f32 v238, v11, v163
    v_fmac_f32 v242, v4, v148
    v_fmac_f32 v238, v12, v164
    v_fmac_f32 v242, v5, v149
    v_fmac_f32 v238, v13, v165
    v_fmac_f32 v242, v6, v150
    v_fmac_f32 v238, v14, v166
    v_fmac_f32 v242, v7, v151
    v_fmac_f32 v238, v15, v167
    v_fmac_f32 v236, v16, v112
    v_mul_f32 v244, v24, v160
    v_fmac_f32 v236, v17, v113
    v_fmac_f32 v244, v25, v161
    v_fmac_f32 v236, v18, v114
    v_fmac_f32 v244, v26, v162
    v_fmac_f32 v236, v19, v115
    v_fmac_f32 v244, v27, v163
    v_fmac_f32 v236, v20, v116
    v_fmac_f32 v244, v28, v164
    v_fmac_f32 v236, v21, v117
    v_fmac_f32 v244, v29, v165
    v_fmac_f32 v236, v22, v118
    v_fmac_f32 v244, v30, v166
    v_fmac_f32 v236, v23, v119
    v_fmac_f32 v244, v31, v167
    v_mul_f32 v243, v32, v152
    v_fma_f32 v239, v40, v168, -v239
    v_fmac_f32 v243, v33, v153
    v_fmac_f32 v239, v41, v169
    v_fmac_f32 v243, v34, v154
    v_fmac_f32 v239, v42, v170
    v_fmac_f32 v243, v35, v155
    v_fmac_f32 v239, v43, v171
    v_fmac_f32 v243, v36, v156
    v_fmac_f32 v239, v44, v172
    v_fmac_f32 v243, v37, v157
    v_fmac_f32 v239, v45, v173
    v_fmac_f32 v243, v38, v158
    v_fmac_f32 v239, v46, v174
    v_fmac_f32 v243, v39, v159
    v_fmac_f32 v239, v47, v175
    v_fmac_f32 v237, v48, v120
    v_mul_f32 v245, v56, v168
    v_fmac_f32 v237, v49, v121
    v_fmac_f32 v245, v57, v169
    v_fmac_f32 v237, v50, v122
    v_fmac_f32 v245, v58, v170
    v_fmac_f32 v237, v51, v123
    s_setprio 1
    s_waitcnt vmcnt(4) lgkmcnt(1)
    v_mfma_f32_32x32x16_bf16 v[0:15], v[64:67], v[176:179], 0
    ds_read_b64_tr_b16 v[184:185], v246 offset:2048
    ds_read_b64_tr_b16 v[186:187], v246 offset:2560
    ds_read_b64_tr_b16 v[188:189], v247 offset:2048
    ds_read_b64_tr_b16 v[190:191], v247 offset:2560
    v_fmac_f32 v245, v59, v171
    v_fmac_f32 v237, v52, v124
    s_mov_b32 m0, s68
    v_mfma_f32_32x32x16_bf16 v[16:31], v[68:71], v[176:179], 0
    buffer_load_dwordx4 v222, s[4:7], s44 offen lds
    buffer_load_dwordx4 v223, s[72:75], s44 offen offset:1024 lds
    s_waitcnt lgkmcnt(4)
    v_mad_u32_u16 v225, v224, s39, v248 op_sel:[1,0,0,0]
    v_mad_u32_u16 v224, v224, s39, v248
    v_fmac_f32 v245, v60, v172
    v_fmac_f32 v237, v53, v125
    v_mfma_f32_32x32x16_bf16 v[32:47], v[64:67], v[180:183], 0
    v_add_u32 v226, s50, v251
    ds_read_b32 v226, v226
    v_fmac_f32 v245, v61, v173
    v_fmac_f32 v237, v54, v126
    v_fmac_f32 v245, v62, v174
    v_fmac_f32 v237, v55, v127
    v_fmac_f32 v245, v63, v175
    v_mfma_f32_32x32x16_bf16 v[48:63], v[68:71], v[180:183], 0
    v_permlane32_swap_b32 v242, v234
    v_permlane32_swap_b32 v243, v235
    v_add_f32 v242, v242, v234
    v_add_f32 v243, v243, v235
    s_waitcnt vmcnt(4) lgkmcnt(1)
    v_mfma_f32_32x32x16_bf16 v[0:15], v[72:75], v[184:187], v[0:15]
    ds_read_b64_tr_b16 v[176:177], v246 offset:4096
    ds_read_b64_tr_b16 v[178:179], v246 offset:4608
    ds_read_b64_tr_b16 v[180:181], v247 offset:4096
    ds_read_b64_tr_b16 v[182:183], v247 offset:4608
    s_mov_b32 m0, s69
    v_mfma_f32_32x32x16_bf16 v[16:31], v[76:79], v[184:187], v[16:31]
    buffer_load_dwordx4 v224, s[4:7], s45 offen lds
    buffer_load_dwordx4 v225, s[72:75], s45 offen offset:1024 lds
    s_waitcnt lgkmcnt(4)
    v_mad_u32_u16 v227, v226, s39, v248 op_sel:[1,0,0,0]
    v_mad_u32_u16 v226, v226, s39, v248
    v_mfma_f32_32x32x16_bf16 v[32:47], v[72:75], v[188:191], v[32:47]
    v_add_u32 v228, s51, v251
    ds_read_b32 v228, v228
    s_set_gpr_idx_on s31, gpr_idx(DST)
    s_nop 0
    v_cvt_pk_bf16_f32 v194, v242, v243
    s_set_gpr_idx_off
    v_mfma_f32_32x32x16_bf16 v[48:63], v[76:79], v[188:191], v[48:63]
    s_waitcnt vmcnt(4) lgkmcnt(1)
    v_mfma_f32_32x32x16_bf16 v[0:15], v[80:83], v[176:179], v[0:15]
    ds_read_b64_tr_b16 v[184:185], v246 offset:6144
    ds_read_b64_tr_b16 v[186:187], v246 offset:6656
    ds_read_b64_tr_b16 v[188:189], v247 offset:6144
    ds_read_b64_tr_b16 v[190:191], v247 offset:6656
    s_mov_b32 s32, s31
    s_mov_b32 s31, s35
    s_mov_b32 m0, s70
    v_mfma_f32_32x32x16_bf16 v[16:31], v[84:87], v[176:179], v[16:31]
    buffer_load_dwordx4 v226, s[4:7], s46 offen lds
    buffer_load_dwordx4 v227, s[72:75], s46 offen offset:1024 lds
    s_waitcnt lgkmcnt(4)
    v_mad_u32_u16 v229, v228, s39, v248 op_sel:[1,0,0,0]
    v_mad_u32_u16 v228, v228, s39, v248
    s_sub_u32 s26, s48, s29
    s_mov_b32 s29, s48
    v_mfma_f32_32x32x16_bf16 v[32:47], v[80:83], v[180:183], v[32:47]
    s_mov_b32 s30, s3
    s_cmp_eq_u32 s34, 0
    s_cselect_b32 s56, s33, 0
    v_mfma_f32_32x32x16_bf16 v[48:63], v[84:87], v[180:183], v[48:63]
    s_waitcnt vmcnt(4) lgkmcnt(0)
    v_mfma_f32_32x32x16_bf16 v[0:15], v[88:91], v[184:187], v[0:15]
    ds_read_b64_tr_b16 v[176:177], v246 offset:0
    ds_read_b64_tr_b16 v[178:179], v246 offset:512
    ds_read_b64_tr_b16 v[180:181], v247 offset:0
    ds_read_b64_tr_b16 v[182:183], v247 offset:512
    s_mov_b32 m0, s71
    v_mfma_f32_32x32x16_bf16 v[16:31], v[92:95], v[184:187], v[16:31]
    buffer_load_dwordx4 v228, s[4:7], s47 offen lds
    buffer_load_dwordx4 v229, s[72:75], s47 offen offset:1024 lds
    v_mfma_f32_32x32x16_bf16 v[32:47], v[88:91], v[188:191], v[32:47]
    s_nop 2
    v_mul_f32 v242, v0, v144
    v_fma_f32 v240, v8, v160, -v240
    v_fmac_f32 v242, v1, v145
    v_fmac_f32 v240, v9, v161
    v_fmac_f32 v242, v2, v146
    v_fmac_f32 v240, v10, v162
    v_fmac_f32 v242, v3, v147
    v_mfma_f32_32x32x16_bf16 v[48:63], v[92:95], v[188:191], v[48:63]
    s_setprio 0
    v_fmac_f32 v240, v11, v163
    v_fmac_f32 v242, v4, v148
    v_fmac_f32 v240, v12, v164
    v_fmac_f32 v242, v5, v149
    v_fmac_f32 v240, v13, v165
    v_fmac_f32 v242, v6, v150
    v_fmac_f32 v240, v14, v166
    v_fmac_f32 v242, v7, v151
    v_fmac_f32 v240, v15, v167
    v_add_u32 v249, s26, v249
    v_add_u32 v250, s26, v250
    v_fma_f32 v244, v16, v160, -v244
    v_fmac_f32 v236, v24, v112
    v_fmac_f32 v244, v17, v161
    v_fmac_f32 v236, v25, v113
    v_fmac_f32 v244, v18, v162
    v_fmac_f32 v236, v26, v114
    v_fmac_f32 v244, v19, v163
    v_fmac_f32 v236, v27, v115
    v_fmac_f32 v244, v20, v164
    v_fmac_f32 v236, v28, v116
    v_fmac_f32 v244, v21, v165
    v_fmac_f32 v236, v29, v117
    v_fmac_f32 v244, v22, v166
    v_fmac_f32 v236, v30, v118
    v_fmac_f32 v244, v23, v167
    v_fmac_f32 v236, v31, v119
    ds_read_b64_tr_b16 v[0:1], v249 offset:0
    ds_read_b64_tr_b16 v[2:3], v249 offset:128
    ds_read_b128 v[4:7], v250 offset:0
    ds_read_b128 v[8:11], v250 offset:16
    ds_read_b128 v[12:15], v250 offset:384
    ds_read_b128 v[16:19], v250 offset:400
    v_mul_f32 v243, v32, v152
    v_fma_f32 v241, v40, v168, -v241
    v_fmac_f32 v243, v33, v153
    v_fmac_f32 v241, v41, v169
    v_fmac_f32 v243, v34, v154
    v_fmac_f32 v241, v42, v170
    v_fmac_f32 v243, v35, v155
    v_fmac_f32 v241, v43, v171
    v_fmac_f32 v243, v36, v156
    v_fmac_f32 v241, v44, v172
    v_fmac_f32 v243, v37, v157
    v_fmac_f32 v241, v45, v173
    v_fmac_f32 v243, v38, v158
    v_fmac_f32 v241, v46, v174
    v_fmac_f32 v243, v39, v159
    v_fmac_f32 v241, v47, v175
    ds_read_b64_tr_b16 v[20:21], v249 offset:512
    ds_read_b64_tr_b16 v[22:23], v249 offset:640
    ds_read_b128 v[24:27], v250 offset:64
    ds_read_b128 v[28:31], v250 offset:80
    ds_read_b128 v[32:35], v250 offset:448
    ds_read_b128 v[36:39], v250 offset:464
    v_fma_f32 v245, v48, v168, -v245
    v_fmac_f32 v237, v56, v120
    v_fmac_f32 v245, v49, v169
    v_fmac_f32 v237, v57, v121
    v_fmac_f32 v245, v50, v170
    v_fmac_f32 v237, v58, v122
    v_fmac_f32 v245, v51, v171
    v_fmac_f32 v237, v59, v123
    v_fmac_f32 v245, v52, v172
    v_fmac_f32 v237, v60, v124
    v_fmac_f32 v245, v53, v173
    v_fmac_f32 v237, v61, v125
    v_fmac_f32 v245, v54, v174
    v_fmac_f32 v237, v62, v126
    v_fmac_f32 v245, v55, v175
    v_fmac_f32 v237, v63, v127
    s_cmp_eq_u32 s56, 2
    s_cbranch_scc1 K2_U20
    s_cmp_eq_u32 s56, 3
    s_cbranch_scc1 K2_U30
    s_branch K2_DSP0
K2_U11:
    s_setprio 1
    v_mov_b32 v254, 163648
    v_mov_b32 v255, 1
    v_lshl_add_u32 v233, v252, 1, s53
    s_mov_b64 exec, 1
    ds_add_rtn_u32 v232, v254, v255
    s_mov_b64 exec, -1
    ds_read_b32 v233, v233
    s_waitcnt lgkmcnt(8)
    v_lshlrev_b32 v40, 16, v0
    v_and_b32 v41, 0xffff0000, v0
    v_lshlrev_b32 v42, 16, v1
    v_and_b32 v43, 0xffff0000, v1
    v_lshlrev_b32 v44, 16, v2
    v_and_b32 v45, 0xffff0000, v2
    v_lshlrev_b32 v46, 16, v3
    v_and_b32 v47, 0xffff0000, v3
    v_mul_f32 v4, v40, v4
    v_mul_f32 v5, v41, v5
    v_mul_f32 v6, v42, v6
    v_mul_f32 v7, v43, v7
    v_mul_f32 v8, v44, v8
    v_mul_f32 v9, v45, v9
    v_mul_f32 v10, v46, v10
    v_mul_f32 v11, v47, v11
    v_cvt_pk_bf16_f32 v64, v4, v5
    v_cvt_pk_bf16_f32 v65, v6, v7
    v_cvt_pk_bf16_f32 v66, v8, v9
    v_cvt_pk_bf16_f32 v67, v10, v11
    v_mul_f32 v12, v40, v12
    v_mul_f32 v13, v41, v13
    v_mul_f32 v14, v42, v14
    v_mul_f32 v15, v43, v15
    v_mul_f32 v16, v44, v16
    v_mul_f32 v17, v45, v17
    v_mul_f32 v18, v46, v18
    v_mul_f32 v19, v47, v19
    v_cvt_pk_bf16_f32 v68, v12, v13
    v_cvt_pk_bf16_f32 v69, v14, v15
    v_cvt_pk_bf16_f32 v70, v16, v17
    v_cvt_pk_bf16_f32 v71, v18, v19
    s_waitcnt lgkmcnt(0)
    v_readfirstlane_b32 s58, v232
    s_nop 0
    s_cmp_lt_u32 s58, s22
    s_cbranch_scc0 K2_nul_84
    s_and_b32 s59, s58, 7
    s_lshr_b32 s60, s58, 3
K2_chk_86:
    v_readlane_b32 s61, v233, s59
    s_nop 0
    s_cmp_gt_u32 s61, s60
    s_cbranch_scc0 K2_spin_85
K2_back_87:
    v_readlane_b32 s3, v253, s58
    s_lshl_b32 s44, s34, 7
    s_lshl_b32 s60, s58, 5
    s_and_b32 s48, s3, 0x3ffff
    s_bfe_u32 s33, s3, 0x30012
    s_sub_u32 s60, s60, s48
    s_and_b32 s60, s60, 0xff
    s_add_u32 s35, s60, s48
    s_mov_b32 s45, s44
    s_add_u32 s47, s44, 256
    s_add_u32 s49, s48, 32
    s_add_u32 s60, s48, 64
    s_cmp_eq_u32 s33, 3
    s_cselect_b32 s46, s44, s47
    s_cselect_b32 s50, s60, s48
    s_cselect_b32 s51, s48, s49
    s_sub_u32 s60, s33, 2
    s_cmp_lt_u32 s60, 2
    s_cbranch_scc0 K2_rare_88
K2_back_89:
    v_add_u32 v222, s48, v251
    ds_read_b32 v222, v222
    v_add_u32 v224, s49, v251
    ds_read_b32 v224, v224
    v_add_u32 v226, s50, v251
    ds_read_b32 v226, v226
    v_add_u32 v228, s51, v251
    ds_read_b32 v228, v228
    s_waitcnt lgkmcnt(3)
    v_mad_u32_u16 v223, v222, s39, v248 op_sel:[1,0,0,0]
    v_mad_u32_u16 v222, v222, s39, v248
    s_waitcnt lgkmcnt(2)
    v_mad_u32_u16 v225, v224, s39, v248 op_sel:[1,0,0,0]
    v_mad_u32_u16 v224, v224, s39, v248
    s_waitcnt lgkmcnt(1)
    v_mad_u32_u16 v227, v226, s39, v248 op_sel:[1,0,0,0]
    v_mad_u32_u16 v226, v226, s39, v248
    s_waitcnt lgkmcnt(0)
    v_mad_u32_u16 v229, v228, s39, v248 op_sel:[1,0,0,0]
    v_mad_u32_u16 v228, v228, s39, v248
    s_waitcnt vmcnt(4)
    v_mfma_f32_32x32x16_bf16 v[0:15], v[64:67], v[176:179], 0
    ds_read_b64_tr_b16 v[184:185], v246 offset:2048
    ds_read_b64_tr_b16 v[186:187], v246 offset:2560
    ds_read_b64_tr_b16 v[188:189], v247 offset:2048
    ds_read_b64_tr_b16 v[190:191], v247 offset:2560
    s_mov_b32 m0, s68
    v_mfma_f32_32x32x16_bf16 v[16:31], v[68:71], v[176:179], 0
    buffer_load_dwordx4 v222, s[4:7], s44 offen lds
    buffer_load_dwordx4 v223, s[72:75], s44 offen offset:1024 lds
    v_permlane32_swap_b32 v242, v236
    v_permlane32_swap_b32 v243, v237
    v_mfma_f32_32x32x16_bf16 v[32:47], v[64:67], v[180:183], 0
    v_permlane32_swap_b32 v244, v238
    v_permlane32_swap_b32 v245, v239
    v_permlane32_swap_b32 v240, v241
    v_add_f32 v242, v242, v236
    v_mfma_f32_32x32x16_bf16 v[48:63], v[68:71], v[180:183], 0
    s_setprio 0
    v_add_f32 v243, v243, v237
    v_add_f32 v244, v244, v238
    v_add_f32 v245, v245, v239
    v_add_f32 v240, -v240, -v241
    v_sub_u32 v241, v230, v231
    v_cvt_pk_bf16_f32 v242, v242, v243
    v_cvt_pk_bf16_f32 v244, v244, v245
    v_cvt_pk_bf16_f32 v240, v240, v240
    ds_write_b32 v230, v242 offset:768
    ds_write_b32 v230, v244 offset:1024
    ds_write_b16 v241, v240 offset:1280
    v_mul_f32 v234, v0, v96
    v_mul_f32 v236, v8, v128
    v_fmac_f32 v234, v1, v97
    v_fmac_f32 v236, v9, v129
    v_fmac_f32 v234, v2, v98
    v_fmac_f32 v236, v10, v130
    v_fmac_f32 v234, v3, v99
    v_fmac_f32 v236, v11, v131
    v_fmac_f32 v234, v4, v100
    v_fmac_f32 v236, v12, v132
    v_fmac_f32 v234, v5, v101
    v_fmac_f32 v236, v13, v133
    v_fmac_f32 v234, v6, v102
    v_fmac_f32 v236, v14, v134
    v_fmac_f32 v234, v7, v103
    v_fmac_f32 v236, v15, v135
    v_mul_f32 v238, v16, v128
    v_mul_f32 v240, v24, v128
    v_fmac_f32 v238, v17, v129
    v_fmac_f32 v240, v25, v129
    v_fmac_f32 v238, v18, v130
    v_fmac_f32 v240, v26, v130
    v_fmac_f32 v238, v19, v131
    v_fmac_f32 v240, v27, v131
    v_fmac_f32 v238, v20, v132
    v_fmac_f32 v240, v28, v132
    v_fmac_f32 v238, v21, v133
    v_fmac_f32 v240, v29, v133
    v_fmac_f32 v238, v22, v134
    v_fmac_f32 v240, v30, v134
    v_fmac_f32 v238, v23, v135
    v_fmac_f32 v240, v31, v135
    v_mul_f32 v235, v32, v104
    v_mul_f32 v237, v40, v136
    v_fmac_f32 v235, v33, v105
    v_fmac_f32 v237, v41, v137
    v_fmac_f32 v235, v34, v106
    v_fmac_f32 v237, v42, v138
    v_fmac_f32 v235, v35, v107
    v_fmac_f32 v237, v43, v139
    v_fmac_f32 v235, v36, v108
    v_fmac_f32 v237, v44, v140
    v_fmac_f32 v235, v37, v109
    v_fmac_f32 v237, v45, v141
    v_fmac_f32 v235, v38, v110
    v_fmac_f32 v237, v46, v142
    v_fmac_f32 v235, v39, v111
    v_fmac_f32 v237, v47, v143
    v_mul_f32 v239, v48, v136
    v_mul_f32 v241, v56, v136
    v_fmac_f32 v239, v49, v137
    v_fmac_f32 v241, v57, v137
    v_fmac_f32 v239, v50, v138
    v_fmac_f32 v241, v58, v138
    v_fmac_f32 v239, v51, v139
    v_fmac_f32 v241, v59, v139
    v_fmac_f32 v239, v52, v140
    v_fmac_f32 v241, v60, v140
    v_fmac_f32 v239, v53, v141
    v_fmac_f32 v241, v61, v141
    v_fmac_f32 v239, v54, v142
    v_fmac_f32 v241, v62, v142
    v_fmac_f32 v239, v55, v143
    v_fmac_f32 v241, v63, v143
    s_setprio 1
    s_waitcnt vmcnt(4) lgkmcnt(3)
    v_mfma_f32_32x32x16_bf16 v[0:15], v[64:67], v[184:187], 0
    ds_read_b64_tr_b16 v[176:177], v246 offset:4096
    ds_read_b64_tr_b16 v[178:179], v246 offset:4608
    ds_read_b64_tr_b16 v[180:181], v247 offset:4096
    ds_read_b64_tr_b16 v[182:183], v247 offset:4608
    s_mov_b32 m0, s69
    v_mfma_f32_32x32x16_bf16 v[16:31], v[68:71], v[184:187], 0
    buffer_load_dwordx4 v224, s[4:7], s45 offen lds
    buffer_load_dwordx4 v225, s[72:75], s45 offen offset:1024 lds
    v_permlane32_swap_b32 v234, v236
    v_permlane32_swap_b32 v235, v237
    v_mfma_f32_32x32x16_bf16 v[32:47], v[64:67], v[188:191], 0
    v_permlane32_swap_b32 v240, v238
    v_permlane32_swap_b32 v241, v239
    v_lshl_add_u32 v230, v252, 1, s31
    v_add_f32 v234, v234, v236
    v_add_f32 v235, v235, v237
    v_mfma_f32_32x32x16_bf16 v[48:63], v[68:71], v[188:191], 0
    s_setprio 0
    v_add_f32 v240, v240, v238
    v_add_f32 v241, v241, v239
    v_cvt_pk_bf16_f32 v234, v234, v235
    v_cvt_pk_bf16_f32 v240, v240, v241
    ds_write_b32 v230, v234 offset:0
    ds_write_b32 v230, v240 offset:256
    v_mul_f32 v234, v0, v144
    v_mul_f32 v236, v8, v112
    v_fmac_f32 v234, v1, v145
    v_fmac_f32 v236, v9, v113
    v_fmac_f32 v234, v2, v146
    v_fmac_f32 v236, v10, v114
    v_fmac_f32 v234, v3, v147
    v_fmac_f32 v236, v11, v115
    v_fmac_f32 v234, v4, v148
    v_fmac_f32 v236, v12, v116
    v_fmac_f32 v234, v5, v149
    v_fmac_f32 v236, v13, v117
    v_fmac_f32 v234, v6, v150
    v_fmac_f32 v236, v14, v118
    v_fmac_f32 v234, v7, v151
    v_fmac_f32 v236, v15, v119
    v_mul_f32 v238, v16, v160
    v_mul_f32 v240, v24, v160
    v_fmac_f32 v238, v17, v161
    v_fmac_f32 v240, v25, v161
    v_fmac_f32 v238, v18, v162
    v_fmac_f32 v240, v26, v162
    v_fmac_f32 v238, v19, v163
    v_fmac_f32 v240, v27, v163
    v_fmac_f32 v238, v20, v164
    v_fmac_f32 v240, v28, v164
    v_fmac_f32 v238, v21, v165
    v_fmac_f32 v240, v29, v165
    v_fmac_f32 v238, v22, v166
    v_fmac_f32 v240, v30, v166
    v_fmac_f32 v238, v23, v167
    v_fmac_f32 v240, v31, v167
    v_mul_f32 v235, v32, v152
    v_mul_f32 v237, v40, v120
    v_fmac_f32 v235, v33, v153
    v_fmac_f32 v237, v41, v121
    v_fmac_f32 v235, v34, v154
    v_fmac_f32 v237, v42, v122
    v_fmac_f32 v235, v35, v155
    v_fmac_f32 v237, v43, v123
    v_fmac_f32 v235, v36, v156
    v_fmac_f32 v237, v44, v124
    v_fmac_f32 v235, v37, v157
    v_fmac_f32 v237, v45, v125
    v_fmac_f32 v235, v38, v158
    v_fmac_f32 v237, v46, v126
    v_fmac_f32 v235, v39, v159
    v_fmac_f32 v237, v47, v127
    v_mul_f32 v239, v48, v168
    v_mul_f32 v241, v56, v168
    v_fmac_f32 v239, v49, v169
    v_fmac_f32 v241, v57, v169
    v_fmac_f32 v239, v50, v170
    v_fmac_f32 v241, v58, v170
    v_fmac_f32 v239, v51, v171
    v_fmac_f32 v241, v59, v171
    v_fmac_f32 v239, v52, v172
    v_fmac_f32 v241, v60, v172
    v_fmac_f32 v239, v53, v173
    v_fmac_f32 v241, v61, v173
    v_fmac_f32 v239, v54, v174
    v_fmac_f32 v241, v62, v174
    v_fmac_f32 v239, v55, v175
    v_fmac_f32 v241, v63, v175
    s_setprio 1
    s_waitcnt vmcnt(4) lgkmcnt(2)
    v_mfma_f32_32x32x16_bf16 v[0:15], v[64:67], v[176:179], 0
    ds_read_b64_tr_b16 v[184:185], v246 offset:6144
    ds_read_b64_tr_b16 v[186:187], v246 offset:6656
    ds_read_b64_tr_b16 v[188:189], v247 offset:6144
    ds_read_b64_tr_b16 v[190:191], v247 offset:6656
    s_mov_b32 s32, s31
    s_mov_b32 s31, s35
    s_mov_b32 m0, s70
    v_mfma_f32_32x32x16_bf16 v[16:31], v[68:71], v[176:179], 0
    buffer_load_dwordx4 v226, s[4:7], s46 offen lds
    buffer_load_dwordx4 v227, s[72:75], s46 offen offset:1024 lds
    s_sub_u32 s26, s48, s29
    s_mov_b32 s29, s48
    s_mov_b32 s30, s3
    s_cmp_lg_u32 s36, 0
    s_cselect_b32 s56, s33, 0
    v_mfma_f32_32x32x16_bf16 v[32:47], v[64:67], v[180:183], 0
    v_mfma_f32_32x32x16_bf16 v[48:63], v[68:71], v[180:183], 0
    s_setprio 0
    v_mul_f32 v242, v0, v144
    v_fma_f32 v238, v8, v160, -v238
    v_fmac_f32 v242, v1, v145
    v_fmac_f32 v238, v9, v161
    v_fmac_f32 v242, v2, v146
    v_fmac_f32 v238, v10, v162
    v_fmac_f32 v242, v3, v147
    v_fmac_f32 v238, v11, v163
    v_fmac_f32 v242, v4, v148
    v_fmac_f32 v238, v12, v164
    v_fmac_f32 v242, v5, v149
    v_fmac_f32 v238, v13, v165
    v_fmac_f32 v242, v6, v150
    v_fmac_f32 v238, v14, v166
    v_fmac_f32 v242, v7, v151
    v_fmac_f32 v238, v15, v167
    v_fmac_f32 v236, v16, v112
    v_mul_f32 v244, v24, v160
    v_fmac_f32 v236, v17, v113
    v_fmac_f32 v244, v25, v161
    v_fmac_f32 v236, v18, v114
    v_fmac_f32 v244, v26, v162
    v_fmac_f32 v236, v19, v115
    v_fmac_f32 v244, v27, v163
    v_fmac_f32 v236, v20, v116
    v_fmac_f32 v244, v28, v164
    v_fmac_f32 v236, v21, v117
    v_fmac_f32 v244, v29, v165
    v_fmac_f32 v236, v22, v118
    v_fmac_f32 v244, v30, v166
    v_fmac_f32 v236, v23, v119
    v_fmac_f32 v244, v31, v167
    v_mul_f32 v243, v32, v152
    v_fma_f32 v239, v40, v168, -v239
    v_fmac_f32 v243, v33, v153
    v_fmac_f32 v239, v41, v169
    v_fmac_f32 v243, v34, v154
    v_fmac_f32 v239, v42, v170
    v_fmac_f32 v243, v35, v155
    v_fmac_f32 v239, v43, v171
    v_fmac_f32 v243, v36, v156
    v_fmac_f32 v239, v44, v172
    v_fmac_f32 v243, v37, v157
    v_fmac_f32 v239, v45, v173
    v_fmac_f32 v243, v38, v158
    v_fmac_f32 v239, v46, v174
    v_fmac_f32 v243, v39, v159
    v_fmac_f32 v239, v47, v175
    v_fmac_f32 v237, v48, v120
    v_mul_f32 v245, v56, v168
    v_fmac_f32 v237, v49, v121
    v_fmac_f32 v245, v57, v169
    v_fmac_f32 v237, v50, v122
    v_fmac_f32 v245, v58, v170
    v_fmac_f32 v237, v51, v123
    v_fmac_f32 v245, v59, v171
    v_fmac_f32 v237, v52, v124
    v_fmac_f32 v245, v60, v172
    v_fmac_f32 v237, v53, v125
    v_fmac_f32 v245, v61, v173
    v_fmac_f32 v237, v54, v126
    v_fmac_f32 v245, v62, v174
    v_fmac_f32 v237, v55, v127
    v_fmac_f32 v245, v63, v175
    s_setprio 1
    s_waitcnt vmcnt(4) lgkmcnt(0)
    v_mfma_f32_32x32x16_bf16 v[0:15], v[64:67], v[184:187], 0
    ds_read_b64_tr_b16 v[176:177], v246 offset:0
    ds_read_b64_tr_b16 v[178:179], v246 offset:512
    ds_read_b64_tr_b16 v[180:181], v247 offset:0
    ds_read_b64_tr_b16 v[182:183], v247 offset:512
    s_mov_b32 m0, s71
    v_mfma_f32_32x32x16_bf16 v[16:31], v[68:71], v[184:187], 0
    buffer_load_dwordx4 v228, s[4:7], s47 offen lds
    buffer_load_dwordx4 v229, s[72:75], s47 offen offset:1024 lds
    v_permlane32_swap_b32 v242, v234
    v_permlane32_swap_b32 v243, v235
    v_add_f32 v242, v242, v234
    v_mfma_f32_32x32x16_bf16 v[32:47], v[64:67], v[188:191], 0
    v_add_f32 v243, v243, v235
    v_cvt_pk_bf16_f32 v242, v242, v243
    ds_write_b32 v230, v242 offset:512
    v_mfma_f32_32x32x16_bf16 v[48:63], v[68:71], v[188:191], 0
    s_setprio 0
    v_mul_f32 v242, v0, v144
    v_fma_f32 v240, v8, v160, -v240
    v_fmac_f32 v242, v1, v145
    v_fmac_f32 v240, v9, v161
    v_fmac_f32 v242, v2, v146
    v_fmac_f32 v240, v10, v162
    v_fmac_f32 v242, v3, v147
    v_fmac_f32 v240, v11, v163
    v_fmac_f32 v242, v4, v148
    v_fmac_f32 v240, v12, v164
    v_fmac_f32 v242, v5, v149
    v_fmac_f32 v240, v13, v165
    v_fmac_f32 v242, v6, v150
    v_fmac_f32 v240, v14, v166
    v_fmac_f32 v242, v7, v151
    v_fmac_f32 v240, v15, v167
    v_add_u32 v249, s26, v249
    v_add_u32 v250, s26, v250
    v_fma_f32 v244, v16, v160, -v244
    v_fmac_f32 v236, v24, v112
    v_fmac_f32 v244, v17, v161
    v_fmac_f32 v236, v25, v113
    v_fmac_f32 v244, v18, v162
    v_fmac_f32 v236, v26, v114
    v_fmac_f32 v244, v19, v163
    v_fmac_f32 v236, v27, v115
    v_fmac_f32 v244, v20, v164
    v_fmac_f32 v236, v28, v116
    v_fmac_f32 v244, v21, v165
    v_fmac_f32 v236, v29, v117
    v_fmac_f32 v244, v22, v166
    v_fmac_f32 v236, v30, v118
    v_fmac_f32 v244, v23, v167
    v_fmac_f32 v236, v31, v119
    ds_read_b64_tr_b16 v[0:1], v249 offset:0
    ds_read_b64_tr_b16 v[2:3], v249 offset:128
    ds_read_b128 v[4:7], v250 offset:0
    ds_read_b128 v[8:11], v250 offset:16
    ds_read_b128 v[12:15], v250 offset:384
    ds_read_b128 v[16:19], v250 offset:400
    v_mul_f32 v243, v32, v152
    v_fma_f32 v241, v40, v168, -v241
    v_fmac_f32 v243, v33, v153
    v_fmac_f32 v241, v41, v169
    v_fmac_f32 v243, v34, v154
    v_fmac_f32 v241, v42, v170
    v_fmac_f32 v243, v35, v155
    v_fmac_f32 v241, v43, v171
    v_fmac_f32 v243, v36, v156
    v_fmac_f32 v241, v44, v172
    v_fmac_f32 v243, v37, v157
    v_fmac_f32 v241, v45, v173
    v_fmac_f32 v243, v38, v158
    v_fmac_f32 v241, v46, v174
    v_fmac_f32 v243, v39, v159
    v_fmac_f32 v241, v47, v175
    ds_read_b64_tr_b16 v[20:21], v249 offset:512
    ds_read_b64_tr_b16 v[22:23], v249 offset:640
    ds_read_b128 v[24:27], v250 offset:64
    ds_read_b128 v[28:31], v250 offset:80
    ds_read_b128 v[32:35], v250 offset:448
    ds_read_b128 v[36:39], v250 offset:464
    v_fma_f32 v245, v48, v168, -v245
    v_fmac_f32 v237, v56, v120
    v_fmac_f32 v245, v49, v169
    v_fmac_f32 v237, v57, v121
    v_fmac_f32 v245, v50, v170
    v_fmac_f32 v237, v58, v122
    v_fmac_f32 v245, v51, v171
    v_fmac_f32 v237, v59, v123
    v_fmac_f32 v245, v52, v172
    v_fmac_f32 v237, v60, v124
    v_fmac_f32 v245, v53, v173
    v_fmac_f32 v237, v61, v125
    v_fmac_f32 v245, v54, v174
    v_fmac_f32 v237, v62, v126
    v_fmac_f32 v245, v55, v175
    v_fmac_f32 v237, v63, v127
    s_cmp_eq_u32 s56, 2
    s_cbranch_scc1 K2_U21
    s_cmp_eq_u32 s56, 3
    s_cbranch_scc1 K2_U31
    s_branch K2_DSP1
K2_U41:
    s_setprio 1
    s_waitcnt lgkmcnt(6)
    v_lshlrev_b32 v40, 16, v0
    v_and_b32 v41, 0xffff0000, v0
    v_lshlrev_b32 v42, 16, v1
    v_and_b32 v43, 0xffff0000, v1
    v_lshlrev_b32 v44, 16, v2
    v_and_b32 v45, 0xffff0000, v2
    v_lshlrev_b32 v46, 16, v3
    v_and_b32 v47, 0xffff0000, v3
    v_mul_f32 v4, v40, v4
    v_mul_f32 v5, v41, v5
    v_mul_f32 v6, v42, v6
    v_mul_f32 v7, v43, v7
    v_mul_f32 v8, v44, v8
    v_mul_f32 v9, v45, v9
    v_mul_f32 v10, v46, v10
    v_mul_f32 v11, v47, v11
    v_cvt_pk_bf16_f32 v64, v4, v5
    v_cvt_pk_bf16_f32 v65, v6, v7
    v_cvt_pk_bf16_f32 v66, v8, v9
    v_cvt_pk_bf16_f32 v67, v10, v11
    v_mul_f32 v12, v40, v12
    v_mul_f32 v13, v41, v13
    v_mul_f32 v14, v42, v14
    v_mul_f32 v15, v43, v15
    v_mul_f32 v16, v44, v16
    v_mul_f32 v17, v45, v17
    v_mul_f32 v18, v46, v18
    v_mul_f32 v19, v47, v19
    v_cvt_pk_bf16_f32 v68, v12, v13
    v_cvt_pk_bf16_f32 v69, v14, v15
    v_cvt_pk_bf16_f32 v70, v16, v17
    v_cvt_pk_bf16_f32 v71, v18, v19
    ds_read_b64_tr_b16 v[0:1], v249 offset:1024
    ds_read_b64_tr_b16 v[2:3], v249 offset:1152
    ds_read_b128 v[4:7], v250 offset:128
    ds_read_b128 v[8:11], v250 offset:144
    ds_read_b128 v[12:15], v250 offset:512
    ds_read_b128 v[16:19], v250 offset:528
    s_waitcnt lgkmcnt(6)
    v_lshlrev_b32 v48, 16, v20
    v_and_b32 v49, 0xffff0000, v20
    v_lshlrev_b32 v50, 16, v21
    v_and_b32 v51, 0xffff0000, v21
    v_lshlrev_b32 v52, 16, v22
    v_and_b32 v53, 0xffff0000, v22
    v_lshlrev_b32 v54, 16, v23
    v_and_b32 v55, 0xffff0000, v23
    v_mul_f32 v24, v48, v24
    v_mul_f32 v25, v49, v25
    v_mul_f32 v26, v50, v26
    v_mul_f32 v27, v51, v27
    v_mul_f32 v28, v52, v28
    v_mul_f32 v29, v53, v29
    v_mul_f32 v30, v54, v30
    v_mul_f32 v31, v55, v31
    v_cvt_pk_bf16_f32 v72, v24, v25
    v_cvt_pk_bf16_f32 v73, v26, v27
    v_cvt_pk_bf16_f32 v74, v28, v29
    v_cvt_pk_bf16_f32 v75, v30, v31
    v_mul_f32 v32, v48, v32
    v_mul_f32 v33, v49, v33
    v_mul_f32 v34, v50, v34
    v_mul_f32 v35, v51, v35
    v_mul_f32 v36, v52, v36
    v_mul_f32 v37, v53, v37
    v_mul_f32 v38, v54, v38
    v_mul_f32 v39, v55, v39
    v_cvt_pk_bf16_f32 v76, v32, v33
    v_cvt_pk_bf16_f32 v77, v34, v35
    v_cvt_pk_bf16_f32 v78, v36, v37
    v_cvt_pk_bf16_f32 v79, v38, v39
    s_lshr_b32 s65, s30, 27
    s_mov_b32 s66, 161536
    s_cmp_ge_u32 s65, 2
    s_cselect_b32 s66, 158112, s66
    s_mul_i32 s65, s65, 512
    s_add_u32 s65, s65, s66
    s_sub_u32 s65, s65, s29
    v_add_u32 v56, s65, v249
    s_lshr_b32 s65, s30, 27
    s_mov_b32 s66, 161536
    s_cmp_ge_u32 s65, 2
    s_cselect_b32 s66, 159008, s66
    s_mul_i32 s65, s65, 64
    s_add_u32 s65, s65, s66
    s_sub_u32 s65, s65, s29
    v_add_u32 v57, s65, v250
    ds_read_b64_tr_b16 v[20:21], v56 offset:0
    ds_read_b64_tr_b16 v[22:23], v56 offset:128
    ds_read_b128 v[24:27], v57 offset:0
    ds_read_b128 v[28:31], v57 offset:16
    ds_read_b128 v[32:35], v57 offset:384
    ds_read_b128 v[36:39], v57 offset:400
    s_waitcnt lgkmcnt(10)
    v_lshlrev_b32 v40, 16, v0
    v_and_b32 v41, 0xffff0000, v0
    v_lshlrev_b32 v42, 16, v1
    v_and_b32 v43, 0xffff0000, v1
    v_lshlrev_b32 v44, 16, v2
    v_and_b32 v45, 0xffff0000, v2
    v_lshlrev_b32 v46, 16, v3
    v_and_b32 v47, 0xffff0000, v3
    s_waitcnt lgkmcnt(8)
    v_mul_f32 v4, v40, v4
    v_mul_f32 v5, v41, v5
    v_mul_f32 v6, v42, v6
    v_mul_f32 v7, v43, v7
    v_mul_f32 v8, v44, v8
    v_mul_f32 v9, v45, v9
    v_mul_f32 v10, v46, v10
    v_mul_f32 v11, v47, v11
    v_cvt_pk_bf16_f32 v80, v4, v5
    v_cvt_pk_bf16_f32 v81, v6, v7
    v_cvt_pk_bf16_f32 v82, v8, v9
    v_cvt_pk_bf16_f32 v83, v10, v11
    s_waitcnt lgkmcnt(6)
    v_mul_f32 v12, v40, v12
    v_mul_f32 v13, v41, v13
    v_mul_f32 v14, v42, v14
    v_mul_f32 v15, v43, v15
    v_mul_f32 v16, v44, v16
    v_mul_f32 v17, v45, v17
    v_mul_f32 v18, v46, v18
    v_mul_f32 v19, v47, v19
    v_cvt_pk_bf16_f32 v84, v12, v13
    v_cvt_pk_bf16_f32 v85, v14, v15
    v_cvt_pk_bf16_f32 v86, v16, v17
    v_cvt_pk_bf16_f32 v87, v18, v19
    s_waitcnt lgkmcnt(4)
    v_lshlrev_b32 v48, 16, v20
    v_and_b32 v49, 0xffff0000, v20
    v_lshlrev_b32 v50, 16, v21
    v_and_b32 v51, 0xffff0000, v21
    v_lshlrev_b32 v52, 16, v22
    v_and_b32 v53, 0xffff0000, v22
    v_lshlrev_b32 v54, 16, v23
    v_and_b32 v55, 0xffff0000, v23
    s_waitcnt lgkmcnt(2)
    v_mul_f32 v24, v48, v24
    v_mul_f32 v25, v49, v25
    v_mul_f32 v26, v50, v26
    v_mul_f32 v27, v51, v27
    v_mul_f32 v28, v52, v28
    v_mul_f32 v29, v53, v29
    v_mul_f32 v30, v54, v30
    v_mul_f32 v31, v55, v31
    v_cvt_pk_bf16_f32 v88, v24, v25
    v_cvt_pk_bf16_f32 v89, v26, v27
    v_cvt_pk_bf16_f32 v90, v28, v29
    v_cvt_pk_bf16_f32 v91, v30, v31
    s_waitcnt lgkmcnt(0)
    v_mul_f32 v32, v48, v32
    v_mul_f32 v33, v49, v33
    v_mul_f32 v34, v50, v34
    v_mul_f32 v35, v51, v35
    v_mul_f32 v36, v52, v36
    v_mul_f32 v37, v53, v37
    v_mul_f32 v38, v54, v38
    v_mul_f32 v39, v55, v39
    v_cvt_pk_bf16_f32 v92, v32, v33
    v_cvt_pk_bf16_f32 v93, v34, v35
    v_cvt_pk_bf16_f32 v94, v36, v37
    v_cvt_pk_bf16_f32 v95, v38, v39
    s_waitcnt vmcnt(4)
    v_mfma_f32_32x32x16_bf16 v[0:15], v[64:67], v[176:179], 0
    ds_read_b64_tr_b16 v[184:185], v246 offset:2048
    ds_read_b64_tr_b16 v[186:187], v246 offset:2560
    ds_read_b64_tr_b16 v[188:189], v247 offset:2048
    ds_read_b64_tr_b16 v[190:191], v247 offset:2560
    s_mov_b32 m0, s68
    v_mfma_f32_32x32x16_bf16 v[16:31], v[68:71], v[176:179], 0
    buffer_load_dwordx4 v222, s[4:7], s41 offen lds
    buffer_load_dwordx4 v223, s[72:75], s41 offen offset:1024 lds
    v_permlane32_swap_b32 v242, v236
    v_permlane32_swap_b32 v243, v237
    v_mov_b32 v254, 163648
    v_mfma_f32_32x32x16_bf16 v[32:47], v[64:67], v[180:183], 0
    v_permlane32_swap_b32 v244, v238
    v_permlane32_swap_b32 v245, v239
    v_permlane32_swap_b32 v240, v241
    v_add_f32 v242, v242, v236
    v_mfma_f32_32x32x16_bf16 v[48:63], v[68:71], v[180:183], 0
    v_add_f32 v243, v243, v237
    v_add_f32 v244, v244, v238
    v_add_f32 v245, v245, v239
    v_add_f32 v240, -v240, -v241
    v_sub_u32 v241, v230, v231
    v_cvt_pk_bf16_f32 v242, v242, v243
    v_mov_b32 v255, 1
    v_lshl_add_u32 v233, v252, 1, s53
    s_mov_b64 exec, 1
    ds_add_rtn_u32 v232, v254, v255
    s_mov_b64 exec, -1
    ds_read_b32 v233, v233
    s_waitcnt vmcnt(4) lgkmcnt(2)
    v_mfma_f32_32x32x16_bf16 v[0:15], v[72:75], v[184:187], v[0:15]
    ds_read_b64_tr_b16 v[176:177], v246 offset:4096
    ds_read_b64_tr_b16 v[178:179], v246 offset:4608
    ds_read_b64_tr_b16 v[180:181], v247 offset:4096
    ds_read_b64_tr_b16 v[182:183], v247 offset:4608
    v_cvt_pk_bf16_f32 v244, v244, v245
    v_cvt_pk_bf16_f32 v240, v240, v240
    s_mov_b32 m0, s69
    v_mfma_f32_32x32x16_bf16 v[16:31], v[76:79], v[184:187], v[16:31]
    buffer_load_dwordx4 v224, s[4:7], s41 offen lds
    buffer_load_dwordx4 v225, s[72:75], s41 offen offset:1024 lds
    ds_write_b32 v230, v242 offset:768
    ds_write_b32 v230, v244 offset:1024
    ds_write_b16 v241, v240 offset:1280
    s_waitcnt lgkmcnt(7)
    v_readfirstlane_b32 s58, v232
    v_mfma_f32_32x32x16_bf16 v[32:47], v[72:75], v[188:191], v[32:47]
    s_cmp_lt_u32 s58, s22
    s_cbranch_scc0 K2_nul_91
    s_and_b32 s59, s58, 7
    s_lshr_b32 s60, s58, 3
K2_chk_93:
    v_readlane_b32 s61, v233, s59
    s_nop 0
    s_cmp_gt_u32 s61, s60
    s_cbranch_scc0 K2_spin_92
K2_back_94:
    v_mfma_f32_32x32x16_bf16 v[48:63], v[76:79], v[188:191], v[48:63]
    v_readlane_b32 s3, v253, s58
    s_lshl_b32 s44, s34, 7
    s_lshl_b32 s60, s58, 5
    s_and_b32 s48, s3, 0x3ffff
    s_bfe_u32 s33, s3, 0x30012
    s_sub_u32 s60, s60, s48
    s_waitcnt vmcnt(4) lgkmcnt(3)
    v_mfma_f32_32x32x16_bf16 v[0:15], v[80:83], v[176:179], v[0:15]
    ds_read_b64_tr_b16 v[184:185], v246 offset:6144
    ds_read_b64_tr_b16 v[186:187], v246 offset:6656
    ds_read_b64_tr_b16 v[188:189], v247 offset:6144
    ds_read_b64_tr_b16 v[190:191], v247 offset:6656
    s_and_b32 s60, s60, 0xff
    s_add_u32 s35, s60, s48
    s_mov_b32 m0, s70
    v_mfma_f32_32x32x16_bf16 v[16:31], v[84:87], v[176:179], v[16:31]
    buffer_load_dwordx4 v226, s[4:7], s41 offen lds
    buffer_load_dwordx4 v227, s[72:75], s41 offen offset:1024 lds
    s_mov_b32 s45, s44
    s_add_u32 s47, s44, 256
    s_add_u32 s49, s48, 32
    s_add_u32 s60, s48, 64
    v_mfma_f32_32x32x16_bf16 v[32:47], v[80:83], v[180:183], v[32:47]
    s_cmp_eq_u32 s33, 3
    s_cselect_b32 s46, s44, s47
    s_cselect_b32 s50, s60, s48
    s_cselect_b32 s51, s48, s49
    s_sub_u32 s60, s33, 2
    s_cmp_lt_u32 s60, 2
    s_cbranch_scc0 K2_rare_95
K2_back_96:
    v_mfma_f32_32x32x16_bf16 v[48:63], v[84:87], v[180:183], v[48:63]
    s_waitcnt vmcnt(4) lgkmcnt(0)
    v_mfma_f32_32x32x16_bf16 v[0:15], v[88:91], v[184:187], v[0:15]
    ds_read_b64_tr_b16 v[176:177], v246 offset:0
    ds_read_b64_tr_b16 v[178:179], v246 offset:512
    ds_read_b64_tr_b16 v[180:181], v247 offset:0
    ds_read_b64_tr_b16 v[182:183], v247 offset:512
    s_mov_b32 m0, s71
    v_mfma_f32_32x32x16_bf16 v[16:31], v[92:95], v[184:187], v[16:31]
    buffer_load_dwordx4 v228, s[4:7], s41 offen lds
    buffer_load_dwordx4 v229, s[72:75], s41 offen offset:1024 lds
    v_mfma_f32_32x32x16_bf16 v[32:47], v[88:91], v[188:191], v[32:47]
    s_nop 2
    v_mul_f32 v234, v0, v96
    v_mul_f32 v236, v8, v128
    v_fmac_f32 v234, v1, v97
    v_fmac_f32 v236, v9, v129
    v_fmac_f32 v234, v2, v98
    v_fmac_f32 v236, v10, v130
    v_fmac_f32 v234, v3, v99
    v_mfma_f32_32x32x16_bf16 v[48:63], v[92:95], v[188:191], v[48:63]
    s_setprio 0
    v_fmac_f32 v236, v11, v131
    v_fmac_f32 v234, v4, v100
    v_fmac_f32 v236, v12, v132
    v_fmac_f32 v234, v5, v101
    v_fmac_f32 v236, v13, v133
    v_fmac_f32 v234, v6, v102
    v_fmac_f32 v236, v14, v134
    v_fmac_f32 v234, v7, v103
    v_fmac_f32 v236, v15, v135
    v_mul_f32 v238, v16, v128
    v_mul_f32 v240, v24, v128
    v_fmac_f32 v238, v17, v129
    v_fmac_f32 v240, v25, v129
    v_fmac_f32 v238, v18, v130
    v_fmac_f32 v240, v26, v130
    v_fmac_f32 v238, v19, v131
    v_fmac_f32 v240, v27, v131
    v_fmac_f32 v238, v20, v132
    v_fmac_f32 v240, v28, v132
    v_fmac_f32 v238, v21, v133
    v_fmac_f32 v240, v29, v133
    v_fmac_f32 v238, v22, v134
    v_fmac_f32 v240, v30, v134
    v_fmac_f32 v238, v23, v135
    v_fmac_f32 v240, v31, v135
    v_mul_f32 v235, v32, v104
    v_mul_f32 v237, v40, v136
    v_fmac_f32 v235, v33, v105
    v_fmac_f32 v237, v41, v137
    v_fmac_f32 v235, v34, v106
    v_fmac_f32 v237, v42, v138
    v_fmac_f32 v235, v35, v107
    v_fmac_f32 v237, v43, v139
    v_fmac_f32 v235, v36, v108
    v_fmac_f32 v237, v44, v140
    v_fmac_f32 v235, v37, v109
    v_fmac_f32 v237, v45, v141
    v_fmac_f32 v235, v38, v110
    v_fmac_f32 v237, v46, v142
    v_fmac_f32 v235, v39, v111
    v_fmac_f32 v237, v47, v143
    v_mul_f32 v239, v48, v136
    v_mul_f32 v241, v56, v136
    s_setprio 1
    s_waitcnt vmcnt(4) lgkmcnt(0)
    v_mfma_f32_32x32x16_bf16 v[0:15], v[64:67], v[176:179], 0
    ds_read_b64_tr_b16 v[184:185], v246 offset:2048
    ds_read_b64_tr_b16 v[186:187], v246 offset:2560
    ds_read_b64_tr_b16 v[188:189], v247 offset:2048
    ds_read_b64_tr_b16 v[190:191], v247 offset:2560
    v_fmac_f32 v239, v49, v137
    v_fmac_f32 v241, v57, v137
    s_mov_b32 m0, s68
    v_mfma_f32_32x32x16_bf16 v[16:31], v[68:71], v[176:179], 0
    buffer_load_dwordx4 v222, s[4:7], s42 offen lds
    buffer_load_dwordx4 v223, s[72:75], s42 offen offset:1024 lds
    v_fmac_f32 v239, v50, v138
    v_fmac_f32 v241, v58, v138
    v_fmac_f32 v239, v51, v139
    v_fmac_f32 v241, v59, v139
    v_fmac_f32 v239, v52, v140
    v_mfma_f32_32x32x16_bf16 v[32:47], v[64:67], v[180:183], 0
    v_fmac_f32 v241, v60, v140
    v_fmac_f32 v239, v53, v141
    v_fmac_f32 v241, v61, v141
    v_fmac_f32 v239, v54, v142
    v_fmac_f32 v241, v62, v142
    v_fmac_f32 v239, v55, v143
    v_fmac_f32 v241, v63, v143
    v_mfma_f32_32x32x16_bf16 v[48:63], v[68:71], v[180:183], 0
    v_permlane32_swap_b32 v234, v236
    v_permlane32_swap_b32 v235, v237
    v_permlane32_swap_b32 v240, v238
    s_waitcnt vmcnt(4) lgkmcnt(0)
    v_mfma_f32_32x32x16_bf16 v[0:15], v[72:75], v[184:187], v[0:15]
    ds_read_b64_tr_b16 v[176:177], v246 offset:4096
    ds_read_b64_tr_b16 v[178:179], v246 offset:4608
    ds_read_b64_tr_b16 v[180:181], v247 offset:4096
    ds_read_b64_tr_b16 v[182:183], v247 offset:4608
    v_permlane32_swap_b32 v241, v239
    s_mov_b32 m0, s69
    v_mfma_f32_32x32x16_bf16 v[16:31], v[76:79], v[184:187], v[16:31]
    buffer_load_dwordx4 v224, s[4:7], s42 offen lds
    buffer_load_dwordx4 v225, s[72:75], s42 offen offset:1024 lds
    v_lshl_add_u32 v230, v252, 1, s31
    v_add_f32 v234, v234, v236
    v_add_f32 v235, v235, v237
    v_add_f32 v240, v240, v238
    v_add_f32 v241, v241, v239
    v_mfma_f32_32x32x16_bf16 v[32:47], v[72:75], v[188:191], v[32:47]
    v_cvt_pk_bf16_f32 v234, v234, v235
    v_cvt_pk_bf16_f32 v240, v240, v241
    ds_write_b32 v230, v234 offset:0
    ds_write_b32 v230, v240 offset:256
    v_mfma_f32_32x32x16_bf16 v[48:63], v[76:79], v[188:191], v[48:63]
    s_waitcnt vmcnt(4) lgkmcnt(2)
    v_mfma_f32_32x32x16_bf16 v[0:15], v[80:83], v[176:179], v[0:15]
    ds_read_b64_tr_b16 v[184:185], v246 offset:6144
    ds_read_b64_tr_b16 v[186:187], v246 offset:6656
    ds_read_b64_tr_b16 v[188:189], v247 offset:6144
    ds_read_b64_tr_b16 v[190:191], v247 offset:6656
    s_mov_b32 m0, s70
    v_mfma_f32_32x32x16_bf16 v[16:31], v[84:87], v[176:179], v[16:31]
    buffer_load_dwordx4 v226, s[4:7], s42 offen lds
    buffer_load_dwordx4 v227, s[72:75], s42 offen offset:1024 lds
    v_mfma_f32_32x32x16_bf16 v[32:47], v[80:83], v[180:183], v[32:47]
    v_mfma_f32_32x32x16_bf16 v[48:63], v[84:87], v[180:183], v[48:63]
    s_waitcnt vmcnt(4) lgkmcnt(0)
    v_mfma_f32_32x32x16_bf16 v[0:15], v[88:91], v[184:187], v[0:15]
    ds_read_b64_tr_b16 v[176:177], v246 offset:0
    ds_read_b64_tr_b16 v[178:179], v246 offset:512
    ds_read_b64_tr_b16 v[180:181], v247 offset:0
    ds_read_b64_tr_b16 v[182:183], v247 offset:512
    s_mov_b32 m0, s71
    v_mfma_f32_32x32x16_bf16 v[16:31], v[92:95], v[184:187], v[16:31]
    buffer_load_dwordx4 v228, s[4:7], s42 offen lds
    buffer_load_dwordx4 v229, s[72:75], s42 offen offset:1024 lds
    v_mfma_f32_32x32x16_bf16 v[32:47], v[88:91], v[188:191], v[32:47]
    s_nop 2
    v_mul_f32 v234, v0, v144
    v_mul_f32 v236, v8, v112
    v_fmac_f32 v234, v1, v145
    v_fmac_f32 v236, v9, v113
    v_fmac_f32 v234, v2, v146
    v_fmac_f32 v236, v10, v114
    v_fmac_f32 v234, v3, v147
    v_mfma_f32_32x32x16_bf16 v[48:63], v[92:95], v[188:191], v[48:63]
    s_setprio 0
    v_fmac_f32 v236, v11, v115
    v_fmac_f32 v234, v4, v148
    v_fmac_f32 v236, v12, v116
    v_fmac_f32 v234, v5, v149
    v_fmac_f32 v236, v13, v117
    v_fmac_f32 v234, v6, v150
    v_fmac_f32 v236, v14, v118
    v_fmac_f32 v234, v7, v151
    v_fmac_f32 v236, v15, v119
    v_mul_f32 v238, v16, v160
    v_mul_f32 v240, v24, v160
    v_fmac_f32 v238, v17, v161
    v_fmac_f32 v240, v25, v161
    v_fmac_f32 v238, v18, v162
    v_fmac_f32 v240, v26, v162
    v_fmac_f32 v238, v19, v163
    v_fmac_f32 v240, v27, v163
    v_fmac_f32 v238, v20, v164
    v_fmac_f32 v240, v28, v164
    v_fmac_f32 v238, v21, v165
    v_fmac_f32 v240, v29, v165
    v_fmac_f32 v238, v22, v166
    v_fmac_f32 v240, v30, v166
    v_fmac_f32 v238, v23, v167
    v_fmac_f32 v240, v31, v167
    v_mul_f32 v235, v32, v152
    v_mul_f32 v237, v40, v120
    v_fmac_f32 v235, v33, v153
    v_fmac_f32 v237, v41, v121
    v_fmac_f32 v235, v34, v154
    v_fmac_f32 v237, v42, v122
    v_fmac_f32 v235, v35, v155
    v_fmac_f32 v237, v43, v123
    v_fmac_f32 v235, v36, v156
    v_fmac_f32 v237, v44, v124
    v_fmac_f32 v235, v37, v157
    v_fmac_f32 v237, v45, v125
    v_fmac_f32 v235, v38, v158
    v_fmac_f32 v237, v46, v126
    v_fmac_f32 v235, v39, v159
    v_fmac_f32 v237, v47, v127
    v_mul_f32 v239, v48, v168
    v_mul_f32 v241, v56, v168
    s_setprio 1
    s_waitcnt vmcnt(4) lgkmcnt(0)
    v_mfma_f32_32x32x16_bf16 v[0:15], v[64:67], v[176:179], 0
    ds_read_b64_tr_b16 v[184:185], v246 offset:2048
    ds_read_b64_tr_b16 v[186:187], v246 offset:2560
    ds_read_b64_tr_b16 v[188:189], v247 offset:2048
    ds_read_b64_tr_b16 v[190:191], v247 offset:2560
    v_fmac_f32 v239, v49, v169
    v_fmac_f32 v241, v57, v169
    s_mov_b32 m0, s68
    v_mfma_f32_32x32x16_bf16 v[16:31], v[68:71], v[176:179], 0
    buffer_load_dwordx4 v222, s[4:7], s43 offen lds
    buffer_load_dwordx4 v223, s[72:75], s43 offen offset:1024 lds
    v_fmac_f32 v239, v50, v170
    v_fmac_f32 v241, v58, v170
    v_fmac_f32 v239, v51, v171
    v_fmac_f32 v241, v59, v171
    v_fmac_f32 v239, v52, v172
    v_mfma_f32_32x32x16_bf16 v[32:47], v[64:67], v[180:183], 0
    v_fmac_f32 v241, v60, v172
    v_fmac_f32 v239, v53, v173
    v_fmac_f32 v241, v61, v173
    v_fmac_f32 v239, v54, v174
    v_fmac_f32 v241, v62, v174
    v_fmac_f32 v239, v55, v175
    v_fmac_f32 v241, v63, v175
    v_mfma_f32_32x32x16_bf16 v[48:63], v[68:71], v[180:183], 0
    s_waitcnt vmcnt(4) lgkmcnt(0)
    v_mfma_f32_32x32x16_bf16 v[0:15], v[72:75], v[184:187], v[0:15]
    ds_read_b64_tr_b16 v[176:177], v246 offset:4096
    ds_read_b64_tr_b16 v[178:179], v246 offset:4608
    ds_read_b64_tr_b16 v[180:181], v247 offset:4096
    ds_read_b64_tr_b16 v[182:183], v247 offset:4608
    s_mov_b32 m0, s69
    v_mfma_f32_32x32x16_bf16 v[16:31], v[76:79], v[184:187], v[16:31]
    buffer_load_dwordx4 v224, s[4:7], s43 offen lds
    buffer_load_dwordx4 v225, s[72:75], s43 offen offset:1024 lds
    v_mfma_f32_32x32x16_bf16 v[32:47], v[72:75], v[188:191], v[32:47]
    v_mfma_f32_32x32x16_bf16 v[48:63], v[76:79], v[188:191], v[48:63]
    s_waitcnt vmcnt(4) lgkmcnt(0)
    v_mfma_f32_32x32x16_bf16 v[0:15], v[80:83], v[176:179], v[0:15]
    ds_read_b64_tr_b16 v[184:185], v246 offset:6144
    ds_read_b64_tr_b16 v[186:187], v246 offset:6656
    ds_read_b64_tr_b16 v[188:189], v247 offset:6144
    ds_read_b64_tr_b16 v[190:191], v247 offset:6656
    s_mov_b32 m0, s70
    v_mfma_f32_32x32x16_bf16 v[16:31], v[84:87], v[176:179], v[16:31]
    buffer_load_dwordx4 v226, s[4:7], s43 offen lds
    buffer_load_dwordx4 v227, s[72:75], s43 offen offset:1024 lds
    v_mfma_f32_32x32x16_bf16 v[32:47], v[80:83], v[180:183], v[32:47]
    v_add_u32 v222, s48, v251
    ds_read_b32 v222, v222
    v_mfma_f32_32x32x16_bf16 v[48:63], v[84:87], v[180:183], v[48:63]
    s_waitcnt vmcnt(4) lgkmcnt(1)
    v_mfma_f32_32x32x16_bf16 v[0:15], v[88:91], v[184:187], v[0:15]
    ds_read_b64_tr_b16 v[176:177], v246 offset:0
    ds_read_b64_tr_b16 v[178:179], v246 offset:512
    ds_read_b64_tr_b16 v[180:181], v247 offset:0
    ds_read_b64_tr_b16 v[182:183], v247 offset:512
    s_mov_b32 m0, s71
    v_mfma_f32_32x32x16_bf16 v[16:31], v[92:95], v[184:187], v[16:31]
    buffer_load_dwordx4 v228, s[4:7], s43 offen lds
    buffer_load_dwordx4 v229, s[72:75], s43 offen offset:1024 lds
    s_waitcnt lgkmcnt(4)
    v_mad_u32_u16 v223, v222, s39, v248 op_sel:[1,0,0,0]
    v_mad_u32_u16 v222, v222, s39, v248
    v_mfma_f32_32x32x16_bf16 v[32:47], v[88:91], v[188:191], v[32:47]
    v_add_u32 v224, s49, v251
    ds_read_b32 v224, v224
    v_mul_f32 v242, v0, v144
    v_fma_f32 v238, v8, v160, -v238
    v_fmac_f32 v242, v1, v145
    v_fmac_f32 v238, v9, v161
    v_fmac_f32 v242, v2, v146
    v_mfma_f32_32x32x16_bf16 v[48:63], v[92:95], v[188:191], v[48:63]
    s_setprio 0
    v_fmac_f32 v238, v10, v162
    v_fmac_f32 v242, v3, v147
    v_fmac_f32 v238, v11, v163
    v_fmac_f32 v242, v4, v148
    v_fmac_f32 v238, v12, v164
    v_fmac_f32 v242, v5, v149
    v_fmac_f32 v238, v13, v165
    v_fmac_f32 v242, v6, v150
    v_fmac_f32 v238, v14, v166
    v_fmac_f32 v242, v7, v151
    v_fmac_f32 v238, v15, v167
    v_fmac_f32 v236, v16, v112
    v_mul_f32 v244, v24, v160
    v_fmac_f32 v236, v17, v113
    v_fmac_f32 v244, v25, v161
    v_fmac_f32 v236, v18, v114
    v_fmac_f32 v244, v26, v162
    v_fmac_f32 v236, v19, v115
    v_fmac_f32 v244, v27, v163
    v_fmac_f32 v236, v20, v116
    v_fmac_f32 v244, v28, v164
    v_fmac_f32 v236, v21, v117
    v_fmac_f32 v244, v29, v165
    v_fmac_f32 v236, v22, v118
    v_fmac_f32 v244, v30, v166
    v_fmac_f32 v236, v23, v119
    v_fmac_f32 v244, v31, v167
    v_mul_f32 v243, v32, v152
    v_fma_f32 v239, v40, v168, -v239
    v_fmac_f32 v243, v33, v153
    v_fmac_f32 v239, v41, v169
    v_fmac_f32 v243, v34, v154
    v_fmac_f32 v239, v42, v170
    v_fmac_f32 v243, v35, v155
    v_fmac_f32 v239, v43, v171
    v_fmac_f32 v243, v36, v156
    v_fmac_f32 v239, v44, v172
    v_fmac_f32 v243, v37, v157
    v_fmac_f32 v239, v45, v173
    v_fmac_f32 v243, v38, v158
    v_fmac_f32 v239, v46, v174
    v_fmac_f32 v243, v39, v159
    v_fmac_f32 v239, v47, v175
    v_fmac_f32 v237, v48, v120
    v_mul_f32 v245, v56, v168
    v_fmac_f32 v237, v49, v121
    v_fmac_f32 v245, v57, v169
    v_fmac_f32 v237, v50, v122
    v_fmac_f32 v245, v58, v170
    v_fmac_f32 v237, v51, v123
    s_setprio 1
    s_waitcnt vmcnt(4) lgkmcnt(1)
    v_mfma_f32_32x32x16_bf16 v[0:15], v[64:67], v[176:179], 0
    ds_read_b64_tr_b16 v[184:185], v246 offset:2048
    ds_read_b64_tr_b16 v[186:187], v246 offset:2560
    ds_read_b64_tr_b16 v[188:189], v247 offset:2048
    ds_read_b64_tr_b16 v[190:191], v247 offset:2560
    v_fmac_f32 v245, v59, v171
    v_fmac_f32 v237, v52, v124
    s_mov_b32 m0, s68
    v_mfma_f32_32x32x16_bf16 v[16:31], v[68:71], v[176:179], 0
    buffer_load_dwordx4 v222, s[4:7], s44 offen lds
    buffer_load_dwordx4 v223, s[72:75], s44 offen offset:1024 lds
    s_waitcnt lgkmcnt(4)
    v_mad_u32_u16 v225, v224, s39, v248 op_sel:[1,0,0,0]
    v_mad_u32_u16 v224, v224, s39, v248
    v_fmac_f32 v245, v60, v172
    v_fmac_f32 v237, v53, v125
    v_mfma_f32_32x32x16_bf16 v[32:47], v[64:67], v[180:183], 0
    v_add_u32 v226, s50, v251
    ds_read_b32 v226, v226
    v_fmac_f32 v245, v61, v173
    v_fmac_f32 v237, v54, v126
    v_fmac_f32 v245, v62, v174
    v_fmac_f32 v237, v55, v127
    v_fmac_f32 v245, v63, v175
    v_mfma_f32_32x32x16_bf16 v[48:63], v[68:71], v[180:183], 0
    v_permlane32_swap_b32 v242, v234
    v_permlane32_swap_b32 v243, v235
    v_add_f32 v242, v242, v234
    v_add_f32 v243, v243, v235
    s_waitcnt vmcnt(4) lgkmcnt(1)
    v_mfma_f32_32x32x16_bf16 v[0:15], v[72:75], v[184:187], v[0:15]
    ds_read_b64_tr_b16 v[176:177], v246 offset:4096
    ds_read_b64_tr_b16 v[178:179], v246 offset:4608
    ds_read_b64_tr_b16 v[180:181], v247 offset:4096
    ds_read_b64_tr_b16 v[182:183], v247 offset:4608
    v_cvt_pk_bf16_f32 v242, v242, v243
    ds_write_b32 v230, v242 offset:512
    s_mov_b32 m0, s69
    v_mfma_f32_32x32x16_bf16 v[16:31], v[76:79], v[184:187], v[16:31]
    buffer_load_dwordx4 v224, s[4:7], s45 offen lds
    buffer_load_dwordx4 v225, s[72:75], s45 offen offset:1024 lds
    s_waitcnt lgkmcnt(5)
    v_mad_u32_u16 v227, v226, s39, v248 op_sel:[1,0,0,0]
    v_mad_u32_u16 v226, v226, s39, v248
    v_mfma_f32_32x32x16_bf16 v[32:47], v[72:75], v[188:191], v[32:47]
    v_add_u32 v228, s51, v251
    ds_read_b32 v228, v228
    v_mfma_f32_32x32x16_bf16 v[48:63], v[76:79], v[188:191], v[48:63]
    s_waitcnt vmcnt(4) lgkmcnt(2)
    v_mfma_f32_32x32x16_bf16 v[0:15], v[80:83], v[176:179], v[0:15]
    ds_read_b64_tr_b16 v[184:185], v246 offset:6144
    ds_read_b64_tr_b16 v[186:187], v246 offset:6656
    ds_read_b64_tr_b16 v[188:189], v247 offset:6144
    ds_read_b64_tr_b16 v[190:191], v247 offset:6656
    s_mov_b32 s32, s31
    s_mov_b32 s31, s35
    s_mov_b32 m0, s70
    v_mfma_f32_32x32x16_bf16 v[16:31], v[84:87], v[176:179], v[16:31]
    buffer_load_dwordx4 v226, s[4:7], s46 offen lds
    buffer_load_dwordx4 v227, s[72:75], s46 offen offset:1024 lds
    s_waitcnt lgkmcnt(4)
    v_mad_u32_u16 v229, v228, s39, v248 op_sel:[1,0,0,0]
    v_mad_u32_u16 v228, v228, s39, v248
    s_sub_u32 s26, s48, s29
    s_mov_b32 s29, s48
    v_mfma_f32_32x32x16_bf16 v[32:47], v[80:83], v[180:183], v[32:47]
    s_mov_b32 s30, s3
    s_cmp_lg_u32 s36, 0
    s_cselect_b32 s56, s33, 0
    v_mfma_f32_32x32x16_bf16 v[48:63], v[84:87], v[180:183], v[48:63]
    s_waitcnt vmcnt(4) lgkmcnt(0)
    v_mfma_f32_32x32x16_bf16 v[0:15], v[88:91], v[184:187], v[0:15]
    ds_read_b64_tr_b16 v[176:177], v246 offset:0
    ds_read_b64_tr_b16 v[178:179], v246 offset:512
    ds_read_b64_tr_b16 v[180:181], v247 offset:0
    ds_read_b64_tr_b16 v[182:183], v247 offset:512
    s_mov_b32 m0, s71
    v_mfma_f32_32x32x16_bf16 v[16:31], v[92:95], v[184:187], v[16:31]
    buffer_load_dwordx4 v228, s[4:7], s47 offen lds
    buffer_load_dwordx4 v229, s[72:75], s47 offen offset:1024 lds
    v_mfma_f32_32x32x16_bf16 v[32:47], v[88:91], v[188:191], v[32:47]
    s_nop 2
    v_mul_f32 v242, v0, v144
    v_fma_f32 v240, v8, v160, -v240
    v_fmac_f32 v242, v1, v145
    v_fmac_f32 v240, v9, v161
    v_fmac_f32 v242, v2, v146
    v_fmac_f32 v240, v10, v162
    v_fmac_f32 v242, v3, v147
    v_mfma_f32_32x32x16_bf16 v[48:63], v[92:95], v[188:191], v[48:63]
    s_setprio 0
    v_fmac_f32 v240, v11, v163
    v_fmac_f32 v242, v4, v148
    v_fmac_f32 v240, v12, v164
    v_fmac_f32 v242, v5, v149
    v_fmac_f32 v240, v13, v165
    v_fmac_f32 v242, v6, v150
    v_fmac_f32 v240, v14, v166
    v_fmac_f32 v242, v7, v151
    v_fmac_f32 v240, v15, v167
    v_add_u32 v249, s26, v249
    v_add_u32 v250, s26, v250
    v_fma_f32 v244, v16, v160, -v244
    v_fmac_f32 v236, v24, v112
    v_fmac_f32 v244, v17, v161
    v_fmac_f32 v236, v25, v113
    v_fmac_f32 v244, v18, v162
    v_fmac_f32 v236, v26, v114
    v_fmac_f32 v244, v19, v163
    v_fmac_f32 v236, v27, v115
    v_fmac_f32 v244, v20, v164
    v_fmac_f32 v236, v28, v116
    v_fmac_f32 v244, v21, v165
    v_fmac_f32 v236, v29, v117
    v_fmac_f32 v244, v22, v166
    v_fmac_f32 v236, v30, v118
    v_fmac_f32 v244, v23, v167
    v_fmac_f32 v236, v31, v119
    ds_read_b64_tr_b16 v[0:1], v249 offset:0
    ds_read_b64_tr_b16 v[2:3], v249 offset:128
    ds_read_b128 v[4:7], v250 offset:0
    ds_read_b128 v[8:11], v250 offset:16
    ds_read_b128 v[12:15], v250 offset:384
    ds_read_b128 v[16:19], v250 offset:400
    v_mul_f32 v243, v32, v152
    v_fma_f32 v241, v40, v168, -v241
    v_fmac_f32 v243, v33, v153
    v_fmac_f32 v241, v41, v169
    v_fmac_f32 v243, v34, v154
    v_fmac_f32 v241, v42, v170
    v_fmac_f32 v243, v35, v155
    v_fmac_f32 v241, v43, v171
    v_fmac_f32 v243, v36, v156
    v_fmac_f32 v241, v44, v172
    v_fmac_f32 v243, v37, v157
    v_fmac_f32 v241, v45, v173
    v_fmac_f32 v243, v38, v158
    v_fmac_f32 v241, v46, v174
    v_fmac_f32 v243, v39, v159
    v_fmac_f32 v241, v47, v175
    ds_read_b64_tr_b16 v[20:21], v249 offset:512
    ds_read_b64_tr_b16 v[22:23], v249 offset:640
    ds_read_b128 v[24:27], v250 offset:64
    ds_read_b128 v[28:31], v250 offset:80
    ds_read_b128 v[32:35], v250 offset:448
    ds_read_b128 v[36:39], v250 offset:464
    v_fma_f32 v245, v48, v168, -v245
    v_fmac_f32 v237, v56, v120
    v_fmac_f32 v245, v49, v169
    v_fmac_f32 v237, v57, v121
    v_fmac_f32 v245, v50, v170
    v_fmac_f32 v237, v58, v122
    v_fmac_f32 v245, v51, v171
    v_fmac_f32 v237, v59, v123
    v_fmac_f32 v245, v52, v172
    v_fmac_f32 v237, v60, v124
    v_fmac_f32 v245, v53, v173
    v_fmac_f32 v237, v61, v125
    v_fmac_f32 v245, v54, v174
    v_fmac_f32 v237, v62, v126
    v_fmac_f32 v245, v55, v175
    v_fmac_f32 v237, v63, v127
    s_cmp_eq_u32 s56, 2
    s_cbranch_scc1 K2_U21
    s_cmp_eq_u32 s56, 3
    s_cbranch_scc1 K2_U31
    s_branch K2_DSP1
K2_DSP0:
    s_cmp_eq_u32 s56, 1
    s_cbranch_scc1 K2_U10
    s_cmp_eq_u32 s56, 4
    s_cbranch_scc1 K2_U40
    s_branch K2_SWITCH
K2_DSP1:
    s_cmp_eq_u32 s56, 1
    s_cbranch_scc1 K2_U11
    s_cmp_eq_u32 s56, 4
    s_cbranch_scc1 K2_U41
    s_branch K2_TAIL
K2_SWITCH:
    v_permlane32_swap_b32 v242, v236
    v_permlane32_swap_b32 v243, v237
    v_permlane32_swap_b32 v244, v238
    v_permlane32_swap_b32 v245, v239
    v_permlane32_swap_b32 v240, v241
    v_add_f32 v242, v242, v236
    v_add_f32 v243, v243, v237
    v_add_f32 v244, v244, v238
    v_add_f32 v245, v245, v239
    v_add_f32 v240, -v240, -v241
    s_set_gpr_idx_on s32, gpr_idx(DST)
    s_nop 0
    v_cvt_pk_bf16_f32 v195, v242, v243
    v_cvt_pk_bf16_f32 v196, v244, v245
    v_cvt_pk_bf16_f32 v197, v240, v240
    s_set_gpr_idx_off
    s_cmp_eq_u32 s36, 0
    s_cbranch_scc1 K2_TAIL2
    v_lshlrev_b32 v254, 3, v252
    v_lshl_add_u32 v230, v252, 1, s35
    v_lshrrev_b32 v231, 6, v252
    v_mul_u32_u24 v231, 126, v231
    s_mov_b32 s58, 7131136
    buffer_load_dwordx4 v[96:99], v254, s[8:11], s58 offen offset:0 sc1
    buffer_load_dwordx4 v[100:103], v254, s[8:11], s58 offen offset:1024 sc1
    buffer_load_dwordx4 v[104:107], v254, s[8:11], s58 offen offset:2048 sc1
    buffer_load_dwordx4 v[108:111], v254, s[8:11], s58 offen offset:3072 sc1
    s_mov_b32 s58, 7135232
    buffer_load_dwordx4 v[112:115], v254, s[8:11], s58 offen offset:0 sc1
    buffer_load_dwordx4 v[116:119], v254, s[8:11], s58 offen offset:1024 sc1
    buffer_load_dwordx4 v[120:123], v254, s[8:11], s58 offen offset:2048 sc1
    buffer_load_dwordx4 v[124:127], v254, s[8:11], s58 offen offset:3072 sc1
    s_mov_b32 s58, 7139328
    buffer_load_dwordx4 v[128:131], v254, s[8:11], s58 offen offset:0 sc1
    buffer_load_dwordx4 v[132:135], v254, s[8:11], s58 offen offset:1024 sc1
    buffer_load_dwordx4 v[136:139], v254, s[8:11], s58 offen offset:2048 sc1
    buffer_load_dwordx4 v[140:143], v254, s[8:11], s58 offen offset:3072 sc1
    s_mov_b32 s58, 7143424
    buffer_load_dwordx4 v[144:147], v254, s[8:11], s58 offen offset:0 sc1
    buffer_load_dwordx4 v[148:151], v254, s[8:11], s58 offen offset:1024 sc1
    buffer_load_dwordx4 v[152:155], v254, s[8:11], s58 offen offset:2048 sc1
    buffer_load_dwordx4 v[156:159], v254, s[8:11], s58 offen offset:3072 sc1
    s_mov_b32 s58, 7147520
    buffer_load_dwordx4 v[160:163], v254, s[8:11], s58 offen offset:0 sc1
    buffer_load_dwordx4 v[164:167], v254, s[8:11], s58 offen offset:1024 sc1
    buffer_load_dwordx4 v[168:171], v254, s[8:11], s58 offen offset:2048 sc1
    buffer_load_dwordx4 v[172:175], v254, s[8:11], s58 offen offset:3072 sc1
    s_movk_i32 s40, 128
    s_movk_i32 s41, 384
    s_movk_i32 s42, 640
    s_movk_i32 s43, 896
    s_cmp_lg_u32 s33, 1
    s_cbranch_scc1 K2_SW2
    s_waitcnt vmcnt(0)
K2_SW2:
    s_mov_b32 s29, s48
    s_mov_b32 s32, s31
    s_mov_b32 s30, s3
    s_mov_b32 s31, s35
    s_cmp_eq_u32 s33, 2
    s_cbranch_scc1 K2_U21
    s_cmp_eq_u32 s33, 3
    s_cbranch_scc1 K2_U31
    s_cmp_eq_u32 s33, 1
    s_cbranch_scc1 K2_U11
    s_branch K2_U41
K2_WINDOW:
    s_mov_b32 s24, 0
    s_mov_b32 s25, 1
K2_LOAD:
    v_mbcnt_lo_u32_b32 v176, -1, 0
    v_mbcnt_hi_u32_b32 v176, -1, v176
    s_lshl_b32 s58, s20, 6
    v_add_u32 v177, s58, v176
    v_lshlrev_b32 v70, 4, v176
    s_mov_b32 s58, 7110656
    buffer_load_dwordx4 v[96:99], v70, s[8:11], s58 offen offset:0 sc1
    buffer_load_dwordx4 v[100:103], v70, s[8:11], s58 offen offset:1024 sc1
    buffer_load_dwordx4 v[104:107], v70, s[8:11], s58 offen offset:2048 sc1
    buffer_load_dwordx4 v[108:111], v70, s[8:11], s58 offen offset:3072 sc1
    s_mov_b32 s58, 7114752
    buffer_load_dwordx4 v[112:115], v70, s[8:11], s58 offen offset:0 sc1
    buffer_load_dwordx4 v[116:119], v70, s[8:11], s58 offen offset:1024 sc1
    buffer_load_dwordx4 v[120:123], v70, s[8:11], s58 offen offset:2048 sc1
    buffer_load_dwordx4 v[124:127], v70, s[8:11], s58 offen offset:3072 sc1
    s_mov_b32 s58, 7118848
    buffer_load_dwordx4 v[128:131], v70, s[8:11], s58 offen offset:0 sc1
    buffer_load_dwordx4 v[132:135], v70, s[8:11], s58 offen offset:1024 sc1
    buffer_load_dwordx4 v[136:139], v70, s[8:11], s58 offen offset:2048 sc1
    buffer_load_dwordx4 v[140:143], v70, s[8:11], s58 offen offset:3072 sc1
    s_mov_b32 s58, 7122944
    buffer_load_dwordx4 v[144:147], v70, s[8:11], s58 offen offset:0 sc1
    buffer_load_dwordx4 v[148:151], v70, s[8:11], s58 offen offset:1024 sc1
    buffer_load_dwordx4 v[152:155], v70, s[8:11], s58 offen offset:2048 sc1
    buffer_load_dwordx4 v[156:159], v70, s[8:11], s58 offen offset:3072 sc1
    s_mov_b32 s58, 7127040
    buffer_load_dwordx4 v[160:163], v70, s[8:11], s58 offen offset:0 sc1
    buffer_load_dwordx4 v[164:167], v70, s[8:11], s58 offen offset:1024 sc1
    buffer_load_dwordx4 v[168:171], v70, s[8:11], s58 offen offset:2048 sc1
    buffer_load_dwordx4 v[172:175], v70, s[8:11], s58 offen offset:3072 sc1
    v_mul_u32_u24 v76, 437, v177
    v_lshrrev_b32 v76, 16, v76
    v_mul_u32_u24 v76, 150, v76
    v_sub_u32 v76, v177, v76
    v_mov_b32 v80, -1
    v_mov_b32 v77, 1.0
    v_cmp_gt_u32 vcc, 48, v76
    v_lshlrev_b32 v78, 4, v177
    v_add_u32 v78, 65536, v78
    v_cndmask_b32 v80, v80, 0, vcc
    v_cmp_gt_u32 vcc, 12, v76
    v_add_u32 v79, 64800, v78
    s_nop 0
    v_cndmask_b32 v80, v80, v77, vcc
    v_cmp_gt_u32 vcc, 450, v177
    v_mov_b32 v81, v80
    v_mov_b32 v82, v80
    v_mov_b32 v83, v80
    s_mov_b64 exec, vcc
    ds_write_b128 v78, v[80:83] offset:0
    ds_write_b128 v78, v[80:83] offset:7200
    ds_write_b128 v78, v[80:83] offset:14400
    ds_write_b128 v78, v[80:83] offset:21600
    ds_write_b128 v78, v[80:83] offset:28800
    ds_write_b128 v78, v[80:83] offset:36000
    ds_write_b128 v78, v[80:83] offset:43200
    ds_write_b128 v78, v[80:83] offset:50400
    ds_write_b128 v78, v[80:83] offset:57600
    ds_write_b128 v79, v[80:83] offset:0
    ds_write_b128 v79, v[80:83] offset:7200
    ds_write_b128 v79, v[80:83] offset:14400
    ds_write_b128 v79, v[80:83] offset:21600
    v_cmp_gt_u32 vcc, 268, v177
    s_nop 0
    s_cbranch_vccz K2_NOCL
    s_mov_b64 exec, vcc
    ds_write_b128 v79, v[80:83] offset:28800
K2_NOCL:
    s_mov_b64 exec, -1
    s_cmp_lg_u32 s20, 7
    s_cbranch_scc1 K2_NOH
    v_mov_b32 v76, 0
    v_mov_b32 v77, -1
    v_lshlrev_b32 v78, 2, v176
    v_add_u32 v78, 163424, v78
    s_mov_b64 exec, 0x1ff
    ds_write_b32 v78, v76 offset:192
    s_mov_b64 exec, 0xff
    ds_write_b32 v78, v77 offset:256
    s_mov_b64 exec, -1
    s_cmp_lg_u32 s24, 0
    s_cbranch_scc1 K2_NOH
    s_mov_b32 exec_hi, 0xffff
    ds_write_b32 v78, v76
    s_mov_b64 exec, 1
    ds_write_b32 v78, v76 offset:228
    s_mov_b64 exec, -1
K2_NOH:
    s_waitcnt lgkmcnt(0)
    s_barrier
    s_branch K2_CELLS
K2_FLGLD:
    buffer_load_dwordx4 v[84:87], v72, s[8:11], s64 offen sc1
    s_mov_b32 s62, 0
    s_branch K2_FLGL2
K2_FLGCK:
    s_cmp_lg_u32 s24, 0
    s_cbranch_scc1 K2_FLGOK
    s_waitcnt vmcnt(0)
K2_FLGW:
    v_xor_b32 v84, s2, v84
    v_xor_b32 v85, s2, v85
    v_xor_b32 v86, s2, v86
    v_xor_b32 v87, s2, v87
    v_or3_b32 v84, v84, v85, v86
    v_or_b32 v84, v84, v87
    v_cmp_ne_u32 vcc, 0, v84
    s_nop 0
    s_and_b32 vcc_hi, vcc_hi, 0x3ffff
    s_cmp_eq_u64 vcc, 0
    s_cbranch_scc1 K2_FLGOK
    s_sub_u32 s60, s60, 1
    s_cbranch_scc1 K2_END
    buffer_load_dwordx4 v[84:87], v72, s[8:11], s64 offen sc1
    s_waitcnt vmcnt(0)
    s_branch K2_FLGW
K2_RT0:
    s_sub_u32 s60, s60, 1
    s_cbranch_scc1 K2_END
    buffer_load_dwordx4 v[0:3], v181, s[8:11], 0 offen offset:0 sc1
    s_waitcnt vmcnt(0)
    s_branch K2_CK0
K2_RT1:
    s_sub_u32 s60, s60, 1
    s_cbranch_scc1 K2_END
    buffer_load_dwordx4 v[4:7], v181, s[8:11], 0 offen offset:32 sc1
    s_waitcnt vmcnt(0)
    s_branch K2_CK1
K2_RT2:
    s_sub_u32 s60, s60, 1
    s_cbranch_scc1 K2_END
    buffer_load_dwordx4 v[8:11], v181, s[8:11], 0 offen offset:64 sc1
    s_waitcnt vmcnt(0)
    s_branch K2_CK2
K2_RT3:
    s_sub_u32 s60, s60, 1
    s_cbranch_scc1 K2_END
    buffer_load_dwordx4 v[12:15], v181, s[8:11], 0 offen offset:96 sc1
    s_waitcnt vmcnt(0)
    s_branch K2_CK3
K2_RT4:
    s_sub_u32 s60, s60, 1
    s_cbranch_scc1 K2_END
    buffer_load_dwordx4 v[16:19], v181, s[8:11], 0 offen offset:128 sc1
    s_waitcnt vmcnt(0)
    s_branch K2_CK4
K2_RT5:
    s_sub_u32 s60, s60, 1
    s_cbranch_scc1 K2_END
    buffer_load_dwordx4 v[20:23], v181, s[8:11], 0 offen offset:160 sc1
    s_waitcnt vmcnt(0)
    s_branch K2_CK5
K2_RT6:
    s_sub_u32 s60, s60, 1
    s_cbranch_scc1 K2_END
    buffer_load_dwordx4 v[24:27], v181, s[8:11], 0 offen offset:192 sc1
    s_waitcnt vmcnt(0)
    s_branch K2_CK6
K2_RT7:
    s_sub_u32 s60, s60, 1
    s_cbranch_scc1 K2_END
    buffer_load_dwordx4 v[28:31], v181, s[8:11], 0 offen offset:224 sc1
    s_waitcnt vmcnt(0)
    s_branch K2_CK7
K2_RT8:
    s_sub_u32 s60, s60, 1
    s_cbranch_scc1 K2_END
    buffer_load_dwordx4 v[32:35], v181, s[8:11], 0 offen offset:256 sc1
    s_waitcnt vmcnt(0)
    s_branch K2_CK8
K2_RT9:
    s_sub_u32 s60, s60, 1
    s_cbranch_scc1 K2_END
    buffer_load_dwordx4 v[36:39], v181, s[8:11], 0 offen offset:288 sc1
    s_waitcnt vmcnt(0)
    s_branch K2_CK9
K2_RK_LOAD:
    s_waitcnt vmcnt(0)
    s_mov_b64 exec, s[40:41]
    s_cbranch_execz K2_RK_B
    v_lshrrev_b32 v50, 24, v3
    buffer_load_dword v40, v179, s[8:11], s66 offen offset:0
    v_mad_u32_u24 v50, v50, s58, v202
    v_and_b32 v3, 0xffffff, v3
    s_mov_b64 exec, s[42:43]
    s_cbranch_execz K2_RK_B
    v_lshrrev_b32 v51, 24, v7
    buffer_load_dword v41, v179, s[8:11], s66 offen offset:8
    v_mad_u32_u24 v51, v51, s58, v202
    v_and_b32 v7, 0xffffff, v7
    s_mov_b64 exec, s[44:45]
    s_cbranch_execz K2_RK_B
    v_lshrrev_b32 v52, 24, v11
    buffer_load_dword v42, v179, s[8:11], s66 offen offset:16
    v_mad_u32_u24 v52, v52, s58, v202
    v_and_b32 v11, 0xffffff, v11
    s_mov_b64 exec, s[46:47]
    s_cbranch_execz K2_RK_B
    v_lshrrev_b32 v53, 24, v15
    buffer_load_dword v43, v179, s[8:11], s66 offen offset:24
    v_mad_u32_u24 v53, v53, s58, v202
    v_and_b32 v15, 0xffffff, v15
    s_mov_b64 exec, s[48:49]
    s_cbranch_execz K2_RK_B
    v_lshrrev_b32 v54, 24, v19
    buffer_load_dword v44, v179, s[8:11], s66 offen offset:32
    v_mad_u32_u24 v54, v54, s58, v202
    v_and_b32 v19, 0xffffff, v19
    s_mov_b64 exec, s[50:51]
    s_cbranch_execz K2_RK_B
    v_lshrrev_b32 v55, 24, v23
    buffer_load_dword v45, v179, s[8:11], s66 offen offset:40
    v_mad_u32_u24 v55, v55, s58, v202
    v_and_b32 v23, 0xffffff, v23
    s_mov_b64 exec, s[90:91]
    s_cbranch_execz K2_RK_B
    v_lshrrev_b32 v56, 24, v27
    buffer_load_dword v46, v179, s[8:11], s66 offen offset:48
    v_mad_u32_u24 v56, v56, s58, v202
    v_and_b32 v27, 0xffffff, v27
    s_mov_b64 exec, s[92:93]
    s_cbranch_execz K2_RK_B
    v_lshrrev_b32 v57, 24, v31
    buffer_load_dword v47, v179, s[8:11], s66 offen offset:56
    v_mad_u32_u24 v57, v57, s58, v202
    v_and_b32 v31, 0xffffff, v31
    s_mov_b64 exec, s[94:95]
    s_cbranch_execz K2_RK_B
    v_lshrrev_b32 v58, 24, v35
    buffer_load_dword v48, v179, s[8:11], s66 offen offset:64
    v_mad_u32_u24 v58, v58, s58, v202
    v_and_b32 v35, 0xffffff, v35
    s_mov_b64 exec, s[96:97]
    s_cbranch_execz K2_RK_B
    v_lshrrev_b32 v59, 24, v39
    buffer_load_dword v49, v179, s[8:11], s66 offen offset:72
    v_mad_u32_u24 v59, v59, s58, v202
    v_and_b32 v39, 0xffffff, v39
K2_RK_B:
    s_mov_b64 exec, -1
    s_mul_i32 s62, s24, 48
    s_waitcnt vmcnt(0)
    v_subrev_u32 v40, s62, v40
    v_subrev_u32 v41, s62, v41
    v_subrev_u32 v42, s62, v42
    v_subrev_u32 v43, s62, v43
    v_subrev_u32 v44, s62, v44
    v_subrev_u32 v45, s62, v45
    v_subrev_u32 v46, s62, v46
    v_subrev_u32 v47, s62, v47
    v_subrev_u32 v48, s62, v48
    v_subrev_u32 v49, s62, v49
    s_branch K2_RK_DONE
K2_BIG:
    s_cmp_lg_u32 s24, 0
    s_cbranch_scc1 K2_TOK
    s_mov_b64 s[62:63], vcc
    s_bcnt1_i32_b64 s60, vcc
    s_cmp_eq_u32 s22, 39
    s_cselect_b32 s61, 5, 2
    s_cmp_gt_u32 s60, s61
    s_cbranch_scc1 K2_SLOW
    v_cmp_lt_u32 vcc, 64, v193
    s_nop 0
    s_cbranch_vccnz K2_SLOW
    v_mbcnt_lo_u32_b32 v197, s62, 0
    v_mbcnt_hi_u32_b32 v197, s63, v197
    v_lshlrev_b32 v198, 27, v197
    v_cndmask_b32 v198, 0, v198, s[62:63]
    s_movk_i32 s26, 64
    v_cmp_le_u32 vcc, 2, v197
    v_mov_b32 v194, 161536
    v_mov_b32 v196, -8229472
    v_cndmask_b32 v194, v194, v196, vcc
    v_lshl_add_u32 v197, v197, 22, v194
    v_mov_b32 v203, v193
    v_mov_b32 v204, v195
    v_mov_b32 v205, v197
    s_mov_b32 s60, 6991
    s_mov_b64 exec, s[40:41]
    s_cbranch_execz K2_OV_DONE
    v_cmp_le_u32 vcc, 48, v40
    s_nop 0
    s_cbranch_vccz K2_ov_1
    s_mov_b64 exec, -1
    v_subrev_u32 v192, 65536, v50
    v_mul_hi_u32_u24 v193, s60, v192
    v_mul_u32_u24 v192, s60, v192
    v_alignbit_b32 v192, v193, v192, 24
    v_lshlrev_b32 v192, 2, v192
    ds_bpermute_b32 v199, v192, v205
    v_subrev_u32 v192, 48, v40
    s_waitcnt lgkmcnt(0)
    s_mov_b64 exec, vcc
    v_lshrrev_b32 v193, 18, v199
    v_add_u32 v192, v192, v193
    v_and_b32 v199, 0x3ffff, v199
    v_lshl_add_u32 v194, v192, 5, v199
    v_lshl_add_u32 v195, v192, 2, v199
    v_lshrrev_b32 v193, 3, v192
    v_mad_i32_i24 v196, v193, -16, v195
    v_and_b32 v193, 1, v193
    v_mad_i32_i24 v196, v193, -14, v196
    ds_write_b32 v194, v3 offset:864
    ds_write_b16 v195, v0 offset:194
    ds_write_b16_d16_hi v195, v0 offset:386
    ds_write_b16_d16_hi v195, v1 offset:578
    ds_write_b16 v196, v2 offset:768
K2_ov_1:
    s_mov_b64 exec, s[42:43]
    s_cbranch_execz K2_OV_DONE
    v_cmp_le_u32 vcc, 48, v41
    s_nop 0
    s_cbranch_vccz K2_ov_2
    s_mov_b64 exec, -1
    v_subrev_u32 v192, 65536, v51
    v_mul_hi_u32_u24 v193, s60, v192
    v_mul_u32_u24 v192, s60, v192
    v_alignbit_b32 v192, v193, v192, 24
    v_lshlrev_b32 v192, 2, v192
    ds_bpermute_b32 v199, v192, v205
    v_subrev_u32 v192, 48, v41
    s_waitcnt lgkmcnt(0)
    s_mov_b64 exec, vcc
    v_lshrrev_b32 v193, 18, v199
    v_add_u32 v192, v192, v193
    v_and_b32 v199, 0x3ffff, v199
    v_lshl_add_u32 v194, v192, 5, v199
    v_lshl_add_u32 v195, v192, 2, v199
    v_lshrrev_b32 v193, 3, v192
    v_mad_i32_i24 v196, v193, -16, v195
    v_and_b32 v193, 1, v193
    v_mad_i32_i24 v196, v193, -14, v196
    ds_write_b32 v194, v7 offset:864
    ds_write_b16 v195, v4 offset:194
    ds_write_b16_d16_hi v195, v4 offset:386
    ds_write_b16_d16_hi v195, v5 offset:578
    ds_write_b16 v196, v6 offset:768
K2_ov_2:
    s_mov_b64 exec, s[44:45]
    s_cbranch_execz K2_OV_DONE
    v_cmp_le_u32 vcc, 48, v42
    s_nop 0
    s_cbranch_vccz K2_ov_3
    s_mov_b64 exec, -1
    v_subrev_u32 v192, 65536, v52
    v_mul_hi_u32_u24 v193, s60, v192
    v_mul_u32_u24 v192, s60, v192
    v_alignbit_b32 v192, v193, v192, 24
    v_lshlrev_b32 v192, 2, v192
    ds_bpermute_b32 v199, v192, v205
    v_subrev_u32 v192, 48, v42
    s_waitcnt lgkmcnt(0)
    s_mov_b64 exec, vcc
    v_lshrrev_b32 v193, 18, v199
    v_add_u32 v192, v192, v193
    v_and_b32 v199, 0x3ffff, v199
    v_lshl_add_u32 v194, v192, 5, v199
    v_lshl_add_u32 v195, v192, 2, v199
    v_lshrrev_b32 v193, 3, v192
    v_mad_i32_i24 v196, v193, -16, v195
    v_and_b32 v193, 1, v193
    v_mad_i32_i24 v196, v193, -14, v196
    ds_write_b32 v194, v11 offset:864
    ds_write_b16 v195, v8 offset:194
    ds_write_b16_d16_hi v195, v8 offset:386
    ds_write_b16_d16_hi v195, v9 offset:578
    ds_write_b16 v196, v10 offset:768
K2_ov_3:
    s_mov_b64 exec, s[46:47]
    s_cbranch_execz K2_OV_DONE
    v_cmp_le_u32 vcc, 48, v43
    s_nop 0
    s_cbranch_vccz K2_ov_4
    s_mov_b64 exec, -1
    v_subrev_u32 v192, 65536, v53
    v_mul_hi_u32_u24 v193, s60, v192
    v_mul_u32_u24 v192, s60, v192
    v_alignbit_b32 v192, v193, v192, 24
    v_lshlrev_b32 v192, 2, v192
    ds_bpermute_b32 v199, v192, v205
    v_subrev_u32 v192, 48, v43
    s_waitcnt lgkmcnt(0)
    s_mov_b64 exec, vcc
    v_lshrrev_b32 v193, 18, v199
    v_add_u32 v192, v192, v193
    v_and_b32 v199, 0x3ffff, v199
    v_lshl_add_u32 v194, v192, 5, v199
    v_lshl_add_u32 v195, v192, 2, v199
    v_lshrrev_b32 v193, 3, v192
    v_mad_i32_i24 v196, v193, -16, v195
    v_and_b32 v193, 1, v193
    v_mad_i32_i24 v196, v193, -14, v196
    ds_write_b32 v194, v15 offset:864
    ds_write_b16 v195, v12 offset:194
    ds_write_b16_d16_hi v195, v12 offset:386
    ds_write_b16_d16_hi v195, v13 offset:578
    ds_write_b16 v196, v14 offset:768
K2_ov_4:
    s_mov_b64 exec, s[48:49]
    s_cbranch_execz K2_OV_DONE
    v_cmp_le_u32 vcc, 48, v44
    s_nop 0
    s_cbranch_vccz K2_ov_5
    s_mov_b64 exec, -1
    v_subrev_u32 v192, 65536, v54
    v_mul_hi_u32_u24 v193, s60, v192
    v_mul_u32_u24 v192, s60, v192
    v_alignbit_b32 v192, v193, v192, 24
    v_lshlrev_b32 v192, 2, v192
    ds_bpermute_b32 v199, v192, v205
    v_subrev_u32 v192, 48, v44
    s_waitcnt lgkmcnt(0)
    s_mov_b64 exec, vcc
    v_lshrrev_b32 v193, 18, v199
    v_add_u32 v192, v192, v193
    v_and_b32 v199, 0x3ffff, v199
    v_lshl_add_u32 v194, v192, 5, v199
    v_lshl_add_u32 v195, v192, 2, v199
    v_lshrrev_b32 v193, 3, v192
    v_mad_i32_i24 v196, v193, -16, v195
    v_and_b32 v193, 1, v193
    v_mad_i32_i24 v196, v193, -14, v196
    ds_write_b32 v194, v19 offset:864
    ds_write_b16 v195, v16 offset:194
    ds_write_b16_d16_hi v195, v16 offset:386
    ds_write_b16_d16_hi v195, v17 offset:578
    ds_write_b16 v196, v18 offset:768
K2_ov_5:
    s_mov_b64 exec, s[50:51]
    s_cbranch_execz K2_OV_DONE
    v_cmp_le_u32 vcc, 48, v45
    s_nop 0
    s_cbranch_vccz K2_ov_6
    s_mov_b64 exec, -1
    v_subrev_u32 v192, 65536, v55
    v_mul_hi_u32_u24 v193, s60, v192
    v_mul_u32_u24 v192, s60, v192
    v_alignbit_b32 v192, v193, v192, 24
    v_lshlrev_b32 v192, 2, v192
    ds_bpermute_b32 v199, v192, v205
    v_subrev_u32 v192, 48, v45
    s_waitcnt lgkmcnt(0)
    s_mov_b64 exec, vcc
    v_lshrrev_b32 v193, 18, v199
    v_add_u32 v192, v192, v193
    v_and_b32 v199, 0x3ffff, v199
    v_lshl_add_u32 v194, v192, 5, v199
    v_lshl_add_u32 v195, v192, 2, v199
    v_lshrrev_b32 v193, 3, v192
    v_mad_i32_i24 v196, v193, -16, v195
    v_and_b32 v193, 1, v193
    v_mad_i32_i24 v196, v193, -14, v196
    ds_write_b32 v194, v23 offset:864
    ds_write_b16 v195, v20 offset:194
    ds_write_b16_d16_hi v195, v20 offset:386
    ds_write_b16_d16_hi v195, v21 offset:578
    ds_write_b16 v196, v22 offset:768
K2_ov_6:
    s_mov_b64 exec, s[90:91]
    s_cbranch_execz K2_OV_DONE
    v_cmp_le_u32 vcc, 48, v46
    s_nop 0
    s_cbranch_vccz K2_ov_7
    s_mov_b64 exec, -1
    v_subrev_u32 v192, 65536, v56
    v_mul_hi_u32_u24 v193, s60, v192
    v_mul_u32_u24 v192, s60, v192
    v_alignbit_b32 v192, v193, v192, 24
    v_lshlrev_b32 v192, 2, v192
    ds_bpermute_b32 v199, v192, v205
    v_subrev_u32 v192, 48, v46
    s_waitcnt lgkmcnt(0)
    s_mov_b64 exec, vcc
    v_lshrrev_b32 v193, 18, v199
    v_add_u32 v192, v192, v193
    v_and_b32 v199, 0x3ffff, v199
    v_lshl_add_u32 v194, v192, 5, v199
    v_lshl_add_u32 v195, v192, 2, v199
    v_lshrrev_b32 v193, 3, v192
    v_mad_i32_i24 v196, v193, -16, v195
    v_and_b32 v193, 1, v193
    v_mad_i32_i24 v196, v193, -14, v196
    ds_write_b32 v194, v27 offset:864
    ds_write_b16 v195, v24 offset:194
    ds_write_b16_d16_hi v195, v24 offset:386
    ds_write_b16_d16_hi v195, v25 offset:578
    ds_write_b16 v196, v26 offset:768
K2_ov_7:
    s_mov_b64 exec, s[92:93]
    s_cbranch_execz K2_OV_DONE
    v_cmp_le_u32 vcc, 48, v47
    s_nop 0
    s_cbranch_vccz K2_ov_8
    s_mov_b64 exec, -1
    v_subrev_u32 v192, 65536, v57
    v_mul_hi_u32_u24 v193, s60, v192
    v_mul_u32_u24 v192, s60, v192
    v_alignbit_b32 v192, v193, v192, 24
    v_lshlrev_b32 v192, 2, v192
    ds_bpermute_b32 v199, v192, v205
    v_subrev_u32 v192, 48, v47
    s_waitcnt lgkmcnt(0)
    s_mov_b64 exec, vcc
    v_lshrrev_b32 v193, 18, v199
    v_add_u32 v192, v192, v193
    v_and_b32 v199, 0x3ffff, v199
    v_lshl_add_u32 v194, v192, 5, v199
    v_lshl_add_u32 v195, v192, 2, v199
    v_lshrrev_b32 v193, 3, v192
    v_mad_i32_i24 v196, v193, -16, v195
    v_and_b32 v193, 1, v193
    v_mad_i32_i24 v196, v193, -14, v196
    ds_write_b32 v194, v31 offset:864
    ds_write_b16 v195, v28 offset:194
    ds_write_b16_d16_hi v195, v28 offset:386
    ds_write_b16_d16_hi v195, v29 offset:578
    ds_write_b16 v196, v30 offset:768
K2_ov_8:
    s_mov_b64 exec, s[94:95]
    s_cbranch_execz K2_OV_DONE
    v_cmp_le_u32 vcc, 48, v48
    s_nop 0
    s_cbranch_vccz K2_ov_9
    s_mov_b64 exec, -1
    v_subrev_u32 v192, 65536, v58
    v_mul_hi_u32_u24 v193, s60, v192
    v_mul_u32_u24 v192, s60, v192
    v_alignbit_b32 v192, v193, v192, 24
    v_lshlrev_b32 v192, 2, v192
    ds_bpermute_b32 v199, v192, v205
    v_subrev_u32 v192, 48, v48
    s_waitcnt lgkmcnt(0)
    s_mov_b64 exec, vcc
    v_lshrrev_b32 v193, 18, v199
    v_add_u32 v192, v192, v193
    v_and_b32 v199, 0x3ffff, v199
    v_lshl_add_u32 v194, v192, 5, v199
    v_lshl_add_u32 v195, v192, 2, v199
    v_lshrrev_b32 v193, 3, v192
    v_mad_i32_i24 v196, v193, -16, v195
    v_and_b32 v193, 1, v193
    v_mad_i32_i24 v196, v193, -14, v196
    ds_write_b32 v194, v35 offset:864
    ds_write_b16 v195, v32 offset:194
    ds_write_b16_d16_hi v195, v32 offset:386
    ds_write_b16_d16_hi v195, v33 offset:578
    ds_write_b16 v196, v34 offset:768
K2_ov_9:
    s_mov_b64 exec, s[96:97]
    s_cbranch_execz K2_OV_DONE
    v_cmp_le_u32 vcc, 48, v49
    s_nop 0
    s_cbranch_vccz K2_ov_10
    s_mov_b64 exec, -1
    v_subrev_u32 v192, 65536, v59
    v_mul_hi_u32_u24 v193, s60, v192
    v_mul_u32_u24 v192, s60, v192
    v_alignbit_b32 v192, v193, v192, 24
    v_lshlrev_b32 v192, 2, v192
    ds_bpermute_b32 v199, v192, v205
    v_subrev_u32 v192, 48, v49
    s_waitcnt lgkmcnt(0)
    s_mov_b64 exec, vcc
    v_lshrrev_b32 v193, 18, v199
    v_add_u32 v192, v192, v193
    v_and_b32 v199, 0x3ffff, v199
    v_lshl_add_u32 v194, v192, 5, v199
    v_lshl_add_u32 v195, v192, 2, v199
    v_lshrrev_b32 v193, 3, v192
    v_mad_i32_i24 v196, v193, -16, v195
    v_and_b32 v193, 1, v193
    v_mad_i32_i24 v196, v193, -14, v196
    ds_write_b32 v194, v39 offset:864
    ds_write_b16 v195, v36 offset:194
    ds_write_b16_d16_hi v195, v36 offset:386
    ds_write_b16_d16_hi v195, v37 offset:578
    ds_write_b16 v196, v38 offset:768
K2_ov_10:
K2_OV_DONE:
    s_mov_b64 exec, -1
    v_mov_b32 v193, v203
    v_mov_b32 v195, v204
    s_waitcnt lgkmcnt(0)
    s_barrier
    s_branch K2_TOK
K2_SLOW:
    v_mov_b32 v197, v193
    s_nop 1
    v_max_u32_dpp v197, v197, v197 row_shr:1 row_mask:0xf bank_mask:0xf bound_ctrl:0
    s_nop 1
    v_max_u32_dpp v197, v197, v197 row_shr:2 row_mask:0xf bank_mask:0xf bound_ctrl:0
    s_nop 1
    v_max_u32_dpp v197, v197, v197 row_shr:4 row_mask:0xf bank_mask:0xf bound_ctrl:0
    s_nop 1
    v_max_u32_dpp v197, v197, v197 row_shr:8 row_mask:0xf bank_mask:0xf bound_ctrl:0
    s_nop 1
    v_max_u32_dpp v197, v197, v197 row_bcast:15 row_mask:0xa bank_mask:0xf
    s_nop 1
    v_max_u32_dpp v197, v197, v197 row_bcast:31 row_mask:0xc bank_mask:0xf
    s_nop 0
    v_readlane_b32 s25, v197, 63
    s_nop 0
    s_add_u32 s25, s25, 47
    s_mul_i32 s25, s25, 43691
    s_lshr_b32 s25, s25, 21
    v_cmp_lt_i32 vcc, 0, v180
    s_nop 0
    s_cbranch_vccz K2_SV_DONE
    s_mov_b64 exec, vcc
    buffer_store_dword v40, v179, s[8:11], s66 offen offset:0
    v_cmp_lt_i32 vcc, 2, v180
    s_nop 0
    s_cbranch_vccz K2_SV_DONE
    s_mov_b64 exec, vcc
    buffer_store_dword v41, v179, s[8:11], s66 offen offset:8
    v_cmp_lt_i32 vcc, 4, v180
    s_nop 0
    s_cbranch_vccz K2_SV_DONE
    s_mov_b64 exec, vcc
    buffer_store_dword v42, v179, s[8:11], s66 offen offset:16
    v_cmp_lt_i32 vcc, 6, v180
    s_nop 0
    s_cbranch_vccz K2_SV_DONE
    s_mov_b64 exec, vcc
    buffer_store_dword v43, v179, s[8:11], s66 offen offset:24
    v_cmp_lt_i32 vcc, 8, v180
    s_nop 0
    s_cbranch_vccz K2_SV_DONE
    s_mov_b64 exec, vcc
    buffer_store_dword v44, v179, s[8:11], s66 offen offset:32
    v_cmp_lt_i32 vcc, 10, v180
    s_nop 0
    s_cbranch_vccz K2_SV_DONE
    s_mov_b64 exec, vcc
    buffer_store_dword v45, v179, s[8:11], s66 offen offset:40
    v_cmp_lt_i32 vcc, 12, v180
    s_nop 0
    s_cbranch_vccz K2_SV_DONE
    s_mov_b64 exec, vcc
    buffer_store_dword v46, v179, s[8:11], s66 offen offset:48
    v_cmp_lt_i32 vcc, 14, v180
    s_nop 0
    s_cbranch_vccz K2_SV_DONE
    s_mov_b64 exec, vcc
    buffer_store_dword v47, v179, s[8:11], s66 offen offset:56
    v_cmp_lt_i32 vcc, 16, v180
    s_nop 0
    s_cbranch_vccz K2_SV_DONE
    s_mov_b64 exec, vcc
    buffer_store_dword v48, v179, s[8:11], s66 offen offset:64
    v_cmp_lt_i32 vcc, 18, v180
    s_nop 0
    s_cbranch_vccz K2_SV_DONE
    s_mov_b64 exec, vcc
    buffer_store_dword v49, v179, s[8:11], s66 offen offset:72
K2_SV_DONE:
    s_mov_b64 exec, -1
    s_branch K2_TOK
K2_rare_11:
    s_cmp_eq_u32 s33, 4
    s_cbranch_scc1 K2_four_13
    s_mov_b32 s49, s48
    s_mov_b32 s51, s48
    s_add_u32 s45, s44, 256
    s_add_u32 s46, s44, 512
    s_add_u32 s47, s44, 768
    s_branch K2_back_12
K2_four_13:
    s_add_u32 s50, s48, 64
    s_lshr_b32 s51, s3, 27
    s_mov_b32 s66, 161536
    s_cmp_ge_u32 s51, 2
    s_cselect_b32 s66, 159072, s66
    s_mul_i32 s51, s51, 32
    s_add_u32 s51, s51, s66
    s_mov_b32 s46, s44
    s_mov_b32 s47, s44
    s_branch K2_back_12
K2_dum_14:
    v_mov_b32 v232, -1
    s_mov_b32 m0, 163712
    s_mov_b64 exec, 1
    buffer_load_dwordx4 v232, s[16:19], 0 offen lds
    buffer_load_dwordx4 v232, s[16:19], 0 offen lds
    s_mov_b64 exec, -1
    s_branch K2_back_16
K2_a4_15:
    s_lshr_b32 s65, s3, 27
    s_mov_b32 s66, 161536
    s_cmp_ge_u32 s65, 2
    s_cselect_b32 s66, 158112, s66
    s_mul_i32 s65, s65, 512
    s_add_u32 s65, s65, s66
    v_add_u32 v232, s65, v230
    ds_read_b32 v232, v232
    s_add_u32 m0, s65, 864
    s_waitcnt lgkmcnt(0)
    v_or_b32 v232, v232, v231
    buffer_load_dwordx4 v232, s[16:19], 0 offen  lds
    s_branch K2_b4_17
K2_nul_20:
    s_mov_b32 s58, 63
    s_mov_b32 s36, 0
    s_branch K2_back_23
K2_spin_21:
    v_lshl_add_u32 v233, v252, 1, s53
    ds_read_b32 v233, v233
    s_waitcnt lgkmcnt(0)
    s_branch K2_chk_22
K2_dyn_18:
    v_mov_b32 v254, 163648
    v_mov_b32 v255, 1
    v_lshl_add_u32 v233, v252, 1, s53
    s_mov_b64 exec, 1
    ds_add_rtn_u32 v232, v254, v255
    s_mov_b64 exec, -1
    ds_read_b32 v233, v233
    s_waitcnt lgkmcnt(0)
    v_readfirstlane_b32 s58, v232
    s_nop 0
    s_cmp_lt_u32 s58, s22
    s_cbranch_scc0 K2_nul_20
    s_and_b32 s59, s58, 7
    s_lshr_b32 s60, s58, 3
K2_chk_22:
    v_readlane_b32 s61, v233, s59
    s_nop 0
    s_cmp_gt_u32 s61, s60
    s_cbranch_scc0 K2_spin_21
K2_back_23:
    s_mov_b32 s34, 1
    s_branch K2_back_19
K2_rare_24:
    s_cmp_eq_u32 s33, 4
    s_cbranch_scc1 K2_four_26
    s_mov_b32 s49, s48
    s_mov_b32 s51, s48
    s_add_u32 s45, s44, 256
    s_add_u32 s46, s44, 512
    s_add_u32 s47, s44, 768
    s_branch K2_back_25
K2_four_26:
    s_add_u32 s50, s48, 64
    s_lshr_b32 s51, s3, 27
    s_mov_b32 s66, 161536
    s_cmp_ge_u32 s51, 2
    s_cselect_b32 s66, 159072, s66
    s_mul_i32 s51, s51, 32
    s_add_u32 s51, s51, s66
    s_mov_b32 s46, s44
    s_mov_b32 s47, s44
    s_branch K2_back_25
K2_dum_27:
    v_mov_b32 v232, -1
    s_mov_b32 m0, 163712
    s_mov_b64 exec, 1
    buffer_load_dwordx4 v232, s[16:19], 0 offen lds
    buffer_load_dwordx4 v232, s[16:19], 0 offen lds
    s_mov_b64 exec, -1
    s_branch K2_back_29
K2_a4_28:
    s_lshr_b32 s65, s3, 27
    s_mov_b32 s66, 161536
    s_cmp_ge_u32 s65, 2
    s_cselect_b32 s66, 158112, s66
    s_mul_i32 s65, s65, 512
    s_add_u32 s65, s65, s66
    v_add_u32 v232, s65, v230
    ds_read_b32 v232, v232
    s_add_u32 m0, s65, 864
    s_waitcnt lgkmcnt(0)
    v_or_b32 v232, v232, v231
    buffer_load_dwordx4 v232, s[16:19], 0 offen  lds
    s_branch K2_b4_30
K2_nul_33:
    s_mov_b32 s58, 63
    s_mov_b32 s36, 0
    s_branch K2_back_36
K2_spin_34:
    v_lshl_add_u32 v233, v252, 1, s53
    ds_read_b32 v233, v233
    s_waitcnt lgkmcnt(0)
    s_branch K2_chk_35
K2_dyn_31:
    v_mov_b32 v254, 163648
    v_mov_b32 v255, 1
    v_lshl_add_u32 v233, v252, 1, s53
    s_mov_b64 exec, 1
    ds_add_rtn_u32 v232, v254, v255
    s_mov_b64 exec, -1
    ds_read_b32 v233, v233
    s_waitcnt lgkmcnt(0)
    v_readfirstlane_b32 s58, v232
    s_nop 0
    s_cmp_lt_u32 s58, s22
    s_cbranch_scc0 K2_nul_33
    s_and_b32 s59, s58, 7
    s_lshr_b32 s60, s58, 3
K2_chk_35:
    v_readlane_b32 s61, v233, s59
    s_nop 0
    s_cmp_gt_u32 s61, s60
    s_cbranch_scc0 K2_spin_34
K2_back_36:
    s_mov_b32 s34, 1
    s_branch K2_back_32
K2_rare_37:
    s_cmp_eq_u32 s33, 4
    s_cbranch_scc1 K2_four_39
    s_mov_b32 s49, s48
    s_mov_b32 s51, s48
    s_add_u32 s45, s44, 256
    s_add_u32 s46, s44, 512
    s_add_u32 s47, s44, 768
    s_branch K2_back_38
K2_four_39:
    s_add_u32 s50, s48, 64
    s_lshr_b32 s51, s3, 27
    s_mov_b32 s66, 161536
    s_cmp_ge_u32 s51, 2
    s_cselect_b32 s66, 159072, s66
    s_mul_i32 s51, s51, 32
    s_add_u32 s51, s51, s66
    s_mov_b32 s46, s44
    s_mov_b32 s47, s44
    s_branch K2_back_38
K2_dum_40:
    v_mov_b32 v232, -1
    s_mov_b32 m0, 163712
    s_mov_b64 exec, 1
    buffer_load_dwordx4 v232, s[16:19], 0 offen lds
    buffer_load_dwordx4 v232, s[16:19], 0 offen lds
    s_mov_b64 exec, -1
    s_branch K2_back_42
K2_a4_41:
    s_lshr_b32 s65, s3, 27
    s_mov_b32 s66, 161536
    s_cmp_ge_u32 s65, 2
    s_cselect_b32 s66, 158112, s66
    s_mul_i32 s65, s65, 512
    s_add_u32 s65, s65, s66
    v_add_u32 v232, s65, v230
    ds_read_b32 v232, v232
    s_add_u32 m0, s65, 864
    s_waitcnt lgkmcnt(0)
    v_or_b32 v232, v232, v231
    buffer_load_dwordx4 v232, s[16:19], 0 offen  lds
    s_branch K2_b4_43
K2_nul_44:
    s_mov_b32 s58, 63
    s_mov_b32 s36, 0
    s_branch K2_back_47
K2_spin_45:
    v_lshl_add_u32 v233, v252, 1, s53
    ds_read_b32 v233, v233
    s_waitcnt lgkmcnt(0)
    s_branch K2_chk_46
K2_rare_48:
    s_cmp_eq_u32 s33, 4
    s_cbranch_scc1 K2_four_50
    s_mov_b32 s49, s48
    s_mov_b32 s51, s48
    s_add_u32 s45, s44, 256
    s_add_u32 s46, s44, 512
    s_add_u32 s47, s44, 768
    s_branch K2_back_49
K2_four_50:
    s_add_u32 s50, s48, 64
    s_lshr_b32 s51, s3, 27
    s_mov_b32 s66, 161536
    s_cmp_ge_u32 s51, 2
    s_cselect_b32 s66, 159072, s66
    s_mul_i32 s51, s51, 32
    s_add_u32 s51, s51, s66
    s_mov_b32 s46, s44
    s_mov_b32 s47, s44
    s_branch K2_back_49
K2_nul_51:
    s_mov_b32 s58, 63
    s_mov_b32 s36, 0
    s_branch K2_back_54
K2_spin_52:
    v_lshl_add_u32 v233, v252, 1, s53
    ds_read_b32 v233, v233
    s_waitcnt lgkmcnt(0)
    s_branch K2_chk_53
K2_rare_55:
    s_cmp_eq_u32 s33, 4
    s_cbranch_scc1 K2_four_57
    s_mov_b32 s49, s48
    s_mov_b32 s51, s48
    s_add_u32 s45, s44, 256
    s_add_u32 s46, s44, 512
    s_add_u32 s47, s44, 768
    s_branch K2_back_56
K2_four_57:
    s_add_u32 s50, s48, 64
    s_lshr_b32 s51, s3, 27
    s_mov_b32 s66, 161536
    s_cmp_ge_u32 s51, 2
    s_cselect_b32 s66, 159072, s66
    s_mul_i32 s51, s51, 32
    s_add_u32 s51, s51, s66
    s_mov_b32 s46, s44
    s_mov_b32 s47, s44
    s_branch K2_back_56
K2_nul_60:
    s_mov_b32 s58, 63
    s_mov_b32 s36, 0
    s_branch K2_back_63
K2_spin_61:
    v_lshl_add_u32 v233, v252, 1, s53
    ds_read_b32 v233, v233
    s_waitcnt lgkmcnt(0)
    s_branch K2_chk_62
K2_dyn_58:
    v_mov_b32 v254, 163648
    v_mov_b32 v255, 1
    v_lshl_add_u32 v233, v252, 1, s53
    s_mov_b64 exec, 1
    ds_add_rtn_u32 v232, v254, v255
    s_mov_b64 exec, -1
    ds_read_b32 v233, v233
    s_waitcnt lgkmcnt(0)
    v_readfirstlane_b32 s58, v232
    s_nop 0
    s_cmp_lt_u32 s58, s22
    s_cbranch_scc0 K2_nul_60
    s_and_b32 s59, s58, 7
    s_lshr_b32 s60, s58, 3
K2_chk_62:
    v_readlane_b32 s61, v233, s59
    s_nop 0
    s_cmp_gt_u32 s61, s60
    s_cbranch_scc0 K2_spin_61
K2_back_63:
    s_mov_b32 s34, 1
    s_branch K2_back_59
K2_rare_64:
    s_cmp_eq_u32 s33, 4
    s_cbranch_scc1 K2_four_66
    s_mov_b32 s49, s48
    s_mov_b32 s51, s48
    s_add_u32 s45, s44, 256
    s_add_u32 s46, s44, 512
    s_add_u32 s47, s44, 768
    s_branch K2_back_65
K2_four_66:
    s_add_u32 s50, s48, 64
    s_lshr_b32 s51, s3, 27
    s_mov_b32 s66, 161536
    s_cmp_ge_u32 s51, 2
    s_cselect_b32 s66, 159072, s66
    s_mul_i32 s51, s51, 32
    s_add_u32 s51, s51, s66
    s_mov_b32 s46, s44
    s_mov_b32 s47, s44
    s_branch K2_back_65
K2_dum_67:
    v_mov_b32 v232, -1
    s_mov_b32 m0, 163712
    s_mov_b64 exec, 1
    buffer_load_dwordx4 v232, s[16:19], 0 offen lds
    buffer_load_dwordx4 v232, s[16:19], 0 offen lds
    s_mov_b64 exec, -1
    s_branch K2_back_69
K2_a4_68:
    s_lshr_b32 s65, s3, 27
    s_mov_b32 s66, 161536
    s_cmp_ge_u32 s65, 2
    s_cselect_b32 s66, 158112, s66
    s_mul_i32 s65, s65, 512
    s_add_u32 s65, s65, s66
    v_add_u32 v232, s65, v230
    ds_read_b32 v232, v232
    s_add_u32 m0, s65, 864
    s_waitcnt lgkmcnt(0)
    v_or_b32 v232, v232, v231
    buffer_load_dwordx4 v232, s[16:19], 0 offen  lds
    s_branch K2_b4_70
K2_nul_73:
    s_mov_b32 s58, 63
    s_mov_b32 s36, 0
    s_branch K2_back_76
K2_spin_74:
    v_lshl_add_u32 v233, v252, 1, s53
    ds_read_b32 v233, v233
    s_waitcnt lgkmcnt(0)
    s_branch K2_chk_75
K2_dyn_71:
    v_mov_b32 v254, 163648
    v_mov_b32 v255, 1
    v_lshl_add_u32 v233, v252, 1, s53
    s_mov_b64 exec, 1
    ds_add_rtn_u32 v232, v254, v255
    s_mov_b64 exec, -1
    ds_read_b32 v233, v233
    s_waitcnt lgkmcnt(0)
    v_readfirstlane_b32 s58, v232
    s_nop 0
    s_cmp_lt_u32 s58, s22
    s_cbranch_scc0 K2_nul_73
    s_and_b32 s59, s58, 7
    s_lshr_b32 s60, s58, 3
K2_chk_75:
    v_readlane_b32 s61, v233, s59
    s_nop 0
    s_cmp_gt_u32 s61, s60
    s_cbranch_scc0 K2_spin_74
K2_back_76:
    s_mov_b32 s34, 1
    s_branch K2_back_72
K2_rare_77:
    s_cmp_eq_u32 s33, 4
    s_cbranch_scc1 K2_four_79
    s_mov_b32 s49, s48
    s_mov_b32 s51, s48
    s_add_u32 s45, s44, 256
    s_add_u32 s46, s44, 512
    s_add_u32 s47, s44, 768
    s_branch K2_back_78
K2_four_79:
    s_add_u32 s50, s48, 64
    s_lshr_b32 s51, s3, 27
    s_mov_b32 s66, 161536
    s_cmp_ge_u32 s51, 2
    s_cselect_b32 s66, 159072, s66
    s_mul_i32 s51, s51, 32
    s_add_u32 s51, s51, s66
    s_mov_b32 s46, s44
    s_mov_b32 s47, s44
    s_branch K2_back_78
K2_dum_80:
    v_mov_b32 v232, -1
    s_mov_b32 m0, 163712
    s_mov_b64 exec, 1
    buffer_load_dwordx4 v232, s[16:19], 0 offen lds
    buffer_load_dwordx4 v232, s[16:19], 0 offen lds
    s_mov_b64 exec, -1
    s_branch K2_back_82
K2_a4_81:
    s_lshr_b32 s65, s3, 27
    s_mov_b32 s66, 161536
    s_cmp_ge_u32 s65, 2
    s_cselect_b32 s66, 158112, s66
    s_mul_i32 s65, s65, 512
    s_add_u32 s65, s65, s66
    v_add_u32 v232, s65, v230
    ds_read_b32 v232, v232
    s_add_u32 m0, s65, 864
    s_waitcnt lgkmcnt(0)
    v_or_b32 v232, v232, v231
    buffer_load_dwordx4 v232, s[16:19], 0 offen  lds
    s_branch K2_b4_83
K2_nul_84:
    s_mov_b32 s58, 63
    s_mov_b32 s36, 0
    s_branch K2_back_87
K2_spin_85:
    v_lshl_add_u32 v233, v252, 1, s53
    ds_read_b32 v233, v233
    s_waitcnt lgkmcnt(0)
    s_branch K2_chk_86
K2_rare_88:
    s_cmp_eq_u32 s33, 4
    s_cbranch_scc1 K2_four_90
    s_mov_b32 s49, s48
    s_mov_b32 s51, s48
    s_add_u32 s45, s44, 256
    s_add_u32 s46, s44, 512
    s_add_u32 s47, s44, 768
    s_branch K2_back_89
K2_four_90:
    s_add_u32 s50, s48, 64
    s_lshr_b32 s51, s3, 27
    s_mov_b32 s66, 161536
    s_cmp_ge_u32 s51, 2
    s_cselect_b32 s66, 159072, s66
    s_mul_i32 s51, s51, 32
    s_add_u32 s51, s51, s66
    s_mov_b32 s46, s44
    s_mov_b32 s47, s44
    s_branch K2_back_89
K2_nul_91:
    s_mov_b32 s58, 63
    s_mov_b32 s36, 0
    s_branch K2_back_94
K2_spin_92:
    v_lshl_add_u32 v233, v252, 1, s53
    ds_read_b32 v233, v233
    s_waitcnt lgkmcnt(0)
    s_branch K2_chk_93
K2_rare_95:
    s_cmp_eq_u32 s33, 4
    s_cbranch_scc1 K2_four_97
    s_mov_b32 s49, s48
    s_mov_b32 s51, s48
    s_add_u32 s45, s44, 256
    s_add_u32 s46, s44, 512
    s_add_u32 s47, s44, 768
    s_branch K2_back_96
K2_four_97:
    s_add_u32 s50, s48, 64
    s_lshr_b32 s51, s3, 27
    s_mov_b32 s66, 161536
    s_cmp_ge_u32 s51, 2
    s_cselect_b32 s66, 159072, s66
    s_mul_i32 s51, s51, 32
    s_add_u32 s51, s51, s66
    s_mov_b32 s46, s44
    s_mov_b32 s47, s44
    s_branch K2_back_96
K2_TAIL2:
    v_lshlrev_b32 v229, 3, v252
    s_mul_i32 s58, s20, 20480
    s_add_u32 s58, s58, 6946816
    s_mul_i32 s59, s20, 8224
    buffer_load_dwordx4 v[96:99], v229, s[8:11], s58 offen offset:0 sc1
    buffer_load_dwordx4 v[100:103], v229, s[8:11], s58 offen offset:1024 sc1
    buffer_load_dwordx4 v[104:107], v229, s[8:11], s58 offen offset:2048 sc1
    buffer_load_dwordx4 v[108:111], v229, s[8:11], s58 offen offset:3072 sc1
    s_add_u32 s58, s58, 4096
    buffer_load_dwordx4 v[112:115], v229, s[8:11], s58 offen offset:0 sc1
    buffer_load_dwordx4 v[116:119], v229, s[8:11], s58 offen offset:1024 sc1
    buffer_load_dwordx4 v[120:123], v229, s[8:11], s58 offen offset:2048 sc1
    buffer_load_dwordx4 v[124:127], v229, s[8:11], s58 offen offset:3072 sc1
    s_add_u32 s58, s58, 4096
    v_lshl_add_u32 v228, v252, 1, s59
    v_lshrrev_b32 v226, 6, v252
    v_mul_u32_u24 v226, 126, v226
    v_sub_u32 v226, v228, v226
    s_branch K2_TAIL3
K2_TAIL:
    v_lshlrev_b32 v229, 3, v252
    s_mul_i32 s58, s20, 20480
    s_add_u32 s58, s58, 6946816
    s_mul_i32 s59, s20, 8224
    buffer_load_dwordx4 v[96:99], v229, s[8:11], s58 offen offset:0 sc1
    v_permlane32_swap_b32 v242, v236
    v_permlane32_swap_b32 v243, v237
    buffer_load_dwordx4 v[100:103], v229, s[8:11], s58 offen offset:1024 sc1
    v_permlane32_swap_b32 v244, v238
    v_permlane32_swap_b32 v245, v239
    buffer_load_dwordx4 v[104:107], v229, s[8:11], s58 offen offset:2048 sc1
    v_permlane32_swap_b32 v240, v241
    v_add_f32 v242, v242, v236
    buffer_load_dwordx4 v[108:111], v229, s[8:11], s58 offen offset:3072 sc1
    s_add_u32 s58, s58, 4096
    v_add_f32 v243, v243, v237
    v_add_f32 v244, v244, v238
    buffer_load_dwordx4 v[112:115], v229, s[8:11], s58 offen offset:0 sc1
    v_add_f32 v245, v245, v239
    v_add_f32 v240, -v240, -v241
    buffer_load_dwordx4 v[116:119], v229, s[8:11], s58 offen offset:1024 sc1
    v_sub_u32 v241, v230, v231
    v_cvt_pk_bf16_f32 v242, v242, v243
    buffer_load_dwordx4 v[120:123], v229, s[8:11], s58 offen offset:2048 sc1
    v_cvt_pk_bf16_f32 v244, v244, v245
    v_cvt_pk_bf16_f32 v240, v240, v240
    buffer_load_dwordx4 v[124:127], v229, s[8:11], s58 offen offset:3072 sc1
    s_add_u32 s58, s58, 4096
    ds_write_b32 v230, v242 offset:768
    ds_write_b32 v230, v244 offset:1024
    ds_write_b16 v241, v240 offset:1280
    v_lshl_add_u32 v228, v252, 1, s59
    v_lshrrev_b32 v226, 6, v252
    v_mul_u32_u24 v226, 126, v226
    v_sub_u32 v226, v228, v226
K2_TAIL3:
    s_waitcnt vmcnt(8)
    ds_write_b32 v228, v192 offset:0
    ds_write_b32 v228, v193 offset:256
    ds_write_b32 v228, v194 offset:512
    buffer_load_dwordx4 v[128:131], v229, s[8:11], s58 offen offset:0 sc1
    v_bfe_u32 v48, v252, 1, 4
    v_lshrrev_b32 v49, 5, v252
    ds_write_b32 v228, v195 offset:768
    ds_write_b32 v228, v196 offset:1024
    ds_write_b16 v226, v197 offset:1280
    buffer_load_dwordx4 v[132:135], v229, s[8:11], s58 offen offset:1024 sc1
    v_lshrrev_b32 v55, 3, v48
    v_lshlrev_b32 v52, 4, v49
    ds_write_b32 v228, v198 offset:1536
    ds_write_b32 v228, v199 offset:1792
    ds_write_b32 v228, v200 offset:2048
    buffer_load_dwordx4 v[136:139], v229, s[8:11], s58 offen offset:2048 sc1
    v_lshl_add_u32 v54, v55, 2, v48
    v_and_b32 v54, 7, v54
    ds_write_b32 v228, v201 offset:2304
    ds_write_b32 v228, v202 offset:2560
    ds_write_b16 v226, v203 offset:2816
    buffer_load_dwordx4 v[140:143], v229, s[8:11], s58 offen offset:3072 sc1
    s_add_u32 s58, s58, 4096
    v_and_b32 v50, 7, v48
    v_mul_u32_u24 v50, 8224, v50
    ds_write_b32 v228, v204 offset:3072
    ds_write_b32 v228, v205 offset:3328
    ds_write_b32 v228, v206 offset:3584
    buffer_load_dwordx4 v[144:147], v229, s[8:11], s58 offen offset:0 sc1
    v_mul_u32_u24 v51, 1536, v55
    v_add_u32 v50, v50, v51
    ds_write_b32 v228, v207 offset:3840
    ds_write_b32 v228, v208 offset:4096
    ds_write_b16 v226, v209 offset:4352
    buffer_load_dwordx4 v[148:151], v229, s[8:11], s58 offen offset:1024 sc1
    v_add_u32 v222, v50, v52
    v_mul_u32_u24 v51, 8224, v54
    ds_write_b32 v228, v210 offset:4608
    ds_write_b32 v228, v211 offset:4864
    ds_write_b32 v228, v212 offset:5120
    buffer_load_dwordx4 v[152:155], v229, s[8:11], s58 offen offset:2048 sc1
    v_add_u32 v232, v51, v52
    v_lshl_add_u32 v247, v55, 7, v232
    ds_write_b32 v228, v213 offset:5376
    ds_write_b32 v228, v214 offset:5632
    ds_write_b16 v226, v215 offset:5888
    buffer_load_dwordx4 v[156:159], v229, s[8:11], s58 offen offset:3072 sc1
    s_add_u32 s58, s58, 4096
    v_mul_u32_u24 v53, 192, v48
    v_and_b32 v53, 0xc0, v53
    ds_write_b32 v228, v216 offset:6144
    ds_write_b32 v228, v217 offset:6400
    ds_write_b32 v228, v218 offset:6656
    buffer_load_dwordx4 v[160:163], v229, s[8:11], s58 offen offset:0 sc1
    v_add_u32 v53, v53, v52
    v_mul_u32_u24 v51, 2400, v48
    ds_write_b32 v228, v219 offset:6912
    ds_write_b32 v228, v220 offset:7168
    ds_write_b16 v226, v221 offset:7424
    buffer_load_dwordx4 v[164:167], v229, s[8:11], s58 offen offset:1024 sc1
    s_mov_b32 s60, 65536
    v_add3_u32 v223, v51, v53, s60
    buffer_load_dwordx4 v[168:171], v229, s[8:11], s58 offen offset:2048 sc1
    v_mul_u32_u24 v51, 2400, v54
    s_mov_b32 s60, 142336
    buffer_load_dwordx4 v[172:175], v229, s[8:11], s58 offen offset:3072 sc1
    v_add3_u32 v225, v51, v53, s60
    v_lshl_add_u32 v248, v55, 7, v225
    s_lshl_b32 s60, s20, 5
    v_lshl_add_u32 v49, v49, 3, s60
    s_mov_b32 s60, 65536
    v_add3_u32 v255, v51, v49, s60
    v_lshl_add_u32 v246, v55, 9, v255
    v_bfe_u32 v53, v48, 2, 1
    v_lshl_add_u32 v49, v53, 4, v49
    v_add_u32 v254, v50, v49
    s_and_b32 s64, s55, s28
    s_waitcnt lgkmcnt(0)
    s_barrier
    s_cmp_eq_u32 s64, 0
    s_cbranch_scc1 K2_MULTI
    s_setprio 3
    ds_read_b128 v[48:51], v222 offset:0
    ds_read_b128 v[52:55], v222 offset:64
    ds_read_b128 v[56:59], v222 offset:896
    ds_read_b128 v[60:63], v222 offset:960
    ds_read_b128 v[64:67], v223 offset:0
    ds_read_b128 v[68:71], v223 offset:64
    ds_read_b128 v[72:75], v223 offset:896
    ds_read_b128 v[76:79], v223 offset:960
    ds_read_b128 v[80:83], v222 offset:128
    ds_read_b128 v[84:87], v222 offset:384
    ds_read_b128 v[88:91], v222 offset:256
    s_waitcnt vmcnt(19) lgkmcnt(9)
    v_mfma_f32_16x16x32_bf16 v[0:3], v[96:99], v[48:51], 0
    ds_read_b128 v[92:95], v222 offset:192
    s_waitcnt vmcnt(18)
    v_mfma_f32_16x16x32_bf16 v[0:3], v[100:103], v[52:55], v[0:3]
    ds_read_b128 v[48:51], v222 offset:448
    s_waitcnt vmcnt(17) lgkmcnt(9)
    v_mfma_f32_16x16x32_bf16 v[0:3], v[104:107], v[56:59], v[0:3]
    s_bfe_u32 s60, s20, 0x10002
    s_lshl_b32 s60, s60, 4
    ds_read_b128 v[52:55], v222 offset:320
    s_waitcnt vmcnt(16)
    v_mfma_f32_16x16x32_bf16 v[0:3], v[108:111], v[60:63], v[0:3]
    s_add_u32 s59, s59, s60
    v_add_u32 v228, s59, v229
    ds_read_b128 v[56:59], v222 offset:640
    s_waitcnt vmcnt(15) lgkmcnt(9)
    v_mfma_f32_16x16x32_bf16 v[0:3], v[112:115], v[64:67], v[0:3]
    s_mul_i32 s60, s20, 2400
    s_add_u32 s60, s60, 65536
    ds_read_b128 v[60:63], v222 offset:512
    s_waitcnt vmcnt(14)
    v_mfma_f32_16x16x32_bf16 v[0:3], v[116:119], v[68:71], v[0:3]
    v_add_u32 v249, s60, v229
    s_mov_b32 s63, 0xbfb8aa3b
    ds_read_b128 v[64:67], v222 offset:768
    s_waitcnt vmcnt(13) lgkmcnt(9)
    v_mfma_f32_16x16x32_bf16 v[0:3], v[120:123], v[72:75], v[0:3]
    s_add_u32 s40, s20, s21
    s_lshl_b32 s40, s40, 10
    ds_read_b128 v[68:71], v222 offset:704
    s_waitcnt vmcnt(12)
    v_mfma_f32_16x16x32_bf16 v[0:3], v[124:127], v[76:79], v[0:3]
    s_add_u32 s41, s40, 8192
    s_add_u32 s42, s40, 16384
    ds_read_b128 v[72:75], v222 offset:576
    s_waitcnt vmcnt(11) lgkmcnt(9)
    v_mfma_f32_16x16x32_bf16 v[4:7], v[128:131], v[80:83], 0
    s_add_u32 s43, s40, 24576
    s_add_u32 s44, s40, 32768
    ds_read_b128 v[76:79], v222 offset:832
    v_mfma_f32_16x16x32_bf16 v[8:11], v[128:131], v[84:87], 0
    ds_read_b128 v[80:83], v222 offset:1024
    s_waitcnt lgkmcnt(9)
    v_mfma_f32_16x16x32_bf16 v[12:15], v[128:131], v[88:91], 0
    ds_read_b128 v[84:87], v222 offset:1280
    s_waitcnt vmcnt(10)
    v_mfma_f32_16x16x32_bf16 v[4:7], v[132:135], v[92:95], v[4:7]
    ds_read_b128 v[88:91], v222 offset:1152
    s_waitcnt lgkmcnt(9)
    v_mfma_f32_16x16x32_bf16 v[8:11], v[132:135], v[48:51], v[8:11]
    v_mul_f32 v204, s63, v0
    ds_read_b128 v[92:95], v222 offset:1088
    v_mfma_f32_16x16x32_bf16 v[12:15], v[132:135], v[52:55], v[12:15]
    v_mul_f32 v205, s63, v1
    s_setprio 2
    ds_read_b128 v[48:51], v222 offset:1344
    s_waitcnt vmcnt(9) lgkmcnt(9)
    v_mfma_f32_16x16x32_bf16 v[4:7], v[136:139], v[56:59], v[4:7]
    ds_read_b128 v[52:55], v222 offset:1216
    v_mfma_f32_16x16x32_bf16 v[8:11], v[136:139], v[60:63], v[8:11]
    v_mul_f32 v206, s63, v2
    ds_read_b128 v[56:59], v223 offset:128
    s_waitcnt lgkmcnt(9)
    v_mfma_f32_16x16x32_bf16 v[12:15], v[136:139], v[64:67], v[12:15]
    v_mul_f32 v207, s63, v3
    ds_read_b128 v[60:63], v223 offset:384
    s_waitcnt vmcnt(8)
    v_mfma_f32_16x16x32_bf16 v[4:7], v[140:143], v[68:71], v[4:7]
    ds_read_b128 v[64:67], v223 offset:256
    s_waitcnt lgkmcnt(9)
    v_mfma_f32_16x16x32_bf16 v[8:11], v[140:143], v[72:75], v[8:11]
    v_exp_f32 v204, v204
    ds_read_b128 v[68:71], v223 offset:192
    v_mfma_f32_16x16x32_bf16 v[12:15], v[140:143], v[76:79], v[12:15]
    ds_read_b128 v[72:75], v223 offset:448
    s_waitcnt vmcnt(7) lgkmcnt(9)
    v_mfma_f32_16x16x32_bf16 v[4:7], v[144:147], v[80:83], v[4:7]
    v_exp_f32 v205, v205
    ds_read_b128 v[76:79], v223 offset:320
    v_mfma_f32_16x16x32_bf16 v[8:11], v[144:147], v[84:87], v[8:11]
    v_exp_f32 v206, v206
    ds_read_b128 v[80:83], v223 offset:640
    s_waitcnt lgkmcnt(9)
    v_mfma_f32_16x16x32_bf16 v[12:15], v[144:147], v[88:91], v[12:15]
    ds_read_b128 v[84:87], v223 offset:512
    s_waitcnt vmcnt(6)
    v_mfma_f32_16x16x32_bf16 v[4:7], v[148:151], v[92:95], v[4:7]
    v_exp_f32 v207, v207
    ds_read_b128 v[88:91], v223 offset:768
    s_waitcnt lgkmcnt(9)
    v_mfma_f32_16x16x32_bf16 v[8:11], v[148:151], v[48:51], v[8:11]
    v_add_f32 v204, 1.0, v204
    ds_read_b128 v[92:95], v223 offset:704
    v_mfma_f32_16x16x32_bf16 v[12:15], v[148:151], v[52:55], v[12:15]
    ds_read_b128 v[48:51], v223 offset:576
    s_waitcnt vmcnt(5) lgkmcnt(9)
    v_mfma_f32_16x16x32_bf16 v[4:7], v[152:155], v[56:59], v[4:7]
    v_add_f32 v205, 1.0, v205
    ds_read_b128 v[52:55], v223 offset:832
    v_mfma_f32_16x16x32_bf16 v[8:11], v[152:155], v[60:63], v[8:11]
    s_setprio 1
    ds_read_b128 v[56:59], v223 offset:1024
    s_waitcnt lgkmcnt(9)
    v_mfma_f32_16x16x32_bf16 v[12:15], v[152:155], v[64:67], v[12:15]
    v_add_f32 v206, 1.0, v206
    ds_read_b128 v[60:63], v223 offset:1280
    s_waitcnt vmcnt(4)
    v_mfma_f32_16x16x32_bf16 v[4:7], v[156:159], v[68:71], v[4:7]
    v_add_f32 v207, 1.0, v207
    ds_read_b128 v[64:67], v223 offset:1152
    s_waitcnt lgkmcnt(9)
    v_mfma_f32_16x16x32_bf16 v[8:11], v[156:159], v[72:75], v[8:11]
    ds_read_b128 v[68:71], v223 offset:1088
    v_mfma_f32_16x16x32_bf16 v[12:15], v[156:159], v[76:79], v[12:15]
    v_rcp_f32 v204, v204
    ds_read_b128 v[72:75], v223 offset:1344
    s_waitcnt vmcnt(3) lgkmcnt(9)
    v_mfma_f32_16x16x32_bf16 v[4:7], v[160:163], v[80:83], v[4:7]
    v_rcp_f32 v205, v205
    ds_read_b128 v[76:79], v223 offset:1216
    v_mfma_f32_16x16x32_bf16 v[8:11], v[160:163], v[84:87], v[8:11]
    ds_read_b128 v[80:83], v222 offset:3072
    s_waitcnt lgkmcnt(9)
    v_mfma_f32_16x16x32_bf16 v[12:15], v[160:163], v[88:91], v[12:15]
    v_rcp_f32 v206, v206
    ds_read_b128 v[84:87], v222 offset:3136
    s_waitcnt vmcnt(2)
    v_mfma_f32_16x16x32_bf16 v[4:7], v[164:167], v[92:95], v[4:7]
    ds_read_b128 v[88:91], v222 offset:3968
    s_waitcnt lgkmcnt(9)
    v_mfma_f32_16x16x32_bf16 v[8:11], v[164:167], v[48:51], v[8:11]
    v_rcp_f32 v207, v207
    ds_read_b128 v[92:95], v222 offset:4032
    v_mfma_f32_16x16x32_bf16 v[12:15], v[164:167], v[52:55], v[12:15]
    v_cvt_pk_bf16_f32 v176, v0, v1
    ds_read_b128 v[48:51], v223 offset:38400
    s_waitcnt vmcnt(1) lgkmcnt(9)
    v_mfma_f32_16x16x32_bf16 v[4:7], v[168:171], v[56:59], v[4:7]
    ds_read_b128 v[52:55], v223 offset:38464
    v_mfma_f32_16x16x32_bf16 v[8:11], v[168:171], v[60:63], v[8:11]
    v_cvt_pk_bf16_f32 v177, v2, v3
    s_setprio 0
    ds_read_b128 v[56:59], v223 offset:39296
    s_waitcnt lgkmcnt(9)
    v_mfma_f32_16x16x32_bf16 v[12:15], v[168:171], v[64:67], v[12:15]
    ds_read_b128 v[60:63], v223 offset:39360
    s_waitcnt vmcnt(0)
    v_mfma_f32_16x16x32_bf16 v[4:7], v[172:175], v[68:71], v[4:7]
    ds_read_b128 v[64:67], v222 offset:3200
    s_waitcnt lgkmcnt(9)
    v_mfma_f32_16x16x32_bf16 v[8:11], v[172:175], v[72:75], v[8:11]
    ds_read_b128 v[68:71], v222 offset:3456
    v_mfma_f32_16x16x32_bf16 v[12:15], v[172:175], v[76:79], v[12:15]
    ds_read_b128 v[72:75], v222 offset:3328
    s_waitcnt lgkmcnt(9)
    v_mfma_f32_16x16x32_bf16 v[16:19], v[96:99], v[80:83], 0
    ds_read_b128 v[76:79], v222 offset:3264
    v_mfma_f32_16x16x32_bf16 v[16:19], v[100:103], v[84:87], v[16:19]
    ds_read_b128 v[80:83], v222 offset:3520
    s_waitcnt lgkmcnt(9)
    v_mfma_f32_16x16x32_bf16 v[16:19], v[104:107], v[88:91], v[16:19]
    s_barrier
    s_setprio 3
    ds_read_b128 v[84:87], v222 offset:3392
    v_mfma_f32_16x16x32_bf16 v[16:19], v[108:111], v[92:95], v[16:19]
    v_mul_f32 v4, v4, v204
    ds_read_b128 v[88:91], v222 offset:3712
    s_waitcnt lgkmcnt(9)
    v_mfma_f32_16x16x32_bf16 v[16:19], v[112:115], v[48:51], v[16:19]
    v_mul_f32 v5, v5, v205
    ds_read_b128 v[92:95], v222 offset:3584
    v_mfma_f32_16x16x32_bf16 v[16:19], v[116:119], v[52:55], v[16:19]
    v_mul_f32 v6, v6, v206
    ds_read_b128 v[48:51], v222 offset:3840
    s_waitcnt lgkmcnt(9)
    v_mfma_f32_16x16x32_bf16 v[16:19], v[120:123], v[56:59], v[16:19]
    v_mul_f32 v7, v7, v207
    ds_read_b128 v[52:55], v222 offset:3776
    v_mfma_f32_16x16x32_bf16 v[16:19], v[124:127], v[60:63], v[16:19]
    v_cvt_pk_bf16_f32 v178, v4, v5
    ds_read_b128 v[56:59], v222 offset:3648
    s_waitcnt lgkmcnt(9)
    v_mfma_f32_16x16x32_bf16 v[20:23], v[128:131], v[64:67], 0
    v_cvt_pk_bf16_f32 v179, v6, v7
    ds_read_b128 v[60:63], v222 offset:3904
    v_mfma_f32_16x16x32_bf16 v[24:27], v[128:131], v[68:71], 0
    v_mul_f32 v8, v8, v204
    ds_read_b128 v[64:67], v222 offset:4096
    s_waitcnt lgkmcnt(9)
    v_mfma_f32_16x16x32_bf16 v[28:31], v[128:131], v[72:75], 0
    v_mul_f32 v9, v9, v205
    ds_read_b128 v[68:71], v222 offset:4352
    v_mfma_f32_16x16x32_bf16 v[20:23], v[132:135], v[76:79], v[20:23]
    v_mul_f32 v10, v10, v206
    ds_read_b128 v[72:75], v222 offset:4224
    s_waitcnt lgkmcnt(9)
    v_mfma_f32_16x16x32_bf16 v[24:27], v[132:135], v[80:83], v[24:27]
    v_mul_f32 v11, v11, v207
    ds_read_b128 v[76:79], v222 offset:4160
    v_mfma_f32_16x16x32_bf16 v[28:31], v[132:135], v[84:87], v[28:31]
    v_cvt_pk_bf16_f32 v180, v8, v9
    ds_read_b128 v[80:83], v222 offset:4416
    s_waitcnt lgkmcnt(9)
    v_mfma_f32_16x16x32_bf16 v[20:23], v[136:139], v[88:91], v[20:23]
    v_cvt_pk_bf16_f32 v181, v10, v11
    ds_read_b128 v[84:87], v222 offset:4288
    v_mfma_f32_16x16x32_bf16 v[24:27], v[136:139], v[92:95], v[24:27]
    v_mul_f32 v12, v12, v204
    s_setprio 2
    ds_read_b128 v[88:91], v223 offset:38528
    s_waitcnt lgkmcnt(9)
    v_mfma_f32_16x16x32_bf16 v[28:31], v[136:139], v[48:51], v[28:31]
    v_mul_f32 v13, v13, v205
    ds_read_b128 v[92:95], v223 offset:38784
    v_mfma_f32_16x16x32_bf16 v[20:23], v[140:143], v[52:55], v[20:23]
    v_mul_f32 v14, v14, v206
    ds_read_b128 v[48:51], v223 offset:38656
    s_waitcnt lgkmcnt(9)
    v_mfma_f32_16x16x32_bf16 v[24:27], v[140:143], v[56:59], v[24:27]
    v_mul_f32 v15, v15, v207
    ds_read_b128 v[52:55], v223 offset:38592
    v_mfma_f32_16x16x32_bf16 v[28:31], v[140:143], v[60:63], v[28:31]
    v_cvt_pk_bf16_f32 v182, v12, v13
    ds_read_b128 v[56:59], v223 offset:38848
    s_waitcnt lgkmcnt(9)
    v_mfma_f32_16x16x32_bf16 v[20:23], v[144:147], v[64:67], v[20:23]
    v_cvt_pk_bf16_f32 v183, v14, v15
    ds_read_b128 v[60:63], v223 offset:38720
    v_mfma_f32_16x16x32_bf16 v[24:27], v[144:147], v[68:71], v[24:27]
    ds_write_b64 v254, v[176:177] offset:0
    ds_write_b64 v254, v[178:179] offset:256
    ds_write_b64 v254, v[180:181] offset:512
    ds_write_b64 v254, v[182:183] offset:768
    ds_read_b128 v[64:67], v223 offset:39040
    s_waitcnt lgkmcnt(13)
    v_mfma_f32_16x16x32_bf16 v[28:31], v[144:147], v[72:75], v[28:31]
    v_mul_f32 v208, s63, v16
    ds_read_b128 v[68:71], v223 offset:38912
    v_mfma_f32_16x16x32_bf16 v[20:23], v[148:151], v[76:79], v[20:23]
    v_mul_f32 v209, s63, v17
    ds_read_b128 v[72:75], v223 offset:39168
    s_waitcnt lgkmcnt(13)
    v_mfma_f32_16x16x32_bf16 v[24:27], v[148:151], v[80:83], v[24:27]
    v_mul_f32 v210, s63, v18
    ds_read_b128 v[76:79], v223 offset:39104
    v_mfma_f32_16x16x32_bf16 v[28:31], v[148:151], v[84:87], v[28:31]
    v_mul_f32 v211, s63, v19
    ds_read_b128 v[80:83], v223 offset:38976
    s_waitcnt lgkmcnt(13)
    v_mfma_f32_16x16x32_bf16 v[20:23], v[152:155], v[88:91], v[20:23]
    v_exp_f32 v208, v208
    ds_read_b128 v[84:87], v223 offset:39232
    v_mfma_f32_16x16x32_bf16 v[24:27], v[152:155], v[92:95], v[24:27]
    v_exp_f32 v209, v209
    ds_read_b128 v[88:91], v223 offset:39424
    s_waitcnt lgkmcnt(13)
    v_mfma_f32_16x16x32_bf16 v[28:31], v[152:155], v[48:51], v[28:31]
    s_setprio 1
    ds_read_b128 v[92:95], v223 offset:39680
    v_mfma_f32_16x16x32_bf16 v[20:23], v[156:159], v[52:55], v[20:23]
    v_exp_f32 v210, v210
    ds_read_b128 v[48:51], v223 offset:39552
    s_waitcnt lgkmcnt(13)
    v_mfma_f32_16x16x32_bf16 v[24:27], v[156:159], v[56:59], v[24:27]
    v_exp_f32 v211, v211
    ds_read_b128 v[52:55], v223 offset:39488
    v_mfma_f32_16x16x32_bf16 v[28:31], v[156:159], v[60:63], v[28:31]
    v_add_f32 v208, 1.0, v208
    ds_read_b128 v[56:59], v223 offset:39744
    s_waitcnt lgkmcnt(9)
    v_mfma_f32_16x16x32_bf16 v[20:23], v[160:163], v[64:67], v[20:23]
    v_add_f32 v209, 1.0, v209
    ds_read_b128 v[60:63], v223 offset:39616
    v_mfma_f32_16x16x32_bf16 v[24:27], v[160:163], v[68:71], v[24:27]
    v_add_f32 v210, 1.0, v210
    ds_read_b128 v[64:67], v232 offset:6144
    s_waitcnt lgkmcnt(9)
    v_mfma_f32_16x16x32_bf16 v[28:31], v[160:163], v[72:75], v[28:31]
    v_add_f32 v211, 1.0, v211
    ds_read_b128 v[68:71], v232 offset:6208
    v_mfma_f32_16x16x32_bf16 v[20:23], v[164:167], v[76:79], v[20:23]
    ds_read_b128 v[72:75], v232 offset:7040
    s_waitcnt lgkmcnt(9)
    v_mfma_f32_16x16x32_bf16 v[24:27], v[164:167], v[80:83], v[24:27]
    v_rcp_f32 v208, v208
    ds_read_b128 v[76:79], v232 offset:7104
    v_mfma_f32_16x16x32_bf16 v[28:31], v[164:167], v[84:87], v[28:31]
    v_rcp_f32 v209, v209
    ds_read_b128 v[80:83], v225 offset:0
    s_waitcnt lgkmcnt(9)
    v_mfma_f32_16x16x32_bf16 v[20:23], v[168:171], v[88:91], v[20:23]
    v_rcp_f32 v210, v210
    ds_read_b128 v[84:87], v225 offset:64
    v_mfma_f32_16x16x32_bf16 v[24:27], v[168:171], v[92:95], v[24:27]
    v_rcp_f32 v211, v211
    ds_read_b128 v[88:91], v225 offset:896
    s_waitcnt lgkmcnt(9)
    v_mfma_f32_16x16x32_bf16 v[28:31], v[168:171], v[48:51], v[28:31]
    v_cvt_pk_bf16_f32 v184, v16, v17
    s_setprio 0
    ds_read_b128 v[92:95], v225 offset:960
    v_mfma_f32_16x16x32_bf16 v[20:23], v[172:175], v[52:55], v[20:23]
    v_cvt_pk_bf16_f32 v185, v18, v19
    ds_read_b128 v[48:51], v247 offset:6272
    s_waitcnt lgkmcnt(9)
    v_mfma_f32_16x16x32_bf16 v[24:27], v[172:175], v[56:59], v[24:27]
    ds_read_b128 v[52:55], v232 offset:6528
    v_mfma_f32_16x16x32_bf16 v[28:31], v[172:175], v[60:63], v[28:31]
    ds_read_b128 v[56:59], v247 offset:6336
    s_waitcnt lgkmcnt(9)
    v_mfma_f32_16x16x32_bf16 v[32:35], v[96:99], v[64:67], 0
    ds_read_b128 v[60:63], v232 offset:6592
    v_mfma_f32_16x16x32_bf16 v[32:35], v[100:103], v[68:71], v[32:35]
    ds_read_b128 v[64:67], v247 offset:6784
    s_waitcnt lgkmcnt(9)
    v_mfma_f32_16x16x32_bf16 v[32:35], v[104:107], v[72:75], v[32:35]
    s_barrier
    ds_read_b128 v[192:195], v228 offset:0
    ds_read_b128 v[196:199], v228 offset:1536
    s_setprio 3
    ds_read_b128 v[68:71], v232 offset:6656
    v_mfma_f32_16x16x32_bf16 v[32:35], v[108:111], v[76:79], v[32:35]
    v_mul_f32 v20, v20, v208
    ds_read_b128 v[72:75], v247 offset:6848
    s_waitcnt lgkmcnt(11)
    v_mfma_f32_16x16x32_bf16 v[32:35], v[112:115], v[80:83], v[32:35]
    v_mul_f32 v21, v21, v209
    ds_read_b128 v[76:79], v232 offset:6720
    v_mfma_f32_16x16x32_bf16 v[32:35], v[116:119], v[84:87], v[32:35]
    v_mul_f32 v22, v22, v210
    ds_read_b128 v[80:83], v247 offset:7168
    s_waitcnt lgkmcnt(11)
    v_mfma_f32_16x16x32_bf16 v[32:35], v[120:123], v[88:91], v[32:35]
    v_mul_f32 v23, v23, v211
    ds_read_b128 v[84:87], v232 offset:7424
    v_mfma_f32_16x16x32_bf16 v[32:35], v[124:127], v[92:95], v[32:35]
    v_cvt_pk_bf16_f32 v186, v20, v21
    ds_read_b128 v[88:91], v247 offset:7232
    s_waitcnt lgkmcnt(11)
    v_mfma_f32_16x16x32_bf16 v[36:39], v[128:131], v[48:51], 0
    v_cvt_pk_bf16_f32 v187, v22, v23
    ds_read_b128 v[92:95], v232 offset:7488
    v_mfma_f32_16x16x32_bf16 v[40:43], v[128:131], v[52:55], 0
    v_mul_f32 v24, v24, v208
    ds_read_b128 v[48:51], v248 offset:128
    s_waitcnt lgkmcnt(11)
    v_mfma_f32_16x16x32_bf16 v[36:39], v[132:135], v[56:59], v[36:39]
    v_mul_f32 v25, v25, v209
    s_waitcnt lgkmcnt(8)
    buffer_store_dwordx4 v[192:195], v229, s[12:15], s40 offen sc1
    buffer_store_dwordx4 v[196:199], v229, s[12:15], s41 offen sc1
    ds_read_b128 v[52:55], v225 offset:384
    v_mfma_f32_16x16x32_bf16 v[40:43], v[132:135], v[60:63], v[40:43]
    v_mul_f32 v26, v26, v210
    s_setprio 2
    ds_read_b128 v[56:59], v248 offset:192
    s_waitcnt lgkmcnt(9)
    v_mfma_f32_16x16x32_bf16 v[36:39], v[136:139], v[64:67], v[36:39]
    v_mul_f32 v27, v27, v211
    v_mul_f32 v204, s63, v32
    ds_read_b128 v[60:63], v225 offset:448
    v_mfma_f32_16x16x32_bf16 v[40:43], v[136:139], v[68:71], v[40:43]
    v_cvt_pk_bf16_f32 v188, v24, v25
    v_mul_f32 v205, s63, v33
    ds_read_b128 v[64:67], v248 offset:640
    s_waitcnt lgkmcnt(9)
    v_mfma_f32_16x16x32_bf16 v[36:39], v[140:143], v[72:75], v[36:39]
    v_cvt_pk_bf16_f32 v189, v26, v27
    v_mul_f32 v206, s63, v34
    ds_read_b128 v[68:71], v225 offset:512
    v_mfma_f32_16x16x32_bf16 v[40:43], v[140:143], v[76:79], v[40:43]
    v_mul_f32 v28, v28, v208
    v_mul_f32 v207, s63, v35
    ds_read_b128 v[72:75], v248 offset:704
    s_waitcnt lgkmcnt(9)
    v_mfma_f32_16x16x32_bf16 v[36:39], v[144:147], v[80:83], v[36:39]
    v_mul_f32 v29, v29, v209
    v_exp_f32 v204, v204
    ds_read_b128 v[76:79], v225 offset:576
    v_mfma_f32_16x16x32_bf16 v[40:43], v[144:147], v[84:87], v[40:43]
    v_mul_f32 v30, v30, v210
    v_exp_f32 v205, v205
    ds_read_b128 v[80:83], v248 offset:1024
    s_waitcnt lgkmcnt(9)
    v_mfma_f32_16x16x32_bf16 v[36:39], v[148:151], v[88:91], v[36:39]
    v_mul_f32 v31, v31, v211
    v_exp_f32 v206, v206
    ds_read_b128 v[84:87], v225 offset:1280
    v_mfma_f32_16x16x32_bf16 v[40:43], v[148:151], v[92:95], v[40:43]
    v_cvt_pk_bf16_f32 v190, v28, v29
    v_exp_f32 v207, v207
    ds_read_b128 v[88:91], v248 offset:1088
    s_waitcnt lgkmcnt(9)
    v_mfma_f32_16x16x32_bf16 v[36:39], v[152:155], v[48:51], v[36:39]
    v_cvt_pk_bf16_f32 v191, v30, v31
    v_add_f32 v204, 1.0, v204
    s_setprio 1
    ds_read_b128 v[92:95], v225 offset:1344
    v_mfma_f32_16x16x32_bf16 v[40:43], v[152:155], v[52:55], v[40:43]
    ds_write_b64 v254, v[184:185] offset:3072
    ds_write_b64 v254, v[186:187] offset:3328
    ds_write_b64 v254, v[188:189] offset:3584
    ds_write_b64 v254, v[190:191] offset:3840
    v_add_f32 v205, 1.0, v205
    s_waitcnt lgkmcnt(12)
    v_mfma_f32_16x16x32_bf16 v[36:39], v[156:159], v[56:59], v[36:39]
    v_add_f32 v206, 1.0, v206
    v_mfma_f32_16x16x32_bf16 v[40:43], v[156:159], v[60:63], v[40:43]
    v_add_f32 v207, 1.0, v207
    s_waitcnt lgkmcnt(10)
    v_mfma_f32_16x16x32_bf16 v[36:39], v[160:163], v[64:67], v[36:39]
    v_rcp_f32 v204, v204
    v_mfma_f32_16x16x32_bf16 v[40:43], v[160:163], v[68:71], v[40:43]
    v_rcp_f32 v205, v205
    s_waitcnt lgkmcnt(8)
    v_mfma_f32_16x16x32_bf16 v[36:39], v[164:167], v[72:75], v[36:39]
    v_rcp_f32 v206, v206
    v_mfma_f32_16x16x32_bf16 v[40:43], v[164:167], v[76:79], v[40:43]
    v_rcp_f32 v207, v207
    s_waitcnt lgkmcnt(6)
    v_mfma_f32_16x16x32_bf16 v[36:39], v[168:171], v[80:83], v[36:39]
    v_cvt_pk_bf16_f32 v176, v32, v33
    s_setprio 0
    v_mfma_f32_16x16x32_bf16 v[40:43], v[168:171], v[84:87], v[40:43]
    v_cvt_pk_bf16_f32 v177, v34, v35
    s_waitcnt lgkmcnt(4)
    v_mfma_f32_16x16x32_bf16 v[36:39], v[172:175], v[88:91], v[36:39]
    ds_write_b64 v255, v[176:177] offset:0
    v_mfma_f32_16x16x32_bf16 v[40:43], v[172:175], v[92:95], v[40:43]
    s_nop 5
    v_mul_f32 v36, v36, v204
    v_mul_f32 v37, v37, v205
    v_mul_f32 v38, v38, v206
    v_mul_f32 v39, v39, v207
    v_cvt_pk_bf16_f32 v178, v36, v37
    v_cvt_pk_bf16_f32 v179, v38, v39
    v_mul_f32 v40, v40, v204
    v_mul_f32 v41, v41, v205
    v_mul_f32 v42, v42, v206
    v_mul_f32 v43, v43, v207
    v_cvt_pk_bf16_f32 v180, v40, v41
    v_cvt_pk_bf16_f32 v181, v42, v43
    ds_write_b64 v246, v[178:179] offset:256
    ds_write_b64 v255, v[180:181] offset:512
    s_waitcnt lgkmcnt(0)
    s_barrier
    ds_read_b128 v[192:195], v228 offset:3072
    ds_read_b128 v[196:199], v228 offset:4608
    ds_read_b128 v[200:203], v249
    s_waitcnt lgkmcnt(1)
    buffer_store_dwordx4 v[192:195], v229, s[12:15], s42 offen sc1
    buffer_store_dwordx4 v[196:199], v229, s[12:15], s43 offen sc1
K2_LASTROW:
    s_add_u32 s59, s20, 32
    s_cmp_ge_u32 s59, s22
    s_cbranch_scc1 K2_FIN
    s_waitcnt lgkmcnt(0)
    buffer_store_dwordx4 v[200:203], v229, s[12:15], s44 offen sc1
K2_FIN:
    s_branch K2_END
K2_MULTI:
    ds_read_b128 v[48:51], v222 offset:0
    ds_read_b128 v[52:55], v222 offset:64
    ds_read_b128 v[56:59], v222 offset:896
    ds_read_b128 v[60:63], v222 offset:960
    ds_read_b128 v[64:67], v223 offset:0
    ds_read_b128 v[68:71], v223 offset:64
    ds_read_b128 v[72:75], v223 offset:896
    ds_read_b128 v[76:79], v223 offset:960
    ds_read_b128 v[80:83], v222 offset:128
    ds_read_b128 v[84:87], v222 offset:384
    ds_read_b128 v[88:91], v222 offset:256
    s_waitcnt vmcnt(19) lgkmcnt(9)
    v_mfma_f32_16x16x32_bf16 v[0:3], v[96:99], v[48:51], 0
    ds_read_b128 v[92:95], v222 offset:192
    s_waitcnt vmcnt(18)
    v_mfma_f32_16x16x32_bf16 v[0:3], v[100:103], v[52:55], v[0:3]
    ds_read_b128 v[48:51], v222 offset:448
    s_waitcnt vmcnt(17) lgkmcnt(9)
    v_mfma_f32_16x16x32_bf16 v[0:3], v[104:107], v[56:59], v[0:3]
    ds_read_b128 v[52:55], v222 offset:320
    s_waitcnt vmcnt(16)
    v_mfma_f32_16x16x32_bf16 v[0:3], v[108:111], v[60:63], v[0:3]
    ds_read_b128 v[56:59], v222 offset:640
    s_waitcnt vmcnt(15) lgkmcnt(9)
    v_mfma_f32_16x16x32_bf16 v[0:3], v[112:115], v[64:67], v[0:3]
    ds_read_b128 v[60:63], v222 offset:512
    s_waitcnt vmcnt(14)
    v_mfma_f32_16x16x32_bf16 v[0:3], v[116:119], v[68:71], v[0:3]
    ds_read_b128 v[64:67], v222 offset:768
    s_waitcnt vmcnt(13) lgkmcnt(9)
    v_mfma_f32_16x16x32_bf16 v[0:3], v[120:123], v[72:75], v[0:3]
    ds_read_b128 v[68:71], v222 offset:704
    s_waitcnt vmcnt(12)
    v_mfma_f32_16x16x32_bf16 v[0:3], v[124:127], v[76:79], v[0:3]
    ds_read_b128 v[72:75], v222 offset:576
    s_waitcnt vmcnt(11) lgkmcnt(9)
    v_mfma_f32_16x16x32_bf16 v[4:7], v[128:131], v[80:83], 0
    ds_read_b128 v[76:79], v222 offset:832
    v_mfma_f32_16x16x32_bf16 v[8:11], v[128:131], v[84:87], 0
    ds_read_b128 v[80:83], v222 offset:1024
    s_waitcnt lgkmcnt(9)
    v_mfma_f32_16x16x32_bf16 v[12:15], v[128:131], v[88:91], 0
    ds_read_b128 v[84:87], v222 offset:1280
    s_waitcnt vmcnt(10)
    v_mfma_f32_16x16x32_bf16 v[4:7], v[132:135], v[92:95], v[4:7]
    ds_read_b128 v[88:91], v222 offset:1152
    s_waitcnt lgkmcnt(9)
    v_mfma_f32_16x16x32_bf16 v[8:11], v[132:135], v[48:51], v[8:11]
    ds_read_b128 v[92:95], v222 offset:1088
    v_mfma_f32_16x16x32_bf16 v[12:15], v[132:135], v[52:55], v[12:15]
    ds_read_b128 v[48:51], v222 offset:1344
    s_waitcnt vmcnt(9) lgkmcnt(9)
    v_mfma_f32_16x16x32_bf16 v[4:7], v[136:139], v[56:59], v[4:7]
    ds_read_b128 v[52:55], v222 offset:1216
    v_mfma_f32_16x16x32_bf16 v[8:11], v[136:139], v[60:63], v[8:11]
    ds_read_b128 v[56:59], v223 offset:128
    s_waitcnt lgkmcnt(9)
    v_mfma_f32_16x16x32_bf16 v[12:15], v[136:139], v[64:67], v[12:15]
    ds_read_b128 v[60:63], v223 offset:384
    s_waitcnt vmcnt(8)
    v_mfma_f32_16x16x32_bf16 v[4:7], v[140:143], v[68:71], v[4:7]
    ds_read_b128 v[64:67], v223 offset:256
    s_waitcnt lgkmcnt(9)
    v_mfma_f32_16x16x32_bf16 v[8:11], v[140:143], v[72:75], v[8:11]
    ds_read_b128 v[68:71], v223 offset:192
    v_mfma_f32_16x16x32_bf16 v[12:15], v[140:143], v[76:79], v[12:15]
    ds_read_b128 v[72:75], v223 offset:448
    s_waitcnt vmcnt(7) lgkmcnt(9)
    v_mfma_f32_16x16x32_bf16 v[4:7], v[144:147], v[80:83], v[4:7]
    ds_read_b128 v[76:79], v223 offset:320
    v_mfma_f32_16x16x32_bf16 v[8:11], v[144:147], v[84:87], v[8:11]
    ds_read_b128 v[80:83], v223 offset:640
    s_waitcnt lgkmcnt(9)
    v_mfma_f32_16x16x32_bf16 v[12:15], v[144:147], v[88:91], v[12:15]
    ds_read_b128 v[84:87], v223 offset:512
    s_waitcnt vmcnt(6)
    v_mfma_f32_16x16x32_bf16 v[4:7], v[148:151], v[92:95], v[4:7]
    ds_read_b128 v[88:91], v223 offset:768
    s_waitcnt lgkmcnt(9)
    v_mfma_f32_16x16x32_bf16 v[8:11], v[148:151], v[48:51], v[8:11]
    ds_read_b128 v[92:95], v223 offset:704
    v_mfma_f32_16x16x32_bf16 v[12:15], v[148:151], v[52:55], v[12:15]
    ds_read_b128 v[48:51], v223 offset:576
    s_waitcnt vmcnt(5) lgkmcnt(9)
    v_mfma_f32_16x16x32_bf16 v[4:7], v[152:155], v[56:59], v[4:7]
    ds_read_b128 v[52:55], v223 offset:832
    v_mfma_f32_16x16x32_bf16 v[8:11], v[152:155], v[60:63], v[8:11]
    ds_read_b128 v[56:59], v223 offset:1024
    s_waitcnt lgkmcnt(9)
    v_mfma_f32_16x16x32_bf16 v[12:15], v[152:155], v[64:67], v[12:15]
    ds_read_b128 v[60:63], v223 offset:1280
    s_waitcnt vmcnt(4)
    v_mfma_f32_16x16x32_bf16 v[4:7], v[156:159], v[68:71], v[4:7]
    ds_read_b128 v[64:67], v223 offset:1152
    s_waitcnt lgkmcnt(9)
    v_mfma_f32_16x16x32_bf16 v[8:11], v[156:159], v[72:75], v[8:11]
    ds_read_b128 v[68:71], v223 offset:1088
    v_mfma_f32_16x16x32_bf16 v[12:15], v[156:159], v[76:79], v[12:15]
    ds_read_b128 v[72:75], v223 offset:1344
    s_waitcnt vmcnt(3) lgkmcnt(9)
    v_mfma_f32_16x16x32_bf16 v[4:7], v[160:163], v[80:83], v[4:7]
    ds_read_b128 v[76:79], v223 offset:1216
    v_mfma_f32_16x16x32_bf16 v[8:11], v[160:163], v[84:87], v[8:11]
    ds_read_b128 v[80:83], v222 offset:3072
    s_waitcnt lgkmcnt(9)
    v_mfma_f32_16x16x32_bf16 v[12:15], v[160:163], v[88:91], v[12:15]
    ds_read_b128 v[84:87], v222 offset:3136
    s_waitcnt vmcnt(2)
    v_mfma_f32_16x16x32_bf16 v[4:7], v[164:167], v[92:95], v[4:7]
    ds_read_b128 v[88:91], v222 offset:3968
    s_waitcnt lgkmcnt(9)
    v_mfma_f32_16x16x32_bf16 v[8:11], v[164:167], v[48:51], v[8:11]
    ds_read_b128 v[92:95], v222 offset:4032
    v_mfma_f32_16x16x32_bf16 v[12:15], v[164:167], v[52:55], v[12:15]
    ds_read_b128 v[48:51], v223 offset:38400
    s_waitcnt vmcnt(1) lgkmcnt(9)
    v_mfma_f32_16x16x32_bf16 v[4:7], v[168:171], v[56:59], v[4:7]
    ds_read_b128 v[52:55], v223 offset:38464
    v_mfma_f32_16x16x32_bf16 v[8:11], v[168:171], v[60:63], v[8:11]
    ds_read_b128 v[56:59], v223 offset:39296
    s_waitcnt lgkmcnt(9)
    v_mfma_f32_16x16x32_bf16 v[12:15], v[168:171], v[64:67], v[12:15]
    ds_read_b128 v[60:63], v223 offset:39360
    s_waitcnt vmcnt(0)
    v_mfma_f32_16x16x32_bf16 v[4:7], v[172:175], v[68:71], v[4:7]
    ds_read_b128 v[64:67], v222 offset:3200
    s_waitcnt lgkmcnt(9)
    v_mfma_f32_16x16x32_bf16 v[8:11], v[172:175], v[72:75], v[8:11]
    ds_read_b128 v[68:71], v222 offset:3456
    v_mfma_f32_16x16x32_bf16 v[12:15], v[172:175], v[76:79], v[12:15]
    ds_read_b128 v[72:75], v222 offset:3328
    s_waitcnt lgkmcnt(9)
    v_mfma_f32_16x16x32_bf16 v[16:19], v[96:99], v[80:83], 0
    ds_read_b128 v[76:79], v222 offset:3264
    v_mfma_f32_16x16x32_bf16 v[16:19], v[100:103], v[84:87], v[16:19]
    ds_read_b128 v[80:83], v222 offset:3520
    s_waitcnt lgkmcnt(9)
    v_mfma_f32_16x16x32_bf16 v[16:19], v[104:107], v[88:91], v[16:19]
    ds_read_b128 v[84:87], v222 offset:3392
    v_mfma_f32_16x16x32_bf16 v[16:19], v[108:111], v[92:95], v[16:19]
    ds_read_b128 v[88:91], v222 offset:3712
    s_waitcnt lgkmcnt(9)
    v_mfma_f32_16x16x32_bf16 v[16:19], v[112:115], v[48:51], v[16:19]
    ds_read_b128 v[92:95], v222 offset:3584
    v_mfma_f32_16x16x32_bf16 v[16:19], v[116:119], v[52:55], v[16:19]
    ds_read_b128 v[48:51], v222 offset:3840
    s_waitcnt lgkmcnt(9)
    v_mfma_f32_16x16x32_bf16 v[16:19], v[120:123], v[56:59], v[16:19]
    ds_read_b128 v[52:55], v222 offset:3776
    v_mfma_f32_16x16x32_bf16 v[16:19], v[124:127], v[60:63], v[16:19]
    ds_read_b128 v[56:59], v222 offset:3648
    s_waitcnt lgkmcnt(9)
    v_mfma_f32_16x16x32_bf16 v[20:23], v[128:131], v[64:67], 0
    ds_read_b128 v[60:63], v222 offset:3904
    v_mfma_f32_16x16x32_bf16 v[24:27], v[128:131], v[68:71], 0
    ds_read_b128 v[64:67], v222 offset:4096
    s_waitcnt lgkmcnt(9)
    v_mfma_f32_16x16x32_bf16 v[28:31], v[128:131], v[72:75], 0
    ds_read_b128 v[68:71], v222 offset:4352
    v_mfma_f32_16x16x32_bf16 v[20:23], v[132:135], v[76:79], v[20:23]
    ds_read_b128 v[72:75], v222 offset:4224
    s_waitcnt lgkmcnt(9)
    v_mfma_f32_16x16x32_bf16 v[24:27], v[132:135], v[80:83], v[24:27]
    ds_read_b128 v[76:79], v222 offset:4160
    v_mfma_f32_16x16x32_bf16 v[28:31], v[132:135], v[84:87], v[28:31]
    ds_read_b128 v[80:83], v222 offset:4416
    s_waitcnt lgkmcnt(9)
    v_mfma_f32_16x16x32_bf16 v[20:23], v[136:139], v[88:91], v[20:23]
    ds_read_b128 v[84:87], v222 offset:4288
    v_mfma_f32_16x16x32_bf16 v[24:27], v[136:139], v[92:95], v[24:27]
    ds_read_b128 v[88:91], v223 offset:38528
    s_waitcnt lgkmcnt(9)
    v_mfma_f32_16x16x32_bf16 v[28:31], v[136:139], v[48:51], v[28:31]
    ds_read_b128 v[92:95], v223 offset:38784
    v_mfma_f32_16x16x32_bf16 v[20:23], v[140:143], v[52:55], v[20:23]
    ds_read_b128 v[48:51], v223 offset:38656
    s_waitcnt lgkmcnt(9)
    v_mfma_f32_16x16x32_bf16 v[24:27], v[140:143], v[56:59], v[24:27]
    ds_read_b128 v[52:55], v223 offset:38592
    v_mfma_f32_16x16x32_bf16 v[28:31], v[140:143], v[60:63], v[28:31]
    ds_read_b128 v[56:59], v223 offset:38848
    s_waitcnt lgkmcnt(9)
    v_mfma_f32_16x16x32_bf16 v[20:23], v[144:147], v[64:67], v[20:23]
    ds_read_b128 v[60:63], v223 offset:38720
    v_mfma_f32_16x16x32_bf16 v[24:27], v[144:147], v[68:71], v[24:27]
    ds_read_b128 v[64:67], v223 offset:39040
    s_waitcnt lgkmcnt(9)
    v_mfma_f32_16x16x32_bf16 v[28:31], v[144:147], v[72:75], v[28:31]
    ds_read_b128 v[68:71], v223 offset:38912
    v_mfma_f32_16x16x32_bf16 v[20:23], v[148:151], v[76:79], v[20:23]
    ds_read_b128 v[72:75], v223 offset:39168
    s_waitcnt lgkmcnt(9)
    v_mfma_f32_16x16x32_bf16 v[24:27], v[148:151], v[80:83], v[24:27]
    ds_read_b128 v[76:79], v223 offset:39104
    v_mfma_f32_16x16x32_bf16 v[28:31], v[148:151], v[84:87], v[28:31]
    ds_read_b128 v[80:83], v223 offset:38976
    s_waitcnt lgkmcnt(9)
    v_mfma_f32_16x16x32_bf16 v[20:23], v[152:155], v[88:91], v[20:23]
    ds_read_b128 v[84:87], v223 offset:39232
    v_mfma_f32_16x16x32_bf16 v[24:27], v[152:155], v[92:95], v[24:27]
    ds_read_b128 v[88:91], v223 offset:39424
    s_waitcnt lgkmcnt(9)
    v_mfma_f32_16x16x32_bf16 v[28:31], v[152:155], v[48:51], v[28:31]
    ds_read_b128 v[92:95], v223 offset:39680
    v_mfma_f32_16x16x32_bf16 v[20:23], v[156:159], v[52:55], v[20:23]
    ds_read_b128 v[48:51], v223 offset:39552
    s_waitcnt lgkmcnt(9)
    v_mfma_f32_16x16x32_bf16 v[24:27], v[156:159], v[56:59], v[24:27]
    ds_read_b128 v[52:55], v223 offset:39488
    v_mfma_f32_16x16x32_bf16 v[28:31], v[156:159], v[60:63], v[28:31]
    ds_read_b128 v[56:59], v223 offset:39744
    s_waitcnt lgkmcnt(9)
    v_mfma_f32_16x16x32_bf16 v[20:23], v[160:163], v[64:67], v[20:23]
    ds_read_b128 v[60:63], v223 offset:39616
    v_mfma_f32_16x16x32_bf16 v[24:27], v[160:163], v[68:71], v[24:27]
    ds_read_b128 v[64:67], v232 offset:6144
    s_waitcnt lgkmcnt(9)
    v_mfma_f32_16x16x32_bf16 v[28:31], v[160:163], v[72:75], v[28:31]
    ds_read_b128 v[68:71], v232 offset:6208
    v_mfma_f32_16x16x32_bf16 v[20:23], v[164:167], v[76:79], v[20:23]
    ds_read_b128 v[72:75], v232 offset:7040
    s_waitcnt lgkmcnt(9)
    v_mfma_f32_16x16x32_bf16 v[24:27], v[164:167], v[80:83], v[24:27]
    ds_read_b128 v[76:79], v232 offset:7104
    v_mfma_f32_16x16x32_bf16 v[28:31], v[164:167], v[84:87], v[28:31]
    ds_read_b128 v[80:83], v225 offset:0
    s_waitcnt lgkmcnt(9)
    v_mfma_f32_16x16x32_bf16 v[20:23], v[168:171], v[88:91], v[20:23]
    ds_read_b128 v[84:87], v225 offset:64
    v_mfma_f32_16x16x32_bf16 v[24:27], v[168:171], v[92:95], v[24:27]
    ds_read_b128 v[88:91], v225 offset:896
    s_waitcnt lgkmcnt(9)
    v_mfma_f32_16x16x32_bf16 v[28:31], v[168:171], v[48:51], v[28:31]
    ds_read_b128 v[92:95], v225 offset:960
    v_mfma_f32_16x16x32_bf16 v[20:23], v[172:175], v[52:55], v[20:23]
    ds_read_b128 v[48:51], v247 offset:6272
    s_waitcnt lgkmcnt(9)
    v_mfma_f32_16x16x32_bf16 v[24:27], v[172:175], v[56:59], v[24:27]
    ds_read_b128 v[52:55], v232 offset:6528
    v_mfma_f32_16x16x32_bf16 v[28:31], v[172:175], v[60:63], v[28:31]
    ds_read_b128 v[56:59], v247 offset:6336
    s_waitcnt lgkmcnt(9)
    v_mfma_f32_16x16x32_bf16 v[32:35], v[96:99], v[64:67], 0
    ds_read_b128 v[60:63], v232 offset:6592
    v_mfma_f32_16x16x32_bf16 v[32:35], v[100:103], v[68:71], v[32:35]
    ds_read_b128 v[64:67], v247 offset:6784
    s_waitcnt lgkmcnt(9)
    v_mfma_f32_16x16x32_bf16 v[32:35], v[104:107], v[72:75], v[32:35]
    ds_read_b128 v[68:71], v232 offset:6656
    v_mfma_f32_16x16x32_bf16 v[32:35], v[108:111], v[76:79], v[32:35]
    ds_read_b128 v[72:75], v247 offset:6848
    s_waitcnt lgkmcnt(9)
    v_mfma_f32_16x16x32_bf16 v[32:35], v[112:115], v[80:83], v[32:35]
    ds_read_b128 v[76:79], v232 offset:6720
    v_mfma_f32_16x16x32_bf16 v[32:35], v[116:119], v[84:87], v[32:35]
    ds_read_b128 v[80:83], v247 offset:7168
    s_waitcnt lgkmcnt(9)
    v_mfma_f32_16x16x32_bf16 v[32:35], v[120:123], v[88:91], v[32:35]
    ds_read_b128 v[84:87], v232 offset:7424
    v_mfma_f32_16x16x32_bf16 v[32:35], v[124:127], v[92:95], v[32:35]
    ds_read_b128 v[88:91], v247 offset:7232
    s_waitcnt lgkmcnt(9)
    v_mfma_f32_16x16x32_bf16 v[36:39], v[128:131], v[48:51], 0
    ds_read_b128 v[92:95], v232 offset:7488
    v_mfma_f32_16x16x32_bf16 v[40:43], v[128:131], v[52:55], 0
    ds_read_b128 v[48:51], v248 offset:128
    s_waitcnt lgkmcnt(9)
    v_mfma_f32_16x16x32_bf16 v[36:39], v[132:135], v[56:59], v[36:39]
    ds_read_b128 v[52:55], v225 offset:384
    v_mfma_f32_16x16x32_bf16 v[40:43], v[132:135], v[60:63], v[40:43]
    ds_read_b128 v[56:59], v248 offset:192
    s_waitcnt lgkmcnt(9)
    v_mfma_f32_16x16x32_bf16 v[36:39], v[136:139], v[64:67], v[36:39]
    ds_read_b128 v[60:63], v225 offset:448
    v_mfma_f32_16x16x32_bf16 v[40:43], v[136:139], v[68:71], v[40:43]
    ds_read_b128 v[64:67], v248 offset:640
    s_waitcnt lgkmcnt(9)
    v_mfma_f32_16x16x32_bf16 v[36:39], v[140:143], v[72:75], v[36:39]
    ds_read_b128 v[68:71], v225 offset:512
    v_mfma_f32_16x16x32_bf16 v[40:43], v[140:143], v[76:79], v[40:43]
    ds_read_b128 v[72:75], v248 offset:704
    s_waitcnt lgkmcnt(9)
    v_mfma_f32_16x16x32_bf16 v[36:39], v[144:147], v[80:83], v[36:39]
    ds_read_b128 v[76:79], v225 offset:576
    v_mfma_f32_16x16x32_bf16 v[40:43], v[144:147], v[84:87], v[40:43]
    ds_read_b128 v[80:83], v248 offset:1024
    s_waitcnt lgkmcnt(9)
    v_mfma_f32_16x16x32_bf16 v[36:39], v[148:151], v[88:91], v[36:39]
    ds_read_b128 v[84:87], v225 offset:1280
    v_mfma_f32_16x16x32_bf16 v[40:43], v[148:151], v[92:95], v[40:43]
    ds_read_b128 v[88:91], v248 offset:1088
    s_waitcnt lgkmcnt(9)
    v_mfma_f32_16x16x32_bf16 v[36:39], v[152:155], v[48:51], v[36:39]
    ds_read_b128 v[92:95], v225 offset:1344
    v_mfma_f32_16x16x32_bf16 v[40:43], v[152:155], v[52:55], v[40:43]
    s_waitcnt lgkmcnt(8)
    v_mfma_f32_16x16x32_bf16 v[36:39], v[156:159], v[56:59], v[36:39]
    v_mfma_f32_16x16x32_bf16 v[40:43], v[156:159], v[60:63], v[40:43]
    s_waitcnt lgkmcnt(6)
    v_mfma_f32_16x16x32_bf16 v[36:39], v[160:163], v[64:67], v[36:39]
    v_mfma_f32_16x16x32_bf16 v[40:43], v[160:163], v[68:71], v[40:43]
    s_waitcnt lgkmcnt(4)
    v_mfma_f32_16x16x32_bf16 v[36:39], v[164:167], v[72:75], v[36:39]
    v_mfma_f32_16x16x32_bf16 v[40:43], v[164:167], v[76:79], v[40:43]
    s_waitcnt lgkmcnt(2)
    v_mfma_f32_16x16x32_bf16 v[36:39], v[168:171], v[80:83], v[36:39]
    v_mfma_f32_16x16x32_bf16 v[40:43], v[168:171], v[84:87], v[40:43]
    s_waitcnt lgkmcnt(0)
    v_mfma_f32_16x16x32_bf16 v[36:39], v[172:175], v[88:91], v[36:39]
    v_mfma_f32_16x16x32_bf16 v[40:43], v[172:175], v[92:95], v[40:43]
    s_lshl_b32 s60, s54, 9
    s_lshl_b32 s61, s20, 6
    s_add_u32 s60, s60, s61
    s_mul_i32 s60, s60, 192
    s_add_u32 s60, s60, 10485760
    v_mul_u32_u24 v227, 96, v252
    s_cmp_lg_u32 s28, 0
    s_cbranch_scc1 K2_NOACC
    buffer_load_dwordx4 v[48:51], v227, s[8:11], s60 offen offset:0
    buffer_load_dwordx4 v[52:55], v227, s[8:11], s60 offen offset:16
    buffer_load_dwordx4 v[56:59], v227, s[8:11], s60 offen offset:32
    buffer_load_dwordx4 v[60:63], v227, s[8:11], s60 offen offset:48
    buffer_load_dwordx4 v[64:67], v227, s[8:11], s60 offen offset:64
    buffer_load_dwordx4 v[68:71], v227, s[8:11], s60 offen offset:80
    buffer_load_dwordx4 v[72:75], v227, s[8:11], s60 offen offset:96
    buffer_load_dwordx4 v[76:79], v227, s[8:11], s60 offen offset:112
    buffer_load_dwordx4 v[80:83], v227, s[8:11], s60 offen offset:128
    buffer_load_dwordx4 v[84:87], v227, s[8:11], s60 offen offset:144
    buffer_load_dwordx4 v[88:91], v227, s[8:11], s60 offen offset:160
    s_waitcnt vmcnt(0)
    v_add_f32 v0, v0, v48
    v_add_f32 v1, v1, v49
    v_add_f32 v2, v2, v50
    v_add_f32 v3, v3, v51
    v_add_f32 v4, v4, v52
    v_add_f32 v5, v5, v53
    v_add_f32 v6, v6, v54
    v_add_f32 v7, v7, v55
    v_add_f32 v8, v8, v56
    v_add_f32 v9, v9, v57
    v_add_f32 v10, v10, v58
    v_add_f32 v11, v11, v59
    v_add_f32 v12, v12, v60
    v_add_f32 v13, v13, v61
    v_add_f32 v14, v14, v62
    v_add_f32 v15, v15, v63
    v_add_f32 v16, v16, v64
    v_add_f32 v17, v17, v65
    v_add_f32 v18, v18, v66
    v_add_f32 v19, v19, v67
    v_add_f32 v20, v20, v68
    v_add_f32 v21, v21, v69
    v_add_f32 v22, v22, v70
    v_add_f32 v23, v23, v71
    v_add_f32 v24, v24, v72
    v_add_f32 v25, v25, v73
    v_add_f32 v26, v26, v74
    v_add_f32 v27, v27, v75
    v_add_f32 v28, v28, v76
    v_add_f32 v29, v29, v77
    v_add_f32 v30, v30, v78
    v_add_f32 v31, v31, v79
    v_add_f32 v32, v32, v80
    v_add_f32 v33, v33, v81
    v_add_f32 v34, v34, v82
    v_add_f32 v35, v35, v83
    v_add_f32 v36, v36, v84
    v_add_f32 v37, v37, v85
    v_add_f32 v38, v38, v86
    v_add_f32 v39, v39, v87
    v_add_f32 v40, v40, v88
    v_add_f32 v41, v41, v89
    v_add_f32 v42, v42, v90
    v_add_f32 v43, v43, v91
K2_NOACC:
    s_barrier
    s_cmp_eq_u32 s55, 0
    s_cbranch_scc1 K2_SPILL
    s_bfe_u32 s60, s20, 0x10002
    s_lshl_b32 s60, s60, 4
    s_add_u32 s59, s59, s60
    v_add_u32 v228, s59, v229
    s_mul_i32 s60, s20, 2400
    s_add_u32 s60, s60, 65536
    v_add_u32 v249, s60, v229
    s_mov_b32 s63, 0xbfb8aa3b
    s_add_u32 s40, s20, s21
    s_lshl_b32 s40, s40, 10
    s_add_u32 s41, s40, 8192
    s_add_u32 s42, s40, 16384
    s_add_u32 s43, s40, 24576
    s_add_u32 s44, s40, 32768
    v_mul_f32 v204, s63, v0
    v_mul_f32 v205, s63, v1
    v_mul_f32 v206, s63, v2
    v_mul_f32 v207, s63, v3
    v_exp_f32 v204, v204
    v_exp_f32 v205, v205
    v_exp_f32 v206, v206
    v_exp_f32 v207, v207
    v_add_f32 v204, 1.0, v204
    v_add_f32 v205, 1.0, v205
    v_add_f32 v206, 1.0, v206
    v_add_f32 v207, 1.0, v207
    v_rcp_f32 v204, v204
    v_rcp_f32 v205, v205
    v_rcp_f32 v206, v206
    v_rcp_f32 v207, v207
    v_cvt_pk_bf16_f32 v176, v0, v1
    v_cvt_pk_bf16_f32 v177, v2, v3
    v_mul_f32 v4, v4, v204
    v_mul_f32 v5, v5, v205
    v_mul_f32 v6, v6, v206
    v_mul_f32 v7, v7, v207
    v_cvt_pk_bf16_f32 v178, v4, v5
    v_cvt_pk_bf16_f32 v179, v6, v7
    v_mul_f32 v8, v8, v204
    v_mul_f32 v9, v9, v205
    v_mul_f32 v10, v10, v206
    v_mul_f32 v11, v11, v207
    v_cvt_pk_bf16_f32 v180, v8, v9
    v_cvt_pk_bf16_f32 v181, v10, v11
    v_mul_f32 v12, v12, v204
    v_mul_f32 v13, v13, v205
    v_mul_f32 v14, v14, v206
    v_mul_f32 v15, v15, v207
    v_cvt_pk_bf16_f32 v182, v12, v13
    v_cvt_pk_bf16_f32 v183, v14, v15
    ds_write_b64 v254, v[176:177] offset:0
    ds_write_b64 v254, v[178:179] offset:256
    ds_write_b64 v254, v[180:181] offset:512
    ds_write_b64 v254, v[182:183] offset:768
    s_waitcnt lgkmcnt(0)
    s_barrier
    ds_read_b128 v[192:195], v228 offset:0
    ds_read_b128 v[196:199], v228 offset:1536
    s_waitcnt lgkmcnt(0)
    buffer_store_dwordx4 v[192:195], v229, s[12:15], s40 offen sc1
    buffer_store_dwordx4 v[196:199], v229, s[12:15], s41 offen sc1
    v_mul_f32 v208, s63, v16
    v_mul_f32 v209, s63, v17
    v_mul_f32 v210, s63, v18
    v_mul_f32 v211, s63, v19
    v_exp_f32 v208, v208
    v_exp_f32 v209, v209
    v_exp_f32 v210, v210
    v_exp_f32 v211, v211
    v_add_f32 v208, 1.0, v208
    v_add_f32 v209, 1.0, v209
    v_add_f32 v210, 1.0, v210
    v_add_f32 v211, 1.0, v211
    v_rcp_f32 v208, v208
    v_rcp_f32 v209, v209
    v_rcp_f32 v210, v210
    v_rcp_f32 v211, v211
    v_cvt_pk_bf16_f32 v184, v16, v17
    v_cvt_pk_bf16_f32 v185, v18, v19
    v_mul_f32 v20, v20, v208
    v_mul_f32 v21, v21, v209
    v_mul_f32 v22, v22, v210
    v_mul_f32 v23, v23, v211
    v_cvt_pk_bf16_f32 v186, v20, v21
    v_cvt_pk_bf16_f32 v187, v22, v23
    v_mul_f32 v24, v24, v208
    v_mul_f32 v25, v25, v209
    v_mul_f32 v26, v26, v210
    v_mul_f32 v27, v27, v211
    v_cvt_pk_bf16_f32 v188, v24, v25
    v_cvt_pk_bf16_f32 v189, v26, v27
    v_mul_f32 v28, v28, v208
    v_mul_f32 v29, v29, v209
    v_mul_f32 v30, v30, v210
    v_mul_f32 v31, v31, v211
    v_cvt_pk_bf16_f32 v190, v28, v29
    v_cvt_pk_bf16_f32 v191, v30, v31
    ds_write_b64 v254, v[184:185] offset:3072
    ds_write_b64 v254, v[186:187] offset:3328
    ds_write_b64 v254, v[188:189] offset:3584
    ds_write_b64 v254, v[190:191] offset:3840
    s_waitcnt lgkmcnt(0)
    s_barrier
    ds_read_b128 v[192:195], v228 offset:3072
    ds_read_b128 v[196:199], v228 offset:4608
    s_waitcnt lgkmcnt(0)
    buffer_store_dwordx4 v[192:195], v229, s[12:15], s42 offen sc1
    buffer_store_dwordx4 v[196:199], v229, s[12:15], s43 offen sc1
    v_mul_f32 v204, s63, v32
    v_mul_f32 v205, s63, v33
    v_mul_f32 v206, s63, v34
    v_mul_f32 v207, s63, v35
    v_exp_f32 v204, v204
    v_exp_f32 v205, v205
    v_exp_f32 v206, v206
    v_exp_f32 v207, v207
    v_add_f32 v204, 1.0, v204
    v_add_f32 v205, 1.0, v205
    v_add_f32 v206, 1.0, v206
    v_add_f32 v207, 1.0, v207
    v_rcp_f32 v204, v204
    v_rcp_f32 v205, v205
    v_rcp_f32 v206, v206
    v_rcp_f32 v207, v207
    v_cvt_pk_bf16_f32 v176, v32, v33
    v_cvt_pk_bf16_f32 v177, v34, v35
    v_mul_f32 v36, v36, v204
    v_mul_f32 v37, v37, v205
    v_mul_f32 v38, v38, v206
    v_mul_f32 v39, v39, v207
    v_cvt_pk_bf16_f32 v178, v36, v37
    v_cvt_pk_bf16_f32 v179, v38, v39
    v_mul_f32 v40, v40, v204
    v_mul_f32 v41, v41, v205
    v_mul_f32 v42, v42, v206
    v_mul_f32 v43, v43, v207
    v_cvt_pk_bf16_f32 v180, v40, v41
    v_cvt_pk_bf16_f32 v181, v42, v43
    ds_write_b64 v255, v[176:177] offset:0
    ds_write_b64 v246, v[178:179] offset:256
    ds_write_b64 v255, v[180:181] offset:512
    s_waitcnt lgkmcnt(0)
    s_barrier
    ds_read_b128 v[200:203], v249
    s_branch K2_LASTROW
K2_SPILL:
    buffer_store_dwordx4 v[0:3], v227, s[8:11], s60 offen offset:0
    buffer_store_dwordx4 v[4:7], v227, s[8:11], s60 offen offset:16
    buffer_store_dwordx4 v[8:11], v227, s[8:11], s60 offen offset:32
    buffer_store_dwordx4 v[12:15], v227, s[8:11], s60 offen offset:48
    buffer_store_dwordx4 v[16:19], v227, s[8:11], s60 offen offset:64
    buffer_store_dwordx4 v[20:23], v227, s[8:11], s60 offen offset:80
    buffer_store_dwordx4 v[24:27], v227, s[8:11], s60 offen offset:96
    buffer_store_dwordx4 v[28:31], v227, s[8:11], s60 offen offset:112
    buffer_store_dwordx4 v[32:35], v227, s[8:11], s60 offen offset:128
    buffer_store_dwordx4 v[36:39], v227, s[8:11], s60 offen offset:144
    buffer_store_dwordx4 v[40:43], v227, s[8:11], s60 offen offset:160
    s_mov_b32 s28, 0
    s_waitcnt vmcnt(0)
    s_cmp_lt_u32 s24, s25
    s_cbranch_scc1 K2_LOAD
    s_add_u32 s23, s23, 20
    s_branch K2_WINDOW
K2_END:
    s_endpgm
.section .rodata,"a"
.p2align 6
.amdhsa_kernel standalone__tensor_product_equiv_equiformer__graph_kernel
  .amdhsa_next_free_vgpr 256
  .amdhsa_next_free_sgpr 102
  .amdhsa_accum_offset 256
  .amdhsa_group_segment_fixed_size 0
  .amdhsa_kernarg_size 96
  .amdhsa_user_sgpr_count 2
  .amdhsa_user_sgpr_kernarg_segment_ptr 1
  .amdhsa_system_sgpr_workgroup_id_x 1
  .amdhsa_float_denorm_mode_32 3
.end_amdhsa_kernel
```

```asm
; @launch grid=(256,1,1) block=(512,1,1) lds=163840
.amdgcn_target "amdgcn-amd-amdhsa--gfx950"
.text
.globl standalone__tensor_product_equiv_equiformer__graph_kernel
.p2align 8
.type standalone__tensor_product_equiv_equiformer__graph_kernel,@function
standalone__tensor_product_equiv_equiformer__graph_kernel:
    s_cmp_ge_u32 s2, 256
    s_cbranch_scc1 K2_END
    s_load_dwordx16 s[80:95], s[0:1], 0
    s_load_dwordx4 s[96:99], s[0:1], 72
    s_load_dwordx2 s[100:101], s[0:1], 88
    s_memrealtime s[74:75]
    v_lshrrev_b32 v1, 6, v0
    s_mov_b32 s54, s2
    v_readfirstlane_b32 s20, v1
    v_and_b32 v8, 63, v0
    v_lshlrev_b32 v9, 4, v8
    v_mov_b32 v6, 0
    v_lshlrev_b32 v5, 4, v0
    v_mul_u32_u24 v4, 24, v0
    s_mul_i32 s64, s2, 5120
    s_mul_i32 s65, s2, 7680
    v_mov_b32 v176, v8
    v_mov_b32 v177, v0
    s_mul_i32 s21, s2, 625
    s_add_u32 s22, s21, 640
    s_add_u32 s21, s21, 15
    s_lshr_b32 s21, s21, 4
    s_lshr_b32 s22, s22, 4
    s_sub_u32 s22, s22, s21
    s_movk_i32 s39, 1024
    s_lshl_b32 s37, s20, 13
    s_mov_b32 s53, 163616
    s_lshl_b32 s52, s20, 2
    s_add_u32 s52, s52, s53
    s_add_u32 s68, s37, 0
    s_add_u32 s69, s37, 2048
    s_add_u32 s70, s37, 4096
    s_add_u32 s71, s37, 6144
    s_waitcnt lgkmcnt(0)
    s_mov_b32 s8, s100
    s_and_b32 s9, s101, 0xffff
    s_mov_b32 s10, 37748736
    s_mov_b32 s11, 0x20000
    s_cmp_ge_u32 s20, 5
    s_cbranch_scc1 KS_HELP
    s_cmp_ge_u32 s2, 250
    s_cbranch_scc1 KS_IDLE
    s_mov_b32 s40, s88
    s_and_b32 s41, s89, 0xffff
    s_mov_b32 s42, 1280000
    s_mov_b32 s43, 0x20000
    buffer_load_dwordx4 v[12:15], v5, s[40:43], s64 offen
    s_mov_b32 s44, s86
    s_and_b32 s45, s87, 0xffff
    s_mov_b32 s46, 1280000
    s_mov_b32 s47, 0x20000
    s_mov_b32 s48, s82
    s_and_b32 s49, s83, 0xffff
    s_mov_b32 s50, 1920000
    s_mov_b32 s51, 0x20000
    buffer_load_dwordx4 v[16:19], v5, s[44:47], s64 offen
    buffer_load_dwordx4 v[20:23], v4, s[48:51], s65 offen
    buffer_load_dwordx2 v[24:25], v4, s[48:51], s65 offen offset:16
    v_lshlrev_b32 v2, 2, v0
    s_lshl_b32 s64, s64, 3
    v_lshl_add_u32 v3, v0, 7, s64
    v_mov_b32 v7, 1
    s_cmp_eq_u32 s20, 4
    s_cbranch_scc1 KS_NOCLR
    ds_write_b32 v2, v6
KS_NOCLR:
    s_waitcnt lgkmcnt(0)
    s_barrier
    v_mul_u32_u24 v76, 2979, v0
    v_lshrrev_b32 v76, 16, v76
    v_mul_u32_u24 v77, 2048, v76
    v_lshl_add_u32 v78, v0, 4, v77
    v_add_u32 v78, 67584, v78
    v_add_u32 v79, 67200, v78
    v_mov_b32 v80, -1
    v_mov_b32 v81, -1
    v_cmp_gt_u32 vcc, 14, v76
    v_cmp_gt_u32 s[56:57], 12, v76
    v_mov_b32 v82, -1
    v_mov_b32 v83, -1
    s_mov_b64 exec, vcc
    ds_write_b128 v78, v[80:83]
    ds_write_b128 v78, v[80:83] offset:33600
    s_mov_b64 exec, s[56:57]
    ds_write_b128 v79, v[80:83]
    s_mov_b64 exec, -1
    s_mov_b32 s4, s80
    s_and_b32 s5, s81, 0xffff
    s_mov_b32 s6, 10240000
    s_mov_b32 s7, 0x20000
    s_mov_b32 s12, s96
    s_and_b32 s13, s97, 0xffff
    s_mov_b32 s14, 10240000
    s_mov_b32 s15, 0x20000
    s_mov_b32 s16, s84
    s_and_b32 s17, s85, 0xffff
    s_mov_b32 s18, 10240000
    s_mov_b32 s19, 0x20000
    s_sub_u32 s80, s80, 1024
    s_subb_u32 s81, s81, 0
    s_mov_b32 s72, s80
    s_and_b32 s73, s81, 0xffff
    s_mov_b32 s74, 10241024
    s_mov_b32 s75, 0x20000
    s_mov_b32 s58, 429497
    s_movk_i32 s59, 625
    s_waitcnt vmcnt(3)
    v_mul_u32_u24 v28, s58, v12
    v_lshrrev_b32 v32, 27, v28
    v_bfe_u32 v36, v28, 24, 3
    v_lshlrev_b32 v32, 2, v32
    v_lshl_or_b32 v32, v36, 7, v32
    ds_add_rtn_u32 v36, v32, v7
    v_mul_u32_u24 v29, s58, v13
    v_lshrrev_b32 v33, 27, v29
    v_bfe_u32 v37, v29, 24, 3
    v_lshlrev_b32 v33, 2, v33
    v_lshl_or_b32 v33, v37, 7, v33
    ds_add_rtn_u32 v37, v33, v7
    v_mul_u32_u24 v30, s58, v14
    v_lshrrev_b32 v34, 27, v30
    v_bfe_u32 v38, v30, 24, 3
    v_lshlrev_b32 v34, 2, v34
    v_lshl_or_b32 v34, v38, 7, v34
    ds_add_rtn_u32 v38, v34, v7
    v_mul_u32_u24 v31, s58, v15
    v_lshrrev_b32 v35, 27, v31
    v_bfe_u32 v39, v31, 24, 3
    v_lshlrev_b32 v35, 2, v35
    v_lshl_or_b32 v35, v39, 7, v35
    ds_add_rtn_u32 v39, v35, v7
    v_lshrrev_b32 v28, 24, v28
    v_mad_u32_u24 v28, v28, s59, 15
    v_lshrrev_b32 v28, 4, v28
    v_sub_u32 v28, v12, v28
    v_add_u32 v12, 0, v3
    v_lshl_or_b32 v28, v28, 26, v12
    v_lshrrev_b32 v29, 24, v29
    v_mad_u32_u24 v29, v29, s59, 15
    v_lshrrev_b32 v29, 4, v29
    v_sub_u32 v29, v13, v29
    v_add_u32 v13, 32, v3
    v_lshl_or_b32 v29, v29, 26, v13
    v_lshrrev_b32 v30, 24, v30
    v_mad_u32_u24 v30, v30, s59, 15
    v_lshrrev_b32 v30, 4, v30
    v_sub_u32 v30, v14, v30
    v_add_u32 v14, 64, v3
    v_lshl_or_b32 v30, v30, 26, v14
    v_lshrrev_b32 v31, 24, v31
    v_mad_u32_u24 v31, v31, s59, 15
    v_lshrrev_b32 v31, 4, v31
    v_sub_u32 v31, v15, v31
    v_add_u32 v15, 96, v3
    v_lshl_or_b32 v31, v31, 26, v15
    v_mov_b32 v59, 163728
    s_mul_i32 s65, s2, 1152
    s_add_u32 s65, s65, 6291456
    s_mul_i32 s64, s2, 20608
    s_waitcnt lgkmcnt(0)
    s_barrier
    ds_read_b128 v[40:43], v9
    ds_read_b32 v59, v59
    s_waitcnt lgkmcnt(1)
    v_add_u32 v45, v40, v41
    v_add_u32 v46, v45, v42
    v_add_u32 v47, v46, v43
    v_mov_b32 v58, v47
    s_nop 1
    v_add_u32_dpp v58, v58, v58 row_shr:1 row_mask:0xf bank_mask:0xf bound_ctrl:0
    s_nop 1
    v_add_u32_dpp v58, v58, v58 row_shr:2 row_mask:0xf bank_mask:0xf bound_ctrl:0
    s_nop 1
    v_add_u32_dpp v58, v58, v58 row_shr:4 row_mask:0xf bank_mask:0xf bound_ctrl:0
    s_nop 1
    v_add_u32_dpp v58, v58, v58 row_shr:8 row_mask:0xf bank_mask:0xf bound_ctrl:0
    s_nop 1
    v_add_u32_dpp v58, v58, v58 row_bcast:15 row_mask:0xa bank_mask:0xf
    s_nop 1
    v_add_u32_dpp v58, v58, v58 row_bcast:31 row_mask:0xc bank_mask:0xf
    v_sub_u32 v48, v58, v47
    v_add_u32 v49, v48, v40
    v_add_u32 v50, v48, v45
    v_add_u32 v51, v48, v46
    ds_write_b128 v9, v[48:51] offset:1024
    s_waitcnt vmcnt(0) lgkmcnt(1)
    s_cmp_lg_u32 s20, 4
    s_cbranch_scc1 KS_NOPUB
    v_lshl_or_b32 v56, v49, 11, v48
    v_lshl_or_b32 v57, v51, 11, v50
    v_lshl_or_b32 v56, v59, 22, v56
    v_lshl_or_b32 v57, v59, 22, v57
    buffer_store_dwordx4 v[56:59], v9, s[8:11], s65 offen sc1
KS_NOPUB:
    s_waitcnt lgkmcnt(0)
    ds_read_b32 v32, v32 offset:1024
    ds_read_b32 v33, v33 offset:1024
    ds_read_b32 v34, v34 offset:1024
    ds_read_b32 v35, v35 offset:1024
    v_and_b32 v60, 0xffff, v59
    v_and_b32 v61, 0xffff0000, v59
    s_mov_b32 s58, 0xffff0000
    v_mov_b32 v40, v20
    v_lshl_or_b32 v41, v21, 16, v60
    v_or_b32 v42, v61, v16
    v_mov_b32 v43, v28
    v_alignbit_b32 v44, v22, v21, 16
    v_and_or_b32 v45, v22, s58, v60
    v_or_b32 v46, v61, v17
    v_mov_b32 v47, v29
    v_mov_b32 v48, v23
    v_lshl_or_b32 v49, v24, 16, v60
    v_or_b32 v50, v61, v18
    v_mov_b32 v51, v30
    v_alignbit_b32 v52, v25, v24, 16
    v_and_or_b32 v53, v25, s58, v60
    v_or_b32 v54, v61, v19
    v_mov_b32 v55, v31
    s_waitcnt lgkmcnt(0)
    v_add_lshl_u32 v32, v32, v36, 4
    ds_write_b128 v32, v[40:43] offset:2048
    v_add_lshl_u32 v33, v33, v37, 4
    ds_write_b128 v33, v[44:47] offset:2048
    v_add_lshl_u32 v34, v34, v38, 4
    ds_write_b128 v34, v[48:51] offset:2048
    v_add_lshl_u32 v35, v35, v39, 4
    ds_write_b128 v35, v[52:55] offset:2048
    s_waitcnt lgkmcnt(0)
    s_barrier
    ds_read_b128 v[12:15], v5 offset:2048
    ds_read_b128 v[16:19], v5 offset:7168
    ds_read_b128 v[20:23], v5 offset:12288
    ds_read_b128 v[24:27], v5 offset:17408
    s_waitcnt lgkmcnt(3)
    buffer_store_dwordx4 v[12:15], v5, s[8:11], s64 offen sc1
    s_add_u32 s64, s64, 5120
    s_waitcnt lgkmcnt(2)
    buffer_store_dwordx4 v[16:19], v5, s[8:11], s64 offen sc1
    s_add_u32 s64, s64, 5120
    s_waitcnt lgkmcnt(1)
    buffer_store_dwordx4 v[20:23], v5, s[8:11], s64 offen sc1
    s_add_u32 s64, s64, 5120
    s_waitcnt lgkmcnt(0)
    buffer_store_dwordx4 v[24:27], v5, s[8:11], s64 offen sc1
    s_branch KS_JOIN
KS_IDLE:
    s_barrier
    v_mul_u32_u24 v76, 2979, v0
    v_lshrrev_b32 v76, 16, v76
    v_mul_u32_u24 v77, 2048, v76
    v_lshl_add_u32 v78, v0, 4, v77
    v_add_u32 v78, 67584, v78
    v_add_u32 v79, 67200, v78
    v_mov_b32 v80, -1
    v_mov_b32 v81, -1
    v_cmp_gt_u32 vcc, 14, v76
    v_cmp_gt_u32 s[56:57], 12, v76
    v_mov_b32 v82, -1
    v_mov_b32 v83, -1
    s_mov_b64 exec, vcc
    ds_write_b128 v78, v[80:83]
    ds_write_b128 v78, v[80:83] offset:33600
    s_mov_b64 exec, s[56:57]
    ds_write_b128 v79, v[80:83]
    s_mov_b64 exec, -1
    s_mov_b32 s4, s80
    s_and_b32 s5, s81, 0xffff
    s_mov_b32 s6, 10240000
    s_mov_b32 s7, 0x20000
    s_mov_b32 s12, s96
    s_and_b32 s13, s97, 0xffff
    s_mov_b32 s14, 10240000
    s_mov_b32 s15, 0x20000
    s_mov_b32 s16, s84
    s_and_b32 s17, s85, 0xffff
    s_mov_b32 s18, 10240000
    s_mov_b32 s19, 0x20000
    s_sub_u32 s80, s80, 1024
    s_subb_u32 s81, s81, 0
    s_mov_b32 s72, s80
    s_and_b32 s73, s81, 0xffff
    s_mov_b32 s74, 10241024
    s_mov_b32 s75, 0x20000
    s_barrier
    s_branch KS_B3
KS_HELP:
    s_cmp_eq_u32 s20, 7
    s_cbranch_scc1 KS_TAG
    s_cmp_eq_u32 s20, 6
    s_cbranch_scc1 KS_RAW
    s_cmp_ge_u32 s2, 200
    s_cbranch_scc1 KS_NOW
    v_and_b32 v1, 15, v8
    v_lshrrev_b32 v3, 4, v8
    s_cmp_ge_u32 s2, 160
    s_cbranch_scc1 K1_WT
    s_cmp_ge_u32 s2, 64
    s_cbranch_scc1 K1_S1
    s_lshr_b32 s24, s2, 3
    s_and_b32 s25, s2, 7
    s_lshr_b32 s26, s25, 2
    s_bfe_u32 s27, s25, 0x10001
    s_and_b32 s28, s25, 1
    s_mov_b32 s60, s92
    s_and_b32 s61, s93, 0xffff
    s_mov_b32 s62, 65536
    s_mov_b32 s63, 0x20000
    s_branch K1_SC
K1_S1:
    s_sub_u32 s29, s2, 64
    s_mul_i32 s24, s29, 43
    s_lshr_b32 s24, s24, 9
    s_mul_i32 s25, s24, 12
    s_sub_u32 s25, s29, s25
    s_cmp_ge_u32 s25, 6
    s_cselect_b32 s26, 1, 0
    s_mul_i32 s27, s26, 6
    s_sub_u32 s27, s25, s27
    s_lshr_b32 s27, s27, 1
    s_and_b32 s28, s25, 1
    s_add_u32 s25, s25, 8
    s_mov_b32 s60, s94
    s_and_b32 s61, s95, 0xffff
    s_mov_b32 s62, 98304
    s_mov_b32 s63, 0x20000
K1_SC:
    s_lshl_b32 s27, s27, 7
    s_lshl_b32 s26, s26, 6
    s_lshl_b32 s28, s28, 4
    s_add_u32 s27, s27, s26
    s_add_u32 s27, s27, s28
    s_lshl_b32 s27, s27, 8
    s_lshl_b32 s26, s24, 5
    s_add_u32 s27, s27, s26
    s_add_u32 s29, s27, 8192
    v_lshlrev_b32 v3, 10, v3
    v_lshl_add_u32 v3, v1, 1, v3
    buffer_load_ushort v64, v3, s[60:63], s27 offen offset:0
    buffer_load_ushort v65, v3, s[60:63], s29 offen offset:0
    buffer_load_ushort v66, v3, s[60:63], s27 offen offset:256
    buffer_load_ushort v67, v3, s[60:63], s29 offen offset:256
    buffer_load_ushort v68, v3, s[60:63], s27 offen offset:512
    buffer_load_ushort v69, v3, s[60:63], s29 offen offset:512
    buffer_load_ushort v70, v3, s[60:63], s27 offen offset:768
    buffer_load_ushort v71, v3, s[60:63], s29 offen offset:768
    s_mul_i32 s24, s24, 20
    s_add_u32 s24, s24, s25
    s_lshl_b32 s24, s24, 10
    s_add_u32 s24, s24, 6946816
    s_branch K1_GO
K1_WT:
    s_sub_u32 s24, s2, 160
    s_cmp_ge_u32 s24, 20
    s_cselect_b32 s26, 1, 0
    s_mul_i32 s25, s26, 20
    s_sub_u32 s25, s24, s25
    s_lshr_b32 s27, s25, 2
    s_bfe_u32 s28, s25, 0x10001
    s_and_b32 s25, s25, 1
    s_mul_i32 s25, s25, 10240
    s_lshl_b32 s27, s27, 8
    s_lshl_b32 s26, s26, 7
    s_lshl_b32 s28, s28, 6
    s_add_u32 s27, s27, s26
    s_add_u32 s27, s27, s28
    s_add_u32 s27, s27, s25
    s_mov_b32 s60, s90
    s_and_b32 s61, s91, 0xffff
    s_mov_b32 s62, 20480
    s_mov_b32 s63, 0x20000
    v_and_b32 v1, 31, v8
    v_lshrrev_b32 v3, 5, v8
    v_mul_u32_u24 v3, 5120, v3
    v_lshl_add_u32 v3, v1, 1, v3
    v_mov_b32 v64, 0
    v_mov_b32 v66, 0
    v_mov_b32 v68, 0
    v_mov_b32 v70, 0
    buffer_load_ushort v65, v3, s[60:63], s27 offen offset:0
    buffer_load_ushort v67, v3, s[60:63], s27 offen offset:1280
    buffer_load_ushort v69, v3, s[60:63], s27 offen offset:2560
    buffer_load_ushort v71, v3, s[60:63], s27 offen offset:3840
    s_lshl_b32 s24, s24, 10
    s_add_u32 s24, s24, 7110656
K1_GO:
    s_barrier
    v_subrev_u32 v76, 320, v0
    v_mov_b32 v80, -1
    v_mov_b32 v77, 1.0
    v_cmp_gt_u32 vcc, 48, v76
    v_lshlrev_b32 v78, 4, v76
    v_add_u32 v78, 65536, v78
    v_cndmask_b32 v80, v80, 0, vcc
    v_cmp_gt_u32 vcc, 12, v76
    v_add_u32 v79, 64800, v78
    s_nop 0
    v_cndmask_b32 v80, v80, v77, vcc
    v_cmp_gt_u32 s[56:57], 54, v8
    v_mov_b32 v81, v80
    v_mov_b32 v82, v80
    v_mov_b32 v83, v80
    ds_write_b128 v78, v[80:83] offset:0
    ds_write_b128 v78, v[80:83] offset:2400
    ds_write_b128 v78, v[80:83] offset:4800
    ds_write_b128 v78, v[80:83] offset:7200
    ds_write_b128 v78, v[80:83] offset:9600
    ds_write_b128 v78, v[80:83] offset:12000
    ds_write_b128 v78, v[80:83] offset:14400
    ds_write_b128 v78, v[80:83] offset:16800
    ds_write_b128 v78, v[80:83] offset:19200
    ds_write_b128 v78, v[80:83] offset:21600
    ds_write_b128 v78, v[80:83] offset:24000
    ds_write_b128 v78, v[80:83] offset:26400
    ds_write_b128 v78, v[80:83] offset:28800
    ds_write_b128 v78, v[80:83] offset:31200
    ds_write_b128 v78, v[80:83] offset:33600
    ds_write_b128 v78, v[80:83] offset:36000
    ds_write_b128 v78, v[80:83] offset:38400
    ds_write_b128 v78, v[80:83] offset:40800
    ds_write_b128 v78, v[80:83] offset:43200
    ds_write_b128 v78, v[80:83] offset:45600
    ds_write_b128 v78, v[80:83] offset:48000
    ds_write_b128 v78, v[80:83] offset:50400
    ds_write_b128 v78, v[80:83] offset:52800
    ds_write_b128 v78, v[80:83] offset:55200
    ds_write_b128 v78, v[80:83] offset:57600
    ds_write_b128 v78, v[80:83] offset:60000
    ds_write_b128 v78, v[80:83] offset:62400
    ds_write_b128 v79, v[80:83] offset:0
    ds_write_b128 v79, v[80:83] offset:2400
    ds_write_b128 v79, v[80:83] offset:4800
    ds_write_b128 v79, v[80:83] offset:7200
    ds_write_b128 v79, v[80:83] offset:9600
    ds_write_b128 v79, v[80:83] offset:12000
    ds_write_b128 v79, v[80:83] offset:14400
    ds_write_b128 v79, v[80:83] offset:16800
    ds_write_b128 v79, v[80:83] offset:19200
    ds_write_b128 v79, v[80:83] offset:21600
    ds_write_b128 v79, v[80:83] offset:24000
    ds_write_b128 v79, v[80:83] offset:26400
    ds_write_b128 v79, v[80:83] offset:28800
    v_mov_b32 v59, 163728
    s_barrier
    ds_read_b32 v59, v59
    s_cmp_eq_u32 s20, 6
    s_cselect_b64 exec, s[56:57], -1
    ds_write_b128 v79, v[80:83] offset:31200
    s_mov_b64 exec, -1
    s_mov_b32 s4, s80
    s_and_b32 s5, s81, 0xffff
    s_mov_b32 s6, 10240000
    s_mov_b32 s7, 0x20000
    s_mov_b32 s12, s96
    s_and_b32 s13, s97, 0xffff
    s_mov_b32 s14, 10240000
    s_mov_b32 s15, 0x20000
    s_mov_b32 s16, s84
    s_and_b32 s17, s85, 0xffff
    s_mov_b32 s18, 10240000
    s_mov_b32 s19, 0x20000
    s_sub_u32 s80, s80, 1024
    s_subb_u32 s81, s81, 0
    s_mov_b32 s72, s80
    s_and_b32 s73, s81, 0xffff
    s_mov_b32 s74, 10241024
    s_mov_b32 s75, 0x20000
    s_waitcnt vmcnt(0)
    v_lshl_or_b32 v40, v65, 16, v64
    v_lshl_or_b32 v41, v67, 16, v66
    v_lshl_or_b32 v42, v69, 16, v68
    v_lshl_or_b32 v43, v71, 16, v70
    buffer_store_dwordx4 v[40:43], v9, s[8:11], s24 offen sc1
    s_waitcnt lgkmcnt(0)
    s_barrier
    s_lshl_b32 s24, s2, 2
    s_add_u32 s24, s24, 7176192
    s_mov_b64 exec, 1
    s_waitcnt vmcnt(0)
    buffer_store_dword v59, v6, s[8:11], s24 offen sc1
    s_mov_b64 exec, -1
    s_branch KS_JOIN
KS_RAW:
    s_barrier
    s_mov_b32 s60, s90
    s_and_b32 s61, s91, 0xffff
    s_mov_b32 s62, 20480
    s_mov_b32 s63, 0x20000
    s_mov_b32 m0, 24576
    s_movk_i32 s24, 0
    buffer_load_dwordx4 v9, s[60:63], s24 offen offset:0 lds
    buffer_load_dwordx4 v9, s[60:63], s24 offen offset:1024 lds
    buffer_load_dwordx4 v9, s[60:63], s24 offen offset:2048 lds
    buffer_load_dwordx4 v9, s[60:63], s24 offen offset:3072 lds
    s_mov_b32 m0, 28672
    s_movk_i32 s24, 4096
    buffer_load_dwordx4 v9, s[60:63], s24 offen offset:0 lds
    buffer_load_dwordx4 v9, s[60:63], s24 offen offset:1024 lds
    buffer_load_dwordx4 v9, s[60:63], s24 offen offset:2048 lds
    buffer_load_dwordx4 v9, s[60:63], s24 offen offset:3072 lds
    s_mov_b32 m0, 32768
    s_movk_i32 s24, 8192
    buffer_load_dwordx4 v9, s[60:63], s24 offen offset:0 lds
    buffer_load_dwordx4 v9, s[60:63], s24 offen offset:1024 lds
    buffer_load_dwordx4 v9, s[60:63], s24 offen offset:2048 lds
    buffer_load_dwordx4 v9, s[60:63], s24 offen offset:3072 lds
    s_mov_b32 m0, 36864
    s_movk_i32 s24, 12288
    buffer_load_dwordx4 v9, s[60:63], s24 offen offset:0 lds
    buffer_load_dwordx4 v9, s[60:63], s24 offen offset:1024 lds
    buffer_load_dwordx4 v9, s[60:63], s24 offen offset:2048 lds
    buffer_load_dwordx4 v9, s[60:63], s24 offen offset:3072 lds
    s_mov_b32 m0, 40960
    s_movk_i32 s24, 16384
    buffer_load_dwordx4 v9, s[60:63], s24 offen offset:0 lds
    buffer_load_dwordx4 v9, s[60:63], s24 offen offset:1024 lds
    buffer_load_dwordx4 v9, s[60:63], s24 offen offset:2048 lds
    buffer_load_dwordx4 v9, s[60:63], s24 offen offset:3072 lds
    s_branch KS_FILL
KS_NOW:
    s_barrier
KS_FILL:
    v_subrev_u32 v76, 320, v0
    v_mov_b32 v80, -1
    v_mov_b32 v77, 1.0
    v_cmp_gt_u32 vcc, 48, v76
    v_lshlrev_b32 v78, 4, v76
    v_add_u32 v78, 65536, v78
    v_cndmask_b32 v80, v80, 0, vcc
    v_cmp_gt_u32 vcc, 12, v76
    v_add_u32 v79, 64800, v78
    s_nop 0
    v_cndmask_b32 v80, v80, v77, vcc
    v_cmp_gt_u32 s[56:57], 54, v8
    v_mov_b32 v81, v80
    v_mov_b32 v82, v80
    v_mov_b32 v83, v80
    ds_write_b128 v78, v[80:83] offset:0
    ds_write_b128 v78, v[80:83] offset:2400
    ds_write_b128 v78, v[80:83] offset:4800
    ds_write_b128 v78, v[80:83] offset:7200
    ds_write_b128 v78, v[80:83] offset:9600
    ds_write_b128 v78, v[80:83] offset:12000
    ds_write_b128 v78, v[80:83] offset:14400
    ds_write_b128 v78, v[80:83] offset:16800
    ds_write_b128 v78, v[80:83] offset:19200
    ds_write_b128 v78, v[80:83] offset:21600
    ds_write_b128 v78, v[80:83] offset:24000
    ds_write_b128 v78, v[80:83] offset:26400
    ds_write_b128 v78, v[80:83] offset:28800
    ds_write_b128 v78, v[80:83] offset:31200
    ds_write_b128 v78, v[80:83] offset:33600
    ds_write_b128 v78, v[80:83] offset:36000
    ds_write_b128 v78, v[80:83] offset:38400
    ds_write_b128 v78, v[80:83] offset:40800
    ds_write_b128 v78, v[80:83] offset:43200
    ds_write_b128 v78, v[80:83] offset:45600
    ds_write_b128 v78, v[80:83] offset:48000
    ds_write_b128 v78, v[80:83] offset:50400
    ds_write_b128 v78, v[80:83] offset:52800
    ds_write_b128 v78, v[80:83] offset:55200
    ds_write_b128 v78, v[80:83] offset:57600
    ds_write_b128 v78, v[80:83] offset:60000
    ds_write_b128 v78, v[80:83] offset:62400
    ds_write_b128 v79, v[80:83] offset:0
    ds_write_b128 v79, v[80:83] offset:2400
    ds_write_b128 v79, v[80:83] offset:4800
    ds_write_b128 v79, v[80:83] offset:7200
    ds_write_b128 v79, v[80:83] offset:9600
    ds_write_b128 v79, v[80:83] offset:12000
    ds_write_b128 v79, v[80:83] offset:14400
    ds_write_b128 v79, v[80:83] offset:16800
    ds_write_b128 v79, v[80:83] offset:19200
    ds_write_b128 v79, v[80:83] offset:21600
    ds_write_b128 v79, v[80:83] offset:24000
    ds_write_b128 v79, v[80:83] offset:26400
    ds_write_b128 v79, v[80:83] offset:28800
    s_barrier
    s_cmp_eq_u32 s20, 6
    s_cselect_b64 exec, s[56:57], -1
    ds_write_b128 v79, v[80:83] offset:31200
    s_mov_b64 exec, -1
    s_mov_b32 s4, s80
    s_and_b32 s5, s81, 0xffff
    s_mov_b32 s6, 10240000
    s_mov_b32 s7, 0x20000
    s_mov_b32 s12, s96
    s_and_b32 s13, s97, 0xffff
    s_mov_b32 s14, 10240000
    s_mov_b32 s15, 0x20000
    s_mov_b32 s16, s84
    s_and_b32 s17, s85, 0xffff
    s_mov_b32 s18, 10240000
    s_mov_b32 s19, 0x20000
    s_sub_u32 s80, s80, 1024
    s_subb_u32 s81, s81, 0
    s_mov_b32 s72, s80
    s_and_b32 s73, s81, 0xffff
    s_mov_b32 s74, 10241024
    s_mov_b32 s75, 0x20000
    s_waitcnt vmcnt(0)
    s_branch KS_B3
KS_TAG:
    s_mov_b32 s60, s98
    s_and_b32 s61, s99, 0xffff
    s_mov_b32 s62, 256
    s_mov_b32 s63, 0x20000
    s_cmp_lg_u32 s2, 0
    s_cbranch_scc1 KS_TAGLD
    s_or_b32 s24, s74, 1
    v_mov_b32 v10, s24
    v_mov_b32 v11, 0
    s_mov_b64 exec, 1
    buffer_atomic_cmpswap v[10:11], v6, s[60:63], 0 offen sc1
KS_TAGLD:
    s_mov_b64 exec, 1
    v_mov_b32 v14, 0
    s_mov_b64 exec, -1
    s_barrier
    v_mov_b32 v76, 0
    v_mov_b32 v77, -1
    v_lshlrev_b32 v78, 2, v8
    v_add_u32 v78, 163424, v78
    s_mov_b64 exec, 0x1ff
    ds_write_b32 v78, v76 offset:192
    s_mov_b64 exec, 0xff
    ds_write_b32 v78, v77 offset:256
    s_mov_b64 exec, -1
    s_mov_b32 exec_hi, 0xffff
    ds_write_b32 v78, v76
    s_mov_b64 exec, 0x3f
    ds_write_b32 v78, v76 offset:228
    s_mov_b64 exec, -1
    s_mov_b32 s4, s80
    s_and_b32 s5, s81, 0xffff
    s_mov_b32 s6, 10240000
    s_mov_b32 s7, 0x20000
    s_mov_b32 s12, s96
    s_and_b32 s13, s97, 0xffff
    s_mov_b32 s14, 10240000
    s_mov_b32 s15, 0x20000
    s_mov_b32 s16, s84
    s_and_b32 s17, s85, 0xffff
    s_mov_b32 s18, 10240000
    s_mov_b32 s19, 0x20000
    s_sub_u32 s80, s80, 1024
    s_subb_u32 s81, s81, 0
    s_mov_b32 s72, s80
    s_and_b32 s73, s81, 0xffff
    s_mov_b32 s74, 10241024
    s_mov_b32 s75, 0x20000
    s_mov_b64 exec, 1
    s_mov_b32 s24, 0x100000
    v_mov_b32 v12, 163728
KS_TAGW:
    buffer_load_dword v15, v6, s[60:63], 0 offen sc1
    s_waitcnt vmcnt(1)
    v_cmp_ne_u32 vcc, 0, v14
    s_nop 0
    s_cbranch_vccnz KS_TAGOK
    s_sub_u32 s24, s24, 1
    s_cbranch_scc1 K2_END
    buffer_load_dword v14, v6, s[60:63], 0 offen sc1
    s_waitcnt vmcnt(1)
    v_cmp_ne_u32 vcc, 0, v15
    s_nop 0
    s_cbranch_vccz KS_TAGW
    ds_write_b32 v12, v15
    s_branch KS_TAGOK2
KS_TAGOK:
    ds_write_b32 v12, v14
KS_TAGOK2:
    s_mov_b64 exec, -1
    s_waitcnt lgkmcnt(0)
    s_barrier
KS_B3:
    v_mov_b32 v59, 163728
    ds_read_b32 v59, v59
    s_waitcnt lgkmcnt(0)
    s_barrier
KS_JOIN:
    v_readfirstlane_b32 s2, v59
    s_mov_b32 s23, 0
    s_mov_b32 s28, 1
    s_mov_b32 s24, 0
    s_mov_b32 s25, 1
K2_CELLS:
    v_lshrrev_b32 v178, 1, v177
    v_min_u32 v178, 249, v178
    v_mul_u32_u24 v72, 1152, v178
    s_and_b32 s58, s54, 7
    s_lshl_b32 s58, s58, 7
    s_lshr_b32 s59, s54, 5
    s_lshl_b32 s59, s59, 4
    s_add_u32 s67, s58, s59
    s_add_u32 s67, s67, 6291456
    buffer_load_dwordx4 v[76:79], v72, s[8:11], s67 offen sc1
    v_and_b32 v84, 15, v176
    v_lshrrev_b32 v85, 5, v176
    v_bfe_u32 v86, v176, 4, 1
    v_lshrrev_b32 v87, 2, v84
    v_and_b32 v88, 3, v84
    v_lshl_add_u32 v89, v85, 3, v87
    v_lshlrev_b32 v249, 5, v89
    v_lshl_add_u32 v249, v88, 3, v249
    v_add_u32 v249, 864, v249
    v_mul_u32_u24 v250, 192, v86
    v_lshl_add_u32 v250, v85, 5, v250
    v_lshrrev_b32 v90, 1, v88
    v_lshl_add_u32 v90, v86, 1, v90
    v_bfe_u32 v91, v87, 1, 1
    v_lshlrev_b32 v91, 2, v91
    v_xor_b32 v90, v90, v91
    v_lshlrev_b32 v90, 4, v90
    v_lshl_add_u32 v90, v89, 7, v90
    v_and_b32 v91, 1, v88
    v_lshl_add_u32 v90, v91, 3, v90
    v_add_u32 v246, s37, v90
    v_xor_b32 v247, 64, v246
    v_lshrrev_b32 v90, 3, v176
    v_lshlrev_b32 v251, 2, v90
    v_add_u32 v251, 768, v251
    v_bfe_u32 v90, v90, 1, 1
    v_lshlrev_b32 v90, 2, v90
    v_and_b32 v91, 7, v176
    v_xor_b32 v90, v90, v91
    v_lshlrev_b32 v248, 4, v90
    v_lshlrev_b32 v252, 1, v176
    v_and_b32 v231, 1, v176
    v_lshlrev_b32 v231, 4, v231
    v_lshrrev_b32 v90, 1, v176
    v_lshlrev_b32 v90, 5, v90
    v_add_u32 v230, 864, v90
    s_lshl_b32 s59, s2, 22
    s_mov_b32 s60, 0x100000
    s_bfe_u32 s61, s54, 0x10004
    s_bfe_u32 s62, s54, 0x10003
    s_add_u32 s63, s61, s62
    s_mul_i32 s62, s62, 11
    s_sub_u32 s64, 11, s62
    v_cmp_gt_u32 vcc, 500, v177
    s_nop 0
    s_mov_b64 s[56:57], vcc
K2_POLL:
    s_waitcnt vmcnt(0)
    v_xor_b32 v73, s59, v76
    v_xor_b32 v74, s59, v77
    v_or_b32 v73, v73, v74
    v_xor_b32 v74, s2, v79
    v_lshrrev_b32 v73, 22, v73
    v_or_b32 v73, v73, v74
    v_cmp_ne_u32 vcc, 0, v73
    s_nop 0
    s_cbranch_vccz K2_POLLED
    s_sub_u32 s60, s60, 1
    s_cbranch_scc1 K2_END
    s_mov_b64 exec, vcc
    buffer_load_dwordx4 v[76:79], v72, s[8:11], s67 offen sc1
    s_mov_b64 exec, -1
    s_branch K2_POLL
K2_POLLED:
    s_set_gpr_idx_on s61, gpr_idx(SRC0)
    s_nop 0
    v_bfe_u32 v179, v76, s62, 11
    s_set_gpr_idx_idx s63
    s_nop 0
    v_bfe_u32 v73, v76, s64, 11
    s_set_gpr_idx_off
    v_sub_u32 v73, v73, v179
    v_cndmask_b32 v73, 0, v73, s[56:57]
    v_and_b32 v1, 1, v177
    v_add_u32 v1, s23, v1
    v_sub_u32 v180, v73, v1
    v_add_u32 v179, v179, v1
    v_mul_u32_u24 v181, 20608, v178
    v_lshl_add_u32 v181, v179, 4, v181
    v_cmp_lt_i32 s[40:41], 0, v180
    v_cmp_lt_i32 s[42:43], 2, v180
    v_cmp_lt_i32 s[44:45], 4, v180
    v_cmp_lt_i32 s[46:47], 6, v180
    v_cmp_lt_i32 s[48:49], 8, v180
    v_cmp_lt_i32 s[50:51], 10, v180
    v_cmp_lt_i32 s[90:91], 12, v180
    v_cmp_lt_i32 s[92:93], 14, v180
    v_cmp_lt_i32 s[94:95], 16, v180
    v_cmp_lt_i32 s[96:97], 18, v180
    s_mov_b64 exec, s[40:41]
    s_cbranch_execz K2_LD_DONE
    buffer_load_dwordx4 v[0:3], v181, s[8:11], 0 offen offset:0 sc1
    s_mov_b64 exec, s[42:43]
    s_cbranch_execz K2_LD_DONE
    buffer_load_dwordx4 v[4:7], v181, s[8:11], 0 offen offset:32 sc1
    s_mov_b64 exec, s[44:45]
    s_cbranch_execz K2_LD_DONE
    buffer_load_dwordx4 v[8:11], v181, s[8:11], 0 offen offset:64 sc1
    s_mov_b64 exec, s[46:47]
    s_cbranch_execz K2_LD_DONE
    buffer_load_dwordx4 v[12:15], v181, s[8:11], 0 offen offset:96 sc1
    s_mov_b64 exec, s[48:49]
    s_cbranch_execz K2_LD_DONE
    buffer_load_dwordx4 v[16:19], v181, s[8:11], 0 offen offset:128 sc1
    s_mov_b64 exec, s[50:51]
    s_cbranch_execz K2_LD_DONE
    buffer_load_dwordx4 v[20:23], v181, s[8:11], 0 offen offset:160 sc1
    s_mov_b64 exec, s[90:91]
    s_cbranch_execz K2_LD_DONE
    buffer_load_dwordx4 v[24:27], v181, s[8:11], 0 offen offset:192 sc1
    s_mov_b64 exec, s[92:93]
    s_cbranch_execz K2_LD_DONE
    buffer_load_dwordx4 v[28:31], v181, s[8:11], 0 offen offset:224 sc1
    s_mov_b64 exec, s[94:95]
    s_cbranch_execz K2_LD_DONE
    buffer_load_dwordx4 v[32:35], v181, s[8:11], 0 offen offset:256 sc1
    s_mov_b64 exec, s[96:97]
    s_cbranch_execz K2_LD_DONE
    buffer_load_dwordx4 v[36:39], v181, s[8:11], 0 offen offset:288 sc1
K2_LD_DONE:
    s_mov_b64 exec, -1
    s_cmp_eq_u32 s28, 0
    s_cbranch_scc1 K2_NOWRAW
    v_lshrrev_b32 v60, 5, v176
    v_bfe_u32 v61, v176, 2, 2
    v_lshl_add_u32 v60, v60, 2, v61
    v_mul_u32_u24 v60, 1280, v60
    v_bfe_u32 v61, v176, 4, 1
    v_lshl_add_u32 v60, v61, 5, v60
    v_and_b32 v61, 3, v176
    v_lshl_add_u32 v60, v61, 3, v60
    ds_read_b64_tr_b16 v[136:137], v60 offset:24576
    ds_read_b64_tr_b16 v[138:139], v60 offset:34816
    ds_read_b64_tr_b16 v[140:141], v60 offset:24640
    ds_read_b64_tr_b16 v[142:143], v60 offset:34880
    ds_read_b64_tr_b16 v[144:145], v60 offset:24832
    ds_read_b64_tr_b16 v[146:147], v60 offset:35072
    ds_read_b64_tr_b16 v[148:149], v60 offset:24896
    ds_read_b64_tr_b16 v[150:151], v60 offset:35136
    ds_read_b64_tr_b16 v[152:153], v60 offset:25088
    ds_read_b64_tr_b16 v[154:155], v60 offset:35328
    ds_read_b64_tr_b16 v[156:157], v60 offset:25152
    ds_read_b64_tr_b16 v[158:159], v60 offset:35392
    ds_read_b64_tr_b16 v[160:161], v60 offset:25344
    ds_read_b64_tr_b16 v[162:163], v60 offset:35584
    ds_read_b64_tr_b16 v[164:165], v60 offset:25408
    ds_read_b64_tr_b16 v[166:167], v60 offset:35648
    ds_read_b64_tr_b16 v[168:169], v60 offset:25600
    ds_read_b64_tr_b16 v[170:171], v60 offset:35840
    ds_read_b64_tr_b16 v[172:173], v60 offset:25664
    ds_read_b64_tr_b16 v[174:175], v60 offset:35904
    s_waitcnt lgkmcnt(0)
    v_lshlrev_b32 v96, 16, v136
    v_and_b32 v97, 0xffff0000, v136
    v_lshlrev_b32 v98, 16, v137
    v_and_b32 v99, 0xffff0000, v137
    v_lshlrev_b32 v100, 16, v138
    v_and_b32 v101, 0xffff0000, v138
    v_lshlrev_b32 v102, 16, v139
    v_and_b32 v103, 0xffff0000, v139
    v_lshlrev_b32 v104, 16, v140
    v_and_b32 v105, 0xffff0000, v140
    v_lshlrev_b32 v106, 16, v141
    v_and_b32 v107, 0xffff0000, v141
    v_lshlrev_b32 v108, 16, v142
    v_and_b32 v109, 0xffff0000, v142
    v_lshlrev_b32 v110, 16, v143
    v_and_b32 v111, 0xffff0000, v143
    v_lshlrev_b32 v112, 16, v144
    v_and_b32 v113, 0xffff0000, v144
    v_lshlrev_b32 v114, 16, v145
    v_and_b32 v115, 0xffff0000, v145
    v_lshlrev_b32 v116, 16, v146
    v_and_b32 v117, 0xffff0000, v146
    v_lshlrev_b32 v118, 16, v147
    v_and_b32 v119, 0xffff0000, v147
    v_lshlrev_b32 v120, 16, v148
    v_and_b32 v121, 0xffff0000, v148
    v_lshlrev_b32 v122, 16, v149
    v_and_b32 v123, 0xffff0000, v149
    v_lshlrev_b32 v124, 16, v150
    v_and_b32 v125, 0xffff0000, v150
    v_lshlrev_b32 v126, 16, v151
    v_and_b32 v127, 0xffff0000, v151
    v_lshlrev_b32 v128, 16, v152
    v_and_b32 v129, 0xffff0000, v152
    v_lshlrev_b32 v130, 16, v153
    v_and_b32 v131, 0xffff0000, v153
    v_lshlrev_b32 v132, 16, v154
    v_and_b32 v133, 0xffff0000, v154
    v_lshlrev_b32 v134, 16, v155
    v_and_b32 v135, 0xffff0000, v155
    v_lshlrev_b32 v136, 16, v156
    v_and_b32 v137, 0xffff0000, v156
    v_lshlrev_b32 v138, 16, v157
    v_and_b32 v139, 0xffff0000, v157
    v_lshlrev_b32 v140, 16, v158
    v_and_b32 v141, 0xffff0000, v158
    v_lshlrev_b32 v142, 16, v159
    v_and_b32 v143, 0xffff0000, v159
    v_lshlrev_b32 v144, 16, v160
    v_and_b32 v145, 0xffff0000, v160
    v_lshlrev_b32 v146, 16, v161
    v_and_b32 v147, 0xffff0000, v161
    v_lshlrev_b32 v148, 16, v162
    v_and_b32 v149, 0xffff0000, v162
    v_lshlrev_b32 v150, 16, v163
    v_and_b32 v151, 0xffff0000, v163
    v_lshlrev_b32 v152, 16, v164
    v_and_b32 v153, 0xffff0000, v164
    v_lshlrev_b32 v154, 16, v165
    v_and_b32 v155, 0xffff0000, v165
    v_lshlrev_b32 v156, 16, v166
    v_and_b32 v157, 0xffff0000, v166
    v_lshlrev_b32 v158, 16, v167
    v_and_b32 v159, 0xffff0000, v167
    v_lshlrev_b32 v160, 16, v168
    v_and_b32 v161, 0xffff0000, v168
    v_lshlrev_b32 v162, 16, v169
    v_and_b32 v163, 0xffff0000, v169
    v_lshlrev_b32 v164, 16, v170
    v_and_b32 v165, 0xffff0000, v170
    v_lshlrev_b32 v166, 16, v171
    v_and_b32 v167, 0xffff0000, v171
    v_lshlrev_b32 v168, 16, v172
    v_and_b32 v169, 0xffff0000, v172
    v_lshlrev_b32 v170, 16, v173
    v_and_b32 v171, 0xffff0000, v173
    v_lshlrev_b32 v172, 16, v174
    v_and_b32 v173, 0xffff0000, v174
    v_lshlrev_b32 v174, 16, v175
    v_and_b32 v175, 0xffff0000, v175
K2_NOWRAW:
    v_mul_u32_u24 v178, 1280, v178
    v_add_lshl_u32 v179, v179, v178, 2
    s_mov_b32 s66, 7340032
    v_mov_b32 v201, 1
    s_movk_i32 s58, 600
    s_movk_i32 s59, 2400
    s_mov_b32 s60, 0x100000
    s_mov_b32 s61, 0xffff
    v_mov_b32 v202, 65536
    s_cmp_lg_u32 s24, 0
    s_cbranch_scc1 K2_RK_LOAD
    v_cmp_lt_i32 vcc, 20, v180
    s_nop 0
    s_cbranch_vccz K2_NOMORE
    v_mov_b32 v61, 163652
    ds_write_b32 v61, v201
K2_NOMORE:
    v_lshlrev_b32 v72, 4, v176
    s_mov_b32 s64, 7176192
    s_mov_b32 s62, 84736
    s_cmp_eq_u32 s20, 7
    s_waitcnt vmcnt(0)
    s_cbranch_scc1 K2_FLGLD
K2_FLGL2:
    s_mov_b64 exec, s[40:41]
    s_cbranch_execz K2_RK_A
K2_CK0:
    v_bfi_b32 v192, s61, v1, v2
    v_lshrrev_b32 v50, 24, v3
    v_cmp_ne_u32 vcc, s2, v192
    v_add_u32 v40, 163424, v50
    s_cbranch_vccnz K2_RT0
    ds_add_rtn_u32 v40, v40, v201
    v_mad_u32_u24 v50, v50, s58, v202
    s_mov_b64 exec, s[42:43]
    s_cbranch_execz K2_RK_A
K2_CK1:
    v_bfi_b32 v192, s61, v5, v6
    v_lshrrev_b32 v51, 24, v7
    v_cmp_ne_u32 vcc, s2, v192
    v_add_u32 v41, 163424, v51
    s_cbranch_vccnz K2_RT1
    ds_add_rtn_u32 v41, v41, v201
    v_mad_u32_u24 v51, v51, s58, v202
    s_mov_b64 exec, s[44:45]
    s_cbranch_execz K2_RK_A
K2_CK2:
    v_bfi_b32 v192, s61, v9, v10
    v_lshrrev_b32 v52, 24, v11
    v_cmp_ne_u32 vcc, s2, v192
    v_add_u32 v42, 163424, v52
    s_cbranch_vccnz K2_RT2
    ds_add_rtn_u32 v42, v42, v201
    v_mad_u32_u24 v52, v52, s58, v202
    s_mov_b64 exec, s[46:47]
    s_cbranch_execz K2_RK_A
K2_CK3:
    v_bfi_b32 v192, s61, v13, v14
    v_lshrrev_b32 v53, 24, v15
    v_cmp_ne_u32 vcc, s2, v192
    v_add_u32 v43, 163424, v53
    s_cbranch_vccnz K2_RT3
    ds_add_rtn_u32 v43, v43, v201
    v_mad_u32_u24 v53, v53, s58, v202
    s_mov_b64 exec, s[48:49]
    s_cbranch_execz K2_RK_A
K2_CK4:
    v_bfi_b32 v192, s61, v17, v18
    v_lshrrev_b32 v54, 24, v19
    v_cmp_ne_u32 vcc, s2, v192
    v_add_u32 v44, 163424, v54
    s_cbranch_vccnz K2_RT4
    ds_add_rtn_u32 v44, v44, v201
    v_mad_u32_u24 v54, v54, s58, v202
    s_mov_b64 exec, s[50:51]
    s_cbranch_execz K2_RK_A
K2_CK5:
    v_bfi_b32 v192, s61, v21, v22
    v_lshrrev_b32 v55, 24, v23
    v_cmp_ne_u32 vcc, s2, v192
    v_add_u32 v45, 163424, v55
    s_cbranch_vccnz K2_RT5
    ds_add_rtn_u32 v45, v45, v201
    v_mad_u32_u24 v55, v55, s58, v202
    s_mov_b64 exec, s[90:91]
    s_cbranch_execz K2_RK_A
K2_CK6:
    v_bfi_b32 v192, s61, v25, v26
    v_lshrrev_b32 v56, 24, v27
    v_cmp_ne_u32 vcc, s2, v192
    v_add_u32 v46, 163424, v56
    s_cbranch_vccnz K2_RT6
    ds_add_rtn_u32 v46, v46, v201
    v_mad_u32_u24 v56, v56, s58, v202
    s_mov_b64 exec, s[92:93]
    s_cbranch_execz K2_RK_A
K2_CK7:
    v_bfi_b32 v192, s61, v29, v30
    v_lshrrev_b32 v57, 24, v31
    v_cmp_ne_u32 vcc, s2, v192
    v_add_u32 v47, 163424, v57
    s_cbranch_vccnz K2_RT7
    ds_add_rtn_u32 v47, v47, v201
    v_mad_u32_u24 v57, v57, s58, v202
    s_mov_b64 exec, s[94:95]
    s_cbranch_execz K2_RK_A
K2_CK8:
    v_bfi_b32 v192, s61, v33, v34
    v_lshrrev_b32 v58, 24, v35
    v_cmp_ne_u32 vcc, s2, v192
    v_add_u32 v48, 163424, v58
    s_cbranch_vccnz K2_RT8
    ds_add_rtn_u32 v48, v48, v201
    v_mad_u32_u24 v58, v58, s58, v202
    s_mov_b64 exec, s[96:97]
    s_cbranch_execz K2_RK_A
K2_CK9:
    v_bfi_b32 v192, s61, v37, v38
    v_lshrrev_b32 v59, 24, v39
    v_cmp_ne_u32 vcc, s2, v192
    v_add_u32 v49, 163424, v59
    s_cbranch_vccnz K2_RT9
    ds_add_rtn_u32 v49, v49, v201
    v_mad_u32_u24 v59, v59, s58, v202
K2_RK_A:
    s_mov_b64 exec, -1
    s_mov_b64 exec, s[40:41]
    s_cbranch_execz K2_TP
    v_cmp_gt_u32 vcc, s62, v50
    v_and_b32 v3, 0xffffff, v3
    s_mov_b64 exec, vcc
    buffer_load_dword v245, v3, s[16:19], 0 offen
    s_mov_b64 exec, s[42:43]
    s_cbranch_execz K2_TP
    v_cmp_gt_u32 vcc, s62, v51
    v_and_b32 v7, 0xffffff, v7
    s_mov_b64 exec, vcc
    buffer_load_dword v245, v7, s[16:19], 0 offen
    s_mov_b64 exec, s[44:45]
    s_cbranch_execz K2_TP
    v_cmp_gt_u32 vcc, s62, v52
    v_and_b32 v11, 0xffffff, v11
    s_mov_b64 exec, vcc
    buffer_load_dword v245, v11, s[16:19], 0 offen
    s_mov_b64 exec, s[46:47]
    s_cbranch_execz K2_TP
    v_cmp_gt_u32 vcc, s62, v53
    v_and_b32 v15, 0xffffff, v15
    s_mov_b64 exec, vcc
    buffer_load_dword v245, v15, s[16:19], 0 offen
    s_mov_b64 exec, s[48:49]
    s_cbranch_execz K2_TP
    v_cmp_gt_u32 vcc, s62, v54
    v_and_b32 v19, 0xffffff, v19
    s_mov_b64 exec, vcc
    buffer_load_dword v245, v19, s[16:19], 0 offen
    s_mov_b64 exec, s[50:51]
    s_cbranch_execz K2_TP
    v_cmp_gt_u32 vcc, s62, v55
    v_and_b32 v23, 0xffffff, v23
    s_mov_b64 exec, vcc
    buffer_load_dword v245, v23, s[16:19], 0 offen
    s_mov_b64 exec, s[90:91]
    s_cbranch_execz K2_TP
    v_cmp_gt_u32 vcc, s62, v56
    v_and_b32 v27, 0xffffff, v27
    s_mov_b64 exec, vcc
    buffer_load_dword v245, v27, s[16:19], 0 offen
    s_mov_b64 exec, s[92:93]
    s_cbranch_execz K2_TP
    v_cmp_gt_u32 vcc, s62, v57
    v_and_b32 v31, 0xffffff, v31
    s_mov_b64 exec, vcc
    buffer_load_dword v245, v31, s[16:19], 0 offen
    s_mov_b64 exec, s[94:95]
    s_cbranch_execz K2_TP
    v_cmp_gt_u32 vcc, s62, v58
    v_and_b32 v35, 0xffffff, v35
    s_mov_b64 exec, vcc
    buffer_load_dword v245, v35, s[16:19], 0 offen
    s_mov_b64 exec, s[96:97]
    s_cbranch_execz K2_TP
    v_cmp_gt_u32 vcc, s62, v59
    v_and_b32 v39, 0xffffff, v39
    s_mov_b64 exec, vcc
    buffer_load_dword v245, v39, s[16:19], 0 offen
K2_TP:
    s_mov_b64 exec, -1
K2_RK_DONE:
    s_mul_i32 s67, s24, 48
    s_waitcnt lgkmcnt(0)
    s_mov_b64 exec, s[40:41]
    s_cbranch_execz K2_SC_DONE
    v_cmpx_gt_u32 vcc, 48, v40
    v_lshl_add_u32 v194, v40, 5, v50
    v_lshl_add_u32 v195, v40, 2, v50
    v_lshrrev_b32 v193, 3, v40
    v_mad_i32_i24 v196, v193, -16, v195
    v_and_b32 v193, 1, v193
    v_mad_i32_i24 v196, v193, -14, v196
    ds_write_b32 v194, v3 offset:864
    ds_write_b16 v195, v0 offset:194
    ds_write_b16_d16_hi v195, v0 offset:386
    ds_write_b16_d16_hi v195, v1 offset:578
    ds_write_b16 v196, v2 offset:768
    s_cmp_lg_u64 exec, s[40:41]
    s_cbranch_scc1 K2_OV0
K2_OB0:
    s_mov_b64 exec, s[42:43]
    s_cbranch_execz K2_SC_DONE
    v_cmpx_gt_u32 vcc, 48, v41
    v_lshl_add_u32 v194, v41, 5, v51
    v_lshl_add_u32 v195, v41, 2, v51
    v_lshrrev_b32 v193, 3, v41
    v_mad_i32_i24 v196, v193, -16, v195
    v_and_b32 v193, 1, v193
    v_mad_i32_i24 v196, v193, -14, v196
    ds_write_b32 v194, v7 offset:864
    ds_write_b16 v195, v4 offset:194
    ds_write_b16_d16_hi v195, v4 offset:386
    ds_write_b16_d16_hi v195, v5 offset:578
    ds_write_b16 v196, v6 offset:768
    s_cmp_lg_u64 exec, s[42:43]
    s_cbranch_scc1 K2_OV1
K2_OB1:
    s_mov_b64 exec, s[44:45]
    s_cbranch_execz K2_SC_DONE
    v_cmpx_gt_u32 vcc, 48, v42
    v_lshl_add_u32 v194, v42, 5, v52
    v_lshl_add_u32 v195, v42, 2, v52
    v_lshrrev_b32 v193, 3, v42
    v_mad_i32_i24 v196, v193, -16, v195
    v_and_b32 v193, 1, v193
    v_mad_i32_i24 v196, v193, -14, v196
    ds_write_b32 v194, v11 offset:864
    ds_write_b16 v195, v8 offset:194
    ds_write_b16_d16_hi v195, v8 offset:386
    ds_write_b16_d16_hi v195, v9 offset:578
    ds_write_b16 v196, v10 offset:768
    s_cmp_lg_u64 exec, s[44:45]
    s_cbranch_scc1 K2_OV2
K2_OB2:
    s_mov_b64 exec, s[46:47]
    s_cbranch_execz K2_SC_DONE
    v_cmpx_gt_u32 vcc, 48, v43
    v_lshl_add_u32 v194, v43, 5, v53
    v_lshl_add_u32 v195, v43, 2, v53
    v_lshrrev_b32 v193, 3, v43
    v_mad_i32_i24 v196, v193, -16, v195
    v_and_b32 v193, 1, v193
    v_mad_i32_i24 v196, v193, -14, v196
    ds_write_b32 v194, v15 offset:864
    ds_write_b16 v195, v12 offset:194
    ds_write_b16_d16_hi v195, v12 offset:386
    ds_write_b16_d16_hi v195, v13 offset:578
    ds_write_b16 v196, v14 offset:768
    s_cmp_lg_u64 exec, s[46:47]
    s_cbranch_scc1 K2_OV3
K2_OB3:
    s_mov_b64 exec, s[48:49]
    s_cbranch_execz K2_SC_DONE
    v_cmpx_gt_u32 vcc, 48, v44
    v_lshl_add_u32 v194, v44, 5, v54
    v_lshl_add_u32 v195, v44, 2, v54
    v_lshrrev_b32 v193, 3, v44
    v_mad_i32_i24 v196, v193, -16, v195
    v_and_b32 v193, 1, v193
    v_mad_i32_i24 v196, v193, -14, v196
    ds_write_b32 v194, v19 offset:864
    ds_write_b16 v195, v16 offset:194
    ds_write_b16_d16_hi v195, v16 offset:386
    ds_write_b16_d16_hi v195, v17 offset:578
    ds_write_b16 v196, v18 offset:768
    s_cmp_lg_u64 exec, s[48:49]
    s_cbranch_scc1 K2_OV4
K2_OB4:
    s_mov_b64 exec, s[50:51]
    s_cbranch_execz K2_SC_DONE
    v_cmpx_gt_u32 vcc, 48, v45
    v_lshl_add_u32 v194, v45, 5, v55
    v_lshl_add_u32 v195, v45, 2, v55
    v_lshrrev_b32 v193, 3, v45
    v_mad_i32_i24 v196, v193, -16, v195
    v_and_b32 v193, 1, v193
    v_mad_i32_i24 v196, v193, -14, v196
    ds_write_b32 v194, v23 offset:864
    ds_write_b16 v195, v20 offset:194
    ds_write_b16_d16_hi v195, v20 offset:386
    ds_write_b16_d16_hi v195, v21 offset:578
    ds_write_b16 v196, v22 offset:768
    s_cmp_lg_u64 exec, s[50:51]
    s_cbranch_scc1 K2_OV5
K2_OB5:
    s_mov_b64 exec, s[90:91]
    s_cbranch_execz K2_SC_DONE
    v_cmpx_gt_u32 vcc, 48, v46
    v_lshl_add_u32 v194, v46, 5, v56
    v_lshl_add_u32 v195, v46, 2, v56
    v_lshrrev_b32 v193, 3, v46
    v_mad_i32_i24 v196, v193, -16, v195
    v_and_b32 v193, 1, v193
    v_mad_i32_i24 v196, v193, -14, v196
    ds_write_b32 v194, v27 offset:864
    ds_write_b16 v195, v24 offset:194
    ds_write_b16_d16_hi v195, v24 offset:386
    ds_write_b16_d16_hi v195, v25 offset:578
    ds_write_b16 v196, v26 offset:768
    s_cmp_lg_u64 exec, s[90:91]
    s_cbranch_scc1 K2_OV6
K2_OB6:
    s_mov_b64 exec, s[92:93]
    s_cbranch_execz K2_SC_DONE
    v_cmpx_gt_u32 vcc, 48, v47
    v_lshl_add_u32 v194, v47, 5, v57
    v_lshl_add_u32 v195, v47, 2, v57
    v_lshrrev_b32 v193, 3, v47
    v_mad_i32_i24 v196, v193, -16, v195
    v_and_b32 v193, 1, v193
    v_mad_i32_i24 v196, v193, -14, v196
    ds_write_b32 v194, v31 offset:864
    ds_write_b16 v195, v28 offset:194
    ds_write_b16_d16_hi v195, v28 offset:386
    ds_write_b16_d16_hi v195, v29 offset:578
    ds_write_b16 v196, v30 offset:768
    s_cmp_lg_u64 exec, s[92:93]
    s_cbranch_scc1 K2_OV7
K2_OB7:
    s_mov_b64 exec, s[94:95]
    s_cbranch_execz K2_SC_DONE
    v_cmpx_gt_u32 vcc, 48, v48
    v_lshl_add_u32 v194, v48, 5, v58
    v_lshl_add_u32 v195, v48, 2, v58
    v_lshrrev_b32 v193, 3, v48
    v_mad_i32_i24 v196, v193, -16, v195
    v_and_b32 v193, 1, v193
    v_mad_i32_i24 v196, v193, -14, v196
    ds_write_b32 v194, v35 offset:864
    ds_write_b16 v195, v32 offset:194
    ds_write_b16_d16_hi v195, v32 offset:386
    ds_write_b16_d16_hi v195, v33 offset:578
    ds_write_b16 v196, v34 offset:768
    s_cmp_lg_u64 exec, s[94:95]
    s_cbranch_scc1 K2_OV8
K2_OB8:
    s_mov_b64 exec, s[96:97]
    s_cbranch_execz K2_SC_DONE
    v_cmpx_gt_u32 vcc, 48, v49
    v_lshl_add_u32 v194, v49, 5, v59
    v_lshl_add_u32 v195, v49, 2, v59
    v_lshrrev_b32 v193, 3, v49
    v_mad_i32_i24 v196, v193, -16, v195
    v_and_b32 v193, 1, v193
    v_mad_i32_i24 v196, v193, -14, v196
    ds_write_b32 v194, v39 offset:864
    ds_write_b16 v195, v36 offset:194
    ds_write_b16_d16_hi v195, v36 offset:386
    ds_write_b16_d16_hi v195, v37 offset:578
    ds_write_b16 v196, v38 offset:768
    s_cmp_lg_u64 exec, s[96:97]
    s_cbranch_scc1 K2_OV9
K2_OB9:
K2_SC_DONE:
    s_mov_b64 exec, -1
    v_lshlrev_b32 v192, 2, v176
    v_add_u32 v192, 163424, v192
    v_mov_b32 v200, 163652
    v_mov_b32 v198, 0
    s_movk_i32 s26, 48
    s_cmp_eq_u32 s20, 7
    s_cbranch_scc1 K2_FLGCK
K2_FLGOK:
    s_waitcnt lgkmcnt(0)
    s_barrier
    ds_read_b32 v193, v192
    ds_read_b32 v200, v200
    v_cmp_gt_u32 s[56:57], s22, v176
    v_mad_u32_u24 v195, v176, s59, v202
    v_lshl_or_b32 v195, v176, 21, v195
    s_waitcnt lgkmcnt(0)
    v_cndmask_b32 v193, 0, v193, s[56:57]
    v_readfirstlane_b32 s27, v200
    v_cmp_lt_u32 vcc, 48, v193
    s_nop 0
    s_cbranch_vccnz K2_BIG
K2_TOK:
    v_subrev_u32 v194, s67, v193
    v_max_i32 v194, 1, v194
    v_min_i32 v194, s26, v194
    v_add_u32 v194, 15, v194
    v_lshrrev_b32 v194, 4, v194
    v_lshl_or_b32 v195, v194, 18, v195
    v_or_b32 v195, v195, v198
    v_mov_b32 v197, 425056
    v_cndmask_b32 v253, v197, v195, s[56:57]
    s_movk_i32 s40, 0
    s_movk_i32 s41, 256
    s_movk_i32 s42, 512
    s_movk_i32 s43, 768
    s_add_u32 s24, s24, 1
    s_cmp_ge_u32 s24, s25
    s_cselect_b32 s55, 1, 0
    s_cmp_eq_u32 s27, 0
    s_cselect_b32 s55, s55, 0
    s_mov_b32 s38, 0
    s_mov_b32 s34, 0
    s_mov_b32 s35, 0
    s_mov_b32 s36, 1
    s_mov_b32 s31, 0
    s_mov_b32 s58, s20
    v_readlane_b32 s3, v253, s58
    s_lshl_b32 s44, s34, 7
    s_lshl_b32 s60, s58, 5
    s_and_b32 s48, s3, 0x3ffff
    s_bfe_u32 s33, s3, 0x30012
    s_sub_u32 s60, s60, s48
    s_and_b32 s60, s60, 0xff
    s_add_u32 s60, s60, s48
    s_mul_i32 s35, s38, 6
    s_cmp_eq_u32 s34, 0
    s_cselect_b32 s35, s35, s60
    s_mov_b32 s45, s44
    s_add_u32 s47, s44, 256
    s_add_u32 s49, s48, 32
    s_add_u32 s60, s48, 64
    s_cmp_eq_u32 s33, 3
    s_cselect_b32 s46, s44, s47
    s_cselect_b32 s50, s60, s48
    s_cselect_b32 s51, s48, s49
    s_sub_u32 s60, s33, 2
    s_cmp_lt_u32 s60, 2
    s_cbranch_scc0 K2_rare_1
K2_back_2:
    v_add_u32 v233, s48, v230
    ds_read_b32 v232, v233
    ds_read_b32 v233, v233 offset:1024
    v_add_u32 v222, s48, v251
    ds_read_b32 v222, v222
    v_add_u32 v224, s49, v251
    ds_read_b32 v224, v224
    v_add_u32 v226, s50, v251
    ds_read_b32 v226, v226
    v_add_u32 v228, s51, v251
    ds_read_b32 v228, v228
    s_waitcnt lgkmcnt(4)
    v_or_b32 v232, v232, v231
    v_or_b32 v233, v233, v231
    s_cmp_lg_u32 s34, 0
    s_cbranch_scc1 K2_dum_4
    s_add_u32 m0, s48, 864
    s_add_u32 s65, s48, 1888
    buffer_load_dwordx4 v232, s[16:19], 0 offen  lds
    s_mov_b32 m0, s65
    s_mov_b32 exec_hi, 0
    buffer_load_dwordx4 v233, s[16:19], 0 offen  lds
    s_cmp_eq_u32 s33, 4
    s_cbranch_scc1 K2_a4_5
K2_b4_7:
    s_mov_b32 exec_hi, -1
K2_back_6:
    s_waitcnt lgkmcnt(3)
    v_mad_u32_u16 v223, v222, s39, v248 op_sel:[1,0,0,0]
    v_mad_u32_u16 v222, v222, s39, v248
    s_waitcnt lgkmcnt(2)
    v_mad_u32_u16 v225, v224, s39, v248 op_sel:[1,0,0,0]
    v_mad_u32_u16 v224, v224, s39, v248
    s_waitcnt lgkmcnt(1)
    v_mad_u32_u16 v227, v226, s39, v248 op_sel:[1,0,0,0]
    v_mad_u32_u16 v226, v226, s39, v248
    s_waitcnt lgkmcnt(0)
    v_mad_u32_u16 v229, v228, s39, v248 op_sel:[1,0,0,0]
    v_mad_u32_u16 v228, v228, s39, v248
    s_mov_b32 m0, s68
    s_nop 0
    buffer_load_dwordx4 v222, s[4:7], s44 offen sc1 lds
    buffer_load_dwordx4 v223, s[72:75], s44 offen offset:1024 sc1 lds
    s_mov_b32 m0, s69
    s_nop 0
    buffer_load_dwordx4 v224, s[4:7], s45 offen sc1 lds
    buffer_load_dwordx4 v225, s[72:75], s45 offen offset:1024 sc1 lds
    s_mov_b32 m0, s70
    s_nop 0
    buffer_load_dwordx4 v226, s[4:7], s46 offen sc1 lds
    buffer_load_dwordx4 v227, s[72:75], s46 offen offset:1024 sc1 lds
    s_mov_b32 m0, s71
    s_nop 0
    buffer_load_dwordx4 v228, s[4:7], s47 offen sc1 lds
    buffer_load_dwordx4 v229, s[72:75], s47 offen offset:1024 sc1 lds
    v_add_u32 v249, s48, v249
    v_add_u32 v250, s48, v250
    s_waitcnt vmcnt(6)
    ds_read_b64_tr_b16 v[176:177], v246 offset:0
    ds_read_b64_tr_b16 v[178:179], v246 offset:512
    ds_read_b64_tr_b16 v[180:181], v247 offset:0
    ds_read_b64_tr_b16 v[182:183], v247 offset:512
    ds_read_b64_tr_b16 v[0:1], v249 offset:0
    ds_read_b64_tr_b16 v[2:3], v249 offset:128
    ds_read_b128 v[4:7], v250 offset:0
    ds_read_b128 v[8:11], v250 offset:16
    ds_read_b128 v[12:15], v250 offset:384
    ds_read_b128 v[16:19], v250 offset:400
    ds_read_b64_tr_b16 v[20:21], v249 offset:512
    ds_read_b64_tr_b16 v[22:23], v249 offset:640
    ds_read_b128 v[24:27], v250 offset:64
    ds_read_b128 v[28:31], v250 offset:80
    ds_read_b128 v[32:35], v250 offset:448
    ds_read_b128 v[36:39], v250 offset:464
    s_mov_b32 s29, s48
    s_mov_b32 s32, s31
    s_mov_b32 s30, s3
    s_mov_b32 s31, s35
    s_cmp_eq_u32 s33, 2
    s_cbranch_scc1 K2_U20
    s_cmp_eq_u32 s33, 3
    s_cbranch_scc1 K2_U30
    s_cmp_eq_u32 s33, 1
    s_cbranch_scc1 K2_U10
    s_branch K2_U40
K2_U20:
    s_setprio 1
    s_waitcnt lgkmcnt(6)
    v_lshlrev_b32 v40, 16, v0
    v_and_b32 v41, 0xffff0000, v0
    v_lshlrev_b32 v42, 16, v1
    v_and_b32 v43, 0xffff0000, v1
    v_lshlrev_b32 v44, 16, v2
    v_and_b32 v45, 0xffff0000, v2
    v_lshlrev_b32 v46, 16, v3
    v_and_b32 v47, 0xffff0000, v3
    v_mul_f32 v4, v40, v4
    v_mul_f32 v5, v41, v5
    v_mul_f32 v6, v42, v6
    v_mul_f32 v7, v43, v7
    v_mul_f32 v8, v44, v8
    v_mul_f32 v9, v45, v9
    v_mul_f32 v10, v46, v10
    v_mul_f32 v11, v47, v11
    v_cvt_pk_bf16_f32 v64, v4, v5
    v_cvt_pk_bf16_f32 v65, v6, v7
    v_cvt_pk_bf16_f32 v66, v8, v9
    v_cvt_pk_bf16_f32 v67, v10, v11
    v_mul_f32 v12, v40, v12
    v_mul_f32 v13, v41, v13
    v_mul_f32 v14, v42, v14
    v_mul_f32 v15, v43, v15
    v_mul_f32 v16, v44, v16
    v_mul_f32 v17, v45, v17
    v_mul_f32 v18, v46, v18
    v_mul_f32 v19, v47, v19
    v_cvt_pk_bf16_f32 v68, v12, v13
    v_cvt_pk_bf16_f32 v69, v14, v15
    v_cvt_pk_bf16_f32 v70, v16, v17
    v_cvt_pk_bf16_f32 v71, v18, v19
    s_waitcnt lgkmcnt(0)
    v_lshlrev_b32 v48, 16, v20
    v_and_b32 v49, 0xffff0000, v20
    v_lshlrev_b32 v50, 16, v21
    v_and_b32 v51, 0xffff0000, v21
    v_lshlrev_b32 v52, 16, v22
    v_and_b32 v53, 0xffff0000, v22
    v_lshlrev_b32 v54, 16, v23
    v_and_b32 v55, 0xffff0000, v23
    v_mul_f32 v24, v48, v24
    v_mul_f32 v25, v49, v25
    v_mul_f32 v26, v50, v26
    v_mul_f32 v27, v51, v27
    v_mul_f32 v28, v52, v28
    v_mul_f32 v29, v53, v29
    v_mul_f32 v30, v54, v30
    v_mul_f32 v31, v55, v31
    v_cvt_pk_bf16_f32 v72, v24, v25
    v_cvt_pk_bf16_f32 v73, v26, v27
    v_cvt_pk_bf16_f32 v74, v28, v29
    v_cvt_pk_bf16_f32 v75, v30, v31
    v_mul_f32 v32, v48, v32
    v_mul_f32 v33, v49, v33
    v_mul_f32 v34, v50, v34
    v_mul_f32 v35, v51, v35
    v_mul_f32 v36, v52, v36
    v_mul_f32 v37, v53, v37
    v_mul_f32 v38, v54, v38
    v_mul_f32 v39, v55, v39
    v_cvt_pk_bf16_f32 v76, v32, v33
    v_cvt_pk_bf16_f32 v77, v34, v35
    v_cvt_pk_bf16_f32 v78, v36, v37
    v_cvt_pk_bf16_f32 v79, v38, v39
    s_waitcnt vmcnt(4)
    v_mfma_f32_32x32x16_bf16 v[0:15], v[64:67], v[176:179], 0
    ds_read_b64_tr_b16 v[184:185], v246 offset:2048
    ds_read_b64_tr_b16 v[186:187], v246 offset:2560
    ds_read_b64_tr_b16 v[188:189], v247 offset:2048
    ds_read_b64_tr_b16 v[190:191], v247 offset:2560
    s_mov_b32 m0, s68
    v_mfma_f32_32x32x16_bf16 v[16:31], v[68:71], v[176:179], 0
    buffer_load_dwordx4 v222, s[4:7], s42 offen sc1 lds
    buffer_load_dwordx4 v223, s[72:75], s42 offen offset:1024 sc1 lds
    v_permlane32_swap_b32 v242, v236
    v_permlane32_swap_b32 v243, v237
    s_add_u32 s38, s38, 1
    v_mfma_f32_32x32x16_bf16 v[32:47], v[64:67], v[180:183], 0
    v_permlane32_swap_b32 v244, v238
    v_permlane32_swap_b32 v245, v239
    v_permlane32_swap_b32 v240, v241
    v_add_f32 v242, v242, v236
    v_mfma_f32_32x32x16_bf16 v[48:63], v[68:71], v[180:183], 0
    v_add_f32 v243, v243, v237
    v_add_f32 v244, v244, v238
    v_add_f32 v245, v245, v239
    v_add_f32 v240, -v240, -v241
    v_mov_b32 v254, s52
    v_mov_b32 v255, s38
    s_waitcnt vmcnt(4) lgkmcnt(0)
    v_mfma_f32_32x32x16_bf16 v[0:15], v[72:75], v[184:187], v[0:15]
    ds_read_b64_tr_b16 v[176:177], v246 offset:4096
    ds_read_b64_tr_b16 v[178:179], v246 offset:4608
    ds_read_b64_tr_b16 v[180:181], v247 offset:4096
    ds_read_b64_tr_b16 v[182:183], v247 offset:4608
    s_lshl_b32 s58, s38, 3
    s_add_u32 s58, s58, s20
    s_mov_b32 m0, s69
    v_mfma_f32_32x32x16_bf16 v[16:31], v[76:79], v[184:187], v[16:31]
    buffer_load_dwordx4 v224, s[4:7], s42 offen sc1 lds
    buffer_load_dwordx4 v225, s[72:75], s42 offen offset:1024 sc1 lds
    s_set_gpr_idx_on s32, gpr_idx(DST)
    s_nop 0
    v_cvt_pk_bf16_f32 v195, v242, v243
    v_cvt_pk_bf16_f32 v196, v244, v245
    v_cvt_pk_bf16_f32 v197, v240, v240
    s_set_gpr_idx_off
    s_mov_b64 exec, 1
    ds_write_b32 v254, v255
    s_mov_b64 exec, -1
    s_cmp_lt_u32 s58, s22
    s_cbranch_scc0 K2_dyn_8
K2_back_9:
    v_readlane_b32 s3, v253, s58
    s_lshl_b32 s44, s34, 7
    s_lshl_b32 s60, s58, 5
    s_and_b32 s48, s3, 0x3ffff
    s_bfe_u32 s33, s3, 0x30012
    s_sub_u32 s60, s60, s48
    s_and_b32 s60, s60, 0xff
    s_add_u32 s60, s60, s48
    s_mul_i32 s35, s38, 6
    s_cmp_eq_u32 s34, 0
    s_cselect_b32 s35, s35, s60
    s_mov_b32 s45, s44
    s_add_u32 s47, s44, 256
    s_add_u32 s49, s48, 32
    s_add_u32 s60, s48, 64
    s_cmp_eq_u32 s33, 3
    s_cselect_b32 s46, s44, s47
    s_cselect_b32 s50, s60, s48
    s_cselect_b32 s51, s48, s49
    s_sub_u32 s60, s33, 2
    s_cmp_lt_u32 s60, 2
    s_cbranch_scc0 K2_rare_14
K2_back_15:
    v_mfma_f32_32x32x16_bf16 v[32:47], v[72:75], v[188:191], v[32:47]
    v_add_u32 v233, s48, v230
    ds_read_b32 v232, v233
    ds_read_b32 v233, v233 offset:1024
    v_mul_f32 v234, v0, v96
    v_mul_f32 v236, v8, v128
    v_fmac_f32 v234, v1, v97
    v_fmac_f32 v236, v9, v129
    v_mfma_f32_32x32x16_bf16 v[48:63], v[76:79], v[188:191], v[48:63]
    s_setprio 0
    v_fmac_f32 v234, v2, v98
    v_fmac_f32 v236, v10, v130
    v_fmac_f32 v234, v3, v99
    v_fmac_f32 v236, v11, v131
    v_fmac_f32 v234, v4, v100
    v_fmac_f32 v236, v12, v132
    v_fmac_f32 v234, v5, v101
    v_fmac_f32 v236, v13, v133
    v_fmac_f32 v234, v6, v102
    v_fmac_f32 v236, v14, v134
    v_fmac_f32 v234, v7, v103
    v_fmac_f32 v236, v15, v135
    v_mul_f32 v238, v16, v128
    v_mul_f32 v240, v24, v128
    v_fmac_f32 v238, v17, v129
    v_fmac_f32 v240, v25, v129
    v_fmac_f32 v238, v18, v130
    v_fmac_f32 v240, v26, v130
    v_fmac_f32 v238, v19, v131
    v_fmac_f32 v240, v27, v131
    v_fmac_f32 v238, v20, v132
    v_fmac_f32 v240, v28, v132
    v_fmac_f32 v238, v21, v133
    v_fmac_f32 v240, v29, v133
    v_fmac_f32 v238, v22, v134
    v_fmac_f32 v240, v30, v134
    v_fmac_f32 v238, v23, v135
    v_fmac_f32 v240, v31, v135
    v_mul_f32 v235, v32, v104
    v_mul_f32 v237, v40, v136
    v_fmac_f32 v235, v33, v105
    v_fmac_f32 v237, v41, v137
    v_fmac_f32 v235, v34, v106
    v_fmac_f32 v237, v42, v138
    v_fmac_f32 v235, v35, v107
    v_fmac_f32 v237, v43, v139
    v_fmac_f32 v235, v36, v108
    v_fmac_f32 v237, v44, v140
    v_fmac_f32 v235, v37, v109
    v_fmac_f32 v237, v45, v141
    v_fmac_f32 v235, v38, v110
    v_fmac_f32 v237, v46, v142
    v_fmac_f32 v235, v39, v111
    v_fmac_f32 v237, v47, v143
    v_mul_f32 v239, v48, v136
    v_mul_f32 v241, v56, v136
    v_fmac_f32 v239, v49, v137
    v_fmac_f32 v241, v57, v137
    s_setprio 1
    s_waitcnt vmcnt(4) lgkmcnt(3)
    v_mfma_f32_32x32x16_bf16 v[0:15], v[64:67], v[176:179], 0
    ds_read_b64_tr_b16 v[184:185], v246 offset:6144
    ds_read_b64_tr_b16 v[186:187], v246 offset:6656
    ds_read_b64_tr_b16 v[188:189], v247 offset:6144
    ds_read_b64_tr_b16 v[190:191], v247 offset:6656
    v_fmac_f32 v239, v50, v138
    v_fmac_f32 v241, v58, v138
    s_mov_b32 m0, s70
    v_mfma_f32_32x32x16_bf16 v[16:31], v[68:71], v[176:179], 0
    buffer_load_dwordx4 v222, s[4:7], s43 offen sc1 lds
    buffer_load_dwordx4 v223, s[72:75], s43 offen offset:1024 sc1 lds
    v_fmac_f32 v239, v51, v139
    v_fmac_f32 v241, v59, v139
    v_fmac_f32 v239, v52, v140
    v_fmac_f32 v241, v60, v140
    v_fmac_f32 v239, v53, v141
    v_mfma_f32_32x32x16_bf16 v[32:47], v[64:67], v[180:183], 0
    v_add_u32 v222, s48, v251
    ds_read_b32 v222, v222
    v_fmac_f32 v241, v61, v141
    v_fmac_f32 v239, v54, v142
    v_fmac_f32 v241, v62, v142
    v_fmac_f32 v239, v55, v143
    v_fmac_f32 v241, v63, v143
    v_mfma_f32_32x32x16_bf16 v[48:63], v[68:71], v[180:183], 0
    v_permlane32_swap_b32 v234, v236
    v_permlane32_swap_b32 v235, v237
    v_permlane32_swap_b32 v240, v238
    s_waitcnt lgkmcnt(5)
    v_or_b32 v232, v232, v231
    v_or_b32 v233, v233, v231
    s_cmp_lg_u32 s34, 0
    s_cbranch_scc1 K2_dum_17
    s_add_u32 m0, s48, 864
    s_add_u32 s65, s48, 1888
    buffer_load_dwordx4 v232, s[16:19], 0 offen  lds
    s_mov_b32 m0, s65
    s_mov_b32 exec_hi, 0
    buffer_load_dwordx4 v233, s[16:19], 0 offen  lds
    s_cmp_eq_u32 s33, 4
    s_cbranch_scc1 K2_a4_18
K2_b4_20:
    s_mov_b32 exec_hi, -1
K2_back_19:
    s_waitcnt vmcnt(6) lgkmcnt(1)
    v_mfma_f32_32x32x16_bf16 v[0:15], v[72:75], v[184:187], v[0:15]
    ds_read_b64_tr_b16 v[176:177], v246 offset:0
    ds_read_b64_tr_b16 v[178:179], v246 offset:512
    ds_read_b64_tr_b16 v[180:181], v247 offset:0
    ds_read_b64_tr_b16 v[182:183], v247 offset:512
    v_permlane32_swap_b32 v241, v239
    s_mov_b32 m0, s71
    v_mfma_f32_32x32x16_bf16 v[16:31], v[76:79], v[184:187], v[16:31]
    buffer_load_dwordx4 v224, s[4:7], s43 offen sc1 lds
    buffer_load_dwordx4 v225, s[72:75], s43 offen offset:1024 sc1 lds
    s_waitcnt lgkmcnt(4)
    v_mad_u32_u16 v223, v222, s39, v248 op_sel:[1,0,0,0]
    v_mad_u32_u16 v222, v222, s39, v248
    v_add_f32 v234, v234, v236
    v_add_f32 v235, v235, v237
    v_add_f32 v240, v240, v238
    v_add_f32 v241, v241, v239
    s_set_gpr_idx_on s31, gpr_idx(DST)
    s_nop 0
    v_cvt_pk_bf16_f32 v192, v234, v235
    v_cvt_pk_bf16_f32 v193, v240, v241
    s_set_gpr_idx_off
    v_mfma_f32_32x32x16_bf16 v[32:47], v[72:75], v[188:191], v[32:47]
    v_add_u32 v224, s49, v251
    ds_read_b32 v224, v224
    v_mul_f32 v234, v0, v144
    v_mul_f32 v236, v8, v112
    v_fmac_f32 v234, v1, v145
    v_fmac_f32 v236, v9, v113
    v_fmac_f32 v234, v2, v146
    v_mfma_f32_32x32x16_bf16 v[48:63], v[76:79], v[188:191], v[48:63]
    s_setprio 0
    v_fmac_f32 v236, v10, v114
    v_fmac_f32 v234, v3, v147
    v_fmac_f32 v236, v11, v115
    v_fmac_f32 v234, v4, v148
    v_fmac_f32 v236, v12, v116
    v_fmac_f32 v234, v5, v149
    v_fmac_f32 v236, v13, v117
    v_fmac_f32 v234, v6, v150
    v_fmac_f32 v236, v14, v118
    v_fmac_f32 v234, v7, v151
    v_fmac_f32 v236, v15, v119
    v_mul_f32 v238, v16, v160
    v_mul_f32 v240, v24, v160
    v_fmac_f32 v238, v17, v161
    v_fmac_f32 v240, v25, v161
    v_fmac_f32 v238, v18, v162
    v_fmac_f32 v240, v26, v162
    v_fmac_f32 v238, v19, v163
    v_fmac_f32 v240, v27, v163
    v_fmac_f32 v238, v20, v164
    v_fmac_f32 v240, v28, v164
    v_fmac_f32 v238, v21, v165
    v_fmac_f32 v240, v29, v165
    v_fmac_f32 v238, v22, v166
    v_fmac_f32 v240, v30, v166
    v_fmac_f32 v238, v23, v167
    v_fmac_f32 v240, v31, v167
    v_mul_f32 v235, v32, v152
    v_mul_f32 v237, v40, v120
    v_fmac_f32 v235, v33, v153
    v_fmac_f32 v237, v41, v121
    v_fmac_f32 v235, v34, v154
    v_fmac_f32 v237, v42, v122
    v_fmac_f32 v235, v35, v155
    v_fmac_f32 v237, v43, v123
    v_fmac_f32 v235, v36, v156
    v_fmac_f32 v237, v44, v124
    v_fmac_f32 v235, v37, v157
    v_fmac_f32 v237, v45, v125
    v_fmac_f32 v235, v38, v158
    v_fmac_f32 v237, v46, v126
    v_fmac_f32 v235, v39, v159
    v_fmac_f32 v237, v47, v127
    v_mul_f32 v239, v48, v168
    v_mul_f32 v241, v56, v168
    v_fmac_f32 v239, v49, v169
    v_fmac_f32 v241, v57, v169
    v_fmac_f32 v239, v50, v170
    v_fmac_f32 v241, v58, v170
    v_fmac_f32 v239, v51, v171
    s_setprio 1
    s_waitcnt vmcnt(6) lgkmcnt(1)
    v_mfma_f32_32x32x16_bf16 v[0:15], v[64:67], v[176:179], 0
    ds_read_b64_tr_b16 v[184:185], v246 offset:2048
    ds_read_b64_tr_b16 v[186:187], v246 offset:2560
    ds_read_b64_tr_b16 v[188:189], v247 offset:2048
    ds_read_b64_tr_b16 v[190:191], v247 offset:2560
    v_fmac_f32 v241, v59, v171
    v_fmac_f32 v239, v52, v172
    s_mov_b32 m0, s68
    v_mfma_f32_32x32x16_bf16 v[16:31], v[68:71], v[176:179], 0
    buffer_load_dwordx4 v222, s[4:7], s44 offen sc1 lds
    buffer_load_dwordx4 v223, s[72:75], s44 offen offset:1024 sc1 lds
    s_waitcnt lgkmcnt(4)
    v_mad_u32_u16 v225, v224, s39, v248 op_sel:[1,0,0,0]
    v_mad_u32_u16 v224, v224, s39, v248
    v_fmac_f32 v241, v60, v172
    v_fmac_f32 v239, v53, v173
    v_mfma_f32_32x32x16_bf16 v[32:47], v[64:67], v[180:183], 0
    v_add_u32 v226, s50, v251
    ds_read_b32 v226, v226
    v_fmac_f32 v241, v61, v173
    v_fmac_f32 v239, v54, v174
    v_fmac_f32 v241, v62, v174
    v_fmac_f32 v239, v55, v175
    v_fmac_f32 v241, v63, v175
    v_mfma_f32_32x32x16_bf16 v[48:63], v[68:71], v[180:183], 0
    s_waitcnt vmcnt(6) lgkmcnt(1)
    v_mfma_f32_32x32x16_bf16 v[0:15], v[72:75], v[184:187], v[0:15]
    ds_read_b64_tr_b16 v[176:177], v246 offset:4096
    ds_read_b64_tr_b16 v[178:179], v246 offset:4608
    ds_read_b64_tr_b16 v[180:181], v247 offset:4096
    ds_read_b64_tr_b16 v[182:183], v247 offset:4608
    s_mov_b32 m0, s69
    v_mfma_f32_32x32x16_bf16 v[16:31], v[76:79], v[184:187], v[16:31]
    buffer_load_dwordx4 v224, s[4:7], s45 offen sc1 lds
    buffer_load_dwordx4 v225, s[72:75], s45 offen offset:1024 sc1 lds
    s_waitcnt lgkmcnt(4)
    v_mad_u32_u16 v227, v226, s39, v248 op_sel:[1,0,0,0]
    v_mad_u32_u16 v226, v226, s39, v248
    v_mfma_f32_32x32x16_bf16 v[32:47], v[72:75], v[188:191], v[32:47]
    v_add_u32 v228, s51, v251
    ds_read_b32 v228, v228
    v_mul_f32 v242, v0, v144
    v_fma_f32 v238, v8, v160, -v238
    v_fmac_f32 v242, v1, v145
    v_fmac_f32 v238, v9, v161
    v_fmac_f32 v242, v2, v146
    v_mfma_f32_32x32x16_bf16 v[48:63], v[76:79], v[188:191], v[48:63]
    s_setprio 0
    v_fmac_f32 v238, v10, v162
    v_fmac_f32 v242, v3, v147
    v_fmac_f32 v238, v11, v163
    v_fmac_f32 v242, v4, v148
    v_fmac_f32 v238, v12, v164
    v_fmac_f32 v242, v5, v149
    v_fmac_f32 v238, v13, v165
    v_fmac_f32 v242, v6, v150
    v_fmac_f32 v238, v14, v166
    v_fmac_f32 v242, v7, v151
    v_fmac_f32 v238, v15, v167
    v_fmac_f32 v236, v16, v112
    v_mul_f32 v244, v24, v160
    v_fmac_f32 v236, v17, v113
    v_fmac_f32 v244, v25, v161
    v_fmac_f32 v236, v18, v114
    v_fmac_f32 v244, v26, v162
    v_fmac_f32 v236, v19, v115
    v_fmac_f32 v244, v27, v163
    v_fmac_f32 v236, v20, v116
    v_fmac_f32 v244, v28, v164
    v_fmac_f32 v236, v21, v117
    v_fmac_f32 v244, v29, v165
    v_fmac_f32 v236, v22, v118
    v_fmac_f32 v244, v30, v166
    v_fmac_f32 v236, v23, v119
    v_fmac_f32 v244, v31, v167
    v_mul_f32 v243, v32, v152
    v_fma_f32 v239, v40, v168, -v239
    v_fmac_f32 v243, v33, v153
    v_fmac_f32 v239, v41, v169
    v_fmac_f32 v243, v34, v154
    v_fmac_f32 v239, v42, v170
    v_fmac_f32 v243, v35, v155
    v_fmac_f32 v239, v43, v171
    v_fmac_f32 v243, v36, v156
    v_fmac_f32 v239, v44, v172
    v_fmac_f32 v243, v37, v157
    v_fmac_f32 v239, v45, v173
    v_fmac_f32 v243, v38, v158
    v_fmac_f32 v239, v46, v174
    v_fmac_f32 v243, v39, v159
    v_fmac_f32 v239, v47, v175
    v_fmac_f32 v237, v48, v120
    v_mul_f32 v245, v56, v168
    v_fmac_f32 v237, v49, v121
    v_fmac_f32 v245, v57, v169
    v_fmac_f32 v237, v50, v122
    s_setprio 1
    s_waitcnt vmcnt(4) lgkmcnt(1)
    v_mfma_f32_32x32x16_bf16 v[0:15], v[64:67], v[176:179], 0
    ds_read_b64_tr_b16 v[184:185], v246 offset:6144
    ds_read_b64_tr_b16 v[186:187], v246 offset:6656
    ds_read_b64_tr_b16 v[188:189], v247 offset:6144
    ds_read_b64_tr_b16 v[190:191], v247 offset:6656
    v_fmac_f32 v245, v58, v170
    v_fmac_f32 v237, v51, v123
    s_mov_b32 m0, s70
    v_mfma_f32_32x32x16_bf16 v[16:31], v[68:71], v[176:179], 0
    buffer_load_dwordx4 v226, s[4:7], s46 offen sc1 lds
    buffer_load_dwordx4 v227, s[72:75], s46 offen offset:1024 sc1 lds
    s_waitcnt lgkmcnt(4)
    v_mad_u32_u16 v229, v228, s39, v248 op_sel:[1,0,0,0]
    v_mad_u32_u16 v228, v228, s39, v248
    v_fmac_f32 v245, v59, v171
    v_fmac_f32 v237, v52, v124
    v_mfma_f32_32x32x16_bf16 v[32:47], v[64:67], v[180:183], 0
    v_fmac_f32 v245, v60, v172
    v_fmac_f32 v237, v53, v125
    v_fmac_f32 v245, v61, v173
    v_fmac_f32 v237, v54, v126
    v_fmac_f32 v245, v62, v174
    v_fmac_f32 v237, v55, v127
    v_fmac_f32 v245, v63, v175
    v_mfma_f32_32x32x16_bf16 v[48:63], v[68:71], v[180:183], 0
    v_permlane32_swap_b32 v242, v234
    v_permlane32_swap_b32 v243, v235
    v_add_f32 v242, v242, v234
    v_add_f32 v243, v243, v235
    s_waitcnt vmcnt(4) lgkmcnt(0)
    v_mfma_f32_32x32x16_bf16 v[0:15], v[72:75], v[184:187], v[0:15]
    ds_read_b64_tr_b16 v[176:177], v246 offset:0
    ds_read_b64_tr_b16 v[178:179], v246 offset:512
    ds_read_b64_tr_b16 v[180:181], v247 offset:0
    ds_read_b64_tr_b16 v[182:183], v247 offset:512
    s_sub_u32 s26, s48, s29
    s_mov_b32 s29, s48
    s_mov_b32 m0, s71
    v_mfma_f32_32x32x16_bf16 v[16:31], v[76:79], v[184:187], v[16:31]
    buffer_load_dwordx4 v228, s[4:7], s47 offen sc1 lds
    buffer_load_dwordx4 v229, s[72:75], s47 offen offset:1024 sc1 lds
    s_set_gpr_idx_on s31, gpr_idx(DST)
    s_nop 0
    v_cvt_pk_bf16_f32 v194, v242, v243
    s_set_gpr_idx_off
    s_mov_b32 s30, s3
    s_cmp_eq_u32 s34, 0
    s_cselect_b32 s56, s33, 0
    v_mfma_f32_32x32x16_bf16 v[32:47], v[72:75], v[188:191], v[32:47]
    s_mov_b32 s32, s31
    s_mov_b32 s31, s35
    v_mul_f32 v242, v0, v144
    v_fma_f32 v240, v8, v160, -v240
    v_fmac_f32 v242, v1, v145
    v_fmac_f32 v240, v9, v161
    v_fmac_f32 v242, v2, v146
    v_mfma_f32_32x32x16_bf16 v[48:63], v[76:79], v[188:191], v[48:63]
    s_setprio 0
    v_fmac_f32 v240, v10, v162
    v_fmac_f32 v242, v3, v147
    v_fmac_f32 v240, v11, v163
    v_fmac_f32 v242, v4, v148
    v_fmac_f32 v240, v12, v164
    v_fmac_f32 v242, v5, v149
    v_fmac_f32 v240, v13, v165
    v_fmac_f32 v242, v6, v150
    v_fmac_f32 v240, v14, v166
    v_fmac_f32 v242, v7, v151
    v_fmac_f32 v240, v15, v167
    v_add_u32 v249, s26, v249
    v_add_u32 v250, s26, v250
    v_fma_f32 v244, v16, v160, -v244
    v_fmac_f32 v236, v24, v112
    v_fmac_f32 v244, v17, v161
    v_fmac_f32 v236, v25, v113
    v_fmac_f32 v244, v18, v162
    v_fmac_f32 v236, v26, v114
    v_fmac_f32 v244, v19, v163
    v_fmac_f32 v236, v27, v115
    v_fmac_f32 v244, v20, v164
    v_fmac_f32 v236, v28, v116
    v_fmac_f32 v244, v21, v165
    v_fmac_f32 v236, v29, v117
    v_fmac_f32 v244, v22, v166
    v_fmac_f32 v236, v30, v118
    v_fmac_f32 v244, v23, v167
    v_fmac_f32 v236, v31, v119
    ds_read_b64_tr_b16 v[0:1], v249 offset:0
    ds_read_b64_tr_b16 v[2:3], v249 offset:128
    ds_read_b128 v[4:7], v250 offset:0
    ds_read_b128 v[8:11], v250 offset:16
    ds_read_b128 v[12:15], v250 offset:384
    ds_read_b128 v[16:19], v250 offset:400
    v_mul_f32 v243, v32, v152
    v_fma_f32 v241, v40, v168, -v241
    v_fmac_f32 v243, v33, v153
    v_fmac_f32 v241, v41, v169
    v_fmac_f32 v243, v34, v154
    v_fmac_f32 v241, v42, v170
    v_fmac_f32 v243, v35, v155
    v_fmac_f32 v241, v43, v171
    v_fmac_f32 v243, v36, v156
    v_fmac_f32 v241, v44, v172
    v_fmac_f32 v243, v37, v157
    v_fmac_f32 v241, v45, v173
    v_fmac_f32 v243, v38, v158
    v_fmac_f32 v241, v46, v174
    v_fmac_f32 v243, v39, v159
    v_fmac_f32 v241, v47, v175
    ds_read_b64_tr_b16 v[20:21], v249 offset:512
    ds_read_b64_tr_b16 v[22:23], v249 offset:640
    ds_read_b128 v[24:27], v250 offset:64
    ds_read_b128 v[28:31], v250 offset:80
    ds_read_b128 v[32:35], v250 offset:448
    ds_read_b128 v[36:39], v250 offset:464
    v_fma_f32 v245, v48, v168, -v245
    v_fmac_f32 v237, v56, v120
    v_fmac_f32 v245, v49, v169
    v_fmac_f32 v237, v57, v121
    v_fmac_f32 v245, v50, v170
    v_fmac_f32 v237, v58, v122
    v_fmac_f32 v245, v51, v171
    v_fmac_f32 v237, v59, v123
    v_fmac_f32 v245, v52, v172
    v_fmac_f32 v237, v60, v124
    v_fmac_f32 v245, v53, v173
    v_fmac_f32 v237, v61, v125
    v_fmac_f32 v245, v54, v174
    v_fmac_f32 v237, v62, v126
    v_fmac_f32 v245, v55, v175
    v_fmac_f32 v237, v63, v127
    s_cmp_eq_u32 s56, 2
    s_cbranch_scc1 K2_U20
    s_cmp_eq_u32 s56, 3
    s_cbranch_scc1 K2_U30
    s_branch K2_DSP0
K2_U30:
    s_setprio 1
    s_waitcnt lgkmcnt(6)
    v_lshlrev_b32 v40, 16, v0
    v_and_b32 v41, 0xffff0000, v0
    v_lshlrev_b32 v42, 16, v1
    v_and_b32 v43, 0xffff0000, v1
    v_lshlrev_b32 v44, 16, v2
    v_and_b32 v45, 0xffff0000, v2
    v_lshlrev_b32 v46, 16, v3
    v_and_b32 v47, 0xffff0000, v3
    v_mul_f32 v4, v40, v4
    v_mul_f32 v5, v41, v5
    v_mul_f32 v6, v42, v6
    v_mul_f32 v7, v43, v7
    v_mul_f32 v8, v44, v8
    v_mul_f32 v9, v45, v9
    v_mul_f32 v10, v46, v10
    v_mul_f32 v11, v47, v11
    v_cvt_pk_bf16_f32 v64, v4, v5
    v_cvt_pk_bf16_f32 v65, v6, v7
    v_cvt_pk_bf16_f32 v66, v8, v9
    v_cvt_pk_bf16_f32 v67, v10, v11
    v_mul_f32 v12, v40, v12
    v_mul_f32 v13, v41, v13
    v_mul_f32 v14, v42, v14
    v_mul_f32 v15, v43, v15
    v_mul_f32 v16, v44, v16
    v_mul_f32 v17, v45, v17
    v_mul_f32 v18, v46, v18
    v_mul_f32 v19, v47, v19
    v_cvt_pk_bf16_f32 v68, v12, v13
    v_cvt_pk_bf16_f32 v69, v14, v15
    v_cvt_pk_bf16_f32 v70, v16, v17
    v_cvt_pk_bf16_f32 v71, v18, v19
    ds_read_b64_tr_b16 v[0:1], v249 offset:1024
    ds_read_b64_tr_b16 v[2:3], v249 offset:1152
    ds_read_b128 v[4:7], v250 offset:128
    ds_read_b128 v[8:11], v250 offset:144
    ds_read_b128 v[12:15], v250 offset:512
    ds_read_b128 v[16:19], v250 offset:528
    s_waitcnt lgkmcnt(6)
    v_lshlrev_b32 v48, 16, v20
    v_and_b32 v49, 0xffff0000, v20
    v_lshlrev_b32 v50, 16, v21
    v_and_b32 v51, 0xffff0000, v21
    v_lshlrev_b32 v52, 16, v22
    v_and_b32 v53, 0xffff0000, v22
    v_lshlrev_b32 v54, 16, v23
    v_and_b32 v55, 0xffff0000, v23
    v_mul_f32 v24, v48, v24
    v_mul_f32 v25, v49, v25
    v_mul_f32 v26, v50, v26
    v_mul_f32 v27, v51, v27
    v_mul_f32 v28, v52, v28
    v_mul_f32 v29, v53, v29
    v_mul_f32 v30, v54, v30
    v_mul_f32 v31, v55, v31
    v_cvt_pk_bf16_f32 v72, v24, v25
    v_cvt_pk_bf16_f32 v73, v26, v27
    v_cvt_pk_bf16_f32 v74, v28, v29
    v_cvt_pk_bf16_f32 v75, v30, v31
    v_mul_f32 v32, v48, v32
    v_mul_f32 v33, v49, v33
    v_mul_f32 v34, v50, v34
    v_mul_f32 v35, v51, v35
    v_mul_f32 v36, v52, v36
    v_mul_f32 v37, v53, v37
    v_mul_f32 v38, v54, v38
    v_mul_f32 v39, v55, v39
    v_cvt_pk_bf16_f32 v76, v32, v33
    v_cvt_pk_bf16_f32 v77, v34, v35
    v_cvt_pk_bf16_f32 v78, v36, v37
    v_cvt_pk_bf16_f32 v79, v38, v39
    s_waitcnt lgkmcnt(4)
    v_lshlrev_b32 v40, 16, v0
    v_and_b32 v41, 0xffff0000, v0
    v_lshlrev_b32 v42, 16, v1
    v_and_b32 v43, 0xffff0000, v1
    v_lshlrev_b32 v44, 16, v2
    v_and_b32 v45, 0xffff0000, v2
    v_lshlrev_b32 v46, 16, v3
    v_and_b32 v47, 0xffff0000, v3
    s_waitcnt lgkmcnt(2)
    v_mul_f32 v4, v40, v4
    v_mul_f32 v5, v41, v5
    v_mul_f32 v6, v42, v6
    v_mul_f32 v7, v43, v7
    v_mul_f32 v8, v44, v8
    v_mul_f32 v9, v45, v9
    v_mul_f32 v10, v46, v10
    v_mul_f32 v11, v47, v11
    v_cvt_pk_bf16_f32 v80, v4, v5
    v_cvt_pk_bf16_f32 v81, v6, v7
    v_cvt_pk_bf16_f32 v82, v8, v9
    v_cvt_pk_bf16_f32 v83, v10, v11
    s_waitcnt lgkmcnt(0)
    v_mul_f32 v12, v40, v12
    v_mul_f32 v13, v41, v13
    v_mul_f32 v14, v42, v14
    v_mul_f32 v15, v43, v15
    v_mul_f32 v16, v44, v16
    v_mul_f32 v17, v45, v17
    v_mul_f32 v18, v46, v18
    v_mul_f32 v19, v47, v19
    v_cvt_pk_bf16_f32 v84, v12, v13
    v_cvt_pk_bf16_f32 v85, v14, v15
    v_cvt_pk_bf16_f32 v86, v16, v17
    v_cvt_pk_bf16_f32 v87, v18, v19
    s_waitcnt vmcnt(4)
    v_mfma_f32_32x32x16_bf16 v[0:15], v[64:67], v[176:179], 0
    ds_read_b64_tr_b16 v[184:185], v246 offset:2048
    ds_read_b64_tr_b16 v[186:187], v246 offset:2560
    ds_read_b64_tr_b16 v[188:189], v247 offset:2048
    ds_read_b64_tr_b16 v[190:191], v247 offset:2560
    s_mov_b32 m0, s68
    v_mfma_f32_32x32x16_bf16 v[16:31], v[68:71], v[176:179], 0
    buffer_load_dwordx4 v224, s[4:7], s41 offen sc1 lds
    buffer_load_dwordx4 v225, s[72:75], s41 offen offset:1024 sc1 lds
    v_permlane32_swap_b32 v242, v236
    v_permlane32_swap_b32 v243, v237
    s_add_u32 s38, s38, 1
    v_mfma_f32_32x32x16_bf16 v[32:47], v[64:67], v[180:183], 0
    v_permlane32_swap_b32 v244, v238
    v_permlane32_swap_b32 v245, v239
    v_permlane32_swap_b32 v240, v241
    v_add_f32 v242, v242, v236
    v_mfma_f32_32x32x16_bf16 v[48:63], v[68:71], v[180:183], 0
    v_add_f32 v243, v243, v237
    v_add_f32 v244, v244, v238
    v_add_f32 v245, v245, v239
    v_add_f32 v240, -v240, -v241
    v_mov_b32 v254, s52
    v_mov_b32 v255, s38
    s_waitcnt vmcnt(4) lgkmcnt(0)
    v_mfma_f32_32x32x16_bf16 v[0:15], v[72:75], v[184:187], v[0:15]
    ds_read_b64_tr_b16 v[176:177], v246 offset:4096
    ds_read_b64_tr_b16 v[178:179], v246 offset:4608
    ds_read_b64_tr_b16 v[180:181], v247 offset:4096
    ds_read_b64_tr_b16 v[182:183], v247 offset:4608
    s_lshl_b32 s58, s38, 3
    s_add_u32 s58, s58, s20
    s_mov_b32 m0, s69
    v_mfma_f32_32x32x16_bf16 v[16:31], v[76:79], v[184:187], v[16:31]
    buffer_load_dwordx4 v226, s[4:7], s41 offen sc1 lds
    buffer_load_dwordx4 v227, s[72:75], s41 offen offset:1024 sc1 lds
    s_set_gpr_idx_on s32, gpr_idx(DST)
    s_nop 0
    v_cvt_pk_bf16_f32 v195, v242, v243
    v_cvt_pk_bf16_f32 v196, v244, v245
    v_cvt_pk_bf16_f32 v197, v240, v240
    s_set_gpr_idx_off
    s_mov_b64 exec, 1
    ds_write_b32 v254, v255
    s_mov_b64 exec, -1
    s_cmp_lt_u32 s58, s22
    s_cbranch_scc0 K2_dyn_21
K2_back_22:
    v_readlane_b32 s3, v253, s58
    s_lshl_b32 s44, s34, 7
    s_lshl_b32 s60, s58, 5
    s_and_b32 s48, s3, 0x3ffff
    s_bfe_u32 s33, s3, 0x30012
    s_sub_u32 s60, s60, s48
    s_and_b32 s60, s60, 0xff
    s_add_u32 s60, s60, s48
    s_mul_i32 s35, s38, 6
    s_cmp_eq_u32 s34, 0
    s_cselect_b32 s35, s35, s60
    s_mov_b32 s45, s44
    s_add_u32 s47, s44, 256
    s_add_u32 s49, s48, 32
    s_add_u32 s60, s48, 64
    s_cmp_eq_u32 s33, 3
    s_cselect_b32 s46, s44, s47
    s_cselect_b32 s50, s60, s48
    s_cselect_b32 s51, s48, s49
    s_sub_u32 s60, s33, 2
    s_cmp_lt_u32 s60, 2
    s_cbranch_scc0 K2_rare_27
K2_back_28:
    v_mfma_f32_32x32x16_bf16 v[32:47], v[72:75], v[188:191], v[32:47]
    v_add_u32 v233, s48, v230
    ds_read_b32 v232, v233
    ds_read_b32 v233, v233 offset:1024
    v_mfma_f32_32x32x16_bf16 v[48:63], v[76:79], v[188:191], v[48:63]
    s_waitcnt vmcnt(4) lgkmcnt(3)
    v_mfma_f32_32x32x16_bf16 v[0:15], v[80:83], v[176:179], v[0:15]
    ds_read_b64_tr_b16 v[184:185], v246 offset:6144
    ds_read_b64_tr_b16 v[186:187], v246 offset:6656
    ds_read_b64_tr_b16 v[188:189], v247 offset:6144
    ds_read_b64_tr_b16 v[190:191], v247 offset:6656
    s_mov_b32 m0, s70
    v_mfma_f32_32x32x16_bf16 v[16:31], v[84:87], v[176:179], v[16:31]
    buffer_load_dwordx4 v222, s[4:7], s42 offen sc1 lds
    buffer_load_dwordx4 v223, s[72:75], s42 offen offset:1024 sc1 lds
    v_mfma_f32_32x32x16_bf16 v[32:47], v[80:83], v[180:183], v[32:47]
    s_nop 2
    v_mul_f32 v234, v0, v96
    v_mul_f32 v236, v8, v128
    v_fmac_f32 v234, v1, v97
    v_fmac_f32 v236, v9, v129
    v_fmac_f32 v234, v2, v98
    v_fmac_f32 v236, v10, v130
    v_fmac_f32 v234, v3, v99
    v_mfma_f32_32x32x16_bf16 v[48:63], v[84:87], v[180:183], v[48:63]
    s_setprio 0
    s_waitcnt lgkmcnt(4)
    v_or_b32 v232, v232, v231
    v_or_b32 v233, v233, v231
    s_cmp_lg_u32 s34, 0
    s_cbranch_scc1 K2_dum_30
    s_add_u32 m0, s48, 864
    s_add_u32 s65, s48, 1888
    buffer_load_dwordx4 v232, s[16:19], 0 offen  lds
    s_mov_b32 m0, s65
    s_mov_b32 exec_hi, 0
    buffer_load_dwordx4 v233, s[16:19], 0 offen  lds
    s_cmp_eq_u32 s33, 4
    s_cbranch_scc1 K2_a4_31
K2_b4_33:
    s_mov_b32 exec_hi, -1
K2_back_32:
    v_fmac_f32 v236, v11, v131
    v_fmac_f32 v234, v4, v100
    v_fmac_f32 v236, v12, v132
    v_fmac_f32 v234, v5, v101
    v_fmac_f32 v236, v13, v133
    v_fmac_f32 v234, v6, v102
    v_fmac_f32 v236, v14, v134
    v_fmac_f32 v234, v7, v103
    v_fmac_f32 v236, v15, v135
    v_mul_f32 v238, v16, v128
    v_mul_f32 v240, v24, v128
    v_fmac_f32 v238, v17, v129
    v_fmac_f32 v240, v25, v129
    v_fmac_f32 v238, v18, v130
    v_fmac_f32 v240, v26, v130
    v_fmac_f32 v238, v19, v131
    v_fmac_f32 v240, v27, v131
    v_fmac_f32 v238, v20, v132
    v_fmac_f32 v240, v28, v132
    v_fmac_f32 v238, v21, v133
    v_fmac_f32 v240, v29, v133
    v_fmac_f32 v238, v22, v134
    v_fmac_f32 v240, v30, v134
    v_fmac_f32 v238, v23, v135
    v_fmac_f32 v240, v31, v135
    v_mul_f32 v235, v32, v104
    v_mul_f32 v237, v40, v136
    v_fmac_f32 v235, v33, v105
    v_fmac_f32 v237, v41, v137
    v_fmac_f32 v235, v34, v106
    v_fmac_f32 v237, v42, v138
    v_fmac_f32 v235, v35, v107
    v_fmac_f32 v237, v43, v139
    v_fmac_f32 v235, v36, v108
    v_fmac_f32 v237, v44, v140
    v_fmac_f32 v235, v37, v109
    v_fmac_f32 v237, v45, v141
    v_fmac_f32 v235, v38, v110
    v_fmac_f32 v237, v46, v142
    v_fmac_f32 v235, v39, v111
    v_fmac_f32 v237, v47, v143
    v_mul_f32 v239, v48, v136
    v_mul_f32 v241, v56, v136
    s_setprio 1
    s_waitcnt vmcnt(6) lgkmcnt(0)
    v_mfma_f32_32x32x16_bf16 v[0:15], v[64:67], v[184:187], 0
    ds_read_b64_tr_b16 v[176:177], v246 offset:0
    ds_read_b64_tr_b16 v[178:179], v246 offset:512
    ds_read_b64_tr_b16 v[180:181], v247 offset:0
    ds_read_b64_tr_b16 v[182:183], v247 offset:512
    v_fmac_f32 v239, v49, v137
    v_fmac_f32 v241, v57, v137
    s_mov_b32 m0, s71
    v_mfma_f32_32x32x16_bf16 v[16:31], v[68:71], v[184:187], 0
    buffer_load_dwordx4 v224, s[4:7], s42 offen sc1 lds
    buffer_load_dwordx4 v225, s[72:75], s42 offen offset:1024 sc1 lds
    v_fmac_f32 v239, v50, v138
    v_fmac_f32 v241, v58, v138
    v_fmac_f32 v239, v51, v139
    v_fmac_f32 v241, v59, v139
    v_fmac_f32 v239, v52, v140
    v_mfma_f32_32x32x16_bf16 v[32:47], v[64:67], v[188:191], 0
    v_fmac_f32 v241, v60, v140
    v_fmac_f32 v239, v53, v141
    v_fmac_f32 v241, v61, v141
    v_fmac_f32 v239, v54, v142
    v_fmac_f32 v241, v62, v142
    v_fmac_f32 v239, v55, v143
    v_fmac_f32 v241, v63, v143
    v_mfma_f32_32x32x16_bf16 v[48:63], v[68:71], v[188:191], 0
    v_permlane32_swap_b32 v234, v236
    v_permlane32_swap_b32 v235, v237
    v_permlane32_swap_b32 v240, v238
    s_waitcnt vmcnt(6) lgkmcnt(0)
    v_mfma_f32_32x32x16_bf16 v[0:15], v[72:75], v[176:179], v[0:15]
    ds_read_b64_tr_b16 v[184:185], v246 offset:2048
    ds_read_b64_tr_b16 v[186:187], v246 offset:2560
    ds_read_b64_tr_b16 v[188:189], v247 offset:2048
    ds_read_b64_tr_b16 v[190:191], v247 offset:2560
    v_permlane32_swap_b32 v241, v239
    s_mov_b32 m0, s68
    v_mfma_f32_32x32x16_bf16 v[16:31], v[76:79], v[176:179], v[16:31]
    buffer_load_dwordx4 v226, s[4:7], s42 offen sc1 lds
    buffer_load_dwordx4 v227, s[72:75], s42 offen offset:1024 sc1 lds
    v_add_f32 v234, v234, v236
    v_add_f32 v235, v235, v237
    v_add_f32 v240, v240, v238
    v_add_f32 v241, v241, v239
    v_mfma_f32_32x32x16_bf16 v[32:47], v[72:75], v[180:183], v[32:47]
    s_set_gpr_idx_on s31, gpr_idx(DST)
    s_nop 0
    v_cvt_pk_bf16_f32 v192, v234, v235
    v_cvt_pk_bf16_f32 v193, v240, v241
    s_set_gpr_idx_off
    v_mfma_f32_32x32x16_bf16 v[48:63], v[76:79], v[180:183], v[48:63]
    s_waitcnt vmcnt(6) lgkmcnt(0)
    v_mfma_f32_32x32x16_bf16 v[0:15], v[80:83], v[184:187], v[0:15]
    ds_read_b64_tr_b16 v[176:177], v246 offset:4096
    ds_read_b64_tr_b16 v[178:179], v246 offset:4608
    ds_read_b64_tr_b16 v[180:181], v247 offset:4096
    ds_read_b64_tr_b16 v[182:183], v247 offset:4608
    s_mov_b32 m0, s69
    v_mfma_f32_32x32x16_bf16 v[16:31], v[84:87], v[184:187], v[16:31]
    buffer_load_dwordx4 v222, s[4:7], s43 offen sc1 lds
    buffer_load_dwordx4 v223, s[72:75], s43 offen offset:1024 sc1 lds
    v_mfma_f32_32x32x16_bf16 v[32:47], v[80:83], v[188:191], v[32:47]
    s_nop 2
    v_mul_f32 v234, v0, v144
    v_mul_f32 v236, v8, v112
    v_fmac_f32 v234, v1, v145
    v_fmac_f32 v236, v9, v113
    v_fmac_f32 v234, v2, v146
    v_fmac_f32 v236, v10, v114
    v_fmac_f32 v234, v3, v147
    v_mfma_f32_32x32x16_bf16 v[48:63], v[84:87], v[188:191], v[48:63]
    s_setprio 0
    v_fmac_f32 v236, v11, v115
    v_fmac_f32 v234, v4, v148
    v_fmac_f32 v236, v12, v116
    v_fmac_f32 v234, v5, v149
    v_fmac_f32 v236, v13, v117
    v_fmac_f32 v234, v6, v150
    v_fmac_f32 v236, v14, v118
    v_fmac_f32 v234, v7, v151
    v_fmac_f32 v236, v15, v119
    v_mul_f32 v238, v16, v160
    v_mul_f32 v240, v24, v160
    v_fmac_f32 v238, v17, v161
    v_fmac_f32 v240, v25, v161
    v_fmac_f32 v238, v18, v162
    v_fmac_f32 v240, v26, v162
    v_fmac_f32 v238, v19, v163
    v_fmac_f32 v240, v27, v163
    v_fmac_f32 v238, v20, v164
    v_fmac_f32 v240, v28, v164
    v_fmac_f32 v238, v21, v165
    v_fmac_f32 v240, v29, v165
    v_fmac_f32 v238, v22, v166
    v_fmac_f32 v240, v30, v166
    v_fmac_f32 v238, v23, v167
    v_fmac_f32 v240, v31, v167
    v_mul_f32 v235, v32, v152
    v_mul_f32 v237, v40, v120
    v_fmac_f32 v235, v33, v153
    v_fmac_f32 v237, v41, v121
    v_fmac_f32 v235, v34, v154
    v_fmac_f32 v237, v42, v122
    v_fmac_f32 v235, v35, v155
    v_fmac_f32 v237, v43, v123
    v_fmac_f32 v235, v36, v156
    v_fmac_f32 v237, v44, v124
    v_fmac_f32 v235, v37, v157
    v_fmac_f32 v237, v45, v125
    v_fmac_f32 v235, v38, v158
    v_fmac_f32 v237, v46, v126
    v_fmac_f32 v235, v39, v159
    v_fmac_f32 v237, v47, v127
    v_mul_f32 v239, v48, v168
    v_mul_f32 v241, v56, v168
    v_fmac_f32 v239, v49, v169
    v_fmac_f32 v241, v57, v169
    s_setprio 1
    s_waitcnt vmcnt(4) lgkmcnt(0)
    v_mfma_f32_32x32x16_bf16 v[0:15], v[64:67], v[176:179], 0
    ds_read_b64_tr_b16 v[184:185], v246 offset:6144
    ds_read_b64_tr_b16 v[186:187], v246 offset:6656
    ds_read_b64_tr_b16 v[188:189], v247 offset:6144
    ds_read_b64_tr_b16 v[190:191], v247 offset:6656
    v_fmac_f32 v239, v50, v170
    v_fmac_f32 v241, v58, v170
    s_mov_b32 m0, s70
    v_mfma_f32_32x32x16_bf16 v[16:31], v[68:71], v[176:179], 0
    buffer_load_dwordx4 v224, s[4:7], s43 offen sc1 lds
    buffer_load_dwordx4 v225, s[72:75], s43 offen offset:1024 sc1 lds
    v_fmac_f32 v239, v51, v171
    v_fmac_f32 v241, v59, v171
    v_fmac_f32 v239, v52, v172
    v_fmac_f32 v241, v60, v172
    v_fmac_f32 v239, v53, v173
    v_mfma_f32_32x32x16_bf16 v[32:47], v[64:67], v[180:183], 0
    v_add_u32 v222, s48, v251
    ds_read_b32 v222, v222
    v_fmac_f32 v241, v61, v173
    v_fmac_f32 v239, v54, v174
    v_fmac_f32 v241, v62, v174
    v_fmac_f32 v239, v55, v175
    v_fmac_f32 v241, v63, v175
    v_mfma_f32_32x32x16_bf16 v[48:63], v[68:71], v[180:183], 0
    s_waitcnt vmcnt(4) lgkmcnt(1)
    v_mfma_f32_32x32x16_bf16 v[0:15], v[72:75], v[184:187], v[0:15]
    ds_read_b64_tr_b16 v[176:177], v246 offset:0
    ds_read_b64_tr_b16 v[178:179], v246 offset:512
    ds_read_b64_tr_b16 v[180:181], v247 offset:0
    ds_read_b64_tr_b16 v[182:183], v247 offset:512
    s_mov_b32 m0, s71
    v_mfma_f32_32x32x16_bf16 v[16:31], v[76:79], v[184:187], v[16:31]
    buffer_load_dwordx4 v226, s[4:7], s43 offen sc1 lds
    buffer_load_dwordx4 v227, s[72:75], s43 offen offset:1024 sc1 lds
    s_waitcnt lgkmcnt(4)
    v_mad_u32_u16 v223, v222, s39, v248 op_sel:[1,0,0,0]
    v_mad_u32_u16 v222, v222, s39, v248
    v_mfma_f32_32x32x16_bf16 v[32:47], v[72:75], v[188:191], v[32:47]
    v_add_u32 v224, s49, v251
    ds_read_b32 v224, v224
    v_mfma_f32_32x32x16_bf16 v[48:63], v[76:79], v[188:191], v[48:63]
    s_waitcnt vmcnt(4) lgkmcnt(1)
    v_mfma_f32_32x32x16_bf16 v[0:15], v[80:83], v[176:179], v[0:15]
    ds_read_b64_tr_b16 v[184:185], v246 offset:2048
    ds_read_b64_tr_b16 v[186:187], v246 offset:2560
    ds_read_b64_tr_b16 v[188:189], v247 offset:2048
    ds_read_b64_tr_b16 v[190:191], v247 offset:2560
    s_mov_b32 m0, s68
    v_mfma_f32_32x32x16_bf16 v[16:31], v[84:87], v[176:179], v[16:31]
    buffer_load_dwordx4 v222, s[4:7], s44 offen sc1 lds
    buffer_load_dwordx4 v223, s[72:75], s44 offen offset:1024 sc1 lds
    s_waitcnt lgkmcnt(4)
    v_mad_u32_u16 v225, v224, s39, v248 op_sel:[1,0,0,0]
    v_mad_u32_u16 v224, v224, s39, v248
    v_mfma_f32_32x32x16_bf16 v[32:47], v[80:83], v[180:183], v[32:47]
    v_add_u32 v226, s50, v251
    ds_read_b32 v226, v226
    v_mul_f32 v242, v0, v144
    v_fma_f32 v238, v8, v160, -v238
    v_fmac_f32 v242, v1, v145
    v_fmac_f32 v238, v9, v161
    v_fmac_f32 v242, v2, v146
    v_mfma_f32_32x32x16_bf16 v[48:63], v[84:87], v[180:183], v[48:63]
    s_setprio 0
    v_fmac_f32 v238, v10, v162
    v_fmac_f32 v242, v3, v147
    v_fmac_f32 v238, v11, v163
    v_fmac_f32 v242, v4, v148
    v_fmac_f32 v238, v12, v164
    v_fmac_f32 v242, v5, v149
    v_fmac_f32 v238, v13, v165
    v_fmac_f32 v242, v6, v150
    v_fmac_f32 v238, v14, v166
    v_fmac_f32 v242, v7, v151
    v_fmac_f32 v238, v15, v167
    v_fmac_f32 v236, v16, v112
    v_mul_f32 v244, v24, v160
    v_fmac_f32 v236, v17, v113
    v_fmac_f32 v244, v25, v161
    v_fmac_f32 v236, v18, v114
    v_fmac_f32 v244, v26, v162
    v_fmac_f32 v236, v19, v115
    v_fmac_f32 v244, v27, v163
    v_fmac_f32 v236, v20, v116
    v_fmac_f32 v244, v28, v164
    v_fmac_f32 v236, v21, v117
    v_fmac_f32 v244, v29, v165
    v_fmac_f32 v236, v22, v118
    v_fmac_f32 v244, v30, v166
    v_fmac_f32 v236, v23, v119
    v_fmac_f32 v244, v31, v167
    v_mul_f32 v243, v32, v152
    v_fma_f32 v239, v40, v168, -v239
    v_fmac_f32 v243, v33, v153
    v_fmac_f32 v239, v41, v169
    v_fmac_f32 v243, v34, v154
    v_fmac_f32 v239, v42, v170
    v_fmac_f32 v243, v35, v155
    v_fmac_f32 v239, v43, v171
    v_fmac_f32 v243, v36, v156
    v_fmac_f32 v239, v44, v172
    v_fmac_f32 v243, v37, v157
    v_fmac_f32 v239, v45, v173
    v_fmac_f32 v243, v38, v158
    v_fmac_f32 v239, v46, v174
    v_fmac_f32 v243, v39, v159
    v_fmac_f32 v239, v47, v175
    v_fmac_f32 v237, v48, v120
    v_mul_f32 v245, v56, v168
    v_fmac_f32 v237, v49, v121
    v_fmac_f32 v245, v57, v169
    v_fmac_f32 v237, v50, v122
    v_fmac_f32 v245, v58, v170
    v_fmac_f32 v237, v51, v123
    s_setprio 1
    s_waitcnt vmcnt(4) lgkmcnt(1)
    v_mfma_f32_32x32x16_bf16 v[0:15], v[64:67], v[184:187], 0
    ds_read_b64_tr_b16 v[176:177], v246 offset:4096
    ds_read_b64_tr_b16 v[178:179], v246 offset:4608
    ds_read_b64_tr_b16 v[180:181], v247 offset:4096
    ds_read_b64_tr_b16 v[182:183], v247 offset:4608
    v_fmac_f32 v245, v59, v171
    v_fmac_f32 v237, v52, v124
    s_mov_b32 m0, s69
    v_mfma_f32_32x32x16_bf16 v[16:31], v[68:71], v[184:187], 0
    buffer_load_dwordx4 v224, s[4:7], s45 offen sc1 lds
    buffer_load_dwordx4 v225, s[72:75], s45 offen offset:1024 sc1 lds
    s_waitcnt lgkmcnt(4)
    v_mad_u32_u16 v227, v226, s39, v248 op_sel:[1,0,0,0]
    v_mad_u32_u16 v226, v226, s39, v248
    v_fmac_f32 v245, v60, v172
    v_fmac_f32 v237, v53, v125
    v_mfma_f32_32x32x16_bf16 v[32:47], v[64:67], v[188:191], 0
    v_add_u32 v228, s51, v251
    ds_read_b32 v228, v228
    v_fmac_f32 v245, v61, v173
    v_fmac_f32 v237, v54, v126
    v_fmac_f32 v245, v62, v174
    v_fmac_f32 v237, v55, v127
    v_fmac_f32 v245, v63, v175
    v_mfma_f32_32x32x16_bf16 v[48:63], v[68:71], v[188:191], 0
    v_permlane32_swap_b32 v242, v234
    v_permlane32_swap_b32 v243, v235
    v_add_f32 v242, v242, v234
    v_add_f32 v243, v243, v235
    s_waitcnt vmcnt(4) lgkmcnt(1)
    v_mfma_f32_32x32x16_bf16 v[0:15], v[72:75], v[176:179], v[0:15]
    ds_read_b64_tr_b16 v[184:185], v246 offset:6144
    ds_read_b64_tr_b16 v[186:187], v246 offset:6656
    ds_read_b64_tr_b16 v[188:189], v247 offset:6144
    ds_read_b64_tr_b16 v[190:191], v247 offset:6656
    s_mov_b32 m0, s70
    v_mfma_f32_32x32x16_bf16 v[16:31], v[76:79], v[176:179], v[16:31]
    buffer_load_dwordx4 v226, s[4:7], s46 offen sc1 lds
    buffer_load_dwordx4 v227, s[72:75], s46 offen offset:1024 sc1 lds
    s_waitcnt lgkmcnt(4)
    v_mad_u32_u16 v229, v228, s39, v248 op_sel:[1,0,0,0]
    v_mad_u32_u16 v228, v228, s39, v248
    s_sub_u32 s26, s48, s29
    s_mov_b32 s29, s48
    v_mfma_f32_32x32x16_bf16 v[32:47], v[72:75], v[180:183], v[32:47]
    s_set_gpr_idx_on s31, gpr_idx(DST)
    s_nop 0
    v_cvt_pk_bf16_f32 v194, v242, v243
    s_set_gpr_idx_off
    s_mov_b32 s30, s3
    s_cmp_eq_u32 s34, 0
    s_cselect_b32 s56, s33, 0
    s_mov_b32 s32, s31
    v_mfma_f32_32x32x16_bf16 v[48:63], v[76:79], v[180:183], v[48:63]
    s_mov_b32 s31, s35
    s_waitcnt vmcnt(4) lgkmcnt(0)
    v_mfma_f32_32x32x16_bf16 v[0:15], v[80:83], v[184:187], v[0:15]
    ds_read_b64_tr_b16 v[176:177], v246 offset:0
    ds_read_b64_tr_b16 v[178:179], v246 offset:512
    ds_read_b64_tr_b16 v[180:181], v247 offset:0
    ds_read_b64_tr_b16 v[182:183], v247 offset:512
    s_mov_b32 m0, s71
    v_mfma_f32_32x32x16_bf16 v[16:31], v[84:87], v[184:187], v[16:31]
    buffer_load_dwordx4 v228, s[4:7], s47 offen sc1 lds
    buffer_load_dwordx4 v229, s[72:75], s47 offen offset:1024 sc1 lds
    v_mfma_f32_32x32x16_bf16 v[32:47], v[80:83], v[188:191], v[32:47]
    s_nop 2
    v_mul_f32 v242, v0, v144
    v_fma_f32 v240, v8, v160, -v240
    v_fmac_f32 v242, v1, v145
    v_fmac_f32 v240, v9, v161
    v_fmac_f32 v242, v2, v146
    v_fmac_f32 v240, v10, v162
    v_fmac_f32 v242, v3, v147
    v_mfma_f32_32x32x16_bf16 v[48:63], v[84:87], v[188:191], v[48:63]
    s_setprio 0
    v_fmac_f32 v240, v11, v163
    v_fmac_f32 v242, v4, v148
    v_fmac_f32 v240, v12, v164
    v_fmac_f32 v242, v5, v149
    v_fmac_f32 v240, v13, v165
    v_fmac_f32 v242, v6, v150
    v_fmac_f32 v240, v14, v166
    v_fmac_f32 v242, v7, v151
    v_fmac_f32 v240, v15, v167
    v_add_u32 v249, s26, v249
    v_add_u32 v250, s26, v250
    v_fma_f32 v244, v16, v160, -v244
    v_fmac_f32 v236, v24, v112
    v_fmac_f32 v244, v17, v161
    v_fmac_f32 v236, v25, v113
    v_fmac_f32 v244, v18, v162
    v_fmac_f32 v236, v26, v114
    v_fmac_f32 v244, v19, v163
    v_fmac_f32 v236, v27, v115
    v_fmac_f32 v244, v20, v164
    v_fmac_f32 v236, v28, v116
    v_fmac_f32 v244, v21, v165
    v_fmac_f32 v236, v29, v117
    v_fmac_f32 v244, v22, v166
    v_fmac_f32 v236, v30, v118
    v_fmac_f32 v244, v23, v167
    v_fmac_f32 v236, v31, v119
    ds_read_b64_tr_b16 v[0:1], v249 offset:0
    ds_read_b64_tr_b16 v[2:3], v249 offset:128
    ds_read_b128 v[4:7], v250 offset:0
    ds_read_b128 v[8:11], v250 offset:16
    ds_read_b128 v[12:15], v250 offset:384
    ds_read_b128 v[16:19], v250 offset:400
    v_mul_f32 v243, v32, v152
    v_fma_f32 v241, v40, v168, -v241
    v_fmac_f32 v243, v33, v153
    v_fmac_f32 v241, v41, v169
    v_fmac_f32 v243, v34, v154
    v_fmac_f32 v241, v42, v170
    v_fmac_f32 v243, v35, v155
    v_fmac_f32 v241, v43, v171
    v_fmac_f32 v243, v36, v156
    v_fmac_f32 v241, v44, v172
    v_fmac_f32 v243, v37, v157
    v_fmac_f32 v241, v45, v173
    v_fmac_f32 v243, v38, v158
    v_fmac_f32 v241, v46, v174
    v_fmac_f32 v243, v39, v159
    v_fmac_f32 v241, v47, v175
    ds_read_b64_tr_b16 v[20:21], v249 offset:512
    ds_read_b64_tr_b16 v[22:23], v249 offset:640
    ds_read_b128 v[24:27], v250 offset:64
    ds_read_b128 v[28:31], v250 offset:80
    ds_read_b128 v[32:35], v250 offset:448
    ds_read_b128 v[36:39], v250 offset:464
    v_fma_f32 v245, v48, v168, -v245
    v_fmac_f32 v237, v56, v120
    v_fmac_f32 v245, v49, v169
    v_fmac_f32 v237, v57, v121
    v_fmac_f32 v245, v50, v170
    v_fmac_f32 v237, v58, v122
    v_fmac_f32 v245, v51, v171
    v_fmac_f32 v237, v59, v123
    v_fmac_f32 v245, v52, v172
    v_fmac_f32 v237, v60, v124
    v_fmac_f32 v245, v53, v173
    v_fmac_f32 v237, v61, v125
    v_fmac_f32 v245, v54, v174
    v_fmac_f32 v237, v62, v126
    v_fmac_f32 v245, v55, v175
    v_fmac_f32 v237, v63, v127
    s_cmp_eq_u32 s56, 2
    s_cbranch_scc1 K2_U20
    s_cmp_eq_u32 s56, 3
    s_cbranch_scc1 K2_U30
    s_branch K2_DSP0
K2_U21:
    s_setprio 1
    s_waitcnt lgkmcnt(6)
    v_lshlrev_b32 v40, 16, v0
    v_and_b32 v41, 0xffff0000, v0
    v_lshlrev_b32 v42, 16, v1
    v_and_b32 v43, 0xffff0000, v1
    v_lshlrev_b32 v44, 16, v2
    v_and_b32 v45, 0xffff0000, v2
    v_lshlrev_b32 v46, 16, v3
    v_and_b32 v47, 0xffff0000, v3
    v_mul_f32 v4, v40, v4
    v_mul_f32 v5, v41, v5
    v_mul_f32 v6, v42, v6
    v_mul_f32 v7, v43, v7
    v_mul_f32 v8, v44, v8
    v_mul_f32 v9, v45, v9
    v_mul_f32 v10, v46, v10
    v_mul_f32 v11, v47, v11
    v_cvt_pk_bf16_f32 v64, v4, v5
    v_cvt_pk_bf16_f32 v65, v6, v7
    v_cvt_pk_bf16_f32 v66, v8, v9
    v_cvt_pk_bf16_f32 v67, v10, v11
    v_mul_f32 v12, v40, v12
    v_mul_f32 v13, v41, v13
    v_mul_f32 v14, v42, v14
    v_mul_f32 v15, v43, v15
    v_mul_f32 v16, v44, v16
    v_mul_f32 v17, v45, v17
    v_mul_f32 v18, v46, v18
    v_mul_f32 v19, v47, v19
    v_cvt_pk_bf16_f32 v68, v12, v13
    v_cvt_pk_bf16_f32 v69, v14, v15
    v_cvt_pk_bf16_f32 v70, v16, v17
    v_cvt_pk_bf16_f32 v71, v18, v19
    s_waitcnt lgkmcnt(0)
    v_lshlrev_b32 v48, 16, v20
    v_and_b32 v49, 0xffff0000, v20
    v_lshlrev_b32 v50, 16, v21
    v_and_b32 v51, 0xffff0000, v21
    v_lshlrev_b32 v52, 16, v22
    v_and_b32 v53, 0xffff0000, v22
    v_lshlrev_b32 v54, 16, v23
    v_and_b32 v55, 0xffff0000, v23
    v_mul_f32 v24, v48, v24
    v_mul_f32 v25, v49, v25
    v_mul_f32 v26, v50, v26
    v_mul_f32 v27, v51, v27
    v_mul_f32 v28, v52, v28
    v_mul_f32 v29, v53, v29
    v_mul_f32 v30, v54, v30
    v_mul_f32 v31, v55, v31
    v_cvt_pk_bf16_f32 v72, v24, v25
    v_cvt_pk_bf16_f32 v73, v26, v27
    v_cvt_pk_bf16_f32 v74, v28, v29
    v_cvt_pk_bf16_f32 v75, v30, v31
    v_mul_f32 v32, v48, v32
    v_mul_f32 v33, v49, v33
    v_mul_f32 v34, v50, v34
    v_mul_f32 v35, v51, v35
    v_mul_f32 v36, v52, v36
    v_mul_f32 v37, v53, v37
    v_mul_f32 v38, v54, v38
    v_mul_f32 v39, v55, v39
    v_cvt_pk_bf16_f32 v76, v32, v33
    v_cvt_pk_bf16_f32 v77, v34, v35
    v_cvt_pk_bf16_f32 v78, v36, v37
    v_cvt_pk_bf16_f32 v79, v38, v39
    s_waitcnt vmcnt(4)
    v_mfma_f32_32x32x16_bf16 v[0:15], v[64:67], v[176:179], 0
    ds_read_b64_tr_b16 v[184:185], v246 offset:2048
    ds_read_b64_tr_b16 v[186:187], v246 offset:2560
    ds_read_b64_tr_b16 v[188:189], v247 offset:2048
    ds_read_b64_tr_b16 v[190:191], v247 offset:2560
    s_mov_b32 m0, s68
    v_mfma_f32_32x32x16_bf16 v[16:31], v[68:71], v[176:179], 0
    buffer_load_dwordx4 v222, s[4:7], s42 offen sc1 lds
    buffer_load_dwordx4 v223, s[72:75], s42 offen offset:1024 sc1 lds
    v_permlane32_swap_b32 v242, v236
    v_permlane32_swap_b32 v243, v237
    v_mov_b32 v254, 163648
    v_mfma_f32_32x32x16_bf16 v[32:47], v[64:67], v[180:183], 0
    v_permlane32_swap_b32 v244, v238
    v_permlane32_swap_b32 v245, v239
    v_permlane32_swap_b32 v240, v241
    v_add_f32 v242, v242, v236
    v_mfma_f32_32x32x16_bf16 v[48:63], v[68:71], v[180:183], 0
    v_add_f32 v243, v243, v237
    v_add_f32 v244, v244, v238
    v_add_f32 v245, v245, v239
    v_add_f32 v240, -v240, -v241
    v_sub_u32 v241, v230, v231
    v_cvt_pk_bf16_f32 v242, v242, v243
    v_mov_b32 v255, 1
    v_lshl_add_u32 v233, v252, 1, s53
    s_mov_b64 exec, 1
    ds_add_rtn_u32 v232, v254, v255
    s_mov_b64 exec, -1
    ds_read_b32 v233, v233
    s_waitcnt vmcnt(4) lgkmcnt(2)
    v_mfma_f32_32x32x16_bf16 v[0:15], v[72:75], v[184:187], v[0:15]
    ds_read_b64_tr_b16 v[176:177], v246 offset:4096
    ds_read_b64_tr_b16 v[178:179], v246 offset:4608
    ds_read_b64_tr_b16 v[180:181], v247 offset:4096
    ds_read_b64_tr_b16 v[182:183], v247 offset:4608
    v_cvt_pk_bf16_f32 v244, v244, v245
    v_cvt_pk_bf16_f32 v240, v240, v240
    s_mov_b32 m0, s69
    v_mfma_f32_32x32x16_bf16 v[16:31], v[76:79], v[184:187], v[16:31]
    buffer_load_dwordx4 v224, s[4:7], s42 offen sc1 lds
    buffer_load_dwordx4 v225, s[72:75], s42 offen offset:1024 sc1 lds
    ds_write_b32 v230, v242 offset:768
    ds_write_b32 v230, v244 offset:1024
    ds_write_b16 v241, v240 offset:1280
    s_waitcnt lgkmcnt(7)
    v_readfirstlane_b32 s58, v232
    v_mfma_f32_32x32x16_bf16 v[32:47], v[72:75], v[188:191], v[32:47]
    s_cmp_lt_u32 s58, s22
    s_cbranch_scc0 K2_nul_34
    s_and_b32 s59, s58, 7
    s_lshr_b32 s60, s58, 3
K2_chk_36:
    v_readlane_b32 s61, v233, s59
    s_nop 0
    s_cmp_gt_u32 s61, s60
    s_cbranch_scc0 K2_spin_35
K2_back_37:
    v_mfma_f32_32x32x16_bf16 v[48:63], v[76:79], v[188:191], v[48:63]
    s_setprio 0
    v_readlane_b32 s3, v253, s58
    s_lshl_b32 s44, s34, 7
    s_lshl_b32 s60, s58, 5
    s_and_b32 s48, s3, 0x3ffff
    s_bfe_u32 s33, s3, 0x30012
    s_sub_u32 s60, s60, s48
    v_mul_f32 v234, v0, v96
    v_mul_f32 v236, v8, v128
    v_fmac_f32 v234, v1, v97
    v_fmac_f32 v236, v9, v129
    v_fmac_f32 v234, v2, v98
    v_fmac_f32 v236, v10, v130
    v_fmac_f32 v234, v3, v99
    v_fmac_f32 v236, v11, v131
    v_fmac_f32 v234, v4, v100
    v_fmac_f32 v236, v12, v132
    v_fmac_f32 v234, v5, v101
    v_fmac_f32 v236, v13, v133
    v_fmac_f32 v234, v6, v102
    v_fmac_f32 v236, v14, v134
    v_fmac_f32 v234, v7, v103
    v_fmac_f32 v236, v15, v135
    v_mul_f32 v238, v16, v128
    v_mul_f32 v240, v24, v128
    v_fmac_f32 v238, v17, v129
    v_fmac_f32 v240, v25, v129
    v_fmac_f32 v238, v18, v130
    v_fmac_f32 v240, v26, v130
    v_fmac_f32 v238, v19, v131
    v_fmac_f32 v240, v27, v131
    v_fmac_f32 v238, v20, v132
    v_fmac_f32 v240, v28, v132
    v_fmac_f32 v238, v21, v133
    v_fmac_f32 v240, v29, v133
    v_fmac_f32 v238, v22, v134
    v_fmac_f32 v240, v30, v134
    v_fmac_f32 v238, v23, v135
    v_fmac_f32 v240, v31, v135
    v_mul_f32 v235, v32, v104
    v_mul_f32 v237, v40, v136
    v_fmac_f32 v235, v33, v105
    v_fmac_f32 v237, v41, v137
    v_fmac_f32 v235, v34, v106
    v_fmac_f32 v237, v42, v138
    v_fmac_f32 v235, v35, v107
    v_fmac_f32 v237, v43, v139
    v_fmac_f32 v235, v36, v108
    v_fmac_f32 v237, v44, v140
    v_fmac_f32 v235, v37, v109
    v_fmac_f32 v237, v45, v141
    v_fmac_f32 v235, v38, v110
    v_fmac_f32 v237, v46, v142
    v_fmac_f32 v235, v39, v111
    v_fmac_f32 v237, v47, v143
    v_mul_f32 v239, v48, v136
    v_mul_f32 v241, v56, v136
    v_fmac_f32 v239, v49, v137
    v_fmac_f32 v241, v57, v137
    s_setprio 1
    s_waitcnt vmcnt(4) lgkmcnt(3)
    v_mfma_f32_32x32x16_bf16 v[0:15], v[64:67], v[176:179], 0
    ds_read_b64_tr_b16 v[184:185], v246 offset:6144
    ds_read_b64_tr_b16 v[186:187], v246 offset:6656
    ds_read_b64_tr_b16 v[188:189], v247 offset:6144
    ds_read_b64_tr_b16 v[190:191], v247 offset:6656
    v_fmac_f32 v239, v50, v138
    v_fmac_f32 v241, v58, v138
    s_mov_b32 m0, s70
    v_mfma_f32_32x32x16_bf16 v[16:31], v[68:71], v[176:179], 0
    buffer_load_dwordx4 v222, s[4:7], s43 offen sc1 lds
    buffer_load_dwordx4 v223, s[72:75], s43 offen offset:1024 sc1 lds
    v_fmac_f32 v239, v51, v139
    v_fmac_f32 v241, v59, v139
    v_fmac_f32 v239, v52, v140
    v_fmac_f32 v241, v60, v140
    v_fmac_f32 v239, v53, v141
    v_mfma_f32_32x32x16_bf16 v[32:47], v[64:67], v[180:183], 0
    s_and_b32 s60, s60, 0xff
    s_add_u32 s35, s60, s48
    s_mov_b32 s45, s44
    s_add_u32 s47, s44, 256
    s_add_u32 s49, s48, 32
    s_add_u32 s60, s48, 64
    s_cmp_eq_u32 s33, 3
    s_cselect_b32 s46, s44, s47
    s_cselect_b32 s50, s60, s48
    s_cselect_b32 s51, s48, s49
    s_sub_u32 s60, s33, 2
    s_cmp_lt_u32 s60, 2
    s_cbranch_scc0 K2_rare_38
K2_back_39:
    v_add_u32 v222, s48, v251
    ds_read_b32 v222, v222
    v_fmac_f32 v241, v61, v141
    v_fmac_f32 v239, v54, v142
    v_fmac_f32 v241, v62, v142
    v_fmac_f32 v239, v55, v143
    v_fmac_f32 v241, v63, v143
    v_mfma_f32_32x32x16_bf16 v[48:63], v[68:71], v[180:183], 0
    v_permlane32_swap_b32 v234, v236
    v_permlane32_swap_b32 v235, v237
    v_permlane32_swap_b32 v240, v238
    s_waitcnt vmcnt(4) lgkmcnt(1)
    v_mfma_f32_32x32x16_bf16 v[0:15], v[72:75], v[184:187], v[0:15]
    ds_read_b64_tr_b16 v[176:177], v246 offset:0
    ds_read_b64_tr_b16 v[178:179], v246 offset:512
    ds_read_b64_tr_b16 v[180:181], v247 offset:0
    ds_read_b64_tr_b16 v[182:183], v247 offset:512
    v_permlane32_swap_b32 v241, v239
    s_mov_b32 m0, s71
    v_mfma_f32_32x32x16_bf16 v[16:31], v[76:79], v[184:187], v[16:31]
    buffer_load_dwordx4 v224, s[4:7], s43 offen sc1 lds
    buffer_load_dwordx4 v225, s[72:75], s43 offen offset:1024 sc1 lds
    s_waitcnt lgkmcnt(4)
    v_mad_u32_u16 v223, v222, s39, v248 op_sel:[1,0,0,0]
    v_mad_u32_u16 v222, v222, s39, v248
    v_lshl_add_u32 v230, v252, 1, s31
    v_add_f32 v234, v234, v236
    v_add_f32 v235, v235, v237
    v_add_f32 v240, v240, v238
    v_add_f32 v241, v241, v239
    v_cvt_pk_bf16_f32 v234, v234, v235
    v_cvt_pk_bf16_f32 v240, v240, v241
    ds_write_b32 v230, v234 offset:0
    ds_write_b32 v230, v240 offset:256
    v_mfma_f32_32x32x16_bf16 v[32:47], v[72:75], v[188:191], v[32:47]
    v_add_u32 v224, s49, v251
    ds_read_b32 v224, v224
    v_mul_f32 v234, v0, v144
    v_mul_f32 v236, v8, v112
    v_fmac_f32 v234, v1, v145
    v_fmac_f32 v236, v9, v113
    v_fmac_f32 v234, v2, v146
    v_mfma_f32_32x32x16_bf16 v[48:63], v[76:79], v[188:191], v[48:63]
    s_setprio 0
    v_fmac_f32 v236, v10, v114
    v_fmac_f32 v234, v3, v147
    v_fmac_f32 v236, v11, v115
    v_fmac_f32 v234, v4, v148
    v_fmac_f32 v236, v12, v116
    v_fmac_f32 v234, v5, v149
    v_fmac_f32 v236, v13, v117
    v_fmac_f32 v234, v6, v150
    v_fmac_f32 v236, v14, v118
    v_fmac_f32 v234, v7, v151
    v_fmac_f32 v236, v15, v119
    v_mul_f32 v238, v16, v160
    v_mul_f32 v240, v24, v160
    v_fmac_f32 v238, v17, v161
    v_fmac_f32 v240, v25, v161
    v_fmac_f32 v238, v18, v162
    v_fmac_f32 v240, v26, v162
    v_fmac_f32 v238, v19, v163
    v_fmac_f32 v240, v27, v163
    v_fmac_f32 v238, v20, v164
    v_fmac_f32 v240, v28, v164
    v_fmac_f32 v238, v21, v165
    v_fmac_f32 v240, v29, v165
    v_fmac_f32 v238, v22, v166
    v_fmac_f32 v240, v30, v166
    v_fmac_f32 v238, v23, v167
    v_fmac_f32 v240, v31, v167
    v_mul_f32 v235, v32, v152
    v_mul_f32 v237, v40, v120
    v_fmac_f32 v235, v33, v153
    v_fmac_f32 v237, v41, v121
    v_fmac_f32 v235, v34, v154
    v_fmac_f32 v237, v42, v122
    v_fmac_f32 v235, v35, v155
    v_fmac_f32 v237, v43, v123
    v_fmac_f32 v235, v36, v156
    v_fmac_f32 v237, v44, v124
    v_fmac_f32 v235, v37, v157
    v_fmac_f32 v237, v45, v125
    v_fmac_f32 v235, v38, v158
    v_fmac_f32 v237, v46, v126
    v_fmac_f32 v235, v39, v159
    v_fmac_f32 v237, v47, v127
    v_mul_f32 v239, v48, v168
    v_mul_f32 v241, v56, v168
    v_fmac_f32 v239, v49, v169
    v_fmac_f32 v241, v57, v169
    v_fmac_f32 v239, v50, v170
    v_fmac_f32 v241, v58, v170
    v_fmac_f32 v239, v51, v171
    s_setprio 1
    s_waitcnt vmcnt(4) lgkmcnt(3)
    v_mfma_f32_32x32x16_bf16 v[0:15], v[64:67], v[176:179], 0
    ds_read_b64_tr_b16 v[184:185], v246 offset:2048
    ds_read_b64_tr_b16 v[186:187], v246 offset:2560
    ds_read_b64_tr_b16 v[188:189], v247 offset:2048
    ds_read_b64_tr_b16 v[190:191], v247 offset:2560
    v_fmac_f32 v241, v59, v171
    v_fmac_f32 v239, v52, v172
    s_mov_b32 m0, s68
    v_mfma_f32_32x32x16_bf16 v[16:31], v[68:71], v[176:179], 0
    buffer_load_dwordx4 v222, s[4:7], s44 offen sc1 lds
    buffer_load_dwordx4 v223, s[72:75], s44 offen offset:1024 sc1 lds
    s_waitcnt lgkmcnt(4)
    v_mad_u32_u16 v225, v224, s39, v248 op_sel:[1,0,0,0]
    v_mad_u32_u16 v224, v224, s39, v248
    v_fmac_f32 v241, v60, v172
    v_fmac_f32 v239, v53, v173
    v_mfma_f32_32x32x16_bf16 v[32:47], v[64:67], v[180:183], 0
    v_add_u32 v226, s50, v251
    ds_read_b32 v226, v226
    v_fmac_f32 v241, v61, v173
    v_fmac_f32 v239, v54, v174
    v_fmac_f32 v241, v62, v174
    v_fmac_f32 v239, v55, v175
    v_fmac_f32 v241, v63, v175
    v_mfma_f32_32x32x16_bf16 v[48:63], v[68:71], v[180:183], 0
    s_waitcnt vmcnt(4) lgkmcnt(1)
    v_mfma_f32_32x32x16_bf16 v[0:15], v[72:75], v[184:187], v[0:15]
    ds_read_b64_tr_b16 v[176:177], v246 offset:4096
    ds_read_b64_tr_b16 v[178:179], v246 offset:4608
    ds_read_b64_tr_b16 v[180:181], v247 offset:4096
    ds_read_b64_tr_b16 v[182:183], v247 offset:4608
    s_mov_b32 m0, s69
    v_mfma_f32_32x32x16_bf16 v[16:31], v[76:79], v[184:187], v[16:31]
    buffer_load_dwordx4 v224, s[4:7], s45 offen sc1 lds
    buffer_load_dwordx4 v225, s[72:75], s45 offen offset:1024 sc1 lds
    s_waitcnt lgkmcnt(4)
    v_mad_u32_u16 v227, v226, s39, v248 op_sel:[1,0,0,0]
    v_mad_u32_u16 v226, v226, s39, v248
    v_mfma_f32_32x32x16_bf16 v[32:47], v[72:75], v[188:191], v[32:47]
    v_add_u32 v228, s51, v251
    ds_read_b32 v228, v228
    v_mul_f32 v242, v0, v144
    v_fma_f32 v238, v8, v160, -v238
    v_fmac_f32 v242, v1, v145
    v_fmac_f32 v238, v9, v161
    v_fmac_f32 v242, v2, v146
    v_mfma_f32_32x32x16_bf16 v[48:63], v[76:79], v[188:191], v[48:63]
    s_setprio 0
    v_fmac_f32 v238, v10, v162
    v_fmac_f32 v242, v3, v147
    v_fmac_f32 v238, v11, v163
    v_fmac_f32 v242, v4, v148
    v_fmac_f32 v238, v12, v164
    v_fmac_f32 v242, v5, v149
    v_fmac_f32 v238, v13, v165
    v_fmac_f32 v242, v6, v150
    v_fmac_f32 v238, v14, v166
    v_fmac_f32 v242, v7, v151
    v_fmac_f32 v238, v15, v167
    v_fmac_f32 v236, v16, v112
    v_mul_f32 v244, v24, v160
    v_fmac_f32 v236, v17, v113
    v_fmac_f32 v244, v25, v161
    v_fmac_f32 v236, v18, v114
    v_fmac_f32 v244, v26, v162
    v_fmac_f32 v236, v19, v115
    v_fmac_f32 v244, v27, v163
    v_fmac_f32 v236, v20, v116
    v_fmac_f32 v244, v28, v164
    v_fmac_f32 v236, v21, v117
    v_fmac_f32 v244, v29, v165
    v_fmac_f32 v236, v22, v118
    v_fmac_f32 v244, v30, v166
    v_fmac_f32 v236, v23, v119
    v_fmac_f32 v244, v31, v167
    v_mul_f32 v243, v32, v152
    v_fma_f32 v239, v40, v168, -v239
    v_fmac_f32 v243, v33, v153
    v_fmac_f32 v239, v41, v169
    v_fmac_f32 v243, v34, v154
    v_fmac_f32 v239, v42, v170
    v_fmac_f32 v243, v35, v155
    v_fmac_f32 v239, v43, v171
    v_fmac_f32 v243, v36, v156
    v_fmac_f32 v239, v44, v172
    v_fmac_f32 v243, v37, v157
    v_fmac_f32 v239, v45, v173
    v_fmac_f32 v243, v38, v158
    v_fmac_f32 v239, v46, v174
    v_fmac_f32 v243, v39, v159
    v_fmac_f32 v239, v47, v175
    v_fmac_f32 v237, v48, v120
    v_mul_f32 v245, v56, v168
    v_fmac_f32 v237, v49, v121
    v_fmac_f32 v245, v57, v169
    v_fmac_f32 v237, v50, v122
    s_setprio 1
    s_waitcnt vmcnt(4) lgkmcnt(1)
    v_mfma_f32_32x32x16_bf16 v[0:15], v[64:67], v[176:179], 0
    ds_read_b64_tr_b16 v[184:185], v246 offset:6144
    ds_read_b64_tr_b16 v[186:187], v246 offset:6656
    ds_read_b64_tr_b16 v[188:189], v247 offset:6144
    ds_read_b64_tr_b16 v[190:191], v247 offset:6656
    v_fmac_f32 v245, v58, v170
    v_fmac_f32 v237, v51, v123
    s_mov_b32 m0, s70
    v_mfma_f32_32x32x16_bf16 v[16:31], v[68:71], v[176:179], 0
    buffer_load_dwordx4 v226, s[4:7], s46 offen sc1 lds
    buffer_load_dwordx4 v227, s[72:75], s46 offen offset:1024 sc1 lds
    s_waitcnt lgkmcnt(4)
    v_mad_u32_u16 v229, v228, s39, v248 op_sel:[1,0,0,0]
    v_mad_u32_u16 v228, v228, s39, v248
    v_fmac_f32 v245, v59, v171
    v_fmac_f32 v237, v52, v124
    v_mfma_f32_32x32x16_bf16 v[32:47], v[64:67], v[180:183], 0
    v_fmac_f32 v245, v60, v172
    v_fmac_f32 v237, v53, v125
    v_fmac_f32 v245, v61, v173
    v_fmac_f32 v237, v54, v126
    v_fmac_f32 v245, v62, v174
    v_fmac_f32 v237, v55, v127
    v_fmac_f32 v245, v63, v175
    v_mfma_f32_32x32x16_bf16 v[48:63], v[68:71], v[180:183], 0
    v_permlane32_swap_b32 v242, v234
    v_permlane32_swap_b32 v243, v235
    v_add_f32 v242, v242, v234
    v_add_f32 v243, v243, v235
    s_waitcnt vmcnt(4) lgkmcnt(0)
    v_mfma_f32_32x32x16_bf16 v[0:15], v[72:75], v[184:187], v[0:15]
    ds_read_b64_tr_b16 v[176:177], v246 offset:0
    ds_read_b64_tr_b16 v[178:179], v246 offset:512
    ds_read_b64_tr_b16 v[180:181], v247 offset:0
    ds_read_b64_tr_b16 v[182:183], v247 offset:512
    v_cvt_pk_bf16_f32 v242, v242, v243
    ds_write_b32 v230, v242 offset:512
    s_mov_b32 m0, s71
    v_mfma_f32_32x32x16_bf16 v[16:31], v[76:79], v[184:187], v[16:31]
    buffer_load_dwordx4 v228, s[4:7], s47 offen sc1 lds
    buffer_load_dwordx4 v229, s[72:75], s47 offen offset:1024 sc1 lds
    s_sub_u32 s26, s48, s29
    s_mov_b32 s29, s48
    s_mov_b32 s30, s3
    s_cmp_lg_u32 s36, 0
    s_cselect_b32 s56, s33, 0
    v_mfma_f32_32x32x16_bf16 v[32:47], v[72:75], v[188:191], v[32:47]
    s_mov_b32 s32, s31
    s_mov_b32 s31, s35
    v_mul_f32 v242, v0, v144
    v_fma_f32 v240, v8, v160, -v240
    v_fmac_f32 v242, v1, v145
    v_fmac_f32 v240, v9, v161
    v_fmac_f32 v242, v2, v146
    v_mfma_f32_32x32x16_bf16 v[48:63], v[76:79], v[188:191], v[48:63]
    s_setprio 0
    v_fmac_f32 v240, v10, v162
    v_fmac_f32 v242, v3, v147
    v_fmac_f32 v240, v11, v163
    v_fmac_f32 v242, v4, v148
    v_fmac_f32 v240, v12, v164
    v_fmac_f32 v242, v5, v149
    v_fmac_f32 v240, v13, v165
    v_fmac_f32 v242, v6, v150
    v_fmac_f32 v240, v14, v166
    v_fmac_f32 v242, v7, v151
    v_fmac_f32 v240, v15, v167
    v_add_u32 v249, s26, v249
    v_add_u32 v250, s26, v250
    v_fma_f32 v244, v16, v160, -v244
    v_fmac_f32 v236, v24, v112
    v_fmac_f32 v244, v17, v161
    v_fmac_f32 v236, v25, v113
    v_fmac_f32 v244, v18, v162
    v_fmac_f32 v236, v26, v114
    v_fmac_f32 v244, v19, v163
    v_fmac_f32 v236, v27, v115
    v_fmac_f32 v244, v20, v164
    v_fmac_f32 v236, v28, v116
    v_fmac_f32 v244, v21, v165
    v_fmac_f32 v236, v29, v117
    v_fmac_f32 v244, v22, v166
    v_fmac_f32 v236, v30, v118
    v_fmac_f32 v244, v23, v167
    v_fmac_f32 v236, v31, v119
    ds_read_b64_tr_b16 v[0:1], v249 offset:0
    ds_read_b64_tr_b16 v[2:3], v249 offset:128
    ds_read_b128 v[4:7], v250 offset:0
    ds_read_b128 v[8:11], v250 offset:16
    ds_read_b128 v[12:15], v250 offset:384
    ds_read_b128 v[16:19], v250 offset:400
    v_mul_f32 v243, v32, v152
    v_fma_f32 v241, v40, v168, -v241
    v_fmac_f32 v243, v33, v153
    v_fmac_f32 v241, v41, v169
    v_fmac_f32 v243, v34, v154
    v_fmac_f32 v241, v42, v170
    v_fmac_f32 v243, v35, v155
    v_fmac_f32 v241, v43, v171
    v_fmac_f32 v243, v36, v156
    v_fmac_f32 v241, v44, v172
    v_fmac_f32 v243, v37, v157
    v_fmac_f32 v241, v45, v173
    v_fmac_f32 v243, v38, v158
    v_fmac_f32 v241, v46, v174
    v_fmac_f32 v243, v39, v159
    v_fmac_f32 v241, v47, v175
    ds_read_b64_tr_b16 v[20:21], v249 offset:512
    ds_read_b64_tr_b16 v[22:23], v249 offset:640
    ds_read_b128 v[24:27], v250 offset:64
    ds_read_b128 v[28:31], v250 offset:80
    ds_read_b128 v[32:35], v250 offset:448
    ds_read_b128 v[36:39], v250 offset:464
    v_fma_f32 v245, v48, v168, -v245
    v_fmac_f32 v237, v56, v120
    v_fmac_f32 v245, v49, v169
    v_fmac_f32 v237, v57, v121
    v_fmac_f32 v245, v50, v170
    v_fmac_f32 v237, v58, v122
    v_fmac_f32 v245, v51, v171
    v_fmac_f32 v237, v59, v123
    v_fmac_f32 v245, v52, v172
    v_fmac_f32 v237, v60, v124
    v_fmac_f32 v245, v53, v173
    v_fmac_f32 v237, v61, v125
    v_fmac_f32 v245, v54, v174
    v_fmac_f32 v237, v62, v126
    v_fmac_f32 v245, v55, v175
    v_fmac_f32 v237, v63, v127
    s_cmp_eq_u32 s56, 2
    s_cbranch_scc1 K2_U21
    s_cmp_eq_u32 s56, 3
    s_cbranch_scc1 K2_U31
    s_branch K2_DSP1
K2_U31:
    s_setprio 1
    s_waitcnt lgkmcnt(6)
    v_lshlrev_b32 v40, 16, v0
    v_and_b32 v41, 0xffff0000, v0
    v_lshlrev_b32 v42, 16, v1
    v_and_b32 v43, 0xffff0000, v1
    v_lshlrev_b32 v44, 16, v2
    v_and_b32 v45, 0xffff0000, v2
    v_lshlrev_b32 v46, 16, v3
    v_and_b32 v47, 0xffff0000, v3
    v_mul_f32 v4, v40, v4
    v_mul_f32 v5, v41, v5
    v_mul_f32 v6, v42, v6
    v_mul_f32 v7, v43, v7
    v_mul_f32 v8, v44, v8
    v_mul_f32 v9, v45, v9
    v_mul_f32 v10, v46, v10
    v_mul_f32 v11, v47, v11
    v_cvt_pk_bf16_f32 v64, v4, v5
    v_cvt_pk_bf16_f32 v65, v6, v7
    v_cvt_pk_bf16_f32 v66, v8, v9
    v_cvt_pk_bf16_f32 v67, v10, v11
    v_mul_f32 v12, v40, v12
    v_mul_f32 v13, v41, v13
    v_mul_f32 v14, v42, v14
    v_mul_f32 v15, v43, v15
    v_mul_f32 v16, v44, v16
    v_mul_f32 v17, v45, v17
    v_mul_f32 v18, v46, v18
    v_mul_f32 v19, v47, v19
    v_cvt_pk_bf16_f32 v68, v12, v13
    v_cvt_pk_bf16_f32 v69, v14, v15
    v_cvt_pk_bf16_f32 v70, v16, v17
    v_cvt_pk_bf16_f32 v71, v18, v19
    ds_read_b64_tr_b16 v[0:1], v249 offset:1024
    ds_read_b64_tr_b16 v[2:3], v249 offset:1152
    ds_read_b128 v[4:7], v250 offset:128
    ds_read_b128 v[8:11], v250 offset:144
    ds_read_b128 v[12:15], v250 offset:512
    ds_read_b128 v[16:19], v250 offset:528
    s_waitcnt lgkmcnt(6)
    v_lshlrev_b32 v48, 16, v20
    v_and_b32 v49, 0xffff0000, v20
    v_lshlrev_b32 v50, 16, v21
    v_and_b32 v51, 0xffff0000, v21
    v_lshlrev_b32 v52, 16, v22
    v_and_b32 v53, 0xffff0000, v22
    v_lshlrev_b32 v54, 16, v23
    v_and_b32 v55, 0xffff0000, v23
    v_mul_f32 v24, v48, v24
    v_mul_f32 v25, v49, v25
    v_mul_f32 v26, v50, v26
    v_mul_f32 v27, v51, v27
    v_mul_f32 v28, v52, v28
    v_mul_f32 v29, v53, v29
    v_mul_f32 v30, v54, v30
    v_mul_f32 v31, v55, v31
    v_cvt_pk_bf16_f32 v72, v24, v25
    v_cvt_pk_bf16_f32 v73, v26, v27
    v_cvt_pk_bf16_f32 v74, v28, v29
    v_cvt_pk_bf16_f32 v75, v30, v31
    v_mul_f32 v32, v48, v32
    v_mul_f32 v33, v49, v33
    v_mul_f32 v34, v50, v34
    v_mul_f32 v35, v51, v35
    v_mul_f32 v36, v52, v36
    v_mul_f32 v37, v53, v37
    v_mul_f32 v38, v54, v38
    v_mul_f32 v39, v55, v39
    v_cvt_pk_bf16_f32 v76, v32, v33
    v_cvt_pk_bf16_f32 v77, v34, v35
    v_cvt_pk_bf16_f32 v78, v36, v37
    v_cvt_pk_bf16_f32 v79, v38, v39
    s_waitcnt lgkmcnt(4)
    v_lshlrev_b32 v40, 16, v0
    v_and_b32 v41, 0xffff0000, v0
    v_lshlrev_b32 v42, 16, v1
    v_and_b32 v43, 0xffff0000, v1
    v_lshlrev_b32 v44, 16, v2
    v_and_b32 v45, 0xffff0000, v2
    v_lshlrev_b32 v46, 16, v3
    v_and_b32 v47, 0xffff0000, v3
    s_waitcnt lgkmcnt(2)
    v_mul_f32 v4, v40, v4
    v_mul_f32 v5, v41, v5
    v_mul_f32 v6, v42, v6
    v_mul_f32 v7, v43, v7
    v_mul_f32 v8, v44, v8
    v_mul_f32 v9, v45, v9
    v_mul_f32 v10, v46, v10
    v_mul_f32 v11, v47, v11
    v_cvt_pk_bf16_f32 v80, v4, v5
    v_cvt_pk_bf16_f32 v81, v6, v7
    v_cvt_pk_bf16_f32 v82, v8, v9
    v_cvt_pk_bf16_f32 v83, v10, v11
    s_waitcnt lgkmcnt(0)
    v_mul_f32 v12, v40, v12
    v_mul_f32 v13, v41, v13
    v_mul_f32 v14, v42, v14
    v_mul_f32 v15, v43, v15
    v_mul_f32 v16, v44, v16
    v_mul_f32 v17, v45, v17
    v_mul_f32 v18, v46, v18
    v_mul_f32 v19, v47, v19
    v_cvt_pk_bf16_f32 v84, v12, v13
    v_cvt_pk_bf16_f32 v85, v14, v15
    v_cvt_pk_bf16_f32 v86, v16, v17
    v_cvt_pk_bf16_f32 v87, v18, v19
    s_waitcnt vmcnt(4)
    v_mfma_f32_32x32x16_bf16 v[0:15], v[64:67], v[176:179], 0
    ds_read_b64_tr_b16 v[184:185], v246 offset:2048
    ds_read_b64_tr_b16 v[186:187], v246 offset:2560
    ds_read_b64_tr_b16 v[188:189], v247 offset:2048
    ds_read_b64_tr_b16 v[190:191], v247 offset:2560
    s_mov_b32 m0, s68
    v_mfma_f32_32x32x16_bf16 v[16:31], v[68:71], v[176:179], 0
    buffer_load_dwordx4 v224, s[4:7], s41 offen sc1 lds
    buffer_load_dwordx4 v225, s[72:75], s41 offen offset:1024 sc1 lds
    v_permlane32_swap_b32 v242, v236
    v_permlane32_swap_b32 v243, v237
    v_mov_b32 v254, 163648
    v_mfma_f32_32x32x16_bf16 v[32:47], v[64:67], v[180:183], 0
    v_permlane32_swap_b32 v244, v238
    v_permlane32_swap_b32 v245, v239
    v_permlane32_swap_b32 v240, v241
    v_add_f32 v242, v242, v236
    v_mfma_f32_32x32x16_bf16 v[48:63], v[68:71], v[180:183], 0
    v_add_f32 v243, v243, v237
    v_add_f32 v244, v244, v238
    v_add_f32 v245, v245, v239
    v_add_f32 v240, -v240, -v241
    v_sub_u32 v241, v230, v231
    v_cvt_pk_bf16_f32 v242, v242, v243
    v_mov_b32 v255, 1
    v_lshl_add_u32 v233, v252, 1, s53
    s_mov_b64 exec, 1
    ds_add_rtn_u32 v232, v254, v255
    s_mov_b64 exec, -1
    ds_read_b32 v233, v233
    s_waitcnt vmcnt(4) lgkmcnt(2)
    v_mfma_f32_32x32x16_bf16 v[0:15], v[72:75], v[184:187], v[0:15]
    ds_read_b64_tr_b16 v[176:177], v246 offset:4096
    ds_read_b64_tr_b16 v[178:179], v246 offset:4608
    ds_read_b64_tr_b16 v[180:181], v247 offset:4096
    ds_read_b64_tr_b16 v[182:183], v247 offset:4608
    v_cvt_pk_bf16_f32 v244, v244, v245
    v_cvt_pk_bf16_f32 v240, v240, v240
    s_mov_b32 m0, s69
    v_mfma_f32_32x32x16_bf16 v[16:31], v[76:79], v[184:187], v[16:31]
    buffer_load_dwordx4 v226, s[4:7], s41 offen sc1 lds
    buffer_load_dwordx4 v227, s[72:75], s41 offen offset:1024 sc1 lds
    ds_write_b32 v230, v242 offset:768
    ds_write_b32 v230, v244 offset:1024
    ds_write_b16 v241, v240 offset:1280
    s_waitcnt lgkmcnt(7)
    v_readfirstlane_b32 s58, v232
    v_mfma_f32_32x32x16_bf16 v[32:47], v[72:75], v[188:191], v[32:47]
    s_cmp_lt_u32 s58, s22
    s_cbranch_scc0 K2_nul_41
    s_and_b32 s59, s58, 7
    s_lshr_b32 s60, s58, 3
K2_chk_43:
    v_readlane_b32 s61, v233, s59
    s_nop 0
    s_cmp_gt_u32 s61, s60
    s_cbranch_scc0 K2_spin_42
K2_back_44:
    v_mfma_f32_32x32x16_bf16 v[48:63], v[76:79], v[188:191], v[48:63]
    v_readlane_b32 s3, v253, s58
    s_lshl_b32 s44, s34, 7
    s_lshl_b32 s60, s58, 5
    s_and_b32 s48, s3, 0x3ffff
    s_bfe_u32 s33, s3, 0x30012
    s_sub_u32 s60, s60, s48
    s_waitcnt vmcnt(4) lgkmcnt(3)
    v_mfma_f32_32x32x16_bf16 v[0:15], v[80:83], v[176:179], v[0:15]
    ds_read_b64_tr_b16 v[184:185], v246 offset:6144
    ds_read_b64_tr_b16 v[186:187], v246 offset:6656
    ds_read_b64_tr_b16 v[188:189], v247 offset:6144
    ds_read_b64_tr_b16 v[190:191], v247 offset:6656
    s_and_b32 s60, s60, 0xff
    s_add_u32 s35, s60, s48
    s_mov_b32 m0, s70
    v_mfma_f32_32x32x16_bf16 v[16:31], v[84:87], v[176:179], v[16:31]
    buffer_load_dwordx4 v222, s[4:7], s42 offen sc1 lds
    buffer_load_dwordx4 v223, s[72:75], s42 offen offset:1024 sc1 lds
    s_mov_b32 s45, s44
    s_add_u32 s47, s44, 256
    s_add_u32 s49, s48, 32
    s_add_u32 s60, s48, 64
    v_mfma_f32_32x32x16_bf16 v[32:47], v[80:83], v[180:183], v[32:47]
    s_cmp_eq_u32 s33, 3
    s_cselect_b32 s46, s44, s47
    s_cselect_b32 s50, s60, s48
    s_cselect_b32 s51, s48, s49
    s_sub_u32 s60, s33, 2
    s_cmp_lt_u32 s60, 2
    s_cbranch_scc0 K2_rare_45
K2_back_46:
    v_mfma_f32_32x32x16_bf16 v[48:63], v[84:87], v[180:183], v[48:63]
    s_setprio 0
    v_mul_f32 v234, v0, v96
    v_mul_f32 v236, v8, v128
    v_fmac_f32 v234, v1, v97
    v_fmac_f32 v236, v9, v129
    v_fmac_f32 v234, v2, v98
    v_fmac_f32 v236, v10, v130
    v_fmac_f32 v234, v3, v99
    v_fmac_f32 v236, v11, v131
    v_fmac_f32 v234, v4, v100
    v_fmac_f32 v236, v12, v132
    v_fmac_f32 v234, v5, v101
    v_fmac_f32 v236, v13, v133
    v_fmac_f32 v234, v6, v102
    v_fmac_f32 v236, v14, v134
    v_fmac_f32 v234, v7, v103
    v_fmac_f32 v236, v15, v135
    v_mul_f32 v238, v16, v128
    v_mul_f32 v240, v24, v128
    v_fmac_f32 v238, v17, v129
    v_fmac_f32 v240, v25, v129
    v_fmac_f32 v238, v18, v130
    v_fmac_f32 v240, v26, v130
    v_fmac_f32 v238, v19, v131
    v_fmac_f32 v240, v27, v131
    v_fmac_f32 v238, v20, v132
    v_fmac_f32 v240, v28, v132
    v_fmac_f32 v238, v21, v133
    v_fmac_f32 v240, v29, v133
    v_fmac_f32 v238, v22, v134
    v_fmac_f32 v240, v30, v134
    v_fmac_f32 v238, v23, v135
    v_fmac_f32 v240, v31, v135
    v_mul_f32 v235, v32, v104
    v_mul_f32 v237, v40, v136
    v_fmac_f32 v235, v33, v105
    v_fmac_f32 v237, v41, v137
    v_fmac_f32 v235, v34, v106
    v_fmac_f32 v237, v42, v138
    v_fmac_f32 v235, v35, v107
    v_fmac_f32 v237, v43, v139
    v_fmac_f32 v235, v36, v108
    v_fmac_f32 v237, v44, v140
    v_fmac_f32 v235, v37, v109
    v_fmac_f32 v237, v45, v141
    v_fmac_f32 v235, v38, v110
    v_fmac_f32 v237, v46, v142
    v_fmac_f32 v235, v39, v111
    v_fmac_f32 v237, v47, v143
    v_mul_f32 v239, v48, v136
    v_mul_f32 v241, v56, v136
    s_setprio 1
    s_waitcnt vmcnt(4) lgkmcnt(0)
    v_mfma_f32_32x32x16_bf16 v[0:15], v[64:67], v[184:187], 0
    ds_read_b64_tr_b16 v[176:177], v246 offset:0
    ds_read_b64_tr_b16 v[178:179], v246 offset:512
    ds_read_b64_tr_b16 v[180:181], v247 offset:0
    ds_read_b64_tr_b16 v[182:183], v247 offset:512
    v_fmac_f32 v239, v49, v137
    v_fmac_f32 v241, v57, v137
    s_mov_b32 m0, s71
    v_mfma_f32_32x32x16_bf16 v[16:31], v[68:71], v[184:187], 0
    buffer_load_dwordx4 v224, s[4:7], s42 offen sc1 lds
    buffer_load_dwordx4 v225, s[72:75], s42 offen offset:1024 sc1 lds
    v_fmac_f32 v239, v50, v138
    v_fmac_f32 v241, v58, v138
    v_fmac_f32 v239, v51, v139
    v_fmac_f32 v241, v59, v139
    v_fmac_f32 v239, v52, v140
    v_mfma_f32_32x32x16_bf16 v[32:47], v[64:67], v[188:191], 0
    v_fmac_f32 v241, v60, v140
    v_fmac_f32 v239, v53, v141
    v_fmac_f32 v241, v61, v141
    v_fmac_f32 v239, v54, v142
    v_fmac_f32 v241, v62, v142
    v_fmac_f32 v239, v55, v143
    v_fmac_f32 v241, v63, v143
    v_mfma_f32_32x32x16_bf16 v[48:63], v[68:71], v[188:191], 0
    v_permlane32_swap_b32 v234, v236
    v_permlane32_swap_b32 v235, v237
    v_permlane32_swap_b32 v240, v238
    s_waitcnt vmcnt(4) lgkmcnt(0)
    v_mfma_f32_32x32x16_bf16 v[0:15], v[72:75], v[176:179], v[0:15]
    ds_read_b64_tr_b16 v[184:185], v246 offset:2048
    ds_read_b64_tr_b16 v[186:187], v246 offset:2560
    ds_read_b64_tr_b16 v[188:189], v247 offset:2048
    ds_read_b64_tr_b16 v[190:191], v247 offset:2560
    v_permlane32_swap_b32 v241, v239
    s_mov_b32 m0, s68
    v_mfma_f32_32x32x16_bf16 v[16:31], v[76:79], v[176:179], v[16:31]
    buffer_load_dwordx4 v226, s[4:7], s42 offen sc1 lds
    buffer_load_dwordx4 v227, s[72:75], s42 offen offset:1024 sc1 lds
    v_lshl_add_u32 v230, v252, 1, s31
    v_add_f32 v234, v234, v236
    v_add_f32 v235, v235, v237
    v_add_f32 v240, v240, v238
    v_add_f32 v241, v241, v239
    v_mfma_f32_32x32x16_bf16 v[32:47], v[72:75], v[180:183], v[32:47]
    v_cvt_pk_bf16_f32 v234, v234, v235
    v_cvt_pk_bf16_f32 v240, v240, v241
    ds_write_b32 v230, v234 offset:0
    ds_write_b32 v230, v240 offset:256
    v_mfma_f32_32x32x16_bf16 v[48:63], v[76:79], v[180:183], v[48:63]
    s_waitcnt vmcnt(4) lgkmcnt(2)
    v_mfma_f32_32x32x16_bf16 v[0:15], v[80:83], v[184:187], v[0:15]
    ds_read_b64_tr_b16 v[176:177], v246 offset:4096
    ds_read_b64_tr_b16 v[178:179], v246 offset:4608
    ds_read_b64_tr_b16 v[180:181], v247 offset:4096
    ds_read_b64_tr_b16 v[182:183], v247 offset:4608
    s_mov_b32 m0, s69
    v_mfma_f32_32x32x16_bf16 v[16:31], v[84:87], v[184:187], v[16:31]
    buffer_load_dwordx4 v222, s[4:7], s43 offen sc1 lds
    buffer_load_dwordx4 v223, s[72:75], s43 offen offset:1024 sc1 lds
    v_mfma_f32_32x32x16_bf16 v[32:47], v[80:83], v[188:191], v[32:47]
    s_nop 2
    v_mul_f32 v234, v0, v144
    v_mul_f32 v236, v8, v112
    v_fmac_f32 v234, v1, v145
    v_fmac_f32 v236, v9, v113
    v_fmac_f32 v234, v2, v146
    v_fmac_f32 v236, v10, v114
    v_fmac_f32 v234, v3, v147
    v_mfma_f32_32x32x16_bf16 v[48:63], v[84:87], v[188:191], v[48:63]
    s_setprio 0
    v_fmac_f32 v236, v11, v115
    v_fmac_f32 v234, v4, v148
    v_fmac_f32 v236, v12, v116
    v_fmac_f32 v234, v5, v149
    v_fmac_f32 v236, v13, v117
    v_fmac_f32 v234, v6, v150
    v_fmac_f32 v236, v14, v118
    v_fmac_f32 v234, v7, v151
    v_fmac_f32 v236, v15, v119
    v_mul_f32 v238, v16, v160
    v_mul_f32 v240, v24, v160
    v_fmac_f32 v238, v17, v161
    v_fmac_f32 v240, v25, v161
    v_fmac_f32 v238, v18, v162
    v_fmac_f32 v240, v26, v162
    v_fmac_f32 v238, v19, v163
    v_fmac_f32 v240, v27, v163
    v_fmac_f32 v238, v20, v164
    v_fmac_f32 v240, v28, v164
    v_fmac_f32 v238, v21, v165
    v_fmac_f32 v240, v29, v165
    v_fmac_f32 v238, v22, v166
    v_fmac_f32 v240, v30, v166
    v_fmac_f32 v238, v23, v167
    v_fmac_f32 v240, v31, v167
    v_mul_f32 v235, v32, v152
    v_mul_f32 v237, v40, v120
    v_fmac_f32 v235, v33, v153
    v_fmac_f32 v237, v41, v121
    v_fmac_f32 v235, v34, v154
    v_fmac_f32 v237, v42, v122
    v_fmac_f32 v235, v35, v155
    v_fmac_f32 v237, v43, v123
    v_fmac_f32 v235, v36, v156
    v_fmac_f32 v237, v44, v124
    v_fmac_f32 v235, v37, v157
    v_fmac_f32 v237, v45, v125
    v_fmac_f32 v235, v38, v158
    v_fmac_f32 v237, v46, v126
    v_fmac_f32 v235, v39, v159
    v_fmac_f32 v237, v47, v127
    v_mul_f32 v239, v48, v168
    v_mul_f32 v241, v56, v168
    v_fmac_f32 v239, v49, v169
    v_fmac_f32 v241, v57, v169
    s_setprio 1
    s_waitcnt vmcnt(4) lgkmcnt(0)
    v_mfma_f32_32x32x16_bf16 v[0:15], v[64:67], v[176:179], 0
    ds_read_b64_tr_b16 v[184:185], v246 offset:6144
    ds_read_b64_tr_b16 v[186:187], v246 offset:6656
    ds_read_b64_tr_b16 v[188:189], v247 offset:6144
    ds_read_b64_tr_b16 v[190:191], v247 offset:6656
    v_fmac_f32 v239, v50, v170
    v_fmac_f32 v241, v58, v170
    s_mov_b32 m0, s70
    v_mfma_f32_32x32x16_bf16 v[16:31], v[68:71], v[176:179], 0
    buffer_load_dwordx4 v224, s[4:7], s43 offen sc1 lds
    buffer_load_dwordx4 v225, s[72:75], s43 offen offset:1024 sc1 lds
    v_fmac_f32 v239, v51, v171
    v_fmac_f32 v241, v59, v171
    v_fmac_f32 v239, v52, v172
    v_fmac_f32 v241, v60, v172
    v_fmac_f32 v239, v53, v173
    v_mfma_f32_32x32x16_bf16 v[32:47], v[64:67], v[180:183], 0
    v_add_u32 v222, s48, v251
    ds_read_b32 v222, v222
    v_fmac_f32 v241, v61, v173
    v_fmac_f32 v239, v54, v174
    v_fmac_f32 v241, v62, v174
    v_fmac_f32 v239, v55, v175
    v_fmac_f32 v241, v63, v175
    v_mfma_f32_32x32x16_bf16 v[48:63], v[68:71], v[180:183], 0
    s_waitcnt vmcnt(4) lgkmcnt(1)
    v_mfma_f32_32x32x16_bf16 v[0:15], v[72:75], v[184:187], v[0:15]
    ds_read_b64_tr_b16 v[176:177], v246 offset:0
    ds_read_b64_tr_b16 v[178:179], v246 offset:512
    ds_read_b64_tr_b16 v[180:181], v247 offset:0
    ds_read_b64_tr_b16 v[182:183], v247 offset:512
    s_mov_b32 m0, s71
    v_mfma_f32_32x32x16_bf16 v[16:31], v[76:79], v[184:187], v[16:31]
    buffer_load_dwordx4 v226, s[4:7], s43 offen sc1 lds
    buffer_load_dwordx4 v227, s[72:75], s43 offen offset:1024 sc1 lds
    s_waitcnt lgkmcnt(4)
    v_mad_u32_u16 v223, v222, s39, v248 op_sel:[1,0,0,0]
    v_mad_u32_u16 v222, v222, s39, v248
    v_mfma_f32_32x32x16_bf16 v[32:47], v[72:75], v[188:191], v[32:47]
    v_add_u32 v224, s49, v251
    ds_read_b32 v224, v224
    v_mfma_f32_32x32x16_bf16 v[48:63], v[76:79], v[188:191], v[48:63]
    s_waitcnt vmcnt(4) lgkmcnt(1)
    v_mfma_f32_32x32x16_bf16 v[0:15], v[80:83], v[176:179], v[0:15]
    ds_read_b64_tr_b16 v[184:185], v246 offset:2048
    ds_read_b64_tr_b16 v[186:187], v246 offset:2560
    ds_read_b64_tr_b16 v[188:189], v247 offset:2048
    ds_read_b64_tr_b16 v[190:191], v247 offset:2560
    s_mov_b32 m0, s68
    v_mfma_f32_32x32x16_bf16 v[16:31], v[84:87], v[176:179], v[16:31]
    buffer_load_dwordx4 v222, s[4:7], s44 offen sc1 lds
    buffer_load_dwordx4 v223, s[72:75], s44 offen offset:1024 sc1 lds
    s_waitcnt lgkmcnt(4)
    v_mad_u32_u16 v225, v224, s39, v248 op_sel:[1,0,0,0]
    v_mad_u32_u16 v224, v224, s39, v248
    v_mfma_f32_32x32x16_bf16 v[32:47], v[80:83], v[180:183], v[32:47]
    v_add_u32 v226, s50, v251
    ds_read_b32 v226, v226
    v_mul_f32 v242, v0, v144
    v_fma_f32 v238, v8, v160, -v238
    v_fmac_f32 v242, v1, v145
    v_fmac_f32 v238, v9, v161
    v_fmac_f32 v242, v2, v146
    v_mfma_f32_32x32x16_bf16 v[48:63], v[84:87], v[180:183], v[48:63]
    s_setprio 0
    v_fmac_f32 v238, v10, v162
    v_fmac_f32 v242, v3, v147
    v_fmac_f32 v238, v11, v163
    v_fmac_f32 v242, v4, v148
    v_fmac_f32 v238, v12, v164
    v_fmac_f32 v242, v5, v149
    v_fmac_f32 v238, v13, v165
    v_fmac_f32 v242, v6, v150
    v_fmac_f32 v238, v14, v166
    v_fmac_f32 v242, v7, v151
    v_fmac_f32 v238, v15, v167
    v_fmac_f32 v236, v16, v112
    v_mul_f32 v244, v24, v160
    v_fmac_f32 v236, v17, v113
    v_fmac_f32 v244, v25, v161
    v_fmac_f32 v236, v18, v114
    v_fmac_f32 v244, v26, v162
    v_fmac_f32 v236, v19, v115
    v_fmac_f32 v244, v27, v163
    v_fmac_f32 v236, v20, v116
    v_fmac_f32 v244, v28, v164
    v_fmac_f32 v236, v21, v117
    v_fmac_f32 v244, v29, v165
    v_fmac_f32 v236, v22, v118
    v_fmac_f32 v244, v30, v166
    v_fmac_f32 v236, v23, v119
    v_fmac_f32 v244, v31, v167
    v_mul_f32 v243, v32, v152
    v_fma_f32 v239, v40, v168, -v239
    v_fmac_f32 v243, v33, v153
    v_fmac_f32 v239, v41, v169
    v_fmac_f32 v243, v34, v154
    v_fmac_f32 v239, v42, v170
    v_fmac_f32 v243, v35, v155
    v_fmac_f32 v239, v43, v171
    v_fmac_f32 v243, v36, v156
    v_fmac_f32 v239, v44, v172
    v_fmac_f32 v243, v37, v157
    v_fmac_f32 v239, v45, v173
    v_fmac_f32 v243, v38, v158
    v_fmac_f32 v239, v46, v174
    v_fmac_f32 v243, v39, v159
    v_fmac_f32 v239, v47, v175
    v_fmac_f32 v237, v48, v120
    v_mul_f32 v245, v56, v168
    v_fmac_f32 v237, v49, v121
    v_fmac_f32 v245, v57, v169
    v_fmac_f32 v237, v50, v122
    v_fmac_f32 v245, v58, v170
    v_fmac_f32 v237, v51, v123
    s_setprio 1
    s_waitcnt vmcnt(4) lgkmcnt(1)
    v_mfma_f32_32x32x16_bf16 v[0:15], v[64:67], v[184:187], 0
    ds_read_b64_tr_b16 v[176:177], v246 offset:4096
    ds_read_b64_tr_b16 v[178:179], v246 offset:4608
    ds_read_b64_tr_b16 v[180:181], v247 offset:4096
    ds_read_b64_tr_b16 v[182:183], v247 offset:4608
    v_fmac_f32 v245, v59, v171
    v_fmac_f32 v237, v52, v124
    s_mov_b32 m0, s69
    v_mfma_f32_32x32x16_bf16 v[16:31], v[68:71], v[184:187], 0
    buffer_load_dwordx4 v224, s[4:7], s45 offen sc1 lds
    buffer_load_dwordx4 v225, s[72:75], s45 offen offset:1024 sc1 lds
    s_waitcnt lgkmcnt(4)
    v_mad_u32_u16 v227, v226, s39, v248 op_sel:[1,0,0,0]
    v_mad_u32_u16 v226, v226, s39, v248
    v_fmac_f32 v245, v60, v172
    v_fmac_f32 v237, v53, v125
    v_mfma_f32_32x32x16_bf16 v[32:47], v[64:67], v[188:191], 0
    v_add_u32 v228, s51, v251
    ds_read_b32 v228, v228
    v_fmac_f32 v245, v61, v173
    v_fmac_f32 v237, v54, v126
    v_fmac_f32 v245, v62, v174
    v_fmac_f32 v237, v55, v127
    v_fmac_f32 v245, v63, v175
    v_mfma_f32_32x32x16_bf16 v[48:63], v[68:71], v[188:191], 0
    v_permlane32_swap_b32 v242, v234
    v_permlane32_swap_b32 v243, v235
    v_add_f32 v242, v242, v234
    v_add_f32 v243, v243, v235
    s_waitcnt vmcnt(4) lgkmcnt(1)
    v_mfma_f32_32x32x16_bf16 v[0:15], v[72:75], v[176:179], v[0:15]
    ds_read_b64_tr_b16 v[184:185], v246 offset:6144
    ds_read_b64_tr_b16 v[186:187], v246 offset:6656
    ds_read_b64_tr_b16 v[188:189], v247 offset:6144
    ds_read_b64_tr_b16 v[190:191], v247 offset:6656
    v_cvt_pk_bf16_f32 v242, v242, v243
    ds_write_b32 v230, v242 offset:512
    s_mov_b32 m0, s70
    v_mfma_f32_32x32x16_bf16 v[16:31], v[76:79], v[176:179], v[16:31]
    buffer_load_dwordx4 v226, s[4:7], s46 offen sc1 lds
    buffer_load_dwordx4 v227, s[72:75], s46 offen offset:1024 sc1 lds
    s_waitcnt lgkmcnt(5)
    v_mad_u32_u16 v229, v228, s39, v248 op_sel:[1,0,0,0]
    v_mad_u32_u16 v228, v228, s39, v248
    s_sub_u32 s26, s48, s29
    s_mov_b32 s29, s48
    v_mfma_f32_32x32x16_bf16 v[32:47], v[72:75], v[180:183], v[32:47]
    s_mov_b32 s30, s3
    s_cmp_lg_u32 s36, 0
    s_cselect_b32 s56, s33, 0
    s_mov_b32 s32, s31
    s_mov_b32 s31, s35
    v_mfma_f32_32x32x16_bf16 v[48:63], v[76:79], v[180:183], v[48:63]
    s_waitcnt vmcnt(4) lgkmcnt(1)
    v_mfma_f32_32x32x16_bf16 v[0:15], v[80:83], v[184:187], v[0:15]
    ds_read_b64_tr_b16 v[176:177], v246 offset:0
    ds_read_b64_tr_b16 v[178:179], v246 offset:512
    ds_read_b64_tr_b16 v[180:181], v247 offset:0
    ds_read_b64_tr_b16 v[182:183], v247 offset:512
    s_mov_b32 m0, s71
    v_mfma_f32_32x32x16_bf16 v[16:31], v[84:87], v[184:187], v[16:31]
    buffer_load_dwordx4 v228, s[4:7], s47 offen sc1 lds
    buffer_load_dwordx4 v229, s[72:75], s47 offen offset:1024 sc1 lds
    v_mfma_f32_32x32x16_bf16 v[32:47], v[80:83], v[188:191], v[32:47]
    s_nop 2
    v_mul_f32 v242, v0, v144
    v_fma_f32 v240, v8, v160, -v240
    v_fmac_f32 v242, v1, v145
    v_fmac_f32 v240, v9, v161
    v_fmac_f32 v242, v2, v146
    v_fmac_f32 v240, v10, v162
    v_fmac_f32 v242, v3, v147
    v_mfma_f32_32x32x16_bf16 v[48:63], v[84:87], v[188:191], v[48:63]
    s_setprio 0
    v_fmac_f32 v240, v11, v163
    v_fmac_f32 v242, v4, v148
    v_fmac_f32 v240, v12, v164
    v_fmac_f32 v242, v5, v149
    v_fmac_f32 v240, v13, v165
    v_fmac_f32 v242, v6, v150
    v_fmac_f32 v240, v14, v166
    v_fmac_f32 v242, v7, v151
    v_fmac_f32 v240, v15, v167
    v_add_u32 v249, s26, v249
    v_add_u32 v250, s26, v250
    v_fma_f32 v244, v16, v160, -v244
    v_fmac_f32 v236, v24, v112
    v_fmac_f32 v244, v17, v161
    v_fmac_f32 v236, v25, v113
    v_fmac_f32 v244, v18, v162
    v_fmac_f32 v236, v26, v114
    v_fmac_f32 v244, v19, v163
    v_fmac_f32 v236, v27, v115
    v_fmac_f32 v244, v20, v164
    v_fmac_f32 v236, v28, v116
    v_fmac_f32 v244, v21, v165
    v_fmac_f32 v236, v29, v117
    v_fmac_f32 v244, v22, v166
    v_fmac_f32 v236, v30, v118
    v_fmac_f32 v244, v23, v167
    v_fmac_f32 v236, v31, v119
    ds_read_b64_tr_b16 v[0:1], v249 offset:0
    ds_read_b64_tr_b16 v[2:3], v249 offset:128
    ds_read_b128 v[4:7], v250 offset:0
    ds_read_b128 v[8:11], v250 offset:16
    ds_read_b128 v[12:15], v250 offset:384
    ds_read_b128 v[16:19], v250 offset:400
    v_mul_f32 v243, v32, v152
    v_fma_f32 v241, v40, v168, -v241
    v_fmac_f32 v243, v33, v153
    v_fmac_f32 v241, v41, v169
    v_fmac_f32 v243, v34, v154
    v_fmac_f32 v241, v42, v170
    v_fmac_f32 v243, v35, v155
    v_fmac_f32 v241, v43, v171
    v_fmac_f32 v243, v36, v156
    v_fmac_f32 v241, v44, v172
    v_fmac_f32 v243, v37, v157
    v_fmac_f32 v241, v45, v173
    v_fmac_f32 v243, v38, v158
    v_fmac_f32 v241, v46, v174
    v_fmac_f32 v243, v39, v159
    v_fmac_f32 v241, v47, v175
    ds_read_b64_tr_b16 v[20:21], v249 offset:512
    ds_read_b64_tr_b16 v[22:23], v249 offset:640
    ds_read_b128 v[24:27], v250 offset:64
    ds_read_b128 v[28:31], v250 offset:80
    ds_read_b128 v[32:35], v250 offset:448
    ds_read_b128 v[36:39], v250 offset:464
    v_fma_f32 v245, v48, v168, -v245
    v_fmac_f32 v237, v56, v120
    v_fmac_f32 v245, v49, v169
    v_fmac_f32 v237, v57, v121
    v_fmac_f32 v245, v50, v170
    v_fmac_f32 v237, v58, v122
    v_fmac_f32 v245, v51, v171
    v_fmac_f32 v237, v59, v123
    v_fmac_f32 v245, v52, v172
    v_fmac_f32 v237, v60, v124
    v_fmac_f32 v245, v53, v173
    v_fmac_f32 v237, v61, v125
    v_fmac_f32 v245, v54, v174
    v_fmac_f32 v237, v62, v126
    v_fmac_f32 v245, v55, v175
    v_fmac_f32 v237, v63, v127
    s_cmp_eq_u32 s56, 2
    s_cbranch_scc1 K2_U21
    s_cmp_eq_u32 s56, 3
    s_cbranch_scc1 K2_U31
    s_branch K2_DSP1
K2_U10:
    s_setprio 1
    s_add_u32 s38, s38, 1
    v_mov_b32 v254, s52
    v_mov_b32 v255, s38
    s_lshl_b32 s58, s38, 3
    s_add_u32 s58, s58, s20
    s_mov_b64 exec, 1
    ds_write_b32 v254, v255
    s_mov_b64 exec, -1
    s_cmp_lt_u32 s58, s22
    s_cbranch_scc0 K2_dyn_48
K2_back_49:
    s_waitcnt lgkmcnt(7)
    v_lshlrev_b32 v40, 16, v0
    v_and_b32 v41, 0xffff0000, v0
    v_lshlrev_b32 v42, 16, v1
    v_and_b32 v43, 0xffff0000, v1
    v_lshlrev_b32 v44, 16, v2
    v_and_b32 v45, 0xffff0000, v2
    v_lshlrev_b32 v46, 16, v3
    v_and_b32 v47, 0xffff0000, v3
    v_mul_f32 v4, v40, v4
    v_mul_f32 v5, v41, v5
    v_mul_f32 v6, v42, v6
    v_mul_f32 v7, v43, v7
    v_mul_f32 v8, v44, v8
    v_mul_f32 v9, v45, v9
    v_mul_f32 v10, v46, v10
    v_mul_f32 v11, v47, v11
    v_cvt_pk_bf16_f32 v64, v4, v5
    v_cvt_pk_bf16_f32 v65, v6, v7
    v_cvt_pk_bf16_f32 v66, v8, v9
    v_cvt_pk_bf16_f32 v67, v10, v11
    v_mul_f32 v12, v40, v12
    v_mul_f32 v13, v41, v13
    v_mul_f32 v14, v42, v14
    v_mul_f32 v15, v43, v15
    v_mul_f32 v16, v44, v16
    v_mul_f32 v17, v45, v17
    v_mul_f32 v18, v46, v18
    v_mul_f32 v19, v47, v19
    v_cvt_pk_bf16_f32 v68, v12, v13
    v_cvt_pk_bf16_f32 v69, v14, v15
    v_cvt_pk_bf16_f32 v70, v16, v17
    v_cvt_pk_bf16_f32 v71, v18, v19
    v_readlane_b32 s3, v253, s58
    s_lshl_b32 s44, s34, 7
    s_lshl_b32 s60, s58, 5
    s_and_b32 s48, s3, 0x3ffff
    s_bfe_u32 s33, s3, 0x30012
    s_sub_u32 s60, s60, s48
    s_and_b32 s60, s60, 0xff
    s_add_u32 s60, s60, s48
    s_mul_i32 s35, s38, 6
    s_cmp_eq_u32 s34, 0
    s_cselect_b32 s35, s35, s60
    s_mov_b32 s45, s44
    s_add_u32 s47, s44, 256
    s_add_u32 s49, s48, 32
    s_add_u32 s60, s48, 64
    s_cmp_eq_u32 s33, 3
    s_cselect_b32 s46, s44, s47
    s_cselect_b32 s50, s60, s48
    s_cselect_b32 s51, s48, s49
    s_sub_u32 s60, s33, 2
    s_cmp_lt_u32 s60, 2
    s_cbranch_scc0 K2_rare_54
K2_back_55:
    v_add_u32 v233, s48, v230
    ds_read_b32 v232, v233
    ds_read_b32 v233, v233 offset:1024
    v_add_u32 v222, s48, v251
    ds_read_b32 v222, v222
    v_add_u32 v224, s49, v251
    ds_read_b32 v224, v224
    v_add_u32 v226, s50, v251
    ds_read_b32 v226, v226
    v_add_u32 v228, s51, v251
    ds_read_b32 v228, v228
    s_waitcnt lgkmcnt(4)
    v_or_b32 v232, v232, v231
    v_or_b32 v233, v233, v231
    s_cmp_lg_u32 s34, 0
    s_cbranch_scc1 K2_dum_57
    s_add_u32 m0, s48, 864
    s_add_u32 s65, s48, 1888
    buffer_load_dwordx4 v232, s[16:19], 0 offen  lds
    s_mov_b32 m0, s65
    s_mov_b32 exec_hi, 0
    buffer_load_dwordx4 v233, s[16:19], 0 offen  lds
    s_cmp_eq_u32 s33, 4
    s_cbranch_scc1 K2_a4_58
K2_b4_60:
    s_mov_b32 exec_hi, -1
K2_back_59:
    s_waitcnt lgkmcnt(3)
    v_mad_u32_u16 v223, v222, s39, v248 op_sel:[1,0,0,0]
    v_mad_u32_u16 v222, v222, s39, v248
    s_waitcnt lgkmcnt(2)
    v_mad_u32_u16 v225, v224, s39, v248 op_sel:[1,0,0,0]
    v_mad_u32_u16 v224, v224, s39, v248
    s_waitcnt lgkmcnt(1)
    v_mad_u32_u16 v227, v226, s39, v248 op_sel:[1,0,0,0]
    v_mad_u32_u16 v226, v226, s39, v248
    s_waitcnt lgkmcnt(0)
    v_mad_u32_u16 v229, v228, s39, v248 op_sel:[1,0,0,0]
    v_mad_u32_u16 v228, v228, s39, v248
    s_waitcnt vmcnt(6)
    v_mfma_f32_32x32x16_bf16 v[0:15], v[64:67], v[176:179], 0
    ds_read_b64_tr_b16 v[184:185], v246 offset:2048
    ds_read_b64_tr_b16 v[186:187], v246 offset:2560
    ds_read_b64_tr_b16 v[188:189], v247 offset:2048
    ds_read_b64_tr_b16 v[190:191], v247 offset:2560
    s_mov_b32 m0, s68
    v_mfma_f32_32x32x16_bf16 v[16:31], v[68:71], v[176:179], 0
    buffer_load_dwordx4 v222, s[4:7], s44 offen sc1 lds
    buffer_load_dwordx4 v223, s[72:75], s44 offen offset:1024 sc1 lds
    v_permlane32_swap_b32 v242, v236
    v_permlane32_swap_b32 v243, v237
    v_mfma_f32_32x32x16_bf16 v[32:47], v[64:67], v[180:183], 0
    v_permlane32_swap_b32 v244, v238
    v_permlane32_swap_b32 v245, v239
    v_permlane32_swap_b32 v240, v241
    v_add_f32 v242, v242, v236
    v_mfma_f32_32x32x16_bf16 v[48:63], v[68:71], v[180:183], 0
    s_setprio 0
    v_add_f32 v243, v243, v237
    v_add_f32 v244, v244, v238
    v_add_f32 v245, v245, v239
    v_add_f32 v240, -v240, -v241
    s_set_gpr_idx_on s32, gpr_idx(DST)
    s_nop 0
    v_cvt_pk_bf16_f32 v195, v242, v243
    v_cvt_pk_bf16_f32 v196, v244, v245
    v_cvt_pk_bf16_f32 v197, v240, v240
    s_set_gpr_idx_off
    v_mul_f32 v234, v0, v96
    v_mul_f32 v236, v8, v128
    v_fmac_f32 v234, v1, v97
    v_fmac_f32 v236, v9, v129
    v_fmac_f32 v234, v2, v98
    v_fmac_f32 v236, v10, v130
    v_fmac_f32 v234, v3, v99
    v_fmac_f32 v236, v11, v131
    v_fmac_f32 v234, v4, v100
    v_fmac_f32 v236, v12, v132
    v_fmac_f32 v234, v5, v101
    v_fmac_f32 v236, v13, v133
    v_fmac_f32 v234, v6, v102
    v_fmac_f32 v236, v14, v134
    v_fmac_f32 v234, v7, v103
    v_fmac_f32 v236, v15, v135
    v_mul_f32 v238, v16, v128
    v_mul_f32 v240, v24, v128
    v_fmac_f32 v238, v17, v129
    v_fmac_f32 v240, v25, v129
    v_fmac_f32 v238, v18, v130
    v_fmac_f32 v240, v26, v130
    v_fmac_f32 v238, v19, v131
    v_fmac_f32 v240, v27, v131
    v_fmac_f32 v238, v20, v132
    v_fmac_f32 v240, v28, v132
    v_fmac_f32 v238, v21, v133
    v_fmac_f32 v240, v29, v133
    v_fmac_f32 v238, v22, v134
    v_fmac_f32 v240, v30, v134
    v_fmac_f32 v238, v23, v135
    v_fmac_f32 v240, v31, v135
    v_mul_f32 v235, v32, v104
    v_mul_f32 v237, v40, v136
    v_fmac_f32 v235, v33, v105
    v_fmac_f32 v237, v41, v137
    v_fmac_f32 v235, v34, v106
    v_fmac_f32 v237, v42, v138
    v_fmac_f32 v235, v35, v107
    v_fmac_f32 v237, v43, v139
    v_fmac_f32 v235, v36, v108
    v_fmac_f32 v237, v44, v140
    v_fmac_f32 v235, v37, v109
    v_fmac_f32 v237, v45, v141
    v_fmac_f32 v235, v38, v110
    v_fmac_f32 v237, v46, v142
    v_fmac_f32 v235, v39, v111
    v_fmac_f32 v237, v47, v143
    v_mul_f32 v239, v48, v136
    v_mul_f32 v241, v56, v136
    v_fmac_f32 v239, v49, v137
    v_fmac_f32 v241, v57, v137
    v_fmac_f32 v239, v50, v138
    v_fmac_f32 v241, v58, v138
    v_fmac_f32 v239, v51, v139
    v_fmac_f32 v241, v59, v139
    v_fmac_f32 v239, v52, v140
    v_fmac_f32 v241, v60, v140
    v_fmac_f32 v239, v53, v141
    v_fmac_f32 v241, v61, v141
    v_fmac_f32 v239, v54, v142
    v_fmac_f32 v241, v62, v142
    v_fmac_f32 v239, v55, v143
    v_fmac_f32 v241, v63, v143
    s_setprio 1
    s_waitcnt vmcnt(6) lgkmcnt(0)
    v_mfma_f32_32x32x16_bf16 v[0:15], v[64:67], v[184:187], 0
    ds_read_b64_tr_b16 v[176:177], v246 offset:4096
    ds_read_b64_tr_b16 v[178:179], v246 offset:4608
    ds_read_b64_tr_b16 v[180:181], v247 offset:4096
    ds_read_b64_tr_b16 v[182:183], v247 offset:4608
    s_mov_b32 m0, s69
    v_mfma_f32_32x32x16_bf16 v[16:31], v[68:71], v[184:187], 0
    buffer_load_dwordx4 v224, s[4:7], s45 offen sc1 lds
    buffer_load_dwordx4 v225, s[72:75], s45 offen offset:1024 sc1 lds
    v_permlane32_swap_b32 v234, v236
    v_permlane32_swap_b32 v235, v237
    v_mfma_f32_32x32x16_bf16 v[32:47], v[64:67], v[188:191], 0
    v_permlane32_swap_b32 v240, v238
    v_permlane32_swap_b32 v241, v239
    v_add_f32 v234, v234, v236
    v_add_f32 v235, v235, v237
    v_add_f32 v240, v240, v238
    v_mfma_f32_32x32x16_bf16 v[48:63], v[68:71], v[188:191], 0
    s_setprio 0
    v_add_f32 v241, v241, v239
    s_set_gpr_idx_on s31, gpr_idx(DST)
    s_nop 0
    v_cvt_pk_bf16_f32 v192, v234, v235
    v_cvt_pk_bf16_f32 v193, v240, v241
    s_set_gpr_idx_off
    v_mul_f32 v234, v0, v144
    v_mul_f32 v236, v8, v112
    v_fmac_f32 v234, v1, v145
    v_fmac_f32 v236, v9, v113
    v_fmac_f32 v234, v2, v146
    v_fmac_f32 v236, v10, v114
    v_fmac_f32 v234, v3, v147
    v_fmac_f32 v236, v11, v115
    v_fmac_f32 v234, v4, v148
    v_fmac_f32 v236, v12, v116
    v_fmac_f32 v234, v5, v149
    v_fmac_f32 v236, v13, v117
    v_fmac_f32 v234, v6, v150
    v_fmac_f32 v236, v14, v118
    v_fmac_f32 v234, v7, v151
    v_fmac_f32 v236, v15, v119
    v_mul_f32 v238, v16, v160
    v_mul_f32 v240, v24, v160
    v_fmac_f32 v238, v17, v161
    v_fmac_f32 v240, v25, v161
    v_fmac_f32 v238, v18, v162
    v_fmac_f32 v240, v26, v162
    v_fmac_f32 v238, v19, v163
    v_fmac_f32 v240, v27, v163
    v_fmac_f32 v238, v20, v164
    v_fmac_f32 v240, v28, v164
    v_fmac_f32 v238, v21, v165
    v_fmac_f32 v240, v29, v165
    v_fmac_f32 v238, v22, v166
    v_fmac_f32 v240, v30, v166
    v_fmac_f32 v238, v23, v167
    v_fmac_f32 v240, v31, v167
    v_mul_f32 v235, v32, v152
    v_mul_f32 v237, v40, v120
    v_fmac_f32 v235, v33, v153
    v_fmac_f32 v237, v41, v121
    v_fmac_f32 v235, v34, v154
    v_fmac_f32 v237, v42, v122
    v_fmac_f32 v235, v35, v155
    v_fmac_f32 v237, v43, v123
    v_fmac_f32 v235, v36, v156
    v_fmac_f32 v237, v44, v124
    v_fmac_f32 v235, v37, v157
    v_fmac_f32 v237, v45, v125
    v_fmac_f32 v235, v38, v158
    v_fmac_f32 v237, v46, v126
    v_fmac_f32 v235, v39, v159
    v_fmac_f32 v237, v47, v127
    v_mul_f32 v239, v48, v168
    v_mul_f32 v241, v56, v168
    v_fmac_f32 v239, v49, v169
    v_fmac_f32 v241, v57, v169
    v_fmac_f32 v239, v50, v170
    v_fmac_f32 v241, v58, v170
    v_fmac_f32 v239, v51, v171
    v_fmac_f32 v241, v59, v171
    v_fmac_f32 v239, v52, v172
    v_fmac_f32 v241, v60, v172
    v_fmac_f32 v239, v53, v173
    v_fmac_f32 v241, v61, v173
    v_fmac_f32 v239, v54, v174
    v_fmac_f32 v241, v62, v174
    v_fmac_f32 v239, v55, v175
    v_fmac_f32 v241, v63, v175
    s_setprio 1
    s_waitcnt vmcnt(6) lgkmcnt(0)
    v_mfma_f32_32x32x16_bf16 v[0:15], v[64:67], v[176:179], 0
    ds_read_b64_tr_b16 v[184:185], v246 offset:6144
    ds_read_b64_tr_b16 v[186:187], v246 offset:6656
    ds_read_b64_tr_b16 v[188:189], v247 offset:6144
    ds_read_b64_tr_b16 v[190:191], v247 offset:6656
    s_mov_b32 m0, s70
    v_mfma_f32_32x32x16_bf16 v[16:31], v[68:71], v[176:179], 0
    buffer_load_dwordx4 v226, s[4:7], s46 offen sc1 lds
    buffer_load_dwordx4 v227, s[72:75], s46 offen offset:1024 sc1 lds
    s_sub_u32 s26, s48, s29
    s_mov_b32 s29, s48
    s_mov_b32 s30, s3
    s_cmp_eq_u32 s34, 0
    s_cselect_b32 s56, s33, 0
    v_mfma_f32_32x32x16_bf16 v[32:47], v[64:67], v[180:183], 0
    v_mfma_f32_32x32x16_bf16 v[48:63], v[68:71], v[180:183], 0
    s_setprio 0
    v_mul_f32 v242, v0, v144
    v_fma_f32 v238, v8, v160, -v238
    v_fmac_f32 v242, v1, v145
    v_fmac_f32 v238, v9, v161
    v_fmac_f32 v242, v2, v146
    v_fmac_f32 v238, v10, v162
    v_fmac_f32 v242, v3, v147
    v_fmac_f32 v238, v11, v163
    v_fmac_f32 v242, v4, v148
    v_fmac_f32 v238, v12, v164
    v_fmac_f32 v242, v5, v149
    v_fmac_f32 v238, v13, v165
    v_fmac_f32 v242, v6, v150
    v_fmac_f32 v238, v14, v166
    v_fmac_f32 v242, v7, v151
    v_fmac_f32 v238, v15, v167
    v_fmac_f32 v236, v16, v112
    v_mul_f32 v244, v24, v160
    v_fmac_f32 v236, v17, v113
    v_fmac_f32 v244, v25, v161
    v_fmac_f32 v236, v18, v114
    v_fmac_f32 v244, v26, v162
    v_fmac_f32 v236, v19, v115
    v_fmac_f32 v244, v27, v163
    v_fmac_f32 v236, v20, v116
    v_fmac_f32 v244, v28, v164
    v_fmac_f32 v236, v21, v117
    v_fmac_f32 v244, v29, v165
    v_fmac_f32 v236, v22, v118
    v_fmac_f32 v244, v30, v166
    v_fmac_f32 v236, v23, v119
    v_fmac_f32 v244, v31, v167
    v_mul_f32 v243, v32, v152
    v_fma_f32 v239, v40, v168, -v239
    v_fmac_f32 v243, v33, v153
    v_fmac_f32 v239, v41, v169
    v_fmac_f32 v243, v34, v154
    v_fmac_f32 v239, v42, v170
    v_fmac_f32 v243, v35, v155
    v_fmac_f32 v239, v43, v171
    v_fmac_f32 v243, v36, v156
    v_fmac_f32 v239, v44, v172
    v_fmac_f32 v243, v37, v157
    v_fmac_f32 v239, v45, v173
    v_fmac_f32 v243, v38, v158
    v_fmac_f32 v239, v46, v174
    v_fmac_f32 v243, v39, v159
    v_fmac_f32 v239, v47, v175
    v_fmac_f32 v237, v48, v120
    v_mul_f32 v245, v56, v168
    v_fmac_f32 v237, v49, v121
    v_fmac_f32 v245, v57, v169
    v_fmac_f32 v237, v50, v122
    v_fmac_f32 v245, v58, v170
    v_fmac_f32 v237, v51, v123
    v_fmac_f32 v245, v59, v171
    v_fmac_f32 v237, v52, v124
    v_fmac_f32 v245, v60, v172
    v_fmac_f32 v237, v53, v125
    v_fmac_f32 v245, v61, v173
    v_fmac_f32 v237, v54, v126
    v_fmac_f32 v245, v62, v174
    v_fmac_f32 v237, v55, v127
    v_fmac_f32 v245, v63, v175
    s_setprio 1
    s_waitcnt vmcnt(4) lgkmcnt(0)
    v_mfma_f32_32x32x16_bf16 v[0:15], v[64:67], v[184:187], 0
    ds_read_b64_tr_b16 v[176:177], v246 offset:0
    ds_read_b64_tr_b16 v[178:179], v246 offset:512
    ds_read_b64_tr_b16 v[180:181], v247 offset:0
    ds_read_b64_tr_b16 v[182:183], v247 offset:512
    s_mov_b32 m0, s71
    v_mfma_f32_32x32x16_bf16 v[16:31], v[68:71], v[184:187], 0
    buffer_load_dwordx4 v228, s[4:7], s47 offen sc1 lds
    buffer_load_dwordx4 v229, s[72:75], s47 offen offset:1024 sc1 lds
    v_permlane32_swap_b32 v242, v234
    v_permlane32_swap_b32 v243, v235
    v_add_f32 v242, v242, v234
    v_mfma_f32_32x32x16_bf16 v[32:47], v[64:67], v[188:191], 0
    v_add_f32 v243, v243, v235
    s_set_gpr_idx_on s31, gpr_idx(DST)
    s_nop 0
    v_cvt_pk_bf16_f32 v194, v242, v243
    s_set_gpr_idx_off
    s_mov_b32 s32, s31
    s_mov_b32 s31, s35
    v_mfma_f32_32x32x16_bf16 v[48:63], v[68:71], v[188:191], 0
    s_setprio 0
    v_mul_f32 v242, v0, v144
    v_fma_f32 v240, v8, v160, -v240
    v_fmac_f32 v242, v1, v145
    v_fmac_f32 v240, v9, v161
    v_fmac_f32 v242, v2, v146
    v_fmac_f32 v240, v10, v162
    v_fmac_f32 v242, v3, v147
    v_fmac_f32 v240, v11, v163
    v_fmac_f32 v242, v4, v148
    v_fmac_f32 v240, v12, v164
    v_fmac_f32 v242, v5, v149
    v_fmac_f32 v240, v13, v165
    v_fmac_f32 v242, v6, v150
    v_fmac_f32 v240, v14, v166
    v_fmac_f32 v242, v7, v151
    v_fmac_f32 v240, v15, v167
    v_add_u32 v249, s26, v249
    v_add_u32 v250, s26, v250
    v_fma_f32 v244, v16, v160, -v244
    v_fmac_f32 v236, v24, v112
    v_fmac_f32 v244, v17, v161
    v_fmac_f32 v236, v25, v113
    v_fmac_f32 v244, v18, v162
    v_fmac_f32 v236, v26, v114
    v_fmac_f32 v244, v19, v163
    v_fmac_f32 v236, v27, v115
    v_fmac_f32 v244, v20, v164
    v_fmac_f32 v236, v28, v116
    v_fmac_f32 v244, v21, v165
    v_fmac_f32 v236, v29, v117
    v_fmac_f32 v244, v22, v166
    v_fmac_f32 v236, v30, v118
    v_fmac_f32 v244, v23, v167
    v_fmac_f32 v236, v31, v119
    ds_read_b64_tr_b16 v[0:1], v249 offset:0
    ds_read_b64_tr_b16 v[2:3], v249 offset:128
    ds_read_b128 v[4:7], v250 offset:0
    ds_read_b128 v[8:11], v250 offset:16
    ds_read_b128 v[12:15], v250 offset:384
    ds_read_b128 v[16:19], v250 offset:400
    v_mul_f32 v243, v32, v152
    v_fma_f32 v241, v40, v168, -v241
    v_fmac_f32 v243, v33, v153
    v_fmac_f32 v241, v41, v169
    v_fmac_f32 v243, v34, v154
    v_fmac_f32 v241, v42, v170
    v_fmac_f32 v243, v35, v155
    v_fmac_f32 v241, v43, v171
    v_fmac_f32 v243, v36, v156
    v_fmac_f32 v241, v44, v172
    v_fmac_f32 v243, v37, v157
    v_fmac_f32 v241, v45, v173
    v_fmac_f32 v243, v38, v158
    v_fmac_f32 v241, v46, v174
    v_fmac_f32 v243, v39, v159
    v_fmac_f32 v241, v47, v175
    ds_read_b64_tr_b16 v[20:21], v249 offset:512
    ds_read_b64_tr_b16 v[22:23], v249 offset:640
    ds_read_b128 v[24:27], v250 offset:64
    ds_read_b128 v[28:31], v250 offset:80
    ds_read_b128 v[32:35], v250 offset:448
    ds_read_b128 v[36:39], v250 offset:464
    v_fma_f32 v245, v48, v168, -v245
    v_fmac_f32 v237, v56, v120
    v_fmac_f32 v245, v49, v169
    v_fmac_f32 v237, v57, v121
    v_fmac_f32 v245, v50, v170
    v_fmac_f32 v237, v58, v122
    v_fmac_f32 v245, v51, v171
    v_fmac_f32 v237, v59, v123
    v_fmac_f32 v245, v52, v172
    v_fmac_f32 v237, v60, v124
    v_fmac_f32 v245, v53, v173
    v_fmac_f32 v237, v61, v125
    v_fmac_f32 v245, v54, v174
    v_fmac_f32 v237, v62, v126
    v_fmac_f32 v245, v55, v175
    v_fmac_f32 v237, v63, v127
    s_cmp_eq_u32 s56, 2
    s_cbranch_scc1 K2_U20
    s_cmp_eq_u32 s56, 3
    s_cbranch_scc1 K2_U30
    s_branch K2_DSP0
K2_U40:
    s_setprio 1
    s_waitcnt lgkmcnt(6)
    v_lshlrev_b32 v40, 16, v0
    v_and_b32 v41, 0xffff0000, v0
    v_lshlrev_b32 v42, 16, v1
    v_and_b32 v43, 0xffff0000, v1
    v_lshlrev_b32 v44, 16, v2
    v_and_b32 v45, 0xffff0000, v2
    v_lshlrev_b32 v46, 16, v3
    v_and_b32 v47, 0xffff0000, v3
    v_mul_f32 v4, v40, v4
    v_mul_f32 v5, v41, v5
    v_mul_f32 v6, v42, v6
    v_mul_f32 v7, v43, v7
    v_mul_f32 v8, v44, v8
    v_mul_f32 v9, v45, v9
    v_mul_f32 v10, v46, v10
    v_mul_f32 v11, v47, v11
    v_cvt_pk_bf16_f32 v64, v4, v5
    v_cvt_pk_bf16_f32 v65, v6, v7
    v_cvt_pk_bf16_f32 v66, v8, v9
    v_cvt_pk_bf16_f32 v67, v10, v11
    v_mul_f32 v12, v40, v12
    v_mul_f32 v13, v41, v13
    v_mul_f32 v14, v42, v14
    v_mul_f32 v15, v43, v15
    v_mul_f32 v16, v44, v16
    v_mul_f32 v17, v45, v17
    v_mul_f32 v18, v46, v18
    v_mul_f32 v19, v47, v19
    v_cvt_pk_bf16_f32 v68, v12, v13
    v_cvt_pk_bf16_f32 v69, v14, v15
    v_cvt_pk_bf16_f32 v70, v16, v17
    v_cvt_pk_bf16_f32 v71, v18, v19
    ds_read_b64_tr_b16 v[0:1], v249 offset:1024
    ds_read_b64_tr_b16 v[2:3], v249 offset:1152
    ds_read_b128 v[4:7], v250 offset:128
    ds_read_b128 v[8:11], v250 offset:144
    ds_read_b128 v[12:15], v250 offset:512
    ds_read_b128 v[16:19], v250 offset:528
    s_waitcnt lgkmcnt(6)
    v_lshlrev_b32 v48, 16, v20
    v_and_b32 v49, 0xffff0000, v20
    v_lshlrev_b32 v50, 16, v21
    v_and_b32 v51, 0xffff0000, v21
    v_lshlrev_b32 v52, 16, v22
    v_and_b32 v53, 0xffff0000, v22
    v_lshlrev_b32 v54, 16, v23
    v_and_b32 v55, 0xffff0000, v23
    v_mul_f32 v24, v48, v24
    v_mul_f32 v25, v49, v25
    v_mul_f32 v26, v50, v26
    v_mul_f32 v27, v51, v27
    v_mul_f32 v28, v52, v28
    v_mul_f32 v29, v53, v29
    v_mul_f32 v30, v54, v30
    v_mul_f32 v31, v55, v31
    v_cvt_pk_bf16_f32 v72, v24, v25
    v_cvt_pk_bf16_f32 v73, v26, v27
    v_cvt_pk_bf16_f32 v74, v28, v29
    v_cvt_pk_bf16_f32 v75, v30, v31
    v_mul_f32 v32, v48, v32
    v_mul_f32 v33, v49, v33
    v_mul_f32 v34, v50, v34
    v_mul_f32 v35, v51, v35
    v_mul_f32 v36, v52, v36
    v_mul_f32 v37, v53, v37
    v_mul_f32 v38, v54, v38
    v_mul_f32 v39, v55, v39
    v_cvt_pk_bf16_f32 v76, v32, v33
    v_cvt_pk_bf16_f32 v77, v34, v35
    v_cvt_pk_bf16_f32 v78, v36, v37
    v_cvt_pk_bf16_f32 v79, v38, v39
    s_lshr_b32 s65, s30, 27
    s_mov_b32 s66, 161536
    s_cmp_ge_u32 s65, 2
    s_cselect_b32 s66, 158112, s66
    s_mul_i32 s65, s65, 512
    s_add_u32 s65, s65, s66
    s_sub_u32 s65, s65, s29
    v_add_u32 v56, s65, v249
    s_lshr_b32 s65, s30, 27
    s_mov_b32 s66, 161536
    s_cmp_ge_u32 s65, 2
    s_cselect_b32 s66, 159008, s66
    s_mul_i32 s65, s65, 64
    s_add_u32 s65, s65, s66
    s_sub_u32 s65, s65, s29
    v_add_u32 v57, s65, v250
    ds_read_b64_tr_b16 v[20:21], v56 offset:0
    ds_read_b64_tr_b16 v[22:23], v56 offset:128
    ds_read_b128 v[24:27], v57 offset:0
    ds_read_b128 v[28:31], v57 offset:16
    ds_read_b128 v[32:35], v57 offset:384
    ds_read_b128 v[36:39], v57 offset:400
    s_waitcnt lgkmcnt(10)
    v_lshlrev_b32 v40, 16, v0
    v_and_b32 v41, 0xffff0000, v0
    v_lshlrev_b32 v42, 16, v1
    v_and_b32 v43, 0xffff0000, v1
    v_lshlrev_b32 v44, 16, v2
    v_and_b32 v45, 0xffff0000, v2
    v_lshlrev_b32 v46, 16, v3
    v_and_b32 v47, 0xffff0000, v3
    s_waitcnt lgkmcnt(8)
    v_mul_f32 v4, v40, v4
    v_mul_f32 v5, v41, v5
    v_mul_f32 v6, v42, v6
    v_mul_f32 v7, v43, v7
    v_mul_f32 v8, v44, v8
    v_mul_f32 v9, v45, v9
    v_mul_f32 v10, v46, v10
    v_mul_f32 v11, v47, v11
    v_cvt_pk_bf16_f32 v80, v4, v5
    v_cvt_pk_bf16_f32 v81, v6, v7
    v_cvt_pk_bf16_f32 v82, v8, v9
    v_cvt_pk_bf16_f32 v83, v10, v11
    s_waitcnt lgkmcnt(6)
    v_mul_f32 v12, v40, v12
    v_mul_f32 v13, v41, v13
    v_mul_f32 v14, v42, v14
    v_mul_f32 v15, v43, v15
    v_mul_f32 v16, v44, v16
    v_mul_f32 v17, v45, v17
    v_mul_f32 v18, v46, v18
    v_mul_f32 v19, v47, v19
    v_cvt_pk_bf16_f32 v84, v12, v13
    v_cvt_pk_bf16_f32 v85, v14, v15
    v_cvt_pk_bf16_f32 v86, v16, v17
    v_cvt_pk_bf16_f32 v87, v18, v19
    s_waitcnt lgkmcnt(4)
    v_lshlrev_b32 v48, 16, v20
    v_and_b32 v49, 0xffff0000, v20
    v_lshlrev_b32 v50, 16, v21
    v_and_b32 v51, 0xffff0000, v21
    v_lshlrev_b32 v52, 16, v22
    v_and_b32 v53, 0xffff0000, v22
    v_lshlrev_b32 v54, 16, v23
    v_and_b32 v55, 0xffff0000, v23
    s_waitcnt lgkmcnt(2)
    v_mul_f32 v24, v48, v24
    v_mul_f32 v25, v49, v25
    v_mul_f32 v26, v50, v26
    v_mul_f32 v27, v51, v27
    v_mul_f32 v28, v52, v28
    v_mul_f32 v29, v53, v29
    v_mul_f32 v30, v54, v30
    v_mul_f32 v31, v55, v31
    v_cvt_pk_bf16_f32 v88, v24, v25
    v_cvt_pk_bf16_f32 v89, v26, v27
    v_cvt_pk_bf16_f32 v90, v28, v29
    v_cvt_pk_bf16_f32 v91, v30, v31
    s_waitcnt lgkmcnt(0)
    v_mul_f32 v32, v48, v32
    v_mul_f32 v33, v49, v33
    v_mul_f32 v34, v50, v34
    v_mul_f32 v35, v51, v35
    v_mul_f32 v36, v52, v36
    v_mul_f32 v37, v53, v37
    v_mul_f32 v38, v54, v38
    v_mul_f32 v39, v55, v39
    v_cvt_pk_bf16_f32 v92, v32, v33
    v_cvt_pk_bf16_f32 v93, v34, v35
    v_cvt_pk_bf16_f32 v94, v36, v37
    v_cvt_pk_bf16_f32 v95, v38, v39
    s_waitcnt vmcnt(4)
    v_mfma_f32_32x32x16_bf16 v[0:15], v[64:67], v[176:179], 0
    ds_read_b64_tr_b16 v[184:185], v246 offset:2048
    ds_read_b64_tr_b16 v[186:187], v246 offset:2560
    ds_read_b64_tr_b16 v[188:189], v247 offset:2048
    ds_read_b64_tr_b16 v[190:191], v247 offset:2560
    s_mov_b32 m0, s68
    v_mfma_f32_32x32x16_bf16 v[16:31], v[68:71], v[176:179], 0
    buffer_load_dwordx4 v222, s[4:7], s41 offen sc1 lds
    buffer_load_dwordx4 v223, s[72:75], s41 offen offset:1024 sc1 lds
    v_permlane32_swap_b32 v242, v236
    v_permlane32_swap_b32 v243, v237
    s_add_u32 s38, s38, 1
    v_mfma_f32_32x32x16_bf16 v[32:47], v[64:67], v[180:183], 0
    v_permlane32_swap_b32 v244, v238
    v_permlane32_swap_b32 v245, v239
    v_permlane32_swap_b32 v240, v241
    v_add_f32 v242, v242, v236
    v_mfma_f32_32x32x16_bf16 v[48:63], v[68:71], v[180:183], 0
    v_add_f32 v243, v243, v237
    v_add_f32 v244, v244, v238
    v_add_f32 v245, v245, v239
    v_add_f32 v240, -v240, -v241
    v_mov_b32 v254, s52
    v_mov_b32 v255, s38
    s_waitcnt vmcnt(4) lgkmcnt(0)
    v_mfma_f32_32x32x16_bf16 v[0:15], v[72:75], v[184:187], v[0:15]
    ds_read_b64_tr_b16 v[176:177], v246 offset:4096
    ds_read_b64_tr_b16 v[178:179], v246 offset:4608
    ds_read_b64_tr_b16 v[180:181], v247 offset:4096
    ds_read_b64_tr_b16 v[182:183], v247 offset:4608
    s_lshl_b32 s58, s38, 3
    s_add_u32 s58, s58, s20
    s_mov_b32 m0, s69
    v_mfma_f32_32x32x16_bf16 v[16:31], v[76:79], v[184:187], v[16:31]
    buffer_load_dwordx4 v224, s[4:7], s41 offen sc1 lds
    buffer_load_dwordx4 v225, s[72:75], s41 offen offset:1024 sc1 lds
    s_set_gpr_idx_on s32, gpr_idx(DST)
    s_nop 0
    v_cvt_pk_bf16_f32 v195, v242, v243
    v_cvt_pk_bf16_f32 v196, v244, v245
    v_cvt_pk_bf16_f32 v197, v240, v240
    s_set_gpr_idx_off
    s_mov_b64 exec, 1
    ds_write_b32 v254, v255
    s_mov_b64 exec, -1
    s_cmp_lt_u32 s58, s22
    s_cbranch_scc0 K2_dyn_61
K2_back_62:
    v_readlane_b32 s3, v253, s58
    s_lshl_b32 s44, s34, 7
    s_lshl_b32 s60, s58, 5
    s_and_b32 s48, s3, 0x3ffff
    s_bfe_u32 s33, s3, 0x30012
    s_sub_u32 s60, s60, s48
    s_and_b32 s60, s60, 0xff
    s_add_u32 s60, s60, s48
    s_mul_i32 s35, s38, 6
    s_cmp_eq_u32 s34, 0
    s_cselect_b32 s35, s35, s60
    s_mov_b32 s45, s44
    s_add_u32 s47, s44, 256
    s_add_u32 s49, s48, 32
    s_add_u32 s60, s48, 64
    s_cmp_eq_u32 s33, 3
    s_cselect_b32 s46, s44, s47
    s_cselect_b32 s50, s60, s48
    s_cselect_b32 s51, s48, s49
    s_sub_u32 s60, s33, 2
    s_cmp_lt_u32 s60, 2
    s_cbranch_scc0 K2_rare_67
K2_back_68:
    v_mfma_f32_32x32x16_bf16 v[32:47], v[72:75], v[188:191], v[32:47]
    v_add_u32 v233, s48, v230
    ds_read_b32 v232, v233
    ds_read_b32 v233, v233 offset:1024
    v_mfma_f32_32x32x16_bf16 v[48:63], v[76:79], v[188:191], v[48:63]
    s_waitcnt vmcnt(4) lgkmcnt(3)
    v_mfma_f32_32x32x16_bf16 v[0:15], v[80:83], v[176:179], v[0:15]
    ds_read_b64_tr_b16 v[184:185], v246 offset:6144
    ds_read_b64_tr_b16 v[186:187], v246 offset:6656
    ds_read_b64_tr_b16 v[188:189], v247 offset:6144
    ds_read_b64_tr_b16 v[190:191], v247 offset:6656
    s_mov_b32 m0, s70
    v_mfma_f32_32x32x16_bf16 v[16:31], v[84:87], v[176:179], v[16:31]
    buffer_load_dwordx4 v226, s[4:7], s41 offen sc1 lds
    buffer_load_dwordx4 v227, s[72:75], s41 offen offset:1024 sc1 lds
    v_mfma_f32_32x32x16_bf16 v[32:47], v[80:83], v[180:183], v[32:47]
    v_mfma_f32_32x32x16_bf16 v[48:63], v[84:87], v[180:183], v[48:63]
    s_waitcnt lgkmcnt(4)
    v_or_b32 v232, v232, v231
    v_or_b32 v233, v233, v231
    s_cmp_lg_u32 s34, 0
    s_cbranch_scc1 K2_dum_70
    s_add_u32 m0, s48, 864
    s_add_u32 s65, s48, 1888
    buffer_load_dwordx4 v232, s[16:19], 0 offen  lds
    s_mov_b32 m0, s65
    s_mov_b32 exec_hi, 0
    buffer_load_dwordx4 v233, s[16:19], 0 offen  lds
    s_cmp_eq_u32 s33, 4
    s_cbranch_scc1 K2_a4_71
K2_b4_73:
    s_mov_b32 exec_hi, -1
K2_back_72:
    s_waitcnt vmcnt(6) lgkmcnt(0)
    v_mfma_f32_32x32x16_bf16 v[0:15], v[88:91], v[184:187], v[0:15]
    ds_read_b64_tr_b16 v[176:177], v246 offset:0
    ds_read_b64_tr_b16 v[178:179], v246 offset:512
    ds_read_b64_tr_b16 v[180:181], v247 offset:0
    ds_read_b64_tr_b16 v[182:183], v247 offset:512
    s_mov_b32 m0, s71
    v_mfma_f32_32x32x16_bf16 v[16:31], v[92:95], v[184:187], v[16:31]
    buffer_load_dwordx4 v228, s[4:7], s41 offen sc1 lds
    buffer_load_dwordx4 v229, s[72:75], s41 offen offset:1024 sc1 lds
    v_mfma_f32_32x32x16_bf16 v[32:47], v[88:91], v[188:191], v[32:47]
    s_nop 2
    v_mul_f32 v234, v0, v96
    v_mul_f32 v236, v8, v128
    v_fmac_f32 v234, v1, v97
    v_fmac_f32 v236, v9, v129
    v_fmac_f32 v234, v2, v98
    v_fmac_f32 v236, v10, v130
    v_fmac_f32 v234, v3, v99
    v_mfma_f32_32x32x16_bf16 v[48:63], v[92:95], v[188:191], v[48:63]
    s_setprio 0
    v_fmac_f32 v236, v11, v131
    v_fmac_f32 v234, v4, v100
    v_fmac_f32 v236, v12, v132
    v_fmac_f32 v234, v5, v101
    v_fmac_f32 v236, v13, v133
    v_fmac_f32 v234, v6, v102
    v_fmac_f32 v236, v14, v134
    v_fmac_f32 v234, v7, v103
    v_fmac_f32 v236, v15, v135
    v_mul_f32 v238, v16, v128
    v_mul_f32 v240, v24, v128
    v_fmac_f32 v238, v17, v129
    v_fmac_f32 v240, v25, v129
    v_fmac_f32 v238, v18, v130
    v_fmac_f32 v240, v26, v130
    v_fmac_f32 v238, v19, v131
    v_fmac_f32 v240, v27, v131
    v_fmac_f32 v238, v20, v132
    v_fmac_f32 v240, v28, v132
    v_fmac_f32 v238, v21, v133
    v_fmac_f32 v240, v29, v133
    v_fmac_f32 v238, v22, v134
    v_fmac_f32 v240, v30, v134
    v_fmac_f32 v238, v23, v135
    v_fmac_f32 v240, v31, v135
    v_mul_f32 v235, v32, v104
    v_mul_f32 v237, v40, v136
    v_fmac_f32 v235, v33, v105
    v_fmac_f32 v237, v41, v137
    v_fmac_f32 v235, v34, v106
    v_fmac_f32 v237, v42, v138
    v_fmac_f32 v235, v35, v107
    v_fmac_f32 v237, v43, v139
    v_fmac_f32 v235, v36, v108
    v_fmac_f32 v237, v44, v140
    v_fmac_f32 v235, v37, v109
    v_fmac_f32 v237, v45, v141
    v_fmac_f32 v235, v38, v110
    v_fmac_f32 v237, v46, v142
    v_fmac_f32 v235, v39, v111
    v_fmac_f32 v237, v47, v143
    v_mul_f32 v239, v48, v136
    v_mul_f32 v241, v56, v136
    s_setprio 1
    s_waitcnt vmcnt(6) lgkmcnt(0)
    v_mfma_f32_32x32x16_bf16 v[0:15], v[64:67], v[176:179], 0
    ds_read_b64_tr_b16 v[184:185], v246 offset:2048
    ds_read_b64_tr_b16 v[186:187], v246 offset:2560
    ds_read_b64_tr_b16 v[188:189], v247 offset:2048
    ds_read_b64_tr_b16 v[190:191], v247 offset:2560
    v_fmac_f32 v239, v49, v137
    v_fmac_f32 v241, v57, v137
    s_mov_b32 m0, s68
    v_mfma_f32_32x32x16_bf16 v[16:31], v[68:71], v[176:179], 0
    buffer_load_dwordx4 v222, s[4:7], s42 offen sc1 lds
    buffer_load_dwordx4 v223, s[72:75], s42 offen offset:1024 sc1 lds
    v_fmac_f32 v239, v50, v138
    v_fmac_f32 v241, v58, v138
    v_fmac_f32 v239, v51, v139
    v_fmac_f32 v241, v59, v139
    v_fmac_f32 v239, v52, v140
    v_mfma_f32_32x32x16_bf16 v[32:47], v[64:67], v[180:183], 0
    v_fmac_f32 v241, v60, v140
    v_fmac_f32 v239, v53, v141
    v_fmac_f32 v241, v61, v141
    v_fmac_f32 v239, v54, v142
    v_fmac_f32 v241, v62, v142
    v_fmac_f32 v239, v55, v143
    v_fmac_f32 v241, v63, v143
    v_mfma_f32_32x32x16_bf16 v[48:63], v[68:71], v[180:183], 0
    v_permlane32_swap_b32 v234, v236
    v_permlane32_swap_b32 v235, v237
    v_permlane32_swap_b32 v240, v238
    s_waitcnt vmcnt(6) lgkmcnt(0)
    v_mfma_f32_32x32x16_bf16 v[0:15], v[72:75], v[184:187], v[0:15]
    ds_read_b64_tr_b16 v[176:177], v246 offset:4096
    ds_read_b64_tr_b16 v[178:179], v246 offset:4608
    ds_read_b64_tr_b16 v[180:181], v247 offset:4096
    ds_read_b64_tr_b16 v[182:183], v247 offset:4608
    v_permlane32_swap_b32 v241, v239
    s_mov_b32 m0, s69
    v_mfma_f32_32x32x16_bf16 v[16:31], v[76:79], v[184:187], v[16:31]
    buffer_load_dwordx4 v224, s[4:7], s42 offen sc1 lds
    buffer_load_dwordx4 v225, s[72:75], s42 offen offset:1024 sc1 lds
    v_add_f32 v234, v234, v236
    v_add_f32 v235, v235, v237
    v_add_f32 v240, v240, v238
    v_add_f32 v241, v241, v239
    v_mfma_f32_32x32x16_bf16 v[32:47], v[72:75], v[188:191], v[32:47]
    s_set_gpr_idx_on s31, gpr_idx(DST)
    s_nop 0
    v_cvt_pk_bf16_f32 v192, v234, v235
    v_cvt_pk_bf16_f32 v193, v240, v241
    s_set_gpr_idx_off
    v_mfma_f32_32x32x16_bf16 v[48:63], v[76:79], v[188:191], v[48:63]
    s_waitcnt vmcnt(4) lgkmcnt(0)
    v_mfma_f32_32x32x16_bf16 v[0:15], v[80:83], v[176:179], v[0:15]
    ds_read_b64_tr_b16 v[184:185], v246 offset:6144
    ds_read_b64_tr_b16 v[186:187], v246 offset:6656
    ds_read_b64_tr_b16 v[188:189], v247 offset:6144
    ds_read_b64_tr_b16 v[190:191], v247 offset:6656
    s_mov_b32 m0, s70
    v_mfma_f32_32x32x16_bf16 v[16:31], v[84:87], v[176:179], v[16:31]
    buffer_load_dwordx4 v226, s[4:7], s42 offen sc1 lds
    buffer_load_dwordx4 v227, s[72:75], s42 offen offset:1024 sc1 lds
    v_mfma_f32_32x32x16_bf16 v[32:47], v[80:83], v[180:183], v[32:47]
    v_mfma_f32_32x32x16_bf16 v[48:63], v[84:87], v[180:183], v[48:63]
    s_waitcnt vmcnt(4) lgkmcnt(0)
    v_mfma_f32_32x32x16_bf16 v[0:15], v[88:91], v[184:187], v[0:15]
    ds_read_b64_tr_b16 v[176:177], v246 offset:0
    ds_read_b64_tr_b16 v[178:179], v246 offset:512
    ds_read_b64_tr_b16 v[180:181], v247 offset:0
    ds_read_b64_tr_b16 v[182:183], v247 offset:512
    s_mov_b32 m0, s71
    v_mfma_f32_32x32x16_bf16 v[16:31], v[92:95], v[184:187], v[16:31]
    buffer_load_dwordx4 v228, s[4:7], s42 offen sc1 lds
    buffer_load_dwordx4 v229, s[72:75], s42 offen offset:1024 sc1 lds
    v_mfma_f32_32x32x16_bf16 v[32:47], v[88:91], v[188:191], v[32:47]
    s_nop 2
    v_mul_f32 v234, v0, v144
    v_mul_f32 v236, v8, v112
    v_fmac_f32 v234, v1, v145
    v_fmac_f32 v236, v9, v113
    v_fmac_f32 v234, v2, v146
    v_fmac_f32 v236, v10, v114
    v_fmac_f32 v234, v3, v147
    v_mfma_f32_32x32x16_bf16 v[48:63], v[92:95], v[188:191], v[48:63]
    s_setprio 0
    v_fmac_f32 v236, v11, v115
    v_fmac_f32 v234, v4, v148
    v_fmac_f32 v236, v12, v116
    v_fmac_f32 v234, v5, v149
    v_fmac_f32 v236, v13, v117
    v_fmac_f32 v234, v6, v150
    v_fmac_f32 v236, v14, v118
    v_fmac_f32 v234, v7, v151
    v_fmac_f32 v236, v15, v119
    v_mul_f32 v238, v16, v160
    v_mul_f32 v240, v24, v160
    v_fmac_f32 v238, v17, v161
    v_fmac_f32 v240, v25, v161
    v_fmac_f32 v238, v18, v162
    v_fmac_f32 v240, v26, v162
    v_fmac_f32 v238, v19, v163
    v_fmac_f32 v240, v27, v163
    v_fmac_f32 v238, v20, v164
    v_fmac_f32 v240, v28, v164
    v_fmac_f32 v238, v21, v165
    v_fmac_f32 v240, v29, v165
    v_fmac_f32 v238, v22, v166
    v_fmac_f32 v240, v30, v166
    v_fmac_f32 v238, v23, v167
    v_fmac_f32 v240, v31, v167
    v_mul_f32 v235, v32, v152
    v_mul_f32 v237, v40, v120
    v_fmac_f32 v235, v33, v153
    v_fmac_f32 v237, v41, v121
    v_fmac_f32 v235, v34, v154
    v_fmac_f32 v237, v42, v122
    v_fmac_f32 v235, v35, v155
    v_fmac_f32 v237, v43, v123
    v_fmac_f32 v235, v36, v156
    v_fmac_f32 v237, v44, v124
    v_fmac_f32 v235, v37, v157
    v_fmac_f32 v237, v45, v125
    v_fmac_f32 v235, v38, v158
    v_fmac_f32 v237, v46, v126
    v_fmac_f32 v235, v39, v159
    v_fmac_f32 v237, v47, v127
    v_mul_f32 v239, v48, v168
    v_mul_f32 v241, v56, v168
    s_setprio 1
    s_waitcnt vmcnt(4) lgkmcnt(0)
    v_mfma_f32_32x32x16_bf16 v[0:15], v[64:67], v[176:179], 0
    ds_read_b64_tr_b16 v[184:185], v246 offset:2048
    ds_read_b64_tr_b16 v[186:187], v246 offset:2560
    ds_read_b64_tr_b16 v[188:189], v247 offset:2048
    ds_read_b64_tr_b16 v[190:191], v247 offset:2560
    v_fmac_f32 v239, v49, v169
    v_fmac_f32 v241, v57, v169
    s_mov_b32 m0, s68
    v_mfma_f32_32x32x16_bf16 v[16:31], v[68:71], v[176:179], 0
    buffer_load_dwordx4 v222, s[4:7], s43 offen sc1 lds
    buffer_load_dwordx4 v223, s[72:75], s43 offen offset:1024 sc1 lds
    v_fmac_f32 v239, v50, v170
    v_fmac_f32 v241, v58, v170
    v_fmac_f32 v239, v51, v171
    v_fmac_f32 v241, v59, v171
    v_fmac_f32 v239, v52, v172
    v_mfma_f32_32x32x16_bf16 v[32:47], v[64:67], v[180:183], 0
    v_fmac_f32 v241, v60, v172
    v_fmac_f32 v239, v53, v173
    v_fmac_f32 v241, v61, v173
    v_fmac_f32 v239, v54, v174
    v_fmac_f32 v241, v62, v174
    v_fmac_f32 v239, v55, v175
    v_fmac_f32 v241, v63, v175
    v_mfma_f32_32x32x16_bf16 v[48:63], v[68:71], v[180:183], 0
    s_waitcnt vmcnt(4) lgkmcnt(0)
    v_mfma_f32_32x32x16_bf16 v[0:15], v[72:75], v[184:187], v[0:15]
    ds_read_b64_tr_b16 v[176:177], v246 offset:4096
    ds_read_b64_tr_b16 v[178:179], v246 offset:4608
    ds_read_b64_tr_b16 v[180:181], v247 offset:4096
    ds_read_b64_tr_b16 v[182:183], v247 offset:4608
    s_mov_b32 m0, s69
    v_mfma_f32_32x32x16_bf16 v[16:31], v[76:79], v[184:187], v[16:31]
    buffer_load_dwordx4 v224, s[4:7], s43 offen sc1 lds
    buffer_load_dwordx4 v225, s[72:75], s43 offen offset:1024 sc1 lds
    v_mfma_f32_32x32x16_bf16 v[32:47], v[72:75], v[188:191], v[32:47]
    v_mfma_f32_32x32x16_bf16 v[48:63], v[76:79], v[188:191], v[48:63]
    s_waitcnt vmcnt(4) lgkmcnt(0)
    v_mfma_f32_32x32x16_bf16 v[0:15], v[80:83], v[176:179], v[0:15]
    ds_read_b64_tr_b16 v[184:185], v246 offset:6144
    ds_read_b64_tr_b16 v[186:187], v246 offset:6656
    ds_read_b64_tr_b16 v[188:189], v247 offset:6144
    ds_read_b64_tr_b16 v[190:191], v247 offset:6656
    s_mov_b32 m0, s70
    v_mfma_f32_32x32x16_bf16 v[16:31], v[84:87], v[176:179], v[16:31]
    buffer_load_dwordx4 v226, s[4:7], s43 offen sc1 lds
    buffer_load_dwordx4 v227, s[72:75], s43 offen offset:1024 sc1 lds
    v_mfma_f32_32x32x16_bf16 v[32:47], v[80:83], v[180:183], v[32:47]
    v_add_u32 v222, s48, v251
    ds_read_b32 v222, v222
    v_mfma_f32_32x32x16_bf16 v[48:63], v[84:87], v[180:183], v[48:63]
    s_waitcnt vmcnt(4) lgkmcnt(1)
    v_mfma_f32_32x32x16_bf16 v[0:15], v[88:91], v[184:187], v[0:15]
    ds_read_b64_tr_b16 v[176:177], v246 offset:0
    ds_read_b64_tr_b16 v[178:179], v246 offset:512
    ds_read_b64_tr_b16 v[180:181], v247 offset:0
    ds_read_b64_tr_b16 v[182:183], v247 offset:512
    s_mov_b32 m0, s71
    v_mfma_f32_32x32x16_bf16 v[16:31], v[92:95], v[184:187], v[16:31]
    buffer_load_dwordx4 v228, s[4:7], s43 offen sc1 lds
    buffer_load_dwordx4 v229, s[72:75], s43 offen offset:1024 sc1 lds
    s_waitcnt lgkmcnt(4)
    v_mad_u32_u16 v223, v222, s39, v248 op_sel:[1,0,0,0]
    v_mad_u32_u16 v222, v222, s39, v248
    v_mfma_f32_32x32x16_bf16 v[32:47], v[88:91], v[188:191], v[32:47]
    v_add_u32 v224, s49, v251
    ds_read_b32 v224, v224
    v_mul_f32 v242, v0, v144
    v_fma_f32 v238, v8, v160, -v238
    v_fmac_f32 v242, v1, v145
    v_fmac_f32 v238, v9, v161
    v_fmac_f32 v242, v2, v146
    v_mfma_f32_32x32x16_bf16 v[48:63], v[92:95], v[188:191], v[48:63]
    s_setprio 0
    v_fmac_f32 v238, v10, v162
    v_fmac_f32 v242, v3, v147
    v_fmac_f32 v238, v11, v163
    v_fmac_f32 v242, v4, v148
    v_fmac_f32 v238, v12, v164
    v_fmac_f32 v242, v5, v149
    v_fmac_f32 v238, v13, v165
    v_fmac_f32 v242, v6, v150
    v_fmac_f32 v238, v14, v166
    v_fmac_f32 v242, v7, v151
    v_fmac_f32 v238, v15, v167
    v_fmac_f32 v236, v16, v112
    v_mul_f32 v244, v24, v160
    v_fmac_f32 v236, v17, v113
    v_fmac_f32 v244, v25, v161
    v_fmac_f32 v236, v18, v114
    v_fmac_f32 v244, v26, v162
    v_fmac_f32 v236, v19, v115
    v_fmac_f32 v244, v27, v163
    v_fmac_f32 v236, v20, v116
    v_fmac_f32 v244, v28, v164
    v_fmac_f32 v236, v21, v117
    v_fmac_f32 v244, v29, v165
    v_fmac_f32 v236, v22, v118
    v_fmac_f32 v244, v30, v166
    v_fmac_f32 v236, v23, v119
    v_fmac_f32 v244, v31, v167
    v_mul_f32 v243, v32, v152
    v_fma_f32 v239, v40, v168, -v239
    v_fmac_f32 v243, v33, v153
    v_fmac_f32 v239, v41, v169
    v_fmac_f32 v243, v34, v154
    v_fmac_f32 v239, v42, v170
    v_fmac_f32 v243, v35, v155
    v_fmac_f32 v239, v43, v171
    v_fmac_f32 v243, v36, v156
    v_fmac_f32 v239, v44, v172
    v_fmac_f32 v243, v37, v157
    v_fmac_f32 v239, v45, v173
    v_fmac_f32 v243, v38, v158
    v_fmac_f32 v239, v46, v174
    v_fmac_f32 v243, v39, v159
    v_fmac_f32 v239, v47, v175
    v_fmac_f32 v237, v48, v120
    v_mul_f32 v245, v56, v168
    v_fmac_f32 v237, v49, v121
    v_fmac_f32 v245, v57, v169
    v_fmac_f32 v237, v50, v122
    v_fmac_f32 v245, v58, v170
    v_fmac_f32 v237, v51, v123
    s_setprio 1
    s_waitcnt vmcnt(4) lgkmcnt(1)
    v_mfma_f32_32x32x16_bf16 v[0:15], v[64:67], v[176:179], 0
    ds_read_b64_tr_b16 v[184:185], v246 offset:2048
    ds_read_b64_tr_b16 v[186:187], v246 offset:2560
    ds_read_b64_tr_b16 v[188:189], v247 offset:2048
    ds_read_b64_tr_b16 v[190:191], v247 offset:2560
    v_fmac_f32 v245, v59, v171
    v_fmac_f32 v237, v52, v124
    s_mov_b32 m0, s68
    v_mfma_f32_32x32x16_bf16 v[16:31], v[68:71], v[176:179], 0
    buffer_load_dwordx4 v222, s[4:7], s44 offen sc1 lds
    buffer_load_dwordx4 v223, s[72:75], s44 offen offset:1024 sc1 lds
    s_waitcnt lgkmcnt(4)
    v_mad_u32_u16 v225, v224, s39, v248 op_sel:[1,0,0,0]
    v_mad_u32_u16 v224, v224, s39, v248
    v_fmac_f32 v245, v60, v172
    v_fmac_f32 v237, v53, v125
    v_mfma_f32_32x32x16_bf16 v[32:47], v[64:67], v[180:183], 0
    v_add_u32 v226, s50, v251
    ds_read_b32 v226, v226
    v_fmac_f32 v245, v61, v173
    v_fmac_f32 v237, v54, v126
    v_fmac_f32 v245, v62, v174
    v_fmac_f32 v237, v55, v127
    v_fmac_f32 v245, v63, v175
    v_mfma_f32_32x32x16_bf16 v[48:63], v[68:71], v[180:183], 0
    v_permlane32_swap_b32 v242, v234
    v_permlane32_swap_b32 v243, v235
    v_add_f32 v242, v242, v234
    v_add_f32 v243, v243, v235
    s_waitcnt vmcnt(4) lgkmcnt(1)
    v_mfma_f32_32x32x16_bf16 v[0:15], v[72:75], v[184:187], v[0:15]
    ds_read_b64_tr_b16 v[176:177], v246 offset:4096
    ds_read_b64_tr_b16 v[178:179], v246 offset:4608
    ds_read_b64_tr_b16 v[180:181], v247 offset:4096
    ds_read_b64_tr_b16 v[182:183], v247 offset:4608
    s_mov_b32 m0, s69
    v_mfma_f32_32x32x16_bf16 v[16:31], v[76:79], v[184:187], v[16:31]
    buffer_load_dwordx4 v224, s[4:7], s45 offen sc1 lds
    buffer_load_dwordx4 v225, s[72:75], s45 offen offset:1024 sc1 lds
    s_waitcnt lgkmcnt(4)
    v_mad_u32_u16 v227, v226, s39, v248 op_sel:[1,0,0,0]
    v_mad_u32_u16 v226, v226, s39, v248
    v_mfma_f32_32x32x16_bf16 v[32:47], v[72:75], v[188:191], v[32:47]
    v_add_u32 v228, s51, v251
    ds_read_b32 v228, v228
    s_set_gpr_idx_on s31, gpr_idx(DST)
    s_nop 0
    v_cvt_pk_bf16_f32 v194, v242, v243
    s_set_gpr_idx_off
    v_mfma_f32_32x32x16_bf16 v[48:63], v[76:79], v[188:191], v[48:63]
    s_waitcnt vmcnt(4) lgkmcnt(1)
    v_mfma_f32_32x32x16_bf16 v[0:15], v[80:83], v[176:179], v[0:15]
    ds_read_b64_tr_b16 v[184:185], v246 offset:6144
    ds_read_b64_tr_b16 v[186:187], v246 offset:6656
    ds_read_b64_tr_b16 v[188:189], v247 offset:6144
    ds_read_b64_tr_b16 v[190:191], v247 offset:6656
    s_mov_b32 s32, s31
    s_mov_b32 s31, s35
    s_mov_b32 m0, s70
    v_mfma_f32_32x32x16_bf16 v[16:31], v[84:87], v[176:179], v[16:31]
    buffer_load_dwordx4 v226, s[4:7], s46 offen sc1 lds
    buffer_load_dwordx4 v227, s[72:75], s46 offen offset:1024 sc1 lds
    s_waitcnt lgkmcnt(4)
    v_mad_u32_u16 v229, v228, s39, v248 op_sel:[1,0,0,0]
    v_mad_u32_u16 v228, v228, s39, v248
    s_sub_u32 s26, s48, s29
    s_mov_b32 s29, s48
    v_mfma_f32_32x32x16_bf16 v[32:47], v[80:83], v[180:183], v[32:47]
    s_mov_b32 s30, s3
    s_cmp_eq_u32 s34, 0
    s_cselect_b32 s56, s33, 0
    v_mfma_f32_32x32x16_bf16 v[48:63], v[84:87], v[180:183], v[48:63]
    s_waitcnt vmcnt(4) lgkmcnt(0)
    v_mfma_f32_32x32x16_bf16 v[0:15], v[88:91], v[184:187], v[0:15]
    ds_read_b64_tr_b16 v[176:177], v246 offset:0
    ds_read_b64_tr_b16 v[178:179], v246 offset:512
    ds_read_b64_tr_b16 v[180:181], v247 offset:0
    ds_read_b64_tr_b16 v[182:183], v247 offset:512
    s_mov_b32 m0, s71
    v_mfma_f32_32x32x16_bf16 v[16:31], v[92:95], v[184:187], v[16:31]
    buffer_load_dwordx4 v228, s[4:7], s47 offen sc1 lds
    buffer_load_dwordx4 v229, s[72:75], s47 offen offset:1024 sc1 lds
    v_mfma_f32_32x32x16_bf16 v[32:47], v[88:91], v[188:191], v[32:47]
    s_nop 2
    v_mul_f32 v242, v0, v144
    v_fma_f32 v240, v8, v160, -v240
    v_fmac_f32 v242, v1, v145
    v_fmac_f32 v240, v9, v161
    v_fmac_f32 v242, v2, v146
    v_fmac_f32 v240, v10, v162
    v_fmac_f32 v242, v3, v147
    v_mfma_f32_32x32x16_bf16 v[48:63], v[92:95], v[188:191], v[48:63]
    s_setprio 0
    v_fmac_f32 v240, v11, v163
    v_fmac_f32 v242, v4, v148
    v_fmac_f32 v240, v12, v164
    v_fmac_f32 v242, v5, v149
    v_fmac_f32 v240, v13, v165
    v_fmac_f32 v242, v6, v150
    v_fmac_f32 v240, v14, v166
    v_fmac_f32 v242, v7, v151
    v_fmac_f32 v240, v15, v167
    v_add_u32 v249, s26, v249
    v_add_u32 v250, s26, v250
    v_fma_f32 v244, v16, v160, -v244
    v_fmac_f32 v236, v24, v112
    v_fmac_f32 v244, v17, v161
    v_fmac_f32 v236, v25, v113
    v_fmac_f32 v244, v18, v162
    v_fmac_f32 v236, v26, v114
    v_fmac_f32 v244, v19, v163
    v_fmac_f32 v236, v27, v115
    v_fmac_f32 v244, v20, v164
    v_fmac_f32 v236, v28, v116
    v_fmac_f32 v244, v21, v165
    v_fmac_f32 v236, v29, v117
    v_fmac_f32 v244, v22, v166
    v_fmac_f32 v236, v30, v118
    v_fmac_f32 v244, v23, v167
    v_fmac_f32 v236, v31, v119
    ds_read_b64_tr_b16 v[0:1], v249 offset:0
    ds_read_b64_tr_b16 v[2:3], v249 offset:128
    ds_read_b128 v[4:7], v250 offset:0
    ds_read_b128 v[8:11], v250 offset:16
    ds_read_b128 v[12:15], v250 offset:384
    ds_read_b128 v[16:19], v250 offset:400
    v_mul_f32 v243, v32, v152
    v_fma_f32 v241, v40, v168, -v241
    v_fmac_f32 v243, v33, v153
    v_fmac_f32 v241, v41, v169
    v_fmac_f32 v243, v34, v154
    v_fmac_f32 v241, v42, v170
    v_fmac_f32 v243, v35, v155
    v_fmac_f32 v241, v43, v171
    v_fmac_f32 v243, v36, v156
    v_fmac_f32 v241, v44, v172
    v_fmac_f32 v243, v37, v157
    v_fmac_f32 v241, v45, v173
    v_fmac_f32 v243, v38, v158
    v_fmac_f32 v241, v46, v174
    v_fmac_f32 v243, v39, v159
    v_fmac_f32 v241, v47, v175
    ds_read_b64_tr_b16 v[20:21], v249 offset:512
    ds_read_b64_tr_b16 v[22:23], v249 offset:640
    ds_read_b128 v[24:27], v250 offset:64
    ds_read_b128 v[28:31], v250 offset:80
    ds_read_b128 v[32:35], v250 offset:448
    ds_read_b128 v[36:39], v250 offset:464
    v_fma_f32 v245, v48, v168, -v245
    v_fmac_f32 v237, v56, v120
    v_fmac_f32 v245, v49, v169
    v_fmac_f32 v237, v57, v121
    v_fmac_f32 v245, v50, v170
    v_fmac_f32 v237, v58, v122
    v_fmac_f32 v245, v51, v171
    v_fmac_f32 v237, v59, v123
    v_fmac_f32 v245, v52, v172
    v_fmac_f32 v237, v60, v124
    v_fmac_f32 v245, v53, v173
    v_fmac_f32 v237, v61, v125
    v_fmac_f32 v245, v54, v174
    v_fmac_f32 v237, v62, v126
    v_fmac_f32 v245, v55, v175
    v_fmac_f32 v237, v63, v127
    s_cmp_eq_u32 s56, 2
    s_cbranch_scc1 K2_U20
    s_cmp_eq_u32 s56, 3
    s_cbranch_scc1 K2_U30
    s_branch K2_DSP0
K2_U11:
    s_setprio 1
    v_mov_b32 v254, 163648
    v_mov_b32 v255, 1
    v_lshl_add_u32 v233, v252, 1, s53
    s_mov_b64 exec, 1
    ds_add_rtn_u32 v232, v254, v255
    s_mov_b64 exec, -1
    ds_read_b32 v233, v233
    s_waitcnt lgkmcnt(8)
    v_lshlrev_b32 v40, 16, v0
    v_and_b32 v41, 0xffff0000, v0
    v_lshlrev_b32 v42, 16, v1
    v_and_b32 v43, 0xffff0000, v1
    v_lshlrev_b32 v44, 16, v2
    v_and_b32 v45, 0xffff0000, v2
    v_lshlrev_b32 v46, 16, v3
    v_and_b32 v47, 0xffff0000, v3
    v_mul_f32 v4, v40, v4
    v_mul_f32 v5, v41, v5
    v_mul_f32 v6, v42, v6
    v_mul_f32 v7, v43, v7
    v_mul_f32 v8, v44, v8
    v_mul_f32 v9, v45, v9
    v_mul_f32 v10, v46, v10
    v_mul_f32 v11, v47, v11
    v_cvt_pk_bf16_f32 v64, v4, v5
    v_cvt_pk_bf16_f32 v65, v6, v7
    v_cvt_pk_bf16_f32 v66, v8, v9
    v_cvt_pk_bf16_f32 v67, v10, v11
    v_mul_f32 v12, v40, v12
    v_mul_f32 v13, v41, v13
    v_mul_f32 v14, v42, v14
    v_mul_f32 v15, v43, v15
    v_mul_f32 v16, v44, v16
    v_mul_f32 v17, v45, v17
    v_mul_f32 v18, v46, v18
    v_mul_f32 v19, v47, v19
    v_cvt_pk_bf16_f32 v68, v12, v13
    v_cvt_pk_bf16_f32 v69, v14, v15
    v_cvt_pk_bf16_f32 v70, v16, v17
    v_cvt_pk_bf16_f32 v71, v18, v19
    s_waitcnt lgkmcnt(0)
    v_readfirstlane_b32 s58, v232
    s_nop 0
    s_cmp_lt_u32 s58, s22
    s_cbranch_scc0 K2_nul_74
    s_and_b32 s59, s58, 7
    s_lshr_b32 s60, s58, 3
K2_chk_76:
    v_readlane_b32 s61, v233, s59
    s_nop 0
    s_cmp_gt_u32 s61, s60
    s_cbranch_scc0 K2_spin_75
K2_back_77:
    v_readlane_b32 s3, v253, s58
    s_lshl_b32 s44, s34, 7
    s_lshl_b32 s60, s58, 5
    s_and_b32 s48, s3, 0x3ffff
    s_bfe_u32 s33, s3, 0x30012
    s_sub_u32 s60, s60, s48
    s_and_b32 s60, s60, 0xff
    s_add_u32 s35, s60, s48
    s_mov_b32 s45, s44
    s_add_u32 s47, s44, 256
    s_add_u32 s49, s48, 32
    s_add_u32 s60, s48, 64
    s_cmp_eq_u32 s33, 3
    s_cselect_b32 s46, s44, s47
    s_cselect_b32 s50, s60, s48
    s_cselect_b32 s51, s48, s49
    s_sub_u32 s60, s33, 2
    s_cmp_lt_u32 s60, 2
    s_cbranch_scc0 K2_rare_78
K2_back_79:
    v_add_u32 v222, s48, v251
    ds_read_b32 v222, v222
    v_add_u32 v224, s49, v251
    ds_read_b32 v224, v224
    v_add_u32 v226, s50, v251
    ds_read_b32 v226, v226
    v_add_u32 v228, s51, v251
    ds_read_b32 v228, v228
    s_waitcnt lgkmcnt(3)
    v_mad_u32_u16 v223, v222, s39, v248 op_sel:[1,0,0,0]
    v_mad_u32_u16 v222, v222, s39, v248
    s_waitcnt lgkmcnt(2)
    v_mad_u32_u16 v225, v224, s39, v248 op_sel:[1,0,0,0]
    v_mad_u32_u16 v224, v224, s39, v248
    s_waitcnt lgkmcnt(1)
    v_mad_u32_u16 v227, v226, s39, v248 op_sel:[1,0,0,0]
    v_mad_u32_u16 v226, v226, s39, v248
    s_waitcnt lgkmcnt(0)
    v_mad_u32_u16 v229, v228, s39, v248 op_sel:[1,0,0,0]
    v_mad_u32_u16 v228, v228, s39, v248
    s_waitcnt vmcnt(4)
    v_mfma_f32_32x32x16_bf16 v[0:15], v[64:67], v[176:179], 0
    ds_read_b64_tr_b16 v[184:185], v246 offset:2048
    ds_read_b64_tr_b16 v[186:187], v246 offset:2560
    ds_read_b64_tr_b16 v[188:189], v247 offset:2048
    ds_read_b64_tr_b16 v[190:191], v247 offset:2560
    s_mov_b32 m0, s68
    v_mfma_f32_32x32x16_bf16 v[16:31], v[68:71], v[176:179], 0
    buffer_load_dwordx4 v222, s[4:7], s44 offen sc1 lds
    buffer_load_dwordx4 v223, s[72:75], s44 offen offset:1024 sc1 lds
    v_permlane32_swap_b32 v242, v236
    v_permlane32_swap_b32 v243, v237
    v_mfma_f32_32x32x16_bf16 v[32:47], v[64:67], v[180:183], 0
    v_permlane32_swap_b32 v244, v238
    v_permlane32_swap_b32 v245, v239
    v_permlane32_swap_b32 v240, v241
    v_add_f32 v242, v242, v236
    v_mfma_f32_32x32x16_bf16 v[48:63], v[68:71], v[180:183], 0
    s_setprio 0
    v_add_f32 v243, v243, v237
    v_add_f32 v244, v244, v238
    v_add_f32 v245, v245, v239
    v_add_f32 v240, -v240, -v241
    v_sub_u32 v241, v230, v231
    v_cvt_pk_bf16_f32 v242, v242, v243
    v_cvt_pk_bf16_f32 v244, v244, v245
    v_cvt_pk_bf16_f32 v240, v240, v240
    ds_write_b32 v230, v242 offset:768
    ds_write_b32 v230, v244 offset:1024
    ds_write_b16 v241, v240 offset:1280
    v_mul_f32 v234, v0, v96
    v_mul_f32 v236, v8, v128
    v_fmac_f32 v234, v1, v97
    v_fmac_f32 v236, v9, v129
    v_fmac_f32 v234, v2, v98
    v_fmac_f32 v236, v10, v130
    v_fmac_f32 v234, v3, v99
    v_fmac_f32 v236, v11, v131
    v_fmac_f32 v234, v4, v100
    v_fmac_f32 v236, v12, v132
    v_fmac_f32 v234, v5, v101
    v_fmac_f32 v236, v13, v133
    v_fmac_f32 v234, v6, v102
    v_fmac_f32 v236, v14, v134
    v_fmac_f32 v234, v7, v103
    v_fmac_f32 v236, v15, v135
    v_mul_f32 v238, v16, v128
    v_mul_f32 v240, v24, v128
    v_fmac_f32 v238, v17, v129
    v_fmac_f32 v240, v25, v129
    v_fmac_f32 v238, v18, v130
    v_fmac_f32 v240, v26, v130
    v_fmac_f32 v238, v19, v131
    v_fmac_f32 v240, v27, v131
    v_fmac_f32 v238, v20, v132
    v_fmac_f32 v240, v28, v132
    v_fmac_f32 v238, v21, v133
    v_fmac_f32 v240, v29, v133
    v_fmac_f32 v238, v22, v134
    v_fmac_f32 v240, v30, v134
    v_fmac_f32 v238, v23, v135
    v_fmac_f32 v240, v31, v135
    v_mul_f32 v235, v32, v104
    v_mul_f32 v237, v40, v136
    v_fmac_f32 v235, v33, v105
    v_fmac_f32 v237, v41, v137
    v_fmac_f32 v235, v34, v106
    v_fmac_f32 v237, v42, v138
    v_fmac_f32 v235, v35, v107
    v_fmac_f32 v237, v43, v139
    v_fmac_f32 v235, v36, v108
    v_fmac_f32 v237, v44, v140
    v_fmac_f32 v235, v37, v109
    v_fmac_f32 v237, v45, v141
    v_fmac_f32 v235, v38, v110
    v_fmac_f32 v237, v46, v142
    v_fmac_f32 v235, v39, v111
    v_fmac_f32 v237, v47, v143
    v_mul_f32 v239, v48, v136
    v_mul_f32 v241, v56, v136
    v_fmac_f32 v239, v49, v137
    v_fmac_f32 v241, v57, v137
    v_fmac_f32 v239, v50, v138
    v_fmac_f32 v241, v58, v138
    v_fmac_f32 v239, v51, v139
    v_fmac_f32 v241, v59, v139
    v_fmac_f32 v239, v52, v140
    v_fmac_f32 v241, v60, v140
    v_fmac_f32 v239, v53, v141
    v_fmac_f32 v241, v61, v141
    v_fmac_f32 v239, v54, v142
    v_fmac_f32 v241, v62, v142
    v_fmac_f32 v239, v55, v143
    v_fmac_f32 v241, v63, v143
    s_setprio 1
    s_waitcnt vmcnt(4) lgkmcnt(3)
    v_mfma_f32_32x32x16_bf16 v[0:15], v[64:67], v[184:187], 0
    ds_read_b64_tr_b16 v[176:177], v246 offset:4096
    ds_read_b64_tr_b16 v[178:179], v246 offset:4608
    ds_read_b64_tr_b16 v[180:181], v247 offset:4096
    ds_read_b64_tr_b16 v[182:183], v247 offset:4608
    s_mov_b32 m0, s69
    v_mfma_f32_32x32x16_bf16 v[16:31], v[68:71], v[184:187], 0
    buffer_load_dwordx4 v224, s[4:7], s45 offen sc1 lds
    buffer_load_dwordx4 v225, s[72:75], s45 offen offset:1024 sc1 lds
    v_permlane32_swap_b32 v234, v236
    v_permlane32_swap_b32 v235, v237
    v_mfma_f32_32x32x16_bf16 v[32:47], v[64:67], v[188:191], 0
    v_permlane32_swap_b32 v240, v238
    v_permlane32_swap_b32 v241, v239
    v_lshl_add_u32 v230, v252, 1, s31
    v_add_f32 v234, v234, v236
    v_add_f32 v235, v235, v237
    v_mfma_f32_32x32x16_bf16 v[48:63], v[68:71], v[188:191], 0
    s_setprio 0
    v_add_f32 v240, v240, v238
    v_add_f32 v241, v241, v239
    v_cvt_pk_bf16_f32 v234, v234, v235
    v_cvt_pk_bf16_f32 v240, v240, v241
    ds_write_b32 v230, v234 offset:0
    ds_write_b32 v230, v240 offset:256
    v_mul_f32 v234, v0, v144
    v_mul_f32 v236, v8, v112
    v_fmac_f32 v234, v1, v145
    v_fmac_f32 v236, v9, v113
    v_fmac_f32 v234, v2, v146
    v_fmac_f32 v236, v10, v114
    v_fmac_f32 v234, v3, v147
    v_fmac_f32 v236, v11, v115
    v_fmac_f32 v234, v4, v148
    v_fmac_f32 v236, v12, v116
    v_fmac_f32 v234, v5, v149
    v_fmac_f32 v236, v13, v117
    v_fmac_f32 v234, v6, v150
    v_fmac_f32 v236, v14, v118
    v_fmac_f32 v234, v7, v151
    v_fmac_f32 v236, v15, v119
    v_mul_f32 v238, v16, v160
    v_mul_f32 v240, v24, v160
    v_fmac_f32 v238, v17, v161
    v_fmac_f32 v240, v25, v161
    v_fmac_f32 v238, v18, v162
    v_fmac_f32 v240, v26, v162
    v_fmac_f32 v238, v19, v163
    v_fmac_f32 v240, v27, v163
    v_fmac_f32 v238, v20, v164
    v_fmac_f32 v240, v28, v164
    v_fmac_f32 v238, v21, v165
    v_fmac_f32 v240, v29, v165
    v_fmac_f32 v238, v22, v166
    v_fmac_f32 v240, v30, v166
    v_fmac_f32 v238, v23, v167
    v_fmac_f32 v240, v31, v167
    v_mul_f32 v235, v32, v152
    v_mul_f32 v237, v40, v120
    v_fmac_f32 v235, v33, v153
    v_fmac_f32 v237, v41, v121
    v_fmac_f32 v235, v34, v154
    v_fmac_f32 v237, v42, v122
    v_fmac_f32 v235, v35, v155
    v_fmac_f32 v237, v43, v123
    v_fmac_f32 v235, v36, v156
    v_fmac_f32 v237, v44, v124
    v_fmac_f32 v235, v37, v157
    v_fmac_f32 v237, v45, v125
    v_fmac_f32 v235, v38, v158
    v_fmac_f32 v237, v46, v126
    v_fmac_f32 v235, v39, v159
    v_fmac_f32 v237, v47, v127
    v_mul_f32 v239, v48, v168
    v_mul_f32 v241, v56, v168
    v_fmac_f32 v239, v49, v169
    v_fmac_f32 v241, v57, v169
    v_fmac_f32 v239, v50, v170
    v_fmac_f32 v241, v58, v170
    v_fmac_f32 v239, v51, v171
    v_fmac_f32 v241, v59, v171
    v_fmac_f32 v239, v52, v172
    v_fmac_f32 v241, v60, v172
    v_fmac_f32 v239, v53, v173
    v_fmac_f32 v241, v61, v173
    v_fmac_f32 v239, v54, v174
    v_fmac_f32 v241, v62, v174
    v_fmac_f32 v239, v55, v175
    v_fmac_f32 v241, v63, v175
    s_setprio 1
    s_waitcnt vmcnt(4) lgkmcnt(2)
    v_mfma_f32_32x32x16_bf16 v[0:15], v[64:67], v[176:179], 0
    ds_read_b64_tr_b16 v[184:185], v246 offset:6144
    ds_read_b64_tr_b16 v[186:187], v246 offset:6656
    ds_read_b64_tr_b16 v[188:189], v247 offset:6144
    ds_read_b64_tr_b16 v[190:191], v247 offset:6656
    s_mov_b32 s32, s31
    s_mov_b32 s31, s35
    s_mov_b32 m0, s70
    v_mfma_f32_32x32x16_bf16 v[16:31], v[68:71], v[176:179], 0
    buffer_load_dwordx4 v226, s[4:7], s46 offen sc1 lds
    buffer_load_dwordx4 v227, s[72:75], s46 offen offset:1024 sc1 lds
    s_sub_u32 s26, s48, s29
    s_mov_b32 s29, s48
    s_mov_b32 s30, s3
    s_cmp_lg_u32 s36, 0
    s_cselect_b32 s56, s33, 0
    v_mfma_f32_32x32x16_bf16 v[32:47], v[64:67], v[180:183], 0
    v_mfma_f32_32x32x16_bf16 v[48:63], v[68:71], v[180:183], 0
    s_setprio 0
    v_mul_f32 v242, v0, v144
    v_fma_f32 v238, v8, v160, -v238
    v_fmac_f32 v242, v1, v145
    v_fmac_f32 v238, v9, v161
    v_fmac_f32 v242, v2, v146
    v_fmac_f32 v238, v10, v162
    v_fmac_f32 v242, v3, v147
    v_fmac_f32 v238, v11, v163
    v_fmac_f32 v242, v4, v148
    v_fmac_f32 v238, v12, v164
    v_fmac_f32 v242, v5, v149
    v_fmac_f32 v238, v13, v165
    v_fmac_f32 v242, v6, v150
    v_fmac_f32 v238, v14, v166
    v_fmac_f32 v242, v7, v151
    v_fmac_f32 v238, v15, v167
    v_fmac_f32 v236, v16, v112
    v_mul_f32 v244, v24, v160
    v_fmac_f32 v236, v17, v113
    v_fmac_f32 v244, v25, v161
    v_fmac_f32 v236, v18, v114
    v_fmac_f32 v244, v26, v162
    v_fmac_f32 v236, v19, v115
    v_fmac_f32 v244, v27, v163
    v_fmac_f32 v236, v20, v116
    v_fmac_f32 v244, v28, v164
    v_fmac_f32 v236, v21, v117
    v_fmac_f32 v244, v29, v165
    v_fmac_f32 v236, v22, v118
    v_fmac_f32 v244, v30, v166
    v_fmac_f32 v236, v23, v119
    v_fmac_f32 v244, v31, v167
    v_mul_f32 v243, v32, v152
    v_fma_f32 v239, v40, v168, -v239
    v_fmac_f32 v243, v33, v153
    v_fmac_f32 v239, v41, v169
    v_fmac_f32 v243, v34, v154
    v_fmac_f32 v239, v42, v170
    v_fmac_f32 v243, v35, v155
    v_fmac_f32 v239, v43, v171
    v_fmac_f32 v243, v36, v156
    v_fmac_f32 v239, v44, v172
    v_fmac_f32 v243, v37, v157
    v_fmac_f32 v239, v45, v173
    v_fmac_f32 v243, v38, v158
    v_fmac_f32 v239, v46, v174
    v_fmac_f32 v243, v39, v159
    v_fmac_f32 v239, v47, v175
    v_fmac_f32 v237, v48, v120
    v_mul_f32 v245, v56, v168
    v_fmac_f32 v237, v49, v121
    v_fmac_f32 v245, v57, v169
    v_fmac_f32 v237, v50, v122
    v_fmac_f32 v245, v58, v170
    v_fmac_f32 v237, v51, v123
    v_fmac_f32 v245, v59, v171
    v_fmac_f32 v237, v52, v124
    v_fmac_f32 v245, v60, v172
    v_fmac_f32 v237, v53, v125
    v_fmac_f32 v245, v61, v173
    v_fmac_f32 v237, v54, v126
    v_fmac_f32 v245, v62, v174
    v_fmac_f32 v237, v55, v127
    v_fmac_f32 v245, v63, v175
    s_setprio 1
    s_waitcnt vmcnt(4) lgkmcnt(0)
    v_mfma_f32_32x32x16_bf16 v[0:15], v[64:67], v[184:187], 0
    ds_read_b64_tr_b16 v[176:177], v246 offset:0
    ds_read_b64_tr_b16 v[178:179], v246 offset:512
    ds_read_b64_tr_b16 v[180:181], v247 offset:0
    ds_read_b64_tr_b16 v[182:183], v247 offset:512
    s_mov_b32 m0, s71
    v_mfma_f32_32x32x16_bf16 v[16:31], v[68:71], v[184:187], 0
    buffer_load_dwordx4 v228, s[4:7], s47 offen sc1 lds
    buffer_load_dwordx4 v229, s[72:75], s47 offen offset:1024 sc1 lds
    v_permlane32_swap_b32 v242, v234
    v_permlane32_swap_b32 v243, v235
    v_add_f32 v242, v242, v234
    v_mfma_f32_32x32x16_bf16 v[32:47], v[64:67], v[188:191], 0
    v_add_f32 v243, v243, v235
    v_cvt_pk_bf16_f32 v242, v242, v243
    ds_write_b32 v230, v242 offset:512
    v_mfma_f32_32x32x16_bf16 v[48:63], v[68:71], v[188:191], 0
    s_setprio 0
    v_mul_f32 v242, v0, v144
    v_fma_f32 v240, v8, v160, -v240
    v_fmac_f32 v242, v1, v145
    v_fmac_f32 v240, v9, v161
    v_fmac_f32 v242, v2, v146
    v_fmac_f32 v240, v10, v162
    v_fmac_f32 v242, v3, v147
    v_fmac_f32 v240, v11, v163
    v_fmac_f32 v242, v4, v148
    v_fmac_f32 v240, v12, v164
    v_fmac_f32 v242, v5, v149
    v_fmac_f32 v240, v13, v165
    v_fmac_f32 v242, v6, v150
    v_fmac_f32 v240, v14, v166
    v_fmac_f32 v242, v7, v151
    v_fmac_f32 v240, v15, v167
    v_add_u32 v249, s26, v249
    v_add_u32 v250, s26, v250
    v_fma_f32 v244, v16, v160, -v244
    v_fmac_f32 v236, v24, v112
    v_fmac_f32 v244, v17, v161
    v_fmac_f32 v236, v25, v113
    v_fmac_f32 v244, v18, v162
    v_fmac_f32 v236, v26, v114
    v_fmac_f32 v244, v19, v163
    v_fmac_f32 v236, v27, v115
    v_fmac_f32 v244, v20, v164
    v_fmac_f32 v236, v28, v116
    v_fmac_f32 v244, v21, v165
    v_fmac_f32 v236, v29, v117
    v_fmac_f32 v244, v22, v166
    v_fmac_f32 v236, v30, v118
    v_fmac_f32 v244, v23, v167
    v_fmac_f32 v236, v31, v119
    ds_read_b64_tr_b16 v[0:1], v249 offset:0
    ds_read_b64_tr_b16 v[2:3], v249 offset:128
    ds_read_b128 v[4:7], v250 offset:0
    ds_read_b128 v[8:11], v250 offset:16
    ds_read_b128 v[12:15], v250 offset:384
    ds_read_b128 v[16:19], v250 offset:400
    v_mul_f32 v243, v32, v152
    v_fma_f32 v241, v40, v168, -v241
    v_fmac_f32 v243, v33, v153
    v_fmac_f32 v241, v41, v169
    v_fmac_f32 v243, v34, v154
    v_fmac_f32 v241, v42, v170
    v_fmac_f32 v243, v35, v155
    v_fmac_f32 v241, v43, v171
    v_fmac_f32 v243, v36, v156
    v_fmac_f32 v241, v44, v172
    v_fmac_f32 v243, v37, v157
    v_fmac_f32 v241, v45, v173
    v_fmac_f32 v243, v38, v158
    v_fmac_f32 v241, v46, v174
    v_fmac_f32 v243, v39, v159
    v_fmac_f32 v241, v47, v175
    ds_read_b64_tr_b16 v[20:21], v249 offset:512
    ds_read_b64_tr_b16 v[22:23], v249 offset:640
    ds_read_b128 v[24:27], v250 offset:64
    ds_read_b128 v[28:31], v250 offset:80
    ds_read_b128 v[32:35], v250 offset:448
    ds_read_b128 v[36:39], v250 offset:464
    v_fma_f32 v245, v48, v168, -v245
    v_fmac_f32 v237, v56, v120
    v_fmac_f32 v245, v49, v169
    v_fmac_f32 v237, v57, v121
    v_fmac_f32 v245, v50, v170
    v_fmac_f32 v237, v58, v122
    v_fmac_f32 v245, v51, v171
    v_fmac_f32 v237, v59, v123
    v_fmac_f32 v245, v52, v172
    v_fmac_f32 v237, v60, v124
    v_fmac_f32 v245, v53, v173
    v_fmac_f32 v237, v61, v125
    v_fmac_f32 v245, v54, v174
    v_fmac_f32 v237, v62, v126
    v_fmac_f32 v245, v55, v175
    v_fmac_f32 v237, v63, v127
    s_cmp_eq_u32 s56, 2
    s_cbranch_scc1 K2_U21
    s_cmp_eq_u32 s56, 3
    s_cbranch_scc1 K2_U31
    s_branch K2_DSP1
K2_U41:
    s_setprio 1
    s_waitcnt lgkmcnt(6)
    v_lshlrev_b32 v40, 16, v0
    v_and_b32 v41, 0xffff0000, v0
    v_lshlrev_b32 v42, 16, v1
    v_and_b32 v43, 0xffff0000, v1
    v_lshlrev_b32 v44, 16, v2
    v_and_b32 v45, 0xffff0000, v2
    v_lshlrev_b32 v46, 16, v3
    v_and_b32 v47, 0xffff0000, v3
    v_mul_f32 v4, v40, v4
    v_mul_f32 v5, v41, v5
    v_mul_f32 v6, v42, v6
    v_mul_f32 v7, v43, v7
    v_mul_f32 v8, v44, v8
    v_mul_f32 v9, v45, v9
    v_mul_f32 v10, v46, v10
    v_mul_f32 v11, v47, v11
    v_cvt_pk_bf16_f32 v64, v4, v5
    v_cvt_pk_bf16_f32 v65, v6, v7
    v_cvt_pk_bf16_f32 v66, v8, v9
    v_cvt_pk_bf16_f32 v67, v10, v11
    v_mul_f32 v12, v40, v12
    v_mul_f32 v13, v41, v13
    v_mul_f32 v14, v42, v14
    v_mul_f32 v15, v43, v15
    v_mul_f32 v16, v44, v16
    v_mul_f32 v17, v45, v17
    v_mul_f32 v18, v46, v18
    v_mul_f32 v19, v47, v19
    v_cvt_pk_bf16_f32 v68, v12, v13
    v_cvt_pk_bf16_f32 v69, v14, v15
    v_cvt_pk_bf16_f32 v70, v16, v17
    v_cvt_pk_bf16_f32 v71, v18, v19
    ds_read_b64_tr_b16 v[0:1], v249 offset:1024
    ds_read_b64_tr_b16 v[2:3], v249 offset:1152
    ds_read_b128 v[4:7], v250 offset:128
    ds_read_b128 v[8:11], v250 offset:144
    ds_read_b128 v[12:15], v250 offset:512
    ds_read_b128 v[16:19], v250 offset:528
    s_waitcnt lgkmcnt(6)
    v_lshlrev_b32 v48, 16, v20
    v_and_b32 v49, 0xffff0000, v20
    v_lshlrev_b32 v50, 16, v21
    v_and_b32 v51, 0xffff0000, v21
    v_lshlrev_b32 v52, 16, v22
    v_and_b32 v53, 0xffff0000, v22
    v_lshlrev_b32 v54, 16, v23
    v_and_b32 v55, 0xffff0000, v23
    v_mul_f32 v24, v48, v24
    v_mul_f32 v25, v49, v25
    v_mul_f32 v26, v50, v26
    v_mul_f32 v27, v51, v27
    v_mul_f32 v28, v52, v28
    v_mul_f32 v29, v53, v29
    v_mul_f32 v30, v54, v30
    v_mul_f32 v31, v55, v31
    v_cvt_pk_bf16_f32 v72, v24, v25
    v_cvt_pk_bf16_f32 v73, v26, v27
    v_cvt_pk_bf16_f32 v74, v28, v29
    v_cvt_pk_bf16_f32 v75, v30, v31
    v_mul_f32 v32, v48, v32
    v_mul_f32 v33, v49, v33
    v_mul_f32 v34, v50, v34
    v_mul_f32 v35, v51, v35
    v_mul_f32 v36, v52, v36
    v_mul_f32 v37, v53, v37
    v_mul_f32 v38, v54, v38
    v_mul_f32 v39, v55, v39
    v_cvt_pk_bf16_f32 v76, v32, v33
    v_cvt_pk_bf16_f32 v77, v34, v35
    v_cvt_pk_bf16_f32 v78, v36, v37
    v_cvt_pk_bf16_f32 v79, v38, v39
    s_lshr_b32 s65, s30, 27
    s_mov_b32 s66, 161536
    s_cmp_ge_u32 s65, 2
    s_cselect_b32 s66, 158112, s66
    s_mul_i32 s65, s65, 512
    s_add_u32 s65, s65, s66
    s_sub_u32 s65, s65, s29
    v_add_u32 v56, s65, v249
    s_lshr_b32 s65, s30, 27
    s_mov_b32 s66, 161536
    s_cmp_ge_u32 s65, 2
    s_cselect_b32 s66, 159008, s66
    s_mul_i32 s65, s65, 64
    s_add_u32 s65, s65, s66
    s_sub_u32 s65, s65, s29
    v_add_u32 v57, s65, v250
    ds_read_b64_tr_b16 v[20:21], v56 offset:0
    ds_read_b64_tr_b16 v[22:23], v56 offset:128
    ds_read_b128 v[24:27], v57 offset:0
    ds_read_b128 v[28:31], v57 offset:16
    ds_read_b128 v[32:35], v57 offset:384
    ds_read_b128 v[36:39], v57 offset:400
    s_waitcnt lgkmcnt(10)
    v_lshlrev_b32 v40, 16, v0
    v_and_b32 v41, 0xffff0000, v0
    v_lshlrev_b32 v42, 16, v1
    v_and_b32 v43, 0xffff0000, v1
    v_lshlrev_b32 v44, 16, v2
    v_and_b32 v45, 0xffff0000, v2
    v_lshlrev_b32 v46, 16, v3
    v_and_b32 v47, 0xffff0000, v3
    s_waitcnt lgkmcnt(8)
    v_mul_f32 v4, v40, v4
    v_mul_f32 v5, v41, v5
    v_mul_f32 v6, v42, v6
    v_mul_f32 v7, v43, v7
    v_mul_f32 v8, v44, v8
    v_mul_f32 v9, v45, v9
    v_mul_f32 v10, v46, v10
    v_mul_f32 v11, v47, v11
    v_cvt_pk_bf16_f32 v80, v4, v5
    v_cvt_pk_bf16_f32 v81, v6, v7
    v_cvt_pk_bf16_f32 v82, v8, v9
    v_cvt_pk_bf16_f32 v83, v10, v11
    s_waitcnt lgkmcnt(6)
    v_mul_f32 v12, v40, v12
    v_mul_f32 v13, v41, v13
    v_mul_f32 v14, v42, v14
    v_mul_f32 v15, v43, v15
    v_mul_f32 v16, v44, v16
    v_mul_f32 v17, v45, v17
    v_mul_f32 v18, v46, v18
    v_mul_f32 v19, v47, v19
    v_cvt_pk_bf16_f32 v84, v12, v13
    v_cvt_pk_bf16_f32 v85, v14, v15
    v_cvt_pk_bf16_f32 v86, v16, v17
    v_cvt_pk_bf16_f32 v87, v18, v19
    s_waitcnt lgkmcnt(4)
    v_lshlrev_b32 v48, 16, v20
    v_and_b32 v49, 0xffff0000, v20
    v_lshlrev_b32 v50, 16, v21
    v_and_b32 v51, 0xffff0000, v21
    v_lshlrev_b32 v52, 16, v22
    v_and_b32 v53, 0xffff0000, v22
    v_lshlrev_b32 v54, 16, v23
    v_and_b32 v55, 0xffff0000, v23
    s_waitcnt lgkmcnt(2)
    v_mul_f32 v24, v48, v24
    v_mul_f32 v25, v49, v25
    v_mul_f32 v26, v50, v26
    v_mul_f32 v27, v51, v27
    v_mul_f32 v28, v52, v28
    v_mul_f32 v29, v53, v29
    v_mul_f32 v30, v54, v30
    v_mul_f32 v31, v55, v31
    v_cvt_pk_bf16_f32 v88, v24, v25
    v_cvt_pk_bf16_f32 v89, v26, v27
    v_cvt_pk_bf16_f32 v90, v28, v29
    v_cvt_pk_bf16_f32 v91, v30, v31
    s_waitcnt lgkmcnt(0)
    v_mul_f32 v32, v48, v32
    v_mul_f32 v33, v49, v33
    v_mul_f32 v34, v50, v34
    v_mul_f32 v35, v51, v35
    v_mul_f32 v36, v52, v36
    v_mul_f32 v37, v53, v37
    v_mul_f32 v38, v54, v38
    v_mul_f32 v39, v55, v39
    v_cvt_pk_bf16_f32 v92, v32, v33
    v_cvt_pk_bf16_f32 v93, v34, v35
    v_cvt_pk_bf16_f32 v94, v36, v37
    v_cvt_pk_bf16_f32 v95, v38, v39
    s_waitcnt vmcnt(4)
    v_mfma_f32_32x32x16_bf16 v[0:15], v[64:67], v[176:179], 0
    ds_read_b64_tr_b16 v[184:185], v246 offset:2048
    ds_read_b64_tr_b16 v[186:187], v246 offset:2560
    ds_read_b64_tr_b16 v[188:189], v247 offset:2048
    ds_read_b64_tr_b16 v[190:191], v247 offset:2560
    s_mov_b32 m0, s68
    v_mfma_f32_32x32x16_bf16 v[16:31], v[68:71], v[176:179], 0
    buffer_load_dwordx4 v222, s[4:7], s41 offen sc1 lds
    buffer_load_dwordx4 v223, s[72:75], s41 offen offset:1024 sc1 lds
    v_permlane32_swap_b32 v242, v236
    v_permlane32_swap_b32 v243, v237
    v_mov_b32 v254, 163648
    v_mfma_f32_32x32x16_bf16 v[32:47], v[64:67], v[180:183], 0
    v_permlane32_swap_b32 v244, v238
    v_permlane32_swap_b32 v245, v239
    v_permlane32_swap_b32 v240, v241
    v_add_f32 v242, v242, v236
    v_mfma_f32_32x32x16_bf16 v[48:63], v[68:71], v[180:183], 0
    v_add_f32 v243, v243, v237
    v_add_f32 v244, v244, v238
    v_add_f32 v245, v245, v239
    v_add_f32 v240, -v240, -v241
    v_sub_u32 v241, v230, v231
    v_cvt_pk_bf16_f32 v242, v242, v243
    v_mov_b32 v255, 1
    v_lshl_add_u32 v233, v252, 1, s53
    s_mov_b64 exec, 1
    ds_add_rtn_u32 v232, v254, v255
    s_mov_b64 exec, -1
    ds_read_b32 v233, v233
    s_waitcnt vmcnt(4) lgkmcnt(2)
    v_mfma_f32_32x32x16_bf16 v[0:15], v[72:75], v[184:187], v[0:15]
    ds_read_b64_tr_b16 v[176:177], v246 offset:4096
    ds_read_b64_tr_b16 v[178:179], v246 offset:4608
    ds_read_b64_tr_b16 v[180:181], v247 offset:4096
    ds_read_b64_tr_b16 v[182:183], v247 offset:4608
    v_cvt_pk_bf16_f32 v244, v244, v245
    v_cvt_pk_bf16_f32 v240, v240, v240
    s_mov_b32 m0, s69
    v_mfma_f32_32x32x16_bf16 v[16:31], v[76:79], v[184:187], v[16:31]
    buffer_load_dwordx4 v224, s[4:7], s41 offen sc1 lds
    buffer_load_dwordx4 v225, s[72:75], s41 offen offset:1024 sc1 lds
    ds_write_b32 v230, v242 offset:768
    ds_write_b32 v230, v244 offset:1024
    ds_write_b16 v241, v240 offset:1280
    s_waitcnt lgkmcnt(7)
    v_readfirstlane_b32 s58, v232
    v_mfma_f32_32x32x16_bf16 v[32:47], v[72:75], v[188:191], v[32:47]
    s_cmp_lt_u32 s58, s22
    s_cbranch_scc0 K2_nul_81
    s_and_b32 s59, s58, 7
    s_lshr_b32 s60, s58, 3
K2_chk_83:
    v_readlane_b32 s61, v233, s59
    s_nop 0
    s_cmp_gt_u32 s61, s60
    s_cbranch_scc0 K2_spin_82
K2_back_84:
    v_mfma_f32_32x32x16_bf16 v[48:63], v[76:79], v[188:191], v[48:63]
    v_readlane_b32 s3, v253, s58
    s_lshl_b32 s44, s34, 7
    s_lshl_b32 s60, s58, 5
    s_and_b32 s48, s3, 0x3ffff
    s_bfe_u32 s33, s3, 0x30012
    s_sub_u32 s60, s60, s48
    s_waitcnt vmcnt(4) lgkmcnt(3)
    v_mfma_f32_32x32x16_bf16 v[0:15], v[80:83], v[176:179], v[0:15]
    ds_read_b64_tr_b16 v[184:185], v246 offset:6144
    ds_read_b64_tr_b16 v[186:187], v246 offset:6656
    ds_read_b64_tr_b16 v[188:189], v247 offset:6144
    ds_read_b64_tr_b16 v[190:191], v247 offset:6656
    s_and_b32 s60, s60, 0xff
    s_add_u32 s35, s60, s48
    s_mov_b32 m0, s70
    v_mfma_f32_32x32x16_bf16 v[16:31], v[84:87], v[176:179], v[16:31]
    buffer_load_dwordx4 v226, s[4:7], s41 offen sc1 lds
    buffer_load_dwordx4 v227, s[72:75], s41 offen offset:1024 sc1 lds
    s_mov_b32 s45, s44
    s_add_u32 s47, s44, 256
    s_add_u32 s49, s48, 32
    s_add_u32 s60, s48, 64
    v_mfma_f32_32x32x16_bf16 v[32:47], v[80:83], v[180:183], v[32:47]
    s_cmp_eq_u32 s33, 3
    s_cselect_b32 s46, s44, s47
    s_cselect_b32 s50, s60, s48
    s_cselect_b32 s51, s48, s49
    s_sub_u32 s60, s33, 2
    s_cmp_lt_u32 s60, 2
    s_cbranch_scc0 K2_rare_85
K2_back_86:
    v_mfma_f32_32x32x16_bf16 v[48:63], v[84:87], v[180:183], v[48:63]
    s_waitcnt vmcnt(4) lgkmcnt(0)
    v_mfma_f32_32x32x16_bf16 v[0:15], v[88:91], v[184:187], v[0:15]
    ds_read_b64_tr_b16 v[176:177], v246 offset:0
    ds_read_b64_tr_b16 v[178:179], v246 offset:512
    ds_read_b64_tr_b16 v[180:181], v247 offset:0
    ds_read_b64_tr_b16 v[182:183], v247 offset:512
    s_mov_b32 m0, s71
    v_mfma_f32_32x32x16_bf16 v[16:31], v[92:95], v[184:187], v[16:31]
    buffer_load_dwordx4 v228, s[4:7], s41 offen sc1 lds
    buffer_load_dwordx4 v229, s[72:75], s41 offen offset:1024 sc1 lds
    v_mfma_f32_32x32x16_bf16 v[32:47], v[88:91], v[188:191], v[32:47]
    s_nop 2
    v_mul_f32 v234, v0, v96
    v_mul_f32 v236, v8, v128
    v_fmac_f32 v234, v1, v97
    v_fmac_f32 v236, v9, v129
    v_fmac_f32 v234, v2, v98
    v_fmac_f32 v236, v10, v130
    v_fmac_f32 v234, v3, v99
    v_mfma_f32_32x32x16_bf16 v[48:63], v[92:95], v[188:191], v[48:63]
    s_setprio 0
    v_fmac_f32 v236, v11, v131
    v_fmac_f32 v234, v4, v100
    v_fmac_f32 v236, v12, v132
    v_fmac_f32 v234, v5, v101
    v_fmac_f32 v236, v13, v133
    v_fmac_f32 v234, v6, v102
    v_fmac_f32 v236, v14, v134
    v_fmac_f32 v234, v7, v103
    v_fmac_f32 v236, v15, v135
    v_mul_f32 v238, v16, v128
    v_mul_f32 v240, v24, v128
    v_fmac_f32 v238, v17, v129
    v_fmac_f32 v240, v25, v129
    v_fmac_f32 v238, v18, v130
    v_fmac_f32 v240, v26, v130
    v_fmac_f32 v238, v19, v131
    v_fmac_f32 v240, v27, v131
    v_fmac_f32 v238, v20, v132
    v_fmac_f32 v240, v28, v132
    v_fmac_f32 v238, v21, v133
    v_fmac_f32 v240, v29, v133
    v_fmac_f32 v238, v22, v134
    v_fmac_f32 v240, v30, v134
    v_fmac_f32 v238, v23, v135
    v_fmac_f32 v240, v31, v135
    v_mul_f32 v235, v32, v104
    v_mul_f32 v237, v40, v136
    v_fmac_f32 v235, v33, v105
    v_fmac_f32 v237, v41, v137
    v_fmac_f32 v235, v34, v106
    v_fmac_f32 v237, v42, v138
    v_fmac_f32 v235, v35, v107
    v_fmac_f32 v237, v43, v139
    v_fmac_f32 v235, v36, v108
    v_fmac_f32 v237, v44, v140
    v_fmac_f32 v235, v37, v109
    v_fmac_f32 v237, v45, v141
    v_fmac_f32 v235, v38, v110
    v_fmac_f32 v237, v46, v142
    v_fmac_f32 v235, v39, v111
    v_fmac_f32 v237, v47, v143
    v_mul_f32 v239, v48, v136
    v_mul_f32 v241, v56, v136
    s_setprio 1
    s_waitcnt vmcnt(4) lgkmcnt(0)
    v_mfma_f32_32x32x16_bf16 v[0:15], v[64:67], v[176:179], 0
    ds_read_b64_tr_b16 v[184:185], v246 offset:2048
    ds_read_b64_tr_b16 v[186:187], v246 offset:2560
    ds_read_b64_tr_b16 v[188:189], v247 offset:2048
    ds_read_b64_tr_b16 v[190:191], v247 offset:2560
    v_fmac_f32 v239, v49, v137
    v_fmac_f32 v241, v57, v137
    s_mov_b32 m0, s68
    v_mfma_f32_32x32x16_bf16 v[16:31], v[68:71], v[176:179], 0
    buffer_load_dwordx4 v222, s[4:7], s42 offen sc1 lds
    buffer_load_dwordx4 v223, s[72:75], s42 offen offset:1024 sc1 lds
    v_fmac_f32 v239, v50, v138
    v_fmac_f32 v241, v58, v138
    v_fmac_f32 v239, v51, v139
    v_fmac_f32 v241, v59, v139
    v_fmac_f32 v239, v52, v140
    v_mfma_f32_32x32x16_bf16 v[32:47], v[64:67], v[180:183], 0
    v_fmac_f32 v241, v60, v140
    v_fmac_f32 v239, v53, v141
    v_fmac_f32 v241, v61, v141
    v_fmac_f32 v239, v54, v142
    v_fmac_f32 v241, v62, v142
    v_fmac_f32 v239, v55, v143
    v_fmac_f32 v241, v63, v143
    v_mfma_f32_32x32x16_bf16 v[48:63], v[68:71], v[180:183], 0
    v_permlane32_swap_b32 v234, v236
    v_permlane32_swap_b32 v235, v237
    v_permlane32_swap_b32 v240, v238
    s_waitcnt vmcnt(4) lgkmcnt(0)
    v_mfma_f32_32x32x16_bf16 v[0:15], v[72:75], v[184:187], v[0:15]
    ds_read_b64_tr_b16 v[176:177], v246 offset:4096
    ds_read_b64_tr_b16 v[178:179], v246 offset:4608
    ds_read_b64_tr_b16 v[180:181], v247 offset:4096
    ds_read_b64_tr_b16 v[182:183], v247 offset:4608
    v_permlane32_swap_b32 v241, v239
    s_mov_b32 m0, s69
    v_mfma_f32_32x32x16_bf16 v[16:31], v[76:79], v[184:187], v[16:31]
    buffer_load_dwordx4 v224, s[4:7], s42 offen sc1 lds
    buffer_load_dwordx4 v225, s[72:75], s42 offen offset:1024 sc1 lds
    v_lshl_add_u32 v230, v252, 1, s31
    v_add_f32 v234, v234, v236
    v_add_f32 v235, v235, v237
    v_add_f32 v240, v240, v238
    v_add_f32 v241, v241, v239
    v_mfma_f32_32x32x16_bf16 v[32:47], v[72:75], v[188:191], v[32:47]
    v_cvt_pk_bf16_f32 v234, v234, v235
    v_cvt_pk_bf16_f32 v240, v240, v241
    ds_write_b32 v230, v234 offset:0
    ds_write_b32 v230, v240 offset:256
    v_mfma_f32_32x32x16_bf16 v[48:63], v[76:79], v[188:191], v[48:63]
    s_waitcnt vmcnt(4) lgkmcnt(2)
    v_mfma_f32_32x32x16_bf16 v[0:15], v[80:83], v[176:179], v[0:15]
    ds_read_b64_tr_b16 v[184:185], v246 offset:6144
    ds_read_b64_tr_b16 v[186:187], v246 offset:6656
    ds_read_b64_tr_b16 v[188:189], v247 offset:6144
    ds_read_b64_tr_b16 v[190:191], v247 offset:6656
    s_mov_b32 m0, s70
    v_mfma_f32_32x32x16_bf16 v[16:31], v[84:87], v[176:179], v[16:31]
    buffer_load_dwordx4 v226, s[4:7], s42 offen sc1 lds
    buffer_load_dwordx4 v227, s[72:75], s42 offen offset:1024 sc1 lds
    v_mfma_f32_32x32x16_bf16 v[32:47], v[80:83], v[180:183], v[32:47]
    v_mfma_f32_32x32x16_bf16 v[48:63], v[84:87], v[180:183], v[48:63]
    s_waitcnt vmcnt(4) lgkmcnt(0)
    v_mfma_f32_32x32x16_bf16 v[0:15], v[88:91], v[184:187], v[0:15]
    ds_read_b64_tr_b16 v[176:177], v246 offset:0
    ds_read_b64_tr_b16 v[178:179], v246 offset:512
    ds_read_b64_tr_b16 v[180:181], v247 offset:0
    ds_read_b64_tr_b16 v[182:183], v247 offset:512
    s_mov_b32 m0, s71
    v_mfma_f32_32x32x16_bf16 v[16:31], v[92:95], v[184:187], v[16:31]
    buffer_load_dwordx4 v228, s[4:7], s42 offen sc1 lds
    buffer_load_dwordx4 v229, s[72:75], s42 offen offset:1024 sc1 lds
    v_mfma_f32_32x32x16_bf16 v[32:47], v[88:91], v[188:191], v[32:47]
    s_nop 2
    v_mul_f32 v234, v0, v144
    v_mul_f32 v236, v8, v112
    v_fmac_f32 v234, v1, v145
    v_fmac_f32 v236, v9, v113
    v_fmac_f32 v234, v2, v146
    v_fmac_f32 v236, v10, v114
    v_fmac_f32 v234, v3, v147
    v_mfma_f32_32x32x16_bf16 v[48:63], v[92:95], v[188:191], v[48:63]
    s_setprio 0
    v_fmac_f32 v236, v11, v115
    v_fmac_f32 v234, v4, v148
    v_fmac_f32 v236, v12, v116
    v_fmac_f32 v234, v5, v149
    v_fmac_f32 v236, v13, v117
    v_fmac_f32 v234, v6, v150
    v_fmac_f32 v236, v14, v118
    v_fmac_f32 v234, v7, v151
    v_fmac_f32 v236, v15, v119
    v_mul_f32 v238, v16, v160
    v_mul_f32 v240, v24, v160
    v_fmac_f32 v238, v17, v161
    v_fmac_f32 v240, v25, v161
    v_fmac_f32 v238, v18, v162
    v_fmac_f32 v240, v26, v162
    v_fmac_f32 v238, v19, v163
    v_fmac_f32 v240, v27, v163
    v_fmac_f32 v238, v20, v164
    v_fmac_f32 v240, v28, v164
    v_fmac_f32 v238, v21, v165
    v_fmac_f32 v240, v29, v165
    v_fmac_f32 v238, v22, v166
    v_fmac_f32 v240, v30, v166
    v_fmac_f32 v238, v23, v167
    v_fmac_f32 v240, v31, v167
    v_mul_f32 v235, v32, v152
    v_mul_f32 v237, v40, v120
    v_fmac_f32 v235, v33, v153
    v_fmac_f32 v237, v41, v121
    v_fmac_f32 v235, v34, v154
    v_fmac_f32 v237, v42, v122
    v_fmac_f32 v235, v35, v155
    v_fmac_f32 v237, v43, v123
    v_fmac_f32 v235, v36, v156
    v_fmac_f32 v237, v44, v124
    v_fmac_f32 v235, v37, v157
    v_fmac_f32 v237, v45, v125
    v_fmac_f32 v235, v38, v158
    v_fmac_f32 v237, v46, v126
    v_fmac_f32 v235, v39, v159
    v_fmac_f32 v237, v47, v127
    v_mul_f32 v239, v48, v168
    v_mul_f32 v241, v56, v168
    s_setprio 1
    s_waitcnt vmcnt(4) lgkmcnt(0)
    v_mfma_f32_32x32x16_bf16 v[0:15], v[64:67], v[176:179], 0
    ds_read_b64_tr_b16 v[184:185], v246 offset:2048
    ds_read_b64_tr_b16 v[186:187], v246 offset:2560
    ds_read_b64_tr_b16 v[188:189], v247 offset:2048
    ds_read_b64_tr_b16 v[190:191], v247 offset:2560
    v_fmac_f32 v239, v49, v169
    v_fmac_f32 v241, v57, v169
    s_mov_b32 m0, s68
    v_mfma_f32_32x32x16_bf16 v[16:31], v[68:71], v[176:179], 0
    buffer_load_dwordx4 v222, s[4:7], s43 offen sc1 lds
    buffer_load_dwordx4 v223, s[72:75], s43 offen offset:1024 sc1 lds
    v_fmac_f32 v239, v50, v170
    v_fmac_f32 v241, v58, v170
    v_fmac_f32 v239, v51, v171
    v_fmac_f32 v241, v59, v171
    v_fmac_f32 v239, v52, v172
    v_mfma_f32_32x32x16_bf16 v[32:47], v[64:67], v[180:183], 0
    v_fmac_f32 v241, v60, v172
    v_fmac_f32 v239, v53, v173
    v_fmac_f32 v241, v61, v173
    v_fmac_f32 v239, v54, v174
    v_fmac_f32 v241, v62, v174
    v_fmac_f32 v239, v55, v175
    v_fmac_f32 v241, v63, v175
    v_mfma_f32_32x32x16_bf16 v[48:63], v[68:71], v[180:183], 0
    s_waitcnt vmcnt(4) lgkmcnt(0)
    v_mfma_f32_32x32x16_bf16 v[0:15], v[72:75], v[184:187], v[0:15]
    ds_read_b64_tr_b16 v[176:177], v246 offset:4096
    ds_read_b64_tr_b16 v[178:179], v246 offset:4608
    ds_read_b64_tr_b16 v[180:181], v247 offset:4096
    ds_read_b64_tr_b16 v[182:183], v247 offset:4608
    s_mov_b32 m0, s69
    v_mfma_f32_32x32x16_bf16 v[16:31], v[76:79], v[184:187], v[16:31]
    buffer_load_dwordx4 v224, s[4:7], s43 offen sc1 lds
    buffer_load_dwordx4 v225, s[72:75], s43 offen offset:1024 sc1 lds
    v_mfma_f32_32x32x16_bf16 v[32:47], v[72:75], v[188:191], v[32:47]
    v_mfma_f32_32x32x16_bf16 v[48:63], v[76:79], v[188:191], v[48:63]
    s_waitcnt vmcnt(4) lgkmcnt(0)
    v_mfma_f32_32x32x16_bf16 v[0:15], v[80:83], v[176:179], v[0:15]
    ds_read_b64_tr_b16 v[184:185], v246 offset:6144
    ds_read_b64_tr_b16 v[186:187], v246 offset:6656
    ds_read_b64_tr_b16 v[188:189], v247 offset:6144
    ds_read_b64_tr_b16 v[190:191], v247 offset:6656
    s_mov_b32 m0, s70
    v_mfma_f32_32x32x16_bf16 v[16:31], v[84:87], v[176:179], v[16:31]
    buffer_load_dwordx4 v226, s[4:7], s43 offen sc1 lds
    buffer_load_dwordx4 v227, s[72:75], s43 offen offset:1024 sc1 lds
    v_mfma_f32_32x32x16_bf16 v[32:47], v[80:83], v[180:183], v[32:47]
    v_add_u32 v222, s48, v251
    ds_read_b32 v222, v222
    v_mfma_f32_32x32x16_bf16 v[48:63], v[84:87], v[180:183], v[48:63]
    s_waitcnt vmcnt(4) lgkmcnt(1)
    v_mfma_f32_32x32x16_bf16 v[0:15], v[88:91], v[184:187], v[0:15]
    ds_read_b64_tr_b16 v[176:177], v246 offset:0
    ds_read_b64_tr_b16 v[178:179], v246 offset:512
    ds_read_b64_tr_b16 v[180:181], v247 offset:0
    ds_read_b64_tr_b16 v[182:183], v247 offset:512
    s_mov_b32 m0, s71
    v_mfma_f32_32x32x16_bf16 v[16:31], v[92:95], v[184:187], v[16:31]
    buffer_load_dwordx4 v228, s[4:7], s43 offen sc1 lds
    buffer_load_dwordx4 v229, s[72:75], s43 offen offset:1024 sc1 lds
    s_waitcnt lgkmcnt(4)
    v_mad_u32_u16 v223, v222, s39, v248 op_sel:[1,0,0,0]
    v_mad_u32_u16 v222, v222, s39, v248
    v_mfma_f32_32x32x16_bf16 v[32:47], v[88:91], v[188:191], v[32:47]
    v_add_u32 v224, s49, v251
    ds_read_b32 v224, v224
    v_mul_f32 v242, v0, v144
    v_fma_f32 v238, v8, v160, -v238
    v_fmac_f32 v242, v1, v145
    v_fmac_f32 v238, v9, v161
    v_fmac_f32 v242, v2, v146
    v_mfma_f32_32x32x16_bf16 v[48:63], v[92:95], v[188:191], v[48:63]
    s_setprio 0
    v_fmac_f32 v238, v10, v162
    v_fmac_f32 v242, v3, v147
    v_fmac_f32 v238, v11, v163
    v_fmac_f32 v242, v4, v148
    v_fmac_f32 v238, v12, v164
    v_fmac_f32 v242, v5, v149
    v_fmac_f32 v238, v13, v165
    v_fmac_f32 v242, v6, v150
    v_fmac_f32 v238, v14, v166
    v_fmac_f32 v242, v7, v151
    v_fmac_f32 v238, v15, v167
    v_fmac_f32 v236, v16, v112
    v_mul_f32 v244, v24, v160
    v_fmac_f32 v236, v17, v113
    v_fmac_f32 v244, v25, v161
    v_fmac_f32 v236, v18, v114
    v_fmac_f32 v244, v26, v162
    v_fmac_f32 v236, v19, v115
    v_fmac_f32 v244, v27, v163
    v_fmac_f32 v236, v20, v116
    v_fmac_f32 v244, v28, v164
    v_fmac_f32 v236, v21, v117
    v_fmac_f32 v244, v29, v165
    v_fmac_f32 v236, v22, v118
    v_fmac_f32 v244, v30, v166
    v_fmac_f32 v236, v23, v119
    v_fmac_f32 v244, v31, v167
    v_mul_f32 v243, v32, v152
    v_fma_f32 v239, v40, v168, -v239
    v_fmac_f32 v243, v33, v153
    v_fmac_f32 v239, v41, v169
    v_fmac_f32 v243, v34, v154
    v_fmac_f32 v239, v42, v170
    v_fmac_f32 v243, v35, v155
    v_fmac_f32 v239, v43, v171
    v_fmac_f32 v243, v36, v156
    v_fmac_f32 v239, v44, v172
    v_fmac_f32 v243, v37, v157
    v_fmac_f32 v239, v45, v173
    v_fmac_f32 v243, v38, v158
    v_fmac_f32 v239, v46, v174
    v_fmac_f32 v243, v39, v159
    v_fmac_f32 v239, v47, v175
    v_fmac_f32 v237, v48, v120
    v_mul_f32 v245, v56, v168
    v_fmac_f32 v237, v49, v121
    v_fmac_f32 v245, v57, v169
    v_fmac_f32 v237, v50, v122
    v_fmac_f32 v245, v58, v170
    v_fmac_f32 v237, v51, v123
    s_setprio 1
    s_waitcnt vmcnt(4) lgkmcnt(1)
    v_mfma_f32_32x32x16_bf16 v[0:15], v[64:67], v[176:179], 0
    ds_read_b64_tr_b16 v[184:185], v246 offset:2048
    ds_read_b64_tr_b16 v[186:187], v246 offset:2560
    ds_read_b64_tr_b16 v[188:189], v247 offset:2048
    ds_read_b64_tr_b16 v[190:191], v247 offset:2560
    v_fmac_f32 v245, v59, v171
    v_fmac_f32 v237, v52, v124
    s_mov_b32 m0, s68
    v_mfma_f32_32x32x16_bf16 v[16:31], v[68:71], v[176:179], 0
    buffer_load_dwordx4 v222, s[4:7], s44 offen sc1 lds
    buffer_load_dwordx4 v223, s[72:75], s44 offen offset:1024 sc1 lds
    s_waitcnt lgkmcnt(4)
    v_mad_u32_u16 v225, v224, s39, v248 op_sel:[1,0,0,0]
    v_mad_u32_u16 v224, v224, s39, v248
    v_fmac_f32 v245, v60, v172
    v_fmac_f32 v237, v53, v125
    v_mfma_f32_32x32x16_bf16 v[32:47], v[64:67], v[180:183], 0
    v_add_u32 v226, s50, v251
    ds_read_b32 v226, v226
    v_fmac_f32 v245, v61, v173
    v_fmac_f32 v237, v54, v126
    v_fmac_f32 v245, v62, v174
    v_fmac_f32 v237, v55, v127
    v_fmac_f32 v245, v63, v175
    v_mfma_f32_32x32x16_bf16 v[48:63], v[68:71], v[180:183], 0
    v_permlane32_swap_b32 v242, v234
    v_permlane32_swap_b32 v243, v235
    v_add_f32 v242, v242, v234
    v_add_f32 v243, v243, v235
    s_waitcnt vmcnt(4) lgkmcnt(1)
    v_mfma_f32_32x32x16_bf16 v[0:15], v[72:75], v[184:187], v[0:15]
    ds_read_b64_tr_b16 v[176:177], v246 offset:4096
    ds_read_b64_tr_b16 v[178:179], v246 offset:4608
    ds_read_b64_tr_b16 v[180:181], v247 offset:4096
    ds_read_b64_tr_b16 v[182:183], v247 offset:4608
    v_cvt_pk_bf16_f32 v242, v242, v243
    ds_write_b32 v230, v242 offset:512
    s_mov_b32 m0, s69
    v_mfma_f32_32x32x16_bf16 v[16:31], v[76:79], v[184:187], v[16:31]
    buffer_load_dwordx4 v224, s[4:7], s45 offen sc1 lds
    buffer_load_dwordx4 v225, s[72:75], s45 offen offset:1024 sc1 lds
    s_waitcnt lgkmcnt(5)
    v_mad_u32_u16 v227, v226, s39, v248 op_sel:[1,0,0,0]
    v_mad_u32_u16 v226, v226, s39, v248
    v_mfma_f32_32x32x16_bf16 v[32:47], v[72:75], v[188:191], v[32:47]
    v_add_u32 v228, s51, v251
    ds_read_b32 v228, v228
    v_mfma_f32_32x32x16_bf16 v[48:63], v[76:79], v[188:191], v[48:63]
    s_waitcnt vmcnt(4) lgkmcnt(2)
    v_mfma_f32_32x32x16_bf16 v[0:15], v[80:83], v[176:179], v[0:15]
    ds_read_b64_tr_b16 v[184:185], v246 offset:6144
    ds_read_b64_tr_b16 v[186:187], v246 offset:6656
    ds_read_b64_tr_b16 v[188:189], v247 offset:6144
    ds_read_b64_tr_b16 v[190:191], v247 offset:6656
    s_mov_b32 s32, s31
    s_mov_b32 s31, s35
    s_mov_b32 m0, s70
    v_mfma_f32_32x32x16_bf16 v[16:31], v[84:87], v[176:179], v[16:31]
    buffer_load_dwordx4 v226, s[4:7], s46 offen sc1 lds
    buffer_load_dwordx4 v227, s[72:75], s46 offen offset:1024 sc1 lds
    s_waitcnt lgkmcnt(4)
    v_mad_u32_u16 v229, v228, s39, v248 op_sel:[1,0,0,0]
    v_mad_u32_u16 v228, v228, s39, v248
    s_sub_u32 s26, s48, s29
    s_mov_b32 s29, s48
    v_mfma_f32_32x32x16_bf16 v[32:47], v[80:83], v[180:183], v[32:47]
    s_mov_b32 s30, s3
    s_cmp_lg_u32 s36, 0
    s_cselect_b32 s56, s33, 0
    v_mfma_f32_32x32x16_bf16 v[48:63], v[84:87], v[180:183], v[48:63]
    s_waitcnt vmcnt(4) lgkmcnt(0)
    v_mfma_f32_32x32x16_bf16 v[0:15], v[88:91], v[184:187], v[0:15]
    ds_read_b64_tr_b16 v[176:177], v246 offset:0
    ds_read_b64_tr_b16 v[178:179], v246 offset:512
    ds_read_b64_tr_b16 v[180:181], v247 offset:0
    ds_read_b64_tr_b16 v[182:183], v247 offset:512
    s_mov_b32 m0, s71
    v_mfma_f32_32x32x16_bf16 v[16:31], v[92:95], v[184:187], v[16:31]
    buffer_load_dwordx4 v228, s[4:7], s47 offen sc1 lds
    buffer_load_dwordx4 v229, s[72:75], s47 offen offset:1024 sc1 lds
    v_mfma_f32_32x32x16_bf16 v[32:47], v[88:91], v[188:191], v[32:47]
    s_nop 2
    v_mul_f32 v242, v0, v144
    v_fma_f32 v240, v8, v160, -v240
    v_fmac_f32 v242, v1, v145
    v_fmac_f32 v240, v9, v161
    v_fmac_f32 v242, v2, v146
    v_fmac_f32 v240, v10, v162
    v_fmac_f32 v242, v3, v147
    v_mfma_f32_32x32x16_bf16 v[48:63], v[92:95], v[188:191], v[48:63]
    s_setprio 0
    v_fmac_f32 v240, v11, v163
    v_fmac_f32 v242, v4, v148
    v_fmac_f32 v240, v12, v164
    v_fmac_f32 v242, v5, v149
    v_fmac_f32 v240, v13, v165
    v_fmac_f32 v242, v6, v150
    v_fmac_f32 v240, v14, v166
    v_fmac_f32 v242, v7, v151
    v_fmac_f32 v240, v15, v167
    v_add_u32 v249, s26, v249
    v_add_u32 v250, s26, v250
    v_fma_f32 v244, v16, v160, -v244
    v_fmac_f32 v236, v24, v112
    v_fmac_f32 v244, v17, v161
    v_fmac_f32 v236, v25, v113
    v_fmac_f32 v244, v18, v162
    v_fmac_f32 v236, v26, v114
    v_fmac_f32 v244, v19, v163
    v_fmac_f32 v236, v27, v115
    v_fmac_f32 v244, v20, v164
    v_fmac_f32 v236, v28, v116
    v_fmac_f32 v244, v21, v165
    v_fmac_f32 v236, v29, v117
    v_fmac_f32 v244, v22, v166
    v_fmac_f32 v236, v30, v118
    v_fmac_f32 v244, v23, v167
    v_fmac_f32 v236, v31, v119
    ds_read_b64_tr_b16 v[0:1], v249 offset:0
    ds_read_b64_tr_b16 v[2:3], v249 offset:128
    ds_read_b128 v[4:7], v250 offset:0
    ds_read_b128 v[8:11], v250 offset:16
    ds_read_b128 v[12:15], v250 offset:384
    ds_read_b128 v[16:19], v250 offset:400
    v_mul_f32 v243, v32, v152
    v_fma_f32 v241, v40, v168, -v241
    v_fmac_f32 v243, v33, v153
    v_fmac_f32 v241, v41, v169
    v_fmac_f32 v243, v34, v154
    v_fmac_f32 v241, v42, v170
    v_fmac_f32 v243, v35, v155
    v_fmac_f32 v241, v43, v171
    v_fmac_f32 v243, v36, v156
    v_fmac_f32 v241, v44, v172
    v_fmac_f32 v243, v37, v157
    v_fmac_f32 v241, v45, v173
    v_fmac_f32 v243, v38, v158
    v_fmac_f32 v241, v46, v174
    v_fmac_f32 v243, v39, v159
    v_fmac_f32 v241, v47, v175
    ds_read_b64_tr_b16 v[20:21], v249 offset:512
    ds_read_b64_tr_b16 v[22:23], v249 offset:640
    ds_read_b128 v[24:27], v250 offset:64
    ds_read_b128 v[28:31], v250 offset:80
    ds_read_b128 v[32:35], v250 offset:448
    ds_read_b128 v[36:39], v250 offset:464
    v_fma_f32 v245, v48, v168, -v245
    v_fmac_f32 v237, v56, v120
    v_fmac_f32 v245, v49, v169
    v_fmac_f32 v237, v57, v121
    v_fmac_f32 v245, v50, v170
    v_fmac_f32 v237, v58, v122
    v_fmac_f32 v245, v51, v171
    v_fmac_f32 v237, v59, v123
    v_fmac_f32 v245, v52, v172
    v_fmac_f32 v237, v60, v124
    v_fmac_f32 v245, v53, v173
    v_fmac_f32 v237, v61, v125
    v_fmac_f32 v245, v54, v174
    v_fmac_f32 v237, v62, v126
    v_fmac_f32 v245, v55, v175
    v_fmac_f32 v237, v63, v127
    s_cmp_eq_u32 s56, 2
    s_cbranch_scc1 K2_U21
    s_cmp_eq_u32 s56, 3
    s_cbranch_scc1 K2_U31
    s_branch K2_DSP1
K2_DSP0:
    s_cmp_eq_u32 s56, 1
    s_cbranch_scc1 K2_U10
    s_cmp_eq_u32 s56, 4
    s_cbranch_scc1 K2_U40
    s_branch K2_SWITCH
K2_DSP1:
    s_cmp_eq_u32 s56, 1
    s_cbranch_scc1 K2_U11
    s_cmp_eq_u32 s56, 4
    s_cbranch_scc1 K2_U41
    s_branch K2_TAIL
K2_SWITCH:
    v_permlane32_swap_b32 v242, v236
    v_permlane32_swap_b32 v243, v237
    v_permlane32_swap_b32 v244, v238
    v_permlane32_swap_b32 v245, v239
    v_permlane32_swap_b32 v240, v241
    v_add_f32 v242, v242, v236
    v_add_f32 v243, v243, v237
    v_add_f32 v244, v244, v238
    v_add_f32 v245, v245, v239
    v_add_f32 v240, -v240, -v241
    s_set_gpr_idx_on s32, gpr_idx(DST)
    s_nop 0
    v_cvt_pk_bf16_f32 v195, v242, v243
    v_cvt_pk_bf16_f32 v196, v244, v245
    v_cvt_pk_bf16_f32 v197, v240, v240
    s_set_gpr_idx_off
    s_cmp_eq_u32 s36, 0
    s_cbranch_scc1 K2_TAIL2
    v_lshlrev_b32 v254, 3, v252
    v_lshl_add_u32 v230, v252, 1, s35
    v_lshrrev_b32 v231, 6, v252
    v_mul_u32_u24 v231, 126, v231
    s_mov_b32 s58, 7131136
    buffer_load_dwordx4 v[96:99], v254, s[8:11], s58 offen offset:0 sc1
    buffer_load_dwordx4 v[100:103], v254, s[8:11], s58 offen offset:1024 sc1
    buffer_load_dwordx4 v[104:107], v254, s[8:11], s58 offen offset:2048 sc1
    buffer_load_dwordx4 v[108:111], v254, s[8:11], s58 offen offset:3072 sc1
    s_mov_b32 s58, 7135232
    buffer_load_dwordx4 v[112:115], v254, s[8:11], s58 offen offset:0 sc1
    buffer_load_dwordx4 v[116:119], v254, s[8:11], s58 offen offset:1024 sc1
    buffer_load_dwordx4 v[120:123], v254, s[8:11], s58 offen offset:2048 sc1
    buffer_load_dwordx4 v[124:127], v254, s[8:11], s58 offen offset:3072 sc1
    s_mov_b32 s58, 7139328
    buffer_load_dwordx4 v[128:131], v254, s[8:11], s58 offen offset:0 sc1
    buffer_load_dwordx4 v[132:135], v254, s[8:11], s58 offen offset:1024 sc1
    buffer_load_dwordx4 v[136:139], v254, s[8:11], s58 offen offset:2048 sc1
    buffer_load_dwordx4 v[140:143], v254, s[8:11], s58 offen offset:3072 sc1
    s_mov_b32 s58, 7143424
    buffer_load_dwordx4 v[144:147], v254, s[8:11], s58 offen offset:0 sc1
    buffer_load_dwordx4 v[148:151], v254, s[8:11], s58 offen offset:1024 sc1
    buffer_load_dwordx4 v[152:155], v254, s[8:11], s58 offen offset:2048 sc1
    buffer_load_dwordx4 v[156:159], v254, s[8:11], s58 offen offset:3072 sc1
    s_mov_b32 s58, 7147520
    buffer_load_dwordx4 v[160:163], v254, s[8:11], s58 offen offset:0 sc1
    buffer_load_dwordx4 v[164:167], v254, s[8:11], s58 offen offset:1024 sc1
    buffer_load_dwordx4 v[168:171], v254, s[8:11], s58 offen offset:2048 sc1
    buffer_load_dwordx4 v[172:175], v254, s[8:11], s58 offen offset:3072 sc1
    s_movk_i32 s40, 128
    s_movk_i32 s41, 384
    s_movk_i32 s42, 640
    s_movk_i32 s43, 896
    s_cmp_lg_u32 s33, 1
    s_cbranch_scc1 K2_SW2
    s_waitcnt vmcnt(0)
K2_SW2:
    s_mov_b32 s29, s48
    s_mov_b32 s32, s31
    s_mov_b32 s30, s3
    s_mov_b32 s31, s35
    s_cmp_eq_u32 s33, 2
    s_cbranch_scc1 K2_U21
    s_cmp_eq_u32 s33, 3
    s_cbranch_scc1 K2_U31
    s_cmp_eq_u32 s33, 1
    s_cbranch_scc1 K2_U11
    s_branch K2_U41
K2_WINDOW:
    s_mov_b32 s24, 0
    s_mov_b32 s25, 1
K2_LOAD:
    v_mbcnt_lo_u32_b32 v176, -1, 0
    v_mbcnt_hi_u32_b32 v176, -1, v176
    s_lshl_b32 s58, s20, 6
    v_add_u32 v177, s58, v176
    v_lshlrev_b32 v70, 4, v176
    s_mov_b32 s58, 7110656
    buffer_load_dwordx4 v[96:99], v70, s[8:11], s58 offen offset:0 sc1
    buffer_load_dwordx4 v[100:103], v70, s[8:11], s58 offen offset:1024 sc1
    buffer_load_dwordx4 v[104:107], v70, s[8:11], s58 offen offset:2048 sc1
    buffer_load_dwordx4 v[108:111], v70, s[8:11], s58 offen offset:3072 sc1
    s_mov_b32 s58, 7114752
    buffer_load_dwordx4 v[112:115], v70, s[8:11], s58 offen offset:0 sc1
    buffer_load_dwordx4 v[116:119], v70, s[8:11], s58 offen offset:1024 sc1
    buffer_load_dwordx4 v[120:123], v70, s[8:11], s58 offen offset:2048 sc1
    buffer_load_dwordx4 v[124:127], v70, s[8:11], s58 offen offset:3072 sc1
    s_mov_b32 s58, 7118848
    buffer_load_dwordx4 v[128:131], v70, s[8:11], s58 offen offset:0 sc1
    buffer_load_dwordx4 v[132:135], v70, s[8:11], s58 offen offset:1024 sc1
    buffer_load_dwordx4 v[136:139], v70, s[8:11], s58 offen offset:2048 sc1
    buffer_load_dwordx4 v[140:143], v70, s[8:11], s58 offen offset:3072 sc1
    s_mov_b32 s58, 7122944
    buffer_load_dwordx4 v[144:147], v70, s[8:11], s58 offen offset:0 sc1
    buffer_load_dwordx4 v[148:151], v70, s[8:11], s58 offen offset:1024 sc1
    buffer_load_dwordx4 v[152:155], v70, s[8:11], s58 offen offset:2048 sc1
    buffer_load_dwordx4 v[156:159], v70, s[8:11], s58 offen offset:3072 sc1
    s_mov_b32 s58, 7127040
    buffer_load_dwordx4 v[160:163], v70, s[8:11], s58 offen offset:0 sc1
    buffer_load_dwordx4 v[164:167], v70, s[8:11], s58 offen offset:1024 sc1
    buffer_load_dwordx4 v[168:171], v70, s[8:11], s58 offen offset:2048 sc1
    buffer_load_dwordx4 v[172:175], v70, s[8:11], s58 offen offset:3072 sc1
    v_mul_u32_u24 v76, 437, v177
    v_lshrrev_b32 v76, 16, v76
    v_mul_u32_u24 v76, 150, v76
    v_sub_u32 v76, v177, v76
    v_mov_b32 v80, -1
    v_mov_b32 v77, 1.0
    v_cmp_gt_u32 vcc, 48, v76
    v_lshlrev_b32 v78, 4, v177
    v_add_u32 v78, 65536, v78
    v_cndmask_b32 v80, v80, 0, vcc
    v_cmp_gt_u32 vcc, 12, v76
    v_add_u32 v79, 64800, v78
    s_nop 0
    v_cndmask_b32 v80, v80, v77, vcc
    v_cmp_gt_u32 vcc, 450, v177
    v_mov_b32 v81, v80
    v_mov_b32 v82, v80
    v_mov_b32 v83, v80
    s_mov_b64 exec, vcc
    ds_write_b128 v78, v[80:83] offset:0
    ds_write_b128 v78, v[80:83] offset:7200
    ds_write_b128 v78, v[80:83] offset:14400
    ds_write_b128 v78, v[80:83] offset:21600
    ds_write_b128 v78, v[80:83] offset:28800
    ds_write_b128 v78, v[80:83] offset:36000
    ds_write_b128 v78, v[80:83] offset:43200
    ds_write_b128 v78, v[80:83] offset:50400
    ds_write_b128 v78, v[80:83] offset:57600
    ds_write_b128 v79, v[80:83] offset:0
    ds_write_b128 v79, v[80:83] offset:7200
    ds_write_b128 v79, v[80:83] offset:14400
    ds_write_b128 v79, v[80:83] offset:21600
    v_cmp_gt_u32 vcc, 268, v177
    s_nop 0
    s_cbranch_vccz K2_NOCL
    s_mov_b64 exec, vcc
    ds_write_b128 v79, v[80:83] offset:28800
K2_NOCL:
    s_mov_b64 exec, -1
    s_cmp_lg_u32 s20, 7
    s_cbranch_scc1 K2_NOH
    v_mov_b32 v76, 0
    v_mov_b32 v77, -1
    v_lshlrev_b32 v78, 2, v176
    v_add_u32 v78, 163424, v78
    s_mov_b64 exec, 0x1ff
    ds_write_b32 v78, v76 offset:192
    s_mov_b64 exec, 0xff
    ds_write_b32 v78, v77 offset:256
    s_mov_b64 exec, -1
    s_cmp_lg_u32 s24, 0
    s_cbranch_scc1 K2_NOH
    s_mov_b32 exec_hi, 0xffff
    ds_write_b32 v78, v76
    s_mov_b64 exec, 0x3f
    ds_write_b32 v78, v76 offset:228
    s_mov_b64 exec, -1
K2_NOH:
    s_waitcnt lgkmcnt(0)
    s_barrier
    s_branch K2_CELLS
K2_FLGLD:
    buffer_load_dwordx4 v[84:87], v72, s[8:11], s64 offen sc1
    s_mov_b32 s62, 0
    s_branch K2_FLGL2
K2_FLGCK:
    s_cmp_lg_u32 s24, 0
    s_cbranch_scc1 K2_FLGOK
    s_waitcnt vmcnt(0)
K2_FLGW:
    v_xor_b32 v84, s2, v84
    v_xor_b32 v85, s2, v85
    v_xor_b32 v86, s2, v86
    v_xor_b32 v87, s2, v87
    v_or3_b32 v84, v84, v85, v86
    v_or_b32 v84, v84, v87
    v_cmp_ne_u32 vcc, 0, v84
    s_nop 0
    s_and_b32 vcc_hi, vcc_hi, 0x3ffff
    s_cmp_eq_u64 vcc, 0
    s_cbranch_scc1 K2_FLGOK
    s_sub_u32 s60, s60, 1
    s_cbranch_scc1 K2_END
    buffer_load_dwordx4 v[84:87], v72, s[8:11], s64 offen sc1
    s_waitcnt vmcnt(0)
    s_branch K2_FLGW
K2_RT0:
    s_sub_u32 s60, s60, 1
    s_cbranch_scc1 K2_END
    buffer_load_dwordx4 v[0:3], v181, s[8:11], 0 offen offset:0 sc1
    s_waitcnt vmcnt(0)
    s_branch K2_CK0
K2_RT1:
    s_sub_u32 s60, s60, 1
    s_cbranch_scc1 K2_END
    buffer_load_dwordx4 v[4:7], v181, s[8:11], 0 offen offset:32 sc1
    s_waitcnt vmcnt(0)
    s_branch K2_CK1
K2_RT2:
    s_sub_u32 s60, s60, 1
    s_cbranch_scc1 K2_END
    buffer_load_dwordx4 v[8:11], v181, s[8:11], 0 offen offset:64 sc1
    s_waitcnt vmcnt(0)
    s_branch K2_CK2
K2_RT3:
    s_sub_u32 s60, s60, 1
    s_cbranch_scc1 K2_END
    buffer_load_dwordx4 v[12:15], v181, s[8:11], 0 offen offset:96 sc1
    s_waitcnt vmcnt(0)
    s_branch K2_CK3
K2_RT4:
    s_sub_u32 s60, s60, 1
    s_cbranch_scc1 K2_END
    buffer_load_dwordx4 v[16:19], v181, s[8:11], 0 offen offset:128 sc1
    s_waitcnt vmcnt(0)
    s_branch K2_CK4
K2_RT5:
    s_sub_u32 s60, s60, 1
    s_cbranch_scc1 K2_END
    buffer_load_dwordx4 v[20:23], v181, s[8:11], 0 offen offset:160 sc1
    s_waitcnt vmcnt(0)
    s_branch K2_CK5
K2_RT6:
    s_sub_u32 s60, s60, 1
    s_cbranch_scc1 K2_END
    buffer_load_dwordx4 v[24:27], v181, s[8:11], 0 offen offset:192 sc1
    s_waitcnt vmcnt(0)
    s_branch K2_CK6
K2_RT7:
    s_sub_u32 s60, s60, 1
    s_cbranch_scc1 K2_END
    buffer_load_dwordx4 v[28:31], v181, s[8:11], 0 offen offset:224 sc1
    s_waitcnt vmcnt(0)
    s_branch K2_CK7
K2_RT8:
    s_sub_u32 s60, s60, 1
    s_cbranch_scc1 K2_END
    buffer_load_dwordx4 v[32:35], v181, s[8:11], 0 offen offset:256 sc1
    s_waitcnt vmcnt(0)
    s_branch K2_CK8
K2_RT9:
    s_sub_u32 s60, s60, 1
    s_cbranch_scc1 K2_END
    buffer_load_dwordx4 v[36:39], v181, s[8:11], 0 offen offset:288 sc1
    s_waitcnt vmcnt(0)
    s_branch K2_CK9
K2_RK_LOAD:
    s_waitcnt vmcnt(0)
    s_mov_b64 exec, s[40:41]
    s_cbranch_execz K2_RK_B
    v_lshrrev_b32 v50, 24, v3
    buffer_load_dword v40, v179, s[8:11], s66 offen offset:0
    v_mad_u32_u24 v50, v50, s58, v202
    v_and_b32 v3, 0xffffff, v3
    s_mov_b64 exec, s[42:43]
    s_cbranch_execz K2_RK_B
    v_lshrrev_b32 v51, 24, v7
    buffer_load_dword v41, v179, s[8:11], s66 offen offset:8
    v_mad_u32_u24 v51, v51, s58, v202
    v_and_b32 v7, 0xffffff, v7
    s_mov_b64 exec, s[44:45]
    s_cbranch_execz K2_RK_B
    v_lshrrev_b32 v52, 24, v11
    buffer_load_dword v42, v179, s[8:11], s66 offen offset:16
    v_mad_u32_u24 v52, v52, s58, v202
    v_and_b32 v11, 0xffffff, v11
    s_mov_b64 exec, s[46:47]
    s_cbranch_execz K2_RK_B
    v_lshrrev_b32 v53, 24, v15
    buffer_load_dword v43, v179, s[8:11], s66 offen offset:24
    v_mad_u32_u24 v53, v53, s58, v202
    v_and_b32 v15, 0xffffff, v15
    s_mov_b64 exec, s[48:49]
    s_cbranch_execz K2_RK_B
    v_lshrrev_b32 v54, 24, v19
    buffer_load_dword v44, v179, s[8:11], s66 offen offset:32
    v_mad_u32_u24 v54, v54, s58, v202
    v_and_b32 v19, 0xffffff, v19
    s_mov_b64 exec, s[50:51]
    s_cbranch_execz K2_RK_B
    v_lshrrev_b32 v55, 24, v23
    buffer_load_dword v45, v179, s[8:11], s66 offen offset:40
    v_mad_u32_u24 v55, v55, s58, v202
    v_and_b32 v23, 0xffffff, v23
    s_mov_b64 exec, s[90:91]
    s_cbranch_execz K2_RK_B
    v_lshrrev_b32 v56, 24, v27
    buffer_load_dword v46, v179, s[8:11], s66 offen offset:48
    v_mad_u32_u24 v56, v56, s58, v202
    v_and_b32 v27, 0xffffff, v27
    s_mov_b64 exec, s[92:93]
    s_cbranch_execz K2_RK_B
    v_lshrrev_b32 v57, 24, v31
    buffer_load_dword v47, v179, s[8:11], s66 offen offset:56
    v_mad_u32_u24 v57, v57, s58, v202
    v_and_b32 v31, 0xffffff, v31
    s_mov_b64 exec, s[94:95]
    s_cbranch_execz K2_RK_B
    v_lshrrev_b32 v58, 24, v35
    buffer_load_dword v48, v179, s[8:11], s66 offen offset:64
    v_mad_u32_u24 v58, v58, s58, v202
    v_and_b32 v35, 0xffffff, v35
    s_mov_b64 exec, s[96:97]
    s_cbranch_execz K2_RK_B
    v_lshrrev_b32 v59, 24, v39
    buffer_load_dword v49, v179, s[8:11], s66 offen offset:72
    v_mad_u32_u24 v59, v59, s58, v202
    v_and_b32 v39, 0xffffff, v39
K2_RK_B:
    s_mov_b64 exec, -1
    s_mul_i32 s62, s24, 48
    s_waitcnt vmcnt(0)
    v_subrev_u32 v40, s62, v40
    v_subrev_u32 v41, s62, v41
    v_subrev_u32 v42, s62, v42
    v_subrev_u32 v43, s62, v43
    v_subrev_u32 v44, s62, v44
    v_subrev_u32 v45, s62, v45
    v_subrev_u32 v46, s62, v46
    v_subrev_u32 v47, s62, v47
    v_subrev_u32 v48, s62, v48
    v_subrev_u32 v49, s62, v49
    s_branch K2_RK_DONE
K2_OV0:
    s_cmp_lg_u32 s24, 0
    s_cbranch_scc1 K2_OB0
    s_andn2_b64 exec, s[40:41], exec
    v_cmp_gt_u32 vcc, 64, v40
    s_nop 0
    s_mov_b64 exec, vcc
    s_cbranch_execz K2_OB0
    v_subrev_u32 v192, 48, v40
    v_mov_b32 v197, 163656
    v_mov_b32 v198, 0
    s_mov_b64 s[56:57], 0
    s_mov_b32 s62, 0
    s_cmp_eq_u32 s22, 39
    s_cselect_b32 s63, 5, 2
K2_OP0:
    ds_cmpst_rtn_b32 v200, v197, v198, v50
    s_cmp_ge_u32 s62, 2
    s_cselect_b32 s65, 159136, 0
    s_cselect_b32 s26, 32, 0
    s_cbranch_scc1 K2_OQ0
    s_mov_b32 s65, 161536
K2_OQ0:
    s_lshl_b32 s61, s62, 4
    s_sub_u32 s61, s61, s26
    v_mov_b32 v199, s65
    v_add_u32 v203, s61, v192
    s_waitcnt lgkmcnt(0)
    v_cmp_eq_u32 vcc, 0, v200
    v_cmp_eq_u32 s[56:57], v200, v50
    s_nop 0
    s_or_b64 vcc, vcc, s[56:57]
    s_andn2_b64 s[56:57], exec, vcc
    s_mov_b64 exec, vcc
    v_lshl_add_u32 v194, v203, 5, v199
    v_lshl_add_u32 v195, v203, 2, v199
    v_lshrrev_b32 v193, 3, v203
    v_mad_i32_i24 v196, v193, -16, v195
    v_and_b32 v193, 1, v193
    v_mad_i32_i24 v196, v193, -14, v196
    ds_write_b32 v194, v3 offset:864
    ds_write_b16 v195, v0 offset:194
    ds_write_b16_d16_hi v195, v0 offset:386
    ds_write_b16_d16_hi v195, v1 offset:578
    ds_write_b16 v196, v2 offset:768
    s_mov_b64 exec, s[56:57]
    s_cbranch_execz K2_OB0
    v_add_u32 v197, 4, v197
    s_add_u32 s62, s62, 1
    s_cmp_lt_u32 s62, s63
    s_cbranch_scc1 K2_OP0
    s_branch K2_OB0
K2_OV1:
    s_cmp_lg_u32 s24, 0
    s_cbranch_scc1 K2_OB1
    s_andn2_b64 exec, s[42:43], exec
    v_cmp_gt_u32 vcc, 64, v41
    s_nop 0
    s_mov_b64 exec, vcc
    s_cbranch_execz K2_OB1
    v_subrev_u32 v192, 48, v41
    v_mov_b32 v197, 163656
    v_mov_b32 v198, 0
    s_mov_b64 s[56:57], 0
    s_mov_b32 s62, 0
    s_cmp_eq_u32 s22, 39
    s_cselect_b32 s63, 5, 2
K2_OP1:
    ds_cmpst_rtn_b32 v200, v197, v198, v51
    s_cmp_ge_u32 s62, 2
    s_cselect_b32 s65, 159136, 0
    s_cselect_b32 s26, 32, 0
    s_cbranch_scc1 K2_OQ1
    s_mov_b32 s65, 161536
K2_OQ1:
    s_lshl_b32 s61, s62, 4
    s_sub_u32 s61, s61, s26
    v_mov_b32 v199, s65
    v_add_u32 v203, s61, v192
    s_waitcnt lgkmcnt(0)
    v_cmp_eq_u32 vcc, 0, v200
    v_cmp_eq_u32 s[56:57], v200, v51
    s_nop 0
    s_or_b64 vcc, vcc, s[56:57]
    s_andn2_b64 s[56:57], exec, vcc
    s_mov_b64 exec, vcc
    v_lshl_add_u32 v194, v203, 5, v199
    v_lshl_add_u32 v195, v203, 2, v199
    v_lshrrev_b32 v193, 3, v203
    v_mad_i32_i24 v196, v193, -16, v195
    v_and_b32 v193, 1, v193
    v_mad_i32_i24 v196, v193, -14, v196
    ds_write_b32 v194, v7 offset:864
    ds_write_b16 v195, v4 offset:194
    ds_write_b16_d16_hi v195, v4 offset:386
    ds_write_b16_d16_hi v195, v5 offset:578
    ds_write_b16 v196, v6 offset:768
    s_mov_b64 exec, s[56:57]
    s_cbranch_execz K2_OB1
    v_add_u32 v197, 4, v197
    s_add_u32 s62, s62, 1
    s_cmp_lt_u32 s62, s63
    s_cbranch_scc1 K2_OP1
    s_branch K2_OB1
K2_OV2:
    s_cmp_lg_u32 s24, 0
    s_cbranch_scc1 K2_OB2
    s_andn2_b64 exec, s[44:45], exec
    v_cmp_gt_u32 vcc, 64, v42
    s_nop 0
    s_mov_b64 exec, vcc
    s_cbranch_execz K2_OB2
    v_subrev_u32 v192, 48, v42
    v_mov_b32 v197, 163656
    v_mov_b32 v198, 0
    s_mov_b64 s[56:57], 0
    s_mov_b32 s62, 0
    s_cmp_eq_u32 s22, 39
    s_cselect_b32 s63, 5, 2
K2_OP2:
    ds_cmpst_rtn_b32 v200, v197, v198, v52
    s_cmp_ge_u32 s62, 2
    s_cselect_b32 s65, 159136, 0
    s_cselect_b32 s26, 32, 0
    s_cbranch_scc1 K2_OQ2
    s_mov_b32 s65, 161536
K2_OQ2:
    s_lshl_b32 s61, s62, 4
    s_sub_u32 s61, s61, s26
    v_mov_b32 v199, s65
    v_add_u32 v203, s61, v192
    s_waitcnt lgkmcnt(0)
    v_cmp_eq_u32 vcc, 0, v200
    v_cmp_eq_u32 s[56:57], v200, v52
    s_nop 0
    s_or_b64 vcc, vcc, s[56:57]
    s_andn2_b64 s[56:57], exec, vcc
    s_mov_b64 exec, vcc
    v_lshl_add_u32 v194, v203, 5, v199
    v_lshl_add_u32 v195, v203, 2, v199
    v_lshrrev_b32 v193, 3, v203
    v_mad_i32_i24 v196, v193, -16, v195
    v_and_b32 v193, 1, v193
    v_mad_i32_i24 v196, v193, -14, v196
    ds_write_b32 v194, v11 offset:864
    ds_write_b16 v195, v8 offset:194
    ds_write_b16_d16_hi v195, v8 offset:386
    ds_write_b16_d16_hi v195, v9 offset:578
    ds_write_b16 v196, v10 offset:768
    s_mov_b64 exec, s[56:57]
    s_cbranch_execz K2_OB2
    v_add_u32 v197, 4, v197
    s_add_u32 s62, s62, 1
    s_cmp_lt_u32 s62, s63
    s_cbranch_scc1 K2_OP2
    s_branch K2_OB2
K2_OV3:
    s_cmp_lg_u32 s24, 0
    s_cbranch_scc1 K2_OB3
    s_andn2_b64 exec, s[46:47], exec
    v_cmp_gt_u32 vcc, 64, v43
    s_nop 0
    s_mov_b64 exec, vcc
    s_cbranch_execz K2_OB3
    v_subrev_u32 v192, 48, v43
    v_mov_b32 v197, 163656
    v_mov_b32 v198, 0
    s_mov_b64 s[56:57], 0
    s_mov_b32 s62, 0
    s_cmp_eq_u32 s22, 39
    s_cselect_b32 s63, 5, 2
K2_OP3:
    ds_cmpst_rtn_b32 v200, v197, v198, v53
    s_cmp_ge_u32 s62, 2
    s_cselect_b32 s65, 159136, 0
    s_cselect_b32 s26, 32, 0
    s_cbranch_scc1 K2_OQ3
    s_mov_b32 s65, 161536
K2_OQ3:
    s_lshl_b32 s61, s62, 4
    s_sub_u32 s61, s61, s26
    v_mov_b32 v199, s65
    v_add_u32 v203, s61, v192
    s_waitcnt lgkmcnt(0)
    v_cmp_eq_u32 vcc, 0, v200
    v_cmp_eq_u32 s[56:57], v200, v53
    s_nop 0
    s_or_b64 vcc, vcc, s[56:57]
    s_andn2_b64 s[56:57], exec, vcc
    s_mov_b64 exec, vcc
    v_lshl_add_u32 v194, v203, 5, v199
    v_lshl_add_u32 v195, v203, 2, v199
    v_lshrrev_b32 v193, 3, v203
    v_mad_i32_i24 v196, v193, -16, v195
    v_and_b32 v193, 1, v193
    v_mad_i32_i24 v196, v193, -14, v196
    ds_write_b32 v194, v15 offset:864
    ds_write_b16 v195, v12 offset:194
    ds_write_b16_d16_hi v195, v12 offset:386
    ds_write_b16_d16_hi v195, v13 offset:578
    ds_write_b16 v196, v14 offset:768
    s_mov_b64 exec, s[56:57]
    s_cbranch_execz K2_OB3
    v_add_u32 v197, 4, v197
    s_add_u32 s62, s62, 1
    s_cmp_lt_u32 s62, s63
    s_cbranch_scc1 K2_OP3
    s_branch K2_OB3
K2_OV4:
    s_cmp_lg_u32 s24, 0
    s_cbranch_scc1 K2_OB4
    s_andn2_b64 exec, s[48:49], exec
    v_cmp_gt_u32 vcc, 64, v44
    s_nop 0
    s_mov_b64 exec, vcc
    s_cbranch_execz K2_OB4
    v_subrev_u32 v192, 48, v44
    v_mov_b32 v197, 163656
    v_mov_b32 v198, 0
    s_mov_b64 s[56:57], 0
    s_mov_b32 s62, 0
    s_cmp_eq_u32 s22, 39
    s_cselect_b32 s63, 5, 2
K2_OP4:
    ds_cmpst_rtn_b32 v200, v197, v198, v54
    s_cmp_ge_u32 s62, 2
    s_cselect_b32 s65, 159136, 0
    s_cselect_b32 s26, 32, 0
    s_cbranch_scc1 K2_OQ4
    s_mov_b32 s65, 161536
K2_OQ4:
    s_lshl_b32 s61, s62, 4
    s_sub_u32 s61, s61, s26
    v_mov_b32 v199, s65
    v_add_u32 v203, s61, v192
    s_waitcnt lgkmcnt(0)
    v_cmp_eq_u32 vcc, 0, v200
    v_cmp_eq_u32 s[56:57], v200, v54
    s_nop 0
    s_or_b64 vcc, vcc, s[56:57]
    s_andn2_b64 s[56:57], exec, vcc
    s_mov_b64 exec, vcc
    v_lshl_add_u32 v194, v203, 5, v199
    v_lshl_add_u32 v195, v203, 2, v199
    v_lshrrev_b32 v193, 3, v203
    v_mad_i32_i24 v196, v193, -16, v195
    v_and_b32 v193, 1, v193
    v_mad_i32_i24 v196, v193, -14, v196
    ds_write_b32 v194, v19 offset:864
    ds_write_b16 v195, v16 offset:194
    ds_write_b16_d16_hi v195, v16 offset:386
    ds_write_b16_d16_hi v195, v17 offset:578
    ds_write_b16 v196, v18 offset:768
    s_mov_b64 exec, s[56:57]
    s_cbranch_execz K2_OB4
    v_add_u32 v197, 4, v197
    s_add_u32 s62, s62, 1
    s_cmp_lt_u32 s62, s63
    s_cbranch_scc1 K2_OP4
    s_branch K2_OB4
K2_OV5:
    s_cmp_lg_u32 s24, 0
    s_cbranch_scc1 K2_OB5
    s_andn2_b64 exec, s[50:51], exec
    v_cmp_gt_u32 vcc, 64, v45
    s_nop 0
    s_mov_b64 exec, vcc
    s_cbranch_execz K2_OB5
    v_subrev_u32 v192, 48, v45
    v_mov_b32 v197, 163656
    v_mov_b32 v198, 0
    s_mov_b64 s[56:57], 0
    s_mov_b32 s62, 0
    s_cmp_eq_u32 s22, 39
    s_cselect_b32 s63, 5, 2
K2_OP5:
    ds_cmpst_rtn_b32 v200, v197, v198, v55
    s_cmp_ge_u32 s62, 2
    s_cselect_b32 s65, 159136, 0
    s_cselect_b32 s26, 32, 0
    s_cbranch_scc1 K2_OQ5
    s_mov_b32 s65, 161536
K2_OQ5:
    s_lshl_b32 s61, s62, 4
    s_sub_u32 s61, s61, s26
    v_mov_b32 v199, s65
    v_add_u32 v203, s61, v192
    s_waitcnt lgkmcnt(0)
    v_cmp_eq_u32 vcc, 0, v200
    v_cmp_eq_u32 s[56:57], v200, v55
    s_nop 0
    s_or_b64 vcc, vcc, s[56:57]
    s_andn2_b64 s[56:57], exec, vcc
    s_mov_b64 exec, vcc
    v_lshl_add_u32 v194, v203, 5, v199
    v_lshl_add_u32 v195, v203, 2, v199
    v_lshrrev_b32 v193, 3, v203
    v_mad_i32_i24 v196, v193, -16, v195
    v_and_b32 v193, 1, v193
    v_mad_i32_i24 v196, v193, -14, v196
    ds_write_b32 v194, v23 offset:864
    ds_write_b16 v195, v20 offset:194
    ds_write_b16_d16_hi v195, v20 offset:386
    ds_write_b16_d16_hi v195, v21 offset:578
    ds_write_b16 v196, v22 offset:768
    s_mov_b64 exec, s[56:57]
    s_cbranch_execz K2_OB5
    v_add_u32 v197, 4, v197
    s_add_u32 s62, s62, 1
    s_cmp_lt_u32 s62, s63
    s_cbranch_scc1 K2_OP5
    s_branch K2_OB5
K2_OV6:
    s_cmp_lg_u32 s24, 0
    s_cbranch_scc1 K2_OB6
    s_andn2_b64 exec, s[90:91], exec
    v_cmp_gt_u32 vcc, 64, v46
    s_nop 0
    s_mov_b64 exec, vcc
    s_cbranch_execz K2_OB6
    v_subrev_u32 v192, 48, v46
    v_mov_b32 v197, 163656
    v_mov_b32 v198, 0
    s_mov_b64 s[56:57], 0
    s_mov_b32 s62, 0
    s_cmp_eq_u32 s22, 39
    s_cselect_b32 s63, 5, 2
K2_OP6:
    ds_cmpst_rtn_b32 v200, v197, v198, v56
    s_cmp_ge_u32 s62, 2
    s_cselect_b32 s65, 159136, 0
    s_cselect_b32 s26, 32, 0
    s_cbranch_scc1 K2_OQ6
    s_mov_b32 s65, 161536
K2_OQ6:
    s_lshl_b32 s61, s62, 4
    s_sub_u32 s61, s61, s26
    v_mov_b32 v199, s65
    v_add_u32 v203, s61, v192
    s_waitcnt lgkmcnt(0)
    v_cmp_eq_u32 vcc, 0, v200
    v_cmp_eq_u32 s[56:57], v200, v56
    s_nop 0
    s_or_b64 vcc, vcc, s[56:57]
    s_andn2_b64 s[56:57], exec, vcc
    s_mov_b64 exec, vcc
    v_lshl_add_u32 v194, v203, 5, v199
    v_lshl_add_u32 v195, v203, 2, v199
    v_lshrrev_b32 v193, 3, v203
    v_mad_i32_i24 v196, v193, -16, v195
    v_and_b32 v193, 1, v193
    v_mad_i32_i24 v196, v193, -14, v196
    ds_write_b32 v194, v27 offset:864
    ds_write_b16 v195, v24 offset:194
    ds_write_b16_d16_hi v195, v24 offset:386
    ds_write_b16_d16_hi v195, v25 offset:578
    ds_write_b16 v196, v26 offset:768
    s_mov_b64 exec, s[56:57]
    s_cbranch_execz K2_OB6
    v_add_u32 v197, 4, v197
    s_add_u32 s62, s62, 1
    s_cmp_lt_u32 s62, s63
    s_cbranch_scc1 K2_OP6
    s_branch K2_OB6
K2_OV7:
    s_cmp_lg_u32 s24, 0
    s_cbranch_scc1 K2_OB7
    s_andn2_b64 exec, s[92:93], exec
    v_cmp_gt_u32 vcc, 64, v47
    s_nop 0
    s_mov_b64 exec, vcc
    s_cbranch_execz K2_OB7
    v_subrev_u32 v192, 48, v47
    v_mov_b32 v197, 163656
    v_mov_b32 v198, 0
    s_mov_b64 s[56:57], 0
    s_mov_b32 s62, 0
    s_cmp_eq_u32 s22, 39
    s_cselect_b32 s63, 5, 2
K2_OP7:
    ds_cmpst_rtn_b32 v200, v197, v198, v57
    s_cmp_ge_u32 s62, 2
    s_cselect_b32 s65, 159136, 0
    s_cselect_b32 s26, 32, 0
    s_cbranch_scc1 K2_OQ7
    s_mov_b32 s65, 161536
K2_OQ7:
    s_lshl_b32 s61, s62, 4
    s_sub_u32 s61, s61, s26
    v_mov_b32 v199, s65
    v_add_u32 v203, s61, v192
    s_waitcnt lgkmcnt(0)
    v_cmp_eq_u32 vcc, 0, v200
    v_cmp_eq_u32 s[56:57], v200, v57
    s_nop 0
    s_or_b64 vcc, vcc, s[56:57]
    s_andn2_b64 s[56:57], exec, vcc
    s_mov_b64 exec, vcc
    v_lshl_add_u32 v194, v203, 5, v199
    v_lshl_add_u32 v195, v203, 2, v199
    v_lshrrev_b32 v193, 3, v203
    v_mad_i32_i24 v196, v193, -16, v195
    v_and_b32 v193, 1, v193
    v_mad_i32_i24 v196, v193, -14, v196
    ds_write_b32 v194, v31 offset:864
    ds_write_b16 v195, v28 offset:194
    ds_write_b16_d16_hi v195, v28 offset:386
    ds_write_b16_d16_hi v195, v29 offset:578
    ds_write_b16 v196, v30 offset:768
    s_mov_b64 exec, s[56:57]
    s_cbranch_execz K2_OB7
    v_add_u32 v197, 4, v197
    s_add_u32 s62, s62, 1
    s_cmp_lt_u32 s62, s63
    s_cbranch_scc1 K2_OP7
    s_branch K2_OB7
K2_OV8:
    s_cmp_lg_u32 s24, 0
    s_cbranch_scc1 K2_OB8
    s_andn2_b64 exec, s[94:95], exec
    v_cmp_gt_u32 vcc, 64, v48
    s_nop 0
    s_mov_b64 exec, vcc
    s_cbranch_execz K2_OB8
    v_subrev_u32 v192, 48, v48
    v_mov_b32 v197, 163656
    v_mov_b32 v198, 0
    s_mov_b64 s[56:57], 0
    s_mov_b32 s62, 0
    s_cmp_eq_u32 s22, 39
    s_cselect_b32 s63, 5, 2
K2_OP8:
    ds_cmpst_rtn_b32 v200, v197, v198, v58
    s_cmp_ge_u32 s62, 2
    s_cselect_b32 s65, 159136, 0
    s_cselect_b32 s26, 32, 0
    s_cbranch_scc1 K2_OQ8
    s_mov_b32 s65, 161536
K2_OQ8:
    s_lshl_b32 s61, s62, 4
    s_sub_u32 s61, s61, s26
    v_mov_b32 v199, s65
    v_add_u32 v203, s61, v192
    s_waitcnt lgkmcnt(0)
    v_cmp_eq_u32 vcc, 0, v200
    v_cmp_eq_u32 s[56:57], v200, v58
    s_nop 0
    s_or_b64 vcc, vcc, s[56:57]
    s_andn2_b64 s[56:57], exec, vcc
    s_mov_b64 exec, vcc
    v_lshl_add_u32 v194, v203, 5, v199
    v_lshl_add_u32 v195, v203, 2, v199
    v_lshrrev_b32 v193, 3, v203
    v_mad_i32_i24 v196, v193, -16, v195
    v_and_b32 v193, 1, v193
    v_mad_i32_i24 v196, v193, -14, v196
    ds_write_b32 v194, v35 offset:864
    ds_write_b16 v195, v32 offset:194
    ds_write_b16_d16_hi v195, v32 offset:386
    ds_write_b16_d16_hi v195, v33 offset:578
    ds_write_b16 v196, v34 offset:768
    s_mov_b64 exec, s[56:57]
    s_cbranch_execz K2_OB8
    v_add_u32 v197, 4, v197
    s_add_u32 s62, s62, 1
    s_cmp_lt_u32 s62, s63
    s_cbranch_scc1 K2_OP8
    s_branch K2_OB8
K2_OV9:
    s_cmp_lg_u32 s24, 0
    s_cbranch_scc1 K2_OB9
    s_andn2_b64 exec, s[96:97], exec
    v_cmp_gt_u32 vcc, 64, v49
    s_nop 0
    s_mov_b64 exec, vcc
    s_cbranch_execz K2_OB9
    v_subrev_u32 v192, 48, v49
    v_mov_b32 v197, 163656
    v_mov_b32 v198, 0
    s_mov_b64 s[56:57], 0
    s_mov_b32 s62, 0
    s_cmp_eq_u32 s22, 39
    s_cselect_b32 s63, 5, 2
K2_OP9:
    ds_cmpst_rtn_b32 v200, v197, v198, v59
    s_cmp_ge_u32 s62, 2
    s_cselect_b32 s65, 159136, 0
    s_cselect_b32 s26, 32, 0
    s_cbranch_scc1 K2_OQ9
    s_mov_b32 s65, 161536
K2_OQ9:
    s_lshl_b32 s61, s62, 4
    s_sub_u32 s61, s61, s26
    v_mov_b32 v199, s65
    v_add_u32 v203, s61, v192
    s_waitcnt lgkmcnt(0)
    v_cmp_eq_u32 vcc, 0, v200
    v_cmp_eq_u32 s[56:57], v200, v59
    s_nop 0
    s_or_b64 vcc, vcc, s[56:57]
    s_andn2_b64 s[56:57], exec, vcc
    s_mov_b64 exec, vcc
    v_lshl_add_u32 v194, v203, 5, v199
    v_lshl_add_u32 v195, v203, 2, v199
    v_lshrrev_b32 v193, 3, v203
    v_mad_i32_i24 v196, v193, -16, v195
    v_and_b32 v193, 1, v193
    v_mad_i32_i24 v196, v193, -14, v196
    ds_write_b32 v194, v39 offset:864
    ds_write_b16 v195, v36 offset:194
    ds_write_b16_d16_hi v195, v36 offset:386
    ds_write_b16_d16_hi v195, v37 offset:578
    ds_write_b16 v196, v38 offset:768
    s_mov_b64 exec, s[56:57]
    s_cbranch_execz K2_OB9
    v_add_u32 v197, 4, v197
    s_add_u32 s62, s62, 1
    s_cmp_lt_u32 s62, s63
    s_cbranch_scc1 K2_OP9
    s_branch K2_OB9
K2_BIG:
    s_cmp_lg_u32 s24, 0
    s_cbranch_scc1 K2_TOK
    s_mov_b64 s[62:63], vcc
    s_bcnt1_i32_b64 s60, vcc
    s_cmp_eq_u32 s22, 39
    s_cselect_b32 s61, 5, 2
    s_cmp_gt_u32 s60, s61
    s_cbranch_scc1 K2_SLOW
    v_cmp_lt_u32 vcc, 64, v193
    s_nop 0
    s_cbranch_vccnz K2_SLOW
    v_mov_b32 v197, 163656
    ds_read_b32 v203, v197
    ds_read_b32 v204, v197 offset:4
    ds_read_b32 v205, v197 offset:8
    ds_read_b32 v206, v197 offset:12
    ds_read_b32 v207, v197 offset:16
    v_and_b32 v197, 0x3ffff, v195
    s_movk_i32 s26, 64
    s_waitcnt lgkmcnt(0)
    v_cmp_eq_u32 vcc, v204, v197
    v_mov_b32 v194, 134217728
    s_nop 0
    v_cndmask_b32 v198, v198, v194, vcc
    v_cmp_eq_u32 vcc, v205, v197
    v_mov_b32 v194, 268435456
    s_nop 0
    v_cndmask_b32 v198, v198, v194, vcc
    v_cmp_eq_u32 vcc, v206, v197
    v_mov_b32 v194, 402653184
    s_nop 0
    v_cndmask_b32 v198, v198, v194, vcc
    v_cmp_eq_u32 vcc, v207, v197
    v_mov_b32 v194, 536870912
    s_nop 0
    v_cndmask_b32 v198, v198, v194, vcc
    s_branch K2_TOK
K2_SLOW:
    v_mov_b32 v197, v193
    s_nop 1
    v_max_u32_dpp v197, v197, v197 row_shr:1 row_mask:0xf bank_mask:0xf bound_ctrl:0
    s_nop 1
    v_max_u32_dpp v197, v197, v197 row_shr:2 row_mask:0xf bank_mask:0xf bound_ctrl:0
    s_nop 1
    v_max_u32_dpp v197, v197, v197 row_shr:4 row_mask:0xf bank_mask:0xf bound_ctrl:0
    s_nop 1
    v_max_u32_dpp v197, v197, v197 row_shr:8 row_mask:0xf bank_mask:0xf bound_ctrl:0
    s_nop 1
    v_max_u32_dpp v197, v197, v197 row_bcast:15 row_mask:0xa bank_mask:0xf
    s_nop 1
    v_max_u32_dpp v197, v197, v197 row_bcast:31 row_mask:0xc bank_mask:0xf
    s_nop 0
    v_readlane_b32 s25, v197, 63
    s_nop 0
    s_add_u32 s25, s25, 47
    s_mul_i32 s25, s25, 43691
    s_lshr_b32 s25, s25, 21
    v_cmp_lt_i32 vcc, 0, v180
    s_nop 0
    s_cbranch_vccz K2_SV_DONE
    s_mov_b64 exec, vcc
    buffer_store_dword v40, v179, s[8:11], s66 offen offset:0
    v_cmp_lt_i32 vcc, 2, v180
    s_nop 0
    s_cbranch_vccz K2_SV_DONE
    s_mov_b64 exec, vcc
    buffer_store_dword v41, v179, s[8:11], s66 offen offset:8
    v_cmp_lt_i32 vcc, 4, v180
    s_nop 0
    s_cbranch_vccz K2_SV_DONE
    s_mov_b64 exec, vcc
    buffer_store_dword v42, v179, s[8:11], s66 offen offset:16
    v_cmp_lt_i32 vcc, 6, v180
    s_nop 0
    s_cbranch_vccz K2_SV_DONE
    s_mov_b64 exec, vcc
    buffer_store_dword v43, v179, s[8:11], s66 offen offset:24
    v_cmp_lt_i32 vcc, 8, v180
    s_nop 0
    s_cbranch_vccz K2_SV_DONE
    s_mov_b64 exec, vcc
    buffer_store_dword v44, v179, s[8:11], s66 offen offset:32
    v_cmp_lt_i32 vcc, 10, v180
    s_nop 0
    s_cbranch_vccz K2_SV_DONE
    s_mov_b64 exec, vcc
    buffer_store_dword v45, v179, s[8:11], s66 offen offset:40
    v_cmp_lt_i32 vcc, 12, v180
    s_nop 0
    s_cbranch_vccz K2_SV_DONE
    s_mov_b64 exec, vcc
    buffer_store_dword v46, v179, s[8:11], s66 offen offset:48
    v_cmp_lt_i32 vcc, 14, v180
    s_nop 0
    s_cbranch_vccz K2_SV_DONE
    s_mov_b64 exec, vcc
    buffer_store_dword v47, v179, s[8:11], s66 offen offset:56
    v_cmp_lt_i32 vcc, 16, v180
    s_nop 0
    s_cbranch_vccz K2_SV_DONE
    s_mov_b64 exec, vcc
    buffer_store_dword v48, v179, s[8:11], s66 offen offset:64
    v_cmp_lt_i32 vcc, 18, v180
    s_nop 0
    s_cbranch_vccz K2_SV_DONE
    s_mov_b64 exec, vcc
    buffer_store_dword v49, v179, s[8:11], s66 offen offset:72
K2_SV_DONE:
    s_mov_b64 exec, -1
    s_branch K2_TOK
K2_rare_1:
    s_cmp_eq_u32 s33, 4
    s_cbranch_scc1 K2_four_3
    s_mov_b32 s49, s48
    s_mov_b32 s51, s48
    s_add_u32 s45, s44, 256
    s_add_u32 s46, s44, 512
    s_add_u32 s47, s44, 768
    s_branch K2_back_2
K2_four_3:
    s_add_u32 s50, s48, 64
    s_lshr_b32 s51, s3, 27
    s_mov_b32 s66, 161536
    s_cmp_ge_u32 s51, 2
    s_cselect_b32 s66, 159072, s66
    s_mul_i32 s51, s51, 32
    s_add_u32 s51, s51, s66
    s_mov_b32 s46, s44
    s_mov_b32 s47, s44
    s_branch K2_back_2
K2_dum_4:
    v_mov_b32 v232, -1
    s_mov_b32 m0, 163712
    s_mov_b64 exec, 1
    buffer_load_dwordx4 v232, s[16:19], 0 offen lds
    buffer_load_dwordx4 v232, s[16:19], 0 offen lds
    s_mov_b64 exec, -1
    s_branch K2_back_6
K2_a4_5:
    s_lshr_b32 s65, s3, 27
    s_mov_b32 s66, 161536
    s_cmp_ge_u32 s65, 2
    s_cselect_b32 s66, 158112, s66
    s_mul_i32 s65, s65, 512
    s_add_u32 s65, s65, s66
    v_add_u32 v232, s65, v230
    ds_read_b32 v232, v232
    s_add_u32 m0, s65, 864
    s_waitcnt lgkmcnt(0)
    v_or_b32 v232, v232, v231
    buffer_load_dwordx4 v232, s[16:19], 0 offen  lds
    s_branch K2_b4_7
K2_nul_10:
    s_mov_b32 s58, 63
    s_mov_b32 s36, 0
    s_branch K2_back_13
K2_spin_11:
    v_lshl_add_u32 v233, v252, 1, s53
    ds_read_b32 v233, v233
    s_waitcnt lgkmcnt(0)
    s_branch K2_chk_12
K2_dyn_8:
    v_mov_b32 v254, 163648
    v_mov_b32 v255, 1
    v_lshl_add_u32 v233, v252, 1, s53
    s_mov_b64 exec, 1
    ds_add_rtn_u32 v232, v254, v255
    s_mov_b64 exec, -1
    ds_read_b32 v233, v233
    s_waitcnt lgkmcnt(0)
    v_readfirstlane_b32 s58, v232
    s_nop 0
    s_cmp_lt_u32 s58, s22
    s_cbranch_scc0 K2_nul_10
    s_and_b32 s59, s58, 7
    s_lshr_b32 s60, s58, 3
K2_chk_12:
    v_readlane_b32 s61, v233, s59
    s_nop 0
    s_cmp_gt_u32 s61, s60
    s_cbranch_scc0 K2_spin_11
K2_back_13:
    s_mov_b32 s34, 1
    s_branch K2_back_9
K2_rare_14:
    s_cmp_eq_u32 s33, 4
    s_cbranch_scc1 K2_four_16
    s_mov_b32 s49, s48
    s_mov_b32 s51, s48
    s_add_u32 s45, s44, 256
    s_add_u32 s46, s44, 512
    s_add_u32 s47, s44, 768
    s_branch K2_back_15
K2_four_16:
    s_add_u32 s50, s48, 64
    s_lshr_b32 s51, s3, 27
    s_mov_b32 s66, 161536
    s_cmp_ge_u32 s51, 2
    s_cselect_b32 s66, 159072, s66
    s_mul_i32 s51, s51, 32
    s_add_u32 s51, s51, s66
    s_mov_b32 s46, s44
    s_mov_b32 s47, s44
    s_branch K2_back_15
K2_dum_17:
    v_mov_b32 v232, -1
    s_mov_b32 m0, 163712
    s_mov_b64 exec, 1
    buffer_load_dwordx4 v232, s[16:19], 0 offen lds
    buffer_load_dwordx4 v232, s[16:19], 0 offen lds
    s_mov_b64 exec, -1
    s_branch K2_back_19
K2_a4_18:
    s_lshr_b32 s65, s3, 27
    s_mov_b32 s66, 161536
    s_cmp_ge_u32 s65, 2
    s_cselect_b32 s66, 158112, s66
    s_mul_i32 s65, s65, 512
    s_add_u32 s65, s65, s66
    v_add_u32 v232, s65, v230
    ds_read_b32 v232, v232
    s_add_u32 m0, s65, 864
    s_waitcnt lgkmcnt(0)
    v_or_b32 v232, v232, v231
    buffer_load_dwordx4 v232, s[16:19], 0 offen  lds
    s_branch K2_b4_20
K2_nul_23:
    s_mov_b32 s58, 63
    s_mov_b32 s36, 0
    s_branch K2_back_26
K2_spin_24:
    v_lshl_add_u32 v233, v252, 1, s53
    ds_read_b32 v233, v233
    s_waitcnt lgkmcnt(0)
    s_branch K2_chk_25
K2_dyn_21:
    v_mov_b32 v254, 163648
    v_mov_b32 v255, 1
    v_lshl_add_u32 v233, v252, 1, s53
    s_mov_b64 exec, 1
    ds_add_rtn_u32 v232, v254, v255
    s_mov_b64 exec, -1
    ds_read_b32 v233, v233
    s_waitcnt lgkmcnt(0)
    v_readfirstlane_b32 s58, v232
    s_nop 0
    s_cmp_lt_u32 s58, s22
    s_cbranch_scc0 K2_nul_23
    s_and_b32 s59, s58, 7
    s_lshr_b32 s60, s58, 3
K2_chk_25:
    v_readlane_b32 s61, v233, s59
    s_nop 0
    s_cmp_gt_u32 s61, s60
    s_cbranch_scc0 K2_spin_24
K2_back_26:
    s_mov_b32 s34, 1
    s_branch K2_back_22
K2_rare_27:
    s_cmp_eq_u32 s33, 4
    s_cbranch_scc1 K2_four_29
    s_mov_b32 s49, s48
    s_mov_b32 s51, s48
    s_add_u32 s45, s44, 256
    s_add_u32 s46, s44, 512
    s_add_u32 s47, s44, 768
    s_branch K2_back_28
K2_four_29:
    s_add_u32 s50, s48, 64
    s_lshr_b32 s51, s3, 27
    s_mov_b32 s66, 161536
    s_cmp_ge_u32 s51, 2
    s_cselect_b32 s66, 159072, s66
    s_mul_i32 s51, s51, 32
    s_add_u32 s51, s51, s66
    s_mov_b32 s46, s44
    s_mov_b32 s47, s44
    s_branch K2_back_28
K2_dum_30:
    v_mov_b32 v232, -1
    s_mov_b32 m0, 163712
    s_mov_b64 exec, 1
    buffer_load_dwordx4 v232, s[16:19], 0 offen lds
    buffer_load_dwordx4 v232, s[16:19], 0 offen lds
    s_mov_b64 exec, -1
    s_branch K2_back_32
K2_a4_31:
    s_lshr_b32 s65, s3, 27
    s_mov_b32 s66, 161536
    s_cmp_ge_u32 s65, 2
    s_cselect_b32 s66, 158112, s66
    s_mul_i32 s65, s65, 512
    s_add_u32 s65, s65, s66
    v_add_u32 v232, s65, v230
    ds_read_b32 v232, v232
    s_add_u32 m0, s65, 864
    s_waitcnt lgkmcnt(0)
    v_or_b32 v232, v232, v231
    buffer_load_dwordx4 v232, s[16:19], 0 offen  lds
    s_branch K2_b4_33
K2_nul_34:
    s_mov_b32 s58, 63
    s_mov_b32 s36, 0
    s_branch K2_back_37
K2_spin_35:
    v_lshl_add_u32 v233, v252, 1, s53
    ds_read_b32 v233, v233
    s_waitcnt lgkmcnt(0)
    s_branch K2_chk_36
K2_rare_38:
    s_cmp_eq_u32 s33, 4
    s_cbranch_scc1 K2_four_40
    s_mov_b32 s49, s48
    s_mov_b32 s51, s48
    s_add_u32 s45, s44, 256
    s_add_u32 s46, s44, 512
    s_add_u32 s47, s44, 768
    s_branch K2_back_39
K2_four_40:
    s_add_u32 s50, s48, 64
    s_lshr_b32 s51, s3, 27
    s_mov_b32 s66, 161536
    s_cmp_ge_u32 s51, 2
    s_cselect_b32 s66, 159072, s66
    s_mul_i32 s51, s51, 32
    s_add_u32 s51, s51, s66
    s_mov_b32 s46, s44
    s_mov_b32 s47, s44
    s_branch K2_back_39
K2_nul_41:
    s_mov_b32 s58, 63
    s_mov_b32 s36, 0
    s_branch K2_back_44
K2_spin_42:
    v_lshl_add_u32 v233, v252, 1, s53
    ds_read_b32 v233, v233
    s_waitcnt lgkmcnt(0)
    s_branch K2_chk_43
K2_rare_45:
    s_cmp_eq_u32 s33, 4
    s_cbranch_scc1 K2_four_47
    s_mov_b32 s49, s48
    s_mov_b32 s51, s48
    s_add_u32 s45, s44, 256
    s_add_u32 s46, s44, 512
    s_add_u32 s47, s44, 768
    s_branch K2_back_46
K2_four_47:
    s_add_u32 s50, s48, 64
    s_lshr_b32 s51, s3, 27
    s_mov_b32 s66, 161536
    s_cmp_ge_u32 s51, 2
    s_cselect_b32 s66, 159072, s66
    s_mul_i32 s51, s51, 32
    s_add_u32 s51, s51, s66
    s_mov_b32 s46, s44
    s_mov_b32 s47, s44
    s_branch K2_back_46
K2_nul_50:
    s_mov_b32 s58, 63
    s_mov_b32 s36, 0
    s_branch K2_back_53
K2_spin_51:
    v_lshl_add_u32 v233, v252, 1, s53
    ds_read_b32 v233, v233
    s_waitcnt lgkmcnt(0)
    s_branch K2_chk_52
K2_dyn_48:
    v_mov_b32 v254, 163648
    v_mov_b32 v255, 1
    v_lshl_add_u32 v233, v252, 1, s53
    s_mov_b64 exec, 1
    ds_add_rtn_u32 v232, v254, v255
    s_mov_b64 exec, -1
    ds_read_b32 v233, v233
    s_waitcnt lgkmcnt(0)
    v_readfirstlane_b32 s58, v232
    s_nop 0
    s_cmp_lt_u32 s58, s22
    s_cbranch_scc0 K2_nul_50
    s_and_b32 s59, s58, 7
    s_lshr_b32 s60, s58, 3
K2_chk_52:
    v_readlane_b32 s61, v233, s59
    s_nop 0
    s_cmp_gt_u32 s61, s60
    s_cbranch_scc0 K2_spin_51
K2_back_53:
    s_mov_b32 s34, 1
    s_branch K2_back_49
K2_rare_54:
    s_cmp_eq_u32 s33, 4
    s_cbranch_scc1 K2_four_56
    s_mov_b32 s49, s48
    s_mov_b32 s51, s48
    s_add_u32 s45, s44, 256
    s_add_u32 s46, s44, 512
    s_add_u32 s47, s44, 768
    s_branch K2_back_55
K2_four_56:
    s_add_u32 s50, s48, 64
    s_lshr_b32 s51, s3, 27
    s_mov_b32 s66, 161536
    s_cmp_ge_u32 s51, 2
    s_cselect_b32 s66, 159072, s66
    s_mul_i32 s51, s51, 32
    s_add_u32 s51, s51, s66
    s_mov_b32 s46, s44
    s_mov_b32 s47, s44
    s_branch K2_back_55
K2_dum_57:
    v_mov_b32 v232, -1
    s_mov_b32 m0, 163712
    s_mov_b64 exec, 1
    buffer_load_dwordx4 v232, s[16:19], 0 offen lds
    buffer_load_dwordx4 v232, s[16:19], 0 offen lds
    s_mov_b64 exec, -1
    s_branch K2_back_59
K2_a4_58:
    s_lshr_b32 s65, s3, 27
    s_mov_b32 s66, 161536
    s_cmp_ge_u32 s65, 2
    s_cselect_b32 s66, 158112, s66
    s_mul_i32 s65, s65, 512
    s_add_u32 s65, s65, s66
    v_add_u32 v232, s65, v230
    ds_read_b32 v232, v232
    s_add_u32 m0, s65, 864
    s_waitcnt lgkmcnt(0)
    v_or_b32 v232, v232, v231
    buffer_load_dwordx4 v232, s[16:19], 0 offen  lds
    s_branch K2_b4_60
K2_nul_63:
    s_mov_b32 s58, 63
    s_mov_b32 s36, 0
    s_branch K2_back_66
K2_spin_64:
    v_lshl_add_u32 v233, v252, 1, s53
    ds_read_b32 v233, v233
    s_waitcnt lgkmcnt(0)
    s_branch K2_chk_65
K2_dyn_61:
    v_mov_b32 v254, 163648
    v_mov_b32 v255, 1
    v_lshl_add_u32 v233, v252, 1, s53
    s_mov_b64 exec, 1
    ds_add_rtn_u32 v232, v254, v255
    s_mov_b64 exec, -1
    ds_read_b32 v233, v233
    s_waitcnt lgkmcnt(0)
    v_readfirstlane_b32 s58, v232
    s_nop 0
    s_cmp_lt_u32 s58, s22
    s_cbranch_scc0 K2_nul_63
    s_and_b32 s59, s58, 7
    s_lshr_b32 s60, s58, 3
K2_chk_65:
    v_readlane_b32 s61, v233, s59
    s_nop 0
    s_cmp_gt_u32 s61, s60
    s_cbranch_scc0 K2_spin_64
K2_back_66:
    s_mov_b32 s34, 1
    s_branch K2_back_62
K2_rare_67:
    s_cmp_eq_u32 s33, 4
    s_cbranch_scc1 K2_four_69
    s_mov_b32 s49, s48
    s_mov_b32 s51, s48
    s_add_u32 s45, s44, 256
    s_add_u32 s46, s44, 512
    s_add_u32 s47, s44, 768
    s_branch K2_back_68
K2_four_69:
    s_add_u32 s50, s48, 64
    s_lshr_b32 s51, s3, 27
    s_mov_b32 s66, 161536
    s_cmp_ge_u32 s51, 2
    s_cselect_b32 s66, 159072, s66
    s_mul_i32 s51, s51, 32
    s_add_u32 s51, s51, s66
    s_mov_b32 s46, s44
    s_mov_b32 s47, s44
    s_branch K2_back_68
K2_dum_70:
    v_mov_b32 v232, -1
    s_mov_b32 m0, 163712
    s_mov_b64 exec, 1
    buffer_load_dwordx4 v232, s[16:19], 0 offen lds
    buffer_load_dwordx4 v232, s[16:19], 0 offen lds
    s_mov_b64 exec, -1
    s_branch K2_back_72
K2_a4_71:
    s_lshr_b32 s65, s3, 27
    s_mov_b32 s66, 161536
    s_cmp_ge_u32 s65, 2
    s_cselect_b32 s66, 158112, s66
    s_mul_i32 s65, s65, 512
    s_add_u32 s65, s65, s66
    v_add_u32 v232, s65, v230
    ds_read_b32 v232, v232
    s_add_u32 m0, s65, 864
    s_waitcnt lgkmcnt(0)
    v_or_b32 v232, v232, v231
    buffer_load_dwordx4 v232, s[16:19], 0 offen  lds
    s_branch K2_b4_73
K2_nul_74:
    s_mov_b32 s58, 63
    s_mov_b32 s36, 0
    s_branch K2_back_77
K2_spin_75:
    v_lshl_add_u32 v233, v252, 1, s53
    ds_read_b32 v233, v233
    s_waitcnt lgkmcnt(0)
    s_branch K2_chk_76
K2_rare_78:
    s_cmp_eq_u32 s33, 4
    s_cbranch_scc1 K2_four_80
    s_mov_b32 s49, s48
    s_mov_b32 s51, s48
    s_add_u32 s45, s44, 256
    s_add_u32 s46, s44, 512
    s_add_u32 s47, s44, 768
    s_branch K2_back_79
K2_four_80:
    s_add_u32 s50, s48, 64
    s_lshr_b32 s51, s3, 27
    s_mov_b32 s66, 161536
    s_cmp_ge_u32 s51, 2
    s_cselect_b32 s66, 159072, s66
    s_mul_i32 s51, s51, 32
    s_add_u32 s51, s51, s66
    s_mov_b32 s46, s44
    s_mov_b32 s47, s44
    s_branch K2_back_79
K2_nul_81:
    s_mov_b32 s58, 63
    s_mov_b32 s36, 0
    s_branch K2_back_84
K2_spin_82:
    v_lshl_add_u32 v233, v252, 1, s53
    ds_read_b32 v233, v233
    s_waitcnt lgkmcnt(0)
    s_branch K2_chk_83
K2_rare_85:
    s_cmp_eq_u32 s33, 4
    s_cbranch_scc1 K2_four_87
    s_mov_b32 s49, s48
    s_mov_b32 s51, s48
    s_add_u32 s45, s44, 256
    s_add_u32 s46, s44, 512
    s_add_u32 s47, s44, 768
    s_branch K2_back_86
K2_four_87:
    s_add_u32 s50, s48, 64
    s_lshr_b32 s51, s3, 27
    s_mov_b32 s66, 161536
    s_cmp_ge_u32 s51, 2
    s_cselect_b32 s66, 159072, s66
    s_mul_i32 s51, s51, 32
    s_add_u32 s51, s51, s66
    s_mov_b32 s46, s44
    s_mov_b32 s47, s44
    s_branch K2_back_86
K2_TAIL2:
    v_lshlrev_b32 v229, 3, v252
    s_mul_i32 s58, s20, 20480
    s_add_u32 s58, s58, 6946816
    s_mul_i32 s59, s20, 8224
    buffer_load_dwordx4 v[96:99], v229, s[8:11], s58 offen offset:0 sc1
    buffer_load_dwordx4 v[100:103], v229, s[8:11], s58 offen offset:1024 sc1
    buffer_load_dwordx4 v[104:107], v229, s[8:11], s58 offen offset:2048 sc1
    buffer_load_dwordx4 v[108:111], v229, s[8:11], s58 offen offset:3072 sc1
    s_add_u32 s58, s58, 4096
    buffer_load_dwordx4 v[112:115], v229, s[8:11], s58 offen offset:0 sc1
    buffer_load_dwordx4 v[116:119], v229, s[8:11], s58 offen offset:1024 sc1
    buffer_load_dwordx4 v[120:123], v229, s[8:11], s58 offen offset:2048 sc1
    buffer_load_dwordx4 v[124:127], v229, s[8:11], s58 offen offset:3072 sc1
    s_add_u32 s58, s58, 4096
    v_lshl_add_u32 v228, v252, 1, s59
    v_lshrrev_b32 v226, 6, v252
    v_mul_u32_u24 v226, 126, v226
    v_sub_u32 v226, v228, v226
    s_branch K2_TAIL3
K2_TAIL:
    v_lshlrev_b32 v229, 3, v252
    s_mul_i32 s58, s20, 20480
    s_add_u32 s58, s58, 6946816
    s_mul_i32 s59, s20, 8224
    buffer_load_dwordx4 v[96:99], v229, s[8:11], s58 offen offset:0 sc1
    v_permlane32_swap_b32 v242, v236
    v_permlane32_swap_b32 v243, v237
    buffer_load_dwordx4 v[100:103], v229, s[8:11], s58 offen offset:1024 sc1
    v_permlane32_swap_b32 v244, v238
    v_permlane32_swap_b32 v245, v239
    buffer_load_dwordx4 v[104:107], v229, s[8:11], s58 offen offset:2048 sc1
    v_permlane32_swap_b32 v240, v241
    v_add_f32 v242, v242, v236
    buffer_load_dwordx4 v[108:111], v229, s[8:11], s58 offen offset:3072 sc1
    s_add_u32 s58, s58, 4096
    v_add_f32 v243, v243, v237
    v_add_f32 v244, v244, v238
    buffer_load_dwordx4 v[112:115], v229, s[8:11], s58 offen offset:0 sc1
    v_add_f32 v245, v245, v239
    v_add_f32 v240, -v240, -v241
    buffer_load_dwordx4 v[116:119], v229, s[8:11], s58 offen offset:1024 sc1
    v_sub_u32 v241, v230, v231
    v_cvt_pk_bf16_f32 v242, v242, v243
    buffer_load_dwordx4 v[120:123], v229, s[8:11], s58 offen offset:2048 sc1
    v_cvt_pk_bf16_f32 v244, v244, v245
    v_cvt_pk_bf16_f32 v240, v240, v240
    buffer_load_dwordx4 v[124:127], v229, s[8:11], s58 offen offset:3072 sc1
    s_add_u32 s58, s58, 4096
    ds_write_b32 v230, v242 offset:768
    ds_write_b32 v230, v244 offset:1024
    ds_write_b16 v241, v240 offset:1280
    v_lshl_add_u32 v228, v252, 1, s59
    v_lshrrev_b32 v226, 6, v252
    v_mul_u32_u24 v226, 126, v226
    v_sub_u32 v226, v228, v226
K2_TAIL3:
    s_waitcnt vmcnt(8)
    ds_write_b32 v228, v192 offset:0
    ds_write_b32 v228, v193 offset:256
    ds_write_b32 v228, v194 offset:512
    buffer_load_dwordx4 v[128:131], v229, s[8:11], s58 offen offset:0 sc1
    v_bfe_u32 v48, v252, 1, 4
    v_lshrrev_b32 v49, 5, v252
    ds_write_b32 v228, v195 offset:768
    ds_write_b32 v228, v196 offset:1024
    ds_write_b16 v226, v197 offset:1280
    buffer_load_dwordx4 v[132:135], v229, s[8:11], s58 offen offset:1024 sc1
    v_lshrrev_b32 v55, 3, v48
    v_lshlrev_b32 v52, 4, v49
    ds_write_b32 v228, v198 offset:1536
    ds_write_b32 v228, v199 offset:1792
    ds_write_b32 v228, v200 offset:2048
    buffer_load_dwordx4 v[136:139], v229, s[8:11], s58 offen offset:2048 sc1
    v_lshl_add_u32 v54, v55, 2, v48
    v_and_b32 v54, 7, v54
    ds_write_b32 v228, v201 offset:2304
    ds_write_b32 v228, v202 offset:2560
    ds_write_b16 v226, v203 offset:2816
    buffer_load_dwordx4 v[140:143], v229, s[8:11], s58 offen offset:3072 sc1
    s_add_u32 s58, s58, 4096
    v_and_b32 v50, 7, v48
    v_mul_u32_u24 v50, 8224, v50
    ds_write_b32 v228, v204 offset:3072
    ds_write_b32 v228, v205 offset:3328
    ds_write_b32 v228, v206 offset:3584
    buffer_load_dwordx4 v[144:147], v229, s[8:11], s58 offen offset:0 sc1
    v_mul_u32_u24 v51, 1536, v55
    v_add_u32 v50, v50, v51
    ds_write_b32 v228, v207 offset:3840
    ds_write_b32 v228, v208 offset:4096
    ds_write_b16 v226, v209 offset:4352
    buffer_load_dwordx4 v[148:151], v229, s[8:11], s58 offen offset:1024 sc1
    v_add_u32 v222, v50, v52
    v_mul_u32_u24 v51, 8224, v54
    ds_write_b32 v228, v210 offset:4608
    ds_write_b32 v228, v211 offset:4864
    ds_write_b32 v228, v212 offset:5120
    buffer_load_dwordx4 v[152:155], v229, s[8:11], s58 offen offset:2048 sc1
    v_add_u32 v232, v51, v52
    v_lshl_add_u32 v247, v55, 7, v232
    ds_write_b32 v228, v213 offset:5376
    ds_write_b32 v228, v214 offset:5632
    ds_write_b16 v226, v215 offset:5888
    buffer_load_dwordx4 v[156:159], v229, s[8:11], s58 offen offset:3072 sc1
    s_add_u32 s58, s58, 4096
    v_mul_u32_u24 v53, 192, v48
    v_and_b32 v53, 0xc0, v53
    ds_write_b32 v228, v216 offset:6144
    ds_write_b32 v228, v217 offset:6400
    ds_write_b32 v228, v218 offset:6656
    buffer_load_dwordx4 v[160:163], v229, s[8:11], s58 offen offset:0 sc1
    v_add_u32 v53, v53, v52
    v_mul_u32_u24 v51, 2400, v48
    ds_write_b32 v228, v219 offset:6912
    ds_write_b32 v228, v220 offset:7168
    ds_write_b16 v226, v221 offset:7424
    buffer_load_dwordx4 v[164:167], v229, s[8:11], s58 offen offset:1024 sc1
    s_mov_b32 s60, 65536
    v_add3_u32 v223, v51, v53, s60
    buffer_load_dwordx4 v[168:171], v229, s[8:11], s58 offen offset:2048 sc1
    v_mul_u32_u24 v51, 2400, v54
    s_mov_b32 s60, 142336
    buffer_load_dwordx4 v[172:175], v229, s[8:11], s58 offen offset:3072 sc1
    v_add3_u32 v225, v51, v53, s60
    v_lshl_add_u32 v248, v55, 7, v225
    s_lshl_b32 s60, s20, 5
    v_lshl_add_u32 v49, v49, 3, s60
    s_mov_b32 s60, 65536
    v_add3_u32 v255, v51, v49, s60
    v_lshl_add_u32 v246, v55, 9, v255
    v_bfe_u32 v53, v48, 2, 1
    v_lshl_add_u32 v49, v53, 4, v49
    v_add_u32 v254, v50, v49
    s_and_b32 s64, s55, s28
    s_waitcnt lgkmcnt(0)
    s_barrier
    s_cmp_eq_u32 s64, 0
    s_cbranch_scc1 K2_MULTI
    s_setprio 3
    ds_read_b128 v[48:51], v222 offset:0
    ds_read_b128 v[52:55], v222 offset:64
    ds_read_b128 v[56:59], v222 offset:896
    ds_read_b128 v[60:63], v222 offset:960
    ds_read_b128 v[64:67], v223 offset:0
    ds_read_b128 v[68:71], v223 offset:64
    ds_read_b128 v[72:75], v223 offset:896
    ds_read_b128 v[76:79], v223 offset:960
    ds_read_b128 v[80:83], v222 offset:128
    ds_read_b128 v[84:87], v222 offset:384
    ds_read_b128 v[88:91], v222 offset:256
    s_waitcnt vmcnt(19) lgkmcnt(9)
    v_mfma_f32_16x16x32_bf16 v[0:3], v[96:99], v[48:51], 0
    ds_read_b128 v[92:95], v222 offset:192
    s_waitcnt vmcnt(18)
    v_mfma_f32_16x16x32_bf16 v[0:3], v[100:103], v[52:55], v[0:3]
    ds_read_b128 v[48:51], v222 offset:448
    s_waitcnt vmcnt(17) lgkmcnt(9)
    v_mfma_f32_16x16x32_bf16 v[0:3], v[104:107], v[56:59], v[0:3]
    s_bfe_u32 s60, s20, 0x10002
    s_lshl_b32 s60, s60, 4
    ds_read_b128 v[52:55], v222 offset:320
    s_waitcnt vmcnt(16)
    v_mfma_f32_16x16x32_bf16 v[0:3], v[108:111], v[60:63], v[0:3]
    s_add_u32 s59, s59, s60
    v_add_u32 v228, s59, v229
    ds_read_b128 v[56:59], v222 offset:640
    s_waitcnt vmcnt(15) lgkmcnt(9)
    v_mfma_f32_16x16x32_bf16 v[0:3], v[112:115], v[64:67], v[0:3]
    s_mul_i32 s60, s20, 2400
    s_add_u32 s60, s60, 65536
    ds_read_b128 v[60:63], v222 offset:512
    s_waitcnt vmcnt(14)
    v_mfma_f32_16x16x32_bf16 v[0:3], v[116:119], v[68:71], v[0:3]
    v_add_u32 v249, s60, v229
    s_mov_b32 s63, 0xbfb8aa3b
    ds_read_b128 v[64:67], v222 offset:768
    s_waitcnt vmcnt(13) lgkmcnt(9)
    v_mfma_f32_16x16x32_bf16 v[0:3], v[120:123], v[72:75], v[0:3]
    s_add_u32 s40, s20, s21
    s_lshl_b32 s40, s40, 10
    ds_read_b128 v[68:71], v222 offset:704
    s_waitcnt vmcnt(12)
    v_mfma_f32_16x16x32_bf16 v[0:3], v[124:127], v[76:79], v[0:3]
    s_add_u32 s41, s40, 8192
    s_add_u32 s42, s40, 16384
    ds_read_b128 v[72:75], v222 offset:576
    s_waitcnt vmcnt(11) lgkmcnt(9)
    v_mfma_f32_16x16x32_bf16 v[4:7], v[128:131], v[80:83], 0
    s_add_u32 s43, s40, 24576
    s_add_u32 s44, s40, 32768
    ds_read_b128 v[76:79], v222 offset:832
    v_mfma_f32_16x16x32_bf16 v[8:11], v[128:131], v[84:87], 0
    ds_read_b128 v[80:83], v222 offset:1024
    s_waitcnt lgkmcnt(9)
    v_mfma_f32_16x16x32_bf16 v[12:15], v[128:131], v[88:91], 0
    ds_read_b128 v[84:87], v222 offset:1280
    s_waitcnt vmcnt(10)
    v_mfma_f32_16x16x32_bf16 v[4:7], v[132:135], v[92:95], v[4:7]
    ds_read_b128 v[88:91], v222 offset:1152
    s_waitcnt lgkmcnt(9)
    v_mfma_f32_16x16x32_bf16 v[8:11], v[132:135], v[48:51], v[8:11]
    v_mul_f32 v204, s63, v0
    ds_read_b128 v[92:95], v222 offset:1088
    v_mfma_f32_16x16x32_bf16 v[12:15], v[132:135], v[52:55], v[12:15]
    v_mul_f32 v205, s63, v1
    s_setprio 2
    ds_read_b128 v[48:51], v222 offset:1344
    s_waitcnt vmcnt(9) lgkmcnt(9)
    v_mfma_f32_16x16x32_bf16 v[4:7], v[136:139], v[56:59], v[4:7]
    ds_read_b128 v[52:55], v222 offset:1216
    v_mfma_f32_16x16x32_bf16 v[8:11], v[136:139], v[60:63], v[8:11]
    v_mul_f32 v206, s63, v2
    ds_read_b128 v[56:59], v223 offset:128
    s_waitcnt lgkmcnt(9)
    v_mfma_f32_16x16x32_bf16 v[12:15], v[136:139], v[64:67], v[12:15]
    v_mul_f32 v207, s63, v3
    ds_read_b128 v[60:63], v223 offset:384
    s_waitcnt vmcnt(8)
    v_mfma_f32_16x16x32_bf16 v[4:7], v[140:143], v[68:71], v[4:7]
    ds_read_b128 v[64:67], v223 offset:256
    s_waitcnt lgkmcnt(9)
    v_mfma_f32_16x16x32_bf16 v[8:11], v[140:143], v[72:75], v[8:11]
    v_exp_f32 v204, v204
    ds_read_b128 v[68:71], v223 offset:192
    v_mfma_f32_16x16x32_bf16 v[12:15], v[140:143], v[76:79], v[12:15]
    ds_read_b128 v[72:75], v223 offset:448
    s_waitcnt vmcnt(7) lgkmcnt(9)
    v_mfma_f32_16x16x32_bf16 v[4:7], v[144:147], v[80:83], v[4:7]
    v_exp_f32 v205, v205
    ds_read_b128 v[76:79], v223 offset:320
    v_mfma_f32_16x16x32_bf16 v[8:11], v[144:147], v[84:87], v[8:11]
    v_exp_f32 v206, v206
    ds_read_b128 v[80:83], v223 offset:640
    s_waitcnt lgkmcnt(9)
    v_mfma_f32_16x16x32_bf16 v[12:15], v[144:147], v[88:91], v[12:15]
    ds_read_b128 v[84:87], v223 offset:512
    s_waitcnt vmcnt(6)
    v_mfma_f32_16x16x32_bf16 v[4:7], v[148:151], v[92:95], v[4:7]
    v_exp_f32 v207, v207
    ds_read_b128 v[88:91], v223 offset:768
    s_waitcnt lgkmcnt(9)
    v_mfma_f32_16x16x32_bf16 v[8:11], v[148:151], v[48:51], v[8:11]
    v_add_f32 v204, 1.0, v204
    ds_read_b128 v[92:95], v223 offset:704
    v_mfma_f32_16x16x32_bf16 v[12:15], v[148:151], v[52:55], v[12:15]
    ds_read_b128 v[48:51], v223 offset:576
    s_waitcnt vmcnt(5) lgkmcnt(9)
    v_mfma_f32_16x16x32_bf16 v[4:7], v[152:155], v[56:59], v[4:7]
    v_add_f32 v205, 1.0, v205
    ds_read_b128 v[52:55], v223 offset:832
    v_mfma_f32_16x16x32_bf16 v[8:11], v[152:155], v[60:63], v[8:11]
    s_setprio 1
    ds_read_b128 v[56:59], v223 offset:1024
    s_waitcnt lgkmcnt(9)
    v_mfma_f32_16x16x32_bf16 v[12:15], v[152:155], v[64:67], v[12:15]
    v_add_f32 v206, 1.0, v206
    ds_read_b128 v[60:63], v223 offset:1280
    s_waitcnt vmcnt(4)
    v_mfma_f32_16x16x32_bf16 v[4:7], v[156:159], v[68:71], v[4:7]
    v_add_f32 v207, 1.0, v207
    ds_read_b128 v[64:67], v223 offset:1152
    s_waitcnt lgkmcnt(9)
    v_mfma_f32_16x16x32_bf16 v[8:11], v[156:159], v[72:75], v[8:11]
    ds_read_b128 v[68:71], v223 offset:1088
    v_mfma_f32_16x16x32_bf16 v[12:15], v[156:159], v[76:79], v[12:15]
    v_rcp_f32 v204, v204
    ds_read_b128 v[72:75], v223 offset:1344
    s_waitcnt vmcnt(3) lgkmcnt(9)
    v_mfma_f32_16x16x32_bf16 v[4:7], v[160:163], v[80:83], v[4:7]
    v_rcp_f32 v205, v205
    ds_read_b128 v[76:79], v223 offset:1216
    v_mfma_f32_16x16x32_bf16 v[8:11], v[160:163], v[84:87], v[8:11]
    ds_read_b128 v[80:83], v222 offset:3072
    s_waitcnt lgkmcnt(9)
    v_mfma_f32_16x16x32_bf16 v[12:15], v[160:163], v[88:91], v[12:15]
    v_rcp_f32 v206, v206
    ds_read_b128 v[84:87], v222 offset:3136
    s_waitcnt vmcnt(2)
    v_mfma_f32_16x16x32_bf16 v[4:7], v[164:167], v[92:95], v[4:7]
    ds_read_b128 v[88:91], v222 offset:3968
    s_waitcnt lgkmcnt(9)
    v_mfma_f32_16x16x32_bf16 v[8:11], v[164:167], v[48:51], v[8:11]
    v_rcp_f32 v207, v207
    ds_read_b128 v[92:95], v222 offset:4032
    v_mfma_f32_16x16x32_bf16 v[12:15], v[164:167], v[52:55], v[12:15]
    v_cvt_pk_bf16_f32 v176, v0, v1
    ds_read_b128 v[48:51], v223 offset:38400
    s_waitcnt vmcnt(1) lgkmcnt(9)
    v_mfma_f32_16x16x32_bf16 v[4:7], v[168:171], v[56:59], v[4:7]
    ds_read_b128 v[52:55], v223 offset:38464
    v_mfma_f32_16x16x32_bf16 v[8:11], v[168:171], v[60:63], v[8:11]
    v_cvt_pk_bf16_f32 v177, v2, v3
    s_setprio 0
    ds_read_b128 v[56:59], v223 offset:39296
    s_waitcnt lgkmcnt(9)
    v_mfma_f32_16x16x32_bf16 v[12:15], v[168:171], v[64:67], v[12:15]
    ds_read_b128 v[60:63], v223 offset:39360
    s_waitcnt vmcnt(0)
    v_mfma_f32_16x16x32_bf16 v[4:7], v[172:175], v[68:71], v[4:7]
    ds_read_b128 v[64:67], v222 offset:3200
    s_waitcnt lgkmcnt(9)
    v_mfma_f32_16x16x32_bf16 v[8:11], v[172:175], v[72:75], v[8:11]
    ds_read_b128 v[68:71], v222 offset:3456
    v_mfma_f32_16x16x32_bf16 v[12:15], v[172:175], v[76:79], v[12:15]
    ds_read_b128 v[72:75], v222 offset:3328
    s_waitcnt lgkmcnt(9)
    v_mfma_f32_16x16x32_bf16 v[16:19], v[96:99], v[80:83], 0
    ds_read_b128 v[76:79], v222 offset:3264
    v_mfma_f32_16x16x32_bf16 v[16:19], v[100:103], v[84:87], v[16:19]
    ds_read_b128 v[80:83], v222 offset:3520
    s_waitcnt lgkmcnt(9)
    v_mfma_f32_16x16x32_bf16 v[16:19], v[104:107], v[88:91], v[16:19]
    s_barrier
    s_setprio 3
    ds_read_b128 v[84:87], v222 offset:3392
    v_mfma_f32_16x16x32_bf16 v[16:19], v[108:111], v[92:95], v[16:19]
    v_mul_f32 v4, v4, v204
    ds_read_b128 v[88:91], v222 offset:3712
    s_waitcnt lgkmcnt(9)
    v_mfma_f32_16x16x32_bf16 v[16:19], v[112:115], v[48:51], v[16:19]
    v_mul_f32 v5, v5, v205
    ds_read_b128 v[92:95], v222 offset:3584
    v_mfma_f32_16x16x32_bf16 v[16:19], v[116:119], v[52:55], v[16:19]
    v_mul_f32 v6, v6, v206
    ds_read_b128 v[48:51], v222 offset:3840
    s_waitcnt lgkmcnt(9)
    v_mfma_f32_16x16x32_bf16 v[16:19], v[120:123], v[56:59], v[16:19]
    v_mul_f32 v7, v7, v207
    ds_read_b128 v[52:55], v222 offset:3776
    v_mfma_f32_16x16x32_bf16 v[16:19], v[124:127], v[60:63], v[16:19]
    v_cvt_pk_bf16_f32 v178, v4, v5
    ds_read_b128 v[56:59], v222 offset:3648
    s_waitcnt lgkmcnt(9)
    v_mfma_f32_16x16x32_bf16 v[20:23], v[128:131], v[64:67], 0
    v_cvt_pk_bf16_f32 v179, v6, v7
    ds_read_b128 v[60:63], v222 offset:3904
    v_mfma_f32_16x16x32_bf16 v[24:27], v[128:131], v[68:71], 0
    v_mul_f32 v8, v8, v204
    ds_read_b128 v[64:67], v222 offset:4096
    s_waitcnt lgkmcnt(9)
    v_mfma_f32_16x16x32_bf16 v[28:31], v[128:131], v[72:75], 0
    v_mul_f32 v9, v9, v205
    ds_read_b128 v[68:71], v222 offset:4352
    v_mfma_f32_16x16x32_bf16 v[20:23], v[132:135], v[76:79], v[20:23]
    v_mul_f32 v10, v10, v206
    ds_read_b128 v[72:75], v222 offset:4224
    s_waitcnt lgkmcnt(9)
    v_mfma_f32_16x16x32_bf16 v[24:27], v[132:135], v[80:83], v[24:27]
    v_mul_f32 v11, v11, v207
    ds_read_b128 v[76:79], v222 offset:4160
    v_mfma_f32_16x16x32_bf16 v[28:31], v[132:135], v[84:87], v[28:31]
    v_cvt_pk_bf16_f32 v180, v8, v9
    ds_read_b128 v[80:83], v222 offset:4416
    s_waitcnt lgkmcnt(9)
    v_mfma_f32_16x16x32_bf16 v[20:23], v[136:139], v[88:91], v[20:23]
    v_cvt_pk_bf16_f32 v181, v10, v11
    ds_read_b128 v[84:87], v222 offset:4288
    v_mfma_f32_16x16x32_bf16 v[24:27], v[136:139], v[92:95], v[24:27]
    v_mul_f32 v12, v12, v204
    s_setprio 2
    ds_read_b128 v[88:91], v223 offset:38528
    s_waitcnt lgkmcnt(9)
    v_mfma_f32_16x16x32_bf16 v[28:31], v[136:139], v[48:51], v[28:31]
    v_mul_f32 v13, v13, v205
    ds_read_b128 v[92:95], v223 offset:38784
    v_mfma_f32_16x16x32_bf16 v[20:23], v[140:143], v[52:55], v[20:23]
    v_mul_f32 v14, v14, v206
    ds_read_b128 v[48:51], v223 offset:38656
    s_waitcnt lgkmcnt(9)
    v_mfma_f32_16x16x32_bf16 v[24:27], v[140:143], v[56:59], v[24:27]
    v_mul_f32 v15, v15, v207
    ds_read_b128 v[52:55], v223 offset:38592
    v_mfma_f32_16x16x32_bf16 v[28:31], v[140:143], v[60:63], v[28:31]
    v_cvt_pk_bf16_f32 v182, v12, v13
    ds_read_b128 v[56:59], v223 offset:38848
    s_waitcnt lgkmcnt(9)
    v_mfma_f32_16x16x32_bf16 v[20:23], v[144:147], v[64:67], v[20:23]
    v_cvt_pk_bf16_f32 v183, v14, v15
    ds_read_b128 v[60:63], v223 offset:38720
    v_mfma_f32_16x16x32_bf16 v[24:27], v[144:147], v[68:71], v[24:27]
    ds_write_b64 v254, v[176:177] offset:0
    ds_write_b64 v254, v[178:179] offset:256
    ds_write_b64 v254, v[180:181] offset:512
    ds_write_b64 v254, v[182:183] offset:768
    ds_read_b128 v[64:67], v223 offset:39040
    s_waitcnt lgkmcnt(13)
    v_mfma_f32_16x16x32_bf16 v[28:31], v[144:147], v[72:75], v[28:31]
    v_mul_f32 v208, s63, v16
    ds_read_b128 v[68:71], v223 offset:38912
    v_mfma_f32_16x16x32_bf16 v[20:23], v[148:151], v[76:79], v[20:23]
    v_mul_f32 v209, s63, v17
    ds_read_b128 v[72:75], v223 offset:39168
    s_waitcnt lgkmcnt(13)
    v_mfma_f32_16x16x32_bf16 v[24:27], v[148:151], v[80:83], v[24:27]
    v_mul_f32 v210, s63, v18
    ds_read_b128 v[76:79], v223 offset:39104
    v_mfma_f32_16x16x32_bf16 v[28:31], v[148:151], v[84:87], v[28:31]
    v_mul_f32 v211, s63, v19
    ds_read_b128 v[80:83], v223 offset:38976
    s_waitcnt lgkmcnt(13)
    v_mfma_f32_16x16x32_bf16 v[20:23], v[152:155], v[88:91], v[20:23]
    v_exp_f32 v208, v208
    ds_read_b128 v[84:87], v223 offset:39232
    v_mfma_f32_16x16x32_bf16 v[24:27], v[152:155], v[92:95], v[24:27]
    v_exp_f32 v209, v209
    ds_read_b128 v[88:91], v223 offset:39424
    s_waitcnt lgkmcnt(13)
    v_mfma_f32_16x16x32_bf16 v[28:31], v[152:155], v[48:51], v[28:31]
    s_setprio 1
    ds_read_b128 v[92:95], v223 offset:39680
    v_mfma_f32_16x16x32_bf16 v[20:23], v[156:159], v[52:55], v[20:23]
    v_exp_f32 v210, v210
    ds_read_b128 v[48:51], v223 offset:39552
    s_waitcnt lgkmcnt(13)
    v_mfma_f32_16x16x32_bf16 v[24:27], v[156:159], v[56:59], v[24:27]
    v_exp_f32 v211, v211
    ds_read_b128 v[52:55], v223 offset:39488
    v_mfma_f32_16x16x32_bf16 v[28:31], v[156:159], v[60:63], v[28:31]
    v_add_f32 v208, 1.0, v208
    ds_read_b128 v[56:59], v223 offset:39744
    s_waitcnt lgkmcnt(9)
    v_mfma_f32_16x16x32_bf16 v[20:23], v[160:163], v[64:67], v[20:23]
    v_add_f32 v209, 1.0, v209
    ds_read_b128 v[60:63], v223 offset:39616
    v_mfma_f32_16x16x32_bf16 v[24:27], v[160:163], v[68:71], v[24:27]
    v_add_f32 v210, 1.0, v210
    ds_read_b128 v[64:67], v232 offset:6144
    s_waitcnt lgkmcnt(9)
    v_mfma_f32_16x16x32_bf16 v[28:31], v[160:163], v[72:75], v[28:31]
    v_add_f32 v211, 1.0, v211
    ds_read_b128 v[68:71], v232 offset:6208
    v_mfma_f32_16x16x32_bf16 v[20:23], v[164:167], v[76:79], v[20:23]
    ds_read_b128 v[72:75], v232 offset:7040
    s_waitcnt lgkmcnt(9)
    v_mfma_f32_16x16x32_bf16 v[24:27], v[164:167], v[80:83], v[24:27]
    v_rcp_f32 v208, v208
    ds_read_b128 v[76:79], v232 offset:7104
    v_mfma_f32_16x16x32_bf16 v[28:31], v[164:167], v[84:87], v[28:31]
    v_rcp_f32 v209, v209
    ds_read_b128 v[80:83], v225 offset:0
    s_waitcnt lgkmcnt(9)
    v_mfma_f32_16x16x32_bf16 v[20:23], v[168:171], v[88:91], v[20:23]
    v_rcp_f32 v210, v210
    ds_read_b128 v[84:87], v225 offset:64
    v_mfma_f32_16x16x32_bf16 v[24:27], v[168:171], v[92:95], v[24:27]
    v_rcp_f32 v211, v211
    ds_read_b128 v[88:91], v225 offset:896
    s_waitcnt lgkmcnt(9)
    v_mfma_f32_16x16x32_bf16 v[28:31], v[168:171], v[48:51], v[28:31]
    v_cvt_pk_bf16_f32 v184, v16, v17
    s_setprio 0
    ds_read_b128 v[92:95], v225 offset:960
    v_mfma_f32_16x16x32_bf16 v[20:23], v[172:175], v[52:55], v[20:23]
    v_cvt_pk_bf16_f32 v185, v18, v19
    ds_read_b128 v[48:51], v247 offset:6272
    s_waitcnt lgkmcnt(9)
    v_mfma_f32_16x16x32_bf16 v[24:27], v[172:175], v[56:59], v[24:27]
    ds_read_b128 v[52:55], v232 offset:6528
    v_mfma_f32_16x16x32_bf16 v[28:31], v[172:175], v[60:63], v[28:31]
    ds_read_b128 v[56:59], v247 offset:6336
    s_waitcnt lgkmcnt(9)
    v_mfma_f32_16x16x32_bf16 v[32:35], v[96:99], v[64:67], 0
    ds_read_b128 v[60:63], v232 offset:6592
    v_mfma_f32_16x16x32_bf16 v[32:35], v[100:103], v[68:71], v[32:35]
    ds_read_b128 v[64:67], v247 offset:6784
    s_waitcnt lgkmcnt(9)
    v_mfma_f32_16x16x32_bf16 v[32:35], v[104:107], v[72:75], v[32:35]
    s_barrier
    ds_read_b128 v[192:195], v228 offset:0
    ds_read_b128 v[196:199], v228 offset:1536
    s_setprio 3
    ds_read_b128 v[68:71], v232 offset:6656
    v_mfma_f32_16x16x32_bf16 v[32:35], v[108:111], v[76:79], v[32:35]
    v_mul_f32 v20, v20, v208
    ds_read_b128 v[72:75], v247 offset:6848
    s_waitcnt lgkmcnt(11)
    v_mfma_f32_16x16x32_bf16 v[32:35], v[112:115], v[80:83], v[32:35]
    v_mul_f32 v21, v21, v209
    ds_read_b128 v[76:79], v232 offset:6720
    v_mfma_f32_16x16x32_bf16 v[32:35], v[116:119], v[84:87], v[32:35]
    v_mul_f32 v22, v22, v210
    ds_read_b128 v[80:83], v247 offset:7168
    s_waitcnt lgkmcnt(11)
    v_mfma_f32_16x16x32_bf16 v[32:35], v[120:123], v[88:91], v[32:35]
    v_mul_f32 v23, v23, v211
    ds_read_b128 v[84:87], v232 offset:7424
    v_mfma_f32_16x16x32_bf16 v[32:35], v[124:127], v[92:95], v[32:35]
    v_cvt_pk_bf16_f32 v186, v20, v21
    ds_read_b128 v[88:91], v247 offset:7232
    s_waitcnt lgkmcnt(11)
    v_mfma_f32_16x16x32_bf16 v[36:39], v[128:131], v[48:51], 0
    v_cvt_pk_bf16_f32 v187, v22, v23
    ds_read_b128 v[92:95], v232 offset:7488
    v_mfma_f32_16x16x32_bf16 v[40:43], v[128:131], v[52:55], 0
    v_mul_f32 v24, v24, v208
    ds_read_b128 v[48:51], v248 offset:128
    s_waitcnt lgkmcnt(11)
    v_mfma_f32_16x16x32_bf16 v[36:39], v[132:135], v[56:59], v[36:39]
    v_mul_f32 v25, v25, v209
    s_waitcnt lgkmcnt(8)
    buffer_store_dwordx4 v[192:195], v229, s[12:15], s40 offen sc1
    buffer_store_dwordx4 v[196:199], v229, s[12:15], s41 offen sc1
    ds_read_b128 v[52:55], v225 offset:384
    v_mfma_f32_16x16x32_bf16 v[40:43], v[132:135], v[60:63], v[40:43]
    v_mul_f32 v26, v26, v210
    s_setprio 2
    ds_read_b128 v[56:59], v248 offset:192
    s_waitcnt lgkmcnt(9)
    v_mfma_f32_16x16x32_bf16 v[36:39], v[136:139], v[64:67], v[36:39]
    v_mul_f32 v27, v27, v211
    v_mul_f32 v204, s63, v32
    ds_read_b128 v[60:63], v225 offset:448
    v_mfma_f32_16x16x32_bf16 v[40:43], v[136:139], v[68:71], v[40:43]
    v_cvt_pk_bf16_f32 v188, v24, v25
    v_mul_f32 v205, s63, v33
    ds_read_b128 v[64:67], v248 offset:640
    s_waitcnt lgkmcnt(9)
    v_mfma_f32_16x16x32_bf16 v[36:39], v[140:143], v[72:75], v[36:39]
    v_cvt_pk_bf16_f32 v189, v26, v27
    v_mul_f32 v206, s63, v34
    ds_read_b128 v[68:71], v225 offset:512
    v_mfma_f32_16x16x32_bf16 v[40:43], v[140:143], v[76:79], v[40:43]
    v_mul_f32 v28, v28, v208
    v_mul_f32 v207, s63, v35
    ds_read_b128 v[72:75], v248 offset:704
    s_waitcnt lgkmcnt(9)
    v_mfma_f32_16x16x32_bf16 v[36:39], v[144:147], v[80:83], v[36:39]
    v_mul_f32 v29, v29, v209
    v_exp_f32 v204, v204
    ds_read_b128 v[76:79], v225 offset:576
    v_mfma_f32_16x16x32_bf16 v[40:43], v[144:147], v[84:87], v[40:43]
    v_mul_f32 v30, v30, v210
    v_exp_f32 v205, v205
    ds_read_b128 v[80:83], v248 offset:1024
    s_waitcnt lgkmcnt(9)
    v_mfma_f32_16x16x32_bf16 v[36:39], v[148:151], v[88:91], v[36:39]
    v_mul_f32 v31, v31, v211
    v_exp_f32 v206, v206
    ds_read_b128 v[84:87], v225 offset:1280
    v_mfma_f32_16x16x32_bf16 v[40:43], v[148:151], v[92:95], v[40:43]
    v_cvt_pk_bf16_f32 v190, v28, v29
    v_exp_f32 v207, v207
    ds_read_b128 v[88:91], v248 offset:1088
    s_waitcnt lgkmcnt(9)
    v_mfma_f32_16x16x32_bf16 v[36:39], v[152:155], v[48:51], v[36:39]
    v_cvt_pk_bf16_f32 v191, v30, v31
    v_add_f32 v204, 1.0, v204
    s_setprio 1
    ds_read_b128 v[92:95], v225 offset:1344
    v_mfma_f32_16x16x32_bf16 v[40:43], v[152:155], v[52:55], v[40:43]
    ds_write_b64 v254, v[184:185] offset:3072
    ds_write_b64 v254, v[186:187] offset:3328
    ds_write_b64 v254, v[188:189] offset:3584
    ds_write_b64 v254, v[190:191] offset:3840
    v_add_f32 v205, 1.0, v205
    s_waitcnt lgkmcnt(12)
    v_mfma_f32_16x16x32_bf16 v[36:39], v[156:159], v[56:59], v[36:39]
    v_add_f32 v206, 1.0, v206
    v_mfma_f32_16x16x32_bf16 v[40:43], v[156:159], v[60:63], v[40:43]
    v_add_f32 v207, 1.0, v207
    s_waitcnt lgkmcnt(10)
    v_mfma_f32_16x16x32_bf16 v[36:39], v[160:163], v[64:67], v[36:39]
    v_rcp_f32 v204, v204
    v_mfma_f32_16x16x32_bf16 v[40:43], v[160:163], v[68:71], v[40:43]
    v_rcp_f32 v205, v205
    s_waitcnt lgkmcnt(8)
    v_mfma_f32_16x16x32_bf16 v[36:39], v[164:167], v[72:75], v[36:39]
    v_rcp_f32 v206, v206
    v_mfma_f32_16x16x32_bf16 v[40:43], v[164:167], v[76:79], v[40:43]
    v_rcp_f32 v207, v207
    s_waitcnt lgkmcnt(6)
    v_mfma_f32_16x16x32_bf16 v[36:39], v[168:171], v[80:83], v[36:39]
    v_cvt_pk_bf16_f32 v176, v32, v33
    s_setprio 0
    v_mfma_f32_16x16x32_bf16 v[40:43], v[168:171], v[84:87], v[40:43]
    v_cvt_pk_bf16_f32 v177, v34, v35
    s_waitcnt lgkmcnt(4)
    v_mfma_f32_16x16x32_bf16 v[36:39], v[172:175], v[88:91], v[36:39]
    ds_write_b64 v255, v[176:177] offset:0
    v_mfma_f32_16x16x32_bf16 v[40:43], v[172:175], v[92:95], v[40:43]
    s_nop 5
    v_mul_f32 v36, v36, v204
    v_mul_f32 v37, v37, v205
    v_mul_f32 v38, v38, v206
    v_mul_f32 v39, v39, v207
    v_cvt_pk_bf16_f32 v178, v36, v37
    v_cvt_pk_bf16_f32 v179, v38, v39
    v_mul_f32 v40, v40, v204
    v_mul_f32 v41, v41, v205
    v_mul_f32 v42, v42, v206
    v_mul_f32 v43, v43, v207
    v_cvt_pk_bf16_f32 v180, v40, v41
    v_cvt_pk_bf16_f32 v181, v42, v43
    ds_write_b64 v246, v[178:179] offset:256
    ds_write_b64 v255, v[180:181] offset:512
    s_waitcnt lgkmcnt(0)
    s_barrier
    ds_read_b128 v[192:195], v228 offset:3072
    ds_read_b128 v[196:199], v228 offset:4608
    ds_read_b128 v[200:203], v249
    s_waitcnt lgkmcnt(1)
    buffer_store_dwordx4 v[192:195], v229, s[12:15], s42 offen sc1
    buffer_store_dwordx4 v[196:199], v229, s[12:15], s43 offen sc1
K2_LASTROW:
    s_add_u32 s59, s20, 32
    s_cmp_ge_u32 s59, s22
    s_cbranch_scc1 K2_FIN
    s_waitcnt lgkmcnt(0)
    buffer_store_dwordx4 v[200:203], v229, s[12:15], s44 offen sc1
K2_FIN:
    s_branch K2_END
K2_MULTI:
    ds_read_b128 v[48:51], v222 offset:0
    ds_read_b128 v[52:55], v222 offset:64
    ds_read_b128 v[56:59], v222 offset:896
    ds_read_b128 v[60:63], v222 offset:960
    ds_read_b128 v[64:67], v223 offset:0
    ds_read_b128 v[68:71], v223 offset:64
    ds_read_b128 v[72:75], v223 offset:896
    ds_read_b128 v[76:79], v223 offset:960
    ds_read_b128 v[80:83], v222 offset:128
    ds_read_b128 v[84:87], v222 offset:384
    ds_read_b128 v[88:91], v222 offset:256
    s_waitcnt vmcnt(19) lgkmcnt(9)
    v_mfma_f32_16x16x32_bf16 v[0:3], v[96:99], v[48:51], 0
    ds_read_b128 v[92:95], v222 offset:192
    s_waitcnt vmcnt(18)
    v_mfma_f32_16x16x32_bf16 v[0:3], v[100:103], v[52:55], v[0:3]
    ds_read_b128 v[48:51], v222 offset:448
    s_waitcnt vmcnt(17) lgkmcnt(9)
    v_mfma_f32_16x16x32_bf16 v[0:3], v[104:107], v[56:59], v[0:3]
    ds_read_b128 v[52:55], v222 offset:320
    s_waitcnt vmcnt(16)
    v_mfma_f32_16x16x32_bf16 v[0:3], v[108:111], v[60:63], v[0:3]
    ds_read_b128 v[56:59], v222 offset:640
    s_waitcnt vmcnt(15) lgkmcnt(9)
    v_mfma_f32_16x16x32_bf16 v[0:3], v[112:115], v[64:67], v[0:3]
    ds_read_b128 v[60:63], v222 offset:512
    s_waitcnt vmcnt(14)
    v_mfma_f32_16x16x32_bf16 v[0:3], v[116:119], v[68:71], v[0:3]
    ds_read_b128 v[64:67], v222 offset:768
    s_waitcnt vmcnt(13) lgkmcnt(9)
    v_mfma_f32_16x16x32_bf16 v[0:3], v[120:123], v[72:75], v[0:3]
    ds_read_b128 v[68:71], v222 offset:704
    s_waitcnt vmcnt(12)
    v_mfma_f32_16x16x32_bf16 v[0:3], v[124:127], v[76:79], v[0:3]
    ds_read_b128 v[72:75], v222 offset:576
    s_waitcnt vmcnt(11) lgkmcnt(9)
    v_mfma_f32_16x16x32_bf16 v[4:7], v[128:131], v[80:83], 0
    ds_read_b128 v[76:79], v222 offset:832
    v_mfma_f32_16x16x32_bf16 v[8:11], v[128:131], v[84:87], 0
    ds_read_b128 v[80:83], v222 offset:1024
    s_waitcnt lgkmcnt(9)
    v_mfma_f32_16x16x32_bf16 v[12:15], v[128:131], v[88:91], 0
    ds_read_b128 v[84:87], v222 offset:1280
    s_waitcnt vmcnt(10)
    v_mfma_f32_16x16x32_bf16 v[4:7], v[132:135], v[92:95], v[4:7]
    ds_read_b128 v[88:91], v222 offset:1152
    s_waitcnt lgkmcnt(9)
    v_mfma_f32_16x16x32_bf16 v[8:11], v[132:135], v[48:51], v[8:11]
    ds_read_b128 v[92:95], v222 offset:1088
    v_mfma_f32_16x16x32_bf16 v[12:15], v[132:135], v[52:55], v[12:15]
    ds_read_b128 v[48:51], v222 offset:1344
    s_waitcnt vmcnt(9) lgkmcnt(9)
    v_mfma_f32_16x16x32_bf16 v[4:7], v[136:139], v[56:59], v[4:7]
    ds_read_b128 v[52:55], v222 offset:1216
    v_mfma_f32_16x16x32_bf16 v[8:11], v[136:139], v[60:63], v[8:11]
    ds_read_b128 v[56:59], v223 offset:128
    s_waitcnt lgkmcnt(9)
    v_mfma_f32_16x16x32_bf16 v[12:15], v[136:139], v[64:67], v[12:15]
    ds_read_b128 v[60:63], v223 offset:384
    s_waitcnt vmcnt(8)
    v_mfma_f32_16x16x32_bf16 v[4:7], v[140:143], v[68:71], v[4:7]
    ds_read_b128 v[64:67], v223 offset:256
    s_waitcnt lgkmcnt(9)
    v_mfma_f32_16x16x32_bf16 v[8:11], v[140:143], v[72:75], v[8:11]
    ds_read_b128 v[68:71], v223 offset:192
    v_mfma_f32_16x16x32_bf16 v[12:15], v[140:143], v[76:79], v[12:15]
    ds_read_b128 v[72:75], v223 offset:448
    s_waitcnt vmcnt(7) lgkmcnt(9)
    v_mfma_f32_16x16x32_bf16 v[4:7], v[144:147], v[80:83], v[4:7]
    ds_read_b128 v[76:79], v223 offset:320
    v_mfma_f32_16x16x32_bf16 v[8:11], v[144:147], v[84:87], v[8:11]
    ds_read_b128 v[80:83], v223 offset:640
    s_waitcnt lgkmcnt(9)
    v_mfma_f32_16x16x32_bf16 v[12:15], v[144:147], v[88:91], v[12:15]
    ds_read_b128 v[84:87], v223 offset:512
    s_waitcnt vmcnt(6)
    v_mfma_f32_16x16x32_bf16 v[4:7], v[148:151], v[92:95], v[4:7]
    ds_read_b128 v[88:91], v223 offset:768
    s_waitcnt lgkmcnt(9)
    v_mfma_f32_16x16x32_bf16 v[8:11], v[148:151], v[48:51], v[8:11]
    ds_read_b128 v[92:95], v223 offset:704
    v_mfma_f32_16x16x32_bf16 v[12:15], v[148:151], v[52:55], v[12:15]
    ds_read_b128 v[48:51], v223 offset:576
    s_waitcnt vmcnt(5) lgkmcnt(9)
    v_mfma_f32_16x16x32_bf16 v[4:7], v[152:155], v[56:59], v[4:7]
    ds_read_b128 v[52:55], v223 offset:832
    v_mfma_f32_16x16x32_bf16 v[8:11], v[152:155], v[60:63], v[8:11]
    ds_read_b128 v[56:59], v223 offset:1024
    s_waitcnt lgkmcnt(9)
    v_mfma_f32_16x16x32_bf16 v[12:15], v[152:155], v[64:67], v[12:15]
    ds_read_b128 v[60:63], v223 offset:1280
    s_waitcnt vmcnt(4)
    v_mfma_f32_16x16x32_bf16 v[4:7], v[156:159], v[68:71], v[4:7]
    ds_read_b128 v[64:67], v223 offset:1152
    s_waitcnt lgkmcnt(9)
    v_mfma_f32_16x16x32_bf16 v[8:11], v[156:159], v[72:75], v[8:11]
    ds_read_b128 v[68:71], v223 offset:1088
    v_mfma_f32_16x16x32_bf16 v[12:15], v[156:159], v[76:79], v[12:15]
    ds_read_b128 v[72:75], v223 offset:1344
    s_waitcnt vmcnt(3) lgkmcnt(9)
    v_mfma_f32_16x16x32_bf16 v[4:7], v[160:163], v[80:83], v[4:7]
    ds_read_b128 v[76:79], v223 offset:1216
    v_mfma_f32_16x16x32_bf16 v[8:11], v[160:163], v[84:87], v[8:11]
    ds_read_b128 v[80:83], v222 offset:3072
    s_waitcnt lgkmcnt(9)
    v_mfma_f32_16x16x32_bf16 v[12:15], v[160:163], v[88:91], v[12:15]
    ds_read_b128 v[84:87], v222 offset:3136
    s_waitcnt vmcnt(2)
    v_mfma_f32_16x16x32_bf16 v[4:7], v[164:167], v[92:95], v[4:7]
    ds_read_b128 v[88:91], v222 offset:3968
    s_waitcnt lgkmcnt(9)
    v_mfma_f32_16x16x32_bf16 v[8:11], v[164:167], v[48:51], v[8:11]
    ds_read_b128 v[92:95], v222 offset:4032
    v_mfma_f32_16x16x32_bf16 v[12:15], v[164:167], v[52:55], v[12:15]
    ds_read_b128 v[48:51], v223 offset:38400
    s_waitcnt vmcnt(1) lgkmcnt(9)
    v_mfma_f32_16x16x32_bf16 v[4:7], v[168:171], v[56:59], v[4:7]
    ds_read_b128 v[52:55], v223 offset:38464
    v_mfma_f32_16x16x32_bf16 v[8:11], v[168:171], v[60:63], v[8:11]
    ds_read_b128 v[56:59], v223 offset:39296
    s_waitcnt lgkmcnt(9)
    v_mfma_f32_16x16x32_bf16 v[12:15], v[168:171], v[64:67], v[12:15]
    ds_read_b128 v[60:63], v223 offset:39360
    s_waitcnt vmcnt(0)
    v_mfma_f32_16x16x32_bf16 v[4:7], v[172:175], v[68:71], v[4:7]
    ds_read_b128 v[64:67], v222 offset:3200
    s_waitcnt lgkmcnt(9)
    v_mfma_f32_16x16x32_bf16 v[8:11], v[172:175], v[72:75], v[8:11]
    ds_read_b128 v[68:71], v222 offset:3456
    v_mfma_f32_16x16x32_bf16 v[12:15], v[172:175], v[76:79], v[12:15]
    ds_read_b128 v[72:75], v222 offset:3328
    s_waitcnt lgkmcnt(9)
    v_mfma_f32_16x16x32_bf16 v[16:19], v[96:99], v[80:83], 0
    ds_read_b128 v[76:79], v222 offset:3264
    v_mfma_f32_16x16x32_bf16 v[16:19], v[100:103], v[84:87], v[16:19]
    ds_read_b128 v[80:83], v222 offset:3520
    s_waitcnt lgkmcnt(9)
    v_mfma_f32_16x16x32_bf16 v[16:19], v[104:107], v[88:91], v[16:19]
    ds_read_b128 v[84:87], v222 offset:3392
    v_mfma_f32_16x16x32_bf16 v[16:19], v[108:111], v[92:95], v[16:19]
    ds_read_b128 v[88:91], v222 offset:3712
    s_waitcnt lgkmcnt(9)
    v_mfma_f32_16x16x32_bf16 v[16:19], v[112:115], v[48:51], v[16:19]
    ds_read_b128 v[92:95], v222 offset:3584
    v_mfma_f32_16x16x32_bf16 v[16:19], v[116:119], v[52:55], v[16:19]
    ds_read_b128 v[48:51], v222 offset:3840
    s_waitcnt lgkmcnt(9)
    v_mfma_f32_16x16x32_bf16 v[16:19], v[120:123], v[56:59], v[16:19]
    ds_read_b128 v[52:55], v222 offset:3776
    v_mfma_f32_16x16x32_bf16 v[16:19], v[124:127], v[60:63], v[16:19]
    ds_read_b128 v[56:59], v222 offset:3648
    s_waitcnt lgkmcnt(9)
    v_mfma_f32_16x16x32_bf16 v[20:23], v[128:131], v[64:67], 0
    ds_read_b128 v[60:63], v222 offset:3904
    v_mfma_f32_16x16x32_bf16 v[24:27], v[128:131], v[68:71], 0
    ds_read_b128 v[64:67], v222 offset:4096
    s_waitcnt lgkmcnt(9)
    v_mfma_f32_16x16x32_bf16 v[28:31], v[128:131], v[72:75], 0
    ds_read_b128 v[68:71], v222 offset:4352
    v_mfma_f32_16x16x32_bf16 v[20:23], v[132:135], v[76:79], v[20:23]
    ds_read_b128 v[72:75], v222 offset:4224
    s_waitcnt lgkmcnt(9)
    v_mfma_f32_16x16x32_bf16 v[24:27], v[132:135], v[80:83], v[24:27]
    ds_read_b128 v[76:79], v222 offset:4160
    v_mfma_f32_16x16x32_bf16 v[28:31], v[132:135], v[84:87], v[28:31]
    ds_read_b128 v[80:83], v222 offset:4416
    s_waitcnt lgkmcnt(9)
    v_mfma_f32_16x16x32_bf16 v[20:23], v[136:139], v[88:91], v[20:23]
    ds_read_b128 v[84:87], v222 offset:4288
    v_mfma_f32_16x16x32_bf16 v[24:27], v[136:139], v[92:95], v[24:27]
    ds_read_b128 v[88:91], v223 offset:38528
    s_waitcnt lgkmcnt(9)
    v_mfma_f32_16x16x32_bf16 v[28:31], v[136:139], v[48:51], v[28:31]
    ds_read_b128 v[92:95], v223 offset:38784
    v_mfma_f32_16x16x32_bf16 v[20:23], v[140:143], v[52:55], v[20:23]
    ds_read_b128 v[48:51], v223 offset:38656
    s_waitcnt lgkmcnt(9)
    v_mfma_f32_16x16x32_bf16 v[24:27], v[140:143], v[56:59], v[24:27]
    ds_read_b128 v[52:55], v223 offset:38592
    v_mfma_f32_16x16x32_bf16 v[28:31], v[140:143], v[60:63], v[28:31]
    ds_read_b128 v[56:59], v223 offset:38848
    s_waitcnt lgkmcnt(9)
    v_mfma_f32_16x16x32_bf16 v[20:23], v[144:147], v[64:67], v[20:23]
    ds_read_b128 v[60:63], v223 offset:38720
    v_mfma_f32_16x16x32_bf16 v[24:27], v[144:147], v[68:71], v[24:27]
    ds_read_b128 v[64:67], v223 offset:39040
    s_waitcnt lgkmcnt(9)
    v_mfma_f32_16x16x32_bf16 v[28:31], v[144:147], v[72:75], v[28:31]
    ds_read_b128 v[68:71], v223 offset:38912
    v_mfma_f32_16x16x32_bf16 v[20:23], v[148:151], v[76:79], v[20:23]
    ds_read_b128 v[72:75], v223 offset:39168
    s_waitcnt lgkmcnt(9)
    v_mfma_f32_16x16x32_bf16 v[24:27], v[148:151], v[80:83], v[24:27]
    ds_read_b128 v[76:79], v223 offset:39104
    v_mfma_f32_16x16x32_bf16 v[28:31], v[148:151], v[84:87], v[28:31]
    ds_read_b128 v[80:83], v223 offset:38976
    s_waitcnt lgkmcnt(9)
    v_mfma_f32_16x16x32_bf16 v[20:23], v[152:155], v[88:91], v[20:23]
    ds_read_b128 v[84:87], v223 offset:39232
    v_mfma_f32_16x16x32_bf16 v[24:27], v[152:155], v[92:95], v[24:27]
    ds_read_b128 v[88:91], v223 offset:39424
    s_waitcnt lgkmcnt(9)
    v_mfma_f32_16x16x32_bf16 v[28:31], v[152:155], v[48:51], v[28:31]
    ds_read_b128 v[92:95], v223 offset:39680
    v_mfma_f32_16x16x32_bf16 v[20:23], v[156:159], v[52:55], v[20:23]
    ds_read_b128 v[48:51], v223 offset:39552
    s_waitcnt lgkmcnt(9)
    v_mfma_f32_16x16x32_bf16 v[24:27], v[156:159], v[56:59], v[24:27]
    ds_read_b128 v[52:55], v223 offset:39488
    v_mfma_f32_16x16x32_bf16 v[28:31], v[156:159], v[60:63], v[28:31]
    ds_read_b128 v[56:59], v223 offset:39744
    s_waitcnt lgkmcnt(9)
    v_mfma_f32_16x16x32_bf16 v[20:23], v[160:163], v[64:67], v[20:23]
    ds_read_b128 v[60:63], v223 offset:39616
    v_mfma_f32_16x16x32_bf16 v[24:27], v[160:163], v[68:71], v[24:27]
    ds_read_b128 v[64:67], v232 offset:6144
    s_waitcnt lgkmcnt(9)
    v_mfma_f32_16x16x32_bf16 v[28:31], v[160:163], v[72:75], v[28:31]
    ds_read_b128 v[68:71], v232 offset:6208
    v_mfma_f32_16x16x32_bf16 v[20:23], v[164:167], v[76:79], v[20:23]
    ds_read_b128 v[72:75], v232 offset:7040
    s_waitcnt lgkmcnt(9)
    v_mfma_f32_16x16x32_bf16 v[24:27], v[164:167], v[80:83], v[24:27]
    ds_read_b128 v[76:79], v232 offset:7104
    v_mfma_f32_16x16x32_bf16 v[28:31], v[164:167], v[84:87], v[28:31]
    ds_read_b128 v[80:83], v225 offset:0
    s_waitcnt lgkmcnt(9)
    v_mfma_f32_16x16x32_bf16 v[20:23], v[168:171], v[88:91], v[20:23]
    ds_read_b128 v[84:87], v225 offset:64
    v_mfma_f32_16x16x32_bf16 v[24:27], v[168:171], v[92:95], v[24:27]
    ds_read_b128 v[88:91], v225 offset:896
    s_waitcnt lgkmcnt(9)
    v_mfma_f32_16x16x32_bf16 v[28:31], v[168:171], v[48:51], v[28:31]
    ds_read_b128 v[92:95], v225 offset:960
    v_mfma_f32_16x16x32_bf16 v[20:23], v[172:175], v[52:55], v[20:23]
    ds_read_b128 v[48:51], v247 offset:6272
    s_waitcnt lgkmcnt(9)
    v_mfma_f32_16x16x32_bf16 v[24:27], v[172:175], v[56:59], v[24:27]
    ds_read_b128 v[52:55], v232 offset:6528
    v_mfma_f32_16x16x32_bf16 v[28:31], v[172:175], v[60:63], v[28:31]
    ds_read_b128 v[56:59], v247 offset:6336
    s_waitcnt lgkmcnt(9)
    v_mfma_f32_16x16x32_bf16 v[32:35], v[96:99], v[64:67], 0
    ds_read_b128 v[60:63], v232 offset:6592
    v_mfma_f32_16x16x32_bf16 v[32:35], v[100:103], v[68:71], v[32:35]
    ds_read_b128 v[64:67], v247 offset:6784
    s_waitcnt lgkmcnt(9)
    v_mfma_f32_16x16x32_bf16 v[32:35], v[104:107], v[72:75], v[32:35]
    ds_read_b128 v[68:71], v232 offset:6656
    v_mfma_f32_16x16x32_bf16 v[32:35], v[108:111], v[76:79], v[32:35]
    ds_read_b128 v[72:75], v247 offset:6848
    s_waitcnt lgkmcnt(9)
    v_mfma_f32_16x16x32_bf16 v[32:35], v[112:115], v[80:83], v[32:35]
    ds_read_b128 v[76:79], v232 offset:6720
    v_mfma_f32_16x16x32_bf16 v[32:35], v[116:119], v[84:87], v[32:35]
    ds_read_b128 v[80:83], v247 offset:7168
    s_waitcnt lgkmcnt(9)
    v_mfma_f32_16x16x32_bf16 v[32:35], v[120:123], v[88:91], v[32:35]
    ds_read_b128 v[84:87], v232 offset:7424
    v_mfma_f32_16x16x32_bf16 v[32:35], v[124:127], v[92:95], v[32:35]
    ds_read_b128 v[88:91], v247 offset:7232
    s_waitcnt lgkmcnt(9)
    v_mfma_f32_16x16x32_bf16 v[36:39], v[128:131], v[48:51], 0
    ds_read_b128 v[92:95], v232 offset:7488
    v_mfma_f32_16x16x32_bf16 v[40:43], v[128:131], v[52:55], 0
    ds_read_b128 v[48:51], v248 offset:128
    s_waitcnt lgkmcnt(9)
    v_mfma_f32_16x16x32_bf16 v[36:39], v[132:135], v[56:59], v[36:39]
    ds_read_b128 v[52:55], v225 offset:384
    v_mfma_f32_16x16x32_bf16 v[40:43], v[132:135], v[60:63], v[40:43]
    ds_read_b128 v[56:59], v248 offset:192
    s_waitcnt lgkmcnt(9)
    v_mfma_f32_16x16x32_bf16 v[36:39], v[136:139], v[64:67], v[36:39]
    ds_read_b128 v[60:63], v225 offset:448
    v_mfma_f32_16x16x32_bf16 v[40:43], v[136:139], v[68:71], v[40:43]
    ds_read_b128 v[64:67], v248 offset:640
    s_waitcnt lgkmcnt(9)
    v_mfma_f32_16x16x32_bf16 v[36:39], v[140:143], v[72:75], v[36:39]
    ds_read_b128 v[68:71], v225 offset:512
    v_mfma_f32_16x16x32_bf16 v[40:43], v[140:143], v[76:79], v[40:43]
    ds_read_b128 v[72:75], v248 offset:704
    s_waitcnt lgkmcnt(9)
    v_mfma_f32_16x16x32_bf16 v[36:39], v[144:147], v[80:83], v[36:39]
    ds_read_b128 v[76:79], v225 offset:576
    v_mfma_f32_16x16x32_bf16 v[40:43], v[144:147], v[84:87], v[40:43]
    ds_read_b128 v[80:83], v248 offset:1024
    s_waitcnt lgkmcnt(9)
    v_mfma_f32_16x16x32_bf16 v[36:39], v[148:151], v[88:91], v[36:39]
    ds_read_b128 v[84:87], v225 offset:1280
    v_mfma_f32_16x16x32_bf16 v[40:43], v[148:151], v[92:95], v[40:43]
    ds_read_b128 v[88:91], v248 offset:1088
    s_waitcnt lgkmcnt(9)
    v_mfma_f32_16x16x32_bf16 v[36:39], v[152:155], v[48:51], v[36:39]
    ds_read_b128 v[92:95], v225 offset:1344
    v_mfma_f32_16x16x32_bf16 v[40:43], v[152:155], v[52:55], v[40:43]
    s_waitcnt lgkmcnt(8)
    v_mfma_f32_16x16x32_bf16 v[36:39], v[156:159], v[56:59], v[36:39]
    v_mfma_f32_16x16x32_bf16 v[40:43], v[156:159], v[60:63], v[40:43]
    s_waitcnt lgkmcnt(6)
    v_mfma_f32_16x16x32_bf16 v[36:39], v[160:163], v[64:67], v[36:39]
    v_mfma_f32_16x16x32_bf16 v[40:43], v[160:163], v[68:71], v[40:43]
    s_waitcnt lgkmcnt(4)
    v_mfma_f32_16x16x32_bf16 v[36:39], v[164:167], v[72:75], v[36:39]
    v_mfma_f32_16x16x32_bf16 v[40:43], v[164:167], v[76:79], v[40:43]
    s_waitcnt lgkmcnt(2)
    v_mfma_f32_16x16x32_bf16 v[36:39], v[168:171], v[80:83], v[36:39]
    v_mfma_f32_16x16x32_bf16 v[40:43], v[168:171], v[84:87], v[40:43]
    s_waitcnt lgkmcnt(0)
    v_mfma_f32_16x16x32_bf16 v[36:39], v[172:175], v[88:91], v[36:39]
    v_mfma_f32_16x16x32_bf16 v[40:43], v[172:175], v[92:95], v[40:43]
    s_lshl_b32 s60, s54, 9
    s_lshl_b32 s61, s20, 6
    s_add_u32 s60, s60, s61
    s_mul_i32 s60, s60, 192
    s_add_u32 s60, s60, 10485760
    v_mul_u32_u24 v227, 96, v252
    s_cmp_lg_u32 s28, 0
    s_cbranch_scc1 K2_NOACC
    buffer_load_dwordx4 v[48:51], v227, s[8:11], s60 offen offset:0
    buffer_load_dwordx4 v[52:55], v227, s[8:11], s60 offen offset:16
    buffer_load_dwordx4 v[56:59], v227, s[8:11], s60 offen offset:32
    buffer_load_dwordx4 v[60:63], v227, s[8:11], s60 offen offset:48
    buffer_load_dwordx4 v[64:67], v227, s[8:11], s60 offen offset:64
    buffer_load_dwordx4 v[68:71], v227, s[8:11], s60 offen offset:80
    buffer_load_dwordx4 v[72:75], v227, s[8:11], s60 offen offset:96
    buffer_load_dwordx4 v[76:79], v227, s[8:11], s60 offen offset:112
    buffer_load_dwordx4 v[80:83], v227, s[8:11], s60 offen offset:128
    buffer_load_dwordx4 v[84:87], v227, s[8:11], s60 offen offset:144
    buffer_load_dwordx4 v[88:91], v227, s[8:11], s60 offen offset:160
    s_waitcnt vmcnt(0)
    v_add_f32 v0, v0, v48
    v_add_f32 v1, v1, v49
    v_add_f32 v2, v2, v50
    v_add_f32 v3, v3, v51
    v_add_f32 v4, v4, v52
    v_add_f32 v5, v5, v53
    v_add_f32 v6, v6, v54
    v_add_f32 v7, v7, v55
    v_add_f32 v8, v8, v56
    v_add_f32 v9, v9, v57
    v_add_f32 v10, v10, v58
    v_add_f32 v11, v11, v59
    v_add_f32 v12, v12, v60
    v_add_f32 v13, v13, v61
    v_add_f32 v14, v14, v62
    v_add_f32 v15, v15, v63
    v_add_f32 v16, v16, v64
    v_add_f32 v17, v17, v65
    v_add_f32 v18, v18, v66
    v_add_f32 v19, v19, v67
    v_add_f32 v20, v20, v68
    v_add_f32 v21, v21, v69
    v_add_f32 v22, v22, v70
    v_add_f32 v23, v23, v71
    v_add_f32 v24, v24, v72
    v_add_f32 v25, v25, v73
    v_add_f32 v26, v26, v74
    v_add_f32 v27, v27, v75
    v_add_f32 v28, v28, v76
    v_add_f32 v29, v29, v77
    v_add_f32 v30, v30, v78
    v_add_f32 v31, v31, v79
    v_add_f32 v32, v32, v80
    v_add_f32 v33, v33, v81
    v_add_f32 v34, v34, v82
    v_add_f32 v35, v35, v83
    v_add_f32 v36, v36, v84
    v_add_f32 v37, v37, v85
    v_add_f32 v38, v38, v86
    v_add_f32 v39, v39, v87
    v_add_f32 v40, v40, v88
    v_add_f32 v41, v41, v89
    v_add_f32 v42, v42, v90
    v_add_f32 v43, v43, v91
K2_NOACC:
    s_barrier
    s_cmp_eq_u32 s55, 0
    s_cbranch_scc1 K2_SPILL
    s_bfe_u32 s60, s20, 0x10002
    s_lshl_b32 s60, s60, 4
    s_add_u32 s59, s59, s60
    v_add_u32 v228, s59, v229
    s_mul_i32 s60, s20, 2400
    s_add_u32 s60, s60, 65536
    v_add_u32 v249, s60, v229
    s_mov_b32 s63, 0xbfb8aa3b
    s_add_u32 s40, s20, s21
    s_lshl_b32 s40, s40, 10
    s_add_u32 s41, s40, 8192
    s_add_u32 s42, s40, 16384
    s_add_u32 s43, s40, 24576
    s_add_u32 s44, s40, 32768
    v_mul_f32 v204, s63, v0
    v_mul_f32 v205, s63, v1
    v_mul_f32 v206, s63, v2
    v_mul_f32 v207, s63, v3
    v_exp_f32 v204, v204
    v_exp_f32 v205, v205
    v_exp_f32 v206, v206
    v_exp_f32 v207, v207
    v_add_f32 v204, 1.0, v204
    v_add_f32 v205, 1.0, v205
    v_add_f32 v206, 1.0, v206
    v_add_f32 v207, 1.0, v207
    v_rcp_f32 v204, v204
    v_rcp_f32 v205, v205
    v_rcp_f32 v206, v206
    v_rcp_f32 v207, v207
    v_cvt_pk_bf16_f32 v176, v0, v1
    v_cvt_pk_bf16_f32 v177, v2, v3
    v_mul_f32 v4, v4, v204
    v_mul_f32 v5, v5, v205
    v_mul_f32 v6, v6, v206
    v_mul_f32 v7, v7, v207
    v_cvt_pk_bf16_f32 v178, v4, v5
    v_cvt_pk_bf16_f32 v179, v6, v7
    v_mul_f32 v8, v8, v204
    v_mul_f32 v9, v9, v205
    v_mul_f32 v10, v10, v206
    v_mul_f32 v11, v11, v207
    v_cvt_pk_bf16_f32 v180, v8, v9
    v_cvt_pk_bf16_f32 v181, v10, v11
    v_mul_f32 v12, v12, v204
    v_mul_f32 v13, v13, v205
    v_mul_f32 v14, v14, v206
    v_mul_f32 v15, v15, v207
    v_cvt_pk_bf16_f32 v182, v12, v13
    v_cvt_pk_bf16_f32 v183, v14, v15
    ds_write_b64 v254, v[176:177] offset:0
    ds_write_b64 v254, v[178:179] offset:256
    ds_write_b64 v254, v[180:181] offset:512
    ds_write_b64 v254, v[182:183] offset:768
    s_waitcnt lgkmcnt(0)
    s_barrier
    ds_read_b128 v[192:195], v228 offset:0
    ds_read_b128 v[196:199], v228 offset:1536
    s_waitcnt lgkmcnt(0)
    buffer_store_dwordx4 v[192:195], v229, s[12:15], s40 offen sc1
    buffer_store_dwordx4 v[196:199], v229, s[12:15], s41 offen sc1
    v_mul_f32 v208, s63, v16
    v_mul_f32 v209, s63, v17
    v_mul_f32 v210, s63, v18
    v_mul_f32 v211, s63, v19
    v_exp_f32 v208, v208
    v_exp_f32 v209, v209
    v_exp_f32 v210, v210
    v_exp_f32 v211, v211
    v_add_f32 v208, 1.0, v208
    v_add_f32 v209, 1.0, v209
    v_add_f32 v210, 1.0, v210
    v_add_f32 v211, 1.0, v211
    v_rcp_f32 v208, v208
    v_rcp_f32 v209, v209
    v_rcp_f32 v210, v210
    v_rcp_f32 v211, v211
    v_cvt_pk_bf16_f32 v184, v16, v17
    v_cvt_pk_bf16_f32 v185, v18, v19
    v_mul_f32 v20, v20, v208
    v_mul_f32 v21, v21, v209
    v_mul_f32 v22, v22, v210
    v_mul_f32 v23, v23, v211
    v_cvt_pk_bf16_f32 v186, v20, v21
    v_cvt_pk_bf16_f32 v187, v22, v23
    v_mul_f32 v24, v24, v208
    v_mul_f32 v25, v25, v209
    v_mul_f32 v26, v26, v210
    v_mul_f32 v27, v27, v211
    v_cvt_pk_bf16_f32 v188, v24, v25
    v_cvt_pk_bf16_f32 v189, v26, v27
    v_mul_f32 v28, v28, v208
    v_mul_f32 v29, v29, v209
    v_mul_f32 v30, v30, v210
    v_mul_f32 v31, v31, v211
    v_cvt_pk_bf16_f32 v190, v28, v29
    v_cvt_pk_bf16_f32 v191, v30, v31
    ds_write_b64 v254, v[184:185] offset:3072
    ds_write_b64 v254, v[186:187] offset:3328
    ds_write_b64 v254, v[188:189] offset:3584
    ds_write_b64 v254, v[190:191] offset:3840
    s_waitcnt lgkmcnt(0)
    s_barrier
    ds_read_b128 v[192:195], v228 offset:3072
    ds_read_b128 v[196:199], v228 offset:4608
    s_waitcnt lgkmcnt(0)
    buffer_store_dwordx4 v[192:195], v229, s[12:15], s42 offen sc1
    buffer_store_dwordx4 v[196:199], v229, s[12:15], s43 offen sc1
    v_mul_f32 v204, s63, v32
    v_mul_f32 v205, s63, v33
    v_mul_f32 v206, s63, v34
    v_mul_f32 v207, s63, v35
    v_exp_f32 v204, v204
    v_exp_f32 v205, v205
    v_exp_f32 v206, v206
    v_exp_f32 v207, v207
    v_add_f32 v204, 1.0, v204
    v_add_f32 v205, 1.0, v205
    v_add_f32 v206, 1.0, v206
    v_add_f32 v207, 1.0, v207
    v_rcp_f32 v204, v204
    v_rcp_f32 v205, v205
    v_rcp_f32 v206, v206
    v_rcp_f32 v207, v207
    v_cvt_pk_bf16_f32 v176, v32, v33
    v_cvt_pk_bf16_f32 v177, v34, v35
    v_mul_f32 v36, v36, v204
    v_mul_f32 v37, v37, v205
    v_mul_f32 v38, v38, v206
    v_mul_f32 v39, v39, v207
    v_cvt_pk_bf16_f32 v178, v36, v37
    v_cvt_pk_bf16_f32 v179, v38, v39
    v_mul_f32 v40, v40, v204
    v_mul_f32 v41, v41, v205
    v_mul_f32 v42, v42, v206
    v_mul_f32 v43, v43, v207
    v_cvt_pk_bf16_f32 v180, v40, v41
    v_cvt_pk_bf16_f32 v181, v42, v43
    ds_write_b64 v255, v[176:177] offset:0
    ds_write_b64 v246, v[178:179] offset:256
    ds_write_b64 v255, v[180:181] offset:512
    s_waitcnt lgkmcnt(0)
    s_barrier
    ds_read_b128 v[200:203], v249
    s_branch K2_LASTROW
K2_SPILL:
    buffer_store_dwordx4 v[0:3], v227, s[8:11], s60 offen offset:0
    buffer_store_dwordx4 v[4:7], v227, s[8:11], s60 offen offset:16
    buffer_store_dwordx4 v[8:11], v227, s[8:11], s60 offen offset:32
    buffer_store_dwordx4 v[12:15], v227, s[8:11], s60 offen offset:48
    buffer_store_dwordx4 v[16:19], v227, s[8:11], s60 offen offset:64
    buffer_store_dwordx4 v[20:23], v227, s[8:11], s60 offen offset:80
    buffer_store_dwordx4 v[24:27], v227, s[8:11], s60 offen offset:96
    buffer_store_dwordx4 v[28:31], v227, s[8:11], s60 offen offset:112
    buffer_store_dwordx4 v[32:35], v227, s[8:11], s60 offen offset:128
    buffer_store_dwordx4 v[36:39], v227, s[8:11], s60 offen offset:144
    buffer_store_dwordx4 v[40:43], v227, s[8:11], s60 offen offset:160
    s_mov_b32 s28, 0
    s_waitcnt vmcnt(0)
    s_cmp_lt_u32 s24, s25
    s_cbranch_scc1 K2_LOAD
    s_add_u32 s23, s23, 20
    s_branch K2_WINDOW
K2_END:
    s_endpgm
.section .rodata,"a"
.p2align 6
.amdhsa_kernel standalone__tensor_product_equiv_equiformer__graph_kernel
  .amdhsa_next_free_vgpr 256
  .amdhsa_next_free_sgpr 102
  .amdhsa_accum_offset 256
  .amdhsa_group_segment_fixed_size 0
  .amdhsa_kernarg_size 96
  .amdhsa_user_sgpr_count 2
  .amdhsa_user_sgpr_kernarg_segment_ptr 1
  .amdhsa_system_sgpr_workgroup_id_x 1
  .amdhsa_float_denorm_mode_32 3
.end_amdhsa_kernel
```

```asm
; @launch grid=(256,1,1) block=(512,1,1) lds=163840
.amdgcn_target "amdgcn-amd-amdhsa--gfx950"
.text
.globl standalone__tensor_product_equiv_equiformer__graph_kernel
.p2align 8
.type standalone__tensor_product_equiv_equiformer__graph_kernel,@function
standalone__tensor_product_equiv_equiformer__graph_kernel:
    s_cmp_ge_u32 s2, 256
    s_cbranch_scc1 K2_END
    s_load_dwordx16 s[80:95], s[0:1], 0
    s_load_dwordx4 s[96:99], s[0:1], 72
    s_load_dwordx2 s[100:101], s[0:1], 88
    s_memrealtime s[74:75]
    v_lshrrev_b32 v1, 6, v0
    s_mov_b32 s54, s2
    v_readfirstlane_b32 s20, v1
    s_mov_b64 exec, 0
    s_cmp_eq_u32 s20, 0
    s_cbranch_scc1 K2_PAD_S1
    s_cmp_eq_u32 s20, 1
    s_cbranch_scc1 K2_PAD_S2
    s_cmp_eq_u32 s20, 5
    s_cbranch_scc1 K2_PAD_H1
    s_cmp_eq_u32 s20, 6
    s_cbranch_scc1 K2_PAD_H2
    s_cmp_eq_u32 s20, 2
    s_cbranch_scc1 K2_PAD_H3
KS_HOP0:
    s_mov_b64 exec, -1
    v_and_b32 v8, 63, v0
    v_lshlrev_b32 v9, 4, v8
    v_mov_b32 v6, 0
    v_lshlrev_b32 v5, 4, v0
    v_mul_u32_u24 v4, 24, v0
    s_mul_i32 s64, s2, 5120
    s_mul_i32 s65, s2, 7680
    v_mov_b32 v176, v8
    v_mov_b32 v177, v0
    s_mul_i32 s21, s2, 625
    s_add_u32 s22, s21, 640
    s_add_u32 s21, s21, 15
    s_lshr_b32 s21, s21, 4
    s_lshr_b32 s22, s22, 4
    s_sub_u32 s22, s22, s21
    s_movk_i32 s39, 1024
    s_lshl_b32 s37, s20, 13
    s_mov_b32 s53, 163616
    s_lshl_b32 s52, s20, 2
    s_add_u32 s52, s52, s53
    s_add_u32 s68, s37, 0
    s_add_u32 s69, s37, 2048
    s_add_u32 s70, s37, 4096
    s_add_u32 s71, s37, 6144
    s_waitcnt lgkmcnt(0)
    s_mov_b32 s8, s100
    s_and_b32 s9, s101, 0xffff
    s_mov_b32 s10, 37748736
    s_mov_b32 s11, 0x20000
    s_cmp_lg_u32 s20, 7
    s_cbranch_scc1 KS_NOTAG
    s_mov_b32 s60, s98
    s_and_b32 s61, s99, 0xffff
    s_mov_b32 s62, 256
    s_mov_b32 s63, 0x20000
    s_cmp_lg_u32 s2, 0
    s_cbranch_scc1 KS_TAGLD
    s_or_b32 s24, s74, 1
    v_mov_b32 v10, s24
    v_mov_b32 v11, 0
    s_mov_b64 exec, 1
    buffer_atomic_cmpswap v[10:11], v6, s[60:63], 0 offen sc1
    s_mov_b64 exec, -1
KS_TAGLD:
    v_mov_b32 v14, 0
    s_barrier
    v_mov_b32 v76, 0
    v_mov_b32 v77, -1
    v_lshlrev_b32 v78, 2, v8
    v_add_u32 v78, 163424, v78
    s_mov_b64 exec, 0x1ff
    ds_write_b32 v78, v76 offset:192
    s_mov_b64 exec, 0xff
    ds_write_b32 v78, v77 offset:256
    s_mov_b64 exec, -1
    s_mov_b32 exec_hi, 0xffff
    ds_write_b32 v78, v76
    s_mov_b64 exec, 0x3f
    ds_write_b32 v78, v76 offset:228
    s_mov_b64 exec, -1
    s_mov_b64 exec, 1
    s_mov_b32 s24, 0x40000
    v_mov_b32 v12, 163728
KS_TAGW:
    buffer_load_dword v15, v6, s[60:63], 0 offen sc1
    s_waitcnt vmcnt(1)
    v_cmp_ne_u32 vcc, 0, v14
    s_nop 0
    s_cbranch_vccnz KS_TAGOK
    s_sub_u32 s24, s24, 1
    s_cbranch_scc1 K2_END
    buffer_load_dword v14, v6, s[60:63], 0 offen sc1
    s_waitcnt vmcnt(1)
    v_cmp_ne_u32 vcc, 0, v15
    s_nop 0
    s_cbranch_vccz KS_TAGW
    ds_write_b32 v12, v15
    s_branch KS_TAGOK2
KS_TAGOK:
    ds_write_b32 v12, v14
KS_TAGOK2:
    s_mov_b64 exec, -1
    s_waitcnt lgkmcnt(0)
    s_barrier
    s_branch KS_B3
KS_H0:
    s_barrier
    s_branch KS_HELP
K2_PAD_S1:
    s_branch KS_HOP0
KS_NOTAG:
    s_cmp_ge_u32 s20, 5
    s_cbranch_scc1 KS_HELP
    s_cmp_ge_u32 s2, 250
    s_cbranch_scc1 KS_IDLE
    s_mov_b32 s40, s88
    s_and_b32 s41, s89, 0xffff
    s_mov_b32 s42, 1280000
    s_mov_b32 s43, 0x20000
    buffer_load_dwordx4 v[12:15], v5, s[40:43], s64 offen
    s_mov_b32 s44, s86
    s_and_b32 s45, s87, 0xffff
    s_mov_b32 s46, 1280000
    s_mov_b32 s47, 0x20000
    s_mov_b32 s48, s82
    s_and_b32 s49, s83, 0xffff
    s_mov_b32 s50, 1920000
    s_mov_b32 s51, 0x20000
    buffer_load_dwordx4 v[16:19], v5, s[44:47], s64 offen
    buffer_load_dwordx4 v[20:23], v4, s[48:51], s65 offen
    buffer_load_dwordx2 v[24:25], v4, s[48:51], s65 offen offset:16
    v_lshlrev_b32 v2, 2, v0
    s_lshl_b32 s64, s64, 3
    v_lshl_add_u32 v3, v0, 7, s64
    v_mov_b32 v7, 1
    s_cmp_eq_u32 s20, 4
    s_cbranch_scc1 KS_NOCLR
    ds_write_b32 v2, v6
KS_NOCLR:
    s_waitcnt lgkmcnt(0)
    s_barrier
    s_mov_b64 exec, 0
    s_cmp_eq_u32 s20, 0
    s_cbranch_scc1 K2_PAD_B3
    s_cmp_eq_u32 s20, 1
    s_cbranch_scc1 K2_PAD_LD
    s_cmp_eq_u32 s20, 2
    s_cbranch_scc1 K2_PAD_NW
    s_cmp_eq_u32 s20, 3
    s_cbranch_scc1 K2_PAD_SC
    s_cmp_eq_u32 s20, 4
    s_cbranch_scc1 K2_PAD_SD
KS_HOP:
    s_mov_b64 exec, -1
    v_mul_u32_u24 v76, 2979, v0
    v_lshrrev_b32 v76, 16, v76
    v_mul_u32_u24 v77, 2048, v76
    v_lshl_add_u32 v78, v0, 4, v77
    v_add_u32 v78, 67584, v78
    v_add_u32 v79, 67200, v78
    v_mov_b32 v80, -1
    v_mov_b32 v81, -1
    v_cmp_gt_u32 vcc, 14, v76
    v_cmp_gt_u32 s[56:57], 12, v76
    v_mov_b32 v82, -1
    v_mov_b32 v83, -1
    s_mov_b64 exec, vcc
    ds_write_b128 v78, v[80:83]
    ds_write_b128 v78, v[80:83] offset:33600
    s_mov_b64 exec, s[56:57]
    ds_write_b128 v79, v[80:83]
    s_mov_b64 exec, -1
    s_mov_b32 s58, 429497
    s_movk_i32 s59, 625
    s_waitcnt vmcnt(3)
    v_mul_u32_u24 v28, s58, v12
    v_lshrrev_b32 v32, 27, v28
    v_bfe_u32 v36, v28, 24, 3
    v_lshlrev_b32 v32, 2, v32
    v_lshl_or_b32 v32, v36, 7, v32
    ds_add_rtn_u32 v36, v32, v7
    v_mul_u32_u24 v29, s58, v13
    v_lshrrev_b32 v33, 27, v29
    v_bfe_u32 v37, v29, 24, 3
    v_lshlrev_b32 v33, 2, v33
    v_lshl_or_b32 v33, v37, 7, v33
    ds_add_rtn_u32 v37, v33, v7
    v_mul_u32_u24 v30, s58, v14
    v_lshrrev_b32 v34, 27, v30
    v_bfe_u32 v38, v30, 24, 3
    v_lshlrev_b32 v34, 2, v34
    v_lshl_or_b32 v34, v38, 7, v34
    ds_add_rtn_u32 v38, v34, v7
    v_mul_u32_u24 v31, s58, v15
    v_lshrrev_b32 v35, 27, v31
    v_bfe_u32 v39, v31, 24, 3
    v_lshlrev_b32 v35, 2, v35
    v_lshl_or_b32 v35, v39, 7, v35
    ds_add_rtn_u32 v39, v35, v7
    v_lshrrev_b32 v28, 24, v28
    v_mad_u32_u24 v28, v28, s59, 15
    v_lshrrev_b32 v28, 4, v28
    v_sub_u32 v28, v12, v28
    v_add_u32 v12, 0, v3
    v_lshl_or_b32 v28, v28, 26, v12
    v_lshrrev_b32 v29, 24, v29
    v_mad_u32_u24 v29, v29, s59, 15
    v_lshrrev_b32 v29, 4, v29
    v_sub_u32 v29, v13, v29
    v_add_u32 v13, 32, v3
    v_lshl_or_b32 v29, v29, 26, v13
    v_lshrrev_b32 v30, 24, v30
    v_mad_u32_u24 v30, v30, s59, 15
    v_lshrrev_b32 v30, 4, v30
    v_sub_u32 v30, v14, v30
    v_add_u32 v14, 64, v3
    v_lshl_or_b32 v30, v30, 26, v14
    v_lshrrev_b32 v31, 24, v31
    v_mad_u32_u24 v31, v31, s59, 15
    v_lshrrev_b32 v31, 4, v31
    v_sub_u32 v31, v15, v31
    v_add_u32 v15, 96, v3
    v_lshl_or_b32 v31, v31, 26, v15
K2_PAD_S2:
    s_cbranch_execz KS_HOP0
    v_mov_b32 v59, 163728
    s_mul_i32 s65, s2, 1152
    s_add_u32 s65, s65, 6291456
    s_mul_i32 s64, s2, 20608
    s_waitcnt lgkmcnt(0)
    s_barrier
    ds_read_b128 v[40:43], v9
    ds_read_b32 v59, v59
    s_waitcnt lgkmcnt(1)
    v_add_u32 v45, v40, v41
    v_add_u32 v46, v45, v42
    v_add_u32 v47, v46, v43
    v_mov_b32 v58, v47
    s_nop 1
    v_add_u32_dpp v58, v58, v58 row_shr:1 row_mask:0xf bank_mask:0xf bound_ctrl:0
    s_nop 1
    v_add_u32_dpp v58, v58, v58 row_shr:2 row_mask:0xf bank_mask:0xf bound_ctrl:0
    s_nop 1
    v_add_u32_dpp v58, v58, v58 row_shr:4 row_mask:0xf bank_mask:0xf bound_ctrl:0
    s_nop 1
    v_add_u32_dpp v58, v58, v58 row_shr:8 row_mask:0xf bank_mask:0xf bound_ctrl:0
    s_nop 1
    v_add_u32_dpp v58, v58, v58 row_bcast:15 row_mask:0xa bank_mask:0xf
    s_nop 1
    v_add_u32_dpp v58, v58, v58 row_bcast:31 row_mask:0xc bank_mask:0xf
    v_sub_u32 v48, v58, v47
    v_add_u32 v49, v48, v40
    v_add_u32 v50, v48, v45
    v_add_u32 v51, v48, v46
    ds_write_b128 v9, v[48:51] offset:1024
    s_waitcnt vmcnt(0) lgkmcnt(1)
    s_cmp_lg_u32 s20, 4
    s_cbranch_scc1 KS_NOPUB
    v_lshl_or_b32 v56, v49, 11, v48
    v_lshl_or_b32 v57, v51, 11, v50
    v_lshl_or_b32 v56, v59, 22, v56
    v_lshl_or_b32 v57, v59, 22, v57
    buffer_store_dwordx4 v[56:59], v9, s[8:11], s65 offen sc1
KS_NOPUB:
    s_waitcnt lgkmcnt(0)
    ds_read_b32 v32, v32 offset:1024
    ds_read_b32 v33, v33 offset:1024
    ds_read_b32 v34, v34 offset:1024
    ds_read_b32 v35, v35 offset:1024
    v_and_b32 v60, 0xffff, v59
    v_and_b32 v61, 0xffff0000, v59
    s_mov_b32 s58, 0xffff0000
    v_mov_b32 v40, v20
    v_lshl_or_b32 v41, v21, 16, v60
    v_or_b32 v42, v61, v16
    v_mov_b32 v43, v28
    v_alignbit_b32 v44, v22, v21, 16
    v_and_or_b32 v45, v22, s58, v60
    v_or_b32 v46, v61, v17
    v_mov_b32 v47, v29
    v_mov_b32 v48, v23
    v_lshl_or_b32 v49, v24, 16, v60
    v_or_b32 v50, v61, v18
    v_mov_b32 v51, v30
    v_alignbit_b32 v52, v25, v24, 16
    v_and_or_b32 v53, v25, s58, v60
    v_or_b32 v54, v61, v19
    v_mov_b32 v55, v31
    s_waitcnt lgkmcnt(0)
    v_add_lshl_u32 v32, v32, v36, 4
    ds_write_b128 v32, v[40:43] offset:2048
    v_add_lshl_u32 v33, v33, v37, 4
    ds_write_b128 v33, v[44:47] offset:2048
    v_add_lshl_u32 v34, v34, v38, 4
    ds_write_b128 v34, v[48:51] offset:2048
    v_add_lshl_u32 v35, v35, v39, 4
    ds_write_b128 v35, v[52:55] offset:2048
    s_waitcnt lgkmcnt(0)
    s_barrier
    ds_read_b128 v[12:15], v5 offset:2048
    ds_read_b128 v[16:19], v5 offset:7168
    ds_read_b128 v[20:23], v5 offset:12288
    ds_read_b128 v[24:27], v5 offset:17408
    s_waitcnt lgkmcnt(3)
    buffer_store_dwordx4 v[12:15], v5, s[8:11], s64 offen sc1
    s_add_u32 s64, s64, 5120
    s_waitcnt lgkmcnt(2)
    buffer_store_dwordx4 v[16:19], v5, s[8:11], s64 offen sc1
    s_add_u32 s64, s64, 5120
    s_waitcnt lgkmcnt(1)
    buffer_store_dwordx4 v[20:23], v5, s[8:11], s64 offen sc1
    s_add_u32 s64, s64, 5120
    s_waitcnt lgkmcnt(0)
    buffer_store_dwordx4 v[24:27], v5, s[8:11], s64 offen sc1
    s_branch KS_JOIN
K2_PAD_B3:
    s_branch KS_HOP
KS_B3:
    v_mov_b32 v59, 163728
    ds_read_b32 v59, v59
    s_waitcnt lgkmcnt(0)
    s_barrier
KS_JOIN:
    v_readfirstlane_b32 s2, v59
    s_mov_b32 s23, 0
    s_mov_b32 s28, 1
    s_mov_b32 s24, 0
    s_mov_b32 s25, 1
K2_CELLS:
    v_lshrrev_b32 v178, 1, v177
    v_min_u32 v178, 249, v178
    v_mul_u32_u24 v72, 1152, v178
    s_and_b32 s58, s54, 7
    s_lshl_b32 s58, s58, 7
    s_lshr_b32 s59, s54, 5
    s_lshl_b32 s59, s59, 4
    s_add_u32 s67, s58, s59
    s_add_u32 s67, s67, 6291456
    buffer_load_dwordx4 v[76:79], v72, s[8:11], s67 offen sc1
    s_cmp_eq_u32 s28, 0
    s_cbranch_scc1 K2_NOSRD
    s_mov_b32 s4, s80
    s_and_b32 s5, s81, 0xffff
    s_mov_b32 s6, 10240000
    s_mov_b32 s7, 0x20000
    s_mov_b32 s12, s96
    s_and_b32 s13, s97, 0xffff
    s_mov_b32 s14, 10240000
    s_mov_b32 s15, 0x20000
    s_mov_b32 s16, s84
    s_and_b32 s17, s85, 0xffff
    s_mov_b32 s18, 10240000
    s_mov_b32 s19, 0x20000
    s_sub_u32 s80, s80, 1024
    s_subb_u32 s81, s81, 0
    s_mov_b32 s72, s80
    s_and_b32 s73, s81, 0xffff
    s_mov_b32 s74, 10241024
    s_mov_b32 s75, 0x20000
    s_mov_b64 exec, 0
    s_cmp_eq_u32 s20, 0
    s_cbranch_scc1 K2_PAD_U20
    s_cmp_eq_u32 s20, 1
    s_cbranch_scc1 K2_PAD_U30
    s_cmp_eq_u32 s20, 2
    s_cbranch_scc1 K2_PAD_U21
    s_cmp_eq_u32 s20, 3
    s_cbranch_scc1 K2_PAD_U31
    s_cmp_eq_u32 s20, 4
    s_cbranch_scc1 K2_PAD_SW
    s_cmp_eq_u32 s20, 5
    s_cbranch_scc1 K2_PAD_TL
    s_cmp_eq_u32 s20, 6
    s_cbranch_scc1 K2_PAD_T2
K2_HOP:
    s_mov_b64 exec, -1
K2_NOSRD:
    v_and_b32 v84, 15, v176
    v_lshrrev_b32 v85, 5, v176
    v_bfe_u32 v86, v176, 4, 1
    v_lshrrev_b32 v87, 2, v84
    v_and_b32 v88, 3, v84
    v_lshl_add_u32 v89, v85, 3, v87
    v_lshlrev_b32 v249, 5, v89
    v_lshl_add_u32 v249, v88, 3, v249
    v_add_u32 v249, 864, v249
    v_mul_u32_u24 v250, 192, v86
    v_lshl_add_u32 v250, v85, 5, v250
    v_lshrrev_b32 v90, 1, v88
    v_lshl_add_u32 v90, v86, 1, v90
    v_bfe_u32 v91, v87, 1, 1
    v_lshlrev_b32 v91, 2, v91
    v_xor_b32 v90, v90, v91
    v_lshlrev_b32 v90, 4, v90
    v_lshl_add_u32 v90, v89, 7, v90
    v_and_b32 v91, 1, v88
    v_lshl_add_u32 v90, v91, 3, v90
    v_add_u32 v246, s37, v90
    v_xor_b32 v247, 64, v246
    v_lshrrev_b32 v90, 3, v176
    v_lshlrev_b32 v251, 2, v90
    v_add_u32 v251, 768, v251
    v_bfe_u32 v90, v90, 1, 1
    v_lshlrev_b32 v90, 2, v90
    v_and_b32 v91, 7, v176
    v_xor_b32 v90, v90, v91
    v_lshlrev_b32 v248, 4, v90
    v_lshlrev_b32 v252, 1, v176
    v_and_b32 v231, 1, v176
    v_lshlrev_b32 v231, 4, v231
    v_lshrrev_b32 v90, 1, v176
    v_lshlrev_b32 v90, 5, v90
    v_add_u32 v230, 864, v90
    s_lshl_b32 s59, s2, 22
    s_mov_b32 s60, 0x40000
    s_bfe_u32 s61, s54, 0x10004
    s_bfe_u32 s62, s54, 0x10003
    s_add_u32 s63, s61, s62
    s_mul_i32 s62, s62, 11
    s_sub_u32 s64, 11, s62
    v_cmp_gt_u32 vcc, 500, v177
    s_nop 0
    s_mov_b64 s[56:57], vcc
K2_POLL:
    s_waitcnt vmcnt(0)
    v_xor_b32 v73, s59, v76
    v_xor_b32 v74, s59, v77
    v_or_b32 v73, v73, v74
    v_xor_b32 v74, s2, v79
    v_lshrrev_b32 v73, 22, v73
    v_or_b32 v73, v73, v74
    v_cmp_ne_u32 vcc, 0, v73
    s_nop 0
    s_cbranch_vccz K2_POLLED
    s_sub_u32 s60, s60, 1
    s_cbranch_scc1 K2_END
    s_mov_b64 exec, vcc
    buffer_load_dwordx4 v[76:79], v72, s[8:11], s67 offen sc1
    s_mov_b64 exec, -1
    s_branch K2_POLL
K2_PAD_LD:
    s_branch KS_HOP
K2_POLLED:
    s_set_gpr_idx_on s61, gpr_idx(SRC0)
    s_nop 0
    v_bfe_u32 v179, v76, s62, 11
    s_set_gpr_idx_idx s63
    s_nop 0
    v_bfe_u32 v73, v76, s64, 11
    s_set_gpr_idx_off
    v_sub_u32 v73, v73, v179
    v_cndmask_b32 v73, 0, v73, s[56:57]
    v_and_b32 v1, 1, v177
    v_add_u32 v1, s23, v1
    v_sub_u32 v180, v73, v1
    v_add_u32 v179, v179, v1
    v_mul_u32_u24 v181, 20608, v178
    v_lshl_add_u32 v181, v179, 4, v181
    v_cmp_lt_i32 s[40:41], 0, v180
    v_cmp_lt_i32 s[42:43], 2, v180
    v_cmp_lt_i32 s[44:45], 4, v180
    v_cmp_lt_i32 s[46:47], 6, v180
    v_cmp_lt_i32 s[48:49], 8, v180
    v_cmp_lt_i32 s[50:51], 10, v180
    v_cmp_lt_i32 s[90:91], 12, v180
    v_cmp_lt_i32 s[92:93], 14, v180
    v_cmp_lt_i32 s[94:95], 16, v180
    v_cmp_lt_i32 s[96:97], 18, v180
    s_mov_b64 exec, s[40:41]
    s_cbranch_execz K2_LD_DONE
    buffer_load_dwordx4 v[0:3], v181, s[8:11], 0 offen offset:0 sc1
    s_mov_b64 exec, s[42:43]
    s_cbranch_execz K2_LD_DONE
    buffer_load_dwordx4 v[4:7], v181, s[8:11], 0 offen offset:32 sc1
    s_mov_b64 exec, s[44:45]
    s_cbranch_execz K2_LD_DONE
    buffer_load_dwordx4 v[8:11], v181, s[8:11], 0 offen offset:64 sc1
    s_mov_b64 exec, s[46:47]
    s_cbranch_execz K2_LD_DONE
    buffer_load_dwordx4 v[12:15], v181, s[8:11], 0 offen offset:96 sc1
    s_mov_b64 exec, s[48:49]
    s_cbranch_execz K2_LD_DONE
    buffer_load_dwordx4 v[16:19], v181, s[8:11], 0 offen offset:128 sc1
    s_mov_b64 exec, s[50:51]
    s_cbranch_execz K2_LD_DONE
    buffer_load_dwordx4 v[20:23], v181, s[8:11], 0 offen offset:160 sc1
    s_mov_b64 exec, s[90:91]
    s_cbranch_execz K2_LD_DONE
    buffer_load_dwordx4 v[24:27], v181, s[8:11], 0 offen offset:192 sc1
    s_mov_b64 exec, s[92:93]
    s_cbranch_execz K2_LD_DONE
    buffer_load_dwordx4 v[28:31], v181, s[8:11], 0 offen offset:224 sc1
    s_mov_b64 exec, s[94:95]
    s_cbranch_execz K2_LD_DONE
    buffer_load_dwordx4 v[32:35], v181, s[8:11], 0 offen offset:256 sc1
    s_mov_b64 exec, s[96:97]
    s_cbranch_execz K2_LD_DONE
    buffer_load_dwordx4 v[36:39], v181, s[8:11], 0 offen offset:288 sc1
K2_LD_DONE:
    s_mov_b64 exec, -1
    s_cmp_eq_u32 s28, 0
    s_cbranch_scc1 K2_NOWRAW
    v_lshrrev_b32 v60, 5, v176
    v_bfe_u32 v61, v176, 2, 2
    v_lshl_add_u32 v60, v60, 2, v61
    v_mul_u32_u24 v60, 1280, v60
    v_bfe_u32 v61, v176, 4, 1
    v_lshl_add_u32 v60, v61, 5, v60
    v_and_b32 v61, 3, v176
    v_lshl_add_u32 v60, v61, 3, v60
    ds_read_b64_tr_b16 v[136:137], v60 offset:24576
    ds_read_b64_tr_b16 v[138:139], v60 offset:34816
    ds_read_b64_tr_b16 v[140:141], v60 offset:24640
    ds_read_b64_tr_b16 v[142:143], v60 offset:34880
    ds_read_b64_tr_b16 v[144:145], v60 offset:24832
    ds_read_b64_tr_b16 v[146:147], v60 offset:35072
    ds_read_b64_tr_b16 v[148:149], v60 offset:24896
    ds_read_b64_tr_b16 v[150:151], v60 offset:35136
    ds_read_b64_tr_b16 v[152:153], v60 offset:25088
    ds_read_b64_tr_b16 v[154:155], v60 offset:35328
    ds_read_b64_tr_b16 v[156:157], v60 offset:25152
    ds_read_b64_tr_b16 v[158:159], v60 offset:35392
    ds_read_b64_tr_b16 v[160:161], v60 offset:25344
    ds_read_b64_tr_b16 v[162:163], v60 offset:35584
    ds_read_b64_tr_b16 v[164:165], v60 offset:25408
    ds_read_b64_tr_b16 v[166:167], v60 offset:35648
    ds_read_b64_tr_b16 v[168:169], v60 offset:25600
    ds_read_b64_tr_b16 v[170:171], v60 offset:35840
    ds_read_b64_tr_b16 v[172:173], v60 offset:25664
    ds_read_b64_tr_b16 v[174:175], v60 offset:35904
    s_waitcnt lgkmcnt(0)
    v_lshlrev_b32 v96, 16, v136
    v_and_b32 v97, 0xffff0000, v136
    v_lshlrev_b32 v98, 16, v137
    v_and_b32 v99, 0xffff0000, v137
    v_lshlrev_b32 v100, 16, v138
    v_and_b32 v101, 0xffff0000, v138
    v_lshlrev_b32 v102, 16, v139
    v_and_b32 v103, 0xffff0000, v139
    v_lshlrev_b32 v104, 16, v140
    v_and_b32 v105, 0xffff0000, v140
    v_lshlrev_b32 v106, 16, v141
    v_and_b32 v107, 0xffff0000, v141
    v_lshlrev_b32 v108, 16, v142
    v_and_b32 v109, 0xffff0000, v142
    v_lshlrev_b32 v110, 16, v143
    v_and_b32 v111, 0xffff0000, v143
    v_lshlrev_b32 v112, 16, v144
    v_and_b32 v113, 0xffff0000, v144
    v_lshlrev_b32 v114, 16, v145
    v_and_b32 v115, 0xffff0000, v145
    v_lshlrev_b32 v116, 16, v146
    v_and_b32 v117, 0xffff0000, v146
    v_lshlrev_b32 v118, 16, v147
    v_and_b32 v119, 0xffff0000, v147
    v_lshlrev_b32 v120, 16, v148
    v_and_b32 v121, 0xffff0000, v148
    v_lshlrev_b32 v122, 16, v149
    v_and_b32 v123, 0xffff0000, v149
    v_lshlrev_b32 v124, 16, v150
    v_and_b32 v125, 0xffff0000, v150
    v_lshlrev_b32 v126, 16, v151
    v_and_b32 v127, 0xffff0000, v151
    v_lshlrev_b32 v128, 16, v152
    v_and_b32 v129, 0xffff0000, v152
    v_lshlrev_b32 v130, 16, v153
    v_and_b32 v131, 0xffff0000, v153
    v_lshlrev_b32 v132, 16, v154
    v_and_b32 v133, 0xffff0000, v154
    v_lshlrev_b32 v134, 16, v155
    v_and_b32 v135, 0xffff0000, v155
    v_lshlrev_b32 v136, 16, v156
    v_and_b32 v137, 0xffff0000, v156
    v_lshlrev_b32 v138, 16, v157
    v_and_b32 v139, 0xffff0000, v157
    v_lshlrev_b32 v140, 16, v158
    v_and_b32 v141, 0xffff0000, v158
    v_lshlrev_b32 v142, 16, v159
    v_and_b32 v143, 0xffff0000, v159
    v_lshlrev_b32 v144, 16, v160
    v_and_b32 v145, 0xffff0000, v160
    v_lshlrev_b32 v146, 16, v161
    v_and_b32 v147, 0xffff0000, v161
    v_lshlrev_b32 v148, 16, v162
    v_and_b32 v149, 0xffff0000, v162
    v_lshlrev_b32 v150, 16, v163
    v_and_b32 v151, 0xffff0000, v163
    v_lshlrev_b32 v152, 16, v164
    v_and_b32 v153, 0xffff0000, v164
    v_lshlrev_b32 v154, 16, v165
    v_and_b32 v155, 0xffff0000, v165
    v_lshlrev_b32 v156, 16, v166
    v_and_b32 v157, 0xffff0000, v166
    v_lshlrev_b32 v158, 16, v167
    v_and_b32 v159, 0xffff0000, v167
    v_lshlrev_b32 v160, 16, v168
    v_and_b32 v161, 0xffff0000, v168
    v_lshlrev_b32 v162, 16, v169
    v_and_b32 v163, 0xffff0000, v169
    v_lshlrev_b32 v164, 16, v170
    v_and_b32 v165, 0xffff0000, v170
    v_lshlrev_b32 v166, 16, v171
    v_and_b32 v167, 0xffff0000, v171
    v_lshlrev_b32 v168, 16, v172
    v_and_b32 v169, 0xffff0000, v172
    v_lshlrev_b32 v170, 16, v173
    v_and_b32 v171, 0xffff0000, v173
    v_lshlrev_b32 v172, 16, v174
    v_and_b32 v173, 0xffff0000, v174
    v_lshlrev_b32 v174, 16, v175
    v_and_b32 v175, 0xffff0000, v175
K2_NOWRAW:
K2_PAD_NW:
    s_cbranch_execz KS_HOP
    v_mul_u32_u24 v178, 1280, v178
    v_add_lshl_u32 v179, v179, v178, 2
    s_mov_b32 s66, 7340032
    v_mov_b32 v201, 1
    s_movk_i32 s58, 600
    s_movk_i32 s59, 2400
    s_mov_b32 s60, 0x40000
    s_mov_b32 s61, 0xffff
    v_mov_b32 v202, 65536
    s_cmp_lg_u32 s24, 0
    s_cbranch_scc1 K2_RK_LOAD
    v_cmp_lt_i32 vcc, 20, v180
    s_nop 0
    s_cbranch_vccz K2_NOMORE
    v_mov_b32 v61, 163652
    ds_write_b32 v61, v201
K2_NOMORE:
    v_lshlrev_b32 v72, 4, v176
    s_mov_b32 s64, 7176192
    s_mov_b32 s62, 84736
    s_cmp_eq_u32 s20, 7
    s_waitcnt vmcnt(0)
    s_cbranch_scc1 K2_FLGLD
K2_FLGL2:
    s_mov_b64 exec, s[40:41]
    s_cbranch_execz K2_RK_A
K2_CK0:
    v_bfi_b32 v192, s61, v1, v2
    v_lshrrev_b32 v50, 24, v3
    v_cmp_ne_u32 vcc, s2, v192
    v_add_u32 v40, 163424, v50
    s_cbranch_vccnz K2_RT0
    ds_add_rtn_u32 v40, v40, v201
    v_mad_u32_u24 v50, v50, s58, v202
    s_mov_b64 exec, s[42:43]
    s_cbranch_execz K2_RK_A
K2_CK1:
    v_bfi_b32 v192, s61, v5, v6
    v_lshrrev_b32 v51, 24, v7
    v_cmp_ne_u32 vcc, s2, v192
    v_add_u32 v41, 163424, v51
    s_cbranch_vccnz K2_RT1
    ds_add_rtn_u32 v41, v41, v201
    v_mad_u32_u24 v51, v51, s58, v202
    s_mov_b64 exec, s[44:45]
    s_cbranch_execz K2_RK_A
K2_CK2:
    v_bfi_b32 v192, s61, v9, v10
    v_lshrrev_b32 v52, 24, v11
    v_cmp_ne_u32 vcc, s2, v192
    v_add_u32 v42, 163424, v52
    s_cbranch_vccnz K2_RT2
    ds_add_rtn_u32 v42, v42, v201
    v_mad_u32_u24 v52, v52, s58, v202
    s_mov_b64 exec, s[46:47]
    s_cbranch_execz K2_RK_A
K2_CK3:
    v_bfi_b32 v192, s61, v13, v14
    v_lshrrev_b32 v53, 24, v15
    v_cmp_ne_u32 vcc, s2, v192
    v_add_u32 v43, 163424, v53
    s_cbranch_vccnz K2_RT3
    ds_add_rtn_u32 v43, v43, v201
    v_mad_u32_u24 v53, v53, s58, v202
    s_mov_b64 exec, s[48:49]
    s_cbranch_execz K2_RK_A
K2_CK4:
    v_bfi_b32 v192, s61, v17, v18
    v_lshrrev_b32 v54, 24, v19
    v_cmp_ne_u32 vcc, s2, v192
    v_add_u32 v44, 163424, v54
    s_cbranch_vccnz K2_RT4
    ds_add_rtn_u32 v44, v44, v201
    v_mad_u32_u24 v54, v54, s58, v202
    s_mov_b64 exec, s[50:51]
    s_cbranch_execz K2_RK_A
K2_CK5:
    v_bfi_b32 v192, s61, v21, v22
    v_lshrrev_b32 v55, 24, v23
    v_cmp_ne_u32 vcc, s2, v192
    v_add_u32 v45, 163424, v55
    s_cbranch_vccnz K2_RT5
    ds_add_rtn_u32 v45, v45, v201
    v_mad_u32_u24 v55, v55, s58, v202
    s_mov_b64 exec, s[90:91]
    s_cbranch_execz K2_RK_A
K2_CK6:
    v_bfi_b32 v192, s61, v25, v26
    v_lshrrev_b32 v56, 24, v27
    v_cmp_ne_u32 vcc, s2, v192
    v_add_u32 v46, 163424, v56
    s_cbranch_vccnz K2_RT6
    ds_add_rtn_u32 v46, v46, v201
    v_mad_u32_u24 v56, v56, s58, v202
    s_mov_b64 exec, s[92:93]
    s_cbranch_execz K2_RK_A
K2_CK7:
    v_bfi_b32 v192, s61, v29, v30
    v_lshrrev_b32 v57, 24, v31
    v_cmp_ne_u32 vcc, s2, v192
    v_add_u32 v47, 163424, v57
    s_cbranch_vccnz K2_RT7
    ds_add_rtn_u32 v47, v47, v201
    v_mad_u32_u24 v57, v57, s58, v202
    s_mov_b64 exec, s[94:95]
    s_cbranch_execz K2_RK_A
K2_CK8:
    v_bfi_b32 v192, s61, v33, v34
    v_lshrrev_b32 v58, 24, v35
    v_cmp_ne_u32 vcc, s2, v192
    v_add_u32 v48, 163424, v58
    s_cbranch_vccnz K2_RT8
    ds_add_rtn_u32 v48, v48, v201
    v_mad_u32_u24 v58, v58, s58, v202
    s_mov_b64 exec, s[96:97]
    s_cbranch_execz K2_RK_A
K2_CK9:
    v_bfi_b32 v192, s61, v37, v38
    v_lshrrev_b32 v59, 24, v39
    v_cmp_ne_u32 vcc, s2, v192
    v_add_u32 v49, 163424, v59
    s_cbranch_vccnz K2_RT9
    ds_add_rtn_u32 v49, v49, v201
    v_mad_u32_u24 v59, v59, s58, v202
K2_RK_A:
    s_mov_b64 exec, -1
    s_mov_b64 exec, s[40:41]
    s_cbranch_execz K2_TP
    v_cmp_gt_u32 vcc, s62, v50
    v_and_b32 v3, 0xffffff, v3
    s_mov_b64 exec, vcc
    buffer_load_dword v245, v3, s[16:19], 0 offen
    s_mov_b64 exec, s[42:43]
    s_cbranch_execz K2_TP
    v_cmp_gt_u32 vcc, s62, v51
    v_and_b32 v7, 0xffffff, v7
    s_mov_b64 exec, vcc
    buffer_load_dword v245, v7, s[16:19], 0 offen
    s_mov_b64 exec, s[44:45]
    s_cbranch_execz K2_TP
    v_cmp_gt_u32 vcc, s62, v52
    v_and_b32 v11, 0xffffff, v11
    s_mov_b64 exec, vcc
    buffer_load_dword v245, v11, s[16:19], 0 offen
    s_mov_b64 exec, s[46:47]
    s_cbranch_execz K2_TP
    v_cmp_gt_u32 vcc, s62, v53
    v_and_b32 v15, 0xffffff, v15
    s_mov_b64 exec, vcc
    buffer_load_dword v245, v15, s[16:19], 0 offen
    s_mov_b64 exec, s[48:49]
    s_cbranch_execz K2_TP
    v_cmp_gt_u32 vcc, s62, v54
    v_and_b32 v19, 0xffffff, v19
    s_mov_b64 exec, vcc
    buffer_load_dword v245, v19, s[16:19], 0 offen
    s_mov_b64 exec, s[50:51]
    s_cbranch_execz K2_TP
    v_cmp_gt_u32 vcc, s62, v55
    v_and_b32 v23, 0xffffff, v23
    s_mov_b64 exec, vcc
    buffer_load_dword v245, v23, s[16:19], 0 offen
    s_mov_b64 exec, s[90:91]
    s_cbranch_execz K2_TP
    v_cmp_gt_u32 vcc, s62, v56
    v_and_b32 v27, 0xffffff, v27
    s_mov_b64 exec, vcc
    buffer_load_dword v245, v27, s[16:19], 0 offen
    s_mov_b64 exec, s[92:93]
    s_cbranch_execz K2_TP
    v_cmp_gt_u32 vcc, s62, v57
    v_and_b32 v31, 0xffffff, v31
    s_mov_b64 exec, vcc
    buffer_load_dword v245, v31, s[16:19], 0 offen
    s_mov_b64 exec, s[94:95]
    s_cbranch_execz K2_TP
    v_cmp_gt_u32 vcc, s62, v58
    v_and_b32 v35, 0xffffff, v35
    s_mov_b64 exec, vcc
    buffer_load_dword v245, v35, s[16:19], 0 offen
    s_mov_b64 exec, s[96:97]
    s_cbranch_execz K2_TP
    v_cmp_gt_u32 vcc, s62, v59
    v_and_b32 v39, 0xffffff, v39
    s_mov_b64 exec, vcc
    buffer_load_dword v245, v39, s[16:19], 0 offen
K2_TP:
    s_mov_b64 exec, -1
K2_RK_DONE:
K2_PAD_SC:
    s_cbranch_execz KS_HOP
    s_mul_i32 s67, s24, 48
    s_waitcnt lgkmcnt(0)
    s_mov_b64 exec, s[40:41]
    s_cbranch_execz K2_SC_DONE
    v_cmpx_gt_u32 vcc, 48, v40
    v_lshl_add_u32 v194, v40, 5, v50
    v_lshl_add_u32 v195, v40, 2, v50
    v_lshrrev_b32 v193, 3, v40
    v_mad_i32_i24 v196, v193, -16, v195
    v_and_b32 v193, 1, v193
    v_mad_i32_i24 v196, v193, -14, v196
    ds_write_b32 v194, v3 offset:864
    ds_write_b16 v195, v0 offset:194
    ds_write_b16_d16_hi v195, v0 offset:386
    ds_write_b16_d16_hi v195, v1 offset:578
    ds_write_b16 v196, v2 offset:768
    s_cmp_lg_u64 exec, s[40:41]
    s_cbranch_scc1 K2_OV0
K2_OB0:
    s_mov_b64 exec, s[42:43]
    s_cbranch_execz K2_SC_DONE
    v_cmpx_gt_u32 vcc, 48, v41
    v_lshl_add_u32 v194, v41, 5, v51
    v_lshl_add_u32 v195, v41, 2, v51
    v_lshrrev_b32 v193, 3, v41
    v_mad_i32_i24 v196, v193, -16, v195
    v_and_b32 v193, 1, v193
    v_mad_i32_i24 v196, v193, -14, v196
    ds_write_b32 v194, v7 offset:864
    ds_write_b16 v195, v4 offset:194
    ds_write_b16_d16_hi v195, v4 offset:386
    ds_write_b16_d16_hi v195, v5 offset:578
    ds_write_b16 v196, v6 offset:768
    s_cmp_lg_u64 exec, s[42:43]
    s_cbranch_scc1 K2_OV1
K2_OB1:
    s_mov_b64 exec, s[44:45]
    s_cbranch_execz K2_SC_DONE
    v_cmpx_gt_u32 vcc, 48, v42
    v_lshl_add_u32 v194, v42, 5, v52
    v_lshl_add_u32 v195, v42, 2, v52
    v_lshrrev_b32 v193, 3, v42
    v_mad_i32_i24 v196, v193, -16, v195
    v_and_b32 v193, 1, v193
    v_mad_i32_i24 v196, v193, -14, v196
    ds_write_b32 v194, v11 offset:864
    ds_write_b16 v195, v8 offset:194
    ds_write_b16_d16_hi v195, v8 offset:386
    ds_write_b16_d16_hi v195, v9 offset:578
    ds_write_b16 v196, v10 offset:768
    s_cmp_lg_u64 exec, s[44:45]
    s_cbranch_scc1 K2_OV2
K2_OB2:
    s_mov_b64 exec, s[46:47]
    s_cbranch_execz K2_SC_DONE
    v_cmpx_gt_u32 vcc, 48, v43
    v_lshl_add_u32 v194, v43, 5, v53
    v_lshl_add_u32 v195, v43, 2, v53
    v_lshrrev_b32 v193, 3, v43
    v_mad_i32_i24 v196, v193, -16, v195
    v_and_b32 v193, 1, v193
    v_mad_i32_i24 v196, v193, -14, v196
    ds_write_b32 v194, v15 offset:864
    ds_write_b16 v195, v12 offset:194
    ds_write_b16_d16_hi v195, v12 offset:386
    ds_write_b16_d16_hi v195, v13 offset:578
    ds_write_b16 v196, v14 offset:768
    s_cmp_lg_u64 exec, s[46:47]
    s_cbranch_scc1 K2_OV3
K2_OB3:
    s_mov_b64 exec, s[48:49]
    s_cbranch_execz K2_SC_DONE
    v_cmpx_gt_u32 vcc, 48, v44
    v_lshl_add_u32 v194, v44, 5, v54
    v_lshl_add_u32 v195, v44, 2, v54
    v_lshrrev_b32 v193, 3, v44
    v_mad_i32_i24 v196, v193, -16, v195
    v_and_b32 v193, 1, v193
    v_mad_i32_i24 v196, v193, -14, v196
    ds_write_b32 v194, v19 offset:864
    ds_write_b16 v195, v16 offset:194
    ds_write_b16_d16_hi v195, v16 offset:386
    ds_write_b16_d16_hi v195, v17 offset:578
    ds_write_b16 v196, v18 offset:768
    s_cmp_lg_u64 exec, s[48:49]
    s_cbranch_scc1 K2_OV4
K2_OB4:
    s_mov_b64 exec, s[50:51]
    s_cbranch_execz K2_SC_DONE
    v_cmpx_gt_u32 vcc, 48, v45
    v_lshl_add_u32 v194, v45, 5, v55
    v_lshl_add_u32 v195, v45, 2, v55
    v_lshrrev_b32 v193, 3, v45
    v_mad_i32_i24 v196, v193, -16, v195
    v_and_b32 v193, 1, v193
    v_mad_i32_i24 v196, v193, -14, v196
    ds_write_b32 v194, v23 offset:864
    ds_write_b16 v195, v20 offset:194
    ds_write_b16_d16_hi v195, v20 offset:386
    ds_write_b16_d16_hi v195, v21 offset:578
    ds_write_b16 v196, v22 offset:768
    s_cmp_lg_u64 exec, s[50:51]
    s_cbranch_scc1 K2_OV5
K2_OB5:
    s_mov_b64 exec, s[90:91]
    s_cbranch_execz K2_SC_DONE
    v_cmpx_gt_u32 vcc, 48, v46
    v_lshl_add_u32 v194, v46, 5, v56
    v_lshl_add_u32 v195, v46, 2, v56
    v_lshrrev_b32 v193, 3, v46
    v_mad_i32_i24 v196, v193, -16, v195
    v_and_b32 v193, 1, v193
    v_mad_i32_i24 v196, v193, -14, v196
    ds_write_b32 v194, v27 offset:864
    ds_write_b16 v195, v24 offset:194
    ds_write_b16_d16_hi v195, v24 offset:386
    ds_write_b16_d16_hi v195, v25 offset:578
    ds_write_b16 v196, v26 offset:768
    s_cmp_lg_u64 exec, s[90:91]
    s_cbranch_scc1 K2_OV6
K2_OB6:
    s_mov_b64 exec, s[92:93]
    s_cbranch_execz K2_SC_DONE
    v_cmpx_gt_u32 vcc, 48, v47
    v_lshl_add_u32 v194, v47, 5, v57
    v_lshl_add_u32 v195, v47, 2, v57
    v_lshrrev_b32 v193, 3, v47
    v_mad_i32_i24 v196, v193, -16, v195
    v_and_b32 v193, 1, v193
    v_mad_i32_i24 v196, v193, -14, v196
    ds_write_b32 v194, v31 offset:864
    ds_write_b16 v195, v28 offset:194
    ds_write_b16_d16_hi v195, v28 offset:386
    ds_write_b16_d16_hi v195, v29 offset:578
    ds_write_b16 v196, v30 offset:768
    s_cmp_lg_u64 exec, s[92:93]
    s_cbranch_scc1 K2_OV7
K2_OB7:
    s_mov_b64 exec, s[94:95]
    s_cbranch_execz K2_SC_DONE
    v_cmpx_gt_u32 vcc, 48, v48
    v_lshl_add_u32 v194, v48, 5, v58
    v_lshl_add_u32 v195, v48, 2, v58
    v_lshrrev_b32 v193, 3, v48
    v_mad_i32_i24 v196, v193, -16, v195
    v_and_b32 v193, 1, v193
    v_mad_i32_i24 v196, v193, -14, v196
    ds_write_b32 v194, v35 offset:864
    ds_write_b16 v195, v32 offset:194
    ds_write_b16_d16_hi v195, v32 offset:386
    ds_write_b16_d16_hi v195, v33 offset:578
    ds_write_b16 v196, v34 offset:768
    s_cmp_lg_u64 exec, s[94:95]
    s_cbranch_scc1 K2_OV8
K2_OB8:
    s_mov_b64 exec, s[96:97]
    s_cbranch_execz K2_SC_DONE
    v_cmpx_gt_u32 vcc, 48, v49
    v_lshl_add_u32 v194, v49, 5, v59
    v_lshl_add_u32 v195, v49, 2, v59
    v_lshrrev_b32 v193, 3, v49
    v_mad_i32_i24 v196, v193, -16, v195
    v_and_b32 v193, 1, v193
    v_mad_i32_i24 v196, v193, -14, v196
    ds_write_b32 v194, v39 offset:864
    ds_write_b16 v195, v36 offset:194
    ds_write_b16_d16_hi v195, v36 offset:386
    ds_write_b16_d16_hi v195, v37 offset:578
    ds_write_b16 v196, v38 offset:768
    s_cmp_lg_u64 exec, s[96:97]
    s_cbranch_scc1 K2_OV9
K2_OB9:
K2_SC_DONE:
    s_mov_b64 exec, -1
K2_PAD_SD:
    s_cbranch_execz KS_HOP
    v_lshlrev_b32 v192, 2, v176
    v_add_u32 v192, 163424, v192
    v_mov_b32 v200, 163652
    v_mov_b32 v198, 0
    s_movk_i32 s26, 48
    s_cmp_eq_u32 s20, 7
    s_cbranch_scc1 K2_FLGCK
K2_FLGOK:
    s_waitcnt lgkmcnt(0)
    s_barrier
    ds_read_b32 v193, v192
    ds_read_b32 v200, v200
    v_cmp_gt_u32 s[56:57], s22, v176
    v_mad_u32_u24 v195, v176, s59, v202
    v_lshl_or_b32 v195, v176, 21, v195
    s_waitcnt lgkmcnt(0)
    v_cndmask_b32 v193, 0, v193, s[56:57]
    v_readfirstlane_b32 s27, v200
    v_cmp_lt_u32 vcc, 48, v193
    s_nop 0
    s_cbranch_vccnz K2_BIG
K2_TOK:
    v_subrev_u32 v194, s67, v193
    v_max_i32 v194, 1, v194
    v_min_i32 v194, s26, v194
    v_add_u32 v194, 15, v194
    v_lshrrev_b32 v194, 4, v194
    v_lshl_or_b32 v195, v194, 18, v195
    v_or_b32 v195, v195, v198
    v_mov_b32 v197, 425056
    v_cndmask_b32 v253, v197, v195, s[56:57]
    s_movk_i32 s40, 0
    s_movk_i32 s41, 256
    s_movk_i32 s42, 512
    s_movk_i32 s43, 768
    s_add_u32 s24, s24, 1
    s_cmp_ge_u32 s24, s25
    s_cselect_b32 s55, 1, 0
    s_cmp_eq_u32 s27, 0
    s_cselect_b32 s55, s55, 0
    s_mov_b32 s27, 0x400000
    s_mov_b32 s38, 0
    s_mov_b32 s34, 0
    s_mov_b32 s35, 0
    s_mov_b32 s36, 1
    s_mov_b32 s31, 0
    s_mov_b32 s58, s20
    v_readlane_b32 s3, v253, s58
    s_lshl_b32 s44, s34, 7
    s_lshl_b32 s60, s58, 5
    s_and_b32 s48, s3, 0x3ffff
    s_bfe_u32 s33, s3, 0x30012
    s_sub_u32 s60, s60, s48
    s_and_b32 s60, s60, 0xff
    s_add_u32 s60, s60, s48
    s_mul_i32 s35, s38, 6
    s_cmp_eq_u32 s34, 0
    s_cselect_b32 s35, s35, s60
    s_mov_b32 s45, s44
    s_add_u32 s47, s44, 256
    s_add_u32 s49, s48, 32
    s_add_u32 s60, s48, 64
    s_cmp_eq_u32 s33, 3
    s_cselect_b32 s46, s44, s47
    s_cselect_b32 s50, s60, s48
    s_cselect_b32 s51, s48, s49
    s_sub_u32 s60, s33, 2
    s_cmp_lt_u32 s60, 2
    s_cbranch_scc0 K2_rare_1
K2_back_2:
    v_add_u32 v233, s48, v230
    ds_read_b32 v232, v233
    ds_read_b32 v233, v233 offset:1024
    v_add_u32 v222, s48, v251
    ds_read_b32 v222, v222
    v_add_u32 v224, s49, v251
    ds_read_b32 v224, v224
    v_add_u32 v226, s50, v251
    ds_read_b32 v226, v226
    v_add_u32 v228, s51, v251
    ds_read_b32 v228, v228
    s_waitcnt lgkmcnt(4)
    v_or_b32 v232, v232, v231
    v_or_b32 v233, v233, v231
    s_cmp_lg_u32 s34, 0
    s_cbranch_scc1 K2_dum_4
    s_add_u32 m0, s48, 864
    s_add_u32 s65, s48, 1888
    buffer_load_dwordx4 v232, s[16:19], 0 offen  lds
    s_mov_b32 m0, s65
    s_mov_b32 exec_hi, 0
    buffer_load_dwordx4 v233, s[16:19], 0 offen  lds
    s_cmp_eq_u32 s33, 4
    s_cbranch_scc1 K2_a4_5
K2_b4_7:
    s_mov_b32 exec_hi, -1
K2_back_6:
    s_waitcnt lgkmcnt(3)
    v_mad_u32_u16 v223, v222, s39, v248 op_sel:[1,0,0,0]
    v_mad_u32_u16 v222, v222, s39, v248
    s_waitcnt lgkmcnt(2)
    v_mad_u32_u16 v225, v224, s39, v248 op_sel:[1,0,0,0]
    v_mad_u32_u16 v224, v224, s39, v248
    s_waitcnt lgkmcnt(1)
    v_mad_u32_u16 v227, v226, s39, v248 op_sel:[1,0,0,0]
    v_mad_u32_u16 v226, v226, s39, v248
    s_waitcnt lgkmcnt(0)
    v_mad_u32_u16 v229, v228, s39, v248 op_sel:[1,0,0,0]
    v_mad_u32_u16 v228, v228, s39, v248
    s_mov_b32 m0, s68
    s_nop 0
    buffer_load_dwordx4 v222, s[4:7], s44 offen sc1 lds
    buffer_load_dwordx4 v223, s[72:75], s44 offen offset:1024 sc1 lds
    s_mov_b32 m0, s69
    s_nop 0
    buffer_load_dwordx4 v224, s[4:7], s45 offen sc1 lds
    buffer_load_dwordx4 v225, s[72:75], s45 offen offset:1024 sc1 lds
    s_mov_b32 m0, s70
    s_nop 0
    buffer_load_dwordx4 v226, s[4:7], s46 offen sc1 lds
    buffer_load_dwordx4 v227, s[72:75], s46 offen offset:1024 sc1 lds
    s_mov_b32 m0, s71
    s_nop 0
    buffer_load_dwordx4 v228, s[4:7], s47 offen sc1 lds
    buffer_load_dwordx4 v229, s[72:75], s47 offen offset:1024 sc1 lds
    v_add_u32 v249, s48, v249
    v_add_u32 v250, s48, v250
    s_waitcnt vmcnt(6)
    ds_read_b64_tr_b16 v[176:177], v246 offset:0
    ds_read_b64_tr_b16 v[178:179], v246 offset:512
    ds_read_b64_tr_b16 v[180:181], v247 offset:0
    ds_read_b64_tr_b16 v[182:183], v247 offset:512
    ds_read_b64_tr_b16 v[0:1], v249 offset:0
    ds_read_b64_tr_b16 v[2:3], v249 offset:128
    ds_read_b128 v[4:7], v250 offset:0
    ds_read_b128 v[8:11], v250 offset:16
    ds_read_b128 v[12:15], v250 offset:384
    ds_read_b128 v[16:19], v250 offset:400
    ds_read_b64_tr_b16 v[20:21], v249 offset:512
    ds_read_b64_tr_b16 v[22:23], v249 offset:640
    ds_read_b128 v[24:27], v250 offset:64
    ds_read_b128 v[28:31], v250 offset:80
    ds_read_b128 v[32:35], v250 offset:448
    ds_read_b128 v[36:39], v250 offset:464
    s_mov_b32 s29, s48
    s_mov_b32 s32, s31
    s_mov_b32 s30, s3
    s_mov_b32 s31, s35
    s_cmp_eq_u32 s33, 2
    s_cbranch_scc1 K2_U20
    s_cmp_eq_u32 s33, 3
    s_cbranch_scc1 K2_U30
    s_cmp_eq_u32 s33, 1
    s_cbranch_scc1 K2_U10
    s_branch K2_U40
K2_PAD_H1:
    s_branch KS_HOP0
KS_HELP:
    s_mov_b32 s30, 0
    s_cmp_eq_u32 s20, 6
    s_cbranch_scc1 KS_RAW
    s_cmp_ge_u32 s2, 200
    s_cbranch_scc1 KS_NOW
    s_mov_b32 s30, 1
    v_and_b32 v1, 15, v8
    v_lshrrev_b32 v3, 4, v8
    s_cmp_ge_u32 s2, 160
    s_cbranch_scc1 K1_WT
    s_cmp_ge_u32 s2, 64
    s_cbranch_scc1 K1_S1
    s_lshr_b32 s24, s2, 3
    s_and_b32 s25, s2, 7
    s_lshr_b32 s26, s25, 2
    s_bfe_u32 s27, s25, 0x10001
    s_and_b32 s28, s25, 1
    s_mov_b32 s60, s92
    s_and_b32 s61, s93, 0xffff
    s_mov_b32 s62, 65536
    s_mov_b32 s63, 0x20000
    s_branch K1_SC
K1_S1:
    s_sub_u32 s29, s2, 64
    s_mul_i32 s24, s29, 43
    s_lshr_b32 s24, s24, 9
    s_mul_i32 s25, s24, 12
    s_sub_u32 s25, s29, s25
    s_cmp_ge_u32 s25, 6
    s_cselect_b32 s26, 1, 0
    s_mul_i32 s27, s26, 6
    s_sub_u32 s27, s25, s27
    s_lshr_b32 s27, s27, 1
    s_and_b32 s28, s25, 1
    s_add_u32 s25, s25, 8
    s_mov_b32 s60, s94
    s_and_b32 s61, s95, 0xffff
    s_mov_b32 s62, 98304
    s_mov_b32 s63, 0x20000
K1_SC:
    s_lshl_b32 s27, s27, 7
    s_lshl_b32 s26, s26, 6
    s_lshl_b32 s28, s28, 4
    s_add_u32 s27, s27, s26
    s_add_u32 s27, s27, s28
    s_lshl_b32 s27, s27, 8
    s_lshl_b32 s26, s24, 5
    s_add_u32 s27, s27, s26
    s_add_u32 s29, s27, 8192
    v_lshlrev_b32 v3, 10, v3
    v_lshl_add_u32 v3, v1, 1, v3
    buffer_load_ushort v64, v3, s[60:63], s27 offen offset:0
    buffer_load_ushort v65, v3, s[60:63], s29 offen offset:0
    buffer_load_ushort v66, v3, s[60:63], s27 offen offset:256
    buffer_load_ushort v67, v3, s[60:63], s29 offen offset:256
    buffer_load_ushort v68, v3, s[60:63], s27 offen offset:512
    buffer_load_ushort v69, v3, s[60:63], s29 offen offset:512
    buffer_load_ushort v70, v3, s[60:63], s27 offen offset:768
    buffer_load_ushort v71, v3, s[60:63], s29 offen offset:768
    s_mul_i32 s24, s24, 20
    s_add_u32 s24, s24, s25
    s_lshl_b32 s24, s24, 10
    s_add_u32 s24, s24, 6946816
    s_branch K1_GO
K1_WT:
    s_sub_u32 s24, s2, 160
    s_cmp_ge_u32 s24, 20
    s_cselect_b32 s26, 1, 0
    s_mul_i32 s25, s26, 20
    s_sub_u32 s25, s24, s25
    s_lshr_b32 s27, s25, 2
    s_bfe_u32 s28, s25, 0x10001
    s_and_b32 s25, s25, 1
    s_mul_i32 s25, s25, 10240
    s_lshl_b32 s27, s27, 8
    s_lshl_b32 s26, s26, 7
    s_lshl_b32 s28, s28, 6
    s_add_u32 s27, s27, s26
    s_add_u32 s27, s27, s28
    s_add_u32 s27, s27, s25
    s_mov_b32 s60, s90
    s_and_b32 s61, s91, 0xffff
    s_mov_b32 s62, 20480
    s_mov_b32 s63, 0x20000
    v_and_b32 v1, 31, v8
    v_lshrrev_b32 v3, 5, v8
    v_mul_u32_u24 v3, 5120, v3
    v_lshl_add_u32 v3, v1, 1, v3
    v_mov_b32 v64, 0
    v_mov_b32 v66, 0
    v_mov_b32 v68, 0
    v_mov_b32 v70, 0
    buffer_load_ushort v65, v3, s[60:63], s27 offen offset:0
    buffer_load_ushort v67, v3, s[60:63], s27 offen offset:1280
    buffer_load_ushort v69, v3, s[60:63], s27 offen offset:2560
    buffer_load_ushort v71, v3, s[60:63], s27 offen offset:3840
    s_lshl_b32 s24, s24, 10
    s_add_u32 s24, s24, 7110656
K1_GO:
KS_NOW:
    s_barrier
K2_PAD_H2:
    s_cbranch_execz KS_HOP0
KS_FILL:
    v_subrev_u32 v76, 320, v0
    v_mov_b32 v80, -1
    v_mov_b32 v77, 1.0
    v_cmp_gt_u32 vcc, 48, v76
    v_lshlrev_b32 v78, 4, v76
    v_add_u32 v78, 65536, v78
    v_cndmask_b32 v80, v80, 0, vcc
    v_cmp_gt_u32 vcc, 12, v76
    v_add_u32 v79, 64800, v78
    s_nop 0
    v_cndmask_b32 v80, v80, v77, vcc
    v_cmp_gt_u32 s[56:57], 54, v8
    v_mov_b32 v81, v80
    v_mov_b32 v82, v80
    v_mov_b32 v83, v80
    ds_write_b128 v78, v[80:83] offset:0
    ds_write_b128 v78, v[80:83] offset:2400
    ds_write_b128 v78, v[80:83] offset:4800
    ds_write_b128 v78, v[80:83] offset:7200
    ds_write_b128 v78, v[80:83] offset:9600
    ds_write_b128 v78, v[80:83] offset:12000
    ds_write_b128 v78, v[80:83] offset:14400
    ds_write_b128 v78, v[80:83] offset:16800
    ds_write_b128 v78, v[80:83] offset:19200
    ds_write_b128 v78, v[80:83] offset:21600
    ds_write_b128 v78, v[80:83] offset:24000
    ds_write_b128 v78, v[80:83] offset:26400
    ds_write_b128 v78, v[80:83] offset:28800
    ds_write_b128 v78, v[80:83] offset:31200
    ds_write_b128 v78, v[80:83] offset:33600
    ds_write_b128 v78, v[80:83] offset:36000
    ds_write_b128 v78, v[80:83] offset:38400
    ds_write_b128 v78, v[80:83] offset:40800
    ds_write_b128 v78, v[80:83] offset:43200
    ds_write_b128 v78, v[80:83] offset:45600
    ds_write_b128 v78, v[80:83] offset:48000
    ds_write_b128 v78, v[80:83] offset:50400
    ds_write_b128 v78, v[80:83] offset:52800
    ds_write_b128 v78, v[80:83] offset:55200
    ds_write_b128 v78, v[80:83] offset:57600
    ds_write_b128 v78, v[80:83] offset:60000
    ds_write_b128 v78, v[80:83] offset:62400
    ds_write_b128 v79, v[80:83] offset:0
    ds_write_b128 v79, v[80:83] offset:2400
    ds_write_b128 v79, v[80:83] offset:4800
    ds_write_b128 v79, v[80:83] offset:7200
    ds_write_b128 v79, v[80:83] offset:9600
    ds_write_b128 v79, v[80:83] offset:12000
    ds_write_b128 v79, v[80:83] offset:14400
    ds_write_b128 v79, v[80:83] offset:16800
    ds_write_b128 v79, v[80:83] offset:19200
    ds_write_b128 v79, v[80:83] offset:21600
    ds_write_b128 v79, v[80:83] offset:24000
    ds_write_b128 v79, v[80:83] offset:26400
    ds_write_b128 v79, v[80:83] offset:28800
    v_mov_b32 v59, 163728
    s_barrier
    ds_read_b32 v59, v59
    s_cmp_eq_u32 s20, 6
    s_cselect_b64 exec, s[56:57], -1
    ds_write_b128 v79, v[80:83] offset:31200
    s_mov_b64 exec, -1
    s_waitcnt vmcnt(0) lgkmcnt(0)
    s_cmp_eq_u32 s30, 0
    s_cbranch_scc1 KS_B3
    v_lshl_or_b32 v40, v65, 16, v64
    v_lshl_or_b32 v41, v67, 16, v66
    v_lshl_or_b32 v42, v69, 16, v68
    v_lshl_or_b32 v43, v71, 16, v70
    buffer_store_dwordx4 v[40:43], v9, s[8:11], s24 offen sc1
    s_waitcnt lgkmcnt(0)
    s_barrier
    s_lshl_b32 s24, s2, 2
    s_add_u32 s24, s24, 7176192
    s_mov_b64 exec, 1
    s_waitcnt vmcnt(0)
    buffer_store_dword v59, v6, s[8:11], s24 offen sc1
    s_mov_b64 exec, -1
    s_branch KS_JOIN
K2_PAD_H3:
    s_branch KS_HOP0
KS_RAW:
    s_barrier
    s_mov_b32 s60, s90
    s_and_b32 s61, s91, 0xffff
    s_mov_b32 s62, 20480
    s_mov_b32 s63, 0x20000
    s_mov_b32 m0, 24576
    s_movk_i32 s24, 0
    buffer_load_dwordx4 v9, s[60:63], s24 offen offset:0 lds
    buffer_load_dwordx4 v9, s[60:63], s24 offen offset:1024 lds
    buffer_load_dwordx4 v9, s[60:63], s24 offen offset:2048 lds
    buffer_load_dwordx4 v9, s[60:63], s24 offen offset:3072 lds
    s_mov_b32 m0, 28672
    s_movk_i32 s24, 4096
    buffer_load_dwordx4 v9, s[60:63], s24 offen offset:0 lds
    buffer_load_dwordx4 v9, s[60:63], s24 offen offset:1024 lds
    buffer_load_dwordx4 v9, s[60:63], s24 offen offset:2048 lds
    buffer_load_dwordx4 v9, s[60:63], s24 offen offset:3072 lds
    s_mov_b32 m0, 32768
    s_movk_i32 s24, 8192
    buffer_load_dwordx4 v9, s[60:63], s24 offen offset:0 lds
    buffer_load_dwordx4 v9, s[60:63], s24 offen offset:1024 lds
    buffer_load_dwordx4 v9, s[60:63], s24 offen offset:2048 lds
    buffer_load_dwordx4 v9, s[60:63], s24 offen offset:3072 lds
    s_mov_b32 m0, 36864
    s_movk_i32 s24, 12288
    buffer_load_dwordx4 v9, s[60:63], s24 offen offset:0 lds
    buffer_load_dwordx4 v9, s[60:63], s24 offen offset:1024 lds
    buffer_load_dwordx4 v9, s[60:63], s24 offen offset:2048 lds
    buffer_load_dwordx4 v9, s[60:63], s24 offen offset:3072 lds
    s_mov_b32 m0, 40960
    s_movk_i32 s24, 16384
    buffer_load_dwordx4 v9, s[60:63], s24 offen offset:0 lds
    buffer_load_dwordx4 v9, s[60:63], s24 offen offset:1024 lds
    buffer_load_dwordx4 v9, s[60:63], s24 offen offset:2048 lds
    buffer_load_dwordx4 v9, s[60:63], s24 offen offset:3072 lds
    s_branch KS_FILL
KS_IDLE:
    s_barrier
    v_mul_u32_u24 v76, 2979, v0
    v_lshrrev_b32 v76, 16, v76
    v_mul_u32_u24 v77, 2048, v76
    v_lshl_add_u32 v78, v0, 4, v77
    v_add_u32 v78, 67584, v78
    v_add_u32 v79, 67200, v78
    v_mov_b32 v80, -1
    v_mov_b32 v81, -1
    v_cmp_gt_u32 vcc, 14, v76
    v_cmp_gt_u32 s[56:57], 12, v76
    v_mov_b32 v82, -1
    v_mov_b32 v83, -1
    s_mov_b64 exec, vcc
    ds_write_b128 v78, v[80:83]
    ds_write_b128 v78, v[80:83] offset:33600
    s_mov_b64 exec, s[56:57]
    ds_write_b128 v79, v[80:83]
    s_mov_b64 exec, -1
    s_barrier
    s_branch KS_B3
K2_PAD_U20:
    s_branch K2_HOP
K2_U20:
    s_setprio 1
    s_waitcnt lgkmcnt(6)
    v_lshlrev_b32 v40, 16, v0
    v_and_b32 v41, 0xffff0000, v0
    v_lshlrev_b32 v42, 16, v1
    v_and_b32 v43, 0xffff0000, v1
    v_lshlrev_b32 v44, 16, v2
    v_and_b32 v45, 0xffff0000, v2
    v_lshlrev_b32 v46, 16, v3
    v_and_b32 v47, 0xffff0000, v3
    v_mul_f32 v4, v40, v4
    v_mul_f32 v5, v41, v5
    v_mul_f32 v6, v42, v6
    v_mul_f32 v7, v43, v7
    v_mul_f32 v8, v44, v8
    v_mul_f32 v9, v45, v9
    v_mul_f32 v10, v46, v10
    v_mul_f32 v11, v47, v11
    v_cvt_pk_bf16_f32 v64, v4, v5
    v_cvt_pk_bf16_f32 v65, v6, v7
    v_cvt_pk_bf16_f32 v66, v8, v9
    v_cvt_pk_bf16_f32 v67, v10, v11
    v_mul_f32 v12, v40, v12
    v_mul_f32 v13, v41, v13
    v_mul_f32 v14, v42, v14
    v_mul_f32 v15, v43, v15
    v_mul_f32 v16, v44, v16
    v_mul_f32 v17, v45, v17
    v_mul_f32 v18, v46, v18
    v_mul_f32 v19, v47, v19
    v_cvt_pk_bf16_f32 v68, v12, v13
    v_cvt_pk_bf16_f32 v69, v14, v15
    v_cvt_pk_bf16_f32 v70, v16, v17
    v_cvt_pk_bf16_f32 v71, v18, v19
    s_waitcnt lgkmcnt(0)
    v_lshlrev_b32 v48, 16, v20
    v_and_b32 v49, 0xffff0000, v20
    v_lshlrev_b32 v50, 16, v21
    v_and_b32 v51, 0xffff0000, v21
    v_lshlrev_b32 v52, 16, v22
    v_and_b32 v53, 0xffff0000, v22
    v_lshlrev_b32 v54, 16, v23
    v_and_b32 v55, 0xffff0000, v23
    v_mul_f32 v24, v48, v24
    v_mul_f32 v25, v49, v25
    v_mul_f32 v26, v50, v26
    v_mul_f32 v27, v51, v27
    v_mul_f32 v28, v52, v28
    v_mul_f32 v29, v53, v29
    v_mul_f32 v30, v54, v30
    v_mul_f32 v31, v55, v31
    v_cvt_pk_bf16_f32 v72, v24, v25
    v_cvt_pk_bf16_f32 v73, v26, v27
    v_cvt_pk_bf16_f32 v74, v28, v29
    v_cvt_pk_bf16_f32 v75, v30, v31
    v_mul_f32 v32, v48, v32
    v_mul_f32 v33, v49, v33
    v_mul_f32 v34, v50, v34
    v_mul_f32 v35, v51, v35
    v_mul_f32 v36, v52, v36
    v_mul_f32 v37, v53, v37
    v_mul_f32 v38, v54, v38
    v_mul_f32 v39, v55, v39
    v_cvt_pk_bf16_f32 v76, v32, v33
    v_cvt_pk_bf16_f32 v77, v34, v35
    v_cvt_pk_bf16_f32 v78, v36, v37
    v_cvt_pk_bf16_f32 v79, v38, v39
    s_waitcnt vmcnt(4)
    v_mfma_f32_32x32x16_bf16 v[0:15], v[64:67], v[176:179], 0
    ds_read_b64_tr_b16 v[184:185], v246 offset:2048
    ds_read_b64_tr_b16 v[186:187], v246 offset:2560
    ds_read_b64_tr_b16 v[188:189], v247 offset:2048
    ds_read_b64_tr_b16 v[190:191], v247 offset:2560
    s_mov_b32 m0, s68
    v_mfma_f32_32x32x16_bf16 v[16:31], v[68:71], v[176:179], 0
    buffer_load_dwordx4 v222, s[4:7], s42 offen sc1 lds
    buffer_load_dwordx4 v223, s[72:75], s42 offen offset:1024 sc1 lds
    v_permlane32_swap_b32 v242, v236
    v_permlane32_swap_b32 v243, v237
    s_add_u32 s38, s38, 1
    v_mfma_f32_32x32x16_bf16 v[32:47], v[64:67], v[180:183], 0
    v_permlane32_swap_b32 v244, v238
    v_permlane32_swap_b32 v245, v239
    v_permlane32_swap_b32 v240, v241
    v_add_f32 v242, v242, v236
    v_mfma_f32_32x32x16_bf16 v[48:63], v[68:71], v[180:183], 0
    v_add_f32 v243, v243, v237
    v_add_f32 v244, v244, v238
    v_add_f32 v245, v245, v239
    v_add_f32 v240, -v240, -v241
    v_mov_b32 v254, s52
    v_mov_b32 v255, s38
    s_waitcnt vmcnt(4) lgkmcnt(0)
    v_mfma_f32_32x32x16_bf16 v[0:15], v[72:75], v[184:187], v[0:15]
    ds_read_b64_tr_b16 v[176:177], v246 offset:4096
    ds_read_b64_tr_b16 v[178:179], v246 offset:4608
    ds_read_b64_tr_b16 v[180:181], v247 offset:4096
    ds_read_b64_tr_b16 v[182:183], v247 offset:4608
    s_lshl_b32 s58, s38, 3
    s_add_u32 s58, s58, s20
    s_mov_b32 m0, s69
    v_mfma_f32_32x32x16_bf16 v[16:31], v[76:79], v[184:187], v[16:31]
    buffer_load_dwordx4 v224, s[4:7], s42 offen sc1 lds
    buffer_load_dwordx4 v225, s[72:75], s42 offen offset:1024 sc1 lds
    s_set_gpr_idx_on s32, gpr_idx(DST)
    s_nop 0
    v_cvt_pk_bf16_f32 v195, v242, v243
    v_cvt_pk_bf16_f32 v196, v244, v245
    v_cvt_pk_bf16_f32 v197, v240, v240
    s_set_gpr_idx_off
    s_mov_b64 exec, 1
    ds_write_b32 v254, v255
    s_mov_b64 exec, -1
    s_cmp_lt_u32 s58, s22
    s_cbranch_scc0 K2_dyn_8
K2_back_9:
    v_readlane_b32 s3, v253, s58
    s_lshl_b32 s44, s34, 7
    s_lshl_b32 s60, s58, 5
    s_and_b32 s48, s3, 0x3ffff
    s_bfe_u32 s33, s3, 0x30012
    s_sub_u32 s60, s60, s48
    s_and_b32 s60, s60, 0xff
    s_add_u32 s60, s60, s48
    s_mul_i32 s35, s38, 6
    s_cmp_eq_u32 s34, 0
    s_cselect_b32 s35, s35, s60
    s_mov_b32 s45, s44
    s_add_u32 s47, s44, 256
    s_add_u32 s49, s48, 32
    s_add_u32 s60, s48, 64
    s_cmp_eq_u32 s33, 3
    s_cselect_b32 s46, s44, s47
    s_cselect_b32 s50, s60, s48
    s_cselect_b32 s51, s48, s49
    s_sub_u32 s60, s33, 2
    s_cmp_lt_u32 s60, 2
    s_cbranch_scc0 K2_rare_14
K2_back_15:
    v_mfma_f32_32x32x16_bf16 v[32:47], v[72:75], v[188:191], v[32:47]
    v_add_u32 v233, s48, v230
    ds_read_b32 v232, v233
    ds_read_b32 v233, v233 offset:1024
    v_mul_f32 v234, v0, v96
    v_mul_f32 v236, v8, v128
    v_fmac_f32 v234, v1, v97
    v_fmac_f32 v236, v9, v129
    v_mfma_f32_32x32x16_bf16 v[48:63], v[76:79], v[188:191], v[48:63]
    s_setprio 0
    v_fmac_f32 v234, v2, v98
    v_fmac_f32 v236, v10, v130
    v_fmac_f32 v234, v3, v99
    v_fmac_f32 v236, v11, v131
    v_fmac_f32 v234, v4, v100
    v_fmac_f32 v236, v12, v132
    v_fmac_f32 v234, v5, v101
    v_fmac_f32 v236, v13, v133
    v_fmac_f32 v234, v6, v102
    v_fmac_f32 v236, v14, v134
    v_fmac_f32 v234, v7, v103
    v_fmac_f32 v236, v15, v135
    v_mul_f32 v238, v16, v128
    v_mul_f32 v240, v24, v128
    v_fmac_f32 v238, v17, v129
    v_fmac_f32 v240, v25, v129
    v_fmac_f32 v238, v18, v130
    v_fmac_f32 v240, v26, v130
    v_fmac_f32 v238, v19, v131
    v_fmac_f32 v240, v27, v131
    v_fmac_f32 v238, v20, v132
    v_fmac_f32 v240, v28, v132
    v_fmac_f32 v238, v21, v133
    v_fmac_f32 v240, v29, v133
    v_fmac_f32 v238, v22, v134
    v_fmac_f32 v240, v30, v134
    v_fmac_f32 v238, v23, v135
    v_fmac_f32 v240, v31, v135
    v_mul_f32 v235, v32, v104
    v_mul_f32 v237, v40, v136
    v_fmac_f32 v235, v33, v105
    v_fmac_f32 v237, v41, v137
    v_fmac_f32 v235, v34, v106
    v_fmac_f32 v237, v42, v138
    v_fmac_f32 v235, v35, v107
    v_fmac_f32 v237, v43, v139
    v_fmac_f32 v235, v36, v108
    v_fmac_f32 v237, v44, v140
    v_fmac_f32 v235, v37, v109
    v_fmac_f32 v237, v45, v141
    v_fmac_f32 v235, v38, v110
    v_fmac_f32 v237, v46, v142
    v_fmac_f32 v235, v39, v111
    v_fmac_f32 v237, v47, v143
    v_mul_f32 v239, v48, v136
    v_mul_f32 v241, v56, v136
    v_fmac_f32 v239, v49, v137
    v_fmac_f32 v241, v57, v137
    s_setprio 1
    s_waitcnt vmcnt(4) lgkmcnt(3)
    v_mfma_f32_32x32x16_bf16 v[0:15], v[64:67], v[176:179], 0
    ds_read_b64_tr_b16 v[184:185], v246 offset:6144
    ds_read_b64_tr_b16 v[186:187], v246 offset:6656
    ds_read_b64_tr_b16 v[188:189], v247 offset:6144
    ds_read_b64_tr_b16 v[190:191], v247 offset:6656
    v_fmac_f32 v239, v50, v138
    v_fmac_f32 v241, v58, v138
    s_mov_b32 m0, s70
    v_mfma_f32_32x32x16_bf16 v[16:31], v[68:71], v[176:179], 0
    buffer_load_dwordx4 v222, s[4:7], s43 offen sc1 lds
    buffer_load_dwordx4 v223, s[72:75], s43 offen offset:1024 sc1 lds
    v_fmac_f32 v239, v51, v139
    v_fmac_f32 v241, v59, v139
    v_fmac_f32 v239, v52, v140
    v_fmac_f32 v241, v60, v140
    v_fmac_f32 v239, v53, v141
    v_mfma_f32_32x32x16_bf16 v[32:47], v[64:67], v[180:183], 0
    v_add_u32 v222, s48, v251
    ds_read_b32 v222, v222
    v_fmac_f32 v241, v61, v141
    v_fmac_f32 v239, v54, v142
    v_fmac_f32 v241, v62, v142
    v_fmac_f32 v239, v55, v143
    v_fmac_f32 v241, v63, v143
    v_mfma_f32_32x32x16_bf16 v[48:63], v[68:71], v[180:183], 0
    v_permlane32_swap_b32 v234, v236
    v_permlane32_swap_b32 v235, v237
    v_permlane32_swap_b32 v240, v238
    s_waitcnt lgkmcnt(5)
    v_or_b32 v232, v232, v231
    v_or_b32 v233, v233, v231
    s_cmp_lg_u32 s34, 0
    s_cbranch_scc1 K2_dum_17
    s_add_u32 m0, s48, 864
    s_add_u32 s65, s48, 1888
    buffer_load_dwordx4 v232, s[16:19], 0 offen  lds
    s_mov_b32 m0, s65
    s_mov_b32 exec_hi, 0
    buffer_load_dwordx4 v233, s[16:19], 0 offen  lds
    s_cmp_eq_u32 s33, 4
    s_cbranch_scc1 K2_a4_18
K2_b4_20:
    s_mov_b32 exec_hi, -1
K2_back_19:
    s_waitcnt vmcnt(6) lgkmcnt(1)
    v_mfma_f32_32x32x16_bf16 v[0:15], v[72:75], v[184:187], v[0:15]
    ds_read_b64_tr_b16 v[176:177], v246 offset:0
    ds_read_b64_tr_b16 v[178:179], v246 offset:512
    ds_read_b64_tr_b16 v[180:181], v247 offset:0
    ds_read_b64_tr_b16 v[182:183], v247 offset:512
    v_permlane32_swap_b32 v241, v239
    s_mov_b32 m0, s71
    v_mfma_f32_32x32x16_bf16 v[16:31], v[76:79], v[184:187], v[16:31]
    buffer_load_dwordx4 v224, s[4:7], s43 offen sc1 lds
    buffer_load_dwordx4 v225, s[72:75], s43 offen offset:1024 sc1 lds
    s_waitcnt lgkmcnt(4)
    v_mad_u32_u16 v223, v222, s39, v248 op_sel:[1,0,0,0]
    v_mad_u32_u16 v222, v222, s39, v248
    v_add_f32 v234, v234, v236
    v_add_f32 v235, v235, v237
    v_add_f32 v240, v240, v238
    v_add_f32 v241, v241, v239
    s_set_gpr_idx_on s31, gpr_idx(DST)
    s_nop 0
    v_cvt_pk_bf16_f32 v192, v234, v235
    v_cvt_pk_bf16_f32 v193, v240, v241
    s_set_gpr_idx_off
    v_mfma_f32_32x32x16_bf16 v[32:47], v[72:75], v[188:191], v[32:47]
    v_add_u32 v224, s49, v251
    ds_read_b32 v224, v224
    v_mul_f32 v234, v0, v144
    v_mul_f32 v236, v8, v112
    v_fmac_f32 v234, v1, v145
    v_fmac_f32 v236, v9, v113
    v_fmac_f32 v234, v2, v146
    v_mfma_f32_32x32x16_bf16 v[48:63], v[76:79], v[188:191], v[48:63]
    s_setprio 0
    v_fmac_f32 v236, v10, v114
    v_fmac_f32 v234, v3, v147
    v_fmac_f32 v236, v11, v115
    v_fmac_f32 v234, v4, v148
    v_fmac_f32 v236, v12, v116
    v_fmac_f32 v234, v5, v149
    v_fmac_f32 v236, v13, v117
    v_fmac_f32 v234, v6, v150
    v_fmac_f32 v236, v14, v118
    v_fmac_f32 v234, v7, v151
    v_fmac_f32 v236, v15, v119
    v_mul_f32 v238, v16, v160
    v_mul_f32 v240, v24, v160
    v_fmac_f32 v238, v17, v161
    v_fmac_f32 v240, v25, v161
    v_fmac_f32 v238, v18, v162
    v_fmac_f32 v240, v26, v162
    v_fmac_f32 v238, v19, v163
    v_fmac_f32 v240, v27, v163
    v_fmac_f32 v238, v20, v164
    v_fmac_f32 v240, v28, v164
    v_fmac_f32 v238, v21, v165
    v_fmac_f32 v240, v29, v165
    v_fmac_f32 v238, v22, v166
    v_fmac_f32 v240, v30, v166
    v_fmac_f32 v238, v23, v167
    v_fmac_f32 v240, v31, v167
    v_mul_f32 v235, v32, v152
    v_mul_f32 v237, v40, v120
    v_fmac_f32 v235, v33, v153
    v_fmac_f32 v237, v41, v121
    v_fmac_f32 v235, v34, v154
    v_fmac_f32 v237, v42, v122
    v_fmac_f32 v235, v35, v155
    v_fmac_f32 v237, v43, v123
    v_fmac_f32 v235, v36, v156
    v_fmac_f32 v237, v44, v124
    v_fmac_f32 v235, v37, v157
    v_fmac_f32 v237, v45, v125
    v_fmac_f32 v235, v38, v158
    v_fmac_f32 v237, v46, v126
    v_fmac_f32 v235, v39, v159
    v_fmac_f32 v237, v47, v127
    v_mul_f32 v239, v48, v168
    v_mul_f32 v241, v56, v168
    v_fmac_f32 v239, v49, v169
    v_fmac_f32 v241, v57, v169
    v_fmac_f32 v239, v50, v170
    v_fmac_f32 v241, v58, v170
    v_fmac_f32 v239, v51, v171
    s_setprio 1
    s_waitcnt vmcnt(6) lgkmcnt(1)
    v_mfma_f32_32x32x16_bf16 v[0:15], v[64:67], v[176:179], 0
    ds_read_b64_tr_b16 v[184:185], v246 offset:2048
    ds_read_b64_tr_b16 v[186:187], v246 offset:2560
    ds_read_b64_tr_b16 v[188:189], v247 offset:2048
    ds_read_b64_tr_b16 v[190:191], v247 offset:2560
    v_fmac_f32 v241, v59, v171
    v_fmac_f32 v239, v52, v172
    s_mov_b32 m0, s68
    v_mfma_f32_32x32x16_bf16 v[16:31], v[68:71], v[176:179], 0
    buffer_load_dwordx4 v222, s[4:7], s44 offen sc1 lds
    buffer_load_dwordx4 v223, s[72:75], s44 offen offset:1024 sc1 lds
    s_waitcnt lgkmcnt(4)
    v_mad_u32_u16 v225, v224, s39, v248 op_sel:[1,0,0,0]
    v_mad_u32_u16 v224, v224, s39, v248
    v_fmac_f32 v241, v60, v172
    v_fmac_f32 v239, v53, v173
    v_mfma_f32_32x32x16_bf16 v[32:47], v[64:67], v[180:183], 0
    v_add_u32 v226, s50, v251
    ds_read_b32 v226, v226
    v_fmac_f32 v241, v61, v173
    v_fmac_f32 v239, v54, v174
    v_fmac_f32 v241, v62, v174
    v_fmac_f32 v239, v55, v175
    v_fmac_f32 v241, v63, v175
    v_mfma_f32_32x32x16_bf16 v[48:63], v[68:71], v[180:183], 0
    s_waitcnt vmcnt(6) lgkmcnt(1)
    v_mfma_f32_32x32x16_bf16 v[0:15], v[72:75], v[184:187], v[0:15]
    ds_read_b64_tr_b16 v[176:177], v246 offset:4096
    ds_read_b64_tr_b16 v[178:179], v246 offset:4608
    ds_read_b64_tr_b16 v[180:181], v247 offset:4096
    ds_read_b64_tr_b16 v[182:183], v247 offset:4608
    s_mov_b32 m0, s69
    v_mfma_f32_32x32x16_bf16 v[16:31], v[76:79], v[184:187], v[16:31]
    buffer_load_dwordx4 v224, s[4:7], s45 offen sc1 lds
    buffer_load_dwordx4 v225, s[72:75], s45 offen offset:1024 sc1 lds
    s_waitcnt lgkmcnt(4)
    v_mad_u32_u16 v227, v226, s39, v248 op_sel:[1,0,0,0]
    v_mad_u32_u16 v226, v226, s39, v248
    v_mfma_f32_32x32x16_bf16 v[32:47], v[72:75], v[188:191], v[32:47]
    v_add_u32 v228, s51, v251
    ds_read_b32 v228, v228
    v_mul_f32 v242, v0, v144
    v_fma_f32 v238, v8, v160, -v238
    v_fmac_f32 v242, v1, v145
    v_fmac_f32 v238, v9, v161
    v_fmac_f32 v242, v2, v146
    v_mfma_f32_32x32x16_bf16 v[48:63], v[76:79], v[188:191], v[48:63]
    s_setprio 0
    v_fmac_f32 v238, v10, v162
    v_fmac_f32 v242, v3, v147
    v_fmac_f32 v238, v11, v163
    v_fmac_f32 v242, v4, v148
    v_fmac_f32 v238, v12, v164
    v_fmac_f32 v242, v5, v149
    v_fmac_f32 v238, v13, v165
    v_fmac_f32 v242, v6, v150
    v_fmac_f32 v238, v14, v166
    v_fmac_f32 v242, v7, v151
    v_fmac_f32 v238, v15, v167
    v_fmac_f32 v236, v16, v112
    v_mul_f32 v244, v24, v160
    v_fmac_f32 v236, v17, v113
    v_fmac_f32 v244, v25, v161
    v_fmac_f32 v236, v18, v114
    v_fmac_f32 v244, v26, v162
    v_fmac_f32 v236, v19, v115
    v_fmac_f32 v244, v27, v163
    v_fmac_f32 v236, v20, v116
    v_fmac_f32 v244, v28, v164
    v_fmac_f32 v236, v21, v117
    v_fmac_f32 v244, v29, v165
    v_fmac_f32 v236, v22, v118
    v_fmac_f32 v244, v30, v166
    v_fmac_f32 v236, v23, v119
    v_fmac_f32 v244, v31, v167
    v_mul_f32 v243, v32, v152
    v_fma_f32 v239, v40, v168, -v239
    v_fmac_f32 v243, v33, v153
    v_fmac_f32 v239, v41, v169
    v_fmac_f32 v243, v34, v154
    v_fmac_f32 v239, v42, v170
    v_fmac_f32 v243, v35, v155
    v_fmac_f32 v239, v43, v171
    v_fmac_f32 v243, v36, v156
    v_fmac_f32 v239, v44, v172
    v_fmac_f32 v243, v37, v157
    v_fmac_f32 v239, v45, v173
    v_fmac_f32 v243, v38, v158
    v_fmac_f32 v239, v46, v174
    v_fmac_f32 v243, v39, v159
    v_fmac_f32 v239, v47, v175
    v_fmac_f32 v237, v48, v120
    v_mul_f32 v245, v56, v168
    v_fmac_f32 v237, v49, v121
    v_fmac_f32 v245, v57, v169
    v_fmac_f32 v237, v50, v122
    s_setprio 1
    s_waitcnt vmcnt(4) lgkmcnt(1)
    v_mfma_f32_32x32x16_bf16 v[0:15], v[64:67], v[176:179], 0
    ds_read_b64_tr_b16 v[184:185], v246 offset:6144
    ds_read_b64_tr_b16 v[186:187], v246 offset:6656
    ds_read_b64_tr_b16 v[188:189], v247 offset:6144
    ds_read_b64_tr_b16 v[190:191], v247 offset:6656
    v_fmac_f32 v245, v58, v170
    v_fmac_f32 v237, v51, v123
    s_mov_b32 m0, s70
    v_mfma_f32_32x32x16_bf16 v[16:31], v[68:71], v[176:179], 0
    buffer_load_dwordx4 v226, s[4:7], s46 offen sc1 lds
    buffer_load_dwordx4 v227, s[72:75], s46 offen offset:1024 sc1 lds
    s_waitcnt lgkmcnt(4)
    v_mad_u32_u16 v229, v228, s39, v248 op_sel:[1,0,0,0]
    v_mad_u32_u16 v228, v228, s39, v248
    v_fmac_f32 v245, v59, v171
    v_fmac_f32 v237, v52, v124
    v_mfma_f32_32x32x16_bf16 v[32:47], v[64:67], v[180:183], 0
    v_fmac_f32 v245, v60, v172
    v_fmac_f32 v237, v53, v125
    v_fmac_f32 v245, v61, v173
    v_fmac_f32 v237, v54, v126
    v_fmac_f32 v245, v62, v174
    v_fmac_f32 v237, v55, v127
    v_fmac_f32 v245, v63, v175
    v_mfma_f32_32x32x16_bf16 v[48:63], v[68:71], v[180:183], 0
    v_permlane32_swap_b32 v242, v234
    v_permlane32_swap_b32 v243, v235
    v_add_f32 v242, v242, v234
    v_add_f32 v243, v243, v235
    s_waitcnt vmcnt(4) lgkmcnt(0)
    v_mfma_f32_32x32x16_bf16 v[0:15], v[72:75], v[184:187], v[0:15]
    ds_read_b64_tr_b16 v[176:177], v246 offset:0
    ds_read_b64_tr_b16 v[178:179], v246 offset:512
    ds_read_b64_tr_b16 v[180:181], v247 offset:0
    ds_read_b64_tr_b16 v[182:183], v247 offset:512
    s_sub_u32 s26, s48, s29
    s_mov_b32 s29, s48
    s_mov_b32 m0, s71
    v_mfma_f32_32x32x16_bf16 v[16:31], v[76:79], v[184:187], v[16:31]
    buffer_load_dwordx4 v228, s[4:7], s47 offen sc1 lds
    buffer_load_dwordx4 v229, s[72:75], s47 offen offset:1024 sc1 lds
    s_set_gpr_idx_on s31, gpr_idx(DST)
    s_nop 0
    v_cvt_pk_bf16_f32 v194, v242, v243
    s_set_gpr_idx_off
    s_mov_b32 s30, s3
    s_cmp_eq_u32 s34, 0
    s_cselect_b32 s56, s33, 0
    v_mfma_f32_32x32x16_bf16 v[32:47], v[72:75], v[188:191], v[32:47]
    s_mov_b32 s32, s31
    s_mov_b32 s31, s35
    v_mul_f32 v242, v0, v144
    v_fma_f32 v240, v8, v160, -v240
    v_fmac_f32 v242, v1, v145
    v_fmac_f32 v240, v9, v161
    v_fmac_f32 v242, v2, v146
    v_mfma_f32_32x32x16_bf16 v[48:63], v[76:79], v[188:191], v[48:63]
    s_setprio 0
    v_fmac_f32 v240, v10, v162
    v_fmac_f32 v242, v3, v147
    v_fmac_f32 v240, v11, v163
    v_fmac_f32 v242, v4, v148
    v_fmac_f32 v240, v12, v164
    v_fmac_f32 v242, v5, v149
    v_fmac_f32 v240, v13, v165
    v_fmac_f32 v242, v6, v150
    v_fmac_f32 v240, v14, v166
    v_fmac_f32 v242, v7, v151
    v_fmac_f32 v240, v15, v167
    v_add_u32 v249, s26, v249
    v_add_u32 v250, s26, v250
    v_fma_f32 v244, v16, v160, -v244
    v_fmac_f32 v236, v24, v112
    v_fmac_f32 v244, v17, v161
    v_fmac_f32 v236, v25, v113
    v_fmac_f32 v244, v18, v162
    v_fmac_f32 v236, v26, v114
    v_fmac_f32 v244, v19, v163
    v_fmac_f32 v236, v27, v115
    v_fmac_f32 v244, v20, v164
    v_fmac_f32 v236, v28, v116
    v_fmac_f32 v244, v21, v165
    v_fmac_f32 v236, v29, v117
    v_fmac_f32 v244, v22, v166
    v_fmac_f32 v236, v30, v118
    v_fmac_f32 v244, v23, v167
    v_fmac_f32 v236, v31, v119
    ds_read_b64_tr_b16 v[0:1], v249 offset:0
    ds_read_b64_tr_b16 v[2:3], v249 offset:128
    ds_read_b128 v[4:7], v250 offset:0
    ds_read_b128 v[8:11], v250 offset:16
    ds_read_b128 v[12:15], v250 offset:384
    ds_read_b128 v[16:19], v250 offset:400
    v_mul_f32 v243, v32, v152
    v_fma_f32 v241, v40, v168, -v241
    v_fmac_f32 v243, v33, v153
    v_fmac_f32 v241, v41, v169
    v_fmac_f32 v243, v34, v154
    v_fmac_f32 v241, v42, v170
    v_fmac_f32 v243, v35, v155
    v_fmac_f32 v241, v43, v171
    v_fmac_f32 v243, v36, v156
    v_fmac_f32 v241, v44, v172
    v_fmac_f32 v243, v37, v157
    v_fmac_f32 v241, v45, v173
    v_fmac_f32 v243, v38, v158
    v_fmac_f32 v241, v46, v174
    v_fmac_f32 v243, v39, v159
    v_fmac_f32 v241, v47, v175
    ds_read_b64_tr_b16 v[20:21], v249 offset:512
    ds_read_b64_tr_b16 v[22:23], v249 offset:640
    ds_read_b128 v[24:27], v250 offset:64
    ds_read_b128 v[28:31], v250 offset:80
    ds_read_b128 v[32:35], v250 offset:448
    ds_read_b128 v[36:39], v250 offset:464
    v_fma_f32 v245, v48, v168, -v245
    v_fmac_f32 v237, v56, v120
    v_fmac_f32 v245, v49, v169
    v_fmac_f32 v237, v57, v121
    v_fmac_f32 v245, v50, v170
    v_fmac_f32 v237, v58, v122
    v_fmac_f32 v245, v51, v171
    v_fmac_f32 v237, v59, v123
    v_fmac_f32 v245, v52, v172
    v_fmac_f32 v237, v60, v124
    v_fmac_f32 v245, v53, v173
    v_fmac_f32 v237, v61, v125
    v_fmac_f32 v245, v54, v174
    v_fmac_f32 v237, v62, v126
    v_fmac_f32 v245, v55, v175
    v_fmac_f32 v237, v63, v127
    s_cmp_eq_u32 s56, 2
    s_cbranch_scc1 K2_U20
    s_cmp_eq_u32 s56, 3
    s_cbranch_scc1 K2_U30
    s_branch K2_DSP0
K2_PAD_U30:
    s_branch K2_HOP
K2_U30:
    s_setprio 1
    s_waitcnt lgkmcnt(6)
    v_lshlrev_b32 v40, 16, v0
    v_and_b32 v41, 0xffff0000, v0
    v_lshlrev_b32 v42, 16, v1
    v_and_b32 v43, 0xffff0000, v1
    v_lshlrev_b32 v44, 16, v2
    v_and_b32 v45, 0xffff0000, v2
    v_lshlrev_b32 v46, 16, v3
    v_and_b32 v47, 0xffff0000, v3
    v_mul_f32 v4, v40, v4
    v_mul_f32 v5, v41, v5
    v_mul_f32 v6, v42, v6
    v_mul_f32 v7, v43, v7
    v_mul_f32 v8, v44, v8
    v_mul_f32 v9, v45, v9
    v_mul_f32 v10, v46, v10
    v_mul_f32 v11, v47, v11
    v_cvt_pk_bf16_f32 v64, v4, v5
    v_cvt_pk_bf16_f32 v65, v6, v7
    v_cvt_pk_bf16_f32 v66, v8, v9
    v_cvt_pk_bf16_f32 v67, v10, v11
    v_mul_f32 v12, v40, v12
    v_mul_f32 v13, v41, v13
    v_mul_f32 v14, v42, v14
    v_mul_f32 v15, v43, v15
    v_mul_f32 v16, v44, v16
    v_mul_f32 v17, v45, v17
    v_mul_f32 v18, v46, v18
    v_mul_f32 v19, v47, v19
    v_cvt_pk_bf16_f32 v68, v12, v13
    v_cvt_pk_bf16_f32 v69, v14, v15
    v_cvt_pk_bf16_f32 v70, v16, v17
    v_cvt_pk_bf16_f32 v71, v18, v19
    ds_read_b64_tr_b16 v[0:1], v249 offset:1024
    ds_read_b64_tr_b16 v[2:3], v249 offset:1152
    ds_read_b128 v[4:7], v250 offset:128
    ds_read_b128 v[8:11], v250 offset:144
    ds_read_b128 v[12:15], v250 offset:512
    ds_read_b128 v[16:19], v250 offset:528
    s_waitcnt lgkmcnt(6)
    v_lshlrev_b32 v48, 16, v20
    v_and_b32 v49, 0xffff0000, v20
    v_lshlrev_b32 v50, 16, v21
    v_and_b32 v51, 0xffff0000, v21
    v_lshlrev_b32 v52, 16, v22
    v_and_b32 v53, 0xffff0000, v22
    v_lshlrev_b32 v54, 16, v23
    v_and_b32 v55, 0xffff0000, v23
    v_mul_f32 v24, v48, v24
    v_mul_f32 v25, v49, v25
    v_mul_f32 v26, v50, v26
    v_mul_f32 v27, v51, v27
    v_mul_f32 v28, v52, v28
    v_mul_f32 v29, v53, v29
    v_mul_f32 v30, v54, v30
    v_mul_f32 v31, v55, v31
    v_cvt_pk_bf16_f32 v72, v24, v25
    v_cvt_pk_bf16_f32 v73, v26, v27
    v_cvt_pk_bf16_f32 v74, v28, v29
    v_cvt_pk_bf16_f32 v75, v30, v31
    v_mul_f32 v32, v48, v32
    v_mul_f32 v33, v49, v33
    v_mul_f32 v34, v50, v34
    v_mul_f32 v35, v51, v35
    v_mul_f32 v36, v52, v36
    v_mul_f32 v37, v53, v37
    v_mul_f32 v38, v54, v38
    v_mul_f32 v39, v55, v39
    v_cvt_pk_bf16_f32 v76, v32, v33
    v_cvt_pk_bf16_f32 v77, v34, v35
    v_cvt_pk_bf16_f32 v78, v36, v37
    v_cvt_pk_bf16_f32 v79, v38, v39
    s_waitcnt lgkmcnt(4)
    v_lshlrev_b32 v40, 16, v0
    v_and_b32 v41, 0xffff0000, v0
    v_lshlrev_b32 v42, 16, v1
    v_and_b32 v43, 0xffff0000, v1
    v_lshlrev_b32 v44, 16, v2
    v_and_b32 v45, 0xffff0000, v2
    v_lshlrev_b32 v46, 16, v3
    v_and_b32 v47, 0xffff0000, v3
    s_waitcnt lgkmcnt(2)
    v_mul_f32 v4, v40, v4
    v_mul_f32 v5, v41, v5
    v_mul_f32 v6, v42, v6
    v_mul_f32 v7, v43, v7
    v_mul_f32 v8, v44, v8
    v_mul_f32 v9, v45, v9
    v_mul_f32 v10, v46, v10
    v_mul_f32 v11, v47, v11
    v_cvt_pk_bf16_f32 v80, v4, v5
    v_cvt_pk_bf16_f32 v81, v6, v7
    v_cvt_pk_bf16_f32 v82, v8, v9
    v_cvt_pk_bf16_f32 v83, v10, v11
    s_waitcnt lgkmcnt(0)
    v_mul_f32 v12, v40, v12
    v_mul_f32 v13, v41, v13
    v_mul_f32 v14, v42, v14
    v_mul_f32 v15, v43, v15
    v_mul_f32 v16, v44, v16
    v_mul_f32 v17, v45, v17
    v_mul_f32 v18, v46, v18
    v_mul_f32 v19, v47, v19
    v_cvt_pk_bf16_f32 v84, v12, v13
    v_cvt_pk_bf16_f32 v85, v14, v15
    v_cvt_pk_bf16_f32 v86, v16, v17
    v_cvt_pk_bf16_f32 v87, v18, v19
    s_waitcnt vmcnt(4)
    v_mfma_f32_32x32x16_bf16 v[0:15], v[64:67], v[176:179], 0
    ds_read_b64_tr_b16 v[184:185], v246 offset:2048
    ds_read_b64_tr_b16 v[186:187], v246 offset:2560
    ds_read_b64_tr_b16 v[188:189], v247 offset:2048
    ds_read_b64_tr_b16 v[190:191], v247 offset:2560
    s_mov_b32 m0, s68
    v_mfma_f32_32x32x16_bf16 v[16:31], v[68:71], v[176:179], 0
    buffer_load_dwordx4 v224, s[4:7], s41 offen sc1 lds
    buffer_load_dwordx4 v225, s[72:75], s41 offen offset:1024 sc1 lds
    v_permlane32_swap_b32 v242, v236
    v_permlane32_swap_b32 v243, v237
    s_add_u32 s38, s38, 1
    v_mfma_f32_32x32x16_bf16 v[32:47], v[64:67], v[180:183], 0
    v_permlane32_swap_b32 v244, v238
    v_permlane32_swap_b32 v245, v239
    v_permlane32_swap_b32 v240, v241
    v_add_f32 v242, v242, v236
    v_mfma_f32_32x32x16_bf16 v[48:63], v[68:71], v[180:183], 0
    v_add_f32 v243, v243, v237
    v_add_f32 v244, v244, v238
    v_add_f32 v245, v245, v239
    v_add_f32 v240, -v240, -v241
    v_mov_b32 v254, s52
    v_mov_b32 v255, s38
    s_waitcnt vmcnt(4) lgkmcnt(0)
    v_mfma_f32_32x32x16_bf16 v[0:15], v[72:75], v[184:187], v[0:15]
    ds_read_b64_tr_b16 v[176:177], v246 offset:4096
    ds_read_b64_tr_b16 v[178:179], v246 offset:4608
    ds_read_b64_tr_b16 v[180:181], v247 offset:4096
    ds_read_b64_tr_b16 v[182:183], v247 offset:4608
    s_lshl_b32 s58, s38, 3
    s_add_u32 s58, s58, s20
    s_mov_b32 m0, s69
    v_mfma_f32_32x32x16_bf16 v[16:31], v[76:79], v[184:187], v[16:31]
    buffer_load_dwordx4 v226, s[4:7], s41 offen sc1 lds
    buffer_load_dwordx4 v227, s[72:75], s41 offen offset:1024 sc1 lds
    s_set_gpr_idx_on s32, gpr_idx(DST)
    s_nop 0
    v_cvt_pk_bf16_f32 v195, v242, v243
    v_cvt_pk_bf16_f32 v196, v244, v245
    v_cvt_pk_bf16_f32 v197, v240, v240
    s_set_gpr_idx_off
    s_mov_b64 exec, 1
    ds_write_b32 v254, v255
    s_mov_b64 exec, -1
    s_cmp_lt_u32 s58, s22
    s_cbranch_scc0 K2_dyn_21
K2_back_22:
    v_readlane_b32 s3, v253, s58
    s_lshl_b32 s44, s34, 7
    s_lshl_b32 s60, s58, 5
    s_and_b32 s48, s3, 0x3ffff
    s_bfe_u32 s33, s3, 0x30012
    s_sub_u32 s60, s60, s48
    s_and_b32 s60, s60, 0xff
    s_add_u32 s60, s60, s48
    s_mul_i32 s35, s38, 6
    s_cmp_eq_u32 s34, 0
    s_cselect_b32 s35, s35, s60
    s_mov_b32 s45, s44
    s_add_u32 s47, s44, 256
    s_add_u32 s49, s48, 32
    s_add_u32 s60, s48, 64
    s_cmp_eq_u32 s33, 3
    s_cselect_b32 s46, s44, s47
    s_cselect_b32 s50, s60, s48
    s_cselect_b32 s51, s48, s49
    s_sub_u32 s60, s33, 2
    s_cmp_lt_u32 s60, 2
    s_cbranch_scc0 K2_rare_27
K2_back_28:
    v_mfma_f32_32x32x16_bf16 v[32:47], v[72:75], v[188:191], v[32:47]
    v_add_u32 v233, s48, v230
    ds_read_b32 v232, v233
    ds_read_b32 v233, v233 offset:1024
    v_mfma_f32_32x32x16_bf16 v[48:63], v[76:79], v[188:191], v[48:63]
    s_waitcnt vmcnt(4) lgkmcnt(3)
    v_mfma_f32_32x32x16_bf16 v[0:15], v[80:83], v[176:179], v[0:15]
    ds_read_b64_tr_b16 v[184:185], v246 offset:6144
    ds_read_b64_tr_b16 v[186:187], v246 offset:6656
    ds_read_b64_tr_b16 v[188:189], v247 offset:6144
    ds_read_b64_tr_b16 v[190:191], v247 offset:6656
    s_mov_b32 m0, s70
    v_mfma_f32_32x32x16_bf16 v[16:31], v[84:87], v[176:179], v[16:31]
    buffer_load_dwordx4 v222, s[4:7], s42 offen sc1 lds
    buffer_load_dwordx4 v223, s[72:75], s42 offen offset:1024 sc1 lds
    v_mfma_f32_32x32x16_bf16 v[32:47], v[80:83], v[180:183], v[32:47]
    s_nop 2
    v_mul_f32 v234, v0, v96
    v_mul_f32 v236, v8, v128
    v_fmac_f32 v234, v1, v97
    v_fmac_f32 v236, v9, v129
    v_fmac_f32 v234, v2, v98
    v_fmac_f32 v236, v10, v130
    v_fmac_f32 v234, v3, v99
    v_mfma_f32_32x32x16_bf16 v[48:63], v[84:87], v[180:183], v[48:63]
    s_setprio 0
    s_waitcnt lgkmcnt(4)
    v_or_b32 v232, v232, v231
    v_or_b32 v233, v233, v231
    s_cmp_lg_u32 s34, 0
    s_cbranch_scc1 K2_dum_30
    s_add_u32 m0, s48, 864
    s_add_u32 s65, s48, 1888
    buffer_load_dwordx4 v232, s[16:19], 0 offen  lds
    s_mov_b32 m0, s65
    s_mov_b32 exec_hi, 0
    buffer_load_dwordx4 v233, s[16:19], 0 offen  lds
    s_cmp_eq_u32 s33, 4
    s_cbranch_scc1 K2_a4_31
K2_b4_33:
    s_mov_b32 exec_hi, -1
K2_back_32:
    v_fmac_f32 v236, v11, v131
    v_fmac_f32 v234, v4, v100
    v_fmac_f32 v236, v12, v132
    v_fmac_f32 v234, v5, v101
    v_fmac_f32 v236, v13, v133
    v_fmac_f32 v234, v6, v102
    v_fmac_f32 v236, v14, v134
    v_fmac_f32 v234, v7, v103
    v_fmac_f32 v236, v15, v135
    v_mul_f32 v238, v16, v128
    v_mul_f32 v240, v24, v128
    v_fmac_f32 v238, v17, v129
    v_fmac_f32 v240, v25, v129
    v_fmac_f32 v238, v18, v130
    v_fmac_f32 v240, v26, v130
    v_fmac_f32 v238, v19, v131
    v_fmac_f32 v240, v27, v131
    v_fmac_f32 v238, v20, v132
    v_fmac_f32 v240, v28, v132
    v_fmac_f32 v238, v21, v133
    v_fmac_f32 v240, v29, v133
    v_fmac_f32 v238, v22, v134
    v_fmac_f32 v240, v30, v134
    v_fmac_f32 v238, v23, v135
    v_fmac_f32 v240, v31, v135
    v_mul_f32 v235, v32, v104
    v_mul_f32 v237, v40, v136
    v_fmac_f32 v235, v33, v105
    v_fmac_f32 v237, v41, v137
    v_fmac_f32 v235, v34, v106
    v_fmac_f32 v237, v42, v138
    v_fmac_f32 v235, v35, v107
    v_fmac_f32 v237, v43, v139
    v_fmac_f32 v235, v36, v108
    v_fmac_f32 v237, v44, v140
    v_fmac_f32 v235, v37, v109
    v_fmac_f32 v237, v45, v141
    v_fmac_f32 v235, v38, v110
    v_fmac_f32 v237, v46, v142
    v_fmac_f32 v235, v39, v111
    v_fmac_f32 v237, v47, v143
    v_mul_f32 v239, v48, v136
    v_mul_f32 v241, v56, v136
    s_setprio 1
    s_waitcnt vmcnt(6) lgkmcnt(0)
    v_mfma_f32_32x32x16_bf16 v[0:15], v[64:67], v[184:187], 0
    ds_read_b64_tr_b16 v[176:177], v246 offset:0
    ds_read_b64_tr_b16 v[178:179], v246 offset:512
    ds_read_b64_tr_b16 v[180:181], v247 offset:0
    ds_read_b64_tr_b16 v[182:183], v247 offset:512
    v_fmac_f32 v239, v49, v137
    v_fmac_f32 v241, v57, v137
    s_mov_b32 m0, s71
    v_mfma_f32_32x32x16_bf16 v[16:31], v[68:71], v[184:187], 0
    buffer_load_dwordx4 v224, s[4:7], s42 offen sc1 lds
    buffer_load_dwordx4 v225, s[72:75], s42 offen offset:1024 sc1 lds
    v_fmac_f32 v239, v50, v138
    v_fmac_f32 v241, v58, v138
    v_fmac_f32 v239, v51, v139
    v_fmac_f32 v241, v59, v139
    v_fmac_f32 v239, v52, v140
    v_mfma_f32_32x32x16_bf16 v[32:47], v[64:67], v[188:191], 0
    v_fmac_f32 v241, v60, v140
    v_fmac_f32 v239, v53, v141
    v_fmac_f32 v241, v61, v141
    v_fmac_f32 v239, v54, v142
    v_fmac_f32 v241, v62, v142
    v_fmac_f32 v239, v55, v143
    v_fmac_f32 v241, v63, v143
    v_mfma_f32_32x32x16_bf16 v[48:63], v[68:71], v[188:191], 0
    v_permlane32_swap_b32 v234, v236
    v_permlane32_swap_b32 v235, v237
    v_permlane32_swap_b32 v240, v238
    s_waitcnt vmcnt(6) lgkmcnt(0)
    v_mfma_f32_32x32x16_bf16 v[0:15], v[72:75], v[176:179], v[0:15]
    ds_read_b64_tr_b16 v[184:185], v246 offset:2048
    ds_read_b64_tr_b16 v[186:187], v246 offset:2560
    ds_read_b64_tr_b16 v[188:189], v247 offset:2048
    ds_read_b64_tr_b16 v[190:191], v247 offset:2560
    v_permlane32_swap_b32 v241, v239
    s_mov_b32 m0, s68
    v_mfma_f32_32x32x16_bf16 v[16:31], v[76:79], v[176:179], v[16:31]
    buffer_load_dwordx4 v226, s[4:7], s42 offen sc1 lds
    buffer_load_dwordx4 v227, s[72:75], s42 offen offset:1024 sc1 lds
    v_add_f32 v234, v234, v236
    v_add_f32 v235, v235, v237
    v_add_f32 v240, v240, v238
    v_add_f32 v241, v241, v239
    v_mfma_f32_32x32x16_bf16 v[32:47], v[72:75], v[180:183], v[32:47]
    s_set_gpr_idx_on s31, gpr_idx(DST)
    s_nop 0
    v_cvt_pk_bf16_f32 v192, v234, v235
    v_cvt_pk_bf16_f32 v193, v240, v241
    s_set_gpr_idx_off
    v_mfma_f32_32x32x16_bf16 v[48:63], v[76:79], v[180:183], v[48:63]
    s_waitcnt vmcnt(6) lgkmcnt(0)
    v_mfma_f32_32x32x16_bf16 v[0:15], v[80:83], v[184:187], v[0:15]
    ds_read_b64_tr_b16 v[176:177], v246 offset:4096
    ds_read_b64_tr_b16 v[178:179], v246 offset:4608
    ds_read_b64_tr_b16 v[180:181], v247 offset:4096
    ds_read_b64_tr_b16 v[182:183], v247 offset:4608
    s_mov_b32 m0, s69
    v_mfma_f32_32x32x16_bf16 v[16:31], v[84:87], v[184:187], v[16:31]
    buffer_load_dwordx4 v222, s[4:7], s43 offen sc1 lds
    buffer_load_dwordx4 v223, s[72:75], s43 offen offset:1024 sc1 lds
    v_mfma_f32_32x32x16_bf16 v[32:47], v[80:83], v[188:191], v[32:47]
    s_nop 2
    v_mul_f32 v234, v0, v144
    v_mul_f32 v236, v8, v112
    v_fmac_f32 v234, v1, v145
    v_fmac_f32 v236, v9, v113
    v_fmac_f32 v234, v2, v146
    v_fmac_f32 v236, v10, v114
    v_fmac_f32 v234, v3, v147
    v_mfma_f32_32x32x16_bf16 v[48:63], v[84:87], v[188:191], v[48:63]
    s_setprio 0
    v_fmac_f32 v236, v11, v115
    v_fmac_f32 v234, v4, v148
    v_fmac_f32 v236, v12, v116
    v_fmac_f32 v234, v5, v149
    v_fmac_f32 v236, v13, v117
    v_fmac_f32 v234, v6, v150
    v_fmac_f32 v236, v14, v118
    v_fmac_f32 v234, v7, v151
    v_fmac_f32 v236, v15, v119
    v_mul_f32 v238, v16, v160
    v_mul_f32 v240, v24, v160
    v_fmac_f32 v238, v17, v161
    v_fmac_f32 v240, v25, v161
    v_fmac_f32 v238, v18, v162
    v_fmac_f32 v240, v26, v162
    v_fmac_f32 v238, v19, v163
    v_fmac_f32 v240, v27, v163
    v_fmac_f32 v238, v20, v164
    v_fmac_f32 v240, v28, v164
    v_fmac_f32 v238, v21, v165
    v_fmac_f32 v240, v29, v165
    v_fmac_f32 v238, v22, v166
    v_fmac_f32 v240, v30, v166
    v_fmac_f32 v238, v23, v167
    v_fmac_f32 v240, v31, v167
    v_mul_f32 v235, v32, v152
    v_mul_f32 v237, v40, v120
    v_fmac_f32 v235, v33, v153
    v_fmac_f32 v237, v41, v121
    v_fmac_f32 v235, v34, v154
    v_fmac_f32 v237, v42, v122
    v_fmac_f32 v235, v35, v155
    v_fmac_f32 v237, v43, v123
    v_fmac_f32 v235, v36, v156
    v_fmac_f32 v237, v44, v124
    v_fmac_f32 v235, v37, v157
    v_fmac_f32 v237, v45, v125
    v_fmac_f32 v235, v38, v158
    v_fmac_f32 v237, v46, v126
    v_fmac_f32 v235, v39, v159
    v_fmac_f32 v237, v47, v127
    v_mul_f32 v239, v48, v168
    v_mul_f32 v241, v56, v168
    v_fmac_f32 v239, v49, v169
    v_fmac_f32 v241, v57, v169
    s_setprio 1
    s_waitcnt vmcnt(4) lgkmcnt(0)
    v_mfma_f32_32x32x16_bf16 v[0:15], v[64:67], v[176:179], 0
    ds_read_b64_tr_b16 v[184:185], v246 offset:6144
    ds_read_b64_tr_b16 v[186:187], v246 offset:6656
    ds_read_b64_tr_b16 v[188:189], v247 offset:6144
    ds_read_b64_tr_b16 v[190:191], v247 offset:6656
    v_fmac_f32 v239, v50, v170
    v_fmac_f32 v241, v58, v170
    s_mov_b32 m0, s70
    v_mfma_f32_32x32x16_bf16 v[16:31], v[68:71], v[176:179], 0
    buffer_load_dwordx4 v224, s[4:7], s43 offen sc1 lds
    buffer_load_dwordx4 v225, s[72:75], s43 offen offset:1024 sc1 lds
    v_fmac_f32 v239, v51, v171
    v_fmac_f32 v241, v59, v171
    v_fmac_f32 v239, v52, v172
    v_fmac_f32 v241, v60, v172
    v_fmac_f32 v239, v53, v173
    v_mfma_f32_32x32x16_bf16 v[32:47], v[64:67], v[180:183], 0
    v_add_u32 v222, s48, v251
    ds_read_b32 v222, v222
    v_fmac_f32 v241, v61, v173
    v_fmac_f32 v239, v54, v174
    v_fmac_f32 v241, v62, v174
    v_fmac_f32 v239, v55, v175
    v_fmac_f32 v241, v63, v175
    v_mfma_f32_32x32x16_bf16 v[48:63], v[68:71], v[180:183], 0
    s_waitcnt vmcnt(4) lgkmcnt(1)
    v_mfma_f32_32x32x16_bf16 v[0:15], v[72:75], v[184:187], v[0:15]
    ds_read_b64_tr_b16 v[176:177], v246 offset:0
    ds_read_b64_tr_b16 v[178:179], v246 offset:512
    ds_read_b64_tr_b16 v[180:181], v247 offset:0
    ds_read_b64_tr_b16 v[182:183], v247 offset:512
    s_mov_b32 m0, s71
    v_mfma_f32_32x32x16_bf16 v[16:31], v[76:79], v[184:187], v[16:31]
    buffer_load_dwordx4 v226, s[4:7], s43 offen sc1 lds
    buffer_load_dwordx4 v227, s[72:75], s43 offen offset:1024 sc1 lds
    s_waitcnt lgkmcnt(4)
    v_mad_u32_u16 v223, v222, s39, v248 op_sel:[1,0,0,0]
    v_mad_u32_u16 v222, v222, s39, v248
    v_mfma_f32_32x32x16_bf16 v[32:47], v[72:75], v[188:191], v[32:47]
    v_add_u32 v224, s49, v251
    ds_read_b32 v224, v224
    v_mfma_f32_32x32x16_bf16 v[48:63], v[76:79], v[188:191], v[48:63]
    s_waitcnt vmcnt(4) lgkmcnt(1)
    v_mfma_f32_32x32x16_bf16 v[0:15], v[80:83], v[176:179], v[0:15]
    ds_read_b64_tr_b16 v[184:185], v246 offset:2048
    ds_read_b64_tr_b16 v[186:187], v246 offset:2560
    ds_read_b64_tr_b16 v[188:189], v247 offset:2048
    ds_read_b64_tr_b16 v[190:191], v247 offset:2560
    s_mov_b32 m0, s68
    v_mfma_f32_32x32x16_bf16 v[16:31], v[84:87], v[176:179], v[16:31]
    buffer_load_dwordx4 v222, s[4:7], s44 offen sc1 lds
    buffer_load_dwordx4 v223, s[72:75], s44 offen offset:1024 sc1 lds
    s_waitcnt lgkmcnt(4)
    v_mad_u32_u16 v225, v224, s39, v248 op_sel:[1,0,0,0]
    v_mad_u32_u16 v224, v224, s39, v248
    v_mfma_f32_32x32x16_bf16 v[32:47], v[80:83], v[180:183], v[32:47]
    v_add_u32 v226, s50, v251
    ds_read_b32 v226, v226
    v_mul_f32 v242, v0, v144
    v_fma_f32 v238, v8, v160, -v238
    v_fmac_f32 v242, v1, v145
    v_fmac_f32 v238, v9, v161
    v_fmac_f32 v242, v2, v146
    v_mfma_f32_32x32x16_bf16 v[48:63], v[84:87], v[180:183], v[48:63]
    s_setprio 0
    v_fmac_f32 v238, v10, v162
    v_fmac_f32 v242, v3, v147
    v_fmac_f32 v238, v11, v163
    v_fmac_f32 v242, v4, v148
    v_fmac_f32 v238, v12, v164
    v_fmac_f32 v242, v5, v149
    v_fmac_f32 v238, v13, v165
    v_fmac_f32 v242, v6, v150
    v_fmac_f32 v238, v14, v166
    v_fmac_f32 v242, v7, v151
    v_fmac_f32 v238, v15, v167
    v_fmac_f32 v236, v16, v112
    v_mul_f32 v244, v24, v160
    v_fmac_f32 v236, v17, v113
    v_fmac_f32 v244, v25, v161
    v_fmac_f32 v236, v18, v114
    v_fmac_f32 v244, v26, v162
    v_fmac_f32 v236, v19, v115
    v_fmac_f32 v244, v27, v163
    v_fmac_f32 v236, v20, v116
    v_fmac_f32 v244, v28, v164
    v_fmac_f32 v236, v21, v117
    v_fmac_f32 v244, v29, v165
    v_fmac_f32 v236, v22, v118
    v_fmac_f32 v244, v30, v166
    v_fmac_f32 v236, v23, v119
    v_fmac_f32 v244, v31, v167
    v_mul_f32 v243, v32, v152
    v_fma_f32 v239, v40, v168, -v239
    v_fmac_f32 v243, v33, v153
    v_fmac_f32 v239, v41, v169
    v_fmac_f32 v243, v34, v154
    v_fmac_f32 v239, v42, v170
    v_fmac_f32 v243, v35, v155
    v_fmac_f32 v239, v43, v171
    v_fmac_f32 v243, v36, v156
    v_fmac_f32 v239, v44, v172
    v_fmac_f32 v243, v37, v157
    v_fmac_f32 v239, v45, v173
    v_fmac_f32 v243, v38, v158
    v_fmac_f32 v239, v46, v174
    v_fmac_f32 v243, v39, v159
    v_fmac_f32 v239, v47, v175
    v_fmac_f32 v237, v48, v120
    v_mul_f32 v245, v56, v168
    v_fmac_f32 v237, v49, v121
    v_fmac_f32 v245, v57, v169
    v_fmac_f32 v237, v50, v122
    v_fmac_f32 v245, v58, v170
    v_fmac_f32 v237, v51, v123
    s_setprio 1
    s_waitcnt vmcnt(4) lgkmcnt(1)
    v_mfma_f32_32x32x16_bf16 v[0:15], v[64:67], v[184:187], 0
    ds_read_b64_tr_b16 v[176:177], v246 offset:4096
    ds_read_b64_tr_b16 v[178:179], v246 offset:4608
    ds_read_b64_tr_b16 v[180:181], v247 offset:4096
    ds_read_b64_tr_b16 v[182:183], v247 offset:4608
    v_fmac_f32 v245, v59, v171
    v_fmac_f32 v237, v52, v124
    s_mov_b32 m0, s69
    v_mfma_f32_32x32x16_bf16 v[16:31], v[68:71], v[184:187], 0
    buffer_load_dwordx4 v224, s[4:7], s45 offen sc1 lds
    buffer_load_dwordx4 v225, s[72:75], s45 offen offset:1024 sc1 lds
    s_waitcnt lgkmcnt(4)
    v_mad_u32_u16 v227, v226, s39, v248 op_sel:[1,0,0,0]
    v_mad_u32_u16 v226, v226, s39, v248
    v_fmac_f32 v245, v60, v172
    v_fmac_f32 v237, v53, v125
    v_mfma_f32_32x32x16_bf16 v[32:47], v[64:67], v[188:191], 0
    v_add_u32 v228, s51, v251
    ds_read_b32 v228, v228
    v_fmac_f32 v245, v61, v173
    v_fmac_f32 v237, v54, v126
    v_fmac_f32 v245, v62, v174
    v_fmac_f32 v237, v55, v127
    v_fmac_f32 v245, v63, v175
    v_mfma_f32_32x32x16_bf16 v[48:63], v[68:71], v[188:191], 0
    v_permlane32_swap_b32 v242, v234
    v_permlane32_swap_b32 v243, v235
    v_add_f32 v242, v242, v234
    v_add_f32 v243, v243, v235
    s_waitcnt vmcnt(4) lgkmcnt(1)
    v_mfma_f32_32x32x16_bf16 v[0:15], v[72:75], v[176:179], v[0:15]
    ds_read_b64_tr_b16 v[184:185], v246 offset:6144
    ds_read_b64_tr_b16 v[186:187], v246 offset:6656
    ds_read_b64_tr_b16 v[188:189], v247 offset:6144
    ds_read_b64_tr_b16 v[190:191], v247 offset:6656
    s_mov_b32 m0, s70
    v_mfma_f32_32x32x16_bf16 v[16:31], v[76:79], v[176:179], v[16:31]
    buffer_load_dwordx4 v226, s[4:7], s46 offen sc1 lds
    buffer_load_dwordx4 v227, s[72:75], s46 offen offset:1024 sc1 lds
    s_waitcnt lgkmcnt(4)
    v_mad_u32_u16 v229, v228, s39, v248 op_sel:[1,0,0,0]
    v_mad_u32_u16 v228, v228, s39, v248
    s_sub_u32 s26, s48, s29
    s_mov_b32 s29, s48
    v_mfma_f32_32x32x16_bf16 v[32:47], v[72:75], v[180:183], v[32:47]
    s_set_gpr_idx_on s31, gpr_idx(DST)
    s_nop 0
    v_cvt_pk_bf16_f32 v194, v242, v243
    s_set_gpr_idx_off
    s_mov_b32 s30, s3
    s_cmp_eq_u32 s34, 0
    s_cselect_b32 s56, s33, 0
    s_mov_b32 s32, s31
    v_mfma_f32_32x32x16_bf16 v[48:63], v[76:79], v[180:183], v[48:63]
    s_mov_b32 s31, s35
    s_waitcnt vmcnt(4) lgkmcnt(0)
    v_mfma_f32_32x32x16_bf16 v[0:15], v[80:83], v[184:187], v[0:15]
    ds_read_b64_tr_b16 v[176:177], v246 offset:0
    ds_read_b64_tr_b16 v[178:179], v246 offset:512
    ds_read_b64_tr_b16 v[180:181], v247 offset:0
    ds_read_b64_tr_b16 v[182:183], v247 offset:512
    s_mov_b32 m0, s71
    v_mfma_f32_32x32x16_bf16 v[16:31], v[84:87], v[184:187], v[16:31]
    buffer_load_dwordx4 v228, s[4:7], s47 offen sc1 lds
    buffer_load_dwordx4 v229, s[72:75], s47 offen offset:1024 sc1 lds
    v_mfma_f32_32x32x16_bf16 v[32:47], v[80:83], v[188:191], v[32:47]
    s_nop 2
    v_mul_f32 v242, v0, v144
    v_fma_f32 v240, v8, v160, -v240
    v_fmac_f32 v242, v1, v145
    v_fmac_f32 v240, v9, v161
    v_fmac_f32 v242, v2, v146
    v_fmac_f32 v240, v10, v162
    v_fmac_f32 v242, v3, v147
    v_mfma_f32_32x32x16_bf16 v[48:63], v[84:87], v[188:191], v[48:63]
    s_setprio 0
    v_fmac_f32 v240, v11, v163
    v_fmac_f32 v242, v4, v148
    v_fmac_f32 v240, v12, v164
    v_fmac_f32 v242, v5, v149
    v_fmac_f32 v240, v13, v165
    v_fmac_f32 v242, v6, v150
    v_fmac_f32 v240, v14, v166
    v_fmac_f32 v242, v7, v151
    v_fmac_f32 v240, v15, v167
    v_add_u32 v249, s26, v249
    v_add_u32 v250, s26, v250
    v_fma_f32 v244, v16, v160, -v244
    v_fmac_f32 v236, v24, v112
    v_fmac_f32 v244, v17, v161
    v_fmac_f32 v236, v25, v113
    v_fmac_f32 v244, v18, v162
    v_fmac_f32 v236, v26, v114
    v_fmac_f32 v244, v19, v163
    v_fmac_f32 v236, v27, v115
    v_fmac_f32 v244, v20, v164
    v_fmac_f32 v236, v28, v116
    v_fmac_f32 v244, v21, v165
    v_fmac_f32 v236, v29, v117
    v_fmac_f32 v244, v22, v166
    v_fmac_f32 v236, v30, v118
    v_fmac_f32 v244, v23, v167
    v_fmac_f32 v236, v31, v119
    ds_read_b64_tr_b16 v[0:1], v249 offset:0
    ds_read_b64_tr_b16 v[2:3], v249 offset:128
    ds_read_b128 v[4:7], v250 offset:0
    ds_read_b128 v[8:11], v250 offset:16
    ds_read_b128 v[12:15], v250 offset:384
    ds_read_b128 v[16:19], v250 offset:400
    v_mul_f32 v243, v32, v152
    v_fma_f32 v241, v40, v168, -v241
    v_fmac_f32 v243, v33, v153
    v_fmac_f32 v241, v41, v169
    v_fmac_f32 v243, v34, v154
    v_fmac_f32 v241, v42, v170
    v_fmac_f32 v243, v35, v155
    v_fmac_f32 v241, v43, v171
    v_fmac_f32 v243, v36, v156
    v_fmac_f32 v241, v44, v172
    v_fmac_f32 v243, v37, v157
    v_fmac_f32 v241, v45, v173
    v_fmac_f32 v243, v38, v158
    v_fmac_f32 v241, v46, v174
    v_fmac_f32 v243, v39, v159
    v_fmac_f32 v241, v47, v175
    ds_read_b64_tr_b16 v[20:21], v249 offset:512
    ds_read_b64_tr_b16 v[22:23], v249 offset:640
    ds_read_b128 v[24:27], v250 offset:64
    ds_read_b128 v[28:31], v250 offset:80
    ds_read_b128 v[32:35], v250 offset:448
    ds_read_b128 v[36:39], v250 offset:464
    v_fma_f32 v245, v48, v168, -v245
    v_fmac_f32 v237, v56, v120
    v_fmac_f32 v245, v49, v169
    v_fmac_f32 v237, v57, v121
    v_fmac_f32 v245, v50, v170
    v_fmac_f32 v237, v58, v122
    v_fmac_f32 v245, v51, v171
    v_fmac_f32 v237, v59, v123
    v_fmac_f32 v245, v52, v172
    v_fmac_f32 v237, v60, v124
    v_fmac_f32 v245, v53, v173
    v_fmac_f32 v237, v61, v125
    v_fmac_f32 v245, v54, v174
    v_fmac_f32 v237, v62, v126
    v_fmac_f32 v245, v55, v175
    v_fmac_f32 v237, v63, v127
    s_cmp_eq_u32 s56, 2
    s_cbranch_scc1 K2_U20
    s_cmp_eq_u32 s56, 3
    s_cbranch_scc1 K2_U30
    s_branch K2_DSP0
K2_PAD_U21:
    s_branch K2_HOP
K2_U21:
    s_setprio 1
    s_waitcnt lgkmcnt(6)
    v_lshlrev_b32 v40, 16, v0
    v_and_b32 v41, 0xffff0000, v0
    v_lshlrev_b32 v42, 16, v1
    v_and_b32 v43, 0xffff0000, v1
    v_lshlrev_b32 v44, 16, v2
    v_and_b32 v45, 0xffff0000, v2
    v_lshlrev_b32 v46, 16, v3
    v_and_b32 v47, 0xffff0000, v3
    v_mul_f32 v4, v40, v4
    v_mul_f32 v5, v41, v5
    v_mul_f32 v6, v42, v6
    v_mul_f32 v7, v43, v7
    v_mul_f32 v8, v44, v8
    v_mul_f32 v9, v45, v9
    v_mul_f32 v10, v46, v10
    v_mul_f32 v11, v47, v11
    v_cvt_pk_bf16_f32 v64, v4, v5
    v_cvt_pk_bf16_f32 v65, v6, v7
    v_cvt_pk_bf16_f32 v66, v8, v9
    v_cvt_pk_bf16_f32 v67, v10, v11
    v_mul_f32 v12, v40, v12
    v_mul_f32 v13, v41, v13
    v_mul_f32 v14, v42, v14
    v_mul_f32 v15, v43, v15
    v_mul_f32 v16, v44, v16
    v_mul_f32 v17, v45, v17
    v_mul_f32 v18, v46, v18
    v_mul_f32 v19, v47, v19
    v_cvt_pk_bf16_f32 v68, v12, v13
    v_cvt_pk_bf16_f32 v69, v14, v15
    v_cvt_pk_bf16_f32 v70, v16, v17
    v_cvt_pk_bf16_f32 v71, v18, v19
    s_waitcnt lgkmcnt(0)
    v_lshlrev_b32 v48, 16, v20
    v_and_b32 v49, 0xffff0000, v20
    v_lshlrev_b32 v50, 16, v21
    v_and_b32 v51, 0xffff0000, v21
    v_lshlrev_b32 v52, 16, v22
    v_and_b32 v53, 0xffff0000, v22
    v_lshlrev_b32 v54, 16, v23
    v_and_b32 v55, 0xffff0000, v23
    v_mul_f32 v24, v48, v24
    v_mul_f32 v25, v49, v25
    v_mul_f32 v26, v50, v26
    v_mul_f32 v27, v51, v27
    v_mul_f32 v28, v52, v28
    v_mul_f32 v29, v53, v29
    v_mul_f32 v30, v54, v30
    v_mul_f32 v31, v55, v31
    v_cvt_pk_bf16_f32 v72, v24, v25
    v_cvt_pk_bf16_f32 v73, v26, v27
    v_cvt_pk_bf16_f32 v74, v28, v29
    v_cvt_pk_bf16_f32 v75, v30, v31
    v_mul_f32 v32, v48, v32
    v_mul_f32 v33, v49, v33
    v_mul_f32 v34, v50, v34
    v_mul_f32 v35, v51, v35
    v_mul_f32 v36, v52, v36
    v_mul_f32 v37, v53, v37
    v_mul_f32 v38, v54, v38
    v_mul_f32 v39, v55, v39
    v_cvt_pk_bf16_f32 v76, v32, v33
    v_cvt_pk_bf16_f32 v77, v34, v35
    v_cvt_pk_bf16_f32 v78, v36, v37
    v_cvt_pk_bf16_f32 v79, v38, v39
    s_waitcnt vmcnt(4)
    v_mfma_f32_32x32x16_bf16 v[0:15], v[64:67], v[176:179], 0
    ds_read_b64_tr_b16 v[184:185], v246 offset:2048
    ds_read_b64_tr_b16 v[186:187], v246 offset:2560
    ds_read_b64_tr_b16 v[188:189], v247 offset:2048
    ds_read_b64_tr_b16 v[190:191], v247 offset:2560
    s_mov_b32 m0, s68
    v_mfma_f32_32x32x16_bf16 v[16:31], v[68:71], v[176:179], 0
    buffer_load_dwordx4 v222, s[4:7], s42 offen sc1 lds
    buffer_load_dwordx4 v223, s[72:75], s42 offen offset:1024 sc1 lds
    v_permlane32_swap_b32 v242, v236
    v_permlane32_swap_b32 v243, v237
    v_mov_b32 v254, 163648
    v_mfma_f32_32x32x16_bf16 v[32:47], v[64:67], v[180:183], 0
    v_permlane32_swap_b32 v244, v238
    v_permlane32_swap_b32 v245, v239
    v_permlane32_swap_b32 v240, v241
    v_add_f32 v242, v242, v236
    v_mfma_f32_32x32x16_bf16 v[48:63], v[68:71], v[180:183], 0
    v_add_f32 v243, v243, v237
    v_add_f32 v244, v244, v238
    v_add_f32 v245, v245, v239
    v_add_f32 v240, -v240, -v241
    v_sub_u32 v241, v230, v231
    v_cvt_pk_bf16_f32 v242, v242, v243
    v_mov_b32 v255, 1
    v_lshl_add_u32 v233, v252, 1, s53
    s_mov_b64 exec, 1
    ds_add_rtn_u32 v232, v254, v255
    s_mov_b64 exec, -1
    ds_read_b32 v233, v233
    s_waitcnt vmcnt(4) lgkmcnt(2)
    v_mfma_f32_32x32x16_bf16 v[0:15], v[72:75], v[184:187], v[0:15]
    ds_read_b64_tr_b16 v[176:177], v246 offset:4096
    ds_read_b64_tr_b16 v[178:179], v246 offset:4608
    ds_read_b64_tr_b16 v[180:181], v247 offset:4096
    ds_read_b64_tr_b16 v[182:183], v247 offset:4608
    v_cvt_pk_bf16_f32 v244, v244, v245
    v_cvt_pk_bf16_f32 v240, v240, v240
    s_mov_b32 m0, s69
    v_mfma_f32_32x32x16_bf16 v[16:31], v[76:79], v[184:187], v[16:31]
    buffer_load_dwordx4 v224, s[4:7], s42 offen sc1 lds
    buffer_load_dwordx4 v225, s[72:75], s42 offen offset:1024 sc1 lds
    ds_write_b32 v230, v242 offset:768
    ds_write_b32 v230, v244 offset:1024
    ds_write_b16 v241, v240 offset:1280
    s_waitcnt lgkmcnt(7)
    v_readfirstlane_b32 s58, v232
    v_mfma_f32_32x32x16_bf16 v[32:47], v[72:75], v[188:191], v[32:47]
    s_cmp_lt_u32 s58, s22
    s_cbranch_scc0 K2_nul_34
    s_and_b32 s59, s58, 7
    s_lshr_b32 s60, s58, 3
K2_chk_36:
    v_readlane_b32 s61, v233, s59
    s_nop 0
    s_cmp_gt_u32 s61, s60
    s_cbranch_scc0 K2_spin_35
K2_back_37:
    v_mfma_f32_32x32x16_bf16 v[48:63], v[76:79], v[188:191], v[48:63]
    s_setprio 0
    v_readlane_b32 s3, v253, s58
    s_lshl_b32 s44, s34, 7
    s_lshl_b32 s60, s58, 5
    s_and_b32 s48, s3, 0x3ffff
    s_bfe_u32 s33, s3, 0x30012
    s_sub_u32 s60, s60, s48
    v_mul_f32 v234, v0, v96
    v_mul_f32 v236, v8, v128
    v_fmac_f32 v234, v1, v97
    v_fmac_f32 v236, v9, v129
    v_fmac_f32 v234, v2, v98
    v_fmac_f32 v236, v10, v130
    v_fmac_f32 v234, v3, v99
    v_fmac_f32 v236, v11, v131
    v_fmac_f32 v234, v4, v100
    v_fmac_f32 v236, v12, v132
    v_fmac_f32 v234, v5, v101
    v_fmac_f32 v236, v13, v133
    v_fmac_f32 v234, v6, v102
    v_fmac_f32 v236, v14, v134
    v_fmac_f32 v234, v7, v103
    v_fmac_f32 v236, v15, v135
    v_mul_f32 v238, v16, v128
    v_mul_f32 v240, v24, v128
    v_fmac_f32 v238, v17, v129
    v_fmac_f32 v240, v25, v129
    v_fmac_f32 v238, v18, v130
    v_fmac_f32 v240, v26, v130
    v_fmac_f32 v238, v19, v131
    v_fmac_f32 v240, v27, v131
    v_fmac_f32 v238, v20, v132
    v_fmac_f32 v240, v28, v132
    v_fmac_f32 v238, v21, v133
    v_fmac_f32 v240, v29, v133
    v_fmac_f32 v238, v22, v134
    v_fmac_f32 v240, v30, v134
    v_fmac_f32 v238, v23, v135
    v_fmac_f32 v240, v31, v135
    v_mul_f32 v235, v32, v104
    v_mul_f32 v237, v40, v136
    v_fmac_f32 v235, v33, v105
    v_fmac_f32 v237, v41, v137
    v_fmac_f32 v235, v34, v106
    v_fmac_f32 v237, v42, v138
    v_fmac_f32 v235, v35, v107
    v_fmac_f32 v237, v43, v139
    v_fmac_f32 v235, v36, v108
    v_fmac_f32 v237, v44, v140
    v_fmac_f32 v235, v37, v109
    v_fmac_f32 v237, v45, v141
    v_fmac_f32 v235, v38, v110
    v_fmac_f32 v237, v46, v142
    v_fmac_f32 v235, v39, v111
    v_fmac_f32 v237, v47, v143
    v_mul_f32 v239, v48, v136
    v_mul_f32 v241, v56, v136
    v_fmac_f32 v239, v49, v137
    v_fmac_f32 v241, v57, v137
    s_setprio 1
    s_waitcnt vmcnt(4) lgkmcnt(3)
    v_mfma_f32_32x32x16_bf16 v[0:15], v[64:67], v[176:179], 0
    ds_read_b64_tr_b16 v[184:185], v246 offset:6144
    ds_read_b64_tr_b16 v[186:187], v246 offset:6656
    ds_read_b64_tr_b16 v[188:189], v247 offset:6144
    ds_read_b64_tr_b16 v[190:191], v247 offset:6656
    v_fmac_f32 v239, v50, v138
    v_fmac_f32 v241, v58, v138
    s_mov_b32 m0, s70
    v_mfma_f32_32x32x16_bf16 v[16:31], v[68:71], v[176:179], 0
    buffer_load_dwordx4 v222, s[4:7], s43 offen sc1 lds
    buffer_load_dwordx4 v223, s[72:75], s43 offen offset:1024 sc1 lds
    v_fmac_f32 v239, v51, v139
    v_fmac_f32 v241, v59, v139
    v_fmac_f32 v239, v52, v140
    v_fmac_f32 v241, v60, v140
    v_fmac_f32 v239, v53, v141
    v_mfma_f32_32x32x16_bf16 v[32:47], v[64:67], v[180:183], 0
    s_and_b32 s60, s60, 0xff
    s_add_u32 s35, s60, s48
    s_mov_b32 s45, s44
    s_add_u32 s47, s44, 256
    s_add_u32 s49, s48, 32
    s_add_u32 s60, s48, 64
    s_cmp_eq_u32 s33, 3
    s_cselect_b32 s46, s44, s47
    s_cselect_b32 s50, s60, s48
    s_cselect_b32 s51, s48, s49
    s_sub_u32 s60, s33, 2
    s_cmp_lt_u32 s60, 2
    s_cbranch_scc0 K2_rare_38
K2_back_39:
    v_add_u32 v222, s48, v251
    ds_read_b32 v222, v222
    v_fmac_f32 v241, v61, v141
    v_fmac_f32 v239, v54, v142
    v_fmac_f32 v241, v62, v142
    v_fmac_f32 v239, v55, v143
    v_fmac_f32 v241, v63, v143
    v_mfma_f32_32x32x16_bf16 v[48:63], v[68:71], v[180:183], 0
    v_permlane32_swap_b32 v234, v236
    v_permlane32_swap_b32 v235, v237
    v_permlane32_swap_b32 v240, v238
    s_waitcnt vmcnt(4) lgkmcnt(1)
    v_mfma_f32_32x32x16_bf16 v[0:15], v[72:75], v[184:187], v[0:15]
    ds_read_b64_tr_b16 v[176:177], v246 offset:0
    ds_read_b64_tr_b16 v[178:179], v246 offset:512
    ds_read_b64_tr_b16 v[180:181], v247 offset:0
    ds_read_b64_tr_b16 v[182:183], v247 offset:512
    v_permlane32_swap_b32 v241, v239
    s_mov_b32 m0, s71
    v_mfma_f32_32x32x16_bf16 v[16:31], v[76:79], v[184:187], v[16:31]
    buffer_load_dwordx4 v224, s[4:7], s43 offen sc1 lds
    buffer_load_dwordx4 v225, s[72:75], s43 offen offset:1024 sc1 lds
    s_waitcnt lgkmcnt(4)
    v_mad_u32_u16 v223, v222, s39, v248 op_sel:[1,0,0,0]
    v_mad_u32_u16 v222, v222, s39, v248
    v_lshl_add_u32 v230, v252, 1, s31
    v_add_f32 v234, v234, v236
    v_add_f32 v235, v235, v237
    v_add_f32 v240, v240, v238
    v_add_f32 v241, v241, v239
    v_cvt_pk_bf16_f32 v234, v234, v235
    v_cvt_pk_bf16_f32 v240, v240, v241
    ds_write_b32 v230, v234 offset:0
    ds_write_b32 v230, v240 offset:256
    v_mfma_f32_32x32x16_bf16 v[32:47], v[72:75], v[188:191], v[32:47]
    v_add_u32 v224, s49, v251
    ds_read_b32 v224, v224
    v_mul_f32 v234, v0, v144
    v_mul_f32 v236, v8, v112
    v_fmac_f32 v234, v1, v145
    v_fmac_f32 v236, v9, v113
    v_fmac_f32 v234, v2, v146
    v_mfma_f32_32x32x16_bf16 v[48:63], v[76:79], v[188:191], v[48:63]
    s_setprio 0
    v_fmac_f32 v236, v10, v114
    v_fmac_f32 v234, v3, v147
    v_fmac_f32 v236, v11, v115
    v_fmac_f32 v234, v4, v148
    v_fmac_f32 v236, v12, v116
    v_fmac_f32 v234, v5, v149
    v_fmac_f32 v236, v13, v117
    v_fmac_f32 v234, v6, v150
    v_fmac_f32 v236, v14, v118
    v_fmac_f32 v234, v7, v151
    v_fmac_f32 v236, v15, v119
    v_mul_f32 v238, v16, v160
    v_mul_f32 v240, v24, v160
    v_fmac_f32 v238, v17, v161
    v_fmac_f32 v240, v25, v161
    v_fmac_f32 v238, v18, v162
    v_fmac_f32 v240, v26, v162
    v_fmac_f32 v238, v19, v163
    v_fmac_f32 v240, v27, v163
    v_fmac_f32 v238, v20, v164
    v_fmac_f32 v240, v28, v164
    v_fmac_f32 v238, v21, v165
    v_fmac_f32 v240, v29, v165
    v_fmac_f32 v238, v22, v166
    v_fmac_f32 v240, v30, v166
    v_fmac_f32 v238, v23, v167
    v_fmac_f32 v240, v31, v167
    v_mul_f32 v235, v32, v152
    v_mul_f32 v237, v40, v120
    v_fmac_f32 v235, v33, v153
    v_fmac_f32 v237, v41, v121
    v_fmac_f32 v235, v34, v154
    v_fmac_f32 v237, v42, v122
    v_fmac_f32 v235, v35, v155
    v_fmac_f32 v237, v43, v123
    v_fmac_f32 v235, v36, v156
    v_fmac_f32 v237, v44, v124
    v_fmac_f32 v235, v37, v157
    v_fmac_f32 v237, v45, v125
    v_fmac_f32 v235, v38, v158
    v_fmac_f32 v237, v46, v126
    v_fmac_f32 v235, v39, v159
    v_fmac_f32 v237, v47, v127
    v_mul_f32 v239, v48, v168
    v_mul_f32 v241, v56, v168
    v_fmac_f32 v239, v49, v169
    v_fmac_f32 v241, v57, v169
    v_fmac_f32 v239, v50, v170
    v_fmac_f32 v241, v58, v170
    v_fmac_f32 v239, v51, v171
    s_setprio 1
    s_waitcnt vmcnt(4) lgkmcnt(3)
    v_mfma_f32_32x32x16_bf16 v[0:15], v[64:67], v[176:179], 0
    ds_read_b64_tr_b16 v[184:185], v246 offset:2048
    ds_read_b64_tr_b16 v[186:187], v246 offset:2560
    ds_read_b64_tr_b16 v[188:189], v247 offset:2048
    ds_read_b64_tr_b16 v[190:191], v247 offset:2560
    v_fmac_f32 v241, v59, v171
    v_fmac_f32 v239, v52, v172
    s_mov_b32 m0, s68
    v_mfma_f32_32x32x16_bf16 v[16:31], v[68:71], v[176:179], 0
    buffer_load_dwordx4 v222, s[4:7], s44 offen sc1 lds
    buffer_load_dwordx4 v223, s[72:75], s44 offen offset:1024 sc1 lds
    s_waitcnt lgkmcnt(4)
    v_mad_u32_u16 v225, v224, s39, v248 op_sel:[1,0,0,0]
    v_mad_u32_u16 v224, v224, s39, v248
    v_fmac_f32 v241, v60, v172
    v_fmac_f32 v239, v53, v173
    v_mfma_f32_32x32x16_bf16 v[32:47], v[64:67], v[180:183], 0
    v_add_u32 v226, s50, v251
    ds_read_b32 v226, v226
    v_fmac_f32 v241, v61, v173
    v_fmac_f32 v239, v54, v174
    v_fmac_f32 v241, v62, v174
    v_fmac_f32 v239, v55, v175
    v_fmac_f32 v241, v63, v175
    v_mfma_f32_32x32x16_bf16 v[48:63], v[68:71], v[180:183], 0
    s_waitcnt vmcnt(4) lgkmcnt(1)
    v_mfma_f32_32x32x16_bf16 v[0:15], v[72:75], v[184:187], v[0:15]
    ds_read_b64_tr_b16 v[176:177], v246 offset:4096
    ds_read_b64_tr_b16 v[178:179], v246 offset:4608
    ds_read_b64_tr_b16 v[180:181], v247 offset:4096
    ds_read_b64_tr_b16 v[182:183], v247 offset:4608
    s_mov_b32 m0, s69
    v_mfma_f32_32x32x16_bf16 v[16:31], v[76:79], v[184:187], v[16:31]
    buffer_load_dwordx4 v224, s[4:7], s45 offen sc1 lds
    buffer_load_dwordx4 v225, s[72:75], s45 offen offset:1024 sc1 lds
    s_waitcnt lgkmcnt(4)
    v_mad_u32_u16 v227, v226, s39, v248 op_sel:[1,0,0,0]
    v_mad_u32_u16 v226, v226, s39, v248
    v_mfma_f32_32x32x16_bf16 v[32:47], v[72:75], v[188:191], v[32:47]
    v_add_u32 v228, s51, v251
    ds_read_b32 v228, v228
    v_mul_f32 v242, v0, v144
    v_fma_f32 v238, v8, v160, -v238
    v_fmac_f32 v242, v1, v145
    v_fmac_f32 v238, v9, v161
    v_fmac_f32 v242, v2, v146
    v_mfma_f32_32x32x16_bf16 v[48:63], v[76:79], v[188:191], v[48:63]
    s_setprio 0
    v_fmac_f32 v238, v10, v162
    v_fmac_f32 v242, v3, v147
    v_fmac_f32 v238, v11, v163
    v_fmac_f32 v242, v4, v148
    v_fmac_f32 v238, v12, v164
    v_fmac_f32 v242, v5, v149
    v_fmac_f32 v238, v13, v165
    v_fmac_f32 v242, v6, v150
    v_fmac_f32 v238, v14, v166
    v_fmac_f32 v242, v7, v151
    v_fmac_f32 v238, v15, v167
    v_fmac_f32 v236, v16, v112
    v_mul_f32 v244, v24, v160
    v_fmac_f32 v236, v17, v113
    v_fmac_f32 v244, v25, v161
    v_fmac_f32 v236, v18, v114
    v_fmac_f32 v244, v26, v162
    v_fmac_f32 v236, v19, v115
    v_fmac_f32 v244, v27, v163
    v_fmac_f32 v236, v20, v116
    v_fmac_f32 v244, v28, v164
    v_fmac_f32 v236, v21, v117
    v_fmac_f32 v244, v29, v165
    v_fmac_f32 v236, v22, v118
    v_fmac_f32 v244, v30, v166
    v_fmac_f32 v236, v23, v119
    v_fmac_f32 v244, v31, v167
    v_mul_f32 v243, v32, v152
    v_fma_f32 v239, v40, v168, -v239
    v_fmac_f32 v243, v33, v153
    v_fmac_f32 v239, v41, v169
    v_fmac_f32 v243, v34, v154
    v_fmac_f32 v239, v42, v170
    v_fmac_f32 v243, v35, v155
    v_fmac_f32 v239, v43, v171
    v_fmac_f32 v243, v36, v156
    v_fmac_f32 v239, v44, v172
    v_fmac_f32 v243, v37, v157
    v_fmac_f32 v239, v45, v173
    v_fmac_f32 v243, v38, v158
    v_fmac_f32 v239, v46, v174
    v_fmac_f32 v243, v39, v159
    v_fmac_f32 v239, v47, v175
    v_fmac_f32 v237, v48, v120
    v_mul_f32 v245, v56, v168
    v_fmac_f32 v237, v49, v121
    v_fmac_f32 v245, v57, v169
    v_fmac_f32 v237, v50, v122
    s_setprio 1
    s_waitcnt vmcnt(4) lgkmcnt(1)
    v_mfma_f32_32x32x16_bf16 v[0:15], v[64:67], v[176:179], 0
    ds_read_b64_tr_b16 v[184:185], v246 offset:6144
    ds_read_b64_tr_b16 v[186:187], v246 offset:6656
    ds_read_b64_tr_b16 v[188:189], v247 offset:6144
    ds_read_b64_tr_b16 v[190:191], v247 offset:6656
    v_fmac_f32 v245, v58, v170
    v_fmac_f32 v237, v51, v123
    s_mov_b32 m0, s70
    v_mfma_f32_32x32x16_bf16 v[16:31], v[68:71], v[176:179], 0
    buffer_load_dwordx4 v226, s[4:7], s46 offen sc1 lds
    buffer_load_dwordx4 v227, s[72:75], s46 offen offset:1024 sc1 lds
    s_waitcnt lgkmcnt(4)
    v_mad_u32_u16 v229, v228, s39, v248 op_sel:[1,0,0,0]
    v_mad_u32_u16 v228, v228, s39, v248
    v_fmac_f32 v245, v59, v171
    v_fmac_f32 v237, v52, v124
    v_mfma_f32_32x32x16_bf16 v[32:47], v[64:67], v[180:183], 0
    v_fmac_f32 v245, v60, v172
    v_fmac_f32 v237, v53, v125
    v_fmac_f32 v245, v61, v173
    v_fmac_f32 v237, v54, v126
    v_fmac_f32 v245, v62, v174
    v_fmac_f32 v237, v55, v127
    v_fmac_f32 v245, v63, v175
    v_mfma_f32_32x32x16_bf16 v[48:63], v[68:71], v[180:183], 0
    v_permlane32_swap_b32 v242, v234
    v_permlane32_swap_b32 v243, v235
    v_add_f32 v242, v242, v234
    v_add_f32 v243, v243, v235
    s_waitcnt vmcnt(4) lgkmcnt(0)
    v_mfma_f32_32x32x16_bf16 v[0:15], v[72:75], v[184:187], v[0:15]
    ds_read_b64_tr_b16 v[176:177], v246 offset:0
    ds_read_b64_tr_b16 v[178:179], v246 offset:512
    ds_read_b64_tr_b16 v[180:181], v247 offset:0
    ds_read_b64_tr_b16 v[182:183], v247 offset:512
    v_cvt_pk_bf16_f32 v242, v242, v243
    ds_write_b32 v230, v242 offset:512
    s_mov_b32 m0, s71
    v_mfma_f32_32x32x16_bf16 v[16:31], v[76:79], v[184:187], v[16:31]
    buffer_load_dwordx4 v228, s[4:7], s47 offen sc1 lds
    buffer_load_dwordx4 v229, s[72:75], s47 offen offset:1024 sc1 lds
    s_sub_u32 s26, s48, s29
    s_mov_b32 s29, s48
    s_mov_b32 s30, s3
    s_cmp_lg_u32 s36, 0
    s_cselect_b32 s56, s33, 0
    v_mfma_f32_32x32x16_bf16 v[32:47], v[72:75], v[188:191], v[32:47]
    s_mov_b32 s32, s31
    s_mov_b32 s31, s35
    v_mul_f32 v242, v0, v144
    v_fma_f32 v240, v8, v160, -v240
    v_fmac_f32 v242, v1, v145
    v_fmac_f32 v240, v9, v161
    v_fmac_f32 v242, v2, v146
    v_mfma_f32_32x32x16_bf16 v[48:63], v[76:79], v[188:191], v[48:63]
    s_setprio 0
    v_fmac_f32 v240, v10, v162
    v_fmac_f32 v242, v3, v147
    v_fmac_f32 v240, v11, v163
    v_fmac_f32 v242, v4, v148
    v_fmac_f32 v240, v12, v164
    v_fmac_f32 v242, v5, v149
    v_fmac_f32 v240, v13, v165
    v_fmac_f32 v242, v6, v150
    v_fmac_f32 v240, v14, v166
    v_fmac_f32 v242, v7, v151
    v_fmac_f32 v240, v15, v167
    v_add_u32 v249, s26, v249
    v_add_u32 v250, s26, v250
    v_fma_f32 v244, v16, v160, -v244
    v_fmac_f32 v236, v24, v112
    v_fmac_f32 v244, v17, v161
    v_fmac_f32 v236, v25, v113
    v_fmac_f32 v244, v18, v162
    v_fmac_f32 v236, v26, v114
    v_fmac_f32 v244, v19, v163
    v_fmac_f32 v236, v27, v115
    v_fmac_f32 v244, v20, v164
    v_fmac_f32 v236, v28, v116
    v_fmac_f32 v244, v21, v165
    v_fmac_f32 v236, v29, v117
    v_fmac_f32 v244, v22, v166
    v_fmac_f32 v236, v30, v118
    v_fmac_f32 v244, v23, v167
    v_fmac_f32 v236, v31, v119
    ds_read_b64_tr_b16 v[0:1], v249 offset:0
    ds_read_b64_tr_b16 v[2:3], v249 offset:128
    ds_read_b128 v[4:7], v250 offset:0
    ds_read_b128 v[8:11], v250 offset:16
    ds_read_b128 v[12:15], v250 offset:384
    ds_read_b128 v[16:19], v250 offset:400
    v_mul_f32 v243, v32, v152
    v_fma_f32 v241, v40, v168, -v241
    v_fmac_f32 v243, v33, v153
    v_fmac_f32 v241, v41, v169
    v_fmac_f32 v243, v34, v154
    v_fmac_f32 v241, v42, v170
    v_fmac_f32 v243, v35, v155
    v_fmac_f32 v241, v43, v171
    v_fmac_f32 v243, v36, v156
    v_fmac_f32 v241, v44, v172
    v_fmac_f32 v243, v37, v157
    v_fmac_f32 v241, v45, v173
    v_fmac_f32 v243, v38, v158
    v_fmac_f32 v241, v46, v174
    v_fmac_f32 v243, v39, v159
    v_fmac_f32 v241, v47, v175
    ds_read_b64_tr_b16 v[20:21], v249 offset:512
    ds_read_b64_tr_b16 v[22:23], v249 offset:640
    ds_read_b128 v[24:27], v250 offset:64
    ds_read_b128 v[28:31], v250 offset:80
    ds_read_b128 v[32:35], v250 offset:448
    ds_read_b128 v[36:39], v250 offset:464
    v_fma_f32 v245, v48, v168, -v245
    v_fmac_f32 v237, v56, v120
    v_fmac_f32 v245, v49, v169
    v_fmac_f32 v237, v57, v121
    v_fmac_f32 v245, v50, v170
    v_fmac_f32 v237, v58, v122
    v_fmac_f32 v245, v51, v171
    v_fmac_f32 v237, v59, v123
    v_fmac_f32 v245, v52, v172
    v_fmac_f32 v237, v60, v124
    v_fmac_f32 v245, v53, v173
    v_fmac_f32 v237, v61, v125
    v_fmac_f32 v245, v54, v174
    v_fmac_f32 v237, v62, v126
    v_fmac_f32 v245, v55, v175
    v_fmac_f32 v237, v63, v127
    s_cmp_eq_u32 s56, 2
    s_cbranch_scc1 K2_U21
    s_cmp_eq_u32 s56, 3
    s_cbranch_scc1 K2_U31
    s_branch K2_DSP1
K2_PAD_U31:
    s_branch K2_HOP
K2_U31:
    s_setprio 1
    s_waitcnt lgkmcnt(6)
    v_lshlrev_b32 v40, 16, v0
    v_and_b32 v41, 0xffff0000, v0
    v_lshlrev_b32 v42, 16, v1
    v_and_b32 v43, 0xffff0000, v1
    v_lshlrev_b32 v44, 16, v2
    v_and_b32 v45, 0xffff0000, v2
    v_lshlrev_b32 v46, 16, v3
    v_and_b32 v47, 0xffff0000, v3
    v_mul_f32 v4, v40, v4
    v_mul_f32 v5, v41, v5
    v_mul_f32 v6, v42, v6
    v_mul_f32 v7, v43, v7
    v_mul_f32 v8, v44, v8
    v_mul_f32 v9, v45, v9
    v_mul_f32 v10, v46, v10
    v_mul_f32 v11, v47, v11
    v_cvt_pk_bf16_f32 v64, v4, v5
    v_cvt_pk_bf16_f32 v65, v6, v7
    v_cvt_pk_bf16_f32 v66, v8, v9
    v_cvt_pk_bf16_f32 v67, v10, v11
    v_mul_f32 v12, v40, v12
    v_mul_f32 v13, v41, v13
    v_mul_f32 v14, v42, v14
    v_mul_f32 v15, v43, v15
    v_mul_f32 v16, v44, v16
    v_mul_f32 v17, v45, v17
    v_mul_f32 v18, v46, v18
    v_mul_f32 v19, v47, v19
    v_cvt_pk_bf16_f32 v68, v12, v13
    v_cvt_pk_bf16_f32 v69, v14, v15
    v_cvt_pk_bf16_f32 v70, v16, v17
    v_cvt_pk_bf16_f32 v71, v18, v19
    ds_read_b64_tr_b16 v[0:1], v249 offset:1024
    ds_read_b64_tr_b16 v[2:3], v249 offset:1152
    ds_read_b128 v[4:7], v250 offset:128
    ds_read_b128 v[8:11], v250 offset:144
    ds_read_b128 v[12:15], v250 offset:512
    ds_read_b128 v[16:19], v250 offset:528
    s_waitcnt lgkmcnt(6)
    v_lshlrev_b32 v48, 16, v20
    v_and_b32 v49, 0xffff0000, v20
    v_lshlrev_b32 v50, 16, v21
    v_and_b32 v51, 0xffff0000, v21
    v_lshlrev_b32 v52, 16, v22
    v_and_b32 v53, 0xffff0000, v22
    v_lshlrev_b32 v54, 16, v23
    v_and_b32 v55, 0xffff0000, v23
    v_mul_f32 v24, v48, v24
    v_mul_f32 v25, v49, v25
    v_mul_f32 v26, v50, v26
    v_mul_f32 v27, v51, v27
    v_mul_f32 v28, v52, v28
    v_mul_f32 v29, v53, v29
    v_mul_f32 v30, v54, v30
    v_mul_f32 v31, v55, v31
    v_cvt_pk_bf16_f32 v72, v24, v25
    v_cvt_pk_bf16_f32 v73, v26, v27
    v_cvt_pk_bf16_f32 v74, v28, v29
    v_cvt_pk_bf16_f32 v75, v30, v31
    v_mul_f32 v32, v48, v32
    v_mul_f32 v33, v49, v33
    v_mul_f32 v34, v50, v34
    v_mul_f32 v35, v51, v35
    v_mul_f32 v36, v52, v36
    v_mul_f32 v37, v53, v37
    v_mul_f32 v38, v54, v38
    v_mul_f32 v39, v55, v39
    v_cvt_pk_bf16_f32 v76, v32, v33
    v_cvt_pk_bf16_f32 v77, v34, v35
    v_cvt_pk_bf16_f32 v78, v36, v37
    v_cvt_pk_bf16_f32 v79, v38, v39
    s_waitcnt lgkmcnt(4)
    v_lshlrev_b32 v40, 16, v0
    v_and_b32 v41, 0xffff0000, v0
    v_lshlrev_b32 v42, 16, v1
    v_and_b32 v43, 0xffff0000, v1
    v_lshlrev_b32 v44, 16, v2
    v_and_b32 v45, 0xffff0000, v2
    v_lshlrev_b32 v46, 16, v3
    v_and_b32 v47, 0xffff0000, v3
    s_waitcnt lgkmcnt(2)
    v_mul_f32 v4, v40, v4
    v_mul_f32 v5, v41, v5
    v_mul_f32 v6, v42, v6
    v_mul_f32 v7, v43, v7
    v_mul_f32 v8, v44, v8
    v_mul_f32 v9, v45, v9
    v_mul_f32 v10, v46, v10
    v_mul_f32 v11, v47, v11
    v_cvt_pk_bf16_f32 v80, v4, v5
    v_cvt_pk_bf16_f32 v81, v6, v7
    v_cvt_pk_bf16_f32 v82, v8, v9
    v_cvt_pk_bf16_f32 v83, v10, v11
    s_waitcnt lgkmcnt(0)
    v_mul_f32 v12, v40, v12
    v_mul_f32 v13, v41, v13
    v_mul_f32 v14, v42, v14
    v_mul_f32 v15, v43, v15
    v_mul_f32 v16, v44, v16
    v_mul_f32 v17, v45, v17
    v_mul_f32 v18, v46, v18
    v_mul_f32 v19, v47, v19
    v_cvt_pk_bf16_f32 v84, v12, v13
    v_cvt_pk_bf16_f32 v85, v14, v15
    v_cvt_pk_bf16_f32 v86, v16, v17
    v_cvt_pk_bf16_f32 v87, v18, v19
    s_waitcnt vmcnt(4)
    v_mfma_f32_32x32x16_bf16 v[0:15], v[64:67], v[176:179], 0
    ds_read_b64_tr_b16 v[184:185], v246 offset:2048
    ds_read_b64_tr_b16 v[186:187], v246 offset:2560
    ds_read_b64_tr_b16 v[188:189], v247 offset:2048
    ds_read_b64_tr_b16 v[190:191], v247 offset:2560
    s_mov_b32 m0, s68
    v_mfma_f32_32x32x16_bf16 v[16:31], v[68:71], v[176:179], 0
    buffer_load_dwordx4 v224, s[4:7], s41 offen sc1 lds
    buffer_load_dwordx4 v225, s[72:75], s41 offen offset:1024 sc1 lds
    v_permlane32_swap_b32 v242, v236
    v_permlane32_swap_b32 v243, v237
    v_mov_b32 v254, 163648
    v_mfma_f32_32x32x16_bf16 v[32:47], v[64:67], v[180:183], 0
    v_permlane32_swap_b32 v244, v238
    v_permlane32_swap_b32 v245, v239
    v_permlane32_swap_b32 v240, v241
    v_add_f32 v242, v242, v236
    v_mfma_f32_32x32x16_bf16 v[48:63], v[68:71], v[180:183], 0
    v_add_f32 v243, v243, v237
    v_add_f32 v244, v244, v238
    v_add_f32 v245, v245, v239
    v_add_f32 v240, -v240, -v241
    v_sub_u32 v241, v230, v231
    v_cvt_pk_bf16_f32 v242, v242, v243
    v_mov_b32 v255, 1
    v_lshl_add_u32 v233, v252, 1, s53
    s_mov_b64 exec, 1
    ds_add_rtn_u32 v232, v254, v255
    s_mov_b64 exec, -1
    ds_read_b32 v233, v233
    s_waitcnt vmcnt(4) lgkmcnt(2)
    v_mfma_f32_32x32x16_bf16 v[0:15], v[72:75], v[184:187], v[0:15]
    ds_read_b64_tr_b16 v[176:177], v246 offset:4096
    ds_read_b64_tr_b16 v[178:179], v246 offset:4608
    ds_read_b64_tr_b16 v[180:181], v247 offset:4096
    ds_read_b64_tr_b16 v[182:183], v247 offset:4608
    v_cvt_pk_bf16_f32 v244, v244, v245
    v_cvt_pk_bf16_f32 v240, v240, v240
    s_mov_b32 m0, s69
    v_mfma_f32_32x32x16_bf16 v[16:31], v[76:79], v[184:187], v[16:31]
    buffer_load_dwordx4 v226, s[4:7], s41 offen sc1 lds
    buffer_load_dwordx4 v227, s[72:75], s41 offen offset:1024 sc1 lds
    ds_write_b32 v230, v242 offset:768
    ds_write_b32 v230, v244 offset:1024
    ds_write_b16 v241, v240 offset:1280
    s_waitcnt lgkmcnt(7)
    v_readfirstlane_b32 s58, v232
    v_mfma_f32_32x32x16_bf16 v[32:47], v[72:75], v[188:191], v[32:47]
    s_cmp_lt_u32 s58, s22
    s_cbranch_scc0 K2_nul_41
    s_and_b32 s59, s58, 7
    s_lshr_b32 s60, s58, 3
K2_chk_43:
    v_readlane_b32 s61, v233, s59
    s_nop 0
    s_cmp_gt_u32 s61, s60
    s_cbranch_scc0 K2_spin_42
K2_back_44:
    v_mfma_f32_32x32x16_bf16 v[48:63], v[76:79], v[188:191], v[48:63]
    v_readlane_b32 s3, v253, s58
    s_lshl_b32 s44, s34, 7
    s_lshl_b32 s60, s58, 5
    s_and_b32 s48, s3, 0x3ffff
    s_bfe_u32 s33, s3, 0x30012
    s_sub_u32 s60, s60, s48
    s_waitcnt vmcnt(4) lgkmcnt(3)
    v_mfma_f32_32x32x16_bf16 v[0:15], v[80:83], v[176:179], v[0:15]
    ds_read_b64_tr_b16 v[184:185], v246 offset:6144
    ds_read_b64_tr_b16 v[186:187], v246 offset:6656
    ds_read_b64_tr_b16 v[188:189], v247 offset:6144
    ds_read_b64_tr_b16 v[190:191], v247 offset:6656
    s_and_b32 s60, s60, 0xff
    s_add_u32 s35, s60, s48
    s_mov_b32 m0, s70
    v_mfma_f32_32x32x16_bf16 v[16:31], v[84:87], v[176:179], v[16:31]
    buffer_load_dwordx4 v222, s[4:7], s42 offen sc1 lds
    buffer_load_dwordx4 v223, s[72:75], s42 offen offset:1024 sc1 lds
    s_mov_b32 s45, s44
    s_add_u32 s47, s44, 256
    s_add_u32 s49, s48, 32
    s_add_u32 s60, s48, 64
    v_mfma_f32_32x32x16_bf16 v[32:47], v[80:83], v[180:183], v[32:47]
    s_cmp_eq_u32 s33, 3
    s_cselect_b32 s46, s44, s47
    s_cselect_b32 s50, s60, s48
    s_cselect_b32 s51, s48, s49
    s_sub_u32 s60, s33, 2
    s_cmp_lt_u32 s60, 2
    s_cbranch_scc0 K2_rare_45
K2_back_46:
    v_mfma_f32_32x32x16_bf16 v[48:63], v[84:87], v[180:183], v[48:63]
    s_setprio 0
    v_mul_f32 v234, v0, v96
    v_mul_f32 v236, v8, v128
    v_fmac_f32 v234, v1, v97
    v_fmac_f32 v236, v9, v129
    v_fmac_f32 v234, v2, v98
    v_fmac_f32 v236, v10, v130
    v_fmac_f32 v234, v3, v99
    v_fmac_f32 v236, v11, v131
    v_fmac_f32 v234, v4, v100
    v_fmac_f32 v236, v12, v132
    v_fmac_f32 v234, v5, v101
    v_fmac_f32 v236, v13, v133
    v_fmac_f32 v234, v6, v102
    v_fmac_f32 v236, v14, v134
    v_fmac_f32 v234, v7, v103
    v_fmac_f32 v236, v15, v135
    v_mul_f32 v238, v16, v128
    v_mul_f32 v240, v24, v128
    v_fmac_f32 v238, v17, v129
    v_fmac_f32 v240, v25, v129
    v_fmac_f32 v238, v18, v130
    v_fmac_f32 v240, v26, v130
    v_fmac_f32 v238, v19, v131
    v_fmac_f32 v240, v27, v131
    v_fmac_f32 v238, v20, v132
    v_fmac_f32 v240, v28, v132
    v_fmac_f32 v238, v21, v133
    v_fmac_f32 v240, v29, v133
    v_fmac_f32 v238, v22, v134
    v_fmac_f32 v240, v30, v134
    v_fmac_f32 v238, v23, v135
    v_fmac_f32 v240, v31, v135
    v_mul_f32 v235, v32, v104
    v_mul_f32 v237, v40, v136
    v_fmac_f32 v235, v33, v105
    v_fmac_f32 v237, v41, v137
    v_fmac_f32 v235, v34, v106
    v_fmac_f32 v237, v42, v138
    v_fmac_f32 v235, v35, v107
    v_fmac_f32 v237, v43, v139
    v_fmac_f32 v235, v36, v108
    v_fmac_f32 v237, v44, v140
    v_fmac_f32 v235, v37, v109
    v_fmac_f32 v237, v45, v141
    v_fmac_f32 v235, v38, v110
    v_fmac_f32 v237, v46, v142
    v_fmac_f32 v235, v39, v111
    v_fmac_f32 v237, v47, v143
    v_mul_f32 v239, v48, v136
    v_mul_f32 v241, v56, v136
    s_setprio 1
    s_waitcnt vmcnt(4) lgkmcnt(0)
    v_mfma_f32_32x32x16_bf16 v[0:15], v[64:67], v[184:187], 0
    ds_read_b64_tr_b16 v[176:177], v246 offset:0
    ds_read_b64_tr_b16 v[178:179], v246 offset:512
    ds_read_b64_tr_b16 v[180:181], v247 offset:0
    ds_read_b64_tr_b16 v[182:183], v247 offset:512
    v_fmac_f32 v239, v49, v137
    v_fmac_f32 v241, v57, v137
    s_mov_b32 m0, s71
    v_mfma_f32_32x32x16_bf16 v[16:31], v[68:71], v[184:187], 0
    buffer_load_dwordx4 v224, s[4:7], s42 offen sc1 lds
    buffer_load_dwordx4 v225, s[72:75], s42 offen offset:1024 sc1 lds
    v_fmac_f32 v239, v50, v138
    v_fmac_f32 v241, v58, v138
    v_fmac_f32 v239, v51, v139
    v_fmac_f32 v241, v59, v139
    v_fmac_f32 v239, v52, v140
    v_mfma_f32_32x32x16_bf16 v[32:47], v[64:67], v[188:191], 0
    v_fmac_f32 v241, v60, v140
    v_fmac_f32 v239, v53, v141
    v_fmac_f32 v241, v61, v141
    v_fmac_f32 v239, v54, v142
    v_fmac_f32 v241, v62, v142
    v_fmac_f32 v239, v55, v143
    v_fmac_f32 v241, v63, v143
    v_mfma_f32_32x32x16_bf16 v[48:63], v[68:71], v[188:191], 0
    v_permlane32_swap_b32 v234, v236
    v_permlane32_swap_b32 v235, v237
    v_permlane32_swap_b32 v240, v238
    s_waitcnt vmcnt(4) lgkmcnt(0)
    v_mfma_f32_32x32x16_bf16 v[0:15], v[72:75], v[176:179], v[0:15]
    ds_read_b64_tr_b16 v[184:185], v246 offset:2048
    ds_read_b64_tr_b16 v[186:187], v246 offset:2560
    ds_read_b64_tr_b16 v[188:189], v247 offset:2048
    ds_read_b64_tr_b16 v[190:191], v247 offset:2560
    v_permlane32_swap_b32 v241, v239
    s_mov_b32 m0, s68
    v_mfma_f32_32x32x16_bf16 v[16:31], v[76:79], v[176:179], v[16:31]
    buffer_load_dwordx4 v226, s[4:7], s42 offen sc1 lds
    buffer_load_dwordx4 v227, s[72:75], s42 offen offset:1024 sc1 lds
    v_lshl_add_u32 v230, v252, 1, s31
    v_add_f32 v234, v234, v236
    v_add_f32 v235, v235, v237
    v_add_f32 v240, v240, v238
    v_add_f32 v241, v241, v239
    v_mfma_f32_32x32x16_bf16 v[32:47], v[72:75], v[180:183], v[32:47]
    v_cvt_pk_bf16_f32 v234, v234, v235
    v_cvt_pk_bf16_f32 v240, v240, v241
    ds_write_b32 v230, v234 offset:0
    ds_write_b32 v230, v240 offset:256
    v_mfma_f32_32x32x16_bf16 v[48:63], v[76:79], v[180:183], v[48:63]
    s_waitcnt vmcnt(4) lgkmcnt(2)
    v_mfma_f32_32x32x16_bf16 v[0:15], v[80:83], v[184:187], v[0:15]
    ds_read_b64_tr_b16 v[176:177], v246 offset:4096
    ds_read_b64_tr_b16 v[178:179], v246 offset:4608
    ds_read_b64_tr_b16 v[180:181], v247 offset:4096
    ds_read_b64_tr_b16 v[182:183], v247 offset:4608
    s_mov_b32 m0, s69
    v_mfma_f32_32x32x16_bf16 v[16:31], v[84:87], v[184:187], v[16:31]
    buffer_load_dwordx4 v222, s[4:7], s43 offen sc1 lds
    buffer_load_dwordx4 v223, s[72:75], s43 offen offset:1024 sc1 lds
    v_mfma_f32_32x32x16_bf16 v[32:47], v[80:83], v[188:191], v[32:47]
    s_nop 2
    v_mul_f32 v234, v0, v144
    v_mul_f32 v236, v8, v112
    v_fmac_f32 v234, v1, v145
    v_fmac_f32 v236, v9, v113
    v_fmac_f32 v234, v2, v146
    v_fmac_f32 v236, v10, v114
    v_fmac_f32 v234, v3, v147
    v_mfma_f32_32x32x16_bf16 v[48:63], v[84:87], v[188:191], v[48:63]
    s_setprio 0
    v_fmac_f32 v236, v11, v115
    v_fmac_f32 v234, v4, v148
    v_fmac_f32 v236, v12, v116
    v_fmac_f32 v234, v5, v149
    v_fmac_f32 v236, v13, v117
    v_fmac_f32 v234, v6, v150
    v_fmac_f32 v236, v14, v118
    v_fmac_f32 v234, v7, v151
    v_fmac_f32 v236, v15, v119
    v_mul_f32 v238, v16, v160
    v_mul_f32 v240, v24, v160
    v_fmac_f32 v238, v17, v161
    v_fmac_f32 v240, v25, v161
    v_fmac_f32 v238, v18, v162
    v_fmac_f32 v240, v26, v162
    v_fmac_f32 v238, v19, v163
    v_fmac_f32 v240, v27, v163
    v_fmac_f32 v238, v20, v164
    v_fmac_f32 v240, v28, v164
    v_fmac_f32 v238, v21, v165
    v_fmac_f32 v240, v29, v165
    v_fmac_f32 v238, v22, v166
    v_fmac_f32 v240, v30, v166
    v_fmac_f32 v238, v23, v167
    v_fmac_f32 v240, v31, v167
    v_mul_f32 v235, v32, v152
    v_mul_f32 v237, v40, v120
    v_fmac_f32 v235, v33, v153
    v_fmac_f32 v237, v41, v121
    v_fmac_f32 v235, v34, v154
    v_fmac_f32 v237, v42, v122
    v_fmac_f32 v235, v35, v155
    v_fmac_f32 v237, v43, v123
    v_fmac_f32 v235, v36, v156
    v_fmac_f32 v237, v44, v124
    v_fmac_f32 v235, v37, v157
    v_fmac_f32 v237, v45, v125
    v_fmac_f32 v235, v38, v158
    v_fmac_f32 v237, v46, v126
    v_fmac_f32 v235, v39, v159
    v_fmac_f32 v237, v47, v127
    v_mul_f32 v239, v48, v168
    v_mul_f32 v241, v56, v168
    v_fmac_f32 v239, v49, v169
    v_fmac_f32 v241, v57, v169
    s_setprio 1
    s_waitcnt vmcnt(4) lgkmcnt(0)
    v_mfma_f32_32x32x16_bf16 v[0:15], v[64:67], v[176:179], 0
    ds_read_b64_tr_b16 v[184:185], v246 offset:6144
    ds_read_b64_tr_b16 v[186:187], v246 offset:6656
    ds_read_b64_tr_b16 v[188:189], v247 offset:6144
    ds_read_b64_tr_b16 v[190:191], v247 offset:6656
    v_fmac_f32 v239, v50, v170
    v_fmac_f32 v241, v58, v170
    s_mov_b32 m0, s70
    v_mfma_f32_32x32x16_bf16 v[16:31], v[68:71], v[176:179], 0
    buffer_load_dwordx4 v224, s[4:7], s43 offen sc1 lds
    buffer_load_dwordx4 v225, s[72:75], s43 offen offset:1024 sc1 lds
    v_fmac_f32 v239, v51, v171
    v_fmac_f32 v241, v59, v171
    v_fmac_f32 v239, v52, v172
    v_fmac_f32 v241, v60, v172
    v_fmac_f32 v239, v53, v173
    v_mfma_f32_32x32x16_bf16 v[32:47], v[64:67], v[180:183], 0
    v_add_u32 v222, s48, v251
    ds_read_b32 v222, v222
    v_fmac_f32 v241, v61, v173
    v_fmac_f32 v239, v54, v174
    v_fmac_f32 v241, v62, v174
    v_fmac_f32 v239, v55, v175
    v_fmac_f32 v241, v63, v175
    v_mfma_f32_32x32x16_bf16 v[48:63], v[68:71], v[180:183], 0
    s_waitcnt vmcnt(4) lgkmcnt(1)
    v_mfma_f32_32x32x16_bf16 v[0:15], v[72:75], v[184:187], v[0:15]
    ds_read_b64_tr_b16 v[176:177], v246 offset:0
    ds_read_b64_tr_b16 v[178:179], v246 offset:512
    ds_read_b64_tr_b16 v[180:181], v247 offset:0
    ds_read_b64_tr_b16 v[182:183], v247 offset:512
    s_mov_b32 m0, s71
    v_mfma_f32_32x32x16_bf16 v[16:31], v[76:79], v[184:187], v[16:31]
    buffer_load_dwordx4 v226, s[4:7], s43 offen sc1 lds
    buffer_load_dwordx4 v227, s[72:75], s43 offen offset:1024 sc1 lds
    s_waitcnt lgkmcnt(4)
    v_mad_u32_u16 v223, v222, s39, v248 op_sel:[1,0,0,0]
    v_mad_u32_u16 v222, v222, s39, v248
    v_mfma_f32_32x32x16_bf16 v[32:47], v[72:75], v[188:191], v[32:47]
    v_add_u32 v224, s49, v251
    ds_read_b32 v224, v224
    v_mfma_f32_32x32x16_bf16 v[48:63], v[76:79], v[188:191], v[48:63]
    s_waitcnt vmcnt(4) lgkmcnt(1)
    v_mfma_f32_32x32x16_bf16 v[0:15], v[80:83], v[176:179], v[0:15]
    ds_read_b64_tr_b16 v[184:185], v246 offset:2048
    ds_read_b64_tr_b16 v[186:187], v246 offset:2560
    ds_read_b64_tr_b16 v[188:189], v247 offset:2048
    ds_read_b64_tr_b16 v[190:191], v247 offset:2560
    s_mov_b32 m0, s68
    v_mfma_f32_32x32x16_bf16 v[16:31], v[84:87], v[176:179], v[16:31]
    buffer_load_dwordx4 v222, s[4:7], s44 offen sc1 lds
    buffer_load_dwordx4 v223, s[72:75], s44 offen offset:1024 sc1 lds
    s_waitcnt lgkmcnt(4)
    v_mad_u32_u16 v225, v224, s39, v248 op_sel:[1,0,0,0]
    v_mad_u32_u16 v224, v224, s39, v248
    v_mfma_f32_32x32x16_bf16 v[32:47], v[80:83], v[180:183], v[32:47]
    v_add_u32 v226, s50, v251
    ds_read_b32 v226, v226
    v_mul_f32 v242, v0, v144
    v_fma_f32 v238, v8, v160, -v238
    v_fmac_f32 v242, v1, v145
    v_fmac_f32 v238, v9, v161
    v_fmac_f32 v242, v2, v146
    v_mfma_f32_32x32x16_bf16 v[48:63], v[84:87], v[180:183], v[48:63]
    s_setprio 0
    v_fmac_f32 v238, v10, v162
    v_fmac_f32 v242, v3, v147
    v_fmac_f32 v238, v11, v163
    v_fmac_f32 v242, v4, v148
    v_fmac_f32 v238, v12, v164
    v_fmac_f32 v242, v5, v149
    v_fmac_f32 v238, v13, v165
    v_fmac_f32 v242, v6, v150
    v_fmac_f32 v238, v14, v166
    v_fmac_f32 v242, v7, v151
    v_fmac_f32 v238, v15, v167
    v_fmac_f32 v236, v16, v112
    v_mul_f32 v244, v24, v160
    v_fmac_f32 v236, v17, v113
    v_fmac_f32 v244, v25, v161
    v_fmac_f32 v236, v18, v114
    v_fmac_f32 v244, v26, v162
    v_fmac_f32 v236, v19, v115
    v_fmac_f32 v244, v27, v163
    v_fmac_f32 v236, v20, v116
    v_fmac_f32 v244, v28, v164
    v_fmac_f32 v236, v21, v117
    v_fmac_f32 v244, v29, v165
    v_fmac_f32 v236, v22, v118
    v_fmac_f32 v244, v30, v166
    v_fmac_f32 v236, v23, v119
    v_fmac_f32 v244, v31, v167
    v_mul_f32 v243, v32, v152
    v_fma_f32 v239, v40, v168, -v239
    v_fmac_f32 v243, v33, v153
    v_fmac_f32 v239, v41, v169
    v_fmac_f32 v243, v34, v154
    v_fmac_f32 v239, v42, v170
    v_fmac_f32 v243, v35, v155
    v_fmac_f32 v239, v43, v171
    v_fmac_f32 v243, v36, v156
    v_fmac_f32 v239, v44, v172
    v_fmac_f32 v243, v37, v157
    v_fmac_f32 v239, v45, v173
    v_fmac_f32 v243, v38, v158
    v_fmac_f32 v239, v46, v174
    v_fmac_f32 v243, v39, v159
    v_fmac_f32 v239, v47, v175
    v_fmac_f32 v237, v48, v120
    v_mul_f32 v245, v56, v168
    v_fmac_f32 v237, v49, v121
    v_fmac_f32 v245, v57, v169
    v_fmac_f32 v237, v50, v122
    v_fmac_f32 v245, v58, v170
    v_fmac_f32 v237, v51, v123
    s_setprio 1
    s_waitcnt vmcnt(4) lgkmcnt(1)
    v_mfma_f32_32x32x16_bf16 v[0:15], v[64:67], v[184:187], 0
    ds_read_b64_tr_b16 v[176:177], v246 offset:4096
    ds_read_b64_tr_b16 v[178:179], v246 offset:4608
    ds_read_b64_tr_b16 v[180:181], v247 offset:4096
    ds_read_b64_tr_b16 v[182:183], v247 offset:4608
    v_fmac_f32 v245, v59, v171
    v_fmac_f32 v237, v52, v124
    s_mov_b32 m0, s69
    v_mfma_f32_32x32x16_bf16 v[16:31], v[68:71], v[184:187], 0
    buffer_load_dwordx4 v224, s[4:7], s45 offen sc1 lds
    buffer_load_dwordx4 v225, s[72:75], s45 offen offset:1024 sc1 lds
    s_waitcnt lgkmcnt(4)
    v_mad_u32_u16 v227, v226, s39, v248 op_sel:[1,0,0,0]
    v_mad_u32_u16 v226, v226, s39, v248
    v_fmac_f32 v245, v60, v172
    v_fmac_f32 v237, v53, v125
    v_mfma_f32_32x32x16_bf16 v[32:47], v[64:67], v[188:191], 0
    v_add_u32 v228, s51, v251
    ds_read_b32 v228, v228
    v_fmac_f32 v245, v61, v173
    v_fmac_f32 v237, v54, v126
    v_fmac_f32 v245, v62, v174
    v_fmac_f32 v237, v55, v127
    v_fmac_f32 v245, v63, v175
    v_mfma_f32_32x32x16_bf16 v[48:63], v[68:71], v[188:191], 0
    v_permlane32_swap_b32 v242, v234
    v_permlane32_swap_b32 v243, v235
    v_add_f32 v242, v242, v234
    v_add_f32 v243, v243, v235
    s_waitcnt vmcnt(4) lgkmcnt(1)
    v_mfma_f32_32x32x16_bf16 v[0:15], v[72:75], v[176:179], v[0:15]
    ds_read_b64_tr_b16 v[184:185], v246 offset:6144
    ds_read_b64_tr_b16 v[186:187], v246 offset:6656
    ds_read_b64_tr_b16 v[188:189], v247 offset:6144
    ds_read_b64_tr_b16 v[190:191], v247 offset:6656
    v_cvt_pk_bf16_f32 v242, v242, v243
    ds_write_b32 v230, v242 offset:512
    s_mov_b32 m0, s70
    v_mfma_f32_32x32x16_bf16 v[16:31], v[76:79], v[176:179], v[16:31]
    buffer_load_dwordx4 v226, s[4:7], s46 offen sc1 lds
    buffer_load_dwordx4 v227, s[72:75], s46 offen offset:1024 sc1 lds
    s_waitcnt lgkmcnt(5)
    v_mad_u32_u16 v229, v228, s39, v248 op_sel:[1,0,0,0]
    v_mad_u32_u16 v228, v228, s39, v248
    s_sub_u32 s26, s48, s29
    s_mov_b32 s29, s48
    v_mfma_f32_32x32x16_bf16 v[32:47], v[72:75], v[180:183], v[32:47]
    s_mov_b32 s30, s3
    s_cmp_lg_u32 s36, 0
    s_cselect_b32 s56, s33, 0
    s_mov_b32 s32, s31
    s_mov_b32 s31, s35
    v_mfma_f32_32x32x16_bf16 v[48:63], v[76:79], v[180:183], v[48:63]
    s_waitcnt vmcnt(4) lgkmcnt(1)
    v_mfma_f32_32x32x16_bf16 v[0:15], v[80:83], v[184:187], v[0:15]
    ds_read_b64_tr_b16 v[176:177], v246 offset:0
    ds_read_b64_tr_b16 v[178:179], v246 offset:512
    ds_read_b64_tr_b16 v[180:181], v247 offset:0
    ds_read_b64_tr_b16 v[182:183], v247 offset:512
    s_mov_b32 m0, s71
    v_mfma_f32_32x32x16_bf16 v[16:31], v[84:87], v[184:187], v[16:31]
    buffer_load_dwordx4 v228, s[4:7], s47 offen sc1 lds
    buffer_load_dwordx4 v229, s[72:75], s47 offen offset:1024 sc1 lds
    v_mfma_f32_32x32x16_bf16 v[32:47], v[80:83], v[188:191], v[32:47]
    s_nop 2
    v_mul_f32 v242, v0, v144
    v_fma_f32 v240, v8, v160, -v240
    v_fmac_f32 v242, v1, v145
    v_fmac_f32 v240, v9, v161
    v_fmac_f32 v242, v2, v146
    v_fmac_f32 v240, v10, v162
    v_fmac_f32 v242, v3, v147
    v_mfma_f32_32x32x16_bf16 v[48:63], v[84:87], v[188:191], v[48:63]
    s_setprio 0
    v_fmac_f32 v240, v11, v163
    v_fmac_f32 v242, v4, v148
    v_fmac_f32 v240, v12, v164
    v_fmac_f32 v242, v5, v149
    v_fmac_f32 v240, v13, v165
    v_fmac_f32 v242, v6, v150
    v_fmac_f32 v240, v14, v166
    v_fmac_f32 v242, v7, v151
    v_fmac_f32 v240, v15, v167
    v_add_u32 v249, s26, v249
    v_add_u32 v250, s26, v250
    v_fma_f32 v244, v16, v160, -v244
    v_fmac_f32 v236, v24, v112
    v_fmac_f32 v244, v17, v161
    v_fmac_f32 v236, v25, v113
    v_fmac_f32 v244, v18, v162
    v_fmac_f32 v236, v26, v114
    v_fmac_f32 v244, v19, v163
    v_fmac_f32 v236, v27, v115
    v_fmac_f32 v244, v20, v164
    v_fmac_f32 v236, v28, v116
    v_fmac_f32 v244, v21, v165
    v_fmac_f32 v236, v29, v117
    v_fmac_f32 v244, v22, v166
    v_fmac_f32 v236, v30, v118
    v_fmac_f32 v244, v23, v167
    v_fmac_f32 v236, v31, v119
    ds_read_b64_tr_b16 v[0:1], v249 offset:0
    ds_read_b64_tr_b16 v[2:3], v249 offset:128
    ds_read_b128 v[4:7], v250 offset:0
    ds_read_b128 v[8:11], v250 offset:16
    ds_read_b128 v[12:15], v250 offset:384
    ds_read_b128 v[16:19], v250 offset:400
    v_mul_f32 v243, v32, v152
    v_fma_f32 v241, v40, v168, -v241
    v_fmac_f32 v243, v33, v153
    v_fmac_f32 v241, v41, v169
    v_fmac_f32 v243, v34, v154
    v_fmac_f32 v241, v42, v170
    v_fmac_f32 v243, v35, v155
    v_fmac_f32 v241, v43, v171
    v_fmac_f32 v243, v36, v156
    v_fmac_f32 v241, v44, v172
    v_fmac_f32 v243, v37, v157
    v_fmac_f32 v241, v45, v173
    v_fmac_f32 v243, v38, v158
    v_fmac_f32 v241, v46, v174
    v_fmac_f32 v243, v39, v159
    v_fmac_f32 v241, v47, v175
    ds_read_b64_tr_b16 v[20:21], v249 offset:512
    ds_read_b64_tr_b16 v[22:23], v249 offset:640
    ds_read_b128 v[24:27], v250 offset:64
    ds_read_b128 v[28:31], v250 offset:80
    ds_read_b128 v[32:35], v250 offset:448
    ds_read_b128 v[36:39], v250 offset:464
    v_fma_f32 v245, v48, v168, -v245
    v_fmac_f32 v237, v56, v120
    v_fmac_f32 v245, v49, v169
    v_fmac_f32 v237, v57, v121
    v_fmac_f32 v245, v50, v170
    v_fmac_f32 v237, v58, v122
    v_fmac_f32 v245, v51, v171
    v_fmac_f32 v237, v59, v123
    v_fmac_f32 v245, v52, v172
    v_fmac_f32 v237, v60, v124
    v_fmac_f32 v245, v53, v173
    v_fmac_f32 v237, v61, v125
    v_fmac_f32 v245, v54, v174
    v_fmac_f32 v237, v62, v126
    v_fmac_f32 v245, v55, v175
    v_fmac_f32 v237, v63, v127
    s_cmp_eq_u32 s56, 2
    s_cbranch_scc1 K2_U21
    s_cmp_eq_u32 s56, 3
    s_cbranch_scc1 K2_U31
    s_branch K2_DSP1
K2_PAD_SW:
    s_branch K2_HOP
K2_DSP0:
    s_cmp_eq_u32 s56, 1
    s_cbranch_scc1 K2_U10
    s_cmp_eq_u32 s56, 4
    s_cbranch_scc1 K2_U40
    s_branch K2_SWITCH
K2_DSP1:
    s_cmp_eq_u32 s56, 1
    s_cbranch_scc1 K2_U11
    s_cmp_eq_u32 s56, 4
    s_cbranch_scc1 K2_U41
    s_branch K2_TAIL
K2_SWITCH:
    v_permlane32_swap_b32 v242, v236
    v_permlane32_swap_b32 v243, v237
    v_permlane32_swap_b32 v244, v238
    v_permlane32_swap_b32 v245, v239
    v_permlane32_swap_b32 v240, v241
    v_add_f32 v242, v242, v236
    v_add_f32 v243, v243, v237
    v_add_f32 v244, v244, v238
    v_add_f32 v245, v245, v239
    v_add_f32 v240, -v240, -v241
    s_set_gpr_idx_on s32, gpr_idx(DST)
    s_nop 0
    v_cvt_pk_bf16_f32 v195, v242, v243
    v_cvt_pk_bf16_f32 v196, v244, v245
    v_cvt_pk_bf16_f32 v197, v240, v240
    s_set_gpr_idx_off
    s_cmp_eq_u32 s36, 0
    s_cbranch_scc1 K2_TAIL2
    v_lshlrev_b32 v254, 3, v252
    v_lshl_add_u32 v230, v252, 1, s35
    v_lshrrev_b32 v231, 6, v252
    v_mul_u32_u24 v231, 126, v231
    s_mov_b32 s58, 7131136
    buffer_load_dwordx4 v[96:99], v254, s[8:11], s58 offen offset:0 sc1
    buffer_load_dwordx4 v[100:103], v254, s[8:11], s58 offen offset:1024 sc1
    buffer_load_dwordx4 v[104:107], v254, s[8:11], s58 offen offset:2048 sc1
    buffer_load_dwordx4 v[108:111], v254, s[8:11], s58 offen offset:3072 sc1
    s_mov_b32 s58, 7135232
    buffer_load_dwordx4 v[112:115], v254, s[8:11], s58 offen offset:0 sc1
    buffer_load_dwordx4 v[116:119], v254, s[8:11], s58 offen offset:1024 sc1
    buffer_load_dwordx4 v[120:123], v254, s[8:11], s58 offen offset:2048 sc1
    buffer_load_dwordx4 v[124:127], v254, s[8:11], s58 offen offset:3072 sc1
    s_mov_b32 s58, 7139328
    buffer_load_dwordx4 v[128:131], v254, s[8:11], s58 offen offset:0 sc1
    buffer_load_dwordx4 v[132:135], v254, s[8:11], s58 offen offset:1024 sc1
    buffer_load_dwordx4 v[136:139], v254, s[8:11], s58 offen offset:2048 sc1
    buffer_load_dwordx4 v[140:143], v254, s[8:11], s58 offen offset:3072 sc1
    s_mov_b32 s58, 7143424
    buffer_load_dwordx4 v[144:147], v254, s[8:11], s58 offen offset:0 sc1
    buffer_load_dwordx4 v[148:151], v254, s[8:11], s58 offen offset:1024 sc1
    buffer_load_dwordx4 v[152:155], v254, s[8:11], s58 offen offset:2048 sc1
    buffer_load_dwordx4 v[156:159], v254, s[8:11], s58 offen offset:3072 sc1
    s_mov_b32 s58, 7147520
    buffer_load_dwordx4 v[160:163], v254, s[8:11], s58 offen offset:0 sc1
    buffer_load_dwordx4 v[164:167], v254, s[8:11], s58 offen offset:1024 sc1
    buffer_load_dwordx4 v[168:171], v254, s[8:11], s58 offen offset:2048 sc1
    buffer_load_dwordx4 v[172:175], v254, s[8:11], s58 offen offset:3072 sc1
    s_movk_i32 s40, 128
    s_movk_i32 s41, 384
    s_movk_i32 s42, 640
    s_movk_i32 s43, 896
    s_cmp_lg_u32 s33, 1
    s_cbranch_scc1 K2_SW2
    s_waitcnt vmcnt(0)
K2_SW2:
    s_mov_b32 s29, s48
    s_mov_b32 s32, s31
    s_mov_b32 s30, s3
    s_mov_b32 s31, s35
    s_cmp_eq_u32 s33, 2
    s_cbranch_scc1 K2_U21
    s_cmp_eq_u32 s33, 3
    s_cbranch_scc1 K2_U31
    s_cmp_eq_u32 s33, 1
    s_cbranch_scc1 K2_U11
    s_branch K2_U41
K2_dum_4:
    v_mov_b32 v232, -1
    s_mov_b32 m0, 163712
    s_mov_b64 exec, 1
    buffer_load_dwordx4 v232, s[16:19], 0 offen lds
    buffer_load_dwordx4 v232, s[16:19], 0 offen lds
    s_mov_b64 exec, -1
    s_branch K2_back_6
K2_nul_10:
    s_mov_b32 s58, 63
    s_mov_b32 s36, 0
    s_branch K2_back_13
K2_spin_11:
    s_sub_u32 s27, s27, 1
    s_cbranch_scc1 K2_END
    v_lshl_add_u32 v233, v252, 1, s53
    ds_read_b32 v233, v233
    s_waitcnt lgkmcnt(0)
    s_branch K2_chk_12
K2_dyn_8:
    v_mov_b32 v254, 163648
    v_mov_b32 v255, 1
    v_lshl_add_u32 v233, v252, 1, s53
    s_mov_b64 exec, 1
    ds_add_rtn_u32 v232, v254, v255
    s_mov_b64 exec, -1
    ds_read_b32 v233, v233
    s_waitcnt lgkmcnt(0)
    v_readfirstlane_b32 s58, v232
    s_nop 0
    s_cmp_lt_u32 s58, s22
    s_cbranch_scc0 K2_nul_10
    s_and_b32 s59, s58, 7
    s_lshr_b32 s60, s58, 3
K2_chk_12:
    v_readlane_b32 s61, v233, s59
    s_nop 0
    s_cmp_gt_u32 s61, s60
    s_cbranch_scc0 K2_spin_11
K2_back_13:
    s_mov_b32 s34, 1
    s_branch K2_back_9
K2_dum_17:
    v_mov_b32 v232, -1
    s_mov_b32 m0, 163712
    s_mov_b64 exec, 1
    buffer_load_dwordx4 v232, s[16:19], 0 offen lds
    buffer_load_dwordx4 v232, s[16:19], 0 offen lds
    s_mov_b64 exec, -1
    s_branch K2_back_19
K2_nul_23:
    s_mov_b32 s58, 63
    s_mov_b32 s36, 0
    s_branch K2_back_26
K2_spin_24:
    s_sub_u32 s27, s27, 1
    s_cbranch_scc1 K2_END
    v_lshl_add_u32 v233, v252, 1, s53
    ds_read_b32 v233, v233
    s_waitcnt lgkmcnt(0)
    s_branch K2_chk_25
K2_dyn_21:
    v_mov_b32 v254, 163648
    v_mov_b32 v255, 1
    v_lshl_add_u32 v233, v252, 1, s53
    s_mov_b64 exec, 1
    ds_add_rtn_u32 v232, v254, v255
    s_mov_b64 exec, -1
    ds_read_b32 v233, v233
    s_waitcnt lgkmcnt(0)
    v_readfirstlane_b32 s58, v232
    s_nop 0
    s_cmp_lt_u32 s58, s22
    s_cbranch_scc0 K2_nul_23
    s_and_b32 s59, s58, 7
    s_lshr_b32 s60, s58, 3
K2_chk_25:
    v_readlane_b32 s61, v233, s59
    s_nop 0
    s_cmp_gt_u32 s61, s60
    s_cbranch_scc0 K2_spin_24
K2_back_26:
    s_mov_b32 s34, 1
    s_branch K2_back_22
K2_dum_30:
    v_mov_b32 v232, -1
    s_mov_b32 m0, 163712
    s_mov_b64 exec, 1
    buffer_load_dwordx4 v232, s[16:19], 0 offen lds
    buffer_load_dwordx4 v232, s[16:19], 0 offen lds
    s_mov_b64 exec, -1
    s_branch K2_back_32
K2_nul_34:
    s_mov_b32 s58, 63
    s_mov_b32 s36, 0
    s_branch K2_back_37
K2_spin_35:
    s_sub_u32 s27, s27, 1
    s_cbranch_scc1 K2_END
    v_lshl_add_u32 v233, v252, 1, s53
    ds_read_b32 v233, v233
    s_waitcnt lgkmcnt(0)
    s_branch K2_chk_36
K2_nul_41:
    s_mov_b32 s58, 63
    s_mov_b32 s36, 0
    s_branch K2_back_44
K2_spin_42:
    s_sub_u32 s27, s27, 1
    s_cbranch_scc1 K2_END
    v_lshl_add_u32 v233, v252, 1, s53
    ds_read_b32 v233, v233
    s_waitcnt lgkmcnt(0)
    s_branch K2_chk_43
K2_PAD_TL:
    s_branch K2_HOP
K2_TAIL2:
    v_lshlrev_b32 v229, 3, v252
    s_mul_i32 s58, s20, 20480
    s_add_u32 s58, s58, 6946816
    s_mul_i32 s59, s20, 8224
    buffer_load_dwordx4 v[96:99], v229, s[8:11], s58 offen offset:0 sc1
    buffer_load_dwordx4 v[100:103], v229, s[8:11], s58 offen offset:1024 sc1
    buffer_load_dwordx4 v[104:107], v229, s[8:11], s58 offen offset:2048 sc1
    buffer_load_dwordx4 v[108:111], v229, s[8:11], s58 offen offset:3072 sc1
    s_add_u32 s58, s58, 4096
    buffer_load_dwordx4 v[112:115], v229, s[8:11], s58 offen offset:0 sc1
    buffer_load_dwordx4 v[116:119], v229, s[8:11], s58 offen offset:1024 sc1
    buffer_load_dwordx4 v[120:123], v229, s[8:11], s58 offen offset:2048 sc1
    buffer_load_dwordx4 v[124:127], v229, s[8:11], s58 offen offset:3072 sc1
    s_add_u32 s58, s58, 4096
    v_lshl_add_u32 v228, v252, 1, s59
    v_lshrrev_b32 v226, 6, v252
    v_mul_u32_u24 v226, 126, v226
    v_sub_u32 v226, v228, v226
    s_branch K2_TAIL3
K2_TAIL:
    v_lshlrev_b32 v229, 3, v252
    s_mul_i32 s58, s20, 20480
    s_add_u32 s58, s58, 6946816
    s_mul_i32 s59, s20, 8224
    buffer_load_dwordx4 v[96:99], v229, s[8:11], s58 offen offset:0 sc1
    v_permlane32_swap_b32 v242, v236
    v_permlane32_swap_b32 v243, v237
    buffer_load_dwordx4 v[100:103], v229, s[8:11], s58 offen offset:1024 sc1
    v_permlane32_swap_b32 v244, v238
    v_permlane32_swap_b32 v245, v239
    buffer_load_dwordx4 v[104:107], v229, s[8:11], s58 offen offset:2048 sc1
    v_permlane32_swap_b32 v240, v241
    v_add_f32 v242, v242, v236
    buffer_load_dwordx4 v[108:111], v229, s[8:11], s58 offen offset:3072 sc1
    s_add_u32 s58, s58, 4096
    v_add_f32 v243, v243, v237
    v_add_f32 v244, v244, v238
    buffer_load_dwordx4 v[112:115], v229, s[8:11], s58 offen offset:0 sc1
    v_add_f32 v245, v245, v239
    v_add_f32 v240, -v240, -v241
    buffer_load_dwordx4 v[116:119], v229, s[8:11], s58 offen offset:1024 sc1
    v_sub_u32 v241, v230, v231
    v_cvt_pk_bf16_f32 v242, v242, v243
    buffer_load_dwordx4 v[120:123], v229, s[8:11], s58 offen offset:2048 sc1
    v_cvt_pk_bf16_f32 v244, v244, v245
    v_cvt_pk_bf16_f32 v240, v240, v240
    buffer_load_dwordx4 v[124:127], v229, s[8:11], s58 offen offset:3072 sc1
    s_add_u32 s58, s58, 4096
    ds_write_b32 v230, v242 offset:768
    ds_write_b32 v230, v244 offset:1024
    ds_write_b16 v241, v240 offset:1280
    v_lshl_add_u32 v228, v252, 1, s59
    v_lshrrev_b32 v226, 6, v252
    v_mul_u32_u24 v226, 126, v226
    v_sub_u32 v226, v228, v226
K2_TAIL3:
    s_waitcnt vmcnt(8)
    ds_write_b32 v228, v192 offset:0
    ds_write_b32 v228, v193 offset:256
    ds_write_b32 v228, v194 offset:512
    buffer_load_dwordx4 v[128:131], v229, s[8:11], s58 offen offset:0 sc1
    v_bfe_u32 v48, v252, 1, 4
    v_lshrrev_b32 v49, 5, v252
    ds_write_b32 v228, v195 offset:768
    ds_write_b32 v228, v196 offset:1024
    ds_write_b16 v226, v197 offset:1280
    buffer_load_dwordx4 v[132:135], v229, s[8:11], s58 offen offset:1024 sc1
    v_lshrrev_b32 v55, 3, v48
    v_lshlrev_b32 v52, 4, v49
    ds_write_b32 v228, v198 offset:1536
    ds_write_b32 v228, v199 offset:1792
    ds_write_b32 v228, v200 offset:2048
    buffer_load_dwordx4 v[136:139], v229, s[8:11], s58 offen offset:2048 sc1
    v_lshl_add_u32 v54, v55, 2, v48
    v_and_b32 v54, 7, v54
    ds_write_b32 v228, v201 offset:2304
    ds_write_b32 v228, v202 offset:2560
    ds_write_b16 v226, v203 offset:2816
    buffer_load_dwordx4 v[140:143], v229, s[8:11], s58 offen offset:3072 sc1
    s_add_u32 s58, s58, 4096
    v_and_b32 v50, 7, v48
    v_mul_u32_u24 v50, 8224, v50
    ds_write_b32 v228, v204 offset:3072
    ds_write_b32 v228, v205 offset:3328
    ds_write_b32 v228, v206 offset:3584
    buffer_load_dwordx4 v[144:147], v229, s[8:11], s58 offen offset:0 sc1
    v_mul_u32_u24 v51, 1536, v55
    v_add_u32 v50, v50, v51
    ds_write_b32 v228, v207 offset:3840
    ds_write_b32 v228, v208 offset:4096
    ds_write_b16 v226, v209 offset:4352
    buffer_load_dwordx4 v[148:151], v229, s[8:11], s58 offen offset:1024 sc1
    v_add_u32 v222, v50, v52
    v_mul_u32_u24 v51, 8224, v54
    ds_write_b32 v228, v210 offset:4608
    ds_write_b32 v228, v211 offset:4864
    ds_write_b32 v228, v212 offset:5120
    buffer_load_dwordx4 v[152:155], v229, s[8:11], s58 offen offset:2048 sc1
    v_add_u32 v232, v51, v52
    v_lshl_add_u32 v247, v55, 7, v232
    ds_write_b32 v228, v213 offset:5376
    ds_write_b32 v228, v214 offset:5632
    ds_write_b16 v226, v215 offset:5888
    buffer_load_dwordx4 v[156:159], v229, s[8:11], s58 offen offset:3072 sc1
    s_add_u32 s58, s58, 4096
    v_mul_u32_u24 v53, 192, v48
    v_and_b32 v53, 0xc0, v53
    ds_write_b32 v228, v216 offset:6144
    ds_write_b32 v228, v217 offset:6400
    ds_write_b32 v228, v218 offset:6656
    buffer_load_dwordx4 v[160:163], v229, s[8:11], s58 offen offset:0 sc1
    v_add_u32 v53, v53, v52
    v_mul_u32_u24 v51, 2400, v48
    ds_write_b32 v228, v219 offset:6912
    ds_write_b32 v228, v220 offset:7168
    ds_write_b16 v226, v221 offset:7424
    buffer_load_dwordx4 v[164:167], v229, s[8:11], s58 offen offset:1024 sc1
    s_mov_b32 s60, 65536
    v_add3_u32 v223, v51, v53, s60
    buffer_load_dwordx4 v[168:171], v229, s[8:11], s58 offen offset:2048 sc1
    v_mul_u32_u24 v51, 2400, v54
    s_mov_b32 s60, 142336
    buffer_load_dwordx4 v[172:175], v229, s[8:11], s58 offen offset:3072 sc1
    v_add3_u32 v225, v51, v53, s60
    v_lshl_add_u32 v248, v55, 7, v225
    s_lshl_b32 s60, s20, 5
    v_lshl_add_u32 v49, v49, 3, s60
    s_mov_b32 s60, 65536
    v_add3_u32 v255, v51, v49, s60
    v_lshl_add_u32 v246, v55, 9, v255
    v_bfe_u32 v53, v48, 2, 1
    v_lshl_add_u32 v49, v53, 4, v49
    v_add_u32 v254, v50, v49
    s_and_b32 s64, s55, s28
    s_waitcnt lgkmcnt(0)
    s_barrier
    s_cmp_eq_u32 s64, 0
    s_cbranch_scc1 K2_MULTI
    s_setprio 3
    ds_read_b128 v[48:51], v222 offset:0
    ds_read_b128 v[52:55], v222 offset:64
    ds_read_b128 v[56:59], v222 offset:896
    ds_read_b128 v[60:63], v222 offset:960
    ds_read_b128 v[64:67], v223 offset:0
    ds_read_b128 v[68:71], v223 offset:64
    ds_read_b128 v[72:75], v223 offset:896
    ds_read_b128 v[76:79], v223 offset:960
    ds_read_b128 v[80:83], v222 offset:128
    ds_read_b128 v[84:87], v222 offset:384
    ds_read_b128 v[88:91], v222 offset:256
    s_waitcnt vmcnt(19) lgkmcnt(9)
    v_mfma_f32_16x16x32_bf16 v[0:3], v[96:99], v[48:51], 0
    ds_read_b128 v[92:95], v222 offset:192
    s_waitcnt vmcnt(18)
    v_mfma_f32_16x16x32_bf16 v[0:3], v[100:103], v[52:55], v[0:3]
    ds_read_b128 v[48:51], v222 offset:448
    s_waitcnt vmcnt(17) lgkmcnt(9)
    v_mfma_f32_16x16x32_bf16 v[0:3], v[104:107], v[56:59], v[0:3]
    s_bfe_u32 s60, s20, 0x10002
    s_lshl_b32 s60, s60, 4
    ds_read_b128 v[52:55], v222 offset:320
    s_waitcnt vmcnt(16)
    v_mfma_f32_16x16x32_bf16 v[0:3], v[108:111], v[60:63], v[0:3]
    s_add_u32 s59, s59, s60
    v_add_u32 v228, s59, v229
    ds_read_b128 v[56:59], v222 offset:640
    s_waitcnt vmcnt(15) lgkmcnt(9)
    v_mfma_f32_16x16x32_bf16 v[0:3], v[112:115], v[64:67], v[0:3]
    s_mul_i32 s60, s20, 2400
    s_add_u32 s60, s60, 65536
    ds_read_b128 v[60:63], v222 offset:512
    s_waitcnt vmcnt(14)
    v_mfma_f32_16x16x32_bf16 v[0:3], v[116:119], v[68:71], v[0:3]
    v_add_u32 v249, s60, v229
    s_mov_b32 s63, 0xbfb8aa3b
    ds_read_b128 v[64:67], v222 offset:768
    s_waitcnt vmcnt(13) lgkmcnt(9)
    v_mfma_f32_16x16x32_bf16 v[0:3], v[120:123], v[72:75], v[0:3]
    s_add_u32 s40, s20, s21
    s_lshl_b32 s40, s40, 10
    ds_read_b128 v[68:71], v222 offset:704
    s_waitcnt vmcnt(12)
    v_mfma_f32_16x16x32_bf16 v[0:3], v[124:127], v[76:79], v[0:3]
    s_add_u32 s41, s40, 8192
    s_add_u32 s42, s40, 16384
    ds_read_b128 v[72:75], v222 offset:576
    s_waitcnt vmcnt(11) lgkmcnt(9)
    v_mfma_f32_16x16x32_bf16 v[4:7], v[128:131], v[80:83], 0
    s_add_u32 s43, s40, 24576
    s_add_u32 s44, s40, 32768
    ds_read_b128 v[76:79], v222 offset:832
    v_mfma_f32_16x16x32_bf16 v[8:11], v[128:131], v[84:87], 0
    ds_read_b128 v[80:83], v222 offset:1024
    s_waitcnt lgkmcnt(9)
    v_mfma_f32_16x16x32_bf16 v[12:15], v[128:131], v[88:91], 0
    ds_read_b128 v[84:87], v222 offset:1280
    s_waitcnt vmcnt(10)
    v_mfma_f32_16x16x32_bf16 v[4:7], v[132:135], v[92:95], v[4:7]
    ds_read_b128 v[88:91], v222 offset:1152
    s_waitcnt lgkmcnt(9)
    v_mfma_f32_16x16x32_bf16 v[8:11], v[132:135], v[48:51], v[8:11]
    v_mul_f32 v204, s63, v0
    ds_read_b128 v[92:95], v222 offset:1088
    v_mfma_f32_16x16x32_bf16 v[12:15], v[132:135], v[52:55], v[12:15]
    v_mul_f32 v205, s63, v1
    s_setprio 2
    ds_read_b128 v[48:51], v222 offset:1344
    s_waitcnt vmcnt(9) lgkmcnt(9)
    v_mfma_f32_16x16x32_bf16 v[4:7], v[136:139], v[56:59], v[4:7]
    ds_read_b128 v[52:55], v222 offset:1216
    v_mfma_f32_16x16x32_bf16 v[8:11], v[136:139], v[60:63], v[8:11]
    v_mul_f32 v206, s63, v2
    ds_read_b128 v[56:59], v223 offset:128
    s_waitcnt lgkmcnt(9)
    v_mfma_f32_16x16x32_bf16 v[12:15], v[136:139], v[64:67], v[12:15]
    v_mul_f32 v207, s63, v3
    ds_read_b128 v[60:63], v223 offset:384
    s_waitcnt vmcnt(8)
    v_mfma_f32_16x16x32_bf16 v[4:7], v[140:143], v[68:71], v[4:7]
    ds_read_b128 v[64:67], v223 offset:256
    s_waitcnt lgkmcnt(9)
    v_mfma_f32_16x16x32_bf16 v[8:11], v[140:143], v[72:75], v[8:11]
    v_exp_f32 v204, v204
    ds_read_b128 v[68:71], v223 offset:192
    v_mfma_f32_16x16x32_bf16 v[12:15], v[140:143], v[76:79], v[12:15]
    ds_read_b128 v[72:75], v223 offset:448
    s_waitcnt vmcnt(7) lgkmcnt(9)
    v_mfma_f32_16x16x32_bf16 v[4:7], v[144:147], v[80:83], v[4:7]
    v_exp_f32 v205, v205
    ds_read_b128 v[76:79], v223 offset:320
    v_mfma_f32_16x16x32_bf16 v[8:11], v[144:147], v[84:87], v[8:11]
    v_exp_f32 v206, v206
    ds_read_b128 v[80:83], v223 offset:640
    s_waitcnt lgkmcnt(9)
    v_mfma_f32_16x16x32_bf16 v[12:15], v[144:147], v[88:91], v[12:15]
    ds_read_b128 v[84:87], v223 offset:512
    s_waitcnt vmcnt(6)
    v_mfma_f32_16x16x32_bf16 v[4:7], v[148:151], v[92:95], v[4:7]
    v_exp_f32 v207, v207
    ds_read_b128 v[88:91], v223 offset:768
    s_waitcnt lgkmcnt(9)
    v_mfma_f32_16x16x32_bf16 v[8:11], v[148:151], v[48:51], v[8:11]
    v_add_f32 v204, 1.0, v204
    ds_read_b128 v[92:95], v223 offset:704
    v_mfma_f32_16x16x32_bf16 v[12:15], v[148:151], v[52:55], v[12:15]
    ds_read_b128 v[48:51], v223 offset:576
    s_waitcnt vmcnt(5) lgkmcnt(9)
    v_mfma_f32_16x16x32_bf16 v[4:7], v[152:155], v[56:59], v[4:7]
    v_add_f32 v205, 1.0, v205
    ds_read_b128 v[52:55], v223 offset:832
    v_mfma_f32_16x16x32_bf16 v[8:11], v[152:155], v[60:63], v[8:11]
    s_setprio 1
    ds_read_b128 v[56:59], v223 offset:1024
    s_waitcnt lgkmcnt(9)
    v_mfma_f32_16x16x32_bf16 v[12:15], v[152:155], v[64:67], v[12:15]
    v_add_f32 v206, 1.0, v206
    ds_read_b128 v[60:63], v223 offset:1280
    s_waitcnt vmcnt(4)
    v_mfma_f32_16x16x32_bf16 v[4:7], v[156:159], v[68:71], v[4:7]
    v_add_f32 v207, 1.0, v207
    ds_read_b128 v[64:67], v223 offset:1152
    s_waitcnt lgkmcnt(9)
    v_mfma_f32_16x16x32_bf16 v[8:11], v[156:159], v[72:75], v[8:11]
    ds_read_b128 v[68:71], v223 offset:1088
    v_mfma_f32_16x16x32_bf16 v[12:15], v[156:159], v[76:79], v[12:15]
    v_rcp_f32 v204, v204
    ds_read_b128 v[72:75], v223 offset:1344
    s_waitcnt vmcnt(3) lgkmcnt(9)
    v_mfma_f32_16x16x32_bf16 v[4:7], v[160:163], v[80:83], v[4:7]
    v_rcp_f32 v205, v205
    ds_read_b128 v[76:79], v223 offset:1216
    v_mfma_f32_16x16x32_bf16 v[8:11], v[160:163], v[84:87], v[8:11]
    ds_read_b128 v[80:83], v222 offset:3072
    s_waitcnt lgkmcnt(9)
    v_mfma_f32_16x16x32_bf16 v[12:15], v[160:163], v[88:91], v[12:15]
    v_rcp_f32 v206, v206
    ds_read_b128 v[84:87], v222 offset:3136
    s_waitcnt vmcnt(2)
    v_mfma_f32_16x16x32_bf16 v[4:7], v[164:167], v[92:95], v[4:7]
    ds_read_b128 v[88:91], v222 offset:3968
    s_waitcnt lgkmcnt(9)
    v_mfma_f32_16x16x32_bf16 v[8:11], v[164:167], v[48:51], v[8:11]
    v_rcp_f32 v207, v207
    ds_read_b128 v[92:95], v222 offset:4032
    v_mfma_f32_16x16x32_bf16 v[12:15], v[164:167], v[52:55], v[12:15]
    v_cvt_pk_bf16_f32 v176, v0, v1
    ds_read_b128 v[48:51], v223 offset:38400
    s_waitcnt vmcnt(1) lgkmcnt(9)
    v_mfma_f32_16x16x32_bf16 v[4:7], v[168:171], v[56:59], v[4:7]
    ds_read_b128 v[52:55], v223 offset:38464
    v_mfma_f32_16x16x32_bf16 v[8:11], v[168:171], v[60:63], v[8:11]
    v_cvt_pk_bf16_f32 v177, v2, v3
    s_setprio 0
    ds_read_b128 v[56:59], v223 offset:39296
    s_waitcnt lgkmcnt(9)
    v_mfma_f32_16x16x32_bf16 v[12:15], v[168:171], v[64:67], v[12:15]
    ds_read_b128 v[60:63], v223 offset:39360
    s_waitcnt vmcnt(0)
    v_mfma_f32_16x16x32_bf16 v[4:7], v[172:175], v[68:71], v[4:7]
K2_PAD_T2:
    s_cbranch_execz K2_HOP
    ds_read_b128 v[64:67], v222 offset:3200
    s_waitcnt lgkmcnt(9)
    v_mfma_f32_16x16x32_bf16 v[8:11], v[172:175], v[72:75], v[8:11]
    ds_read_b128 v[68:71], v222 offset:3456
    v_mfma_f32_16x16x32_bf16 v[12:15], v[172:175], v[76:79], v[12:15]
    ds_read_b128 v[72:75], v222 offset:3328
    s_waitcnt lgkmcnt(9)
    v_mfma_f32_16x16x32_bf16 v[16:19], v[96:99], v[80:83], 0
    ds_read_b128 v[76:79], v222 offset:3264
    v_mfma_f32_16x16x32_bf16 v[16:19], v[100:103], v[84:87], v[16:19]
    ds_read_b128 v[80:83], v222 offset:3520
    s_waitcnt lgkmcnt(9)
    v_mfma_f32_16x16x32_bf16 v[16:19], v[104:107], v[88:91], v[16:19]
    s_barrier
    s_setprio 3
    ds_read_b128 v[84:87], v222 offset:3392
    v_mfma_f32_16x16x32_bf16 v[16:19], v[108:111], v[92:95], v[16:19]
    v_mul_f32 v4, v4, v204
    ds_read_b128 v[88:91], v222 offset:3712
    s_waitcnt lgkmcnt(9)
    v_mfma_f32_16x16x32_bf16 v[16:19], v[112:115], v[48:51], v[16:19]
    v_mul_f32 v5, v5, v205
    ds_read_b128 v[92:95], v222 offset:3584
    v_mfma_f32_16x16x32_bf16 v[16:19], v[116:119], v[52:55], v[16:19]
    v_mul_f32 v6, v6, v206
    ds_read_b128 v[48:51], v222 offset:3840
    s_waitcnt lgkmcnt(9)
    v_mfma_f32_16x16x32_bf16 v[16:19], v[120:123], v[56:59], v[16:19]
    v_mul_f32 v7, v7, v207
    ds_read_b128 v[52:55], v222 offset:3776
    v_mfma_f32_16x16x32_bf16 v[16:19], v[124:127], v[60:63], v[16:19]
    v_cvt_pk_bf16_f32 v178, v4, v5
    ds_read_b128 v[56:59], v222 offset:3648
    s_waitcnt lgkmcnt(9)
    v_mfma_f32_16x16x32_bf16 v[20:23], v[128:131], v[64:67], 0
    v_cvt_pk_bf16_f32 v179, v6, v7
    ds_read_b128 v[60:63], v222 offset:3904
    v_mfma_f32_16x16x32_bf16 v[24:27], v[128:131], v[68:71], 0
    v_mul_f32 v8, v8, v204
    ds_read_b128 v[64:67], v222 offset:4096
    s_waitcnt lgkmcnt(9)
    v_mfma_f32_16x16x32_bf16 v[28:31], v[128:131], v[72:75], 0
    v_mul_f32 v9, v9, v205
    ds_read_b128 v[68:71], v222 offset:4352
    v_mfma_f32_16x16x32_bf16 v[20:23], v[132:135], v[76:79], v[20:23]
    v_mul_f32 v10, v10, v206
    ds_read_b128 v[72:75], v222 offset:4224
    s_waitcnt lgkmcnt(9)
    v_mfma_f32_16x16x32_bf16 v[24:27], v[132:135], v[80:83], v[24:27]
    v_mul_f32 v11, v11, v207
    ds_read_b128 v[76:79], v222 offset:4160
    v_mfma_f32_16x16x32_bf16 v[28:31], v[132:135], v[84:87], v[28:31]
    v_cvt_pk_bf16_f32 v180, v8, v9
    ds_read_b128 v[80:83], v222 offset:4416
    s_waitcnt lgkmcnt(9)
    v_mfma_f32_16x16x32_bf16 v[20:23], v[136:139], v[88:91], v[20:23]
    v_cvt_pk_bf16_f32 v181, v10, v11
    ds_read_b128 v[84:87], v222 offset:4288
    v_mfma_f32_16x16x32_bf16 v[24:27], v[136:139], v[92:95], v[24:27]
    v_mul_f32 v12, v12, v204
    s_setprio 2
    ds_read_b128 v[88:91], v223 offset:38528
    s_waitcnt lgkmcnt(9)
    v_mfma_f32_16x16x32_bf16 v[28:31], v[136:139], v[48:51], v[28:31]
    v_mul_f32 v13, v13, v205
    ds_read_b128 v[92:95], v223 offset:38784
    v_mfma_f32_16x16x32_bf16 v[20:23], v[140:143], v[52:55], v[20:23]
    v_mul_f32 v14, v14, v206
    ds_read_b128 v[48:51], v223 offset:38656
    s_waitcnt lgkmcnt(9)
    v_mfma_f32_16x16x32_bf16 v[24:27], v[140:143], v[56:59], v[24:27]
    v_mul_f32 v15, v15, v207
    ds_read_b128 v[52:55], v223 offset:38592
    v_mfma_f32_16x16x32_bf16 v[28:31], v[140:143], v[60:63], v[28:31]
    v_cvt_pk_bf16_f32 v182, v12, v13
    ds_read_b128 v[56:59], v223 offset:38848
    s_waitcnt lgkmcnt(9)
    v_mfma_f32_16x16x32_bf16 v[20:23], v[144:147], v[64:67], v[20:23]
    v_cvt_pk_bf16_f32 v183, v14, v15
    ds_read_b128 v[60:63], v223 offset:38720
    v_mfma_f32_16x16x32_bf16 v[24:27], v[144:147], v[68:71], v[24:27]
    ds_write_b64 v254, v[176:177] offset:0
    ds_write_b64 v254, v[178:179] offset:256
    ds_write_b64 v254, v[180:181] offset:512
    ds_write_b64 v254, v[182:183] offset:768
    ds_read_b128 v[64:67], v223 offset:39040
    s_waitcnt lgkmcnt(13)
    v_mfma_f32_16x16x32_bf16 v[28:31], v[144:147], v[72:75], v[28:31]
    v_mul_f32 v208, s63, v16
    ds_read_b128 v[68:71], v223 offset:38912
    v_mfma_f32_16x16x32_bf16 v[20:23], v[148:151], v[76:79], v[20:23]
    v_mul_f32 v209, s63, v17
    ds_read_b128 v[72:75], v223 offset:39168
    s_waitcnt lgkmcnt(13)
    v_mfma_f32_16x16x32_bf16 v[24:27], v[148:151], v[80:83], v[24:27]
    v_mul_f32 v210, s63, v18
    ds_read_b128 v[76:79], v223 offset:39104
    v_mfma_f32_16x16x32_bf16 v[28:31], v[148:151], v[84:87], v[28:31]
    v_mul_f32 v211, s63, v19
    ds_read_b128 v[80:83], v223 offset:38976
    s_waitcnt lgkmcnt(13)
    v_mfma_f32_16x16x32_bf16 v[20:23], v[152:155], v[88:91], v[20:23]
    v_exp_f32 v208, v208
    ds_read_b128 v[84:87], v223 offset:39232
    v_mfma_f32_16x16x32_bf16 v[24:27], v[152:155], v[92:95], v[24:27]
    v_exp_f32 v209, v209
    ds_read_b128 v[88:91], v223 offset:39424
    s_waitcnt lgkmcnt(13)
    v_mfma_f32_16x16x32_bf16 v[28:31], v[152:155], v[48:51], v[28:31]
    s_setprio 1
    ds_read_b128 v[92:95], v223 offset:39680
    v_mfma_f32_16x16x32_bf16 v[20:23], v[156:159], v[52:55], v[20:23]
    v_exp_f32 v210, v210
    ds_read_b128 v[48:51], v223 offset:39552
    s_waitcnt lgkmcnt(13)
    v_mfma_f32_16x16x32_bf16 v[24:27], v[156:159], v[56:59], v[24:27]
    v_exp_f32 v211, v211
    ds_read_b128 v[52:55], v223 offset:39488
    v_mfma_f32_16x16x32_bf16 v[28:31], v[156:159], v[60:63], v[28:31]
    v_add_f32 v208, 1.0, v208
    ds_read_b128 v[56:59], v223 offset:39744
    s_waitcnt lgkmcnt(9)
    v_mfma_f32_16x16x32_bf16 v[20:23], v[160:163], v[64:67], v[20:23]
    v_add_f32 v209, 1.0, v209
    ds_read_b128 v[60:63], v223 offset:39616
    v_mfma_f32_16x16x32_bf16 v[24:27], v[160:163], v[68:71], v[24:27]
    v_add_f32 v210, 1.0, v210
    ds_read_b128 v[64:67], v232 offset:6144
    s_waitcnt lgkmcnt(9)
    v_mfma_f32_16x16x32_bf16 v[28:31], v[160:163], v[72:75], v[28:31]
    v_add_f32 v211, 1.0, v211
    ds_read_b128 v[68:71], v232 offset:6208
    v_mfma_f32_16x16x32_bf16 v[20:23], v[164:167], v[76:79], v[20:23]
    ds_read_b128 v[72:75], v232 offset:7040
    s_waitcnt lgkmcnt(9)
    v_mfma_f32_16x16x32_bf16 v[24:27], v[164:167], v[80:83], v[24:27]
    v_rcp_f32 v208, v208
    ds_read_b128 v[76:79], v232 offset:7104
    v_mfma_f32_16x16x32_bf16 v[28:31], v[164:167], v[84:87], v[28:31]
    v_rcp_f32 v209, v209
    ds_read_b128 v[80:83], v225 offset:0
    s_waitcnt lgkmcnt(9)
    v_mfma_f32_16x16x32_bf16 v[20:23], v[168:171], v[88:91], v[20:23]
    v_rcp_f32 v210, v210
    ds_read_b128 v[84:87], v225 offset:64
    v_mfma_f32_16x16x32_bf16 v[24:27], v[168:171], v[92:95], v[24:27]
    v_rcp_f32 v211, v211
    ds_read_b128 v[88:91], v225 offset:896
    s_waitcnt lgkmcnt(9)
    v_mfma_f32_16x16x32_bf16 v[28:31], v[168:171], v[48:51], v[28:31]
    v_cvt_pk_bf16_f32 v184, v16, v17
    s_setprio 0
    ds_read_b128 v[92:95], v225 offset:960
    v_mfma_f32_16x16x32_bf16 v[20:23], v[172:175], v[52:55], v[20:23]
    v_cvt_pk_bf16_f32 v185, v18, v19
    ds_read_b128 v[48:51], v247 offset:6272
    s_waitcnt lgkmcnt(9)
    v_mfma_f32_16x16x32_bf16 v[24:27], v[172:175], v[56:59], v[24:27]
    ds_read_b128 v[52:55], v232 offset:6528
    v_mfma_f32_16x16x32_bf16 v[28:31], v[172:175], v[60:63], v[28:31]
    ds_read_b128 v[56:59], v247 offset:6336
    s_waitcnt lgkmcnt(9)
    v_mfma_f32_16x16x32_bf16 v[32:35], v[96:99], v[64:67], 0
    ds_read_b128 v[60:63], v232 offset:6592
    v_mfma_f32_16x16x32_bf16 v[32:35], v[100:103], v[68:71], v[32:35]
    ds_read_b128 v[64:67], v247 offset:6784
    s_waitcnt lgkmcnt(9)
    v_mfma_f32_16x16x32_bf16 v[32:35], v[104:107], v[72:75], v[32:35]
    s_barrier
    ds_read_b128 v[192:195], v228 offset:0
    ds_read_b128 v[196:199], v228 offset:1536
    s_setprio 3
    ds_read_b128 v[68:71], v232 offset:6656
    v_mfma_f32_16x16x32_bf16 v[32:35], v[108:111], v[76:79], v[32:35]
    v_mul_f32 v20, v20, v208
    ds_read_b128 v[72:75], v247 offset:6848
    s_waitcnt lgkmcnt(11)
    v_mfma_f32_16x16x32_bf16 v[32:35], v[112:115], v[80:83], v[32:35]
    v_mul_f32 v21, v21, v209
    ds_read_b128 v[76:79], v232 offset:6720
    v_mfma_f32_16x16x32_bf16 v[32:35], v[116:119], v[84:87], v[32:35]
    v_mul_f32 v22, v22, v210
    ds_read_b128 v[80:83], v247 offset:7168
    s_waitcnt lgkmcnt(11)
    v_mfma_f32_16x16x32_bf16 v[32:35], v[120:123], v[88:91], v[32:35]
    v_mul_f32 v23, v23, v211
    ds_read_b128 v[84:87], v232 offset:7424
    v_mfma_f32_16x16x32_bf16 v[32:35], v[124:127], v[92:95], v[32:35]
    v_cvt_pk_bf16_f32 v186, v20, v21
    ds_read_b128 v[88:91], v247 offset:7232
    s_waitcnt lgkmcnt(11)
    v_mfma_f32_16x16x32_bf16 v[36:39], v[128:131], v[48:51], 0
    v_cvt_pk_bf16_f32 v187, v22, v23
    ds_read_b128 v[92:95], v232 offset:7488
    v_mfma_f32_16x16x32_bf16 v[40:43], v[128:131], v[52:55], 0
    v_mul_f32 v24, v24, v208
    ds_read_b128 v[48:51], v248 offset:128
    s_waitcnt lgkmcnt(11)
    v_mfma_f32_16x16x32_bf16 v[36:39], v[132:135], v[56:59], v[36:39]
    v_mul_f32 v25, v25, v209
    s_waitcnt lgkmcnt(8)
    buffer_store_dwordx4 v[192:195], v229, s[12:15], s40 offen sc1
    buffer_store_dwordx4 v[196:199], v229, s[12:15], s41 offen sc1
    ds_read_b128 v[52:55], v225 offset:384
    v_mfma_f32_16x16x32_bf16 v[40:43], v[132:135], v[60:63], v[40:43]
    v_mul_f32 v26, v26, v210
    s_setprio 2
    ds_read_b128 v[56:59], v248 offset:192
    s_waitcnt lgkmcnt(9)
    v_mfma_f32_16x16x32_bf16 v[36:39], v[136:139], v[64:67], v[36:39]
    v_mul_f32 v27, v27, v211
    v_mul_f32 v204, s63, v32
    ds_read_b128 v[60:63], v225 offset:448
    v_mfma_f32_16x16x32_bf16 v[40:43], v[136:139], v[68:71], v[40:43]
    v_cvt_pk_bf16_f32 v188, v24, v25
    v_mul_f32 v205, s63, v33
    ds_read_b128 v[64:67], v248 offset:640
    s_waitcnt lgkmcnt(9)
    v_mfma_f32_16x16x32_bf16 v[36:39], v[140:143], v[72:75], v[36:39]
    v_cvt_pk_bf16_f32 v189, v26, v27
    v_mul_f32 v206, s63, v34
    ds_read_b128 v[68:71], v225 offset:512
    v_mfma_f32_16x16x32_bf16 v[40:43], v[140:143], v[76:79], v[40:43]
    v_mul_f32 v28, v28, v208
    v_mul_f32 v207, s63, v35
    ds_read_b128 v[72:75], v248 offset:704
    s_waitcnt lgkmcnt(9)
    v_mfma_f32_16x16x32_bf16 v[36:39], v[144:147], v[80:83], v[36:39]
    v_mul_f32 v29, v29, v209
    v_exp_f32 v204, v204
    ds_read_b128 v[76:79], v225 offset:576
    v_mfma_f32_16x16x32_bf16 v[40:43], v[144:147], v[84:87], v[40:43]
    v_mul_f32 v30, v30, v210
    v_exp_f32 v205, v205
    ds_read_b128 v[80:83], v248 offset:1024
    s_waitcnt lgkmcnt(9)
    v_mfma_f32_16x16x32_bf16 v[36:39], v[148:151], v[88:91], v[36:39]
    v_mul_f32 v31, v31, v211
    v_exp_f32 v206, v206
    ds_read_b128 v[84:87], v225 offset:1280
    v_mfma_f32_16x16x32_bf16 v[40:43], v[148:151], v[92:95], v[40:43]
    v_cvt_pk_bf16_f32 v190, v28, v29
    v_exp_f32 v207, v207
    ds_read_b128 v[88:91], v248 offset:1088
    s_waitcnt lgkmcnt(9)
    v_mfma_f32_16x16x32_bf16 v[36:39], v[152:155], v[48:51], v[36:39]
    v_cvt_pk_bf16_f32 v191, v30, v31
    v_add_f32 v204, 1.0, v204
    s_setprio 1
    ds_read_b128 v[92:95], v225 offset:1344
    v_mfma_f32_16x16x32_bf16 v[40:43], v[152:155], v[52:55], v[40:43]
    ds_write_b64 v254, v[184:185] offset:3072
    ds_write_b64 v254, v[186:187] offset:3328
    ds_write_b64 v254, v[188:189] offset:3584
    ds_write_b64 v254, v[190:191] offset:3840
    v_add_f32 v205, 1.0, v205
    s_waitcnt lgkmcnt(12)
    v_mfma_f32_16x16x32_bf16 v[36:39], v[156:159], v[56:59], v[36:39]
    v_add_f32 v206, 1.0, v206
    v_mfma_f32_16x16x32_bf16 v[40:43], v[156:159], v[60:63], v[40:43]
    v_add_f32 v207, 1.0, v207
    s_waitcnt lgkmcnt(10)
    v_mfma_f32_16x16x32_bf16 v[36:39], v[160:163], v[64:67], v[36:39]
    v_rcp_f32 v204, v204
    v_mfma_f32_16x16x32_bf16 v[40:43], v[160:163], v[68:71], v[40:43]
    v_rcp_f32 v205, v205
    s_waitcnt lgkmcnt(8)
    v_mfma_f32_16x16x32_bf16 v[36:39], v[164:167], v[72:75], v[36:39]
    v_rcp_f32 v206, v206
    v_mfma_f32_16x16x32_bf16 v[40:43], v[164:167], v[76:79], v[40:43]
    v_rcp_f32 v207, v207
    s_waitcnt lgkmcnt(6)
    v_mfma_f32_16x16x32_bf16 v[36:39], v[168:171], v[80:83], v[36:39]
    v_cvt_pk_bf16_f32 v176, v32, v33
    s_setprio 0
    v_mfma_f32_16x16x32_bf16 v[40:43], v[168:171], v[84:87], v[40:43]
    v_cvt_pk_bf16_f32 v177, v34, v35
    s_waitcnt lgkmcnt(4)
    v_mfma_f32_16x16x32_bf16 v[36:39], v[172:175], v[88:91], v[36:39]
    ds_write_b64 v255, v[176:177] offset:0
    v_mfma_f32_16x16x32_bf16 v[40:43], v[172:175], v[92:95], v[40:43]
    s_nop 5
    v_mul_f32 v36, v36, v204
    v_mul_f32 v37, v37, v205
    v_mul_f32 v38, v38, v206
    v_mul_f32 v39, v39, v207
    v_cvt_pk_bf16_f32 v178, v36, v37
    v_cvt_pk_bf16_f32 v179, v38, v39
    v_mul_f32 v40, v40, v204
    v_mul_f32 v41, v41, v205
    v_mul_f32 v42, v42, v206
    v_mul_f32 v43, v43, v207
    v_cvt_pk_bf16_f32 v180, v40, v41
    v_cvt_pk_bf16_f32 v181, v42, v43
    ds_write_b64 v246, v[178:179] offset:256
    ds_write_b64 v255, v[180:181] offset:512
    s_waitcnt lgkmcnt(0)
    s_barrier
    ds_read_b128 v[192:195], v228 offset:3072
    ds_read_b128 v[196:199], v228 offset:4608
    ds_read_b128 v[200:203], v249
    s_waitcnt lgkmcnt(1)
    buffer_store_dwordx4 v[192:195], v229, s[12:15], s42 offen sc1
    buffer_store_dwordx4 v[196:199], v229, s[12:15], s43 offen sc1
K2_LASTROW:
    s_add_u32 s59, s20, 32
    s_cmp_ge_u32 s59, s22
    s_cbranch_scc1 K2_FIN
    s_waitcnt lgkmcnt(0)
    buffer_store_dwordx4 v[200:203], v229, s[12:15], s44 offen sc1
K2_FIN:
    s_endpgm
K2_MULTI:
    ds_read_b128 v[48:51], v222 offset:0
    ds_read_b128 v[52:55], v222 offset:64
    ds_read_b128 v[56:59], v222 offset:896
    ds_read_b128 v[60:63], v222 offset:960
    ds_read_b128 v[64:67], v223 offset:0
    ds_read_b128 v[68:71], v223 offset:64
    ds_read_b128 v[72:75], v223 offset:896
    ds_read_b128 v[76:79], v223 offset:960
    ds_read_b128 v[80:83], v222 offset:128
    ds_read_b128 v[84:87], v222 offset:384
    ds_read_b128 v[88:91], v222 offset:256
    s_waitcnt vmcnt(19) lgkmcnt(9)
    v_mfma_f32_16x16x32_bf16 v[0:3], v[96:99], v[48:51], 0
    ds_read_b128 v[92:95], v222 offset:192
    s_waitcnt vmcnt(18)
    v_mfma_f32_16x16x32_bf16 v[0:3], v[100:103], v[52:55], v[0:3]
    ds_read_b128 v[48:51], v222 offset:448
    s_waitcnt vmcnt(17) lgkmcnt(9)
    v_mfma_f32_16x16x32_bf16 v[0:3], v[104:107], v[56:59], v[0:3]
    ds_read_b128 v[52:55], v222 offset:320
    s_waitcnt vmcnt(16)
    v_mfma_f32_16x16x32_bf16 v[0:3], v[108:111], v[60:63], v[0:3]
    ds_read_b128 v[56:59], v222 offset:640
    s_waitcnt vmcnt(15) lgkmcnt(9)
    v_mfma_f32_16x16x32_bf16 v[0:3], v[112:115], v[64:67], v[0:3]
    ds_read_b128 v[60:63], v222 offset:512
    s_waitcnt vmcnt(14)
    v_mfma_f32_16x16x32_bf16 v[0:3], v[116:119], v[68:71], v[0:3]
    ds_read_b128 v[64:67], v222 offset:768
    s_waitcnt vmcnt(13) lgkmcnt(9)
    v_mfma_f32_16x16x32_bf16 v[0:3], v[120:123], v[72:75], v[0:3]
    ds_read_b128 v[68:71], v222 offset:704
    s_waitcnt vmcnt(12)
    v_mfma_f32_16x16x32_bf16 v[0:3], v[124:127], v[76:79], v[0:3]
    ds_read_b128 v[72:75], v222 offset:576
    s_waitcnt vmcnt(11) lgkmcnt(9)
    v_mfma_f32_16x16x32_bf16 v[4:7], v[128:131], v[80:83], 0
    ds_read_b128 v[76:79], v222 offset:832
    v_mfma_f32_16x16x32_bf16 v[8:11], v[128:131], v[84:87], 0
    ds_read_b128 v[80:83], v222 offset:1024
    s_waitcnt lgkmcnt(9)
    v_mfma_f32_16x16x32_bf16 v[12:15], v[128:131], v[88:91], 0
    ds_read_b128 v[84:87], v222 offset:1280
    s_waitcnt vmcnt(10)
    v_mfma_f32_16x16x32_bf16 v[4:7], v[132:135], v[92:95], v[4:7]
    ds_read_b128 v[88:91], v222 offset:1152
    s_waitcnt lgkmcnt(9)
    v_mfma_f32_16x16x32_bf16 v[8:11], v[132:135], v[48:51], v[8:11]
    ds_read_b128 v[92:95], v222 offset:1088
    v_mfma_f32_16x16x32_bf16 v[12:15], v[132:135], v[52:55], v[12:15]
    ds_read_b128 v[48:51], v222 offset:1344
    s_waitcnt vmcnt(9) lgkmcnt(9)
    v_mfma_f32_16x16x32_bf16 v[4:7], v[136:139], v[56:59], v[4:7]
    ds_read_b128 v[52:55], v222 offset:1216
    v_mfma_f32_16x16x32_bf16 v[8:11], v[136:139], v[60:63], v[8:11]
    ds_read_b128 v[56:59], v223 offset:128
    s_waitcnt lgkmcnt(9)
    v_mfma_f32_16x16x32_bf16 v[12:15], v[136:139], v[64:67], v[12:15]
    ds_read_b128 v[60:63], v223 offset:384
    s_waitcnt vmcnt(8)
    v_mfma_f32_16x16x32_bf16 v[4:7], v[140:143], v[68:71], v[4:7]
    ds_read_b128 v[64:67], v223 offset:256
    s_waitcnt lgkmcnt(9)
    v_mfma_f32_16x16x32_bf16 v[8:11], v[140:143], v[72:75], v[8:11]
    ds_read_b128 v[68:71], v223 offset:192
    v_mfma_f32_16x16x32_bf16 v[12:15], v[140:143], v[76:79], v[12:15]
    ds_read_b128 v[72:75], v223 offset:448
    s_waitcnt vmcnt(7) lgkmcnt(9)
    v_mfma_f32_16x16x32_bf16 v[4:7], v[144:147], v[80:83], v[4:7]
    ds_read_b128 v[76:79], v223 offset:320
    v_mfma_f32_16x16x32_bf16 v[8:11], v[144:147], v[84:87], v[8:11]
    ds_read_b128 v[80:83], v223 offset:640
    s_waitcnt lgkmcnt(9)
    v_mfma_f32_16x16x32_bf16 v[12:15], v[144:147], v[88:91], v[12:15]
    ds_read_b128 v[84:87], v223 offset:512
    s_waitcnt vmcnt(6)
    v_mfma_f32_16x16x32_bf16 v[4:7], v[148:151], v[92:95], v[4:7]
    ds_read_b128 v[88:91], v223 offset:768
    s_waitcnt lgkmcnt(9)
    v_mfma_f32_16x16x32_bf16 v[8:11], v[148:151], v[48:51], v[8:11]
    ds_read_b128 v[92:95], v223 offset:704
    v_mfma_f32_16x16x32_bf16 v[12:15], v[148:151], v[52:55], v[12:15]
    ds_read_b128 v[48:51], v223 offset:576
    s_waitcnt vmcnt(5) lgkmcnt(9)
    v_mfma_f32_16x16x32_bf16 v[4:7], v[152:155], v[56:59], v[4:7]
    ds_read_b128 v[52:55], v223 offset:832
    v_mfma_f32_16x16x32_bf16 v[8:11], v[152:155], v[60:63], v[8:11]
    ds_read_b128 v[56:59], v223 offset:1024
    s_waitcnt lgkmcnt(9)
    v_mfma_f32_16x16x32_bf16 v[12:15], v[152:155], v[64:67], v[12:15]
    ds_read_b128 v[60:63], v223 offset:1280
    s_waitcnt vmcnt(4)
    v_mfma_f32_16x16x32_bf16 v[4:7], v[156:159], v[68:71], v[4:7]
    ds_read_b128 v[64:67], v223 offset:1152
    s_waitcnt lgkmcnt(9)
    v_mfma_f32_16x16x32_bf16 v[8:11], v[156:159], v[72:75], v[8:11]
    ds_read_b128 v[68:71], v223 offset:1088
    v_mfma_f32_16x16x32_bf16 v[12:15], v[156:159], v[76:79], v[12:15]
    ds_read_b128 v[72:75], v223 offset:1344
    s_waitcnt vmcnt(3) lgkmcnt(9)
    v_mfma_f32_16x16x32_bf16 v[4:7], v[160:163], v[80:83], v[4:7]
    ds_read_b128 v[76:79], v223 offset:1216
    v_mfma_f32_16x16x32_bf16 v[8:11], v[160:163], v[84:87], v[8:11]
    ds_read_b128 v[80:83], v222 offset:3072
    s_waitcnt lgkmcnt(9)
    v_mfma_f32_16x16x32_bf16 v[12:15], v[160:163], v[88:91], v[12:15]
    ds_read_b128 v[84:87], v222 offset:3136
    s_waitcnt vmcnt(2)
    v_mfma_f32_16x16x32_bf16 v[4:7], v[164:167], v[92:95], v[4:7]
    ds_read_b128 v[88:91], v222 offset:3968
    s_waitcnt lgkmcnt(9)
    v_mfma_f32_16x16x32_bf16 v[8:11], v[164:167], v[48:51], v[8:11]
    ds_read_b128 v[92:95], v222 offset:4032
    v_mfma_f32_16x16x32_bf16 v[12:15], v[164:167], v[52:55], v[12:15]
    ds_read_b128 v[48:51], v223 offset:38400
    s_waitcnt vmcnt(1) lgkmcnt(9)
    v_mfma_f32_16x16x32_bf16 v[4:7], v[168:171], v[56:59], v[4:7]
    ds_read_b128 v[52:55], v223 offset:38464
    v_mfma_f32_16x16x32_bf16 v[8:11], v[168:171], v[60:63], v[8:11]
    ds_read_b128 v[56:59], v223 offset:39296
    s_waitcnt lgkmcnt(9)
    v_mfma_f32_16x16x32_bf16 v[12:15], v[168:171], v[64:67], v[12:15]
    ds_read_b128 v[60:63], v223 offset:39360
    s_waitcnt vmcnt(0)
    v_mfma_f32_16x16x32_bf16 v[4:7], v[172:175], v[68:71], v[4:7]
    ds_read_b128 v[64:67], v222 offset:3200
    s_waitcnt lgkmcnt(9)
    v_mfma_f32_16x16x32_bf16 v[8:11], v[172:175], v[72:75], v[8:11]
    ds_read_b128 v[68:71], v222 offset:3456
    v_mfma_f32_16x16x32_bf16 v[12:15], v[172:175], v[76:79], v[12:15]
    ds_read_b128 v[72:75], v222 offset:3328
    s_waitcnt lgkmcnt(9)
    v_mfma_f32_16x16x32_bf16 v[16:19], v[96:99], v[80:83], 0
    ds_read_b128 v[76:79], v222 offset:3264
    v_mfma_f32_16x16x32_bf16 v[16:19], v[100:103], v[84:87], v[16:19]
    ds_read_b128 v[80:83], v222 offset:3520
    s_waitcnt lgkmcnt(9)
    v_mfma_f32_16x16x32_bf16 v[16:19], v[104:107], v[88:91], v[16:19]
    ds_read_b128 v[84:87], v222 offset:3392
    v_mfma_f32_16x16x32_bf16 v[16:19], v[108:111], v[92:95], v[16:19]
    ds_read_b128 v[88:91], v222 offset:3712
    s_waitcnt lgkmcnt(9)
    v_mfma_f32_16x16x32_bf16 v[16:19], v[112:115], v[48:51], v[16:19]
    ds_read_b128 v[92:95], v222 offset:3584
    v_mfma_f32_16x16x32_bf16 v[16:19], v[116:119], v[52:55], v[16:19]
    ds_read_b128 v[48:51], v222 offset:3840
    s_waitcnt lgkmcnt(9)
    v_mfma_f32_16x16x32_bf16 v[16:19], v[120:123], v[56:59], v[16:19]
    ds_read_b128 v[52:55], v222 offset:3776
    v_mfma_f32_16x16x32_bf16 v[16:19], v[124:127], v[60:63], v[16:19]
    ds_read_b128 v[56:59], v222 offset:3648
    s_waitcnt lgkmcnt(9)
    v_mfma_f32_16x16x32_bf16 v[20:23], v[128:131], v[64:67], 0
    ds_read_b128 v[60:63], v222 offset:3904
    v_mfma_f32_16x16x32_bf16 v[24:27], v[128:131], v[68:71], 0
    ds_read_b128 v[64:67], v222 offset:4096
    s_waitcnt lgkmcnt(9)
    v_mfma_f32_16x16x32_bf16 v[28:31], v[128:131], v[72:75], 0
    ds_read_b128 v[68:71], v222 offset:4352
    v_mfma_f32_16x16x32_bf16 v[20:23], v[132:135], v[76:79], v[20:23]
    ds_read_b128 v[72:75], v222 offset:4224
    s_waitcnt lgkmcnt(9)
    v_mfma_f32_16x16x32_bf16 v[24:27], v[132:135], v[80:83], v[24:27]
    ds_read_b128 v[76:79], v222 offset:4160
    v_mfma_f32_16x16x32_bf16 v[28:31], v[132:135], v[84:87], v[28:31]
    ds_read_b128 v[80:83], v222 offset:4416
    s_waitcnt lgkmcnt(9)
    v_mfma_f32_16x16x32_bf16 v[20:23], v[136:139], v[88:91], v[20:23]
    ds_read_b128 v[84:87], v222 offset:4288
    v_mfma_f32_16x16x32_bf16 v[24:27], v[136:139], v[92:95], v[24:27]
    ds_read_b128 v[88:91], v223 offset:38528
    s_waitcnt lgkmcnt(9)
    v_mfma_f32_16x16x32_bf16 v[28:31], v[136:139], v[48:51], v[28:31]
    ds_read_b128 v[92:95], v223 offset:38784
    v_mfma_f32_16x16x32_bf16 v[20:23], v[140:143], v[52:55], v[20:23]
    ds_read_b128 v[48:51], v223 offset:38656
    s_waitcnt lgkmcnt(9)
    v_mfma_f32_16x16x32_bf16 v[24:27], v[140:143], v[56:59], v[24:27]
    ds_read_b128 v[52:55], v223 offset:38592
    v_mfma_f32_16x16x32_bf16 v[28:31], v[140:143], v[60:63], v[28:31]
    ds_read_b128 v[56:59], v223 offset:38848
    s_waitcnt lgkmcnt(9)
    v_mfma_f32_16x16x32_bf16 v[20:23], v[144:147], v[64:67], v[20:23]
    ds_read_b128 v[60:63], v223 offset:38720
    v_mfma_f32_16x16x32_bf16 v[24:27], v[144:147], v[68:71], v[24:27]
    ds_read_b128 v[64:67], v223 offset:39040
    s_waitcnt lgkmcnt(9)
    v_mfma_f32_16x16x32_bf16 v[28:31], v[144:147], v[72:75], v[28:31]
    ds_read_b128 v[68:71], v223 offset:38912
    v_mfma_f32_16x16x32_bf16 v[20:23], v[148:151], v[76:79], v[20:23]
    ds_read_b128 v[72:75], v223 offset:39168
    s_waitcnt lgkmcnt(9)
    v_mfma_f32_16x16x32_bf16 v[24:27], v[148:151], v[80:83], v[24:27]
    ds_read_b128 v[76:79], v223 offset:39104
    v_mfma_f32_16x16x32_bf16 v[28:31], v[148:151], v[84:87], v[28:31]
    ds_read_b128 v[80:83], v223 offset:38976
    s_waitcnt lgkmcnt(9)
    v_mfma_f32_16x16x32_bf16 v[20:23], v[152:155], v[88:91], v[20:23]
    ds_read_b128 v[84:87], v223 offset:39232
    v_mfma_f32_16x16x32_bf16 v[24:27], v[152:155], v[92:95], v[24:27]
    ds_read_b128 v[88:91], v223 offset:39424
    s_waitcnt lgkmcnt(9)
    v_mfma_f32_16x16x32_bf16 v[28:31], v[152:155], v[48:51], v[28:31]
    ds_read_b128 v[92:95], v223 offset:39680
    v_mfma_f32_16x16x32_bf16 v[20:23], v[156:159], v[52:55], v[20:23]
    ds_read_b128 v[48:51], v223 offset:39552
    s_waitcnt lgkmcnt(9)
    v_mfma_f32_16x16x32_bf16 v[24:27], v[156:159], v[56:59], v[24:27]
    ds_read_b128 v[52:55], v223 offset:39488
    v_mfma_f32_16x16x32_bf16 v[28:31], v[156:159], v[60:63], v[28:31]
    ds_read_b128 v[56:59], v223 offset:39744
    s_waitcnt lgkmcnt(9)
    v_mfma_f32_16x16x32_bf16 v[20:23], v[160:163], v[64:67], v[20:23]
    ds_read_b128 v[60:63], v223 offset:39616
    v_mfma_f32_16x16x32_bf16 v[24:27], v[160:163], v[68:71], v[24:27]
    ds_read_b128 v[64:67], v232 offset:6144
    s_waitcnt lgkmcnt(9)
    v_mfma_f32_16x16x32_bf16 v[28:31], v[160:163], v[72:75], v[28:31]
    ds_read_b128 v[68:71], v232 offset:6208
    v_mfma_f32_16x16x32_bf16 v[20:23], v[164:167], v[76:79], v[20:23]
    ds_read_b128 v[72:75], v232 offset:7040
    s_waitcnt lgkmcnt(9)
    v_mfma_f32_16x16x32_bf16 v[24:27], v[164:167], v[80:83], v[24:27]
    ds_read_b128 v[76:79], v232 offset:7104
    v_mfma_f32_16x16x32_bf16 v[28:31], v[164:167], v[84:87], v[28:31]
    ds_read_b128 v[80:83], v225 offset:0
    s_waitcnt lgkmcnt(9)
    v_mfma_f32_16x16x32_bf16 v[20:23], v[168:171], v[88:91], v[20:23]
    ds_read_b128 v[84:87], v225 offset:64
    v_mfma_f32_16x16x32_bf16 v[24:27], v[168:171], v[92:95], v[24:27]
    ds_read_b128 v[88:91], v225 offset:896
    s_waitcnt lgkmcnt(9)
    v_mfma_f32_16x16x32_bf16 v[28:31], v[168:171], v[48:51], v[28:31]
    ds_read_b128 v[92:95], v225 offset:960
    v_mfma_f32_16x16x32_bf16 v[20:23], v[172:175], v[52:55], v[20:23]
    ds_read_b128 v[48:51], v247 offset:6272
    s_waitcnt lgkmcnt(9)
    v_mfma_f32_16x16x32_bf16 v[24:27], v[172:175], v[56:59], v[24:27]
    ds_read_b128 v[52:55], v232 offset:6528
    v_mfma_f32_16x16x32_bf16 v[28:31], v[172:175], v[60:63], v[28:31]
    ds_read_b128 v[56:59], v247 offset:6336
    s_waitcnt lgkmcnt(9)
    v_mfma_f32_16x16x32_bf16 v[32:35], v[96:99], v[64:67], 0
    ds_read_b128 v[60:63], v232 offset:6592
    v_mfma_f32_16x16x32_bf16 v[32:35], v[100:103], v[68:71], v[32:35]
    ds_read_b128 v[64:67], v247 offset:6784
    s_waitcnt lgkmcnt(9)
    v_mfma_f32_16x16x32_bf16 v[32:35], v[104:107], v[72:75], v[32:35]
    ds_read_b128 v[68:71], v232 offset:6656
    v_mfma_f32_16x16x32_bf16 v[32:35], v[108:111], v[76:79], v[32:35]
    ds_read_b128 v[72:75], v247 offset:6848
    s_waitcnt lgkmcnt(9)
    v_mfma_f32_16x16x32_bf16 v[32:35], v[112:115], v[80:83], v[32:35]
    ds_read_b128 v[76:79], v232 offset:6720
    v_mfma_f32_16x16x32_bf16 v[32:35], v[116:119], v[84:87], v[32:35]
    ds_read_b128 v[80:83], v247 offset:7168
    s_waitcnt lgkmcnt(9)
    v_mfma_f32_16x16x32_bf16 v[32:35], v[120:123], v[88:91], v[32:35]
    ds_read_b128 v[84:87], v232 offset:7424
    v_mfma_f32_16x16x32_bf16 v[32:35], v[124:127], v[92:95], v[32:35]
    ds_read_b128 v[88:91], v247 offset:7232
    s_waitcnt lgkmcnt(9)
    v_mfma_f32_16x16x32_bf16 v[36:39], v[128:131], v[48:51], 0
    ds_read_b128 v[92:95], v232 offset:7488
    v_mfma_f32_16x16x32_bf16 v[40:43], v[128:131], v[52:55], 0
    ds_read_b128 v[48:51], v248 offset:128
    s_waitcnt lgkmcnt(9)
    v_mfma_f32_16x16x32_bf16 v[36:39], v[132:135], v[56:59], v[36:39]
    ds_read_b128 v[52:55], v225 offset:384
    v_mfma_f32_16x16x32_bf16 v[40:43], v[132:135], v[60:63], v[40:43]
    ds_read_b128 v[56:59], v248 offset:192
    s_waitcnt lgkmcnt(9)
    v_mfma_f32_16x16x32_bf16 v[36:39], v[136:139], v[64:67], v[36:39]
    ds_read_b128 v[60:63], v225 offset:448
    v_mfma_f32_16x16x32_bf16 v[40:43], v[136:139], v[68:71], v[40:43]
    ds_read_b128 v[64:67], v248 offset:640
    s_waitcnt lgkmcnt(9)
    v_mfma_f32_16x16x32_bf16 v[36:39], v[140:143], v[72:75], v[36:39]
    ds_read_b128 v[68:71], v225 offset:512
    v_mfma_f32_16x16x32_bf16 v[40:43], v[140:143], v[76:79], v[40:43]
    ds_read_b128 v[72:75], v248 offset:704
    s_waitcnt lgkmcnt(9)
    v_mfma_f32_16x16x32_bf16 v[36:39], v[144:147], v[80:83], v[36:39]
    ds_read_b128 v[76:79], v225 offset:576
    v_mfma_f32_16x16x32_bf16 v[40:43], v[144:147], v[84:87], v[40:43]
    ds_read_b128 v[80:83], v248 offset:1024
    s_waitcnt lgkmcnt(9)
    v_mfma_f32_16x16x32_bf16 v[36:39], v[148:151], v[88:91], v[36:39]
    ds_read_b128 v[84:87], v225 offset:1280
    v_mfma_f32_16x16x32_bf16 v[40:43], v[148:151], v[92:95], v[40:43]
    ds_read_b128 v[88:91], v248 offset:1088
    s_waitcnt lgkmcnt(9)
    v_mfma_f32_16x16x32_bf16 v[36:39], v[152:155], v[48:51], v[36:39]
    ds_read_b128 v[92:95], v225 offset:1344
    v_mfma_f32_16x16x32_bf16 v[40:43], v[152:155], v[52:55], v[40:43]
    s_waitcnt lgkmcnt(8)
    v_mfma_f32_16x16x32_bf16 v[36:39], v[156:159], v[56:59], v[36:39]
    v_mfma_f32_16x16x32_bf16 v[40:43], v[156:159], v[60:63], v[40:43]
    s_waitcnt lgkmcnt(6)
    v_mfma_f32_16x16x32_bf16 v[36:39], v[160:163], v[64:67], v[36:39]
    v_mfma_f32_16x16x32_bf16 v[40:43], v[160:163], v[68:71], v[40:43]
    s_waitcnt lgkmcnt(4)
    v_mfma_f32_16x16x32_bf16 v[36:39], v[164:167], v[72:75], v[36:39]
    v_mfma_f32_16x16x32_bf16 v[40:43], v[164:167], v[76:79], v[40:43]
    s_waitcnt lgkmcnt(2)
    v_mfma_f32_16x16x32_bf16 v[36:39], v[168:171], v[80:83], v[36:39]
    v_mfma_f32_16x16x32_bf16 v[40:43], v[168:171], v[84:87], v[40:43]
    s_waitcnt lgkmcnt(0)
    v_mfma_f32_16x16x32_bf16 v[36:39], v[172:175], v[88:91], v[36:39]
    v_mfma_f32_16x16x32_bf16 v[40:43], v[172:175], v[92:95], v[40:43]
    s_lshl_b32 s60, s54, 9
    s_lshl_b32 s61, s20, 6
    s_add_u32 s60, s60, s61
    s_mul_i32 s60, s60, 192
    s_add_u32 s60, s60, 10485760
    v_mul_u32_u24 v227, 96, v252
    s_cmp_lg_u32 s28, 0
    s_cbranch_scc1 K2_NOACC
    buffer_load_dwordx4 v[48:51], v227, s[8:11], s60 offen offset:0
    buffer_load_dwordx4 v[52:55], v227, s[8:11], s60 offen offset:16
    buffer_load_dwordx4 v[56:59], v227, s[8:11], s60 offen offset:32
    buffer_load_dwordx4 v[60:63], v227, s[8:11], s60 offen offset:48
    buffer_load_dwordx4 v[64:67], v227, s[8:11], s60 offen offset:64
    buffer_load_dwordx4 v[68:71], v227, s[8:11], s60 offen offset:80
    buffer_load_dwordx4 v[72:75], v227, s[8:11], s60 offen offset:96
    buffer_load_dwordx4 v[76:79], v227, s[8:11], s60 offen offset:112
    buffer_load_dwordx4 v[80:83], v227, s[8:11], s60 offen offset:128
    buffer_load_dwordx4 v[84:87], v227, s[8:11], s60 offen offset:144
    buffer_load_dwordx4 v[88:91], v227, s[8:11], s60 offen offset:160
    s_waitcnt vmcnt(0)
    v_add_f32 v0, v0, v48
    v_add_f32 v1, v1, v49
    v_add_f32 v2, v2, v50
    v_add_f32 v3, v3, v51
    v_add_f32 v4, v4, v52
    v_add_f32 v5, v5, v53
    v_add_f32 v6, v6, v54
    v_add_f32 v7, v7, v55
    v_add_f32 v8, v8, v56
    v_add_f32 v9, v9, v57
    v_add_f32 v10, v10, v58
    v_add_f32 v11, v11, v59
    v_add_f32 v12, v12, v60
    v_add_f32 v13, v13, v61
    v_add_f32 v14, v14, v62
    v_add_f32 v15, v15, v63
    v_add_f32 v16, v16, v64
    v_add_f32 v17, v17, v65
    v_add_f32 v18, v18, v66
    v_add_f32 v19, v19, v67
    v_add_f32 v20, v20, v68
    v_add_f32 v21, v21, v69
    v_add_f32 v22, v22, v70
    v_add_f32 v23, v23, v71
    v_add_f32 v24, v24, v72
    v_add_f32 v25, v25, v73
    v_add_f32 v26, v26, v74
    v_add_f32 v27, v27, v75
    v_add_f32 v28, v28, v76
    v_add_f32 v29, v29, v77
    v_add_f32 v30, v30, v78
    v_add_f32 v31, v31, v79
    v_add_f32 v32, v32, v80
    v_add_f32 v33, v33, v81
    v_add_f32 v34, v34, v82
    v_add_f32 v35, v35, v83
    v_add_f32 v36, v36, v84
    v_add_f32 v37, v37, v85
    v_add_f32 v38, v38, v86
    v_add_f32 v39, v39, v87
    v_add_f32 v40, v40, v88
    v_add_f32 v41, v41, v89
    v_add_f32 v42, v42, v90
    v_add_f32 v43, v43, v91
K2_NOACC:
    s_barrier
    s_cmp_eq_u32 s55, 0
    s_cbranch_scc1 K2_SPILL
    s_bfe_u32 s60, s20, 0x10002
    s_lshl_b32 s60, s60, 4
    s_add_u32 s59, s59, s60
    v_add_u32 v228, s59, v229
    s_mul_i32 s60, s20, 2400
    s_add_u32 s60, s60, 65536
    v_add_u32 v249, s60, v229
    s_mov_b32 s63, 0xbfb8aa3b
    s_add_u32 s40, s20, s21
    s_lshl_b32 s40, s40, 10
    s_add_u32 s41, s40, 8192
    s_add_u32 s42, s40, 16384
    s_add_u32 s43, s40, 24576
    s_add_u32 s44, s40, 32768
    v_mul_f32 v204, s63, v0
    v_mul_f32 v205, s63, v1
    v_mul_f32 v206, s63, v2
    v_mul_f32 v207, s63, v3
    v_exp_f32 v204, v204
    v_exp_f32 v205, v205
    v_exp_f32 v206, v206
    v_exp_f32 v207, v207
    v_add_f32 v204, 1.0, v204
    v_add_f32 v205, 1.0, v205
    v_add_f32 v206, 1.0, v206
    v_add_f32 v207, 1.0, v207
    v_rcp_f32 v204, v204
    v_rcp_f32 v205, v205
    v_rcp_f32 v206, v206
    v_rcp_f32 v207, v207
    v_cvt_pk_bf16_f32 v176, v0, v1
    v_cvt_pk_bf16_f32 v177, v2, v3
    v_mul_f32 v4, v4, v204
    v_mul_f32 v5, v5, v205
    v_mul_f32 v6, v6, v206
    v_mul_f32 v7, v7, v207
    v_cvt_pk_bf16_f32 v178, v4, v5
    v_cvt_pk_bf16_f32 v179, v6, v7
    v_mul_f32 v8, v8, v204
    v_mul_f32 v9, v9, v205
    v_mul_f32 v10, v10, v206
    v_mul_f32 v11, v11, v207
    v_cvt_pk_bf16_f32 v180, v8, v9
    v_cvt_pk_bf16_f32 v181, v10, v11
    v_mul_f32 v12, v12, v204
    v_mul_f32 v13, v13, v205
    v_mul_f32 v14, v14, v206
    v_mul_f32 v15, v15, v207
    v_cvt_pk_bf16_f32 v182, v12, v13
    v_cvt_pk_bf16_f32 v183, v14, v15
    ds_write_b64 v254, v[176:177] offset:0
    ds_write_b64 v254, v[178:179] offset:256
    ds_write_b64 v254, v[180:181] offset:512
    ds_write_b64 v254, v[182:183] offset:768
    s_waitcnt lgkmcnt(0)
    s_barrier
    ds_read_b128 v[192:195], v228 offset:0
    ds_read_b128 v[196:199], v228 offset:1536
    s_waitcnt lgkmcnt(0)
    buffer_store_dwordx4 v[192:195], v229, s[12:15], s40 offen sc1
    buffer_store_dwordx4 v[196:199], v229, s[12:15], s41 offen sc1
    v_mul_f32 v208, s63, v16
    v_mul_f32 v209, s63, v17
    v_mul_f32 v210, s63, v18
    v_mul_f32 v211, s63, v19
    v_exp_f32 v208, v208
    v_exp_f32 v209, v209
    v_exp_f32 v210, v210
    v_exp_f32 v211, v211
    v_add_f32 v208, 1.0, v208
    v_add_f32 v209, 1.0, v209
    v_add_f32 v210, 1.0, v210
    v_add_f32 v211, 1.0, v211
    v_rcp_f32 v208, v208
    v_rcp_f32 v209, v209
    v_rcp_f32 v210, v210
    v_rcp_f32 v211, v211
    v_cvt_pk_bf16_f32 v184, v16, v17
    v_cvt_pk_bf16_f32 v185, v18, v19
    v_mul_f32 v20, v20, v208
    v_mul_f32 v21, v21, v209
    v_mul_f32 v22, v22, v210
    v_mul_f32 v23, v23, v211
    v_cvt_pk_bf16_f32 v186, v20, v21
    v_cvt_pk_bf16_f32 v187, v22, v23
    v_mul_f32 v24, v24, v208
    v_mul_f32 v25, v25, v209
    v_mul_f32 v26, v26, v210
    v_mul_f32 v27, v27, v211
    v_cvt_pk_bf16_f32 v188, v24, v25
    v_cvt_pk_bf16_f32 v189, v26, v27
    v_mul_f32 v28, v28, v208
    v_mul_f32 v29, v29, v209
    v_mul_f32 v30, v30, v210
    v_mul_f32 v31, v31, v211
    v_cvt_pk_bf16_f32 v190, v28, v29
    v_cvt_pk_bf16_f32 v191, v30, v31
    ds_write_b64 v254, v[184:185] offset:3072
    ds_write_b64 v254, v[186:187] offset:3328
    ds_write_b64 v254, v[188:189] offset:3584
    ds_write_b64 v254, v[190:191] offset:3840
    s_waitcnt lgkmcnt(0)
    s_barrier
    ds_read_b128 v[192:195], v228 offset:3072
    ds_read_b128 v[196:199], v228 offset:4608
    s_waitcnt lgkmcnt(0)
    buffer_store_dwordx4 v[192:195], v229, s[12:15], s42 offen sc1
    buffer_store_dwordx4 v[196:199], v229, s[12:15], s43 offen sc1
    v_mul_f32 v204, s63, v32
    v_mul_f32 v205, s63, v33
    v_mul_f32 v206, s63, v34
    v_mul_f32 v207, s63, v35
    v_exp_f32 v204, v204
    v_exp_f32 v205, v205
    v_exp_f32 v206, v206
    v_exp_f32 v207, v207
    v_add_f32 v204, 1.0, v204
    v_add_f32 v205, 1.0, v205
    v_add_f32 v206, 1.0, v206
    v_add_f32 v207, 1.0, v207
    v_rcp_f32 v204, v204
    v_rcp_f32 v205, v205
    v_rcp_f32 v206, v206
    v_rcp_f32 v207, v207
    v_cvt_pk_bf16_f32 v176, v32, v33
    v_cvt_pk_bf16_f32 v177, v34, v35
    v_mul_f32 v36, v36, v204
    v_mul_f32 v37, v37, v205
    v_mul_f32 v38, v38, v206
    v_mul_f32 v39, v39, v207
    v_cvt_pk_bf16_f32 v178, v36, v37
    v_cvt_pk_bf16_f32 v179, v38, v39
    v_mul_f32 v40, v40, v204
    v_mul_f32 v41, v41, v205
    v_mul_f32 v42, v42, v206
    v_mul_f32 v43, v43, v207
    v_cvt_pk_bf16_f32 v180, v40, v41
    v_cvt_pk_bf16_f32 v181, v42, v43
    ds_write_b64 v255, v[176:177] offset:0
    ds_write_b64 v246, v[178:179] offset:256
    ds_write_b64 v255, v[180:181] offset:512
    s_waitcnt lgkmcnt(0)
    s_barrier
    ds_read_b128 v[200:203], v249
    s_branch K2_LASTROW
K2_SPILL:
    buffer_store_dwordx4 v[0:3], v227, s[8:11], s60 offen offset:0
    buffer_store_dwordx4 v[4:7], v227, s[8:11], s60 offen offset:16
    buffer_store_dwordx4 v[8:11], v227, s[8:11], s60 offen offset:32
    buffer_store_dwordx4 v[12:15], v227, s[8:11], s60 offen offset:48
    buffer_store_dwordx4 v[16:19], v227, s[8:11], s60 offen offset:64
    buffer_store_dwordx4 v[20:23], v227, s[8:11], s60 offen offset:80
    buffer_store_dwordx4 v[24:27], v227, s[8:11], s60 offen offset:96
    buffer_store_dwordx4 v[28:31], v227, s[8:11], s60 offen offset:112
    buffer_store_dwordx4 v[32:35], v227, s[8:11], s60 offen offset:128
    buffer_store_dwordx4 v[36:39], v227, s[8:11], s60 offen offset:144
    buffer_store_dwordx4 v[40:43], v227, s[8:11], s60 offen offset:160
    s_mov_b32 s28, 0
    s_waitcnt vmcnt(0)
    s_cmp_lt_u32 s24, s25
    s_cbranch_scc1 K2_LOAD
    s_add_u32 s23, s23, 20
    s_branch K2_WINDOW
K2_WINDOW:
    s_mov_b32 s24, 0
    s_mov_b32 s25, 1
K2_LOAD:
    v_mbcnt_lo_u32_b32 v176, -1, 0
    v_mbcnt_hi_u32_b32 v176, -1, v176
    s_lshl_b32 s58, s20, 6
    v_add_u32 v177, s58, v176
    v_lshlrev_b32 v70, 4, v176
    s_mov_b32 s58, 7110656
    buffer_load_dwordx4 v[96:99], v70, s[8:11], s58 offen offset:0 sc1
    buffer_load_dwordx4 v[100:103], v70, s[8:11], s58 offen offset:1024 sc1
    buffer_load_dwordx4 v[104:107], v70, s[8:11], s58 offen offset:2048 sc1
    buffer_load_dwordx4 v[108:111], v70, s[8:11], s58 offen offset:3072 sc1
    s_mov_b32 s58, 7114752
    buffer_load_dwordx4 v[112:115], v70, s[8:11], s58 offen offset:0 sc1
    buffer_load_dwordx4 v[116:119], v70, s[8:11], s58 offen offset:1024 sc1
    buffer_load_dwordx4 v[120:123], v70, s[8:11], s58 offen offset:2048 sc1
    buffer_load_dwordx4 v[124:127], v70, s[8:11], s58 offen offset:3072 sc1
    s_mov_b32 s58, 7118848
    buffer_load_dwordx4 v[128:131], v70, s[8:11], s58 offen offset:0 sc1
    buffer_load_dwordx4 v[132:135], v70, s[8:11], s58 offen offset:1024 sc1
    buffer_load_dwordx4 v[136:139], v70, s[8:11], s58 offen offset:2048 sc1
    buffer_load_dwordx4 v[140:143], v70, s[8:11], s58 offen offset:3072 sc1
    s_mov_b32 s58, 7122944
    buffer_load_dwordx4 v[144:147], v70, s[8:11], s58 offen offset:0 sc1
    buffer_load_dwordx4 v[148:151], v70, s[8:11], s58 offen offset:1024 sc1
    buffer_load_dwordx4 v[152:155], v70, s[8:11], s58 offen offset:2048 sc1
    buffer_load_dwordx4 v[156:159], v70, s[8:11], s58 offen offset:3072 sc1
    s_mov_b32 s58, 7127040
    buffer_load_dwordx4 v[160:163], v70, s[8:11], s58 offen offset:0 sc1
    buffer_load_dwordx4 v[164:167], v70, s[8:11], s58 offen offset:1024 sc1
    buffer_load_dwordx4 v[168:171], v70, s[8:11], s58 offen offset:2048 sc1
    buffer_load_dwordx4 v[172:175], v70, s[8:11], s58 offen offset:3072 sc1
    v_mul_u32_u24 v76, 437, v177
    v_lshrrev_b32 v76, 16, v76
    v_mul_u32_u24 v76, 150, v76
    v_sub_u32 v76, v177, v76
    v_mov_b32 v80, -1
    v_mov_b32 v77, 1.0
    v_cmp_gt_u32 vcc, 48, v76
    v_lshlrev_b32 v78, 4, v177
    v_add_u32 v78, 65536, v78
    v_cndmask_b32 v80, v80, 0, vcc
    v_cmp_gt_u32 vcc, 12, v76
    v_add_u32 v79, 64800, v78
    s_nop 0
    v_cndmask_b32 v80, v80, v77, vcc
    v_cmp_gt_u32 vcc, 450, v177
    v_mov_b32 v81, v80
    v_mov_b32 v82, v80
    v_mov_b32 v83, v80
    s_mov_b64 exec, vcc
    ds_write_b128 v78, v[80:83] offset:0
    ds_write_b128 v78, v[80:83] offset:7200
    ds_write_b128 v78, v[80:83] offset:14400
    ds_write_b128 v78, v[80:83] offset:21600
    ds_write_b128 v78, v[80:83] offset:28800
    ds_write_b128 v78, v[80:83] offset:36000
    ds_write_b128 v78, v[80:83] offset:43200
    ds_write_b128 v78, v[80:83] offset:50400
    ds_write_b128 v78, v[80:83] offset:57600
    ds_write_b128 v79, v[80:83] offset:0
    ds_write_b128 v79, v[80:83] offset:7200
    ds_write_b128 v79, v[80:83] offset:14400
    ds_write_b128 v79, v[80:83] offset:21600
    v_cmp_gt_u32 vcc, 268, v177
    s_nop 0
    s_cbranch_vccz K2_NOCL
    s_mov_b64 exec, vcc
    ds_write_b128 v79, v[80:83] offset:28800
K2_NOCL:
    s_mov_b64 exec, -1
    s_cmp_lg_u32 s20, 7
    s_cbranch_scc1 K2_NOH
    v_mov_b32 v76, 0
    v_mov_b32 v77, -1
    v_lshlrev_b32 v78, 2, v176
    v_add_u32 v78, 163424, v78
    s_mov_b64 exec, 0x1ff
    ds_write_b32 v78, v76 offset:192
    s_mov_b64 exec, 0xff
    ds_write_b32 v78, v77 offset:256
    s_mov_b64 exec, -1
    s_cmp_lg_u32 s24, 0
    s_cbranch_scc1 K2_NOH
    s_mov_b32 exec_hi, 0xffff
    ds_write_b32 v78, v76
    s_mov_b64 exec, 0x3f
    ds_write_b32 v78, v76 offset:228
    s_mov_b64 exec, -1
K2_NOH:
    s_waitcnt lgkmcnt(0)
    s_barrier
    s_branch K2_CELLS
K2_FLGLD:
    buffer_load_dwordx4 v[84:87], v72, s[8:11], s64 offen sc1
    s_mov_b32 s62, 0
    s_branch K2_FLGL2
K2_FLGCK:
    s_cmp_lg_u32 s24, 0
    s_cbranch_scc1 K2_FLGOK
    s_waitcnt vmcnt(0)
K2_FLGW:
    v_xor_b32 v84, s2, v84
    v_xor_b32 v85, s2, v85
    v_xor_b32 v86, s2, v86
    v_xor_b32 v87, s2, v87
    v_or3_b32 v84, v84, v85, v86
    v_or_b32 v84, v84, v87
    v_cmp_ne_u32 vcc, 0, v84
    s_nop 0
    s_and_b32 vcc_hi, vcc_hi, 0x3ffff
    s_cmp_eq_u64 vcc, 0
    s_cbranch_scc1 K2_FLGOK
    s_sub_u32 s60, s60, 1
    s_cbranch_scc1 K2_END
    buffer_load_dwordx4 v[84:87], v72, s[8:11], s64 offen sc1
    s_waitcnt vmcnt(0)
    s_branch K2_FLGW
K2_RT0:
    s_sub_u32 s60, s60, 1
    s_cbranch_scc1 K2_END
    buffer_load_dwordx4 v[0:3], v181, s[8:11], 0 offen offset:0 sc1
    s_waitcnt vmcnt(0)
    s_branch K2_CK0
K2_RT1:
    s_sub_u32 s60, s60, 1
    s_cbranch_scc1 K2_END
    buffer_load_dwordx4 v[4:7], v181, s[8:11], 0 offen offset:32 sc1
    s_waitcnt vmcnt(0)
    s_branch K2_CK1
K2_RT2:
    s_sub_u32 s60, s60, 1
    s_cbranch_scc1 K2_END
    buffer_load_dwordx4 v[8:11], v181, s[8:11], 0 offen offset:64 sc1
    s_waitcnt vmcnt(0)
    s_branch K2_CK2
K2_RT3:
    s_sub_u32 s60, s60, 1
    s_cbranch_scc1 K2_END
    buffer_load_dwordx4 v[12:15], v181, s[8:11], 0 offen offset:96 sc1
    s_waitcnt vmcnt(0)
    s_branch K2_CK3
K2_RT4:
    s_sub_u32 s60, s60, 1
    s_cbranch_scc1 K2_END
    buffer_load_dwordx4 v[16:19], v181, s[8:11], 0 offen offset:128 sc1
    s_waitcnt vmcnt(0)
    s_branch K2_CK4
K2_RT5:
    s_sub_u32 s60, s60, 1
    s_cbranch_scc1 K2_END
    buffer_load_dwordx4 v[20:23], v181, s[8:11], 0 offen offset:160 sc1
    s_waitcnt vmcnt(0)
    s_branch K2_CK5
K2_RT6:
    s_sub_u32 s60, s60, 1
    s_cbranch_scc1 K2_END
    buffer_load_dwordx4 v[24:27], v181, s[8:11], 0 offen offset:192 sc1
    s_waitcnt vmcnt(0)
    s_branch K2_CK6
K2_RT7:
    s_sub_u32 s60, s60, 1
    s_cbranch_scc1 K2_END
    buffer_load_dwordx4 v[28:31], v181, s[8:11], 0 offen offset:224 sc1
    s_waitcnt vmcnt(0)
    s_branch K2_CK7
K2_RT8:
    s_sub_u32 s60, s60, 1
    s_cbranch_scc1 K2_END
    buffer_load_dwordx4 v[32:35], v181, s[8:11], 0 offen offset:256 sc1
    s_waitcnt vmcnt(0)
    s_branch K2_CK8
K2_RT9:
    s_sub_u32 s60, s60, 1
    s_cbranch_scc1 K2_END
    buffer_load_dwordx4 v[36:39], v181, s[8:11], 0 offen offset:288 sc1
    s_waitcnt vmcnt(0)
    s_branch K2_CK9
K2_RK_LOAD:
    s_waitcnt vmcnt(0)
    s_mov_b64 exec, s[40:41]
    s_cbranch_execz K2_RK_B
    v_lshrrev_b32 v50, 24, v3
    buffer_load_dword v40, v179, s[8:11], s66 offen offset:0
    v_mad_u32_u24 v50, v50, s58, v202
    v_and_b32 v3, 0xffffff, v3
    s_mov_b64 exec, s[42:43]
    s_cbranch_execz K2_RK_B
    v_lshrrev_b32 v51, 24, v7
    buffer_load_dword v41, v179, s[8:11], s66 offen offset:8
    v_mad_u32_u24 v51, v51, s58, v202
    v_and_b32 v7, 0xffffff, v7
    s_mov_b64 exec, s[44:45]
    s_cbranch_execz K2_RK_B
    v_lshrrev_b32 v52, 24, v11
    buffer_load_dword v42, v179, s[8:11], s66 offen offset:16
    v_mad_u32_u24 v52, v52, s58, v202
    v_and_b32 v11, 0xffffff, v11
    s_mov_b64 exec, s[46:47]
    s_cbranch_execz K2_RK_B
    v_lshrrev_b32 v53, 24, v15
    buffer_load_dword v43, v179, s[8:11], s66 offen offset:24
    v_mad_u32_u24 v53, v53, s58, v202
    v_and_b32 v15, 0xffffff, v15
    s_mov_b64 exec, s[48:49]
    s_cbranch_execz K2_RK_B
    v_lshrrev_b32 v54, 24, v19
    buffer_load_dword v44, v179, s[8:11], s66 offen offset:32
    v_mad_u32_u24 v54, v54, s58, v202
    v_and_b32 v19, 0xffffff, v19
    s_mov_b64 exec, s[50:51]
    s_cbranch_execz K2_RK_B
    v_lshrrev_b32 v55, 24, v23
    buffer_load_dword v45, v179, s[8:11], s66 offen offset:40
    v_mad_u32_u24 v55, v55, s58, v202
    v_and_b32 v23, 0xffffff, v23
    s_mov_b64 exec, s[90:91]
    s_cbranch_execz K2_RK_B
    v_lshrrev_b32 v56, 24, v27
    buffer_load_dword v46, v179, s[8:11], s66 offen offset:48
    v_mad_u32_u24 v56, v56, s58, v202
    v_and_b32 v27, 0xffffff, v27
    s_mov_b64 exec, s[92:93]
    s_cbranch_execz K2_RK_B
    v_lshrrev_b32 v57, 24, v31
    buffer_load_dword v47, v179, s[8:11], s66 offen offset:56
    v_mad_u32_u24 v57, v57, s58, v202
    v_and_b32 v31, 0xffffff, v31
    s_mov_b64 exec, s[94:95]
    s_cbranch_execz K2_RK_B
    v_lshrrev_b32 v58, 24, v35
    buffer_load_dword v48, v179, s[8:11], s66 offen offset:64
    v_mad_u32_u24 v58, v58, s58, v202
    v_and_b32 v35, 0xffffff, v35
    s_mov_b64 exec, s[96:97]
    s_cbranch_execz K2_RK_B
    v_lshrrev_b32 v59, 24, v39
    buffer_load_dword v49, v179, s[8:11], s66 offen offset:72
    v_mad_u32_u24 v59, v59, s58, v202
    v_and_b32 v39, 0xffffff, v39
K2_RK_B:
    s_mov_b64 exec, -1
    s_mul_i32 s62, s24, 48
    s_waitcnt vmcnt(0)
    v_subrev_u32 v40, s62, v40
    v_subrev_u32 v41, s62, v41
    v_subrev_u32 v42, s62, v42
    v_subrev_u32 v43, s62, v43
    v_subrev_u32 v44, s62, v44
    v_subrev_u32 v45, s62, v45
    v_subrev_u32 v46, s62, v46
    v_subrev_u32 v47, s62, v47
    v_subrev_u32 v48, s62, v48
    v_subrev_u32 v49, s62, v49
    s_branch K2_RK_DONE
K2_OV0:
    s_cmp_lg_u32 s24, 0
    s_cbranch_scc1 K2_OB0
    s_andn2_b64 exec, s[40:41], exec
    v_cmp_gt_u32 vcc, 64, v40
    s_nop 0
    s_mov_b64 exec, vcc
    s_cbranch_execz K2_OB0
    v_subrev_u32 v192, 48, v40
    v_mov_b32 v197, 163656
    v_mov_b32 v198, 0
    s_mov_b64 s[56:57], 0
    s_mov_b32 s62, 0
    s_cmp_eq_u32 s22, 39
    s_cselect_b32 s63, 5, 2
K2_OP0:
    ds_cmpst_rtn_b32 v200, v197, v198, v50
    s_cmp_ge_u32 s62, 2
    s_cselect_b32 s65, 159136, 0
    s_cselect_b32 s26, 32, 0
    s_cbranch_scc1 K2_OQ0
    s_mov_b32 s65, 161536
K2_OQ0:
    s_lshl_b32 s61, s62, 4
    s_sub_u32 s61, s61, s26
    v_mov_b32 v199, s65
    v_add_u32 v203, s61, v192
    s_waitcnt lgkmcnt(0)
    v_cmp_eq_u32 vcc, 0, v200
    v_cmp_eq_u32 s[56:57], v200, v50
    s_nop 0
    s_or_b64 vcc, vcc, s[56:57]
    s_andn2_b64 s[56:57], exec, vcc
    s_mov_b64 exec, vcc
    v_lshl_add_u32 v194, v203, 5, v199
    v_lshl_add_u32 v195, v203, 2, v199
    v_lshrrev_b32 v193, 3, v203
    v_mad_i32_i24 v196, v193, -16, v195
    v_and_b32 v193, 1, v193
    v_mad_i32_i24 v196, v193, -14, v196
    ds_write_b32 v194, v3 offset:864
    ds_write_b16 v195, v0 offset:194
    ds_write_b16_d16_hi v195, v0 offset:386
    ds_write_b16_d16_hi v195, v1 offset:578
    ds_write_b16 v196, v2 offset:768
    s_mov_b64 exec, s[56:57]
    s_cbranch_execz K2_OB0
    v_add_u32 v197, 4, v197
    s_add_u32 s62, s62, 1
    s_cmp_lt_u32 s62, s63
    s_cbranch_scc1 K2_OP0
    s_branch K2_OB0
K2_OV1:
    s_cmp_lg_u32 s24, 0
    s_cbranch_scc1 K2_OB1
    s_andn2_b64 exec, s[42:43], exec
    v_cmp_gt_u32 vcc, 64, v41
    s_nop 0
    s_mov_b64 exec, vcc
    s_cbranch_execz K2_OB1
    v_subrev_u32 v192, 48, v41
    v_mov_b32 v197, 163656
    v_mov_b32 v198, 0
    s_mov_b64 s[56:57], 0
    s_mov_b32 s62, 0
    s_cmp_eq_u32 s22, 39
    s_cselect_b32 s63, 5, 2
K2_OP1:
    ds_cmpst_rtn_b32 v200, v197, v198, v51
    s_cmp_ge_u32 s62, 2
    s_cselect_b32 s65, 159136, 0
    s_cselect_b32 s26, 32, 0
    s_cbranch_scc1 K2_OQ1
    s_mov_b32 s65, 161536
K2_OQ1:
    s_lshl_b32 s61, s62, 4
    s_sub_u32 s61, s61, s26
    v_mov_b32 v199, s65
    v_add_u32 v203, s61, v192
    s_waitcnt lgkmcnt(0)
    v_cmp_eq_u32 vcc, 0, v200
    v_cmp_eq_u32 s[56:57], v200, v51
    s_nop 0
    s_or_b64 vcc, vcc, s[56:57]
    s_andn2_b64 s[56:57], exec, vcc
    s_mov_b64 exec, vcc
    v_lshl_add_u32 v194, v203, 5, v199
    v_lshl_add_u32 v195, v203, 2, v199
    v_lshrrev_b32 v193, 3, v203
    v_mad_i32_i24 v196, v193, -16, v195
    v_and_b32 v193, 1, v193
    v_mad_i32_i24 v196, v193, -14, v196
    ds_write_b32 v194, v7 offset:864
    ds_write_b16 v195, v4 offset:194
    ds_write_b16_d16_hi v195, v4 offset:386
    ds_write_b16_d16_hi v195, v5 offset:578
    ds_write_b16 v196, v6 offset:768
    s_mov_b64 exec, s[56:57]
    s_cbranch_execz K2_OB1
    v_add_u32 v197, 4, v197
    s_add_u32 s62, s62, 1
    s_cmp_lt_u32 s62, s63
    s_cbranch_scc1 K2_OP1
    s_branch K2_OB1
K2_OV2:
    s_cmp_lg_u32 s24, 0
    s_cbranch_scc1 K2_OB2
    s_andn2_b64 exec, s[44:45], exec
    v_cmp_gt_u32 vcc, 64, v42
    s_nop 0
    s_mov_b64 exec, vcc
    s_cbranch_execz K2_OB2
    v_subrev_u32 v192, 48, v42
    v_mov_b32 v197, 163656
    v_mov_b32 v198, 0
    s_mov_b64 s[56:57], 0
    s_mov_b32 s62, 0
    s_cmp_eq_u32 s22, 39
    s_cselect_b32 s63, 5, 2
K2_OP2:
    ds_cmpst_rtn_b32 v200, v197, v198, v52
    s_cmp_ge_u32 s62, 2
    s_cselect_b32 s65, 159136, 0
    s_cselect_b32 s26, 32, 0
    s_cbranch_scc1 K2_OQ2
    s_mov_b32 s65, 161536
K2_OQ2:
    s_lshl_b32 s61, s62, 4
    s_sub_u32 s61, s61, s26
    v_mov_b32 v199, s65
    v_add_u32 v203, s61, v192
    s_waitcnt lgkmcnt(0)
    v_cmp_eq_u32 vcc, 0, v200
    v_cmp_eq_u32 s[56:57], v200, v52
    s_nop 0
    s_or_b64 vcc, vcc, s[56:57]
    s_andn2_b64 s[56:57], exec, vcc
    s_mov_b64 exec, vcc
    v_lshl_add_u32 v194, v203, 5, v199
    v_lshl_add_u32 v195, v203, 2, v199
    v_lshrrev_b32 v193, 3, v203
    v_mad_i32_i24 v196, v193, -16, v195
    v_and_b32 v193, 1, v193
    v_mad_i32_i24 v196, v193, -14, v196
    ds_write_b32 v194, v11 offset:864
    ds_write_b16 v195, v8 offset:194
    ds_write_b16_d16_hi v195, v8 offset:386
    ds_write_b16_d16_hi v195, v9 offset:578
    ds_write_b16 v196, v10 offset:768
    s_mov_b64 exec, s[56:57]
    s_cbranch_execz K2_OB2
    v_add_u32 v197, 4, v197
    s_add_u32 s62, s62, 1
    s_cmp_lt_u32 s62, s63
    s_cbranch_scc1 K2_OP2
    s_branch K2_OB2
K2_OV3:
    s_cmp_lg_u32 s24, 0
    s_cbranch_scc1 K2_OB3
    s_andn2_b64 exec, s[46:47], exec
    v_cmp_gt_u32 vcc, 64, v43
    s_nop 0
    s_mov_b64 exec, vcc
    s_cbranch_execz K2_OB3
    v_subrev_u32 v192, 48, v43
    v_mov_b32 v197, 163656
    v_mov_b32 v198, 0
    s_mov_b64 s[56:57], 0
    s_mov_b32 s62, 0
    s_cmp_eq_u32 s22, 39
    s_cselect_b32 s63, 5, 2
K2_OP3:
    ds_cmpst_rtn_b32 v200, v197, v198, v53
    s_cmp_ge_u32 s62, 2
    s_cselect_b32 s65, 159136, 0
    s_cselect_b32 s26, 32, 0
    s_cbranch_scc1 K2_OQ3
    s_mov_b32 s65, 161536
K2_OQ3:
    s_lshl_b32 s61, s62, 4
    s_sub_u32 s61, s61, s26
    v_mov_b32 v199, s65
    v_add_u32 v203, s61, v192
    s_waitcnt lgkmcnt(0)
    v_cmp_eq_u32 vcc, 0, v200
    v_cmp_eq_u32 s[56:57], v200, v53
    s_nop 0
    s_or_b64 vcc, vcc, s[56:57]
    s_andn2_b64 s[56:57], exec, vcc
    s_mov_b64 exec, vcc
    v_lshl_add_u32 v194, v203, 5, v199
    v_lshl_add_u32 v195, v203, 2, v199
    v_lshrrev_b32 v193, 3, v203
    v_mad_i32_i24 v196, v193, -16, v195
    v_and_b32 v193, 1, v193
    v_mad_i32_i24 v196, v193, -14, v196
    ds_write_b32 v194, v15 offset:864
    ds_write_b16 v195, v12 offset:194
    ds_write_b16_d16_hi v195, v12 offset:386
    ds_write_b16_d16_hi v195, v13 offset:578
    ds_write_b16 v196, v14 offset:768
    s_mov_b64 exec, s[56:57]
    s_cbranch_execz K2_OB3
    v_add_u32 v197, 4, v197
    s_add_u32 s62, s62, 1
    s_cmp_lt_u32 s62, s63
    s_cbranch_scc1 K2_OP3
    s_branch K2_OB3
K2_OV4:
    s_cmp_lg_u32 s24, 0
    s_cbranch_scc1 K2_OB4
    s_andn2_b64 exec, s[48:49], exec
    v_cmp_gt_u32 vcc, 64, v44
    s_nop 0
    s_mov_b64 exec, vcc
    s_cbranch_execz K2_OB4
    v_subrev_u32 v192, 48, v44
    v_mov_b32 v197, 163656
    v_mov_b32 v198, 0
    s_mov_b64 s[56:57], 0
    s_mov_b32 s62, 0
    s_cmp_eq_u32 s22, 39
    s_cselect_b32 s63, 5, 2
K2_OP4:
    ds_cmpst_rtn_b32 v200, v197, v198, v54
    s_cmp_ge_u32 s62, 2
    s_cselect_b32 s65, 159136, 0
    s_cselect_b32 s26, 32, 0
    s_cbranch_scc1 K2_OQ4
    s_mov_b32 s65, 161536
K2_OQ4:
    s_lshl_b32 s61, s62, 4
    s_sub_u32 s61, s61, s26
    v_mov_b32 v199, s65
    v_add_u32 v203, s61, v192
    s_waitcnt lgkmcnt(0)
    v_cmp_eq_u32 vcc, 0, v200
    v_cmp_eq_u32 s[56:57], v200, v54
    s_nop 0
    s_or_b64 vcc, vcc, s[56:57]
    s_andn2_b64 s[56:57], exec, vcc
    s_mov_b64 exec, vcc
    v_lshl_add_u32 v194, v203, 5, v199
    v_lshl_add_u32 v195, v203, 2, v199
    v_lshrrev_b32 v193, 3, v203
    v_mad_i32_i24 v196, v193, -16, v195
    v_and_b32 v193, 1, v193
    v_mad_i32_i24 v196, v193, -14, v196
    ds_write_b32 v194, v19 offset:864
    ds_write_b16 v195, v16 offset:194
    ds_write_b16_d16_hi v195, v16 offset:386
    ds_write_b16_d16_hi v195, v17 offset:578
    ds_write_b16 v196, v18 offset:768
    s_mov_b64 exec, s[56:57]
    s_cbranch_execz K2_OB4
    v_add_u32 v197, 4, v197
    s_add_u32 s62, s62, 1
    s_cmp_lt_u32 s62, s63
    s_cbranch_scc1 K2_OP4
    s_branch K2_OB4
K2_OV5:
    s_cmp_lg_u32 s24, 0
    s_cbranch_scc1 K2_OB5
    s_andn2_b64 exec, s[50:51], exec
    v_cmp_gt_u32 vcc, 64, v45
    s_nop 0
    s_mov_b64 exec, vcc
    s_cbranch_execz K2_OB5
    v_subrev_u32 v192, 48, v45
    v_mov_b32 v197, 163656
    v_mov_b32 v198, 0
    s_mov_b64 s[56:57], 0
    s_mov_b32 s62, 0
    s_cmp_eq_u32 s22, 39
    s_cselect_b32 s63, 5, 2
K2_OP5:
    ds_cmpst_rtn_b32 v200, v197, v198, v55
    s_cmp_ge_u32 s62, 2
    s_cselect_b32 s65, 159136, 0
    s_cselect_b32 s26, 32, 0
    s_cbranch_scc1 K2_OQ5
    s_mov_b32 s65, 161536
K2_OQ5:
    s_lshl_b32 s61, s62, 4
    s_sub_u32 s61, s61, s26
    v_mov_b32 v199, s65
    v_add_u32 v203, s61, v192
    s_waitcnt lgkmcnt(0)
    v_cmp_eq_u32 vcc, 0, v200
    v_cmp_eq_u32 s[56:57], v200, v55
    s_nop 0
    s_or_b64 vcc, vcc, s[56:57]
    s_andn2_b64 s[56:57], exec, vcc
    s_mov_b64 exec, vcc
    v_lshl_add_u32 v194, v203, 5, v199
    v_lshl_add_u32 v195, v203, 2, v199
    v_lshrrev_b32 v193, 3, v203
    v_mad_i32_i24 v196, v193, -16, v195
    v_and_b32 v193, 1, v193
    v_mad_i32_i24 v196, v193, -14, v196
    ds_write_b32 v194, v23 offset:864
    ds_write_b16 v195, v20 offset:194
    ds_write_b16_d16_hi v195, v20 offset:386
    ds_write_b16_d16_hi v195, v21 offset:578
    ds_write_b16 v196, v22 offset:768
    s_mov_b64 exec, s[56:57]
    s_cbranch_execz K2_OB5
    v_add_u32 v197, 4, v197
    s_add_u32 s62, s62, 1
    s_cmp_lt_u32 s62, s63
    s_cbranch_scc1 K2_OP5
    s_branch K2_OB5
K2_OV6:
    s_cmp_lg_u32 s24, 0
    s_cbranch_scc1 K2_OB6
    s_andn2_b64 exec, s[90:91], exec
    v_cmp_gt_u32 vcc, 64, v46
    s_nop 0
    s_mov_b64 exec, vcc
    s_cbranch_execz K2_OB6
    v_subrev_u32 v192, 48, v46
    v_mov_b32 v197, 163656
    v_mov_b32 v198, 0
    s_mov_b64 s[56:57], 0
    s_mov_b32 s62, 0
    s_cmp_eq_u32 s22, 39
    s_cselect_b32 s63, 5, 2
K2_OP6:
    ds_cmpst_rtn_b32 v200, v197, v198, v56
    s_cmp_ge_u32 s62, 2
    s_cselect_b32 s65, 159136, 0
    s_cselect_b32 s26, 32, 0
    s_cbranch_scc1 K2_OQ6
    s_mov_b32 s65, 161536
K2_OQ6:
    s_lshl_b32 s61, s62, 4
    s_sub_u32 s61, s61, s26
    v_mov_b32 v199, s65
    v_add_u32 v203, s61, v192
    s_waitcnt lgkmcnt(0)
    v_cmp_eq_u32 vcc, 0, v200
    v_cmp_eq_u32 s[56:57], v200, v56
    s_nop 0
    s_or_b64 vcc, vcc, s[56:57]
    s_andn2_b64 s[56:57], exec, vcc
    s_mov_b64 exec, vcc
    v_lshl_add_u32 v194, v203, 5, v199
    v_lshl_add_u32 v195, v203, 2, v199
    v_lshrrev_b32 v193, 3, v203
    v_mad_i32_i24 v196, v193, -16, v195
    v_and_b32 v193, 1, v193
    v_mad_i32_i24 v196, v193, -14, v196
    ds_write_b32 v194, v27 offset:864
    ds_write_b16 v195, v24 offset:194
    ds_write_b16_d16_hi v195, v24 offset:386
    ds_write_b16_d16_hi v195, v25 offset:578
    ds_write_b16 v196, v26 offset:768
    s_mov_b64 exec, s[56:57]
    s_cbranch_execz K2_OB6
    v_add_u32 v197, 4, v197
    s_add_u32 s62, s62, 1
    s_cmp_lt_u32 s62, s63
    s_cbranch_scc1 K2_OP6
    s_branch K2_OB6
K2_OV7:
    s_cmp_lg_u32 s24, 0
    s_cbranch_scc1 K2_OB7
    s_andn2_b64 exec, s[92:93], exec
    v_cmp_gt_u32 vcc, 64, v47
    s_nop 0
    s_mov_b64 exec, vcc
    s_cbranch_execz K2_OB7
    v_subrev_u32 v192, 48, v47
    v_mov_b32 v197, 163656
    v_mov_b32 v198, 0
    s_mov_b64 s[56:57], 0
    s_mov_b32 s62, 0
    s_cmp_eq_u32 s22, 39
    s_cselect_b32 s63, 5, 2
K2_OP7:
    ds_cmpst_rtn_b32 v200, v197, v198, v57
    s_cmp_ge_u32 s62, 2
    s_cselect_b32 s65, 159136, 0
    s_cselect_b32 s26, 32, 0
    s_cbranch_scc1 K2_OQ7
    s_mov_b32 s65, 161536
K2_OQ7:
    s_lshl_b32 s61, s62, 4
    s_sub_u32 s61, s61, s26
    v_mov_b32 v199, s65
    v_add_u32 v203, s61, v192
    s_waitcnt lgkmcnt(0)
    v_cmp_eq_u32 vcc, 0, v200
    v_cmp_eq_u32 s[56:57], v200, v57
    s_nop 0
    s_or_b64 vcc, vcc, s[56:57]
    s_andn2_b64 s[56:57], exec, vcc
    s_mov_b64 exec, vcc
    v_lshl_add_u32 v194, v203, 5, v199
    v_lshl_add_u32 v195, v203, 2, v199
    v_lshrrev_b32 v193, 3, v203
    v_mad_i32_i24 v196, v193, -16, v195
    v_and_b32 v193, 1, v193
    v_mad_i32_i24 v196, v193, -14, v196
    ds_write_b32 v194, v31 offset:864
    ds_write_b16 v195, v28 offset:194
    ds_write_b16_d16_hi v195, v28 offset:386
    ds_write_b16_d16_hi v195, v29 offset:578
    ds_write_b16 v196, v30 offset:768
    s_mov_b64 exec, s[56:57]
    s_cbranch_execz K2_OB7
    v_add_u32 v197, 4, v197
    s_add_u32 s62, s62, 1
    s_cmp_lt_u32 s62, s63
    s_cbranch_scc1 K2_OP7
    s_branch K2_OB7
K2_OV8:
    s_cmp_lg_u32 s24, 0
    s_cbranch_scc1 K2_OB8
    s_andn2_b64 exec, s[94:95], exec
    v_cmp_gt_u32 vcc, 64, v48
    s_nop 0
    s_mov_b64 exec, vcc
    s_cbranch_execz K2_OB8
    v_subrev_u32 v192, 48, v48
    v_mov_b32 v197, 163656
    v_mov_b32 v198, 0
    s_mov_b64 s[56:57], 0
    s_mov_b32 s62, 0
    s_cmp_eq_u32 s22, 39
    s_cselect_b32 s63, 5, 2
K2_OP8:
    ds_cmpst_rtn_b32 v200, v197, v198, v58
    s_cmp_ge_u32 s62, 2
    s_cselect_b32 s65, 159136, 0
    s_cselect_b32 s26, 32, 0
    s_cbranch_scc1 K2_OQ8
    s_mov_b32 s65, 161536
K2_OQ8:
    s_lshl_b32 s61, s62, 4
    s_sub_u32 s61, s61, s26
    v_mov_b32 v199, s65
    v_add_u32 v203, s61, v192
    s_waitcnt lgkmcnt(0)
    v_cmp_eq_u32 vcc, 0, v200
    v_cmp_eq_u32 s[56:57], v200, v58
    s_nop 0
    s_or_b64 vcc, vcc, s[56:57]
    s_andn2_b64 s[56:57], exec, vcc
    s_mov_b64 exec, vcc
    v_lshl_add_u32 v194, v203, 5, v199
    v_lshl_add_u32 v195, v203, 2, v199
    v_lshrrev_b32 v193, 3, v203
    v_mad_i32_i24 v196, v193, -16, v195
    v_and_b32 v193, 1, v193
    v_mad_i32_i24 v196, v193, -14, v196
    ds_write_b32 v194, v35 offset:864
    ds_write_b16 v195, v32 offset:194
    ds_write_b16_d16_hi v195, v32 offset:386
    ds_write_b16_d16_hi v195, v33 offset:578
    ds_write_b16 v196, v34 offset:768
    s_mov_b64 exec, s[56:57]
    s_cbranch_execz K2_OB8
    v_add_u32 v197, 4, v197
    s_add_u32 s62, s62, 1
    s_cmp_lt_u32 s62, s63
    s_cbranch_scc1 K2_OP8
    s_branch K2_OB8
K2_OV9:
    s_cmp_lg_u32 s24, 0
    s_cbranch_scc1 K2_OB9
    s_andn2_b64 exec, s[96:97], exec
    v_cmp_gt_u32 vcc, 64, v49
    s_nop 0
    s_mov_b64 exec, vcc
    s_cbranch_execz K2_OB9
    v_subrev_u32 v192, 48, v49
    v_mov_b32 v197, 163656
    v_mov_b32 v198, 0
    s_mov_b64 s[56:57], 0
    s_mov_b32 s62, 0
    s_cmp_eq_u32 s22, 39
    s_cselect_b32 s63, 5, 2
K2_OP9:
    ds_cmpst_rtn_b32 v200, v197, v198, v59
    s_cmp_ge_u32 s62, 2
    s_cselect_b32 s65, 159136, 0
    s_cselect_b32 s26, 32, 0
    s_cbranch_scc1 K2_OQ9
    s_mov_b32 s65, 161536
K2_OQ9:
    s_lshl_b32 s61, s62, 4
    s_sub_u32 s61, s61, s26
    v_mov_b32 v199, s65
    v_add_u32 v203, s61, v192
    s_waitcnt lgkmcnt(0)
    v_cmp_eq_u32 vcc, 0, v200
    v_cmp_eq_u32 s[56:57], v200, v59
    s_nop 0
    s_or_b64 vcc, vcc, s[56:57]
    s_andn2_b64 s[56:57], exec, vcc
    s_mov_b64 exec, vcc
    v_lshl_add_u32 v194, v203, 5, v199
    v_lshl_add_u32 v195, v203, 2, v199
    v_lshrrev_b32 v193, 3, v203
    v_mad_i32_i24 v196, v193, -16, v195
    v_and_b32 v193, 1, v193
    v_mad_i32_i24 v196, v193, -14, v196
    ds_write_b32 v194, v39 offset:864
    ds_write_b16 v195, v36 offset:194
    ds_write_b16_d16_hi v195, v36 offset:386
    ds_write_b16_d16_hi v195, v37 offset:578
    ds_write_b16 v196, v38 offset:768
    s_mov_b64 exec, s[56:57]
    s_cbranch_execz K2_OB9
    v_add_u32 v197, 4, v197
    s_add_u32 s62, s62, 1
    s_cmp_lt_u32 s62, s63
    s_cbranch_scc1 K2_OP9
    s_branch K2_OB9
K2_BIG:
    s_cmp_lg_u32 s24, 0
    s_cbranch_scc1 K2_TOK
    s_mov_b64 s[62:63], vcc
    s_bcnt1_i32_b64 s60, vcc
    s_cmp_eq_u32 s22, 39
    s_cselect_b32 s61, 5, 2
    s_cmp_gt_u32 s60, s61
    s_cbranch_scc1 K2_SLOW
    v_cmp_lt_u32 vcc, 64, v193
    s_nop 0
    s_cbranch_vccnz K2_SLOW
    v_mov_b32 v197, 163656
    ds_read_b32 v203, v197
    ds_read_b32 v204, v197 offset:4
    ds_read_b32 v205, v197 offset:8
    ds_read_b32 v206, v197 offset:12
    ds_read_b32 v207, v197 offset:16
    v_and_b32 v197, 0x3ffff, v195
    s_movk_i32 s26, 64
    s_waitcnt lgkmcnt(0)
    v_cmp_eq_u32 vcc, v204, v197
    v_mov_b32 v194, 134217728
    s_nop 0
    v_cndmask_b32 v198, v198, v194, vcc
    v_cmp_eq_u32 vcc, v205, v197
    v_mov_b32 v194, 268435456
    s_nop 0
    v_cndmask_b32 v198, v198, v194, vcc
    v_cmp_eq_u32 vcc, v206, v197
    v_mov_b32 v194, 402653184
    s_nop 0
    v_cndmask_b32 v198, v198, v194, vcc
    v_cmp_eq_u32 vcc, v207, v197
    v_mov_b32 v194, 536870912
    s_nop 0
    v_cndmask_b32 v198, v198, v194, vcc
    s_branch K2_TOK
K2_SLOW:
    v_mov_b32 v197, v193
    s_nop 1
    v_max_u32_dpp v197, v197, v197 row_shr:1 row_mask:0xf bank_mask:0xf bound_ctrl:0
    s_nop 1
    v_max_u32_dpp v197, v197, v197 row_shr:2 row_mask:0xf bank_mask:0xf bound_ctrl:0
    s_nop 1
    v_max_u32_dpp v197, v197, v197 row_shr:4 row_mask:0xf bank_mask:0xf bound_ctrl:0
    s_nop 1
    v_max_u32_dpp v197, v197, v197 row_shr:8 row_mask:0xf bank_mask:0xf bound_ctrl:0
    s_nop 1
    v_max_u32_dpp v197, v197, v197 row_bcast:15 row_mask:0xa bank_mask:0xf
    s_nop 1
    v_max_u32_dpp v197, v197, v197 row_bcast:31 row_mask:0xc bank_mask:0xf
    s_nop 0
    v_readlane_b32 s25, v197, 63
    s_nop 0
    s_add_u32 s25, s25, 47
    s_mul_i32 s25, s25, 43691
    s_lshr_b32 s25, s25, 21
    v_cmp_lt_i32 vcc, 0, v180
    s_nop 0
    s_cbranch_vccz K2_SV_DONE
    s_mov_b64 exec, vcc
    buffer_store_dword v40, v179, s[8:11], s66 offen offset:0
    v_cmp_lt_i32 vcc, 2, v180
    s_nop 0
    s_cbranch_vccz K2_SV_DONE
    s_mov_b64 exec, vcc
    buffer_store_dword v41, v179, s[8:11], s66 offen offset:8
    v_cmp_lt_i32 vcc, 4, v180
    s_nop 0
    s_cbranch_vccz K2_SV_DONE
    s_mov_b64 exec, vcc
    buffer_store_dword v42, v179, s[8:11], s66 offen offset:16
    v_cmp_lt_i32 vcc, 6, v180
    s_nop 0
    s_cbranch_vccz K2_SV_DONE
    s_mov_b64 exec, vcc
    buffer_store_dword v43, v179, s[8:11], s66 offen offset:24
    v_cmp_lt_i32 vcc, 8, v180
    s_nop 0
    s_cbranch_vccz K2_SV_DONE
    s_mov_b64 exec, vcc
    buffer_store_dword v44, v179, s[8:11], s66 offen offset:32
    v_cmp_lt_i32 vcc, 10, v180
    s_nop 0
    s_cbranch_vccz K2_SV_DONE
    s_mov_b64 exec, vcc
    buffer_store_dword v45, v179, s[8:11], s66 offen offset:40
    v_cmp_lt_i32 vcc, 12, v180
    s_nop 0
    s_cbranch_vccz K2_SV_DONE
    s_mov_b64 exec, vcc
    buffer_store_dword v46, v179, s[8:11], s66 offen offset:48
    v_cmp_lt_i32 vcc, 14, v180
    s_nop 0
    s_cbranch_vccz K2_SV_DONE
    s_mov_b64 exec, vcc
    buffer_store_dword v47, v179, s[8:11], s66 offen offset:56
    v_cmp_lt_i32 vcc, 16, v180
    s_nop 0
    s_cbranch_vccz K2_SV_DONE
    s_mov_b64 exec, vcc
    buffer_store_dword v48, v179, s[8:11], s66 offen offset:64
    v_cmp_lt_i32 vcc, 18, v180
    s_nop 0
    s_cbranch_vccz K2_SV_DONE
    s_mov_b64 exec, vcc
    buffer_store_dword v49, v179, s[8:11], s66 offen offset:72
K2_SV_DONE:
    s_mov_b64 exec, -1
    s_branch K2_TOK
K2_rare_1:
    s_cmp_eq_u32 s33, 4
    s_cbranch_scc1 K2_four_3
    s_mov_b32 s49, s48
    s_mov_b32 s51, s48
    s_add_u32 s45, s44, 256
    s_add_u32 s46, s44, 512
    s_add_u32 s47, s44, 768
    s_branch K2_back_2
K2_four_3:
    s_add_u32 s50, s48, 64
    s_lshr_b32 s51, s3, 27
    s_mov_b32 s66, 161536
    s_cmp_ge_u32 s51, 2
    s_cselect_b32 s66, 159072, s66
    s_mul_i32 s51, s51, 32
    s_add_u32 s51, s51, s66
    s_mov_b32 s46, s44
    s_mov_b32 s47, s44
    s_branch K2_back_2
K2_a4_5:
    s_lshr_b32 s65, s3, 27
    s_mov_b32 s66, 161536
    s_cmp_ge_u32 s65, 2
    s_cselect_b32 s66, 158112, s66
    s_mul_i32 s65, s65, 512
    s_add_u32 s65, s65, s66
    v_add_u32 v232, s65, v230
    ds_read_b32 v232, v232
    s_add_u32 m0, s65, 864
    s_waitcnt lgkmcnt(0)
    v_or_b32 v232, v232, v231
    buffer_load_dwordx4 v232, s[16:19], 0 offen  lds
    s_branch K2_b4_7
K2_rare_14:
    s_cmp_eq_u32 s33, 4
    s_cbranch_scc1 K2_four_16
    s_mov_b32 s49, s48
    s_mov_b32 s51, s48
    s_add_u32 s45, s44, 256
    s_add_u32 s46, s44, 512
    s_add_u32 s47, s44, 768
    s_branch K2_back_15
K2_four_16:
    s_add_u32 s50, s48, 64
    s_lshr_b32 s51, s3, 27
    s_mov_b32 s66, 161536
    s_cmp_ge_u32 s51, 2
    s_cselect_b32 s66, 159072, s66
    s_mul_i32 s51, s51, 32
    s_add_u32 s51, s51, s66
    s_mov_b32 s46, s44
    s_mov_b32 s47, s44
    s_branch K2_back_15
K2_a4_18:
    s_lshr_b32 s65, s3, 27
    s_mov_b32 s66, 161536
    s_cmp_ge_u32 s65, 2
    s_cselect_b32 s66, 158112, s66
    s_mul_i32 s65, s65, 512
    s_add_u32 s65, s65, s66
    v_add_u32 v232, s65, v230
    ds_read_b32 v232, v232
    s_add_u32 m0, s65, 864
    s_waitcnt lgkmcnt(0)
    v_or_b32 v232, v232, v231
    buffer_load_dwordx4 v232, s[16:19], 0 offen  lds
    s_branch K2_b4_20
K2_rare_27:
    s_cmp_eq_u32 s33, 4
    s_cbranch_scc1 K2_four_29
    s_mov_b32 s49, s48
    s_mov_b32 s51, s48
    s_add_u32 s45, s44, 256
    s_add_u32 s46, s44, 512
    s_add_u32 s47, s44, 768
    s_branch K2_back_28
K2_four_29:
    s_add_u32 s50, s48, 64
    s_lshr_b32 s51, s3, 27
    s_mov_b32 s66, 161536
    s_cmp_ge_u32 s51, 2
    s_cselect_b32 s66, 159072, s66
    s_mul_i32 s51, s51, 32
    s_add_u32 s51, s51, s66
    s_mov_b32 s46, s44
    s_mov_b32 s47, s44
    s_branch K2_back_28
K2_a4_31:
    s_lshr_b32 s65, s3, 27
    s_mov_b32 s66, 161536
    s_cmp_ge_u32 s65, 2
    s_cselect_b32 s66, 158112, s66
    s_mul_i32 s65, s65, 512
    s_add_u32 s65, s65, s66
    v_add_u32 v232, s65, v230
    ds_read_b32 v232, v232
    s_add_u32 m0, s65, 864
    s_waitcnt lgkmcnt(0)
    v_or_b32 v232, v232, v231
    buffer_load_dwordx4 v232, s[16:19], 0 offen  lds
    s_branch K2_b4_33
K2_rare_38:
    s_cmp_eq_u32 s33, 4
    s_cbranch_scc1 K2_four_40
    s_mov_b32 s49, s48
    s_mov_b32 s51, s48
    s_add_u32 s45, s44, 256
    s_add_u32 s46, s44, 512
    s_add_u32 s47, s44, 768
    s_branch K2_back_39
K2_four_40:
    s_add_u32 s50, s48, 64
    s_lshr_b32 s51, s3, 27
    s_mov_b32 s66, 161536
    s_cmp_ge_u32 s51, 2
    s_cselect_b32 s66, 159072, s66
    s_mul_i32 s51, s51, 32
    s_add_u32 s51, s51, s66
    s_mov_b32 s46, s44
    s_mov_b32 s47, s44
    s_branch K2_back_39
K2_rare_45:
    s_cmp_eq_u32 s33, 4
    s_cbranch_scc1 K2_four_47
    s_mov_b32 s49, s48
    s_mov_b32 s51, s48
    s_add_u32 s45, s44, 256
    s_add_u32 s46, s44, 512
    s_add_u32 s47, s44, 768
    s_branch K2_back_46
K2_four_47:
    s_add_u32 s50, s48, 64
    s_lshr_b32 s51, s3, 27
    s_mov_b32 s66, 161536
    s_cmp_ge_u32 s51, 2
    s_cselect_b32 s66, 159072, s66
    s_mul_i32 s51, s51, 32
    s_add_u32 s51, s51, s66
    s_mov_b32 s46, s44
    s_mov_b32 s47, s44
    s_branch K2_back_46
K2_U10:
    s_setprio 1
    s_add_u32 s38, s38, 1
    v_mov_b32 v254, s52
    v_mov_b32 v255, s38
    s_lshl_b32 s58, s38, 3
    s_add_u32 s58, s58, s20
    s_mov_b64 exec, 1
    ds_write_b32 v254, v255
    s_mov_b64 exec, -1
    s_cmp_lt_u32 s58, s22
    s_cbranch_scc0 K2_dyn_48
K2_back_49:
    s_waitcnt lgkmcnt(7)
    v_lshlrev_b32 v40, 16, v0
    v_and_b32 v41, 0xffff0000, v0
    v_lshlrev_b32 v42, 16, v1
    v_and_b32 v43, 0xffff0000, v1
    v_lshlrev_b32 v44, 16, v2
    v_and_b32 v45, 0xffff0000, v2
    v_lshlrev_b32 v46, 16, v3
    v_and_b32 v47, 0xffff0000, v3
    v_mul_f32 v4, v40, v4
    v_mul_f32 v5, v41, v5
    v_mul_f32 v6, v42, v6
    v_mul_f32 v7, v43, v7
    v_mul_f32 v8, v44, v8
    v_mul_f32 v9, v45, v9
    v_mul_f32 v10, v46, v10
    v_mul_f32 v11, v47, v11
    v_cvt_pk_bf16_f32 v64, v4, v5
    v_cvt_pk_bf16_f32 v65, v6, v7
    v_cvt_pk_bf16_f32 v66, v8, v9
    v_cvt_pk_bf16_f32 v67, v10, v11
    v_mul_f32 v12, v40, v12
    v_mul_f32 v13, v41, v13
    v_mul_f32 v14, v42, v14
    v_mul_f32 v15, v43, v15
    v_mul_f32 v16, v44, v16
    v_mul_f32 v17, v45, v17
    v_mul_f32 v18, v46, v18
    v_mul_f32 v19, v47, v19
    v_cvt_pk_bf16_f32 v68, v12, v13
    v_cvt_pk_bf16_f32 v69, v14, v15
    v_cvt_pk_bf16_f32 v70, v16, v17
    v_cvt_pk_bf16_f32 v71, v18, v19
    v_readlane_b32 s3, v253, s58
    s_lshl_b32 s44, s34, 7
    s_lshl_b32 s60, s58, 5
    s_and_b32 s48, s3, 0x3ffff
    s_bfe_u32 s33, s3, 0x30012
    s_sub_u32 s60, s60, s48
    s_and_b32 s60, s60, 0xff
    s_add_u32 s60, s60, s48
    s_mul_i32 s35, s38, 6
    s_cmp_eq_u32 s34, 0
    s_cselect_b32 s35, s35, s60
    s_mov_b32 s45, s44
    s_add_u32 s47, s44, 256
    s_add_u32 s49, s48, 32
    s_add_u32 s60, s48, 64
    s_cmp_eq_u32 s33, 3
    s_cselect_b32 s46, s44, s47
    s_cselect_b32 s50, s60, s48
    s_cselect_b32 s51, s48, s49
    s_sub_u32 s60, s33, 2
    s_cmp_lt_u32 s60, 2
    s_cbranch_scc0 K2_rare_54
K2_back_55:
    v_add_u32 v233, s48, v230
    ds_read_b32 v232, v233
    ds_read_b32 v233, v233 offset:1024
    v_add_u32 v222, s48, v251
    ds_read_b32 v222, v222
    v_add_u32 v224, s49, v251
    ds_read_b32 v224, v224
    v_add_u32 v226, s50, v251
    ds_read_b32 v226, v226
    v_add_u32 v228, s51, v251
    ds_read_b32 v228, v228
    s_waitcnt lgkmcnt(4)
    v_or_b32 v232, v232, v231
    v_or_b32 v233, v233, v231
    s_cmp_lg_u32 s34, 0
    s_cbranch_scc1 K2_dum_57
    s_add_u32 m0, s48, 864
    s_add_u32 s65, s48, 1888
    buffer_load_dwordx4 v232, s[16:19], 0 offen  lds
    s_mov_b32 m0, s65
    s_mov_b32 exec_hi, 0
    buffer_load_dwordx4 v233, s[16:19], 0 offen  lds
    s_cmp_eq_u32 s33, 4
    s_cbranch_scc1 K2_a4_58
K2_b4_60:
    s_mov_b32 exec_hi, -1
K2_back_59:
    s_waitcnt lgkmcnt(3)
    v_mad_u32_u16 v223, v222, s39, v248 op_sel:[1,0,0,0]
    v_mad_u32_u16 v222, v222, s39, v248
    s_waitcnt lgkmcnt(2)
    v_mad_u32_u16 v225, v224, s39, v248 op_sel:[1,0,0,0]
    v_mad_u32_u16 v224, v224, s39, v248
    s_waitcnt lgkmcnt(1)
    v_mad_u32_u16 v227, v226, s39, v248 op_sel:[1,0,0,0]
    v_mad_u32_u16 v226, v226, s39, v248
    s_waitcnt lgkmcnt(0)
    v_mad_u32_u16 v229, v228, s39, v248 op_sel:[1,0,0,0]
    v_mad_u32_u16 v228, v228, s39, v248
    s_waitcnt vmcnt(6)
    v_mfma_f32_32x32x16_bf16 v[0:15], v[64:67], v[176:179], 0
    ds_read_b64_tr_b16 v[184:185], v246 offset:2048
    ds_read_b64_tr_b16 v[186:187], v246 offset:2560
    ds_read_b64_tr_b16 v[188:189], v247 offset:2048
    ds_read_b64_tr_b16 v[190:191], v247 offset:2560
    s_mov_b32 m0, s68
    v_mfma_f32_32x32x16_bf16 v[16:31], v[68:71], v[176:179], 0
    buffer_load_dwordx4 v222, s[4:7], s44 offen sc1 lds
    buffer_load_dwordx4 v223, s[72:75], s44 offen offset:1024 sc1 lds
    v_permlane32_swap_b32 v242, v236
    v_permlane32_swap_b32 v243, v237
    v_mfma_f32_32x32x16_bf16 v[32:47], v[64:67], v[180:183], 0
    v_permlane32_swap_b32 v244, v238
    v_permlane32_swap_b32 v245, v239
    v_permlane32_swap_b32 v240, v241
    v_add_f32 v242, v242, v236
    v_mfma_f32_32x32x16_bf16 v[48:63], v[68:71], v[180:183], 0
    s_setprio 0
    v_add_f32 v243, v243, v237
    v_add_f32 v244, v244, v238
    v_add_f32 v245, v245, v239
    v_add_f32 v240, -v240, -v241
    s_set_gpr_idx_on s32, gpr_idx(DST)
    s_nop 0
    v_cvt_pk_bf16_f32 v195, v242, v243
    v_cvt_pk_bf16_f32 v196, v244, v245
    v_cvt_pk_bf16_f32 v197, v240, v240
    s_set_gpr_idx_off
    v_mul_f32 v234, v0, v96
    v_mul_f32 v236, v8, v128
    v_fmac_f32 v234, v1, v97
    v_fmac_f32 v236, v9, v129
    v_fmac_f32 v234, v2, v98
    v_fmac_f32 v236, v10, v130
    v_fmac_f32 v234, v3, v99
    v_fmac_f32 v236, v11, v131
    v_fmac_f32 v234, v4, v100
    v_fmac_f32 v236, v12, v132
    v_fmac_f32 v234, v5, v101
    v_fmac_f32 v236, v13, v133
    v_fmac_f32 v234, v6, v102
    v_fmac_f32 v236, v14, v134
    v_fmac_f32 v234, v7, v103
    v_fmac_f32 v236, v15, v135
    v_mul_f32 v238, v16, v128
    v_mul_f32 v240, v24, v128
    v_fmac_f32 v238, v17, v129
    v_fmac_f32 v240, v25, v129
    v_fmac_f32 v238, v18, v130
    v_fmac_f32 v240, v26, v130
    v_fmac_f32 v238, v19, v131
    v_fmac_f32 v240, v27, v131
    v_fmac_f32 v238, v20, v132
    v_fmac_f32 v240, v28, v132
    v_fmac_f32 v238, v21, v133
    v_fmac_f32 v240, v29, v133
    v_fmac_f32 v238, v22, v134
    v_fmac_f32 v240, v30, v134
    v_fmac_f32 v238, v23, v135
    v_fmac_f32 v240, v31, v135
    v_mul_f32 v235, v32, v104
    v_mul_f32 v237, v40, v136
    v_fmac_f32 v235, v33, v105
    v_fmac_f32 v237, v41, v137
    v_fmac_f32 v235, v34, v106
    v_fmac_f32 v237, v42, v138
    v_fmac_f32 v235, v35, v107
    v_fmac_f32 v237, v43, v139
    v_fmac_f32 v235, v36, v108
    v_fmac_f32 v237, v44, v140
    v_fmac_f32 v235, v37, v109
    v_fmac_f32 v237, v45, v141
    v_fmac_f32 v235, v38, v110
    v_fmac_f32 v237, v46, v142
    v_fmac_f32 v235, v39, v111
    v_fmac_f32 v237, v47, v143
    v_mul_f32 v239, v48, v136
    v_mul_f32 v241, v56, v136
    v_fmac_f32 v239, v49, v137
    v_fmac_f32 v241, v57, v137
    v_fmac_f32 v239, v50, v138
    v_fmac_f32 v241, v58, v138
    v_fmac_f32 v239, v51, v139
    v_fmac_f32 v241, v59, v139
    v_fmac_f32 v239, v52, v140
    v_fmac_f32 v241, v60, v140
    v_fmac_f32 v239, v53, v141
    v_fmac_f32 v241, v61, v141
    v_fmac_f32 v239, v54, v142
    v_fmac_f32 v241, v62, v142
    v_fmac_f32 v239, v55, v143
    v_fmac_f32 v241, v63, v143
    s_setprio 1
    s_waitcnt vmcnt(6) lgkmcnt(0)
    v_mfma_f32_32x32x16_bf16 v[0:15], v[64:67], v[184:187], 0
    ds_read_b64_tr_b16 v[176:177], v246 offset:4096
    ds_read_b64_tr_b16 v[178:179], v246 offset:4608
    ds_read_b64_tr_b16 v[180:181], v247 offset:4096
    ds_read_b64_tr_b16 v[182:183], v247 offset:4608
    s_mov_b32 m0, s69
    v_mfma_f32_32x32x16_bf16 v[16:31], v[68:71], v[184:187], 0
    buffer_load_dwordx4 v224, s[4:7], s45 offen sc1 lds
    buffer_load_dwordx4 v225, s[72:75], s45 offen offset:1024 sc1 lds
    v_permlane32_swap_b32 v234, v236
    v_permlane32_swap_b32 v235, v237
    v_mfma_f32_32x32x16_bf16 v[32:47], v[64:67], v[188:191], 0
    v_permlane32_swap_b32 v240, v238
    v_permlane32_swap_b32 v241, v239
    v_add_f32 v234, v234, v236
    v_add_f32 v235, v235, v237
    v_add_f32 v240, v240, v238
    v_mfma_f32_32x32x16_bf16 v[48:63], v[68:71], v[188:191], 0
    s_setprio 0
    v_add_f32 v241, v241, v239
    s_set_gpr_idx_on s31, gpr_idx(DST)
    s_nop 0
    v_cvt_pk_bf16_f32 v192, v234, v235
    v_cvt_pk_bf16_f32 v193, v240, v241
    s_set_gpr_idx_off
    v_mul_f32 v234, v0, v144
    v_mul_f32 v236, v8, v112
    v_fmac_f32 v234, v1, v145
    v_fmac_f32 v236, v9, v113
    v_fmac_f32 v234, v2, v146
    v_fmac_f32 v236, v10, v114
    v_fmac_f32 v234, v3, v147
    v_fmac_f32 v236, v11, v115
    v_fmac_f32 v234, v4, v148
    v_fmac_f32 v236, v12, v116
    v_fmac_f32 v234, v5, v149
    v_fmac_f32 v236, v13, v117
    v_fmac_f32 v234, v6, v150
    v_fmac_f32 v236, v14, v118
    v_fmac_f32 v234, v7, v151
    v_fmac_f32 v236, v15, v119
    v_mul_f32 v238, v16, v160
    v_mul_f32 v240, v24, v160
    v_fmac_f32 v238, v17, v161
    v_fmac_f32 v240, v25, v161
    v_fmac_f32 v238, v18, v162
    v_fmac_f32 v240, v26, v162
    v_fmac_f32 v238, v19, v163
    v_fmac_f32 v240, v27, v163
    v_fmac_f32 v238, v20, v164
    v_fmac_f32 v240, v28, v164
    v_fmac_f32 v238, v21, v165
    v_fmac_f32 v240, v29, v165
    v_fmac_f32 v238, v22, v166
    v_fmac_f32 v240, v30, v166
    v_fmac_f32 v238, v23, v167
    v_fmac_f32 v240, v31, v167
    v_mul_f32 v235, v32, v152
    v_mul_f32 v237, v40, v120
    v_fmac_f32 v235, v33, v153
    v_fmac_f32 v237, v41, v121
    v_fmac_f32 v235, v34, v154
    v_fmac_f32 v237, v42, v122
    v_fmac_f32 v235, v35, v155
    v_fmac_f32 v237, v43, v123
    v_fmac_f32 v235, v36, v156
    v_fmac_f32 v237, v44, v124
    v_fmac_f32 v235, v37, v157
    v_fmac_f32 v237, v45, v125
    v_fmac_f32 v235, v38, v158
    v_fmac_f32 v237, v46, v126
    v_fmac_f32 v235, v39, v159
    v_fmac_f32 v237, v47, v127
    v_mul_f32 v239, v48, v168
    v_mul_f32 v241, v56, v168
    v_fmac_f32 v239, v49, v169
    v_fmac_f32 v241, v57, v169
    v_fmac_f32 v239, v50, v170
    v_fmac_f32 v241, v58, v170
    v_fmac_f32 v239, v51, v171
    v_fmac_f32 v241, v59, v171
    v_fmac_f32 v239, v52, v172
    v_fmac_f32 v241, v60, v172
    v_fmac_f32 v239, v53, v173
    v_fmac_f32 v241, v61, v173
    v_fmac_f32 v239, v54, v174
    v_fmac_f32 v241, v62, v174
    v_fmac_f32 v239, v55, v175
    v_fmac_f32 v241, v63, v175
    s_setprio 1
    s_waitcnt vmcnt(6) lgkmcnt(0)
    v_mfma_f32_32x32x16_bf16 v[0:15], v[64:67], v[176:179], 0
    ds_read_b64_tr_b16 v[184:185], v246 offset:6144
    ds_read_b64_tr_b16 v[186:187], v246 offset:6656
    ds_read_b64_tr_b16 v[188:189], v247 offset:6144
    ds_read_b64_tr_b16 v[190:191], v247 offset:6656
    s_mov_b32 m0, s70
    v_mfma_f32_32x32x16_bf16 v[16:31], v[68:71], v[176:179], 0
    buffer_load_dwordx4 v226, s[4:7], s46 offen sc1 lds
    buffer_load_dwordx4 v227, s[72:75], s46 offen offset:1024 sc1 lds
    s_sub_u32 s26, s48, s29
    s_mov_b32 s29, s48
    s_mov_b32 s30, s3
    s_cmp_eq_u32 s34, 0
    s_cselect_b32 s56, s33, 0
    v_mfma_f32_32x32x16_bf16 v[32:47], v[64:67], v[180:183], 0
    v_mfma_f32_32x32x16_bf16 v[48:63], v[68:71], v[180:183], 0
    s_setprio 0
    v_mul_f32 v242, v0, v144
    v_fma_f32 v238, v8, v160, -v238
    v_fmac_f32 v242, v1, v145
    v_fmac_f32 v238, v9, v161
    v_fmac_f32 v242, v2, v146
    v_fmac_f32 v238, v10, v162
    v_fmac_f32 v242, v3, v147
    v_fmac_f32 v238, v11, v163
    v_fmac_f32 v242, v4, v148
    v_fmac_f32 v238, v12, v164
    v_fmac_f32 v242, v5, v149
    v_fmac_f32 v238, v13, v165
    v_fmac_f32 v242, v6, v150
    v_fmac_f32 v238, v14, v166
    v_fmac_f32 v242, v7, v151
    v_fmac_f32 v238, v15, v167
    v_fmac_f32 v236, v16, v112
    v_mul_f32 v244, v24, v160
    v_fmac_f32 v236, v17, v113
    v_fmac_f32 v244, v25, v161
    v_fmac_f32 v236, v18, v114
    v_fmac_f32 v244, v26, v162
    v_fmac_f32 v236, v19, v115
    v_fmac_f32 v244, v27, v163
    v_fmac_f32 v236, v20, v116
    v_fmac_f32 v244, v28, v164
    v_fmac_f32 v236, v21, v117
    v_fmac_f32 v244, v29, v165
    v_fmac_f32 v236, v22, v118
    v_fmac_f32 v244, v30, v166
    v_fmac_f32 v236, v23, v119
    v_fmac_f32 v244, v31, v167
    v_mul_f32 v243, v32, v152
    v_fma_f32 v239, v40, v168, -v239
    v_fmac_f32 v243, v33, v153
    v_fmac_f32 v239, v41, v169
    v_fmac_f32 v243, v34, v154
    v_fmac_f32 v239, v42, v170
    v_fmac_f32 v243, v35, v155
    v_fmac_f32 v239, v43, v171
    v_fmac_f32 v243, v36, v156
    v_fmac_f32 v239, v44, v172
    v_fmac_f32 v243, v37, v157
    v_fmac_f32 v239, v45, v173
    v_fmac_f32 v243, v38, v158
    v_fmac_f32 v239, v46, v174
    v_fmac_f32 v243, v39, v159
    v_fmac_f32 v239, v47, v175
    v_fmac_f32 v237, v48, v120
    v_mul_f32 v245, v56, v168
    v_fmac_f32 v237, v49, v121
    v_fmac_f32 v245, v57, v169
    v_fmac_f32 v237, v50, v122
    v_fmac_f32 v245, v58, v170
    v_fmac_f32 v237, v51, v123
    v_fmac_f32 v245, v59, v171
    v_fmac_f32 v237, v52, v124
    v_fmac_f32 v245, v60, v172
    v_fmac_f32 v237, v53, v125
    v_fmac_f32 v245, v61, v173
    v_fmac_f32 v237, v54, v126
    v_fmac_f32 v245, v62, v174
    v_fmac_f32 v237, v55, v127
    v_fmac_f32 v245, v63, v175
    s_setprio 1
    s_waitcnt vmcnt(4) lgkmcnt(0)
    v_mfma_f32_32x32x16_bf16 v[0:15], v[64:67], v[184:187], 0
    ds_read_b64_tr_b16 v[176:177], v246 offset:0
    ds_read_b64_tr_b16 v[178:179], v246 offset:512
    ds_read_b64_tr_b16 v[180:181], v247 offset:0
    ds_read_b64_tr_b16 v[182:183], v247 offset:512
    s_mov_b32 m0, s71
    v_mfma_f32_32x32x16_bf16 v[16:31], v[68:71], v[184:187], 0
    buffer_load_dwordx4 v228, s[4:7], s47 offen sc1 lds
    buffer_load_dwordx4 v229, s[72:75], s47 offen offset:1024 sc1 lds
    v_permlane32_swap_b32 v242, v234
    v_permlane32_swap_b32 v243, v235
    v_add_f32 v242, v242, v234
    v_mfma_f32_32x32x16_bf16 v[32:47], v[64:67], v[188:191], 0
    v_add_f32 v243, v243, v235
    s_set_gpr_idx_on s31, gpr_idx(DST)
    s_nop 0
    v_cvt_pk_bf16_f32 v194, v242, v243
    s_set_gpr_idx_off
    s_mov_b32 s32, s31
    s_mov_b32 s31, s35
    v_mfma_f32_32x32x16_bf16 v[48:63], v[68:71], v[188:191], 0
    s_setprio 0
    v_mul_f32 v242, v0, v144
    v_fma_f32 v240, v8, v160, -v240
    v_fmac_f32 v242, v1, v145
    v_fmac_f32 v240, v9, v161
    v_fmac_f32 v242, v2, v146
    v_fmac_f32 v240, v10, v162
    v_fmac_f32 v242, v3, v147
    v_fmac_f32 v240, v11, v163
    v_fmac_f32 v242, v4, v148
    v_fmac_f32 v240, v12, v164
    v_fmac_f32 v242, v5, v149
    v_fmac_f32 v240, v13, v165
    v_fmac_f32 v242, v6, v150
    v_fmac_f32 v240, v14, v166
    v_fmac_f32 v242, v7, v151
    v_fmac_f32 v240, v15, v167
    v_add_u32 v249, s26, v249
    v_add_u32 v250, s26, v250
    v_fma_f32 v244, v16, v160, -v244
    v_fmac_f32 v236, v24, v112
    v_fmac_f32 v244, v17, v161
    v_fmac_f32 v236, v25, v113
    v_fmac_f32 v244, v18, v162
    v_fmac_f32 v236, v26, v114
    v_fmac_f32 v244, v19, v163
    v_fmac_f32 v236, v27, v115
    v_fmac_f32 v244, v20, v164
    v_fmac_f32 v236, v28, v116
    v_fmac_f32 v244, v21, v165
    v_fmac_f32 v236, v29, v117
    v_fmac_f32 v244, v22, v166
    v_fmac_f32 v236, v30, v118
    v_fmac_f32 v244, v23, v167
    v_fmac_f32 v236, v31, v119
    ds_read_b64_tr_b16 v[0:1], v249 offset:0
    ds_read_b64_tr_b16 v[2:3], v249 offset:128
    ds_read_b128 v[4:7], v250 offset:0
    ds_read_b128 v[8:11], v250 offset:16
    ds_read_b128 v[12:15], v250 offset:384
    ds_read_b128 v[16:19], v250 offset:400
    v_mul_f32 v243, v32, v152
    v_fma_f32 v241, v40, v168, -v241
    v_fmac_f32 v243, v33, v153
    v_fmac_f32 v241, v41, v169
    v_fmac_f32 v243, v34, v154
    v_fmac_f32 v241, v42, v170
    v_fmac_f32 v243, v35, v155
    v_fmac_f32 v241, v43, v171
    v_fmac_f32 v243, v36, v156
    v_fmac_f32 v241, v44, v172
    v_fmac_f32 v243, v37, v157
    v_fmac_f32 v241, v45, v173
    v_fmac_f32 v243, v38, v158
    v_fmac_f32 v241, v46, v174
    v_fmac_f32 v243, v39, v159
    v_fmac_f32 v241, v47, v175
    ds_read_b64_tr_b16 v[20:21], v249 offset:512
    ds_read_b64_tr_b16 v[22:23], v249 offset:640
    ds_read_b128 v[24:27], v250 offset:64
    ds_read_b128 v[28:31], v250 offset:80
    ds_read_b128 v[32:35], v250 offset:448
    ds_read_b128 v[36:39], v250 offset:464
    v_fma_f32 v245, v48, v168, -v245
    v_fmac_f32 v237, v56, v120
    v_fmac_f32 v245, v49, v169
    v_fmac_f32 v237, v57, v121
    v_fmac_f32 v245, v50, v170
    v_fmac_f32 v237, v58, v122
    v_fmac_f32 v245, v51, v171
    v_fmac_f32 v237, v59, v123
    v_fmac_f32 v245, v52, v172
    v_fmac_f32 v237, v60, v124
    v_fmac_f32 v245, v53, v173
    v_fmac_f32 v237, v61, v125
    v_fmac_f32 v245, v54, v174
    v_fmac_f32 v237, v62, v126
    v_fmac_f32 v245, v55, v175
    v_fmac_f32 v237, v63, v127
    s_cmp_eq_u32 s56, 2
    s_cbranch_scc1 K2_U20
    s_cmp_eq_u32 s56, 3
    s_cbranch_scc1 K2_U30
    s_branch K2_DSP0
K2_U40:
    s_setprio 1
    s_waitcnt lgkmcnt(6)
    v_lshlrev_b32 v40, 16, v0
    v_and_b32 v41, 0xffff0000, v0
    v_lshlrev_b32 v42, 16, v1
    v_and_b32 v43, 0xffff0000, v1
    v_lshlrev_b32 v44, 16, v2
    v_and_b32 v45, 0xffff0000, v2
    v_lshlrev_b32 v46, 16, v3
    v_and_b32 v47, 0xffff0000, v3
    v_mul_f32 v4, v40, v4
    v_mul_f32 v5, v41, v5
    v_mul_f32 v6, v42, v6
    v_mul_f32 v7, v43, v7
    v_mul_f32 v8, v44, v8
    v_mul_f32 v9, v45, v9
    v_mul_f32 v10, v46, v10
    v_mul_f32 v11, v47, v11
    v_cvt_pk_bf16_f32 v64, v4, v5
    v_cvt_pk_bf16_f32 v65, v6, v7
    v_cvt_pk_bf16_f32 v66, v8, v9
    v_cvt_pk_bf16_f32 v67, v10, v11
    v_mul_f32 v12, v40, v12
    v_mul_f32 v13, v41, v13
    v_mul_f32 v14, v42, v14
    v_mul_f32 v15, v43, v15
    v_mul_f32 v16, v44, v16
    v_mul_f32 v17, v45, v17
    v_mul_f32 v18, v46, v18
    v_mul_f32 v19, v47, v19
    v_cvt_pk_bf16_f32 v68, v12, v13
    v_cvt_pk_bf16_f32 v69, v14, v15
    v_cvt_pk_bf16_f32 v70, v16, v17
    v_cvt_pk_bf16_f32 v71, v18, v19
    ds_read_b64_tr_b16 v[0:1], v249 offset:1024
    ds_read_b64_tr_b16 v[2:3], v249 offset:1152
    ds_read_b128 v[4:7], v250 offset:128
    ds_read_b128 v[8:11], v250 offset:144
    ds_read_b128 v[12:15], v250 offset:512
    ds_read_b128 v[16:19], v250 offset:528
    s_waitcnt lgkmcnt(6)
    v_lshlrev_b32 v48, 16, v20
    v_and_b32 v49, 0xffff0000, v20
    v_lshlrev_b32 v50, 16, v21
    v_and_b32 v51, 0xffff0000, v21
    v_lshlrev_b32 v52, 16, v22
    v_and_b32 v53, 0xffff0000, v22
    v_lshlrev_b32 v54, 16, v23
    v_and_b32 v55, 0xffff0000, v23
    v_mul_f32 v24, v48, v24
    v_mul_f32 v25, v49, v25
    v_mul_f32 v26, v50, v26
    v_mul_f32 v27, v51, v27
    v_mul_f32 v28, v52, v28
    v_mul_f32 v29, v53, v29
    v_mul_f32 v30, v54, v30
    v_mul_f32 v31, v55, v31
    v_cvt_pk_bf16_f32 v72, v24, v25
    v_cvt_pk_bf16_f32 v73, v26, v27
    v_cvt_pk_bf16_f32 v74, v28, v29
    v_cvt_pk_bf16_f32 v75, v30, v31
    v_mul_f32 v32, v48, v32
    v_mul_f32 v33, v49, v33
    v_mul_f32 v34, v50, v34
    v_mul_f32 v35, v51, v35
    v_mul_f32 v36, v52, v36
    v_mul_f32 v37, v53, v37
    v_mul_f32 v38, v54, v38
    v_mul_f32 v39, v55, v39
    v_cvt_pk_bf16_f32 v76, v32, v33
    v_cvt_pk_bf16_f32 v77, v34, v35
    v_cvt_pk_bf16_f32 v78, v36, v37
    v_cvt_pk_bf16_f32 v79, v38, v39
    s_lshr_b32 s65, s30, 27
    s_mov_b32 s66, 161536
    s_cmp_ge_u32 s65, 2
    s_cselect_b32 s66, 158112, s66
    s_mul_i32 s65, s65, 512
    s_add_u32 s65, s65, s66
    s_sub_u32 s65, s65, s29
    v_add_u32 v56, s65, v249
    s_lshr_b32 s65, s30, 27
    s_mov_b32 s66, 161536
    s_cmp_ge_u32 s65, 2
    s_cselect_b32 s66, 159008, s66
    s_mul_i32 s65, s65, 64
    s_add_u32 s65, s65, s66
    s_sub_u32 s65, s65, s29
    v_add_u32 v57, s65, v250
    ds_read_b64_tr_b16 v[20:21], v56 offset:0
    ds_read_b64_tr_b16 v[22:23], v56 offset:128
    ds_read_b128 v[24:27], v57 offset:0
    ds_read_b128 v[28:31], v57 offset:16
    ds_read_b128 v[32:35], v57 offset:384
    ds_read_b128 v[36:39], v57 offset:400
    s_waitcnt lgkmcnt(10)
    v_lshlrev_b32 v40, 16, v0
    v_and_b32 v41, 0xffff0000, v0
    v_lshlrev_b32 v42, 16, v1
    v_and_b32 v43, 0xffff0000, v1
    v_lshlrev_b32 v44, 16, v2
    v_and_b32 v45, 0xffff0000, v2
    v_lshlrev_b32 v46, 16, v3
    v_and_b32 v47, 0xffff0000, v3
    s_waitcnt lgkmcnt(8)
    v_mul_f32 v4, v40, v4
    v_mul_f32 v5, v41, v5
    v_mul_f32 v6, v42, v6
    v_mul_f32 v7, v43, v7
    v_mul_f32 v8, v44, v8
    v_mul_f32 v9, v45, v9
    v_mul_f32 v10, v46, v10
    v_mul_f32 v11, v47, v11
    v_cvt_pk_bf16_f32 v80, v4, v5
    v_cvt_pk_bf16_f32 v81, v6, v7
    v_cvt_pk_bf16_f32 v82, v8, v9
    v_cvt_pk_bf16_f32 v83, v10, v11
    s_waitcnt lgkmcnt(6)
    v_mul_f32 v12, v40, v12
    v_mul_f32 v13, v41, v13
    v_mul_f32 v14, v42, v14
    v_mul_f32 v15, v43, v15
    v_mul_f32 v16, v44, v16
    v_mul_f32 v17, v45, v17
    v_mul_f32 v18, v46, v18
    v_mul_f32 v19, v47, v19
    v_cvt_pk_bf16_f32 v84, v12, v13
    v_cvt_pk_bf16_f32 v85, v14, v15
    v_cvt_pk_bf16_f32 v86, v16, v17
    v_cvt_pk_bf16_f32 v87, v18, v19
    s_waitcnt lgkmcnt(4)
    v_lshlrev_b32 v48, 16, v20
    v_and_b32 v49, 0xffff0000, v20
    v_lshlrev_b32 v50, 16, v21
    v_and_b32 v51, 0xffff0000, v21
    v_lshlrev_b32 v52, 16, v22
    v_and_b32 v53, 0xffff0000, v22
    v_lshlrev_b32 v54, 16, v23
    v_and_b32 v55, 0xffff0000, v23
    s_waitcnt lgkmcnt(2)
    v_mul_f32 v24, v48, v24
    v_mul_f32 v25, v49, v25
    v_mul_f32 v26, v50, v26
    v_mul_f32 v27, v51, v27
    v_mul_f32 v28, v52, v28
    v_mul_f32 v29, v53, v29
    v_mul_f32 v30, v54, v30
    v_mul_f32 v31, v55, v31
    v_cvt_pk_bf16_f32 v88, v24, v25
    v_cvt_pk_bf16_f32 v89, v26, v27
    v_cvt_pk_bf16_f32 v90, v28, v29
    v_cvt_pk_bf16_f32 v91, v30, v31
    s_waitcnt lgkmcnt(0)
    v_mul_f32 v32, v48, v32
    v_mul_f32 v33, v49, v33
    v_mul_f32 v34, v50, v34
    v_mul_f32 v35, v51, v35
    v_mul_f32 v36, v52, v36
    v_mul_f32 v37, v53, v37
    v_mul_f32 v38, v54, v38
    v_mul_f32 v39, v55, v39
    v_cvt_pk_bf16_f32 v92, v32, v33
    v_cvt_pk_bf16_f32 v93, v34, v35
    v_cvt_pk_bf16_f32 v94, v36, v37
    v_cvt_pk_bf16_f32 v95, v38, v39
    s_waitcnt vmcnt(4)
    v_mfma_f32_32x32x16_bf16 v[0:15], v[64:67], v[176:179], 0
    ds_read_b64_tr_b16 v[184:185], v246 offset:2048
    ds_read_b64_tr_b16 v[186:187], v246 offset:2560
    ds_read_b64_tr_b16 v[188:189], v247 offset:2048
    ds_read_b64_tr_b16 v[190:191], v247 offset:2560
    s_mov_b32 m0, s68
    v_mfma_f32_32x32x16_bf16 v[16:31], v[68:71], v[176:179], 0
    buffer_load_dwordx4 v222, s[4:7], s41 offen sc1 lds
    buffer_load_dwordx4 v223, s[72:75], s41 offen offset:1024 sc1 lds
    v_permlane32_swap_b32 v242, v236
    v_permlane32_swap_b32 v243, v237
    s_add_u32 s38, s38, 1
    v_mfma_f32_32x32x16_bf16 v[32:47], v[64:67], v[180:183], 0
    v_permlane32_swap_b32 v244, v238
    v_permlane32_swap_b32 v245, v239
    v_permlane32_swap_b32 v240, v241
    v_add_f32 v242, v242, v236
    v_mfma_f32_32x32x16_bf16 v[48:63], v[68:71], v[180:183], 0
    v_add_f32 v243, v243, v237
    v_add_f32 v244, v244, v238
    v_add_f32 v245, v245, v239
    v_add_f32 v240, -v240, -v241
    v_mov_b32 v254, s52
    v_mov_b32 v255, s38
    s_waitcnt vmcnt(4) lgkmcnt(0)
    v_mfma_f32_32x32x16_bf16 v[0:15], v[72:75], v[184:187], v[0:15]
    ds_read_b64_tr_b16 v[176:177], v246 offset:4096
    ds_read_b64_tr_b16 v[178:179], v246 offset:4608
    ds_read_b64_tr_b16 v[180:181], v247 offset:4096
    ds_read_b64_tr_b16 v[182:183], v247 offset:4608
    s_lshl_b32 s58, s38, 3
    s_add_u32 s58, s58, s20
    s_mov_b32 m0, s69
    v_mfma_f32_32x32x16_bf16 v[16:31], v[76:79], v[184:187], v[16:31]
    buffer_load_dwordx4 v224, s[4:7], s41 offen sc1 lds
    buffer_load_dwordx4 v225, s[72:75], s41 offen offset:1024 sc1 lds
    s_set_gpr_idx_on s32, gpr_idx(DST)
    s_nop 0
    v_cvt_pk_bf16_f32 v195, v242, v243
    v_cvt_pk_bf16_f32 v196, v244, v245
    v_cvt_pk_bf16_f32 v197, v240, v240
    s_set_gpr_idx_off
    s_mov_b64 exec, 1
    ds_write_b32 v254, v255
    s_mov_b64 exec, -1
    s_cmp_lt_u32 s58, s22
    s_cbranch_scc0 K2_dyn_61
K2_back_62:
    v_readlane_b32 s3, v253, s58
    s_lshl_b32 s44, s34, 7
    s_lshl_b32 s60, s58, 5
    s_and_b32 s48, s3, 0x3ffff
    s_bfe_u32 s33, s3, 0x30012
    s_sub_u32 s60, s60, s48
    s_and_b32 s60, s60, 0xff
    s_add_u32 s60, s60, s48
    s_mul_i32 s35, s38, 6
    s_cmp_eq_u32 s34, 0
    s_cselect_b32 s35, s35, s60
    s_mov_b32 s45, s44
    s_add_u32 s47, s44, 256
    s_add_u32 s49, s48, 32
    s_add_u32 s60, s48, 64
    s_cmp_eq_u32 s33, 3
    s_cselect_b32 s46, s44, s47
    s_cselect_b32 s50, s60, s48
    s_cselect_b32 s51, s48, s49
    s_sub_u32 s60, s33, 2
    s_cmp_lt_u32 s60, 2
    s_cbranch_scc0 K2_rare_67
K2_back_68:
    v_mfma_f32_32x32x16_bf16 v[32:47], v[72:75], v[188:191], v[32:47]
    v_add_u32 v233, s48, v230
    ds_read_b32 v232, v233
    ds_read_b32 v233, v233 offset:1024
    v_mfma_f32_32x32x16_bf16 v[48:63], v[76:79], v[188:191], v[48:63]
    s_waitcnt vmcnt(4) lgkmcnt(3)
    v_mfma_f32_32x32x16_bf16 v[0:15], v[80:83], v[176:179], v[0:15]
    ds_read_b64_tr_b16 v[184:185], v246 offset:6144
    ds_read_b64_tr_b16 v[186:187], v246 offset:6656
    ds_read_b64_tr_b16 v[188:189], v247 offset:6144
    ds_read_b64_tr_b16 v[190:191], v247 offset:6656
    s_mov_b32 m0, s70
    v_mfma_f32_32x32x16_bf16 v[16:31], v[84:87], v[176:179], v[16:31]
    buffer_load_dwordx4 v226, s[4:7], s41 offen sc1 lds
    buffer_load_dwordx4 v227, s[72:75], s41 offen offset:1024 sc1 lds
    v_mfma_f32_32x32x16_bf16 v[32:47], v[80:83], v[180:183], v[32:47]
    v_mfma_f32_32x32x16_bf16 v[48:63], v[84:87], v[180:183], v[48:63]
    s_waitcnt lgkmcnt(4)
    v_or_b32 v232, v232, v231
    v_or_b32 v233, v233, v231
    s_cmp_lg_u32 s34, 0
    s_cbranch_scc1 K2_dum_70
    s_add_u32 m0, s48, 864
    s_add_u32 s65, s48, 1888
    buffer_load_dwordx4 v232, s[16:19], 0 offen  lds
    s_mov_b32 m0, s65
    s_mov_b32 exec_hi, 0
    buffer_load_dwordx4 v233, s[16:19], 0 offen  lds
    s_cmp_eq_u32 s33, 4
    s_cbranch_scc1 K2_a4_71
K2_b4_73:
    s_mov_b32 exec_hi, -1
K2_back_72:
    s_waitcnt vmcnt(6) lgkmcnt(0)
    v_mfma_f32_32x32x16_bf16 v[0:15], v[88:91], v[184:187], v[0:15]
    ds_read_b64_tr_b16 v[176:177], v246 offset:0
    ds_read_b64_tr_b16 v[178:179], v246 offset:512
    ds_read_b64_tr_b16 v[180:181], v247 offset:0
    ds_read_b64_tr_b16 v[182:183], v247 offset:512
    s_mov_b32 m0, s71
    v_mfma_f32_32x32x16_bf16 v[16:31], v[92:95], v[184:187], v[16:31]
    buffer_load_dwordx4 v228, s[4:7], s41 offen sc1 lds
    buffer_load_dwordx4 v229, s[72:75], s41 offen offset:1024 sc1 lds
    v_mfma_f32_32x32x16_bf16 v[32:47], v[88:91], v[188:191], v[32:47]
    s_nop 2
    v_mul_f32 v234, v0, v96
    v_mul_f32 v236, v8, v128
    v_fmac_f32 v234, v1, v97
    v_fmac_f32 v236, v9, v129
    v_fmac_f32 v234, v2, v98
    v_fmac_f32 v236, v10, v130
    v_fmac_f32 v234, v3, v99
    v_mfma_f32_32x32x16_bf16 v[48:63], v[92:95], v[188:191], v[48:63]
    s_setprio 0
    v_fmac_f32 v236, v11, v131
    v_fmac_f32 v234, v4, v100
    v_fmac_f32 v236, v12, v132
    v_fmac_f32 v234, v5, v101
    v_fmac_f32 v236, v13, v133
    v_fmac_f32 v234, v6, v102
    v_fmac_f32 v236, v14, v134
    v_fmac_f32 v234, v7, v103
    v_fmac_f32 v236, v15, v135
    v_mul_f32 v238, v16, v128
    v_mul_f32 v240, v24, v128
    v_fmac_f32 v238, v17, v129
    v_fmac_f32 v240, v25, v129
    v_fmac_f32 v238, v18, v130
    v_fmac_f32 v240, v26, v130
    v_fmac_f32 v238, v19, v131
    v_fmac_f32 v240, v27, v131
    v_fmac_f32 v238, v20, v132
    v_fmac_f32 v240, v28, v132
    v_fmac_f32 v238, v21, v133
    v_fmac_f32 v240, v29, v133
    v_fmac_f32 v238, v22, v134
    v_fmac_f32 v240, v30, v134
    v_fmac_f32 v238, v23, v135
    v_fmac_f32 v240, v31, v135
    v_mul_f32 v235, v32, v104
    v_mul_f32 v237, v40, v136
    v_fmac_f32 v235, v33, v105
    v_fmac_f32 v237, v41, v137
    v_fmac_f32 v235, v34, v106
    v_fmac_f32 v237, v42, v138
    v_fmac_f32 v235, v35, v107
    v_fmac_f32 v237, v43, v139
    v_fmac_f32 v235, v36, v108
    v_fmac_f32 v237, v44, v140
    v_fmac_f32 v235, v37, v109
    v_fmac_f32 v237, v45, v141
    v_fmac_f32 v235, v38, v110
    v_fmac_f32 v237, v46, v142
    v_fmac_f32 v235, v39, v111
    v_fmac_f32 v237, v47, v143
    v_mul_f32 v239, v48, v136
    v_mul_f32 v241, v56, v136
    s_setprio 1
    s_waitcnt vmcnt(6) lgkmcnt(0)
    v_mfma_f32_32x32x16_bf16 v[0:15], v[64:67], v[176:179], 0
    ds_read_b64_tr_b16 v[184:185], v246 offset:2048
    ds_read_b64_tr_b16 v[186:187], v246 offset:2560
    ds_read_b64_tr_b16 v[188:189], v247 offset:2048
    ds_read_b64_tr_b16 v[190:191], v247 offset:2560
    v_fmac_f32 v239, v49, v137
    v_fmac_f32 v241, v57, v137
    s_mov_b32 m0, s68
    v_mfma_f32_32x32x16_bf16 v[16:31], v[68:71], v[176:179], 0
    buffer_load_dwordx4 v222, s[4:7], s42 offen sc1 lds
    buffer_load_dwordx4 v223, s[72:75], s42 offen offset:1024 sc1 lds
    v_fmac_f32 v239, v50, v138
    v_fmac_f32 v241, v58, v138
    v_fmac_f32 v239, v51, v139
    v_fmac_f32 v241, v59, v139
    v_fmac_f32 v239, v52, v140
    v_mfma_f32_32x32x16_bf16 v[32:47], v[64:67], v[180:183], 0
    v_fmac_f32 v241, v60, v140
    v_fmac_f32 v239, v53, v141
    v_fmac_f32 v241, v61, v141
    v_fmac_f32 v239, v54, v142
    v_fmac_f32 v241, v62, v142
    v_fmac_f32 v239, v55, v143
    v_fmac_f32 v241, v63, v143
    v_mfma_f32_32x32x16_bf16 v[48:63], v[68:71], v[180:183], 0
    v_permlane32_swap_b32 v234, v236
    v_permlane32_swap_b32 v235, v237
    v_permlane32_swap_b32 v240, v238
    s_waitcnt vmcnt(6) lgkmcnt(0)
    v_mfma_f32_32x32x16_bf16 v[0:15], v[72:75], v[184:187], v[0:15]
    ds_read_b64_tr_b16 v[176:177], v246 offset:4096
    ds_read_b64_tr_b16 v[178:179], v246 offset:4608
    ds_read_b64_tr_b16 v[180:181], v247 offset:4096
    ds_read_b64_tr_b16 v[182:183], v247 offset:4608
    v_permlane32_swap_b32 v241, v239
    s_mov_b32 m0, s69
    v_mfma_f32_32x32x16_bf16 v[16:31], v[76:79], v[184:187], v[16:31]
    buffer_load_dwordx4 v224, s[4:7], s42 offen sc1 lds
    buffer_load_dwordx4 v225, s[72:75], s42 offen offset:1024 sc1 lds
    v_add_f32 v234, v234, v236
    v_add_f32 v235, v235, v237
    v_add_f32 v240, v240, v238
    v_add_f32 v241, v241, v239
    v_mfma_f32_32x32x16_bf16 v[32:47], v[72:75], v[188:191], v[32:47]
    s_set_gpr_idx_on s31, gpr_idx(DST)
    s_nop 0
    v_cvt_pk_bf16_f32 v192, v234, v235
    v_cvt_pk_bf16_f32 v193, v240, v241
    s_set_gpr_idx_off
    v_mfma_f32_32x32x16_bf16 v[48:63], v[76:79], v[188:191], v[48:63]
    s_waitcnt vmcnt(4) lgkmcnt(0)
    v_mfma_f32_32x32x16_bf16 v[0:15], v[80:83], v[176:179], v[0:15]
    ds_read_b64_tr_b16 v[184:185], v246 offset:6144
    ds_read_b64_tr_b16 v[186:187], v246 offset:6656
    ds_read_b64_tr_b16 v[188:189], v247 offset:6144
    ds_read_b64_tr_b16 v[190:191], v247 offset:6656
    s_mov_b32 m0, s70
    v_mfma_f32_32x32x16_bf16 v[16:31], v[84:87], v[176:179], v[16:31]
    buffer_load_dwordx4 v226, s[4:7], s42 offen sc1 lds
    buffer_load_dwordx4 v227, s[72:75], s42 offen offset:1024 sc1 lds
    v_mfma_f32_32x32x16_bf16 v[32:47], v[80:83], v[180:183], v[32:47]
    v_mfma_f32_32x32x16_bf16 v[48:63], v[84:87], v[180:183], v[48:63]
    s_waitcnt vmcnt(4) lgkmcnt(0)
    v_mfma_f32_32x32x16_bf16 v[0:15], v[88:91], v[184:187], v[0:15]
    ds_read_b64_tr_b16 v[176:177], v246 offset:0
    ds_read_b64_tr_b16 v[178:179], v246 offset:512
    ds_read_b64_tr_b16 v[180:181], v247 offset:0
    ds_read_b64_tr_b16 v[182:183], v247 offset:512
    s_mov_b32 m0, s71
    v_mfma_f32_32x32x16_bf16 v[16:31], v[92:95], v[184:187], v[16:31]
    buffer_load_dwordx4 v228, s[4:7], s42 offen sc1 lds
    buffer_load_dwordx4 v229, s[72:75], s42 offen offset:1024 sc1 lds
    v_mfma_f32_32x32x16_bf16 v[32:47], v[88:91], v[188:191], v[32:47]
    s_nop 2
    v_mul_f32 v234, v0, v144
    v_mul_f32 v236, v8, v112
    v_fmac_f32 v234, v1, v145
    v_fmac_f32 v236, v9, v113
    v_fmac_f32 v234, v2, v146
    v_fmac_f32 v236, v10, v114
    v_fmac_f32 v234, v3, v147
    v_mfma_f32_32x32x16_bf16 v[48:63], v[92:95], v[188:191], v[48:63]
    s_setprio 0
    v_fmac_f32 v236, v11, v115
    v_fmac_f32 v234, v4, v148
    v_fmac_f32 v236, v12, v116
    v_fmac_f32 v234, v5, v149
    v_fmac_f32 v236, v13, v117
    v_fmac_f32 v234, v6, v150
    v_fmac_f32 v236, v14, v118
    v_fmac_f32 v234, v7, v151
    v_fmac_f32 v236, v15, v119
    v_mul_f32 v238, v16, v160
    v_mul_f32 v240, v24, v160
    v_fmac_f32 v238, v17, v161
    v_fmac_f32 v240, v25, v161
    v_fmac_f32 v238, v18, v162
    v_fmac_f32 v240, v26, v162
    v_fmac_f32 v238, v19, v163
    v_fmac_f32 v240, v27, v163
    v_fmac_f32 v238, v20, v164
    v_fmac_f32 v240, v28, v164
    v_fmac_f32 v238, v21, v165
    v_fmac_f32 v240, v29, v165
    v_fmac_f32 v238, v22, v166
    v_fmac_f32 v240, v30, v166
    v_fmac_f32 v238, v23, v167
    v_fmac_f32 v240, v31, v167
    v_mul_f32 v235, v32, v152
    v_mul_f32 v237, v40, v120
    v_fmac_f32 v235, v33, v153
    v_fmac_f32 v237, v41, v121
    v_fmac_f32 v235, v34, v154
    v_fmac_f32 v237, v42, v122
    v_fmac_f32 v235, v35, v155
    v_fmac_f32 v237, v43, v123
    v_fmac_f32 v235, v36, v156
    v_fmac_f32 v237, v44, v124
    v_fmac_f32 v235, v37, v157
    v_fmac_f32 v237, v45, v125
    v_fmac_f32 v235, v38, v158
    v_fmac_f32 v237, v46, v126
    v_fmac_f32 v235, v39, v159
    v_fmac_f32 v237, v47, v127
    v_mul_f32 v239, v48, v168
    v_mul_f32 v241, v56, v168
    s_setprio 1
    s_waitcnt vmcnt(4) lgkmcnt(0)
    v_mfma_f32_32x32x16_bf16 v[0:15], v[64:67], v[176:179], 0
    ds_read_b64_tr_b16 v[184:185], v246 offset:2048
    ds_read_b64_tr_b16 v[186:187], v246 offset:2560
    ds_read_b64_tr_b16 v[188:189], v247 offset:2048
    ds_read_b64_tr_b16 v[190:191], v247 offset:2560
    v_fmac_f32 v239, v49, v169
    v_fmac_f32 v241, v57, v169
    s_mov_b32 m0, s68
    v_mfma_f32_32x32x16_bf16 v[16:31], v[68:71], v[176:179], 0
    buffer_load_dwordx4 v222, s[4:7], s43 offen sc1 lds
    buffer_load_dwordx4 v223, s[72:75], s43 offen offset:1024 sc1 lds
    v_fmac_f32 v239, v50, v170
    v_fmac_f32 v241, v58, v170
    v_fmac_f32 v239, v51, v171
    v_fmac_f32 v241, v59, v171
    v_fmac_f32 v239, v52, v172
    v_mfma_f32_32x32x16_bf16 v[32:47], v[64:67], v[180:183], 0
    v_fmac_f32 v241, v60, v172
    v_fmac_f32 v239, v53, v173
    v_fmac_f32 v241, v61, v173
    v_fmac_f32 v239, v54, v174
    v_fmac_f32 v241, v62, v174
    v_fmac_f32 v239, v55, v175
    v_fmac_f32 v241, v63, v175
    v_mfma_f32_32x32x16_bf16 v[48:63], v[68:71], v[180:183], 0
    s_waitcnt vmcnt(4) lgkmcnt(0)
    v_mfma_f32_32x32x16_bf16 v[0:15], v[72:75], v[184:187], v[0:15]
    ds_read_b64_tr_b16 v[176:177], v246 offset:4096
    ds_read_b64_tr_b16 v[178:179], v246 offset:4608
    ds_read_b64_tr_b16 v[180:181], v247 offset:4096
    ds_read_b64_tr_b16 v[182:183], v247 offset:4608
    s_mov_b32 m0, s69
    v_mfma_f32_32x32x16_bf16 v[16:31], v[76:79], v[184:187], v[16:31]
    buffer_load_dwordx4 v224, s[4:7], s43 offen sc1 lds
    buffer_load_dwordx4 v225, s[72:75], s43 offen offset:1024 sc1 lds
    v_mfma_f32_32x32x16_bf16 v[32:47], v[72:75], v[188:191], v[32:47]
    v_mfma_f32_32x32x16_bf16 v[48:63], v[76:79], v[188:191], v[48:63]
    s_waitcnt vmcnt(4) lgkmcnt(0)
    v_mfma_f32_32x32x16_bf16 v[0:15], v[80:83], v[176:179], v[0:15]
    ds_read_b64_tr_b16 v[184:185], v246 offset:6144
    ds_read_b64_tr_b16 v[186:187], v246 offset:6656
    ds_read_b64_tr_b16 v[188:189], v247 offset:6144
    ds_read_b64_tr_b16 v[190:191], v247 offset:6656
    s_mov_b32 m0, s70
    v_mfma_f32_32x32x16_bf16 v[16:31], v[84:87], v[176:179], v[16:31]
    buffer_load_dwordx4 v226, s[4:7], s43 offen sc1 lds
    buffer_load_dwordx4 v227, s[72:75], s43 offen offset:1024 sc1 lds
    v_mfma_f32_32x32x16_bf16 v[32:47], v[80:83], v[180:183], v[32:47]
    v_add_u32 v222, s48, v251
    ds_read_b32 v222, v222
    v_mfma_f32_32x32x16_bf16 v[48:63], v[84:87], v[180:183], v[48:63]
    s_waitcnt vmcnt(4) lgkmcnt(1)
    v_mfma_f32_32x32x16_bf16 v[0:15], v[88:91], v[184:187], v[0:15]
    ds_read_b64_tr_b16 v[176:177], v246 offset:0
    ds_read_b64_tr_b16 v[178:179], v246 offset:512
    ds_read_b64_tr_b16 v[180:181], v247 offset:0
    ds_read_b64_tr_b16 v[182:183], v247 offset:512
    s_mov_b32 m0, s71
    v_mfma_f32_32x32x16_bf16 v[16:31], v[92:95], v[184:187], v[16:31]
    buffer_load_dwordx4 v228, s[4:7], s43 offen sc1 lds
    buffer_load_dwordx4 v229, s[72:75], s43 offen offset:1024 sc1 lds
    s_waitcnt lgkmcnt(4)
    v_mad_u32_u16 v223, v222, s39, v248 op_sel:[1,0,0,0]
    v_mad_u32_u16 v222, v222, s39, v248
    v_mfma_f32_32x32x16_bf16 v[32:47], v[88:91], v[188:191], v[32:47]
    v_add_u32 v224, s49, v251
    ds_read_b32 v224, v224
    v_mul_f32 v242, v0, v144
    v_fma_f32 v238, v8, v160, -v238
    v_fmac_f32 v242, v1, v145
    v_fmac_f32 v238, v9, v161
    v_fmac_f32 v242, v2, v146
    v_mfma_f32_32x32x16_bf16 v[48:63], v[92:95], v[188:191], v[48:63]
    s_setprio 0
    v_fmac_f32 v238, v10, v162
    v_fmac_f32 v242, v3, v147
    v_fmac_f32 v238, v11, v163
    v_fmac_f32 v242, v4, v148
    v_fmac_f32 v238, v12, v164
    v_fmac_f32 v242, v5, v149
    v_fmac_f32 v238, v13, v165
    v_fmac_f32 v242, v6, v150
    v_fmac_f32 v238, v14, v166
    v_fmac_f32 v242, v7, v151
    v_fmac_f32 v238, v15, v167
    v_fmac_f32 v236, v16, v112
    v_mul_f32 v244, v24, v160
    v_fmac_f32 v236, v17, v113
    v_fmac_f32 v244, v25, v161
    v_fmac_f32 v236, v18, v114
    v_fmac_f32 v244, v26, v162
    v_fmac_f32 v236, v19, v115
    v_fmac_f32 v244, v27, v163
    v_fmac_f32 v236, v20, v116
    v_fmac_f32 v244, v28, v164
    v_fmac_f32 v236, v21, v117
    v_fmac_f32 v244, v29, v165
    v_fmac_f32 v236, v22, v118
    v_fmac_f32 v244, v30, v166
    v_fmac_f32 v236, v23, v119
    v_fmac_f32 v244, v31, v167
    v_mul_f32 v243, v32, v152
    v_fma_f32 v239, v40, v168, -v239
    v_fmac_f32 v243, v33, v153
    v_fmac_f32 v239, v41, v169
    v_fmac_f32 v243, v34, v154
    v_fmac_f32 v239, v42, v170
    v_fmac_f32 v243, v35, v155
    v_fmac_f32 v239, v43, v171
    v_fmac_f32 v243, v36, v156
    v_fmac_f32 v239, v44, v172
    v_fmac_f32 v243, v37, v157
    v_fmac_f32 v239, v45, v173
    v_fmac_f32 v243, v38, v158
    v_fmac_f32 v239, v46, v174
    v_fmac_f32 v243, v39, v159
    v_fmac_f32 v239, v47, v175
    v_fmac_f32 v237, v48, v120
    v_mul_f32 v245, v56, v168
    v_fmac_f32 v237, v49, v121
    v_fmac_f32 v245, v57, v169
    v_fmac_f32 v237, v50, v122
    v_fmac_f32 v245, v58, v170
    v_fmac_f32 v237, v51, v123
    s_setprio 1
    s_waitcnt vmcnt(4) lgkmcnt(1)
    v_mfma_f32_32x32x16_bf16 v[0:15], v[64:67], v[176:179], 0
    ds_read_b64_tr_b16 v[184:185], v246 offset:2048
    ds_read_b64_tr_b16 v[186:187], v246 offset:2560
    ds_read_b64_tr_b16 v[188:189], v247 offset:2048
    ds_read_b64_tr_b16 v[190:191], v247 offset:2560
    v_fmac_f32 v245, v59, v171
    v_fmac_f32 v237, v52, v124
    s_mov_b32 m0, s68
    v_mfma_f32_32x32x16_bf16 v[16:31], v[68:71], v[176:179], 0
    buffer_load_dwordx4 v222, s[4:7], s44 offen sc1 lds
    buffer_load_dwordx4 v223, s[72:75], s44 offen offset:1024 sc1 lds
    s_waitcnt lgkmcnt(4)
    v_mad_u32_u16 v225, v224, s39, v248 op_sel:[1,0,0,0]
    v_mad_u32_u16 v224, v224, s39, v248
    v_fmac_f32 v245, v60, v172
    v_fmac_f32 v237, v53, v125
    v_mfma_f32_32x32x16_bf16 v[32:47], v[64:67], v[180:183], 0
    v_add_u32 v226, s50, v251
    ds_read_b32 v226, v226
    v_fmac_f32 v245, v61, v173
    v_fmac_f32 v237, v54, v126
    v_fmac_f32 v245, v62, v174
    v_fmac_f32 v237, v55, v127
    v_fmac_f32 v245, v63, v175
    v_mfma_f32_32x32x16_bf16 v[48:63], v[68:71], v[180:183], 0
    v_permlane32_swap_b32 v242, v234
    v_permlane32_swap_b32 v243, v235
    v_add_f32 v242, v242, v234
    v_add_f32 v243, v243, v235
    s_waitcnt vmcnt(4) lgkmcnt(1)
    v_mfma_f32_32x32x16_bf16 v[0:15], v[72:75], v[184:187], v[0:15]
    ds_read_b64_tr_b16 v[176:177], v246 offset:4096
    ds_read_b64_tr_b16 v[178:179], v246 offset:4608
    ds_read_b64_tr_b16 v[180:181], v247 offset:4096
    ds_read_b64_tr_b16 v[182:183], v247 offset:4608
    s_mov_b32 m0, s69
    v_mfma_f32_32x32x16_bf16 v[16:31], v[76:79], v[184:187], v[16:31]
    buffer_load_dwordx4 v224, s[4:7], s45 offen sc1 lds
    buffer_load_dwordx4 v225, s[72:75], s45 offen offset:1024 sc1 lds
    s_waitcnt lgkmcnt(4)
    v_mad_u32_u16 v227, v226, s39, v248 op_sel:[1,0,0,0]
    v_mad_u32_u16 v226, v226, s39, v248
    v_mfma_f32_32x32x16_bf16 v[32:47], v[72:75], v[188:191], v[32:47]
    v_add_u32 v228, s51, v251
    ds_read_b32 v228, v228
    s_set_gpr_idx_on s31, gpr_idx(DST)
    s_nop 0
    v_cvt_pk_bf16_f32 v194, v242, v243
    s_set_gpr_idx_off
    v_mfma_f32_32x32x16_bf16 v[48:63], v[76:79], v[188:191], v[48:63]
    s_waitcnt vmcnt(4) lgkmcnt(1)
    v_mfma_f32_32x32x16_bf16 v[0:15], v[80:83], v[176:179], v[0:15]
    ds_read_b64_tr_b16 v[184:185], v246 offset:6144
    ds_read_b64_tr_b16 v[186:187], v246 offset:6656
    ds_read_b64_tr_b16 v[188:189], v247 offset:6144
    ds_read_b64_tr_b16 v[190:191], v247 offset:6656
    s_mov_b32 s32, s31
    s_mov_b32 s31, s35
    s_mov_b32 m0, s70
    v_mfma_f32_32x32x16_bf16 v[16:31], v[84:87], v[176:179], v[16:31]
    buffer_load_dwordx4 v226, s[4:7], s46 offen sc1 lds
    buffer_load_dwordx4 v227, s[72:75], s46 offen offset:1024 sc1 lds
    s_waitcnt lgkmcnt(4)
    v_mad_u32_u16 v229, v228, s39, v248 op_sel:[1,0,0,0]
    v_mad_u32_u16 v228, v228, s39, v248
    s_sub_u32 s26, s48, s29
    s_mov_b32 s29, s48
    v_mfma_f32_32x32x16_bf16 v[32:47], v[80:83], v[180:183], v[32:47]
    s_mov_b32 s30, s3
    s_cmp_eq_u32 s34, 0
    s_cselect_b32 s56, s33, 0
    v_mfma_f32_32x32x16_bf16 v[48:63], v[84:87], v[180:183], v[48:63]
    s_waitcnt vmcnt(4) lgkmcnt(0)
    v_mfma_f32_32x32x16_bf16 v[0:15], v[88:91], v[184:187], v[0:15]
    ds_read_b64_tr_b16 v[176:177], v246 offset:0
    ds_read_b64_tr_b16 v[178:179], v246 offset:512
    ds_read_b64_tr_b16 v[180:181], v247 offset:0
    ds_read_b64_tr_b16 v[182:183], v247 offset:512
    s_mov_b32 m0, s71
    v_mfma_f32_32x32x16_bf16 v[16:31], v[92:95], v[184:187], v[16:31]
    buffer_load_dwordx4 v228, s[4:7], s47 offen sc1 lds
    buffer_load_dwordx4 v229, s[72:75], s47 offen offset:1024 sc1 lds
    v_mfma_f32_32x32x16_bf16 v[32:47], v[88:91], v[188:191], v[32:47]
    s_nop 2
    v_mul_f32 v242, v0, v144
    v_fma_f32 v240, v8, v160, -v240
    v_fmac_f32 v242, v1, v145
    v_fmac_f32 v240, v9, v161
    v_fmac_f32 v242, v2, v146
    v_fmac_f32 v240, v10, v162
    v_fmac_f32 v242, v3, v147
    v_mfma_f32_32x32x16_bf16 v[48:63], v[92:95], v[188:191], v[48:63]
    s_setprio 0
    v_fmac_f32 v240, v11, v163
    v_fmac_f32 v242, v4, v148
    v_fmac_f32 v240, v12, v164
    v_fmac_f32 v242, v5, v149
    v_fmac_f32 v240, v13, v165
    v_fmac_f32 v242, v6, v150
    v_fmac_f32 v240, v14, v166
    v_fmac_f32 v242, v7, v151
    v_fmac_f32 v240, v15, v167
    v_add_u32 v249, s26, v249
    v_add_u32 v250, s26, v250
    v_fma_f32 v244, v16, v160, -v244
    v_fmac_f32 v236, v24, v112
    v_fmac_f32 v244, v17, v161
    v_fmac_f32 v236, v25, v113
    v_fmac_f32 v244, v18, v162
    v_fmac_f32 v236, v26, v114
    v_fmac_f32 v244, v19, v163
    v_fmac_f32 v236, v27, v115
    v_fmac_f32 v244, v20, v164
    v_fmac_f32 v236, v28, v116
    v_fmac_f32 v244, v21, v165
    v_fmac_f32 v236, v29, v117
    v_fmac_f32 v244, v22, v166
    v_fmac_f32 v236, v30, v118
    v_fmac_f32 v244, v23, v167
    v_fmac_f32 v236, v31, v119
    ds_read_b64_tr_b16 v[0:1], v249 offset:0
    ds_read_b64_tr_b16 v[2:3], v249 offset:128
    ds_read_b128 v[4:7], v250 offset:0
    ds_read_b128 v[8:11], v250 offset:16
    ds_read_b128 v[12:15], v250 offset:384
    ds_read_b128 v[16:19], v250 offset:400
    v_mul_f32 v243, v32, v152
    v_fma_f32 v241, v40, v168, -v241
    v_fmac_f32 v243, v33, v153
    v_fmac_f32 v241, v41, v169
    v_fmac_f32 v243, v34, v154
    v_fmac_f32 v241, v42, v170
    v_fmac_f32 v243, v35, v155
    v_fmac_f32 v241, v43, v171
    v_fmac_f32 v243, v36, v156
    v_fmac_f32 v241, v44, v172
    v_fmac_f32 v243, v37, v157
    v_fmac_f32 v241, v45, v173
    v_fmac_f32 v243, v38, v158
    v_fmac_f32 v241, v46, v174
    v_fmac_f32 v243, v39, v159
    v_fmac_f32 v241, v47, v175
    ds_read_b64_tr_b16 v[20:21], v249 offset:512
    ds_read_b64_tr_b16 v[22:23], v249 offset:640
    ds_read_b128 v[24:27], v250 offset:64
    ds_read_b128 v[28:31], v250 offset:80
    ds_read_b128 v[32:35], v250 offset:448
    ds_read_b128 v[36:39], v250 offset:464
    v_fma_f32 v245, v48, v168, -v245
    v_fmac_f32 v237, v56, v120
    v_fmac_f32 v245, v49, v169
    v_fmac_f32 v237, v57, v121
    v_fmac_f32 v245, v50, v170
    v_fmac_f32 v237, v58, v122
    v_fmac_f32 v245, v51, v171
    v_fmac_f32 v237, v59, v123
    v_fmac_f32 v245, v52, v172
    v_fmac_f32 v237, v60, v124
    v_fmac_f32 v245, v53, v173
    v_fmac_f32 v237, v61, v125
    v_fmac_f32 v245, v54, v174
    v_fmac_f32 v237, v62, v126
    v_fmac_f32 v245, v55, v175
    v_fmac_f32 v237, v63, v127
    s_cmp_eq_u32 s56, 2
    s_cbranch_scc1 K2_U20
    s_cmp_eq_u32 s56, 3
    s_cbranch_scc1 K2_U30
    s_branch K2_DSP0
K2_U11:
    s_setprio 1
    v_mov_b32 v254, 163648
    v_mov_b32 v255, 1
    v_lshl_add_u32 v233, v252, 1, s53
    s_mov_b64 exec, 1
    ds_add_rtn_u32 v232, v254, v255
    s_mov_b64 exec, -1
    ds_read_b32 v233, v233
    s_waitcnt lgkmcnt(8)
    v_lshlrev_b32 v40, 16, v0
    v_and_b32 v41, 0xffff0000, v0
    v_lshlrev_b32 v42, 16, v1
    v_and_b32 v43, 0xffff0000, v1
    v_lshlrev_b32 v44, 16, v2
    v_and_b32 v45, 0xffff0000, v2
    v_lshlrev_b32 v46, 16, v3
    v_and_b32 v47, 0xffff0000, v3
    v_mul_f32 v4, v40, v4
    v_mul_f32 v5, v41, v5
    v_mul_f32 v6, v42, v6
    v_mul_f32 v7, v43, v7
    v_mul_f32 v8, v44, v8
    v_mul_f32 v9, v45, v9
    v_mul_f32 v10, v46, v10
    v_mul_f32 v11, v47, v11
    v_cvt_pk_bf16_f32 v64, v4, v5
    v_cvt_pk_bf16_f32 v65, v6, v7
    v_cvt_pk_bf16_f32 v66, v8, v9
    v_cvt_pk_bf16_f32 v67, v10, v11
    v_mul_f32 v12, v40, v12
    v_mul_f32 v13, v41, v13
    v_mul_f32 v14, v42, v14
    v_mul_f32 v15, v43, v15
    v_mul_f32 v16, v44, v16
    v_mul_f32 v17, v45, v17
    v_mul_f32 v18, v46, v18
    v_mul_f32 v19, v47, v19
    v_cvt_pk_bf16_f32 v68, v12, v13
    v_cvt_pk_bf16_f32 v69, v14, v15
    v_cvt_pk_bf16_f32 v70, v16, v17
    v_cvt_pk_bf16_f32 v71, v18, v19
    s_waitcnt lgkmcnt(0)
    v_readfirstlane_b32 s58, v232
    s_nop 0
    s_cmp_lt_u32 s58, s22
    s_cbranch_scc0 K2_nul_74
    s_and_b32 s59, s58, 7
    s_lshr_b32 s60, s58, 3
K2_chk_76:
    v_readlane_b32 s61, v233, s59
    s_nop 0
    s_cmp_gt_u32 s61, s60
    s_cbranch_scc0 K2_spin_75
K2_back_77:
    v_readlane_b32 s3, v253, s58
    s_lshl_b32 s44, s34, 7
    s_lshl_b32 s60, s58, 5
    s_and_b32 s48, s3, 0x3ffff
    s_bfe_u32 s33, s3, 0x30012
    s_sub_u32 s60, s60, s48
    s_and_b32 s60, s60, 0xff
    s_add_u32 s35, s60, s48
    s_mov_b32 s45, s44
    s_add_u32 s47, s44, 256
    s_add_u32 s49, s48, 32
    s_add_u32 s60, s48, 64
    s_cmp_eq_u32 s33, 3
    s_cselect_b32 s46, s44, s47
    s_cselect_b32 s50, s60, s48
    s_cselect_b32 s51, s48, s49
    s_sub_u32 s60, s33, 2
    s_cmp_lt_u32 s60, 2
    s_cbranch_scc0 K2_rare_78
K2_back_79:
    v_add_u32 v222, s48, v251
    ds_read_b32 v222, v222
    v_add_u32 v224, s49, v251
    ds_read_b32 v224, v224
    v_add_u32 v226, s50, v251
    ds_read_b32 v226, v226
    v_add_u32 v228, s51, v251
    ds_read_b32 v228, v228
    s_waitcnt lgkmcnt(3)
    v_mad_u32_u16 v223, v222, s39, v248 op_sel:[1,0,0,0]
    v_mad_u32_u16 v222, v222, s39, v248
    s_waitcnt lgkmcnt(2)
    v_mad_u32_u16 v225, v224, s39, v248 op_sel:[1,0,0,0]
    v_mad_u32_u16 v224, v224, s39, v248
    s_waitcnt lgkmcnt(1)
    v_mad_u32_u16 v227, v226, s39, v248 op_sel:[1,0,0,0]
    v_mad_u32_u16 v226, v226, s39, v248
    s_waitcnt lgkmcnt(0)
    v_mad_u32_u16 v229, v228, s39, v248 op_sel:[1,0,0,0]
    v_mad_u32_u16 v228, v228, s39, v248
    s_waitcnt vmcnt(4)
    v_mfma_f32_32x32x16_bf16 v[0:15], v[64:67], v[176:179], 0
    ds_read_b64_tr_b16 v[184:185], v246 offset:2048
    ds_read_b64_tr_b16 v[186:187], v246 offset:2560
    ds_read_b64_tr_b16 v[188:189], v247 offset:2048
    ds_read_b64_tr_b16 v[190:191], v247 offset:2560
    s_mov_b32 m0, s68
    v_mfma_f32_32x32x16_bf16 v[16:31], v[68:71], v[176:179], 0
    buffer_load_dwordx4 v222, s[4:7], s44 offen sc1 lds
    buffer_load_dwordx4 v223, s[72:75], s44 offen offset:1024 sc1 lds
    v_permlane32_swap_b32 v242, v236
    v_permlane32_swap_b32 v243, v237
    v_mfma_f32_32x32x16_bf16 v[32:47], v[64:67], v[180:183], 0
    v_permlane32_swap_b32 v244, v238
    v_permlane32_swap_b32 v245, v239
    v_permlane32_swap_b32 v240, v241
    v_add_f32 v242, v242, v236
    v_mfma_f32_32x32x16_bf16 v[48:63], v[68:71], v[180:183], 0
    s_setprio 0
    v_add_f32 v243, v243, v237
    v_add_f32 v244, v244, v238
    v_add_f32 v245, v245, v239
    v_add_f32 v240, -v240, -v241
    v_sub_u32 v241, v230, v231
    v_cvt_pk_bf16_f32 v242, v242, v243
    v_cvt_pk_bf16_f32 v244, v244, v245
    v_cvt_pk_bf16_f32 v240, v240, v240
    ds_write_b32 v230, v242 offset:768
    ds_write_b32 v230, v244 offset:1024
    ds_write_b16 v241, v240 offset:1280
    v_mul_f32 v234, v0, v96
    v_mul_f32 v236, v8, v128
    v_fmac_f32 v234, v1, v97
    v_fmac_f32 v236, v9, v129
    v_fmac_f32 v234, v2, v98
    v_fmac_f32 v236, v10, v130
    v_fmac_f32 v234, v3, v99
    v_fmac_f32 v236, v11, v131
    v_fmac_f32 v234, v4, v100
    v_fmac_f32 v236, v12, v132
    v_fmac_f32 v234, v5, v101
    v_fmac_f32 v236, v13, v133
    v_fmac_f32 v234, v6, v102
    v_fmac_f32 v236, v14, v134
    v_fmac_f32 v234, v7, v103
    v_fmac_f32 v236, v15, v135
    v_mul_f32 v238, v16, v128
    v_mul_f32 v240, v24, v128
    v_fmac_f32 v238, v17, v129
    v_fmac_f32 v240, v25, v129
    v_fmac_f32 v238, v18, v130
    v_fmac_f32 v240, v26, v130
    v_fmac_f32 v238, v19, v131
    v_fmac_f32 v240, v27, v131
    v_fmac_f32 v238, v20, v132
    v_fmac_f32 v240, v28, v132
    v_fmac_f32 v238, v21, v133
    v_fmac_f32 v240, v29, v133
    v_fmac_f32 v238, v22, v134
    v_fmac_f32 v240, v30, v134
    v_fmac_f32 v238, v23, v135
    v_fmac_f32 v240, v31, v135
    v_mul_f32 v235, v32, v104
    v_mul_f32 v237, v40, v136
    v_fmac_f32 v235, v33, v105
    v_fmac_f32 v237, v41, v137
    v_fmac_f32 v235, v34, v106
    v_fmac_f32 v237, v42, v138
    v_fmac_f32 v235, v35, v107
    v_fmac_f32 v237, v43, v139
    v_fmac_f32 v235, v36, v108
    v_fmac_f32 v237, v44, v140
    v_fmac_f32 v235, v37, v109
    v_fmac_f32 v237, v45, v141
    v_fmac_f32 v235, v38, v110
    v_fmac_f32 v237, v46, v142
    v_fmac_f32 v235, v39, v111
    v_fmac_f32 v237, v47, v143
    v_mul_f32 v239, v48, v136
    v_mul_f32 v241, v56, v136
    v_fmac_f32 v239, v49, v137
    v_fmac_f32 v241, v57, v137
    v_fmac_f32 v239, v50, v138
    v_fmac_f32 v241, v58, v138
    v_fmac_f32 v239, v51, v139
    v_fmac_f32 v241, v59, v139
    v_fmac_f32 v239, v52, v140
    v_fmac_f32 v241, v60, v140
    v_fmac_f32 v239, v53, v141
    v_fmac_f32 v241, v61, v141
    v_fmac_f32 v239, v54, v142
    v_fmac_f32 v241, v62, v142
    v_fmac_f32 v239, v55, v143
    v_fmac_f32 v241, v63, v143
    s_setprio 1
    s_waitcnt vmcnt(4) lgkmcnt(3)
    v_mfma_f32_32x32x16_bf16 v[0:15], v[64:67], v[184:187], 0
    ds_read_b64_tr_b16 v[176:177], v246 offset:4096
    ds_read_b64_tr_b16 v[178:179], v246 offset:4608
    ds_read_b64_tr_b16 v[180:181], v247 offset:4096
    ds_read_b64_tr_b16 v[182:183], v247 offset:4608
    s_mov_b32 m0, s69
    v_mfma_f32_32x32x16_bf16 v[16:31], v[68:71], v[184:187], 0
    buffer_load_dwordx4 v224, s[4:7], s45 offen sc1 lds
    buffer_load_dwordx4 v225, s[72:75], s45 offen offset:1024 sc1 lds
    v_permlane32_swap_b32 v234, v236
    v_permlane32_swap_b32 v235, v237
    v_mfma_f32_32x32x16_bf16 v[32:47], v[64:67], v[188:191], 0
    v_permlane32_swap_b32 v240, v238
    v_permlane32_swap_b32 v241, v239
    v_lshl_add_u32 v230, v252, 1, s31
    v_add_f32 v234, v234, v236
    v_add_f32 v235, v235, v237
    v_mfma_f32_32x32x16_bf16 v[48:63], v[68:71], v[188:191], 0
    s_setprio 0
    v_add_f32 v240, v240, v238
    v_add_f32 v241, v241, v239
    v_cvt_pk_bf16_f32 v234, v234, v235
    v_cvt_pk_bf16_f32 v240, v240, v241
    ds_write_b32 v230, v234 offset:0
    ds_write_b32 v230, v240 offset:256
    v_mul_f32 v234, v0, v144
    v_mul_f32 v236, v8, v112
    v_fmac_f32 v234, v1, v145
    v_fmac_f32 v236, v9, v113
    v_fmac_f32 v234, v2, v146
    v_fmac_f32 v236, v10, v114
    v_fmac_f32 v234, v3, v147
    v_fmac_f32 v236, v11, v115
    v_fmac_f32 v234, v4, v148
    v_fmac_f32 v236, v12, v116
    v_fmac_f32 v234, v5, v149
    v_fmac_f32 v236, v13, v117
    v_fmac_f32 v234, v6, v150
    v_fmac_f32 v236, v14, v118
    v_fmac_f32 v234, v7, v151
    v_fmac_f32 v236, v15, v119
    v_mul_f32 v238, v16, v160
    v_mul_f32 v240, v24, v160
    v_fmac_f32 v238, v17, v161
    v_fmac_f32 v240, v25, v161
    v_fmac_f32 v238, v18, v162
    v_fmac_f32 v240, v26, v162
    v_fmac_f32 v238, v19, v163
    v_fmac_f32 v240, v27, v163
    v_fmac_f32 v238, v20, v164
    v_fmac_f32 v240, v28, v164
    v_fmac_f32 v238, v21, v165
    v_fmac_f32 v240, v29, v165
    v_fmac_f32 v238, v22, v166
    v_fmac_f32 v240, v30, v166
    v_fmac_f32 v238, v23, v167
    v_fmac_f32 v240, v31, v167
    v_mul_f32 v235, v32, v152
    v_mul_f32 v237, v40, v120
    v_fmac_f32 v235, v33, v153
    v_fmac_f32 v237, v41, v121
    v_fmac_f32 v235, v34, v154
    v_fmac_f32 v237, v42, v122
    v_fmac_f32 v235, v35, v155
    v_fmac_f32 v237, v43, v123
    v_fmac_f32 v235, v36, v156
    v_fmac_f32 v237, v44, v124
    v_fmac_f32 v235, v37, v157
    v_fmac_f32 v237, v45, v125
    v_fmac_f32 v235, v38, v158
    v_fmac_f32 v237, v46, v126
    v_fmac_f32 v235, v39, v159
    v_fmac_f32 v237, v47, v127
    v_mul_f32 v239, v48, v168
    v_mul_f32 v241, v56, v168
    v_fmac_f32 v239, v49, v169
    v_fmac_f32 v241, v57, v169
    v_fmac_f32 v239, v50, v170
    v_fmac_f32 v241, v58, v170
    v_fmac_f32 v239, v51, v171
    v_fmac_f32 v241, v59, v171
    v_fmac_f32 v239, v52, v172
    v_fmac_f32 v241, v60, v172
    v_fmac_f32 v239, v53, v173
    v_fmac_f32 v241, v61, v173
    v_fmac_f32 v239, v54, v174
    v_fmac_f32 v241, v62, v174
    v_fmac_f32 v239, v55, v175
    v_fmac_f32 v241, v63, v175
    s_setprio 1
    s_waitcnt vmcnt(4) lgkmcnt(2)
    v_mfma_f32_32x32x16_bf16 v[0:15], v[64:67], v[176:179], 0
    ds_read_b64_tr_b16 v[184:185], v246 offset:6144
    ds_read_b64_tr_b16 v[186:187], v246 offset:6656
    ds_read_b64_tr_b16 v[188:189], v247 offset:6144
    ds_read_b64_tr_b16 v[190:191], v247 offset:6656
    s_mov_b32 s32, s31
    s_mov_b32 s31, s35
    s_mov_b32 m0, s70
    v_mfma_f32_32x32x16_bf16 v[16:31], v[68:71], v[176:179], 0
    buffer_load_dwordx4 v226, s[4:7], s46 offen sc1 lds
    buffer_load_dwordx4 v227, s[72:75], s46 offen offset:1024 sc1 lds
    s_sub_u32 s26, s48, s29
    s_mov_b32 s29, s48
    s_mov_b32 s30, s3
    s_cmp_lg_u32 s36, 0
    s_cselect_b32 s56, s33, 0
    v_mfma_f32_32x32x16_bf16 v[32:47], v[64:67], v[180:183], 0
    v_mfma_f32_32x32x16_bf16 v[48:63], v[68:71], v[180:183], 0
    s_setprio 0
    v_mul_f32 v242, v0, v144
    v_fma_f32 v238, v8, v160, -v238
    v_fmac_f32 v242, v1, v145
    v_fmac_f32 v238, v9, v161
    v_fmac_f32 v242, v2, v146
    v_fmac_f32 v238, v10, v162
    v_fmac_f32 v242, v3, v147
    v_fmac_f32 v238, v11, v163
    v_fmac_f32 v242, v4, v148
    v_fmac_f32 v238, v12, v164
    v_fmac_f32 v242, v5, v149
    v_fmac_f32 v238, v13, v165
    v_fmac_f32 v242, v6, v150
    v_fmac_f32 v238, v14, v166
    v_fmac_f32 v242, v7, v151
    v_fmac_f32 v238, v15, v167
    v_fmac_f32 v236, v16, v112
    v_mul_f32 v244, v24, v160
    v_fmac_f32 v236, v17, v113
    v_fmac_f32 v244, v25, v161
    v_fmac_f32 v236, v18, v114
    v_fmac_f32 v244, v26, v162
    v_fmac_f32 v236, v19, v115
    v_fmac_f32 v244, v27, v163
    v_fmac_f32 v236, v20, v116
    v_fmac_f32 v244, v28, v164
    v_fmac_f32 v236, v21, v117
    v_fmac_f32 v244, v29, v165
    v_fmac_f32 v236, v22, v118
    v_fmac_f32 v244, v30, v166
    v_fmac_f32 v236, v23, v119
    v_fmac_f32 v244, v31, v167
    v_mul_f32 v243, v32, v152
    v_fma_f32 v239, v40, v168, -v239
    v_fmac_f32 v243, v33, v153
    v_fmac_f32 v239, v41, v169
    v_fmac_f32 v243, v34, v154
    v_fmac_f32 v239, v42, v170
    v_fmac_f32 v243, v35, v155
    v_fmac_f32 v239, v43, v171
    v_fmac_f32 v243, v36, v156
    v_fmac_f32 v239, v44, v172
    v_fmac_f32 v243, v37, v157
    v_fmac_f32 v239, v45, v173
    v_fmac_f32 v243, v38, v158
    v_fmac_f32 v239, v46, v174
    v_fmac_f32 v243, v39, v159
    v_fmac_f32 v239, v47, v175
    v_fmac_f32 v237, v48, v120
    v_mul_f32 v245, v56, v168
    v_fmac_f32 v237, v49, v121
    v_fmac_f32 v245, v57, v169
    v_fmac_f32 v237, v50, v122
    v_fmac_f32 v245, v58, v170
    v_fmac_f32 v237, v51, v123
    v_fmac_f32 v245, v59, v171
    v_fmac_f32 v237, v52, v124
    v_fmac_f32 v245, v60, v172
    v_fmac_f32 v237, v53, v125
    v_fmac_f32 v245, v61, v173
    v_fmac_f32 v237, v54, v126
    v_fmac_f32 v245, v62, v174
    v_fmac_f32 v237, v55, v127
    v_fmac_f32 v245, v63, v175
    s_setprio 1
    s_waitcnt vmcnt(4) lgkmcnt(0)
    v_mfma_f32_32x32x16_bf16 v[0:15], v[64:67], v[184:187], 0
    ds_read_b64_tr_b16 v[176:177], v246 offset:0
    ds_read_b64_tr_b16 v[178:179], v246 offset:512
    ds_read_b64_tr_b16 v[180:181], v247 offset:0
    ds_read_b64_tr_b16 v[182:183], v247 offset:512
    s_mov_b32 m0, s71
    v_mfma_f32_32x32x16_bf16 v[16:31], v[68:71], v[184:187], 0
    buffer_load_dwordx4 v228, s[4:7], s47 offen sc1 lds
    buffer_load_dwordx4 v229, s[72:75], s47 offen offset:1024 sc1 lds
    v_permlane32_swap_b32 v242, v234
    v_permlane32_swap_b32 v243, v235
    v_add_f32 v242, v242, v234
    v_mfma_f32_32x32x16_bf16 v[32:47], v[64:67], v[188:191], 0
    v_add_f32 v243, v243, v235
    v_cvt_pk_bf16_f32 v242, v242, v243
    ds_write_b32 v230, v242 offset:512
    v_mfma_f32_32x32x16_bf16 v[48:63], v[68:71], v[188:191], 0
    s_setprio 0
    v_mul_f32 v242, v0, v144
    v_fma_f32 v240, v8, v160, -v240
    v_fmac_f32 v242, v1, v145
    v_fmac_f32 v240, v9, v161
    v_fmac_f32 v242, v2, v146
    v_fmac_f32 v240, v10, v162
    v_fmac_f32 v242, v3, v147
    v_fmac_f32 v240, v11, v163
    v_fmac_f32 v242, v4, v148
    v_fmac_f32 v240, v12, v164
    v_fmac_f32 v242, v5, v149
    v_fmac_f32 v240, v13, v165
    v_fmac_f32 v242, v6, v150
    v_fmac_f32 v240, v14, v166
    v_fmac_f32 v242, v7, v151
    v_fmac_f32 v240, v15, v167
    v_add_u32 v249, s26, v249
    v_add_u32 v250, s26, v250
    v_fma_f32 v244, v16, v160, -v244
    v_fmac_f32 v236, v24, v112
    v_fmac_f32 v244, v17, v161
    v_fmac_f32 v236, v25, v113
    v_fmac_f32 v244, v18, v162
    v_fmac_f32 v236, v26, v114
    v_fmac_f32 v244, v19, v163
    v_fmac_f32 v236, v27, v115
    v_fmac_f32 v244, v20, v164
    v_fmac_f32 v236, v28, v116
    v_fmac_f32 v244, v21, v165
    v_fmac_f32 v236, v29, v117
    v_fmac_f32 v244, v22, v166
    v_fmac_f32 v236, v30, v118
    v_fmac_f32 v244, v23, v167
    v_fmac_f32 v236, v31, v119
    ds_read_b64_tr_b16 v[0:1], v249 offset:0
    ds_read_b64_tr_b16 v[2:3], v249 offset:128
    ds_read_b128 v[4:7], v250 offset:0
    ds_read_b128 v[8:11], v250 offset:16
    ds_read_b128 v[12:15], v250 offset:384
    ds_read_b128 v[16:19], v250 offset:400
    v_mul_f32 v243, v32, v152
    v_fma_f32 v241, v40, v168, -v241
    v_fmac_f32 v243, v33, v153
    v_fmac_f32 v241, v41, v169
    v_fmac_f32 v243, v34, v154
    v_fmac_f32 v241, v42, v170
    v_fmac_f32 v243, v35, v155
    v_fmac_f32 v241, v43, v171
    v_fmac_f32 v243, v36, v156
    v_fmac_f32 v241, v44, v172
    v_fmac_f32 v243, v37, v157
    v_fmac_f32 v241, v45, v173
    v_fmac_f32 v243, v38, v158
    v_fmac_f32 v241, v46, v174
    v_fmac_f32 v243, v39, v159
    v_fmac_f32 v241, v47, v175
    ds_read_b64_tr_b16 v[20:21], v249 offset:512
    ds_read_b64_tr_b16 v[22:23], v249 offset:640
    ds_read_b128 v[24:27], v250 offset:64
    ds_read_b128 v[28:31], v250 offset:80
    ds_read_b128 v[32:35], v250 offset:448
    ds_read_b128 v[36:39], v250 offset:464
    v_fma_f32 v245, v48, v168, -v245
    v_fmac_f32 v237, v56, v120
    v_fmac_f32 v245, v49, v169
    v_fmac_f32 v237, v57, v121
    v_fmac_f32 v245, v50, v170
    v_fmac_f32 v237, v58, v122
    v_fmac_f32 v245, v51, v171
    v_fmac_f32 v237, v59, v123
    v_fmac_f32 v245, v52, v172
    v_fmac_f32 v237, v60, v124
    v_fmac_f32 v245, v53, v173
    v_fmac_f32 v237, v61, v125
    v_fmac_f32 v245, v54, v174
    v_fmac_f32 v237, v62, v126
    v_fmac_f32 v245, v55, v175
    v_fmac_f32 v237, v63, v127
    s_cmp_eq_u32 s56, 2
    s_cbranch_scc1 K2_U21
    s_cmp_eq_u32 s56, 3
    s_cbranch_scc1 K2_U31
    s_branch K2_DSP1
K2_U41:
    s_setprio 1
    s_waitcnt lgkmcnt(6)
    v_lshlrev_b32 v40, 16, v0
    v_and_b32 v41, 0xffff0000, v0
    v_lshlrev_b32 v42, 16, v1
    v_and_b32 v43, 0xffff0000, v1
    v_lshlrev_b32 v44, 16, v2
    v_and_b32 v45, 0xffff0000, v2
    v_lshlrev_b32 v46, 16, v3
    v_and_b32 v47, 0xffff0000, v3
    v_mul_f32 v4, v40, v4
    v_mul_f32 v5, v41, v5
    v_mul_f32 v6, v42, v6
    v_mul_f32 v7, v43, v7
    v_mul_f32 v8, v44, v8
    v_mul_f32 v9, v45, v9
    v_mul_f32 v10, v46, v10
    v_mul_f32 v11, v47, v11
    v_cvt_pk_bf16_f32 v64, v4, v5
    v_cvt_pk_bf16_f32 v65, v6, v7
    v_cvt_pk_bf16_f32 v66, v8, v9
    v_cvt_pk_bf16_f32 v67, v10, v11
    v_mul_f32 v12, v40, v12
    v_mul_f32 v13, v41, v13
    v_mul_f32 v14, v42, v14
    v_mul_f32 v15, v43, v15
    v_mul_f32 v16, v44, v16
    v_mul_f32 v17, v45, v17
    v_mul_f32 v18, v46, v18
    v_mul_f32 v19, v47, v19
    v_cvt_pk_bf16_f32 v68, v12, v13
    v_cvt_pk_bf16_f32 v69, v14, v15
    v_cvt_pk_bf16_f32 v70, v16, v17
    v_cvt_pk_bf16_f32 v71, v18, v19
    ds_read_b64_tr_b16 v[0:1], v249 offset:1024
    ds_read_b64_tr_b16 v[2:3], v249 offset:1152
    ds_read_b128 v[4:7], v250 offset:128
    ds_read_b128 v[8:11], v250 offset:144
    ds_read_b128 v[12:15], v250 offset:512
    ds_read_b128 v[16:19], v250 offset:528
    s_waitcnt lgkmcnt(6)
    v_lshlrev_b32 v48, 16, v20
    v_and_b32 v49, 0xffff0000, v20
    v_lshlrev_b32 v50, 16, v21
    v_and_b32 v51, 0xffff0000, v21
    v_lshlrev_b32 v52, 16, v22
    v_and_b32 v53, 0xffff0000, v22
    v_lshlrev_b32 v54, 16, v23
    v_and_b32 v55, 0xffff0000, v23
    v_mul_f32 v24, v48, v24
    v_mul_f32 v25, v49, v25
    v_mul_f32 v26, v50, v26
    v_mul_f32 v27, v51, v27
    v_mul_f32 v28, v52, v28
    v_mul_f32 v29, v53, v29
    v_mul_f32 v30, v54, v30
    v_mul_f32 v31, v55, v31
    v_cvt_pk_bf16_f32 v72, v24, v25
    v_cvt_pk_bf16_f32 v73, v26, v27
    v_cvt_pk_bf16_f32 v74, v28, v29
    v_cvt_pk_bf16_f32 v75, v30, v31
    v_mul_f32 v32, v48, v32
    v_mul_f32 v33, v49, v33
    v_mul_f32 v34, v50, v34
    v_mul_f32 v35, v51, v35
    v_mul_f32 v36, v52, v36
    v_mul_f32 v37, v53, v37
    v_mul_f32 v38, v54, v38
    v_mul_f32 v39, v55, v39
    v_cvt_pk_bf16_f32 v76, v32, v33
    v_cvt_pk_bf16_f32 v77, v34, v35
    v_cvt_pk_bf16_f32 v78, v36, v37
    v_cvt_pk_bf16_f32 v79, v38, v39
    s_lshr_b32 s65, s30, 27
    s_mov_b32 s66, 161536
    s_cmp_ge_u32 s65, 2
    s_cselect_b32 s66, 158112, s66
    s_mul_i32 s65, s65, 512
    s_add_u32 s65, s65, s66
    s_sub_u32 s65, s65, s29
    v_add_u32 v56, s65, v249
    s_lshr_b32 s65, s30, 27
    s_mov_b32 s66, 161536
    s_cmp_ge_u32 s65, 2
    s_cselect_b32 s66, 159008, s66
    s_mul_i32 s65, s65, 64
    s_add_u32 s65, s65, s66
    s_sub_u32 s65, s65, s29
    v_add_u32 v57, s65, v250
    ds_read_b64_tr_b16 v[20:21], v56 offset:0
    ds_read_b64_tr_b16 v[22:23], v56 offset:128
    ds_read_b128 v[24:27], v57 offset:0
    ds_read_b128 v[28:31], v57 offset:16
    ds_read_b128 v[32:35], v57 offset:384
    ds_read_b128 v[36:39], v57 offset:400
    s_waitcnt lgkmcnt(10)
    v_lshlrev_b32 v40, 16, v0
    v_and_b32 v41, 0xffff0000, v0
    v_lshlrev_b32 v42, 16, v1
    v_and_b32 v43, 0xffff0000, v1
    v_lshlrev_b32 v44, 16, v2
    v_and_b32 v45, 0xffff0000, v2
    v_lshlrev_b32 v46, 16, v3
    v_and_b32 v47, 0xffff0000, v3
    s_waitcnt lgkmcnt(8)
    v_mul_f32 v4, v40, v4
    v_mul_f32 v5, v41, v5
    v_mul_f32 v6, v42, v6
    v_mul_f32 v7, v43, v7
    v_mul_f32 v8, v44, v8
    v_mul_f32 v9, v45, v9
    v_mul_f32 v10, v46, v10
    v_mul_f32 v11, v47, v11
    v_cvt_pk_bf16_f32 v80, v4, v5
    v_cvt_pk_bf16_f32 v81, v6, v7
    v_cvt_pk_bf16_f32 v82, v8, v9
    v_cvt_pk_bf16_f32 v83, v10, v11
    s_waitcnt lgkmcnt(6)
    v_mul_f32 v12, v40, v12
    v_mul_f32 v13, v41, v13
    v_mul_f32 v14, v42, v14
    v_mul_f32 v15, v43, v15
    v_mul_f32 v16, v44, v16
    v_mul_f32 v17, v45, v17
    v_mul_f32 v18, v46, v18
    v_mul_f32 v19, v47, v19
    v_cvt_pk_bf16_f32 v84, v12, v13
    v_cvt_pk_bf16_f32 v85, v14, v15
    v_cvt_pk_bf16_f32 v86, v16, v17
    v_cvt_pk_bf16_f32 v87, v18, v19
    s_waitcnt lgkmcnt(4)
    v_lshlrev_b32 v48, 16, v20
    v_and_b32 v49, 0xffff0000, v20
    v_lshlrev_b32 v50, 16, v21
    v_and_b32 v51, 0xffff0000, v21
    v_lshlrev_b32 v52, 16, v22
    v_and_b32 v53, 0xffff0000, v22
    v_lshlrev_b32 v54, 16, v23
    v_and_b32 v55, 0xffff0000, v23
    s_waitcnt lgkmcnt(2)
    v_mul_f32 v24, v48, v24
    v_mul_f32 v25, v49, v25
    v_mul_f32 v26, v50, v26
    v_mul_f32 v27, v51, v27
    v_mul_f32 v28, v52, v28
    v_mul_f32 v29, v53, v29
    v_mul_f32 v30, v54, v30
    v_mul_f32 v31, v55, v31
    v_cvt_pk_bf16_f32 v88, v24, v25
    v_cvt_pk_bf16_f32 v89, v26, v27
    v_cvt_pk_bf16_f32 v90, v28, v29
    v_cvt_pk_bf16_f32 v91, v30, v31
    s_waitcnt lgkmcnt(0)
    v_mul_f32 v32, v48, v32
    v_mul_f32 v33, v49, v33
    v_mul_f32 v34, v50, v34
    v_mul_f32 v35, v51, v35
    v_mul_f32 v36, v52, v36
    v_mul_f32 v37, v53, v37
    v_mul_f32 v38, v54, v38
    v_mul_f32 v39, v55, v39
    v_cvt_pk_bf16_f32 v92, v32, v33
    v_cvt_pk_bf16_f32 v93, v34, v35
    v_cvt_pk_bf16_f32 v94, v36, v37
    v_cvt_pk_bf16_f32 v95, v38, v39
    s_waitcnt vmcnt(4)
    v_mfma_f32_32x32x16_bf16 v[0:15], v[64:67], v[176:179], 0
    ds_read_b64_tr_b16 v[184:185], v246 offset:2048
    ds_read_b64_tr_b16 v[186:187], v246 offset:2560
    ds_read_b64_tr_b16 v[188:189], v247 offset:2048
    ds_read_b64_tr_b16 v[190:191], v247 offset:2560
    s_mov_b32 m0, s68
    v_mfma_f32_32x32x16_bf16 v[16:31], v[68:71], v[176:179], 0
    buffer_load_dwordx4 v222, s[4:7], s41 offen sc1 lds
    buffer_load_dwordx4 v223, s[72:75], s41 offen offset:1024 sc1 lds
    v_permlane32_swap_b32 v242, v236
    v_permlane32_swap_b32 v243, v237
    v_mov_b32 v254, 163648
    v_mfma_f32_32x32x16_bf16 v[32:47], v[64:67], v[180:183], 0
    v_permlane32_swap_b32 v244, v238
    v_permlane32_swap_b32 v245, v239
    v_permlane32_swap_b32 v240, v241
    v_add_f32 v242, v242, v236
    v_mfma_f32_32x32x16_bf16 v[48:63], v[68:71], v[180:183], 0
    v_add_f32 v243, v243, v237
    v_add_f32 v244, v244, v238
    v_add_f32 v245, v245, v239
    v_add_f32 v240, -v240, -v241
    v_sub_u32 v241, v230, v231
    v_cvt_pk_bf16_f32 v242, v242, v243
    v_mov_b32 v255, 1
    v_lshl_add_u32 v233, v252, 1, s53
    s_mov_b64 exec, 1
    ds_add_rtn_u32 v232, v254, v255
    s_mov_b64 exec, -1
    ds_read_b32 v233, v233
    s_waitcnt vmcnt(4) lgkmcnt(2)
    v_mfma_f32_32x32x16_bf16 v[0:15], v[72:75], v[184:187], v[0:15]
    ds_read_b64_tr_b16 v[176:177], v246 offset:4096
    ds_read_b64_tr_b16 v[178:179], v246 offset:4608
    ds_read_b64_tr_b16 v[180:181], v247 offset:4096
    ds_read_b64_tr_b16 v[182:183], v247 offset:4608
    v_cvt_pk_bf16_f32 v244, v244, v245
    v_cvt_pk_bf16_f32 v240, v240, v240
    s_mov_b32 m0, s69
    v_mfma_f32_32x32x16_bf16 v[16:31], v[76:79], v[184:187], v[16:31]
    buffer_load_dwordx4 v224, s[4:7], s41 offen sc1 lds
    buffer_load_dwordx4 v225, s[72:75], s41 offen offset:1024 sc1 lds
    ds_write_b32 v230, v242 offset:768
    ds_write_b32 v230, v244 offset:1024
    ds_write_b16 v241, v240 offset:1280
    s_waitcnt lgkmcnt(7)
    v_readfirstlane_b32 s58, v232
    v_mfma_f32_32x32x16_bf16 v[32:47], v[72:75], v[188:191], v[32:47]
    s_cmp_lt_u32 s58, s22
    s_cbranch_scc0 K2_nul_81
    s_and_b32 s59, s58, 7
    s_lshr_b32 s60, s58, 3
K2_chk_83:
    v_readlane_b32 s61, v233, s59
    s_nop 0
    s_cmp_gt_u32 s61, s60
    s_cbranch_scc0 K2_spin_82
K2_back_84:
    v_mfma_f32_32x32x16_bf16 v[48:63], v[76:79], v[188:191], v[48:63]
    v_readlane_b32 s3, v253, s58
    s_lshl_b32 s44, s34, 7
    s_lshl_b32 s60, s58, 5
    s_and_b32 s48, s3, 0x3ffff
    s_bfe_u32 s33, s3, 0x30012
    s_sub_u32 s60, s60, s48
    s_waitcnt vmcnt(4) lgkmcnt(3)
    v_mfma_f32_32x32x16_bf16 v[0:15], v[80:83], v[176:179], v[0:15]
    ds_read_b64_tr_b16 v[184:185], v246 offset:6144
    ds_read_b64_tr_b16 v[186:187], v246 offset:6656
    ds_read_b64_tr_b16 v[188:189], v247 offset:6144
    ds_read_b64_tr_b16 v[190:191], v247 offset:6656
    s_and_b32 s60, s60, 0xff
    s_add_u32 s35, s60, s48
    s_mov_b32 m0, s70
    v_mfma_f32_32x32x16_bf16 v[16:31], v[84:87], v[176:179], v[16:31]
    buffer_load_dwordx4 v226, s[4:7], s41 offen sc1 lds
    buffer_load_dwordx4 v227, s[72:75], s41 offen offset:1024 sc1 lds
    s_mov_b32 s45, s44
    s_add_u32 s47, s44, 256
    s_add_u32 s49, s48, 32
    s_add_u32 s60, s48, 64
    v_mfma_f32_32x32x16_bf16 v[32:47], v[80:83], v[180:183], v[32:47]
    s_cmp_eq_u32 s33, 3
    s_cselect_b32 s46, s44, s47
    s_cselect_b32 s50, s60, s48
    s_cselect_b32 s51, s48, s49
    s_sub_u32 s60, s33, 2
    s_cmp_lt_u32 s60, 2
    s_cbranch_scc0 K2_rare_85
K2_back_86:
    v_mfma_f32_32x32x16_bf16 v[48:63], v[84:87], v[180:183], v[48:63]
    s_waitcnt vmcnt(4) lgkmcnt(0)
    v_mfma_f32_32x32x16_bf16 v[0:15], v[88:91], v[184:187], v[0:15]
    ds_read_b64_tr_b16 v[176:177], v246 offset:0
    ds_read_b64_tr_b16 v[178:179], v246 offset:512
    ds_read_b64_tr_b16 v[180:181], v247 offset:0
    ds_read_b64_tr_b16 v[182:183], v247 offset:512
    s_mov_b32 m0, s71
    v_mfma_f32_32x32x16_bf16 v[16:31], v[92:95], v[184:187], v[16:31]
    buffer_load_dwordx4 v228, s[4:7], s41 offen sc1 lds
    buffer_load_dwordx4 v229, s[72:75], s41 offen offset:1024 sc1 lds
    v_mfma_f32_32x32x16_bf16 v[32:47], v[88:91], v[188:191], v[32:47]
    s_nop 2
    v_mul_f32 v234, v0, v96
    v_mul_f32 v236, v8, v128
    v_fmac_f32 v234, v1, v97
    v_fmac_f32 v236, v9, v129
    v_fmac_f32 v234, v2, v98
    v_fmac_f32 v236, v10, v130
    v_fmac_f32 v234, v3, v99
    v_mfma_f32_32x32x16_bf16 v[48:63], v[92:95], v[188:191], v[48:63]
    s_setprio 0
    v_fmac_f32 v236, v11, v131
    v_fmac_f32 v234, v4, v100
    v_fmac_f32 v236, v12, v132
    v_fmac_f32 v234, v5, v101
    v_fmac_f32 v236, v13, v133
    v_fmac_f32 v234, v6, v102
    v_fmac_f32 v236, v14, v134
    v_fmac_f32 v234, v7, v103
    v_fmac_f32 v236, v15, v135
    v_mul_f32 v238, v16, v128
    v_mul_f32 v240, v24, v128
    v_fmac_f32 v238, v17, v129
    v_fmac_f32 v240, v25, v129
    v_fmac_f32 v238, v18, v130
    v_fmac_f32 v240, v26, v130
    v_fmac_f32 v238, v19, v131
    v_fmac_f32 v240, v27, v131
    v_fmac_f32 v238, v20, v132
    v_fmac_f32 v240, v28, v132
    v_fmac_f32 v238, v21, v133
    v_fmac_f32 v240, v29, v133
    v_fmac_f32 v238, v22, v134
    v_fmac_f32 v240, v30, v134
    v_fmac_f32 v238, v23, v135
    v_fmac_f32 v240, v31, v135
    v_mul_f32 v235, v32, v104
    v_mul_f32 v237, v40, v136
    v_fmac_f32 v235, v33, v105
    v_fmac_f32 v237, v41, v137
    v_fmac_f32 v235, v34, v106
    v_fmac_f32 v237, v42, v138
    v_fmac_f32 v235, v35, v107
    v_fmac_f32 v237, v43, v139
    v_fmac_f32 v235, v36, v108
    v_fmac_f32 v237, v44, v140
    v_fmac_f32 v235, v37, v109
    v_fmac_f32 v237, v45, v141
    v_fmac_f32 v235, v38, v110
    v_fmac_f32 v237, v46, v142
    v_fmac_f32 v235, v39, v111
    v_fmac_f32 v237, v47, v143
    v_mul_f32 v239, v48, v136
    v_mul_f32 v241, v56, v136
    s_setprio 1
    s_waitcnt vmcnt(4) lgkmcnt(0)
    v_mfma_f32_32x32x16_bf16 v[0:15], v[64:67], v[176:179], 0
    ds_read_b64_tr_b16 v[184:185], v246 offset:2048
    ds_read_b64_tr_b16 v[186:187], v246 offset:2560
    ds_read_b64_tr_b16 v[188:189], v247 offset:2048
    ds_read_b64_tr_b16 v[190:191], v247 offset:2560
    v_fmac_f32 v239, v49, v137
    v_fmac_f32 v241, v57, v137
    s_mov_b32 m0, s68
    v_mfma_f32_32x32x16_bf16 v[16:31], v[68:71], v[176:179], 0
    buffer_load_dwordx4 v222, s[4:7], s42 offen sc1 lds
    buffer_load_dwordx4 v223, s[72:75], s42 offen offset:1024 sc1 lds
    v_fmac_f32 v239, v50, v138
    v_fmac_f32 v241, v58, v138
    v_fmac_f32 v239, v51, v139
    v_fmac_f32 v241, v59, v139
    v_fmac_f32 v239, v52, v140
    v_mfma_f32_32x32x16_bf16 v[32:47], v[64:67], v[180:183], 0
    v_fmac_f32 v241, v60, v140
    v_fmac_f32 v239, v53, v141
    v_fmac_f32 v241, v61, v141
    v_fmac_f32 v239, v54, v142
    v_fmac_f32 v241, v62, v142
    v_fmac_f32 v239, v55, v143
    v_fmac_f32 v241, v63, v143
    v_mfma_f32_32x32x16_bf16 v[48:63], v[68:71], v[180:183], 0
    v_permlane32_swap_b32 v234, v236
    v_permlane32_swap_b32 v235, v237
    v_permlane32_swap_b32 v240, v238
    s_waitcnt vmcnt(4) lgkmcnt(0)
    v_mfma_f32_32x32x16_bf16 v[0:15], v[72:75], v[184:187], v[0:15]
    ds_read_b64_tr_b16 v[176:177], v246 offset:4096
    ds_read_b64_tr_b16 v[178:179], v246 offset:4608
    ds_read_b64_tr_b16 v[180:181], v247 offset:4096
    ds_read_b64_tr_b16 v[182:183], v247 offset:4608
    v_permlane32_swap_b32 v241, v239
    s_mov_b32 m0, s69
    v_mfma_f32_32x32x16_bf16 v[16:31], v[76:79], v[184:187], v[16:31]
    buffer_load_dwordx4 v224, s[4:7], s42 offen sc1 lds
    buffer_load_dwordx4 v225, s[72:75], s42 offen offset:1024 sc1 lds
    v_lshl_add_u32 v230, v252, 1, s31
    v_add_f32 v234, v234, v236
    v_add_f32 v235, v235, v237
    v_add_f32 v240, v240, v238
    v_add_f32 v241, v241, v239
    v_mfma_f32_32x32x16_bf16 v[32:47], v[72:75], v[188:191], v[32:47]
    v_cvt_pk_bf16_f32 v234, v234, v235
    v_cvt_pk_bf16_f32 v240, v240, v241
    ds_write_b32 v230, v234 offset:0
    ds_write_b32 v230, v240 offset:256
    v_mfma_f32_32x32x16_bf16 v[48:63], v[76:79], v[188:191], v[48:63]
    s_waitcnt vmcnt(4) lgkmcnt(2)
    v_mfma_f32_32x32x16_bf16 v[0:15], v[80:83], v[176:179], v[0:15]
    ds_read_b64_tr_b16 v[184:185], v246 offset:6144
    ds_read_b64_tr_b16 v[186:187], v246 offset:6656
    ds_read_b64_tr_b16 v[188:189], v247 offset:6144
    ds_read_b64_tr_b16 v[190:191], v247 offset:6656
    s_mov_b32 m0, s70
    v_mfma_f32_32x32x16_bf16 v[16:31], v[84:87], v[176:179], v[16:31]
    buffer_load_dwordx4 v226, s[4:7], s42 offen sc1 lds
    buffer_load_dwordx4 v227, s[72:75], s42 offen offset:1024 sc1 lds
    v_mfma_f32_32x32x16_bf16 v[32:47], v[80:83], v[180:183], v[32:47]
    v_mfma_f32_32x32x16_bf16 v[48:63], v[84:87], v[180:183], v[48:63]
    s_waitcnt vmcnt(4) lgkmcnt(0)
    v_mfma_f32_32x32x16_bf16 v[0:15], v[88:91], v[184:187], v[0:15]
    ds_read_b64_tr_b16 v[176:177], v246 offset:0
    ds_read_b64_tr_b16 v[178:179], v246 offset:512
    ds_read_b64_tr_b16 v[180:181], v247 offset:0
    ds_read_b64_tr_b16 v[182:183], v247 offset:512
    s_mov_b32 m0, s71
    v_mfma_f32_32x32x16_bf16 v[16:31], v[92:95], v[184:187], v[16:31]
    buffer_load_dwordx4 v228, s[4:7], s42 offen sc1 lds
    buffer_load_dwordx4 v229, s[72:75], s42 offen offset:1024 sc1 lds
    v_mfma_f32_32x32x16_bf16 v[32:47], v[88:91], v[188:191], v[32:47]
    s_nop 2
    v_mul_f32 v234, v0, v144
    v_mul_f32 v236, v8, v112
    v_fmac_f32 v234, v1, v145
    v_fmac_f32 v236, v9, v113
    v_fmac_f32 v234, v2, v146
    v_fmac_f32 v236, v10, v114
    v_fmac_f32 v234, v3, v147
    v_mfma_f32_32x32x16_bf16 v[48:63], v[92:95], v[188:191], v[48:63]
    s_setprio 0
    v_fmac_f32 v236, v11, v115
    v_fmac_f32 v234, v4, v148
    v_fmac_f32 v236, v12, v116
    v_fmac_f32 v234, v5, v149
    v_fmac_f32 v236, v13, v117
    v_fmac_f32 v234, v6, v150
    v_fmac_f32 v236, v14, v118
    v_fmac_f32 v234, v7, v151
    v_fmac_f32 v236, v15, v119
    v_mul_f32 v238, v16, v160
    v_mul_f32 v240, v24, v160
    v_fmac_f32 v238, v17, v161
    v_fmac_f32 v240, v25, v161
    v_fmac_f32 v238, v18, v162
    v_fmac_f32 v240, v26, v162
    v_fmac_f32 v238, v19, v163
    v_fmac_f32 v240, v27, v163
    v_fmac_f32 v238, v20, v164
    v_fmac_f32 v240, v28, v164
    v_fmac_f32 v238, v21, v165
    v_fmac_f32 v240, v29, v165
    v_fmac_f32 v238, v22, v166
    v_fmac_f32 v240, v30, v166
    v_fmac_f32 v238, v23, v167
    v_fmac_f32 v240, v31, v167
    v_mul_f32 v235, v32, v152
    v_mul_f32 v237, v40, v120
    v_fmac_f32 v235, v33, v153
    v_fmac_f32 v237, v41, v121
    v_fmac_f32 v235, v34, v154
    v_fmac_f32 v237, v42, v122
    v_fmac_f32 v235, v35, v155
    v_fmac_f32 v237, v43, v123
    v_fmac_f32 v235, v36, v156
    v_fmac_f32 v237, v44, v124
    v_fmac_f32 v235, v37, v157
    v_fmac_f32 v237, v45, v125
    v_fmac_f32 v235, v38, v158
    v_fmac_f32 v237, v46, v126
    v_fmac_f32 v235, v39, v159
    v_fmac_f32 v237, v47, v127
    v_mul_f32 v239, v48, v168
    v_mul_f32 v241, v56, v168
    s_setprio 1
    s_waitcnt vmcnt(4) lgkmcnt(0)
    v_mfma_f32_32x32x16_bf16 v[0:15], v[64:67], v[176:179], 0
    ds_read_b64_tr_b16 v[184:185], v246 offset:2048
    ds_read_b64_tr_b16 v[186:187], v246 offset:2560
    ds_read_b64_tr_b16 v[188:189], v247 offset:2048
    ds_read_b64_tr_b16 v[190:191], v247 offset:2560
    v_fmac_f32 v239, v49, v169
    v_fmac_f32 v241, v57, v169
    s_mov_b32 m0, s68
    v_mfma_f32_32x32x16_bf16 v[16:31], v[68:71], v[176:179], 0
    buffer_load_dwordx4 v222, s[4:7], s43 offen sc1 lds
    buffer_load_dwordx4 v223, s[72:75], s43 offen offset:1024 sc1 lds
    v_fmac_f32 v239, v50, v170
    v_fmac_f32 v241, v58, v170
    v_fmac_f32 v239, v51, v171
    v_fmac_f32 v241, v59, v171
    v_fmac_f32 v239, v52, v172
    v_mfma_f32_32x32x16_bf16 v[32:47], v[64:67], v[180:183], 0
    v_fmac_f32 v241, v60, v172
    v_fmac_f32 v239, v53, v173
    v_fmac_f32 v241, v61, v173
    v_fmac_f32 v239, v54, v174
    v_fmac_f32 v241, v62, v174
    v_fmac_f32 v239, v55, v175
    v_fmac_f32 v241, v63, v175
    v_mfma_f32_32x32x16_bf16 v[48:63], v[68:71], v[180:183], 0
    s_waitcnt vmcnt(4) lgkmcnt(0)
    v_mfma_f32_32x32x16_bf16 v[0:15], v[72:75], v[184:187], v[0:15]
    ds_read_b64_tr_b16 v[176:177], v246 offset:4096
    ds_read_b64_tr_b16 v[178:179], v246 offset:4608
    ds_read_b64_tr_b16 v[180:181], v247 offset:4096
    ds_read_b64_tr_b16 v[182:183], v247 offset:4608
    s_mov_b32 m0, s69
    v_mfma_f32_32x32x16_bf16 v[16:31], v[76:79], v[184:187], v[16:31]
    buffer_load_dwordx4 v224, s[4:7], s43 offen sc1 lds
    buffer_load_dwordx4 v225, s[72:75], s43 offen offset:1024 sc1 lds
    v_mfma_f32_32x32x16_bf16 v[32:47], v[72:75], v[188:191], v[32:47]
    v_mfma_f32_32x32x16_bf16 v[48:63], v[76:79], v[188:191], v[48:63]
    s_waitcnt vmcnt(4) lgkmcnt(0)
    v_mfma_f32_32x32x16_bf16 v[0:15], v[80:83], v[176:179], v[0:15]
    ds_read_b64_tr_b16 v[184:185], v246 offset:6144
    ds_read_b64_tr_b16 v[186:187], v246 offset:6656
    ds_read_b64_tr_b16 v[188:189], v247 offset:6144
    ds_read_b64_tr_b16 v[190:191], v247 offset:6656
    s_mov_b32 m0, s70
    v_mfma_f32_32x32x16_bf16 v[16:31], v[84:87], v[176:179], v[16:31]
    buffer_load_dwordx4 v226, s[4:7], s43 offen sc1 lds
    buffer_load_dwordx4 v227, s[72:75], s43 offen offset:1024 sc1 lds
    v_mfma_f32_32x32x16_bf16 v[32:47], v[80:83], v[180:183], v[32:47]
    v_add_u32 v222, s48, v251
    ds_read_b32 v222, v222
    v_mfma_f32_32x32x16_bf16 v[48:63], v[84:87], v[180:183], v[48:63]
    s_waitcnt vmcnt(4) lgkmcnt(1)
    v_mfma_f32_32x32x16_bf16 v[0:15], v[88:91], v[184:187], v[0:15]
    ds_read_b64_tr_b16 v[176:177], v246 offset:0
    ds_read_b64_tr_b16 v[178:179], v246 offset:512
    ds_read_b64_tr_b16 v[180:181], v247 offset:0
    ds_read_b64_tr_b16 v[182:183], v247 offset:512
    s_mov_b32 m0, s71
    v_mfma_f32_32x32x16_bf16 v[16:31], v[92:95], v[184:187], v[16:31]
    buffer_load_dwordx4 v228, s[4:7], s43 offen sc1 lds
    buffer_load_dwordx4 v229, s[72:75], s43 offen offset:1024 sc1 lds
    s_waitcnt lgkmcnt(4)
    v_mad_u32_u16 v223, v222, s39, v248 op_sel:[1,0,0,0]
    v_mad_u32_u16 v222, v222, s39, v248
    v_mfma_f32_32x32x16_bf16 v[32:47], v[88:91], v[188:191], v[32:47]
    v_add_u32 v224, s49, v251
    ds_read_b32 v224, v224
    v_mul_f32 v242, v0, v144
    v_fma_f32 v238, v8, v160, -v238
    v_fmac_f32 v242, v1, v145
    v_fmac_f32 v238, v9, v161
    v_fmac_f32 v242, v2, v146
    v_mfma_f32_32x32x16_bf16 v[48:63], v[92:95], v[188:191], v[48:63]
    s_setprio 0
    v_fmac_f32 v238, v10, v162
    v_fmac_f32 v242, v3, v147
    v_fmac_f32 v238, v11, v163
    v_fmac_f32 v242, v4, v148
    v_fmac_f32 v238, v12, v164
    v_fmac_f32 v242, v5, v149
    v_fmac_f32 v238, v13, v165
    v_fmac_f32 v242, v6, v150
    v_fmac_f32 v238, v14, v166
    v_fmac_f32 v242, v7, v151
    v_fmac_f32 v238, v15, v167
    v_fmac_f32 v236, v16, v112
    v_mul_f32 v244, v24, v160
    v_fmac_f32 v236, v17, v113
    v_fmac_f32 v244, v25, v161
    v_fmac_f32 v236, v18, v114
    v_fmac_f32 v244, v26, v162
    v_fmac_f32 v236, v19, v115
    v_fmac_f32 v244, v27, v163
    v_fmac_f32 v236, v20, v116
    v_fmac_f32 v244, v28, v164
    v_fmac_f32 v236, v21, v117
    v_fmac_f32 v244, v29, v165
    v_fmac_f32 v236, v22, v118
    v_fmac_f32 v244, v30, v166
    v_fmac_f32 v236, v23, v119
    v_fmac_f32 v244, v31, v167
    v_mul_f32 v243, v32, v152
    v_fma_f32 v239, v40, v168, -v239
    v_fmac_f32 v243, v33, v153
    v_fmac_f32 v239, v41, v169
    v_fmac_f32 v243, v34, v154
    v_fmac_f32 v239, v42, v170
    v_fmac_f32 v243, v35, v155
    v_fmac_f32 v239, v43, v171
    v_fmac_f32 v243, v36, v156
    v_fmac_f32 v239, v44, v172
    v_fmac_f32 v243, v37, v157
    v_fmac_f32 v239, v45, v173
    v_fmac_f32 v243, v38, v158
    v_fmac_f32 v239, v46, v174
    v_fmac_f32 v243, v39, v159
    v_fmac_f32 v239, v47, v175
    v_fmac_f32 v237, v48, v120
    v_mul_f32 v245, v56, v168
    v_fmac_f32 v237, v49, v121
    v_fmac_f32 v245, v57, v169
    v_fmac_f32 v237, v50, v122
    v_fmac_f32 v245, v58, v170
    v_fmac_f32 v237, v51, v123
    s_setprio 1
    s_waitcnt vmcnt(4) lgkmcnt(1)
    v_mfma_f32_32x32x16_bf16 v[0:15], v[64:67], v[176:179], 0
    ds_read_b64_tr_b16 v[184:185], v246 offset:2048
    ds_read_b64_tr_b16 v[186:187], v246 offset:2560
    ds_read_b64_tr_b16 v[188:189], v247 offset:2048
    ds_read_b64_tr_b16 v[190:191], v247 offset:2560
    v_fmac_f32 v245, v59, v171
    v_fmac_f32 v237, v52, v124
    s_mov_b32 m0, s68
    v_mfma_f32_32x32x16_bf16 v[16:31], v[68:71], v[176:179], 0
    buffer_load_dwordx4 v222, s[4:7], s44 offen sc1 lds
    buffer_load_dwordx4 v223, s[72:75], s44 offen offset:1024 sc1 lds
    s_waitcnt lgkmcnt(4)
    v_mad_u32_u16 v225, v224, s39, v248 op_sel:[1,0,0,0]
    v_mad_u32_u16 v224, v224, s39, v248
    v_fmac_f32 v245, v60, v172
    v_fmac_f32 v237, v53, v125
    v_mfma_f32_32x32x16_bf16 v[32:47], v[64:67], v[180:183], 0
    v_add_u32 v226, s50, v251
    ds_read_b32 v226, v226
    v_fmac_f32 v245, v61, v173
    v_fmac_f32 v237, v54, v126
    v_fmac_f32 v245, v62, v174
    v_fmac_f32 v237, v55, v127
    v_fmac_f32 v245, v63, v175
    v_mfma_f32_32x32x16_bf16 v[48:63], v[68:71], v[180:183], 0
    v_permlane32_swap_b32 v242, v234
    v_permlane32_swap_b32 v243, v235
    v_add_f32 v242, v242, v234
    v_add_f32 v243, v243, v235
    s_waitcnt vmcnt(4) lgkmcnt(1)
    v_mfma_f32_32x32x16_bf16 v[0:15], v[72:75], v[184:187], v[0:15]
    ds_read_b64_tr_b16 v[176:177], v246 offset:4096
    ds_read_b64_tr_b16 v[178:179], v246 offset:4608
    ds_read_b64_tr_b16 v[180:181], v247 offset:4096
    ds_read_b64_tr_b16 v[182:183], v247 offset:4608
    v_cvt_pk_bf16_f32 v242, v242, v243
    ds_write_b32 v230, v242 offset:512
    s_mov_b32 m0, s69
    v_mfma_f32_32x32x16_bf16 v[16:31], v[76:79], v[184:187], v[16:31]
    buffer_load_dwordx4 v224, s[4:7], s45 offen sc1 lds
    buffer_load_dwordx4 v225, s[72:75], s45 offen offset:1024 sc1 lds
    s_waitcnt lgkmcnt(5)
    v_mad_u32_u16 v227, v226, s39, v248 op_sel:[1,0,0,0]
    v_mad_u32_u16 v226, v226, s39, v248
    v_mfma_f32_32x32x16_bf16 v[32:47], v[72:75], v[188:191], v[32:47]
    v_add_u32 v228, s51, v251
    ds_read_b32 v228, v228
    v_mfma_f32_32x32x16_bf16 v[48:63], v[76:79], v[188:191], v[48:63]
    s_waitcnt vmcnt(4) lgkmcnt(2)
    v_mfma_f32_32x32x16_bf16 v[0:15], v[80:83], v[176:179], v[0:15]
    ds_read_b64_tr_b16 v[184:185], v246 offset:6144
    ds_read_b64_tr_b16 v[186:187], v246 offset:6656
    ds_read_b64_tr_b16 v[188:189], v247 offset:6144
    ds_read_b64_tr_b16 v[190:191], v247 offset:6656
    s_mov_b32 s32, s31
    s_mov_b32 s31, s35
    s_mov_b32 m0, s70
    v_mfma_f32_32x32x16_bf16 v[16:31], v[84:87], v[176:179], v[16:31]
    buffer_load_dwordx4 v226, s[4:7], s46 offen sc1 lds
    buffer_load_dwordx4 v227, s[72:75], s46 offen offset:1024 sc1 lds
    s_waitcnt lgkmcnt(4)
    v_mad_u32_u16 v229, v228, s39, v248 op_sel:[1,0,0,0]
    v_mad_u32_u16 v228, v228, s39, v248
    s_sub_u32 s26, s48, s29
    s_mov_b32 s29, s48
    v_mfma_f32_32x32x16_bf16 v[32:47], v[80:83], v[180:183], v[32:47]
    s_mov_b32 s30, s3
    s_cmp_lg_u32 s36, 0
    s_cselect_b32 s56, s33, 0
    v_mfma_f32_32x32x16_bf16 v[48:63], v[84:87], v[180:183], v[48:63]
    s_waitcnt vmcnt(4) lgkmcnt(0)
    v_mfma_f32_32x32x16_bf16 v[0:15], v[88:91], v[184:187], v[0:15]
    ds_read_b64_tr_b16 v[176:177], v246 offset:0
    ds_read_b64_tr_b16 v[178:179], v246 offset:512
    ds_read_b64_tr_b16 v[180:181], v247 offset:0
    ds_read_b64_tr_b16 v[182:183], v247 offset:512
    s_mov_b32 m0, s71
    v_mfma_f32_32x32x16_bf16 v[16:31], v[92:95], v[184:187], v[16:31]
    buffer_load_dwordx4 v228, s[4:7], s47 offen sc1 lds
    buffer_load_dwordx4 v229, s[72:75], s47 offen offset:1024 sc1 lds
    v_mfma_f32_32x32x16_bf16 v[32:47], v[88:91], v[188:191], v[32:47]
    s_nop 2
    v_mul_f32 v242, v0, v144
    v_fma_f32 v240, v8, v160, -v240
    v_fmac_f32 v242, v1, v145
    v_fmac_f32 v240, v9, v161
    v_fmac_f32 v242, v2, v146
    v_fmac_f32 v240, v10, v162
    v_fmac_f32 v242, v3, v147
    v_mfma_f32_32x32x16_bf16 v[48:63], v[92:95], v[188:191], v[48:63]
    s_setprio 0
    v_fmac_f32 v240, v11, v163
    v_fmac_f32 v242, v4, v148
    v_fmac_f32 v240, v12, v164
    v_fmac_f32 v242, v5, v149
    v_fmac_f32 v240, v13, v165
    v_fmac_f32 v242, v6, v150
    v_fmac_f32 v240, v14, v166
    v_fmac_f32 v242, v7, v151
    v_fmac_f32 v240, v15, v167
    v_add_u32 v249, s26, v249
    v_add_u32 v250, s26, v250
    v_fma_f32 v244, v16, v160, -v244
    v_fmac_f32 v236, v24, v112
    v_fmac_f32 v244, v17, v161
    v_fmac_f32 v236, v25, v113
    v_fmac_f32 v244, v18, v162
    v_fmac_f32 v236, v26, v114
    v_fmac_f32 v244, v19, v163
    v_fmac_f32 v236, v27, v115
    v_fmac_f32 v244, v20, v164
    v_fmac_f32 v236, v28, v116
    v_fmac_f32 v244, v21, v165
    v_fmac_f32 v236, v29, v117
    v_fmac_f32 v244, v22, v166
    v_fmac_f32 v236, v30, v118
    v_fmac_f32 v244, v23, v167
    v_fmac_f32 v236, v31, v119
    ds_read_b64_tr_b16 v[0:1], v249 offset:0
    ds_read_b64_tr_b16 v[2:3], v249 offset:128
    ds_read_b128 v[4:7], v250 offset:0
    ds_read_b128 v[8:11], v250 offset:16
    ds_read_b128 v[12:15], v250 offset:384
    ds_read_b128 v[16:19], v250 offset:400
    v_mul_f32 v243, v32, v152
    v_fma_f32 v241, v40, v168, -v241
    v_fmac_f32 v243, v33, v153
    v_fmac_f32 v241, v41, v169
    v_fmac_f32 v243, v34, v154
    v_fmac_f32 v241, v42, v170
    v_fmac_f32 v243, v35, v155
    v_fmac_f32 v241, v43, v171
    v_fmac_f32 v243, v36, v156
    v_fmac_f32 v241, v44, v172
    v_fmac_f32 v243, v37, v157
    v_fmac_f32 v241, v45, v173
    v_fmac_f32 v243, v38, v158
    v_fmac_f32 v241, v46, v174
    v_fmac_f32 v243, v39, v159
    v_fmac_f32 v241, v47, v175
    ds_read_b64_tr_b16 v[20:21], v249 offset:512
    ds_read_b64_tr_b16 v[22:23], v249 offset:640
    ds_read_b128 v[24:27], v250 offset:64
    ds_read_b128 v[28:31], v250 offset:80
    ds_read_b128 v[32:35], v250 offset:448
    ds_read_b128 v[36:39], v250 offset:464
    v_fma_f32 v245, v48, v168, -v245
    v_fmac_f32 v237, v56, v120
    v_fmac_f32 v245, v49, v169
    v_fmac_f32 v237, v57, v121
    v_fmac_f32 v245, v50, v170
    v_fmac_f32 v237, v58, v122
    v_fmac_f32 v245, v51, v171
    v_fmac_f32 v237, v59, v123
    v_fmac_f32 v245, v52, v172
    v_fmac_f32 v237, v60, v124
    v_fmac_f32 v245, v53, v173
    v_fmac_f32 v237, v61, v125
    v_fmac_f32 v245, v54, v174
    v_fmac_f32 v237, v62, v126
    v_fmac_f32 v245, v55, v175
    v_fmac_f32 v237, v63, v127
    s_cmp_eq_u32 s56, 2
    s_cbranch_scc1 K2_U21
    s_cmp_eq_u32 s56, 3
    s_cbranch_scc1 K2_U31
    s_branch K2_DSP1
K2_nul_50:
    s_mov_b32 s58, 63
    s_mov_b32 s36, 0
    s_branch K2_back_53
K2_spin_51:
    s_sub_u32 s27, s27, 1
    s_cbranch_scc1 K2_END
    v_lshl_add_u32 v233, v252, 1, s53
    ds_read_b32 v233, v233
    s_waitcnt lgkmcnt(0)
    s_branch K2_chk_52
K2_dyn_48:
    v_mov_b32 v254, 163648
    v_mov_b32 v255, 1
    v_lshl_add_u32 v233, v252, 1, s53
    s_mov_b64 exec, 1
    ds_add_rtn_u32 v232, v254, v255
    s_mov_b64 exec, -1
    ds_read_b32 v233, v233
    s_waitcnt lgkmcnt(0)
    v_readfirstlane_b32 s58, v232
    s_nop 0
    s_cmp_lt_u32 s58, s22
    s_cbranch_scc0 K2_nul_50
    s_and_b32 s59, s58, 7
    s_lshr_b32 s60, s58, 3
K2_chk_52:
    v_readlane_b32 s61, v233, s59
    s_nop 0
    s_cmp_gt_u32 s61, s60
    s_cbranch_scc0 K2_spin_51
K2_back_53:
    s_mov_b32 s34, 1
    s_branch K2_back_49
K2_rare_54:
    s_cmp_eq_u32 s33, 4
    s_cbranch_scc1 K2_four_56
    s_mov_b32 s49, s48
    s_mov_b32 s51, s48
    s_add_u32 s45, s44, 256
    s_add_u32 s46, s44, 512
    s_add_u32 s47, s44, 768
    s_branch K2_back_55
K2_four_56:
    s_add_u32 s50, s48, 64
    s_lshr_b32 s51, s3, 27
    s_mov_b32 s66, 161536
    s_cmp_ge_u32 s51, 2
    s_cselect_b32 s66, 159072, s66
    s_mul_i32 s51, s51, 32
    s_add_u32 s51, s51, s66
    s_mov_b32 s46, s44
    s_mov_b32 s47, s44
    s_branch K2_back_55
K2_dum_57:
    v_mov_b32 v232, -1
    s_mov_b32 m0, 163712
    s_mov_b64 exec, 1
    buffer_load_dwordx4 v232, s[16:19], 0 offen lds
    buffer_load_dwordx4 v232, s[16:19], 0 offen lds
    s_mov_b64 exec, -1
    s_branch K2_back_59
K2_a4_58:
    s_lshr_b32 s65, s3, 27
    s_mov_b32 s66, 161536
    s_cmp_ge_u32 s65, 2
    s_cselect_b32 s66, 158112, s66
    s_mul_i32 s65, s65, 512
    s_add_u32 s65, s65, s66
    v_add_u32 v232, s65, v230
    ds_read_b32 v232, v232
    s_add_u32 m0, s65, 864
    s_waitcnt lgkmcnt(0)
    v_or_b32 v232, v232, v231
    buffer_load_dwordx4 v232, s[16:19], 0 offen  lds
    s_branch K2_b4_60
K2_nul_63:
    s_mov_b32 s58, 63
    s_mov_b32 s36, 0
    s_branch K2_back_66
K2_spin_64:
    s_sub_u32 s27, s27, 1
    s_cbranch_scc1 K2_END
    v_lshl_add_u32 v233, v252, 1, s53
    ds_read_b32 v233, v233
    s_waitcnt lgkmcnt(0)
    s_branch K2_chk_65
K2_dyn_61:
    v_mov_b32 v254, 163648
    v_mov_b32 v255, 1
    v_lshl_add_u32 v233, v252, 1, s53
    s_mov_b64 exec, 1
    ds_add_rtn_u32 v232, v254, v255
    s_mov_b64 exec, -1
    ds_read_b32 v233, v233
    s_waitcnt lgkmcnt(0)
    v_readfirstlane_b32 s58, v232
    s_nop 0
    s_cmp_lt_u32 s58, s22
    s_cbranch_scc0 K2_nul_63
    s_and_b32 s59, s58, 7
    s_lshr_b32 s60, s58, 3
K2_chk_65:
    v_readlane_b32 s61, v233, s59
    s_nop 0
    s_cmp_gt_u32 s61, s60
    s_cbranch_scc0 K2_spin_64
K2_back_66:
    s_mov_b32 s34, 1
    s_branch K2_back_62
K2_rare_67:
    s_cmp_eq_u32 s33, 4
    s_cbranch_scc1 K2_four_69
    s_mov_b32 s49, s48
    s_mov_b32 s51, s48
    s_add_u32 s45, s44, 256
    s_add_u32 s46, s44, 512
    s_add_u32 s47, s44, 768
    s_branch K2_back_68
K2_four_69:
    s_add_u32 s50, s48, 64
    s_lshr_b32 s51, s3, 27
    s_mov_b32 s66, 161536
    s_cmp_ge_u32 s51, 2
    s_cselect_b32 s66, 159072, s66
    s_mul_i32 s51, s51, 32
    s_add_u32 s51, s51, s66
    s_mov_b32 s46, s44
    s_mov_b32 s47, s44
    s_branch K2_back_68
K2_dum_70:
    v_mov_b32 v232, -1
    s_mov_b32 m0, 163712
    s_mov_b64 exec, 1
    buffer_load_dwordx4 v232, s[16:19], 0 offen lds
    buffer_load_dwordx4 v232, s[16:19], 0 offen lds
    s_mov_b64 exec, -1
    s_branch K2_back_72
K2_a4_71:
    s_lshr_b32 s65, s3, 27
    s_mov_b32 s66, 161536
    s_cmp_ge_u32 s65, 2
    s_cselect_b32 s66, 158112, s66
    s_mul_i32 s65, s65, 512
    s_add_u32 s65, s65, s66
    v_add_u32 v232, s65, v230
    ds_read_b32 v232, v232
    s_add_u32 m0, s65, 864
    s_waitcnt lgkmcnt(0)
    v_or_b32 v232, v232, v231
    buffer_load_dwordx4 v232, s[16:19], 0 offen  lds
    s_branch K2_b4_73
K2_nul_74:
    s_mov_b32 s58, 63
    s_mov_b32 s36, 0
    s_branch K2_back_77
K2_spin_75:
    s_sub_u32 s27, s27, 1
    s_cbranch_scc1 K2_END
    v_lshl_add_u32 v233, v252, 1, s53
    ds_read_b32 v233, v233
    s_waitcnt lgkmcnt(0)
    s_branch K2_chk_76
K2_rare_78:
    s_cmp_eq_u32 s33, 4
    s_cbranch_scc1 K2_four_80
    s_mov_b32 s49, s48
    s_mov_b32 s51, s48
    s_add_u32 s45, s44, 256
    s_add_u32 s46, s44, 512
    s_add_u32 s47, s44, 768
    s_branch K2_back_79
K2_four_80:
    s_add_u32 s50, s48, 64
    s_lshr_b32 s51, s3, 27
    s_mov_b32 s66, 161536
    s_cmp_ge_u32 s51, 2
    s_cselect_b32 s66, 159072, s66
    s_mul_i32 s51, s51, 32
    s_add_u32 s51, s51, s66
    s_mov_b32 s46, s44
    s_mov_b32 s47, s44
    s_branch K2_back_79
K2_nul_81:
    s_mov_b32 s58, 63
    s_mov_b32 s36, 0
    s_branch K2_back_84
K2_spin_82:
    s_sub_u32 s27, s27, 1
    s_cbranch_scc1 K2_END
    v_lshl_add_u32 v233, v252, 1, s53
    ds_read_b32 v233, v233
    s_waitcnt lgkmcnt(0)
    s_branch K2_chk_83
K2_rare_85:
    s_cmp_eq_u32 s33, 4
    s_cbranch_scc1 K2_four_87
    s_mov_b32 s49, s48
    s_mov_b32 s51, s48
    s_add_u32 s45, s44, 256
    s_add_u32 s46, s44, 512
    s_add_u32 s47, s44, 768
    s_branch K2_back_86
K2_four_87:
    s_add_u32 s50, s48, 64
    s_lshr_b32 s51, s3, 27
    s_mov_b32 s66, 161536
    s_cmp_ge_u32 s51, 2
    s_cselect_b32 s66, 159072, s66
    s_mul_i32 s51, s51, 32
    s_add_u32 s51, s51, s66
    s_mov_b32 s46, s44
    s_mov_b32 s47, s44
    s_branch K2_back_86
K2_END:
    s_endpgm
.section .rodata,"a"
.p2align 6
.amdhsa_kernel standalone__tensor_product_equiv_equiformer__graph_kernel
  .amdhsa_next_free_vgpr 256
  .amdhsa_next_free_sgpr 102
  .amdhsa_accum_offset 256
  .amdhsa_group_segment_fixed_size 0
  .amdhsa_kernarg_size 96
  .amdhsa_user_sgpr_count 2
  .amdhsa_user_sgpr_kernarg_segment_ptr 1
  .amdhsa_system_sgpr_workgroup_id_x 1
  .amdhsa_float_denorm_mode_32 3
.end_amdhsa_kernel
```

```asm
; @launch grid=(256,1,1) block=(512,1,1) lds=163840
.amdgcn_target "amdgcn-amd-amdhsa--gfx950"
.text
.globl standalone__tensor_product_equiv_equiformer__graph_kernel
.p2align 8
.type standalone__tensor_product_equiv_equiformer__graph_kernel,@function
standalone__tensor_product_equiv_equiformer__graph_kernel:
    s_cmp_ge_u32 s2, 256
    s_cbranch_scc1 K2_END
    s_load_dwordx16 s[80:95], s[0:1], 0
    s_load_dwordx4 s[96:99], s[0:1], 72
    s_load_dwordx2 s[100:101], s[0:1], 88
    s_memrealtime s[74:75]
    v_lshrrev_b32 v1, 6, v0
    s_mov_b32 s54, s2
    v_readfirstlane_b32 s20, v1
    s_mov_b64 exec, 0
    s_cmp_eq_u32 s20, 0
    s_cbranch_scc1 K2_PAD_S1
    s_cmp_eq_u32 s20, 1
    s_cbranch_scc1 K2_PAD_S2
    s_cmp_eq_u32 s20, 5
    s_cbranch_scc1 K2_PAD_H1
    s_cmp_eq_u32 s20, 6
    s_cbranch_scc1 K2_PAD_H2
    s_cmp_eq_u32 s20, 2
    s_cbranch_scc1 K2_PAD_H3
KS_HOP0:
    s_mov_b64 exec, -1
    v_and_b32 v8, 63, v0
    v_lshlrev_b32 v9, 4, v8
    v_mov_b32 v6, 0
    v_lshlrev_b32 v5, 4, v0
    v_mul_u32_u24 v4, 24, v0
    s_mul_i32 s64, s2, 5120
    s_mul_i32 s65, s2, 7680
    v_mov_b32 v176, v8
    v_mov_b32 v177, v0
    s_mul_i32 s21, s2, 625
    s_add_u32 s22, s21, 640
    s_add_u32 s21, s21, 15
    s_lshr_b32 s21, s21, 4
    s_lshr_b32 s22, s22, 4
    s_sub_u32 s22, s22, s21
    s_movk_i32 s39, 1024
    s_lshl_b32 s37, s20, 13
    s_mov_b32 s53, 163616
    s_lshl_b32 s52, s20, 2
    s_add_u32 s52, s52, s53
    s_add_u32 s68, s37, 0
    s_add_u32 s69, s37, 2048
    s_add_u32 s70, s37, 4096
    s_add_u32 s71, s37, 6144
    s_waitcnt lgkmcnt(0)
    s_mov_b32 s8, s100
    s_and_b32 s9, s101, 0xffff
    s_mov_b32 s10, 37748736
    s_mov_b32 s11, 0x20000
    s_cmp_lg_u32 s20, 7
    s_cbranch_scc1 KS_NOTAG
    s_mov_b32 s60, s98
    s_and_b32 s61, s99, 0xffff
    s_mov_b32 s62, 256
    s_mov_b32 s63, 0x20000
    s_cmp_lg_u32 s2, 0
    s_cbranch_scc1 KS_TAGLD
    s_or_b32 s24, s74, 1
    v_mov_b32 v10, s24
    v_mov_b32 v11, 0
    s_mov_b64 exec, 1
    buffer_atomic_cmpswap v[10:11], v6, s[60:63], 0 offen sc1
    s_mov_b64 exec, -1
KS_TAGLD:
    v_mov_b32 v14, 0
    s_barrier
    v_mov_b32 v76, 0
    v_mov_b32 v77, -1
    v_lshlrev_b32 v78, 2, v8
    v_add_u32 v78, 163424, v78
    s_mov_b64 exec, 0x1ff
    ds_write_b32 v78, v76 offset:192
    s_mov_b64 exec, 0xff
    ds_write_b32 v78, v77 offset:256
    s_mov_b64 exec, -1
    s_mov_b32 exec_hi, 0xffff
    ds_write_b32 v78, v76
    s_mov_b64 exec, 0x3f
    ds_write_b32 v78, v76 offset:228
    s_mov_b64 exec, -1
    s_mov_b64 exec, 1
    s_mov_b32 s24, 0x40000
    v_mov_b32 v12, 163728
KS_TAGW:
    buffer_load_dword v15, v6, s[60:63], 0 offen sc1
    s_waitcnt vmcnt(1)
    v_cmp_ne_u32 vcc, 0, v14
    s_nop 0
    s_cbranch_vccnz KS_TAGOK
    s_sub_u32 s24, s24, 1
    s_cbranch_scc1 K2_END
    buffer_load_dword v14, v6, s[60:63], 0 offen sc1
    s_waitcnt vmcnt(1)
    v_cmp_ne_u32 vcc, 0, v15
    s_nop 0
    s_cbranch_vccz KS_TAGW
    ds_write_b32 v12, v15
    s_branch KS_TAGOK2
KS_TAGOK:
    ds_write_b32 v12, v14
KS_TAGOK2:
    s_mov_b64 exec, -1
    s_waitcnt lgkmcnt(0)
    s_barrier
    s_branch KS_B3
KS_H0:
    s_barrier
    s_branch KS_HELP
K2_PAD_S1:
    s_branch KS_HOP0
KS_NOTAG:
    s_cmp_ge_u32 s20, 5
    s_cbranch_scc1 KS_HELP
    s_cmp_ge_u32 s2, 250
    s_cbranch_scc1 KS_IDLE
    s_mov_b32 s40, s88
    s_and_b32 s41, s89, 0xffff
    s_mov_b32 s42, 1280000
    s_mov_b32 s43, 0x20000
    buffer_load_dwordx4 v[12:15], v5, s[40:43], s64 offen
    s_mov_b32 s44, s86
    s_and_b32 s45, s87, 0xffff
    s_mov_b32 s46, 1280000
    s_mov_b32 s47, 0x20000
    s_mov_b32 s48, s82
    s_and_b32 s49, s83, 0xffff
    s_mov_b32 s50, 1920000
    s_mov_b32 s51, 0x20000
    buffer_load_dwordx4 v[16:19], v5, s[44:47], s64 offen
    buffer_load_dwordx4 v[20:23], v4, s[48:51], s65 offen
    buffer_load_dwordx2 v[24:25], v4, s[48:51], s65 offen offset:16
    v_lshlrev_b32 v2, 2, v0
    s_lshl_b32 s64, s64, 3
    v_lshl_add_u32 v3, v0, 7, s64
    v_mov_b32 v7, 1
    s_cmp_eq_u32 s20, 4
    s_cbranch_scc1 KS_NOCLR
    ds_write_b32 v2, v6
KS_NOCLR:
    s_waitcnt lgkmcnt(0)
    s_barrier
    s_mov_b64 exec, 0
    s_cmp_eq_u32 s20, 0
    s_cbranch_scc1 K2_PAD_B3
    s_cmp_eq_u32 s20, 1
    s_cbranch_scc1 K2_PAD_LD
    s_cmp_eq_u32 s20, 2
    s_cbranch_scc1 K2_PAD_NW
    s_cmp_eq_u32 s20, 3
    s_cbranch_scc1 K2_PAD_SC
    s_cmp_eq_u32 s20, 4
    s_cbranch_scc1 K2_PAD_SD
KS_HOP:
    s_mov_b64 exec, -1
    v_mul_u32_u24 v76, 2979, v0
    v_lshrrev_b32 v76, 16, v76
    v_mul_u32_u24 v77, 2048, v76
    v_lshl_add_u32 v78, v0, 4, v77
    v_add_u32 v78, 67584, v78
    v_add_u32 v79, 67200, v78
    v_mov_b32 v80, -1
    v_mov_b32 v81, -1
    v_cmp_gt_u32 vcc, 14, v76
    v_cmp_gt_u32 s[56:57], 12, v76
    v_mov_b32 v82, -1
    v_mov_b32 v83, -1
    s_mov_b64 exec, vcc
    ds_write_b128 v78, v[80:83]
    ds_write_b128 v78, v[80:83] offset:33600
    s_mov_b64 exec, s[56:57]
    ds_write_b128 v79, v[80:83]
    s_mov_b64 exec, -1
    s_mov_b32 s58, 429497
    s_movk_i32 s59, 625
    s_waitcnt vmcnt(3)
    v_mul_u32_u24 v28, s58, v12
    v_lshrrev_b32 v32, 27, v28
    v_bfe_u32 v36, v28, 24, 3
    v_lshlrev_b32 v32, 2, v32
    v_lshl_or_b32 v32, v36, 7, v32
    ds_add_rtn_u32 v36, v32, v7
    v_mul_u32_u24 v29, s58, v13
    v_lshrrev_b32 v33, 27, v29
    v_bfe_u32 v37, v29, 24, 3
    v_lshlrev_b32 v33, 2, v33
    v_lshl_or_b32 v33, v37, 7, v33
    ds_add_rtn_u32 v37, v33, v7
    v_mul_u32_u24 v30, s58, v14
    v_lshrrev_b32 v34, 27, v30
    v_bfe_u32 v38, v30, 24, 3
    v_lshlrev_b32 v34, 2, v34
    v_lshl_or_b32 v34, v38, 7, v34
    ds_add_rtn_u32 v38, v34, v7
    v_mul_u32_u24 v31, s58, v15
    v_lshrrev_b32 v35, 27, v31
    v_bfe_u32 v39, v31, 24, 3
    v_lshlrev_b32 v35, 2, v35
    v_lshl_or_b32 v35, v39, 7, v35
    ds_add_rtn_u32 v39, v35, v7
    v_lshrrev_b32 v28, 24, v28
    v_mad_u32_u24 v28, v28, s59, 15
    v_lshrrev_b32 v28, 4, v28
    v_sub_u32 v28, v12, v28
    v_add_u32 v12, 0, v3
    v_lshl_or_b32 v28, v28, 26, v12
    v_lshrrev_b32 v29, 24, v29
    v_mad_u32_u24 v29, v29, s59, 15
    v_lshrrev_b32 v29, 4, v29
    v_sub_u32 v29, v13, v29
    v_add_u32 v13, 32, v3
    v_lshl_or_b32 v29, v29, 26, v13
    v_lshrrev_b32 v30, 24, v30
    v_mad_u32_u24 v30, v30, s59, 15
    v_lshrrev_b32 v30, 4, v30
    v_sub_u32 v30, v14, v30
    v_add_u32 v14, 64, v3
    v_lshl_or_b32 v30, v30, 26, v14
    v_lshrrev_b32 v31, 24, v31
    v_mad_u32_u24 v31, v31, s59, 15
    v_lshrrev_b32 v31, 4, v31
    v_sub_u32 v31, v15, v31
    v_add_u32 v15, 96, v3
    v_lshl_or_b32 v31, v31, 26, v15
K2_PAD_S2:
    s_cbranch_execz KS_HOP0
    v_mov_b32 v59, 163728
    s_mul_i32 s65, s2, 1152
    s_add_u32 s65, s65, 6291456
    s_mul_i32 s64, s2, 20608
    s_waitcnt lgkmcnt(0)
    s_barrier
    ds_read_b128 v[40:43], v9
    ds_read_b32 v59, v59
    s_waitcnt lgkmcnt(1)
    v_add_u32 v45, v40, v41
    v_add_u32 v46, v45, v42
    v_add_u32 v47, v46, v43
    v_mov_b32 v58, v47
    s_nop 1
    v_add_u32_dpp v58, v58, v58 row_shr:1 row_mask:0xf bank_mask:0xf bound_ctrl:0
    s_nop 1
    v_add_u32_dpp v58, v58, v58 row_shr:2 row_mask:0xf bank_mask:0xf bound_ctrl:0
    s_nop 1
    v_add_u32_dpp v58, v58, v58 row_shr:4 row_mask:0xf bank_mask:0xf bound_ctrl:0
    s_nop 1
    v_add_u32_dpp v58, v58, v58 row_shr:8 row_mask:0xf bank_mask:0xf bound_ctrl:0
    s_nop 1
    v_add_u32_dpp v58, v58, v58 row_bcast:15 row_mask:0xa bank_mask:0xf
    s_nop 1
    v_add_u32_dpp v58, v58, v58 row_bcast:31 row_mask:0xc bank_mask:0xf
    v_sub_u32 v48, v58, v47
    v_add_u32 v49, v48, v40
    v_add_u32 v50, v48, v45
    v_add_u32 v51, v48, v46
    ds_write_b128 v9, v[48:51] offset:1024
    s_waitcnt vmcnt(0) lgkmcnt(1)
    s_cmp_lg_u32 s20, 4
    s_cbranch_scc1 KS_NOPUB
    v_lshl_or_b32 v56, v49, 11, v48
    v_lshl_or_b32 v57, v51, 11, v50
    v_lshl_or_b32 v56, v59, 22, v56
    v_lshl_or_b32 v57, v59, 22, v57
    buffer_store_dwordx4 v[56:59], v9, s[8:11], s65 offen sc1
KS_NOPUB:
    s_waitcnt lgkmcnt(0)
    ds_read_b32 v32, v32 offset:1024
    ds_read_b32 v33, v33 offset:1024
    ds_read_b32 v34, v34 offset:1024
    ds_read_b32 v35, v35 offset:1024
    v_and_b32 v60, 0xffff, v59
    v_and_b32 v61, 0xffff0000, v59
    s_mov_b32 s58, 0xffff0000
    v_mov_b32 v40, v20
    v_lshl_or_b32 v41, v21, 16, v60
    v_or_b32 v42, v61, v16
    v_mov_b32 v43, v28
    v_alignbit_b32 v44, v22, v21, 16
    v_and_or_b32 v45, v22, s58, v60
    v_or_b32 v46, v61, v17
    v_mov_b32 v47, v29
    v_mov_b32 v48, v23
    v_lshl_or_b32 v49, v24, 16, v60
    v_or_b32 v50, v61, v18
    v_mov_b32 v51, v30
    v_alignbit_b32 v52, v25, v24, 16
    v_and_or_b32 v53, v25, s58, v60
    v_or_b32 v54, v61, v19
    v_mov_b32 v55, v31
    s_waitcnt lgkmcnt(0)
    v_add_lshl_u32 v32, v32, v36, 4
    ds_write_b128 v32, v[40:43] offset:2048
    v_add_lshl_u32 v33, v33, v37, 4
    ds_write_b128 v33, v[44:47] offset:2048
    v_add_lshl_u32 v34, v34, v38, 4
    ds_write_b128 v34, v[48:51] offset:2048
    v_add_lshl_u32 v35, v35, v39, 4
    ds_write_b128 v35, v[52:55] offset:2048
    s_waitcnt lgkmcnt(0)
    s_barrier
    ds_read_b128 v[12:15], v5 offset:2048
    ds_read_b128 v[16:19], v5 offset:7168
    ds_read_b128 v[20:23], v5 offset:12288
    ds_read_b128 v[24:27], v5 offset:17408
    s_waitcnt lgkmcnt(3)
    buffer_store_dwordx4 v[12:15], v5, s[8:11], s64 offen sc1
    s_add_u32 s64, s64, 5120
    s_waitcnt lgkmcnt(2)
    buffer_store_dwordx4 v[16:19], v5, s[8:11], s64 offen sc1
    s_add_u32 s64, s64, 5120
    s_waitcnt lgkmcnt(1)
    buffer_store_dwordx4 v[20:23], v5, s[8:11], s64 offen sc1
    s_add_u32 s64, s64, 5120
    s_waitcnt lgkmcnt(0)
    buffer_store_dwordx4 v[24:27], v5, s[8:11], s64 offen sc1
    s_branch KS_JOIN
K2_PAD_B3:
    s_branch KS_HOP
KS_B3:
    v_mov_b32 v59, 163728
    ds_read_b32 v59, v59
    s_waitcnt lgkmcnt(0)
    s_barrier
KS_JOIN:
    v_readfirstlane_b32 s2, v59
    s_mov_b32 s23, 0
    s_mov_b32 s28, 1
    s_mov_b32 s24, 0
    s_mov_b32 s25, 1
K2_CELLS:
    v_lshrrev_b32 v178, 1, v177
    v_min_u32 v178, 249, v178
    v_mul_u32_u24 v72, 1152, v178
    s_and_b32 s58, s54, 7
    s_lshl_b32 s58, s58, 7
    s_lshr_b32 s59, s54, 5
    s_lshl_b32 s59, s59, 4
    s_add_u32 s67, s58, s59
    s_add_u32 s67, s67, 6291456
    buffer_load_dwordx4 v[76:79], v72, s[8:11], s67 offen sc1
    s_cmp_eq_u32 s28, 0
    s_cbranch_scc1 K2_NOSRD
    s_mov_b32 s4, s80
    s_and_b32 s5, s81, 0xffff
    s_mov_b32 s6, 10240000
    s_mov_b32 s7, 0x20000
    s_mov_b32 s12, s96
    s_and_b32 s13, s97, 0xffff
    s_mov_b32 s14, 10240000
    s_mov_b32 s15, 0x20000
    s_mov_b32 s16, s84
    s_and_b32 s17, s85, 0xffff
    s_mov_b32 s18, 10240000
    s_mov_b32 s19, 0x20000
    s_sub_u32 s80, s80, 1024
    s_subb_u32 s81, s81, 0
    s_mov_b32 s72, s80
    s_and_b32 s73, s81, 0xffff
    s_mov_b32 s74, 10241024
    s_mov_b32 s75, 0x20000
    s_mov_b64 exec, 0
    s_cmp_eq_u32 s20, 0
    s_cbranch_scc1 K2_PAD_U20
    s_cmp_eq_u32 s20, 1
    s_cbranch_scc1 K2_PAD_U30
    s_cmp_eq_u32 s20, 2
    s_cbranch_scc1 K2_PAD_U21
    s_cmp_eq_u32 s20, 3
    s_cbranch_scc1 K2_PAD_U31
    s_cmp_eq_u32 s20, 4
    s_cbranch_scc1 K2_PAD_SW
    s_cmp_eq_u32 s20, 5
    s_cbranch_scc1 K2_PAD_TL
    s_cmp_eq_u32 s20, 6
    s_cbranch_scc1 K2_PAD_T2
    s_cmp_eq_u32 s20, 7
    s_cbranch_scc1 K2_PAD_OV
K2_HOP:
    s_mov_b64 exec, -1
K2_NOSRD:
    v_and_b32 v84, 15, v176
    v_lshrrev_b32 v85, 5, v176
    v_bfe_u32 v86, v176, 4, 1
    v_lshrrev_b32 v87, 2, v84
    v_and_b32 v88, 3, v84
    v_lshl_add_u32 v89, v85, 3, v87
    v_lshlrev_b32 v249, 5, v89
    v_lshl_add_u32 v249, v88, 3, v249
    v_add_u32 v249, 864, v249
    v_mul_u32_u24 v250, 192, v86
    v_lshl_add_u32 v250, v85, 5, v250
    v_lshrrev_b32 v90, 1, v88
    v_lshl_add_u32 v90, v86, 1, v90
    v_bfe_u32 v91, v87, 1, 1
    v_lshlrev_b32 v91, 2, v91
    v_xor_b32 v90, v90, v91
    v_lshlrev_b32 v90, 4, v90
    v_lshl_add_u32 v90, v89, 7, v90
    v_and_b32 v91, 1, v88
    v_lshl_add_u32 v90, v91, 3, v90
    v_add_u32 v246, s37, v90
    v_xor_b32 v247, 64, v246
    v_lshrrev_b32 v90, 3, v176
    v_lshlrev_b32 v251, 2, v90
    v_add_u32 v251, 768, v251
    v_bfe_u32 v90, v90, 1, 1
    v_lshlrev_b32 v90, 2, v90
    v_and_b32 v91, 7, v176
    v_xor_b32 v90, v90, v91
    v_lshlrev_b32 v248, 4, v90
    v_lshlrev_b32 v252, 1, v176
    v_and_b32 v231, 1, v176
    v_lshlrev_b32 v231, 4, v231
    v_lshrrev_b32 v90, 1, v176
    v_lshlrev_b32 v90, 5, v90
    v_add_u32 v230, 864, v90
    s_lshl_b32 s59, s2, 22
    s_mov_b32 s60, 0x40000
    s_bfe_u32 s61, s54, 0x10004
    s_bfe_u32 s62, s54, 0x10003
    s_add_u32 s63, s61, s62
    s_mul_i32 s62, s62, 11
    s_sub_u32 s64, 11, s62
    v_cmp_gt_u32 vcc, 500, v177
    s_nop 0
    s_mov_b64 s[56:57], vcc
K2_POLL:
    s_waitcnt vmcnt(0)
    v_xor_b32 v73, s59, v76
    v_xor_b32 v74, s59, v77
    v_or_b32 v73, v73, v74
    v_xor_b32 v74, s2, v79
    v_lshrrev_b32 v73, 22, v73
    v_or_b32 v73, v73, v74
    v_cmp_ne_u32 vcc, 0, v73
    s_nop 0
    s_cbranch_vccz K2_POLLED
    s_sub_u32 s60, s60, 1
    s_cbranch_scc1 K2_END
    s_mov_b64 exec, vcc
    buffer_load_dwordx4 v[76:79], v72, s[8:11], s67 offen sc1
    s_mov_b64 exec, -1
    s_branch K2_POLL
K2_PAD_LD:
    s_branch KS_HOP
K2_POLLED:
    s_set_gpr_idx_on s61, gpr_idx(SRC0)
    s_nop 0
    v_bfe_u32 v179, v76, s62, 11
    s_set_gpr_idx_idx s63
    s_nop 0
    v_bfe_u32 v73, v76, s64, 11
    s_set_gpr_idx_off
    v_sub_u32 v73, v73, v179
    v_cndmask_b32 v73, 0, v73, s[56:57]
    v_and_b32 v1, 1, v177
    v_add_u32 v1, s23, v1
    v_sub_u32 v180, v73, v1
    v_add_u32 v179, v179, v1
    v_mul_u32_u24 v181, 20608, v178
    v_lshl_add_u32 v181, v179, 4, v181
    v_cmp_lt_i32 s[40:41], 0, v180
    v_cmp_lt_i32 s[42:43], 2, v180
    v_cmp_lt_i32 s[44:45], 4, v180
    v_cmp_lt_i32 s[46:47], 6, v180
    v_cmp_lt_i32 s[48:49], 8, v180
    v_cmp_lt_i32 s[50:51], 10, v180
    v_cmp_lt_i32 s[90:91], 12, v180
    v_cmp_lt_i32 s[92:93], 14, v180
    v_cmp_lt_i32 s[94:95], 16, v180
    v_cmp_lt_i32 s[96:97], 18, v180
    s_mov_b64 exec, s[40:41]
    s_cbranch_execz K2_LD_DONE
    buffer_load_dwordx4 v[0:3], v181, s[8:11], 0 offen offset:0 sc1
    s_mov_b64 exec, s[42:43]
    s_cbranch_execz K2_LD_DONE
    buffer_load_dwordx4 v[4:7], v181, s[8:11], 0 offen offset:32 sc1
    s_mov_b64 exec, s[44:45]
    s_cbranch_execz K2_LD_DONE
    buffer_load_dwordx4 v[8:11], v181, s[8:11], 0 offen offset:64 sc1
    s_mov_b64 exec, s[46:47]
    s_cbranch_execz K2_LD_DONE
    buffer_load_dwordx4 v[12:15], v181, s[8:11], 0 offen offset:96 sc1
    s_mov_b64 exec, s[48:49]
    s_cbranch_execz K2_LD_DONE
    buffer_load_dwordx4 v[16:19], v181, s[8:11], 0 offen offset:128 sc1
    s_mov_b64 exec, s[50:51]
    s_cbranch_execz K2_LD_DONE
    buffer_load_dwordx4 v[20:23], v181, s[8:11], 0 offen offset:160 sc1
    s_mov_b64 exec, s[90:91]
    s_cbranch_execz K2_LD_DONE
    buffer_load_dwordx4 v[24:27], v181, s[8:11], 0 offen offset:192 sc1
    s_mov_b64 exec, s[92:93]
    s_cbranch_execz K2_LD_DONE
    buffer_load_dwordx4 v[28:31], v181, s[8:11], 0 offen offset:224 sc1
    s_mov_b64 exec, s[94:95]
    s_cbranch_execz K2_LD_DONE
    buffer_load_dwordx4 v[32:35], v181, s[8:11], 0 offen offset:256 sc1
    s_mov_b64 exec, s[96:97]
    s_cbranch_execz K2_LD_DONE
    buffer_load_dwordx4 v[36:39], v181, s[8:11], 0 offen offset:288 sc1
K2_LD_DONE:
    s_mov_b64 exec, -1
    s_cmp_eq_u32 s28, 0
    s_cbranch_scc1 K2_NOWRAW
    v_lshrrev_b32 v60, 5, v176
    v_bfe_u32 v61, v176, 2, 2
    v_lshl_add_u32 v60, v60, 2, v61
    v_mul_u32_u24 v60, 1280, v60
    v_bfe_u32 v61, v176, 4, 1
    v_lshl_add_u32 v60, v61, 5, v60
    v_and_b32 v61, 3, v176
    v_lshl_add_u32 v60, v61, 3, v60
    ds_read_b64_tr_b16 v[136:137], v60 offset:24576
    ds_read_b64_tr_b16 v[138:139], v60 offset:34816
    ds_read_b64_tr_b16 v[140:141], v60 offset:24640
    ds_read_b64_tr_b16 v[142:143], v60 offset:34880
    ds_read_b64_tr_b16 v[144:145], v60 offset:24832
    ds_read_b64_tr_b16 v[146:147], v60 offset:35072
    ds_read_b64_tr_b16 v[148:149], v60 offset:24896
    ds_read_b64_tr_b16 v[150:151], v60 offset:35136
    ds_read_b64_tr_b16 v[152:153], v60 offset:25088
    ds_read_b64_tr_b16 v[154:155], v60 offset:35328
    ds_read_b64_tr_b16 v[156:157], v60 offset:25152
    ds_read_b64_tr_b16 v[158:159], v60 offset:35392
    ds_read_b64_tr_b16 v[160:161], v60 offset:25344
    ds_read_b64_tr_b16 v[162:163], v60 offset:35584
    ds_read_b64_tr_b16 v[164:165], v60 offset:25408
    ds_read_b64_tr_b16 v[166:167], v60 offset:35648
    ds_read_b64_tr_b16 v[168:169], v60 offset:25600
    ds_read_b64_tr_b16 v[170:171], v60 offset:35840
    ds_read_b64_tr_b16 v[172:173], v60 offset:25664
    ds_read_b64_tr_b16 v[174:175], v60 offset:35904
    s_waitcnt lgkmcnt(0)
    v_lshlrev_b32 v96, 16, v136
    v_and_b32 v97, 0xffff0000, v136
    v_lshlrev_b32 v98, 16, v137
    v_and_b32 v99, 0xffff0000, v137
    v_lshlrev_b32 v100, 16, v138
    v_and_b32 v101, 0xffff0000, v138
    v_lshlrev_b32 v102, 16, v139
    v_and_b32 v103, 0xffff0000, v139
    v_lshlrev_b32 v104, 16, v140
    v_and_b32 v105, 0xffff0000, v140
    v_lshlrev_b32 v106, 16, v141
    v_and_b32 v107, 0xffff0000, v141
    v_lshlrev_b32 v108, 16, v142
    v_and_b32 v109, 0xffff0000, v142
    v_lshlrev_b32 v110, 16, v143
    v_and_b32 v111, 0xffff0000, v143
    v_lshlrev_b32 v112, 16, v144
    v_and_b32 v113, 0xffff0000, v144
    v_lshlrev_b32 v114, 16, v145
    v_and_b32 v115, 0xffff0000, v145
    v_lshlrev_b32 v116, 16, v146
    v_and_b32 v117, 0xffff0000, v146
    v_lshlrev_b32 v118, 16, v147
    v_and_b32 v119, 0xffff0000, v147
    v_lshlrev_b32 v120, 16, v148
    v_and_b32 v121, 0xffff0000, v148
    v_lshlrev_b32 v122, 16, v149
    v_and_b32 v123, 0xffff0000, v149
    v_lshlrev_b32 v124, 16, v150
    v_and_b32 v125, 0xffff0000, v150
    v_lshlrev_b32 v126, 16, v151
    v_and_b32 v127, 0xffff0000, v151
    v_lshlrev_b32 v128, 16, v152
    v_and_b32 v129, 0xffff0000, v152
    v_lshlrev_b32 v130, 16, v153
    v_and_b32 v131, 0xffff0000, v153
    v_lshlrev_b32 v132, 16, v154
    v_and_b32 v133, 0xffff0000, v154
    v_lshlrev_b32 v134, 16, v155
    v_and_b32 v135, 0xffff0000, v155
    v_lshlrev_b32 v136, 16, v156
    v_and_b32 v137, 0xffff0000, v156
    v_lshlrev_b32 v138, 16, v157
    v_and_b32 v139, 0xffff0000, v157
    v_lshlrev_b32 v140, 16, v158
    v_and_b32 v141, 0xffff0000, v158
    v_lshlrev_b32 v142, 16, v159
    v_and_b32 v143, 0xffff0000, v159
    v_lshlrev_b32 v144, 16, v160
    v_and_b32 v145, 0xffff0000, v160
    v_lshlrev_b32 v146, 16, v161
    v_and_b32 v147, 0xffff0000, v161
    v_lshlrev_b32 v148, 16, v162
    v_and_b32 v149, 0xffff0000, v162
    v_lshlrev_b32 v150, 16, v163
    v_and_b32 v151, 0xffff0000, v163
    v_lshlrev_b32 v152, 16, v164
    v_and_b32 v153, 0xffff0000, v164
    v_lshlrev_b32 v154, 16, v165
    v_and_b32 v155, 0xffff0000, v165
    v_lshlrev_b32 v156, 16, v166
    v_and_b32 v157, 0xffff0000, v166
    v_lshlrev_b32 v158, 16, v167
    v_and_b32 v159, 0xffff0000, v167
    v_lshlrev_b32 v160, 16, v168
    v_and_b32 v161, 0xffff0000, v168
    v_lshlrev_b32 v162, 16, v169
    v_and_b32 v163, 0xffff0000, v169
    v_lshlrev_b32 v164, 16, v170
    v_and_b32 v165, 0xffff0000, v170
    v_lshlrev_b32 v166, 16, v171
    v_and_b32 v167, 0xffff0000, v171
    v_lshlrev_b32 v168, 16, v172
    v_and_b32 v169, 0xffff0000, v172
    v_lshlrev_b32 v170, 16, v173
    v_and_b32 v171, 0xffff0000, v173
    v_lshlrev_b32 v172, 16, v174
    v_and_b32 v173, 0xffff0000, v174
    v_lshlrev_b32 v174, 16, v175
    v_and_b32 v175, 0xffff0000, v175
K2_NOWRAW:
K2_PAD_NW:
    s_cbranch_execz KS_HOP
    v_mul_u32_u24 v178, 1280, v178
    v_add_lshl_u32 v179, v179, v178, 2
    s_mov_b32 s66, 7340032
    v_mov_b32 v201, 1
    s_movk_i32 s58, 600
    s_movk_i32 s59, 2400
    s_mov_b32 s60, 0x40000
    s_mov_b32 s61, 0xffff
    v_mov_b32 v202, 65536
    s_cmp_lg_u32 s24, 0
    s_cbranch_scc1 K2_RK_LOAD
    v_cmp_lt_i32 vcc, 20, v180
    s_nop 0
    s_cbranch_vccz K2_NOMORE
    v_mov_b32 v61, 163652
    ds_write_b32 v61, v201
K2_NOMORE:
    v_lshlrev_b32 v72, 4, v176
    s_mov_b32 s64, 7176192
    s_mov_b32 s62, 84736
    s_cmp_eq_u32 s20, 7
    s_waitcnt vmcnt(0)
    s_cbranch_scc1 K2_FLGLD
K2_FLGL2:
    s_mov_b64 exec, s[40:41]
    s_cbranch_execz K2_RK_A
K2_CK0:
    v_bfi_b32 v192, s61, v1, v2
    v_lshrrev_b32 v50, 24, v3
    v_cmp_ne_u32 vcc, s2, v192
    v_add_u32 v40, 163424, v50
    s_cbranch_vccnz K2_RT0
    ds_add_rtn_u32 v40, v40, v201
    v_mad_u32_u24 v50, v50, s58, v202
    s_mov_b64 exec, s[42:43]
    s_cbranch_execz K2_RK_A
K2_CK1:
    v_bfi_b32 v192, s61, v5, v6
    v_lshrrev_b32 v51, 24, v7
    v_cmp_ne_u32 vcc, s2, v192
    v_add_u32 v41, 163424, v51
    s_cbranch_vccnz K2_RT1
    ds_add_rtn_u32 v41, v41, v201
    v_mad_u32_u24 v51, v51, s58, v202
    s_mov_b64 exec, s[44:45]
    s_cbranch_execz K2_RK_A
K2_CK2:
    v_bfi_b32 v192, s61, v9, v10
    v_lshrrev_b32 v52, 24, v11
    v_cmp_ne_u32 vcc, s2, v192
    v_add_u32 v42, 163424, v52
    s_cbranch_vccnz K2_RT2
    ds_add_rtn_u32 v42, v42, v201
    v_mad_u32_u24 v52, v52, s58, v202
    s_mov_b64 exec, s[46:47]
    s_cbranch_execz K2_RK_A
K2_CK3:
    v_bfi_b32 v192, s61, v13, v14
    v_lshrrev_b32 v53, 24, v15
    v_cmp_ne_u32 vcc, s2, v192
    v_add_u32 v43, 163424, v53
    s_cbranch_vccnz K2_RT3
    ds_add_rtn_u32 v43, v43, v201
    v_mad_u32_u24 v53, v53, s58, v202
    s_mov_b64 exec, s[48:49]
    s_cbranch_execz K2_RK_A
K2_CK4:
    v_bfi_b32 v192, s61, v17, v18
    v_lshrrev_b32 v54, 24, v19
    v_cmp_ne_u32 vcc, s2, v192
    v_add_u32 v44, 163424, v54
    s_cbranch_vccnz K2_RT4
    ds_add_rtn_u32 v44, v44, v201
    v_mad_u32_u24 v54, v54, s58, v202
    s_mov_b64 exec, s[50:51]
    s_cbranch_execz K2_RK_A
K2_CK5:
    v_bfi_b32 v192, s61, v21, v22
    v_lshrrev_b32 v55, 24, v23
    v_cmp_ne_u32 vcc, s2, v192
    v_add_u32 v45, 163424, v55
    s_cbranch_vccnz K2_RT5
    ds_add_rtn_u32 v45, v45, v201
    v_mad_u32_u24 v55, v55, s58, v202
    s_mov_b64 exec, s[90:91]
    s_cbranch_execz K2_RK_A
K2_CK6:
    v_bfi_b32 v192, s61, v25, v26
    v_lshrrev_b32 v56, 24, v27
    v_cmp_ne_u32 vcc, s2, v192
    v_add_u32 v46, 163424, v56
    s_cbranch_vccnz K2_RT6
    ds_add_rtn_u32 v46, v46, v201
    v_mad_u32_u24 v56, v56, s58, v202
    s_mov_b64 exec, s[92:93]
    s_cbranch_execz K2_RK_A
K2_CK7:
    v_bfi_b32 v192, s61, v29, v30
    v_lshrrev_b32 v57, 24, v31
    v_cmp_ne_u32 vcc, s2, v192
    v_add_u32 v47, 163424, v57
    s_cbranch_vccnz K2_RT7
    ds_add_rtn_u32 v47, v47, v201
    v_mad_u32_u24 v57, v57, s58, v202
    s_mov_b64 exec, s[94:95]
    s_cbranch_execz K2_RK_A
K2_CK8:
    v_bfi_b32 v192, s61, v33, v34
    v_lshrrev_b32 v58, 24, v35
    v_cmp_ne_u32 vcc, s2, v192
    v_add_u32 v48, 163424, v58
    s_cbranch_vccnz K2_RT8
    ds_add_rtn_u32 v48, v48, v201
    v_mad_u32_u24 v58, v58, s58, v202
    s_mov_b64 exec, s[96:97]
    s_cbranch_execz K2_RK_A
K2_CK9:
    v_bfi_b32 v192, s61, v37, v38
    v_lshrrev_b32 v59, 24, v39
    v_cmp_ne_u32 vcc, s2, v192
    v_add_u32 v49, 163424, v59
    s_cbranch_vccnz K2_RT9
    ds_add_rtn_u32 v49, v49, v201
    v_mad_u32_u24 v59, v59, s58, v202
K2_RK_A:
    s_mov_b64 exec, -1
    s_mov_b64 exec, s[40:41]
    s_cbranch_execz K2_TP
    v_cmp_gt_u32 vcc, s62, v50
    v_and_b32 v3, 0xffffff, v3
    s_mov_b64 exec, vcc
    buffer_load_dword v245, v3, s[16:19], 0 offen
    s_mov_b64 exec, s[42:43]
    s_cbranch_execz K2_TP
    v_cmp_gt_u32 vcc, s62, v51
    v_and_b32 v7, 0xffffff, v7
    s_mov_b64 exec, vcc
    buffer_load_dword v245, v7, s[16:19], 0 offen
    s_mov_b64 exec, s[44:45]
    s_cbranch_execz K2_TP
    v_cmp_gt_u32 vcc, s62, v52
    v_and_b32 v11, 0xffffff, v11
    s_mov_b64 exec, vcc
    buffer_load_dword v245, v11, s[16:19], 0 offen
    s_mov_b64 exec, s[46:47]
    s_cbranch_execz K2_TP
    v_cmp_gt_u32 vcc, s62, v53
    v_and_b32 v15, 0xffffff, v15
    s_mov_b64 exec, vcc
    buffer_load_dword v245, v15, s[16:19], 0 offen
    s_mov_b64 exec, s[48:49]
    s_cbranch_execz K2_TP
    v_cmp_gt_u32 vcc, s62, v54
    v_and_b32 v19, 0xffffff, v19
    s_mov_b64 exec, vcc
    buffer_load_dword v245, v19, s[16:19], 0 offen
    s_mov_b64 exec, s[50:51]
    s_cbranch_execz K2_TP
    v_cmp_gt_u32 vcc, s62, v55
    v_and_b32 v23, 0xffffff, v23
    s_mov_b64 exec, vcc
    buffer_load_dword v245, v23, s[16:19], 0 offen
    s_mov_b64 exec, s[90:91]
    s_cbranch_execz K2_TP
    v_cmp_gt_u32 vcc, s62, v56
    v_and_b32 v27, 0xffffff, v27
    s_mov_b64 exec, vcc
    buffer_load_dword v245, v27, s[16:19], 0 offen
    s_mov_b64 exec, s[92:93]
    s_cbranch_execz K2_TP
    v_cmp_gt_u32 vcc, s62, v57
    v_and_b32 v31, 0xffffff, v31
    s_mov_b64 exec, vcc
    buffer_load_dword v245, v31, s[16:19], 0 offen
    s_mov_b64 exec, s[94:95]
    s_cbranch_execz K2_TP
    v_cmp_gt_u32 vcc, s62, v58
    v_and_b32 v35, 0xffffff, v35
    s_mov_b64 exec, vcc
    buffer_load_dword v245, v35, s[16:19], 0 offen
    s_mov_b64 exec, s[96:97]
    s_cbranch_execz K2_TP
    v_cmp_gt_u32 vcc, s62, v59
    v_and_b32 v39, 0xffffff, v39
    s_mov_b64 exec, vcc
    buffer_load_dword v245, v39, s[16:19], 0 offen
K2_TP:
    s_mov_b64 exec, -1
K2_RK_DONE:
K2_PAD_SC:
    s_cbranch_execz KS_HOP
    s_mul_i32 s67, s24, 48
    s_mov_b32 s58, 1
    s_waitcnt lgkmcnt(0)
    s_mov_b64 exec, s[40:41]
    s_cbranch_execz K2_SC_DONE
    v_cmpx_gt_u32 vcc, 48, v40
    v_lshl_add_u32 v194, v40, 5, v50
    v_lshl_add_u32 v195, v40, 2, v50
    v_lshrrev_b32 v193, 3, v40
    v_mad_i32_i24 v196, v193, -16, v195
    v_and_b32 v193, 1, v193
    v_mad_i32_i24 v196, v193, -14, v196
    ds_write_b32 v194, v3 offset:864
    ds_write_b16 v195, v0 offset:194
    ds_write_b16_d16_hi v195, v0 offset:386
    ds_write_b16_d16_hi v195, v1 offset:578
    ds_write_b16 v196, v2 offset:768
    s_cmp_lg_u64 exec, s[40:41]
    s_addc_u32 s58, s58, s58
    s_mov_b64 exec, s[42:43]
    s_cbranch_execz K2_SC_DONE
    v_cmpx_gt_u32 vcc, 48, v41
    v_lshl_add_u32 v194, v41, 5, v51
    v_lshl_add_u32 v195, v41, 2, v51
    v_lshrrev_b32 v193, 3, v41
    v_mad_i32_i24 v196, v193, -16, v195
    v_and_b32 v193, 1, v193
    v_mad_i32_i24 v196, v193, -14, v196
    ds_write_b32 v194, v7 offset:864
    ds_write_b16 v195, v4 offset:194
    ds_write_b16_d16_hi v195, v4 offset:386
    ds_write_b16_d16_hi v195, v5 offset:578
    ds_write_b16 v196, v6 offset:768
    s_cmp_lg_u64 exec, s[42:43]
    s_addc_u32 s58, s58, s58
    s_mov_b64 exec, s[44:45]
    s_cbranch_execz K2_SC_DONE
    v_cmpx_gt_u32 vcc, 48, v42
    v_lshl_add_u32 v194, v42, 5, v52
    v_lshl_add_u32 v195, v42, 2, v52
    v_lshrrev_b32 v193, 3, v42
    v_mad_i32_i24 v196, v193, -16, v195
    v_and_b32 v193, 1, v193
    v_mad_i32_i24 v196, v193, -14, v196
    ds_write_b32 v194, v11 offset:864
    ds_write_b16 v195, v8 offset:194
    ds_write_b16_d16_hi v195, v8 offset:386
    ds_write_b16_d16_hi v195, v9 offset:578
    ds_write_b16 v196, v10 offset:768
    s_cmp_lg_u64 exec, s[44:45]
    s_addc_u32 s58, s58, s58
    s_mov_b64 exec, s[46:47]
    s_cbranch_execz K2_SC_DONE
    v_cmpx_gt_u32 vcc, 48, v43
    v_lshl_add_u32 v194, v43, 5, v53
    v_lshl_add_u32 v195, v43, 2, v53
    v_lshrrev_b32 v193, 3, v43
    v_mad_i32_i24 v196, v193, -16, v195
    v_and_b32 v193, 1, v193
    v_mad_i32_i24 v196, v193, -14, v196
    ds_write_b32 v194, v15 offset:864
    ds_write_b16 v195, v12 offset:194
    ds_write_b16_d16_hi v195, v12 offset:386
    ds_write_b16_d16_hi v195, v13 offset:578
    ds_write_b16 v196, v14 offset:768
    s_cmp_lg_u64 exec, s[46:47]
    s_addc_u32 s58, s58, s58
    s_mov_b64 exec, s[48:49]
    s_cbranch_execz K2_SC_DONE
    v_cmpx_gt_u32 vcc, 48, v44
    v_lshl_add_u32 v194, v44, 5, v54
    v_lshl_add_u32 v195, v44, 2, v54
    v_lshrrev_b32 v193, 3, v44
    v_mad_i32_i24 v196, v193, -16, v195
    v_and_b32 v193, 1, v193
    v_mad_i32_i24 v196, v193, -14, v196
    ds_write_b32 v194, v19 offset:864
    ds_write_b16 v195, v16 offset:194
    ds_write_b16_d16_hi v195, v16 offset:386
    ds_write_b16_d16_hi v195, v17 offset:578
    ds_write_b16 v196, v18 offset:768
    s_cmp_lg_u64 exec, s[48:49]
    s_addc_u32 s58, s58, s58
    s_mov_b64 exec, s[50:51]
    s_cbranch_execz K2_SC_DONE
    v_cmpx_gt_u32 vcc, 48, v45
    v_lshl_add_u32 v194, v45, 5, v55
    v_lshl_add_u32 v195, v45, 2, v55
    v_lshrrev_b32 v193, 3, v45
    v_mad_i32_i24 v196, v193, -16, v195
    v_and_b32 v193, 1, v193
    v_mad_i32_i24 v196, v193, -14, v196
    ds_write_b32 v194, v23 offset:864
    ds_write_b16 v195, v20 offset:194
    ds_write_b16_d16_hi v195, v20 offset:386
    ds_write_b16_d16_hi v195, v21 offset:578
    ds_write_b16 v196, v22 offset:768
    s_cmp_lg_u64 exec, s[50:51]
    s_addc_u32 s58, s58, s58
    s_mov_b64 exec, s[90:91]
    s_cbranch_execz K2_SC_DONE
    v_cmpx_gt_u32 vcc, 48, v46
    v_lshl_add_u32 v194, v46, 5, v56
    v_lshl_add_u32 v195, v46, 2, v56
    v_lshrrev_b32 v193, 3, v46
    v_mad_i32_i24 v196, v193, -16, v195
    v_and_b32 v193, 1, v193
    v_mad_i32_i24 v196, v193, -14, v196
    ds_write_b32 v194, v27 offset:864
    ds_write_b16 v195, v24 offset:194
    ds_write_b16_d16_hi v195, v24 offset:386
    ds_write_b16_d16_hi v195, v25 offset:578
    ds_write_b16 v196, v26 offset:768
    s_cmp_lg_u64 exec, s[90:91]
    s_addc_u32 s58, s58, s58
    s_mov_b64 exec, s[92:93]
    s_cbranch_execz K2_SC_DONE
    v_cmpx_gt_u32 vcc, 48, v47
    v_lshl_add_u32 v194, v47, 5, v57
    v_lshl_add_u32 v195, v47, 2, v57
    v_lshrrev_b32 v193, 3, v47
    v_mad_i32_i24 v196, v193, -16, v195
    v_and_b32 v193, 1, v193
    v_mad_i32_i24 v196, v193, -14, v196
    ds_write_b32 v194, v31 offset:864
    ds_write_b16 v195, v28 offset:194
    ds_write_b16_d16_hi v195, v28 offset:386
    ds_write_b16_d16_hi v195, v29 offset:578
    ds_write_b16 v196, v30 offset:768
    s_cmp_lg_u64 exec, s[92:93]
    s_addc_u32 s58, s58, s58
    s_mov_b64 exec, s[94:95]
    s_cbranch_execz K2_SC_DONE
    v_cmpx_gt_u32 vcc, 48, v48
    v_lshl_add_u32 v194, v48, 5, v58
    v_lshl_add_u32 v195, v48, 2, v58
    v_lshrrev_b32 v193, 3, v48
    v_mad_i32_i24 v196, v193, -16, v195
    v_and_b32 v193, 1, v193
    v_mad_i32_i24 v196, v193, -14, v196
    ds_write_b32 v194, v35 offset:864
    ds_write_b16 v195, v32 offset:194
    ds_write_b16_d16_hi v195, v32 offset:386
    ds_write_b16_d16_hi v195, v33 offset:578
    ds_write_b16 v196, v34 offset:768
    s_cmp_lg_u64 exec, s[94:95]
    s_addc_u32 s58, s58, s58
    s_mov_b64 exec, s[96:97]
    s_cbranch_execz K2_SC_DONE
    v_cmpx_gt_u32 vcc, 48, v49
    v_lshl_add_u32 v194, v49, 5, v59
    v_lshl_add_u32 v195, v49, 2, v59
    v_lshrrev_b32 v193, 3, v49
    v_mad_i32_i24 v196, v193, -16, v195
    v_and_b32 v193, 1, v193
    v_mad_i32_i24 v196, v193, -14, v196
    ds_write_b32 v194, v39 offset:864
    ds_write_b16 v195, v36 offset:194
    ds_write_b16_d16_hi v195, v36 offset:386
    ds_write_b16_d16_hi v195, v37 offset:578
    ds_write_b16 v196, v38 offset:768
    s_cmp_lg_u64 exec, s[96:97]
    s_addc_u32 s58, s58, s58
K2_SC_DONE:
    s_mov_b64 exec, -1
K2_PAD_SD:
    s_cbranch_execz KS_HOP
    s_bcnt1_i32_b32 s61, s58
    s_cmp_gt_u32 s61, 1
    s_cbranch_scc1 K2_OV
K2_OB:
    v_lshlrev_b32 v192, 2, v176
    v_add_u32 v192, 163424, v192
    v_mov_b32 v200, 163652
    v_mov_b32 v198, 0
    s_movk_i32 s26, 48
    s_cmp_eq_u32 s20, 7
    s_cbranch_scc1 K2_FLGCK
K2_FLGOK:
    s_waitcnt lgkmcnt(0)
    s_barrier
    ds_read_b32 v193, v192
    ds_read_b32 v200, v200
    v_cmp_gt_u32 s[56:57], s22, v176
    v_mad_u32_u24 v195, v176, s59, v202
    v_lshl_or_b32 v195, v176, 21, v195
    s_waitcnt lgkmcnt(0)
    v_cndmask_b32 v193, 0, v193, s[56:57]
    v_readfirstlane_b32 s27, v200
    v_cmp_lt_u32 vcc, 48, v193
    s_nop 0
    s_cbranch_vccnz K2_BIG
K2_TOK:
    v_subrev_u32 v194, s67, v193
    v_max_i32 v194, 1, v194
    v_min_i32 v194, s26, v194
    v_add_u32 v194, 15, v194
    v_lshrrev_b32 v194, 4, v194
    v_lshl_or_b32 v195, v194, 18, v195
    v_or_b32 v195, v195, v198
    v_mov_b32 v197, 425056
    v_cndmask_b32 v253, v197, v195, s[56:57]
    s_movk_i32 s40, 0
    s_movk_i32 s41, 256
    s_movk_i32 s42, 512
    s_movk_i32 s43, 768
    s_add_u32 s24, s24, 1
    s_cmp_ge_u32 s24, s25
    s_cselect_b32 s55, 1, 0
    s_cmp_eq_u32 s27, 0
    s_cselect_b32 s55, s55, 0
    s_mov_b32 s27, 0x400000
    s_mov_b32 s38, 0
    s_mov_b32 s34, 0
    s_mov_b32 s35, 0
    s_mov_b32 s36, 1
    s_mov_b32 s31, 0
    s_mov_b32 s58, s20
    v_readlane_b32 s3, v253, s58
    s_lshl_b32 s44, s34, 7
    s_lshl_b32 s60, s58, 5
    s_and_b32 s48, s3, 0x3ffff
    s_bfe_u32 s33, s3, 0x30012
    s_sub_u32 s60, s60, s48
    s_and_b32 s60, s60, 0xff
    s_add_u32 s60, s60, s48
    s_mul_i32 s35, s38, 6
    s_cmp_eq_u32 s34, 0
    s_cselect_b32 s35, s35, s60
    s_mov_b32 s45, s44
    s_add_u32 s47, s44, 256
    s_add_u32 s49, s48, 32
    s_add_u32 s60, s48, 64
    s_cmp_eq_u32 s33, 3
    s_cselect_b32 s46, s44, s47
    s_cselect_b32 s50, s60, s48
    s_cselect_b32 s51, s48, s49
    s_sub_u32 s60, s33, 2
    s_cmp_lt_u32 s60, 2
    s_cbranch_scc0 K2_rare_1
K2_back_2:
    v_add_u32 v233, s48, v230
    ds_read_b32 v232, v233
    ds_read_b32 v233, v233 offset:1024
    v_add_u32 v222, s48, v251
    ds_read_b32 v222, v222
    v_add_u32 v224, s49, v251
    ds_read_b32 v224, v224
    v_add_u32 v226, s50, v251
    ds_read_b32 v226, v226
    v_add_u32 v228, s51, v251
    ds_read_b32 v228, v228
    s_waitcnt lgkmcnt(4)
    v_or_b32 v232, v232, v231
    v_or_b32 v233, v233, v231
    s_cmp_lg_u32 s34, 0
    s_cbranch_scc1 K2_dum_4
    s_add_u32 m0, s48, 864
    s_add_u32 s65, s48, 1888
    buffer_load_dwordx4 v232, s[16:19], 0 offen  lds
    s_mov_b32 m0, s65
    s_mov_b32 exec_hi, 0
    buffer_load_dwordx4 v233, s[16:19], 0 offen  lds
    s_cmp_eq_u32 s33, 4
    s_cbranch_scc1 K2_a4_5
K2_b4_7:
    s_mov_b32 exec_hi, -1
K2_back_6:
    s_waitcnt lgkmcnt(3)
    v_mad_u32_u16 v223, v222, s39, v248 op_sel:[1,0,0,0]
    v_mad_u32_u16 v222, v222, s39, v248
    s_waitcnt lgkmcnt(2)
    v_mad_u32_u16 v225, v224, s39, v248 op_sel:[1,0,0,0]
    v_mad_u32_u16 v224, v224, s39, v248
    s_waitcnt lgkmcnt(1)
    v_mad_u32_u16 v227, v226, s39, v248 op_sel:[1,0,0,0]
    v_mad_u32_u16 v226, v226, s39, v248
    s_waitcnt lgkmcnt(0)
    v_mad_u32_u16 v229, v228, s39, v248 op_sel:[1,0,0,0]
    v_mad_u32_u16 v228, v228, s39, v248
    s_mov_b32 m0, s68
    s_nop 0
    buffer_load_dwordx4 v222, s[4:7], s44 offen sc1 lds
    buffer_load_dwordx4 v223, s[72:75], s44 offen offset:1024 sc1 lds
    s_mov_b32 m0, s69
    s_nop 0
    buffer_load_dwordx4 v224, s[4:7], s45 offen sc1 lds
    buffer_load_dwordx4 v225, s[72:75], s45 offen offset:1024 sc1 lds
    s_mov_b32 m0, s70
    s_nop 0
    buffer_load_dwordx4 v226, s[4:7], s46 offen sc1 lds
    buffer_load_dwordx4 v227, s[72:75], s46 offen offset:1024 sc1 lds
    s_mov_b32 m0, s71
    s_nop 0
    buffer_load_dwordx4 v228, s[4:7], s47 offen sc1 lds
    buffer_load_dwordx4 v229, s[72:75], s47 offen offset:1024 sc1 lds
    v_add_u32 v249, s48, v249
    v_add_u32 v250, s48, v250
    s_waitcnt vmcnt(6)
    ds_read_b64_tr_b16 v[176:177], v246 offset:0
    ds_read_b64_tr_b16 v[178:179], v246 offset:512
    ds_read_b64_tr_b16 v[180:181], v247 offset:0
    ds_read_b64_tr_b16 v[182:183], v247 offset:512
    ds_read_b64_tr_b16 v[0:1], v249 offset:0
    ds_read_b64_tr_b16 v[2:3], v249 offset:128
    ds_read_b128 v[4:7], v250 offset:0
    ds_read_b128 v[8:11], v250 offset:16
    ds_read_b128 v[12:15], v250 offset:384
    ds_read_b128 v[16:19], v250 offset:400
    ds_read_b64_tr_b16 v[20:21], v249 offset:512
    ds_read_b64_tr_b16 v[22:23], v249 offset:640
    ds_read_b128 v[24:27], v250 offset:64
    ds_read_b128 v[28:31], v250 offset:80
    ds_read_b128 v[32:35], v250 offset:448
    ds_read_b128 v[36:39], v250 offset:464
    s_mov_b32 s29, s48
    s_mov_b32 s32, s31
    s_mov_b32 s30, s3
    s_mov_b32 s31, s35
    s_cmp_eq_u32 s33, 2
    s_cbranch_scc1 K2_U20
    s_cmp_eq_u32 s33, 3
    s_cbranch_scc1 K2_U30
    s_cmp_eq_u32 s33, 1
    s_cbranch_scc1 K2_U10
    s_branch K2_U40
K2_PAD_H1:
    s_branch KS_HOP0
KS_HELP:
    s_mov_b32 s30, 0
    s_cmp_eq_u32 s20, 6
    s_cbranch_scc1 KS_RAW
    s_cmp_ge_u32 s2, 200
    s_cbranch_scc1 KS_NOW
    s_mov_b32 s30, 1
    v_and_b32 v1, 15, v8
    v_lshrrev_b32 v3, 4, v8
    s_cmp_ge_u32 s2, 160
    s_cbranch_scc1 K1_WT
    s_cmp_ge_u32 s2, 64
    s_cbranch_scc1 K1_S1
    s_lshr_b32 s24, s2, 3
    s_and_b32 s25, s2, 7
    s_lshr_b32 s26, s25, 2
    s_bfe_u32 s27, s25, 0x10001
    s_and_b32 s28, s25, 1
    s_mov_b32 s60, s92
    s_and_b32 s61, s93, 0xffff
    s_mov_b32 s62, 65536
    s_mov_b32 s63, 0x20000
    s_branch K1_SC
K1_S1:
    s_sub_u32 s29, s2, 64
    s_mul_i32 s24, s29, 43
    s_lshr_b32 s24, s24, 9
    s_mul_i32 s25, s24, 12
    s_sub_u32 s25, s29, s25
    s_cmp_ge_u32 s25, 6
    s_cselect_b32 s26, 1, 0
    s_mul_i32 s27, s26, 6
    s_sub_u32 s27, s25, s27
    s_lshr_b32 s27, s27, 1
    s_and_b32 s28, s25, 1
    s_add_u32 s25, s25, 8
    s_mov_b32 s60, s94
    s_and_b32 s61, s95, 0xffff
    s_mov_b32 s62, 98304
    s_mov_b32 s63, 0x20000
K1_SC:
    s_lshl_b32 s27, s27, 7
    s_lshl_b32 s26, s26, 6
    s_lshl_b32 s28, s28, 4
    s_add_u32 s27, s27, s26
    s_add_u32 s27, s27, s28
    s_lshl_b32 s27, s27, 8
    s_lshl_b32 s26, s24, 5
    s_add_u32 s27, s27, s26
    s_add_u32 s29, s27, 8192
    v_lshlrev_b32 v3, 10, v3
    v_lshl_add_u32 v3, v1, 1, v3
    buffer_load_ushort v64, v3, s[60:63], s27 offen offset:0
    buffer_load_ushort v65, v3, s[60:63], s29 offen offset:0
    buffer_load_ushort v66, v3, s[60:63], s27 offen offset:256
    buffer_load_ushort v67, v3, s[60:63], s29 offen offset:256
    buffer_load_ushort v68, v3, s[60:63], s27 offen offset:512
    buffer_load_ushort v69, v3, s[60:63], s29 offen offset:512
    buffer_load_ushort v70, v3, s[60:63], s27 offen offset:768
    buffer_load_ushort v71, v3, s[60:63], s29 offen offset:768
    s_mul_i32 s24, s24, 20
    s_add_u32 s24, s24, s25
    s_lshl_b32 s24, s24, 10
    s_add_u32 s24, s24, 6946816
    s_branch K1_GO
K1_WT:
    s_sub_u32 s24, s2, 160
    s_cmp_ge_u32 s24, 20
    s_cselect_b32 s26, 1, 0
    s_mul_i32 s25, s26, 20
    s_sub_u32 s25, s24, s25
    s_lshr_b32 s27, s25, 2
    s_bfe_u32 s28, s25, 0x10001
    s_and_b32 s25, s25, 1
    s_mul_i32 s25, s25, 10240
    s_lshl_b32 s27, s27, 8
    s_lshl_b32 s26, s26, 7
    s_lshl_b32 s28, s28, 6
    s_add_u32 s27, s27, s26
    s_add_u32 s27, s27, s28
    s_add_u32 s27, s27, s25
    s_mov_b32 s60, s90
    s_and_b32 s61, s91, 0xffff
    s_mov_b32 s62, 20480
    s_mov_b32 s63, 0x20000
    v_and_b32 v1, 31, v8
    v_lshrrev_b32 v3, 5, v8
    v_mul_u32_u24 v3, 5120, v3
    v_lshl_add_u32 v3, v1, 1, v3
    v_mov_b32 v64, 0
    v_mov_b32 v66, 0
    v_mov_b32 v68, 0
    v_mov_b32 v70, 0
    buffer_load_ushort v65, v3, s[60:63], s27 offen offset:0
    buffer_load_ushort v67, v3, s[60:63], s27 offen offset:1280
    buffer_load_ushort v69, v3, s[60:63], s27 offen offset:2560
    buffer_load_ushort v71, v3, s[60:63], s27 offen offset:3840
    s_lshl_b32 s24, s24, 10
    s_add_u32 s24, s24, 7110656
K1_GO:
KS_NOW:
    s_barrier
K2_PAD_H2:
    s_cbranch_execz KS_HOP0
KS_FILL:
    v_subrev_u32 v76, 320, v0
    v_mov_b32 v80, -1
    v_mov_b32 v77, 1.0
    v_cmp_gt_u32 vcc, 48, v76
    v_lshlrev_b32 v78, 4, v76
    v_add_u32 v78, 65536, v78
    v_cndmask_b32 v80, v80, 0, vcc
    v_cmp_gt_u32 vcc, 12, v76
    v_add_u32 v79, 64800, v78
    s_nop 0
    v_cndmask_b32 v80, v80, v77, vcc
    v_cmp_gt_u32 s[56:57], 54, v8
    v_mov_b32 v81, v80
    v_mov_b32 v82, v80
    v_mov_b32 v83, v80
    ds_write_b128 v78, v[80:83] offset:0
    ds_write_b128 v78, v[80:83] offset:2400
    ds_write_b128 v78, v[80:83] offset:4800
    ds_write_b128 v78, v[80:83] offset:7200
    ds_write_b128 v78, v[80:83] offset:9600
    ds_write_b128 v78, v[80:83] offset:12000
    ds_write_b128 v78, v[80:83] offset:14400
    ds_write_b128 v78, v[80:83] offset:16800
    ds_write_b128 v78, v[80:83] offset:19200
    ds_write_b128 v78, v[80:83] offset:21600
    ds_write_b128 v78, v[80:83] offset:24000
    ds_write_b128 v78, v[80:83] offset:26400
    ds_write_b128 v78, v[80:83] offset:28800
    ds_write_b128 v78, v[80:83] offset:31200
    ds_write_b128 v78, v[80:83] offset:33600
    ds_write_b128 v78, v[80:83] offset:36000
    ds_write_b128 v78, v[80:83] offset:38400
    ds_write_b128 v78, v[80:83] offset:40800
    ds_write_b128 v78, v[80:83] offset:43200
    ds_write_b128 v78, v[80:83] offset:45600
    ds_write_b128 v78, v[80:83] offset:48000
    ds_write_b128 v78, v[80:83] offset:50400
    ds_write_b128 v78, v[80:83] offset:52800
    ds_write_b128 v78, v[80:83] offset:55200
    ds_write_b128 v78, v[80:83] offset:57600
    ds_write_b128 v78, v[80:83] offset:60000
    ds_write_b128 v78, v[80:83] offset:62400
    ds_write_b128 v79, v[80:83] offset:0
    ds_write_b128 v79, v[80:83] offset:2400
    ds_write_b128 v79, v[80:83] offset:4800
    ds_write_b128 v79, v[80:83] offset:7200
    ds_write_b128 v79, v[80:83] offset:9600
    ds_write_b128 v79, v[80:83] offset:12000
    ds_write_b128 v79, v[80:83] offset:14400
    ds_write_b128 v79, v[80:83] offset:16800
    ds_write_b128 v79, v[80:83] offset:19200
    ds_write_b128 v79, v[80:83] offset:21600
    ds_write_b128 v79, v[80:83] offset:24000
    ds_write_b128 v79, v[80:83] offset:26400
    ds_write_b128 v79, v[80:83] offset:28800
    v_mov_b32 v59, 163728
    s_barrier
    ds_read_b32 v59, v59
    s_cmp_eq_u32 s20, 6
    s_cselect_b64 exec, s[56:57], -1
    ds_write_b128 v79, v[80:83] offset:31200
    s_mov_b64 exec, -1
    s_waitcnt vmcnt(0) lgkmcnt(0)
    s_cmp_eq_u32 s30, 0
    s_cbranch_scc1 KS_B3
    v_lshl_or_b32 v40, v65, 16, v64
    v_lshl_or_b32 v41, v67, 16, v66
    v_lshl_or_b32 v42, v69, 16, v68
    v_lshl_or_b32 v43, v71, 16, v70
    buffer_store_dwordx4 v[40:43], v9, s[8:11], s24 offen sc1
    s_waitcnt lgkmcnt(0)
    s_barrier
    s_lshl_b32 s24, s2, 2
    s_add_u32 s24, s24, 7176192
    s_mov_b64 exec, 1
    s_waitcnt vmcnt(0)
    buffer_store_dword v59, v6, s[8:11], s24 offen sc1
    s_mov_b64 exec, -1
    s_branch KS_JOIN
K2_PAD_H3:
    s_branch KS_HOP0
KS_RAW:
    s_barrier
    s_mov_b32 s60, s90
    s_and_b32 s61, s91, 0xffff
    s_mov_b32 s62, 20480
    s_mov_b32 s63, 0x20000
    s_mov_b32 m0, 24576
    s_movk_i32 s24, 0
    buffer_load_dwordx4 v9, s[60:63], s24 offen offset:0 lds
    buffer_load_dwordx4 v9, s[60:63], s24 offen offset:1024 lds
    buffer_load_dwordx4 v9, s[60:63], s24 offen offset:2048 lds
    buffer_load_dwordx4 v9, s[60:63], s24 offen offset:3072 lds
    s_mov_b32 m0, 28672
    s_movk_i32 s24, 4096
    buffer_load_dwordx4 v9, s[60:63], s24 offen offset:0 lds
    buffer_load_dwordx4 v9, s[60:63], s24 offen offset:1024 lds
    buffer_load_dwordx4 v9, s[60:63], s24 offen offset:2048 lds
    buffer_load_dwordx4 v9, s[60:63], s24 offen offset:3072 lds
    s_mov_b32 m0, 32768
    s_movk_i32 s24, 8192
    buffer_load_dwordx4 v9, s[60:63], s24 offen offset:0 lds
    buffer_load_dwordx4 v9, s[60:63], s24 offen offset:1024 lds
    buffer_load_dwordx4 v9, s[60:63], s24 offen offset:2048 lds
    buffer_load_dwordx4 v9, s[60:63], s24 offen offset:3072 lds
    s_mov_b32 m0, 36864
    s_movk_i32 s24, 12288
    buffer_load_dwordx4 v9, s[60:63], s24 offen offset:0 lds
    buffer_load_dwordx4 v9, s[60:63], s24 offen offset:1024 lds
    buffer_load_dwordx4 v9, s[60:63], s24 offen offset:2048 lds
    buffer_load_dwordx4 v9, s[60:63], s24 offen offset:3072 lds
    s_mov_b32 m0, 40960
    s_movk_i32 s24, 16384
    buffer_load_dwordx4 v9, s[60:63], s24 offen offset:0 lds
    buffer_load_dwordx4 v9, s[60:63], s24 offen offset:1024 lds
    buffer_load_dwordx4 v9, s[60:63], s24 offen offset:2048 lds
    buffer_load_dwordx4 v9, s[60:63], s24 offen offset:3072 lds
    s_branch KS_FILL
KS_IDLE:
    s_barrier
    v_mul_u32_u24 v76, 2979, v0
    v_lshrrev_b32 v76, 16, v76
    v_mul_u32_u24 v77, 2048, v76
    v_lshl_add_u32 v78, v0, 4, v77
    v_add_u32 v78, 67584, v78
    v_add_u32 v79, 67200, v78
    v_mov_b32 v80, -1
    v_mov_b32 v81, -1
    v_cmp_gt_u32 vcc, 14, v76
    v_cmp_gt_u32 s[56:57], 12, v76
    v_mov_b32 v82, -1
    v_mov_b32 v83, -1
    s_mov_b64 exec, vcc
    ds_write_b128 v78, v[80:83]
    ds_write_b128 v78, v[80:83] offset:33600
    s_mov_b64 exec, s[56:57]
    ds_write_b128 v79, v[80:83]
    s_mov_b64 exec, -1
    s_barrier
    s_branch KS_B3
K2_PAD_U20:
    s_branch K2_HOP
K2_U20:
    s_setprio 1
    s_waitcnt lgkmcnt(6)
    v_lshlrev_b32 v40, 16, v0
    v_and_b32 v41, 0xffff0000, v0
    v_lshlrev_b32 v42, 16, v1
    v_and_b32 v43, 0xffff0000, v1
    v_lshlrev_b32 v44, 16, v2
    v_and_b32 v45, 0xffff0000, v2
    v_lshlrev_b32 v46, 16, v3
    v_and_b32 v47, 0xffff0000, v3
    v_mul_f32 v4, v40, v4
    v_mul_f32 v5, v41, v5
    v_mul_f32 v6, v42, v6
    v_mul_f32 v7, v43, v7
    v_mul_f32 v8, v44, v8
    v_mul_f32 v9, v45, v9
    v_mul_f32 v10, v46, v10
    v_mul_f32 v11, v47, v11
    v_cvt_pk_bf16_f32 v64, v4, v5
    v_cvt_pk_bf16_f32 v65, v6, v7
    v_cvt_pk_bf16_f32 v66, v8, v9
    v_cvt_pk_bf16_f32 v67, v10, v11
    v_mul_f32 v12, v40, v12
    v_mul_f32 v13, v41, v13
    v_mul_f32 v14, v42, v14
    v_mul_f32 v15, v43, v15
    v_mul_f32 v16, v44, v16
    v_mul_f32 v17, v45, v17
    v_mul_f32 v18, v46, v18
    v_mul_f32 v19, v47, v19
    v_cvt_pk_bf16_f32 v68, v12, v13
    v_cvt_pk_bf16_f32 v69, v14, v15
    v_cvt_pk_bf16_f32 v70, v16, v17
    v_cvt_pk_bf16_f32 v71, v18, v19
    s_waitcnt lgkmcnt(0)
    v_lshlrev_b32 v48, 16, v20
    v_and_b32 v49, 0xffff0000, v20
    v_lshlrev_b32 v50, 16, v21
    v_and_b32 v51, 0xffff0000, v21
    v_lshlrev_b32 v52, 16, v22
    v_and_b32 v53, 0xffff0000, v22
    v_lshlrev_b32 v54, 16, v23
    v_and_b32 v55, 0xffff0000, v23
    v_mul_f32 v24, v48, v24
    v_mul_f32 v25, v49, v25
    v_mul_f32 v26, v50, v26
    v_mul_f32 v27, v51, v27
    v_mul_f32 v28, v52, v28
    v_mul_f32 v29, v53, v29
    v_mul_f32 v30, v54, v30
    v_mul_f32 v31, v55, v31
    v_cvt_pk_bf16_f32 v72, v24, v25
    v_cvt_pk_bf16_f32 v73, v26, v27
    v_cvt_pk_bf16_f32 v74, v28, v29
    v_cvt_pk_bf16_f32 v75, v30, v31
    v_mul_f32 v32, v48, v32
    v_mul_f32 v33, v49, v33
    v_mul_f32 v34, v50, v34
    v_mul_f32 v35, v51, v35
    v_mul_f32 v36, v52, v36
    v_mul_f32 v37, v53, v37
    v_mul_f32 v38, v54, v38
    v_mul_f32 v39, v55, v39
    v_cvt_pk_bf16_f32 v76, v32, v33
    v_cvt_pk_bf16_f32 v77, v34, v35
    v_cvt_pk_bf16_f32 v78, v36, v37
    v_cvt_pk_bf16_f32 v79, v38, v39
    s_waitcnt vmcnt(4)
    v_mfma_f32_32x32x16_bf16 v[0:15], v[64:67], v[176:179], 0
    ds_read_b64_tr_b16 v[184:185], v246 offset:2048
    ds_read_b64_tr_b16 v[186:187], v246 offset:2560
    ds_read_b64_tr_b16 v[188:189], v247 offset:2048
    ds_read_b64_tr_b16 v[190:191], v247 offset:2560
    s_mov_b32 m0, s68
    v_mfma_f32_32x32x16_bf16 v[16:31], v[68:71], v[176:179], 0
    buffer_load_dwordx4 v222, s[4:7], s42 offen sc1 lds
    buffer_load_dwordx4 v223, s[72:75], s42 offen offset:1024 sc1 lds
    v_permlane32_swap_b32 v242, v236
    v_permlane32_swap_b32 v243, v237
    s_add_u32 s38, s38, 1
    v_mfma_f32_32x32x16_bf16 v[32:47], v[64:67], v[180:183], 0
    v_permlane32_swap_b32 v244, v238
    v_permlane32_swap_b32 v245, v239
    v_permlane32_swap_b32 v240, v241
    v_add_f32 v242, v242, v236
    v_mfma_f32_32x32x16_bf16 v[48:63], v[68:71], v[180:183], 0
    v_add_f32 v243, v243, v237
    v_add_f32 v244, v244, v238
    v_add_f32 v245, v245, v239
    v_add_f32 v240, -v240, -v241
    v_mov_b32 v254, s52
    v_mov_b32 v255, s38
    s_waitcnt vmcnt(4) lgkmcnt(0)
    v_mfma_f32_32x32x16_bf16 v[0:15], v[72:75], v[184:187], v[0:15]
    ds_read_b64_tr_b16 v[176:177], v246 offset:4096
    ds_read_b64_tr_b16 v[178:179], v246 offset:4608
    ds_read_b64_tr_b16 v[180:181], v247 offset:4096
    ds_read_b64_tr_b16 v[182:183], v247 offset:4608
    s_lshl_b32 s58, s38, 3
    s_add_u32 s58, s58, s20
    s_mov_b32 m0, s69
    v_mfma_f32_32x32x16_bf16 v[16:31], v[76:79], v[184:187], v[16:31]
    buffer_load_dwordx4 v224, s[4:7], s42 offen sc1 lds
    buffer_load_dwordx4 v225, s[72:75], s42 offen offset:1024 sc1 lds
    s_set_gpr_idx_on s32, gpr_idx(DST)
    s_nop 0
    v_cvt_pk_bf16_f32 v195, v242, v243
    v_cvt_pk_bf16_f32 v196, v244, v245
    v_cvt_pk_bf16_f32 v197, v240, v240
    s_set_gpr_idx_off
    s_mov_b64 exec, 1
    ds_write_b32 v254, v255
    s_mov_b64 exec, -1
    s_cmp_lt_u32 s58, s22
    s_cbranch_scc0 K2_dyn_8
K2_back_9:
    v_readlane_b32 s3, v253, s58
    s_lshl_b32 s44, s34, 7
    s_lshl_b32 s60, s58, 5
    s_and_b32 s48, s3, 0x3ffff
    s_bfe_u32 s33, s3, 0x30012
    s_sub_u32 s60, s60, s48
    s_and_b32 s60, s60, 0xff
    s_add_u32 s60, s60, s48
    s_mul_i32 s35, s38, 6
    s_cmp_eq_u32 s34, 0
    s_cselect_b32 s35, s35, s60
    s_mov_b32 s45, s44
    s_add_u32 s47, s44, 256
    s_add_u32 s49, s48, 32
    s_add_u32 s60, s48, 64
    s_cmp_eq_u32 s33, 3
    s_cselect_b32 s46, s44, s47
    s_cselect_b32 s50, s60, s48
    s_cselect_b32 s51, s48, s49
    s_sub_u32 s60, s33, 2
    s_cmp_lt_u32 s60, 2
    s_cbranch_scc0 K2_rare_14
K2_back_15:
    v_mfma_f32_32x32x16_bf16 v[32:47], v[72:75], v[188:191], v[32:47]
    v_add_u32 v233, s48, v230
    ds_read_b32 v232, v233
    ds_read_b32 v233, v233 offset:1024
    v_mul_f32 v234, v0, v96
    v_mul_f32 v236, v8, v128
    v_fmac_f32 v234, v1, v97
    v_fmac_f32 v236, v9, v129
    v_mfma_f32_32x32x16_bf16 v[48:63], v[76:79], v[188:191], v[48:63]
    s_setprio 0
    v_fmac_f32 v234, v2, v98
    v_fmac_f32 v236, v10, v130
    v_fmac_f32 v234, v3, v99
    v_fmac_f32 v236, v11, v131
    v_fmac_f32 v234, v4, v100
    v_fmac_f32 v236, v12, v132
    v_fmac_f32 v234, v5, v101
    v_fmac_f32 v236, v13, v133
    v_fmac_f32 v234, v6, v102
    v_fmac_f32 v236, v14, v134
    v_fmac_f32 v234, v7, v103
    v_fmac_f32 v236, v15, v135
    v_mul_f32 v238, v16, v128
    v_mul_f32 v240, v24, v128
    v_fmac_f32 v238, v17, v129
    v_fmac_f32 v240, v25, v129
    v_fmac_f32 v238, v18, v130
    v_fmac_f32 v240, v26, v130
    v_fmac_f32 v238, v19, v131
    v_fmac_f32 v240, v27, v131
    v_fmac_f32 v238, v20, v132
    v_fmac_f32 v240, v28, v132
    v_fmac_f32 v238, v21, v133
    v_fmac_f32 v240, v29, v133
    v_fmac_f32 v238, v22, v134
    v_fmac_f32 v240, v30, v134
    v_fmac_f32 v238, v23, v135
    v_fmac_f32 v240, v31, v135
    v_mul_f32 v235, v32, v104
    v_mul_f32 v237, v40, v136
    v_fmac_f32 v235, v33, v105
    v_fmac_f32 v237, v41, v137
    v_fmac_f32 v235, v34, v106
    v_fmac_f32 v237, v42, v138
    v_fmac_f32 v235, v35, v107
    v_fmac_f32 v237, v43, v139
    v_fmac_f32 v235, v36, v108
    v_fmac_f32 v237, v44, v140
    v_fmac_f32 v235, v37, v109
    v_fmac_f32 v237, v45, v141
    v_fmac_f32 v235, v38, v110
    v_fmac_f32 v237, v46, v142
    v_fmac_f32 v235, v39, v111
    v_fmac_f32 v237, v47, v143
    v_mul_f32 v239, v48, v136
    v_mul_f32 v241, v56, v136
    v_fmac_f32 v239, v49, v137
    v_fmac_f32 v241, v57, v137
    s_setprio 1
    s_waitcnt vmcnt(4) lgkmcnt(3)
    v_mfma_f32_32x32x16_bf16 v[0:15], v[64:67], v[176:179], 0
    ds_read_b64_tr_b16 v[184:185], v246 offset:6144
    ds_read_b64_tr_b16 v[186:187], v246 offset:6656
    ds_read_b64_tr_b16 v[188:189], v247 offset:6144
    ds_read_b64_tr_b16 v[190:191], v247 offset:6656
    v_fmac_f32 v239, v50, v138
    v_fmac_f32 v241, v58, v138
    s_mov_b32 m0, s70
    v_mfma_f32_32x32x16_bf16 v[16:31], v[68:71], v[176:179], 0
    buffer_load_dwordx4 v222, s[4:7], s43 offen sc1 lds
    buffer_load_dwordx4 v223, s[72:75], s43 offen offset:1024 sc1 lds
    v_fmac_f32 v239, v51, v139
    v_fmac_f32 v241, v59, v139
    v_fmac_f32 v239, v52, v140
    v_fmac_f32 v241, v60, v140
    v_fmac_f32 v239, v53, v141
    v_mfma_f32_32x32x16_bf16 v[32:47], v[64:67], v[180:183], 0
    v_add_u32 v222, s48, v251
    ds_read_b32 v222, v222
    v_fmac_f32 v241, v61, v141
    v_fmac_f32 v239, v54, v142
    v_fmac_f32 v241, v62, v142
    v_fmac_f32 v239, v55, v143
    v_fmac_f32 v241, v63, v143
    v_mfma_f32_32x32x16_bf16 v[48:63], v[68:71], v[180:183], 0
    v_permlane32_swap_b32 v234, v236
    v_permlane32_swap_b32 v235, v237
    v_permlane32_swap_b32 v240, v238
    s_waitcnt lgkmcnt(5)
    v_or_b32 v232, v232, v231
    v_or_b32 v233, v233, v231
    s_cmp_lg_u32 s34, 0
    s_cbranch_scc1 K2_dum_17
    s_add_u32 m0, s48, 864
    s_add_u32 s65, s48, 1888
    buffer_load_dwordx4 v232, s[16:19], 0 offen  lds
    s_mov_b32 m0, s65
    s_mov_b32 exec_hi, 0
    buffer_load_dwordx4 v233, s[16:19], 0 offen  lds
    s_cmp_eq_u32 s33, 4
    s_cbranch_scc1 K2_a4_18
K2_b4_20:
    s_mov_b32 exec_hi, -1
K2_back_19:
    s_waitcnt vmcnt(6) lgkmcnt(1)
    v_mfma_f32_32x32x16_bf16 v[0:15], v[72:75], v[184:187], v[0:15]
    ds_read_b64_tr_b16 v[176:177], v246 offset:0
    ds_read_b64_tr_b16 v[178:179], v246 offset:512
    ds_read_b64_tr_b16 v[180:181], v247 offset:0
    ds_read_b64_tr_b16 v[182:183], v247 offset:512
    v_permlane32_swap_b32 v241, v239
    s_mov_b32 m0, s71
    v_mfma_f32_32x32x16_bf16 v[16:31], v[76:79], v[184:187], v[16:31]
    buffer_load_dwordx4 v224, s[4:7], s43 offen sc1 lds
    buffer_load_dwordx4 v225, s[72:75], s43 offen offset:1024 sc1 lds
    s_waitcnt lgkmcnt(4)
    v_mad_u32_u16 v223, v222, s39, v248 op_sel:[1,0,0,0]
    v_mad_u32_u16 v222, v222, s39, v248
    v_add_f32 v234, v234, v236
    v_add_f32 v235, v235, v237
    v_add_f32 v240, v240, v238
    v_add_f32 v241, v241, v239
    s_set_gpr_idx_on s31, gpr_idx(DST)
    s_nop 0
    v_cvt_pk_bf16_f32 v192, v234, v235
    v_cvt_pk_bf16_f32 v193, v240, v241
    s_set_gpr_idx_off
    v_mfma_f32_32x32x16_bf16 v[32:47], v[72:75], v[188:191], v[32:47]
    v_add_u32 v224, s49, v251
    ds_read_b32 v224, v224
    v_mul_f32 v234, v0, v144
    v_mul_f32 v236, v8, v112
    v_fmac_f32 v234, v1, v145
    v_fmac_f32 v236, v9, v113
    v_fmac_f32 v234, v2, v146
    v_mfma_f32_32x32x16_bf16 v[48:63], v[76:79], v[188:191], v[48:63]
    s_setprio 0
    v_fmac_f32 v236, v10, v114
    v_fmac_f32 v234, v3, v147
    v_fmac_f32 v236, v11, v115
    v_fmac_f32 v234, v4, v148
    v_fmac_f32 v236, v12, v116
    v_fmac_f32 v234, v5, v149
    v_fmac_f32 v236, v13, v117
    v_fmac_f32 v234, v6, v150
    v_fmac_f32 v236, v14, v118
    v_fmac_f32 v234, v7, v151
    v_fmac_f32 v236, v15, v119
    v_mul_f32 v238, v16, v160
    v_mul_f32 v240, v24, v160
    v_fmac_f32 v238, v17, v161
    v_fmac_f32 v240, v25, v161
    v_fmac_f32 v238, v18, v162
    v_fmac_f32 v240, v26, v162
    v_fmac_f32 v238, v19, v163
    v_fmac_f32 v240, v27, v163
    v_fmac_f32 v238, v20, v164
    v_fmac_f32 v240, v28, v164
    v_fmac_f32 v238, v21, v165
    v_fmac_f32 v240, v29, v165
    v_fmac_f32 v238, v22, v166
    v_fmac_f32 v240, v30, v166
    v_fmac_f32 v238, v23, v167
    v_fmac_f32 v240, v31, v167
    v_mul_f32 v235, v32, v152
    v_mul_f32 v237, v40, v120
    v_fmac_f32 v235, v33, v153
    v_fmac_f32 v237, v41, v121
    v_fmac_f32 v235, v34, v154
    v_fmac_f32 v237, v42, v122
    v_fmac_f32 v235, v35, v155
    v_fmac_f32 v237, v43, v123
    v_fmac_f32 v235, v36, v156
    v_fmac_f32 v237, v44, v124
    v_fmac_f32 v235, v37, v157
    v_fmac_f32 v237, v45, v125
    v_fmac_f32 v235, v38, v158
    v_fmac_f32 v237, v46, v126
    v_fmac_f32 v235, v39, v159
    v_fmac_f32 v237, v47, v127
    v_mul_f32 v239, v48, v168
    v_mul_f32 v241, v56, v168
    v_fmac_f32 v239, v49, v169
    v_fmac_f32 v241, v57, v169
    v_fmac_f32 v239, v50, v170
    v_fmac_f32 v241, v58, v170
    v_fmac_f32 v239, v51, v171
    s_setprio 1
    s_waitcnt vmcnt(6) lgkmcnt(1)
    v_mfma_f32_32x32x16_bf16 v[0:15], v[64:67], v[176:179], 0
    ds_read_b64_tr_b16 v[184:185], v246 offset:2048
    ds_read_b64_tr_b16 v[186:187], v246 offset:2560
    ds_read_b64_tr_b16 v[188:189], v247 offset:2048
    ds_read_b64_tr_b16 v[190:191], v247 offset:2560
    v_fmac_f32 v241, v59, v171
    v_fmac_f32 v239, v52, v172
    s_mov_b32 m0, s68
    v_mfma_f32_32x32x16_bf16 v[16:31], v[68:71], v[176:179], 0
    buffer_load_dwordx4 v222, s[4:7], s44 offen sc1 lds
    buffer_load_dwordx4 v223, s[72:75], s44 offen offset:1024 sc1 lds
    s_waitcnt lgkmcnt(4)
    v_mad_u32_u16 v225, v224, s39, v248 op_sel:[1,0,0,0]
    v_mad_u32_u16 v224, v224, s39, v248
    v_fmac_f32 v241, v60, v172
    v_fmac_f32 v239, v53, v173
    v_mfma_f32_32x32x16_bf16 v[32:47], v[64:67], v[180:183], 0
    v_add_u32 v226, s50, v251
    ds_read_b32 v226, v226
    v_fmac_f32 v241, v61, v173
    v_fmac_f32 v239, v54, v174
    v_fmac_f32 v241, v62, v174
    v_fmac_f32 v239, v55, v175
    v_fmac_f32 v241, v63, v175
    v_mfma_f32_32x32x16_bf16 v[48:63], v[68:71], v[180:183], 0
    s_waitcnt vmcnt(6) lgkmcnt(1)
    v_mfma_f32_32x32x16_bf16 v[0:15], v[72:75], v[184:187], v[0:15]
    ds_read_b64_tr_b16 v[176:177], v246 offset:4096
    ds_read_b64_tr_b16 v[178:179], v246 offset:4608
    ds_read_b64_tr_b16 v[180:181], v247 offset:4096
    ds_read_b64_tr_b16 v[182:183], v247 offset:4608
    s_mov_b32 m0, s69
    v_mfma_f32_32x32x16_bf16 v[16:31], v[76:79], v[184:187], v[16:31]
    buffer_load_dwordx4 v224, s[4:7], s45 offen sc1 lds
    buffer_load_dwordx4 v225, s[72:75], s45 offen offset:1024 sc1 lds
    s_waitcnt lgkmcnt(4)
    v_mad_u32_u16 v227, v226, s39, v248 op_sel:[1,0,0,0]
    v_mad_u32_u16 v226, v226, s39, v248
    v_mfma_f32_32x32x16_bf16 v[32:47], v[72:75], v[188:191], v[32:47]
    v_add_u32 v228, s51, v251
    ds_read_b32 v228, v228
    v_mul_f32 v242, v0, v144
    v_fma_f32 v238, v8, v160, -v238
    v_fmac_f32 v242, v1, v145
    v_fmac_f32 v238, v9, v161
    v_fmac_f32 v242, v2, v146
    v_mfma_f32_32x32x16_bf16 v[48:63], v[76:79], v[188:191], v[48:63]
    s_setprio 0
    v_fmac_f32 v238, v10, v162
    v_fmac_f32 v242, v3, v147
    v_fmac_f32 v238, v11, v163
    v_fmac_f32 v242, v4, v148
    v_fmac_f32 v238, v12, v164
    v_fmac_f32 v242, v5, v149
    v_fmac_f32 v238, v13, v165
    v_fmac_f32 v242, v6, v150
    v_fmac_f32 v238, v14, v166
    v_fmac_f32 v242, v7, v151
    v_fmac_f32 v238, v15, v167
    v_fmac_f32 v236, v16, v112
    v_mul_f32 v244, v24, v160
    v_fmac_f32 v236, v17, v113
    v_fmac_f32 v244, v25, v161
    v_fmac_f32 v236, v18, v114
    v_fmac_f32 v244, v26, v162
    v_fmac_f32 v236, v19, v115
    v_fmac_f32 v244, v27, v163
    v_fmac_f32 v236, v20, v116
    v_fmac_f32 v244, v28, v164
    v_fmac_f32 v236, v21, v117
    v_fmac_f32 v244, v29, v165
    v_fmac_f32 v236, v22, v118
    v_fmac_f32 v244, v30, v166
    v_fmac_f32 v236, v23, v119
    v_fmac_f32 v244, v31, v167
    v_mul_f32 v243, v32, v152
    v_fma_f32 v239, v40, v168, -v239
    v_fmac_f32 v243, v33, v153
    v_fmac_f32 v239, v41, v169
    v_fmac_f32 v243, v34, v154
    v_fmac_f32 v239, v42, v170
    v_fmac_f32 v243, v35, v155
    v_fmac_f32 v239, v43, v171
    v_fmac_f32 v243, v36, v156
    v_fmac_f32 v239, v44, v172
    v_fmac_f32 v243, v37, v157
    v_fmac_f32 v239, v45, v173
    v_fmac_f32 v243, v38, v158
    v_fmac_f32 v239, v46, v174
    v_fmac_f32 v243, v39, v159
    v_fmac_f32 v239, v47, v175
    v_fmac_f32 v237, v48, v120
    v_mul_f32 v245, v56, v168
    v_fmac_f32 v237, v49, v121
    v_fmac_f32 v245, v57, v169
    v_fmac_f32 v237, v50, v122
    s_setprio 1
    s_waitcnt vmcnt(4) lgkmcnt(1)
    v_mfma_f32_32x32x16_bf16 v[0:15], v[64:67], v[176:179], 0
    ds_read_b64_tr_b16 v[184:185], v246 offset:6144
    ds_read_b64_tr_b16 v[186:187], v246 offset:6656
    ds_read_b64_tr_b16 v[188:189], v247 offset:6144
    ds_read_b64_tr_b16 v[190:191], v247 offset:6656
    v_fmac_f32 v245, v58, v170
    v_fmac_f32 v237, v51, v123
    s_mov_b32 m0, s70
    v_mfma_f32_32x32x16_bf16 v[16:31], v[68:71], v[176:179], 0
    buffer_load_dwordx4 v226, s[4:7], s46 offen sc1 lds
    buffer_load_dwordx4 v227, s[72:75], s46 offen offset:1024 sc1 lds
    s_waitcnt lgkmcnt(4)
    v_mad_u32_u16 v229, v228, s39, v248 op_sel:[1,0,0,0]
    v_mad_u32_u16 v228, v228, s39, v248
    v_fmac_f32 v245, v59, v171
    v_fmac_f32 v237, v52, v124
    v_mfma_f32_32x32x16_bf16 v[32:47], v[64:67], v[180:183], 0
    v_fmac_f32 v245, v60, v172
    v_fmac_f32 v237, v53, v125
    v_fmac_f32 v245, v61, v173
    v_fmac_f32 v237, v54, v126
    v_fmac_f32 v245, v62, v174
    v_fmac_f32 v237, v55, v127
    v_fmac_f32 v245, v63, v175
    v_mfma_f32_32x32x16_bf16 v[48:63], v[68:71], v[180:183], 0
    v_permlane32_swap_b32 v242, v234
    v_permlane32_swap_b32 v243, v235
    v_add_f32 v242, v242, v234
    v_add_f32 v243, v243, v235
    s_waitcnt vmcnt(4) lgkmcnt(0)
    v_mfma_f32_32x32x16_bf16 v[0:15], v[72:75], v[184:187], v[0:15]
    ds_read_b64_tr_b16 v[176:177], v246 offset:0
    ds_read_b64_tr_b16 v[178:179], v246 offset:512
    ds_read_b64_tr_b16 v[180:181], v247 offset:0
    ds_read_b64_tr_b16 v[182:183], v247 offset:512
    s_sub_u32 s26, s48, s29
    s_mov_b32 s29, s48
    s_mov_b32 m0, s71
    v_mfma_f32_32x32x16_bf16 v[16:31], v[76:79], v[184:187], v[16:31]
    buffer_load_dwordx4 v228, s[4:7], s47 offen sc1 lds
    buffer_load_dwordx4 v229, s[72:75], s47 offen offset:1024 sc1 lds
    s_set_gpr_idx_on s31, gpr_idx(DST)
    s_nop 0
    v_cvt_pk_bf16_f32 v194, v242, v243
    s_set_gpr_idx_off
    s_mov_b32 s30, s3
    s_cmp_eq_u32 s34, 0
    s_cselect_b32 s56, s33, 0
    v_mfma_f32_32x32x16_bf16 v[32:47], v[72:75], v[188:191], v[32:47]
    s_mov_b32 s32, s31
    s_mov_b32 s31, s35
    v_mul_f32 v242, v0, v144
    v_fma_f32 v240, v8, v160, -v240
    v_fmac_f32 v242, v1, v145
    v_fmac_f32 v240, v9, v161
    v_fmac_f32 v242, v2, v146
    v_mfma_f32_32x32x16_bf16 v[48:63], v[76:79], v[188:191], v[48:63]
    s_setprio 0
    v_fmac_f32 v240, v10, v162
    v_fmac_f32 v242, v3, v147
    v_fmac_f32 v240, v11, v163
    v_fmac_f32 v242, v4, v148
    v_fmac_f32 v240, v12, v164
    v_fmac_f32 v242, v5, v149
    v_fmac_f32 v240, v13, v165
    v_fmac_f32 v242, v6, v150
    v_fmac_f32 v240, v14, v166
    v_fmac_f32 v242, v7, v151
    v_fmac_f32 v240, v15, v167
    v_add_u32 v249, s26, v249
    v_add_u32 v250, s26, v250
    v_fma_f32 v244, v16, v160, -v244
    v_fmac_f32 v236, v24, v112
    v_fmac_f32 v244, v17, v161
    v_fmac_f32 v236, v25, v113
    v_fmac_f32 v244, v18, v162
    v_fmac_f32 v236, v26, v114
    v_fmac_f32 v244, v19, v163
    v_fmac_f32 v236, v27, v115
    v_fmac_f32 v244, v20, v164
    v_fmac_f32 v236, v28, v116
    v_fmac_f32 v244, v21, v165
    v_fmac_f32 v236, v29, v117
    v_fmac_f32 v244, v22, v166
    v_fmac_f32 v236, v30, v118
    v_fmac_f32 v244, v23, v167
    v_fmac_f32 v236, v31, v119
    ds_read_b64_tr_b16 v[0:1], v249 offset:0
    ds_read_b64_tr_b16 v[2:3], v249 offset:128
    ds_read_b128 v[4:7], v250 offset:0
    ds_read_b128 v[8:11], v250 offset:16
    ds_read_b128 v[12:15], v250 offset:384
    ds_read_b128 v[16:19], v250 offset:400
    v_mul_f32 v243, v32, v152
    v_fma_f32 v241, v40, v168, -v241
    v_fmac_f32 v243, v33, v153
    v_fmac_f32 v241, v41, v169
    v_fmac_f32 v243, v34, v154
    v_fmac_f32 v241, v42, v170
    v_fmac_f32 v243, v35, v155
    v_fmac_f32 v241, v43, v171
    v_fmac_f32 v243, v36, v156
    v_fmac_f32 v241, v44, v172
    v_fmac_f32 v243, v37, v157
    v_fmac_f32 v241, v45, v173
    v_fmac_f32 v243, v38, v158
    v_fmac_f32 v241, v46, v174
    v_fmac_f32 v243, v39, v159
    v_fmac_f32 v241, v47, v175
    ds_read_b64_tr_b16 v[20:21], v249 offset:512
    ds_read_b64_tr_b16 v[22:23], v249 offset:640
    ds_read_b128 v[24:27], v250 offset:64
    ds_read_b128 v[28:31], v250 offset:80
    ds_read_b128 v[32:35], v250 offset:448
    ds_read_b128 v[36:39], v250 offset:464
    v_fma_f32 v245, v48, v168, -v245
    v_fmac_f32 v237, v56, v120
    v_fmac_f32 v245, v49, v169
    v_fmac_f32 v237, v57, v121
    v_fmac_f32 v245, v50, v170
    v_fmac_f32 v237, v58, v122
    v_fmac_f32 v245, v51, v171
    v_fmac_f32 v237, v59, v123
    v_fmac_f32 v245, v52, v172
    v_fmac_f32 v237, v60, v124
    v_fmac_f32 v245, v53, v173
    v_fmac_f32 v237, v61, v125
    v_fmac_f32 v245, v54, v174
    v_fmac_f32 v237, v62, v126
    v_fmac_f32 v245, v55, v175
    v_fmac_f32 v237, v63, v127
    s_cmp_eq_u32 s56, 2
    s_cbranch_scc1 K2_U20
    s_cmp_eq_u32 s56, 3
    s_cbranch_scc1 K2_U30
    s_branch K2_DSP0
K2_PAD_U30:
    s_branch K2_HOP
K2_U30:
    s_setprio 1
    s_waitcnt lgkmcnt(6)
    v_lshlrev_b32 v40, 16, v0
    v_and_b32 v41, 0xffff0000, v0
    v_lshlrev_b32 v42, 16, v1
    v_and_b32 v43, 0xffff0000, v1
    v_lshlrev_b32 v44, 16, v2
    v_and_b32 v45, 0xffff0000, v2
    v_lshlrev_b32 v46, 16, v3
    v_and_b32 v47, 0xffff0000, v3
    v_mul_f32 v4, v40, v4
    v_mul_f32 v5, v41, v5
    v_mul_f32 v6, v42, v6
    v_mul_f32 v7, v43, v7
    v_mul_f32 v8, v44, v8
    v_mul_f32 v9, v45, v9
    v_mul_f32 v10, v46, v10
    v_mul_f32 v11, v47, v11
    v_cvt_pk_bf16_f32 v64, v4, v5
    v_cvt_pk_bf16_f32 v65, v6, v7
    v_cvt_pk_bf16_f32 v66, v8, v9
    v_cvt_pk_bf16_f32 v67, v10, v11
    v_mul_f32 v12, v40, v12
    v_mul_f32 v13, v41, v13
    v_mul_f32 v14, v42, v14
    v_mul_f32 v15, v43, v15
    v_mul_f32 v16, v44, v16
    v_mul_f32 v17, v45, v17
    v_mul_f32 v18, v46, v18
    v_mul_f32 v19, v47, v19
    v_cvt_pk_bf16_f32 v68, v12, v13
    v_cvt_pk_bf16_f32 v69, v14, v15
    v_cvt_pk_bf16_f32 v70, v16, v17
    v_cvt_pk_bf16_f32 v71, v18, v19
    ds_read_b64_tr_b16 v[0:1], v249 offset:1024
    ds_read_b64_tr_b16 v[2:3], v249 offset:1152
    ds_read_b128 v[4:7], v250 offset:128
    ds_read_b128 v[8:11], v250 offset:144
    ds_read_b128 v[12:15], v250 offset:512
    ds_read_b128 v[16:19], v250 offset:528
    s_waitcnt lgkmcnt(6)
    v_lshlrev_b32 v48, 16, v20
    v_and_b32 v49, 0xffff0000, v20
    v_lshlrev_b32 v50, 16, v21
    v_and_b32 v51, 0xffff0000, v21
    v_lshlrev_b32 v52, 16, v22
    v_and_b32 v53, 0xffff0000, v22
    v_lshlrev_b32 v54, 16, v23
    v_and_b32 v55, 0xffff0000, v23
    v_mul_f32 v24, v48, v24
    v_mul_f32 v25, v49, v25
    v_mul_f32 v26, v50, v26
    v_mul_f32 v27, v51, v27
    v_mul_f32 v28, v52, v28
    v_mul_f32 v29, v53, v29
    v_mul_f32 v30, v54, v30
    v_mul_f32 v31, v55, v31
    v_cvt_pk_bf16_f32 v72, v24, v25
    v_cvt_pk_bf16_f32 v73, v26, v27
    v_cvt_pk_bf16_f32 v74, v28, v29
    v_cvt_pk_bf16_f32 v75, v30, v31
    v_mul_f32 v32, v48, v32
    v_mul_f32 v33, v49, v33
    v_mul_f32 v34, v50, v34
    v_mul_f32 v35, v51, v35
    v_mul_f32 v36, v52, v36
    v_mul_f32 v37, v53, v37
    v_mul_f32 v38, v54, v38
    v_mul_f32 v39, v55, v39
    v_cvt_pk_bf16_f32 v76, v32, v33
    v_cvt_pk_bf16_f32 v77, v34, v35
    v_cvt_pk_bf16_f32 v78, v36, v37
    v_cvt_pk_bf16_f32 v79, v38, v39
    s_waitcnt lgkmcnt(4)
    v_lshlrev_b32 v40, 16, v0
    v_and_b32 v41, 0xffff0000, v0
    v_lshlrev_b32 v42, 16, v1
    v_and_b32 v43, 0xffff0000, v1
    v_lshlrev_b32 v44, 16, v2
    v_and_b32 v45, 0xffff0000, v2
    v_lshlrev_b32 v46, 16, v3
    v_and_b32 v47, 0xffff0000, v3
    s_waitcnt lgkmcnt(2)
    v_mul_f32 v4, v40, v4
    v_mul_f32 v5, v41, v5
    v_mul_f32 v6, v42, v6
    v_mul_f32 v7, v43, v7
    v_mul_f32 v8, v44, v8
    v_mul_f32 v9, v45, v9
    v_mul_f32 v10, v46, v10
    v_mul_f32 v11, v47, v11
    v_cvt_pk_bf16_f32 v80, v4, v5
    v_cvt_pk_bf16_f32 v81, v6, v7
    v_cvt_pk_bf16_f32 v82, v8, v9
    v_cvt_pk_bf16_f32 v83, v10, v11
    s_waitcnt lgkmcnt(0)
    v_mul_f32 v12, v40, v12
    v_mul_f32 v13, v41, v13
    v_mul_f32 v14, v42, v14
    v_mul_f32 v15, v43, v15
    v_mul_f32 v16, v44, v16
    v_mul_f32 v17, v45, v17
    v_mul_f32 v18, v46, v18
    v_mul_f32 v19, v47, v19
    v_cvt_pk_bf16_f32 v84, v12, v13
    v_cvt_pk_bf16_f32 v85, v14, v15
    v_cvt_pk_bf16_f32 v86, v16, v17
    v_cvt_pk_bf16_f32 v87, v18, v19
    s_waitcnt vmcnt(4)
    v_mfma_f32_32x32x16_bf16 v[0:15], v[64:67], v[176:179], 0
    ds_read_b64_tr_b16 v[184:185], v246 offset:2048
    ds_read_b64_tr_b16 v[186:187], v246 offset:2560
    ds_read_b64_tr_b16 v[188:189], v247 offset:2048
    ds_read_b64_tr_b16 v[190:191], v247 offset:2560
    s_mov_b32 m0, s68
    v_mfma_f32_32x32x16_bf16 v[16:31], v[68:71], v[176:179], 0
    buffer_load_dwordx4 v224, s[4:7], s41 offen sc1 lds
    buffer_load_dwordx4 v225, s[72:75], s41 offen offset:1024 sc1 lds
    v_permlane32_swap_b32 v242, v236
    v_permlane32_swap_b32 v243, v237
    s_add_u32 s38, s38, 1
    v_mfma_f32_32x32x16_bf16 v[32:47], v[64:67], v[180:183], 0
    v_permlane32_swap_b32 v244, v238
    v_permlane32_swap_b32 v245, v239
    v_permlane32_swap_b32 v240, v241
    v_add_f32 v242, v242, v236
    v_mfma_f32_32x32x16_bf16 v[48:63], v[68:71], v[180:183], 0
    v_add_f32 v243, v243, v237
    v_add_f32 v244, v244, v238
    v_add_f32 v245, v245, v239
    v_add_f32 v240, -v240, -v241
    v_mov_b32 v254, s52
    v_mov_b32 v255, s38
    s_waitcnt vmcnt(4) lgkmcnt(0)
    v_mfma_f32_32x32x16_bf16 v[0:15], v[72:75], v[184:187], v[0:15]
    ds_read_b64_tr_b16 v[176:177], v246 offset:4096
    ds_read_b64_tr_b16 v[178:179], v246 offset:4608
    ds_read_b64_tr_b16 v[180:181], v247 offset:4096
    ds_read_b64_tr_b16 v[182:183], v247 offset:4608
    s_lshl_b32 s58, s38, 3
    s_add_u32 s58, s58, s20
    s_mov_b32 m0, s69
    v_mfma_f32_32x32x16_bf16 v[16:31], v[76:79], v[184:187], v[16:31]
    buffer_load_dwordx4 v226, s[4:7], s41 offen sc1 lds
    buffer_load_dwordx4 v227, s[72:75], s41 offen offset:1024 sc1 lds
    s_set_gpr_idx_on s32, gpr_idx(DST)
    s_nop 0
    v_cvt_pk_bf16_f32 v195, v242, v243
    v_cvt_pk_bf16_f32 v196, v244, v245
    v_cvt_pk_bf16_f32 v197, v240, v240
    s_set_gpr_idx_off
    s_mov_b64 exec, 1
    ds_write_b32 v254, v255
    s_mov_b64 exec, -1
    s_cmp_lt_u32 s58, s22
    s_cbranch_scc0 K2_dyn_21
K2_back_22:
    v_readlane_b32 s3, v253, s58
    s_lshl_b32 s44, s34, 7
    s_lshl_b32 s60, s58, 5
    s_and_b32 s48, s3, 0x3ffff
    s_bfe_u32 s33, s3, 0x30012
    s_sub_u32 s60, s60, s48
    s_and_b32 s60, s60, 0xff
    s_add_u32 s60, s60, s48
    s_mul_i32 s35, s38, 6
    s_cmp_eq_u32 s34, 0
    s_cselect_b32 s35, s35, s60
    s_mov_b32 s45, s44
    s_add_u32 s47, s44, 256
    s_add_u32 s49, s48, 32
    s_add_u32 s60, s48, 64
    s_cmp_eq_u32 s33, 3
    s_cselect_b32 s46, s44, s47
    s_cselect_b32 s50, s60, s48
    s_cselect_b32 s51, s48, s49
    s_sub_u32 s60, s33, 2
    s_cmp_lt_u32 s60, 2
    s_cbranch_scc0 K2_rare_27
K2_back_28:
    v_mfma_f32_32x32x16_bf16 v[32:47], v[72:75], v[188:191], v[32:47]
    v_add_u32 v233, s48, v230
    ds_read_b32 v232, v233
    ds_read_b32 v233, v233 offset:1024
    v_mfma_f32_32x32x16_bf16 v[48:63], v[76:79], v[188:191], v[48:63]
    s_waitcnt vmcnt(4) lgkmcnt(3)
    v_mfma_f32_32x32x16_bf16 v[0:15], v[80:83], v[176:179], v[0:15]
    ds_read_b64_tr_b16 v[184:185], v246 offset:6144
    ds_read_b64_tr_b16 v[186:187], v246 offset:6656
    ds_read_b64_tr_b16 v[188:189], v247 offset:6144
    ds_read_b64_tr_b16 v[190:191], v247 offset:6656
    s_mov_b32 m0, s70
    v_mfma_f32_32x32x16_bf16 v[16:31], v[84:87], v[176:179], v[16:31]
    buffer_load_dwordx4 v222, s[4:7], s42 offen sc1 lds
    buffer_load_dwordx4 v223, s[72:75], s42 offen offset:1024 sc1 lds
    v_mfma_f32_32x32x16_bf16 v[32:47], v[80:83], v[180:183], v[32:47]
    s_nop 2
    v_mul_f32 v234, v0, v96
    v_mul_f32 v236, v8, v128
    v_fmac_f32 v234, v1, v97
    v_fmac_f32 v236, v9, v129
    v_fmac_f32 v234, v2, v98
    v_fmac_f32 v236, v10, v130
    v_fmac_f32 v234, v3, v99
    v_mfma_f32_32x32x16_bf16 v[48:63], v[84:87], v[180:183], v[48:63]
    s_setprio 0
    s_waitcnt lgkmcnt(4)
    v_or_b32 v232, v232, v231
    v_or_b32 v233, v233, v231
    s_cmp_lg_u32 s34, 0
    s_cbranch_scc1 K2_dum_30
    s_add_u32 m0, s48, 864
    s_add_u32 s65, s48, 1888
    buffer_load_dwordx4 v232, s[16:19], 0 offen  lds
    s_mov_b32 m0, s65
    s_mov_b32 exec_hi, 0
    buffer_load_dwordx4 v233, s[16:19], 0 offen  lds
    s_cmp_eq_u32 s33, 4
    s_cbranch_scc1 K2_a4_31
K2_b4_33:
    s_mov_b32 exec_hi, -1
K2_back_32:
    v_fmac_f32 v236, v11, v131
    v_fmac_f32 v234, v4, v100
    v_fmac_f32 v236, v12, v132
    v_fmac_f32 v234, v5, v101
    v_fmac_f32 v236, v13, v133
    v_fmac_f32 v234, v6, v102
    v_fmac_f32 v236, v14, v134
    v_fmac_f32 v234, v7, v103
    v_fmac_f32 v236, v15, v135
    v_mul_f32 v238, v16, v128
    v_mul_f32 v240, v24, v128
    v_fmac_f32 v238, v17, v129
    v_fmac_f32 v240, v25, v129
    v_fmac_f32 v238, v18, v130
    v_fmac_f32 v240, v26, v130
    v_fmac_f32 v238, v19, v131
    v_fmac_f32 v240, v27, v131
    v_fmac_f32 v238, v20, v132
    v_fmac_f32 v240, v28, v132
    v_fmac_f32 v238, v21, v133
    v_fmac_f32 v240, v29, v133
    v_fmac_f32 v238, v22, v134
    v_fmac_f32 v240, v30, v134
    v_fmac_f32 v238, v23, v135
    v_fmac_f32 v240, v31, v135
    v_mul_f32 v235, v32, v104
    v_mul_f32 v237, v40, v136
    v_fmac_f32 v235, v33, v105
    v_fmac_f32 v237, v41, v137
    v_fmac_f32 v235, v34, v106
    v_fmac_f32 v237, v42, v138
    v_fmac_f32 v235, v35, v107
    v_fmac_f32 v237, v43, v139
    v_fmac_f32 v235, v36, v108
    v_fmac_f32 v237, v44, v140
    v_fmac_f32 v235, v37, v109
    v_fmac_f32 v237, v45, v141
    v_fmac_f32 v235, v38, v110
    v_fmac_f32 v237, v46, v142
    v_fmac_f32 v235, v39, v111
    v_fmac_f32 v237, v47, v143
    v_mul_f32 v239, v48, v136
    v_mul_f32 v241, v56, v136
    s_setprio 1
    s_waitcnt vmcnt(6) lgkmcnt(0)
    v_mfma_f32_32x32x16_bf16 v[0:15], v[64:67], v[184:187], 0
    ds_read_b64_tr_b16 v[176:177], v246 offset:0
    ds_read_b64_tr_b16 v[178:179], v246 offset:512
    ds_read_b64_tr_b16 v[180:181], v247 offset:0
    ds_read_b64_tr_b16 v[182:183], v247 offset:512
    v_fmac_f32 v239, v49, v137
    v_fmac_f32 v241, v57, v137
    s_mov_b32 m0, s71
    v_mfma_f32_32x32x16_bf16 v[16:31], v[68:71], v[184:187], 0
    buffer_load_dwordx4 v224, s[4:7], s42 offen sc1 lds
    buffer_load_dwordx4 v225, s[72:75], s42 offen offset:1024 sc1 lds
    v_fmac_f32 v239, v50, v138
    v_fmac_f32 v241, v58, v138
    v_fmac_f32 v239, v51, v139
    v_fmac_f32 v241, v59, v139
    v_fmac_f32 v239, v52, v140
    v_mfma_f32_32x32x16_bf16 v[32:47], v[64:67], v[188:191], 0
    v_fmac_f32 v241, v60, v140
    v_fmac_f32 v239, v53, v141
    v_fmac_f32 v241, v61, v141
    v_fmac_f32 v239, v54, v142
    v_fmac_f32 v241, v62, v142
    v_fmac_f32 v239, v55, v143
    v_fmac_f32 v241, v63, v143
    v_mfma_f32_32x32x16_bf16 v[48:63], v[68:71], v[188:191], 0
    v_permlane32_swap_b32 v234, v236
    v_permlane32_swap_b32 v235, v237
    v_permlane32_swap_b32 v240, v238
    s_waitcnt vmcnt(6) lgkmcnt(0)
    v_mfma_f32_32x32x16_bf16 v[0:15], v[72:75], v[176:179], v[0:15]
    ds_read_b64_tr_b16 v[184:185], v246 offset:2048
    ds_read_b64_tr_b16 v[186:187], v246 offset:2560
    ds_read_b64_tr_b16 v[188:189], v247 offset:2048
    ds_read_b64_tr_b16 v[190:191], v247 offset:2560
    v_permlane32_swap_b32 v241, v239
    s_mov_b32 m0, s68
    v_mfma_f32_32x32x16_bf16 v[16:31], v[76:79], v[176:179], v[16:31]
    buffer_load_dwordx4 v226, s[4:7], s42 offen sc1 lds
    buffer_load_dwordx4 v227, s[72:75], s42 offen offset:1024 sc1 lds
    v_add_f32 v234, v234, v236
    v_add_f32 v235, v235, v237
    v_add_f32 v240, v240, v238
    v_add_f32 v241, v241, v239
    v_mfma_f32_32x32x16_bf16 v[32:47], v[72:75], v[180:183], v[32:47]
    s_set_gpr_idx_on s31, gpr_idx(DST)
    s_nop 0
    v_cvt_pk_bf16_f32 v192, v234, v235
    v_cvt_pk_bf16_f32 v193, v240, v241
    s_set_gpr_idx_off
    v_mfma_f32_32x32x16_bf16 v[48:63], v[76:79], v[180:183], v[48:63]
    s_waitcnt vmcnt(6) lgkmcnt(0)
    v_mfma_f32_32x32x16_bf16 v[0:15], v[80:83], v[184:187], v[0:15]
    ds_read_b64_tr_b16 v[176:177], v246 offset:4096
    ds_read_b64_tr_b16 v[178:179], v246 offset:4608
    ds_read_b64_tr_b16 v[180:181], v247 offset:4096
    ds_read_b64_tr_b16 v[182:183], v247 offset:4608
    s_mov_b32 m0, s69
    v_mfma_f32_32x32x16_bf16 v[16:31], v[84:87], v[184:187], v[16:31]
    buffer_load_dwordx4 v222, s[4:7], s43 offen sc1 lds
    buffer_load_dwordx4 v223, s[72:75], s43 offen offset:1024 sc1 lds
    v_mfma_f32_32x32x16_bf16 v[32:47], v[80:83], v[188:191], v[32:47]
    s_nop 2
    v_mul_f32 v234, v0, v144
    v_mul_f32 v236, v8, v112
    v_fmac_f32 v234, v1, v145
    v_fmac_f32 v236, v9, v113
    v_fmac_f32 v234, v2, v146
    v_fmac_f32 v236, v10, v114
    v_fmac_f32 v234, v3, v147
    v_mfma_f32_32x32x16_bf16 v[48:63], v[84:87], v[188:191], v[48:63]
    s_setprio 0
    v_fmac_f32 v236, v11, v115
    v_fmac_f32 v234, v4, v148
    v_fmac_f32 v236, v12, v116
    v_fmac_f32 v234, v5, v149
    v_fmac_f32 v236, v13, v117
    v_fmac_f32 v234, v6, v150
    v_fmac_f32 v236, v14, v118
    v_fmac_f32 v234, v7, v151
    v_fmac_f32 v236, v15, v119
    v_mul_f32 v238, v16, v160
    v_mul_f32 v240, v24, v160
    v_fmac_f32 v238, v17, v161
    v_fmac_f32 v240, v25, v161
    v_fmac_f32 v238, v18, v162
    v_fmac_f32 v240, v26, v162
    v_fmac_f32 v238, v19, v163
    v_fmac_f32 v240, v27, v163
    v_fmac_f32 v238, v20, v164
    v_fmac_f32 v240, v28, v164
    v_fmac_f32 v238, v21, v165
    v_fmac_f32 v240, v29, v165
    v_fmac_f32 v238, v22, v166
    v_fmac_f32 v240, v30, v166
    v_fmac_f32 v238, v23, v167
    v_fmac_f32 v240, v31, v167
    v_mul_f32 v235, v32, v152
    v_mul_f32 v237, v40, v120
    v_fmac_f32 v235, v33, v153
    v_fmac_f32 v237, v41, v121
    v_fmac_f32 v235, v34, v154
    v_fmac_f32 v237, v42, v122
    v_fmac_f32 v235, v35, v155
    v_fmac_f32 v237, v43, v123
    v_fmac_f32 v235, v36, v156
    v_fmac_f32 v237, v44, v124
    v_fmac_f32 v235, v37, v157
    v_fmac_f32 v237, v45, v125
    v_fmac_f32 v235, v38, v158
    v_fmac_f32 v237, v46, v126
    v_fmac_f32 v235, v39, v159
    v_fmac_f32 v237, v47, v127
    v_mul_f32 v239, v48, v168
    v_mul_f32 v241, v56, v168
    v_fmac_f32 v239, v49, v169
    v_fmac_f32 v241, v57, v169
    s_setprio 1
    s_waitcnt vmcnt(4) lgkmcnt(0)
    v_mfma_f32_32x32x16_bf16 v[0:15], v[64:67], v[176:179], 0
    ds_read_b64_tr_b16 v[184:185], v246 offset:6144
    ds_read_b64_tr_b16 v[186:187], v246 offset:6656
    ds_read_b64_tr_b16 v[188:189], v247 offset:6144
    ds_read_b64_tr_b16 v[190:191], v247 offset:6656
    v_fmac_f32 v239, v50, v170
    v_fmac_f32 v241, v58, v170
    s_mov_b32 m0, s70
    v_mfma_f32_32x32x16_bf16 v[16:31], v[68:71], v[176:179], 0
    buffer_load_dwordx4 v224, s[4:7], s43 offen sc1 lds
    buffer_load_dwordx4 v225, s[72:75], s43 offen offset:1024 sc1 lds
    v_fmac_f32 v239, v51, v171
    v_fmac_f32 v241, v59, v171
    v_fmac_f32 v239, v52, v172
    v_fmac_f32 v241, v60, v172
    v_fmac_f32 v239, v53, v173
    v_mfma_f32_32x32x16_bf16 v[32:47], v[64:67], v[180:183], 0
    v_add_u32 v222, s48, v251
    ds_read_b32 v222, v222
    v_fmac_f32 v241, v61, v173
    v_fmac_f32 v239, v54, v174
    v_fmac_f32 v241, v62, v174
    v_fmac_f32 v239, v55, v175
    v_fmac_f32 v241, v63, v175
    v_mfma_f32_32x32x16_bf16 v[48:63], v[68:71], v[180:183], 0
    s_waitcnt vmcnt(4) lgkmcnt(1)
    v_mfma_f32_32x32x16_bf16 v[0:15], v[72:75], v[184:187], v[0:15]
    ds_read_b64_tr_b16 v[176:177], v246 offset:0
    ds_read_b64_tr_b16 v[178:179], v246 offset:512
    ds_read_b64_tr_b16 v[180:181], v247 offset:0
    ds_read_b64_tr_b16 v[182:183], v247 offset:512
    s_mov_b32 m0, s71
    v_mfma_f32_32x32x16_bf16 v[16:31], v[76:79], v[184:187], v[16:31]
    buffer_load_dwordx4 v226, s[4:7], s43 offen sc1 lds
    buffer_load_dwordx4 v227, s[72:75], s43 offen offset:1024 sc1 lds
    s_waitcnt lgkmcnt(4)
    v_mad_u32_u16 v223, v222, s39, v248 op_sel:[1,0,0,0]
    v_mad_u32_u16 v222, v222, s39, v248
    v_mfma_f32_32x32x16_bf16 v[32:47], v[72:75], v[188:191], v[32:47]
    v_add_u32 v224, s49, v251
    ds_read_b32 v224, v224
    v_mfma_f32_32x32x16_bf16 v[48:63], v[76:79], v[188:191], v[48:63]
    s_waitcnt vmcnt(4) lgkmcnt(1)
    v_mfma_f32_32x32x16_bf16 v[0:15], v[80:83], v[176:179], v[0:15]
    ds_read_b64_tr_b16 v[184:185], v246 offset:2048
    ds_read_b64_tr_b16 v[186:187], v246 offset:2560
    ds_read_b64_tr_b16 v[188:189], v247 offset:2048
    ds_read_b64_tr_b16 v[190:191], v247 offset:2560
    s_mov_b32 m0, s68
    v_mfma_f32_32x32x16_bf16 v[16:31], v[84:87], v[176:179], v[16:31]
    buffer_load_dwordx4 v222, s[4:7], s44 offen sc1 lds
    buffer_load_dwordx4 v223, s[72:75], s44 offen offset:1024 sc1 lds
    s_waitcnt lgkmcnt(4)
    v_mad_u32_u16 v225, v224, s39, v248 op_sel:[1,0,0,0]
    v_mad_u32_u16 v224, v224, s39, v248
    v_mfma_f32_32x32x16_bf16 v[32:47], v[80:83], v[180:183], v[32:47]
    v_add_u32 v226, s50, v251
    ds_read_b32 v226, v226
    v_mul_f32 v242, v0, v144
    v_fma_f32 v238, v8, v160, -v238
    v_fmac_f32 v242, v1, v145
    v_fmac_f32 v238, v9, v161
    v_fmac_f32 v242, v2, v146
    v_mfma_f32_32x32x16_bf16 v[48:63], v[84:87], v[180:183], v[48:63]
    s_setprio 0
    v_fmac_f32 v238, v10, v162
    v_fmac_f32 v242, v3, v147
    v_fmac_f32 v238, v11, v163
    v_fmac_f32 v242, v4, v148
    v_fmac_f32 v238, v12, v164
    v_fmac_f32 v242, v5, v149
    v_fmac_f32 v238, v13, v165
    v_fmac_f32 v242, v6, v150
    v_fmac_f32 v238, v14, v166
    v_fmac_f32 v242, v7, v151
    v_fmac_f32 v238, v15, v167
    v_fmac_f32 v236, v16, v112
    v_mul_f32 v244, v24, v160
    v_fmac_f32 v236, v17, v113
    v_fmac_f32 v244, v25, v161
    v_fmac_f32 v236, v18, v114
    v_fmac_f32 v244, v26, v162
    v_fmac_f32 v236, v19, v115
    v_fmac_f32 v244, v27, v163
    v_fmac_f32 v236, v20, v116
    v_fmac_f32 v244, v28, v164
    v_fmac_f32 v236, v21, v117
    v_fmac_f32 v244, v29, v165
    v_fmac_f32 v236, v22, v118
    v_fmac_f32 v244, v30, v166
    v_fmac_f32 v236, v23, v119
    v_fmac_f32 v244, v31, v167
    v_mul_f32 v243, v32, v152
    v_fma_f32 v239, v40, v168, -v239
    v_fmac_f32 v243, v33, v153
    v_fmac_f32 v239, v41, v169
    v_fmac_f32 v243, v34, v154
    v_fmac_f32 v239, v42, v170
    v_fmac_f32 v243, v35, v155
    v_fmac_f32 v239, v43, v171
    v_fmac_f32 v243, v36, v156
    v_fmac_f32 v239, v44, v172
    v_fmac_f32 v243, v37, v157
    v_fmac_f32 v239, v45, v173
    v_fmac_f32 v243, v38, v158
    v_fmac_f32 v239, v46, v174
    v_fmac_f32 v243, v39, v159
    v_fmac_f32 v239, v47, v175
    v_fmac_f32 v237, v48, v120
    v_mul_f32 v245, v56, v168
    v_fmac_f32 v237, v49, v121
    v_fmac_f32 v245, v57, v169
    v_fmac_f32 v237, v50, v122
    v_fmac_f32 v245, v58, v170
    v_fmac_f32 v237, v51, v123
    s_setprio 1
    s_waitcnt vmcnt(4) lgkmcnt(1)
    v_mfma_f32_32x32x16_bf16 v[0:15], v[64:67], v[184:187], 0
    ds_read_b64_tr_b16 v[176:177], v246 offset:4096
    ds_read_b64_tr_b16 v[178:179], v246 offset:4608
    ds_read_b64_tr_b16 v[180:181], v247 offset:4096
    ds_read_b64_tr_b16 v[182:183], v247 offset:4608
    v_fmac_f32 v245, v59, v171
    v_fmac_f32 v237, v52, v124
    s_mov_b32 m0, s69
    v_mfma_f32_32x32x16_bf16 v[16:31], v[68:71], v[184:187], 0
    buffer_load_dwordx4 v224, s[4:7], s45 offen sc1 lds
    buffer_load_dwordx4 v225, s[72:75], s45 offen offset:1024 sc1 lds
    s_waitcnt lgkmcnt(4)
    v_mad_u32_u16 v227, v226, s39, v248 op_sel:[1,0,0,0]
    v_mad_u32_u16 v226, v226, s39, v248
    v_fmac_f32 v245, v60, v172
    v_fmac_f32 v237, v53, v125
    v_mfma_f32_32x32x16_bf16 v[32:47], v[64:67], v[188:191], 0
    v_add_u32 v228, s51, v251
    ds_read_b32 v228, v228
    v_fmac_f32 v245, v61, v173
    v_fmac_f32 v237, v54, v126
    v_fmac_f32 v245, v62, v174
    v_fmac_f32 v237, v55, v127
    v_fmac_f32 v245, v63, v175
    v_mfma_f32_32x32x16_bf16 v[48:63], v[68:71], v[188:191], 0
    v_permlane32_swap_b32 v242, v234
    v_permlane32_swap_b32 v243, v235
    v_add_f32 v242, v242, v234
    v_add_f32 v243, v243, v235
    s_waitcnt vmcnt(4) lgkmcnt(1)
    v_mfma_f32_32x32x16_bf16 v[0:15], v[72:75], v[176:179], v[0:15]
    ds_read_b64_tr_b16 v[184:185], v246 offset:6144
    ds_read_b64_tr_b16 v[186:187], v246 offset:6656
    ds_read_b64_tr_b16 v[188:189], v247 offset:6144
    ds_read_b64_tr_b16 v[190:191], v247 offset:6656
    s_mov_b32 m0, s70
    v_mfma_f32_32x32x16_bf16 v[16:31], v[76:79], v[176:179], v[16:31]
    buffer_load_dwordx4 v226, s[4:7], s46 offen sc1 lds
    buffer_load_dwordx4 v227, s[72:75], s46 offen offset:1024 sc1 lds
    s_waitcnt lgkmcnt(4)
    v_mad_u32_u16 v229, v228, s39, v248 op_sel:[1,0,0,0]
    v_mad_u32_u16 v228, v228, s39, v248
    s_sub_u32 s26, s48, s29
    s_mov_b32 s29, s48
    v_mfma_f32_32x32x16_bf16 v[32:47], v[72:75], v[180:183], v[32:47]
    s_set_gpr_idx_on s31, gpr_idx(DST)
    s_nop 0
    v_cvt_pk_bf16_f32 v194, v242, v243
    s_set_gpr_idx_off
    s_mov_b32 s30, s3
    s_cmp_eq_u32 s34, 0
    s_cselect_b32 s56, s33, 0
    s_mov_b32 s32, s31
    v_mfma_f32_32x32x16_bf16 v[48:63], v[76:79], v[180:183], v[48:63]
    s_mov_b32 s31, s35
    s_waitcnt vmcnt(4) lgkmcnt(0)
    v_mfma_f32_32x32x16_bf16 v[0:15], v[80:83], v[184:187], v[0:15]
    ds_read_b64_tr_b16 v[176:177], v246 offset:0
    ds_read_b64_tr_b16 v[178:179], v246 offset:512
    ds_read_b64_tr_b16 v[180:181], v247 offset:0
    ds_read_b64_tr_b16 v[182:183], v247 offset:512
    s_mov_b32 m0, s71
    v_mfma_f32_32x32x16_bf16 v[16:31], v[84:87], v[184:187], v[16:31]
    buffer_load_dwordx4 v228, s[4:7], s47 offen sc1 lds
    buffer_load_dwordx4 v229, s[72:75], s47 offen offset:1024 sc1 lds
    v_mfma_f32_32x32x16_bf16 v[32:47], v[80:83], v[188:191], v[32:47]
    s_nop 2
    v_mul_f32 v242, v0, v144
    v_fma_f32 v240, v8, v160, -v240
    v_fmac_f32 v242, v1, v145
    v_fmac_f32 v240, v9, v161
    v_fmac_f32 v242, v2, v146
    v_fmac_f32 v240, v10, v162
    v_fmac_f32 v242, v3, v147
    v_mfma_f32_32x32x16_bf16 v[48:63], v[84:87], v[188:191], v[48:63]
    s_setprio 0
    v_fmac_f32 v240, v11, v163
    v_fmac_f32 v242, v4, v148
    v_fmac_f32 v240, v12, v164
    v_fmac_f32 v242, v5, v149
    v_fmac_f32 v240, v13, v165
    v_fmac_f32 v242, v6, v150
    v_fmac_f32 v240, v14, v166
    v_fmac_f32 v242, v7, v151
    v_fmac_f32 v240, v15, v167
    v_add_u32 v249, s26, v249
    v_add_u32 v250, s26, v250
    v_fma_f32 v244, v16, v160, -v244
    v_fmac_f32 v236, v24, v112
    v_fmac_f32 v244, v17, v161
    v_fmac_f32 v236, v25, v113
    v_fmac_f32 v244, v18, v162
    v_fmac_f32 v236, v26, v114
    v_fmac_f32 v244, v19, v163
    v_fmac_f32 v236, v27, v115
    v_fmac_f32 v244, v20, v164
    v_fmac_f32 v236, v28, v116
    v_fmac_f32 v244, v21, v165
    v_fmac_f32 v236, v29, v117
    v_fmac_f32 v244, v22, v166
    v_fmac_f32 v236, v30, v118
    v_fmac_f32 v244, v23, v167
    v_fmac_f32 v236, v31, v119
    ds_read_b64_tr_b16 v[0:1], v249 offset:0
    ds_read_b64_tr_b16 v[2:3], v249 offset:128
    ds_read_b128 v[4:7], v250 offset:0
    ds_read_b128 v[8:11], v250 offset:16
    ds_read_b128 v[12:15], v250 offset:384
    ds_read_b128 v[16:19], v250 offset:400
    v_mul_f32 v243, v32, v152
    v_fma_f32 v241, v40, v168, -v241
    v_fmac_f32 v243, v33, v153
    v_fmac_f32 v241, v41, v169
    v_fmac_f32 v243, v34, v154
    v_fmac_f32 v241, v42, v170
    v_fmac_f32 v243, v35, v155
    v_fmac_f32 v241, v43, v171
    v_fmac_f32 v243, v36, v156
    v_fmac_f32 v241, v44, v172
    v_fmac_f32 v243, v37, v157
    v_fmac_f32 v241, v45, v173
    v_fmac_f32 v243, v38, v158
    v_fmac_f32 v241, v46, v174
    v_fmac_f32 v243, v39, v159
    v_fmac_f32 v241, v47, v175
    ds_read_b64_tr_b16 v[20:21], v249 offset:512
    ds_read_b64_tr_b16 v[22:23], v249 offset:640
    ds_read_b128 v[24:27], v250 offset:64
    ds_read_b128 v[28:31], v250 offset:80
    ds_read_b128 v[32:35], v250 offset:448
    ds_read_b128 v[36:39], v250 offset:464
    v_fma_f32 v245, v48, v168, -v245
    v_fmac_f32 v237, v56, v120
    v_fmac_f32 v245, v49, v169
    v_fmac_f32 v237, v57, v121
    v_fmac_f32 v245, v50, v170
    v_fmac_f32 v237, v58, v122
    v_fmac_f32 v245, v51, v171
    v_fmac_f32 v237, v59, v123
    v_fmac_f32 v245, v52, v172
    v_fmac_f32 v237, v60, v124
    v_fmac_f32 v245, v53, v173
    v_fmac_f32 v237, v61, v125
    v_fmac_f32 v245, v54, v174
    v_fmac_f32 v237, v62, v126
    v_fmac_f32 v245, v55, v175
    v_fmac_f32 v237, v63, v127
    s_cmp_eq_u32 s56, 2
    s_cbranch_scc1 K2_U20
    s_cmp_eq_u32 s56, 3
    s_cbranch_scc1 K2_U30
    s_branch K2_DSP0
K2_PAD_U21:
    s_branch K2_HOP
K2_U21:
    s_setprio 1
    s_waitcnt lgkmcnt(6)
    v_lshlrev_b32 v40, 16, v0
    v_and_b32 v41, 0xffff0000, v0
    v_lshlrev_b32 v42, 16, v1
    v_and_b32 v43, 0xffff0000, v1
    v_lshlrev_b32 v44, 16, v2
    v_and_b32 v45, 0xffff0000, v2
    v_lshlrev_b32 v46, 16, v3
    v_and_b32 v47, 0xffff0000, v3
    v_mul_f32 v4, v40, v4
    v_mul_f32 v5, v41, v5
    v_mul_f32 v6, v42, v6
    v_mul_f32 v7, v43, v7
    v_mul_f32 v8, v44, v8
    v_mul_f32 v9, v45, v9
    v_mul_f32 v10, v46, v10
    v_mul_f32 v11, v47, v11
    v_cvt_pk_bf16_f32 v64, v4, v5
    v_cvt_pk_bf16_f32 v65, v6, v7
    v_cvt_pk_bf16_f32 v66, v8, v9
    v_cvt_pk_bf16_f32 v67, v10, v11
    v_mul_f32 v12, v40, v12
    v_mul_f32 v13, v41, v13
    v_mul_f32 v14, v42, v14
    v_mul_f32 v15, v43, v15
    v_mul_f32 v16, v44, v16
    v_mul_f32 v17, v45, v17
    v_mul_f32 v18, v46, v18
    v_mul_f32 v19, v47, v19
    v_cvt_pk_bf16_f32 v68, v12, v13
    v_cvt_pk_bf16_f32 v69, v14, v15
    v_cvt_pk_bf16_f32 v70, v16, v17
    v_cvt_pk_bf16_f32 v71, v18, v19
    s_waitcnt lgkmcnt(0)
    v_lshlrev_b32 v48, 16, v20
    v_and_b32 v49, 0xffff0000, v20
    v_lshlrev_b32 v50, 16, v21
    v_and_b32 v51, 0xffff0000, v21
    v_lshlrev_b32 v52, 16, v22
    v_and_b32 v53, 0xffff0000, v22
    v_lshlrev_b32 v54, 16, v23
    v_and_b32 v55, 0xffff0000, v23
    v_mul_f32 v24, v48, v24
    v_mul_f32 v25, v49, v25
    v_mul_f32 v26, v50, v26
    v_mul_f32 v27, v51, v27
    v_mul_f32 v28, v52, v28
    v_mul_f32 v29, v53, v29
    v_mul_f32 v30, v54, v30
    v_mul_f32 v31, v55, v31
    v_cvt_pk_bf16_f32 v72, v24, v25
    v_cvt_pk_bf16_f32 v73, v26, v27
    v_cvt_pk_bf16_f32 v74, v28, v29
    v_cvt_pk_bf16_f32 v75, v30, v31
    v_mul_f32 v32, v48, v32
    v_mul_f32 v33, v49, v33
    v_mul_f32 v34, v50, v34
    v_mul_f32 v35, v51, v35
    v_mul_f32 v36, v52, v36
    v_mul_f32 v37, v53, v37
    v_mul_f32 v38, v54, v38
    v_mul_f32 v39, v55, v39
    v_cvt_pk_bf16_f32 v76, v32, v33
    v_cvt_pk_bf16_f32 v77, v34, v35
    v_cvt_pk_bf16_f32 v78, v36, v37
    v_cvt_pk_bf16_f32 v79, v38, v39
    s_waitcnt vmcnt(4)
    v_mfma_f32_32x32x16_bf16 v[0:15], v[64:67], v[176:179], 0
    ds_read_b64_tr_b16 v[184:185], v246 offset:2048
    ds_read_b64_tr_b16 v[186:187], v246 offset:2560
    ds_read_b64_tr_b16 v[188:189], v247 offset:2048
    ds_read_b64_tr_b16 v[190:191], v247 offset:2560
    s_mov_b32 m0, s68
    v_mfma_f32_32x32x16_bf16 v[16:31], v[68:71], v[176:179], 0
    buffer_load_dwordx4 v222, s[4:7], s42 offen sc1 lds
    buffer_load_dwordx4 v223, s[72:75], s42 offen offset:1024 sc1 lds
    v_permlane32_swap_b32 v242, v236
    v_permlane32_swap_b32 v243, v237
    v_mov_b32 v254, 163648
    v_mfma_f32_32x32x16_bf16 v[32:47], v[64:67], v[180:183], 0
    v_permlane32_swap_b32 v244, v238
    v_permlane32_swap_b32 v245, v239
    v_permlane32_swap_b32 v240, v241
    v_add_f32 v242, v242, v236
    v_mfma_f32_32x32x16_bf16 v[48:63], v[68:71], v[180:183], 0
    v_add_f32 v243, v243, v237
    v_add_f32 v244, v244, v238
    v_add_f32 v245, v245, v239
    v_add_f32 v240, -v240, -v241
    v_sub_u32 v241, v230, v231
    v_cvt_pk_bf16_f32 v242, v242, v243
    v_mov_b32 v255, 1
    v_lshl_add_u32 v233, v252, 1, s53
    s_mov_b64 exec, 1
    ds_add_rtn_u32 v232, v254, v255
    s_mov_b64 exec, -1
    ds_read_b32 v233, v233
    s_waitcnt vmcnt(4) lgkmcnt(2)
    v_mfma_f32_32x32x16_bf16 v[0:15], v[72:75], v[184:187], v[0:15]
    ds_read_b64_tr_b16 v[176:177], v246 offset:4096
    ds_read_b64_tr_b16 v[178:179], v246 offset:4608
    ds_read_b64_tr_b16 v[180:181], v247 offset:4096
    ds_read_b64_tr_b16 v[182:183], v247 offset:4608
    v_cvt_pk_bf16_f32 v244, v244, v245
    v_cvt_pk_bf16_f32 v240, v240, v240
    s_mov_b32 m0, s69
    v_mfma_f32_32x32x16_bf16 v[16:31], v[76:79], v[184:187], v[16:31]
    buffer_load_dwordx4 v224, s[4:7], s42 offen sc1 lds
    buffer_load_dwordx4 v225, s[72:75], s42 offen offset:1024 sc1 lds
    ds_write_b32 v230, v242 offset:768
    ds_write_b32 v230, v244 offset:1024
    ds_write_b16 v241, v240 offset:1280
    s_waitcnt lgkmcnt(7)
    v_readfirstlane_b32 s58, v232
    v_mfma_f32_32x32x16_bf16 v[32:47], v[72:75], v[188:191], v[32:47]
    s_cmp_lt_u32 s58, s22
    s_cbranch_scc0 K2_nul_34
    s_and_b32 s59, s58, 7
    s_lshr_b32 s60, s58, 3
K2_chk_36:
    v_readlane_b32 s61, v233, s59
    s_nop 0
    s_cmp_gt_u32 s61, s60
    s_cbranch_scc0 K2_spin_35
K2_back_37:
    v_mfma_f32_32x32x16_bf16 v[48:63], v[76:79], v[188:191], v[48:63]
    s_setprio 0
    v_readlane_b32 s3, v253, s58
    s_lshl_b32 s44, s34, 7
    s_lshl_b32 s60, s58, 5
    s_and_b32 s48, s3, 0x3ffff
    s_bfe_u32 s33, s3, 0x30012
    s_sub_u32 s60, s60, s48
    v_mul_f32 v234, v0, v96
    v_mul_f32 v236, v8, v128
    v_fmac_f32 v234, v1, v97
    v_fmac_f32 v236, v9, v129
    v_fmac_f32 v234, v2, v98
    v_fmac_f32 v236, v10, v130
    v_fmac_f32 v234, v3, v99
    v_fmac_f32 v236, v11, v131
    v_fmac_f32 v234, v4, v100
    v_fmac_f32 v236, v12, v132
    v_fmac_f32 v234, v5, v101
    v_fmac_f32 v236, v13, v133
    v_fmac_f32 v234, v6, v102
    v_fmac_f32 v236, v14, v134
    v_fmac_f32 v234, v7, v103
    v_fmac_f32 v236, v15, v135
    v_mul_f32 v238, v16, v128
    v_mul_f32 v240, v24, v128
    v_fmac_f32 v238, v17, v129
    v_fmac_f32 v240, v25, v129
    v_fmac_f32 v238, v18, v130
    v_fmac_f32 v240, v26, v130
    v_fmac_f32 v238, v19, v131
    v_fmac_f32 v240, v27, v131
    v_fmac_f32 v238, v20, v132
    v_fmac_f32 v240, v28, v132
    v_fmac_f32 v238, v21, v133
    v_fmac_f32 v240, v29, v133
    v_fmac_f32 v238, v22, v134
    v_fmac_f32 v240, v30, v134
    v_fmac_f32 v238, v23, v135
    v_fmac_f32 v240, v31, v135
    v_mul_f32 v235, v32, v104
    v_mul_f32 v237, v40, v136
    v_fmac_f32 v235, v33, v105
    v_fmac_f32 v237, v41, v137
    v_fmac_f32 v235, v34, v106
    v_fmac_f32 v237, v42, v138
    v_fmac_f32 v235, v35, v107
    v_fmac_f32 v237, v43, v139
    v_fmac_f32 v235, v36, v108
    v_fmac_f32 v237, v44, v140
    v_fmac_f32 v235, v37, v109
    v_fmac_f32 v237, v45, v141
    v_fmac_f32 v235, v38, v110
    v_fmac_f32 v237, v46, v142
    v_fmac_f32 v235, v39, v111
    v_fmac_f32 v237, v47, v143
    v_mul_f32 v239, v48, v136
    v_mul_f32 v241, v56, v136
    v_fmac_f32 v239, v49, v137
    v_fmac_f32 v241, v57, v137
    s_setprio 1
    s_waitcnt vmcnt(4) lgkmcnt(3)
    v_mfma_f32_32x32x16_bf16 v[0:15], v[64:67], v[176:179], 0
    ds_read_b64_tr_b16 v[184:185], v246 offset:6144
    ds_read_b64_tr_b16 v[186:187], v246 offset:6656
    ds_read_b64_tr_b16 v[188:189], v247 offset:6144
    ds_read_b64_tr_b16 v[190:191], v247 offset:6656
    v_fmac_f32 v239, v50, v138
    v_fmac_f32 v241, v58, v138
    s_mov_b32 m0, s70
    v_mfma_f32_32x32x16_bf16 v[16:31], v[68:71], v[176:179], 0
    buffer_load_dwordx4 v222, s[4:7], s43 offen sc1 lds
    buffer_load_dwordx4 v223, s[72:75], s43 offen offset:1024 sc1 lds
    v_fmac_f32 v239, v51, v139
    v_fmac_f32 v241, v59, v139
    v_fmac_f32 v239, v52, v140
    v_fmac_f32 v241, v60, v140
    v_fmac_f32 v239, v53, v141
    v_mfma_f32_32x32x16_bf16 v[32:47], v[64:67], v[180:183], 0
    s_and_b32 s60, s60, 0xff
    s_add_u32 s35, s60, s48
    s_mov_b32 s45, s44
    s_add_u32 s47, s44, 256
    s_add_u32 s49, s48, 32
    s_add_u32 s60, s48, 64
    s_cmp_eq_u32 s33, 3
    s_cselect_b32 s46, s44, s47
    s_cselect_b32 s50, s60, s48
    s_cselect_b32 s51, s48, s49
    s_sub_u32 s60, s33, 2
    s_cmp_lt_u32 s60, 2
    s_cbranch_scc0 K2_rare_38
K2_back_39:
    v_add_u32 v222, s48, v251
    ds_read_b32 v222, v222
    v_fmac_f32 v241, v61, v141
    v_fmac_f32 v239, v54, v142
    v_fmac_f32 v241, v62, v142
    v_fmac_f32 v239, v55, v143
    v_fmac_f32 v241, v63, v143
    v_mfma_f32_32x32x16_bf16 v[48:63], v[68:71], v[180:183], 0
    v_permlane32_swap_b32 v234, v236
    v_permlane32_swap_b32 v235, v237
    v_permlane32_swap_b32 v240, v238
    s_waitcnt vmcnt(4) lgkmcnt(1)
    v_mfma_f32_32x32x16_bf16 v[0:15], v[72:75], v[184:187], v[0:15]
    ds_read_b64_tr_b16 v[176:177], v246 offset:0
    ds_read_b64_tr_b16 v[178:179], v246 offset:512
    ds_read_b64_tr_b16 v[180:181], v247 offset:0
    ds_read_b64_tr_b16 v[182:183], v247 offset:512
    v_permlane32_swap_b32 v241, v239
    s_mov_b32 m0, s71
    v_mfma_f32_32x32x16_bf16 v[16:31], v[76:79], v[184:187], v[16:31]
    buffer_load_dwordx4 v224, s[4:7], s43 offen sc1 lds
    buffer_load_dwordx4 v225, s[72:75], s43 offen offset:1024 sc1 lds
    s_waitcnt lgkmcnt(4)
    v_mad_u32_u16 v223, v222, s39, v248 op_sel:[1,0,0,0]
    v_mad_u32_u16 v222, v222, s39, v248
    v_lshl_add_u32 v230, v252, 1, s31
    v_add_f32 v234, v234, v236
    v_add_f32 v235, v235, v237
    v_add_f32 v240, v240, v238
    v_add_f32 v241, v241, v239
    v_cvt_pk_bf16_f32 v234, v234, v235
    v_cvt_pk_bf16_f32 v240, v240, v241
    ds_write_b32 v230, v234 offset:0
    ds_write_b32 v230, v240 offset:256
    v_mfma_f32_32x32x16_bf16 v[32:47], v[72:75], v[188:191], v[32:47]
    v_add_u32 v224, s49, v251
    ds_read_b32 v224, v224
    v_mul_f32 v234, v0, v144
    v_mul_f32 v236, v8, v112
    v_fmac_f32 v234, v1, v145
    v_fmac_f32 v236, v9, v113
    v_fmac_f32 v234, v2, v146
    v_mfma_f32_32x32x16_bf16 v[48:63], v[76:79], v[188:191], v[48:63]
    s_setprio 0
    v_fmac_f32 v236, v10, v114
    v_fmac_f32 v234, v3, v147
    v_fmac_f32 v236, v11, v115
    v_fmac_f32 v234, v4, v148
    v_fmac_f32 v236, v12, v116
    v_fmac_f32 v234, v5, v149
    v_fmac_f32 v236, v13, v117
    v_fmac_f32 v234, v6, v150
    v_fmac_f32 v236, v14, v118
    v_fmac_f32 v234, v7, v151
    v_fmac_f32 v236, v15, v119
    v_mul_f32 v238, v16, v160
    v_mul_f32 v240, v24, v160
    v_fmac_f32 v238, v17, v161
    v_fmac_f32 v240, v25, v161
    v_fmac_f32 v238, v18, v162
    v_fmac_f32 v240, v26, v162
    v_fmac_f32 v238, v19, v163
    v_fmac_f32 v240, v27, v163
    v_fmac_f32 v238, v20, v164
    v_fmac_f32 v240, v28, v164
    v_fmac_f32 v238, v21, v165
    v_fmac_f32 v240, v29, v165
    v_fmac_f32 v238, v22, v166
    v_fmac_f32 v240, v30, v166
    v_fmac_f32 v238, v23, v167
    v_fmac_f32 v240, v31, v167
    v_mul_f32 v235, v32, v152
    v_mul_f32 v237, v40, v120
    v_fmac_f32 v235, v33, v153
    v_fmac_f32 v237, v41, v121
    v_fmac_f32 v235, v34, v154
    v_fmac_f32 v237, v42, v122
    v_fmac_f32 v235, v35, v155
    v_fmac_f32 v237, v43, v123
    v_fmac_f32 v235, v36, v156
    v_fmac_f32 v237, v44, v124
    v_fmac_f32 v235, v37, v157
    v_fmac_f32 v237, v45, v125
    v_fmac_f32 v235, v38, v158
    v_fmac_f32 v237, v46, v126
    v_fmac_f32 v235, v39, v159
    v_fmac_f32 v237, v47, v127
    v_mul_f32 v239, v48, v168
    v_mul_f32 v241, v56, v168
    v_fmac_f32 v239, v49, v169
    v_fmac_f32 v241, v57, v169
    v_fmac_f32 v239, v50, v170
    v_fmac_f32 v241, v58, v170
    v_fmac_f32 v239, v51, v171
    s_setprio 1
    s_waitcnt vmcnt(4) lgkmcnt(3)
    v_mfma_f32_32x32x16_bf16 v[0:15], v[64:67], v[176:179], 0
    ds_read_b64_tr_b16 v[184:185], v246 offset:2048
    ds_read_b64_tr_b16 v[186:187], v246 offset:2560
    ds_read_b64_tr_b16 v[188:189], v247 offset:2048
    ds_read_b64_tr_b16 v[190:191], v247 offset:2560
    v_fmac_f32 v241, v59, v171
    v_fmac_f32 v239, v52, v172
    s_mov_b32 m0, s68
    v_mfma_f32_32x32x16_bf16 v[16:31], v[68:71], v[176:179], 0
    buffer_load_dwordx4 v222, s[4:7], s44 offen sc1 lds
    buffer_load_dwordx4 v223, s[72:75], s44 offen offset:1024 sc1 lds
    s_waitcnt lgkmcnt(4)
    v_mad_u32_u16 v225, v224, s39, v248 op_sel:[1,0,0,0]
    v_mad_u32_u16 v224, v224, s39, v248
    v_fmac_f32 v241, v60, v172
    v_fmac_f32 v239, v53, v173
    v_mfma_f32_32x32x16_bf16 v[32:47], v[64:67], v[180:183], 0
    v_add_u32 v226, s50, v251
    ds_read_b32 v226, v226
    v_fmac_f32 v241, v61, v173
    v_fmac_f32 v239, v54, v174
    v_fmac_f32 v241, v62, v174
    v_fmac_f32 v239, v55, v175
    v_fmac_f32 v241, v63, v175
    v_mfma_f32_32x32x16_bf16 v[48:63], v[68:71], v[180:183], 0
    s_waitcnt vmcnt(4) lgkmcnt(1)
    v_mfma_f32_32x32x16_bf16 v[0:15], v[72:75], v[184:187], v[0:15]
    ds_read_b64_tr_b16 v[176:177], v246 offset:4096
    ds_read_b64_tr_b16 v[178:179], v246 offset:4608
    ds_read_b64_tr_b16 v[180:181], v247 offset:4096
    ds_read_b64_tr_b16 v[182:183], v247 offset:4608
    s_mov_b32 m0, s69
    v_mfma_f32_32x32x16_bf16 v[16:31], v[76:79], v[184:187], v[16:31]
    buffer_load_dwordx4 v224, s[4:7], s45 offen sc1 lds
    buffer_load_dwordx4 v225, s[72:75], s45 offen offset:1024 sc1 lds
    s_waitcnt lgkmcnt(4)
    v_mad_u32_u16 v227, v226, s39, v248 op_sel:[1,0,0,0]
    v_mad_u32_u16 v226, v226, s39, v248
    v_mfma_f32_32x32x16_bf16 v[32:47], v[72:75], v[188:191], v[32:47]
    v_add_u32 v228, s51, v251
    ds_read_b32 v228, v228
    v_mul_f32 v242, v0, v144
    v_fma_f32 v238, v8, v160, -v238
    v_fmac_f32 v242, v1, v145
    v_fmac_f32 v238, v9, v161
    v_fmac_f32 v242, v2, v146
    v_mfma_f32_32x32x16_bf16 v[48:63], v[76:79], v[188:191], v[48:63]
    s_setprio 0
    v_fmac_f32 v238, v10, v162
    v_fmac_f32 v242, v3, v147
    v_fmac_f32 v238, v11, v163
    v_fmac_f32 v242, v4, v148
    v_fmac_f32 v238, v12, v164
    v_fmac_f32 v242, v5, v149
    v_fmac_f32 v238, v13, v165
    v_fmac_f32 v242, v6, v150
    v_fmac_f32 v238, v14, v166
    v_fmac_f32 v242, v7, v151
    v_fmac_f32 v238, v15, v167
    v_fmac_f32 v236, v16, v112
    v_mul_f32 v244, v24, v160
    v_fmac_f32 v236, v17, v113
    v_fmac_f32 v244, v25, v161
    v_fmac_f32 v236, v18, v114
    v_fmac_f32 v244, v26, v162
    v_fmac_f32 v236, v19, v115
    v_fmac_f32 v244, v27, v163
    v_fmac_f32 v236, v20, v116
    v_fmac_f32 v244, v28, v164
    v_fmac_f32 v236, v21, v117
    v_fmac_f32 v244, v29, v165
    v_fmac_f32 v236, v22, v118
    v_fmac_f32 v244, v30, v166
    v_fmac_f32 v236, v23, v119
    v_fmac_f32 v244, v31, v167
    v_mul_f32 v243, v32, v152
    v_fma_f32 v239, v40, v168, -v239
    v_fmac_f32 v243, v33, v153
    v_fmac_f32 v239, v41, v169
    v_fmac_f32 v243, v34, v154
    v_fmac_f32 v239, v42, v170
    v_fmac_f32 v243, v35, v155
    v_fmac_f32 v239, v43, v171
    v_fmac_f32 v243, v36, v156
    v_fmac_f32 v239, v44, v172
    v_fmac_f32 v243, v37, v157
    v_fmac_f32 v239, v45, v173
    v_fmac_f32 v243, v38, v158
    v_fmac_f32 v239, v46, v174
    v_fmac_f32 v243, v39, v159
    v_fmac_f32 v239, v47, v175
    v_fmac_f32 v237, v48, v120
    v_mul_f32 v245, v56, v168
    v_fmac_f32 v237, v49, v121
    v_fmac_f32 v245, v57, v169
    v_fmac_f32 v237, v50, v122
    s_setprio 1
    s_waitcnt vmcnt(4) lgkmcnt(1)
    v_mfma_f32_32x32x16_bf16 v[0:15], v[64:67], v[176:179], 0
    ds_read_b64_tr_b16 v[184:185], v246 offset:6144
    ds_read_b64_tr_b16 v[186:187], v246 offset:6656
    ds_read_b64_tr_b16 v[188:189], v247 offset:6144
    ds_read_b64_tr_b16 v[190:191], v247 offset:6656
    v_fmac_f32 v245, v58, v170
    v_fmac_f32 v237, v51, v123
    s_mov_b32 m0, s70
    v_mfma_f32_32x32x16_bf16 v[16:31], v[68:71], v[176:179], 0
    buffer_load_dwordx4 v226, s[4:7], s46 offen sc1 lds
    buffer_load_dwordx4 v227, s[72:75], s46 offen offset:1024 sc1 lds
    s_waitcnt lgkmcnt(4)
    v_mad_u32_u16 v229, v228, s39, v248 op_sel:[1,0,0,0]
    v_mad_u32_u16 v228, v228, s39, v248
    v_fmac_f32 v245, v59, v171
    v_fmac_f32 v237, v52, v124
    v_mfma_f32_32x32x16_bf16 v[32:47], v[64:67], v[180:183], 0
    v_fmac_f32 v245, v60, v172
    v_fmac_f32 v237, v53, v125
    v_fmac_f32 v245, v61, v173
    v_fmac_f32 v237, v54, v126
    v_fmac_f32 v245, v62, v174
    v_fmac_f32 v237, v55, v127
    v_fmac_f32 v245, v63, v175
    v_mfma_f32_32x32x16_bf16 v[48:63], v[68:71], v[180:183], 0
    v_permlane32_swap_b32 v242, v234
    v_permlane32_swap_b32 v243, v235
    v_add_f32 v242, v242, v234
    v_add_f32 v243, v243, v235
    s_waitcnt vmcnt(4) lgkmcnt(0)
    v_mfma_f32_32x32x16_bf16 v[0:15], v[72:75], v[184:187], v[0:15]
    ds_read_b64_tr_b16 v[176:177], v246 offset:0
    ds_read_b64_tr_b16 v[178:179], v246 offset:512
    ds_read_b64_tr_b16 v[180:181], v247 offset:0
    ds_read_b64_tr_b16 v[182:183], v247 offset:512
    v_cvt_pk_bf16_f32 v242, v242, v243
    ds_write_b32 v230, v242 offset:512
    s_mov_b32 m0, s71
    v_mfma_f32_32x32x16_bf16 v[16:31], v[76:79], v[184:187], v[16:31]
    buffer_load_dwordx4 v228, s[4:7], s47 offen sc1 lds
    buffer_load_dwordx4 v229, s[72:75], s47 offen offset:1024 sc1 lds
    s_sub_u32 s26, s48, s29
    s_mov_b32 s29, s48
    s_mov_b32 s30, s3
    s_cmp_lg_u32 s36, 0
    s_cselect_b32 s56, s33, 0
    v_mfma_f32_32x32x16_bf16 v[32:47], v[72:75], v[188:191], v[32:47]
    s_mov_b32 s32, s31
    s_mov_b32 s31, s35
    v_mul_f32 v242, v0, v144
    v_fma_f32 v240, v8, v160, -v240
    v_fmac_f32 v242, v1, v145
    v_fmac_f32 v240, v9, v161
    v_fmac_f32 v242, v2, v146
    v_mfma_f32_32x32x16_bf16 v[48:63], v[76:79], v[188:191], v[48:63]
    s_setprio 0
    v_fmac_f32 v240, v10, v162
    v_fmac_f32 v242, v3, v147
    v_fmac_f32 v240, v11, v163
    v_fmac_f32 v242, v4, v148
    v_fmac_f32 v240, v12, v164
    v_fmac_f32 v242, v5, v149
    v_fmac_f32 v240, v13, v165
    v_fmac_f32 v242, v6, v150
    v_fmac_f32 v240, v14, v166
    v_fmac_f32 v242, v7, v151
    v_fmac_f32 v240, v15, v167
    v_add_u32 v249, s26, v249
    v_add_u32 v250, s26, v250
    v_fma_f32 v244, v16, v160, -v244
    v_fmac_f32 v236, v24, v112
    v_fmac_f32 v244, v17, v161
    v_fmac_f32 v236, v25, v113
    v_fmac_f32 v244, v18, v162
    v_fmac_f32 v236, v26, v114
    v_fmac_f32 v244, v19, v163
    v_fmac_f32 v236, v27, v115
    v_fmac_f32 v244, v20, v164
    v_fmac_f32 v236, v28, v116
    v_fmac_f32 v244, v21, v165
    v_fmac_f32 v236, v29, v117
    v_fmac_f32 v244, v22, v166
    v_fmac_f32 v236, v30, v118
    v_fmac_f32 v244, v23, v167
    v_fmac_f32 v236, v31, v119
    ds_read_b64_tr_b16 v[0:1], v249 offset:0
    ds_read_b64_tr_b16 v[2:3], v249 offset:128
    ds_read_b128 v[4:7], v250 offset:0
    ds_read_b128 v[8:11], v250 offset:16
    ds_read_b128 v[12:15], v250 offset:384
    ds_read_b128 v[16:19], v250 offset:400
    v_mul_f32 v243, v32, v152
    v_fma_f32 v241, v40, v168, -v241
    v_fmac_f32 v243, v33, v153
    v_fmac_f32 v241, v41, v169
    v_fmac_f32 v243, v34, v154
    v_fmac_f32 v241, v42, v170
    v_fmac_f32 v243, v35, v155
    v_fmac_f32 v241, v43, v171
    v_fmac_f32 v243, v36, v156
    v_fmac_f32 v241, v44, v172
    v_fmac_f32 v243, v37, v157
    v_fmac_f32 v241, v45, v173
    v_fmac_f32 v243, v38, v158
    v_fmac_f32 v241, v46, v174
    v_fmac_f32 v243, v39, v159
    v_fmac_f32 v241, v47, v175
    ds_read_b64_tr_b16 v[20:21], v249 offset:512
    ds_read_b64_tr_b16 v[22:23], v249 offset:640
    ds_read_b128 v[24:27], v250 offset:64
    ds_read_b128 v[28:31], v250 offset:80
    ds_read_b128 v[32:35], v250 offset:448
    ds_read_b128 v[36:39], v250 offset:464
    v_fma_f32 v245, v48, v168, -v245
    v_fmac_f32 v237, v56, v120
    v_fmac_f32 v245, v49, v169
    v_fmac_f32 v237, v57, v121
    v_fmac_f32 v245, v50, v170
    v_fmac_f32 v237, v58, v122
    v_fmac_f32 v245, v51, v171
    v_fmac_f32 v237, v59, v123
    v_fmac_f32 v245, v52, v172
    v_fmac_f32 v237, v60, v124
    v_fmac_f32 v245, v53, v173
    v_fmac_f32 v237, v61, v125
    v_fmac_f32 v245, v54, v174
    v_fmac_f32 v237, v62, v126
    v_fmac_f32 v245, v55, v175
    v_fmac_f32 v237, v63, v127
    s_cmp_eq_u32 s56, 2
    s_cbranch_scc1 K2_U21
    s_cmp_eq_u32 s56, 3
    s_cbranch_scc1 K2_U31
    s_branch K2_DSP1
K2_PAD_U31:
    s_branch K2_HOP
K2_U31:
    s_setprio 1
    s_waitcnt lgkmcnt(6)
    v_lshlrev_b32 v40, 16, v0
    v_and_b32 v41, 0xffff0000, v0
    v_lshlrev_b32 v42, 16, v1
    v_and_b32 v43, 0xffff0000, v1
    v_lshlrev_b32 v44, 16, v2
    v_and_b32 v45, 0xffff0000, v2
    v_lshlrev_b32 v46, 16, v3
    v_and_b32 v47, 0xffff0000, v3
    v_mul_f32 v4, v40, v4
    v_mul_f32 v5, v41, v5
    v_mul_f32 v6, v42, v6
    v_mul_f32 v7, v43, v7
    v_mul_f32 v8, v44, v8
    v_mul_f32 v9, v45, v9
    v_mul_f32 v10, v46, v10
    v_mul_f32 v11, v47, v11
    v_cvt_pk_bf16_f32 v64, v4, v5
    v_cvt_pk_bf16_f32 v65, v6, v7
    v_cvt_pk_bf16_f32 v66, v8, v9
    v_cvt_pk_bf16_f32 v67, v10, v11
    v_mul_f32 v12, v40, v12
    v_mul_f32 v13, v41, v13
    v_mul_f32 v14, v42, v14
    v_mul_f32 v15, v43, v15
    v_mul_f32 v16, v44, v16
    v_mul_f32 v17, v45, v17
    v_mul_f32 v18, v46, v18
    v_mul_f32 v19, v47, v19
    v_cvt_pk_bf16_f32 v68, v12, v13
    v_cvt_pk_bf16_f32 v69, v14, v15
    v_cvt_pk_bf16_f32 v70, v16, v17
    v_cvt_pk_bf16_f32 v71, v18, v19
    ds_read_b64_tr_b16 v[0:1], v249 offset:1024
    ds_read_b64_tr_b16 v[2:3], v249 offset:1152
    ds_read_b128 v[4:7], v250 offset:128
    ds_read_b128 v[8:11], v250 offset:144
    ds_read_b128 v[12:15], v250 offset:512
    ds_read_b128 v[16:19], v250 offset:528
    s_waitcnt lgkmcnt(6)
    v_lshlrev_b32 v48, 16, v20
    v_and_b32 v49, 0xffff0000, v20
    v_lshlrev_b32 v50, 16, v21
    v_and_b32 v51, 0xffff0000, v21
    v_lshlrev_b32 v52, 16, v22
    v_and_b32 v53, 0xffff0000, v22
    v_lshlrev_b32 v54, 16, v23
    v_and_b32 v55, 0xffff0000, v23
    v_mul_f32 v24, v48, v24
    v_mul_f32 v25, v49, v25
    v_mul_f32 v26, v50, v26
    v_mul_f32 v27, v51, v27
    v_mul_f32 v28, v52, v28
    v_mul_f32 v29, v53, v29
    v_mul_f32 v30, v54, v30
    v_mul_f32 v31, v55, v31
    v_cvt_pk_bf16_f32 v72, v24, v25
    v_cvt_pk_bf16_f32 v73, v26, v27
    v_cvt_pk_bf16_f32 v74, v28, v29
    v_cvt_pk_bf16_f32 v75, v30, v31
    v_mul_f32 v32, v48, v32
    v_mul_f32 v33, v49, v33
    v_mul_f32 v34, v50, v34
    v_mul_f32 v35, v51, v35
    v_mul_f32 v36, v52, v36
    v_mul_f32 v37, v53, v37
    v_mul_f32 v38, v54, v38
    v_mul_f32 v39, v55, v39
    v_cvt_pk_bf16_f32 v76, v32, v33
    v_cvt_pk_bf16_f32 v77, v34, v35
    v_cvt_pk_bf16_f32 v78, v36, v37
    v_cvt_pk_bf16_f32 v79, v38, v39
    s_waitcnt lgkmcnt(4)
    v_lshlrev_b32 v40, 16, v0
    v_and_b32 v41, 0xffff0000, v0
    v_lshlrev_b32 v42, 16, v1
    v_and_b32 v43, 0xffff0000, v1
    v_lshlrev_b32 v44, 16, v2
    v_and_b32 v45, 0xffff0000, v2
    v_lshlrev_b32 v46, 16, v3
    v_and_b32 v47, 0xffff0000, v3
    s_waitcnt lgkmcnt(2)
    v_mul_f32 v4, v40, v4
    v_mul_f32 v5, v41, v5
    v_mul_f32 v6, v42, v6
    v_mul_f32 v7, v43, v7
    v_mul_f32 v8, v44, v8
    v_mul_f32 v9, v45, v9
    v_mul_f32 v10, v46, v10
    v_mul_f32 v11, v47, v11
    v_cvt_pk_bf16_f32 v80, v4, v5
    v_cvt_pk_bf16_f32 v81, v6, v7
    v_cvt_pk_bf16_f32 v82, v8, v9
    v_cvt_pk_bf16_f32 v83, v10, v11
    s_waitcnt lgkmcnt(0)
    v_mul_f32 v12, v40, v12
    v_mul_f32 v13, v41, v13
    v_mul_f32 v14, v42, v14
    v_mul_f32 v15, v43, v15
    v_mul_f32 v16, v44, v16
    v_mul_f32 v17, v45, v17
    v_mul_f32 v18, v46, v18
    v_mul_f32 v19, v47, v19
    v_cvt_pk_bf16_f32 v84, v12, v13
    v_cvt_pk_bf16_f32 v85, v14, v15
    v_cvt_pk_bf16_f32 v86, v16, v17
    v_cvt_pk_bf16_f32 v87, v18, v19
    s_waitcnt vmcnt(4)
    v_mfma_f32_32x32x16_bf16 v[0:15], v[64:67], v[176:179], 0
    ds_read_b64_tr_b16 v[184:185], v246 offset:2048
    ds_read_b64_tr_b16 v[186:187], v246 offset:2560
    ds_read_b64_tr_b16 v[188:189], v247 offset:2048
    ds_read_b64_tr_b16 v[190:191], v247 offset:2560
    s_mov_b32 m0, s68
    v_mfma_f32_32x32x16_bf16 v[16:31], v[68:71], v[176:179], 0
    buffer_load_dwordx4 v224, s[4:7], s41 offen sc1 lds
    buffer_load_dwordx4 v225, s[72:75], s41 offen offset:1024 sc1 lds
    v_permlane32_swap_b32 v242, v236
    v_permlane32_swap_b32 v243, v237
    v_mov_b32 v254, 163648
    v_mfma_f32_32x32x16_bf16 v[32:47], v[64:67], v[180:183], 0
    v_permlane32_swap_b32 v244, v238
    v_permlane32_swap_b32 v245, v239
    v_permlane32_swap_b32 v240, v241
    v_add_f32 v242, v242, v236
    v_mfma_f32_32x32x16_bf16 v[48:63], v[68:71], v[180:183], 0
    v_add_f32 v243, v243, v237
    v_add_f32 v244, v244, v238
    v_add_f32 v245, v245, v239
    v_add_f32 v240, -v240, -v241
    v_sub_u32 v241, v230, v231
    v_cvt_pk_bf16_f32 v242, v242, v243
    v_mov_b32 v255, 1
    v_lshl_add_u32 v233, v252, 1, s53
    s_mov_b64 exec, 1
    ds_add_rtn_u32 v232, v254, v255
    s_mov_b64 exec, -1
    ds_read_b32 v233, v233
    s_waitcnt vmcnt(4) lgkmcnt(2)
    v_mfma_f32_32x32x16_bf16 v[0:15], v[72:75], v[184:187], v[0:15]
    ds_read_b64_tr_b16 v[176:177], v246 offset:4096
    ds_read_b64_tr_b16 v[178:179], v246 offset:4608
    ds_read_b64_tr_b16 v[180:181], v247 offset:4096
    ds_read_b64_tr_b16 v[182:183], v247 offset:4608
    v_cvt_pk_bf16_f32 v244, v244, v245
    v_cvt_pk_bf16_f32 v240, v240, v240
    s_mov_b32 m0, s69
    v_mfma_f32_32x32x16_bf16 v[16:31], v[76:79], v[184:187], v[16:31]
    buffer_load_dwordx4 v226, s[4:7], s41 offen sc1 lds
    buffer_load_dwordx4 v227, s[72:75], s41 offen offset:1024 sc1 lds
    ds_write_b32 v230, v242 offset:768
    ds_write_b32 v230, v244 offset:1024
    ds_write_b16 v241, v240 offset:1280
    s_waitcnt lgkmcnt(7)
    v_readfirstlane_b32 s58, v232
    v_mfma_f32_32x32x16_bf16 v[32:47], v[72:75], v[188:191], v[32:47]
    s_cmp_lt_u32 s58, s22
    s_cbranch_scc0 K2_nul_41
    s_and_b32 s59, s58, 7
    s_lshr_b32 s60, s58, 3
K2_chk_43:
    v_readlane_b32 s61, v233, s59
    s_nop 0
    s_cmp_gt_u32 s61, s60
    s_cbranch_scc0 K2_spin_42
K2_back_44:
    v_mfma_f32_32x32x16_bf16 v[48:63], v[76:79], v[188:191], v[48:63]
    v_readlane_b32 s3, v253, s58
    s_lshl_b32 s44, s34, 7
    s_lshl_b32 s60, s58, 5
    s_and_b32 s48, s3, 0x3ffff
    s_bfe_u32 s33, s3, 0x30012
    s_sub_u32 s60, s60, s48
    s_waitcnt vmcnt(4) lgkmcnt(3)
    v_mfma_f32_32x32x16_bf16 v[0:15], v[80:83], v[176:179], v[0:15]
    ds_read_b64_tr_b16 v[184:185], v246 offset:6144
    ds_read_b64_tr_b16 v[186:187], v246 offset:6656
    ds_read_b64_tr_b16 v[188:189], v247 offset:6144
    ds_read_b64_tr_b16 v[190:191], v247 offset:6656
    s_and_b32 s60, s60, 0xff
    s_add_u32 s35, s60, s48
    s_mov_b32 m0, s70
    v_mfma_f32_32x32x16_bf16 v[16:31], v[84:87], v[176:179], v[16:31]
    buffer_load_dwordx4 v222, s[4:7], s42 offen sc1 lds
    buffer_load_dwordx4 v223, s[72:75], s42 offen offset:1024 sc1 lds
    s_mov_b32 s45, s44
    s_add_u32 s47, s44, 256
    s_add_u32 s49, s48, 32
    s_add_u32 s60, s48, 64
    v_mfma_f32_32x32x16_bf16 v[32:47], v[80:83], v[180:183], v[32:47]
    s_cmp_eq_u32 s33, 3
    s_cselect_b32 s46, s44, s47
    s_cselect_b32 s50, s60, s48
    s_cselect_b32 s51, s48, s49
    s_sub_u32 s60, s33, 2
    s_cmp_lt_u32 s60, 2
    s_cbranch_scc0 K2_rare_45
K2_back_46:
    v_mfma_f32_32x32x16_bf16 v[48:63], v[84:87], v[180:183], v[48:63]
    s_setprio 0
    v_mul_f32 v234, v0, v96
    v_mul_f32 v236, v8, v128
    v_fmac_f32 v234, v1, v97
    v_fmac_f32 v236, v9, v129
    v_fmac_f32 v234, v2, v98
    v_fmac_f32 v236, v10, v130
    v_fmac_f32 v234, v3, v99
    v_fmac_f32 v236, v11, v131
    v_fmac_f32 v234, v4, v100
    v_fmac_f32 v236, v12, v132
    v_fmac_f32 v234, v5, v101
    v_fmac_f32 v236, v13, v133
    v_fmac_f32 v234, v6, v102
    v_fmac_f32 v236, v14, v134
    v_fmac_f32 v234, v7, v103
    v_fmac_f32 v236, v15, v135
    v_mul_f32 v238, v16, v128
    v_mul_f32 v240, v24, v128
    v_fmac_f32 v238, v17, v129
    v_fmac_f32 v240, v25, v129
    v_fmac_f32 v238, v18, v130
    v_fmac_f32 v240, v26, v130
    v_fmac_f32 v238, v19, v131
    v_fmac_f32 v240, v27, v131
    v_fmac_f32 v238, v20, v132
    v_fmac_f32 v240, v28, v132
    v_fmac_f32 v238, v21, v133
    v_fmac_f32 v240, v29, v133
    v_fmac_f32 v238, v22, v134
    v_fmac_f32 v240, v30, v134
    v_fmac_f32 v238, v23, v135
    v_fmac_f32 v240, v31, v135
    v_mul_f32 v235, v32, v104
    v_mul_f32 v237, v40, v136
    v_fmac_f32 v235, v33, v105
    v_fmac_f32 v237, v41, v137
    v_fmac_f32 v235, v34, v106
    v_fmac_f32 v237, v42, v138
    v_fmac_f32 v235, v35, v107
    v_fmac_f32 v237, v43, v139
    v_fmac_f32 v235, v36, v108
    v_fmac_f32 v237, v44, v140
    v_fmac_f32 v235, v37, v109
    v_fmac_f32 v237, v45, v141
    v_fmac_f32 v235, v38, v110
    v_fmac_f32 v237, v46, v142
    v_fmac_f32 v235, v39, v111
    v_fmac_f32 v237, v47, v143
    v_mul_f32 v239, v48, v136
    v_mul_f32 v241, v56, v136
    s_setprio 1
    s_waitcnt vmcnt(4) lgkmcnt(0)
    v_mfma_f32_32x32x16_bf16 v[0:15], v[64:67], v[184:187], 0
    ds_read_b64_tr_b16 v[176:177], v246 offset:0
    ds_read_b64_tr_b16 v[178:179], v246 offset:512
    ds_read_b64_tr_b16 v[180:181], v247 offset:0
    ds_read_b64_tr_b16 v[182:183], v247 offset:512
    v_fmac_f32 v239, v49, v137
    v_fmac_f32 v241, v57, v137
    s_mov_b32 m0, s71
    v_mfma_f32_32x32x16_bf16 v[16:31], v[68:71], v[184:187], 0
    buffer_load_dwordx4 v224, s[4:7], s42 offen sc1 lds
    buffer_load_dwordx4 v225, s[72:75], s42 offen offset:1024 sc1 lds
    v_fmac_f32 v239, v50, v138
    v_fmac_f32 v241, v58, v138
    v_fmac_f32 v239, v51, v139
    v_fmac_f32 v241, v59, v139
    v_fmac_f32 v239, v52, v140
    v_mfma_f32_32x32x16_bf16 v[32:47], v[64:67], v[188:191], 0
    v_fmac_f32 v241, v60, v140
    v_fmac_f32 v239, v53, v141
    v_fmac_f32 v241, v61, v141
    v_fmac_f32 v239, v54, v142
    v_fmac_f32 v241, v62, v142
    v_fmac_f32 v239, v55, v143
    v_fmac_f32 v241, v63, v143
    v_mfma_f32_32x32x16_bf16 v[48:63], v[68:71], v[188:191], 0
    v_permlane32_swap_b32 v234, v236
    v_permlane32_swap_b32 v235, v237
    v_permlane32_swap_b32 v240, v238
    s_waitcnt vmcnt(4) lgkmcnt(0)
    v_mfma_f32_32x32x16_bf16 v[0:15], v[72:75], v[176:179], v[0:15]
    ds_read_b64_tr_b16 v[184:185], v246 offset:2048
    ds_read_b64_tr_b16 v[186:187], v246 offset:2560
    ds_read_b64_tr_b16 v[188:189], v247 offset:2048
    ds_read_b64_tr_b16 v[190:191], v247 offset:2560
    v_permlane32_swap_b32 v241, v239
    s_mov_b32 m0, s68
    v_mfma_f32_32x32x16_bf16 v[16:31], v[76:79], v[176:179], v[16:31]
    buffer_load_dwordx4 v226, s[4:7], s42 offen sc1 lds
    buffer_load_dwordx4 v227, s[72:75], s42 offen offset:1024 sc1 lds
    v_lshl_add_u32 v230, v252, 1, s31
    v_add_f32 v234, v234, v236
    v_add_f32 v235, v235, v237
    v_add_f32 v240, v240, v238
    v_add_f32 v241, v241, v239
    v_mfma_f32_32x32x16_bf16 v[32:47], v[72:75], v[180:183], v[32:47]
    v_cvt_pk_bf16_f32 v234, v234, v235
    v_cvt_pk_bf16_f32 v240, v240, v241
    ds_write_b32 v230, v234 offset:0
    ds_write_b32 v230, v240 offset:256
    v_mfma_f32_32x32x16_bf16 v[48:63], v[76:79], v[180:183], v[48:63]
    s_waitcnt vmcnt(4) lgkmcnt(2)
    v_mfma_f32_32x32x16_bf16 v[0:15], v[80:83], v[184:187], v[0:15]
    ds_read_b64_tr_b16 v[176:177], v246 offset:4096
    ds_read_b64_tr_b16 v[178:179], v246 offset:4608
    ds_read_b64_tr_b16 v[180:181], v247 offset:4096
    ds_read_b64_tr_b16 v[182:183], v247 offset:4608
    s_mov_b32 m0, s69
    v_mfma_f32_32x32x16_bf16 v[16:31], v[84:87], v[184:187], v[16:31]
    buffer_load_dwordx4 v222, s[4:7], s43 offen sc1 lds
    buffer_load_dwordx4 v223, s[72:75], s43 offen offset:1024 sc1 lds
    v_mfma_f32_32x32x16_bf16 v[32:47], v[80:83], v[188:191], v[32:47]
    s_nop 2
    v_mul_f32 v234, v0, v144
    v_mul_f32 v236, v8, v112
    v_fmac_f32 v234, v1, v145
    v_fmac_f32 v236, v9, v113
    v_fmac_f32 v234, v2, v146
    v_fmac_f32 v236, v10, v114
    v_fmac_f32 v234, v3, v147
    v_mfma_f32_32x32x16_bf16 v[48:63], v[84:87], v[188:191], v[48:63]
    s_setprio 0
    v_fmac_f32 v236, v11, v115
    v_fmac_f32 v234, v4, v148
    v_fmac_f32 v236, v12, v116
    v_fmac_f32 v234, v5, v149
    v_fmac_f32 v236, v13, v117
    v_fmac_f32 v234, v6, v150
    v_fmac_f32 v236, v14, v118
    v_fmac_f32 v234, v7, v151
    v_fmac_f32 v236, v15, v119
    v_mul_f32 v238, v16, v160
    v_mul_f32 v240, v24, v160
    v_fmac_f32 v238, v17, v161
    v_fmac_f32 v240, v25, v161
    v_fmac_f32 v238, v18, v162
    v_fmac_f32 v240, v26, v162
    v_fmac_f32 v238, v19, v163
    v_fmac_f32 v240, v27, v163
    v_fmac_f32 v238, v20, v164
    v_fmac_f32 v240, v28, v164
    v_fmac_f32 v238, v21, v165
    v_fmac_f32 v240, v29, v165
    v_fmac_f32 v238, v22, v166
    v_fmac_f32 v240, v30, v166
    v_fmac_f32 v238, v23, v167
    v_fmac_f32 v240, v31, v167
    v_mul_f32 v235, v32, v152
    v_mul_f32 v237, v40, v120
    v_fmac_f32 v235, v33, v153
    v_fmac_f32 v237, v41, v121
    v_fmac_f32 v235, v34, v154
    v_fmac_f32 v237, v42, v122
    v_fmac_f32 v235, v35, v155
    v_fmac_f32 v237, v43, v123
    v_fmac_f32 v235, v36, v156
    v_fmac_f32 v237, v44, v124
    v_fmac_f32 v235, v37, v157
    v_fmac_f32 v237, v45, v125
    v_fmac_f32 v235, v38, v158
    v_fmac_f32 v237, v46, v126
    v_fmac_f32 v235, v39, v159
    v_fmac_f32 v237, v47, v127
    v_mul_f32 v239, v48, v168
    v_mul_f32 v241, v56, v168
    v_fmac_f32 v239, v49, v169
    v_fmac_f32 v241, v57, v169
    s_setprio 1
    s_waitcnt vmcnt(4) lgkmcnt(0)
    v_mfma_f32_32x32x16_bf16 v[0:15], v[64:67], v[176:179], 0
    ds_read_b64_tr_b16 v[184:185], v246 offset:6144
    ds_read_b64_tr_b16 v[186:187], v246 offset:6656
    ds_read_b64_tr_b16 v[188:189], v247 offset:6144
    ds_read_b64_tr_b16 v[190:191], v247 offset:6656
    v_fmac_f32 v239, v50, v170
    v_fmac_f32 v241, v58, v170
    s_mov_b32 m0, s70
    v_mfma_f32_32x32x16_bf16 v[16:31], v[68:71], v[176:179], 0
    buffer_load_dwordx4 v224, s[4:7], s43 offen sc1 lds
    buffer_load_dwordx4 v225, s[72:75], s43 offen offset:1024 sc1 lds
    v_fmac_f32 v239, v51, v171
    v_fmac_f32 v241, v59, v171
    v_fmac_f32 v239, v52, v172
    v_fmac_f32 v241, v60, v172
    v_fmac_f32 v239, v53, v173
    v_mfma_f32_32x32x16_bf16 v[32:47], v[64:67], v[180:183], 0
    v_add_u32 v222, s48, v251
    ds_read_b32 v222, v222
    v_fmac_f32 v241, v61, v173
    v_fmac_f32 v239, v54, v174
    v_fmac_f32 v241, v62, v174
    v_fmac_f32 v239, v55, v175
    v_fmac_f32 v241, v63, v175
    v_mfma_f32_32x32x16_bf16 v[48:63], v[68:71], v[180:183], 0
    s_waitcnt vmcnt(4) lgkmcnt(1)
    v_mfma_f32_32x32x16_bf16 v[0:15], v[72:75], v[184:187], v[0:15]
    ds_read_b64_tr_b16 v[176:177], v246 offset:0
    ds_read_b64_tr_b16 v[178:179], v246 offset:512
    ds_read_b64_tr_b16 v[180:181], v247 offset:0
    ds_read_b64_tr_b16 v[182:183], v247 offset:512
    s_mov_b32 m0, s71
    v_mfma_f32_32x32x16_bf16 v[16:31], v[76:79], v[184:187], v[16:31]
    buffer_load_dwordx4 v226, s[4:7], s43 offen sc1 lds
    buffer_load_dwordx4 v227, s[72:75], s43 offen offset:1024 sc1 lds
    s_waitcnt lgkmcnt(4)
    v_mad_u32_u16 v223, v222, s39, v248 op_sel:[1,0,0,0]
    v_mad_u32_u16 v222, v222, s39, v248
    v_mfma_f32_32x32x16_bf16 v[32:47], v[72:75], v[188:191], v[32:47]
    v_add_u32 v224, s49, v251
    ds_read_b32 v224, v224
    v_mfma_f32_32x32x16_bf16 v[48:63], v[76:79], v[188:191], v[48:63]
    s_waitcnt vmcnt(4) lgkmcnt(1)
    v_mfma_f32_32x32x16_bf16 v[0:15], v[80:83], v[176:179], v[0:15]
    ds_read_b64_tr_b16 v[184:185], v246 offset:2048
    ds_read_b64_tr_b16 v[186:187], v246 offset:2560
    ds_read_b64_tr_b16 v[188:189], v247 offset:2048
    ds_read_b64_tr_b16 v[190:191], v247 offset:2560
    s_mov_b32 m0, s68
    v_mfma_f32_32x32x16_bf16 v[16:31], v[84:87], v[176:179], v[16:31]
    buffer_load_dwordx4 v222, s[4:7], s44 offen sc1 lds
    buffer_load_dwordx4 v223, s[72:75], s44 offen offset:1024 sc1 lds
    s_waitcnt lgkmcnt(4)
    v_mad_u32_u16 v225, v224, s39, v248 op_sel:[1,0,0,0]
    v_mad_u32_u16 v224, v224, s39, v248
    v_mfma_f32_32x32x16_bf16 v[32:47], v[80:83], v[180:183], v[32:47]
    v_add_u32 v226, s50, v251
    ds_read_b32 v226, v226
    v_mul_f32 v242, v0, v144
    v_fma_f32 v238, v8, v160, -v238
    v_fmac_f32 v242, v1, v145
    v_fmac_f32 v238, v9, v161
    v_fmac_f32 v242, v2, v146
    v_mfma_f32_32x32x16_bf16 v[48:63], v[84:87], v[180:183], v[48:63]
    s_setprio 0
    v_fmac_f32 v238, v10, v162
    v_fmac_f32 v242, v3, v147
    v_fmac_f32 v238, v11, v163
    v_fmac_f32 v242, v4, v148
    v_fmac_f32 v238, v12, v164
    v_fmac_f32 v242, v5, v149
    v_fmac_f32 v238, v13, v165
    v_fmac_f32 v242, v6, v150
    v_fmac_f32 v238, v14, v166
    v_fmac_f32 v242, v7, v151
    v_fmac_f32 v238, v15, v167
    v_fmac_f32 v236, v16, v112
    v_mul_f32 v244, v24, v160
    v_fmac_f32 v236, v17, v113
    v_fmac_f32 v244, v25, v161
    v_fmac_f32 v236, v18, v114
    v_fmac_f32 v244, v26, v162
    v_fmac_f32 v236, v19, v115
    v_fmac_f32 v244, v27, v163
    v_fmac_f32 v236, v20, v116
    v_fmac_f32 v244, v28, v164
    v_fmac_f32 v236, v21, v117
    v_fmac_f32 v244, v29, v165
    v_fmac_f32 v236, v22, v118
    v_fmac_f32 v244, v30, v166
    v_fmac_f32 v236, v23, v119
    v_fmac_f32 v244, v31, v167
    v_mul_f32 v243, v32, v152
    v_fma_f32 v239, v40, v168, -v239
    v_fmac_f32 v243, v33, v153
    v_fmac_f32 v239, v41, v169
    v_fmac_f32 v243, v34, v154
    v_fmac_f32 v239, v42, v170
    v_fmac_f32 v243, v35, v155
    v_fmac_f32 v239, v43, v171
    v_fmac_f32 v243, v36, v156
    v_fmac_f32 v239, v44, v172
    v_fmac_f32 v243, v37, v157
    v_fmac_f32 v239, v45, v173
    v_fmac_f32 v243, v38, v158
    v_fmac_f32 v239, v46, v174
    v_fmac_f32 v243, v39, v159
    v_fmac_f32 v239, v47, v175
    v_fmac_f32 v237, v48, v120
    v_mul_f32 v245, v56, v168
    v_fmac_f32 v237, v49, v121
    v_fmac_f32 v245, v57, v169
    v_fmac_f32 v237, v50, v122
    v_fmac_f32 v245, v58, v170
    v_fmac_f32 v237, v51, v123
    s_setprio 1
    s_waitcnt vmcnt(4) lgkmcnt(1)
    v_mfma_f32_32x32x16_bf16 v[0:15], v[64:67], v[184:187], 0
    ds_read_b64_tr_b16 v[176:177], v246 offset:4096
    ds_read_b64_tr_b16 v[178:179], v246 offset:4608
    ds_read_b64_tr_b16 v[180:181], v247 offset:4096
    ds_read_b64_tr_b16 v[182:183], v247 offset:4608
    v_fmac_f32 v245, v59, v171
    v_fmac_f32 v237, v52, v124
    s_mov_b32 m0, s69
    v_mfma_f32_32x32x16_bf16 v[16:31], v[68:71], v[184:187], 0
    buffer_load_dwordx4 v224, s[4:7], s45 offen sc1 lds
    buffer_load_dwordx4 v225, s[72:75], s45 offen offset:1024 sc1 lds
    s_waitcnt lgkmcnt(4)
    v_mad_u32_u16 v227, v226, s39, v248 op_sel:[1,0,0,0]
    v_mad_u32_u16 v226, v226, s39, v248
    v_fmac_f32 v245, v60, v172
    v_fmac_f32 v237, v53, v125
    v_mfma_f32_32x32x16_bf16 v[32:47], v[64:67], v[188:191], 0
    v_add_u32 v228, s51, v251
    ds_read_b32 v228, v228
    v_fmac_f32 v245, v61, v173
    v_fmac_f32 v237, v54, v126
    v_fmac_f32 v245, v62, v174
    v_fmac_f32 v237, v55, v127
    v_fmac_f32 v245, v63, v175
    v_mfma_f32_32x32x16_bf16 v[48:63], v[68:71], v[188:191], 0
    v_permlane32_swap_b32 v242, v234
    v_permlane32_swap_b32 v243, v235
    v_add_f32 v242, v242, v234
    v_add_f32 v243, v243, v235
    s_waitcnt vmcnt(4) lgkmcnt(1)
    v_mfma_f32_32x32x16_bf16 v[0:15], v[72:75], v[176:179], v[0:15]
    ds_read_b64_tr_b16 v[184:185], v246 offset:6144
    ds_read_b64_tr_b16 v[186:187], v246 offset:6656
    ds_read_b64_tr_b16 v[188:189], v247 offset:6144
    ds_read_b64_tr_b16 v[190:191], v247 offset:6656
    v_cvt_pk_bf16_f32 v242, v242, v243
    ds_write_b32 v230, v242 offset:512
    s_mov_b32 m0, s70
    v_mfma_f32_32x32x16_bf16 v[16:31], v[76:79], v[176:179], v[16:31]
    buffer_load_dwordx4 v226, s[4:7], s46 offen sc1 lds
    buffer_load_dwordx4 v227, s[72:75], s46 offen offset:1024 sc1 lds
    s_waitcnt lgkmcnt(5)
    v_mad_u32_u16 v229, v228, s39, v248 op_sel:[1,0,0,0]
    v_mad_u32_u16 v228, v228, s39, v248
    s_sub_u32 s26, s48, s29
    s_mov_b32 s29, s48
    v_mfma_f32_32x32x16_bf16 v[32:47], v[72:75], v[180:183], v[32:47]
    s_mov_b32 s30, s3
    s_cmp_lg_u32 s36, 0
    s_cselect_b32 s56, s33, 0
    s_mov_b32 s32, s31
    s_mov_b32 s31, s35
    v_mfma_f32_32x32x16_bf16 v[48:63], v[76:79], v[180:183], v[48:63]
    s_waitcnt vmcnt(4) lgkmcnt(1)
    v_mfma_f32_32x32x16_bf16 v[0:15], v[80:83], v[184:187], v[0:15]
    ds_read_b64_tr_b16 v[176:177], v246 offset:0
    ds_read_b64_tr_b16 v[178:179], v246 offset:512
    ds_read_b64_tr_b16 v[180:181], v247 offset:0
    ds_read_b64_tr_b16 v[182:183], v247 offset:512
    s_mov_b32 m0, s71
    v_mfma_f32_32x32x16_bf16 v[16:31], v[84:87], v[184:187], v[16:31]
    buffer_load_dwordx4 v228, s[4:7], s47 offen sc1 lds
    buffer_load_dwordx4 v229, s[72:75], s47 offen offset:1024 sc1 lds
    v_mfma_f32_32x32x16_bf16 v[32:47], v[80:83], v[188:191], v[32:47]
    s_nop 2
    v_mul_f32 v242, v0, v144
    v_fma_f32 v240, v8, v160, -v240
    v_fmac_f32 v242, v1, v145
    v_fmac_f32 v240, v9, v161
    v_fmac_f32 v242, v2, v146
    v_fmac_f32 v240, v10, v162
    v_fmac_f32 v242, v3, v147
    v_mfma_f32_32x32x16_bf16 v[48:63], v[84:87], v[188:191], v[48:63]
    s_setprio 0
    v_fmac_f32 v240, v11, v163
    v_fmac_f32 v242, v4, v148
    v_fmac_f32 v240, v12, v164
    v_fmac_f32 v242, v5, v149
    v_fmac_f32 v240, v13, v165
    v_fmac_f32 v242, v6, v150
    v_fmac_f32 v240, v14, v166
    v_fmac_f32 v242, v7, v151
    v_fmac_f32 v240, v15, v167
    v_add_u32 v249, s26, v249
    v_add_u32 v250, s26, v250
    v_fma_f32 v244, v16, v160, -v244
    v_fmac_f32 v236, v24, v112
    v_fmac_f32 v244, v17, v161
    v_fmac_f32 v236, v25, v113
    v_fmac_f32 v244, v18, v162
    v_fmac_f32 v236, v26, v114
    v_fmac_f32 v244, v19, v163
    v_fmac_f32 v236, v27, v115
    v_fmac_f32 v244, v20, v164
    v_fmac_f32 v236, v28, v116
    v_fmac_f32 v244, v21, v165
    v_fmac_f32 v236, v29, v117
    v_fmac_f32 v244, v22, v166
    v_fmac_f32 v236, v30, v118
    v_fmac_f32 v244, v23, v167
    v_fmac_f32 v236, v31, v119
    ds_read_b64_tr_b16 v[0:1], v249 offset:0
    ds_read_b64_tr_b16 v[2:3], v249 offset:128
    ds_read_b128 v[4:7], v250 offset:0
    ds_read_b128 v[8:11], v250 offset:16
    ds_read_b128 v[12:15], v250 offset:384
    ds_read_b128 v[16:19], v250 offset:400
    v_mul_f32 v243, v32, v152
    v_fma_f32 v241, v40, v168, -v241
    v_fmac_f32 v243, v33, v153
    v_fmac_f32 v241, v41, v169
    v_fmac_f32 v243, v34, v154
    v_fmac_f32 v241, v42, v170
    v_fmac_f32 v243, v35, v155
    v_fmac_f32 v241, v43, v171
    v_fmac_f32 v243, v36, v156
    v_fmac_f32 v241, v44, v172
    v_fmac_f32 v243, v37, v157
    v_fmac_f32 v241, v45, v173
    v_fmac_f32 v243, v38, v158
    v_fmac_f32 v241, v46, v174
    v_fmac_f32 v243, v39, v159
    v_fmac_f32 v241, v47, v175
    ds_read_b64_tr_b16 v[20:21], v249 offset:512
    ds_read_b64_tr_b16 v[22:23], v249 offset:640
    ds_read_b128 v[24:27], v250 offset:64
    ds_read_b128 v[28:31], v250 offset:80
    ds_read_b128 v[32:35], v250 offset:448
    ds_read_b128 v[36:39], v250 offset:464
    v_fma_f32 v245, v48, v168, -v245
    v_fmac_f32 v237, v56, v120
    v_fmac_f32 v245, v49, v169
    v_fmac_f32 v237, v57, v121
    v_fmac_f32 v245, v50, v170
    v_fmac_f32 v237, v58, v122
    v_fmac_f32 v245, v51, v171
    v_fmac_f32 v237, v59, v123
    v_fmac_f32 v245, v52, v172
    v_fmac_f32 v237, v60, v124
    v_fmac_f32 v245, v53, v173
    v_fmac_f32 v237, v61, v125
    v_fmac_f32 v245, v54, v174
    v_fmac_f32 v237, v62, v126
    v_fmac_f32 v245, v55, v175
    v_fmac_f32 v237, v63, v127
    s_cmp_eq_u32 s56, 2
    s_cbranch_scc1 K2_U21
    s_cmp_eq_u32 s56, 3
    s_cbranch_scc1 K2_U31
    s_branch K2_DSP1
K2_PAD_SW:
    s_branch K2_HOP
K2_DSP0:
    s_cmp_eq_u32 s56, 1
    s_cbranch_scc1 K2_U10
    s_cmp_eq_u32 s56, 4
    s_cbranch_scc1 K2_U40
    s_branch K2_SWITCH
K2_DSP1:
    s_cmp_eq_u32 s56, 1
    s_cbranch_scc1 K2_U11
    s_cmp_eq_u32 s56, 4
    s_cbranch_scc1 K2_U41
    s_branch K2_TAIL
K2_SWITCH:
    v_permlane32_swap_b32 v242, v236
    v_permlane32_swap_b32 v243, v237
    v_permlane32_swap_b32 v244, v238
    v_permlane32_swap_b32 v245, v239
    v_permlane32_swap_b32 v240, v241
    v_add_f32 v242, v242, v236
    v_add_f32 v243, v243, v237
    v_add_f32 v244, v244, v238
    v_add_f32 v245, v245, v239
    v_add_f32 v240, -v240, -v241
    s_set_gpr_idx_on s32, gpr_idx(DST)
    s_nop 0
    v_cvt_pk_bf16_f32 v195, v242, v243
    v_cvt_pk_bf16_f32 v196, v244, v245
    v_cvt_pk_bf16_f32 v197, v240, v240
    s_set_gpr_idx_off
    s_cmp_eq_u32 s36, 0
    s_cbranch_scc1 K2_TAIL2
    v_lshlrev_b32 v254, 3, v252
    v_lshl_add_u32 v230, v252, 1, s35
    v_lshrrev_b32 v231, 6, v252
    v_mul_u32_u24 v231, 126, v231
    s_mov_b32 s58, 7131136
    buffer_load_dwordx4 v[96:99], v254, s[8:11], s58 offen offset:0 sc1
    buffer_load_dwordx4 v[100:103], v254, s[8:11], s58 offen offset:1024 sc1
    buffer_load_dwordx4 v[104:107], v254, s[8:11], s58 offen offset:2048 sc1
    buffer_load_dwordx4 v[108:111], v254, s[8:11], s58 offen offset:3072 sc1
    s_mov_b32 s58, 7135232
    buffer_load_dwordx4 v[112:115], v254, s[8:11], s58 offen offset:0 sc1
    buffer_load_dwordx4 v[116:119], v254, s[8:11], s58 offen offset:1024 sc1
    buffer_load_dwordx4 v[120:123], v254, s[8:11], s58 offen offset:2048 sc1
    buffer_load_dwordx4 v[124:127], v254, s[8:11], s58 offen offset:3072 sc1
    s_mov_b32 s58, 7139328
    buffer_load_dwordx4 v[128:131], v254, s[8:11], s58 offen offset:0 sc1
    buffer_load_dwordx4 v[132:135], v254, s[8:11], s58 offen offset:1024 sc1
    buffer_load_dwordx4 v[136:139], v254, s[8:11], s58 offen offset:2048 sc1
    buffer_load_dwordx4 v[140:143], v254, s[8:11], s58 offen offset:3072 sc1
    s_mov_b32 s58, 7143424
    buffer_load_dwordx4 v[144:147], v254, s[8:11], s58 offen offset:0 sc1
    buffer_load_dwordx4 v[148:151], v254, s[8:11], s58 offen offset:1024 sc1
    buffer_load_dwordx4 v[152:155], v254, s[8:11], s58 offen offset:2048 sc1
    buffer_load_dwordx4 v[156:159], v254, s[8:11], s58 offen offset:3072 sc1
    s_mov_b32 s58, 7147520
    buffer_load_dwordx4 v[160:163], v254, s[8:11], s58 offen offset:0 sc1
    buffer_load_dwordx4 v[164:167], v254, s[8:11], s58 offen offset:1024 sc1
    buffer_load_dwordx4 v[168:171], v254, s[8:11], s58 offen offset:2048 sc1
    buffer_load_dwordx4 v[172:175], v254, s[8:11], s58 offen offset:3072 sc1
    s_movk_i32 s40, 128
    s_movk_i32 s41, 384
    s_movk_i32 s42, 640
    s_movk_i32 s43, 896
    s_cmp_lg_u32 s33, 1
    s_cbranch_scc1 K2_SW2
    s_waitcnt vmcnt(0)
K2_SW2:
    s_mov_b32 s29, s48
    s_mov_b32 s32, s31
    s_mov_b32 s30, s3
    s_mov_b32 s31, s35
    s_cmp_eq_u32 s33, 2
    s_cbranch_scc1 K2_U21
    s_cmp_eq_u32 s33, 3
    s_cbranch_scc1 K2_U31
    s_cmp_eq_u32 s33, 1
    s_cbranch_scc1 K2_U11
    s_branch K2_U41
K2_dum_4:
    v_mov_b32 v232, -1
    s_mov_b32 m0, 163712
    s_mov_b64 exec, 1
    buffer_load_dwordx4 v232, s[16:19], 0 offen lds
    buffer_load_dwordx4 v232, s[16:19], 0 offen lds
    s_mov_b64 exec, -1
    s_branch K2_back_6
K2_nul_10:
    s_mov_b32 s58, 63
    s_mov_b32 s36, 0
    s_branch K2_back_13
K2_spin_11:
    s_sub_u32 s27, s27, 1
    s_cbranch_scc1 K2_END
    v_lshl_add_u32 v233, v252, 1, s53
    ds_read_b32 v233, v233
    s_waitcnt lgkmcnt(0)
    s_branch K2_chk_12
K2_dyn_8:
    v_mov_b32 v254, 163648
    v_mov_b32 v255, 1
    v_lshl_add_u32 v233, v252, 1, s53
    s_mov_b64 exec, 1
    ds_add_rtn_u32 v232, v254, v255
    s_mov_b64 exec, -1
    ds_read_b32 v233, v233
    s_waitcnt lgkmcnt(0)
    v_readfirstlane_b32 s58, v232
    s_nop 0
    s_cmp_lt_u32 s58, s22
    s_cbranch_scc0 K2_nul_10
    s_and_b32 s59, s58, 7
    s_lshr_b32 s60, s58, 3
K2_chk_12:
    v_readlane_b32 s61, v233, s59
    s_nop 0
    s_cmp_gt_u32 s61, s60
    s_cbranch_scc0 K2_spin_11
K2_back_13:
    s_mov_b32 s34, 1
    s_branch K2_back_9
K2_dum_17:
    v_mov_b32 v232, -1
    s_mov_b32 m0, 163712
    s_mov_b64 exec, 1
    buffer_load_dwordx4 v232, s[16:19], 0 offen lds
    buffer_load_dwordx4 v232, s[16:19], 0 offen lds
    s_mov_b64 exec, -1
    s_branch K2_back_19
K2_nul_23:
    s_mov_b32 s58, 63
    s_mov_b32 s36, 0
    s_branch K2_back_26
K2_spin_24:
    s_sub_u32 s27, s27, 1
    s_cbranch_scc1 K2_END
    v_lshl_add_u32 v233, v252, 1, s53
    ds_read_b32 v233, v233
    s_waitcnt lgkmcnt(0)
    s_branch K2_chk_25
K2_dyn_21:
    v_mov_b32 v254, 163648
    v_mov_b32 v255, 1
    v_lshl_add_u32 v233, v252, 1, s53
    s_mov_b64 exec, 1
    ds_add_rtn_u32 v232, v254, v255
    s_mov_b64 exec, -1
    ds_read_b32 v233, v233
    s_waitcnt lgkmcnt(0)
    v_readfirstlane_b32 s58, v232
    s_nop 0
    s_cmp_lt_u32 s58, s22
    s_cbranch_scc0 K2_nul_23
    s_and_b32 s59, s58, 7
    s_lshr_b32 s60, s58, 3
K2_chk_25:
    v_readlane_b32 s61, v233, s59
    s_nop 0
    s_cmp_gt_u32 s61, s60
    s_cbranch_scc0 K2_spin_24
K2_back_26:
    s_mov_b32 s34, 1
    s_branch K2_back_22
K2_dum_30:
    v_mov_b32 v232, -1
    s_mov_b32 m0, 163712
    s_mov_b64 exec, 1
    buffer_load_dwordx4 v232, s[16:19], 0 offen lds
    buffer_load_dwordx4 v232, s[16:19], 0 offen lds
    s_mov_b64 exec, -1
    s_branch K2_back_32
K2_nul_34:
    s_mov_b32 s58, 63
    s_mov_b32 s36, 0
    s_branch K2_back_37
K2_spin_35:
    s_sub_u32 s27, s27, 1
    s_cbranch_scc1 K2_END
    v_lshl_add_u32 v233, v252, 1, s53
    ds_read_b32 v233, v233
    s_waitcnt lgkmcnt(0)
    s_branch K2_chk_36
K2_nul_41:
    s_mov_b32 s58, 63
    s_mov_b32 s36, 0
    s_branch K2_back_44
K2_spin_42:
    s_sub_u32 s27, s27, 1
    s_cbranch_scc1 K2_END
    v_lshl_add_u32 v233, v252, 1, s53
    ds_read_b32 v233, v233
    s_waitcnt lgkmcnt(0)
    s_branch K2_chk_43
K2_PAD_TL:
    s_branch K2_HOP
K2_TAIL2:
    v_lshlrev_b32 v229, 3, v252
    s_mul_i32 s58, s20, 20480
    s_add_u32 s58, s58, 6946816
    s_mul_i32 s59, s20, 8224
    buffer_load_dwordx4 v[96:99], v229, s[8:11], s58 offen offset:0 sc1
    buffer_load_dwordx4 v[100:103], v229, s[8:11], s58 offen offset:1024 sc1
    buffer_load_dwordx4 v[104:107], v229, s[8:11], s58 offen offset:2048 sc1
    buffer_load_dwordx4 v[108:111], v229, s[8:11], s58 offen offset:3072 sc1
    s_add_u32 s58, s58, 4096
    buffer_load_dwordx4 v[112:115], v229, s[8:11], s58 offen offset:0 sc1
    buffer_load_dwordx4 v[116:119], v229, s[8:11], s58 offen offset:1024 sc1
    buffer_load_dwordx4 v[120:123], v229, s[8:11], s58 offen offset:2048 sc1
    buffer_load_dwordx4 v[124:127], v229, s[8:11], s58 offen offset:3072 sc1
    s_add_u32 s58, s58, 4096
    v_lshl_add_u32 v228, v252, 1, s59
    v_lshrrev_b32 v226, 6, v252
    v_mul_u32_u24 v226, 126, v226
    v_sub_u32 v226, v228, v226
    s_branch K2_TAIL3
K2_TAIL:
    v_lshlrev_b32 v229, 3, v252
    s_mul_i32 s58, s20, 20480
    s_add_u32 s58, s58, 6946816
    s_mul_i32 s59, s20, 8224
    buffer_load_dwordx4 v[96:99], v229, s[8:11], s58 offen offset:0 sc1
    v_permlane32_swap_b32 v242, v236
    v_permlane32_swap_b32 v243, v237
    buffer_load_dwordx4 v[100:103], v229, s[8:11], s58 offen offset:1024 sc1
    v_permlane32_swap_b32 v244, v238
    v_permlane32_swap_b32 v245, v239
    buffer_load_dwordx4 v[104:107], v229, s[8:11], s58 offen offset:2048 sc1
    v_permlane32_swap_b32 v240, v241
    v_add_f32 v242, v242, v236
    buffer_load_dwordx4 v[108:111], v229, s[8:11], s58 offen offset:3072 sc1
    s_add_u32 s58, s58, 4096
    v_add_f32 v243, v243, v237
    v_add_f32 v244, v244, v238
    buffer_load_dwordx4 v[112:115], v229, s[8:11], s58 offen offset:0 sc1
    v_add_f32 v245, v245, v239
    v_add_f32 v240, -v240, -v241
    buffer_load_dwordx4 v[116:119], v229, s[8:11], s58 offen offset:1024 sc1
    v_sub_u32 v241, v230, v231
    v_cvt_pk_bf16_f32 v242, v242, v243
    buffer_load_dwordx4 v[120:123], v229, s[8:11], s58 offen offset:2048 sc1
    v_cvt_pk_bf16_f32 v244, v244, v245
    v_cvt_pk_bf16_f32 v240, v240, v240
    buffer_load_dwordx4 v[124:127], v229, s[8:11], s58 offen offset:3072 sc1
    s_add_u32 s58, s58, 4096
    ds_write_b32 v230, v242 offset:768
    ds_write_b32 v230, v244 offset:1024
    ds_write_b16 v241, v240 offset:1280
    v_lshl_add_u32 v228, v252, 1, s59
    v_lshrrev_b32 v226, 6, v252
    v_mul_u32_u24 v226, 126, v226
    v_sub_u32 v226, v228, v226
K2_TAIL3:
    s_waitcnt vmcnt(8)
    ds_write_b32 v228, v192 offset:0
    ds_write_b32 v228, v193 offset:256
    ds_write_b32 v228, v194 offset:512
    buffer_load_dwordx4 v[128:131], v229, s[8:11], s58 offen offset:0 sc1
    v_bfe_u32 v48, v252, 1, 4
    v_lshrrev_b32 v49, 5, v252
    ds_write_b32 v228, v195 offset:768
    ds_write_b32 v228, v196 offset:1024
    ds_write_b16 v226, v197 offset:1280
    buffer_load_dwordx4 v[132:135], v229, s[8:11], s58 offen offset:1024 sc1
    v_lshrrev_b32 v55, 3, v48
    v_lshlrev_b32 v52, 4, v49
    ds_write_b32 v228, v198 offset:1536
    ds_write_b32 v228, v199 offset:1792
    ds_write_b32 v228, v200 offset:2048
    buffer_load_dwordx4 v[136:139], v229, s[8:11], s58 offen offset:2048 sc1
    v_lshl_add_u32 v54, v55, 2, v48
    v_and_b32 v54, 7, v54
    ds_write_b32 v228, v201 offset:2304
    ds_write_b32 v228, v202 offset:2560
    ds_write_b16 v226, v203 offset:2816
    buffer_load_dwordx4 v[140:143], v229, s[8:11], s58 offen offset:3072 sc1
    s_add_u32 s58, s58, 4096
    v_and_b32 v50, 7, v48
    v_mul_u32_u24 v50, 8224, v50
    ds_write_b32 v228, v204 offset:3072
    ds_write_b32 v228, v205 offset:3328
    ds_write_b32 v228, v206 offset:3584
    buffer_load_dwordx4 v[144:147], v229, s[8:11], s58 offen offset:0 sc1
    v_mul_u32_u24 v51, 1536, v55
    v_add_u32 v50, v50, v51
    ds_write_b32 v228, v207 offset:3840
    ds_write_b32 v228, v208 offset:4096
    ds_write_b16 v226, v209 offset:4352
    buffer_load_dwordx4 v[148:151], v229, s[8:11], s58 offen offset:1024 sc1
    v_add_u32 v222, v50, v52
    v_mul_u32_u24 v51, 8224, v54
    ds_write_b32 v228, v210 offset:4608
    ds_write_b32 v228, v211 offset:4864
    ds_write_b32 v228, v212 offset:5120
    buffer_load_dwordx4 v[152:155], v229, s[8:11], s58 offen offset:2048 sc1
    v_add_u32 v232, v51, v52
    v_lshl_add_u32 v247, v55, 7, v232
    ds_write_b32 v228, v213 offset:5376
    ds_write_b32 v228, v214 offset:5632
    ds_write_b16 v226, v215 offset:5888
    buffer_load_dwordx4 v[156:159], v229, s[8:11], s58 offen offset:3072 sc1
    s_add_u32 s58, s58, 4096
    v_mul_u32_u24 v53, 192, v48
    v_and_b32 v53, 0xc0, v53
    ds_write_b32 v228, v216 offset:6144
    ds_write_b32 v228, v217 offset:6400
    ds_write_b32 v228, v218 offset:6656
    buffer_load_dwordx4 v[160:163], v229, s[8:11], s58 offen offset:0 sc1
    v_add_u32 v53, v53, v52
    v_mul_u32_u24 v51, 2400, v48
    ds_write_b32 v228, v219 offset:6912
    ds_write_b32 v228, v220 offset:7168
    ds_write_b16 v226, v221 offset:7424
    buffer_load_dwordx4 v[164:167], v229, s[8:11], s58 offen offset:1024 sc1
    s_mov_b32 s60, 65536
    v_add3_u32 v223, v51, v53, s60
    buffer_load_dwordx4 v[168:171], v229, s[8:11], s58 offen offset:2048 sc1
    v_mul_u32_u24 v51, 2400, v54
    s_mov_b32 s60, 142336
    buffer_load_dwordx4 v[172:175], v229, s[8:11], s58 offen offset:3072 sc1
    v_add3_u32 v225, v51, v53, s60
    v_lshl_add_u32 v248, v55, 7, v225
    s_lshl_b32 s60, s20, 5
    v_lshl_add_u32 v49, v49, 3, s60
    s_mov_b32 s60, 65536
    v_add3_u32 v255, v51, v49, s60
    v_lshl_add_u32 v246, v55, 9, v255
    v_bfe_u32 v53, v48, 2, 1
    v_lshl_add_u32 v49, v53, 4, v49
    v_add_u32 v254, v50, v49
    s_and_b32 s64, s55, s28
    s_waitcnt lgkmcnt(0)
    s_barrier
    s_cmp_eq_u32 s64, 0
    s_cbranch_scc1 K2_MULTI
    s_setprio 3
    ds_read_b128 v[48:51], v222 offset:0
    ds_read_b128 v[52:55], v222 offset:64
    ds_read_b128 v[56:59], v222 offset:896
    ds_read_b128 v[60:63], v222 offset:960
    ds_read_b128 v[64:67], v223 offset:0
    ds_read_b128 v[68:71], v223 offset:64
    ds_read_b128 v[72:75], v223 offset:896
    ds_read_b128 v[76:79], v223 offset:960
    ds_read_b128 v[80:83], v222 offset:128
    ds_read_b128 v[84:87], v222 offset:384
    ds_read_b128 v[88:91], v222 offset:256
    s_waitcnt vmcnt(19) lgkmcnt(9)
    v_mfma_f32_16x16x32_bf16 v[0:3], v[96:99], v[48:51], 0
    ds_read_b128 v[92:95], v222 offset:192
    s_waitcnt vmcnt(18)
    v_mfma_f32_16x16x32_bf16 v[0:3], v[100:103], v[52:55], v[0:3]
    ds_read_b128 v[48:51], v222 offset:448
    s_waitcnt vmcnt(17) lgkmcnt(9)
    v_mfma_f32_16x16x32_bf16 v[0:3], v[104:107], v[56:59], v[0:3]
    s_bfe_u32 s60, s20, 0x10002
    s_lshl_b32 s60, s60, 4
    ds_read_b128 v[52:55], v222 offset:320
    s_waitcnt vmcnt(16)
    v_mfma_f32_16x16x32_bf16 v[0:3], v[108:111], v[60:63], v[0:3]
    s_add_u32 s59, s59, s60
    v_add_u32 v228, s59, v229
    ds_read_b128 v[56:59], v222 offset:640
    s_waitcnt vmcnt(15) lgkmcnt(9)
    v_mfma_f32_16x16x32_bf16 v[0:3], v[112:115], v[64:67], v[0:3]
    s_mul_i32 s60, s20, 2400
    s_add_u32 s60, s60, 65536
    ds_read_b128 v[60:63], v222 offset:512
    s_waitcnt vmcnt(14)
    v_mfma_f32_16x16x32_bf16 v[0:3], v[116:119], v[68:71], v[0:3]
    v_add_u32 v249, s60, v229
    s_mov_b32 s63, 0xbfb8aa3b
    ds_read_b128 v[64:67], v222 offset:768
    s_waitcnt vmcnt(13) lgkmcnt(9)
    v_mfma_f32_16x16x32_bf16 v[0:3], v[120:123], v[72:75], v[0:3]
    s_add_u32 s40, s20, s21
    s_lshl_b32 s40, s40, 10
    ds_read_b128 v[68:71], v222 offset:704
    s_waitcnt vmcnt(12)
    v_mfma_f32_16x16x32_bf16 v[0:3], v[124:127], v[76:79], v[0:3]
    s_add_u32 s41, s40, 8192
    s_add_u32 s42, s40, 16384
    ds_read_b128 v[72:75], v222 offset:576
    s_waitcnt vmcnt(11) lgkmcnt(9)
    v_mfma_f32_16x16x32_bf16 v[4:7], v[128:131], v[80:83], 0
    s_add_u32 s43, s40, 24576
    s_add_u32 s44, s40, 32768
    ds_read_b128 v[76:79], v222 offset:832
    v_mfma_f32_16x16x32_bf16 v[8:11], v[128:131], v[84:87], 0
    ds_read_b128 v[80:83], v222 offset:1024
    s_waitcnt lgkmcnt(9)
    v_mfma_f32_16x16x32_bf16 v[12:15], v[128:131], v[88:91], 0
    ds_read_b128 v[84:87], v222 offset:1280
    s_waitcnt vmcnt(10)
    v_mfma_f32_16x16x32_bf16 v[4:7], v[132:135], v[92:95], v[4:7]
    ds_read_b128 v[88:91], v222 offset:1152
    s_waitcnt lgkmcnt(9)
    v_mfma_f32_16x16x32_bf16 v[8:11], v[132:135], v[48:51], v[8:11]
    v_mul_f32 v204, s63, v0
    ds_read_b128 v[92:95], v222 offset:1088
    v_mfma_f32_16x16x32_bf16 v[12:15], v[132:135], v[52:55], v[12:15]
    v_mul_f32 v205, s63, v1
    s_setprio 2
    ds_read_b128 v[48:51], v222 offset:1344
    s_waitcnt vmcnt(9) lgkmcnt(9)
    v_mfma_f32_16x16x32_bf16 v[4:7], v[136:139], v[56:59], v[4:7]
    ds_read_b128 v[52:55], v222 offset:1216
    v_mfma_f32_16x16x32_bf16 v[8:11], v[136:139], v[60:63], v[8:11]
    v_mul_f32 v206, s63, v2
    ds_read_b128 v[56:59], v223 offset:128
    s_waitcnt lgkmcnt(9)
    v_mfma_f32_16x16x32_bf16 v[12:15], v[136:139], v[64:67], v[12:15]
    v_mul_f32 v207, s63, v3
    ds_read_b128 v[60:63], v223 offset:384
    s_waitcnt vmcnt(8)
    v_mfma_f32_16x16x32_bf16 v[4:7], v[140:143], v[68:71], v[4:7]
    ds_read_b128 v[64:67], v223 offset:256
    s_waitcnt lgkmcnt(9)
    v_mfma_f32_16x16x32_bf16 v[8:11], v[140:143], v[72:75], v[8:11]
    v_exp_f32 v204, v204
    ds_read_b128 v[68:71], v223 offset:192
    v_mfma_f32_16x16x32_bf16 v[12:15], v[140:143], v[76:79], v[12:15]
    ds_read_b128 v[72:75], v223 offset:448
    s_waitcnt vmcnt(7) lgkmcnt(9)
    v_mfma_f32_16x16x32_bf16 v[4:7], v[144:147], v[80:83], v[4:7]
    v_exp_f32 v205, v205
    ds_read_b128 v[76:79], v223 offset:320
    v_mfma_f32_16x16x32_bf16 v[8:11], v[144:147], v[84:87], v[8:11]
    v_exp_f32 v206, v206
    ds_read_b128 v[80:83], v223 offset:640
    s_waitcnt lgkmcnt(9)
    v_mfma_f32_16x16x32_bf16 v[12:15], v[144:147], v[88:91], v[12:15]
    ds_read_b128 v[84:87], v223 offset:512
    s_waitcnt vmcnt(6)
    v_mfma_f32_16x16x32_bf16 v[4:7], v[148:151], v[92:95], v[4:7]
    v_exp_f32 v207, v207
    ds_read_b128 v[88:91], v223 offset:768
    s_waitcnt lgkmcnt(9)
    v_mfma_f32_16x16x32_bf16 v[8:11], v[148:151], v[48:51], v[8:11]
    v_add_f32 v204, 1.0, v204
    ds_read_b128 v[92:95], v223 offset:704
    v_mfma_f32_16x16x32_bf16 v[12:15], v[148:151], v[52:55], v[12:15]
    ds_read_b128 v[48:51], v223 offset:576
    s_waitcnt vmcnt(5) lgkmcnt(9)
    v_mfma_f32_16x16x32_bf16 v[4:7], v[152:155], v[56:59], v[4:7]
    v_add_f32 v205, 1.0, v205
    ds_read_b128 v[52:55], v223 offset:832
    v_mfma_f32_16x16x32_bf16 v[8:11], v[152:155], v[60:63], v[8:11]
    s_setprio 1
    ds_read_b128 v[56:59], v223 offset:1024
    s_waitcnt lgkmcnt(9)
    v_mfma_f32_16x16x32_bf16 v[12:15], v[152:155], v[64:67], v[12:15]
    v_add_f32 v206, 1.0, v206
    ds_read_b128 v[60:63], v223 offset:1280
    s_waitcnt vmcnt(4)
    v_mfma_f32_16x16x32_bf16 v[4:7], v[156:159], v[68:71], v[4:7]
    v_add_f32 v207, 1.0, v207
    ds_read_b128 v[64:67], v223 offset:1152
    s_waitcnt lgkmcnt(9)
    v_mfma_f32_16x16x32_bf16 v[8:11], v[156:159], v[72:75], v[8:11]
    ds_read_b128 v[68:71], v223 offset:1088
    v_mfma_f32_16x16x32_bf16 v[12:15], v[156:159], v[76:79], v[12:15]
    v_rcp_f32 v204, v204
    ds_read_b128 v[72:75], v223 offset:1344
    s_waitcnt vmcnt(3) lgkmcnt(9)
    v_mfma_f32_16x16x32_bf16 v[4:7], v[160:163], v[80:83], v[4:7]
    v_rcp_f32 v205, v205
    ds_read_b128 v[76:79], v223 offset:1216
    v_mfma_f32_16x16x32_bf16 v[8:11], v[160:163], v[84:87], v[8:11]
    ds_read_b128 v[80:83], v222 offset:3072
    s_waitcnt lgkmcnt(9)
    v_mfma_f32_16x16x32_bf16 v[12:15], v[160:163], v[88:91], v[12:15]
    v_rcp_f32 v206, v206
    ds_read_b128 v[84:87], v222 offset:3136
    s_waitcnt vmcnt(2)
    v_mfma_f32_16x16x32_bf16 v[4:7], v[164:167], v[92:95], v[4:7]
    ds_read_b128 v[88:91], v222 offset:3968
    s_waitcnt lgkmcnt(9)
    v_mfma_f32_16x16x32_bf16 v[8:11], v[164:167], v[48:51], v[8:11]
    v_rcp_f32 v207, v207
    ds_read_b128 v[92:95], v222 offset:4032
    v_mfma_f32_16x16x32_bf16 v[12:15], v[164:167], v[52:55], v[12:15]
    v_cvt_pk_bf16_f32 v176, v0, v1
    ds_read_b128 v[48:51], v223 offset:38400
    s_waitcnt vmcnt(1) lgkmcnt(9)
    v_mfma_f32_16x16x32_bf16 v[4:7], v[168:171], v[56:59], v[4:7]
    ds_read_b128 v[52:55], v223 offset:38464
    v_mfma_f32_16x16x32_bf16 v[8:11], v[168:171], v[60:63], v[8:11]
    v_cvt_pk_bf16_f32 v177, v2, v3
    s_setprio 0
    ds_read_b128 v[56:59], v223 offset:39296
    s_waitcnt lgkmcnt(9)
    v_mfma_f32_16x16x32_bf16 v[12:15], v[168:171], v[64:67], v[12:15]
    ds_read_b128 v[60:63], v223 offset:39360
    s_waitcnt vmcnt(0)
    v_mfma_f32_16x16x32_bf16 v[4:7], v[172:175], v[68:71], v[4:7]
K2_PAD_T2:
    s_cbranch_execz K2_HOP
    ds_read_b128 v[64:67], v222 offset:3200
    s_waitcnt lgkmcnt(9)
    v_mfma_f32_16x16x32_bf16 v[8:11], v[172:175], v[72:75], v[8:11]
    ds_read_b128 v[68:71], v222 offset:3456
    v_mfma_f32_16x16x32_bf16 v[12:15], v[172:175], v[76:79], v[12:15]
    ds_read_b128 v[72:75], v222 offset:3328
    s_waitcnt lgkmcnt(9)
    v_mfma_f32_16x16x32_bf16 v[16:19], v[96:99], v[80:83], 0
    ds_read_b128 v[76:79], v222 offset:3264
    v_mfma_f32_16x16x32_bf16 v[16:19], v[100:103], v[84:87], v[16:19]
    ds_read_b128 v[80:83], v222 offset:3520
    s_waitcnt lgkmcnt(9)
    v_mfma_f32_16x16x32_bf16 v[16:19], v[104:107], v[88:91], v[16:19]
    s_barrier
    s_setprio 3
    ds_read_b128 v[84:87], v222 offset:3392
    v_mfma_f32_16x16x32_bf16 v[16:19], v[108:111], v[92:95], v[16:19]
    v_mul_f32 v4, v4, v204
    ds_read_b128 v[88:91], v222 offset:3712
    s_waitcnt lgkmcnt(9)
    v_mfma_f32_16x16x32_bf16 v[16:19], v[112:115], v[48:51], v[16:19]
    v_mul_f32 v5, v5, v205
    ds_read_b128 v[92:95], v222 offset:3584
    v_mfma_f32_16x16x32_bf16 v[16:19], v[116:119], v[52:55], v[16:19]
    v_mul_f32 v6, v6, v206
    ds_read_b128 v[48:51], v222 offset:3840
    s_waitcnt lgkmcnt(9)
    v_mfma_f32_16x16x32_bf16 v[16:19], v[120:123], v[56:59], v[16:19]
    v_mul_f32 v7, v7, v207
    ds_read_b128 v[52:55], v222 offset:3776
    v_mfma_f32_16x16x32_bf16 v[16:19], v[124:127], v[60:63], v[16:19]
    v_cvt_pk_bf16_f32 v178, v4, v5
    ds_read_b128 v[56:59], v222 offset:3648
    s_waitcnt lgkmcnt(9)
    v_mfma_f32_16x16x32_bf16 v[20:23], v[128:131], v[64:67], 0
    v_cvt_pk_bf16_f32 v179, v6, v7
    ds_read_b128 v[60:63], v222 offset:3904
    v_mfma_f32_16x16x32_bf16 v[24:27], v[128:131], v[68:71], 0
    v_mul_f32 v8, v8, v204
    ds_read_b128 v[64:67], v222 offset:4096
    s_waitcnt lgkmcnt(9)
    v_mfma_f32_16x16x32_bf16 v[28:31], v[128:131], v[72:75], 0
    v_mul_f32 v9, v9, v205
    ds_read_b128 v[68:71], v222 offset:4352
    v_mfma_f32_16x16x32_bf16 v[20:23], v[132:135], v[76:79], v[20:23]
    v_mul_f32 v10, v10, v206
    ds_read_b128 v[72:75], v222 offset:4224
    s_waitcnt lgkmcnt(9)
    v_mfma_f32_16x16x32_bf16 v[24:27], v[132:135], v[80:83], v[24:27]
    v_mul_f32 v11, v11, v207
    ds_read_b128 v[76:79], v222 offset:4160
    v_mfma_f32_16x16x32_bf16 v[28:31], v[132:135], v[84:87], v[28:31]
    v_cvt_pk_bf16_f32 v180, v8, v9
    ds_read_b128 v[80:83], v222 offset:4416
    s_waitcnt lgkmcnt(9)
    v_mfma_f32_16x16x32_bf16 v[20:23], v[136:139], v[88:91], v[20:23]
    v_cvt_pk_bf16_f32 v181, v10, v11
    ds_read_b128 v[84:87], v222 offset:4288
    v_mfma_f32_16x16x32_bf16 v[24:27], v[136:139], v[92:95], v[24:27]
    v_mul_f32 v12, v12, v204
    s_setprio 2
    ds_read_b128 v[88:91], v223 offset:38528
    s_waitcnt lgkmcnt(9)
    v_mfma_f32_16x16x32_bf16 v[28:31], v[136:139], v[48:51], v[28:31]
    v_mul_f32 v13, v13, v205
    ds_read_b128 v[92:95], v223 offset:38784
    v_mfma_f32_16x16x32_bf16 v[20:23], v[140:143], v[52:55], v[20:23]
    v_mul_f32 v14, v14, v206
    ds_read_b128 v[48:51], v223 offset:38656
    s_waitcnt lgkmcnt(9)
    v_mfma_f32_16x16x32_bf16 v[24:27], v[140:143], v[56:59], v[24:27]
    v_mul_f32 v15, v15, v207
    ds_read_b128 v[52:55], v223 offset:38592
    v_mfma_f32_16x16x32_bf16 v[28:31], v[140:143], v[60:63], v[28:31]
    v_cvt_pk_bf16_f32 v182, v12, v13
    ds_read_b128 v[56:59], v223 offset:38848
    s_waitcnt lgkmcnt(9)
    v_mfma_f32_16x16x32_bf16 v[20:23], v[144:147], v[64:67], v[20:23]
    v_cvt_pk_bf16_f32 v183, v14, v15
    ds_read_b128 v[60:63], v223 offset:38720
    v_mfma_f32_16x16x32_bf16 v[24:27], v[144:147], v[68:71], v[24:27]
    ds_write_b64 v254, v[176:177] offset:0
    ds_write_b64 v254, v[178:179] offset:256
    ds_write_b64 v254, v[180:181] offset:512
    ds_write_b64 v254, v[182:183] offset:768
    ds_read_b128 v[64:67], v223 offset:39040
    s_waitcnt lgkmcnt(13)
    v_mfma_f32_16x16x32_bf16 v[28:31], v[144:147], v[72:75], v[28:31]
    v_mul_f32 v208, s63, v16
    ds_read_b128 v[68:71], v223 offset:38912
    v_mfma_f32_16x16x32_bf16 v[20:23], v[148:151], v[76:79], v[20:23]
    v_mul_f32 v209, s63, v17
    ds_read_b128 v[72:75], v223 offset:39168
    s_waitcnt lgkmcnt(13)
    v_mfma_f32_16x16x32_bf16 v[24:27], v[148:151], v[80:83], v[24:27]
    v_mul_f32 v210, s63, v18
    ds_read_b128 v[76:79], v223 offset:39104
    v_mfma_f32_16x16x32_bf16 v[28:31], v[148:151], v[84:87], v[28:31]
    v_mul_f32 v211, s63, v19
    ds_read_b128 v[80:83], v223 offset:38976
    s_waitcnt lgkmcnt(13)
    v_mfma_f32_16x16x32_bf16 v[20:23], v[152:155], v[88:91], v[20:23]
    v_exp_f32 v208, v208
    ds_read_b128 v[84:87], v223 offset:39232
    v_mfma_f32_16x16x32_bf16 v[24:27], v[152:155], v[92:95], v[24:27]
    v_exp_f32 v209, v209
    ds_read_b128 v[88:91], v223 offset:39424
    s_waitcnt lgkmcnt(13)
    v_mfma_f32_16x16x32_bf16 v[28:31], v[152:155], v[48:51], v[28:31]
    s_setprio 1
    ds_read_b128 v[92:95], v223 offset:39680
    v_mfma_f32_16x16x32_bf16 v[20:23], v[156:159], v[52:55], v[20:23]
    v_exp_f32 v210, v210
    ds_read_b128 v[48:51], v223 offset:39552
    s_waitcnt lgkmcnt(13)
    v_mfma_f32_16x16x32_bf16 v[24:27], v[156:159], v[56:59], v[24:27]
    v_exp_f32 v211, v211
    ds_read_b128 v[52:55], v223 offset:39488
    v_mfma_f32_16x16x32_bf16 v[28:31], v[156:159], v[60:63], v[28:31]
    v_add_f32 v208, 1.0, v208
    ds_read_b128 v[56:59], v223 offset:39744
    s_waitcnt lgkmcnt(9)
    v_mfma_f32_16x16x32_bf16 v[20:23], v[160:163], v[64:67], v[20:23]
    v_add_f32 v209, 1.0, v209
    ds_read_b128 v[60:63], v223 offset:39616
    v_mfma_f32_16x16x32_bf16 v[24:27], v[160:163], v[68:71], v[24:27]
    v_add_f32 v210, 1.0, v210
    ds_read_b128 v[64:67], v232 offset:6144
    s_waitcnt lgkmcnt(9)
    v_mfma_f32_16x16x32_bf16 v[28:31], v[160:163], v[72:75], v[28:31]
    v_add_f32 v211, 1.0, v211
    ds_read_b128 v[68:71], v232 offset:6208
    v_mfma_f32_16x16x32_bf16 v[20:23], v[164:167], v[76:79], v[20:23]
    ds_read_b128 v[72:75], v232 offset:7040
    s_waitcnt lgkmcnt(9)
    v_mfma_f32_16x16x32_bf16 v[24:27], v[164:167], v[80:83], v[24:27]
    v_rcp_f32 v208, v208
    ds_read_b128 v[76:79], v232 offset:7104
    v_mfma_f32_16x16x32_bf16 v[28:31], v[164:167], v[84:87], v[28:31]
    v_rcp_f32 v209, v209
    ds_read_b128 v[80:83], v225 offset:0
    s_waitcnt lgkmcnt(9)
    v_mfma_f32_16x16x32_bf16 v[20:23], v[168:171], v[88:91], v[20:23]
    v_rcp_f32 v210, v210
    ds_read_b128 v[84:87], v225 offset:64
    v_mfma_f32_16x16x32_bf16 v[24:27], v[168:171], v[92:95], v[24:27]
    v_rcp_f32 v211, v211
    ds_read_b128 v[88:91], v225 offset:896
    s_waitcnt lgkmcnt(9)
    v_mfma_f32_16x16x32_bf16 v[28:31], v[168:171], v[48:51], v[28:31]
    v_cvt_pk_bf16_f32 v184, v16, v17
    s_setprio 0
    ds_read_b128 v[92:95], v225 offset:960
    v_mfma_f32_16x16x32_bf16 v[20:23], v[172:175], v[52:55], v[20:23]
    v_cvt_pk_bf16_f32 v185, v18, v19
    ds_read_b128 v[48:51], v247 offset:6272
    s_waitcnt lgkmcnt(9)
    v_mfma_f32_16x16x32_bf16 v[24:27], v[172:175], v[56:59], v[24:27]
    ds_read_b128 v[52:55], v232 offset:6528
    v_mfma_f32_16x16x32_bf16 v[28:31], v[172:175], v[60:63], v[28:31]
    ds_read_b128 v[56:59], v247 offset:6336
    s_waitcnt lgkmcnt(9)
    v_mfma_f32_16x16x32_bf16 v[32:35], v[96:99], v[64:67], 0
    ds_read_b128 v[60:63], v232 offset:6592
    v_mfma_f32_16x16x32_bf16 v[32:35], v[100:103], v[68:71], v[32:35]
    ds_read_b128 v[64:67], v247 offset:6784
    s_waitcnt lgkmcnt(9)
    v_mfma_f32_16x16x32_bf16 v[32:35], v[104:107], v[72:75], v[32:35]
    s_barrier
    ds_read_b128 v[192:195], v228 offset:0
    ds_read_b128 v[196:199], v228 offset:1536
    s_setprio 3
    ds_read_b128 v[68:71], v232 offset:6656
    v_mfma_f32_16x16x32_bf16 v[32:35], v[108:111], v[76:79], v[32:35]
    v_mul_f32 v20, v20, v208
    ds_read_b128 v[72:75], v247 offset:6848
    s_waitcnt lgkmcnt(11)
    v_mfma_f32_16x16x32_bf16 v[32:35], v[112:115], v[80:83], v[32:35]
    v_mul_f32 v21, v21, v209
    ds_read_b128 v[76:79], v232 offset:6720
    v_mfma_f32_16x16x32_bf16 v[32:35], v[116:119], v[84:87], v[32:35]
    v_mul_f32 v22, v22, v210
    ds_read_b128 v[80:83], v247 offset:7168
    s_waitcnt lgkmcnt(11)
    v_mfma_f32_16x16x32_bf16 v[32:35], v[120:123], v[88:91], v[32:35]
    v_mul_f32 v23, v23, v211
    ds_read_b128 v[84:87], v232 offset:7424
    v_mfma_f32_16x16x32_bf16 v[32:35], v[124:127], v[92:95], v[32:35]
    v_cvt_pk_bf16_f32 v186, v20, v21
    ds_read_b128 v[88:91], v247 offset:7232
    s_waitcnt lgkmcnt(11)
    v_mfma_f32_16x16x32_bf16 v[36:39], v[128:131], v[48:51], 0
    v_cvt_pk_bf16_f32 v187, v22, v23
    ds_read_b128 v[92:95], v232 offset:7488
    v_mfma_f32_16x16x32_bf16 v[40:43], v[128:131], v[52:55], 0
    v_mul_f32 v24, v24, v208
    ds_read_b128 v[48:51], v248 offset:128
    s_waitcnt lgkmcnt(11)
    v_mfma_f32_16x16x32_bf16 v[36:39], v[132:135], v[56:59], v[36:39]
    v_mul_f32 v25, v25, v209
    s_waitcnt lgkmcnt(8)
    buffer_store_dwordx4 v[192:195], v229, s[12:15], s40 offen sc1
    buffer_store_dwordx4 v[196:199], v229, s[12:15], s41 offen sc1
    ds_read_b128 v[52:55], v225 offset:384
    v_mfma_f32_16x16x32_bf16 v[40:43], v[132:135], v[60:63], v[40:43]
    v_mul_f32 v26, v26, v210
    s_setprio 2
    ds_read_b128 v[56:59], v248 offset:192
    s_waitcnt lgkmcnt(9)
    v_mfma_f32_16x16x32_bf16 v[36:39], v[136:139], v[64:67], v[36:39]
    v_mul_f32 v27, v27, v211
    v_mul_f32 v204, s63, v32
    ds_read_b128 v[60:63], v225 offset:448
    v_mfma_f32_16x16x32_bf16 v[40:43], v[136:139], v[68:71], v[40:43]
    v_cvt_pk_bf16_f32 v188, v24, v25
    v_mul_f32 v205, s63, v33
    ds_read_b128 v[64:67], v248 offset:640
    s_waitcnt lgkmcnt(9)
    v_mfma_f32_16x16x32_bf16 v[36:39], v[140:143], v[72:75], v[36:39]
    v_cvt_pk_bf16_f32 v189, v26, v27
    v_mul_f32 v206, s63, v34
    ds_read_b128 v[68:71], v225 offset:512
    v_mfma_f32_16x16x32_bf16 v[40:43], v[140:143], v[76:79], v[40:43]
    v_mul_f32 v28, v28, v208
    v_mul_f32 v207, s63, v35
    ds_read_b128 v[72:75], v248 offset:704
    s_waitcnt lgkmcnt(9)
    v_mfma_f32_16x16x32_bf16 v[36:39], v[144:147], v[80:83], v[36:39]
    v_mul_f32 v29, v29, v209
    v_exp_f32 v204, v204
    ds_read_b128 v[76:79], v225 offset:576
    v_mfma_f32_16x16x32_bf16 v[40:43], v[144:147], v[84:87], v[40:43]
    v_mul_f32 v30, v30, v210
    v_exp_f32 v205, v205
    ds_read_b128 v[80:83], v248 offset:1024
    s_waitcnt lgkmcnt(9)
    v_mfma_f32_16x16x32_bf16 v[36:39], v[148:151], v[88:91], v[36:39]
    v_mul_f32 v31, v31, v211
    v_exp_f32 v206, v206
    ds_read_b128 v[84:87], v225 offset:1280
    v_mfma_f32_16x16x32_bf16 v[40:43], v[148:151], v[92:95], v[40:43]
    v_cvt_pk_bf16_f32 v190, v28, v29
    v_exp_f32 v207, v207
    ds_read_b128 v[88:91], v248 offset:1088
    s_waitcnt lgkmcnt(9)
    v_mfma_f32_16x16x32_bf16 v[36:39], v[152:155], v[48:51], v[36:39]
    v_cvt_pk_bf16_f32 v191, v30, v31
    v_add_f32 v204, 1.0, v204
    s_setprio 1
    ds_read_b128 v[92:95], v225 offset:1344
    v_mfma_f32_16x16x32_bf16 v[40:43], v[152:155], v[52:55], v[40:43]
    ds_write_b64 v254, v[184:185] offset:3072
    ds_write_b64 v254, v[186:187] offset:3328
    ds_write_b64 v254, v[188:189] offset:3584
    ds_write_b64 v254, v[190:191] offset:3840
    v_add_f32 v205, 1.0, v205
    s_waitcnt lgkmcnt(12)
    v_mfma_f32_16x16x32_bf16 v[36:39], v[156:159], v[56:59], v[36:39]
    v_add_f32 v206, 1.0, v206
    v_mfma_f32_16x16x32_bf16 v[40:43], v[156:159], v[60:63], v[40:43]
    v_add_f32 v207, 1.0, v207
    s_waitcnt lgkmcnt(10)
    v_mfma_f32_16x16x32_bf16 v[36:39], v[160:163], v[64:67], v[36:39]
    v_rcp_f32 v204, v204
    v_mfma_f32_16x16x32_bf16 v[40:43], v[160:163], v[68:71], v[40:43]
    v_rcp_f32 v205, v205
    s_waitcnt lgkmcnt(8)
    v_mfma_f32_16x16x32_bf16 v[36:39], v[164:167], v[72:75], v[36:39]
    v_rcp_f32 v206, v206
    v_mfma_f32_16x16x32_bf16 v[40:43], v[164:167], v[76:79], v[40:43]
    v_rcp_f32 v207, v207
    s_waitcnt lgkmcnt(6)
    v_mfma_f32_16x16x32_bf16 v[36:39], v[168:171], v[80:83], v[36:39]
    v_cvt_pk_bf16_f32 v176, v32, v33
    s_setprio 0
    v_mfma_f32_16x16x32_bf16 v[40:43], v[168:171], v[84:87], v[40:43]
    v_cvt_pk_bf16_f32 v177, v34, v35
    s_waitcnt lgkmcnt(4)
    v_mfma_f32_16x16x32_bf16 v[36:39], v[172:175], v[88:91], v[36:39]
    ds_write_b64 v255, v[176:177] offset:0
    v_mfma_f32_16x16x32_bf16 v[40:43], v[172:175], v[92:95], v[40:43]
    s_nop 5
    v_mul_f32 v36, v36, v204
    v_mul_f32 v37, v37, v205
    v_mul_f32 v38, v38, v206
    v_mul_f32 v39, v39, v207
    v_cvt_pk_bf16_f32 v178, v36, v37
    v_cvt_pk_bf16_f32 v179, v38, v39
    v_mul_f32 v40, v40, v204
    v_mul_f32 v41, v41, v205
    v_mul_f32 v42, v42, v206
    v_mul_f32 v43, v43, v207
    v_cvt_pk_bf16_f32 v180, v40, v41
    v_cvt_pk_bf16_f32 v181, v42, v43
    ds_write_b64 v246, v[178:179] offset:256
    ds_write_b64 v255, v[180:181] offset:512
    s_waitcnt lgkmcnt(0)
    s_barrier
    ds_read_b128 v[192:195], v228 offset:3072
    ds_read_b128 v[196:199], v228 offset:4608
    ds_read_b128 v[200:203], v249
    s_waitcnt lgkmcnt(1)
    buffer_store_dwordx4 v[192:195], v229, s[12:15], s42 offen sc1
    buffer_store_dwordx4 v[196:199], v229, s[12:15], s43 offen sc1
K2_LASTROW:
    s_add_u32 s59, s20, 32
    s_cmp_ge_u32 s59, s22
    s_cbranch_scc1 K2_FIN
    s_waitcnt lgkmcnt(0)
    buffer_store_dwordx4 v[200:203], v229, s[12:15], s44 offen sc1
K2_FIN:
    s_endpgm
K2_MULTI:
    ds_read_b128 v[48:51], v222 offset:0
    ds_read_b128 v[52:55], v222 offset:64
    ds_read_b128 v[56:59], v222 offset:896
    ds_read_b128 v[60:63], v222 offset:960
    ds_read_b128 v[64:67], v223 offset:0
    ds_read_b128 v[68:71], v223 offset:64
    ds_read_b128 v[72:75], v223 offset:896
    ds_read_b128 v[76:79], v223 offset:960
    ds_read_b128 v[80:83], v222 offset:128
    ds_read_b128 v[84:87], v222 offset:384
    ds_read_b128 v[88:91], v222 offset:256
    s_waitcnt vmcnt(19) lgkmcnt(9)
    v_mfma_f32_16x16x32_bf16 v[0:3], v[96:99], v[48:51], 0
    ds_read_b128 v[92:95], v222 offset:192
    s_waitcnt vmcnt(18)
    v_mfma_f32_16x16x32_bf16 v[0:3], v[100:103], v[52:55], v[0:3]
    ds_read_b128 v[48:51], v222 offset:448
    s_waitcnt vmcnt(17) lgkmcnt(9)
    v_mfma_f32_16x16x32_bf16 v[0:3], v[104:107], v[56:59], v[0:3]
    ds_read_b128 v[52:55], v222 offset:320
    s_waitcnt vmcnt(16)
    v_mfma_f32_16x16x32_bf16 v[0:3], v[108:111], v[60:63], v[0:3]
    ds_read_b128 v[56:59], v222 offset:640
    s_waitcnt vmcnt(15) lgkmcnt(9)
    v_mfma_f32_16x16x32_bf16 v[0:3], v[112:115], v[64:67], v[0:3]
    ds_read_b128 v[60:63], v222 offset:512
    s_waitcnt vmcnt(14)
    v_mfma_f32_16x16x32_bf16 v[0:3], v[116:119], v[68:71], v[0:3]
    ds_read_b128 v[64:67], v222 offset:768
    s_waitcnt vmcnt(13) lgkmcnt(9)
    v_mfma_f32_16x16x32_bf16 v[0:3], v[120:123], v[72:75], v[0:3]
    ds_read_b128 v[68:71], v222 offset:704
    s_waitcnt vmcnt(12)
    v_mfma_f32_16x16x32_bf16 v[0:3], v[124:127], v[76:79], v[0:3]
    ds_read_b128 v[72:75], v222 offset:576
    s_waitcnt vmcnt(11) lgkmcnt(9)
    v_mfma_f32_16x16x32_bf16 v[4:7], v[128:131], v[80:83], 0
    ds_read_b128 v[76:79], v222 offset:832
    v_mfma_f32_16x16x32_bf16 v[8:11], v[128:131], v[84:87], 0
    ds_read_b128 v[80:83], v222 offset:1024
    s_waitcnt lgkmcnt(9)
    v_mfma_f32_16x16x32_bf16 v[12:15], v[128:131], v[88:91], 0
    ds_read_b128 v[84:87], v222 offset:1280
    s_waitcnt vmcnt(10)
    v_mfma_f32_16x16x32_bf16 v[4:7], v[132:135], v[92:95], v[4:7]
    ds_read_b128 v[88:91], v222 offset:1152
    s_waitcnt lgkmcnt(9)
    v_mfma_f32_16x16x32_bf16 v[8:11], v[132:135], v[48:51], v[8:11]
    ds_read_b128 v[92:95], v222 offset:1088
    v_mfma_f32_16x16x32_bf16 v[12:15], v[132:135], v[52:55], v[12:15]
    ds_read_b128 v[48:51], v222 offset:1344
    s_waitcnt vmcnt(9) lgkmcnt(9)
    v_mfma_f32_16x16x32_bf16 v[4:7], v[136:139], v[56:59], v[4:7]
    ds_read_b128 v[52:55], v222 offset:1216
    v_mfma_f32_16x16x32_bf16 v[8:11], v[136:139], v[60:63], v[8:11]
    ds_read_b128 v[56:59], v223 offset:128
    s_waitcnt lgkmcnt(9)
    v_mfma_f32_16x16x32_bf16 v[12:15], v[136:139], v[64:67], v[12:15]
    ds_read_b128 v[60:63], v223 offset:384
    s_waitcnt vmcnt(8)
    v_mfma_f32_16x16x32_bf16 v[4:7], v[140:143], v[68:71], v[4:7]
    ds_read_b128 v[64:67], v223 offset:256
    s_waitcnt lgkmcnt(9)
    v_mfma_f32_16x16x32_bf16 v[8:11], v[140:143], v[72:75], v[8:11]
    ds_read_b128 v[68:71], v223 offset:192
    v_mfma_f32_16x16x32_bf16 v[12:15], v[140:143], v[76:79], v[12:15]
    ds_read_b128 v[72:75], v223 offset:448
    s_waitcnt vmcnt(7) lgkmcnt(9)
    v_mfma_f32_16x16x32_bf16 v[4:7], v[144:147], v[80:83], v[4:7]
    ds_read_b128 v[76:79], v223 offset:320
    v_mfma_f32_16x16x32_bf16 v[8:11], v[144:147], v[84:87], v[8:11]
    ds_read_b128 v[80:83], v223 offset:640
    s_waitcnt lgkmcnt(9)
    v_mfma_f32_16x16x32_bf16 v[12:15], v[144:147], v[88:91], v[12:15]
    ds_read_b128 v[84:87], v223 offset:512
    s_waitcnt vmcnt(6)
    v_mfma_f32_16x16x32_bf16 v[4:7], v[148:151], v[92:95], v[4:7]
    ds_read_b128 v[88:91], v223 offset:768
    s_waitcnt lgkmcnt(9)
    v_mfma_f32_16x16x32_bf16 v[8:11], v[148:151], v[48:51], v[8:11]
    ds_read_b128 v[92:95], v223 offset:704
    v_mfma_f32_16x16x32_bf16 v[12:15], v[148:151], v[52:55], v[12:15]
    ds_read_b128 v[48:51], v223 offset:576
    s_waitcnt vmcnt(5) lgkmcnt(9)
    v_mfma_f32_16x16x32_bf16 v[4:7], v[152:155], v[56:59], v[4:7]
    ds_read_b128 v[52:55], v223 offset:832
    v_mfma_f32_16x16x32_bf16 v[8:11], v[152:155], v[60:63], v[8:11]
    ds_read_b128 v[56:59], v223 offset:1024
    s_waitcnt lgkmcnt(9)
    v_mfma_f32_16x16x32_bf16 v[12:15], v[152:155], v[64:67], v[12:15]
    ds_read_b128 v[60:63], v223 offset:1280
    s_waitcnt vmcnt(4)
    v_mfma_f32_16x16x32_bf16 v[4:7], v[156:159], v[68:71], v[4:7]
    ds_read_b128 v[64:67], v223 offset:1152
    s_waitcnt lgkmcnt(9)
    v_mfma_f32_16x16x32_bf16 v[8:11], v[156:159], v[72:75], v[8:11]
    ds_read_b128 v[68:71], v223 offset:1088
    v_mfma_f32_16x16x32_bf16 v[12:15], v[156:159], v[76:79], v[12:15]
    ds_read_b128 v[72:75], v223 offset:1344
    s_waitcnt vmcnt(3) lgkmcnt(9)
    v_mfma_f32_16x16x32_bf16 v[4:7], v[160:163], v[80:83], v[4:7]
    ds_read_b128 v[76:79], v223 offset:1216
    v_mfma_f32_16x16x32_bf16 v[8:11], v[160:163], v[84:87], v[8:11]
    ds_read_b128 v[80:83], v222 offset:3072
    s_waitcnt lgkmcnt(9)
    v_mfma_f32_16x16x32_bf16 v[12:15], v[160:163], v[88:91], v[12:15]
    ds_read_b128 v[84:87], v222 offset:3136
    s_waitcnt vmcnt(2)
    v_mfma_f32_16x16x32_bf16 v[4:7], v[164:167], v[92:95], v[4:7]
    ds_read_b128 v[88:91], v222 offset:3968
    s_waitcnt lgkmcnt(9)
    v_mfma_f32_16x16x32_bf16 v[8:11], v[164:167], v[48:51], v[8:11]
    ds_read_b128 v[92:95], v222 offset:4032
    v_mfma_f32_16x16x32_bf16 v[12:15], v[164:167], v[52:55], v[12:15]
    ds_read_b128 v[48:51], v223 offset:38400
    s_waitcnt vmcnt(1) lgkmcnt(9)
    v_mfma_f32_16x16x32_bf16 v[4:7], v[168:171], v[56:59], v[4:7]
    ds_read_b128 v[52:55], v223 offset:38464
    v_mfma_f32_16x16x32_bf16 v[8:11], v[168:171], v[60:63], v[8:11]
    ds_read_b128 v[56:59], v223 offset:39296
    s_waitcnt lgkmcnt(9)
    v_mfma_f32_16x16x32_bf16 v[12:15], v[168:171], v[64:67], v[12:15]
    ds_read_b128 v[60:63], v223 offset:39360
    s_waitcnt vmcnt(0)
    v_mfma_f32_16x16x32_bf16 v[4:7], v[172:175], v[68:71], v[4:7]
    ds_read_b128 v[64:67], v222 offset:3200
    s_waitcnt lgkmcnt(9)
    v_mfma_f32_16x16x32_bf16 v[8:11], v[172:175], v[72:75], v[8:11]
    ds_read_b128 v[68:71], v222 offset:3456
    v_mfma_f32_16x16x32_bf16 v[12:15], v[172:175], v[76:79], v[12:15]
    ds_read_b128 v[72:75], v222 offset:3328
    s_waitcnt lgkmcnt(9)
    v_mfma_f32_16x16x32_bf16 v[16:19], v[96:99], v[80:83], 0
    ds_read_b128 v[76:79], v222 offset:3264
    v_mfma_f32_16x16x32_bf16 v[16:19], v[100:103], v[84:87], v[16:19]
    ds_read_b128 v[80:83], v222 offset:3520
    s_waitcnt lgkmcnt(9)
    v_mfma_f32_16x16x32_bf16 v[16:19], v[104:107], v[88:91], v[16:19]
    ds_read_b128 v[84:87], v222 offset:3392
    v_mfma_f32_16x16x32_bf16 v[16:19], v[108:111], v[92:95], v[16:19]
    ds_read_b128 v[88:91], v222 offset:3712
    s_waitcnt lgkmcnt(9)
    v_mfma_f32_16x16x32_bf16 v[16:19], v[112:115], v[48:51], v[16:19]
    ds_read_b128 v[92:95], v222 offset:3584
    v_mfma_f32_16x16x32_bf16 v[16:19], v[116:119], v[52:55], v[16:19]
    ds_read_b128 v[48:51], v222 offset:3840
    s_waitcnt lgkmcnt(9)
    v_mfma_f32_16x16x32_bf16 v[16:19], v[120:123], v[56:59], v[16:19]
    ds_read_b128 v[52:55], v222 offset:3776
    v_mfma_f32_16x16x32_bf16 v[16:19], v[124:127], v[60:63], v[16:19]
    ds_read_b128 v[56:59], v222 offset:3648
    s_waitcnt lgkmcnt(9)
    v_mfma_f32_16x16x32_bf16 v[20:23], v[128:131], v[64:67], 0
    ds_read_b128 v[60:63], v222 offset:3904
    v_mfma_f32_16x16x32_bf16 v[24:27], v[128:131], v[68:71], 0
    ds_read_b128 v[64:67], v222 offset:4096
    s_waitcnt lgkmcnt(9)
    v_mfma_f32_16x16x32_bf16 v[28:31], v[128:131], v[72:75], 0
    ds_read_b128 v[68:71], v222 offset:4352
    v_mfma_f32_16x16x32_bf16 v[20:23], v[132:135], v[76:79], v[20:23]
    ds_read_b128 v[72:75], v222 offset:4224
    s_waitcnt lgkmcnt(9)
    v_mfma_f32_16x16x32_bf16 v[24:27], v[132:135], v[80:83], v[24:27]
    ds_read_b128 v[76:79], v222 offset:4160
    v_mfma_f32_16x16x32_bf16 v[28:31], v[132:135], v[84:87], v[28:31]
    ds_read_b128 v[80:83], v222 offset:4416
    s_waitcnt lgkmcnt(9)
    v_mfma_f32_16x16x32_bf16 v[20:23], v[136:139], v[88:91], v[20:23]
    ds_read_b128 v[84:87], v222 offset:4288
    v_mfma_f32_16x16x32_bf16 v[24:27], v[136:139], v[92:95], v[24:27]
    ds_read_b128 v[88:91], v223 offset:38528
    s_waitcnt lgkmcnt(9)
    v_mfma_f32_16x16x32_bf16 v[28:31], v[136:139], v[48:51], v[28:31]
    ds_read_b128 v[92:95], v223 offset:38784
    v_mfma_f32_16x16x32_bf16 v[20:23], v[140:143], v[52:55], v[20:23]
    ds_read_b128 v[48:51], v223 offset:38656
    s_waitcnt lgkmcnt(9)
    v_mfma_f32_16x16x32_bf16 v[24:27], v[140:143], v[56:59], v[24:27]
    ds_read_b128 v[52:55], v223 offset:38592
    v_mfma_f32_16x16x32_bf16 v[28:31], v[140:143], v[60:63], v[28:31]
    ds_read_b128 v[56:59], v223 offset:38848
    s_waitcnt lgkmcnt(9)
    v_mfma_f32_16x16x32_bf16 v[20:23], v[144:147], v[64:67], v[20:23]
    ds_read_b128 v[60:63], v223 offset:38720
    v_mfma_f32_16x16x32_bf16 v[24:27], v[144:147], v[68:71], v[24:27]
    ds_read_b128 v[64:67], v223 offset:39040
    s_waitcnt lgkmcnt(9)
    v_mfma_f32_16x16x32_bf16 v[28:31], v[144:147], v[72:75], v[28:31]
    ds_read_b128 v[68:71], v223 offset:38912
    v_mfma_f32_16x16x32_bf16 v[20:23], v[148:151], v[76:79], v[20:23]
    ds_read_b128 v[72:75], v223 offset:39168
    s_waitcnt lgkmcnt(9)
    v_mfma_f32_16x16x32_bf16 v[24:27], v[148:151], v[80:83], v[24:27]
    ds_read_b128 v[76:79], v223 offset:39104
    v_mfma_f32_16x16x32_bf16 v[28:31], v[148:151], v[84:87], v[28:31]
    ds_read_b128 v[80:83], v223 offset:38976
    s_waitcnt lgkmcnt(9)
    v_mfma_f32_16x16x32_bf16 v[20:23], v[152:155], v[88:91], v[20:23]
    ds_read_b128 v[84:87], v223 offset:39232
    v_mfma_f32_16x16x32_bf16 v[24:27], v[152:155], v[92:95], v[24:27]
    ds_read_b128 v[88:91], v223 offset:39424
    s_waitcnt lgkmcnt(9)
    v_mfma_f32_16x16x32_bf16 v[28:31], v[152:155], v[48:51], v[28:31]
    ds_read_b128 v[92:95], v223 offset:39680
    v_mfma_f32_16x16x32_bf16 v[20:23], v[156:159], v[52:55], v[20:23]
    ds_read_b128 v[48:51], v223 offset:39552
    s_waitcnt lgkmcnt(9)
    v_mfma_f32_16x16x32_bf16 v[24:27], v[156:159], v[56:59], v[24:27]
    ds_read_b128 v[52:55], v223 offset:39488
    v_mfma_f32_16x16x32_bf16 v[28:31], v[156:159], v[60:63], v[28:31]
    ds_read_b128 v[56:59], v223 offset:39744
    s_waitcnt lgkmcnt(9)
    v_mfma_f32_16x16x32_bf16 v[20:23], v[160:163], v[64:67], v[20:23]
    ds_read_b128 v[60:63], v223 offset:39616
    v_mfma_f32_16x16x32_bf16 v[24:27], v[160:163], v[68:71], v[24:27]
    ds_read_b128 v[64:67], v232 offset:6144
    s_waitcnt lgkmcnt(9)
    v_mfma_f32_16x16x32_bf16 v[28:31], v[160:163], v[72:75], v[28:31]
    ds_read_b128 v[68:71], v232 offset:6208
    v_mfma_f32_16x16x32_bf16 v[20:23], v[164:167], v[76:79], v[20:23]
    ds_read_b128 v[72:75], v232 offset:7040
    s_waitcnt lgkmcnt(9)
    v_mfma_f32_16x16x32_bf16 v[24:27], v[164:167], v[80:83], v[24:27]
    ds_read_b128 v[76:79], v232 offset:7104
    v_mfma_f32_16x16x32_bf16 v[28:31], v[164:167], v[84:87], v[28:31]
    ds_read_b128 v[80:83], v225 offset:0
    s_waitcnt lgkmcnt(9)
    v_mfma_f32_16x16x32_bf16 v[20:23], v[168:171], v[88:91], v[20:23]
    ds_read_b128 v[84:87], v225 offset:64
    v_mfma_f32_16x16x32_bf16 v[24:27], v[168:171], v[92:95], v[24:27]
    ds_read_b128 v[88:91], v225 offset:896
    s_waitcnt lgkmcnt(9)
    v_mfma_f32_16x16x32_bf16 v[28:31], v[168:171], v[48:51], v[28:31]
    ds_read_b128 v[92:95], v225 offset:960
    v_mfma_f32_16x16x32_bf16 v[20:23], v[172:175], v[52:55], v[20:23]
    ds_read_b128 v[48:51], v247 offset:6272
    s_waitcnt lgkmcnt(9)
    v_mfma_f32_16x16x32_bf16 v[24:27], v[172:175], v[56:59], v[24:27]
    ds_read_b128 v[52:55], v232 offset:6528
    v_mfma_f32_16x16x32_bf16 v[28:31], v[172:175], v[60:63], v[28:31]
    ds_read_b128 v[56:59], v247 offset:6336
    s_waitcnt lgkmcnt(9)
    v_mfma_f32_16x16x32_bf16 v[32:35], v[96:99], v[64:67], 0
    ds_read_b128 v[60:63], v232 offset:6592
    v_mfma_f32_16x16x32_bf16 v[32:35], v[100:103], v[68:71], v[32:35]
    ds_read_b128 v[64:67], v247 offset:6784
    s_waitcnt lgkmcnt(9)
    v_mfma_f32_16x16x32_bf16 v[32:35], v[104:107], v[72:75], v[32:35]
    ds_read_b128 v[68:71], v232 offset:6656
    v_mfma_f32_16x16x32_bf16 v[32:35], v[108:111], v[76:79], v[32:35]
    ds_read_b128 v[72:75], v247 offset:6848
    s_waitcnt lgkmcnt(9)
    v_mfma_f32_16x16x32_bf16 v[32:35], v[112:115], v[80:83], v[32:35]
    ds_read_b128 v[76:79], v232 offset:6720
    v_mfma_f32_16x16x32_bf16 v[32:35], v[116:119], v[84:87], v[32:35]
    ds_read_b128 v[80:83], v247 offset:7168
    s_waitcnt lgkmcnt(9)
    v_mfma_f32_16x16x32_bf16 v[32:35], v[120:123], v[88:91], v[32:35]
    ds_read_b128 v[84:87], v232 offset:7424
    v_mfma_f32_16x16x32_bf16 v[32:35], v[124:127], v[92:95], v[32:35]
    ds_read_b128 v[88:91], v247 offset:7232
    s_waitcnt lgkmcnt(9)
    v_mfma_f32_16x16x32_bf16 v[36:39], v[128:131], v[48:51], 0
    ds_read_b128 v[92:95], v232 offset:7488
    v_mfma_f32_16x16x32_bf16 v[40:43], v[128:131], v[52:55], 0
    ds_read_b128 v[48:51], v248 offset:128
    s_waitcnt lgkmcnt(9)
    v_mfma_f32_16x16x32_bf16 v[36:39], v[132:135], v[56:59], v[36:39]
    ds_read_b128 v[52:55], v225 offset:384
    v_mfma_f32_16x16x32_bf16 v[40:43], v[132:135], v[60:63], v[40:43]
    ds_read_b128 v[56:59], v248 offset:192
    s_waitcnt lgkmcnt(9)
    v_mfma_f32_16x16x32_bf16 v[36:39], v[136:139], v[64:67], v[36:39]
    ds_read_b128 v[60:63], v225 offset:448
    v_mfma_f32_16x16x32_bf16 v[40:43], v[136:139], v[68:71], v[40:43]
    ds_read_b128 v[64:67], v248 offset:640
    s_waitcnt lgkmcnt(9)
    v_mfma_f32_16x16x32_bf16 v[36:39], v[140:143], v[72:75], v[36:39]
    ds_read_b128 v[68:71], v225 offset:512
    v_mfma_f32_16x16x32_bf16 v[40:43], v[140:143], v[76:79], v[40:43]
    ds_read_b128 v[72:75], v248 offset:704
    s_waitcnt lgkmcnt(9)
    v_mfma_f32_16x16x32_bf16 v[36:39], v[144:147], v[80:83], v[36:39]
    ds_read_b128 v[76:79], v225 offset:576
    v_mfma_f32_16x16x32_bf16 v[40:43], v[144:147], v[84:87], v[40:43]
    ds_read_b128 v[80:83], v248 offset:1024
    s_waitcnt lgkmcnt(9)
    v_mfma_f32_16x16x32_bf16 v[36:39], v[148:151], v[88:91], v[36:39]
    ds_read_b128 v[84:87], v225 offset:1280
    v_mfma_f32_16x16x32_bf16 v[40:43], v[148:151], v[92:95], v[40:43]
    ds_read_b128 v[88:91], v248 offset:1088
    s_waitcnt lgkmcnt(9)
    v_mfma_f32_16x16x32_bf16 v[36:39], v[152:155], v[48:51], v[36:39]
    ds_read_b128 v[92:95], v225 offset:1344
    v_mfma_f32_16x16x32_bf16 v[40:43], v[152:155], v[52:55], v[40:43]
    s_waitcnt lgkmcnt(8)
    v_mfma_f32_16x16x32_bf16 v[36:39], v[156:159], v[56:59], v[36:39]
    v_mfma_f32_16x16x32_bf16 v[40:43], v[156:159], v[60:63], v[40:43]
    s_waitcnt lgkmcnt(6)
    v_mfma_f32_16x16x32_bf16 v[36:39], v[160:163], v[64:67], v[36:39]
    v_mfma_f32_16x16x32_bf16 v[40:43], v[160:163], v[68:71], v[40:43]
    s_waitcnt lgkmcnt(4)
    v_mfma_f32_16x16x32_bf16 v[36:39], v[164:167], v[72:75], v[36:39]
    v_mfma_f32_16x16x32_bf16 v[40:43], v[164:167], v[76:79], v[40:43]
    s_waitcnt lgkmcnt(2)
    v_mfma_f32_16x16x32_bf16 v[36:39], v[168:171], v[80:83], v[36:39]
    v_mfma_f32_16x16x32_bf16 v[40:43], v[168:171], v[84:87], v[40:43]
    s_waitcnt lgkmcnt(0)
    v_mfma_f32_16x16x32_bf16 v[36:39], v[172:175], v[88:91], v[36:39]
    v_mfma_f32_16x16x32_bf16 v[40:43], v[172:175], v[92:95], v[40:43]
    s_lshl_b32 s60, s54, 9
    s_lshl_b32 s61, s20, 6
    s_add_u32 s60, s60, s61
    s_mul_i32 s60, s60, 192
    s_add_u32 s60, s60, 10485760
    v_mul_u32_u24 v227, 96, v252
    s_cmp_lg_u32 s28, 0
    s_cbranch_scc1 K2_NOACC
    buffer_load_dwordx4 v[48:51], v227, s[8:11], s60 offen offset:0
    buffer_load_dwordx4 v[52:55], v227, s[8:11], s60 offen offset:16
    buffer_load_dwordx4 v[56:59], v227, s[8:11], s60 offen offset:32
    buffer_load_dwordx4 v[60:63], v227, s[8:11], s60 offen offset:48
    buffer_load_dwordx4 v[64:67], v227, s[8:11], s60 offen offset:64
    buffer_load_dwordx4 v[68:71], v227, s[8:11], s60 offen offset:80
    buffer_load_dwordx4 v[72:75], v227, s[8:11], s60 offen offset:96
    buffer_load_dwordx4 v[76:79], v227, s[8:11], s60 offen offset:112
    buffer_load_dwordx4 v[80:83], v227, s[8:11], s60 offen offset:128
    buffer_load_dwordx4 v[84:87], v227, s[8:11], s60 offen offset:144
    buffer_load_dwordx4 v[88:91], v227, s[8:11], s60 offen offset:160
    s_waitcnt vmcnt(0)
    v_add_f32 v0, v0, v48
    v_add_f32 v1, v1, v49
    v_add_f32 v2, v2, v50
    v_add_f32 v3, v3, v51
    v_add_f32 v4, v4, v52
    v_add_f32 v5, v5, v53
    v_add_f32 v6, v6, v54
    v_add_f32 v7, v7, v55
    v_add_f32 v8, v8, v56
    v_add_f32 v9, v9, v57
    v_add_f32 v10, v10, v58
    v_add_f32 v11, v11, v59
    v_add_f32 v12, v12, v60
    v_add_f32 v13, v13, v61
    v_add_f32 v14, v14, v62
    v_add_f32 v15, v15, v63
    v_add_f32 v16, v16, v64
    v_add_f32 v17, v17, v65
    v_add_f32 v18, v18, v66
    v_add_f32 v19, v19, v67
    v_add_f32 v20, v20, v68
    v_add_f32 v21, v21, v69
    v_add_f32 v22, v22, v70
    v_add_f32 v23, v23, v71
    v_add_f32 v24, v24, v72
    v_add_f32 v25, v25, v73
    v_add_f32 v26, v26, v74
    v_add_f32 v27, v27, v75
    v_add_f32 v28, v28, v76
    v_add_f32 v29, v29, v77
    v_add_f32 v30, v30, v78
    v_add_f32 v31, v31, v79
    v_add_f32 v32, v32, v80
    v_add_f32 v33, v33, v81
    v_add_f32 v34, v34, v82
    v_add_f32 v35, v35, v83
    v_add_f32 v36, v36, v84
    v_add_f32 v37, v37, v85
    v_add_f32 v38, v38, v86
    v_add_f32 v39, v39, v87
    v_add_f32 v40, v40, v88
    v_add_f32 v41, v41, v89
    v_add_f32 v42, v42, v90
    v_add_f32 v43, v43, v91
K2_NOACC:
    s_barrier
    s_cmp_eq_u32 s55, 0
    s_cbranch_scc1 K2_SPILL
    s_bfe_u32 s60, s20, 0x10002
    s_lshl_b32 s60, s60, 4
    s_add_u32 s59, s59, s60
    v_add_u32 v228, s59, v229
    s_mul_i32 s60, s20, 2400
    s_add_u32 s60, s60, 65536
    v_add_u32 v249, s60, v229
    s_mov_b32 s63, 0xbfb8aa3b
    s_add_u32 s40, s20, s21
    s_lshl_b32 s40, s40, 10
    s_add_u32 s41, s40, 8192
    s_add_u32 s42, s40, 16384
    s_add_u32 s43, s40, 24576
    s_add_u32 s44, s40, 32768
    v_mul_f32 v204, s63, v0
    v_mul_f32 v205, s63, v1
    v_mul_f32 v206, s63, v2
    v_mul_f32 v207, s63, v3
    v_exp_f32 v204, v204
    v_exp_f32 v205, v205
    v_exp_f32 v206, v206
    v_exp_f32 v207, v207
    v_add_f32 v204, 1.0, v204
    v_add_f32 v205, 1.0, v205
    v_add_f32 v206, 1.0, v206
    v_add_f32 v207, 1.0, v207
    v_rcp_f32 v204, v204
    v_rcp_f32 v205, v205
    v_rcp_f32 v206, v206
    v_rcp_f32 v207, v207
    v_cvt_pk_bf16_f32 v176, v0, v1
    v_cvt_pk_bf16_f32 v177, v2, v3
    v_mul_f32 v4, v4, v204
    v_mul_f32 v5, v5, v205
    v_mul_f32 v6, v6, v206
    v_mul_f32 v7, v7, v207
    v_cvt_pk_bf16_f32 v178, v4, v5
    v_cvt_pk_bf16_f32 v179, v6, v7
    v_mul_f32 v8, v8, v204
    v_mul_f32 v9, v9, v205
    v_mul_f32 v10, v10, v206
    v_mul_f32 v11, v11, v207
    v_cvt_pk_bf16_f32 v180, v8, v9
    v_cvt_pk_bf16_f32 v181, v10, v11
    v_mul_f32 v12, v12, v204
    v_mul_f32 v13, v13, v205
    v_mul_f32 v14, v14, v206
    v_mul_f32 v15, v15, v207
    v_cvt_pk_bf16_f32 v182, v12, v13
    v_cvt_pk_bf16_f32 v183, v14, v15
    ds_write_b64 v254, v[176:177] offset:0
    ds_write_b64 v254, v[178:179] offset:256
    ds_write_b64 v254, v[180:181] offset:512
    ds_write_b64 v254, v[182:183] offset:768
    s_waitcnt lgkmcnt(0)
    s_barrier
    ds_read_b128 v[192:195], v228 offset:0
    ds_read_b128 v[196:199], v228 offset:1536
    s_waitcnt lgkmcnt(0)
    buffer_store_dwordx4 v[192:195], v229, s[12:15], s40 offen sc1
    buffer_store_dwordx4 v[196:199], v229, s[12:15], s41 offen sc1
    v_mul_f32 v208, s63, v16
    v_mul_f32 v209, s63, v17
    v_mul_f32 v210, s63, v18
    v_mul_f32 v211, s63, v19
    v_exp_f32 v208, v208
    v_exp_f32 v209, v209
    v_exp_f32 v210, v210
    v_exp_f32 v211, v211
    v_add_f32 v208, 1.0, v208
    v_add_f32 v209, 1.0, v209
    v_add_f32 v210, 1.0, v210
    v_add_f32 v211, 1.0, v211
    v_rcp_f32 v208, v208
    v_rcp_f32 v209, v209
    v_rcp_f32 v210, v210
    v_rcp_f32 v211, v211
    v_cvt_pk_bf16_f32 v184, v16, v17
    v_cvt_pk_bf16_f32 v185, v18, v19
    v_mul_f32 v20, v20, v208
    v_mul_f32 v21, v21, v209
    v_mul_f32 v22, v22, v210
    v_mul_f32 v23, v23, v211
    v_cvt_pk_bf16_f32 v186, v20, v21
    v_cvt_pk_bf16_f32 v187, v22, v23
    v_mul_f32 v24, v24, v208
    v_mul_f32 v25, v25, v209
    v_mul_f32 v26, v26, v210
    v_mul_f32 v27, v27, v211
    v_cvt_pk_bf16_f32 v188, v24, v25
    v_cvt_pk_bf16_f32 v189, v26, v27
    v_mul_f32 v28, v28, v208
    v_mul_f32 v29, v29, v209
    v_mul_f32 v30, v30, v210
    v_mul_f32 v31, v31, v211
    v_cvt_pk_bf16_f32 v190, v28, v29
    v_cvt_pk_bf16_f32 v191, v30, v31
    ds_write_b64 v254, v[184:185] offset:3072
    ds_write_b64 v254, v[186:187] offset:3328
    ds_write_b64 v254, v[188:189] offset:3584
    ds_write_b64 v254, v[190:191] offset:3840
    s_waitcnt lgkmcnt(0)
    s_barrier
    ds_read_b128 v[192:195], v228 offset:3072
    ds_read_b128 v[196:199], v228 offset:4608
    s_waitcnt lgkmcnt(0)
    buffer_store_dwordx4 v[192:195], v229, s[12:15], s42 offen sc1
    buffer_store_dwordx4 v[196:199], v229, s[12:15], s43 offen sc1
    v_mul_f32 v204, s63, v32
    v_mul_f32 v205, s63, v33
    v_mul_f32 v206, s63, v34
    v_mul_f32 v207, s63, v35
    v_exp_f32 v204, v204
    v_exp_f32 v205, v205
    v_exp_f32 v206, v206
    v_exp_f32 v207, v207
    v_add_f32 v204, 1.0, v204
    v_add_f32 v205, 1.0, v205
    v_add_f32 v206, 1.0, v206
    v_add_f32 v207, 1.0, v207
    v_rcp_f32 v204, v204
    v_rcp_f32 v205, v205
    v_rcp_f32 v206, v206
    v_rcp_f32 v207, v207
    v_cvt_pk_bf16_f32 v176, v32, v33
    v_cvt_pk_bf16_f32 v177, v34, v35
    v_mul_f32 v36, v36, v204
    v_mul_f32 v37, v37, v205
    v_mul_f32 v38, v38, v206
    v_mul_f32 v39, v39, v207
    v_cvt_pk_bf16_f32 v178, v36, v37
    v_cvt_pk_bf16_f32 v179, v38, v39
    v_mul_f32 v40, v40, v204
    v_mul_f32 v41, v41, v205
    v_mul_f32 v42, v42, v206
    v_mul_f32 v43, v43, v207
    v_cvt_pk_bf16_f32 v180, v40, v41
    v_cvt_pk_bf16_f32 v181, v42, v43
    ds_write_b64 v255, v[176:177] offset:0
    ds_write_b64 v246, v[178:179] offset:256
    ds_write_b64 v255, v[180:181] offset:512
    s_waitcnt lgkmcnt(0)
    s_barrier
    ds_read_b128 v[200:203], v249
    s_branch K2_LASTROW
K2_SPILL:
    buffer_store_dwordx4 v[0:3], v227, s[8:11], s60 offen offset:0
    buffer_store_dwordx4 v[4:7], v227, s[8:11], s60 offen offset:16
    buffer_store_dwordx4 v[8:11], v227, s[8:11], s60 offen offset:32
    buffer_store_dwordx4 v[12:15], v227, s[8:11], s60 offen offset:48
    buffer_store_dwordx4 v[16:19], v227, s[8:11], s60 offen offset:64
    buffer_store_dwordx4 v[20:23], v227, s[8:11], s60 offen offset:80
    buffer_store_dwordx4 v[24:27], v227, s[8:11], s60 offen offset:96
    buffer_store_dwordx4 v[28:31], v227, s[8:11], s60 offen offset:112
    buffer_store_dwordx4 v[32:35], v227, s[8:11], s60 offen offset:128
    buffer_store_dwordx4 v[36:39], v227, s[8:11], s60 offen offset:144
    buffer_store_dwordx4 v[40:43], v227, s[8:11], s60 offen offset:160
    s_mov_b32 s28, 0
    s_waitcnt vmcnt(0)
    s_cmp_lt_u32 s24, s25
    s_cbranch_scc1 K2_LOAD
    s_add_u32 s23, s23, 20
    s_branch K2_WINDOW
K2_WINDOW:
    s_mov_b32 s24, 0
    s_mov_b32 s25, 1
K2_LOAD:
    v_mbcnt_lo_u32_b32 v176, -1, 0
    v_mbcnt_hi_u32_b32 v176, -1, v176
    s_lshl_b32 s58, s20, 6
    v_add_u32 v177, s58, v176
    v_lshlrev_b32 v70, 4, v176
    s_mov_b32 s58, 7110656
    buffer_load_dwordx4 v[96:99], v70, s[8:11], s58 offen offset:0 sc1
    buffer_load_dwordx4 v[100:103], v70, s[8:11], s58 offen offset:1024 sc1
    buffer_load_dwordx4 v[104:107], v70, s[8:11], s58 offen offset:2048 sc1
    buffer_load_dwordx4 v[108:111], v70, s[8:11], s58 offen offset:3072 sc1
    s_mov_b32 s58, 7114752
    buffer_load_dwordx4 v[112:115], v70, s[8:11], s58 offen offset:0 sc1
    buffer_load_dwordx4 v[116:119], v70, s[8:11], s58 offen offset:1024 sc1
    buffer_load_dwordx4 v[120:123], v70, s[8:11], s58 offen offset:2048 sc1
    buffer_load_dwordx4 v[124:127], v70, s[8:11], s58 offen offset:3072 sc1
    s_mov_b32 s58, 7118848
    buffer_load_dwordx4 v[128:131], v70, s[8:11], s58 offen offset:0 sc1
    buffer_load_dwordx4 v[132:135], v70, s[8:11], s58 offen offset:1024 sc1
    buffer_load_dwordx4 v[136:139], v70, s[8:11], s58 offen offset:2048 sc1
    buffer_load_dwordx4 v[140:143], v70, s[8:11], s58 offen offset:3072 sc1
    s_mov_b32 s58, 7122944
    buffer_load_dwordx4 v[144:147], v70, s[8:11], s58 offen offset:0 sc1
    buffer_load_dwordx4 v[148:151], v70, s[8:11], s58 offen offset:1024 sc1
    buffer_load_dwordx4 v[152:155], v70, s[8:11], s58 offen offset:2048 sc1
    buffer_load_dwordx4 v[156:159], v70, s[8:11], s58 offen offset:3072 sc1
    s_mov_b32 s58, 7127040
    buffer_load_dwordx4 v[160:163], v70, s[8:11], s58 offen offset:0 sc1
    buffer_load_dwordx4 v[164:167], v70, s[8:11], s58 offen offset:1024 sc1
    buffer_load_dwordx4 v[168:171], v70, s[8:11], s58 offen offset:2048 sc1
    buffer_load_dwordx4 v[172:175], v70, s[8:11], s58 offen offset:3072 sc1
    v_mul_u32_u24 v76, 437, v177
    v_lshrrev_b32 v76, 16, v76
    v_mul_u32_u24 v76, 150, v76
    v_sub_u32 v76, v177, v76
    v_mov_b32 v80, -1
    v_mov_b32 v77, 1.0
    v_cmp_gt_u32 vcc, 48, v76
    v_lshlrev_b32 v78, 4, v177
    v_add_u32 v78, 65536, v78
    v_cndmask_b32 v80, v80, 0, vcc
    v_cmp_gt_u32 vcc, 12, v76
    v_add_u32 v79, 64800, v78
    s_nop 0
    v_cndmask_b32 v80, v80, v77, vcc
    v_cmp_gt_u32 vcc, 450, v177
    v_mov_b32 v81, v80
    v_mov_b32 v82, v80
    v_mov_b32 v83, v80
    s_mov_b64 exec, vcc
    ds_write_b128 v78, v[80:83] offset:0
    ds_write_b128 v78, v[80:83] offset:7200
    ds_write_b128 v78, v[80:83] offset:14400
    ds_write_b128 v78, v[80:83] offset:21600
    ds_write_b128 v78, v[80:83] offset:28800
    ds_write_b128 v78, v[80:83] offset:36000
    ds_write_b128 v78, v[80:83] offset:43200
    ds_write_b128 v78, v[80:83] offset:50400
    ds_write_b128 v78, v[80:83] offset:57600
    ds_write_b128 v79, v[80:83] offset:0
    ds_write_b128 v79, v[80:83] offset:7200
    ds_write_b128 v79, v[80:83] offset:14400
    ds_write_b128 v79, v[80:83] offset:21600
    v_cmp_gt_u32 vcc, 268, v177
    s_nop 0
    s_cbranch_vccz K2_NOCL
    s_mov_b64 exec, vcc
    ds_write_b128 v79, v[80:83] offset:28800
K2_NOCL:
    s_mov_b64 exec, -1
    s_cmp_lg_u32 s20, 7
    s_cbranch_scc1 K2_NOH
    v_mov_b32 v76, 0
    v_mov_b32 v77, -1
    v_lshlrev_b32 v78, 2, v176
    v_add_u32 v78, 163424, v78
    s_mov_b64 exec, 0x1ff
    ds_write_b32 v78, v76 offset:192
    s_mov_b64 exec, 0xff
    ds_write_b32 v78, v77 offset:256
    s_mov_b64 exec, -1
    s_cmp_lg_u32 s24, 0
    s_cbranch_scc1 K2_NOH
    s_mov_b32 exec_hi, 0xffff
    ds_write_b32 v78, v76
    s_mov_b64 exec, 0x3f
    ds_write_b32 v78, v76 offset:228
    s_mov_b64 exec, -1
K2_NOH:
    s_waitcnt lgkmcnt(0)
    s_barrier
    s_branch K2_CELLS
K2_FLGLD:
    buffer_load_dwordx4 v[84:87], v72, s[8:11], s64 offen sc1
    s_mov_b32 s62, 0
    s_branch K2_FLGL2
K2_FLGCK:
    s_cmp_lg_u32 s24, 0
    s_cbranch_scc1 K2_FLGOK
    s_waitcnt vmcnt(0)
K2_FLGW:
    v_xor_b32 v84, s2, v84
    v_xor_b32 v85, s2, v85
    v_xor_b32 v86, s2, v86
    v_xor_b32 v87, s2, v87
    v_or3_b32 v84, v84, v85, v86
    v_or_b32 v84, v84, v87
    v_cmp_ne_u32 vcc, 0, v84
    s_nop 0
    s_and_b32 vcc_hi, vcc_hi, 0x3ffff
    s_cmp_eq_u64 vcc, 0
    s_cbranch_scc1 K2_FLGOK
    s_sub_u32 s60, s60, 1
    s_cbranch_scc1 K2_END
    buffer_load_dwordx4 v[84:87], v72, s[8:11], s64 offen sc1
    s_waitcnt vmcnt(0)
    s_branch K2_FLGW
K2_RT0:
    s_sub_u32 s60, s60, 1
    s_cbranch_scc1 K2_END
    buffer_load_dwordx4 v[0:3], v181, s[8:11], 0 offen offset:0 sc1
    s_waitcnt vmcnt(0)
    s_branch K2_CK0
K2_RT1:
    s_sub_u32 s60, s60, 1
    s_cbranch_scc1 K2_END
    buffer_load_dwordx4 v[4:7], v181, s[8:11], 0 offen offset:32 sc1
    s_waitcnt vmcnt(0)
    s_branch K2_CK1
K2_RT2:
    s_sub_u32 s60, s60, 1
    s_cbranch_scc1 K2_END
    buffer_load_dwordx4 v[8:11], v181, s[8:11], 0 offen offset:64 sc1
    s_waitcnt vmcnt(0)
    s_branch K2_CK2
K2_RT3:
    s_sub_u32 s60, s60, 1
    s_cbranch_scc1 K2_END
    buffer_load_dwordx4 v[12:15], v181, s[8:11], 0 offen offset:96 sc1
    s_waitcnt vmcnt(0)
    s_branch K2_CK3
K2_RT4:
    s_sub_u32 s60, s60, 1
    s_cbranch_scc1 K2_END
    buffer_load_dwordx4 v[16:19], v181, s[8:11], 0 offen offset:128 sc1
    s_waitcnt vmcnt(0)
    s_branch K2_CK4
K2_RT5:
    s_sub_u32 s60, s60, 1
    s_cbranch_scc1 K2_END
    buffer_load_dwordx4 v[20:23], v181, s[8:11], 0 offen offset:160 sc1
    s_waitcnt vmcnt(0)
    s_branch K2_CK5
K2_RT6:
    s_sub_u32 s60, s60, 1
    s_cbranch_scc1 K2_END
    buffer_load_dwordx4 v[24:27], v181, s[8:11], 0 offen offset:192 sc1
    s_waitcnt vmcnt(0)
    s_branch K2_CK6
K2_RT7:
    s_sub_u32 s60, s60, 1
    s_cbranch_scc1 K2_END
    buffer_load_dwordx4 v[28:31], v181, s[8:11], 0 offen offset:224 sc1
    s_waitcnt vmcnt(0)
    s_branch K2_CK7
K2_RT8:
    s_sub_u32 s60, s60, 1
    s_cbranch_scc1 K2_END
    buffer_load_dwordx4 v[32:35], v181, s[8:11], 0 offen offset:256 sc1
    s_waitcnt vmcnt(0)
    s_branch K2_CK8
K2_RT9:
    s_sub_u32 s60, s60, 1
    s_cbranch_scc1 K2_END
    buffer_load_dwordx4 v[36:39], v181, s[8:11], 0 offen offset:288 sc1
    s_waitcnt vmcnt(0)
    s_branch K2_CK9
K2_RK_LOAD:
    s_waitcnt vmcnt(0)
    s_mov_b64 exec, s[40:41]
    s_cbranch_execz K2_RK_B
    v_lshrrev_b32 v50, 24, v3
    buffer_load_dword v40, v179, s[8:11], s66 offen offset:0
    v_mad_u32_u24 v50, v50, s58, v202
    v_and_b32 v3, 0xffffff, v3
    s_mov_b64 exec, s[42:43]
    s_cbranch_execz K2_RK_B
    v_lshrrev_b32 v51, 24, v7
    buffer_load_dword v41, v179, s[8:11], s66 offen offset:8
    v_mad_u32_u24 v51, v51, s58, v202
    v_and_b32 v7, 0xffffff, v7
    s_mov_b64 exec, s[44:45]
    s_cbranch_execz K2_RK_B
    v_lshrrev_b32 v52, 24, v11
    buffer_load_dword v42, v179, s[8:11], s66 offen offset:16
    v_mad_u32_u24 v52, v52, s58, v202
    v_and_b32 v11, 0xffffff, v11
    s_mov_b64 exec, s[46:47]
    s_cbranch_execz K2_RK_B
    v_lshrrev_b32 v53, 24, v15
    buffer_load_dword v43, v179, s[8:11], s66 offen offset:24
    v_mad_u32_u24 v53, v53, s58, v202
    v_and_b32 v15, 0xffffff, v15
    s_mov_b64 exec, s[48:49]
    s_cbranch_execz K2_RK_B
    v_lshrrev_b32 v54, 24, v19
    buffer_load_dword v44, v179, s[8:11], s66 offen offset:32
    v_mad_u32_u24 v54, v54, s58, v202
    v_and_b32 v19, 0xffffff, v19
    s_mov_b64 exec, s[50:51]
    s_cbranch_execz K2_RK_B
    v_lshrrev_b32 v55, 24, v23
    buffer_load_dword v45, v179, s[8:11], s66 offen offset:40
    v_mad_u32_u24 v55, v55, s58, v202
    v_and_b32 v23, 0xffffff, v23
    s_mov_b64 exec, s[90:91]
    s_cbranch_execz K2_RK_B
    v_lshrrev_b32 v56, 24, v27
    buffer_load_dword v46, v179, s[8:11], s66 offen offset:48
    v_mad_u32_u24 v56, v56, s58, v202
    v_and_b32 v27, 0xffffff, v27
    s_mov_b64 exec, s[92:93]
    s_cbranch_execz K2_RK_B
    v_lshrrev_b32 v57, 24, v31
    buffer_load_dword v47, v179, s[8:11], s66 offen offset:56
    v_mad_u32_u24 v57, v57, s58, v202
    v_and_b32 v31, 0xffffff, v31
    s_mov_b64 exec, s[94:95]
    s_cbranch_execz K2_RK_B
    v_lshrrev_b32 v58, 24, v35
    buffer_load_dword v48, v179, s[8:11], s66 offen offset:64
    v_mad_u32_u24 v58, v58, s58, v202
    v_and_b32 v35, 0xffffff, v35
    s_mov_b64 exec, s[96:97]
    s_cbranch_execz K2_RK_B
    v_lshrrev_b32 v59, 24, v39
    buffer_load_dword v49, v179, s[8:11], s66 offen offset:72
    v_mad_u32_u24 v59, v59, s58, v202
    v_and_b32 v39, 0xffffff, v39
K2_RK_B:
    s_mov_b64 exec, -1
    s_mul_i32 s62, s24, 48
    s_waitcnt vmcnt(0)
    v_subrev_u32 v40, s62, v40
    v_subrev_u32 v41, s62, v41
    v_subrev_u32 v42, s62, v42
    v_subrev_u32 v43, s62, v43
    v_subrev_u32 v44, s62, v44
    v_subrev_u32 v45, s62, v45
    v_subrev_u32 v46, s62, v46
    v_subrev_u32 v47, s62, v47
    v_subrev_u32 v48, s62, v48
    v_subrev_u32 v49, s62, v49
    s_branch K2_RK_DONE
K2_PAD_OV:
    s_branch K2_HOP
K2_OV:
    s_cmp_lg_u32 s24, 0
    s_cbranch_scc1 K2_OB
    s_cmp_eq_u32 s22, 39
    s_cselect_b32 s63, 5, 2
    s_flbit_i32_b32 s56, s58
    s_sub_u32 s56, 31, s56
    s_bitset0_b32 s58, s56
    s_sub_u32 s57, s56, 1
    v_mov_b32 v198, 0
    v_mov_b32 v206, s57
K2_OVL:
    s_mov_b64 exec, -1
    s_ff1_i32_b32 s61, s58
    s_bitset0_b32 s58, s61
    v_readfirstlane_b32 s62, v206
    s_nop 0
    s_sub_u32 s62, s62, s61
    s_lshl_b32 s61, s62, 1
    v_cmp_lt_i32 vcc, s61, v180
    s_lshl_b32 s61, s62, 2
    s_set_gpr_idx_on s62, gpr_idx(SRC0)
    s_nop 0
    v_mov_b32 v204, v40
    v_mov_b32 v205, v50
    s_set_gpr_idx_idx s61
    s_nop 0
    v_mov_b32 v208, v0
    v_mov_b32 v209, v1
    v_mov_b32 v210, v2
    v_mov_b32 v211, v3
    s_set_gpr_idx_off
    s_mov_b64 exec, vcc
    v_subrev_u32 v192, 48, v204
    v_mov_b32 v197, 163656
    v_cmp_gt_u32 vcc, 16, v192
    s_mov_b32 s62, 0
    s_mov_b64 exec, vcc
    s_cbranch_execz K2_OVN
K2_OP:
    ds_cmpst_rtn_b32 v200, v197, v198, v205
    s_cmp_ge_u32 s62, 2
    s_cselect_b32 s65, 2400, 0
    s_cselect_b32 s26, 32, 0
    s_sub_u32 s65, 161536, s65
    s_lshl_b32 s61, s62, 4
    s_sub_u32 s61, s61, s26
    v_mov_b32 v199, s65
    v_add_u32 v203, s61, v192
    s_waitcnt lgkmcnt(0)
    v_cmp_eq_u32 vcc, 0, v200
    v_cmp_eq_u32 s[56:57], v200, v205
    s_nop 0
    s_or_b64 vcc, vcc, s[56:57]
    s_andn2_b64 s[56:57], exec, vcc
    s_mov_b64 exec, vcc
    v_lshl_add_u32 v194, v203, 5, v199
    v_lshl_add_u32 v195, v203, 2, v199
    v_lshrrev_b32 v193, 3, v203
    v_mad_i32_i24 v196, v193, -16, v195
    v_and_b32 v193, 1, v193
    v_mad_i32_i24 v196, v193, -14, v196
    ds_write_b32 v194, v211 offset:864
    ds_write_b16 v195, v208 offset:194
    ds_write_b16_d16_hi v195, v208 offset:386
    ds_write_b16_d16_hi v195, v209 offset:578
    ds_write_b16 v196, v210 offset:768
    s_mov_b64 exec, s[56:57]
    s_cbranch_execz K2_OVN
    v_add_u32 v197, 4, v197
    s_add_u32 s62, s62, 1
    s_cmp_lt_u32 s62, s63
    s_cbranch_scc1 K2_OP
K2_OVN:
    s_cmp_lg_u32 s58, 0
    s_cbranch_scc1 K2_OVL
    s_mov_b64 exec, -1
    s_branch K2_OB
K2_BIG:
    s_cmp_lg_u32 s24, 0
    s_cbranch_scc1 K2_TOK
    s_mov_b64 s[62:63], vcc
    s_bcnt1_i32_b64 s60, vcc
    s_cmp_eq_u32 s22, 39
    s_cselect_b32 s61, 5, 2
    s_cmp_gt_u32 s60, s61
    s_cbranch_scc1 K2_SLOW
    v_cmp_lt_u32 vcc, 64, v193
    s_nop 0
    s_cbranch_vccnz K2_SLOW
    v_mov_b32 v197, 163656
    ds_read_b32 v203, v197
    ds_read_b32 v204, v197 offset:4
    ds_read_b32 v205, v197 offset:8
    ds_read_b32 v206, v197 offset:12
    ds_read_b32 v207, v197 offset:16
    v_and_b32 v197, 0x3ffff, v195
    s_movk_i32 s26, 64
    s_waitcnt lgkmcnt(0)
    v_cmp_eq_u32 vcc, v204, v197
    v_mov_b32 v194, 134217728
    s_nop 0
    v_cndmask_b32 v198, v198, v194, vcc
    v_cmp_eq_u32 vcc, v205, v197
    v_mov_b32 v194, 268435456
    s_nop 0
    v_cndmask_b32 v198, v198, v194, vcc
    v_cmp_eq_u32 vcc, v206, v197
    v_mov_b32 v194, 402653184
    s_nop 0
    v_cndmask_b32 v198, v198, v194, vcc
    v_cmp_eq_u32 vcc, v207, v197
    v_mov_b32 v194, 536870912
    s_nop 0
    v_cndmask_b32 v198, v198, v194, vcc
    s_branch K2_TOK
K2_SLOW:
    v_mov_b32 v197, v193
    s_nop 1
    v_max_u32_dpp v197, v197, v197 row_shr:1 row_mask:0xf bank_mask:0xf bound_ctrl:0
    s_nop 1
    v_max_u32_dpp v197, v197, v197 row_shr:2 row_mask:0xf bank_mask:0xf bound_ctrl:0
    s_nop 1
    v_max_u32_dpp v197, v197, v197 row_shr:4 row_mask:0xf bank_mask:0xf bound_ctrl:0
    s_nop 1
    v_max_u32_dpp v197, v197, v197 row_shr:8 row_mask:0xf bank_mask:0xf bound_ctrl:0
    s_nop 1
    v_max_u32_dpp v197, v197, v197 row_bcast:15 row_mask:0xa bank_mask:0xf
    s_nop 1
    v_max_u32_dpp v197, v197, v197 row_bcast:31 row_mask:0xc bank_mask:0xf
    s_nop 0
    v_readlane_b32 s25, v197, 63
    s_nop 0
    s_add_u32 s25, s25, 47
    s_mul_i32 s25, s25, 43691
    s_lshr_b32 s25, s25, 21
    v_cmp_lt_i32 vcc, 0, v180
    s_nop 0
    s_cbranch_vccz K2_SV_DONE
    s_mov_b64 exec, vcc
    buffer_store_dword v40, v179, s[8:11], s66 offen offset:0
    v_cmp_lt_i32 vcc, 2, v180
    s_nop 0
    s_cbranch_vccz K2_SV_DONE
    s_mov_b64 exec, vcc
    buffer_store_dword v41, v179, s[8:11], s66 offen offset:8
    v_cmp_lt_i32 vcc, 4, v180
    s_nop 0
    s_cbranch_vccz K2_SV_DONE
    s_mov_b64 exec, vcc
    buffer_store_dword v42, v179, s[8:11], s66 offen offset:16
    v_cmp_lt_i32 vcc, 6, v180
    s_nop 0
    s_cbranch_vccz K2_SV_DONE
    s_mov_b64 exec, vcc
    buffer_store_dword v43, v179, s[8:11], s66 offen offset:24
    v_cmp_lt_i32 vcc, 8, v180
    s_nop 0
    s_cbranch_vccz K2_SV_DONE
    s_mov_b64 exec, vcc
    buffer_store_dword v44, v179, s[8:11], s66 offen offset:32
    v_cmp_lt_i32 vcc, 10, v180
    s_nop 0
    s_cbranch_vccz K2_SV_DONE
    s_mov_b64 exec, vcc
    buffer_store_dword v45, v179, s[8:11], s66 offen offset:40
    v_cmp_lt_i32 vcc, 12, v180
    s_nop 0
    s_cbranch_vccz K2_SV_DONE
    s_mov_b64 exec, vcc
    buffer_store_dword v46, v179, s[8:11], s66 offen offset:48
    v_cmp_lt_i32 vcc, 14, v180
    s_nop 0
    s_cbranch_vccz K2_SV_DONE
    s_mov_b64 exec, vcc
    buffer_store_dword v47, v179, s[8:11], s66 offen offset:56
    v_cmp_lt_i32 vcc, 16, v180
    s_nop 0
    s_cbranch_vccz K2_SV_DONE
    s_mov_b64 exec, vcc
    buffer_store_dword v48, v179, s[8:11], s66 offen offset:64
    v_cmp_lt_i32 vcc, 18, v180
    s_nop 0
    s_cbranch_vccz K2_SV_DONE
    s_mov_b64 exec, vcc
    buffer_store_dword v49, v179, s[8:11], s66 offen offset:72
K2_SV_DONE:
    s_mov_b64 exec, -1
    s_branch K2_TOK
K2_rare_1:
    s_cmp_eq_u32 s33, 4
    s_cbranch_scc1 K2_four_3
    s_mov_b32 s49, s48
    s_mov_b32 s51, s48
    s_add_u32 s45, s44, 256
    s_add_u32 s46, s44, 512
    s_add_u32 s47, s44, 768
    s_branch K2_back_2
K2_four_3:
    s_add_u32 s50, s48, 64
    s_lshr_b32 s51, s3, 27
    s_mov_b32 s66, 161536
    s_cmp_ge_u32 s51, 2
    s_cselect_b32 s66, 159072, s66
    s_mul_i32 s51, s51, 32
    s_add_u32 s51, s51, s66
    s_mov_b32 s46, s44
    s_mov_b32 s47, s44
    s_branch K2_back_2
K2_a4_5:
    s_lshr_b32 s65, s3, 27
    s_mov_b32 s66, 161536
    s_cmp_ge_u32 s65, 2
    s_cselect_b32 s66, 158112, s66
    s_mul_i32 s65, s65, 512
    s_add_u32 s65, s65, s66
    v_add_u32 v232, s65, v230
    ds_read_b32 v232, v232
    s_add_u32 m0, s65, 864
    s_waitcnt lgkmcnt(0)
    v_or_b32 v232, v232, v231
    buffer_load_dwordx4 v232, s[16:19], 0 offen  lds
    s_branch K2_b4_7
K2_rare_14:
    s_cmp_eq_u32 s33, 4
    s_cbranch_scc1 K2_four_16
    s_mov_b32 s49, s48
    s_mov_b32 s51, s48
    s_add_u32 s45, s44, 256
    s_add_u32 s46, s44, 512
    s_add_u32 s47, s44, 768
    s_branch K2_back_15
K2_four_16:
    s_add_u32 s50, s48, 64
    s_lshr_b32 s51, s3, 27
    s_mov_b32 s66, 161536
    s_cmp_ge_u32 s51, 2
    s_cselect_b32 s66, 159072, s66
    s_mul_i32 s51, s51, 32
    s_add_u32 s51, s51, s66
    s_mov_b32 s46, s44
    s_mov_b32 s47, s44
    s_branch K2_back_15
K2_a4_18:
    s_lshr_b32 s65, s3, 27
    s_mov_b32 s66, 161536
    s_cmp_ge_u32 s65, 2
    s_cselect_b32 s66, 158112, s66
    s_mul_i32 s65, s65, 512
    s_add_u32 s65, s65, s66
    v_add_u32 v232, s65, v230
    ds_read_b32 v232, v232
    s_add_u32 m0, s65, 864
    s_waitcnt lgkmcnt(0)
    v_or_b32 v232, v232, v231
    buffer_load_dwordx4 v232, s[16:19], 0 offen  lds
    s_branch K2_b4_20
K2_rare_27:
    s_cmp_eq_u32 s33, 4
    s_cbranch_scc1 K2_four_29
    s_mov_b32 s49, s48
    s_mov_b32 s51, s48
    s_add_u32 s45, s44, 256
    s_add_u32 s46, s44, 512
    s_add_u32 s47, s44, 768
    s_branch K2_back_28
K2_four_29:
    s_add_u32 s50, s48, 64
    s_lshr_b32 s51, s3, 27
    s_mov_b32 s66, 161536
    s_cmp_ge_u32 s51, 2
    s_cselect_b32 s66, 159072, s66
    s_mul_i32 s51, s51, 32
    s_add_u32 s51, s51, s66
    s_mov_b32 s46, s44
    s_mov_b32 s47, s44
    s_branch K2_back_28
K2_a4_31:
    s_lshr_b32 s65, s3, 27
    s_mov_b32 s66, 161536
    s_cmp_ge_u32 s65, 2
    s_cselect_b32 s66, 158112, s66
    s_mul_i32 s65, s65, 512
    s_add_u32 s65, s65, s66
    v_add_u32 v232, s65, v230
    ds_read_b32 v232, v232
    s_add_u32 m0, s65, 864
    s_waitcnt lgkmcnt(0)
    v_or_b32 v232, v232, v231
    buffer_load_dwordx4 v232, s[16:19], 0 offen  lds
    s_branch K2_b4_33
K2_rare_38:
    s_cmp_eq_u32 s33, 4
    s_cbranch_scc1 K2_four_40
    s_mov_b32 s49, s48
    s_mov_b32 s51, s48
    s_add_u32 s45, s44, 256
    s_add_u32 s46, s44, 512
    s_add_u32 s47, s44, 768
    s_branch K2_back_39
K2_four_40:
    s_add_u32 s50, s48, 64
    s_lshr_b32 s51, s3, 27
    s_mov_b32 s66, 161536
    s_cmp_ge_u32 s51, 2
    s_cselect_b32 s66, 159072, s66
    s_mul_i32 s51, s51, 32
    s_add_u32 s51, s51, s66
    s_mov_b32 s46, s44
    s_mov_b32 s47, s44
    s_branch K2_back_39
K2_rare_45:
    s_cmp_eq_u32 s33, 4
    s_cbranch_scc1 K2_four_47
    s_mov_b32 s49, s48
    s_mov_b32 s51, s48
    s_add_u32 s45, s44, 256
    s_add_u32 s46, s44, 512
    s_add_u32 s47, s44, 768
    s_branch K2_back_46
K2_four_47:
    s_add_u32 s50, s48, 64
    s_lshr_b32 s51, s3, 27
    s_mov_b32 s66, 161536
    s_cmp_ge_u32 s51, 2
    s_cselect_b32 s66, 159072, s66
    s_mul_i32 s51, s51, 32
    s_add_u32 s51, s51, s66
    s_mov_b32 s46, s44
    s_mov_b32 s47, s44
    s_branch K2_back_46
K2_U10:
    s_setprio 1
    s_add_u32 s38, s38, 1
    v_mov_b32 v254, s52
    v_mov_b32 v255, s38
    s_lshl_b32 s58, s38, 3
    s_add_u32 s58, s58, s20
    s_mov_b64 exec, 1
    ds_write_b32 v254, v255
    s_mov_b64 exec, -1
    s_cmp_lt_u32 s58, s22
    s_cbranch_scc0 K2_dyn_48
K2_back_49:
    s_waitcnt lgkmcnt(7)
    v_lshlrev_b32 v40, 16, v0
    v_and_b32 v41, 0xffff0000, v0
    v_lshlrev_b32 v42, 16, v1
    v_and_b32 v43, 0xffff0000, v1
    v_lshlrev_b32 v44, 16, v2
    v_and_b32 v45, 0xffff0000, v2
    v_lshlrev_b32 v46, 16, v3
    v_and_b32 v47, 0xffff0000, v3
    v_mul_f32 v4, v40, v4
    v_mul_f32 v5, v41, v5
    v_mul_f32 v6, v42, v6
    v_mul_f32 v7, v43, v7
    v_mul_f32 v8, v44, v8
    v_mul_f32 v9, v45, v9
    v_mul_f32 v10, v46, v10
    v_mul_f32 v11, v47, v11
    v_cvt_pk_bf16_f32 v64, v4, v5
    v_cvt_pk_bf16_f32 v65, v6, v7
    v_cvt_pk_bf16_f32 v66, v8, v9
    v_cvt_pk_bf16_f32 v67, v10, v11
    v_mul_f32 v12, v40, v12
    v_mul_f32 v13, v41, v13
    v_mul_f32 v14, v42, v14
    v_mul_f32 v15, v43, v15
    v_mul_f32 v16, v44, v16
    v_mul_f32 v17, v45, v17
    v_mul_f32 v18, v46, v18
    v_mul_f32 v19, v47, v19
    v_cvt_pk_bf16_f32 v68, v12, v13
    v_cvt_pk_bf16_f32 v69, v14, v15
    v_cvt_pk_bf16_f32 v70, v16, v17
    v_cvt_pk_bf16_f32 v71, v18, v19
    v_readlane_b32 s3, v253, s58
    s_lshl_b32 s44, s34, 7
    s_lshl_b32 s60, s58, 5
    s_and_b32 s48, s3, 0x3ffff
    s_bfe_u32 s33, s3, 0x30012
    s_sub_u32 s60, s60, s48
    s_and_b32 s60, s60, 0xff
    s_add_u32 s60, s60, s48
    s_mul_i32 s35, s38, 6
    s_cmp_eq_u32 s34, 0
    s_cselect_b32 s35, s35, s60
    s_mov_b32 s45, s44
    s_add_u32 s47, s44, 256
    s_add_u32 s49, s48, 32
    s_add_u32 s60, s48, 64
    s_cmp_eq_u32 s33, 3
    s_cselect_b32 s46, s44, s47
    s_cselect_b32 s50, s60, s48
    s_cselect_b32 s51, s48, s49
    s_sub_u32 s60, s33, 2
    s_cmp_lt_u32 s60, 2
    s_cbranch_scc0 K2_rare_54
K2_back_55:
    v_add_u32 v233, s48, v230
    ds_read_b32 v232, v233
    ds_read_b32 v233, v233 offset:1024
    v_add_u32 v222, s48, v251
    ds_read_b32 v222, v222
    v_add_u32 v224, s49, v251
    ds_read_b32 v224, v224
    v_add_u32 v226, s50, v251
    ds_read_b32 v226, v226
    v_add_u32 v228, s51, v251
    ds_read_b32 v228, v228
    s_waitcnt lgkmcnt(4)
    v_or_b32 v232, v232, v231
    v_or_b32 v233, v233, v231
    s_cmp_lg_u32 s34, 0
    s_cbranch_scc1 K2_dum_57
    s_add_u32 m0, s48, 864
    s_add_u32 s65, s48, 1888
    buffer_load_dwordx4 v232, s[16:19], 0 offen  lds
    s_mov_b32 m0, s65
    s_mov_b32 exec_hi, 0
    buffer_load_dwordx4 v233, s[16:19], 0 offen  lds
    s_cmp_eq_u32 s33, 4
    s_cbranch_scc1 K2_a4_58
K2_b4_60:
    s_mov_b32 exec_hi, -1
K2_back_59:
    s_waitcnt lgkmcnt(3)
    v_mad_u32_u16 v223, v222, s39, v248 op_sel:[1,0,0,0]
    v_mad_u32_u16 v222, v222, s39, v248
    s_waitcnt lgkmcnt(2)
    v_mad_u32_u16 v225, v224, s39, v248 op_sel:[1,0,0,0]
    v_mad_u32_u16 v224, v224, s39, v248
    s_waitcnt lgkmcnt(1)
    v_mad_u32_u16 v227, v226, s39, v248 op_sel:[1,0,0,0]
    v_mad_u32_u16 v226, v226, s39, v248
    s_waitcnt lgkmcnt(0)
    v_mad_u32_u16 v229, v228, s39, v248 op_sel:[1,0,0,0]
    v_mad_u32_u16 v228, v228, s39, v248
    s_waitcnt vmcnt(6)
    v_mfma_f32_32x32x16_bf16 v[0:15], v[64:67], v[176:179], 0
    ds_read_b64_tr_b16 v[184:185], v246 offset:2048
    ds_read_b64_tr_b16 v[186:187], v246 offset:2560
    ds_read_b64_tr_b16 v[188:189], v247 offset:2048
    ds_read_b64_tr_b16 v[190:191], v247 offset:2560
    s_mov_b32 m0, s68
    v_mfma_f32_32x32x16_bf16 v[16:31], v[68:71], v[176:179], 0
    buffer_load_dwordx4 v222, s[4:7], s44 offen sc1 lds
    buffer_load_dwordx4 v223, s[72:75], s44 offen offset:1024 sc1 lds
    v_permlane32_swap_b32 v242, v236
    v_permlane32_swap_b32 v243, v237
    v_mfma_f32_32x32x16_bf16 v[32:47], v[64:67], v[180:183], 0
    v_permlane32_swap_b32 v244, v238
    v_permlane32_swap_b32 v245, v239
    v_permlane32_swap_b32 v240, v241
    v_add_f32 v242, v242, v236
    v_mfma_f32_32x32x16_bf16 v[48:63], v[68:71], v[180:183], 0
    s_setprio 0
    v_add_f32 v243, v243, v237
    v_add_f32 v244, v244, v238
    v_add_f32 v245, v245, v239
    v_add_f32 v240, -v240, -v241
    s_set_gpr_idx_on s32, gpr_idx(DST)
    s_nop 0
    v_cvt_pk_bf16_f32 v195, v242, v243
    v_cvt_pk_bf16_f32 v196, v244, v245
    v_cvt_pk_bf16_f32 v197, v240, v240
    s_set_gpr_idx_off
    v_mul_f32 v234, v0, v96
    v_mul_f32 v236, v8, v128
    v_fmac_f32 v234, v1, v97
    v_fmac_f32 v236, v9, v129
    v_fmac_f32 v234, v2, v98
    v_fmac_f32 v236, v10, v130
    v_fmac_f32 v234, v3, v99
    v_fmac_f32 v236, v11, v131
    v_fmac_f32 v234, v4, v100
    v_fmac_f32 v236, v12, v132
    v_fmac_f32 v234, v5, v101
    v_fmac_f32 v236, v13, v133
    v_fmac_f32 v234, v6, v102
    v_fmac_f32 v236, v14, v134
    v_fmac_f32 v234, v7, v103
    v_fmac_f32 v236, v15, v135
    v_mul_f32 v238, v16, v128
    v_mul_f32 v240, v24, v128
    v_fmac_f32 v238, v17, v129
    v_fmac_f32 v240, v25, v129
    v_fmac_f32 v238, v18, v130
    v_fmac_f32 v240, v26, v130
    v_fmac_f32 v238, v19, v131
    v_fmac_f32 v240, v27, v131
    v_fmac_f32 v238, v20, v132
    v_fmac_f32 v240, v28, v132
    v_fmac_f32 v238, v21, v133
    v_fmac_f32 v240, v29, v133
    v_fmac_f32 v238, v22, v134
    v_fmac_f32 v240, v30, v134
    v_fmac_f32 v238, v23, v135
    v_fmac_f32 v240, v31, v135
    v_mul_f32 v235, v32, v104
    v_mul_f32 v237, v40, v136
    v_fmac_f32 v235, v33, v105
    v_fmac_f32 v237, v41, v137
    v_fmac_f32 v235, v34, v106
    v_fmac_f32 v237, v42, v138
    v_fmac_f32 v235, v35, v107
    v_fmac_f32 v237, v43, v139
    v_fmac_f32 v235, v36, v108
    v_fmac_f32 v237, v44, v140
    v_fmac_f32 v235, v37, v109
    v_fmac_f32 v237, v45, v141
    v_fmac_f32 v235, v38, v110
    v_fmac_f32 v237, v46, v142
    v_fmac_f32 v235, v39, v111
    v_fmac_f32 v237, v47, v143
    v_mul_f32 v239, v48, v136
    v_mul_f32 v241, v56, v136
    v_fmac_f32 v239, v49, v137
    v_fmac_f32 v241, v57, v137
    v_fmac_f32 v239, v50, v138
    v_fmac_f32 v241, v58, v138
    v_fmac_f32 v239, v51, v139
    v_fmac_f32 v241, v59, v139
    v_fmac_f32 v239, v52, v140
    v_fmac_f32 v241, v60, v140
    v_fmac_f32 v239, v53, v141
    v_fmac_f32 v241, v61, v141
    v_fmac_f32 v239, v54, v142
    v_fmac_f32 v241, v62, v142
    v_fmac_f32 v239, v55, v143
    v_fmac_f32 v241, v63, v143
    s_setprio 1
    s_waitcnt vmcnt(6) lgkmcnt(0)
    v_mfma_f32_32x32x16_bf16 v[0:15], v[64:67], v[184:187], 0
    ds_read_b64_tr_b16 v[176:177], v246 offset:4096
    ds_read_b64_tr_b16 v[178:179], v246 offset:4608
    ds_read_b64_tr_b16 v[180:181], v247 offset:4096
    ds_read_b64_tr_b16 v[182:183], v247 offset:4608
    s_mov_b32 m0, s69
    v_mfma_f32_32x32x16_bf16 v[16:31], v[68:71], v[184:187], 0
    buffer_load_dwordx4 v224, s[4:7], s45 offen sc1 lds
    buffer_load_dwordx4 v225, s[72:75], s45 offen offset:1024 sc1 lds
    v_permlane32_swap_b32 v234, v236
    v_permlane32_swap_b32 v235, v237
    v_mfma_f32_32x32x16_bf16 v[32:47], v[64:67], v[188:191], 0
    v_permlane32_swap_b32 v240, v238
    v_permlane32_swap_b32 v241, v239
    v_add_f32 v234, v234, v236
    v_add_f32 v235, v235, v237
    v_add_f32 v240, v240, v238
    v_mfma_f32_32x32x16_bf16 v[48:63], v[68:71], v[188:191], 0
    s_setprio 0
    v_add_f32 v241, v241, v239
    s_set_gpr_idx_on s31, gpr_idx(DST)
    s_nop 0
    v_cvt_pk_bf16_f32 v192, v234, v235
    v_cvt_pk_bf16_f32 v193, v240, v241
    s_set_gpr_idx_off
    v_mul_f32 v234, v0, v144
    v_mul_f32 v236, v8, v112
    v_fmac_f32 v234, v1, v145
    v_fmac_f32 v236, v9, v113
    v_fmac_f32 v234, v2, v146
    v_fmac_f32 v236, v10, v114
    v_fmac_f32 v234, v3, v147
    v_fmac_f32 v236, v11, v115
    v_fmac_f32 v234, v4, v148
    v_fmac_f32 v236, v12, v116
    v_fmac_f32 v234, v5, v149
    v_fmac_f32 v236, v13, v117
    v_fmac_f32 v234, v6, v150
    v_fmac_f32 v236, v14, v118
    v_fmac_f32 v234, v7, v151
    v_fmac_f32 v236, v15, v119
    v_mul_f32 v238, v16, v160
    v_mul_f32 v240, v24, v160
    v_fmac_f32 v238, v17, v161
    v_fmac_f32 v240, v25, v161
    v_fmac_f32 v238, v18, v162
    v_fmac_f32 v240, v26, v162
    v_fmac_f32 v238, v19, v163
    v_fmac_f32 v240, v27, v163
    v_fmac_f32 v238, v20, v164
    v_fmac_f32 v240, v28, v164
    v_fmac_f32 v238, v21, v165
    v_fmac_f32 v240, v29, v165
    v_fmac_f32 v238, v22, v166
    v_fmac_f32 v240, v30, v166
    v_fmac_f32 v238, v23, v167
    v_fmac_f32 v240, v31, v167
    v_mul_f32 v235, v32, v152
    v_mul_f32 v237, v40, v120
    v_fmac_f32 v235, v33, v153
    v_fmac_f32 v237, v41, v121
    v_fmac_f32 v235, v34, v154
    v_fmac_f32 v237, v42, v122
    v_fmac_f32 v235, v35, v155
    v_fmac_f32 v237, v43, v123
    v_fmac_f32 v235, v36, v156
    v_fmac_f32 v237, v44, v124
    v_fmac_f32 v235, v37, v157
    v_fmac_f32 v237, v45, v125
    v_fmac_f32 v235, v38, v158
    v_fmac_f32 v237, v46, v126
    v_fmac_f32 v235, v39, v159
    v_fmac_f32 v237, v47, v127
    v_mul_f32 v239, v48, v168
    v_mul_f32 v241, v56, v168
    v_fmac_f32 v239, v49, v169
    v_fmac_f32 v241, v57, v169
    v_fmac_f32 v239, v50, v170
    v_fmac_f32 v241, v58, v170
    v_fmac_f32 v239, v51, v171
    v_fmac_f32 v241, v59, v171
    v_fmac_f32 v239, v52, v172
    v_fmac_f32 v241, v60, v172
    v_fmac_f32 v239, v53, v173
    v_fmac_f32 v241, v61, v173
    v_fmac_f32 v239, v54, v174
    v_fmac_f32 v241, v62, v174
    v_fmac_f32 v239, v55, v175
    v_fmac_f32 v241, v63, v175
    s_setprio 1
    s_waitcnt vmcnt(6) lgkmcnt(0)
    v_mfma_f32_32x32x16_bf16 v[0:15], v[64:67], v[176:179], 0
    ds_read_b64_tr_b16 v[184:185], v246 offset:6144
    ds_read_b64_tr_b16 v[186:187], v246 offset:6656
    ds_read_b64_tr_b16 v[188:189], v247 offset:6144
    ds_read_b64_tr_b16 v[190:191], v247 offset:6656
    s_mov_b32 m0, s70
    v_mfma_f32_32x32x16_bf16 v[16:31], v[68:71], v[176:179], 0
    buffer_load_dwordx4 v226, s[4:7], s46 offen sc1 lds
    buffer_load_dwordx4 v227, s[72:75], s46 offen offset:1024 sc1 lds
    s_sub_u32 s26, s48, s29
    s_mov_b32 s29, s48
    s_mov_b32 s30, s3
    s_cmp_eq_u32 s34, 0
    s_cselect_b32 s56, s33, 0
    v_mfma_f32_32x32x16_bf16 v[32:47], v[64:67], v[180:183], 0
    v_mfma_f32_32x32x16_bf16 v[48:63], v[68:71], v[180:183], 0
    s_setprio 0
    v_mul_f32 v242, v0, v144
    v_fma_f32 v238, v8, v160, -v238
    v_fmac_f32 v242, v1, v145
    v_fmac_f32 v238, v9, v161
    v_fmac_f32 v242, v2, v146
    v_fmac_f32 v238, v10, v162
    v_fmac_f32 v242, v3, v147
    v_fmac_f32 v238, v11, v163
    v_fmac_f32 v242, v4, v148
    v_fmac_f32 v238, v12, v164
    v_fmac_f32 v242, v5, v149
    v_fmac_f32 v238, v13, v165
    v_fmac_f32 v242, v6, v150
    v_fmac_f32 v238, v14, v166
    v_fmac_f32 v242, v7, v151
    v_fmac_f32 v238, v15, v167
    v_fmac_f32 v236, v16, v112
    v_mul_f32 v244, v24, v160
    v_fmac_f32 v236, v17, v113
    v_fmac_f32 v244, v25, v161
    v_fmac_f32 v236, v18, v114
    v_fmac_f32 v244, v26, v162
    v_fmac_f32 v236, v19, v115
    v_fmac_f32 v244, v27, v163
    v_fmac_f32 v236, v20, v116
    v_fmac_f32 v244, v28, v164
    v_fmac_f32 v236, v21, v117
    v_fmac_f32 v244, v29, v165
    v_fmac_f32 v236, v22, v118
    v_fmac_f32 v244, v30, v166
    v_fmac_f32 v236, v23, v119
    v_fmac_f32 v244, v31, v167
    v_mul_f32 v243, v32, v152
    v_fma_f32 v239, v40, v168, -v239
    v_fmac_f32 v243, v33, v153
    v_fmac_f32 v239, v41, v169
    v_fmac_f32 v243, v34, v154
    v_fmac_f32 v239, v42, v170
    v_fmac_f32 v243, v35, v155
    v_fmac_f32 v239, v43, v171
    v_fmac_f32 v243, v36, v156
    v_fmac_f32 v239, v44, v172
    v_fmac_f32 v243, v37, v157
    v_fmac_f32 v239, v45, v173
    v_fmac_f32 v243, v38, v158
    v_fmac_f32 v239, v46, v174
    v_fmac_f32 v243, v39, v159
    v_fmac_f32 v239, v47, v175
    v_fmac_f32 v237, v48, v120
    v_mul_f32 v245, v56, v168
    v_fmac_f32 v237, v49, v121
    v_fmac_f32 v245, v57, v169
    v_fmac_f32 v237, v50, v122
    v_fmac_f32 v245, v58, v170
    v_fmac_f32 v237, v51, v123
    v_fmac_f32 v245, v59, v171
    v_fmac_f32 v237, v52, v124
    v_fmac_f32 v245, v60, v172
    v_fmac_f32 v237, v53, v125
    v_fmac_f32 v245, v61, v173
    v_fmac_f32 v237, v54, v126
    v_fmac_f32 v245, v62, v174
    v_fmac_f32 v237, v55, v127
    v_fmac_f32 v245, v63, v175
    s_setprio 1
    s_waitcnt vmcnt(4) lgkmcnt(0)
    v_mfma_f32_32x32x16_bf16 v[0:15], v[64:67], v[184:187], 0
    ds_read_b64_tr_b16 v[176:177], v246 offset:0
    ds_read_b64_tr_b16 v[178:179], v246 offset:512
    ds_read_b64_tr_b16 v[180:181], v247 offset:0
    ds_read_b64_tr_b16 v[182:183], v247 offset:512
    s_mov_b32 m0, s71
    v_mfma_f32_32x32x16_bf16 v[16:31], v[68:71], v[184:187], 0
    buffer_load_dwordx4 v228, s[4:7], s47 offen sc1 lds
    buffer_load_dwordx4 v229, s[72:75], s47 offen offset:1024 sc1 lds
    v_permlane32_swap_b32 v242, v234
    v_permlane32_swap_b32 v243, v235
    v_add_f32 v242, v242, v234
    v_mfma_f32_32x32x16_bf16 v[32:47], v[64:67], v[188:191], 0
    v_add_f32 v243, v243, v235
    s_set_gpr_idx_on s31, gpr_idx(DST)
    s_nop 0
    v_cvt_pk_bf16_f32 v194, v242, v243
    s_set_gpr_idx_off
    s_mov_b32 s32, s31
    s_mov_b32 s31, s35
    v_mfma_f32_32x32x16_bf16 v[48:63], v[68:71], v[188:191], 0
    s_setprio 0
    v_mul_f32 v242, v0, v144
    v_fma_f32 v240, v8, v160, -v240
    v_fmac_f32 v242, v1, v145
    v_fmac_f32 v240, v9, v161
    v_fmac_f32 v242, v2, v146
    v_fmac_f32 v240, v10, v162
    v_fmac_f32 v242, v3, v147
    v_fmac_f32 v240, v11, v163
    v_fmac_f32 v242, v4, v148
    v_fmac_f32 v240, v12, v164
    v_fmac_f32 v242, v5, v149
    v_fmac_f32 v240, v13, v165
    v_fmac_f32 v242, v6, v150
    v_fmac_f32 v240, v14, v166
    v_fmac_f32 v242, v7, v151
    v_fmac_f32 v240, v15, v167
    v_add_u32 v249, s26, v249
    v_add_u32 v250, s26, v250
    v_fma_f32 v244, v16, v160, -v244
    v_fmac_f32 v236, v24, v112
    v_fmac_f32 v244, v17, v161
    v_fmac_f32 v236, v25, v113
    v_fmac_f32 v244, v18, v162
    v_fmac_f32 v236, v26, v114
    v_fmac_f32 v244, v19, v163
    v_fmac_f32 v236, v27, v115
    v_fmac_f32 v244, v20, v164
    v_fmac_f32 v236, v28, v116
    v_fmac_f32 v244, v21, v165
    v_fmac_f32 v236, v29, v117
    v_fmac_f32 v244, v22, v166
    v_fmac_f32 v236, v30, v118
    v_fmac_f32 v244, v23, v167
    v_fmac_f32 v236, v31, v119
    ds_read_b64_tr_b16 v[0:1], v249 offset:0
    ds_read_b64_tr_b16 v[2:3], v249 offset:128
    ds_read_b128 v[4:7], v250 offset:0
    ds_read_b128 v[8:11], v250 offset:16
    ds_read_b128 v[12:15], v250 offset:384
    ds_read_b128 v[16:19], v250 offset:400
    v_mul_f32 v243, v32, v152
    v_fma_f32 v241, v40, v168, -v241
    v_fmac_f32 v243, v33, v153
    v_fmac_f32 v241, v41, v169
    v_fmac_f32 v243, v34, v154
    v_fmac_f32 v241, v42, v170
    v_fmac_f32 v243, v35, v155
    v_fmac_f32 v241, v43, v171
    v_fmac_f32 v243, v36, v156
    v_fmac_f32 v241, v44, v172
    v_fmac_f32 v243, v37, v157
    v_fmac_f32 v241, v45, v173
    v_fmac_f32 v243, v38, v158
    v_fmac_f32 v241, v46, v174
    v_fmac_f32 v243, v39, v159
    v_fmac_f32 v241, v47, v175
    ds_read_b64_tr_b16 v[20:21], v249 offset:512
    ds_read_b64_tr_b16 v[22:23], v249 offset:640
    ds_read_b128 v[24:27], v250 offset:64
    ds_read_b128 v[28:31], v250 offset:80
    ds_read_b128 v[32:35], v250 offset:448
    ds_read_b128 v[36:39], v250 offset:464
    v_fma_f32 v245, v48, v168, -v245
    v_fmac_f32 v237, v56, v120
    v_fmac_f32 v245, v49, v169
    v_fmac_f32 v237, v57, v121
    v_fmac_f32 v245, v50, v170
    v_fmac_f32 v237, v58, v122
    v_fmac_f32 v245, v51, v171
    v_fmac_f32 v237, v59, v123
    v_fmac_f32 v245, v52, v172
    v_fmac_f32 v237, v60, v124
    v_fmac_f32 v245, v53, v173
    v_fmac_f32 v237, v61, v125
    v_fmac_f32 v245, v54, v174
    v_fmac_f32 v237, v62, v126
    v_fmac_f32 v245, v55, v175
    v_fmac_f32 v237, v63, v127
    s_cmp_eq_u32 s56, 2
    s_cbranch_scc1 K2_U20
    s_cmp_eq_u32 s56, 3
    s_cbranch_scc1 K2_U30
    s_branch K2_DSP0
K2_U40:
    s_setprio 1
    s_waitcnt lgkmcnt(6)
    v_lshlrev_b32 v40, 16, v0
    v_and_b32 v41, 0xffff0000, v0
    v_lshlrev_b32 v42, 16, v1
    v_and_b32 v43, 0xffff0000, v1
    v_lshlrev_b32 v44, 16, v2
    v_and_b32 v45, 0xffff0000, v2
    v_lshlrev_b32 v46, 16, v3
    v_and_b32 v47, 0xffff0000, v3
    v_mul_f32 v4, v40, v4
    v_mul_f32 v5, v41, v5
    v_mul_f32 v6, v42, v6
    v_mul_f32 v7, v43, v7
    v_mul_f32 v8, v44, v8
    v_mul_f32 v9, v45, v9
    v_mul_f32 v10, v46, v10
    v_mul_f32 v11, v47, v11
    v_cvt_pk_bf16_f32 v64, v4, v5
    v_cvt_pk_bf16_f32 v65, v6, v7
    v_cvt_pk_bf16_f32 v66, v8, v9
    v_cvt_pk_bf16_f32 v67, v10, v11
    v_mul_f32 v12, v40, v12
    v_mul_f32 v13, v41, v13
    v_mul_f32 v14, v42, v14
    v_mul_f32 v15, v43, v15
    v_mul_f32 v16, v44, v16
    v_mul_f32 v17, v45, v17
    v_mul_f32 v18, v46, v18
    v_mul_f32 v19, v47, v19
    v_cvt_pk_bf16_f32 v68, v12, v13
    v_cvt_pk_bf16_f32 v69, v14, v15
    v_cvt_pk_bf16_f32 v70, v16, v17
    v_cvt_pk_bf16_f32 v71, v18, v19
    ds_read_b64_tr_b16 v[0:1], v249 offset:1024
    ds_read_b64_tr_b16 v[2:3], v249 offset:1152
    ds_read_b128 v[4:7], v250 offset:128
    ds_read_b128 v[8:11], v250 offset:144
    ds_read_b128 v[12:15], v250 offset:512
    ds_read_b128 v[16:19], v250 offset:528
    s_waitcnt lgkmcnt(6)
    v_lshlrev_b32 v48, 16, v20
    v_and_b32 v49, 0xffff0000, v20
    v_lshlrev_b32 v50, 16, v21
    v_and_b32 v51, 0xffff0000, v21
    v_lshlrev_b32 v52, 16, v22
    v_and_b32 v53, 0xffff0000, v22
    v_lshlrev_b32 v54, 16, v23
    v_and_b32 v55, 0xffff0000, v23
    v_mul_f32 v24, v48, v24
    v_mul_f32 v25, v49, v25
    v_mul_f32 v26, v50, v26
    v_mul_f32 v27, v51, v27
    v_mul_f32 v28, v52, v28
    v_mul_f32 v29, v53, v29
    v_mul_f32 v30, v54, v30
    v_mul_f32 v31, v55, v31
    v_cvt_pk_bf16_f32 v72, v24, v25
    v_cvt_pk_bf16_f32 v73, v26, v27
    v_cvt_pk_bf16_f32 v74, v28, v29
    v_cvt_pk_bf16_f32 v75, v30, v31
    v_mul_f32 v32, v48, v32
    v_mul_f32 v33, v49, v33
    v_mul_f32 v34, v50, v34
    v_mul_f32 v35, v51, v35
    v_mul_f32 v36, v52, v36
    v_mul_f32 v37, v53, v37
    v_mul_f32 v38, v54, v38
    v_mul_f32 v39, v55, v39
    v_cvt_pk_bf16_f32 v76, v32, v33
    v_cvt_pk_bf16_f32 v77, v34, v35
    v_cvt_pk_bf16_f32 v78, v36, v37
    v_cvt_pk_bf16_f32 v79, v38, v39
    s_lshr_b32 s65, s30, 27
    s_mov_b32 s66, 161536
    s_cmp_ge_u32 s65, 2
    s_cselect_b32 s66, 158112, s66
    s_mul_i32 s65, s65, 512
    s_add_u32 s65, s65, s66
    s_sub_u32 s65, s65, s29
    v_add_u32 v56, s65, v249
    s_lshr_b32 s65, s30, 27
    s_mov_b32 s66, 161536
    s_cmp_ge_u32 s65, 2
    s_cselect_b32 s66, 159008, s66
    s_mul_i32 s65, s65, 64
    s_add_u32 s65, s65, s66
    s_sub_u32 s65, s65, s29
    v_add_u32 v57, s65, v250
    ds_read_b64_tr_b16 v[20:21], v56 offset:0
    ds_read_b64_tr_b16 v[22:23], v56 offset:128
    ds_read_b128 v[24:27], v57 offset:0
    ds_read_b128 v[28:31], v57 offset:16
    ds_read_b128 v[32:35], v57 offset:384
    ds_read_b128 v[36:39], v57 offset:400
    s_waitcnt lgkmcnt(10)
    v_lshlrev_b32 v40, 16, v0
    v_and_b32 v41, 0xffff0000, v0
    v_lshlrev_b32 v42, 16, v1
    v_and_b32 v43, 0xffff0000, v1
    v_lshlrev_b32 v44, 16, v2
    v_and_b32 v45, 0xffff0000, v2
    v_lshlrev_b32 v46, 16, v3
    v_and_b32 v47, 0xffff0000, v3
    s_waitcnt lgkmcnt(8)
    v_mul_f32 v4, v40, v4
    v_mul_f32 v5, v41, v5
    v_mul_f32 v6, v42, v6
    v_mul_f32 v7, v43, v7
    v_mul_f32 v8, v44, v8
    v_mul_f32 v9, v45, v9
    v_mul_f32 v10, v46, v10
    v_mul_f32 v11, v47, v11
    v_cvt_pk_bf16_f32 v80, v4, v5
    v_cvt_pk_bf16_f32 v81, v6, v7
    v_cvt_pk_bf16_f32 v82, v8, v9
    v_cvt_pk_bf16_f32 v83, v10, v11
    s_waitcnt lgkmcnt(6)
    v_mul_f32 v12, v40, v12
    v_mul_f32 v13, v41, v13
    v_mul_f32 v14, v42, v14
    v_mul_f32 v15, v43, v15
    v_mul_f32 v16, v44, v16
    v_mul_f32 v17, v45, v17
    v_mul_f32 v18, v46, v18
    v_mul_f32 v19, v47, v19
    v_cvt_pk_bf16_f32 v84, v12, v13
    v_cvt_pk_bf16_f32 v85, v14, v15
    v_cvt_pk_bf16_f32 v86, v16, v17
    v_cvt_pk_bf16_f32 v87, v18, v19
    s_waitcnt lgkmcnt(4)
    v_lshlrev_b32 v48, 16, v20
    v_and_b32 v49, 0xffff0000, v20
    v_lshlrev_b32 v50, 16, v21
    v_and_b32 v51, 0xffff0000, v21
    v_lshlrev_b32 v52, 16, v22
    v_and_b32 v53, 0xffff0000, v22
    v_lshlrev_b32 v54, 16, v23
    v_and_b32 v55, 0xffff0000, v23
    s_waitcnt lgkmcnt(2)
    v_mul_f32 v24, v48, v24
    v_mul_f32 v25, v49, v25
    v_mul_f32 v26, v50, v26
    v_mul_f32 v27, v51, v27
    v_mul_f32 v28, v52, v28
    v_mul_f32 v29, v53, v29
    v_mul_f32 v30, v54, v30
    v_mul_f32 v31, v55, v31
    v_cvt_pk_bf16_f32 v88, v24, v25
    v_cvt_pk_bf16_f32 v89, v26, v27
    v_cvt_pk_bf16_f32 v90, v28, v29
    v_cvt_pk_bf16_f32 v91, v30, v31
    s_waitcnt lgkmcnt(0)
    v_mul_f32 v32, v48, v32
    v_mul_f32 v33, v49, v33
    v_mul_f32 v34, v50, v34
    v_mul_f32 v35, v51, v35
    v_mul_f32 v36, v52, v36
    v_mul_f32 v37, v53, v37
    v_mul_f32 v38, v54, v38
    v_mul_f32 v39, v55, v39
    v_cvt_pk_bf16_f32 v92, v32, v33
    v_cvt_pk_bf16_f32 v93, v34, v35
    v_cvt_pk_bf16_f32 v94, v36, v37
    v_cvt_pk_bf16_f32 v95, v38, v39
    s_waitcnt vmcnt(4)
    v_mfma_f32_32x32x16_bf16 v[0:15], v[64:67], v[176:179], 0
    ds_read_b64_tr_b16 v[184:185], v246 offset:2048
    ds_read_b64_tr_b16 v[186:187], v246 offset:2560
    ds_read_b64_tr_b16 v[188:189], v247 offset:2048
    ds_read_b64_tr_b16 v[190:191], v247 offset:2560
    s_mov_b32 m0, s68
    v_mfma_f32_32x32x16_bf16 v[16:31], v[68:71], v[176:179], 0
    buffer_load_dwordx4 v222, s[4:7], s41 offen sc1 lds
    buffer_load_dwordx4 v223, s[72:75], s41 offen offset:1024 sc1 lds
    v_permlane32_swap_b32 v242, v236
    v_permlane32_swap_b32 v243, v237
    s_add_u32 s38, s38, 1
    v_mfma_f32_32x32x16_bf16 v[32:47], v[64:67], v[180:183], 0
    v_permlane32_swap_b32 v244, v238
    v_permlane32_swap_b32 v245, v239
    v_permlane32_swap_b32 v240, v241
    v_add_f32 v242, v242, v236
    v_mfma_f32_32x32x16_bf16 v[48:63], v[68:71], v[180:183], 0
    v_add_f32 v243, v243, v237
    v_add_f32 v244, v244, v238
    v_add_f32 v245, v245, v239
    v_add_f32 v240, -v240, -v241
    v_mov_b32 v254, s52
    v_mov_b32 v255, s38
    s_waitcnt vmcnt(4) lgkmcnt(0)
    v_mfma_f32_32x32x16_bf16 v[0:15], v[72:75], v[184:187], v[0:15]
    ds_read_b64_tr_b16 v[176:177], v246 offset:4096
    ds_read_b64_tr_b16 v[178:179], v246 offset:4608
    ds_read_b64_tr_b16 v[180:181], v247 offset:4096
    ds_read_b64_tr_b16 v[182:183], v247 offset:4608
    s_lshl_b32 s58, s38, 3
    s_add_u32 s58, s58, s20
    s_mov_b32 m0, s69
    v_mfma_f32_32x32x16_bf16 v[16:31], v[76:79], v[184:187], v[16:31]
    buffer_load_dwordx4 v224, s[4:7], s41 offen sc1 lds
    buffer_load_dwordx4 v225, s[72:75], s41 offen offset:1024 sc1 lds
    s_set_gpr_idx_on s32, gpr_idx(DST)
    s_nop 0
    v_cvt_pk_bf16_f32 v195, v242, v243
    v_cvt_pk_bf16_f32 v196, v244, v245
    v_cvt_pk_bf16_f32 v197, v240, v240
    s_set_gpr_idx_off
    s_mov_b64 exec, 1
    ds_write_b32 v254, v255
    s_mov_b64 exec, -1
    s_cmp_lt_u32 s58, s22
    s_cbranch_scc0 K2_dyn_61
K2_back_62:
    v_readlane_b32 s3, v253, s58
    s_lshl_b32 s44, s34, 7
    s_lshl_b32 s60, s58, 5
    s_and_b32 s48, s3, 0x3ffff
    s_bfe_u32 s33, s3, 0x30012
    s_sub_u32 s60, s60, s48
    s_and_b32 s60, s60, 0xff
    s_add_u32 s60, s60, s48
    s_mul_i32 s35, s38, 6
    s_cmp_eq_u32 s34, 0
    s_cselect_b32 s35, s35, s60
    s_mov_b32 s45, s44
    s_add_u32 s47, s44, 256
    s_add_u32 s49, s48, 32
    s_add_u32 s60, s48, 64
    s_cmp_eq_u32 s33, 3
    s_cselect_b32 s46, s44, s47
    s_cselect_b32 s50, s60, s48
    s_cselect_b32 s51, s48, s49
    s_sub_u32 s60, s33, 2
    s_cmp_lt_u32 s60, 2
    s_cbranch_scc0 K2_rare_67
K2_back_68:
    v_mfma_f32_32x32x16_bf16 v[32:47], v[72:75], v[188:191], v[32:47]
    v_add_u32 v233, s48, v230
    ds_read_b32 v232, v233
    ds_read_b32 v233, v233 offset:1024
    v_mfma_f32_32x32x16_bf16 v[48:63], v[76:79], v[188:191], v[48:63]
    s_waitcnt vmcnt(4) lgkmcnt(3)
    v_mfma_f32_32x32x16_bf16 v[0:15], v[80:83], v[176:179], v[0:15]
    ds_read_b64_tr_b16 v[184:185], v246 offset:6144
    ds_read_b64_tr_b16 v[186:187], v246 offset:6656
    ds_read_b64_tr_b16 v[188:189], v247 offset:6144
    ds_read_b64_tr_b16 v[190:191], v247 offset:6656
    s_mov_b32 m0, s70
    v_mfma_f32_32x32x16_bf16 v[16:31], v[84:87], v[176:179], v[16:31]
    buffer_load_dwordx4 v226, s[4:7], s41 offen sc1 lds
    buffer_load_dwordx4 v227, s[72:75], s41 offen offset:1024 sc1 lds
    v_mfma_f32_32x32x16_bf16 v[32:47], v[80:83], v[180:183], v[32:47]
    v_mfma_f32_32x32x16_bf16 v[48:63], v[84:87], v[180:183], v[48:63]
    s_waitcnt lgkmcnt(4)
    v_or_b32 v232, v232, v231
    v_or_b32 v233, v233, v231
    s_cmp_lg_u32 s34, 0
    s_cbranch_scc1 K2_dum_70
    s_add_u32 m0, s48, 864
    s_add_u32 s65, s48, 1888
    buffer_load_dwordx4 v232, s[16:19], 0 offen  lds
    s_mov_b32 m0, s65
    s_mov_b32 exec_hi, 0
    buffer_load_dwordx4 v233, s[16:19], 0 offen  lds
    s_cmp_eq_u32 s33, 4
    s_cbranch_scc1 K2_a4_71
K2_b4_73:
    s_mov_b32 exec_hi, -1
K2_back_72:
    s_waitcnt vmcnt(6) lgkmcnt(0)
    v_mfma_f32_32x32x16_bf16 v[0:15], v[88:91], v[184:187], v[0:15]
    ds_read_b64_tr_b16 v[176:177], v246 offset:0
    ds_read_b64_tr_b16 v[178:179], v246 offset:512
    ds_read_b64_tr_b16 v[180:181], v247 offset:0
    ds_read_b64_tr_b16 v[182:183], v247 offset:512
    s_mov_b32 m0, s71
    v_mfma_f32_32x32x16_bf16 v[16:31], v[92:95], v[184:187], v[16:31]
    buffer_load_dwordx4 v228, s[4:7], s41 offen sc1 lds
    buffer_load_dwordx4 v229, s[72:75], s41 offen offset:1024 sc1 lds
    v_mfma_f32_32x32x16_bf16 v[32:47], v[88:91], v[188:191], v[32:47]
    s_nop 2
    v_mul_f32 v234, v0, v96
    v_mul_f32 v236, v8, v128
    v_fmac_f32 v234, v1, v97
    v_fmac_f32 v236, v9, v129
    v_fmac_f32 v234, v2, v98
    v_fmac_f32 v236, v10, v130
    v_fmac_f32 v234, v3, v99
    v_mfma_f32_32x32x16_bf16 v[48:63], v[92:95], v[188:191], v[48:63]
    s_setprio 0
    v_fmac_f32 v236, v11, v131
    v_fmac_f32 v234, v4, v100
    v_fmac_f32 v236, v12, v132
    v_fmac_f32 v234, v5, v101
    v_fmac_f32 v236, v13, v133
    v_fmac_f32 v234, v6, v102
    v_fmac_f32 v236, v14, v134
    v_fmac_f32 v234, v7, v103
    v_fmac_f32 v236, v15, v135
    v_mul_f32 v238, v16, v128
    v_mul_f32 v240, v24, v128
    v_fmac_f32 v238, v17, v129
    v_fmac_f32 v240, v25, v129
    v_fmac_f32 v238, v18, v130
    v_fmac_f32 v240, v26, v130
    v_fmac_f32 v238, v19, v131
    v_fmac_f32 v240, v27, v131
    v_fmac_f32 v238, v20, v132
    v_fmac_f32 v240, v28, v132
    v_fmac_f32 v238, v21, v133
    v_fmac_f32 v240, v29, v133
    v_fmac_f32 v238, v22, v134
    v_fmac_f32 v240, v30, v134
    v_fmac_f32 v238, v23, v135
    v_fmac_f32 v240, v31, v135
    v_mul_f32 v235, v32, v104
    v_mul_f32 v237, v40, v136
    v_fmac_f32 v235, v33, v105
    v_fmac_f32 v237, v41, v137
    v_fmac_f32 v235, v34, v106
    v_fmac_f32 v237, v42, v138
    v_fmac_f32 v235, v35, v107
    v_fmac_f32 v237, v43, v139
    v_fmac_f32 v235, v36, v108
    v_fmac_f32 v237, v44, v140
    v_fmac_f32 v235, v37, v109
    v_fmac_f32 v237, v45, v141
    v_fmac_f32 v235, v38, v110
    v_fmac_f32 v237, v46, v142
    v_fmac_f32 v235, v39, v111
    v_fmac_f32 v237, v47, v143
    v_mul_f32 v239, v48, v136
    v_mul_f32 v241, v56, v136
    s_setprio 1
    s_waitcnt vmcnt(6) lgkmcnt(0)
    v_mfma_f32_32x32x16_bf16 v[0:15], v[64:67], v[176:179], 0
    ds_read_b64_tr_b16 v[184:185], v246 offset:2048
    ds_read_b64_tr_b16 v[186:187], v246 offset:2560
    ds_read_b64_tr_b16 v[188:189], v247 offset:2048
    ds_read_b64_tr_b16 v[190:191], v247 offset:2560
    v_fmac_f32 v239, v49, v137
    v_fmac_f32 v241, v57, v137
    s_mov_b32 m0, s68
    v_mfma_f32_32x32x16_bf16 v[16:31], v[68:71], v[176:179], 0
    buffer_load_dwordx4 v222, s[4:7], s42 offen sc1 lds
    buffer_load_dwordx4 v223, s[72:75], s42 offen offset:1024 sc1 lds
    v_fmac_f32 v239, v50, v138
    v_fmac_f32 v241, v58, v138
    v_fmac_f32 v239, v51, v139
    v_fmac_f32 v241, v59, v139
    v_fmac_f32 v239, v52, v140
    v_mfma_f32_32x32x16_bf16 v[32:47], v[64:67], v[180:183], 0
    v_fmac_f32 v241, v60, v140
    v_fmac_f32 v239, v53, v141
    v_fmac_f32 v241, v61, v141
    v_fmac_f32 v239, v54, v142
    v_fmac_f32 v241, v62, v142
    v_fmac_f32 v239, v55, v143
    v_fmac_f32 v241, v63, v143
    v_mfma_f32_32x32x16_bf16 v[48:63], v[68:71], v[180:183], 0
    v_permlane32_swap_b32 v234, v236
    v_permlane32_swap_b32 v235, v237
    v_permlane32_swap_b32 v240, v238
    s_waitcnt vmcnt(6) lgkmcnt(0)
    v_mfma_f32_32x32x16_bf16 v[0:15], v[72:75], v[184:187], v[0:15]
    ds_read_b64_tr_b16 v[176:177], v246 offset:4096
    ds_read_b64_tr_b16 v[178:179], v246 offset:4608
    ds_read_b64_tr_b16 v[180:181], v247 offset:4096
    ds_read_b64_tr_b16 v[182:183], v247 offset:4608
    v_permlane32_swap_b32 v241, v239
    s_mov_b32 m0, s69
    v_mfma_f32_32x32x16_bf16 v[16:31], v[76:79], v[184:187], v[16:31]
    buffer_load_dwordx4 v224, s[4:7], s42 offen sc1 lds
    buffer_load_dwordx4 v225, s[72:75], s42 offen offset:1024 sc1 lds
    v_add_f32 v234, v234, v236
    v_add_f32 v235, v235, v237
    v_add_f32 v240, v240, v238
    v_add_f32 v241, v241, v239
    v_mfma_f32_32x32x16_bf16 v[32:47], v[72:75], v[188:191], v[32:47]
    s_set_gpr_idx_on s31, gpr_idx(DST)
    s_nop 0
    v_cvt_pk_bf16_f32 v192, v234, v235
    v_cvt_pk_bf16_f32 v193, v240, v241
    s_set_gpr_idx_off
    v_mfma_f32_32x32x16_bf16 v[48:63], v[76:79], v[188:191], v[48:63]
    s_waitcnt vmcnt(4) lgkmcnt(0)
    v_mfma_f32_32x32x16_bf16 v[0:15], v[80:83], v[176:179], v[0:15]
    ds_read_b64_tr_b16 v[184:185], v246 offset:6144
    ds_read_b64_tr_b16 v[186:187], v246 offset:6656
    ds_read_b64_tr_b16 v[188:189], v247 offset:6144
    ds_read_b64_tr_b16 v[190:191], v247 offset:6656
    s_mov_b32 m0, s70
    v_mfma_f32_32x32x16_bf16 v[16:31], v[84:87], v[176:179], v[16:31]
    buffer_load_dwordx4 v226, s[4:7], s42 offen sc1 lds
    buffer_load_dwordx4 v227, s[72:75], s42 offen offset:1024 sc1 lds
    v_mfma_f32_32x32x16_bf16 v[32:47], v[80:83], v[180:183], v[32:47]
    v_mfma_f32_32x32x16_bf16 v[48:63], v[84:87], v[180:183], v[48:63]
    s_waitcnt vmcnt(4) lgkmcnt(0)
    v_mfma_f32_32x32x16_bf16 v[0:15], v[88:91], v[184:187], v[0:15]
    ds_read_b64_tr_b16 v[176:177], v246 offset:0
    ds_read_b64_tr_b16 v[178:179], v246 offset:512
    ds_read_b64_tr_b16 v[180:181], v247 offset:0
    ds_read_b64_tr_b16 v[182:183], v247 offset:512
    s_mov_b32 m0, s71
    v_mfma_f32_32x32x16_bf16 v[16:31], v[92:95], v[184:187], v[16:31]
    buffer_load_dwordx4 v228, s[4:7], s42 offen sc1 lds
    buffer_load_dwordx4 v229, s[72:75], s42 offen offset:1024 sc1 lds
    v_mfma_f32_32x32x16_bf16 v[32:47], v[88:91], v[188:191], v[32:47]
    s_nop 2
    v_mul_f32 v234, v0, v144
    v_mul_f32 v236, v8, v112
    v_fmac_f32 v234, v1, v145
    v_fmac_f32 v236, v9, v113
    v_fmac_f32 v234, v2, v146
    v_fmac_f32 v236, v10, v114
    v_fmac_f32 v234, v3, v147
    v_mfma_f32_32x32x16_bf16 v[48:63], v[92:95], v[188:191], v[48:63]
    s_setprio 0
    v_fmac_f32 v236, v11, v115
    v_fmac_f32 v234, v4, v148
    v_fmac_f32 v236, v12, v116
    v_fmac_f32 v234, v5, v149
    v_fmac_f32 v236, v13, v117
    v_fmac_f32 v234, v6, v150
    v_fmac_f32 v236, v14, v118
    v_fmac_f32 v234, v7, v151
    v_fmac_f32 v236, v15, v119
    v_mul_f32 v238, v16, v160
    v_mul_f32 v240, v24, v160
    v_fmac_f32 v238, v17, v161
    v_fmac_f32 v240, v25, v161
    v_fmac_f32 v238, v18, v162
    v_fmac_f32 v240, v26, v162
    v_fmac_f32 v238, v19, v163
    v_fmac_f32 v240, v27, v163
    v_fmac_f32 v238, v20, v164
    v_fmac_f32 v240, v28, v164
    v_fmac_f32 v238, v21, v165
    v_fmac_f32 v240, v29, v165
    v_fmac_f32 v238, v22, v166
    v_fmac_f32 v240, v30, v166
    v_fmac_f32 v238, v23, v167
    v_fmac_f32 v240, v31, v167
    v_mul_f32 v235, v32, v152
    v_mul_f32 v237, v40, v120
    v_fmac_f32 v235, v33, v153
    v_fmac_f32 v237, v41, v121
    v_fmac_f32 v235, v34, v154
    v_fmac_f32 v237, v42, v122
    v_fmac_f32 v235, v35, v155
    v_fmac_f32 v237, v43, v123
    v_fmac_f32 v235, v36, v156
    v_fmac_f32 v237, v44, v124
    v_fmac_f32 v235, v37, v157
    v_fmac_f32 v237, v45, v125
    v_fmac_f32 v235, v38, v158
    v_fmac_f32 v237, v46, v126
    v_fmac_f32 v235, v39, v159
    v_fmac_f32 v237, v47, v127
    v_mul_f32 v239, v48, v168
    v_mul_f32 v241, v56, v168
    s_setprio 1
    s_waitcnt vmcnt(4) lgkmcnt(0)
    v_mfma_f32_32x32x16_bf16 v[0:15], v[64:67], v[176:179], 0
    ds_read_b64_tr_b16 v[184:185], v246 offset:2048
    ds_read_b64_tr_b16 v[186:187], v246 offset:2560
    ds_read_b64_tr_b16 v[188:189], v247 offset:2048
    ds_read_b64_tr_b16 v[190:191], v247 offset:2560
    v_fmac_f32 v239, v49, v169
    v_fmac_f32 v241, v57, v169
    s_mov_b32 m0, s68
    v_mfma_f32_32x32x16_bf16 v[16:31], v[68:71], v[176:179], 0
    buffer_load_dwordx4 v222, s[4:7], s43 offen sc1 lds
    buffer_load_dwordx4 v223, s[72:75], s43 offen offset:1024 sc1 lds
    v_fmac_f32 v239, v50, v170
    v_fmac_f32 v241, v58, v170
    v_fmac_f32 v239, v51, v171
    v_fmac_f32 v241, v59, v171
    v_fmac_f32 v239, v52, v172
    v_mfma_f32_32x32x16_bf16 v[32:47], v[64:67], v[180:183], 0
    v_fmac_f32 v241, v60, v172
    v_fmac_f32 v239, v53, v173
    v_fmac_f32 v241, v61, v173
    v_fmac_f32 v239, v54, v174
    v_fmac_f32 v241, v62, v174
    v_fmac_f32 v239, v55, v175
    v_fmac_f32 v241, v63, v175
    v_mfma_f32_32x32x16_bf16 v[48:63], v[68:71], v[180:183], 0
    s_waitcnt vmcnt(4) lgkmcnt(0)
    v_mfma_f32_32x32x16_bf16 v[0:15], v[72:75], v[184:187], v[0:15]
    ds_read_b64_tr_b16 v[176:177], v246 offset:4096
    ds_read_b64_tr_b16 v[178:179], v246 offset:4608
    ds_read_b64_tr_b16 v[180:181], v247 offset:4096
    ds_read_b64_tr_b16 v[182:183], v247 offset:4608
    s_mov_b32 m0, s69
    v_mfma_f32_32x32x16_bf16 v[16:31], v[76:79], v[184:187], v[16:31]
    buffer_load_dwordx4 v224, s[4:7], s43 offen sc1 lds
    buffer_load_dwordx4 v225, s[72:75], s43 offen offset:1024 sc1 lds
    v_mfma_f32_32x32x16_bf16 v[32:47], v[72:75], v[188:191], v[32:47]
    v_mfma_f32_32x32x16_bf16 v[48:63], v[76:79], v[188:191], v[48:63]
    s_waitcnt vmcnt(4) lgkmcnt(0)
    v_mfma_f32_32x32x16_bf16 v[0:15], v[80:83], v[176:179], v[0:15]
    ds_read_b64_tr_b16 v[184:185], v246 offset:6144
    ds_read_b64_tr_b16 v[186:187], v246 offset:6656
    ds_read_b64_tr_b16 v[188:189], v247 offset:6144
    ds_read_b64_tr_b16 v[190:191], v247 offset:6656
    s_mov_b32 m0, s70
    v_mfma_f32_32x32x16_bf16 v[16:31], v[84:87], v[176:179], v[16:31]
    buffer_load_dwordx4 v226, s[4:7], s43 offen sc1 lds
    buffer_load_dwordx4 v227, s[72:75], s43 offen offset:1024 sc1 lds
    v_mfma_f32_32x32x16_bf16 v[32:47], v[80:83], v[180:183], v[32:47]
    v_add_u32 v222, s48, v251
    ds_read_b32 v222, v222
    v_mfma_f32_32x32x16_bf16 v[48:63], v[84:87], v[180:183], v[48:63]
    s_waitcnt vmcnt(4) lgkmcnt(1)
    v_mfma_f32_32x32x16_bf16 v[0:15], v[88:91], v[184:187], v[0:15]
    ds_read_b64_tr_b16 v[176:177], v246 offset:0
    ds_read_b64_tr_b16 v[178:179], v246 offset:512
    ds_read_b64_tr_b16 v[180:181], v247 offset:0
    ds_read_b64_tr_b16 v[182:183], v247 offset:512
    s_mov_b32 m0, s71
    v_mfma_f32_32x32x16_bf16 v[16:31], v[92:95], v[184:187], v[16:31]
    buffer_load_dwordx4 v228, s[4:7], s43 offen sc1 lds
    buffer_load_dwordx4 v229, s[72:75], s43 offen offset:1024 sc1 lds
    s_waitcnt lgkmcnt(4)
    v_mad_u32_u16 v223, v222, s39, v248 op_sel:[1,0,0,0]
    v_mad_u32_u16 v222, v222, s39, v248
    v_mfma_f32_32x32x16_bf16 v[32:47], v[88:91], v[188:191], v[32:47]
    v_add_u32 v224, s49, v251
    ds_read_b32 v224, v224
    v_mul_f32 v242, v0, v144
    v_fma_f32 v238, v8, v160, -v238
    v_fmac_f32 v242, v1, v145
    v_fmac_f32 v238, v9, v161
    v_fmac_f32 v242, v2, v146
    v_mfma_f32_32x32x16_bf16 v[48:63], v[92:95], v[188:191], v[48:63]
    s_setprio 0
    v_fmac_f32 v238, v10, v162
    v_fmac_f32 v242, v3, v147
    v_fmac_f32 v238, v11, v163
    v_fmac_f32 v242, v4, v148
    v_fmac_f32 v238, v12, v164
    v_fmac_f32 v242, v5, v149
    v_fmac_f32 v238, v13, v165
    v_fmac_f32 v242, v6, v150
    v_fmac_f32 v238, v14, v166
    v_fmac_f32 v242, v7, v151
    v_fmac_f32 v238, v15, v167
    v_fmac_f32 v236, v16, v112
    v_mul_f32 v244, v24, v160
    v_fmac_f32 v236, v17, v113
    v_fmac_f32 v244, v25, v161
    v_fmac_f32 v236, v18, v114
    v_fmac_f32 v244, v26, v162
    v_fmac_f32 v236, v19, v115
    v_fmac_f32 v244, v27, v163
    v_fmac_f32 v236, v20, v116
    v_fmac_f32 v244, v28, v164
    v_fmac_f32 v236, v21, v117
    v_fmac_f32 v244, v29, v165
    v_fmac_f32 v236, v22, v118
    v_fmac_f32 v244, v30, v166
    v_fmac_f32 v236, v23, v119
    v_fmac_f32 v244, v31, v167
    v_mul_f32 v243, v32, v152
    v_fma_f32 v239, v40, v168, -v239
    v_fmac_f32 v243, v33, v153
    v_fmac_f32 v239, v41, v169
    v_fmac_f32 v243, v34, v154
    v_fmac_f32 v239, v42, v170
    v_fmac_f32 v243, v35, v155
    v_fmac_f32 v239, v43, v171
    v_fmac_f32 v243, v36, v156
    v_fmac_f32 v239, v44, v172
    v_fmac_f32 v243, v37, v157
    v_fmac_f32 v239, v45, v173
    v_fmac_f32 v243, v38, v158
    v_fmac_f32 v239, v46, v174
    v_fmac_f32 v243, v39, v159
    v_fmac_f32 v239, v47, v175
    v_fmac_f32 v237, v48, v120
    v_mul_f32 v245, v56, v168
    v_fmac_f32 v237, v49, v121
    v_fmac_f32 v245, v57, v169
    v_fmac_f32 v237, v50, v122
    v_fmac_f32 v245, v58, v170
    v_fmac_f32 v237, v51, v123
    s_setprio 1
    s_waitcnt vmcnt(4) lgkmcnt(1)
    v_mfma_f32_32x32x16_bf16 v[0:15], v[64:67], v[176:179], 0
    ds_read_b64_tr_b16 v[184:185], v246 offset:2048
    ds_read_b64_tr_b16 v[186:187], v246 offset:2560
    ds_read_b64_tr_b16 v[188:189], v247 offset:2048
    ds_read_b64_tr_b16 v[190:191], v247 offset:2560
    v_fmac_f32 v245, v59, v171
    v_fmac_f32 v237, v52, v124
    s_mov_b32 m0, s68
    v_mfma_f32_32x32x16_bf16 v[16:31], v[68:71], v[176:179], 0
    buffer_load_dwordx4 v222, s[4:7], s44 offen sc1 lds
    buffer_load_dwordx4 v223, s[72:75], s44 offen offset:1024 sc1 lds
    s_waitcnt lgkmcnt(4)
    v_mad_u32_u16 v225, v224, s39, v248 op_sel:[1,0,0,0]
    v_mad_u32_u16 v224, v224, s39, v248
    v_fmac_f32 v245, v60, v172
    v_fmac_f32 v237, v53, v125
    v_mfma_f32_32x32x16_bf16 v[32:47], v[64:67], v[180:183], 0
    v_add_u32 v226, s50, v251
    ds_read_b32 v226, v226
    v_fmac_f32 v245, v61, v173
    v_fmac_f32 v237, v54, v126
    v_fmac_f32 v245, v62, v174
    v_fmac_f32 v237, v55, v127
    v_fmac_f32 v245, v63, v175
    v_mfma_f32_32x32x16_bf16 v[48:63], v[68:71], v[180:183], 0
    v_permlane32_swap_b32 v242, v234
    v_permlane32_swap_b32 v243, v235
    v_add_f32 v242, v242, v234
    v_add_f32 v243, v243, v235
    s_waitcnt vmcnt(4) lgkmcnt(1)
    v_mfma_f32_32x32x16_bf16 v[0:15], v[72:75], v[184:187], v[0:15]
    ds_read_b64_tr_b16 v[176:177], v246 offset:4096
    ds_read_b64_tr_b16 v[178:179], v246 offset:4608
    ds_read_b64_tr_b16 v[180:181], v247 offset:4096
    ds_read_b64_tr_b16 v[182:183], v247 offset:4608
    s_mov_b32 m0, s69
    v_mfma_f32_32x32x16_bf16 v[16:31], v[76:79], v[184:187], v[16:31]
    buffer_load_dwordx4 v224, s[4:7], s45 offen sc1 lds
    buffer_load_dwordx4 v225, s[72:75], s45 offen offset:1024 sc1 lds
    s_waitcnt lgkmcnt(4)
    v_mad_u32_u16 v227, v226, s39, v248 op_sel:[1,0,0,0]
    v_mad_u32_u16 v226, v226, s39, v248
    v_mfma_f32_32x32x16_bf16 v[32:47], v[72:75], v[188:191], v[32:47]
    v_add_u32 v228, s51, v251
    ds_read_b32 v228, v228
    s_set_gpr_idx_on s31, gpr_idx(DST)
    s_nop 0
    v_cvt_pk_bf16_f32 v194, v242, v243
    s_set_gpr_idx_off
    v_mfma_f32_32x32x16_bf16 v[48:63], v[76:79], v[188:191], v[48:63]
    s_waitcnt vmcnt(4) lgkmcnt(1)
    v_mfma_f32_32x32x16_bf16 v[0:15], v[80:83], v[176:179], v[0:15]
    ds_read_b64_tr_b16 v[184:185], v246 offset:6144
    ds_read_b64_tr_b16 v[186:187], v246 offset:6656
    ds_read_b64_tr_b16 v[188:189], v247 offset:6144
    ds_read_b64_tr_b16 v[190:191], v247 offset:6656
    s_mov_b32 s32, s31
    s_mov_b32 s31, s35
    s_mov_b32 m0, s70
    v_mfma_f32_32x32x16_bf16 v[16:31], v[84:87], v[176:179], v[16:31]
    buffer_load_dwordx4 v226, s[4:7], s46 offen sc1 lds
    buffer_load_dwordx4 v227, s[72:75], s46 offen offset:1024 sc1 lds
    s_waitcnt lgkmcnt(4)
    v_mad_u32_u16 v229, v228, s39, v248 op_sel:[1,0,0,0]
    v_mad_u32_u16 v228, v228, s39, v248
    s_sub_u32 s26, s48, s29
    s_mov_b32 s29, s48
    v_mfma_f32_32x32x16_bf16 v[32:47], v[80:83], v[180:183], v[32:47]
    s_mov_b32 s30, s3
    s_cmp_eq_u32 s34, 0
    s_cselect_b32 s56, s33, 0
    v_mfma_f32_32x32x16_bf16 v[48:63], v[84:87], v[180:183], v[48:63]
    s_waitcnt vmcnt(4) lgkmcnt(0)
    v_mfma_f32_32x32x16_bf16 v[0:15], v[88:91], v[184:187], v[0:15]
    ds_read_b64_tr_b16 v[176:177], v246 offset:0
    ds_read_b64_tr_b16 v[178:179], v246 offset:512
    ds_read_b64_tr_b16 v[180:181], v247 offset:0
    ds_read_b64_tr_b16 v[182:183], v247 offset:512
    s_mov_b32 m0, s71
    v_mfma_f32_32x32x16_bf16 v[16:31], v[92:95], v[184:187], v[16:31]
    buffer_load_dwordx4 v228, s[4:7], s47 offen sc1 lds
    buffer_load_dwordx4 v229, s[72:75], s47 offen offset:1024 sc1 lds
    v_mfma_f32_32x32x16_bf16 v[32:47], v[88:91], v[188:191], v[32:47]
    s_nop 2
    v_mul_f32 v242, v0, v144
    v_fma_f32 v240, v8, v160, -v240
    v_fmac_f32 v242, v1, v145
    v_fmac_f32 v240, v9, v161
    v_fmac_f32 v242, v2, v146
    v_fmac_f32 v240, v10, v162
    v_fmac_f32 v242, v3, v147
    v_mfma_f32_32x32x16_bf16 v[48:63], v[92:95], v[188:191], v[48:63]
    s_setprio 0
    v_fmac_f32 v240, v11, v163
    v_fmac_f32 v242, v4, v148
    v_fmac_f32 v240, v12, v164
    v_fmac_f32 v242, v5, v149
    v_fmac_f32 v240, v13, v165
    v_fmac_f32 v242, v6, v150
    v_fmac_f32 v240, v14, v166
    v_fmac_f32 v242, v7, v151
    v_fmac_f32 v240, v15, v167
    v_add_u32 v249, s26, v249
    v_add_u32 v250, s26, v250
    v_fma_f32 v244, v16, v160, -v244
    v_fmac_f32 v236, v24, v112
    v_fmac_f32 v244, v17, v161
    v_fmac_f32 v236, v25, v113
    v_fmac_f32 v244, v18, v162
    v_fmac_f32 v236, v26, v114
    v_fmac_f32 v244, v19, v163
    v_fmac_f32 v236, v27, v115
    v_fmac_f32 v244, v20, v164
    v_fmac_f32 v236, v28, v116
    v_fmac_f32 v244, v21, v165
    v_fmac_f32 v236, v29, v117
    v_fmac_f32 v244, v22, v166
    v_fmac_f32 v236, v30, v118
    v_fmac_f32 v244, v23, v167
    v_fmac_f32 v236, v31, v119
    ds_read_b64_tr_b16 v[0:1], v249 offset:0
    ds_read_b64_tr_b16 v[2:3], v249 offset:128
    ds_read_b128 v[4:7], v250 offset:0
    ds_read_b128 v[8:11], v250 offset:16
    ds_read_b128 v[12:15], v250 offset:384
    ds_read_b128 v[16:19], v250 offset:400
    v_mul_f32 v243, v32, v152
    v_fma_f32 v241, v40, v168, -v241
    v_fmac_f32 v243, v33, v153
    v_fmac_f32 v241, v41, v169
    v_fmac_f32 v243, v34, v154
    v_fmac_f32 v241, v42, v170
    v_fmac_f32 v243, v35, v155
    v_fmac_f32 v241, v43, v171
    v_fmac_f32 v243, v36, v156
    v_fmac_f32 v241, v44, v172
    v_fmac_f32 v243, v37, v157
    v_fmac_f32 v241, v45, v173
    v_fmac_f32 v243, v38, v158
    v_fmac_f32 v241, v46, v174
    v_fmac_f32 v243, v39, v159
    v_fmac_f32 v241, v47, v175
    ds_read_b64_tr_b16 v[20:21], v249 offset:512
    ds_read_b64_tr_b16 v[22:23], v249 offset:640
    ds_read_b128 v[24:27], v250 offset:64
    ds_read_b128 v[28:31], v250 offset:80
    ds_read_b128 v[32:35], v250 offset:448
    ds_read_b128 v[36:39], v250 offset:464
    v_fma_f32 v245, v48, v168, -v245
    v_fmac_f32 v237, v56, v120
    v_fmac_f32 v245, v49, v169
    v_fmac_f32 v237, v57, v121
    v_fmac_f32 v245, v50, v170
    v_fmac_f32 v237, v58, v122
    v_fmac_f32 v245, v51, v171
    v_fmac_f32 v237, v59, v123
    v_fmac_f32 v245, v52, v172
    v_fmac_f32 v237, v60, v124
    v_fmac_f32 v245, v53, v173
    v_fmac_f32 v237, v61, v125
    v_fmac_f32 v245, v54, v174
    v_fmac_f32 v237, v62, v126
    v_fmac_f32 v245, v55, v175
    v_fmac_f32 v237, v63, v127
    s_cmp_eq_u32 s56, 2
    s_cbranch_scc1 K2_U20
    s_cmp_eq_u32 s56, 3
    s_cbranch_scc1 K2_U30
    s_branch K2_DSP0
K2_U11:
    s_setprio 1
    v_mov_b32 v254, 163648
    v_mov_b32 v255, 1
    v_lshl_add_u32 v233, v252, 1, s53
    s_mov_b64 exec, 1
    ds_add_rtn_u32 v232, v254, v255
    s_mov_b64 exec, -1
    ds_read_b32 v233, v233
    s_waitcnt lgkmcnt(8)
    v_lshlrev_b32 v40, 16, v0
    v_and_b32 v41, 0xffff0000, v0
    v_lshlrev_b32 v42, 16, v1
    v_and_b32 v43, 0xffff0000, v1
    v_lshlrev_b32 v44, 16, v2
    v_and_b32 v45, 0xffff0000, v2
    v_lshlrev_b32 v46, 16, v3
    v_and_b32 v47, 0xffff0000, v3
    v_mul_f32 v4, v40, v4
    v_mul_f32 v5, v41, v5
    v_mul_f32 v6, v42, v6
    v_mul_f32 v7, v43, v7
    v_mul_f32 v8, v44, v8
    v_mul_f32 v9, v45, v9
    v_mul_f32 v10, v46, v10
    v_mul_f32 v11, v47, v11
    v_cvt_pk_bf16_f32 v64, v4, v5
    v_cvt_pk_bf16_f32 v65, v6, v7
    v_cvt_pk_bf16_f32 v66, v8, v9
    v_cvt_pk_bf16_f32 v67, v10, v11
    v_mul_f32 v12, v40, v12
    v_mul_f32 v13, v41, v13
    v_mul_f32 v14, v42, v14
    v_mul_f32 v15, v43, v15
    v_mul_f32 v16, v44, v16
    v_mul_f32 v17, v45, v17
    v_mul_f32 v18, v46, v18
    v_mul_f32 v19, v47, v19
    v_cvt_pk_bf16_f32 v68, v12, v13
    v_cvt_pk_bf16_f32 v69, v14, v15
    v_cvt_pk_bf16_f32 v70, v16, v17
    v_cvt_pk_bf16_f32 v71, v18, v19
    s_waitcnt lgkmcnt(0)
    v_readfirstlane_b32 s58, v232
    s_nop 0
    s_cmp_lt_u32 s58, s22
    s_cbranch_scc0 K2_nul_74
    s_and_b32 s59, s58, 7
    s_lshr_b32 s60, s58, 3
K2_chk_76:
    v_readlane_b32 s61, v233, s59
    s_nop 0
    s_cmp_gt_u32 s61, s60
    s_cbranch_scc0 K2_spin_75
K2_back_77:
    v_readlane_b32 s3, v253, s58
    s_lshl_b32 s44, s34, 7
    s_lshl_b32 s60, s58, 5
    s_and_b32 s48, s3, 0x3ffff
    s_bfe_u32 s33, s3, 0x30012
    s_sub_u32 s60, s60, s48
    s_and_b32 s60, s60, 0xff
    s_add_u32 s35, s60, s48
    s_mov_b32 s45, s44
    s_add_u32 s47, s44, 256
    s_add_u32 s49, s48, 32
    s_add_u32 s60, s48, 64
    s_cmp_eq_u32 s33, 3
    s_cselect_b32 s46, s44, s47
    s_cselect_b32 s50, s60, s48
    s_cselect_b32 s51, s48, s49
    s_sub_u32 s60, s33, 2
    s_cmp_lt_u32 s60, 2
    s_cbranch_scc0 K2_rare_78
K2_back_79:
    v_add_u32 v222, s48, v251
    ds_read_b32 v222, v222
    v_add_u32 v224, s49, v251
    ds_read_b32 v224, v224
    v_add_u32 v226, s50, v251
    ds_read_b32 v226, v226
    v_add_u32 v228, s51, v251
    ds_read_b32 v228, v228
    s_waitcnt lgkmcnt(3)
    v_mad_u32_u16 v223, v222, s39, v248 op_sel:[1,0,0,0]
    v_mad_u32_u16 v222, v222, s39, v248
    s_waitcnt lgkmcnt(2)
    v_mad_u32_u16 v225, v224, s39, v248 op_sel:[1,0,0,0]
    v_mad_u32_u16 v224, v224, s39, v248
    s_waitcnt lgkmcnt(1)
    v_mad_u32_u16 v227, v226, s39, v248 op_sel:[1,0,0,0]
    v_mad_u32_u16 v226, v226, s39, v248
    s_waitcnt lgkmcnt(0)
    v_mad_u32_u16 v229, v228, s39, v248 op_sel:[1,0,0,0]
    v_mad_u32_u16 v228, v228, s39, v248
    s_waitcnt vmcnt(4)
    v_mfma_f32_32x32x16_bf16 v[0:15], v[64:67], v[176:179], 0
    ds_read_b64_tr_b16 v[184:185], v246 offset:2048
    ds_read_b64_tr_b16 v[186:187], v246 offset:2560
    ds_read_b64_tr_b16 v[188:189], v247 offset:2048
    ds_read_b64_tr_b16 v[190:191], v247 offset:2560
    s_mov_b32 m0, s68
    v_mfma_f32_32x32x16_bf16 v[16:31], v[68:71], v[176:179], 0
    buffer_load_dwordx4 v222, s[4:7], s44 offen sc1 lds
    buffer_load_dwordx4 v223, s[72:75], s44 offen offset:1024 sc1 lds
    v_permlane32_swap_b32 v242, v236
    v_permlane32_swap_b32 v243, v237
    v_mfma_f32_32x32x16_bf16 v[32:47], v[64:67], v[180:183], 0
    v_permlane32_swap_b32 v244, v238
    v_permlane32_swap_b32 v245, v239
    v_permlane32_swap_b32 v240, v241
    v_add_f32 v242, v242, v236
    v_mfma_f32_32x32x16_bf16 v[48:63], v[68:71], v[180:183], 0
    s_setprio 0
    v_add_f32 v243, v243, v237
    v_add_f32 v244, v244, v238
    v_add_f32 v245, v245, v239
    v_add_f32 v240, -v240, -v241
    v_sub_u32 v241, v230, v231
    v_cvt_pk_bf16_f32 v242, v242, v243
    v_cvt_pk_bf16_f32 v244, v244, v245
    v_cvt_pk_bf16_f32 v240, v240, v240
    ds_write_b32 v230, v242 offset:768
    ds_write_b32 v230, v244 offset:1024
    ds_write_b16 v241, v240 offset:1280
    v_mul_f32 v234, v0, v96
    v_mul_f32 v236, v8, v128
    v_fmac_f32 v234, v1, v97
    v_fmac_f32 v236, v9, v129
    v_fmac_f32 v234, v2, v98
    v_fmac_f32 v236, v10, v130
    v_fmac_f32 v234, v3, v99
    v_fmac_f32 v236, v11, v131
    v_fmac_f32 v234, v4, v100
    v_fmac_f32 v236, v12, v132
    v_fmac_f32 v234, v5, v101
    v_fmac_f32 v236, v13, v133
    v_fmac_f32 v234, v6, v102
    v_fmac_f32 v236, v14, v134
    v_fmac_f32 v234, v7, v103
    v_fmac_f32 v236, v15, v135
    v_mul_f32 v238, v16, v128
    v_mul_f32 v240, v24, v128
    v_fmac_f32 v238, v17, v129
    v_fmac_f32 v240, v25, v129
    v_fmac_f32 v238, v18, v130
    v_fmac_f32 v240, v26, v130
    v_fmac_f32 v238, v19, v131
    v_fmac_f32 v240, v27, v131
    v_fmac_f32 v238, v20, v132
    v_fmac_f32 v240, v28, v132
    v_fmac_f32 v238, v21, v133
    v_fmac_f32 v240, v29, v133
    v_fmac_f32 v238, v22, v134
    v_fmac_f32 v240, v30, v134
    v_fmac_f32 v238, v23, v135
    v_fmac_f32 v240, v31, v135
    v_mul_f32 v235, v32, v104
    v_mul_f32 v237, v40, v136
    v_fmac_f32 v235, v33, v105
    v_fmac_f32 v237, v41, v137
    v_fmac_f32 v235, v34, v106
    v_fmac_f32 v237, v42, v138
    v_fmac_f32 v235, v35, v107
    v_fmac_f32 v237, v43, v139
    v_fmac_f32 v235, v36, v108
    v_fmac_f32 v237, v44, v140
    v_fmac_f32 v235, v37, v109
    v_fmac_f32 v237, v45, v141
    v_fmac_f32 v235, v38, v110
    v_fmac_f32 v237, v46, v142
    v_fmac_f32 v235, v39, v111
    v_fmac_f32 v237, v47, v143
    v_mul_f32 v239, v48, v136
    v_mul_f32 v241, v56, v136
    v_fmac_f32 v239, v49, v137
    v_fmac_f32 v241, v57, v137
    v_fmac_f32 v239, v50, v138
    v_fmac_f32 v241, v58, v138
    v_fmac_f32 v239, v51, v139
    v_fmac_f32 v241, v59, v139
    v_fmac_f32 v239, v52, v140
    v_fmac_f32 v241, v60, v140
    v_fmac_f32 v239, v53, v141
    v_fmac_f32 v241, v61, v141
    v_fmac_f32 v239, v54, v142
    v_fmac_f32 v241, v62, v142
    v_fmac_f32 v239, v55, v143
    v_fmac_f32 v241, v63, v143
    s_setprio 1
    s_waitcnt vmcnt(4) lgkmcnt(3)
    v_mfma_f32_32x32x16_bf16 v[0:15], v[64:67], v[184:187], 0
    ds_read_b64_tr_b16 v[176:177], v246 offset:4096
    ds_read_b64_tr_b16 v[178:179], v246 offset:4608
    ds_read_b64_tr_b16 v[180:181], v247 offset:4096
    ds_read_b64_tr_b16 v[182:183], v247 offset:4608
    s_mov_b32 m0, s69
    v_mfma_f32_32x32x16_bf16 v[16:31], v[68:71], v[184:187], 0
    buffer_load_dwordx4 v224, s[4:7], s45 offen sc1 lds
    buffer_load_dwordx4 v225, s[72:75], s45 offen offset:1024 sc1 lds
    v_permlane32_swap_b32 v234, v236
    v_permlane32_swap_b32 v235, v237
    v_mfma_f32_32x32x16_bf16 v[32:47], v[64:67], v[188:191], 0
    v_permlane32_swap_b32 v240, v238
    v_permlane32_swap_b32 v241, v239
    v_lshl_add_u32 v230, v252, 1, s31
    v_add_f32 v234, v234, v236
    v_add_f32 v235, v235, v237
    v_mfma_f32_32x32x16_bf16 v[48:63], v[68:71], v[188:191], 0
    s_setprio 0
    v_add_f32 v240, v240, v238
    v_add_f32 v241, v241, v239
    v_cvt_pk_bf16_f32 v234, v234, v235
    v_cvt_pk_bf16_f32 v240, v240, v241
    ds_write_b32 v230, v234 offset:0
    ds_write_b32 v230, v240 offset:256
    v_mul_f32 v234, v0, v144
    v_mul_f32 v236, v8, v112
    v_fmac_f32 v234, v1, v145
    v_fmac_f32 v236, v9, v113
    v_fmac_f32 v234, v2, v146
    v_fmac_f32 v236, v10, v114
    v_fmac_f32 v234, v3, v147
    v_fmac_f32 v236, v11, v115
    v_fmac_f32 v234, v4, v148
    v_fmac_f32 v236, v12, v116
    v_fmac_f32 v234, v5, v149
    v_fmac_f32 v236, v13, v117
    v_fmac_f32 v234, v6, v150
    v_fmac_f32 v236, v14, v118
    v_fmac_f32 v234, v7, v151
    v_fmac_f32 v236, v15, v119
    v_mul_f32 v238, v16, v160
    v_mul_f32 v240, v24, v160
    v_fmac_f32 v238, v17, v161
    v_fmac_f32 v240, v25, v161
    v_fmac_f32 v238, v18, v162
    v_fmac_f32 v240, v26, v162
    v_fmac_f32 v238, v19, v163
    v_fmac_f32 v240, v27, v163
    v_fmac_f32 v238, v20, v164
    v_fmac_f32 v240, v28, v164
    v_fmac_f32 v238, v21, v165
    v_fmac_f32 v240, v29, v165
    v_fmac_f32 v238, v22, v166
    v_fmac_f32 v240, v30, v166
    v_fmac_f32 v238, v23, v167
    v_fmac_f32 v240, v31, v167
    v_mul_f32 v235, v32, v152
    v_mul_f32 v237, v40, v120
    v_fmac_f32 v235, v33, v153
    v_fmac_f32 v237, v41, v121
    v_fmac_f32 v235, v34, v154
    v_fmac_f32 v237, v42, v122
    v_fmac_f32 v235, v35, v155
    v_fmac_f32 v237, v43, v123
    v_fmac_f32 v235, v36, v156
    v_fmac_f32 v237, v44, v124
    v_fmac_f32 v235, v37, v157
    v_fmac_f32 v237, v45, v125
    v_fmac_f32 v235, v38, v158
    v_fmac_f32 v237, v46, v126
    v_fmac_f32 v235, v39, v159
    v_fmac_f32 v237, v47, v127
    v_mul_f32 v239, v48, v168
    v_mul_f32 v241, v56, v168
    v_fmac_f32 v239, v49, v169
    v_fmac_f32 v241, v57, v169
    v_fmac_f32 v239, v50, v170
    v_fmac_f32 v241, v58, v170
    v_fmac_f32 v239, v51, v171
    v_fmac_f32 v241, v59, v171
    v_fmac_f32 v239, v52, v172
    v_fmac_f32 v241, v60, v172
    v_fmac_f32 v239, v53, v173
    v_fmac_f32 v241, v61, v173
    v_fmac_f32 v239, v54, v174
    v_fmac_f32 v241, v62, v174
    v_fmac_f32 v239, v55, v175
    v_fmac_f32 v241, v63, v175
    s_setprio 1
    s_waitcnt vmcnt(4) lgkmcnt(2)
    v_mfma_f32_32x32x16_bf16 v[0:15], v[64:67], v[176:179], 0
    ds_read_b64_tr_b16 v[184:185], v246 offset:6144
    ds_read_b64_tr_b16 v[186:187], v246 offset:6656
    ds_read_b64_tr_b16 v[188:189], v247 offset:6144
    ds_read_b64_tr_b16 v[190:191], v247 offset:6656
    s_mov_b32 s32, s31
    s_mov_b32 s31, s35
    s_mov_b32 m0, s70
    v_mfma_f32_32x32x16_bf16 v[16:31], v[68:71], v[176:179], 0
    buffer_load_dwordx4 v226, s[4:7], s46 offen sc1 lds
    buffer_load_dwordx4 v227, s[72:75], s46 offen offset:1024 sc1 lds
    s_sub_u32 s26, s48, s29
    s_mov_b32 s29, s48
    s_mov_b32 s30, s3
    s_cmp_lg_u32 s36, 0
    s_cselect_b32 s56, s33, 0
    v_mfma_f32_32x32x16_bf16 v[32:47], v[64:67], v[180:183], 0
    v_mfma_f32_32x32x16_bf16 v[48:63], v[68:71], v[180:183], 0
    s_setprio 0
    v_mul_f32 v242, v0, v144
    v_fma_f32 v238, v8, v160, -v238
    v_fmac_f32 v242, v1, v145
    v_fmac_f32 v238, v9, v161
    v_fmac_f32 v242, v2, v146
    v_fmac_f32 v238, v10, v162
    v_fmac_f32 v242, v3, v147
    v_fmac_f32 v238, v11, v163
    v_fmac_f32 v242, v4, v148
    v_fmac_f32 v238, v12, v164
    v_fmac_f32 v242, v5, v149
    v_fmac_f32 v238, v13, v165
    v_fmac_f32 v242, v6, v150
    v_fmac_f32 v238, v14, v166
    v_fmac_f32 v242, v7, v151
    v_fmac_f32 v238, v15, v167
    v_fmac_f32 v236, v16, v112
    v_mul_f32 v244, v24, v160
    v_fmac_f32 v236, v17, v113
    v_fmac_f32 v244, v25, v161
    v_fmac_f32 v236, v18, v114
    v_fmac_f32 v244, v26, v162
    v_fmac_f32 v236, v19, v115
    v_fmac_f32 v244, v27, v163
    v_fmac_f32 v236, v20, v116
    v_fmac_f32 v244, v28, v164
    v_fmac_f32 v236, v21, v117
    v_fmac_f32 v244, v29, v165
    v_fmac_f32 v236, v22, v118
    v_fmac_f32 v244, v30, v166
    v_fmac_f32 v236, v23, v119
    v_fmac_f32 v244, v31, v167
    v_mul_f32 v243, v32, v152
    v_fma_f32 v239, v40, v168, -v239
    v_fmac_f32 v243, v33, v153
    v_fmac_f32 v239, v41, v169
    v_fmac_f32 v243, v34, v154
    v_fmac_f32 v239, v42, v170
    v_fmac_f32 v243, v35, v155
    v_fmac_f32 v239, v43, v171
    v_fmac_f32 v243, v36, v156
    v_fmac_f32 v239, v44, v172
    v_fmac_f32 v243, v37, v157
    v_fmac_f32 v239, v45, v173
    v_fmac_f32 v243, v38, v158
    v_fmac_f32 v239, v46, v174
    v_fmac_f32 v243, v39, v159
    v_fmac_f32 v239, v47, v175
    v_fmac_f32 v237, v48, v120
    v_mul_f32 v245, v56, v168
    v_fmac_f32 v237, v49, v121
    v_fmac_f32 v245, v57, v169
    v_fmac_f32 v237, v50, v122
    v_fmac_f32 v245, v58, v170
    v_fmac_f32 v237, v51, v123
    v_fmac_f32 v245, v59, v171
    v_fmac_f32 v237, v52, v124
    v_fmac_f32 v245, v60, v172
    v_fmac_f32 v237, v53, v125
    v_fmac_f32 v245, v61, v173
    v_fmac_f32 v237, v54, v126
    v_fmac_f32 v245, v62, v174
    v_fmac_f32 v237, v55, v127
    v_fmac_f32 v245, v63, v175
    s_setprio 1
    s_waitcnt vmcnt(4) lgkmcnt(0)
    v_mfma_f32_32x32x16_bf16 v[0:15], v[64:67], v[184:187], 0
    ds_read_b64_tr_b16 v[176:177], v246 offset:0
    ds_read_b64_tr_b16 v[178:179], v246 offset:512
    ds_read_b64_tr_b16 v[180:181], v247 offset:0
    ds_read_b64_tr_b16 v[182:183], v247 offset:512
    s_mov_b32 m0, s71
    v_mfma_f32_32x32x16_bf16 v[16:31], v[68:71], v[184:187], 0
    buffer_load_dwordx4 v228, s[4:7], s47 offen sc1 lds
    buffer_load_dwordx4 v229, s[72:75], s47 offen offset:1024 sc1 lds
    v_permlane32_swap_b32 v242, v234
    v_permlane32_swap_b32 v243, v235
    v_add_f32 v242, v242, v234
    v_mfma_f32_32x32x16_bf16 v[32:47], v[64:67], v[188:191], 0
    v_add_f32 v243, v243, v235
    v_cvt_pk_bf16_f32 v242, v242, v243
    ds_write_b32 v230, v242 offset:512
    v_mfma_f32_32x32x16_bf16 v[48:63], v[68:71], v[188:191], 0
    s_setprio 0
    v_mul_f32 v242, v0, v144
    v_fma_f32 v240, v8, v160, -v240
    v_fmac_f32 v242, v1, v145
    v_fmac_f32 v240, v9, v161
    v_fmac_f32 v242, v2, v146
    v_fmac_f32 v240, v10, v162
    v_fmac_f32 v242, v3, v147
    v_fmac_f32 v240, v11, v163
    v_fmac_f32 v242, v4, v148
    v_fmac_f32 v240, v12, v164
    v_fmac_f32 v242, v5, v149
    v_fmac_f32 v240, v13, v165
    v_fmac_f32 v242, v6, v150
    v_fmac_f32 v240, v14, v166
    v_fmac_f32 v242, v7, v151
    v_fmac_f32 v240, v15, v167
    v_add_u32 v249, s26, v249
    v_add_u32 v250, s26, v250
    v_fma_f32 v244, v16, v160, -v244
    v_fmac_f32 v236, v24, v112
    v_fmac_f32 v244, v17, v161
    v_fmac_f32 v236, v25, v113
    v_fmac_f32 v244, v18, v162
    v_fmac_f32 v236, v26, v114
    v_fmac_f32 v244, v19, v163
    v_fmac_f32 v236, v27, v115
    v_fmac_f32 v244, v20, v164
    v_fmac_f32 v236, v28, v116
    v_fmac_f32 v244, v21, v165
    v_fmac_f32 v236, v29, v117
    v_fmac_f32 v244, v22, v166
    v_fmac_f32 v236, v30, v118
    v_fmac_f32 v244, v23, v167
    v_fmac_f32 v236, v31, v119
    ds_read_b64_tr_b16 v[0:1], v249 offset:0
    ds_read_b64_tr_b16 v[2:3], v249 offset:128
    ds_read_b128 v[4:7], v250 offset:0
    ds_read_b128 v[8:11], v250 offset:16
    ds_read_b128 v[12:15], v250 offset:384
    ds_read_b128 v[16:19], v250 offset:400
    v_mul_f32 v243, v32, v152
    v_fma_f32 v241, v40, v168, -v241
    v_fmac_f32 v243, v33, v153
    v_fmac_f32 v241, v41, v169
    v_fmac_f32 v243, v34, v154
    v_fmac_f32 v241, v42, v170
    v_fmac_f32 v243, v35, v155
    v_fmac_f32 v241, v43, v171
    v_fmac_f32 v243, v36, v156
    v_fmac_f32 v241, v44, v172
    v_fmac_f32 v243, v37, v157
    v_fmac_f32 v241, v45, v173
    v_fmac_f32 v243, v38, v158
    v_fmac_f32 v241, v46, v174
    v_fmac_f32 v243, v39, v159
    v_fmac_f32 v241, v47, v175
    ds_read_b64_tr_b16 v[20:21], v249 offset:512
    ds_read_b64_tr_b16 v[22:23], v249 offset:640
    ds_read_b128 v[24:27], v250 offset:64
    ds_read_b128 v[28:31], v250 offset:80
    ds_read_b128 v[32:35], v250 offset:448
    ds_read_b128 v[36:39], v250 offset:464
    v_fma_f32 v245, v48, v168, -v245
    v_fmac_f32 v237, v56, v120
    v_fmac_f32 v245, v49, v169
    v_fmac_f32 v237, v57, v121
    v_fmac_f32 v245, v50, v170
    v_fmac_f32 v237, v58, v122
    v_fmac_f32 v245, v51, v171
    v_fmac_f32 v237, v59, v123
    v_fmac_f32 v245, v52, v172
    v_fmac_f32 v237, v60, v124
    v_fmac_f32 v245, v53, v173
    v_fmac_f32 v237, v61, v125
    v_fmac_f32 v245, v54, v174
    v_fmac_f32 v237, v62, v126
    v_fmac_f32 v245, v55, v175
    v_fmac_f32 v237, v63, v127
    s_cmp_eq_u32 s56, 2
    s_cbranch_scc1 K2_U21
    s_cmp_eq_u32 s56, 3
    s_cbranch_scc1 K2_U31
    s_branch K2_DSP1
K2_U41:
    s_setprio 1
    s_waitcnt lgkmcnt(6)
    v_lshlrev_b32 v40, 16, v0
    v_and_b32 v41, 0xffff0000, v0
    v_lshlrev_b32 v42, 16, v1
    v_and_b32 v43, 0xffff0000, v1
    v_lshlrev_b32 v44, 16, v2
    v_and_b32 v45, 0xffff0000, v2
    v_lshlrev_b32 v46, 16, v3
    v_and_b32 v47, 0xffff0000, v3
    v_mul_f32 v4, v40, v4
    v_mul_f32 v5, v41, v5
    v_mul_f32 v6, v42, v6
    v_mul_f32 v7, v43, v7
    v_mul_f32 v8, v44, v8
    v_mul_f32 v9, v45, v9
    v_mul_f32 v10, v46, v10
    v_mul_f32 v11, v47, v11
    v_cvt_pk_bf16_f32 v64, v4, v5
    v_cvt_pk_bf16_f32 v65, v6, v7
    v_cvt_pk_bf16_f32 v66, v8, v9
    v_cvt_pk_bf16_f32 v67, v10, v11
    v_mul_f32 v12, v40, v12
    v_mul_f32 v13, v41, v13
    v_mul_f32 v14, v42, v14
    v_mul_f32 v15, v43, v15
    v_mul_f32 v16, v44, v16
    v_mul_f32 v17, v45, v17
    v_mul_f32 v18, v46, v18
    v_mul_f32 v19, v47, v19
    v_cvt_pk_bf16_f32 v68, v12, v13
    v_cvt_pk_bf16_f32 v69, v14, v15
    v_cvt_pk_bf16_f32 v70, v16, v17
    v_cvt_pk_bf16_f32 v71, v18, v19
    ds_read_b64_tr_b16 v[0:1], v249 offset:1024
    ds_read_b64_tr_b16 v[2:3], v249 offset:1152
    ds_read_b128 v[4:7], v250 offset:128
    ds_read_b128 v[8:11], v250 offset:144
    ds_read_b128 v[12:15], v250 offset:512
    ds_read_b128 v[16:19], v250 offset:528
    s_waitcnt lgkmcnt(6)
    v_lshlrev_b32 v48, 16, v20
    v_and_b32 v49, 0xffff0000, v20
    v_lshlrev_b32 v50, 16, v21
    v_and_b32 v51, 0xffff0000, v21
    v_lshlrev_b32 v52, 16, v22
    v_and_b32 v53, 0xffff0000, v22
    v_lshlrev_b32 v54, 16, v23
    v_and_b32 v55, 0xffff0000, v23
    v_mul_f32 v24, v48, v24
    v_mul_f32 v25, v49, v25
    v_mul_f32 v26, v50, v26
    v_mul_f32 v27, v51, v27
    v_mul_f32 v28, v52, v28
    v_mul_f32 v29, v53, v29
    v_mul_f32 v30, v54, v30
    v_mul_f32 v31, v55, v31
    v_cvt_pk_bf16_f32 v72, v24, v25
    v_cvt_pk_bf16_f32 v73, v26, v27
    v_cvt_pk_bf16_f32 v74, v28, v29
    v_cvt_pk_bf16_f32 v75, v30, v31
    v_mul_f32 v32, v48, v32
    v_mul_f32 v33, v49, v33
    v_mul_f32 v34, v50, v34
    v_mul_f32 v35, v51, v35
    v_mul_f32 v36, v52, v36
    v_mul_f32 v37, v53, v37
    v_mul_f32 v38, v54, v38
    v_mul_f32 v39, v55, v39
    v_cvt_pk_bf16_f32 v76, v32, v33
    v_cvt_pk_bf16_f32 v77, v34, v35
    v_cvt_pk_bf16_f32 v78, v36, v37
    v_cvt_pk_bf16_f32 v79, v38, v39
    s_lshr_b32 s65, s30, 27
    s_mov_b32 s66, 161536
    s_cmp_ge_u32 s65, 2
    s_cselect_b32 s66, 158112, s66
    s_mul_i32 s65, s65, 512
    s_add_u32 s65, s65, s66
    s_sub_u32 s65, s65, s29
    v_add_u32 v56, s65, v249
    s_lshr_b32 s65, s30, 27
    s_mov_b32 s66, 161536
    s_cmp_ge_u32 s65, 2
    s_cselect_b32 s66, 159008, s66
    s_mul_i32 s65, s65, 64
    s_add_u32 s65, s65, s66
    s_sub_u32 s65, s65, s29
    v_add_u32 v57, s65, v250
    ds_read_b64_tr_b16 v[20:21], v56 offset:0
    ds_read_b64_tr_b16 v[22:23], v56 offset:128
    ds_read_b128 v[24:27], v57 offset:0
    ds_read_b128 v[28:31], v57 offset:16
    ds_read_b128 v[32:35], v57 offset:384
    ds_read_b128 v[36:39], v57 offset:400
    s_waitcnt lgkmcnt(10)
    v_lshlrev_b32 v40, 16, v0
    v_and_b32 v41, 0xffff0000, v0
    v_lshlrev_b32 v42, 16, v1
    v_and_b32 v43, 0xffff0000, v1
    v_lshlrev_b32 v44, 16, v2
    v_and_b32 v45, 0xffff0000, v2
    v_lshlrev_b32 v46, 16, v3
    v_and_b32 v47, 0xffff0000, v3
    s_waitcnt lgkmcnt(8)
    v_mul_f32 v4, v40, v4
    v_mul_f32 v5, v41, v5
    v_mul_f32 v6, v42, v6
    v_mul_f32 v7, v43, v7
    v_mul_f32 v8, v44, v8
    v_mul_f32 v9, v45, v9
    v_mul_f32 v10, v46, v10
    v_mul_f32 v11, v47, v11
    v_cvt_pk_bf16_f32 v80, v4, v5
    v_cvt_pk_bf16_f32 v81, v6, v7
    v_cvt_pk_bf16_f32 v82, v8, v9
    v_cvt_pk_bf16_f32 v83, v10, v11
    s_waitcnt lgkmcnt(6)
    v_mul_f32 v12, v40, v12
    v_mul_f32 v13, v41, v13
    v_mul_f32 v14, v42, v14
    v_mul_f32 v15, v43, v15
    v_mul_f32 v16, v44, v16
    v_mul_f32 v17, v45, v17
    v_mul_f32 v18, v46, v18
    v_mul_f32 v19, v47, v19
    v_cvt_pk_bf16_f32 v84, v12, v13
    v_cvt_pk_bf16_f32 v85, v14, v15
    v_cvt_pk_bf16_f32 v86, v16, v17
    v_cvt_pk_bf16_f32 v87, v18, v19
    s_waitcnt lgkmcnt(4)
    v_lshlrev_b32 v48, 16, v20
    v_and_b32 v49, 0xffff0000, v20
    v_lshlrev_b32 v50, 16, v21
    v_and_b32 v51, 0xffff0000, v21
    v_lshlrev_b32 v52, 16, v22
    v_and_b32 v53, 0xffff0000, v22
    v_lshlrev_b32 v54, 16, v23
    v_and_b32 v55, 0xffff0000, v23
    s_waitcnt lgkmcnt(2)
    v_mul_f32 v24, v48, v24
    v_mul_f32 v25, v49, v25
    v_mul_f32 v26, v50, v26
    v_mul_f32 v27, v51, v27
    v_mul_f32 v28, v52, v28
    v_mul_f32 v29, v53, v29
    v_mul_f32 v30, v54, v30
    v_mul_f32 v31, v55, v31
    v_cvt_pk_bf16_f32 v88, v24, v25
    v_cvt_pk_bf16_f32 v89, v26, v27
    v_cvt_pk_bf16_f32 v90, v28, v29
    v_cvt_pk_bf16_f32 v91, v30, v31
    s_waitcnt lgkmcnt(0)
    v_mul_f32 v32, v48, v32
    v_mul_f32 v33, v49, v33
    v_mul_f32 v34, v50, v34
    v_mul_f32 v35, v51, v35
    v_mul_f32 v36, v52, v36
    v_mul_f32 v37, v53, v37
    v_mul_f32 v38, v54, v38
    v_mul_f32 v39, v55, v39
    v_cvt_pk_bf16_f32 v92, v32, v33
    v_cvt_pk_bf16_f32 v93, v34, v35
    v_cvt_pk_bf16_f32 v94, v36, v37
    v_cvt_pk_bf16_f32 v95, v38, v39
    s_waitcnt vmcnt(4)
    v_mfma_f32_32x32x16_bf16 v[0:15], v[64:67], v[176:179], 0
    ds_read_b64_tr_b16 v[184:185], v246 offset:2048
    ds_read_b64_tr_b16 v[186:187], v246 offset:2560
    ds_read_b64_tr_b16 v[188:189], v247 offset:2048
    ds_read_b64_tr_b16 v[190:191], v247 offset:2560
    s_mov_b32 m0, s68
    v_mfma_f32_32x32x16_bf16 v[16:31], v[68:71], v[176:179], 0
    buffer_load_dwordx4 v222, s[4:7], s41 offen sc1 lds
    buffer_load_dwordx4 v223, s[72:75], s41 offen offset:1024 sc1 lds
    v_permlane32_swap_b32 v242, v236
    v_permlane32_swap_b32 v243, v237
    v_mov_b32 v254, 163648
    v_mfma_f32_32x32x16_bf16 v[32:47], v[64:67], v[180:183], 0
    v_permlane32_swap_b32 v244, v238
    v_permlane32_swap_b32 v245, v239
    v_permlane32_swap_b32 v240, v241
    v_add_f32 v242, v242, v236
    v_mfma_f32_32x32x16_bf16 v[48:63], v[68:71], v[180:183], 0
    v_add_f32 v243, v243, v237
    v_add_f32 v244, v244, v238
    v_add_f32 v245, v245, v239
    v_add_f32 v240, -v240, -v241
    v_sub_u32 v241, v230, v231
    v_cvt_pk_bf16_f32 v242, v242, v243
    v_mov_b32 v255, 1
    v_lshl_add_u32 v233, v252, 1, s53
    s_mov_b64 exec, 1
    ds_add_rtn_u32 v232, v254, v255
    s_mov_b64 exec, -1
    ds_read_b32 v233, v233
    s_waitcnt vmcnt(4) lgkmcnt(2)
    v_mfma_f32_32x32x16_bf16 v[0:15], v[72:75], v[184:187], v[0:15]
    ds_read_b64_tr_b16 v[176:177], v246 offset:4096
    ds_read_b64_tr_b16 v[178:179], v246 offset:4608
    ds_read_b64_tr_b16 v[180:181], v247 offset:4096
    ds_read_b64_tr_b16 v[182:183], v247 offset:4608
    v_cvt_pk_bf16_f32 v244, v244, v245
    v_cvt_pk_bf16_f32 v240, v240, v240
    s_mov_b32 m0, s69
    v_mfma_f32_32x32x16_bf16 v[16:31], v[76:79], v[184:187], v[16:31]
    buffer_load_dwordx4 v224, s[4:7], s41 offen sc1 lds
    buffer_load_dwordx4 v225, s[72:75], s41 offen offset:1024 sc1 lds
    ds_write_b32 v230, v242 offset:768
    ds_write_b32 v230, v244 offset:1024
    ds_write_b16 v241, v240 offset:1280
    s_waitcnt lgkmcnt(7)
    v_readfirstlane_b32 s58, v232
    v_mfma_f32_32x32x16_bf16 v[32:47], v[72:75], v[188:191], v[32:47]
    s_cmp_lt_u32 s58, s22
    s_cbranch_scc0 K2_nul_81
    s_and_b32 s59, s58, 7
    s_lshr_b32 s60, s58, 3
K2_chk_83:
    v_readlane_b32 s61, v233, s59
    s_nop 0
    s_cmp_gt_u32 s61, s60
    s_cbranch_scc0 K2_spin_82
K2_back_84:
    v_mfma_f32_32x32x16_bf16 v[48:63], v[76:79], v[188:191], v[48:63]
    v_readlane_b32 s3, v253, s58
    s_lshl_b32 s44, s34, 7
    s_lshl_b32 s60, s58, 5
    s_and_b32 s48, s3, 0x3ffff
    s_bfe_u32 s33, s3, 0x30012
    s_sub_u32 s60, s60, s48
    s_waitcnt vmcnt(4) lgkmcnt(3)
    v_mfma_f32_32x32x16_bf16 v[0:15], v[80:83], v[176:179], v[0:15]
    ds_read_b64_tr_b16 v[184:185], v246 offset:6144
    ds_read_b64_tr_b16 v[186:187], v246 offset:6656
    ds_read_b64_tr_b16 v[188:189], v247 offset:6144
    ds_read_b64_tr_b16 v[190:191], v247 offset:6656
    s_and_b32 s60, s60, 0xff
    s_add_u32 s35, s60, s48
    s_mov_b32 m0, s70
    v_mfma_f32_32x32x16_bf16 v[16:31], v[84:87], v[176:179], v[16:31]
    buffer_load_dwordx4 v226, s[4:7], s41 offen sc1 lds
    buffer_load_dwordx4 v227, s[72:75], s41 offen offset:1024 sc1 lds
    s_mov_b32 s45, s44
    s_add_u32 s47, s44, 256
    s_add_u32 s49, s48, 32
    s_add_u32 s60, s48, 64
    v_mfma_f32_32x32x16_bf16 v[32:47], v[80:83], v[180:183], v[32:47]
    s_cmp_eq_u32 s33, 3
    s_cselect_b32 s46, s44, s47
    s_cselect_b32 s50, s60, s48
    s_cselect_b32 s51, s48, s49
    s_sub_u32 s60, s33, 2
    s_cmp_lt_u32 s60, 2
    s_cbranch_scc0 K2_rare_85
K2_back_86:
    v_mfma_f32_32x32x16_bf16 v[48:63], v[84:87], v[180:183], v[48:63]
    s_waitcnt vmcnt(4) lgkmcnt(0)
    v_mfma_f32_32x32x16_bf16 v[0:15], v[88:91], v[184:187], v[0:15]
    ds_read_b64_tr_b16 v[176:177], v246 offset:0
    ds_read_b64_tr_b16 v[178:179], v246 offset:512
    ds_read_b64_tr_b16 v[180:181], v247 offset:0
    ds_read_b64_tr_b16 v[182:183], v247 offset:512
    s_mov_b32 m0, s71
    v_mfma_f32_32x32x16_bf16 v[16:31], v[92:95], v[184:187], v[16:31]
    buffer_load_dwordx4 v228, s[4:7], s41 offen sc1 lds
    buffer_load_dwordx4 v229, s[72:75], s41 offen offset:1024 sc1 lds
    v_mfma_f32_32x32x16_bf16 v[32:47], v[88:91], v[188:191], v[32:47]
    s_nop 2
    v_mul_f32 v234, v0, v96
    v_mul_f32 v236, v8, v128
    v_fmac_f32 v234, v1, v97
    v_fmac_f32 v236, v9, v129
    v_fmac_f32 v234, v2, v98
    v_fmac_f32 v236, v10, v130
    v_fmac_f32 v234, v3, v99
    v_mfma_f32_32x32x16_bf16 v[48:63], v[92:95], v[188:191], v[48:63]
    s_setprio 0
    v_fmac_f32 v236, v11, v131
    v_fmac_f32 v234, v4, v100
    v_fmac_f32 v236, v12, v132
    v_fmac_f32 v234, v5, v101
    v_fmac_f32 v236, v13, v133
    v_fmac_f32 v234, v6, v102
    v_fmac_f32 v236, v14, v134
    v_fmac_f32 v234, v7, v103
    v_fmac_f32 v236, v15, v135
    v_mul_f32 v238, v16, v128
    v_mul_f32 v240, v24, v128
    v_fmac_f32 v238, v17, v129
    v_fmac_f32 v240, v25, v129
    v_fmac_f32 v238, v18, v130
    v_fmac_f32 v240, v26, v130
    v_fmac_f32 v238, v19, v131
    v_fmac_f32 v240, v27, v131
    v_fmac_f32 v238, v20, v132
    v_fmac_f32 v240, v28, v132
    v_fmac_f32 v238, v21, v133
    v_fmac_f32 v240, v29, v133
    v_fmac_f32 v238, v22, v134
    v_fmac_f32 v240, v30, v134
    v_fmac_f32 v238, v23, v135
    v_fmac_f32 v240, v31, v135
    v_mul_f32 v235, v32, v104
    v_mul_f32 v237, v40, v136
    v_fmac_f32 v235, v33, v105
    v_fmac_f32 v237, v41, v137
    v_fmac_f32 v235, v34, v106
    v_fmac_f32 v237, v42, v138
    v_fmac_f32 v235, v35, v107
    v_fmac_f32 v237, v43, v139
    v_fmac_f32 v235, v36, v108
    v_fmac_f32 v237, v44, v140
    v_fmac_f32 v235, v37, v109
    v_fmac_f32 v237, v45, v141
    v_fmac_f32 v235, v38, v110
    v_fmac_f32 v237, v46, v142
    v_fmac_f32 v235, v39, v111
    v_fmac_f32 v237, v47, v143
    v_mul_f32 v239, v48, v136
    v_mul_f32 v241, v56, v136
    s_setprio 1
    s_waitcnt vmcnt(4) lgkmcnt(0)
    v_mfma_f32_32x32x16_bf16 v[0:15], v[64:67], v[176:179], 0
    ds_read_b64_tr_b16 v[184:185], v246 offset:2048
    ds_read_b64_tr_b16 v[186:187], v246 offset:2560
    ds_read_b64_tr_b16 v[188:189], v247 offset:2048
    ds_read_b64_tr_b16 v[190:191], v247 offset:2560
    v_fmac_f32 v239, v49, v137
    v_fmac_f32 v241, v57, v137
    s_mov_b32 m0, s68
    v_mfma_f32_32x32x16_bf16 v[16:31], v[68:71], v[176:179], 0
    buffer_load_dwordx4 v222, s[4:7], s42 offen sc1 lds
    buffer_load_dwordx4 v223, s[72:75], s42 offen offset:1024 sc1 lds
    v_fmac_f32 v239, v50, v138
    v_fmac_f32 v241, v58, v138
    v_fmac_f32 v239, v51, v139
    v_fmac_f32 v241, v59, v139
    v_fmac_f32 v239, v52, v140
    v_mfma_f32_32x32x16_bf16 v[32:47], v[64:67], v[180:183], 0
    v_fmac_f32 v241, v60, v140
    v_fmac_f32 v239, v53, v141
    v_fmac_f32 v241, v61, v141
    v_fmac_f32 v239, v54, v142
    v_fmac_f32 v241, v62, v142
    v_fmac_f32 v239, v55, v143
    v_fmac_f32 v241, v63, v143
    v_mfma_f32_32x32x16_bf16 v[48:63], v[68:71], v[180:183], 0
    v_permlane32_swap_b32 v234, v236
    v_permlane32_swap_b32 v235, v237
    v_permlane32_swap_b32 v240, v238
    s_waitcnt vmcnt(4) lgkmcnt(0)
    v_mfma_f32_32x32x16_bf16 v[0:15], v[72:75], v[184:187], v[0:15]
    ds_read_b64_tr_b16 v[176:177], v246 offset:4096
    ds_read_b64_tr_b16 v[178:179], v246 offset:4608
    ds_read_b64_tr_b16 v[180:181], v247 offset:4096
    ds_read_b64_tr_b16 v[182:183], v247 offset:4608
    v_permlane32_swap_b32 v241, v239
    s_mov_b32 m0, s69
    v_mfma_f32_32x32x16_bf16 v[16:31], v[76:79], v[184:187], v[16:31]
    buffer_load_dwordx4 v224, s[4:7], s42 offen sc1 lds
    buffer_load_dwordx4 v225, s[72:75], s42 offen offset:1024 sc1 lds
    v_lshl_add_u32 v230, v252, 1, s31
    v_add_f32 v234, v234, v236
    v_add_f32 v235, v235, v237
    v_add_f32 v240, v240, v238
    v_add_f32 v241, v241, v239
    v_mfma_f32_32x32x16_bf16 v[32:47], v[72:75], v[188:191], v[32:47]
    v_cvt_pk_bf16_f32 v234, v234, v235
    v_cvt_pk_bf16_f32 v240, v240, v241
    ds_write_b32 v230, v234 offset:0
    ds_write_b32 v230, v240 offset:256
    v_mfma_f32_32x32x16_bf16 v[48:63], v[76:79], v[188:191], v[48:63]
    s_waitcnt vmcnt(4) lgkmcnt(2)
    v_mfma_f32_32x32x16_bf16 v[0:15], v[80:83], v[176:179], v[0:15]
    ds_read_b64_tr_b16 v[184:185], v246 offset:6144
    ds_read_b64_tr_b16 v[186:187], v246 offset:6656
    ds_read_b64_tr_b16 v[188:189], v247 offset:6144
    ds_read_b64_tr_b16 v[190:191], v247 offset:6656
    s_mov_b32 m0, s70
    v_mfma_f32_32x32x16_bf16 v[16:31], v[84:87], v[176:179], v[16:31]
    buffer_load_dwordx4 v226, s[4:7], s42 offen sc1 lds
    buffer_load_dwordx4 v227, s[72:75], s42 offen offset:1024 sc1 lds
    v_mfma_f32_32x32x16_bf16 v[32:47], v[80:83], v[180:183], v[32:47]
    v_mfma_f32_32x32x16_bf16 v[48:63], v[84:87], v[180:183], v[48:63]
    s_waitcnt vmcnt(4) lgkmcnt(0)
    v_mfma_f32_32x32x16_bf16 v[0:15], v[88:91], v[184:187], v[0:15]
    ds_read_b64_tr_b16 v[176:177], v246 offset:0
    ds_read_b64_tr_b16 v[178:179], v246 offset:512
    ds_read_b64_tr_b16 v[180:181], v247 offset:0
    ds_read_b64_tr_b16 v[182:183], v247 offset:512
    s_mov_b32 m0, s71
    v_mfma_f32_32x32x16_bf16 v[16:31], v[92:95], v[184:187], v[16:31]
    buffer_load_dwordx4 v228, s[4:7], s42 offen sc1 lds
    buffer_load_dwordx4 v229, s[72:75], s42 offen offset:1024 sc1 lds
    v_mfma_f32_32x32x16_bf16 v[32:47], v[88:91], v[188:191], v[32:47]
    s_nop 2
    v_mul_f32 v234, v0, v144
    v_mul_f32 v236, v8, v112
    v_fmac_f32 v234, v1, v145
    v_fmac_f32 v236, v9, v113
    v_fmac_f32 v234, v2, v146
    v_fmac_f32 v236, v10, v114
    v_fmac_f32 v234, v3, v147
    v_mfma_f32_32x32x16_bf16 v[48:63], v[92:95], v[188:191], v[48:63]
    s_setprio 0
    v_fmac_f32 v236, v11, v115
    v_fmac_f32 v234, v4, v148
    v_fmac_f32 v236, v12, v116
    v_fmac_f32 v234, v5, v149
    v_fmac_f32 v236, v13, v117
    v_fmac_f32 v234, v6, v150
    v_fmac_f32 v236, v14, v118
    v_fmac_f32 v234, v7, v151
    v_fmac_f32 v236, v15, v119
    v_mul_f32 v238, v16, v160
    v_mul_f32 v240, v24, v160
    v_fmac_f32 v238, v17, v161
    v_fmac_f32 v240, v25, v161
    v_fmac_f32 v238, v18, v162
    v_fmac_f32 v240, v26, v162
    v_fmac_f32 v238, v19, v163
    v_fmac_f32 v240, v27, v163
    v_fmac_f32 v238, v20, v164
    v_fmac_f32 v240, v28, v164
    v_fmac_f32 v238, v21, v165
    v_fmac_f32 v240, v29, v165
    v_fmac_f32 v238, v22, v166
    v_fmac_f32 v240, v30, v166
    v_fmac_f32 v238, v23, v167
    v_fmac_f32 v240, v31, v167
    v_mul_f32 v235, v32, v152
    v_mul_f32 v237, v40, v120
    v_fmac_f32 v235, v33, v153
    v_fmac_f32 v237, v41, v121
    v_fmac_f32 v235, v34, v154
    v_fmac_f32 v237, v42, v122
    v_fmac_f32 v235, v35, v155
    v_fmac_f32 v237, v43, v123
    v_fmac_f32 v235, v36, v156
    v_fmac_f32 v237, v44, v124
    v_fmac_f32 v235, v37, v157
    v_fmac_f32 v237, v45, v125
    v_fmac_f32 v235, v38, v158
    v_fmac_f32 v237, v46, v126
    v_fmac_f32 v235, v39, v159
    v_fmac_f32 v237, v47, v127
    v_mul_f32 v239, v48, v168
    v_mul_f32 v241, v56, v168
    s_setprio 1
    s_waitcnt vmcnt(4) lgkmcnt(0)
    v_mfma_f32_32x32x16_bf16 v[0:15], v[64:67], v[176:179], 0
    ds_read_b64_tr_b16 v[184:185], v246 offset:2048
    ds_read_b64_tr_b16 v[186:187], v246 offset:2560
    ds_read_b64_tr_b16 v[188:189], v247 offset:2048
    ds_read_b64_tr_b16 v[190:191], v247 offset:2560
    v_fmac_f32 v239, v49, v169
    v_fmac_f32 v241, v57, v169
    s_mov_b32 m0, s68
    v_mfma_f32_32x32x16_bf16 v[16:31], v[68:71], v[176:179], 0
    buffer_load_dwordx4 v222, s[4:7], s43 offen sc1 lds
    buffer_load_dwordx4 v223, s[72:75], s43 offen offset:1024 sc1 lds
    v_fmac_f32 v239, v50, v170
    v_fmac_f32 v241, v58, v170
    v_fmac_f32 v239, v51, v171
    v_fmac_f32 v241, v59, v171
    v_fmac_f32 v239, v52, v172
    v_mfma_f32_32x32x16_bf16 v[32:47], v[64:67], v[180:183], 0
    v_fmac_f32 v241, v60, v172
    v_fmac_f32 v239, v53, v173
    v_fmac_f32 v241, v61, v173
    v_fmac_f32 v239, v54, v174
    v_fmac_f32 v241, v62, v174
    v_fmac_f32 v239, v55, v175
    v_fmac_f32 v241, v63, v175
    v_mfma_f32_32x32x16_bf16 v[48:63], v[68:71], v[180:183], 0
    s_waitcnt vmcnt(4) lgkmcnt(0)
    v_mfma_f32_32x32x16_bf16 v[0:15], v[72:75], v[184:187], v[0:15]
    ds_read_b64_tr_b16 v[176:177], v246 offset:4096
    ds_read_b64_tr_b16 v[178:179], v246 offset:4608
    ds_read_b64_tr_b16 v[180:181], v247 offset:4096
    ds_read_b64_tr_b16 v[182:183], v247 offset:4608
    s_mov_b32 m0, s69
    v_mfma_f32_32x32x16_bf16 v[16:31], v[76:79], v[184:187], v[16:31]
    buffer_load_dwordx4 v224, s[4:7], s43 offen sc1 lds
    buffer_load_dwordx4 v225, s[72:75], s43 offen offset:1024 sc1 lds
    v_mfma_f32_32x32x16_bf16 v[32:47], v[72:75], v[188:191], v[32:47]
    v_mfma_f32_32x32x16_bf16 v[48:63], v[76:79], v[188:191], v[48:63]
    s_waitcnt vmcnt(4) lgkmcnt(0)
    v_mfma_f32_32x32x16_bf16 v[0:15], v[80:83], v[176:179], v[0:15]
    ds_read_b64_tr_b16 v[184:185], v246 offset:6144
    ds_read_b64_tr_b16 v[186:187], v246 offset:6656
    ds_read_b64_tr_b16 v[188:189], v247 offset:6144
    ds_read_b64_tr_b16 v[190:191], v247 offset:6656
    s_mov_b32 m0, s70
    v_mfma_f32_32x32x16_bf16 v[16:31], v[84:87], v[176:179], v[16:31]
    buffer_load_dwordx4 v226, s[4:7], s43 offen sc1 lds
    buffer_load_dwordx4 v227, s[72:75], s43 offen offset:1024 sc1 lds
    v_mfma_f32_32x32x16_bf16 v[32:47], v[80:83], v[180:183], v[32:47]
    v_add_u32 v222, s48, v251
    ds_read_b32 v222, v222
    v_mfma_f32_32x32x16_bf16 v[48:63], v[84:87], v[180:183], v[48:63]
    s_waitcnt vmcnt(4) lgkmcnt(1)
    v_mfma_f32_32x32x16_bf16 v[0:15], v[88:91], v[184:187], v[0:15]
    ds_read_b64_tr_b16 v[176:177], v246 offset:0
    ds_read_b64_tr_b16 v[178:179], v246 offset:512
    ds_read_b64_tr_b16 v[180:181], v247 offset:0
    ds_read_b64_tr_b16 v[182:183], v247 offset:512
    s_mov_b32 m0, s71
    v_mfma_f32_32x32x16_bf16 v[16:31], v[92:95], v[184:187], v[16:31]
    buffer_load_dwordx4 v228, s[4:7], s43 offen sc1 lds
    buffer_load_dwordx4 v229, s[72:75], s43 offen offset:1024 sc1 lds
    s_waitcnt lgkmcnt(4)
    v_mad_u32_u16 v223, v222, s39, v248 op_sel:[1,0,0,0]
    v_mad_u32_u16 v222, v222, s39, v248
    v_mfma_f32_32x32x16_bf16 v[32:47], v[88:91], v[188:191], v[32:47]
    v_add_u32 v224, s49, v251
    ds_read_b32 v224, v224
    v_mul_f32 v242, v0, v144
    v_fma_f32 v238, v8, v160, -v238
    v_fmac_f32 v242, v1, v145
    v_fmac_f32 v238, v9, v161
    v_fmac_f32 v242, v2, v146
    v_mfma_f32_32x32x16_bf16 v[48:63], v[92:95], v[188:191], v[48:63]
    s_setprio 0
    v_fmac_f32 v238, v10, v162
    v_fmac_f32 v242, v3, v147
    v_fmac_f32 v238, v11, v163
    v_fmac_f32 v242, v4, v148
    v_fmac_f32 v238, v12, v164
    v_fmac_f32 v242, v5, v149
    v_fmac_f32 v238, v13, v165
    v_fmac_f32 v242, v6, v150
    v_fmac_f32 v238, v14, v166
    v_fmac_f32 v242, v7, v151
    v_fmac_f32 v238, v15, v167
    v_fmac_f32 v236, v16, v112
    v_mul_f32 v244, v24, v160
    v_fmac_f32 v236, v17, v113
    v_fmac_f32 v244, v25, v161
    v_fmac_f32 v236, v18, v114
    v_fmac_f32 v244, v26, v162
    v_fmac_f32 v236, v19, v115
    v_fmac_f32 v244, v27, v163
    v_fmac_f32 v236, v20, v116
    v_fmac_f32 v244, v28, v164
    v_fmac_f32 v236, v21, v117
    v_fmac_f32 v244, v29, v165
    v_fmac_f32 v236, v22, v118
    v_fmac_f32 v244, v30, v166
    v_fmac_f32 v236, v23, v119
    v_fmac_f32 v244, v31, v167
    v_mul_f32 v243, v32, v152
    v_fma_f32 v239, v40, v168, -v239
    v_fmac_f32 v243, v33, v153
    v_fmac_f32 v239, v41, v169
    v_fmac_f32 v243, v34, v154
    v_fmac_f32 v239, v42, v170
    v_fmac_f32 v243, v35, v155
    v_fmac_f32 v239, v43, v171
    v_fmac_f32 v243, v36, v156
    v_fmac_f32 v239, v44, v172
    v_fmac_f32 v243, v37, v157
    v_fmac_f32 v239, v45, v173
    v_fmac_f32 v243, v38, v158
    v_fmac_f32 v239, v46, v174
    v_fmac_f32 v243, v39, v159
    v_fmac_f32 v239, v47, v175
    v_fmac_f32 v237, v48, v120
    v_mul_f32 v245, v56, v168
    v_fmac_f32 v237, v49, v121
    v_fmac_f32 v245, v57, v169
    v_fmac_f32 v237, v50, v122
    v_fmac_f32 v245, v58, v170
    v_fmac_f32 v237, v51, v123
    s_setprio 1
    s_waitcnt vmcnt(4) lgkmcnt(1)
    v_mfma_f32_32x32x16_bf16 v[0:15], v[64:67], v[176:179], 0
    ds_read_b64_tr_b16 v[184:185], v246 offset:2048
    ds_read_b64_tr_b16 v[186:187], v246 offset:2560
    ds_read_b64_tr_b16 v[188:189], v247 offset:2048
    ds_read_b64_tr_b16 v[190:191], v247 offset:2560
    v_fmac_f32 v245, v59, v171
    v_fmac_f32 v237, v52, v124
    s_mov_b32 m0, s68
    v_mfma_f32_32x32x16_bf16 v[16:31], v[68:71], v[176:179], 0
    buffer_load_dwordx4 v222, s[4:7], s44 offen sc1 lds
    buffer_load_dwordx4 v223, s[72:75], s44 offen offset:1024 sc1 lds
    s_waitcnt lgkmcnt(4)
    v_mad_u32_u16 v225, v224, s39, v248 op_sel:[1,0,0,0]
    v_mad_u32_u16 v224, v224, s39, v248
    v_fmac_f32 v245, v60, v172
    v_fmac_f32 v237, v53, v125
    v_mfma_f32_32x32x16_bf16 v[32:47], v[64:67], v[180:183], 0
    v_add_u32 v226, s50, v251
    ds_read_b32 v226, v226
    v_fmac_f32 v245, v61, v173
    v_fmac_f32 v237, v54, v126
    v_fmac_f32 v245, v62, v174
    v_fmac_f32 v237, v55, v127
    v_fmac_f32 v245, v63, v175
    v_mfma_f32_32x32x16_bf16 v[48:63], v[68:71], v[180:183], 0
    v_permlane32_swap_b32 v242, v234
    v_permlane32_swap_b32 v243, v235
    v_add_f32 v242, v242, v234
    v_add_f32 v243, v243, v235
    s_waitcnt vmcnt(4) lgkmcnt(1)
    v_mfma_f32_32x32x16_bf16 v[0:15], v[72:75], v[184:187], v[0:15]
    ds_read_b64_tr_b16 v[176:177], v246 offset:4096
    ds_read_b64_tr_b16 v[178:179], v246 offset:4608
    ds_read_b64_tr_b16 v[180:181], v247 offset:4096
    ds_read_b64_tr_b16 v[182:183], v247 offset:4608
    v_cvt_pk_bf16_f32 v242, v242, v243
    ds_write_b32 v230, v242 offset:512
    s_mov_b32 m0, s69
    v_mfma_f32_32x32x16_bf16 v[16:31], v[76:79], v[184:187], v[16:31]
    buffer_load_dwordx4 v224, s[4:7], s45 offen sc1 lds
    buffer_load_dwordx4 v225, s[72:75], s45 offen offset:1024 sc1 lds
    s_waitcnt lgkmcnt(5)
    v_mad_u32_u16 v227, v226, s39, v248 op_sel:[1,0,0,0]
    v_mad_u32_u16 v226, v226, s39, v248
    v_mfma_f32_32x32x16_bf16 v[32:47], v[72:75], v[188:191], v[32:47]
    v_add_u32 v228, s51, v251
    ds_read_b32 v228, v228
    v_mfma_f32_32x32x16_bf16 v[48:63], v[76:79], v[188:191], v[48:63]
    s_waitcnt vmcnt(4) lgkmcnt(2)
    v_mfma_f32_32x32x16_bf16 v[0:15], v[80:83], v[176:179], v[0:15]
    ds_read_b64_tr_b16 v[184:185], v246 offset:6144
    ds_read_b64_tr_b16 v[186:187], v246 offset:6656
    ds_read_b64_tr_b16 v[188:189], v247 offset:6144
    ds_read_b64_tr_b16 v[190:191], v247 offset:6656
    s_mov_b32 s32, s31
    s_mov_b32 s31, s35
    s_mov_b32 m0, s70
    v_mfma_f32_32x32x16_bf16 v[16:31], v[84:87], v[176:179], v[16:31]
    buffer_load_dwordx4 v226, s[4:7], s46 offen sc1 lds
    buffer_load_dwordx4 v227, s[72:75], s46 offen offset:1024 sc1 lds
    s_waitcnt lgkmcnt(4)
    v_mad_u32_u16 v229, v228, s39, v248 op_sel:[1,0,0,0]
    v_mad_u32_u16 v228, v228, s39, v248
    s_sub_u32 s26, s48, s29
    s_mov_b32 s29, s48
    v_mfma_f32_32x32x16_bf16 v[32:47], v[80:83], v[180:183], v[32:47]
    s_mov_b32 s30, s3
    s_cmp_lg_u32 s36, 0
    s_cselect_b32 s56, s33, 0
    v_mfma_f32_32x32x16_bf16 v[48:63], v[84:87], v[180:183], v[48:63]
    s_waitcnt vmcnt(4) lgkmcnt(0)
    v_mfma_f32_32x32x16_bf16 v[0:15], v[88:91], v[184:187], v[0:15]
    ds_read_b64_tr_b16 v[176:177], v246 offset:0
    ds_read_b64_tr_b16 v[178:179], v246 offset:512
    ds_read_b64_tr_b16 v[180:181], v247 offset:0
    ds_read_b64_tr_b16 v[182:183], v247 offset:512
    s_mov_b32 m0, s71
    v_mfma_f32_32x32x16_bf16 v[16:31], v[92:95], v[184:187], v[16:31]
    buffer_load_dwordx4 v228, s[4:7], s47 offen sc1 lds
    buffer_load_dwordx4 v229, s[72:75], s47 offen offset:1024 sc1 lds
    v_mfma_f32_32x32x16_bf16 v[32:47], v[88:91], v[188:191], v[32:47]
    s_nop 2
    v_mul_f32 v242, v0, v144
    v_fma_f32 v240, v8, v160, -v240
    v_fmac_f32 v242, v1, v145
    v_fmac_f32 v240, v9, v161
    v_fmac_f32 v242, v2, v146
    v_fmac_f32 v240, v10, v162
    v_fmac_f32 v242, v3, v147
    v_mfma_f32_32x32x16_bf16 v[48:63], v[92:95], v[188:191], v[48:63]
    s_setprio 0
    v_fmac_f32 v240, v11, v163
    v_fmac_f32 v242, v4, v148
    v_fmac_f32 v240, v12, v164
    v_fmac_f32 v242, v5, v149
    v_fmac_f32 v240, v13, v165
    v_fmac_f32 v242, v6, v150
    v_fmac_f32 v240, v14, v166
    v_fmac_f32 v242, v7, v151
    v_fmac_f32 v240, v15, v167
    v_add_u32 v249, s26, v249
    v_add_u32 v250, s26, v250
    v_fma_f32 v244, v16, v160, -v244
    v_fmac_f32 v236, v24, v112
    v_fmac_f32 v244, v17, v161
    v_fmac_f32 v236, v25, v113
    v_fmac_f32 v244, v18, v162
    v_fmac_f32 v236, v26, v114
    v_fmac_f32 v244, v19, v163
    v_fmac_f32 v236, v27, v115
    v_fmac_f32 v244, v20, v164
    v_fmac_f32 v236, v28, v116
    v_fmac_f32 v244, v21, v165
    v_fmac_f32 v236, v29, v117
    v_fmac_f32 v244, v22, v166
    v_fmac_f32 v236, v30, v118
    v_fmac_f32 v244, v23, v167
    v_fmac_f32 v236, v31, v119
    ds_read_b64_tr_b16 v[0:1], v249 offset:0
    ds_read_b64_tr_b16 v[2:3], v249 offset:128
    ds_read_b128 v[4:7], v250 offset:0
    ds_read_b128 v[8:11], v250 offset:16
    ds_read_b128 v[12:15], v250 offset:384
    ds_read_b128 v[16:19], v250 offset:400
    v_mul_f32 v243, v32, v152
    v_fma_f32 v241, v40, v168, -v241
    v_fmac_f32 v243, v33, v153
    v_fmac_f32 v241, v41, v169
    v_fmac_f32 v243, v34, v154
    v_fmac_f32 v241, v42, v170
    v_fmac_f32 v243, v35, v155
    v_fmac_f32 v241, v43, v171
    v_fmac_f32 v243, v36, v156
    v_fmac_f32 v241, v44, v172
    v_fmac_f32 v243, v37, v157
    v_fmac_f32 v241, v45, v173
    v_fmac_f32 v243, v38, v158
    v_fmac_f32 v241, v46, v174
    v_fmac_f32 v243, v39, v159
    v_fmac_f32 v241, v47, v175
    ds_read_b64_tr_b16 v[20:21], v249 offset:512
    ds_read_b64_tr_b16 v[22:23], v249 offset:640
    ds_read_b128 v[24:27], v250 offset:64
    ds_read_b128 v[28:31], v250 offset:80
    ds_read_b128 v[32:35], v250 offset:448
    ds_read_b128 v[36:39], v250 offset:464
    v_fma_f32 v245, v48, v168, -v245
    v_fmac_f32 v237, v56, v120
    v_fmac_f32 v245, v49, v169
    v_fmac_f32 v237, v57, v121
    v_fmac_f32 v245, v50, v170
    v_fmac_f32 v237, v58, v122
    v_fmac_f32 v245, v51, v171
    v_fmac_f32 v237, v59, v123
    v_fmac_f32 v245, v52, v172
    v_fmac_f32 v237, v60, v124
    v_fmac_f32 v245, v53, v173
    v_fmac_f32 v237, v61, v125
    v_fmac_f32 v245, v54, v174
    v_fmac_f32 v237, v62, v126
    v_fmac_f32 v245, v55, v175
    v_fmac_f32 v237, v63, v127
    s_cmp_eq_u32 s56, 2
    s_cbranch_scc1 K2_U21
    s_cmp_eq_u32 s56, 3
    s_cbranch_scc1 K2_U31
    s_branch K2_DSP1
K2_nul_50:
    s_mov_b32 s58, 63
    s_mov_b32 s36, 0
    s_branch K2_back_53
K2_spin_51:
    s_sub_u32 s27, s27, 1
    s_cbranch_scc1 K2_END
    v_lshl_add_u32 v233, v252, 1, s53
    ds_read_b32 v233, v233
    s_waitcnt lgkmcnt(0)
    s_branch K2_chk_52
K2_dyn_48:
    v_mov_b32 v254, 163648
    v_mov_b32 v255, 1
    v_lshl_add_u32 v233, v252, 1, s53
    s_mov_b64 exec, 1
    ds_add_rtn_u32 v232, v254, v255
    s_mov_b64 exec, -1
    ds_read_b32 v233, v233
    s_waitcnt lgkmcnt(0)
    v_readfirstlane_b32 s58, v232
    s_nop 0
    s_cmp_lt_u32 s58, s22
    s_cbranch_scc0 K2_nul_50
    s_and_b32 s59, s58, 7
    s_lshr_b32 s60, s58, 3
K2_chk_52:
    v_readlane_b32 s61, v233, s59
    s_nop 0
    s_cmp_gt_u32 s61, s60
    s_cbranch_scc0 K2_spin_51
K2_back_53:
    s_mov_b32 s34, 1
    s_branch K2_back_49
K2_rare_54:
    s_cmp_eq_u32 s33, 4
    s_cbranch_scc1 K2_four_56
    s_mov_b32 s49, s48
    s_mov_b32 s51, s48
    s_add_u32 s45, s44, 256
    s_add_u32 s46, s44, 512
    s_add_u32 s47, s44, 768
    s_branch K2_back_55
K2_four_56:
    s_add_u32 s50, s48, 64
    s_lshr_b32 s51, s3, 27
    s_mov_b32 s66, 161536
    s_cmp_ge_u32 s51, 2
    s_cselect_b32 s66, 159072, s66
    s_mul_i32 s51, s51, 32
    s_add_u32 s51, s51, s66
    s_mov_b32 s46, s44
    s_mov_b32 s47, s44
    s_branch K2_back_55
K2_dum_57:
    v_mov_b32 v232, -1
    s_mov_b32 m0, 163712
    s_mov_b64 exec, 1
    buffer_load_dwordx4 v232, s[16:19], 0 offen lds
    buffer_load_dwordx4 v232, s[16:19], 0 offen lds
    s_mov_b64 exec, -1
    s_branch K2_back_59
K2_a4_58:
    s_lshr_b32 s65, s3, 27
    s_mov_b32 s66, 161536
    s_cmp_ge_u32 s65, 2
    s_cselect_b32 s66, 158112, s66
    s_mul_i32 s65, s65, 512
    s_add_u32 s65, s65, s66
    v_add_u32 v232, s65, v230
    ds_read_b32 v232, v232
    s_add_u32 m0, s65, 864
    s_waitcnt lgkmcnt(0)
    v_or_b32 v232, v232, v231
    buffer_load_dwordx4 v232, s[16:19], 0 offen  lds
    s_branch K2_b4_60
K2_nul_63:
    s_mov_b32 s58, 63
    s_mov_b32 s36, 0
    s_branch K2_back_66
K2_spin_64:
    s_sub_u32 s27, s27, 1
    s_cbranch_scc1 K2_END
    v_lshl_add_u32 v233, v252, 1, s53
    ds_read_b32 v233, v233
    s_waitcnt lgkmcnt(0)
    s_branch K2_chk_65
K2_dyn_61:
    v_mov_b32 v254, 163648
    v_mov_b32 v255, 1
    v_lshl_add_u32 v233, v252, 1, s53
    s_mov_b64 exec, 1
    ds_add_rtn_u32 v232, v254, v255
    s_mov_b64 exec, -1
    ds_read_b32 v233, v233
    s_waitcnt lgkmcnt(0)
    v_readfirstlane_b32 s58, v232
    s_nop 0
    s_cmp_lt_u32 s58, s22
    s_cbranch_scc0 K2_nul_63
    s_and_b32 s59, s58, 7
    s_lshr_b32 s60, s58, 3
K2_chk_65:
    v_readlane_b32 s61, v233, s59
    s_nop 0
    s_cmp_gt_u32 s61, s60
    s_cbranch_scc0 K2_spin_64
K2_back_66:
    s_mov_b32 s34, 1
    s_branch K2_back_62
K2_rare_67:
    s_cmp_eq_u32 s33, 4
    s_cbranch_scc1 K2_four_69
    s_mov_b32 s49, s48
    s_mov_b32 s51, s48
    s_add_u32 s45, s44, 256
    s_add_u32 s46, s44, 512
    s_add_u32 s47, s44, 768
    s_branch K2_back_68
K2_four_69:
    s_add_u32 s50, s48, 64
    s_lshr_b32 s51, s3, 27
    s_mov_b32 s66, 161536
    s_cmp_ge_u32 s51, 2
    s_cselect_b32 s66, 159072, s66
    s_mul_i32 s51, s51, 32
    s_add_u32 s51, s51, s66
    s_mov_b32 s46, s44
    s_mov_b32 s47, s44
    s_branch K2_back_68
K2_dum_70:
    v_mov_b32 v232, -1
    s_mov_b32 m0, 163712
    s_mov_b64 exec, 1
    buffer_load_dwordx4 v232, s[16:19], 0 offen lds
    buffer_load_dwordx4 v232, s[16:19], 0 offen lds
    s_mov_b64 exec, -1
    s_branch K2_back_72
K2_a4_71:
    s_lshr_b32 s65, s3, 27
    s_mov_b32 s66, 161536
    s_cmp_ge_u32 s65, 2
    s_cselect_b32 s66, 158112, s66
    s_mul_i32 s65, s65, 512
    s_add_u32 s65, s65, s66
    v_add_u32 v232, s65, v230
    ds_read_b32 v232, v232
    s_add_u32 m0, s65, 864
    s_waitcnt lgkmcnt(0)
    v_or_b32 v232, v232, v231
    buffer_load_dwordx4 v232, s[16:19], 0 offen  lds
    s_branch K2_b4_73
K2_nul_74:
    s_mov_b32 s58, 63
    s_mov_b32 s36, 0
    s_branch K2_back_77
K2_spin_75:
    s_sub_u32 s27, s27, 1
    s_cbranch_scc1 K2_END
    v_lshl_add_u32 v233, v252, 1, s53
    ds_read_b32 v233, v233
    s_waitcnt lgkmcnt(0)
    s_branch K2_chk_76
K2_rare_78:
    s_cmp_eq_u32 s33, 4
    s_cbranch_scc1 K2_four_80
    s_mov_b32 s49, s48
    s_mov_b32 s51, s48
    s_add_u32 s45, s44, 256
    s_add_u32 s46, s44, 512
    s_add_u32 s47, s44, 768
    s_branch K2_back_79
K2_four_80:
    s_add_u32 s50, s48, 64
    s_lshr_b32 s51, s3, 27
    s_mov_b32 s66, 161536
    s_cmp_ge_u32 s51, 2
    s_cselect_b32 s66, 159072, s66
    s_mul_i32 s51, s51, 32
    s_add_u32 s51, s51, s66
    s_mov_b32 s46, s44
    s_mov_b32 s47, s44
    s_branch K2_back_79
K2_nul_81:
    s_mov_b32 s58, 63
    s_mov_b32 s36, 0
    s_branch K2_back_84
K2_spin_82:
    s_sub_u32 s27, s27, 1
    s_cbranch_scc1 K2_END
    v_lshl_add_u32 v233, v252, 1, s53
    ds_read_b32 v233, v233
    s_waitcnt lgkmcnt(0)
    s_branch K2_chk_83
K2_rare_85:
    s_cmp_eq_u32 s33, 4
    s_cbranch_scc1 K2_four_87
    s_mov_b32 s49, s48
    s_mov_b32 s51, s48
    s_add_u32 s45, s44, 256
    s_add_u32 s46, s44, 512
    s_add_u32 s47, s44, 768
    s_branch K2_back_86
K2_four_87:
    s_add_u32 s50, s48, 64
    s_lshr_b32 s51, s3, 27
    s_mov_b32 s66, 161536
    s_cmp_ge_u32 s51, 2
    s_cselect_b32 s66, 159072, s66
    s_mul_i32 s51, s51, 32
    s_add_u32 s51, s51, s66
    s_mov_b32 s46, s44
    s_mov_b32 s47, s44
    s_branch K2_back_86
K2_END:
    s_endpgm
.section .rodata,"a"
.p2align 6
.amdhsa_kernel standalone__tensor_product_equiv_equiformer__graph_kernel
  .amdhsa_next_free_vgpr 256
  .amdhsa_next_free_sgpr 102
  .amdhsa_accum_offset 256
  .amdhsa_group_segment_fixed_size 0
  .amdhsa_kernarg_size 96
  .amdhsa_user_sgpr_count 2
  .amdhsa_user_sgpr_kernarg_segment_ptr 1
  .amdhsa_system_sgpr_workgroup_id_x 1
  .amdhsa_float_denorm_mode_32 3
.end_amdhsa_kernel
```

```asm
; @launch grid=(256,1,1) block=(512,1,1) lds=163840
.amdgcn_target "amdgcn-amd-amdhsa--gfx950"
.text
.globl standalone__tensor_product_equiv_equiformer__graph_kernel
.p2align 8
.type standalone__tensor_product_equiv_equiformer__graph_kernel,@function
standalone__tensor_product_equiv_equiformer__graph_kernel:
    s_cmp_ge_u32 s2, 256
    s_cbranch_scc1 K2_END
    s_load_dwordx16 s[80:95], s[0:1], 0
    s_load_dwordx4 s[96:99], s[0:1], 72
    s_load_dwordx2 s[100:101], s[0:1], 88
    s_memrealtime s[74:75]
    v_lshrrev_b32 v1, 6, v0
    s_mov_b32 s54, s2
    v_readfirstlane_b32 s20, v1
    s_mov_b64 exec, 0
    s_cmp_eq_u32 s20, 0
    s_cbranch_scc1 K2_PAD_S1
    s_cmp_eq_u32 s20, 1
    s_cbranch_scc1 K2_PAD_S2
    s_cmp_eq_u32 s20, 5
    s_cbranch_scc1 K2_PAD_H1
    s_cmp_eq_u32 s20, 6
    s_cbranch_scc1 K2_PAD_H2
    s_cmp_eq_u32 s20, 2
    s_cbranch_scc1 K2_PAD_H3
KS_HOP0:
    s_mov_b64 exec, -1
    v_and_b32 v8, 63, v0
    v_lshlrev_b32 v9, 4, v8
    v_mov_b32 v6, 0
    v_lshlrev_b32 v5, 4, v0
    v_mul_u32_u24 v4, 24, v0
    s_mul_i32 s64, s2, 5120
    s_mul_i32 s65, s2, 7680
    v_mov_b32 v176, v8
    v_mov_b32 v177, v0
    s_mul_i32 s21, s2, 625
    s_add_u32 s22, s21, 640
    s_add_u32 s21, s21, 15
    s_lshr_b32 s21, s21, 4
    s_lshr_b32 s22, s22, 4
    s_sub_u32 s22, s22, s21
    s_movk_i32 s39, 1024
    s_lshl_b32 s37, s20, 13
    s_mov_b32 s53, 163616
    s_lshl_b32 s52, s20, 2
    s_add_u32 s52, s52, s53
    s_add_u32 s68, s37, 0
    s_add_u32 s69, s37, 2048
    s_add_u32 s70, s37, 4096
    s_add_u32 s71, s37, 6144
    s_waitcnt lgkmcnt(0)
    s_mov_b32 s8, s100
    s_and_b32 s9, s101, 0xffff
    s_mov_b32 s10, 37748736
    s_mov_b32 s11, 0x20000
    s_cmp_lg_u32 s20, 7
    s_cbranch_scc1 KS_NOTAG
    s_mov_b32 s60, s98
    s_and_b32 s61, s99, 0xffff
    s_mov_b32 s62, 256
    s_mov_b32 s63, 0x20000
    s_cmp_lg_u32 s2, 0
    s_cbranch_scc1 KS_TAGLD
    s_or_b32 s24, s74, 1
    v_mov_b32 v10, s24
    v_mov_b32 v11, 0
    s_mov_b64 exec, 1
    buffer_atomic_cmpswap v[10:11], v6, s[60:63], 0 offen sc1
    s_mov_b64 exec, -1
KS_TAGLD:
    v_mov_b32 v14, 0
    s_barrier
    v_mov_b32 v76, 0
    v_mov_b32 v77, -1
    v_lshlrev_b32 v78, 2, v8
    v_add_u32 v78, 163424, v78
    s_mov_b64 exec, 0x1ff
    ds_write_b32 v78, v76 offset:192
    s_mov_b64 exec, 0xff
    ds_write_b32 v78, v77 offset:256
    s_mov_b64 exec, -1
    s_mov_b32 exec_hi, 0xffff
    ds_write_b32 v78, v76
    s_mov_b64 exec, 0x3f
    ds_write_b32 v78, v76 offset:228
    s_mov_b64 exec, -1
    s_mov_b64 exec, 1
    s_mov_b32 s24, 0x40000
    v_mov_b32 v12, 163728
KS_TAGW:
    buffer_load_dword v15, v6, s[60:63], 0 offen sc1
    s_waitcnt vmcnt(1)
    v_cmp_ne_u32 vcc, 0, v14
    s_nop 0
    s_cbranch_vccnz KS_TAGOK
    s_sub_u32 s24, s24, 1
    s_cbranch_scc1 K2_END
    buffer_load_dword v14, v6, s[60:63], 0 offen sc1
    s_waitcnt vmcnt(1)
    v_cmp_ne_u32 vcc, 0, v15
    s_nop 0
    s_cbranch_vccz KS_TAGW
    ds_write_b32 v12, v15
    s_branch KS_TAGOK2
KS_TAGOK:
    ds_write_b32 v12, v14
KS_TAGOK2:
    s_mov_b64 exec, -1
    s_waitcnt lgkmcnt(0)
    s_barrier
    s_branch KS_B3
KS_H0:
    s_barrier
    s_branch KS_HELP
K2_PAD_S1:
    s_branch KS_HOP0
KS_NOTAG:
    s_cmp_ge_u32 s20, 5
    s_cbranch_scc1 KS_HELP
    s_cmp_ge_u32 s2, 250
    s_cbranch_scc1 KS_IDLE
    s_mov_b32 s40, s88
    s_and_b32 s41, s89, 0xffff
    s_mov_b32 s42, 1280000
    s_mov_b32 s43, 0x20000
    buffer_load_dwordx4 v[12:15], v5, s[40:43], s64 offen
    s_mov_b32 s44, s86
    s_and_b32 s45, s87, 0xffff
    s_mov_b32 s46, 1280000
    s_mov_b32 s47, 0x20000
    s_mov_b32 s48, s82
    s_and_b32 s49, s83, 0xffff
    s_mov_b32 s50, 1920000
    s_mov_b32 s51, 0x20000
    buffer_load_dwordx4 v[16:19], v5, s[44:47], s64 offen
    buffer_load_dwordx4 v[20:23], v4, s[48:51], s65 offen
    buffer_load_dwordx2 v[24:25], v4, s[48:51], s65 offen offset:16
    v_lshlrev_b32 v2, 2, v0
    s_lshl_b32 s64, s64, 3
    v_lshl_add_u32 v3, v0, 7, s64
    v_mov_b32 v7, 1
    s_cmp_eq_u32 s20, 4
    s_cbranch_scc1 KS_NOCLR
    ds_write_b32 v2, v6
KS_NOCLR:
    s_waitcnt lgkmcnt(0)
    s_barrier
    s_mov_b64 exec, 0
    s_cmp_eq_u32 s20, 0
    s_cbranch_scc1 K2_PAD_B3
    s_cmp_eq_u32 s20, 1
    s_cbranch_scc1 K2_PAD_LD
    s_cmp_eq_u32 s20, 2
    s_cbranch_scc1 K2_PAD_NW
    s_cmp_eq_u32 s20, 3
    s_cbranch_scc1 K2_PAD_SC
    s_cmp_eq_u32 s20, 4
    s_cbranch_scc1 K2_PAD_SD
KS_HOP:
    s_mov_b64 exec, -1
    v_mul_u32_u24 v76, 2979, v0
    v_lshrrev_b32 v76, 16, v76
    v_mul_u32_u24 v77, 2048, v76
    v_lshl_add_u32 v78, v0, 4, v77
    v_add_u32 v78, 67584, v78
    v_add_u32 v79, 67200, v78
    v_mov_b32 v80, -1
    v_mov_b32 v81, -1
    v_cmp_gt_u32 vcc, 14, v76
    v_cmp_gt_u32 s[56:57], 12, v76
    v_mov_b32 v82, -1
    v_mov_b32 v83, -1
    s_mov_b64 exec, vcc
    ds_write_b128 v78, v[80:83]
    ds_write_b128 v78, v[80:83] offset:33600
    s_mov_b64 exec, s[56:57]
    ds_write_b128 v79, v[80:83]
    s_mov_b64 exec, -1
    s_mov_b32 s58, 429497
    s_movk_i32 s59, 625
    s_waitcnt vmcnt(3)
    v_mul_u32_u24 v28, s58, v12
    v_lshrrev_b32 v32, 27, v28
    v_bfe_u32 v36, v28, 24, 3
    v_lshlrev_b32 v32, 2, v32
    v_lshl_or_b32 v32, v36, 7, v32
    ds_add_rtn_u32 v36, v32, v7
    v_mul_u32_u24 v29, s58, v13
    v_lshrrev_b32 v33, 27, v29
    v_bfe_u32 v37, v29, 24, 3
    v_lshlrev_b32 v33, 2, v33
    v_lshl_or_b32 v33, v37, 7, v33
    ds_add_rtn_u32 v37, v33, v7
    v_mul_u32_u24 v30, s58, v14
    v_lshrrev_b32 v34, 27, v30
    v_bfe_u32 v38, v30, 24, 3
    v_lshlrev_b32 v34, 2, v34
    v_lshl_or_b32 v34, v38, 7, v34
    ds_add_rtn_u32 v38, v34, v7
    v_mul_u32_u24 v31, s58, v15
    v_lshrrev_b32 v35, 27, v31
    v_bfe_u32 v39, v31, 24, 3
    v_lshlrev_b32 v35, 2, v35
    v_lshl_or_b32 v35, v39, 7, v35
    ds_add_rtn_u32 v39, v35, v7
    v_lshrrev_b32 v28, 24, v28
    v_mad_u32_u24 v28, v28, s59, 15
    v_lshrrev_b32 v28, 4, v28
    v_sub_u32 v28, v12, v28
    v_add_u32 v12, 0, v3
    v_lshl_or_b32 v28, v28, 26, v12
    v_lshrrev_b32 v29, 24, v29
    v_mad_u32_u24 v29, v29, s59, 15
    v_lshrrev_b32 v29, 4, v29
    v_sub_u32 v29, v13, v29
    v_add_u32 v13, 32, v3
    v_lshl_or_b32 v29, v29, 26, v13
    v_lshrrev_b32 v30, 24, v30
    v_mad_u32_u24 v30, v30, s59, 15
    v_lshrrev_b32 v30, 4, v30
    v_sub_u32 v30, v14, v30
    v_add_u32 v14, 64, v3
    v_lshl_or_b32 v30, v30, 26, v14
    v_lshrrev_b32 v31, 24, v31
    v_mad_u32_u24 v31, v31, s59, 15
    v_lshrrev_b32 v31, 4, v31
    v_sub_u32 v31, v15, v31
    v_add_u32 v15, 96, v3
    v_lshl_or_b32 v31, v31, 26, v15
K2_PAD_S2:
    s_cbranch_execz KS_HOP0
    v_mov_b32 v59, 163728
    s_mul_i32 s65, s2, 1152
    s_add_u32 s65, s65, 6291456
    s_mul_i32 s64, s2, 20608
    s_waitcnt lgkmcnt(0)
    s_barrier
    ds_read_b128 v[40:43], v9
    ds_read_b32 v59, v59
    s_waitcnt lgkmcnt(1)
    v_add_u32 v45, v40, v41
    v_add_u32 v46, v45, v42
    v_add_u32 v47, v46, v43
    v_mov_b32 v58, v47
    s_nop 1
    v_add_u32_dpp v58, v58, v58 row_shr:1 row_mask:0xf bank_mask:0xf bound_ctrl:0
    s_nop 1
    v_add_u32_dpp v58, v58, v58 row_shr:2 row_mask:0xf bank_mask:0xf bound_ctrl:0
    s_nop 1
    v_add_u32_dpp v58, v58, v58 row_shr:4 row_mask:0xf bank_mask:0xf bound_ctrl:0
    s_nop 1
    v_add_u32_dpp v58, v58, v58 row_shr:8 row_mask:0xf bank_mask:0xf bound_ctrl:0
    s_nop 1
    v_add_u32_dpp v58, v58, v58 row_bcast:15 row_mask:0xa bank_mask:0xf
    s_nop 1
    v_add_u32_dpp v58, v58, v58 row_bcast:31 row_mask:0xc bank_mask:0xf
    v_sub_u32 v48, v58, v47
    v_add_u32 v49, v48, v40
    v_add_u32 v50, v48, v45
    v_add_u32 v51, v48, v46
    ds_write_b128 v9, v[48:51] offset:1024
    s_waitcnt vmcnt(0) lgkmcnt(1)
    s_cmp_lg_u32 s20, 4
    s_cbranch_scc1 KS_NOPUB
    v_lshl_or_b32 v56, v49, 11, v48
    v_lshl_or_b32 v57, v51, 11, v50
    v_lshl_or_b32 v56, v59, 22, v56
    v_lshl_or_b32 v57, v59, 22, v57
    buffer_store_dwordx4 v[56:59], v9, s[8:11], s65 offen sc1
KS_NOPUB:
    s_waitcnt lgkmcnt(0)
    ds_read_b32 v32, v32 offset:1024
    ds_read_b32 v33, v33 offset:1024
    ds_read_b32 v34, v34 offset:1024
    ds_read_b32 v35, v35 offset:1024
    v_and_b32 v60, 0xffff, v59
    v_and_b32 v61, 0xffff0000, v59
    s_mov_b32 s58, 0xffff0000
    v_mov_b32 v40, v20
    v_lshl_or_b32 v41, v21, 16, v60
    v_or_b32 v42, v61, v16
    v_mov_b32 v43, v28
    v_alignbit_b32 v44, v22, v21, 16
    v_and_or_b32 v45, v22, s58, v60
    v_or_b32 v46, v61, v17
    v_mov_b32 v47, v29
    v_mov_b32 v48, v23
    v_lshl_or_b32 v49, v24, 16, v60
    v_or_b32 v50, v61, v18
    v_mov_b32 v51, v30
    v_alignbit_b32 v52, v25, v24, 16
    v_and_or_b32 v53, v25, s58, v60
    v_or_b32 v54, v61, v19
    v_mov_b32 v55, v31
    s_waitcnt lgkmcnt(0)
    v_add_lshl_u32 v32, v32, v36, 4
    ds_write_b128 v32, v[40:43] offset:2048
    v_add_lshl_u32 v33, v33, v37, 4
    ds_write_b128 v33, v[44:47] offset:2048
    v_add_lshl_u32 v34, v34, v38, 4
    ds_write_b128 v34, v[48:51] offset:2048
    v_add_lshl_u32 v35, v35, v39, 4
    ds_write_b128 v35, v[52:55] offset:2048
    s_waitcnt lgkmcnt(0)
    s_barrier
    ds_read_b128 v[12:15], v5 offset:2048
    ds_read_b128 v[16:19], v5 offset:7168
    ds_read_b128 v[20:23], v5 offset:12288
    ds_read_b128 v[24:27], v5 offset:17408
    s_waitcnt lgkmcnt(3)
    buffer_store_dwordx4 v[12:15], v5, s[8:11], s64 offen sc1
    s_add_u32 s64, s64, 5120
    s_waitcnt lgkmcnt(2)
    buffer_store_dwordx4 v[16:19], v5, s[8:11], s64 offen sc1
    s_add_u32 s64, s64, 5120
    s_waitcnt lgkmcnt(1)
    buffer_store_dwordx4 v[20:23], v5, s[8:11], s64 offen sc1
    s_add_u32 s64, s64, 5120
    s_waitcnt lgkmcnt(0)
    buffer_store_dwordx4 v[24:27], v5, s[8:11], s64 offen sc1
    s_branch KS_JOIN
K2_PAD_B3:
    s_branch KS_HOP
KS_B3:
    v_mov_b32 v59, 163728
    ds_read_b32 v59, v59
    s_waitcnt lgkmcnt(0)
    s_barrier
KS_JOIN:
    v_readfirstlane_b32 s2, v59
    s_mov_b32 s23, 0
    s_mov_b32 s28, 1
    s_mov_b32 s24, 0
    s_mov_b32 s25, 1
K2_CELLS:
    v_lshrrev_b32 v178, 1, v177
    v_min_u32 v178, 249, v178
    v_mul_u32_u24 v72, 1152, v178
    s_and_b32 s58, s54, 7
    s_lshl_b32 s58, s58, 7
    s_lshr_b32 s59, s54, 5
    s_lshl_b32 s59, s59, 4
    s_add_u32 s67, s58, s59
    s_add_u32 s67, s67, 6291456
    buffer_load_dwordx4 v[76:79], v72, s[8:11], s67 offen sc1
    s_cmp_eq_u32 s28, 0
    s_cbranch_scc1 K2_NOSRD
    s_mov_b32 s4, s80
    s_and_b32 s5, s81, 0xffff
    s_mov_b32 s6, 10240000
    s_mov_b32 s7, 0x20000
    s_mov_b32 s12, s96
    s_and_b32 s13, s97, 0xffff
    s_mov_b32 s14, 10240000
    s_mov_b32 s15, 0x20000
    s_mov_b32 s16, s84
    s_and_b32 s17, s85, 0xffff
    s_mov_b32 s18, 10240000
    s_mov_b32 s19, 0x20000
    s_sub_u32 s80, s80, 1024
    s_subb_u32 s81, s81, 0
    s_mov_b32 s72, s80
    s_and_b32 s73, s81, 0xffff
    s_mov_b32 s74, 10241024
    s_mov_b32 s75, 0x20000
    s_mov_b64 exec, 0
    s_cmp_eq_u32 s20, 0
    s_cbranch_scc1 K2_PAD_U20
    s_cmp_eq_u32 s20, 1
    s_cbranch_scc1 K2_PAD_U30
    s_cmp_eq_u32 s20, 2
    s_cbranch_scc1 K2_PAD_U21
    s_cmp_eq_u32 s20, 3
    s_cbranch_scc1 K2_PAD_U31
    s_cmp_eq_u32 s20, 4
    s_cbranch_scc1 K2_PAD_SW
    s_cmp_eq_u32 s20, 5
    s_cbranch_scc1 K2_PAD_TL
    s_cmp_eq_u32 s20, 6
    s_cbranch_scc1 K2_PAD_T2
    s_cmp_eq_u32 s20, 7
    s_cbranch_scc1 K2_PAD_OV
K2_HOP:
    s_mov_b64 exec, -1
K2_NOSRD:
    v_and_b32 v84, 15, v176
    v_lshrrev_b32 v85, 5, v176
    v_bfe_u32 v86, v176, 4, 1
    v_lshrrev_b32 v87, 2, v84
    v_and_b32 v88, 3, v84
    v_lshl_add_u32 v89, v85, 3, v87
    v_lshlrev_b32 v249, 5, v89
    v_lshl_add_u32 v249, v88, 3, v249
    v_add_u32 v249, 864, v249
    v_mul_u32_u24 v250, 192, v86
    v_lshl_add_u32 v250, v85, 5, v250
    v_lshrrev_b32 v90, 1, v88
    v_lshl_add_u32 v90, v86, 1, v90
    v_bfe_u32 v91, v87, 1, 1
    v_lshlrev_b32 v91, 2, v91
    v_xor_b32 v90, v90, v91
    v_lshlrev_b32 v90, 4, v90
    v_lshl_add_u32 v90, v89, 7, v90
    v_and_b32 v91, 1, v88
    v_lshl_add_u32 v90, v91, 3, v90
    v_add_u32 v246, s37, v90
    v_xor_b32 v247, 64, v246
    v_lshrrev_b32 v90, 3, v176
    v_lshlrev_b32 v251, 2, v90
    v_add_u32 v251, 768, v251
    v_bfe_u32 v90, v90, 1, 1
    v_lshlrev_b32 v90, 2, v90
    v_and_b32 v91, 7, v176
    v_xor_b32 v90, v90, v91
    v_lshlrev_b32 v248, 4, v90
    v_lshlrev_b32 v252, 1, v176
    v_and_b32 v231, 1, v176
    v_lshlrev_b32 v231, 4, v231
    v_lshrrev_b32 v90, 1, v176
    v_lshlrev_b32 v90, 5, v90
    v_add_u32 v230, 864, v90
    s_lshl_b32 s59, s2, 22
    s_mov_b32 s60, 0x40000
    s_bfe_u32 s61, s54, 0x10004
    s_bfe_u32 s62, s54, 0x10003
    s_add_u32 s63, s61, s62
    s_mul_i32 s62, s62, 11
    s_sub_u32 s64, 11, s62
    v_cmp_gt_u32 vcc, 500, v177
    s_nop 0
    s_mov_b64 s[56:57], vcc
K2_POLL:
    s_waitcnt vmcnt(0)
    v_xor_b32 v73, s59, v76
    v_xor_b32 v74, s59, v77
    v_or_b32 v73, v73, v74
    v_xor_b32 v74, s2, v79
    v_lshrrev_b32 v73, 22, v73
    v_or_b32 v73, v73, v74
    v_cmp_ne_u32 vcc, 0, v73
    s_nop 0
    s_cbranch_vccz K2_POLLED
    s_sub_u32 s60, s60, 1
    s_cbranch_scc1 K2_END
    s_mov_b64 exec, vcc
    buffer_load_dwordx4 v[76:79], v72, s[8:11], s67 offen sc1
    s_mov_b64 exec, -1
    s_branch K2_POLL
K2_PAD_LD:
    s_branch KS_HOP
K2_POLLED:
    s_set_gpr_idx_on s61, gpr_idx(SRC0)
    s_nop 0
    v_bfe_u32 v179, v76, s62, 11
    s_set_gpr_idx_idx s63
    s_nop 0
    v_bfe_u32 v73, v76, s64, 11
    s_set_gpr_idx_off
    v_sub_u32 v73, v73, v179
    v_cndmask_b32 v73, 0, v73, s[56:57]
    v_and_b32 v1, 1, v177
    v_add_u32 v1, s23, v1
    v_sub_u32 v180, v73, v1
    v_add_u32 v179, v179, v1
    v_mul_u32_u24 v181, 20608, v178
    v_lshl_add_u32 v181, v179, 4, v181
    v_cmp_lt_i32 s[40:41], 0, v180
    v_cmp_lt_i32 s[42:43], 2, v180
    v_cmp_lt_i32 s[44:45], 4, v180
    v_add_u32 v182, 96, v181
    s_mov_b32 s65, 0
    s_mov_b64 exec, s[40:41]
    buffer_load_dwordx4 v[0:3], v181, s[8:11], 0 offen offset:0 sc1
    s_mov_b64 exec, s[42:43]
    buffer_load_dwordx4 v[4:7], v181, s[8:11], 0 offen offset:32 sc1
    s_mov_b64 exec, s[44:45]
    buffer_load_dwordx4 v[8:11], v181, s[8:11], 0 offen offset:64 sc1
    s_mov_b64 exec, -1
    v_cmp_lt_i32 s[46:47], 6, v180
    v_cmp_lt_i32 s[48:49], 8, v180
    v_cmp_lt_i32 s[50:51], 10, v180
    v_cmp_lt_i32 s[90:91], 12, v180
    v_cmp_lt_i32 s[92:93], 14, v180
    v_cmp_lt_i32 s[94:95], 16, v180
    v_cmp_lt_i32 s[96:97], 18, v180
    v_subrev_u32 v62, 5, v180
    v_ashrrev_i32 v62, 1, v62
    v_med3_i32 v62, v62, 0, 7
    s_cmp_eq_u64 s[46:47], 0
    s_cbranch_scc1 K2_LD_DONE
    v_mov_b32 v63, v62
    s_nop 1
    v_add_u32_dpp v63, v63, v63 row_shr:1 row_mask:0xf bank_mask:0xf bound_ctrl:0
    s_nop 1
    v_add_u32_dpp v63, v63, v63 row_shr:2 row_mask:0xf bank_mask:0xf bound_ctrl:0
    s_nop 1
    v_add_u32_dpp v63, v63, v63 row_shr:4 row_mask:0xf bank_mask:0xf bound_ctrl:0
    s_nop 1
    v_add_u32_dpp v63, v63, v63 row_shr:8 row_mask:0xf bank_mask:0xf bound_ctrl:0
    s_nop 1
    v_add_u32_dpp v63, v63, v63 row_bcast:15 row_mask:0xa bank_mask:0xf
    s_nop 1
    v_add_u32_dpp v63, v63, v63 row_bcast:31 row_mask:0xc bank_mask:0xf
    s_lshl_b32 s58, s20, 8
    s_add_u32 s58, s58, 45056
    v_readlane_b32 s59, v63, 63
    v_sub_u32 v63, v63, v62
    v_lshl_add_u32 v64, v63, 2, s58
    v_lshlrev_b32 v63, 5, v63
    v_sub_u32 v63, v182, v63
    s_cmp_gt_u32 s59, 63
    s_cbranch_scc1 K2_LD_GEN
    s_mov_b64 exec, s[46:47]
    s_cbranch_execz K2_LD_L
    ds_write_b32 v64, v63 offset:0
    s_mov_b64 exec, s[48:49]
    s_cbranch_execz K2_LD_L
    ds_write_b32 v64, v63 offset:4
    s_mov_b64 exec, s[50:51]
    s_cbranch_execz K2_LD_L
    ds_write_b32 v64, v63 offset:8
    s_mov_b64 exec, s[90:91]
    s_cbranch_execz K2_LD_L
    ds_write_b32 v64, v63 offset:12
    s_mov_b64 exec, s[92:93]
    s_cbranch_execz K2_LD_L
    ds_write_b32 v64, v63 offset:16
    s_mov_b64 exec, s[94:95]
    s_cbranch_execz K2_LD_L
    ds_write_b32 v64, v63 offset:20
    s_mov_b64 exec, s[96:97]
    s_cbranch_execz K2_LD_L
    ds_write_b32 v64, v63 offset:24
K2_LD_L:
    s_mov_b64 exec, -1
    v_lshl_add_u32 v64, v176, 2, s58
    s_bfm_b64 s[46:47], s59, 0
    s_mov_b64 s[48:49], 0
    s_waitcnt lgkmcnt(0)
    ds_read_b32 v64, v64
    s_mov_b32 s65, 1
    s_waitcnt lgkmcnt(0)
    v_lshl_add_u32 v182, v176, 5, v64
    s_mov_b64 exec, s[46:47]
    buffer_load_dwordx4 v[12:15], v182, s[8:11], 0 offen sc1
K2_LD_DONE:
    s_mov_b64 exec, -1
    s_cmp_eq_u32 s28, 0
    s_cbranch_scc1 K2_NOWRAW
    v_lshrrev_b32 v60, 5, v176
    v_bfe_u32 v61, v176, 2, 2
    v_lshl_add_u32 v60, v60, 2, v61
    v_mul_u32_u24 v60, 1280, v60
    v_bfe_u32 v61, v176, 4, 1
    v_lshl_add_u32 v60, v61, 5, v60
    v_and_b32 v61, 3, v176
    v_lshl_add_u32 v60, v61, 3, v60
    ds_read_b64_tr_b16 v[136:137], v60 offset:24576
    ds_read_b64_tr_b16 v[138:139], v60 offset:34816
    ds_read_b64_tr_b16 v[140:141], v60 offset:24640
    ds_read_b64_tr_b16 v[142:143], v60 offset:34880
    ds_read_b64_tr_b16 v[144:145], v60 offset:24832
    ds_read_b64_tr_b16 v[146:147], v60 offset:35072
    ds_read_b64_tr_b16 v[148:149], v60 offset:24896
    ds_read_b64_tr_b16 v[150:151], v60 offset:35136
    ds_read_b64_tr_b16 v[152:153], v60 offset:25088
    ds_read_b64_tr_b16 v[154:155], v60 offset:35328
    ds_read_b64_tr_b16 v[156:157], v60 offset:25152
    ds_read_b64_tr_b16 v[158:159], v60 offset:35392
    ds_read_b64_tr_b16 v[160:161], v60 offset:25344
    ds_read_b64_tr_b16 v[162:163], v60 offset:35584
    ds_read_b64_tr_b16 v[164:165], v60 offset:25408
    ds_read_b64_tr_b16 v[166:167], v60 offset:35648
    ds_read_b64_tr_b16 v[168:169], v60 offset:25600
    ds_read_b64_tr_b16 v[170:171], v60 offset:35840
    ds_read_b64_tr_b16 v[172:173], v60 offset:25664
    ds_read_b64_tr_b16 v[174:175], v60 offset:35904
    s_waitcnt lgkmcnt(0)
    v_lshlrev_b32 v96, 16, v136
    v_and_b32 v97, 0xffff0000, v136
    v_lshlrev_b32 v98, 16, v137
    v_and_b32 v99, 0xffff0000, v137
    v_lshlrev_b32 v100, 16, v138
    v_and_b32 v101, 0xffff0000, v138
    v_lshlrev_b32 v102, 16, v139
    v_and_b32 v103, 0xffff0000, v139
    v_lshlrev_b32 v104, 16, v140
    v_and_b32 v105, 0xffff0000, v140
    v_lshlrev_b32 v106, 16, v141
    v_and_b32 v107, 0xffff0000, v141
    v_lshlrev_b32 v108, 16, v142
    v_and_b32 v109, 0xffff0000, v142
    v_lshlrev_b32 v110, 16, v143
    v_and_b32 v111, 0xffff0000, v143
    v_lshlrev_b32 v112, 16, v144
    v_and_b32 v113, 0xffff0000, v144
    v_lshlrev_b32 v114, 16, v145
    v_and_b32 v115, 0xffff0000, v145
    v_lshlrev_b32 v116, 16, v146
    v_and_b32 v117, 0xffff0000, v146
    v_lshlrev_b32 v118, 16, v147
    v_and_b32 v119, 0xffff0000, v147
    v_lshlrev_b32 v120, 16, v148
    v_and_b32 v121, 0xffff0000, v148
    v_lshlrev_b32 v122, 16, v149
    v_and_b32 v123, 0xffff0000, v149
    v_lshlrev_b32 v124, 16, v150
    v_and_b32 v125, 0xffff0000, v150
    v_lshlrev_b32 v126, 16, v151
    v_and_b32 v127, 0xffff0000, v151
    v_lshlrev_b32 v128, 16, v152
    v_and_b32 v129, 0xffff0000, v152
    v_lshlrev_b32 v130, 16, v153
    v_and_b32 v131, 0xffff0000, v153
    v_lshlrev_b32 v132, 16, v154
    v_and_b32 v133, 0xffff0000, v154
    v_lshlrev_b32 v134, 16, v155
    v_and_b32 v135, 0xffff0000, v155
    v_lshlrev_b32 v136, 16, v156
    v_and_b32 v137, 0xffff0000, v156
    v_lshlrev_b32 v138, 16, v157
    v_and_b32 v139, 0xffff0000, v157
    v_lshlrev_b32 v140, 16, v158
    v_and_b32 v141, 0xffff0000, v158
    v_lshlrev_b32 v142, 16, v159
    v_and_b32 v143, 0xffff0000, v159
    v_lshlrev_b32 v144, 16, v160
    v_and_b32 v145, 0xffff0000, v160
    v_lshlrev_b32 v146, 16, v161
    v_and_b32 v147, 0xffff0000, v161
    v_lshlrev_b32 v148, 16, v162
    v_and_b32 v149, 0xffff0000, v162
    v_lshlrev_b32 v150, 16, v163
    v_and_b32 v151, 0xffff0000, v163
    v_lshlrev_b32 v152, 16, v164
    v_and_b32 v153, 0xffff0000, v164
    v_lshlrev_b32 v154, 16, v165
    v_and_b32 v155, 0xffff0000, v165
    v_lshlrev_b32 v156, 16, v166
    v_and_b32 v157, 0xffff0000, v166
    v_lshlrev_b32 v158, 16, v167
    v_and_b32 v159, 0xffff0000, v167
    v_lshlrev_b32 v160, 16, v168
    v_and_b32 v161, 0xffff0000, v168
    v_lshlrev_b32 v162, 16, v169
    v_and_b32 v163, 0xffff0000, v169
    v_lshlrev_b32 v164, 16, v170
    v_and_b32 v165, 0xffff0000, v170
    v_lshlrev_b32 v166, 16, v171
    v_and_b32 v167, 0xffff0000, v171
    v_lshlrev_b32 v168, 16, v172
    v_and_b32 v169, 0xffff0000, v172
    v_lshlrev_b32 v170, 16, v173
    v_and_b32 v171, 0xffff0000, v173
    v_lshlrev_b32 v172, 16, v174
    v_and_b32 v173, 0xffff0000, v174
    v_lshlrev_b32 v174, 16, v175
    v_and_b32 v175, 0xffff0000, v175
K2_NOWRAW:
K2_PAD_NW:
    s_cbranch_execz KS_HOP
    v_lshrrev_b32 v179, 2, v181
    v_lshrrev_b32 v183, 2, v182
    s_mov_b32 s66, 7340032
    v_mov_b32 v201, 1
    s_movk_i32 s58, 600
    s_movk_i32 s59, 2400
    s_mov_b32 s60, 0x40000
    s_mov_b32 s61, 0xffff
    v_mov_b32 v202, 65536
    s_cmp_lg_u32 s24, 0
    s_cbranch_scc1 K2_RK_LOAD
    v_cmp_lt_i32 vcc, 20, v180
    s_nop 0
    s_cbranch_vccz K2_NOMORE
    v_mov_b32 v61, 163652
    ds_write_b32 v61, v201
K2_NOMORE:
    v_lshlrev_b32 v72, 4, v176
    s_mov_b32 s64, 7176192
    s_mov_b32 s62, 84736
    s_cmp_eq_u32 s65, 0
    s_waitcnt vmcnt(1)
    s_cbranch_scc0 K2_ARR
    s_waitcnt vmcnt(0)
K2_ARR:
    s_mov_b64 exec, s[40:41]
    s_cbranch_execz K2_RK_A
K2_CK0:
    v_bfi_b32 v192, s61, v1, v2
    v_lshrrev_b32 v50, 24, v3
    v_cmp_ne_u32 vcc, s2, v192
    v_add_u32 v40, 163424, v50
    s_cbranch_vccnz K2_RT0
    ds_add_rtn_u32 v40, v40, v201
    v_mad_u32_u24 v50, v50, s58, v202
    s_mov_b64 exec, s[42:43]
    s_cbranch_execz K2_RK_A
K2_CK1:
    v_bfi_b32 v192, s61, v5, v6
    v_lshrrev_b32 v51, 24, v7
    v_cmp_ne_u32 vcc, s2, v192
    v_add_u32 v41, 163424, v51
    s_cbranch_vccnz K2_RT1
    ds_add_rtn_u32 v41, v41, v201
    v_mad_u32_u24 v51, v51, s58, v202
    s_mov_b64 exec, s[44:45]
    s_cbranch_execz K2_RK_A
K2_CK2:
    v_bfi_b32 v192, s61, v9, v10
    v_lshrrev_b32 v52, 24, v11
    v_cmp_ne_u32 vcc, s2, v192
    v_add_u32 v42, 163424, v52
    s_cbranch_vccnz K2_RT2
    ds_add_rtn_u32 v42, v42, v201
    v_mad_u32_u24 v52, v52, s58, v202
    s_mov_b64 exec, s[46:47]
    s_cbranch_execz K2_RK_A
    s_waitcnt vmcnt(0)
K2_CK3:
    v_bfi_b32 v192, s61, v13, v14
    v_lshrrev_b32 v53, 24, v15
    v_cmp_ne_u32 vcc, s2, v192
    v_add_u32 v43, 163424, v53
    s_cbranch_vccnz K2_RT3
    ds_add_rtn_u32 v43, v43, v201
    v_mad_u32_u24 v53, v53, s58, v202
    s_mov_b64 exec, s[48:49]
    s_cbranch_execz K2_RK_A
K2_CK4:
    v_bfi_b32 v192, s61, v17, v18
    v_lshrrev_b32 v54, 24, v19
    v_cmp_ne_u32 vcc, s2, v192
    v_add_u32 v44, 163424, v54
    s_cbranch_vccnz K2_RT4
    ds_add_rtn_u32 v44, v44, v201
    v_mad_u32_u24 v54, v54, s58, v202
    s_mov_b64 exec, s[50:51]
    s_cbranch_execz K2_RK_A
K2_CK5:
    v_bfi_b32 v192, s61, v21, v22
    v_lshrrev_b32 v55, 24, v23
    v_cmp_ne_u32 vcc, s2, v192
    v_add_u32 v45, 163424, v55
    s_cbranch_vccnz K2_RT5
    ds_add_rtn_u32 v45, v45, v201
    v_mad_u32_u24 v55, v55, s58, v202
    s_mov_b64 exec, s[90:91]
    s_cbranch_execz K2_RK_A
K2_CK6:
    v_bfi_b32 v192, s61, v25, v26
    v_lshrrev_b32 v56, 24, v27
    v_cmp_ne_u32 vcc, s2, v192
    v_add_u32 v46, 163424, v56
    s_cbranch_vccnz K2_RT6
    ds_add_rtn_u32 v46, v46, v201
    v_mad_u32_u24 v56, v56, s58, v202
    s_mov_b64 exec, s[92:93]
    s_cbranch_execz K2_RK_A
K2_CK7:
    v_bfi_b32 v192, s61, v29, v30
    v_lshrrev_b32 v57, 24, v31
    v_cmp_ne_u32 vcc, s2, v192
    v_add_u32 v47, 163424, v57
    s_cbranch_vccnz K2_RT7
    ds_add_rtn_u32 v47, v47, v201
    v_mad_u32_u24 v57, v57, s58, v202
    s_mov_b64 exec, s[94:95]
    s_cbranch_execz K2_RK_A
K2_CK8:
    v_bfi_b32 v192, s61, v33, v34
    v_lshrrev_b32 v58, 24, v35
    v_cmp_ne_u32 vcc, s2, v192
    v_add_u32 v48, 163424, v58
    s_cbranch_vccnz K2_RT8
    ds_add_rtn_u32 v48, v48, v201
    v_mad_u32_u24 v58, v58, s58, v202
    s_mov_b64 exec, s[96:97]
    s_cbranch_execz K2_RK_A
K2_CK9:
    v_bfi_b32 v192, s61, v37, v38
    v_lshrrev_b32 v59, 24, v39
    v_cmp_ne_u32 vcc, s2, v192
    v_add_u32 v49, 163424, v59
    s_cbranch_vccnz K2_RT9
    ds_add_rtn_u32 v49, v49, v201
    v_mad_u32_u24 v59, v59, s58, v202
K2_RK_A:
    s_mov_b64 exec, -1
    s_cmp_eq_u32 s20, 7
    s_cbranch_scc1 K2_FLGLD
K2_FLGL2:
    s_mov_b64 exec, s[40:41]
    s_cbranch_execz K2_TP
    v_cmp_gt_u32 vcc, s62, v50
    v_and_b32 v3, 0xffffff, v3
    s_mov_b64 exec, vcc
    buffer_load_dword v245, v3, s[16:19], 0 offen
    s_mov_b64 exec, s[42:43]
    s_cbranch_execz K2_TP
    v_cmp_gt_u32 vcc, s62, v51
    v_and_b32 v7, 0xffffff, v7
    s_mov_b64 exec, vcc
    buffer_load_dword v245, v7, s[16:19], 0 offen
    s_mov_b64 exec, s[44:45]
    s_cbranch_execz K2_TP
    v_cmp_gt_u32 vcc, s62, v52
    v_and_b32 v11, 0xffffff, v11
    s_mov_b64 exec, vcc
    buffer_load_dword v245, v11, s[16:19], 0 offen
    s_mov_b64 exec, s[46:47]
    s_cbranch_execz K2_TP
    v_cmp_gt_u32 vcc, s62, v53
    v_and_b32 v15, 0xffffff, v15
    s_mov_b64 exec, vcc
    buffer_load_dword v245, v15, s[16:19], 0 offen
    s_mov_b64 exec, s[48:49]
    s_cbranch_execz K2_TP
    v_cmp_gt_u32 vcc, s62, v54
    v_and_b32 v19, 0xffffff, v19
    s_mov_b64 exec, vcc
    buffer_load_dword v245, v19, s[16:19], 0 offen
    s_mov_b64 exec, s[50:51]
    s_cbranch_execz K2_TP
    v_cmp_gt_u32 vcc, s62, v55
    v_and_b32 v23, 0xffffff, v23
    s_mov_b64 exec, vcc
    buffer_load_dword v245, v23, s[16:19], 0 offen
    s_mov_b64 exec, s[90:91]
    s_cbranch_execz K2_TP
    v_cmp_gt_u32 vcc, s62, v56
    v_and_b32 v27, 0xffffff, v27
    s_mov_b64 exec, vcc
    buffer_load_dword v245, v27, s[16:19], 0 offen
    s_mov_b64 exec, s[92:93]
    s_cbranch_execz K2_TP
    v_cmp_gt_u32 vcc, s62, v57
    v_and_b32 v31, 0xffffff, v31
    s_mov_b64 exec, vcc
    buffer_load_dword v245, v31, s[16:19], 0 offen
    s_mov_b64 exec, s[94:95]
    s_cbranch_execz K2_TP
    v_cmp_gt_u32 vcc, s62, v58
    v_and_b32 v35, 0xffffff, v35
    s_mov_b64 exec, vcc
    buffer_load_dword v245, v35, s[16:19], 0 offen
    s_mov_b64 exec, s[96:97]
    s_cbranch_execz K2_TP
    v_cmp_gt_u32 vcc, s62, v59
    v_and_b32 v39, 0xffffff, v39
    s_mov_b64 exec, vcc
    buffer_load_dword v245, v39, s[16:19], 0 offen
K2_TP:
    s_mov_b64 exec, -1
K2_RK_DONE:
K2_PAD_SC:
    s_cbranch_execz KS_HOP
    s_mul_i32 s67, s24, 48
    s_mov_b32 s58, 1
    s_waitcnt lgkmcnt(0)
    s_mov_b64 exec, s[40:41]
    s_cbranch_execz K2_SC_DONE
    v_cmpx_gt_u32 vcc, 48, v40
    v_lshl_add_u32 v194, v40, 5, v50
    v_lshl_add_u32 v195, v40, 2, v50
    v_lshrrev_b32 v193, 3, v40
    v_mad_i32_i24 v196, v193, -16, v195
    v_and_b32 v193, 1, v193
    v_mad_i32_i24 v196, v193, -14, v196
    ds_write_b32 v194, v3 offset:864
    ds_write_b16 v195, v0 offset:194
    ds_write_b16_d16_hi v195, v0 offset:386
    ds_write_b16_d16_hi v195, v1 offset:578
    ds_write_b16 v196, v2 offset:768
    s_cmp_lg_u64 exec, s[40:41]
    s_addc_u32 s58, s58, s58
    s_mov_b64 exec, s[42:43]
    s_cbranch_execz K2_SC_DONE
    v_cmpx_gt_u32 vcc, 48, v41
    v_lshl_add_u32 v194, v41, 5, v51
    v_lshl_add_u32 v195, v41, 2, v51
    v_lshrrev_b32 v193, 3, v41
    v_mad_i32_i24 v196, v193, -16, v195
    v_and_b32 v193, 1, v193
    v_mad_i32_i24 v196, v193, -14, v196
    ds_write_b32 v194, v7 offset:864
    ds_write_b16 v195, v4 offset:194
    ds_write_b16_d16_hi v195, v4 offset:386
    ds_write_b16_d16_hi v195, v5 offset:578
    ds_write_b16 v196, v6 offset:768
    s_cmp_lg_u64 exec, s[42:43]
    s_addc_u32 s58, s58, s58
    s_mov_b64 exec, s[44:45]
    s_cbranch_execz K2_SC_DONE
    v_cmpx_gt_u32 vcc, 48, v42
    v_lshl_add_u32 v194, v42, 5, v52
    v_lshl_add_u32 v195, v42, 2, v52
    v_lshrrev_b32 v193, 3, v42
    v_mad_i32_i24 v196, v193, -16, v195
    v_and_b32 v193, 1, v193
    v_mad_i32_i24 v196, v193, -14, v196
    ds_write_b32 v194, v11 offset:864
    ds_write_b16 v195, v8 offset:194
    ds_write_b16_d16_hi v195, v8 offset:386
    ds_write_b16_d16_hi v195, v9 offset:578
    ds_write_b16 v196, v10 offset:768
    s_cmp_lg_u64 exec, s[44:45]
    s_addc_u32 s58, s58, s58
    s_mov_b64 exec, s[46:47]
    s_cbranch_execz K2_SC_DONE
    v_cmpx_gt_u32 vcc, 48, v43
    v_lshl_add_u32 v194, v43, 5, v53
    v_lshl_add_u32 v195, v43, 2, v53
    v_lshrrev_b32 v193, 3, v43
    v_mad_i32_i24 v196, v193, -16, v195
    v_and_b32 v193, 1, v193
    v_mad_i32_i24 v196, v193, -14, v196
    ds_write_b32 v194, v15 offset:864
    ds_write_b16 v195, v12 offset:194
    ds_write_b16_d16_hi v195, v12 offset:386
    ds_write_b16_d16_hi v195, v13 offset:578
    ds_write_b16 v196, v14 offset:768
    s_cmp_lg_u64 exec, s[46:47]
    s_addc_u32 s58, s58, s58
    s_mov_b64 exec, s[48:49]
    s_cbranch_execz K2_SC_DONE
    v_cmpx_gt_u32 vcc, 48, v44
    v_lshl_add_u32 v194, v44, 5, v54
    v_lshl_add_u32 v195, v44, 2, v54
    v_lshrrev_b32 v193, 3, v44
    v_mad_i32_i24 v196, v193, -16, v195
    v_and_b32 v193, 1, v193
    v_mad_i32_i24 v196, v193, -14, v196
    ds_write_b32 v194, v19 offset:864
    ds_write_b16 v195, v16 offset:194
    ds_write_b16_d16_hi v195, v16 offset:386
    ds_write_b16_d16_hi v195, v17 offset:578
    ds_write_b16 v196, v18 offset:768
    s_cmp_lg_u64 exec, s[48:49]
    s_addc_u32 s58, s58, s58
    s_mov_b64 exec, s[50:51]
    s_cbranch_execz K2_SC_DONE
    v_cmpx_gt_u32 vcc, 48, v45
    v_lshl_add_u32 v194, v45, 5, v55
    v_lshl_add_u32 v195, v45, 2, v55
    v_lshrrev_b32 v193, 3, v45
    v_mad_i32_i24 v196, v193, -16, v195
    v_and_b32 v193, 1, v193
    v_mad_i32_i24 v196, v193, -14, v196
    ds_write_b32 v194, v23 offset:864
    ds_write_b16 v195, v20 offset:194
    ds_write_b16_d16_hi v195, v20 offset:386
    ds_write_b16_d16_hi v195, v21 offset:578
    ds_write_b16 v196, v22 offset:768
    s_cmp_lg_u64 exec, s[50:51]
    s_addc_u32 s58, s58, s58
    s_mov_b64 exec, s[90:91]
    s_cbranch_execz K2_SC_DONE
    v_cmpx_gt_u32 vcc, 48, v46
    v_lshl_add_u32 v194, v46, 5, v56
    v_lshl_add_u32 v195, v46, 2, v56
    v_lshrrev_b32 v193, 3, v46
    v_mad_i32_i24 v196, v193, -16, v195
    v_and_b32 v193, 1, v193
    v_mad_i32_i24 v196, v193, -14, v196
    ds_write_b32 v194, v27 offset:864
    ds_write_b16 v195, v24 offset:194
    ds_write_b16_d16_hi v195, v24 offset:386
    ds_write_b16_d16_hi v195, v25 offset:578
    ds_write_b16 v196, v26 offset:768
    s_cmp_lg_u64 exec, s[90:91]
    s_addc_u32 s58, s58, s58
    s_mov_b64 exec, s[92:93]
    s_cbranch_execz K2_SC_DONE
    v_cmpx_gt_u32 vcc, 48, v47
    v_lshl_add_u32 v194, v47, 5, v57
    v_lshl_add_u32 v195, v47, 2, v57
    v_lshrrev_b32 v193, 3, v47
    v_mad_i32_i24 v196, v193, -16, v195
    v_and_b32 v193, 1, v193
    v_mad_i32_i24 v196, v193, -14, v196
    ds_write_b32 v194, v31 offset:864
    ds_write_b16 v195, v28 offset:194
    ds_write_b16_d16_hi v195, v28 offset:386
    ds_write_b16_d16_hi v195, v29 offset:578
    ds_write_b16 v196, v30 offset:768
    s_cmp_lg_u64 exec, s[92:93]
    s_addc_u32 s58, s58, s58
    s_mov_b64 exec, s[94:95]
    s_cbranch_execz K2_SC_DONE
    v_cmpx_gt_u32 vcc, 48, v48
    v_lshl_add_u32 v194, v48, 5, v58
    v_lshl_add_u32 v195, v48, 2, v58
    v_lshrrev_b32 v193, 3, v48
    v_mad_i32_i24 v196, v193, -16, v195
    v_and_b32 v193, 1, v193
    v_mad_i32_i24 v196, v193, -14, v196
    ds_write_b32 v194, v35 offset:864
    ds_write_b16 v195, v32 offset:194
    ds_write_b16_d16_hi v195, v32 offset:386
    ds_write_b16_d16_hi v195, v33 offset:578
    ds_write_b16 v196, v34 offset:768
    s_cmp_lg_u64 exec, s[94:95]
    s_addc_u32 s58, s58, s58
    s_mov_b64 exec, s[96:97]
    s_cbranch_execz K2_SC_DONE
    v_cmpx_gt_u32 vcc, 48, v49
    v_lshl_add_u32 v194, v49, 5, v59
    v_lshl_add_u32 v195, v49, 2, v59
    v_lshrrev_b32 v193, 3, v49
    v_mad_i32_i24 v196, v193, -16, v195
    v_and_b32 v193, 1, v193
    v_mad_i32_i24 v196, v193, -14, v196
    ds_write_b32 v194, v39 offset:864
    ds_write_b16 v195, v36 offset:194
    ds_write_b16_d16_hi v195, v36 offset:386
    ds_write_b16_d16_hi v195, v37 offset:578
    ds_write_b16 v196, v38 offset:768
    s_cmp_lg_u64 exec, s[96:97]
    s_addc_u32 s58, s58, s58
K2_SC_DONE:
    s_mov_b64 exec, -1
K2_PAD_SD:
    s_cbranch_execz KS_HOP
    s_bcnt1_i32_b32 s61, s58
    s_cmp_gt_u32 s61, 1
    s_cbranch_scc1 K2_OV
K2_OB:
    v_lshlrev_b32 v192, 2, v176
    v_add_u32 v192, 163424, v192
    v_mov_b32 v200, 163652
    v_mov_b32 v198, 0
    s_movk_i32 s26, 48
    s_cmp_eq_u32 s20, 7
    s_cbranch_scc1 K2_FLGCK
K2_FLGOK:
    s_waitcnt lgkmcnt(0)
    s_barrier
    ds_read_b32 v193, v192
    ds_read_b32 v200, v200
    v_cmp_gt_u32 s[56:57], s22, v176
    v_mad_u32_u24 v195, v176, s59, v202
    s_waitcnt lgkmcnt(0)
    v_cndmask_b32 v193, 0, v193, s[56:57]
    v_readfirstlane_b32 s27, v200
    v_cmp_lt_u32 vcc, 48, v193
    s_nop 0
    s_cbranch_vccnz K2_BIG
K2_TOK:
    v_subrev_u32 v194, s67, v193
    v_max_i32 v194, 1, v194
    v_min_i32 v194, s26, v194
    v_add_u32 v194, 15, v194
    v_lshrrev_b32 v194, 4, v194
    v_lshl_or_b32 v195, v194, 18, v195
    v_or_b32 v195, v195, v198
    v_mov_b32 v197, 425056
    v_cndmask_b32 v253, v197, v195, s[56:57]
    s_movk_i32 s40, 0
    s_movk_i32 s41, 256
    s_movk_i32 s42, 512
    s_movk_i32 s43, 768
    s_add_u32 s24, s24, 1
    s_cmp_ge_u32 s24, s25
    s_cselect_b32 s55, 1, 0
    s_cmp_eq_u32 s27, 0
    s_cselect_b32 s55, s55, 0
    s_mov_b32 s27, 0x400000
    s_mov_b32 s38, 0
    s_mov_b32 s34, 0
    s_mov_b32 s35, 0
    s_mov_b32 s36, 1
    s_mov_b32 s31, 0
    s_mov_b32 s58, s20
    v_readlane_b32 s3, v253, s58
    s_lshl_b32 s44, s34, 7
    s_lshl_b32 s60, s58, 5
    s_and_b32 s48, s3, 0x3ffff
    s_bfe_u32 s33, s3, 0x30012
    s_sub_u32 s60, s60, s48
    s_and_b32 s60, s60, 0xff
    s_add_u32 s60, s60, s48
    s_mul_i32 s35, s38, 6
    s_cmp_eq_u32 s34, 0
    s_cselect_b32 s35, s35, s60
    s_mov_b32 s45, s44
    s_add_u32 s47, s44, 256
    s_add_u32 s49, s48, 32
    s_add_u32 s60, s48, 64
    s_cmp_eq_u32 s33, 3
    s_cselect_b32 s46, s44, s47
    s_cselect_b32 s50, s60, s48
    s_cselect_b32 s51, s48, s49
    s_sub_u32 s60, s33, 2
    s_cmp_lt_u32 s60, 2
    s_cbranch_scc0 K2_rare_1
K2_back_2:
    v_add_u32 v233, s48, v230
    ds_read_b32 v232, v233
    ds_read_b32 v233, v233 offset:1024
    v_add_u32 v222, s48, v251
    ds_read_b32 v222, v222
    v_add_u32 v224, s49, v251
    ds_read_b32 v224, v224
    v_add_u32 v226, s50, v251
    ds_read_b32 v226, v226
    v_add_u32 v228, s51, v251
    ds_read_b32 v228, v228
    s_waitcnt lgkmcnt(4)
    v_or_b32 v232, v232, v231
    v_or_b32 v233, v233, v231
    s_cmp_lg_u32 s34, 0
    s_cbranch_scc1 K2_dum_4
    s_add_u32 m0, s48, 864
    s_add_u32 s65, s48, 1888
    buffer_load_dwordx4 v232, s[16:19], 0 offen  lds
    s_mov_b32 m0, s65
    s_mov_b32 exec_hi, 0
    buffer_load_dwordx4 v233, s[16:19], 0 offen  lds
    s_cmp_eq_u32 s33, 4
    s_cbranch_scc1 K2_a4_5
K2_b4_7:
    s_mov_b32 exec_hi, -1
K2_back_6:
    s_waitcnt lgkmcnt(3)
    v_mad_u32_u16 v223, v222, s39, v248 op_sel:[1,0,0,0]
    v_mad_u32_u16 v222, v222, s39, v248
    s_waitcnt lgkmcnt(2)
    v_mad_u32_u16 v225, v224, s39, v248 op_sel:[1,0,0,0]
    v_mad_u32_u16 v224, v224, s39, v248
    s_waitcnt lgkmcnt(1)
    v_mad_u32_u16 v227, v226, s39, v248 op_sel:[1,0,0,0]
    v_mad_u32_u16 v226, v226, s39, v248
    s_waitcnt lgkmcnt(0)
    v_mad_u32_u16 v229, v228, s39, v248 op_sel:[1,0,0,0]
    v_mad_u32_u16 v228, v228, s39, v248
    s_mov_b32 m0, s68
    s_nop 0
    buffer_load_dwordx4 v222, s[4:7], s44 offen sc1 lds
    buffer_load_dwordx4 v223, s[72:75], s44 offen offset:1024 sc1 lds
    s_mov_b32 m0, s69
    s_nop 0
    buffer_load_dwordx4 v224, s[4:7], s45 offen sc1 lds
    buffer_load_dwordx4 v225, s[72:75], s45 offen offset:1024 sc1 lds
    s_mov_b32 m0, s70
    s_nop 0
    buffer_load_dwordx4 v226, s[4:7], s46 offen sc1 lds
    buffer_load_dwordx4 v227, s[72:75], s46 offen offset:1024 sc1 lds
    s_mov_b32 m0, s71
    s_nop 0
    buffer_load_dwordx4 v228, s[4:7], s47 offen sc1 lds
    buffer_load_dwordx4 v229, s[72:75], s47 offen offset:1024 sc1 lds
    v_add_u32 v249, s48, v249
    v_add_u32 v250, s48, v250
    s_waitcnt vmcnt(6)
    ds_read_b64_tr_b16 v[176:177], v246 offset:0
    ds_read_b64_tr_b16 v[178:179], v246 offset:512
    ds_read_b64_tr_b16 v[180:181], v247 offset:0
    ds_read_b64_tr_b16 v[182:183], v247 offset:512
    ds_read_b64_tr_b16 v[0:1], v249 offset:0
    ds_read_b64_tr_b16 v[2:3], v249 offset:128
    ds_read_b128 v[4:7], v250 offset:0
    ds_read_b128 v[8:11], v250 offset:16
    ds_read_b128 v[12:15], v250 offset:384
    ds_read_b128 v[16:19], v250 offset:400
    ds_read_b64_tr_b16 v[20:21], v249 offset:512
    ds_read_b64_tr_b16 v[22:23], v249 offset:640
    ds_read_b128 v[24:27], v250 offset:64
    ds_read_b128 v[28:31], v250 offset:80
    ds_read_b128 v[32:35], v250 offset:448
    ds_read_b128 v[36:39], v250 offset:464
    s_mov_b32 s29, s48
    s_mov_b32 s32, s31
    s_mov_b32 s30, s3
    s_mov_b32 s31, s35
    s_cmp_eq_u32 s33, 2
    s_cbranch_scc1 K2_U20
    s_cmp_eq_u32 s33, 3
    s_cbranch_scc1 K2_U30
    s_cmp_eq_u32 s33, 1
    s_cbranch_scc1 K2_U10
    s_branch K2_U40
K2_PAD_H1:
    s_branch KS_HOP0
KS_HELP:
    s_mov_b32 s30, 0
    s_cmp_eq_u32 s20, 6
    s_cbranch_scc1 KS_RAW
    s_cmp_ge_u32 s2, 200
    s_cbranch_scc1 KS_NOW
    s_mov_b32 s30, 1
    v_and_b32 v1, 15, v8
    v_lshrrev_b32 v3, 4, v8
    s_cmp_ge_u32 s2, 160
    s_cbranch_scc1 K1_WT
    s_cmp_ge_u32 s2, 64
    s_cbranch_scc1 K1_S1
    s_lshr_b32 s24, s2, 3
    s_and_b32 s25, s2, 7
    s_lshr_b32 s26, s25, 2
    s_bfe_u32 s27, s25, 0x10001
    s_and_b32 s28, s25, 1
    s_mov_b32 s60, s92
    s_and_b32 s61, s93, 0xffff
    s_mov_b32 s62, 65536
    s_mov_b32 s63, 0x20000
    s_branch K1_SC
K1_S1:
    s_sub_u32 s29, s2, 64
    s_mul_i32 s24, s29, 43
    s_lshr_b32 s24, s24, 9
    s_mul_i32 s25, s24, 12
    s_sub_u32 s25, s29, s25
    s_cmp_ge_u32 s25, 6
    s_cselect_b32 s26, 1, 0
    s_mul_i32 s27, s26, 6
    s_sub_u32 s27, s25, s27
    s_lshr_b32 s27, s27, 1
    s_and_b32 s28, s25, 1
    s_add_u32 s25, s25, 8
    s_mov_b32 s60, s94
    s_and_b32 s61, s95, 0xffff
    s_mov_b32 s62, 98304
    s_mov_b32 s63, 0x20000
K1_SC:
    s_lshl_b32 s27, s27, 7
    s_lshl_b32 s26, s26, 6
    s_lshl_b32 s28, s28, 4
    s_add_u32 s27, s27, s26
    s_add_u32 s27, s27, s28
    s_lshl_b32 s27, s27, 8
    s_lshl_b32 s26, s24, 5
    s_add_u32 s27, s27, s26
    s_add_u32 s29, s27, 8192
    v_lshlrev_b32 v3, 10, v3
    v_lshl_add_u32 v3, v1, 1, v3
    buffer_load_ushort v64, v3, s[60:63], s27 offen offset:0
    buffer_load_ushort v65, v3, s[60:63], s29 offen offset:0
    buffer_load_ushort v66, v3, s[60:63], s27 offen offset:256
    buffer_load_ushort v67, v3, s[60:63], s29 offen offset:256
    buffer_load_ushort v68, v3, s[60:63], s27 offen offset:512
    buffer_load_ushort v69, v3, s[60:63], s29 offen offset:512
    buffer_load_ushort v70, v3, s[60:63], s27 offen offset:768
    buffer_load_ushort v71, v3, s[60:63], s29 offen offset:768
    s_mul_i32 s24, s24, 20
    s_add_u32 s24, s24, s25
    s_lshl_b32 s24, s24, 10
    s_add_u32 s24, s24, 6946816
    s_branch K1_GO
K1_WT:
    s_sub_u32 s24, s2, 160
    s_cmp_ge_u32 s24, 20
    s_cselect_b32 s26, 1, 0
    s_mul_i32 s25, s26, 20
    s_sub_u32 s25, s24, s25
    s_lshr_b32 s27, s25, 2
    s_bfe_u32 s28, s25, 0x10001
    s_and_b32 s25, s25, 1
    s_mul_i32 s25, s25, 10240
    s_lshl_b32 s27, s27, 8
    s_lshl_b32 s26, s26, 7
    s_lshl_b32 s28, s28, 6
    s_add_u32 s27, s27, s26
    s_add_u32 s27, s27, s28
    s_add_u32 s27, s27, s25
    s_mov_b32 s60, s90
    s_and_b32 s61, s91, 0xffff
    s_mov_b32 s62, 20480
    s_mov_b32 s63, 0x20000
    v_and_b32 v1, 31, v8
    v_lshrrev_b32 v3, 5, v8
    v_mul_u32_u24 v3, 5120, v3
    v_lshl_add_u32 v3, v1, 1, v3
    v_mov_b32 v64, 0
    v_mov_b32 v66, 0
    v_mov_b32 v68, 0
    v_mov_b32 v70, 0
    buffer_load_ushort v65, v3, s[60:63], s27 offen offset:0
    buffer_load_ushort v67, v3, s[60:63], s27 offen offset:1280
    buffer_load_ushort v69, v3, s[60:63], s27 offen offset:2560
    buffer_load_ushort v71, v3, s[60:63], s27 offen offset:3840
    s_lshl_b32 s24, s24, 10
    s_add_u32 s24, s24, 7110656
K1_GO:
KS_NOW:
    s_barrier
K2_PAD_H2:
    s_cbranch_execz KS_HOP0
KS_FILL:
    v_subrev_u32 v76, 320, v0
    v_mov_b32 v80, -1
    v_mov_b32 v77, 1.0
    v_cmp_gt_u32 vcc, 48, v76
    v_lshlrev_b32 v78, 4, v76
    v_add_u32 v78, 65536, v78
    v_cndmask_b32 v80, v80, 0, vcc
    v_cmp_gt_u32 vcc, 12, v76
    v_add_u32 v79, 64800, v78
    s_nop 0
    v_cndmask_b32 v80, v80, v77, vcc
    v_cmp_gt_u32 s[56:57], 54, v8
    v_mov_b32 v81, v80
    v_mov_b32 v82, v80
    v_mov_b32 v83, v80
    ds_write_b128 v78, v[80:83] offset:0
    ds_write_b128 v78, v[80:83] offset:2400
    ds_write_b128 v78, v[80:83] offset:4800
    ds_write_b128 v78, v[80:83] offset:7200
    ds_write_b128 v78, v[80:83] offset:9600
    ds_write_b128 v78, v[80:83] offset:12000
    ds_write_b128 v78, v[80:83] offset:14400
    ds_write_b128 v78, v[80:83] offset:16800
    ds_write_b128 v78, v[80:83] offset:19200
    ds_write_b128 v78, v[80:83] offset:21600
    ds_write_b128 v78, v[80:83] offset:24000
    ds_write_b128 v78, v[80:83] offset:26400
    ds_write_b128 v78, v[80:83] offset:28800
    ds_write_b128 v78, v[80:83] offset:31200
    ds_write_b128 v78, v[80:83] offset:33600
    ds_write_b128 v78, v[80:83] offset:36000
    ds_write_b128 v78, v[80:83] offset:38400
    ds_write_b128 v78, v[80:83] offset:40800
    ds_write_b128 v78, v[80:83] offset:43200
    ds_write_b128 v78, v[80:83] offset:45600
    ds_write_b128 v78, v[80:83] offset:48000
    ds_write_b128 v78, v[80:83] offset:50400
    ds_write_b128 v78, v[80:83] offset:52800
    ds_write_b128 v78, v[80:83] offset:55200
    ds_write_b128 v78, v[80:83] offset:57600
    ds_write_b128 v78, v[80:83] offset:60000
    ds_write_b128 v78, v[80:83] offset:62400
    ds_write_b128 v79, v[80:83] offset:0
    ds_write_b128 v79, v[80:83] offset:2400
    ds_write_b128 v79, v[80:83] offset:4800
    ds_write_b128 v79, v[80:83] offset:7200
    ds_write_b128 v79, v[80:83] offset:9600
    ds_write_b128 v79, v[80:83] offset:12000
    ds_write_b128 v79, v[80:83] offset:14400
    ds_write_b128 v79, v[80:83] offset:16800
    ds_write_b128 v79, v[80:83] offset:19200
    ds_write_b128 v79, v[80:83] offset:21600
    ds_write_b128 v79, v[80:83] offset:24000
    ds_write_b128 v79, v[80:83] offset:26400
    ds_write_b128 v79, v[80:83] offset:28800
    v_mov_b32 v59, 163728
    s_barrier
    ds_read_b32 v59, v59
    s_cmp_eq_u32 s20, 6
    s_cselect_b64 exec, s[56:57], -1
    ds_write_b128 v79, v[80:83] offset:31200
    s_mov_b64 exec, -1
    s_waitcnt vmcnt(0) lgkmcnt(0)
    s_cmp_eq_u32 s30, 0
    s_cbranch_scc1 KS_B3
    v_lshl_or_b32 v40, v65, 16, v64
    v_lshl_or_b32 v41, v67, 16, v66
    v_lshl_or_b32 v42, v69, 16, v68
    v_lshl_or_b32 v43, v71, 16, v70
    buffer_store_dwordx4 v[40:43], v9, s[8:11], s24 offen sc1
    s_waitcnt lgkmcnt(0)
    s_barrier
    s_lshl_b32 s24, s2, 2
    s_add_u32 s24, s24, 7176192
    s_mov_b64 exec, 1
    s_waitcnt vmcnt(0)
    buffer_store_dword v59, v6, s[8:11], s24 offen sc1
    s_mov_b64 exec, -1
    s_branch KS_JOIN
K2_PAD_H3:
    s_branch KS_HOP0
KS_RAW:
    s_barrier
    s_mov_b32 s60, s90
    s_and_b32 s61, s91, 0xffff
    s_mov_b32 s62, 20480
    s_mov_b32 s63, 0x20000
    s_mov_b32 m0, 24576
    s_movk_i32 s24, 0
    buffer_load_dwordx4 v9, s[60:63], s24 offen offset:0 lds
    buffer_load_dwordx4 v9, s[60:63], s24 offen offset:1024 lds
    buffer_load_dwordx4 v9, s[60:63], s24 offen offset:2048 lds
    buffer_load_dwordx4 v9, s[60:63], s24 offen offset:3072 lds
    s_mov_b32 m0, 28672
    s_movk_i32 s24, 4096
    buffer_load_dwordx4 v9, s[60:63], s24 offen offset:0 lds
    buffer_load_dwordx4 v9, s[60:63], s24 offen offset:1024 lds
    buffer_load_dwordx4 v9, s[60:63], s24 offen offset:2048 lds
    buffer_load_dwordx4 v9, s[60:63], s24 offen offset:3072 lds
    s_mov_b32 m0, 32768
    s_movk_i32 s24, 8192
    buffer_load_dwordx4 v9, s[60:63], s24 offen offset:0 lds
    buffer_load_dwordx4 v9, s[60:63], s24 offen offset:1024 lds
    buffer_load_dwordx4 v9, s[60:63], s24 offen offset:2048 lds
    buffer_load_dwordx4 v9, s[60:63], s24 offen offset:3072 lds
    s_mov_b32 m0, 36864
    s_movk_i32 s24, 12288
    buffer_load_dwordx4 v9, s[60:63], s24 offen offset:0 lds
    buffer_load_dwordx4 v9, s[60:63], s24 offen offset:1024 lds
    buffer_load_dwordx4 v9, s[60:63], s24 offen offset:2048 lds
    buffer_load_dwordx4 v9, s[60:63], s24 offen offset:3072 lds
    s_mov_b32 m0, 40960
    s_movk_i32 s24, 16384
    buffer_load_dwordx4 v9, s[60:63], s24 offen offset:0 lds
    buffer_load_dwordx4 v9, s[60:63], s24 offen offset:1024 lds
    buffer_load_dwordx4 v9, s[60:63], s24 offen offset:2048 lds
    buffer_load_dwordx4 v9, s[60:63], s24 offen offset:3072 lds
    s_branch KS_FILL
KS_IDLE:
    s_barrier
    v_mul_u32_u24 v76, 2979, v0
    v_lshrrev_b32 v76, 16, v76
    v_mul_u32_u24 v77, 2048, v76
    v_lshl_add_u32 v78, v0, 4, v77
    v_add_u32 v78, 67584, v78
    v_add_u32 v79, 67200, v78
    v_mov_b32 v80, -1
    v_mov_b32 v81, -1
    v_cmp_gt_u32 vcc, 14, v76
    v_cmp_gt_u32 s[56:57], 12, v76
    v_mov_b32 v82, -1
    v_mov_b32 v83, -1
    s_mov_b64 exec, vcc
    ds_write_b128 v78, v[80:83]
    ds_write_b128 v78, v[80:83] offset:33600
    s_mov_b64 exec, s[56:57]
    ds_write_b128 v79, v[80:83]
    s_mov_b64 exec, -1
    s_barrier
    s_branch KS_B3
K2_PAD_U20:
    s_branch K2_HOP
K2_U20:
    s_setprio 1
    s_waitcnt lgkmcnt(6)
    v_lshlrev_b32 v40, 16, v0
    v_and_b32 v41, 0xffff0000, v0
    v_lshlrev_b32 v42, 16, v1
    v_and_b32 v43, 0xffff0000, v1
    v_lshlrev_b32 v44, 16, v2
    v_and_b32 v45, 0xffff0000, v2
    v_lshlrev_b32 v46, 16, v3
    v_and_b32 v47, 0xffff0000, v3
    v_mul_f32 v4, v40, v4
    v_mul_f32 v5, v41, v5
    v_mul_f32 v6, v42, v6
    v_mul_f32 v7, v43, v7
    v_mul_f32 v8, v44, v8
    v_mul_f32 v9, v45, v9
    v_mul_f32 v10, v46, v10
    v_mul_f32 v11, v47, v11
    v_cvt_pk_bf16_f32 v64, v4, v5
    v_cvt_pk_bf16_f32 v65, v6, v7
    v_cvt_pk_bf16_f32 v66, v8, v9
    v_cvt_pk_bf16_f32 v67, v10, v11
    v_mul_f32 v12, v40, v12
    v_mul_f32 v13, v41, v13
    v_mul_f32 v14, v42, v14
    v_mul_f32 v15, v43, v15
    v_mul_f32 v16, v44, v16
    v_mul_f32 v17, v45, v17
    v_mul_f32 v18, v46, v18
    v_mul_f32 v19, v47, v19
    v_cvt_pk_bf16_f32 v68, v12, v13
    v_cvt_pk_bf16_f32 v69, v14, v15
    v_cvt_pk_bf16_f32 v70, v16, v17
    v_cvt_pk_bf16_f32 v71, v18, v19
    s_waitcnt lgkmcnt(0)
    v_lshlrev_b32 v48, 16, v20
    v_and_b32 v49, 0xffff0000, v20
    v_lshlrev_b32 v50, 16, v21
    v_and_b32 v51, 0xffff0000, v21
    v_lshlrev_b32 v52, 16, v22
    v_and_b32 v53, 0xffff0000, v22
    v_lshlrev_b32 v54, 16, v23
    v_and_b32 v55, 0xffff0000, v23
    v_mul_f32 v24, v48, v24
    v_mul_f32 v25, v49, v25
    v_mul_f32 v26, v50, v26
    v_mul_f32 v27, v51, v27
    v_mul_f32 v28, v52, v28
    v_mul_f32 v29, v53, v29
    v_mul_f32 v30, v54, v30
    v_mul_f32 v31, v55, v31
    v_cvt_pk_bf16_f32 v72, v24, v25
    v_cvt_pk_bf16_f32 v73, v26, v27
    v_cvt_pk_bf16_f32 v74, v28, v29
    v_cvt_pk_bf16_f32 v75, v30, v31
    v_mul_f32 v32, v48, v32
    v_mul_f32 v33, v49, v33
    v_mul_f32 v34, v50, v34
    v_mul_f32 v35, v51, v35
    v_mul_f32 v36, v52, v36
    v_mul_f32 v37, v53, v37
    v_mul_f32 v38, v54, v38
    v_mul_f32 v39, v55, v39
    v_cvt_pk_bf16_f32 v76, v32, v33
    v_cvt_pk_bf16_f32 v77, v34, v35
    v_cvt_pk_bf16_f32 v78, v36, v37
    v_cvt_pk_bf16_f32 v79, v38, v39
    s_waitcnt vmcnt(4)
    v_mfma_f32_32x32x16_bf16 v[0:15], v[64:67], v[176:179], 0
    ds_read_b64_tr_b16 v[184:185], v246 offset:2048
    ds_read_b64_tr_b16 v[186:187], v246 offset:2560
    ds_read_b64_tr_b16 v[188:189], v247 offset:2048
    ds_read_b64_tr_b16 v[190:191], v247 offset:2560
    s_mov_b32 m0, s68
    v_mfma_f32_32x32x16_bf16 v[16:31], v[68:71], v[176:179], 0
    buffer_load_dwordx4 v222, s[4:7], s42 offen sc1 lds
    buffer_load_dwordx4 v223, s[72:75], s42 offen offset:1024 sc1 lds
    v_permlane32_swap_b32 v242, v236
    v_permlane32_swap_b32 v243, v237
    s_add_u32 s38, s38, 1
    v_mfma_f32_32x32x16_bf16 v[32:47], v[64:67], v[180:183], 0
    v_permlane32_swap_b32 v244, v238
    v_permlane32_swap_b32 v245, v239
    v_permlane32_swap_b32 v240, v241
    v_add_f32 v242, v242, v236
    v_mfma_f32_32x32x16_bf16 v[48:63], v[68:71], v[180:183], 0
    v_add_f32 v243, v243, v237
    v_add_f32 v244, v244, v238
    v_add_f32 v245, v245, v239
    v_add_f32 v240, -v240, -v241
    v_mov_b32 v254, s52
    v_mov_b32 v255, s38
    s_waitcnt vmcnt(4) lgkmcnt(0)
    v_mfma_f32_32x32x16_bf16 v[0:15], v[72:75], v[184:187], v[0:15]
    ds_read_b64_tr_b16 v[176:177], v246 offset:4096
    ds_read_b64_tr_b16 v[178:179], v246 offset:4608
    ds_read_b64_tr_b16 v[180:181], v247 offset:4096
    ds_read_b64_tr_b16 v[182:183], v247 offset:4608
    s_lshl_b32 s58, s38, 3
    s_add_u32 s58, s58, s20
    s_mov_b32 m0, s69
    v_mfma_f32_32x32x16_bf16 v[16:31], v[76:79], v[184:187], v[16:31]
    buffer_load_dwordx4 v224, s[4:7], s42 offen sc1 lds
    buffer_load_dwordx4 v225, s[72:75], s42 offen offset:1024 sc1 lds
    s_set_gpr_idx_on s32, gpr_idx(DST)
    s_nop 0
    v_cvt_pk_bf16_f32 v195, v242, v243
    v_cvt_pk_bf16_f32 v196, v244, v245
    v_cvt_pk_bf16_f32 v197, v240, v240
    s_set_gpr_idx_off
    s_mov_b64 exec, 1
    ds_write_b32 v254, v255
    s_mov_b64 exec, -1
    s_cmp_lt_u32 s58, s22
    s_cbranch_scc0 K2_dyn_8
K2_back_9:
    v_readlane_b32 s3, v253, s58
    s_lshl_b32 s44, s34, 7
    s_lshl_b32 s60, s58, 5
    s_and_b32 s48, s3, 0x3ffff
    s_bfe_u32 s33, s3, 0x30012
    s_sub_u32 s60, s60, s48
    s_and_b32 s60, s60, 0xff
    s_add_u32 s60, s60, s48
    s_mul_i32 s35, s38, 6
    s_cmp_eq_u32 s34, 0
    s_cselect_b32 s35, s35, s60
    s_mov_b32 s45, s44
    s_add_u32 s47, s44, 256
    s_add_u32 s49, s48, 32
    s_add_u32 s60, s48, 64
    s_cmp_eq_u32 s33, 3
    s_cselect_b32 s46, s44, s47
    s_cselect_b32 s50, s60, s48
    s_cselect_b32 s51, s48, s49
    s_sub_u32 s60, s33, 2
    s_cmp_lt_u32 s60, 2
    s_cbranch_scc0 K2_rare_14
K2_back_15:
    v_mfma_f32_32x32x16_bf16 v[32:47], v[72:75], v[188:191], v[32:47]
    v_add_u32 v233, s48, v230
    ds_read_b32 v232, v233
    ds_read_b32 v233, v233 offset:1024
    v_mul_f32 v234, v0, v96
    v_mul_f32 v236, v8, v128
    v_fmac_f32 v234, v1, v97
    v_fmac_f32 v236, v9, v129
    v_mfma_f32_32x32x16_bf16 v[48:63], v[76:79], v[188:191], v[48:63]
    s_setprio 0
    v_fmac_f32 v234, v2, v98
    v_fmac_f32 v236, v10, v130
    v_fmac_f32 v234, v3, v99
    v_fmac_f32 v236, v11, v131
    v_fmac_f32 v234, v4, v100
    v_fmac_f32 v236, v12, v132
    v_fmac_f32 v234, v5, v101
    v_fmac_f32 v236, v13, v133
    v_fmac_f32 v234, v6, v102
    v_fmac_f32 v236, v14, v134
    v_fmac_f32 v234, v7, v103
    v_fmac_f32 v236, v15, v135
    v_mul_f32 v238, v16, v128
    v_mul_f32 v240, v24, v128
    v_fmac_f32 v238, v17, v129
    v_fmac_f32 v240, v25, v129
    v_fmac_f32 v238, v18, v130
    v_fmac_f32 v240, v26, v130
    v_fmac_f32 v238, v19, v131
    v_fmac_f32 v240, v27, v131
    v_fmac_f32 v238, v20, v132
    v_fmac_f32 v240, v28, v132
    v_fmac_f32 v238, v21, v133
    v_fmac_f32 v240, v29, v133
    v_fmac_f32 v238, v22, v134
    v_fmac_f32 v240, v30, v134
    v_fmac_f32 v238, v23, v135
    v_fmac_f32 v240, v31, v135
    v_mul_f32 v235, v32, v104
    v_mul_f32 v237, v40, v136
    v_fmac_f32 v235, v33, v105
    v_fmac_f32 v237, v41, v137
    v_fmac_f32 v235, v34, v106
    v_fmac_f32 v237, v42, v138
    v_fmac_f32 v235, v35, v107
    v_fmac_f32 v237, v43, v139
    v_fmac_f32 v235, v36, v108
    v_fmac_f32 v237, v44, v140
    v_fmac_f32 v235, v37, v109
    v_fmac_f32 v237, v45, v141
    v_fmac_f32 v235, v38, v110
    v_fmac_f32 v237, v46, v142
    v_fmac_f32 v235, v39, v111
    v_fmac_f32 v237, v47, v143
    v_mul_f32 v239, v48, v136
    v_mul_f32 v241, v56, v136
    v_fmac_f32 v239, v49, v137
    v_fmac_f32 v241, v57, v137
    s_setprio 1
    s_waitcnt vmcnt(4) lgkmcnt(3)
    v_mfma_f32_32x32x16_bf16 v[0:15], v[64:67], v[176:179], 0
    ds_read_b64_tr_b16 v[184:185], v246 offset:6144
    ds_read_b64_tr_b16 v[186:187], v246 offset:6656
    ds_read_b64_tr_b16 v[188:189], v247 offset:6144
    ds_read_b64_tr_b16 v[190:191], v247 offset:6656
    v_fmac_f32 v239, v50, v138
    v_fmac_f32 v241, v58, v138
    s_mov_b32 m0, s70
    v_mfma_f32_32x32x16_bf16 v[16:31], v[68:71], v[176:179], 0
    buffer_load_dwordx4 v222, s[4:7], s43 offen sc1 lds
    buffer_load_dwordx4 v223, s[72:75], s43 offen offset:1024 sc1 lds
    v_fmac_f32 v239, v51, v139
    v_fmac_f32 v241, v59, v139
    v_fmac_f32 v239, v52, v140
    v_fmac_f32 v241, v60, v140
    v_fmac_f32 v239, v53, v141
    v_mfma_f32_32x32x16_bf16 v[32:47], v[64:67], v[180:183], 0
    v_add_u32 v222, s48, v251
    ds_read_b32 v222, v222
    v_fmac_f32 v241, v61, v141
    v_fmac_f32 v239, v54, v142
    v_fmac_f32 v241, v62, v142
    v_fmac_f32 v239, v55, v143
    v_fmac_f32 v241, v63, v143
    v_mfma_f32_32x32x16_bf16 v[48:63], v[68:71], v[180:183], 0
    v_permlane32_swap_b32 v234, v236
    v_permlane32_swap_b32 v235, v237
    v_permlane32_swap_b32 v240, v238
    s_waitcnt lgkmcnt(5)
    v_or_b32 v232, v232, v231
    v_or_b32 v233, v233, v231
    s_cmp_lg_u32 s34, 0
    s_cbranch_scc1 K2_dum_17
    s_add_u32 m0, s48, 864
    s_add_u32 s65, s48, 1888
    buffer_load_dwordx4 v232, s[16:19], 0 offen  lds
    s_mov_b32 m0, s65
    s_mov_b32 exec_hi, 0
    buffer_load_dwordx4 v233, s[16:19], 0 offen  lds
    s_cmp_eq_u32 s33, 4
    s_cbranch_scc1 K2_a4_18
K2_b4_20:
    s_mov_b32 exec_hi, -1
K2_back_19:
    s_waitcnt vmcnt(6) lgkmcnt(1)
    v_mfma_f32_32x32x16_bf16 v[0:15], v[72:75], v[184:187], v[0:15]
    ds_read_b64_tr_b16 v[176:177], v246 offset:0
    ds_read_b64_tr_b16 v[178:179], v246 offset:512
    ds_read_b64_tr_b16 v[180:181], v247 offset:0
    ds_read_b64_tr_b16 v[182:183], v247 offset:512
    v_permlane32_swap_b32 v241, v239
    s_mov_b32 m0, s71
    v_mfma_f32_32x32x16_bf16 v[16:31], v[76:79], v[184:187], v[16:31]
    buffer_load_dwordx4 v224, s[4:7], s43 offen sc1 lds
    buffer_load_dwordx4 v225, s[72:75], s43 offen offset:1024 sc1 lds
    s_waitcnt lgkmcnt(4)
    v_mad_u32_u16 v223, v222, s39, v248 op_sel:[1,0,0,0]
    v_mad_u32_u16 v222, v222, s39, v248
    v_add_f32 v234, v234, v236
    v_add_f32 v235, v235, v237
    v_add_f32 v240, v240, v238
    v_add_f32 v241, v241, v239
    s_set_gpr_idx_on s31, gpr_idx(DST)
    s_nop 0
    v_cvt_pk_bf16_f32 v192, v234, v235
    v_cvt_pk_bf16_f32 v193, v240, v241
    s_set_gpr_idx_off
    v_mfma_f32_32x32x16_bf16 v[32:47], v[72:75], v[188:191], v[32:47]
    v_add_u32 v224, s49, v251
    ds_read_b32 v224, v224
    v_mul_f32 v234, v0, v144
    v_mul_f32 v236, v8, v112
    v_fmac_f32 v234, v1, v145
    v_fmac_f32 v236, v9, v113
    v_fmac_f32 v234, v2, v146
    v_mfma_f32_32x32x16_bf16 v[48:63], v[76:79], v[188:191], v[48:63]
    s_setprio 0
    v_fmac_f32 v236, v10, v114
    v_fmac_f32 v234, v3, v147
    v_fmac_f32 v236, v11, v115
    v_fmac_f32 v234, v4, v148
    v_fmac_f32 v236, v12, v116
    v_fmac_f32 v234, v5, v149
    v_fmac_f32 v236, v13, v117
    v_fmac_f32 v234, v6, v150
    v_fmac_f32 v236, v14, v118
    v_fmac_f32 v234, v7, v151
    v_fmac_f32 v236, v15, v119
    v_mul_f32 v238, v16, v160
    v_mul_f32 v240, v24, v160
    v_fmac_f32 v238, v17, v161
    v_fmac_f32 v240, v25, v161
    v_fmac_f32 v238, v18, v162
    v_fmac_f32 v240, v26, v162
    v_fmac_f32 v238, v19, v163
    v_fmac_f32 v240, v27, v163
    v_fmac_f32 v238, v20, v164
    v_fmac_f32 v240, v28, v164
    v_fmac_f32 v238, v21, v165
    v_fmac_f32 v240, v29, v165
    v_fmac_f32 v238, v22, v166
    v_fmac_f32 v240, v30, v166
    v_fmac_f32 v238, v23, v167
    v_fmac_f32 v240, v31, v167
    v_mul_f32 v235, v32, v152
    v_mul_f32 v237, v40, v120
    v_fmac_f32 v235, v33, v153
    v_fmac_f32 v237, v41, v121
    v_fmac_f32 v235, v34, v154
    v_fmac_f32 v237, v42, v122
    v_fmac_f32 v235, v35, v155
    v_fmac_f32 v237, v43, v123
    v_fmac_f32 v235, v36, v156
    v_fmac_f32 v237, v44, v124
    v_fmac_f32 v235, v37, v157
    v_fmac_f32 v237, v45, v125
    v_fmac_f32 v235, v38, v158
    v_fmac_f32 v237, v46, v126
    v_fmac_f32 v235, v39, v159
    v_fmac_f32 v237, v47, v127
    v_mul_f32 v239, v48, v168
    v_mul_f32 v241, v56, v168
    v_fmac_f32 v239, v49, v169
    v_fmac_f32 v241, v57, v169
    v_fmac_f32 v239, v50, v170
    v_fmac_f32 v241, v58, v170
    v_fmac_f32 v239, v51, v171
    s_setprio 1
    s_waitcnt vmcnt(6) lgkmcnt(1)
    v_mfma_f32_32x32x16_bf16 v[0:15], v[64:67], v[176:179], 0
    ds_read_b64_tr_b16 v[184:185], v246 offset:2048
    ds_read_b64_tr_b16 v[186:187], v246 offset:2560
    ds_read_b64_tr_b16 v[188:189], v247 offset:2048
    ds_read_b64_tr_b16 v[190:191], v247 offset:2560
    v_fmac_f32 v241, v59, v171
    v_fmac_f32 v239, v52, v172
    s_mov_b32 m0, s68
    v_mfma_f32_32x32x16_bf16 v[16:31], v[68:71], v[176:179], 0
    buffer_load_dwordx4 v222, s[4:7], s44 offen sc1 lds
    buffer_load_dwordx4 v223, s[72:75], s44 offen offset:1024 sc1 lds
    s_waitcnt lgkmcnt(4)
    v_mad_u32_u16 v225, v224, s39, v248 op_sel:[1,0,0,0]
    v_mad_u32_u16 v224, v224, s39, v248
    v_fmac_f32 v241, v60, v172
    v_fmac_f32 v239, v53, v173
    v_mfma_f32_32x32x16_bf16 v[32:47], v[64:67], v[180:183], 0
    v_add_u32 v226, s50, v251
    ds_read_b32 v226, v226
    v_fmac_f32 v241, v61, v173
    v_fmac_f32 v239, v54, v174
    v_fmac_f32 v241, v62, v174
    v_fmac_f32 v239, v55, v175
    v_fmac_f32 v241, v63, v175
    v_mfma_f32_32x32x16_bf16 v[48:63], v[68:71], v[180:183], 0
    s_waitcnt vmcnt(6) lgkmcnt(1)
    v_mfma_f32_32x32x16_bf16 v[0:15], v[72:75], v[184:187], v[0:15]
    ds_read_b64_tr_b16 v[176:177], v246 offset:4096
    ds_read_b64_tr_b16 v[178:179], v246 offset:4608
    ds_read_b64_tr_b16 v[180:181], v247 offset:4096
    ds_read_b64_tr_b16 v[182:183], v247 offset:4608
    s_mov_b32 m0, s69
    v_mfma_f32_32x32x16_bf16 v[16:31], v[76:79], v[184:187], v[16:31]
    buffer_load_dwordx4 v224, s[4:7], s45 offen sc1 lds
    buffer_load_dwordx4 v225, s[72:75], s45 offen offset:1024 sc1 lds
    s_waitcnt lgkmcnt(4)
    v_mad_u32_u16 v227, v226, s39, v248 op_sel:[1,0,0,0]
    v_mad_u32_u16 v226, v226, s39, v248
    v_mfma_f32_32x32x16_bf16 v[32:47], v[72:75], v[188:191], v[32:47]
    v_add_u32 v228, s51, v251
    ds_read_b32 v228, v228
    v_mul_f32 v242, v0, v144
    v_fma_f32 v238, v8, v160, -v238
    v_fmac_f32 v242, v1, v145
    v_fmac_f32 v238, v9, v161
    v_fmac_f32 v242, v2, v146
    v_mfma_f32_32x32x16_bf16 v[48:63], v[76:79], v[188:191], v[48:63]
    s_setprio 0
    v_fmac_f32 v238, v10, v162
    v_fmac_f32 v242, v3, v147
    v_fmac_f32 v238, v11, v163
    v_fmac_f32 v242, v4, v148
    v_fmac_f32 v238, v12, v164
    v_fmac_f32 v242, v5, v149
    v_fmac_f32 v238, v13, v165
    v_fmac_f32 v242, v6, v150
    v_fmac_f32 v238, v14, v166
    v_fmac_f32 v242, v7, v151
    v_fmac_f32 v238, v15, v167
    v_fmac_f32 v236, v16, v112
    v_mul_f32 v244, v24, v160
    v_fmac_f32 v236, v17, v113
    v_fmac_f32 v244, v25, v161
    v_fmac_f32 v236, v18, v114
    v_fmac_f32 v244, v26, v162
    v_fmac_f32 v236, v19, v115
    v_fmac_f32 v244, v27, v163
    v_fmac_f32 v236, v20, v116
    v_fmac_f32 v244, v28, v164
    v_fmac_f32 v236, v21, v117
    v_fmac_f32 v244, v29, v165
    v_fmac_f32 v236, v22, v118
    v_fmac_f32 v244, v30, v166
    v_fmac_f32 v236, v23, v119
    v_fmac_f32 v244, v31, v167
    v_mul_f32 v243, v32, v152
    v_fma_f32 v239, v40, v168, -v239
    v_fmac_f32 v243, v33, v153
    v_fmac_f32 v239, v41, v169
    v_fmac_f32 v243, v34, v154
    v_fmac_f32 v239, v42, v170
    v_fmac_f32 v243, v35, v155
    v_fmac_f32 v239, v43, v171
    v_fmac_f32 v243, v36, v156
    v_fmac_f32 v239, v44, v172
    v_fmac_f32 v243, v37, v157
    v_fmac_f32 v239, v45, v173
    v_fmac_f32 v243, v38, v158
    v_fmac_f32 v239, v46, v174
    v_fmac_f32 v243, v39, v159
    v_fmac_f32 v239, v47, v175
    v_fmac_f32 v237, v48, v120
    v_mul_f32 v245, v56, v168
    v_fmac_f32 v237, v49, v121
    v_fmac_f32 v245, v57, v169
    v_fmac_f32 v237, v50, v122
    s_setprio 1
    s_waitcnt vmcnt(4) lgkmcnt(1)
    v_mfma_f32_32x32x16_bf16 v[0:15], v[64:67], v[176:179], 0
    ds_read_b64_tr_b16 v[184:185], v246 offset:6144
    ds_read_b64_tr_b16 v[186:187], v246 offset:6656
    ds_read_b64_tr_b16 v[188:189], v247 offset:6144
    ds_read_b64_tr_b16 v[190:191], v247 offset:6656
    v_fmac_f32 v245, v58, v170
    v_fmac_f32 v237, v51, v123
    s_mov_b32 m0, s70
    v_mfma_f32_32x32x16_bf16 v[16:31], v[68:71], v[176:179], 0
    buffer_load_dwordx4 v226, s[4:7], s46 offen sc1 lds
    buffer_load_dwordx4 v227, s[72:75], s46 offen offset:1024 sc1 lds
    s_waitcnt lgkmcnt(4)
    v_mad_u32_u16 v229, v228, s39, v248 op_sel:[1,0,0,0]
    v_mad_u32_u16 v228, v228, s39, v248
    v_fmac_f32 v245, v59, v171
    v_fmac_f32 v237, v52, v124
    v_mfma_f32_32x32x16_bf16 v[32:47], v[64:67], v[180:183], 0
    v_fmac_f32 v245, v60, v172
    v_fmac_f32 v237, v53, v125
    v_fmac_f32 v245, v61, v173
    v_fmac_f32 v237, v54, v126
    v_fmac_f32 v245, v62, v174
    v_fmac_f32 v237, v55, v127
    v_fmac_f32 v245, v63, v175
    v_mfma_f32_32x32x16_bf16 v[48:63], v[68:71], v[180:183], 0
    v_permlane32_swap_b32 v242, v234
    v_permlane32_swap_b32 v243, v235
    v_add_f32 v242, v242, v234
    v_add_f32 v243, v243, v235
    s_waitcnt vmcnt(4) lgkmcnt(0)
    v_mfma_f32_32x32x16_bf16 v[0:15], v[72:75], v[184:187], v[0:15]
    ds_read_b64_tr_b16 v[176:177], v246 offset:0
    ds_read_b64_tr_b16 v[178:179], v246 offset:512
    ds_read_b64_tr_b16 v[180:181], v247 offset:0
    ds_read_b64_tr_b16 v[182:183], v247 offset:512
    s_sub_u32 s26, s48, s29
    s_mov_b32 s29, s48
    s_mov_b32 m0, s71
    v_mfma_f32_32x32x16_bf16 v[16:31], v[76:79], v[184:187], v[16:31]
    buffer_load_dwordx4 v228, s[4:7], s47 offen sc1 lds
    buffer_load_dwordx4 v229, s[72:75], s47 offen offset:1024 sc1 lds
    s_set_gpr_idx_on s31, gpr_idx(DST)
    s_nop 0
    v_cvt_pk_bf16_f32 v194, v242, v243
    s_set_gpr_idx_off
    s_mov_b32 s30, s3
    s_cmp_eq_u32 s34, 0
    s_cselect_b32 s56, s33, 0
    v_mfma_f32_32x32x16_bf16 v[32:47], v[72:75], v[188:191], v[32:47]
    s_mov_b32 s32, s31
    s_mov_b32 s31, s35
    v_mul_f32 v242, v0, v144
    v_fma_f32 v240, v8, v160, -v240
    v_fmac_f32 v242, v1, v145
    v_fmac_f32 v240, v9, v161
    v_fmac_f32 v242, v2, v146
    v_mfma_f32_32x32x16_bf16 v[48:63], v[76:79], v[188:191], v[48:63]
    s_setprio 0
    v_fmac_f32 v240, v10, v162
    v_fmac_f32 v242, v3, v147
    v_fmac_f32 v240, v11, v163
    v_fmac_f32 v242, v4, v148
    v_fmac_f32 v240, v12, v164
    v_fmac_f32 v242, v5, v149
    v_fmac_f32 v240, v13, v165
    v_fmac_f32 v242, v6, v150
    v_fmac_f32 v240, v14, v166
    v_fmac_f32 v242, v7, v151
    v_fmac_f32 v240, v15, v167
    v_add_u32 v249, s26, v249
    v_add_u32 v250, s26, v250
    v_fma_f32 v244, v16, v160, -v244
    v_fmac_f32 v236, v24, v112
    v_fmac_f32 v244, v17, v161
    v_fmac_f32 v236, v25, v113
    v_fmac_f32 v244, v18, v162
    v_fmac_f32 v236, v26, v114
    v_fmac_f32 v244, v19, v163
    v_fmac_f32 v236, v27, v115
    v_fmac_f32 v244, v20, v164
    v_fmac_f32 v236, v28, v116
    v_fmac_f32 v244, v21, v165
    v_fmac_f32 v236, v29, v117
    v_fmac_f32 v244, v22, v166
    v_fmac_f32 v236, v30, v118
    v_fmac_f32 v244, v23, v167
    v_fmac_f32 v236, v31, v119
    ds_read_b64_tr_b16 v[0:1], v249 offset:0
    ds_read_b64_tr_b16 v[2:3], v249 offset:128
    ds_read_b128 v[4:7], v250 offset:0
    ds_read_b128 v[8:11], v250 offset:16
    ds_read_b128 v[12:15], v250 offset:384
    ds_read_b128 v[16:19], v250 offset:400
    v_mul_f32 v243, v32, v152
    v_fma_f32 v241, v40, v168, -v241
    v_fmac_f32 v243, v33, v153
    v_fmac_f32 v241, v41, v169
    v_fmac_f32 v243, v34, v154
    v_fmac_f32 v241, v42, v170
    v_fmac_f32 v243, v35, v155
    v_fmac_f32 v241, v43, v171
    v_fmac_f32 v243, v36, v156
    v_fmac_f32 v241, v44, v172
    v_fmac_f32 v243, v37, v157
    v_fmac_f32 v241, v45, v173
    v_fmac_f32 v243, v38, v158
    v_fmac_f32 v241, v46, v174
    v_fmac_f32 v243, v39, v159
    v_fmac_f32 v241, v47, v175
    ds_read_b64_tr_b16 v[20:21], v249 offset:512
    ds_read_b64_tr_b16 v[22:23], v249 offset:640
    ds_read_b128 v[24:27], v250 offset:64
    ds_read_b128 v[28:31], v250 offset:80
    ds_read_b128 v[32:35], v250 offset:448
    ds_read_b128 v[36:39], v250 offset:464
    v_fma_f32 v245, v48, v168, -v245
    v_fmac_f32 v237, v56, v120
    v_fmac_f32 v245, v49, v169
    v_fmac_f32 v237, v57, v121
    v_fmac_f32 v245, v50, v170
    v_fmac_f32 v237, v58, v122
    v_fmac_f32 v245, v51, v171
    v_fmac_f32 v237, v59, v123
    v_fmac_f32 v245, v52, v172
    v_fmac_f32 v237, v60, v124
    v_fmac_f32 v245, v53, v173
    v_fmac_f32 v237, v61, v125
    v_fmac_f32 v245, v54, v174
    v_fmac_f32 v237, v62, v126
    v_fmac_f32 v245, v55, v175
    v_fmac_f32 v237, v63, v127
    s_cmp_eq_u32 s56, 2
    s_cbranch_scc1 K2_U20
    s_cmp_eq_u32 s56, 3
    s_cbranch_scc1 K2_U30
    s_branch K2_DSP0
K2_PAD_U30:
    s_branch K2_HOP
K2_U30:
    s_setprio 1
    s_waitcnt lgkmcnt(6)
    v_lshlrev_b32 v40, 16, v0
    v_and_b32 v41, 0xffff0000, v0
    v_lshlrev_b32 v42, 16, v1
    v_and_b32 v43, 0xffff0000, v1
    v_lshlrev_b32 v44, 16, v2
    v_and_b32 v45, 0xffff0000, v2
    v_lshlrev_b32 v46, 16, v3
    v_and_b32 v47, 0xffff0000, v3
    v_mul_f32 v4, v40, v4
    v_mul_f32 v5, v41, v5
    v_mul_f32 v6, v42, v6
    v_mul_f32 v7, v43, v7
    v_mul_f32 v8, v44, v8
    v_mul_f32 v9, v45, v9
    v_mul_f32 v10, v46, v10
    v_mul_f32 v11, v47, v11
    v_cvt_pk_bf16_f32 v64, v4, v5
    v_cvt_pk_bf16_f32 v65, v6, v7
    v_cvt_pk_bf16_f32 v66, v8, v9
    v_cvt_pk_bf16_f32 v67, v10, v11
    v_mul_f32 v12, v40, v12
    v_mul_f32 v13, v41, v13
    v_mul_f32 v14, v42, v14
    v_mul_f32 v15, v43, v15
    v_mul_f32 v16, v44, v16
    v_mul_f32 v17, v45, v17
    v_mul_f32 v18, v46, v18
    v_mul_f32 v19, v47, v19
    v_cvt_pk_bf16_f32 v68, v12, v13
    v_cvt_pk_bf16_f32 v69, v14, v15
    v_cvt_pk_bf16_f32 v70, v16, v17
    v_cvt_pk_bf16_f32 v71, v18, v19
    ds_read_b64_tr_b16 v[0:1], v249 offset:1024
    ds_read_b64_tr_b16 v[2:3], v249 offset:1152
    ds_read_b128 v[4:7], v250 offset:128
    ds_read_b128 v[8:11], v250 offset:144
    ds_read_b128 v[12:15], v250 offset:512
    ds_read_b128 v[16:19], v250 offset:528
    s_waitcnt lgkmcnt(6)
    v_lshlrev_b32 v48, 16, v20
    v_and_b32 v49, 0xffff0000, v20
    v_lshlrev_b32 v50, 16, v21
    v_and_b32 v51, 0xffff0000, v21
    v_lshlrev_b32 v52, 16, v22
    v_and_b32 v53, 0xffff0000, v22
    v_lshlrev_b32 v54, 16, v23
    v_and_b32 v55, 0xffff0000, v23
    v_mul_f32 v24, v48, v24
    v_mul_f32 v25, v49, v25
    v_mul_f32 v26, v50, v26
    v_mul_f32 v27, v51, v27
    v_mul_f32 v28, v52, v28
    v_mul_f32 v29, v53, v29
    v_mul_f32 v30, v54, v30
    v_mul_f32 v31, v55, v31
    v_cvt_pk_bf16_f32 v72, v24, v25
    v_cvt_pk_bf16_f32 v73, v26, v27
    v_cvt_pk_bf16_f32 v74, v28, v29
    v_cvt_pk_bf16_f32 v75, v30, v31
    v_mul_f32 v32, v48, v32
    v_mul_f32 v33, v49, v33
    v_mul_f32 v34, v50, v34
    v_mul_f32 v35, v51, v35
    v_mul_f32 v36, v52, v36
    v_mul_f32 v37, v53, v37
    v_mul_f32 v38, v54, v38
    v_mul_f32 v39, v55, v39
    v_cvt_pk_bf16_f32 v76, v32, v33
    v_cvt_pk_bf16_f32 v77, v34, v35
    v_cvt_pk_bf16_f32 v78, v36, v37
    v_cvt_pk_bf16_f32 v79, v38, v39
    s_waitcnt lgkmcnt(4)
    v_lshlrev_b32 v40, 16, v0
    v_and_b32 v41, 0xffff0000, v0
    v_lshlrev_b32 v42, 16, v1
    v_and_b32 v43, 0xffff0000, v1
    v_lshlrev_b32 v44, 16, v2
    v_and_b32 v45, 0xffff0000, v2
    v_lshlrev_b32 v46, 16, v3
    v_and_b32 v47, 0xffff0000, v3
    s_waitcnt lgkmcnt(2)
    v_mul_f32 v4, v40, v4
    v_mul_f32 v5, v41, v5
    v_mul_f32 v6, v42, v6
    v_mul_f32 v7, v43, v7
    v_mul_f32 v8, v44, v8
    v_mul_f32 v9, v45, v9
    v_mul_f32 v10, v46, v10
    v_mul_f32 v11, v47, v11
    v_cvt_pk_bf16_f32 v80, v4, v5
    v_cvt_pk_bf16_f32 v81, v6, v7
    v_cvt_pk_bf16_f32 v82, v8, v9
    v_cvt_pk_bf16_f32 v83, v10, v11
    s_waitcnt lgkmcnt(0)
    v_mul_f32 v12, v40, v12
    v_mul_f32 v13, v41, v13
    v_mul_f32 v14, v42, v14
    v_mul_f32 v15, v43, v15
    v_mul_f32 v16, v44, v16
    v_mul_f32 v17, v45, v17
    v_mul_f32 v18, v46, v18
    v_mul_f32 v19, v47, v19
    v_cvt_pk_bf16_f32 v84, v12, v13
    v_cvt_pk_bf16_f32 v85, v14, v15
    v_cvt_pk_bf16_f32 v86, v16, v17
    v_cvt_pk_bf16_f32 v87, v18, v19
    s_waitcnt vmcnt(4)
    v_mfma_f32_32x32x16_bf16 v[0:15], v[64:67], v[176:179], 0
    ds_read_b64_tr_b16 v[184:185], v246 offset:2048
    ds_read_b64_tr_b16 v[186:187], v246 offset:2560
    ds_read_b64_tr_b16 v[188:189], v247 offset:2048
    ds_read_b64_tr_b16 v[190:191], v247 offset:2560
    s_mov_b32 m0, s68
    v_mfma_f32_32x32x16_bf16 v[16:31], v[68:71], v[176:179], 0
    buffer_load_dwordx4 v224, s[4:7], s41 offen sc1 lds
    buffer_load_dwordx4 v225, s[72:75], s41 offen offset:1024 sc1 lds
    v_permlane32_swap_b32 v242, v236
    v_permlane32_swap_b32 v243, v237
    s_add_u32 s38, s38, 1
    v_mfma_f32_32x32x16_bf16 v[32:47], v[64:67], v[180:183], 0
    v_permlane32_swap_b32 v244, v238
    v_permlane32_swap_b32 v245, v239
    v_permlane32_swap_b32 v240, v241
    v_add_f32 v242, v242, v236
    v_mfma_f32_32x32x16_bf16 v[48:63], v[68:71], v[180:183], 0
    v_add_f32 v243, v243, v237
    v_add_f32 v244, v244, v238
    v_add_f32 v245, v245, v239
    v_add_f32 v240, -v240, -v241
    v_mov_b32 v254, s52
    v_mov_b32 v255, s38
    s_waitcnt vmcnt(4) lgkmcnt(0)
    v_mfma_f32_32x32x16_bf16 v[0:15], v[72:75], v[184:187], v[0:15]
    ds_read_b64_tr_b16 v[176:177], v246 offset:4096
    ds_read_b64_tr_b16 v[178:179], v246 offset:4608
    ds_read_b64_tr_b16 v[180:181], v247 offset:4096
    ds_read_b64_tr_b16 v[182:183], v247 offset:4608
    s_lshl_b32 s58, s38, 3
    s_add_u32 s58, s58, s20
    s_mov_b32 m0, s69
    v_mfma_f32_32x32x16_bf16 v[16:31], v[76:79], v[184:187], v[16:31]
    buffer_load_dwordx4 v226, s[4:7], s41 offen sc1 lds
    buffer_load_dwordx4 v227, s[72:75], s41 offen offset:1024 sc1 lds
    s_set_gpr_idx_on s32, gpr_idx(DST)
    s_nop 0
    v_cvt_pk_bf16_f32 v195, v242, v243
    v_cvt_pk_bf16_f32 v196, v244, v245
    v_cvt_pk_bf16_f32 v197, v240, v240
    s_set_gpr_idx_off
    s_mov_b64 exec, 1
    ds_write_b32 v254, v255
    s_mov_b64 exec, -1
    s_cmp_lt_u32 s58, s22
    s_cbranch_scc0 K2_dyn_21
K2_back_22:
    v_readlane_b32 s3, v253, s58
    s_lshl_b32 s44, s34, 7
    s_lshl_b32 s60, s58, 5
    s_and_b32 s48, s3, 0x3ffff
    s_bfe_u32 s33, s3, 0x30012
    s_sub_u32 s60, s60, s48
    s_and_b32 s60, s60, 0xff
    s_add_u32 s60, s60, s48
    s_mul_i32 s35, s38, 6
    s_cmp_eq_u32 s34, 0
    s_cselect_b32 s35, s35, s60
    s_mov_b32 s45, s44
    s_add_u32 s47, s44, 256
    s_add_u32 s49, s48, 32
    s_add_u32 s60, s48, 64
    s_cmp_eq_u32 s33, 3
    s_cselect_b32 s46, s44, s47
    s_cselect_b32 s50, s60, s48
    s_cselect_b32 s51, s48, s49
    s_sub_u32 s60, s33, 2
    s_cmp_lt_u32 s60, 2
    s_cbranch_scc0 K2_rare_27
K2_back_28:
    v_mfma_f32_32x32x16_bf16 v[32:47], v[72:75], v[188:191], v[32:47]
    v_add_u32 v233, s48, v230
    ds_read_b32 v232, v233
    ds_read_b32 v233, v233 offset:1024
    v_mfma_f32_32x32x16_bf16 v[48:63], v[76:79], v[188:191], v[48:63]
    s_waitcnt vmcnt(4) lgkmcnt(3)
    v_mfma_f32_32x32x16_bf16 v[0:15], v[80:83], v[176:179], v[0:15]
    ds_read_b64_tr_b16 v[184:185], v246 offset:6144
    ds_read_b64_tr_b16 v[186:187], v246 offset:6656
    ds_read_b64_tr_b16 v[188:189], v247 offset:6144
    ds_read_b64_tr_b16 v[190:191], v247 offset:6656
    s_mov_b32 m0, s70
    v_mfma_f32_32x32x16_bf16 v[16:31], v[84:87], v[176:179], v[16:31]
    buffer_load_dwordx4 v222, s[4:7], s42 offen sc1 lds
    buffer_load_dwordx4 v223, s[72:75], s42 offen offset:1024 sc1 lds
    v_mfma_f32_32x32x16_bf16 v[32:47], v[80:83], v[180:183], v[32:47]
    s_nop 2
    v_mul_f32 v234, v0, v96
    v_mul_f32 v236, v8, v128
    v_fmac_f32 v234, v1, v97
    v_fmac_f32 v236, v9, v129
    v_fmac_f32 v234, v2, v98
    v_fmac_f32 v236, v10, v130
    v_fmac_f32 v234, v3, v99
    v_mfma_f32_32x32x16_bf16 v[48:63], v[84:87], v[180:183], v[48:63]
    s_setprio 0
    s_waitcnt lgkmcnt(4)
    v_or_b32 v232, v232, v231
    v_or_b32 v233, v233, v231
    s_cmp_lg_u32 s34, 0
    s_cbranch_scc1 K2_dum_30
    s_add_u32 m0, s48, 864
    s_add_u32 s65, s48, 1888
    buffer_load_dwordx4 v232, s[16:19], 0 offen  lds
    s_mov_b32 m0, s65
    s_mov_b32 exec_hi, 0
    buffer_load_dwordx4 v233, s[16:19], 0 offen  lds
    s_cmp_eq_u32 s33, 4
    s_cbranch_scc1 K2_a4_31
K2_b4_33:
    s_mov_b32 exec_hi, -1
K2_back_32:
    v_fmac_f32 v236, v11, v131
    v_fmac_f32 v234, v4, v100
    v_fmac_f32 v236, v12, v132
    v_fmac_f32 v234, v5, v101
    v_fmac_f32 v236, v13, v133
    v_fmac_f32 v234, v6, v102
    v_fmac_f32 v236, v14, v134
    v_fmac_f32 v234, v7, v103
    v_fmac_f32 v236, v15, v135
    v_mul_f32 v238, v16, v128
    v_mul_f32 v240, v24, v128
    v_fmac_f32 v238, v17, v129
    v_fmac_f32 v240, v25, v129
    v_fmac_f32 v238, v18, v130
    v_fmac_f32 v240, v26, v130
    v_fmac_f32 v238, v19, v131
    v_fmac_f32 v240, v27, v131
    v_fmac_f32 v238, v20, v132
    v_fmac_f32 v240, v28, v132
    v_fmac_f32 v238, v21, v133
    v_fmac_f32 v240, v29, v133
    v_fmac_f32 v238, v22, v134
    v_fmac_f32 v240, v30, v134
    v_fmac_f32 v238, v23, v135
    v_fmac_f32 v240, v31, v135
    v_mul_f32 v235, v32, v104
    v_mul_f32 v237, v40, v136
    v_fmac_f32 v235, v33, v105
    v_fmac_f32 v237, v41, v137
    v_fmac_f32 v235, v34, v106
    v_fmac_f32 v237, v42, v138
    v_fmac_f32 v235, v35, v107
    v_fmac_f32 v237, v43, v139
    v_fmac_f32 v235, v36, v108
    v_fmac_f32 v237, v44, v140
    v_fmac_f32 v235, v37, v109
    v_fmac_f32 v237, v45, v141
    v_fmac_f32 v235, v38, v110
    v_fmac_f32 v237, v46, v142
    v_fmac_f32 v235, v39, v111
    v_fmac_f32 v237, v47, v143
    v_mul_f32 v239, v48, v136
    v_mul_f32 v241, v56, v136
    s_setprio 1
    s_waitcnt vmcnt(6) lgkmcnt(0)
    v_mfma_f32_32x32x16_bf16 v[0:15], v[64:67], v[184:187], 0
    ds_read_b64_tr_b16 v[176:177], v246 offset:0
    ds_read_b64_tr_b16 v[178:179], v246 offset:512
    ds_read_b64_tr_b16 v[180:181], v247 offset:0
    ds_read_b64_tr_b16 v[182:183], v247 offset:512
    v_fmac_f32 v239, v49, v137
    v_fmac_f32 v241, v57, v137
    s_mov_b32 m0, s71
    v_mfma_f32_32x32x16_bf16 v[16:31], v[68:71], v[184:187], 0
    buffer_load_dwordx4 v224, s[4:7], s42 offen sc1 lds
    buffer_load_dwordx4 v225, s[72:75], s42 offen offset:1024 sc1 lds
    v_fmac_f32 v239, v50, v138
    v_fmac_f32 v241, v58, v138
    v_fmac_f32 v239, v51, v139
    v_fmac_f32 v241, v59, v139
    v_fmac_f32 v239, v52, v140
    v_mfma_f32_32x32x16_bf16 v[32:47], v[64:67], v[188:191], 0
    v_fmac_f32 v241, v60, v140
    v_fmac_f32 v239, v53, v141
    v_fmac_f32 v241, v61, v141
    v_fmac_f32 v239, v54, v142
    v_fmac_f32 v241, v62, v142
    v_fmac_f32 v239, v55, v143
    v_fmac_f32 v241, v63, v143
    v_mfma_f32_32x32x16_bf16 v[48:63], v[68:71], v[188:191], 0
    v_permlane32_swap_b32 v234, v236
    v_permlane32_swap_b32 v235, v237
    v_permlane32_swap_b32 v240, v238
    s_waitcnt vmcnt(6) lgkmcnt(0)
    v_mfma_f32_32x32x16_bf16 v[0:15], v[72:75], v[176:179], v[0:15]
    ds_read_b64_tr_b16 v[184:185], v246 offset:2048
    ds_read_b64_tr_b16 v[186:187], v246 offset:2560
    ds_read_b64_tr_b16 v[188:189], v247 offset:2048
    ds_read_b64_tr_b16 v[190:191], v247 offset:2560
    v_permlane32_swap_b32 v241, v239
    s_mov_b32 m0, s68
    v_mfma_f32_32x32x16_bf16 v[16:31], v[76:79], v[176:179], v[16:31]
    buffer_load_dwordx4 v226, s[4:7], s42 offen sc1 lds
    buffer_load_dwordx4 v227, s[72:75], s42 offen offset:1024 sc1 lds
    v_add_f32 v234, v234, v236
    v_add_f32 v235, v235, v237
    v_add_f32 v240, v240, v238
    v_add_f32 v241, v241, v239
    v_mfma_f32_32x32x16_bf16 v[32:47], v[72:75], v[180:183], v[32:47]
    s_set_gpr_idx_on s31, gpr_idx(DST)
    s_nop 0
    v_cvt_pk_bf16_f32 v192, v234, v235
    v_cvt_pk_bf16_f32 v193, v240, v241
    s_set_gpr_idx_off
    v_mfma_f32_32x32x16_bf16 v[48:63], v[76:79], v[180:183], v[48:63]
    s_waitcnt vmcnt(6) lgkmcnt(0)
    v_mfma_f32_32x32x16_bf16 v[0:15], v[80:83], v[184:187], v[0:15]
    ds_read_b64_tr_b16 v[176:177], v246 offset:4096
    ds_read_b64_tr_b16 v[178:179], v246 offset:4608
    ds_read_b64_tr_b16 v[180:181], v247 offset:4096
    ds_read_b64_tr_b16 v[182:183], v247 offset:4608
    s_mov_b32 m0, s69
    v_mfma_f32_32x32x16_bf16 v[16:31], v[84:87], v[184:187], v[16:31]
    buffer_load_dwordx4 v222, s[4:7], s43 offen sc1 lds
    buffer_load_dwordx4 v223, s[72:75], s43 offen offset:1024 sc1 lds
    v_mfma_f32_32x32x16_bf16 v[32:47], v[80:83], v[188:191], v[32:47]
    s_nop 2
    v_mul_f32 v234, v0, v144
    v_mul_f32 v236, v8, v112
    v_fmac_f32 v234, v1, v145
    v_fmac_f32 v236, v9, v113
    v_fmac_f32 v234, v2, v146
    v_fmac_f32 v236, v10, v114
    v_fmac_f32 v234, v3, v147
    v_mfma_f32_32x32x16_bf16 v[48:63], v[84:87], v[188:191], v[48:63]
    s_setprio 0
    v_fmac_f32 v236, v11, v115
    v_fmac_f32 v234, v4, v148
    v_fmac_f32 v236, v12, v116
    v_fmac_f32 v234, v5, v149
    v_fmac_f32 v236, v13, v117
    v_fmac_f32 v234, v6, v150
    v_fmac_f32 v236, v14, v118
    v_fmac_f32 v234, v7, v151
    v_fmac_f32 v236, v15, v119
    v_mul_f32 v238, v16, v160
    v_mul_f32 v240, v24, v160
    v_fmac_f32 v238, v17, v161
    v_fmac_f32 v240, v25, v161
    v_fmac_f32 v238, v18, v162
    v_fmac_f32 v240, v26, v162
    v_fmac_f32 v238, v19, v163
    v_fmac_f32 v240, v27, v163
    v_fmac_f32 v238, v20, v164
    v_fmac_f32 v240, v28, v164
    v_fmac_f32 v238, v21, v165
    v_fmac_f32 v240, v29, v165
    v_fmac_f32 v238, v22, v166
    v_fmac_f32 v240, v30, v166
    v_fmac_f32 v238, v23, v167
    v_fmac_f32 v240, v31, v167
    v_mul_f32 v235, v32, v152
    v_mul_f32 v237, v40, v120
    v_fmac_f32 v235, v33, v153
    v_fmac_f32 v237, v41, v121
    v_fmac_f32 v235, v34, v154
    v_fmac_f32 v237, v42, v122
    v_fmac_f32 v235, v35, v155
    v_fmac_f32 v237, v43, v123
    v_fmac_f32 v235, v36, v156
    v_fmac_f32 v237, v44, v124
    v_fmac_f32 v235, v37, v157
    v_fmac_f32 v237, v45, v125
    v_fmac_f32 v235, v38, v158
    v_fmac_f32 v237, v46, v126
    v_fmac_f32 v235, v39, v159
    v_fmac_f32 v237, v47, v127
    v_mul_f32 v239, v48, v168
    v_mul_f32 v241, v56, v168
    v_fmac_f32 v239, v49, v169
    v_fmac_f32 v241, v57, v169
    s_setprio 1
    s_waitcnt vmcnt(4) lgkmcnt(0)
    v_mfma_f32_32x32x16_bf16 v[0:15], v[64:67], v[176:179], 0
    ds_read_b64_tr_b16 v[184:185], v246 offset:6144
    ds_read_b64_tr_b16 v[186:187], v246 offset:6656
    ds_read_b64_tr_b16 v[188:189], v247 offset:6144
    ds_read_b64_tr_b16 v[190:191], v247 offset:6656
    v_fmac_f32 v239, v50, v170
    v_fmac_f32 v241, v58, v170
    s_mov_b32 m0, s70
    v_mfma_f32_32x32x16_bf16 v[16:31], v[68:71], v[176:179], 0
    buffer_load_dwordx4 v224, s[4:7], s43 offen sc1 lds
    buffer_load_dwordx4 v225, s[72:75], s43 offen offset:1024 sc1 lds
    v_fmac_f32 v239, v51, v171
    v_fmac_f32 v241, v59, v171
    v_fmac_f32 v239, v52, v172
    v_fmac_f32 v241, v60, v172
    v_fmac_f32 v239, v53, v173
    v_mfma_f32_32x32x16_bf16 v[32:47], v[64:67], v[180:183], 0
    v_add_u32 v222, s48, v251
    ds_read_b32 v222, v222
    v_fmac_f32 v241, v61, v173
    v_fmac_f32 v239, v54, v174
    v_fmac_f32 v241, v62, v174
    v_fmac_f32 v239, v55, v175
    v_fmac_f32 v241, v63, v175
    v_mfma_f32_32x32x16_bf16 v[48:63], v[68:71], v[180:183], 0
    s_waitcnt vmcnt(4) lgkmcnt(1)
    v_mfma_f32_32x32x16_bf16 v[0:15], v[72:75], v[184:187], v[0:15]
    ds_read_b64_tr_b16 v[176:177], v246 offset:0
    ds_read_b64_tr_b16 v[178:179], v246 offset:512
    ds_read_b64_tr_b16 v[180:181], v247 offset:0
    ds_read_b64_tr_b16 v[182:183], v247 offset:512
    s_mov_b32 m0, s71
    v_mfma_f32_32x32x16_bf16 v[16:31], v[76:79], v[184:187], v[16:31]
    buffer_load_dwordx4 v226, s[4:7], s43 offen sc1 lds
    buffer_load_dwordx4 v227, s[72:75], s43 offen offset:1024 sc1 lds
    s_waitcnt lgkmcnt(4)
    v_mad_u32_u16 v223, v222, s39, v248 op_sel:[1,0,0,0]
    v_mad_u32_u16 v222, v222, s39, v248
    v_mfma_f32_32x32x16_bf16 v[32:47], v[72:75], v[188:191], v[32:47]
    v_add_u32 v224, s49, v251
    ds_read_b32 v224, v224
    v_mfma_f32_32x32x16_bf16 v[48:63], v[76:79], v[188:191], v[48:63]
    s_waitcnt vmcnt(4) lgkmcnt(1)
    v_mfma_f32_32x32x16_bf16 v[0:15], v[80:83], v[176:179], v[0:15]
    ds_read_b64_tr_b16 v[184:185], v246 offset:2048
    ds_read_b64_tr_b16 v[186:187], v246 offset:2560
    ds_read_b64_tr_b16 v[188:189], v247 offset:2048
    ds_read_b64_tr_b16 v[190:191], v247 offset:2560
    s_mov_b32 m0, s68
    v_mfma_f32_32x32x16_bf16 v[16:31], v[84:87], v[176:179], v[16:31]
    buffer_load_dwordx4 v222, s[4:7], s44 offen sc1 lds
    buffer_load_dwordx4 v223, s[72:75], s44 offen offset:1024 sc1 lds
    s_waitcnt lgkmcnt(4)
    v_mad_u32_u16 v225, v224, s39, v248 op_sel:[1,0,0,0]
    v_mad_u32_u16 v224, v224, s39, v248
    v_mfma_f32_32x32x16_bf16 v[32:47], v[80:83], v[180:183], v[32:47]
    v_add_u32 v226, s50, v251
    ds_read_b32 v226, v226
    v_mul_f32 v242, v0, v144
    v_fma_f32 v238, v8, v160, -v238
    v_fmac_f32 v242, v1, v145
    v_fmac_f32 v238, v9, v161
    v_fmac_f32 v242, v2, v146
    v_mfma_f32_32x32x16_bf16 v[48:63], v[84:87], v[180:183], v[48:63]
    s_setprio 0
    v_fmac_f32 v238, v10, v162
    v_fmac_f32 v242, v3, v147
    v_fmac_f32 v238, v11, v163
    v_fmac_f32 v242, v4, v148
    v_fmac_f32 v238, v12, v164
    v_fmac_f32 v242, v5, v149
    v_fmac_f32 v238, v13, v165
    v_fmac_f32 v242, v6, v150
    v_fmac_f32 v238, v14, v166
    v_fmac_f32 v242, v7, v151
    v_fmac_f32 v238, v15, v167
    v_fmac_f32 v236, v16, v112
    v_mul_f32 v244, v24, v160
    v_fmac_f32 v236, v17, v113
    v_fmac_f32 v244, v25, v161
    v_fmac_f32 v236, v18, v114
    v_fmac_f32 v244, v26, v162
    v_fmac_f32 v236, v19, v115
    v_fmac_f32 v244, v27, v163
    v_fmac_f32 v236, v20, v116
    v_fmac_f32 v244, v28, v164
    v_fmac_f32 v236, v21, v117
    v_fmac_f32 v244, v29, v165
    v_fmac_f32 v236, v22, v118
    v_fmac_f32 v244, v30, v166
    v_fmac_f32 v236, v23, v119
    v_fmac_f32 v244, v31, v167
    v_mul_f32 v243, v32, v152
    v_fma_f32 v239, v40, v168, -v239
    v_fmac_f32 v243, v33, v153
    v_fmac_f32 v239, v41, v169
    v_fmac_f32 v243, v34, v154
    v_fmac_f32 v239, v42, v170
    v_fmac_f32 v243, v35, v155
    v_fmac_f32 v239, v43, v171
    v_fmac_f32 v243, v36, v156
    v_fmac_f32 v239, v44, v172
    v_fmac_f32 v243, v37, v157
    v_fmac_f32 v239, v45, v173
    v_fmac_f32 v243, v38, v158
    v_fmac_f32 v239, v46, v174
    v_fmac_f32 v243, v39, v159
    v_fmac_f32 v239, v47, v175
    v_fmac_f32 v237, v48, v120
    v_mul_f32 v245, v56, v168
    v_fmac_f32 v237, v49, v121
    v_fmac_f32 v245, v57, v169
    v_fmac_f32 v237, v50, v122
    v_fmac_f32 v245, v58, v170
    v_fmac_f32 v237, v51, v123
    s_setprio 1
    s_waitcnt vmcnt(4) lgkmcnt(1)
    v_mfma_f32_32x32x16_bf16 v[0:15], v[64:67], v[184:187], 0
    ds_read_b64_tr_b16 v[176:177], v246 offset:4096
    ds_read_b64_tr_b16 v[178:179], v246 offset:4608
    ds_read_b64_tr_b16 v[180:181], v247 offset:4096
    ds_read_b64_tr_b16 v[182:183], v247 offset:4608
    v_fmac_f32 v245, v59, v171
    v_fmac_f32 v237, v52, v124
    s_mov_b32 m0, s69
    v_mfma_f32_32x32x16_bf16 v[16:31], v[68:71], v[184:187], 0
    buffer_load_dwordx4 v224, s[4:7], s45 offen sc1 lds
    buffer_load_dwordx4 v225, s[72:75], s45 offen offset:1024 sc1 lds
    s_waitcnt lgkmcnt(4)
    v_mad_u32_u16 v227, v226, s39, v248 op_sel:[1,0,0,0]
    v_mad_u32_u16 v226, v226, s39, v248
    v_fmac_f32 v245, v60, v172
    v_fmac_f32 v237, v53, v125
    v_mfma_f32_32x32x16_bf16 v[32:47], v[64:67], v[188:191], 0
    v_add_u32 v228, s51, v251
    ds_read_b32 v228, v228
    v_fmac_f32 v245, v61, v173
    v_fmac_f32 v237, v54, v126
    v_fmac_f32 v245, v62, v174
    v_fmac_f32 v237, v55, v127
    v_fmac_f32 v245, v63, v175
    v_mfma_f32_32x32x16_bf16 v[48:63], v[68:71], v[188:191], 0
    v_permlane32_swap_b32 v242, v234
    v_permlane32_swap_b32 v243, v235
    v_add_f32 v242, v242, v234
    v_add_f32 v243, v243, v235
    s_waitcnt vmcnt(4) lgkmcnt(1)
    v_mfma_f32_32x32x16_bf16 v[0:15], v[72:75], v[176:179], v[0:15]
    ds_read_b64_tr_b16 v[184:185], v246 offset:6144
    ds_read_b64_tr_b16 v[186:187], v246 offset:6656
    ds_read_b64_tr_b16 v[188:189], v247 offset:6144
    ds_read_b64_tr_b16 v[190:191], v247 offset:6656
    s_mov_b32 m0, s70
    v_mfma_f32_32x32x16_bf16 v[16:31], v[76:79], v[176:179], v[16:31]
    buffer_load_dwordx4 v226, s[4:7], s46 offen sc1 lds
    buffer_load_dwordx4 v227, s[72:75], s46 offen offset:1024 sc1 lds
    s_waitcnt lgkmcnt(4)
    v_mad_u32_u16 v229, v228, s39, v248 op_sel:[1,0,0,0]
    v_mad_u32_u16 v228, v228, s39, v248
    s_sub_u32 s26, s48, s29
    s_mov_b32 s29, s48
    v_mfma_f32_32x32x16_bf16 v[32:47], v[72:75], v[180:183], v[32:47]
    s_set_gpr_idx_on s31, gpr_idx(DST)
    s_nop 0
    v_cvt_pk_bf16_f32 v194, v242, v243
    s_set_gpr_idx_off
    s_mov_b32 s30, s3
    s_cmp_eq_u32 s34, 0
    s_cselect_b32 s56, s33, 0
    s_mov_b32 s32, s31
    v_mfma_f32_32x32x16_bf16 v[48:63], v[76:79], v[180:183], v[48:63]
    s_mov_b32 s31, s35
    s_waitcnt vmcnt(4) lgkmcnt(0)
    v_mfma_f32_32x32x16_bf16 v[0:15], v[80:83], v[184:187], v[0:15]
    ds_read_b64_tr_b16 v[176:177], v246 offset:0
    ds_read_b64_tr_b16 v[178:179], v246 offset:512
    ds_read_b64_tr_b16 v[180:181], v247 offset:0
    ds_read_b64_tr_b16 v[182:183], v247 offset:512
    s_mov_b32 m0, s71
    v_mfma_f32_32x32x16_bf16 v[16:31], v[84:87], v[184:187], v[16:31]
    buffer_load_dwordx4 v228, s[4:7], s47 offen sc1 lds
    buffer_load_dwordx4 v229, s[72:75], s47 offen offset:1024 sc1 lds
    v_mfma_f32_32x32x16_bf16 v[32:47], v[80:83], v[188:191], v[32:47]
    s_nop 2
    v_mul_f32 v242, v0, v144
    v_fma_f32 v240, v8, v160, -v240
    v_fmac_f32 v242, v1, v145
    v_fmac_f32 v240, v9, v161
    v_fmac_f32 v242, v2, v146
    v_fmac_f32 v240, v10, v162
    v_fmac_f32 v242, v3, v147
    v_mfma_f32_32x32x16_bf16 v[48:63], v[84:87], v[188:191], v[48:63]
    s_setprio 0
    v_fmac_f32 v240, v11, v163
    v_fmac_f32 v242, v4, v148
    v_fmac_f32 v240, v12, v164
    v_fmac_f32 v242, v5, v149
    v_fmac_f32 v240, v13, v165
    v_fmac_f32 v242, v6, v150
    v_fmac_f32 v240, v14, v166
    v_fmac_f32 v242, v7, v151
    v_fmac_f32 v240, v15, v167
    v_add_u32 v249, s26, v249
    v_add_u32 v250, s26, v250
    v_fma_f32 v244, v16, v160, -v244
    v_fmac_f32 v236, v24, v112
    v_fmac_f32 v244, v17, v161
    v_fmac_f32 v236, v25, v113
    v_fmac_f32 v244, v18, v162
    v_fmac_f32 v236, v26, v114
    v_fmac_f32 v244, v19, v163
    v_fmac_f32 v236, v27, v115
    v_fmac_f32 v244, v20, v164
    v_fmac_f32 v236, v28, v116
    v_fmac_f32 v244, v21, v165
    v_fmac_f32 v236, v29, v117
    v_fmac_f32 v244, v22, v166
    v_fmac_f32 v236, v30, v118
    v_fmac_f32 v244, v23, v167
    v_fmac_f32 v236, v31, v119
    ds_read_b64_tr_b16 v[0:1], v249 offset:0
    ds_read_b64_tr_b16 v[2:3], v249 offset:128
    ds_read_b128 v[4:7], v250 offset:0
    ds_read_b128 v[8:11], v250 offset:16
    ds_read_b128 v[12:15], v250 offset:384
    ds_read_b128 v[16:19], v250 offset:400
    v_mul_f32 v243, v32, v152
    v_fma_f32 v241, v40, v168, -v241
    v_fmac_f32 v243, v33, v153
    v_fmac_f32 v241, v41, v169
    v_fmac_f32 v243, v34, v154
    v_fmac_f32 v241, v42, v170
    v_fmac_f32 v243, v35, v155
    v_fmac_f32 v241, v43, v171
    v_fmac_f32 v243, v36, v156
    v_fmac_f32 v241, v44, v172
    v_fmac_f32 v243, v37, v157
    v_fmac_f32 v241, v45, v173
    v_fmac_f32 v243, v38, v158
    v_fmac_f32 v241, v46, v174
    v_fmac_f32 v243, v39, v159
    v_fmac_f32 v241, v47, v175
    ds_read_b64_tr_b16 v[20:21], v249 offset:512
    ds_read_b64_tr_b16 v[22:23], v249 offset:640
    ds_read_b128 v[24:27], v250 offset:64
    ds_read_b128 v[28:31], v250 offset:80
    ds_read_b128 v[32:35], v250 offset:448
    ds_read_b128 v[36:39], v250 offset:464
    v_fma_f32 v245, v48, v168, -v245
    v_fmac_f32 v237, v56, v120
    v_fmac_f32 v245, v49, v169
    v_fmac_f32 v237, v57, v121
    v_fmac_f32 v245, v50, v170
    v_fmac_f32 v237, v58, v122
    v_fmac_f32 v245, v51, v171
    v_fmac_f32 v237, v59, v123
    v_fmac_f32 v245, v52, v172
    v_fmac_f32 v237, v60, v124
    v_fmac_f32 v245, v53, v173
    v_fmac_f32 v237, v61, v125
    v_fmac_f32 v245, v54, v174
    v_fmac_f32 v237, v62, v126
    v_fmac_f32 v245, v55, v175
    v_fmac_f32 v237, v63, v127
    s_cmp_eq_u32 s56, 2
    s_cbranch_scc1 K2_U20
    s_cmp_eq_u32 s56, 3
    s_cbranch_scc1 K2_U30
    s_branch K2_DSP0
K2_PAD_U21:
    s_branch K2_HOP
K2_U21:
    s_setprio 1
    s_waitcnt lgkmcnt(6)
    v_lshlrev_b32 v40, 16, v0
    v_and_b32 v41, 0xffff0000, v0
    v_lshlrev_b32 v42, 16, v1
    v_and_b32 v43, 0xffff0000, v1
    v_lshlrev_b32 v44, 16, v2
    v_and_b32 v45, 0xffff0000, v2
    v_lshlrev_b32 v46, 16, v3
    v_and_b32 v47, 0xffff0000, v3
    v_mul_f32 v4, v40, v4
    v_mul_f32 v5, v41, v5
    v_mul_f32 v6, v42, v6
    v_mul_f32 v7, v43, v7
    v_mul_f32 v8, v44, v8
    v_mul_f32 v9, v45, v9
    v_mul_f32 v10, v46, v10
    v_mul_f32 v11, v47, v11
    v_cvt_pk_bf16_f32 v64, v4, v5
    v_cvt_pk_bf16_f32 v65, v6, v7
    v_cvt_pk_bf16_f32 v66, v8, v9
    v_cvt_pk_bf16_f32 v67, v10, v11
    v_mul_f32 v12, v40, v12
    v_mul_f32 v13, v41, v13
    v_mul_f32 v14, v42, v14
    v_mul_f32 v15, v43, v15
    v_mul_f32 v16, v44, v16
    v_mul_f32 v17, v45, v17
    v_mul_f32 v18, v46, v18
    v_mul_f32 v19, v47, v19
    v_cvt_pk_bf16_f32 v68, v12, v13
    v_cvt_pk_bf16_f32 v69, v14, v15
    v_cvt_pk_bf16_f32 v70, v16, v17
    v_cvt_pk_bf16_f32 v71, v18, v19
    s_waitcnt lgkmcnt(0)
    v_lshlrev_b32 v48, 16, v20
    v_and_b32 v49, 0xffff0000, v20
    v_lshlrev_b32 v50, 16, v21
    v_and_b32 v51, 0xffff0000, v21
    v_lshlrev_b32 v52, 16, v22
    v_and_b32 v53, 0xffff0000, v22
    v_lshlrev_b32 v54, 16, v23
    v_and_b32 v55, 0xffff0000, v23
    v_mul_f32 v24, v48, v24
    v_mul_f32 v25, v49, v25
    v_mul_f32 v26, v50, v26
    v_mul_f32 v27, v51, v27
    v_mul_f32 v28, v52, v28
    v_mul_f32 v29, v53, v29
    v_mul_f32 v30, v54, v30
    v_mul_f32 v31, v55, v31
    v_cvt_pk_bf16_f32 v72, v24, v25
    v_cvt_pk_bf16_f32 v73, v26, v27
    v_cvt_pk_bf16_f32 v74, v28, v29
    v_cvt_pk_bf16_f32 v75, v30, v31
    v_mul_f32 v32, v48, v32
    v_mul_f32 v33, v49, v33
    v_mul_f32 v34, v50, v34
    v_mul_f32 v35, v51, v35
    v_mul_f32 v36, v52, v36
    v_mul_f32 v37, v53, v37
    v_mul_f32 v38, v54, v38
    v_mul_f32 v39, v55, v39
    v_cvt_pk_bf16_f32 v76, v32, v33
    v_cvt_pk_bf16_f32 v77, v34, v35
    v_cvt_pk_bf16_f32 v78, v36, v37
    v_cvt_pk_bf16_f32 v79, v38, v39
    s_waitcnt vmcnt(4)
    v_mfma_f32_32x32x16_bf16 v[0:15], v[64:67], v[176:179], 0
    ds_read_b64_tr_b16 v[184:185], v246 offset:2048
    ds_read_b64_tr_b16 v[186:187], v246 offset:2560
    ds_read_b64_tr_b16 v[188:189], v247 offset:2048
    ds_read_b64_tr_b16 v[190:191], v247 offset:2560
    s_mov_b32 m0, s68
    v_mfma_f32_32x32x16_bf16 v[16:31], v[68:71], v[176:179], 0
    buffer_load_dwordx4 v222, s[4:7], s42 offen sc1 lds
    buffer_load_dwordx4 v223, s[72:75], s42 offen offset:1024 sc1 lds
    v_permlane32_swap_b32 v242, v236
    v_permlane32_swap_b32 v243, v237
    v_mov_b32 v254, 163648
    v_mfma_f32_32x32x16_bf16 v[32:47], v[64:67], v[180:183], 0
    v_permlane32_swap_b32 v244, v238
    v_permlane32_swap_b32 v245, v239
    v_permlane32_swap_b32 v240, v241
    v_add_f32 v242, v242, v236
    v_mfma_f32_32x32x16_bf16 v[48:63], v[68:71], v[180:183], 0
    v_add_f32 v243, v243, v237
    v_add_f32 v244, v244, v238
    v_add_f32 v245, v245, v239
    v_add_f32 v240, -v240, -v241
    v_sub_u32 v241, v230, v231
    v_cvt_pk_bf16_f32 v242, v242, v243
    v_mov_b32 v255, 1
    v_lshl_add_u32 v233, v252, 1, s53
    s_mov_b64 exec, 1
    ds_add_rtn_u32 v232, v254, v255
    s_mov_b64 exec, -1
    ds_read_b32 v233, v233
    s_waitcnt vmcnt(4) lgkmcnt(2)
    v_mfma_f32_32x32x16_bf16 v[0:15], v[72:75], v[184:187], v[0:15]
    ds_read_b64_tr_b16 v[176:177], v246 offset:4096
    ds_read_b64_tr_b16 v[178:179], v246 offset:4608
    ds_read_b64_tr_b16 v[180:181], v247 offset:4096
    ds_read_b64_tr_b16 v[182:183], v247 offset:4608
    v_cvt_pk_bf16_f32 v244, v244, v245
    v_cvt_pk_bf16_f32 v240, v240, v240
    s_mov_b32 m0, s69
    v_mfma_f32_32x32x16_bf16 v[16:31], v[76:79], v[184:187], v[16:31]
    buffer_load_dwordx4 v224, s[4:7], s42 offen sc1 lds
    buffer_load_dwordx4 v225, s[72:75], s42 offen offset:1024 sc1 lds
    ds_write_b32 v230, v242 offset:768
    ds_write_b32 v230, v244 offset:1024
    ds_write_b16 v241, v240 offset:1280
    s_waitcnt lgkmcnt(7)
    v_readfirstlane_b32 s58, v232
    v_mfma_f32_32x32x16_bf16 v[32:47], v[72:75], v[188:191], v[32:47]
    s_cmp_lt_u32 s58, s22
    s_cbranch_scc0 K2_nul_34
    s_and_b32 s59, s58, 7
    s_lshr_b32 s60, s58, 3
K2_chk_36:
    v_readlane_b32 s61, v233, s59
    s_nop 0
    s_cmp_gt_u32 s61, s60
    s_cbranch_scc0 K2_spin_35
K2_back_37:
    v_mfma_f32_32x32x16_bf16 v[48:63], v[76:79], v[188:191], v[48:63]
    s_setprio 0
    v_readlane_b32 s3, v253, s58
    s_lshl_b32 s44, s34, 7
    s_lshl_b32 s60, s58, 5
    s_and_b32 s48, s3, 0x3ffff
    s_bfe_u32 s33, s3, 0x30012
    s_sub_u32 s60, s60, s48
    v_mul_f32 v234, v0, v96
    v_mul_f32 v236, v8, v128
    v_fmac_f32 v234, v1, v97
    v_fmac_f32 v236, v9, v129
    v_fmac_f32 v234, v2, v98
    v_fmac_f32 v236, v10, v130
    v_fmac_f32 v234, v3, v99
    v_fmac_f32 v236, v11, v131
    v_fmac_f32 v234, v4, v100
    v_fmac_f32 v236, v12, v132
    v_fmac_f32 v234, v5, v101
    v_fmac_f32 v236, v13, v133
    v_fmac_f32 v234, v6, v102
    v_fmac_f32 v236, v14, v134
    v_fmac_f32 v234, v7, v103
    v_fmac_f32 v236, v15, v135
    v_mul_f32 v238, v16, v128
    v_mul_f32 v240, v24, v128
    v_fmac_f32 v238, v17, v129
    v_fmac_f32 v240, v25, v129
    v_fmac_f32 v238, v18, v130
    v_fmac_f32 v240, v26, v130
    v_fmac_f32 v238, v19, v131
    v_fmac_f32 v240, v27, v131
    v_fmac_f32 v238, v20, v132
    v_fmac_f32 v240, v28, v132
    v_fmac_f32 v238, v21, v133
    v_fmac_f32 v240, v29, v133
    v_fmac_f32 v238, v22, v134
    v_fmac_f32 v240, v30, v134
    v_fmac_f32 v238, v23, v135
    v_fmac_f32 v240, v31, v135
    v_mul_f32 v235, v32, v104
    v_mul_f32 v237, v40, v136
    v_fmac_f32 v235, v33, v105
    v_fmac_f32 v237, v41, v137
    v_fmac_f32 v235, v34, v106
    v_fmac_f32 v237, v42, v138
    v_fmac_f32 v235, v35, v107
    v_fmac_f32 v237, v43, v139
    v_fmac_f32 v235, v36, v108
    v_fmac_f32 v237, v44, v140
    v_fmac_f32 v235, v37, v109
    v_fmac_f32 v237, v45, v141
    v_fmac_f32 v235, v38, v110
    v_fmac_f32 v237, v46, v142
    v_fmac_f32 v235, v39, v111
    v_fmac_f32 v237, v47, v143
    v_mul_f32 v239, v48, v136
    v_mul_f32 v241, v56, v136
    v_fmac_f32 v239, v49, v137
    v_fmac_f32 v241, v57, v137
    s_setprio 1
    s_waitcnt vmcnt(4) lgkmcnt(3)
    v_mfma_f32_32x32x16_bf16 v[0:15], v[64:67], v[176:179], 0
    ds_read_b64_tr_b16 v[184:185], v246 offset:6144
    ds_read_b64_tr_b16 v[186:187], v246 offset:6656
    ds_read_b64_tr_b16 v[188:189], v247 offset:6144
    ds_read_b64_tr_b16 v[190:191], v247 offset:6656
    v_fmac_f32 v239, v50, v138
    v_fmac_f32 v241, v58, v138
    s_mov_b32 m0, s70
    v_mfma_f32_32x32x16_bf16 v[16:31], v[68:71], v[176:179], 0
    buffer_load_dwordx4 v222, s[4:7], s43 offen sc1 lds
    buffer_load_dwordx4 v223, s[72:75], s43 offen offset:1024 sc1 lds
    v_fmac_f32 v239, v51, v139
    v_fmac_f32 v241, v59, v139
    v_fmac_f32 v239, v52, v140
    v_fmac_f32 v241, v60, v140
    v_fmac_f32 v239, v53, v141
    v_mfma_f32_32x32x16_bf16 v[32:47], v[64:67], v[180:183], 0
    s_and_b32 s60, s60, 0xff
    s_add_u32 s35, s60, s48
    s_mov_b32 s45, s44
    s_add_u32 s47, s44, 256
    s_add_u32 s49, s48, 32
    s_add_u32 s60, s48, 64
    s_cmp_eq_u32 s33, 3
    s_cselect_b32 s46, s44, s47
    s_cselect_b32 s50, s60, s48
    s_cselect_b32 s51, s48, s49
    s_sub_u32 s60, s33, 2
    s_cmp_lt_u32 s60, 2
    s_cbranch_scc0 K2_rare_38
K2_back_39:
    v_add_u32 v222, s48, v251
    ds_read_b32 v222, v222
    v_fmac_f32 v241, v61, v141
    v_fmac_f32 v239, v54, v142
    v_fmac_f32 v241, v62, v142
    v_fmac_f32 v239, v55, v143
    v_fmac_f32 v241, v63, v143
    v_mfma_f32_32x32x16_bf16 v[48:63], v[68:71], v[180:183], 0
    v_permlane32_swap_b32 v234, v236
    v_permlane32_swap_b32 v235, v237
    v_permlane32_swap_b32 v240, v238
    s_waitcnt vmcnt(4) lgkmcnt(1)
    v_mfma_f32_32x32x16_bf16 v[0:15], v[72:75], v[184:187], v[0:15]
    ds_read_b64_tr_b16 v[176:177], v246 offset:0
    ds_read_b64_tr_b16 v[178:179], v246 offset:512
    ds_read_b64_tr_b16 v[180:181], v247 offset:0
    ds_read_b64_tr_b16 v[182:183], v247 offset:512
    v_permlane32_swap_b32 v241, v239
    s_mov_b32 m0, s71
    v_mfma_f32_32x32x16_bf16 v[16:31], v[76:79], v[184:187], v[16:31]
    buffer_load_dwordx4 v224, s[4:7], s43 offen sc1 lds
    buffer_load_dwordx4 v225, s[72:75], s43 offen offset:1024 sc1 lds
    s_waitcnt lgkmcnt(4)
    v_mad_u32_u16 v223, v222, s39, v248 op_sel:[1,0,0,0]
    v_mad_u32_u16 v222, v222, s39, v248
    v_lshl_add_u32 v230, v252, 1, s31
    v_add_f32 v234, v234, v236
    v_add_f32 v235, v235, v237
    v_add_f32 v240, v240, v238
    v_add_f32 v241, v241, v239
    v_cvt_pk_bf16_f32 v234, v234, v235
    v_cvt_pk_bf16_f32 v240, v240, v241
    ds_write_b32 v230, v234 offset:0
    ds_write_b32 v230, v240 offset:256
    v_mfma_f32_32x32x16_bf16 v[32:47], v[72:75], v[188:191], v[32:47]
    v_add_u32 v224, s49, v251
    ds_read_b32 v224, v224
    v_mul_f32 v234, v0, v144
    v_mul_f32 v236, v8, v112
    v_fmac_f32 v234, v1, v145
    v_fmac_f32 v236, v9, v113
    v_fmac_f32 v234, v2, v146
    v_mfma_f32_32x32x16_bf16 v[48:63], v[76:79], v[188:191], v[48:63]
    s_setprio 0
    v_fmac_f32 v236, v10, v114
    v_fmac_f32 v234, v3, v147
    v_fmac_f32 v236, v11, v115
    v_fmac_f32 v234, v4, v148
    v_fmac_f32 v236, v12, v116
    v_fmac_f32 v234, v5, v149
    v_fmac_f32 v236, v13, v117
    v_fmac_f32 v234, v6, v150
    v_fmac_f32 v236, v14, v118
    v_fmac_f32 v234, v7, v151
    v_fmac_f32 v236, v15, v119
    v_mul_f32 v238, v16, v160
    v_mul_f32 v240, v24, v160
    v_fmac_f32 v238, v17, v161
    v_fmac_f32 v240, v25, v161
    v_fmac_f32 v238, v18, v162
    v_fmac_f32 v240, v26, v162
    v_fmac_f32 v238, v19, v163
    v_fmac_f32 v240, v27, v163
    v_fmac_f32 v238, v20, v164
    v_fmac_f32 v240, v28, v164
    v_fmac_f32 v238, v21, v165
    v_fmac_f32 v240, v29, v165
    v_fmac_f32 v238, v22, v166
    v_fmac_f32 v240, v30, v166
    v_fmac_f32 v238, v23, v167
    v_fmac_f32 v240, v31, v167
    v_mul_f32 v235, v32, v152
    v_mul_f32 v237, v40, v120
    v_fmac_f32 v235, v33, v153
    v_fmac_f32 v237, v41, v121
    v_fmac_f32 v235, v34, v154
    v_fmac_f32 v237, v42, v122
    v_fmac_f32 v235, v35, v155
    v_fmac_f32 v237, v43, v123
    v_fmac_f32 v235, v36, v156
    v_fmac_f32 v237, v44, v124
    v_fmac_f32 v235, v37, v157
    v_fmac_f32 v237, v45, v125
    v_fmac_f32 v235, v38, v158
    v_fmac_f32 v237, v46, v126
    v_fmac_f32 v235, v39, v159
    v_fmac_f32 v237, v47, v127
    v_mul_f32 v239, v48, v168
    v_mul_f32 v241, v56, v168
    v_fmac_f32 v239, v49, v169
    v_fmac_f32 v241, v57, v169
    v_fmac_f32 v239, v50, v170
    v_fmac_f32 v241, v58, v170
    v_fmac_f32 v239, v51, v171
    s_setprio 1
    s_waitcnt vmcnt(4) lgkmcnt(3)
    v_mfma_f32_32x32x16_bf16 v[0:15], v[64:67], v[176:179], 0
    ds_read_b64_tr_b16 v[184:185], v246 offset:2048
    ds_read_b64_tr_b16 v[186:187], v246 offset:2560
    ds_read_b64_tr_b16 v[188:189], v247 offset:2048
    ds_read_b64_tr_b16 v[190:191], v247 offset:2560
    v_fmac_f32 v241, v59, v171
    v_fmac_f32 v239, v52, v172
    s_mov_b32 m0, s68
    v_mfma_f32_32x32x16_bf16 v[16:31], v[68:71], v[176:179], 0
    buffer_load_dwordx4 v222, s[4:7], s44 offen sc1 lds
    buffer_load_dwordx4 v223, s[72:75], s44 offen offset:1024 sc1 lds
    s_waitcnt lgkmcnt(4)
    v_mad_u32_u16 v225, v224, s39, v248 op_sel:[1,0,0,0]
    v_mad_u32_u16 v224, v224, s39, v248
    v_fmac_f32 v241, v60, v172
    v_fmac_f32 v239, v53, v173
    v_mfma_f32_32x32x16_bf16 v[32:47], v[64:67], v[180:183], 0
    v_add_u32 v226, s50, v251
    ds_read_b32 v226, v226
    v_fmac_f32 v241, v61, v173
    v_fmac_f32 v239, v54, v174
    v_fmac_f32 v241, v62, v174
    v_fmac_f32 v239, v55, v175
    v_fmac_f32 v241, v63, v175
    v_mfma_f32_32x32x16_bf16 v[48:63], v[68:71], v[180:183], 0
    s_waitcnt vmcnt(4) lgkmcnt(1)
    v_mfma_f32_32x32x16_bf16 v[0:15], v[72:75], v[184:187], v[0:15]
    ds_read_b64_tr_b16 v[176:177], v246 offset:4096
    ds_read_b64_tr_b16 v[178:179], v246 offset:4608
    ds_read_b64_tr_b16 v[180:181], v247 offset:4096
    ds_read_b64_tr_b16 v[182:183], v247 offset:4608
    s_mov_b32 m0, s69
    v_mfma_f32_32x32x16_bf16 v[16:31], v[76:79], v[184:187], v[16:31]
    buffer_load_dwordx4 v224, s[4:7], s45 offen sc1 lds
    buffer_load_dwordx4 v225, s[72:75], s45 offen offset:1024 sc1 lds
    s_waitcnt lgkmcnt(4)
    v_mad_u32_u16 v227, v226, s39, v248 op_sel:[1,0,0,0]
    v_mad_u32_u16 v226, v226, s39, v248
    v_mfma_f32_32x32x16_bf16 v[32:47], v[72:75], v[188:191], v[32:47]
    v_add_u32 v228, s51, v251
    ds_read_b32 v228, v228
    v_mul_f32 v242, v0, v144
    v_fma_f32 v238, v8, v160, -v238
    v_fmac_f32 v242, v1, v145
    v_fmac_f32 v238, v9, v161
    v_fmac_f32 v242, v2, v146
    v_mfma_f32_32x32x16_bf16 v[48:63], v[76:79], v[188:191], v[48:63]
    s_setprio 0
    v_fmac_f32 v238, v10, v162
    v_fmac_f32 v242, v3, v147
    v_fmac_f32 v238, v11, v163
    v_fmac_f32 v242, v4, v148
    v_fmac_f32 v238, v12, v164
    v_fmac_f32 v242, v5, v149
    v_fmac_f32 v238, v13, v165
    v_fmac_f32 v242, v6, v150
    v_fmac_f32 v238, v14, v166
    v_fmac_f32 v242, v7, v151
    v_fmac_f32 v238, v15, v167
    v_fmac_f32 v236, v16, v112
    v_mul_f32 v244, v24, v160
    v_fmac_f32 v236, v17, v113
    v_fmac_f32 v244, v25, v161
    v_fmac_f32 v236, v18, v114
    v_fmac_f32 v244, v26, v162
    v_fmac_f32 v236, v19, v115
    v_fmac_f32 v244, v27, v163
    v_fmac_f32 v236, v20, v116
    v_fmac_f32 v244, v28, v164
    v_fmac_f32 v236, v21, v117
    v_fmac_f32 v244, v29, v165
    v_fmac_f32 v236, v22, v118
    v_fmac_f32 v244, v30, v166
    v_fmac_f32 v236, v23, v119
    v_fmac_f32 v244, v31, v167
    v_mul_f32 v243, v32, v152
    v_fma_f32 v239, v40, v168, -v239
    v_fmac_f32 v243, v33, v153
    v_fmac_f32 v239, v41, v169
    v_fmac_f32 v243, v34, v154
    v_fmac_f32 v239, v42, v170
    v_fmac_f32 v243, v35, v155
    v_fmac_f32 v239, v43, v171
    v_fmac_f32 v243, v36, v156
    v_fmac_f32 v239, v44, v172
    v_fmac_f32 v243, v37, v157
    v_fmac_f32 v239, v45, v173
    v_fmac_f32 v243, v38, v158
    v_fmac_f32 v239, v46, v174
    v_fmac_f32 v243, v39, v159
    v_fmac_f32 v239, v47, v175
    v_fmac_f32 v237, v48, v120
    v_mul_f32 v245, v56, v168
    v_fmac_f32 v237, v49, v121
    v_fmac_f32 v245, v57, v169
    v_fmac_f32 v237, v50, v122
    s_setprio 1
    s_waitcnt vmcnt(4) lgkmcnt(1)
    v_mfma_f32_32x32x16_bf16 v[0:15], v[64:67], v[176:179], 0
    ds_read_b64_tr_b16 v[184:185], v246 offset:6144
    ds_read_b64_tr_b16 v[186:187], v246 offset:6656
    ds_read_b64_tr_b16 v[188:189], v247 offset:6144
    ds_read_b64_tr_b16 v[190:191], v247 offset:6656
    v_fmac_f32 v245, v58, v170
    v_fmac_f32 v237, v51, v123
    s_mov_b32 m0, s70
    v_mfma_f32_32x32x16_bf16 v[16:31], v[68:71], v[176:179], 0
    buffer_load_dwordx4 v226, s[4:7], s46 offen sc1 lds
    buffer_load_dwordx4 v227, s[72:75], s46 offen offset:1024 sc1 lds
    s_waitcnt lgkmcnt(4)
    v_mad_u32_u16 v229, v228, s39, v248 op_sel:[1,0,0,0]
    v_mad_u32_u16 v228, v228, s39, v248
    v_fmac_f32 v245, v59, v171
    v_fmac_f32 v237, v52, v124
    v_mfma_f32_32x32x16_bf16 v[32:47], v[64:67], v[180:183], 0
    v_fmac_f32 v245, v60, v172
    v_fmac_f32 v237, v53, v125
    v_fmac_f32 v245, v61, v173
    v_fmac_f32 v237, v54, v126
    v_fmac_f32 v245, v62, v174
    v_fmac_f32 v237, v55, v127
    v_fmac_f32 v245, v63, v175
    v_mfma_f32_32x32x16_bf16 v[48:63], v[68:71], v[180:183], 0
    v_permlane32_swap_b32 v242, v234
    v_permlane32_swap_b32 v243, v235
    v_add_f32 v242, v242, v234
    v_add_f32 v243, v243, v235
    s_waitcnt vmcnt(4) lgkmcnt(0)
    v_mfma_f32_32x32x16_bf16 v[0:15], v[72:75], v[184:187], v[0:15]
    ds_read_b64_tr_b16 v[176:177], v246 offset:0
    ds_read_b64_tr_b16 v[178:179], v246 offset:512
    ds_read_b64_tr_b16 v[180:181], v247 offset:0
    ds_read_b64_tr_b16 v[182:183], v247 offset:512
    v_cvt_pk_bf16_f32 v242, v242, v243
    ds_write_b32 v230, v242 offset:512
    s_mov_b32 m0, s71
    v_mfma_f32_32x32x16_bf16 v[16:31], v[76:79], v[184:187], v[16:31]
    buffer_load_dwordx4 v228, s[4:7], s47 offen sc1 lds
    buffer_load_dwordx4 v229, s[72:75], s47 offen offset:1024 sc1 lds
    s_sub_u32 s26, s48, s29
    s_mov_b32 s29, s48
    s_mov_b32 s30, s3
    s_cmp_lg_u32 s36, 0
    s_cselect_b32 s56, s33, 0
    v_mfma_f32_32x32x16_bf16 v[32:47], v[72:75], v[188:191], v[32:47]
    s_mov_b32 s32, s31
    s_mov_b32 s31, s35
    v_mul_f32 v242, v0, v144
    v_fma_f32 v240, v8, v160, -v240
    v_fmac_f32 v242, v1, v145
    v_fmac_f32 v240, v9, v161
    v_fmac_f32 v242, v2, v146
    v_mfma_f32_32x32x16_bf16 v[48:63], v[76:79], v[188:191], v[48:63]
    s_setprio 0
    v_fmac_f32 v240, v10, v162
    v_fmac_f32 v242, v3, v147
    v_fmac_f32 v240, v11, v163
    v_fmac_f32 v242, v4, v148
    v_fmac_f32 v240, v12, v164
    v_fmac_f32 v242, v5, v149
    v_fmac_f32 v240, v13, v165
    v_fmac_f32 v242, v6, v150
    v_fmac_f32 v240, v14, v166
    v_fmac_f32 v242, v7, v151
    v_fmac_f32 v240, v15, v167
    v_add_u32 v249, s26, v249
    v_add_u32 v250, s26, v250
    v_fma_f32 v244, v16, v160, -v244
    v_fmac_f32 v236, v24, v112
    v_fmac_f32 v244, v17, v161
    v_fmac_f32 v236, v25, v113
    v_fmac_f32 v244, v18, v162
    v_fmac_f32 v236, v26, v114
    v_fmac_f32 v244, v19, v163
    v_fmac_f32 v236, v27, v115
    v_fmac_f32 v244, v20, v164
    v_fmac_f32 v236, v28, v116
    v_fmac_f32 v244, v21, v165
    v_fmac_f32 v236, v29, v117
    v_fmac_f32 v244, v22, v166
    v_fmac_f32 v236, v30, v118
    v_fmac_f32 v244, v23, v167
    v_fmac_f32 v236, v31, v119
    ds_read_b64_tr_b16 v[0:1], v249 offset:0
    ds_read_b64_tr_b16 v[2:3], v249 offset:128
    ds_read_b128 v[4:7], v250 offset:0
    ds_read_b128 v[8:11], v250 offset:16
    ds_read_b128 v[12:15], v250 offset:384
    ds_read_b128 v[16:19], v250 offset:400
    v_mul_f32 v243, v32, v152
    v_fma_f32 v241, v40, v168, -v241
    v_fmac_f32 v243, v33, v153
    v_fmac_f32 v241, v41, v169
    v_fmac_f32 v243, v34, v154
    v_fmac_f32 v241, v42, v170
    v_fmac_f32 v243, v35, v155
    v_fmac_f32 v241, v43, v171
    v_fmac_f32 v243, v36, v156
    v_fmac_f32 v241, v44, v172
    v_fmac_f32 v243, v37, v157
    v_fmac_f32 v241, v45, v173
    v_fmac_f32 v243, v38, v158
    v_fmac_f32 v241, v46, v174
    v_fmac_f32 v243, v39, v159
    v_fmac_f32 v241, v47, v175
    ds_read_b64_tr_b16 v[20:21], v249 offset:512
    ds_read_b64_tr_b16 v[22:23], v249 offset:640
    ds_read_b128 v[24:27], v250 offset:64
    ds_read_b128 v[28:31], v250 offset:80
    ds_read_b128 v[32:35], v250 offset:448
    ds_read_b128 v[36:39], v250 offset:464
    v_fma_f32 v245, v48, v168, -v245
    v_fmac_f32 v237, v56, v120
    v_fmac_f32 v245, v49, v169
    v_fmac_f32 v237, v57, v121
    v_fmac_f32 v245, v50, v170
    v_fmac_f32 v237, v58, v122
    v_fmac_f32 v245, v51, v171
    v_fmac_f32 v237, v59, v123
    v_fmac_f32 v245, v52, v172
    v_fmac_f32 v237, v60, v124
    v_fmac_f32 v245, v53, v173
    v_fmac_f32 v237, v61, v125
    v_fmac_f32 v245, v54, v174
    v_fmac_f32 v237, v62, v126
    v_fmac_f32 v245, v55, v175
    v_fmac_f32 v237, v63, v127
    s_cmp_eq_u32 s56, 2
    s_cbranch_scc1 K2_U21
    s_cmp_eq_u32 s56, 3
    s_cbranch_scc1 K2_U31
    s_branch K2_DSP1
K2_PAD_U31:
    s_branch K2_HOP
K2_U31:
    s_setprio 1
    s_waitcnt lgkmcnt(6)
    v_lshlrev_b32 v40, 16, v0
    v_and_b32 v41, 0xffff0000, v0
    v_lshlrev_b32 v42, 16, v1
    v_and_b32 v43, 0xffff0000, v1
    v_lshlrev_b32 v44, 16, v2
    v_and_b32 v45, 0xffff0000, v2
    v_lshlrev_b32 v46, 16, v3
    v_and_b32 v47, 0xffff0000, v3
    v_mul_f32 v4, v40, v4
    v_mul_f32 v5, v41, v5
    v_mul_f32 v6, v42, v6
    v_mul_f32 v7, v43, v7
    v_mul_f32 v8, v44, v8
    v_mul_f32 v9, v45, v9
    v_mul_f32 v10, v46, v10
    v_mul_f32 v11, v47, v11
    v_cvt_pk_bf16_f32 v64, v4, v5
    v_cvt_pk_bf16_f32 v65, v6, v7
    v_cvt_pk_bf16_f32 v66, v8, v9
    v_cvt_pk_bf16_f32 v67, v10, v11
    v_mul_f32 v12, v40, v12
    v_mul_f32 v13, v41, v13
    v_mul_f32 v14, v42, v14
    v_mul_f32 v15, v43, v15
    v_mul_f32 v16, v44, v16
    v_mul_f32 v17, v45, v17
    v_mul_f32 v18, v46, v18
    v_mul_f32 v19, v47, v19
    v_cvt_pk_bf16_f32 v68, v12, v13
    v_cvt_pk_bf16_f32 v69, v14, v15
    v_cvt_pk_bf16_f32 v70, v16, v17
    v_cvt_pk_bf16_f32 v71, v18, v19
    ds_read_b64_tr_b16 v[0:1], v249 offset:1024
    ds_read_b64_tr_b16 v[2:3], v249 offset:1152
    ds_read_b128 v[4:7], v250 offset:128
    ds_read_b128 v[8:11], v250 offset:144
    ds_read_b128 v[12:15], v250 offset:512
    ds_read_b128 v[16:19], v250 offset:528
    s_waitcnt lgkmcnt(6)
    v_lshlrev_b32 v48, 16, v20
    v_and_b32 v49, 0xffff0000, v20
    v_lshlrev_b32 v50, 16, v21
    v_and_b32 v51, 0xffff0000, v21
    v_lshlrev_b32 v52, 16, v22
    v_and_b32 v53, 0xffff0000, v22
    v_lshlrev_b32 v54, 16, v23
    v_and_b32 v55, 0xffff0000, v23
    v_mul_f32 v24, v48, v24
    v_mul_f32 v25, v49, v25
    v_mul_f32 v26, v50, v26
    v_mul_f32 v27, v51, v27
    v_mul_f32 v28, v52, v28
    v_mul_f32 v29, v53, v29
    v_mul_f32 v30, v54, v30
    v_mul_f32 v31, v55, v31
    v_cvt_pk_bf16_f32 v72, v24, v25
    v_cvt_pk_bf16_f32 v73, v26, v27
    v_cvt_pk_bf16_f32 v74, v28, v29
    v_cvt_pk_bf16_f32 v75, v30, v31
    v_mul_f32 v32, v48, v32
    v_mul_f32 v33, v49, v33
    v_mul_f32 v34, v50, v34
    v_mul_f32 v35, v51, v35
    v_mul_f32 v36, v52, v36
    v_mul_f32 v37, v53, v37
    v_mul_f32 v38, v54, v38
    v_mul_f32 v39, v55, v39
    v_cvt_pk_bf16_f32 v76, v32, v33
    v_cvt_pk_bf16_f32 v77, v34, v35
    v_cvt_pk_bf16_f32 v78, v36, v37
    v_cvt_pk_bf16_f32 v79, v38, v39
    s_waitcnt lgkmcnt(4)
    v_lshlrev_b32 v40, 16, v0
    v_and_b32 v41, 0xffff0000, v0
    v_lshlrev_b32 v42, 16, v1
    v_and_b32 v43, 0xffff0000, v1
    v_lshlrev_b32 v44, 16, v2
    v_and_b32 v45, 0xffff0000, v2
    v_lshlrev_b32 v46, 16, v3
    v_and_b32 v47, 0xffff0000, v3
    s_waitcnt lgkmcnt(2)
    v_mul_f32 v4, v40, v4
    v_mul_f32 v5, v41, v5
    v_mul_f32 v6, v42, v6
    v_mul_f32 v7, v43, v7
    v_mul_f32 v8, v44, v8
    v_mul_f32 v9, v45, v9
    v_mul_f32 v10, v46, v10
    v_mul_f32 v11, v47, v11
    v_cvt_pk_bf16_f32 v80, v4, v5
    v_cvt_pk_bf16_f32 v81, v6, v7
    v_cvt_pk_bf16_f32 v82, v8, v9
    v_cvt_pk_bf16_f32 v83, v10, v11
    s_waitcnt lgkmcnt(0)
    v_mul_f32 v12, v40, v12
    v_mul_f32 v13, v41, v13
    v_mul_f32 v14, v42, v14
    v_mul_f32 v15, v43, v15
    v_mul_f32 v16, v44, v16
    v_mul_f32 v17, v45, v17
    v_mul_f32 v18, v46, v18
    v_mul_f32 v19, v47, v19
    v_cvt_pk_bf16_f32 v84, v12, v13
    v_cvt_pk_bf16_f32 v85, v14, v15
    v_cvt_pk_bf16_f32 v86, v16, v17
    v_cvt_pk_bf16_f32 v87, v18, v19
    s_waitcnt vmcnt(4)
    v_mfma_f32_32x32x16_bf16 v[0:15], v[64:67], v[176:179], 0
    ds_read_b64_tr_b16 v[184:185], v246 offset:2048
    ds_read_b64_tr_b16 v[186:187], v246 offset:2560
    ds_read_b64_tr_b16 v[188:189], v247 offset:2048
    ds_read_b64_tr_b16 v[190:191], v247 offset:2560
    s_mov_b32 m0, s68
    v_mfma_f32_32x32x16_bf16 v[16:31], v[68:71], v[176:179], 0
    buffer_load_dwordx4 v224, s[4:7], s41 offen sc1 lds
    buffer_load_dwordx4 v225, s[72:75], s41 offen offset:1024 sc1 lds
    v_permlane32_swap_b32 v242, v236
    v_permlane32_swap_b32 v243, v237
    v_mov_b32 v254, 163648
    v_mfma_f32_32x32x16_bf16 v[32:47], v[64:67], v[180:183], 0
    v_permlane32_swap_b32 v244, v238
    v_permlane32_swap_b32 v245, v239
    v_permlane32_swap_b32 v240, v241
    v_add_f32 v242, v242, v236
    v_mfma_f32_32x32x16_bf16 v[48:63], v[68:71], v[180:183], 0
    v_add_f32 v243, v243, v237
    v_add_f32 v244, v244, v238
    v_add_f32 v245, v245, v239
    v_add_f32 v240, -v240, -v241
    v_sub_u32 v241, v230, v231
    v_cvt_pk_bf16_f32 v242, v242, v243
    v_mov_b32 v255, 1
    v_lshl_add_u32 v233, v252, 1, s53
    s_mov_b64 exec, 1
    ds_add_rtn_u32 v232, v254, v255
    s_mov_b64 exec, -1
    ds_read_b32 v233, v233
    s_waitcnt vmcnt(4) lgkmcnt(2)
    v_mfma_f32_32x32x16_bf16 v[0:15], v[72:75], v[184:187], v[0:15]
    ds_read_b64_tr_b16 v[176:177], v246 offset:4096
    ds_read_b64_tr_b16 v[178:179], v246 offset:4608
    ds_read_b64_tr_b16 v[180:181], v247 offset:4096
    ds_read_b64_tr_b16 v[182:183], v247 offset:4608
    v_cvt_pk_bf16_f32 v244, v244, v245
    v_cvt_pk_bf16_f32 v240, v240, v240
    s_mov_b32 m0, s69
    v_mfma_f32_32x32x16_bf16 v[16:31], v[76:79], v[184:187], v[16:31]
    buffer_load_dwordx4 v226, s[4:7], s41 offen sc1 lds
    buffer_load_dwordx4 v227, s[72:75], s41 offen offset:1024 sc1 lds
    ds_write_b32 v230, v242 offset:768
    ds_write_b32 v230, v244 offset:1024
    ds_write_b16 v241, v240 offset:1280
    s_waitcnt lgkmcnt(7)
    v_readfirstlane_b32 s58, v232
    v_mfma_f32_32x32x16_bf16 v[32:47], v[72:75], v[188:191], v[32:47]
    s_cmp_lt_u32 s58, s22
    s_cbranch_scc0 K2_nul_41
    s_and_b32 s59, s58, 7
    s_lshr_b32 s60, s58, 3
K2_chk_43:
    v_readlane_b32 s61, v233, s59
    s_nop 0
    s_cmp_gt_u32 s61, s60
    s_cbranch_scc0 K2_spin_42
K2_back_44:
    v_mfma_f32_32x32x16_bf16 v[48:63], v[76:79], v[188:191], v[48:63]
    v_readlane_b32 s3, v253, s58
    s_lshl_b32 s44, s34, 7
    s_lshl_b32 s60, s58, 5
    s_and_b32 s48, s3, 0x3ffff
    s_bfe_u32 s33, s3, 0x30012
    s_sub_u32 s60, s60, s48
    s_waitcnt vmcnt(4) lgkmcnt(3)
    v_mfma_f32_32x32x16_bf16 v[0:15], v[80:83], v[176:179], v[0:15]
    ds_read_b64_tr_b16 v[184:185], v246 offset:6144
    ds_read_b64_tr_b16 v[186:187], v246 offset:6656
    ds_read_b64_tr_b16 v[188:189], v247 offset:6144
    ds_read_b64_tr_b16 v[190:191], v247 offset:6656
    s_and_b32 s60, s60, 0xff
    s_add_u32 s35, s60, s48
    s_mov_b32 m0, s70
    v_mfma_f32_32x32x16_bf16 v[16:31], v[84:87], v[176:179], v[16:31]
    buffer_load_dwordx4 v222, s[4:7], s42 offen sc1 lds
    buffer_load_dwordx4 v223, s[72:75], s42 offen offset:1024 sc1 lds
    s_mov_b32 s45, s44
    s_add_u32 s47, s44, 256
    s_add_u32 s49, s48, 32
    s_add_u32 s60, s48, 64
    v_mfma_f32_32x32x16_bf16 v[32:47], v[80:83], v[180:183], v[32:47]
    s_cmp_eq_u32 s33, 3
    s_cselect_b32 s46, s44, s47
    s_cselect_b32 s50, s60, s48
    s_cselect_b32 s51, s48, s49
    s_sub_u32 s60, s33, 2
    s_cmp_lt_u32 s60, 2
    s_cbranch_scc0 K2_rare_45
K2_back_46:
    v_mfma_f32_32x32x16_bf16 v[48:63], v[84:87], v[180:183], v[48:63]
    s_setprio 0
    v_mul_f32 v234, v0, v96
    v_mul_f32 v236, v8, v128
    v_fmac_f32 v234, v1, v97
    v_fmac_f32 v236, v9, v129
    v_fmac_f32 v234, v2, v98
    v_fmac_f32 v236, v10, v130
    v_fmac_f32 v234, v3, v99
    v_fmac_f32 v236, v11, v131
    v_fmac_f32 v234, v4, v100
    v_fmac_f32 v236, v12, v132
    v_fmac_f32 v234, v5, v101
    v_fmac_f32 v236, v13, v133
    v_fmac_f32 v234, v6, v102
    v_fmac_f32 v236, v14, v134
    v_fmac_f32 v234, v7, v103
    v_fmac_f32 v236, v15, v135
    v_mul_f32 v238, v16, v128
    v_mul_f32 v240, v24, v128
    v_fmac_f32 v238, v17, v129
    v_fmac_f32 v240, v25, v129
    v_fmac_f32 v238, v18, v130
    v_fmac_f32 v240, v26, v130
    v_fmac_f32 v238, v19, v131
    v_fmac_f32 v240, v27, v131
    v_fmac_f32 v238, v20, v132
    v_fmac_f32 v240, v28, v132
    v_fmac_f32 v238, v21, v133
    v_fmac_f32 v240, v29, v133
    v_fmac_f32 v238, v22, v134
    v_fmac_f32 v240, v30, v134
    v_fmac_f32 v238, v23, v135
    v_fmac_f32 v240, v31, v135
    v_mul_f32 v235, v32, v104
    v_mul_f32 v237, v40, v136
    v_fmac_f32 v235, v33, v105
    v_fmac_f32 v237, v41, v137
    v_fmac_f32 v235, v34, v106
    v_fmac_f32 v237, v42, v138
    v_fmac_f32 v235, v35, v107
    v_fmac_f32 v237, v43, v139
    v_fmac_f32 v235, v36, v108
    v_fmac_f32 v237, v44, v140
    v_fmac_f32 v235, v37, v109
    v_fmac_f32 v237, v45, v141
    v_fmac_f32 v235, v38, v110
    v_fmac_f32 v237, v46, v142
    v_fmac_f32 v235, v39, v111
    v_fmac_f32 v237, v47, v143
    v_mul_f32 v239, v48, v136
    v_mul_f32 v241, v56, v136
    s_setprio 1
    s_waitcnt vmcnt(4) lgkmcnt(0)
    v_mfma_f32_32x32x16_bf16 v[0:15], v[64:67], v[184:187], 0
    ds_read_b64_tr_b16 v[176:177], v246 offset:0
    ds_read_b64_tr_b16 v[178:179], v246 offset:512
    ds_read_b64_tr_b16 v[180:181], v247 offset:0
    ds_read_b64_tr_b16 v[182:183], v247 offset:512
    v_fmac_f32 v239, v49, v137
    v_fmac_f32 v241, v57, v137
    s_mov_b32 m0, s71
    v_mfma_f32_32x32x16_bf16 v[16:31], v[68:71], v[184:187], 0
    buffer_load_dwordx4 v224, s[4:7], s42 offen sc1 lds
    buffer_load_dwordx4 v225, s[72:75], s42 offen offset:1024 sc1 lds
    v_fmac_f32 v239, v50, v138
    v_fmac_f32 v241, v58, v138
    v_fmac_f32 v239, v51, v139
    v_fmac_f32 v241, v59, v139
    v_fmac_f32 v239, v52, v140
    v_mfma_f32_32x32x16_bf16 v[32:47], v[64:67], v[188:191], 0
    v_fmac_f32 v241, v60, v140
    v_fmac_f32 v239, v53, v141
    v_fmac_f32 v241, v61, v141
    v_fmac_f32 v239, v54, v142
    v_fmac_f32 v241, v62, v142
    v_fmac_f32 v239, v55, v143
    v_fmac_f32 v241, v63, v143
    v_mfma_f32_32x32x16_bf16 v[48:63], v[68:71], v[188:191], 0
    v_permlane32_swap_b32 v234, v236
    v_permlane32_swap_b32 v235, v237
    v_permlane32_swap_b32 v240, v238
    s_waitcnt vmcnt(4) lgkmcnt(0)
    v_mfma_f32_32x32x16_bf16 v[0:15], v[72:75], v[176:179], v[0:15]
    ds_read_b64_tr_b16 v[184:185], v246 offset:2048
    ds_read_b64_tr_b16 v[186:187], v246 offset:2560
    ds_read_b64_tr_b16 v[188:189], v247 offset:2048
    ds_read_b64_tr_b16 v[190:191], v247 offset:2560
    v_permlane32_swap_b32 v241, v239
    s_mov_b32 m0, s68
    v_mfma_f32_32x32x16_bf16 v[16:31], v[76:79], v[176:179], v[16:31]
    buffer_load_dwordx4 v226, s[4:7], s42 offen sc1 lds
    buffer_load_dwordx4 v227, s[72:75], s42 offen offset:1024 sc1 lds
    v_lshl_add_u32 v230, v252, 1, s31
    v_add_f32 v234, v234, v236
    v_add_f32 v235, v235, v237
    v_add_f32 v240, v240, v238
    v_add_f32 v241, v241, v239
    v_mfma_f32_32x32x16_bf16 v[32:47], v[72:75], v[180:183], v[32:47]
    v_cvt_pk_bf16_f32 v234, v234, v235
    v_cvt_pk_bf16_f32 v240, v240, v241
    ds_write_b32 v230, v234 offset:0
    ds_write_b32 v230, v240 offset:256
    v_mfma_f32_32x32x16_bf16 v[48:63], v[76:79], v[180:183], v[48:63]
    s_waitcnt vmcnt(4) lgkmcnt(2)
    v_mfma_f32_32x32x16_bf16 v[0:15], v[80:83], v[184:187], v[0:15]
    ds_read_b64_tr_b16 v[176:177], v246 offset:4096
    ds_read_b64_tr_b16 v[178:179], v246 offset:4608
    ds_read_b64_tr_b16 v[180:181], v247 offset:4096
    ds_read_b64_tr_b16 v[182:183], v247 offset:4608
    s_mov_b32 m0, s69
    v_mfma_f32_32x32x16_bf16 v[16:31], v[84:87], v[184:187], v[16:31]
    buffer_load_dwordx4 v222, s[4:7], s43 offen sc1 lds
    buffer_load_dwordx4 v223, s[72:75], s43 offen offset:1024 sc1 lds
    v_mfma_f32_32x32x16_bf16 v[32:47], v[80:83], v[188:191], v[32:47]
    s_nop 2
    v_mul_f32 v234, v0, v144
    v_mul_f32 v236, v8, v112
    v_fmac_f32 v234, v1, v145
    v_fmac_f32 v236, v9, v113
    v_fmac_f32 v234, v2, v146
    v_fmac_f32 v236, v10, v114
    v_fmac_f32 v234, v3, v147
    v_mfma_f32_32x32x16_bf16 v[48:63], v[84:87], v[188:191], v[48:63]
    s_setprio 0
    v_fmac_f32 v236, v11, v115
    v_fmac_f32 v234, v4, v148
    v_fmac_f32 v236, v12, v116
    v_fmac_f32 v234, v5, v149
    v_fmac_f32 v236, v13, v117
    v_fmac_f32 v234, v6, v150
    v_fmac_f32 v236, v14, v118
    v_fmac_f32 v234, v7, v151
    v_fmac_f32 v236, v15, v119
    v_mul_f32 v238, v16, v160
    v_mul_f32 v240, v24, v160
    v_fmac_f32 v238, v17, v161
    v_fmac_f32 v240, v25, v161
    v_fmac_f32 v238, v18, v162
    v_fmac_f32 v240, v26, v162
    v_fmac_f32 v238, v19, v163
    v_fmac_f32 v240, v27, v163
    v_fmac_f32 v238, v20, v164
    v_fmac_f32 v240, v28, v164
    v_fmac_f32 v238, v21, v165
    v_fmac_f32 v240, v29, v165
    v_fmac_f32 v238, v22, v166
    v_fmac_f32 v240, v30, v166
    v_fmac_f32 v238, v23, v167
    v_fmac_f32 v240, v31, v167
    v_mul_f32 v235, v32, v152
    v_mul_f32 v237, v40, v120
    v_fmac_f32 v235, v33, v153
    v_fmac_f32 v237, v41, v121
    v_fmac_f32 v235, v34, v154
    v_fmac_f32 v237, v42, v122
    v_fmac_f32 v235, v35, v155
    v_fmac_f32 v237, v43, v123
    v_fmac_f32 v235, v36, v156
    v_fmac_f32 v237, v44, v124
    v_fmac_f32 v235, v37, v157
    v_fmac_f32 v237, v45, v125
    v_fmac_f32 v235, v38, v158
    v_fmac_f32 v237, v46, v126
    v_fmac_f32 v235, v39, v159
    v_fmac_f32 v237, v47, v127
    v_mul_f32 v239, v48, v168
    v_mul_f32 v241, v56, v168
    v_fmac_f32 v239, v49, v169
    v_fmac_f32 v241, v57, v169
    s_setprio 1
    s_waitcnt vmcnt(4) lgkmcnt(0)
    v_mfma_f32_32x32x16_bf16 v[0:15], v[64:67], v[176:179], 0
    ds_read_b64_tr_b16 v[184:185], v246 offset:6144
    ds_read_b64_tr_b16 v[186:187], v246 offset:6656
    ds_read_b64_tr_b16 v[188:189], v247 offset:6144
    ds_read_b64_tr_b16 v[190:191], v247 offset:6656
    v_fmac_f32 v239, v50, v170
    v_fmac_f32 v241, v58, v170
    s_mov_b32 m0, s70
    v_mfma_f32_32x32x16_bf16 v[16:31], v[68:71], v[176:179], 0
    buffer_load_dwordx4 v224, s[4:7], s43 offen sc1 lds
    buffer_load_dwordx4 v225, s[72:75], s43 offen offset:1024 sc1 lds
    v_fmac_f32 v239, v51, v171
    v_fmac_f32 v241, v59, v171
    v_fmac_f32 v239, v52, v172
    v_fmac_f32 v241, v60, v172
    v_fmac_f32 v239, v53, v173
    v_mfma_f32_32x32x16_bf16 v[32:47], v[64:67], v[180:183], 0
    v_add_u32 v222, s48, v251
    ds_read_b32 v222, v222
    v_fmac_f32 v241, v61, v173
    v_fmac_f32 v239, v54, v174
    v_fmac_f32 v241, v62, v174
    v_fmac_f32 v239, v55, v175
    v_fmac_f32 v241, v63, v175
    v_mfma_f32_32x32x16_bf16 v[48:63], v[68:71], v[180:183], 0
    s_waitcnt vmcnt(4) lgkmcnt(1)
    v_mfma_f32_32x32x16_bf16 v[0:15], v[72:75], v[184:187], v[0:15]
    ds_read_b64_tr_b16 v[176:177], v246 offset:0
    ds_read_b64_tr_b16 v[178:179], v246 offset:512
    ds_read_b64_tr_b16 v[180:181], v247 offset:0
    ds_read_b64_tr_b16 v[182:183], v247 offset:512
    s_mov_b32 m0, s71
    v_mfma_f32_32x32x16_bf16 v[16:31], v[76:79], v[184:187], v[16:31]
    buffer_load_dwordx4 v226, s[4:7], s43 offen sc1 lds
    buffer_load_dwordx4 v227, s[72:75], s43 offen offset:1024 sc1 lds
    s_waitcnt lgkmcnt(4)
    v_mad_u32_u16 v223, v222, s39, v248 op_sel:[1,0,0,0]
    v_mad_u32_u16 v222, v222, s39, v248
    v_mfma_f32_32x32x16_bf16 v[32:47], v[72:75], v[188:191], v[32:47]
    v_add_u32 v224, s49, v251
    ds_read_b32 v224, v224
    v_mfma_f32_32x32x16_bf16 v[48:63], v[76:79], v[188:191], v[48:63]
    s_waitcnt vmcnt(4) lgkmcnt(1)
    v_mfma_f32_32x32x16_bf16 v[0:15], v[80:83], v[176:179], v[0:15]
    ds_read_b64_tr_b16 v[184:185], v246 offset:2048
    ds_read_b64_tr_b16 v[186:187], v246 offset:2560
    ds_read_b64_tr_b16 v[188:189], v247 offset:2048
    ds_read_b64_tr_b16 v[190:191], v247 offset:2560
    s_mov_b32 m0, s68
    v_mfma_f32_32x32x16_bf16 v[16:31], v[84:87], v[176:179], v[16:31]
    buffer_load_dwordx4 v222, s[4:7], s44 offen sc1 lds
    buffer_load_dwordx4 v223, s[72:75], s44 offen offset:1024 sc1 lds
    s_waitcnt lgkmcnt(4)
    v_mad_u32_u16 v225, v224, s39, v248 op_sel:[1,0,0,0]
    v_mad_u32_u16 v224, v224, s39, v248
    v_mfma_f32_32x32x16_bf16 v[32:47], v[80:83], v[180:183], v[32:47]
    v_add_u32 v226, s50, v251
    ds_read_b32 v226, v226
    v_mul_f32 v242, v0, v144
    v_fma_f32 v238, v8, v160, -v238
    v_fmac_f32 v242, v1, v145
    v_fmac_f32 v238, v9, v161
    v_fmac_f32 v242, v2, v146
    v_mfma_f32_32x32x16_bf16 v[48:63], v[84:87], v[180:183], v[48:63]
    s_setprio 0
    v_fmac_f32 v238, v10, v162
    v_fmac_f32 v242, v3, v147
    v_fmac_f32 v238, v11, v163
    v_fmac_f32 v242, v4, v148
    v_fmac_f32 v238, v12, v164
    v_fmac_f32 v242, v5, v149
    v_fmac_f32 v238, v13, v165
    v_fmac_f32 v242, v6, v150
    v_fmac_f32 v238, v14, v166
    v_fmac_f32 v242, v7, v151
    v_fmac_f32 v238, v15, v167
    v_fmac_f32 v236, v16, v112
    v_mul_f32 v244, v24, v160
    v_fmac_f32 v236, v17, v113
    v_fmac_f32 v244, v25, v161
    v_fmac_f32 v236, v18, v114
    v_fmac_f32 v244, v26, v162
    v_fmac_f32 v236, v19, v115
    v_fmac_f32 v244, v27, v163
    v_fmac_f32 v236, v20, v116
    v_fmac_f32 v244, v28, v164
    v_fmac_f32 v236, v21, v117
    v_fmac_f32 v244, v29, v165
    v_fmac_f32 v236, v22, v118
    v_fmac_f32 v244, v30, v166
    v_fmac_f32 v236, v23, v119
    v_fmac_f32 v244, v31, v167
    v_mul_f32 v243, v32, v152
    v_fma_f32 v239, v40, v168, -v239
    v_fmac_f32 v243, v33, v153
    v_fmac_f32 v239, v41, v169
    v_fmac_f32 v243, v34, v154
    v_fmac_f32 v239, v42, v170
    v_fmac_f32 v243, v35, v155
    v_fmac_f32 v239, v43, v171
    v_fmac_f32 v243, v36, v156
    v_fmac_f32 v239, v44, v172
    v_fmac_f32 v243, v37, v157
    v_fmac_f32 v239, v45, v173
    v_fmac_f32 v243, v38, v158
    v_fmac_f32 v239, v46, v174
    v_fmac_f32 v243, v39, v159
    v_fmac_f32 v239, v47, v175
    v_fmac_f32 v237, v48, v120
    v_mul_f32 v245, v56, v168
    v_fmac_f32 v237, v49, v121
    v_fmac_f32 v245, v57, v169
    v_fmac_f32 v237, v50, v122
    v_fmac_f32 v245, v58, v170
    v_fmac_f32 v237, v51, v123
    s_setprio 1
    s_waitcnt vmcnt(4) lgkmcnt(1)
    v_mfma_f32_32x32x16_bf16 v[0:15], v[64:67], v[184:187], 0
    ds_read_b64_tr_b16 v[176:177], v246 offset:4096
    ds_read_b64_tr_b16 v[178:179], v246 offset:4608
    ds_read_b64_tr_b16 v[180:181], v247 offset:4096
    ds_read_b64_tr_b16 v[182:183], v247 offset:4608
    v_fmac_f32 v245, v59, v171
    v_fmac_f32 v237, v52, v124
    s_mov_b32 m0, s69
    v_mfma_f32_32x32x16_bf16 v[16:31], v[68:71], v[184:187], 0
    buffer_load_dwordx4 v224, s[4:7], s45 offen sc1 lds
    buffer_load_dwordx4 v225, s[72:75], s45 offen offset:1024 sc1 lds
    s_waitcnt lgkmcnt(4)
    v_mad_u32_u16 v227, v226, s39, v248 op_sel:[1,0,0,0]
    v_mad_u32_u16 v226, v226, s39, v248
    v_fmac_f32 v245, v60, v172
    v_fmac_f32 v237, v53, v125
    v_mfma_f32_32x32x16_bf16 v[32:47], v[64:67], v[188:191], 0
    v_add_u32 v228, s51, v251
    ds_read_b32 v228, v228
    v_fmac_f32 v245, v61, v173
    v_fmac_f32 v237, v54, v126
    v_fmac_f32 v245, v62, v174
    v_fmac_f32 v237, v55, v127
    v_fmac_f32 v245, v63, v175
    v_mfma_f32_32x32x16_bf16 v[48:63], v[68:71], v[188:191], 0
    v_permlane32_swap_b32 v242, v234
    v_permlane32_swap_b32 v243, v235
    v_add_f32 v242, v242, v234
    v_add_f32 v243, v243, v235
    s_waitcnt vmcnt(4) lgkmcnt(1)
    v_mfma_f32_32x32x16_bf16 v[0:15], v[72:75], v[176:179], v[0:15]
    ds_read_b64_tr_b16 v[184:185], v246 offset:6144
    ds_read_b64_tr_b16 v[186:187], v246 offset:6656
    ds_read_b64_tr_b16 v[188:189], v247 offset:6144
    ds_read_b64_tr_b16 v[190:191], v247 offset:6656
    v_cvt_pk_bf16_f32 v242, v242, v243
    ds_write_b32 v230, v242 offset:512
    s_mov_b32 m0, s70
    v_mfma_f32_32x32x16_bf16 v[16:31], v[76:79], v[176:179], v[16:31]
    buffer_load_dwordx4 v226, s[4:7], s46 offen sc1 lds
    buffer_load_dwordx4 v227, s[72:75], s46 offen offset:1024 sc1 lds
    s_waitcnt lgkmcnt(5)
    v_mad_u32_u16 v229, v228, s39, v248 op_sel:[1,0,0,0]
    v_mad_u32_u16 v228, v228, s39, v248
    s_sub_u32 s26, s48, s29
    s_mov_b32 s29, s48
    v_mfma_f32_32x32x16_bf16 v[32:47], v[72:75], v[180:183], v[32:47]
    s_mov_b32 s30, s3
    s_cmp_lg_u32 s36, 0
    s_cselect_b32 s56, s33, 0
    s_mov_b32 s32, s31
    s_mov_b32 s31, s35
    v_mfma_f32_32x32x16_bf16 v[48:63], v[76:79], v[180:183], v[48:63]
    s_waitcnt vmcnt(4) lgkmcnt(1)
    v_mfma_f32_32x32x16_bf16 v[0:15], v[80:83], v[184:187], v[0:15]
    ds_read_b64_tr_b16 v[176:177], v246 offset:0
    ds_read_b64_tr_b16 v[178:179], v246 offset:512
    ds_read_b64_tr_b16 v[180:181], v247 offset:0
    ds_read_b64_tr_b16 v[182:183], v247 offset:512
    s_mov_b32 m0, s71
    v_mfma_f32_32x32x16_bf16 v[16:31], v[84:87], v[184:187], v[16:31]
    buffer_load_dwordx4 v228, s[4:7], s47 offen sc1 lds
    buffer_load_dwordx4 v229, s[72:75], s47 offen offset:1024 sc1 lds
    v_mfma_f32_32x32x16_bf16 v[32:47], v[80:83], v[188:191], v[32:47]
    s_nop 2
    v_mul_f32 v242, v0, v144
    v_fma_f32 v240, v8, v160, -v240
    v_fmac_f32 v242, v1, v145
    v_fmac_f32 v240, v9, v161
    v_fmac_f32 v242, v2, v146
    v_fmac_f32 v240, v10, v162
    v_fmac_f32 v242, v3, v147
    v_mfma_f32_32x32x16_bf16 v[48:63], v[84:87], v[188:191], v[48:63]
    s_setprio 0
    v_fmac_f32 v240, v11, v163
    v_fmac_f32 v242, v4, v148
    v_fmac_f32 v240, v12, v164
    v_fmac_f32 v242, v5, v149
    v_fmac_f32 v240, v13, v165
    v_fmac_f32 v242, v6, v150
    v_fmac_f32 v240, v14, v166
    v_fmac_f32 v242, v7, v151
    v_fmac_f32 v240, v15, v167
    v_add_u32 v249, s26, v249
    v_add_u32 v250, s26, v250
    v_fma_f32 v244, v16, v160, -v244
    v_fmac_f32 v236, v24, v112
    v_fmac_f32 v244, v17, v161
    v_fmac_f32 v236, v25, v113
    v_fmac_f32 v244, v18, v162
    v_fmac_f32 v236, v26, v114
    v_fmac_f32 v244, v19, v163
    v_fmac_f32 v236, v27, v115
    v_fmac_f32 v244, v20, v164
    v_fmac_f32 v236, v28, v116
    v_fmac_f32 v244, v21, v165
    v_fmac_f32 v236, v29, v117
    v_fmac_f32 v244, v22, v166
    v_fmac_f32 v236, v30, v118
    v_fmac_f32 v244, v23, v167
    v_fmac_f32 v236, v31, v119
    ds_read_b64_tr_b16 v[0:1], v249 offset:0
    ds_read_b64_tr_b16 v[2:3], v249 offset:128
    ds_read_b128 v[4:7], v250 offset:0
    ds_read_b128 v[8:11], v250 offset:16
    ds_read_b128 v[12:15], v250 offset:384
    ds_read_b128 v[16:19], v250 offset:400
    v_mul_f32 v243, v32, v152
    v_fma_f32 v241, v40, v168, -v241
    v_fmac_f32 v243, v33, v153
    v_fmac_f32 v241, v41, v169
    v_fmac_f32 v243, v34, v154
    v_fmac_f32 v241, v42, v170
    v_fmac_f32 v243, v35, v155
    v_fmac_f32 v241, v43, v171
    v_fmac_f32 v243, v36, v156
    v_fmac_f32 v241, v44, v172
    v_fmac_f32 v243, v37, v157
    v_fmac_f32 v241, v45, v173
    v_fmac_f32 v243, v38, v158
    v_fmac_f32 v241, v46, v174
    v_fmac_f32 v243, v39, v159
    v_fmac_f32 v241, v47, v175
    ds_read_b64_tr_b16 v[20:21], v249 offset:512
    ds_read_b64_tr_b16 v[22:23], v249 offset:640
    ds_read_b128 v[24:27], v250 offset:64
    ds_read_b128 v[28:31], v250 offset:80
    ds_read_b128 v[32:35], v250 offset:448
    ds_read_b128 v[36:39], v250 offset:464
    v_fma_f32 v245, v48, v168, -v245
    v_fmac_f32 v237, v56, v120
    v_fmac_f32 v245, v49, v169
    v_fmac_f32 v237, v57, v121
    v_fmac_f32 v245, v50, v170
    v_fmac_f32 v237, v58, v122
    v_fmac_f32 v245, v51, v171
    v_fmac_f32 v237, v59, v123
    v_fmac_f32 v245, v52, v172
    v_fmac_f32 v237, v60, v124
    v_fmac_f32 v245, v53, v173
    v_fmac_f32 v237, v61, v125
    v_fmac_f32 v245, v54, v174
    v_fmac_f32 v237, v62, v126
    v_fmac_f32 v245, v55, v175
    v_fmac_f32 v237, v63, v127
    s_cmp_eq_u32 s56, 2
    s_cbranch_scc1 K2_U21
    s_cmp_eq_u32 s56, 3
    s_cbranch_scc1 K2_U31
    s_branch K2_DSP1
K2_PAD_SW:
    s_branch K2_HOP
K2_DSP0:
    s_cmp_eq_u32 s56, 1
    s_cbranch_scc1 K2_U10
    s_cmp_eq_u32 s56, 4
    s_cbranch_scc1 K2_U40
    s_branch K2_SWITCH
K2_DSP1:
    s_cmp_eq_u32 s56, 1
    s_cbranch_scc1 K2_U11
    s_cmp_eq_u32 s56, 4
    s_cbranch_scc1 K2_U41
    s_branch K2_TAIL
K2_SWITCH:
    v_permlane32_swap_b32 v242, v236
    v_permlane32_swap_b32 v243, v237
    v_permlane32_swap_b32 v244, v238
    v_permlane32_swap_b32 v245, v239
    v_permlane32_swap_b32 v240, v241
    v_add_f32 v242, v242, v236
    v_add_f32 v243, v243, v237
    v_add_f32 v244, v244, v238
    v_add_f32 v245, v245, v239
    v_add_f32 v240, -v240, -v241
    s_set_gpr_idx_on s32, gpr_idx(DST)
    s_nop 0
    v_cvt_pk_bf16_f32 v195, v242, v243
    v_cvt_pk_bf16_f32 v196, v244, v245
    v_cvt_pk_bf16_f32 v197, v240, v240
    s_set_gpr_idx_off
    s_cmp_eq_u32 s36, 0
    s_cbranch_scc1 K2_TAIL2
    v_lshlrev_b32 v254, 3, v252
    v_lshl_add_u32 v230, v252, 1, s35
    v_lshrrev_b32 v231, 6, v252
    v_mul_u32_u24 v231, 126, v231
    s_mov_b32 s58, 7131136
    buffer_load_dwordx4 v[96:99], v254, s[8:11], s58 offen offset:0 sc1
    buffer_load_dwordx4 v[100:103], v254, s[8:11], s58 offen offset:1024 sc1
    buffer_load_dwordx4 v[104:107], v254, s[8:11], s58 offen offset:2048 sc1
    buffer_load_dwordx4 v[108:111], v254, s[8:11], s58 offen offset:3072 sc1
    s_mov_b32 s58, 7135232
    buffer_load_dwordx4 v[112:115], v254, s[8:11], s58 offen offset:0 sc1
    buffer_load_dwordx4 v[116:119], v254, s[8:11], s58 offen offset:1024 sc1
    buffer_load_dwordx4 v[120:123], v254, s[8:11], s58 offen offset:2048 sc1
    buffer_load_dwordx4 v[124:127], v254, s[8:11], s58 offen offset:3072 sc1
    s_mov_b32 s58, 7139328
    buffer_load_dwordx4 v[128:131], v254, s[8:11], s58 offen offset:0 sc1
    buffer_load_dwordx4 v[132:135], v254, s[8:11], s58 offen offset:1024 sc1
    buffer_load_dwordx4 v[136:139], v254, s[8:11], s58 offen offset:2048 sc1
    buffer_load_dwordx4 v[140:143], v254, s[8:11], s58 offen offset:3072 sc1
    s_mov_b32 s58, 7143424
    buffer_load_dwordx4 v[144:147], v254, s[8:11], s58 offen offset:0 sc1
    buffer_load_dwordx4 v[148:151], v254, s[8:11], s58 offen offset:1024 sc1
    buffer_load_dwordx4 v[152:155], v254, s[8:11], s58 offen offset:2048 sc1
    buffer_load_dwordx4 v[156:159], v254, s[8:11], s58 offen offset:3072 sc1
    s_mov_b32 s58, 7147520
    buffer_load_dwordx4 v[160:163], v254, s[8:11], s58 offen offset:0 sc1
    buffer_load_dwordx4 v[164:167], v254, s[8:11], s58 offen offset:1024 sc1
    buffer_load_dwordx4 v[168:171], v254, s[8:11], s58 offen offset:2048 sc1
    buffer_load_dwordx4 v[172:175], v254, s[8:11], s58 offen offset:3072 sc1
    s_movk_i32 s40, 128
    s_movk_i32 s41, 384
    s_movk_i32 s42, 640
    s_movk_i32 s43, 896
    s_cmp_lg_u32 s33, 1
    s_cbranch_scc1 K2_SW2
    s_waitcnt vmcnt(0)
K2_SW2:
    s_mov_b32 s29, s48
    s_mov_b32 s32, s31
    s_mov_b32 s30, s3
    s_mov_b32 s31, s35
    s_cmp_eq_u32 s33, 2
    s_cbranch_scc1 K2_U21
    s_cmp_eq_u32 s33, 3
    s_cbranch_scc1 K2_U31
    s_cmp_eq_u32 s33, 1
    s_cbranch_scc1 K2_U11
    s_branch K2_U41
K2_dum_4:
    v_mov_b32 v232, -1
    s_mov_b32 m0, 163712
    s_mov_b64 exec, 1
    buffer_load_dwordx4 v232, s[16:19], 0 offen lds
    buffer_load_dwordx4 v232, s[16:19], 0 offen lds
    s_mov_b64 exec, -1
    s_branch K2_back_6
K2_nul_10:
    s_mov_b32 s58, 63
    s_mov_b32 s36, 0
    s_branch K2_back_13
K2_spin_11:
    s_sub_u32 s27, s27, 1
    s_cbranch_scc1 K2_END
    v_lshl_add_u32 v233, v252, 1, s53
    ds_read_b32 v233, v233
    s_waitcnt lgkmcnt(0)
    s_branch K2_chk_12
K2_dyn_8:
    v_mov_b32 v254, 163648
    v_mov_b32 v255, 1
    v_lshl_add_u32 v233, v252, 1, s53
    s_mov_b64 exec, 1
    ds_add_rtn_u32 v232, v254, v255
    s_mov_b64 exec, -1
    ds_read_b32 v233, v233
    s_waitcnt lgkmcnt(0)
    v_readfirstlane_b32 s58, v232
    s_nop 0
    s_cmp_lt_u32 s58, s22
    s_cbranch_scc0 K2_nul_10
    s_and_b32 s59, s58, 7
    s_lshr_b32 s60, s58, 3
K2_chk_12:
    v_readlane_b32 s61, v233, s59
    s_nop 0
    s_cmp_gt_u32 s61, s60
    s_cbranch_scc0 K2_spin_11
K2_back_13:
    s_mov_b32 s34, 1
    s_branch K2_back_9
K2_dum_17:
    v_mov_b32 v232, -1
    s_mov_b32 m0, 163712
    s_mov_b64 exec, 1
    buffer_load_dwordx4 v232, s[16:19], 0 offen lds
    buffer_load_dwordx4 v232, s[16:19], 0 offen lds
    s_mov_b64 exec, -1
    s_branch K2_back_19
K2_nul_23:
    s_mov_b32 s58, 63
    s_mov_b32 s36, 0
    s_branch K2_back_26
K2_spin_24:
    s_sub_u32 s27, s27, 1
    s_cbranch_scc1 K2_END
    v_lshl_add_u32 v233, v252, 1, s53
    ds_read_b32 v233, v233
    s_waitcnt lgkmcnt(0)
    s_branch K2_chk_25
K2_dyn_21:
    v_mov_b32 v254, 163648
    v_mov_b32 v255, 1
    v_lshl_add_u32 v233, v252, 1, s53
    s_mov_b64 exec, 1
    ds_add_rtn_u32 v232, v254, v255
    s_mov_b64 exec, -1
    ds_read_b32 v233, v233
    s_waitcnt lgkmcnt(0)
    v_readfirstlane_b32 s58, v232
    s_nop 0
    s_cmp_lt_u32 s58, s22
    s_cbranch_scc0 K2_nul_23
    s_and_b32 s59, s58, 7
    s_lshr_b32 s60, s58, 3
K2_chk_25:
    v_readlane_b32 s61, v233, s59
    s_nop 0
    s_cmp_gt_u32 s61, s60
    s_cbranch_scc0 K2_spin_24
K2_back_26:
    s_mov_b32 s34, 1
    s_branch K2_back_22
K2_dum_30:
    v_mov_b32 v232, -1
    s_mov_b32 m0, 163712
    s_mov_b64 exec, 1
    buffer_load_dwordx4 v232, s[16:19], 0 offen lds
    buffer_load_dwordx4 v232, s[16:19], 0 offen lds
    s_mov_b64 exec, -1
    s_branch K2_back_32
K2_nul_34:
    s_mov_b32 s58, 63
    s_mov_b32 s36, 0
    s_branch K2_back_37
K2_spin_35:
    s_sub_u32 s27, s27, 1
    s_cbranch_scc1 K2_END
    v_lshl_add_u32 v233, v252, 1, s53
    ds_read_b32 v233, v233
    s_waitcnt lgkmcnt(0)
    s_branch K2_chk_36
K2_nul_41:
    s_mov_b32 s58, 63
    s_mov_b32 s36, 0
    s_branch K2_back_44
K2_spin_42:
    s_sub_u32 s27, s27, 1
    s_cbranch_scc1 K2_END
    v_lshl_add_u32 v233, v252, 1, s53
    ds_read_b32 v233, v233
    s_waitcnt lgkmcnt(0)
    s_branch K2_chk_43
K2_PAD_TL:
    s_branch K2_HOP
K2_TAIL2:
    v_lshlrev_b32 v229, 3, v252
    s_mul_i32 s58, s20, 20480
    s_add_u32 s58, s58, 6946816
    s_mul_i32 s59, s20, 8224
    buffer_load_dwordx4 v[96:99], v229, s[8:11], s58 offen offset:0 sc1
    buffer_load_dwordx4 v[100:103], v229, s[8:11], s58 offen offset:1024 sc1
    buffer_load_dwordx4 v[104:107], v229, s[8:11], s58 offen offset:2048 sc1
    buffer_load_dwordx4 v[108:111], v229, s[8:11], s58 offen offset:3072 sc1
    s_add_u32 s58, s58, 4096
    buffer_load_dwordx4 v[112:115], v229, s[8:11], s58 offen offset:0 sc1
    buffer_load_dwordx4 v[116:119], v229, s[8:11], s58 offen offset:1024 sc1
    buffer_load_dwordx4 v[120:123], v229, s[8:11], s58 offen offset:2048 sc1
    buffer_load_dwordx4 v[124:127], v229, s[8:11], s58 offen offset:3072 sc1
    s_add_u32 s58, s58, 4096
    v_lshl_add_u32 v228, v252, 1, s59
    v_lshrrev_b32 v226, 6, v252
    v_mul_u32_u24 v226, 126, v226
    v_sub_u32 v226, v228, v226
    s_branch K2_TAIL3
K2_TAIL:
    v_lshlrev_b32 v229, 3, v252
    s_mul_i32 s58, s20, 20480
    s_add_u32 s58, s58, 6946816
    s_mul_i32 s59, s20, 8224
    buffer_load_dwordx4 v[96:99], v229, s[8:11], s58 offen offset:0 sc1
    v_permlane32_swap_b32 v242, v236
    v_permlane32_swap_b32 v243, v237
    buffer_load_dwordx4 v[100:103], v229, s[8:11], s58 offen offset:1024 sc1
    v_permlane32_swap_b32 v244, v238
    v_permlane32_swap_b32 v245, v239
    buffer_load_dwordx4 v[104:107], v229, s[8:11], s58 offen offset:2048 sc1
    v_permlane32_swap_b32 v240, v241
    v_add_f32 v242, v242, v236
    buffer_load_dwordx4 v[108:111], v229, s[8:11], s58 offen offset:3072 sc1
    s_add_u32 s58, s58, 4096
    v_add_f32 v243, v243, v237
    v_add_f32 v244, v244, v238
    buffer_load_dwordx4 v[112:115], v229, s[8:11], s58 offen offset:0 sc1
    v_add_f32 v245, v245, v239
    v_add_f32 v240, -v240, -v241
    buffer_load_dwordx4 v[116:119], v229, s[8:11], s58 offen offset:1024 sc1
    v_sub_u32 v241, v230, v231
    v_cvt_pk_bf16_f32 v242, v242, v243
    buffer_load_dwordx4 v[120:123], v229, s[8:11], s58 offen offset:2048 sc1
    v_cvt_pk_bf16_f32 v244, v244, v245
    v_cvt_pk_bf16_f32 v240, v240, v240
    buffer_load_dwordx4 v[124:127], v229, s[8:11], s58 offen offset:3072 sc1
    s_add_u32 s58, s58, 4096
    ds_write_b32 v230, v242 offset:768
    ds_write_b32 v230, v244 offset:1024
    ds_write_b16 v241, v240 offset:1280
    v_lshl_add_u32 v228, v252, 1, s59
    v_lshrrev_b32 v226, 6, v252
    v_mul_u32_u24 v226, 126, v226
    v_sub_u32 v226, v228, v226
K2_TAIL3:
    s_waitcnt vmcnt(8)
    ds_write_b32 v228, v192 offset:0
    ds_write_b32 v228, v193 offset:256
    ds_write_b32 v228, v194 offset:512
    buffer_load_dwordx4 v[128:131], v229, s[8:11], s58 offen offset:0 sc1
    v_bfe_u32 v48, v252, 1, 4
    v_lshrrev_b32 v49, 5, v252
    ds_write_b32 v228, v195 offset:768
    ds_write_b32 v228, v196 offset:1024
    ds_write_b16 v226, v197 offset:1280
    buffer_load_dwordx4 v[132:135], v229, s[8:11], s58 offen offset:1024 sc1
    v_lshrrev_b32 v55, 3, v48
    v_lshlrev_b32 v52, 4, v49
    ds_write_b32 v228, v198 offset:1536
    ds_write_b32 v228, v199 offset:1792
    ds_write_b32 v228, v200 offset:2048
    buffer_load_dwordx4 v[136:139], v229, s[8:11], s58 offen offset:2048 sc1
    v_lshl_add_u32 v54, v55, 2, v48
    v_and_b32 v54, 7, v54
    ds_write_b32 v228, v201 offset:2304
    ds_write_b32 v228, v202 offset:2560
    ds_write_b16 v226, v203 offset:2816
    buffer_load_dwordx4 v[140:143], v229, s[8:11], s58 offen offset:3072 sc1
    s_add_u32 s58, s58, 4096
    v_and_b32 v50, 7, v48
    v_mul_u32_u24 v50, 8224, v50
    ds_write_b32 v228, v204 offset:3072
    ds_write_b32 v228, v205 offset:3328
    ds_write_b32 v228, v206 offset:3584
    buffer_load_dwordx4 v[144:147], v229, s[8:11], s58 offen offset:0 sc1
    v_mul_u32_u24 v51, 1536, v55
    v_add_u32 v50, v50, v51
    ds_write_b32 v228, v207 offset:3840
    ds_write_b32 v228, v208 offset:4096
    ds_write_b16 v226, v209 offset:4352
    buffer_load_dwordx4 v[148:151], v229, s[8:11], s58 offen offset:1024 sc1
    v_add_u32 v222, v50, v52
    v_mul_u32_u24 v51, 8224, v54
    ds_write_b32 v228, v210 offset:4608
    ds_write_b32 v228, v211 offset:4864
    ds_write_b32 v228, v212 offset:5120
    buffer_load_dwordx4 v[152:155], v229, s[8:11], s58 offen offset:2048 sc1
    v_add_u32 v232, v51, v52
    v_lshl_add_u32 v247, v55, 7, v232
    ds_write_b32 v228, v213 offset:5376
    ds_write_b32 v228, v214 offset:5632
    ds_write_b16 v226, v215 offset:5888
    buffer_load_dwordx4 v[156:159], v229, s[8:11], s58 offen offset:3072 sc1
    s_add_u32 s58, s58, 4096
    v_mul_u32_u24 v53, 192, v48
    v_and_b32 v53, 0xc0, v53
    ds_write_b32 v228, v216 offset:6144
    ds_write_b32 v228, v217 offset:6400
    ds_write_b32 v228, v218 offset:6656
    buffer_load_dwordx4 v[160:163], v229, s[8:11], s58 offen offset:0 sc1
    v_add_u32 v53, v53, v52
    v_mul_u32_u24 v51, 2400, v48
    ds_write_b32 v228, v219 offset:6912
    ds_write_b32 v228, v220 offset:7168
    ds_write_b16 v226, v221 offset:7424
    buffer_load_dwordx4 v[164:167], v229, s[8:11], s58 offen offset:1024 sc1
    s_mov_b32 s60, 65536
    v_add3_u32 v223, v51, v53, s60
    buffer_load_dwordx4 v[168:171], v229, s[8:11], s58 offen offset:2048 sc1
    v_mul_u32_u24 v51, 2400, v54
    s_mov_b32 s60, 142336
    buffer_load_dwordx4 v[172:175], v229, s[8:11], s58 offen offset:3072 sc1
    v_add3_u32 v225, v51, v53, s60
    v_lshl_add_u32 v248, v55, 7, v225
    s_lshl_b32 s60, s20, 5
    v_lshl_add_u32 v49, v49, 3, s60
    s_mov_b32 s60, 65536
    v_add3_u32 v255, v51, v49, s60
    v_lshl_add_u32 v246, v55, 9, v255
    v_bfe_u32 v53, v48, 2, 1
    v_lshl_add_u32 v49, v53, 4, v49
    v_add_u32 v254, v50, v49
    s_and_b32 s64, s55, s28
    s_waitcnt lgkmcnt(0)
    s_barrier
    s_cmp_eq_u32 s64, 0
    s_cbranch_scc1 K2_MULTI
    s_setprio 3
    ds_read_b128 v[48:51], v222 offset:0
    ds_read_b128 v[52:55], v222 offset:64
    ds_read_b128 v[56:59], v222 offset:896
    ds_read_b128 v[60:63], v222 offset:960
    ds_read_b128 v[64:67], v223 offset:0
    ds_read_b128 v[68:71], v223 offset:64
    ds_read_b128 v[72:75], v223 offset:896
    ds_read_b128 v[76:79], v223 offset:960
    ds_read_b128 v[80:83], v222 offset:128
    ds_read_b128 v[84:87], v222 offset:384
    ds_read_b128 v[88:91], v222 offset:256
    s_waitcnt vmcnt(19) lgkmcnt(9)
    v_mfma_f32_16x16x32_bf16 v[0:3], v[96:99], v[48:51], 0
    ds_read_b128 v[92:95], v222 offset:192
    s_waitcnt vmcnt(18)
    v_mfma_f32_16x16x32_bf16 v[0:3], v[100:103], v[52:55], v[0:3]
    ds_read_b128 v[48:51], v222 offset:448
    s_waitcnt vmcnt(17) lgkmcnt(9)
    v_mfma_f32_16x16x32_bf16 v[0:3], v[104:107], v[56:59], v[0:3]
    s_bfe_u32 s60, s20, 0x10002
    s_lshl_b32 s60, s60, 4
    ds_read_b128 v[52:55], v222 offset:320
    s_waitcnt vmcnt(16)
    v_mfma_f32_16x16x32_bf16 v[0:3], v[108:111], v[60:63], v[0:3]
    s_add_u32 s59, s59, s60
    v_add_u32 v228, s59, v229
    ds_read_b128 v[56:59], v222 offset:640
    s_waitcnt vmcnt(15) lgkmcnt(9)
    v_mfma_f32_16x16x32_bf16 v[0:3], v[112:115], v[64:67], v[0:3]
    s_mul_i32 s60, s20, 2400
    s_add_u32 s60, s60, 65536
    ds_read_b128 v[60:63], v222 offset:512
    s_waitcnt vmcnt(14)
    v_mfma_f32_16x16x32_bf16 v[0:3], v[116:119], v[68:71], v[0:3]
    v_add_u32 v249, s60, v229
    s_mov_b32 s63, 0xbfb8aa3b
    ds_read_b128 v[64:67], v222 offset:768
    s_waitcnt vmcnt(13) lgkmcnt(9)
    v_mfma_f32_16x16x32_bf16 v[0:3], v[120:123], v[72:75], v[0:3]
    s_add_u32 s40, s20, s21
    s_lshl_b32 s40, s40, 10
    ds_read_b128 v[68:71], v222 offset:704
    s_waitcnt vmcnt(12)
    v_mfma_f32_16x16x32_bf16 v[0:3], v[124:127], v[76:79], v[0:3]
    s_add_u32 s41, s40, 8192
    s_add_u32 s42, s40, 16384
    ds_read_b128 v[72:75], v222 offset:576
    s_waitcnt vmcnt(11) lgkmcnt(9)
    v_mfma_f32_16x16x32_bf16 v[4:7], v[128:131], v[80:83], 0
    s_add_u32 s43, s40, 24576
    s_add_u32 s44, s40, 32768
    ds_read_b128 v[76:79], v222 offset:832
    v_mfma_f32_16x16x32_bf16 v[8:11], v[128:131], v[84:87], 0
    ds_read_b128 v[80:83], v222 offset:1024
    s_waitcnt lgkmcnt(9)
    v_mfma_f32_16x16x32_bf16 v[12:15], v[128:131], v[88:91], 0
    ds_read_b128 v[84:87], v222 offset:1280
    s_waitcnt vmcnt(10)
    v_mfma_f32_16x16x32_bf16 v[4:7], v[132:135], v[92:95], v[4:7]
    ds_read_b128 v[88:91], v222 offset:1152
    s_waitcnt lgkmcnt(9)
    v_mfma_f32_16x16x32_bf16 v[8:11], v[132:135], v[48:51], v[8:11]
    v_mul_f32 v204, s63, v0
    ds_read_b128 v[92:95], v222 offset:1088
    v_mfma_f32_16x16x32_bf16 v[12:15], v[132:135], v[52:55], v[12:15]
    v_mul_f32 v205, s63, v1
    s_setprio 2
    ds_read_b128 v[48:51], v222 offset:1344
    s_waitcnt vmcnt(9) lgkmcnt(9)
    v_mfma_f32_16x16x32_bf16 v[4:7], v[136:139], v[56:59], v[4:7]
    ds_read_b128 v[52:55], v222 offset:1216
    v_mfma_f32_16x16x32_bf16 v[8:11], v[136:139], v[60:63], v[8:11]
    v_mul_f32 v206, s63, v2
    ds_read_b128 v[56:59], v223 offset:128
    s_waitcnt lgkmcnt(9)
    v_mfma_f32_16x16x32_bf16 v[12:15], v[136:139], v[64:67], v[12:15]
    v_mul_f32 v207, s63, v3
    ds_read_b128 v[60:63], v223 offset:384
    s_waitcnt vmcnt(8)
    v_mfma_f32_16x16x32_bf16 v[4:7], v[140:143], v[68:71], v[4:7]
    ds_read_b128 v[64:67], v223 offset:256
    s_waitcnt lgkmcnt(9)
    v_mfma_f32_16x16x32_bf16 v[8:11], v[140:143], v[72:75], v[8:11]
    v_exp_f32 v204, v204
    ds_read_b128 v[68:71], v223 offset:192
    v_mfma_f32_16x16x32_bf16 v[12:15], v[140:143], v[76:79], v[12:15]
    ds_read_b128 v[72:75], v223 offset:448
    s_waitcnt vmcnt(7) lgkmcnt(9)
    v_mfma_f32_16x16x32_bf16 v[4:7], v[144:147], v[80:83], v[4:7]
    v_exp_f32 v205, v205
    ds_read_b128 v[76:79], v223 offset:320
    v_mfma_f32_16x16x32_bf16 v[8:11], v[144:147], v[84:87], v[8:11]
    v_exp_f32 v206, v206
    ds_read_b128 v[80:83], v223 offset:640
    s_waitcnt lgkmcnt(9)
    v_mfma_f32_16x16x32_bf16 v[12:15], v[144:147], v[88:91], v[12:15]
    ds_read_b128 v[84:87], v223 offset:512
    s_waitcnt vmcnt(6)
    v_mfma_f32_16x16x32_bf16 v[4:7], v[148:151], v[92:95], v[4:7]
    v_exp_f32 v207, v207
    ds_read_b128 v[88:91], v223 offset:768
    s_waitcnt lgkmcnt(9)
    v_mfma_f32_16x16x32_bf16 v[8:11], v[148:151], v[48:51], v[8:11]
    v_add_f32 v204, 1.0, v204
    ds_read_b128 v[92:95], v223 offset:704
    v_mfma_f32_16x16x32_bf16 v[12:15], v[148:151], v[52:55], v[12:15]
    ds_read_b128 v[48:51], v223 offset:576
    s_waitcnt vmcnt(5) lgkmcnt(9)
    v_mfma_f32_16x16x32_bf16 v[4:7], v[152:155], v[56:59], v[4:7]
    v_add_f32 v205, 1.0, v205
    ds_read_b128 v[52:55], v223 offset:832
    v_mfma_f32_16x16x32_bf16 v[8:11], v[152:155], v[60:63], v[8:11]
    s_setprio 1
    ds_read_b128 v[56:59], v223 offset:1024
    s_waitcnt lgkmcnt(9)
    v_mfma_f32_16x16x32_bf16 v[12:15], v[152:155], v[64:67], v[12:15]
    v_add_f32 v206, 1.0, v206
    ds_read_b128 v[60:63], v223 offset:1280
    s_waitcnt vmcnt(4)
    v_mfma_f32_16x16x32_bf16 v[4:7], v[156:159], v[68:71], v[4:7]
    v_add_f32 v207, 1.0, v207
    ds_read_b128 v[64:67], v223 offset:1152
    s_waitcnt lgkmcnt(9)
    v_mfma_f32_16x16x32_bf16 v[8:11], v[156:159], v[72:75], v[8:11]
    ds_read_b128 v[68:71], v223 offset:1088
    v_mfma_f32_16x16x32_bf16 v[12:15], v[156:159], v[76:79], v[12:15]
    v_rcp_f32 v204, v204
    ds_read_b128 v[72:75], v223 offset:1344
    s_waitcnt vmcnt(3) lgkmcnt(9)
    v_mfma_f32_16x16x32_bf16 v[4:7], v[160:163], v[80:83], v[4:7]
    v_rcp_f32 v205, v205
    ds_read_b128 v[76:79], v223 offset:1216
    v_mfma_f32_16x16x32_bf16 v[8:11], v[160:163], v[84:87], v[8:11]
    ds_read_b128 v[80:83], v222 offset:3072
    s_waitcnt lgkmcnt(9)
    v_mfma_f32_16x16x32_bf16 v[12:15], v[160:163], v[88:91], v[12:15]
    v_rcp_f32 v206, v206
    ds_read_b128 v[84:87], v222 offset:3136
    s_waitcnt vmcnt(2)
    v_mfma_f32_16x16x32_bf16 v[4:7], v[164:167], v[92:95], v[4:7]
    ds_read_b128 v[88:91], v222 offset:3968
    s_waitcnt lgkmcnt(9)
    v_mfma_f32_16x16x32_bf16 v[8:11], v[164:167], v[48:51], v[8:11]
    v_rcp_f32 v207, v207
    ds_read_b128 v[92:95], v222 offset:4032
    v_mfma_f32_16x16x32_bf16 v[12:15], v[164:167], v[52:55], v[12:15]
    v_cvt_pk_bf16_f32 v176, v0, v1
    ds_read_b128 v[48:51], v223 offset:38400
    s_waitcnt vmcnt(1) lgkmcnt(9)
    v_mfma_f32_16x16x32_bf16 v[4:7], v[168:171], v[56:59], v[4:7]
    ds_read_b128 v[52:55], v223 offset:38464
    v_mfma_f32_16x16x32_bf16 v[8:11], v[168:171], v[60:63], v[8:11]
    v_cvt_pk_bf16_f32 v177, v2, v3
    s_setprio 0
    ds_read_b128 v[56:59], v223 offset:39296
    s_waitcnt lgkmcnt(9)
    v_mfma_f32_16x16x32_bf16 v[12:15], v[168:171], v[64:67], v[12:15]
    ds_read_b128 v[60:63], v223 offset:39360
    s_waitcnt vmcnt(0)
    v_mfma_f32_16x16x32_bf16 v[4:7], v[172:175], v[68:71], v[4:7]
K2_PAD_T2:
    s_cbranch_execz K2_HOP
    ds_read_b128 v[64:67], v222 offset:3200
    s_waitcnt lgkmcnt(9)
    v_mfma_f32_16x16x32_bf16 v[8:11], v[172:175], v[72:75], v[8:11]
    ds_read_b128 v[68:71], v222 offset:3456
    v_mfma_f32_16x16x32_bf16 v[12:15], v[172:175], v[76:79], v[12:15]
    ds_read_b128 v[72:75], v222 offset:3328
    s_waitcnt lgkmcnt(9)
    v_mfma_f32_16x16x32_bf16 v[16:19], v[96:99], v[80:83], 0
    ds_read_b128 v[76:79], v222 offset:3264
    v_mfma_f32_16x16x32_bf16 v[16:19], v[100:103], v[84:87], v[16:19]
    ds_read_b128 v[80:83], v222 offset:3520
    s_waitcnt lgkmcnt(9)
    v_mfma_f32_16x16x32_bf16 v[16:19], v[104:107], v[88:91], v[16:19]
    s_barrier
    s_setprio 3
    ds_read_b128 v[84:87], v222 offset:3392
    v_mfma_f32_16x16x32_bf16 v[16:19], v[108:111], v[92:95], v[16:19]
    v_mul_f32 v4, v4, v204
    ds_read_b128 v[88:91], v222 offset:3712
    s_waitcnt lgkmcnt(9)
    v_mfma_f32_16x16x32_bf16 v[16:19], v[112:115], v[48:51], v[16:19]
    v_mul_f32 v5, v5, v205
    ds_read_b128 v[92:95], v222 offset:3584
    v_mfma_f32_16x16x32_bf16 v[16:19], v[116:119], v[52:55], v[16:19]
    v_mul_f32 v6, v6, v206
    ds_read_b128 v[48:51], v222 offset:3840
    s_waitcnt lgkmcnt(9)
    v_mfma_f32_16x16x32_bf16 v[16:19], v[120:123], v[56:59], v[16:19]
    v_mul_f32 v7, v7, v207
    ds_read_b128 v[52:55], v222 offset:3776
    v_mfma_f32_16x16x32_bf16 v[16:19], v[124:127], v[60:63], v[16:19]
    v_cvt_pk_bf16_f32 v178, v4, v5
    ds_read_b128 v[56:59], v222 offset:3648
    s_waitcnt lgkmcnt(9)
    v_mfma_f32_16x16x32_bf16 v[20:23], v[128:131], v[64:67], 0
    v_cvt_pk_bf16_f32 v179, v6, v7
    ds_read_b128 v[60:63], v222 offset:3904
    v_mfma_f32_16x16x32_bf16 v[24:27], v[128:131], v[68:71], 0
    v_mul_f32 v8, v8, v204
    ds_read_b128 v[64:67], v222 offset:4096
    s_waitcnt lgkmcnt(9)
    v_mfma_f32_16x16x32_bf16 v[28:31], v[128:131], v[72:75], 0
    v_mul_f32 v9, v9, v205
    ds_read_b128 v[68:71], v222 offset:4352
    v_mfma_f32_16x16x32_bf16 v[20:23], v[132:135], v[76:79], v[20:23]
    v_mul_f32 v10, v10, v206
    ds_read_b128 v[72:75], v222 offset:4224
    s_waitcnt lgkmcnt(9)
    v_mfma_f32_16x16x32_bf16 v[24:27], v[132:135], v[80:83], v[24:27]
    v_mul_f32 v11, v11, v207
    ds_read_b128 v[76:79], v222 offset:4160
    v_mfma_f32_16x16x32_bf16 v[28:31], v[132:135], v[84:87], v[28:31]
    v_cvt_pk_bf16_f32 v180, v8, v9
    ds_read_b128 v[80:83], v222 offset:4416
    s_waitcnt lgkmcnt(9)
    v_mfma_f32_16x16x32_bf16 v[20:23], v[136:139], v[88:91], v[20:23]
    v_cvt_pk_bf16_f32 v181, v10, v11
    ds_read_b128 v[84:87], v222 offset:4288
    v_mfma_f32_16x16x32_bf16 v[24:27], v[136:139], v[92:95], v[24:27]
    v_mul_f32 v12, v12, v204
    s_setprio 2
    ds_read_b128 v[88:91], v223 offset:38528
    s_waitcnt lgkmcnt(9)
    v_mfma_f32_16x16x32_bf16 v[28:31], v[136:139], v[48:51], v[28:31]
    v_mul_f32 v13, v13, v205
    ds_read_b128 v[92:95], v223 offset:38784
    v_mfma_f32_16x16x32_bf16 v[20:23], v[140:143], v[52:55], v[20:23]
    v_mul_f32 v14, v14, v206
    ds_read_b128 v[48:51], v223 offset:38656
    s_waitcnt lgkmcnt(9)
    v_mfma_f32_16x16x32_bf16 v[24:27], v[140:143], v[56:59], v[24:27]
    v_mul_f32 v15, v15, v207
    ds_read_b128 v[52:55], v223 offset:38592
    v_mfma_f32_16x16x32_bf16 v[28:31], v[140:143], v[60:63], v[28:31]
    v_cvt_pk_bf16_f32 v182, v12, v13
    ds_read_b128 v[56:59], v223 offset:38848
    s_waitcnt lgkmcnt(9)
    v_mfma_f32_16x16x32_bf16 v[20:23], v[144:147], v[64:67], v[20:23]
    v_cvt_pk_bf16_f32 v183, v14, v15
    ds_read_b128 v[60:63], v223 offset:38720
    v_mfma_f32_16x16x32_bf16 v[24:27], v[144:147], v[68:71], v[24:27]
    ds_write_b64 v254, v[176:177] offset:0
    ds_write_b64 v254, v[178:179] offset:256
    ds_write_b64 v254, v[180:181] offset:512
    ds_write_b64 v254, v[182:183] offset:768
    ds_read_b128 v[64:67], v223 offset:39040
    s_waitcnt lgkmcnt(13)
    v_mfma_f32_16x16x32_bf16 v[28:31], v[144:147], v[72:75], v[28:31]
    v_mul_f32 v208, s63, v16
    ds_read_b128 v[68:71], v223 offset:38912
    v_mfma_f32_16x16x32_bf16 v[20:23], v[148:151], v[76:79], v[20:23]
    v_mul_f32 v209, s63, v17
    ds_read_b128 v[72:75], v223 offset:39168
    s_waitcnt lgkmcnt(13)
    v_mfma_f32_16x16x32_bf16 v[24:27], v[148:151], v[80:83], v[24:27]
    v_mul_f32 v210, s63, v18
    ds_read_b128 v[76:79], v223 offset:39104
    v_mfma_f32_16x16x32_bf16 v[28:31], v[148:151], v[84:87], v[28:31]
    v_mul_f32 v211, s63, v19
    ds_read_b128 v[80:83], v223 offset:38976
    s_waitcnt lgkmcnt(13)
    v_mfma_f32_16x16x32_bf16 v[20:23], v[152:155], v[88:91], v[20:23]
    v_exp_f32 v208, v208
    ds_read_b128 v[84:87], v223 offset:39232
    v_mfma_f32_16x16x32_bf16 v[24:27], v[152:155], v[92:95], v[24:27]
    v_exp_f32 v209, v209
    ds_read_b128 v[88:91], v223 offset:39424
    s_waitcnt lgkmcnt(13)
    v_mfma_f32_16x16x32_bf16 v[28:31], v[152:155], v[48:51], v[28:31]
    s_setprio 1
    ds_read_b128 v[92:95], v223 offset:39680
    v_mfma_f32_16x16x32_bf16 v[20:23], v[156:159], v[52:55], v[20:23]
    v_exp_f32 v210, v210
    ds_read_b128 v[48:51], v223 offset:39552
    s_waitcnt lgkmcnt(13)
    v_mfma_f32_16x16x32_bf16 v[24:27], v[156:159], v[56:59], v[24:27]
    v_exp_f32 v211, v211
    ds_read_b128 v[52:55], v223 offset:39488
    v_mfma_f32_16x16x32_bf16 v[28:31], v[156:159], v[60:63], v[28:31]
    v_add_f32 v208, 1.0, v208
    ds_read_b128 v[56:59], v223 offset:39744
    s_waitcnt lgkmcnt(9)
    v_mfma_f32_16x16x32_bf16 v[20:23], v[160:163], v[64:67], v[20:23]
    v_add_f32 v209, 1.0, v209
    ds_read_b128 v[60:63], v223 offset:39616
    v_mfma_f32_16x16x32_bf16 v[24:27], v[160:163], v[68:71], v[24:27]
    v_add_f32 v210, 1.0, v210
    ds_read_b128 v[64:67], v232 offset:6144
    s_waitcnt lgkmcnt(9)
    v_mfma_f32_16x16x32_bf16 v[28:31], v[160:163], v[72:75], v[28:31]
    v_add_f32 v211, 1.0, v211
    ds_read_b128 v[68:71], v232 offset:6208
    v_mfma_f32_16x16x32_bf16 v[20:23], v[164:167], v[76:79], v[20:23]
    ds_read_b128 v[72:75], v232 offset:7040
    s_waitcnt lgkmcnt(9)
    v_mfma_f32_16x16x32_bf16 v[24:27], v[164:167], v[80:83], v[24:27]
    v_rcp_f32 v208, v208
    ds_read_b128 v[76:79], v232 offset:7104
    v_mfma_f32_16x16x32_bf16 v[28:31], v[164:167], v[84:87], v[28:31]
    v_rcp_f32 v209, v209
    ds_read_b128 v[80:83], v225 offset:0
    s_waitcnt lgkmcnt(9)
    v_mfma_f32_16x16x32_bf16 v[20:23], v[168:171], v[88:91], v[20:23]
    v_rcp_f32 v210, v210
    ds_read_b128 v[84:87], v225 offset:64
    v_mfma_f32_16x16x32_bf16 v[24:27], v[168:171], v[92:95], v[24:27]
    v_rcp_f32 v211, v211
    ds_read_b128 v[88:91], v225 offset:896
    s_waitcnt lgkmcnt(9)
    v_mfma_f32_16x16x32_bf16 v[28:31], v[168:171], v[48:51], v[28:31]
    v_cvt_pk_bf16_f32 v184, v16, v17
    s_setprio 0
    ds_read_b128 v[92:95], v225 offset:960
    v_mfma_f32_16x16x32_bf16 v[20:23], v[172:175], v[52:55], v[20:23]
    v_cvt_pk_bf16_f32 v185, v18, v19
    ds_read_b128 v[48:51], v247 offset:6272
    s_waitcnt lgkmcnt(9)
    v_mfma_f32_16x16x32_bf16 v[24:27], v[172:175], v[56:59], v[24:27]
    ds_read_b128 v[52:55], v232 offset:6528
    v_mfma_f32_16x16x32_bf16 v[28:31], v[172:175], v[60:63], v[28:31]
    ds_read_b128 v[56:59], v247 offset:6336
    s_waitcnt lgkmcnt(9)
    v_mfma_f32_16x16x32_bf16 v[32:35], v[96:99], v[64:67], 0
    ds_read_b128 v[60:63], v232 offset:6592
    v_mfma_f32_16x16x32_bf16 v[32:35], v[100:103], v[68:71], v[32:35]
    ds_read_b128 v[64:67], v247 offset:6784
    s_waitcnt lgkmcnt(9)
    v_mfma_f32_16x16x32_bf16 v[32:35], v[104:107], v[72:75], v[32:35]
    s_barrier
    ds_read_b128 v[192:195], v228 offset:0
    ds_read_b128 v[196:199], v228 offset:1536
    s_setprio 3
    ds_read_b128 v[68:71], v232 offset:6656
    v_mfma_f32_16x16x32_bf16 v[32:35], v[108:111], v[76:79], v[32:35]
    v_mul_f32 v20, v20, v208
    ds_read_b128 v[72:75], v247 offset:6848
    s_waitcnt lgkmcnt(11)
    v_mfma_f32_16x16x32_bf16 v[32:35], v[112:115], v[80:83], v[32:35]
    v_mul_f32 v21, v21, v209
    ds_read_b128 v[76:79], v232 offset:6720
    v_mfma_f32_16x16x32_bf16 v[32:35], v[116:119], v[84:87], v[32:35]
    v_mul_f32 v22, v22, v210
    ds_read_b128 v[80:83], v247 offset:7168
    s_waitcnt lgkmcnt(11)
    v_mfma_f32_16x16x32_bf16 v[32:35], v[120:123], v[88:91], v[32:35]
    v_mul_f32 v23, v23, v211
    ds_read_b128 v[84:87], v232 offset:7424
    v_mfma_f32_16x16x32_bf16 v[32:35], v[124:127], v[92:95], v[32:35]
    v_cvt_pk_bf16_f32 v186, v20, v21
    ds_read_b128 v[88:91], v247 offset:7232
    s_waitcnt lgkmcnt(11)
    v_mfma_f32_16x16x32_bf16 v[36:39], v[128:131], v[48:51], 0
    v_cvt_pk_bf16_f32 v187, v22, v23
    ds_read_b128 v[92:95], v232 offset:7488
    v_mfma_f32_16x16x32_bf16 v[40:43], v[128:131], v[52:55], 0
    v_mul_f32 v24, v24, v208
    ds_read_b128 v[48:51], v248 offset:128
    s_waitcnt lgkmcnt(11)
    v_mfma_f32_16x16x32_bf16 v[36:39], v[132:135], v[56:59], v[36:39]
    v_mul_f32 v25, v25, v209
    s_waitcnt lgkmcnt(8)
    buffer_store_dwordx4 v[192:195], v229, s[12:15], s40 offen sc1
    buffer_store_dwordx4 v[196:199], v229, s[12:15], s41 offen sc1
    ds_read_b128 v[52:55], v225 offset:384
    v_mfma_f32_16x16x32_bf16 v[40:43], v[132:135], v[60:63], v[40:43]
    v_mul_f32 v26, v26, v210
    s_setprio 2
    ds_read_b128 v[56:59], v248 offset:192
    s_waitcnt lgkmcnt(9)
    v_mfma_f32_16x16x32_bf16 v[36:39], v[136:139], v[64:67], v[36:39]
    v_mul_f32 v27, v27, v211
    v_mul_f32 v204, s63, v32
    ds_read_b128 v[60:63], v225 offset:448
    v_mfma_f32_16x16x32_bf16 v[40:43], v[136:139], v[68:71], v[40:43]
    v_cvt_pk_bf16_f32 v188, v24, v25
    v_mul_f32 v205, s63, v33
    ds_read_b128 v[64:67], v248 offset:640
    s_waitcnt lgkmcnt(9)
    v_mfma_f32_16x16x32_bf16 v[36:39], v[140:143], v[72:75], v[36:39]
    v_cvt_pk_bf16_f32 v189, v26, v27
    v_mul_f32 v206, s63, v34
    ds_read_b128 v[68:71], v225 offset:512
    v_mfma_f32_16x16x32_bf16 v[40:43], v[140:143], v[76:79], v[40:43]
    v_mul_f32 v28, v28, v208
    v_mul_f32 v207, s63, v35
    ds_read_b128 v[72:75], v248 offset:704
    s_waitcnt lgkmcnt(9)
    v_mfma_f32_16x16x32_bf16 v[36:39], v[144:147], v[80:83], v[36:39]
    v_mul_f32 v29, v29, v209
    v_exp_f32 v204, v204
    ds_read_b128 v[76:79], v225 offset:576
    v_mfma_f32_16x16x32_bf16 v[40:43], v[144:147], v[84:87], v[40:43]
    v_mul_f32 v30, v30, v210
    v_exp_f32 v205, v205
    ds_read_b128 v[80:83], v248 offset:1024
    s_waitcnt lgkmcnt(9)
    v_mfma_f32_16x16x32_bf16 v[36:39], v[148:151], v[88:91], v[36:39]
    v_mul_f32 v31, v31, v211
    v_exp_f32 v206, v206
    ds_read_b128 v[84:87], v225 offset:1280
    v_mfma_f32_16x16x32_bf16 v[40:43], v[148:151], v[92:95], v[40:43]
    v_cvt_pk_bf16_f32 v190, v28, v29
    v_exp_f32 v207, v207
    ds_read_b128 v[88:91], v248 offset:1088
    s_waitcnt lgkmcnt(9)
    v_mfma_f32_16x16x32_bf16 v[36:39], v[152:155], v[48:51], v[36:39]
    v_cvt_pk_bf16_f32 v191, v30, v31
    v_add_f32 v204, 1.0, v204
    s_setprio 1
    ds_read_b128 v[92:95], v225 offset:1344
    v_mfma_f32_16x16x32_bf16 v[40:43], v[152:155], v[52:55], v[40:43]
    ds_write_b64 v254, v[184:185] offset:3072
    ds_write_b64 v254, v[186:187] offset:3328
    ds_write_b64 v254, v[188:189] offset:3584
    ds_write_b64 v254, v[190:191] offset:3840
    v_add_f32 v205, 1.0, v205
    s_waitcnt lgkmcnt(12)
    v_mfma_f32_16x16x32_bf16 v[36:39], v[156:159], v[56:59], v[36:39]
    v_add_f32 v206, 1.0, v206
    v_mfma_f32_16x16x32_bf16 v[40:43], v[156:159], v[60:63], v[40:43]
    v_add_f32 v207, 1.0, v207
    s_waitcnt lgkmcnt(10)
    v_mfma_f32_16x16x32_bf16 v[36:39], v[160:163], v[64:67], v[36:39]
    v_rcp_f32 v204, v204
    v_mfma_f32_16x16x32_bf16 v[40:43], v[160:163], v[68:71], v[40:43]
    v_rcp_f32 v205, v205
    s_waitcnt lgkmcnt(8)
    v_mfma_f32_16x16x32_bf16 v[36:39], v[164:167], v[72:75], v[36:39]
    v_rcp_f32 v206, v206
    v_mfma_f32_16x16x32_bf16 v[40:43], v[164:167], v[76:79], v[40:43]
    v_rcp_f32 v207, v207
    s_waitcnt lgkmcnt(6)
    v_mfma_f32_16x16x32_bf16 v[36:39], v[168:171], v[80:83], v[36:39]
    v_cvt_pk_bf16_f32 v176, v32, v33
    s_setprio 0
    v_mfma_f32_16x16x32_bf16 v[40:43], v[168:171], v[84:87], v[40:43]
    v_cvt_pk_bf16_f32 v177, v34, v35
    s_waitcnt lgkmcnt(4)
    v_mfma_f32_16x16x32_bf16 v[36:39], v[172:175], v[88:91], v[36:39]
    ds_write_b64 v255, v[176:177] offset:0
    v_mfma_f32_16x16x32_bf16 v[40:43], v[172:175], v[92:95], v[40:43]
    s_nop 5
    v_mul_f32 v36, v36, v204
    v_mul_f32 v37, v37, v205
    v_mul_f32 v38, v38, v206
    v_mul_f32 v39, v39, v207
    v_cvt_pk_bf16_f32 v178, v36, v37
    v_cvt_pk_bf16_f32 v179, v38, v39
    v_mul_f32 v40, v40, v204
    v_mul_f32 v41, v41, v205
    v_mul_f32 v42, v42, v206
    v_mul_f32 v43, v43, v207
    v_cvt_pk_bf16_f32 v180, v40, v41
    v_cvt_pk_bf16_f32 v181, v42, v43
    ds_write_b64 v246, v[178:179] offset:256
    ds_write_b64 v255, v[180:181] offset:512
    s_waitcnt lgkmcnt(0)
    s_barrier
    ds_read_b128 v[192:195], v228 offset:3072
    ds_read_b128 v[196:199], v228 offset:4608
    ds_read_b128 v[200:203], v249
    s_waitcnt lgkmcnt(1)
    buffer_store_dwordx4 v[192:195], v229, s[12:15], s42 offen sc1
    buffer_store_dwordx4 v[196:199], v229, s[12:15], s43 offen sc1
K2_LASTROW:
    s_add_u32 s59, s20, 32
    s_cmp_ge_u32 s59, s22
    s_cbranch_scc1 K2_FIN
    s_waitcnt lgkmcnt(0)
    buffer_store_dwordx4 v[200:203], v229, s[12:15], s44 offen sc1
K2_FIN:
    s_endpgm
K2_MULTI:
    ds_read_b128 v[48:51], v222 offset:0
    ds_read_b128 v[52:55], v222 offset:64
    ds_read_b128 v[56:59], v222 offset:896
    ds_read_b128 v[60:63], v222 offset:960
    ds_read_b128 v[64:67], v223 offset:0
    ds_read_b128 v[68:71], v223 offset:64
    ds_read_b128 v[72:75], v223 offset:896
    ds_read_b128 v[76:79], v223 offset:960
    ds_read_b128 v[80:83], v222 offset:128
    ds_read_b128 v[84:87], v222 offset:384
    ds_read_b128 v[88:91], v222 offset:256
    s_waitcnt vmcnt(19) lgkmcnt(9)
    v_mfma_f32_16x16x32_bf16 v[0:3], v[96:99], v[48:51], 0
    ds_read_b128 v[92:95], v222 offset:192
    s_waitcnt vmcnt(18)
    v_mfma_f32_16x16x32_bf16 v[0:3], v[100:103], v[52:55], v[0:3]
    ds_read_b128 v[48:51], v222 offset:448
    s_waitcnt vmcnt(17) lgkmcnt(9)
    v_mfma_f32_16x16x32_bf16 v[0:3], v[104:107], v[56:59], v[0:3]
    ds_read_b128 v[52:55], v222 offset:320
    s_waitcnt vmcnt(16)
    v_mfma_f32_16x16x32_bf16 v[0:3], v[108:111], v[60:63], v[0:3]
    ds_read_b128 v[56:59], v222 offset:640
    s_waitcnt vmcnt(15) lgkmcnt(9)
    v_mfma_f32_16x16x32_bf16 v[0:3], v[112:115], v[64:67], v[0:3]
    ds_read_b128 v[60:63], v222 offset:512
    s_waitcnt vmcnt(14)
    v_mfma_f32_16x16x32_bf16 v[0:3], v[116:119], v[68:71], v[0:3]
    ds_read_b128 v[64:67], v222 offset:768
    s_waitcnt vmcnt(13) lgkmcnt(9)
    v_mfma_f32_16x16x32_bf16 v[0:3], v[120:123], v[72:75], v[0:3]
    ds_read_b128 v[68:71], v222 offset:704
    s_waitcnt vmcnt(12)
    v_mfma_f32_16x16x32_bf16 v[0:3], v[124:127], v[76:79], v[0:3]
    ds_read_b128 v[72:75], v222 offset:576
    s_waitcnt vmcnt(11) lgkmcnt(9)
    v_mfma_f32_16x16x32_bf16 v[4:7], v[128:131], v[80:83], 0
    ds_read_b128 v[76:79], v222 offset:832
    v_mfma_f32_16x16x32_bf16 v[8:11], v[128:131], v[84:87], 0
    ds_read_b128 v[80:83], v222 offset:1024
    s_waitcnt lgkmcnt(9)
    v_mfma_f32_16x16x32_bf16 v[12:15], v[128:131], v[88:91], 0
    ds_read_b128 v[84:87], v222 offset:1280
    s_waitcnt vmcnt(10)
    v_mfma_f32_16x16x32_bf16 v[4:7], v[132:135], v[92:95], v[4:7]
    ds_read_b128 v[88:91], v222 offset:1152
    s_waitcnt lgkmcnt(9)
    v_mfma_f32_16x16x32_bf16 v[8:11], v[132:135], v[48:51], v[8:11]
    ds_read_b128 v[92:95], v222 offset:1088
    v_mfma_f32_16x16x32_bf16 v[12:15], v[132:135], v[52:55], v[12:15]
    ds_read_b128 v[48:51], v222 offset:1344
    s_waitcnt vmcnt(9) lgkmcnt(9)
    v_mfma_f32_16x16x32_bf16 v[4:7], v[136:139], v[56:59], v[4:7]
    ds_read_b128 v[52:55], v222 offset:1216
    v_mfma_f32_16x16x32_bf16 v[8:11], v[136:139], v[60:63], v[8:11]
    ds_read_b128 v[56:59], v223 offset:128
    s_waitcnt lgkmcnt(9)
    v_mfma_f32_16x16x32_bf16 v[12:15], v[136:139], v[64:67], v[12:15]
    ds_read_b128 v[60:63], v223 offset:384
    s_waitcnt vmcnt(8)
    v_mfma_f32_16x16x32_bf16 v[4:7], v[140:143], v[68:71], v[4:7]
    ds_read_b128 v[64:67], v223 offset:256
    s_waitcnt lgkmcnt(9)
    v_mfma_f32_16x16x32_bf16 v[8:11], v[140:143], v[72:75], v[8:11]
    ds_read_b128 v[68:71], v223 offset:192
    v_mfma_f32_16x16x32_bf16 v[12:15], v[140:143], v[76:79], v[12:15]
    ds_read_b128 v[72:75], v223 offset:448
    s_waitcnt vmcnt(7) lgkmcnt(9)
    v_mfma_f32_16x16x32_bf16 v[4:7], v[144:147], v[80:83], v[4:7]
    ds_read_b128 v[76:79], v223 offset:320
    v_mfma_f32_16x16x32_bf16 v[8:11], v[144:147], v[84:87], v[8:11]
    ds_read_b128 v[80:83], v223 offset:640
    s_waitcnt lgkmcnt(9)
    v_mfma_f32_16x16x32_bf16 v[12:15], v[144:147], v[88:91], v[12:15]
    ds_read_b128 v[84:87], v223 offset:512
    s_waitcnt vmcnt(6)
    v_mfma_f32_16x16x32_bf16 v[4:7], v[148:151], v[92:95], v[4:7]
    ds_read_b128 v[88:91], v223 offset:768
    s_waitcnt lgkmcnt(9)
    v_mfma_f32_16x16x32_bf16 v[8:11], v[148:151], v[48:51], v[8:11]
    ds_read_b128 v[92:95], v223 offset:704
    v_mfma_f32_16x16x32_bf16 v[12:15], v[148:151], v[52:55], v[12:15]
    ds_read_b128 v[48:51], v223 offset:576
    s_waitcnt vmcnt(5) lgkmcnt(9)
    v_mfma_f32_16x16x32_bf16 v[4:7], v[152:155], v[56:59], v[4:7]
    ds_read_b128 v[52:55], v223 offset:832
    v_mfma_f32_16x16x32_bf16 v[8:11], v[152:155], v[60:63], v[8:11]
    ds_read_b128 v[56:59], v223 offset:1024
    s_waitcnt lgkmcnt(9)
    v_mfma_f32_16x16x32_bf16 v[12:15], v[152:155], v[64:67], v[12:15]
    ds_read_b128 v[60:63], v223 offset:1280
    s_waitcnt vmcnt(4)
    v_mfma_f32_16x16x32_bf16 v[4:7], v[156:159], v[68:71], v[4:7]
    ds_read_b128 v[64:67], v223 offset:1152
    s_waitcnt lgkmcnt(9)
    v_mfma_f32_16x16x32_bf16 v[8:11], v[156:159], v[72:75], v[8:11]
    ds_read_b128 v[68:71], v223 offset:1088
    v_mfma_f32_16x16x32_bf16 v[12:15], v[156:159], v[76:79], v[12:15]
    ds_read_b128 v[72:75], v223 offset:1344
    s_waitcnt vmcnt(3) lgkmcnt(9)
    v_mfma_f32_16x16x32_bf16 v[4:7], v[160:163], v[80:83], v[4:7]
    ds_read_b128 v[76:79], v223 offset:1216
    v_mfma_f32_16x16x32_bf16 v[8:11], v[160:163], v[84:87], v[8:11]
    ds_read_b128 v[80:83], v222 offset:3072
    s_waitcnt lgkmcnt(9)
    v_mfma_f32_16x16x32_bf16 v[12:15], v[160:163], v[88:91], v[12:15]
    ds_read_b128 v[84:87], v222 offset:3136
    s_waitcnt vmcnt(2)
    v_mfma_f32_16x16x32_bf16 v[4:7], v[164:167], v[92:95], v[4:7]
    ds_read_b128 v[88:91], v222 offset:3968
    s_waitcnt lgkmcnt(9)
    v_mfma_f32_16x16x32_bf16 v[8:11], v[164:167], v[48:51], v[8:11]
    ds_read_b128 v[92:95], v222 offset:4032
    v_mfma_f32_16x16x32_bf16 v[12:15], v[164:167], v[52:55], v[12:15]
    ds_read_b128 v[48:51], v223 offset:38400
    s_waitcnt vmcnt(1) lgkmcnt(9)
    v_mfma_f32_16x16x32_bf16 v[4:7], v[168:171], v[56:59], v[4:7]
    ds_read_b128 v[52:55], v223 offset:38464
    v_mfma_f32_16x16x32_bf16 v[8:11], v[168:171], v[60:63], v[8:11]
    ds_read_b128 v[56:59], v223 offset:39296
    s_waitcnt lgkmcnt(9)
    v_mfma_f32_16x16x32_bf16 v[12:15], v[168:171], v[64:67], v[12:15]
    ds_read_b128 v[60:63], v223 offset:39360
    s_waitcnt vmcnt(0)
    v_mfma_f32_16x16x32_bf16 v[4:7], v[172:175], v[68:71], v[4:7]
    ds_read_b128 v[64:67], v222 offset:3200
    s_waitcnt lgkmcnt(9)
    v_mfma_f32_16x16x32_bf16 v[8:11], v[172:175], v[72:75], v[8:11]
    ds_read_b128 v[68:71], v222 offset:3456
    v_mfma_f32_16x16x32_bf16 v[12:15], v[172:175], v[76:79], v[12:15]
    ds_read_b128 v[72:75], v222 offset:3328
    s_waitcnt lgkmcnt(9)
    v_mfma_f32_16x16x32_bf16 v[16:19], v[96:99], v[80:83], 0
    ds_read_b128 v[76:79], v222 offset:3264
    v_mfma_f32_16x16x32_bf16 v[16:19], v[100:103], v[84:87], v[16:19]
    ds_read_b128 v[80:83], v222 offset:3520
    s_waitcnt lgkmcnt(9)
    v_mfma_f32_16x16x32_bf16 v[16:19], v[104:107], v[88:91], v[16:19]
    ds_read_b128 v[84:87], v222 offset:3392
    v_mfma_f32_16x16x32_bf16 v[16:19], v[108:111], v[92:95], v[16:19]
    ds_read_b128 v[88:91], v222 offset:3712
    s_waitcnt lgkmcnt(9)
    v_mfma_f32_16x16x32_bf16 v[16:19], v[112:115], v[48:51], v[16:19]
    ds_read_b128 v[92:95], v222 offset:3584
    v_mfma_f32_16x16x32_bf16 v[16:19], v[116:119], v[52:55], v[16:19]
    ds_read_b128 v[48:51], v222 offset:3840
    s_waitcnt lgkmcnt(9)
    v_mfma_f32_16x16x32_bf16 v[16:19], v[120:123], v[56:59], v[16:19]
    ds_read_b128 v[52:55], v222 offset:3776
    v_mfma_f32_16x16x32_bf16 v[16:19], v[124:127], v[60:63], v[16:19]
    ds_read_b128 v[56:59], v222 offset:3648
    s_waitcnt lgkmcnt(9)
    v_mfma_f32_16x16x32_bf16 v[20:23], v[128:131], v[64:67], 0
    ds_read_b128 v[60:63], v222 offset:3904
    v_mfma_f32_16x16x32_bf16 v[24:27], v[128:131], v[68:71], 0
    ds_read_b128 v[64:67], v222 offset:4096
    s_waitcnt lgkmcnt(9)
    v_mfma_f32_16x16x32_bf16 v[28:31], v[128:131], v[72:75], 0
    ds_read_b128 v[68:71], v222 offset:4352
    v_mfma_f32_16x16x32_bf16 v[20:23], v[132:135], v[76:79], v[20:23]
    ds_read_b128 v[72:75], v222 offset:4224
    s_waitcnt lgkmcnt(9)
    v_mfma_f32_16x16x32_bf16 v[24:27], v[132:135], v[80:83], v[24:27]
    ds_read_b128 v[76:79], v222 offset:4160
    v_mfma_f32_16x16x32_bf16 v[28:31], v[132:135], v[84:87], v[28:31]
    ds_read_b128 v[80:83], v222 offset:4416
    s_waitcnt lgkmcnt(9)
    v_mfma_f32_16x16x32_bf16 v[20:23], v[136:139], v[88:91], v[20:23]
    ds_read_b128 v[84:87], v222 offset:4288
    v_mfma_f32_16x16x32_bf16 v[24:27], v[136:139], v[92:95], v[24:27]
    ds_read_b128 v[88:91], v223 offset:38528
    s_waitcnt lgkmcnt(9)
    v_mfma_f32_16x16x32_bf16 v[28:31], v[136:139], v[48:51], v[28:31]
    ds_read_b128 v[92:95], v223 offset:38784
    v_mfma_f32_16x16x32_bf16 v[20:23], v[140:143], v[52:55], v[20:23]
    ds_read_b128 v[48:51], v223 offset:38656
    s_waitcnt lgkmcnt(9)
    v_mfma_f32_16x16x32_bf16 v[24:27], v[140:143], v[56:59], v[24:27]
    ds_read_b128 v[52:55], v223 offset:38592
    v_mfma_f32_16x16x32_bf16 v[28:31], v[140:143], v[60:63], v[28:31]
    ds_read_b128 v[56:59], v223 offset:38848
    s_waitcnt lgkmcnt(9)
    v_mfma_f32_16x16x32_bf16 v[20:23], v[144:147], v[64:67], v[20:23]
    ds_read_b128 v[60:63], v223 offset:38720
    v_mfma_f32_16x16x32_bf16 v[24:27], v[144:147], v[68:71], v[24:27]
    ds_read_b128 v[64:67], v223 offset:39040
    s_waitcnt lgkmcnt(9)
    v_mfma_f32_16x16x32_bf16 v[28:31], v[144:147], v[72:75], v[28:31]
    ds_read_b128 v[68:71], v223 offset:38912
    v_mfma_f32_16x16x32_bf16 v[20:23], v[148:151], v[76:79], v[20:23]
    ds_read_b128 v[72:75], v223 offset:39168
    s_waitcnt lgkmcnt(9)
    v_mfma_f32_16x16x32_bf16 v[24:27], v[148:151], v[80:83], v[24:27]
    ds_read_b128 v[76:79], v223 offset:39104
    v_mfma_f32_16x16x32_bf16 v[28:31], v[148:151], v[84:87], v[28:31]
    ds_read_b128 v[80:83], v223 offset:38976
    s_waitcnt lgkmcnt(9)
    v_mfma_f32_16x16x32_bf16 v[20:23], v[152:155], v[88:91], v[20:23]
    ds_read_b128 v[84:87], v223 offset:39232
    v_mfma_f32_16x16x32_bf16 v[24:27], v[152:155], v[92:95], v[24:27]
    ds_read_b128 v[88:91], v223 offset:39424
    s_waitcnt lgkmcnt(9)
    v_mfma_f32_16x16x32_bf16 v[28:31], v[152:155], v[48:51], v[28:31]
    ds_read_b128 v[92:95], v223 offset:39680
    v_mfma_f32_16x16x32_bf16 v[20:23], v[156:159], v[52:55], v[20:23]
    ds_read_b128 v[48:51], v223 offset:39552
    s_waitcnt lgkmcnt(9)
    v_mfma_f32_16x16x32_bf16 v[24:27], v[156:159], v[56:59], v[24:27]
    ds_read_b128 v[52:55], v223 offset:39488
    v_mfma_f32_16x16x32_bf16 v[28:31], v[156:159], v[60:63], v[28:31]
    ds_read_b128 v[56:59], v223 offset:39744
    s_waitcnt lgkmcnt(9)
    v_mfma_f32_16x16x32_bf16 v[20:23], v[160:163], v[64:67], v[20:23]
    ds_read_b128 v[60:63], v223 offset:39616
    v_mfma_f32_16x16x32_bf16 v[24:27], v[160:163], v[68:71], v[24:27]
    ds_read_b128 v[64:67], v232 offset:6144
    s_waitcnt lgkmcnt(9)
    v_mfma_f32_16x16x32_bf16 v[28:31], v[160:163], v[72:75], v[28:31]
    ds_read_b128 v[68:71], v232 offset:6208
    v_mfma_f32_16x16x32_bf16 v[20:23], v[164:167], v[76:79], v[20:23]
    ds_read_b128 v[72:75], v232 offset:7040
    s_waitcnt lgkmcnt(9)
    v_mfma_f32_16x16x32_bf16 v[24:27], v[164:167], v[80:83], v[24:27]
    ds_read_b128 v[76:79], v232 offset:7104
    v_mfma_f32_16x16x32_bf16 v[28:31], v[164:167], v[84:87], v[28:31]
    ds_read_b128 v[80:83], v225 offset:0
    s_waitcnt lgkmcnt(9)
    v_mfma_f32_16x16x32_bf16 v[20:23], v[168:171], v[88:91], v[20:23]
    ds_read_b128 v[84:87], v225 offset:64
    v_mfma_f32_16x16x32_bf16 v[24:27], v[168:171], v[92:95], v[24:27]
    ds_read_b128 v[88:91], v225 offset:896
    s_waitcnt lgkmcnt(9)
    v_mfma_f32_16x16x32_bf16 v[28:31], v[168:171], v[48:51], v[28:31]
    ds_read_b128 v[92:95], v225 offset:960
    v_mfma_f32_16x16x32_bf16 v[20:23], v[172:175], v[52:55], v[20:23]
    ds_read_b128 v[48:51], v247 offset:6272
    s_waitcnt lgkmcnt(9)
    v_mfma_f32_16x16x32_bf16 v[24:27], v[172:175], v[56:59], v[24:27]
    ds_read_b128 v[52:55], v232 offset:6528
    v_mfma_f32_16x16x32_bf16 v[28:31], v[172:175], v[60:63], v[28:31]
    ds_read_b128 v[56:59], v247 offset:6336
    s_waitcnt lgkmcnt(9)
    v_mfma_f32_16x16x32_bf16 v[32:35], v[96:99], v[64:67], 0
    ds_read_b128 v[60:63], v232 offset:6592
    v_mfma_f32_16x16x32_bf16 v[32:35], v[100:103], v[68:71], v[32:35]
    ds_read_b128 v[64:67], v247 offset:6784
    s_waitcnt lgkmcnt(9)
    v_mfma_f32_16x16x32_bf16 v[32:35], v[104:107], v[72:75], v[32:35]
    ds_read_b128 v[68:71], v232 offset:6656
    v_mfma_f32_16x16x32_bf16 v[32:35], v[108:111], v[76:79], v[32:35]
    ds_read_b128 v[72:75], v247 offset:6848
    s_waitcnt lgkmcnt(9)
    v_mfma_f32_16x16x32_bf16 v[32:35], v[112:115], v[80:83], v[32:35]
    ds_read_b128 v[76:79], v232 offset:6720
    v_mfma_f32_16x16x32_bf16 v[32:35], v[116:119], v[84:87], v[32:35]
    ds_read_b128 v[80:83], v247 offset:7168
    s_waitcnt lgkmcnt(9)
    v_mfma_f32_16x16x32_bf16 v[32:35], v[120:123], v[88:91], v[32:35]
    ds_read_b128 v[84:87], v232 offset:7424
    v_mfma_f32_16x16x32_bf16 v[32:35], v[124:127], v[92:95], v[32:35]
    ds_read_b128 v[88:91], v247 offset:7232
    s_waitcnt lgkmcnt(9)
    v_mfma_f32_16x16x32_bf16 v[36:39], v[128:131], v[48:51], 0
    ds_read_b128 v[92:95], v232 offset:7488
    v_mfma_f32_16x16x32_bf16 v[40:43], v[128:131], v[52:55], 0
    ds_read_b128 v[48:51], v248 offset:128
    s_waitcnt lgkmcnt(9)
    v_mfma_f32_16x16x32_bf16 v[36:39], v[132:135], v[56:59], v[36:39]
    ds_read_b128 v[52:55], v225 offset:384
    v_mfma_f32_16x16x32_bf16 v[40:43], v[132:135], v[60:63], v[40:43]
    ds_read_b128 v[56:59], v248 offset:192
    s_waitcnt lgkmcnt(9)
    v_mfma_f32_16x16x32_bf16 v[36:39], v[136:139], v[64:67], v[36:39]
    ds_read_b128 v[60:63], v225 offset:448
    v_mfma_f32_16x16x32_bf16 v[40:43], v[136:139], v[68:71], v[40:43]
    ds_read_b128 v[64:67], v248 offset:640
    s_waitcnt lgkmcnt(9)
    v_mfma_f32_16x16x32_bf16 v[36:39], v[140:143], v[72:75], v[36:39]
    ds_read_b128 v[68:71], v225 offset:512
    v_mfma_f32_16x16x32_bf16 v[40:43], v[140:143], v[76:79], v[40:43]
    ds_read_b128 v[72:75], v248 offset:704
    s_waitcnt lgkmcnt(9)
    v_mfma_f32_16x16x32_bf16 v[36:39], v[144:147], v[80:83], v[36:39]
    ds_read_b128 v[76:79], v225 offset:576
    v_mfma_f32_16x16x32_bf16 v[40:43], v[144:147], v[84:87], v[40:43]
    ds_read_b128 v[80:83], v248 offset:1024
    s_waitcnt lgkmcnt(9)
    v_mfma_f32_16x16x32_bf16 v[36:39], v[148:151], v[88:91], v[36:39]
    ds_read_b128 v[84:87], v225 offset:1280
    v_mfma_f32_16x16x32_bf16 v[40:43], v[148:151], v[92:95], v[40:43]
    ds_read_b128 v[88:91], v248 offset:1088
    s_waitcnt lgkmcnt(9)
    v_mfma_f32_16x16x32_bf16 v[36:39], v[152:155], v[48:51], v[36:39]
    ds_read_b128 v[92:95], v225 offset:1344
    v_mfma_f32_16x16x32_bf16 v[40:43], v[152:155], v[52:55], v[40:43]
    s_waitcnt lgkmcnt(8)
    v_mfma_f32_16x16x32_bf16 v[36:39], v[156:159], v[56:59], v[36:39]
    v_mfma_f32_16x16x32_bf16 v[40:43], v[156:159], v[60:63], v[40:43]
    s_waitcnt lgkmcnt(6)
    v_mfma_f32_16x16x32_bf16 v[36:39], v[160:163], v[64:67], v[36:39]
    v_mfma_f32_16x16x32_bf16 v[40:43], v[160:163], v[68:71], v[40:43]
    s_waitcnt lgkmcnt(4)
    v_mfma_f32_16x16x32_bf16 v[36:39], v[164:167], v[72:75], v[36:39]
    v_mfma_f32_16x16x32_bf16 v[40:43], v[164:167], v[76:79], v[40:43]
    s_waitcnt lgkmcnt(2)
    v_mfma_f32_16x16x32_bf16 v[36:39], v[168:171], v[80:83], v[36:39]
    v_mfma_f32_16x16x32_bf16 v[40:43], v[168:171], v[84:87], v[40:43]
    s_waitcnt lgkmcnt(0)
    v_mfma_f32_16x16x32_bf16 v[36:39], v[172:175], v[88:91], v[36:39]
    v_mfma_f32_16x16x32_bf16 v[40:43], v[172:175], v[92:95], v[40:43]
    s_lshl_b32 s60, s54, 9
    s_lshl_b32 s61, s20, 6
    s_add_u32 s60, s60, s61
    s_mul_i32 s60, s60, 192
    s_add_u32 s60, s60, 10485760
    v_mul_u32_u24 v227, 96, v252
    s_cmp_lg_u32 s28, 0
    s_cbranch_scc1 K2_NOACC
    buffer_load_dwordx4 v[48:51], v227, s[8:11], s60 offen offset:0
    buffer_load_dwordx4 v[52:55], v227, s[8:11], s60 offen offset:16
    buffer_load_dwordx4 v[56:59], v227, s[8:11], s60 offen offset:32
    buffer_load_dwordx4 v[60:63], v227, s[8:11], s60 offen offset:48
    buffer_load_dwordx4 v[64:67], v227, s[8:11], s60 offen offset:64
    buffer_load_dwordx4 v[68:71], v227, s[8:11], s60 offen offset:80
    buffer_load_dwordx4 v[72:75], v227, s[8:11], s60 offen offset:96
    buffer_load_dwordx4 v[76:79], v227, s[8:11], s60 offen offset:112
    buffer_load_dwordx4 v[80:83], v227, s[8:11], s60 offen offset:128
    buffer_load_dwordx4 v[84:87], v227, s[8:11], s60 offen offset:144
    buffer_load_dwordx4 v[88:91], v227, s[8:11], s60 offen offset:160
    s_waitcnt vmcnt(0)
    v_add_f32 v0, v0, v48
    v_add_f32 v1, v1, v49
    v_add_f32 v2, v2, v50
    v_add_f32 v3, v3, v51
    v_add_f32 v4, v4, v52
    v_add_f32 v5, v5, v53
    v_add_f32 v6, v6, v54
    v_add_f32 v7, v7, v55
    v_add_f32 v8, v8, v56
    v_add_f32 v9, v9, v57
    v_add_f32 v10, v10, v58
    v_add_f32 v11, v11, v59
    v_add_f32 v12, v12, v60
    v_add_f32 v13, v13, v61
    v_add_f32 v14, v14, v62
    v_add_f32 v15, v15, v63
    v_add_f32 v16, v16, v64
    v_add_f32 v17, v17, v65
    v_add_f32 v18, v18, v66
    v_add_f32 v19, v19, v67
    v_add_f32 v20, v20, v68
    v_add_f32 v21, v21, v69
    v_add_f32 v22, v22, v70
    v_add_f32 v23, v23, v71
    v_add_f32 v24, v24, v72
    v_add_f32 v25, v25, v73
    v_add_f32 v26, v26, v74
    v_add_f32 v27, v27, v75
    v_add_f32 v28, v28, v76
    v_add_f32 v29, v29, v77
    v_add_f32 v30, v30, v78
    v_add_f32 v31, v31, v79
    v_add_f32 v32, v32, v80
    v_add_f32 v33, v33, v81
    v_add_f32 v34, v34, v82
    v_add_f32 v35, v35, v83
    v_add_f32 v36, v36, v84
    v_add_f32 v37, v37, v85
    v_add_f32 v38, v38, v86
    v_add_f32 v39, v39, v87
    v_add_f32 v40, v40, v88
    v_add_f32 v41, v41, v89
    v_add_f32 v42, v42, v90
    v_add_f32 v43, v43, v91
K2_NOACC:
    s_barrier
    s_cmp_eq_u32 s55, 0
    s_cbranch_scc1 K2_SPILL
    s_bfe_u32 s60, s20, 0x10002
    s_lshl_b32 s60, s60, 4
    s_add_u32 s59, s59, s60
    v_add_u32 v228, s59, v229
    s_mul_i32 s60, s20, 2400
    s_add_u32 s60, s60, 65536
    v_add_u32 v249, s60, v229
    s_mov_b32 s63, 0xbfb8aa3b
    s_add_u32 s40, s20, s21
    s_lshl_b32 s40, s40, 10
    s_add_u32 s41, s40, 8192
    s_add_u32 s42, s40, 16384
    s_add_u32 s43, s40, 24576
    s_add_u32 s44, s40, 32768
    v_mul_f32 v204, s63, v0
    v_mul_f32 v205, s63, v1
    v_mul_f32 v206, s63, v2
    v_mul_f32 v207, s63, v3
    v_exp_f32 v204, v204
    v_exp_f32 v205, v205
    v_exp_f32 v206, v206
    v_exp_f32 v207, v207
    v_add_f32 v204, 1.0, v204
    v_add_f32 v205, 1.0, v205
    v_add_f32 v206, 1.0, v206
    v_add_f32 v207, 1.0, v207
    v_rcp_f32 v204, v204
    v_rcp_f32 v205, v205
    v_rcp_f32 v206, v206
    v_rcp_f32 v207, v207
    v_cvt_pk_bf16_f32 v176, v0, v1
    v_cvt_pk_bf16_f32 v177, v2, v3
    v_mul_f32 v4, v4, v204
    v_mul_f32 v5, v5, v205
    v_mul_f32 v6, v6, v206
    v_mul_f32 v7, v7, v207
    v_cvt_pk_bf16_f32 v178, v4, v5
    v_cvt_pk_bf16_f32 v179, v6, v7
    v_mul_f32 v8, v8, v204
    v_mul_f32 v9, v9, v205
    v_mul_f32 v10, v10, v206
    v_mul_f32 v11, v11, v207
    v_cvt_pk_bf16_f32 v180, v8, v9
    v_cvt_pk_bf16_f32 v181, v10, v11
    v_mul_f32 v12, v12, v204
    v_mul_f32 v13, v13, v205
    v_mul_f32 v14, v14, v206
    v_mul_f32 v15, v15, v207
    v_cvt_pk_bf16_f32 v182, v12, v13
    v_cvt_pk_bf16_f32 v183, v14, v15
    ds_write_b64 v254, v[176:177] offset:0
    ds_write_b64 v254, v[178:179] offset:256
    ds_write_b64 v254, v[180:181] offset:512
    ds_write_b64 v254, v[182:183] offset:768
    s_waitcnt lgkmcnt(0)
    s_barrier
    ds_read_b128 v[192:195], v228 offset:0
    ds_read_b128 v[196:199], v228 offset:1536
    s_waitcnt lgkmcnt(0)
    buffer_store_dwordx4 v[192:195], v229, s[12:15], s40 offen sc1
    buffer_store_dwordx4 v[196:199], v229, s[12:15], s41 offen sc1
    v_mul_f32 v208, s63, v16
    v_mul_f32 v209, s63, v17
    v_mul_f32 v210, s63, v18
    v_mul_f32 v211, s63, v19
    v_exp_f32 v208, v208
    v_exp_f32 v209, v209
    v_exp_f32 v210, v210
    v_exp_f32 v211, v211
    v_add_f32 v208, 1.0, v208
    v_add_f32 v209, 1.0, v209
    v_add_f32 v210, 1.0, v210
    v_add_f32 v211, 1.0, v211
    v_rcp_f32 v208, v208
    v_rcp_f32 v209, v209
    v_rcp_f32 v210, v210
    v_rcp_f32 v211, v211
    v_cvt_pk_bf16_f32 v184, v16, v17
    v_cvt_pk_bf16_f32 v185, v18, v19
    v_mul_f32 v20, v20, v208
    v_mul_f32 v21, v21, v209
    v_mul_f32 v22, v22, v210
    v_mul_f32 v23, v23, v211
    v_cvt_pk_bf16_f32 v186, v20, v21
    v_cvt_pk_bf16_f32 v187, v22, v23
    v_mul_f32 v24, v24, v208
    v_mul_f32 v25, v25, v209
    v_mul_f32 v26, v26, v210
    v_mul_f32 v27, v27, v211
    v_cvt_pk_bf16_f32 v188, v24, v25
    v_cvt_pk_bf16_f32 v189, v26, v27
    v_mul_f32 v28, v28, v208
    v_mul_f32 v29, v29, v209
    v_mul_f32 v30, v30, v210
    v_mul_f32 v31, v31, v211
    v_cvt_pk_bf16_f32 v190, v28, v29
    v_cvt_pk_bf16_f32 v191, v30, v31
    ds_write_b64 v254, v[184:185] offset:3072
    ds_write_b64 v254, v[186:187] offset:3328
    ds_write_b64 v254, v[188:189] offset:3584
    ds_write_b64 v254, v[190:191] offset:3840
    s_waitcnt lgkmcnt(0)
    s_barrier
    ds_read_b128 v[192:195], v228 offset:3072
    ds_read_b128 v[196:199], v228 offset:4608
    s_waitcnt lgkmcnt(0)
    buffer_store_dwordx4 v[192:195], v229, s[12:15], s42 offen sc1
    buffer_store_dwordx4 v[196:199], v229, s[12:15], s43 offen sc1
    v_mul_f32 v204, s63, v32
    v_mul_f32 v205, s63, v33
    v_mul_f32 v206, s63, v34
    v_mul_f32 v207, s63, v35
    v_exp_f32 v204, v204
    v_exp_f32 v205, v205
    v_exp_f32 v206, v206
    v_exp_f32 v207, v207
    v_add_f32 v204, 1.0, v204
    v_add_f32 v205, 1.0, v205
    v_add_f32 v206, 1.0, v206
    v_add_f32 v207, 1.0, v207
    v_rcp_f32 v204, v204
    v_rcp_f32 v205, v205
    v_rcp_f32 v206, v206
    v_rcp_f32 v207, v207
    v_cvt_pk_bf16_f32 v176, v32, v33
    v_cvt_pk_bf16_f32 v177, v34, v35
    v_mul_f32 v36, v36, v204
    v_mul_f32 v37, v37, v205
    v_mul_f32 v38, v38, v206
    v_mul_f32 v39, v39, v207
    v_cvt_pk_bf16_f32 v178, v36, v37
    v_cvt_pk_bf16_f32 v179, v38, v39
    v_mul_f32 v40, v40, v204
    v_mul_f32 v41, v41, v205
    v_mul_f32 v42, v42, v206
    v_mul_f32 v43, v43, v207
    v_cvt_pk_bf16_f32 v180, v40, v41
    v_cvt_pk_bf16_f32 v181, v42, v43
    ds_write_b64 v255, v[176:177] offset:0
    ds_write_b64 v246, v[178:179] offset:256
    ds_write_b64 v255, v[180:181] offset:512
    s_waitcnt lgkmcnt(0)
    s_barrier
    ds_read_b128 v[200:203], v249
    s_branch K2_LASTROW
K2_SPILL:
    buffer_store_dwordx4 v[0:3], v227, s[8:11], s60 offen offset:0
    buffer_store_dwordx4 v[4:7], v227, s[8:11], s60 offen offset:16
    buffer_store_dwordx4 v[8:11], v227, s[8:11], s60 offen offset:32
    buffer_store_dwordx4 v[12:15], v227, s[8:11], s60 offen offset:48
    buffer_store_dwordx4 v[16:19], v227, s[8:11], s60 offen offset:64
    buffer_store_dwordx4 v[20:23], v227, s[8:11], s60 offen offset:80
    buffer_store_dwordx4 v[24:27], v227, s[8:11], s60 offen offset:96
    buffer_store_dwordx4 v[28:31], v227, s[8:11], s60 offen offset:112
    buffer_store_dwordx4 v[32:35], v227, s[8:11], s60 offen offset:128
    buffer_store_dwordx4 v[36:39], v227, s[8:11], s60 offen offset:144
    buffer_store_dwordx4 v[40:43], v227, s[8:11], s60 offen offset:160
    s_mov_b32 s28, 0
    s_waitcnt vmcnt(0)
    s_cmp_lt_u32 s24, s25
    s_cbranch_scc1 K2_LOAD
    s_add_u32 s23, s23, 20
    s_branch K2_WINDOW
K2_WINDOW:
    s_mov_b32 s24, 0
    s_mov_b32 s25, 1
K2_LOAD:
    v_mbcnt_lo_u32_b32 v176, -1, 0
    v_mbcnt_hi_u32_b32 v176, -1, v176
    s_lshl_b32 s58, s20, 6
    v_add_u32 v177, s58, v176
    v_lshlrev_b32 v70, 4, v176
    s_mov_b32 s58, 7110656
    buffer_load_dwordx4 v[96:99], v70, s[8:11], s58 offen offset:0 sc1
    buffer_load_dwordx4 v[100:103], v70, s[8:11], s58 offen offset:1024 sc1
    buffer_load_dwordx4 v[104:107], v70, s[8:11], s58 offen offset:2048 sc1
    buffer_load_dwordx4 v[108:111], v70, s[8:11], s58 offen offset:3072 sc1
    s_mov_b32 s58, 7114752
    buffer_load_dwordx4 v[112:115], v70, s[8:11], s58 offen offset:0 sc1
    buffer_load_dwordx4 v[116:119], v70, s[8:11], s58 offen offset:1024 sc1
    buffer_load_dwordx4 v[120:123], v70, s[8:11], s58 offen offset:2048 sc1
    buffer_load_dwordx4 v[124:127], v70, s[8:11], s58 offen offset:3072 sc1
    s_mov_b32 s58, 7118848
    buffer_load_dwordx4 v[128:131], v70, s[8:11], s58 offen offset:0 sc1
    buffer_load_dwordx4 v[132:135], v70, s[8:11], s58 offen offset:1024 sc1
    buffer_load_dwordx4 v[136:139], v70, s[8:11], s58 offen offset:2048 sc1
    buffer_load_dwordx4 v[140:143], v70, s[8:11], s58 offen offset:3072 sc1
    s_mov_b32 s58, 7122944
    buffer_load_dwordx4 v[144:147], v70, s[8:11], s58 offen offset:0 sc1
    buffer_load_dwordx4 v[148:151], v70, s[8:11], s58 offen offset:1024 sc1
    buffer_load_dwordx4 v[152:155], v70, s[8:11], s58 offen offset:2048 sc1
    buffer_load_dwordx4 v[156:159], v70, s[8:11], s58 offen offset:3072 sc1
    s_mov_b32 s58, 7127040
    buffer_load_dwordx4 v[160:163], v70, s[8:11], s58 offen offset:0 sc1
    buffer_load_dwordx4 v[164:167], v70, s[8:11], s58 offen offset:1024 sc1
    buffer_load_dwordx4 v[168:171], v70, s[8:11], s58 offen offset:2048 sc1
    buffer_load_dwordx4 v[172:175], v70, s[8:11], s58 offen offset:3072 sc1
    v_mul_u32_u24 v76, 437, v177
    v_lshrrev_b32 v76, 16, v76
    v_mul_u32_u24 v76, 150, v76
    v_sub_u32 v76, v177, v76
    v_mov_b32 v80, -1
    v_mov_b32 v77, 1.0
    v_cmp_gt_u32 vcc, 48, v76
    v_lshlrev_b32 v78, 4, v177
    v_add_u32 v78, 65536, v78
    v_cndmask_b32 v80, v80, 0, vcc
    v_cmp_gt_u32 vcc, 12, v76
    v_add_u32 v79, 64800, v78
    s_nop 0
    v_cndmask_b32 v80, v80, v77, vcc
    v_cmp_gt_u32 vcc, 450, v177
    v_mov_b32 v81, v80
    v_mov_b32 v82, v80
    v_mov_b32 v83, v80
    s_mov_b64 exec, vcc
    ds_write_b128 v78, v[80:83] offset:0
    ds_write_b128 v78, v[80:83] offset:7200
    ds_write_b128 v78, v[80:83] offset:14400
    ds_write_b128 v78, v[80:83] offset:21600
    ds_write_b128 v78, v[80:83] offset:28800
    ds_write_b128 v78, v[80:83] offset:36000
    ds_write_b128 v78, v[80:83] offset:43200
    ds_write_b128 v78, v[80:83] offset:50400
    ds_write_b128 v78, v[80:83] offset:57600
    ds_write_b128 v79, v[80:83] offset:0
    ds_write_b128 v79, v[80:83] offset:7200
    ds_write_b128 v79, v[80:83] offset:14400
    ds_write_b128 v79, v[80:83] offset:21600
    v_cmp_gt_u32 vcc, 268, v177
    s_nop 0
    s_cbranch_vccz K2_NOCL
    s_mov_b64 exec, vcc
    ds_write_b128 v79, v[80:83] offset:28800
K2_NOCL:
    s_mov_b64 exec, -1
    s_cmp_lg_u32 s20, 7
    s_cbranch_scc1 K2_NOH
    v_mov_b32 v76, 0
    v_mov_b32 v77, -1
    v_lshlrev_b32 v78, 2, v176
    v_add_u32 v78, 163424, v78
    s_mov_b64 exec, 0x1ff
    ds_write_b32 v78, v76 offset:192
    s_mov_b64 exec, 0xff
    ds_write_b32 v78, v77 offset:256
    s_mov_b64 exec, -1
    s_cmp_lg_u32 s24, 0
    s_cbranch_scc1 K2_NOH
    s_mov_b32 exec_hi, 0xffff
    ds_write_b32 v78, v76
    s_mov_b64 exec, 0x3f
    ds_write_b32 v78, v76 offset:228
    s_mov_b64 exec, -1
K2_NOH:
    s_waitcnt lgkmcnt(0)
    s_barrier
    s_branch K2_CELLS
K2_LD_GEN:
    s_mov_b64 exec, s[46:47]
    s_cbranch_execz K2_LD_DONE
    buffer_load_dwordx4 v[12:15], v182, s[8:11], 0 offen sc1
    s_mov_b64 exec, s[48:49]
    s_cbranch_execz K2_LD_DONE
    buffer_load_dwordx4 v[16:19], v181, s[8:11], 0 offen offset:128 sc1
    s_mov_b64 exec, s[50:51]
    s_cbranch_execz K2_LD_DONE
    buffer_load_dwordx4 v[20:23], v181, s[8:11], 0 offen offset:160 sc1
    s_mov_b64 exec, s[90:91]
    s_cbranch_execz K2_LD_DONE
    buffer_load_dwordx4 v[24:27], v181, s[8:11], 0 offen offset:192 sc1
    s_mov_b64 exec, s[92:93]
    s_cbranch_execz K2_LD_DONE
    buffer_load_dwordx4 v[28:31], v181, s[8:11], 0 offen offset:224 sc1
    s_mov_b64 exec, s[94:95]
    s_cbranch_execz K2_LD_DONE
    buffer_load_dwordx4 v[32:35], v181, s[8:11], 0 offen offset:256 sc1
    s_mov_b64 exec, s[96:97]
    s_cbranch_execz K2_LD_DONE
    buffer_load_dwordx4 v[36:39], v181, s[8:11], 0 offen offset:288 sc1
    s_branch K2_LD_DONE
K2_FLGLD:
    buffer_load_dwordx4 v[84:87], v72, s[8:11], s64 offen sc1
    s_mov_b32 s62, 0
    s_branch K2_FLGL2
K2_FLGCK:
    s_cmp_lg_u32 s24, 0
    s_cbranch_scc1 K2_FLGOK
    s_waitcnt vmcnt(0)
K2_FLGW:
    v_xor_b32 v84, s2, v84
    v_xor_b32 v85, s2, v85
    v_xor_b32 v86, s2, v86
    v_xor_b32 v87, s2, v87
    v_or3_b32 v84, v84, v85, v86
    v_or_b32 v84, v84, v87
    v_cmp_ne_u32 vcc, 0, v84
    s_nop 0
    s_and_b32 vcc_hi, vcc_hi, 0x3ffff
    s_cmp_eq_u64 vcc, 0
    s_cbranch_scc1 K2_FLGOK
    s_sub_u32 s60, s60, 1
    s_cbranch_scc1 K2_END
    buffer_load_dwordx4 v[84:87], v72, s[8:11], s64 offen sc1
    s_waitcnt vmcnt(0)
    s_branch K2_FLGW
K2_RT0:
    s_sub_u32 s60, s60, 1
    s_cbranch_scc1 K2_END
    buffer_load_dwordx4 v[0:3], v181, s[8:11], 0 offen offset:0 sc1
    s_waitcnt vmcnt(0)
    s_branch K2_CK0
K2_RT1:
    s_sub_u32 s60, s60, 1
    s_cbranch_scc1 K2_END
    buffer_load_dwordx4 v[4:7], v181, s[8:11], 0 offen offset:32 sc1
    s_waitcnt vmcnt(0)
    s_branch K2_CK1
K2_RT2:
    s_sub_u32 s60, s60, 1
    s_cbranch_scc1 K2_END
    buffer_load_dwordx4 v[8:11], v181, s[8:11], 0 offen offset:64 sc1
    s_waitcnt vmcnt(0)
    s_branch K2_CK2
K2_RT3:
    s_sub_u32 s60, s60, 1
    s_cbranch_scc1 K2_END
    buffer_load_dwordx4 v[12:15], v182, s[8:11], 0 offen sc1
    s_waitcnt vmcnt(0)
    s_branch K2_CK3
K2_RT4:
    s_sub_u32 s60, s60, 1
    s_cbranch_scc1 K2_END
    buffer_load_dwordx4 v[16:19], v181, s[8:11], 0 offen offset:128 sc1
    s_waitcnt vmcnt(0)
    s_branch K2_CK4
K2_RT5:
    s_sub_u32 s60, s60, 1
    s_cbranch_scc1 K2_END
    buffer_load_dwordx4 v[20:23], v181, s[8:11], 0 offen offset:160 sc1
    s_waitcnt vmcnt(0)
    s_branch K2_CK5
K2_RT6:
    s_sub_u32 s60, s60, 1
    s_cbranch_scc1 K2_END
    buffer_load_dwordx4 v[24:27], v181, s[8:11], 0 offen offset:192 sc1
    s_waitcnt vmcnt(0)
    s_branch K2_CK6
K2_RT7:
    s_sub_u32 s60, s60, 1
    s_cbranch_scc1 K2_END
    buffer_load_dwordx4 v[28:31], v181, s[8:11], 0 offen offset:224 sc1
    s_waitcnt vmcnt(0)
    s_branch K2_CK7
K2_RT8:
    s_sub_u32 s60, s60, 1
    s_cbranch_scc1 K2_END
    buffer_load_dwordx4 v[32:35], v181, s[8:11], 0 offen offset:256 sc1
    s_waitcnt vmcnt(0)
    s_branch K2_CK8
K2_RT9:
    s_sub_u32 s60, s60, 1
    s_cbranch_scc1 K2_END
    buffer_load_dwordx4 v[36:39], v181, s[8:11], 0 offen offset:288 sc1
    s_waitcnt vmcnt(0)
    s_branch K2_CK9
K2_RK_LOAD:
    s_waitcnt vmcnt(0)
    s_mov_b64 exec, s[40:41]
    s_cbranch_execz K2_RK_B
    v_lshrrev_b32 v50, 24, v3
    buffer_load_dword v40, v179, s[8:11], s66 offen offset:0
    v_mad_u32_u24 v50, v50, s58, v202
    v_and_b32 v3, 0xffffff, v3
    s_mov_b64 exec, s[42:43]
    s_cbranch_execz K2_RK_B
    v_lshrrev_b32 v51, 24, v7
    buffer_load_dword v41, v179, s[8:11], s66 offen offset:8
    v_mad_u32_u24 v51, v51, s58, v202
    v_and_b32 v7, 0xffffff, v7
    s_mov_b64 exec, s[44:45]
    s_cbranch_execz K2_RK_B
    v_lshrrev_b32 v52, 24, v11
    buffer_load_dword v42, v179, s[8:11], s66 offen offset:16
    v_mad_u32_u24 v52, v52, s58, v202
    v_and_b32 v11, 0xffffff, v11
    s_mov_b64 exec, s[46:47]
    s_cbranch_execz K2_RK_B
    v_lshrrev_b32 v53, 24, v15
    buffer_load_dword v43, v183, s[8:11], s66 offen
    v_mad_u32_u24 v53, v53, s58, v202
    v_and_b32 v15, 0xffffff, v15
    s_mov_b64 exec, s[48:49]
    s_cbranch_execz K2_RK_B
    v_lshrrev_b32 v54, 24, v19
    buffer_load_dword v44, v179, s[8:11], s66 offen offset:32
    v_mad_u32_u24 v54, v54, s58, v202
    v_and_b32 v19, 0xffffff, v19
    s_mov_b64 exec, s[50:51]
    s_cbranch_execz K2_RK_B
    v_lshrrev_b32 v55, 24, v23
    buffer_load_dword v45, v179, s[8:11], s66 offen offset:40
    v_mad_u32_u24 v55, v55, s58, v202
    v_and_b32 v23, 0xffffff, v23
    s_mov_b64 exec, s[90:91]
    s_cbranch_execz K2_RK_B
    v_lshrrev_b32 v56, 24, v27
    buffer_load_dword v46, v179, s[8:11], s66 offen offset:48
    v_mad_u32_u24 v56, v56, s58, v202
    v_and_b32 v27, 0xffffff, v27
    s_mov_b64 exec, s[92:93]
    s_cbranch_execz K2_RK_B
    v_lshrrev_b32 v57, 24, v31
    buffer_load_dword v47, v179, s[8:11], s66 offen offset:56
    v_mad_u32_u24 v57, v57, s58, v202
    v_and_b32 v31, 0xffffff, v31
    s_mov_b64 exec, s[94:95]
    s_cbranch_execz K2_RK_B
    v_lshrrev_b32 v58, 24, v35
    buffer_load_dword v48, v179, s[8:11], s66 offen offset:64
    v_mad_u32_u24 v58, v58, s58, v202
    v_and_b32 v35, 0xffffff, v35
    s_mov_b64 exec, s[96:97]
    s_cbranch_execz K2_RK_B
    v_lshrrev_b32 v59, 24, v39
    buffer_load_dword v49, v179, s[8:11], s66 offen offset:72
    v_mad_u32_u24 v59, v59, s58, v202
    v_and_b32 v39, 0xffffff, v39
K2_RK_B:
    s_mov_b64 exec, -1
    s_mul_i32 s62, s24, 48
    s_waitcnt vmcnt(0)
    v_subrev_u32 v40, s62, v40
    v_subrev_u32 v41, s62, v41
    v_subrev_u32 v42, s62, v42
    v_subrev_u32 v43, s62, v43
    v_subrev_u32 v44, s62, v44
    v_subrev_u32 v45, s62, v45
    v_subrev_u32 v46, s62, v46
    v_subrev_u32 v47, s62, v47
    v_subrev_u32 v48, s62, v48
    v_subrev_u32 v49, s62, v49
    s_branch K2_RK_DONE
K2_PAD_OV:
    s_branch K2_HOP
K2_OV:
    s_cmp_lg_u32 s24, 0
    s_cbranch_scc1 K2_OB
    s_cmp_eq_u32 s22, 39
    s_cselect_b32 s63, 5, 2
    s_flbit_i32_b32 s56, s58
    s_sub_u32 s56, 31, s56
    s_bitset0_b32 s58, s56
    s_sub_u32 s57, s56, 1
    v_mov_b32 v198, 0
    v_mov_b32 v206, s57
K2_OVL:
    s_mov_b64 exec, -1
    s_ff1_i32_b32 s61, s58
    s_bitset0_b32 s58, s61
    v_readfirstlane_b32 s62, v206
    s_nop 0
    s_sub_u32 s62, s62, s61
    s_lshl_b32 s61, s62, 1
    v_cmp_lt_i32 vcc, s61, v180
    s_cmp_eq_u32 s62, 3
    s_cselect_b64 vcc, s[46:47], vcc
    s_lshl_b32 s61, s62, 2
    s_set_gpr_idx_on s62, gpr_idx(SRC0)
    s_nop 0
    v_mov_b32 v204, v40
    v_mov_b32 v205, v50
    s_set_gpr_idx_idx s61
    s_nop 0
    v_mov_b32 v208, v0
    v_mov_b32 v209, v1
    v_mov_b32 v210, v2
    v_mov_b32 v211, v3
    s_set_gpr_idx_off
    s_mov_b64 exec, vcc
    v_subrev_u32 v192, 48, v204
    v_mov_b32 v197, 163656
    v_cmp_gt_u32 vcc, 16, v192
    s_mov_b32 s62, 0
    s_mov_b64 exec, vcc
    s_cbranch_execz K2_OVN
K2_OP:
    ds_cmpst_rtn_b32 v200, v197, v198, v205
    s_cmp_ge_u32 s62, 2
    s_cselect_b32 s65, 2400, 0
    s_cselect_b32 s26, 32, 0
    s_sub_u32 s65, 161536, s65
    s_lshl_b32 s61, s62, 4
    s_sub_u32 s61, s61, s26
    v_mov_b32 v199, s65
    v_add_u32 v203, s61, v192
    s_waitcnt lgkmcnt(0)
    v_cmp_eq_u32 vcc, 0, v200
    v_cmp_eq_u32 s[56:57], v200, v205
    s_nop 0
    s_or_b64 vcc, vcc, s[56:57]
    s_andn2_b64 s[56:57], exec, vcc
    s_mov_b64 exec, vcc
    v_lshl_add_u32 v194, v203, 5, v199
    v_lshl_add_u32 v195, v203, 2, v199
    v_lshrrev_b32 v193, 3, v203
    v_mad_i32_i24 v196, v193, -16, v195
    v_and_b32 v193, 1, v193
    v_mad_i32_i24 v196, v193, -14, v196
    ds_write_b32 v194, v211 offset:864
    ds_write_b16 v195, v208 offset:194
    ds_write_b16_d16_hi v195, v208 offset:386
    ds_write_b16_d16_hi v195, v209 offset:578
    ds_write_b16 v196, v210 offset:768
    s_mov_b64 exec, s[56:57]
    s_cbranch_execz K2_OVN
    v_add_u32 v197, 4, v197
    s_add_u32 s62, s62, 1
    s_cmp_lt_u32 s62, s63
    s_cbranch_scc1 K2_OP
K2_OVN:
    s_cmp_lg_u32 s58, 0
    s_cbranch_scc1 K2_OVL
    s_mov_b64 exec, -1
    s_branch K2_OB
K2_BIG:
    s_cmp_lg_u32 s24, 0
    s_cbranch_scc1 K2_TOK
    s_mov_b64 s[62:63], vcc
    s_bcnt1_i32_b64 s60, vcc
    s_cmp_eq_u32 s22, 39
    s_cselect_b32 s61, 5, 2
    s_cmp_gt_u32 s60, s61
    s_cbranch_scc1 K2_SLOW
    v_cmp_lt_u32 vcc, 64, v193
    s_nop 0
    s_cbranch_vccnz K2_SLOW
    v_mov_b32 v197, 163656
    ds_read_b32 v203, v197
    ds_read_b32 v204, v197 offset:4
    ds_read_b32 v205, v197 offset:8
    ds_read_b32 v206, v197 offset:12
    ds_read_b32 v207, v197 offset:16
    v_and_b32 v197, 0x3ffff, v195
    s_movk_i32 s26, 64
    s_waitcnt lgkmcnt(0)
    v_cmp_eq_u32 vcc, v204, v197
    v_mov_b32 v194, 134217728
    s_nop 0
    v_cndmask_b32 v198, v198, v194, vcc
    v_cmp_eq_u32 vcc, v205, v197
    v_mov_b32 v194, 268435456
    s_nop 0
    v_cndmask_b32 v198, v198, v194, vcc
    v_cmp_eq_u32 vcc, v206, v197
    v_mov_b32 v194, 402653184
    s_nop 0
    v_cndmask_b32 v198, v198, v194, vcc
    v_cmp_eq_u32 vcc, v207, v197
    v_mov_b32 v194, 536870912
    s_nop 0
    v_cndmask_b32 v198, v198, v194, vcc
    s_branch K2_TOK
K2_SLOW:
    v_mov_b32 v197, v193
    s_nop 1
    v_max_u32_dpp v197, v197, v197 row_shr:1 row_mask:0xf bank_mask:0xf bound_ctrl:0
    s_nop 1
    v_max_u32_dpp v197, v197, v197 row_shr:2 row_mask:0xf bank_mask:0xf bound_ctrl:0
    s_nop 1
    v_max_u32_dpp v197, v197, v197 row_shr:4 row_mask:0xf bank_mask:0xf bound_ctrl:0
    s_nop 1
    v_max_u32_dpp v197, v197, v197 row_shr:8 row_mask:0xf bank_mask:0xf bound_ctrl:0
    s_nop 1
    v_max_u32_dpp v197, v197, v197 row_bcast:15 row_mask:0xa bank_mask:0xf
    s_nop 1
    v_max_u32_dpp v197, v197, v197 row_bcast:31 row_mask:0xc bank_mask:0xf
    s_nop 0
    v_readlane_b32 s25, v197, 63
    s_nop 0
    s_add_u32 s25, s25, 47
    s_mul_i32 s25, s25, 43691
    s_lshr_b32 s25, s25, 21
    s_mov_b64 exec, s[40:41]
    s_cbranch_execz K2_SV_DONE
    buffer_store_dword v40, v179, s[8:11], s66 offen offset:0
    s_mov_b64 exec, s[42:43]
    s_cbranch_execz K2_SV_DONE
    buffer_store_dword v41, v179, s[8:11], s66 offen offset:8
    s_mov_b64 exec, s[44:45]
    s_cbranch_execz K2_SV_DONE
    buffer_store_dword v42, v179, s[8:11], s66 offen offset:16
    s_mov_b64 exec, s[46:47]
    s_cbranch_execz K2_SV_DONE
    buffer_store_dword v43, v183, s[8:11], s66 offen
    s_mov_b64 exec, s[48:49]
    s_cbranch_execz K2_SV_DONE
    buffer_store_dword v44, v179, s[8:11], s66 offen offset:32
    s_mov_b64 exec, s[50:51]
    s_cbranch_execz K2_SV_DONE
    buffer_store_dword v45, v179, s[8:11], s66 offen offset:40
    s_mov_b64 exec, s[90:91]
    s_cbranch_execz K2_SV_DONE
    buffer_store_dword v46, v179, s[8:11], s66 offen offset:48
    s_mov_b64 exec, s[92:93]
    s_cbranch_execz K2_SV_DONE
    buffer_store_dword v47, v179, s[8:11], s66 offen offset:56
    s_mov_b64 exec, s[94:95]
    s_cbranch_execz K2_SV_DONE
    buffer_store_dword v48, v179, s[8:11], s66 offen offset:64
    s_mov_b64 exec, s[96:97]
    s_cbranch_execz K2_SV_DONE
    buffer_store_dword v49, v179, s[8:11], s66 offen offset:72
K2_SV_DONE:
    s_mov_b64 exec, -1
    s_branch K2_TOK
K2_rare_1:
    s_cmp_eq_u32 s33, 4
    s_cbranch_scc1 K2_four_3
    s_mov_b32 s49, s48
    s_mov_b32 s51, s48
    s_add_u32 s45, s44, 256
    s_add_u32 s46, s44, 512
    s_add_u32 s47, s44, 768
    s_branch K2_back_2
K2_four_3:
    s_add_u32 s50, s48, 64
    s_lshr_b32 s51, s3, 27
    s_mov_b32 s66, 161536
    s_cmp_ge_u32 s51, 2
    s_cselect_b32 s66, 159072, s66
    s_mul_i32 s51, s51, 32
    s_add_u32 s51, s51, s66
    s_mov_b32 s46, s44
    s_mov_b32 s47, s44
    s_branch K2_back_2
K2_a4_5:
    s_lshr_b32 s65, s3, 27
    s_mov_b32 s66, 161536
    s_cmp_ge_u32 s65, 2
    s_cselect_b32 s66, 158112, s66
    s_mul_i32 s65, s65, 512
    s_add_u32 s65, s65, s66
    v_add_u32 v232, s65, v230
    ds_read_b32 v232, v232
    s_add_u32 m0, s65, 864
    s_waitcnt lgkmcnt(0)
    v_or_b32 v232, v232, v231
    buffer_load_dwordx4 v232, s[16:19], 0 offen  lds
    s_branch K2_b4_7
K2_rare_14:
    s_cmp_eq_u32 s33, 4
    s_cbranch_scc1 K2_four_16
    s_mov_b32 s49, s48
    s_mov_b32 s51, s48
    s_add_u32 s45, s44, 256
    s_add_u32 s46, s44, 512
    s_add_u32 s47, s44, 768
    s_branch K2_back_15
K2_four_16:
    s_add_u32 s50, s48, 64
    s_lshr_b32 s51, s3, 27
    s_mov_b32 s66, 161536
    s_cmp_ge_u32 s51, 2
    s_cselect_b32 s66, 159072, s66
    s_mul_i32 s51, s51, 32
    s_add_u32 s51, s51, s66
    s_mov_b32 s46, s44
    s_mov_b32 s47, s44
    s_branch K2_back_15
K2_a4_18:
    s_lshr_b32 s65, s3, 27
    s_mov_b32 s66, 161536
    s_cmp_ge_u32 s65, 2
    s_cselect_b32 s66, 158112, s66
    s_mul_i32 s65, s65, 512
    s_add_u32 s65, s65, s66
    v_add_u32 v232, s65, v230
    ds_read_b32 v232, v232
    s_add_u32 m0, s65, 864
    s_waitcnt lgkmcnt(0)
    v_or_b32 v232, v232, v231
    buffer_load_dwordx4 v232, s[16:19], 0 offen  lds
    s_branch K2_b4_20
K2_rare_27:
    s_cmp_eq_u32 s33, 4
    s_cbranch_scc1 K2_four_29
    s_mov_b32 s49, s48
    s_mov_b32 s51, s48
    s_add_u32 s45, s44, 256
    s_add_u32 s46, s44, 512
    s_add_u32 s47, s44, 768
    s_branch K2_back_28
K2_four_29:
    s_add_u32 s50, s48, 64
    s_lshr_b32 s51, s3, 27
    s_mov_b32 s66, 161536
    s_cmp_ge_u32 s51, 2
    s_cselect_b32 s66, 159072, s66
    s_mul_i32 s51, s51, 32
    s_add_u32 s51, s51, s66
    s_mov_b32 s46, s44
    s_mov_b32 s47, s44
    s_branch K2_back_28
K2_a4_31:
    s_lshr_b32 s65, s3, 27
    s_mov_b32 s66, 161536
    s_cmp_ge_u32 s65, 2
    s_cselect_b32 s66, 158112, s66
    s_mul_i32 s65, s65, 512
    s_add_u32 s65, s65, s66
    v_add_u32 v232, s65, v230
    ds_read_b32 v232, v232
    s_add_u32 m0, s65, 864
    s_waitcnt lgkmcnt(0)
    v_or_b32 v232, v232, v231
    buffer_load_dwordx4 v232, s[16:19], 0 offen  lds
    s_branch K2_b4_33
K2_rare_38:
    s_cmp_eq_u32 s33, 4
    s_cbranch_scc1 K2_four_40
    s_mov_b32 s49, s48
    s_mov_b32 s51, s48
    s_add_u32 s45, s44, 256
    s_add_u32 s46, s44, 512
    s_add_u32 s47, s44, 768
    s_branch K2_back_39
K2_four_40:
    s_add_u32 s50, s48, 64
    s_lshr_b32 s51, s3, 27
    s_mov_b32 s66, 161536
    s_cmp_ge_u32 s51, 2
    s_cselect_b32 s66, 159072, s66
    s_mul_i32 s51, s51, 32
    s_add_u32 s51, s51, s66
    s_mov_b32 s46, s44
    s_mov_b32 s47, s44
    s_branch K2_back_39
K2_rare_45:
    s_cmp_eq_u32 s33, 4
    s_cbranch_scc1 K2_four_47
    s_mov_b32 s49, s48
    s_mov_b32 s51, s48
    s_add_u32 s45, s44, 256
    s_add_u32 s46, s44, 512
    s_add_u32 s47, s44, 768
    s_branch K2_back_46
K2_four_47:
    s_add_u32 s50, s48, 64
    s_lshr_b32 s51, s3, 27
    s_mov_b32 s66, 161536
    s_cmp_ge_u32 s51, 2
    s_cselect_b32 s66, 159072, s66
    s_mul_i32 s51, s51, 32
    s_add_u32 s51, s51, s66
    s_mov_b32 s46, s44
    s_mov_b32 s47, s44
    s_branch K2_back_46
K2_U10:
    s_setprio 1
    s_add_u32 s38, s38, 1
    v_mov_b32 v254, s52
    v_mov_b32 v255, s38
    s_lshl_b32 s58, s38, 3
    s_add_u32 s58, s58, s20
    s_mov_b64 exec, 1
    ds_write_b32 v254, v255
    s_mov_b64 exec, -1
    s_cmp_lt_u32 s58, s22
    s_cbranch_scc0 K2_dyn_48
K2_back_49:
    s_waitcnt lgkmcnt(7)
    v_lshlrev_b32 v40, 16, v0
    v_and_b32 v41, 0xffff0000, v0
    v_lshlrev_b32 v42, 16, v1
    v_and_b32 v43, 0xffff0000, v1
    v_lshlrev_b32 v44, 16, v2
    v_and_b32 v45, 0xffff0000, v2
    v_lshlrev_b32 v46, 16, v3
    v_and_b32 v47, 0xffff0000, v3
    v_mul_f32 v4, v40, v4
    v_mul_f32 v5, v41, v5
    v_mul_f32 v6, v42, v6
    v_mul_f32 v7, v43, v7
    v_mul_f32 v8, v44, v8
    v_mul_f32 v9, v45, v9
    v_mul_f32 v10, v46, v10
    v_mul_f32 v11, v47, v11
    v_cvt_pk_bf16_f32 v64, v4, v5
    v_cvt_pk_bf16_f32 v65, v6, v7
    v_cvt_pk_bf16_f32 v66, v8, v9
    v_cvt_pk_bf16_f32 v67, v10, v11
    v_mul_f32 v12, v40, v12
    v_mul_f32 v13, v41, v13
    v_mul_f32 v14, v42, v14
    v_mul_f32 v15, v43, v15
    v_mul_f32 v16, v44, v16
    v_mul_f32 v17, v45, v17
    v_mul_f32 v18, v46, v18
    v_mul_f32 v19, v47, v19
    v_cvt_pk_bf16_f32 v68, v12, v13
    v_cvt_pk_bf16_f32 v69, v14, v15
    v_cvt_pk_bf16_f32 v70, v16, v17
    v_cvt_pk_bf16_f32 v71, v18, v19
    v_readlane_b32 s3, v253, s58
    s_lshl_b32 s44, s34, 7
    s_lshl_b32 s60, s58, 5
    s_and_b32 s48, s3, 0x3ffff
    s_bfe_u32 s33, s3, 0x30012
    s_sub_u32 s60, s60, s48
    s_and_b32 s60, s60, 0xff
    s_add_u32 s60, s60, s48
    s_mul_i32 s35, s38, 6
    s_cmp_eq_u32 s34, 0
    s_cselect_b32 s35, s35, s60
    s_mov_b32 s45, s44
    s_add_u32 s47, s44, 256
    s_add_u32 s49, s48, 32
    s_add_u32 s60, s48, 64
    s_cmp_eq_u32 s33, 3
    s_cselect_b32 s46, s44, s47
    s_cselect_b32 s50, s60, s48
    s_cselect_b32 s51, s48, s49
    s_sub_u32 s60, s33, 2
    s_cmp_lt_u32 s60, 2
    s_cbranch_scc0 K2_rare_54
K2_back_55:
    v_add_u32 v233, s48, v230
    ds_read_b32 v232, v233
    ds_read_b32 v233, v233 offset:1024
    v_add_u32 v222, s48, v251
    ds_read_b32 v222, v222
    v_add_u32 v224, s49, v251
    ds_read_b32 v224, v224
    v_add_u32 v226, s50, v251
    ds_read_b32 v226, v226
    v_add_u32 v228, s51, v251
    ds_read_b32 v228, v228
    s_waitcnt lgkmcnt(4)
    v_or_b32 v232, v232, v231
    v_or_b32 v233, v233, v231
    s_cmp_lg_u32 s34, 0
    s_cbranch_scc1 K2_dum_57
    s_add_u32 m0, s48, 864
    s_add_u32 s65, s48, 1888
    buffer_load_dwordx4 v232, s[16:19], 0 offen  lds
    s_mov_b32 m0, s65
    s_mov_b32 exec_hi, 0
    buffer_load_dwordx4 v233, s[16:19], 0 offen  lds
    s_cmp_eq_u32 s33, 4
    s_cbranch_scc1 K2_a4_58
K2_b4_60:
    s_mov_b32 exec_hi, -1
K2_back_59:
    s_waitcnt lgkmcnt(3)
    v_mad_u32_u16 v223, v222, s39, v248 op_sel:[1,0,0,0]
    v_mad_u32_u16 v222, v222, s39, v248
    s_waitcnt lgkmcnt(2)
    v_mad_u32_u16 v225, v224, s39, v248 op_sel:[1,0,0,0]
    v_mad_u32_u16 v224, v224, s39, v248
    s_waitcnt lgkmcnt(1)
    v_mad_u32_u16 v227, v226, s39, v248 op_sel:[1,0,0,0]
    v_mad_u32_u16 v226, v226, s39, v248
    s_waitcnt lgkmcnt(0)
    v_mad_u32_u16 v229, v228, s39, v248 op_sel:[1,0,0,0]
    v_mad_u32_u16 v228, v228, s39, v248
    s_waitcnt vmcnt(6)
    v_mfma_f32_32x32x16_bf16 v[0:15], v[64:67], v[176:179], 0
    ds_read_b64_tr_b16 v[184:185], v246 offset:2048
    ds_read_b64_tr_b16 v[186:187], v246 offset:2560
    ds_read_b64_tr_b16 v[188:189], v247 offset:2048
    ds_read_b64_tr_b16 v[190:191], v247 offset:2560
    s_mov_b32 m0, s68
    v_mfma_f32_32x32x16_bf16 v[16:31], v[68:71], v[176:179], 0
    buffer_load_dwordx4 v222, s[4:7], s44 offen sc1 lds
    buffer_load_dwordx4 v223, s[72:75], s44 offen offset:1024 sc1 lds
    v_permlane32_swap_b32 v242, v236
    v_permlane32_swap_b32 v243, v237
    v_mfma_f32_32x32x16_bf16 v[32:47], v[64:67], v[180:183], 0
    v_permlane32_swap_b32 v244, v238
    v_permlane32_swap_b32 v245, v239
    v_permlane32_swap_b32 v240, v241
    v_add_f32 v242, v242, v236
    v_mfma_f32_32x32x16_bf16 v[48:63], v[68:71], v[180:183], 0
    s_setprio 0
    v_add_f32 v243, v243, v237
    v_add_f32 v244, v244, v238
    v_add_f32 v245, v245, v239
    v_add_f32 v240, -v240, -v241
    s_set_gpr_idx_on s32, gpr_idx(DST)
    s_nop 0
    v_cvt_pk_bf16_f32 v195, v242, v243
    v_cvt_pk_bf16_f32 v196, v244, v245
    v_cvt_pk_bf16_f32 v197, v240, v240
    s_set_gpr_idx_off
    v_mul_f32 v234, v0, v96
    v_mul_f32 v236, v8, v128
    v_fmac_f32 v234, v1, v97
    v_fmac_f32 v236, v9, v129
    v_fmac_f32 v234, v2, v98
    v_fmac_f32 v236, v10, v130
    v_fmac_f32 v234, v3, v99
    v_fmac_f32 v236, v11, v131
    v_fmac_f32 v234, v4, v100
    v_fmac_f32 v236, v12, v132
    v_fmac_f32 v234, v5, v101
    v_fmac_f32 v236, v13, v133
    v_fmac_f32 v234, v6, v102
    v_fmac_f32 v236, v14, v134
    v_fmac_f32 v234, v7, v103
    v_fmac_f32 v236, v15, v135
    v_mul_f32 v238, v16, v128
    v_mul_f32 v240, v24, v128
    v_fmac_f32 v238, v17, v129
    v_fmac_f32 v240, v25, v129
    v_fmac_f32 v238, v18, v130
    v_fmac_f32 v240, v26, v130
    v_fmac_f32 v238, v19, v131
    v_fmac_f32 v240, v27, v131
    v_fmac_f32 v238, v20, v132
    v_fmac_f32 v240, v28, v132
    v_fmac_f32 v238, v21, v133
    v_fmac_f32 v240, v29, v133
    v_fmac_f32 v238, v22, v134
    v_fmac_f32 v240, v30, v134
    v_fmac_f32 v238, v23, v135
    v_fmac_f32 v240, v31, v135
    v_mul_f32 v235, v32, v104
    v_mul_f32 v237, v40, v136
    v_fmac_f32 v235, v33, v105
    v_fmac_f32 v237, v41, v137
    v_fmac_f32 v235, v34, v106
    v_fmac_f32 v237, v42, v138
    v_fmac_f32 v235, v35, v107
    v_fmac_f32 v237, v43, v139
    v_fmac_f32 v235, v36, v108
    v_fmac_f32 v237, v44, v140
    v_fmac_f32 v235, v37, v109
    v_fmac_f32 v237, v45, v141
    v_fmac_f32 v235, v38, v110
    v_fmac_f32 v237, v46, v142
    v_fmac_f32 v235, v39, v111
    v_fmac_f32 v237, v47, v143
    v_mul_f32 v239, v48, v136
    v_mul_f32 v241, v56, v136
    v_fmac_f32 v239, v49, v137
    v_fmac_f32 v241, v57, v137
    v_fmac_f32 v239, v50, v138
    v_fmac_f32 v241, v58, v138
    v_fmac_f32 v239, v51, v139
    v_fmac_f32 v241, v59, v139
    v_fmac_f32 v239, v52, v140
    v_fmac_f32 v241, v60, v140
    v_fmac_f32 v239, v53, v141
    v_fmac_f32 v241, v61, v141
    v_fmac_f32 v239, v54, v142
    v_fmac_f32 v241, v62, v142
    v_fmac_f32 v239, v55, v143
    v_fmac_f32 v241, v63, v143
    s_setprio 1
    s_waitcnt vmcnt(6) lgkmcnt(0)
    v_mfma_f32_32x32x16_bf16 v[0:15], v[64:67], v[184:187], 0
    ds_read_b64_tr_b16 v[176:177], v246 offset:4096
    ds_read_b64_tr_b16 v[178:179], v246 offset:4608
    ds_read_b64_tr_b16 v[180:181], v247 offset:4096
    ds_read_b64_tr_b16 v[182:183], v247 offset:4608
    s_mov_b32 m0, s69
    v_mfma_f32_32x32x16_bf16 v[16:31], v[68:71], v[184:187], 0
    buffer_load_dwordx4 v224, s[4:7], s45 offen sc1 lds
    buffer_load_dwordx4 v225, s[72:75], s45 offen offset:1024 sc1 lds
    v_permlane32_swap_b32 v234, v236
    v_permlane32_swap_b32 v235, v237
    v_mfma_f32_32x32x16_bf16 v[32:47], v[64:67], v[188:191], 0
    v_permlane32_swap_b32 v240, v238
    v_permlane32_swap_b32 v241, v239
    v_add_f32 v234, v234, v236
    v_add_f32 v235, v235, v237
    v_add_f32 v240, v240, v238
    v_mfma_f32_32x32x16_bf16 v[48:63], v[68:71], v[188:191], 0
    s_setprio 0
    v_add_f32 v241, v241, v239
    s_set_gpr_idx_on s31, gpr_idx(DST)
    s_nop 0
    v_cvt_pk_bf16_f32 v192, v234, v235
    v_cvt_pk_bf16_f32 v193, v240, v241
    s_set_gpr_idx_off
    v_mul_f32 v234, v0, v144
    v_mul_f32 v236, v8, v112
    v_fmac_f32 v234, v1, v145
    v_fmac_f32 v236, v9, v113
    v_fmac_f32 v234, v2, v146
    v_fmac_f32 v236, v10, v114
    v_fmac_f32 v234, v3, v147
    v_fmac_f32 v236, v11, v115
    v_fmac_f32 v234, v4, v148
    v_fmac_f32 v236, v12, v116
    v_fmac_f32 v234, v5, v149
    v_fmac_f32 v236, v13, v117
    v_fmac_f32 v234, v6, v150
    v_fmac_f32 v236, v14, v118
    v_fmac_f32 v234, v7, v151
    v_fmac_f32 v236, v15, v119
    v_mul_f32 v238, v16, v160
    v_mul_f32 v240, v24, v160
    v_fmac_f32 v238, v17, v161
    v_fmac_f32 v240, v25, v161
    v_fmac_f32 v238, v18, v162
    v_fmac_f32 v240, v26, v162
    v_fmac_f32 v238, v19, v163
    v_fmac_f32 v240, v27, v163
    v_fmac_f32 v238, v20, v164
    v_fmac_f32 v240, v28, v164
    v_fmac_f32 v238, v21, v165
    v_fmac_f32 v240, v29, v165
    v_fmac_f32 v238, v22, v166
    v_fmac_f32 v240, v30, v166
    v_fmac_f32 v238, v23, v167
    v_fmac_f32 v240, v31, v167
    v_mul_f32 v235, v32, v152
    v_mul_f32 v237, v40, v120
    v_fmac_f32 v235, v33, v153
    v_fmac_f32 v237, v41, v121
    v_fmac_f32 v235, v34, v154
    v_fmac_f32 v237, v42, v122
    v_fmac_f32 v235, v35, v155
    v_fmac_f32 v237, v43, v123
    v_fmac_f32 v235, v36, v156
    v_fmac_f32 v237, v44, v124
    v_fmac_f32 v235, v37, v157
    v_fmac_f32 v237, v45, v125
    v_fmac_f32 v235, v38, v158
    v_fmac_f32 v237, v46, v126
    v_fmac_f32 v235, v39, v159
    v_fmac_f32 v237, v47, v127
    v_mul_f32 v239, v48, v168
    v_mul_f32 v241, v56, v168
    v_fmac_f32 v239, v49, v169
    v_fmac_f32 v241, v57, v169
    v_fmac_f32 v239, v50, v170
    v_fmac_f32 v241, v58, v170
    v_fmac_f32 v239, v51, v171
    v_fmac_f32 v241, v59, v171
    v_fmac_f32 v239, v52, v172
    v_fmac_f32 v241, v60, v172
    v_fmac_f32 v239, v53, v173
    v_fmac_f32 v241, v61, v173
    v_fmac_f32 v239, v54, v174
    v_fmac_f32 v241, v62, v174
    v_fmac_f32 v239, v55, v175
    v_fmac_f32 v241, v63, v175
    s_setprio 1
    s_waitcnt vmcnt(6) lgkmcnt(0)
    v_mfma_f32_32x32x16_bf16 v[0:15], v[64:67], v[176:179], 0
    ds_read_b64_tr_b16 v[184:185], v246 offset:6144
    ds_read_b64_tr_b16 v[186:187], v246 offset:6656
    ds_read_b64_tr_b16 v[188:189], v247 offset:6144
    ds_read_b64_tr_b16 v[190:191], v247 offset:6656
    s_mov_b32 m0, s70
    v_mfma_f32_32x32x16_bf16 v[16:31], v[68:71], v[176:179], 0
    buffer_load_dwordx4 v226, s[4:7], s46 offen sc1 lds
    buffer_load_dwordx4 v227, s[72:75], s46 offen offset:1024 sc1 lds
    s_sub_u32 s26, s48, s29
    s_mov_b32 s29, s48
    s_mov_b32 s30, s3
    s_cmp_eq_u32 s34, 0
    s_cselect_b32 s56, s33, 0
    v_mfma_f32_32x32x16_bf16 v[32:47], v[64:67], v[180:183], 0
    v_mfma_f32_32x32x16_bf16 v[48:63], v[68:71], v[180:183], 0
    s_setprio 0
    v_mul_f32 v242, v0, v144
    v_fma_f32 v238, v8, v160, -v238
    v_fmac_f32 v242, v1, v145
    v_fmac_f32 v238, v9, v161
    v_fmac_f32 v242, v2, v146
    v_fmac_f32 v238, v10, v162
    v_fmac_f32 v242, v3, v147
    v_fmac_f32 v238, v11, v163
    v_fmac_f32 v242, v4, v148
    v_fmac_f32 v238, v12, v164
    v_fmac_f32 v242, v5, v149
    v_fmac_f32 v238, v13, v165
    v_fmac_f32 v242, v6, v150
    v_fmac_f32 v238, v14, v166
    v_fmac_f32 v242, v7, v151
    v_fmac_f32 v238, v15, v167
    v_fmac_f32 v236, v16, v112
    v_mul_f32 v244, v24, v160
    v_fmac_f32 v236, v17, v113
    v_fmac_f32 v244, v25, v161
    v_fmac_f32 v236, v18, v114
    v_fmac_f32 v244, v26, v162
    v_fmac_f32 v236, v19, v115
    v_fmac_f32 v244, v27, v163
    v_fmac_f32 v236, v20, v116
    v_fmac_f32 v244, v28, v164
    v_fmac_f32 v236, v21, v117
    v_fmac_f32 v244, v29, v165
    v_fmac_f32 v236, v22, v118
    v_fmac_f32 v244, v30, v166
    v_fmac_f32 v236, v23, v119
    v_fmac_f32 v244, v31, v167
    v_mul_f32 v243, v32, v152
    v_fma_f32 v239, v40, v168, -v239
    v_fmac_f32 v243, v33, v153
    v_fmac_f32 v239, v41, v169
    v_fmac_f32 v243, v34, v154
    v_fmac_f32 v239, v42, v170
    v_fmac_f32 v243, v35, v155
    v_fmac_f32 v239, v43, v171
    v_fmac_f32 v243, v36, v156
    v_fmac_f32 v239, v44, v172
    v_fmac_f32 v243, v37, v157
    v_fmac_f32 v239, v45, v173
    v_fmac_f32 v243, v38, v158
    v_fmac_f32 v239, v46, v174
    v_fmac_f32 v243, v39, v159
    v_fmac_f32 v239, v47, v175
    v_fmac_f32 v237, v48, v120
    v_mul_f32 v245, v56, v168
    v_fmac_f32 v237, v49, v121
    v_fmac_f32 v245, v57, v169
    v_fmac_f32 v237, v50, v122
    v_fmac_f32 v245, v58, v170
    v_fmac_f32 v237, v51, v123
    v_fmac_f32 v245, v59, v171
    v_fmac_f32 v237, v52, v124
    v_fmac_f32 v245, v60, v172
    v_fmac_f32 v237, v53, v125
    v_fmac_f32 v245, v61, v173
    v_fmac_f32 v237, v54, v126
    v_fmac_f32 v245, v62, v174
    v_fmac_f32 v237, v55, v127
    v_fmac_f32 v245, v63, v175
    s_setprio 1
    s_waitcnt vmcnt(4) lgkmcnt(0)
    v_mfma_f32_32x32x16_bf16 v[0:15], v[64:67], v[184:187], 0
    ds_read_b64_tr_b16 v[176:177], v246 offset:0
    ds_read_b64_tr_b16 v[178:179], v246 offset:512
    ds_read_b64_tr_b16 v[180:181], v247 offset:0
    ds_read_b64_tr_b16 v[182:183], v247 offset:512
    s_mov_b32 m0, s71
    v_mfma_f32_32x32x16_bf16 v[16:31], v[68:71], v[184:187], 0
    buffer_load_dwordx4 v228, s[4:7], s47 offen sc1 lds
    buffer_load_dwordx4 v229, s[72:75], s47 offen offset:1024 sc1 lds
    v_permlane32_swap_b32 v242, v234
    v_permlane32_swap_b32 v243, v235
    v_add_f32 v242, v242, v234
    v_mfma_f32_32x32x16_bf16 v[32:47], v[64:67], v[188:191], 0
    v_add_f32 v243, v243, v235
    s_set_gpr_idx_on s31, gpr_idx(DST)
    s_nop 0
    v_cvt_pk_bf16_f32 v194, v242, v243
    s_set_gpr_idx_off
    s_mov_b32 s32, s31
    s_mov_b32 s31, s35
    v_mfma_f32_32x32x16_bf16 v[48:63], v[68:71], v[188:191], 0
    s_setprio 0
    v_mul_f32 v242, v0, v144
    v_fma_f32 v240, v8, v160, -v240
    v_fmac_f32 v242, v1, v145
    v_fmac_f32 v240, v9, v161
    v_fmac_f32 v242, v2, v146
    v_fmac_f32 v240, v10, v162
    v_fmac_f32 v242, v3, v147
    v_fmac_f32 v240, v11, v163
    v_fmac_f32 v242, v4, v148
    v_fmac_f32 v240, v12, v164
    v_fmac_f32 v242, v5, v149
    v_fmac_f32 v240, v13, v165
    v_fmac_f32 v242, v6, v150
    v_fmac_f32 v240, v14, v166
    v_fmac_f32 v242, v7, v151
    v_fmac_f32 v240, v15, v167
    v_add_u32 v249, s26, v249
    v_add_u32 v250, s26, v250
    v_fma_f32 v244, v16, v160, -v244
    v_fmac_f32 v236, v24, v112
    v_fmac_f32 v244, v17, v161
    v_fmac_f32 v236, v25, v113
    v_fmac_f32 v244, v18, v162
    v_fmac_f32 v236, v26, v114
    v_fmac_f32 v244, v19, v163
    v_fmac_f32 v236, v27, v115
    v_fmac_f32 v244, v20, v164
    v_fmac_f32 v236, v28, v116
    v_fmac_f32 v244, v21, v165
    v_fmac_f32 v236, v29, v117
    v_fmac_f32 v244, v22, v166
    v_fmac_f32 v236, v30, v118
    v_fmac_f32 v244, v23, v167
    v_fmac_f32 v236, v31, v119
    ds_read_b64_tr_b16 v[0:1], v249 offset:0
    ds_read_b64_tr_b16 v[2:3], v249 offset:128
    ds_read_b128 v[4:7], v250 offset:0
    ds_read_b128 v[8:11], v250 offset:16
    ds_read_b128 v[12:15], v250 offset:384
    ds_read_b128 v[16:19], v250 offset:400
    v_mul_f32 v243, v32, v152
    v_fma_f32 v241, v40, v168, -v241
    v_fmac_f32 v243, v33, v153
    v_fmac_f32 v241, v41, v169
    v_fmac_f32 v243, v34, v154
    v_fmac_f32 v241, v42, v170
    v_fmac_f32 v243, v35, v155
    v_fmac_f32 v241, v43, v171
    v_fmac_f32 v243, v36, v156
    v_fmac_f32 v241, v44, v172
    v_fmac_f32 v243, v37, v157
    v_fmac_f32 v241, v45, v173
    v_fmac_f32 v243, v38, v158
    v_fmac_f32 v241, v46, v174
    v_fmac_f32 v243, v39, v159
    v_fmac_f32 v241, v47, v175
    ds_read_b64_tr_b16 v[20:21], v249 offset:512
    ds_read_b64_tr_b16 v[22:23], v249 offset:640
    ds_read_b128 v[24:27], v250 offset:64
    ds_read_b128 v[28:31], v250 offset:80
    ds_read_b128 v[32:35], v250 offset:448
    ds_read_b128 v[36:39], v250 offset:464
    v_fma_f32 v245, v48, v168, -v245
    v_fmac_f32 v237, v56, v120
    v_fmac_f32 v245, v49, v169
    v_fmac_f32 v237, v57, v121
    v_fmac_f32 v245, v50, v170
    v_fmac_f32 v237, v58, v122
    v_fmac_f32 v245, v51, v171
    v_fmac_f32 v237, v59, v123
    v_fmac_f32 v245, v52, v172
    v_fmac_f32 v237, v60, v124
    v_fmac_f32 v245, v53, v173
    v_fmac_f32 v237, v61, v125
    v_fmac_f32 v245, v54, v174
    v_fmac_f32 v237, v62, v126
    v_fmac_f32 v245, v55, v175
    v_fmac_f32 v237, v63, v127
    s_cmp_eq_u32 s56, 2
    s_cbranch_scc1 K2_U20
    s_cmp_eq_u32 s56, 3
    s_cbranch_scc1 K2_U30
    s_branch K2_DSP0
K2_U40:
    s_setprio 1
    s_waitcnt lgkmcnt(6)
    v_lshlrev_b32 v40, 16, v0
    v_and_b32 v41, 0xffff0000, v0
    v_lshlrev_b32 v42, 16, v1
    v_and_b32 v43, 0xffff0000, v1
    v_lshlrev_b32 v44, 16, v2
    v_and_b32 v45, 0xffff0000, v2
    v_lshlrev_b32 v46, 16, v3
    v_and_b32 v47, 0xffff0000, v3
    v_mul_f32 v4, v40, v4
    v_mul_f32 v5, v41, v5
    v_mul_f32 v6, v42, v6
    v_mul_f32 v7, v43, v7
    v_mul_f32 v8, v44, v8
    v_mul_f32 v9, v45, v9
    v_mul_f32 v10, v46, v10
    v_mul_f32 v11, v47, v11
    v_cvt_pk_bf16_f32 v64, v4, v5
    v_cvt_pk_bf16_f32 v65, v6, v7
    v_cvt_pk_bf16_f32 v66, v8, v9
    v_cvt_pk_bf16_f32 v67, v10, v11
    v_mul_f32 v12, v40, v12
    v_mul_f32 v13, v41, v13
    v_mul_f32 v14, v42, v14
    v_mul_f32 v15, v43, v15
    v_mul_f32 v16, v44, v16
    v_mul_f32 v17, v45, v17
    v_mul_f32 v18, v46, v18
    v_mul_f32 v19, v47, v19
    v_cvt_pk_bf16_f32 v68, v12, v13
    v_cvt_pk_bf16_f32 v69, v14, v15
    v_cvt_pk_bf16_f32 v70, v16, v17
    v_cvt_pk_bf16_f32 v71, v18, v19
    ds_read_b64_tr_b16 v[0:1], v249 offset:1024
    ds_read_b64_tr_b16 v[2:3], v249 offset:1152
    ds_read_b128 v[4:7], v250 offset:128
    ds_read_b128 v[8:11], v250 offset:144
    ds_read_b128 v[12:15], v250 offset:512
    ds_read_b128 v[16:19], v250 offset:528
    s_waitcnt lgkmcnt(6)
    v_lshlrev_b32 v48, 16, v20
    v_and_b32 v49, 0xffff0000, v20
    v_lshlrev_b32 v50, 16, v21
    v_and_b32 v51, 0xffff0000, v21
    v_lshlrev_b32 v52, 16, v22
    v_and_b32 v53, 0xffff0000, v22
    v_lshlrev_b32 v54, 16, v23
    v_and_b32 v55, 0xffff0000, v23
    v_mul_f32 v24, v48, v24
    v_mul_f32 v25, v49, v25
    v_mul_f32 v26, v50, v26
    v_mul_f32 v27, v51, v27
    v_mul_f32 v28, v52, v28
    v_mul_f32 v29, v53, v29
    v_mul_f32 v30, v54, v30
    v_mul_f32 v31, v55, v31
    v_cvt_pk_bf16_f32 v72, v24, v25
    v_cvt_pk_bf16_f32 v73, v26, v27
    v_cvt_pk_bf16_f32 v74, v28, v29
    v_cvt_pk_bf16_f32 v75, v30, v31
    v_mul_f32 v32, v48, v32
    v_mul_f32 v33, v49, v33
    v_mul_f32 v34, v50, v34
    v_mul_f32 v35, v51, v35
    v_mul_f32 v36, v52, v36
    v_mul_f32 v37, v53, v37
    v_mul_f32 v38, v54, v38
    v_mul_f32 v39, v55, v39
    v_cvt_pk_bf16_f32 v76, v32, v33
    v_cvt_pk_bf16_f32 v77, v34, v35
    v_cvt_pk_bf16_f32 v78, v36, v37
    v_cvt_pk_bf16_f32 v79, v38, v39
    s_lshr_b32 s65, s30, 27
    s_mov_b32 s66, 161536
    s_cmp_ge_u32 s65, 2
    s_cselect_b32 s66, 158112, s66
    s_mul_i32 s65, s65, 512
    s_add_u32 s65, s65, s66
    s_sub_u32 s65, s65, s29
    v_add_u32 v56, s65, v249
    s_lshr_b32 s65, s30, 27
    s_mov_b32 s66, 161536
    s_cmp_ge_u32 s65, 2
    s_cselect_b32 s66, 159008, s66
    s_mul_i32 s65, s65, 64
    s_add_u32 s65, s65, s66
    s_sub_u32 s65, s65, s29
    v_add_u32 v57, s65, v250
    ds_read_b64_tr_b16 v[20:21], v56 offset:0
    ds_read_b64_tr_b16 v[22:23], v56 offset:128
    ds_read_b128 v[24:27], v57 offset:0
    ds_read_b128 v[28:31], v57 offset:16
    ds_read_b128 v[32:35], v57 offset:384
    ds_read_b128 v[36:39], v57 offset:400
    s_waitcnt lgkmcnt(10)
    v_lshlrev_b32 v40, 16, v0
    v_and_b32 v41, 0xffff0000, v0
    v_lshlrev_b32 v42, 16, v1
    v_and_b32 v43, 0xffff0000, v1
    v_lshlrev_b32 v44, 16, v2
    v_and_b32 v45, 0xffff0000, v2
    v_lshlrev_b32 v46, 16, v3
    v_and_b32 v47, 0xffff0000, v3
    s_waitcnt lgkmcnt(8)
    v_mul_f32 v4, v40, v4
    v_mul_f32 v5, v41, v5
    v_mul_f32 v6, v42, v6
    v_mul_f32 v7, v43, v7
    v_mul_f32 v8, v44, v8
    v_mul_f32 v9, v45, v9
    v_mul_f32 v10, v46, v10
    v_mul_f32 v11, v47, v11
    v_cvt_pk_bf16_f32 v80, v4, v5
    v_cvt_pk_bf16_f32 v81, v6, v7
    v_cvt_pk_bf16_f32 v82, v8, v9
    v_cvt_pk_bf16_f32 v83, v10, v11
    s_waitcnt lgkmcnt(6)
    v_mul_f32 v12, v40, v12
    v_mul_f32 v13, v41, v13
    v_mul_f32 v14, v42, v14
    v_mul_f32 v15, v43, v15
    v_mul_f32 v16, v44, v16
    v_mul_f32 v17, v45, v17
    v_mul_f32 v18, v46, v18
    v_mul_f32 v19, v47, v19
    v_cvt_pk_bf16_f32 v84, v12, v13
    v_cvt_pk_bf16_f32 v85, v14, v15
    v_cvt_pk_bf16_f32 v86, v16, v17
    v_cvt_pk_bf16_f32 v87, v18, v19
    s_waitcnt lgkmcnt(4)
    v_lshlrev_b32 v48, 16, v20
    v_and_b32 v49, 0xffff0000, v20
    v_lshlrev_b32 v50, 16, v21
    v_and_b32 v51, 0xffff0000, v21
    v_lshlrev_b32 v52, 16, v22
    v_and_b32 v53, 0xffff0000, v22
    v_lshlrev_b32 v54, 16, v23
    v_and_b32 v55, 0xffff0000, v23
    s_waitcnt lgkmcnt(2)
    v_mul_f32 v24, v48, v24
    v_mul_f32 v25, v49, v25
    v_mul_f32 v26, v50, v26
    v_mul_f32 v27, v51, v27
    v_mul_f32 v28, v52, v28
    v_mul_f32 v29, v53, v29
    v_mul_f32 v30, v54, v30
    v_mul_f32 v31, v55, v31
    v_cvt_pk_bf16_f32 v88, v24, v25
    v_cvt_pk_bf16_f32 v89, v26, v27
    v_cvt_pk_bf16_f32 v90, v28, v29
    v_cvt_pk_bf16_f32 v91, v30, v31
    s_waitcnt lgkmcnt(0)
    v_mul_f32 v32, v48, v32
    v_mul_f32 v33, v49, v33
    v_mul_f32 v34, v50, v34
    v_mul_f32 v35, v51, v35
    v_mul_f32 v36, v52, v36
    v_mul_f32 v37, v53, v37
    v_mul_f32 v38, v54, v38
    v_mul_f32 v39, v55, v39
    v_cvt_pk_bf16_f32 v92, v32, v33
    v_cvt_pk_bf16_f32 v93, v34, v35
    v_cvt_pk_bf16_f32 v94, v36, v37
    v_cvt_pk_bf16_f32 v95, v38, v39
    s_waitcnt vmcnt(4)
    v_mfma_f32_32x32x16_bf16 v[0:15], v[64:67], v[176:179], 0
    ds_read_b64_tr_b16 v[184:185], v246 offset:2048
    ds_read_b64_tr_b16 v[186:187], v246 offset:2560
    ds_read_b64_tr_b16 v[188:189], v247 offset:2048
    ds_read_b64_tr_b16 v[190:191], v247 offset:2560
    s_mov_b32 m0, s68
    v_mfma_f32_32x32x16_bf16 v[16:31], v[68:71], v[176:179], 0
    buffer_load_dwordx4 v222, s[4:7], s41 offen sc1 lds
    buffer_load_dwordx4 v223, s[72:75], s41 offen offset:1024 sc1 lds
    v_permlane32_swap_b32 v242, v236
    v_permlane32_swap_b32 v243, v237
    s_add_u32 s38, s38, 1
    v_mfma_f32_32x32x16_bf16 v[32:47], v[64:67], v[180:183], 0
    v_permlane32_swap_b32 v244, v238
    v_permlane32_swap_b32 v245, v239
    v_permlane32_swap_b32 v240, v241
    v_add_f32 v242, v242, v236
    v_mfma_f32_32x32x16_bf16 v[48:63], v[68:71], v[180:183], 0
    v_add_f32 v243, v243, v237
    v_add_f32 v244, v244, v238
    v_add_f32 v245, v245, v239
    v_add_f32 v240, -v240, -v241
    v_mov_b32 v254, s52
    v_mov_b32 v255, s38
    s_waitcnt vmcnt(4) lgkmcnt(0)
    v_mfma_f32_32x32x16_bf16 v[0:15], v[72:75], v[184:187], v[0:15]
    ds_read_b64_tr_b16 v[176:177], v246 offset:4096
    ds_read_b64_tr_b16 v[178:179], v246 offset:4608
    ds_read_b64_tr_b16 v[180:181], v247 offset:4096
    ds_read_b64_tr_b16 v[182:183], v247 offset:4608
    s_lshl_b32 s58, s38, 3
    s_add_u32 s58, s58, s20
    s_mov_b32 m0, s69
    v_mfma_f32_32x32x16_bf16 v[16:31], v[76:79], v[184:187], v[16:31]
    buffer_load_dwordx4 v224, s[4:7], s41 offen sc1 lds
    buffer_load_dwordx4 v225, s[72:75], s41 offen offset:1024 sc1 lds
    s_set_gpr_idx_on s32, gpr_idx(DST)
    s_nop 0
    v_cvt_pk_bf16_f32 v195, v242, v243
    v_cvt_pk_bf16_f32 v196, v244, v245
    v_cvt_pk_bf16_f32 v197, v240, v240
    s_set_gpr_idx_off
    s_mov_b64 exec, 1
    ds_write_b32 v254, v255
    s_mov_b64 exec, -1
    s_cmp_lt_u32 s58, s22
    s_cbranch_scc0 K2_dyn_61
K2_back_62:
    v_readlane_b32 s3, v253, s58
    s_lshl_b32 s44, s34, 7
    s_lshl_b32 s60, s58, 5
    s_and_b32 s48, s3, 0x3ffff
    s_bfe_u32 s33, s3, 0x30012
    s_sub_u32 s60, s60, s48
    s_and_b32 s60, s60, 0xff
    s_add_u32 s60, s60, s48
    s_mul_i32 s35, s38, 6
    s_cmp_eq_u32 s34, 0
    s_cselect_b32 s35, s35, s60
    s_mov_b32 s45, s44
    s_add_u32 s47, s44, 256
    s_add_u32 s49, s48, 32
    s_add_u32 s60, s48, 64
    s_cmp_eq_u32 s33, 3
    s_cselect_b32 s46, s44, s47
    s_cselect_b32 s50, s60, s48
    s_cselect_b32 s51, s48, s49
    s_sub_u32 s60, s33, 2
    s_cmp_lt_u32 s60, 2
    s_cbranch_scc0 K2_rare_67
K2_back_68:
    v_mfma_f32_32x32x16_bf16 v[32:47], v[72:75], v[188:191], v[32:47]
    v_add_u32 v233, s48, v230
    ds_read_b32 v232, v233
    ds_read_b32 v233, v233 offset:1024
    v_mfma_f32_32x32x16_bf16 v[48:63], v[76:79], v[188:191], v[48:63]
    s_waitcnt vmcnt(4) lgkmcnt(3)
    v_mfma_f32_32x32x16_bf16 v[0:15], v[80:83], v[176:179], v[0:15]
    ds_read_b64_tr_b16 v[184:185], v246 offset:6144
    ds_read_b64_tr_b16 v[186:187], v246 offset:6656
    ds_read_b64_tr_b16 v[188:189], v247 offset:6144
    ds_read_b64_tr_b16 v[190:191], v247 offset:6656
    s_mov_b32 m0, s70
    v_mfma_f32_32x32x16_bf16 v[16:31], v[84:87], v[176:179], v[16:31]
    buffer_load_dwordx4 v226, s[4:7], s41 offen sc1 lds
    buffer_load_dwordx4 v227, s[72:75], s41 offen offset:1024 sc1 lds
    v_mfma_f32_32x32x16_bf16 v[32:47], v[80:83], v[180:183], v[32:47]
    v_mfma_f32_32x32x16_bf16 v[48:63], v[84:87], v[180:183], v[48:63]
    s_waitcnt lgkmcnt(4)
    v_or_b32 v232, v232, v231
    v_or_b32 v233, v233, v231
    s_cmp_lg_u32 s34, 0
    s_cbranch_scc1 K2_dum_70
    s_add_u32 m0, s48, 864
    s_add_u32 s65, s48, 1888
    buffer_load_dwordx4 v232, s[16:19], 0 offen  lds
    s_mov_b32 m0, s65
    s_mov_b32 exec_hi, 0
    buffer_load_dwordx4 v233, s[16:19], 0 offen  lds
    s_cmp_eq_u32 s33, 4
    s_cbranch_scc1 K2_a4_71
K2_b4_73:
    s_mov_b32 exec_hi, -1
K2_back_72:
    s_waitcnt vmcnt(6) lgkmcnt(0)
    v_mfma_f32_32x32x16_bf16 v[0:15], v[88:91], v[184:187], v[0:15]
    ds_read_b64_tr_b16 v[176:177], v246 offset:0
    ds_read_b64_tr_b16 v[178:179], v246 offset:512
    ds_read_b64_tr_b16 v[180:181], v247 offset:0
    ds_read_b64_tr_b16 v[182:183], v247 offset:512
    s_mov_b32 m0, s71
    v_mfma_f32_32x32x16_bf16 v[16:31], v[92:95], v[184:187], v[16:31]
    buffer_load_dwordx4 v228, s[4:7], s41 offen sc1 lds
    buffer_load_dwordx4 v229, s[72:75], s41 offen offset:1024 sc1 lds
    v_mfma_f32_32x32x16_bf16 v[32:47], v[88:91], v[188:191], v[32:47]
    s_nop 2
    v_mul_f32 v234, v0, v96
    v_mul_f32 v236, v8, v128
    v_fmac_f32 v234, v1, v97
    v_fmac_f32 v236, v9, v129
    v_fmac_f32 v234, v2, v98
    v_fmac_f32 v236, v10, v130
    v_fmac_f32 v234, v3, v99
    v_mfma_f32_32x32x16_bf16 v[48:63], v[92:95], v[188:191], v[48:63]
    s_setprio 0
    v_fmac_f32 v236, v11, v131
    v_fmac_f32 v234, v4, v100
    v_fmac_f32 v236, v12, v132
    v_fmac_f32 v234, v5, v101
    v_fmac_f32 v236, v13, v133
    v_fmac_f32 v234, v6, v102
    v_fmac_f32 v236, v14, v134
    v_fmac_f32 v234, v7, v103
    v_fmac_f32 v236, v15, v135
    v_mul_f32 v238, v16, v128
    v_mul_f32 v240, v24, v128
    v_fmac_f32 v238, v17, v129
    v_fmac_f32 v240, v25, v129
    v_fmac_f32 v238, v18, v130
    v_fmac_f32 v240, v26, v130
    v_fmac_f32 v238, v19, v131
    v_fmac_f32 v240, v27, v131
    v_fmac_f32 v238, v20, v132
    v_fmac_f32 v240, v28, v132
    v_fmac_f32 v238, v21, v133
    v_fmac_f32 v240, v29, v133
    v_fmac_f32 v238, v22, v134
    v_fmac_f32 v240, v30, v134
    v_fmac_f32 v238, v23, v135
    v_fmac_f32 v240, v31, v135
    v_mul_f32 v235, v32, v104
    v_mul_f32 v237, v40, v136
    v_fmac_f32 v235, v33, v105
    v_fmac_f32 v237, v41, v137
    v_fmac_f32 v235, v34, v106
    v_fmac_f32 v237, v42, v138
    v_fmac_f32 v235, v35, v107
    v_fmac_f32 v237, v43, v139
    v_fmac_f32 v235, v36, v108
    v_fmac_f32 v237, v44, v140
    v_fmac_f32 v235, v37, v109
    v_fmac_f32 v237, v45, v141
    v_fmac_f32 v235, v38, v110
    v_fmac_f32 v237, v46, v142
    v_fmac_f32 v235, v39, v111
    v_fmac_f32 v237, v47, v143
    v_mul_f32 v239, v48, v136
    v_mul_f32 v241, v56, v136
    s_setprio 1
    s_waitcnt vmcnt(6) lgkmcnt(0)
    v_mfma_f32_32x32x16_bf16 v[0:15], v[64:67], v[176:179], 0
    ds_read_b64_tr_b16 v[184:185], v246 offset:2048
    ds_read_b64_tr_b16 v[186:187], v246 offset:2560
    ds_read_b64_tr_b16 v[188:189], v247 offset:2048
    ds_read_b64_tr_b16 v[190:191], v247 offset:2560
    v_fmac_f32 v239, v49, v137
    v_fmac_f32 v241, v57, v137
    s_mov_b32 m0, s68
    v_mfma_f32_32x32x16_bf16 v[16:31], v[68:71], v[176:179], 0
    buffer_load_dwordx4 v222, s[4:7], s42 offen sc1 lds
    buffer_load_dwordx4 v223, s[72:75], s42 offen offset:1024 sc1 lds
    v_fmac_f32 v239, v50, v138
    v_fmac_f32 v241, v58, v138
    v_fmac_f32 v239, v51, v139
    v_fmac_f32 v241, v59, v139
    v_fmac_f32 v239, v52, v140
    v_mfma_f32_32x32x16_bf16 v[32:47], v[64:67], v[180:183], 0
    v_fmac_f32 v241, v60, v140
    v_fmac_f32 v239, v53, v141
    v_fmac_f32 v241, v61, v141
    v_fmac_f32 v239, v54, v142
    v_fmac_f32 v241, v62, v142
    v_fmac_f32 v239, v55, v143
    v_fmac_f32 v241, v63, v143
    v_mfma_f32_32x32x16_bf16 v[48:63], v[68:71], v[180:183], 0
    v_permlane32_swap_b32 v234, v236
    v_permlane32_swap_b32 v235, v237
    v_permlane32_swap_b32 v240, v238
    s_waitcnt vmcnt(6) lgkmcnt(0)
    v_mfma_f32_32x32x16_bf16 v[0:15], v[72:75], v[184:187], v[0:15]
    ds_read_b64_tr_b16 v[176:177], v246 offset:4096
    ds_read_b64_tr_b16 v[178:179], v246 offset:4608
    ds_read_b64_tr_b16 v[180:181], v247 offset:4096
    ds_read_b64_tr_b16 v[182:183], v247 offset:4608
    v_permlane32_swap_b32 v241, v239
    s_mov_b32 m0, s69
    v_mfma_f32_32x32x16_bf16 v[16:31], v[76:79], v[184:187], v[16:31]
    buffer_load_dwordx4 v224, s[4:7], s42 offen sc1 lds
    buffer_load_dwordx4 v225, s[72:75], s42 offen offset:1024 sc1 lds
    v_add_f32 v234, v234, v236
    v_add_f32 v235, v235, v237
    v_add_f32 v240, v240, v238
    v_add_f32 v241, v241, v239
    v_mfma_f32_32x32x16_bf16 v[32:47], v[72:75], v[188:191], v[32:47]
    s_set_gpr_idx_on s31, gpr_idx(DST)
    s_nop 0
    v_cvt_pk_bf16_f32 v192, v234, v235
    v_cvt_pk_bf16_f32 v193, v240, v241
    s_set_gpr_idx_off
    v_mfma_f32_32x32x16_bf16 v[48:63], v[76:79], v[188:191], v[48:63]
    s_waitcnt vmcnt(4) lgkmcnt(0)
    v_mfma_f32_32x32x16_bf16 v[0:15], v[80:83], v[176:179], v[0:15]
    ds_read_b64_tr_b16 v[184:185], v246 offset:6144
    ds_read_b64_tr_b16 v[186:187], v246 offset:6656
    ds_read_b64_tr_b16 v[188:189], v247 offset:6144
    ds_read_b64_tr_b16 v[190:191], v247 offset:6656
    s_mov_b32 m0, s70
    v_mfma_f32_32x32x16_bf16 v[16:31], v[84:87], v[176:179], v[16:31]
    buffer_load_dwordx4 v226, s[4:7], s42 offen sc1 lds
    buffer_load_dwordx4 v227, s[72:75], s42 offen offset:1024 sc1 lds
    v_mfma_f32_32x32x16_bf16 v[32:47], v[80:83], v[180:183], v[32:47]
    v_mfma_f32_32x32x16_bf16 v[48:63], v[84:87], v[180:183], v[48:63]
    s_waitcnt vmcnt(4) lgkmcnt(0)
    v_mfma_f32_32x32x16_bf16 v[0:15], v[88:91], v[184:187], v[0:15]
    ds_read_b64_tr_b16 v[176:177], v246 offset:0
    ds_read_b64_tr_b16 v[178:179], v246 offset:512
    ds_read_b64_tr_b16 v[180:181], v247 offset:0
    ds_read_b64_tr_b16 v[182:183], v247 offset:512
    s_mov_b32 m0, s71
    v_mfma_f32_32x32x16_bf16 v[16:31], v[92:95], v[184:187], v[16:31]
    buffer_load_dwordx4 v228, s[4:7], s42 offen sc1 lds
    buffer_load_dwordx4 v229, s[72:75], s42 offen offset:1024 sc1 lds
    v_mfma_f32_32x32x16_bf16 v[32:47], v[88:91], v[188:191], v[32:47]
    s_nop 2
    v_mul_f32 v234, v0, v144
    v_mul_f32 v236, v8, v112
    v_fmac_f32 v234, v1, v145
    v_fmac_f32 v236, v9, v113
    v_fmac_f32 v234, v2, v146
    v_fmac_f32 v236, v10, v114
    v_fmac_f32 v234, v3, v147
    v_mfma_f32_32x32x16_bf16 v[48:63], v[92:95], v[188:191], v[48:63]
    s_setprio 0
    v_fmac_f32 v236, v11, v115
    v_fmac_f32 v234, v4, v148
    v_fmac_f32 v236, v12, v116
    v_fmac_f32 v234, v5, v149
    v_fmac_f32 v236, v13, v117
    v_fmac_f32 v234, v6, v150
    v_fmac_f32 v236, v14, v118
    v_fmac_f32 v234, v7, v151
    v_fmac_f32 v236, v15, v119
    v_mul_f32 v238, v16, v160
    v_mul_f32 v240, v24, v160
    v_fmac_f32 v238, v17, v161
    v_fmac_f32 v240, v25, v161
    v_fmac_f32 v238, v18, v162
    v_fmac_f32 v240, v26, v162
    v_fmac_f32 v238, v19, v163
    v_fmac_f32 v240, v27, v163
    v_fmac_f32 v238, v20, v164
    v_fmac_f32 v240, v28, v164
    v_fmac_f32 v238, v21, v165
    v_fmac_f32 v240, v29, v165
    v_fmac_f32 v238, v22, v166
    v_fmac_f32 v240, v30, v166
    v_fmac_f32 v238, v23, v167
    v_fmac_f32 v240, v31, v167
    v_mul_f32 v235, v32, v152
    v_mul_f32 v237, v40, v120
    v_fmac_f32 v235, v33, v153
    v_fmac_f32 v237, v41, v121
    v_fmac_f32 v235, v34, v154
    v_fmac_f32 v237, v42, v122
    v_fmac_f32 v235, v35, v155
    v_fmac_f32 v237, v43, v123
    v_fmac_f32 v235, v36, v156
    v_fmac_f32 v237, v44, v124
    v_fmac_f32 v235, v37, v157
    v_fmac_f32 v237, v45, v125
    v_fmac_f32 v235, v38, v158
    v_fmac_f32 v237, v46, v126
    v_fmac_f32 v235, v39, v159
    v_fmac_f32 v237, v47, v127
    v_mul_f32 v239, v48, v168
    v_mul_f32 v241, v56, v168
    s_setprio 1
    s_waitcnt vmcnt(4) lgkmcnt(0)
    v_mfma_f32_32x32x16_bf16 v[0:15], v[64:67], v[176:179], 0
    ds_read_b64_tr_b16 v[184:185], v246 offset:2048
    ds_read_b64_tr_b16 v[186:187], v246 offset:2560
    ds_read_b64_tr_b16 v[188:189], v247 offset:2048
    ds_read_b64_tr_b16 v[190:191], v247 offset:2560
    v_fmac_f32 v239, v49, v169
    v_fmac_f32 v241, v57, v169
    s_mov_b32 m0, s68
    v_mfma_f32_32x32x16_bf16 v[16:31], v[68:71], v[176:179], 0
    buffer_load_dwordx4 v222, s[4:7], s43 offen sc1 lds
    buffer_load_dwordx4 v223, s[72:75], s43 offen offset:1024 sc1 lds
    v_fmac_f32 v239, v50, v170
    v_fmac_f32 v241, v58, v170
    v_fmac_f32 v239, v51, v171
    v_fmac_f32 v241, v59, v171
    v_fmac_f32 v239, v52, v172
    v_mfma_f32_32x32x16_bf16 v[32:47], v[64:67], v[180:183], 0
    v_fmac_f32 v241, v60, v172
    v_fmac_f32 v239, v53, v173
    v_fmac_f32 v241, v61, v173
    v_fmac_f32 v239, v54, v174
    v_fmac_f32 v241, v62, v174
    v_fmac_f32 v239, v55, v175
    v_fmac_f32 v241, v63, v175
    v_mfma_f32_32x32x16_bf16 v[48:63], v[68:71], v[180:183], 0
    s_waitcnt vmcnt(4) lgkmcnt(0)
    v_mfma_f32_32x32x16_bf16 v[0:15], v[72:75], v[184:187], v[0:15]
    ds_read_b64_tr_b16 v[176:177], v246 offset:4096
    ds_read_b64_tr_b16 v[178:179], v246 offset:4608
    ds_read_b64_tr_b16 v[180:181], v247 offset:4096
    ds_read_b64_tr_b16 v[182:183], v247 offset:4608
    s_mov_b32 m0, s69
    v_mfma_f32_32x32x16_bf16 v[16:31], v[76:79], v[184:187], v[16:31]
    buffer_load_dwordx4 v224, s[4:7], s43 offen sc1 lds
    buffer_load_dwordx4 v225, s[72:75], s43 offen offset:1024 sc1 lds
    v_mfma_f32_32x32x16_bf16 v[32:47], v[72:75], v[188:191], v[32:47]
    v_mfma_f32_32x32x16_bf16 v[48:63], v[76:79], v[188:191], v[48:63]
    s_waitcnt vmcnt(4) lgkmcnt(0)
    v_mfma_f32_32x32x16_bf16 v[0:15], v[80:83], v[176:179], v[0:15]
    ds_read_b64_tr_b16 v[184:185], v246 offset:6144
    ds_read_b64_tr_b16 v[186:187], v246 offset:6656
    ds_read_b64_tr_b16 v[188:189], v247 offset:6144
    ds_read_b64_tr_b16 v[190:191], v247 offset:6656
    s_mov_b32 m0, s70
    v_mfma_f32_32x32x16_bf16 v[16:31], v[84:87], v[176:179], v[16:31]
    buffer_load_dwordx4 v226, s[4:7], s43 offen sc1 lds
    buffer_load_dwordx4 v227, s[72:75], s43 offen offset:1024 sc1 lds
    v_mfma_f32_32x32x16_bf16 v[32:47], v[80:83], v[180:183], v[32:47]
    v_add_u32 v222, s48, v251
    ds_read_b32 v222, v222
    v_mfma_f32_32x32x16_bf16 v[48:63], v[84:87], v[180:183], v[48:63]
    s_waitcnt vmcnt(4) lgkmcnt(1)
    v_mfma_f32_32x32x16_bf16 v[0:15], v[88:91], v[184:187], v[0:15]
    ds_read_b64_tr_b16 v[176:177], v246 offset:0
    ds_read_b64_tr_b16 v[178:179], v246 offset:512
    ds_read_b64_tr_b16 v[180:181], v247 offset:0
    ds_read_b64_tr_b16 v[182:183], v247 offset:512
    s_mov_b32 m0, s71
    v_mfma_f32_32x32x16_bf16 v[16:31], v[92:95], v[184:187], v[16:31]
    buffer_load_dwordx4 v228, s[4:7], s43 offen sc1 lds
    buffer_load_dwordx4 v229, s[72:75], s43 offen offset:1024 sc1 lds
    s_waitcnt lgkmcnt(4)
    v_mad_u32_u16 v223, v222, s39, v248 op_sel:[1,0,0,0]
    v_mad_u32_u16 v222, v222, s39, v248
    v_mfma_f32_32x32x16_bf16 v[32:47], v[88:91], v[188:191], v[32:47]
    v_add_u32 v224, s49, v251
    ds_read_b32 v224, v224
    v_mul_f32 v242, v0, v144
    v_fma_f32 v238, v8, v160, -v238
    v_fmac_f32 v242, v1, v145
    v_fmac_f32 v238, v9, v161
    v_fmac_f32 v242, v2, v146
    v_mfma_f32_32x32x16_bf16 v[48:63], v[92:95], v[188:191], v[48:63]
    s_setprio 0
    v_fmac_f32 v238, v10, v162
    v_fmac_f32 v242, v3, v147
    v_fmac_f32 v238, v11, v163
    v_fmac_f32 v242, v4, v148
    v_fmac_f32 v238, v12, v164
    v_fmac_f32 v242, v5, v149
    v_fmac_f32 v238, v13, v165
    v_fmac_f32 v242, v6, v150
    v_fmac_f32 v238, v14, v166
    v_fmac_f32 v242, v7, v151
    v_fmac_f32 v238, v15, v167
    v_fmac_f32 v236, v16, v112
    v_mul_f32 v244, v24, v160
    v_fmac_f32 v236, v17, v113
    v_fmac_f32 v244, v25, v161
    v_fmac_f32 v236, v18, v114
    v_fmac_f32 v244, v26, v162
    v_fmac_f32 v236, v19, v115
    v_fmac_f32 v244, v27, v163
    v_fmac_f32 v236, v20, v116
    v_fmac_f32 v244, v28, v164
    v_fmac_f32 v236, v21, v117
    v_fmac_f32 v244, v29, v165
    v_fmac_f32 v236, v22, v118
    v_fmac_f32 v244, v30, v166
    v_fmac_f32 v236, v23, v119
    v_fmac_f32 v244, v31, v167
    v_mul_f32 v243, v32, v152
    v_fma_f32 v239, v40, v168, -v239
    v_fmac_f32 v243, v33, v153
    v_fmac_f32 v239, v41, v169
    v_fmac_f32 v243, v34, v154
    v_fmac_f32 v239, v42, v170
    v_fmac_f32 v243, v35, v155
    v_fmac_f32 v239, v43, v171
    v_fmac_f32 v243, v36, v156
    v_fmac_f32 v239, v44, v172
    v_fmac_f32 v243, v37, v157
    v_fmac_f32 v239, v45, v173
    v_fmac_f32 v243, v38, v158
    v_fmac_f32 v239, v46, v174
    v_fmac_f32 v243, v39, v159
    v_fmac_f32 v239, v47, v175
    v_fmac_f32 v237, v48, v120
    v_mul_f32 v245, v56, v168
    v_fmac_f32 v237, v49, v121
    v_fmac_f32 v245, v57, v169
    v_fmac_f32 v237, v50, v122
    v_fmac_f32 v245, v58, v170
    v_fmac_f32 v237, v51, v123
    s_setprio 1
    s_waitcnt vmcnt(4) lgkmcnt(1)
    v_mfma_f32_32x32x16_bf16 v[0:15], v[64:67], v[176:179], 0
    ds_read_b64_tr_b16 v[184:185], v246 offset:2048
    ds_read_b64_tr_b16 v[186:187], v246 offset:2560
    ds_read_b64_tr_b16 v[188:189], v247 offset:2048
    ds_read_b64_tr_b16 v[190:191], v247 offset:2560
    v_fmac_f32 v245, v59, v171
    v_fmac_f32 v237, v52, v124
    s_mov_b32 m0, s68
    v_mfma_f32_32x32x16_bf16 v[16:31], v[68:71], v[176:179], 0
    buffer_load_dwordx4 v222, s[4:7], s44 offen sc1 lds
    buffer_load_dwordx4 v223, s[72:75], s44 offen offset:1024 sc1 lds
    s_waitcnt lgkmcnt(4)
    v_mad_u32_u16 v225, v224, s39, v248 op_sel:[1,0,0,0]
    v_mad_u32_u16 v224, v224, s39, v248
    v_fmac_f32 v245, v60, v172
    v_fmac_f32 v237, v53, v125
    v_mfma_f32_32x32x16_bf16 v[32:47], v[64:67], v[180:183], 0
    v_add_u32 v226, s50, v251
    ds_read_b32 v226, v226
    v_fmac_f32 v245, v61, v173
    v_fmac_f32 v237, v54, v126
    v_fmac_f32 v245, v62, v174
    v_fmac_f32 v237, v55, v127
    v_fmac_f32 v245, v63, v175
    v_mfma_f32_32x32x16_bf16 v[48:63], v[68:71], v[180:183], 0
    v_permlane32_swap_b32 v242, v234
    v_permlane32_swap_b32 v243, v235
    v_add_f32 v242, v242, v234
    v_add_f32 v243, v243, v235
    s_waitcnt vmcnt(4) lgkmcnt(1)
    v_mfma_f32_32x32x16_bf16 v[0:15], v[72:75], v[184:187], v[0:15]
    ds_read_b64_tr_b16 v[176:177], v246 offset:4096
    ds_read_b64_tr_b16 v[178:179], v246 offset:4608
    ds_read_b64_tr_b16 v[180:181], v247 offset:4096
    ds_read_b64_tr_b16 v[182:183], v247 offset:4608
    s_mov_b32 m0, s69
    v_mfma_f32_32x32x16_bf16 v[16:31], v[76:79], v[184:187], v[16:31]
    buffer_load_dwordx4 v224, s[4:7], s45 offen sc1 lds
    buffer_load_dwordx4 v225, s[72:75], s45 offen offset:1024 sc1 lds
    s_waitcnt lgkmcnt(4)
    v_mad_u32_u16 v227, v226, s39, v248 op_sel:[1,0,0,0]
    v_mad_u32_u16 v226, v226, s39, v248
    v_mfma_f32_32x32x16_bf16 v[32:47], v[72:75], v[188:191], v[32:47]
    v_add_u32 v228, s51, v251
    ds_read_b32 v228, v228
    s_set_gpr_idx_on s31, gpr_idx(DST)
    s_nop 0
    v_cvt_pk_bf16_f32 v194, v242, v243
    s_set_gpr_idx_off
    v_mfma_f32_32x32x16_bf16 v[48:63], v[76:79], v[188:191], v[48:63]
    s_waitcnt vmcnt(4) lgkmcnt(1)
    v_mfma_f32_32x32x16_bf16 v[0:15], v[80:83], v[176:179], v[0:15]
    ds_read_b64_tr_b16 v[184:185], v246 offset:6144
    ds_read_b64_tr_b16 v[186:187], v246 offset:6656
    ds_read_b64_tr_b16 v[188:189], v247 offset:6144
    ds_read_b64_tr_b16 v[190:191], v247 offset:6656
    s_mov_b32 s32, s31
    s_mov_b32 s31, s35
    s_mov_b32 m0, s70
    v_mfma_f32_32x32x16_bf16 v[16:31], v[84:87], v[176:179], v[16:31]
    buffer_load_dwordx4 v226, s[4:7], s46 offen sc1 lds
    buffer_load_dwordx4 v227, s[72:75], s46 offen offset:1024 sc1 lds
    s_waitcnt lgkmcnt(4)
    v_mad_u32_u16 v229, v228, s39, v248 op_sel:[1,0,0,0]
    v_mad_u32_u16 v228, v228, s39, v248
    s_sub_u32 s26, s48, s29
    s_mov_b32 s29, s48
    v_mfma_f32_32x32x16_bf16 v[32:47], v[80:83], v[180:183], v[32:47]
    s_mov_b32 s30, s3
    s_cmp_eq_u32 s34, 0
    s_cselect_b32 s56, s33, 0
    v_mfma_f32_32x32x16_bf16 v[48:63], v[84:87], v[180:183], v[48:63]
    s_waitcnt vmcnt(4) lgkmcnt(0)
    v_mfma_f32_32x32x16_bf16 v[0:15], v[88:91], v[184:187], v[0:15]
    ds_read_b64_tr_b16 v[176:177], v246 offset:0
    ds_read_b64_tr_b16 v[178:179], v246 offset:512
    ds_read_b64_tr_b16 v[180:181], v247 offset:0
    ds_read_b64_tr_b16 v[182:183], v247 offset:512
    s_mov_b32 m0, s71
    v_mfma_f32_32x32x16_bf16 v[16:31], v[92:95], v[184:187], v[16:31]
    buffer_load_dwordx4 v228, s[4:7], s47 offen sc1 lds
    buffer_load_dwordx4 v229, s[72:75], s47 offen offset:1024 sc1 lds
    v_mfma_f32_32x32x16_bf16 v[32:47], v[88:91], v[188:191], v[32:47]
    s_nop 2
    v_mul_f32 v242, v0, v144
    v_fma_f32 v240, v8, v160, -v240
    v_fmac_f32 v242, v1, v145
    v_fmac_f32 v240, v9, v161
    v_fmac_f32 v242, v2, v146
    v_fmac_f32 v240, v10, v162
    v_fmac_f32 v242, v3, v147
    v_mfma_f32_32x32x16_bf16 v[48:63], v[92:95], v[188:191], v[48:63]
    s_setprio 0
    v_fmac_f32 v240, v11, v163
    v_fmac_f32 v242, v4, v148
    v_fmac_f32 v240, v12, v164
    v_fmac_f32 v242, v5, v149
    v_fmac_f32 v240, v13, v165
    v_fmac_f32 v242, v6, v150
    v_fmac_f32 v240, v14, v166
    v_fmac_f32 v242, v7, v151
    v_fmac_f32 v240, v15, v167
    v_add_u32 v249, s26, v249
    v_add_u32 v250, s26, v250
    v_fma_f32 v244, v16, v160, -v244
    v_fmac_f32 v236, v24, v112
    v_fmac_f32 v244, v17, v161
    v_fmac_f32 v236, v25, v113
    v_fmac_f32 v244, v18, v162
    v_fmac_f32 v236, v26, v114
    v_fmac_f32 v244, v19, v163
    v_fmac_f32 v236, v27, v115
    v_fmac_f32 v244, v20, v164
    v_fmac_f32 v236, v28, v116
    v_fmac_f32 v244, v21, v165
    v_fmac_f32 v236, v29, v117
    v_fmac_f32 v244, v22, v166
    v_fmac_f32 v236, v30, v118
    v_fmac_f32 v244, v23, v167
    v_fmac_f32 v236, v31, v119
    ds_read_b64_tr_b16 v[0:1], v249 offset:0
    ds_read_b64_tr_b16 v[2:3], v249 offset:128
    ds_read_b128 v[4:7], v250 offset:0
    ds_read_b128 v[8:11], v250 offset:16
    ds_read_b128 v[12:15], v250 offset:384
    ds_read_b128 v[16:19], v250 offset:400
    v_mul_f32 v243, v32, v152
    v_fma_f32 v241, v40, v168, -v241
    v_fmac_f32 v243, v33, v153
    v_fmac_f32 v241, v41, v169
    v_fmac_f32 v243, v34, v154
    v_fmac_f32 v241, v42, v170
    v_fmac_f32 v243, v35, v155
    v_fmac_f32 v241, v43, v171
    v_fmac_f32 v243, v36, v156
    v_fmac_f32 v241, v44, v172
    v_fmac_f32 v243, v37, v157
    v_fmac_f32 v241, v45, v173
    v_fmac_f32 v243, v38, v158
    v_fmac_f32 v241, v46, v174
    v_fmac_f32 v243, v39, v159
    v_fmac_f32 v241, v47, v175
    ds_read_b64_tr_b16 v[20:21], v249 offset:512
    ds_read_b64_tr_b16 v[22:23], v249 offset:640
    ds_read_b128 v[24:27], v250 offset:64
    ds_read_b128 v[28:31], v250 offset:80
    ds_read_b128 v[32:35], v250 offset:448
    ds_read_b128 v[36:39], v250 offset:464
    v_fma_f32 v245, v48, v168, -v245
    v_fmac_f32 v237, v56, v120
    v_fmac_f32 v245, v49, v169
    v_fmac_f32 v237, v57, v121
    v_fmac_f32 v245, v50, v170
    v_fmac_f32 v237, v58, v122
    v_fmac_f32 v245, v51, v171
    v_fmac_f32 v237, v59, v123
    v_fmac_f32 v245, v52, v172
    v_fmac_f32 v237, v60, v124
    v_fmac_f32 v245, v53, v173
    v_fmac_f32 v237, v61, v125
    v_fmac_f32 v245, v54, v174
    v_fmac_f32 v237, v62, v126
    v_fmac_f32 v245, v55, v175
    v_fmac_f32 v237, v63, v127
    s_cmp_eq_u32 s56, 2
    s_cbranch_scc1 K2_U20
    s_cmp_eq_u32 s56, 3
    s_cbranch_scc1 K2_U30
    s_branch K2_DSP0
K2_U11:
    s_setprio 1
    v_mov_b32 v254, 163648
    v_mov_b32 v255, 1
    v_lshl_add_u32 v233, v252, 1, s53
    s_mov_b64 exec, 1
    ds_add_rtn_u32 v232, v254, v255
    s_mov_b64 exec, -1
    ds_read_b32 v233, v233
    s_waitcnt lgkmcnt(8)
    v_lshlrev_b32 v40, 16, v0
    v_and_b32 v41, 0xffff0000, v0
    v_lshlrev_b32 v42, 16, v1
    v_and_b32 v43, 0xffff0000, v1
    v_lshlrev_b32 v44, 16, v2
    v_and_b32 v45, 0xffff0000, v2
    v_lshlrev_b32 v46, 16, v3
    v_and_b32 v47, 0xffff0000, v3
    v_mul_f32 v4, v40, v4
    v_mul_f32 v5, v41, v5
    v_mul_f32 v6, v42, v6
    v_mul_f32 v7, v43, v7
    v_mul_f32 v8, v44, v8
    v_mul_f32 v9, v45, v9
    v_mul_f32 v10, v46, v10
    v_mul_f32 v11, v47, v11
    v_cvt_pk_bf16_f32 v64, v4, v5
    v_cvt_pk_bf16_f32 v65, v6, v7
    v_cvt_pk_bf16_f32 v66, v8, v9
    v_cvt_pk_bf16_f32 v67, v10, v11
    v_mul_f32 v12, v40, v12
    v_mul_f32 v13, v41, v13
    v_mul_f32 v14, v42, v14
    v_mul_f32 v15, v43, v15
    v_mul_f32 v16, v44, v16
    v_mul_f32 v17, v45, v17
    v_mul_f32 v18, v46, v18
    v_mul_f32 v19, v47, v19
    v_cvt_pk_bf16_f32 v68, v12, v13
    v_cvt_pk_bf16_f32 v69, v14, v15
    v_cvt_pk_bf16_f32 v70, v16, v17
    v_cvt_pk_bf16_f32 v71, v18, v19
    s_waitcnt lgkmcnt(0)
    v_readfirstlane_b32 s58, v232
    s_nop 0
    s_cmp_lt_u32 s58, s22
    s_cbranch_scc0 K2_nul_74
    s_and_b32 s59, s58, 7
    s_lshr_b32 s60, s58, 3
K2_chk_76:
    v_readlane_b32 s61, v233, s59
    s_nop 0
    s_cmp_gt_u32 s61, s60
    s_cbranch_scc0 K2_spin_75
K2_back_77:
    v_readlane_b32 s3, v253, s58
    s_lshl_b32 s44, s34, 7
    s_lshl_b32 s60, s58, 5
    s_and_b32 s48, s3, 0x3ffff
    s_bfe_u32 s33, s3, 0x30012
    s_sub_u32 s60, s60, s48
    s_and_b32 s60, s60, 0xff
    s_add_u32 s35, s60, s48
    s_mov_b32 s45, s44
    s_add_u32 s47, s44, 256
    s_add_u32 s49, s48, 32
    s_add_u32 s60, s48, 64
    s_cmp_eq_u32 s33, 3
    s_cselect_b32 s46, s44, s47
    s_cselect_b32 s50, s60, s48
    s_cselect_b32 s51, s48, s49
    s_sub_u32 s60, s33, 2
    s_cmp_lt_u32 s60, 2
    s_cbranch_scc0 K2_rare_78
K2_back_79:
    v_add_u32 v222, s48, v251
    ds_read_b32 v222, v222
    v_add_u32 v224, s49, v251
    ds_read_b32 v224, v224
    v_add_u32 v226, s50, v251
    ds_read_b32 v226, v226
    v_add_u32 v228, s51, v251
    ds_read_b32 v228, v228
    s_waitcnt lgkmcnt(3)
    v_mad_u32_u16 v223, v222, s39, v248 op_sel:[1,0,0,0]
    v_mad_u32_u16 v222, v222, s39, v248
    s_waitcnt lgkmcnt(2)
    v_mad_u32_u16 v225, v224, s39, v248 op_sel:[1,0,0,0]
    v_mad_u32_u16 v224, v224, s39, v248
    s_waitcnt lgkmcnt(1)
    v_mad_u32_u16 v227, v226, s39, v248 op_sel:[1,0,0,0]
    v_mad_u32_u16 v226, v226, s39, v248
    s_waitcnt lgkmcnt(0)
    v_mad_u32_u16 v229, v228, s39, v248 op_sel:[1,0,0,0]
    v_mad_u32_u16 v228, v228, s39, v248
    s_waitcnt vmcnt(4)
    v_mfma_f32_32x32x16_bf16 v[0:15], v[64:67], v[176:179], 0
    ds_read_b64_tr_b16 v[184:185], v246 offset:2048
    ds_read_b64_tr_b16 v[186:187], v246 offset:2560
    ds_read_b64_tr_b16 v[188:189], v247 offset:2048
    ds_read_b64_tr_b16 v[190:191], v247 offset:2560
    s_mov_b32 m0, s68
    v_mfma_f32_32x32x16_bf16 v[16:31], v[68:71], v[176:179], 0
    buffer_load_dwordx4 v222, s[4:7], s44 offen sc1 lds
    buffer_load_dwordx4 v223, s[72:75], s44 offen offset:1024 sc1 lds
    v_permlane32_swap_b32 v242, v236
    v_permlane32_swap_b32 v243, v237
    v_mfma_f32_32x32x16_bf16 v[32:47], v[64:67], v[180:183], 0
    v_permlane32_swap_b32 v244, v238
    v_permlane32_swap_b32 v245, v239
    v_permlane32_swap_b32 v240, v241
    v_add_f32 v242, v242, v236
    v_mfma_f32_32x32x16_bf16 v[48:63], v[68:71], v[180:183], 0
    s_setprio 0
    v_add_f32 v243, v243, v237
    v_add_f32 v244, v244, v238
    v_add_f32 v245, v245, v239
    v_add_f32 v240, -v240, -v241
    v_sub_u32 v241, v230, v231
    v_cvt_pk_bf16_f32 v242, v242, v243
    v_cvt_pk_bf16_f32 v244, v244, v245
    v_cvt_pk_bf16_f32 v240, v240, v240
    ds_write_b32 v230, v242 offset:768
    ds_write_b32 v230, v244 offset:1024
    ds_write_b16 v241, v240 offset:1280
    v_mul_f32 v234, v0, v96
    v_mul_f32 v236, v8, v128
    v_fmac_f32 v234, v1, v97
    v_fmac_f32 v236, v9, v129
    v_fmac_f32 v234, v2, v98
    v_fmac_f32 v236, v10, v130
    v_fmac_f32 v234, v3, v99
    v_fmac_f32 v236, v11, v131
    v_fmac_f32 v234, v4, v100
    v_fmac_f32 v236, v12, v132
    v_fmac_f32 v234, v5, v101
    v_fmac_f32 v236, v13, v133
    v_fmac_f32 v234, v6, v102
    v_fmac_f32 v236, v14, v134
    v_fmac_f32 v234, v7, v103
    v_fmac_f32 v236, v15, v135
    v_mul_f32 v238, v16, v128
    v_mul_f32 v240, v24, v128
    v_fmac_f32 v238, v17, v129
    v_fmac_f32 v240, v25, v129
    v_fmac_f32 v238, v18, v130
    v_fmac_f32 v240, v26, v130
    v_fmac_f32 v238, v19, v131
    v_fmac_f32 v240, v27, v131
    v_fmac_f32 v238, v20, v132
    v_fmac_f32 v240, v28, v132
    v_fmac_f32 v238, v21, v133
    v_fmac_f32 v240, v29, v133
    v_fmac_f32 v238, v22, v134
    v_fmac_f32 v240, v30, v134
    v_fmac_f32 v238, v23, v135
    v_fmac_f32 v240, v31, v135
    v_mul_f32 v235, v32, v104
    v_mul_f32 v237, v40, v136
    v_fmac_f32 v235, v33, v105
    v_fmac_f32 v237, v41, v137
    v_fmac_f32 v235, v34, v106
    v_fmac_f32 v237, v42, v138
    v_fmac_f32 v235, v35, v107
    v_fmac_f32 v237, v43, v139
    v_fmac_f32 v235, v36, v108
    v_fmac_f32 v237, v44, v140
    v_fmac_f32 v235, v37, v109
    v_fmac_f32 v237, v45, v141
    v_fmac_f32 v235, v38, v110
    v_fmac_f32 v237, v46, v142
    v_fmac_f32 v235, v39, v111
    v_fmac_f32 v237, v47, v143
    v_mul_f32 v239, v48, v136
    v_mul_f32 v241, v56, v136
    v_fmac_f32 v239, v49, v137
    v_fmac_f32 v241, v57, v137
    v_fmac_f32 v239, v50, v138
    v_fmac_f32 v241, v58, v138
    v_fmac_f32 v239, v51, v139
    v_fmac_f32 v241, v59, v139
    v_fmac_f32 v239, v52, v140
    v_fmac_f32 v241, v60, v140
    v_fmac_f32 v239, v53, v141
    v_fmac_f32 v241, v61, v141
    v_fmac_f32 v239, v54, v142
    v_fmac_f32 v241, v62, v142
    v_fmac_f32 v239, v55, v143
    v_fmac_f32 v241, v63, v143
    s_setprio 1
    s_waitcnt vmcnt(4) lgkmcnt(3)
    v_mfma_f32_32x32x16_bf16 v[0:15], v[64:67], v[184:187], 0
    ds_read_b64_tr_b16 v[176:177], v246 offset:4096
    ds_read_b64_tr_b16 v[178:179], v246 offset:4608
    ds_read_b64_tr_b16 v[180:181], v247 offset:4096
    ds_read_b64_tr_b16 v[182:183], v247 offset:4608
    s_mov_b32 m0, s69
    v_mfma_f32_32x32x16_bf16 v[16:31], v[68:71], v[184:187], 0
    buffer_load_dwordx4 v224, s[4:7], s45 offen sc1 lds
    buffer_load_dwordx4 v225, s[72:75], s45 offen offset:1024 sc1 lds
    v_permlane32_swap_b32 v234, v236
    v_permlane32_swap_b32 v235, v237
    v_mfma_f32_32x32x16_bf16 v[32:47], v[64:67], v[188:191], 0
    v_permlane32_swap_b32 v240, v238
    v_permlane32_swap_b32 v241, v239
    v_lshl_add_u32 v230, v252, 1, s31
    v_add_f32 v234, v234, v236
    v_add_f32 v235, v235, v237
    v_mfma_f32_32x32x16_bf16 v[48:63], v[68:71], v[188:191], 0
    s_setprio 0
    v_add_f32 v240, v240, v238
    v_add_f32 v241, v241, v239
    v_cvt_pk_bf16_f32 v234, v234, v235
    v_cvt_pk_bf16_f32 v240, v240, v241
    ds_write_b32 v230, v234 offset:0
    ds_write_b32 v230, v240 offset:256
    v_mul_f32 v234, v0, v144
    v_mul_f32 v236, v8, v112
    v_fmac_f32 v234, v1, v145
    v_fmac_f32 v236, v9, v113
    v_fmac_f32 v234, v2, v146
    v_fmac_f32 v236, v10, v114
    v_fmac_f32 v234, v3, v147
    v_fmac_f32 v236, v11, v115
    v_fmac_f32 v234, v4, v148
    v_fmac_f32 v236, v12, v116
    v_fmac_f32 v234, v5, v149
    v_fmac_f32 v236, v13, v117
    v_fmac_f32 v234, v6, v150
    v_fmac_f32 v236, v14, v118
    v_fmac_f32 v234, v7, v151
    v_fmac_f32 v236, v15, v119
    v_mul_f32 v238, v16, v160
    v_mul_f32 v240, v24, v160
    v_fmac_f32 v238, v17, v161
    v_fmac_f32 v240, v25, v161
    v_fmac_f32 v238, v18, v162
    v_fmac_f32 v240, v26, v162
    v_fmac_f32 v238, v19, v163
    v_fmac_f32 v240, v27, v163
    v_fmac_f32 v238, v20, v164
    v_fmac_f32 v240, v28, v164
    v_fmac_f32 v238, v21, v165
    v_fmac_f32 v240, v29, v165
    v_fmac_f32 v238, v22, v166
    v_fmac_f32 v240, v30, v166
    v_fmac_f32 v238, v23, v167
    v_fmac_f32 v240, v31, v167
    v_mul_f32 v235, v32, v152
    v_mul_f32 v237, v40, v120
    v_fmac_f32 v235, v33, v153
    v_fmac_f32 v237, v41, v121
    v_fmac_f32 v235, v34, v154
    v_fmac_f32 v237, v42, v122
    v_fmac_f32 v235, v35, v155
    v_fmac_f32 v237, v43, v123
    v_fmac_f32 v235, v36, v156
    v_fmac_f32 v237, v44, v124
    v_fmac_f32 v235, v37, v157
    v_fmac_f32 v237, v45, v125
    v_fmac_f32 v235, v38, v158
    v_fmac_f32 v237, v46, v126
    v_fmac_f32 v235, v39, v159
    v_fmac_f32 v237, v47, v127
    v_mul_f32 v239, v48, v168
    v_mul_f32 v241, v56, v168
    v_fmac_f32 v239, v49, v169
    v_fmac_f32 v241, v57, v169
    v_fmac_f32 v239, v50, v170
    v_fmac_f32 v241, v58, v170
    v_fmac_f32 v239, v51, v171
    v_fmac_f32 v241, v59, v171
    v_fmac_f32 v239, v52, v172
    v_fmac_f32 v241, v60, v172
    v_fmac_f32 v239, v53, v173
    v_fmac_f32 v241, v61, v173
    v_fmac_f32 v239, v54, v174
    v_fmac_f32 v241, v62, v174
    v_fmac_f32 v239, v55, v175
    v_fmac_f32 v241, v63, v175
    s_setprio 1
    s_waitcnt vmcnt(4) lgkmcnt(2)
    v_mfma_f32_32x32x16_bf16 v[0:15], v[64:67], v[176:179], 0
    ds_read_b64_tr_b16 v[184:185], v246 offset:6144
    ds_read_b64_tr_b16 v[186:187], v246 offset:6656
    ds_read_b64_tr_b16 v[188:189], v247 offset:6144
    ds_read_b64_tr_b16 v[190:191], v247 offset:6656
    s_mov_b32 s32, s31
    s_mov_b32 s31, s35
    s_mov_b32 m0, s70
    v_mfma_f32_32x32x16_bf16 v[16:31], v[68:71], v[176:179], 0
    buffer_load_dwordx4 v226, s[4:7], s46 offen sc1 lds
    buffer_load_dwordx4 v227, s[72:75], s46 offen offset:1024 sc1 lds
    s_sub_u32 s26, s48, s29
    s_mov_b32 s29, s48
    s_mov_b32 s30, s3
    s_cmp_lg_u32 s36, 0
    s_cselect_b32 s56, s33, 0
    v_mfma_f32_32x32x16_bf16 v[32:47], v[64:67], v[180:183], 0
    v_mfma_f32_32x32x16_bf16 v[48:63], v[68:71], v[180:183], 0
    s_setprio 0
    v_mul_f32 v242, v0, v144
    v_fma_f32 v238, v8, v160, -v238
    v_fmac_f32 v242, v1, v145
    v_fmac_f32 v238, v9, v161
    v_fmac_f32 v242, v2, v146
    v_fmac_f32 v238, v10, v162
    v_fmac_f32 v242, v3, v147
    v_fmac_f32 v238, v11, v163
    v_fmac_f32 v242, v4, v148
    v_fmac_f32 v238, v12, v164
    v_fmac_f32 v242, v5, v149
    v_fmac_f32 v238, v13, v165
    v_fmac_f32 v242, v6, v150
    v_fmac_f32 v238, v14, v166
    v_fmac_f32 v242, v7, v151
    v_fmac_f32 v238, v15, v167
    v_fmac_f32 v236, v16, v112
    v_mul_f32 v244, v24, v160
    v_fmac_f32 v236, v17, v113
    v_fmac_f32 v244, v25, v161
    v_fmac_f32 v236, v18, v114
    v_fmac_f32 v244, v26, v162
    v_fmac_f32 v236, v19, v115
    v_fmac_f32 v244, v27, v163
    v_fmac_f32 v236, v20, v116
    v_fmac_f32 v244, v28, v164
    v_fmac_f32 v236, v21, v117
    v_fmac_f32 v244, v29, v165
    v_fmac_f32 v236, v22, v118
    v_fmac_f32 v244, v30, v166
    v_fmac_f32 v236, v23, v119
    v_fmac_f32 v244, v31, v167
    v_mul_f32 v243, v32, v152
    v_fma_f32 v239, v40, v168, -v239
    v_fmac_f32 v243, v33, v153
    v_fmac_f32 v239, v41, v169
    v_fmac_f32 v243, v34, v154
    v_fmac_f32 v239, v42, v170
    v_fmac_f32 v243, v35, v155
    v_fmac_f32 v239, v43, v171
    v_fmac_f32 v243, v36, v156
    v_fmac_f32 v239, v44, v172
    v_fmac_f32 v243, v37, v157
    v_fmac_f32 v239, v45, v173
    v_fmac_f32 v243, v38, v158
    v_fmac_f32 v239, v46, v174
    v_fmac_f32 v243, v39, v159
    v_fmac_f32 v239, v47, v175
    v_fmac_f32 v237, v48, v120
    v_mul_f32 v245, v56, v168
    v_fmac_f32 v237, v49, v121
    v_fmac_f32 v245, v57, v169
    v_fmac_f32 v237, v50, v122
    v_fmac_f32 v245, v58, v170
    v_fmac_f32 v237, v51, v123
    v_fmac_f32 v245, v59, v171
    v_fmac_f32 v237, v52, v124
    v_fmac_f32 v245, v60, v172
    v_fmac_f32 v237, v53, v125
    v_fmac_f32 v245, v61, v173
    v_fmac_f32 v237, v54, v126
    v_fmac_f32 v245, v62, v174
    v_fmac_f32 v237, v55, v127
    v_fmac_f32 v245, v63, v175
    s_setprio 1
    s_waitcnt vmcnt(4) lgkmcnt(0)
    v_mfma_f32_32x32x16_bf16 v[0:15], v[64:67], v[184:187], 0
    ds_read_b64_tr_b16 v[176:177], v246 offset:0
    ds_read_b64_tr_b16 v[178:179], v246 offset:512
    ds_read_b64_tr_b16 v[180:181], v247 offset:0
    ds_read_b64_tr_b16 v[182:183], v247 offset:512
    s_mov_b32 m0, s71
    v_mfma_f32_32x32x16_bf16 v[16:31], v[68:71], v[184:187], 0
    buffer_load_dwordx4 v228, s[4:7], s47 offen sc1 lds
    buffer_load_dwordx4 v229, s[72:75], s47 offen offset:1024 sc1 lds
    v_permlane32_swap_b32 v242, v234
    v_permlane32_swap_b32 v243, v235
    v_add_f32 v242, v242, v234
    v_mfma_f32_32x32x16_bf16 v[32:47], v[64:67], v[188:191], 0
    v_add_f32 v243, v243, v235
    v_cvt_pk_bf16_f32 v242, v242, v243
    ds_write_b32 v230, v242 offset:512
    v_mfma_f32_32x32x16_bf16 v[48:63], v[68:71], v[188:191], 0
    s_setprio 0
    v_mul_f32 v242, v0, v144
    v_fma_f32 v240, v8, v160, -v240
    v_fmac_f32 v242, v1, v145
    v_fmac_f32 v240, v9, v161
    v_fmac_f32 v242, v2, v146
    v_fmac_f32 v240, v10, v162
    v_fmac_f32 v242, v3, v147
    v_fmac_f32 v240, v11, v163
    v_fmac_f32 v242, v4, v148
    v_fmac_f32 v240, v12, v164
    v_fmac_f32 v242, v5, v149
    v_fmac_f32 v240, v13, v165
    v_fmac_f32 v242, v6, v150
    v_fmac_f32 v240, v14, v166
    v_fmac_f32 v242, v7, v151
    v_fmac_f32 v240, v15, v167
    v_add_u32 v249, s26, v249
    v_add_u32 v250, s26, v250
    v_fma_f32 v244, v16, v160, -v244
    v_fmac_f32 v236, v24, v112
    v_fmac_f32 v244, v17, v161
    v_fmac_f32 v236, v25, v113
    v_fmac_f32 v244, v18, v162
    v_fmac_f32 v236, v26, v114
    v_fmac_f32 v244, v19, v163
    v_fmac_f32 v236, v27, v115
    v_fmac_f32 v244, v20, v164
    v_fmac_f32 v236, v28, v116
    v_fmac_f32 v244, v21, v165
    v_fmac_f32 v236, v29, v117
    v_fmac_f32 v244, v22, v166
    v_fmac_f32 v236, v30, v118
    v_fmac_f32 v244, v23, v167
    v_fmac_f32 v236, v31, v119
    ds_read_b64_tr_b16 v[0:1], v249 offset:0
    ds_read_b64_tr_b16 v[2:3], v249 offset:128
    ds_read_b128 v[4:7], v250 offset:0
    ds_read_b128 v[8:11], v250 offset:16
    ds_read_b128 v[12:15], v250 offset:384
    ds_read_b128 v[16:19], v250 offset:400
    v_mul_f32 v243, v32, v152
    v_fma_f32 v241, v40, v168, -v241
    v_fmac_f32 v243, v33, v153
    v_fmac_f32 v241, v41, v169
    v_fmac_f32 v243, v34, v154
    v_fmac_f32 v241, v42, v170
    v_fmac_f32 v243, v35, v155
    v_fmac_f32 v241, v43, v171
    v_fmac_f32 v243, v36, v156
    v_fmac_f32 v241, v44, v172
    v_fmac_f32 v243, v37, v157
    v_fmac_f32 v241, v45, v173
    v_fmac_f32 v243, v38, v158
    v_fmac_f32 v241, v46, v174
    v_fmac_f32 v243, v39, v159
    v_fmac_f32 v241, v47, v175
    ds_read_b64_tr_b16 v[20:21], v249 offset:512
    ds_read_b64_tr_b16 v[22:23], v249 offset:640
    ds_read_b128 v[24:27], v250 offset:64
    ds_read_b128 v[28:31], v250 offset:80
    ds_read_b128 v[32:35], v250 offset:448
    ds_read_b128 v[36:39], v250 offset:464
    v_fma_f32 v245, v48, v168, -v245
    v_fmac_f32 v237, v56, v120
    v_fmac_f32 v245, v49, v169
    v_fmac_f32 v237, v57, v121
    v_fmac_f32 v245, v50, v170
    v_fmac_f32 v237, v58, v122
    v_fmac_f32 v245, v51, v171
    v_fmac_f32 v237, v59, v123
    v_fmac_f32 v245, v52, v172
    v_fmac_f32 v237, v60, v124
    v_fmac_f32 v245, v53, v173
    v_fmac_f32 v237, v61, v125
    v_fmac_f32 v245, v54, v174
    v_fmac_f32 v237, v62, v126
    v_fmac_f32 v245, v55, v175
    v_fmac_f32 v237, v63, v127
    s_cmp_eq_u32 s56, 2
    s_cbranch_scc1 K2_U21
    s_cmp_eq_u32 s56, 3
    s_cbranch_scc1 K2_U31
    s_branch K2_DSP1
K2_U41:
    s_setprio 1
    s_waitcnt lgkmcnt(6)
    v_lshlrev_b32 v40, 16, v0
    v_and_b32 v41, 0xffff0000, v0
    v_lshlrev_b32 v42, 16, v1
    v_and_b32 v43, 0xffff0000, v1
    v_lshlrev_b32 v44, 16, v2
    v_and_b32 v45, 0xffff0000, v2
    v_lshlrev_b32 v46, 16, v3
    v_and_b32 v47, 0xffff0000, v3
    v_mul_f32 v4, v40, v4
    v_mul_f32 v5, v41, v5
    v_mul_f32 v6, v42, v6
    v_mul_f32 v7, v43, v7
    v_mul_f32 v8, v44, v8
    v_mul_f32 v9, v45, v9
    v_mul_f32 v10, v46, v10
    v_mul_f32 v11, v47, v11
    v_cvt_pk_bf16_f32 v64, v4, v5
    v_cvt_pk_bf16_f32 v65, v6, v7
    v_cvt_pk_bf16_f32 v66, v8, v9
    v_cvt_pk_bf16_f32 v67, v10, v11
    v_mul_f32 v12, v40, v12
    v_mul_f32 v13, v41, v13
    v_mul_f32 v14, v42, v14
    v_mul_f32 v15, v43, v15
    v_mul_f32 v16, v44, v16
    v_mul_f32 v17, v45, v17
    v_mul_f32 v18, v46, v18
    v_mul_f32 v19, v47, v19
    v_cvt_pk_bf16_f32 v68, v12, v13
    v_cvt_pk_bf16_f32 v69, v14, v15
    v_cvt_pk_bf16_f32 v70, v16, v17
    v_cvt_pk_bf16_f32 v71, v18, v19
    ds_read_b64_tr_b16 v[0:1], v249 offset:1024
    ds_read_b64_tr_b16 v[2:3], v249 offset:1152
    ds_read_b128 v[4:7], v250 offset:128
    ds_read_b128 v[8:11], v250 offset:144
    ds_read_b128 v[12:15], v250 offset:512
    ds_read_b128 v[16:19], v250 offset:528
    s_waitcnt lgkmcnt(6)
    v_lshlrev_b32 v48, 16, v20
    v_and_b32 v49, 0xffff0000, v20
    v_lshlrev_b32 v50, 16, v21
    v_and_b32 v51, 0xffff0000, v21
    v_lshlrev_b32 v52, 16, v22
    v_and_b32 v53, 0xffff0000, v22
    v_lshlrev_b32 v54, 16, v23
    v_and_b32 v55, 0xffff0000, v23
    v_mul_f32 v24, v48, v24
    v_mul_f32 v25, v49, v25
    v_mul_f32 v26, v50, v26
    v_mul_f32 v27, v51, v27
    v_mul_f32 v28, v52, v28
    v_mul_f32 v29, v53, v29
    v_mul_f32 v30, v54, v30
    v_mul_f32 v31, v55, v31
    v_cvt_pk_bf16_f32 v72, v24, v25
    v_cvt_pk_bf16_f32 v73, v26, v27
    v_cvt_pk_bf16_f32 v74, v28, v29
    v_cvt_pk_bf16_f32 v75, v30, v31
    v_mul_f32 v32, v48, v32
    v_mul_f32 v33, v49, v33
    v_mul_f32 v34, v50, v34
    v_mul_f32 v35, v51, v35
    v_mul_f32 v36, v52, v36
    v_mul_f32 v37, v53, v37
    v_mul_f32 v38, v54, v38
    v_mul_f32 v39, v55, v39
    v_cvt_pk_bf16_f32 v76, v32, v33
    v_cvt_pk_bf16_f32 v77, v34, v35
    v_cvt_pk_bf16_f32 v78, v36, v37
    v_cvt_pk_bf16_f32 v79, v38, v39
    s_lshr_b32 s65, s30, 27
    s_mov_b32 s66, 161536
    s_cmp_ge_u32 s65, 2
    s_cselect_b32 s66, 158112, s66
    s_mul_i32 s65, s65, 512
    s_add_u32 s65, s65, s66
    s_sub_u32 s65, s65, s29
    v_add_u32 v56, s65, v249
    s_lshr_b32 s65, s30, 27
    s_mov_b32 s66, 161536
    s_cmp_ge_u32 s65, 2
    s_cselect_b32 s66, 159008, s66
    s_mul_i32 s65, s65, 64
    s_add_u32 s65, s65, s66
    s_sub_u32 s65, s65, s29
    v_add_u32 v57, s65, v250
    ds_read_b64_tr_b16 v[20:21], v56 offset:0
    ds_read_b64_tr_b16 v[22:23], v56 offset:128
    ds_read_b128 v[24:27], v57 offset:0
    ds_read_b128 v[28:31], v57 offset:16
    ds_read_b128 v[32:35], v57 offset:384
    ds_read_b128 v[36:39], v57 offset:400
    s_waitcnt lgkmcnt(10)
    v_lshlrev_b32 v40, 16, v0
    v_and_b32 v41, 0xffff0000, v0
    v_lshlrev_b32 v42, 16, v1
    v_and_b32 v43, 0xffff0000, v1
    v_lshlrev_b32 v44, 16, v2
    v_and_b32 v45, 0xffff0000, v2
    v_lshlrev_b32 v46, 16, v3
    v_and_b32 v47, 0xffff0000, v3
    s_waitcnt lgkmcnt(8)
    v_mul_f32 v4, v40, v4
    v_mul_f32 v5, v41, v5
    v_mul_f32 v6, v42, v6
    v_mul_f32 v7, v43, v7
    v_mul_f32 v8, v44, v8
    v_mul_f32 v9, v45, v9
    v_mul_f32 v10, v46, v10
    v_mul_f32 v11, v47, v11
    v_cvt_pk_bf16_f32 v80, v4, v5
    v_cvt_pk_bf16_f32 v81, v6, v7
    v_cvt_pk_bf16_f32 v82, v8, v9
    v_cvt_pk_bf16_f32 v83, v10, v11
    s_waitcnt lgkmcnt(6)
    v_mul_f32 v12, v40, v12
    v_mul_f32 v13, v41, v13
    v_mul_f32 v14, v42, v14
    v_mul_f32 v15, v43, v15
    v_mul_f32 v16, v44, v16
    v_mul_f32 v17, v45, v17
    v_mul_f32 v18, v46, v18
    v_mul_f32 v19, v47, v19
    v_cvt_pk_bf16_f32 v84, v12, v13
    v_cvt_pk_bf16_f32 v85, v14, v15
    v_cvt_pk_bf16_f32 v86, v16, v17
    v_cvt_pk_bf16_f32 v87, v18, v19
    s_waitcnt lgkmcnt(4)
    v_lshlrev_b32 v48, 16, v20
    v_and_b32 v49, 0xffff0000, v20
    v_lshlrev_b32 v50, 16, v21
    v_and_b32 v51, 0xffff0000, v21
    v_lshlrev_b32 v52, 16, v22
    v_and_b32 v53, 0xffff0000, v22
    v_lshlrev_b32 v54, 16, v23
    v_and_b32 v55, 0xffff0000, v23
    s_waitcnt lgkmcnt(2)
    v_mul_f32 v24, v48, v24
    v_mul_f32 v25, v49, v25
    v_mul_f32 v26, v50, v26
    v_mul_f32 v27, v51, v27
    v_mul_f32 v28, v52, v28
    v_mul_f32 v29, v53, v29
    v_mul_f32 v30, v54, v30
    v_mul_f32 v31, v55, v31
    v_cvt_pk_bf16_f32 v88, v24, v25
    v_cvt_pk_bf16_f32 v89, v26, v27
    v_cvt_pk_bf16_f32 v90, v28, v29
    v_cvt_pk_bf16_f32 v91, v30, v31
    s_waitcnt lgkmcnt(0)
    v_mul_f32 v32, v48, v32
    v_mul_f32 v33, v49, v33
    v_mul_f32 v34, v50, v34
    v_mul_f32 v35, v51, v35
    v_mul_f32 v36, v52, v36
    v_mul_f32 v37, v53, v37
    v_mul_f32 v38, v54, v38
    v_mul_f32 v39, v55, v39
    v_cvt_pk_bf16_f32 v92, v32, v33
    v_cvt_pk_bf16_f32 v93, v34, v35
    v_cvt_pk_bf16_f32 v94, v36, v37
    v_cvt_pk_bf16_f32 v95, v38, v39
    s_waitcnt vmcnt(4)
    v_mfma_f32_32x32x16_bf16 v[0:15], v[64:67], v[176:179], 0
    ds_read_b64_tr_b16 v[184:185], v246 offset:2048
    ds_read_b64_tr_b16 v[186:187], v246 offset:2560
    ds_read_b64_tr_b16 v[188:189], v247 offset:2048
    ds_read_b64_tr_b16 v[190:191], v247 offset:2560
    s_mov_b32 m0, s68
    v_mfma_f32_32x32x16_bf16 v[16:31], v[68:71], v[176:179], 0
    buffer_load_dwordx4 v222, s[4:7], s41 offen sc1 lds
    buffer_load_dwordx4 v223, s[72:75], s41 offen offset:1024 sc1 lds
    v_permlane32_swap_b32 v242, v236
    v_permlane32_swap_b32 v243, v237
    v_mov_b32 v254, 163648
    v_mfma_f32_32x32x16_bf16 v[32:47], v[64:67], v[180:183], 0
    v_permlane32_swap_b32 v244, v238
    v_permlane32_swap_b32 v245, v239
    v_permlane32_swap_b32 v240, v241
    v_add_f32 v242, v242, v236
    v_mfma_f32_32x32x16_bf16 v[48:63], v[68:71], v[180:183], 0
    v_add_f32 v243, v243, v237
    v_add_f32 v244, v244, v238
    v_add_f32 v245, v245, v239
    v_add_f32 v240, -v240, -v241
    v_sub_u32 v241, v230, v231
    v_cvt_pk_bf16_f32 v242, v242, v243
    v_mov_b32 v255, 1
    v_lshl_add_u32 v233, v252, 1, s53
    s_mov_b64 exec, 1
    ds_add_rtn_u32 v232, v254, v255
    s_mov_b64 exec, -1
    ds_read_b32 v233, v233
    s_waitcnt vmcnt(4) lgkmcnt(2)
    v_mfma_f32_32x32x16_bf16 v[0:15], v[72:75], v[184:187], v[0:15]
    ds_read_b64_tr_b16 v[176:177], v246 offset:4096
    ds_read_b64_tr_b16 v[178:179], v246 offset:4608
    ds_read_b64_tr_b16 v[180:181], v247 offset:4096
    ds_read_b64_tr_b16 v[182:183], v247 offset:4608
    v_cvt_pk_bf16_f32 v244, v244, v245
    v_cvt_pk_bf16_f32 v240, v240, v240
    s_mov_b32 m0, s69
    v_mfma_f32_32x32x16_bf16 v[16:31], v[76:79], v[184:187], v[16:31]
    buffer_load_dwordx4 v224, s[4:7], s41 offen sc1 lds
    buffer_load_dwordx4 v225, s[72:75], s41 offen offset:1024 sc1 lds
    ds_write_b32 v230, v242 offset:768
    ds_write_b32 v230, v244 offset:1024
    ds_write_b16 v241, v240 offset:1280
    s_waitcnt lgkmcnt(7)
    v_readfirstlane_b32 s58, v232
    v_mfma_f32_32x32x16_bf16 v[32:47], v[72:75], v[188:191], v[32:47]
    s_cmp_lt_u32 s58, s22
    s_cbranch_scc0 K2_nul_81
    s_and_b32 s59, s58, 7
    s_lshr_b32 s60, s58, 3
K2_chk_83:
    v_readlane_b32 s61, v233, s59
    s_nop 0
    s_cmp_gt_u32 s61, s60
    s_cbranch_scc0 K2_spin_82
K2_back_84:
    v_mfma_f32_32x32x16_bf16 v[48:63], v[76:79], v[188:191], v[48:63]
    v_readlane_b32 s3, v253, s58
    s_lshl_b32 s44, s34, 7
    s_lshl_b32 s60, s58, 5
    s_and_b32 s48, s3, 0x3ffff
    s_bfe_u32 s33, s3, 0x30012
    s_sub_u32 s60, s60, s48
    s_waitcnt vmcnt(4) lgkmcnt(3)
    v_mfma_f32_32x32x16_bf16 v[0:15], v[80:83], v[176:179], v[0:15]
    ds_read_b64_tr_b16 v[184:185], v246 offset:6144
    ds_read_b64_tr_b16 v[186:187], v246 offset:6656
    ds_read_b64_tr_b16 v[188:189], v247 offset:6144
    ds_read_b64_tr_b16 v[190:191], v247 offset:6656
    s_and_b32 s60, s60, 0xff
    s_add_u32 s35, s60, s48
    s_mov_b32 m0, s70
    v_mfma_f32_32x32x16_bf16 v[16:31], v[84:87], v[176:179], v[16:31]
    buffer_load_dwordx4 v226, s[4:7], s41 offen sc1 lds
    buffer_load_dwordx4 v227, s[72:75], s41 offen offset:1024 sc1 lds
    s_mov_b32 s45, s44
    s_add_u32 s47, s44, 256
    s_add_u32 s49, s48, 32
    s_add_u32 s60, s48, 64
    v_mfma_f32_32x32x16_bf16 v[32:47], v[80:83], v[180:183], v[32:47]
    s_cmp_eq_u32 s33, 3
    s_cselect_b32 s46, s44, s47
    s_cselect_b32 s50, s60, s48
    s_cselect_b32 s51, s48, s49
    s_sub_u32 s60, s33, 2
    s_cmp_lt_u32 s60, 2
    s_cbranch_scc0 K2_rare_85
K2_back_86:
    v_mfma_f32_32x32x16_bf16 v[48:63], v[84:87], v[180:183], v[48:63]
    s_waitcnt vmcnt(4) lgkmcnt(0)
    v_mfma_f32_32x32x16_bf16 v[0:15], v[88:91], v[184:187], v[0:15]
    ds_read_b64_tr_b16 v[176:177], v246 offset:0
    ds_read_b64_tr_b16 v[178:179], v246 offset:512
    ds_read_b64_tr_b16 v[180:181], v247 offset:0
    ds_read_b64_tr_b16 v[182:183], v247 offset:512
    s_mov_b32 m0, s71
    v_mfma_f32_32x32x16_bf16 v[16:31], v[92:95], v[184:187], v[16:31]
    buffer_load_dwordx4 v228, s[4:7], s41 offen sc1 lds
    buffer_load_dwordx4 v229, s[72:75], s41 offen offset:1024 sc1 lds
    v_mfma_f32_32x32x16_bf16 v[32:47], v[88:91], v[188:191], v[32:47]
    s_nop 2
    v_mul_f32 v234, v0, v96
    v_mul_f32 v236, v8, v128
    v_fmac_f32 v234, v1, v97
    v_fmac_f32 v236, v9, v129
    v_fmac_f32 v234, v2, v98
    v_fmac_f32 v236, v10, v130
    v_fmac_f32 v234, v3, v99
    v_mfma_f32_32x32x16_bf16 v[48:63], v[92:95], v[188:191], v[48:63]
    s_setprio 0
    v_fmac_f32 v236, v11, v131
    v_fmac_f32 v234, v4, v100
    v_fmac_f32 v236, v12, v132
    v_fmac_f32 v234, v5, v101
    v_fmac_f32 v236, v13, v133
    v_fmac_f32 v234, v6, v102
    v_fmac_f32 v236, v14, v134
    v_fmac_f32 v234, v7, v103
    v_fmac_f32 v236, v15, v135
    v_mul_f32 v238, v16, v128
    v_mul_f32 v240, v24, v128
    v_fmac_f32 v238, v17, v129
    v_fmac_f32 v240, v25, v129
    v_fmac_f32 v238, v18, v130
    v_fmac_f32 v240, v26, v130
    v_fmac_f32 v238, v19, v131
    v_fmac_f32 v240, v27, v131
    v_fmac_f32 v238, v20, v132
    v_fmac_f32 v240, v28, v132
    v_fmac_f32 v238, v21, v133
    v_fmac_f32 v240, v29, v133
    v_fmac_f32 v238, v22, v134
    v_fmac_f32 v240, v30, v134
    v_fmac_f32 v238, v23, v135
    v_fmac_f32 v240, v31, v135
    v_mul_f32 v235, v32, v104
    v_mul_f32 v237, v40, v136
    v_fmac_f32 v235, v33, v105
    v_fmac_f32 v237, v41, v137
    v_fmac_f32 v235, v34, v106
    v_fmac_f32 v237, v42, v138
    v_fmac_f32 v235, v35, v107
    v_fmac_f32 v237, v43, v139
    v_fmac_f32 v235, v36, v108
    v_fmac_f32 v237, v44, v140
    v_fmac_f32 v235, v37, v109
    v_fmac_f32 v237, v45, v141
    v_fmac_f32 v235, v38, v110
    v_fmac_f32 v237, v46, v142
    v_fmac_f32 v235, v39, v111
    v_fmac_f32 v237, v47, v143
    v_mul_f32 v239, v48, v136
    v_mul_f32 v241, v56, v136
    s_setprio 1
    s_waitcnt vmcnt(4) lgkmcnt(0)
    v_mfma_f32_32x32x16_bf16 v[0:15], v[64:67], v[176:179], 0
    ds_read_b64_tr_b16 v[184:185], v246 offset:2048
    ds_read_b64_tr_b16 v[186:187], v246 offset:2560
    ds_read_b64_tr_b16 v[188:189], v247 offset:2048
    ds_read_b64_tr_b16 v[190:191], v247 offset:2560
    v_fmac_f32 v239, v49, v137
    v_fmac_f32 v241, v57, v137
    s_mov_b32 m0, s68
    v_mfma_f32_32x32x16_bf16 v[16:31], v[68:71], v[176:179], 0
    buffer_load_dwordx4 v222, s[4:7], s42 offen sc1 lds
    buffer_load_dwordx4 v223, s[72:75], s42 offen offset:1024 sc1 lds
    v_fmac_f32 v239, v50, v138
    v_fmac_f32 v241, v58, v138
    v_fmac_f32 v239, v51, v139
    v_fmac_f32 v241, v59, v139
    v_fmac_f32 v239, v52, v140
    v_mfma_f32_32x32x16_bf16 v[32:47], v[64:67], v[180:183], 0
    v_fmac_f32 v241, v60, v140
    v_fmac_f32 v239, v53, v141
    v_fmac_f32 v241, v61, v141
    v_fmac_f32 v239, v54, v142
    v_fmac_f32 v241, v62, v142
    v_fmac_f32 v239, v55, v143
    v_fmac_f32 v241, v63, v143
    v_mfma_f32_32x32x16_bf16 v[48:63], v[68:71], v[180:183], 0
    v_permlane32_swap_b32 v234, v236
    v_permlane32_swap_b32 v235, v237
    v_permlane32_swap_b32 v240, v238
    s_waitcnt vmcnt(4) lgkmcnt(0)
    v_mfma_f32_32x32x16_bf16 v[0:15], v[72:75], v[184:187], v[0:15]
    ds_read_b64_tr_b16 v[176:177], v246 offset:4096
    ds_read_b64_tr_b16 v[178:179], v246 offset:4608
    ds_read_b64_tr_b16 v[180:181], v247 offset:4096
    ds_read_b64_tr_b16 v[182:183], v247 offset:4608
    v_permlane32_swap_b32 v241, v239
    s_mov_b32 m0, s69
    v_mfma_f32_32x32x16_bf16 v[16:31], v[76:79], v[184:187], v[16:31]
    buffer_load_dwordx4 v224, s[4:7], s42 offen sc1 lds
    buffer_load_dwordx4 v225, s[72:75], s42 offen offset:1024 sc1 lds
    v_lshl_add_u32 v230, v252, 1, s31
    v_add_f32 v234, v234, v236
    v_add_f32 v235, v235, v237
    v_add_f32 v240, v240, v238
    v_add_f32 v241, v241, v239
    v_mfma_f32_32x32x16_bf16 v[32:47], v[72:75], v[188:191], v[32:47]
    v_cvt_pk_bf16_f32 v234, v234, v235
    v_cvt_pk_bf16_f32 v240, v240, v241
    ds_write_b32 v230, v234 offset:0
    ds_write_b32 v230, v240 offset:256
    v_mfma_f32_32x32x16_bf16 v[48:63], v[76:79], v[188:191], v[48:63]
    s_waitcnt vmcnt(4) lgkmcnt(2)
    v_mfma_f32_32x32x16_bf16 v[0:15], v[80:83], v[176:179], v[0:15]
    ds_read_b64_tr_b16 v[184:185], v246 offset:6144
    ds_read_b64_tr_b16 v[186:187], v246 offset:6656
    ds_read_b64_tr_b16 v[188:189], v247 offset:6144
    ds_read_b64_tr_b16 v[190:191], v247 offset:6656
    s_mov_b32 m0, s70
    v_mfma_f32_32x32x16_bf16 v[16:31], v[84:87], v[176:179], v[16:31]
    buffer_load_dwordx4 v226, s[4:7], s42 offen sc1 lds
    buffer_load_dwordx4 v227, s[72:75], s42 offen offset:1024 sc1 lds
    v_mfma_f32_32x32x16_bf16 v[32:47], v[80:83], v[180:183], v[32:47]
    v_mfma_f32_32x32x16_bf16 v[48:63], v[84:87], v[180:183], v[48:63]
    s_waitcnt vmcnt(4) lgkmcnt(0)
    v_mfma_f32_32x32x16_bf16 v[0:15], v[88:91], v[184:187], v[0:15]
    ds_read_b64_tr_b16 v[176:177], v246 offset:0
    ds_read_b64_tr_b16 v[178:179], v246 offset:512
    ds_read_b64_tr_b16 v[180:181], v247 offset:0
    ds_read_b64_tr_b16 v[182:183], v247 offset:512
    s_mov_b32 m0, s71
    v_mfma_f32_32x32x16_bf16 v[16:31], v[92:95], v[184:187], v[16:31]
    buffer_load_dwordx4 v228, s[4:7], s42 offen sc1 lds
    buffer_load_dwordx4 v229, s[72:75], s42 offen offset:1024 sc1 lds
    v_mfma_f32_32x32x16_bf16 v[32:47], v[88:91], v[188:191], v[32:47]
    s_nop 2
    v_mul_f32 v234, v0, v144
    v_mul_f32 v236, v8, v112
    v_fmac_f32 v234, v1, v145
    v_fmac_f32 v236, v9, v113
    v_fmac_f32 v234, v2, v146
    v_fmac_f32 v236, v10, v114
    v_fmac_f32 v234, v3, v147
    v_mfma_f32_32x32x16_bf16 v[48:63], v[92:95], v[188:191], v[48:63]
    s_setprio 0
    v_fmac_f32 v236, v11, v115
    v_fmac_f32 v234, v4, v148
    v_fmac_f32 v236, v12, v116
    v_fmac_f32 v234, v5, v149
    v_fmac_f32 v236, v13, v117
    v_fmac_f32 v234, v6, v150
    v_fmac_f32 v236, v14, v118
    v_fmac_f32 v234, v7, v151
    v_fmac_f32 v236, v15, v119
    v_mul_f32 v238, v16, v160
    v_mul_f32 v240, v24, v160
    v_fmac_f32 v238, v17, v161
    v_fmac_f32 v240, v25, v161
    v_fmac_f32 v238, v18, v162
    v_fmac_f32 v240, v26, v162
    v_fmac_f32 v238, v19, v163
    v_fmac_f32 v240, v27, v163
    v_fmac_f32 v238, v20, v164
    v_fmac_f32 v240, v28, v164
    v_fmac_f32 v238, v21, v165
    v_fmac_f32 v240, v29, v165
    v_fmac_f32 v238, v22, v166
    v_fmac_f32 v240, v30, v166
    v_fmac_f32 v238, v23, v167
    v_fmac_f32 v240, v31, v167
    v_mul_f32 v235, v32, v152
    v_mul_f32 v237, v40, v120
    v_fmac_f32 v235, v33, v153
    v_fmac_f32 v237, v41, v121
    v_fmac_f32 v235, v34, v154
    v_fmac_f32 v237, v42, v122
    v_fmac_f32 v235, v35, v155
    v_fmac_f32 v237, v43, v123
    v_fmac_f32 v235, v36, v156
    v_fmac_f32 v237, v44, v124
    v_fmac_f32 v235, v37, v157
    v_fmac_f32 v237, v45, v125
    v_fmac_f32 v235, v38, v158
    v_fmac_f32 v237, v46, v126
    v_fmac_f32 v235, v39, v159
    v_fmac_f32 v237, v47, v127
    v_mul_f32 v239, v48, v168
    v_mul_f32 v241, v56, v168
    s_setprio 1
    s_waitcnt vmcnt(4) lgkmcnt(0)
    v_mfma_f32_32x32x16_bf16 v[0:15], v[64:67], v[176:179], 0
    ds_read_b64_tr_b16 v[184:185], v246 offset:2048
    ds_read_b64_tr_b16 v[186:187], v246 offset:2560
    ds_read_b64_tr_b16 v[188:189], v247 offset:2048
    ds_read_b64_tr_b16 v[190:191], v247 offset:2560
    v_fmac_f32 v239, v49, v169
    v_fmac_f32 v241, v57, v169
    s_mov_b32 m0, s68
    v_mfma_f32_32x32x16_bf16 v[16:31], v[68:71], v[176:179], 0
    buffer_load_dwordx4 v222, s[4:7], s43 offen sc1 lds
    buffer_load_dwordx4 v223, s[72:75], s43 offen offset:1024 sc1 lds
    v_fmac_f32 v239, v50, v170
    v_fmac_f32 v241, v58, v170
    v_fmac_f32 v239, v51, v171
    v_fmac_f32 v241, v59, v171
    v_fmac_f32 v239, v52, v172
    v_mfma_f32_32x32x16_bf16 v[32:47], v[64:67], v[180:183], 0
    v_fmac_f32 v241, v60, v172
    v_fmac_f32 v239, v53, v173
    v_fmac_f32 v241, v61, v173
    v_fmac_f32 v239, v54, v174
    v_fmac_f32 v241, v62, v174
    v_fmac_f32 v239, v55, v175
    v_fmac_f32 v241, v63, v175
    v_mfma_f32_32x32x16_bf16 v[48:63], v[68:71], v[180:183], 0
    s_waitcnt vmcnt(4) lgkmcnt(0)
    v_mfma_f32_32x32x16_bf16 v[0:15], v[72:75], v[184:187], v[0:15]
    ds_read_b64_tr_b16 v[176:177], v246 offset:4096
    ds_read_b64_tr_b16 v[178:179], v246 offset:4608
    ds_read_b64_tr_b16 v[180:181], v247 offset:4096
    ds_read_b64_tr_b16 v[182:183], v247 offset:4608
    s_mov_b32 m0, s69
    v_mfma_f32_32x32x16_bf16 v[16:31], v[76:79], v[184:187], v[16:31]
    buffer_load_dwordx4 v224, s[4:7], s43 offen sc1 lds
    buffer_load_dwordx4 v225, s[72:75], s43 offen offset:1024 sc1 lds
    v_mfma_f32_32x32x16_bf16 v[32:47], v[72:75], v[188:191], v[32:47]
    v_mfma_f32_32x32x16_bf16 v[48:63], v[76:79], v[188:191], v[48:63]
    s_waitcnt vmcnt(4) lgkmcnt(0)
    v_mfma_f32_32x32x16_bf16 v[0:15], v[80:83], v[176:179], v[0:15]
    ds_read_b64_tr_b16 v[184:185], v246 offset:6144
    ds_read_b64_tr_b16 v[186:187], v246 offset:6656
    ds_read_b64_tr_b16 v[188:189], v247 offset:6144
    ds_read_b64_tr_b16 v[190:191], v247 offset:6656
    s_mov_b32 m0, s70
    v_mfma_f32_32x32x16_bf16 v[16:31], v[84:87], v[176:179], v[16:31]
    buffer_load_dwordx4 v226, s[4:7], s43 offen sc1 lds
    buffer_load_dwordx4 v227, s[72:75], s43 offen offset:1024 sc1 lds
    v_mfma_f32_32x32x16_bf16 v[32:47], v[80:83], v[180:183], v[32:47]
    v_add_u32 v222, s48, v251
    ds_read_b32 v222, v222
    v_mfma_f32_32x32x16_bf16 v[48:63], v[84:87], v[180:183], v[48:63]
    s_waitcnt vmcnt(4) lgkmcnt(1)
    v_mfma_f32_32x32x16_bf16 v[0:15], v[88:91], v[184:187], v[0:15]
    ds_read_b64_tr_b16 v[176:177], v246 offset:0
    ds_read_b64_tr_b16 v[178:179], v246 offset:512
    ds_read_b64_tr_b16 v[180:181], v247 offset:0
    ds_read_b64_tr_b16 v[182:183], v247 offset:512
    s_mov_b32 m0, s71
    v_mfma_f32_32x32x16_bf16 v[16:31], v[92:95], v[184:187], v[16:31]
    buffer_load_dwordx4 v228, s[4:7], s43 offen sc1 lds
    buffer_load_dwordx4 v229, s[72:75], s43 offen offset:1024 sc1 lds
    s_waitcnt lgkmcnt(4)
    v_mad_u32_u16 v223, v222, s39, v248 op_sel:[1,0,0,0]
    v_mad_u32_u16 v222, v222, s39, v248
    v_mfma_f32_32x32x16_bf16 v[32:47], v[88:91], v[188:191], v[32:47]
    v_add_u32 v224, s49, v251
    ds_read_b32 v224, v224
    v_mul_f32 v242, v0, v144
    v_fma_f32 v238, v8, v160, -v238
    v_fmac_f32 v242, v1, v145
    v_fmac_f32 v238, v9, v161
    v_fmac_f32 v242, v2, v146
    v_mfma_f32_32x32x16_bf16 v[48:63], v[92:95], v[188:191], v[48:63]
    s_setprio 0
    v_fmac_f32 v238, v10, v162
    v_fmac_f32 v242, v3, v147
    v_fmac_f32 v238, v11, v163
    v_fmac_f32 v242, v4, v148
    v_fmac_f32 v238, v12, v164
    v_fmac_f32 v242, v5, v149
    v_fmac_f32 v238, v13, v165
    v_fmac_f32 v242, v6, v150
    v_fmac_f32 v238, v14, v166
    v_fmac_f32 v242, v7, v151
    v_fmac_f32 v238, v15, v167
    v_fmac_f32 v236, v16, v112
    v_mul_f32 v244, v24, v160
    v_fmac_f32 v236, v17, v113
    v_fmac_f32 v244, v25, v161
    v_fmac_f32 v236, v18, v114
    v_fmac_f32 v244, v26, v162
    v_fmac_f32 v236, v19, v115
    v_fmac_f32 v244, v27, v163
    v_fmac_f32 v236, v20, v116
    v_fmac_f32 v244, v28, v164
    v_fmac_f32 v236, v21, v117
    v_fmac_f32 v244, v29, v165
    v_fmac_f32 v236, v22, v118
    v_fmac_f32 v244, v30, v166
    v_fmac_f32 v236, v23, v119
    v_fmac_f32 v244, v31, v167
    v_mul_f32 v243, v32, v152
    v_fma_f32 v239, v40, v168, -v239
    v_fmac_f32 v243, v33, v153
    v_fmac_f32 v239, v41, v169
    v_fmac_f32 v243, v34, v154
    v_fmac_f32 v239, v42, v170
    v_fmac_f32 v243, v35, v155
    v_fmac_f32 v239, v43, v171
    v_fmac_f32 v243, v36, v156
    v_fmac_f32 v239, v44, v172
    v_fmac_f32 v243, v37, v157
    v_fmac_f32 v239, v45, v173
    v_fmac_f32 v243, v38, v158
    v_fmac_f32 v239, v46, v174
    v_fmac_f32 v243, v39, v159
    v_fmac_f32 v239, v47, v175
    v_fmac_f32 v237, v48, v120
    v_mul_f32 v245, v56, v168
    v_fmac_f32 v237, v49, v121
    v_fmac_f32 v245, v57, v169
    v_fmac_f32 v237, v50, v122
    v_fmac_f32 v245, v58, v170
    v_fmac_f32 v237, v51, v123
    s_setprio 1
    s_waitcnt vmcnt(4) lgkmcnt(1)
    v_mfma_f32_32x32x16_bf16 v[0:15], v[64:67], v[176:179], 0
    ds_read_b64_tr_b16 v[184:185], v246 offset:2048
    ds_read_b64_tr_b16 v[186:187], v246 offset:2560
    ds_read_b64_tr_b16 v[188:189], v247 offset:2048
    ds_read_b64_tr_b16 v[190:191], v247 offset:2560
    v_fmac_f32 v245, v59, v171
    v_fmac_f32 v237, v52, v124
    s_mov_b32 m0, s68
    v_mfma_f32_32x32x16_bf16 v[16:31], v[68:71], v[176:179], 0
    buffer_load_dwordx4 v222, s[4:7], s44 offen sc1 lds
    buffer_load_dwordx4 v223, s[72:75], s44 offen offset:1024 sc1 lds
    s_waitcnt lgkmcnt(4)
    v_mad_u32_u16 v225, v224, s39, v248 op_sel:[1,0,0,0]
    v_mad_u32_u16 v224, v224, s39, v248
    v_fmac_f32 v245, v60, v172
    v_fmac_f32 v237, v53, v125
    v_mfma_f32_32x32x16_bf16 v[32:47], v[64:67], v[180:183], 0
    v_add_u32 v226, s50, v251
    ds_read_b32 v226, v226
    v_fmac_f32 v245, v61, v173
    v_fmac_f32 v237, v54, v126
    v_fmac_f32 v245, v62, v174
    v_fmac_f32 v237, v55, v127
    v_fmac_f32 v245, v63, v175
    v_mfma_f32_32x32x16_bf16 v[48:63], v[68:71], v[180:183], 0
    v_permlane32_swap_b32 v242, v234
    v_permlane32_swap_b32 v243, v235
    v_add_f32 v242, v242, v234
    v_add_f32 v243, v243, v235
    s_waitcnt vmcnt(4) lgkmcnt(1)
    v_mfma_f32_32x32x16_bf16 v[0:15], v[72:75], v[184:187], v[0:15]
    ds_read_b64_tr_b16 v[176:177], v246 offset:4096
    ds_read_b64_tr_b16 v[178:179], v246 offset:4608
    ds_read_b64_tr_b16 v[180:181], v247 offset:4096
    ds_read_b64_tr_b16 v[182:183], v247 offset:4608
    v_cvt_pk_bf16_f32 v242, v242, v243
    ds_write_b32 v230, v242 offset:512
    s_mov_b32 m0, s69
    v_mfma_f32_32x32x16_bf16 v[16:31], v[76:79], v[184:187], v[16:31]
    buffer_load_dwordx4 v224, s[4:7], s45 offen sc1 lds
    buffer_load_dwordx4 v225, s[72:75], s45 offen offset:1024 sc1 lds
    s_waitcnt lgkmcnt(5)
    v_mad_u32_u16 v227, v226, s39, v248 op_sel:[1,0,0,0]
    v_mad_u32_u16 v226, v226, s39, v248
    v_mfma_f32_32x32x16_bf16 v[32:47], v[72:75], v[188:191], v[32:47]
    v_add_u32 v228, s51, v251
    ds_read_b32 v228, v228
    v_mfma_f32_32x32x16_bf16 v[48:63], v[76:79], v[188:191], v[48:63]
    s_waitcnt vmcnt(4) lgkmcnt(2)
    v_mfma_f32_32x32x16_bf16 v[0:15], v[80:83], v[176:179], v[0:15]
    ds_read_b64_tr_b16 v[184:185], v246 offset:6144
    ds_read_b64_tr_b16 v[186:187], v246 offset:6656
    ds_read_b64_tr_b16 v[188:189], v247 offset:6144
    ds_read_b64_tr_b16 v[190:191], v247 offset:6656
    s_mov_b32 s32, s31
    s_mov_b32 s31, s35
    s_mov_b32 m0, s70
    v_mfma_f32_32x32x16_bf16 v[16:31], v[84:87], v[176:179], v[16:31]
    buffer_load_dwordx4 v226, s[4:7], s46 offen sc1 lds
    buffer_load_dwordx4 v227, s[72:75], s46 offen offset:1024 sc1 lds
    s_waitcnt lgkmcnt(4)
    v_mad_u32_u16 v229, v228, s39, v248 op_sel:[1,0,0,0]
    v_mad_u32_u16 v228, v228, s39, v248
    s_sub_u32 s26, s48, s29
    s_mov_b32 s29, s48
    v_mfma_f32_32x32x16_bf16 v[32:47], v[80:83], v[180:183], v[32:47]
    s_mov_b32 s30, s3
    s_cmp_lg_u32 s36, 0
    s_cselect_b32 s56, s33, 0
    v_mfma_f32_32x32x16_bf16 v[48:63], v[84:87], v[180:183], v[48:63]
    s_waitcnt vmcnt(4) lgkmcnt(0)
    v_mfma_f32_32x32x16_bf16 v[0:15], v[88:91], v[184:187], v[0:15]
    ds_read_b64_tr_b16 v[176:177], v246 offset:0
    ds_read_b64_tr_b16 v[178:179], v246 offset:512
    ds_read_b64_tr_b16 v[180:181], v247 offset:0
    ds_read_b64_tr_b16 v[182:183], v247 offset:512
    s_mov_b32 m0, s71
    v_mfma_f32_32x32x16_bf16 v[16:31], v[92:95], v[184:187], v[16:31]
    buffer_load_dwordx4 v228, s[4:7], s47 offen sc1 lds
    buffer_load_dwordx4 v229, s[72:75], s47 offen offset:1024 sc1 lds
    v_mfma_f32_32x32x16_bf16 v[32:47], v[88:91], v[188:191], v[32:47]
    s_nop 2
    v_mul_f32 v242, v0, v144
    v_fma_f32 v240, v8, v160, -v240
    v_fmac_f32 v242, v1, v145
    v_fmac_f32 v240, v9, v161
    v_fmac_f32 v242, v2, v146
    v_fmac_f32 v240, v10, v162
    v_fmac_f32 v242, v3, v147
    v_mfma_f32_32x32x16_bf16 v[48:63], v[92:95], v[188:191], v[48:63]
    s_setprio 0
    v_fmac_f32 v240, v11, v163
    v_fmac_f32 v242, v4, v148
    v_fmac_f32 v240, v12, v164
    v_fmac_f32 v242, v5, v149
    v_fmac_f32 v240, v13, v165
    v_fmac_f32 v242, v6, v150
    v_fmac_f32 v240, v14, v166
    v_fmac_f32 v242, v7, v151
    v_fmac_f32 v240, v15, v167
    v_add_u32 v249, s26, v249
    v_add_u32 v250, s26, v250
    v_fma_f32 v244, v16, v160, -v244
    v_fmac_f32 v236, v24, v112
    v_fmac_f32 v244, v17, v161
    v_fmac_f32 v236, v25, v113
    v_fmac_f32 v244, v18, v162
    v_fmac_f32 v236, v26, v114
    v_fmac_f32 v244, v19, v163
    v_fmac_f32 v236, v27, v115
    v_fmac_f32 v244, v20, v164
    v_fmac_f32 v236, v28, v116
    v_fmac_f32 v244, v21, v165
    v_fmac_f32 v236, v29, v117
    v_fmac_f32 v244, v22, v166
    v_fmac_f32 v236, v30, v118
    v_fmac_f32 v244, v23, v167
    v_fmac_f32 v236, v31, v119
    ds_read_b64_tr_b16 v[0:1], v249 offset:0
    ds_read_b64_tr_b16 v[2:3], v249 offset:128
    ds_read_b128 v[4:7], v250 offset:0
    ds_read_b128 v[8:11], v250 offset:16
    ds_read_b128 v[12:15], v250 offset:384
    ds_read_b128 v[16:19], v250 offset:400
    v_mul_f32 v243, v32, v152
    v_fma_f32 v241, v40, v168, -v241
    v_fmac_f32 v243, v33, v153
    v_fmac_f32 v241, v41, v169
    v_fmac_f32 v243, v34, v154
    v_fmac_f32 v241, v42, v170
    v_fmac_f32 v243, v35, v155
    v_fmac_f32 v241, v43, v171
    v_fmac_f32 v243, v36, v156
    v_fmac_f32 v241, v44, v172
    v_fmac_f32 v243, v37, v157
    v_fmac_f32 v241, v45, v173
    v_fmac_f32 v243, v38, v158
    v_fmac_f32 v241, v46, v174
    v_fmac_f32 v243, v39, v159
    v_fmac_f32 v241, v47, v175
    ds_read_b64_tr_b16 v[20:21], v249 offset:512
    ds_read_b64_tr_b16 v[22:23], v249 offset:640
    ds_read_b128 v[24:27], v250 offset:64
    ds_read_b128 v[28:31], v250 offset:80
    ds_read_b128 v[32:35], v250 offset:448
    ds_read_b128 v[36:39], v250 offset:464
    v_fma_f32 v245, v48, v168, -v245
    v_fmac_f32 v237, v56, v120
    v_fmac_f32 v245, v49, v169
    v_fmac_f32 v237, v57, v121
    v_fmac_f32 v245, v50, v170
    v_fmac_f32 v237, v58, v122
    v_fmac_f32 v245, v51, v171
    v_fmac_f32 v237, v59, v123
    v_fmac_f32 v245, v52, v172
    v_fmac_f32 v237, v60, v124
    v_fmac_f32 v245, v53, v173
    v_fmac_f32 v237, v61, v125
    v_fmac_f32 v245, v54, v174
    v_fmac_f32 v237, v62, v126
    v_fmac_f32 v245, v55, v175
    v_fmac_f32 v237, v63, v127
    s_cmp_eq_u32 s56, 2
    s_cbranch_scc1 K2_U21
    s_cmp_eq_u32 s56, 3
    s_cbranch_scc1 K2_U31
    s_branch K2_DSP1
K2_nul_50:
    s_mov_b32 s58, 63
    s_mov_b32 s36, 0
    s_branch K2_back_53
K2_spin_51:
    s_sub_u32 s27, s27, 1
    s_cbranch_scc1 K2_END
    v_lshl_add_u32 v233, v252, 1, s53
    ds_read_b32 v233, v233
    s_waitcnt lgkmcnt(0)
    s_branch K2_chk_52
K2_dyn_48:
    v_mov_b32 v254, 163648
    v_mov_b32 v255, 1
    v_lshl_add_u32 v233, v252, 1, s53
    s_mov_b64 exec, 1
    ds_add_rtn_u32 v232, v254, v255
    s_mov_b64 exec, -1
    ds_read_b32 v233, v233
    s_waitcnt lgkmcnt(0)
    v_readfirstlane_b32 s58, v232
    s_nop 0
    s_cmp_lt_u32 s58, s22
    s_cbranch_scc0 K2_nul_50
    s_and_b32 s59, s58, 7
    s_lshr_b32 s60, s58, 3
K2_chk_52:
    v_readlane_b32 s61, v233, s59
    s_nop 0
    s_cmp_gt_u32 s61, s60
    s_cbranch_scc0 K2_spin_51
K2_back_53:
    s_mov_b32 s34, 1
    s_branch K2_back_49
K2_rare_54:
    s_cmp_eq_u32 s33, 4
    s_cbranch_scc1 K2_four_56
    s_mov_b32 s49, s48
    s_mov_b32 s51, s48
    s_add_u32 s45, s44, 256
    s_add_u32 s46, s44, 512
    s_add_u32 s47, s44, 768
    s_branch K2_back_55
K2_four_56:
    s_add_u32 s50, s48, 64
    s_lshr_b32 s51, s3, 27
    s_mov_b32 s66, 161536
    s_cmp_ge_u32 s51, 2
    s_cselect_b32 s66, 159072, s66
    s_mul_i32 s51, s51, 32
    s_add_u32 s51, s51, s66
    s_mov_b32 s46, s44
    s_mov_b32 s47, s44
    s_branch K2_back_55
K2_dum_57:
    v_mov_b32 v232, -1
    s_mov_b32 m0, 163712
    s_mov_b64 exec, 1
    buffer_load_dwordx4 v232, s[16:19], 0 offen lds
    buffer_load_dwordx4 v232, s[16:19], 0 offen lds
    s_mov_b64 exec, -1
    s_branch K2_back_59
K2_a4_58:
    s_lshr_b32 s65, s3, 27
    s_mov_b32 s66, 161536
    s_cmp_ge_u32 s65, 2
    s_cselect_b32 s66, 158112, s66
    s_mul_i32 s65, s65, 512
    s_add_u32 s65, s65, s66
    v_add_u32 v232, s65, v230
    ds_read_b32 v232, v232
    s_add_u32 m0, s65, 864
    s_waitcnt lgkmcnt(0)
    v_or_b32 v232, v232, v231
    buffer_load_dwordx4 v232, s[16:19], 0 offen  lds
    s_branch K2_b4_60
K2_nul_63:
    s_mov_b32 s58, 63
    s_mov_b32 s36, 0
    s_branch K2_back_66
K2_spin_64:
    s_sub_u32 s27, s27, 1
    s_cbranch_scc1 K2_END
    v_lshl_add_u32 v233, v252, 1, s53
    ds_read_b32 v233, v233
    s_waitcnt lgkmcnt(0)
    s_branch K2_chk_65
K2_dyn_61:
    v_mov_b32 v254, 163648
    v_mov_b32 v255, 1
    v_lshl_add_u32 v233, v252, 1, s53
    s_mov_b64 exec, 1
    ds_add_rtn_u32 v232, v254, v255
    s_mov_b64 exec, -1
    ds_read_b32 v233, v233
    s_waitcnt lgkmcnt(0)
    v_readfirstlane_b32 s58, v232
    s_nop 0
    s_cmp_lt_u32 s58, s22
    s_cbranch_scc0 K2_nul_63
    s_and_b32 s59, s58, 7
    s_lshr_b32 s60, s58, 3
K2_chk_65:
    v_readlane_b32 s61, v233, s59
    s_nop 0
    s_cmp_gt_u32 s61, s60
    s_cbranch_scc0 K2_spin_64
K2_back_66:
    s_mov_b32 s34, 1
    s_branch K2_back_62
K2_rare_67:
    s_cmp_eq_u32 s33, 4
    s_cbranch_scc1 K2_four_69
    s_mov_b32 s49, s48
    s_mov_b32 s51, s48
    s_add_u32 s45, s44, 256
    s_add_u32 s46, s44, 512
    s_add_u32 s47, s44, 768
    s_branch K2_back_68
K2_four_69:
    s_add_u32 s50, s48, 64
    s_lshr_b32 s51, s3, 27
    s_mov_b32 s66, 161536
    s_cmp_ge_u32 s51, 2
    s_cselect_b32 s66, 159072, s66
    s_mul_i32 s51, s51, 32
    s_add_u32 s51, s51, s66
    s_mov_b32 s46, s44
    s_mov_b32 s47, s44
    s_branch K2_back_68
K2_dum_70:
    v_mov_b32 v232, -1
    s_mov_b32 m0, 163712
    s_mov_b64 exec, 1
    buffer_load_dwordx4 v232, s[16:19], 0 offen lds
    buffer_load_dwordx4 v232, s[16:19], 0 offen lds
    s_mov_b64 exec, -1
    s_branch K2_back_72
K2_a4_71:
    s_lshr_b32 s65, s3, 27
    s_mov_b32 s66, 161536
    s_cmp_ge_u32 s65, 2
    s_cselect_b32 s66, 158112, s66
    s_mul_i32 s65, s65, 512
    s_add_u32 s65, s65, s66
    v_add_u32 v232, s65, v230
    ds_read_b32 v232, v232
    s_add_u32 m0, s65, 864
    s_waitcnt lgkmcnt(0)
    v_or_b32 v232, v232, v231
    buffer_load_dwordx4 v232, s[16:19], 0 offen  lds
    s_branch K2_b4_73
K2_nul_74:
    s_mov_b32 s58, 63
    s_mov_b32 s36, 0
    s_branch K2_back_77
K2_spin_75:
    s_sub_u32 s27, s27, 1
    s_cbranch_scc1 K2_END
    v_lshl_add_u32 v233, v252, 1, s53
    ds_read_b32 v233, v233
    s_waitcnt lgkmcnt(0)
    s_branch K2_chk_76
K2_rare_78:
    s_cmp_eq_u32 s33, 4
    s_cbranch_scc1 K2_four_80
    s_mov_b32 s49, s48
    s_mov_b32 s51, s48
    s_add_u32 s45, s44, 256
    s_add_u32 s46, s44, 512
    s_add_u32 s47, s44, 768
    s_branch K2_back_79
K2_four_80:
    s_add_u32 s50, s48, 64
    s_lshr_b32 s51, s3, 27
    s_mov_b32 s66, 161536
    s_cmp_ge_u32 s51, 2
    s_cselect_b32 s66, 159072, s66
    s_mul_i32 s51, s51, 32
    s_add_u32 s51, s51, s66
    s_mov_b32 s46, s44
    s_mov_b32 s47, s44
    s_branch K2_back_79
K2_nul_81:
    s_mov_b32 s58, 63
    s_mov_b32 s36, 0
    s_branch K2_back_84
K2_spin_82:
    s_sub_u32 s27, s27, 1
    s_cbranch_scc1 K2_END
    v_lshl_add_u32 v233, v252, 1, s53
    ds_read_b32 v233, v233
    s_waitcnt lgkmcnt(0)
    s_branch K2_chk_83
K2_rare_85:
    s_cmp_eq_u32 s33, 4
    s_cbranch_scc1 K2_four_87
    s_mov_b32 s49, s48
    s_mov_b32 s51, s48
    s_add_u32 s45, s44, 256
    s_add_u32 s46, s44, 512
    s_add_u32 s47, s44, 768
    s_branch K2_back_86
K2_four_87:
    s_add_u32 s50, s48, 64
    s_lshr_b32 s51, s3, 27
    s_mov_b32 s66, 161536
    s_cmp_ge_u32 s51, 2
    s_cselect_b32 s66, 159072, s66
    s_mul_i32 s51, s51, 32
    s_add_u32 s51, s51, s66
    s_mov_b32 s46, s44
    s_mov_b32 s47, s44
    s_branch K2_back_86
K2_END:
    s_endpgm
.section .rodata,"a"
.p2align 6
.amdhsa_kernel standalone__tensor_product_equiv_equiformer__graph_kernel
  .amdhsa_next_free_vgpr 256
  .amdhsa_next_free_sgpr 102
  .amdhsa_accum_offset 256
  .amdhsa_group_segment_fixed_size 0
  .amdhsa_kernarg_size 96
  .amdhsa_user_sgpr_count 2
  .amdhsa_user_sgpr_kernarg_segment_ptr 1
  .amdhsa_system_sgpr_workgroup_id_x 1
  .amdhsa_float_denorm_mode_32 3
.end_amdhsa_kernel
```

```asm
; @launch grid=(256,1,1) block=(512,1,1) lds=163840
.amdgcn_target "amdgcn-amd-amdhsa--gfx950"
.text
.globl standalone__tensor_product_equiv_equiformer__graph_kernel
.p2align 8
.type standalone__tensor_product_equiv_equiformer__graph_kernel,@function
standalone__tensor_product_equiv_equiformer__graph_kernel:
    s_cmp_ge_u32 s2, 256
    s_cbranch_scc1 K2_END
    s_load_dwordx16 s[80:95], s[0:1], 0
    s_load_dwordx4 s[96:99], s[0:1], 72
    s_load_dwordx2 s[100:101], s[0:1], 88
    s_memrealtime s[74:75]
    v_lshrrev_b32 v1, 6, v0
    s_mov_b32 s54, s2
    v_readfirstlane_b32 s20, v1
    s_mov_b64 exec, 0
    s_cmp_eq_u32 s20, 0
    s_cbranch_scc1 K2_PAD_S1
    s_cmp_eq_u32 s20, 1
    s_cbranch_scc1 K2_PAD_S2
    s_cmp_eq_u32 s20, 5
    s_cbranch_scc1 K2_PAD_H1
    s_cmp_eq_u32 s20, 6
    s_cbranch_scc1 K2_PAD_H2
    s_cmp_eq_u32 s20, 2
    s_cbranch_scc1 K2_PAD_H3
KS_HOP0:
    s_mov_b64 exec, -1
    v_and_b32 v8, 63, v0
    v_lshlrev_b32 v9, 4, v8
    v_mov_b32 v6, 0
    v_lshlrev_b32 v5, 4, v0
    v_mul_u32_u24 v4, 24, v0
    s_mul_i32 s64, s2, 5120
    s_mul_i32 s65, s2, 7680
    v_mov_b32 v176, v8
    v_mov_b32 v177, v0
    s_mul_i32 s21, s2, 625
    s_add_u32 s22, s21, 640
    s_add_u32 s21, s21, 15
    s_lshr_b32 s21, s21, 4
    s_lshr_b32 s22, s22, 4
    s_sub_u32 s22, s22, s21
    s_movk_i32 s39, 1024
    s_lshl_b32 s37, s20, 13
    s_mov_b32 s53, 163616
    s_lshl_b32 s52, s20, 2
    s_add_u32 s52, s52, s53
    s_add_u32 s68, s37, 0
    s_add_u32 s69, s37, 2048
    s_add_u32 s70, s37, 4096
    s_add_u32 s71, s37, 6144
    s_waitcnt lgkmcnt(0)
    s_mov_b32 s8, s100
    s_and_b32 s9, s101, 0xffff
    s_mov_b32 s10, 37748736
    s_mov_b32 s11, 0x20000
    s_cmp_lg_u32 s20, 7
    s_cbranch_scc1 KS_NOTAG
    s_mov_b32 s60, s98
    s_and_b32 s61, s99, 0xffff
    s_mov_b32 s62, 256
    s_mov_b32 s63, 0x20000
    s_cmp_lg_u32 s2, 0
    s_cbranch_scc1 KS_TAGLD
    s_or_b32 s24, s74, 1
    v_mov_b32 v10, s24
    v_mov_b32 v11, 0
    s_mov_b64 exec, 1
    buffer_atomic_cmpswap v[10:11], v6, s[60:63], 0 offen sc1
    s_mov_b64 exec, -1
KS_TAGLD:
    v_mov_b32 v14, 0
    s_barrier
    v_mov_b32 v76, 0
    v_mov_b32 v77, -1
    v_lshlrev_b32 v78, 2, v8
    v_add_u32 v78, 163424, v78
    s_mov_b64 exec, 0x1ff
    ds_write_b32 v78, v76 offset:192
    s_mov_b64 exec, 0xff
    ds_write_b32 v78, v77 offset:256
    s_mov_b64 exec, -1
    s_mov_b32 exec_hi, 0xffff
    ds_write_b32 v78, v76
    s_mov_b64 exec, 0x3f
    ds_write_b32 v78, v76 offset:228
    s_mov_b64 exec, -1
    s_mov_b64 exec, 1
    s_mov_b32 s24, 0x40000
    v_mov_b32 v12, 163728
KS_TAGW:
    buffer_load_dword v15, v6, s[60:63], 0 offen sc1
    s_waitcnt vmcnt(1)
    v_cmp_ne_u32 vcc, 0, v14
    s_nop 0
    s_cbranch_vccnz KS_TAGOK
    s_sub_u32 s24, s24, 1
    s_cbranch_scc1 K2_END
    buffer_load_dword v14, v6, s[60:63], 0 offen sc1
    s_waitcnt vmcnt(1)
    v_cmp_ne_u32 vcc, 0, v15
    s_nop 0
    s_cbranch_vccz KS_TAGW
    ds_write_b32 v12, v15
    s_branch KS_TAGOK2
KS_TAGOK:
    ds_write_b32 v12, v14
KS_TAGOK2:
    s_mov_b64 exec, -1
    s_waitcnt lgkmcnt(0)
    s_barrier
    s_branch KS_B3
KS_H0:
    s_barrier
    s_branch KS_HELP
K2_PAD_S1:
    s_branch KS_HOP0
KS_NOTAG:
    s_cmp_ge_u32 s20, 5
    s_cbranch_scc1 KS_HELP
    s_cmp_ge_u32 s2, 250
    s_cbranch_scc1 KS_IDLE
    s_mov_b32 s40, s88
    s_and_b32 s41, s89, 0xffff
    s_mov_b32 s42, 1280000
    s_mov_b32 s43, 0x20000
    buffer_load_dwordx4 v[12:15], v5, s[40:43], s64 offen
    s_mov_b32 s44, s86
    s_and_b32 s45, s87, 0xffff
    s_mov_b32 s46, 1280000
    s_mov_b32 s47, 0x20000
    s_mov_b32 s48, s82
    s_and_b32 s49, s83, 0xffff
    s_mov_b32 s50, 1920000
    s_mov_b32 s51, 0x20000
    buffer_load_dwordx4 v[16:19], v5, s[44:47], s64 offen
    buffer_load_dwordx4 v[20:23], v4, s[48:51], s65 offen
    buffer_load_dwordx2 v[24:25], v4, s[48:51], s65 offen offset:16
    v_lshlrev_b32 v2, 2, v0
    s_lshl_b32 s64, s64, 3
    v_lshl_add_u32 v3, v0, 7, s64
    v_mov_b32 v7, 1
    s_cmp_eq_u32 s20, 4
    s_cbranch_scc1 KS_NOCLR
    ds_write_b32 v2, v6
KS_NOCLR:
    s_waitcnt lgkmcnt(0)
    s_barrier
    s_mov_b64 exec, 0
    s_cmp_eq_u32 s20, 0
    s_cbranch_scc1 K2_PAD_B3
    s_cmp_eq_u32 s20, 1
    s_cbranch_scc1 K2_PAD_LD
    s_cmp_eq_u32 s20, 2
    s_cbranch_scc1 K2_PAD_NW
    s_cmp_eq_u32 s20, 3
    s_cbranch_scc1 K2_PAD_SC
    s_cmp_eq_u32 s20, 4
    s_cbranch_scc1 K2_PAD_SD
KS_HOP:
    s_mov_b64 exec, -1
    v_mul_u32_u24 v76, 2979, v0
    v_lshrrev_b32 v76, 16, v76
    v_mul_u32_u24 v77, 2048, v76
    v_lshl_add_u32 v78, v0, 4, v77
    v_add_u32 v78, 67584, v78
    v_add_u32 v79, 67200, v78
    v_mov_b32 v80, -1
    v_mov_b32 v81, -1
    v_cmp_gt_u32 vcc, 14, v76
    v_cmp_gt_u32 s[56:57], 12, v76
    v_mov_b32 v82, -1
    v_mov_b32 v83, -1
    s_mov_b64 exec, vcc
    ds_write_b128 v78, v[80:83]
    ds_write_b128 v78, v[80:83] offset:33600
    s_mov_b64 exec, s[56:57]
    ds_write_b128 v79, v[80:83]
    s_mov_b64 exec, -1
    s_mov_b32 s58, 429497
    s_movk_i32 s59, 625
    s_waitcnt vmcnt(3)
    v_mul_u32_u24 v28, s58, v12
    v_lshrrev_b32 v32, 27, v28
    v_bfe_u32 v36, v28, 24, 3
    v_lshlrev_b32 v32, 2, v32
    v_lshl_or_b32 v32, v36, 7, v32
    ds_add_rtn_u32 v36, v32, v7
    v_mul_u32_u24 v29, s58, v13
    v_lshrrev_b32 v33, 27, v29
    v_bfe_u32 v37, v29, 24, 3
    v_lshlrev_b32 v33, 2, v33
    v_lshl_or_b32 v33, v37, 7, v33
    ds_add_rtn_u32 v37, v33, v7
    v_mul_u32_u24 v30, s58, v14
    v_lshrrev_b32 v34, 27, v30
    v_bfe_u32 v38, v30, 24, 3
    v_lshlrev_b32 v34, 2, v34
    v_lshl_or_b32 v34, v38, 7, v34
    ds_add_rtn_u32 v38, v34, v7
    v_mul_u32_u24 v31, s58, v15
    v_lshrrev_b32 v35, 27, v31
    v_bfe_u32 v39, v31, 24, 3
    v_lshlrev_b32 v35, 2, v35
    v_lshl_or_b32 v35, v39, 7, v35
    ds_add_rtn_u32 v39, v35, v7
    v_lshrrev_b32 v28, 24, v28
    v_mad_u32_u24 v28, v28, s59, 15
    v_lshrrev_b32 v28, 4, v28
    v_sub_u32 v28, v12, v28
    v_add_u32 v12, 0, v3
    v_lshl_or_b32 v28, v28, 26, v12
    v_lshrrev_b32 v29, 24, v29
    v_mad_u32_u24 v29, v29, s59, 15
    v_lshrrev_b32 v29, 4, v29
    v_sub_u32 v29, v13, v29
    v_add_u32 v13, 32, v3
    v_lshl_or_b32 v29, v29, 26, v13
    v_lshrrev_b32 v30, 24, v30
    v_mad_u32_u24 v30, v30, s59, 15
    v_lshrrev_b32 v30, 4, v30
    v_sub_u32 v30, v14, v30
    v_add_u32 v14, 64, v3
    v_lshl_or_b32 v30, v30, 26, v14
    v_lshrrev_b32 v31, 24, v31
    v_mad_u32_u24 v31, v31, s59, 15
    v_lshrrev_b32 v31, 4, v31
    v_sub_u32 v31, v15, v31
    v_add_u32 v15, 96, v3
    v_lshl_or_b32 v31, v31, 26, v15
K2_PAD_S2:
    s_cbranch_execz KS_HOP0
    v_mov_b32 v59, 163728
    s_mul_i32 s65, s2, 1152
    s_add_u32 s65, s65, 6291456
    s_mul_i32 s64, s2, 20608
    s_waitcnt lgkmcnt(0)
    s_barrier
    ds_read_b128 v[40:43], v9
    ds_read_b32 v59, v59
    s_waitcnt lgkmcnt(1)
    v_add_u32 v45, v40, v41
    v_add_u32 v46, v45, v42
    v_add_u32 v47, v46, v43
    v_mov_b32 v58, v47
    s_nop 1
    v_add_u32_dpp v58, v58, v58 row_shr:1 row_mask:0xf bank_mask:0xf bound_ctrl:0
    s_nop 1
    v_add_u32_dpp v58, v58, v58 row_shr:2 row_mask:0xf bank_mask:0xf bound_ctrl:0
    s_nop 1
    v_add_u32_dpp v58, v58, v58 row_shr:4 row_mask:0xf bank_mask:0xf bound_ctrl:0
    s_nop 1
    v_add_u32_dpp v58, v58, v58 row_shr:8 row_mask:0xf bank_mask:0xf bound_ctrl:0
    s_nop 1
    v_add_u32_dpp v58, v58, v58 row_bcast:15 row_mask:0xa bank_mask:0xf
    s_nop 1
    v_add_u32_dpp v58, v58, v58 row_bcast:31 row_mask:0xc bank_mask:0xf
    v_sub_u32 v48, v58, v47
    v_add_u32 v49, v48, v40
    v_add_u32 v50, v48, v45
    v_add_u32 v51, v48, v46
    ds_write_b128 v9, v[48:51] offset:1024
    s_waitcnt vmcnt(0) lgkmcnt(1)
    s_cmp_lg_u32 s20, 4
    s_cbranch_scc1 KS_NOPUB
    v_lshl_or_b32 v56, v49, 11, v48
    v_lshl_or_b32 v57, v51, 11, v50
    v_lshl_or_b32 v56, v59, 22, v56
    v_lshl_or_b32 v57, v59, 22, v57
    buffer_store_dwordx4 v[56:59], v9, s[8:11], s65 offen sc1
KS_NOPUB:
    s_waitcnt lgkmcnt(0)
    ds_read_b32 v32, v32 offset:1024
    ds_read_b32 v33, v33 offset:1024
    ds_read_b32 v34, v34 offset:1024
    ds_read_b32 v35, v35 offset:1024
    v_and_b32 v60, 0xffff, v59
    v_and_b32 v61, 0xffff0000, v59
    s_mov_b32 s58, 0xffff0000
    v_mov_b32 v40, v20
    v_lshl_or_b32 v41, v21, 16, v60
    v_or_b32 v42, v61, v16
    v_mov_b32 v43, v28
    v_alignbit_b32 v44, v22, v21, 16
    v_and_or_b32 v45, v22, s58, v60
    v_or_b32 v46, v61, v17
    v_mov_b32 v47, v29
    v_mov_b32 v48, v23
    v_lshl_or_b32 v49, v24, 16, v60
    v_or_b32 v50, v61, v18
    v_mov_b32 v51, v30
    v_alignbit_b32 v52, v25, v24, 16
    v_and_or_b32 v53, v25, s58, v60
    v_or_b32 v54, v61, v19
    v_mov_b32 v55, v31
    s_waitcnt lgkmcnt(0)
    v_add_lshl_u32 v32, v32, v36, 4
    ds_write_b128 v32, v[40:43] offset:2048
    v_add_lshl_u32 v33, v33, v37, 4
    ds_write_b128 v33, v[44:47] offset:2048
    v_add_lshl_u32 v34, v34, v38, 4
    ds_write_b128 v34, v[48:51] offset:2048
    v_add_lshl_u32 v35, v35, v39, 4
    ds_write_b128 v35, v[52:55] offset:2048
    s_waitcnt lgkmcnt(0)
    s_barrier
    ds_read_b128 v[12:15], v5 offset:2048
    ds_read_b128 v[16:19], v5 offset:7168
    ds_read_b128 v[20:23], v5 offset:12288
    ds_read_b128 v[24:27], v5 offset:17408
    s_waitcnt lgkmcnt(3)
    buffer_store_dwordx4 v[12:15], v5, s[8:11], s64 offen sc1
    s_add_u32 s64, s64, 5120
    s_waitcnt lgkmcnt(2)
    buffer_store_dwordx4 v[16:19], v5, s[8:11], s64 offen sc1
    s_add_u32 s64, s64, 5120
    s_waitcnt lgkmcnt(1)
    buffer_store_dwordx4 v[20:23], v5, s[8:11], s64 offen sc1
    s_add_u32 s64, s64, 5120
    s_waitcnt lgkmcnt(0)
    buffer_store_dwordx4 v[24:27], v5, s[8:11], s64 offen sc1
    s_branch KS_JOIN
K2_PAD_B3:
    s_branch KS_HOP
KS_B3:
    v_mov_b32 v59, 163728
    ds_read_b32 v59, v59
    s_waitcnt lgkmcnt(0)
    s_barrier
KS_JOIN:
    v_readfirstlane_b32 s2, v59
    s_mov_b32 s23, 0
    s_mov_b32 s28, 1
    s_mov_b32 s24, 0
    s_mov_b32 s25, 1
K2_CELLS:
    v_lshrrev_b32 v178, 1, v177
    v_min_u32 v178, 249, v178
    v_mul_u32_u24 v72, 1152, v178
    s_and_b32 s58, s54, 7
    s_lshl_b32 s58, s58, 7
    s_lshr_b32 s59, s54, 5
    s_lshl_b32 s59, s59, 4
    s_add_u32 s67, s58, s59
    s_add_u32 s67, s67, 6291456
    buffer_load_dwordx4 v[76:79], v72, s[8:11], s67 offen sc1
    s_cmp_eq_u32 s28, 0
    s_cbranch_scc1 K2_NOSRD
    s_mov_b32 s4, s80
    s_and_b32 s5, s81, 0xffff
    s_mov_b32 s6, 10240000
    s_mov_b32 s7, 0x20000
    s_mov_b32 s12, s96
    s_and_b32 s13, s97, 0xffff
    s_mov_b32 s14, 10240000
    s_mov_b32 s15, 0x20000
    s_mov_b32 s16, s84
    s_and_b32 s17, s85, 0xffff
    s_mov_b32 s18, 10240000
    s_mov_b32 s19, 0x20000
    s_sub_u32 s80, s80, 1024
    s_subb_u32 s81, s81, 0
    s_mov_b32 s72, s80
    s_and_b32 s73, s81, 0xffff
    s_mov_b32 s74, 10241024
    s_mov_b32 s75, 0x20000
    s_mov_b64 exec, 0
    s_cmp_eq_u32 s20, 0
    s_cbranch_scc1 K2_PAD_U20
    s_cmp_eq_u32 s20, 1
    s_cbranch_scc1 K2_PAD_U30
    s_cmp_eq_u32 s20, 2
    s_cbranch_scc1 K2_PAD_U21
    s_cmp_eq_u32 s20, 3
    s_cbranch_scc1 K2_PAD_U31
    s_cmp_eq_u32 s20, 4
    s_cbranch_scc1 K2_PAD_SW
    s_cmp_eq_u32 s20, 5
    s_cbranch_scc1 K2_PAD_TL
    s_cmp_eq_u32 s20, 6
    s_cbranch_scc1 K2_PAD_T2
    s_cmp_eq_u32 s20, 7
    s_cbranch_scc1 K2_PAD_OV
K2_HOP:
    s_mov_b64 exec, -1
K2_NOSRD:
    v_and_b32 v84, 15, v176
    v_lshrrev_b32 v85, 5, v176
    v_bfe_u32 v86, v176, 4, 1
    v_lshrrev_b32 v87, 2, v84
    v_and_b32 v88, 3, v84
    v_lshl_add_u32 v89, v85, 3, v87
    v_lshlrev_b32 v249, 5, v89
    v_lshl_add_u32 v249, v88, 3, v249
    v_add_u32 v249, 864, v249
    v_mul_u32_u24 v250, 192, v86
    v_lshl_add_u32 v250, v85, 5, v250
    v_lshrrev_b32 v90, 1, v88
    v_lshl_add_u32 v90, v86, 1, v90
    v_bfe_u32 v91, v87, 1, 1
    v_lshlrev_b32 v91, 2, v91
    v_xor_b32 v90, v90, v91
    v_lshlrev_b32 v90, 4, v90
    v_lshl_add_u32 v90, v89, 7, v90
    v_and_b32 v91, 1, v88
    v_lshl_add_u32 v90, v91, 3, v90
    v_add_u32 v246, s37, v90
    v_xor_b32 v247, 64, v246
    v_lshrrev_b32 v90, 3, v176
    v_lshlrev_b32 v251, 2, v90
    v_add_u32 v251, 768, v251
    v_bfe_u32 v90, v90, 1, 1
    v_lshlrev_b32 v90, 2, v90
    v_and_b32 v91, 7, v176
    v_xor_b32 v90, v90, v91
    v_lshlrev_b32 v248, 4, v90
    v_lshlrev_b32 v252, 1, v176
    v_and_b32 v231, 1, v176
    v_lshlrev_b32 v231, 4, v231
    v_lshrrev_b32 v90, 1, v176
    v_lshlrev_b32 v90, 5, v90
    v_add_u32 v230, 864, v90
    s_lshl_b32 s59, s2, 22
    s_mov_b32 s60, 0x40000
    s_bfe_u32 s61, s54, 0x10004
    s_bfe_u32 s62, s54, 0x10003
    s_add_u32 s63, s61, s62
    s_mul_i32 s62, s62, 11
    s_sub_u32 s64, 11, s62
    v_cmp_gt_u32 vcc, 500, v177
    s_nop 0
    s_mov_b64 s[56:57], vcc
K2_POLL:
    s_waitcnt vmcnt(0)
    v_xor_b32 v73, s59, v76
    v_xor_b32 v74, s59, v77
    v_or_b32 v73, v73, v74
    v_xor_b32 v74, s2, v79
    v_lshrrev_b32 v73, 22, v73
    v_or_b32 v73, v73, v74
    v_cmp_ne_u32 vcc, 0, v73
    s_nop 0
    s_cbranch_vccz K2_POLLED
    s_sub_u32 s60, s60, 1
    s_cbranch_scc1 K2_END
    s_mov_b64 exec, vcc
    buffer_load_dwordx4 v[76:79], v72, s[8:11], s67 offen sc1
    s_mov_b64 exec, -1
    s_branch K2_POLL
K2_PAD_LD:
    s_branch KS_HOP
K2_POLLED:
    s_set_gpr_idx_on s61, gpr_idx(SRC0)
    s_nop 0
    v_bfe_u32 v179, v76, s62, 11
    s_set_gpr_idx_idx s63
    s_nop 0
    v_bfe_u32 v73, v76, s64, 11
    s_set_gpr_idx_off
    v_sub_u32 v73, v73, v179
    v_cndmask_b32 v73, 0, v73, s[56:57]
    v_and_b32 v1, 1, v177
    v_add_u32 v1, s23, v1
    v_sub_u32 v180, v73, v1
    v_add_u32 v179, v179, v1
    v_mul_u32_u24 v181, 20608, v178
    v_lshl_add_u32 v181, v179, 4, v181
    v_cmp_lt_i32 s[40:41], 0, v180
    v_add_u32 v182, 32, v181
    s_mov_b32 s65, 0
    s_mov_b64 exec, s[40:41]
    buffer_load_dwordx4 v[0:3], v181, s[8:11], 0 offen offset:0 sc1
    s_mov_b64 exec, -1
    v_cmp_lt_i32 s[42:43], 2, v180
    v_cmp_lt_i32 s[44:45], 4, v180
    v_cmp_lt_i32 s[46:47], 6, v180
    v_cmp_lt_i32 s[48:49], 8, v180
    v_cmp_lt_i32 s[50:51], 10, v180
    v_cmp_lt_i32 s[90:91], 12, v180
    v_cmp_lt_i32 s[92:93], 14, v180
    v_cmp_lt_i32 s[94:95], 16, v180
    v_cmp_lt_i32 s[96:97], 18, v180
    v_add_u32 v183, 64, v181
    v_add_u32 v184, 96, v181
    v_subrev_u32 v62, 1, v180
    v_ashrrev_i32 v62, 1, v62
    v_med3_i32 v62, v62, 0, 9
    s_cmp_eq_u64 s[42:43], 0
    s_cbranch_scc1 K2_LD_DONE
    v_mov_b32 v63, v62
    s_nop 1
    v_add_u32_dpp v63, v63, v63 row_shr:1 row_mask:0xf bank_mask:0xf bound_ctrl:0
    s_nop 1
    v_add_u32_dpp v63, v63, v63 row_shr:2 row_mask:0xf bank_mask:0xf bound_ctrl:0
    s_nop 1
    v_add_u32_dpp v63, v63, v63 row_shr:4 row_mask:0xf bank_mask:0xf bound_ctrl:0
    s_nop 1
    v_add_u32_dpp v63, v63, v63 row_shr:8 row_mask:0xf bank_mask:0xf bound_ctrl:0
    s_nop 1
    v_add_u32_dpp v63, v63, v63 row_bcast:15 row_mask:0xa bank_mask:0xf
    s_nop 1
    v_add_u32_dpp v63, v63, v63 row_bcast:31 row_mask:0xc bank_mask:0xf
    s_lshl_b32 s58, s20, 10
    s_add_u32 s58, s58, 45056
    v_readlane_b32 s59, v63, 63
    v_sub_u32 v63, v63, v62
    v_lshl_add_u32 v64, v63, 2, s58
    v_lshlrev_b32 v63, 5, v63
    v_sub_u32 v63, v182, v63
    s_cmp_gt_u32 s59, 189
    s_cbranch_scc1 K2_LD_GEN
    s_mov_b64 exec, s[42:43]
    s_cbranch_execz K2_LD_L
    ds_write_b32 v64, v63 offset:0
    s_mov_b64 exec, s[44:45]
    s_cbranch_execz K2_LD_L
    ds_write_b32 v64, v63 offset:4
    s_mov_b64 exec, s[46:47]
    s_cbranch_execz K2_LD_L
    ds_write_b32 v64, v63 offset:8
    s_mov_b64 exec, s[48:49]
    s_cbranch_execz K2_LD_L
    ds_write_b32 v64, v63 offset:12
    s_mov_b64 exec, s[50:51]
    s_cbranch_execz K2_LD_L
    ds_write_b32 v64, v63 offset:16
    s_mov_b64 exec, s[90:91]
    s_cbranch_execz K2_LD_L
    ds_write_b32 v64, v63 offset:20
    s_mov_b64 exec, s[92:93]
    s_cbranch_execz K2_LD_L
    ds_write_b32 v64, v63 offset:24
    s_mov_b64 exec, s[94:95]
    s_cbranch_execz K2_LD_L
    ds_write_b32 v64, v63 offset:28
    s_mov_b64 exec, s[96:97]
    s_cbranch_execz K2_LD_L
    ds_write_b32 v64, v63 offset:32
K2_LD_L:
    s_mov_b64 exec, -1
    v_lshl_add_u32 v63, v176, 2, s58
    v_lshlrev_b32 v62, 5, v176
    s_waitcnt lgkmcnt(0)
    ds_read_b32 v64, v63 offset:0
    ds_read_b32 v65, v63 offset:252
    ds_read_b32 v66, v63 offset:504
    s_min_u32 s60, s59, 63
    s_sub_u32 s59, s59, s60
    s_bfm_b64 s[42:43], s60, 0
    s_min_u32 s60, s59, 63
    s_sub_u32 s59, s59, s60
    s_bfm_b64 s[44:45], s60, 0
    s_min_u32 s60, s59, 63
    s_sub_u32 s59, s59, s60
    s_bfm_b64 s[46:47], s60, 0
    s_mov_b64 s[48:49], 0
    s_mov_b32 s65, 1
    s_mov_b32 s60, 0
    s_waitcnt lgkmcnt(2)
    v_add3_u32 v182, v62, v64, s60
    s_mov_b64 exec, s[42:43]
    buffer_load_dwordx4 v[4:7], v182, s[8:11], 0 offen sc1
    s_mov_b32 s60, 2016
    s_waitcnt lgkmcnt(1)
    v_add3_u32 v183, v62, v65, s60
    s_mov_b64 exec, s[44:45]
    buffer_load_dwordx4 v[8:11], v183, s[8:11], 0 offen sc1
    s_mov_b32 s60, 4032
    s_waitcnt lgkmcnt(0)
    v_add3_u32 v184, v62, v66, s60
    s_mov_b64 exec, s[46:47]
    buffer_load_dwordx4 v[12:15], v184, s[8:11], 0 offen sc1
K2_LD_DONE:
    s_mov_b64 exec, -1
    s_cmp_eq_u32 s28, 0
    s_cbranch_scc1 K2_NOWRAW
    v_lshrrev_b32 v60, 5, v176
    v_bfe_u32 v61, v176, 2, 2
    v_lshl_add_u32 v60, v60, 2, v61
    v_mul_u32_u24 v60, 1280, v60
    v_bfe_u32 v61, v176, 4, 1
    v_lshl_add_u32 v60, v61, 5, v60
    v_and_b32 v61, 3, v176
    v_lshl_add_u32 v60, v61, 3, v60
    ds_read_b64_tr_b16 v[136:137], v60 offset:24576
    ds_read_b64_tr_b16 v[138:139], v60 offset:34816
    ds_read_b64_tr_b16 v[140:141], v60 offset:24640
    ds_read_b64_tr_b16 v[142:143], v60 offset:34880
    ds_read_b64_tr_b16 v[144:145], v60 offset:24832
    ds_read_b64_tr_b16 v[146:147], v60 offset:35072
    ds_read_b64_tr_b16 v[148:149], v60 offset:24896
    ds_read_b64_tr_b16 v[150:151], v60 offset:35136
    ds_read_b64_tr_b16 v[152:153], v60 offset:25088
    ds_read_b64_tr_b16 v[154:155], v60 offset:35328
    ds_read_b64_tr_b16 v[156:157], v60 offset:25152
    ds_read_b64_tr_b16 v[158:159], v60 offset:35392
    ds_read_b64_tr_b16 v[160:161], v60 offset:25344
    ds_read_b64_tr_b16 v[162:163], v60 offset:35584
    ds_read_b64_tr_b16 v[164:165], v60 offset:25408
    ds_read_b64_tr_b16 v[166:167], v60 offset:35648
    ds_read_b64_tr_b16 v[168:169], v60 offset:25600
    ds_read_b64_tr_b16 v[170:171], v60 offset:35840
    ds_read_b64_tr_b16 v[172:173], v60 offset:25664
    ds_read_b64_tr_b16 v[174:175], v60 offset:35904
    s_waitcnt lgkmcnt(0)
    v_lshlrev_b32 v96, 16, v136
    v_and_b32 v97, 0xffff0000, v136
    v_lshlrev_b32 v98, 16, v137
    v_and_b32 v99, 0xffff0000, v137
    v_lshlrev_b32 v100, 16, v138
    v_and_b32 v101, 0xffff0000, v138
    v_lshlrev_b32 v102, 16, v139
    v_and_b32 v103, 0xffff0000, v139
    v_lshlrev_b32 v104, 16, v140
    v_and_b32 v105, 0xffff0000, v140
    v_lshlrev_b32 v106, 16, v141
    v_and_b32 v107, 0xffff0000, v141
    v_lshlrev_b32 v108, 16, v142
    v_and_b32 v109, 0xffff0000, v142
    v_lshlrev_b32 v110, 16, v143
    v_and_b32 v111, 0xffff0000, v143
    v_lshlrev_b32 v112, 16, v144
    v_and_b32 v113, 0xffff0000, v144
    v_lshlrev_b32 v114, 16, v145
    v_and_b32 v115, 0xffff0000, v145
    v_lshlrev_b32 v116, 16, v146
    v_and_b32 v117, 0xffff0000, v146
    v_lshlrev_b32 v118, 16, v147
    v_and_b32 v119, 0xffff0000, v147
    v_lshlrev_b32 v120, 16, v148
    v_and_b32 v121, 0xffff0000, v148
    v_lshlrev_b32 v122, 16, v149
    v_and_b32 v123, 0xffff0000, v149
    v_lshlrev_b32 v124, 16, v150
    v_and_b32 v125, 0xffff0000, v150
    v_lshlrev_b32 v126, 16, v151
    v_and_b32 v127, 0xffff0000, v151
    v_lshlrev_b32 v128, 16, v152
    v_and_b32 v129, 0xffff0000, v152
    v_lshlrev_b32 v130, 16, v153
    v_and_b32 v131, 0xffff0000, v153
    v_lshlrev_b32 v132, 16, v154
    v_and_b32 v133, 0xffff0000, v154
    v_lshlrev_b32 v134, 16, v155
    v_and_b32 v135, 0xffff0000, v155
    v_lshlrev_b32 v136, 16, v156
    v_and_b32 v137, 0xffff0000, v156
    v_lshlrev_b32 v138, 16, v157
    v_and_b32 v139, 0xffff0000, v157
    v_lshlrev_b32 v140, 16, v158
    v_and_b32 v141, 0xffff0000, v158
    v_lshlrev_b32 v142, 16, v159
    v_and_b32 v143, 0xffff0000, v159
    v_lshlrev_b32 v144, 16, v160
    v_and_b32 v145, 0xffff0000, v160
    v_lshlrev_b32 v146, 16, v161
    v_and_b32 v147, 0xffff0000, v161
    v_lshlrev_b32 v148, 16, v162
    v_and_b32 v149, 0xffff0000, v162
    v_lshlrev_b32 v150, 16, v163
    v_and_b32 v151, 0xffff0000, v163
    v_lshlrev_b32 v152, 16, v164
    v_and_b32 v153, 0xffff0000, v164
    v_lshlrev_b32 v154, 16, v165
    v_and_b32 v155, 0xffff0000, v165
    v_lshlrev_b32 v156, 16, v166
    v_and_b32 v157, 0xffff0000, v166
    v_lshlrev_b32 v158, 16, v167
    v_and_b32 v159, 0xffff0000, v167
    v_lshlrev_b32 v160, 16, v168
    v_and_b32 v161, 0xffff0000, v168
    v_lshlrev_b32 v162, 16, v169
    v_and_b32 v163, 0xffff0000, v169
    v_lshlrev_b32 v164, 16, v170
    v_and_b32 v165, 0xffff0000, v170
    v_lshlrev_b32 v166, 16, v171
    v_and_b32 v167, 0xffff0000, v171
    v_lshlrev_b32 v168, 16, v172
    v_and_b32 v169, 0xffff0000, v172
    v_lshlrev_b32 v170, 16, v173
    v_and_b32 v171, 0xffff0000, v173
    v_lshlrev_b32 v172, 16, v174
    v_and_b32 v173, 0xffff0000, v174
    v_lshlrev_b32 v174, 16, v175
    v_and_b32 v175, 0xffff0000, v175
K2_NOWRAW:
K2_PAD_NW:
    s_cbranch_execz KS_HOP
    v_lshrrev_b32 v179, 2, v181
    v_lshrrev_b32 v185, 2, v182
    v_lshrrev_b32 v186, 2, v183
    v_lshrrev_b32 v187, 2, v184
    s_mov_b32 s66, 7340032
    v_mov_b32 v201, 1
    s_movk_i32 s58, 600
    s_movk_i32 s59, 2400
    s_mov_b32 s60, 0x40000
    s_mov_b32 s61, 0xffff
    v_mov_b32 v202, 65536
    s_cmp_lg_u32 s24, 0
    s_cbranch_scc1 K2_RK_LOAD
    v_cmp_lt_i32 vcc, 20, v180
    s_nop 0
    s_cbranch_vccz K2_NOMORE
    v_mov_b32 v61, 163652
    ds_write_b32 v61, v201
K2_NOMORE:
    v_lshlrev_b32 v72, 4, v176
    s_mov_b32 s64, 7176192
    s_mov_b32 s62, 84736
    s_cmp_eq_u32 s65, 0
    s_waitcnt vmcnt(3)
    s_cbranch_scc0 K2_ARR
    s_waitcnt vmcnt(0)
K2_ARR:
    s_mov_b64 exec, s[40:41]
    s_cbranch_execz K2_RK_A
K2_CK0:
    v_bfi_b32 v192, s61, v1, v2
    v_lshrrev_b32 v50, 24, v3
    v_cmp_ne_u32 vcc, s2, v192
    v_add_u32 v40, 163424, v50
    s_cbranch_vccnz K2_RT0
    ds_add_rtn_u32 v40, v40, v201
    v_mad_u32_u24 v50, v50, s58, v202
    s_mov_b64 exec, s[42:43]
    s_cbranch_execz K2_RK_A
    s_waitcnt vmcnt(2)
K2_CK1:
    v_bfi_b32 v192, s61, v5, v6
    v_lshrrev_b32 v51, 24, v7
    v_cmp_ne_u32 vcc, s2, v192
    v_add_u32 v41, 163424, v51
    s_cbranch_vccnz K2_RT1
    ds_add_rtn_u32 v41, v41, v201
    v_mad_u32_u24 v51, v51, s58, v202
    s_mov_b64 exec, s[44:45]
    s_cbranch_execz K2_RK_A
    s_waitcnt vmcnt(1)
K2_CK2:
    v_bfi_b32 v192, s61, v9, v10
    v_lshrrev_b32 v52, 24, v11
    v_cmp_ne_u32 vcc, s2, v192
    v_add_u32 v42, 163424, v52
    s_cbranch_vccnz K2_RT2
    ds_add_rtn_u32 v42, v42, v201
    v_mad_u32_u24 v52, v52, s58, v202
    s_mov_b64 exec, s[46:47]
    s_cbranch_execz K2_RK_A
    s_waitcnt vmcnt(0)
K2_CK3:
    v_bfi_b32 v192, s61, v13, v14
    v_lshrrev_b32 v53, 24, v15
    v_cmp_ne_u32 vcc, s2, v192
    v_add_u32 v43, 163424, v53
    s_cbranch_vccnz K2_RT3
    ds_add_rtn_u32 v43, v43, v201
    v_mad_u32_u24 v53, v53, s58, v202
    s_mov_b64 exec, s[48:49]
    s_cbranch_execz K2_RK_A
K2_CK4:
    v_bfi_b32 v192, s61, v17, v18
    v_lshrrev_b32 v54, 24, v19
    v_cmp_ne_u32 vcc, s2, v192
    v_add_u32 v44, 163424, v54
    s_cbranch_vccnz K2_RT4
    ds_add_rtn_u32 v44, v44, v201
    v_mad_u32_u24 v54, v54, s58, v202
    s_mov_b64 exec, s[50:51]
    s_cbranch_execz K2_RK_A
K2_CK5:
    v_bfi_b32 v192, s61, v21, v22
    v_lshrrev_b32 v55, 24, v23
    v_cmp_ne_u32 vcc, s2, v192
    v_add_u32 v45, 163424, v55
    s_cbranch_vccnz K2_RT5
    ds_add_rtn_u32 v45, v45, v201
    v_mad_u32_u24 v55, v55, s58, v202
    s_mov_b64 exec, s[90:91]
    s_cbranch_execz K2_RK_A
K2_CK6:
    v_bfi_b32 v192, s61, v25, v26
    v_lshrrev_b32 v56, 24, v27
    v_cmp_ne_u32 vcc, s2, v192
    v_add_u32 v46, 163424, v56
    s_cbranch_vccnz K2_RT6
    ds_add_rtn_u32 v46, v46, v201
    v_mad_u32_u24 v56, v56, s58, v202
    s_mov_b64 exec, s[92:93]
    s_cbranch_execz K2_RK_A
K2_CK7:
    v_bfi_b32 v192, s61, v29, v30
    v_lshrrev_b32 v57, 24, v31
    v_cmp_ne_u32 vcc, s2, v192
    v_add_u32 v47, 163424, v57
    s_cbranch_vccnz K2_RT7
    ds_add_rtn_u32 v47, v47, v201
    v_mad_u32_u24 v57, v57, s58, v202
    s_mov_b64 exec, s[94:95]
    s_cbranch_execz K2_RK_A
K2_CK8:
    v_bfi_b32 v192, s61, v33, v34
    v_lshrrev_b32 v58, 24, v35
    v_cmp_ne_u32 vcc, s2, v192
    v_add_u32 v48, 163424, v58
    s_cbranch_vccnz K2_RT8
    ds_add_rtn_u32 v48, v48, v201
    v_mad_u32_u24 v58, v58, s58, v202
    s_mov_b64 exec, s[96:97]
    s_cbranch_execz K2_RK_A
K2_CK9:
    v_bfi_b32 v192, s61, v37, v38
    v_lshrrev_b32 v59, 24, v39
    v_cmp_ne_u32 vcc, s2, v192
    v_add_u32 v49, 163424, v59
    s_cbranch_vccnz K2_RT9
    ds_add_rtn_u32 v49, v49, v201
    v_mad_u32_u24 v59, v59, s58, v202
K2_RK_A:
    s_mov_b64 exec, -1
    s_cmp_eq_u32 s20, 7
    s_cbranch_scc1 K2_FLGLD
K2_FLGL2:
    s_mov_b64 exec, s[40:41]
    s_cbranch_execz K2_TP
    v_cmp_gt_u32 vcc, s62, v50
    v_and_b32 v3, 0xffffff, v3
    s_mov_b64 exec, vcc
    buffer_load_dword v245, v3, s[16:19], 0 offen
    s_mov_b64 exec, s[42:43]
    s_cbranch_execz K2_TP
    v_cmp_gt_u32 vcc, s62, v51
    v_and_b32 v7, 0xffffff, v7
    s_mov_b64 exec, vcc
    buffer_load_dword v245, v7, s[16:19], 0 offen
    s_mov_b64 exec, s[44:45]
    s_cbranch_execz K2_TP
    v_cmp_gt_u32 vcc, s62, v52
    v_and_b32 v11, 0xffffff, v11
    s_mov_b64 exec, vcc
    buffer_load_dword v245, v11, s[16:19], 0 offen
    s_mov_b64 exec, s[46:47]
    s_cbranch_execz K2_TP
    v_cmp_gt_u32 vcc, s62, v53
    v_and_b32 v15, 0xffffff, v15
    s_mov_b64 exec, vcc
    buffer_load_dword v245, v15, s[16:19], 0 offen
    s_mov_b64 exec, s[48:49]
    s_cbranch_execz K2_TP
    v_cmp_gt_u32 vcc, s62, v54
    v_and_b32 v19, 0xffffff, v19
    s_mov_b64 exec, vcc
    buffer_load_dword v245, v19, s[16:19], 0 offen
    s_mov_b64 exec, s[50:51]
    s_cbranch_execz K2_TP
    v_cmp_gt_u32 vcc, s62, v55
    v_and_b32 v23, 0xffffff, v23
    s_mov_b64 exec, vcc
    buffer_load_dword v245, v23, s[16:19], 0 offen
    s_mov_b64 exec, s[90:91]
    s_cbranch_execz K2_TP
    v_cmp_gt_u32 vcc, s62, v56
    v_and_b32 v27, 0xffffff, v27
    s_mov_b64 exec, vcc
    buffer_load_dword v245, v27, s[16:19], 0 offen
    s_mov_b64 exec, s[92:93]
    s_cbranch_execz K2_TP
    v_cmp_gt_u32 vcc, s62, v57
    v_and_b32 v31, 0xffffff, v31
    s_mov_b64 exec, vcc
    buffer_load_dword v245, v31, s[16:19], 0 offen
    s_mov_b64 exec, s[94:95]
    s_cbranch_execz K2_TP
    v_cmp_gt_u32 vcc, s62, v58
    v_and_b32 v35, 0xffffff, v35
    s_mov_b64 exec, vcc
    buffer_load_dword v245, v35, s[16:19], 0 offen
    s_mov_b64 exec, s[96:97]
    s_cbranch_execz K2_TP
    v_cmp_gt_u32 vcc, s62, v59
    v_and_b32 v39, 0xffffff, v39
    s_mov_b64 exec, vcc
    buffer_load_dword v245, v39, s[16:19], 0 offen
K2_TP:
    s_mov_b64 exec, -1
K2_RK_DONE:
K2_PAD_SC:
    s_cbranch_execz KS_HOP
    s_mul_i32 s67, s24, 48
    s_mov_b32 s58, 1
    s_waitcnt lgkmcnt(0)
    s_mov_b64 exec, s[40:41]
    s_cbranch_execz K2_SC_DONE
    v_cmpx_gt_u32 vcc, 48, v40
    v_lshl_add_u32 v194, v40, 5, v50
    v_lshl_add_u32 v195, v40, 2, v50
    v_lshrrev_b32 v193, 3, v40
    v_mad_i32_i24 v196, v193, -16, v195
    v_and_b32 v193, 1, v193
    v_mad_i32_i24 v196, v193, -14, v196
    ds_write_b32 v194, v3 offset:864
    ds_write_b16 v195, v0 offset:194
    ds_write_b16_d16_hi v195, v0 offset:386
    ds_write_b16_d16_hi v195, v1 offset:578
    ds_write_b16 v196, v2 offset:768
    s_cmp_lg_u64 exec, s[40:41]
    s_addc_u32 s58, s58, s58
    s_mov_b64 exec, s[42:43]
    s_cbranch_execz K2_SC_DONE
    v_cmpx_gt_u32 vcc, 48, v41
    v_lshl_add_u32 v194, v41, 5, v51
    v_lshl_add_u32 v195, v41, 2, v51
    v_lshrrev_b32 v193, 3, v41
    v_mad_i32_i24 v196, v193, -16, v195
    v_and_b32 v193, 1, v193
    v_mad_i32_i24 v196, v193, -14, v196
    ds_write_b32 v194, v7 offset:864
    ds_write_b16 v195, v4 offset:194
    ds_write_b16_d16_hi v195, v4 offset:386
    ds_write_b16_d16_hi v195, v5 offset:578
    ds_write_b16 v196, v6 offset:768
    s_cmp_lg_u64 exec, s[42:43]
    s_addc_u32 s58, s58, s58
    s_mov_b64 exec, s[44:45]
    s_cbranch_execz K2_SC_DONE
    v_cmpx_gt_u32 vcc, 48, v42
    v_lshl_add_u32 v194, v42, 5, v52
    v_lshl_add_u32 v195, v42, 2, v52
    v_lshrrev_b32 v193, 3, v42
    v_mad_i32_i24 v196, v193, -16, v195
    v_and_b32 v193, 1, v193
    v_mad_i32_i24 v196, v193, -14, v196
    ds_write_b32 v194, v11 offset:864
    ds_write_b16 v195, v8 offset:194
    ds_write_b16_d16_hi v195, v8 offset:386
    ds_write_b16_d16_hi v195, v9 offset:578
    ds_write_b16 v196, v10 offset:768
    s_cmp_lg_u64 exec, s[44:45]
    s_addc_u32 s58, s58, s58
    s_mov_b64 exec, s[46:47]
    s_cbranch_execz K2_SC_DONE
    v_cmpx_gt_u32 vcc, 48, v43
    v_lshl_add_u32 v194, v43, 5, v53
    v_lshl_add_u32 v195, v43, 2, v53
    v_lshrrev_b32 v193, 3, v43
    v_mad_i32_i24 v196, v193, -16, v195
    v_and_b32 v193, 1, v193
    v_mad_i32_i24 v196, v193, -14, v196
    ds_write_b32 v194, v15 offset:864
    ds_write_b16 v195, v12 offset:194
    ds_write_b16_d16_hi v195, v12 offset:386
    ds_write_b16_d16_hi v195, v13 offset:578
    ds_write_b16 v196, v14 offset:768
    s_cmp_lg_u64 exec, s[46:47]
    s_addc_u32 s58, s58, s58
    s_mov_b64 exec, s[48:49]
    s_cbranch_execz K2_SC_DONE
    v_cmpx_gt_u32 vcc, 48, v44
    v_lshl_add_u32 v194, v44, 5, v54
    v_lshl_add_u32 v195, v44, 2, v54
    v_lshrrev_b32 v193, 3, v44
    v_mad_i32_i24 v196, v193, -16, v195
    v_and_b32 v193, 1, v193
    v_mad_i32_i24 v196, v193, -14, v196
    ds_write_b32 v194, v19 offset:864
    ds_write_b16 v195, v16 offset:194
    ds_write_b16_d16_hi v195, v16 offset:386
    ds_write_b16_d16_hi v195, v17 offset:578
    ds_write_b16 v196, v18 offset:768
    s_cmp_lg_u64 exec, s[48:49]
    s_addc_u32 s58, s58, s58
    s_mov_b64 exec, s[50:51]
    s_cbranch_execz K2_SC_DONE
    v_cmpx_gt_u32 vcc, 48, v45
    v_lshl_add_u32 v194, v45, 5, v55
    v_lshl_add_u32 v195, v45, 2, v55
    v_lshrrev_b32 v193, 3, v45
    v_mad_i32_i24 v196, v193, -16, v195
    v_and_b32 v193, 1, v193
    v_mad_i32_i24 v196, v193, -14, v196
    ds_write_b32 v194, v23 offset:864
    ds_write_b16 v195, v20 offset:194
    ds_write_b16_d16_hi v195, v20 offset:386
    ds_write_b16_d16_hi v195, v21 offset:578
    ds_write_b16 v196, v22 offset:768
    s_cmp_lg_u64 exec, s[50:51]
    s_addc_u32 s58, s58, s58
    s_mov_b64 exec, s[90:91]
    s_cbranch_execz K2_SC_DONE
    v_cmpx_gt_u32 vcc, 48, v46
    v_lshl_add_u32 v194, v46, 5, v56
    v_lshl_add_u32 v195, v46, 2, v56
    v_lshrrev_b32 v193, 3, v46
    v_mad_i32_i24 v196, v193, -16, v195
    v_and_b32 v193, 1, v193
    v_mad_i32_i24 v196, v193, -14, v196
    ds_write_b32 v194, v27 offset:864
    ds_write_b16 v195, v24 offset:194
    ds_write_b16_d16_hi v195, v24 offset:386
    ds_write_b16_d16_hi v195, v25 offset:578
    ds_write_b16 v196, v26 offset:768
    s_cmp_lg_u64 exec, s[90:91]
    s_addc_u32 s58, s58, s58
    s_mov_b64 exec, s[92:93]
    s_cbranch_execz K2_SC_DONE
    v_cmpx_gt_u32 vcc, 48, v47
    v_lshl_add_u32 v194, v47, 5, v57
    v_lshl_add_u32 v195, v47, 2, v57
    v_lshrrev_b32 v193, 3, v47
    v_mad_i32_i24 v196, v193, -16, v195
    v_and_b32 v193, 1, v193
    v_mad_i32_i24 v196, v193, -14, v196
    ds_write_b32 v194, v31 offset:864
    ds_write_b16 v195, v28 offset:194
    ds_write_b16_d16_hi v195, v28 offset:386
    ds_write_b16_d16_hi v195, v29 offset:578
    ds_write_b16 v196, v30 offset:768
    s_cmp_lg_u64 exec, s[92:93]
    s_addc_u32 s58, s58, s58
    s_mov_b64 exec, s[94:95]
    s_cbranch_execz K2_SC_DONE
    v_cmpx_gt_u32 vcc, 48, v48
    v_lshl_add_u32 v194, v48, 5, v58
    v_lshl_add_u32 v195, v48, 2, v58
    v_lshrrev_b32 v193, 3, v48
    v_mad_i32_i24 v196, v193, -16, v195
    v_and_b32 v193, 1, v193
    v_mad_i32_i24 v196, v193, -14, v196
    ds_write_b32 v194, v35 offset:864
    ds_write_b16 v195, v32 offset:194
    ds_write_b16_d16_hi v195, v32 offset:386
    ds_write_b16_d16_hi v195, v33 offset:578
    ds_write_b16 v196, v34 offset:768
    s_cmp_lg_u64 exec, s[94:95]
    s_addc_u32 s58, s58, s58
    s_mov_b64 exec, s[96:97]
    s_cbranch_execz K2_SC_DONE
    v_cmpx_gt_u32 vcc, 48, v49
    v_lshl_add_u32 v194, v49, 5, v59
    v_lshl_add_u32 v195, v49, 2, v59
    v_lshrrev_b32 v193, 3, v49
    v_mad_i32_i24 v196, v193, -16, v195
    v_and_b32 v193, 1, v193
    v_mad_i32_i24 v196, v193, -14, v196
    ds_write_b32 v194, v39 offset:864
    ds_write_b16 v195, v36 offset:194
    ds_write_b16_d16_hi v195, v36 offset:386
    ds_write_b16_d16_hi v195, v37 offset:578
    ds_write_b16 v196, v38 offset:768
    s_cmp_lg_u64 exec, s[96:97]
    s_addc_u32 s58, s58, s58
K2_SC_DONE:
    s_mov_b64 exec, -1
K2_PAD_SD:
    s_cbranch_execz KS_HOP
    s_bcnt1_i32_b32 s61, s58
    s_cmp_gt_u32 s61, 1
    s_cbranch_scc1 K2_OV
K2_OB:
    v_lshlrev_b32 v192, 2, v176
    v_add_u32 v192, 163424, v192
    v_mov_b32 v200, 163652
    v_mov_b32 v198, 0
    s_movk_i32 s26, 48
    s_cmp_eq_u32 s20, 7
    s_cbranch_scc1 K2_FLGCK
K2_FLGOK:
    s_waitcnt lgkmcnt(0)
    s_barrier
    ds_read_b32 v193, v192
    ds_read_b32 v200, v200
    v_cmp_gt_u32 s[56:57], s22, v176
    v_mad_u32_u24 v195, v176, s59, v202
    s_waitcnt lgkmcnt(0)
    v_cndmask_b32 v193, 0, v193, s[56:57]
    v_readfirstlane_b32 s27, v200
    v_cmp_lt_u32 vcc, 48, v193
    s_nop 0
    s_cbranch_vccnz K2_BIG
K2_TOK:
    v_subrev_u32 v194, s67, v193
    v_max_i32 v194, 1, v194
    v_min_i32 v194, s26, v194
    v_add_u32 v194, 15, v194
    v_lshrrev_b32 v194, 4, v194
    v_lshl_or_b32 v195, v194, 18, v195
    v_or_b32 v195, v195, v198
    v_mov_b32 v197, 425056
    v_cndmask_b32 v253, v197, v195, s[56:57]
    s_movk_i32 s40, 0
    s_movk_i32 s41, 256
    s_movk_i32 s42, 512
    s_movk_i32 s43, 768
    s_add_u32 s24, s24, 1
    s_cmp_ge_u32 s24, s25
    s_cselect_b32 s55, 1, 0
    s_cmp_eq_u32 s27, 0
    s_cselect_b32 s55, s55, 0
    s_mov_b32 s27, 0x400000
    s_mov_b32 s38, 0
    s_mov_b32 s34, 0
    s_mov_b32 s35, 0
    s_mov_b32 s36, 1
    s_mov_b32 s31, 0
    s_mov_b32 s58, s20
    v_readlane_b32 s3, v253, s58
    s_lshl_b32 s44, s34, 7
    s_lshl_b32 s60, s58, 5
    s_and_b32 s48, s3, 0x3ffff
    s_bfe_u32 s33, s3, 0x30012
    s_sub_u32 s60, s60, s48
    s_and_b32 s60, s60, 0xff
    s_add_u32 s60, s60, s48
    s_mul_i32 s35, s38, 6
    s_cmp_eq_u32 s34, 0
    s_cselect_b32 s35, s35, s60
    s_mov_b32 s45, s44
    s_add_u32 s47, s44, 256
    s_add_u32 s49, s48, 32
    s_add_u32 s60, s48, 64
    s_cmp_eq_u32 s33, 3
    s_cselect_b32 s46, s44, s47
    s_cselect_b32 s50, s60, s48
    s_cselect_b32 s51, s48, s49
    s_sub_u32 s60, s33, 2
    s_cmp_lt_u32 s60, 2
    s_cbranch_scc0 K2_rare_1
K2_back_2:
    v_add_u32 v233, s48, v230
    ds_read_b32 v232, v233
    ds_read_b32 v233, v233 offset:1024
    v_add_u32 v222, s48, v251
    ds_read_b32 v222, v222
    v_add_u32 v224, s49, v251
    ds_read_b32 v224, v224
    v_add_u32 v226, s50, v251
    ds_read_b32 v226, v226
    v_add_u32 v228, s51, v251
    ds_read_b32 v228, v228
    s_waitcnt lgkmcnt(4)
    v_or_b32 v232, v232, v231
    v_or_b32 v233, v233, v231
    s_cmp_lg_u32 s34, 0
    s_cbranch_scc1 K2_dum_4
    s_add_u32 m0, s48, 864
    s_add_u32 s65, s48, 1888
    buffer_load_dwordx4 v232, s[16:19], 0 offen  lds
    s_mov_b32 m0, s65
    s_mov_b32 exec_hi, 0
    buffer_load_dwordx4 v233, s[16:19], 0 offen  lds
    s_cmp_eq_u32 s33, 4
    s_cbranch_scc1 K2_a4_5
K2_b4_7:
    s_mov_b32 exec_hi, -1
K2_back_6:
    s_waitcnt lgkmcnt(3)
    v_mad_u32_u16 v223, v222, s39, v248 op_sel:[1,0,0,0]
    v_mad_u32_u16 v222, v222, s39, v248
    s_waitcnt lgkmcnt(2)
    v_mad_u32_u16 v225, v224, s39, v248 op_sel:[1,0,0,0]
    v_mad_u32_u16 v224, v224, s39, v248
    s_waitcnt lgkmcnt(1)
    v_mad_u32_u16 v227, v226, s39, v248 op_sel:[1,0,0,0]
    v_mad_u32_u16 v226, v226, s39, v248
    s_waitcnt lgkmcnt(0)
    v_mad_u32_u16 v229, v228, s39, v248 op_sel:[1,0,0,0]
    v_mad_u32_u16 v228, v228, s39, v248
    s_mov_b32 m0, s68
    s_nop 0
    buffer_load_dwordx4 v222, s[4:7], s44 offen sc1 lds
    buffer_load_dwordx4 v223, s[72:75], s44 offen offset:1024 sc1 lds
    s_mov_b32 m0, s69
    s_nop 0
    buffer_load_dwordx4 v224, s[4:7], s45 offen sc1 lds
    buffer_load_dwordx4 v225, s[72:75], s45 offen offset:1024 sc1 lds
    s_mov_b32 m0, s70
    s_nop 0
    buffer_load_dwordx4 v226, s[4:7], s46 offen sc1 lds
    buffer_load_dwordx4 v227, s[72:75], s46 offen offset:1024 sc1 lds
    s_mov_b32 m0, s71
    s_nop 0
    buffer_load_dwordx4 v228, s[4:7], s47 offen sc1 lds
    buffer_load_dwordx4 v229, s[72:75], s47 offen offset:1024 sc1 lds
    v_add_u32 v249, s48, v249
    v_add_u32 v250, s48, v250
    s_waitcnt vmcnt(6)
    ds_read_b64_tr_b16 v[176:177], v246 offset:0
    ds_read_b64_tr_b16 v[178:179], v246 offset:512
    ds_read_b64_tr_b16 v[180:181], v247 offset:0
    ds_read_b64_tr_b16 v[182:183], v247 offset:512
    ds_read_b64_tr_b16 v[0:1], v249 offset:0
    ds_read_b64_tr_b16 v[2:3], v249 offset:128
    ds_read_b128 v[4:7], v250 offset:0
    ds_read_b128 v[8:11], v250 offset:16
    ds_read_b128 v[12:15], v250 offset:384
    ds_read_b128 v[16:19], v250 offset:400
    ds_read_b64_tr_b16 v[20:21], v249 offset:512
    ds_read_b64_tr_b16 v[22:23], v249 offset:640
    ds_read_b128 v[24:27], v250 offset:64
    ds_read_b128 v[28:31], v250 offset:80
    ds_read_b128 v[32:35], v250 offset:448
    ds_read_b128 v[36:39], v250 offset:464
    s_mov_b32 s29, s48
    s_mov_b32 s32, s31
    s_mov_b32 s30, s3
    s_mov_b32 s31, s35
    s_cmp_eq_u32 s33, 2
    s_cbranch_scc1 K2_U20
    s_cmp_eq_u32 s33, 3
    s_cbranch_scc1 K2_U30
    s_cmp_eq_u32 s33, 1
    s_cbranch_scc1 K2_U10
    s_branch K2_U40
K2_PAD_H1:
    s_branch KS_HOP0
KS_HELP:
    s_mov_b32 s30, 0
    s_cmp_eq_u32 s20, 6
    s_cbranch_scc1 KS_RAW
    s_cmp_ge_u32 s2, 200
    s_cbranch_scc1 KS_NOW
    s_mov_b32 s30, 1
    v_and_b32 v1, 15, v8
    v_lshrrev_b32 v3, 4, v8
    s_cmp_ge_u32 s2, 160
    s_cbranch_scc1 K1_WT
    s_cmp_ge_u32 s2, 64
    s_cbranch_scc1 K1_S1
    s_lshr_b32 s24, s2, 3
    s_and_b32 s25, s2, 7
    s_lshr_b32 s26, s25, 2
    s_bfe_u32 s27, s25, 0x10001
    s_and_b32 s28, s25, 1
    s_mov_b32 s60, s92
    s_and_b32 s61, s93, 0xffff
    s_mov_b32 s62, 65536
    s_mov_b32 s63, 0x20000
    s_branch K1_SC
K1_S1:
    s_sub_u32 s29, s2, 64
    s_mul_i32 s24, s29, 43
    s_lshr_b32 s24, s24, 9
    s_mul_i32 s25, s24, 12
    s_sub_u32 s25, s29, s25
    s_cmp_ge_u32 s25, 6
    s_cselect_b32 s26, 1, 0
    s_mul_i32 s27, s26, 6
    s_sub_u32 s27, s25, s27
    s_lshr_b32 s27, s27, 1
    s_and_b32 s28, s25, 1
    s_add_u32 s25, s25, 8
    s_mov_b32 s60, s94
    s_and_b32 s61, s95, 0xffff
    s_mov_b32 s62, 98304
    s_mov_b32 s63, 0x20000
K1_SC:
    s_lshl_b32 s27, s27, 7
    s_lshl_b32 s26, s26, 6
    s_lshl_b32 s28, s28, 4
    s_add_u32 s27, s27, s26
    s_add_u32 s27, s27, s28
    s_lshl_b32 s27, s27, 8
    s_lshl_b32 s26, s24, 5
    s_add_u32 s27, s27, s26
    s_add_u32 s29, s27, 8192
    v_lshlrev_b32 v3, 10, v3
    v_lshl_add_u32 v3, v1, 1, v3
    buffer_load_ushort v64, v3, s[60:63], s27 offen offset:0
    buffer_load_ushort v65, v3, s[60:63], s29 offen offset:0
    buffer_load_ushort v66, v3, s[60:63], s27 offen offset:256
    buffer_load_ushort v67, v3, s[60:63], s29 offen offset:256
    buffer_load_ushort v68, v3, s[60:63], s27 offen offset:512
    buffer_load_ushort v69, v3, s[60:63], s29 offen offset:512
    buffer_load_ushort v70, v3, s[60:63], s27 offen offset:768
    buffer_load_ushort v71, v3, s[60:63], s29 offen offset:768
    s_mul_i32 s24, s24, 20
    s_add_u32 s24, s24, s25
    s_lshl_b32 s24, s24, 10
    s_add_u32 s24, s24, 6946816
    s_branch K1_GO
K1_WT:
    s_sub_u32 s24, s2, 160
    s_cmp_ge_u32 s24, 20
    s_cselect_b32 s26, 1, 0
    s_mul_i32 s25, s26, 20
    s_sub_u32 s25, s24, s25
    s_lshr_b32 s27, s25, 2
    s_bfe_u32 s28, s25, 0x10001
    s_and_b32 s25, s25, 1
    s_mul_i32 s25, s25, 10240
    s_lshl_b32 s27, s27, 8
    s_lshl_b32 s26, s26, 7
    s_lshl_b32 s28, s28, 6
    s_add_u32 s27, s27, s26
    s_add_u32 s27, s27, s28
    s_add_u32 s27, s27, s25
    s_mov_b32 s60, s90
    s_and_b32 s61, s91, 0xffff
    s_mov_b32 s62, 20480
    s_mov_b32 s63, 0x20000
    v_and_b32 v1, 31, v8
    v_lshrrev_b32 v3, 5, v8
    v_mul_u32_u24 v3, 5120, v3
    v_lshl_add_u32 v3, v1, 1, v3
    v_mov_b32 v64, 0
    v_mov_b32 v66, 0
    v_mov_b32 v68, 0
    v_mov_b32 v70, 0
    buffer_load_ushort v65, v3, s[60:63], s27 offen offset:0
    buffer_load_ushort v67, v3, s[60:63], s27 offen offset:1280
    buffer_load_ushort v69, v3, s[60:63], s27 offen offset:2560
    buffer_load_ushort v71, v3, s[60:63], s27 offen offset:3840
    s_lshl_b32 s24, s24, 10
    s_add_u32 s24, s24, 7110656
K1_GO:
KS_NOW:
    s_barrier
K2_PAD_H2:
    s_cbranch_execz KS_HOP0
KS_FILL:
    v_subrev_u32 v76, 320, v0
    v_mov_b32 v80, -1
    v_mov_b32 v77, 1.0
    v_cmp_gt_u32 vcc, 48, v76
    v_lshlrev_b32 v78, 4, v76
    v_add_u32 v78, 65536, v78
    v_cndmask_b32 v80, v80, 0, vcc
    v_cmp_gt_u32 vcc, 12, v76
    v_add_u32 v79, 64800, v78
    s_nop 0
    v_cndmask_b32 v80, v80, v77, vcc
    v_cmp_gt_u32 s[56:57], 54, v8
    v_mov_b32 v81, v80
    v_mov_b32 v82, v80
    v_mov_b32 v83, v80
    ds_write_b128 v78, v[80:83] offset:0
    ds_write_b128 v78, v[80:83] offset:2400
    ds_write_b128 v78, v[80:83] offset:4800
    ds_write_b128 v78, v[80:83] offset:7200
    ds_write_b128 v78, v[80:83] offset:9600
    ds_write_b128 v78, v[80:83] offset:12000
    ds_write_b128 v78, v[80:83] offset:14400
    ds_write_b128 v78, v[80:83] offset:16800
    ds_write_b128 v78, v[80:83] offset:19200
    ds_write_b128 v78, v[80:83] offset:21600
    ds_write_b128 v78, v[80:83] offset:24000
    ds_write_b128 v78, v[80:83] offset:26400
    ds_write_b128 v78, v[80:83] offset:28800
    ds_write_b128 v78, v[80:83] offset:31200
    ds_write_b128 v78, v[80:83] offset:33600
    ds_write_b128 v78, v[80:83] offset:36000
    ds_write_b128 v78, v[80:83] offset:38400
    ds_write_b128 v78, v[80:83] offset:40800
    ds_write_b128 v78, v[80:83] offset:43200
    ds_write_b128 v78, v[80:83] offset:45600
    ds_write_b128 v78, v[80:83] offset:48000
    ds_write_b128 v78, v[80:83] offset:50400
    ds_write_b128 v78, v[80:83] offset:52800
    ds_write_b128 v78, v[80:83] offset:55200
    ds_write_b128 v78, v[80:83] offset:57600
    ds_write_b128 v78, v[80:83] offset:60000
    ds_write_b128 v78, v[80:83] offset:62400
    ds_write_b128 v79, v[80:83] offset:0
    ds_write_b128 v79, v[80:83] offset:2400
    ds_write_b128 v79, v[80:83] offset:4800
    ds_write_b128 v79, v[80:83] offset:7200
    ds_write_b128 v79, v[80:83] offset:9600
    ds_write_b128 v79, v[80:83] offset:12000
    ds_write_b128 v79, v[80:83] offset:14400
    ds_write_b128 v79, v[80:83] offset:16800
    ds_write_b128 v79, v[80:83] offset:19200
    ds_write_b128 v79, v[80:83] offset:21600
    ds_write_b128 v79, v[80:83] offset:24000
    ds_write_b128 v79, v[80:83] offset:26400
    ds_write_b128 v79, v[80:83] offset:28800
    v_mov_b32 v59, 163728
    s_barrier
    ds_read_b32 v59, v59
    s_cmp_eq_u32 s20, 6
    s_cselect_b64 exec, s[56:57], -1
    ds_write_b128 v79, v[80:83] offset:31200
    s_mov_b64 exec, -1
    s_waitcnt vmcnt(0) lgkmcnt(0)
    s_cmp_eq_u32 s30, 0
    s_cbranch_scc1 KS_B3
    v_lshl_or_b32 v40, v65, 16, v64
    v_lshl_or_b32 v41, v67, 16, v66
    v_lshl_or_b32 v42, v69, 16, v68
    v_lshl_or_b32 v43, v71, 16, v70
    buffer_store_dwordx4 v[40:43], v9, s[8:11], s24 offen sc1
    s_waitcnt lgkmcnt(0)
    s_barrier
    s_lshl_b32 s24, s2, 2
    s_add_u32 s24, s24, 7176192
    s_mov_b64 exec, 1
    s_waitcnt vmcnt(0)
    buffer_store_dword v59, v6, s[8:11], s24 offen sc1
    s_mov_b64 exec, -1
    s_branch KS_JOIN
K2_PAD_H3:
    s_branch KS_HOP0
KS_RAW:
    s_barrier
    s_mov_b32 s60, s90
    s_and_b32 s61, s91, 0xffff
    s_mov_b32 s62, 20480
    s_mov_b32 s63, 0x20000
    s_mov_b32 m0, 24576
    s_movk_i32 s24, 0
    buffer_load_dwordx4 v9, s[60:63], s24 offen offset:0 lds
    buffer_load_dwordx4 v9, s[60:63], s24 offen offset:1024 lds
    buffer_load_dwordx4 v9, s[60:63], s24 offen offset:2048 lds
    buffer_load_dwordx4 v9, s[60:63], s24 offen offset:3072 lds
    s_mov_b32 m0, 28672
    s_movk_i32 s24, 4096
    buffer_load_dwordx4 v9, s[60:63], s24 offen offset:0 lds
    buffer_load_dwordx4 v9, s[60:63], s24 offen offset:1024 lds
    buffer_load_dwordx4 v9, s[60:63], s24 offen offset:2048 lds
    buffer_load_dwordx4 v9, s[60:63], s24 offen offset:3072 lds
    s_mov_b32 m0, 32768
    s_movk_i32 s24, 8192
    buffer_load_dwordx4 v9, s[60:63], s24 offen offset:0 lds
    buffer_load_dwordx4 v9, s[60:63], s24 offen offset:1024 lds
    buffer_load_dwordx4 v9, s[60:63], s24 offen offset:2048 lds
    buffer_load_dwordx4 v9, s[60:63], s24 offen offset:3072 lds
    s_mov_b32 m0, 36864
    s_movk_i32 s24, 12288
    buffer_load_dwordx4 v9, s[60:63], s24 offen offset:0 lds
    buffer_load_dwordx4 v9, s[60:63], s24 offen offset:1024 lds
    buffer_load_dwordx4 v9, s[60:63], s24 offen offset:2048 lds
    buffer_load_dwordx4 v9, s[60:63], s24 offen offset:3072 lds
    s_mov_b32 m0, 40960
    s_movk_i32 s24, 16384
    buffer_load_dwordx4 v9, s[60:63], s24 offen offset:0 lds
    buffer_load_dwordx4 v9, s[60:63], s24 offen offset:1024 lds
    buffer_load_dwordx4 v9, s[60:63], s24 offen offset:2048 lds
    buffer_load_dwordx4 v9, s[60:63], s24 offen offset:3072 lds
    s_branch KS_FILL
KS_IDLE:
    s_barrier
    v_mul_u32_u24 v76, 2979, v0
    v_lshrrev_b32 v76, 16, v76
    v_mul_u32_u24 v77, 2048, v76
    v_lshl_add_u32 v78, v0, 4, v77
    v_add_u32 v78, 67584, v78
    v_add_u32 v79, 67200, v78
    v_mov_b32 v80, -1
    v_mov_b32 v81, -1
    v_cmp_gt_u32 vcc, 14, v76
    v_cmp_gt_u32 s[56:57], 12, v76
    v_mov_b32 v82, -1
    v_mov_b32 v83, -1
    s_mov_b64 exec, vcc
    ds_write_b128 v78, v[80:83]
    ds_write_b128 v78, v[80:83] offset:33600
    s_mov_b64 exec, s[56:57]
    ds_write_b128 v79, v[80:83]
    s_mov_b64 exec, -1
    s_barrier
    s_branch KS_B3
K2_PAD_U20:
    s_branch K2_HOP
K2_U20:
    s_setprio 1
    s_waitcnt lgkmcnt(6)
    v_lshlrev_b32 v40, 16, v0
    v_and_b32 v41, 0xffff0000, v0
    v_lshlrev_b32 v42, 16, v1
    v_and_b32 v43, 0xffff0000, v1
    v_lshlrev_b32 v44, 16, v2
    v_and_b32 v45, 0xffff0000, v2
    v_lshlrev_b32 v46, 16, v3
    v_and_b32 v47, 0xffff0000, v3
    v_mul_f32 v4, v40, v4
    v_mul_f32 v5, v41, v5
    v_mul_f32 v6, v42, v6
    v_mul_f32 v7, v43, v7
    v_mul_f32 v8, v44, v8
    v_mul_f32 v9, v45, v9
    v_mul_f32 v10, v46, v10
    v_mul_f32 v11, v47, v11
    v_cvt_pk_bf16_f32 v64, v4, v5
    v_cvt_pk_bf16_f32 v65, v6, v7
    v_cvt_pk_bf16_f32 v66, v8, v9
    v_cvt_pk_bf16_f32 v67, v10, v11
    v_mul_f32 v12, v40, v12
    v_mul_f32 v13, v41, v13
    v_mul_f32 v14, v42, v14
    v_mul_f32 v15, v43, v15
    v_mul_f32 v16, v44, v16
    v_mul_f32 v17, v45, v17
    v_mul_f32 v18, v46, v18
    v_mul_f32 v19, v47, v19
    v_cvt_pk_bf16_f32 v68, v12, v13
    v_cvt_pk_bf16_f32 v69, v14, v15
    v_cvt_pk_bf16_f32 v70, v16, v17
    v_cvt_pk_bf16_f32 v71, v18, v19
    s_waitcnt lgkmcnt(0)
    v_lshlrev_b32 v48, 16, v20
    v_and_b32 v49, 0xffff0000, v20
    v_lshlrev_b32 v50, 16, v21
    v_and_b32 v51, 0xffff0000, v21
    v_lshlrev_b32 v52, 16, v22
    v_and_b32 v53, 0xffff0000, v22
    v_lshlrev_b32 v54, 16, v23
    v_and_b32 v55, 0xffff0000, v23
    v_mul_f32 v24, v48, v24
    v_mul_f32 v25, v49, v25
    v_mul_f32 v26, v50, v26
    v_mul_f32 v27, v51, v27
    v_mul_f32 v28, v52, v28
    v_mul_f32 v29, v53, v29
    v_mul_f32 v30, v54, v30
    v_mul_f32 v31, v55, v31
    v_cvt_pk_bf16_f32 v72, v24, v25
    v_cvt_pk_bf16_f32 v73, v26, v27
    v_cvt_pk_bf16_f32 v74, v28, v29
    v_cvt_pk_bf16_f32 v75, v30, v31
    v_mul_f32 v32, v48, v32
    v_mul_f32 v33, v49, v33
    v_mul_f32 v34, v50, v34
    v_mul_f32 v35, v51, v35
    v_mul_f32 v36, v52, v36
    v_mul_f32 v37, v53, v37
    v_mul_f32 v38, v54, v38
    v_mul_f32 v39, v55, v39
    v_cvt_pk_bf16_f32 v76, v32, v33
    v_cvt_pk_bf16_f32 v77, v34, v35
    v_cvt_pk_bf16_f32 v78, v36, v37
    v_cvt_pk_bf16_f32 v79, v38, v39
    s_waitcnt vmcnt(4)
    v_mfma_f32_32x32x16_bf16 v[0:15], v[64:67], v[176:179], 0
    ds_read_b64_tr_b16 v[184:185], v246 offset:2048
    ds_read_b64_tr_b16 v[186:187], v246 offset:2560
    ds_read_b64_tr_b16 v[188:189], v247 offset:2048
    ds_read_b64_tr_b16 v[190:191], v247 offset:2560
    s_mov_b32 m0, s68
    v_mfma_f32_32x32x16_bf16 v[16:31], v[68:71], v[176:179], 0
    buffer_load_dwordx4 v222, s[4:7], s42 offen sc1 lds
    buffer_load_dwordx4 v223, s[72:75], s42 offen offset:1024 sc1 lds
    v_permlane32_swap_b32 v242, v236
    v_permlane32_swap_b32 v243, v237
    s_add_u32 s38, s38, 1
    v_mfma_f32_32x32x16_bf16 v[32:47], v[64:67], v[180:183], 0
    v_permlane32_swap_b32 v244, v238
    v_permlane32_swap_b32 v245, v239
    v_permlane32_swap_b32 v240, v241
    v_add_f32 v242, v242, v236
    v_mfma_f32_32x32x16_bf16 v[48:63], v[68:71], v[180:183], 0
    v_add_f32 v243, v243, v237
    v_add_f32 v244, v244, v238
    v_add_f32 v245, v245, v239
    v_add_f32 v240, -v240, -v241
    v_mov_b32 v254, s52
    v_mov_b32 v255, s38
    s_waitcnt vmcnt(4) lgkmcnt(0)
    v_mfma_f32_32x32x16_bf16 v[0:15], v[72:75], v[184:187], v[0:15]
    ds_read_b64_tr_b16 v[176:177], v246 offset:4096
    ds_read_b64_tr_b16 v[178:179], v246 offset:4608
    ds_read_b64_tr_b16 v[180:181], v247 offset:4096
    ds_read_b64_tr_b16 v[182:183], v247 offset:4608
    s_lshl_b32 s58, s38, 3
    s_add_u32 s58, s58, s20
    s_mov_b32 m0, s69
    v_mfma_f32_32x32x16_bf16 v[16:31], v[76:79], v[184:187], v[16:31]
    buffer_load_dwordx4 v224, s[4:7], s42 offen sc1 lds
    buffer_load_dwordx4 v225, s[72:75], s42 offen offset:1024 sc1 lds
    s_set_gpr_idx_on s32, gpr_idx(DST)
    s_nop 0
    v_cvt_pk_bf16_f32 v195, v242, v243
    v_cvt_pk_bf16_f32 v196, v244, v245
    v_cvt_pk_bf16_f32 v197, v240, v240
    s_set_gpr_idx_off
    s_mov_b64 exec, 1
    ds_write_b32 v254, v255
    s_mov_b64 exec, -1
    s_cmp_lt_u32 s58, s22
    s_cbranch_scc0 K2_dyn_8
K2_back_9:
    v_readlane_b32 s3, v253, s58
    s_lshl_b32 s44, s34, 7
    s_lshl_b32 s60, s58, 5
    s_and_b32 s48, s3, 0x3ffff
    s_bfe_u32 s33, s3, 0x30012
    s_sub_u32 s60, s60, s48
    s_and_b32 s60, s60, 0xff
    s_add_u32 s60, s60, s48
    s_mul_i32 s35, s38, 6
    s_cmp_eq_u32 s34, 0
    s_cselect_b32 s35, s35, s60
    s_mov_b32 s45, s44
    s_add_u32 s47, s44, 256
    s_add_u32 s49, s48, 32
    s_add_u32 s60, s48, 64
    s_cmp_eq_u32 s33, 3
    s_cselect_b32 s46, s44, s47
    s_cselect_b32 s50, s60, s48
    s_cselect_b32 s51, s48, s49
    s_sub_u32 s60, s33, 2
    s_cmp_lt_u32 s60, 2
    s_cbranch_scc0 K2_rare_14
K2_back_15:
    v_mfma_f32_32x32x16_bf16 v[32:47], v[72:75], v[188:191], v[32:47]
    v_add_u32 v233, s48, v230
    ds_read_b32 v232, v233
    ds_read_b32 v233, v233 offset:1024
    v_mul_f32 v234, v0, v96
    v_mul_f32 v236, v8, v128
    v_fmac_f32 v234, v1, v97
    v_fmac_f32 v236, v9, v129
    v_mfma_f32_32x32x16_bf16 v[48:63], v[76:79], v[188:191], v[48:63]
    s_setprio 0
    v_fmac_f32 v234, v2, v98
    v_fmac_f32 v236, v10, v130
    v_fmac_f32 v234, v3, v99
    v_fmac_f32 v236, v11, v131
    v_fmac_f32 v234, v4, v100
    v_fmac_f32 v236, v12, v132
    v_fmac_f32 v234, v5, v101
    v_fmac_f32 v236, v13, v133
    v_fmac_f32 v234, v6, v102
    v_fmac_f32 v236, v14, v134
    v_fmac_f32 v234, v7, v103
    v_fmac_f32 v236, v15, v135
    v_mul_f32 v238, v16, v128
    v_mul_f32 v240, v24, v128
    v_fmac_f32 v238, v17, v129
    v_fmac_f32 v240, v25, v129
    v_fmac_f32 v238, v18, v130
    v_fmac_f32 v240, v26, v130
    v_fmac_f32 v238, v19, v131
    v_fmac_f32 v240, v27, v131
    v_fmac_f32 v238, v20, v132
    v_fmac_f32 v240, v28, v132
    v_fmac_f32 v238, v21, v133
    v_fmac_f32 v240, v29, v133
    v_fmac_f32 v238, v22, v134
    v_fmac_f32 v240, v30, v134
    v_fmac_f32 v238, v23, v135
    v_fmac_f32 v240, v31, v135
    v_mul_f32 v235, v32, v104
    v_mul_f32 v237, v40, v136
    v_fmac_f32 v235, v33, v105
    v_fmac_f32 v237, v41, v137
    v_fmac_f32 v235, v34, v106
    v_fmac_f32 v237, v42, v138
    v_fmac_f32 v235, v35, v107
    v_fmac_f32 v237, v43, v139
    v_fmac_f32 v235, v36, v108
    v_fmac_f32 v237, v44, v140
    v_fmac_f32 v235, v37, v109
    v_fmac_f32 v237, v45, v141
    v_fmac_f32 v235, v38, v110
    v_fmac_f32 v237, v46, v142
    v_fmac_f32 v235, v39, v111
    v_fmac_f32 v237, v47, v143
    v_mul_f32 v239, v48, v136
    v_mul_f32 v241, v56, v136
    v_fmac_f32 v239, v49, v137
    v_fmac_f32 v241, v57, v137
    s_setprio 1
    s_waitcnt vmcnt(4) lgkmcnt(3)
    v_mfma_f32_32x32x16_bf16 v[0:15], v[64:67], v[176:179], 0
    ds_read_b64_tr_b16 v[184:185], v246 offset:6144
    ds_read_b64_tr_b16 v[186:187], v246 offset:6656
    ds_read_b64_tr_b16 v[188:189], v247 offset:6144
    ds_read_b64_tr_b16 v[190:191], v247 offset:6656
    v_fmac_f32 v239, v50, v138
    v_fmac_f32 v241, v58, v138
    s_mov_b32 m0, s70
    v_mfma_f32_32x32x16_bf16 v[16:31], v[68:71], v[176:179], 0
    buffer_load_dwordx4 v222, s[4:7], s43 offen sc1 lds
    buffer_load_dwordx4 v223, s[72:75], s43 offen offset:1024 sc1 lds
    v_fmac_f32 v239, v51, v139
    v_fmac_f32 v241, v59, v139
    v_fmac_f32 v239, v52, v140
    v_fmac_f32 v241, v60, v140
    v_fmac_f32 v239, v53, v141
    v_mfma_f32_32x32x16_bf16 v[32:47], v[64:67], v[180:183], 0
    v_add_u32 v222, s48, v251
    ds_read_b32 v222, v222
    v_fmac_f32 v241, v61, v141
    v_fmac_f32 v239, v54, v142
    v_fmac_f32 v241, v62, v142
    v_fmac_f32 v239, v55, v143
    v_fmac_f32 v241, v63, v143
    v_mfma_f32_32x32x16_bf16 v[48:63], v[68:71], v[180:183], 0
    v_permlane32_swap_b32 v234, v236
    v_permlane32_swap_b32 v235, v237
    v_permlane32_swap_b32 v240, v238
    s_waitcnt lgkmcnt(5)
    v_or_b32 v232, v232, v231
    v_or_b32 v233, v233, v231
    s_cmp_lg_u32 s34, 0
    s_cbranch_scc1 K2_dum_17
    s_add_u32 m0, s48, 864
    s_add_u32 s65, s48, 1888
    buffer_load_dwordx4 v232, s[16:19], 0 offen  lds
    s_mov_b32 m0, s65
    s_mov_b32 exec_hi, 0
    buffer_load_dwordx4 v233, s[16:19], 0 offen  lds
    s_cmp_eq_u32 s33, 4
    s_cbranch_scc1 K2_a4_18
K2_b4_20:
    s_mov_b32 exec_hi, -1
K2_back_19:
    s_waitcnt vmcnt(6) lgkmcnt(1)
    v_mfma_f32_32x32x16_bf16 v[0:15], v[72:75], v[184:187], v[0:15]
    ds_read_b64_tr_b16 v[176:177], v246 offset:0
    ds_read_b64_tr_b16 v[178:179], v246 offset:512
    ds_read_b64_tr_b16 v[180:181], v247 offset:0
    ds_read_b64_tr_b16 v[182:183], v247 offset:512
    v_permlane32_swap_b32 v241, v239
    s_mov_b32 m0, s71
    v_mfma_f32_32x32x16_bf16 v[16:31], v[76:79], v[184:187], v[16:31]
    buffer_load_dwordx4 v224, s[4:7], s43 offen sc1 lds
    buffer_load_dwordx4 v225, s[72:75], s43 offen offset:1024 sc1 lds
    s_waitcnt lgkmcnt(4)
    v_mad_u32_u16 v223, v222, s39, v248 op_sel:[1,0,0,0]
    v_mad_u32_u16 v222, v222, s39, v248
    v_add_f32 v234, v234, v236
    v_add_f32 v235, v235, v237
    v_add_f32 v240, v240, v238
    v_add_f32 v241, v241, v239
    s_set_gpr_idx_on s31, gpr_idx(DST)
    s_nop 0
    v_cvt_pk_bf16_f32 v192, v234, v235
    v_cvt_pk_bf16_f32 v193, v240, v241
    s_set_gpr_idx_off
    v_mfma_f32_32x32x16_bf16 v[32:47], v[72:75], v[188:191], v[32:47]
    v_add_u32 v224, s49, v251
    ds_read_b32 v224, v224
    v_mul_f32 v234, v0, v144
    v_mul_f32 v236, v8, v112
    v_fmac_f32 v234, v1, v145
    v_fmac_f32 v236, v9, v113
    v_fmac_f32 v234, v2, v146
    v_mfma_f32_32x32x16_bf16 v[48:63], v[76:79], v[188:191], v[48:63]
    s_setprio 0
    v_fmac_f32 v236, v10, v114
    v_fmac_f32 v234, v3, v147
    v_fmac_f32 v236, v11, v115
    v_fmac_f32 v234, v4, v148
    v_fmac_f32 v236, v12, v116
    v_fmac_f32 v234, v5, v149
    v_fmac_f32 v236, v13, v117
    v_fmac_f32 v234, v6, v150
    v_fmac_f32 v236, v14, v118
    v_fmac_f32 v234, v7, v151
    v_fmac_f32 v236, v15, v119
    v_mul_f32 v238, v16, v160
    v_mul_f32 v240, v24, v160
    v_fmac_f32 v238, v17, v161
    v_fmac_f32 v240, v25, v161
    v_fmac_f32 v238, v18, v162
    v_fmac_f32 v240, v26, v162
    v_fmac_f32 v238, v19, v163
    v_fmac_f32 v240, v27, v163
    v_fmac_f32 v238, v20, v164
    v_fmac_f32 v240, v28, v164
    v_fmac_f32 v238, v21, v165
    v_fmac_f32 v240, v29, v165
    v_fmac_f32 v238, v22, v166
    v_fmac_f32 v240, v30, v166
    v_fmac_f32 v238, v23, v167
    v_fmac_f32 v240, v31, v167
    v_mul_f32 v235, v32, v152
    v_mul_f32 v237, v40, v120
    v_fmac_f32 v235, v33, v153
    v_fmac_f32 v237, v41, v121
    v_fmac_f32 v235, v34, v154
    v_fmac_f32 v237, v42, v122
    v_fmac_f32 v235, v35, v155
    v_fmac_f32 v237, v43, v123
    v_fmac_f32 v235, v36, v156
    v_fmac_f32 v237, v44, v124
    v_fmac_f32 v235, v37, v157
    v_fmac_f32 v237, v45, v125
    v_fmac_f32 v235, v38, v158
    v_fmac_f32 v237, v46, v126
    v_fmac_f32 v235, v39, v159
    v_fmac_f32 v237, v47, v127
    v_mul_f32 v239, v48, v168
    v_mul_f32 v241, v56, v168
    v_fmac_f32 v239, v49, v169
    v_fmac_f32 v241, v57, v169
    v_fmac_f32 v239, v50, v170
    v_fmac_f32 v241, v58, v170
    v_fmac_f32 v239, v51, v171
    s_setprio 1
    s_waitcnt vmcnt(6) lgkmcnt(1)
    v_mfma_f32_32x32x16_bf16 v[0:15], v[64:67], v[176:179], 0
    ds_read_b64_tr_b16 v[184:185], v246 offset:2048
    ds_read_b64_tr_b16 v[186:187], v246 offset:2560
    ds_read_b64_tr_b16 v[188:189], v247 offset:2048
    ds_read_b64_tr_b16 v[190:191], v247 offset:2560
    v_fmac_f32 v241, v59, v171
    v_fmac_f32 v239, v52, v172
    s_mov_b32 m0, s68
    v_mfma_f32_32x32x16_bf16 v[16:31], v[68:71], v[176:179], 0
    buffer_load_dwordx4 v222, s[4:7], s44 offen sc1 lds
    buffer_load_dwordx4 v223, s[72:75], s44 offen offset:1024 sc1 lds
    s_waitcnt lgkmcnt(4)
    v_mad_u32_u16 v225, v224, s39, v248 op_sel:[1,0,0,0]
    v_mad_u32_u16 v224, v224, s39, v248
    v_fmac_f32 v241, v60, v172
    v_fmac_f32 v239, v53, v173
    v_mfma_f32_32x32x16_bf16 v[32:47], v[64:67], v[180:183], 0
    v_add_u32 v226, s50, v251
    ds_read_b32 v226, v226
    v_fmac_f32 v241, v61, v173
    v_fmac_f32 v239, v54, v174
    v_fmac_f32 v241, v62, v174
    v_fmac_f32 v239, v55, v175
    v_fmac_f32 v241, v63, v175
    v_mfma_f32_32x32x16_bf16 v[48:63], v[68:71], v[180:183], 0
    s_waitcnt vmcnt(6) lgkmcnt(1)
    v_mfma_f32_32x32x16_bf16 v[0:15], v[72:75], v[184:187], v[0:15]
    ds_read_b64_tr_b16 v[176:177], v246 offset:4096
    ds_read_b64_tr_b16 v[178:179], v246 offset:4608
    ds_read_b64_tr_b16 v[180:181], v247 offset:4096
    ds_read_b64_tr_b16 v[182:183], v247 offset:4608
    s_mov_b32 m0, s69
    v_mfma_f32_32x32x16_bf16 v[16:31], v[76:79], v[184:187], v[16:31]
    buffer_load_dwordx4 v224, s[4:7], s45 offen sc1 lds
    buffer_load_dwordx4 v225, s[72:75], s45 offen offset:1024 sc1 lds
    s_waitcnt lgkmcnt(4)
    v_mad_u32_u16 v227, v226, s39, v248 op_sel:[1,0,0,0]
    v_mad_u32_u16 v226, v226, s39, v248
    v_mfma_f32_32x32x16_bf16 v[32:47], v[72:75], v[188:191], v[32:47]
    v_add_u32 v228, s51, v251
    ds_read_b32 v228, v228
    v_mul_f32 v242, v0, v144
    v_fma_f32 v238, v8, v160, -v238
    v_fmac_f32 v242, v1, v145
    v_fmac_f32 v238, v9, v161
    v_fmac_f32 v242, v2, v146
    v_mfma_f32_32x32x16_bf16 v[48:63], v[76:79], v[188:191], v[48:63]
    s_setprio 0
    v_fmac_f32 v238, v10, v162
    v_fmac_f32 v242, v3, v147
    v_fmac_f32 v238, v11, v163
    v_fmac_f32 v242, v4, v148
    v_fmac_f32 v238, v12, v164
    v_fmac_f32 v242, v5, v149
    v_fmac_f32 v238, v13, v165
    v_fmac_f32 v242, v6, v150
    v_fmac_f32 v238, v14, v166
    v_fmac_f32 v242, v7, v151
    v_fmac_f32 v238, v15, v167
    v_fmac_f32 v236, v16, v112
    v_mul_f32 v244, v24, v160
    v_fmac_f32 v236, v17, v113
    v_fmac_f32 v244, v25, v161
    v_fmac_f32 v236, v18, v114
    v_fmac_f32 v244, v26, v162
    v_fmac_f32 v236, v19, v115
    v_fmac_f32 v244, v27, v163
    v_fmac_f32 v236, v20, v116
    v_fmac_f32 v244, v28, v164
    v_fmac_f32 v236, v21, v117
    v_fmac_f32 v244, v29, v165
    v_fmac_f32 v236, v22, v118
    v_fmac_f32 v244, v30, v166
    v_fmac_f32 v236, v23, v119
    v_fmac_f32 v244, v31, v167
    v_mul_f32 v243, v32, v152
    v_fma_f32 v239, v40, v168, -v239
    v_fmac_f32 v243, v33, v153
    v_fmac_f32 v239, v41, v169
    v_fmac_f32 v243, v34, v154
    v_fmac_f32 v239, v42, v170
    v_fmac_f32 v243, v35, v155
    v_fmac_f32 v239, v43, v171
    v_fmac_f32 v243, v36, v156
    v_fmac_f32 v239, v44, v172
    v_fmac_f32 v243, v37, v157
    v_fmac_f32 v239, v45, v173
    v_fmac_f32 v243, v38, v158
    v_fmac_f32 v239, v46, v174
    v_fmac_f32 v243, v39, v159
    v_fmac_f32 v239, v47, v175
    v_fmac_f32 v237, v48, v120
    v_mul_f32 v245, v56, v168
    v_fmac_f32 v237, v49, v121
    v_fmac_f32 v245, v57, v169
    v_fmac_f32 v237, v50, v122
    s_setprio 1
    s_waitcnt vmcnt(4) lgkmcnt(1)
    v_mfma_f32_32x32x16_bf16 v[0:15], v[64:67], v[176:179], 0
    ds_read_b64_tr_b16 v[184:185], v246 offset:6144
    ds_read_b64_tr_b16 v[186:187], v246 offset:6656
    ds_read_b64_tr_b16 v[188:189], v247 offset:6144
    ds_read_b64_tr_b16 v[190:191], v247 offset:6656
    v_fmac_f32 v245, v58, v170
    v_fmac_f32 v237, v51, v123
    s_mov_b32 m0, s70
    v_mfma_f32_32x32x16_bf16 v[16:31], v[68:71], v[176:179], 0
    buffer_load_dwordx4 v226, s[4:7], s46 offen sc1 lds
    buffer_load_dwordx4 v227, s[72:75], s46 offen offset:1024 sc1 lds
    s_waitcnt lgkmcnt(4)
    v_mad_u32_u16 v229, v228, s39, v248 op_sel:[1,0,0,0]
    v_mad_u32_u16 v228, v228, s39, v248
    v_fmac_f32 v245, v59, v171
    v_fmac_f32 v237, v52, v124
    v_mfma_f32_32x32x16_bf16 v[32:47], v[64:67], v[180:183], 0
    v_fmac_f32 v245, v60, v172
    v_fmac_f32 v237, v53, v125
    v_fmac_f32 v245, v61, v173
    v_fmac_f32 v237, v54, v126
    v_fmac_f32 v245, v62, v174
    v_fmac_f32 v237, v55, v127
    v_fmac_f32 v245, v63, v175
    v_mfma_f32_32x32x16_bf16 v[48:63], v[68:71], v[180:183], 0
    v_permlane32_swap_b32 v242, v234
    v_permlane32_swap_b32 v243, v235
    v_add_f32 v242, v242, v234
    v_add_f32 v243, v243, v235
    s_waitcnt vmcnt(4) lgkmcnt(0)
    v_mfma_f32_32x32x16_bf16 v[0:15], v[72:75], v[184:187], v[0:15]
    ds_read_b64_tr_b16 v[176:177], v246 offset:0
    ds_read_b64_tr_b16 v[178:179], v246 offset:512
    ds_read_b64_tr_b16 v[180:181], v247 offset:0
    ds_read_b64_tr_b16 v[182:183], v247 offset:512
    s_sub_u32 s26, s48, s29
    s_mov_b32 s29, s48
    s_mov_b32 m0, s71
    v_mfma_f32_32x32x16_bf16 v[16:31], v[76:79], v[184:187], v[16:31]
    buffer_load_dwordx4 v228, s[4:7], s47 offen sc1 lds
    buffer_load_dwordx4 v229, s[72:75], s47 offen offset:1024 sc1 lds
    s_set_gpr_idx_on s31, gpr_idx(DST)
    s_nop 0
    v_cvt_pk_bf16_f32 v194, v242, v243
    s_set_gpr_idx_off
    s_mov_b32 s30, s3
    s_cmp_eq_u32 s34, 0
    s_cselect_b32 s56, s33, 0
    v_mfma_f32_32x32x16_bf16 v[32:47], v[72:75], v[188:191], v[32:47]
    s_mov_b32 s32, s31
    s_mov_b32 s31, s35
    v_mul_f32 v242, v0, v144
    v_fma_f32 v240, v8, v160, -v240
    v_fmac_f32 v242, v1, v145
    v_fmac_f32 v240, v9, v161
    v_fmac_f32 v242, v2, v146
    v_mfma_f32_32x32x16_bf16 v[48:63], v[76:79], v[188:191], v[48:63]
    s_setprio 0
    v_fmac_f32 v240, v10, v162
    v_fmac_f32 v242, v3, v147
    v_fmac_f32 v240, v11, v163
    v_fmac_f32 v242, v4, v148
    v_fmac_f32 v240, v12, v164
    v_fmac_f32 v242, v5, v149
    v_fmac_f32 v240, v13, v165
    v_fmac_f32 v242, v6, v150
    v_fmac_f32 v240, v14, v166
    v_fmac_f32 v242, v7, v151
    v_fmac_f32 v240, v15, v167
    v_add_u32 v249, s26, v249
    v_add_u32 v250, s26, v250
    v_fma_f32 v244, v16, v160, -v244
    v_fmac_f32 v236, v24, v112
    v_fmac_f32 v244, v17, v161
    v_fmac_f32 v236, v25, v113
    v_fmac_f32 v244, v18, v162
    v_fmac_f32 v236, v26, v114
    v_fmac_f32 v244, v19, v163
    v_fmac_f32 v236, v27, v115
    v_fmac_f32 v244, v20, v164
    v_fmac_f32 v236, v28, v116
    v_fmac_f32 v244, v21, v165
    v_fmac_f32 v236, v29, v117
    v_fmac_f32 v244, v22, v166
    v_fmac_f32 v236, v30, v118
    v_fmac_f32 v244, v23, v167
    v_fmac_f32 v236, v31, v119
    ds_read_b64_tr_b16 v[0:1], v249 offset:0
    ds_read_b64_tr_b16 v[2:3], v249 offset:128
    ds_read_b128 v[4:7], v250 offset:0
    ds_read_b128 v[8:11], v250 offset:16
    ds_read_b128 v[12:15], v250 offset:384
    ds_read_b128 v[16:19], v250 offset:400
    v_mul_f32 v243, v32, v152
    v_fma_f32 v241, v40, v168, -v241
    v_fmac_f32 v243, v33, v153
    v_fmac_f32 v241, v41, v169
    v_fmac_f32 v243, v34, v154
    v_fmac_f32 v241, v42, v170
    v_fmac_f32 v243, v35, v155
    v_fmac_f32 v241, v43, v171
    v_fmac_f32 v243, v36, v156
    v_fmac_f32 v241, v44, v172
    v_fmac_f32 v243, v37, v157
    v_fmac_f32 v241, v45, v173
    v_fmac_f32 v243, v38, v158
    v_fmac_f32 v241, v46, v174
    v_fmac_f32 v243, v39, v159
    v_fmac_f32 v241, v47, v175
    ds_read_b64_tr_b16 v[20:21], v249 offset:512
    ds_read_b64_tr_b16 v[22:23], v249 offset:640
    ds_read_b128 v[24:27], v250 offset:64
    ds_read_b128 v[28:31], v250 offset:80
    ds_read_b128 v[32:35], v250 offset:448
    ds_read_b128 v[36:39], v250 offset:464
    v_fma_f32 v245, v48, v168, -v245
    v_fmac_f32 v237, v56, v120
    v_fmac_f32 v245, v49, v169
    v_fmac_f32 v237, v57, v121
    v_fmac_f32 v245, v50, v170
    v_fmac_f32 v237, v58, v122
    v_fmac_f32 v245, v51, v171
    v_fmac_f32 v237, v59, v123
    v_fmac_f32 v245, v52, v172
    v_fmac_f32 v237, v60, v124
    v_fmac_f32 v245, v53, v173
    v_fmac_f32 v237, v61, v125
    v_fmac_f32 v245, v54, v174
    v_fmac_f32 v237, v62, v126
    v_fmac_f32 v245, v55, v175
    v_fmac_f32 v237, v63, v127
    s_cmp_eq_u32 s56, 2
    s_cbranch_scc1 K2_U20
    s_cmp_eq_u32 s56, 3
    s_cbranch_scc1 K2_U30
    s_branch K2_DSP0
K2_PAD_U30:
    s_branch K2_HOP
K2_U30:
    s_setprio 1
    s_waitcnt lgkmcnt(6)
    v_lshlrev_b32 v40, 16, v0
    v_and_b32 v41, 0xffff0000, v0
    v_lshlrev_b32 v42, 16, v1
    v_and_b32 v43, 0xffff0000, v1
    v_lshlrev_b32 v44, 16, v2
    v_and_b32 v45, 0xffff0000, v2
    v_lshlrev_b32 v46, 16, v3
    v_and_b32 v47, 0xffff0000, v3
    v_mul_f32 v4, v40, v4
    v_mul_f32 v5, v41, v5
    v_mul_f32 v6, v42, v6
    v_mul_f32 v7, v43, v7
    v_mul_f32 v8, v44, v8
    v_mul_f32 v9, v45, v9
    v_mul_f32 v10, v46, v10
    v_mul_f32 v11, v47, v11
    v_cvt_pk_bf16_f32 v64, v4, v5
    v_cvt_pk_bf16_f32 v65, v6, v7
    v_cvt_pk_bf16_f32 v66, v8, v9
    v_cvt_pk_bf16_f32 v67, v10, v11
    v_mul_f32 v12, v40, v12
    v_mul_f32 v13, v41, v13
    v_mul_f32 v14, v42, v14
    v_mul_f32 v15, v43, v15
    v_mul_f32 v16, v44, v16
    v_mul_f32 v17, v45, v17
    v_mul_f32 v18, v46, v18
    v_mul_f32 v19, v47, v19
    v_cvt_pk_bf16_f32 v68, v12, v13
    v_cvt_pk_bf16_f32 v69, v14, v15
    v_cvt_pk_bf16_f32 v70, v16, v17
    v_cvt_pk_bf16_f32 v71, v18, v19
    ds_read_b64_tr_b16 v[0:1], v249 offset:1024
    ds_read_b64_tr_b16 v[2:3], v249 offset:1152
    ds_read_b128 v[4:7], v250 offset:128
    ds_read_b128 v[8:11], v250 offset:144
    ds_read_b128 v[12:15], v250 offset:512
    ds_read_b128 v[16:19], v250 offset:528
    s_waitcnt lgkmcnt(6)
    v_lshlrev_b32 v48, 16, v20
    v_and_b32 v49, 0xffff0000, v20
    v_lshlrev_b32 v50, 16, v21
    v_and_b32 v51, 0xffff0000, v21
    v_lshlrev_b32 v52, 16, v22
    v_and_b32 v53, 0xffff0000, v22
    v_lshlrev_b32 v54, 16, v23
    v_and_b32 v55, 0xffff0000, v23
    v_mul_f32 v24, v48, v24
    v_mul_f32 v25, v49, v25
    v_mul_f32 v26, v50, v26
    v_mul_f32 v27, v51, v27
    v_mul_f32 v28, v52, v28
    v_mul_f32 v29, v53, v29
    v_mul_f32 v30, v54, v30
    v_mul_f32 v31, v55, v31
    v_cvt_pk_bf16_f32 v72, v24, v25
    v_cvt_pk_bf16_f32 v73, v26, v27
    v_cvt_pk_bf16_f32 v74, v28, v29
    v_cvt_pk_bf16_f32 v75, v30, v31
    v_mul_f32 v32, v48, v32
    v_mul_f32 v33, v49, v33
    v_mul_f32 v34, v50, v34
    v_mul_f32 v35, v51, v35
    v_mul_f32 v36, v52, v36
    v_mul_f32 v37, v53, v37
    v_mul_f32 v38, v54, v38
    v_mul_f32 v39, v55, v39
    v_cvt_pk_bf16_f32 v76, v32, v33
    v_cvt_pk_bf16_f32 v77, v34, v35
    v_cvt_pk_bf16_f32 v78, v36, v37
    v_cvt_pk_bf16_f32 v79, v38, v39
    s_waitcnt lgkmcnt(4)
    v_lshlrev_b32 v40, 16, v0
    v_and_b32 v41, 0xffff0000, v0
    v_lshlrev_b32 v42, 16, v1
    v_and_b32 v43, 0xffff0000, v1
    v_lshlrev_b32 v44, 16, v2
    v_and_b32 v45, 0xffff0000, v2
    v_lshlrev_b32 v46, 16, v3
    v_and_b32 v47, 0xffff0000, v3
    s_waitcnt lgkmcnt(2)
    v_mul_f32 v4, v40, v4
    v_mul_f32 v5, v41, v5
    v_mul_f32 v6, v42, v6
    v_mul_f32 v7, v43, v7
    v_mul_f32 v8, v44, v8
    v_mul_f32 v9, v45, v9
    v_mul_f32 v10, v46, v10
    v_mul_f32 v11, v47, v11
    v_cvt_pk_bf16_f32 v80, v4, v5
    v_cvt_pk_bf16_f32 v81, v6, v7
    v_cvt_pk_bf16_f32 v82, v8, v9
    v_cvt_pk_bf16_f32 v83, v10, v11
    s_waitcnt lgkmcnt(0)
    v_mul_f32 v12, v40, v12
    v_mul_f32 v13, v41, v13
    v_mul_f32 v14, v42, v14
    v_mul_f32 v15, v43, v15
    v_mul_f32 v16, v44, v16
    v_mul_f32 v17, v45, v17
    v_mul_f32 v18, v46, v18
    v_mul_f32 v19, v47, v19
    v_cvt_pk_bf16_f32 v84, v12, v13
    v_cvt_pk_bf16_f32 v85, v14, v15
    v_cvt_pk_bf16_f32 v86, v16, v17
    v_cvt_pk_bf16_f32 v87, v18, v19
    s_waitcnt vmcnt(4)
    v_mfma_f32_32x32x16_bf16 v[0:15], v[64:67], v[176:179], 0
    ds_read_b64_tr_b16 v[184:185], v246 offset:2048
    ds_read_b64_tr_b16 v[186:187], v246 offset:2560
    ds_read_b64_tr_b16 v[188:189], v247 offset:2048
    ds_read_b64_tr_b16 v[190:191], v247 offset:2560
    s_mov_b32 m0, s68
    v_mfma_f32_32x32x16_bf16 v[16:31], v[68:71], v[176:179], 0
    buffer_load_dwordx4 v224, s[4:7], s41 offen sc1 lds
    buffer_load_dwordx4 v225, s[72:75], s41 offen offset:1024 sc1 lds
    v_permlane32_swap_b32 v242, v236
    v_permlane32_swap_b32 v243, v237
    s_add_u32 s38, s38, 1
    v_mfma_f32_32x32x16_bf16 v[32:47], v[64:67], v[180:183], 0
    v_permlane32_swap_b32 v244, v238
    v_permlane32_swap_b32 v245, v239
    v_permlane32_swap_b32 v240, v241
    v_add_f32 v242, v242, v236
    v_mfma_f32_32x32x16_bf16 v[48:63], v[68:71], v[180:183], 0
    v_add_f32 v243, v243, v237
    v_add_f32 v244, v244, v238
    v_add_f32 v245, v245, v239
    v_add_f32 v240, -v240, -v241
    v_mov_b32 v254, s52
    v_mov_b32 v255, s38
    s_waitcnt vmcnt(4) lgkmcnt(0)
    v_mfma_f32_32x32x16_bf16 v[0:15], v[72:75], v[184:187], v[0:15]
    ds_read_b64_tr_b16 v[176:177], v246 offset:4096
    ds_read_b64_tr_b16 v[178:179], v246 offset:4608
    ds_read_b64_tr_b16 v[180:181], v247 offset:4096
    ds_read_b64_tr_b16 v[182:183], v247 offset:4608
    s_lshl_b32 s58, s38, 3
    s_add_u32 s58, s58, s20
    s_mov_b32 m0, s69
    v_mfma_f32_32x32x16_bf16 v[16:31], v[76:79], v[184:187], v[16:31]
    buffer_load_dwordx4 v226, s[4:7], s41 offen sc1 lds
    buffer_load_dwordx4 v227, s[72:75], s41 offen offset:1024 sc1 lds
    s_set_gpr_idx_on s32, gpr_idx(DST)
    s_nop 0
    v_cvt_pk_bf16_f32 v195, v242, v243
    v_cvt_pk_bf16_f32 v196, v244, v245
    v_cvt_pk_bf16_f32 v197, v240, v240
    s_set_gpr_idx_off
    s_mov_b64 exec, 1
    ds_write_b32 v254, v255
    s_mov_b64 exec, -1
    s_cmp_lt_u32 s58, s22
    s_cbranch_scc0 K2_dyn_21
K2_back_22:
    v_readlane_b32 s3, v253, s58
    s_lshl_b32 s44, s34, 7
    s_lshl_b32 s60, s58, 5
    s_and_b32 s48, s3, 0x3ffff
    s_bfe_u32 s33, s3, 0x30012
    s_sub_u32 s60, s60, s48
    s_and_b32 s60, s60, 0xff
    s_add_u32 s60, s60, s48
    s_mul_i32 s35, s38, 6
    s_cmp_eq_u32 s34, 0
    s_cselect_b32 s35, s35, s60
    s_mov_b32 s45, s44
    s_add_u32 s47, s44, 256
    s_add_u32 s49, s48, 32
    s_add_u32 s60, s48, 64
    s_cmp_eq_u32 s33, 3
    s_cselect_b32 s46, s44, s47
    s_cselect_b32 s50, s60, s48
    s_cselect_b32 s51, s48, s49
    s_sub_u32 s60, s33, 2
    s_cmp_lt_u32 s60, 2
    s_cbranch_scc0 K2_rare_27
K2_back_28:
    v_mfma_f32_32x32x16_bf16 v[32:47], v[72:75], v[188:191], v[32:47]
    v_add_u32 v233, s48, v230
    ds_read_b32 v232, v233
    ds_read_b32 v233, v233 offset:1024
    v_mfma_f32_32x32x16_bf16 v[48:63], v[76:79], v[188:191], v[48:63]
    s_waitcnt vmcnt(4) lgkmcnt(3)
    v_mfma_f32_32x32x16_bf16 v[0:15], v[80:83], v[176:179], v[0:15]
    ds_read_b64_tr_b16 v[184:185], v246 offset:6144
    ds_read_b64_tr_b16 v[186:187], v246 offset:6656
    ds_read_b64_tr_b16 v[188:189], v247 offset:6144
    ds_read_b64_tr_b16 v[190:191], v247 offset:6656
    s_mov_b32 m0, s70
    v_mfma_f32_32x32x16_bf16 v[16:31], v[84:87], v[176:179], v[16:31]
    buffer_load_dwordx4 v222, s[4:7], s42 offen sc1 lds
    buffer_load_dwordx4 v223, s[72:75], s42 offen offset:1024 sc1 lds
    v_mfma_f32_32x32x16_bf16 v[32:47], v[80:83], v[180:183], v[32:47]
    s_nop 2
    v_mul_f32 v234, v0, v96
    v_mul_f32 v236, v8, v128
    v_fmac_f32 v234, v1, v97
    v_fmac_f32 v236, v9, v129
    v_fmac_f32 v234, v2, v98
    v_fmac_f32 v236, v10, v130
    v_fmac_f32 v234, v3, v99
    v_mfma_f32_32x32x16_bf16 v[48:63], v[84:87], v[180:183], v[48:63]
    s_setprio 0
    s_waitcnt lgkmcnt(4)
    v_or_b32 v232, v232, v231
    v_or_b32 v233, v233, v231
    s_cmp_lg_u32 s34, 0
    s_cbranch_scc1 K2_dum_30
    s_add_u32 m0, s48, 864
    s_add_u32 s65, s48, 1888
    buffer_load_dwordx4 v232, s[16:19], 0 offen  lds
    s_mov_b32 m0, s65
    s_mov_b32 exec_hi, 0
    buffer_load_dwordx4 v233, s[16:19], 0 offen  lds
    s_cmp_eq_u32 s33, 4
    s_cbranch_scc1 K2_a4_31
K2_b4_33:
    s_mov_b32 exec_hi, -1
K2_back_32:
    v_fmac_f32 v236, v11, v131
    v_fmac_f32 v234, v4, v100
    v_fmac_f32 v236, v12, v132
    v_fmac_f32 v234, v5, v101
    v_fmac_f32 v236, v13, v133
    v_fmac_f32 v234, v6, v102
    v_fmac_f32 v236, v14, v134
    v_fmac_f32 v234, v7, v103
    v_fmac_f32 v236, v15, v135
    v_mul_f32 v238, v16, v128
    v_mul_f32 v240, v24, v128
    v_fmac_f32 v238, v17, v129
    v_fmac_f32 v240, v25, v129
    v_fmac_f32 v238, v18, v130
    v_fmac_f32 v240, v26, v130
    v_fmac_f32 v238, v19, v131
    v_fmac_f32 v240, v27, v131
    v_fmac_f32 v238, v20, v132
    v_fmac_f32 v240, v28, v132
    v_fmac_f32 v238, v21, v133
    v_fmac_f32 v240, v29, v133
    v_fmac_f32 v238, v22, v134
    v_fmac_f32 v240, v30, v134
    v_fmac_f32 v238, v23, v135
    v_fmac_f32 v240, v31, v135
    v_mul_f32 v235, v32, v104
    v_mul_f32 v237, v40, v136
    v_fmac_f32 v235, v33, v105
    v_fmac_f32 v237, v41, v137
    v_fmac_f32 v235, v34, v106
    v_fmac_f32 v237, v42, v138
    v_fmac_f32 v235, v35, v107
    v_fmac_f32 v237, v43, v139
    v_fmac_f32 v235, v36, v108
    v_fmac_f32 v237, v44, v140
    v_fmac_f32 v235, v37, v109
    v_fmac_f32 v237, v45, v141
    v_fmac_f32 v235, v38, v110
    v_fmac_f32 v237, v46, v142
    v_fmac_f32 v235, v39, v111
    v_fmac_f32 v237, v47, v143
    v_mul_f32 v239, v48, v136
    v_mul_f32 v241, v56, v136
    s_setprio 1
    s_waitcnt vmcnt(6) lgkmcnt(0)
    v_mfma_f32_32x32x16_bf16 v[0:15], v[64:67], v[184:187], 0
    ds_read_b64_tr_b16 v[176:177], v246 offset:0
    ds_read_b64_tr_b16 v[178:179], v246 offset:512
    ds_read_b64_tr_b16 v[180:181], v247 offset:0
    ds_read_b64_tr_b16 v[182:183], v247 offset:512
    v_fmac_f32 v239, v49, v137
    v_fmac_f32 v241, v57, v137
    s_mov_b32 m0, s71
    v_mfma_f32_32x32x16_bf16 v[16:31], v[68:71], v[184:187], 0
    buffer_load_dwordx4 v224, s[4:7], s42 offen sc1 lds
    buffer_load_dwordx4 v225, s[72:75], s42 offen offset:1024 sc1 lds
    v_fmac_f32 v239, v50, v138
    v_fmac_f32 v241, v58, v138
    v_fmac_f32 v239, v51, v139
    v_fmac_f32 v241, v59, v139
    v_fmac_f32 v239, v52, v140
    v_mfma_f32_32x32x16_bf16 v[32:47], v[64:67], v[188:191], 0
    v_fmac_f32 v241, v60, v140
    v_fmac_f32 v239, v53, v141
    v_fmac_f32 v241, v61, v141
    v_fmac_f32 v239, v54, v142
    v_fmac_f32 v241, v62, v142
    v_fmac_f32 v239, v55, v143
    v_fmac_f32 v241, v63, v143
    v_mfma_f32_32x32x16_bf16 v[48:63], v[68:71], v[188:191], 0
    v_permlane32_swap_b32 v234, v236
    v_permlane32_swap_b32 v235, v237
    v_permlane32_swap_b32 v240, v238
    s_waitcnt vmcnt(6) lgkmcnt(0)
    v_mfma_f32_32x32x16_bf16 v[0:15], v[72:75], v[176:179], v[0:15]
    ds_read_b64_tr_b16 v[184:185], v246 offset:2048
    ds_read_b64_tr_b16 v[186:187], v246 offset:2560
    ds_read_b64_tr_b16 v[188:189], v247 offset:2048
    ds_read_b64_tr_b16 v[190:191], v247 offset:2560
    v_permlane32_swap_b32 v241, v239
    s_mov_b32 m0, s68
    v_mfma_f32_32x32x16_bf16 v[16:31], v[76:79], v[176:179], v[16:31]
    buffer_load_dwordx4 v226, s[4:7], s42 offen sc1 lds
    buffer_load_dwordx4 v227, s[72:75], s42 offen offset:1024 sc1 lds
    v_add_f32 v234, v234, v236
    v_add_f32 v235, v235, v237
    v_add_f32 v240, v240, v238
    v_add_f32 v241, v241, v239
    v_mfma_f32_32x32x16_bf16 v[32:47], v[72:75], v[180:183], v[32:47]
    s_set_gpr_idx_on s31, gpr_idx(DST)
    s_nop 0
    v_cvt_pk_bf16_f32 v192, v234, v235
    v_cvt_pk_bf16_f32 v193, v240, v241
    s_set_gpr_idx_off
    v_mfma_f32_32x32x16_bf16 v[48:63], v[76:79], v[180:183], v[48:63]
    s_waitcnt vmcnt(6) lgkmcnt(0)
    v_mfma_f32_32x32x16_bf16 v[0:15], v[80:83], v[184:187], v[0:15]
    ds_read_b64_tr_b16 v[176:177], v246 offset:4096
    ds_read_b64_tr_b16 v[178:179], v246 offset:4608
    ds_read_b64_tr_b16 v[180:181], v247 offset:4096
    ds_read_b64_tr_b16 v[182:183], v247 offset:4608
    s_mov_b32 m0, s69
    v_mfma_f32_32x32x16_bf16 v[16:31], v[84:87], v[184:187], v[16:31]
    buffer_load_dwordx4 v222, s[4:7], s43 offen sc1 lds
    buffer_load_dwordx4 v223, s[72:75], s43 offen offset:1024 sc1 lds
    v_mfma_f32_32x32x16_bf16 v[32:47], v[80:83], v[188:191], v[32:47]
    s_nop 2
    v_mul_f32 v234, v0, v144
    v_mul_f32 v236, v8, v112
    v_fmac_f32 v234, v1, v145
    v_fmac_f32 v236, v9, v113
    v_fmac_f32 v234, v2, v146
    v_fmac_f32 v236, v10, v114
    v_fmac_f32 v234, v3, v147
    v_mfma_f32_32x32x16_bf16 v[48:63], v[84:87], v[188:191], v[48:63]
    s_setprio 0
    v_fmac_f32 v236, v11, v115
    v_fmac_f32 v234, v4, v148
    v_fmac_f32 v236, v12, v116
    v_fmac_f32 v234, v5, v149
    v_fmac_f32 v236, v13, v117
    v_fmac_f32 v234, v6, v150
    v_fmac_f32 v236, v14, v118
    v_fmac_f32 v234, v7, v151
    v_fmac_f32 v236, v15, v119
    v_mul_f32 v238, v16, v160
    v_mul_f32 v240, v24, v160
    v_fmac_f32 v238, v17, v161
    v_fmac_f32 v240, v25, v161
    v_fmac_f32 v238, v18, v162
    v_fmac_f32 v240, v26, v162
    v_fmac_f32 v238, v19, v163
    v_fmac_f32 v240, v27, v163
    v_fmac_f32 v238, v20, v164
    v_fmac_f32 v240, v28, v164
    v_fmac_f32 v238, v21, v165
    v_fmac_f32 v240, v29, v165
    v_fmac_f32 v238, v22, v166
    v_fmac_f32 v240, v30, v166
    v_fmac_f32 v238, v23, v167
    v_fmac_f32 v240, v31, v167
    v_mul_f32 v235, v32, v152
    v_mul_f32 v237, v40, v120
    v_fmac_f32 v235, v33, v153
    v_fmac_f32 v237, v41, v121
    v_fmac_f32 v235, v34, v154
    v_fmac_f32 v237, v42, v122
    v_fmac_f32 v235, v35, v155
    v_fmac_f32 v237, v43, v123
    v_fmac_f32 v235, v36, v156
    v_fmac_f32 v237, v44, v124
    v_fmac_f32 v235, v37, v157
    v_fmac_f32 v237, v45, v125
    v_fmac_f32 v235, v38, v158
    v_fmac_f32 v237, v46, v126
    v_fmac_f32 v235, v39, v159
    v_fmac_f32 v237, v47, v127
    v_mul_f32 v239, v48, v168
    v_mul_f32 v241, v56, v168
    v_fmac_f32 v239, v49, v169
    v_fmac_f32 v241, v57, v169
    s_setprio 1
    s_waitcnt vmcnt(4) lgkmcnt(0)
    v_mfma_f32_32x32x16_bf16 v[0:15], v[64:67], v[176:179], 0
    ds_read_b64_tr_b16 v[184:185], v246 offset:6144
    ds_read_b64_tr_b16 v[186:187], v246 offset:6656
    ds_read_b64_tr_b16 v[188:189], v247 offset:6144
    ds_read_b64_tr_b16 v[190:191], v247 offset:6656
    v_fmac_f32 v239, v50, v170
    v_fmac_f32 v241, v58, v170
    s_mov_b32 m0, s70
    v_mfma_f32_32x32x16_bf16 v[16:31], v[68:71], v[176:179], 0
    buffer_load_dwordx4 v224, s[4:7], s43 offen sc1 lds
    buffer_load_dwordx4 v225, s[72:75], s43 offen offset:1024 sc1 lds
    v_fmac_f32 v239, v51, v171
    v_fmac_f32 v241, v59, v171
    v_fmac_f32 v239, v52, v172
    v_fmac_f32 v241, v60, v172
    v_fmac_f32 v239, v53, v173
    v_mfma_f32_32x32x16_bf16 v[32:47], v[64:67], v[180:183], 0
    v_add_u32 v222, s48, v251
    ds_read_b32 v222, v222
    v_fmac_f32 v241, v61, v173
    v_fmac_f32 v239, v54, v174
    v_fmac_f32 v241, v62, v174
    v_fmac_f32 v239, v55, v175
    v_fmac_f32 v241, v63, v175
    v_mfma_f32_32x32x16_bf16 v[48:63], v[68:71], v[180:183], 0
    s_waitcnt vmcnt(4) lgkmcnt(1)
    v_mfma_f32_32x32x16_bf16 v[0:15], v[72:75], v[184:187], v[0:15]
    ds_read_b64_tr_b16 v[176:177], v246 offset:0
    ds_read_b64_tr_b16 v[178:179], v246 offset:512
    ds_read_b64_tr_b16 v[180:181], v247 offset:0
    ds_read_b64_tr_b16 v[182:183], v247 offset:512
    s_mov_b32 m0, s71
    v_mfma_f32_32x32x16_bf16 v[16:31], v[76:79], v[184:187], v[16:31]
    buffer_load_dwordx4 v226, s[4:7], s43 offen sc1 lds
    buffer_load_dwordx4 v227, s[72:75], s43 offen offset:1024 sc1 lds
    s_waitcnt lgkmcnt(4)
    v_mad_u32_u16 v223, v222, s39, v248 op_sel:[1,0,0,0]
    v_mad_u32_u16 v222, v222, s39, v248
    v_mfma_f32_32x32x16_bf16 v[32:47], v[72:75], v[188:191], v[32:47]
    v_add_u32 v224, s49, v251
    ds_read_b32 v224, v224
    v_mfma_f32_32x32x16_bf16 v[48:63], v[76:79], v[188:191], v[48:63]
    s_waitcnt vmcnt(4) lgkmcnt(1)
    v_mfma_f32_32x32x16_bf16 v[0:15], v[80:83], v[176:179], v[0:15]
    ds_read_b64_tr_b16 v[184:185], v246 offset:2048
    ds_read_b64_tr_b16 v[186:187], v246 offset:2560
    ds_read_b64_tr_b16 v[188:189], v247 offset:2048
    ds_read_b64_tr_b16 v[190:191], v247 offset:2560
    s_mov_b32 m0, s68
    v_mfma_f32_32x32x16_bf16 v[16:31], v[84:87], v[176:179], v[16:31]
    buffer_load_dwordx4 v222, s[4:7], s44 offen sc1 lds
    buffer_load_dwordx4 v223, s[72:75], s44 offen offset:1024 sc1 lds
    s_waitcnt lgkmcnt(4)
    v_mad_u32_u16 v225, v224, s39, v248 op_sel:[1,0,0,0]
    v_mad_u32_u16 v224, v224, s39, v248
    v_mfma_f32_32x32x16_bf16 v[32:47], v[80:83], v[180:183], v[32:47]
    v_add_u32 v226, s50, v251
    ds_read_b32 v226, v226
    v_mul_f32 v242, v0, v144
    v_fma_f32 v238, v8, v160, -v238
    v_fmac_f32 v242, v1, v145
    v_fmac_f32 v238, v9, v161
    v_fmac_f32 v242, v2, v146
    v_mfma_f32_32x32x16_bf16 v[48:63], v[84:87], v[180:183], v[48:63]
    s_setprio 0
    v_fmac_f32 v238, v10, v162
    v_fmac_f32 v242, v3, v147
    v_fmac_f32 v238, v11, v163
    v_fmac_f32 v242, v4, v148
    v_fmac_f32 v238, v12, v164
    v_fmac_f32 v242, v5, v149
    v_fmac_f32 v238, v13, v165
    v_fmac_f32 v242, v6, v150
    v_fmac_f32 v238, v14, v166
    v_fmac_f32 v242, v7, v151
    v_fmac_f32 v238, v15, v167
    v_fmac_f32 v236, v16, v112
    v_mul_f32 v244, v24, v160
    v_fmac_f32 v236, v17, v113
    v_fmac_f32 v244, v25, v161
    v_fmac_f32 v236, v18, v114
    v_fmac_f32 v244, v26, v162
    v_fmac_f32 v236, v19, v115
    v_fmac_f32 v244, v27, v163
    v_fmac_f32 v236, v20, v116
    v_fmac_f32 v244, v28, v164
    v_fmac_f32 v236, v21, v117
    v_fmac_f32 v244, v29, v165
    v_fmac_f32 v236, v22, v118
    v_fmac_f32 v244, v30, v166
    v_fmac_f32 v236, v23, v119
    v_fmac_f32 v244, v31, v167
    v_mul_f32 v243, v32, v152
    v_fma_f32 v239, v40, v168, -v239
    v_fmac_f32 v243, v33, v153
    v_fmac_f32 v239, v41, v169
    v_fmac_f32 v243, v34, v154
    v_fmac_f32 v239, v42, v170
    v_fmac_f32 v243, v35, v155
    v_fmac_f32 v239, v43, v171
    v_fmac_f32 v243, v36, v156
    v_fmac_f32 v239, v44, v172
    v_fmac_f32 v243, v37, v157
    v_fmac_f32 v239, v45, v173
    v_fmac_f32 v243, v38, v158
    v_fmac_f32 v239, v46, v174
    v_fmac_f32 v243, v39, v159
    v_fmac_f32 v239, v47, v175
    v_fmac_f32 v237, v48, v120
    v_mul_f32 v245, v56, v168
    v_fmac_f32 v237, v49, v121
    v_fmac_f32 v245, v57, v169
    v_fmac_f32 v237, v50, v122
    v_fmac_f32 v245, v58, v170
    v_fmac_f32 v237, v51, v123
    s_setprio 1
    s_waitcnt vmcnt(4) lgkmcnt(1)
    v_mfma_f32_32x32x16_bf16 v[0:15], v[64:67], v[184:187], 0
    ds_read_b64_tr_b16 v[176:177], v246 offset:4096
    ds_read_b64_tr_b16 v[178:179], v246 offset:4608
    ds_read_b64_tr_b16 v[180:181], v247 offset:4096
    ds_read_b64_tr_b16 v[182:183], v247 offset:4608
    v_fmac_f32 v245, v59, v171
    v_fmac_f32 v237, v52, v124
    s_mov_b32 m0, s69
    v_mfma_f32_32x32x16_bf16 v[16:31], v[68:71], v[184:187], 0
    buffer_load_dwordx4 v224, s[4:7], s45 offen sc1 lds
    buffer_load_dwordx4 v225, s[72:75], s45 offen offset:1024 sc1 lds
    s_waitcnt lgkmcnt(4)
    v_mad_u32_u16 v227, v226, s39, v248 op_sel:[1,0,0,0]
    v_mad_u32_u16 v226, v226, s39, v248
    v_fmac_f32 v245, v60, v172
    v_fmac_f32 v237, v53, v125
    v_mfma_f32_32x32x16_bf16 v[32:47], v[64:67], v[188:191], 0
    v_add_u32 v228, s51, v251
    ds_read_b32 v228, v228
    v_fmac_f32 v245, v61, v173
    v_fmac_f32 v237, v54, v126
    v_fmac_f32 v245, v62, v174
    v_fmac_f32 v237, v55, v127
    v_fmac_f32 v245, v63, v175
    v_mfma_f32_32x32x16_bf16 v[48:63], v[68:71], v[188:191], 0
    v_permlane32_swap_b32 v242, v234
    v_permlane32_swap_b32 v243, v235
    v_add_f32 v242, v242, v234
    v_add_f32 v243, v243, v235
    s_waitcnt vmcnt(4) lgkmcnt(1)
    v_mfma_f32_32x32x16_bf16 v[0:15], v[72:75], v[176:179], v[0:15]
    ds_read_b64_tr_b16 v[184:185], v246 offset:6144
    ds_read_b64_tr_b16 v[186:187], v246 offset:6656
    ds_read_b64_tr_b16 v[188:189], v247 offset:6144
    ds_read_b64_tr_b16 v[190:191], v247 offset:6656
    s_mov_b32 m0, s70
    v_mfma_f32_32x32x16_bf16 v[16:31], v[76:79], v[176:179], v[16:31]
    buffer_load_dwordx4 v226, s[4:7], s46 offen sc1 lds
    buffer_load_dwordx4 v227, s[72:75], s46 offen offset:1024 sc1 lds
    s_waitcnt lgkmcnt(4)
    v_mad_u32_u16 v229, v228, s39, v248 op_sel:[1,0,0,0]
    v_mad_u32_u16 v228, v228, s39, v248
    s_sub_u32 s26, s48, s29
    s_mov_b32 s29, s48
    v_mfma_f32_32x32x16_bf16 v[32:47], v[72:75], v[180:183], v[32:47]
    s_set_gpr_idx_on s31, gpr_idx(DST)
    s_nop 0
    v_cvt_pk_bf16_f32 v194, v242, v243
    s_set_gpr_idx_off
    s_mov_b32 s30, s3
    s_cmp_eq_u32 s34, 0
    s_cselect_b32 s56, s33, 0
    s_mov_b32 s32, s31
    v_mfma_f32_32x32x16_bf16 v[48:63], v[76:79], v[180:183], v[48:63]
    s_mov_b32 s31, s35
    s_waitcnt vmcnt(4) lgkmcnt(0)
    v_mfma_f32_32x32x16_bf16 v[0:15], v[80:83], v[184:187], v[0:15]
    ds_read_b64_tr_b16 v[176:177], v246 offset:0
    ds_read_b64_tr_b16 v[178:179], v246 offset:512
    ds_read_b64_tr_b16 v[180:181], v247 offset:0
    ds_read_b64_tr_b16 v[182:183], v247 offset:512
    s_mov_b32 m0, s71
    v_mfma_f32_32x32x16_bf16 v[16:31], v[84:87], v[184:187], v[16:31]
    buffer_load_dwordx4 v228, s[4:7], s47 offen sc1 lds
    buffer_load_dwordx4 v229, s[72:75], s47 offen offset:1024 sc1 lds
    v_mfma_f32_32x32x16_bf16 v[32:47], v[80:83], v[188:191], v[32:47]
    s_nop 2
    v_mul_f32 v242, v0, v144
    v_fma_f32 v240, v8, v160, -v240
    v_fmac_f32 v242, v1, v145
    v_fmac_f32 v240, v9, v161
    v_fmac_f32 v242, v2, v146
    v_fmac_f32 v240, v10, v162
    v_fmac_f32 v242, v3, v147
    v_mfma_f32_32x32x16_bf16 v[48:63], v[84:87], v[188:191], v[48:63]
    s_setprio 0
    v_fmac_f32 v240, v11, v163
    v_fmac_f32 v242, v4, v148
    v_fmac_f32 v240, v12, v164
    v_fmac_f32 v242, v5, v149
    v_fmac_f32 v240, v13, v165
    v_fmac_f32 v242, v6, v150
    v_fmac_f32 v240, v14, v166
    v_fmac_f32 v242, v7, v151
    v_fmac_f32 v240, v15, v167
    v_add_u32 v249, s26, v249
    v_add_u32 v250, s26, v250
    v_fma_f32 v244, v16, v160, -v244
    v_fmac_f32 v236, v24, v112
    v_fmac_f32 v244, v17, v161
    v_fmac_f32 v236, v25, v113
    v_fmac_f32 v244, v18, v162
    v_fmac_f32 v236, v26, v114
    v_fmac_f32 v244, v19, v163
    v_fmac_f32 v236, v27, v115
    v_fmac_f32 v244, v20, v164
    v_fmac_f32 v236, v28, v116
    v_fmac_f32 v244, v21, v165
    v_fmac_f32 v236, v29, v117
    v_fmac_f32 v244, v22, v166
    v_fmac_f32 v236, v30, v118
    v_fmac_f32 v244, v23, v167
    v_fmac_f32 v236, v31, v119
    ds_read_b64_tr_b16 v[0:1], v249 offset:0
    ds_read_b64_tr_b16 v[2:3], v249 offset:128
    ds_read_b128 v[4:7], v250 offset:0
    ds_read_b128 v[8:11], v250 offset:16
    ds_read_b128 v[12:15], v250 offset:384
    ds_read_b128 v[16:19], v250 offset:400
    v_mul_f32 v243, v32, v152
    v_fma_f32 v241, v40, v168, -v241
    v_fmac_f32 v243, v33, v153
    v_fmac_f32 v241, v41, v169
    v_fmac_f32 v243, v34, v154
    v_fmac_f32 v241, v42, v170
    v_fmac_f32 v243, v35, v155
    v_fmac_f32 v241, v43, v171
    v_fmac_f32 v243, v36, v156
    v_fmac_f32 v241, v44, v172
    v_fmac_f32 v243, v37, v157
    v_fmac_f32 v241, v45, v173
    v_fmac_f32 v243, v38, v158
    v_fmac_f32 v241, v46, v174
    v_fmac_f32 v243, v39, v159
    v_fmac_f32 v241, v47, v175
    ds_read_b64_tr_b16 v[20:21], v249 offset:512
    ds_read_b64_tr_b16 v[22:23], v249 offset:640
    ds_read_b128 v[24:27], v250 offset:64
    ds_read_b128 v[28:31], v250 offset:80
    ds_read_b128 v[32:35], v250 offset:448
    ds_read_b128 v[36:39], v250 offset:464
    v_fma_f32 v245, v48, v168, -v245
    v_fmac_f32 v237, v56, v120
    v_fmac_f32 v245, v49, v169
    v_fmac_f32 v237, v57, v121
    v_fmac_f32 v245, v50, v170
    v_fmac_f32 v237, v58, v122
    v_fmac_f32 v245, v51, v171
    v_fmac_f32 v237, v59, v123
    v_fmac_f32 v245, v52, v172
    v_fmac_f32 v237, v60, v124
    v_fmac_f32 v245, v53, v173
    v_fmac_f32 v237, v61, v125
    v_fmac_f32 v245, v54, v174
    v_fmac_f32 v237, v62, v126
    v_fmac_f32 v245, v55, v175
    v_fmac_f32 v237, v63, v127
    s_cmp_eq_u32 s56, 2
    s_cbranch_scc1 K2_U20
    s_cmp_eq_u32 s56, 3
    s_cbranch_scc1 K2_U30
    s_branch K2_DSP0
K2_PAD_U21:
    s_branch K2_HOP
K2_U21:
    s_setprio 1
    s_waitcnt lgkmcnt(6)
    v_lshlrev_b32 v40, 16, v0
    v_and_b32 v41, 0xffff0000, v0
    v_lshlrev_b32 v42, 16, v1
    v_and_b32 v43, 0xffff0000, v1
    v_lshlrev_b32 v44, 16, v2
    v_and_b32 v45, 0xffff0000, v2
    v_lshlrev_b32 v46, 16, v3
    v_and_b32 v47, 0xffff0000, v3
    v_mul_f32 v4, v40, v4
    v_mul_f32 v5, v41, v5
    v_mul_f32 v6, v42, v6
    v_mul_f32 v7, v43, v7
    v_mul_f32 v8, v44, v8
    v_mul_f32 v9, v45, v9
    v_mul_f32 v10, v46, v10
    v_mul_f32 v11, v47, v11
    v_cvt_pk_bf16_f32 v64, v4, v5
    v_cvt_pk_bf16_f32 v65, v6, v7
    v_cvt_pk_bf16_f32 v66, v8, v9
    v_cvt_pk_bf16_f32 v67, v10, v11
    v_mul_f32 v12, v40, v12
    v_mul_f32 v13, v41, v13
    v_mul_f32 v14, v42, v14
    v_mul_f32 v15, v43, v15
    v_mul_f32 v16, v44, v16
    v_mul_f32 v17, v45, v17
    v_mul_f32 v18, v46, v18
    v_mul_f32 v19, v47, v19
    v_cvt_pk_bf16_f32 v68, v12, v13
    v_cvt_pk_bf16_f32 v69, v14, v15
    v_cvt_pk_bf16_f32 v70, v16, v17
    v_cvt_pk_bf16_f32 v71, v18, v19
    s_waitcnt lgkmcnt(0)
    v_lshlrev_b32 v48, 16, v20
    v_and_b32 v49, 0xffff0000, v20
    v_lshlrev_b32 v50, 16, v21
    v_and_b32 v51, 0xffff0000, v21
    v_lshlrev_b32 v52, 16, v22
    v_and_b32 v53, 0xffff0000, v22
    v_lshlrev_b32 v54, 16, v23
    v_and_b32 v55, 0xffff0000, v23
    v_mul_f32 v24, v48, v24
    v_mul_f32 v25, v49, v25
    v_mul_f32 v26, v50, v26
    v_mul_f32 v27, v51, v27
    v_mul_f32 v28, v52, v28
    v_mul_f32 v29, v53, v29
    v_mul_f32 v30, v54, v30
    v_mul_f32 v31, v55, v31
    v_cvt_pk_bf16_f32 v72, v24, v25
    v_cvt_pk_bf16_f32 v73, v26, v27
    v_cvt_pk_bf16_f32 v74, v28, v29
    v_cvt_pk_bf16_f32 v75, v30, v31
    v_mul_f32 v32, v48, v32
    v_mul_f32 v33, v49, v33
    v_mul_f32 v34, v50, v34
    v_mul_f32 v35, v51, v35
    v_mul_f32 v36, v52, v36
    v_mul_f32 v37, v53, v37
    v_mul_f32 v38, v54, v38
    v_mul_f32 v39, v55, v39
    v_cvt_pk_bf16_f32 v76, v32, v33
    v_cvt_pk_bf16_f32 v77, v34, v35
    v_cvt_pk_bf16_f32 v78, v36, v37
    v_cvt_pk_bf16_f32 v79, v38, v39
    s_waitcnt vmcnt(4)
    v_mfma_f32_32x32x16_bf16 v[0:15], v[64:67], v[176:179], 0
    ds_read_b64_tr_b16 v[184:185], v246 offset:2048
    ds_read_b64_tr_b16 v[186:187], v246 offset:2560
    ds_read_b64_tr_b16 v[188:189], v247 offset:2048
    ds_read_b64_tr_b16 v[190:191], v247 offset:2560
    s_mov_b32 m0, s68
    v_mfma_f32_32x32x16_bf16 v[16:31], v[68:71], v[176:179], 0
    buffer_load_dwordx4 v222, s[4:7], s42 offen sc1 lds
    buffer_load_dwordx4 v223, s[72:75], s42 offen offset:1024 sc1 lds
    v_permlane32_swap_b32 v242, v236
    v_permlane32_swap_b32 v243, v237
    v_mov_b32 v254, 163648
    v_mfma_f32_32x32x16_bf16 v[32:47], v[64:67], v[180:183], 0
    v_permlane32_swap_b32 v244, v238
    v_permlane32_swap_b32 v245, v239
    v_permlane32_swap_b32 v240, v241
    v_add_f32 v242, v242, v236
    v_mfma_f32_32x32x16_bf16 v[48:63], v[68:71], v[180:183], 0
    v_add_f32 v243, v243, v237
    v_add_f32 v244, v244, v238
    v_add_f32 v245, v245, v239
    v_add_f32 v240, -v240, -v241
    v_sub_u32 v241, v230, v231
    v_cvt_pk_bf16_f32 v242, v242, v243
    v_mov_b32 v255, 1
    v_lshl_add_u32 v233, v252, 1, s53
    s_mov_b64 exec, 1
    ds_add_rtn_u32 v232, v254, v255
    s_mov_b64 exec, -1
    ds_read_b32 v233, v233
    s_waitcnt vmcnt(4) lgkmcnt(2)
    v_mfma_f32_32x32x16_bf16 v[0:15], v[72:75], v[184:187], v[0:15]
    ds_read_b64_tr_b16 v[176:177], v246 offset:4096
    ds_read_b64_tr_b16 v[178:179], v246 offset:4608
    ds_read_b64_tr_b16 v[180:181], v247 offset:4096
    ds_read_b64_tr_b16 v[182:183], v247 offset:4608
    v_cvt_pk_bf16_f32 v244, v244, v245
    v_cvt_pk_bf16_f32 v240, v240, v240
    s_mov_b32 m0, s69
    v_mfma_f32_32x32x16_bf16 v[16:31], v[76:79], v[184:187], v[16:31]
    buffer_load_dwordx4 v224, s[4:7], s42 offen sc1 lds
    buffer_load_dwordx4 v225, s[72:75], s42 offen offset:1024 sc1 lds
    ds_write_b32 v230, v242 offset:768
    ds_write_b32 v230, v244 offset:1024
    ds_write_b16 v241, v240 offset:1280
    s_waitcnt lgkmcnt(7)
    v_readfirstlane_b32 s58, v232
    v_mfma_f32_32x32x16_bf16 v[32:47], v[72:75], v[188:191], v[32:47]
    s_cmp_lt_u32 s58, s22
    s_cbranch_scc0 K2_nul_34
    s_and_b32 s59, s58, 7
    s_lshr_b32 s60, s58, 3
K2_chk_36:
    v_readlane_b32 s61, v233, s59
    s_nop 0
    s_cmp_gt_u32 s61, s60
    s_cbranch_scc0 K2_spin_35
K2_back_37:
    v_mfma_f32_32x32x16_bf16 v[48:63], v[76:79], v[188:191], v[48:63]
    s_setprio 0
    v_readlane_b32 s3, v253, s58
    s_lshl_b32 s44, s34, 7
    s_lshl_b32 s60, s58, 5
    s_and_b32 s48, s3, 0x3ffff
    s_bfe_u32 s33, s3, 0x30012
    s_sub_u32 s60, s60, s48
    v_mul_f32 v234, v0, v96
    v_mul_f32 v236, v8, v128
    v_fmac_f32 v234, v1, v97
    v_fmac_f32 v236, v9, v129
    v_fmac_f32 v234, v2, v98
    v_fmac_f32 v236, v10, v130
    v_fmac_f32 v234, v3, v99
    v_fmac_f32 v236, v11, v131
    v_fmac_f32 v234, v4, v100
    v_fmac_f32 v236, v12, v132
    v_fmac_f32 v234, v5, v101
    v_fmac_f32 v236, v13, v133
    v_fmac_f32 v234, v6, v102
    v_fmac_f32 v236, v14, v134
    v_fmac_f32 v234, v7, v103
    v_fmac_f32 v236, v15, v135
    v_mul_f32 v238, v16, v128
    v_mul_f32 v240, v24, v128
    v_fmac_f32 v238, v17, v129
    v_fmac_f32 v240, v25, v129
    v_fmac_f32 v238, v18, v130
    v_fmac_f32 v240, v26, v130
    v_fmac_f32 v238, v19, v131
    v_fmac_f32 v240, v27, v131
    v_fmac_f32 v238, v20, v132
    v_fmac_f32 v240, v28, v132
    v_fmac_f32 v238, v21, v133
    v_fmac_f32 v240, v29, v133
    v_fmac_f32 v238, v22, v134
    v_fmac_f32 v240, v30, v134
    v_fmac_f32 v238, v23, v135
    v_fmac_f32 v240, v31, v135
    v_mul_f32 v235, v32, v104
    v_mul_f32 v237, v40, v136
    v_fmac_f32 v235, v33, v105
    v_fmac_f32 v237, v41, v137
    v_fmac_f32 v235, v34, v106
    v_fmac_f32 v237, v42, v138
    v_fmac_f32 v235, v35, v107
    v_fmac_f32 v237, v43, v139
    v_fmac_f32 v235, v36, v108
    v_fmac_f32 v237, v44, v140
    v_fmac_f32 v235, v37, v109
    v_fmac_f32 v237, v45, v141
    v_fmac_f32 v235, v38, v110
    v_fmac_f32 v237, v46, v142
    v_fmac_f32 v235, v39, v111
    v_fmac_f32 v237, v47, v143
    v_mul_f32 v239, v48, v136
    v_mul_f32 v241, v56, v136
    v_fmac_f32 v239, v49, v137
    v_fmac_f32 v241, v57, v137
    s_setprio 1
    s_waitcnt vmcnt(4) lgkmcnt(3)
    v_mfma_f32_32x32x16_bf16 v[0:15], v[64:67], v[176:179], 0
    ds_read_b64_tr_b16 v[184:185], v246 offset:6144
    ds_read_b64_tr_b16 v[186:187], v246 offset:6656
    ds_read_b64_tr_b16 v[188:189], v247 offset:6144
    ds_read_b64_tr_b16 v[190:191], v247 offset:6656
    v_fmac_f32 v239, v50, v138
    v_fmac_f32 v241, v58, v138
    s_mov_b32 m0, s70
    v_mfma_f32_32x32x16_bf16 v[16:31], v[68:71], v[176:179], 0
    buffer_load_dwordx4 v222, s[4:7], s43 offen sc1 lds
    buffer_load_dwordx4 v223, s[72:75], s43 offen offset:1024 sc1 lds
    v_fmac_f32 v239, v51, v139
    v_fmac_f32 v241, v59, v139
    v_fmac_f32 v239, v52, v140
    v_fmac_f32 v241, v60, v140
    v_fmac_f32 v239, v53, v141
    v_mfma_f32_32x32x16_bf16 v[32:47], v[64:67], v[180:183], 0
    s_and_b32 s60, s60, 0xff
    s_add_u32 s35, s60, s48
    s_mov_b32 s45, s44
    s_add_u32 s47, s44, 256
    s_add_u32 s49, s48, 32
    s_add_u32 s60, s48, 64
    s_cmp_eq_u32 s33, 3
    s_cselect_b32 s46, s44, s47
    s_cselect_b32 s50, s60, s48
    s_cselect_b32 s51, s48, s49
    s_sub_u32 s60, s33, 2
    s_cmp_lt_u32 s60, 2
    s_cbranch_scc0 K2_rare_38
K2_back_39:
    v_add_u32 v222, s48, v251
    ds_read_b32 v222, v222
    v_fmac_f32 v241, v61, v141
    v_fmac_f32 v239, v54, v142
    v_fmac_f32 v241, v62, v142
    v_fmac_f32 v239, v55, v143
    v_fmac_f32 v241, v63, v143
    v_mfma_f32_32x32x16_bf16 v[48:63], v[68:71], v[180:183], 0
    v_permlane32_swap_b32 v234, v236
    v_permlane32_swap_b32 v235, v237
    v_permlane32_swap_b32 v240, v238
    s_waitcnt vmcnt(4) lgkmcnt(1)
    v_mfma_f32_32x32x16_bf16 v[0:15], v[72:75], v[184:187], v[0:15]
    ds_read_b64_tr_b16 v[176:177], v246 offset:0
    ds_read_b64_tr_b16 v[178:179], v246 offset:512
    ds_read_b64_tr_b16 v[180:181], v247 offset:0
    ds_read_b64_tr_b16 v[182:183], v247 offset:512
    v_permlane32_swap_b32 v241, v239
    s_mov_b32 m0, s71
    v_mfma_f32_32x32x16_bf16 v[16:31], v[76:79], v[184:187], v[16:31]
    buffer_load_dwordx4 v224, s[4:7], s43 offen sc1 lds
    buffer_load_dwordx4 v225, s[72:75], s43 offen offset:1024 sc1 lds
    s_waitcnt lgkmcnt(4)
    v_mad_u32_u16 v223, v222, s39, v248 op_sel:[1,0,0,0]
    v_mad_u32_u16 v222, v222, s39, v248
    v_lshl_add_u32 v230, v252, 1, s31
    v_add_f32 v234, v234, v236
    v_add_f32 v235, v235, v237
    v_add_f32 v240, v240, v238
    v_add_f32 v241, v241, v239
    v_cvt_pk_bf16_f32 v234, v234, v235
    v_cvt_pk_bf16_f32 v240, v240, v241
    ds_write_b32 v230, v234 offset:0
    ds_write_b32 v230, v240 offset:256
    v_mfma_f32_32x32x16_bf16 v[32:47], v[72:75], v[188:191], v[32:47]
    v_add_u32 v224, s49, v251
    ds_read_b32 v224, v224
    v_mul_f32 v234, v0, v144
    v_mul_f32 v236, v8, v112
    v_fmac_f32 v234, v1, v145
    v_fmac_f32 v236, v9, v113
    v_fmac_f32 v234, v2, v146
    v_mfma_f32_32x32x16_bf16 v[48:63], v[76:79], v[188:191], v[48:63]
    s_setprio 0
    v_fmac_f32 v236, v10, v114
    v_fmac_f32 v234, v3, v147
    v_fmac_f32 v236, v11, v115
    v_fmac_f32 v234, v4, v148
    v_fmac_f32 v236, v12, v116
    v_fmac_f32 v234, v5, v149
    v_fmac_f32 v236, v13, v117
    v_fmac_f32 v234, v6, v150
    v_fmac_f32 v236, v14, v118
    v_fmac_f32 v234, v7, v151
    v_fmac_f32 v236, v15, v119
    v_mul_f32 v238, v16, v160
    v_mul_f32 v240, v24, v160
    v_fmac_f32 v238, v17, v161
    v_fmac_f32 v240, v25, v161
    v_fmac_f32 v238, v18, v162
    v_fmac_f32 v240, v26, v162
    v_fmac_f32 v238, v19, v163
    v_fmac_f32 v240, v27, v163
    v_fmac_f32 v238, v20, v164
    v_fmac_f32 v240, v28, v164
    v_fmac_f32 v238, v21, v165
    v_fmac_f32 v240, v29, v165
    v_fmac_f32 v238, v22, v166
    v_fmac_f32 v240, v30, v166
    v_fmac_f32 v238, v23, v167
    v_fmac_f32 v240, v31, v167
    v_mul_f32 v235, v32, v152
    v_mul_f32 v237, v40, v120
    v_fmac_f32 v235, v33, v153
    v_fmac_f32 v237, v41, v121
    v_fmac_f32 v235, v34, v154
    v_fmac_f32 v237, v42, v122
    v_fmac_f32 v235, v35, v155
    v_fmac_f32 v237, v43, v123
    v_fmac_f32 v235, v36, v156
    v_fmac_f32 v237, v44, v124
    v_fmac_f32 v235, v37, v157
    v_fmac_f32 v237, v45, v125
    v_fmac_f32 v235, v38, v158
    v_fmac_f32 v237, v46, v126
    v_fmac_f32 v235, v39, v159
    v_fmac_f32 v237, v47, v127
    v_mul_f32 v239, v48, v168
    v_mul_f32 v241, v56, v168
    v_fmac_f32 v239, v49, v169
    v_fmac_f32 v241, v57, v169
    v_fmac_f32 v239, v50, v170
    v_fmac_f32 v241, v58, v170
    v_fmac_f32 v239, v51, v171
    s_setprio 1
    s_waitcnt vmcnt(4) lgkmcnt(3)
    v_mfma_f32_32x32x16_bf16 v[0:15], v[64:67], v[176:179], 0
    ds_read_b64_tr_b16 v[184:185], v246 offset:2048
    ds_read_b64_tr_b16 v[186:187], v246 offset:2560
    ds_read_b64_tr_b16 v[188:189], v247 offset:2048
    ds_read_b64_tr_b16 v[190:191], v247 offset:2560
    v_fmac_f32 v241, v59, v171
    v_fmac_f32 v239, v52, v172
    s_mov_b32 m0, s68
    v_mfma_f32_32x32x16_bf16 v[16:31], v[68:71], v[176:179], 0
    buffer_load_dwordx4 v222, s[4:7], s44 offen sc1 lds
    buffer_load_dwordx4 v223, s[72:75], s44 offen offset:1024 sc1 lds
    s_waitcnt lgkmcnt(4)
    v_mad_u32_u16 v225, v224, s39, v248 op_sel:[1,0,0,0]
    v_mad_u32_u16 v224, v224, s39, v248
    v_fmac_f32 v241, v60, v172
    v_fmac_f32 v239, v53, v173
    v_mfma_f32_32x32x16_bf16 v[32:47], v[64:67], v[180:183], 0
    v_add_u32 v226, s50, v251
    ds_read_b32 v226, v226
    v_fmac_f32 v241, v61, v173
    v_fmac_f32 v239, v54, v174
    v_fmac_f32 v241, v62, v174
    v_fmac_f32 v239, v55, v175
    v_fmac_f32 v241, v63, v175
    v_mfma_f32_32x32x16_bf16 v[48:63], v[68:71], v[180:183], 0
    s_waitcnt vmcnt(4) lgkmcnt(1)
    v_mfma_f32_32x32x16_bf16 v[0:15], v[72:75], v[184:187], v[0:15]
    ds_read_b64_tr_b16 v[176:177], v246 offset:4096
    ds_read_b64_tr_b16 v[178:179], v246 offset:4608
    ds_read_b64_tr_b16 v[180:181], v247 offset:4096
    ds_read_b64_tr_b16 v[182:183], v247 offset:4608
    s_mov_b32 m0, s69
    v_mfma_f32_32x32x16_bf16 v[16:31], v[76:79], v[184:187], v[16:31]
    buffer_load_dwordx4 v224, s[4:7], s45 offen sc1 lds
    buffer_load_dwordx4 v225, s[72:75], s45 offen offset:1024 sc1 lds
    s_waitcnt lgkmcnt(4)
    v_mad_u32_u16 v227, v226, s39, v248 op_sel:[1,0,0,0]
    v_mad_u32_u16 v226, v226, s39, v248
    v_mfma_f32_32x32x16_bf16 v[32:47], v[72:75], v[188:191], v[32:47]
    v_add_u32 v228, s51, v251
    ds_read_b32 v228, v228
    v_mul_f32 v242, v0, v144
    v_fma_f32 v238, v8, v160, -v238
    v_fmac_f32 v242, v1, v145
    v_fmac_f32 v238, v9, v161
    v_fmac_f32 v242, v2, v146
    v_mfma_f32_32x32x16_bf16 v[48:63], v[76:79], v[188:191], v[48:63]
    s_setprio 0
    v_fmac_f32 v238, v10, v162
    v_fmac_f32 v242, v3, v147
    v_fmac_f32 v238, v11, v163
    v_fmac_f32 v242, v4, v148
    v_fmac_f32 v238, v12, v164
    v_fmac_f32 v242, v5, v149
    v_fmac_f32 v238, v13, v165
    v_fmac_f32 v242, v6, v150
    v_fmac_f32 v238, v14, v166
    v_fmac_f32 v242, v7, v151
    v_fmac_f32 v238, v15, v167
    v_fmac_f32 v236, v16, v112
    v_mul_f32 v244, v24, v160
    v_fmac_f32 v236, v17, v113
    v_fmac_f32 v244, v25, v161
    v_fmac_f32 v236, v18, v114
    v_fmac_f32 v244, v26, v162
    v_fmac_f32 v236, v19, v115
    v_fmac_f32 v244, v27, v163
    v_fmac_f32 v236, v20, v116
    v_fmac_f32 v244, v28, v164
    v_fmac_f32 v236, v21, v117
    v_fmac_f32 v244, v29, v165
    v_fmac_f32 v236, v22, v118
    v_fmac_f32 v244, v30, v166
    v_fmac_f32 v236, v23, v119
    v_fmac_f32 v244, v31, v167
    v_mul_f32 v243, v32, v152
    v_fma_f32 v239, v40, v168, -v239
    v_fmac_f32 v243, v33, v153
    v_fmac_f32 v239, v41, v169
    v_fmac_f32 v243, v34, v154
    v_fmac_f32 v239, v42, v170
    v_fmac_f32 v243, v35, v155
    v_fmac_f32 v239, v43, v171
    v_fmac_f32 v243, v36, v156
    v_fmac_f32 v239, v44, v172
    v_fmac_f32 v243, v37, v157
    v_fmac_f32 v239, v45, v173
    v_fmac_f32 v243, v38, v158
    v_fmac_f32 v239, v46, v174
    v_fmac_f32 v243, v39, v159
    v_fmac_f32 v239, v47, v175
    v_fmac_f32 v237, v48, v120
    v_mul_f32 v245, v56, v168
    v_fmac_f32 v237, v49, v121
    v_fmac_f32 v245, v57, v169
    v_fmac_f32 v237, v50, v122
    s_setprio 1
    s_waitcnt vmcnt(4) lgkmcnt(1)
    v_mfma_f32_32x32x16_bf16 v[0:15], v[64:67], v[176:179], 0
    ds_read_b64_tr_b16 v[184:185], v246 offset:6144
    ds_read_b64_tr_b16 v[186:187], v246 offset:6656
    ds_read_b64_tr_b16 v[188:189], v247 offset:6144
    ds_read_b64_tr_b16 v[190:191], v247 offset:6656
    v_fmac_f32 v245, v58, v170
    v_fmac_f32 v237, v51, v123
    s_mov_b32 m0, s70
    v_mfma_f32_32x32x16_bf16 v[16:31], v[68:71], v[176:179], 0
    buffer_load_dwordx4 v226, s[4:7], s46 offen sc1 lds
    buffer_load_dwordx4 v227, s[72:75], s46 offen offset:1024 sc1 lds
    s_waitcnt lgkmcnt(4)
    v_mad_u32_u16 v229, v228, s39, v248 op_sel:[1,0,0,0]
    v_mad_u32_u16 v228, v228, s39, v248
    v_fmac_f32 v245, v59, v171
    v_fmac_f32 v237, v52, v124
    v_mfma_f32_32x32x16_bf16 v[32:47], v[64:67], v[180:183], 0
    v_fmac_f32 v245, v60, v172
    v_fmac_f32 v237, v53, v125
    v_fmac_f32 v245, v61, v173
    v_fmac_f32 v237, v54, v126
    v_fmac_f32 v245, v62, v174
    v_fmac_f32 v237, v55, v127
    v_fmac_f32 v245, v63, v175
    v_mfma_f32_32x32x16_bf16 v[48:63], v[68:71], v[180:183], 0
    v_permlane32_swap_b32 v242, v234
    v_permlane32_swap_b32 v243, v235
    v_add_f32 v242, v242, v234
    v_add_f32 v243, v243, v235
    s_waitcnt vmcnt(4) lgkmcnt(0)
    v_mfma_f32_32x32x16_bf16 v[0:15], v[72:75], v[184:187], v[0:15]
    ds_read_b64_tr_b16 v[176:177], v246 offset:0
    ds_read_b64_tr_b16 v[178:179], v246 offset:512
    ds_read_b64_tr_b16 v[180:181], v247 offset:0
    ds_read_b64_tr_b16 v[182:183], v247 offset:512
    v_cvt_pk_bf16_f32 v242, v242, v243
    ds_write_b32 v230, v242 offset:512
    s_mov_b32 m0, s71
    v_mfma_f32_32x32x16_bf16 v[16:31], v[76:79], v[184:187], v[16:31]
    buffer_load_dwordx4 v228, s[4:7], s47 offen sc1 lds
    buffer_load_dwordx4 v229, s[72:75], s47 offen offset:1024 sc1 lds
    s_sub_u32 s26, s48, s29
    s_mov_b32 s29, s48
    s_mov_b32 s30, s3
    s_cmp_lg_u32 s36, 0
    s_cselect_b32 s56, s33, 0
    v_mfma_f32_32x32x16_bf16 v[32:47], v[72:75], v[188:191], v[32:47]
    s_mov_b32 s32, s31
    s_mov_b32 s31, s35
    v_mul_f32 v242, v0, v144
    v_fma_f32 v240, v8, v160, -v240
    v_fmac_f32 v242, v1, v145
    v_fmac_f32 v240, v9, v161
    v_fmac_f32 v242, v2, v146
    v_mfma_f32_32x32x16_bf16 v[48:63], v[76:79], v[188:191], v[48:63]
    s_setprio 0
    v_fmac_f32 v240, v10, v162
    v_fmac_f32 v242, v3, v147
    v_fmac_f32 v240, v11, v163
    v_fmac_f32 v242, v4, v148
    v_fmac_f32 v240, v12, v164
    v_fmac_f32 v242, v5, v149
    v_fmac_f32 v240, v13, v165
    v_fmac_f32 v242, v6, v150
    v_fmac_f32 v240, v14, v166
    v_fmac_f32 v242, v7, v151
    v_fmac_f32 v240, v15, v167
    v_add_u32 v249, s26, v249
    v_add_u32 v250, s26, v250
    v_fma_f32 v244, v16, v160, -v244
    v_fmac_f32 v236, v24, v112
    v_fmac_f32 v244, v17, v161
    v_fmac_f32 v236, v25, v113
    v_fmac_f32 v244, v18, v162
    v_fmac_f32 v236, v26, v114
    v_fmac_f32 v244, v19, v163
    v_fmac_f32 v236, v27, v115
    v_fmac_f32 v244, v20, v164
    v_fmac_f32 v236, v28, v116
    v_fmac_f32 v244, v21, v165
    v_fmac_f32 v236, v29, v117
    v_fmac_f32 v244, v22, v166
    v_fmac_f32 v236, v30, v118
    v_fmac_f32 v244, v23, v167
    v_fmac_f32 v236, v31, v119
    ds_read_b64_tr_b16 v[0:1], v249 offset:0
    ds_read_b64_tr_b16 v[2:3], v249 offset:128
    ds_read_b128 v[4:7], v250 offset:0
    ds_read_b128 v[8:11], v250 offset:16
    ds_read_b128 v[12:15], v250 offset:384
    ds_read_b128 v[16:19], v250 offset:400
    v_mul_f32 v243, v32, v152
    v_fma_f32 v241, v40, v168, -v241
    v_fmac_f32 v243, v33, v153
    v_fmac_f32 v241, v41, v169
    v_fmac_f32 v243, v34, v154
    v_fmac_f32 v241, v42, v170
    v_fmac_f32 v243, v35, v155
    v_fmac_f32 v241, v43, v171
    v_fmac_f32 v243, v36, v156
    v_fmac_f32 v241, v44, v172
    v_fmac_f32 v243, v37, v157
    v_fmac_f32 v241, v45, v173
    v_fmac_f32 v243, v38, v158
    v_fmac_f32 v241, v46, v174
    v_fmac_f32 v243, v39, v159
    v_fmac_f32 v241, v47, v175
    ds_read_b64_tr_b16 v[20:21], v249 offset:512
    ds_read_b64_tr_b16 v[22:23], v249 offset:640
    ds_read_b128 v[24:27], v250 offset:64
    ds_read_b128 v[28:31], v250 offset:80
    ds_read_b128 v[32:35], v250 offset:448
    ds_read_b128 v[36:39], v250 offset:464
    v_fma_f32 v245, v48, v168, -v245
    v_fmac_f32 v237, v56, v120
    v_fmac_f32 v245, v49, v169
    v_fmac_f32 v237, v57, v121
    v_fmac_f32 v245, v50, v170
    v_fmac_f32 v237, v58, v122
    v_fmac_f32 v245, v51, v171
    v_fmac_f32 v237, v59, v123
    v_fmac_f32 v245, v52, v172
    v_fmac_f32 v237, v60, v124
    v_fmac_f32 v245, v53, v173
    v_fmac_f32 v237, v61, v125
    v_fmac_f32 v245, v54, v174
    v_fmac_f32 v237, v62, v126
    v_fmac_f32 v245, v55, v175
    v_fmac_f32 v237, v63, v127
    s_cmp_eq_u32 s56, 2
    s_cbranch_scc1 K2_U21
    s_cmp_eq_u32 s56, 3
    s_cbranch_scc1 K2_U31
    s_branch K2_DSP1
K2_PAD_U31:
    s_branch K2_HOP
K2_U31:
    s_setprio 1
    s_waitcnt lgkmcnt(6)
    v_lshlrev_b32 v40, 16, v0
    v_and_b32 v41, 0xffff0000, v0
    v_lshlrev_b32 v42, 16, v1
    v_and_b32 v43, 0xffff0000, v1
    v_lshlrev_b32 v44, 16, v2
    v_and_b32 v45, 0xffff0000, v2
    v_lshlrev_b32 v46, 16, v3
    v_and_b32 v47, 0xffff0000, v3
    v_mul_f32 v4, v40, v4
    v_mul_f32 v5, v41, v5
    v_mul_f32 v6, v42, v6
    v_mul_f32 v7, v43, v7
    v_mul_f32 v8, v44, v8
    v_mul_f32 v9, v45, v9
    v_mul_f32 v10, v46, v10
    v_mul_f32 v11, v47, v11
    v_cvt_pk_bf16_f32 v64, v4, v5
    v_cvt_pk_bf16_f32 v65, v6, v7
    v_cvt_pk_bf16_f32 v66, v8, v9
    v_cvt_pk_bf16_f32 v67, v10, v11
    v_mul_f32 v12, v40, v12
    v_mul_f32 v13, v41, v13
    v_mul_f32 v14, v42, v14
    v_mul_f32 v15, v43, v15
    v_mul_f32 v16, v44, v16
    v_mul_f32 v17, v45, v17
    v_mul_f32 v18, v46, v18
    v_mul_f32 v19, v47, v19
    v_cvt_pk_bf16_f32 v68, v12, v13
    v_cvt_pk_bf16_f32 v69, v14, v15
    v_cvt_pk_bf16_f32 v70, v16, v17
    v_cvt_pk_bf16_f32 v71, v18, v19
    ds_read_b64_tr_b16 v[0:1], v249 offset:1024
    ds_read_b64_tr_b16 v[2:3], v249 offset:1152
    ds_read_b128 v[4:7], v250 offset:128
    ds_read_b128 v[8:11], v250 offset:144
    ds_read_b128 v[12:15], v250 offset:512
    ds_read_b128 v[16:19], v250 offset:528
    s_waitcnt lgkmcnt(6)
    v_lshlrev_b32 v48, 16, v20
    v_and_b32 v49, 0xffff0000, v20
    v_lshlrev_b32 v50, 16, v21
    v_and_b32 v51, 0xffff0000, v21
    v_lshlrev_b32 v52, 16, v22
    v_and_b32 v53, 0xffff0000, v22
    v_lshlrev_b32 v54, 16, v23
    v_and_b32 v55, 0xffff0000, v23
    v_mul_f32 v24, v48, v24
    v_mul_f32 v25, v49, v25
    v_mul_f32 v26, v50, v26
    v_mul_f32 v27, v51, v27
    v_mul_f32 v28, v52, v28
    v_mul_f32 v29, v53, v29
    v_mul_f32 v30, v54, v30
    v_mul_f32 v31, v55, v31
    v_cvt_pk_bf16_f32 v72, v24, v25
    v_cvt_pk_bf16_f32 v73, v26, v27
    v_cvt_pk_bf16_f32 v74, v28, v29
    v_cvt_pk_bf16_f32 v75, v30, v31
    v_mul_f32 v32, v48, v32
    v_mul_f32 v33, v49, v33
    v_mul_f32 v34, v50, v34
    v_mul_f32 v35, v51, v35
    v_mul_f32 v36, v52, v36
    v_mul_f32 v37, v53, v37
    v_mul_f32 v38, v54, v38
    v_mul_f32 v39, v55, v39
    v_cvt_pk_bf16_f32 v76, v32, v33
    v_cvt_pk_bf16_f32 v77, v34, v35
    v_cvt_pk_bf16_f32 v78, v36, v37
    v_cvt_pk_bf16_f32 v79, v38, v39
    s_waitcnt lgkmcnt(4)
    v_lshlrev_b32 v40, 16, v0
    v_and_b32 v41, 0xffff0000, v0
    v_lshlrev_b32 v42, 16, v1
    v_and_b32 v43, 0xffff0000, v1
    v_lshlrev_b32 v44, 16, v2
    v_and_b32 v45, 0xffff0000, v2
    v_lshlrev_b32 v46, 16, v3
    v_and_b32 v47, 0xffff0000, v3
    s_waitcnt lgkmcnt(2)
    v_mul_f32 v4, v40, v4
    v_mul_f32 v5, v41, v5
    v_mul_f32 v6, v42, v6
    v_mul_f32 v7, v43, v7
    v_mul_f32 v8, v44, v8
    v_mul_f32 v9, v45, v9
    v_mul_f32 v10, v46, v10
    v_mul_f32 v11, v47, v11
    v_cvt_pk_bf16_f32 v80, v4, v5
    v_cvt_pk_bf16_f32 v81, v6, v7
    v_cvt_pk_bf16_f32 v82, v8, v9
    v_cvt_pk_bf16_f32 v83, v10, v11
    s_waitcnt lgkmcnt(0)
    v_mul_f32 v12, v40, v12
    v_mul_f32 v13, v41, v13
    v_mul_f32 v14, v42, v14
    v_mul_f32 v15, v43, v15
    v_mul_f32 v16, v44, v16
    v_mul_f32 v17, v45, v17
    v_mul_f32 v18, v46, v18
    v_mul_f32 v19, v47, v19
    v_cvt_pk_bf16_f32 v84, v12, v13
    v_cvt_pk_bf16_f32 v85, v14, v15
    v_cvt_pk_bf16_f32 v86, v16, v17
    v_cvt_pk_bf16_f32 v87, v18, v19
    s_waitcnt vmcnt(4)
    v_mfma_f32_32x32x16_bf16 v[0:15], v[64:67], v[176:179], 0
    ds_read_b64_tr_b16 v[184:185], v246 offset:2048
    ds_read_b64_tr_b16 v[186:187], v246 offset:2560
    ds_read_b64_tr_b16 v[188:189], v247 offset:2048
    ds_read_b64_tr_b16 v[190:191], v247 offset:2560
    s_mov_b32 m0, s68
    v_mfma_f32_32x32x16_bf16 v[16:31], v[68:71], v[176:179], 0
    buffer_load_dwordx4 v224, s[4:7], s41 offen sc1 lds
    buffer_load_dwordx4 v225, s[72:75], s41 offen offset:1024 sc1 lds
    v_permlane32_swap_b32 v242, v236
    v_permlane32_swap_b32 v243, v237
    v_mov_b32 v254, 163648
    v_mfma_f32_32x32x16_bf16 v[32:47], v[64:67], v[180:183], 0
    v_permlane32_swap_b32 v244, v238
    v_permlane32_swap_b32 v245, v239
    v_permlane32_swap_b32 v240, v241
    v_add_f32 v242, v242, v236
    v_mfma_f32_32x32x16_bf16 v[48:63], v[68:71], v[180:183], 0
    v_add_f32 v243, v243, v237
    v_add_f32 v244, v244, v238
    v_add_f32 v245, v245, v239
    v_add_f32 v240, -v240, -v241
    v_sub_u32 v241, v230, v231
    v_cvt_pk_bf16_f32 v242, v242, v243
    v_mov_b32 v255, 1
    v_lshl_add_u32 v233, v252, 1, s53
    s_mov_b64 exec, 1
    ds_add_rtn_u32 v232, v254, v255
    s_mov_b64 exec, -1
    ds_read_b32 v233, v233
    s_waitcnt vmcnt(4) lgkmcnt(2)
    v_mfma_f32_32x32x16_bf16 v[0:15], v[72:75], v[184:187], v[0:15]
    ds_read_b64_tr_b16 v[176:177], v246 offset:4096
    ds_read_b64_tr_b16 v[178:179], v246 offset:4608
    ds_read_b64_tr_b16 v[180:181], v247 offset:4096
    ds_read_b64_tr_b16 v[182:183], v247 offset:4608
    v_cvt_pk_bf16_f32 v244, v244, v245
    v_cvt_pk_bf16_f32 v240, v240, v240
    s_mov_b32 m0, s69
    v_mfma_f32_32x32x16_bf16 v[16:31], v[76:79], v[184:187], v[16:31]
    buffer_load_dwordx4 v226, s[4:7], s41 offen sc1 lds
    buffer_load_dwordx4 v227, s[72:75], s41 offen offset:1024 sc1 lds
    ds_write_b32 v230, v242 offset:768
    ds_write_b32 v230, v244 offset:1024
    ds_write_b16 v241, v240 offset:1280
    s_waitcnt lgkmcnt(7)
    v_readfirstlane_b32 s58, v232
    v_mfma_f32_32x32x16_bf16 v[32:47], v[72:75], v[188:191], v[32:47]
    s_cmp_lt_u32 s58, s22
    s_cbranch_scc0 K2_nul_41
    s_and_b32 s59, s58, 7
    s_lshr_b32 s60, s58, 3
K2_chk_43:
    v_readlane_b32 s61, v233, s59
    s_nop 0
    s_cmp_gt_u32 s61, s60
    s_cbranch_scc0 K2_spin_42
K2_back_44:
    v_mfma_f32_32x32x16_bf16 v[48:63], v[76:79], v[188:191], v[48:63]
    v_readlane_b32 s3, v253, s58
    s_lshl_b32 s44, s34, 7
    s_lshl_b32 s60, s58, 5
    s_and_b32 s48, s3, 0x3ffff
    s_bfe_u32 s33, s3, 0x30012
    s_sub_u32 s60, s60, s48
    s_waitcnt vmcnt(4) lgkmcnt(3)
    v_mfma_f32_32x32x16_bf16 v[0:15], v[80:83], v[176:179], v[0:15]
    ds_read_b64_tr_b16 v[184:185], v246 offset:6144
    ds_read_b64_tr_b16 v[186:187], v246 offset:6656
    ds_read_b64_tr_b16 v[188:189], v247 offset:6144
    ds_read_b64_tr_b16 v[190:191], v247 offset:6656
    s_and_b32 s60, s60, 0xff
    s_add_u32 s35, s60, s48
    s_mov_b32 m0, s70
    v_mfma_f32_32x32x16_bf16 v[16:31], v[84:87], v[176:179], v[16:31]
    buffer_load_dwordx4 v222, s[4:7], s42 offen sc1 lds
    buffer_load_dwordx4 v223, s[72:75], s42 offen offset:1024 sc1 lds
    s_mov_b32 s45, s44
    s_add_u32 s47, s44, 256
    s_add_u32 s49, s48, 32
    s_add_u32 s60, s48, 64
    v_mfma_f32_32x32x16_bf16 v[32:47], v[80:83], v[180:183], v[32:47]
    s_cmp_eq_u32 s33, 3
    s_cselect_b32 s46, s44, s47
    s_cselect_b32 s50, s60, s48
    s_cselect_b32 s51, s48, s49
    s_sub_u32 s60, s33, 2
    s_cmp_lt_u32 s60, 2
    s_cbranch_scc0 K2_rare_45
K2_back_46:
    v_mfma_f32_32x32x16_bf16 v[48:63], v[84:87], v[180:183], v[48:63]
    s_setprio 0
    v_mul_f32 v234, v0, v96
    v_mul_f32 v236, v8, v128
    v_fmac_f32 v234, v1, v97
    v_fmac_f32 v236, v9, v129
    v_fmac_f32 v234, v2, v98
    v_fmac_f32 v236, v10, v130
    v_fmac_f32 v234, v3, v99
    v_fmac_f32 v236, v11, v131
    v_fmac_f32 v234, v4, v100
    v_fmac_f32 v236, v12, v132
    v_fmac_f32 v234, v5, v101
    v_fmac_f32 v236, v13, v133
    v_fmac_f32 v234, v6, v102
    v_fmac_f32 v236, v14, v134
    v_fmac_f32 v234, v7, v103
    v_fmac_f32 v236, v15, v135
    v_mul_f32 v238, v16, v128
    v_mul_f32 v240, v24, v128
    v_fmac_f32 v238, v17, v129
    v_fmac_f32 v240, v25, v129
    v_fmac_f32 v238, v18, v130
    v_fmac_f32 v240, v26, v130
    v_fmac_f32 v238, v19, v131
    v_fmac_f32 v240, v27, v131
    v_fmac_f32 v238, v20, v132
    v_fmac_f32 v240, v28, v132
    v_fmac_f32 v238, v21, v133
    v_fmac_f32 v240, v29, v133
    v_fmac_f32 v238, v22, v134
    v_fmac_f32 v240, v30, v134
    v_fmac_f32 v238, v23, v135
    v_fmac_f32 v240, v31, v135
    v_mul_f32 v235, v32, v104
    v_mul_f32 v237, v40, v136
    v_fmac_f32 v235, v33, v105
    v_fmac_f32 v237, v41, v137
    v_fmac_f32 v235, v34, v106
    v_fmac_f32 v237, v42, v138
    v_fmac_f32 v235, v35, v107
    v_fmac_f32 v237, v43, v139
    v_fmac_f32 v235, v36, v108
    v_fmac_f32 v237, v44, v140
    v_fmac_f32 v235, v37, v109
    v_fmac_f32 v237, v45, v141
    v_fmac_f32 v235, v38, v110
    v_fmac_f32 v237, v46, v142
    v_fmac_f32 v235, v39, v111
    v_fmac_f32 v237, v47, v143
    v_mul_f32 v239, v48, v136
    v_mul_f32 v241, v56, v136
    s_setprio 1
    s_waitcnt vmcnt(4) lgkmcnt(0)
    v_mfma_f32_32x32x16_bf16 v[0:15], v[64:67], v[184:187], 0
    ds_read_b64_tr_b16 v[176:177], v246 offset:0
    ds_read_b64_tr_b16 v[178:179], v246 offset:512
    ds_read_b64_tr_b16 v[180:181], v247 offset:0
    ds_read_b64_tr_b16 v[182:183], v247 offset:512
    v_fmac_f32 v239, v49, v137
    v_fmac_f32 v241, v57, v137
    s_mov_b32 m0, s71
    v_mfma_f32_32x32x16_bf16 v[16:31], v[68:71], v[184:187], 0
    buffer_load_dwordx4 v224, s[4:7], s42 offen sc1 lds
    buffer_load_dwordx4 v225, s[72:75], s42 offen offset:1024 sc1 lds
    v_fmac_f32 v239, v50, v138
    v_fmac_f32 v241, v58, v138
    v_fmac_f32 v239, v51, v139
    v_fmac_f32 v241, v59, v139
    v_fmac_f32 v239, v52, v140
    v_mfma_f32_32x32x16_bf16 v[32:47], v[64:67], v[188:191], 0
    v_fmac_f32 v241, v60, v140
    v_fmac_f32 v239, v53, v141
    v_fmac_f32 v241, v61, v141
    v_fmac_f32 v239, v54, v142
    v_fmac_f32 v241, v62, v142
    v_fmac_f32 v239, v55, v143
    v_fmac_f32 v241, v63, v143
    v_mfma_f32_32x32x16_bf16 v[48:63], v[68:71], v[188:191], 0
    v_permlane32_swap_b32 v234, v236
    v_permlane32_swap_b32 v235, v237
    v_permlane32_swap_b32 v240, v238
    s_waitcnt vmcnt(4) lgkmcnt(0)
    v_mfma_f32_32x32x16_bf16 v[0:15], v[72:75], v[176:179], v[0:15]
    ds_read_b64_tr_b16 v[184:185], v246 offset:2048
    ds_read_b64_tr_b16 v[186:187], v246 offset:2560
    ds_read_b64_tr_b16 v[188:189], v247 offset:2048
    ds_read_b64_tr_b16 v[190:191], v247 offset:2560
    v_permlane32_swap_b32 v241, v239
    s_mov_b32 m0, s68
    v_mfma_f32_32x32x16_bf16 v[16:31], v[76:79], v[176:179], v[16:31]
    buffer_load_dwordx4 v226, s[4:7], s42 offen sc1 lds
    buffer_load_dwordx4 v227, s[72:75], s42 offen offset:1024 sc1 lds
    v_lshl_add_u32 v230, v252, 1, s31
    v_add_f32 v234, v234, v236
    v_add_f32 v235, v235, v237
    v_add_f32 v240, v240, v238
    v_add_f32 v241, v241, v239
    v_mfma_f32_32x32x16_bf16 v[32:47], v[72:75], v[180:183], v[32:47]
    v_cvt_pk_bf16_f32 v234, v234, v235
    v_cvt_pk_bf16_f32 v240, v240, v241
    ds_write_b32 v230, v234 offset:0
    ds_write_b32 v230, v240 offset:256
    v_mfma_f32_32x32x16_bf16 v[48:63], v[76:79], v[180:183], v[48:63]
    s_waitcnt vmcnt(4) lgkmcnt(2)
    v_mfma_f32_32x32x16_bf16 v[0:15], v[80:83], v[184:187], v[0:15]
    ds_read_b64_tr_b16 v[176:177], v246 offset:4096
    ds_read_b64_tr_b16 v[178:179], v246 offset:4608
    ds_read_b64_tr_b16 v[180:181], v247 offset:4096
    ds_read_b64_tr_b16 v[182:183], v247 offset:4608
    s_mov_b32 m0, s69
    v_mfma_f32_32x32x16_bf16 v[16:31], v[84:87], v[184:187], v[16:31]
    buffer_load_dwordx4 v222, s[4:7], s43 offen sc1 lds
    buffer_load_dwordx4 v223, s[72:75], s43 offen offset:1024 sc1 lds
    v_mfma_f32_32x32x16_bf16 v[32:47], v[80:83], v[188:191], v[32:47]
    s_nop 2
    v_mul_f32 v234, v0, v144
    v_mul_f32 v236, v8, v112
    v_fmac_f32 v234, v1, v145
    v_fmac_f32 v236, v9, v113
    v_fmac_f32 v234, v2, v146
    v_fmac_f32 v236, v10, v114
    v_fmac_f32 v234, v3, v147
    v_mfma_f32_32x32x16_bf16 v[48:63], v[84:87], v[188:191], v[48:63]
    s_setprio 0
    v_fmac_f32 v236, v11, v115
    v_fmac_f32 v234, v4, v148
    v_fmac_f32 v236, v12, v116
    v_fmac_f32 v234, v5, v149
    v_fmac_f32 v236, v13, v117
    v_fmac_f32 v234, v6, v150
    v_fmac_f32 v236, v14, v118
    v_fmac_f32 v234, v7, v151
    v_fmac_f32 v236, v15, v119
    v_mul_f32 v238, v16, v160
    v_mul_f32 v240, v24, v160
    v_fmac_f32 v238, v17, v161
    v_fmac_f32 v240, v25, v161
    v_fmac_f32 v238, v18, v162
    v_fmac_f32 v240, v26, v162
    v_fmac_f32 v238, v19, v163
    v_fmac_f32 v240, v27, v163
    v_fmac_f32 v238, v20, v164
    v_fmac_f32 v240, v28, v164
    v_fmac_f32 v238, v21, v165
    v_fmac_f32 v240, v29, v165
    v_fmac_f32 v238, v22, v166
    v_fmac_f32 v240, v30, v166
    v_fmac_f32 v238, v23, v167
    v_fmac_f32 v240, v31, v167
    v_mul_f32 v235, v32, v152
    v_mul_f32 v237, v40, v120
    v_fmac_f32 v235, v33, v153
    v_fmac_f32 v237, v41, v121
    v_fmac_f32 v235, v34, v154
    v_fmac_f32 v237, v42, v122
    v_fmac_f32 v235, v35, v155
    v_fmac_f32 v237, v43, v123
    v_fmac_f32 v235, v36, v156
    v_fmac_f32 v237, v44, v124
    v_fmac_f32 v235, v37, v157
    v_fmac_f32 v237, v45, v125
    v_fmac_f32 v235, v38, v158
    v_fmac_f32 v237, v46, v126
    v_fmac_f32 v235, v39, v159
    v_fmac_f32 v237, v47, v127
    v_mul_f32 v239, v48, v168
    v_mul_f32 v241, v56, v168
    v_fmac_f32 v239, v49, v169
    v_fmac_f32 v241, v57, v169
    s_setprio 1
    s_waitcnt vmcnt(4) lgkmcnt(0)
    v_mfma_f32_32x32x16_bf16 v[0:15], v[64:67], v[176:179], 0
    ds_read_b64_tr_b16 v[184:185], v246 offset:6144
    ds_read_b64_tr_b16 v[186:187], v246 offset:6656
    ds_read_b64_tr_b16 v[188:189], v247 offset:6144
    ds_read_b64_tr_b16 v[190:191], v247 offset:6656
    v_fmac_f32 v239, v50, v170
    v_fmac_f32 v241, v58, v170
    s_mov_b32 m0, s70
    v_mfma_f32_32x32x16_bf16 v[16:31], v[68:71], v[176:179], 0
    buffer_load_dwordx4 v224, s[4:7], s43 offen sc1 lds
    buffer_load_dwordx4 v225, s[72:75], s43 offen offset:1024 sc1 lds
    v_fmac_f32 v239, v51, v171
    v_fmac_f32 v241, v59, v171
    v_fmac_f32 v239, v52, v172
    v_fmac_f32 v241, v60, v172
    v_fmac_f32 v239, v53, v173
    v_mfma_f32_32x32x16_bf16 v[32:47], v[64:67], v[180:183], 0
    v_add_u32 v222, s48, v251
    ds_read_b32 v222, v222
    v_fmac_f32 v241, v61, v173
    v_fmac_f32 v239, v54, v174
    v_fmac_f32 v241, v62, v174
    v_fmac_f32 v239, v55, v175
    v_fmac_f32 v241, v63, v175
    v_mfma_f32_32x32x16_bf16 v[48:63], v[68:71], v[180:183], 0
    s_waitcnt vmcnt(4) lgkmcnt(1)
    v_mfma_f32_32x32x16_bf16 v[0:15], v[72:75], v[184:187], v[0:15]
    ds_read_b64_tr_b16 v[176:177], v246 offset:0
    ds_read_b64_tr_b16 v[178:179], v246 offset:512
    ds_read_b64_tr_b16 v[180:181], v247 offset:0
    ds_read_b64_tr_b16 v[182:183], v247 offset:512
    s_mov_b32 m0, s71
    v_mfma_f32_32x32x16_bf16 v[16:31], v[76:79], v[184:187], v[16:31]
    buffer_load_dwordx4 v226, s[4:7], s43 offen sc1 lds
    buffer_load_dwordx4 v227, s[72:75], s43 offen offset:1024 sc1 lds
    s_waitcnt lgkmcnt(4)
    v_mad_u32_u16 v223, v222, s39, v248 op_sel:[1,0,0,0]
    v_mad_u32_u16 v222, v222, s39, v248
    v_mfma_f32_32x32x16_bf16 v[32:47], v[72:75], v[188:191], v[32:47]
    v_add_u32 v224, s49, v251
    ds_read_b32 v224, v224
    v_mfma_f32_32x32x16_bf16 v[48:63], v[76:79], v[188:191], v[48:63]
    s_waitcnt vmcnt(4) lgkmcnt(1)
    v_mfma_f32_32x32x16_bf16 v[0:15], v[80:83], v[176:179], v[0:15]
    ds_read_b64_tr_b16 v[184:185], v246 offset:2048
    ds_read_b64_tr_b16 v[186:187], v246 offset:2560
    ds_read_b64_tr_b16 v[188:189], v247 offset:2048
    ds_read_b64_tr_b16 v[190:191], v247 offset:2560
    s_mov_b32 m0, s68
    v_mfma_f32_32x32x16_bf16 v[16:31], v[84:87], v[176:179], v[16:31]
    buffer_load_dwordx4 v222, s[4:7], s44 offen sc1 lds
    buffer_load_dwordx4 v223, s[72:75], s44 offen offset:1024 sc1 lds
    s_waitcnt lgkmcnt(4)
    v_mad_u32_u16 v225, v224, s39, v248 op_sel:[1,0,0,0]
    v_mad_u32_u16 v224, v224, s39, v248
    v_mfma_f32_32x32x16_bf16 v[32:47], v[80:83], v[180:183], v[32:47]
    v_add_u32 v226, s50, v251
    ds_read_b32 v226, v226
    v_mul_f32 v242, v0, v144
    v_fma_f32 v238, v8, v160, -v238
    v_fmac_f32 v242, v1, v145
    v_fmac_f32 v238, v9, v161
    v_fmac_f32 v242, v2, v146
    v_mfma_f32_32x32x16_bf16 v[48:63], v[84:87], v[180:183], v[48:63]
    s_setprio 0
    v_fmac_f32 v238, v10, v162
    v_fmac_f32 v242, v3, v147
    v_fmac_f32 v238, v11, v163
    v_fmac_f32 v242, v4, v148
    v_fmac_f32 v238, v12, v164
    v_fmac_f32 v242, v5, v149
    v_fmac_f32 v238, v13, v165
    v_fmac_f32 v242, v6, v150
    v_fmac_f32 v238, v14, v166
    v_fmac_f32 v242, v7, v151
    v_fmac_f32 v238, v15, v167
    v_fmac_f32 v236, v16, v112
    v_mul_f32 v244, v24, v160
    v_fmac_f32 v236, v17, v113
    v_fmac_f32 v244, v25, v161
    v_fmac_f32 v236, v18, v114
    v_fmac_f32 v244, v26, v162
    v_fmac_f32 v236, v19, v115
    v_fmac_f32 v244, v27, v163
    v_fmac_f32 v236, v20, v116
    v_fmac_f32 v244, v28, v164
    v_fmac_f32 v236, v21, v117
    v_fmac_f32 v244, v29, v165
    v_fmac_f32 v236, v22, v118
    v_fmac_f32 v244, v30, v166
    v_fmac_f32 v236, v23, v119
    v_fmac_f32 v244, v31, v167
    v_mul_f32 v243, v32, v152
    v_fma_f32 v239, v40, v168, -v239
    v_fmac_f32 v243, v33, v153
    v_fmac_f32 v239, v41, v169
    v_fmac_f32 v243, v34, v154
    v_fmac_f32 v239, v42, v170
    v_fmac_f32 v243, v35, v155
    v_fmac_f32 v239, v43, v171
    v_fmac_f32 v243, v36, v156
    v_fmac_f32 v239, v44, v172
    v_fmac_f32 v243, v37, v157
    v_fmac_f32 v239, v45, v173
    v_fmac_f32 v243, v38, v158
    v_fmac_f32 v239, v46, v174
    v_fmac_f32 v243, v39, v159
    v_fmac_f32 v239, v47, v175
    v_fmac_f32 v237, v48, v120
    v_mul_f32 v245, v56, v168
    v_fmac_f32 v237, v49, v121
    v_fmac_f32 v245, v57, v169
    v_fmac_f32 v237, v50, v122
    v_fmac_f32 v245, v58, v170
    v_fmac_f32 v237, v51, v123
    s_setprio 1
    s_waitcnt vmcnt(4) lgkmcnt(1)
    v_mfma_f32_32x32x16_bf16 v[0:15], v[64:67], v[184:187], 0
    ds_read_b64_tr_b16 v[176:177], v246 offset:4096
    ds_read_b64_tr_b16 v[178:179], v246 offset:4608
    ds_read_b64_tr_b16 v[180:181], v247 offset:4096
    ds_read_b64_tr_b16 v[182:183], v247 offset:4608
    v_fmac_f32 v245, v59, v171
    v_fmac_f32 v237, v52, v124
    s_mov_b32 m0, s69
    v_mfma_f32_32x32x16_bf16 v[16:31], v[68:71], v[184:187], 0
    buffer_load_dwordx4 v224, s[4:7], s45 offen sc1 lds
    buffer_load_dwordx4 v225, s[72:75], s45 offen offset:1024 sc1 lds
    s_waitcnt lgkmcnt(4)
    v_mad_u32_u16 v227, v226, s39, v248 op_sel:[1,0,0,0]
    v_mad_u32_u16 v226, v226, s39, v248
    v_fmac_f32 v245, v60, v172
    v_fmac_f32 v237, v53, v125
    v_mfma_f32_32x32x16_bf16 v[32:47], v[64:67], v[188:191], 0
    v_add_u32 v228, s51, v251
    ds_read_b32 v228, v228
    v_fmac_f32 v245, v61, v173
    v_fmac_f32 v237, v54, v126
    v_fmac_f32 v245, v62, v174
    v_fmac_f32 v237, v55, v127
    v_fmac_f32 v245, v63, v175
    v_mfma_f32_32x32x16_bf16 v[48:63], v[68:71], v[188:191], 0
    v_permlane32_swap_b32 v242, v234
    v_permlane32_swap_b32 v243, v235
    v_add_f32 v242, v242, v234
    v_add_f32 v243, v243, v235
    s_waitcnt vmcnt(4) lgkmcnt(1)
    v_mfma_f32_32x32x16_bf16 v[0:15], v[72:75], v[176:179], v[0:15]
    ds_read_b64_tr_b16 v[184:185], v246 offset:6144
    ds_read_b64_tr_b16 v[186:187], v246 offset:6656
    ds_read_b64_tr_b16 v[188:189], v247 offset:6144
    ds_read_b64_tr_b16 v[190:191], v247 offset:6656
    v_cvt_pk_bf16_f32 v242, v242, v243
    ds_write_b32 v230, v242 offset:512
    s_mov_b32 m0, s70
    v_mfma_f32_32x32x16_bf16 v[16:31], v[76:79], v[176:179], v[16:31]
    buffer_load_dwordx4 v226, s[4:7], s46 offen sc1 lds
    buffer_load_dwordx4 v227, s[72:75], s46 offen offset:1024 sc1 lds
    s_waitcnt lgkmcnt(5)
    v_mad_u32_u16 v229, v228, s39, v248 op_sel:[1,0,0,0]
    v_mad_u32_u16 v228, v228, s39, v248
    s_sub_u32 s26, s48, s29
    s_mov_b32 s29, s48
    v_mfma_f32_32x32x16_bf16 v[32:47], v[72:75], v[180:183], v[32:47]
    s_mov_b32 s30, s3
    s_cmp_lg_u32 s36, 0
    s_cselect_b32 s56, s33, 0
    s_mov_b32 s32, s31
    s_mov_b32 s31, s35
    v_mfma_f32_32x32x16_bf16 v[48:63], v[76:79], v[180:183], v[48:63]
    s_waitcnt vmcnt(4) lgkmcnt(1)
    v_mfma_f32_32x32x16_bf16 v[0:15], v[80:83], v[184:187], v[0:15]
    ds_read_b64_tr_b16 v[176:177], v246 offset:0
    ds_read_b64_tr_b16 v[178:179], v246 offset:512
    ds_read_b64_tr_b16 v[180:181], v247 offset:0
    ds_read_b64_tr_b16 v[182:183], v247 offset:512
    s_mov_b32 m0, s71
    v_mfma_f32_32x32x16_bf16 v[16:31], v[84:87], v[184:187], v[16:31]
    buffer_load_dwordx4 v228, s[4:7], s47 offen sc1 lds
    buffer_load_dwordx4 v229, s[72:75], s47 offen offset:1024 sc1 lds
    v_mfma_f32_32x32x16_bf16 v[32:47], v[80:83], v[188:191], v[32:47]
    s_nop 2
    v_mul_f32 v242, v0, v144
    v_fma_f32 v240, v8, v160, -v240
    v_fmac_f32 v242, v1, v145
    v_fmac_f32 v240, v9, v161
    v_fmac_f32 v242, v2, v146
    v_fmac_f32 v240, v10, v162
    v_fmac_f32 v242, v3, v147
    v_mfma_f32_32x32x16_bf16 v[48:63], v[84:87], v[188:191], v[48:63]
    s_setprio 0
    v_fmac_f32 v240, v11, v163
    v_fmac_f32 v242, v4, v148
    v_fmac_f32 v240, v12, v164
    v_fmac_f32 v242, v5, v149
    v_fmac_f32 v240, v13, v165
    v_fmac_f32 v242, v6, v150
    v_fmac_f32 v240, v14, v166
    v_fmac_f32 v242, v7, v151
    v_fmac_f32 v240, v15, v167
    v_add_u32 v249, s26, v249
    v_add_u32 v250, s26, v250
    v_fma_f32 v244, v16, v160, -v244
    v_fmac_f32 v236, v24, v112
    v_fmac_f32 v244, v17, v161
    v_fmac_f32 v236, v25, v113
    v_fmac_f32 v244, v18, v162
    v_fmac_f32 v236, v26, v114
    v_fmac_f32 v244, v19, v163
    v_fmac_f32 v236, v27, v115
    v_fmac_f32 v244, v20, v164
    v_fmac_f32 v236, v28, v116
    v_fmac_f32 v244, v21, v165
    v_fmac_f32 v236, v29, v117
    v_fmac_f32 v244, v22, v166
    v_fmac_f32 v236, v30, v118
    v_fmac_f32 v244, v23, v167
    v_fmac_f32 v236, v31, v119
    ds_read_b64_tr_b16 v[0:1], v249 offset:0
    ds_read_b64_tr_b16 v[2:3], v249 offset:128
    ds_read_b128 v[4:7], v250 offset:0
    ds_read_b128 v[8:11], v250 offset:16
    ds_read_b128 v[12:15], v250 offset:384
    ds_read_b128 v[16:19], v250 offset:400
    v_mul_f32 v243, v32, v152
    v_fma_f32 v241, v40, v168, -v241
    v_fmac_f32 v243, v33, v153
    v_fmac_f32 v241, v41, v169
    v_fmac_f32 v243, v34, v154
    v_fmac_f32 v241, v42, v170
    v_fmac_f32 v243, v35, v155
    v_fmac_f32 v241, v43, v171
    v_fmac_f32 v243, v36, v156
    v_fmac_f32 v241, v44, v172
    v_fmac_f32 v243, v37, v157
    v_fmac_f32 v241, v45, v173
    v_fmac_f32 v243, v38, v158
    v_fmac_f32 v241, v46, v174
    v_fmac_f32 v243, v39, v159
    v_fmac_f32 v241, v47, v175
    ds_read_b64_tr_b16 v[20:21], v249 offset:512
    ds_read_b64_tr_b16 v[22:23], v249 offset:640
    ds_read_b128 v[24:27], v250 offset:64
    ds_read_b128 v[28:31], v250 offset:80
    ds_read_b128 v[32:35], v250 offset:448
    ds_read_b128 v[36:39], v250 offset:464
    v_fma_f32 v245, v48, v168, -v245
    v_fmac_f32 v237, v56, v120
    v_fmac_f32 v245, v49, v169
    v_fmac_f32 v237, v57, v121
    v_fmac_f32 v245, v50, v170
    v_fmac_f32 v237, v58, v122
    v_fmac_f32 v245, v51, v171
    v_fmac_f32 v237, v59, v123
    v_fmac_f32 v245, v52, v172
    v_fmac_f32 v237, v60, v124
    v_fmac_f32 v245, v53, v173
    v_fmac_f32 v237, v61, v125
    v_fmac_f32 v245, v54, v174
    v_fmac_f32 v237, v62, v126
    v_fmac_f32 v245, v55, v175
    v_fmac_f32 v237, v63, v127
    s_cmp_eq_u32 s56, 2
    s_cbranch_scc1 K2_U21
    s_cmp_eq_u32 s56, 3
    s_cbranch_scc1 K2_U31
    s_branch K2_DSP1
K2_PAD_SW:
    s_branch K2_HOP
K2_DSP0:
    s_cmp_eq_u32 s56, 1
    s_cbranch_scc1 K2_U10
    s_cmp_eq_u32 s56, 4
    s_cbranch_scc1 K2_U40
    s_branch K2_SWITCH
K2_DSP1:
    s_cmp_eq_u32 s56, 1
    s_cbranch_scc1 K2_U11
    s_cmp_eq_u32 s56, 4
    s_cbranch_scc1 K2_U41
    s_branch K2_TAIL
K2_SWITCH:
    v_permlane32_swap_b32 v242, v236
    v_permlane32_swap_b32 v243, v237
    v_permlane32_swap_b32 v244, v238
    v_permlane32_swap_b32 v245, v239
    v_permlane32_swap_b32 v240, v241
    v_add_f32 v242, v242, v236
    v_add_f32 v243, v243, v237
    v_add_f32 v244, v244, v238
    v_add_f32 v245, v245, v239
    v_add_f32 v240, -v240, -v241
    s_set_gpr_idx_on s32, gpr_idx(DST)
    s_nop 0
    v_cvt_pk_bf16_f32 v195, v242, v243
    v_cvt_pk_bf16_f32 v196, v244, v245
    v_cvt_pk_bf16_f32 v197, v240, v240
    s_set_gpr_idx_off
    s_cmp_eq_u32 s36, 0
    s_cbranch_scc1 K2_TAIL2
    v_lshlrev_b32 v254, 3, v252
    v_lshl_add_u32 v230, v252, 1, s35
    v_lshrrev_b32 v231, 6, v252
    v_mul_u32_u24 v231, 126, v231
    s_mov_b32 s58, 7131136
    buffer_load_dwordx4 v[96:99], v254, s[8:11], s58 offen offset:0 sc1
    buffer_load_dwordx4 v[100:103], v254, s[8:11], s58 offen offset:1024 sc1
    buffer_load_dwordx4 v[104:107], v254, s[8:11], s58 offen offset:2048 sc1
    buffer_load_dwordx4 v[108:111], v254, s[8:11], s58 offen offset:3072 sc1
    s_mov_b32 s58, 7135232
    buffer_load_dwordx4 v[112:115], v254, s[8:11], s58 offen offset:0 sc1
    buffer_load_dwordx4 v[116:119], v254, s[8:11], s58 offen offset:1024 sc1
    buffer_load_dwordx4 v[120:123], v254, s[8:11], s58 offen offset:2048 sc1
    buffer_load_dwordx4 v[124:127], v254, s[8:11], s58 offen offset:3072 sc1
    s_mov_b32 s58, 7139328
    buffer_load_dwordx4 v[128:131], v254, s[8:11], s58 offen offset:0 sc1
    buffer_load_dwordx4 v[132:135], v254, s[8:11], s58 offen offset:1024 sc1
    buffer_load_dwordx4 v[136:139], v254, s[8:11], s58 offen offset:2048 sc1
    buffer_load_dwordx4 v[140:143], v254, s[8:11], s58 offen offset:3072 sc1
    s_mov_b32 s58, 7143424
    buffer_load_dwordx4 v[144:147], v254, s[8:11], s58 offen offset:0 sc1
    buffer_load_dwordx4 v[148:151], v254, s[8:11], s58 offen offset:1024 sc1
    buffer_load_dwordx4 v[152:155], v254, s[8:11], s58 offen offset:2048 sc1
    buffer_load_dwordx4 v[156:159], v254, s[8:11], s58 offen offset:3072 sc1
    s_mov_b32 s58, 7147520
    buffer_load_dwordx4 v[160:163], v254, s[8:11], s58 offen offset:0 sc1
    buffer_load_dwordx4 v[164:167], v254, s[8:11], s58 offen offset:1024 sc1
    buffer_load_dwordx4 v[168:171], v254, s[8:11], s58 offen offset:2048 sc1
    buffer_load_dwordx4 v[172:175], v254, s[8:11], s58 offen offset:3072 sc1
    s_movk_i32 s40, 128
    s_movk_i32 s41, 384
    s_movk_i32 s42, 640
    s_movk_i32 s43, 896
    s_cmp_lg_u32 s33, 1
    s_cbranch_scc1 K2_SW2
    s_waitcnt vmcnt(0)
K2_SW2:
    s_mov_b32 s29, s48
    s_mov_b32 s32, s31
    s_mov_b32 s30, s3
    s_mov_b32 s31, s35
    s_cmp_eq_u32 s33, 2
    s_cbranch_scc1 K2_U21
    s_cmp_eq_u32 s33, 3
    s_cbranch_scc1 K2_U31
    s_cmp_eq_u32 s33, 1
    s_cbranch_scc1 K2_U11
    s_branch K2_U41
K2_dum_4:
    v_mov_b32 v232, -1
    s_mov_b32 m0, 163712
    s_mov_b64 exec, 1
    buffer_load_dwordx4 v232, s[16:19], 0 offen lds
    buffer_load_dwordx4 v232, s[16:19], 0 offen lds
    s_mov_b64 exec, -1
    s_branch K2_back_6
K2_nul_10:
    s_mov_b32 s58, 63
    s_mov_b32 s36, 0
    s_branch K2_back_13
K2_spin_11:
    s_sub_u32 s27, s27, 1
    s_cbranch_scc1 K2_END
    v_lshl_add_u32 v233, v252, 1, s53
    ds_read_b32 v233, v233
    s_waitcnt lgkmcnt(0)
    s_branch K2_chk_12
K2_dyn_8:
    v_mov_b32 v254, 163648
    v_mov_b32 v255, 1
    v_lshl_add_u32 v233, v252, 1, s53
    s_mov_b64 exec, 1
    ds_add_rtn_u32 v232, v254, v255
    s_mov_b64 exec, -1
    ds_read_b32 v233, v233
    s_waitcnt lgkmcnt(0)
    v_readfirstlane_b32 s58, v232
    s_nop 0
    s_cmp_lt_u32 s58, s22
    s_cbranch_scc0 K2_nul_10
    s_and_b32 s59, s58, 7
    s_lshr_b32 s60, s58, 3
K2_chk_12:
    v_readlane_b32 s61, v233, s59
    s_nop 0
    s_cmp_gt_u32 s61, s60
    s_cbranch_scc0 K2_spin_11
K2_back_13:
    s_mov_b32 s34, 1
    s_branch K2_back_9
K2_dum_17:
    v_mov_b32 v232, -1
    s_mov_b32 m0, 163712
    s_mov_b64 exec, 1
    buffer_load_dwordx4 v232, s[16:19], 0 offen lds
    buffer_load_dwordx4 v232, s[16:19], 0 offen lds
    s_mov_b64 exec, -1
    s_branch K2_back_19
K2_nul_23:
    s_mov_b32 s58, 63
    s_mov_b32 s36, 0
    s_branch K2_back_26
K2_spin_24:
    s_sub_u32 s27, s27, 1
    s_cbranch_scc1 K2_END
    v_lshl_add_u32 v233, v252, 1, s53
    ds_read_b32 v233, v233
    s_waitcnt lgkmcnt(0)
    s_branch K2_chk_25
K2_dyn_21:
    v_mov_b32 v254, 163648
    v_mov_b32 v255, 1
    v_lshl_add_u32 v233, v252, 1, s53
    s_mov_b64 exec, 1
    ds_add_rtn_u32 v232, v254, v255
    s_mov_b64 exec, -1
    ds_read_b32 v233, v233
    s_waitcnt lgkmcnt(0)
    v_readfirstlane_b32 s58, v232
    s_nop 0
    s_cmp_lt_u32 s58, s22
    s_cbranch_scc0 K2_nul_23
    s_and_b32 s59, s58, 7
    s_lshr_b32 s60, s58, 3
K2_chk_25:
    v_readlane_b32 s61, v233, s59
    s_nop 0
    s_cmp_gt_u32 s61, s60
    s_cbranch_scc0 K2_spin_24
K2_back_26:
    s_mov_b32 s34, 1
    s_branch K2_back_22
K2_dum_30:
    v_mov_b32 v232, -1
    s_mov_b32 m0, 163712
    s_mov_b64 exec, 1
    buffer_load_dwordx4 v232, s[16:19], 0 offen lds
    buffer_load_dwordx4 v232, s[16:19], 0 offen lds
    s_mov_b64 exec, -1
    s_branch K2_back_32
K2_nul_34:
    s_mov_b32 s58, 63
    s_mov_b32 s36, 0
    s_branch K2_back_37
K2_spin_35:
    s_sub_u32 s27, s27, 1
    s_cbranch_scc1 K2_END
    v_lshl_add_u32 v233, v252, 1, s53
    ds_read_b32 v233, v233
    s_waitcnt lgkmcnt(0)
    s_branch K2_chk_36
K2_nul_41:
    s_mov_b32 s58, 63
    s_mov_b32 s36, 0
    s_branch K2_back_44
K2_spin_42:
    s_sub_u32 s27, s27, 1
    s_cbranch_scc1 K2_END
    v_lshl_add_u32 v233, v252, 1, s53
    ds_read_b32 v233, v233
    s_waitcnt lgkmcnt(0)
    s_branch K2_chk_43
K2_PAD_TL:
    s_branch K2_HOP
K2_TAIL2:
    v_lshlrev_b32 v229, 3, v252
    s_mul_i32 s58, s20, 20480
    s_add_u32 s58, s58, 6946816
    s_mul_i32 s59, s20, 8224
    buffer_load_dwordx4 v[96:99], v229, s[8:11], s58 offen offset:0 sc1
    buffer_load_dwordx4 v[100:103], v229, s[8:11], s58 offen offset:1024 sc1
    buffer_load_dwordx4 v[104:107], v229, s[8:11], s58 offen offset:2048 sc1
    buffer_load_dwordx4 v[108:111], v229, s[8:11], s58 offen offset:3072 sc1
    s_add_u32 s58, s58, 4096
    buffer_load_dwordx4 v[112:115], v229, s[8:11], s58 offen offset:0 sc1
    buffer_load_dwordx4 v[116:119], v229, s[8:11], s58 offen offset:1024 sc1
    buffer_load_dwordx4 v[120:123], v229, s[8:11], s58 offen offset:2048 sc1
    buffer_load_dwordx4 v[124:127], v229, s[8:11], s58 offen offset:3072 sc1
    s_add_u32 s58, s58, 4096
    v_lshl_add_u32 v228, v252, 1, s59
    v_lshrrev_b32 v226, 6, v252
    v_mul_u32_u24 v226, 126, v226
    v_sub_u32 v226, v228, v226
    s_branch K2_TAIL3
K2_TAIL:
    v_lshlrev_b32 v229, 3, v252
    s_mul_i32 s58, s20, 20480
    s_add_u32 s58, s58, 6946816
    s_mul_i32 s59, s20, 8224
    buffer_load_dwordx4 v[96:99], v229, s[8:11], s58 offen offset:0 sc1
    v_permlane32_swap_b32 v242, v236
    v_permlane32_swap_b32 v243, v237
    buffer_load_dwordx4 v[100:103], v229, s[8:11], s58 offen offset:1024 sc1
    v_permlane32_swap_b32 v244, v238
    v_permlane32_swap_b32 v245, v239
    buffer_load_dwordx4 v[104:107], v229, s[8:11], s58 offen offset:2048 sc1
    v_permlane32_swap_b32 v240, v241
    v_add_f32 v242, v242, v236
    buffer_load_dwordx4 v[108:111], v229, s[8:11], s58 offen offset:3072 sc1
    s_add_u32 s58, s58, 4096
    v_add_f32 v243, v243, v237
    v_add_f32 v244, v244, v238
    buffer_load_dwordx4 v[112:115], v229, s[8:11], s58 offen offset:0 sc1
    v_add_f32 v245, v245, v239
    v_add_f32 v240, -v240, -v241
    buffer_load_dwordx4 v[116:119], v229, s[8:11], s58 offen offset:1024 sc1
    v_sub_u32 v241, v230, v231
    v_cvt_pk_bf16_f32 v242, v242, v243
    buffer_load_dwordx4 v[120:123], v229, s[8:11], s58 offen offset:2048 sc1
    v_cvt_pk_bf16_f32 v244, v244, v245
    v_cvt_pk_bf16_f32 v240, v240, v240
    buffer_load_dwordx4 v[124:127], v229, s[8:11], s58 offen offset:3072 sc1
    s_add_u32 s58, s58, 4096
    ds_write_b32 v230, v242 offset:768
    ds_write_b32 v230, v244 offset:1024
    ds_write_b16 v241, v240 offset:1280
    v_lshl_add_u32 v228, v252, 1, s59
    v_lshrrev_b32 v226, 6, v252
    v_mul_u32_u24 v226, 126, v226
    v_sub_u32 v226, v228, v226
K2_TAIL3:
    s_waitcnt vmcnt(8)
    ds_write_b32 v228, v192 offset:0
    ds_write_b32 v228, v193 offset:256
    ds_write_b32 v228, v194 offset:512
    buffer_load_dwordx4 v[128:131], v229, s[8:11], s58 offen offset:0 sc1
    v_bfe_u32 v48, v252, 1, 4
    v_lshrrev_b32 v49, 5, v252
    ds_write_b32 v228, v195 offset:768
    ds_write_b32 v228, v196 offset:1024
    ds_write_b16 v226, v197 offset:1280
    buffer_load_dwordx4 v[132:135], v229, s[8:11], s58 offen offset:1024 sc1
    v_lshrrev_b32 v55, 3, v48
    v_lshlrev_b32 v52, 4, v49
    ds_write_b32 v228, v198 offset:1536
    ds_write_b32 v228, v199 offset:1792
    ds_write_b32 v228, v200 offset:2048
    buffer_load_dwordx4 v[136:139], v229, s[8:11], s58 offen offset:2048 sc1
    v_lshl_add_u32 v54, v55, 2, v48
    v_and_b32 v54, 7, v54
    ds_write_b32 v228, v201 offset:2304
    ds_write_b32 v228, v202 offset:2560
    ds_write_b16 v226, v203 offset:2816
    buffer_load_dwordx4 v[140:143], v229, s[8:11], s58 offen offset:3072 sc1
    s_add_u32 s58, s58, 4096
    v_and_b32 v50, 7, v48
    v_mul_u32_u24 v50, 8224, v50
    ds_write_b32 v228, v204 offset:3072
    ds_write_b32 v228, v205 offset:3328
    ds_write_b32 v228, v206 offset:3584
    buffer_load_dwordx4 v[144:147], v229, s[8:11], s58 offen offset:0 sc1
    v_mul_u32_u24 v51, 1536, v55
    v_add_u32 v50, v50, v51
    ds_write_b32 v228, v207 offset:3840
    ds_write_b32 v228, v208 offset:4096
    ds_write_b16 v226, v209 offset:4352
    buffer_load_dwordx4 v[148:151], v229, s[8:11], s58 offen offset:1024 sc1
    v_add_u32 v222, v50, v52
    v_mul_u32_u24 v51, 8224, v54
    ds_write_b32 v228, v210 offset:4608
    ds_write_b32 v228, v211 offset:4864
    ds_write_b32 v228, v212 offset:5120
    buffer_load_dwordx4 v[152:155], v229, s[8:11], s58 offen offset:2048 sc1
    v_add_u32 v232, v51, v52
    v_lshl_add_u32 v247, v55, 7, v232
    ds_write_b32 v228, v213 offset:5376
    ds_write_b32 v228, v214 offset:5632
    ds_write_b16 v226, v215 offset:5888
    buffer_load_dwordx4 v[156:159], v229, s[8:11], s58 offen offset:3072 sc1
    s_add_u32 s58, s58, 4096
    v_mul_u32_u24 v53, 192, v48
    v_and_b32 v53, 0xc0, v53
    ds_write_b32 v228, v216 offset:6144
    ds_write_b32 v228, v217 offset:6400
    ds_write_b32 v228, v218 offset:6656
    buffer_load_dwordx4 v[160:163], v229, s[8:11], s58 offen offset:0 sc1
    v_add_u32 v53, v53, v52
    v_mul_u32_u24 v51, 2400, v48
    ds_write_b32 v228, v219 offset:6912
    ds_write_b32 v228, v220 offset:7168
    ds_write_b16 v226, v221 offset:7424
    buffer_load_dwordx4 v[164:167], v229, s[8:11], s58 offen offset:1024 sc1
    s_mov_b32 s60, 65536
    v_add3_u32 v223, v51, v53, s60
    buffer_load_dwordx4 v[168:171], v229, s[8:11], s58 offen offset:2048 sc1
    v_mul_u32_u24 v51, 2400, v54
    s_mov_b32 s60, 142336
    buffer_load_dwordx4 v[172:175], v229, s[8:11], s58 offen offset:3072 sc1
    v_add3_u32 v225, v51, v53, s60
    v_lshl_add_u32 v248, v55, 7, v225
    s_lshl_b32 s60, s20, 5
    v_lshl_add_u32 v49, v49, 3, s60
    s_mov_b32 s60, 65536
    v_add3_u32 v255, v51, v49, s60
    v_lshl_add_u32 v246, v55, 9, v255
    v_bfe_u32 v53, v48, 2, 1
    v_lshl_add_u32 v49, v53, 4, v49
    v_add_u32 v254, v50, v49
    s_and_b32 s64, s55, s28
    s_waitcnt lgkmcnt(0)
    s_barrier
    s_cmp_eq_u32 s64, 0
    s_cbranch_scc1 K2_MULTI
    s_setprio 3
    ds_read_b128 v[48:51], v222 offset:0
    ds_read_b128 v[52:55], v222 offset:64
    ds_read_b128 v[56:59], v222 offset:896
    ds_read_b128 v[60:63], v222 offset:960
    ds_read_b128 v[64:67], v223 offset:0
    ds_read_b128 v[68:71], v223 offset:64
    ds_read_b128 v[72:75], v223 offset:896
    ds_read_b128 v[76:79], v223 offset:960
    ds_read_b128 v[80:83], v222 offset:128
    ds_read_b128 v[84:87], v222 offset:384
    ds_read_b128 v[88:91], v222 offset:256
    s_waitcnt vmcnt(19) lgkmcnt(9)
    v_mfma_f32_16x16x32_bf16 v[0:3], v[96:99], v[48:51], 0
    ds_read_b128 v[92:95], v222 offset:192
    s_waitcnt vmcnt(18)
    v_mfma_f32_16x16x32_bf16 v[0:3], v[100:103], v[52:55], v[0:3]
    ds_read_b128 v[48:51], v222 offset:448
    s_waitcnt vmcnt(17) lgkmcnt(9)
    v_mfma_f32_16x16x32_bf16 v[0:3], v[104:107], v[56:59], v[0:3]
    s_bfe_u32 s60, s20, 0x10002
    s_lshl_b32 s60, s60, 4
    ds_read_b128 v[52:55], v222 offset:320
    s_waitcnt vmcnt(16)
    v_mfma_f32_16x16x32_bf16 v[0:3], v[108:111], v[60:63], v[0:3]
    s_add_u32 s59, s59, s60
    v_add_u32 v228, s59, v229
    ds_read_b128 v[56:59], v222 offset:640
    s_waitcnt vmcnt(15) lgkmcnt(9)
    v_mfma_f32_16x16x32_bf16 v[0:3], v[112:115], v[64:67], v[0:3]
    s_mul_i32 s60, s20, 2400
    s_add_u32 s60, s60, 65536
    ds_read_b128 v[60:63], v222 offset:512
    s_waitcnt vmcnt(14)
    v_mfma_f32_16x16x32_bf16 v[0:3], v[116:119], v[68:71], v[0:3]
    v_add_u32 v249, s60, v229
    s_mov_b32 s63, 0xbfb8aa3b
    ds_read_b128 v[64:67], v222 offset:768
    s_waitcnt vmcnt(13) lgkmcnt(9)
    v_mfma_f32_16x16x32_bf16 v[0:3], v[120:123], v[72:75], v[0:3]
    s_add_u32 s40, s20, s21
    s_lshl_b32 s40, s40, 10
    ds_read_b128 v[68:71], v222 offset:704
    s_waitcnt vmcnt(12)
    v_mfma_f32_16x16x32_bf16 v[0:3], v[124:127], v[76:79], v[0:3]
    s_add_u32 s41, s40, 8192
    s_add_u32 s42, s40, 16384
    ds_read_b128 v[72:75], v222 offset:576
    s_waitcnt vmcnt(11) lgkmcnt(9)
    v_mfma_f32_16x16x32_bf16 v[4:7], v[128:131], v[80:83], 0
    s_add_u32 s43, s40, 24576
    s_add_u32 s44, s40, 32768
    ds_read_b128 v[76:79], v222 offset:832
    v_mfma_f32_16x16x32_bf16 v[8:11], v[128:131], v[84:87], 0
    ds_read_b128 v[80:83], v222 offset:1024
    s_waitcnt lgkmcnt(9)
    v_mfma_f32_16x16x32_bf16 v[12:15], v[128:131], v[88:91], 0
    ds_read_b128 v[84:87], v222 offset:1280
    s_waitcnt vmcnt(10)
    v_mfma_f32_16x16x32_bf16 v[4:7], v[132:135], v[92:95], v[4:7]
    ds_read_b128 v[88:91], v222 offset:1152
    s_waitcnt lgkmcnt(9)
    v_mfma_f32_16x16x32_bf16 v[8:11], v[132:135], v[48:51], v[8:11]
    v_mul_f32 v204, s63, v0
    ds_read_b128 v[92:95], v222 offset:1088
    v_mfma_f32_16x16x32_bf16 v[12:15], v[132:135], v[52:55], v[12:15]
    v_mul_f32 v205, s63, v1
    s_setprio 2
    ds_read_b128 v[48:51], v222 offset:1344
    s_waitcnt vmcnt(9) lgkmcnt(9)
    v_mfma_f32_16x16x32_bf16 v[4:7], v[136:139], v[56:59], v[4:7]
    ds_read_b128 v[52:55], v222 offset:1216
    v_mfma_f32_16x16x32_bf16 v[8:11], v[136:139], v[60:63], v[8:11]
    v_mul_f32 v206, s63, v2
    ds_read_b128 v[56:59], v223 offset:128
    s_waitcnt lgkmcnt(9)
    v_mfma_f32_16x16x32_bf16 v[12:15], v[136:139], v[64:67], v[12:15]
    v_mul_f32 v207, s63, v3
    ds_read_b128 v[60:63], v223 offset:384
    s_waitcnt vmcnt(8)
    v_mfma_f32_16x16x32_bf16 v[4:7], v[140:143], v[68:71], v[4:7]
    ds_read_b128 v[64:67], v223 offset:256
    s_waitcnt lgkmcnt(9)
    v_mfma_f32_16x16x32_bf16 v[8:11], v[140:143], v[72:75], v[8:11]
    v_exp_f32 v204, v204
    ds_read_b128 v[68:71], v223 offset:192
    v_mfma_f32_16x16x32_bf16 v[12:15], v[140:143], v[76:79], v[12:15]
    ds_read_b128 v[72:75], v223 offset:448
    s_waitcnt vmcnt(7) lgkmcnt(9)
    v_mfma_f32_16x16x32_bf16 v[4:7], v[144:147], v[80:83], v[4:7]
    v_exp_f32 v205, v205
    ds_read_b128 v[76:79], v223 offset:320
    v_mfma_f32_16x16x32_bf16 v[8:11], v[144:147], v[84:87], v[8:11]
    v_exp_f32 v206, v206
    ds_read_b128 v[80:83], v223 offset:640
    s_waitcnt lgkmcnt(9)
    v_mfma_f32_16x16x32_bf16 v[12:15], v[144:147], v[88:91], v[12:15]
    ds_read_b128 v[84:87], v223 offset:512
    s_waitcnt vmcnt(6)
    v_mfma_f32_16x16x32_bf16 v[4:7], v[148:151], v[92:95], v[4:7]
    v_exp_f32 v207, v207
    ds_read_b128 v[88:91], v223 offset:768
    s_waitcnt lgkmcnt(9)
    v_mfma_f32_16x16x32_bf16 v[8:11], v[148:151], v[48:51], v[8:11]
    v_add_f32 v204, 1.0, v204
    ds_read_b128 v[92:95], v223 offset:704
    v_mfma_f32_16x16x32_bf16 v[12:15], v[148:151], v[52:55], v[12:15]
    ds_read_b128 v[48:51], v223 offset:576
    s_waitcnt vmcnt(5) lgkmcnt(9)
    v_mfma_f32_16x16x32_bf16 v[4:7], v[152:155], v[56:59], v[4:7]
    v_add_f32 v205, 1.0, v205
    ds_read_b128 v[52:55], v223 offset:832
    v_mfma_f32_16x16x32_bf16 v[8:11], v[152:155], v[60:63], v[8:11]
    s_setprio 1
    ds_read_b128 v[56:59], v223 offset:1024
    s_waitcnt lgkmcnt(9)
    v_mfma_f32_16x16x32_bf16 v[12:15], v[152:155], v[64:67], v[12:15]
    v_add_f32 v206, 1.0, v206
    ds_read_b128 v[60:63], v223 offset:1280
    s_waitcnt vmcnt(4)
    v_mfma_f32_16x16x32_bf16 v[4:7], v[156:159], v[68:71], v[4:7]
    v_add_f32 v207, 1.0, v207
    ds_read_b128 v[64:67], v223 offset:1152
    s_waitcnt lgkmcnt(9)
    v_mfma_f32_16x16x32_bf16 v[8:11], v[156:159], v[72:75], v[8:11]
    ds_read_b128 v[68:71], v223 offset:1088
    v_mfma_f32_16x16x32_bf16 v[12:15], v[156:159], v[76:79], v[12:15]
    v_rcp_f32 v204, v204
    ds_read_b128 v[72:75], v223 offset:1344
    s_waitcnt vmcnt(3) lgkmcnt(9)
    v_mfma_f32_16x16x32_bf16 v[4:7], v[160:163], v[80:83], v[4:7]
    v_rcp_f32 v205, v205
    ds_read_b128 v[76:79], v223 offset:1216
    v_mfma_f32_16x16x32_bf16 v[8:11], v[160:163], v[84:87], v[8:11]
    ds_read_b128 v[80:83], v222 offset:3072
    s_waitcnt lgkmcnt(9)
    v_mfma_f32_16x16x32_bf16 v[12:15], v[160:163], v[88:91], v[12:15]
    v_rcp_f32 v206, v206
    ds_read_b128 v[84:87], v222 offset:3136
    s_waitcnt vmcnt(2)
    v_mfma_f32_16x16x32_bf16 v[4:7], v[164:167], v[92:95], v[4:7]
    ds_read_b128 v[88:91], v222 offset:3968
    s_waitcnt lgkmcnt(9)
    v_mfma_f32_16x16x32_bf16 v[8:11], v[164:167], v[48:51], v[8:11]
    v_rcp_f32 v207, v207
    ds_read_b128 v[92:95], v222 offset:4032
    v_mfma_f32_16x16x32_bf16 v[12:15], v[164:167], v[52:55], v[12:15]
    v_cvt_pk_bf16_f32 v176, v0, v1
    ds_read_b128 v[48:51], v223 offset:38400
    s_waitcnt vmcnt(1) lgkmcnt(9)
    v_mfma_f32_16x16x32_bf16 v[4:7], v[168:171], v[56:59], v[4:7]
    ds_read_b128 v[52:55], v223 offset:38464
    v_mfma_f32_16x16x32_bf16 v[8:11], v[168:171], v[60:63], v[8:11]
    v_cvt_pk_bf16_f32 v177, v2, v3
    s_setprio 0
    ds_read_b128 v[56:59], v223 offset:39296
    s_waitcnt lgkmcnt(9)
    v_mfma_f32_16x16x32_bf16 v[12:15], v[168:171], v[64:67], v[12:15]
    ds_read_b128 v[60:63], v223 offset:39360
    s_waitcnt vmcnt(0)
    v_mfma_f32_16x16x32_bf16 v[4:7], v[172:175], v[68:71], v[4:7]
K2_PAD_T2:
    s_cbranch_execz K2_HOP
    ds_read_b128 v[64:67], v222 offset:3200
    s_waitcnt lgkmcnt(9)
    v_mfma_f32_16x16x32_bf16 v[8:11], v[172:175], v[72:75], v[8:11]
    ds_read_b128 v[68:71], v222 offset:3456
    v_mfma_f32_16x16x32_bf16 v[12:15], v[172:175], v[76:79], v[12:15]
    ds_read_b128 v[72:75], v222 offset:3328
    s_waitcnt lgkmcnt(9)
    v_mfma_f32_16x16x32_bf16 v[16:19], v[96:99], v[80:83], 0
    ds_read_b128 v[76:79], v222 offset:3264
    v_mfma_f32_16x16x32_bf16 v[16:19], v[100:103], v[84:87], v[16:19]
    ds_read_b128 v[80:83], v222 offset:3520
    s_waitcnt lgkmcnt(9)
    v_mfma_f32_16x16x32_bf16 v[16:19], v[104:107], v[88:91], v[16:19]
    s_barrier
    s_setprio 3
    ds_read_b128 v[84:87], v222 offset:3392
    v_mfma_f32_16x16x32_bf16 v[16:19], v[108:111], v[92:95], v[16:19]
    v_mul_f32 v4, v4, v204
    ds_read_b128 v[88:91], v222 offset:3712
    s_waitcnt lgkmcnt(9)
    v_mfma_f32_16x16x32_bf16 v[16:19], v[112:115], v[48:51], v[16:19]
    v_mul_f32 v5, v5, v205
    ds_read_b128 v[92:95], v222 offset:3584
    v_mfma_f32_16x16x32_bf16 v[16:19], v[116:119], v[52:55], v[16:19]
    v_mul_f32 v6, v6, v206
    ds_read_b128 v[48:51], v222 offset:3840
    s_waitcnt lgkmcnt(9)
    v_mfma_f32_16x16x32_bf16 v[16:19], v[120:123], v[56:59], v[16:19]
    v_mul_f32 v7, v7, v207
    ds_read_b128 v[52:55], v222 offset:3776
    v_mfma_f32_16x16x32_bf16 v[16:19], v[124:127], v[60:63], v[16:19]
    v_cvt_pk_bf16_f32 v178, v4, v5
    ds_read_b128 v[56:59], v222 offset:3648
    s_waitcnt lgkmcnt(9)
    v_mfma_f32_16x16x32_bf16 v[20:23], v[128:131], v[64:67], 0
    v_cvt_pk_bf16_f32 v179, v6, v7
    ds_read_b128 v[60:63], v222 offset:3904
    v_mfma_f32_16x16x32_bf16 v[24:27], v[128:131], v[68:71], 0
    v_mul_f32 v8, v8, v204
    ds_read_b128 v[64:67], v222 offset:4096
    s_waitcnt lgkmcnt(9)
    v_mfma_f32_16x16x32_bf16 v[28:31], v[128:131], v[72:75], 0
    v_mul_f32 v9, v9, v205
    ds_read_b128 v[68:71], v222 offset:4352
    v_mfma_f32_16x16x32_bf16 v[20:23], v[132:135], v[76:79], v[20:23]
    v_mul_f32 v10, v10, v206
    ds_read_b128 v[72:75], v222 offset:4224
    s_waitcnt lgkmcnt(9)
    v_mfma_f32_16x16x32_bf16 v[24:27], v[132:135], v[80:83], v[24:27]
    v_mul_f32 v11, v11, v207
    ds_read_b128 v[76:79], v222 offset:4160
    v_mfma_f32_16x16x32_bf16 v[28:31], v[132:135], v[84:87], v[28:31]
    v_cvt_pk_bf16_f32 v180, v8, v9
    ds_read_b128 v[80:83], v222 offset:4416
    s_waitcnt lgkmcnt(9)
    v_mfma_f32_16x16x32_bf16 v[20:23], v[136:139], v[88:91], v[20:23]
    v_cvt_pk_bf16_f32 v181, v10, v11
    ds_read_b128 v[84:87], v222 offset:4288
    v_mfma_f32_16x16x32_bf16 v[24:27], v[136:139], v[92:95], v[24:27]
    v_mul_f32 v12, v12, v204
    s_setprio 2
    ds_read_b128 v[88:91], v223 offset:38528
    s_waitcnt lgkmcnt(9)
    v_mfma_f32_16x16x32_bf16 v[28:31], v[136:139], v[48:51], v[28:31]
    v_mul_f32 v13, v13, v205
    ds_read_b128 v[92:95], v223 offset:38784
    v_mfma_f32_16x16x32_bf16 v[20:23], v[140:143], v[52:55], v[20:23]
    v_mul_f32 v14, v14, v206
    ds_read_b128 v[48:51], v223 offset:38656
    s_waitcnt lgkmcnt(9)
    v_mfma_f32_16x16x32_bf16 v[24:27], v[140:143], v[56:59], v[24:27]
    v_mul_f32 v15, v15, v207
    ds_read_b128 v[52:55], v223 offset:38592
    v_mfma_f32_16x16x32_bf16 v[28:31], v[140:143], v[60:63], v[28:31]
    v_cvt_pk_bf16_f32 v182, v12, v13
    ds_read_b128 v[56:59], v223 offset:38848
    s_waitcnt lgkmcnt(9)
    v_mfma_f32_16x16x32_bf16 v[20:23], v[144:147], v[64:67], v[20:23]
    v_cvt_pk_bf16_f32 v183, v14, v15
    ds_read_b128 v[60:63], v223 offset:38720
    v_mfma_f32_16x16x32_bf16 v[24:27], v[144:147], v[68:71], v[24:27]
    ds_write_b64 v254, v[176:177] offset:0
    ds_write_b64 v254, v[178:179] offset:256
    ds_write_b64 v254, v[180:181] offset:512
    ds_write_b64 v254, v[182:183] offset:768
    ds_read_b128 v[64:67], v223 offset:39040
    s_waitcnt lgkmcnt(13)
    v_mfma_f32_16x16x32_bf16 v[28:31], v[144:147], v[72:75], v[28:31]
    v_mul_f32 v208, s63, v16
    ds_read_b128 v[68:71], v223 offset:38912
    v_mfma_f32_16x16x32_bf16 v[20:23], v[148:151], v[76:79], v[20:23]
    v_mul_f32 v209, s63, v17
    ds_read_b128 v[72:75], v223 offset:39168
    s_waitcnt lgkmcnt(13)
    v_mfma_f32_16x16x32_bf16 v[24:27], v[148:151], v[80:83], v[24:27]
    v_mul_f32 v210, s63, v18
    ds_read_b128 v[76:79], v223 offset:39104
    v_mfma_f32_16x16x32_bf16 v[28:31], v[148:151], v[84:87], v[28:31]
    v_mul_f32 v211, s63, v19
    ds_read_b128 v[80:83], v223 offset:38976
    s_waitcnt lgkmcnt(13)
    v_mfma_f32_16x16x32_bf16 v[20:23], v[152:155], v[88:91], v[20:23]
    v_exp_f32 v208, v208
    ds_read_b128 v[84:87], v223 offset:39232
    v_mfma_f32_16x16x32_bf16 v[24:27], v[152:155], v[92:95], v[24:27]
    v_exp_f32 v209, v209
    ds_read_b128 v[88:91], v223 offset:39424
    s_waitcnt lgkmcnt(13)
    v_mfma_f32_16x16x32_bf16 v[28:31], v[152:155], v[48:51], v[28:31]
    s_setprio 1
    ds_read_b128 v[92:95], v223 offset:39680
    v_mfma_f32_16x16x32_bf16 v[20:23], v[156:159], v[52:55], v[20:23]
    v_exp_f32 v210, v210
    ds_read_b128 v[48:51], v223 offset:39552
    s_waitcnt lgkmcnt(13)
    v_mfma_f32_16x16x32_bf16 v[24:27], v[156:159], v[56:59], v[24:27]
    v_exp_f32 v211, v211
    ds_read_b128 v[52:55], v223 offset:39488
    v_mfma_f32_16x16x32_bf16 v[28:31], v[156:159], v[60:63], v[28:31]
    v_add_f32 v208, 1.0, v208
    ds_read_b128 v[56:59], v223 offset:39744
    s_waitcnt lgkmcnt(9)
    v_mfma_f32_16x16x32_bf16 v[20:23], v[160:163], v[64:67], v[20:23]
    v_add_f32 v209, 1.0, v209
    ds_read_b128 v[60:63], v223 offset:39616
    v_mfma_f32_16x16x32_bf16 v[24:27], v[160:163], v[68:71], v[24:27]
    v_add_f32 v210, 1.0, v210
    ds_read_b128 v[64:67], v232 offset:6144
    s_waitcnt lgkmcnt(9)
    v_mfma_f32_16x16x32_bf16 v[28:31], v[160:163], v[72:75], v[28:31]
    v_add_f32 v211, 1.0, v211
    ds_read_b128 v[68:71], v232 offset:6208
    v_mfma_f32_16x16x32_bf16 v[20:23], v[164:167], v[76:79], v[20:23]
    ds_read_b128 v[72:75], v232 offset:7040
    s_waitcnt lgkmcnt(9)
    v_mfma_f32_16x16x32_bf16 v[24:27], v[164:167], v[80:83], v[24:27]
    v_rcp_f32 v208, v208
    ds_read_b128 v[76:79], v232 offset:7104
    v_mfma_f32_16x16x32_bf16 v[28:31], v[164:167], v[84:87], v[28:31]
    v_rcp_f32 v209, v209
    ds_read_b128 v[80:83], v225 offset:0
    s_waitcnt lgkmcnt(9)
    v_mfma_f32_16x16x32_bf16 v[20:23], v[168:171], v[88:91], v[20:23]
    v_rcp_f32 v210, v210
    ds_read_b128 v[84:87], v225 offset:64
    v_mfma_f32_16x16x32_bf16 v[24:27], v[168:171], v[92:95], v[24:27]
    v_rcp_f32 v211, v211
    ds_read_b128 v[88:91], v225 offset:896
    s_waitcnt lgkmcnt(9)
    v_mfma_f32_16x16x32_bf16 v[28:31], v[168:171], v[48:51], v[28:31]
    v_cvt_pk_bf16_f32 v184, v16, v17
    s_setprio 0
    ds_read_b128 v[92:95], v225 offset:960
    v_mfma_f32_16x16x32_bf16 v[20:23], v[172:175], v[52:55], v[20:23]
    v_cvt_pk_bf16_f32 v185, v18, v19
    ds_read_b128 v[48:51], v247 offset:6272
    s_waitcnt lgkmcnt(9)
    v_mfma_f32_16x16x32_bf16 v[24:27], v[172:175], v[56:59], v[24:27]
    ds_read_b128 v[52:55], v232 offset:6528
    v_mfma_f32_16x16x32_bf16 v[28:31], v[172:175], v[60:63], v[28:31]
    ds_read_b128 v[56:59], v247 offset:6336
    s_waitcnt lgkmcnt(9)
    v_mfma_f32_16x16x32_bf16 v[32:35], v[96:99], v[64:67], 0
    ds_read_b128 v[60:63], v232 offset:6592
    v_mfma_f32_16x16x32_bf16 v[32:35], v[100:103], v[68:71], v[32:35]
    ds_read_b128 v[64:67], v247 offset:6784
    s_waitcnt lgkmcnt(9)
    v_mfma_f32_16x16x32_bf16 v[32:35], v[104:107], v[72:75], v[32:35]
    s_barrier
    ds_read_b128 v[192:195], v228 offset:0
    ds_read_b128 v[196:199], v228 offset:1536
    s_setprio 3
    ds_read_b128 v[68:71], v232 offset:6656
    v_mfma_f32_16x16x32_bf16 v[32:35], v[108:111], v[76:79], v[32:35]
    v_mul_f32 v20, v20, v208
    ds_read_b128 v[72:75], v247 offset:6848
    s_waitcnt lgkmcnt(11)
    v_mfma_f32_16x16x32_bf16 v[32:35], v[112:115], v[80:83], v[32:35]
    v_mul_f32 v21, v21, v209
    ds_read_b128 v[76:79], v232 offset:6720
    v_mfma_f32_16x16x32_bf16 v[32:35], v[116:119], v[84:87], v[32:35]
    v_mul_f32 v22, v22, v210
    ds_read_b128 v[80:83], v247 offset:7168
    s_waitcnt lgkmcnt(11)
    v_mfma_f32_16x16x32_bf16 v[32:35], v[120:123], v[88:91], v[32:35]
    v_mul_f32 v23, v23, v211
    ds_read_b128 v[84:87], v232 offset:7424
    v_mfma_f32_16x16x32_bf16 v[32:35], v[124:127], v[92:95], v[32:35]
    v_cvt_pk_bf16_f32 v186, v20, v21
    ds_read_b128 v[88:91], v247 offset:7232
    s_waitcnt lgkmcnt(11)
    v_mfma_f32_16x16x32_bf16 v[36:39], v[128:131], v[48:51], 0
    v_cvt_pk_bf16_f32 v187, v22, v23
    ds_read_b128 v[92:95], v232 offset:7488
    v_mfma_f32_16x16x32_bf16 v[40:43], v[128:131], v[52:55], 0
    v_mul_f32 v24, v24, v208
    ds_read_b128 v[48:51], v248 offset:128
    s_waitcnt lgkmcnt(11)
    v_mfma_f32_16x16x32_bf16 v[36:39], v[132:135], v[56:59], v[36:39]
    v_mul_f32 v25, v25, v209
    s_waitcnt lgkmcnt(8)
    buffer_store_dwordx4 v[192:195], v229, s[12:15], s40 offen sc1
    buffer_store_dwordx4 v[196:199], v229, s[12:15], s41 offen sc1
    ds_read_b128 v[52:55], v225 offset:384
    v_mfma_f32_16x16x32_bf16 v[40:43], v[132:135], v[60:63], v[40:43]
    v_mul_f32 v26, v26, v210
    s_setprio 2
    ds_read_b128 v[56:59], v248 offset:192
    s_waitcnt lgkmcnt(9)
    v_mfma_f32_16x16x32_bf16 v[36:39], v[136:139], v[64:67], v[36:39]
    v_mul_f32 v27, v27, v211
    v_mul_f32 v204, s63, v32
    ds_read_b128 v[60:63], v225 offset:448
    v_mfma_f32_16x16x32_bf16 v[40:43], v[136:139], v[68:71], v[40:43]
    v_cvt_pk_bf16_f32 v188, v24, v25
    v_mul_f32 v205, s63, v33
    ds_read_b128 v[64:67], v248 offset:640
    s_waitcnt lgkmcnt(9)
    v_mfma_f32_16x16x32_bf16 v[36:39], v[140:143], v[72:75], v[36:39]
    v_cvt_pk_bf16_f32 v189, v26, v27
    v_mul_f32 v206, s63, v34
    ds_read_b128 v[68:71], v225 offset:512
    v_mfma_f32_16x16x32_bf16 v[40:43], v[140:143], v[76:79], v[40:43]
    v_mul_f32 v28, v28, v208
    v_mul_f32 v207, s63, v35
    ds_read_b128 v[72:75], v248 offset:704
    s_waitcnt lgkmcnt(9)
    v_mfma_f32_16x16x32_bf16 v[36:39], v[144:147], v[80:83], v[36:39]
    v_mul_f32 v29, v29, v209
    v_exp_f32 v204, v204
    ds_read_b128 v[76:79], v225 offset:576
    v_mfma_f32_16x16x32_bf16 v[40:43], v[144:147], v[84:87], v[40:43]
    v_mul_f32 v30, v30, v210
    v_exp_f32 v205, v205
    ds_read_b128 v[80:83], v248 offset:1024
    s_waitcnt lgkmcnt(9)
    v_mfma_f32_16x16x32_bf16 v[36:39], v[148:151], v[88:91], v[36:39]
    v_mul_f32 v31, v31, v211
    v_exp_f32 v206, v206
    ds_read_b128 v[84:87], v225 offset:1280
    v_mfma_f32_16x16x32_bf16 v[40:43], v[148:151], v[92:95], v[40:43]
    v_cvt_pk_bf16_f32 v190, v28, v29
    v_exp_f32 v207, v207
    ds_read_b128 v[88:91], v248 offset:1088
    s_waitcnt lgkmcnt(9)
    v_mfma_f32_16x16x32_bf16 v[36:39], v[152:155], v[48:51], v[36:39]
    v_cvt_pk_bf16_f32 v191, v30, v31
    v_add_f32 v204, 1.0, v204
    s_setprio 1
    ds_read_b128 v[92:95], v225 offset:1344
    v_mfma_f32_16x16x32_bf16 v[40:43], v[152:155], v[52:55], v[40:43]
    ds_write_b64 v254, v[184:185] offset:3072
    ds_write_b64 v254, v[186:187] offset:3328
    ds_write_b64 v254, v[188:189] offset:3584
    ds_write_b64 v254, v[190:191] offset:3840
    v_add_f32 v205, 1.0, v205
    s_waitcnt lgkmcnt(12)
    v_mfma_f32_16x16x32_bf16 v[36:39], v[156:159], v[56:59], v[36:39]
    v_add_f32 v206, 1.0, v206
    v_mfma_f32_16x16x32_bf16 v[40:43], v[156:159], v[60:63], v[40:43]
    v_add_f32 v207, 1.0, v207
    s_waitcnt lgkmcnt(10)
    v_mfma_f32_16x16x32_bf16 v[36:39], v[160:163], v[64:67], v[36:39]
    v_rcp_f32 v204, v204
    v_mfma_f32_16x16x32_bf16 v[40:43], v[160:163], v[68:71], v[40:43]
    v_rcp_f32 v205, v205
    s_waitcnt lgkmcnt(8)
    v_mfma_f32_16x16x32_bf16 v[36:39], v[164:167], v[72:75], v[36:39]
    v_rcp_f32 v206, v206
    v_mfma_f32_16x16x32_bf16 v[40:43], v[164:167], v[76:79], v[40:43]
    v_rcp_f32 v207, v207
    s_waitcnt lgkmcnt(6)
    v_mfma_f32_16x16x32_bf16 v[36:39], v[168:171], v[80:83], v[36:39]
    v_cvt_pk_bf16_f32 v176, v32, v33
    s_setprio 0
    v_mfma_f32_16x16x32_bf16 v[40:43], v[168:171], v[84:87], v[40:43]
    v_cvt_pk_bf16_f32 v177, v34, v35
    s_waitcnt lgkmcnt(4)
    v_mfma_f32_16x16x32_bf16 v[36:39], v[172:175], v[88:91], v[36:39]
    ds_write_b64 v255, v[176:177] offset:0
    v_mfma_f32_16x16x32_bf16 v[40:43], v[172:175], v[92:95], v[40:43]
    s_nop 5
    v_mul_f32 v36, v36, v204
    v_mul_f32 v37, v37, v205
    v_mul_f32 v38, v38, v206
    v_mul_f32 v39, v39, v207
    v_cvt_pk_bf16_f32 v178, v36, v37
    v_cvt_pk_bf16_f32 v179, v38, v39
    v_mul_f32 v40, v40, v204
    v_mul_f32 v41, v41, v205
    v_mul_f32 v42, v42, v206
    v_mul_f32 v43, v43, v207
    v_cvt_pk_bf16_f32 v180, v40, v41
    v_cvt_pk_bf16_f32 v181, v42, v43
    ds_write_b64 v246, v[178:179] offset:256
    ds_write_b64 v255, v[180:181] offset:512
    s_waitcnt lgkmcnt(0)
    s_barrier
    ds_read_b128 v[192:195], v228 offset:3072
    ds_read_b128 v[196:199], v228 offset:4608
    ds_read_b128 v[200:203], v249
    s_waitcnt lgkmcnt(1)
    buffer_store_dwordx4 v[192:195], v229, s[12:15], s42 offen sc1
    buffer_store_dwordx4 v[196:199], v229, s[12:15], s43 offen sc1
K2_LASTROW:
    s_add_u32 s59, s20, 32
    s_cmp_ge_u32 s59, s22
    s_cbranch_scc1 K2_FIN
    s_waitcnt lgkmcnt(0)
    buffer_store_dwordx4 v[200:203], v229, s[12:15], s44 offen sc1
K2_FIN:
    s_endpgm
K2_MULTI:
    ds_read_b128 v[48:51], v222 offset:0
    ds_read_b128 v[52:55], v222 offset:64
    ds_read_b128 v[56:59], v222 offset:896
    ds_read_b128 v[60:63], v222 offset:960
    ds_read_b128 v[64:67], v223 offset:0
    ds_read_b128 v[68:71], v223 offset:64
    ds_read_b128 v[72:75], v223 offset:896
    ds_read_b128 v[76:79], v223 offset:960
    ds_read_b128 v[80:83], v222 offset:128
    ds_read_b128 v[84:87], v222 offset:384
    ds_read_b128 v[88:91], v222 offset:256
    s_waitcnt vmcnt(19) lgkmcnt(9)
    v_mfma_f32_16x16x32_bf16 v[0:3], v[96:99], v[48:51], 0
    ds_read_b128 v[92:95], v222 offset:192
    s_waitcnt vmcnt(18)
    v_mfma_f32_16x16x32_bf16 v[0:3], v[100:103], v[52:55], v[0:3]
    ds_read_b128 v[48:51], v222 offset:448
    s_waitcnt vmcnt(17) lgkmcnt(9)
    v_mfma_f32_16x16x32_bf16 v[0:3], v[104:107], v[56:59], v[0:3]
    ds_read_b128 v[52:55], v222 offset:320
    s_waitcnt vmcnt(16)
    v_mfma_f32_16x16x32_bf16 v[0:3], v[108:111], v[60:63], v[0:3]
    ds_read_b128 v[56:59], v222 offset:640
    s_waitcnt vmcnt(15) lgkmcnt(9)
    v_mfma_f32_16x16x32_bf16 v[0:3], v[112:115], v[64:67], v[0:3]
    ds_read_b128 v[60:63], v222 offset:512
    s_waitcnt vmcnt(14)
    v_mfma_f32_16x16x32_bf16 v[0:3], v[116:119], v[68:71], v[0:3]
    ds_read_b128 v[64:67], v222 offset:768
    s_waitcnt vmcnt(13) lgkmcnt(9)
    v_mfma_f32_16x16x32_bf16 v[0:3], v[120:123], v[72:75], v[0:3]
    ds_read_b128 v[68:71], v222 offset:704
    s_waitcnt vmcnt(12)
    v_mfma_f32_16x16x32_bf16 v[0:3], v[124:127], v[76:79], v[0:3]
    ds_read_b128 v[72:75], v222 offset:576
    s_waitcnt vmcnt(11) lgkmcnt(9)
    v_mfma_f32_16x16x32_bf16 v[4:7], v[128:131], v[80:83], 0
    ds_read_b128 v[76:79], v222 offset:832
    v_mfma_f32_16x16x32_bf16 v[8:11], v[128:131], v[84:87], 0
    ds_read_b128 v[80:83], v222 offset:1024
    s_waitcnt lgkmcnt(9)
    v_mfma_f32_16x16x32_bf16 v[12:15], v[128:131], v[88:91], 0
    ds_read_b128 v[84:87], v222 offset:1280
    s_waitcnt vmcnt(10)
    v_mfma_f32_16x16x32_bf16 v[4:7], v[132:135], v[92:95], v[4:7]
    ds_read_b128 v[88:91], v222 offset:1152
    s_waitcnt lgkmcnt(9)
    v_mfma_f32_16x16x32_bf16 v[8:11], v[132:135], v[48:51], v[8:11]
    ds_read_b128 v[92:95], v222 offset:1088
    v_mfma_f32_16x16x32_bf16 v[12:15], v[132:135], v[52:55], v[12:15]
    ds_read_b128 v[48:51], v222 offset:1344
    s_waitcnt vmcnt(9) lgkmcnt(9)
    v_mfma_f32_16x16x32_bf16 v[4:7], v[136:139], v[56:59], v[4:7]
    ds_read_b128 v[52:55], v222 offset:1216
    v_mfma_f32_16x16x32_bf16 v[8:11], v[136:139], v[60:63], v[8:11]
    ds_read_b128 v[56:59], v223 offset:128
    s_waitcnt lgkmcnt(9)
    v_mfma_f32_16x16x32_bf16 v[12:15], v[136:139], v[64:67], v[12:15]
    ds_read_b128 v[60:63], v223 offset:384
    s_waitcnt vmcnt(8)
    v_mfma_f32_16x16x32_bf16 v[4:7], v[140:143], v[68:71], v[4:7]
    ds_read_b128 v[64:67], v223 offset:256
    s_waitcnt lgkmcnt(9)
    v_mfma_f32_16x16x32_bf16 v[8:11], v[140:143], v[72:75], v[8:11]
    ds_read_b128 v[68:71], v223 offset:192
    v_mfma_f32_16x16x32_bf16 v[12:15], v[140:143], v[76:79], v[12:15]
    ds_read_b128 v[72:75], v223 offset:448
    s_waitcnt vmcnt(7) lgkmcnt(9)
    v_mfma_f32_16x16x32_bf16 v[4:7], v[144:147], v[80:83], v[4:7]
    ds_read_b128 v[76:79], v223 offset:320
    v_mfma_f32_16x16x32_bf16 v[8:11], v[144:147], v[84:87], v[8:11]
    ds_read_b128 v[80:83], v223 offset:640
    s_waitcnt lgkmcnt(9)
    v_mfma_f32_16x16x32_bf16 v[12:15], v[144:147], v[88:91], v[12:15]
    ds_read_b128 v[84:87], v223 offset:512
    s_waitcnt vmcnt(6)
    v_mfma_f32_16x16x32_bf16 v[4:7], v[148:151], v[92:95], v[4:7]
    ds_read_b128 v[88:91], v223 offset:768
    s_waitcnt lgkmcnt(9)
    v_mfma_f32_16x16x32_bf16 v[8:11], v[148:151], v[48:51], v[8:11]
    ds_read_b128 v[92:95], v223 offset:704
    v_mfma_f32_16x16x32_bf16 v[12:15], v[148:151], v[52:55], v[12:15]
    ds_read_b128 v[48:51], v223 offset:576
    s_waitcnt vmcnt(5) lgkmcnt(9)
    v_mfma_f32_16x16x32_bf16 v[4:7], v[152:155], v[56:59], v[4:7]
    ds_read_b128 v[52:55], v223 offset:832
    v_mfma_f32_16x16x32_bf16 v[8:11], v[152:155], v[60:63], v[8:11]
    ds_read_b128 v[56:59], v223 offset:1024
    s_waitcnt lgkmcnt(9)
    v_mfma_f32_16x16x32_bf16 v[12:15], v[152:155], v[64:67], v[12:15]
    ds_read_b128 v[60:63], v223 offset:1280
    s_waitcnt vmcnt(4)
    v_mfma_f32_16x16x32_bf16 v[4:7], v[156:159], v[68:71], v[4:7]
    ds_read_b128 v[64:67], v223 offset:1152
    s_waitcnt lgkmcnt(9)
    v_mfma_f32_16x16x32_bf16 v[8:11], v[156:159], v[72:75], v[8:11]
    ds_read_b128 v[68:71], v223 offset:1088
    v_mfma_f32_16x16x32_bf16 v[12:15], v[156:159], v[76:79], v[12:15]
    ds_read_b128 v[72:75], v223 offset:1344
    s_waitcnt vmcnt(3) lgkmcnt(9)
    v_mfma_f32_16x16x32_bf16 v[4:7], v[160:163], v[80:83], v[4:7]
    ds_read_b128 v[76:79], v223 offset:1216
    v_mfma_f32_16x16x32_bf16 v[8:11], v[160:163], v[84:87], v[8:11]
    ds_read_b128 v[80:83], v222 offset:3072
    s_waitcnt lgkmcnt(9)
    v_mfma_f32_16x16x32_bf16 v[12:15], v[160:163], v[88:91], v[12:15]
    ds_read_b128 v[84:87], v222 offset:3136
    s_waitcnt vmcnt(2)
    v_mfma_f32_16x16x32_bf16 v[4:7], v[164:167], v[92:95], v[4:7]
    ds_read_b128 v[88:91], v222 offset:3968
    s_waitcnt lgkmcnt(9)
    v_mfma_f32_16x16x32_bf16 v[8:11], v[164:167], v[48:51], v[8:11]
    ds_read_b128 v[92:95], v222 offset:4032
    v_mfma_f32_16x16x32_bf16 v[12:15], v[164:167], v[52:55], v[12:15]
    ds_read_b128 v[48:51], v223 offset:38400
    s_waitcnt vmcnt(1) lgkmcnt(9)
    v_mfma_f32_16x16x32_bf16 v[4:7], v[168:171], v[56:59], v[4:7]
    ds_read_b128 v[52:55], v223 offset:38464
    v_mfma_f32_16x16x32_bf16 v[8:11], v[168:171], v[60:63], v[8:11]
    ds_read_b128 v[56:59], v223 offset:39296
    s_waitcnt lgkmcnt(9)
    v_mfma_f32_16x16x32_bf16 v[12:15], v[168:171], v[64:67], v[12:15]
    ds_read_b128 v[60:63], v223 offset:39360
    s_waitcnt vmcnt(0)
    v_mfma_f32_16x16x32_bf16 v[4:7], v[172:175], v[68:71], v[4:7]
    ds_read_b128 v[64:67], v222 offset:3200
    s_waitcnt lgkmcnt(9)
    v_mfma_f32_16x16x32_bf16 v[8:11], v[172:175], v[72:75], v[8:11]
    ds_read_b128 v[68:71], v222 offset:3456
    v_mfma_f32_16x16x32_bf16 v[12:15], v[172:175], v[76:79], v[12:15]
    ds_read_b128 v[72:75], v222 offset:3328
    s_waitcnt lgkmcnt(9)
    v_mfma_f32_16x16x32_bf16 v[16:19], v[96:99], v[80:83], 0
    ds_read_b128 v[76:79], v222 offset:3264
    v_mfma_f32_16x16x32_bf16 v[16:19], v[100:103], v[84:87], v[16:19]
    ds_read_b128 v[80:83], v222 offset:3520
    s_waitcnt lgkmcnt(9)
    v_mfma_f32_16x16x32_bf16 v[16:19], v[104:107], v[88:91], v[16:19]
    ds_read_b128 v[84:87], v222 offset:3392
    v_mfma_f32_16x16x32_bf16 v[16:19], v[108:111], v[92:95], v[16:19]
    ds_read_b128 v[88:91], v222 offset:3712
    s_waitcnt lgkmcnt(9)
    v_mfma_f32_16x16x32_bf16 v[16:19], v[112:115], v[48:51], v[16:19]
    ds_read_b128 v[92:95], v222 offset:3584
    v_mfma_f32_16x16x32_bf16 v[16:19], v[116:119], v[52:55], v[16:19]
    ds_read_b128 v[48:51], v222 offset:3840
    s_waitcnt lgkmcnt(9)
    v_mfma_f32_16x16x32_bf16 v[16:19], v[120:123], v[56:59], v[16:19]
    ds_read_b128 v[52:55], v222 offset:3776
    v_mfma_f32_16x16x32_bf16 v[16:19], v[124:127], v[60:63], v[16:19]
    ds_read_b128 v[56:59], v222 offset:3648
    s_waitcnt lgkmcnt(9)
    v_mfma_f32_16x16x32_bf16 v[20:23], v[128:131], v[64:67], 0
    ds_read_b128 v[60:63], v222 offset:3904
    v_mfma_f32_16x16x32_bf16 v[24:27], v[128:131], v[68:71], 0
    ds_read_b128 v[64:67], v222 offset:4096
    s_waitcnt lgkmcnt(9)
    v_mfma_f32_16x16x32_bf16 v[28:31], v[128:131], v[72:75], 0
    ds_read_b128 v[68:71], v222 offset:4352
    v_mfma_f32_16x16x32_bf16 v[20:23], v[132:135], v[76:79], v[20:23]
    ds_read_b128 v[72:75], v222 offset:4224
    s_waitcnt lgkmcnt(9)
    v_mfma_f32_16x16x32_bf16 v[24:27], v[132:135], v[80:83], v[24:27]
    ds_read_b128 v[76:79], v222 offset:4160
    v_mfma_f32_16x16x32_bf16 v[28:31], v[132:135], v[84:87], v[28:31]
    ds_read_b128 v[80:83], v222 offset:4416
    s_waitcnt lgkmcnt(9)
    v_mfma_f32_16x16x32_bf16 v[20:23], v[136:139], v[88:91], v[20:23]
    ds_read_b128 v[84:87], v222 offset:4288
    v_mfma_f32_16x16x32_bf16 v[24:27], v[136:139], v[92:95], v[24:27]
    ds_read_b128 v[88:91], v223 offset:38528
    s_waitcnt lgkmcnt(9)
    v_mfma_f32_16x16x32_bf16 v[28:31], v[136:139], v[48:51], v[28:31]
    ds_read_b128 v[92:95], v223 offset:38784
    v_mfma_f32_16x16x32_bf16 v[20:23], v[140:143], v[52:55], v[20:23]
    ds_read_b128 v[48:51], v223 offset:38656
    s_waitcnt lgkmcnt(9)
    v_mfma_f32_16x16x32_bf16 v[24:27], v[140:143], v[56:59], v[24:27]
    ds_read_b128 v[52:55], v223 offset:38592
    v_mfma_f32_16x16x32_bf16 v[28:31], v[140:143], v[60:63], v[28:31]
    ds_read_b128 v[56:59], v223 offset:38848
    s_waitcnt lgkmcnt(9)
    v_mfma_f32_16x16x32_bf16 v[20:23], v[144:147], v[64:67], v[20:23]
    ds_read_b128 v[60:63], v223 offset:38720
    v_mfma_f32_16x16x32_bf16 v[24:27], v[144:147], v[68:71], v[24:27]
    ds_read_b128 v[64:67], v223 offset:39040
    s_waitcnt lgkmcnt(9)
    v_mfma_f32_16x16x32_bf16 v[28:31], v[144:147], v[72:75], v[28:31]
    ds_read_b128 v[68:71], v223 offset:38912
    v_mfma_f32_16x16x32_bf16 v[20:23], v[148:151], v[76:79], v[20:23]
    ds_read_b128 v[72:75], v223 offset:39168
    s_waitcnt lgkmcnt(9)
    v_mfma_f32_16x16x32_bf16 v[24:27], v[148:151], v[80:83], v[24:27]
    ds_read_b128 v[76:79], v223 offset:39104
    v_mfma_f32_16x16x32_bf16 v[28:31], v[148:151], v[84:87], v[28:31]
    ds_read_b128 v[80:83], v223 offset:38976
    s_waitcnt lgkmcnt(9)
    v_mfma_f32_16x16x32_bf16 v[20:23], v[152:155], v[88:91], v[20:23]
    ds_read_b128 v[84:87], v223 offset:39232
    v_mfma_f32_16x16x32_bf16 v[24:27], v[152:155], v[92:95], v[24:27]
    ds_read_b128 v[88:91], v223 offset:39424
    s_waitcnt lgkmcnt(9)
    v_mfma_f32_16x16x32_bf16 v[28:31], v[152:155], v[48:51], v[28:31]
    ds_read_b128 v[92:95], v223 offset:39680
    v_mfma_f32_16x16x32_bf16 v[20:23], v[156:159], v[52:55], v[20:23]
    ds_read_b128 v[48:51], v223 offset:39552
    s_waitcnt lgkmcnt(9)
    v_mfma_f32_16x16x32_bf16 v[24:27], v[156:159], v[56:59], v[24:27]
    ds_read_b128 v[52:55], v223 offset:39488
    v_mfma_f32_16x16x32_bf16 v[28:31], v[156:159], v[60:63], v[28:31]
    ds_read_b128 v[56:59], v223 offset:39744
    s_waitcnt lgkmcnt(9)
    v_mfma_f32_16x16x32_bf16 v[20:23], v[160:163], v[64:67], v[20:23]
    ds_read_b128 v[60:63], v223 offset:39616
    v_mfma_f32_16x16x32_bf16 v[24:27], v[160:163], v[68:71], v[24:27]
    ds_read_b128 v[64:67], v232 offset:6144
    s_waitcnt lgkmcnt(9)
    v_mfma_f32_16x16x32_bf16 v[28:31], v[160:163], v[72:75], v[28:31]
    ds_read_b128 v[68:71], v232 offset:6208
    v_mfma_f32_16x16x32_bf16 v[20:23], v[164:167], v[76:79], v[20:23]
    ds_read_b128 v[72:75], v232 offset:7040
    s_waitcnt lgkmcnt(9)
    v_mfma_f32_16x16x32_bf16 v[24:27], v[164:167], v[80:83], v[24:27]
    ds_read_b128 v[76:79], v232 offset:7104
    v_mfma_f32_16x16x32_bf16 v[28:31], v[164:167], v[84:87], v[28:31]
    ds_read_b128 v[80:83], v225 offset:0
    s_waitcnt lgkmcnt(9)
    v_mfma_f32_16x16x32_bf16 v[20:23], v[168:171], v[88:91], v[20:23]
    ds_read_b128 v[84:87], v225 offset:64
    v_mfma_f32_16x16x32_bf16 v[24:27], v[168:171], v[92:95], v[24:27]
    ds_read_b128 v[88:91], v225 offset:896
    s_waitcnt lgkmcnt(9)
    v_mfma_f32_16x16x32_bf16 v[28:31], v[168:171], v[48:51], v[28:31]
    ds_read_b128 v[92:95], v225 offset:960
    v_mfma_f32_16x16x32_bf16 v[20:23], v[172:175], v[52:55], v[20:23]
    ds_read_b128 v[48:51], v247 offset:6272
    s_waitcnt lgkmcnt(9)
    v_mfma_f32_16x16x32_bf16 v[24:27], v[172:175], v[56:59], v[24:27]
    ds_read_b128 v[52:55], v232 offset:6528
    v_mfma_f32_16x16x32_bf16 v[28:31], v[172:175], v[60:63], v[28:31]
    ds_read_b128 v[56:59], v247 offset:6336
    s_waitcnt lgkmcnt(9)
    v_mfma_f32_16x16x32_bf16 v[32:35], v[96:99], v[64:67], 0
    ds_read_b128 v[60:63], v232 offset:6592
    v_mfma_f32_16x16x32_bf16 v[32:35], v[100:103], v[68:71], v[32:35]
    ds_read_b128 v[64:67], v247 offset:6784
    s_waitcnt lgkmcnt(9)
    v_mfma_f32_16x16x32_bf16 v[32:35], v[104:107], v[72:75], v[32:35]
    ds_read_b128 v[68:71], v232 offset:6656
    v_mfma_f32_16x16x32_bf16 v[32:35], v[108:111], v[76:79], v[32:35]
    ds_read_b128 v[72:75], v247 offset:6848
    s_waitcnt lgkmcnt(9)
    v_mfma_f32_16x16x32_bf16 v[32:35], v[112:115], v[80:83], v[32:35]
    ds_read_b128 v[76:79], v232 offset:6720
    v_mfma_f32_16x16x32_bf16 v[32:35], v[116:119], v[84:87], v[32:35]
    ds_read_b128 v[80:83], v247 offset:7168
    s_waitcnt lgkmcnt(9)
    v_mfma_f32_16x16x32_bf16 v[32:35], v[120:123], v[88:91], v[32:35]
    ds_read_b128 v[84:87], v232 offset:7424
    v_mfma_f32_16x16x32_bf16 v[32:35], v[124:127], v[92:95], v[32:35]
    ds_read_b128 v[88:91], v247 offset:7232
    s_waitcnt lgkmcnt(9)
    v_mfma_f32_16x16x32_bf16 v[36:39], v[128:131], v[48:51], 0
    ds_read_b128 v[92:95], v232 offset:7488
    v_mfma_f32_16x16x32_bf16 v[40:43], v[128:131], v[52:55], 0
    ds_read_b128 v[48:51], v248 offset:128
    s_waitcnt lgkmcnt(9)
    v_mfma_f32_16x16x32_bf16 v[36:39], v[132:135], v[56:59], v[36:39]
    ds_read_b128 v[52:55], v225 offset:384
    v_mfma_f32_16x16x32_bf16 v[40:43], v[132:135], v[60:63], v[40:43]
    ds_read_b128 v[56:59], v248 offset:192
    s_waitcnt lgkmcnt(9)
    v_mfma_f32_16x16x32_bf16 v[36:39], v[136:139], v[64:67], v[36:39]
    ds_read_b128 v[60:63], v225 offset:448
    v_mfma_f32_16x16x32_bf16 v[40:43], v[136:139], v[68:71], v[40:43]
    ds_read_b128 v[64:67], v248 offset:640
    s_waitcnt lgkmcnt(9)
    v_mfma_f32_16x16x32_bf16 v[36:39], v[140:143], v[72:75], v[36:39]
    ds_read_b128 v[68:71], v225 offset:512
    v_mfma_f32_16x16x32_bf16 v[40:43], v[140:143], v[76:79], v[40:43]
    ds_read_b128 v[72:75], v248 offset:704
    s_waitcnt lgkmcnt(9)
    v_mfma_f32_16x16x32_bf16 v[36:39], v[144:147], v[80:83], v[36:39]
    ds_read_b128 v[76:79], v225 offset:576
    v_mfma_f32_16x16x32_bf16 v[40:43], v[144:147], v[84:87], v[40:43]
    ds_read_b128 v[80:83], v248 offset:1024
    s_waitcnt lgkmcnt(9)
    v_mfma_f32_16x16x32_bf16 v[36:39], v[148:151], v[88:91], v[36:39]
    ds_read_b128 v[84:87], v225 offset:1280
    v_mfma_f32_16x16x32_bf16 v[40:43], v[148:151], v[92:95], v[40:43]
    ds_read_b128 v[88:91], v248 offset:1088
    s_waitcnt lgkmcnt(9)
    v_mfma_f32_16x16x32_bf16 v[36:39], v[152:155], v[48:51], v[36:39]
    ds_read_b128 v[92:95], v225 offset:1344
    v_mfma_f32_16x16x32_bf16 v[40:43], v[152:155], v[52:55], v[40:43]
    s_waitcnt lgkmcnt(8)
    v_mfma_f32_16x16x32_bf16 v[36:39], v[156:159], v[56:59], v[36:39]
    v_mfma_f32_16x16x32_bf16 v[40:43], v[156:159], v[60:63], v[40:43]
    s_waitcnt lgkmcnt(6)
    v_mfma_f32_16x16x32_bf16 v[36:39], v[160:163], v[64:67], v[36:39]
    v_mfma_f32_16x16x32_bf16 v[40:43], v[160:163], v[68:71], v[40:43]
    s_waitcnt lgkmcnt(4)
    v_mfma_f32_16x16x32_bf16 v[36:39], v[164:167], v[72:75], v[36:39]
    v_mfma_f32_16x16x32_bf16 v[40:43], v[164:167], v[76:79], v[40:43]
    s_waitcnt lgkmcnt(2)
    v_mfma_f32_16x16x32_bf16 v[36:39], v[168:171], v[80:83], v[36:39]
    v_mfma_f32_16x16x32_bf16 v[40:43], v[168:171], v[84:87], v[40:43]
    s_waitcnt lgkmcnt(0)
    v_mfma_f32_16x16x32_bf16 v[36:39], v[172:175], v[88:91], v[36:39]
    v_mfma_f32_16x16x32_bf16 v[40:43], v[172:175], v[92:95], v[40:43]
    s_lshl_b32 s60, s54, 9
    s_lshl_b32 s61, s20, 6
    s_add_u32 s60, s60, s61
    s_mul_i32 s60, s60, 192
    s_add_u32 s60, s60, 10485760
    v_mul_u32_u24 v227, 96, v252
    s_cmp_lg_u32 s28, 0
    s_cbranch_scc1 K2_NOACC
    buffer_load_dwordx4 v[48:51], v227, s[8:11], s60 offen offset:0
    buffer_load_dwordx4 v[52:55], v227, s[8:11], s60 offen offset:16
    buffer_load_dwordx4 v[56:59], v227, s[8:11], s60 offen offset:32
    buffer_load_dwordx4 v[60:63], v227, s[8:11], s60 offen offset:48
    buffer_load_dwordx4 v[64:67], v227, s[8:11], s60 offen offset:64
    buffer_load_dwordx4 v[68:71], v227, s[8:11], s60 offen offset:80
    buffer_load_dwordx4 v[72:75], v227, s[8:11], s60 offen offset:96
    buffer_load_dwordx4 v[76:79], v227, s[8:11], s60 offen offset:112
    buffer_load_dwordx4 v[80:83], v227, s[8:11], s60 offen offset:128
    buffer_load_dwordx4 v[84:87], v227, s[8:11], s60 offen offset:144
    buffer_load_dwordx4 v[88:91], v227, s[8:11], s60 offen offset:160
    s_waitcnt vmcnt(0)
    v_add_f32 v0, v0, v48
    v_add_f32 v1, v1, v49
    v_add_f32 v2, v2, v50
    v_add_f32 v3, v3, v51
    v_add_f32 v4, v4, v52
    v_add_f32 v5, v5, v53
    v_add_f32 v6, v6, v54
    v_add_f32 v7, v7, v55
    v_add_f32 v8, v8, v56
    v_add_f32 v9, v9, v57
    v_add_f32 v10, v10, v58
    v_add_f32 v11, v11, v59
    v_add_f32 v12, v12, v60
    v_add_f32 v13, v13, v61
    v_add_f32 v14, v14, v62
    v_add_f32 v15, v15, v63
    v_add_f32 v16, v16, v64
    v_add_f32 v17, v17, v65
    v_add_f32 v18, v18, v66
    v_add_f32 v19, v19, v67
    v_add_f32 v20, v20, v68
    v_add_f32 v21, v21, v69
    v_add_f32 v22, v22, v70
    v_add_f32 v23, v23, v71
    v_add_f32 v24, v24, v72
    v_add_f32 v25, v25, v73
    v_add_f32 v26, v26, v74
    v_add_f32 v27, v27, v75
    v_add_f32 v28, v28, v76
    v_add_f32 v29, v29, v77
    v_add_f32 v30, v30, v78
    v_add_f32 v31, v31, v79
    v_add_f32 v32, v32, v80
    v_add_f32 v33, v33, v81
    v_add_f32 v34, v34, v82
    v_add_f32 v35, v35, v83
    v_add_f32 v36, v36, v84
    v_add_f32 v37, v37, v85
    v_add_f32 v38, v38, v86
    v_add_f32 v39, v39, v87
    v_add_f32 v40, v40, v88
    v_add_f32 v41, v41, v89
    v_add_f32 v42, v42, v90
    v_add_f32 v43, v43, v91
K2_NOACC:
    s_barrier
    s_cmp_eq_u32 s55, 0
    s_cbranch_scc1 K2_SPILL
    s_bfe_u32 s60, s20, 0x10002
    s_lshl_b32 s60, s60, 4
    s_add_u32 s59, s59, s60
    v_add_u32 v228, s59, v229
    s_mul_i32 s60, s20, 2400
    s_add_u32 s60, s60, 65536
    v_add_u32 v249, s60, v229
    s_mov_b32 s63, 0xbfb8aa3b
    s_add_u32 s40, s20, s21
    s_lshl_b32 s40, s40, 10
    s_add_u32 s41, s40, 8192
    s_add_u32 s42, s40, 16384
    s_add_u32 s43, s40, 24576
    s_add_u32 s44, s40, 32768
    v_mul_f32 v204, s63, v0
    v_mul_f32 v205, s63, v1
    v_mul_f32 v206, s63, v2
    v_mul_f32 v207, s63, v3
    v_exp_f32 v204, v204
    v_exp_f32 v205, v205
    v_exp_f32 v206, v206
    v_exp_f32 v207, v207
    v_add_f32 v204, 1.0, v204
    v_add_f32 v205, 1.0, v205
    v_add_f32 v206, 1.0, v206
    v_add_f32 v207, 1.0, v207
    v_rcp_f32 v204, v204
    v_rcp_f32 v205, v205
    v_rcp_f32 v206, v206
    v_rcp_f32 v207, v207
    v_cvt_pk_bf16_f32 v176, v0, v1
    v_cvt_pk_bf16_f32 v177, v2, v3
    v_mul_f32 v4, v4, v204
    v_mul_f32 v5, v5, v205
    v_mul_f32 v6, v6, v206
    v_mul_f32 v7, v7, v207
    v_cvt_pk_bf16_f32 v178, v4, v5
    v_cvt_pk_bf16_f32 v179, v6, v7
    v_mul_f32 v8, v8, v204
    v_mul_f32 v9, v9, v205
    v_mul_f32 v10, v10, v206
    v_mul_f32 v11, v11, v207
    v_cvt_pk_bf16_f32 v180, v8, v9
    v_cvt_pk_bf16_f32 v181, v10, v11
    v_mul_f32 v12, v12, v204
    v_mul_f32 v13, v13, v205
    v_mul_f32 v14, v14, v206
    v_mul_f32 v15, v15, v207
    v_cvt_pk_bf16_f32 v182, v12, v13
    v_cvt_pk_bf16_f32 v183, v14, v15
    ds_write_b64 v254, v[176:177] offset:0
    ds_write_b64 v254, v[178:179] offset:256
    ds_write_b64 v254, v[180:181] offset:512
    ds_write_b64 v254, v[182:183] offset:768
    s_waitcnt lgkmcnt(0)
    s_barrier
    ds_read_b128 v[192:195], v228 offset:0
    ds_read_b128 v[196:199], v228 offset:1536
    s_waitcnt lgkmcnt(0)
    buffer_store_dwordx4 v[192:195], v229, s[12:15], s40 offen sc1
    buffer_store_dwordx4 v[196:199], v229, s[12:15], s41 offen sc1
    v_mul_f32 v208, s63, v16
    v_mul_f32 v209, s63, v17
    v_mul_f32 v210, s63, v18
    v_mul_f32 v211, s63, v19
    v_exp_f32 v208, v208
    v_exp_f32 v209, v209
    v_exp_f32 v210, v210
    v_exp_f32 v211, v211
    v_add_f32 v208, 1.0, v208
    v_add_f32 v209, 1.0, v209
    v_add_f32 v210, 1.0, v210
    v_add_f32 v211, 1.0, v211
    v_rcp_f32 v208, v208
    v_rcp_f32 v209, v209
    v_rcp_f32 v210, v210
    v_rcp_f32 v211, v211
    v_cvt_pk_bf16_f32 v184, v16, v17
    v_cvt_pk_bf16_f32 v185, v18, v19
    v_mul_f32 v20, v20, v208
    v_mul_f32 v21, v21, v209
    v_mul_f32 v22, v22, v210
    v_mul_f32 v23, v23, v211
    v_cvt_pk_bf16_f32 v186, v20, v21
    v_cvt_pk_bf16_f32 v187, v22, v23
    v_mul_f32 v24, v24, v208
    v_mul_f32 v25, v25, v209
    v_mul_f32 v26, v26, v210
    v_mul_f32 v27, v27, v211
    v_cvt_pk_bf16_f32 v188, v24, v25
    v_cvt_pk_bf16_f32 v189, v26, v27
    v_mul_f32 v28, v28, v208
    v_mul_f32 v29, v29, v209
    v_mul_f32 v30, v30, v210
    v_mul_f32 v31, v31, v211
    v_cvt_pk_bf16_f32 v190, v28, v29
    v_cvt_pk_bf16_f32 v191, v30, v31
    ds_write_b64 v254, v[184:185] offset:3072
    ds_write_b64 v254, v[186:187] offset:3328
    ds_write_b64 v254, v[188:189] offset:3584
    ds_write_b64 v254, v[190:191] offset:3840
    s_waitcnt lgkmcnt(0)
    s_barrier
    ds_read_b128 v[192:195], v228 offset:3072
    ds_read_b128 v[196:199], v228 offset:4608
    s_waitcnt lgkmcnt(0)
    buffer_store_dwordx4 v[192:195], v229, s[12:15], s42 offen sc1
    buffer_store_dwordx4 v[196:199], v229, s[12:15], s43 offen sc1
    v_mul_f32 v204, s63, v32
    v_mul_f32 v205, s63, v33
    v_mul_f32 v206, s63, v34
    v_mul_f32 v207, s63, v35
    v_exp_f32 v204, v204
    v_exp_f32 v205, v205
    v_exp_f32 v206, v206
    v_exp_f32 v207, v207
    v_add_f32 v204, 1.0, v204
    v_add_f32 v205, 1.0, v205
    v_add_f32 v206, 1.0, v206
    v_add_f32 v207, 1.0, v207
    v_rcp_f32 v204, v204
    v_rcp_f32 v205, v205
    v_rcp_f32 v206, v206
    v_rcp_f32 v207, v207
    v_cvt_pk_bf16_f32 v176, v32, v33
    v_cvt_pk_bf16_f32 v177, v34, v35
    v_mul_f32 v36, v36, v204
    v_mul_f32 v37, v37, v205
    v_mul_f32 v38, v38, v206
    v_mul_f32 v39, v39, v207
    v_cvt_pk_bf16_f32 v178, v36, v37
    v_cvt_pk_bf16_f32 v179, v38, v39
    v_mul_f32 v40, v40, v204
    v_mul_f32 v41, v41, v205
    v_mul_f32 v42, v42, v206
    v_mul_f32 v43, v43, v207
    v_cvt_pk_bf16_f32 v180, v40, v41
    v_cvt_pk_bf16_f32 v181, v42, v43
    ds_write_b64 v255, v[176:177] offset:0
    ds_write_b64 v246, v[178:179] offset:256
    ds_write_b64 v255, v[180:181] offset:512
    s_waitcnt lgkmcnt(0)
    s_barrier
    ds_read_b128 v[200:203], v249
    s_branch K2_LASTROW
K2_SPILL:
    buffer_store_dwordx4 v[0:3], v227, s[8:11], s60 offen offset:0
    buffer_store_dwordx4 v[4:7], v227, s[8:11], s60 offen offset:16
    buffer_store_dwordx4 v[8:11], v227, s[8:11], s60 offen offset:32
    buffer_store_dwordx4 v[12:15], v227, s[8:11], s60 offen offset:48
    buffer_store_dwordx4 v[16:19], v227, s[8:11], s60 offen offset:64
    buffer_store_dwordx4 v[20:23], v227, s[8:11], s60 offen offset:80
    buffer_store_dwordx4 v[24:27], v227, s[8:11], s60 offen offset:96
    buffer_store_dwordx4 v[28:31], v227, s[8:11], s60 offen offset:112
    buffer_store_dwordx4 v[32:35], v227, s[8:11], s60 offen offset:128
    buffer_store_dwordx4 v[36:39], v227, s[8:11], s60 offen offset:144
    buffer_store_dwordx4 v[40:43], v227, s[8:11], s60 offen offset:160
    s_mov_b32 s28, 0
    s_waitcnt vmcnt(0)
    s_cmp_lt_u32 s24, s25
    s_cbranch_scc1 K2_LOAD
    s_add_u32 s23, s23, 20
    s_branch K2_WINDOW
K2_WINDOW:
    s_mov_b32 s24, 0
    s_mov_b32 s25, 1
K2_LOAD:
    v_mbcnt_lo_u32_b32 v176, -1, 0
    v_mbcnt_hi_u32_b32 v176, -1, v176
    s_lshl_b32 s58, s20, 6
    v_add_u32 v177, s58, v176
    v_lshlrev_b32 v70, 4, v176
    s_mov_b32 s58, 7110656
    buffer_load_dwordx4 v[96:99], v70, s[8:11], s58 offen offset:0 sc1
    buffer_load_dwordx4 v[100:103], v70, s[8:11], s58 offen offset:1024 sc1
    buffer_load_dwordx4 v[104:107], v70, s[8:11], s58 offen offset:2048 sc1
    buffer_load_dwordx4 v[108:111], v70, s[8:11], s58 offen offset:3072 sc1
    s_mov_b32 s58, 7114752
    buffer_load_dwordx4 v[112:115], v70, s[8:11], s58 offen offset:0 sc1
    buffer_load_dwordx4 v[116:119], v70, s[8:11], s58 offen offset:1024 sc1
    buffer_load_dwordx4 v[120:123], v70, s[8:11], s58 offen offset:2048 sc1
    buffer_load_dwordx4 v[124:127], v70, s[8:11], s58 offen offset:3072 sc1
    s_mov_b32 s58, 7118848
    buffer_load_dwordx4 v[128:131], v70, s[8:11], s58 offen offset:0 sc1
    buffer_load_dwordx4 v[132:135], v70, s[8:11], s58 offen offset:1024 sc1
    buffer_load_dwordx4 v[136:139], v70, s[8:11], s58 offen offset:2048 sc1
    buffer_load_dwordx4 v[140:143], v70, s[8:11], s58 offen offset:3072 sc1
    s_mov_b32 s58, 7122944
    buffer_load_dwordx4 v[144:147], v70, s[8:11], s58 offen offset:0 sc1
    buffer_load_dwordx4 v[148:151], v70, s[8:11], s58 offen offset:1024 sc1
    buffer_load_dwordx4 v[152:155], v70, s[8:11], s58 offen offset:2048 sc1
    buffer_load_dwordx4 v[156:159], v70, s[8:11], s58 offen offset:3072 sc1
    s_mov_b32 s58, 7127040
    buffer_load_dwordx4 v[160:163], v70, s[8:11], s58 offen offset:0 sc1
    buffer_load_dwordx4 v[164:167], v70, s[8:11], s58 offen offset:1024 sc1
    buffer_load_dwordx4 v[168:171], v70, s[8:11], s58 offen offset:2048 sc1
    buffer_load_dwordx4 v[172:175], v70, s[8:11], s58 offen offset:3072 sc1
    v_mul_u32_u24 v76, 437, v177
    v_lshrrev_b32 v76, 16, v76
    v_mul_u32_u24 v76, 150, v76
    v_sub_u32 v76, v177, v76
    v_mov_b32 v80, -1
    v_mov_b32 v77, 1.0
    v_cmp_gt_u32 vcc, 48, v76
    v_lshlrev_b32 v78, 4, v177
    v_add_u32 v78, 65536, v78
    v_cndmask_b32 v80, v80, 0, vcc
    v_cmp_gt_u32 vcc, 12, v76
    v_add_u32 v79, 64800, v78
    s_nop 0
    v_cndmask_b32 v80, v80, v77, vcc
    v_cmp_gt_u32 vcc, 450, v177
    v_mov_b32 v81, v80
    v_mov_b32 v82, v80
    v_mov_b32 v83, v80
    s_mov_b64 exec, vcc
    ds_write_b128 v78, v[80:83] offset:0
    ds_write_b128 v78, v[80:83] offset:7200
    ds_write_b128 v78, v[80:83] offset:14400
    ds_write_b128 v78, v[80:83] offset:21600
    ds_write_b128 v78, v[80:83] offset:28800
    ds_write_b128 v78, v[80:83] offset:36000
    ds_write_b128 v78, v[80:83] offset:43200
    ds_write_b128 v78, v[80:83] offset:50400
    ds_write_b128 v78, v[80:83] offset:57600
    ds_write_b128 v79, v[80:83] offset:0
    ds_write_b128 v79, v[80:83] offset:7200
    ds_write_b128 v79, v[80:83] offset:14400
    ds_write_b128 v79, v[80:83] offset:21600
    v_cmp_gt_u32 vcc, 268, v177
    s_nop 0
    s_cbranch_vccz K2_NOCL
    s_mov_b64 exec, vcc
    ds_write_b128 v79, v[80:83] offset:28800
K2_NOCL:
    s_mov_b64 exec, -1
    s_cmp_lg_u32 s20, 7
    s_cbranch_scc1 K2_NOH
    v_mov_b32 v76, 0
    v_mov_b32 v77, -1
    v_lshlrev_b32 v78, 2, v176
    v_add_u32 v78, 163424, v78
    s_mov_b64 exec, 0x1ff
    ds_write_b32 v78, v76 offset:192
    s_mov_b64 exec, 0xff
    ds_write_b32 v78, v77 offset:256
    s_mov_b64 exec, -1
    s_cmp_lg_u32 s24, 0
    s_cbranch_scc1 K2_NOH
    s_mov_b32 exec_hi, 0xffff
    ds_write_b32 v78, v76
    s_mov_b64 exec, 0x3f
    ds_write_b32 v78, v76 offset:228
    s_mov_b64 exec, -1
K2_NOH:
    s_waitcnt lgkmcnt(0)
    s_barrier
    s_branch K2_CELLS
K2_LD_GEN:
    s_mov_b64 exec, s[42:43]
    s_cbranch_execz K2_LD_DONE
    buffer_load_dwordx4 v[4:7], v182, s[8:11], 0 offen sc1
    s_mov_b64 exec, s[44:45]
    s_cbranch_execz K2_LD_DONE
    buffer_load_dwordx4 v[8:11], v183, s[8:11], 0 offen sc1
    s_mov_b64 exec, s[46:47]
    s_cbranch_execz K2_LD_DONE
    buffer_load_dwordx4 v[12:15], v184, s[8:11], 0 offen sc1
    s_mov_b64 exec, s[48:49]
    s_cbranch_execz K2_LD_DONE
    buffer_load_dwordx4 v[16:19], v181, s[8:11], 0 offen offset:128 sc1
    s_mov_b64 exec, s[50:51]
    s_cbranch_execz K2_LD_DONE
    buffer_load_dwordx4 v[20:23], v181, s[8:11], 0 offen offset:160 sc1
    s_mov_b64 exec, s[90:91]
    s_cbranch_execz K2_LD_DONE
    buffer_load_dwordx4 v[24:27], v181, s[8:11], 0 offen offset:192 sc1
    s_mov_b64 exec, s[92:93]
    s_cbranch_execz K2_LD_DONE
    buffer_load_dwordx4 v[28:31], v181, s[8:11], 0 offen offset:224 sc1
    s_mov_b64 exec, s[94:95]
    s_cbranch_execz K2_LD_DONE
    buffer_load_dwordx4 v[32:35], v181, s[8:11], 0 offen offset:256 sc1
    s_mov_b64 exec, s[96:97]
    s_cbranch_execz K2_LD_DONE
    buffer_load_dwordx4 v[36:39], v181, s[8:11], 0 offen offset:288 sc1
    s_branch K2_LD_DONE
K2_FLGLD:
    buffer_load_dwordx4 v[84:87], v72, s[8:11], s64 offen sc1
    s_mov_b32 s62, 0
    s_branch K2_FLGL2
K2_FLGCK:
    s_cmp_lg_u32 s24, 0
    s_cbranch_scc1 K2_FLGOK
    s_waitcnt vmcnt(0)
K2_FLGW:
    v_xor_b32 v84, s2, v84
    v_xor_b32 v85, s2, v85
    v_xor_b32 v86, s2, v86
    v_xor_b32 v87, s2, v87
    v_or3_b32 v84, v84, v85, v86
    v_or_b32 v84, v84, v87
    v_cmp_ne_u32 vcc, 0, v84
    s_nop 0
    s_and_b32 vcc_hi, vcc_hi, 0x3ffff
    s_cmp_eq_u64 vcc, 0
    s_cbranch_scc1 K2_FLGOK
    s_sub_u32 s60, s60, 1
    s_cbranch_scc1 K2_END
    buffer_load_dwordx4 v[84:87], v72, s[8:11], s64 offen sc1
    s_waitcnt vmcnt(0)
    s_branch K2_FLGW
K2_RT0:
    s_sub_u32 s60, s60, 1
    s_cbranch_scc1 K2_END
    buffer_load_dwordx4 v[0:3], v181, s[8:11], 0 offen offset:0 sc1
    s_waitcnt vmcnt(0)
    s_branch K2_CK0
K2_RT1:
    s_sub_u32 s60, s60, 1
    s_cbranch_scc1 K2_END
    buffer_load_dwordx4 v[4:7], v182, s[8:11], 0 offen sc1
    s_waitcnt vmcnt(0)
    s_branch K2_CK1
K2_RT2:
    s_sub_u32 s60, s60, 1
    s_cbranch_scc1 K2_END
    buffer_load_dwordx4 v[8:11], v183, s[8:11], 0 offen sc1
    s_waitcnt vmcnt(0)
    s_branch K2_CK2
K2_RT3:
    s_sub_u32 s60, s60, 1
    s_cbranch_scc1 K2_END
    buffer_load_dwordx4 v[12:15], v184, s[8:11], 0 offen sc1
    s_waitcnt vmcnt(0)
    s_branch K2_CK3
K2_RT4:
    s_sub_u32 s60, s60, 1
    s_cbranch_scc1 K2_END
    buffer_load_dwordx4 v[16:19], v181, s[8:11], 0 offen offset:128 sc1
    s_waitcnt vmcnt(0)
    s_branch K2_CK4
K2_RT5:
    s_sub_u32 s60, s60, 1
    s_cbranch_scc1 K2_END
    buffer_load_dwordx4 v[20:23], v181, s[8:11], 0 offen offset:160 sc1
    s_waitcnt vmcnt(0)
    s_branch K2_CK5
K2_RT6:
    s_sub_u32 s60, s60, 1
    s_cbranch_scc1 K2_END
    buffer_load_dwordx4 v[24:27], v181, s[8:11], 0 offen offset:192 sc1
    s_waitcnt vmcnt(0)
    s_branch K2_CK6
K2_RT7:
    s_sub_u32 s60, s60, 1
    s_cbranch_scc1 K2_END
    buffer_load_dwordx4 v[28:31], v181, s[8:11], 0 offen offset:224 sc1
    s_waitcnt vmcnt(0)
    s_branch K2_CK7
K2_RT8:
    s_sub_u32 s60, s60, 1
    s_cbranch_scc1 K2_END
    buffer_load_dwordx4 v[32:35], v181, s[8:11], 0 offen offset:256 sc1
    s_waitcnt vmcnt(0)
    s_branch K2_CK8
K2_RT9:
    s_sub_u32 s60, s60, 1
    s_cbranch_scc1 K2_END
    buffer_load_dwordx4 v[36:39], v181, s[8:11], 0 offen offset:288 sc1
    s_waitcnt vmcnt(0)
    s_branch K2_CK9
K2_RK_LOAD:
    s_waitcnt vmcnt(0)
    s_mov_b64 exec, s[40:41]
    s_cbranch_execz K2_RK_B
    v_lshrrev_b32 v50, 24, v3
    buffer_load_dword v40, v179, s[8:11], s66 offen offset:0
    v_mad_u32_u24 v50, v50, s58, v202
    v_and_b32 v3, 0xffffff, v3
    s_mov_b64 exec, s[42:43]
    s_cbranch_execz K2_RK_B
    v_lshrrev_b32 v51, 24, v7
    buffer_load_dword v41, v185, s[8:11], s66 offen
    v_mad_u32_u24 v51, v51, s58, v202
    v_and_b32 v7, 0xffffff, v7
    s_mov_b64 exec, s[44:45]
    s_cbranch_execz K2_RK_B
    v_lshrrev_b32 v52, 24, v11
    buffer_load_dword v42, v186, s[8:11], s66 offen
    v_mad_u32_u24 v52, v52, s58, v202
    v_and_b32 v11, 0xffffff, v11
    s_mov_b64 exec, s[46:47]
    s_cbranch_execz K2_RK_B
    v_lshrrev_b32 v53, 24, v15
    buffer_load_dword v43, v187, s[8:11], s66 offen
    v_mad_u32_u24 v53, v53, s58, v202
    v_and_b32 v15, 0xffffff, v15
    s_mov_b64 exec, s[48:49]
    s_cbranch_execz K2_RK_B
    v_lshrrev_b32 v54, 24, v19
    buffer_load_dword v44, v179, s[8:11], s66 offen offset:32
    v_mad_u32_u24 v54, v54, s58, v202
    v_and_b32 v19, 0xffffff, v19
    s_mov_b64 exec, s[50:51]
    s_cbranch_execz K2_RK_B
    v_lshrrev_b32 v55, 24, v23
    buffer_load_dword v45, v179, s[8:11], s66 offen offset:40
    v_mad_u32_u24 v55, v55, s58, v202
    v_and_b32 v23, 0xffffff, v23
    s_mov_b64 exec, s[90:91]
    s_cbranch_execz K2_RK_B
    v_lshrrev_b32 v56, 24, v27
    buffer_load_dword v46, v179, s[8:11], s66 offen offset:48
    v_mad_u32_u24 v56, v56, s58, v202
    v_and_b32 v27, 0xffffff, v27
    s_mov_b64 exec, s[92:93]
    s_cbranch_execz K2_RK_B
    v_lshrrev_b32 v57, 24, v31
    buffer_load_dword v47, v179, s[8:11], s66 offen offset:56
    v_mad_u32_u24 v57, v57, s58, v202
    v_and_b32 v31, 0xffffff, v31
    s_mov_b64 exec, s[94:95]
    s_cbranch_execz K2_RK_B
    v_lshrrev_b32 v58, 24, v35
    buffer_load_dword v48, v179, s[8:11], s66 offen offset:64
    v_mad_u32_u24 v58, v58, s58, v202
    v_and_b32 v35, 0xffffff, v35
    s_mov_b64 exec, s[96:97]
    s_cbranch_execz K2_RK_B
    v_lshrrev_b32 v59, 24, v39
    buffer_load_dword v49, v179, s[8:11], s66 offen offset:72
    v_mad_u32_u24 v59, v59, s58, v202
    v_and_b32 v39, 0xffffff, v39
K2_RK_B:
    s_mov_b64 exec, -1
    s_mul_i32 s62, s24, 48
    s_waitcnt vmcnt(0)
    v_subrev_u32 v40, s62, v40
    v_subrev_u32 v41, s62, v41
    v_subrev_u32 v42, s62, v42
    v_subrev_u32 v43, s62, v43
    v_subrev_u32 v44, s62, v44
    v_subrev_u32 v45, s62, v45
    v_subrev_u32 v46, s62, v46
    v_subrev_u32 v47, s62, v47
    v_subrev_u32 v48, s62, v48
    v_subrev_u32 v49, s62, v49
    s_branch K2_RK_DONE
K2_PAD_OV:
    s_branch K2_HOP
K2_OV:
    s_cmp_lg_u32 s24, 0
    s_cbranch_scc1 K2_OB
    s_cmp_eq_u32 s22, 39
    s_cselect_b32 s63, 5, 2
    s_flbit_i32_b32 s56, s58
    s_sub_u32 s56, 31, s56
    s_bitset0_b32 s58, s56
    s_sub_u32 s57, s56, 1
    v_mov_b32 v198, 0
    v_mov_b32 v206, s57
K2_OVL:
    s_mov_b64 exec, -1
    s_ff1_i32_b32 s61, s58
    s_bitset0_b32 s58, s61
    v_readfirstlane_b32 s62, v206
    s_nop 0
    s_sub_u32 s62, s62, s61
    s_lshl_b32 s61, s62, 1
    v_cmp_lt_i32 vcc, s61, v180
    s_cmp_eq_u32 s62, 1
    s_cselect_b64 vcc, s[42:43], vcc
    s_cmp_eq_u32 s62, 2
    s_cselect_b64 vcc, s[44:45], vcc
    s_cmp_eq_u32 s62, 3
    s_cselect_b64 vcc, s[46:47], vcc
    s_lshl_b32 s61, s62, 2
    s_set_gpr_idx_on s62, gpr_idx(SRC0)
    s_nop 0
    v_mov_b32 v204, v40
    v_mov_b32 v205, v50
    s_set_gpr_idx_idx s61
    s_nop 0
    v_mov_b32 v208, v0
    v_mov_b32 v209, v1
    v_mov_b32 v210, v2
    v_mov_b32 v211, v3
    s_set_gpr_idx_off
    s_mov_b64 exec, vcc
    v_subrev_u32 v192, 48, v204
    v_mov_b32 v197, 163656
    v_cmp_gt_u32 vcc, 16, v192
    s_mov_b32 s62, 0
    s_mov_b64 exec, vcc
    s_cbranch_execz K2_OVN
K2_OP:
    ds_cmpst_rtn_b32 v200, v197, v198, v205
    s_cmp_ge_u32 s62, 2
    s_cselect_b32 s65, 2400, 0
    s_cselect_b32 s26, 32, 0
    s_sub_u32 s65, 161536, s65
    s_lshl_b32 s61, s62, 4
    s_sub_u32 s61, s61, s26
    v_mov_b32 v199, s65
    v_add_u32 v203, s61, v192
    s_waitcnt lgkmcnt(0)
    v_cmp_eq_u32 vcc, 0, v200
    v_cmp_eq_u32 s[56:57], v200, v205
    s_nop 0
    s_or_b64 vcc, vcc, s[56:57]
    s_andn2_b64 s[56:57], exec, vcc
    s_mov_b64 exec, vcc
    v_lshl_add_u32 v194, v203, 5, v199
    v_lshl_add_u32 v195, v203, 2, v199
    v_lshrrev_b32 v193, 3, v203
    v_mad_i32_i24 v196, v193, -16, v195
    v_and_b32 v193, 1, v193
    v_mad_i32_i24 v196, v193, -14, v196
    ds_write_b32 v194, v211 offset:864
    ds_write_b16 v195, v208 offset:194
    ds_write_b16_d16_hi v195, v208 offset:386
    ds_write_b16_d16_hi v195, v209 offset:578
    ds_write_b16 v196, v210 offset:768
    s_mov_b64 exec, s[56:57]
    s_cbranch_execz K2_OVN
    v_add_u32 v197, 4, v197
    s_add_u32 s62, s62, 1
    s_cmp_lt_u32 s62, s63
    s_cbranch_scc1 K2_OP
K2_OVN:
    s_cmp_lg_u32 s58, 0
    s_cbranch_scc1 K2_OVL
    s_mov_b64 exec, -1
    s_branch K2_OB
K2_BIG:
    s_cmp_lg_u32 s24, 0
    s_cbranch_scc1 K2_TOK
    s_mov_b64 s[62:63], vcc
    s_bcnt1_i32_b64 s60, vcc
    s_cmp_eq_u32 s22, 39
    s_cselect_b32 s61, 5, 2
    s_cmp_gt_u32 s60, s61
    s_cbranch_scc1 K2_SLOW
    v_cmp_lt_u32 vcc, 64, v193
    s_nop 0
    s_cbranch_vccnz K2_SLOW
    v_mov_b32 v197, 163656
    ds_read_b32 v203, v197
    ds_read_b32 v204, v197 offset:4
    ds_read_b32 v205, v197 offset:8
    ds_read_b32 v206, v197 offset:12
    ds_read_b32 v207, v197 offset:16
    v_and_b32 v197, 0x3ffff, v195
    s_movk_i32 s26, 64
    s_waitcnt lgkmcnt(0)
    v_cmp_eq_u32 vcc, v204, v197
    v_mov_b32 v194, 134217728
    s_nop 0
    v_cndmask_b32 v198, v198, v194, vcc
    v_cmp_eq_u32 vcc, v205, v197
    v_mov_b32 v194, 268435456
    s_nop 0
    v_cndmask_b32 v198, v198, v194, vcc
    v_cmp_eq_u32 vcc, v206, v197
    v_mov_b32 v194, 402653184
    s_nop 0
    v_cndmask_b32 v198, v198, v194, vcc
    v_cmp_eq_u32 vcc, v207, v197
    v_mov_b32 v194, 536870912
    s_nop 0
    v_cndmask_b32 v198, v198, v194, vcc
    s_branch K2_TOK
K2_SLOW:
    v_mov_b32 v197, v193
    s_nop 1
    v_max_u32_dpp v197, v197, v197 row_shr:1 row_mask:0xf bank_mask:0xf bound_ctrl:0
    s_nop 1
    v_max_u32_dpp v197, v197, v197 row_shr:2 row_mask:0xf bank_mask:0xf bound_ctrl:0
    s_nop 1
    v_max_u32_dpp v197, v197, v197 row_shr:4 row_mask:0xf bank_mask:0xf bound_ctrl:0
    s_nop 1
    v_max_u32_dpp v197, v197, v197 row_shr:8 row_mask:0xf bank_mask:0xf bound_ctrl:0
    s_nop 1
    v_max_u32_dpp v197, v197, v197 row_bcast:15 row_mask:0xa bank_mask:0xf
    s_nop 1
    v_max_u32_dpp v197, v197, v197 row_bcast:31 row_mask:0xc bank_mask:0xf
    s_nop 0
    v_readlane_b32 s25, v197, 63
    s_nop 0
    s_add_u32 s25, s25, 47
    s_mul_i32 s25, s25, 43691
    s_lshr_b32 s25, s25, 21
    s_mov_b64 exec, s[40:41]
    s_cbranch_execz K2_SV_DONE
    buffer_store_dword v40, v179, s[8:11], s66 offen offset:0
    s_mov_b64 exec, s[42:43]
    s_cbranch_execz K2_SV_DONE
    buffer_store_dword v41, v185, s[8:11], s66 offen
    s_mov_b64 exec, s[44:45]
    s_cbranch_execz K2_SV_DONE
    buffer_store_dword v42, v186, s[8:11], s66 offen
    s_mov_b64 exec, s[46:47]
    s_cbranch_execz K2_SV_DONE
    buffer_store_dword v43, v187, s[8:11], s66 offen
    s_mov_b64 exec, s[48:49]
    s_cbranch_execz K2_SV_DONE
    buffer_store_dword v44, v179, s[8:11], s66 offen offset:32
    s_mov_b64 exec, s[50:51]
    s_cbranch_execz K2_SV_DONE
    buffer_store_dword v45, v179, s[8:11], s66 offen offset:40
    s_mov_b64 exec, s[90:91]
    s_cbranch_execz K2_SV_DONE
    buffer_store_dword v46, v179, s[8:11], s66 offen offset:48
    s_mov_b64 exec, s[92:93]
    s_cbranch_execz K2_SV_DONE
    buffer_store_dword v47, v179, s[8:11], s66 offen offset:56
    s_mov_b64 exec, s[94:95]
    s_cbranch_execz K2_SV_DONE
    buffer_store_dword v48, v179, s[8:11], s66 offen offset:64
    s_mov_b64 exec, s[96:97]
    s_cbranch_execz K2_SV_DONE
    buffer_store_dword v49, v179, s[8:11], s66 offen offset:72
K2_SV_DONE:
    s_mov_b64 exec, -1
    s_branch K2_TOK
K2_rare_1:
    s_cmp_eq_u32 s33, 4
    s_cbranch_scc1 K2_four_3
    s_mov_b32 s49, s48
    s_mov_b32 s51, s48
    s_add_u32 s45, s44, 256
    s_add_u32 s46, s44, 512
    s_add_u32 s47, s44, 768
    s_branch K2_back_2
K2_four_3:
    s_add_u32 s50, s48, 64
    s_lshr_b32 s51, s3, 27
    s_mov_b32 s66, 161536
    s_cmp_ge_u32 s51, 2
    s_cselect_b32 s66, 159072, s66
    s_mul_i32 s51, s51, 32
    s_add_u32 s51, s51, s66
    s_mov_b32 s46, s44
    s_mov_b32 s47, s44
    s_branch K2_back_2
K2_a4_5:
    s_lshr_b32 s65, s3, 27
    s_mov_b32 s66, 161536
    s_cmp_ge_u32 s65, 2
    s_cselect_b32 s66, 158112, s66
    s_mul_i32 s65, s65, 512
    s_add_u32 s65, s65, s66
    v_add_u32 v232, s65, v230
    ds_read_b32 v232, v232
    s_add_u32 m0, s65, 864
    s_waitcnt lgkmcnt(0)
    v_or_b32 v232, v232, v231
    buffer_load_dwordx4 v232, s[16:19], 0 offen  lds
    s_branch K2_b4_7
K2_rare_14:
    s_cmp_eq_u32 s33, 4
    s_cbranch_scc1 K2_four_16
    s_mov_b32 s49, s48
    s_mov_b32 s51, s48
    s_add_u32 s45, s44, 256
    s_add_u32 s46, s44, 512
    s_add_u32 s47, s44, 768
    s_branch K2_back_15
K2_four_16:
    s_add_u32 s50, s48, 64
    s_lshr_b32 s51, s3, 27
    s_mov_b32 s66, 161536
    s_cmp_ge_u32 s51, 2
    s_cselect_b32 s66, 159072, s66
    s_mul_i32 s51, s51, 32
    s_add_u32 s51, s51, s66
    s_mov_b32 s46, s44
    s_mov_b32 s47, s44
    s_branch K2_back_15
K2_a4_18:
    s_lshr_b32 s65, s3, 27
    s_mov_b32 s66, 161536
    s_cmp_ge_u32 s65, 2
    s_cselect_b32 s66, 158112, s66
    s_mul_i32 s65, s65, 512
    s_add_u32 s65, s65, s66
    v_add_u32 v232, s65, v230
    ds_read_b32 v232, v232
    s_add_u32 m0, s65, 864
    s_waitcnt lgkmcnt(0)
    v_or_b32 v232, v232, v231
    buffer_load_dwordx4 v232, s[16:19], 0 offen  lds
    s_branch K2_b4_20
K2_rare_27:
    s_cmp_eq_u32 s33, 4
    s_cbranch_scc1 K2_four_29
    s_mov_b32 s49, s48
    s_mov_b32 s51, s48
    s_add_u32 s45, s44, 256
    s_add_u32 s46, s44, 512
    s_add_u32 s47, s44, 768
    s_branch K2_back_28
K2_four_29:
    s_add_u32 s50, s48, 64
    s_lshr_b32 s51, s3, 27
    s_mov_b32 s66, 161536
    s_cmp_ge_u32 s51, 2
    s_cselect_b32 s66, 159072, s66
    s_mul_i32 s51, s51, 32
    s_add_u32 s51, s51, s66
    s_mov_b32 s46, s44
    s_mov_b32 s47, s44
    s_branch K2_back_28
K2_a4_31:
    s_lshr_b32 s65, s3, 27
    s_mov_b32 s66, 161536
    s_cmp_ge_u32 s65, 2
    s_cselect_b32 s66, 158112, s66
    s_mul_i32 s65, s65, 512
    s_add_u32 s65, s65, s66
    v_add_u32 v232, s65, v230
    ds_read_b32 v232, v232
    s_add_u32 m0, s65, 864
    s_waitcnt lgkmcnt(0)
    v_or_b32 v232, v232, v231
    buffer_load_dwordx4 v232, s[16:19], 0 offen  lds
    s_branch K2_b4_33
K2_rare_38:
    s_cmp_eq_u32 s33, 4
    s_cbranch_scc1 K2_four_40
    s_mov_b32 s49, s48
    s_mov_b32 s51, s48
    s_add_u32 s45, s44, 256
    s_add_u32 s46, s44, 512
    s_add_u32 s47, s44, 768
    s_branch K2_back_39
K2_four_40:
    s_add_u32 s50, s48, 64
    s_lshr_b32 s51, s3, 27
    s_mov_b32 s66, 161536
    s_cmp_ge_u32 s51, 2
    s_cselect_b32 s66, 159072, s66
    s_mul_i32 s51, s51, 32
    s_add_u32 s51, s51, s66
    s_mov_b32 s46, s44
    s_mov_b32 s47, s44
    s_branch K2_back_39
K2_rare_45:
    s_cmp_eq_u32 s33, 4
    s_cbranch_scc1 K2_four_47
    s_mov_b32 s49, s48
    s_mov_b32 s51, s48
    s_add_u32 s45, s44, 256
    s_add_u32 s46, s44, 512
    s_add_u32 s47, s44, 768
    s_branch K2_back_46
K2_four_47:
    s_add_u32 s50, s48, 64
    s_lshr_b32 s51, s3, 27
    s_mov_b32 s66, 161536
    s_cmp_ge_u32 s51, 2
    s_cselect_b32 s66, 159072, s66
    s_mul_i32 s51, s51, 32
    s_add_u32 s51, s51, s66
    s_mov_b32 s46, s44
    s_mov_b32 s47, s44
    s_branch K2_back_46
K2_U10:
    s_setprio 1
    s_add_u32 s38, s38, 1
    v_mov_b32 v254, s52
    v_mov_b32 v255, s38
    s_lshl_b32 s58, s38, 3
    s_add_u32 s58, s58, s20
    s_mov_b64 exec, 1
    ds_write_b32 v254, v255
    s_mov_b64 exec, -1
    s_cmp_lt_u32 s58, s22
    s_cbranch_scc0 K2_dyn_48
K2_back_49:
    s_waitcnt lgkmcnt(7)
    v_lshlrev_b32 v40, 16, v0
    v_and_b32 v41, 0xffff0000, v0
    v_lshlrev_b32 v42, 16, v1
    v_and_b32 v43, 0xffff0000, v1
    v_lshlrev_b32 v44, 16, v2
    v_and_b32 v45, 0xffff0000, v2
    v_lshlrev_b32 v46, 16, v3
    v_and_b32 v47, 0xffff0000, v3
    v_mul_f32 v4, v40, v4
    v_mul_f32 v5, v41, v5
    v_mul_f32 v6, v42, v6
    v_mul_f32 v7, v43, v7
    v_mul_f32 v8, v44, v8
    v_mul_f32 v9, v45, v9
    v_mul_f32 v10, v46, v10
    v_mul_f32 v11, v47, v11
    v_cvt_pk_bf16_f32 v64, v4, v5
    v_cvt_pk_bf16_f32 v65, v6, v7
    v_cvt_pk_bf16_f32 v66, v8, v9
    v_cvt_pk_bf16_f32 v67, v10, v11
    v_mul_f32 v12, v40, v12
    v_mul_f32 v13, v41, v13
    v_mul_f32 v14, v42, v14
    v_mul_f32 v15, v43, v15
    v_mul_f32 v16, v44, v16
    v_mul_f32 v17, v45, v17
    v_mul_f32 v18, v46, v18
    v_mul_f32 v19, v47, v19
    v_cvt_pk_bf16_f32 v68, v12, v13
    v_cvt_pk_bf16_f32 v69, v14, v15
    v_cvt_pk_bf16_f32 v70, v16, v17
    v_cvt_pk_bf16_f32 v71, v18, v19
    v_readlane_b32 s3, v253, s58
    s_lshl_b32 s44, s34, 7
    s_lshl_b32 s60, s58, 5
    s_and_b32 s48, s3, 0x3ffff
    s_bfe_u32 s33, s3, 0x30012
    s_sub_u32 s60, s60, s48
    s_and_b32 s60, s60, 0xff
    s_add_u32 s60, s60, s48
    s_mul_i32 s35, s38, 6
    s_cmp_eq_u32 s34, 0
    s_cselect_b32 s35, s35, s60
    s_mov_b32 s45, s44
    s_add_u32 s47, s44, 256
    s_add_u32 s49, s48, 32
    s_add_u32 s60, s48, 64
    s_cmp_eq_u32 s33, 3
    s_cselect_b32 s46, s44, s47
    s_cselect_b32 s50, s60, s48
    s_cselect_b32 s51, s48, s49
    s_sub_u32 s60, s33, 2
    s_cmp_lt_u32 s60, 2
    s_cbranch_scc0 K2_rare_54
K2_back_55:
    v_add_u32 v233, s48, v230
    ds_read_b32 v232, v233
    ds_read_b32 v233, v233 offset:1024
    v_add_u32 v222, s48, v251
    ds_read_b32 v222, v222
    v_add_u32 v224, s49, v251
    ds_read_b32 v224, v224
    v_add_u32 v226, s50, v251
    ds_read_b32 v226, v226
    v_add_u32 v228, s51, v251
    ds_read_b32 v228, v228
    s_waitcnt lgkmcnt(4)
    v_or_b32 v232, v232, v231
    v_or_b32 v233, v233, v231
    s_cmp_lg_u32 s34, 0
    s_cbranch_scc1 K2_dum_57
    s_add_u32 m0, s48, 864
    s_add_u32 s65, s48, 1888
    buffer_load_dwordx4 v232, s[16:19], 0 offen  lds
    s_mov_b32 m0, s65
    s_mov_b32 exec_hi, 0
    buffer_load_dwordx4 v233, s[16:19], 0 offen  lds
    s_cmp_eq_u32 s33, 4
    s_cbranch_scc1 K2_a4_58
K2_b4_60:
    s_mov_b32 exec_hi, -1
K2_back_59:
    s_waitcnt lgkmcnt(3)
    v_mad_u32_u16 v223, v222, s39, v248 op_sel:[1,0,0,0]
    v_mad_u32_u16 v222, v222, s39, v248
    s_waitcnt lgkmcnt(2)
    v_mad_u32_u16 v225, v224, s39, v248 op_sel:[1,0,0,0]
    v_mad_u32_u16 v224, v224, s39, v248
    s_waitcnt lgkmcnt(1)
    v_mad_u32_u16 v227, v226, s39, v248 op_sel:[1,0,0,0]
    v_mad_u32_u16 v226, v226, s39, v248
    s_waitcnt lgkmcnt(0)
    v_mad_u32_u16 v229, v228, s39, v248 op_sel:[1,0,0,0]
    v_mad_u32_u16 v228, v228, s39, v248
    s_waitcnt vmcnt(6)
    v_mfma_f32_32x32x16_bf16 v[0:15], v[64:67], v[176:179], 0
    ds_read_b64_tr_b16 v[184:185], v246 offset:2048
    ds_read_b64_tr_b16 v[186:187], v246 offset:2560
    ds_read_b64_tr_b16 v[188:189], v247 offset:2048
    ds_read_b64_tr_b16 v[190:191], v247 offset:2560
    s_mov_b32 m0, s68
    v_mfma_f32_32x32x16_bf16 v[16:31], v[68:71], v[176:179], 0
    buffer_load_dwordx4 v222, s[4:7], s44 offen sc1 lds
    buffer_load_dwordx4 v223, s[72:75], s44 offen offset:1024 sc1 lds
    v_permlane32_swap_b32 v242, v236
    v_permlane32_swap_b32 v243, v237
    v_mfma_f32_32x32x16_bf16 v[32:47], v[64:67], v[180:183], 0
    v_permlane32_swap_b32 v244, v238
    v_permlane32_swap_b32 v245, v239
    v_permlane32_swap_b32 v240, v241
    v_add_f32 v242, v242, v236
    v_mfma_f32_32x32x16_bf16 v[48:63], v[68:71], v[180:183], 0
    s_setprio 0
    v_add_f32 v243, v243, v237
    v_add_f32 v244, v244, v238
    v_add_f32 v245, v245, v239
    v_add_f32 v240, -v240, -v241
    s_set_gpr_idx_on s32, gpr_idx(DST)
    s_nop 0
    v_cvt_pk_bf16_f32 v195, v242, v243
    v_cvt_pk_bf16_f32 v196, v244, v245
    v_cvt_pk_bf16_f32 v197, v240, v240
    s_set_gpr_idx_off
    v_mul_f32 v234, v0, v96
    v_mul_f32 v236, v8, v128
    v_fmac_f32 v234, v1, v97
    v_fmac_f32 v236, v9, v129
    v_fmac_f32 v234, v2, v98
    v_fmac_f32 v236, v10, v130
    v_fmac_f32 v234, v3, v99
    v_fmac_f32 v236, v11, v131
    v_fmac_f32 v234, v4, v100
    v_fmac_f32 v236, v12, v132
    v_fmac_f32 v234, v5, v101
    v_fmac_f32 v236, v13, v133
    v_fmac_f32 v234, v6, v102
    v_fmac_f32 v236, v14, v134
    v_fmac_f32 v234, v7, v103
    v_fmac_f32 v236, v15, v135
    v_mul_f32 v238, v16, v128
    v_mul_f32 v240, v24, v128
    v_fmac_f32 v238, v17, v129
    v_fmac_f32 v240, v25, v129
    v_fmac_f32 v238, v18, v130
    v_fmac_f32 v240, v26, v130
    v_fmac_f32 v238, v19, v131
    v_fmac_f32 v240, v27, v131
    v_fmac_f32 v238, v20, v132
    v_fmac_f32 v240, v28, v132
    v_fmac_f32 v238, v21, v133
    v_fmac_f32 v240, v29, v133
    v_fmac_f32 v238, v22, v134
    v_fmac_f32 v240, v30, v134
    v_fmac_f32 v238, v23, v135
    v_fmac_f32 v240, v31, v135
    v_mul_f32 v235, v32, v104
    v_mul_f32 v237, v40, v136
    v_fmac_f32 v235, v33, v105
    v_fmac_f32 v237, v41, v137
    v_fmac_f32 v235, v34, v106
    v_fmac_f32 v237, v42, v138
    v_fmac_f32 v235, v35, v107
    v_fmac_f32 v237, v43, v139
    v_fmac_f32 v235, v36, v108
    v_fmac_f32 v237, v44, v140
    v_fmac_f32 v235, v37, v109
    v_fmac_f32 v237, v45, v141
    v_fmac_f32 v235, v38, v110
    v_fmac_f32 v237, v46, v142
    v_fmac_f32 v235, v39, v111
    v_fmac_f32 v237, v47, v143
    v_mul_f32 v239, v48, v136
    v_mul_f32 v241, v56, v136
    v_fmac_f32 v239, v49, v137
    v_fmac_f32 v241, v57, v137
    v_fmac_f32 v239, v50, v138
    v_fmac_f32 v241, v58, v138
    v_fmac_f32 v239, v51, v139
    v_fmac_f32 v241, v59, v139
    v_fmac_f32 v239, v52, v140
    v_fmac_f32 v241, v60, v140
    v_fmac_f32 v239, v53, v141
    v_fmac_f32 v241, v61, v141
    v_fmac_f32 v239, v54, v142
    v_fmac_f32 v241, v62, v142
    v_fmac_f32 v239, v55, v143
    v_fmac_f32 v241, v63, v143
    s_setprio 1
    s_waitcnt vmcnt(6) lgkmcnt(0)
    v_mfma_f32_32x32x16_bf16 v[0:15], v[64:67], v[184:187], 0
    ds_read_b64_tr_b16 v[176:177], v246 offset:4096
    ds_read_b64_tr_b16 v[178:179], v246 offset:4608
    ds_read_b64_tr_b16 v[180:181], v247 offset:4096
    ds_read_b64_tr_b16 v[182:183], v247 offset:4608
    s_mov_b32 m0, s69
    v_mfma_f32_32x32x16_bf16 v[16:31], v[68:71], v[184:187], 0
    buffer_load_dwordx4 v224, s[4:7], s45 offen sc1 lds
    buffer_load_dwordx4 v225, s[72:75], s45 offen offset:1024 sc1 lds
    v_permlane32_swap_b32 v234, v236
    v_permlane32_swap_b32 v235, v237
    v_mfma_f32_32x32x16_bf16 v[32:47], v[64:67], v[188:191], 0
    v_permlane32_swap_b32 v240, v238
    v_permlane32_swap_b32 v241, v239
    v_add_f32 v234, v234, v236
    v_add_f32 v235, v235, v237
    v_add_f32 v240, v240, v238
    v_mfma_f32_32x32x16_bf16 v[48:63], v[68:71], v[188:191], 0
    s_setprio 0
    v_add_f32 v241, v241, v239
    s_set_gpr_idx_on s31, gpr_idx(DST)
    s_nop 0
    v_cvt_pk_bf16_f32 v192, v234, v235
    v_cvt_pk_bf16_f32 v193, v240, v241
    s_set_gpr_idx_off
    v_mul_f32 v234, v0, v144
    v_mul_f32 v236, v8, v112
    v_fmac_f32 v234, v1, v145
    v_fmac_f32 v236, v9, v113
    v_fmac_f32 v234, v2, v146
    v_fmac_f32 v236, v10, v114
    v_fmac_f32 v234, v3, v147
    v_fmac_f32 v236, v11, v115
    v_fmac_f32 v234, v4, v148
    v_fmac_f32 v236, v12, v116
    v_fmac_f32 v234, v5, v149
    v_fmac_f32 v236, v13, v117
    v_fmac_f32 v234, v6, v150
    v_fmac_f32 v236, v14, v118
    v_fmac_f32 v234, v7, v151
    v_fmac_f32 v236, v15, v119
    v_mul_f32 v238, v16, v160
    v_mul_f32 v240, v24, v160
    v_fmac_f32 v238, v17, v161
    v_fmac_f32 v240, v25, v161
    v_fmac_f32 v238, v18, v162
    v_fmac_f32 v240, v26, v162
    v_fmac_f32 v238, v19, v163
    v_fmac_f32 v240, v27, v163
    v_fmac_f32 v238, v20, v164
    v_fmac_f32 v240, v28, v164
    v_fmac_f32 v238, v21, v165
    v_fmac_f32 v240, v29, v165
    v_fmac_f32 v238, v22, v166
    v_fmac_f32 v240, v30, v166
    v_fmac_f32 v238, v23, v167
    v_fmac_f32 v240, v31, v167
    v_mul_f32 v235, v32, v152
    v_mul_f32 v237, v40, v120
    v_fmac_f32 v235, v33, v153
    v_fmac_f32 v237, v41, v121
    v_fmac_f32 v235, v34, v154
    v_fmac_f32 v237, v42, v122
    v_fmac_f32 v235, v35, v155
    v_fmac_f32 v237, v43, v123
    v_fmac_f32 v235, v36, v156
    v_fmac_f32 v237, v44, v124
    v_fmac_f32 v235, v37, v157
    v_fmac_f32 v237, v45, v125
    v_fmac_f32 v235, v38, v158
    v_fmac_f32 v237, v46, v126
    v_fmac_f32 v235, v39, v159
    v_fmac_f32 v237, v47, v127
    v_mul_f32 v239, v48, v168
    v_mul_f32 v241, v56, v168
    v_fmac_f32 v239, v49, v169
    v_fmac_f32 v241, v57, v169
    v_fmac_f32 v239, v50, v170
    v_fmac_f32 v241, v58, v170
    v_fmac_f32 v239, v51, v171
    v_fmac_f32 v241, v59, v171
    v_fmac_f32 v239, v52, v172
    v_fmac_f32 v241, v60, v172
    v_fmac_f32 v239, v53, v173
    v_fmac_f32 v241, v61, v173
    v_fmac_f32 v239, v54, v174
    v_fmac_f32 v241, v62, v174
    v_fmac_f32 v239, v55, v175
    v_fmac_f32 v241, v63, v175
    s_setprio 1
    s_waitcnt vmcnt(6) lgkmcnt(0)
    v_mfma_f32_32x32x16_bf16 v[0:15], v[64:67], v[176:179], 0
    ds_read_b64_tr_b16 v[184:185], v246 offset:6144
    ds_read_b64_tr_b16 v[186:187], v246 offset:6656
    ds_read_b64_tr_b16 v[188:189], v247 offset:6144
    ds_read_b64_tr_b16 v[190:191], v247 offset:6656
    s_mov_b32 m0, s70
    v_mfma_f32_32x32x16_bf16 v[16:31], v[68:71], v[176:179], 0
    buffer_load_dwordx4 v226, s[4:7], s46 offen sc1 lds
    buffer_load_dwordx4 v227, s[72:75], s46 offen offset:1024 sc1 lds
    s_sub_u32 s26, s48, s29
    s_mov_b32 s29, s48
    s_mov_b32 s30, s3
    s_cmp_eq_u32 s34, 0
    s_cselect_b32 s56, s33, 0
    v_mfma_f32_32x32x16_bf16 v[32:47], v[64:67], v[180:183], 0
    v_mfma_f32_32x32x16_bf16 v[48:63], v[68:71], v[180:183], 0
    s_setprio 0
    v_mul_f32 v242, v0, v144
    v_fma_f32 v238, v8, v160, -v238
    v_fmac_f32 v242, v1, v145
    v_fmac_f32 v238, v9, v161
    v_fmac_f32 v242, v2, v146
    v_fmac_f32 v238, v10, v162
    v_fmac_f32 v242, v3, v147
    v_fmac_f32 v238, v11, v163
    v_fmac_f32 v242, v4, v148
    v_fmac_f32 v238, v12, v164
    v_fmac_f32 v242, v5, v149
    v_fmac_f32 v238, v13, v165
    v_fmac_f32 v242, v6, v150
    v_fmac_f32 v238, v14, v166
    v_fmac_f32 v242, v7, v151
    v_fmac_f32 v238, v15, v167
    v_fmac_f32 v236, v16, v112
    v_mul_f32 v244, v24, v160
    v_fmac_f32 v236, v17, v113
    v_fmac_f32 v244, v25, v161
    v_fmac_f32 v236, v18, v114
    v_fmac_f32 v244, v26, v162
    v_fmac_f32 v236, v19, v115
    v_fmac_f32 v244, v27, v163
    v_fmac_f32 v236, v20, v116
    v_fmac_f32 v244, v28, v164
    v_fmac_f32 v236, v21, v117
    v_fmac_f32 v244, v29, v165
    v_fmac_f32 v236, v22, v118
    v_fmac_f32 v244, v30, v166
    v_fmac_f32 v236, v23, v119
    v_fmac_f32 v244, v31, v167
    v_mul_f32 v243, v32, v152
    v_fma_f32 v239, v40, v168, -v239
    v_fmac_f32 v243, v33, v153
    v_fmac_f32 v239, v41, v169
    v_fmac_f32 v243, v34, v154
    v_fmac_f32 v239, v42, v170
    v_fmac_f32 v243, v35, v155
    v_fmac_f32 v239, v43, v171
    v_fmac_f32 v243, v36, v156
    v_fmac_f32 v239, v44, v172
    v_fmac_f32 v243, v37, v157
    v_fmac_f32 v239, v45, v173
    v_fmac_f32 v243, v38, v158
    v_fmac_f32 v239, v46, v174
    v_fmac_f32 v243, v39, v159
    v_fmac_f32 v239, v47, v175
    v_fmac_f32 v237, v48, v120
    v_mul_f32 v245, v56, v168
    v_fmac_f32 v237, v49, v121
    v_fmac_f32 v245, v57, v169
    v_fmac_f32 v237, v50, v122
    v_fmac_f32 v245, v58, v170
    v_fmac_f32 v237, v51, v123
    v_fmac_f32 v245, v59, v171
    v_fmac_f32 v237, v52, v124
    v_fmac_f32 v245, v60, v172
    v_fmac_f32 v237, v53, v125
    v_fmac_f32 v245, v61, v173
    v_fmac_f32 v237, v54, v126
    v_fmac_f32 v245, v62, v174
    v_fmac_f32 v237, v55, v127
    v_fmac_f32 v245, v63, v175
    s_setprio 1
    s_waitcnt vmcnt(4) lgkmcnt(0)
    v_mfma_f32_32x32x16_bf16 v[0:15], v[64:67], v[184:187], 0
    ds_read_b64_tr_b16 v[176:177], v246 offset:0
    ds_read_b64_tr_b16 v[178:179], v246 offset:512
    ds_read_b64_tr_b16 v[180:181], v247 offset:0
    ds_read_b64_tr_b16 v[182:183], v247 offset:512
    s_mov_b32 m0, s71
    v_mfma_f32_32x32x16_bf16 v[16:31], v[68:71], v[184:187], 0
    buffer_load_dwordx4 v228, s[4:7], s47 offen sc1 lds
    buffer_load_dwordx4 v229, s[72:75], s47 offen offset:1024 sc1 lds
    v_permlane32_swap_b32 v242, v234
    v_permlane32_swap_b32 v243, v235
    v_add_f32 v242, v242, v234
    v_mfma_f32_32x32x16_bf16 v[32:47], v[64:67], v[188:191], 0
    v_add_f32 v243, v243, v235
    s_set_gpr_idx_on s31, gpr_idx(DST)
    s_nop 0
    v_cvt_pk_bf16_f32 v194, v242, v243
    s_set_gpr_idx_off
    s_mov_b32 s32, s31
    s_mov_b32 s31, s35
    v_mfma_f32_32x32x16_bf16 v[48:63], v[68:71], v[188:191], 0
    s_setprio 0
    v_mul_f32 v242, v0, v144
    v_fma_f32 v240, v8, v160, -v240
    v_fmac_f32 v242, v1, v145
    v_fmac_f32 v240, v9, v161
    v_fmac_f32 v242, v2, v146
    v_fmac_f32 v240, v10, v162
    v_fmac_f32 v242, v3, v147
    v_fmac_f32 v240, v11, v163
    v_fmac_f32 v242, v4, v148
    v_fmac_f32 v240, v12, v164
    v_fmac_f32 v242, v5, v149
    v_fmac_f32 v240, v13, v165
    v_fmac_f32 v242, v6, v150
    v_fmac_f32 v240, v14, v166
    v_fmac_f32 v242, v7, v151
    v_fmac_f32 v240, v15, v167
    v_add_u32 v249, s26, v249
    v_add_u32 v250, s26, v250
    v_fma_f32 v244, v16, v160, -v244
    v_fmac_f32 v236, v24, v112
    v_fmac_f32 v244, v17, v161
    v_fmac_f32 v236, v25, v113
    v_fmac_f32 v244, v18, v162
    v_fmac_f32 v236, v26, v114
    v_fmac_f32 v244, v19, v163
    v_fmac_f32 v236, v27, v115
    v_fmac_f32 v244, v20, v164
    v_fmac_f32 v236, v28, v116
    v_fmac_f32 v244, v21, v165
    v_fmac_f32 v236, v29, v117
    v_fmac_f32 v244, v22, v166
    v_fmac_f32 v236, v30, v118
    v_fmac_f32 v244, v23, v167
    v_fmac_f32 v236, v31, v119
    ds_read_b64_tr_b16 v[0:1], v249 offset:0
    ds_read_b64_tr_b16 v[2:3], v249 offset:128
    ds_read_b128 v[4:7], v250 offset:0
    ds_read_b128 v[8:11], v250 offset:16
    ds_read_b128 v[12:15], v250 offset:384
    ds_read_b128 v[16:19], v250 offset:400
    v_mul_f32 v243, v32, v152
    v_fma_f32 v241, v40, v168, -v241
    v_fmac_f32 v243, v33, v153
    v_fmac_f32 v241, v41, v169
    v_fmac_f32 v243, v34, v154
    v_fmac_f32 v241, v42, v170
    v_fmac_f32 v243, v35, v155
    v_fmac_f32 v241, v43, v171
    v_fmac_f32 v243, v36, v156
    v_fmac_f32 v241, v44, v172
    v_fmac_f32 v243, v37, v157
    v_fmac_f32 v241, v45, v173
    v_fmac_f32 v243, v38, v158
    v_fmac_f32 v241, v46, v174
    v_fmac_f32 v243, v39, v159
    v_fmac_f32 v241, v47, v175
    ds_read_b64_tr_b16 v[20:21], v249 offset:512
    ds_read_b64_tr_b16 v[22:23], v249 offset:640
    ds_read_b128 v[24:27], v250 offset:64
    ds_read_b128 v[28:31], v250 offset:80
    ds_read_b128 v[32:35], v250 offset:448
    ds_read_b128 v[36:39], v250 offset:464
    v_fma_f32 v245, v48, v168, -v245
    v_fmac_f32 v237, v56, v120
    v_fmac_f32 v245, v49, v169
    v_fmac_f32 v237, v57, v121
    v_fmac_f32 v245, v50, v170
    v_fmac_f32 v237, v58, v122
    v_fmac_f32 v245, v51, v171
    v_fmac_f32 v237, v59, v123
    v_fmac_f32 v245, v52, v172
    v_fmac_f32 v237, v60, v124
    v_fmac_f32 v245, v53, v173
    v_fmac_f32 v237, v61, v125
    v_fmac_f32 v245, v54, v174
    v_fmac_f32 v237, v62, v126
    v_fmac_f32 v245, v55, v175
    v_fmac_f32 v237, v63, v127
    s_cmp_eq_u32 s56, 2
    s_cbranch_scc1 K2_U20
    s_cmp_eq_u32 s56, 3
    s_cbranch_scc1 K2_U30
    s_branch K2_DSP0
K2_U40:
    s_setprio 1
    s_waitcnt lgkmcnt(6)
    v_lshlrev_b32 v40, 16, v0
    v_and_b32 v41, 0xffff0000, v0
    v_lshlrev_b32 v42, 16, v1
    v_and_b32 v43, 0xffff0000, v1
    v_lshlrev_b32 v44, 16, v2
    v_and_b32 v45, 0xffff0000, v2
    v_lshlrev_b32 v46, 16, v3
    v_and_b32 v47, 0xffff0000, v3
    v_mul_f32 v4, v40, v4
    v_mul_f32 v5, v41, v5
    v_mul_f32 v6, v42, v6
    v_mul_f32 v7, v43, v7
    v_mul_f32 v8, v44, v8
    v_mul_f32 v9, v45, v9
    v_mul_f32 v10, v46, v10
    v_mul_f32 v11, v47, v11
    v_cvt_pk_bf16_f32 v64, v4, v5
    v_cvt_pk_bf16_f32 v65, v6, v7
    v_cvt_pk_bf16_f32 v66, v8, v9
    v_cvt_pk_bf16_f32 v67, v10, v11
    v_mul_f32 v12, v40, v12
    v_mul_f32 v13, v41, v13
    v_mul_f32 v14, v42, v14
    v_mul_f32 v15, v43, v15
    v_mul_f32 v16, v44, v16
    v_mul_f32 v17, v45, v17
    v_mul_f32 v18, v46, v18
    v_mul_f32 v19, v47, v19
    v_cvt_pk_bf16_f32 v68, v12, v13
    v_cvt_pk_bf16_f32 v69, v14, v15
    v_cvt_pk_bf16_f32 v70, v16, v17
    v_cvt_pk_bf16_f32 v71, v18, v19
    ds_read_b64_tr_b16 v[0:1], v249 offset:1024
    ds_read_b64_tr_b16 v[2:3], v249 offset:1152
    ds_read_b128 v[4:7], v250 offset:128
    ds_read_b128 v[8:11], v250 offset:144
    ds_read_b128 v[12:15], v250 offset:512
    ds_read_b128 v[16:19], v250 offset:528
    s_waitcnt lgkmcnt(6)
    v_lshlrev_b32 v48, 16, v20
    v_and_b32 v49, 0xffff0000, v20
    v_lshlrev_b32 v50, 16, v21
    v_and_b32 v51, 0xffff0000, v21
    v_lshlrev_b32 v52, 16, v22
    v_and_b32 v53, 0xffff0000, v22
    v_lshlrev_b32 v54, 16, v23
    v_and_b32 v55, 0xffff0000, v23
    v_mul_f32 v24, v48, v24
    v_mul_f32 v25, v49, v25
    v_mul_f32 v26, v50, v26
    v_mul_f32 v27, v51, v27
    v_mul_f32 v28, v52, v28
    v_mul_f32 v29, v53, v29
    v_mul_f32 v30, v54, v30
    v_mul_f32 v31, v55, v31
    v_cvt_pk_bf16_f32 v72, v24, v25
    v_cvt_pk_bf16_f32 v73, v26, v27
    v_cvt_pk_bf16_f32 v74, v28, v29
    v_cvt_pk_bf16_f32 v75, v30, v31
    v_mul_f32 v32, v48, v32
    v_mul_f32 v33, v49, v33
    v_mul_f32 v34, v50, v34
    v_mul_f32 v35, v51, v35
    v_mul_f32 v36, v52, v36
    v_mul_f32 v37, v53, v37
    v_mul_f32 v38, v54, v38
    v_mul_f32 v39, v55, v39
    v_cvt_pk_bf16_f32 v76, v32, v33
    v_cvt_pk_bf16_f32 v77, v34, v35
    v_cvt_pk_bf16_f32 v78, v36, v37
    v_cvt_pk_bf16_f32 v79, v38, v39
    s_lshr_b32 s65, s30, 27
    s_mov_b32 s66, 161536
    s_cmp_ge_u32 s65, 2
    s_cselect_b32 s66, 158112, s66
    s_mul_i32 s65, s65, 512
    s_add_u32 s65, s65, s66
    s_sub_u32 s65, s65, s29
    v_add_u32 v56, s65, v249
    s_lshr_b32 s65, s30, 27
    s_mov_b32 s66, 161536
    s_cmp_ge_u32 s65, 2
    s_cselect_b32 s66, 159008, s66
    s_mul_i32 s65, s65, 64
    s_add_u32 s65, s65, s66
    s_sub_u32 s65, s65, s29
    v_add_u32 v57, s65, v250
    ds_read_b64_tr_b16 v[20:21], v56 offset:0
    ds_read_b64_tr_b16 v[22:23], v56 offset:128
    ds_read_b128 v[24:27], v57 offset:0
    ds_read_b128 v[28:31], v57 offset:16
    ds_read_b128 v[32:35], v57 offset:384
    ds_read_b128 v[36:39], v57 offset:400
    s_waitcnt lgkmcnt(10)
    v_lshlrev_b32 v40, 16, v0
    v_and_b32 v41, 0xffff0000, v0
    v_lshlrev_b32 v42, 16, v1
    v_and_b32 v43, 0xffff0000, v1
    v_lshlrev_b32 v44, 16, v2
    v_and_b32 v45, 0xffff0000, v2
    v_lshlrev_b32 v46, 16, v3
    v_and_b32 v47, 0xffff0000, v3
    s_waitcnt lgkmcnt(8)
    v_mul_f32 v4, v40, v4
    v_mul_f32 v5, v41, v5
    v_mul_f32 v6, v42, v6
    v_mul_f32 v7, v43, v7
    v_mul_f32 v8, v44, v8
    v_mul_f32 v9, v45, v9
    v_mul_f32 v10, v46, v10
    v_mul_f32 v11, v47, v11
    v_cvt_pk_bf16_f32 v80, v4, v5
    v_cvt_pk_bf16_f32 v81, v6, v7
    v_cvt_pk_bf16_f32 v82, v8, v9
    v_cvt_pk_bf16_f32 v83, v10, v11
    s_waitcnt lgkmcnt(6)
    v_mul_f32 v12, v40, v12
    v_mul_f32 v13, v41, v13
    v_mul_f32 v14, v42, v14
    v_mul_f32 v15, v43, v15
    v_mul_f32 v16, v44, v16
    v_mul_f32 v17, v45, v17
    v_mul_f32 v18, v46, v18
    v_mul_f32 v19, v47, v19
    v_cvt_pk_bf16_f32 v84, v12, v13
    v_cvt_pk_bf16_f32 v85, v14, v15
    v_cvt_pk_bf16_f32 v86, v16, v17
    v_cvt_pk_bf16_f32 v87, v18, v19
    s_waitcnt lgkmcnt(4)
    v_lshlrev_b32 v48, 16, v20
    v_and_b32 v49, 0xffff0000, v20
    v_lshlrev_b32 v50, 16, v21
    v_and_b32 v51, 0xffff0000, v21
    v_lshlrev_b32 v52, 16, v22
    v_and_b32 v53, 0xffff0000, v22
    v_lshlrev_b32 v54, 16, v23
    v_and_b32 v55, 0xffff0000, v23
    s_waitcnt lgkmcnt(2)
    v_mul_f32 v24, v48, v24
    v_mul_f32 v25, v49, v25
    v_mul_f32 v26, v50, v26
    v_mul_f32 v27, v51, v27
    v_mul_f32 v28, v52, v28
    v_mul_f32 v29, v53, v29
    v_mul_f32 v30, v54, v30
    v_mul_f32 v31, v55, v31
    v_cvt_pk_bf16_f32 v88, v24, v25
    v_cvt_pk_bf16_f32 v89, v26, v27
    v_cvt_pk_bf16_f32 v90, v28, v29
    v_cvt_pk_bf16_f32 v91, v30, v31
    s_waitcnt lgkmcnt(0)
    v_mul_f32 v32, v48, v32
    v_mul_f32 v33, v49, v33
    v_mul_f32 v34, v50, v34
    v_mul_f32 v35, v51, v35
    v_mul_f32 v36, v52, v36
    v_mul_f32 v37, v53, v37
    v_mul_f32 v38, v54, v38
    v_mul_f32 v39, v55, v39
    v_cvt_pk_bf16_f32 v92, v32, v33
    v_cvt_pk_bf16_f32 v93, v34, v35
    v_cvt_pk_bf16_f32 v94, v36, v37
    v_cvt_pk_bf16_f32 v95, v38, v39
    s_waitcnt vmcnt(4)
    v_mfma_f32_32x32x16_bf16 v[0:15], v[64:67], v[176:179], 0
    ds_read_b64_tr_b16 v[184:185], v246 offset:2048
    ds_read_b64_tr_b16 v[186:187], v246 offset:2560
    ds_read_b64_tr_b16 v[188:189], v247 offset:2048
    ds_read_b64_tr_b16 v[190:191], v247 offset:2560
    s_mov_b32 m0, s68
    v_mfma_f32_32x32x16_bf16 v[16:31], v[68:71], v[176:179], 0
    buffer_load_dwordx4 v222, s[4:7], s41 offen sc1 lds
    buffer_load_dwordx4 v223, s[72:75], s41 offen offset:1024 sc1 lds
    v_permlane32_swap_b32 v242, v236
    v_permlane32_swap_b32 v243, v237
    s_add_u32 s38, s38, 1
    v_mfma_f32_32x32x16_bf16 v[32:47], v[64:67], v[180:183], 0
    v_permlane32_swap_b32 v244, v238
    v_permlane32_swap_b32 v245, v239
    v_permlane32_swap_b32 v240, v241
    v_add_f32 v242, v242, v236
    v_mfma_f32_32x32x16_bf16 v[48:63], v[68:71], v[180:183], 0
    v_add_f32 v243, v243, v237
    v_add_f32 v244, v244, v238
    v_add_f32 v245, v245, v239
    v_add_f32 v240, -v240, -v241
    v_mov_b32 v254, s52
    v_mov_b32 v255, s38
    s_waitcnt vmcnt(4) lgkmcnt(0)
    v_mfma_f32_32x32x16_bf16 v[0:15], v[72:75], v[184:187], v[0:15]
    ds_read_b64_tr_b16 v[176:177], v246 offset:4096
    ds_read_b64_tr_b16 v[178:179], v246 offset:4608
    ds_read_b64_tr_b16 v[180:181], v247 offset:4096
    ds_read_b64_tr_b16 v[182:183], v247 offset:4608
    s_lshl_b32 s58, s38, 3
    s_add_u32 s58, s58, s20
    s_mov_b32 m0, s69
    v_mfma_f32_32x32x16_bf16 v[16:31], v[76:79], v[184:187], v[16:31]
    buffer_load_dwordx4 v224, s[4:7], s41 offen sc1 lds
    buffer_load_dwordx4 v225, s[72:75], s41 offen offset:1024 sc1 lds
    s_set_gpr_idx_on s32, gpr_idx(DST)
    s_nop 0
    v_cvt_pk_bf16_f32 v195, v242, v243
    v_cvt_pk_bf16_f32 v196, v244, v245
    v_cvt_pk_bf16_f32 v197, v240, v240
    s_set_gpr_idx_off
    s_mov_b64 exec, 1
    ds_write_b32 v254, v255
    s_mov_b64 exec, -1
    s_cmp_lt_u32 s58, s22
    s_cbranch_scc0 K2_dyn_61
K2_back_62:
    v_readlane_b32 s3, v253, s58
    s_lshl_b32 s44, s34, 7
    s_lshl_b32 s60, s58, 5
    s_and_b32 s48, s3, 0x3ffff
    s_bfe_u32 s33, s3, 0x30012
    s_sub_u32 s60, s60, s48
    s_and_b32 s60, s60, 0xff
    s_add_u32 s60, s60, s48
    s_mul_i32 s35, s38, 6
    s_cmp_eq_u32 s34, 0
    s_cselect_b32 s35, s35, s60
    s_mov_b32 s45, s44
    s_add_u32 s47, s44, 256
    s_add_u32 s49, s48, 32
    s_add_u32 s60, s48, 64
    s_cmp_eq_u32 s33, 3
    s_cselect_b32 s46, s44, s47
    s_cselect_b32 s50, s60, s48
    s_cselect_b32 s51, s48, s49
    s_sub_u32 s60, s33, 2
    s_cmp_lt_u32 s60, 2
    s_cbranch_scc0 K2_rare_67
K2_back_68:
    v_mfma_f32_32x32x16_bf16 v[32:47], v[72:75], v[188:191], v[32:47]
    v_add_u32 v233, s48, v230
    ds_read_b32 v232, v233
    ds_read_b32 v233, v233 offset:1024
    v_mfma_f32_32x32x16_bf16 v[48:63], v[76:79], v[188:191], v[48:63]
    s_waitcnt vmcnt(4) lgkmcnt(3)
    v_mfma_f32_32x32x16_bf16 v[0:15], v[80:83], v[176:179], v[0:15]
    ds_read_b64_tr_b16 v[184:185], v246 offset:6144
    ds_read_b64_tr_b16 v[186:187], v246 offset:6656
    ds_read_b64_tr_b16 v[188:189], v247 offset:6144
    ds_read_b64_tr_b16 v[190:191], v247 offset:6656
    s_mov_b32 m0, s70
    v_mfma_f32_32x32x16_bf16 v[16:31], v[84:87], v[176:179], v[16:31]
    buffer_load_dwordx4 v226, s[4:7], s41 offen sc1 lds
    buffer_load_dwordx4 v227, s[72:75], s41 offen offset:1024 sc1 lds
    v_mfma_f32_32x32x16_bf16 v[32:47], v[80:83], v[180:183], v[32:47]
    v_mfma_f32_32x32x16_bf16 v[48:63], v[84:87], v[180:183], v[48:63]
    s_waitcnt lgkmcnt(4)
    v_or_b32 v232, v232, v231
    v_or_b32 v233, v233, v231
    s_cmp_lg_u32 s34, 0
    s_cbranch_scc1 K2_dum_70
    s_add_u32 m0, s48, 864
    s_add_u32 s65, s48, 1888
    buffer_load_dwordx4 v232, s[16:19], 0 offen  lds
    s_mov_b32 m0, s65
    s_mov_b32 exec_hi, 0
    buffer_load_dwordx4 v233, s[16:19], 0 offen  lds
    s_cmp_eq_u32 s33, 4
    s_cbranch_scc1 K2_a4_71
K2_b4_73:
    s_mov_b32 exec_hi, -1
K2_back_72:
    s_waitcnt vmcnt(6) lgkmcnt(0)
    v_mfma_f32_32x32x16_bf16 v[0:15], v[88:91], v[184:187], v[0:15]
    ds_read_b64_tr_b16 v[176:177], v246 offset:0
    ds_read_b64_tr_b16 v[178:179], v246 offset:512
    ds_read_b64_tr_b16 v[180:181], v247 offset:0
    ds_read_b64_tr_b16 v[182:183], v247 offset:512
    s_mov_b32 m0, s71
    v_mfma_f32_32x32x16_bf16 v[16:31], v[92:95], v[184:187], v[16:31]
    buffer_load_dwordx4 v228, s[4:7], s41 offen sc1 lds
    buffer_load_dwordx4 v229, s[72:75], s41 offen offset:1024 sc1 lds
    v_mfma_f32_32x32x16_bf16 v[32:47], v[88:91], v[188:191], v[32:47]
    s_nop 2
    v_mul_f32 v234, v0, v96
    v_mul_f32 v236, v8, v128
    v_fmac_f32 v234, v1, v97
    v_fmac_f32 v236, v9, v129
    v_fmac_f32 v234, v2, v98
    v_fmac_f32 v236, v10, v130
    v_fmac_f32 v234, v3, v99
    v_mfma_f32_32x32x16_bf16 v[48:63], v[92:95], v[188:191], v[48:63]
    s_setprio 0
    v_fmac_f32 v236, v11, v131
    v_fmac_f32 v234, v4, v100
    v_fmac_f32 v236, v12, v132
    v_fmac_f32 v234, v5, v101
    v_fmac_f32 v236, v13, v133
    v_fmac_f32 v234, v6, v102
    v_fmac_f32 v236, v14, v134
    v_fmac_f32 v234, v7, v103
    v_fmac_f32 v236, v15, v135
    v_mul_f32 v238, v16, v128
    v_mul_f32 v240, v24, v128
    v_fmac_f32 v238, v17, v129
    v_fmac_f32 v240, v25, v129
    v_fmac_f32 v238, v18, v130
    v_fmac_f32 v240, v26, v130
    v_fmac_f32 v238, v19, v131
    v_fmac_f32 v240, v27, v131
    v_fmac_f32 v238, v20, v132
    v_fmac_f32 v240, v28, v132
    v_fmac_f32 v238, v21, v133
    v_fmac_f32 v240, v29, v133
    v_fmac_f32 v238, v22, v134
    v_fmac_f32 v240, v30, v134
    v_fmac_f32 v238, v23, v135
    v_fmac_f32 v240, v31, v135
    v_mul_f32 v235, v32, v104
    v_mul_f32 v237, v40, v136
    v_fmac_f32 v235, v33, v105
    v_fmac_f32 v237, v41, v137
    v_fmac_f32 v235, v34, v106
    v_fmac_f32 v237, v42, v138
    v_fmac_f32 v235, v35, v107
    v_fmac_f32 v237, v43, v139
    v_fmac_f32 v235, v36, v108
    v_fmac_f32 v237, v44, v140
    v_fmac_f32 v235, v37, v109
    v_fmac_f32 v237, v45, v141
    v_fmac_f32 v235, v38, v110
    v_fmac_f32 v237, v46, v142
    v_fmac_f32 v235, v39, v111
    v_fmac_f32 v237, v47, v143
    v_mul_f32 v239, v48, v136
    v_mul_f32 v241, v56, v136
    s_setprio 1
    s_waitcnt vmcnt(6) lgkmcnt(0)
    v_mfma_f32_32x32x16_bf16 v[0:15], v[64:67], v[176:179], 0
    ds_read_b64_tr_b16 v[184:185], v246 offset:2048
    ds_read_b64_tr_b16 v[186:187], v246 offset:2560
    ds_read_b64_tr_b16 v[188:189], v247 offset:2048
    ds_read_b64_tr_b16 v[190:191], v247 offset:2560
    v_fmac_f32 v239, v49, v137
    v_fmac_f32 v241, v57, v137
    s_mov_b32 m0, s68
    v_mfma_f32_32x32x16_bf16 v[16:31], v[68:71], v[176:179], 0
    buffer_load_dwordx4 v222, s[4:7], s42 offen sc1 lds
    buffer_load_dwordx4 v223, s[72:75], s42 offen offset:1024 sc1 lds
    v_fmac_f32 v239, v50, v138
    v_fmac_f32 v241, v58, v138
    v_fmac_f32 v239, v51, v139
    v_fmac_f32 v241, v59, v139
    v_fmac_f32 v239, v52, v140
    v_mfma_f32_32x32x16_bf16 v[32:47], v[64:67], v[180:183], 0
    v_fmac_f32 v241, v60, v140
    v_fmac_f32 v239, v53, v141
    v_fmac_f32 v241, v61, v141
    v_fmac_f32 v239, v54, v142
    v_fmac_f32 v241, v62, v142
    v_fmac_f32 v239, v55, v143
    v_fmac_f32 v241, v63, v143
    v_mfma_f32_32x32x16_bf16 v[48:63], v[68:71], v[180:183], 0
    v_permlane32_swap_b32 v234, v236
    v_permlane32_swap_b32 v235, v237
    v_permlane32_swap_b32 v240, v238
    s_waitcnt vmcnt(6) lgkmcnt(0)
    v_mfma_f32_32x32x16_bf16 v[0:15], v[72:75], v[184:187], v[0:15]
    ds_read_b64_tr_b16 v[176:177], v246 offset:4096
    ds_read_b64_tr_b16 v[178:179], v246 offset:4608
    ds_read_b64_tr_b16 v[180:181], v247 offset:4096
    ds_read_b64_tr_b16 v[182:183], v247 offset:4608
    v_permlane32_swap_b32 v241, v239
    s_mov_b32 m0, s69
    v_mfma_f32_32x32x16_bf16 v[16:31], v[76:79], v[184:187], v[16:31]
    buffer_load_dwordx4 v224, s[4:7], s42 offen sc1 lds
    buffer_load_dwordx4 v225, s[72:75], s42 offen offset:1024 sc1 lds
    v_add_f32 v234, v234, v236
    v_add_f32 v235, v235, v237
    v_add_f32 v240, v240, v238
    v_add_f32 v241, v241, v239
    v_mfma_f32_32x32x16_bf16 v[32:47], v[72:75], v[188:191], v[32:47]
    s_set_gpr_idx_on s31, gpr_idx(DST)
    s_nop 0
    v_cvt_pk_bf16_f32 v192, v234, v235
    v_cvt_pk_bf16_f32 v193, v240, v241
    s_set_gpr_idx_off
    v_mfma_f32_32x32x16_bf16 v[48:63], v[76:79], v[188:191], v[48:63]
    s_waitcnt vmcnt(4) lgkmcnt(0)
    v_mfma_f32_32x32x16_bf16 v[0:15], v[80:83], v[176:179], v[0:15]
    ds_read_b64_tr_b16 v[184:185], v246 offset:6144
    ds_read_b64_tr_b16 v[186:187], v246 offset:6656
    ds_read_b64_tr_b16 v[188:189], v247 offset:6144
    ds_read_b64_tr_b16 v[190:191], v247 offset:6656
    s_mov_b32 m0, s70
    v_mfma_f32_32x32x16_bf16 v[16:31], v[84:87], v[176:179], v[16:31]
    buffer_load_dwordx4 v226, s[4:7], s42 offen sc1 lds
    buffer_load_dwordx4 v227, s[72:75], s42 offen offset:1024 sc1 lds
    v_mfma_f32_32x32x16_bf16 v[32:47], v[80:83], v[180:183], v[32:47]
    v_mfma_f32_32x32x16_bf16 v[48:63], v[84:87], v[180:183], v[48:63]
    s_waitcnt vmcnt(4) lgkmcnt(0)
    v_mfma_f32_32x32x16_bf16 v[0:15], v[88:91], v[184:187], v[0:15]
    ds_read_b64_tr_b16 v[176:177], v246 offset:0
    ds_read_b64_tr_b16 v[178:179], v246 offset:512
    ds_read_b64_tr_b16 v[180:181], v247 offset:0
    ds_read_b64_tr_b16 v[182:183], v247 offset:512
    s_mov_b32 m0, s71
    v_mfma_f32_32x32x16_bf16 v[16:31], v[92:95], v[184:187], v[16:31]
    buffer_load_dwordx4 v228, s[4:7], s42 offen sc1 lds
    buffer_load_dwordx4 v229, s[72:75], s42 offen offset:1024 sc1 lds
    v_mfma_f32_32x32x16_bf16 v[32:47], v[88:91], v[188:191], v[32:47]
    s_nop 2
    v_mul_f32 v234, v0, v144
    v_mul_f32 v236, v8, v112
    v_fmac_f32 v234, v1, v145
    v_fmac_f32 v236, v9, v113
    v_fmac_f32 v234, v2, v146
    v_fmac_f32 v236, v10, v114
    v_fmac_f32 v234, v3, v147
    v_mfma_f32_32x32x16_bf16 v[48:63], v[92:95], v[188:191], v[48:63]
    s_setprio 0
    v_fmac_f32 v236, v11, v115
    v_fmac_f32 v234, v4, v148
    v_fmac_f32 v236, v12, v116
    v_fmac_f32 v234, v5, v149
    v_fmac_f32 v236, v13, v117
    v_fmac_f32 v234, v6, v150
    v_fmac_f32 v236, v14, v118
    v_fmac_f32 v234, v7, v151
    v_fmac_f32 v236, v15, v119
    v_mul_f32 v238, v16, v160
    v_mul_f32 v240, v24, v160
    v_fmac_f32 v238, v17, v161
    v_fmac_f32 v240, v25, v161
    v_fmac_f32 v238, v18, v162
    v_fmac_f32 v240, v26, v162
    v_fmac_f32 v238, v19, v163
    v_fmac_f32 v240, v27, v163
    v_fmac_f32 v238, v20, v164
    v_fmac_f32 v240, v28, v164
    v_fmac_f32 v238, v21, v165
    v_fmac_f32 v240, v29, v165
    v_fmac_f32 v238, v22, v166
    v_fmac_f32 v240, v30, v166
    v_fmac_f32 v238, v23, v167
    v_fmac_f32 v240, v31, v167
    v_mul_f32 v235, v32, v152
    v_mul_f32 v237, v40, v120
    v_fmac_f32 v235, v33, v153
    v_fmac_f32 v237, v41, v121
    v_fmac_f32 v235, v34, v154
    v_fmac_f32 v237, v42, v122
    v_fmac_f32 v235, v35, v155
    v_fmac_f32 v237, v43, v123
    v_fmac_f32 v235, v36, v156
    v_fmac_f32 v237, v44, v124
    v_fmac_f32 v235, v37, v157
    v_fmac_f32 v237, v45, v125
    v_fmac_f32 v235, v38, v158
    v_fmac_f32 v237, v46, v126
    v_fmac_f32 v235, v39, v159
    v_fmac_f32 v237, v47, v127
    v_mul_f32 v239, v48, v168
    v_mul_f32 v241, v56, v168
    s_setprio 1
    s_waitcnt vmcnt(4) lgkmcnt(0)
    v_mfma_f32_32x32x16_bf16 v[0:15], v[64:67], v[176:179], 0
    ds_read_b64_tr_b16 v[184:185], v246 offset:2048
    ds_read_b64_tr_b16 v[186:187], v246 offset:2560
    ds_read_b64_tr_b16 v[188:189], v247 offset:2048
    ds_read_b64_tr_b16 v[190:191], v247 offset:2560
    v_fmac_f32 v239, v49, v169
    v_fmac_f32 v241, v57, v169
    s_mov_b32 m0, s68
    v_mfma_f32_32x32x16_bf16 v[16:31], v[68:71], v[176:179], 0
    buffer_load_dwordx4 v222, s[4:7], s43 offen sc1 lds
    buffer_load_dwordx4 v223, s[72:75], s43 offen offset:1024 sc1 lds
    v_fmac_f32 v239, v50, v170
    v_fmac_f32 v241, v58, v170
    v_fmac_f32 v239, v51, v171
    v_fmac_f32 v241, v59, v171
    v_fmac_f32 v239, v52, v172
    v_mfma_f32_32x32x16_bf16 v[32:47], v[64:67], v[180:183], 0
    v_fmac_f32 v241, v60, v172
    v_fmac_f32 v239, v53, v173
    v_fmac_f32 v241, v61, v173
    v_fmac_f32 v239, v54, v174
    v_fmac_f32 v241, v62, v174
    v_fmac_f32 v239, v55, v175
    v_fmac_f32 v241, v63, v175
    v_mfma_f32_32x32x16_bf16 v[48:63], v[68:71], v[180:183], 0
    s_waitcnt vmcnt(4) lgkmcnt(0)
    v_mfma_f32_32x32x16_bf16 v[0:15], v[72:75], v[184:187], v[0:15]
    ds_read_b64_tr_b16 v[176:177], v246 offset:4096
    ds_read_b64_tr_b16 v[178:179], v246 offset:4608
    ds_read_b64_tr_b16 v[180:181], v247 offset:4096
    ds_read_b64_tr_b16 v[182:183], v247 offset:4608
    s_mov_b32 m0, s69
    v_mfma_f32_32x32x16_bf16 v[16:31], v[76:79], v[184:187], v[16:31]
    buffer_load_dwordx4 v224, s[4:7], s43 offen sc1 lds
    buffer_load_dwordx4 v225, s[72:75], s43 offen offset:1024 sc1 lds
    v_mfma_f32_32x32x16_bf16 v[32:47], v[72:75], v[188:191], v[32:47]
    v_mfma_f32_32x32x16_bf16 v[48:63], v[76:79], v[188:191], v[48:63]
    s_waitcnt vmcnt(4) lgkmcnt(0)
    v_mfma_f32_32x32x16_bf16 v[0:15], v[80:83], v[176:179], v[0:15]
    ds_read_b64_tr_b16 v[184:185], v246 offset:6144
    ds_read_b64_tr_b16 v[186:187], v246 offset:6656
    ds_read_b64_tr_b16 v[188:189], v247 offset:6144
    ds_read_b64_tr_b16 v[190:191], v247 offset:6656
    s_mov_b32 m0, s70
    v_mfma_f32_32x32x16_bf16 v[16:31], v[84:87], v[176:179], v[16:31]
    buffer_load_dwordx4 v226, s[4:7], s43 offen sc1 lds
    buffer_load_dwordx4 v227, s[72:75], s43 offen offset:1024 sc1 lds
    v_mfma_f32_32x32x16_bf16 v[32:47], v[80:83], v[180:183], v[32:47]
    v_add_u32 v222, s48, v251
    ds_read_b32 v222, v222
    v_mfma_f32_32x32x16_bf16 v[48:63], v[84:87], v[180:183], v[48:63]
    s_waitcnt vmcnt(4) lgkmcnt(1)
    v_mfma_f32_32x32x16_bf16 v[0:15], v[88:91], v[184:187], v[0:15]
    ds_read_b64_tr_b16 v[176:177], v246 offset:0
    ds_read_b64_tr_b16 v[178:179], v246 offset:512
    ds_read_b64_tr_b16 v[180:181], v247 offset:0
    ds_read_b64_tr_b16 v[182:183], v247 offset:512
    s_mov_b32 m0, s71
    v_mfma_f32_32x32x16_bf16 v[16:31], v[92:95], v[184:187], v[16:31]
    buffer_load_dwordx4 v228, s[4:7], s43 offen sc1 lds
    buffer_load_dwordx4 v229, s[72:75], s43 offen offset:1024 sc1 lds
    s_waitcnt lgkmcnt(4)
    v_mad_u32_u16 v223, v222, s39, v248 op_sel:[1,0,0,0]
    v_mad_u32_u16 v222, v222, s39, v248
    v_mfma_f32_32x32x16_bf16 v[32:47], v[88:91], v[188:191], v[32:47]
    v_add_u32 v224, s49, v251
    ds_read_b32 v224, v224
    v_mul_f32 v242, v0, v144
    v_fma_f32 v238, v8, v160, -v238
    v_fmac_f32 v242, v1, v145
    v_fmac_f32 v238, v9, v161
    v_fmac_f32 v242, v2, v146
    v_mfma_f32_32x32x16_bf16 v[48:63], v[92:95], v[188:191], v[48:63]
    s_setprio 0
    v_fmac_f32 v238, v10, v162
    v_fmac_f32 v242, v3, v147
    v_fmac_f32 v238, v11, v163
    v_fmac_f32 v242, v4, v148
    v_fmac_f32 v238, v12, v164
    v_fmac_f32 v242, v5, v149
    v_fmac_f32 v238, v13, v165
    v_fmac_f32 v242, v6, v150
    v_fmac_f32 v238, v14, v166
    v_fmac_f32 v242, v7, v151
    v_fmac_f32 v238, v15, v167
    v_fmac_f32 v236, v16, v112
    v_mul_f32 v244, v24, v160
    v_fmac_f32 v236, v17, v113
    v_fmac_f32 v244, v25, v161
    v_fmac_f32 v236, v18, v114
    v_fmac_f32 v244, v26, v162
    v_fmac_f32 v236, v19, v115
    v_fmac_f32 v244, v27, v163
    v_fmac_f32 v236, v20, v116
    v_fmac_f32 v244, v28, v164
    v_fmac_f32 v236, v21, v117
    v_fmac_f32 v244, v29, v165
    v_fmac_f32 v236, v22, v118
    v_fmac_f32 v244, v30, v166
    v_fmac_f32 v236, v23, v119
    v_fmac_f32 v244, v31, v167
    v_mul_f32 v243, v32, v152
    v_fma_f32 v239, v40, v168, -v239
    v_fmac_f32 v243, v33, v153
    v_fmac_f32 v239, v41, v169
    v_fmac_f32 v243, v34, v154
    v_fmac_f32 v239, v42, v170
    v_fmac_f32 v243, v35, v155
    v_fmac_f32 v239, v43, v171
    v_fmac_f32 v243, v36, v156
    v_fmac_f32 v239, v44, v172
    v_fmac_f32 v243, v37, v157
    v_fmac_f32 v239, v45, v173
    v_fmac_f32 v243, v38, v158
    v_fmac_f32 v239, v46, v174
    v_fmac_f32 v243, v39, v159
    v_fmac_f32 v239, v47, v175
    v_fmac_f32 v237, v48, v120
    v_mul_f32 v245, v56, v168
    v_fmac_f32 v237, v49, v121
    v_fmac_f32 v245, v57, v169
    v_fmac_f32 v237, v50, v122
    v_fmac_f32 v245, v58, v170
    v_fmac_f32 v237, v51, v123
    s_setprio 1
    s_waitcnt vmcnt(4) lgkmcnt(1)
    v_mfma_f32_32x32x16_bf16 v[0:15], v[64:67], v[176:179], 0
    ds_read_b64_tr_b16 v[184:185], v246 offset:2048
    ds_read_b64_tr_b16 v[186:187], v246 offset:2560
    ds_read_b64_tr_b16 v[188:189], v247 offset:2048
    ds_read_b64_tr_b16 v[190:191], v247 offset:2560
    v_fmac_f32 v245, v59, v171
    v_fmac_f32 v237, v52, v124
    s_mov_b32 m0, s68
    v_mfma_f32_32x32x16_bf16 v[16:31], v[68:71], v[176:179], 0
    buffer_load_dwordx4 v222, s[4:7], s44 offen sc1 lds
    buffer_load_dwordx4 v223, s[72:75], s44 offen offset:1024 sc1 lds
    s_waitcnt lgkmcnt(4)
    v_mad_u32_u16 v225, v224, s39, v248 op_sel:[1,0,0,0]
    v_mad_u32_u16 v224, v224, s39, v248
    v_fmac_f32 v245, v60, v172
    v_fmac_f32 v237, v53, v125
    v_mfma_f32_32x32x16_bf16 v[32:47], v[64:67], v[180:183], 0
    v_add_u32 v226, s50, v251
    ds_read_b32 v226, v226
    v_fmac_f32 v245, v61, v173
    v_fmac_f32 v237, v54, v126
    v_fmac_f32 v245, v62, v174
    v_fmac_f32 v237, v55, v127
    v_fmac_f32 v245, v63, v175
    v_mfma_f32_32x32x16_bf16 v[48:63], v[68:71], v[180:183], 0
    v_permlane32_swap_b32 v242, v234
    v_permlane32_swap_b32 v243, v235
    v_add_f32 v242, v242, v234
    v_add_f32 v243, v243, v235
    s_waitcnt vmcnt(4) lgkmcnt(1)
    v_mfma_f32_32x32x16_bf16 v[0:15], v[72:75], v[184:187], v[0:15]
    ds_read_b64_tr_b16 v[176:177], v246 offset:4096
    ds_read_b64_tr_b16 v[178:179], v246 offset:4608
    ds_read_b64_tr_b16 v[180:181], v247 offset:4096
    ds_read_b64_tr_b16 v[182:183], v247 offset:4608
    s_mov_b32 m0, s69
    v_mfma_f32_32x32x16_bf16 v[16:31], v[76:79], v[184:187], v[16:31]
    buffer_load_dwordx4 v224, s[4:7], s45 offen sc1 lds
    buffer_load_dwordx4 v225, s[72:75], s45 offen offset:1024 sc1 lds
    s_waitcnt lgkmcnt(4)
    v_mad_u32_u16 v227, v226, s39, v248 op_sel:[1,0,0,0]
    v_mad_u32_u16 v226, v226, s39, v248
    v_mfma_f32_32x32x16_bf16 v[32:47], v[72:75], v[188:191], v[32:47]
    v_add_u32 v228, s51, v251
    ds_read_b32 v228, v228
    s_set_gpr_idx_on s31, gpr_idx(DST)
    s_nop 0
    v_cvt_pk_bf16_f32 v194, v242, v243
    s_set_gpr_idx_off
    v_mfma_f32_32x32x16_bf16 v[48:63], v[76:79], v[188:191], v[48:63]
    s_waitcnt vmcnt(4) lgkmcnt(1)
    v_mfma_f32_32x32x16_bf16 v[0:15], v[80:83], v[176:179], v[0:15]
    ds_read_b64_tr_b16 v[184:185], v246 offset:6144
    ds_read_b64_tr_b16 v[186:187], v246 offset:6656
    ds_read_b64_tr_b16 v[188:189], v247 offset:6144
    ds_read_b64_tr_b16 v[190:191], v247 offset:6656
    s_mov_b32 s32, s31
    s_mov_b32 s31, s35
    s_mov_b32 m0, s70
    v_mfma_f32_32x32x16_bf16 v[16:31], v[84:87], v[176:179], v[16:31]
    buffer_load_dwordx4 v226, s[4:7], s46 offen sc1 lds
    buffer_load_dwordx4 v227, s[72:75], s46 offen offset:1024 sc1 lds
    s_waitcnt lgkmcnt(4)
    v_mad_u32_u16 v229, v228, s39, v248 op_sel:[1,0,0,0]
    v_mad_u32_u16 v228, v228, s39, v248
    s_sub_u32 s26, s48, s29
    s_mov_b32 s29, s48
    v_mfma_f32_32x32x16_bf16 v[32:47], v[80:83], v[180:183], v[32:47]
    s_mov_b32 s30, s3
    s_cmp_eq_u32 s34, 0
    s_cselect_b32 s56, s33, 0
    v_mfma_f32_32x32x16_bf16 v[48:63], v[84:87], v[180:183], v[48:63]
    s_waitcnt vmcnt(4) lgkmcnt(0)
    v_mfma_f32_32x32x16_bf16 v[0:15], v[88:91], v[184:187], v[0:15]
    ds_read_b64_tr_b16 v[176:177], v246 offset:0
    ds_read_b64_tr_b16 v[178:179], v246 offset:512
    ds_read_b64_tr_b16 v[180:181], v247 offset:0
    ds_read_b64_tr_b16 v[182:183], v247 offset:512
    s_mov_b32 m0, s71
    v_mfma_f32_32x32x16_bf16 v[16:31], v[92:95], v[184:187], v[16:31]
    buffer_load_dwordx4 v228, s[4:7], s47 offen sc1 lds
    buffer_load_dwordx4 v229, s[72:75], s47 offen offset:1024 sc1 lds
    v_mfma_f32_32x32x16_bf16 v[32:47], v[88:91], v[188:191], v[32:47]
    s_nop 2
    v_mul_f32 v242, v0, v144
    v_fma_f32 v240, v8, v160, -v240
    v_fmac_f32 v242, v1, v145
    v_fmac_f32 v240, v9, v161
    v_fmac_f32 v242, v2, v146
    v_fmac_f32 v240, v10, v162
    v_fmac_f32 v242, v3, v147
    v_mfma_f32_32x32x16_bf16 v[48:63], v[92:95], v[188:191], v[48:63]
    s_setprio 0
    v_fmac_f32 v240, v11, v163
    v_fmac_f32 v242, v4, v148
    v_fmac_f32 v240, v12, v164
    v_fmac_f32 v242, v5, v149
    v_fmac_f32 v240, v13, v165
    v_fmac_f32 v242, v6, v150
    v_fmac_f32 v240, v14, v166
    v_fmac_f32 v242, v7, v151
    v_fmac_f32 v240, v15, v167
    v_add_u32 v249, s26, v249
    v_add_u32 v250, s26, v250
    v_fma_f32 v244, v16, v160, -v244
    v_fmac_f32 v236, v24, v112
    v_fmac_f32 v244, v17, v161
    v_fmac_f32 v236, v25, v113
    v_fmac_f32 v244, v18, v162
    v_fmac_f32 v236, v26, v114
    v_fmac_f32 v244, v19, v163
    v_fmac_f32 v236, v27, v115
    v_fmac_f32 v244, v20, v164
    v_fmac_f32 v236, v28, v116
    v_fmac_f32 v244, v21, v165
    v_fmac_f32 v236, v29, v117
    v_fmac_f32 v244, v22, v166
    v_fmac_f32 v236, v30, v118
    v_fmac_f32 v244, v23, v167
    v_fmac_f32 v236, v31, v119
    ds_read_b64_tr_b16 v[0:1], v249 offset:0
    ds_read_b64_tr_b16 v[2:3], v249 offset:128
    ds_read_b128 v[4:7], v250 offset:0
    ds_read_b128 v[8:11], v250 offset:16
    ds_read_b128 v[12:15], v250 offset:384
    ds_read_b128 v[16:19], v250 offset:400
    v_mul_f32 v243, v32, v152
    v_fma_f32 v241, v40, v168, -v241
    v_fmac_f32 v243, v33, v153
    v_fmac_f32 v241, v41, v169
    v_fmac_f32 v243, v34, v154
    v_fmac_f32 v241, v42, v170
    v_fmac_f32 v243, v35, v155
    v_fmac_f32 v241, v43, v171
    v_fmac_f32 v243, v36, v156
    v_fmac_f32 v241, v44, v172
    v_fmac_f32 v243, v37, v157
    v_fmac_f32 v241, v45, v173
    v_fmac_f32 v243, v38, v158
    v_fmac_f32 v241, v46, v174
    v_fmac_f32 v243, v39, v159
    v_fmac_f32 v241, v47, v175
    ds_read_b64_tr_b16 v[20:21], v249 offset:512
    ds_read_b64_tr_b16 v[22:23], v249 offset:640
    ds_read_b128 v[24:27], v250 offset:64
    ds_read_b128 v[28:31], v250 offset:80
    ds_read_b128 v[32:35], v250 offset:448
    ds_read_b128 v[36:39], v250 offset:464
    v_fma_f32 v245, v48, v168, -v245
    v_fmac_f32 v237, v56, v120
    v_fmac_f32 v245, v49, v169
    v_fmac_f32 v237, v57, v121
    v_fmac_f32 v245, v50, v170
    v_fmac_f32 v237, v58, v122
    v_fmac_f32 v245, v51, v171
    v_fmac_f32 v237, v59, v123
    v_fmac_f32 v245, v52, v172
    v_fmac_f32 v237, v60, v124
    v_fmac_f32 v245, v53, v173
    v_fmac_f32 v237, v61, v125
    v_fmac_f32 v245, v54, v174
    v_fmac_f32 v237, v62, v126
    v_fmac_f32 v245, v55, v175
    v_fmac_f32 v237, v63, v127
    s_cmp_eq_u32 s56, 2
    s_cbranch_scc1 K2_U20
    s_cmp_eq_u32 s56, 3
    s_cbranch_scc1 K2_U30
    s_branch K2_DSP0
K2_U11:
    s_setprio 1
    v_mov_b32 v254, 163648
    v_mov_b32 v255, 1
    v_lshl_add_u32 v233, v252, 1, s53
    s_mov_b64 exec, 1
    ds_add_rtn_u32 v232, v254, v255
    s_mov_b64 exec, -1
    ds_read_b32 v233, v233
    s_waitcnt lgkmcnt(8)
    v_lshlrev_b32 v40, 16, v0
    v_and_b32 v41, 0xffff0000, v0
    v_lshlrev_b32 v42, 16, v1
    v_and_b32 v43, 0xffff0000, v1
    v_lshlrev_b32 v44, 16, v2
    v_and_b32 v45, 0xffff0000, v2
    v_lshlrev_b32 v46, 16, v3
    v_and_b32 v47, 0xffff0000, v3
    v_mul_f32 v4, v40, v4
    v_mul_f32 v5, v41, v5
    v_mul_f32 v6, v42, v6
    v_mul_f32 v7, v43, v7
    v_mul_f32 v8, v44, v8
    v_mul_f32 v9, v45, v9
    v_mul_f32 v10, v46, v10
    v_mul_f32 v11, v47, v11
    v_cvt_pk_bf16_f32 v64, v4, v5
    v_cvt_pk_bf16_f32 v65, v6, v7
    v_cvt_pk_bf16_f32 v66, v8, v9
    v_cvt_pk_bf16_f32 v67, v10, v11
    v_mul_f32 v12, v40, v12
    v_mul_f32 v13, v41, v13
    v_mul_f32 v14, v42, v14
    v_mul_f32 v15, v43, v15
    v_mul_f32 v16, v44, v16
    v_mul_f32 v17, v45, v17
    v_mul_f32 v18, v46, v18
    v_mul_f32 v19, v47, v19
    v_cvt_pk_bf16_f32 v68, v12, v13
    v_cvt_pk_bf16_f32 v69, v14, v15
    v_cvt_pk_bf16_f32 v70, v16, v17
    v_cvt_pk_bf16_f32 v71, v18, v19
    s_waitcnt lgkmcnt(0)
    v_readfirstlane_b32 s58, v232
    s_nop 0
    s_cmp_lt_u32 s58, s22
    s_cbranch_scc0 K2_nul_74
    s_and_b32 s59, s58, 7
    s_lshr_b32 s60, s58, 3
K2_chk_76:
    v_readlane_b32 s61, v233, s59
    s_nop 0
    s_cmp_gt_u32 s61, s60
    s_cbranch_scc0 K2_spin_75
K2_back_77:
    v_readlane_b32 s3, v253, s58
    s_lshl_b32 s44, s34, 7
    s_lshl_b32 s60, s58, 5
    s_and_b32 s48, s3, 0x3ffff
    s_bfe_u32 s33, s3, 0x30012
    s_sub_u32 s60, s60, s48
    s_and_b32 s60, s60, 0xff
    s_add_u32 s35, s60, s48
    s_mov_b32 s45, s44
    s_add_u32 s47, s44, 256
    s_add_u32 s49, s48, 32
    s_add_u32 s60, s48, 64
    s_cmp_eq_u32 s33, 3
    s_cselect_b32 s46, s44, s47
    s_cselect_b32 s50, s60, s48
    s_cselect_b32 s51, s48, s49
    s_sub_u32 s60, s33, 2
    s_cmp_lt_u32 s60, 2
    s_cbranch_scc0 K2_rare_78
K2_back_79:
    v_add_u32 v222, s48, v251
    ds_read_b32 v222, v222
    v_add_u32 v224, s49, v251
    ds_read_b32 v224, v224
    v_add_u32 v226, s50, v251
    ds_read_b32 v226, v226
    v_add_u32 v228, s51, v251
    ds_read_b32 v228, v228
    s_waitcnt lgkmcnt(3)
    v_mad_u32_u16 v223, v222, s39, v248 op_sel:[1,0,0,0]
    v_mad_u32_u16 v222, v222, s39, v248
    s_waitcnt lgkmcnt(2)
    v_mad_u32_u16 v225, v224, s39, v248 op_sel:[1,0,0,0]
    v_mad_u32_u16 v224, v224, s39, v248
    s_waitcnt lgkmcnt(1)
    v_mad_u32_u16 v227, v226, s39, v248 op_sel:[1,0,0,0]
    v_mad_u32_u16 v226, v226, s39, v248
    s_waitcnt lgkmcnt(0)
    v_mad_u32_u16 v229, v228, s39, v248 op_sel:[1,0,0,0]
    v_mad_u32_u16 v228, v228, s39, v248
    s_waitcnt vmcnt(4)
    v_mfma_f32_32x32x16_bf16 v[0:15], v[64:67], v[176:179], 0
    ds_read_b64_tr_b16 v[184:185], v246 offset:2048
    ds_read_b64_tr_b16 v[186:187], v246 offset:2560
    ds_read_b64_tr_b16 v[188:189], v247 offset:2048
    ds_read_b64_tr_b16 v[190:191], v247 offset:2560
    s_mov_b32 m0, s68
    v_mfma_f32_32x32x16_bf16 v[16:31], v[68:71], v[176:179], 0
    buffer_load_dwordx4 v222, s[4:7], s44 offen sc1 lds
    buffer_load_dwordx4 v223, s[72:75], s44 offen offset:1024 sc1 lds
    v_permlane32_swap_b32 v242, v236
    v_permlane32_swap_b32 v243, v237
    v_mfma_f32_32x32x16_bf16 v[32:47], v[64:67], v[180:183], 0
    v_permlane32_swap_b32 v244, v238
    v_permlane32_swap_b32 v245, v239
    v_permlane32_swap_b32 v240, v241
    v_add_f32 v242, v242, v236
    v_mfma_f32_32x32x16_bf16 v[48:63], v[68:71], v[180:183], 0
    s_setprio 0
    v_add_f32 v243, v243, v237
    v_add_f32 v244, v244, v238
    v_add_f32 v245, v245, v239
    v_add_f32 v240, -v240, -v241
    v_sub_u32 v241, v230, v231
    v_cvt_pk_bf16_f32 v242, v242, v243
    v_cvt_pk_bf16_f32 v244, v244, v245
    v_cvt_pk_bf16_f32 v240, v240, v240
    ds_write_b32 v230, v242 offset:768
    ds_write_b32 v230, v244 offset:1024
    ds_write_b16 v241, v240 offset:1280
    v_mul_f32 v234, v0, v96
    v_mul_f32 v236, v8, v128
    v_fmac_f32 v234, v1, v97
    v_fmac_f32 v236, v9, v129
    v_fmac_f32 v234, v2, v98
    v_fmac_f32 v236, v10, v130
    v_fmac_f32 v234, v3, v99
    v_fmac_f32 v236, v11, v131
    v_fmac_f32 v234, v4, v100
    v_fmac_f32 v236, v12, v132
    v_fmac_f32 v234, v5, v101
    v_fmac_f32 v236, v13, v133
    v_fmac_f32 v234, v6, v102
    v_fmac_f32 v236, v14, v134
    v_fmac_f32 v234, v7, v103
    v_fmac_f32 v236, v15, v135
    v_mul_f32 v238, v16, v128
    v_mul_f32 v240, v24, v128
    v_fmac_f32 v238, v17, v129
    v_fmac_f32 v240, v25, v129
    v_fmac_f32 v238, v18, v130
    v_fmac_f32 v240, v26, v130
    v_fmac_f32 v238, v19, v131
    v_fmac_f32 v240, v27, v131
    v_fmac_f32 v238, v20, v132
    v_fmac_f32 v240, v28, v132
    v_fmac_f32 v238, v21, v133
    v_fmac_f32 v240, v29, v133
    v_fmac_f32 v238, v22, v134
    v_fmac_f32 v240, v30, v134
    v_fmac_f32 v238, v23, v135
    v_fmac_f32 v240, v31, v135
    v_mul_f32 v235, v32, v104
    v_mul_f32 v237, v40, v136
    v_fmac_f32 v235, v33, v105
    v_fmac_f32 v237, v41, v137
    v_fmac_f32 v235, v34, v106
    v_fmac_f32 v237, v42, v138
    v_fmac_f32 v235, v35, v107
    v_fmac_f32 v237, v43, v139
    v_fmac_f32 v235, v36, v108
    v_fmac_f32 v237, v44, v140
    v_fmac_f32 v235, v37, v109
    v_fmac_f32 v237, v45, v141
    v_fmac_f32 v235, v38, v110
    v_fmac_f32 v237, v46, v142
    v_fmac_f32 v235, v39, v111
    v_fmac_f32 v237, v47, v143
    v_mul_f32 v239, v48, v136
    v_mul_f32 v241, v56, v136
    v_fmac_f32 v239, v49, v137
    v_fmac_f32 v241, v57, v137
    v_fmac_f32 v239, v50, v138
    v_fmac_f32 v241, v58, v138
    v_fmac_f32 v239, v51, v139
    v_fmac_f32 v241, v59, v139
    v_fmac_f32 v239, v52, v140
    v_fmac_f32 v241, v60, v140
    v_fmac_f32 v239, v53, v141
    v_fmac_f32 v241, v61, v141
    v_fmac_f32 v239, v54, v142
    v_fmac_f32 v241, v62, v142
    v_fmac_f32 v239, v55, v143
    v_fmac_f32 v241, v63, v143
    s_setprio 1
    s_waitcnt vmcnt(4) lgkmcnt(3)
    v_mfma_f32_32x32x16_bf16 v[0:15], v[64:67], v[184:187], 0
    ds_read_b64_tr_b16 v[176:177], v246 offset:4096
    ds_read_b64_tr_b16 v[178:179], v246 offset:4608
    ds_read_b64_tr_b16 v[180:181], v247 offset:4096
    ds_read_b64_tr_b16 v[182:183], v247 offset:4608
    s_mov_b32 m0, s69
    v_mfma_f32_32x32x16_bf16 v[16:31], v[68:71], v[184:187], 0
    buffer_load_dwordx4 v224, s[4:7], s45 offen sc1 lds
    buffer_load_dwordx4 v225, s[72:75], s45 offen offset:1024 sc1 lds
    v_permlane32_swap_b32 v234, v236
    v_permlane32_swap_b32 v235, v237
    v_mfma_f32_32x32x16_bf16 v[32:47], v[64:67], v[188:191], 0
    v_permlane32_swap_b32 v240, v238
    v_permlane32_swap_b32 v241, v239
    v_lshl_add_u32 v230, v252, 1, s31
    v_add_f32 v234, v234, v236
    v_add_f32 v235, v235, v237
    v_mfma_f32_32x32x16_bf16 v[48:63], v[68:71], v[188:191], 0
    s_setprio 0
    v_add_f32 v240, v240, v238
    v_add_f32 v241, v241, v239
    v_cvt_pk_bf16_f32 v234, v234, v235
    v_cvt_pk_bf16_f32 v240, v240, v241
    ds_write_b32 v230, v234 offset:0
    ds_write_b32 v230, v240 offset:256
    v_mul_f32 v234, v0, v144
    v_mul_f32 v236, v8, v112
    v_fmac_f32 v234, v1, v145
    v_fmac_f32 v236, v9, v113
    v_fmac_f32 v234, v2, v146
    v_fmac_f32 v236, v10, v114
    v_fmac_f32 v234, v3, v147
    v_fmac_f32 v236, v11, v115
    v_fmac_f32 v234, v4, v148
    v_fmac_f32 v236, v12, v116
    v_fmac_f32 v234, v5, v149
    v_fmac_f32 v236, v13, v117
    v_fmac_f32 v234, v6, v150
    v_fmac_f32 v236, v14, v118
    v_fmac_f32 v234, v7, v151
    v_fmac_f32 v236, v15, v119
    v_mul_f32 v238, v16, v160
    v_mul_f32 v240, v24, v160
    v_fmac_f32 v238, v17, v161
    v_fmac_f32 v240, v25, v161
    v_fmac_f32 v238, v18, v162
    v_fmac_f32 v240, v26, v162
    v_fmac_f32 v238, v19, v163
    v_fmac_f32 v240, v27, v163
    v_fmac_f32 v238, v20, v164
    v_fmac_f32 v240, v28, v164
    v_fmac_f32 v238, v21, v165
    v_fmac_f32 v240, v29, v165
    v_fmac_f32 v238, v22, v166
    v_fmac_f32 v240, v30, v166
    v_fmac_f32 v238, v23, v167
    v_fmac_f32 v240, v31, v167
    v_mul_f32 v235, v32, v152
    v_mul_f32 v237, v40, v120
    v_fmac_f32 v235, v33, v153
    v_fmac_f32 v237, v41, v121
    v_fmac_f32 v235, v34, v154
    v_fmac_f32 v237, v42, v122
    v_fmac_f32 v235, v35, v155
    v_fmac_f32 v237, v43, v123
    v_fmac_f32 v235, v36, v156
    v_fmac_f32 v237, v44, v124
    v_fmac_f32 v235, v37, v157
    v_fmac_f32 v237, v45, v125
    v_fmac_f32 v235, v38, v158
    v_fmac_f32 v237, v46, v126
    v_fmac_f32 v235, v39, v159
    v_fmac_f32 v237, v47, v127
    v_mul_f32 v239, v48, v168
    v_mul_f32 v241, v56, v168
    v_fmac_f32 v239, v49, v169
    v_fmac_f32 v241, v57, v169
    v_fmac_f32 v239, v50, v170
    v_fmac_f32 v241, v58, v170
    v_fmac_f32 v239, v51, v171
    v_fmac_f32 v241, v59, v171
    v_fmac_f32 v239, v52, v172
    v_fmac_f32 v241, v60, v172
    v_fmac_f32 v239, v53, v173
    v_fmac_f32 v241, v61, v173
    v_fmac_f32 v239, v54, v174
    v_fmac_f32 v241, v62, v174
    v_fmac_f32 v239, v55, v175
    v_fmac_f32 v241, v63, v175
    s_setprio 1
    s_waitcnt vmcnt(4) lgkmcnt(2)
    v_mfma_f32_32x32x16_bf16 v[0:15], v[64:67], v[176:179], 0
    ds_read_b64_tr_b16 v[184:185], v246 offset:6144
    ds_read_b64_tr_b16 v[186:187], v246 offset:6656
    ds_read_b64_tr_b16 v[188:189], v247 offset:6144
    ds_read_b64_tr_b16 v[190:191], v247 offset:6656
    s_mov_b32 s32, s31
    s_mov_b32 s31, s35
    s_mov_b32 m0, s70
    v_mfma_f32_32x32x16_bf16 v[16:31], v[68:71], v[176:179], 0
    buffer_load_dwordx4 v226, s[4:7], s46 offen sc1 lds
    buffer_load_dwordx4 v227, s[72:75], s46 offen offset:1024 sc1 lds
    s_sub_u32 s26, s48, s29
    s_mov_b32 s29, s48
    s_mov_b32 s30, s3
    s_cmp_lg_u32 s36, 0
    s_cselect_b32 s56, s33, 0
    v_mfma_f32_32x32x16_bf16 v[32:47], v[64:67], v[180:183], 0
    v_mfma_f32_32x32x16_bf16 v[48:63], v[68:71], v[180:183], 0
    s_setprio 0
    v_mul_f32 v242, v0, v144
    v_fma_f32 v238, v8, v160, -v238
    v_fmac_f32 v242, v1, v145
    v_fmac_f32 v238, v9, v161
    v_fmac_f32 v242, v2, v146
    v_fmac_f32 v238, v10, v162
    v_fmac_f32 v242, v3, v147
    v_fmac_f32 v238, v11, v163
    v_fmac_f32 v242, v4, v148
    v_fmac_f32 v238, v12, v164
    v_fmac_f32 v242, v5, v149
    v_fmac_f32 v238, v13, v165
    v_fmac_f32 v242, v6, v150
    v_fmac_f32 v238, v14, v166
    v_fmac_f32 v242, v7, v151
    v_fmac_f32 v238, v15, v167
    v_fmac_f32 v236, v16, v112
    v_mul_f32 v244, v24, v160
    v_fmac_f32 v236, v17, v113
    v_fmac_f32 v244, v25, v161
    v_fmac_f32 v236, v18, v114
    v_fmac_f32 v244, v26, v162
    v_fmac_f32 v236, v19, v115
    v_fmac_f32 v244, v27, v163
    v_fmac_f32 v236, v20, v116
    v_fmac_f32 v244, v28, v164
    v_fmac_f32 v236, v21, v117
    v_fmac_f32 v244, v29, v165
    v_fmac_f32 v236, v22, v118
    v_fmac_f32 v244, v30, v166
    v_fmac_f32 v236, v23, v119
    v_fmac_f32 v244, v31, v167
    v_mul_f32 v243, v32, v152
    v_fma_f32 v239, v40, v168, -v239
    v_fmac_f32 v243, v33, v153
    v_fmac_f32 v239, v41, v169
    v_fmac_f32 v243, v34, v154
    v_fmac_f32 v239, v42, v170
    v_fmac_f32 v243, v35, v155
    v_fmac_f32 v239, v43, v171
    v_fmac_f32 v243, v36, v156
    v_fmac_f32 v239, v44, v172
    v_fmac_f32 v243, v37, v157
    v_fmac_f32 v239, v45, v173
    v_fmac_f32 v243, v38, v158
    v_fmac_f32 v239, v46, v174
    v_fmac_f32 v243, v39, v159
    v_fmac_f32 v239, v47, v175
    v_fmac_f32 v237, v48, v120
    v_mul_f32 v245, v56, v168
    v_fmac_f32 v237, v49, v121
    v_fmac_f32 v245, v57, v169
    v_fmac_f32 v237, v50, v122
    v_fmac_f32 v245, v58, v170
    v_fmac_f32 v237, v51, v123
    v_fmac_f32 v245, v59, v171
    v_fmac_f32 v237, v52, v124
    v_fmac_f32 v245, v60, v172
    v_fmac_f32 v237, v53, v125
    v_fmac_f32 v245, v61, v173
    v_fmac_f32 v237, v54, v126
    v_fmac_f32 v245, v62, v174
    v_fmac_f32 v237, v55, v127
    v_fmac_f32 v245, v63, v175
    s_setprio 1
    s_waitcnt vmcnt(4) lgkmcnt(0)
    v_mfma_f32_32x32x16_bf16 v[0:15], v[64:67], v[184:187], 0
    ds_read_b64_tr_b16 v[176:177], v246 offset:0
    ds_read_b64_tr_b16 v[178:179], v246 offset:512
    ds_read_b64_tr_b16 v[180:181], v247 offset:0
    ds_read_b64_tr_b16 v[182:183], v247 offset:512
    s_mov_b32 m0, s71
    v_mfma_f32_32x32x16_bf16 v[16:31], v[68:71], v[184:187], 0
    buffer_load_dwordx4 v228, s[4:7], s47 offen sc1 lds
    buffer_load_dwordx4 v229, s[72:75], s47 offen offset:1024 sc1 lds
    v_permlane32_swap_b32 v242, v234
    v_permlane32_swap_b32 v243, v235
    v_add_f32 v242, v242, v234
    v_mfma_f32_32x32x16_bf16 v[32:47], v[64:67], v[188:191], 0
    v_add_f32 v243, v243, v235
    v_cvt_pk_bf16_f32 v242, v242, v243
    ds_write_b32 v230, v242 offset:512
    v_mfma_f32_32x32x16_bf16 v[48:63], v[68:71], v[188:191], 0
    s_setprio 0
    v_mul_f32 v242, v0, v144
    v_fma_f32 v240, v8, v160, -v240
    v_fmac_f32 v242, v1, v145
    v_fmac_f32 v240, v9, v161
    v_fmac_f32 v242, v2, v146
    v_fmac_f32 v240, v10, v162
    v_fmac_f32 v242, v3, v147
    v_fmac_f32 v240, v11, v163
    v_fmac_f32 v242, v4, v148
    v_fmac_f32 v240, v12, v164
    v_fmac_f32 v242, v5, v149
    v_fmac_f32 v240, v13, v165
    v_fmac_f32 v242, v6, v150
    v_fmac_f32 v240, v14, v166
    v_fmac_f32 v242, v7, v151
    v_fmac_f32 v240, v15, v167
    v_add_u32 v249, s26, v249
    v_add_u32 v250, s26, v250
    v_fma_f32 v244, v16, v160, -v244
    v_fmac_f32 v236, v24, v112
    v_fmac_f32 v244, v17, v161
    v_fmac_f32 v236, v25, v113
    v_fmac_f32 v244, v18, v162
    v_fmac_f32 v236, v26, v114
    v_fmac_f32 v244, v19, v163
    v_fmac_f32 v236, v27, v115
    v_fmac_f32 v244, v20, v164
    v_fmac_f32 v236, v28, v116
    v_fmac_f32 v244, v21, v165
    v_fmac_f32 v236, v29, v117
    v_fmac_f32 v244, v22, v166
    v_fmac_f32 v236, v30, v118
    v_fmac_f32 v244, v23, v167
    v_fmac_f32 v236, v31, v119
    ds_read_b64_tr_b16 v[0:1], v249 offset:0
    ds_read_b64_tr_b16 v[2:3], v249 offset:128
    ds_read_b128 v[4:7], v250 offset:0
    ds_read_b128 v[8:11], v250 offset:16
    ds_read_b128 v[12:15], v250 offset:384
    ds_read_b128 v[16:19], v250 offset:400
    v_mul_f32 v243, v32, v152
    v_fma_f32 v241, v40, v168, -v241
    v_fmac_f32 v243, v33, v153
    v_fmac_f32 v241, v41, v169
    v_fmac_f32 v243, v34, v154
    v_fmac_f32 v241, v42, v170
    v_fmac_f32 v243, v35, v155
    v_fmac_f32 v241, v43, v171
    v_fmac_f32 v243, v36, v156
    v_fmac_f32 v241, v44, v172
    v_fmac_f32 v243, v37, v157
    v_fmac_f32 v241, v45, v173
    v_fmac_f32 v243, v38, v158
    v_fmac_f32 v241, v46, v174
    v_fmac_f32 v243, v39, v159
    v_fmac_f32 v241, v47, v175
    ds_read_b64_tr_b16 v[20:21], v249 offset:512
    ds_read_b64_tr_b16 v[22:23], v249 offset:640
    ds_read_b128 v[24:27], v250 offset:64
    ds_read_b128 v[28:31], v250 offset:80
    ds_read_b128 v[32:35], v250 offset:448
    ds_read_b128 v[36:39], v250 offset:464
    v_fma_f32 v245, v48, v168, -v245
    v_fmac_f32 v237, v56, v120
    v_fmac_f32 v245, v49, v169
    v_fmac_f32 v237, v57, v121
    v_fmac_f32 v245, v50, v170
    v_fmac_f32 v237, v58, v122
    v_fmac_f32 v245, v51, v171
    v_fmac_f32 v237, v59, v123
    v_fmac_f32 v245, v52, v172
    v_fmac_f32 v237, v60, v124
    v_fmac_f32 v245, v53, v173
    v_fmac_f32 v237, v61, v125
    v_fmac_f32 v245, v54, v174
    v_fmac_f32 v237, v62, v126
    v_fmac_f32 v245, v55, v175
    v_fmac_f32 v237, v63, v127
    s_cmp_eq_u32 s56, 2
    s_cbranch_scc1 K2_U21
    s_cmp_eq_u32 s56, 3
    s_cbranch_scc1 K2_U31
    s_branch K2_DSP1
K2_U41:
    s_setprio 1
    s_waitcnt lgkmcnt(6)
    v_lshlrev_b32 v40, 16, v0
    v_and_b32 v41, 0xffff0000, v0
    v_lshlrev_b32 v42, 16, v1
    v_and_b32 v43, 0xffff0000, v1
    v_lshlrev_b32 v44, 16, v2
    v_and_b32 v45, 0xffff0000, v2
    v_lshlrev_b32 v46, 16, v3
    v_and_b32 v47, 0xffff0000, v3
    v_mul_f32 v4, v40, v4
    v_mul_f32 v5, v41, v5
    v_mul_f32 v6, v42, v6
    v_mul_f32 v7, v43, v7
    v_mul_f32 v8, v44, v8
    v_mul_f32 v9, v45, v9
    v_mul_f32 v10, v46, v10
    v_mul_f32 v11, v47, v11
    v_cvt_pk_bf16_f32 v64, v4, v5
    v_cvt_pk_bf16_f32 v65, v6, v7
    v_cvt_pk_bf16_f32 v66, v8, v9
    v_cvt_pk_bf16_f32 v67, v10, v11
    v_mul_f32 v12, v40, v12
    v_mul_f32 v13, v41, v13
    v_mul_f32 v14, v42, v14
    v_mul_f32 v15, v43, v15
    v_mul_f32 v16, v44, v16
    v_mul_f32 v17, v45, v17
    v_mul_f32 v18, v46, v18
    v_mul_f32 v19, v47, v19
    v_cvt_pk_bf16_f32 v68, v12, v13
    v_cvt_pk_bf16_f32 v69, v14, v15
    v_cvt_pk_bf16_f32 v70, v16, v17
    v_cvt_pk_bf16_f32 v71, v18, v19
    ds_read_b64_tr_b16 v[0:1], v249 offset:1024
    ds_read_b64_tr_b16 v[2:3], v249 offset:1152
    ds_read_b128 v[4:7], v250 offset:128
    ds_read_b128 v[8:11], v250 offset:144
    ds_read_b128 v[12:15], v250 offset:512
    ds_read_b128 v[16:19], v250 offset:528
    s_waitcnt lgkmcnt(6)
    v_lshlrev_b32 v48, 16, v20
    v_and_b32 v49, 0xffff0000, v20
    v_lshlrev_b32 v50, 16, v21
    v_and_b32 v51, 0xffff0000, v21
    v_lshlrev_b32 v52, 16, v22
    v_and_b32 v53, 0xffff0000, v22
    v_lshlrev_b32 v54, 16, v23
    v_and_b32 v55, 0xffff0000, v23
    v_mul_f32 v24, v48, v24
    v_mul_f32 v25, v49, v25
    v_mul_f32 v26, v50, v26
    v_mul_f32 v27, v51, v27
    v_mul_f32 v28, v52, v28
    v_mul_f32 v29, v53, v29
    v_mul_f32 v30, v54, v30
    v_mul_f32 v31, v55, v31
    v_cvt_pk_bf16_f32 v72, v24, v25
    v_cvt_pk_bf16_f32 v73, v26, v27
    v_cvt_pk_bf16_f32 v74, v28, v29
    v_cvt_pk_bf16_f32 v75, v30, v31
    v_mul_f32 v32, v48, v32
    v_mul_f32 v33, v49, v33
    v_mul_f32 v34, v50, v34
    v_mul_f32 v35, v51, v35
    v_mul_f32 v36, v52, v36
    v_mul_f32 v37, v53, v37
    v_mul_f32 v38, v54, v38
    v_mul_f32 v39, v55, v39
    v_cvt_pk_bf16_f32 v76, v32, v33
    v_cvt_pk_bf16_f32 v77, v34, v35
    v_cvt_pk_bf16_f32 v78, v36, v37
    v_cvt_pk_bf16_f32 v79, v38, v39
    s_lshr_b32 s65, s30, 27
    s_mov_b32 s66, 161536
    s_cmp_ge_u32 s65, 2
    s_cselect_b32 s66, 158112, s66
    s_mul_i32 s65, s65, 512
    s_add_u32 s65, s65, s66
    s_sub_u32 s65, s65, s29
    v_add_u32 v56, s65, v249
    s_lshr_b32 s65, s30, 27
    s_mov_b32 s66, 161536
    s_cmp_ge_u32 s65, 2
    s_cselect_b32 s66, 159008, s66
    s_mul_i32 s65, s65, 64
    s_add_u32 s65, s65, s66
    s_sub_u32 s65, s65, s29
    v_add_u32 v57, s65, v250
    ds_read_b64_tr_b16 v[20:21], v56 offset:0
    ds_read_b64_tr_b16 v[22:23], v56 offset:128
    ds_read_b128 v[24:27], v57 offset:0
    ds_read_b128 v[28:31], v57 offset:16
    ds_read_b128 v[32:35], v57 offset:384
    ds_read_b128 v[36:39], v57 offset:400
    s_waitcnt lgkmcnt(10)
    v_lshlrev_b32 v40, 16, v0
    v_and_b32 v41, 0xffff0000, v0
    v_lshlrev_b32 v42, 16, v1
    v_and_b32 v43, 0xffff0000, v1
    v_lshlrev_b32 v44, 16, v2
    v_and_b32 v45, 0xffff0000, v2
    v_lshlrev_b32 v46, 16, v3
    v_and_b32 v47, 0xffff0000, v3
    s_waitcnt lgkmcnt(8)
    v_mul_f32 v4, v40, v4
    v_mul_f32 v5, v41, v5
    v_mul_f32 v6, v42, v6
    v_mul_f32 v7, v43, v7
    v_mul_f32 v8, v44, v8
    v_mul_f32 v9, v45, v9
    v_mul_f32 v10, v46, v10
    v_mul_f32 v11, v47, v11
    v_cvt_pk_bf16_f32 v80, v4, v5
    v_cvt_pk_bf16_f32 v81, v6, v7
    v_cvt_pk_bf16_f32 v82, v8, v9
    v_cvt_pk_bf16_f32 v83, v10, v11
    s_waitcnt lgkmcnt(6)
    v_mul_f32 v12, v40, v12
    v_mul_f32 v13, v41, v13
    v_mul_f32 v14, v42, v14
    v_mul_f32 v15, v43, v15
    v_mul_f32 v16, v44, v16
    v_mul_f32 v17, v45, v17
    v_mul_f32 v18, v46, v18
    v_mul_f32 v19, v47, v19
    v_cvt_pk_bf16_f32 v84, v12, v13
    v_cvt_pk_bf16_f32 v85, v14, v15
    v_cvt_pk_bf16_f32 v86, v16, v17
    v_cvt_pk_bf16_f32 v87, v18, v19
    s_waitcnt lgkmcnt(4)
    v_lshlrev_b32 v48, 16, v20
    v_and_b32 v49, 0xffff0000, v20
    v_lshlrev_b32 v50, 16, v21
    v_and_b32 v51, 0xffff0000, v21
    v_lshlrev_b32 v52, 16, v22
    v_and_b32 v53, 0xffff0000, v22
    v_lshlrev_b32 v54, 16, v23
    v_and_b32 v55, 0xffff0000, v23
    s_waitcnt lgkmcnt(2)
    v_mul_f32 v24, v48, v24
    v_mul_f32 v25, v49, v25
    v_mul_f32 v26, v50, v26
    v_mul_f32 v27, v51, v27
    v_mul_f32 v28, v52, v28
    v_mul_f32 v29, v53, v29
    v_mul_f32 v30, v54, v30
    v_mul_f32 v31, v55, v31
    v_cvt_pk_bf16_f32 v88, v24, v25
    v_cvt_pk_bf16_f32 v89, v26, v27
    v_cvt_pk_bf16_f32 v90, v28, v29
    v_cvt_pk_bf16_f32 v91, v30, v31
    s_waitcnt lgkmcnt(0)
    v_mul_f32 v32, v48, v32
    v_mul_f32 v33, v49, v33
    v_mul_f32 v34, v50, v34
    v_mul_f32 v35, v51, v35
    v_mul_f32 v36, v52, v36
    v_mul_f32 v37, v53, v37
    v_mul_f32 v38, v54, v38
    v_mul_f32 v39, v55, v39
    v_cvt_pk_bf16_f32 v92, v32, v33
    v_cvt_pk_bf16_f32 v93, v34, v35
    v_cvt_pk_bf16_f32 v94, v36, v37
    v_cvt_pk_bf16_f32 v95, v38, v39
    s_waitcnt vmcnt(4)
    v_mfma_f32_32x32x16_bf16 v[0:15], v[64:67], v[176:179], 0
    ds_read_b64_tr_b16 v[184:185], v246 offset:2048
    ds_read_b64_tr_b16 v[186:187], v246 offset:2560
    ds_read_b64_tr_b16 v[188:189], v247 offset:2048
    ds_read_b64_tr_b16 v[190:191], v247 offset:2560
    s_mov_b32 m0, s68
    v_mfma_f32_32x32x16_bf16 v[16:31], v[68:71], v[176:179], 0
    buffer_load_dwordx4 v222, s[4:7], s41 offen sc1 lds
    buffer_load_dwordx4 v223, s[72:75], s41 offen offset:1024 sc1 lds
    v_permlane32_swap_b32 v242, v236
    v_permlane32_swap_b32 v243, v237
    v_mov_b32 v254, 163648
    v_mfma_f32_32x32x16_bf16 v[32:47], v[64:67], v[180:183], 0
    v_permlane32_swap_b32 v244, v238
    v_permlane32_swap_b32 v245, v239
    v_permlane32_swap_b32 v240, v241
    v_add_f32 v242, v242, v236
    v_mfma_f32_32x32x16_bf16 v[48:63], v[68:71], v[180:183], 0
    v_add_f32 v243, v243, v237
    v_add_f32 v244, v244, v238
    v_add_f32 v245, v245, v239
    v_add_f32 v240, -v240, -v241
    v_sub_u32 v241, v230, v231
    v_cvt_pk_bf16_f32 v242, v242, v243
    v_mov_b32 v255, 1
    v_lshl_add_u32 v233, v252, 1, s53
    s_mov_b64 exec, 1
    ds_add_rtn_u32 v232, v254, v255
    s_mov_b64 exec, -1
    ds_read_b32 v233, v233
    s_waitcnt vmcnt(4) lgkmcnt(2)
    v_mfma_f32_32x32x16_bf16 v[0:15], v[72:75], v[184:187], v[0:15]
    ds_read_b64_tr_b16 v[176:177], v246 offset:4096
    ds_read_b64_tr_b16 v[178:179], v246 offset:4608
    ds_read_b64_tr_b16 v[180:181], v247 offset:4096
    ds_read_b64_tr_b16 v[182:183], v247 offset:4608
    v_cvt_pk_bf16_f32 v244, v244, v245
    v_cvt_pk_bf16_f32 v240, v240, v240
    s_mov_b32 m0, s69
    v_mfma_f32_32x32x16_bf16 v[16:31], v[76:79], v[184:187], v[16:31]
    buffer_load_dwordx4 v224, s[4:7], s41 offen sc1 lds
    buffer_load_dwordx4 v225, s[72:75], s41 offen offset:1024 sc1 lds
    ds_write_b32 v230, v242 offset:768
    ds_write_b32 v230, v244 offset:1024
    ds_write_b16 v241, v240 offset:1280
    s_waitcnt lgkmcnt(7)
    v_readfirstlane_b32 s58, v232
    v_mfma_f32_32x32x16_bf16 v[32:47], v[72:75], v[188:191], v[32:47]
    s_cmp_lt_u32 s58, s22
    s_cbranch_scc0 K2_nul_81
    s_and_b32 s59, s58, 7
    s_lshr_b32 s60, s58, 3
K2_chk_83:
    v_readlane_b32 s61, v233, s59
    s_nop 0
    s_cmp_gt_u32 s61, s60
    s_cbranch_scc0 K2_spin_82
K2_back_84:
    v_mfma_f32_32x32x16_bf16 v[48:63], v[76:79], v[188:191], v[48:63]
    v_readlane_b32 s3, v253, s58
    s_lshl_b32 s44, s34, 7
    s_lshl_b32 s60, s58, 5
    s_and_b32 s48, s3, 0x3ffff
    s_bfe_u32 s33, s3, 0x30012
    s_sub_u32 s60, s60, s48
    s_waitcnt vmcnt(4) lgkmcnt(3)
    v_mfma_f32_32x32x16_bf16 v[0:15], v[80:83], v[176:179], v[0:15]
    ds_read_b64_tr_b16 v[184:185], v246 offset:6144
    ds_read_b64_tr_b16 v[186:187], v246 offset:6656
    ds_read_b64_tr_b16 v[188:189], v247 offset:6144
    ds_read_b64_tr_b16 v[190:191], v247 offset:6656
    s_and_b32 s60, s60, 0xff
    s_add_u32 s35, s60, s48
    s_mov_b32 m0, s70
    v_mfma_f32_32x32x16_bf16 v[16:31], v[84:87], v[176:179], v[16:31]
    buffer_load_dwordx4 v226, s[4:7], s41 offen sc1 lds
    buffer_load_dwordx4 v227, s[72:75], s41 offen offset:1024 sc1 lds
    s_mov_b32 s45, s44
    s_add_u32 s47, s44, 256
    s_add_u32 s49, s48, 32
    s_add_u32 s60, s48, 64
    v_mfma_f32_32x32x16_bf16 v[32:47], v[80:83], v[180:183], v[32:47]
    s_cmp_eq_u32 s33, 3
    s_cselect_b32 s46, s44, s47
    s_cselect_b32 s50, s60, s48
    s_cselect_b32 s51, s48, s49
    s_sub_u32 s60, s33, 2
    s_cmp_lt_u32 s60, 2
    s_cbranch_scc0 K2_rare_85
K2_back_86:
    v_mfma_f32_32x32x16_bf16 v[48:63], v[84:87], v[180:183], v[48:63]
    s_waitcnt vmcnt(4) lgkmcnt(0)
    v_mfma_f32_32x32x16_bf16 v[0:15], v[88:91], v[184:187], v[0:15]
    ds_read_b64_tr_b16 v[176:177], v246 offset:0
    ds_read_b64_tr_b16 v[178:179], v246 offset:512
    ds_read_b64_tr_b16 v[180:181], v247 offset:0
    ds_read_b64_tr_b16 v[182:183], v247 offset:512
    s_mov_b32 m0, s71
    v_mfma_f32_32x32x16_bf16 v[16:31], v[92:95], v[184:187], v[16:31]
    buffer_load_dwordx4 v228, s[4:7], s41 offen sc1 lds
    buffer_load_dwordx4 v229, s[72:75], s41 offen offset:1024 sc1 lds
    v_mfma_f32_32x32x16_bf16 v[32:47], v[88:91], v[188:191], v[32:47]
    s_nop 2
    v_mul_f32 v234, v0, v96
    v_mul_f32 v236, v8, v128
    v_fmac_f32 v234, v1, v97
    v_fmac_f32 v236, v9, v129
    v_fmac_f32 v234, v2, v98
    v_fmac_f32 v236, v10, v130
    v_fmac_f32 v234, v3, v99
    v_mfma_f32_32x32x16_bf16 v[48:63], v[92:95], v[188:191], v[48:63]
    s_setprio 0
    v_fmac_f32 v236, v11, v131
    v_fmac_f32 v234, v4, v100
    v_fmac_f32 v236, v12, v132
    v_fmac_f32 v234, v5, v101
    v_fmac_f32 v236, v13, v133
    v_fmac_f32 v234, v6, v102
    v_fmac_f32 v236, v14, v134
    v_fmac_f32 v234, v7, v103
    v_fmac_f32 v236, v15, v135
    v_mul_f32 v238, v16, v128
    v_mul_f32 v240, v24, v128
    v_fmac_f32 v238, v17, v129
    v_fmac_f32 v240, v25, v129
    v_fmac_f32 v238, v18, v130
    v_fmac_f32 v240, v26, v130
    v_fmac_f32 v238, v19, v131
    v_fmac_f32 v240, v27, v131
    v_fmac_f32 v238, v20, v132
    v_fmac_f32 v240, v28, v132
    v_fmac_f32 v238, v21, v133
    v_fmac_f32 v240, v29, v133
    v_fmac_f32 v238, v22, v134
    v_fmac_f32 v240, v30, v134
    v_fmac_f32 v238, v23, v135
    v_fmac_f32 v240, v31, v135
    v_mul_f32 v235, v32, v104
    v_mul_f32 v237, v40, v136
    v_fmac_f32 v235, v33, v105
    v_fmac_f32 v237, v41, v137
    v_fmac_f32 v235, v34, v106
    v_fmac_f32 v237, v42, v138
    v_fmac_f32 v235, v35, v107
    v_fmac_f32 v237, v43, v139
    v_fmac_f32 v235, v36, v108
    v_fmac_f32 v237, v44, v140
    v_fmac_f32 v235, v37, v109
    v_fmac_f32 v237, v45, v141
    v_fmac_f32 v235, v38, v110
    v_fmac_f32 v237, v46, v142
    v_fmac_f32 v235, v39, v111
    v_fmac_f32 v237, v47, v143
    v_mul_f32 v239, v48, v136
    v_mul_f32 v241, v56, v136
    s_setprio 1
    s_waitcnt vmcnt(4) lgkmcnt(0)
    v_mfma_f32_32x32x16_bf16 v[0:15], v[64:67], v[176:179], 0
    ds_read_b64_tr_b16 v[184:185], v246 offset:2048
    ds_read_b64_tr_b16 v[186:187], v246 offset:2560
    ds_read_b64_tr_b16 v[188:189], v247 offset:2048
    ds_read_b64_tr_b16 v[190:191], v247 offset:2560
    v_fmac_f32 v239, v49, v137
    v_fmac_f32 v241, v57, v137
    s_mov_b32 m0, s68
    v_mfma_f32_32x32x16_bf16 v[16:31], v[68:71], v[176:179], 0
    buffer_load_dwordx4 v222, s[4:7], s42 offen sc1 lds
    buffer_load_dwordx4 v223, s[72:75], s42 offen offset:1024 sc1 lds
    v_fmac_f32 v239, v50, v138
    v_fmac_f32 v241, v58, v138
    v_fmac_f32 v239, v51, v139
    v_fmac_f32 v241, v59, v139
    v_fmac_f32 v239, v52, v140
    v_mfma_f32_32x32x16_bf16 v[32:47], v[64:67], v[180:183], 0
    v_fmac_f32 v241, v60, v140
    v_fmac_f32 v239, v53, v141
    v_fmac_f32 v241, v61, v141
    v_fmac_f32 v239, v54, v142
    v_fmac_f32 v241, v62, v142
    v_fmac_f32 v239, v55, v143
    v_fmac_f32 v241, v63, v143
    v_mfma_f32_32x32x16_bf16 v[48:63], v[68:71], v[180:183], 0
    v_permlane32_swap_b32 v234, v236
    v_permlane32_swap_b32 v235, v237
    v_permlane32_swap_b32 v240, v238
    s_waitcnt vmcnt(4) lgkmcnt(0)
    v_mfma_f32_32x32x16_bf16 v[0:15], v[72:75], v[184:187], v[0:15]
    ds_read_b64_tr_b16 v[176:177], v246 offset:4096
    ds_read_b64_tr_b16 v[178:179], v246 offset:4608
    ds_read_b64_tr_b16 v[180:181], v247 offset:4096
    ds_read_b64_tr_b16 v[182:183], v247 offset:4608
    v_permlane32_swap_b32 v241, v239
    s_mov_b32 m0, s69
    v_mfma_f32_32x32x16_bf16 v[16:31], v[76:79], v[184:187], v[16:31]
    buffer_load_dwordx4 v224, s[4:7], s42 offen sc1 lds
    buffer_load_dwordx4 v225, s[72:75], s42 offen offset:1024 sc1 lds
    v_lshl_add_u32 v230, v252, 1, s31
    v_add_f32 v234, v234, v236
    v_add_f32 v235, v235, v237
    v_add_f32 v240, v240, v238
    v_add_f32 v241, v241, v239
    v_mfma_f32_32x32x16_bf16 v[32:47], v[72:75], v[188:191], v[32:47]
    v_cvt_pk_bf16_f32 v234, v234, v235
    v_cvt_pk_bf16_f32 v240, v240, v241
    ds_write_b32 v230, v234 offset:0
    ds_write_b32 v230, v240 offset:256
    v_mfma_f32_32x32x16_bf16 v[48:63], v[76:79], v[188:191], v[48:63]
    s_waitcnt vmcnt(4) lgkmcnt(2)
    v_mfma_f32_32x32x16_bf16 v[0:15], v[80:83], v[176:179], v[0:15]
    ds_read_b64_tr_b16 v[184:185], v246 offset:6144
    ds_read_b64_tr_b16 v[186:187], v246 offset:6656
    ds_read_b64_tr_b16 v[188:189], v247 offset:6144
    ds_read_b64_tr_b16 v[190:191], v247 offset:6656
    s_mov_b32 m0, s70
    v_mfma_f32_32x32x16_bf16 v[16:31], v[84:87], v[176:179], v[16:31]
    buffer_load_dwordx4 v226, s[4:7], s42 offen sc1 lds
    buffer_load_dwordx4 v227, s[72:75], s42 offen offset:1024 sc1 lds
    v_mfma_f32_32x32x16_bf16 v[32:47], v[80:83], v[180:183], v[32:47]
    v_mfma_f32_32x32x16_bf16 v[48:63], v[84:87], v[180:183], v[48:63]
    s_waitcnt vmcnt(4) lgkmcnt(0)
    v_mfma_f32_32x32x16_bf16 v[0:15], v[88:91], v[184:187], v[0:15]
    ds_read_b64_tr_b16 v[176:177], v246 offset:0
    ds_read_b64_tr_b16 v[178:179], v246 offset:512
    ds_read_b64_tr_b16 v[180:181], v247 offset:0
    ds_read_b64_tr_b16 v[182:183], v247 offset:512
    s_mov_b32 m0, s71
    v_mfma_f32_32x32x16_bf16 v[16:31], v[92:95], v[184:187], v[16:31]
    buffer_load_dwordx4 v228, s[4:7], s42 offen sc1 lds
    buffer_load_dwordx4 v229, s[72:75], s42 offen offset:1024 sc1 lds
    v_mfma_f32_32x32x16_bf16 v[32:47], v[88:91], v[188:191], v[32:47]
    s_nop 2
    v_mul_f32 v234, v0, v144
    v_mul_f32 v236, v8, v112
    v_fmac_f32 v234, v1, v145
    v_fmac_f32 v236, v9, v113
    v_fmac_f32 v234, v2, v146
    v_fmac_f32 v236, v10, v114
    v_fmac_f32 v234, v3, v147
    v_mfma_f32_32x32x16_bf16 v[48:63], v[92:95], v[188:191], v[48:63]
    s_setprio 0
    v_fmac_f32 v236, v11, v115
    v_fmac_f32 v234, v4, v148
    v_fmac_f32 v236, v12, v116
    v_fmac_f32 v234, v5, v149
    v_fmac_f32 v236, v13, v117
    v_fmac_f32 v234, v6, v150
    v_fmac_f32 v236, v14, v118
    v_fmac_f32 v234, v7, v151
    v_fmac_f32 v236, v15, v119
    v_mul_f32 v238, v16, v160
    v_mul_f32 v240, v24, v160
    v_fmac_f32 v238, v17, v161
    v_fmac_f32 v240, v25, v161
    v_fmac_f32 v238, v18, v162
    v_fmac_f32 v240, v26, v162
    v_fmac_f32 v238, v19, v163
    v_fmac_f32 v240, v27, v163
    v_fmac_f32 v238, v20, v164
    v_fmac_f32 v240, v28, v164
    v_fmac_f32 v238, v21, v165
    v_fmac_f32 v240, v29, v165
    v_fmac_f32 v238, v22, v166
    v_fmac_f32 v240, v30, v166
    v_fmac_f32 v238, v23, v167
    v_fmac_f32 v240, v31, v167
    v_mul_f32 v235, v32, v152
    v_mul_f32 v237, v40, v120
    v_fmac_f32 v235, v33, v153
    v_fmac_f32 v237, v41, v121
    v_fmac_f32 v235, v34, v154
    v_fmac_f32 v237, v42, v122
    v_fmac_f32 v235, v35, v155
    v_fmac_f32 v237, v43, v123
    v_fmac_f32 v235, v36, v156
    v_fmac_f32 v237, v44, v124
    v_fmac_f32 v235, v37, v157
    v_fmac_f32 v237, v45, v125
    v_fmac_f32 v235, v38, v158
    v_fmac_f32 v237, v46, v126
    v_fmac_f32 v235, v39, v159
    v_fmac_f32 v237, v47, v127
    v_mul_f32 v239, v48, v168
    v_mul_f32 v241, v56, v168
    s_setprio 1
    s_waitcnt vmcnt(4) lgkmcnt(0)
    v_mfma_f32_32x32x16_bf16 v[0:15], v[64:67], v[176:179], 0
    ds_read_b64_tr_b16 v[184:185], v246 offset:2048
    ds_read_b64_tr_b16 v[186:187], v246 offset:2560
    ds_read_b64_tr_b16 v[188:189], v247 offset:2048
    ds_read_b64_tr_b16 v[190:191], v247 offset:2560
    v_fmac_f32 v239, v49, v169
    v_fmac_f32 v241, v57, v169
    s_mov_b32 m0, s68
    v_mfma_f32_32x32x16_bf16 v[16:31], v[68:71], v[176:179], 0
    buffer_load_dwordx4 v222, s[4:7], s43 offen sc1 lds
    buffer_load_dwordx4 v223, s[72:75], s43 offen offset:1024 sc1 lds
    v_fmac_f32 v239, v50, v170
    v_fmac_f32 v241, v58, v170
    v_fmac_f32 v239, v51, v171
    v_fmac_f32 v241, v59, v171
    v_fmac_f32 v239, v52, v172
    v_mfma_f32_32x32x16_bf16 v[32:47], v[64:67], v[180:183], 0
    v_fmac_f32 v241, v60, v172
    v_fmac_f32 v239, v53, v173
    v_fmac_f32 v241, v61, v173
    v_fmac_f32 v239, v54, v174
    v_fmac_f32 v241, v62, v174
    v_fmac_f32 v239, v55, v175
    v_fmac_f32 v241, v63, v175
    v_mfma_f32_32x32x16_bf16 v[48:63], v[68:71], v[180:183], 0
    s_waitcnt vmcnt(4) lgkmcnt(0)
    v_mfma_f32_32x32x16_bf16 v[0:15], v[72:75], v[184:187], v[0:15]
    ds_read_b64_tr_b16 v[176:177], v246 offset:4096
    ds_read_b64_tr_b16 v[178:179], v246 offset:4608
    ds_read_b64_tr_b16 v[180:181], v247 offset:4096
    ds_read_b64_tr_b16 v[182:183], v247 offset:4608
    s_mov_b32 m0, s69
    v_mfma_f32_32x32x16_bf16 v[16:31], v[76:79], v[184:187], v[16:31]
    buffer_load_dwordx4 v224, s[4:7], s43 offen sc1 lds
    buffer_load_dwordx4 v225, s[72:75], s43 offen offset:1024 sc1 lds
    v_mfma_f32_32x32x16_bf16 v[32:47], v[72:75], v[188:191], v[32:47]
    v_mfma_f32_32x32x16_bf16 v[48:63], v[76:79], v[188:191], v[48:63]
    s_waitcnt vmcnt(4) lgkmcnt(0)
    v_mfma_f32_32x32x16_bf16 v[0:15], v[80:83], v[176:179], v[0:15]
    ds_read_b64_tr_b16 v[184:185], v246 offset:6144
    ds_read_b64_tr_b16 v[186:187], v246 offset:6656
    ds_read_b64_tr_b16 v[188:189], v247 offset:6144
    ds_read_b64_tr_b16 v[190:191], v247 offset:6656
    s_mov_b32 m0, s70
    v_mfma_f32_32x32x16_bf16 v[16:31], v[84:87], v[176:179], v[16:31]
    buffer_load_dwordx4 v226, s[4:7], s43 offen sc1 lds
    buffer_load_dwordx4 v227, s[72:75], s43 offen offset:1024 sc1 lds
    v_mfma_f32_32x32x16_bf16 v[32:47], v[80:83], v[180:183], v[32:47]
    v_add_u32 v222, s48, v251
    ds_read_b32 v222, v222
    v_mfma_f32_32x32x16_bf16 v[48:63], v[84:87], v[180:183], v[48:63]
    s_waitcnt vmcnt(4) lgkmcnt(1)
    v_mfma_f32_32x32x16_bf16 v[0:15], v[88:91], v[184:187], v[0:15]
    ds_read_b64_tr_b16 v[176:177], v246 offset:0
    ds_read_b64_tr_b16 v[178:179], v246 offset:512
    ds_read_b64_tr_b16 v[180:181], v247 offset:0
    ds_read_b64_tr_b16 v[182:183], v247 offset:512
    s_mov_b32 m0, s71
    v_mfma_f32_32x32x16_bf16 v[16:31], v[92:95], v[184:187], v[16:31]
    buffer_load_dwordx4 v228, s[4:7], s43 offen sc1 lds
    buffer_load_dwordx4 v229, s[72:75], s43 offen offset:1024 sc1 lds
    s_waitcnt lgkmcnt(4)
    v_mad_u32_u16 v223, v222, s39, v248 op_sel:[1,0,0,0]
    v_mad_u32_u16 v222, v222, s39, v248
    v_mfma_f32_32x32x16_bf16 v[32:47], v[88:91], v[188:191], v[32:47]
    v_add_u32 v224, s49, v251
    ds_read_b32 v224, v224
    v_mul_f32 v242, v0, v144
    v_fma_f32 v238, v8, v160, -v238
    v_fmac_f32 v242, v1, v145
    v_fmac_f32 v238, v9, v161
    v_fmac_f32 v242, v2, v146
    v_mfma_f32_32x32x16_bf16 v[48:63], v[92:95], v[188:191], v[48:63]
    s_setprio 0
    v_fmac_f32 v238, v10, v162
    v_fmac_f32 v242, v3, v147
    v_fmac_f32 v238, v11, v163
    v_fmac_f32 v242, v4, v148
    v_fmac_f32 v238, v12, v164
    v_fmac_f32 v242, v5, v149
    v_fmac_f32 v238, v13, v165
    v_fmac_f32 v242, v6, v150
    v_fmac_f32 v238, v14, v166
    v_fmac_f32 v242, v7, v151
    v_fmac_f32 v238, v15, v167
    v_fmac_f32 v236, v16, v112
    v_mul_f32 v244, v24, v160
    v_fmac_f32 v236, v17, v113
    v_fmac_f32 v244, v25, v161
    v_fmac_f32 v236, v18, v114
    v_fmac_f32 v244, v26, v162
    v_fmac_f32 v236, v19, v115
    v_fmac_f32 v244, v27, v163
    v_fmac_f32 v236, v20, v116
    v_fmac_f32 v244, v28, v164
    v_fmac_f32 v236, v21, v117
    v_fmac_f32 v244, v29, v165
    v_fmac_f32 v236, v22, v118
    v_fmac_f32 v244, v30, v166
    v_fmac_f32 v236, v23, v119
    v_fmac_f32 v244, v31, v167
    v_mul_f32 v243, v32, v152
    v_fma_f32 v239, v40, v168, -v239
    v_fmac_f32 v243, v33, v153
    v_fmac_f32 v239, v41, v169
    v_fmac_f32 v243, v34, v154
    v_fmac_f32 v239, v42, v170
    v_fmac_f32 v243, v35, v155
    v_fmac_f32 v239, v43, v171
    v_fmac_f32 v243, v36, v156
    v_fmac_f32 v239, v44, v172
    v_fmac_f32 v243, v37, v157
    v_fmac_f32 v239, v45, v173
    v_fmac_f32 v243, v38, v158
    v_fmac_f32 v239, v46, v174
    v_fmac_f32 v243, v39, v159
    v_fmac_f32 v239, v47, v175
    v_fmac_f32 v237, v48, v120
    v_mul_f32 v245, v56, v168
    v_fmac_f32 v237, v49, v121
    v_fmac_f32 v245, v57, v169
    v_fmac_f32 v237, v50, v122
    v_fmac_f32 v245, v58, v170
    v_fmac_f32 v237, v51, v123
    s_setprio 1
    s_waitcnt vmcnt(4) lgkmcnt(1)
    v_mfma_f32_32x32x16_bf16 v[0:15], v[64:67], v[176:179], 0
    ds_read_b64_tr_b16 v[184:185], v246 offset:2048
    ds_read_b64_tr_b16 v[186:187], v246 offset:2560
    ds_read_b64_tr_b16 v[188:189], v247 offset:2048
    ds_read_b64_tr_b16 v[190:191], v247 offset:2560
    v_fmac_f32 v245, v59, v171
    v_fmac_f32 v237, v52, v124
    s_mov_b32 m0, s68
    v_mfma_f32_32x32x16_bf16 v[16:31], v[68:71], v[176:179], 0
    buffer_load_dwordx4 v222, s[4:7], s44 offen sc1 lds
    buffer_load_dwordx4 v223, s[72:75], s44 offen offset:1024 sc1 lds
    s_waitcnt lgkmcnt(4)
    v_mad_u32_u16 v225, v224, s39, v248 op_sel:[1,0,0,0]
    v_mad_u32_u16 v224, v224, s39, v248
    v_fmac_f32 v245, v60, v172
    v_fmac_f32 v237, v53, v125
    v_mfma_f32_32x32x16_bf16 v[32:47], v[64:67], v[180:183], 0
    v_add_u32 v226, s50, v251
    ds_read_b32 v226, v226
    v_fmac_f32 v245, v61, v173
    v_fmac_f32 v237, v54, v126
    v_fmac_f32 v245, v62, v174
    v_fmac_f32 v237, v55, v127
    v_fmac_f32 v245, v63, v175
    v_mfma_f32_32x32x16_bf16 v[48:63], v[68:71], v[180:183], 0
    v_permlane32_swap_b32 v242, v234
    v_permlane32_swap_b32 v243, v235
    v_add_f32 v242, v242, v234
    v_add_f32 v243, v243, v235
    s_waitcnt vmcnt(4) lgkmcnt(1)
    v_mfma_f32_32x32x16_bf16 v[0:15], v[72:75], v[184:187], v[0:15]
    ds_read_b64_tr_b16 v[176:177], v246 offset:4096
    ds_read_b64_tr_b16 v[178:179], v246 offset:4608
    ds_read_b64_tr_b16 v[180:181], v247 offset:4096
    ds_read_b64_tr_b16 v[182:183], v247 offset:4608
    v_cvt_pk_bf16_f32 v242, v242, v243
    ds_write_b32 v230, v242 offset:512
    s_mov_b32 m0, s69
    v_mfma_f32_32x32x16_bf16 v[16:31], v[76:79], v[184:187], v[16:31]
    buffer_load_dwordx4 v224, s[4:7], s45 offen sc1 lds
    buffer_load_dwordx4 v225, s[72:75], s45 offen offset:1024 sc1 lds
    s_waitcnt lgkmcnt(5)
    v_mad_u32_u16 v227, v226, s39, v248 op_sel:[1,0,0,0]
    v_mad_u32_u16 v226, v226, s39, v248
    v_mfma_f32_32x32x16_bf16 v[32:47], v[72:75], v[188:191], v[32:47]
    v_add_u32 v228, s51, v251
    ds_read_b32 v228, v228
    v_mfma_f32_32x32x16_bf16 v[48:63], v[76:79], v[188:191], v[48:63]
    s_waitcnt vmcnt(4) lgkmcnt(2)
    v_mfma_f32_32x32x16_bf16 v[0:15], v[80:83], v[176:179], v[0:15]
    ds_read_b64_tr_b16 v[184:185], v246 offset:6144
    ds_read_b64_tr_b16 v[186:187], v246 offset:6656
    ds_read_b64_tr_b16 v[188:189], v247 offset:6144
    ds_read_b64_tr_b16 v[190:191], v247 offset:6656
    s_mov_b32 s32, s31
    s_mov_b32 s31, s35
    s_mov_b32 m0, s70
    v_mfma_f32_32x32x16_bf16 v[16:31], v[84:87], v[176:179], v[16:31]
    buffer_load_dwordx4 v226, s[4:7], s46 offen sc1 lds
    buffer_load_dwordx4 v227, s[72:75], s46 offen offset:1024 sc1 lds
    s_waitcnt lgkmcnt(4)
    v_mad_u32_u16 v229, v228, s39, v248 op_sel:[1,0,0,0]
    v_mad_u32_u16 v228, v228, s39, v248
    s_sub_u32 s26, s48, s29
    s_mov_b32 s29, s48
    v_mfma_f32_32x32x16_bf16 v[32:47], v[80:83], v[180:183], v[32:47]
    s_mov_b32 s30, s3
    s_cmp_lg_u32 s36, 0
    s_cselect_b32 s56, s33, 0
    v_mfma_f32_32x32x16_bf16 v[48:63], v[84:87], v[180:183], v[48:63]
    s_waitcnt vmcnt(4) lgkmcnt(0)
    v_mfma_f32_32x32x16_bf16 v[0:15], v[88:91], v[184:187], v[0:15]
    ds_read_b64_tr_b16 v[176:177], v246 offset:0
    ds_read_b64_tr_b16 v[178:179], v246 offset:512
    ds_read_b64_tr_b16 v[180:181], v247 offset:0
    ds_read_b64_tr_b16 v[182:183], v247 offset:512
    s_mov_b32 m0, s71
    v_mfma_f32_32x32x16_bf16 v[16:31], v[92:95], v[184:187], v[16:31]
    buffer_load_dwordx4 v228, s[4:7], s47 offen sc1 lds
    buffer_load_dwordx4 v229, s[72:75], s47 offen offset:1024 sc1 lds
    v_mfma_f32_32x32x16_bf16 v[32:47], v[88:91], v[188:191], v[32:47]
    s_nop 2
    v_mul_f32 v242, v0, v144
    v_fma_f32 v240, v8, v160, -v240
    v_fmac_f32 v242, v1, v145
    v_fmac_f32 v240, v9, v161
    v_fmac_f32 v242, v2, v146
    v_fmac_f32 v240, v10, v162
    v_fmac_f32 v242, v3, v147
    v_mfma_f32_32x32x16_bf16 v[48:63], v[92:95], v[188:191], v[48:63]
    s_setprio 0
    v_fmac_f32 v240, v11, v163
    v_fmac_f32 v242, v4, v148
    v_fmac_f32 v240, v12, v164
    v_fmac_f32 v242, v5, v149
    v_fmac_f32 v240, v13, v165
    v_fmac_f32 v242, v6, v150
    v_fmac_f32 v240, v14, v166
    v_fmac_f32 v242, v7, v151
    v_fmac_f32 v240, v15, v167
    v_add_u32 v249, s26, v249
    v_add_u32 v250, s26, v250
    v_fma_f32 v244, v16, v160, -v244
    v_fmac_f32 v236, v24, v112
    v_fmac_f32 v244, v17, v161
    v_fmac_f32 v236, v25, v113
    v_fmac_f32 v244, v18, v162
    v_fmac_f32 v236, v26, v114
    v_fmac_f32 v244, v19, v163
    v_fmac_f32 v236, v27, v115
    v_fmac_f32 v244, v20, v164
    v_fmac_f32 v236, v28, v116
    v_fmac_f32 v244, v21, v165
    v_fmac_f32 v236, v29, v117
    v_fmac_f32 v244, v22, v166
    v_fmac_f32 v236, v30, v118
    v_fmac_f32 v244, v23, v167
    v_fmac_f32 v236, v31, v119
    ds_read_b64_tr_b16 v[0:1], v249 offset:0
    ds_read_b64_tr_b16 v[2:3], v249 offset:128
    ds_read_b128 v[4:7], v250 offset:0
    ds_read_b128 v[8:11], v250 offset:16
    ds_read_b128 v[12:15], v250 offset:384
    ds_read_b128 v[16:19], v250 offset:400
    v_mul_f32 v243, v32, v152
    v_fma_f32 v241, v40, v168, -v241
    v_fmac_f32 v243, v33, v153
    v_fmac_f32 v241, v41, v169
    v_fmac_f32 v243, v34, v154
    v_fmac_f32 v241, v42, v170
    v_fmac_f32 v243, v35, v155
    v_fmac_f32 v241, v43, v171
    v_fmac_f32 v243, v36, v156
    v_fmac_f32 v241, v44, v172
    v_fmac_f32 v243, v37, v157
    v_fmac_f32 v241, v45, v173
    v_fmac_f32 v243, v38, v158
    v_fmac_f32 v241, v46, v174
    v_fmac_f32 v243, v39, v159
    v_fmac_f32 v241, v47, v175
    ds_read_b64_tr_b16 v[20:21], v249 offset:512
    ds_read_b64_tr_b16 v[22:23], v249 offset:640
    ds_read_b128 v[24:27], v250 offset:64
    ds_read_b128 v[28:31], v250 offset:80
    ds_read_b128 v[32:35], v250 offset:448
    ds_read_b128 v[36:39], v250 offset:464
    v_fma_f32 v245, v48, v168, -v245
    v_fmac_f32 v237, v56, v120
    v_fmac_f32 v245, v49, v169
    v_fmac_f32 v237, v57, v121
    v_fmac_f32 v245, v50, v170
    v_fmac_f32 v237, v58, v122
    v_fmac_f32 v245, v51, v171
    v_fmac_f32 v237, v59, v123
    v_fmac_f32 v245, v52, v172
    v_fmac_f32 v237, v60, v124
    v_fmac_f32 v245, v53, v173
    v_fmac_f32 v237, v61, v125
    v_fmac_f32 v245, v54, v174
    v_fmac_f32 v237, v62, v126
    v_fmac_f32 v245, v55, v175
    v_fmac_f32 v237, v63, v127
    s_cmp_eq_u32 s56, 2
    s_cbranch_scc1 K2_U21
    s_cmp_eq_u32 s56, 3
    s_cbranch_scc1 K2_U31
    s_branch K2_DSP1
K2_nul_50:
    s_mov_b32 s58, 63
    s_mov_b32 s36, 0
    s_branch K2_back_53
K2_spin_51:
    s_sub_u32 s27, s27, 1
    s_cbranch_scc1 K2_END
    v_lshl_add_u32 v233, v252, 1, s53
    ds_read_b32 v233, v233
    s_waitcnt lgkmcnt(0)
    s_branch K2_chk_52
K2_dyn_48:
    v_mov_b32 v254, 163648
    v_mov_b32 v255, 1
    v_lshl_add_u32 v233, v252, 1, s53
    s_mov_b64 exec, 1
    ds_add_rtn_u32 v232, v254, v255
    s_mov_b64 exec, -1
    ds_read_b32 v233, v233
    s_waitcnt lgkmcnt(0)
    v_readfirstlane_b32 s58, v232
    s_nop 0
    s_cmp_lt_u32 s58, s22
    s_cbranch_scc0 K2_nul_50
    s_and_b32 s59, s58, 7
    s_lshr_b32 s60, s58, 3
K2_chk_52:
    v_readlane_b32 s61, v233, s59
    s_nop 0
    s_cmp_gt_u32 s61, s60
    s_cbranch_scc0 K2_spin_51
K2_back_53:
    s_mov_b32 s34, 1
    s_branch K2_back_49
K2_rare_54:
    s_cmp_eq_u32 s33, 4
    s_cbranch_scc1 K2_four_56
    s_mov_b32 s49, s48
    s_mov_b32 s51, s48
    s_add_u32 s45, s44, 256
    s_add_u32 s46, s44, 512
    s_add_u32 s47, s44, 768
    s_branch K2_back_55
K2_four_56:
    s_add_u32 s50, s48, 64
    s_lshr_b32 s51, s3, 27
    s_mov_b32 s66, 161536
    s_cmp_ge_u32 s51, 2
    s_cselect_b32 s66, 159072, s66
    s_mul_i32 s51, s51, 32
    s_add_u32 s51, s51, s66
    s_mov_b32 s46, s44
    s_mov_b32 s47, s44
    s_branch K2_back_55
K2_dum_57:
    v_mov_b32 v232, -1
    s_mov_b32 m0, 163712
    s_mov_b64 exec, 1
    buffer_load_dwordx4 v232, s[16:19], 0 offen lds
    buffer_load_dwordx4 v232, s[16:19], 0 offen lds
    s_mov_b64 exec, -1
    s_branch K2_back_59
K2_a4_58:
    s_lshr_b32 s65, s3, 27
    s_mov_b32 s66, 161536
    s_cmp_ge_u32 s65, 2
    s_cselect_b32 s66, 158112, s66
    s_mul_i32 s65, s65, 512
    s_add_u32 s65, s65, s66
    v_add_u32 v232, s65, v230
    ds_read_b32 v232, v232
    s_add_u32 m0, s65, 864
    s_waitcnt lgkmcnt(0)
    v_or_b32 v232, v232, v231
    buffer_load_dwordx4 v232, s[16:19], 0 offen  lds
    s_branch K2_b4_60
K2_nul_63:
    s_mov_b32 s58, 63
    s_mov_b32 s36, 0
    s_branch K2_back_66
K2_spin_64:
    s_sub_u32 s27, s27, 1
    s_cbranch_scc1 K2_END
    v_lshl_add_u32 v233, v252, 1, s53
    ds_read_b32 v233, v233
    s_waitcnt lgkmcnt(0)
    s_branch K2_chk_65
K2_dyn_61:
    v_mov_b32 v254, 163648
    v_mov_b32 v255, 1
    v_lshl_add_u32 v233, v252, 1, s53
    s_mov_b64 exec, 1
    ds_add_rtn_u32 v232, v254, v255
    s_mov_b64 exec, -1
    ds_read_b32 v233, v233
    s_waitcnt lgkmcnt(0)
    v_readfirstlane_b32 s58, v232
    s_nop 0
    s_cmp_lt_u32 s58, s22
    s_cbranch_scc0 K2_nul_63
    s_and_b32 s59, s58, 7
    s_lshr_b32 s60, s58, 3
K2_chk_65:
    v_readlane_b32 s61, v233, s59
    s_nop 0
    s_cmp_gt_u32 s61, s60
    s_cbranch_scc0 K2_spin_64
K2_back_66:
    s_mov_b32 s34, 1
    s_branch K2_back_62
K2_rare_67:
    s_cmp_eq_u32 s33, 4
    s_cbranch_scc1 K2_four_69
    s_mov_b32 s49, s48
    s_mov_b32 s51, s48
    s_add_u32 s45, s44, 256
    s_add_u32 s46, s44, 512
    s_add_u32 s47, s44, 768
    s_branch K2_back_68
K2_four_69:
    s_add_u32 s50, s48, 64
    s_lshr_b32 s51, s3, 27
    s_mov_b32 s66, 161536
    s_cmp_ge_u32 s51, 2
    s_cselect_b32 s66, 159072, s66
    s_mul_i32 s51, s51, 32
    s_add_u32 s51, s51, s66
    s_mov_b32 s46, s44
    s_mov_b32 s47, s44
    s_branch K2_back_68
K2_dum_70:
    v_mov_b32 v232, -1
    s_mov_b32 m0, 163712
    s_mov_b64 exec, 1
    buffer_load_dwordx4 v232, s[16:19], 0 offen lds
    buffer_load_dwordx4 v232, s[16:19], 0 offen lds
    s_mov_b64 exec, -1
    s_branch K2_back_72
K2_a4_71:
    s_lshr_b32 s65, s3, 27
    s_mov_b32 s66, 161536
    s_cmp_ge_u32 s65, 2
    s_cselect_b32 s66, 158112, s66
    s_mul_i32 s65, s65, 512
    s_add_u32 s65, s65, s66
    v_add_u32 v232, s65, v230
    ds_read_b32 v232, v232
    s_add_u32 m0, s65, 864
    s_waitcnt lgkmcnt(0)
    v_or_b32 v232, v232, v231
    buffer_load_dwordx4 v232, s[16:19], 0 offen  lds
    s_branch K2_b4_73
K2_nul_74:
    s_mov_b32 s58, 63
    s_mov_b32 s36, 0
    s_branch K2_back_77
K2_spin_75:
    s_sub_u32 s27, s27, 1
    s_cbranch_scc1 K2_END
    v_lshl_add_u32 v233, v252, 1, s53
    ds_read_b32 v233, v233
    s_waitcnt lgkmcnt(0)
    s_branch K2_chk_76
K2_rare_78:
    s_cmp_eq_u32 s33, 4
    s_cbranch_scc1 K2_four_80
    s_mov_b32 s49, s48
    s_mov_b32 s51, s48
    s_add_u32 s45, s44, 256
    s_add_u32 s46, s44, 512
    s_add_u32 s47, s44, 768
    s_branch K2_back_79
K2_four_80:
    s_add_u32 s50, s48, 64
    s_lshr_b32 s51, s3, 27
    s_mov_b32 s66, 161536
    s_cmp_ge_u32 s51, 2
    s_cselect_b32 s66, 159072, s66
    s_mul_i32 s51, s51, 32
    s_add_u32 s51, s51, s66
    s_mov_b32 s46, s44
    s_mov_b32 s47, s44
    s_branch K2_back_79
K2_nul_81:
    s_mov_b32 s58, 63
    s_mov_b32 s36, 0
    s_branch K2_back_84
K2_spin_82:
    s_sub_u32 s27, s27, 1
    s_cbranch_scc1 K2_END
    v_lshl_add_u32 v233, v252, 1, s53
    ds_read_b32 v233, v233
    s_waitcnt lgkmcnt(0)
    s_branch K2_chk_83
K2_rare_85:
    s_cmp_eq_u32 s33, 4
    s_cbranch_scc1 K2_four_87
    s_mov_b32 s49, s48
    s_mov_b32 s51, s48
    s_add_u32 s45, s44, 256
    s_add_u32 s46, s44, 512
    s_add_u32 s47, s44, 768
    s_branch K2_back_86
K2_four_87:
    s_add_u32 s50, s48, 64
    s_lshr_b32 s51, s3, 27
    s_mov_b32 s66, 161536
    s_cmp_ge_u32 s51, 2
    s_cselect_b32 s66, 159072, s66
    s_mul_i32 s51, s51, 32
    s_add_u32 s51, s51, s66
    s_mov_b32 s46, s44
    s_mov_b32 s47, s44
    s_branch K2_back_86
K2_END:
    s_endpgm
.section .rodata,"a"
.p2align 6
.amdhsa_kernel standalone__tensor_product_equiv_equiformer__graph_kernel
  .amdhsa_next_free_vgpr 256
  .amdhsa_next_free_sgpr 102
  .amdhsa_accum_offset 256
  .amdhsa_group_segment_fixed_size 0
  .amdhsa_kernarg_size 96
  .amdhsa_user_sgpr_count 2
  .amdhsa_user_sgpr_kernarg_segment_ptr 1
  .amdhsa_system_sgpr_workgroup_id_x 1
  .amdhsa_float_denorm_mode_32 3
.end_amdhsa_kernel
```

```asm
; @launch grid=(256,1,1) block=(512,1,1) lds=163840
.amdgcn_target "amdgcn-amd-amdhsa--gfx950"
.text
.globl standalone__tensor_product_equiv_equiformer__graph_kernel
.p2align 8
.type standalone__tensor_product_equiv_equiformer__graph_kernel,@function
standalone__tensor_product_equiv_equiformer__graph_kernel:
    s_cmp_ge_u32 s2, 256
    s_cbranch_scc1 K2_END
    s_load_dwordx16 s[80:95], s[0:1], 0
    s_load_dwordx4 s[96:99], s[0:1], 72
    s_load_dwordx2 s[100:101], s[0:1], 88
    v_lshrrev_b32 v1, 6, v0
    s_mov_b32 s54, s2
    v_readfirstlane_b32 s20, v1
    s_mov_b64 exec, 0
    s_cmp_eq_u32 s20, 0
    s_cbranch_scc1 K2_PAD_S1
    s_cmp_eq_u32 s20, 1
    s_cbranch_scc1 K2_PAD_S2
    s_cmp_eq_u32 s20, 5
    s_cbranch_scc1 K2_PAD_H1
    s_cmp_eq_u32 s20, 6
    s_cbranch_scc1 K2_PAD_H2
    s_cmp_eq_u32 s20, 2
    s_cbranch_scc1 K2_PAD_H3
KS_HOP0:
    s_mov_b64 exec, -1
    v_and_b32 v8, 63, v0
    v_lshlrev_b32 v9, 4, v8
    v_mov_b32 v6, 0
    v_lshlrev_b32 v5, 4, v0
    v_mul_u32_u24 v4, 24, v0
    s_mul_i32 s64, s2, 5120
    s_mul_i32 s65, s2, 7680
    v_mov_b32 v176, v8
    v_mov_b32 v177, v0
    s_mul_i32 s21, s2, 625
    s_add_u32 s22, s21, 640
    s_add_u32 s21, s21, 15
    s_lshr_b32 s21, s21, 4
    s_lshr_b32 s22, s22, 4
    s_sub_u32 s22, s22, s21
    s_movk_i32 s39, 1024
    s_lshl_b32 s37, s20, 13
    s_mov_b32 s53, 163616
    s_lshl_b32 s52, s20, 2
    s_add_u32 s52, s52, s53
    s_add_u32 s68, s37, 0
    s_add_u32 s69, s37, 2048
    s_add_u32 s70, s37, 4096
    s_add_u32 s71, s37, 6144
    s_sub_u32 s30, s20, 5
    s_cmp_lt_u32 s30, 2
    s_cbranch_scc1 KS_PRE
KS_PRE2:
    s_waitcnt lgkmcnt(0)
    s_mov_b32 s8, s100
    s_and_b32 s9, s101, 0xffff
    s_mov_b32 s10, 37748736
    s_mov_b32 s11, 0x20000
    s_cmp_lg_u32 s20, 7
    s_cbranch_scc1 KS_NOTAG
    s_mov_b32 s24, 7178240
    s_mov_b64 exec, 1
    buffer_load_dword v14, v6, s[8:11], s24 offen sc1
    s_mov_b64 exec, -1
    s_barrier
    v_mov_b32 v76, 0
    v_mov_b32 v77, -1
    v_lshlrev_b32 v78, 2, v8
    v_add_u32 v78, 163424, v78
    s_mov_b64 exec, 0x1ff
    ds_write_b32 v78, v76 offset:192
    s_mov_b64 exec, 0xff
    ds_write_b32 v78, v77 offset:256
    s_mov_b64 exec, -1
    s_mov_b32 exec_hi, 0xffff
    ds_write_b32 v78, v76
    s_mov_b64 exec, 0x3f
    ds_write_b32 v78, v76 offset:228
    s_mov_b64 exec, -1
    s_mov_b64 exec, 1
    v_mov_b32 v12, 163728
    s_waitcnt vmcnt(0)
    v_add_u32 v14, 1, v14
    ds_write_b32 v12, v14
KS_TAGOK2:
    s_mov_b64 exec, -1
    s_waitcnt lgkmcnt(0)
    s_barrier
    s_branch KS_B3
KS_H0:
    s_barrier
    s_branch KS_HELP
K2_PAD_S1:
    s_branch KS_HOP0
KS_NOTAG:
    s_cmp_ge_u32 s20, 5
    s_cbranch_scc1 KS_HELP
    s_cmp_ge_u32 s2, 250
    s_cbranch_scc1 KS_IDLE
    s_mov_b32 s40, s88
    s_and_b32 s41, s89, 0xffff
    s_mov_b32 s42, 1280000
    s_mov_b32 s43, 0x20000
    buffer_load_dwordx4 v[12:15], v5, s[40:43], s64 offen
    s_mov_b32 s44, s86
    s_and_b32 s45, s87, 0xffff
    s_mov_b32 s46, 1280000
    s_mov_b32 s47, 0x20000
    s_mov_b32 s48, s82
    s_and_b32 s49, s83, 0xffff
    s_mov_b32 s50, 1920000
    s_mov_b32 s51, 0x20000
    buffer_load_dwordx4 v[16:19], v5, s[44:47], s64 offen
    buffer_load_dwordx4 v[20:23], v4, s[48:51], s65 offen
    buffer_load_dwordx2 v[24:25], v4, s[48:51], s65 offen offset:16
    v_lshlrev_b32 v2, 2, v0
    s_lshl_b32 s64, s64, 3
    v_lshl_add_u32 v3, v0, 7, s64
    v_mov_b32 v7, 1
    s_cmp_eq_u32 s20, 4
    s_cbranch_scc1 KS_NOCLR
    ds_write_b32 v2, v6
KS_NOCLR:
    s_waitcnt lgkmcnt(0)
    s_barrier
    s_mov_b64 exec, 0
    s_cmp_eq_u32 s20, 0
    s_cbranch_scc1 K2_PAD_B3
    s_cmp_eq_u32 s20, 1
    s_cbranch_scc1 K2_PAD_LD
    s_cmp_eq_u32 s20, 2
    s_cbranch_scc1 K2_PAD_NW
    s_cmp_eq_u32 s20, 3
    s_cbranch_scc1 K2_PAD_SC
    s_cmp_eq_u32 s20, 4
    s_cbranch_scc1 K2_PAD_SD
KS_HOP:
    s_mov_b64 exec, -1
    v_mul_u32_u24 v76, 2979, v0
    v_lshrrev_b32 v76, 16, v76
    v_mul_u32_u24 v77, 2048, v76
    v_lshl_add_u32 v78, v0, 4, v77
    v_add_u32 v78, 67584, v78
    v_add_u32 v79, 67200, v78
    v_mov_b32 v80, -1
    v_mov_b32 v81, -1
    v_cmp_gt_u32 vcc, 14, v76
    v_cmp_gt_u32 s[56:57], 12, v76
    v_mov_b32 v82, -1
    v_mov_b32 v83, -1
    s_mov_b64 exec, vcc
    ds_write_b128 v78, v[80:83]
    ds_write_b128 v78, v[80:83] offset:33600
    s_mov_b64 exec, s[56:57]
    ds_write_b128 v79, v[80:83]
    s_mov_b64 exec, -1
    s_mov_b32 s58, 429497
    s_movk_i32 s59, 625
    s_waitcnt vmcnt(3)
    v_mul_u32_u24 v28, s58, v12
    v_lshrrev_b32 v32, 27, v28
    v_bfe_u32 v36, v28, 24, 3
    v_lshlrev_b32 v32, 2, v32
    v_lshl_or_b32 v32, v36, 7, v32
    ds_add_rtn_u32 v36, v32, v7
    v_mul_u32_u24 v29, s58, v13
    v_lshrrev_b32 v33, 27, v29
    v_bfe_u32 v37, v29, 24, 3
    v_lshlrev_b32 v33, 2, v33
    v_lshl_or_b32 v33, v37, 7, v33
    ds_add_rtn_u32 v37, v33, v7
    v_mul_u32_u24 v30, s58, v14
    v_lshrrev_b32 v34, 27, v30
    v_bfe_u32 v38, v30, 24, 3
    v_lshlrev_b32 v34, 2, v34
    v_lshl_or_b32 v34, v38, 7, v34
    ds_add_rtn_u32 v38, v34, v7
    v_mul_u32_u24 v31, s58, v15
    v_lshrrev_b32 v35, 27, v31
    v_bfe_u32 v39, v31, 24, 3
    v_lshlrev_b32 v35, 2, v35
    v_lshl_or_b32 v35, v39, 7, v35
    ds_add_rtn_u32 v39, v35, v7
    v_lshrrev_b32 v28, 24, v28
    v_mad_u32_u24 v28, v28, s59, 15
    v_lshrrev_b32 v28, 4, v28
    v_sub_u32 v28, v12, v28
    v_add_u32 v12, 0, v3
    v_lshl_or_b32 v28, v28, 26, v12
    v_lshrrev_b32 v29, 24, v29
    v_mad_u32_u24 v29, v29, s59, 15
    v_lshrrev_b32 v29, 4, v29
    v_sub_u32 v29, v13, v29
    v_add_u32 v13, 32, v3
    v_lshl_or_b32 v29, v29, 26, v13
    v_lshrrev_b32 v30, 24, v30
    v_mad_u32_u24 v30, v30, s59, 15
    v_lshrrev_b32 v30, 4, v30
    v_sub_u32 v30, v14, v30
    v_add_u32 v14, 64, v3
    v_lshl_or_b32 v30, v30, 26, v14
    v_lshrrev_b32 v31, 24, v31
    v_mad_u32_u24 v31, v31, s59, 15
    v_lshrrev_b32 v31, 4, v31
    v_sub_u32 v31, v15, v31
    v_add_u32 v15, 96, v3
    v_lshl_or_b32 v31, v31, 26, v15
K2_PAD_S2:
    s_cbranch_execz KS_HOP0
    v_mov_b32 v59, 163728
    s_mul_i32 s65, s2, 1152
    s_add_u32 s65, s65, 6291456
    s_mul_i32 s64, s2, 20608
    s_waitcnt lgkmcnt(0)
    s_barrier
    ds_read_b128 v[40:43], v9
    ds_read_b32 v59, v59
    s_waitcnt lgkmcnt(1)
    v_add_u32 v45, v40, v41
    v_add_u32 v46, v45, v42
    v_add_u32 v47, v46, v43
    v_mov_b32 v58, v47
    s_nop 1
    v_add_u32_dpp v58, v58, v58 row_shr:1 row_mask:0xf bank_mask:0xf bound_ctrl:0
    s_nop 1
    v_add_u32_dpp v58, v58, v58 row_shr:2 row_mask:0xf bank_mask:0xf bound_ctrl:0
    s_nop 1
    v_add_u32_dpp v58, v58, v58 row_shr:4 row_mask:0xf bank_mask:0xf bound_ctrl:0
    s_nop 1
    v_add_u32_dpp v58, v58, v58 row_shr:8 row_mask:0xf bank_mask:0xf bound_ctrl:0
    s_nop 1
    v_add_u32_dpp v58, v58, v58 row_bcast:15 row_mask:0xa bank_mask:0xf
    s_nop 1
    v_add_u32_dpp v58, v58, v58 row_bcast:31 row_mask:0xc bank_mask:0xf
    v_sub_u32 v48, v58, v47
    v_add_u32 v49, v48, v40
    v_add_u32 v50, v48, v45
    v_add_u32 v51, v48, v46
    ds_write_b128 v9, v[48:51] offset:1024
    s_waitcnt vmcnt(0) lgkmcnt(1)
    s_cmp_lg_u32 s20, 4
    s_cbranch_scc1 KS_NOPUB
    v_lshl_or_b32 v56, v49, 11, v48
    v_lshl_or_b32 v57, v51, 11, v50
    v_lshl_or_b32 v56, v59, 22, v56
    v_lshl_or_b32 v57, v59, 22, v57
    buffer_store_dwordx4 v[56:59], v9, s[8:11], s65 offen sc1
KS_NOPUB:
    s_waitcnt lgkmcnt(0)
    ds_read_b32 v32, v32 offset:1024
    ds_read_b32 v33, v33 offset:1024
    ds_read_b32 v34, v34 offset:1024
    ds_read_b32 v35, v35 offset:1024
    v_and_b32 v60, 0xffff, v59
    v_and_b32 v61, 0xffff0000, v59
    s_mov_b32 s58, 0xffff0000
    v_mov_b32 v40, v20
    v_lshl_or_b32 v41, v21, 16, v60
    v_or_b32 v42, v61, v16
    v_mov_b32 v43, v28
    v_alignbit_b32 v44, v22, v21, 16
    v_and_or_b32 v45, v22, s58, v60
    v_or_b32 v46, v61, v17
    v_mov_b32 v47, v29
    v_mov_b32 v48, v23
    v_lshl_or_b32 v49, v24, 16, v60
    v_or_b32 v50, v61, v18
    v_mov_b32 v51, v30
    v_alignbit_b32 v52, v25, v24, 16
    v_and_or_b32 v53, v25, s58, v60
    v_or_b32 v54, v61, v19
    v_mov_b32 v55, v31
    s_waitcnt lgkmcnt(0)
    v_add_lshl_u32 v32, v32, v36, 4
    ds_write_b128 v32, v[40:43] offset:2048
    v_add_lshl_u32 v33, v33, v37, 4
    ds_write_b128 v33, v[44:47] offset:2048
    v_add_lshl_u32 v34, v34, v38, 4
    ds_write_b128 v34, v[48:51] offset:2048
    v_add_lshl_u32 v35, v35, v39, 4
    ds_write_b128 v35, v[52:55] offset:2048
    s_waitcnt lgkmcnt(0)
    s_barrier
    ds_read_b128 v[12:15], v5 offset:2048
    ds_read_b128 v[16:19], v5 offset:7168
    ds_read_b128 v[20:23], v5 offset:12288
    ds_read_b128 v[24:27], v5 offset:17408
    s_waitcnt lgkmcnt(3)
    buffer_store_dwordx4 v[12:15], v5, s[8:11], s64 offen sc1
    s_add_u32 s64, s64, 5120
    s_waitcnt lgkmcnt(2)
    buffer_store_dwordx4 v[16:19], v5, s[8:11], s64 offen sc1
    s_add_u32 s64, s64, 5120
    s_waitcnt lgkmcnt(1)
    buffer_store_dwordx4 v[20:23], v5, s[8:11], s64 offen sc1
    s_add_u32 s64, s64, 5120
    s_waitcnt lgkmcnt(0)
    buffer_store_dwordx4 v[24:27], v5, s[8:11], s64 offen sc1
    s_branch KS_JOIN
K2_PAD_B3:
    s_branch KS_HOP
KS_B3:
    v_mov_b32 v59, 163728
    ds_read_b32 v59, v59
    s_waitcnt lgkmcnt(0)
    s_barrier
KS_JOIN:
    v_readfirstlane_b32 s2, v59
    s_mov_b32 s23, 0
    s_mov_b32 s28, 1
    s_mov_b32 s24, 0
    s_mov_b32 s25, 1
K2_CELLS:
    v_lshrrev_b32 v178, 1, v177
    v_min_u32 v178, 249, v178
    v_mul_u32_u24 v72, 1152, v178
    s_and_b32 s58, s54, 7
    s_lshl_b32 s58, s58, 7
    s_lshr_b32 s59, s54, 5
    s_lshl_b32 s59, s59, 4
    s_add_u32 s67, s58, s59
    s_add_u32 s67, s67, 6291456
    buffer_load_dwordx4 v[76:79], v72, s[8:11], s67 offen sc1
    s_cmp_eq_u32 s28, 0
    s_cbranch_scc1 K2_NOSRD
    s_mov_b32 s4, s80
    s_and_b32 s5, s81, 0xffff
    s_mov_b32 s6, 10240000
    s_mov_b32 s7, 0x20000
    s_mov_b32 s12, s96
    s_and_b32 s13, s97, 0xffff
    s_mov_b32 s14, 10240000
    s_mov_b32 s15, 0x20000
    s_mov_b32 s16, s84
    s_and_b32 s17, s85, 0xffff
    s_mov_b32 s18, 10240000
    s_mov_b32 s19, 0x20000
    s_sub_u32 s80, s80, 1024
    s_subb_u32 s81, s81, 0
    s_mov_b32 s72, s80
    s_and_b32 s73, s81, 0xffff
    s_mov_b32 s74, 10241024
    s_mov_b32 s75, 0x20000
    s_mov_b64 exec, 0
    s_cmp_eq_u32 s20, 0
    s_cbranch_scc1 K2_PAD_U20
    s_cmp_eq_u32 s20, 1
    s_cbranch_scc1 K2_PAD_U30
    s_cmp_eq_u32 s20, 2
    s_cbranch_scc1 K2_PAD_U21
    s_cmp_eq_u32 s20, 3
    s_cbranch_scc1 K2_PAD_U31
    s_cmp_eq_u32 s20, 4
    s_cbranch_scc1 K2_PAD_SW
    s_cmp_eq_u32 s20, 5
    s_cbranch_scc1 K2_PAD_TL
    s_cmp_eq_u32 s20, 6
    s_cbranch_scc1 K2_PAD_T2
    s_cmp_eq_u32 s20, 7
    s_cbranch_scc1 K2_PAD_OV
K2_HOP:
    s_mov_b64 exec, -1
K2_NOSRD:
    v_and_b32 v84, 15, v176
    v_lshrrev_b32 v85, 5, v176
    v_bfe_u32 v86, v176, 4, 1
    v_lshrrev_b32 v87, 2, v84
    v_and_b32 v88, 3, v84
    v_lshl_add_u32 v89, v85, 3, v87
    v_lshlrev_b32 v249, 5, v89
    v_lshl_add_u32 v249, v88, 3, v249
    v_add_u32 v249, 864, v249
    v_mul_u32_u24 v250, 192, v86
    v_lshl_add_u32 v250, v85, 5, v250
    v_lshrrev_b32 v90, 1, v88
    v_lshl_add_u32 v90, v86, 1, v90
    v_bfe_u32 v91, v87, 1, 1
    v_lshlrev_b32 v91, 2, v91
    v_xor_b32 v90, v90, v91
    v_lshlrev_b32 v90, 4, v90
    v_lshl_add_u32 v90, v89, 7, v90
    v_and_b32 v91, 1, v88
    v_lshl_add_u32 v90, v91, 3, v90
    v_add_u32 v246, s37, v90
    v_xor_b32 v247, 64, v246
    v_lshrrev_b32 v90, 3, v176
    v_lshlrev_b32 v251, 2, v90
    v_add_u32 v251, 768, v251
    v_bfe_u32 v90, v90, 1, 1
    v_lshlrev_b32 v90, 2, v90
    v_and_b32 v91, 7, v176
    v_xor_b32 v90, v90, v91
    v_lshlrev_b32 v248, 4, v90
    v_lshlrev_b32 v252, 1, v176
    v_and_b32 v231, 1, v176
    v_lshlrev_b32 v231, 4, v231
    v_lshrrev_b32 v90, 1, v176
    v_lshlrev_b32 v90, 5, v90
    v_add_u32 v230, 864, v90
    s_lshl_b32 s59, s2, 22
    s_mov_b32 s60, 0x40000
    s_bfe_u32 s61, s54, 0x10004
    s_bfe_u32 s62, s54, 0x10003
    s_add_u32 s63, s61, s62
    s_mul_i32 s62, s62, 11
    s_sub_u32 s64, 11, s62
    v_cmp_gt_u32 vcc, 500, v177
    s_nop 0
    s_mov_b64 s[56:57], vcc
K2_POLL:
    s_waitcnt vmcnt(0)
    v_xor_b32 v73, s59, v76
    v_xor_b32 v74, s59, v77
    v_or_b32 v73, v73, v74
    v_xor_b32 v74, s2, v79
    v_lshrrev_b32 v73, 22, v73
    v_or_b32 v73, v73, v74
    v_cmp_ne_u32 vcc, 0, v73
    s_nop 0
    s_cbranch_vccz K2_POLLED
    s_sub_u32 s60, s60, 1
    s_cbranch_scc1 K2_END
    s_mov_b64 exec, vcc
    buffer_load_dwordx4 v[76:79], v72, s[8:11], s67 offen sc1
    s_mov_b64 exec, -1
    s_branch K2_POLL
K2_PAD_LD:
    s_branch KS_HOP
K2_POLLED:
    s_set_gpr_idx_on s61, gpr_idx(SRC0)
    s_nop 0
    v_bfe_u32 v179, v76, s62, 11
    s_set_gpr_idx_idx s63
    s_nop 0
    v_bfe_u32 v73, v76, s64, 11
    s_set_gpr_idx_off
    v_sub_u32 v73, v73, v179
    v_cndmask_b32 v73, 0, v73, s[56:57]
    v_and_b32 v1, 1, v177
    v_add_u32 v1, s23, v1
    v_sub_u32 v180, v73, v1
    v_add_u32 v179, v179, v1
    v_mul_u32_u24 v181, 20608, v178
    v_lshl_add_u32 v181, v179, 4, v181
    v_cmp_lt_i32 s[40:41], 0, v180
    v_add_u32 v182, 32, v181
    s_mov_b32 s65, 0
    s_mov_b64 exec, s[40:41]
    buffer_load_dwordx4 v[0:3], v181, s[8:11], 0 offen offset:0 sc1
    s_mov_b64 exec, -1
    v_cmp_lt_i32 s[42:43], 2, v180
    v_cmp_lt_i32 s[44:45], 4, v180
    v_cmp_lt_i32 s[46:47], 6, v180
    v_cmp_lt_i32 s[48:49], 8, v180
    v_cmp_lt_i32 s[50:51], 10, v180
    v_cmp_lt_i32 s[90:91], 12, v180
    v_cmp_lt_i32 s[92:93], 14, v180
    v_cmp_lt_i32 s[94:95], 16, v180
    v_cmp_lt_i32 s[96:97], 18, v180
    v_add_u32 v183, 64, v181
    v_add_u32 v184, 96, v181
    v_subrev_u32 v62, 1, v180
    v_ashrrev_i32 v62, 1, v62
    v_med3_i32 v62, v62, 0, 9
    s_cmp_eq_u64 s[42:43], 0
    s_cbranch_scc1 K2_LD_DONE
    v_mov_b32 v63, v62
    s_nop 1
    v_add_u32_dpp v63, v63, v63 row_shr:1 row_mask:0xf bank_mask:0xf bound_ctrl:0
    s_nop 1
    v_add_u32_dpp v63, v63, v63 row_shr:2 row_mask:0xf bank_mask:0xf bound_ctrl:0
    s_nop 1
    v_add_u32_dpp v63, v63, v63 row_shr:4 row_mask:0xf bank_mask:0xf bound_ctrl:0
    s_nop 1
    v_add_u32_dpp v63, v63, v63 row_shr:8 row_mask:0xf bank_mask:0xf bound_ctrl:0
    s_nop 1
    v_add_u32_dpp v63, v63, v63 row_bcast:15 row_mask:0xa bank_mask:0xf
    s_nop 1
    v_add_u32_dpp v63, v63, v63 row_bcast:31 row_mask:0xc bank_mask:0xf
    s_lshl_b32 s58, s20, 10
    s_add_u32 s58, s58, 45056
    v_readlane_b32 s59, v63, 63
    v_sub_u32 v63, v63, v62
    v_lshl_add_u32 v64, v63, 2, s58
    v_lshlrev_b32 v63, 5, v63
    v_sub_u32 v63, v182, v63
    s_cmp_gt_u32 s59, 189
    s_cbranch_scc1 K2_LD_GEN
    s_mov_b64 exec, s[42:43]
    s_cbranch_execz K2_LD_L
    ds_write_b32 v64, v63 offset:0
    s_mov_b64 exec, s[44:45]
    s_cbranch_execz K2_LD_L
    ds_write_b32 v64, v63 offset:4
    s_mov_b64 exec, s[46:47]
    s_cbranch_execz K2_LD_L
    ds_write_b32 v64, v63 offset:8
    s_mov_b64 exec, s[48:49]
    s_cbranch_execz K2_LD_L
    ds_write_b32 v64, v63 offset:12
    s_mov_b64 exec, s[50:51]
    s_cbranch_execz K2_LD_L
    ds_write_b32 v64, v63 offset:16
    s_mov_b64 exec, s[90:91]
    s_cbranch_execz K2_LD_L
    ds_write_b32 v64, v63 offset:20
    s_mov_b64 exec, s[92:93]
    s_cbranch_execz K2_LD_L
    ds_write_b32 v64, v63 offset:24
    s_mov_b64 exec, s[94:95]
    s_cbranch_execz K2_LD_L
    ds_write_b32 v64, v63 offset:28
    s_mov_b64 exec, s[96:97]
    s_cbranch_execz K2_LD_L
    ds_write_b32 v64, v63 offset:32
K2_LD_L:
    s_mov_b64 exec, -1
    v_lshl_add_u32 v63, v176, 2, s58
    v_lshlrev_b32 v62, 5, v176
    s_waitcnt lgkmcnt(0)
    ds_read_b32 v64, v63 offset:0
    ds_read_b32 v65, v63 offset:252
    ds_read_b32 v66, v63 offset:504
    s_min_u32 s60, s59, 63
    s_sub_u32 s59, s59, s60
    s_bfm_b64 s[42:43], s60, 0
    s_min_u32 s60, s59, 63
    s_sub_u32 s59, s59, s60
    s_bfm_b64 s[44:45], s60, 0
    s_min_u32 s60, s59, 63
    s_sub_u32 s59, s59, s60
    s_bfm_b64 s[46:47], s60, 0
    s_mov_b64 s[48:49], 0
    s_mov_b32 s65, 1
    s_mov_b32 s60, 0
    s_waitcnt lgkmcnt(2)
    v_add3_u32 v182, v62, v64, s60
    s_mov_b64 exec, s[42:43]
    buffer_load_dwordx4 v[4:7], v182, s[8:11], 0 offen sc1
    s_mov_b32 s60, 2016
    s_waitcnt lgkmcnt(1)
    v_add3_u32 v183, v62, v65, s60
    s_mov_b64 exec, s[44:45]
    buffer_load_dwordx4 v[8:11], v183, s[8:11], 0 offen sc1
    s_mov_b32 s60, 4032
    s_waitcnt lgkmcnt(0)
    v_add3_u32 v184, v62, v66, s60
    s_mov_b64 exec, s[46:47]
    buffer_load_dwordx4 v[12:15], v184, s[8:11], 0 offen sc1
K2_LD_DONE:
    s_mov_b64 exec, -1
    s_cmp_eq_u32 s28, 0
    s_cbranch_scc1 K2_NOWRAW
    v_lshrrev_b32 v60, 5, v176
    v_bfe_u32 v61, v176, 2, 2
    v_lshl_add_u32 v60, v60, 2, v61
    v_mul_u32_u24 v60, 1280, v60
    v_bfe_u32 v61, v176, 4, 1
    v_lshl_add_u32 v60, v61, 5, v60
    v_and_b32 v61, 3, v176
    v_lshl_add_u32 v60, v61, 3, v60
    ds_read_b64_tr_b16 v[136:137], v60 offset:24576
    ds_read_b64_tr_b16 v[138:139], v60 offset:34816
    ds_read_b64_tr_b16 v[140:141], v60 offset:24640
    ds_read_b64_tr_b16 v[142:143], v60 offset:34880
    ds_read_b64_tr_b16 v[144:145], v60 offset:24832
    ds_read_b64_tr_b16 v[146:147], v60 offset:35072
    ds_read_b64_tr_b16 v[148:149], v60 offset:24896
    ds_read_b64_tr_b16 v[150:151], v60 offset:35136
    ds_read_b64_tr_b16 v[152:153], v60 offset:25088
    ds_read_b64_tr_b16 v[154:155], v60 offset:35328
    ds_read_b64_tr_b16 v[156:157], v60 offset:25152
    ds_read_b64_tr_b16 v[158:159], v60 offset:35392
    ds_read_b64_tr_b16 v[160:161], v60 offset:25344
    ds_read_b64_tr_b16 v[162:163], v60 offset:35584
    ds_read_b64_tr_b16 v[164:165], v60 offset:25408
    ds_read_b64_tr_b16 v[166:167], v60 offset:35648
    ds_read_b64_tr_b16 v[168:169], v60 offset:25600
    ds_read_b64_tr_b16 v[170:171], v60 offset:35840
    ds_read_b64_tr_b16 v[172:173], v60 offset:25664
    ds_read_b64_tr_b16 v[174:175], v60 offset:35904
    s_waitcnt lgkmcnt(0)
    v_lshlrev_b32 v96, 16, v136
    v_and_b32 v97, 0xffff0000, v136
    v_lshlrev_b32 v98, 16, v137
    v_and_b32 v99, 0xffff0000, v137
    v_lshlrev_b32 v100, 16, v138
    v_and_b32 v101, 0xffff0000, v138
    v_lshlrev_b32 v102, 16, v139
    v_and_b32 v103, 0xffff0000, v139
    v_lshlrev_b32 v104, 16, v140
    v_and_b32 v105, 0xffff0000, v140
    v_lshlrev_b32 v106, 16, v141
    v_and_b32 v107, 0xffff0000, v141
    v_lshlrev_b32 v108, 16, v142
    v_and_b32 v109, 0xffff0000, v142
    v_lshlrev_b32 v110, 16, v143
    v_and_b32 v111, 0xffff0000, v143
    v_lshlrev_b32 v112, 16, v144
    v_and_b32 v113, 0xffff0000, v144
    v_lshlrev_b32 v114, 16, v145
    v_and_b32 v115, 0xffff0000, v145
    v_lshlrev_b32 v116, 16, v146
    v_and_b32 v117, 0xffff0000, v146
    v_lshlrev_b32 v118, 16, v147
    v_and_b32 v119, 0xffff0000, v147
    v_lshlrev_b32 v120, 16, v148
    v_and_b32 v121, 0xffff0000, v148
    v_lshlrev_b32 v122, 16, v149
    v_and_b32 v123, 0xffff0000, v149
    v_lshlrev_b32 v124, 16, v150
    v_and_b32 v125, 0xffff0000, v150
    v_lshlrev_b32 v126, 16, v151
    v_and_b32 v127, 0xffff0000, v151
    v_lshlrev_b32 v128, 16, v152
    v_and_b32 v129, 0xffff0000, v152
    v_lshlrev_b32 v130, 16, v153
    v_and_b32 v131, 0xffff0000, v153
    v_lshlrev_b32 v132, 16, v154
    v_and_b32 v133, 0xffff0000, v154
    v_lshlrev_b32 v134, 16, v155
    v_and_b32 v135, 0xffff0000, v155
    v_lshlrev_b32 v136, 16, v156
    v_and_b32 v137, 0xffff0000, v156
    v_lshlrev_b32 v138, 16, v157
    v_and_b32 v139, 0xffff0000, v157
    v_lshlrev_b32 v140, 16, v158
    v_and_b32 v141, 0xffff0000, v158
    v_lshlrev_b32 v142, 16, v159
    v_and_b32 v143, 0xffff0000, v159
    v_lshlrev_b32 v144, 16, v160
    v_and_b32 v145, 0xffff0000, v160
    v_lshlrev_b32 v146, 16, v161
    v_and_b32 v147, 0xffff0000, v161
    v_lshlrev_b32 v148, 16, v162
    v_and_b32 v149, 0xffff0000, v162
    v_lshlrev_b32 v150, 16, v163
    v_and_b32 v151, 0xffff0000, v163
    v_lshlrev_b32 v152, 16, v164
    v_and_b32 v153, 0xffff0000, v164
    v_lshlrev_b32 v154, 16, v165
    v_and_b32 v155, 0xffff0000, v165
    v_lshlrev_b32 v156, 16, v166
    v_and_b32 v157, 0xffff0000, v166
    v_lshlrev_b32 v158, 16, v167
    v_and_b32 v159, 0xffff0000, v167
    v_lshlrev_b32 v160, 16, v168
    v_and_b32 v161, 0xffff0000, v168
    v_lshlrev_b32 v162, 16, v169
    v_and_b32 v163, 0xffff0000, v169
    v_lshlrev_b32 v164, 16, v170
    v_and_b32 v165, 0xffff0000, v170
    v_lshlrev_b32 v166, 16, v171
    v_and_b32 v167, 0xffff0000, v171
    v_lshlrev_b32 v168, 16, v172
    v_and_b32 v169, 0xffff0000, v172
    v_lshlrev_b32 v170, 16, v173
    v_and_b32 v171, 0xffff0000, v173
    v_lshlrev_b32 v172, 16, v174
    v_and_b32 v173, 0xffff0000, v174
    v_lshlrev_b32 v174, 16, v175
    v_and_b32 v175, 0xffff0000, v175
K2_NOWRAW:
K2_PAD_NW:
    s_cbranch_execz KS_HOP
    v_lshrrev_b32 v179, 2, v181
    v_lshrrev_b32 v185, 2, v182
    v_lshrrev_b32 v186, 2, v183
    v_lshrrev_b32 v187, 2, v184
    s_mov_b32 s66, 7340032
    v_mov_b32 v201, 1
    s_movk_i32 s58, 600
    s_movk_i32 s59, 2400
    s_mov_b32 s60, 0x40000
    s_mov_b32 s61, 0xffff
    v_mov_b32 v202, 65536
    s_cmp_lg_u32 s24, 0
    s_cbranch_scc1 K2_RK_LOAD
    v_cmp_lt_i32 vcc, 20, v180
    s_nop 0
    s_cbranch_vccz K2_NOMORE
    v_mov_b32 v61, 163652
    ds_write_b32 v61, v201
K2_NOMORE:
    v_lshlrev_b32 v72, 4, v176
    s_mov_b32 s64, 7176192
    s_mov_b32 s62, 84736
    s_cmp_eq_u32 s65, 0
    s_waitcnt vmcnt(3)
    s_cbranch_scc0 K2_ARR
    s_waitcnt vmcnt(0)
K2_ARR:
    s_mov_b64 exec, s[40:41]
    s_cbranch_execz K2_RK_A
K2_CK0:
    v_bfi_b32 v192, s61, v1, v2
    v_lshrrev_b32 v50, 24, v3
    v_cmp_ne_u32 vcc, s2, v192
    v_add_u32 v40, 163424, v50
    s_cbranch_vccnz K2_RT0
    ds_add_rtn_u32 v40, v40, v201
    v_mad_u32_u24 v50, v50, s58, v202
    s_mov_b64 exec, s[42:43]
    s_cbranch_execz K2_RK_A
    s_waitcnt vmcnt(2)
K2_CK1:
    v_bfi_b32 v192, s61, v5, v6
    v_lshrrev_b32 v51, 24, v7
    v_cmp_ne_u32 vcc, s2, v192
    v_add_u32 v41, 163424, v51
    s_cbranch_vccnz K2_RT1
    ds_add_rtn_u32 v41, v41, v201
    v_mad_u32_u24 v51, v51, s58, v202
    s_mov_b64 exec, s[44:45]
    s_cbranch_execz K2_RK_A
    s_waitcnt vmcnt(1)
K2_CK2:
    v_bfi_b32 v192, s61, v9, v10
    v_lshrrev_b32 v52, 24, v11
    v_cmp_ne_u32 vcc, s2, v192
    v_add_u32 v42, 163424, v52
    s_cbranch_vccnz K2_RT2
    ds_add_rtn_u32 v42, v42, v201
    v_mad_u32_u24 v52, v52, s58, v202
    s_mov_b64 exec, s[46:47]
    s_cbranch_execz K2_RK_A
    s_waitcnt vmcnt(0)
K2_CK3:
    v_bfi_b32 v192, s61, v13, v14
    v_lshrrev_b32 v53, 24, v15
    v_cmp_ne_u32 vcc, s2, v192
    v_add_u32 v43, 163424, v53
    s_cbranch_vccnz K2_RT3
    ds_add_rtn_u32 v43, v43, v201
    v_mad_u32_u24 v53, v53, s58, v202
    s_mov_b64 exec, s[48:49]
    s_cbranch_execz K2_RK_A
K2_CK4:
    v_bfi_b32 v192, s61, v17, v18
    v_lshrrev_b32 v54, 24, v19
    v_cmp_ne_u32 vcc, s2, v192
    v_add_u32 v44, 163424, v54
    s_cbranch_vccnz K2_RT4
    ds_add_rtn_u32 v44, v44, v201
    v_mad_u32_u24 v54, v54, s58, v202
    s_mov_b64 exec, s[50:51]
    s_cbranch_execz K2_RK_A
K2_CK5:
    v_bfi_b32 v192, s61, v21, v22
    v_lshrrev_b32 v55, 24, v23
    v_cmp_ne_u32 vcc, s2, v192
    v_add_u32 v45, 163424, v55
    s_cbranch_vccnz K2_RT5
    ds_add_rtn_u32 v45, v45, v201
    v_mad_u32_u24 v55, v55, s58, v202
    s_mov_b64 exec, s[90:91]
    s_cbranch_execz K2_RK_A
K2_CK6:
    v_bfi_b32 v192, s61, v25, v26
    v_lshrrev_b32 v56, 24, v27
    v_cmp_ne_u32 vcc, s2, v192
    v_add_u32 v46, 163424, v56
    s_cbranch_vccnz K2_RT6
    ds_add_rtn_u32 v46, v46, v201
    v_mad_u32_u24 v56, v56, s58, v202
    s_mov_b64 exec, s[92:93]
    s_cbranch_execz K2_RK_A
K2_CK7:
    v_bfi_b32 v192, s61, v29, v30
    v_lshrrev_b32 v57, 24, v31
    v_cmp_ne_u32 vcc, s2, v192
    v_add_u32 v47, 163424, v57
    s_cbranch_vccnz K2_RT7
    ds_add_rtn_u32 v47, v47, v201
    v_mad_u32_u24 v57, v57, s58, v202
    s_mov_b64 exec, s[94:95]
    s_cbranch_execz K2_RK_A
K2_CK8:
    v_bfi_b32 v192, s61, v33, v34
    v_lshrrev_b32 v58, 24, v35
    v_cmp_ne_u32 vcc, s2, v192
    v_add_u32 v48, 163424, v58
    s_cbranch_vccnz K2_RT8
    ds_add_rtn_u32 v48, v48, v201
    v_mad_u32_u24 v58, v58, s58, v202
    s_mov_b64 exec, s[96:97]
    s_cbranch_execz K2_RK_A
K2_CK9:
    v_bfi_b32 v192, s61, v37, v38
    v_lshrrev_b32 v59, 24, v39
    v_cmp_ne_u32 vcc, s2, v192
    v_add_u32 v49, 163424, v59
    s_cbranch_vccnz K2_RT9
    ds_add_rtn_u32 v49, v49, v201
    v_mad_u32_u24 v59, v59, s58, v202
K2_RK_A:
    s_mov_b64 exec, -1
    s_cmp_eq_u32 s20, 7
    s_cbranch_scc1 K2_FLGLD
K2_FLGL2:
    s_mov_b64 exec, s[40:41]
    s_cbranch_execz K2_TP
    v_cmp_gt_u32 vcc, s62, v50
    v_and_b32 v3, 0xffffff, v3
    s_mov_b64 exec, vcc
    buffer_load_dword v245, v3, s[16:19], 0 offen
    s_mov_b64 exec, s[42:43]
    s_cbranch_execz K2_TP
    v_cmp_gt_u32 vcc, s62, v51
    v_and_b32 v7, 0xffffff, v7
    s_mov_b64 exec, vcc
    buffer_load_dword v245, v7, s[16:19], 0 offen
    s_mov_b64 exec, s[44:45]
    s_cbranch_execz K2_TP
    v_cmp_gt_u32 vcc, s62, v52
    v_and_b32 v11, 0xffffff, v11
    s_mov_b64 exec, vcc
    buffer_load_dword v245, v11, s[16:19], 0 offen
    s_mov_b64 exec, s[46:47]
    s_cbranch_execz K2_TP
    v_cmp_gt_u32 vcc, s62, v53
    v_and_b32 v15, 0xffffff, v15
    s_mov_b64 exec, vcc
    buffer_load_dword v245, v15, s[16:19], 0 offen
    s_mov_b64 exec, s[48:49]
    s_cbranch_execz K2_TP
    v_cmp_gt_u32 vcc, s62, v54
    v_and_b32 v19, 0xffffff, v19
    s_mov_b64 exec, vcc
    buffer_load_dword v245, v19, s[16:19], 0 offen
    s_mov_b64 exec, s[50:51]
    s_cbranch_execz K2_TP
    v_cmp_gt_u32 vcc, s62, v55
    v_and_b32 v23, 0xffffff, v23
    s_mov_b64 exec, vcc
    buffer_load_dword v245, v23, s[16:19], 0 offen
    s_mov_b64 exec, s[90:91]
    s_cbranch_execz K2_TP
    v_cmp_gt_u32 vcc, s62, v56
    v_and_b32 v27, 0xffffff, v27
    s_mov_b64 exec, vcc
    buffer_load_dword v245, v27, s[16:19], 0 offen
    s_mov_b64 exec, s[92:93]
    s_cbranch_execz K2_TP
    v_cmp_gt_u32 vcc, s62, v57
    v_and_b32 v31, 0xffffff, v31
    s_mov_b64 exec, vcc
    buffer_load_dword v245, v31, s[16:19], 0 offen
    s_mov_b64 exec, s[94:95]
    s_cbranch_execz K2_TP
    v_cmp_gt_u32 vcc, s62, v58
    v_and_b32 v35, 0xffffff, v35
    s_mov_b64 exec, vcc
    buffer_load_dword v245, v35, s[16:19], 0 offen
    s_mov_b64 exec, s[96:97]
    s_cbranch_execz K2_TP
    v_cmp_gt_u32 vcc, s62, v59
    v_and_b32 v39, 0xffffff, v39
    s_mov_b64 exec, vcc
    buffer_load_dword v245, v39, s[16:19], 0 offen
K2_TP:
    s_mov_b64 exec, -1
K2_RK_DONE:
K2_PAD_SC:
    s_cbranch_execz KS_HOP
    s_mul_i32 s67, s24, 48
    s_mov_b32 s58, 1
    s_waitcnt lgkmcnt(0)
    s_mov_b64 exec, s[40:41]
    s_cbranch_execz K2_SC_DONE
    v_cmpx_gt_u32 vcc, 48, v40
    v_lshl_add_u32 v194, v40, 5, v50
    v_lshl_add_u32 v195, v40, 2, v50
    v_lshrrev_b32 v193, 3, v40
    v_mad_i32_i24 v196, v193, -16, v195
    v_and_b32 v193, 1, v193
    v_mad_i32_i24 v196, v193, -14, v196
    ds_write_b32 v194, v3 offset:864
    ds_write_b16 v195, v0 offset:194
    ds_write_b16_d16_hi v195, v0 offset:386
    ds_write_b16_d16_hi v195, v1 offset:578
    ds_write_b16 v196, v2 offset:768
    s_cmp_lg_u64 exec, s[40:41]
    s_addc_u32 s58, s58, s58
    s_mov_b64 exec, s[42:43]
    s_cbranch_execz K2_SC_DONE
    v_cmpx_gt_u32 vcc, 48, v41
    v_lshl_add_u32 v194, v41, 5, v51
    v_lshl_add_u32 v195, v41, 2, v51
    v_lshrrev_b32 v193, 3, v41
    v_mad_i32_i24 v196, v193, -16, v195
    v_and_b32 v193, 1, v193
    v_mad_i32_i24 v196, v193, -14, v196
    ds_write_b32 v194, v7 offset:864
    ds_write_b16 v195, v4 offset:194
    ds_write_b16_d16_hi v195, v4 offset:386
    ds_write_b16_d16_hi v195, v5 offset:578
    ds_write_b16 v196, v6 offset:768
    s_cmp_lg_u64 exec, s[42:43]
    s_addc_u32 s58, s58, s58
    s_mov_b64 exec, s[44:45]
    s_cbranch_execz K2_SC_DONE
    v_cmpx_gt_u32 vcc, 48, v42
    v_lshl_add_u32 v194, v42, 5, v52
    v_lshl_add_u32 v195, v42, 2, v52
    v_lshrrev_b32 v193, 3, v42
    v_mad_i32_i24 v196, v193, -16, v195
    v_and_b32 v193, 1, v193
    v_mad_i32_i24 v196, v193, -14, v196
    ds_write_b32 v194, v11 offset:864
    ds_write_b16 v195, v8 offset:194
    ds_write_b16_d16_hi v195, v8 offset:386
    ds_write_b16_d16_hi v195, v9 offset:578
    ds_write_b16 v196, v10 offset:768
    s_cmp_lg_u64 exec, s[44:45]
    s_addc_u32 s58, s58, s58
    s_mov_b64 exec, s[46:47]
    s_cbranch_execz K2_SC_DONE
    v_cmpx_gt_u32 vcc, 48, v43
    v_lshl_add_u32 v194, v43, 5, v53
    v_lshl_add_u32 v195, v43, 2, v53
    v_lshrrev_b32 v193, 3, v43
    v_mad_i32_i24 v196, v193, -16, v195
    v_and_b32 v193, 1, v193
    v_mad_i32_i24 v196, v193, -14, v196
    ds_write_b32 v194, v15 offset:864
    ds_write_b16 v195, v12 offset:194
    ds_write_b16_d16_hi v195, v12 offset:386
    ds_write_b16_d16_hi v195, v13 offset:578
    ds_write_b16 v196, v14 offset:768
    s_cmp_lg_u64 exec, s[46:47]
    s_addc_u32 s58, s58, s58
    s_mov_b64 exec, s[48:49]
    s_cbranch_execz K2_SC_DONE
    v_cmpx_gt_u32 vcc, 48, v44
    v_lshl_add_u32 v194, v44, 5, v54
    v_lshl_add_u32 v195, v44, 2, v54
    v_lshrrev_b32 v193, 3, v44
    v_mad_i32_i24 v196, v193, -16, v195
    v_and_b32 v193, 1, v193
    v_mad_i32_i24 v196, v193, -14, v196
    ds_write_b32 v194, v19 offset:864
    ds_write_b16 v195, v16 offset:194
    ds_write_b16_d16_hi v195, v16 offset:386
    ds_write_b16_d16_hi v195, v17 offset:578
    ds_write_b16 v196, v18 offset:768
    s_cmp_lg_u64 exec, s[48:49]
    s_addc_u32 s58, s58, s58
    s_mov_b64 exec, s[50:51]
    s_cbranch_execz K2_SC_DONE
    v_cmpx_gt_u32 vcc, 48, v45
    v_lshl_add_u32 v194, v45, 5, v55
    v_lshl_add_u32 v195, v45, 2, v55
    v_lshrrev_b32 v193, 3, v45
    v_mad_i32_i24 v196, v193, -16, v195
    v_and_b32 v193, 1, v193
    v_mad_i32_i24 v196, v193, -14, v196
    ds_write_b32 v194, v23 offset:864
    ds_write_b16 v195, v20 offset:194
    ds_write_b16_d16_hi v195, v20 offset:386
    ds_write_b16_d16_hi v195, v21 offset:578
    ds_write_b16 v196, v22 offset:768
    s_cmp_lg_u64 exec, s[50:51]
    s_addc_u32 s58, s58, s58
    s_mov_b64 exec, s[90:91]
    s_cbranch_execz K2_SC_DONE
    v_cmpx_gt_u32 vcc, 48, v46
    v_lshl_add_u32 v194, v46, 5, v56
    v_lshl_add_u32 v195, v46, 2, v56
    v_lshrrev_b32 v193, 3, v46
    v_mad_i32_i24 v196, v193, -16, v195
    v_and_b32 v193, 1, v193
    v_mad_i32_i24 v196, v193, -14, v196
    ds_write_b32 v194, v27 offset:864
    ds_write_b16 v195, v24 offset:194
    ds_write_b16_d16_hi v195, v24 offset:386
    ds_write_b16_d16_hi v195, v25 offset:578
    ds_write_b16 v196, v26 offset:768
    s_cmp_lg_u64 exec, s[90:91]
    s_addc_u32 s58, s58, s58
    s_mov_b64 exec, s[92:93]
    s_cbranch_execz K2_SC_DONE
    v_cmpx_gt_u32 vcc, 48, v47
    v_lshl_add_u32 v194, v47, 5, v57
    v_lshl_add_u32 v195, v47, 2, v57
    v_lshrrev_b32 v193, 3, v47
    v_mad_i32_i24 v196, v193, -16, v195
    v_and_b32 v193, 1, v193
    v_mad_i32_i24 v196, v193, -14, v196
    ds_write_b32 v194, v31 offset:864
    ds_write_b16 v195, v28 offset:194
    ds_write_b16_d16_hi v195, v28 offset:386
    ds_write_b16_d16_hi v195, v29 offset:578
    ds_write_b16 v196, v30 offset:768
    s_cmp_lg_u64 exec, s[92:93]
    s_addc_u32 s58, s58, s58
    s_mov_b64 exec, s[94:95]
    s_cbranch_execz K2_SC_DONE
    v_cmpx_gt_u32 vcc, 48, v48
    v_lshl_add_u32 v194, v48, 5, v58
    v_lshl_add_u32 v195, v48, 2, v58
    v_lshrrev_b32 v193, 3, v48
    v_mad_i32_i24 v196, v193, -16, v195
    v_and_b32 v193, 1, v193
    v_mad_i32_i24 v196, v193, -14, v196
    ds_write_b32 v194, v35 offset:864
    ds_write_b16 v195, v32 offset:194
    ds_write_b16_d16_hi v195, v32 offset:386
    ds_write_b16_d16_hi v195, v33 offset:578
    ds_write_b16 v196, v34 offset:768
    s_cmp_lg_u64 exec, s[94:95]
    s_addc_u32 s58, s58, s58
    s_mov_b64 exec, s[96:97]
    s_cbranch_execz K2_SC_DONE
    v_cmpx_gt_u32 vcc, 48, v49
    v_lshl_add_u32 v194, v49, 5, v59
    v_lshl_add_u32 v195, v49, 2, v59
    v_lshrrev_b32 v193, 3, v49
    v_mad_i32_i24 v196, v193, -16, v195
    v_and_b32 v193, 1, v193
    v_mad_i32_i24 v196, v193, -14, v196
    ds_write_b32 v194, v39 offset:864
    ds_write_b16 v195, v36 offset:194
    ds_write_b16_d16_hi v195, v36 offset:386
    ds_write_b16_d16_hi v195, v37 offset:578
    ds_write_b16 v196, v38 offset:768
    s_cmp_lg_u64 exec, s[96:97]
    s_addc_u32 s58, s58, s58
K2_SC_DONE:
    s_mov_b64 exec, -1
K2_PAD_SD:
    s_cbranch_execz KS_HOP
    s_bcnt1_i32_b32 s61, s58
    s_cmp_gt_u32 s61, 1
    s_cbranch_scc1 K2_OV
K2_OB:
    v_lshlrev_b32 v192, 2, v176
    v_add_u32 v192, 163424, v192
    v_mov_b32 v200, 163652
    v_mov_b32 v198, 0
    s_movk_i32 s26, 48
    s_cmp_eq_u32 s20, 7
    s_cbranch_scc1 K2_FLGCK
K2_FLGOK:
    s_waitcnt lgkmcnt(0)
    s_barrier
    ds_read_b32 v193, v192
    ds_read_b32 v200, v200
    v_cmp_gt_u32 s[56:57], s22, v176
    v_mad_u32_u24 v195, v176, s59, v202
    s_waitcnt lgkmcnt(0)
    v_cndmask_b32 v193, 0, v193, s[56:57]
    v_readfirstlane_b32 s27, v200
    v_cmp_lt_u32 vcc, 48, v193
    s_nop 0
    s_cbranch_vccnz K2_BIG
K2_TOK:
    v_subrev_u32 v194, s67, v193
    v_max_i32 v194, 1, v194
    v_min_i32 v194, s26, v194
    v_add_u32 v194, 15, v194
    v_lshrrev_b32 v194, 4, v194
    v_lshl_or_b32 v195, v194, 18, v195
    v_or_b32 v195, v195, v198
    v_mov_b32 v197, 425056
    v_cndmask_b32 v253, v197, v195, s[56:57]
    s_movk_i32 s40, 0
    s_movk_i32 s41, 256
    s_movk_i32 s42, 512
    s_movk_i32 s43, 768
    s_add_u32 s24, s24, 1
    s_cmp_ge_u32 s24, s25
    s_cselect_b32 s55, 1, 0
    s_cmp_eq_u32 s27, 0
    s_cselect_b32 s55, s55, 0
    s_mov_b32 s27, 0x400000
    s_mov_b32 s38, 0
    s_mov_b32 s34, 0
    s_mov_b32 s35, 0
    s_mov_b32 s36, 1
    s_mov_b32 s31, 0
    s_mov_b32 s58, s20
    v_readlane_b32 s3, v253, s58
    s_lshl_b32 s44, s34, 7
    s_lshl_b32 s60, s58, 5
    s_and_b32 s48, s3, 0x3ffff
    s_bfe_u32 s33, s3, 0x30012
    s_sub_u32 s60, s60, s48
    s_and_b32 s60, s60, 0xff
    s_add_u32 s60, s60, s48
    s_mul_i32 s35, s38, 6
    s_cmp_eq_u32 s34, 0
    s_cselect_b32 s35, s35, s60
    s_mov_b32 s45, s44
    s_add_u32 s47, s44, 256
    s_add_u32 s49, s48, 32
    s_add_u32 s60, s48, 64
    s_cmp_eq_u32 s33, 3
    s_cselect_b32 s46, s44, s47
    s_cselect_b32 s50, s60, s48
    s_cselect_b32 s51, s48, s49
    s_sub_u32 s60, s33, 2
    s_cmp_lt_u32 s60, 2
    s_cbranch_scc0 K2_rare_1
K2_back_2:
    v_add_u32 v233, s48, v230
    ds_read_b32 v232, v233
    ds_read_b32 v233, v233 offset:1024
    v_add_u32 v222, s48, v251
    ds_read_b32 v222, v222
    v_add_u32 v224, s49, v251
    ds_read_b32 v224, v224
    v_add_u32 v226, s50, v251
    ds_read_b32 v226, v226
    v_add_u32 v228, s51, v251
    ds_read_b32 v228, v228
    s_waitcnt lgkmcnt(4)
    v_or_b32 v232, v232, v231
    v_or_b32 v233, v233, v231
    s_cmp_lg_u32 s34, 0
    s_cbranch_scc1 K2_dum_4
    s_add_u32 m0, s48, 864
    s_add_u32 s65, s48, 1888
    buffer_load_dwordx4 v232, s[16:19], 0 offen  lds
    s_mov_b32 m0, s65
    s_mov_b32 exec_hi, 0
    buffer_load_dwordx4 v233, s[16:19], 0 offen  lds
    s_cmp_eq_u32 s33, 4
    s_cbranch_scc1 K2_a4_5
K2_b4_7:
    s_mov_b32 exec_hi, -1
K2_back_6:
    s_waitcnt lgkmcnt(3)
    v_mad_u32_u16 v223, v222, s39, v248 op_sel:[1,0,0,0]
    v_mad_u32_u16 v222, v222, s39, v248
    s_waitcnt lgkmcnt(2)
    v_mad_u32_u16 v225, v224, s39, v248 op_sel:[1,0,0,0]
    v_mad_u32_u16 v224, v224, s39, v248
    s_waitcnt lgkmcnt(1)
    v_mad_u32_u16 v227, v226, s39, v248 op_sel:[1,0,0,0]
    v_mad_u32_u16 v226, v226, s39, v248
    s_waitcnt lgkmcnt(0)
    v_mad_u32_u16 v229, v228, s39, v248 op_sel:[1,0,0,0]
    v_mad_u32_u16 v228, v228, s39, v248
    s_mov_b32 m0, s68
    s_nop 0
    buffer_load_dwordx4 v222, s[4:7], s44 offen sc1 lds
    buffer_load_dwordx4 v223, s[72:75], s44 offen offset:1024 sc1 lds
    s_mov_b32 m0, s69
    s_nop 0
    buffer_load_dwordx4 v224, s[4:7], s45 offen sc1 lds
    buffer_load_dwordx4 v225, s[72:75], s45 offen offset:1024 sc1 lds
    s_mov_b32 m0, s70
    s_nop 0
    buffer_load_dwordx4 v226, s[4:7], s46 offen sc1 lds
    buffer_load_dwordx4 v227, s[72:75], s46 offen offset:1024 sc1 lds
    s_mov_b32 m0, s71
    s_nop 0
    buffer_load_dwordx4 v228, s[4:7], s47 offen sc1 lds
    buffer_load_dwordx4 v229, s[72:75], s47 offen offset:1024 sc1 lds
    v_add_u32 v249, s48, v249
    v_add_u32 v250, s48, v250
    s_waitcnt vmcnt(6)
    ds_read_b64_tr_b16 v[176:177], v246 offset:0
    ds_read_b64_tr_b16 v[178:179], v246 offset:512
    ds_read_b64_tr_b16 v[180:181], v247 offset:0
    ds_read_b64_tr_b16 v[182:183], v247 offset:512
    ds_read_b64_tr_b16 v[0:1], v249 offset:0
    ds_read_b64_tr_b16 v[2:3], v249 offset:128
    ds_read_b128 v[4:7], v250 offset:0
    ds_read_b128 v[8:11], v250 offset:16
    ds_read_b128 v[12:15], v250 offset:384
    ds_read_b128 v[16:19], v250 offset:400
    ds_read_b64_tr_b16 v[20:21], v249 offset:512
    ds_read_b64_tr_b16 v[22:23], v249 offset:640
    ds_read_b128 v[24:27], v250 offset:64
    ds_read_b128 v[28:31], v250 offset:80
    ds_read_b128 v[32:35], v250 offset:448
    ds_read_b128 v[36:39], v250 offset:464
    s_mov_b32 s29, s48
    s_mov_b32 s32, s31
    s_mov_b32 s30, s3
    s_mov_b32 s31, s35
    s_cmp_eq_u32 s33, 2
    s_cbranch_scc1 K2_U20
    s_cmp_eq_u32 s33, 3
    s_cbranch_scc1 K2_U30
    s_cmp_eq_u32 s33, 1
    s_cbranch_scc1 K2_U10
    s_branch K2_U40
K2_PAD_H1:
    s_branch KS_HOP0
KS_PRE:
    v_subrev_u32 v76, 320, v0
    v_mov_b32 v80, -1
    v_mov_b32 v77, 1.0
    v_cmp_gt_u32 vcc, 48, v76
    v_lshlrev_b32 v78, 4, v76
    v_add_u32 v78, 65536, v78
    v_cndmask_b32 v80, v80, 0, vcc
    v_cmp_gt_u32 vcc, 12, v76
    v_add_u32 v79, 64800, v78
    s_nop 0
    v_cndmask_b32 v80, v80, v77, vcc
    v_cmp_gt_u32 s[56:57], 54, v8
    v_mov_b32 v81, v80
    v_mov_b32 v82, v80
    v_mov_b32 v83, v80
    ds_write_b128 v78, v[80:83] offset:0
    ds_write_b128 v78, v[80:83] offset:2400
    ds_write_b128 v78, v[80:83] offset:4800
    ds_write_b128 v78, v[80:83] offset:7200
    ds_write_b128 v78, v[80:83] offset:9600
    ds_write_b128 v78, v[80:83] offset:12000
    ds_write_b128 v78, v[80:83] offset:14400
    ds_write_b128 v78, v[80:83] offset:16800
    ds_write_b128 v78, v[80:83] offset:19200
    ds_write_b128 v78, v[80:83] offset:21600
    ds_write_b128 v78, v[80:83] offset:24000
    ds_write_b128 v78, v[80:83] offset:26400
    ds_write_b128 v78, v[80:83] offset:28800
    ds_write_b128 v78, v[80:83] offset:31200
    s_branch KS_PRE2
KS_HELP:
    s_mov_b32 s30, 0
    s_cmp_eq_u32 s20, 6
    s_cbranch_scc1 KS_RAW
    s_mov_b32 s30, 2
    s_cmp_ge_u32 s2, 200
    s_cbranch_scc1 KS_NOW
    s_mov_b32 s30, 1
    v_and_b32 v1, 15, v8
    v_lshrrev_b32 v3, 4, v8
    s_cmp_ge_u32 s2, 160
    s_cbranch_scc1 K1_WT
    s_cmp_ge_u32 s2, 64
    s_cbranch_scc1 K1_S1
    s_lshr_b32 s24, s2, 3
    s_and_b32 s25, s2, 7
    s_lshr_b32 s26, s25, 2
    s_bfe_u32 s27, s25, 0x10001
    s_and_b32 s28, s25, 1
    s_mov_b32 s60, s92
    s_and_b32 s61, s93, 0xffff
    s_mov_b32 s62, 65536
    s_mov_b32 s63, 0x20000
    s_branch K1_SC
K1_S1:
    s_sub_u32 s29, s2, 64
    s_mul_i32 s24, s29, 43
    s_lshr_b32 s24, s24, 9
    s_mul_i32 s25, s24, 12
    s_sub_u32 s25, s29, s25
    s_cmp_ge_u32 s25, 6
    s_cselect_b32 s26, 1, 0
    s_mul_i32 s27, s26, 6
    s_sub_u32 s27, s25, s27
    s_lshr_b32 s27, s27, 1
    s_and_b32 s28, s25, 1
    s_add_u32 s25, s25, 8
    s_mov_b32 s60, s94
    s_and_b32 s61, s95, 0xffff
    s_mov_b32 s62, 98304
    s_mov_b32 s63, 0x20000
K1_SC:
    s_lshl_b32 s27, s27, 7
    s_lshl_b32 s26, s26, 6
    s_lshl_b32 s28, s28, 4
    s_add_u32 s27, s27, s26
    s_add_u32 s27, s27, s28
    s_lshl_b32 s27, s27, 8
    s_lshl_b32 s26, s24, 5
    s_add_u32 s27, s27, s26
    s_add_u32 s29, s27, 8192
    v_lshlrev_b32 v3, 10, v3
    v_lshl_add_u32 v3, v1, 1, v3
    buffer_load_ushort v64, v3, s[60:63], s27 offen offset:0
    buffer_load_ushort v65, v3, s[60:63], s29 offen offset:0
    buffer_load_ushort v66, v3, s[60:63], s27 offen offset:256
    buffer_load_ushort v67, v3, s[60:63], s29 offen offset:256
    buffer_load_ushort v68, v3, s[60:63], s27 offen offset:512
    buffer_load_ushort v69, v3, s[60:63], s29 offen offset:512
    buffer_load_ushort v70, v3, s[60:63], s27 offen offset:768
    buffer_load_ushort v71, v3, s[60:63], s29 offen offset:768
    s_mul_i32 s24, s24, 20
    s_add_u32 s24, s24, s25
    s_lshl_b32 s24, s24, 10
    s_add_u32 s24, s24, 6946816
    s_branch K1_GO
K1_WT:
    s_sub_u32 s24, s2, 160
    s_cmp_ge_u32 s24, 20
    s_cselect_b32 s26, 1, 0
    s_mul_i32 s25, s26, 20
    s_sub_u32 s25, s24, s25
    s_lshr_b32 s27, s25, 2
    s_bfe_u32 s28, s25, 0x10001
    s_and_b32 s25, s25, 1
    s_mul_i32 s25, s25, 10240
    s_lshl_b32 s27, s27, 8
    s_lshl_b32 s26, s26, 7
    s_lshl_b32 s28, s28, 6
    s_add_u32 s27, s27, s26
    s_add_u32 s27, s27, s28
    s_add_u32 s27, s27, s25
    s_mov_b32 s60, s90
    s_and_b32 s61, s91, 0xffff
    s_mov_b32 s62, 20480
    s_mov_b32 s63, 0x20000
    v_and_b32 v1, 31, v8
    v_lshrrev_b32 v3, 5, v8
    v_mul_u32_u24 v3, 5120, v3
    v_lshl_add_u32 v3, v1, 1, v3
    v_mov_b32 v64, 0
    v_mov_b32 v66, 0
    v_mov_b32 v68, 0
    v_mov_b32 v70, 0
    buffer_load_ushort v65, v3, s[60:63], s27 offen offset:0
    buffer_load_ushort v67, v3, s[60:63], s27 offen offset:1280
    buffer_load_ushort v69, v3, s[60:63], s27 offen offset:2560
    buffer_load_ushort v71, v3, s[60:63], s27 offen offset:3840
    s_lshl_b32 s24, s24, 10
    s_add_u32 s24, s24, 7110656
K1_GO:
KS_NOW:
    s_barrier
K2_PAD_H2:
    s_cbranch_execz KS_HOP0
KS_FILL:
    ds_write_b128 v78, v[80:83] offset:33600
    ds_write_b128 v78, v[80:83] offset:36000
    ds_write_b128 v78, v[80:83] offset:38400
    ds_write_b128 v78, v[80:83] offset:40800
    ds_write_b128 v78, v[80:83] offset:43200
    ds_write_b128 v78, v[80:83] offset:45600
    ds_write_b128 v78, v[80:83] offset:48000
    ds_write_b128 v78, v[80:83] offset:50400
    ds_write_b128 v78, v[80:83] offset:52800
    ds_write_b128 v78, v[80:83] offset:55200
    ds_write_b128 v78, v[80:83] offset:57600
    ds_write_b128 v78, v[80:83] offset:60000
    ds_write_b128 v78, v[80:83] offset:62400
    ds_write_b128 v79, v[80:83] offset:0
    ds_write_b128 v79, v[80:83] offset:2400
    ds_write_b128 v79, v[80:83] offset:4800
    ds_write_b128 v79, v[80:83] offset:7200
    ds_write_b128 v79, v[80:83] offset:9600
    ds_write_b128 v79, v[80:83] offset:12000
    ds_write_b128 v79, v[80:83] offset:14400
    ds_write_b128 v79, v[80:83] offset:16800
    ds_write_b128 v79, v[80:83] offset:19200
    ds_write_b128 v79, v[80:83] offset:21600
    ds_write_b128 v79, v[80:83] offset:24000
    ds_write_b128 v79, v[80:83] offset:26400
    ds_write_b128 v79, v[80:83] offset:28800
    v_mov_b32 v59, 163728
    s_barrier
    ds_read_b32 v59, v59
    s_cmp_eq_u32 s20, 6
    s_cselect_b64 exec, s[56:57], -1
    ds_write_b128 v79, v[80:83] offset:31200
    s_mov_b64 exec, -1
    s_waitcnt vmcnt(0) lgkmcnt(0)
    s_cmp_eq_u32 s30, 0
    s_cbranch_scc1 KS_B3
    s_cmp_eq_u32 s30, 2
    s_cbranch_scc1 KS_NOST
    v_lshl_or_b32 v40, v65, 16, v64
    v_lshl_or_b32 v41, v67, 16, v66
    v_lshl_or_b32 v42, v69, 16, v68
    v_lshl_or_b32 v43, v71, 16, v70
    buffer_store_dwordx4 v[40:43], v9, s[8:11], s24 offen sc1
KS_NOST:
    s_waitcnt lgkmcnt(0)
    s_barrier
    s_lshl_b32 s24, s2, 2
    s_add_u32 s24, s24, 7176192
    s_mov_b64 exec, 1
    s_waitcnt vmcnt(0)
    buffer_store_dword v59, v6, s[8:11], s24 offen sc1
    s_mov_b64 exec, -1
    s_branch KS_JOIN
K2_PAD_H3:
    s_branch KS_HOP0
KS_RAW:
    s_barrier
    s_mov_b32 s60, s90
    s_and_b32 s61, s91, 0xffff
    s_mov_b32 s62, 20480
    s_mov_b32 s63, 0x20000
    s_mov_b32 m0, 24576
    s_movk_i32 s24, 0
    buffer_load_dwordx4 v9, s[60:63], s24 offen offset:0 lds
    buffer_load_dwordx4 v9, s[60:63], s24 offen offset:1024 lds
    buffer_load_dwordx4 v9, s[60:63], s24 offen offset:2048 lds
    buffer_load_dwordx4 v9, s[60:63], s24 offen offset:3072 lds
    s_mov_b32 m0, 28672
    s_movk_i32 s24, 4096
    buffer_load_dwordx4 v9, s[60:63], s24 offen offset:0 lds
    buffer_load_dwordx4 v9, s[60:63], s24 offen offset:1024 lds
    buffer_load_dwordx4 v9, s[60:63], s24 offen offset:2048 lds
    buffer_load_dwordx4 v9, s[60:63], s24 offen offset:3072 lds
    s_mov_b32 m0, 32768
    s_movk_i32 s24, 8192
    buffer_load_dwordx4 v9, s[60:63], s24 offen offset:0 lds
    buffer_load_dwordx4 v9, s[60:63], s24 offen offset:1024 lds
    buffer_load_dwordx4 v9, s[60:63], s24 offen offset:2048 lds
    buffer_load_dwordx4 v9, s[60:63], s24 offen offset:3072 lds
    s_mov_b32 m0, 36864
    s_movk_i32 s24, 12288
    buffer_load_dwordx4 v9, s[60:63], s24 offen offset:0 lds
    buffer_load_dwordx4 v9, s[60:63], s24 offen offset:1024 lds
    buffer_load_dwordx4 v9, s[60:63], s24 offen offset:2048 lds
    buffer_load_dwordx4 v9, s[60:63], s24 offen offset:3072 lds
    s_mov_b32 m0, 40960
    s_movk_i32 s24, 16384
    buffer_load_dwordx4 v9, s[60:63], s24 offen offset:0 lds
    buffer_load_dwordx4 v9, s[60:63], s24 offen offset:1024 lds
    buffer_load_dwordx4 v9, s[60:63], s24 offen offset:2048 lds
    buffer_load_dwordx4 v9, s[60:63], s24 offen offset:3072 lds
    s_branch KS_FILL
KS_IDLE:
    s_barrier
    v_mul_u32_u24 v76, 2979, v0
    v_lshrrev_b32 v76, 16, v76
    v_mul_u32_u24 v77, 2048, v76
    v_lshl_add_u32 v78, v0, 4, v77
    v_add_u32 v78, 67584, v78
    v_add_u32 v79, 67200, v78
    v_mov_b32 v80, -1
    v_mov_b32 v81, -1
    v_cmp_gt_u32 vcc, 14, v76
    v_cmp_gt_u32 s[56:57], 12, v76
    v_mov_b32 v82, -1
    v_mov_b32 v83, -1
    s_mov_b64 exec, vcc
    ds_write_b128 v78, v[80:83]
    ds_write_b128 v78, v[80:83] offset:33600
    s_mov_b64 exec, s[56:57]
    ds_write_b128 v79, v[80:83]
    s_mov_b64 exec, -1
    s_barrier
    s_branch KS_B3
K2_PAD_U20:
    s_branch K2_HOP
K2_U20:
    s_setprio 1
    s_waitcnt lgkmcnt(6)
    v_lshlrev_b32 v40, 16, v0
    v_and_b32 v41, 0xffff0000, v0
    v_lshlrev_b32 v42, 16, v1
    v_and_b32 v43, 0xffff0000, v1
    v_lshlrev_b32 v44, 16, v2
    v_and_b32 v45, 0xffff0000, v2
    v_lshlrev_b32 v46, 16, v3
    v_and_b32 v47, 0xffff0000, v3
    v_mul_f32 v4, v40, v4
    v_mul_f32 v5, v41, v5
    v_mul_f32 v6, v42, v6
    v_mul_f32 v7, v43, v7
    v_mul_f32 v8, v44, v8
    v_mul_f32 v9, v45, v9
    v_mul_f32 v10, v46, v10
    v_mul_f32 v11, v47, v11
    v_cvt_pk_bf16_f32 v64, v4, v5
    v_cvt_pk_bf16_f32 v65, v6, v7
    v_cvt_pk_bf16_f32 v66, v8, v9
    v_cvt_pk_bf16_f32 v67, v10, v11
    v_mul_f32 v12, v40, v12
    v_mul_f32 v13, v41, v13
    v_mul_f32 v14, v42, v14
    v_mul_f32 v15, v43, v15
    v_mul_f32 v16, v44, v16
    v_mul_f32 v17, v45, v17
    v_mul_f32 v18, v46, v18
    v_mul_f32 v19, v47, v19
    v_cvt_pk_bf16_f32 v68, v12, v13
    v_cvt_pk_bf16_f32 v69, v14, v15
    v_cvt_pk_bf16_f32 v70, v16, v17
    v_cvt_pk_bf16_f32 v71, v18, v19
    s_waitcnt lgkmcnt(0)
    v_lshlrev_b32 v48, 16, v20
    v_and_b32 v49, 0xffff0000, v20
    v_lshlrev_b32 v50, 16, v21
    v_and_b32 v51, 0xffff0000, v21
    v_lshlrev_b32 v52, 16, v22
    v_and_b32 v53, 0xffff0000, v22
    v_lshlrev_b32 v54, 16, v23
    v_and_b32 v55, 0xffff0000, v23
    v_mul_f32 v24, v48, v24
    v_mul_f32 v25, v49, v25
    v_mul_f32 v26, v50, v26
    v_mul_f32 v27, v51, v27
    v_mul_f32 v28, v52, v28
    v_mul_f32 v29, v53, v29
    v_mul_f32 v30, v54, v30
    v_mul_f32 v31, v55, v31
    v_cvt_pk_bf16_f32 v72, v24, v25
    v_cvt_pk_bf16_f32 v73, v26, v27
    v_cvt_pk_bf16_f32 v74, v28, v29
    v_cvt_pk_bf16_f32 v75, v30, v31
    v_mul_f32 v32, v48, v32
    v_mul_f32 v33, v49, v33
    v_mul_f32 v34, v50, v34
    v_mul_f32 v35, v51, v35
    v_mul_f32 v36, v52, v36
    v_mul_f32 v37, v53, v37
    v_mul_f32 v38, v54, v38
    v_mul_f32 v39, v55, v39
    v_cvt_pk_bf16_f32 v76, v32, v33
    v_cvt_pk_bf16_f32 v77, v34, v35
    v_cvt_pk_bf16_f32 v78, v36, v37
    v_cvt_pk_bf16_f32 v79, v38, v39
    s_waitcnt vmcnt(4)
    v_mfma_f32_32x32x16_bf16 v[0:15], v[64:67], v[176:179], 0
    ds_read_b64_tr_b16 v[184:185], v246 offset:2048
    ds_read_b64_tr_b16 v[186:187], v246 offset:2560
    ds_read_b64_tr_b16 v[188:189], v247 offset:2048
    ds_read_b64_tr_b16 v[190:191], v247 offset:2560
    s_mov_b32 m0, s68
    v_mfma_f32_32x32x16_bf16 v[16:31], v[68:71], v[176:179], 0
    buffer_load_dwordx4 v222, s[4:7], s42 offen sc1 lds
    buffer_load_dwordx4 v223, s[72:75], s42 offen offset:1024 sc1 lds
    v_permlane32_swap_b32 v242, v236
    v_permlane32_swap_b32 v243, v237
    s_add_u32 s38, s38, 1
    v_mfma_f32_32x32x16_bf16 v[32:47], v[64:67], v[180:183], 0
    v_permlane32_swap_b32 v244, v238
    v_permlane32_swap_b32 v245, v239
    v_permlane32_swap_b32 v240, v241
    v_add_f32 v242, v242, v236
    v_mfma_f32_32x32x16_bf16 v[48:63], v[68:71], v[180:183], 0
    v_add_f32 v243, v243, v237
    v_add_f32 v244, v244, v238
    v_add_f32 v245, v245, v239
    v_add_f32 v240, -v240, -v241
    v_mov_b32 v254, s52
    v_mov_b32 v255, s38
    s_waitcnt vmcnt(4) lgkmcnt(0)
    v_mfma_f32_32x32x16_bf16 v[0:15], v[72:75], v[184:187], v[0:15]
    ds_read_b64_tr_b16 v[176:177], v246 offset:4096
    ds_read_b64_tr_b16 v[178:179], v246 offset:4608
    ds_read_b64_tr_b16 v[180:181], v247 offset:4096
    ds_read_b64_tr_b16 v[182:183], v247 offset:4608
    s_lshl_b32 s58, s38, 3
    s_add_u32 s58, s58, s20
    s_mov_b32 m0, s69
    v_mfma_f32_32x32x16_bf16 v[16:31], v[76:79], v[184:187], v[16:31]
    buffer_load_dwordx4 v224, s[4:7], s42 offen sc1 lds
    buffer_load_dwordx4 v225, s[72:75], s42 offen offset:1024 sc1 lds
    s_set_gpr_idx_on s32, gpr_idx(DST)
    s_nop 0
    v_cvt_pk_bf16_f32 v195, v242, v243
    v_cvt_pk_bf16_f32 v196, v244, v245
    v_cvt_pk_bf16_f32 v197, v240, v240
    s_set_gpr_idx_off
    s_mov_b64 exec, 1
    ds_write_b32 v254, v255
    s_mov_b64 exec, -1
    s_cmp_lt_u32 s58, s22
    s_cbranch_scc0 K2_dyn_8
K2_back_9:
    v_readlane_b32 s3, v253, s58
    s_lshl_b32 s44, s34, 7
    s_lshl_b32 s60, s58, 5
    s_and_b32 s48, s3, 0x3ffff
    s_bfe_u32 s33, s3, 0x30012
    s_sub_u32 s60, s60, s48
    s_and_b32 s60, s60, 0xff
    s_add_u32 s60, s60, s48
    s_mul_i32 s35, s38, 6
    s_cmp_eq_u32 s34, 0
    s_cselect_b32 s35, s35, s60
    s_mov_b32 s45, s44
    s_add_u32 s47, s44, 256
    s_add_u32 s49, s48, 32
    s_add_u32 s60, s48, 64
    s_cmp_eq_u32 s33, 3
    s_cselect_b32 s46, s44, s47
    s_cselect_b32 s50, s60, s48
    s_cselect_b32 s51, s48, s49
    s_sub_u32 s60, s33, 2
    s_cmp_lt_u32 s60, 2
    s_cbranch_scc0 K2_rare_14
K2_back_15:
    v_mfma_f32_32x32x16_bf16 v[32:47], v[72:75], v[188:191], v[32:47]
    v_add_u32 v233, s48, v230
    ds_read_b32 v232, v233
    ds_read_b32 v233, v233 offset:1024
    v_mul_f32 v234, v0, v96
    v_mul_f32 v236, v8, v128
    v_fmac_f32 v234, v1, v97
    v_fmac_f32 v236, v9, v129
    v_mfma_f32_32x32x16_bf16 v[48:63], v[76:79], v[188:191], v[48:63]
    s_setprio 0
    v_fmac_f32 v234, v2, v98
    v_fmac_f32 v236, v10, v130
    v_fmac_f32 v234, v3, v99
    v_fmac_f32 v236, v11, v131
    v_fmac_f32 v234, v4, v100
    v_fmac_f32 v236, v12, v132
    v_fmac_f32 v234, v5, v101
    v_fmac_f32 v236, v13, v133
    v_fmac_f32 v234, v6, v102
    v_fmac_f32 v236, v14, v134
    v_fmac_f32 v234, v7, v103
    v_fmac_f32 v236, v15, v135
    v_mul_f32 v238, v16, v128
    v_mul_f32 v240, v24, v128
    v_fmac_f32 v238, v17, v129
    v_fmac_f32 v240, v25, v129
    v_fmac_f32 v238, v18, v130
    v_fmac_f32 v240, v26, v130
    v_fmac_f32 v238, v19, v131
    v_fmac_f32 v240, v27, v131
    v_fmac_f32 v238, v20, v132
    v_fmac_f32 v240, v28, v132
    v_fmac_f32 v238, v21, v133
    v_fmac_f32 v240, v29, v133
    v_fmac_f32 v238, v22, v134
    v_fmac_f32 v240, v30, v134
    v_fmac_f32 v238, v23, v135
    v_fmac_f32 v240, v31, v135
    v_mul_f32 v235, v32, v104
    v_mul_f32 v237, v40, v136
    v_fmac_f32 v235, v33, v105
    v_fmac_f32 v237, v41, v137
    v_fmac_f32 v235, v34, v106
    v_fmac_f32 v237, v42, v138
    v_fmac_f32 v235, v35, v107
    v_fmac_f32 v237, v43, v139
    v_fmac_f32 v235, v36, v108
    v_fmac_f32 v237, v44, v140
    v_fmac_f32 v235, v37, v109
    v_fmac_f32 v237, v45, v141
    v_fmac_f32 v235, v38, v110
    v_fmac_f32 v237, v46, v142
    v_fmac_f32 v235, v39, v111
    v_fmac_f32 v237, v47, v143
    v_mul_f32 v239, v48, v136
    v_mul_f32 v241, v56, v136
    v_fmac_f32 v239, v49, v137
    v_fmac_f32 v241, v57, v137
    s_setprio 1
    s_waitcnt vmcnt(4) lgkmcnt(3)
    v_mfma_f32_32x32x16_bf16 v[0:15], v[64:67], v[176:179], 0
    ds_read_b64_tr_b16 v[184:185], v246 offset:6144
    ds_read_b64_tr_b16 v[186:187], v246 offset:6656
    ds_read_b64_tr_b16 v[188:189], v247 offset:6144
    ds_read_b64_tr_b16 v[190:191], v247 offset:6656
    v_fmac_f32 v239, v50, v138
    v_fmac_f32 v241, v58, v138
    s_mov_b32 m0, s70
    v_mfma_f32_32x32x16_bf16 v[16:31], v[68:71], v[176:179], 0
    buffer_load_dwordx4 v222, s[4:7], s43 offen sc1 lds
    buffer_load_dwordx4 v223, s[72:75], s43 offen offset:1024 sc1 lds
    v_fmac_f32 v239, v51, v139
    v_fmac_f32 v241, v59, v139
    v_fmac_f32 v239, v52, v140
    v_fmac_f32 v241, v60, v140
    v_fmac_f32 v239, v53, v141
    v_mfma_f32_32x32x16_bf16 v[32:47], v[64:67], v[180:183], 0
    v_add_u32 v222, s48, v251
    ds_read_b32 v222, v222
    v_fmac_f32 v241, v61, v141
    v_fmac_f32 v239, v54, v142
    v_fmac_f32 v241, v62, v142
    v_fmac_f32 v239, v55, v143
    v_fmac_f32 v241, v63, v143
    v_mfma_f32_32x32x16_bf16 v[48:63], v[68:71], v[180:183], 0
    v_permlane32_swap_b32 v234, v236
    v_permlane32_swap_b32 v235, v237
    v_permlane32_swap_b32 v240, v238
    s_waitcnt lgkmcnt(5)
    v_or_b32 v232, v232, v231
    v_or_b32 v233, v233, v231
    s_cmp_lg_u32 s34, 0
    s_cbranch_scc1 K2_dum_17
    s_add_u32 m0, s48, 864
    s_add_u32 s65, s48, 1888
    buffer_load_dwordx4 v232, s[16:19], 0 offen  lds
    s_mov_b32 m0, s65
    s_mov_b32 exec_hi, 0
    buffer_load_dwordx4 v233, s[16:19], 0 offen  lds
    s_cmp_eq_u32 s33, 4
    s_cbranch_scc1 K2_a4_18
K2_b4_20:
    s_mov_b32 exec_hi, -1
K2_back_19:
    s_waitcnt vmcnt(6) lgkmcnt(1)
    v_mfma_f32_32x32x16_bf16 v[0:15], v[72:75], v[184:187], v[0:15]
    ds_read_b64_tr_b16 v[176:177], v246 offset:0
    ds_read_b64_tr_b16 v[178:179], v246 offset:512
    ds_read_b64_tr_b16 v[180:181], v247 offset:0
    ds_read_b64_tr_b16 v[182:183], v247 offset:512
    v_permlane32_swap_b32 v241, v239
    s_mov_b32 m0, s71
    v_mfma_f32_32x32x16_bf16 v[16:31], v[76:79], v[184:187], v[16:31]
    buffer_load_dwordx4 v224, s[4:7], s43 offen sc1 lds
    buffer_load_dwordx4 v225, s[72:75], s43 offen offset:1024 sc1 lds
    s_waitcnt lgkmcnt(4)
    v_mad_u32_u16 v223, v222, s39, v248 op_sel:[1,0,0,0]
    v_mad_u32_u16 v222, v222, s39, v248
    v_add_f32 v234, v234, v236
    v_add_f32 v235, v235, v237
    v_add_f32 v240, v240, v238
    v_add_f32 v241, v241, v239
    s_set_gpr_idx_on s31, gpr_idx(DST)
    s_nop 0
    v_cvt_pk_bf16_f32 v192, v234, v235
    v_cvt_pk_bf16_f32 v193, v240, v241
    s_set_gpr_idx_off
    v_mfma_f32_32x32x16_bf16 v[32:47], v[72:75], v[188:191], v[32:47]
    v_add_u32 v224, s49, v251
    ds_read_b32 v224, v224
    v_mul_f32 v234, v0, v144
    v_mul_f32 v236, v8, v112
    v_fmac_f32 v234, v1, v145
    v_fmac_f32 v236, v9, v113
    v_fmac_f32 v234, v2, v146
    v_mfma_f32_32x32x16_bf16 v[48:63], v[76:79], v[188:191], v[48:63]
    s_setprio 0
    v_fmac_f32 v236, v10, v114
    v_fmac_f32 v234, v3, v147
    v_fmac_f32 v236, v11, v115
    v_fmac_f32 v234, v4, v148
    v_fmac_f32 v236, v12, v116
    v_fmac_f32 v234, v5, v149
    v_fmac_f32 v236, v13, v117
    v_fmac_f32 v234, v6, v150
    v_fmac_f32 v236, v14, v118
    v_fmac_f32 v234, v7, v151
    v_fmac_f32 v236, v15, v119
    v_mul_f32 v238, v16, v160
    v_mul_f32 v240, v24, v160
    v_fmac_f32 v238, v17, v161
    v_fmac_f32 v240, v25, v161
    v_fmac_f32 v238, v18, v162
    v_fmac_f32 v240, v26, v162
    v_fmac_f32 v238, v19, v163
    v_fmac_f32 v240, v27, v163
    v_fmac_f32 v238, v20, v164
    v_fmac_f32 v240, v28, v164
    v_fmac_f32 v238, v21, v165
    v_fmac_f32 v240, v29, v165
    v_fmac_f32 v238, v22, v166
    v_fmac_f32 v240, v30, v166
    v_fmac_f32 v238, v23, v167
    v_fmac_f32 v240, v31, v167
    v_mul_f32 v235, v32, v152
    v_mul_f32 v237, v40, v120
    v_fmac_f32 v235, v33, v153
    v_fmac_f32 v237, v41, v121
    v_fmac_f32 v235, v34, v154
    v_fmac_f32 v237, v42, v122
    v_fmac_f32 v235, v35, v155
    v_fmac_f32 v237, v43, v123
    v_fmac_f32 v235, v36, v156
    v_fmac_f32 v237, v44, v124
    v_fmac_f32 v235, v37, v157
    v_fmac_f32 v237, v45, v125
    v_fmac_f32 v235, v38, v158
    v_fmac_f32 v237, v46, v126
    v_fmac_f32 v235, v39, v159
    v_fmac_f32 v237, v47, v127
    v_mul_f32 v239, v48, v168
    v_mul_f32 v241, v56, v168
    v_fmac_f32 v239, v49, v169
    v_fmac_f32 v241, v57, v169
    v_fmac_f32 v239, v50, v170
    v_fmac_f32 v241, v58, v170
    v_fmac_f32 v239, v51, v171
    s_setprio 1
    s_waitcnt vmcnt(6) lgkmcnt(1)
    v_mfma_f32_32x32x16_bf16 v[0:15], v[64:67], v[176:179], 0
    ds_read_b64_tr_b16 v[184:185], v246 offset:2048
    ds_read_b64_tr_b16 v[186:187], v246 offset:2560
    ds_read_b64_tr_b16 v[188:189], v247 offset:2048
    ds_read_b64_tr_b16 v[190:191], v247 offset:2560
    v_fmac_f32 v241, v59, v171
    v_fmac_f32 v239, v52, v172
    s_mov_b32 m0, s68
    v_mfma_f32_32x32x16_bf16 v[16:31], v[68:71], v[176:179], 0
    buffer_load_dwordx4 v222, s[4:7], s44 offen sc1 lds
    buffer_load_dwordx4 v223, s[72:75], s44 offen offset:1024 sc1 lds
    s_waitcnt lgkmcnt(4)
    v_mad_u32_u16 v225, v224, s39, v248 op_sel:[1,0,0,0]
    v_mad_u32_u16 v224, v224, s39, v248
    v_fmac_f32 v241, v60, v172
    v_fmac_f32 v239, v53, v173
    v_mfma_f32_32x32x16_bf16 v[32:47], v[64:67], v[180:183], 0
    v_add_u32 v226, s50, v251
    ds_read_b32 v226, v226
    v_fmac_f32 v241, v61, v173
    v_fmac_f32 v239, v54, v174
    v_fmac_f32 v241, v62, v174
    v_fmac_f32 v239, v55, v175
    v_fmac_f32 v241, v63, v175
    v_mfma_f32_32x32x16_bf16 v[48:63], v[68:71], v[180:183], 0
    s_waitcnt vmcnt(6) lgkmcnt(1)
    v_mfma_f32_32x32x16_bf16 v[0:15], v[72:75], v[184:187], v[0:15]
    ds_read_b64_tr_b16 v[176:177], v246 offset:4096
    ds_read_b64_tr_b16 v[178:179], v246 offset:4608
    ds_read_b64_tr_b16 v[180:181], v247 offset:4096
    ds_read_b64_tr_b16 v[182:183], v247 offset:4608
    s_mov_b32 m0, s69
    v_mfma_f32_32x32x16_bf16 v[16:31], v[76:79], v[184:187], v[16:31]
    buffer_load_dwordx4 v224, s[4:7], s45 offen sc1 lds
    buffer_load_dwordx4 v225, s[72:75], s45 offen offset:1024 sc1 lds
    s_waitcnt lgkmcnt(4)
    v_mad_u32_u16 v227, v226, s39, v248 op_sel:[1,0,0,0]
    v_mad_u32_u16 v226, v226, s39, v248
    v_mfma_f32_32x32x16_bf16 v[32:47], v[72:75], v[188:191], v[32:47]
    v_add_u32 v228, s51, v251
    ds_read_b32 v228, v228
    v_mul_f32 v242, v0, v144
    v_fma_f32 v238, v8, v160, -v238
    v_fmac_f32 v242, v1, v145
    v_fmac_f32 v238, v9, v161
    v_fmac_f32 v242, v2, v146
    v_mfma_f32_32x32x16_bf16 v[48:63], v[76:79], v[188:191], v[48:63]
    s_setprio 0
    v_fmac_f32 v238, v10, v162
    v_fmac_f32 v242, v3, v147
    v_fmac_f32 v238, v11, v163
    v_fmac_f32 v242, v4, v148
    v_fmac_f32 v238, v12, v164
    v_fmac_f32 v242, v5, v149
    v_fmac_f32 v238, v13, v165
    v_fmac_f32 v242, v6, v150
    v_fmac_f32 v238, v14, v166
    v_fmac_f32 v242, v7, v151
    v_fmac_f32 v238, v15, v167
    v_fmac_f32 v236, v16, v112
    v_mul_f32 v244, v24, v160
    v_fmac_f32 v236, v17, v113
    v_fmac_f32 v244, v25, v161
    v_fmac_f32 v236, v18, v114
    v_fmac_f32 v244, v26, v162
    v_fmac_f32 v236, v19, v115
    v_fmac_f32 v244, v27, v163
    v_fmac_f32 v236, v20, v116
    v_fmac_f32 v244, v28, v164
    v_fmac_f32 v236, v21, v117
    v_fmac_f32 v244, v29, v165
    v_fmac_f32 v236, v22, v118
    v_fmac_f32 v244, v30, v166
    v_fmac_f32 v236, v23, v119
    v_fmac_f32 v244, v31, v167
    v_mul_f32 v243, v32, v152
    v_fma_f32 v239, v40, v168, -v239
    v_fmac_f32 v243, v33, v153
    v_fmac_f32 v239, v41, v169
    v_fmac_f32 v243, v34, v154
    v_fmac_f32 v239, v42, v170
    v_fmac_f32 v243, v35, v155
    v_fmac_f32 v239, v43, v171
    v_fmac_f32 v243, v36, v156
    v_fmac_f32 v239, v44, v172
    v_fmac_f32 v243, v37, v157
    v_fmac_f32 v239, v45, v173
    v_fmac_f32 v243, v38, v158
    v_fmac_f32 v239, v46, v174
    v_fmac_f32 v243, v39, v159
    v_fmac_f32 v239, v47, v175
    v_fmac_f32 v237, v48, v120
    v_mul_f32 v245, v56, v168
    v_fmac_f32 v237, v49, v121
    v_fmac_f32 v245, v57, v169
    v_fmac_f32 v237, v50, v122
    s_setprio 1
    s_waitcnt vmcnt(4) lgkmcnt(1)
    v_mfma_f32_32x32x16_bf16 v[0:15], v[64:67], v[176:179], 0
    ds_read_b64_tr_b16 v[184:185], v246 offset:6144
    ds_read_b64_tr_b16 v[186:187], v246 offset:6656
    ds_read_b64_tr_b16 v[188:189], v247 offset:6144
    ds_read_b64_tr_b16 v[190:191], v247 offset:6656
    v_fmac_f32 v245, v58, v170
    v_fmac_f32 v237, v51, v123
    s_mov_b32 m0, s70
    v_mfma_f32_32x32x16_bf16 v[16:31], v[68:71], v[176:179], 0
    buffer_load_dwordx4 v226, s[4:7], s46 offen sc1 lds
    buffer_load_dwordx4 v227, s[72:75], s46 offen offset:1024 sc1 lds
    s_waitcnt lgkmcnt(4)
    v_mad_u32_u16 v229, v228, s39, v248 op_sel:[1,0,0,0]
    v_mad_u32_u16 v228, v228, s39, v248
    v_fmac_f32 v245, v59, v171
    v_fmac_f32 v237, v52, v124
    v_mfma_f32_32x32x16_bf16 v[32:47], v[64:67], v[180:183], 0
    v_fmac_f32 v245, v60, v172
    v_fmac_f32 v237, v53, v125
    v_fmac_f32 v245, v61, v173
    v_fmac_f32 v237, v54, v126
    v_fmac_f32 v245, v62, v174
    v_fmac_f32 v237, v55, v127
    v_fmac_f32 v245, v63, v175
    v_mfma_f32_32x32x16_bf16 v[48:63], v[68:71], v[180:183], 0
    v_permlane32_swap_b32 v242, v234
    v_permlane32_swap_b32 v243, v235
    v_add_f32 v242, v242, v234
    v_add_f32 v243, v243, v235
    s_waitcnt vmcnt(4) lgkmcnt(0)
    v_mfma_f32_32x32x16_bf16 v[0:15], v[72:75], v[184:187], v[0:15]
    ds_read_b64_tr_b16 v[176:177], v246 offset:0
    ds_read_b64_tr_b16 v[178:179], v246 offset:512
    ds_read_b64_tr_b16 v[180:181], v247 offset:0
    ds_read_b64_tr_b16 v[182:183], v247 offset:512
    s_sub_u32 s26, s48, s29
    s_mov_b32 s29, s48
    s_mov_b32 m0, s71
    v_mfma_f32_32x32x16_bf16 v[16:31], v[76:79], v[184:187], v[16:31]
    buffer_load_dwordx4 v228, s[4:7], s47 offen sc1 lds
    buffer_load_dwordx4 v229, s[72:75], s47 offen offset:1024 sc1 lds
    s_set_gpr_idx_on s31, gpr_idx(DST)
    s_nop 0
    v_cvt_pk_bf16_f32 v194, v242, v243
    s_set_gpr_idx_off
    s_mov_b32 s30, s3
    s_cmp_eq_u32 s34, 0
    s_cselect_b32 s56, s33, 0
    v_mfma_f32_32x32x16_bf16 v[32:47], v[72:75], v[188:191], v[32:47]
    s_mov_b32 s32, s31
    s_mov_b32 s31, s35
    v_mul_f32 v242, v0, v144
    v_fma_f32 v240, v8, v160, -v240
    v_fmac_f32 v242, v1, v145
    v_fmac_f32 v240, v9, v161
    v_fmac_f32 v242, v2, v146
    v_mfma_f32_32x32x16_bf16 v[48:63], v[76:79], v[188:191], v[48:63]
    s_setprio 0
    v_fmac_f32 v240, v10, v162
    v_fmac_f32 v242, v3, v147
    v_fmac_f32 v240, v11, v163
    v_fmac_f32 v242, v4, v148
    v_fmac_f32 v240, v12, v164
    v_fmac_f32 v242, v5, v149
    v_fmac_f32 v240, v13, v165
    v_fmac_f32 v242, v6, v150
    v_fmac_f32 v240, v14, v166
    v_fmac_f32 v242, v7, v151
    v_fmac_f32 v240, v15, v167
    v_add_u32 v249, s26, v249
    v_add_u32 v250, s26, v250
    v_fma_f32 v244, v16, v160, -v244
    v_fmac_f32 v236, v24, v112
    v_fmac_f32 v244, v17, v161
    v_fmac_f32 v236, v25, v113
    v_fmac_f32 v244, v18, v162
    v_fmac_f32 v236, v26, v114
    v_fmac_f32 v244, v19, v163
    v_fmac_f32 v236, v27, v115
    v_fmac_f32 v244, v20, v164
    v_fmac_f32 v236, v28, v116
    v_fmac_f32 v244, v21, v165
    v_fmac_f32 v236, v29, v117
    v_fmac_f32 v244, v22, v166
    v_fmac_f32 v236, v30, v118
    v_fmac_f32 v244, v23, v167
    v_fmac_f32 v236, v31, v119
    ds_read_b64_tr_b16 v[0:1], v249 offset:0
    ds_read_b64_tr_b16 v[2:3], v249 offset:128
    ds_read_b128 v[4:7], v250 offset:0
    ds_read_b128 v[8:11], v250 offset:16
    ds_read_b128 v[12:15], v250 offset:384
    ds_read_b128 v[16:19], v250 offset:400
    v_mul_f32 v243, v32, v152
    v_fma_f32 v241, v40, v168, -v241
    v_fmac_f32 v243, v33, v153
    v_fmac_f32 v241, v41, v169
    v_fmac_f32 v243, v34, v154
    v_fmac_f32 v241, v42, v170
    v_fmac_f32 v243, v35, v155
    v_fmac_f32 v241, v43, v171
    v_fmac_f32 v243, v36, v156
    v_fmac_f32 v241, v44, v172
    v_fmac_f32 v243, v37, v157
    v_fmac_f32 v241, v45, v173
    v_fmac_f32 v243, v38, v158
    v_fmac_f32 v241, v46, v174
    v_fmac_f32 v243, v39, v159
    v_fmac_f32 v241, v47, v175
    ds_read_b64_tr_b16 v[20:21], v249 offset:512
    ds_read_b64_tr_b16 v[22:23], v249 offset:640
    ds_read_b128 v[24:27], v250 offset:64
    ds_read_b128 v[28:31], v250 offset:80
    ds_read_b128 v[32:35], v250 offset:448
    ds_read_b128 v[36:39], v250 offset:464
    v_fma_f32 v245, v48, v168, -v245
    v_fmac_f32 v237, v56, v120
    v_fmac_f32 v245, v49, v169
    v_fmac_f32 v237, v57, v121
    v_fmac_f32 v245, v50, v170
    v_fmac_f32 v237, v58, v122
    v_fmac_f32 v245, v51, v171
    v_fmac_f32 v237, v59, v123
    v_fmac_f32 v245, v52, v172
    v_fmac_f32 v237, v60, v124
    v_fmac_f32 v245, v53, v173
    v_fmac_f32 v237, v61, v125
    v_fmac_f32 v245, v54, v174
    v_fmac_f32 v237, v62, v126
    v_fmac_f32 v245, v55, v175
    v_fmac_f32 v237, v63, v127
    s_cmp_eq_u32 s56, 2
    s_cbranch_scc1 K2_U20
    s_cmp_eq_u32 s56, 3
    s_cbranch_scc1 K2_U30
    s_branch K2_DSP0
K2_PAD_U30:
    s_branch K2_HOP
K2_U30:
    s_setprio 1
    s_waitcnt lgkmcnt(6)
    v_lshlrev_b32 v40, 16, v0
    v_and_b32 v41, 0xffff0000, v0
    v_lshlrev_b32 v42, 16, v1
    v_and_b32 v43, 0xffff0000, v1
    v_lshlrev_b32 v44, 16, v2
    v_and_b32 v45, 0xffff0000, v2
    v_lshlrev_b32 v46, 16, v3
    v_and_b32 v47, 0xffff0000, v3
    v_mul_f32 v4, v40, v4
    v_mul_f32 v5, v41, v5
    v_mul_f32 v6, v42, v6
    v_mul_f32 v7, v43, v7
    v_mul_f32 v8, v44, v8
    v_mul_f32 v9, v45, v9
    v_mul_f32 v10, v46, v10
    v_mul_f32 v11, v47, v11
    v_cvt_pk_bf16_f32 v64, v4, v5
    v_cvt_pk_bf16_f32 v65, v6, v7
    v_cvt_pk_bf16_f32 v66, v8, v9
    v_cvt_pk_bf16_f32 v67, v10, v11
    v_mul_f32 v12, v40, v12
    v_mul_f32 v13, v41, v13
    v_mul_f32 v14, v42, v14
    v_mul_f32 v15, v43, v15
    v_mul_f32 v16, v44, v16
    v_mul_f32 v17, v45, v17
    v_mul_f32 v18, v46, v18
    v_mul_f32 v19, v47, v19
    v_cvt_pk_bf16_f32 v68, v12, v13
    v_cvt_pk_bf16_f32 v69, v14, v15
    v_cvt_pk_bf16_f32 v70, v16, v17
    v_cvt_pk_bf16_f32 v71, v18, v19
    ds_read_b64_tr_b16 v[0:1], v249 offset:1024
    ds_read_b64_tr_b16 v[2:3], v249 offset:1152
    ds_read_b128 v[4:7], v250 offset:128
    ds_read_b128 v[8:11], v250 offset:144
    ds_read_b128 v[12:15], v250 offset:512
    ds_read_b128 v[16:19], v250 offset:528
    s_waitcnt lgkmcnt(6)
    v_lshlrev_b32 v48, 16, v20
    v_and_b32 v49, 0xffff0000, v20
    v_lshlrev_b32 v50, 16, v21
    v_and_b32 v51, 0xffff0000, v21
    v_lshlrev_b32 v52, 16, v22
    v_and_b32 v53, 0xffff0000, v22
    v_lshlrev_b32 v54, 16, v23
    v_and_b32 v55, 0xffff0000, v23
    v_mul_f32 v24, v48, v24
    v_mul_f32 v25, v49, v25
    v_mul_f32 v26, v50, v26
    v_mul_f32 v27, v51, v27
    v_mul_f32 v28, v52, v28
    v_mul_f32 v29, v53, v29
    v_mul_f32 v30, v54, v30
    v_mul_f32 v31, v55, v31
    v_cvt_pk_bf16_f32 v72, v24, v25
    v_cvt_pk_bf16_f32 v73, v26, v27
    v_cvt_pk_bf16_f32 v74, v28, v29
    v_cvt_pk_bf16_f32 v75, v30, v31
    v_mul_f32 v32, v48, v32
    v_mul_f32 v33, v49, v33
    v_mul_f32 v34, v50, v34
    v_mul_f32 v35, v51, v35
    v_mul_f32 v36, v52, v36
    v_mul_f32 v37, v53, v37
    v_mul_f32 v38, v54, v38
    v_mul_f32 v39, v55, v39
    v_cvt_pk_bf16_f32 v76, v32, v33
    v_cvt_pk_bf16_f32 v77, v34, v35
    v_cvt_pk_bf16_f32 v78, v36, v37
    v_cvt_pk_bf16_f32 v79, v38, v39
    s_waitcnt lgkmcnt(4)
    v_lshlrev_b32 v40, 16, v0
    v_and_b32 v41, 0xffff0000, v0
    v_lshlrev_b32 v42, 16, v1
    v_and_b32 v43, 0xffff0000, v1
    v_lshlrev_b32 v44, 16, v2
    v_and_b32 v45, 0xffff0000, v2
    v_lshlrev_b32 v46, 16, v3
    v_and_b32 v47, 0xffff0000, v3
    s_waitcnt lgkmcnt(2)
    v_mul_f32 v4, v40, v4
    v_mul_f32 v5, v41, v5
    v_mul_f32 v6, v42, v6
    v_mul_f32 v7, v43, v7
    v_mul_f32 v8, v44, v8
    v_mul_f32 v9, v45, v9
    v_mul_f32 v10, v46, v10
    v_mul_f32 v11, v47, v11
    v_cvt_pk_bf16_f32 v80, v4, v5
    v_cvt_pk_bf16_f32 v81, v6, v7
    v_cvt_pk_bf16_f32 v82, v8, v9
    v_cvt_pk_bf16_f32 v83, v10, v11
    s_waitcnt lgkmcnt(0)
    v_mul_f32 v12, v40, v12
    v_mul_f32 v13, v41, v13
    v_mul_f32 v14, v42, v14
    v_mul_f32 v15, v43, v15
    v_mul_f32 v16, v44, v16
    v_mul_f32 v17, v45, v17
    v_mul_f32 v18, v46, v18
    v_mul_f32 v19, v47, v19
    v_cvt_pk_bf16_f32 v84, v12, v13
    v_cvt_pk_bf16_f32 v85, v14, v15
    v_cvt_pk_bf16_f32 v86, v16, v17
    v_cvt_pk_bf16_f32 v87, v18, v19
    s_waitcnt vmcnt(4)
    v_mfma_f32_32x32x16_bf16 v[0:15], v[64:67], v[176:179], 0
    ds_read_b64_tr_b16 v[184:185], v246 offset:2048
    ds_read_b64_tr_b16 v[186:187], v246 offset:2560
    ds_read_b64_tr_b16 v[188:189], v247 offset:2048
    ds_read_b64_tr_b16 v[190:191], v247 offset:2560
    s_mov_b32 m0, s68
    v_mfma_f32_32x32x16_bf16 v[16:31], v[68:71], v[176:179], 0
    buffer_load_dwordx4 v224, s[4:7], s41 offen sc1 lds
    buffer_load_dwordx4 v225, s[72:75], s41 offen offset:1024 sc1 lds
    v_permlane32_swap_b32 v242, v236
    v_permlane32_swap_b32 v243, v237
    s_add_u32 s38, s38, 1
    v_mfma_f32_32x32x16_bf16 v[32:47], v[64:67], v[180:183], 0
    v_permlane32_swap_b32 v244, v238
    v_permlane32_swap_b32 v245, v239
    v_permlane32_swap_b32 v240, v241
    v_add_f32 v242, v242, v236
    v_mfma_f32_32x32x16_bf16 v[48:63], v[68:71], v[180:183], 0
    v_add_f32 v243, v243, v237
    v_add_f32 v244, v244, v238
    v_add_f32 v245, v245, v239
    v_add_f32 v240, -v240, -v241
    v_mov_b32 v254, s52
    v_mov_b32 v255, s38
    s_waitcnt vmcnt(4) lgkmcnt(0)
    v_mfma_f32_32x32x16_bf16 v[0:15], v[72:75], v[184:187], v[0:15]
    ds_read_b64_tr_b16 v[176:177], v246 offset:4096
    ds_read_b64_tr_b16 v[178:179], v246 offset:4608
    ds_read_b64_tr_b16 v[180:181], v247 offset:4096
    ds_read_b64_tr_b16 v[182:183], v247 offset:4608
    s_lshl_b32 s58, s38, 3
    s_add_u32 s58, s58, s20
    s_mov_b32 m0, s69
    v_mfma_f32_32x32x16_bf16 v[16:31], v[76:79], v[184:187], v[16:31]
    buffer_load_dwordx4 v226, s[4:7], s41 offen sc1 lds
    buffer_load_dwordx4 v227, s[72:75], s41 offen offset:1024 sc1 lds
    s_set_gpr_idx_on s32, gpr_idx(DST)
    s_nop 0
    v_cvt_pk_bf16_f32 v195, v242, v243
    v_cvt_pk_bf16_f32 v196, v244, v245
    v_cvt_pk_bf16_f32 v197, v240, v240
    s_set_gpr_idx_off
    s_mov_b64 exec, 1
    ds_write_b32 v254, v255
    s_mov_b64 exec, -1
    s_cmp_lt_u32 s58, s22
    s_cbranch_scc0 K2_dyn_21
K2_back_22:
    v_readlane_b32 s3, v253, s58
    s_lshl_b32 s44, s34, 7
    s_lshl_b32 s60, s58, 5
    s_and_b32 s48, s3, 0x3ffff
    s_bfe_u32 s33, s3, 0x30012
    s_sub_u32 s60, s60, s48
    s_and_b32 s60, s60, 0xff
    s_add_u32 s60, s60, s48
    s_mul_i32 s35, s38, 6
    s_cmp_eq_u32 s34, 0
    s_cselect_b32 s35, s35, s60
    s_mov_b32 s45, s44
    s_add_u32 s47, s44, 256
    s_add_u32 s49, s48, 32
    s_add_u32 s60, s48, 64
    s_cmp_eq_u32 s33, 3
    s_cselect_b32 s46, s44, s47
    s_cselect_b32 s50, s60, s48
    s_cselect_b32 s51, s48, s49
    s_sub_u32 s60, s33, 2
    s_cmp_lt_u32 s60, 2
    s_cbranch_scc0 K2_rare_27
K2_back_28:
    v_mfma_f32_32x32x16_bf16 v[32:47], v[72:75], v[188:191], v[32:47]
    v_add_u32 v233, s48, v230
    ds_read_b32 v232, v233
    ds_read_b32 v233, v233 offset:1024
    v_mfma_f32_32x32x16_bf16 v[48:63], v[76:79], v[188:191], v[48:63]
    s_waitcnt vmcnt(4) lgkmcnt(3)
    v_mfma_f32_32x32x16_bf16 v[0:15], v[80:83], v[176:179], v[0:15]
    ds_read_b64_tr_b16 v[184:185], v246 offset:6144
    ds_read_b64_tr_b16 v[186:187], v246 offset:6656
    ds_read_b64_tr_b16 v[188:189], v247 offset:6144
    ds_read_b64_tr_b16 v[190:191], v247 offset:6656
    s_mov_b32 m0, s70
    v_mfma_f32_32x32x16_bf16 v[16:31], v[84:87], v[176:179], v[16:31]
    buffer_load_dwordx4 v222, s[4:7], s42 offen sc1 lds
    buffer_load_dwordx4 v223, s[72:75], s42 offen offset:1024 sc1 lds
    v_mfma_f32_32x32x16_bf16 v[32:47], v[80:83], v[180:183], v[32:47]
    s_nop 2
    v_mul_f32 v234, v0, v96
    v_mul_f32 v236, v8, v128
    v_fmac_f32 v234, v1, v97
    v_fmac_f32 v236, v9, v129
    v_fmac_f32 v234, v2, v98
    v_fmac_f32 v236, v10, v130
    v_fmac_f32 v234, v3, v99
    v_mfma_f32_32x32x16_bf16 v[48:63], v[84:87], v[180:183], v[48:63]
    s_setprio 0
    s_waitcnt lgkmcnt(4)
    v_or_b32 v232, v232, v231
    v_or_b32 v233, v233, v231
    s_cmp_lg_u32 s34, 0
    s_cbranch_scc1 K2_dum_30
    s_add_u32 m0, s48, 864
    s_add_u32 s65, s48, 1888
    buffer_load_dwordx4 v232, s[16:19], 0 offen  lds
    s_mov_b32 m0, s65
    s_mov_b32 exec_hi, 0
    buffer_load_dwordx4 v233, s[16:19], 0 offen  lds
    s_cmp_eq_u32 s33, 4
    s_cbranch_scc1 K2_a4_31
K2_b4_33:
    s_mov_b32 exec_hi, -1
K2_back_32:
    v_fmac_f32 v236, v11, v131
    v_fmac_f32 v234, v4, v100
    v_fmac_f32 v236, v12, v132
    v_fmac_f32 v234, v5, v101
    v_fmac_f32 v236, v13, v133
    v_fmac_f32 v234, v6, v102
    v_fmac_f32 v236, v14, v134
    v_fmac_f32 v234, v7, v103
    v_fmac_f32 v236, v15, v135
    v_mul_f32 v238, v16, v128
    v_mul_f32 v240, v24, v128
    v_fmac_f32 v238, v17, v129
    v_fmac_f32 v240, v25, v129
    v_fmac_f32 v238, v18, v130
    v_fmac_f32 v240, v26, v130
    v_fmac_f32 v238, v19, v131
    v_fmac_f32 v240, v27, v131
    v_fmac_f32 v238, v20, v132
    v_fmac_f32 v240, v28, v132
    v_fmac_f32 v238, v21, v133
    v_fmac_f32 v240, v29, v133
    v_fmac_f32 v238, v22, v134
    v_fmac_f32 v240, v30, v134
    v_fmac_f32 v238, v23, v135
    v_fmac_f32 v240, v31, v135
    v_mul_f32 v235, v32, v104
    v_mul_f32 v237, v40, v136
    v_fmac_f32 v235, v33, v105
    v_fmac_f32 v237, v41, v137
    v_fmac_f32 v235, v34, v106
    v_fmac_f32 v237, v42, v138
    v_fmac_f32 v235, v35, v107
    v_fmac_f32 v237, v43, v139
    v_fmac_f32 v235, v36, v108
    v_fmac_f32 v237, v44, v140
    v_fmac_f32 v235, v37, v109
    v_fmac_f32 v237, v45, v141
    v_fmac_f32 v235, v38, v110
    v_fmac_f32 v237, v46, v142
    v_fmac_f32 v235, v39, v111
    v_fmac_f32 v237, v47, v143
    v_mul_f32 v239, v48, v136
    v_mul_f32 v241, v56, v136
    s_setprio 1
    s_waitcnt vmcnt(6) lgkmcnt(0)
    v_mfma_f32_32x32x16_bf16 v[0:15], v[64:67], v[184:187], 0
    ds_read_b64_tr_b16 v[176:177], v246 offset:0
    ds_read_b64_tr_b16 v[178:179], v246 offset:512
    ds_read_b64_tr_b16 v[180:181], v247 offset:0
    ds_read_b64_tr_b16 v[182:183], v247 offset:512
    v_fmac_f32 v239, v49, v137
    v_fmac_f32 v241, v57, v137
    s_mov_b32 m0, s71
    v_mfma_f32_32x32x16_bf16 v[16:31], v[68:71], v[184:187], 0
    buffer_load_dwordx4 v224, s[4:7], s42 offen sc1 lds
    buffer_load_dwordx4 v225, s[72:75], s42 offen offset:1024 sc1 lds
    v_fmac_f32 v239, v50, v138
    v_fmac_f32 v241, v58, v138
    v_fmac_f32 v239, v51, v139
    v_fmac_f32 v241, v59, v139
    v_fmac_f32 v239, v52, v140
    v_mfma_f32_32x32x16_bf16 v[32:47], v[64:67], v[188:191], 0
    v_fmac_f32 v241, v60, v140
    v_fmac_f32 v239, v53, v141
    v_fmac_f32 v241, v61, v141
    v_fmac_f32 v239, v54, v142
    v_fmac_f32 v241, v62, v142
    v_fmac_f32 v239, v55, v143
    v_fmac_f32 v241, v63, v143
    v_mfma_f32_32x32x16_bf16 v[48:63], v[68:71], v[188:191], 0
    v_permlane32_swap_b32 v234, v236
    v_permlane32_swap_b32 v235, v237
    v_permlane32_swap_b32 v240, v238
    s_waitcnt vmcnt(6) lgkmcnt(0)
    v_mfma_f32_32x32x16_bf16 v[0:15], v[72:75], v[176:179], v[0:15]
    ds_read_b64_tr_b16 v[184:185], v246 offset:2048
    ds_read_b64_tr_b16 v[186:187], v246 offset:2560
    ds_read_b64_tr_b16 v[188:189], v247 offset:2048
    ds_read_b64_tr_b16 v[190:191], v247 offset:2560
    v_permlane32_swap_b32 v241, v239
    s_mov_b32 m0, s68
    v_mfma_f32_32x32x16_bf16 v[16:31], v[76:79], v[176:179], v[16:31]
    buffer_load_dwordx4 v226, s[4:7], s42 offen sc1 lds
    buffer_load_dwordx4 v227, s[72:75], s42 offen offset:1024 sc1 lds
    v_add_f32 v234, v234, v236
    v_add_f32 v235, v235, v237
    v_add_f32 v240, v240, v238
    v_add_f32 v241, v241, v239
    v_mfma_f32_32x32x16_bf16 v[32:47], v[72:75], v[180:183], v[32:47]
    s_set_gpr_idx_on s31, gpr_idx(DST)
    s_nop 0
    v_cvt_pk_bf16_f32 v192, v234, v235
    v_cvt_pk_bf16_f32 v193, v240, v241
    s_set_gpr_idx_off
    v_mfma_f32_32x32x16_bf16 v[48:63], v[76:79], v[180:183], v[48:63]
    s_waitcnt vmcnt(6) lgkmcnt(0)
    v_mfma_f32_32x32x16_bf16 v[0:15], v[80:83], v[184:187], v[0:15]
    ds_read_b64_tr_b16 v[176:177], v246 offset:4096
    ds_read_b64_tr_b16 v[178:179], v246 offset:4608
    ds_read_b64_tr_b16 v[180:181], v247 offset:4096
    ds_read_b64_tr_b16 v[182:183], v247 offset:4608
    s_mov_b32 m0, s69
    v_mfma_f32_32x32x16_bf16 v[16:31], v[84:87], v[184:187], v[16:31]
    buffer_load_dwordx4 v222, s[4:7], s43 offen sc1 lds
    buffer_load_dwordx4 v223, s[72:75], s43 offen offset:1024 sc1 lds
    v_mfma_f32_32x32x16_bf16 v[32:47], v[80:83], v[188:191], v[32:47]
    s_nop 2
    v_mul_f32 v234, v0, v144
    v_mul_f32 v236, v8, v112
    v_fmac_f32 v234, v1, v145
    v_fmac_f32 v236, v9, v113
    v_fmac_f32 v234, v2, v146
    v_fmac_f32 v236, v10, v114
    v_fmac_f32 v234, v3, v147
    v_mfma_f32_32x32x16_bf16 v[48:63], v[84:87], v[188:191], v[48:63]
    s_setprio 0
    v_fmac_f32 v236, v11, v115
    v_fmac_f32 v234, v4, v148
    v_fmac_f32 v236, v12, v116
    v_fmac_f32 v234, v5, v149
    v_fmac_f32 v236, v13, v117
    v_fmac_f32 v234, v6, v150
    v_fmac_f32 v236, v14, v118
    v_fmac_f32 v234, v7, v151
    v_fmac_f32 v236, v15, v119
    v_mul_f32 v238, v16, v160
    v_mul_f32 v240, v24, v160
    v_fmac_f32 v238, v17, v161
    v_fmac_f32 v240, v25, v161
    v_fmac_f32 v238, v18, v162
    v_fmac_f32 v240, v26, v162
    v_fmac_f32 v238, v19, v163
    v_fmac_f32 v240, v27, v163
    v_fmac_f32 v238, v20, v164
    v_fmac_f32 v240, v28, v164
    v_fmac_f32 v238, v21, v165
    v_fmac_f32 v240, v29, v165
    v_fmac_f32 v238, v22, v166
    v_fmac_f32 v240, v30, v166
    v_fmac_f32 v238, v23, v167
    v_fmac_f32 v240, v31, v167
    v_mul_f32 v235, v32, v152
    v_mul_f32 v237, v40, v120
    v_fmac_f32 v235, v33, v153
    v_fmac_f32 v237, v41, v121
    v_fmac_f32 v235, v34, v154
    v_fmac_f32 v237, v42, v122
    v_fmac_f32 v235, v35, v155
    v_fmac_f32 v237, v43, v123
    v_fmac_f32 v235, v36, v156
    v_fmac_f32 v237, v44, v124
    v_fmac_f32 v235, v37, v157
    v_fmac_f32 v237, v45, v125
    v_fmac_f32 v235, v38, v158
    v_fmac_f32 v237, v46, v126
    v_fmac_f32 v235, v39, v159
    v_fmac_f32 v237, v47, v127
    v_mul_f32 v239, v48, v168
    v_mul_f32 v241, v56, v168
    v_fmac_f32 v239, v49, v169
    v_fmac_f32 v241, v57, v169
    s_setprio 1
    s_waitcnt vmcnt(4) lgkmcnt(0)
    v_mfma_f32_32x32x16_bf16 v[0:15], v[64:67], v[176:179], 0
    ds_read_b64_tr_b16 v[184:185], v246 offset:6144
    ds_read_b64_tr_b16 v[186:187], v246 offset:6656
    ds_read_b64_tr_b16 v[188:189], v247 offset:6144
    ds_read_b64_tr_b16 v[190:191], v247 offset:6656
    v_fmac_f32 v239, v50, v170
    v_fmac_f32 v241, v58, v170
    s_mov_b32 m0, s70
    v_mfma_f32_32x32x16_bf16 v[16:31], v[68:71], v[176:179], 0
    buffer_load_dwordx4 v224, s[4:7], s43 offen sc1 lds
    buffer_load_dwordx4 v225, s[72:75], s43 offen offset:1024 sc1 lds
    v_fmac_f32 v239, v51, v171
    v_fmac_f32 v241, v59, v171
    v_fmac_f32 v239, v52, v172
    v_fmac_f32 v241, v60, v172
    v_fmac_f32 v239, v53, v173
    v_mfma_f32_32x32x16_bf16 v[32:47], v[64:67], v[180:183], 0
    v_add_u32 v222, s48, v251
    ds_read_b32 v222, v222
    v_fmac_f32 v241, v61, v173
    v_fmac_f32 v239, v54, v174
    v_fmac_f32 v241, v62, v174
    v_fmac_f32 v239, v55, v175
    v_fmac_f32 v241, v63, v175
    v_mfma_f32_32x32x16_bf16 v[48:63], v[68:71], v[180:183], 0
    s_waitcnt vmcnt(4) lgkmcnt(1)
    v_mfma_f32_32x32x16_bf16 v[0:15], v[72:75], v[184:187], v[0:15]
    ds_read_b64_tr_b16 v[176:177], v246 offset:0
    ds_read_b64_tr_b16 v[178:179], v246 offset:512
    ds_read_b64_tr_b16 v[180:181], v247 offset:0
    ds_read_b64_tr_b16 v[182:183], v247 offset:512
    s_mov_b32 m0, s71
    v_mfma_f32_32x32x16_bf16 v[16:31], v[76:79], v[184:187], v[16:31]
    buffer_load_dwordx4 v226, s[4:7], s43 offen sc1 lds
    buffer_load_dwordx4 v227, s[72:75], s43 offen offset:1024 sc1 lds
    s_waitcnt lgkmcnt(4)
    v_mad_u32_u16 v223, v222, s39, v248 op_sel:[1,0,0,0]
    v_mad_u32_u16 v222, v222, s39, v248
    v_mfma_f32_32x32x16_bf16 v[32:47], v[72:75], v[188:191], v[32:47]
    v_add_u32 v224, s49, v251
    ds_read_b32 v224, v224
    v_mfma_f32_32x32x16_bf16 v[48:63], v[76:79], v[188:191], v[48:63]
    s_waitcnt vmcnt(4) lgkmcnt(1)
    v_mfma_f32_32x32x16_bf16 v[0:15], v[80:83], v[176:179], v[0:15]
    ds_read_b64_tr_b16 v[184:185], v246 offset:2048
    ds_read_b64_tr_b16 v[186:187], v246 offset:2560
    ds_read_b64_tr_b16 v[188:189], v247 offset:2048
    ds_read_b64_tr_b16 v[190:191], v247 offset:2560
    s_mov_b32 m0, s68
    v_mfma_f32_32x32x16_bf16 v[16:31], v[84:87], v[176:179], v[16:31]
    buffer_load_dwordx4 v222, s[4:7], s44 offen sc1 lds
    buffer_load_dwordx4 v223, s[72:75], s44 offen offset:1024 sc1 lds
    s_waitcnt lgkmcnt(4)
    v_mad_u32_u16 v225, v224, s39, v248 op_sel:[1,0,0,0]
    v_mad_u32_u16 v224, v224, s39, v248
    v_mfma_f32_32x32x16_bf16 v[32:47], v[80:83], v[180:183], v[32:47]
    v_add_u32 v226, s50, v251
    ds_read_b32 v226, v226
    v_mul_f32 v242, v0, v144
    v_fma_f32 v238, v8, v160, -v238
    v_fmac_f32 v242, v1, v145
    v_fmac_f32 v238, v9, v161
    v_fmac_f32 v242, v2, v146
    v_mfma_f32_32x32x16_bf16 v[48:63], v[84:87], v[180:183], v[48:63]
    s_setprio 0
    v_fmac_f32 v238, v10, v162
    v_fmac_f32 v242, v3, v147
    v_fmac_f32 v238, v11, v163
    v_fmac_f32 v242, v4, v148
    v_fmac_f32 v238, v12, v164
    v_fmac_f32 v242, v5, v149
    v_fmac_f32 v238, v13, v165
    v_fmac_f32 v242, v6, v150
    v_fmac_f32 v238, v14, v166
    v_fmac_f32 v242, v7, v151
    v_fmac_f32 v238, v15, v167
    v_fmac_f32 v236, v16, v112
    v_mul_f32 v244, v24, v160
    v_fmac_f32 v236, v17, v113
    v_fmac_f32 v244, v25, v161
    v_fmac_f32 v236, v18, v114
    v_fmac_f32 v244, v26, v162
    v_fmac_f32 v236, v19, v115
    v_fmac_f32 v244, v27, v163
    v_fmac_f32 v236, v20, v116
    v_fmac_f32 v244, v28, v164
    v_fmac_f32 v236, v21, v117
    v_fmac_f32 v244, v29, v165
    v_fmac_f32 v236, v22, v118
    v_fmac_f32 v244, v30, v166
    v_fmac_f32 v236, v23, v119
    v_fmac_f32 v244, v31, v167
    v_mul_f32 v243, v32, v152
    v_fma_f32 v239, v40, v168, -v239
    v_fmac_f32 v243, v33, v153
    v_fmac_f32 v239, v41, v169
    v_fmac_f32 v243, v34, v154
    v_fmac_f32 v239, v42, v170
    v_fmac_f32 v243, v35, v155
    v_fmac_f32 v239, v43, v171
    v_fmac_f32 v243, v36, v156
    v_fmac_f32 v239, v44, v172
    v_fmac_f32 v243, v37, v157
    v_fmac_f32 v239, v45, v173
    v_fmac_f32 v243, v38, v158
    v_fmac_f32 v239, v46, v174
    v_fmac_f32 v243, v39, v159
    v_fmac_f32 v239, v47, v175
    v_fmac_f32 v237, v48, v120
    v_mul_f32 v245, v56, v168
    v_fmac_f32 v237, v49, v121
    v_fmac_f32 v245, v57, v169
    v_fmac_f32 v237, v50, v122
    v_fmac_f32 v245, v58, v170
    v_fmac_f32 v237, v51, v123
    s_setprio 1
    s_waitcnt vmcnt(4) lgkmcnt(1)
    v_mfma_f32_32x32x16_bf16 v[0:15], v[64:67], v[184:187], 0
    ds_read_b64_tr_b16 v[176:177], v246 offset:4096
    ds_read_b64_tr_b16 v[178:179], v246 offset:4608
    ds_read_b64_tr_b16 v[180:181], v247 offset:4096
    ds_read_b64_tr_b16 v[182:183], v247 offset:4608
    v_fmac_f32 v245, v59, v171
    v_fmac_f32 v237, v52, v124
    s_mov_b32 m0, s69
    v_mfma_f32_32x32x16_bf16 v[16:31], v[68:71], v[184:187], 0
    buffer_load_dwordx4 v224, s[4:7], s45 offen sc1 lds
    buffer_load_dwordx4 v225, s[72:75], s45 offen offset:1024 sc1 lds
    s_waitcnt lgkmcnt(4)
    v_mad_u32_u16 v227, v226, s39, v248 op_sel:[1,0,0,0]
    v_mad_u32_u16 v226, v226, s39, v248
    v_fmac_f32 v245, v60, v172
    v_fmac_f32 v237, v53, v125
    v_mfma_f32_32x32x16_bf16 v[32:47], v[64:67], v[188:191], 0
    v_add_u32 v228, s51, v251
    ds_read_b32 v228, v228
    v_fmac_f32 v245, v61, v173
    v_fmac_f32 v237, v54, v126
    v_fmac_f32 v245, v62, v174
    v_fmac_f32 v237, v55, v127
    v_fmac_f32 v245, v63, v175
    v_mfma_f32_32x32x16_bf16 v[48:63], v[68:71], v[188:191], 0
    v_permlane32_swap_b32 v242, v234
    v_permlane32_swap_b32 v243, v235
    v_add_f32 v242, v242, v234
    v_add_f32 v243, v243, v235
    s_waitcnt vmcnt(4) lgkmcnt(1)
    v_mfma_f32_32x32x16_bf16 v[0:15], v[72:75], v[176:179], v[0:15]
    ds_read_b64_tr_b16 v[184:185], v246 offset:6144
    ds_read_b64_tr_b16 v[186:187], v246 offset:6656
    ds_read_b64_tr_b16 v[188:189], v247 offset:6144
    ds_read_b64_tr_b16 v[190:191], v247 offset:6656
    s_mov_b32 m0, s70
    v_mfma_f32_32x32x16_bf16 v[16:31], v[76:79], v[176:179], v[16:31]
    buffer_load_dwordx4 v226, s[4:7], s46 offen sc1 lds
    buffer_load_dwordx4 v227, s[72:75], s46 offen offset:1024 sc1 lds
    s_waitcnt lgkmcnt(4)
    v_mad_u32_u16 v229, v228, s39, v248 op_sel:[1,0,0,0]
    v_mad_u32_u16 v228, v228, s39, v248
    s_sub_u32 s26, s48, s29
    s_mov_b32 s29, s48
    v_mfma_f32_32x32x16_bf16 v[32:47], v[72:75], v[180:183], v[32:47]
    s_set_gpr_idx_on s31, gpr_idx(DST)
    s_nop 0
    v_cvt_pk_bf16_f32 v194, v242, v243
    s_set_gpr_idx_off
    s_mov_b32 s30, s3
    s_cmp_eq_u32 s34, 0
    s_cselect_b32 s56, s33, 0
    s_mov_b32 s32, s31
    v_mfma_f32_32x32x16_bf16 v[48:63], v[76:79], v[180:183], v[48:63]
    s_mov_b32 s31, s35
    s_waitcnt vmcnt(4) lgkmcnt(0)
    v_mfma_f32_32x32x16_bf16 v[0:15], v[80:83], v[184:187], v[0:15]
    ds_read_b64_tr_b16 v[176:177], v246 offset:0
    ds_read_b64_tr_b16 v[178:179], v246 offset:512
    ds_read_b64_tr_b16 v[180:181], v247 offset:0
    ds_read_b64_tr_b16 v[182:183], v247 offset:512
    s_mov_b32 m0, s71
    v_mfma_f32_32x32x16_bf16 v[16:31], v[84:87], v[184:187], v[16:31]
    buffer_load_dwordx4 v228, s[4:7], s47 offen sc1 lds
    buffer_load_dwordx4 v229, s[72:75], s47 offen offset:1024 sc1 lds
    v_mfma_f32_32x32x16_bf16 v[32:47], v[80:83], v[188:191], v[32:47]
    s_nop 2
    v_mul_f32 v242, v0, v144
    v_fma_f32 v240, v8, v160, -v240
    v_fmac_f32 v242, v1, v145
    v_fmac_f32 v240, v9, v161
    v_fmac_f32 v242, v2, v146
    v_fmac_f32 v240, v10, v162
    v_fmac_f32 v242, v3, v147
    v_mfma_f32_32x32x16_bf16 v[48:63], v[84:87], v[188:191], v[48:63]
    s_setprio 0
    v_fmac_f32 v240, v11, v163
    v_fmac_f32 v242, v4, v148
    v_fmac_f32 v240, v12, v164
    v_fmac_f32 v242, v5, v149
    v_fmac_f32 v240, v13, v165
    v_fmac_f32 v242, v6, v150
    v_fmac_f32 v240, v14, v166
    v_fmac_f32 v242, v7, v151
    v_fmac_f32 v240, v15, v167
    v_add_u32 v249, s26, v249
    v_add_u32 v250, s26, v250
    v_fma_f32 v244, v16, v160, -v244
    v_fmac_f32 v236, v24, v112
    v_fmac_f32 v244, v17, v161
    v_fmac_f32 v236, v25, v113
    v_fmac_f32 v244, v18, v162
    v_fmac_f32 v236, v26, v114
    v_fmac_f32 v244, v19, v163
    v_fmac_f32 v236, v27, v115
    v_fmac_f32 v244, v20, v164
    v_fmac_f32 v236, v28, v116
    v_fmac_f32 v244, v21, v165
    v_fmac_f32 v236, v29, v117
    v_fmac_f32 v244, v22, v166
    v_fmac_f32 v236, v30, v118
    v_fmac_f32 v244, v23, v167
    v_fmac_f32 v236, v31, v119
    ds_read_b64_tr_b16 v[0:1], v249 offset:0
    ds_read_b64_tr_b16 v[2:3], v249 offset:128
    ds_read_b128 v[4:7], v250 offset:0
    ds_read_b128 v[8:11], v250 offset:16
    ds_read_b128 v[12:15], v250 offset:384
    ds_read_b128 v[16:19], v250 offset:400
    v_mul_f32 v243, v32, v152
    v_fma_f32 v241, v40, v168, -v241
    v_fmac_f32 v243, v33, v153
    v_fmac_f32 v241, v41, v169
    v_fmac_f32 v243, v34, v154
    v_fmac_f32 v241, v42, v170
    v_fmac_f32 v243, v35, v155
    v_fmac_f32 v241, v43, v171
    v_fmac_f32 v243, v36, v156
    v_fmac_f32 v241, v44, v172
    v_fmac_f32 v243, v37, v157
    v_fmac_f32 v241, v45, v173
    v_fmac_f32 v243, v38, v158
    v_fmac_f32 v241, v46, v174
    v_fmac_f32 v243, v39, v159
    v_fmac_f32 v241, v47, v175
    ds_read_b64_tr_b16 v[20:21], v249 offset:512
    ds_read_b64_tr_b16 v[22:23], v249 offset:640
    ds_read_b128 v[24:27], v250 offset:64
    ds_read_b128 v[28:31], v250 offset:80
    ds_read_b128 v[32:35], v250 offset:448
    ds_read_b128 v[36:39], v250 offset:464
    v_fma_f32 v245, v48, v168, -v245
    v_fmac_f32 v237, v56, v120
    v_fmac_f32 v245, v49, v169
    v_fmac_f32 v237, v57, v121
    v_fmac_f32 v245, v50, v170
    v_fmac_f32 v237, v58, v122
    v_fmac_f32 v245, v51, v171
    v_fmac_f32 v237, v59, v123
    v_fmac_f32 v245, v52, v172
    v_fmac_f32 v237, v60, v124
    v_fmac_f32 v245, v53, v173
    v_fmac_f32 v237, v61, v125
    v_fmac_f32 v245, v54, v174
    v_fmac_f32 v237, v62, v126
    v_fmac_f32 v245, v55, v175
    v_fmac_f32 v237, v63, v127
    s_cmp_eq_u32 s56, 2
    s_cbranch_scc1 K2_U20
    s_cmp_eq_u32 s56, 3
    s_cbranch_scc1 K2_U30
    s_branch K2_DSP0
K2_PAD_U21:
    s_branch K2_HOP
K2_U21:
    s_setprio 1
    s_waitcnt lgkmcnt(6)
    v_lshlrev_b32 v40, 16, v0
    v_and_b32 v41, 0xffff0000, v0
    v_lshlrev_b32 v42, 16, v1
    v_and_b32 v43, 0xffff0000, v1
    v_lshlrev_b32 v44, 16, v2
    v_and_b32 v45, 0xffff0000, v2
    v_lshlrev_b32 v46, 16, v3
    v_and_b32 v47, 0xffff0000, v3
    v_mul_f32 v4, v40, v4
    v_mul_f32 v5, v41, v5
    v_mul_f32 v6, v42, v6
    v_mul_f32 v7, v43, v7
    v_mul_f32 v8, v44, v8
    v_mul_f32 v9, v45, v9
    v_mul_f32 v10, v46, v10
    v_mul_f32 v11, v47, v11
    v_cvt_pk_bf16_f32 v64, v4, v5
    v_cvt_pk_bf16_f32 v65, v6, v7
    v_cvt_pk_bf16_f32 v66, v8, v9
    v_cvt_pk_bf16_f32 v67, v10, v11
    v_mul_f32 v12, v40, v12
    v_mul_f32 v13, v41, v13
    v_mul_f32 v14, v42, v14
    v_mul_f32 v15, v43, v15
    v_mul_f32 v16, v44, v16
    v_mul_f32 v17, v45, v17
    v_mul_f32 v18, v46, v18
    v_mul_f32 v19, v47, v19
    v_cvt_pk_bf16_f32 v68, v12, v13
    v_cvt_pk_bf16_f32 v69, v14, v15
    v_cvt_pk_bf16_f32 v70, v16, v17
    v_cvt_pk_bf16_f32 v71, v18, v19
    s_waitcnt lgkmcnt(0)
    v_lshlrev_b32 v48, 16, v20
    v_and_b32 v49, 0xffff0000, v20
    v_lshlrev_b32 v50, 16, v21
    v_and_b32 v51, 0xffff0000, v21
    v_lshlrev_b32 v52, 16, v22
    v_and_b32 v53, 0xffff0000, v22
    v_lshlrev_b32 v54, 16, v23
    v_and_b32 v55, 0xffff0000, v23
    v_mul_f32 v24, v48, v24
    v_mul_f32 v25, v49, v25
    v_mul_f32 v26, v50, v26
    v_mul_f32 v27, v51, v27
    v_mul_f32 v28, v52, v28
    v_mul_f32 v29, v53, v29
    v_mul_f32 v30, v54, v30
    v_mul_f32 v31, v55, v31
    v_cvt_pk_bf16_f32 v72, v24, v25
    v_cvt_pk_bf16_f32 v73, v26, v27
    v_cvt_pk_bf16_f32 v74, v28, v29
    v_cvt_pk_bf16_f32 v75, v30, v31
    v_mul_f32 v32, v48, v32
    v_mul_f32 v33, v49, v33
    v_mul_f32 v34, v50, v34
    v_mul_f32 v35, v51, v35
    v_mul_f32 v36, v52, v36
    v_mul_f32 v37, v53, v37
    v_mul_f32 v38, v54, v38
    v_mul_f32 v39, v55, v39
    v_cvt_pk_bf16_f32 v76, v32, v33
    v_cvt_pk_bf16_f32 v77, v34, v35
    v_cvt_pk_bf16_f32 v78, v36, v37
    v_cvt_pk_bf16_f32 v79, v38, v39
    s_waitcnt vmcnt(4)
    v_mfma_f32_32x32x16_bf16 v[0:15], v[64:67], v[176:179], 0
    ds_read_b64_tr_b16 v[184:185], v246 offset:2048
    ds_read_b64_tr_b16 v[186:187], v246 offset:2560
    ds_read_b64_tr_b16 v[188:189], v247 offset:2048
    ds_read_b64_tr_b16 v[190:191], v247 offset:2560
    s_mov_b32 m0, s68
    v_mfma_f32_32x32x16_bf16 v[16:31], v[68:71], v[176:179], 0
    buffer_load_dwordx4 v222, s[4:7], s42 offen sc1 lds
    buffer_load_dwordx4 v223, s[72:75], s42 offen offset:1024 sc1 lds
    v_permlane32_swap_b32 v242, v236
    v_permlane32_swap_b32 v243, v237
    v_mov_b32 v254, 163648
    v_mfma_f32_32x32x16_bf16 v[32:47], v[64:67], v[180:183], 0
    v_permlane32_swap_b32 v244, v238
    v_permlane32_swap_b32 v245, v239
    v_permlane32_swap_b32 v240, v241
    v_add_f32 v242, v242, v236
    v_mfma_f32_32x32x16_bf16 v[48:63], v[68:71], v[180:183], 0
    v_add_f32 v243, v243, v237
    v_add_f32 v244, v244, v238
    v_add_f32 v245, v245, v239
    v_add_f32 v240, -v240, -v241
    v_sub_u32 v241, v230, v231
    v_cvt_pk_bf16_f32 v242, v242, v243
    v_mov_b32 v255, 1
    v_lshl_add_u32 v233, v252, 1, s53
    s_mov_b64 exec, 1
    ds_add_rtn_u32 v232, v254, v255
    s_mov_b64 exec, -1
    ds_read_b32 v233, v233
    s_waitcnt vmcnt(4) lgkmcnt(2)
    v_mfma_f32_32x32x16_bf16 v[0:15], v[72:75], v[184:187], v[0:15]
    ds_read_b64_tr_b16 v[176:177], v246 offset:4096
    ds_read_b64_tr_b16 v[178:179], v246 offset:4608
    ds_read_b64_tr_b16 v[180:181], v247 offset:4096
    ds_read_b64_tr_b16 v[182:183], v247 offset:4608
    v_cvt_pk_bf16_f32 v244, v244, v245
    v_cvt_pk_bf16_f32 v240, v240, v240
    s_mov_b32 m0, s69
    v_mfma_f32_32x32x16_bf16 v[16:31], v[76:79], v[184:187], v[16:31]
    buffer_load_dwordx4 v224, s[4:7], s42 offen sc1 lds
    buffer_load_dwordx4 v225, s[72:75], s42 offen offset:1024 sc1 lds
    ds_write_b32 v230, v242 offset:768
    ds_write_b32 v230, v244 offset:1024
    ds_write_b16 v241, v240 offset:1280
    s_waitcnt lgkmcnt(7)
    v_readfirstlane_b32 s58, v232
    v_mfma_f32_32x32x16_bf16 v[32:47], v[72:75], v[188:191], v[32:47]
    s_cmp_lt_u32 s58, s22
    s_cbranch_scc0 K2_nul_34
    s_and_b32 s59, s58, 7
    s_lshr_b32 s60, s58, 3
K2_chk_36:
    v_readlane_b32 s61, v233, s59
    s_nop 0
    s_cmp_gt_u32 s61, s60
    s_cbranch_scc0 K2_spin_35
K2_back_37:
    v_mfma_f32_32x32x16_bf16 v[48:63], v[76:79], v[188:191], v[48:63]
    s_setprio 0
    v_readlane_b32 s3, v253, s58
    s_lshl_b32 s44, s34, 7
    s_lshl_b32 s60, s58, 5
    s_and_b32 s48, s3, 0x3ffff
    s_bfe_u32 s33, s3, 0x30012
    s_sub_u32 s60, s60, s48
    v_mul_f32 v234, v0, v96
    v_mul_f32 v236, v8, v128
    v_fmac_f32 v234, v1, v97
    v_fmac_f32 v236, v9, v129
    v_fmac_f32 v234, v2, v98
    v_fmac_f32 v236, v10, v130
    v_fmac_f32 v234, v3, v99
    v_fmac_f32 v236, v11, v131
    v_fmac_f32 v234, v4, v100
    v_fmac_f32 v236, v12, v132
    v_fmac_f32 v234, v5, v101
    v_fmac_f32 v236, v13, v133
    v_fmac_f32 v234, v6, v102
    v_fmac_f32 v236, v14, v134
    v_fmac_f32 v234, v7, v103
    v_fmac_f32 v236, v15, v135
    v_mul_f32 v238, v16, v128
    v_mul_f32 v240, v24, v128
    v_fmac_f32 v238, v17, v129
    v_fmac_f32 v240, v25, v129
    v_fmac_f32 v238, v18, v130
    v_fmac_f32 v240, v26, v130
    v_fmac_f32 v238, v19, v131
    v_fmac_f32 v240, v27, v131
    v_fmac_f32 v238, v20, v132
    v_fmac_f32 v240, v28, v132
    v_fmac_f32 v238, v21, v133
    v_fmac_f32 v240, v29, v133
    v_fmac_f32 v238, v22, v134
    v_fmac_f32 v240, v30, v134
    v_fmac_f32 v238, v23, v135
    v_fmac_f32 v240, v31, v135
    v_mul_f32 v235, v32, v104
    v_mul_f32 v237, v40, v136
    v_fmac_f32 v235, v33, v105
    v_fmac_f32 v237, v41, v137
    v_fmac_f32 v235, v34, v106
    v_fmac_f32 v237, v42, v138
    v_fmac_f32 v235, v35, v107
    v_fmac_f32 v237, v43, v139
    v_fmac_f32 v235, v36, v108
    v_fmac_f32 v237, v44, v140
    v_fmac_f32 v235, v37, v109
    v_fmac_f32 v237, v45, v141
    v_fmac_f32 v235, v38, v110
    v_fmac_f32 v237, v46, v142
    v_fmac_f32 v235, v39, v111
    v_fmac_f32 v237, v47, v143
    v_mul_f32 v239, v48, v136
    v_mul_f32 v241, v56, v136
    v_fmac_f32 v239, v49, v137
    v_fmac_f32 v241, v57, v137
    s_setprio 1
    s_waitcnt vmcnt(4) lgkmcnt(3)
    v_mfma_f32_32x32x16_bf16 v[0:15], v[64:67], v[176:179], 0
    ds_read_b64_tr_b16 v[184:185], v246 offset:6144
    ds_read_b64_tr_b16 v[186:187], v246 offset:6656
    ds_read_b64_tr_b16 v[188:189], v247 offset:6144
    ds_read_b64_tr_b16 v[190:191], v247 offset:6656
    v_fmac_f32 v239, v50, v138
    v_fmac_f32 v241, v58, v138
    s_mov_b32 m0, s70
    v_mfma_f32_32x32x16_bf16 v[16:31], v[68:71], v[176:179], 0
    buffer_load_dwordx4 v222, s[4:7], s43 offen sc1 lds
    buffer_load_dwordx4 v223, s[72:75], s43 offen offset:1024 sc1 lds
    v_fmac_f32 v239, v51, v139
    v_fmac_f32 v241, v59, v139
    v_fmac_f32 v239, v52, v140
    v_fmac_f32 v241, v60, v140
    v_fmac_f32 v239, v53, v141
    v_mfma_f32_32x32x16_bf16 v[32:47], v[64:67], v[180:183], 0
    s_and_b32 s60, s60, 0xff
    s_add_u32 s35, s60, s48
    s_mov_b32 s45, s44
    s_add_u32 s47, s44, 256
    s_add_u32 s49, s48, 32
    s_add_u32 s60, s48, 64
    s_cmp_eq_u32 s33, 3
    s_cselect_b32 s46, s44, s47
    s_cselect_b32 s50, s60, s48
    s_cselect_b32 s51, s48, s49
    s_sub_u32 s60, s33, 2
    s_cmp_lt_u32 s60, 2
    s_cbranch_scc0 K2_rare_38
K2_back_39:
    v_add_u32 v222, s48, v251
    ds_read_b32 v222, v222
    v_fmac_f32 v241, v61, v141
    v_fmac_f32 v239, v54, v142
    v_fmac_f32 v241, v62, v142
    v_fmac_f32 v239, v55, v143
    v_fmac_f32 v241, v63, v143
    v_mfma_f32_32x32x16_bf16 v[48:63], v[68:71], v[180:183], 0
    v_permlane32_swap_b32 v234, v236
    v_permlane32_swap_b32 v235, v237
    v_permlane32_swap_b32 v240, v238
    s_waitcnt vmcnt(4) lgkmcnt(1)
    v_mfma_f32_32x32x16_bf16 v[0:15], v[72:75], v[184:187], v[0:15]
    ds_read_b64_tr_b16 v[176:177], v246 offset:0
    ds_read_b64_tr_b16 v[178:179], v246 offset:512
    ds_read_b64_tr_b16 v[180:181], v247 offset:0
    ds_read_b64_tr_b16 v[182:183], v247 offset:512
    v_permlane32_swap_b32 v241, v239
    s_mov_b32 m0, s71
    v_mfma_f32_32x32x16_bf16 v[16:31], v[76:79], v[184:187], v[16:31]
    buffer_load_dwordx4 v224, s[4:7], s43 offen sc1 lds
    buffer_load_dwordx4 v225, s[72:75], s43 offen offset:1024 sc1 lds
    s_waitcnt lgkmcnt(4)
    v_mad_u32_u16 v223, v222, s39, v248 op_sel:[1,0,0,0]
    v_mad_u32_u16 v222, v222, s39, v248
    v_lshl_add_u32 v230, v252, 1, s31
    v_add_f32 v234, v234, v236
    v_add_f32 v235, v235, v237
    v_add_f32 v240, v240, v238
    v_add_f32 v241, v241, v239
    v_cvt_pk_bf16_f32 v234, v234, v235
    v_cvt_pk_bf16_f32 v240, v240, v241
    ds_write_b32 v230, v234 offset:0
    ds_write_b32 v230, v240 offset:256
    v_mfma_f32_32x32x16_bf16 v[32:47], v[72:75], v[188:191], v[32:47]
    v_add_u32 v224, s49, v251
    ds_read_b32 v224, v224
    v_mul_f32 v234, v0, v144
    v_mul_f32 v236, v8, v112
    v_fmac_f32 v234, v1, v145
    v_fmac_f32 v236, v9, v113
    v_fmac_f32 v234, v2, v146
    v_mfma_f32_32x32x16_bf16 v[48:63], v[76:79], v[188:191], v[48:63]
    s_setprio 0
    v_fmac_f32 v236, v10, v114
    v_fmac_f32 v234, v3, v147
    v_fmac_f32 v236, v11, v115
    v_fmac_f32 v234, v4, v148
    v_fmac_f32 v236, v12, v116
    v_fmac_f32 v234, v5, v149
    v_fmac_f32 v236, v13, v117
    v_fmac_f32 v234, v6, v150
    v_fmac_f32 v236, v14, v118
    v_fmac_f32 v234, v7, v151
    v_fmac_f32 v236, v15, v119
    v_mul_f32 v238, v16, v160
    v_mul_f32 v240, v24, v160
    v_fmac_f32 v238, v17, v161
    v_fmac_f32 v240, v25, v161
    v_fmac_f32 v238, v18, v162
    v_fmac_f32 v240, v26, v162
    v_fmac_f32 v238, v19, v163
    v_fmac_f32 v240, v27, v163
    v_fmac_f32 v238, v20, v164
    v_fmac_f32 v240, v28, v164
    v_fmac_f32 v238, v21, v165
    v_fmac_f32 v240, v29, v165
    v_fmac_f32 v238, v22, v166
    v_fmac_f32 v240, v30, v166
    v_fmac_f32 v238, v23, v167
    v_fmac_f32 v240, v31, v167
    v_mul_f32 v235, v32, v152
    v_mul_f32 v237, v40, v120
    v_fmac_f32 v235, v33, v153
    v_fmac_f32 v237, v41, v121
    v_fmac_f32 v235, v34, v154
    v_fmac_f32 v237, v42, v122
    v_fmac_f32 v235, v35, v155
    v_fmac_f32 v237, v43, v123
    v_fmac_f32 v235, v36, v156
    v_fmac_f32 v237, v44, v124
    v_fmac_f32 v235, v37, v157
    v_fmac_f32 v237, v45, v125
    v_fmac_f32 v235, v38, v158
    v_fmac_f32 v237, v46, v126
    v_fmac_f32 v235, v39, v159
    v_fmac_f32 v237, v47, v127
    v_mul_f32 v239, v48, v168
    v_mul_f32 v241, v56, v168
    v_fmac_f32 v239, v49, v169
    v_fmac_f32 v241, v57, v169
    v_fmac_f32 v239, v50, v170
    v_fmac_f32 v241, v58, v170
    v_fmac_f32 v239, v51, v171
    s_setprio 1
    s_waitcnt vmcnt(4) lgkmcnt(3)
    v_mfma_f32_32x32x16_bf16 v[0:15], v[64:67], v[176:179], 0
    ds_read_b64_tr_b16 v[184:185], v246 offset:2048
    ds_read_b64_tr_b16 v[186:187], v246 offset:2560
    ds_read_b64_tr_b16 v[188:189], v247 offset:2048
    ds_read_b64_tr_b16 v[190:191], v247 offset:2560
    v_fmac_f32 v241, v59, v171
    v_fmac_f32 v239, v52, v172
    s_mov_b32 m0, s68
    v_mfma_f32_32x32x16_bf16 v[16:31], v[68:71], v[176:179], 0
    buffer_load_dwordx4 v222, s[4:7], s44 offen sc1 lds
    buffer_load_dwordx4 v223, s[72:75], s44 offen offset:1024 sc1 lds
    s_waitcnt lgkmcnt(4)
    v_mad_u32_u16 v225, v224, s39, v248 op_sel:[1,0,0,0]
    v_mad_u32_u16 v224, v224, s39, v248
    v_fmac_f32 v241, v60, v172
    v_fmac_f32 v239, v53, v173
    v_mfma_f32_32x32x16_bf16 v[32:47], v[64:67], v[180:183], 0
    v_add_u32 v226, s50, v251
    ds_read_b32 v226, v226
    v_fmac_f32 v241, v61, v173
    v_fmac_f32 v239, v54, v174
    v_fmac_f32 v241, v62, v174
    v_fmac_f32 v239, v55, v175
    v_fmac_f32 v241, v63, v175
    v_mfma_f32_32x32x16_bf16 v[48:63], v[68:71], v[180:183], 0
    s_waitcnt vmcnt(4) lgkmcnt(1)
    v_mfma_f32_32x32x16_bf16 v[0:15], v[72:75], v[184:187], v[0:15]
    ds_read_b64_tr_b16 v[176:177], v246 offset:4096
    ds_read_b64_tr_b16 v[178:179], v246 offset:4608
    ds_read_b64_tr_b16 v[180:181], v247 offset:4096
    ds_read_b64_tr_b16 v[182:183], v247 offset:4608
    s_mov_b32 m0, s69
    v_mfma_f32_32x32x16_bf16 v[16:31], v[76:79], v[184:187], v[16:31]
    buffer_load_dwordx4 v224, s[4:7], s45 offen sc1 lds
    buffer_load_dwordx4 v225, s[72:75], s45 offen offset:1024 sc1 lds
    s_waitcnt lgkmcnt(4)
    v_mad_u32_u16 v227, v226, s39, v248 op_sel:[1,0,0,0]
    v_mad_u32_u16 v226, v226, s39, v248
    v_mfma_f32_32x32x16_bf16 v[32:47], v[72:75], v[188:191], v[32:47]
    v_add_u32 v228, s51, v251
    ds_read_b32 v228, v228
    v_mul_f32 v242, v0, v144
    v_fma_f32 v238, v8, v160, -v238
    v_fmac_f32 v242, v1, v145
    v_fmac_f32 v238, v9, v161
    v_fmac_f32 v242, v2, v146
    v_mfma_f32_32x32x16_bf16 v[48:63], v[76:79], v[188:191], v[48:63]
    s_setprio 0
    v_fmac_f32 v238, v10, v162
    v_fmac_f32 v242, v3, v147
    v_fmac_f32 v238, v11, v163
    v_fmac_f32 v242, v4, v148
    v_fmac_f32 v238, v12, v164
    v_fmac_f32 v242, v5, v149
    v_fmac_f32 v238, v13, v165
    v_fmac_f32 v242, v6, v150
    v_fmac_f32 v238, v14, v166
    v_fmac_f32 v242, v7, v151
    v_fmac_f32 v238, v15, v167
    v_fmac_f32 v236, v16, v112
    v_mul_f32 v244, v24, v160
    v_fmac_f32 v236, v17, v113
    v_fmac_f32 v244, v25, v161
    v_fmac_f32 v236, v18, v114
    v_fmac_f32 v244, v26, v162
    v_fmac_f32 v236, v19, v115
    v_fmac_f32 v244, v27, v163
    v_fmac_f32 v236, v20, v116
    v_fmac_f32 v244, v28, v164
    v_fmac_f32 v236, v21, v117
    v_fmac_f32 v244, v29, v165
    v_fmac_f32 v236, v22, v118
    v_fmac_f32 v244, v30, v166
    v_fmac_f32 v236, v23, v119
    v_fmac_f32 v244, v31, v167
    v_mul_f32 v243, v32, v152
    v_fma_f32 v239, v40, v168, -v239
    v_fmac_f32 v243, v33, v153
    v_fmac_f32 v239, v41, v169
    v_fmac_f32 v243, v34, v154
    v_fmac_f32 v239, v42, v170
    v_fmac_f32 v243, v35, v155
    v_fmac_f32 v239, v43, v171
    v_fmac_f32 v243, v36, v156
    v_fmac_f32 v239, v44, v172
    v_fmac_f32 v243, v37, v157
    v_fmac_f32 v239, v45, v173
    v_fmac_f32 v243, v38, v158
    v_fmac_f32 v239, v46, v174
    v_fmac_f32 v243, v39, v159
    v_fmac_f32 v239, v47, v175
    v_fmac_f32 v237, v48, v120
    v_mul_f32 v245, v56, v168
    v_fmac_f32 v237, v49, v121
    v_fmac_f32 v245, v57, v169
    v_fmac_f32 v237, v50, v122
    s_setprio 1
    s_waitcnt vmcnt(4) lgkmcnt(1)
    v_mfma_f32_32x32x16_bf16 v[0:15], v[64:67], v[176:179], 0
    ds_read_b64_tr_b16 v[184:185], v246 offset:6144
    ds_read_b64_tr_b16 v[186:187], v246 offset:6656
    ds_read_b64_tr_b16 v[188:189], v247 offset:6144
    ds_read_b64_tr_b16 v[190:191], v247 offset:6656
    v_fmac_f32 v245, v58, v170
    v_fmac_f32 v237, v51, v123
    s_mov_b32 m0, s70
    v_mfma_f32_32x32x16_bf16 v[16:31], v[68:71], v[176:179], 0
    buffer_load_dwordx4 v226, s[4:7], s46 offen sc1 lds
    buffer_load_dwordx4 v227, s[72:75], s46 offen offset:1024 sc1 lds
    s_waitcnt lgkmcnt(4)
    v_mad_u32_u16 v229, v228, s39, v248 op_sel:[1,0,0,0]
    v_mad_u32_u16 v228, v228, s39, v248
    v_fmac_f32 v245, v59, v171
    v_fmac_f32 v237, v52, v124
    v_mfma_f32_32x32x16_bf16 v[32:47], v[64:67], v[180:183], 0
    v_fmac_f32 v245, v60, v172
    v_fmac_f32 v237, v53, v125
    v_fmac_f32 v245, v61, v173
    v_fmac_f32 v237, v54, v126
    v_fmac_f32 v245, v62, v174
    v_fmac_f32 v237, v55, v127
    v_fmac_f32 v245, v63, v175
    v_mfma_f32_32x32x16_bf16 v[48:63], v[68:71], v[180:183], 0
    v_permlane32_swap_b32 v242, v234
    v_permlane32_swap_b32 v243, v235
    v_add_f32 v242, v242, v234
    v_add_f32 v243, v243, v235
    s_waitcnt vmcnt(4) lgkmcnt(0)
    v_mfma_f32_32x32x16_bf16 v[0:15], v[72:75], v[184:187], v[0:15]
    ds_read_b64_tr_b16 v[176:177], v246 offset:0
    ds_read_b64_tr_b16 v[178:179], v246 offset:512
    ds_read_b64_tr_b16 v[180:181], v247 offset:0
    ds_read_b64_tr_b16 v[182:183], v247 offset:512
    v_cvt_pk_bf16_f32 v242, v242, v243
    ds_write_b32 v230, v242 offset:512
    s_mov_b32 m0, s71
    v_mfma_f32_32x32x16_bf16 v[16:31], v[76:79], v[184:187], v[16:31]
    buffer_load_dwordx4 v228, s[4:7], s47 offen sc1 lds
    buffer_load_dwordx4 v229, s[72:75], s47 offen offset:1024 sc1 lds
    s_sub_u32 s26, s48, s29
    s_mov_b32 s29, s48
    s_mov_b32 s30, s3
    s_cmp_lg_u32 s36, 0
    s_cselect_b32 s56, s33, 0
    v_mfma_f32_32x32x16_bf16 v[32:47], v[72:75], v[188:191], v[32:47]
    s_mov_b32 s32, s31
    s_mov_b32 s31, s35
    v_mul_f32 v242, v0, v144
    v_fma_f32 v240, v8, v160, -v240
    v_fmac_f32 v242, v1, v145
    v_fmac_f32 v240, v9, v161
    v_fmac_f32 v242, v2, v146
    v_mfma_f32_32x32x16_bf16 v[48:63], v[76:79], v[188:191], v[48:63]
    s_setprio 0
    v_fmac_f32 v240, v10, v162
    v_fmac_f32 v242, v3, v147
    v_fmac_f32 v240, v11, v163
    v_fmac_f32 v242, v4, v148
    v_fmac_f32 v240, v12, v164
    v_fmac_f32 v242, v5, v149
    v_fmac_f32 v240, v13, v165
    v_fmac_f32 v242, v6, v150
    v_fmac_f32 v240, v14, v166
    v_fmac_f32 v242, v7, v151
    v_fmac_f32 v240, v15, v167
    v_add_u32 v249, s26, v249
    v_add_u32 v250, s26, v250
    v_fma_f32 v244, v16, v160, -v244
    v_fmac_f32 v236, v24, v112
    v_fmac_f32 v244, v17, v161
    v_fmac_f32 v236, v25, v113
    v_fmac_f32 v244, v18, v162
    v_fmac_f32 v236, v26, v114
    v_fmac_f32 v244, v19, v163
    v_fmac_f32 v236, v27, v115
    v_fmac_f32 v244, v20, v164
    v_fmac_f32 v236, v28, v116
    v_fmac_f32 v244, v21, v165
    v_fmac_f32 v236, v29, v117
    v_fmac_f32 v244, v22, v166
    v_fmac_f32 v236, v30, v118
    v_fmac_f32 v244, v23, v167
    v_fmac_f32 v236, v31, v119
    ds_read_b64_tr_b16 v[0:1], v249 offset:0
    ds_read_b64_tr_b16 v[2:3], v249 offset:128
    ds_read_b128 v[4:7], v250 offset:0
    ds_read_b128 v[8:11], v250 offset:16
    ds_read_b128 v[12:15], v250 offset:384
    ds_read_b128 v[16:19], v250 offset:400
    v_mul_f32 v243, v32, v152
    v_fma_f32 v241, v40, v168, -v241
    v_fmac_f32 v243, v33, v153
    v_fmac_f32 v241, v41, v169
    v_fmac_f32 v243, v34, v154
    v_fmac_f32 v241, v42, v170
    v_fmac_f32 v243, v35, v155
    v_fmac_f32 v241, v43, v171
    v_fmac_f32 v243, v36, v156
    v_fmac_f32 v241, v44, v172
    v_fmac_f32 v243, v37, v157
    v_fmac_f32 v241, v45, v173
    v_fmac_f32 v243, v38, v158
    v_fmac_f32 v241, v46, v174
    v_fmac_f32 v243, v39, v159
    v_fmac_f32 v241, v47, v175
    ds_read_b64_tr_b16 v[20:21], v249 offset:512
    ds_read_b64_tr_b16 v[22:23], v249 offset:640
    ds_read_b128 v[24:27], v250 offset:64
    ds_read_b128 v[28:31], v250 offset:80
    ds_read_b128 v[32:35], v250 offset:448
    ds_read_b128 v[36:39], v250 offset:464
    v_fma_f32 v245, v48, v168, -v245
    v_fmac_f32 v237, v56, v120
    v_fmac_f32 v245, v49, v169
    v_fmac_f32 v237, v57, v121
    v_fmac_f32 v245, v50, v170
    v_fmac_f32 v237, v58, v122
    v_fmac_f32 v245, v51, v171
    v_fmac_f32 v237, v59, v123
    v_fmac_f32 v245, v52, v172
    v_fmac_f32 v237, v60, v124
    v_fmac_f32 v245, v53, v173
    v_fmac_f32 v237, v61, v125
    v_fmac_f32 v245, v54, v174
    v_fmac_f32 v237, v62, v126
    v_fmac_f32 v245, v55, v175
    v_fmac_f32 v237, v63, v127
    s_cmp_eq_u32 s56, 2
    s_cbranch_scc1 K2_U21
    s_cmp_eq_u32 s56, 3
    s_cbranch_scc1 K2_U31
    s_branch K2_DSP1
K2_PAD_U31:
    s_branch K2_HOP
K2_U31:
    s_setprio 1
    s_waitcnt lgkmcnt(6)
    v_lshlrev_b32 v40, 16, v0
    v_and_b32 v41, 0xffff0000, v0
    v_lshlrev_b32 v42, 16, v1
    v_and_b32 v43, 0xffff0000, v1
    v_lshlrev_b32 v44, 16, v2
    v_and_b32 v45, 0xffff0000, v2
    v_lshlrev_b32 v46, 16, v3
    v_and_b32 v47, 0xffff0000, v3
    v_mul_f32 v4, v40, v4
    v_mul_f32 v5, v41, v5
    v_mul_f32 v6, v42, v6
    v_mul_f32 v7, v43, v7
    v_mul_f32 v8, v44, v8
    v_mul_f32 v9, v45, v9
    v_mul_f32 v10, v46, v10
    v_mul_f32 v11, v47, v11
    v_cvt_pk_bf16_f32 v64, v4, v5
    v_cvt_pk_bf16_f32 v65, v6, v7
    v_cvt_pk_bf16_f32 v66, v8, v9
    v_cvt_pk_bf16_f32 v67, v10, v11
    v_mul_f32 v12, v40, v12
    v_mul_f32 v13, v41, v13
    v_mul_f32 v14, v42, v14
    v_mul_f32 v15, v43, v15
    v_mul_f32 v16, v44, v16
    v_mul_f32 v17, v45, v17
    v_mul_f32 v18, v46, v18
    v_mul_f32 v19, v47, v19
    v_cvt_pk_bf16_f32 v68, v12, v13
    v_cvt_pk_bf16_f32 v69, v14, v15
    v_cvt_pk_bf16_f32 v70, v16, v17
    v_cvt_pk_bf16_f32 v71, v18, v19
    ds_read_b64_tr_b16 v[0:1], v249 offset:1024
    ds_read_b64_tr_b16 v[2:3], v249 offset:1152
    ds_read_b128 v[4:7], v250 offset:128
    ds_read_b128 v[8:11], v250 offset:144
    ds_read_b128 v[12:15], v250 offset:512
    ds_read_b128 v[16:19], v250 offset:528
    s_waitcnt lgkmcnt(6)
    v_lshlrev_b32 v48, 16, v20
    v_and_b32 v49, 0xffff0000, v20
    v_lshlrev_b32 v50, 16, v21
    v_and_b32 v51, 0xffff0000, v21
    v_lshlrev_b32 v52, 16, v22
    v_and_b32 v53, 0xffff0000, v22
    v_lshlrev_b32 v54, 16, v23
    v_and_b32 v55, 0xffff0000, v23
    v_mul_f32 v24, v48, v24
    v_mul_f32 v25, v49, v25
    v_mul_f32 v26, v50, v26
    v_mul_f32 v27, v51, v27
    v_mul_f32 v28, v52, v28
    v_mul_f32 v29, v53, v29
    v_mul_f32 v30, v54, v30
    v_mul_f32 v31, v55, v31
    v_cvt_pk_bf16_f32 v72, v24, v25
    v_cvt_pk_bf16_f32 v73, v26, v27
    v_cvt_pk_bf16_f32 v74, v28, v29
    v_cvt_pk_bf16_f32 v75, v30, v31
    v_mul_f32 v32, v48, v32
    v_mul_f32 v33, v49, v33
    v_mul_f32 v34, v50, v34
    v_mul_f32 v35, v51, v35
    v_mul_f32 v36, v52, v36
    v_mul_f32 v37, v53, v37
    v_mul_f32 v38, v54, v38
    v_mul_f32 v39, v55, v39
    v_cvt_pk_bf16_f32 v76, v32, v33
    v_cvt_pk_bf16_f32 v77, v34, v35
    v_cvt_pk_bf16_f32 v78, v36, v37
    v_cvt_pk_bf16_f32 v79, v38, v39
    s_waitcnt lgkmcnt(4)
    v_lshlrev_b32 v40, 16, v0
    v_and_b32 v41, 0xffff0000, v0
    v_lshlrev_b32 v42, 16, v1
    v_and_b32 v43, 0xffff0000, v1
    v_lshlrev_b32 v44, 16, v2
    v_and_b32 v45, 0xffff0000, v2
    v_lshlrev_b32 v46, 16, v3
    v_and_b32 v47, 0xffff0000, v3
    s_waitcnt lgkmcnt(2)
    v_mul_f32 v4, v40, v4
    v_mul_f32 v5, v41, v5
    v_mul_f32 v6, v42, v6
    v_mul_f32 v7, v43, v7
    v_mul_f32 v8, v44, v8
    v_mul_f32 v9, v45, v9
    v_mul_f32 v10, v46, v10
    v_mul_f32 v11, v47, v11
    v_cvt_pk_bf16_f32 v80, v4, v5
    v_cvt_pk_bf16_f32 v81, v6, v7
    v_cvt_pk_bf16_f32 v82, v8, v9
    v_cvt_pk_bf16_f32 v83, v10, v11
    s_waitcnt lgkmcnt(0)
    v_mul_f32 v12, v40, v12
    v_mul_f32 v13, v41, v13
    v_mul_f32 v14, v42, v14
    v_mul_f32 v15, v43, v15
    v_mul_f32 v16, v44, v16
    v_mul_f32 v17, v45, v17
    v_mul_f32 v18, v46, v18
    v_mul_f32 v19, v47, v19
    v_cvt_pk_bf16_f32 v84, v12, v13
    v_cvt_pk_bf16_f32 v85, v14, v15
    v_cvt_pk_bf16_f32 v86, v16, v17
    v_cvt_pk_bf16_f32 v87, v18, v19
    s_waitcnt vmcnt(4)
    v_mfma_f32_32x32x16_bf16 v[0:15], v[64:67], v[176:179], 0
    ds_read_b64_tr_b16 v[184:185], v246 offset:2048
    ds_read_b64_tr_b16 v[186:187], v246 offset:2560
    ds_read_b64_tr_b16 v[188:189], v247 offset:2048
    ds_read_b64_tr_b16 v[190:191], v247 offset:2560
    s_mov_b32 m0, s68
    v_mfma_f32_32x32x16_bf16 v[16:31], v[68:71], v[176:179], 0
    buffer_load_dwordx4 v224, s[4:7], s41 offen sc1 lds
    buffer_load_dwordx4 v225, s[72:75], s41 offen offset:1024 sc1 lds
    v_permlane32_swap_b32 v242, v236
    v_permlane32_swap_b32 v243, v237
    v_mov_b32 v254, 163648
    v_mfma_f32_32x32x16_bf16 v[32:47], v[64:67], v[180:183], 0
    v_permlane32_swap_b32 v244, v238
    v_permlane32_swap_b32 v245, v239
    v_permlane32_swap_b32 v240, v241
    v_add_f32 v242, v242, v236
    v_mfma_f32_32x32x16_bf16 v[48:63], v[68:71], v[180:183], 0
    v_add_f32 v243, v243, v237
    v_add_f32 v244, v244, v238
    v_add_f32 v245, v245, v239
    v_add_f32 v240, -v240, -v241
    v_sub_u32 v241, v230, v231
    v_cvt_pk_bf16_f32 v242, v242, v243
    v_mov_b32 v255, 1
    v_lshl_add_u32 v233, v252, 1, s53
    s_mov_b64 exec, 1
    ds_add_rtn_u32 v232, v254, v255
    s_mov_b64 exec, -1
    ds_read_b32 v233, v233
    s_waitcnt vmcnt(4) lgkmcnt(2)
    v_mfma_f32_32x32x16_bf16 v[0:15], v[72:75], v[184:187], v[0:15]
    ds_read_b64_tr_b16 v[176:177], v246 offset:4096
    ds_read_b64_tr_b16 v[178:179], v246 offset:4608
    ds_read_b64_tr_b16 v[180:181], v247 offset:4096
    ds_read_b64_tr_b16 v[182:183], v247 offset:4608
    v_cvt_pk_bf16_f32 v244, v244, v245
    v_cvt_pk_bf16_f32 v240, v240, v240
    s_mov_b32 m0, s69
    v_mfma_f32_32x32x16_bf16 v[16:31], v[76:79], v[184:187], v[16:31]
    buffer_load_dwordx4 v226, s[4:7], s41 offen sc1 lds
    buffer_load_dwordx4 v227, s[72:75], s41 offen offset:1024 sc1 lds
    ds_write_b32 v230, v242 offset:768
    ds_write_b32 v230, v244 offset:1024
    ds_write_b16 v241, v240 offset:1280
    s_waitcnt lgkmcnt(7)
    v_readfirstlane_b32 s58, v232
    v_mfma_f32_32x32x16_bf16 v[32:47], v[72:75], v[188:191], v[32:47]
    s_cmp_lt_u32 s58, s22
    s_cbranch_scc0 K2_nul_41
    s_and_b32 s59, s58, 7
    s_lshr_b32 s60, s58, 3
K2_chk_43:
    v_readlane_b32 s61, v233, s59
    s_nop 0
    s_cmp_gt_u32 s61, s60
    s_cbranch_scc0 K2_spin_42
K2_back_44:
    v_mfma_f32_32x32x16_bf16 v[48:63], v[76:79], v[188:191], v[48:63]
    v_readlane_b32 s3, v253, s58
    s_lshl_b32 s44, s34, 7
    s_lshl_b32 s60, s58, 5
    s_and_b32 s48, s3, 0x3ffff
    s_bfe_u32 s33, s3, 0x30012
    s_sub_u32 s60, s60, s48
    s_waitcnt vmcnt(4) lgkmcnt(3)
    v_mfma_f32_32x32x16_bf16 v[0:15], v[80:83], v[176:179], v[0:15]
    ds_read_b64_tr_b16 v[184:185], v246 offset:6144
    ds_read_b64_tr_b16 v[186:187], v246 offset:6656
    ds_read_b64_tr_b16 v[188:189], v247 offset:6144
    ds_read_b64_tr_b16 v[190:191], v247 offset:6656
    s_and_b32 s60, s60, 0xff
    s_add_u32 s35, s60, s48
    s_mov_b32 m0, s70
    v_mfma_f32_32x32x16_bf16 v[16:31], v[84:87], v[176:179], v[16:31]
    buffer_load_dwordx4 v222, s[4:7], s42 offen sc1 lds
    buffer_load_dwordx4 v223, s[72:75], s42 offen offset:1024 sc1 lds
    s_mov_b32 s45, s44
    s_add_u32 s47, s44, 256
    s_add_u32 s49, s48, 32
    s_add_u32 s60, s48, 64
    v_mfma_f32_32x32x16_bf16 v[32:47], v[80:83], v[180:183], v[32:47]
    s_cmp_eq_u32 s33, 3
    s_cselect_b32 s46, s44, s47
    s_cselect_b32 s50, s60, s48
    s_cselect_b32 s51, s48, s49
    s_sub_u32 s60, s33, 2
    s_cmp_lt_u32 s60, 2
    s_cbranch_scc0 K2_rare_45
K2_back_46:
    v_mfma_f32_32x32x16_bf16 v[48:63], v[84:87], v[180:183], v[48:63]
    s_setprio 0
    v_mul_f32 v234, v0, v96
    v_mul_f32 v236, v8, v128
    v_fmac_f32 v234, v1, v97
    v_fmac_f32 v236, v9, v129
    v_fmac_f32 v234, v2, v98
    v_fmac_f32 v236, v10, v130
    v_fmac_f32 v234, v3, v99
    v_fmac_f32 v236, v11, v131
    v_fmac_f32 v234, v4, v100
    v_fmac_f32 v236, v12, v132
    v_fmac_f32 v234, v5, v101
    v_fmac_f32 v236, v13, v133
    v_fmac_f32 v234, v6, v102
    v_fmac_f32 v236, v14, v134
    v_fmac_f32 v234, v7, v103
    v_fmac_f32 v236, v15, v135
    v_mul_f32 v238, v16, v128
    v_mul_f32 v240, v24, v128
    v_fmac_f32 v238, v17, v129
    v_fmac_f32 v240, v25, v129
    v_fmac_f32 v238, v18, v130
    v_fmac_f32 v240, v26, v130
    v_fmac_f32 v238, v19, v131
    v_fmac_f32 v240, v27, v131
    v_fmac_f32 v238, v20, v132
    v_fmac_f32 v240, v28, v132
    v_fmac_f32 v238, v21, v133
    v_fmac_f32 v240, v29, v133
    v_fmac_f32 v238, v22, v134
    v_fmac_f32 v240, v30, v134
    v_fmac_f32 v238, v23, v135
    v_fmac_f32 v240, v31, v135
    v_mul_f32 v235, v32, v104
    v_mul_f32 v237, v40, v136
    v_fmac_f32 v235, v33, v105
    v_fmac_f32 v237, v41, v137
    v_fmac_f32 v235, v34, v106
    v_fmac_f32 v237, v42, v138
    v_fmac_f32 v235, v35, v107
    v_fmac_f32 v237, v43, v139
    v_fmac_f32 v235, v36, v108
    v_fmac_f32 v237, v44, v140
    v_fmac_f32 v235, v37, v109
    v_fmac_f32 v237, v45, v141
    v_fmac_f32 v235, v38, v110
    v_fmac_f32 v237, v46, v142
    v_fmac_f32 v235, v39, v111
    v_fmac_f32 v237, v47, v143
    v_mul_f32 v239, v48, v136
    v_mul_f32 v241, v56, v136
    s_setprio 1
    s_waitcnt vmcnt(4) lgkmcnt(0)
    v_mfma_f32_32x32x16_bf16 v[0:15], v[64:67], v[184:187], 0
    ds_read_b64_tr_b16 v[176:177], v246 offset:0
    ds_read_b64_tr_b16 v[178:179], v246 offset:512
    ds_read_b64_tr_b16 v[180:181], v247 offset:0
    ds_read_b64_tr_b16 v[182:183], v247 offset:512
    v_fmac_f32 v239, v49, v137
    v_fmac_f32 v241, v57, v137
    s_mov_b32 m0, s71
    v_mfma_f32_32x32x16_bf16 v[16:31], v[68:71], v[184:187], 0
    buffer_load_dwordx4 v224, s[4:7], s42 offen sc1 lds
    buffer_load_dwordx4 v225, s[72:75], s42 offen offset:1024 sc1 lds
    v_fmac_f32 v239, v50, v138
    v_fmac_f32 v241, v58, v138
    v_fmac_f32 v239, v51, v139
    v_fmac_f32 v241, v59, v139
    v_fmac_f32 v239, v52, v140
    v_mfma_f32_32x32x16_bf16 v[32:47], v[64:67], v[188:191], 0
    v_fmac_f32 v241, v60, v140
    v_fmac_f32 v239, v53, v141
    v_fmac_f32 v241, v61, v141
    v_fmac_f32 v239, v54, v142
    v_fmac_f32 v241, v62, v142
    v_fmac_f32 v239, v55, v143
    v_fmac_f32 v241, v63, v143
    v_mfma_f32_32x32x16_bf16 v[48:63], v[68:71], v[188:191], 0
    v_permlane32_swap_b32 v234, v236
    v_permlane32_swap_b32 v235, v237
    v_permlane32_swap_b32 v240, v238
    s_waitcnt vmcnt(4) lgkmcnt(0)
    v_mfma_f32_32x32x16_bf16 v[0:15], v[72:75], v[176:179], v[0:15]
    ds_read_b64_tr_b16 v[184:185], v246 offset:2048
    ds_read_b64_tr_b16 v[186:187], v246 offset:2560
    ds_read_b64_tr_b16 v[188:189], v247 offset:2048
    ds_read_b64_tr_b16 v[190:191], v247 offset:2560
    v_permlane32_swap_b32 v241, v239
    s_mov_b32 m0, s68
    v_mfma_f32_32x32x16_bf16 v[16:31], v[76:79], v[176:179], v[16:31]
    buffer_load_dwordx4 v226, s[4:7], s42 offen sc1 lds
    buffer_load_dwordx4 v227, s[72:75], s42 offen offset:1024 sc1 lds
    v_lshl_add_u32 v230, v252, 1, s31
    v_add_f32 v234, v234, v236
    v_add_f32 v235, v235, v237
    v_add_f32 v240, v240, v238
    v_add_f32 v241, v241, v239
    v_mfma_f32_32x32x16_bf16 v[32:47], v[72:75], v[180:183], v[32:47]
    v_cvt_pk_bf16_f32 v234, v234, v235
    v_cvt_pk_bf16_f32 v240, v240, v241
    ds_write_b32 v230, v234 offset:0
    ds_write_b32 v230, v240 offset:256
    v_mfma_f32_32x32x16_bf16 v[48:63], v[76:79], v[180:183], v[48:63]
    s_waitcnt vmcnt(4) lgkmcnt(2)
    v_mfma_f32_32x32x16_bf16 v[0:15], v[80:83], v[184:187], v[0:15]
    ds_read_b64_tr_b16 v[176:177], v246 offset:4096
    ds_read_b64_tr_b16 v[178:179], v246 offset:4608
    ds_read_b64_tr_b16 v[180:181], v247 offset:4096
    ds_read_b64_tr_b16 v[182:183], v247 offset:4608
    s_mov_b32 m0, s69
    v_mfma_f32_32x32x16_bf16 v[16:31], v[84:87], v[184:187], v[16:31]
    buffer_load_dwordx4 v222, s[4:7], s43 offen sc1 lds
    buffer_load_dwordx4 v223, s[72:75], s43 offen offset:1024 sc1 lds
    v_mfma_f32_32x32x16_bf16 v[32:47], v[80:83], v[188:191], v[32:47]
    s_nop 2
    v_mul_f32 v234, v0, v144
    v_mul_f32 v236, v8, v112
    v_fmac_f32 v234, v1, v145
    v_fmac_f32 v236, v9, v113
    v_fmac_f32 v234, v2, v146
    v_fmac_f32 v236, v10, v114
    v_fmac_f32 v234, v3, v147
    v_mfma_f32_32x32x16_bf16 v[48:63], v[84:87], v[188:191], v[48:63]
    s_setprio 0
    v_fmac_f32 v236, v11, v115
    v_fmac_f32 v234, v4, v148
    v_fmac_f32 v236, v12, v116
    v_fmac_f32 v234, v5, v149
    v_fmac_f32 v236, v13, v117
    v_fmac_f32 v234, v6, v150
    v_fmac_f32 v236, v14, v118
    v_fmac_f32 v234, v7, v151
    v_fmac_f32 v236, v15, v119
    v_mul_f32 v238, v16, v160
    v_mul_f32 v240, v24, v160
    v_fmac_f32 v238, v17, v161
    v_fmac_f32 v240, v25, v161
    v_fmac_f32 v238, v18, v162
    v_fmac_f32 v240, v26, v162
    v_fmac_f32 v238, v19, v163
    v_fmac_f32 v240, v27, v163
    v_fmac_f32 v238, v20, v164
    v_fmac_f32 v240, v28, v164
    v_fmac_f32 v238, v21, v165
    v_fmac_f32 v240, v29, v165
    v_fmac_f32 v238, v22, v166
    v_fmac_f32 v240, v30, v166
    v_fmac_f32 v238, v23, v167
    v_fmac_f32 v240, v31, v167
    v_mul_f32 v235, v32, v152
    v_mul_f32 v237, v40, v120
    v_fmac_f32 v235, v33, v153
    v_fmac_f32 v237, v41, v121
    v_fmac_f32 v235, v34, v154
    v_fmac_f32 v237, v42, v122
    v_fmac_f32 v235, v35, v155
    v_fmac_f32 v237, v43, v123
    v_fmac_f32 v235, v36, v156
    v_fmac_f32 v237, v44, v124
    v_fmac_f32 v235, v37, v157
    v_fmac_f32 v237, v45, v125
    v_fmac_f32 v235, v38, v158
    v_fmac_f32 v237, v46, v126
    v_fmac_f32 v235, v39, v159
    v_fmac_f32 v237, v47, v127
    v_mul_f32 v239, v48, v168
    v_mul_f32 v241, v56, v168
    v_fmac_f32 v239, v49, v169
    v_fmac_f32 v241, v57, v169
    s_setprio 1
    s_waitcnt vmcnt(4) lgkmcnt(0)
    v_mfma_f32_32x32x16_bf16 v[0:15], v[64:67], v[176:179], 0
    ds_read_b64_tr_b16 v[184:185], v246 offset:6144
    ds_read_b64_tr_b16 v[186:187], v246 offset:6656
    ds_read_b64_tr_b16 v[188:189], v247 offset:6144
    ds_read_b64_tr_b16 v[190:191], v247 offset:6656
    v_fmac_f32 v239, v50, v170
    v_fmac_f32 v241, v58, v170
    s_mov_b32 m0, s70
    v_mfma_f32_32x32x16_bf16 v[16:31], v[68:71], v[176:179], 0
    buffer_load_dwordx4 v224, s[4:7], s43 offen sc1 lds
    buffer_load_dwordx4 v225, s[72:75], s43 offen offset:1024 sc1 lds
    v_fmac_f32 v239, v51, v171
    v_fmac_f32 v241, v59, v171
    v_fmac_f32 v239, v52, v172
    v_fmac_f32 v241, v60, v172
    v_fmac_f32 v239, v53, v173
    v_mfma_f32_32x32x16_bf16 v[32:47], v[64:67], v[180:183], 0
    v_add_u32 v222, s48, v251
    ds_read_b32 v222, v222
    v_fmac_f32 v241, v61, v173
    v_fmac_f32 v239, v54, v174
    v_fmac_f32 v241, v62, v174
    v_fmac_f32 v239, v55, v175
    v_fmac_f32 v241, v63, v175
    v_mfma_f32_32x32x16_bf16 v[48:63], v[68:71], v[180:183], 0
    s_waitcnt vmcnt(4) lgkmcnt(1)
    v_mfma_f32_32x32x16_bf16 v[0:15], v[72:75], v[184:187], v[0:15]
    ds_read_b64_tr_b16 v[176:177], v246 offset:0
    ds_read_b64_tr_b16 v[178:179], v246 offset:512
    ds_read_b64_tr_b16 v[180:181], v247 offset:0
    ds_read_b64_tr_b16 v[182:183], v247 offset:512
    s_mov_b32 m0, s71
    v_mfma_f32_32x32x16_bf16 v[16:31], v[76:79], v[184:187], v[16:31]
    buffer_load_dwordx4 v226, s[4:7], s43 offen sc1 lds
    buffer_load_dwordx4 v227, s[72:75], s43 offen offset:1024 sc1 lds
    s_waitcnt lgkmcnt(4)
    v_mad_u32_u16 v223, v222, s39, v248 op_sel:[1,0,0,0]
    v_mad_u32_u16 v222, v222, s39, v248
    v_mfma_f32_32x32x16_bf16 v[32:47], v[72:75], v[188:191], v[32:47]
    v_add_u32 v224, s49, v251
    ds_read_b32 v224, v224
    v_mfma_f32_32x32x16_bf16 v[48:63], v[76:79], v[188:191], v[48:63]
    s_waitcnt vmcnt(4) lgkmcnt(1)
    v_mfma_f32_32x32x16_bf16 v[0:15], v[80:83], v[176:179], v[0:15]
    ds_read_b64_tr_b16 v[184:185], v246 offset:2048
    ds_read_b64_tr_b16 v[186:187], v246 offset:2560
    ds_read_b64_tr_b16 v[188:189], v247 offset:2048
    ds_read_b64_tr_b16 v[190:191], v247 offset:2560
    s_mov_b32 m0, s68
    v_mfma_f32_32x32x16_bf16 v[16:31], v[84:87], v[176:179], v[16:31]
    buffer_load_dwordx4 v222, s[4:7], s44 offen sc1 lds
    buffer_load_dwordx4 v223, s[72:75], s44 offen offset:1024 sc1 lds
    s_waitcnt lgkmcnt(4)
    v_mad_u32_u16 v225, v224, s39, v248 op_sel:[1,0,0,0]
    v_mad_u32_u16 v224, v224, s39, v248
    v_mfma_f32_32x32x16_bf16 v[32:47], v[80:83], v[180:183], v[32:47]
    v_add_u32 v226, s50, v251
    ds_read_b32 v226, v226
    v_mul_f32 v242, v0, v144
    v_fma_f32 v238, v8, v160, -v238
    v_fmac_f32 v242, v1, v145
    v_fmac_f32 v238, v9, v161
    v_fmac_f32 v242, v2, v146
    v_mfma_f32_32x32x16_bf16 v[48:63], v[84:87], v[180:183], v[48:63]
    s_setprio 0
    v_fmac_f32 v238, v10, v162
    v_fmac_f32 v242, v3, v147
    v_fmac_f32 v238, v11, v163
    v_fmac_f32 v242, v4, v148
    v_fmac_f32 v238, v12, v164
    v_fmac_f32 v242, v5, v149
    v_fmac_f32 v238, v13, v165
    v_fmac_f32 v242, v6, v150
    v_fmac_f32 v238, v14, v166
    v_fmac_f32 v242, v7, v151
    v_fmac_f32 v238, v15, v167
    v_fmac_f32 v236, v16, v112
    v_mul_f32 v244, v24, v160
    v_fmac_f32 v236, v17, v113
    v_fmac_f32 v244, v25, v161
    v_fmac_f32 v236, v18, v114
    v_fmac_f32 v244, v26, v162
    v_fmac_f32 v236, v19, v115
    v_fmac_f32 v244, v27, v163
    v_fmac_f32 v236, v20, v116
    v_fmac_f32 v244, v28, v164
    v_fmac_f32 v236, v21, v117
    v_fmac_f32 v244, v29, v165
    v_fmac_f32 v236, v22, v118
    v_fmac_f32 v244, v30, v166
    v_fmac_f32 v236, v23, v119
    v_fmac_f32 v244, v31, v167
    v_mul_f32 v243, v32, v152
    v_fma_f32 v239, v40, v168, -v239
    v_fmac_f32 v243, v33, v153
    v_fmac_f32 v239, v41, v169
    v_fmac_f32 v243, v34, v154
    v_fmac_f32 v239, v42, v170
    v_fmac_f32 v243, v35, v155
    v_fmac_f32 v239, v43, v171
    v_fmac_f32 v243, v36, v156
    v_fmac_f32 v239, v44, v172
    v_fmac_f32 v243, v37, v157
    v_fmac_f32 v239, v45, v173
    v_fmac_f32 v243, v38, v158
    v_fmac_f32 v239, v46, v174
    v_fmac_f32 v243, v39, v159
    v_fmac_f32 v239, v47, v175
    v_fmac_f32 v237, v48, v120
    v_mul_f32 v245, v56, v168
    v_fmac_f32 v237, v49, v121
    v_fmac_f32 v245, v57, v169
    v_fmac_f32 v237, v50, v122
    v_fmac_f32 v245, v58, v170
    v_fmac_f32 v237, v51, v123
    s_setprio 1
    s_waitcnt vmcnt(4) lgkmcnt(1)
    v_mfma_f32_32x32x16_bf16 v[0:15], v[64:67], v[184:187], 0
    ds_read_b64_tr_b16 v[176:177], v246 offset:4096
    ds_read_b64_tr_b16 v[178:179], v246 offset:4608
    ds_read_b64_tr_b16 v[180:181], v247 offset:4096
    ds_read_b64_tr_b16 v[182:183], v247 offset:4608
    v_fmac_f32 v245, v59, v171
    v_fmac_f32 v237, v52, v124
    s_mov_b32 m0, s69
    v_mfma_f32_32x32x16_bf16 v[16:31], v[68:71], v[184:187], 0
    buffer_load_dwordx4 v224, s[4:7], s45 offen sc1 lds
    buffer_load_dwordx4 v225, s[72:75], s45 offen offset:1024 sc1 lds
    s_waitcnt lgkmcnt(4)
    v_mad_u32_u16 v227, v226, s39, v248 op_sel:[1,0,0,0]
    v_mad_u32_u16 v226, v226, s39, v248
    v_fmac_f32 v245, v60, v172
    v_fmac_f32 v237, v53, v125
    v_mfma_f32_32x32x16_bf16 v[32:47], v[64:67], v[188:191], 0
    v_add_u32 v228, s51, v251
    ds_read_b32 v228, v228
    v_fmac_f32 v245, v61, v173
    v_fmac_f32 v237, v54, v126
    v_fmac_f32 v245, v62, v174
    v_fmac_f32 v237, v55, v127
    v_fmac_f32 v245, v63, v175
    v_mfma_f32_32x32x16_bf16 v[48:63], v[68:71], v[188:191], 0
    v_permlane32_swap_b32 v242, v234
    v_permlane32_swap_b32 v243, v235
    v_add_f32 v242, v242, v234
    v_add_f32 v243, v243, v235
    s_waitcnt vmcnt(4) lgkmcnt(1)
    v_mfma_f32_32x32x16_bf16 v[0:15], v[72:75], v[176:179], v[0:15]
    ds_read_b64_tr_b16 v[184:185], v246 offset:6144
    ds_read_b64_tr_b16 v[186:187], v246 offset:6656
    ds_read_b64_tr_b16 v[188:189], v247 offset:6144
    ds_read_b64_tr_b16 v[190:191], v247 offset:6656
    v_cvt_pk_bf16_f32 v242, v242, v243
    ds_write_b32 v230, v242 offset:512
    s_mov_b32 m0, s70
    v_mfma_f32_32x32x16_bf16 v[16:31], v[76:79], v[176:179], v[16:31]
    buffer_load_dwordx4 v226, s[4:7], s46 offen sc1 lds
    buffer_load_dwordx4 v227, s[72:75], s46 offen offset:1024 sc1 lds
    s_waitcnt lgkmcnt(5)
    v_mad_u32_u16 v229, v228, s39, v248 op_sel:[1,0,0,0]
    v_mad_u32_u16 v228, v228, s39, v248
    s_sub_u32 s26, s48, s29
    s_mov_b32 s29, s48
    v_mfma_f32_32x32x16_bf16 v[32:47], v[72:75], v[180:183], v[32:47]
    s_mov_b32 s30, s3
    s_cmp_lg_u32 s36, 0
    s_cselect_b32 s56, s33, 0
    s_mov_b32 s32, s31
    s_mov_b32 s31, s35
    v_mfma_f32_32x32x16_bf16 v[48:63], v[76:79], v[180:183], v[48:63]
    s_waitcnt vmcnt(4) lgkmcnt(1)
    v_mfma_f32_32x32x16_bf16 v[0:15], v[80:83], v[184:187], v[0:15]
    ds_read_b64_tr_b16 v[176:177], v246 offset:0
    ds_read_b64_tr_b16 v[178:179], v246 offset:512
    ds_read_b64_tr_b16 v[180:181], v247 offset:0
    ds_read_b64_tr_b16 v[182:183], v247 offset:512
    s_mov_b32 m0, s71
    v_mfma_f32_32x32x16_bf16 v[16:31], v[84:87], v[184:187], v[16:31]
    buffer_load_dwordx4 v228, s[4:7], s47 offen sc1 lds
    buffer_load_dwordx4 v229, s[72:75], s47 offen offset:1024 sc1 lds
    v_mfma_f32_32x32x16_bf16 v[32:47], v[80:83], v[188:191], v[32:47]
    s_nop 2
    v_mul_f32 v242, v0, v144
    v_fma_f32 v240, v8, v160, -v240
    v_fmac_f32 v242, v1, v145
    v_fmac_f32 v240, v9, v161
    v_fmac_f32 v242, v2, v146
    v_fmac_f32 v240, v10, v162
    v_fmac_f32 v242, v3, v147
    v_mfma_f32_32x32x16_bf16 v[48:63], v[84:87], v[188:191], v[48:63]
    s_setprio 0
    v_fmac_f32 v240, v11, v163
    v_fmac_f32 v242, v4, v148
    v_fmac_f32 v240, v12, v164
    v_fmac_f32 v242, v5, v149
    v_fmac_f32 v240, v13, v165
    v_fmac_f32 v242, v6, v150
    v_fmac_f32 v240, v14, v166
    v_fmac_f32 v242, v7, v151
    v_fmac_f32 v240, v15, v167
    v_add_u32 v249, s26, v249
    v_add_u32 v250, s26, v250
    v_fma_f32 v244, v16, v160, -v244
    v_fmac_f32 v236, v24, v112
    v_fmac_f32 v244, v17, v161
    v_fmac_f32 v236, v25, v113
    v_fmac_f32 v244, v18, v162
    v_fmac_f32 v236, v26, v114
    v_fmac_f32 v244, v19, v163
    v_fmac_f32 v236, v27, v115
    v_fmac_f32 v244, v20, v164
    v_fmac_f32 v236, v28, v116
    v_fmac_f32 v244, v21, v165
    v_fmac_f32 v236, v29, v117
    v_fmac_f32 v244, v22, v166
    v_fmac_f32 v236, v30, v118
    v_fmac_f32 v244, v23, v167
    v_fmac_f32 v236, v31, v119
    ds_read_b64_tr_b16 v[0:1], v249 offset:0
    ds_read_b64_tr_b16 v[2:3], v249 offset:128
    ds_read_b128 v[4:7], v250 offset:0
    ds_read_b128 v[8:11], v250 offset:16
    ds_read_b128 v[12:15], v250 offset:384
    ds_read_b128 v[16:19], v250 offset:400
    v_mul_f32 v243, v32, v152
    v_fma_f32 v241, v40, v168, -v241
    v_fmac_f32 v243, v33, v153
    v_fmac_f32 v241, v41, v169
    v_fmac_f32 v243, v34, v154
    v_fmac_f32 v241, v42, v170
    v_fmac_f32 v243, v35, v155
    v_fmac_f32 v241, v43, v171
    v_fmac_f32 v243, v36, v156
    v_fmac_f32 v241, v44, v172
    v_fmac_f32 v243, v37, v157
    v_fmac_f32 v241, v45, v173
    v_fmac_f32 v243, v38, v158
    v_fmac_f32 v241, v46, v174
    v_fmac_f32 v243, v39, v159
    v_fmac_f32 v241, v47, v175
    ds_read_b64_tr_b16 v[20:21], v249 offset:512
    ds_read_b64_tr_b16 v[22:23], v249 offset:640
    ds_read_b128 v[24:27], v250 offset:64
    ds_read_b128 v[28:31], v250 offset:80
    ds_read_b128 v[32:35], v250 offset:448
    ds_read_b128 v[36:39], v250 offset:464
    v_fma_f32 v245, v48, v168, -v245
    v_fmac_f32 v237, v56, v120
    v_fmac_f32 v245, v49, v169
    v_fmac_f32 v237, v57, v121
    v_fmac_f32 v245, v50, v170
    v_fmac_f32 v237, v58, v122
    v_fmac_f32 v245, v51, v171
    v_fmac_f32 v237, v59, v123
    v_fmac_f32 v245, v52, v172
    v_fmac_f32 v237, v60, v124
    v_fmac_f32 v245, v53, v173
    v_fmac_f32 v237, v61, v125
    v_fmac_f32 v245, v54, v174
    v_fmac_f32 v237, v62, v126
    v_fmac_f32 v245, v55, v175
    v_fmac_f32 v237, v63, v127
    s_cmp_eq_u32 s56, 2
    s_cbranch_scc1 K2_U21
    s_cmp_eq_u32 s56, 3
    s_cbranch_scc1 K2_U31
    s_branch K2_DSP1
K2_PAD_SW:
    s_branch K2_HOP
K2_DSP0:
    s_cmp_eq_u32 s56, 1
    s_cbranch_scc1 K2_U10
    s_cmp_eq_u32 s56, 4
    s_cbranch_scc1 K2_U40
    s_branch K2_SWITCH
K2_DSP1:
    s_cmp_eq_u32 s56, 1
    s_cbranch_scc1 K2_U11
    s_cmp_eq_u32 s56, 4
    s_cbranch_scc1 K2_U41
    s_branch K2_TAIL
K2_SWITCH:
    v_permlane32_swap_b32 v242, v236
    v_permlane32_swap_b32 v243, v237
    v_permlane32_swap_b32 v244, v238
    v_permlane32_swap_b32 v245, v239
    v_permlane32_swap_b32 v240, v241
    v_add_f32 v242, v242, v236
    v_add_f32 v243, v243, v237
    v_add_f32 v244, v244, v238
    v_add_f32 v245, v245, v239
    v_add_f32 v240, -v240, -v241
    s_set_gpr_idx_on s32, gpr_idx(DST)
    s_nop 0
    v_cvt_pk_bf16_f32 v195, v242, v243
    v_cvt_pk_bf16_f32 v196, v244, v245
    v_cvt_pk_bf16_f32 v197, v240, v240
    s_set_gpr_idx_off
    s_cmp_eq_u32 s36, 0
    s_cbranch_scc1 K2_TAIL2
    v_lshlrev_b32 v254, 3, v252
    v_lshl_add_u32 v230, v252, 1, s35
    v_lshrrev_b32 v231, 6, v252
    v_mul_u32_u24 v231, 126, v231
    s_mov_b32 s58, 7131136
    buffer_load_dwordx4 v[96:99], v254, s[8:11], s58 offen offset:0 sc1
    buffer_load_dwordx4 v[100:103], v254, s[8:11], s58 offen offset:1024 sc1
    buffer_load_dwordx4 v[104:107], v254, s[8:11], s58 offen offset:2048 sc1
    buffer_load_dwordx4 v[108:111], v254, s[8:11], s58 offen offset:3072 sc1
    s_mov_b32 s58, 7135232
    buffer_load_dwordx4 v[112:115], v254, s[8:11], s58 offen offset:0 sc1
    buffer_load_dwordx4 v[116:119], v254, s[8:11], s58 offen offset:1024 sc1
    buffer_load_dwordx4 v[120:123], v254, s[8:11], s58 offen offset:2048 sc1
    buffer_load_dwordx4 v[124:127], v254, s[8:11], s58 offen offset:3072 sc1
    s_mov_b32 s58, 7139328
    buffer_load_dwordx4 v[128:131], v254, s[8:11], s58 offen offset:0 sc1
    buffer_load_dwordx4 v[132:135], v254, s[8:11], s58 offen offset:1024 sc1
    buffer_load_dwordx4 v[136:139], v254, s[8:11], s58 offen offset:2048 sc1
    buffer_load_dwordx4 v[140:143], v254, s[8:11], s58 offen offset:3072 sc1
    s_mov_b32 s58, 7143424
    buffer_load_dwordx4 v[144:147], v254, s[8:11], s58 offen offset:0 sc1
    buffer_load_dwordx4 v[148:151], v254, s[8:11], s58 offen offset:1024 sc1
    buffer_load_dwordx4 v[152:155], v254, s[8:11], s58 offen offset:2048 sc1
    buffer_load_dwordx4 v[156:159], v254, s[8:11], s58 offen offset:3072 sc1
    s_mov_b32 s58, 7147520
    buffer_load_dwordx4 v[160:163], v254, s[8:11], s58 offen offset:0 sc1
    buffer_load_dwordx4 v[164:167], v254, s[8:11], s58 offen offset:1024 sc1
    buffer_load_dwordx4 v[168:171], v254, s[8:11], s58 offen offset:2048 sc1
    buffer_load_dwordx4 v[172:175], v254, s[8:11], s58 offen offset:3072 sc1
    s_movk_i32 s40, 128
    s_movk_i32 s41, 384
    s_movk_i32 s42, 640
    s_movk_i32 s43, 896
    s_cmp_lg_u32 s33, 1
    s_cbranch_scc1 K2_SW2
    s_waitcnt vmcnt(0)
K2_SW2:
    s_mov_b32 s29, s48
    s_mov_b32 s32, s31
    s_mov_b32 s30, s3
    s_mov_b32 s31, s35
    s_cmp_eq_u32 s33, 2
    s_cbranch_scc1 K2_U21
    s_cmp_eq_u32 s33, 3
    s_cbranch_scc1 K2_U31
    s_cmp_eq_u32 s33, 1
    s_cbranch_scc1 K2_U11
    s_branch K2_U41
K2_dum_4:
    v_mov_b32 v232, -1
    s_mov_b32 m0, 163712
    s_mov_b64 exec, 1
    buffer_load_dwordx4 v232, s[16:19], 0 offen lds
    buffer_load_dwordx4 v232, s[16:19], 0 offen lds
    s_mov_b64 exec, -1
    s_branch K2_back_6
K2_nul_10:
    s_mov_b32 s58, 63
    s_mov_b32 s36, 0
    s_branch K2_back_13
K2_spin_11:
    s_sub_u32 s27, s27, 1
    s_cbranch_scc1 K2_END
    v_lshl_add_u32 v233, v252, 1, s53
    ds_read_b32 v233, v233
    s_waitcnt lgkmcnt(0)
    s_branch K2_chk_12
K2_dyn_8:
    v_mov_b32 v254, 163648
    v_mov_b32 v255, 1
    v_lshl_add_u32 v233, v252, 1, s53
    s_mov_b64 exec, 1
    ds_add_rtn_u32 v232, v254, v255
    s_mov_b64 exec, -1
    ds_read_b32 v233, v233
    s_waitcnt lgkmcnt(0)
    v_readfirstlane_b32 s58, v232
    s_nop 0
    s_cmp_lt_u32 s58, s22
    s_cbranch_scc0 K2_nul_10
    s_and_b32 s59, s58, 7
    s_lshr_b32 s60, s58, 3
K2_chk_12:
    v_readlane_b32 s61, v233, s59
    s_nop 0
    s_cmp_gt_u32 s61, s60
    s_cbranch_scc0 K2_spin_11
K2_back_13:
    s_mov_b32 s34, 1
    s_branch K2_back_9
K2_dum_17:
    v_mov_b32 v232, -1
    s_mov_b32 m0, 163712
    s_mov_b64 exec, 1
    buffer_load_dwordx4 v232, s[16:19], 0 offen lds
    buffer_load_dwordx4 v232, s[16:19], 0 offen lds
    s_mov_b64 exec, -1
    s_branch K2_back_19
K2_nul_23:
    s_mov_b32 s58, 63
    s_mov_b32 s36, 0
    s_branch K2_back_26
K2_spin_24:
    s_sub_u32 s27, s27, 1
    s_cbranch_scc1 K2_END
    v_lshl_add_u32 v233, v252, 1, s53
    ds_read_b32 v233, v233
    s_waitcnt lgkmcnt(0)
    s_branch K2_chk_25
K2_dyn_21:
    v_mov_b32 v254, 163648
    v_mov_b32 v255, 1
    v_lshl_add_u32 v233, v252, 1, s53
    s_mov_b64 exec, 1
    ds_add_rtn_u32 v232, v254, v255
    s_mov_b64 exec, -1
    ds_read_b32 v233, v233
    s_waitcnt lgkmcnt(0)
    v_readfirstlane_b32 s58, v232
    s_nop 0
    s_cmp_lt_u32 s58, s22
    s_cbranch_scc0 K2_nul_23
    s_and_b32 s59, s58, 7
    s_lshr_b32 s60, s58, 3
K2_chk_25:
    v_readlane_b32 s61, v233, s59
    s_nop 0
    s_cmp_gt_u32 s61, s60
    s_cbranch_scc0 K2_spin_24
K2_back_26:
    s_mov_b32 s34, 1
    s_branch K2_back_22
K2_dum_30:
    v_mov_b32 v232, -1
    s_mov_b32 m0, 163712
    s_mov_b64 exec, 1
    buffer_load_dwordx4 v232, s[16:19], 0 offen lds
    buffer_load_dwordx4 v232, s[16:19], 0 offen lds
    s_mov_b64 exec, -1
    s_branch K2_back_32
K2_nul_34:
    s_mov_b32 s58, 63
    s_mov_b32 s36, 0
    s_branch K2_back_37
K2_spin_35:
    s_sub_u32 s27, s27, 1
    s_cbranch_scc1 K2_END
    v_lshl_add_u32 v233, v252, 1, s53
    ds_read_b32 v233, v233
    s_waitcnt lgkmcnt(0)
    s_branch K2_chk_36
K2_nul_41:
    s_mov_b32 s58, 63
    s_mov_b32 s36, 0
    s_branch K2_back_44
K2_spin_42:
    s_sub_u32 s27, s27, 1
    s_cbranch_scc1 K2_END
    v_lshl_add_u32 v233, v252, 1, s53
    ds_read_b32 v233, v233
    s_waitcnt lgkmcnt(0)
    s_branch K2_chk_43
K2_PAD_TL:
    s_branch K2_HOP
K2_TAIL2:
    v_lshlrev_b32 v229, 3, v252
    s_mul_i32 s58, s20, 20480
    s_add_u32 s58, s58, 6946816
    s_mul_i32 s59, s20, 8224
    buffer_load_dwordx4 v[96:99], v229, s[8:11], s58 offen offset:0 sc1
    buffer_load_dwordx4 v[100:103], v229, s[8:11], s58 offen offset:1024 sc1
    buffer_load_dwordx4 v[104:107], v229, s[8:11], s58 offen offset:2048 sc1
    buffer_load_dwordx4 v[108:111], v229, s[8:11], s58 offen offset:3072 sc1
    s_add_u32 s58, s58, 4096
    buffer_load_dwordx4 v[112:115], v229, s[8:11], s58 offen offset:0 sc1
    buffer_load_dwordx4 v[116:119], v229, s[8:11], s58 offen offset:1024 sc1
    buffer_load_dwordx4 v[120:123], v229, s[8:11], s58 offen offset:2048 sc1
    buffer_load_dwordx4 v[124:127], v229, s[8:11], s58 offen offset:3072 sc1
    s_add_u32 s58, s58, 4096
    v_lshl_add_u32 v228, v252, 1, s59
    v_lshrrev_b32 v226, 6, v252
    v_mul_u32_u24 v226, 126, v226
    v_sub_u32 v226, v228, v226
    s_branch K2_TAIL3
K2_TAIL:
    v_lshlrev_b32 v229, 3, v252
    s_mul_i32 s58, s20, 20480
    s_add_u32 s58, s58, 6946816
    s_mul_i32 s59, s20, 8224
    buffer_load_dwordx4 v[96:99], v229, s[8:11], s58 offen offset:0 sc1
    v_permlane32_swap_b32 v242, v236
    v_permlane32_swap_b32 v243, v237
    buffer_load_dwordx4 v[100:103], v229, s[8:11], s58 offen offset:1024 sc1
    v_permlane32_swap_b32 v244, v238
    v_permlane32_swap_b32 v245, v239
    buffer_load_dwordx4 v[104:107], v229, s[8:11], s58 offen offset:2048 sc1
    v_permlane32_swap_b32 v240, v241
    v_add_f32 v242, v242, v236
    buffer_load_dwordx4 v[108:111], v229, s[8:11], s58 offen offset:3072 sc1
    s_add_u32 s58, s58, 4096
    v_add_f32 v243, v243, v237
    v_add_f32 v244, v244, v238
    buffer_load_dwordx4 v[112:115], v229, s[8:11], s58 offen offset:0 sc1
    v_add_f32 v245, v245, v239
    v_add_f32 v240, -v240, -v241
    buffer_load_dwordx4 v[116:119], v229, s[8:11], s58 offen offset:1024 sc1
    v_sub_u32 v241, v230, v231
    v_cvt_pk_bf16_f32 v242, v242, v243
    buffer_load_dwordx4 v[120:123], v229, s[8:11], s58 offen offset:2048 sc1
    v_cvt_pk_bf16_f32 v244, v244, v245
    v_cvt_pk_bf16_f32 v240, v240, v240
    buffer_load_dwordx4 v[124:127], v229, s[8:11], s58 offen offset:3072 sc1
    s_add_u32 s58, s58, 4096
    ds_write_b32 v230, v242 offset:768
    ds_write_b32 v230, v244 offset:1024
    ds_write_b16 v241, v240 offset:1280
    v_lshl_add_u32 v228, v252, 1, s59
    v_lshrrev_b32 v226, 6, v252
    v_mul_u32_u24 v226, 126, v226
    v_sub_u32 v226, v228, v226
K2_TAIL3:
    s_waitcnt vmcnt(8)
    ds_write_b32 v228, v192 offset:0
    ds_write_b32 v228, v193 offset:256
    ds_write_b32 v228, v194 offset:512
    buffer_load_dwordx4 v[128:131], v229, s[8:11], s58 offen offset:0 sc1
    v_bfe_u32 v48, v252, 1, 4
    v_lshrrev_b32 v49, 5, v252
    ds_write_b32 v228, v195 offset:768
    ds_write_b32 v228, v196 offset:1024
    ds_write_b16 v226, v197 offset:1280
    buffer_load_dwordx4 v[132:135], v229, s[8:11], s58 offen offset:1024 sc1
    v_lshrrev_b32 v55, 3, v48
    v_lshlrev_b32 v52, 4, v49
    ds_write_b32 v228, v198 offset:1536
    ds_write_b32 v228, v199 offset:1792
    ds_write_b32 v228, v200 offset:2048
    buffer_load_dwordx4 v[136:139], v229, s[8:11], s58 offen offset:2048 sc1
    v_lshl_add_u32 v54, v55, 2, v48
    v_and_b32 v54, 7, v54
    ds_write_b32 v228, v201 offset:2304
    ds_write_b32 v228, v202 offset:2560
    ds_write_b16 v226, v203 offset:2816
    buffer_load_dwordx4 v[140:143], v229, s[8:11], s58 offen offset:3072 sc1
    s_add_u32 s58, s58, 4096
    v_and_b32 v50, 7, v48
    v_mul_u32_u24 v50, 8224, v50
    ds_write_b32 v228, v204 offset:3072
    ds_write_b32 v228, v205 offset:3328
    ds_write_b32 v228, v206 offset:3584
    buffer_load_dwordx4 v[144:147], v229, s[8:11], s58 offen offset:0 sc1
    v_mul_u32_u24 v51, 1536, v55
    v_add_u32 v50, v50, v51
    ds_write_b32 v228, v207 offset:3840
    ds_write_b32 v228, v208 offset:4096
    ds_write_b16 v226, v209 offset:4352
    buffer_load_dwordx4 v[148:151], v229, s[8:11], s58 offen offset:1024 sc1
    v_add_u32 v222, v50, v52
    v_mul_u32_u24 v51, 8224, v54
    ds_write_b32 v228, v210 offset:4608
    ds_write_b32 v228, v211 offset:4864
    ds_write_b32 v228, v212 offset:5120
    buffer_load_dwordx4 v[152:155], v229, s[8:11], s58 offen offset:2048 sc1
    v_add_u32 v232, v51, v52
    v_lshl_add_u32 v247, v55, 7, v232
    ds_write_b32 v228, v213 offset:5376
    ds_write_b32 v228, v214 offset:5632
    ds_write_b16 v226, v215 offset:5888
    buffer_load_dwordx4 v[156:159], v229, s[8:11], s58 offen offset:3072 sc1
    s_add_u32 s58, s58, 4096
    v_mul_u32_u24 v53, 192, v48
    v_and_b32 v53, 0xc0, v53
    ds_write_b32 v228, v216 offset:6144
    ds_write_b32 v228, v217 offset:6400
    ds_write_b32 v228, v218 offset:6656
    buffer_load_dwordx4 v[160:163], v229, s[8:11], s58 offen offset:0 sc1
    v_add_u32 v53, v53, v52
    v_mul_u32_u24 v51, 2400, v48
    ds_write_b32 v228, v219 offset:6912
    ds_write_b32 v228, v220 offset:7168
    ds_write_b16 v226, v221 offset:7424
    buffer_load_dwordx4 v[164:167], v229, s[8:11], s58 offen offset:1024 sc1
    s_mov_b32 s60, 65536
    v_add3_u32 v223, v51, v53, s60
    buffer_load_dwordx4 v[168:171], v229, s[8:11], s58 offen offset:2048 sc1
    v_mul_u32_u24 v51, 2400, v54
    s_mov_b32 s60, 142336
    buffer_load_dwordx4 v[172:175], v229, s[8:11], s58 offen offset:3072 sc1
    v_add3_u32 v225, v51, v53, s60
    v_lshl_add_u32 v248, v55, 7, v225
    s_lshl_b32 s60, s20, 5
    v_lshl_add_u32 v49, v49, 3, s60
    s_mov_b32 s60, 65536
    v_add3_u32 v255, v51, v49, s60
    v_lshl_add_u32 v246, v55, 9, v255
    v_bfe_u32 v53, v48, 2, 1
    v_lshl_add_u32 v49, v53, 4, v49
    v_add_u32 v254, v50, v49
    s_and_b32 s64, s55, s28
    s_waitcnt lgkmcnt(0)
    s_barrier
    s_cmp_eq_u32 s64, 0
    s_cbranch_scc1 K2_MULTI
    s_setprio 3
    ds_read_b128 v[48:51], v222 offset:0
    ds_read_b128 v[52:55], v222 offset:64
    ds_read_b128 v[56:59], v222 offset:896
    ds_read_b128 v[60:63], v222 offset:960
    ds_read_b128 v[64:67], v223 offset:0
    ds_read_b128 v[68:71], v223 offset:64
    ds_read_b128 v[72:75], v223 offset:896
    ds_read_b128 v[76:79], v223 offset:960
    ds_read_b128 v[80:83], v222 offset:128
    ds_read_b128 v[84:87], v222 offset:384
    ds_read_b128 v[88:91], v222 offset:256
    s_waitcnt vmcnt(19) lgkmcnt(9)
    v_mfma_f32_16x16x32_bf16 v[0:3], v[96:99], v[48:51], 0
    ds_read_b128 v[92:95], v222 offset:192
    s_waitcnt vmcnt(18)
    v_mfma_f32_16x16x32_bf16 v[0:3], v[100:103], v[52:55], v[0:3]
    ds_read_b128 v[48:51], v222 offset:448
    s_waitcnt vmcnt(17) lgkmcnt(9)
    v_mfma_f32_16x16x32_bf16 v[0:3], v[104:107], v[56:59], v[0:3]
    s_bfe_u32 s60, s20, 0x10002
    s_lshl_b32 s60, s60, 4
    ds_read_b128 v[52:55], v222 offset:320
    s_waitcnt vmcnt(16)
    v_mfma_f32_16x16x32_bf16 v[0:3], v[108:111], v[60:63], v[0:3]
    s_add_u32 s59, s59, s60
    v_add_u32 v228, s59, v229
    ds_read_b128 v[56:59], v222 offset:640
    s_waitcnt vmcnt(15) lgkmcnt(9)
    v_mfma_f32_16x16x32_bf16 v[0:3], v[112:115], v[64:67], v[0:3]
    s_mul_i32 s60, s20, 2400
    s_add_u32 s60, s60, 65536
    ds_read_b128 v[60:63], v222 offset:512
    s_waitcnt vmcnt(14)
    v_mfma_f32_16x16x32_bf16 v[0:3], v[116:119], v[68:71], v[0:3]
    v_add_u32 v249, s60, v229
    s_mov_b32 s63, 0xbfb8aa3b
    ds_read_b128 v[64:67], v222 offset:768
    s_waitcnt vmcnt(13) lgkmcnt(9)
    v_mfma_f32_16x16x32_bf16 v[0:3], v[120:123], v[72:75], v[0:3]
    s_add_u32 s40, s20, s21
    s_lshl_b32 s40, s40, 10
    ds_read_b128 v[68:71], v222 offset:704
    s_waitcnt vmcnt(12)
    v_mfma_f32_16x16x32_bf16 v[0:3], v[124:127], v[76:79], v[0:3]
    s_add_u32 s41, s40, 8192
    s_add_u32 s42, s40, 16384
    ds_read_b128 v[72:75], v222 offset:576
    s_waitcnt vmcnt(11) lgkmcnt(9)
    v_mfma_f32_16x16x32_bf16 v[4:7], v[128:131], v[80:83], 0
    s_add_u32 s43, s40, 24576
    s_add_u32 s44, s40, 32768
    ds_read_b128 v[76:79], v222 offset:832
    v_mfma_f32_16x16x32_bf16 v[8:11], v[128:131], v[84:87], 0
    ds_read_b128 v[80:83], v222 offset:1024
    s_waitcnt lgkmcnt(9)
    v_mfma_f32_16x16x32_bf16 v[12:15], v[128:131], v[88:91], 0
    ds_read_b128 v[84:87], v222 offset:1280
    s_waitcnt vmcnt(10)
    v_mfma_f32_16x16x32_bf16 v[4:7], v[132:135], v[92:95], v[4:7]
    ds_read_b128 v[88:91], v222 offset:1152
    s_waitcnt lgkmcnt(9)
    v_mfma_f32_16x16x32_bf16 v[8:11], v[132:135], v[48:51], v[8:11]
    v_mul_f32 v204, s63, v0
    ds_read_b128 v[92:95], v222 offset:1088
    v_mfma_f32_16x16x32_bf16 v[12:15], v[132:135], v[52:55], v[12:15]
    v_mul_f32 v205, s63, v1
    s_setprio 2
    ds_read_b128 v[48:51], v222 offset:1344
    s_waitcnt vmcnt(9) lgkmcnt(9)
    v_mfma_f32_16x16x32_bf16 v[4:7], v[136:139], v[56:59], v[4:7]
    ds_read_b128 v[52:55], v222 offset:1216
    v_mfma_f32_16x16x32_bf16 v[8:11], v[136:139], v[60:63], v[8:11]
    v_mul_f32 v206, s63, v2
    ds_read_b128 v[56:59], v223 offset:128
    s_waitcnt lgkmcnt(9)
    v_mfma_f32_16x16x32_bf16 v[12:15], v[136:139], v[64:67], v[12:15]
    v_mul_f32 v207, s63, v3
    ds_read_b128 v[60:63], v223 offset:384
    s_waitcnt vmcnt(8)
    v_mfma_f32_16x16x32_bf16 v[4:7], v[140:143], v[68:71], v[4:7]
    ds_read_b128 v[64:67], v223 offset:256
    s_waitcnt lgkmcnt(9)
    v_mfma_f32_16x16x32_bf16 v[8:11], v[140:143], v[72:75], v[8:11]
    v_exp_f32 v204, v204
    ds_read_b128 v[68:71], v223 offset:192
    v_mfma_f32_16x16x32_bf16 v[12:15], v[140:143], v[76:79], v[12:15]
    ds_read_b128 v[72:75], v223 offset:448
    s_waitcnt vmcnt(7) lgkmcnt(9)
    v_mfma_f32_16x16x32_bf16 v[4:7], v[144:147], v[80:83], v[4:7]
    v_exp_f32 v205, v205
    ds_read_b128 v[76:79], v223 offset:320
    v_mfma_f32_16x16x32_bf16 v[8:11], v[144:147], v[84:87], v[8:11]
    v_exp_f32 v206, v206
    ds_read_b128 v[80:83], v223 offset:640
    s_waitcnt lgkmcnt(9)
    v_mfma_f32_16x16x32_bf16 v[12:15], v[144:147], v[88:91], v[12:15]
    ds_read_b128 v[84:87], v223 offset:512
    s_waitcnt vmcnt(6)
    v_mfma_f32_16x16x32_bf16 v[4:7], v[148:151], v[92:95], v[4:7]
    v_exp_f32 v207, v207
    ds_read_b128 v[88:91], v223 offset:768
    s_waitcnt lgkmcnt(9)
    v_mfma_f32_16x16x32_bf16 v[8:11], v[148:151], v[48:51], v[8:11]
    v_add_f32 v204, 1.0, v204
    ds_read_b128 v[92:95], v223 offset:704
    v_mfma_f32_16x16x32_bf16 v[12:15], v[148:151], v[52:55], v[12:15]
    ds_read_b128 v[48:51], v223 offset:576
    s_waitcnt vmcnt(5) lgkmcnt(9)
    v_mfma_f32_16x16x32_bf16 v[4:7], v[152:155], v[56:59], v[4:7]
    v_add_f32 v205, 1.0, v205
    ds_read_b128 v[52:55], v223 offset:832
    v_mfma_f32_16x16x32_bf16 v[8:11], v[152:155], v[60:63], v[8:11]
    s_setprio 1
    ds_read_b128 v[56:59], v223 offset:1024
    s_waitcnt lgkmcnt(9)
    v_mfma_f32_16x16x32_bf16 v[12:15], v[152:155], v[64:67], v[12:15]
    v_add_f32 v206, 1.0, v206
    ds_read_b128 v[60:63], v223 offset:1280
    s_waitcnt vmcnt(4)
    v_mfma_f32_16x16x32_bf16 v[4:7], v[156:159], v[68:71], v[4:7]
    v_add_f32 v207, 1.0, v207
    ds_read_b128 v[64:67], v223 offset:1152
    s_waitcnt lgkmcnt(9)
    v_mfma_f32_16x16x32_bf16 v[8:11], v[156:159], v[72:75], v[8:11]
    ds_read_b128 v[68:71], v223 offset:1088
    v_mfma_f32_16x16x32_bf16 v[12:15], v[156:159], v[76:79], v[12:15]
    v_rcp_f32 v204, v204
    ds_read_b128 v[72:75], v223 offset:1344
    s_waitcnt vmcnt(3) lgkmcnt(9)
    v_mfma_f32_16x16x32_bf16 v[4:7], v[160:163], v[80:83], v[4:7]
    v_rcp_f32 v205, v205
    ds_read_b128 v[76:79], v223 offset:1216
    v_mfma_f32_16x16x32_bf16 v[8:11], v[160:163], v[84:87], v[8:11]
    ds_read_b128 v[80:83], v222 offset:3072
    s_waitcnt lgkmcnt(9)
    v_mfma_f32_16x16x32_bf16 v[12:15], v[160:163], v[88:91], v[12:15]
    v_rcp_f32 v206, v206
    ds_read_b128 v[84:87], v222 offset:3136
    s_waitcnt vmcnt(2)
    v_mfma_f32_16x16x32_bf16 v[4:7], v[164:167], v[92:95], v[4:7]
    ds_read_b128 v[88:91], v222 offset:3968
    s_waitcnt lgkmcnt(9)
    v_mfma_f32_16x16x32_bf16 v[8:11], v[164:167], v[48:51], v[8:11]
    v_rcp_f32 v207, v207
    ds_read_b128 v[92:95], v222 offset:4032
    v_mfma_f32_16x16x32_bf16 v[12:15], v[164:167], v[52:55], v[12:15]
    v_cvt_pk_bf16_f32 v176, v0, v1
    ds_read_b128 v[48:51], v223 offset:38400
    s_waitcnt vmcnt(1) lgkmcnt(9)
    v_mfma_f32_16x16x32_bf16 v[4:7], v[168:171], v[56:59], v[4:7]
    ds_read_b128 v[52:55], v223 offset:38464
    v_mfma_f32_16x16x32_bf16 v[8:11], v[168:171], v[60:63], v[8:11]
    v_cvt_pk_bf16_f32 v177, v2, v3
    s_setprio 0
    ds_read_b128 v[56:59], v223 offset:39296
    s_waitcnt lgkmcnt(9)
    v_mfma_f32_16x16x32_bf16 v[12:15], v[168:171], v[64:67], v[12:15]
    ds_read_b128 v[60:63], v223 offset:39360
    s_waitcnt vmcnt(0)
    v_mfma_f32_16x16x32_bf16 v[4:7], v[172:175], v[68:71], v[4:7]
K2_PAD_T2:
    s_cbranch_execz K2_HOP
    ds_read_b128 v[64:67], v222 offset:3200
    s_waitcnt lgkmcnt(9)
    v_mfma_f32_16x16x32_bf16 v[8:11], v[172:175], v[72:75], v[8:11]
    ds_read_b128 v[68:71], v222 offset:3456
    v_mfma_f32_16x16x32_bf16 v[12:15], v[172:175], v[76:79], v[12:15]
    ds_read_b128 v[72:75], v222 offset:3328
    s_waitcnt lgkmcnt(9)
    v_mfma_f32_16x16x32_bf16 v[16:19], v[96:99], v[80:83], 0
    ds_read_b128 v[76:79], v222 offset:3264
    v_mfma_f32_16x16x32_bf16 v[16:19], v[100:103], v[84:87], v[16:19]
    ds_read_b128 v[80:83], v222 offset:3520
    s_waitcnt lgkmcnt(9)
    v_mfma_f32_16x16x32_bf16 v[16:19], v[104:107], v[88:91], v[16:19]
    s_barrier
    s_setprio 3
    ds_read_b128 v[84:87], v222 offset:3392
    v_mfma_f32_16x16x32_bf16 v[16:19], v[108:111], v[92:95], v[16:19]
    v_mul_f32 v4, v4, v204
    ds_read_b128 v[88:91], v222 offset:3712
    s_waitcnt lgkmcnt(9)
    v_mfma_f32_16x16x32_bf16 v[16:19], v[112:115], v[48:51], v[16:19]
    v_mul_f32 v5, v5, v205
    ds_read_b128 v[92:95], v222 offset:3584
    v_mfma_f32_16x16x32_bf16 v[16:19], v[116:119], v[52:55], v[16:19]
    v_mul_f32 v6, v6, v206
    ds_read_b128 v[48:51], v222 offset:3840
    s_waitcnt lgkmcnt(9)
    v_mfma_f32_16x16x32_bf16 v[16:19], v[120:123], v[56:59], v[16:19]
    v_mul_f32 v7, v7, v207
    ds_read_b128 v[52:55], v222 offset:3776
    v_mfma_f32_16x16x32_bf16 v[16:19], v[124:127], v[60:63], v[16:19]
    v_cvt_pk_bf16_f32 v178, v4, v5
    ds_read_b128 v[56:59], v222 offset:3648
    s_waitcnt lgkmcnt(9)
    v_mfma_f32_16x16x32_bf16 v[20:23], v[128:131], v[64:67], 0
    v_cvt_pk_bf16_f32 v179, v6, v7
    ds_read_b128 v[60:63], v222 offset:3904
    v_mfma_f32_16x16x32_bf16 v[24:27], v[128:131], v[68:71], 0
    v_mul_f32 v8, v8, v204
    ds_read_b128 v[64:67], v222 offset:4096
    s_waitcnt lgkmcnt(9)
    v_mfma_f32_16x16x32_bf16 v[28:31], v[128:131], v[72:75], 0
    v_mul_f32 v9, v9, v205
    ds_read_b128 v[68:71], v222 offset:4352
    v_mfma_f32_16x16x32_bf16 v[20:23], v[132:135], v[76:79], v[20:23]
    v_mul_f32 v10, v10, v206
    ds_read_b128 v[72:75], v222 offset:4224
    s_waitcnt lgkmcnt(9)
    v_mfma_f32_16x16x32_bf16 v[24:27], v[132:135], v[80:83], v[24:27]
    v_mul_f32 v11, v11, v207
    ds_read_b128 v[76:79], v222 offset:4160
    v_mfma_f32_16x16x32_bf16 v[28:31], v[132:135], v[84:87], v[28:31]
    v_cvt_pk_bf16_f32 v180, v8, v9
    ds_read_b128 v[80:83], v222 offset:4416
    s_waitcnt lgkmcnt(9)
    v_mfma_f32_16x16x32_bf16 v[20:23], v[136:139], v[88:91], v[20:23]
    v_cvt_pk_bf16_f32 v181, v10, v11
    ds_read_b128 v[84:87], v222 offset:4288
    v_mfma_f32_16x16x32_bf16 v[24:27], v[136:139], v[92:95], v[24:27]
    v_mul_f32 v12, v12, v204
    s_setprio 2
    ds_read_b128 v[88:91], v223 offset:38528
    s_waitcnt lgkmcnt(9)
    v_mfma_f32_16x16x32_bf16 v[28:31], v[136:139], v[48:51], v[28:31]
    v_mul_f32 v13, v13, v205
    ds_read_b128 v[92:95], v223 offset:38784
    v_mfma_f32_16x16x32_bf16 v[20:23], v[140:143], v[52:55], v[20:23]
    v_mul_f32 v14, v14, v206
    ds_read_b128 v[48:51], v223 offset:38656
    s_waitcnt lgkmcnt(9)
    v_mfma_f32_16x16x32_bf16 v[24:27], v[140:143], v[56:59], v[24:27]
    v_mul_f32 v15, v15, v207
    ds_read_b128 v[52:55], v223 offset:38592
    v_mfma_f32_16x16x32_bf16 v[28:31], v[140:143], v[60:63], v[28:31]
    v_cvt_pk_bf16_f32 v182, v12, v13
    ds_read_b128 v[56:59], v223 offset:38848
    s_waitcnt lgkmcnt(9)
    v_mfma_f32_16x16x32_bf16 v[20:23], v[144:147], v[64:67], v[20:23]
    v_cvt_pk_bf16_f32 v183, v14, v15
    ds_read_b128 v[60:63], v223 offset:38720
    v_mfma_f32_16x16x32_bf16 v[24:27], v[144:147], v[68:71], v[24:27]
    ds_write_b64 v254, v[176:177] offset:0
    ds_write_b64 v254, v[178:179] offset:256
    ds_write_b64 v254, v[180:181] offset:512
    ds_write_b64 v254, v[182:183] offset:768
    ds_read_b128 v[64:67], v223 offset:39040
    s_waitcnt lgkmcnt(13)
    v_mfma_f32_16x16x32_bf16 v[28:31], v[144:147], v[72:75], v[28:31]
    v_mul_f32 v208, s63, v16
    ds_read_b128 v[68:71], v223 offset:38912
    v_mfma_f32_16x16x32_bf16 v[20:23], v[148:151], v[76:79], v[20:23]
    v_mul_f32 v209, s63, v17
    ds_read_b128 v[72:75], v223 offset:39168
    s_waitcnt lgkmcnt(13)
    v_mfma_f32_16x16x32_bf16 v[24:27], v[148:151], v[80:83], v[24:27]
    v_mul_f32 v210, s63, v18
    ds_read_b128 v[76:79], v223 offset:39104
    v_mfma_f32_16x16x32_bf16 v[28:31], v[148:151], v[84:87], v[28:31]
    v_mul_f32 v211, s63, v19
    ds_read_b128 v[80:83], v223 offset:38976
    s_waitcnt lgkmcnt(13)
    v_mfma_f32_16x16x32_bf16 v[20:23], v[152:155], v[88:91], v[20:23]
    v_exp_f32 v208, v208
    ds_read_b128 v[84:87], v223 offset:39232
    v_mfma_f32_16x16x32_bf16 v[24:27], v[152:155], v[92:95], v[24:27]
    v_exp_f32 v209, v209
    ds_read_b128 v[88:91], v223 offset:39424
    s_waitcnt lgkmcnt(13)
    v_mfma_f32_16x16x32_bf16 v[28:31], v[152:155], v[48:51], v[28:31]
    s_setprio 1
    ds_read_b128 v[92:95], v223 offset:39680
    v_mfma_f32_16x16x32_bf16 v[20:23], v[156:159], v[52:55], v[20:23]
    v_exp_f32 v210, v210
    ds_read_b128 v[48:51], v223 offset:39552
    s_waitcnt lgkmcnt(13)
    v_mfma_f32_16x16x32_bf16 v[24:27], v[156:159], v[56:59], v[24:27]
    v_exp_f32 v211, v211
    ds_read_b128 v[52:55], v223 offset:39488
    v_mfma_f32_16x16x32_bf16 v[28:31], v[156:159], v[60:63], v[28:31]
    v_add_f32 v208, 1.0, v208
    ds_read_b128 v[56:59], v223 offset:39744
    s_waitcnt lgkmcnt(9)
    v_mfma_f32_16x16x32_bf16 v[20:23], v[160:163], v[64:67], v[20:23]
    v_add_f32 v209, 1.0, v209
    ds_read_b128 v[60:63], v223 offset:39616
    v_mfma_f32_16x16x32_bf16 v[24:27], v[160:163], v[68:71], v[24:27]
    v_add_f32 v210, 1.0, v210
    ds_read_b128 v[64:67], v232 offset:6144
    s_waitcnt lgkmcnt(9)
    v_mfma_f32_16x16x32_bf16 v[28:31], v[160:163], v[72:75], v[28:31]
    v_add_f32 v211, 1.0, v211
    ds_read_b128 v[68:71], v232 offset:6208
    v_mfma_f32_16x16x32_bf16 v[20:23], v[164:167], v[76:79], v[20:23]
    ds_read_b128 v[72:75], v232 offset:7040
    s_waitcnt lgkmcnt(9)
    v_mfma_f32_16x16x32_bf16 v[24:27], v[164:167], v[80:83], v[24:27]
    v_rcp_f32 v208, v208
    ds_read_b128 v[76:79], v232 offset:7104
    v_mfma_f32_16x16x32_bf16 v[28:31], v[164:167], v[84:87], v[28:31]
    v_rcp_f32 v209, v209
    ds_read_b128 v[80:83], v225 offset:0
    s_waitcnt lgkmcnt(9)
    v_mfma_f32_16x16x32_bf16 v[20:23], v[168:171], v[88:91], v[20:23]
    v_rcp_f32 v210, v210
    ds_read_b128 v[84:87], v225 offset:64
    v_mfma_f32_16x16x32_bf16 v[24:27], v[168:171], v[92:95], v[24:27]
    v_rcp_f32 v211, v211
    ds_read_b128 v[88:91], v225 offset:896
    s_waitcnt lgkmcnt(9)
    v_mfma_f32_16x16x32_bf16 v[28:31], v[168:171], v[48:51], v[28:31]
    v_cvt_pk_bf16_f32 v184, v16, v17
    s_setprio 0
    ds_read_b128 v[92:95], v225 offset:960
    v_mfma_f32_16x16x32_bf16 v[20:23], v[172:175], v[52:55], v[20:23]
    v_cvt_pk_bf16_f32 v185, v18, v19
    ds_read_b128 v[48:51], v247 offset:6272
    s_waitcnt lgkmcnt(9)
    v_mfma_f32_16x16x32_bf16 v[24:27], v[172:175], v[56:59], v[24:27]
    ds_read_b128 v[52:55], v232 offset:6528
    v_mfma_f32_16x16x32_bf16 v[28:31], v[172:175], v[60:63], v[28:31]
    ds_read_b128 v[56:59], v247 offset:6336
    s_waitcnt lgkmcnt(9)
    v_mfma_f32_16x16x32_bf16 v[32:35], v[96:99], v[64:67], 0
    ds_read_b128 v[60:63], v232 offset:6592
    v_mfma_f32_16x16x32_bf16 v[32:35], v[100:103], v[68:71], v[32:35]
    ds_read_b128 v[64:67], v247 offset:6784
    s_waitcnt lgkmcnt(9)
    v_mfma_f32_16x16x32_bf16 v[32:35], v[104:107], v[72:75], v[32:35]
    s_barrier
    ds_read_b128 v[192:195], v228 offset:0
    ds_read_b128 v[196:199], v228 offset:1536
    s_setprio 3
    ds_read_b128 v[68:71], v232 offset:6656
    v_mfma_f32_16x16x32_bf16 v[32:35], v[108:111], v[76:79], v[32:35]
    v_mul_f32 v20, v20, v208
    ds_read_b128 v[72:75], v247 offset:6848
    s_waitcnt lgkmcnt(11)
    v_mfma_f32_16x16x32_bf16 v[32:35], v[112:115], v[80:83], v[32:35]
    v_mul_f32 v21, v21, v209
    ds_read_b128 v[76:79], v232 offset:6720
    v_mfma_f32_16x16x32_bf16 v[32:35], v[116:119], v[84:87], v[32:35]
    v_mul_f32 v22, v22, v210
    ds_read_b128 v[80:83], v247 offset:7168
    s_waitcnt lgkmcnt(11)
    v_mfma_f32_16x16x32_bf16 v[32:35], v[120:123], v[88:91], v[32:35]
    v_mul_f32 v23, v23, v211
    ds_read_b128 v[84:87], v232 offset:7424
    v_mfma_f32_16x16x32_bf16 v[32:35], v[124:127], v[92:95], v[32:35]
    v_cvt_pk_bf16_f32 v186, v20, v21
    ds_read_b128 v[88:91], v247 offset:7232
    s_waitcnt lgkmcnt(11)
    v_mfma_f32_16x16x32_bf16 v[36:39], v[128:131], v[48:51], 0
    v_cvt_pk_bf16_f32 v187, v22, v23
    ds_read_b128 v[92:95], v232 offset:7488
    v_mfma_f32_16x16x32_bf16 v[40:43], v[128:131], v[52:55], 0
    v_mul_f32 v24, v24, v208
    ds_read_b128 v[48:51], v248 offset:128
    s_waitcnt lgkmcnt(11)
    v_mfma_f32_16x16x32_bf16 v[36:39], v[132:135], v[56:59], v[36:39]
    v_mul_f32 v25, v25, v209
    s_waitcnt lgkmcnt(8)
    buffer_store_dwordx4 v[192:195], v229, s[12:15], s40 offen sc1
    buffer_store_dwordx4 v[196:199], v229, s[12:15], s41 offen sc1
    ds_read_b128 v[52:55], v225 offset:384
    v_mfma_f32_16x16x32_bf16 v[40:43], v[132:135], v[60:63], v[40:43]
    v_mul_f32 v26, v26, v210
    s_setprio 2
    ds_read_b128 v[56:59], v248 offset:192
    s_waitcnt lgkmcnt(9)
    v_mfma_f32_16x16x32_bf16 v[36:39], v[136:139], v[64:67], v[36:39]
    v_mul_f32 v27, v27, v211
    v_mul_f32 v204, s63, v32
    ds_read_b128 v[60:63], v225 offset:448
    v_mfma_f32_16x16x32_bf16 v[40:43], v[136:139], v[68:71], v[40:43]
    v_cvt_pk_bf16_f32 v188, v24, v25
    v_mul_f32 v205, s63, v33
    ds_read_b128 v[64:67], v248 offset:640
    s_waitcnt lgkmcnt(9)
    v_mfma_f32_16x16x32_bf16 v[36:39], v[140:143], v[72:75], v[36:39]
    v_cvt_pk_bf16_f32 v189, v26, v27
    v_mul_f32 v206, s63, v34
    ds_read_b128 v[68:71], v225 offset:512
    v_mfma_f32_16x16x32_bf16 v[40:43], v[140:143], v[76:79], v[40:43]
    v_mul_f32 v28, v28, v208
    v_mul_f32 v207, s63, v35
    ds_read_b128 v[72:75], v248 offset:704
    s_waitcnt lgkmcnt(9)
    v_mfma_f32_16x16x32_bf16 v[36:39], v[144:147], v[80:83], v[36:39]
    v_mul_f32 v29, v29, v209
    v_exp_f32 v204, v204
    ds_read_b128 v[76:79], v225 offset:576
    v_mfma_f32_16x16x32_bf16 v[40:43], v[144:147], v[84:87], v[40:43]
    v_mul_f32 v30, v30, v210
    v_exp_f32 v205, v205
    ds_read_b128 v[80:83], v248 offset:1024
    s_waitcnt lgkmcnt(9)
    v_mfma_f32_16x16x32_bf16 v[36:39], v[148:151], v[88:91], v[36:39]
    v_mul_f32 v31, v31, v211
    v_exp_f32 v206, v206
    ds_read_b128 v[84:87], v225 offset:1280
    v_mfma_f32_16x16x32_bf16 v[40:43], v[148:151], v[92:95], v[40:43]
    v_cvt_pk_bf16_f32 v190, v28, v29
    v_exp_f32 v207, v207
    ds_read_b128 v[88:91], v248 offset:1088
    s_waitcnt lgkmcnt(9)
    v_mfma_f32_16x16x32_bf16 v[36:39], v[152:155], v[48:51], v[36:39]
    v_cvt_pk_bf16_f32 v191, v30, v31
    v_add_f32 v204, 1.0, v204
    s_setprio 1
    ds_read_b128 v[92:95], v225 offset:1344
    v_mfma_f32_16x16x32_bf16 v[40:43], v[152:155], v[52:55], v[40:43]
    ds_write_b64 v254, v[184:185] offset:3072
    ds_write_b64 v254, v[186:187] offset:3328
    ds_write_b64 v254, v[188:189] offset:3584
    ds_write_b64 v254, v[190:191] offset:3840
    v_add_f32 v205, 1.0, v205
    s_waitcnt lgkmcnt(12)
    v_mfma_f32_16x16x32_bf16 v[36:39], v[156:159], v[56:59], v[36:39]
    v_add_f32 v206, 1.0, v206
    v_mfma_f32_16x16x32_bf16 v[40:43], v[156:159], v[60:63], v[40:43]
    v_add_f32 v207, 1.0, v207
    s_waitcnt lgkmcnt(10)
    v_mfma_f32_16x16x32_bf16 v[36:39], v[160:163], v[64:67], v[36:39]
    v_rcp_f32 v204, v204
    v_mfma_f32_16x16x32_bf16 v[40:43], v[160:163], v[68:71], v[40:43]
    v_rcp_f32 v205, v205
    s_waitcnt lgkmcnt(8)
    v_mfma_f32_16x16x32_bf16 v[36:39], v[164:167], v[72:75], v[36:39]
    v_rcp_f32 v206, v206
    v_mfma_f32_16x16x32_bf16 v[40:43], v[164:167], v[76:79], v[40:43]
    v_rcp_f32 v207, v207
    s_waitcnt lgkmcnt(6)
    v_mfma_f32_16x16x32_bf16 v[36:39], v[168:171], v[80:83], v[36:39]
    v_cvt_pk_bf16_f32 v176, v32, v33
    s_setprio 0
    v_mfma_f32_16x16x32_bf16 v[40:43], v[168:171], v[84:87], v[40:43]
    v_cvt_pk_bf16_f32 v177, v34, v35
    s_waitcnt lgkmcnt(4)
    v_mfma_f32_16x16x32_bf16 v[36:39], v[172:175], v[88:91], v[36:39]
    ds_write_b64 v255, v[176:177] offset:0
    v_mfma_f32_16x16x32_bf16 v[40:43], v[172:175], v[92:95], v[40:43]
    s_nop 5
    v_mul_f32 v36, v36, v204
    v_mul_f32 v37, v37, v205
    v_mul_f32 v38, v38, v206
    v_mul_f32 v39, v39, v207
    v_cvt_pk_bf16_f32 v178, v36, v37
    v_cvt_pk_bf16_f32 v179, v38, v39
    v_mul_f32 v40, v40, v204
    v_mul_f32 v41, v41, v205
    v_mul_f32 v42, v42, v206
    v_mul_f32 v43, v43, v207
    v_cvt_pk_bf16_f32 v180, v40, v41
    v_cvt_pk_bf16_f32 v181, v42, v43
    ds_write_b64 v246, v[178:179] offset:256
    ds_write_b64 v255, v[180:181] offset:512
    s_waitcnt lgkmcnt(0)
    s_barrier
    ds_read_b128 v[192:195], v228 offset:3072
    ds_read_b128 v[196:199], v228 offset:4608
    ds_read_b128 v[200:203], v249
    s_waitcnt lgkmcnt(1)
    buffer_store_dwordx4 v[192:195], v229, s[12:15], s42 offen sc1
    buffer_store_dwordx4 v[196:199], v229, s[12:15], s43 offen sc1
K2_LASTROW:
    s_add_u32 s59, s20, 32
    s_cmp_ge_u32 s59, s22
    s_cbranch_scc1 K2_FIN
    s_waitcnt lgkmcnt(0)
    buffer_store_dwordx4 v[200:203], v229, s[12:15], s44 offen sc1
K2_FIN:
    s_endpgm
K2_MULTI:
    ds_read_b128 v[48:51], v222 offset:0
    ds_read_b128 v[52:55], v222 offset:64
    ds_read_b128 v[56:59], v222 offset:896
    ds_read_b128 v[60:63], v222 offset:960
    ds_read_b128 v[64:67], v223 offset:0
    ds_read_b128 v[68:71], v223 offset:64
    ds_read_b128 v[72:75], v223 offset:896
    ds_read_b128 v[76:79], v223 offset:960
    ds_read_b128 v[80:83], v222 offset:128
    ds_read_b128 v[84:87], v222 offset:384
    ds_read_b128 v[88:91], v222 offset:256
    s_waitcnt vmcnt(19) lgkmcnt(9)
    v_mfma_f32_16x16x32_bf16 v[0:3], v[96:99], v[48:51], 0
    ds_read_b128 v[92:95], v222 offset:192
    s_waitcnt vmcnt(18)
    v_mfma_f32_16x16x32_bf16 v[0:3], v[100:103], v[52:55], v[0:3]
    ds_read_b128 v[48:51], v222 offset:448
    s_waitcnt vmcnt(17) lgkmcnt(9)
    v_mfma_f32_16x16x32_bf16 v[0:3], v[104:107], v[56:59], v[0:3]
    ds_read_b128 v[52:55], v222 offset:320
    s_waitcnt vmcnt(16)
    v_mfma_f32_16x16x32_bf16 v[0:3], v[108:111], v[60:63], v[0:3]
    ds_read_b128 v[56:59], v222 offset:640
    s_waitcnt vmcnt(15) lgkmcnt(9)
    v_mfma_f32_16x16x32_bf16 v[0:3], v[112:115], v[64:67], v[0:3]
    ds_read_b128 v[60:63], v222 offset:512
    s_waitcnt vmcnt(14)
    v_mfma_f32_16x16x32_bf16 v[0:3], v[116:119], v[68:71], v[0:3]
    ds_read_b128 v[64:67], v222 offset:768
    s_waitcnt vmcnt(13) lgkmcnt(9)
    v_mfma_f32_16x16x32_bf16 v[0:3], v[120:123], v[72:75], v[0:3]
    ds_read_b128 v[68:71], v222 offset:704
    s_waitcnt vmcnt(12)
    v_mfma_f32_16x16x32_bf16 v[0:3], v[124:127], v[76:79], v[0:3]
    ds_read_b128 v[72:75], v222 offset:576
    s_waitcnt vmcnt(11) lgkmcnt(9)
    v_mfma_f32_16x16x32_bf16 v[4:7], v[128:131], v[80:83], 0
    ds_read_b128 v[76:79], v222 offset:832
    v_mfma_f32_16x16x32_bf16 v[8:11], v[128:131], v[84:87], 0
    ds_read_b128 v[80:83], v222 offset:1024
    s_waitcnt lgkmcnt(9)
    v_mfma_f32_16x16x32_bf16 v[12:15], v[128:131], v[88:91], 0
    ds_read_b128 v[84:87], v222 offset:1280
    s_waitcnt vmcnt(10)
    v_mfma_f32_16x16x32_bf16 v[4:7], v[132:135], v[92:95], v[4:7]
    ds_read_b128 v[88:91], v222 offset:1152
    s_waitcnt lgkmcnt(9)
    v_mfma_f32_16x16x32_bf16 v[8:11], v[132:135], v[48:51], v[8:11]
    ds_read_b128 v[92:95], v222 offset:1088
    v_mfma_f32_16x16x32_bf16 v[12:15], v[132:135], v[52:55], v[12:15]
    ds_read_b128 v[48:51], v222 offset:1344
    s_waitcnt vmcnt(9) lgkmcnt(9)
    v_mfma_f32_16x16x32_bf16 v[4:7], v[136:139], v[56:59], v[4:7]
    ds_read_b128 v[52:55], v222 offset:1216
    v_mfma_f32_16x16x32_bf16 v[8:11], v[136:139], v[60:63], v[8:11]
    ds_read_b128 v[56:59], v223 offset:128
    s_waitcnt lgkmcnt(9)
    v_mfma_f32_16x16x32_bf16 v[12:15], v[136:139], v[64:67], v[12:15]
    ds_read_b128 v[60:63], v223 offset:384
    s_waitcnt vmcnt(8)
    v_mfma_f32_16x16x32_bf16 v[4:7], v[140:143], v[68:71], v[4:7]
    ds_read_b128 v[64:67], v223 offset:256
    s_waitcnt lgkmcnt(9)
    v_mfma_f32_16x16x32_bf16 v[8:11], v[140:143], v[72:75], v[8:11]
    ds_read_b128 v[68:71], v223 offset:192
    v_mfma_f32_16x16x32_bf16 v[12:15], v[140:143], v[76:79], v[12:15]
    ds_read_b128 v[72:75], v223 offset:448
    s_waitcnt vmcnt(7) lgkmcnt(9)
    v_mfma_f32_16x16x32_bf16 v[4:7], v[144:147], v[80:83], v[4:7]
    ds_read_b128 v[76:79], v223 offset:320
    v_mfma_f32_16x16x32_bf16 v[8:11], v[144:147], v[84:87], v[8:11]
    ds_read_b128 v[80:83], v223 offset:640
    s_waitcnt lgkmcnt(9)
    v_mfma_f32_16x16x32_bf16 v[12:15], v[144:147], v[88:91], v[12:15]
    ds_read_b128 v[84:87], v223 offset:512
    s_waitcnt vmcnt(6)
    v_mfma_f32_16x16x32_bf16 v[4:7], v[148:151], v[92:95], v[4:7]
    ds_read_b128 v[88:91], v223 offset:768
    s_waitcnt lgkmcnt(9)
    v_mfma_f32_16x16x32_bf16 v[8:11], v[148:151], v[48:51], v[8:11]
    ds_read_b128 v[92:95], v223 offset:704
    v_mfma_f32_16x16x32_bf16 v[12:15], v[148:151], v[52:55], v[12:15]
    ds_read_b128 v[48:51], v223 offset:576
    s_waitcnt vmcnt(5) lgkmcnt(9)
    v_mfma_f32_16x16x32_bf16 v[4:7], v[152:155], v[56:59], v[4:7]
    ds_read_b128 v[52:55], v223 offset:832
    v_mfma_f32_16x16x32_bf16 v[8:11], v[152:155], v[60:63], v[8:11]
    ds_read_b128 v[56:59], v223 offset:1024
    s_waitcnt lgkmcnt(9)
    v_mfma_f32_16x16x32_bf16 v[12:15], v[152:155], v[64:67], v[12:15]
    ds_read_b128 v[60:63], v223 offset:1280
    s_waitcnt vmcnt(4)
    v_mfma_f32_16x16x32_bf16 v[4:7], v[156:159], v[68:71], v[4:7]
    ds_read_b128 v[64:67], v223 offset:1152
    s_waitcnt lgkmcnt(9)
    v_mfma_f32_16x16x32_bf16 v[8:11], v[156:159], v[72:75], v[8:11]
    ds_read_b128 v[68:71], v223 offset:1088
    v_mfma_f32_16x16x32_bf16 v[12:15], v[156:159], v[76:79], v[12:15]
    ds_read_b128 v[72:75], v223 offset:1344
    s_waitcnt vmcnt(3) lgkmcnt(9)
    v_mfma_f32_16x16x32_bf16 v[4:7], v[160:163], v[80:83], v[4:7]
    ds_read_b128 v[76:79], v223 offset:1216
    v_mfma_f32_16x16x32_bf16 v[8:11], v[160:163], v[84:87], v[8:11]
    ds_read_b128 v[80:83], v222 offset:3072
    s_waitcnt lgkmcnt(9)
    v_mfma_f32_16x16x32_bf16 v[12:15], v[160:163], v[88:91], v[12:15]
    ds_read_b128 v[84:87], v222 offset:3136
    s_waitcnt vmcnt(2)
    v_mfma_f32_16x16x32_bf16 v[4:7], v[164:167], v[92:95], v[4:7]
    ds_read_b128 v[88:91], v222 offset:3968
    s_waitcnt lgkmcnt(9)
    v_mfma_f32_16x16x32_bf16 v[8:11], v[164:167], v[48:51], v[8:11]
    ds_read_b128 v[92:95], v222 offset:4032
    v_mfma_f32_16x16x32_bf16 v[12:15], v[164:167], v[52:55], v[12:15]
    ds_read_b128 v[48:51], v223 offset:38400
    s_waitcnt vmcnt(1) lgkmcnt(9)
    v_mfma_f32_16x16x32_bf16 v[4:7], v[168:171], v[56:59], v[4:7]
    ds_read_b128 v[52:55], v223 offset:38464
    v_mfma_f32_16x16x32_bf16 v[8:11], v[168:171], v[60:63], v[8:11]
    ds_read_b128 v[56:59], v223 offset:39296
    s_waitcnt lgkmcnt(9)
    v_mfma_f32_16x16x32_bf16 v[12:15], v[168:171], v[64:67], v[12:15]
    ds_read_b128 v[60:63], v223 offset:39360
    s_waitcnt vmcnt(0)
    v_mfma_f32_16x16x32_bf16 v[4:7], v[172:175], v[68:71], v[4:7]
    ds_read_b128 v[64:67], v222 offset:3200
    s_waitcnt lgkmcnt(9)
    v_mfma_f32_16x16x32_bf16 v[8:11], v[172:175], v[72:75], v[8:11]
    ds_read_b128 v[68:71], v222 offset:3456
    v_mfma_f32_16x16x32_bf16 v[12:15], v[172:175], v[76:79], v[12:15]
    ds_read_b128 v[72:75], v222 offset:3328
    s_waitcnt lgkmcnt(9)
    v_mfma_f32_16x16x32_bf16 v[16:19], v[96:99], v[80:83], 0
    ds_read_b128 v[76:79], v222 offset:3264
    v_mfma_f32_16x16x32_bf16 v[16:19], v[100:103], v[84:87], v[16:19]
    ds_read_b128 v[80:83], v222 offset:3520
    s_waitcnt lgkmcnt(9)
    v_mfma_f32_16x16x32_bf16 v[16:19], v[104:107], v[88:91], v[16:19]
    ds_read_b128 v[84:87], v222 offset:3392
    v_mfma_f32_16x16x32_bf16 v[16:19], v[108:111], v[92:95], v[16:19]
    ds_read_b128 v[88:91], v222 offset:3712
    s_waitcnt lgkmcnt(9)
    v_mfma_f32_16x16x32_bf16 v[16:19], v[112:115], v[48:51], v[16:19]
    ds_read_b128 v[92:95], v222 offset:3584
    v_mfma_f32_16x16x32_bf16 v[16:19], v[116:119], v[52:55], v[16:19]
    ds_read_b128 v[48:51], v222 offset:3840
    s_waitcnt lgkmcnt(9)
    v_mfma_f32_16x16x32_bf16 v[16:19], v[120:123], v[56:59], v[16:19]
    ds_read_b128 v[52:55], v222 offset:3776
    v_mfma_f32_16x16x32_bf16 v[16:19], v[124:127], v[60:63], v[16:19]
    ds_read_b128 v[56:59], v222 offset:3648
    s_waitcnt lgkmcnt(9)
    v_mfma_f32_16x16x32_bf16 v[20:23], v[128:131], v[64:67], 0
    ds_read_b128 v[60:63], v222 offset:3904
    v_mfma_f32_16x16x32_bf16 v[24:27], v[128:131], v[68:71], 0
    ds_read_b128 v[64:67], v222 offset:4096
    s_waitcnt lgkmcnt(9)
    v_mfma_f32_16x16x32_bf16 v[28:31], v[128:131], v[72:75], 0
    ds_read_b128 v[68:71], v222 offset:4352
    v_mfma_f32_16x16x32_bf16 v[20:23], v[132:135], v[76:79], v[20:23]
    ds_read_b128 v[72:75], v222 offset:4224
    s_waitcnt lgkmcnt(9)
    v_mfma_f32_16x16x32_bf16 v[24:27], v[132:135], v[80:83], v[24:27]
    ds_read_b128 v[76:79], v222 offset:4160
    v_mfma_f32_16x16x32_bf16 v[28:31], v[132:135], v[84:87], v[28:31]
    ds_read_b128 v[80:83], v222 offset:4416
    s_waitcnt lgkmcnt(9)
    v_mfma_f32_16x16x32_bf16 v[20:23], v[136:139], v[88:91], v[20:23]
    ds_read_b128 v[84:87], v222 offset:4288
    v_mfma_f32_16x16x32_bf16 v[24:27], v[136:139], v[92:95], v[24:27]
    ds_read_b128 v[88:91], v223 offset:38528
    s_waitcnt lgkmcnt(9)
    v_mfma_f32_16x16x32_bf16 v[28:31], v[136:139], v[48:51], v[28:31]
    ds_read_b128 v[92:95], v223 offset:38784
    v_mfma_f32_16x16x32_bf16 v[20:23], v[140:143], v[52:55], v[20:23]
    ds_read_b128 v[48:51], v223 offset:38656
    s_waitcnt lgkmcnt(9)
    v_mfma_f32_16x16x32_bf16 v[24:27], v[140:143], v[56:59], v[24:27]
    ds_read_b128 v[52:55], v223 offset:38592
    v_mfma_f32_16x16x32_bf16 v[28:31], v[140:143], v[60:63], v[28:31]
    ds_read_b128 v[56:59], v223 offset:38848
    s_waitcnt lgkmcnt(9)
    v_mfma_f32_16x16x32_bf16 v[20:23], v[144:147], v[64:67], v[20:23]
    ds_read_b128 v[60:63], v223 offset:38720
    v_mfma_f32_16x16x32_bf16 v[24:27], v[144:147], v[68:71], v[24:27]
    ds_read_b128 v[64:67], v223 offset:39040
    s_waitcnt lgkmcnt(9)
    v_mfma_f32_16x16x32_bf16 v[28:31], v[144:147], v[72:75], v[28:31]
    ds_read_b128 v[68:71], v223 offset:38912
    v_mfma_f32_16x16x32_bf16 v[20:23], v[148:151], v[76:79], v[20:23]
    ds_read_b128 v[72:75], v223 offset:39168
    s_waitcnt lgkmcnt(9)
    v_mfma_f32_16x16x32_bf16 v[24:27], v[148:151], v[80:83], v[24:27]
    ds_read_b128 v[76:79], v223 offset:39104
    v_mfma_f32_16x16x32_bf16 v[28:31], v[148:151], v[84:87], v[28:31]
    ds_read_b128 v[80:83], v223 offset:38976
    s_waitcnt lgkmcnt(9)
    v_mfma_f32_16x16x32_bf16 v[20:23], v[152:155], v[88:91], v[20:23]
    ds_read_b128 v[84:87], v223 offset:39232
    v_mfma_f32_16x16x32_bf16 v[24:27], v[152:155], v[92:95], v[24:27]
    ds_read_b128 v[88:91], v223 offset:39424
    s_waitcnt lgkmcnt(9)
    v_mfma_f32_16x16x32_bf16 v[28:31], v[152:155], v[48:51], v[28:31]
    ds_read_b128 v[92:95], v223 offset:39680
    v_mfma_f32_16x16x32_bf16 v[20:23], v[156:159], v[52:55], v[20:23]
    ds_read_b128 v[48:51], v223 offset:39552
    s_waitcnt lgkmcnt(9)
    v_mfma_f32_16x16x32_bf16 v[24:27], v[156:159], v[56:59], v[24:27]
    ds_read_b128 v[52:55], v223 offset:39488
    v_mfma_f32_16x16x32_bf16 v[28:31], v[156:159], v[60:63], v[28:31]
    ds_read_b128 v[56:59], v223 offset:39744
    s_waitcnt lgkmcnt(9)
    v_mfma_f32_16x16x32_bf16 v[20:23], v[160:163], v[64:67], v[20:23]
    ds_read_b128 v[60:63], v223 offset:39616
    v_mfma_f32_16x16x32_bf16 v[24:27], v[160:163], v[68:71], v[24:27]
    ds_read_b128 v[64:67], v232 offset:6144
    s_waitcnt lgkmcnt(9)
    v_mfma_f32_16x16x32_bf16 v[28:31], v[160:163], v[72:75], v[28:31]
    ds_read_b128 v[68:71], v232 offset:6208
    v_mfma_f32_16x16x32_bf16 v[20:23], v[164:167], v[76:79], v[20:23]
    ds_read_b128 v[72:75], v232 offset:7040
    s_waitcnt lgkmcnt(9)
    v_mfma_f32_16x16x32_bf16 v[24:27], v[164:167], v[80:83], v[24:27]
    ds_read_b128 v[76:79], v232 offset:7104
    v_mfma_f32_16x16x32_bf16 v[28:31], v[164:167], v[84:87], v[28:31]
    ds_read_b128 v[80:83], v225 offset:0
    s_waitcnt lgkmcnt(9)
    v_mfma_f32_16x16x32_bf16 v[20:23], v[168:171], v[88:91], v[20:23]
    ds_read_b128 v[84:87], v225 offset:64
    v_mfma_f32_16x16x32_bf16 v[24:27], v[168:171], v[92:95], v[24:27]
    ds_read_b128 v[88:91], v225 offset:896
    s_waitcnt lgkmcnt(9)
    v_mfma_f32_16x16x32_bf16 v[28:31], v[168:171], v[48:51], v[28:31]
    ds_read_b128 v[92:95], v225 offset:960
    v_mfma_f32_16x16x32_bf16 v[20:23], v[172:175], v[52:55], v[20:23]
    ds_read_b128 v[48:51], v247 offset:6272
    s_waitcnt lgkmcnt(9)
    v_mfma_f32_16x16x32_bf16 v[24:27], v[172:175], v[56:59], v[24:27]
    ds_read_b128 v[52:55], v232 offset:6528
    v_mfma_f32_16x16x32_bf16 v[28:31], v[172:175], v[60:63], v[28:31]
    ds_read_b128 v[56:59], v247 offset:6336
    s_waitcnt lgkmcnt(9)
    v_mfma_f32_16x16x32_bf16 v[32:35], v[96:99], v[64:67], 0
    ds_read_b128 v[60:63], v232 offset:6592
    v_mfma_f32_16x16x32_bf16 v[32:35], v[100:103], v[68:71], v[32:35]
    ds_read_b128 v[64:67], v247 offset:6784
    s_waitcnt lgkmcnt(9)
    v_mfma_f32_16x16x32_bf16 v[32:35], v[104:107], v[72:75], v[32:35]
    ds_read_b128 v[68:71], v232 offset:6656
    v_mfma_f32_16x16x32_bf16 v[32:35], v[108:111], v[76:79], v[32:35]
    ds_read_b128 v[72:75], v247 offset:6848
    s_waitcnt lgkmcnt(9)
    v_mfma_f32_16x16x32_bf16 v[32:35], v[112:115], v[80:83], v[32:35]
    ds_read_b128 v[76:79], v232 offset:6720
    v_mfma_f32_16x16x32_bf16 v[32:35], v[116:119], v[84:87], v[32:35]
    ds_read_b128 v[80:83], v247 offset:7168
    s_waitcnt lgkmcnt(9)
    v_mfma_f32_16x16x32_bf16 v[32:35], v[120:123], v[88:91], v[32:35]
    ds_read_b128 v[84:87], v232 offset:7424
    v_mfma_f32_16x16x32_bf16 v[32:35], v[124:127], v[92:95], v[32:35]
    ds_read_b128 v[88:91], v247 offset:7232
    s_waitcnt lgkmcnt(9)
    v_mfma_f32_16x16x32_bf16 v[36:39], v[128:131], v[48:51], 0
    ds_read_b128 v[92:95], v232 offset:7488
    v_mfma_f32_16x16x32_bf16 v[40:43], v[128:131], v[52:55], 0
    ds_read_b128 v[48:51], v248 offset:128
    s_waitcnt lgkmcnt(9)
    v_mfma_f32_16x16x32_bf16 v[36:39], v[132:135], v[56:59], v[36:39]
    ds_read_b128 v[52:55], v225 offset:384
    v_mfma_f32_16x16x32_bf16 v[40:43], v[132:135], v[60:63], v[40:43]
    ds_read_b128 v[56:59], v248 offset:192
    s_waitcnt lgkmcnt(9)
    v_mfma_f32_16x16x32_bf16 v[36:39], v[136:139], v[64:67], v[36:39]
    ds_read_b128 v[60:63], v225 offset:448
    v_mfma_f32_16x16x32_bf16 v[40:43], v[136:139], v[68:71], v[40:43]
    ds_read_b128 v[64:67], v248 offset:640
    s_waitcnt lgkmcnt(9)
    v_mfma_f32_16x16x32_bf16 v[36:39], v[140:143], v[72:75], v[36:39]
    ds_read_b128 v[68:71], v225 offset:512
    v_mfma_f32_16x16x32_bf16 v[40:43], v[140:143], v[76:79], v[40:43]
    ds_read_b128 v[72:75], v248 offset:704
    s_waitcnt lgkmcnt(9)
    v_mfma_f32_16x16x32_bf16 v[36:39], v[144:147], v[80:83], v[36:39]
    ds_read_b128 v[76:79], v225 offset:576
    v_mfma_f32_16x16x32_bf16 v[40:43], v[144:147], v[84:87], v[40:43]
    ds_read_b128 v[80:83], v248 offset:1024
    s_waitcnt lgkmcnt(9)
    v_mfma_f32_16x16x32_bf16 v[36:39], v[148:151], v[88:91], v[36:39]
    ds_read_b128 v[84:87], v225 offset:1280
    v_mfma_f32_16x16x32_bf16 v[40:43], v[148:151], v[92:95], v[40:43]
    ds_read_b128 v[88:91], v248 offset:1088
    s_waitcnt lgkmcnt(9)
    v_mfma_f32_16x16x32_bf16 v[36:39], v[152:155], v[48:51], v[36:39]
    ds_read_b128 v[92:95], v225 offset:1344
    v_mfma_f32_16x16x32_bf16 v[40:43], v[152:155], v[52:55], v[40:43]
    s_waitcnt lgkmcnt(8)
    v_mfma_f32_16x16x32_bf16 v[36:39], v[156:159], v[56:59], v[36:39]
    v_mfma_f32_16x16x32_bf16 v[40:43], v[156:159], v[60:63], v[40:43]
    s_waitcnt lgkmcnt(6)
    v_mfma_f32_16x16x32_bf16 v[36:39], v[160:163], v[64:67], v[36:39]
    v_mfma_f32_16x16x32_bf16 v[40:43], v[160:163], v[68:71], v[40:43]
    s_waitcnt lgkmcnt(4)
    v_mfma_f32_16x16x32_bf16 v[36:39], v[164:167], v[72:75], v[36:39]
    v_mfma_f32_16x16x32_bf16 v[40:43], v[164:167], v[76:79], v[40:43]
    s_waitcnt lgkmcnt(2)
    v_mfma_f32_16x16x32_bf16 v[36:39], v[168:171], v[80:83], v[36:39]
    v_mfma_f32_16x16x32_bf16 v[40:43], v[168:171], v[84:87], v[40:43]
    s_waitcnt lgkmcnt(0)
    v_mfma_f32_16x16x32_bf16 v[36:39], v[172:175], v[88:91], v[36:39]
    v_mfma_f32_16x16x32_bf16 v[40:43], v[172:175], v[92:95], v[40:43]
    s_lshl_b32 s60, s54, 9
    s_lshl_b32 s61, s20, 6
    s_add_u32 s60, s60, s61
    s_mul_i32 s60, s60, 192
    s_add_u32 s60, s60, 10485760
    v_mul_u32_u24 v227, 96, v252
    s_cmp_lg_u32 s28, 0
    s_cbranch_scc1 K2_NOACC
    buffer_load_dwordx4 v[48:51], v227, s[8:11], s60 offen offset:0
    buffer_load_dwordx4 v[52:55], v227, s[8:11], s60 offen offset:16
    buffer_load_dwordx4 v[56:59], v227, s[8:11], s60 offen offset:32
    buffer_load_dwordx4 v[60:63], v227, s[8:11], s60 offen offset:48
    buffer_load_dwordx4 v[64:67], v227, s[8:11], s60 offen offset:64
    buffer_load_dwordx4 v[68:71], v227, s[8:11], s60 offen offset:80
    buffer_load_dwordx4 v[72:75], v227, s[8:11], s60 offen offset:96
    buffer_load_dwordx4 v[76:79], v227, s[8:11], s60 offen offset:112
    buffer_load_dwordx4 v[80:83], v227, s[8:11], s60 offen offset:128
    buffer_load_dwordx4 v[84:87], v227, s[8:11], s60 offen offset:144
    buffer_load_dwordx4 v[88:91], v227, s[8:11], s60 offen offset:160
    s_waitcnt vmcnt(0)
    v_add_f32 v0, v0, v48
    v_add_f32 v1, v1, v49
    v_add_f32 v2, v2, v50
    v_add_f32 v3, v3, v51
    v_add_f32 v4, v4, v52
    v_add_f32 v5, v5, v53
    v_add_f32 v6, v6, v54
    v_add_f32 v7, v7, v55
    v_add_f32 v8, v8, v56
    v_add_f32 v9, v9, v57
    v_add_f32 v10, v10, v58
    v_add_f32 v11, v11, v59
    v_add_f32 v12, v12, v60
    v_add_f32 v13, v13, v61
    v_add_f32 v14, v14, v62
    v_add_f32 v15, v15, v63
    v_add_f32 v16, v16, v64
    v_add_f32 v17, v17, v65
    v_add_f32 v18, v18, v66
    v_add_f32 v19, v19, v67
    v_add_f32 v20, v20, v68
    v_add_f32 v21, v21, v69
    v_add_f32 v22, v22, v70
    v_add_f32 v23, v23, v71
    v_add_f32 v24, v24, v72
    v_add_f32 v25, v25, v73
    v_add_f32 v26, v26, v74
    v_add_f32 v27, v27, v75
    v_add_f32 v28, v28, v76
    v_add_f32 v29, v29, v77
    v_add_f32 v30, v30, v78
    v_add_f32 v31, v31, v79
    v_add_f32 v32, v32, v80
    v_add_f32 v33, v33, v81
    v_add_f32 v34, v34, v82
    v_add_f32 v35, v35, v83
    v_add_f32 v36, v36, v84
    v_add_f32 v37, v37, v85
    v_add_f32 v38, v38, v86
    v_add_f32 v39, v39, v87
    v_add_f32 v40, v40, v88
    v_add_f32 v41, v41, v89
    v_add_f32 v42, v42, v90
    v_add_f32 v43, v43, v91
K2_NOACC:
    s_barrier
    s_cmp_eq_u32 s55, 0
    s_cbranch_scc1 K2_SPILL
    s_bfe_u32 s60, s20, 0x10002
    s_lshl_b32 s60, s60, 4
    s_add_u32 s59, s59, s60
    v_add_u32 v228, s59, v229
    s_mul_i32 s60, s20, 2400
    s_add_u32 s60, s60, 65536
    v_add_u32 v249, s60, v229
    s_mov_b32 s63, 0xbfb8aa3b
    s_add_u32 s40, s20, s21
    s_lshl_b32 s40, s40, 10
    s_add_u32 s41, s40, 8192
    s_add_u32 s42, s40, 16384
    s_add_u32 s43, s40, 24576
    s_add_u32 s44, s40, 32768
    v_mul_f32 v204, s63, v0
    v_mul_f32 v205, s63, v1
    v_mul_f32 v206, s63, v2
    v_mul_f32 v207, s63, v3
    v_exp_f32 v204, v204
    v_exp_f32 v205, v205
    v_exp_f32 v206, v206
    v_exp_f32 v207, v207
    v_add_f32 v204, 1.0, v204
    v_add_f32 v205, 1.0, v205
    v_add_f32 v206, 1.0, v206
    v_add_f32 v207, 1.0, v207
    v_rcp_f32 v204, v204
    v_rcp_f32 v205, v205
    v_rcp_f32 v206, v206
    v_rcp_f32 v207, v207
    v_cvt_pk_bf16_f32 v176, v0, v1
    v_cvt_pk_bf16_f32 v177, v2, v3
    v_mul_f32 v4, v4, v204
    v_mul_f32 v5, v5, v205
    v_mul_f32 v6, v6, v206
    v_mul_f32 v7, v7, v207
    v_cvt_pk_bf16_f32 v178, v4, v5
    v_cvt_pk_bf16_f32 v179, v6, v7
    v_mul_f32 v8, v8, v204
    v_mul_f32 v9, v9, v205
    v_mul_f32 v10, v10, v206
    v_mul_f32 v11, v11, v207
    v_cvt_pk_bf16_f32 v180, v8, v9
    v_cvt_pk_bf16_f32 v181, v10, v11
    v_mul_f32 v12, v12, v204
    v_mul_f32 v13, v13, v205
    v_mul_f32 v14, v14, v206
    v_mul_f32 v15, v15, v207
    v_cvt_pk_bf16_f32 v182, v12, v13
    v_cvt_pk_bf16_f32 v183, v14, v15
    ds_write_b64 v254, v[176:177] offset:0
    ds_write_b64 v254, v[178:179] offset:256
    ds_write_b64 v254, v[180:181] offset:512
    ds_write_b64 v254, v[182:183] offset:768
    s_waitcnt lgkmcnt(0)
    s_barrier
    ds_read_b128 v[192:195], v228 offset:0
    ds_read_b128 v[196:199], v228 offset:1536
    s_waitcnt lgkmcnt(0)
    buffer_store_dwordx4 v[192:195], v229, s[12:15], s40 offen sc1
    buffer_store_dwordx4 v[196:199], v229, s[12:15], s41 offen sc1
    v_mul_f32 v208, s63, v16
    v_mul_f32 v209, s63, v17
    v_mul_f32 v210, s63, v18
    v_mul_f32 v211, s63, v19
    v_exp_f32 v208, v208
    v_exp_f32 v209, v209
    v_exp_f32 v210, v210
    v_exp_f32 v211, v211
    v_add_f32 v208, 1.0, v208
    v_add_f32 v209, 1.0, v209
    v_add_f32 v210, 1.0, v210
    v_add_f32 v211, 1.0, v211
    v_rcp_f32 v208, v208
    v_rcp_f32 v209, v209
    v_rcp_f32 v210, v210
    v_rcp_f32 v211, v211
    v_cvt_pk_bf16_f32 v184, v16, v17
    v_cvt_pk_bf16_f32 v185, v18, v19
    v_mul_f32 v20, v20, v208
    v_mul_f32 v21, v21, v209
    v_mul_f32 v22, v22, v210
    v_mul_f32 v23, v23, v211
    v_cvt_pk_bf16_f32 v186, v20, v21
    v_cvt_pk_bf16_f32 v187, v22, v23
    v_mul_f32 v24, v24, v208
    v_mul_f32 v25, v25, v209
    v_mul_f32 v26, v26, v210
    v_mul_f32 v27, v27, v211
    v_cvt_pk_bf16_f32 v188, v24, v25
    v_cvt_pk_bf16_f32 v189, v26, v27
    v_mul_f32 v28, v28, v208
    v_mul_f32 v29, v29, v209
    v_mul_f32 v30, v30, v210
    v_mul_f32 v31, v31, v211
    v_cvt_pk_bf16_f32 v190, v28, v29
    v_cvt_pk_bf16_f32 v191, v30, v31
    ds_write_b64 v254, v[184:185] offset:3072
    ds_write_b64 v254, v[186:187] offset:3328
    ds_write_b64 v254, v[188:189] offset:3584
    ds_write_b64 v254, v[190:191] offset:3840
    s_waitcnt lgkmcnt(0)
    s_barrier
    ds_read_b128 v[192:195], v228 offset:3072
    ds_read_b128 v[196:199], v228 offset:4608
    s_waitcnt lgkmcnt(0)
    buffer_store_dwordx4 v[192:195], v229, s[12:15], s42 offen sc1
    buffer_store_dwordx4 v[196:199], v229, s[12:15], s43 offen sc1
    v_mul_f32 v204, s63, v32
    v_mul_f32 v205, s63, v33
    v_mul_f32 v206, s63, v34
    v_mul_f32 v207, s63, v35
    v_exp_f32 v204, v204
    v_exp_f32 v205, v205
    v_exp_f32 v206, v206
    v_exp_f32 v207, v207
    v_add_f32 v204, 1.0, v204
    v_add_f32 v205, 1.0, v205
    v_add_f32 v206, 1.0, v206
    v_add_f32 v207, 1.0, v207
    v_rcp_f32 v204, v204
    v_rcp_f32 v205, v205
    v_rcp_f32 v206, v206
    v_rcp_f32 v207, v207
    v_cvt_pk_bf16_f32 v176, v32, v33
    v_cvt_pk_bf16_f32 v177, v34, v35
    v_mul_f32 v36, v36, v204
    v_mul_f32 v37, v37, v205
    v_mul_f32 v38, v38, v206
    v_mul_f32 v39, v39, v207
    v_cvt_pk_bf16_f32 v178, v36, v37
    v_cvt_pk_bf16_f32 v179, v38, v39
    v_mul_f32 v40, v40, v204
    v_mul_f32 v41, v41, v205
    v_mul_f32 v42, v42, v206
    v_mul_f32 v43, v43, v207
    v_cvt_pk_bf16_f32 v180, v40, v41
    v_cvt_pk_bf16_f32 v181, v42, v43
    ds_write_b64 v255, v[176:177] offset:0
    ds_write_b64 v246, v[178:179] offset:256
    ds_write_b64 v255, v[180:181] offset:512
    s_waitcnt lgkmcnt(0)
    s_barrier
    ds_read_b128 v[200:203], v249
    s_branch K2_LASTROW
K2_SPILL:
    buffer_store_dwordx4 v[0:3], v227, s[8:11], s60 offen offset:0
    buffer_store_dwordx4 v[4:7], v227, s[8:11], s60 offen offset:16
    buffer_store_dwordx4 v[8:11], v227, s[8:11], s60 offen offset:32
    buffer_store_dwordx4 v[12:15], v227, s[8:11], s60 offen offset:48
    buffer_store_dwordx4 v[16:19], v227, s[8:11], s60 offen offset:64
    buffer_store_dwordx4 v[20:23], v227, s[8:11], s60 offen offset:80
    buffer_store_dwordx4 v[24:27], v227, s[8:11], s60 offen offset:96
    buffer_store_dwordx4 v[28:31], v227, s[8:11], s60 offen offset:112
    buffer_store_dwordx4 v[32:35], v227, s[8:11], s60 offen offset:128
    buffer_store_dwordx4 v[36:39], v227, s[8:11], s60 offen offset:144
    buffer_store_dwordx4 v[40:43], v227, s[8:11], s60 offen offset:160
    s_mov_b32 s28, 0
    s_waitcnt vmcnt(0)
    s_cmp_lt_u32 s24, s25
    s_cbranch_scc1 K2_LOAD
    s_add_u32 s23, s23, 20
    s_branch K2_WINDOW
K2_WINDOW:
    s_mov_b32 s24, 0
    s_mov_b32 s25, 1
K2_LOAD:
    v_mbcnt_lo_u32_b32 v176, -1, 0
    v_mbcnt_hi_u32_b32 v176, -1, v176
    s_lshl_b32 s58, s20, 6
    v_add_u32 v177, s58, v176
    v_lshlrev_b32 v70, 4, v176
    s_mov_b32 s58, 7110656
    buffer_load_dwordx4 v[96:99], v70, s[8:11], s58 offen offset:0 sc1
    buffer_load_dwordx4 v[100:103], v70, s[8:11], s58 offen offset:1024 sc1
    buffer_load_dwordx4 v[104:107], v70, s[8:11], s58 offen offset:2048 sc1
    buffer_load_dwordx4 v[108:111], v70, s[8:11], s58 offen offset:3072 sc1
    s_mov_b32 s58, 7114752
    buffer_load_dwordx4 v[112:115], v70, s[8:11], s58 offen offset:0 sc1
    buffer_load_dwordx4 v[116:119], v70, s[8:11], s58 offen offset:1024 sc1
    buffer_load_dwordx4 v[120:123], v70, s[8:11], s58 offen offset:2048 sc1
    buffer_load_dwordx4 v[124:127], v70, s[8:11], s58 offen offset:3072 sc1
    s_mov_b32 s58, 7118848
    buffer_load_dwordx4 v[128:131], v70, s[8:11], s58 offen offset:0 sc1
    buffer_load_dwordx4 v[132:135], v70, s[8:11], s58 offen offset:1024 sc1
    buffer_load_dwordx4 v[136:139], v70, s[8:11], s58 offen offset:2048 sc1
    buffer_load_dwordx4 v[140:143], v70, s[8:11], s58 offen offset:3072 sc1
    s_mov_b32 s58, 7122944
    buffer_load_dwordx4 v[144:147], v70, s[8:11], s58 offen offset:0 sc1
    buffer_load_dwordx4 v[148:151], v70, s[8:11], s58 offen offset:1024 sc1
    buffer_load_dwordx4 v[152:155], v70, s[8:11], s58 offen offset:2048 sc1
    buffer_load_dwordx4 v[156:159], v70, s[8:11], s58 offen offset:3072 sc1
    s_mov_b32 s58, 7127040
    buffer_load_dwordx4 v[160:163], v70, s[8:11], s58 offen offset:0 sc1
    buffer_load_dwordx4 v[164:167], v70, s[8:11], s58 offen offset:1024 sc1
    buffer_load_dwordx4 v[168:171], v70, s[8:11], s58 offen offset:2048 sc1
    buffer_load_dwordx4 v[172:175], v70, s[8:11], s58 offen offset:3072 sc1
    v_mul_u32_u24 v76, 437, v177
    v_lshrrev_b32 v76, 16, v76
    v_mul_u32_u24 v76, 150, v76
    v_sub_u32 v76, v177, v76
    v_mov_b32 v80, -1
    v_mov_b32 v77, 1.0
    v_cmp_gt_u32 vcc, 48, v76
    v_lshlrev_b32 v78, 4, v177
    v_add_u32 v78, 65536, v78
    v_cndmask_b32 v80, v80, 0, vcc
    v_cmp_gt_u32 vcc, 12, v76
    v_add_u32 v79, 64800, v78
    s_nop 0
    v_cndmask_b32 v80, v80, v77, vcc
    v_cmp_gt_u32 vcc, 450, v177
    v_mov_b32 v81, v80
    v_mov_b32 v82, v80
    v_mov_b32 v83, v80
    s_mov_b64 exec, vcc
    ds_write_b128 v78, v[80:83] offset:0
    ds_write_b128 v78, v[80:83] offset:7200
    ds_write_b128 v78, v[80:83] offset:14400
    ds_write_b128 v78, v[80:83] offset:21600
    ds_write_b128 v78, v[80:83] offset:28800
    ds_write_b128 v78, v[80:83] offset:36000
    ds_write_b128 v78, v[80:83] offset:43200
    ds_write_b128 v78, v[80:83] offset:50400
    ds_write_b128 v78, v[80:83] offset:57600
    ds_write_b128 v79, v[80:83] offset:0
    ds_write_b128 v79, v[80:83] offset:7200
    ds_write_b128 v79, v[80:83] offset:14400
    ds_write_b128 v79, v[80:83] offset:21600
    v_cmp_gt_u32 vcc, 268, v177
    s_nop 0
    s_cbranch_vccz K2_NOCL
    s_mov_b64 exec, vcc
    ds_write_b128 v79, v[80:83] offset:28800
K2_NOCL:
    s_mov_b64 exec, -1
    s_cmp_lg_u32 s20, 7
    s_cbranch_scc1 K2_NOH
    v_mov_b32 v76, 0
    v_mov_b32 v77, -1
    v_lshlrev_b32 v78, 2, v176
    v_add_u32 v78, 163424, v78
    s_mov_b64 exec, 0x1ff
    ds_write_b32 v78, v76 offset:192
    s_mov_b64 exec, 0xff
    ds_write_b32 v78, v77 offset:256
    s_mov_b64 exec, -1
    s_cmp_lg_u32 s24, 0
    s_cbranch_scc1 K2_NOH
    s_mov_b32 exec_hi, 0xffff
    ds_write_b32 v78, v76
    s_mov_b64 exec, 0x3f
    ds_write_b32 v78, v76 offset:228
    s_mov_b64 exec, -1
K2_NOH:
    s_waitcnt lgkmcnt(0)
    s_barrier
    s_branch K2_CELLS
K2_LD_GEN:
    s_mov_b64 exec, s[42:43]
    s_cbranch_execz K2_LD_DONE
    buffer_load_dwordx4 v[4:7], v182, s[8:11], 0 offen sc1
    s_mov_b64 exec, s[44:45]
    s_cbranch_execz K2_LD_DONE
    buffer_load_dwordx4 v[8:11], v183, s[8:11], 0 offen sc1
    s_mov_b64 exec, s[46:47]
    s_cbranch_execz K2_LD_DONE
    buffer_load_dwordx4 v[12:15], v184, s[8:11], 0 offen sc1
    s_mov_b64 exec, s[48:49]
    s_cbranch_execz K2_LD_DONE
    buffer_load_dwordx4 v[16:19], v181, s[8:11], 0 offen offset:128 sc1
    s_mov_b64 exec, s[50:51]
    s_cbranch_execz K2_LD_DONE
    buffer_load_dwordx4 v[20:23], v181, s[8:11], 0 offen offset:160 sc1
    s_mov_b64 exec, s[90:91]
    s_cbranch_execz K2_LD_DONE
    buffer_load_dwordx4 v[24:27], v181, s[8:11], 0 offen offset:192 sc1
    s_mov_b64 exec, s[92:93]
    s_cbranch_execz K2_LD_DONE
    buffer_load_dwordx4 v[28:31], v181, s[8:11], 0 offen offset:224 sc1
    s_mov_b64 exec, s[94:95]
    s_cbranch_execz K2_LD_DONE
    buffer_load_dwordx4 v[32:35], v181, s[8:11], 0 offen offset:256 sc1
    s_mov_b64 exec, s[96:97]
    s_cbranch_execz K2_LD_DONE
    buffer_load_dwordx4 v[36:39], v181, s[8:11], 0 offen offset:288 sc1
    s_branch K2_LD_DONE
K2_FLGLD:
    buffer_load_dwordx4 v[84:87], v72, s[8:11], s64 offen sc1
    s_mov_b32 s62, 0
    s_branch K2_FLGL2
K2_FLGCK:
    s_cmp_lg_u32 s24, 0
    s_cbranch_scc1 K2_FLGOK
    s_waitcnt vmcnt(0)
K2_FLGW:
    v_xor_b32 v84, s2, v84
    v_xor_b32 v85, s2, v85
    v_xor_b32 v86, s2, v86
    v_xor_b32 v87, s2, v87
    v_or3_b32 v84, v84, v85, v86
    v_or_b32 v84, v84, v87
    v_cmp_ne_u32 vcc, 0, v84
    s_nop 0
    s_cbranch_vccz K2_FLGY
    s_sub_u32 s60, s60, 1
    s_cbranch_scc1 K2_END
    buffer_load_dwordx4 v[84:87], v72, s[8:11], s64 offen sc1
    s_waitcnt vmcnt(0)
    s_branch K2_FLGW
K2_FLGY:
    s_cmp_lg_u32 s54, 0
    s_cbranch_scc1 K2_FLGOK
    v_mov_b32 v84, s2
    v_mov_b32 v85, 7178240
    s_mov_b64 exec, 1
    buffer_store_dword v84, v85, s[8:11], 0 offen sc1
    s_mov_b64 exec, -1
    s_branch K2_FLGOK
K2_RT0:
    s_sub_u32 s60, s60, 1
    s_cbranch_scc1 K2_END
    buffer_load_dwordx4 v[0:3], v181, s[8:11], 0 offen offset:0 sc1
    s_waitcnt vmcnt(0)
    s_branch K2_CK0
K2_RT1:
    s_sub_u32 s60, s60, 1
    s_cbranch_scc1 K2_END
    buffer_load_dwordx4 v[4:7], v182, s[8:11], 0 offen sc1
    s_waitcnt vmcnt(0)
    s_branch K2_CK1
K2_RT2:
    s_sub_u32 s60, s60, 1
    s_cbranch_scc1 K2_END
    buffer_load_dwordx4 v[8:11], v183, s[8:11], 0 offen sc1
    s_waitcnt vmcnt(0)
    s_branch K2_CK2
K2_RT3:
    s_sub_u32 s60, s60, 1
    s_cbranch_scc1 K2_END
    buffer_load_dwordx4 v[12:15], v184, s[8:11], 0 offen sc1
    s_waitcnt vmcnt(0)
    s_branch K2_CK3
K2_RT4:
    s_sub_u32 s60, s60, 1
    s_cbranch_scc1 K2_END
    buffer_load_dwordx4 v[16:19], v181, s[8:11], 0 offen offset:128 sc1
    s_waitcnt vmcnt(0)
    s_branch K2_CK4
K2_RT5:
    s_sub_u32 s60, s60, 1
    s_cbranch_scc1 K2_END
    buffer_load_dwordx4 v[20:23], v181, s[8:11], 0 offen offset:160 sc1
    s_waitcnt vmcnt(0)
    s_branch K2_CK5
K2_RT6:
    s_sub_u32 s60, s60, 1
    s_cbranch_scc1 K2_END
    buffer_load_dwordx4 v[24:27], v181, s[8:11], 0 offen offset:192 sc1
    s_waitcnt vmcnt(0)
    s_branch K2_CK6
K2_RT7:
    s_sub_u32 s60, s60, 1
    s_cbranch_scc1 K2_END
    buffer_load_dwordx4 v[28:31], v181, s[8:11], 0 offen offset:224 sc1
    s_waitcnt vmcnt(0)
    s_branch K2_CK7
K2_RT8:
    s_sub_u32 s60, s60, 1
    s_cbranch_scc1 K2_END
    buffer_load_dwordx4 v[32:35], v181, s[8:11], 0 offen offset:256 sc1
    s_waitcnt vmcnt(0)
    s_branch K2_CK8
K2_RT9:
    s_sub_u32 s60, s60, 1
    s_cbranch_scc1 K2_END
    buffer_load_dwordx4 v[36:39], v181, s[8:11], 0 offen offset:288 sc1
    s_waitcnt vmcnt(0)
    s_branch K2_CK9
K2_RK_LOAD:
    s_waitcnt vmcnt(0)
    s_mov_b64 exec, s[40:41]
    s_cbranch_execz K2_RK_B
    v_lshrrev_b32 v50, 24, v3
    buffer_load_dword v40, v179, s[8:11], s66 offen offset:0
    v_mad_u32_u24 v50, v50, s58, v202
    v_and_b32 v3, 0xffffff, v3
    s_mov_b64 exec, s[42:43]
    s_cbranch_execz K2_RK_B
    v_lshrrev_b32 v51, 24, v7
    buffer_load_dword v41, v185, s[8:11], s66 offen
    v_mad_u32_u24 v51, v51, s58, v202
    v_and_b32 v7, 0xffffff, v7
    s_mov_b64 exec, s[44:45]
    s_cbranch_execz K2_RK_B
    v_lshrrev_b32 v52, 24, v11
    buffer_load_dword v42, v186, s[8:11], s66 offen
    v_mad_u32_u24 v52, v52, s58, v202
    v_and_b32 v11, 0xffffff, v11
    s_mov_b64 exec, s[46:47]
    s_cbranch_execz K2_RK_B
    v_lshrrev_b32 v53, 24, v15
    buffer_load_dword v43, v187, s[8:11], s66 offen
    v_mad_u32_u24 v53, v53, s58, v202
    v_and_b32 v15, 0xffffff, v15
    s_mov_b64 exec, s[48:49]
    s_cbranch_execz K2_RK_B
    v_lshrrev_b32 v54, 24, v19
    buffer_load_dword v44, v179, s[8:11], s66 offen offset:32
    v_mad_u32_u24 v54, v54, s58, v202
    v_and_b32 v19, 0xffffff, v19
    s_mov_b64 exec, s[50:51]
    s_cbranch_execz K2_RK_B
    v_lshrrev_b32 v55, 24, v23
    buffer_load_dword v45, v179, s[8:11], s66 offen offset:40
    v_mad_u32_u24 v55, v55, s58, v202
    v_and_b32 v23, 0xffffff, v23
    s_mov_b64 exec, s[90:91]
    s_cbranch_execz K2_RK_B
    v_lshrrev_b32 v56, 24, v27
    buffer_load_dword v46, v179, s[8:11], s66 offen offset:48
    v_mad_u32_u24 v56, v56, s58, v202
    v_and_b32 v27, 0xffffff, v27
    s_mov_b64 exec, s[92:93]
    s_cbranch_execz K2_RK_B
    v_lshrrev_b32 v57, 24, v31
    buffer_load_dword v47, v179, s[8:11], s66 offen offset:56
    v_mad_u32_u24 v57, v57, s58, v202
    v_and_b32 v31, 0xffffff, v31
    s_mov_b64 exec, s[94:95]
    s_cbranch_execz K2_RK_B
    v_lshrrev_b32 v58, 24, v35
    buffer_load_dword v48, v179, s[8:11], s66 offen offset:64
    v_mad_u32_u24 v58, v58, s58, v202
    v_and_b32 v35, 0xffffff, v35
    s_mov_b64 exec, s[96:97]
    s_cbranch_execz K2_RK_B
    v_lshrrev_b32 v59, 24, v39
    buffer_load_dword v49, v179, s[8:11], s66 offen offset:72
    v_mad_u32_u24 v59, v59, s58, v202
    v_and_b32 v39, 0xffffff, v39
K2_RK_B:
    s_mov_b64 exec, -1
    s_mul_i32 s62, s24, 48
    s_waitcnt vmcnt(0)
    v_subrev_u32 v40, s62, v40
    v_subrev_u32 v41, s62, v41
    v_subrev_u32 v42, s62, v42
    v_subrev_u32 v43, s62, v43
    v_subrev_u32 v44, s62, v44
    v_subrev_u32 v45, s62, v45
    v_subrev_u32 v46, s62, v46
    v_subrev_u32 v47, s62, v47
    v_subrev_u32 v48, s62, v48
    v_subrev_u32 v49, s62, v49
    s_branch K2_RK_DONE
K2_PAD_OV:
    s_branch K2_HOP
K2_OV:
    s_cmp_lg_u32 s24, 0
    s_cbranch_scc1 K2_OB
    s_cmp_eq_u32 s22, 39
    s_cselect_b32 s63, 5, 2
    s_flbit_i32_b32 s56, s58
    s_sub_u32 s56, 31, s56
    s_bitset0_b32 s58, s56
    s_sub_u32 s57, s56, 1
    v_mov_b32 v198, 0
    v_mov_b32 v206, s57
K2_OVL:
    s_mov_b64 exec, -1
    s_ff1_i32_b32 s61, s58
    s_bitset0_b32 s58, s61
    v_readfirstlane_b32 s62, v206
    s_nop 0
    s_sub_u32 s62, s62, s61
    s_lshl_b32 s61, s62, 1
    v_cmp_lt_i32 vcc, s61, v180
    s_cmp_eq_u32 s62, 1
    s_cselect_b64 vcc, s[42:43], vcc
    s_cmp_eq_u32 s62, 2
    s_cselect_b64 vcc, s[44:45], vcc
    s_cmp_eq_u32 s62, 3
    s_cselect_b64 vcc, s[46:47], vcc
    s_lshl_b32 s61, s62, 2
    s_set_gpr_idx_on s62, gpr_idx(SRC0)
    s_nop 0
    v_mov_b32 v204, v40
    v_mov_b32 v205, v50
    s_set_gpr_idx_idx s61
    s_nop 0
    v_mov_b32 v208, v0
    v_mov_b32 v209, v1
    v_mov_b32 v210, v2
    v_mov_b32 v211, v3
    s_set_gpr_idx_off
    s_mov_b64 exec, vcc
    v_subrev_u32 v192, 48, v204
    v_mov_b32 v197, 163656
    v_cmp_gt_u32 vcc, 16, v192
    s_mov_b32 s62, 0
    s_mov_b64 exec, vcc
    s_cbranch_execz K2_OVN
K2_OP:
    ds_cmpst_rtn_b32 v200, v197, v198, v205
    s_cmp_ge_u32 s62, 2
    s_cselect_b32 s65, 2400, 0
    s_cselect_b32 s26, 32, 0
    s_sub_u32 s65, 161536, s65
    s_lshl_b32 s61, s62, 4
    s_sub_u32 s61, s61, s26
    v_mov_b32 v199, s65
    v_add_u32 v203, s61, v192
    s_waitcnt lgkmcnt(0)
    v_cmp_eq_u32 vcc, 0, v200
    v_cmp_eq_u32 s[56:57], v200, v205
    s_nop 0
    s_or_b64 vcc, vcc, s[56:57]
    s_andn2_b64 s[56:57], exec, vcc
    s_mov_b64 exec, vcc
    v_lshl_add_u32 v194, v203, 5, v199
    v_lshl_add_u32 v195, v203, 2, v199
    v_lshrrev_b32 v193, 3, v203
    v_mad_i32_i24 v196, v193, -16, v195
    v_and_b32 v193, 1, v193
    v_mad_i32_i24 v196, v193, -14, v196
    ds_write_b32 v194, v211 offset:864
    ds_write_b16 v195, v208 offset:194
    ds_write_b16_d16_hi v195, v208 offset:386
    ds_write_b16_d16_hi v195, v209 offset:578
    ds_write_b16 v196, v210 offset:768
    s_mov_b64 exec, s[56:57]
    s_cbranch_execz K2_OVN
    v_add_u32 v197, 4, v197
    s_add_u32 s62, s62, 1
    s_cmp_lt_u32 s62, s63
    s_cbranch_scc1 K2_OP
K2_OVN:
    s_cmp_lg_u32 s58, 0
    s_cbranch_scc1 K2_OVL
    s_mov_b64 exec, -1
    s_branch K2_OB
K2_BIG:
    s_cmp_lg_u32 s24, 0
    s_cbranch_scc1 K2_TOK
    s_mov_b64 s[62:63], vcc
    s_bcnt1_i32_b64 s60, vcc
    s_cmp_eq_u32 s22, 39
    s_cselect_b32 s61, 5, 2
    s_cmp_gt_u32 s60, s61
    s_cbranch_scc1 K2_SLOW
    v_cmp_lt_u32 vcc, 64, v193
    s_nop 0
    s_cbranch_vccnz K2_SLOW
    v_mov_b32 v197, 163656
    ds_read_b32 v203, v197
    ds_read_b32 v204, v197 offset:4
    ds_read_b32 v205, v197 offset:8
    ds_read_b32 v206, v197 offset:12
    ds_read_b32 v207, v197 offset:16
    v_and_b32 v197, 0x3ffff, v195
    s_movk_i32 s26, 64
    s_waitcnt lgkmcnt(0)
    v_cmp_eq_u32 vcc, v204, v197
    v_mov_b32 v194, 134217728
    s_nop 0
    v_cndmask_b32 v198, v198, v194, vcc
    v_cmp_eq_u32 vcc, v205, v197
    v_mov_b32 v194, 268435456
    s_nop 0
    v_cndmask_b32 v198, v198, v194, vcc
    v_cmp_eq_u32 vcc, v206, v197
    v_mov_b32 v194, 402653184
    s_nop 0
    v_cndmask_b32 v198, v198, v194, vcc
    v_cmp_eq_u32 vcc, v207, v197
    v_mov_b32 v194, 536870912
    s_nop 0
    v_cndmask_b32 v198, v198, v194, vcc
    s_branch K2_TOK
K2_SLOW:
    v_mov_b32 v197, v193
    s_nop 1
    v_max_u32_dpp v197, v197, v197 row_shr:1 row_mask:0xf bank_mask:0xf bound_ctrl:0
    s_nop 1
    v_max_u32_dpp v197, v197, v197 row_shr:2 row_mask:0xf bank_mask:0xf bound_ctrl:0
    s_nop 1
    v_max_u32_dpp v197, v197, v197 row_shr:4 row_mask:0xf bank_mask:0xf bound_ctrl:0
    s_nop 1
    v_max_u32_dpp v197, v197, v197 row_shr:8 row_mask:0xf bank_mask:0xf bound_ctrl:0
    s_nop 1
    v_max_u32_dpp v197, v197, v197 row_bcast:15 row_mask:0xa bank_mask:0xf
    s_nop 1
    v_max_u32_dpp v197, v197, v197 row_bcast:31 row_mask:0xc bank_mask:0xf
    s_nop 0
    v_readlane_b32 s25, v197, 63
    s_nop 0
    s_add_u32 s25, s25, 47
    s_mul_i32 s25, s25, 43691
    s_lshr_b32 s25, s25, 21
    s_mov_b64 exec, s[40:41]
    s_cbranch_execz K2_SV_DONE
    buffer_store_dword v40, v179, s[8:11], s66 offen offset:0
    s_mov_b64 exec, s[42:43]
    s_cbranch_execz K2_SV_DONE
    buffer_store_dword v41, v185, s[8:11], s66 offen
    s_mov_b64 exec, s[44:45]
    s_cbranch_execz K2_SV_DONE
    buffer_store_dword v42, v186, s[8:11], s66 offen
    s_mov_b64 exec, s[46:47]
    s_cbranch_execz K2_SV_DONE
    buffer_store_dword v43, v187, s[8:11], s66 offen
    s_mov_b64 exec, s[48:49]
    s_cbranch_execz K2_SV_DONE
    buffer_store_dword v44, v179, s[8:11], s66 offen offset:32
    s_mov_b64 exec, s[50:51]
    s_cbranch_execz K2_SV_DONE
    buffer_store_dword v45, v179, s[8:11], s66 offen offset:40
    s_mov_b64 exec, s[90:91]
    s_cbranch_execz K2_SV_DONE
    buffer_store_dword v46, v179, s[8:11], s66 offen offset:48
    s_mov_b64 exec, s[92:93]
    s_cbranch_execz K2_SV_DONE
    buffer_store_dword v47, v179, s[8:11], s66 offen offset:56
    s_mov_b64 exec, s[94:95]
    s_cbranch_execz K2_SV_DONE
    buffer_store_dword v48, v179, s[8:11], s66 offen offset:64
    s_mov_b64 exec, s[96:97]
    s_cbranch_execz K2_SV_DONE
    buffer_store_dword v49, v179, s[8:11], s66 offen offset:72
K2_SV_DONE:
    s_mov_b64 exec, -1
    s_branch K2_TOK
K2_rare_1:
    s_cmp_eq_u32 s33, 4
    s_cbranch_scc1 K2_four_3
    s_mov_b32 s49, s48
    s_mov_b32 s51, s48
    s_add_u32 s45, s44, 256
    s_add_u32 s46, s44, 512
    s_add_u32 s47, s44, 768
    s_branch K2_back_2
K2_four_3:
    s_add_u32 s50, s48, 64
    s_lshr_b32 s51, s3, 27
    s_mov_b32 s66, 161536
    s_cmp_ge_u32 s51, 2
    s_cselect_b32 s66, 159072, s66
    s_mul_i32 s51, s51, 32
    s_add_u32 s51, s51, s66
    s_mov_b32 s46, s44
    s_mov_b32 s47, s44
    s_branch K2_back_2
K2_a4_5:
    s_lshr_b32 s65, s3, 27
    s_mov_b32 s66, 161536
    s_cmp_ge_u32 s65, 2
    s_cselect_b32 s66, 158112, s66
    s_mul_i32 s65, s65, 512
    s_add_u32 s65, s65, s66
    v_add_u32 v232, s65, v230
    ds_read_b32 v232, v232
    s_add_u32 m0, s65, 864
    s_waitcnt lgkmcnt(0)
    v_or_b32 v232, v232, v231
    buffer_load_dwordx4 v232, s[16:19], 0 offen  lds
    s_branch K2_b4_7
K2_rare_14:
    s_cmp_eq_u32 s33, 4
    s_cbranch_scc1 K2_four_16
    s_mov_b32 s49, s48
    s_mov_b32 s51, s48
    s_add_u32 s45, s44, 256
    s_add_u32 s46, s44, 512
    s_add_u32 s47, s44, 768
    s_branch K2_back_15
K2_four_16:
    s_add_u32 s50, s48, 64
    s_lshr_b32 s51, s3, 27
    s_mov_b32 s66, 161536
    s_cmp_ge_u32 s51, 2
    s_cselect_b32 s66, 159072, s66
    s_mul_i32 s51, s51, 32
    s_add_u32 s51, s51, s66
    s_mov_b32 s46, s44
    s_mov_b32 s47, s44
    s_branch K2_back_15
K2_a4_18:
    s_lshr_b32 s65, s3, 27
    s_mov_b32 s66, 161536
    s_cmp_ge_u32 s65, 2
    s_cselect_b32 s66, 158112, s66
    s_mul_i32 s65, s65, 512
    s_add_u32 s65, s65, s66
    v_add_u32 v232, s65, v230
    ds_read_b32 v232, v232
    s_add_u32 m0, s65, 864
    s_waitcnt lgkmcnt(0)
    v_or_b32 v232, v232, v231
    buffer_load_dwordx4 v232, s[16:19], 0 offen  lds
    s_branch K2_b4_20
K2_rare_27:
    s_cmp_eq_u32 s33, 4
    s_cbranch_scc1 K2_four_29
    s_mov_b32 s49, s48
    s_mov_b32 s51, s48
    s_add_u32 s45, s44, 256
    s_add_u32 s46, s44, 512
    s_add_u32 s47, s44, 768
    s_branch K2_back_28
K2_four_29:
    s_add_u32 s50, s48, 64
    s_lshr_b32 s51, s3, 27
    s_mov_b32 s66, 161536
    s_cmp_ge_u32 s51, 2
    s_cselect_b32 s66, 159072, s66
    s_mul_i32 s51, s51, 32
    s_add_u32 s51, s51, s66
    s_mov_b32 s46, s44
    s_mov_b32 s47, s44
    s_branch K2_back_28
K2_a4_31:
    s_lshr_b32 s65, s3, 27
    s_mov_b32 s66, 161536
    s_cmp_ge_u32 s65, 2
    s_cselect_b32 s66, 158112, s66
    s_mul_i32 s65, s65, 512
    s_add_u32 s65, s65, s66
    v_add_u32 v232, s65, v230
    ds_read_b32 v232, v232
    s_add_u32 m0, s65, 864
    s_waitcnt lgkmcnt(0)
    v_or_b32 v232, v232, v231
    buffer_load_dwordx4 v232, s[16:19], 0 offen  lds
    s_branch K2_b4_33
K2_rare_38:
    s_cmp_eq_u32 s33, 4
    s_cbranch_scc1 K2_four_40
    s_mov_b32 s49, s48
    s_mov_b32 s51, s48
    s_add_u32 s45, s44, 256
    s_add_u32 s46, s44, 512
    s_add_u32 s47, s44, 768
    s_branch K2_back_39
K2_four_40:
    s_add_u32 s50, s48, 64
    s_lshr_b32 s51, s3, 27
    s_mov_b32 s66, 161536
    s_cmp_ge_u32 s51, 2
    s_cselect_b32 s66, 159072, s66
    s_mul_i32 s51, s51, 32
    s_add_u32 s51, s51, s66
    s_mov_b32 s46, s44
    s_mov_b32 s47, s44
    s_branch K2_back_39
K2_rare_45:
    s_cmp_eq_u32 s33, 4
    s_cbranch_scc1 K2_four_47
    s_mov_b32 s49, s48
    s_mov_b32 s51, s48
    s_add_u32 s45, s44, 256
    s_add_u32 s46, s44, 512
    s_add_u32 s47, s44, 768
    s_branch K2_back_46
K2_four_47:
    s_add_u32 s50, s48, 64
    s_lshr_b32 s51, s3, 27
    s_mov_b32 s66, 161536
    s_cmp_ge_u32 s51, 2
    s_cselect_b32 s66, 159072, s66
    s_mul_i32 s51, s51, 32
    s_add_u32 s51, s51, s66
    s_mov_b32 s46, s44
    s_mov_b32 s47, s44
    s_branch K2_back_46
K2_U10:
    s_setprio 1
    s_add_u32 s38, s38, 1
    v_mov_b32 v254, s52
    v_mov_b32 v255, s38
    s_lshl_b32 s58, s38, 3
    s_add_u32 s58, s58, s20
    s_mov_b64 exec, 1
    ds_write_b32 v254, v255
    s_mov_b64 exec, -1
    s_cmp_lt_u32 s58, s22
    s_cbranch_scc0 K2_dyn_48
K2_back_49:
    s_waitcnt lgkmcnt(7)
    v_lshlrev_b32 v40, 16, v0
    v_and_b32 v41, 0xffff0000, v0
    v_lshlrev_b32 v42, 16, v1
    v_and_b32 v43, 0xffff0000, v1
    v_lshlrev_b32 v44, 16, v2
    v_and_b32 v45, 0xffff0000, v2
    v_lshlrev_b32 v46, 16, v3
    v_and_b32 v47, 0xffff0000, v3
    v_mul_f32 v4, v40, v4
    v_mul_f32 v5, v41, v5
    v_mul_f32 v6, v42, v6
    v_mul_f32 v7, v43, v7
    v_mul_f32 v8, v44, v8
    v_mul_f32 v9, v45, v9
    v_mul_f32 v10, v46, v10
    v_mul_f32 v11, v47, v11
    v_cvt_pk_bf16_f32 v64, v4, v5
    v_cvt_pk_bf16_f32 v65, v6, v7
    v_cvt_pk_bf16_f32 v66, v8, v9
    v_cvt_pk_bf16_f32 v67, v10, v11
    v_mul_f32 v12, v40, v12
    v_mul_f32 v13, v41, v13
    v_mul_f32 v14, v42, v14
    v_mul_f32 v15, v43, v15
    v_mul_f32 v16, v44, v16
    v_mul_f32 v17, v45, v17
    v_mul_f32 v18, v46, v18
    v_mul_f32 v19, v47, v19
    v_cvt_pk_bf16_f32 v68, v12, v13
    v_cvt_pk_bf16_f32 v69, v14, v15
    v_cvt_pk_bf16_f32 v70, v16, v17
    v_cvt_pk_bf16_f32 v71, v18, v19
    v_readlane_b32 s3, v253, s58
    s_lshl_b32 s44, s34, 7
    s_lshl_b32 s60, s58, 5
    s_and_b32 s48, s3, 0x3ffff
    s_bfe_u32 s33, s3, 0x30012
    s_sub_u32 s60, s60, s48
    s_and_b32 s60, s60, 0xff
    s_add_u32 s60, s60, s48
    s_mul_i32 s35, s38, 6
    s_cmp_eq_u32 s34, 0
    s_cselect_b32 s35, s35, s60
    s_mov_b32 s45, s44
    s_add_u32 s47, s44, 256
    s_add_u32 s49, s48, 32
    s_add_u32 s60, s48, 64
    s_cmp_eq_u32 s33, 3
    s_cselect_b32 s46, s44, s47
    s_cselect_b32 s50, s60, s48
    s_cselect_b32 s51, s48, s49
    s_sub_u32 s60, s33, 2
    s_cmp_lt_u32 s60, 2
    s_cbranch_scc0 K2_rare_54
K2_back_55:
    v_add_u32 v233, s48, v230
    ds_read_b32 v232, v233
    ds_read_b32 v233, v233 offset:1024
    v_add_u32 v222, s48, v251
    ds_read_b32 v222, v222
    v_add_u32 v224, s49, v251
    ds_read_b32 v224, v224
    v_add_u32 v226, s50, v251
    ds_read_b32 v226, v226
    v_add_u32 v228, s51, v251
    ds_read_b32 v228, v228
    s_waitcnt lgkmcnt(4)
    v_or_b32 v232, v232, v231
    v_or_b32 v233, v233, v231
    s_cmp_lg_u32 s34, 0
    s_cbranch_scc1 K2_dum_57
    s_add_u32 m0, s48, 864
    s_add_u32 s65, s48, 1888
    buffer_load_dwordx4 v232, s[16:19], 0 offen  lds
    s_mov_b32 m0, s65
    s_mov_b32 exec_hi, 0
    buffer_load_dwordx4 v233, s[16:19], 0 offen  lds
    s_cmp_eq_u32 s33, 4
    s_cbranch_scc1 K2_a4_58
K2_b4_60:
    s_mov_b32 exec_hi, -1
K2_back_59:
    s_waitcnt lgkmcnt(3)
    v_mad_u32_u16 v223, v222, s39, v248 op_sel:[1,0,0,0]
    v_mad_u32_u16 v222, v222, s39, v248
    s_waitcnt lgkmcnt(2)
    v_mad_u32_u16 v225, v224, s39, v248 op_sel:[1,0,0,0]
    v_mad_u32_u16 v224, v224, s39, v248
    s_waitcnt lgkmcnt(1)
    v_mad_u32_u16 v227, v226, s39, v248 op_sel:[1,0,0,0]
    v_mad_u32_u16 v226, v226, s39, v248
    s_waitcnt lgkmcnt(0)
    v_mad_u32_u16 v229, v228, s39, v248 op_sel:[1,0,0,0]
    v_mad_u32_u16 v228, v228, s39, v248
    s_waitcnt vmcnt(6)
    v_mfma_f32_32x32x16_bf16 v[0:15], v[64:67], v[176:179], 0
    ds_read_b64_tr_b16 v[184:185], v246 offset:2048
    ds_read_b64_tr_b16 v[186:187], v246 offset:2560
    ds_read_b64_tr_b16 v[188:189], v247 offset:2048
    ds_read_b64_tr_b16 v[190:191], v247 offset:2560
    s_mov_b32 m0, s68
    v_mfma_f32_32x32x16_bf16 v[16:31], v[68:71], v[176:179], 0
    buffer_load_dwordx4 v222, s[4:7], s44 offen sc1 lds
    buffer_load_dwordx4 v223, s[72:75], s44 offen offset:1024 sc1 lds
    v_permlane32_swap_b32 v242, v236
    v_permlane32_swap_b32 v243, v237
    v_mfma_f32_32x32x16_bf16 v[32:47], v[64:67], v[180:183], 0
    v_permlane32_swap_b32 v244, v238
    v_permlane32_swap_b32 v245, v239
    v_permlane32_swap_b32 v240, v241
    v_add_f32 v242, v242, v236
    v_mfma_f32_32x32x16_bf16 v[48:63], v[68:71], v[180:183], 0
    s_setprio 0
    v_add_f32 v243, v243, v237
    v_add_f32 v244, v244, v238
    v_add_f32 v245, v245, v239
    v_add_f32 v240, -v240, -v241
    s_set_gpr_idx_on s32, gpr_idx(DST)
    s_nop 0
    v_cvt_pk_bf16_f32 v195, v242, v243
    v_cvt_pk_bf16_f32 v196, v244, v245
    v_cvt_pk_bf16_f32 v197, v240, v240
    s_set_gpr_idx_off
    v_mul_f32 v234, v0, v96
    v_mul_f32 v236, v8, v128
    v_fmac_f32 v234, v1, v97
    v_fmac_f32 v236, v9, v129
    v_fmac_f32 v234, v2, v98
    v_fmac_f32 v236, v10, v130
    v_fmac_f32 v234, v3, v99
    v_fmac_f32 v236, v11, v131
    v_fmac_f32 v234, v4, v100
    v_fmac_f32 v236, v12, v132
    v_fmac_f32 v234, v5, v101
    v_fmac_f32 v236, v13, v133
    v_fmac_f32 v234, v6, v102
    v_fmac_f32 v236, v14, v134
    v_fmac_f32 v234, v7, v103
    v_fmac_f32 v236, v15, v135
    v_mul_f32 v238, v16, v128
    v_mul_f32 v240, v24, v128
    v_fmac_f32 v238, v17, v129
    v_fmac_f32 v240, v25, v129
    v_fmac_f32 v238, v18, v130
    v_fmac_f32 v240, v26, v130
    v_fmac_f32 v238, v19, v131
    v_fmac_f32 v240, v27, v131
    v_fmac_f32 v238, v20, v132
    v_fmac_f32 v240, v28, v132
    v_fmac_f32 v238, v21, v133
    v_fmac_f32 v240, v29, v133
    v_fmac_f32 v238, v22, v134
    v_fmac_f32 v240, v30, v134
    v_fmac_f32 v238, v23, v135
    v_fmac_f32 v240, v31, v135
    v_mul_f32 v235, v32, v104
    v_mul_f32 v237, v40, v136
    v_fmac_f32 v235, v33, v105
    v_fmac_f32 v237, v41, v137
    v_fmac_f32 v235, v34, v106
    v_fmac_f32 v237, v42, v138
    v_fmac_f32 v235, v35, v107
    v_fmac_f32 v237, v43, v139
    v_fmac_f32 v235, v36, v108
    v_fmac_f32 v237, v44, v140
    v_fmac_f32 v235, v37, v109
    v_fmac_f32 v237, v45, v141
    v_fmac_f32 v235, v38, v110
    v_fmac_f32 v237, v46, v142
    v_fmac_f32 v235, v39, v111
    v_fmac_f32 v237, v47, v143
    v_mul_f32 v239, v48, v136
    v_mul_f32 v241, v56, v136
    v_fmac_f32 v239, v49, v137
    v_fmac_f32 v241, v57, v137
    v_fmac_f32 v239, v50, v138
    v_fmac_f32 v241, v58, v138
    v_fmac_f32 v239, v51, v139
    v_fmac_f32 v241, v59, v139
    v_fmac_f32 v239, v52, v140
    v_fmac_f32 v241, v60, v140
    v_fmac_f32 v239, v53, v141
    v_fmac_f32 v241, v61, v141
    v_fmac_f32 v239, v54, v142
    v_fmac_f32 v241, v62, v142
    v_fmac_f32 v239, v55, v143
    v_fmac_f32 v241, v63, v143
    s_setprio 1
    s_waitcnt vmcnt(6) lgkmcnt(0)
    v_mfma_f32_32x32x16_bf16 v[0:15], v[64:67], v[184:187], 0
    ds_read_b64_tr_b16 v[176:177], v246 offset:4096
    ds_read_b64_tr_b16 v[178:179], v246 offset:4608
    ds_read_b64_tr_b16 v[180:181], v247 offset:4096
    ds_read_b64_tr_b16 v[182:183], v247 offset:4608
    s_mov_b32 m0, s69
    v_mfma_f32_32x32x16_bf16 v[16:31], v[68:71], v[184:187], 0
    buffer_load_dwordx4 v224, s[4:7], s45 offen sc1 lds
    buffer_load_dwordx4 v225, s[72:75], s45 offen offset:1024 sc1 lds
    v_permlane32_swap_b32 v234, v236
    v_permlane32_swap_b32 v235, v237
    v_mfma_f32_32x32x16_bf16 v[32:47], v[64:67], v[188:191], 0
    v_permlane32_swap_b32 v240, v238
    v_permlane32_swap_b32 v241, v239
    v_add_f32 v234, v234, v236
    v_add_f32 v235, v235, v237
    v_add_f32 v240, v240, v238
    v_mfma_f32_32x32x16_bf16 v[48:63], v[68:71], v[188:191], 0
    s_setprio 0
    v_add_f32 v241, v241, v239
    s_set_gpr_idx_on s31, gpr_idx(DST)
    s_nop 0
    v_cvt_pk_bf16_f32 v192, v234, v235
    v_cvt_pk_bf16_f32 v193, v240, v241
    s_set_gpr_idx_off
    v_mul_f32 v234, v0, v144
    v_mul_f32 v236, v8, v112
    v_fmac_f32 v234, v1, v145
    v_fmac_f32 v236, v9, v113
    v_fmac_f32 v234, v2, v146
    v_fmac_f32 v236, v10, v114
    v_fmac_f32 v234, v3, v147
    v_fmac_f32 v236, v11, v115
    v_fmac_f32 v234, v4, v148
    v_fmac_f32 v236, v12, v116
    v_fmac_f32 v234, v5, v149
    v_fmac_f32 v236, v13, v117
    v_fmac_f32 v234, v6, v150
    v_fmac_f32 v236, v14, v118
    v_fmac_f32 v234, v7, v151
    v_fmac_f32 v236, v15, v119
    v_mul_f32 v238, v16, v160
    v_mul_f32 v240, v24, v160
    v_fmac_f32 v238, v17, v161
    v_fmac_f32 v240, v25, v161
    v_fmac_f32 v238, v18, v162
    v_fmac_f32 v240, v26, v162
    v_fmac_f32 v238, v19, v163
    v_fmac_f32 v240, v27, v163
    v_fmac_f32 v238, v20, v164
    v_fmac_f32 v240, v28, v164
    v_fmac_f32 v238, v21, v165
    v_fmac_f32 v240, v29, v165
    v_fmac_f32 v238, v22, v166
    v_fmac_f32 v240, v30, v166
    v_fmac_f32 v238, v23, v167
    v_fmac_f32 v240, v31, v167
    v_mul_f32 v235, v32, v152
    v_mul_f32 v237, v40, v120
    v_fmac_f32 v235, v33, v153
    v_fmac_f32 v237, v41, v121
    v_fmac_f32 v235, v34, v154
    v_fmac_f32 v237, v42, v122
    v_fmac_f32 v235, v35, v155
    v_fmac_f32 v237, v43, v123
    v_fmac_f32 v235, v36, v156
    v_fmac_f32 v237, v44, v124
    v_fmac_f32 v235, v37, v157
    v_fmac_f32 v237, v45, v125
    v_fmac_f32 v235, v38, v158
    v_fmac_f32 v237, v46, v126
    v_fmac_f32 v235, v39, v159
    v_fmac_f32 v237, v47, v127
    v_mul_f32 v239, v48, v168
    v_mul_f32 v241, v56, v168
    v_fmac_f32 v239, v49, v169
    v_fmac_f32 v241, v57, v169
    v_fmac_f32 v239, v50, v170
    v_fmac_f32 v241, v58, v170
    v_fmac_f32 v239, v51, v171
    v_fmac_f32 v241, v59, v171
    v_fmac_f32 v239, v52, v172
    v_fmac_f32 v241, v60, v172
    v_fmac_f32 v239, v53, v173
    v_fmac_f32 v241, v61, v173
    v_fmac_f32 v239, v54, v174
    v_fmac_f32 v241, v62, v174
    v_fmac_f32 v239, v55, v175
    v_fmac_f32 v241, v63, v175
    s_setprio 1
    s_waitcnt vmcnt(6) lgkmcnt(0)
    v_mfma_f32_32x32x16_bf16 v[0:15], v[64:67], v[176:179], 0
    ds_read_b64_tr_b16 v[184:185], v246 offset:6144
    ds_read_b64_tr_b16 v[186:187], v246 offset:6656
    ds_read_b64_tr_b16 v[188:189], v247 offset:6144
    ds_read_b64_tr_b16 v[190:191], v247 offset:6656
    s_mov_b32 m0, s70
    v_mfma_f32_32x32x16_bf16 v[16:31], v[68:71], v[176:179], 0
    buffer_load_dwordx4 v226, s[4:7], s46 offen sc1 lds
    buffer_load_dwordx4 v227, s[72:75], s46 offen offset:1024 sc1 lds
    s_sub_u32 s26, s48, s29
    s_mov_b32 s29, s48
    s_mov_b32 s30, s3
    s_cmp_eq_u32 s34, 0
    s_cselect_b32 s56, s33, 0
    v_mfma_f32_32x32x16_bf16 v[32:47], v[64:67], v[180:183], 0
    v_mfma_f32_32x32x16_bf16 v[48:63], v[68:71], v[180:183], 0
    s_setprio 0
    v_mul_f32 v242, v0, v144
    v_fma_f32 v238, v8, v160, -v238
    v_fmac_f32 v242, v1, v145
    v_fmac_f32 v238, v9, v161
    v_fmac_f32 v242, v2, v146
    v_fmac_f32 v238, v10, v162
    v_fmac_f32 v242, v3, v147
    v_fmac_f32 v238, v11, v163
    v_fmac_f32 v242, v4, v148
    v_fmac_f32 v238, v12, v164
    v_fmac_f32 v242, v5, v149
    v_fmac_f32 v238, v13, v165
    v_fmac_f32 v242, v6, v150
    v_fmac_f32 v238, v14, v166
    v_fmac_f32 v242, v7, v151
    v_fmac_f32 v238, v15, v167
    v_fmac_f32 v236, v16, v112
    v_mul_f32 v244, v24, v160
    v_fmac_f32 v236, v17, v113
    v_fmac_f32 v244, v25, v161
    v_fmac_f32 v236, v18, v114
    v_fmac_f32 v244, v26, v162
    v_fmac_f32 v236, v19, v115
    v_fmac_f32 v244, v27, v163
    v_fmac_f32 v236, v20, v116
    v_fmac_f32 v244, v28, v164
    v_fmac_f32 v236, v21, v117
    v_fmac_f32 v244, v29, v165
    v_fmac_f32 v236, v22, v118
    v_fmac_f32 v244, v30, v166
    v_fmac_f32 v236, v23, v119
    v_fmac_f32 v244, v31, v167
    v_mul_f32 v243, v32, v152
    v_fma_f32 v239, v40, v168, -v239
    v_fmac_f32 v243, v33, v153
    v_fmac_f32 v239, v41, v169
    v_fmac_f32 v243, v34, v154
    v_fmac_f32 v239, v42, v170
    v_fmac_f32 v243, v35, v155
    v_fmac_f32 v239, v43, v171
    v_fmac_f32 v243, v36, v156
    v_fmac_f32 v239, v44, v172
    v_fmac_f32 v243, v37, v157
    v_fmac_f32 v239, v45, v173
    v_fmac_f32 v243, v38, v158
    v_fmac_f32 v239, v46, v174
    v_fmac_f32 v243, v39, v159
    v_fmac_f32 v239, v47, v175
    v_fmac_f32 v237, v48, v120
    v_mul_f32 v245, v56, v168
    v_fmac_f32 v237, v49, v121
    v_fmac_f32 v245, v57, v169
    v_fmac_f32 v237, v50, v122
    v_fmac_f32 v245, v58, v170
    v_fmac_f32 v237, v51, v123
    v_fmac_f32 v245, v59, v171
    v_fmac_f32 v237, v52, v124
    v_fmac_f32 v245, v60, v172
    v_fmac_f32 v237, v53, v125
    v_fmac_f32 v245, v61, v173
    v_fmac_f32 v237, v54, v126
    v_fmac_f32 v245, v62, v174
    v_fmac_f32 v237, v55, v127
    v_fmac_f32 v245, v63, v175
    s_setprio 1
    s_waitcnt vmcnt(4) lgkmcnt(0)
    v_mfma_f32_32x32x16_bf16 v[0:15], v[64:67], v[184:187], 0
    ds_read_b64_tr_b16 v[176:177], v246 offset:0
    ds_read_b64_tr_b16 v[178:179], v246 offset:512
    ds_read_b64_tr_b16 v[180:181], v247 offset:0
    ds_read_b64_tr_b16 v[182:183], v247 offset:512
    s_mov_b32 m0, s71
    v_mfma_f32_32x32x16_bf16 v[16:31], v[68:71], v[184:187], 0
    buffer_load_dwordx4 v228, s[4:7], s47 offen sc1 lds
    buffer_load_dwordx4 v229, s[72:75], s47 offen offset:1024 sc1 lds
    v_permlane32_swap_b32 v242, v234
    v_permlane32_swap_b32 v243, v235
    v_add_f32 v242, v242, v234
    v_mfma_f32_32x32x16_bf16 v[32:47], v[64:67], v[188:191], 0
    v_add_f32 v243, v243, v235
    s_set_gpr_idx_on s31, gpr_idx(DST)
    s_nop 0
    v_cvt_pk_bf16_f32 v194, v242, v243
    s_set_gpr_idx_off
    s_mov_b32 s32, s31
    s_mov_b32 s31, s35
    v_mfma_f32_32x32x16_bf16 v[48:63], v[68:71], v[188:191], 0
    s_setprio 0
    v_mul_f32 v242, v0, v144
    v_fma_f32 v240, v8, v160, -v240
    v_fmac_f32 v242, v1, v145
    v_fmac_f32 v240, v9, v161
    v_fmac_f32 v242, v2, v146
    v_fmac_f32 v240, v10, v162
    v_fmac_f32 v242, v3, v147
    v_fmac_f32 v240, v11, v163
    v_fmac_f32 v242, v4, v148
    v_fmac_f32 v240, v12, v164
    v_fmac_f32 v242, v5, v149
    v_fmac_f32 v240, v13, v165
    v_fmac_f32 v242, v6, v150
    v_fmac_f32 v240, v14, v166
    v_fmac_f32 v242, v7, v151
    v_fmac_f32 v240, v15, v167
    v_add_u32 v249, s26, v249
    v_add_u32 v250, s26, v250
    v_fma_f32 v244, v16, v160, -v244
    v_fmac_f32 v236, v24, v112
    v_fmac_f32 v244, v17, v161
    v_fmac_f32 v236, v25, v113
    v_fmac_f32 v244, v18, v162
    v_fmac_f32 v236, v26, v114
    v_fmac_f32 v244, v19, v163
    v_fmac_f32 v236, v27, v115
    v_fmac_f32 v244, v20, v164
    v_fmac_f32 v236, v28, v116
    v_fmac_f32 v244, v21, v165
    v_fmac_f32 v236, v29, v117
    v_fmac_f32 v244, v22, v166
    v_fmac_f32 v236, v30, v118
    v_fmac_f32 v244, v23, v167
    v_fmac_f32 v236, v31, v119
    ds_read_b64_tr_b16 v[0:1], v249 offset:0
    ds_read_b64_tr_b16 v[2:3], v249 offset:128
    ds_read_b128 v[4:7], v250 offset:0
    ds_read_b128 v[8:11], v250 offset:16
    ds_read_b128 v[12:15], v250 offset:384
    ds_read_b128 v[16:19], v250 offset:400
    v_mul_f32 v243, v32, v152
    v_fma_f32 v241, v40, v168, -v241
    v_fmac_f32 v243, v33, v153
    v_fmac_f32 v241, v41, v169
    v_fmac_f32 v243, v34, v154
    v_fmac_f32 v241, v42, v170
    v_fmac_f32 v243, v35, v155
    v_fmac_f32 v241, v43, v171
    v_fmac_f32 v243, v36, v156
    v_fmac_f32 v241, v44, v172
    v_fmac_f32 v243, v37, v157
    v_fmac_f32 v241, v45, v173
    v_fmac_f32 v243, v38, v158
    v_fmac_f32 v241, v46, v174
    v_fmac_f32 v243, v39, v159
    v_fmac_f32 v241, v47, v175
    ds_read_b64_tr_b16 v[20:21], v249 offset:512
    ds_read_b64_tr_b16 v[22:23], v249 offset:640
    ds_read_b128 v[24:27], v250 offset:64
    ds_read_b128 v[28:31], v250 offset:80
    ds_read_b128 v[32:35], v250 offset:448
    ds_read_b128 v[36:39], v250 offset:464
    v_fma_f32 v245, v48, v168, -v245
    v_fmac_f32 v237, v56, v120
    v_fmac_f32 v245, v49, v169
    v_fmac_f32 v237, v57, v121
    v_fmac_f32 v245, v50, v170
    v_fmac_f32 v237, v58, v122
    v_fmac_f32 v245, v51, v171
    v_fmac_f32 v237, v59, v123
    v_fmac_f32 v245, v52, v172
    v_fmac_f32 v237, v60, v124
    v_fmac_f32 v245, v53, v173
    v_fmac_f32 v237, v61, v125
    v_fmac_f32 v245, v54, v174
    v_fmac_f32 v237, v62, v126
    v_fmac_f32 v245, v55, v175
    v_fmac_f32 v237, v63, v127
    s_cmp_eq_u32 s56, 2
    s_cbranch_scc1 K2_U20
    s_cmp_eq_u32 s56, 3
    s_cbranch_scc1 K2_U30
    s_branch K2_DSP0
K2_U40:
    s_setprio 1
    s_waitcnt lgkmcnt(6)
    v_lshlrev_b32 v40, 16, v0
    v_and_b32 v41, 0xffff0000, v0
    v_lshlrev_b32 v42, 16, v1
    v_and_b32 v43, 0xffff0000, v1
    v_lshlrev_b32 v44, 16, v2
    v_and_b32 v45, 0xffff0000, v2
    v_lshlrev_b32 v46, 16, v3
    v_and_b32 v47, 0xffff0000, v3
    v_mul_f32 v4, v40, v4
    v_mul_f32 v5, v41, v5
    v_mul_f32 v6, v42, v6
    v_mul_f32 v7, v43, v7
    v_mul_f32 v8, v44, v8
    v_mul_f32 v9, v45, v9
    v_mul_f32 v10, v46, v10
    v_mul_f32 v11, v47, v11
    v_cvt_pk_bf16_f32 v64, v4, v5
    v_cvt_pk_bf16_f32 v65, v6, v7
    v_cvt_pk_bf16_f32 v66, v8, v9
    v_cvt_pk_bf16_f32 v67, v10, v11
    v_mul_f32 v12, v40, v12
    v_mul_f32 v13, v41, v13
    v_mul_f32 v14, v42, v14
    v_mul_f32 v15, v43, v15
    v_mul_f32 v16, v44, v16
    v_mul_f32 v17, v45, v17
    v_mul_f32 v18, v46, v18
    v_mul_f32 v19, v47, v19
    v_cvt_pk_bf16_f32 v68, v12, v13
    v_cvt_pk_bf16_f32 v69, v14, v15
    v_cvt_pk_bf16_f32 v70, v16, v17
    v_cvt_pk_bf16_f32 v71, v18, v19
    ds_read_b64_tr_b16 v[0:1], v249 offset:1024
    ds_read_b64_tr_b16 v[2:3], v249 offset:1152
    ds_read_b128 v[4:7], v250 offset:128
    ds_read_b128 v[8:11], v250 offset:144
    ds_read_b128 v[12:15], v250 offset:512
    ds_read_b128 v[16:19], v250 offset:528
    s_waitcnt lgkmcnt(6)
    v_lshlrev_b32 v48, 16, v20
    v_and_b32 v49, 0xffff0000, v20
    v_lshlrev_b32 v50, 16, v21
    v_and_b32 v51, 0xffff0000, v21
    v_lshlrev_b32 v52, 16, v22
    v_and_b32 v53, 0xffff0000, v22
    v_lshlrev_b32 v54, 16, v23
    v_and_b32 v55, 0xffff0000, v23
    v_mul_f32 v24, v48, v24
    v_mul_f32 v25, v49, v25
    v_mul_f32 v26, v50, v26
    v_mul_f32 v27, v51, v27
    v_mul_f32 v28, v52, v28
    v_mul_f32 v29, v53, v29
    v_mul_f32 v30, v54, v30
    v_mul_f32 v31, v55, v31
    v_cvt_pk_bf16_f32 v72, v24, v25
    v_cvt_pk_bf16_f32 v73, v26, v27
    v_cvt_pk_bf16_f32 v74, v28, v29
    v_cvt_pk_bf16_f32 v75, v30, v31
    v_mul_f32 v32, v48, v32
    v_mul_f32 v33, v49, v33
    v_mul_f32 v34, v50, v34
    v_mul_f32 v35, v51, v35
    v_mul_f32 v36, v52, v36
    v_mul_f32 v37, v53, v37
    v_mul_f32 v38, v54, v38
    v_mul_f32 v39, v55, v39
    v_cvt_pk_bf16_f32 v76, v32, v33
    v_cvt_pk_bf16_f32 v77, v34, v35
    v_cvt_pk_bf16_f32 v78, v36, v37
    v_cvt_pk_bf16_f32 v79, v38, v39
    s_lshr_b32 s65, s30, 27
    s_mov_b32 s66, 161536
    s_cmp_ge_u32 s65, 2
    s_cselect_b32 s66, 158112, s66
    s_mul_i32 s65, s65, 512
    s_add_u32 s65, s65, s66
    s_sub_u32 s65, s65, s29
    v_add_u32 v56, s65, v249
    s_lshr_b32 s65, s30, 27
    s_mov_b32 s66, 161536
    s_cmp_ge_u32 s65, 2
    s_cselect_b32 s66, 159008, s66
    s_mul_i32 s65, s65, 64
    s_add_u32 s65, s65, s66
    s_sub_u32 s65, s65, s29
    v_add_u32 v57, s65, v250
    ds_read_b64_tr_b16 v[20:21], v56 offset:0
    ds_read_b64_tr_b16 v[22:23], v56 offset:128
    ds_read_b128 v[24:27], v57 offset:0
    ds_read_b128 v[28:31], v57 offset:16
    ds_read_b128 v[32:35], v57 offset:384
    ds_read_b128 v[36:39], v57 offset:400
    s_waitcnt lgkmcnt(10)
    v_lshlrev_b32 v40, 16, v0
    v_and_b32 v41, 0xffff0000, v0
    v_lshlrev_b32 v42, 16, v1
    v_and_b32 v43, 0xffff0000, v1
    v_lshlrev_b32 v44, 16, v2
    v_and_b32 v45, 0xffff0000, v2
    v_lshlrev_b32 v46, 16, v3
    v_and_b32 v47, 0xffff0000, v3
    s_waitcnt lgkmcnt(8)
    v_mul_f32 v4, v40, v4
    v_mul_f32 v5, v41, v5
    v_mul_f32 v6, v42, v6
    v_mul_f32 v7, v43, v7
    v_mul_f32 v8, v44, v8
    v_mul_f32 v9, v45, v9
    v_mul_f32 v10, v46, v10
    v_mul_f32 v11, v47, v11
    v_cvt_pk_bf16_f32 v80, v4, v5
    v_cvt_pk_bf16_f32 v81, v6, v7
    v_cvt_pk_bf16_f32 v82, v8, v9
    v_cvt_pk_bf16_f32 v83, v10, v11
    s_waitcnt lgkmcnt(6)
    v_mul_f32 v12, v40, v12
    v_mul_f32 v13, v41, v13
    v_mul_f32 v14, v42, v14
    v_mul_f32 v15, v43, v15
    v_mul_f32 v16, v44, v16
    v_mul_f32 v17, v45, v17
    v_mul_f32 v18, v46, v18
    v_mul_f32 v19, v47, v19
    v_cvt_pk_bf16_f32 v84, v12, v13
    v_cvt_pk_bf16_f32 v85, v14, v15
    v_cvt_pk_bf16_f32 v86, v16, v17
    v_cvt_pk_bf16_f32 v87, v18, v19
    s_waitcnt lgkmcnt(4)
    v_lshlrev_b32 v48, 16, v20
    v_and_b32 v49, 0xffff0000, v20
    v_lshlrev_b32 v50, 16, v21
    v_and_b32 v51, 0xffff0000, v21
    v_lshlrev_b32 v52, 16, v22
    v_and_b32 v53, 0xffff0000, v22
    v_lshlrev_b32 v54, 16, v23
    v_and_b32 v55, 0xffff0000, v23
    s_waitcnt lgkmcnt(2)
    v_mul_f32 v24, v48, v24
    v_mul_f32 v25, v49, v25
    v_mul_f32 v26, v50, v26
    v_mul_f32 v27, v51, v27
    v_mul_f32 v28, v52, v28
    v_mul_f32 v29, v53, v29
    v_mul_f32 v30, v54, v30
    v_mul_f32 v31, v55, v31
    v_cvt_pk_bf16_f32 v88, v24, v25
    v_cvt_pk_bf16_f32 v89, v26, v27
    v_cvt_pk_bf16_f32 v90, v28, v29
    v_cvt_pk_bf16_f32 v91, v30, v31
    s_waitcnt lgkmcnt(0)
    v_mul_f32 v32, v48, v32
    v_mul_f32 v33, v49, v33
    v_mul_f32 v34, v50, v34
    v_mul_f32 v35, v51, v35
    v_mul_f32 v36, v52, v36
    v_mul_f32 v37, v53, v37
    v_mul_f32 v38, v54, v38
    v_mul_f32 v39, v55, v39
    v_cvt_pk_bf16_f32 v92, v32, v33
    v_cvt_pk_bf16_f32 v93, v34, v35
    v_cvt_pk_bf16_f32 v94, v36, v37
    v_cvt_pk_bf16_f32 v95, v38, v39
    s_waitcnt vmcnt(4)
    v_mfma_f32_32x32x16_bf16 v[0:15], v[64:67], v[176:179], 0
    ds_read_b64_tr_b16 v[184:185], v246 offset:2048
    ds_read_b64_tr_b16 v[186:187], v246 offset:2560
    ds_read_b64_tr_b16 v[188:189], v247 offset:2048
    ds_read_b64_tr_b16 v[190:191], v247 offset:2560
    s_mov_b32 m0, s68
    v_mfma_f32_32x32x16_bf16 v[16:31], v[68:71], v[176:179], 0
    buffer_load_dwordx4 v222, s[4:7], s41 offen sc1 lds
    buffer_load_dwordx4 v223, s[72:75], s41 offen offset:1024 sc1 lds
    v_permlane32_swap_b32 v242, v236
    v_permlane32_swap_b32 v243, v237
    s_add_u32 s38, s38, 1
    v_mfma_f32_32x32x16_bf16 v[32:47], v[64:67], v[180:183], 0
    v_permlane32_swap_b32 v244, v238
    v_permlane32_swap_b32 v245, v239
    v_permlane32_swap_b32 v240, v241
    v_add_f32 v242, v242, v236
    v_mfma_f32_32x32x16_bf16 v[48:63], v[68:71], v[180:183], 0
    v_add_f32 v243, v243, v237
    v_add_f32 v244, v244, v238
    v_add_f32 v245, v245, v239
    v_add_f32 v240, -v240, -v241
    v_mov_b32 v254, s52
    v_mov_b32 v255, s38
    s_waitcnt vmcnt(4) lgkmcnt(0)
    v_mfma_f32_32x32x16_bf16 v[0:15], v[72:75], v[184:187], v[0:15]
    ds_read_b64_tr_b16 v[176:177], v246 offset:4096
    ds_read_b64_tr_b16 v[178:179], v246 offset:4608
    ds_read_b64_tr_b16 v[180:181], v247 offset:4096
    ds_read_b64_tr_b16 v[182:183], v247 offset:4608
    s_lshl_b32 s58, s38, 3
    s_add_u32 s58, s58, s20
    s_mov_b32 m0, s69
    v_mfma_f32_32x32x16_bf16 v[16:31], v[76:79], v[184:187], v[16:31]
    buffer_load_dwordx4 v224, s[4:7], s41 offen sc1 lds
    buffer_load_dwordx4 v225, s[72:75], s41 offen offset:1024 sc1 lds
    s_set_gpr_idx_on s32, gpr_idx(DST)
    s_nop 0
    v_cvt_pk_bf16_f32 v195, v242, v243
    v_cvt_pk_bf16_f32 v196, v244, v245
    v_cvt_pk_bf16_f32 v197, v240, v240
    s_set_gpr_idx_off
    s_mov_b64 exec, 1
    ds_write_b32 v254, v255
    s_mov_b64 exec, -1
    s_cmp_lt_u32 s58, s22
    s_cbranch_scc0 K2_dyn_61
K2_back_62:
    v_readlane_b32 s3, v253, s58
    s_lshl_b32 s44, s34, 7
    s_lshl_b32 s60, s58, 5
    s_and_b32 s48, s3, 0x3ffff
    s_bfe_u32 s33, s3, 0x30012
    s_sub_u32 s60, s60, s48
    s_and_b32 s60, s60, 0xff
    s_add_u32 s60, s60, s48
    s_mul_i32 s35, s38, 6
    s_cmp_eq_u32 s34, 0
    s_cselect_b32 s35, s35, s60
    s_mov_b32 s45, s44
    s_add_u32 s47, s44, 256
    s_add_u32 s49, s48, 32
    s_add_u32 s60, s48, 64
    s_cmp_eq_u32 s33, 3
    s_cselect_b32 s46, s44, s47
    s_cselect_b32 s50, s60, s48
    s_cselect_b32 s51, s48, s49
    s_sub_u32 s60, s33, 2
    s_cmp_lt_u32 s60, 2
    s_cbranch_scc0 K2_rare_67
K2_back_68:
    v_mfma_f32_32x32x16_bf16 v[32:47], v[72:75], v[188:191], v[32:47]
    v_add_u32 v233, s48, v230
    ds_read_b32 v232, v233
    ds_read_b32 v233, v233 offset:1024
    v_mfma_f32_32x32x16_bf16 v[48:63], v[76:79], v[188:191], v[48:63]
    s_waitcnt vmcnt(4) lgkmcnt(3)
    v_mfma_f32_32x32x16_bf16 v[0:15], v[80:83], v[176:179], v[0:15]
    ds_read_b64_tr_b16 v[184:185], v246 offset:6144
    ds_read_b64_tr_b16 v[186:187], v246 offset:6656
    ds_read_b64_tr_b16 v[188:189], v247 offset:6144
    ds_read_b64_tr_b16 v[190:191], v247 offset:6656
    s_mov_b32 m0, s70
    v_mfma_f32_32x32x16_bf16 v[16:31], v[84:87], v[176:179], v[16:31]
    buffer_load_dwordx4 v226, s[4:7], s41 offen sc1 lds
    buffer_load_dwordx4 v227, s[72:75], s41 offen offset:1024 sc1 lds
    v_mfma_f32_32x32x16_bf16 v[32:47], v[80:83], v[180:183], v[32:47]
    v_mfma_f32_32x32x16_bf16 v[48:63], v[84:87], v[180:183], v[48:63]
    s_waitcnt lgkmcnt(4)
    v_or_b32 v232, v232, v231
    v_or_b32 v233, v233, v231
    s_cmp_lg_u32 s34, 0
    s_cbranch_scc1 K2_dum_70
    s_add_u32 m0, s48, 864
    s_add_u32 s65, s48, 1888
    buffer_load_dwordx4 v232, s[16:19], 0 offen  lds
    s_mov_b32 m0, s65
    s_mov_b32 exec_hi, 0
    buffer_load_dwordx4 v233, s[16:19], 0 offen  lds
    s_cmp_eq_u32 s33, 4
    s_cbranch_scc1 K2_a4_71
K2_b4_73:
    s_mov_b32 exec_hi, -1
K2_back_72:
    s_waitcnt vmcnt(6) lgkmcnt(0)
    v_mfma_f32_32x32x16_bf16 v[0:15], v[88:91], v[184:187], v[0:15]
    ds_read_b64_tr_b16 v[176:177], v246 offset:0
    ds_read_b64_tr_b16 v[178:179], v246 offset:512
    ds_read_b64_tr_b16 v[180:181], v247 offset:0
    ds_read_b64_tr_b16 v[182:183], v247 offset:512
    s_mov_b32 m0, s71
    v_mfma_f32_32x32x16_bf16 v[16:31], v[92:95], v[184:187], v[16:31]
    buffer_load_dwordx4 v228, s[4:7], s41 offen sc1 lds
    buffer_load_dwordx4 v229, s[72:75], s41 offen offset:1024 sc1 lds
    v_mfma_f32_32x32x16_bf16 v[32:47], v[88:91], v[188:191], v[32:47]
    s_nop 2
    v_mul_f32 v234, v0, v96
    v_mul_f32 v236, v8, v128
    v_fmac_f32 v234, v1, v97
    v_fmac_f32 v236, v9, v129
    v_fmac_f32 v234, v2, v98
    v_fmac_f32 v236, v10, v130
    v_fmac_f32 v234, v3, v99
    v_mfma_f32_32x32x16_bf16 v[48:63], v[92:95], v[188:191], v[48:63]
    s_setprio 0
    v_fmac_f32 v236, v11, v131
    v_fmac_f32 v234, v4, v100
    v_fmac_f32 v236, v12, v132
    v_fmac_f32 v234, v5, v101
    v_fmac_f32 v236, v13, v133
    v_fmac_f32 v234, v6, v102
    v_fmac_f32 v236, v14, v134
    v_fmac_f32 v234, v7, v103
    v_fmac_f32 v236, v15, v135
    v_mul_f32 v238, v16, v128
    v_mul_f32 v240, v24, v128
    v_fmac_f32 v238, v17, v129
    v_fmac_f32 v240, v25, v129
    v_fmac_f32 v238, v18, v130
    v_fmac_f32 v240, v26, v130
    v_fmac_f32 v238, v19, v131
    v_fmac_f32 v240, v27, v131
    v_fmac_f32 v238, v20, v132
    v_fmac_f32 v240, v28, v132
    v_fmac_f32 v238, v21, v133
    v_fmac_f32 v240, v29, v133
    v_fmac_f32 v238, v22, v134
    v_fmac_f32 v240, v30, v134
    v_fmac_f32 v238, v23, v135
    v_fmac_f32 v240, v31, v135
    v_mul_f32 v235, v32, v104
    v_mul_f32 v237, v40, v136
    v_fmac_f32 v235, v33, v105
    v_fmac_f32 v237, v41, v137
    v_fmac_f32 v235, v34, v106
    v_fmac_f32 v237, v42, v138
    v_fmac_f32 v235, v35, v107
    v_fmac_f32 v237, v43, v139
    v_fmac_f32 v235, v36, v108
    v_fmac_f32 v237, v44, v140
    v_fmac_f32 v235, v37, v109
    v_fmac_f32 v237, v45, v141
    v_fmac_f32 v235, v38, v110
    v_fmac_f32 v237, v46, v142
    v_fmac_f32 v235, v39, v111
    v_fmac_f32 v237, v47, v143
    v_mul_f32 v239, v48, v136
    v_mul_f32 v241, v56, v136
    s_setprio 1
    s_waitcnt vmcnt(6) lgkmcnt(0)
    v_mfma_f32_32x32x16_bf16 v[0:15], v[64:67], v[176:179], 0
    ds_read_b64_tr_b16 v[184:185], v246 offset:2048
    ds_read_b64_tr_b16 v[186:187], v246 offset:2560
    ds_read_b64_tr_b16 v[188:189], v247 offset:2048
    ds_read_b64_tr_b16 v[190:191], v247 offset:2560
    v_fmac_f32 v239, v49, v137
    v_fmac_f32 v241, v57, v137
    s_mov_b32 m0, s68
    v_mfma_f32_32x32x16_bf16 v[16:31], v[68:71], v[176:179], 0
    buffer_load_dwordx4 v222, s[4:7], s42 offen sc1 lds
    buffer_load_dwordx4 v223, s[72:75], s42 offen offset:1024 sc1 lds
    v_fmac_f32 v239, v50, v138
    v_fmac_f32 v241, v58, v138
    v_fmac_f32 v239, v51, v139
    v_fmac_f32 v241, v59, v139
    v_fmac_f32 v239, v52, v140
    v_mfma_f32_32x32x16_bf16 v[32:47], v[64:67], v[180:183], 0
    v_fmac_f32 v241, v60, v140
    v_fmac_f32 v239, v53, v141
    v_fmac_f32 v241, v61, v141
    v_fmac_f32 v239, v54, v142
    v_fmac_f32 v241, v62, v142
    v_fmac_f32 v239, v55, v143
    v_fmac_f32 v241, v63, v143
    v_mfma_f32_32x32x16_bf16 v[48:63], v[68:71], v[180:183], 0
    v_permlane32_swap_b32 v234, v236
    v_permlane32_swap_b32 v235, v237
    v_permlane32_swap_b32 v240, v238
    s_waitcnt vmcnt(6) lgkmcnt(0)
    v_mfma_f32_32x32x16_bf16 v[0:15], v[72:75], v[184:187], v[0:15]
    ds_read_b64_tr_b16 v[176:177], v246 offset:4096
    ds_read_b64_tr_b16 v[178:179], v246 offset:4608
    ds_read_b64_tr_b16 v[180:181], v247 offset:4096
    ds_read_b64_tr_b16 v[182:183], v247 offset:4608
    v_permlane32_swap_b32 v241, v239
    s_mov_b32 m0, s69
    v_mfma_f32_32x32x16_bf16 v[16:31], v[76:79], v[184:187], v[16:31]
    buffer_load_dwordx4 v224, s[4:7], s42 offen sc1 lds
    buffer_load_dwordx4 v225, s[72:75], s42 offen offset:1024 sc1 lds
    v_add_f32 v234, v234, v236
    v_add_f32 v235, v235, v237
    v_add_f32 v240, v240, v238
    v_add_f32 v241, v241, v239
    v_mfma_f32_32x32x16_bf16 v[32:47], v[72:75], v[188:191], v[32:47]
    s_set_gpr_idx_on s31, gpr_idx(DST)
    s_nop 0
    v_cvt_pk_bf16_f32 v192, v234, v235
    v_cvt_pk_bf16_f32 v193, v240, v241
    s_set_gpr_idx_off
    v_mfma_f32_32x32x16_bf16 v[48:63], v[76:79], v[188:191], v[48:63]
    s_waitcnt vmcnt(4) lgkmcnt(0)
    v_mfma_f32_32x32x16_bf16 v[0:15], v[80:83], v[176:179], v[0:15]
    ds_read_b64_tr_b16 v[184:185], v246 offset:6144
    ds_read_b64_tr_b16 v[186:187], v246 offset:6656
    ds_read_b64_tr_b16 v[188:189], v247 offset:6144
    ds_read_b64_tr_b16 v[190:191], v247 offset:6656
    s_mov_b32 m0, s70
    v_mfma_f32_32x32x16_bf16 v[16:31], v[84:87], v[176:179], v[16:31]
    buffer_load_dwordx4 v226, s[4:7], s42 offen sc1 lds
    buffer_load_dwordx4 v227, s[72:75], s42 offen offset:1024 sc1 lds
    v_mfma_f32_32x32x16_bf16 v[32:47], v[80:83], v[180:183], v[32:47]
    v_mfma_f32_32x32x16_bf16 v[48:63], v[84:87], v[180:183], v[48:63]
    s_waitcnt vmcnt(4) lgkmcnt(0)
    v_mfma_f32_32x32x16_bf16 v[0:15], v[88:91], v[184:187], v[0:15]
    ds_read_b64_tr_b16 v[176:177], v246 offset:0
    ds_read_b64_tr_b16 v[178:179], v246 offset:512
    ds_read_b64_tr_b16 v[180:181], v247 offset:0
    ds_read_b64_tr_b16 v[182:183], v247 offset:512
    s_mov_b32 m0, s71
    v_mfma_f32_32x32x16_bf16 v[16:31], v[92:95], v[184:187], v[16:31]
    buffer_load_dwordx4 v228, s[4:7], s42 offen sc1 lds
    buffer_load_dwordx4 v229, s[72:75], s42 offen offset:1024 sc1 lds
    v_mfma_f32_32x32x16_bf16 v[32:47], v[88:91], v[188:191], v[32:47]
    s_nop 2
    v_mul_f32 v234, v0, v144
    v_mul_f32 v236, v8, v112
    v_fmac_f32 v234, v1, v145
    v_fmac_f32 v236, v9, v113
    v_fmac_f32 v234, v2, v146
    v_fmac_f32 v236, v10, v114
    v_fmac_f32 v234, v3, v147
    v_mfma_f32_32x32x16_bf16 v[48:63], v[92:95], v[188:191], v[48:63]
    s_setprio 0
    v_fmac_f32 v236, v11, v115
    v_fmac_f32 v234, v4, v148
    v_fmac_f32 v236, v12, v116
    v_fmac_f32 v234, v5, v149
    v_fmac_f32 v236, v13, v117
    v_fmac_f32 v234, v6, v150
    v_fmac_f32 v236, v14, v118
    v_fmac_f32 v234, v7, v151
    v_fmac_f32 v236, v15, v119
    v_mul_f32 v238, v16, v160
    v_mul_f32 v240, v24, v160
    v_fmac_f32 v238, v17, v161
    v_fmac_f32 v240, v25, v161
    v_fmac_f32 v238, v18, v162
    v_fmac_f32 v240, v26, v162
    v_fmac_f32 v238, v19, v163
    v_fmac_f32 v240, v27, v163
    v_fmac_f32 v238, v20, v164
    v_fmac_f32 v240, v28, v164
    v_fmac_f32 v238, v21, v165
    v_fmac_f32 v240, v29, v165
    v_fmac_f32 v238, v22, v166
    v_fmac_f32 v240, v30, v166
    v_fmac_f32 v238, v23, v167
    v_fmac_f32 v240, v31, v167
    v_mul_f32 v235, v32, v152
    v_mul_f32 v237, v40, v120
    v_fmac_f32 v235, v33, v153
    v_fmac_f32 v237, v41, v121
    v_fmac_f32 v235, v34, v154
    v_fmac_f32 v237, v42, v122
    v_fmac_f32 v235, v35, v155
    v_fmac_f32 v237, v43, v123
    v_fmac_f32 v235, v36, v156
    v_fmac_f32 v237, v44, v124
    v_fmac_f32 v235, v37, v157
    v_fmac_f32 v237, v45, v125
    v_fmac_f32 v235, v38, v158
    v_fmac_f32 v237, v46, v126
    v_fmac_f32 v235, v39, v159
    v_fmac_f32 v237, v47, v127
    v_mul_f32 v239, v48, v168
    v_mul_f32 v241, v56, v168
    s_setprio 1
    s_waitcnt vmcnt(4) lgkmcnt(0)
    v_mfma_f32_32x32x16_bf16 v[0:15], v[64:67], v[176:179], 0
    ds_read_b64_tr_b16 v[184:185], v246 offset:2048
    ds_read_b64_tr_b16 v[186:187], v246 offset:2560
    ds_read_b64_tr_b16 v[188:189], v247 offset:2048
    ds_read_b64_tr_b16 v[190:191], v247 offset:2560
    v_fmac_f32 v239, v49, v169
    v_fmac_f32 v241, v57, v169
    s_mov_b32 m0, s68
    v_mfma_f32_32x32x16_bf16 v[16:31], v[68:71], v[176:179], 0
    buffer_load_dwordx4 v222, s[4:7], s43 offen sc1 lds
    buffer_load_dwordx4 v223, s[72:75], s43 offen offset:1024 sc1 lds
    v_fmac_f32 v239, v50, v170
    v_fmac_f32 v241, v58, v170
    v_fmac_f32 v239, v51, v171
    v_fmac_f32 v241, v59, v171
    v_fmac_f32 v239, v52, v172
    v_mfma_f32_32x32x16_bf16 v[32:47], v[64:67], v[180:183], 0
    v_fmac_f32 v241, v60, v172
    v_fmac_f32 v239, v53, v173
    v_fmac_f32 v241, v61, v173
    v_fmac_f32 v239, v54, v174
    v_fmac_f32 v241, v62, v174
    v_fmac_f32 v239, v55, v175
    v_fmac_f32 v241, v63, v175
    v_mfma_f32_32x32x16_bf16 v[48:63], v[68:71], v[180:183], 0
    s_waitcnt vmcnt(4) lgkmcnt(0)
    v_mfma_f32_32x32x16_bf16 v[0:15], v[72:75], v[184:187], v[0:15]
    ds_read_b64_tr_b16 v[176:177], v246 offset:4096
    ds_read_b64_tr_b16 v[178:179], v246 offset:4608
    ds_read_b64_tr_b16 v[180:181], v247 offset:4096
    ds_read_b64_tr_b16 v[182:183], v247 offset:4608
    s_mov_b32 m0, s69
    v_mfma_f32_32x32x16_bf16 v[16:31], v[76:79], v[184:187], v[16:31]
    buffer_load_dwordx4 v224, s[4:7], s43 offen sc1 lds
    buffer_load_dwordx4 v225, s[72:75], s43 offen offset:1024 sc1 lds
    v_mfma_f32_32x32x16_bf16 v[32:47], v[72:75], v[188:191], v[32:47]
    v_mfma_f32_32x32x16_bf16 v[48:63], v[76:79], v[188:191], v[48:63]
    s_waitcnt vmcnt(4) lgkmcnt(0)
    v_mfma_f32_32x32x16_bf16 v[0:15], v[80:83], v[176:179], v[0:15]
    ds_read_b64_tr_b16 v[184:185], v246 offset:6144
    ds_read_b64_tr_b16 v[186:187], v246 offset:6656
    ds_read_b64_tr_b16 v[188:189], v247 offset:6144
    ds_read_b64_tr_b16 v[190:191], v247 offset:6656
    s_mov_b32 m0, s70
    v_mfma_f32_32x32x16_bf16 v[16:31], v[84:87], v[176:179], v[16:31]
    buffer_load_dwordx4 v226, s[4:7], s43 offen sc1 lds
    buffer_load_dwordx4 v227, s[72:75], s43 offen offset:1024 sc1 lds
    v_mfma_f32_32x32x16_bf16 v[32:47], v[80:83], v[180:183], v[32:47]
    v_add_u32 v222, s48, v251
    ds_read_b32 v222, v222
    v_mfma_f32_32x32x16_bf16 v[48:63], v[84:87], v[180:183], v[48:63]
    s_waitcnt vmcnt(4) lgkmcnt(1)
    v_mfma_f32_32x32x16_bf16 v[0:15], v[88:91], v[184:187], v[0:15]
    ds_read_b64_tr_b16 v[176:177], v246 offset:0
    ds_read_b64_tr_b16 v[178:179], v246 offset:512
    ds_read_b64_tr_b16 v[180:181], v247 offset:0
    ds_read_b64_tr_b16 v[182:183], v247 offset:512
    s_mov_b32 m0, s71
    v_mfma_f32_32x32x16_bf16 v[16:31], v[92:95], v[184:187], v[16:31]
    buffer_load_dwordx4 v228, s[4:7], s43 offen sc1 lds
    buffer_load_dwordx4 v229, s[72:75], s43 offen offset:1024 sc1 lds
    s_waitcnt lgkmcnt(4)
    v_mad_u32_u16 v223, v222, s39, v248 op_sel:[1,0,0,0]
    v_mad_u32_u16 v222, v222, s39, v248
    v_mfma_f32_32x32x16_bf16 v[32:47], v[88:91], v[188:191], v[32:47]
    v_add_u32 v224, s49, v251
    ds_read_b32 v224, v224
    v_mul_f32 v242, v0, v144
    v_fma_f32 v238, v8, v160, -v238
    v_fmac_f32 v242, v1, v145
    v_fmac_f32 v238, v9, v161
    v_fmac_f32 v242, v2, v146
    v_mfma_f32_32x32x16_bf16 v[48:63], v[92:95], v[188:191], v[48:63]
    s_setprio 0
    v_fmac_f32 v238, v10, v162
    v_fmac_f32 v242, v3, v147
    v_fmac_f32 v238, v11, v163
    v_fmac_f32 v242, v4, v148
    v_fmac_f32 v238, v12, v164
    v_fmac_f32 v242, v5, v149
    v_fmac_f32 v238, v13, v165
    v_fmac_f32 v242, v6, v150
    v_fmac_f32 v238, v14, v166
    v_fmac_f32 v242, v7, v151
    v_fmac_f32 v238, v15, v167
    v_fmac_f32 v236, v16, v112
    v_mul_f32 v244, v24, v160
    v_fmac_f32 v236, v17, v113
    v_fmac_f32 v244, v25, v161
    v_fmac_f32 v236, v18, v114
    v_fmac_f32 v244, v26, v162
    v_fmac_f32 v236, v19, v115
    v_fmac_f32 v244, v27, v163
    v_fmac_f32 v236, v20, v116
    v_fmac_f32 v244, v28, v164
    v_fmac_f32 v236, v21, v117
    v_fmac_f32 v244, v29, v165
    v_fmac_f32 v236, v22, v118
    v_fmac_f32 v244, v30, v166
    v_fmac_f32 v236, v23, v119
    v_fmac_f32 v244, v31, v167
    v_mul_f32 v243, v32, v152
    v_fma_f32 v239, v40, v168, -v239
    v_fmac_f32 v243, v33, v153
    v_fmac_f32 v239, v41, v169
    v_fmac_f32 v243, v34, v154
    v_fmac_f32 v239, v42, v170
    v_fmac_f32 v243, v35, v155
    v_fmac_f32 v239, v43, v171
    v_fmac_f32 v243, v36, v156
    v_fmac_f32 v239, v44, v172
    v_fmac_f32 v243, v37, v157
    v_fmac_f32 v239, v45, v173
    v_fmac_f32 v243, v38, v158
    v_fmac_f32 v239, v46, v174
    v_fmac_f32 v243, v39, v159
    v_fmac_f32 v239, v47, v175
    v_fmac_f32 v237, v48, v120
    v_mul_f32 v245, v56, v168
    v_fmac_f32 v237, v49, v121
    v_fmac_f32 v245, v57, v169
    v_fmac_f32 v237, v50, v122
    v_fmac_f32 v245, v58, v170
    v_fmac_f32 v237, v51, v123
    s_setprio 1
    s_waitcnt vmcnt(4) lgkmcnt(1)
    v_mfma_f32_32x32x16_bf16 v[0:15], v[64:67], v[176:179], 0
    ds_read_b64_tr_b16 v[184:185], v246 offset:2048
    ds_read_b64_tr_b16 v[186:187], v246 offset:2560
    ds_read_b64_tr_b16 v[188:189], v247 offset:2048
    ds_read_b64_tr_b16 v[190:191], v247 offset:2560
    v_fmac_f32 v245, v59, v171
    v_fmac_f32 v237, v52, v124
    s_mov_b32 m0, s68
    v_mfma_f32_32x32x16_bf16 v[16:31], v[68:71], v[176:179], 0
    buffer_load_dwordx4 v222, s[4:7], s44 offen sc1 lds
    buffer_load_dwordx4 v223, s[72:75], s44 offen offset:1024 sc1 lds
    s_waitcnt lgkmcnt(4)
    v_mad_u32_u16 v225, v224, s39, v248 op_sel:[1,0,0,0]
    v_mad_u32_u16 v224, v224, s39, v248
    v_fmac_f32 v245, v60, v172
    v_fmac_f32 v237, v53, v125
    v_mfma_f32_32x32x16_bf16 v[32:47], v[64:67], v[180:183], 0
    v_add_u32 v226, s50, v251
    ds_read_b32 v226, v226
    v_fmac_f32 v245, v61, v173
    v_fmac_f32 v237, v54, v126
    v_fmac_f32 v245, v62, v174
    v_fmac_f32 v237, v55, v127
    v_fmac_f32 v245, v63, v175
    v_mfma_f32_32x32x16_bf16 v[48:63], v[68:71], v[180:183], 0
    v_permlane32_swap_b32 v242, v234
    v_permlane32_swap_b32 v243, v235
    v_add_f32 v242, v242, v234
    v_add_f32 v243, v243, v235
    s_waitcnt vmcnt(4) lgkmcnt(1)
    v_mfma_f32_32x32x16_bf16 v[0:15], v[72:75], v[184:187], v[0:15]
    ds_read_b64_tr_b16 v[176:177], v246 offset:4096
    ds_read_b64_tr_b16 v[178:179], v246 offset:4608
    ds_read_b64_tr_b16 v[180:181], v247 offset:4096
    ds_read_b64_tr_b16 v[182:183], v247 offset:4608
    s_mov_b32 m0, s69
    v_mfma_f32_32x32x16_bf16 v[16:31], v[76:79], v[184:187], v[16:31]
    buffer_load_dwordx4 v224, s[4:7], s45 offen sc1 lds
    buffer_load_dwordx4 v225, s[72:75], s45 offen offset:1024 sc1 lds
    s_waitcnt lgkmcnt(4)
    v_mad_u32_u16 v227, v226, s39, v248 op_sel:[1,0,0,0]
    v_mad_u32_u16 v226, v226, s39, v248
    v_mfma_f32_32x32x16_bf16 v[32:47], v[72:75], v[188:191], v[32:47]
    v_add_u32 v228, s51, v251
    ds_read_b32 v228, v228
    s_set_gpr_idx_on s31, gpr_idx(DST)
    s_nop 0
    v_cvt_pk_bf16_f32 v194, v242, v243
    s_set_gpr_idx_off
    v_mfma_f32_32x32x16_bf16 v[48:63], v[76:79], v[188:191], v[48:63]
    s_waitcnt vmcnt(4) lgkmcnt(1)
    v_mfma_f32_32x32x16_bf16 v[0:15], v[80:83], v[176:179], v[0:15]
    ds_read_b64_tr_b16 v[184:185], v246 offset:6144
    ds_read_b64_tr_b16 v[186:187], v246 offset:6656
    ds_read_b64_tr_b16 v[188:189], v247 offset:6144
    ds_read_b64_tr_b16 v[190:191], v247 offset:6656
    s_mov_b32 s32, s31
    s_mov_b32 s31, s35
    s_mov_b32 m0, s70
    v_mfma_f32_32x32x16_bf16 v[16:31], v[84:87], v[176:179], v[16:31]
    buffer_load_dwordx4 v226, s[4:7], s46 offen sc1 lds
    buffer_load_dwordx4 v227, s[72:75], s46 offen offset:1024 sc1 lds
    s_waitcnt lgkmcnt(4)
    v_mad_u32_u16 v229, v228, s39, v248 op_sel:[1,0,0,0]
    v_mad_u32_u16 v228, v228, s39, v248
    s_sub_u32 s26, s48, s29
    s_mov_b32 s29, s48
    v_mfma_f32_32x32x16_bf16 v[32:47], v[80:83], v[180:183], v[32:47]
    s_mov_b32 s30, s3
    s_cmp_eq_u32 s34, 0
    s_cselect_b32 s56, s33, 0
    v_mfma_f32_32x32x16_bf16 v[48:63], v[84:87], v[180:183], v[48:63]
    s_waitcnt vmcnt(4) lgkmcnt(0)
    v_mfma_f32_32x32x16_bf16 v[0:15], v[88:91], v[184:187], v[0:15]
    ds_read_b64_tr_b16 v[176:177], v246 offset:0
    ds_read_b64_tr_b16 v[178:179], v246 offset:512
    ds_read_b64_tr_b16 v[180:181], v247 offset:0
    ds_read_b64_tr_b16 v[182:183], v247 offset:512
    s_mov_b32 m0, s71
    v_mfma_f32_32x32x16_bf16 v[16:31], v[92:95], v[184:187], v[16:31]
    buffer_load_dwordx4 v228, s[4:7], s47 offen sc1 lds
    buffer_load_dwordx4 v229, s[72:75], s47 offen offset:1024 sc1 lds
    v_mfma_f32_32x32x16_bf16 v[32:47], v[88:91], v[188:191], v[32:47]
    s_nop 2
    v_mul_f32 v242, v0, v144
    v_fma_f32 v240, v8, v160, -v240
    v_fmac_f32 v242, v1, v145
    v_fmac_f32 v240, v9, v161
    v_fmac_f32 v242, v2, v146
    v_fmac_f32 v240, v10, v162
    v_fmac_f32 v242, v3, v147
    v_mfma_f32_32x32x16_bf16 v[48:63], v[92:95], v[188:191], v[48:63]
    s_setprio 0
    v_fmac_f32 v240, v11, v163
    v_fmac_f32 v242, v4, v148
    v_fmac_f32 v240, v12, v164
    v_fmac_f32 v242, v5, v149
    v_fmac_f32 v240, v13, v165
    v_fmac_f32 v242, v6, v150
    v_fmac_f32 v240, v14, v166
    v_fmac_f32 v242, v7, v151
    v_fmac_f32 v240, v15, v167
    v_add_u32 v249, s26, v249
    v_add_u32 v250, s26, v250
    v_fma_f32 v244, v16, v160, -v244
    v_fmac_f32 v236, v24, v112
    v_fmac_f32 v244, v17, v161
    v_fmac_f32 v236, v25, v113
    v_fmac_f32 v244, v18, v162
    v_fmac_f32 v236, v26, v114
    v_fmac_f32 v244, v19, v163
    v_fmac_f32 v236, v27, v115
    v_fmac_f32 v244, v20, v164
    v_fmac_f32 v236, v28, v116
    v_fmac_f32 v244, v21, v165
    v_fmac_f32 v236, v29, v117
    v_fmac_f32 v244, v22, v166
    v_fmac_f32 v236, v30, v118
    v_fmac_f32 v244, v23, v167
    v_fmac_f32 v236, v31, v119
    ds_read_b64_tr_b16 v[0:1], v249 offset:0
    ds_read_b64_tr_b16 v[2:3], v249 offset:128
    ds_read_b128 v[4:7], v250 offset:0
    ds_read_b128 v[8:11], v250 offset:16
    ds_read_b128 v[12:15], v250 offset:384
    ds_read_b128 v[16:19], v250 offset:400
    v_mul_f32 v243, v32, v152
    v_fma_f32 v241, v40, v168, -v241
    v_fmac_f32 v243, v33, v153
    v_fmac_f32 v241, v41, v169
    v_fmac_f32 v243, v34, v154
    v_fmac_f32 v241, v42, v170
    v_fmac_f32 v243, v35, v155
    v_fmac_f32 v241, v43, v171
    v_fmac_f32 v243, v36, v156
    v_fmac_f32 v241, v44, v172
    v_fmac_f32 v243, v37, v157
    v_fmac_f32 v241, v45, v173
    v_fmac_f32 v243, v38, v158
    v_fmac_f32 v241, v46, v174
    v_fmac_f32 v243, v39, v159
    v_fmac_f32 v241, v47, v175
    ds_read_b64_tr_b16 v[20:21], v249 offset:512
    ds_read_b64_tr_b16 v[22:23], v249 offset:640
    ds_read_b128 v[24:27], v250 offset:64
    ds_read_b128 v[28:31], v250 offset:80
    ds_read_b128 v[32:35], v250 offset:448
    ds_read_b128 v[36:39], v250 offset:464
    v_fma_f32 v245, v48, v168, -v245
    v_fmac_f32 v237, v56, v120
    v_fmac_f32 v245, v49, v169
    v_fmac_f32 v237, v57, v121
    v_fmac_f32 v245, v50, v170
    v_fmac_f32 v237, v58, v122
    v_fmac_f32 v245, v51, v171
    v_fmac_f32 v237, v59, v123
    v_fmac_f32 v245, v52, v172
    v_fmac_f32 v237, v60, v124
    v_fmac_f32 v245, v53, v173
    v_fmac_f32 v237, v61, v125
    v_fmac_f32 v245, v54, v174
    v_fmac_f32 v237, v62, v126
    v_fmac_f32 v245, v55, v175
    v_fmac_f32 v237, v63, v127
    s_cmp_eq_u32 s56, 2
    s_cbranch_scc1 K2_U20
    s_cmp_eq_u32 s56, 3
    s_cbranch_scc1 K2_U30
    s_branch K2_DSP0
K2_U11:
    s_setprio 1
    v_mov_b32 v254, 163648
    v_mov_b32 v255, 1
    v_lshl_add_u32 v233, v252, 1, s53
    s_mov_b64 exec, 1
    ds_add_rtn_u32 v232, v254, v255
    s_mov_b64 exec, -1
    ds_read_b32 v233, v233
    s_waitcnt lgkmcnt(8)
    v_lshlrev_b32 v40, 16, v0
    v_and_b32 v41, 0xffff0000, v0
    v_lshlrev_b32 v42, 16, v1
    v_and_b32 v43, 0xffff0000, v1
    v_lshlrev_b32 v44, 16, v2
    v_and_b32 v45, 0xffff0000, v2
    v_lshlrev_b32 v46, 16, v3
    v_and_b32 v47, 0xffff0000, v3
    v_mul_f32 v4, v40, v4
    v_mul_f32 v5, v41, v5
    v_mul_f32 v6, v42, v6
    v_mul_f32 v7, v43, v7
    v_mul_f32 v8, v44, v8
    v_mul_f32 v9, v45, v9
    v_mul_f32 v10, v46, v10
    v_mul_f32 v11, v47, v11
    v_cvt_pk_bf16_f32 v64, v4, v5
    v_cvt_pk_bf16_f32 v65, v6, v7
    v_cvt_pk_bf16_f32 v66, v8, v9
    v_cvt_pk_bf16_f32 v67, v10, v11
    v_mul_f32 v12, v40, v12
    v_mul_f32 v13, v41, v13
    v_mul_f32 v14, v42, v14
    v_mul_f32 v15, v43, v15
    v_mul_f32 v16, v44, v16
    v_mul_f32 v17, v45, v17
    v_mul_f32 v18, v46, v18
    v_mul_f32 v19, v47, v19
    v_cvt_pk_bf16_f32 v68, v12, v13
    v_cvt_pk_bf16_f32 v69, v14, v15
    v_cvt_pk_bf16_f32 v70, v16, v17
    v_cvt_pk_bf16_f32 v71, v18, v19
    s_waitcnt lgkmcnt(0)
    v_readfirstlane_b32 s58, v232
    s_nop 0
    s_cmp_lt_u32 s58, s22
    s_cbranch_scc0 K2_nul_74
    s_and_b32 s59, s58, 7
    s_lshr_b32 s60, s58, 3
K2_chk_76:
    v_readlane_b32 s61, v233, s59
    s_nop 0
    s_cmp_gt_u32 s61, s60
    s_cbranch_scc0 K2_spin_75
K2_back_77:
    v_readlane_b32 s3, v253, s58
    s_lshl_b32 s44, s34, 7
    s_lshl_b32 s60, s58, 5
    s_and_b32 s48, s3, 0x3ffff
    s_bfe_u32 s33, s3, 0x30012
    s_sub_u32 s60, s60, s48
    s_and_b32 s60, s60, 0xff
    s_add_u32 s35, s60, s48
    s_mov_b32 s45, s44
    s_add_u32 s47, s44, 256
    s_add_u32 s49, s48, 32
    s_add_u32 s60, s48, 64
    s_cmp_eq_u32 s33, 3
    s_cselect_b32 s46, s44, s47
    s_cselect_b32 s50, s60, s48
    s_cselect_b32 s51, s48, s49
    s_sub_u32 s60, s33, 2
    s_cmp_lt_u32 s60, 2
    s_cbranch_scc0 K2_rare_78
K2_back_79:
    v_add_u32 v222, s48, v251
    ds_read_b32 v222, v222
    v_add_u32 v224, s49, v251
    ds_read_b32 v224, v224
    v_add_u32 v226, s50, v251
    ds_read_b32 v226, v226
    v_add_u32 v228, s51, v251
    ds_read_b32 v228, v228
    s_waitcnt lgkmcnt(3)
    v_mad_u32_u16 v223, v222, s39, v248 op_sel:[1,0,0,0]
    v_mad_u32_u16 v222, v222, s39, v248
    s_waitcnt lgkmcnt(2)
    v_mad_u32_u16 v225, v224, s39, v248 op_sel:[1,0,0,0]
    v_mad_u32_u16 v224, v224, s39, v248
    s_waitcnt lgkmcnt(1)
    v_mad_u32_u16 v227, v226, s39, v248 op_sel:[1,0,0,0]
    v_mad_u32_u16 v226, v226, s39, v248
    s_waitcnt lgkmcnt(0)
    v_mad_u32_u16 v229, v228, s39, v248 op_sel:[1,0,0,0]
    v_mad_u32_u16 v228, v228, s39, v248
    s_waitcnt vmcnt(4)
    v_mfma_f32_32x32x16_bf16 v[0:15], v[64:67], v[176:179], 0
    ds_read_b64_tr_b16 v[184:185], v246 offset:2048
    ds_read_b64_tr_b16 v[186:187], v246 offset:2560
    ds_read_b64_tr_b16 v[188:189], v247 offset:2048
    ds_read_b64_tr_b16 v[190:191], v247 offset:2560
    s_mov_b32 m0, s68
    v_mfma_f32_32x32x16_bf16 v[16:31], v[68:71], v[176:179], 0
    buffer_load_dwordx4 v222, s[4:7], s44 offen sc1 lds
    buffer_load_dwordx4 v223, s[72:75], s44 offen offset:1024 sc1 lds
    v_permlane32_swap_b32 v242, v236
    v_permlane32_swap_b32 v243, v237
    v_mfma_f32_32x32x16_bf16 v[32:47], v[64:67], v[180:183], 0
    v_permlane32_swap_b32 v244, v238
    v_permlane32_swap_b32 v245, v239
    v_permlane32_swap_b32 v240, v241
    v_add_f32 v242, v242, v236
    v_mfma_f32_32x32x16_bf16 v[48:63], v[68:71], v[180:183], 0
    s_setprio 0
    v_add_f32 v243, v243, v237
    v_add_f32 v244, v244, v238
    v_add_f32 v245, v245, v239
    v_add_f32 v240, -v240, -v241
    v_sub_u32 v241, v230, v231
    v_cvt_pk_bf16_f32 v242, v242, v243
    v_cvt_pk_bf16_f32 v244, v244, v245
    v_cvt_pk_bf16_f32 v240, v240, v240
    ds_write_b32 v230, v242 offset:768
    ds_write_b32 v230, v244 offset:1024
    ds_write_b16 v241, v240 offset:1280
    v_mul_f32 v234, v0, v96
    v_mul_f32 v236, v8, v128
    v_fmac_f32 v234, v1, v97
    v_fmac_f32 v236, v9, v129
    v_fmac_f32 v234, v2, v98
    v_fmac_f32 v236, v10, v130
    v_fmac_f32 v234, v3, v99
    v_fmac_f32 v236, v11, v131
    v_fmac_f32 v234, v4, v100
    v_fmac_f32 v236, v12, v132
    v_fmac_f32 v234, v5, v101
    v_fmac_f32 v236, v13, v133
    v_fmac_f32 v234, v6, v102
    v_fmac_f32 v236, v14, v134
    v_fmac_f32 v234, v7, v103
    v_fmac_f32 v236, v15, v135
    v_mul_f32 v238, v16, v128
    v_mul_f32 v240, v24, v128
    v_fmac_f32 v238, v17, v129
    v_fmac_f32 v240, v25, v129
    v_fmac_f32 v238, v18, v130
    v_fmac_f32 v240, v26, v130
    v_fmac_f32 v238, v19, v131
    v_fmac_f32 v240, v27, v131
    v_fmac_f32 v238, v20, v132
    v_fmac_f32 v240, v28, v132
    v_fmac_f32 v238, v21, v133
    v_fmac_f32 v240, v29, v133
    v_fmac_f32 v238, v22, v134
    v_fmac_f32 v240, v30, v134
    v_fmac_f32 v238, v23, v135
    v_fmac_f32 v240, v31, v135
    v_mul_f32 v235, v32, v104
    v_mul_f32 v237, v40, v136
    v_fmac_f32 v235, v33, v105
    v_fmac_f32 v237, v41, v137
    v_fmac_f32 v235, v34, v106
    v_fmac_f32 v237, v42, v138
    v_fmac_f32 v235, v35, v107
    v_fmac_f32 v237, v43, v139
    v_fmac_f32 v235, v36, v108
    v_fmac_f32 v237, v44, v140
    v_fmac_f32 v235, v37, v109
    v_fmac_f32 v237, v45, v141
    v_fmac_f32 v235, v38, v110
    v_fmac_f32 v237, v46, v142
    v_fmac_f32 v235, v39, v111
    v_fmac_f32 v237, v47, v143
    v_mul_f32 v239, v48, v136
    v_mul_f32 v241, v56, v136
    v_fmac_f32 v239, v49, v137
    v_fmac_f32 v241, v57, v137
    v_fmac_f32 v239, v50, v138
    v_fmac_f32 v241, v58, v138
    v_fmac_f32 v239, v51, v139
    v_fmac_f32 v241, v59, v139
    v_fmac_f32 v239, v52, v140
    v_fmac_f32 v241, v60, v140
    v_fmac_f32 v239, v53, v141
    v_fmac_f32 v241, v61, v141
    v_fmac_f32 v239, v54, v142
    v_fmac_f32 v241, v62, v142
    v_fmac_f32 v239, v55, v143
    v_fmac_f32 v241, v63, v143
    s_setprio 1
    s_waitcnt vmcnt(4) lgkmcnt(3)
    v_mfma_f32_32x32x16_bf16 v[0:15], v[64:67], v[184:187], 0
    ds_read_b64_tr_b16 v[176:177], v246 offset:4096
    ds_read_b64_tr_b16 v[178:179], v246 offset:4608
    ds_read_b64_tr_b16 v[180:181], v247 offset:4096
    ds_read_b64_tr_b16 v[182:183], v247 offset:4608
    s_mov_b32 m0, s69
    v_mfma_f32_32x32x16_bf16 v[16:31], v[68:71], v[184:187], 0
    buffer_load_dwordx4 v224, s[4:7], s45 offen sc1 lds
    buffer_load_dwordx4 v225, s[72:75], s45 offen offset:1024 sc1 lds
    v_permlane32_swap_b32 v234, v236
    v_permlane32_swap_b32 v235, v237
    v_mfma_f32_32x32x16_bf16 v[32:47], v[64:67], v[188:191], 0
    v_permlane32_swap_b32 v240, v238
    v_permlane32_swap_b32 v241, v239
    v_lshl_add_u32 v230, v252, 1, s31
    v_add_f32 v234, v234, v236
    v_add_f32 v235, v235, v237
    v_mfma_f32_32x32x16_bf16 v[48:63], v[68:71], v[188:191], 0
    s_setprio 0
    v_add_f32 v240, v240, v238
    v_add_f32 v241, v241, v239
    v_cvt_pk_bf16_f32 v234, v234, v235
    v_cvt_pk_bf16_f32 v240, v240, v241
    ds_write_b32 v230, v234 offset:0
    ds_write_b32 v230, v240 offset:256
    v_mul_f32 v234, v0, v144
    v_mul_f32 v236, v8, v112
    v_fmac_f32 v234, v1, v145
    v_fmac_f32 v236, v9, v113
    v_fmac_f32 v234, v2, v146
    v_fmac_f32 v236, v10, v114
    v_fmac_f32 v234, v3, v147
    v_fmac_f32 v236, v11, v115
    v_fmac_f32 v234, v4, v148
    v_fmac_f32 v236, v12, v116
    v_fmac_f32 v234, v5, v149
    v_fmac_f32 v236, v13, v117
    v_fmac_f32 v234, v6, v150
    v_fmac_f32 v236, v14, v118
    v_fmac_f32 v234, v7, v151
    v_fmac_f32 v236, v15, v119
    v_mul_f32 v238, v16, v160
    v_mul_f32 v240, v24, v160
    v_fmac_f32 v238, v17, v161
    v_fmac_f32 v240, v25, v161
    v_fmac_f32 v238, v18, v162
    v_fmac_f32 v240, v26, v162
    v_fmac_f32 v238, v19, v163
    v_fmac_f32 v240, v27, v163
    v_fmac_f32 v238, v20, v164
    v_fmac_f32 v240, v28, v164
    v_fmac_f32 v238, v21, v165
    v_fmac_f32 v240, v29, v165
    v_fmac_f32 v238, v22, v166
    v_fmac_f32 v240, v30, v166
    v_fmac_f32 v238, v23, v167
    v_fmac_f32 v240, v31, v167
    v_mul_f32 v235, v32, v152
    v_mul_f32 v237, v40, v120
    v_fmac_f32 v235, v33, v153
    v_fmac_f32 v237, v41, v121
    v_fmac_f32 v235, v34, v154
    v_fmac_f32 v237, v42, v122
    v_fmac_f32 v235, v35, v155
    v_fmac_f32 v237, v43, v123
    v_fmac_f32 v235, v36, v156
    v_fmac_f32 v237, v44, v124
    v_fmac_f32 v235, v37, v157
    v_fmac_f32 v237, v45, v125
    v_fmac_f32 v235, v38, v158
    v_fmac_f32 v237, v46, v126
    v_fmac_f32 v235, v39, v159
    v_fmac_f32 v237, v47, v127
    v_mul_f32 v239, v48, v168
    v_mul_f32 v241, v56, v168
    v_fmac_f32 v239, v49, v169
    v_fmac_f32 v241, v57, v169
    v_fmac_f32 v239, v50, v170
    v_fmac_f32 v241, v58, v170
    v_fmac_f32 v239, v51, v171
    v_fmac_f32 v241, v59, v171
    v_fmac_f32 v239, v52, v172
    v_fmac_f32 v241, v60, v172
    v_fmac_f32 v239, v53, v173
    v_fmac_f32 v241, v61, v173
    v_fmac_f32 v239, v54, v174
    v_fmac_f32 v241, v62, v174
    v_fmac_f32 v239, v55, v175
    v_fmac_f32 v241, v63, v175
    s_setprio 1
    s_waitcnt vmcnt(4) lgkmcnt(2)
    v_mfma_f32_32x32x16_bf16 v[0:15], v[64:67], v[176:179], 0
    ds_read_b64_tr_b16 v[184:185], v246 offset:6144
    ds_read_b64_tr_b16 v[186:187], v246 offset:6656
    ds_read_b64_tr_b16 v[188:189], v247 offset:6144
    ds_read_b64_tr_b16 v[190:191], v247 offset:6656
    s_mov_b32 s32, s31
    s_mov_b32 s31, s35
    s_mov_b32 m0, s70
    v_mfma_f32_32x32x16_bf16 v[16:31], v[68:71], v[176:179], 0
    buffer_load_dwordx4 v226, s[4:7], s46 offen sc1 lds
    buffer_load_dwordx4 v227, s[72:75], s46 offen offset:1024 sc1 lds
    s_sub_u32 s26, s48, s29
    s_mov_b32 s29, s48
    s_mov_b32 s30, s3
    s_cmp_lg_u32 s36, 0
    s_cselect_b32 s56, s33, 0
    v_mfma_f32_32x32x16_bf16 v[32:47], v[64:67], v[180:183], 0
    v_mfma_f32_32x32x16_bf16 v[48:63], v[68:71], v[180:183], 0
    s_setprio 0
    v_mul_f32 v242, v0, v144
    v_fma_f32 v238, v8, v160, -v238
    v_fmac_f32 v242, v1, v145
    v_fmac_f32 v238, v9, v161
    v_fmac_f32 v242, v2, v146
    v_fmac_f32 v238, v10, v162
    v_fmac_f32 v242, v3, v147
    v_fmac_f32 v238, v11, v163
    v_fmac_f32 v242, v4, v148
    v_fmac_f32 v238, v12, v164
    v_fmac_f32 v242, v5, v149
    v_fmac_f32 v238, v13, v165
    v_fmac_f32 v242, v6, v150
    v_fmac_f32 v238, v14, v166
    v_fmac_f32 v242, v7, v151
    v_fmac_f32 v238, v15, v167
    v_fmac_f32 v236, v16, v112
    v_mul_f32 v244, v24, v160
    v_fmac_f32 v236, v17, v113
    v_fmac_f32 v244, v25, v161
    v_fmac_f32 v236, v18, v114
    v_fmac_f32 v244, v26, v162
    v_fmac_f32 v236, v19, v115
    v_fmac_f32 v244, v27, v163
    v_fmac_f32 v236, v20, v116
    v_fmac_f32 v244, v28, v164
    v_fmac_f32 v236, v21, v117
    v_fmac_f32 v244, v29, v165
    v_fmac_f32 v236, v22, v118
    v_fmac_f32 v244, v30, v166
    v_fmac_f32 v236, v23, v119
    v_fmac_f32 v244, v31, v167
    v_mul_f32 v243, v32, v152
    v_fma_f32 v239, v40, v168, -v239
    v_fmac_f32 v243, v33, v153
    v_fmac_f32 v239, v41, v169
    v_fmac_f32 v243, v34, v154
    v_fmac_f32 v239, v42, v170
    v_fmac_f32 v243, v35, v155
    v_fmac_f32 v239, v43, v171
    v_fmac_f32 v243, v36, v156
    v_fmac_f32 v239, v44, v172
    v_fmac_f32 v243, v37, v157
    v_fmac_f32 v239, v45, v173
    v_fmac_f32 v243, v38, v158
    v_fmac_f32 v239, v46, v174
    v_fmac_f32 v243, v39, v159
    v_fmac_f32 v239, v47, v175
    v_fmac_f32 v237, v48, v120
    v_mul_f32 v245, v56, v168
    v_fmac_f32 v237, v49, v121
    v_fmac_f32 v245, v57, v169
    v_fmac_f32 v237, v50, v122
    v_fmac_f32 v245, v58, v170
    v_fmac_f32 v237, v51, v123
    v_fmac_f32 v245, v59, v171
    v_fmac_f32 v237, v52, v124
    v_fmac_f32 v245, v60, v172
    v_fmac_f32 v237, v53, v125
    v_fmac_f32 v245, v61, v173
    v_fmac_f32 v237, v54, v126
    v_fmac_f32 v245, v62, v174
    v_fmac_f32 v237, v55, v127
    v_fmac_f32 v245, v63, v175
    s_setprio 1
    s_waitcnt vmcnt(4) lgkmcnt(0)
    v_mfma_f32_32x32x16_bf16 v[0:15], v[64:67], v[184:187], 0
    ds_read_b64_tr_b16 v[176:177], v246 offset:0
    ds_read_b64_tr_b16 v[178:179], v246 offset:512
    ds_read_b64_tr_b16 v[180:181], v247 offset:0
    ds_read_b64_tr_b16 v[182:183], v247 offset:512
    s_mov_b32 m0, s71
    v_mfma_f32_32x32x16_bf16 v[16:31], v[68:71], v[184:187], 0
    buffer_load_dwordx4 v228, s[4:7], s47 offen sc1 lds
    buffer_load_dwordx4 v229, s[72:75], s47 offen offset:1024 sc1 lds
    v_permlane32_swap_b32 v242, v234
    v_permlane32_swap_b32 v243, v235
    v_add_f32 v242, v242, v234
    v_mfma_f32_32x32x16_bf16 v[32:47], v[64:67], v[188:191], 0
    v_add_f32 v243, v243, v235
    v_cvt_pk_bf16_f32 v242, v242, v243
    ds_write_b32 v230, v242 offset:512
    v_mfma_f32_32x32x16_bf16 v[48:63], v[68:71], v[188:191], 0
    s_setprio 0
    v_mul_f32 v242, v0, v144
    v_fma_f32 v240, v8, v160, -v240
    v_fmac_f32 v242, v1, v145
    v_fmac_f32 v240, v9, v161
    v_fmac_f32 v242, v2, v146
    v_fmac_f32 v240, v10, v162
    v_fmac_f32 v242, v3, v147
    v_fmac_f32 v240, v11, v163
    v_fmac_f32 v242, v4, v148
    v_fmac_f32 v240, v12, v164
    v_fmac_f32 v242, v5, v149
    v_fmac_f32 v240, v13, v165
    v_fmac_f32 v242, v6, v150
    v_fmac_f32 v240, v14, v166
    v_fmac_f32 v242, v7, v151
    v_fmac_f32 v240, v15, v167
    v_add_u32 v249, s26, v249
    v_add_u32 v250, s26, v250
    v_fma_f32 v244, v16, v160, -v244
    v_fmac_f32 v236, v24, v112
    v_fmac_f32 v244, v17, v161
    v_fmac_f32 v236, v25, v113
    v_fmac_f32 v244, v18, v162
    v_fmac_f32 v236, v26, v114
    v_fmac_f32 v244, v19, v163
    v_fmac_f32 v236, v27, v115
    v_fmac_f32 v244, v20, v164
    v_fmac_f32 v236, v28, v116
    v_fmac_f32 v244, v21, v165
    v_fmac_f32 v236, v29, v117
    v_fmac_f32 v244, v22, v166
    v_fmac_f32 v236, v30, v118
    v_fmac_f32 v244, v23, v167
    v_fmac_f32 v236, v31, v119
    ds_read_b64_tr_b16 v[0:1], v249 offset:0
    ds_read_b64_tr_b16 v[2:3], v249 offset:128
    ds_read_b128 v[4:7], v250 offset:0
    ds_read_b128 v[8:11], v250 offset:16
    ds_read_b128 v[12:15], v250 offset:384
    ds_read_b128 v[16:19], v250 offset:400
    v_mul_f32 v243, v32, v152
    v_fma_f32 v241, v40, v168, -v241
    v_fmac_f32 v243, v33, v153
    v_fmac_f32 v241, v41, v169
    v_fmac_f32 v243, v34, v154
    v_fmac_f32 v241, v42, v170
    v_fmac_f32 v243, v35, v155
    v_fmac_f32 v241, v43, v171
    v_fmac_f32 v243, v36, v156
    v_fmac_f32 v241, v44, v172
    v_fmac_f32 v243, v37, v157
    v_fmac_f32 v241, v45, v173
    v_fmac_f32 v243, v38, v158
    v_fmac_f32 v241, v46, v174
    v_fmac_f32 v243, v39, v159
    v_fmac_f32 v241, v47, v175
    ds_read_b64_tr_b16 v[20:21], v249 offset:512
    ds_read_b64_tr_b16 v[22:23], v249 offset:640
    ds_read_b128 v[24:27], v250 offset:64
    ds_read_b128 v[28:31], v250 offset:80
    ds_read_b128 v[32:35], v250 offset:448
    ds_read_b128 v[36:39], v250 offset:464
    v_fma_f32 v245, v48, v168, -v245
    v_fmac_f32 v237, v56, v120
    v_fmac_f32 v245, v49, v169
    v_fmac_f32 v237, v57, v121
    v_fmac_f32 v245, v50, v170
    v_fmac_f32 v237, v58, v122
    v_fmac_f32 v245, v51, v171
    v_fmac_f32 v237, v59, v123
    v_fmac_f32 v245, v52, v172
    v_fmac_f32 v237, v60, v124
    v_fmac_f32 v245, v53, v173
    v_fmac_f32 v237, v61, v125
    v_fmac_f32 v245, v54, v174
    v_fmac_f32 v237, v62, v126
    v_fmac_f32 v245, v55, v175
    v_fmac_f32 v237, v63, v127
    s_cmp_eq_u32 s56, 2
    s_cbranch_scc1 K2_U21
    s_cmp_eq_u32 s56, 3
    s_cbranch_scc1 K2_U31
    s_branch K2_DSP1
K2_U41:
    s_setprio 1
    s_waitcnt lgkmcnt(6)
    v_lshlrev_b32 v40, 16, v0
    v_and_b32 v41, 0xffff0000, v0
    v_lshlrev_b32 v42, 16, v1
    v_and_b32 v43, 0xffff0000, v1
    v_lshlrev_b32 v44, 16, v2
    v_and_b32 v45, 0xffff0000, v2
    v_lshlrev_b32 v46, 16, v3
    v_and_b32 v47, 0xffff0000, v3
    v_mul_f32 v4, v40, v4
    v_mul_f32 v5, v41, v5
    v_mul_f32 v6, v42, v6
    v_mul_f32 v7, v43, v7
    v_mul_f32 v8, v44, v8
    v_mul_f32 v9, v45, v9
    v_mul_f32 v10, v46, v10
    v_mul_f32 v11, v47, v11
    v_cvt_pk_bf16_f32 v64, v4, v5
    v_cvt_pk_bf16_f32 v65, v6, v7
    v_cvt_pk_bf16_f32 v66, v8, v9
    v_cvt_pk_bf16_f32 v67, v10, v11
    v_mul_f32 v12, v40, v12
    v_mul_f32 v13, v41, v13
    v_mul_f32 v14, v42, v14
    v_mul_f32 v15, v43, v15
    v_mul_f32 v16, v44, v16
    v_mul_f32 v17, v45, v17
    v_mul_f32 v18, v46, v18
    v_mul_f32 v19, v47, v19
    v_cvt_pk_bf16_f32 v68, v12, v13
    v_cvt_pk_bf16_f32 v69, v14, v15
    v_cvt_pk_bf16_f32 v70, v16, v17
    v_cvt_pk_bf16_f32 v71, v18, v19
    ds_read_b64_tr_b16 v[0:1], v249 offset:1024
    ds_read_b64_tr_b16 v[2:3], v249 offset:1152
    ds_read_b128 v[4:7], v250 offset:128
    ds_read_b128 v[8:11], v250 offset:144
    ds_read_b128 v[12:15], v250 offset:512
    ds_read_b128 v[16:19], v250 offset:528
    s_waitcnt lgkmcnt(6)
    v_lshlrev_b32 v48, 16, v20
    v_and_b32 v49, 0xffff0000, v20
    v_lshlrev_b32 v50, 16, v21
    v_and_b32 v51, 0xffff0000, v21
    v_lshlrev_b32 v52, 16, v22
    v_and_b32 v53, 0xffff0000, v22
    v_lshlrev_b32 v54, 16, v23
    v_and_b32 v55, 0xffff0000, v23
    v_mul_f32 v24, v48, v24
    v_mul_f32 v25, v49, v25
    v_mul_f32 v26, v50, v26
    v_mul_f32 v27, v51, v27
    v_mul_f32 v28, v52, v28
    v_mul_f32 v29, v53, v29
    v_mul_f32 v30, v54, v30
    v_mul_f32 v31, v55, v31
    v_cvt_pk_bf16_f32 v72, v24, v25
    v_cvt_pk_bf16_f32 v73, v26, v27
    v_cvt_pk_bf16_f32 v74, v28, v29
    v_cvt_pk_bf16_f32 v75, v30, v31
    v_mul_f32 v32, v48, v32
    v_mul_f32 v33, v49, v33
    v_mul_f32 v34, v50, v34
    v_mul_f32 v35, v51, v35
    v_mul_f32 v36, v52, v36
    v_mul_f32 v37, v53, v37
    v_mul_f32 v38, v54, v38
    v_mul_f32 v39, v55, v39
    v_cvt_pk_bf16_f32 v76, v32, v33
    v_cvt_pk_bf16_f32 v77, v34, v35
    v_cvt_pk_bf16_f32 v78, v36, v37
    v_cvt_pk_bf16_f32 v79, v38, v39
    s_lshr_b32 s65, s30, 27
    s_mov_b32 s66, 161536
    s_cmp_ge_u32 s65, 2
    s_cselect_b32 s66, 158112, s66
    s_mul_i32 s65, s65, 512
    s_add_u32 s65, s65, s66
    s_sub_u32 s65, s65, s29
    v_add_u32 v56, s65, v249
    s_lshr_b32 s65, s30, 27
    s_mov_b32 s66, 161536
    s_cmp_ge_u32 s65, 2
    s_cselect_b32 s66, 159008, s66
    s_mul_i32 s65, s65, 64
    s_add_u32 s65, s65, s66
    s_sub_u32 s65, s65, s29
    v_add_u32 v57, s65, v250
    ds_read_b64_tr_b16 v[20:21], v56 offset:0
    ds_read_b64_tr_b16 v[22:23], v56 offset:128
    ds_read_b128 v[24:27], v57 offset:0
    ds_read_b128 v[28:31], v57 offset:16
    ds_read_b128 v[32:35], v57 offset:384
    ds_read_b128 v[36:39], v57 offset:400
    s_waitcnt lgkmcnt(10)
    v_lshlrev_b32 v40, 16, v0
    v_and_b32 v41, 0xffff0000, v0
    v_lshlrev_b32 v42, 16, v1
    v_and_b32 v43, 0xffff0000, v1
    v_lshlrev_b32 v44, 16, v2
    v_and_b32 v45, 0xffff0000, v2
    v_lshlrev_b32 v46, 16, v3
    v_and_b32 v47, 0xffff0000, v3
    s_waitcnt lgkmcnt(8)
    v_mul_f32 v4, v40, v4
    v_mul_f32 v5, v41, v5
    v_mul_f32 v6, v42, v6
    v_mul_f32 v7, v43, v7
    v_mul_f32 v8, v44, v8
    v_mul_f32 v9, v45, v9
    v_mul_f32 v10, v46, v10
    v_mul_f32 v11, v47, v11
    v_cvt_pk_bf16_f32 v80, v4, v5
    v_cvt_pk_bf16_f32 v81, v6, v7
    v_cvt_pk_bf16_f32 v82, v8, v9
    v_cvt_pk_bf16_f32 v83, v10, v11
    s_waitcnt lgkmcnt(6)
    v_mul_f32 v12, v40, v12
    v_mul_f32 v13, v41, v13
    v_mul_f32 v14, v42, v14
    v_mul_f32 v15, v43, v15
    v_mul_f32 v16, v44, v16
    v_mul_f32 v17, v45, v17
    v_mul_f32 v18, v46, v18
    v_mul_f32 v19, v47, v19
    v_cvt_pk_bf16_f32 v84, v12, v13
    v_cvt_pk_bf16_f32 v85, v14, v15
    v_cvt_pk_bf16_f32 v86, v16, v17
    v_cvt_pk_bf16_f32 v87, v18, v19
    s_waitcnt lgkmcnt(4)
    v_lshlrev_b32 v48, 16, v20
    v_and_b32 v49, 0xffff0000, v20
    v_lshlrev_b32 v50, 16, v21
    v_and_b32 v51, 0xffff0000, v21
    v_lshlrev_b32 v52, 16, v22
    v_and_b32 v53, 0xffff0000, v22
    v_lshlrev_b32 v54, 16, v23
    v_and_b32 v55, 0xffff0000, v23
    s_waitcnt lgkmcnt(2)
    v_mul_f32 v24, v48, v24
    v_mul_f32 v25, v49, v25
    v_mul_f32 v26, v50, v26
    v_mul_f32 v27, v51, v27
    v_mul_f32 v28, v52, v28
    v_mul_f32 v29, v53, v29
    v_mul_f32 v30, v54, v30
    v_mul_f32 v31, v55, v31
    v_cvt_pk_bf16_f32 v88, v24, v25
    v_cvt_pk_bf16_f32 v89, v26, v27
    v_cvt_pk_bf16_f32 v90, v28, v29
    v_cvt_pk_bf16_f32 v91, v30, v31
    s_waitcnt lgkmcnt(0)
    v_mul_f32 v32, v48, v32
    v_mul_f32 v33, v49, v33
    v_mul_f32 v34, v50, v34
    v_mul_f32 v35, v51, v35
    v_mul_f32 v36, v52, v36
    v_mul_f32 v37, v53, v37
    v_mul_f32 v38, v54, v38
    v_mul_f32 v39, v55, v39
    v_cvt_pk_bf16_f32 v92, v32, v33
    v_cvt_pk_bf16_f32 v93, v34, v35
    v_cvt_pk_bf16_f32 v94, v36, v37
    v_cvt_pk_bf16_f32 v95, v38, v39
    s_waitcnt vmcnt(4)
    v_mfma_f32_32x32x16_bf16 v[0:15], v[64:67], v[176:179], 0
    ds_read_b64_tr_b16 v[184:185], v246 offset:2048
    ds_read_b64_tr_b16 v[186:187], v246 offset:2560
    ds_read_b64_tr_b16 v[188:189], v247 offset:2048
    ds_read_b64_tr_b16 v[190:191], v247 offset:2560
    s_mov_b32 m0, s68
    v_mfma_f32_32x32x16_bf16 v[16:31], v[68:71], v[176:179], 0
    buffer_load_dwordx4 v222, s[4:7], s41 offen sc1 lds
    buffer_load_dwordx4 v223, s[72:75], s41 offen offset:1024 sc1 lds
    v_permlane32_swap_b32 v242, v236
    v_permlane32_swap_b32 v243, v237
    v_mov_b32 v254, 163648
    v_mfma_f32_32x32x16_bf16 v[32:47], v[64:67], v[180:183], 0
    v_permlane32_swap_b32 v244, v238
    v_permlane32_swap_b32 v245, v239
    v_permlane32_swap_b32 v240, v241
    v_add_f32 v242, v242, v236
    v_mfma_f32_32x32x16_bf16 v[48:63], v[68:71], v[180:183], 0
    v_add_f32 v243, v243, v237
    v_add_f32 v244, v244, v238
    v_add_f32 v245, v245, v239
    v_add_f32 v240, -v240, -v241
    v_sub_u32 v241, v230, v231
    v_cvt_pk_bf16_f32 v242, v242, v243
    v_mov_b32 v255, 1
    v_lshl_add_u32 v233, v252, 1, s53
    s_mov_b64 exec, 1
    ds_add_rtn_u32 v232, v254, v255
    s_mov_b64 exec, -1
    ds_read_b32 v233, v233
    s_waitcnt vmcnt(4) lgkmcnt(2)
    v_mfma_f32_32x32x16_bf16 v[0:15], v[72:75], v[184:187], v[0:15]
    ds_read_b64_tr_b16 v[176:177], v246 offset:4096
    ds_read_b64_tr_b16 v[178:179], v246 offset:4608
    ds_read_b64_tr_b16 v[180:181], v247 offset:4096
    ds_read_b64_tr_b16 v[182:183], v247 offset:4608
    v_cvt_pk_bf16_f32 v244, v244, v245
    v_cvt_pk_bf16_f32 v240, v240, v240
    s_mov_b32 m0, s69
    v_mfma_f32_32x32x16_bf16 v[16:31], v[76:79], v[184:187], v[16:31]
    buffer_load_dwordx4 v224, s[4:7], s41 offen sc1 lds
    buffer_load_dwordx4 v225, s[72:75], s41 offen offset:1024 sc1 lds
    ds_write_b32 v230, v242 offset:768
    ds_write_b32 v230, v244 offset:1024
    ds_write_b16 v241, v240 offset:1280
    s_waitcnt lgkmcnt(7)
    v_readfirstlane_b32 s58, v232
    v_mfma_f32_32x32x16_bf16 v[32:47], v[72:75], v[188:191], v[32:47]
    s_cmp_lt_u32 s58, s22
    s_cbranch_scc0 K2_nul_81
    s_and_b32 s59, s58, 7
    s_lshr_b32 s60, s58, 3
K2_chk_83:
    v_readlane_b32 s61, v233, s59
    s_nop 0
    s_cmp_gt_u32 s61, s60
    s_cbranch_scc0 K2_spin_82
K2_back_84:
    v_mfma_f32_32x32x16_bf16 v[48:63], v[76:79], v[188:191], v[48:63]
    v_readlane_b32 s3, v253, s58
    s_lshl_b32 s44, s34, 7
    s_lshl_b32 s60, s58, 5
    s_and_b32 s48, s3, 0x3ffff
    s_bfe_u32 s33, s3, 0x30012
    s_sub_u32 s60, s60, s48
    s_waitcnt vmcnt(4) lgkmcnt(3)
    v_mfma_f32_32x32x16_bf16 v[0:15], v[80:83], v[176:179], v[0:15]
    ds_read_b64_tr_b16 v[184:185], v246 offset:6144
    ds_read_b64_tr_b16 v[186:187], v246 offset:6656
    ds_read_b64_tr_b16 v[188:189], v247 offset:6144
    ds_read_b64_tr_b16 v[190:191], v247 offset:6656
    s_and_b32 s60, s60, 0xff
    s_add_u32 s35, s60, s48
    s_mov_b32 m0, s70
    v_mfma_f32_32x32x16_bf16 v[16:31], v[84:87], v[176:179], v[16:31]
    buffer_load_dwordx4 v226, s[4:7], s41 offen sc1 lds
    buffer_load_dwordx4 v227, s[72:75], s41 offen offset:1024 sc1 lds
    s_mov_b32 s45, s44
    s_add_u32 s47, s44, 256
    s_add_u32 s49, s48, 32
    s_add_u32 s60, s48, 64
    v_mfma_f32_32x32x16_bf16 v[32:47], v[80:83], v[180:183], v[32:47]
    s_cmp_eq_u32 s33, 3
    s_cselect_b32 s46, s44, s47
    s_cselect_b32 s50, s60, s48
    s_cselect_b32 s51, s48, s49
    s_sub_u32 s60, s33, 2
    s_cmp_lt_u32 s60, 2
    s_cbranch_scc0 K2_rare_85
K2_back_86:
    v_mfma_f32_32x32x16_bf16 v[48:63], v[84:87], v[180:183], v[48:63]
    s_waitcnt vmcnt(4) lgkmcnt(0)
    v_mfma_f32_32x32x16_bf16 v[0:15], v[88:91], v[184:187], v[0:15]
    ds_read_b64_tr_b16 v[176:177], v246 offset:0
    ds_read_b64_tr_b16 v[178:179], v246 offset:512
    ds_read_b64_tr_b16 v[180:181], v247 offset:0
    ds_read_b64_tr_b16 v[182:183], v247 offset:512
    s_mov_b32 m0, s71
    v_mfma_f32_32x32x16_bf16 v[16:31], v[92:95], v[184:187], v[16:31]
    buffer_load_dwordx4 v228, s[4:7], s41 offen sc1 lds
    buffer_load_dwordx4 v229, s[72:75], s41 offen offset:1024 sc1 lds
    v_mfma_f32_32x32x16_bf16 v[32:47], v[88:91], v[188:191], v[32:47]
    s_nop 2
    v_mul_f32 v234, v0, v96
    v_mul_f32 v236, v8, v128
    v_fmac_f32 v234, v1, v97
    v_fmac_f32 v236, v9, v129
    v_fmac_f32 v234, v2, v98
    v_fmac_f32 v236, v10, v130
    v_fmac_f32 v234, v3, v99
    v_mfma_f32_32x32x16_bf16 v[48:63], v[92:95], v[188:191], v[48:63]
    s_setprio 0
    v_fmac_f32 v236, v11, v131
    v_fmac_f32 v234, v4, v100
    v_fmac_f32 v236, v12, v132
    v_fmac_f32 v234, v5, v101
    v_fmac_f32 v236, v13, v133
    v_fmac_f32 v234, v6, v102
    v_fmac_f32 v236, v14, v134
    v_fmac_f32 v234, v7, v103
    v_fmac_f32 v236, v15, v135
    v_mul_f32 v238, v16, v128
    v_mul_f32 v240, v24, v128
    v_fmac_f32 v238, v17, v129
    v_fmac_f32 v240, v25, v129
    v_fmac_f32 v238, v18, v130
    v_fmac_f32 v240, v26, v130
    v_fmac_f32 v238, v19, v131
    v_fmac_f32 v240, v27, v131
    v_fmac_f32 v238, v20, v132
    v_fmac_f32 v240, v28, v132
    v_fmac_f32 v238, v21, v133
    v_fmac_f32 v240, v29, v133
    v_fmac_f32 v238, v22, v134
    v_fmac_f32 v240, v30, v134
    v_fmac_f32 v238, v23, v135
    v_fmac_f32 v240, v31, v135
    v_mul_f32 v235, v32, v104
    v_mul_f32 v237, v40, v136
    v_fmac_f32 v235, v33, v105
    v_fmac_f32 v237, v41, v137
    v_fmac_f32 v235, v34, v106
    v_fmac_f32 v237, v42, v138
    v_fmac_f32 v235, v35, v107
    v_fmac_f32 v237, v43, v139
    v_fmac_f32 v235, v36, v108
    v_fmac_f32 v237, v44, v140
    v_fmac_f32 v235, v37, v109
    v_fmac_f32 v237, v45, v141
    v_fmac_f32 v235, v38, v110
    v_fmac_f32 v237, v46, v142
    v_fmac_f32 v235, v39, v111
    v_fmac_f32 v237, v47, v143
    v_mul_f32 v239, v48, v136
    v_mul_f32 v241, v56, v136
    s_setprio 1
    s_waitcnt vmcnt(4) lgkmcnt(0)
    v_mfma_f32_32x32x16_bf16 v[0:15], v[64:67], v[176:179], 0
    ds_read_b64_tr_b16 v[184:185], v246 offset:2048
    ds_read_b64_tr_b16 v[186:187], v246 offset:2560
    ds_read_b64_tr_b16 v[188:189], v247 offset:2048
    ds_read_b64_tr_b16 v[190:191], v247 offset:2560
    v_fmac_f32 v239, v49, v137
    v_fmac_f32 v241, v57, v137
    s_mov_b32 m0, s68
    v_mfma_f32_32x32x16_bf16 v[16:31], v[68:71], v[176:179], 0
    buffer_load_dwordx4 v222, s[4:7], s42 offen sc1 lds
    buffer_load_dwordx4 v223, s[72:75], s42 offen offset:1024 sc1 lds
    v_fmac_f32 v239, v50, v138
    v_fmac_f32 v241, v58, v138
    v_fmac_f32 v239, v51, v139
    v_fmac_f32 v241, v59, v139
    v_fmac_f32 v239, v52, v140
    v_mfma_f32_32x32x16_bf16 v[32:47], v[64:67], v[180:183], 0
    v_fmac_f32 v241, v60, v140
    v_fmac_f32 v239, v53, v141
    v_fmac_f32 v241, v61, v141
    v_fmac_f32 v239, v54, v142
    v_fmac_f32 v241, v62, v142
    v_fmac_f32 v239, v55, v143
    v_fmac_f32 v241, v63, v143
    v_mfma_f32_32x32x16_bf16 v[48:63], v[68:71], v[180:183], 0
    v_permlane32_swap_b32 v234, v236
    v_permlane32_swap_b32 v235, v237
    v_permlane32_swap_b32 v240, v238
    s_waitcnt vmcnt(4) lgkmcnt(0)
    v_mfma_f32_32x32x16_bf16 v[0:15], v[72:75], v[184:187], v[0:15]
    ds_read_b64_tr_b16 v[176:177], v246 offset:4096
    ds_read_b64_tr_b16 v[178:179], v246 offset:4608
    ds_read_b64_tr_b16 v[180:181], v247 offset:4096
    ds_read_b64_tr_b16 v[182:183], v247 offset:4608
    v_permlane32_swap_b32 v241, v239
    s_mov_b32 m0, s69
    v_mfma_f32_32x32x16_bf16 v[16:31], v[76:79], v[184:187], v[16:31]
    buffer_load_dwordx4 v224, s[4:7], s42 offen sc1 lds
    buffer_load_dwordx4 v225, s[72:75], s42 offen offset:1024 sc1 lds
    v_lshl_add_u32 v230, v252, 1, s31
    v_add_f32 v234, v234, v236
    v_add_f32 v235, v235, v237
    v_add_f32 v240, v240, v238
    v_add_f32 v241, v241, v239
    v_mfma_f32_32x32x16_bf16 v[32:47], v[72:75], v[188:191], v[32:47]
    v_cvt_pk_bf16_f32 v234, v234, v235
    v_cvt_pk_bf16_f32 v240, v240, v241
    ds_write_b32 v230, v234 offset:0
    ds_write_b32 v230, v240 offset:256
    v_mfma_f32_32x32x16_bf16 v[48:63], v[76:79], v[188:191], v[48:63]
    s_waitcnt vmcnt(4) lgkmcnt(2)
    v_mfma_f32_32x32x16_bf16 v[0:15], v[80:83], v[176:179], v[0:15]
    ds_read_b64_tr_b16 v[184:185], v246 offset:6144
    ds_read_b64_tr_b16 v[186:187], v246 offset:6656
    ds_read_b64_tr_b16 v[188:189], v247 offset:6144
    ds_read_b64_tr_b16 v[190:191], v247 offset:6656
    s_mov_b32 m0, s70
    v_mfma_f32_32x32x16_bf16 v[16:31], v[84:87], v[176:179], v[16:31]
    buffer_load_dwordx4 v226, s[4:7], s42 offen sc1 lds
    buffer_load_dwordx4 v227, s[72:75], s42 offen offset:1024 sc1 lds
    v_mfma_f32_32x32x16_bf16 v[32:47], v[80:83], v[180:183], v[32:47]
    v_mfma_f32_32x32x16_bf16 v[48:63], v[84:87], v[180:183], v[48:63]
    s_waitcnt vmcnt(4) lgkmcnt(0)
    v_mfma_f32_32x32x16_bf16 v[0:15], v[88:91], v[184:187], v[0:15]
    ds_read_b64_tr_b16 v[176:177], v246 offset:0
    ds_read_b64_tr_b16 v[178:179], v246 offset:512
    ds_read_b64_tr_b16 v[180:181], v247 offset:0
    ds_read_b64_tr_b16 v[182:183], v247 offset:512
    s_mov_b32 m0, s71
    v_mfma_f32_32x32x16_bf16 v[16:31], v[92:95], v[184:187], v[16:31]
    buffer_load_dwordx4 v228, s[4:7], s42 offen sc1 lds
    buffer_load_dwordx4 v229, s[72:75], s42 offen offset:1024 sc1 lds
    v_mfma_f32_32x32x16_bf16 v[32:47], v[88:91], v[188:191], v[32:47]
    s_nop 2
    v_mul_f32 v234, v0, v144
    v_mul_f32 v236, v8, v112
    v_fmac_f32 v234, v1, v145
    v_fmac_f32 v236, v9, v113
    v_fmac_f32 v234, v2, v146
    v_fmac_f32 v236, v10, v114
    v_fmac_f32 v234, v3, v147
    v_mfma_f32_32x32x16_bf16 v[48:63], v[92:95], v[188:191], v[48:63]
    s_setprio 0
    v_fmac_f32 v236, v11, v115
    v_fmac_f32 v234, v4, v148
    v_fmac_f32 v236, v12, v116
    v_fmac_f32 v234, v5, v149
    v_fmac_f32 v236, v13, v117
    v_fmac_f32 v234, v6, v150
    v_fmac_f32 v236, v14, v118
    v_fmac_f32 v234, v7, v151
    v_fmac_f32 v236, v15, v119
    v_mul_f32 v238, v16, v160
    v_mul_f32 v240, v24, v160
    v_fmac_f32 v238, v17, v161
    v_fmac_f32 v240, v25, v161
    v_fmac_f32 v238, v18, v162
    v_fmac_f32 v240, v26, v162
    v_fmac_f32 v238, v19, v163
    v_fmac_f32 v240, v27, v163
    v_fmac_f32 v238, v20, v164
    v_fmac_f32 v240, v28, v164
    v_fmac_f32 v238, v21, v165
    v_fmac_f32 v240, v29, v165
    v_fmac_f32 v238, v22, v166
    v_fmac_f32 v240, v30, v166
    v_fmac_f32 v238, v23, v167
    v_fmac_f32 v240, v31, v167
    v_mul_f32 v235, v32, v152
    v_mul_f32 v237, v40, v120
    v_fmac_f32 v235, v33, v153
    v_fmac_f32 v237, v41, v121
    v_fmac_f32 v235, v34, v154
    v_fmac_f32 v237, v42, v122
    v_fmac_f32 v235, v35, v155
    v_fmac_f32 v237, v43, v123
    v_fmac_f32 v235, v36, v156
    v_fmac_f32 v237, v44, v124
    v_fmac_f32 v235, v37, v157
    v_fmac_f32 v237, v45, v125
    v_fmac_f32 v235, v38, v158
    v_fmac_f32 v237, v46, v126
    v_fmac_f32 v235, v39, v159
    v_fmac_f32 v237, v47, v127
    v_mul_f32 v239, v48, v168
    v_mul_f32 v241, v56, v168
    s_setprio 1
    s_waitcnt vmcnt(4) lgkmcnt(0)
    v_mfma_f32_32x32x16_bf16 v[0:15], v[64:67], v[176:179], 0
    ds_read_b64_tr_b16 v[184:185], v246 offset:2048
    ds_read_b64_tr_b16 v[186:187], v246 offset:2560
    ds_read_b64_tr_b16 v[188:189], v247 offset:2048
    ds_read_b64_tr_b16 v[190:191], v247 offset:2560
    v_fmac_f32 v239, v49, v169
    v_fmac_f32 v241, v57, v169
    s_mov_b32 m0, s68
    v_mfma_f32_32x32x16_bf16 v[16:31], v[68:71], v[176:179], 0
    buffer_load_dwordx4 v222, s[4:7], s43 offen sc1 lds
    buffer_load_dwordx4 v223, s[72:75], s43 offen offset:1024 sc1 lds
    v_fmac_f32 v239, v50, v170
    v_fmac_f32 v241, v58, v170
    v_fmac_f32 v239, v51, v171
    v_fmac_f32 v241, v59, v171
    v_fmac_f32 v239, v52, v172
    v_mfma_f32_32x32x16_bf16 v[32:47], v[64:67], v[180:183], 0
    v_fmac_f32 v241, v60, v172
    v_fmac_f32 v239, v53, v173
    v_fmac_f32 v241, v61, v173
    v_fmac_f32 v239, v54, v174
    v_fmac_f32 v241, v62, v174
    v_fmac_f32 v239, v55, v175
    v_fmac_f32 v241, v63, v175
    v_mfma_f32_32x32x16_bf16 v[48:63], v[68:71], v[180:183], 0
    s_waitcnt vmcnt(4) lgkmcnt(0)
    v_mfma_f32_32x32x16_bf16 v[0:15], v[72:75], v[184:187], v[0:15]
    ds_read_b64_tr_b16 v[176:177], v246 offset:4096
    ds_read_b64_tr_b16 v[178:179], v246 offset:4608
    ds_read_b64_tr_b16 v[180:181], v247 offset:4096
    ds_read_b64_tr_b16 v[182:183], v247 offset:4608
    s_mov_b32 m0, s69
    v_mfma_f32_32x32x16_bf16 v[16:31], v[76:79], v[184:187], v[16:31]
    buffer_load_dwordx4 v224, s[4:7], s43 offen sc1 lds
    buffer_load_dwordx4 v225, s[72:75], s43 offen offset:1024 sc1 lds
    v_mfma_f32_32x32x16_bf16 v[32:47], v[72:75], v[188:191], v[32:47]
    v_mfma_f32_32x32x16_bf16 v[48:63], v[76:79], v[188:191], v[48:63]
    s_waitcnt vmcnt(4) lgkmcnt(0)
    v_mfma_f32_32x32x16_bf16 v[0:15], v[80:83], v[176:179], v[0:15]
    ds_read_b64_tr_b16 v[184:185], v246 offset:6144
    ds_read_b64_tr_b16 v[186:187], v246 offset:6656
    ds_read_b64_tr_b16 v[188:189], v247 offset:6144
    ds_read_b64_tr_b16 v[190:191], v247 offset:6656
    s_mov_b32 m0, s70
    v_mfma_f32_32x32x16_bf16 v[16:31], v[84:87], v[176:179], v[16:31]
    buffer_load_dwordx4 v226, s[4:7], s43 offen sc1 lds
    buffer_load_dwordx4 v227, s[72:75], s43 offen offset:1024 sc1 lds
    v_mfma_f32_32x32x16_bf16 v[32:47], v[80:83], v[180:183], v[32:47]
    v_add_u32 v222, s48, v251
    ds_read_b32 v222, v222
    v_mfma_f32_32x32x16_bf16 v[48:63], v[84:87], v[180:183], v[48:63]
    s_waitcnt vmcnt(4) lgkmcnt(1)
    v_mfma_f32_32x32x16_bf16 v[0:15], v[88:91], v[184:187], v[0:15]
    ds_read_b64_tr_b16 v[176:177], v246 offset:0
    ds_read_b64_tr_b16 v[178:179], v246 offset:512
    ds_read_b64_tr_b16 v[180:181], v247 offset:0
    ds_read_b64_tr_b16 v[182:183], v247 offset:512
    s_mov_b32 m0, s71
    v_mfma_f32_32x32x16_bf16 v[16:31], v[92:95], v[184:187], v[16:31]
    buffer_load_dwordx4 v228, s[4:7], s43 offen sc1 lds
    buffer_load_dwordx4 v229, s[72:75], s43 offen offset:1024 sc1 lds
    s_waitcnt lgkmcnt(4)
    v_mad_u32_u16 v223, v222, s39, v248 op_sel:[1,0,0,0]
    v_mad_u32_u16 v222, v222, s39, v248
    v_mfma_f32_32x32x16_bf16 v[32:47], v[88:91], v[188:191], v[32:47]
    v_add_u32 v224, s49, v251
    ds_read_b32 v224, v224
    v_mul_f32 v242, v0, v144
    v_fma_f32 v238, v8, v160, -v238
    v_fmac_f32 v242, v1, v145
    v_fmac_f32 v238, v9, v161
    v_fmac_f32 v242, v2, v146
    v_mfma_f32_32x32x16_bf16 v[48:63], v[92:95], v[188:191], v[48:63]
    s_setprio 0
    v_fmac_f32 v238, v10, v162
    v_fmac_f32 v242, v3, v147
    v_fmac_f32 v238, v11, v163
    v_fmac_f32 v242, v4, v148
    v_fmac_f32 v238, v12, v164
    v_fmac_f32 v242, v5, v149
    v_fmac_f32 v238, v13, v165
    v_fmac_f32 v242, v6, v150
    v_fmac_f32 v238, v14, v166
    v_fmac_f32 v242, v7, v151
    v_fmac_f32 v238, v15, v167
    v_fmac_f32 v236, v16, v112
    v_mul_f32 v244, v24, v160
    v_fmac_f32 v236, v17, v113
    v_fmac_f32 v244, v25, v161
    v_fmac_f32 v236, v18, v114
    v_fmac_f32 v244, v26, v162
    v_fmac_f32 v236, v19, v115
    v_fmac_f32 v244, v27, v163
    v_fmac_f32 v236, v20, v116
    v_fmac_f32 v244, v28, v164
    v_fmac_f32 v236, v21, v117
    v_fmac_f32 v244, v29, v165
    v_fmac_f32 v236, v22, v118
    v_fmac_f32 v244, v30, v166
    v_fmac_f32 v236, v23, v119
    v_fmac_f32 v244, v31, v167
    v_mul_f32 v243, v32, v152
    v_fma_f32 v239, v40, v168, -v239
    v_fmac_f32 v243, v33, v153
    v_fmac_f32 v239, v41, v169
    v_fmac_f32 v243, v34, v154
    v_fmac_f32 v239, v42, v170
    v_fmac_f32 v243, v35, v155
    v_fmac_f32 v239, v43, v171
    v_fmac_f32 v243, v36, v156
    v_fmac_f32 v239, v44, v172
    v_fmac_f32 v243, v37, v157
    v_fmac_f32 v239, v45, v173
    v_fmac_f32 v243, v38, v158
    v_fmac_f32 v239, v46, v174
    v_fmac_f32 v243, v39, v159
    v_fmac_f32 v239, v47, v175
    v_fmac_f32 v237, v48, v120
    v_mul_f32 v245, v56, v168
    v_fmac_f32 v237, v49, v121
    v_fmac_f32 v245, v57, v169
    v_fmac_f32 v237, v50, v122
    v_fmac_f32 v245, v58, v170
    v_fmac_f32 v237, v51, v123
    s_setprio 1
    s_waitcnt vmcnt(4) lgkmcnt(1)
    v_mfma_f32_32x32x16_bf16 v[0:15], v[64:67], v[176:179], 0
    ds_read_b64_tr_b16 v[184:185], v246 offset:2048
    ds_read_b64_tr_b16 v[186:187], v246 offset:2560
    ds_read_b64_tr_b16 v[188:189], v247 offset:2048
    ds_read_b64_tr_b16 v[190:191], v247 offset:2560
    v_fmac_f32 v245, v59, v171
    v_fmac_f32 v237, v52, v124
    s_mov_b32 m0, s68
    v_mfma_f32_32x32x16_bf16 v[16:31], v[68:71], v[176:179], 0
    buffer_load_dwordx4 v222, s[4:7], s44 offen sc1 lds
    buffer_load_dwordx4 v223, s[72:75], s44 offen offset:1024 sc1 lds
    s_waitcnt lgkmcnt(4)
    v_mad_u32_u16 v225, v224, s39, v248 op_sel:[1,0,0,0]
    v_mad_u32_u16 v224, v224, s39, v248
    v_fmac_f32 v245, v60, v172
    v_fmac_f32 v237, v53, v125
    v_mfma_f32_32x32x16_bf16 v[32:47], v[64:67], v[180:183], 0
    v_add_u32 v226, s50, v251
    ds_read_b32 v226, v226
    v_fmac_f32 v245, v61, v173
    v_fmac_f32 v237, v54, v126
    v_fmac_f32 v245, v62, v174
    v_fmac_f32 v237, v55, v127
    v_fmac_f32 v245, v63, v175
    v_mfma_f32_32x32x16_bf16 v[48:63], v[68:71], v[180:183], 0
    v_permlane32_swap_b32 v242, v234
    v_permlane32_swap_b32 v243, v235
    v_add_f32 v242, v242, v234
    v_add_f32 v243, v243, v235
    s_waitcnt vmcnt(4) lgkmcnt(1)
    v_mfma_f32_32x32x16_bf16 v[0:15], v[72:75], v[184:187], v[0:15]
    ds_read_b64_tr_b16 v[176:177], v246 offset:4096
    ds_read_b64_tr_b16 v[178:179], v246 offset:4608
    ds_read_b64_tr_b16 v[180:181], v247 offset:4096
    ds_read_b64_tr_b16 v[182:183], v247 offset:4608
    v_cvt_pk_bf16_f32 v242, v242, v243
    ds_write_b32 v230, v242 offset:512
    s_mov_b32 m0, s69
    v_mfma_f32_32x32x16_bf16 v[16:31], v[76:79], v[184:187], v[16:31]
    buffer_load_dwordx4 v224, s[4:7], s45 offen sc1 lds
    buffer_load_dwordx4 v225, s[72:75], s45 offen offset:1024 sc1 lds
    s_waitcnt lgkmcnt(5)
    v_mad_u32_u16 v227, v226, s39, v248 op_sel:[1,0,0,0]
    v_mad_u32_u16 v226, v226, s39, v248
    v_mfma_f32_32x32x16_bf16 v[32:47], v[72:75], v[188:191], v[32:47]
    v_add_u32 v228, s51, v251
    ds_read_b32 v228, v228
    v_mfma_f32_32x32x16_bf16 v[48:63], v[76:79], v[188:191], v[48:63]
    s_waitcnt vmcnt(4) lgkmcnt(2)
    v_mfma_f32_32x32x16_bf16 v[0:15], v[80:83], v[176:179], v[0:15]
    ds_read_b64_tr_b16 v[184:185], v246 offset:6144
    ds_read_b64_tr_b16 v[186:187], v246 offset:6656
    ds_read_b64_tr_b16 v[188:189], v247 offset:6144
    ds_read_b64_tr_b16 v[190:191], v247 offset:6656
    s_mov_b32 s32, s31
    s_mov_b32 s31, s35
    s_mov_b32 m0, s70
    v_mfma_f32_32x32x16_bf16 v[16:31], v[84:87], v[176:179], v[16:31]
    buffer_load_dwordx4 v226, s[4:7], s46 offen sc1 lds
    buffer_load_dwordx4 v227, s[72:75], s46 offen offset:1024 sc1 lds
    s_waitcnt lgkmcnt(4)
    v_mad_u32_u16 v229, v228, s39, v248 op_sel:[1,0,0,0]
    v_mad_u32_u16 v228, v228, s39, v248
    s_sub_u32 s26, s48, s29
    s_mov_b32 s29, s48
    v_mfma_f32_32x32x16_bf16 v[32:47], v[80:83], v[180:183], v[32:47]
    s_mov_b32 s30, s3
    s_cmp_lg_u32 s36, 0
    s_cselect_b32 s56, s33, 0
    v_mfma_f32_32x32x16_bf16 v[48:63], v[84:87], v[180:183], v[48:63]
    s_waitcnt vmcnt(4) lgkmcnt(0)
    v_mfma_f32_32x32x16_bf16 v[0:15], v[88:91], v[184:187], v[0:15]
    ds_read_b64_tr_b16 v[176:177], v246 offset:0
    ds_read_b64_tr_b16 v[178:179], v246 offset:512
    ds_read_b64_tr_b16 v[180:181], v247 offset:0
    ds_read_b64_tr_b16 v[182:183], v247 offset:512
    s_mov_b32 m0, s71
    v_mfma_f32_32x32x16_bf16 v[16:31], v[92:95], v[184:187], v[16:31]
    buffer_load_dwordx4 v228, s[4:7], s47 offen sc1 lds
    buffer_load_dwordx4 v229, s[72:75], s47 offen offset:1024 sc1 lds
    v_mfma_f32_32x32x16_bf16 v[32:47], v[88:91], v[188:191], v[32:47]
    s_nop 2
    v_mul_f32 v242, v0, v144
    v_fma_f32 v240, v8, v160, -v240
    v_fmac_f32 v242, v1, v145
    v_fmac_f32 v240, v9, v161
    v_fmac_f32 v242, v2, v146
    v_fmac_f32 v240, v10, v162
    v_fmac_f32 v242, v3, v147
    v_mfma_f32_32x32x16_bf16 v[48:63], v[92:95], v[188:191], v[48:63]
    s_setprio 0
    v_fmac_f32 v240, v11, v163
    v_fmac_f32 v242, v4, v148
    v_fmac_f32 v240, v12, v164
    v_fmac_f32 v242, v5, v149
    v_fmac_f32 v240, v13, v165
    v_fmac_f32 v242, v6, v150
    v_fmac_f32 v240, v14, v166
    v_fmac_f32 v242, v7, v151
    v_fmac_f32 v240, v15, v167
    v_add_u32 v249, s26, v249
    v_add_u32 v250, s26, v250
    v_fma_f32 v244, v16, v160, -v244
    v_fmac_f32 v236, v24, v112
    v_fmac_f32 v244, v17, v161
    v_fmac_f32 v236, v25, v113
    v_fmac_f32 v244, v18, v162
    v_fmac_f32 v236, v26, v114
    v_fmac_f32 v244, v19, v163
    v_fmac_f32 v236, v27, v115
    v_fmac_f32 v244, v20, v164
    v_fmac_f32 v236, v28, v116
    v_fmac_f32 v244, v21, v165
    v_fmac_f32 v236, v29, v117
    v_fmac_f32 v244, v22, v166
    v_fmac_f32 v236, v30, v118
    v_fmac_f32 v244, v23, v167
    v_fmac_f32 v236, v31, v119
    ds_read_b64_tr_b16 v[0:1], v249 offset:0
    ds_read_b64_tr_b16 v[2:3], v249 offset:128
    ds_read_b128 v[4:7], v250 offset:0
    ds_read_b128 v[8:11], v250 offset:16
    ds_read_b128 v[12:15], v250 offset:384
    ds_read_b128 v[16:19], v250 offset:400
    v_mul_f32 v243, v32, v152
    v_fma_f32 v241, v40, v168, -v241
    v_fmac_f32 v243, v33, v153
    v_fmac_f32 v241, v41, v169
    v_fmac_f32 v243, v34, v154
    v_fmac_f32 v241, v42, v170
    v_fmac_f32 v243, v35, v155
    v_fmac_f32 v241, v43, v171
    v_fmac_f32 v243, v36, v156
    v_fmac_f32 v241, v44, v172
    v_fmac_f32 v243, v37, v157
    v_fmac_f32 v241, v45, v173
    v_fmac_f32 v243, v38, v158
    v_fmac_f32 v241, v46, v174
    v_fmac_f32 v243, v39, v159
    v_fmac_f32 v241, v47, v175
    ds_read_b64_tr_b16 v[20:21], v249 offset:512
    ds_read_b64_tr_b16 v[22:23], v249 offset:640
    ds_read_b128 v[24:27], v250 offset:64
    ds_read_b128 v[28:31], v250 offset:80
    ds_read_b128 v[32:35], v250 offset:448
    ds_read_b128 v[36:39], v250 offset:464
    v_fma_f32 v245, v48, v168, -v245
    v_fmac_f32 v237, v56, v120
    v_fmac_f32 v245, v49, v169
    v_fmac_f32 v237, v57, v121
    v_fmac_f32 v245, v50, v170
    v_fmac_f32 v237, v58, v122
    v_fmac_f32 v245, v51, v171
    v_fmac_f32 v237, v59, v123
    v_fmac_f32 v245, v52, v172
    v_fmac_f32 v237, v60, v124
    v_fmac_f32 v245, v53, v173
    v_fmac_f32 v237, v61, v125
    v_fmac_f32 v245, v54, v174
    v_fmac_f32 v237, v62, v126
    v_fmac_f32 v245, v55, v175
    v_fmac_f32 v237, v63, v127
    s_cmp_eq_u32 s56, 2
    s_cbranch_scc1 K2_U21
    s_cmp_eq_u32 s56, 3
    s_cbranch_scc1 K2_U31
    s_branch K2_DSP1
K2_nul_50:
    s_mov_b32 s58, 63
    s_mov_b32 s36, 0
    s_branch K2_back_53
K2_spin_51:
    s_sub_u32 s27, s27, 1
    s_cbranch_scc1 K2_END
    v_lshl_add_u32 v233, v252, 1, s53
    ds_read_b32 v233, v233
    s_waitcnt lgkmcnt(0)
    s_branch K2_chk_52
K2_dyn_48:
    v_mov_b32 v254, 163648
    v_mov_b32 v255, 1
    v_lshl_add_u32 v233, v252, 1, s53
    s_mov_b64 exec, 1
    ds_add_rtn_u32 v232, v254, v255
    s_mov_b64 exec, -1
    ds_read_b32 v233, v233
    s_waitcnt lgkmcnt(0)
    v_readfirstlane_b32 s58, v232
    s_nop 0
    s_cmp_lt_u32 s58, s22
    s_cbranch_scc0 K2_nul_50
    s_and_b32 s59, s58, 7
    s_lshr_b32 s60, s58, 3
K2_chk_52:
    v_readlane_b32 s61, v233, s59
    s_nop 0
    s_cmp_gt_u32 s61, s60
    s_cbranch_scc0 K2_spin_51
K2_back_53:
    s_mov_b32 s34, 1
    s_branch K2_back_49
K2_rare_54:
    s_cmp_eq_u32 s33, 4
    s_cbranch_scc1 K2_four_56
    s_mov_b32 s49, s48
    s_mov_b32 s51, s48
    s_add_u32 s45, s44, 256
    s_add_u32 s46, s44, 512
    s_add_u32 s47, s44, 768
    s_branch K2_back_55
K2_four_56:
    s_add_u32 s50, s48, 64
    s_lshr_b32 s51, s3, 27
    s_mov_b32 s66, 161536
    s_cmp_ge_u32 s51, 2
    s_cselect_b32 s66, 159072, s66
    s_mul_i32 s51, s51, 32
    s_add_u32 s51, s51, s66
    s_mov_b32 s46, s44
    s_mov_b32 s47, s44
    s_branch K2_back_55
K2_dum_57:
    v_mov_b32 v232, -1
    s_mov_b32 m0, 163712
    s_mov_b64 exec, 1
    buffer_load_dwordx4 v232, s[16:19], 0 offen lds
    buffer_load_dwordx4 v232, s[16:19], 0 offen lds
    s_mov_b64 exec, -1
    s_branch K2_back_59
K2_a4_58:
    s_lshr_b32 s65, s3, 27
    s_mov_b32 s66, 161536
    s_cmp_ge_u32 s65, 2
    s_cselect_b32 s66, 158112, s66
    s_mul_i32 s65, s65, 512
    s_add_u32 s65, s65, s66
    v_add_u32 v232, s65, v230
    ds_read_b32 v232, v232
    s_add_u32 m0, s65, 864
    s_waitcnt lgkmcnt(0)
    v_or_b32 v232, v232, v231
    buffer_load_dwordx4 v232, s[16:19], 0 offen  lds
    s_branch K2_b4_60
K2_nul_63:
    s_mov_b32 s58, 63
    s_mov_b32 s36, 0
    s_branch K2_back_66
K2_spin_64:
    s_sub_u32 s27, s27, 1
    s_cbranch_scc1 K2_END
    v_lshl_add_u32 v233, v252, 1, s53
    ds_read_b32 v233, v233
    s_waitcnt lgkmcnt(0)
    s_branch K2_chk_65
K2_dyn_61:
    v_mov_b32 v254, 163648
    v_mov_b32 v255, 1
    v_lshl_add_u32 v233, v252, 1, s53
    s_mov_b64 exec, 1
    ds_add_rtn_u32 v232, v254, v255
    s_mov_b64 exec, -1
    ds_read_b32 v233, v233
    s_waitcnt lgkmcnt(0)
    v_readfirstlane_b32 s58, v232
    s_nop 0
    s_cmp_lt_u32 s58, s22
    s_cbranch_scc0 K2_nul_63
    s_and_b32 s59, s58, 7
    s_lshr_b32 s60, s58, 3
K2_chk_65:
    v_readlane_b32 s61, v233, s59
    s_nop 0
    s_cmp_gt_u32 s61, s60
    s_cbranch_scc0 K2_spin_64
K2_back_66:
    s_mov_b32 s34, 1
    s_branch K2_back_62
K2_rare_67:
    s_cmp_eq_u32 s33, 4
    s_cbranch_scc1 K2_four_69
    s_mov_b32 s49, s48
    s_mov_b32 s51, s48
    s_add_u32 s45, s44, 256
    s_add_u32 s46, s44, 512
    s_add_u32 s47, s44, 768
    s_branch K2_back_68
K2_four_69:
    s_add_u32 s50, s48, 64
    s_lshr_b32 s51, s3, 27
    s_mov_b32 s66, 161536
    s_cmp_ge_u32 s51, 2
    s_cselect_b32 s66, 159072, s66
    s_mul_i32 s51, s51, 32
    s_add_u32 s51, s51, s66
    s_mov_b32 s46, s44
    s_mov_b32 s47, s44
    s_branch K2_back_68
K2_dum_70:
    v_mov_b32 v232, -1
    s_mov_b32 m0, 163712
    s_mov_b64 exec, 1
    buffer_load_dwordx4 v232, s[16:19], 0 offen lds
    buffer_load_dwordx4 v232, s[16:19], 0 offen lds
    s_mov_b64 exec, -1
    s_branch K2_back_72
K2_a4_71:
    s_lshr_b32 s65, s3, 27
    s_mov_b32 s66, 161536
    s_cmp_ge_u32 s65, 2
    s_cselect_b32 s66, 158112, s66
    s_mul_i32 s65, s65, 512
    s_add_u32 s65, s65, s66
    v_add_u32 v232, s65, v230
    ds_read_b32 v232, v232
    s_add_u32 m0, s65, 864
    s_waitcnt lgkmcnt(0)
    v_or_b32 v232, v232, v231
    buffer_load_dwordx4 v232, s[16:19], 0 offen  lds
    s_branch K2_b4_73
K2_nul_74:
    s_mov_b32 s58, 63
    s_mov_b32 s36, 0
    s_branch K2_back_77
K2_spin_75:
    s_sub_u32 s27, s27, 1
    s_cbranch_scc1 K2_END
    v_lshl_add_u32 v233, v252, 1, s53
    ds_read_b32 v233, v233
    s_waitcnt lgkmcnt(0)
    s_branch K2_chk_76
K2_rare_78:
    s_cmp_eq_u32 s33, 4
    s_cbranch_scc1 K2_four_80
    s_mov_b32 s49, s48
    s_mov_b32 s51, s48
    s_add_u32 s45, s44, 256
    s_add_u32 s46, s44, 512
    s_add_u32 s47, s44, 768
    s_branch K2_back_79
K2_four_80:
    s_add_u32 s50, s48, 64
    s_lshr_b32 s51, s3, 27
    s_mov_b32 s66, 161536
    s_cmp_ge_u32 s51, 2
    s_cselect_b32 s66, 159072, s66
    s_mul_i32 s51, s51, 32
    s_add_u32 s51, s51, s66
    s_mov_b32 s46, s44
    s_mov_b32 s47, s44
    s_branch K2_back_79
K2_nul_81:
    s_mov_b32 s58, 63
    s_mov_b32 s36, 0
    s_branch K2_back_84
K2_spin_82:
    s_sub_u32 s27, s27, 1
    s_cbranch_scc1 K2_END
    v_lshl_add_u32 v233, v252, 1, s53
    ds_read_b32 v233, v233
    s_waitcnt lgkmcnt(0)
    s_branch K2_chk_83
K2_rare_85:
    s_cmp_eq_u32 s33, 4
    s_cbranch_scc1 K2_four_87
    s_mov_b32 s49, s48
    s_mov_b32 s51, s48
    s_add_u32 s45, s44, 256
    s_add_u32 s46, s44, 512
    s_add_u32 s47, s44, 768
    s_branch K2_back_86
K2_four_87:
    s_add_u32 s50, s48, 64
    s_lshr_b32 s51, s3, 27
    s_mov_b32 s66, 161536
    s_cmp_ge_u32 s51, 2
    s_cselect_b32 s66, 159072, s66
    s_mul_i32 s51, s51, 32
    s_add_u32 s51, s51, s66
    s_mov_b32 s46, s44
    s_mov_b32 s47, s44
    s_branch K2_back_86
K2_END:
    s_endpgm
.section .rodata,"a"
.p2align 6
.amdhsa_kernel standalone__tensor_product_equiv_equiformer__graph_kernel
  .amdhsa_next_free_vgpr 256
  .amdhsa_next_free_sgpr 102
  .amdhsa_accum_offset 256
  .amdhsa_group_segment_fixed_size 0
  .amdhsa_kernarg_size 96
  .amdhsa_user_sgpr_count 2
  .amdhsa_user_sgpr_kernarg_segment_ptr 1
  .amdhsa_system_sgpr_workgroup_id_x 1
  .amdhsa_float_denorm_mode_32 3
.end_amdhsa_kernel
```

```asm
; @launch grid=(256,1,1) block=(512,1,1) lds=163840
.amdgcn_target "amdgcn-amd-amdhsa--gfx950"
.text
.globl standalone__tensor_product_equiv_equiformer__graph_kernel
.p2align 8
.type standalone__tensor_product_equiv_equiformer__graph_kernel,@function
standalone__tensor_product_equiv_equiformer__graph_kernel:
    s_cmp_ge_u32 s2, 256
    s_cbranch_scc1 K2_END
    s_load_dwordx16 s[80:95], s[0:1], 0
    s_load_dwordx4 s[96:99], s[0:1], 72
    s_load_dwordx2 s[100:101], s[0:1], 88
    v_lshrrev_b32 v1, 6, v0
    s_mov_b32 s54, s2
    v_readfirstlane_b32 s20, v1
    s_mov_b64 exec, 0
    s_cmp_eq_u32 s20, 0
    s_cbranch_scc1 K2_PAD_S1
    s_cmp_eq_u32 s20, 1
    s_cbranch_scc1 K2_PAD_S2
    s_cmp_eq_u32 s20, 5
    s_cbranch_scc1 K2_PAD_H1
    s_cmp_eq_u32 s20, 6
    s_cbranch_scc1 K2_PAD_H2
    s_cmp_eq_u32 s20, 2
    s_cbranch_scc1 K2_PAD_H3
KS_HOP0:
    s_mov_b64 exec, -1
    v_and_b32 v8, 63, v0
    v_lshlrev_b32 v9, 4, v8
    v_mov_b32 v6, 0
    v_lshlrev_b32 v5, 4, v0
    v_mul_u32_u24 v4, 24, v0
    s_mul_i32 s64, s2, 5120
    s_mul_i32 s65, s2, 7680
    v_mov_b32 v176, v8
    v_mov_b32 v177, v0
    s_mul_i32 s21, s2, 625
    s_add_u32 s22, s21, 640
    s_add_u32 s21, s21, 15
    s_lshr_b32 s21, s21, 4
    s_lshr_b32 s22, s22, 4
    s_sub_u32 s22, s22, s21
    s_movk_i32 s39, 1024
    s_lshl_b32 s37, s20, 13
    s_mov_b32 s53, 163616
    s_lshl_b32 s52, s20, 2
    s_add_u32 s52, s52, s53
    s_add_u32 s68, s37, 0
    s_add_u32 s69, s37, 2048
    s_add_u32 s70, s37, 4096
    s_add_u32 s71, s37, 6144
KS_PRE2:
    s_waitcnt lgkmcnt(0)
    s_mov_b32 s8, s100
    s_and_b32 s9, s101, 0xffff
    s_mov_b32 s10, 37748736
    s_mov_b32 s11, 0x20000
    s_cmp_lg_u32 s20, 7
    s_cbranch_scc1 KS_NOTAG
    s_mov_b32 s24, 7178240
    s_mov_b64 exec, 1
    buffer_load_dword v14, v6, s[8:11], s24 offen sc1
    s_mov_b64 exec, -1
    s_barrier
    v_mov_b32 v76, 0
    v_mov_b32 v77, -1
    v_lshlrev_b32 v78, 2, v8
    v_add_u32 v78, 163424, v78
    s_mov_b64 exec, 0x1ff
    ds_write_b32 v78, v76 offset:192
    s_mov_b64 exec, 0xff
    ds_write_b32 v78, v77 offset:256
    s_mov_b64 exec, -1
    s_mov_b32 exec_hi, 0xffff
    ds_write_b32 v78, v76
    s_mov_b64 exec, 0x3f
    ds_write_b32 v78, v76 offset:228
    s_mov_b64 exec, -1
    s_mov_b64 exec, 1
    v_mov_b32 v12, 163728
    s_mov_b32 s24, 1664525
    s_waitcnt vmcnt(0)
    v_mul_lo_u32 v14, v14, s24
    v_add_u32 v14, 1013904223, v14
    ds_write_b32 v12, v14
KS_TAGOK2:
    s_mov_b64 exec, -1
    s_waitcnt lgkmcnt(0)
    s_barrier
    s_branch KS_B3
KS_H0:
    s_barrier
    s_branch KS_HELP
K2_PAD_S1:
    s_branch KS_HOP0
KS_NOTAG:
    s_cmp_ge_u32 s20, 5
    s_cbranch_scc1 KS_HELP
    s_cmp_ge_u32 s2, 250
    s_cbranch_scc1 KS_IDLE
    s_mov_b32 s40, s88
    s_and_b32 s41, s89, 0xffff
    s_mov_b32 s42, 1280000
    s_mov_b32 s43, 0x20000
    buffer_load_dwordx4 v[12:15], v5, s[40:43], s64 offen
    s_mov_b32 s44, s86
    s_and_b32 s45, s87, 0xffff
    s_mov_b32 s46, 1280000
    s_mov_b32 s47, 0x20000
    s_mov_b32 s48, s82
    s_and_b32 s49, s83, 0xffff
    s_mov_b32 s50, 1920000
    s_mov_b32 s51, 0x20000
    buffer_load_dwordx4 v[16:19], v5, s[44:47], s64 offen
    buffer_load_dwordx4 v[20:23], v4, s[48:51], s65 offen
    buffer_load_dwordx2 v[24:25], v4, s[48:51], s65 offen offset:16
    v_lshlrev_b32 v2, 2, v0
    s_lshl_b32 s64, s64, 3
    v_lshl_add_u32 v3, v0, 7, s64
    v_mov_b32 v7, 1
    s_cmp_eq_u32 s20, 4
    s_cbranch_scc1 KS_NOCLR
    ds_write_b32 v2, v6
KS_NOCLR:
    s_waitcnt lgkmcnt(0)
    s_barrier
    s_mov_b64 exec, 0
    s_cmp_eq_u32 s20, 0
    s_cbranch_scc1 K2_PAD_B3
    s_cmp_eq_u32 s20, 1
    s_cbranch_scc1 K2_PAD_LD
    s_cmp_eq_u32 s20, 2
    s_cbranch_scc1 K2_PAD_NW
    s_cmp_eq_u32 s20, 3
    s_cbranch_scc1 K2_PAD_SC
    s_cmp_eq_u32 s20, 4
    s_cbranch_scc1 K2_PAD_SD
KS_HOP:
    s_mov_b64 exec, -1
    v_mul_u32_u24 v76, 2979, v0
    v_lshrrev_b32 v76, 16, v76
    v_mul_u32_u24 v77, 2048, v76
    v_lshl_add_u32 v78, v0, 4, v77
    v_add_u32 v78, 67584, v78
    v_add_u32 v79, 67200, v78
    v_mov_b32 v80, -1
    v_mov_b32 v81, -1
    v_cmp_gt_u32 vcc, 14, v76
    v_cmp_gt_u32 s[56:57], 12, v76
    v_mov_b32 v82, -1
    v_mov_b32 v83, -1
    s_mov_b64 exec, vcc
    ds_write_b128 v78, v[80:83]
    ds_write_b128 v78, v[80:83] offset:33600
    s_mov_b64 exec, s[56:57]
    ds_write_b128 v79, v[80:83]
    s_mov_b64 exec, -1
    s_mov_b32 s58, 429497
    s_movk_i32 s59, 625
    s_waitcnt vmcnt(3)
    v_mul_u32_u24 v28, s58, v12
    v_lshrrev_b32 v32, 27, v28
    v_bfe_u32 v36, v28, 24, 3
    v_lshlrev_b32 v32, 2, v32
    v_lshl_or_b32 v32, v36, 7, v32
    ds_add_rtn_u32 v36, v32, v7
    v_mul_u32_u24 v29, s58, v13
    v_lshrrev_b32 v33, 27, v29
    v_bfe_u32 v37, v29, 24, 3
    v_lshlrev_b32 v33, 2, v33
    v_lshl_or_b32 v33, v37, 7, v33
    ds_add_rtn_u32 v37, v33, v7
    v_mul_u32_u24 v30, s58, v14
    v_lshrrev_b32 v34, 27, v30
    v_bfe_u32 v38, v30, 24, 3
    v_lshlrev_b32 v34, 2, v34
    v_lshl_or_b32 v34, v38, 7, v34
    ds_add_rtn_u32 v38, v34, v7
    v_mul_u32_u24 v31, s58, v15
    v_lshrrev_b32 v35, 27, v31
    v_bfe_u32 v39, v31, 24, 3
    v_lshlrev_b32 v35, 2, v35
    v_lshl_or_b32 v35, v39, 7, v35
    ds_add_rtn_u32 v39, v35, v7
    v_lshrrev_b32 v28, 24, v28
    v_mad_u32_u24 v28, v28, s59, 15
    v_lshrrev_b32 v28, 4, v28
    v_sub_u32 v28, v12, v28
    v_add_u32 v12, 0, v3
    v_lshl_or_b32 v28, v28, 26, v12
    v_lshrrev_b32 v29, 24, v29
    v_mad_u32_u24 v29, v29, s59, 15
    v_lshrrev_b32 v29, 4, v29
    v_sub_u32 v29, v13, v29
    v_add_u32 v13, 32, v3
    v_lshl_or_b32 v29, v29, 26, v13
    v_lshrrev_b32 v30, 24, v30
    v_mad_u32_u24 v30, v30, s59, 15
    v_lshrrev_b32 v30, 4, v30
    v_sub_u32 v30, v14, v30
    v_add_u32 v14, 64, v3
    v_lshl_or_b32 v30, v30, 26, v14
    v_lshrrev_b32 v31, 24, v31
    v_mad_u32_u24 v31, v31, s59, 15
    v_lshrrev_b32 v31, 4, v31
    v_sub_u32 v31, v15, v31
    v_add_u32 v15, 96, v3
    v_lshl_or_b32 v31, v31, 26, v15
K2_PAD_S2:
    s_cbranch_execz KS_HOP0
    v_mov_b32 v59, 163728
    s_mul_i32 s65, s2, 1152
    s_add_u32 s65, s65, 6291456
    s_mul_i32 s64, s2, 20608
    s_waitcnt lgkmcnt(0)
    s_barrier
    ds_read_b128 v[40:43], v9
    ds_read_b32 v59, v59
    s_waitcnt lgkmcnt(1)
    v_add_u32 v45, v40, v41
    v_add_u32 v46, v45, v42
    v_add_u32 v47, v46, v43
    v_mov_b32 v58, v47
    s_nop 1
    v_add_u32_dpp v58, v58, v58 row_shr:1 row_mask:0xf bank_mask:0xf bound_ctrl:0
    s_nop 1
    v_add_u32_dpp v58, v58, v58 row_shr:2 row_mask:0xf bank_mask:0xf bound_ctrl:0
    s_nop 1
    v_add_u32_dpp v58, v58, v58 row_shr:4 row_mask:0xf bank_mask:0xf bound_ctrl:0
    s_nop 1
    v_add_u32_dpp v58, v58, v58 row_shr:8 row_mask:0xf bank_mask:0xf bound_ctrl:0
    s_nop 1
    v_add_u32_dpp v58, v58, v58 row_bcast:15 row_mask:0xa bank_mask:0xf
    s_nop 1
    v_add_u32_dpp v58, v58, v58 row_bcast:31 row_mask:0xc bank_mask:0xf
    v_sub_u32 v48, v58, v47
    v_add_u32 v49, v48, v40
    v_add_u32 v50, v48, v45
    v_add_u32 v51, v48, v46
    ds_write_b128 v9, v[48:51] offset:1024
    s_waitcnt vmcnt(0) lgkmcnt(1)
    s_cmp_lg_u32 s20, 4
    s_cbranch_scc1 KS_NOPUB
    v_lshl_or_b32 v56, v49, 11, v48
    v_lshl_or_b32 v57, v51, 11, v50
    v_lshl_or_b32 v56, v59, 22, v56
    v_lshl_or_b32 v57, v59, 22, v57
    buffer_store_dwordx4 v[56:59], v9, s[8:11], s65 offen sc1
KS_NOPUB:
    s_waitcnt lgkmcnt(0)
    ds_read_b32 v32, v32 offset:1024
    ds_read_b32 v33, v33 offset:1024
    ds_read_b32 v34, v34 offset:1024
    ds_read_b32 v35, v35 offset:1024
    v_and_b32 v60, 0xffff, v59
    v_and_b32 v61, 0xffff0000, v59
    s_mov_b32 s58, 0xffff0000
    v_mov_b32 v40, v20
    v_lshl_or_b32 v41, v21, 16, v60
    v_or_b32 v42, v61, v16
    v_mov_b32 v43, v28
    v_alignbit_b32 v44, v22, v21, 16
    v_and_or_b32 v45, v22, s58, v60
    v_or_b32 v46, v61, v17
    v_mov_b32 v47, v29
    v_mov_b32 v48, v23
    v_lshl_or_b32 v49, v24, 16, v60
    v_or_b32 v50, v61, v18
    v_mov_b32 v51, v30
    v_alignbit_b32 v52, v25, v24, 16
    v_and_or_b32 v53, v25, s58, v60
    v_or_b32 v54, v61, v19
    v_mov_b32 v55, v31
    s_waitcnt lgkmcnt(0)
    v_add_lshl_u32 v32, v32, v36, 4
    ds_write_b128 v32, v[40:43] offset:2048
    v_add_lshl_u32 v33, v33, v37, 4
    ds_write_b128 v33, v[44:47] offset:2048
    v_add_lshl_u32 v34, v34, v38, 4
    ds_write_b128 v34, v[48:51] offset:2048
    v_add_lshl_u32 v35, v35, v39, 4
    ds_write_b128 v35, v[52:55] offset:2048
    s_waitcnt lgkmcnt(0)
    s_barrier
    ds_read_b128 v[12:15], v5 offset:2048
    ds_read_b128 v[16:19], v5 offset:7168
    ds_read_b128 v[20:23], v5 offset:12288
    ds_read_b128 v[24:27], v5 offset:17408
    s_waitcnt lgkmcnt(3)
    buffer_store_dwordx4 v[12:15], v5, s[8:11], s64 offen sc1
    s_add_u32 s64, s64, 5120
    s_waitcnt lgkmcnt(2)
    buffer_store_dwordx4 v[16:19], v5, s[8:11], s64 offen sc1
    s_add_u32 s64, s64, 5120
    s_waitcnt lgkmcnt(1)
    buffer_store_dwordx4 v[20:23], v5, s[8:11], s64 offen sc1
    s_add_u32 s64, s64, 5120
    s_waitcnt lgkmcnt(0)
    buffer_store_dwordx4 v[24:27], v5, s[8:11], s64 offen sc1
    s_branch KS_JOIN
K2_PAD_B3:
    s_branch KS_HOP
KS_B3:
    v_mov_b32 v59, 163728
    ds_read_b32 v59, v59
    s_waitcnt lgkmcnt(0)
    s_barrier
KS_JOIN:
    v_readfirstlane_b32 s2, v59
    s_mov_b32 s23, 0
    s_mov_b32 s28, 1
    s_mov_b32 s24, 0
    s_mov_b32 s25, 1
K2_CELLS:
    v_lshrrev_b32 v178, 1, v177
    v_min_u32 v178, 249, v178
    v_mul_u32_u24 v72, 1152, v178
    s_and_b32 s58, s54, 7
    s_lshl_b32 s58, s58, 7
    s_lshr_b32 s59, s54, 5
    s_lshl_b32 s59, s59, 4
    s_add_u32 s67, s58, s59
    s_add_u32 s67, s67, 6291456
    buffer_load_dwordx4 v[76:79], v72, s[8:11], s67 offen sc1
    s_cmp_eq_u32 s28, 0
    s_cbranch_scc1 K2_NOSRD
    s_mov_b32 s4, s80
    s_and_b32 s5, s81, 0xffff
    s_mov_b32 s6, 10240000
    s_mov_b32 s7, 0x20000
    s_mov_b32 s12, s96
    s_and_b32 s13, s97, 0xffff
    s_mov_b32 s14, 10240000
    s_mov_b32 s15, 0x20000
    s_mov_b32 s16, s84
    s_and_b32 s17, s85, 0xffff
    s_mov_b32 s18, 10240000
    s_mov_b32 s19, 0x20000
    s_sub_u32 s80, s80, 1024
    s_subb_u32 s81, s81, 0
    s_mov_b32 s72, s80
    s_and_b32 s73, s81, 0xffff
    s_mov_b32 s74, 10241024
    s_mov_b32 s75, 0x20000
    s_mov_b64 exec, 0
    s_cmp_eq_u32 s20, 0
    s_cbranch_scc1 K2_PAD_U20
    s_cmp_eq_u32 s20, 1
    s_cbranch_scc1 K2_PAD_U30
    s_cmp_eq_u32 s20, 2
    s_cbranch_scc1 K2_PAD_U21
    s_cmp_eq_u32 s20, 3
    s_cbranch_scc1 K2_PAD_U31
    s_cmp_eq_u32 s20, 4
    s_cbranch_scc1 K2_PAD_SW
    s_cmp_eq_u32 s20, 5
    s_cbranch_scc1 K2_PAD_TL
    s_cmp_eq_u32 s20, 6
    s_cbranch_scc1 K2_PAD_T2
    s_cmp_eq_u32 s20, 7
    s_cbranch_scc1 K2_PAD_OV
K2_HOP:
    s_mov_b64 exec, -1
K2_NOSRD:
    v_and_b32 v84, 15, v176
    v_lshrrev_b32 v85, 5, v176
    v_bfe_u32 v86, v176, 4, 1
    v_lshrrev_b32 v87, 2, v84
    v_and_b32 v88, 3, v84
    v_lshl_add_u32 v89, v85, 3, v87
    v_lshlrev_b32 v249, 5, v89
    v_lshl_add_u32 v249, v88, 3, v249
    v_add_u32 v249, 864, v249
    v_mul_u32_u24 v250, 192, v86
    v_lshl_add_u32 v250, v85, 5, v250
    v_lshrrev_b32 v90, 1, v88
    v_lshl_add_u32 v90, v86, 1, v90
    v_bfe_u32 v91, v87, 1, 1
    v_lshlrev_b32 v91, 2, v91
    v_xor_b32 v90, v90, v91
    v_lshlrev_b32 v90, 4, v90
    v_lshl_add_u32 v90, v89, 7, v90
    v_and_b32 v91, 1, v88
    v_lshl_add_u32 v90, v91, 3, v90
    v_add_u32 v246, s37, v90
    v_xor_b32 v247, 64, v246
    v_lshrrev_b32 v90, 3, v176
    v_lshlrev_b32 v251, 2, v90
    v_add_u32 v251, 768, v251
    v_bfe_u32 v90, v90, 1, 1
    v_lshlrev_b32 v90, 2, v90
    v_and_b32 v91, 7, v176
    v_xor_b32 v90, v90, v91
    v_lshlrev_b32 v248, 4, v90
    v_lshlrev_b32 v252, 1, v176
    v_and_b32 v231, 1, v176
    v_lshlrev_b32 v231, 4, v231
    v_lshrrev_b32 v90, 1, v176
    v_lshlrev_b32 v90, 5, v90
    v_add_u32 v230, 864, v90
    s_lshl_b32 s59, s2, 22
    s_mov_b32 s60, 0x40000
    s_bfe_u32 s61, s54, 0x10004
    s_bfe_u32 s62, s54, 0x10003
    s_add_u32 s63, s61, s62
    s_mul_i32 s62, s62, 11
    s_sub_u32 s64, 11, s62
    v_cmp_gt_u32 vcc, 500, v177
    s_nop 0
    s_mov_b64 s[56:57], vcc
K2_POLL:
    s_waitcnt vmcnt(0)
    v_xor_b32 v73, s59, v76
    v_xor_b32 v74, s59, v77
    v_or_b32 v73, v73, v74
    v_xor_b32 v74, s2, v79
    v_lshrrev_b32 v73, 22, v73
    v_or_b32 v73, v73, v74
    v_cmp_ne_u32 vcc, 0, v73
    s_nop 0
    s_cbranch_vccz K2_POLLED
    s_sub_u32 s60, s60, 1
    s_cbranch_scc1 K2_END
    s_mov_b64 exec, vcc
    buffer_load_dwordx4 v[76:79], v72, s[8:11], s67 offen sc1
    s_mov_b64 exec, -1
    s_branch K2_POLL
K2_PAD_LD:
    s_branch KS_HOP
K2_POLLED:
    s_set_gpr_idx_on s61, gpr_idx(SRC0)
    s_nop 0
    v_bfe_u32 v179, v76, s62, 11
    s_set_gpr_idx_idx s63
    s_nop 0
    v_bfe_u32 v73, v76, s64, 11
    s_set_gpr_idx_off
    v_sub_u32 v73, v73, v179
    v_cndmask_b32 v73, 0, v73, s[56:57]
    v_and_b32 v1, 1, v177
    v_add_u32 v1, s23, v1
    v_sub_u32 v180, v73, v1
    v_add_u32 v179, v179, v1
    v_mul_u32_u24 v181, 20608, v178
    v_lshl_add_u32 v181, v179, 4, v181
    v_cmp_lt_i32 s[40:41], 0, v180
    v_add_u32 v182, 32, v181
    s_mov_b32 s65, 0
    s_mov_b64 exec, s[40:41]
    buffer_load_dwordx4 v[0:3], v181, s[8:11], 0 offen offset:0 sc1
    s_mov_b64 exec, -1
    v_cmp_lt_i32 s[42:43], 2, v180
    v_cmp_lt_i32 s[44:45], 4, v180
    v_cmp_lt_i32 s[46:47], 6, v180
    v_cmp_lt_i32 s[48:49], 8, v180
    v_cmp_lt_i32 s[50:51], 10, v180
    v_cmp_lt_i32 s[90:91], 12, v180
    v_cmp_lt_i32 s[92:93], 14, v180
    v_cmp_lt_i32 s[94:95], 16, v180
    v_cmp_lt_i32 s[96:97], 18, v180
    v_add_u32 v183, 64, v181
    v_add_u32 v184, 96, v181
    v_subrev_u32 v62, 1, v180
    v_ashrrev_i32 v62, 1, v62
    v_med3_i32 v62, v62, 0, 9
    s_cmp_eq_u64 s[42:43], 0
    s_cbranch_scc1 K2_LD_DONE
    v_mov_b32 v63, v62
    s_nop 1
    v_add_u32_dpp v63, v63, v63 row_shr:1 row_mask:0xf bank_mask:0xf bound_ctrl:0
    s_nop 1
    v_add_u32_dpp v63, v63, v63 row_shr:2 row_mask:0xf bank_mask:0xf bound_ctrl:0
    s_nop 1
    v_add_u32_dpp v63, v63, v63 row_shr:4 row_mask:0xf bank_mask:0xf bound_ctrl:0
    s_nop 1
    v_add_u32_dpp v63, v63, v63 row_shr:8 row_mask:0xf bank_mask:0xf bound_ctrl:0
    s_nop 1
    v_add_u32_dpp v63, v63, v63 row_bcast:15 row_mask:0xa bank_mask:0xf
    s_nop 1
    v_add_u32_dpp v63, v63, v63 row_bcast:31 row_mask:0xc bank_mask:0xf
    s_lshl_b32 s58, s20, 10
    s_add_u32 s58, s58, 45056
    v_readlane_b32 s59, v63, 63
    v_sub_u32 v63, v63, v62
    v_lshl_add_u32 v64, v63, 2, s58
    v_lshlrev_b32 v63, 5, v63
    v_sub_u32 v63, v182, v63
    s_cmp_gt_u32 s59, 189
    s_cbranch_scc1 K2_LD_GEN
    s_mov_b64 exec, s[42:43]
    s_cbranch_execz K2_LD_L
    ds_write_b32 v64, v63 offset:0
    s_mov_b64 exec, s[44:45]
    s_cbranch_execz K2_LD_L
    ds_write_b32 v64, v63 offset:4
    s_mov_b64 exec, s[46:47]
    s_cbranch_execz K2_LD_L
    ds_write_b32 v64, v63 offset:8
    s_mov_b64 exec, s[48:49]
    s_cbranch_execz K2_LD_L
    ds_write_b32 v64, v63 offset:12
    s_mov_b64 exec, s[50:51]
    s_cbranch_execz K2_LD_L
    ds_write_b32 v64, v63 offset:16
    s_mov_b64 exec, s[90:91]
    s_cbranch_execz K2_LD_L
    ds_write_b32 v64, v63 offset:20
    s_mov_b64 exec, s[92:93]
    s_cbranch_execz K2_LD_L
    ds_write_b32 v64, v63 offset:24
    s_mov_b64 exec, s[94:95]
    s_cbranch_execz K2_LD_L
    ds_write_b32 v64, v63 offset:28
    s_mov_b64 exec, s[96:97]
    s_cbranch_execz K2_LD_L
    ds_write_b32 v64, v63 offset:32
K2_LD_L:
    s_mov_b64 exec, -1
    v_lshl_add_u32 v63, v176, 2, s58
    v_lshlrev_b32 v62, 5, v176
    s_waitcnt lgkmcnt(0)
    ds_read_b32 v64, v63 offset:0
    ds_read_b32 v65, v63 offset:252
    ds_read_b32 v66, v63 offset:504
    s_min_u32 s60, s59, 63
    s_sub_u32 s59, s59, s60
    s_bfm_b64 s[42:43], s60, 0
    s_min_u32 s60, s59, 63
    s_sub_u32 s59, s59, s60
    s_bfm_b64 s[44:45], s60, 0
    s_min_u32 s60, s59, 63
    s_sub_u32 s59, s59, s60
    s_bfm_b64 s[46:47], s60, 0
    s_mov_b64 s[48:49], 0
    s_mov_b32 s65, 1
    s_mov_b32 s60, 0
    s_waitcnt lgkmcnt(2)
    v_add3_u32 v182, v62, v64, s60
    s_mov_b64 exec, s[42:43]
    buffer_load_dwordx4 v[4:7], v182, s[8:11], 0 offen sc1
    s_mov_b32 s60, 2016
    s_waitcnt lgkmcnt(1)
    v_add3_u32 v183, v62, v65, s60
    s_mov_b64 exec, s[44:45]
    buffer_load_dwordx4 v[8:11], v183, s[8:11], 0 offen sc1
    s_mov_b32 s60, 4032
    s_waitcnt lgkmcnt(0)
    v_add3_u32 v184, v62, v66, s60
    s_mov_b64 exec, s[46:47]
    buffer_load_dwordx4 v[12:15], v184, s[8:11], 0 offen sc1
K2_LD_DONE:
    s_mov_b64 exec, -1
    s_cmp_eq_u32 s28, 0
    s_cbranch_scc1 K2_WLATE
    v_lshrrev_b32 v60, 5, v176
    v_bfe_u32 v61, v176, 2, 2
    v_lshl_add_u32 v60, v60, 2, v61
    v_mul_u32_u24 v60, 1280, v60
    v_bfe_u32 v61, v176, 4, 1
    v_lshl_add_u32 v60, v61, 5, v60
    v_and_b32 v61, 3, v176
    v_lshl_add_u32 v60, v61, 3, v60
    ds_read_b64_tr_b16 v[136:137], v60 offset:24576
    ds_read_b64_tr_b16 v[138:139], v60 offset:34816
    ds_read_b64_tr_b16 v[140:141], v60 offset:24640
    ds_read_b64_tr_b16 v[142:143], v60 offset:34880
    ds_read_b64_tr_b16 v[144:145], v60 offset:24832
    ds_read_b64_tr_b16 v[146:147], v60 offset:35072
    ds_read_b64_tr_b16 v[148:149], v60 offset:24896
    ds_read_b64_tr_b16 v[150:151], v60 offset:35136
    ds_read_b64_tr_b16 v[152:153], v60 offset:25088
    ds_read_b64_tr_b16 v[154:155], v60 offset:35328
    ds_read_b64_tr_b16 v[156:157], v60 offset:25152
    ds_read_b64_tr_b16 v[158:159], v60 offset:35392
    ds_read_b64_tr_b16 v[160:161], v60 offset:25344
    ds_read_b64_tr_b16 v[162:163], v60 offset:35584
    ds_read_b64_tr_b16 v[164:165], v60 offset:25408
    ds_read_b64_tr_b16 v[166:167], v60 offset:35648
    ds_read_b64_tr_b16 v[168:169], v60 offset:25600
    ds_read_b64_tr_b16 v[170:171], v60 offset:35840
    ds_read_b64_tr_b16 v[172:173], v60 offset:25664
    ds_read_b64_tr_b16 v[174:175], v60 offset:35904
    s_waitcnt lgkmcnt(0)
K2_WUNP:
    v_lshlrev_b32 v96, 16, v136
    v_and_b32 v97, 0xffff0000, v136
    v_lshlrev_b32 v98, 16, v137
    v_and_b32 v99, 0xffff0000, v137
    v_lshlrev_b32 v100, 16, v138
    v_and_b32 v101, 0xffff0000, v138
    v_lshlrev_b32 v102, 16, v139
    v_and_b32 v103, 0xffff0000, v139
    v_lshlrev_b32 v104, 16, v140
    v_and_b32 v105, 0xffff0000, v140
    v_lshlrev_b32 v106, 16, v141
    v_and_b32 v107, 0xffff0000, v141
    v_lshlrev_b32 v108, 16, v142
    v_and_b32 v109, 0xffff0000, v142
    v_lshlrev_b32 v110, 16, v143
    v_and_b32 v111, 0xffff0000, v143
    v_lshlrev_b32 v112, 16, v144
    v_and_b32 v113, 0xffff0000, v144
    v_lshlrev_b32 v114, 16, v145
    v_and_b32 v115, 0xffff0000, v145
    v_lshlrev_b32 v116, 16, v146
    v_and_b32 v117, 0xffff0000, v146
    v_lshlrev_b32 v118, 16, v147
    v_and_b32 v119, 0xffff0000, v147
    v_lshlrev_b32 v120, 16, v148
    v_and_b32 v121, 0xffff0000, v148
    v_lshlrev_b32 v122, 16, v149
    v_and_b32 v123, 0xffff0000, v149
    v_lshlrev_b32 v124, 16, v150
    v_and_b32 v125, 0xffff0000, v150
    v_lshlrev_b32 v126, 16, v151
    v_and_b32 v127, 0xffff0000, v151
    v_lshlrev_b32 v128, 16, v152
    v_and_b32 v129, 0xffff0000, v152
    v_lshlrev_b32 v130, 16, v153
    v_and_b32 v131, 0xffff0000, v153
    v_lshlrev_b32 v132, 16, v154
    v_and_b32 v133, 0xffff0000, v154
    v_lshlrev_b32 v134, 16, v155
    v_and_b32 v135, 0xffff0000, v155
    v_lshlrev_b32 v136, 16, v156
    v_and_b32 v137, 0xffff0000, v156
    v_lshlrev_b32 v138, 16, v157
    v_and_b32 v139, 0xffff0000, v157
    v_lshlrev_b32 v140, 16, v158
    v_and_b32 v141, 0xffff0000, v158
    v_lshlrev_b32 v142, 16, v159
    v_and_b32 v143, 0xffff0000, v159
    v_lshlrev_b32 v144, 16, v160
    v_and_b32 v145, 0xffff0000, v160
    v_lshlrev_b32 v146, 16, v161
    v_and_b32 v147, 0xffff0000, v161
    v_lshlrev_b32 v148, 16, v162
    v_and_b32 v149, 0xffff0000, v162
    v_lshlrev_b32 v150, 16, v163
    v_and_b32 v151, 0xffff0000, v163
    v_lshlrev_b32 v152, 16, v164
    v_and_b32 v153, 0xffff0000, v164
    v_lshlrev_b32 v154, 16, v165
    v_and_b32 v155, 0xffff0000, v165
    v_lshlrev_b32 v156, 16, v166
    v_and_b32 v157, 0xffff0000, v166
    v_lshlrev_b32 v158, 16, v167
    v_and_b32 v159, 0xffff0000, v167
    v_lshlrev_b32 v160, 16, v168
    v_and_b32 v161, 0xffff0000, v168
    v_lshlrev_b32 v162, 16, v169
    v_and_b32 v163, 0xffff0000, v169
    v_lshlrev_b32 v164, 16, v170
    v_and_b32 v165, 0xffff0000, v170
    v_lshlrev_b32 v166, 16, v171
    v_and_b32 v167, 0xffff0000, v171
    v_lshlrev_b32 v168, 16, v172
    v_and_b32 v169, 0xffff0000, v172
    v_lshlrev_b32 v170, 16, v173
    v_and_b32 v171, 0xffff0000, v173
    v_lshlrev_b32 v172, 16, v174
    v_and_b32 v173, 0xffff0000, v174
    v_lshlrev_b32 v174, 16, v175
    v_and_b32 v175, 0xffff0000, v175
K2_NOWRAW:
K2_PAD_NW:
    s_cbranch_execz KS_HOP
    v_lshrrev_b32 v179, 2, v181
    v_lshrrev_b32 v185, 2, v182
    v_lshrrev_b32 v186, 2, v183
    v_lshrrev_b32 v187, 2, v184
    s_mov_b32 s66, 7340032
    v_mov_b32 v201, 1
    s_movk_i32 s58, 600
    s_movk_i32 s59, 2400
    s_mov_b32 s60, 0x40000
    s_mov_b32 s61, 0xffff
    v_mov_b32 v202, 65536
    s_cmp_lg_u32 s24, 0
    s_cbranch_scc1 K2_RK_LOAD
    v_cmp_lt_i32 vcc, 20, v180
    s_nop 0
    s_cbranch_vccz K2_NOMORE
    v_mov_b32 v61, 163652
    ds_write_b32 v61, v201
K2_NOMORE:
    v_lshlrev_b32 v72, 4, v176
    s_mov_b32 s64, 7176192
    s_mov_b32 s62, 84736
    s_cmp_eq_u32 s65, 0
    s_waitcnt vmcnt(3)
    s_cbranch_scc0 K2_ARR
    s_waitcnt vmcnt(0)
K2_ARR:
    s_mov_b64 exec, s[40:41]
    s_cbranch_execz K2_RK_A
K2_CK0:
    v_bfi_b32 v192, s61, v1, v2
    v_lshrrev_b32 v50, 24, v3
    v_cmp_ne_u32 vcc, s2, v192
    v_add_u32 v40, 163424, v50
    s_cbranch_vccnz K2_RT0
    ds_add_rtn_u32 v40, v40, v201
    v_mad_u32_u24 v50, v50, s58, v202
    s_mov_b64 exec, s[42:43]
    s_cbranch_execz K2_RK_A
    s_waitcnt vmcnt(2)
K2_CK1:
    v_bfi_b32 v192, s61, v5, v6
    v_lshrrev_b32 v51, 24, v7
    v_cmp_ne_u32 vcc, s2, v192
    v_add_u32 v41, 163424, v51
    s_cbranch_vccnz K2_RT1
    ds_add_rtn_u32 v41, v41, v201
    v_mad_u32_u24 v51, v51, s58, v202
    s_mov_b64 exec, s[44:45]
    s_cbranch_execz K2_RK_A
    s_waitcnt vmcnt(1)
K2_CK2:
    v_bfi_b32 v192, s61, v9, v10
    v_lshrrev_b32 v52, 24, v11
    v_cmp_ne_u32 vcc, s2, v192
    v_add_u32 v42, 163424, v52
    s_cbranch_vccnz K2_RT2
    ds_add_rtn_u32 v42, v42, v201
    v_mad_u32_u24 v52, v52, s58, v202
    s_mov_b64 exec, s[46:47]
    s_cbranch_execz K2_RK_A
    s_waitcnt vmcnt(0)
K2_CK3:
    v_bfi_b32 v192, s61, v13, v14
    v_lshrrev_b32 v53, 24, v15
    v_cmp_ne_u32 vcc, s2, v192
    v_add_u32 v43, 163424, v53
    s_cbranch_vccnz K2_RT3
    ds_add_rtn_u32 v43, v43, v201
    v_mad_u32_u24 v53, v53, s58, v202
    s_mov_b64 exec, s[48:49]
    s_cbranch_execz K2_RK_A
K2_CK4:
    v_bfi_b32 v192, s61, v17, v18
    v_lshrrev_b32 v54, 24, v19
    v_cmp_ne_u32 vcc, s2, v192
    v_add_u32 v44, 163424, v54
    s_cbranch_vccnz K2_RT4
    ds_add_rtn_u32 v44, v44, v201
    v_mad_u32_u24 v54, v54, s58, v202
    s_mov_b64 exec, s[50:51]
    s_cbranch_execz K2_RK_A
K2_CK5:
    v_bfi_b32 v192, s61, v21, v22
    v_lshrrev_b32 v55, 24, v23
    v_cmp_ne_u32 vcc, s2, v192
    v_add_u32 v45, 163424, v55
    s_cbranch_vccnz K2_RT5
    ds_add_rtn_u32 v45, v45, v201
    v_mad_u32_u24 v55, v55, s58, v202
    s_mov_b64 exec, s[90:91]
    s_cbranch_execz K2_RK_A
K2_CK6:
    v_bfi_b32 v192, s61, v25, v26
    v_lshrrev_b32 v56, 24, v27
    v_cmp_ne_u32 vcc, s2, v192
    v_add_u32 v46, 163424, v56
    s_cbranch_vccnz K2_RT6
    ds_add_rtn_u32 v46, v46, v201
    v_mad_u32_u24 v56, v56, s58, v202
    s_mov_b64 exec, s[92:93]
    s_cbranch_execz K2_RK_A
K2_CK7:
    v_bfi_b32 v192, s61, v29, v30
    v_lshrrev_b32 v57, 24, v31
    v_cmp_ne_u32 vcc, s2, v192
    v_add_u32 v47, 163424, v57
    s_cbranch_vccnz K2_RT7
    ds_add_rtn_u32 v47, v47, v201
    v_mad_u32_u24 v57, v57, s58, v202
    s_mov_b64 exec, s[94:95]
    s_cbranch_execz K2_RK_A
K2_CK8:
    v_bfi_b32 v192, s61, v33, v34
    v_lshrrev_b32 v58, 24, v35
    v_cmp_ne_u32 vcc, s2, v192
    v_add_u32 v48, 163424, v58
    s_cbranch_vccnz K2_RT8
    ds_add_rtn_u32 v48, v48, v201
    v_mad_u32_u24 v58, v58, s58, v202
    s_mov_b64 exec, s[96:97]
    s_cbranch_execz K2_RK_A
K2_CK9:
    v_bfi_b32 v192, s61, v37, v38
    v_lshrrev_b32 v59, 24, v39
    v_cmp_ne_u32 vcc, s2, v192
    v_add_u32 v49, 163424, v59
    s_cbranch_vccnz K2_RT9
    ds_add_rtn_u32 v49, v49, v201
    v_mad_u32_u24 v59, v59, s58, v202
K2_RK_A:
    s_mov_b64 exec, -1
    s_cmp_eq_u32 s20, 7
    s_cbranch_scc1 K2_FLGLD
K2_FLGL2:
    s_mov_b64 exec, s[40:41]
    s_cbranch_execz K2_TP
    v_cmp_gt_u32 vcc, s62, v50
    v_and_b32 v3, 0xffffff, v3
    s_mov_b64 exec, vcc
    buffer_load_dword v245, v3, s[16:19], 0 offen
    s_mov_b64 exec, s[42:43]
    s_cbranch_execz K2_TP
    v_cmp_gt_u32 vcc, s62, v51
    v_and_b32 v7, 0xffffff, v7
    s_mov_b64 exec, vcc
    buffer_load_dword v245, v7, s[16:19], 0 offen
    s_mov_b64 exec, s[44:45]
    s_cbranch_execz K2_TP
    v_cmp_gt_u32 vcc, s62, v52
    v_and_b32 v11, 0xffffff, v11
    s_mov_b64 exec, vcc
    buffer_load_dword v245, v11, s[16:19], 0 offen
    s_mov_b64 exec, s[46:47]
    s_cbranch_execz K2_TP
    v_cmp_gt_u32 vcc, s62, v53
    v_and_b32 v15, 0xffffff, v15
    s_mov_b64 exec, vcc
    buffer_load_dword v245, v15, s[16:19], 0 offen
    s_mov_b64 exec, s[48:49]
    s_cbranch_execz K2_TP
    v_cmp_gt_u32 vcc, s62, v54
    v_and_b32 v19, 0xffffff, v19
    s_mov_b64 exec, vcc
    buffer_load_dword v245, v19, s[16:19], 0 offen
    s_mov_b64 exec, s[50:51]
    s_cbranch_execz K2_TP
    v_cmp_gt_u32 vcc, s62, v55
    v_and_b32 v23, 0xffffff, v23
    s_mov_b64 exec, vcc
    buffer_load_dword v245, v23, s[16:19], 0 offen
    s_mov_b64 exec, s[90:91]
    s_cbranch_execz K2_TP
    v_cmp_gt_u32 vcc, s62, v56
    v_and_b32 v27, 0xffffff, v27
    s_mov_b64 exec, vcc
    buffer_load_dword v245, v27, s[16:19], 0 offen
    s_mov_b64 exec, s[92:93]
    s_cbranch_execz K2_TP
    v_cmp_gt_u32 vcc, s62, v57
    v_and_b32 v31, 0xffffff, v31
    s_mov_b64 exec, vcc
    buffer_load_dword v245, v31, s[16:19], 0 offen
    s_mov_b64 exec, s[94:95]
    s_cbranch_execz K2_TP
    v_cmp_gt_u32 vcc, s62, v58
    v_and_b32 v35, 0xffffff, v35
    s_mov_b64 exec, vcc
    buffer_load_dword v245, v35, s[16:19], 0 offen
    s_mov_b64 exec, s[96:97]
    s_cbranch_execz K2_TP
    v_cmp_gt_u32 vcc, s62, v59
    v_and_b32 v39, 0xffffff, v39
    s_mov_b64 exec, vcc
    buffer_load_dword v245, v39, s[16:19], 0 offen
K2_TP:
    s_mov_b64 exec, -1
K2_RK_DONE:
K2_PAD_SC:
    s_cbranch_execz KS_HOP
    s_mul_i32 s67, s24, 48
    s_mov_b32 s58, 1
    s_waitcnt lgkmcnt(0)
    s_mov_b64 exec, s[40:41]
    s_cbranch_execz K2_SC_DONE
    v_cmpx_gt_u32 vcc, 48, v40
    v_lshl_add_u32 v194, v40, 5, v50
    v_lshl_add_u32 v195, v40, 2, v50
    v_lshrrev_b32 v193, 3, v40
    v_mad_i32_i24 v196, v193, -16, v195
    v_and_b32 v193, 1, v193
    v_mad_i32_i24 v196, v193, -14, v196
    ds_write_b32 v194, v3 offset:864
    ds_write_b16 v195, v0 offset:194
    ds_write_b16_d16_hi v195, v0 offset:386
    ds_write_b16_d16_hi v195, v1 offset:578
    ds_write_b16 v196, v2 offset:768
    s_cmp_lg_u64 exec, s[40:41]
    s_addc_u32 s58, s58, s58
    s_mov_b64 exec, s[42:43]
    s_cbranch_execz K2_SC_DONE
    v_cmpx_gt_u32 vcc, 48, v41
    v_lshl_add_u32 v194, v41, 5, v51
    v_lshl_add_u32 v195, v41, 2, v51
    v_lshrrev_b32 v193, 3, v41
    v_mad_i32_i24 v196, v193, -16, v195
    v_and_b32 v193, 1, v193
    v_mad_i32_i24 v196, v193, -14, v196
    ds_write_b32 v194, v7 offset:864
    ds_write_b16 v195, v4 offset:194
    ds_write_b16_d16_hi v195, v4 offset:386
    ds_write_b16_d16_hi v195, v5 offset:578
    ds_write_b16 v196, v6 offset:768
    s_cmp_lg_u64 exec, s[42:43]
    s_addc_u32 s58, s58, s58
    s_mov_b64 exec, s[44:45]
    s_cbranch_execz K2_SC_DONE
    v_cmpx_gt_u32 vcc, 48, v42
    v_lshl_add_u32 v194, v42, 5, v52
    v_lshl_add_u32 v195, v42, 2, v52
    v_lshrrev_b32 v193, 3, v42
    v_mad_i32_i24 v196, v193, -16, v195
    v_and_b32 v193, 1, v193
    v_mad_i32_i24 v196, v193, -14, v196
    ds_write_b32 v194, v11 offset:864
    ds_write_b16 v195, v8 offset:194
    ds_write_b16_d16_hi v195, v8 offset:386
    ds_write_b16_d16_hi v195, v9 offset:578
    ds_write_b16 v196, v10 offset:768
    s_cmp_lg_u64 exec, s[44:45]
    s_addc_u32 s58, s58, s58
    s_mov_b64 exec, s[46:47]
    s_cbranch_execz K2_SC_DONE
    v_cmpx_gt_u32 vcc, 48, v43
    v_lshl_add_u32 v194, v43, 5, v53
    v_lshl_add_u32 v195, v43, 2, v53
    v_lshrrev_b32 v193, 3, v43
    v_mad_i32_i24 v196, v193, -16, v195
    v_and_b32 v193, 1, v193
    v_mad_i32_i24 v196, v193, -14, v196
    ds_write_b32 v194, v15 offset:864
    ds_write_b16 v195, v12 offset:194
    ds_write_b16_d16_hi v195, v12 offset:386
    ds_write_b16_d16_hi v195, v13 offset:578
    ds_write_b16 v196, v14 offset:768
    s_cmp_lg_u64 exec, s[46:47]
    s_addc_u32 s58, s58, s58
    s_mov_b64 exec, s[48:49]
    s_cbranch_execz K2_SC_DONE
    v_cmpx_gt_u32 vcc, 48, v44
    v_lshl_add_u32 v194, v44, 5, v54
    v_lshl_add_u32 v195, v44, 2, v54
    v_lshrrev_b32 v193, 3, v44
    v_mad_i32_i24 v196, v193, -16, v195
    v_and_b32 v193, 1, v193
    v_mad_i32_i24 v196, v193, -14, v196
    ds_write_b32 v194, v19 offset:864
    ds_write_b16 v195, v16 offset:194
    ds_write_b16_d16_hi v195, v16 offset:386
    ds_write_b16_d16_hi v195, v17 offset:578
    ds_write_b16 v196, v18 offset:768
    s_cmp_lg_u64 exec, s[48:49]
    s_addc_u32 s58, s58, s58
    s_mov_b64 exec, s[50:51]
    s_cbranch_execz K2_SC_DONE
    v_cmpx_gt_u32 vcc, 48, v45
    v_lshl_add_u32 v194, v45, 5, v55
    v_lshl_add_u32 v195, v45, 2, v55
    v_lshrrev_b32 v193, 3, v45
    v_mad_i32_i24 v196, v193, -16, v195
    v_and_b32 v193, 1, v193
    v_mad_i32_i24 v196, v193, -14, v196
    ds_write_b32 v194, v23 offset:864
    ds_write_b16 v195, v20 offset:194
    ds_write_b16_d16_hi v195, v20 offset:386
    ds_write_b16_d16_hi v195, v21 offset:578
    ds_write_b16 v196, v22 offset:768
    s_cmp_lg_u64 exec, s[50:51]
    s_addc_u32 s58, s58, s58
    s_mov_b64 exec, s[90:91]
    s_cbranch_execz K2_SC_DONE
    v_cmpx_gt_u32 vcc, 48, v46
    v_lshl_add_u32 v194, v46, 5, v56
    v_lshl_add_u32 v195, v46, 2, v56
    v_lshrrev_b32 v193, 3, v46
    v_mad_i32_i24 v196, v193, -16, v195
    v_and_b32 v193, 1, v193
    v_mad_i32_i24 v196, v193, -14, v196
    ds_write_b32 v194, v27 offset:864
    ds_write_b16 v195, v24 offset:194
    ds_write_b16_d16_hi v195, v24 offset:386
    ds_write_b16_d16_hi v195, v25 offset:578
    ds_write_b16 v196, v26 offset:768
    s_cmp_lg_u64 exec, s[90:91]
    s_addc_u32 s58, s58, s58
    s_mov_b64 exec, s[92:93]
    s_cbranch_execz K2_SC_DONE
    v_cmpx_gt_u32 vcc, 48, v47
    v_lshl_add_u32 v194, v47, 5, v57
    v_lshl_add_u32 v195, v47, 2, v57
    v_lshrrev_b32 v193, 3, v47
    v_mad_i32_i24 v196, v193, -16, v195
    v_and_b32 v193, 1, v193
    v_mad_i32_i24 v196, v193, -14, v196
    ds_write_b32 v194, v31 offset:864
    ds_write_b16 v195, v28 offset:194
    ds_write_b16_d16_hi v195, v28 offset:386
    ds_write_b16_d16_hi v195, v29 offset:578
    ds_write_b16 v196, v30 offset:768
    s_cmp_lg_u64 exec, s[92:93]
    s_addc_u32 s58, s58, s58
    s_mov_b64 exec, s[94:95]
    s_cbranch_execz K2_SC_DONE
    v_cmpx_gt_u32 vcc, 48, v48
    v_lshl_add_u32 v194, v48, 5, v58
    v_lshl_add_u32 v195, v48, 2, v58
    v_lshrrev_b32 v193, 3, v48
    v_mad_i32_i24 v196, v193, -16, v195
    v_and_b32 v193, 1, v193
    v_mad_i32_i24 v196, v193, -14, v196
    ds_write_b32 v194, v35 offset:864
    ds_write_b16 v195, v32 offset:194
    ds_write_b16_d16_hi v195, v32 offset:386
    ds_write_b16_d16_hi v195, v33 offset:578
    ds_write_b16 v196, v34 offset:768
    s_cmp_lg_u64 exec, s[94:95]
    s_addc_u32 s58, s58, s58
    s_mov_b64 exec, s[96:97]
    s_cbranch_execz K2_SC_DONE
    v_cmpx_gt_u32 vcc, 48, v49
    v_lshl_add_u32 v194, v49, 5, v59
    v_lshl_add_u32 v195, v49, 2, v59
    v_lshrrev_b32 v193, 3, v49
    v_mad_i32_i24 v196, v193, -16, v195
    v_and_b32 v193, 1, v193
    v_mad_i32_i24 v196, v193, -14, v196
    ds_write_b32 v194, v39 offset:864
    ds_write_b16 v195, v36 offset:194
    ds_write_b16_d16_hi v195, v36 offset:386
    ds_write_b16_d16_hi v195, v37 offset:578
    ds_write_b16 v196, v38 offset:768
    s_cmp_lg_u64 exec, s[96:97]
    s_addc_u32 s58, s58, s58
K2_SC_DONE:
    s_mov_b64 exec, -1
K2_PAD_SD:
    s_cbranch_execz KS_HOP
    s_bcnt1_i32_b32 s61, s58
    s_cmp_gt_u32 s61, 1
    s_cbranch_scc1 K2_OV
K2_OB:
    v_lshlrev_b32 v192, 2, v176
    v_add_u32 v192, 163424, v192
    v_mov_b32 v200, 163652
    v_mov_b32 v198, 0
    s_movk_i32 s26, 48
    s_cmp_eq_u32 s20, 7
    s_cbranch_scc1 K2_FLGCK
K2_FLGOK:
    s_waitcnt lgkmcnt(0)
    s_barrier
    ds_read_b32 v193, v192
    ds_read_b32 v200, v200
    v_cmp_gt_u32 s[56:57], s22, v176
    v_mad_u32_u24 v195, v176, s59, v202
    s_waitcnt lgkmcnt(0)
    v_cndmask_b32 v193, 0, v193, s[56:57]
    v_readfirstlane_b32 s27, v200
    v_cmp_lt_u32 vcc, 48, v193
    s_nop 0
    s_cbranch_vccnz K2_BIG
K2_TOK:
    v_subrev_u32 v194, s67, v193
    v_max_i32 v194, 1, v194
    v_min_i32 v194, s26, v194
    v_add_u32 v194, 15, v194
    v_lshrrev_b32 v194, 4, v194
    v_lshl_or_b32 v195, v194, 18, v195
    v_or_b32 v195, v195, v198
    v_mov_b32 v197, 425056
    v_cndmask_b32 v253, v197, v195, s[56:57]
    s_movk_i32 s40, 0
    s_movk_i32 s41, 256
    s_movk_i32 s42, 512
    s_movk_i32 s43, 768
    s_add_u32 s24, s24, 1
    s_cmp_ge_u32 s24, s25
    s_cselect_b32 s55, 1, 0
    s_cmp_eq_u32 s27, 0
    s_cselect_b32 s55, s55, 0
    s_mov_b32 s27, 0x400000
    s_mov_b32 s38, 0
    s_mov_b32 s34, 0
    s_mov_b32 s35, 0
    s_mov_b32 s36, 1
    s_mov_b32 s31, 0
    s_mov_b32 s58, s20
    v_readlane_b32 s3, v253, s58
    s_lshl_b32 s44, s34, 7
    s_lshl_b32 s60, s58, 5
    s_and_b32 s48, s3, 0x3ffff
    s_bfe_u32 s33, s3, 0x30012
    s_sub_u32 s60, s60, s48
    s_and_b32 s60, s60, 0xff
    s_add_u32 s60, s60, s48
    s_mul_i32 s35, s38, 6
    s_cmp_eq_u32 s34, 0
    s_cselect_b32 s35, s35, s60
    s_mov_b32 s45, s44
    s_add_u32 s47, s44, 256
    s_add_u32 s49, s48, 32
    s_add_u32 s60, s48, 64
    s_cmp_eq_u32 s33, 3
    s_cselect_b32 s46, s44, s47
    s_cselect_b32 s50, s60, s48
    s_cselect_b32 s51, s48, s49
    s_sub_u32 s60, s33, 2
    s_cmp_lt_u32 s60, 2
    s_cbranch_scc0 K2_rare_1
K2_back_2:
    v_add_u32 v233, s48, v230
    ds_read_b32 v232, v233
    ds_read_b32 v233, v233 offset:1024
    v_add_u32 v222, s48, v251
    ds_read_b32 v222, v222
    v_add_u32 v224, s49, v251
    ds_read_b32 v224, v224
    v_add_u32 v226, s50, v251
    ds_read_b32 v226, v226
    v_add_u32 v228, s51, v251
    ds_read_b32 v228, v228
    s_waitcnt lgkmcnt(4)
    v_or_b32 v232, v232, v231
    v_or_b32 v233, v233, v231
    s_cmp_lg_u32 s34, 0
    s_cbranch_scc1 K2_dum_4
    s_add_u32 m0, s48, 864
    s_add_u32 s65, s48, 1888
    buffer_load_dwordx4 v232, s[16:19], 0 offen  lds
    s_mov_b32 m0, s65
    s_mov_b32 exec_hi, 0
    buffer_load_dwordx4 v233, s[16:19], 0 offen  lds
    s_cmp_eq_u32 s33, 4
    s_cbranch_scc1 K2_a4_5
K2_b4_7:
    s_mov_b32 exec_hi, -1
K2_back_6:
    s_waitcnt lgkmcnt(3)
    v_mad_u32_u16 v223, v222, s39, v248 op_sel:[1,0,0,0]
    v_mad_u32_u16 v222, v222, s39, v248
    s_waitcnt lgkmcnt(2)
    v_mad_u32_u16 v225, v224, s39, v248 op_sel:[1,0,0,0]
    v_mad_u32_u16 v224, v224, s39, v248
    s_waitcnt lgkmcnt(1)
    v_mad_u32_u16 v227, v226, s39, v248 op_sel:[1,0,0,0]
    v_mad_u32_u16 v226, v226, s39, v248
    s_waitcnt lgkmcnt(0)
    v_mad_u32_u16 v229, v228, s39, v248 op_sel:[1,0,0,0]
    v_mad_u32_u16 v228, v228, s39, v248
    s_mov_b32 m0, s68
    s_nop 0
    buffer_load_dwordx4 v222, s[4:7], s44 offen sc1 lds
    buffer_load_dwordx4 v223, s[72:75], s44 offen offset:1024 sc1 lds
    s_mov_b32 m0, s69
    s_nop 0
    buffer_load_dwordx4 v224, s[4:7], s45 offen sc1 lds
    buffer_load_dwordx4 v225, s[72:75], s45 offen offset:1024 sc1 lds
    s_mov_b32 m0, s70
    s_nop 0
    buffer_load_dwordx4 v226, s[4:7], s46 offen sc1 lds
    buffer_load_dwordx4 v227, s[72:75], s46 offen offset:1024 sc1 lds
    s_mov_b32 m0, s71
    s_nop 0
    buffer_load_dwordx4 v228, s[4:7], s47 offen sc1 lds
    buffer_load_dwordx4 v229, s[72:75], s47 offen offset:1024 sc1 lds
    v_add_u32 v249, s48, v249
    v_add_u32 v250, s48, v250
    s_mov_b64 vcc, 0
    s_waitcnt vmcnt(6)
    ds_read_b64_tr_b16 v[176:177], v246 offset:0
    ds_read_b64_tr_b16 v[178:179], v246 offset:512
    ds_read_b64_tr_b16 v[180:181], v247 offset:0
    ds_read_b64_tr_b16 v[182:183], v247 offset:512
    ds_read_b64_tr_b16 v[0:1], v249 offset:0
    ds_read_b64_tr_b16 v[2:3], v249 offset:128
    ds_read_b128 v[4:7], v250 offset:0
    ds_read_b128 v[8:11], v250 offset:16
    ds_read_b128 v[12:15], v250 offset:384
    ds_read_b128 v[16:19], v250 offset:400
    ds_read_b64_tr_b16 v[20:21], v249 offset:512
    ds_read_b64_tr_b16 v[22:23], v249 offset:640
    ds_read_b128 v[24:27], v250 offset:64
    ds_read_b128 v[28:31], v250 offset:80
    ds_read_b128 v[32:35], v250 offset:448
    ds_read_b128 v[36:39], v250 offset:464
    s_mov_b32 s29, s48
    s_mov_b32 s32, s31
    s_mov_b32 s30, s3
    s_mov_b32 s31, s35
    s_cmp_eq_u32 s33, 2
    s_cbranch_scc1 K2_U20
    s_cmp_eq_u32 s33, 3
    s_cbranch_scc1 K2_U30
    s_cmp_eq_u32 s33, 1
    s_cbranch_scc1 K2_U10
    s_branch K2_U40
K2_PAD_H1:
    s_branch KS_HOP0
KS_PRE:
    s_branch KS_PRE2
KS_HELP:
    s_mov_b32 s30, 0
    s_cmp_eq_u32 s20, 6
    s_cbranch_scc1 KS_RAW
    s_mov_b32 s30, 2
    s_cmp_ge_u32 s2, 180
    s_cbranch_scc1 KS_NOW
    s_mov_b32 s30, 1
    v_and_b32 v1, 15, v8
    v_lshrrev_b32 v3, 4, v8
    s_cmp_ge_u32 s2, 160
    s_cbranch_scc1 K1_WT
    s_cmp_ge_u32 s2, 64
    s_cbranch_scc1 K1_S1
    s_lshr_b32 s24, s2, 3
    s_and_b32 s25, s2, 7
    s_lshr_b32 s26, s25, 2
    s_bfe_u32 s27, s25, 0x10001
    s_and_b32 s28, s25, 1
    s_mov_b32 s60, s92
    s_and_b32 s61, s93, 0xffff
    s_mov_b32 s62, 65536
    s_mov_b32 s63, 0x20000
    s_branch K1_SC
K1_S1:
    s_sub_u32 s29, s2, 64
    s_mul_i32 s24, s29, 43
    s_lshr_b32 s24, s24, 9
    s_mul_i32 s25, s24, 12
    s_sub_u32 s25, s29, s25
    s_cmp_ge_u32 s25, 6
    s_cselect_b32 s26, 1, 0
    s_mul_i32 s27, s26, 6
    s_sub_u32 s27, s25, s27
    s_lshr_b32 s27, s27, 1
    s_and_b32 s28, s25, 1
    s_add_u32 s25, s25, 8
    s_mov_b32 s60, s94
    s_and_b32 s61, s95, 0xffff
    s_mov_b32 s62, 98304
    s_mov_b32 s63, 0x20000
K1_SC:
    s_lshl_b32 s27, s27, 7
    s_lshl_b32 s26, s26, 6
    s_lshl_b32 s28, s28, 4
    s_add_u32 s27, s27, s26
    s_add_u32 s27, s27, s28
    s_lshl_b32 s27, s27, 8
    s_lshl_b32 s26, s24, 5
    s_add_u32 s27, s27, s26
    s_add_u32 s29, s27, 8192
    v_lshlrev_b32 v3, 10, v3
    v_lshl_add_u32 v3, v1, 1, v3
    buffer_load_ushort v64, v3, s[60:63], s27 offen offset:0
    buffer_load_ushort v65, v3, s[60:63], s29 offen offset:0
    buffer_load_ushort v66, v3, s[60:63], s27 offen offset:256
    buffer_load_ushort v67, v3, s[60:63], s29 offen offset:256
    buffer_load_ushort v68, v3, s[60:63], s27 offen offset:512
    buffer_load_ushort v69, v3, s[60:63], s29 offen offset:512
    buffer_load_ushort v70, v3, s[60:63], s27 offen offset:768
    buffer_load_ushort v71, v3, s[60:63], s29 offen offset:768
    s_mul_i32 s24, s24, 20
    s_add_u32 s24, s24, s25
    s_lshl_b32 s24, s24, 10
    s_add_u32 s24, s24, 6946816
    s_branch K1_GO
K1_WT:
    s_sub_u32 s24, s2, 160
    s_cmp_ge_u32 s24, 10
    s_cselect_b32 s26, 1, 0
    s_mul_i32 s25, s26, 10
    s_sub_u32 s25, s24, s25
    s_lshr_b32 s27, s25, 1
    s_and_b32 s28, s25, 1
    s_lshl_b32 s27, s27, 8
    s_lshl_b32 s26, s26, 7
    s_lshl_b32 s28, s28, 6
    s_add_u32 s27, s27, s26
    s_add_u32 s27, s27, s28
    s_add_u32 s29, s27, 10240
    s_mov_b32 s60, s90
    s_and_b32 s61, s91, 0xffff
    s_mov_b32 s62, 20480
    s_mov_b32 s63, 0x20000
    v_and_b32 v1, 31, v8
    v_lshrrev_b32 v3, 5, v8
    v_mul_u32_u24 v3, 5120, v3
    v_lshl_add_u32 v3, v1, 1, v3
    buffer_load_ushort v64, v3, s[60:63], s27 offen offset:0
    buffer_load_ushort v65, v3, s[60:63], s27 offen offset:1280
    buffer_load_ushort v66, v3, s[60:63], s27 offen offset:2560
    buffer_load_ushort v67, v3, s[60:63], s27 offen offset:3840
    buffer_load_ushort v68, v3, s[60:63], s29 offen offset:0
    buffer_load_ushort v69, v3, s[60:63], s29 offen offset:1280
    buffer_load_ushort v70, v3, s[60:63], s29 offen offset:2560
    buffer_load_ushort v71, v3, s[60:63], s29 offen offset:3840
    s_lshl_b32 s24, s24, 10
    s_add_u32 s24, s24, 7110656
K1_GO:
KS_NOW:
    s_barrier
K2_PAD_H2:
    s_cbranch_execz KS_HOP0
KS_FILL:
    v_subrev_u32 v76, 320, v0
    v_mov_b32 v80, -1
    v_mov_b32 v77, 1.0
    v_cmp_gt_u32 vcc, 48, v76
    v_lshlrev_b32 v78, 4, v76
    v_add_u32 v78, 65536, v78
    v_cndmask_b32 v80, v80, 0, vcc
    v_cmp_gt_u32 vcc, 12, v76
    v_add_u32 v79, 64800, v78
    s_nop 0
    v_cndmask_b32 v80, v80, v77, vcc
    v_cmp_gt_u32 s[56:57], 54, v8
    v_mov_b32 v81, v80
    v_mov_b32 v82, v80
    v_mov_b32 v83, v80
    ds_write_b128 v78, v[80:83] offset:0
    ds_write_b128 v78, v[80:83] offset:2400
    ds_write_b128 v78, v[80:83] offset:4800
    ds_write_b128 v78, v[80:83] offset:7200
    ds_write_b128 v78, v[80:83] offset:9600
    ds_write_b128 v78, v[80:83] offset:12000
    ds_write_b128 v78, v[80:83] offset:14400
    ds_write_b128 v78, v[80:83] offset:16800
    ds_write_b128 v78, v[80:83] offset:19200
    ds_write_b128 v78, v[80:83] offset:21600
    ds_write_b128 v78, v[80:83] offset:24000
    ds_write_b128 v78, v[80:83] offset:26400
    ds_write_b128 v78, v[80:83] offset:28800
    ds_write_b128 v78, v[80:83] offset:31200
    ds_write_b128 v78, v[80:83] offset:33600
    ds_write_b128 v78, v[80:83] offset:36000
    ds_write_b128 v78, v[80:83] offset:38400
    ds_write_b128 v78, v[80:83] offset:40800
    ds_write_b128 v78, v[80:83] offset:43200
    ds_write_b128 v78, v[80:83] offset:45600
    ds_write_b128 v78, v[80:83] offset:48000
    ds_write_b128 v78, v[80:83] offset:50400
    ds_write_b128 v78, v[80:83] offset:52800
    ds_write_b128 v78, v[80:83] offset:55200
    ds_write_b128 v78, v[80:83] offset:57600
    ds_write_b128 v78, v[80:83] offset:60000
    ds_write_b128 v78, v[80:83] offset:62400
    ds_write_b128 v79, v[80:83] offset:0
    ds_write_b128 v79, v[80:83] offset:2400
    ds_write_b128 v79, v[80:83] offset:4800
    ds_write_b128 v79, v[80:83] offset:7200
    ds_write_b128 v79, v[80:83] offset:9600
    ds_write_b128 v79, v[80:83] offset:12000
    ds_write_b128 v79, v[80:83] offset:14400
    ds_write_b128 v79, v[80:83] offset:16800
    ds_write_b128 v79, v[80:83] offset:19200
    ds_write_b128 v79, v[80:83] offset:21600
    ds_write_b128 v79, v[80:83] offset:24000
    ds_write_b128 v79, v[80:83] offset:26400
    ds_write_b128 v79, v[80:83] offset:28800
    v_mov_b32 v59, 163728
    s_barrier
    ds_read_b32 v59, v59
    s_cmp_eq_u32 s20, 6
    s_cselect_b64 exec, s[56:57], -1
    ds_write_b128 v79, v[80:83] offset:31200
    s_mov_b64 exec, -1
    s_waitcnt vmcnt(0) lgkmcnt(0)
    s_cmp_eq_u32 s30, 0
    s_cbranch_scc1 KS_B3
    s_cmp_eq_u32 s30, 2
    s_cbranch_scc1 KS_NOST
    v_lshl_or_b32 v40, v65, 16, v64
    v_lshl_or_b32 v41, v67, 16, v66
    v_lshl_or_b32 v42, v69, 16, v68
    v_lshl_or_b32 v43, v71, 16, v70
    buffer_store_dwordx4 v[40:43], v9, s[8:11], s24 offen sc1
KS_NOST:
    s_waitcnt lgkmcnt(0)
    s_barrier
    s_lshl_b32 s24, s2, 2
    s_add_u32 s24, s24, 7176192
    s_mov_b64 exec, 1
    s_waitcnt vmcnt(0)
    buffer_store_dword v59, v6, s[8:11], s24 offen sc1
    s_mov_b64 exec, -1
    s_branch KS_JOIN
K2_PAD_H3:
    s_branch KS_HOP0
KS_RAW:
    s_barrier
    s_mov_b32 s60, s90
    s_and_b32 s61, s91, 0xffff
    s_mov_b32 s62, 20480
    s_mov_b32 s63, 0x20000
    s_mov_b32 m0, 24576
    s_movk_i32 s24, 0
    buffer_load_dwordx4 v9, s[60:63], s24 offen offset:0 lds
    buffer_load_dwordx4 v9, s[60:63], s24 offen offset:1024 lds
    buffer_load_dwordx4 v9, s[60:63], s24 offen offset:2048 lds
    buffer_load_dwordx4 v9, s[60:63], s24 offen offset:3072 lds
    s_mov_b32 m0, 28672
    s_movk_i32 s24, 4096
    buffer_load_dwordx4 v9, s[60:63], s24 offen offset:0 lds
    buffer_load_dwordx4 v9, s[60:63], s24 offen offset:1024 lds
    buffer_load_dwordx4 v9, s[60:63], s24 offen offset:2048 lds
    buffer_load_dwordx4 v9, s[60:63], s24 offen offset:3072 lds
    s_mov_b32 m0, 32768
    s_movk_i32 s24, 8192
    buffer_load_dwordx4 v9, s[60:63], s24 offen offset:0 lds
    buffer_load_dwordx4 v9, s[60:63], s24 offen offset:1024 lds
    buffer_load_dwordx4 v9, s[60:63], s24 offen offset:2048 lds
    buffer_load_dwordx4 v9, s[60:63], s24 offen offset:3072 lds
    s_mov_b32 m0, 36864
    s_movk_i32 s24, 12288
    buffer_load_dwordx4 v9, s[60:63], s24 offen offset:0 lds
    buffer_load_dwordx4 v9, s[60:63], s24 offen offset:1024 lds
    buffer_load_dwordx4 v9, s[60:63], s24 offen offset:2048 lds
    buffer_load_dwordx4 v9, s[60:63], s24 offen offset:3072 lds
    s_mov_b32 m0, 40960
    s_movk_i32 s24, 16384
    buffer_load_dwordx4 v9, s[60:63], s24 offen offset:0 lds
    buffer_load_dwordx4 v9, s[60:63], s24 offen offset:1024 lds
    buffer_load_dwordx4 v9, s[60:63], s24 offen offset:2048 lds
    buffer_load_dwordx4 v9, s[60:63], s24 offen offset:3072 lds
    s_branch KS_FILL
KS_IDLE:
    s_barrier
    v_mul_u32_u24 v76, 2979, v0
    v_lshrrev_b32 v76, 16, v76
    v_mul_u32_u24 v77, 2048, v76
    v_lshl_add_u32 v78, v0, 4, v77
    v_add_u32 v78, 67584, v78
    v_add_u32 v79, 67200, v78
    v_mov_b32 v80, -1
    v_mov_b32 v81, -1
    v_cmp_gt_u32 vcc, 14, v76
    v_cmp_gt_u32 s[56:57], 12, v76
    v_mov_b32 v82, -1
    v_mov_b32 v83, -1
    s_mov_b64 exec, vcc
    ds_write_b128 v78, v[80:83]
    ds_write_b128 v78, v[80:83] offset:33600
    s_mov_b64 exec, s[56:57]
    ds_write_b128 v79, v[80:83]
    s_mov_b64 exec, -1
    s_barrier
    s_branch KS_B3
K2_PAD_U20:
    s_branch K2_HOP
K2_U20:
    s_setprio 1
    s_waitcnt lgkmcnt(6)
    v_lshlrev_b32 v40, 16, v0
    v_and_b32 v41, 0xffff0000, v0
    v_lshlrev_b32 v42, 16, v1
    v_and_b32 v43, 0xffff0000, v1
    v_lshlrev_b32 v44, 16, v2
    v_and_b32 v45, 0xffff0000, v2
    v_lshlrev_b32 v46, 16, v3
    v_and_b32 v47, 0xffff0000, v3
    v_mul_f32 v4, v40, v4
    v_mul_f32 v5, v41, v5
    v_mul_f32 v6, v42, v6
    v_mul_f32 v7, v43, v7
    v_mul_f32 v8, v44, v8
    v_mul_f32 v9, v45, v9
    v_mul_f32 v10, v46, v10
    v_mul_f32 v11, v47, v11
    v_cvt_pk_bf16_f32 v64, v4, v5
    v_cvt_pk_bf16_f32 v65, v6, v7
    v_cvt_pk_bf16_f32 v66, v8, v9
    v_cvt_pk_bf16_f32 v67, v10, v11
    v_mul_f32 v12, v40, v12
    v_mul_f32 v13, v41, v13
    v_mul_f32 v14, v42, v14
    v_mul_f32 v15, v43, v15
    v_mul_f32 v16, v44, v16
    v_mul_f32 v17, v45, v17
    v_mul_f32 v18, v46, v18
    v_mul_f32 v19, v47, v19
    v_cvt_pk_bf16_f32 v68, v12, v13
    v_cvt_pk_bf16_f32 v69, v14, v15
    v_cvt_pk_bf16_f32 v70, v16, v17
    v_cvt_pk_bf16_f32 v71, v18, v19
    s_waitcnt lgkmcnt(0)
    v_lshlrev_b32 v48, 16, v20
    v_and_b32 v49, 0xffff0000, v20
    v_lshlrev_b32 v50, 16, v21
    v_and_b32 v51, 0xffff0000, v21
    v_lshlrev_b32 v52, 16, v22
    v_and_b32 v53, 0xffff0000, v22
    v_lshlrev_b32 v54, 16, v23
    v_and_b32 v55, 0xffff0000, v23
    v_mul_f32 v24, v48, v24
    v_mul_f32 v25, v49, v25
    v_mul_f32 v26, v50, v26
    v_mul_f32 v27, v51, v27
    v_mul_f32 v28, v52, v28
    v_mul_f32 v29, v53, v29
    v_mul_f32 v30, v54, v30
    v_mul_f32 v31, v55, v31
    v_cvt_pk_bf16_f32 v72, v24, v25
    v_cvt_pk_bf16_f32 v73, v26, v27
    v_cvt_pk_bf16_f32 v74, v28, v29
    v_cvt_pk_bf16_f32 v75, v30, v31
    v_mul_f32 v32, v48, v32
    v_mul_f32 v33, v49, v33
    v_mul_f32 v34, v50, v34
    v_mul_f32 v35, v51, v35
    v_mul_f32 v36, v52, v36
    v_mul_f32 v37, v53, v37
    v_mul_f32 v38, v54, v38
    v_mul_f32 v39, v55, v39
    v_cvt_pk_bf16_f32 v76, v32, v33
    v_cvt_pk_bf16_f32 v77, v34, v35
    v_cvt_pk_bf16_f32 v78, v36, v37
    v_cvt_pk_bf16_f32 v79, v38, v39
    s_waitcnt vmcnt(4)
    v_mfma_f32_32x32x16_bf16 v[0:15], v[64:67], v[176:179], 0
    ds_read_b64_tr_b16 v[184:185], v246 offset:2048
    ds_read_b64_tr_b16 v[186:187], v246 offset:2560
    ds_read_b64_tr_b16 v[188:189], v247 offset:2048
    ds_read_b64_tr_b16 v[190:191], v247 offset:2560
    s_mov_b32 m0, s68
    v_mfma_f32_32x32x16_bf16 v[16:31], v[68:71], v[176:179], 0
    buffer_load_dwordx4 v222, s[4:7], s42 offen sc1 lds
    buffer_load_dwordx4 v223, s[72:75], s42 offen offset:1024 sc1 lds
    v_permlane32_swap_b32 v242, v236
    v_permlane32_swap_b32 v243, v237
    s_add_u32 s38, s38, 1
    v_mfma_f32_32x32x16_bf16 v[32:47], v[64:67], v[180:183], 0
    v_permlane32_swap_b32 v244, v238
    v_permlane32_swap_b32 v245, v239
    v_permlane32_swap_b32 v240, v241
    v_add_f32 v242, v242, v236
    v_mfma_f32_32x32x16_bf16 v[48:63], v[68:71], v[180:183], 0
    v_add_f32 v243, v243, v237
    v_add_f32 v244, v244, v238
    v_add_f32 v245, v245, v239
    v_add_f32 v240, -v240, -v241
    v_mov_b32 v254, s52
    v_mov_b32 v255, s38
    s_waitcnt vmcnt(4) lgkmcnt(0)
    v_mfma_f32_32x32x16_bf16 v[0:15], v[72:75], v[184:187], v[0:15]
    ds_read_b64_tr_b16 v[176:177], v246 offset:4096
    ds_read_b64_tr_b16 v[178:179], v246 offset:4608
    ds_read_b64_tr_b16 v[180:181], v247 offset:4096
    ds_read_b64_tr_b16 v[182:183], v247 offset:4608
    s_lshl_b32 s58, s38, 3
    s_add_u32 s58, s58, s20
    s_mov_b32 m0, s69
    v_mfma_f32_32x32x16_bf16 v[16:31], v[76:79], v[184:187], v[16:31]
    buffer_load_dwordx4 v224, s[4:7], s42 offen sc1 lds
    buffer_load_dwordx4 v225, s[72:75], s42 offen offset:1024 sc1 lds
    s_set_gpr_idx_on s32, gpr_idx(DST)
    s_nop 0
    v_cvt_pk_bf16_f32 v195, v242, v243
    v_cvt_pk_bf16_f32 v196, v244, v245
    v_cvt_pk_bf16_f32 v197, v240, v240
    s_set_gpr_idx_off
    s_mov_b64 exec, 1
    ds_write_b32 v254, v255
    s_mov_b64 exec, -1
    s_cmp_lt_u32 s58, s22
    s_cbranch_scc0 K2_dyn_8
K2_back_9:
    v_readlane_b32 s3, v253, s58
    s_lshl_b32 s44, s34, 7
    s_lshl_b32 s60, s58, 5
    s_and_b32 s48, s3, 0x3ffff
    s_bfe_u32 s33, s3, 0x30012
    s_sub_u32 s60, s60, s48
    s_and_b32 s60, s60, 0xff
    s_add_u32 s60, s60, s48
    s_mul_i32 s35, s38, 6
    s_cmp_eq_u32 s34, 0
    s_cselect_b32 s35, s35, s60
    s_mov_b32 s45, s44
    s_add_u32 s47, s44, 256
    s_add_u32 s49, s48, 32
    s_add_u32 s60, s48, 64
    s_cmp_eq_u32 s33, 3
    s_cselect_b32 s46, s44, s47
    s_cselect_b32 s50, s60, s48
    s_cselect_b32 s51, s48, s49
    s_sub_u32 s60, s33, 2
    s_cmp_lt_u32 s60, 2
    s_cbranch_scc0 K2_rare_14
K2_back_15:
    v_mfma_f32_32x32x16_bf16 v[32:47], v[72:75], v[188:191], v[32:47]
    v_add_u32 v233, s48, v230
    ds_read_b32 v232, v233
    ds_read_b32 v233, v233 offset:1024
    v_mul_f32 v234, v0, v96
    v_mul_f32 v236, v8, v128
    v_fmac_f32 v234, v1, v97
    v_fmac_f32 v236, v9, v129
    v_mfma_f32_32x32x16_bf16 v[48:63], v[76:79], v[188:191], v[48:63]
    s_setprio 0
    v_fmac_f32 v234, v2, v98
    v_fmac_f32 v236, v10, v130
    v_fmac_f32 v234, v3, v99
    v_fmac_f32 v236, v11, v131
    v_fmac_f32 v234, v4, v100
    v_fmac_f32 v236, v12, v132
    v_fmac_f32 v234, v5, v101
    v_fmac_f32 v236, v13, v133
    v_fmac_f32 v234, v6, v102
    v_fmac_f32 v236, v14, v134
    v_fmac_f32 v234, v7, v103
    v_fmac_f32 v236, v15, v135
    v_mul_f32 v238, v16, v128
    v_mul_f32 v240, v24, v128
    v_fmac_f32 v238, v17, v129
    v_fmac_f32 v240, v25, v129
    v_fmac_f32 v238, v18, v130
    v_fmac_f32 v240, v26, v130
    v_fmac_f32 v238, v19, v131
    v_fmac_f32 v240, v27, v131
    v_fmac_f32 v238, v20, v132
    v_fmac_f32 v240, v28, v132
    v_fmac_f32 v238, v21, v133
    v_fmac_f32 v240, v29, v133
    v_fmac_f32 v238, v22, v134
    v_fmac_f32 v240, v30, v134
    v_fmac_f32 v238, v23, v135
    v_fmac_f32 v240, v31, v135
    v_mul_f32 v235, v32, v104
    v_mul_f32 v237, v40, v136
    v_fmac_f32 v235, v33, v105
    v_fmac_f32 v237, v41, v137
    v_fmac_f32 v235, v34, v106
    v_fmac_f32 v237, v42, v138
    v_fmac_f32 v235, v35, v107
    v_fmac_f32 v237, v43, v139
    v_fmac_f32 v235, v36, v108
    v_fmac_f32 v237, v44, v140
    v_fmac_f32 v235, v37, v109
    v_fmac_f32 v237, v45, v141
    v_fmac_f32 v235, v38, v110
    v_fmac_f32 v237, v46, v142
    v_fmac_f32 v235, v39, v111
    v_fmac_f32 v237, v47, v143
    v_mul_f32 v239, v48, v136
    v_mul_f32 v241, v56, v136
    v_fmac_f32 v239, v49, v137
    v_fmac_f32 v241, v57, v137
    s_setprio 1
    s_waitcnt vmcnt(4) lgkmcnt(3)
    v_mfma_f32_32x32x16_bf16 v[0:15], v[64:67], v[176:179], 0
    ds_read_b64_tr_b16 v[184:185], v246 offset:6144
    ds_read_b64_tr_b16 v[186:187], v246 offset:6656
    ds_read_b64_tr_b16 v[188:189], v247 offset:6144
    ds_read_b64_tr_b16 v[190:191], v247 offset:6656
    v_fmac_f32 v239, v50, v138
    v_fmac_f32 v241, v58, v138
    s_mov_b32 m0, s70
    v_mfma_f32_32x32x16_bf16 v[16:31], v[68:71], v[176:179], 0
    buffer_load_dwordx4 v222, s[4:7], s43 offen sc1 lds
    buffer_load_dwordx4 v223, s[72:75], s43 offen offset:1024 sc1 lds
    v_fmac_f32 v239, v51, v139
    v_fmac_f32 v241, v59, v139
    v_fmac_f32 v239, v52, v140
    v_fmac_f32 v241, v60, v140
    v_fmac_f32 v239, v53, v141
    v_mfma_f32_32x32x16_bf16 v[32:47], v[64:67], v[180:183], 0
    v_add_u32 v222, s48, v251
    ds_read_b32 v222, v222
    v_fmac_f32 v241, v61, v141
    v_fmac_f32 v239, v54, v142
    v_fmac_f32 v241, v62, v142
    v_fmac_f32 v239, v55, v143
    v_fmac_f32 v241, v63, v143
    v_mfma_f32_32x32x16_bf16 v[48:63], v[68:71], v[180:183], 0
    v_permlane32_swap_b32 v234, v236
    v_permlane32_swap_b32 v235, v237
    v_permlane32_swap_b32 v240, v238
    s_waitcnt lgkmcnt(5)
    v_or_b32 v232, v232, v231
    v_or_b32 v233, v233, v231
    s_cmp_lg_u32 s34, 0
    s_cbranch_scc1 K2_dum_19
    s_add_u32 m0, s48, 864
    s_add_u32 s65, s48, 1888
    buffer_load_dwordx4 v232, s[16:19], 0 offen  lds
    s_mov_b32 m0, s65
    s_mov_b32 exec_hi, 0
    buffer_load_dwordx4 v233, s[16:19], 0 offen  lds
    s_cmp_eq_u32 s33, 4
    s_cbranch_scc1 K2_a4_20
K2_b4_22:
    s_mov_b32 exec_hi, -1
K2_back_21:
    s_waitcnt vmcnt(6) lgkmcnt(1)
    v_mfma_f32_32x32x16_bf16 v[0:15], v[72:75], v[184:187], v[0:15]
    ds_read_b64_tr_b16 v[176:177], v246 offset:0
    ds_read_b64_tr_b16 v[178:179], v246 offset:512
    ds_read_b64_tr_b16 v[180:181], v247 offset:0
    ds_read_b64_tr_b16 v[182:183], v247 offset:512
    v_permlane32_swap_b32 v241, v239
    s_mov_b32 m0, s71
    v_mfma_f32_32x32x16_bf16 v[16:31], v[76:79], v[184:187], v[16:31]
    buffer_load_dwordx4 v224, s[4:7], s43 offen sc1 lds
    buffer_load_dwordx4 v225, s[72:75], s43 offen offset:1024 sc1 lds
    s_waitcnt lgkmcnt(4)
    v_mad_u32_u16 v223, v222, s39, v248 op_sel:[1,0,0,0]
    v_mad_u32_u16 v222, v222, s39, v248
    v_add_f32 v234, v234, v236
    v_add_f32 v235, v235, v237
    v_add_f32 v240, v240, v238
    v_add_f32 v241, v241, v239
    s_set_gpr_idx_on s31, gpr_idx(DST)
    s_nop 0
    v_cvt_pk_bf16_f32 v192, v234, v235
    v_cvt_pk_bf16_f32 v193, v240, v241
    s_set_gpr_idx_off
    v_mfma_f32_32x32x16_bf16 v[32:47], v[72:75], v[188:191], v[32:47]
    v_add_u32 v224, s49, v251
    ds_read_b32 v224, v224
    v_mul_f32 v234, v0, v144
    v_mul_f32 v236, v8, v112
    v_fmac_f32 v234, v1, v145
    v_fmac_f32 v236, v9, v113
    v_fmac_f32 v234, v2, v146
    v_mfma_f32_32x32x16_bf16 v[48:63], v[76:79], v[188:191], v[48:63]
    s_setprio 0
    v_fmac_f32 v236, v10, v114
    v_fmac_f32 v234, v3, v147
    v_fmac_f32 v236, v11, v115
    v_fmac_f32 v234, v4, v148
    v_fmac_f32 v236, v12, v116
    v_fmac_f32 v234, v5, v149
    v_fmac_f32 v236, v13, v117
    v_fmac_f32 v234, v6, v150
    v_fmac_f32 v236, v14, v118
    v_fmac_f32 v234, v7, v151
    v_fmac_f32 v236, v15, v119
    v_mul_f32 v238, v16, v160
    v_mul_f32 v240, v24, v160
    v_fmac_f32 v238, v17, v161
    v_fmac_f32 v240, v25, v161
    v_fmac_f32 v238, v18, v162
    v_fmac_f32 v240, v26, v162
    v_fmac_f32 v238, v19, v163
    v_fmac_f32 v240, v27, v163
    v_fmac_f32 v238, v20, v164
    v_fmac_f32 v240, v28, v164
    v_fmac_f32 v238, v21, v165
    v_fmac_f32 v240, v29, v165
    v_fmac_f32 v238, v22, v166
    v_fmac_f32 v240, v30, v166
    v_fmac_f32 v238, v23, v167
    v_fmac_f32 v240, v31, v167
    v_mul_f32 v235, v32, v152
    v_mul_f32 v237, v40, v120
    v_fmac_f32 v235, v33, v153
    v_fmac_f32 v237, v41, v121
    v_fmac_f32 v235, v34, v154
    v_fmac_f32 v237, v42, v122
    v_fmac_f32 v235, v35, v155
    v_fmac_f32 v237, v43, v123
    v_fmac_f32 v235, v36, v156
    v_fmac_f32 v237, v44, v124
    v_fmac_f32 v235, v37, v157
    v_fmac_f32 v237, v45, v125
    v_fmac_f32 v235, v38, v158
    v_fmac_f32 v237, v46, v126
    v_fmac_f32 v235, v39, v159
    v_fmac_f32 v237, v47, v127
    v_mul_f32 v239, v48, v168
    v_mul_f32 v241, v56, v168
    v_fmac_f32 v239, v49, v169
    v_fmac_f32 v241, v57, v169
    v_fmac_f32 v239, v50, v170
    v_fmac_f32 v241, v58, v170
    v_fmac_f32 v239, v51, v171
    v_fmac_f32 v241, v59, v171
    v_fmac_f32 v239, v52, v172
    s_setprio 1
    s_waitcnt vmcnt(6) lgkmcnt(1)
    v_mfma_f32_32x32x16_bf16 v[0:15], v[64:67], v[176:179], 0
    ds_read_b64_tr_b16 v[184:185], v246 offset:2048
    ds_read_b64_tr_b16 v[186:187], v246 offset:2560
    ds_read_b64_tr_b16 v[188:189], v247 offset:2048
    ds_read_b64_tr_b16 v[190:191], v247 offset:2560
    s_cmp_lg_u32 s34, 0
    s_cbranch_scc1 K2_ew_17
K2_back_18:
    s_mov_b32 m0, s68
    v_mfma_f32_32x32x16_bf16 v[16:31], v[68:71], v[176:179], 0
    buffer_load_dwordx4 v222, s[4:7], s44 offen sc1 lds
    buffer_load_dwordx4 v223, s[72:75], s44 offen offset:1024 sc1 lds
    s_waitcnt lgkmcnt(4)
    v_mad_u32_u16 v225, v224, s39, v248 op_sel:[1,0,0,0]
    v_mad_u32_u16 v224, v224, s39, v248
    v_fmac_f32 v241, v60, v172
    v_fmac_f32 v239, v53, v173
    v_mfma_f32_32x32x16_bf16 v[32:47], v[64:67], v[180:183], 0
    v_add_u32 v226, s50, v251
    ds_read_b32 v226, v226
    v_fmac_f32 v241, v61, v173
    v_fmac_f32 v239, v54, v174
    v_fmac_f32 v241, v62, v174
    v_fmac_f32 v239, v55, v175
    v_fmac_f32 v241, v63, v175
    v_mfma_f32_32x32x16_bf16 v[48:63], v[68:71], v[180:183], 0
    s_cbranch_vccnz K2_rlx_23
    s_waitcnt vmcnt(6) lgkmcnt(1)
K2_back_24:
    v_mfma_f32_32x32x16_bf16 v[0:15], v[72:75], v[184:187], v[0:15]
    ds_read_b64_tr_b16 v[176:177], v246 offset:4096
    ds_read_b64_tr_b16 v[178:179], v246 offset:4608
    ds_read_b64_tr_b16 v[180:181], v247 offset:4096
    ds_read_b64_tr_b16 v[182:183], v247 offset:4608
    s_mov_b32 m0, s69
    v_mfma_f32_32x32x16_bf16 v[16:31], v[76:79], v[184:187], v[16:31]
    buffer_load_dwordx4 v224, s[4:7], s45 offen sc1 lds
    buffer_load_dwordx4 v225, s[72:75], s45 offen offset:1024 sc1 lds
    s_waitcnt lgkmcnt(4)
    v_mad_u32_u16 v227, v226, s39, v248 op_sel:[1,0,0,0]
    v_mad_u32_u16 v226, v226, s39, v248
    v_mfma_f32_32x32x16_bf16 v[32:47], v[72:75], v[188:191], v[32:47]
    v_add_u32 v228, s51, v251
    ds_read_b32 v228, v228
    v_mul_f32 v242, v0, v144
    v_fma_f32 v238, v8, v160, -v238
    v_fmac_f32 v242, v1, v145
    v_fmac_f32 v238, v9, v161
    v_fmac_f32 v242, v2, v146
    v_mfma_f32_32x32x16_bf16 v[48:63], v[76:79], v[188:191], v[48:63]
    s_setprio 0
    v_fmac_f32 v238, v10, v162
    v_fmac_f32 v242, v3, v147
    v_fmac_f32 v238, v11, v163
    v_fmac_f32 v242, v4, v148
    v_fmac_f32 v238, v12, v164
    v_fmac_f32 v242, v5, v149
    v_fmac_f32 v238, v13, v165
    v_fmac_f32 v242, v6, v150
    v_fmac_f32 v238, v14, v166
    v_fmac_f32 v242, v7, v151
    v_fmac_f32 v238, v15, v167
    v_fmac_f32 v236, v16, v112
    v_mul_f32 v244, v24, v160
    v_fmac_f32 v236, v17, v113
    v_fmac_f32 v244, v25, v161
    v_fmac_f32 v236, v18, v114
    v_fmac_f32 v244, v26, v162
    v_fmac_f32 v236, v19, v115
    v_fmac_f32 v244, v27, v163
    v_fmac_f32 v236, v20, v116
    v_fmac_f32 v244, v28, v164
    v_fmac_f32 v236, v21, v117
    v_fmac_f32 v244, v29, v165
    v_fmac_f32 v236, v22, v118
    v_fmac_f32 v244, v30, v166
    v_fmac_f32 v236, v23, v119
    v_fmac_f32 v244, v31, v167
    v_mul_f32 v243, v32, v152
    v_fma_f32 v239, v40, v168, -v239
    v_fmac_f32 v243, v33, v153
    v_fmac_f32 v239, v41, v169
    v_fmac_f32 v243, v34, v154
    v_fmac_f32 v239, v42, v170
    v_fmac_f32 v243, v35, v155
    v_fmac_f32 v239, v43, v171
    v_fmac_f32 v243, v36, v156
    v_fmac_f32 v239, v44, v172
    v_fmac_f32 v243, v37, v157
    v_fmac_f32 v239, v45, v173
    v_fmac_f32 v243, v38, v158
    v_fmac_f32 v239, v46, v174
    v_fmac_f32 v243, v39, v159
    v_fmac_f32 v239, v47, v175
    v_fmac_f32 v237, v48, v120
    v_mul_f32 v245, v56, v168
    v_fmac_f32 v237, v49, v121
    v_fmac_f32 v245, v57, v169
    v_fmac_f32 v237, v50, v122
    s_setprio 1
    s_cbranch_vccnz K2_rlx_25
    s_waitcnt vmcnt(4) lgkmcnt(1)
K2_back_26:
    v_mfma_f32_32x32x16_bf16 v[0:15], v[64:67], v[176:179], 0
    ds_read_b64_tr_b16 v[184:185], v246 offset:6144
    ds_read_b64_tr_b16 v[186:187], v246 offset:6656
    ds_read_b64_tr_b16 v[188:189], v247 offset:6144
    ds_read_b64_tr_b16 v[190:191], v247 offset:6656
    v_fmac_f32 v245, v58, v170
    v_fmac_f32 v237, v51, v123
    s_mov_b32 m0, s70
    v_mfma_f32_32x32x16_bf16 v[16:31], v[68:71], v[176:179], 0
    buffer_load_dwordx4 v226, s[4:7], s46 offen sc1 lds
    buffer_load_dwordx4 v227, s[72:75], s46 offen offset:1024 sc1 lds
    s_waitcnt lgkmcnt(4)
    v_mad_u32_u16 v229, v228, s39, v248 op_sel:[1,0,0,0]
    v_mad_u32_u16 v228, v228, s39, v248
    v_fmac_f32 v245, v59, v171
    v_fmac_f32 v237, v52, v124
    v_mfma_f32_32x32x16_bf16 v[32:47], v[64:67], v[180:183], 0
    v_fmac_f32 v245, v60, v172
    v_fmac_f32 v237, v53, v125
    v_fmac_f32 v245, v61, v173
    v_fmac_f32 v237, v54, v126
    v_fmac_f32 v245, v62, v174
    v_fmac_f32 v237, v55, v127
    v_fmac_f32 v245, v63, v175
    v_mfma_f32_32x32x16_bf16 v[48:63], v[68:71], v[180:183], 0
    v_permlane32_swap_b32 v242, v234
    v_permlane32_swap_b32 v243, v235
    v_add_f32 v242, v242, v234
    v_add_f32 v243, v243, v235
    s_waitcnt vmcnt(4) lgkmcnt(0)
    v_mfma_f32_32x32x16_bf16 v[0:15], v[72:75], v[184:187], v[0:15]
    ds_read_b64_tr_b16 v[176:177], v246 offset:0
    ds_read_b64_tr_b16 v[178:179], v246 offset:512
    ds_read_b64_tr_b16 v[180:181], v247 offset:0
    ds_read_b64_tr_b16 v[182:183], v247 offset:512
    s_sub_u32 s26, s48, s29
    s_mov_b32 s29, s48
    s_mov_b32 m0, s71
    v_mfma_f32_32x32x16_bf16 v[16:31], v[76:79], v[184:187], v[16:31]
    buffer_load_dwordx4 v228, s[4:7], s47 offen sc1 lds
    buffer_load_dwordx4 v229, s[72:75], s47 offen offset:1024 sc1 lds
    s_set_gpr_idx_on s31, gpr_idx(DST)
    s_nop 0
    v_cvt_pk_bf16_f32 v194, v242, v243
    s_set_gpr_idx_off
    s_mov_b32 s30, s3
    s_cmp_eq_u32 s34, 0
    s_cselect_b32 s56, s33, 0
    v_mfma_f32_32x32x16_bf16 v[32:47], v[72:75], v[188:191], v[32:47]
    s_mov_b32 s32, s31
    s_mov_b32 s31, s35
    v_mul_f32 v242, v0, v144
    v_fma_f32 v240, v8, v160, -v240
    v_fmac_f32 v242, v1, v145
    v_fmac_f32 v240, v9, v161
    v_fmac_f32 v242, v2, v146
    v_mfma_f32_32x32x16_bf16 v[48:63], v[76:79], v[188:191], v[48:63]
    s_setprio 0
    v_fmac_f32 v240, v10, v162
    v_fmac_f32 v242, v3, v147
    v_fmac_f32 v240, v11, v163
    v_fmac_f32 v242, v4, v148
    v_fmac_f32 v240, v12, v164
    v_fmac_f32 v242, v5, v149
    v_fmac_f32 v240, v13, v165
    v_fmac_f32 v242, v6, v150
    v_fmac_f32 v240, v14, v166
    v_fmac_f32 v242, v7, v151
    v_fmac_f32 v240, v15, v167
    v_add_u32 v249, s26, v249
    v_add_u32 v250, s26, v250
    v_fma_f32 v244, v16, v160, -v244
    v_fmac_f32 v236, v24, v112
    v_fmac_f32 v244, v17, v161
    v_fmac_f32 v236, v25, v113
    v_fmac_f32 v244, v18, v162
    v_fmac_f32 v236, v26, v114
    v_fmac_f32 v244, v19, v163
    v_fmac_f32 v236, v27, v115
    v_fmac_f32 v244, v20, v164
    v_fmac_f32 v236, v28, v116
    v_fmac_f32 v244, v21, v165
    v_fmac_f32 v236, v29, v117
    v_fmac_f32 v244, v22, v166
    v_fmac_f32 v236, v30, v118
    v_fmac_f32 v244, v23, v167
    v_fmac_f32 v236, v31, v119
    ds_read_b64_tr_b16 v[0:1], v249 offset:0
    ds_read_b64_tr_b16 v[2:3], v249 offset:128
    ds_read_b128 v[4:7], v250 offset:0
    ds_read_b128 v[8:11], v250 offset:16
    ds_read_b128 v[12:15], v250 offset:384
    ds_read_b128 v[16:19], v250 offset:400
    v_mul_f32 v243, v32, v152
    v_fma_f32 v241, v40, v168, -v241
    v_fmac_f32 v243, v33, v153
    v_fmac_f32 v241, v41, v169
    v_fmac_f32 v243, v34, v154
    v_fmac_f32 v241, v42, v170
    v_fmac_f32 v243, v35, v155
    v_fmac_f32 v241, v43, v171
    v_fmac_f32 v243, v36, v156
    v_fmac_f32 v241, v44, v172
    v_fmac_f32 v243, v37, v157
    v_fmac_f32 v241, v45, v173
    v_fmac_f32 v243, v38, v158
    v_fmac_f32 v241, v46, v174
    v_fmac_f32 v243, v39, v159
    v_fmac_f32 v241, v47, v175
    ds_read_b64_tr_b16 v[20:21], v249 offset:512
    ds_read_b64_tr_b16 v[22:23], v249 offset:640
    ds_read_b128 v[24:27], v250 offset:64
    ds_read_b128 v[28:31], v250 offset:80
    ds_read_b128 v[32:35], v250 offset:448
    ds_read_b128 v[36:39], v250 offset:464
    v_fma_f32 v245, v48, v168, -v245
    v_fmac_f32 v237, v56, v120
    v_fmac_f32 v245, v49, v169
    v_fmac_f32 v237, v57, v121
    v_fmac_f32 v245, v50, v170
    v_fmac_f32 v237, v58, v122
    v_fmac_f32 v245, v51, v171
    v_fmac_f32 v237, v59, v123
    v_fmac_f32 v245, v52, v172
    v_fmac_f32 v237, v60, v124
    v_fmac_f32 v245, v53, v173
    v_fmac_f32 v237, v61, v125
    v_fmac_f32 v245, v54, v174
    v_fmac_f32 v237, v62, v126
    v_fmac_f32 v245, v55, v175
    v_fmac_f32 v237, v63, v127
    s_cmp_eq_u32 s56, 2
    s_cbranch_scc1 K2_U20
    s_cmp_eq_u32 s56, 3
    s_cbranch_scc1 K2_U30
    s_branch K2_DSP0
K2_PAD_U30:
    s_branch K2_HOP
K2_U30:
    s_setprio 1
    s_waitcnt lgkmcnt(6)
    v_lshlrev_b32 v40, 16, v0
    v_and_b32 v41, 0xffff0000, v0
    v_lshlrev_b32 v42, 16, v1
    v_and_b32 v43, 0xffff0000, v1
    v_lshlrev_b32 v44, 16, v2
    v_and_b32 v45, 0xffff0000, v2
    v_lshlrev_b32 v46, 16, v3
    v_and_b32 v47, 0xffff0000, v3
    v_mul_f32 v4, v40, v4
    v_mul_f32 v5, v41, v5
    v_mul_f32 v6, v42, v6
    v_mul_f32 v7, v43, v7
    v_mul_f32 v8, v44, v8
    v_mul_f32 v9, v45, v9
    v_mul_f32 v10, v46, v10
    v_mul_f32 v11, v47, v11
    v_cvt_pk_bf16_f32 v64, v4, v5
    v_cvt_pk_bf16_f32 v65, v6, v7
    v_cvt_pk_bf16_f32 v66, v8, v9
    v_cvt_pk_bf16_f32 v67, v10, v11
    v_mul_f32 v12, v40, v12
    v_mul_f32 v13, v41, v13
    v_mul_f32 v14, v42, v14
    v_mul_f32 v15, v43, v15
    v_mul_f32 v16, v44, v16
    v_mul_f32 v17, v45, v17
    v_mul_f32 v18, v46, v18
    v_mul_f32 v19, v47, v19
    v_cvt_pk_bf16_f32 v68, v12, v13
    v_cvt_pk_bf16_f32 v69, v14, v15
    v_cvt_pk_bf16_f32 v70, v16, v17
    v_cvt_pk_bf16_f32 v71, v18, v19
    ds_read_b64_tr_b16 v[0:1], v249 offset:1024
    ds_read_b64_tr_b16 v[2:3], v249 offset:1152
    ds_read_b128 v[4:7], v250 offset:128
    ds_read_b128 v[8:11], v250 offset:144
    ds_read_b128 v[12:15], v250 offset:512
    ds_read_b128 v[16:19], v250 offset:528
    s_waitcnt lgkmcnt(6)
    v_lshlrev_b32 v48, 16, v20
    v_and_b32 v49, 0xffff0000, v20
    v_lshlrev_b32 v50, 16, v21
    v_and_b32 v51, 0xffff0000, v21
    v_lshlrev_b32 v52, 16, v22
    v_and_b32 v53, 0xffff0000, v22
    v_lshlrev_b32 v54, 16, v23
    v_and_b32 v55, 0xffff0000, v23
    v_mul_f32 v24, v48, v24
    v_mul_f32 v25, v49, v25
    v_mul_f32 v26, v50, v26
    v_mul_f32 v27, v51, v27
    v_mul_f32 v28, v52, v28
    v_mul_f32 v29, v53, v29
    v_mul_f32 v30, v54, v30
    v_mul_f32 v31, v55, v31
    v_cvt_pk_bf16_f32 v72, v24, v25
    v_cvt_pk_bf16_f32 v73, v26, v27
    v_cvt_pk_bf16_f32 v74, v28, v29
    v_cvt_pk_bf16_f32 v75, v30, v31
    v_mul_f32 v32, v48, v32
    v_mul_f32 v33, v49, v33
    v_mul_f32 v34, v50, v34
    v_mul_f32 v35, v51, v35
    v_mul_f32 v36, v52, v36
    v_mul_f32 v37, v53, v37
    v_mul_f32 v38, v54, v38
    v_mul_f32 v39, v55, v39
    v_cvt_pk_bf16_f32 v76, v32, v33
    v_cvt_pk_bf16_f32 v77, v34, v35
    v_cvt_pk_bf16_f32 v78, v36, v37
    v_cvt_pk_bf16_f32 v79, v38, v39
    s_waitcnt lgkmcnt(4)
    v_lshlrev_b32 v40, 16, v0
    v_and_b32 v41, 0xffff0000, v0
    v_lshlrev_b32 v42, 16, v1
    v_and_b32 v43, 0xffff0000, v1
    v_lshlrev_b32 v44, 16, v2
    v_and_b32 v45, 0xffff0000, v2
    v_lshlrev_b32 v46, 16, v3
    v_and_b32 v47, 0xffff0000, v3
    s_waitcnt lgkmcnt(2)
    v_mul_f32 v4, v40, v4
    v_mul_f32 v5, v41, v5
    v_mul_f32 v6, v42, v6
    v_mul_f32 v7, v43, v7
    v_mul_f32 v8, v44, v8
    v_mul_f32 v9, v45, v9
    v_mul_f32 v10, v46, v10
    v_mul_f32 v11, v47, v11
    v_cvt_pk_bf16_f32 v80, v4, v5
    v_cvt_pk_bf16_f32 v81, v6, v7
    v_cvt_pk_bf16_f32 v82, v8, v9
    v_cvt_pk_bf16_f32 v83, v10, v11
    s_waitcnt lgkmcnt(0)
    v_mul_f32 v12, v40, v12
    v_mul_f32 v13, v41, v13
    v_mul_f32 v14, v42, v14
    v_mul_f32 v15, v43, v15
    v_mul_f32 v16, v44, v16
    v_mul_f32 v17, v45, v17
    v_mul_f32 v18, v46, v18
    v_mul_f32 v19, v47, v19
    v_cvt_pk_bf16_f32 v84, v12, v13
    v_cvt_pk_bf16_f32 v85, v14, v15
    v_cvt_pk_bf16_f32 v86, v16, v17
    v_cvt_pk_bf16_f32 v87, v18, v19
    s_waitcnt vmcnt(4)
    v_mfma_f32_32x32x16_bf16 v[0:15], v[64:67], v[176:179], 0
    ds_read_b64_tr_b16 v[184:185], v246 offset:2048
    ds_read_b64_tr_b16 v[186:187], v246 offset:2560
    ds_read_b64_tr_b16 v[188:189], v247 offset:2048
    ds_read_b64_tr_b16 v[190:191], v247 offset:2560
    s_mov_b32 m0, s68
    v_mfma_f32_32x32x16_bf16 v[16:31], v[68:71], v[176:179], 0
    buffer_load_dwordx4 v224, s[4:7], s41 offen sc1 lds
    buffer_load_dwordx4 v225, s[72:75], s41 offen offset:1024 sc1 lds
    v_permlane32_swap_b32 v242, v236
    v_permlane32_swap_b32 v243, v237
    s_add_u32 s38, s38, 1
    v_mfma_f32_32x32x16_bf16 v[32:47], v[64:67], v[180:183], 0
    v_permlane32_swap_b32 v244, v238
    v_permlane32_swap_b32 v245, v239
    v_permlane32_swap_b32 v240, v241
    v_add_f32 v242, v242, v236
    v_mfma_f32_32x32x16_bf16 v[48:63], v[68:71], v[180:183], 0
    v_add_f32 v243, v243, v237
    v_add_f32 v244, v244, v238
    v_add_f32 v245, v245, v239
    v_add_f32 v240, -v240, -v241
    v_mov_b32 v254, s52
    v_mov_b32 v255, s38
    s_waitcnt vmcnt(4) lgkmcnt(0)
    v_mfma_f32_32x32x16_bf16 v[0:15], v[72:75], v[184:187], v[0:15]
    ds_read_b64_tr_b16 v[176:177], v246 offset:4096
    ds_read_b64_tr_b16 v[178:179], v246 offset:4608
    ds_read_b64_tr_b16 v[180:181], v247 offset:4096
    ds_read_b64_tr_b16 v[182:183], v247 offset:4608
    s_lshl_b32 s58, s38, 3
    s_add_u32 s58, s58, s20
    s_mov_b32 m0, s69
    v_mfma_f32_32x32x16_bf16 v[16:31], v[76:79], v[184:187], v[16:31]
    buffer_load_dwordx4 v226, s[4:7], s41 offen sc1 lds
    buffer_load_dwordx4 v227, s[72:75], s41 offen offset:1024 sc1 lds
    s_set_gpr_idx_on s32, gpr_idx(DST)
    s_nop 0
    v_cvt_pk_bf16_f32 v195, v242, v243
    v_cvt_pk_bf16_f32 v196, v244, v245
    v_cvt_pk_bf16_f32 v197, v240, v240
    s_set_gpr_idx_off
    s_mov_b64 exec, 1
    ds_write_b32 v254, v255
    s_mov_b64 exec, -1
    s_cmp_lt_u32 s58, s22
    s_cbranch_scc0 K2_dyn_27
K2_back_28:
    v_readlane_b32 s3, v253, s58
    s_lshl_b32 s44, s34, 7
    s_lshl_b32 s60, s58, 5
    s_and_b32 s48, s3, 0x3ffff
    s_bfe_u32 s33, s3, 0x30012
    s_sub_u32 s60, s60, s48
    s_and_b32 s60, s60, 0xff
    s_add_u32 s60, s60, s48
    s_mul_i32 s35, s38, 6
    s_cmp_eq_u32 s34, 0
    s_cselect_b32 s35, s35, s60
    s_mov_b32 s45, s44
    s_add_u32 s47, s44, 256
    s_add_u32 s49, s48, 32
    s_add_u32 s60, s48, 64
    s_cmp_eq_u32 s33, 3
    s_cselect_b32 s46, s44, s47
    s_cselect_b32 s50, s60, s48
    s_cselect_b32 s51, s48, s49
    s_sub_u32 s60, s33, 2
    s_cmp_lt_u32 s60, 2
    s_cbranch_scc0 K2_rare_33
K2_back_34:
    v_mfma_f32_32x32x16_bf16 v[32:47], v[72:75], v[188:191], v[32:47]
    v_add_u32 v233, s48, v230
    ds_read_b32 v232, v233
    ds_read_b32 v233, v233 offset:1024
    v_mfma_f32_32x32x16_bf16 v[48:63], v[76:79], v[188:191], v[48:63]
    s_waitcnt vmcnt(4) lgkmcnt(3)
    v_mfma_f32_32x32x16_bf16 v[0:15], v[80:83], v[176:179], v[0:15]
    ds_read_b64_tr_b16 v[184:185], v246 offset:6144
    ds_read_b64_tr_b16 v[186:187], v246 offset:6656
    ds_read_b64_tr_b16 v[188:189], v247 offset:6144
    ds_read_b64_tr_b16 v[190:191], v247 offset:6656
    s_mov_b32 m0, s70
    v_mfma_f32_32x32x16_bf16 v[16:31], v[84:87], v[176:179], v[16:31]
    buffer_load_dwordx4 v222, s[4:7], s42 offen sc1 lds
    buffer_load_dwordx4 v223, s[72:75], s42 offen offset:1024 sc1 lds
    v_mfma_f32_32x32x16_bf16 v[32:47], v[80:83], v[180:183], v[32:47]
    s_nop 2
    v_mul_f32 v234, v0, v96
    v_mul_f32 v236, v8, v128
    v_fmac_f32 v234, v1, v97
    v_fmac_f32 v236, v9, v129
    v_fmac_f32 v234, v2, v98
    v_fmac_f32 v236, v10, v130
    v_fmac_f32 v234, v3, v99
    v_mfma_f32_32x32x16_bf16 v[48:63], v[84:87], v[180:183], v[48:63]
    s_setprio 0
    s_waitcnt lgkmcnt(4)
    v_or_b32 v232, v232, v231
    v_or_b32 v233, v233, v231
    s_cmp_lg_u32 s34, 0
    s_cbranch_scc1 K2_dum_38
    s_add_u32 m0, s48, 864
    s_add_u32 s65, s48, 1888
    buffer_load_dwordx4 v232, s[16:19], 0 offen  lds
    s_mov_b32 m0, s65
    s_mov_b32 exec_hi, 0
    buffer_load_dwordx4 v233, s[16:19], 0 offen  lds
    s_cmp_eq_u32 s33, 4
    s_cbranch_scc1 K2_a4_39
K2_b4_41:
    s_mov_b32 exec_hi, -1
K2_back_40:
    v_fmac_f32 v236, v11, v131
    v_fmac_f32 v234, v4, v100
    v_fmac_f32 v236, v12, v132
    v_fmac_f32 v234, v5, v101
    v_fmac_f32 v236, v13, v133
    v_fmac_f32 v234, v6, v102
    v_fmac_f32 v236, v14, v134
    v_fmac_f32 v234, v7, v103
    v_fmac_f32 v236, v15, v135
    v_mul_f32 v238, v16, v128
    v_mul_f32 v240, v24, v128
    v_fmac_f32 v238, v17, v129
    v_fmac_f32 v240, v25, v129
    v_fmac_f32 v238, v18, v130
    v_fmac_f32 v240, v26, v130
    v_fmac_f32 v238, v19, v131
    v_fmac_f32 v240, v27, v131
    v_fmac_f32 v238, v20, v132
    v_fmac_f32 v240, v28, v132
    v_fmac_f32 v238, v21, v133
    v_fmac_f32 v240, v29, v133
    v_fmac_f32 v238, v22, v134
    v_fmac_f32 v240, v30, v134
    v_fmac_f32 v238, v23, v135
    v_fmac_f32 v240, v31, v135
    v_mul_f32 v235, v32, v104
    v_mul_f32 v237, v40, v136
    v_fmac_f32 v235, v33, v105
    v_fmac_f32 v237, v41, v137
    v_fmac_f32 v235, v34, v106
    v_fmac_f32 v237, v42, v138
    v_fmac_f32 v235, v35, v107
    v_fmac_f32 v237, v43, v139
    v_fmac_f32 v235, v36, v108
    v_fmac_f32 v237, v44, v140
    v_fmac_f32 v235, v37, v109
    v_fmac_f32 v237, v45, v141
    v_fmac_f32 v235, v38, v110
    v_fmac_f32 v237, v46, v142
    v_fmac_f32 v235, v39, v111
    v_fmac_f32 v237, v47, v143
    v_mul_f32 v239, v48, v136
    v_mul_f32 v241, v56, v136
    s_setprio 1
    s_waitcnt vmcnt(6) lgkmcnt(0)
    v_mfma_f32_32x32x16_bf16 v[0:15], v[64:67], v[184:187], 0
    ds_read_b64_tr_b16 v[176:177], v246 offset:0
    ds_read_b64_tr_b16 v[178:179], v246 offset:512
    ds_read_b64_tr_b16 v[180:181], v247 offset:0
    ds_read_b64_tr_b16 v[182:183], v247 offset:512
    v_fmac_f32 v239, v49, v137
    v_fmac_f32 v241, v57, v137
    s_mov_b32 m0, s71
    v_mfma_f32_32x32x16_bf16 v[16:31], v[68:71], v[184:187], 0
    buffer_load_dwordx4 v224, s[4:7], s42 offen sc1 lds
    buffer_load_dwordx4 v225, s[72:75], s42 offen offset:1024 sc1 lds
    v_fmac_f32 v239, v50, v138
    v_fmac_f32 v241, v58, v138
    v_fmac_f32 v239, v51, v139
    v_fmac_f32 v241, v59, v139
    v_fmac_f32 v239, v52, v140
    v_mfma_f32_32x32x16_bf16 v[32:47], v[64:67], v[188:191], 0
    v_fmac_f32 v241, v60, v140
    v_fmac_f32 v239, v53, v141
    v_fmac_f32 v241, v61, v141
    v_fmac_f32 v239, v54, v142
    v_fmac_f32 v241, v62, v142
    v_fmac_f32 v239, v55, v143
    v_fmac_f32 v241, v63, v143
    v_mfma_f32_32x32x16_bf16 v[48:63], v[68:71], v[188:191], 0
    v_permlane32_swap_b32 v234, v236
    v_permlane32_swap_b32 v235, v237
    v_permlane32_swap_b32 v240, v238
    s_waitcnt vmcnt(6) lgkmcnt(0)
    v_mfma_f32_32x32x16_bf16 v[0:15], v[72:75], v[176:179], v[0:15]
    ds_read_b64_tr_b16 v[184:185], v246 offset:2048
    ds_read_b64_tr_b16 v[186:187], v246 offset:2560
    ds_read_b64_tr_b16 v[188:189], v247 offset:2048
    ds_read_b64_tr_b16 v[190:191], v247 offset:2560
    v_permlane32_swap_b32 v241, v239
    s_mov_b32 m0, s68
    v_mfma_f32_32x32x16_bf16 v[16:31], v[76:79], v[176:179], v[16:31]
    buffer_load_dwordx4 v226, s[4:7], s42 offen sc1 lds
    buffer_load_dwordx4 v227, s[72:75], s42 offen offset:1024 sc1 lds
    v_add_f32 v234, v234, v236
    v_add_f32 v235, v235, v237
    v_add_f32 v240, v240, v238
    v_add_f32 v241, v241, v239
    v_mfma_f32_32x32x16_bf16 v[32:47], v[72:75], v[180:183], v[32:47]
    s_set_gpr_idx_on s31, gpr_idx(DST)
    s_nop 0
    v_cvt_pk_bf16_f32 v192, v234, v235
    v_cvt_pk_bf16_f32 v193, v240, v241
    s_set_gpr_idx_off
    v_mfma_f32_32x32x16_bf16 v[48:63], v[76:79], v[180:183], v[48:63]
    s_waitcnt vmcnt(6) lgkmcnt(0)
    v_mfma_f32_32x32x16_bf16 v[0:15], v[80:83], v[184:187], v[0:15]
    ds_read_b64_tr_b16 v[176:177], v246 offset:4096
    ds_read_b64_tr_b16 v[178:179], v246 offset:4608
    ds_read_b64_tr_b16 v[180:181], v247 offset:4096
    ds_read_b64_tr_b16 v[182:183], v247 offset:4608
    s_mov_b32 m0, s69
    v_mfma_f32_32x32x16_bf16 v[16:31], v[84:87], v[184:187], v[16:31]
    buffer_load_dwordx4 v222, s[4:7], s43 offen sc1 lds
    buffer_load_dwordx4 v223, s[72:75], s43 offen offset:1024 sc1 lds
    v_mfma_f32_32x32x16_bf16 v[32:47], v[80:83], v[188:191], v[32:47]
    s_nop 2
    v_mul_f32 v234, v0, v144
    v_mul_f32 v236, v8, v112
    v_fmac_f32 v234, v1, v145
    v_fmac_f32 v236, v9, v113
    v_fmac_f32 v234, v2, v146
    v_fmac_f32 v236, v10, v114
    v_fmac_f32 v234, v3, v147
    v_mfma_f32_32x32x16_bf16 v[48:63], v[84:87], v[188:191], v[48:63]
    s_setprio 0
    v_fmac_f32 v236, v11, v115
    v_fmac_f32 v234, v4, v148
    v_fmac_f32 v236, v12, v116
    v_fmac_f32 v234, v5, v149
    v_fmac_f32 v236, v13, v117
    v_fmac_f32 v234, v6, v150
    v_fmac_f32 v236, v14, v118
    v_fmac_f32 v234, v7, v151
    v_fmac_f32 v236, v15, v119
    v_mul_f32 v238, v16, v160
    v_mul_f32 v240, v24, v160
    v_fmac_f32 v238, v17, v161
    v_fmac_f32 v240, v25, v161
    v_fmac_f32 v238, v18, v162
    v_fmac_f32 v240, v26, v162
    v_fmac_f32 v238, v19, v163
    v_fmac_f32 v240, v27, v163
    v_fmac_f32 v238, v20, v164
    v_fmac_f32 v240, v28, v164
    v_fmac_f32 v238, v21, v165
    v_fmac_f32 v240, v29, v165
    v_fmac_f32 v238, v22, v166
    v_fmac_f32 v240, v30, v166
    v_fmac_f32 v238, v23, v167
    v_fmac_f32 v240, v31, v167
    v_mul_f32 v235, v32, v152
    v_mul_f32 v237, v40, v120
    v_fmac_f32 v235, v33, v153
    v_fmac_f32 v237, v41, v121
    v_fmac_f32 v235, v34, v154
    v_fmac_f32 v237, v42, v122
    v_fmac_f32 v235, v35, v155
    v_fmac_f32 v237, v43, v123
    v_fmac_f32 v235, v36, v156
    v_fmac_f32 v237, v44, v124
    v_fmac_f32 v235, v37, v157
    v_fmac_f32 v237, v45, v125
    v_fmac_f32 v235, v38, v158
    v_fmac_f32 v237, v46, v126
    v_fmac_f32 v235, v39, v159
    v_fmac_f32 v237, v47, v127
    v_mul_f32 v239, v48, v168
    v_mul_f32 v241, v56, v168
    v_fmac_f32 v239, v49, v169
    v_fmac_f32 v241, v57, v169
    s_setprio 1
    s_waitcnt vmcnt(4) lgkmcnt(0)
    v_mfma_f32_32x32x16_bf16 v[0:15], v[64:67], v[176:179], 0
    ds_read_b64_tr_b16 v[184:185], v246 offset:6144
    ds_read_b64_tr_b16 v[186:187], v246 offset:6656
    ds_read_b64_tr_b16 v[188:189], v247 offset:6144
    ds_read_b64_tr_b16 v[190:191], v247 offset:6656
    v_fmac_f32 v239, v50, v170
    v_fmac_f32 v241, v58, v170
    s_mov_b32 m0, s70
    v_mfma_f32_32x32x16_bf16 v[16:31], v[68:71], v[176:179], 0
    buffer_load_dwordx4 v224, s[4:7], s43 offen sc1 lds
    buffer_load_dwordx4 v225, s[72:75], s43 offen offset:1024 sc1 lds
    v_fmac_f32 v239, v51, v171
    v_fmac_f32 v241, v59, v171
    v_fmac_f32 v239, v52, v172
    v_fmac_f32 v241, v60, v172
    v_fmac_f32 v239, v53, v173
    v_mfma_f32_32x32x16_bf16 v[32:47], v[64:67], v[180:183], 0
    v_add_u32 v222, s48, v251
    ds_read_b32 v222, v222
    v_fmac_f32 v241, v61, v173
    v_fmac_f32 v239, v54, v174
    v_fmac_f32 v241, v62, v174
    v_fmac_f32 v239, v55, v175
    v_fmac_f32 v241, v63, v175
    v_mfma_f32_32x32x16_bf16 v[48:63], v[68:71], v[180:183], 0
    s_waitcnt vmcnt(4) lgkmcnt(1)
    v_mfma_f32_32x32x16_bf16 v[0:15], v[72:75], v[184:187], v[0:15]
    ds_read_b64_tr_b16 v[176:177], v246 offset:0
    ds_read_b64_tr_b16 v[178:179], v246 offset:512
    ds_read_b64_tr_b16 v[180:181], v247 offset:0
    ds_read_b64_tr_b16 v[182:183], v247 offset:512
    s_mov_b32 m0, s71
    v_mfma_f32_32x32x16_bf16 v[16:31], v[76:79], v[184:187], v[16:31]
    buffer_load_dwordx4 v226, s[4:7], s43 offen sc1 lds
    buffer_load_dwordx4 v227, s[72:75], s43 offen offset:1024 sc1 lds
    s_waitcnt lgkmcnt(4)
    v_mad_u32_u16 v223, v222, s39, v248 op_sel:[1,0,0,0]
    v_mad_u32_u16 v222, v222, s39, v248
    v_mfma_f32_32x32x16_bf16 v[32:47], v[72:75], v[188:191], v[32:47]
    v_add_u32 v224, s49, v251
    ds_read_b32 v224, v224
    v_mfma_f32_32x32x16_bf16 v[48:63], v[76:79], v[188:191], v[48:63]
    s_waitcnt vmcnt(4) lgkmcnt(1)
    v_mfma_f32_32x32x16_bf16 v[0:15], v[80:83], v[176:179], v[0:15]
    ds_read_b64_tr_b16 v[184:185], v246 offset:2048
    ds_read_b64_tr_b16 v[186:187], v246 offset:2560
    ds_read_b64_tr_b16 v[188:189], v247 offset:2048
    ds_read_b64_tr_b16 v[190:191], v247 offset:2560
    s_cmp_lg_u32 s34, 0
    s_cbranch_scc1 K2_ew_36
K2_back_37:
    s_mov_b32 m0, s68
    v_mfma_f32_32x32x16_bf16 v[16:31], v[84:87], v[176:179], v[16:31]
    buffer_load_dwordx4 v222, s[4:7], s44 offen sc1 lds
    buffer_load_dwordx4 v223, s[72:75], s44 offen offset:1024 sc1 lds
    s_waitcnt lgkmcnt(4)
    v_mad_u32_u16 v225, v224, s39, v248 op_sel:[1,0,0,0]
    v_mad_u32_u16 v224, v224, s39, v248
    v_mfma_f32_32x32x16_bf16 v[32:47], v[80:83], v[180:183], v[32:47]
    v_add_u32 v226, s50, v251
    ds_read_b32 v226, v226
    v_mul_f32 v242, v0, v144
    v_fma_f32 v238, v8, v160, -v238
    v_fmac_f32 v242, v1, v145
    v_fmac_f32 v238, v9, v161
    v_fmac_f32 v242, v2, v146
    v_mfma_f32_32x32x16_bf16 v[48:63], v[84:87], v[180:183], v[48:63]
    s_setprio 0
    v_fmac_f32 v238, v10, v162
    v_fmac_f32 v242, v3, v147
    v_fmac_f32 v238, v11, v163
    v_fmac_f32 v242, v4, v148
    v_fmac_f32 v238, v12, v164
    v_fmac_f32 v242, v5, v149
    v_fmac_f32 v238, v13, v165
    v_fmac_f32 v242, v6, v150
    v_fmac_f32 v238, v14, v166
    v_fmac_f32 v242, v7, v151
    v_fmac_f32 v238, v15, v167
    v_fmac_f32 v236, v16, v112
    v_mul_f32 v244, v24, v160
    v_fmac_f32 v236, v17, v113
    v_fmac_f32 v244, v25, v161
    v_fmac_f32 v236, v18, v114
    v_fmac_f32 v244, v26, v162
    v_fmac_f32 v236, v19, v115
    v_fmac_f32 v244, v27, v163
    v_fmac_f32 v236, v20, v116
    v_fmac_f32 v244, v28, v164
    v_fmac_f32 v236, v21, v117
    v_fmac_f32 v244, v29, v165
    v_fmac_f32 v236, v22, v118
    v_fmac_f32 v244, v30, v166
    v_fmac_f32 v236, v23, v119
    v_fmac_f32 v244, v31, v167
    v_mul_f32 v243, v32, v152
    v_fma_f32 v239, v40, v168, -v239
    v_fmac_f32 v243, v33, v153
    v_fmac_f32 v239, v41, v169
    v_fmac_f32 v243, v34, v154
    v_fmac_f32 v239, v42, v170
    v_fmac_f32 v243, v35, v155
    v_fmac_f32 v239, v43, v171
    v_fmac_f32 v243, v36, v156
    v_fmac_f32 v239, v44, v172
    v_fmac_f32 v243, v37, v157
    v_fmac_f32 v239, v45, v173
    v_fmac_f32 v243, v38, v158
    v_fmac_f32 v239, v46, v174
    v_fmac_f32 v243, v39, v159
    v_fmac_f32 v239, v47, v175
    v_fmac_f32 v237, v48, v120
    v_mul_f32 v245, v56, v168
    v_fmac_f32 v237, v49, v121
    v_fmac_f32 v245, v57, v169
    v_fmac_f32 v237, v50, v122
    v_fmac_f32 v245, v58, v170
    v_fmac_f32 v237, v51, v123
    s_setprio 1
    s_cbranch_vccnz K2_rlx_42
    s_waitcnt vmcnt(4) lgkmcnt(1)
K2_back_43:
    v_mfma_f32_32x32x16_bf16 v[0:15], v[64:67], v[184:187], 0
    ds_read_b64_tr_b16 v[176:177], v246 offset:4096
    ds_read_b64_tr_b16 v[178:179], v246 offset:4608
    ds_read_b64_tr_b16 v[180:181], v247 offset:4096
    ds_read_b64_tr_b16 v[182:183], v247 offset:4608
    v_fmac_f32 v245, v59, v171
    v_fmac_f32 v237, v52, v124
    s_mov_b32 m0, s69
    v_mfma_f32_32x32x16_bf16 v[16:31], v[68:71], v[184:187], 0
    buffer_load_dwordx4 v224, s[4:7], s45 offen sc1 lds
    buffer_load_dwordx4 v225, s[72:75], s45 offen offset:1024 sc1 lds
    s_waitcnt lgkmcnt(4)
    v_mad_u32_u16 v227, v226, s39, v248 op_sel:[1,0,0,0]
    v_mad_u32_u16 v226, v226, s39, v248
    v_fmac_f32 v245, v60, v172
    v_fmac_f32 v237, v53, v125
    v_mfma_f32_32x32x16_bf16 v[32:47], v[64:67], v[188:191], 0
    v_add_u32 v228, s51, v251
    ds_read_b32 v228, v228
    v_fmac_f32 v245, v61, v173
    v_fmac_f32 v237, v54, v126
    v_fmac_f32 v245, v62, v174
    v_fmac_f32 v237, v55, v127
    v_fmac_f32 v245, v63, v175
    v_mfma_f32_32x32x16_bf16 v[48:63], v[68:71], v[188:191], 0
    v_permlane32_swap_b32 v242, v234
    v_permlane32_swap_b32 v243, v235
    v_add_f32 v242, v242, v234
    s_cbranch_vccnz K2_rlx_44
    s_waitcnt vmcnt(4) lgkmcnt(1)
K2_back_45:
    v_mfma_f32_32x32x16_bf16 v[0:15], v[72:75], v[176:179], v[0:15]
    ds_read_b64_tr_b16 v[184:185], v246 offset:6144
    ds_read_b64_tr_b16 v[186:187], v246 offset:6656
    ds_read_b64_tr_b16 v[188:189], v247 offset:6144
    ds_read_b64_tr_b16 v[190:191], v247 offset:6656
    v_add_f32 v243, v243, v235
    s_mov_b32 m0, s70
    v_mfma_f32_32x32x16_bf16 v[16:31], v[76:79], v[176:179], v[16:31]
    buffer_load_dwordx4 v226, s[4:7], s46 offen sc1 lds
    buffer_load_dwordx4 v227, s[72:75], s46 offen offset:1024 sc1 lds
    s_waitcnt lgkmcnt(4)
    v_mad_u32_u16 v229, v228, s39, v248 op_sel:[1,0,0,0]
    v_mad_u32_u16 v228, v228, s39, v248
    s_sub_u32 s26, s48, s29
    s_mov_b32 s29, s48
    v_mfma_f32_32x32x16_bf16 v[32:47], v[72:75], v[180:183], v[32:47]
    s_set_gpr_idx_on s31, gpr_idx(DST)
    s_nop 0
    v_cvt_pk_bf16_f32 v194, v242, v243
    s_set_gpr_idx_off
    s_mov_b32 s30, s3
    s_cmp_eq_u32 s34, 0
    s_cselect_b32 s56, s33, 0
    s_mov_b32 s32, s31
    v_mfma_f32_32x32x16_bf16 v[48:63], v[76:79], v[180:183], v[48:63]
    s_mov_b32 s31, s35
    s_waitcnt vmcnt(4) lgkmcnt(0)
    v_mfma_f32_32x32x16_bf16 v[0:15], v[80:83], v[184:187], v[0:15]
    ds_read_b64_tr_b16 v[176:177], v246 offset:0
    ds_read_b64_tr_b16 v[178:179], v246 offset:512
    ds_read_b64_tr_b16 v[180:181], v247 offset:0
    ds_read_b64_tr_b16 v[182:183], v247 offset:512
    s_mov_b32 m0, s71
    v_mfma_f32_32x32x16_bf16 v[16:31], v[84:87], v[184:187], v[16:31]
    buffer_load_dwordx4 v228, s[4:7], s47 offen sc1 lds
    buffer_load_dwordx4 v229, s[72:75], s47 offen offset:1024 sc1 lds
    v_mfma_f32_32x32x16_bf16 v[32:47], v[80:83], v[188:191], v[32:47]
    s_nop 2
    v_mul_f32 v242, v0, v144
    v_fma_f32 v240, v8, v160, -v240
    v_fmac_f32 v242, v1, v145
    v_fmac_f32 v240, v9, v161
    v_fmac_f32 v242, v2, v146
    v_fmac_f32 v240, v10, v162
    v_fmac_f32 v242, v3, v147
    v_mfma_f32_32x32x16_bf16 v[48:63], v[84:87], v[188:191], v[48:63]
    s_setprio 0
    v_fmac_f32 v240, v11, v163
    v_fmac_f32 v242, v4, v148
    v_fmac_f32 v240, v12, v164
    v_fmac_f32 v242, v5, v149
    v_fmac_f32 v240, v13, v165
    v_fmac_f32 v242, v6, v150
    v_fmac_f32 v240, v14, v166
    v_fmac_f32 v242, v7, v151
    v_fmac_f32 v240, v15, v167
    v_add_u32 v249, s26, v249
    v_add_u32 v250, s26, v250
    v_fma_f32 v244, v16, v160, -v244
    v_fmac_f32 v236, v24, v112
    v_fmac_f32 v244, v17, v161
    v_fmac_f32 v236, v25, v113
    v_fmac_f32 v244, v18, v162
    v_fmac_f32 v236, v26, v114
    v_fmac_f32 v244, v19, v163
    v_fmac_f32 v236, v27, v115
    v_fmac_f32 v244, v20, v164
    v_fmac_f32 v236, v28, v116
    v_fmac_f32 v244, v21, v165
    v_fmac_f32 v236, v29, v117
    v_fmac_f32 v244, v22, v166
    v_fmac_f32 v236, v30, v118
    v_fmac_f32 v244, v23, v167
    v_fmac_f32 v236, v31, v119
    ds_read_b64_tr_b16 v[0:1], v249 offset:0
    ds_read_b64_tr_b16 v[2:3], v249 offset:128
    ds_read_b128 v[4:7], v250 offset:0
    ds_read_b128 v[8:11], v250 offset:16
    ds_read_b128 v[12:15], v250 offset:384
    ds_read_b128 v[16:19], v250 offset:400
    v_mul_f32 v243, v32, v152
    v_fma_f32 v241, v40, v168, -v241
    v_fmac_f32 v243, v33, v153
    v_fmac_f32 v241, v41, v169
    v_fmac_f32 v243, v34, v154
    v_fmac_f32 v241, v42, v170
    v_fmac_f32 v243, v35, v155
    v_fmac_f32 v241, v43, v171
    v_fmac_f32 v243, v36, v156
    v_fmac_f32 v241, v44, v172
    v_fmac_f32 v243, v37, v157
    v_fmac_f32 v241, v45, v173
    v_fmac_f32 v243, v38, v158
    v_fmac_f32 v241, v46, v174
    v_fmac_f32 v243, v39, v159
    v_fmac_f32 v241, v47, v175
    ds_read_b64_tr_b16 v[20:21], v249 offset:512
    ds_read_b64_tr_b16 v[22:23], v249 offset:640
    ds_read_b128 v[24:27], v250 offset:64
    ds_read_b128 v[28:31], v250 offset:80
    ds_read_b128 v[32:35], v250 offset:448
    ds_read_b128 v[36:39], v250 offset:464
    v_fma_f32 v245, v48, v168, -v245
    v_fmac_f32 v237, v56, v120
    v_fmac_f32 v245, v49, v169
    v_fmac_f32 v237, v57, v121
    v_fmac_f32 v245, v50, v170
    v_fmac_f32 v237, v58, v122
    v_fmac_f32 v245, v51, v171
    v_fmac_f32 v237, v59, v123
    v_fmac_f32 v245, v52, v172
    v_fmac_f32 v237, v60, v124
    v_fmac_f32 v245, v53, v173
    v_fmac_f32 v237, v61, v125
    v_fmac_f32 v245, v54, v174
    v_fmac_f32 v237, v62, v126
    v_fmac_f32 v245, v55, v175
    v_fmac_f32 v237, v63, v127
    s_cmp_eq_u32 s56, 2
    s_cbranch_scc1 K2_U20
    s_cmp_eq_u32 s56, 3
    s_cbranch_scc1 K2_U30
    s_branch K2_DSP0
K2_PAD_U21:
    s_branch K2_HOP
K2_U21:
    s_setprio 1
    s_waitcnt lgkmcnt(6)
    v_lshlrev_b32 v40, 16, v0
    v_and_b32 v41, 0xffff0000, v0
    v_lshlrev_b32 v42, 16, v1
    v_and_b32 v43, 0xffff0000, v1
    v_lshlrev_b32 v44, 16, v2
    v_and_b32 v45, 0xffff0000, v2
    v_lshlrev_b32 v46, 16, v3
    v_and_b32 v47, 0xffff0000, v3
    v_mul_f32 v4, v40, v4
    v_mul_f32 v5, v41, v5
    v_mul_f32 v6, v42, v6
    v_mul_f32 v7, v43, v7
    v_mul_f32 v8, v44, v8
    v_mul_f32 v9, v45, v9
    v_mul_f32 v10, v46, v10
    v_mul_f32 v11, v47, v11
    v_cvt_pk_bf16_f32 v64, v4, v5
    v_cvt_pk_bf16_f32 v65, v6, v7
    v_cvt_pk_bf16_f32 v66, v8, v9
    v_cvt_pk_bf16_f32 v67, v10, v11
    v_mul_f32 v12, v40, v12
    v_mul_f32 v13, v41, v13
    v_mul_f32 v14, v42, v14
    v_mul_f32 v15, v43, v15
    v_mul_f32 v16, v44, v16
    v_mul_f32 v17, v45, v17
    v_mul_f32 v18, v46, v18
    v_mul_f32 v19, v47, v19
    v_cvt_pk_bf16_f32 v68, v12, v13
    v_cvt_pk_bf16_f32 v69, v14, v15
    v_cvt_pk_bf16_f32 v70, v16, v17
    v_cvt_pk_bf16_f32 v71, v18, v19
    s_waitcnt lgkmcnt(0)
    v_lshlrev_b32 v48, 16, v20
    v_and_b32 v49, 0xffff0000, v20
    v_lshlrev_b32 v50, 16, v21
    v_and_b32 v51, 0xffff0000, v21
    v_lshlrev_b32 v52, 16, v22
    v_and_b32 v53, 0xffff0000, v22
    v_lshlrev_b32 v54, 16, v23
    v_and_b32 v55, 0xffff0000, v23
    v_mul_f32 v24, v48, v24
    v_mul_f32 v25, v49, v25
    v_mul_f32 v26, v50, v26
    v_mul_f32 v27, v51, v27
    v_mul_f32 v28, v52, v28
    v_mul_f32 v29, v53, v29
    v_mul_f32 v30, v54, v30
    v_mul_f32 v31, v55, v31
    v_cvt_pk_bf16_f32 v72, v24, v25
    v_cvt_pk_bf16_f32 v73, v26, v27
    v_cvt_pk_bf16_f32 v74, v28, v29
    v_cvt_pk_bf16_f32 v75, v30, v31
    v_mul_f32 v32, v48, v32
    v_mul_f32 v33, v49, v33
    v_mul_f32 v34, v50, v34
    v_mul_f32 v35, v51, v35
    v_mul_f32 v36, v52, v36
    v_mul_f32 v37, v53, v37
    v_mul_f32 v38, v54, v38
    v_mul_f32 v39, v55, v39
    v_cvt_pk_bf16_f32 v76, v32, v33
    v_cvt_pk_bf16_f32 v77, v34, v35
    v_cvt_pk_bf16_f32 v78, v36, v37
    v_cvt_pk_bf16_f32 v79, v38, v39
    s_waitcnt vmcnt(4)
    v_mfma_f32_32x32x16_bf16 v[0:15], v[64:67], v[176:179], 0
    ds_read_b64_tr_b16 v[184:185], v246 offset:2048
    ds_read_b64_tr_b16 v[186:187], v246 offset:2560
    ds_read_b64_tr_b16 v[188:189], v247 offset:2048
    ds_read_b64_tr_b16 v[190:191], v247 offset:2560
    s_mov_b32 m0, s68
    v_mfma_f32_32x32x16_bf16 v[16:31], v[68:71], v[176:179], 0
    buffer_load_dwordx4 v222, s[4:7], s42 offen sc1 lds
    buffer_load_dwordx4 v223, s[72:75], s42 offen offset:1024 sc1 lds
    v_permlane32_swap_b32 v242, v236
    v_permlane32_swap_b32 v243, v237
    v_mov_b32 v254, 163648
    v_mfma_f32_32x32x16_bf16 v[32:47], v[64:67], v[180:183], 0
    v_permlane32_swap_b32 v244, v238
    v_permlane32_swap_b32 v245, v239
    v_permlane32_swap_b32 v240, v241
    v_add_f32 v242, v242, v236
    v_mfma_f32_32x32x16_bf16 v[48:63], v[68:71], v[180:183], 0
    v_add_f32 v243, v243, v237
    v_add_f32 v244, v244, v238
    v_add_f32 v245, v245, v239
    v_add_f32 v240, -v240, -v241
    v_sub_u32 v241, v230, v231
    v_cvt_pk_bf16_f32 v242, v242, v243
    v_mov_b32 v255, 1
    v_lshl_add_u32 v233, v252, 1, s53
    s_mov_b64 exec, 1
    ds_add_rtn_u32 v232, v254, v255
    s_mov_b64 exec, -1
    ds_read_b32 v233, v233
    s_waitcnt vmcnt(4) lgkmcnt(2)
    v_mfma_f32_32x32x16_bf16 v[0:15], v[72:75], v[184:187], v[0:15]
    ds_read_b64_tr_b16 v[176:177], v246 offset:4096
    ds_read_b64_tr_b16 v[178:179], v246 offset:4608
    ds_read_b64_tr_b16 v[180:181], v247 offset:4096
    ds_read_b64_tr_b16 v[182:183], v247 offset:4608
    v_cvt_pk_bf16_f32 v244, v244, v245
    v_cvt_pk_bf16_f32 v240, v240, v240
    s_mov_b32 m0, s69
    v_mfma_f32_32x32x16_bf16 v[16:31], v[76:79], v[184:187], v[16:31]
    buffer_load_dwordx4 v224, s[4:7], s42 offen sc1 lds
    buffer_load_dwordx4 v225, s[72:75], s42 offen offset:1024 sc1 lds
    ds_write_b32 v230, v242 offset:768
    ds_write_b32 v230, v244 offset:1024
    ds_write_b16 v241, v240 offset:1280
    s_waitcnt lgkmcnt(7)
    v_readfirstlane_b32 s58, v232
    v_mfma_f32_32x32x16_bf16 v[32:47], v[72:75], v[188:191], v[32:47]
    s_cmp_lt_u32 s58, s22
    s_cbranch_scc0 K2_nul_46
    s_and_b32 s59, s58, 7
    s_lshr_b32 s60, s58, 3
K2_chk_48:
    v_readlane_b32 s61, v233, s59
    s_nop 0
    s_cmp_gt_u32 s61, s60
    s_cbranch_scc0 K2_spin_47
K2_back_49:
    v_mfma_f32_32x32x16_bf16 v[48:63], v[76:79], v[188:191], v[48:63]
    s_setprio 0
    v_readlane_b32 s3, v253, s58
    s_lshl_b32 s44, s34, 7
    s_lshl_b32 s60, s58, 5
    s_and_b32 s48, s3, 0x3ffff
    s_bfe_u32 s33, s3, 0x30012
    s_sub_u32 s60, s60, s48
    v_mul_f32 v234, v0, v96
    v_mul_f32 v236, v8, v128
    v_fmac_f32 v234, v1, v97
    v_fmac_f32 v236, v9, v129
    v_fmac_f32 v234, v2, v98
    v_fmac_f32 v236, v10, v130
    v_fmac_f32 v234, v3, v99
    v_fmac_f32 v236, v11, v131
    v_fmac_f32 v234, v4, v100
    v_fmac_f32 v236, v12, v132
    v_fmac_f32 v234, v5, v101
    v_fmac_f32 v236, v13, v133
    v_fmac_f32 v234, v6, v102
    v_fmac_f32 v236, v14, v134
    v_fmac_f32 v234, v7, v103
    v_fmac_f32 v236, v15, v135
    v_mul_f32 v238, v16, v128
    v_mul_f32 v240, v24, v128
    v_fmac_f32 v238, v17, v129
    v_fmac_f32 v240, v25, v129
    v_fmac_f32 v238, v18, v130
    v_fmac_f32 v240, v26, v130
    v_fmac_f32 v238, v19, v131
    v_fmac_f32 v240, v27, v131
    v_fmac_f32 v238, v20, v132
    v_fmac_f32 v240, v28, v132
    v_fmac_f32 v238, v21, v133
    v_fmac_f32 v240, v29, v133
    v_fmac_f32 v238, v22, v134
    v_fmac_f32 v240, v30, v134
    v_fmac_f32 v238, v23, v135
    v_fmac_f32 v240, v31, v135
    v_mul_f32 v235, v32, v104
    v_mul_f32 v237, v40, v136
    v_fmac_f32 v235, v33, v105
    v_fmac_f32 v237, v41, v137
    v_fmac_f32 v235, v34, v106
    v_fmac_f32 v237, v42, v138
    v_fmac_f32 v235, v35, v107
    v_fmac_f32 v237, v43, v139
    v_fmac_f32 v235, v36, v108
    v_fmac_f32 v237, v44, v140
    v_fmac_f32 v235, v37, v109
    v_fmac_f32 v237, v45, v141
    v_fmac_f32 v235, v38, v110
    v_fmac_f32 v237, v46, v142
    v_fmac_f32 v235, v39, v111
    v_fmac_f32 v237, v47, v143
    v_mul_f32 v239, v48, v136
    v_mul_f32 v241, v56, v136
    v_fmac_f32 v239, v49, v137
    v_fmac_f32 v241, v57, v137
    s_setprio 1
    s_waitcnt vmcnt(4) lgkmcnt(3)
    v_mfma_f32_32x32x16_bf16 v[0:15], v[64:67], v[176:179], 0
    ds_read_b64_tr_b16 v[184:185], v246 offset:6144
    ds_read_b64_tr_b16 v[186:187], v246 offset:6656
    ds_read_b64_tr_b16 v[188:189], v247 offset:6144
    ds_read_b64_tr_b16 v[190:191], v247 offset:6656
    v_fmac_f32 v239, v50, v138
    v_fmac_f32 v241, v58, v138
    s_mov_b32 m0, s70
    v_mfma_f32_32x32x16_bf16 v[16:31], v[68:71], v[176:179], 0
    buffer_load_dwordx4 v222, s[4:7], s43 offen sc1 lds
    buffer_load_dwordx4 v223, s[72:75], s43 offen offset:1024 sc1 lds
    v_fmac_f32 v239, v51, v139
    v_fmac_f32 v241, v59, v139
    v_fmac_f32 v239, v52, v140
    v_fmac_f32 v241, v60, v140
    v_fmac_f32 v239, v53, v141
    v_mfma_f32_32x32x16_bf16 v[32:47], v[64:67], v[180:183], 0
    s_and_b32 s60, s60, 0xff
    s_add_u32 s35, s60, s48
    s_mov_b32 s45, s44
    s_add_u32 s47, s44, 256
    s_add_u32 s49, s48, 32
    s_add_u32 s60, s48, 64
    s_cmp_eq_u32 s33, 3
    s_cselect_b32 s46, s44, s47
    s_cselect_b32 s50, s60, s48
    s_cselect_b32 s51, s48, s49
    s_sub_u32 s60, s33, 2
    s_cmp_lt_u32 s60, 2
    s_cbranch_scc0 K2_rare_50
K2_back_51:
    v_add_u32 v222, s48, v251
    ds_read_b32 v222, v222
    v_fmac_f32 v241, v61, v141
    v_fmac_f32 v239, v54, v142
    v_fmac_f32 v241, v62, v142
    v_fmac_f32 v239, v55, v143
    v_fmac_f32 v241, v63, v143
    v_mfma_f32_32x32x16_bf16 v[48:63], v[68:71], v[180:183], 0
    v_permlane32_swap_b32 v234, v236
    v_permlane32_swap_b32 v235, v237
    v_permlane32_swap_b32 v240, v238
    s_waitcnt vmcnt(4) lgkmcnt(1)
    v_mfma_f32_32x32x16_bf16 v[0:15], v[72:75], v[184:187], v[0:15]
    ds_read_b64_tr_b16 v[176:177], v246 offset:0
    ds_read_b64_tr_b16 v[178:179], v246 offset:512
    ds_read_b64_tr_b16 v[180:181], v247 offset:0
    ds_read_b64_tr_b16 v[182:183], v247 offset:512
    v_permlane32_swap_b32 v241, v239
    s_mov_b32 m0, s71
    v_mfma_f32_32x32x16_bf16 v[16:31], v[76:79], v[184:187], v[16:31]
    buffer_load_dwordx4 v224, s[4:7], s43 offen sc1 lds
    buffer_load_dwordx4 v225, s[72:75], s43 offen offset:1024 sc1 lds
    s_waitcnt lgkmcnt(4)
    v_mad_u32_u16 v223, v222, s39, v248 op_sel:[1,0,0,0]
    v_mad_u32_u16 v222, v222, s39, v248
    v_lshl_add_u32 v230, v252, 1, s31
    v_add_f32 v234, v234, v236
    v_add_f32 v235, v235, v237
    v_add_f32 v240, v240, v238
    v_add_f32 v241, v241, v239
    v_cvt_pk_bf16_f32 v234, v234, v235
    v_cvt_pk_bf16_f32 v240, v240, v241
    ds_write_b32 v230, v234 offset:0
    ds_write_b32 v230, v240 offset:256
    v_mfma_f32_32x32x16_bf16 v[32:47], v[72:75], v[188:191], v[32:47]
    v_add_u32 v224, s49, v251
    ds_read_b32 v224, v224
    v_mul_f32 v234, v0, v144
    v_mul_f32 v236, v8, v112
    v_fmac_f32 v234, v1, v145
    v_fmac_f32 v236, v9, v113
    v_fmac_f32 v234, v2, v146
    v_mfma_f32_32x32x16_bf16 v[48:63], v[76:79], v[188:191], v[48:63]
    s_setprio 0
    v_fmac_f32 v236, v10, v114
    v_fmac_f32 v234, v3, v147
    v_fmac_f32 v236, v11, v115
    v_fmac_f32 v234, v4, v148
    v_fmac_f32 v236, v12, v116
    v_fmac_f32 v234, v5, v149
    v_fmac_f32 v236, v13, v117
    v_fmac_f32 v234, v6, v150
    v_fmac_f32 v236, v14, v118
    v_fmac_f32 v234, v7, v151
    v_fmac_f32 v236, v15, v119
    v_mul_f32 v238, v16, v160
    v_mul_f32 v240, v24, v160
    v_fmac_f32 v238, v17, v161
    v_fmac_f32 v240, v25, v161
    v_fmac_f32 v238, v18, v162
    v_fmac_f32 v240, v26, v162
    v_fmac_f32 v238, v19, v163
    v_fmac_f32 v240, v27, v163
    v_fmac_f32 v238, v20, v164
    v_fmac_f32 v240, v28, v164
    v_fmac_f32 v238, v21, v165
    v_fmac_f32 v240, v29, v165
    v_fmac_f32 v238, v22, v166
    v_fmac_f32 v240, v30, v166
    v_fmac_f32 v238, v23, v167
    v_fmac_f32 v240, v31, v167
    v_mul_f32 v235, v32, v152
    v_mul_f32 v237, v40, v120
    v_fmac_f32 v235, v33, v153
    v_fmac_f32 v237, v41, v121
    v_fmac_f32 v235, v34, v154
    v_fmac_f32 v237, v42, v122
    v_fmac_f32 v235, v35, v155
    v_fmac_f32 v237, v43, v123
    v_fmac_f32 v235, v36, v156
    v_fmac_f32 v237, v44, v124
    v_fmac_f32 v235, v37, v157
    v_fmac_f32 v237, v45, v125
    v_fmac_f32 v235, v38, v158
    v_fmac_f32 v237, v46, v126
    v_fmac_f32 v235, v39, v159
    v_fmac_f32 v237, v47, v127
    v_mul_f32 v239, v48, v168
    v_mul_f32 v241, v56, v168
    v_fmac_f32 v239, v49, v169
    v_fmac_f32 v241, v57, v169
    v_fmac_f32 v239, v50, v170
    v_fmac_f32 v241, v58, v170
    v_fmac_f32 v239, v51, v171
    s_setprio 1
    s_waitcnt vmcnt(4) lgkmcnt(3)
    v_mfma_f32_32x32x16_bf16 v[0:15], v[64:67], v[176:179], 0
    ds_read_b64_tr_b16 v[184:185], v246 offset:2048
    ds_read_b64_tr_b16 v[186:187], v246 offset:2560
    ds_read_b64_tr_b16 v[188:189], v247 offset:2048
    ds_read_b64_tr_b16 v[190:191], v247 offset:2560
    v_fmac_f32 v241, v59, v171
    v_fmac_f32 v239, v52, v172
    s_mov_b32 m0, s68
    v_mfma_f32_32x32x16_bf16 v[16:31], v[68:71], v[176:179], 0
    buffer_load_dwordx4 v222, s[4:7], s44 offen sc1 lds
    buffer_load_dwordx4 v223, s[72:75], s44 offen offset:1024 sc1 lds
    s_waitcnt lgkmcnt(4)
    v_mad_u32_u16 v225, v224, s39, v248 op_sel:[1,0,0,0]
    v_mad_u32_u16 v224, v224, s39, v248
    v_fmac_f32 v241, v60, v172
    v_fmac_f32 v239, v53, v173
    v_mfma_f32_32x32x16_bf16 v[32:47], v[64:67], v[180:183], 0
    v_add_u32 v226, s50, v251
    ds_read_b32 v226, v226
    v_fmac_f32 v241, v61, v173
    v_fmac_f32 v239, v54, v174
    v_fmac_f32 v241, v62, v174
    v_fmac_f32 v239, v55, v175
    v_fmac_f32 v241, v63, v175
    v_mfma_f32_32x32x16_bf16 v[48:63], v[68:71], v[180:183], 0
    s_waitcnt vmcnt(4) lgkmcnt(1)
    v_mfma_f32_32x32x16_bf16 v[0:15], v[72:75], v[184:187], v[0:15]
    ds_read_b64_tr_b16 v[176:177], v246 offset:4096
    ds_read_b64_tr_b16 v[178:179], v246 offset:4608
    ds_read_b64_tr_b16 v[180:181], v247 offset:4096
    ds_read_b64_tr_b16 v[182:183], v247 offset:4608
    s_mov_b32 m0, s69
    v_mfma_f32_32x32x16_bf16 v[16:31], v[76:79], v[184:187], v[16:31]
    buffer_load_dwordx4 v224, s[4:7], s45 offen sc1 lds
    buffer_load_dwordx4 v225, s[72:75], s45 offen offset:1024 sc1 lds
    s_waitcnt lgkmcnt(4)
    v_mad_u32_u16 v227, v226, s39, v248 op_sel:[1,0,0,0]
    v_mad_u32_u16 v226, v226, s39, v248
    v_mfma_f32_32x32x16_bf16 v[32:47], v[72:75], v[188:191], v[32:47]
    v_add_u32 v228, s51, v251
    ds_read_b32 v228, v228
    v_mul_f32 v242, v0, v144
    v_fma_f32 v238, v8, v160, -v238
    v_fmac_f32 v242, v1, v145
    v_fmac_f32 v238, v9, v161
    v_fmac_f32 v242, v2, v146
    v_mfma_f32_32x32x16_bf16 v[48:63], v[76:79], v[188:191], v[48:63]
    s_setprio 0
    v_fmac_f32 v238, v10, v162
    v_fmac_f32 v242, v3, v147
    v_fmac_f32 v238, v11, v163
    v_fmac_f32 v242, v4, v148
    v_fmac_f32 v238, v12, v164
    v_fmac_f32 v242, v5, v149
    v_fmac_f32 v238, v13, v165
    v_fmac_f32 v242, v6, v150
    v_fmac_f32 v238, v14, v166
    v_fmac_f32 v242, v7, v151
    v_fmac_f32 v238, v15, v167
    v_fmac_f32 v236, v16, v112
    v_mul_f32 v244, v24, v160
    v_fmac_f32 v236, v17, v113
    v_fmac_f32 v244, v25, v161
    v_fmac_f32 v236, v18, v114
    v_fmac_f32 v244, v26, v162
    v_fmac_f32 v236, v19, v115
    v_fmac_f32 v244, v27, v163
    v_fmac_f32 v236, v20, v116
    v_fmac_f32 v244, v28, v164
    v_fmac_f32 v236, v21, v117
    v_fmac_f32 v244, v29, v165
    v_fmac_f32 v236, v22, v118
    v_fmac_f32 v244, v30, v166
    v_fmac_f32 v236, v23, v119
    v_fmac_f32 v244, v31, v167
    v_mul_f32 v243, v32, v152
    v_fma_f32 v239, v40, v168, -v239
    v_fmac_f32 v243, v33, v153
    v_fmac_f32 v239, v41, v169
    v_fmac_f32 v243, v34, v154
    v_fmac_f32 v239, v42, v170
    v_fmac_f32 v243, v35, v155
    v_fmac_f32 v239, v43, v171
    v_fmac_f32 v243, v36, v156
    v_fmac_f32 v239, v44, v172
    v_fmac_f32 v243, v37, v157
    v_fmac_f32 v239, v45, v173
    v_fmac_f32 v243, v38, v158
    v_fmac_f32 v239, v46, v174
    v_fmac_f32 v243, v39, v159
    v_fmac_f32 v239, v47, v175
    v_fmac_f32 v237, v48, v120
    v_mul_f32 v245, v56, v168
    v_fmac_f32 v237, v49, v121
    v_fmac_f32 v245, v57, v169
    v_fmac_f32 v237, v50, v122
    s_setprio 1
    s_waitcnt vmcnt(4) lgkmcnt(1)
    v_mfma_f32_32x32x16_bf16 v[0:15], v[64:67], v[176:179], 0
    ds_read_b64_tr_b16 v[184:185], v246 offset:6144
    ds_read_b64_tr_b16 v[186:187], v246 offset:6656
    ds_read_b64_tr_b16 v[188:189], v247 offset:6144
    ds_read_b64_tr_b16 v[190:191], v247 offset:6656
    v_fmac_f32 v245, v58, v170
    v_fmac_f32 v237, v51, v123
    s_mov_b32 m0, s70
    v_mfma_f32_32x32x16_bf16 v[16:31], v[68:71], v[176:179], 0
    buffer_load_dwordx4 v226, s[4:7], s46 offen sc1 lds
    buffer_load_dwordx4 v227, s[72:75], s46 offen offset:1024 sc1 lds
    s_waitcnt lgkmcnt(4)
    v_mad_u32_u16 v229, v228, s39, v248 op_sel:[1,0,0,0]
    v_mad_u32_u16 v228, v228, s39, v248
    v_fmac_f32 v245, v59, v171
    v_fmac_f32 v237, v52, v124
    v_mfma_f32_32x32x16_bf16 v[32:47], v[64:67], v[180:183], 0
    v_fmac_f32 v245, v60, v172
    v_fmac_f32 v237, v53, v125
    v_fmac_f32 v245, v61, v173
    v_fmac_f32 v237, v54, v126
    v_fmac_f32 v245, v62, v174
    v_fmac_f32 v237, v55, v127
    v_fmac_f32 v245, v63, v175
    v_mfma_f32_32x32x16_bf16 v[48:63], v[68:71], v[180:183], 0
    v_permlane32_swap_b32 v242, v234
    v_permlane32_swap_b32 v243, v235
    v_add_f32 v242, v242, v234
    v_add_f32 v243, v243, v235
    s_waitcnt vmcnt(4) lgkmcnt(0)
    v_mfma_f32_32x32x16_bf16 v[0:15], v[72:75], v[184:187], v[0:15]
    ds_read_b64_tr_b16 v[176:177], v246 offset:0
    ds_read_b64_tr_b16 v[178:179], v246 offset:512
    ds_read_b64_tr_b16 v[180:181], v247 offset:0
    ds_read_b64_tr_b16 v[182:183], v247 offset:512
    v_cvt_pk_bf16_f32 v242, v242, v243
    ds_write_b32 v230, v242 offset:512
    s_mov_b32 m0, s71
    v_mfma_f32_32x32x16_bf16 v[16:31], v[76:79], v[184:187], v[16:31]
    buffer_load_dwordx4 v228, s[4:7], s47 offen sc1 lds
    buffer_load_dwordx4 v229, s[72:75], s47 offen offset:1024 sc1 lds
    s_sub_u32 s26, s48, s29
    s_mov_b32 s29, s48
    s_mov_b32 s30, s3
    s_cmp_lg_u32 s36, 0
    s_cselect_b32 s56, s33, 0
    v_mfma_f32_32x32x16_bf16 v[32:47], v[72:75], v[188:191], v[32:47]
    s_mov_b32 s32, s31
    s_mov_b32 s31, s35
    v_mul_f32 v242, v0, v144
    v_fma_f32 v240, v8, v160, -v240
    v_fmac_f32 v242, v1, v145
    v_fmac_f32 v240, v9, v161
    v_fmac_f32 v242, v2, v146
    v_mfma_f32_32x32x16_bf16 v[48:63], v[76:79], v[188:191], v[48:63]
    s_setprio 0
    v_fmac_f32 v240, v10, v162
    v_fmac_f32 v242, v3, v147
    v_fmac_f32 v240, v11, v163
    v_fmac_f32 v242, v4, v148
    v_fmac_f32 v240, v12, v164
    v_fmac_f32 v242, v5, v149
    v_fmac_f32 v240, v13, v165
    v_fmac_f32 v242, v6, v150
    v_fmac_f32 v240, v14, v166
    v_fmac_f32 v242, v7, v151
    v_fmac_f32 v240, v15, v167
    v_add_u32 v249, s26, v249
    v_add_u32 v250, s26, v250
    v_fma_f32 v244, v16, v160, -v244
    v_fmac_f32 v236, v24, v112
    v_fmac_f32 v244, v17, v161
    v_fmac_f32 v236, v25, v113
    v_fmac_f32 v244, v18, v162
    v_fmac_f32 v236, v26, v114
    v_fmac_f32 v244, v19, v163
    v_fmac_f32 v236, v27, v115
    v_fmac_f32 v244, v20, v164
    v_fmac_f32 v236, v28, v116
    v_fmac_f32 v244, v21, v165
    v_fmac_f32 v236, v29, v117
    v_fmac_f32 v244, v22, v166
    v_fmac_f32 v236, v30, v118
    v_fmac_f32 v244, v23, v167
    v_fmac_f32 v236, v31, v119
    ds_read_b64_tr_b16 v[0:1], v249 offset:0
    ds_read_b64_tr_b16 v[2:3], v249 offset:128
    ds_read_b128 v[4:7], v250 offset:0
    ds_read_b128 v[8:11], v250 offset:16
    ds_read_b128 v[12:15], v250 offset:384
    ds_read_b128 v[16:19], v250 offset:400
    v_mul_f32 v243, v32, v152
    v_fma_f32 v241, v40, v168, -v241
    v_fmac_f32 v243, v33, v153
    v_fmac_f32 v241, v41, v169
    v_fmac_f32 v243, v34, v154
    v_fmac_f32 v241, v42, v170
    v_fmac_f32 v243, v35, v155
    v_fmac_f32 v241, v43, v171
    v_fmac_f32 v243, v36, v156
    v_fmac_f32 v241, v44, v172
    v_fmac_f32 v243, v37, v157
    v_fmac_f32 v241, v45, v173
    v_fmac_f32 v243, v38, v158
    v_fmac_f32 v241, v46, v174
    v_fmac_f32 v243, v39, v159
    v_fmac_f32 v241, v47, v175
    ds_read_b64_tr_b16 v[20:21], v249 offset:512
    ds_read_b64_tr_b16 v[22:23], v249 offset:640
    ds_read_b128 v[24:27], v250 offset:64
    ds_read_b128 v[28:31], v250 offset:80
    ds_read_b128 v[32:35], v250 offset:448
    ds_read_b128 v[36:39], v250 offset:464
    v_fma_f32 v245, v48, v168, -v245
    v_fmac_f32 v237, v56, v120
    v_fmac_f32 v245, v49, v169
    v_fmac_f32 v237, v57, v121
    v_fmac_f32 v245, v50, v170
    v_fmac_f32 v237, v58, v122
    v_fmac_f32 v245, v51, v171
    v_fmac_f32 v237, v59, v123
    v_fmac_f32 v245, v52, v172
    v_fmac_f32 v237, v60, v124
    v_fmac_f32 v245, v53, v173
    v_fmac_f32 v237, v61, v125
    v_fmac_f32 v245, v54, v174
    v_fmac_f32 v237, v62, v126
    v_fmac_f32 v245, v55, v175
    v_fmac_f32 v237, v63, v127
    s_cmp_eq_u32 s56, 2
    s_cbranch_scc1 K2_U21
    s_cmp_eq_u32 s56, 3
    s_cbranch_scc1 K2_U31
    s_branch K2_DSP1
K2_PAD_U31:
    s_branch K2_HOP
K2_U31:
    s_setprio 1
    s_waitcnt lgkmcnt(6)
    v_lshlrev_b32 v40, 16, v0
    v_and_b32 v41, 0xffff0000, v0
    v_lshlrev_b32 v42, 16, v1
    v_and_b32 v43, 0xffff0000, v1
    v_lshlrev_b32 v44, 16, v2
    v_and_b32 v45, 0xffff0000, v2
    v_lshlrev_b32 v46, 16, v3
    v_and_b32 v47, 0xffff0000, v3
    v_mul_f32 v4, v40, v4
    v_mul_f32 v5, v41, v5
    v_mul_f32 v6, v42, v6
    v_mul_f32 v7, v43, v7
    v_mul_f32 v8, v44, v8
    v_mul_f32 v9, v45, v9
    v_mul_f32 v10, v46, v10
    v_mul_f32 v11, v47, v11
    v_cvt_pk_bf16_f32 v64, v4, v5
    v_cvt_pk_bf16_f32 v65, v6, v7
    v_cvt_pk_bf16_f32 v66, v8, v9
    v_cvt_pk_bf16_f32 v67, v10, v11
    v_mul_f32 v12, v40, v12
    v_mul_f32 v13, v41, v13
    v_mul_f32 v14, v42, v14
    v_mul_f32 v15, v43, v15
    v_mul_f32 v16, v44, v16
    v_mul_f32 v17, v45, v17
    v_mul_f32 v18, v46, v18
    v_mul_f32 v19, v47, v19
    v_cvt_pk_bf16_f32 v68, v12, v13
    v_cvt_pk_bf16_f32 v69, v14, v15
    v_cvt_pk_bf16_f32 v70, v16, v17
    v_cvt_pk_bf16_f32 v71, v18, v19
    ds_read_b64_tr_b16 v[0:1], v249 offset:1024
    ds_read_b64_tr_b16 v[2:3], v249 offset:1152
    ds_read_b128 v[4:7], v250 offset:128
    ds_read_b128 v[8:11], v250 offset:144
    ds_read_b128 v[12:15], v250 offset:512
    ds_read_b128 v[16:19], v250 offset:528
    s_waitcnt lgkmcnt(6)
    v_lshlrev_b32 v48, 16, v20
    v_and_b32 v49, 0xffff0000, v20
    v_lshlrev_b32 v50, 16, v21
    v_and_b32 v51, 0xffff0000, v21
    v_lshlrev_b32 v52, 16, v22
    v_and_b32 v53, 0xffff0000, v22
    v_lshlrev_b32 v54, 16, v23
    v_and_b32 v55, 0xffff0000, v23
    v_mul_f32 v24, v48, v24
    v_mul_f32 v25, v49, v25
    v_mul_f32 v26, v50, v26
    v_mul_f32 v27, v51, v27
    v_mul_f32 v28, v52, v28
    v_mul_f32 v29, v53, v29
    v_mul_f32 v30, v54, v30
    v_mul_f32 v31, v55, v31
    v_cvt_pk_bf16_f32 v72, v24, v25
    v_cvt_pk_bf16_f32 v73, v26, v27
    v_cvt_pk_bf16_f32 v74, v28, v29
    v_cvt_pk_bf16_f32 v75, v30, v31
    v_mul_f32 v32, v48, v32
    v_mul_f32 v33, v49, v33
    v_mul_f32 v34, v50, v34
    v_mul_f32 v35, v51, v35
    v_mul_f32 v36, v52, v36
    v_mul_f32 v37, v53, v37
    v_mul_f32 v38, v54, v38
    v_mul_f32 v39, v55, v39
    v_cvt_pk_bf16_f32 v76, v32, v33
    v_cvt_pk_bf16_f32 v77, v34, v35
    v_cvt_pk_bf16_f32 v78, v36, v37
    v_cvt_pk_bf16_f32 v79, v38, v39
    s_waitcnt lgkmcnt(4)
    v_lshlrev_b32 v40, 16, v0
    v_and_b32 v41, 0xffff0000, v0
    v_lshlrev_b32 v42, 16, v1
    v_and_b32 v43, 0xffff0000, v1
    v_lshlrev_b32 v44, 16, v2
    v_and_b32 v45, 0xffff0000, v2
    v_lshlrev_b32 v46, 16, v3
    v_and_b32 v47, 0xffff0000, v3
    s_waitcnt lgkmcnt(2)
    v_mul_f32 v4, v40, v4
    v_mul_f32 v5, v41, v5
    v_mul_f32 v6, v42, v6
    v_mul_f32 v7, v43, v7
    v_mul_f32 v8, v44, v8
    v_mul_f32 v9, v45, v9
    v_mul_f32 v10, v46, v10
    v_mul_f32 v11, v47, v11
    v_cvt_pk_bf16_f32 v80, v4, v5
    v_cvt_pk_bf16_f32 v81, v6, v7
    v_cvt_pk_bf16_f32 v82, v8, v9
    v_cvt_pk_bf16_f32 v83, v10, v11
    s_waitcnt lgkmcnt(0)
    v_mul_f32 v12, v40, v12
    v_mul_f32 v13, v41, v13
    v_mul_f32 v14, v42, v14
    v_mul_f32 v15, v43, v15
    v_mul_f32 v16, v44, v16
    v_mul_f32 v17, v45, v17
    v_mul_f32 v18, v46, v18
    v_mul_f32 v19, v47, v19
    v_cvt_pk_bf16_f32 v84, v12, v13
    v_cvt_pk_bf16_f32 v85, v14, v15
    v_cvt_pk_bf16_f32 v86, v16, v17
    v_cvt_pk_bf16_f32 v87, v18, v19
    s_waitcnt vmcnt(4)
    v_mfma_f32_32x32x16_bf16 v[0:15], v[64:67], v[176:179], 0
    ds_read_b64_tr_b16 v[184:185], v246 offset:2048
    ds_read_b64_tr_b16 v[186:187], v246 offset:2560
    ds_read_b64_tr_b16 v[188:189], v247 offset:2048
    ds_read_b64_tr_b16 v[190:191], v247 offset:2560
    s_mov_b32 m0, s68
    v_mfma_f32_32x32x16_bf16 v[16:31], v[68:71], v[176:179], 0
    buffer_load_dwordx4 v224, s[4:7], s41 offen sc1 lds
    buffer_load_dwordx4 v225, s[72:75], s41 offen offset:1024 sc1 lds
    v_permlane32_swap_b32 v242, v236
    v_permlane32_swap_b32 v243, v237
    v_mov_b32 v254, 163648
    v_mfma_f32_32x32x16_bf16 v[32:47], v[64:67], v[180:183], 0
    v_permlane32_swap_b32 v244, v238
    v_permlane32_swap_b32 v245, v239
    v_permlane32_swap_b32 v240, v241
    v_add_f32 v242, v242, v236
    v_mfma_f32_32x32x16_bf16 v[48:63], v[68:71], v[180:183], 0
    v_add_f32 v243, v243, v237
    v_add_f32 v244, v244, v238
    v_add_f32 v245, v245, v239
    v_add_f32 v240, -v240, -v241
    v_sub_u32 v241, v230, v231
    v_cvt_pk_bf16_f32 v242, v242, v243
    v_mov_b32 v255, 1
    v_lshl_add_u32 v233, v252, 1, s53
    s_mov_b64 exec, 1
    ds_add_rtn_u32 v232, v254, v255
    s_mov_b64 exec, -1
    ds_read_b32 v233, v233
    s_waitcnt vmcnt(4) lgkmcnt(2)
    v_mfma_f32_32x32x16_bf16 v[0:15], v[72:75], v[184:187], v[0:15]
    ds_read_b64_tr_b16 v[176:177], v246 offset:4096
    ds_read_b64_tr_b16 v[178:179], v246 offset:4608
    ds_read_b64_tr_b16 v[180:181], v247 offset:4096
    ds_read_b64_tr_b16 v[182:183], v247 offset:4608
    v_cvt_pk_bf16_f32 v244, v244, v245
    v_cvt_pk_bf16_f32 v240, v240, v240
    s_mov_b32 m0, s69
    v_mfma_f32_32x32x16_bf16 v[16:31], v[76:79], v[184:187], v[16:31]
    buffer_load_dwordx4 v226, s[4:7], s41 offen sc1 lds
    buffer_load_dwordx4 v227, s[72:75], s41 offen offset:1024 sc1 lds
    ds_write_b32 v230, v242 offset:768
    ds_write_b32 v230, v244 offset:1024
    ds_write_b16 v241, v240 offset:1280
    s_waitcnt lgkmcnt(7)
    v_readfirstlane_b32 s58, v232
    v_mfma_f32_32x32x16_bf16 v[32:47], v[72:75], v[188:191], v[32:47]
    s_cmp_lt_u32 s58, s22
    s_cbranch_scc0 K2_nul_53
    s_and_b32 s59, s58, 7
    s_lshr_b32 s60, s58, 3
K2_chk_55:
    v_readlane_b32 s61, v233, s59
    s_nop 0
    s_cmp_gt_u32 s61, s60
    s_cbranch_scc0 K2_spin_54
K2_back_56:
    v_mfma_f32_32x32x16_bf16 v[48:63], v[76:79], v[188:191], v[48:63]
    v_readlane_b32 s3, v253, s58
    s_lshl_b32 s44, s34, 7
    s_lshl_b32 s60, s58, 5
    s_and_b32 s48, s3, 0x3ffff
    s_bfe_u32 s33, s3, 0x30012
    s_sub_u32 s60, s60, s48
    s_waitcnt vmcnt(4) lgkmcnt(3)
    v_mfma_f32_32x32x16_bf16 v[0:15], v[80:83], v[176:179], v[0:15]
    ds_read_b64_tr_b16 v[184:185], v246 offset:6144
    ds_read_b64_tr_b16 v[186:187], v246 offset:6656
    ds_read_b64_tr_b16 v[188:189], v247 offset:6144
    ds_read_b64_tr_b16 v[190:191], v247 offset:6656
    s_and_b32 s60, s60, 0xff
    s_add_u32 s35, s60, s48
    s_mov_b32 m0, s70
    v_mfma_f32_32x32x16_bf16 v[16:31], v[84:87], v[176:179], v[16:31]
    buffer_load_dwordx4 v222, s[4:7], s42 offen sc1 lds
    buffer_load_dwordx4 v223, s[72:75], s42 offen offset:1024 sc1 lds
    s_mov_b32 s45, s44
    s_add_u32 s47, s44, 256
    s_add_u32 s49, s48, 32
    s_add_u32 s60, s48, 64
    v_mfma_f32_32x32x16_bf16 v[32:47], v[80:83], v[180:183], v[32:47]
    s_cmp_eq_u32 s33, 3
    s_cselect_b32 s46, s44, s47
    s_cselect_b32 s50, s60, s48
    s_cselect_b32 s51, s48, s49
    s_sub_u32 s60, s33, 2
    s_cmp_lt_u32 s60, 2
    s_cbranch_scc0 K2_rare_57
K2_back_58:
    v_mfma_f32_32x32x16_bf16 v[48:63], v[84:87], v[180:183], v[48:63]
    s_setprio 0
    v_mul_f32 v234, v0, v96
    v_mul_f32 v236, v8, v128
    v_fmac_f32 v234, v1, v97
    v_fmac_f32 v236, v9, v129
    v_fmac_f32 v234, v2, v98
    v_fmac_f32 v236, v10, v130
    v_fmac_f32 v234, v3, v99
    v_fmac_f32 v236, v11, v131
    v_fmac_f32 v234, v4, v100
    v_fmac_f32 v236, v12, v132
    v_fmac_f32 v234, v5, v101
    v_fmac_f32 v236, v13, v133
    v_fmac_f32 v234, v6, v102
    v_fmac_f32 v236, v14, v134
    v_fmac_f32 v234, v7, v103
    v_fmac_f32 v236, v15, v135
    v_mul_f32 v238, v16, v128
    v_mul_f32 v240, v24, v128
    v_fmac_f32 v238, v17, v129
    v_fmac_f32 v240, v25, v129
    v_fmac_f32 v238, v18, v130
    v_fmac_f32 v240, v26, v130
    v_fmac_f32 v238, v19, v131
    v_fmac_f32 v240, v27, v131
    v_fmac_f32 v238, v20, v132
    v_fmac_f32 v240, v28, v132
    v_fmac_f32 v238, v21, v133
    v_fmac_f32 v240, v29, v133
    v_fmac_f32 v238, v22, v134
    v_fmac_f32 v240, v30, v134
    v_fmac_f32 v238, v23, v135
    v_fmac_f32 v240, v31, v135
    v_mul_f32 v235, v32, v104
    v_mul_f32 v237, v40, v136
    v_fmac_f32 v235, v33, v105
    v_fmac_f32 v237, v41, v137
    v_fmac_f32 v235, v34, v106
    v_fmac_f32 v237, v42, v138
    v_fmac_f32 v235, v35, v107
    v_fmac_f32 v237, v43, v139
    v_fmac_f32 v235, v36, v108
    v_fmac_f32 v237, v44, v140
    v_fmac_f32 v235, v37, v109
    v_fmac_f32 v237, v45, v141
    v_fmac_f32 v235, v38, v110
    v_fmac_f32 v237, v46, v142
    v_fmac_f32 v235, v39, v111
    v_fmac_f32 v237, v47, v143
    v_mul_f32 v239, v48, v136
    v_mul_f32 v241, v56, v136
    s_setprio 1
    s_waitcnt vmcnt(4) lgkmcnt(0)
    v_mfma_f32_32x32x16_bf16 v[0:15], v[64:67], v[184:187], 0
    ds_read_b64_tr_b16 v[176:177], v246 offset:0
    ds_read_b64_tr_b16 v[178:179], v246 offset:512
    ds_read_b64_tr_b16 v[180:181], v247 offset:0
    ds_read_b64_tr_b16 v[182:183], v247 offset:512
    v_fmac_f32 v239, v49, v137
    v_fmac_f32 v241, v57, v137
    s_mov_b32 m0, s71
    v_mfma_f32_32x32x16_bf16 v[16:31], v[68:71], v[184:187], 0
    buffer_load_dwordx4 v224, s[4:7], s42 offen sc1 lds
    buffer_load_dwordx4 v225, s[72:75], s42 offen offset:1024 sc1 lds
    v_fmac_f32 v239, v50, v138
    v_fmac_f32 v241, v58, v138
    v_fmac_f32 v239, v51, v139
    v_fmac_f32 v241, v59, v139
    v_fmac_f32 v239, v52, v140
    v_mfma_f32_32x32x16_bf16 v[32:47], v[64:67], v[188:191], 0
    v_fmac_f32 v241, v60, v140
    v_fmac_f32 v239, v53, v141
    v_fmac_f32 v241, v61, v141
    v_fmac_f32 v239, v54, v142
    v_fmac_f32 v241, v62, v142
    v_fmac_f32 v239, v55, v143
    v_fmac_f32 v241, v63, v143
    v_mfma_f32_32x32x16_bf16 v[48:63], v[68:71], v[188:191], 0
    v_permlane32_swap_b32 v234, v236
    v_permlane32_swap_b32 v235, v237
    v_permlane32_swap_b32 v240, v238
    s_waitcnt vmcnt(4) lgkmcnt(0)
    v_mfma_f32_32x32x16_bf16 v[0:15], v[72:75], v[176:179], v[0:15]
    ds_read_b64_tr_b16 v[184:185], v246 offset:2048
    ds_read_b64_tr_b16 v[186:187], v246 offset:2560
    ds_read_b64_tr_b16 v[188:189], v247 offset:2048
    ds_read_b64_tr_b16 v[190:191], v247 offset:2560
    v_permlane32_swap_b32 v241, v239
    s_mov_b32 m0, s68
    v_mfma_f32_32x32x16_bf16 v[16:31], v[76:79], v[176:179], v[16:31]
    buffer_load_dwordx4 v226, s[4:7], s42 offen sc1 lds
    buffer_load_dwordx4 v227, s[72:75], s42 offen offset:1024 sc1 lds
    v_lshl_add_u32 v230, v252, 1, s31
    v_add_f32 v234, v234, v236
    v_add_f32 v235, v235, v237
    v_add_f32 v240, v240, v238
    v_add_f32 v241, v241, v239
    v_mfma_f32_32x32x16_bf16 v[32:47], v[72:75], v[180:183], v[32:47]
    v_cvt_pk_bf16_f32 v234, v234, v235
    v_cvt_pk_bf16_f32 v240, v240, v241
    ds_write_b32 v230, v234 offset:0
    ds_write_b32 v230, v240 offset:256
    v_mfma_f32_32x32x16_bf16 v[48:63], v[76:79], v[180:183], v[48:63]
    s_waitcnt vmcnt(4) lgkmcnt(2)
    v_mfma_f32_32x32x16_bf16 v[0:15], v[80:83], v[184:187], v[0:15]
    ds_read_b64_tr_b16 v[176:177], v246 offset:4096
    ds_read_b64_tr_b16 v[178:179], v246 offset:4608
    ds_read_b64_tr_b16 v[180:181], v247 offset:4096
    ds_read_b64_tr_b16 v[182:183], v247 offset:4608
    s_mov_b32 m0, s69
    v_mfma_f32_32x32x16_bf16 v[16:31], v[84:87], v[184:187], v[16:31]
    buffer_load_dwordx4 v222, s[4:7], s43 offen sc1 lds
    buffer_load_dwordx4 v223, s[72:75], s43 offen offset:1024 sc1 lds
    v_mfma_f32_32x32x16_bf16 v[32:47], v[80:83], v[188:191], v[32:47]
    s_nop 2
    v_mul_f32 v234, v0, v144
    v_mul_f32 v236, v8, v112
    v_fmac_f32 v234, v1, v145
    v_fmac_f32 v236, v9, v113
    v_fmac_f32 v234, v2, v146
    v_fmac_f32 v236, v10, v114
    v_fmac_f32 v234, v3, v147
    v_mfma_f32_32x32x16_bf16 v[48:63], v[84:87], v[188:191], v[48:63]
    s_setprio 0
    v_fmac_f32 v236, v11, v115
    v_fmac_f32 v234, v4, v148
    v_fmac_f32 v236, v12, v116
    v_fmac_f32 v234, v5, v149
    v_fmac_f32 v236, v13, v117
    v_fmac_f32 v234, v6, v150
    v_fmac_f32 v236, v14, v118
    v_fmac_f32 v234, v7, v151
    v_fmac_f32 v236, v15, v119
    v_mul_f32 v238, v16, v160
    v_mul_f32 v240, v24, v160
    v_fmac_f32 v238, v17, v161
    v_fmac_f32 v240, v25, v161
    v_fmac_f32 v238, v18, v162
    v_fmac_f32 v240, v26, v162
    v_fmac_f32 v238, v19, v163
    v_fmac_f32 v240, v27, v163
    v_fmac_f32 v238, v20, v164
    v_fmac_f32 v240, v28, v164
    v_fmac_f32 v238, v21, v165
    v_fmac_f32 v240, v29, v165
    v_fmac_f32 v238, v22, v166
    v_fmac_f32 v240, v30, v166
    v_fmac_f32 v238, v23, v167
    v_fmac_f32 v240, v31, v167
    v_mul_f32 v235, v32, v152
    v_mul_f32 v237, v40, v120
    v_fmac_f32 v235, v33, v153
    v_fmac_f32 v237, v41, v121
    v_fmac_f32 v235, v34, v154
    v_fmac_f32 v237, v42, v122
    v_fmac_f32 v235, v35, v155
    v_fmac_f32 v237, v43, v123
    v_fmac_f32 v235, v36, v156
    v_fmac_f32 v237, v44, v124
    v_fmac_f32 v235, v37, v157
    v_fmac_f32 v237, v45, v125
    v_fmac_f32 v235, v38, v158
    v_fmac_f32 v237, v46, v126
    v_fmac_f32 v235, v39, v159
    v_fmac_f32 v237, v47, v127
    v_mul_f32 v239, v48, v168
    v_mul_f32 v241, v56, v168
    v_fmac_f32 v239, v49, v169
    v_fmac_f32 v241, v57, v169
    s_setprio 1
    s_waitcnt vmcnt(4) lgkmcnt(0)
    v_mfma_f32_32x32x16_bf16 v[0:15], v[64:67], v[176:179], 0
    ds_read_b64_tr_b16 v[184:185], v246 offset:6144
    ds_read_b64_tr_b16 v[186:187], v246 offset:6656
    ds_read_b64_tr_b16 v[188:189], v247 offset:6144
    ds_read_b64_tr_b16 v[190:191], v247 offset:6656
    v_fmac_f32 v239, v50, v170
    v_fmac_f32 v241, v58, v170
    s_mov_b32 m0, s70
    v_mfma_f32_32x32x16_bf16 v[16:31], v[68:71], v[176:179], 0
    buffer_load_dwordx4 v224, s[4:7], s43 offen sc1 lds
    buffer_load_dwordx4 v225, s[72:75], s43 offen offset:1024 sc1 lds
    v_fmac_f32 v239, v51, v171
    v_fmac_f32 v241, v59, v171
    v_fmac_f32 v239, v52, v172
    v_fmac_f32 v241, v60, v172
    v_fmac_f32 v239, v53, v173
    v_mfma_f32_32x32x16_bf16 v[32:47], v[64:67], v[180:183], 0
    v_add_u32 v222, s48, v251
    ds_read_b32 v222, v222
    v_fmac_f32 v241, v61, v173
    v_fmac_f32 v239, v54, v174
    v_fmac_f32 v241, v62, v174
    v_fmac_f32 v239, v55, v175
    v_fmac_f32 v241, v63, v175
    v_mfma_f32_32x32x16_bf16 v[48:63], v[68:71], v[180:183], 0
    s_waitcnt vmcnt(4) lgkmcnt(1)
    v_mfma_f32_32x32x16_bf16 v[0:15], v[72:75], v[184:187], v[0:15]
    ds_read_b64_tr_b16 v[176:177], v246 offset:0
    ds_read_b64_tr_b16 v[178:179], v246 offset:512
    ds_read_b64_tr_b16 v[180:181], v247 offset:0
    ds_read_b64_tr_b16 v[182:183], v247 offset:512
    s_mov_b32 m0, s71
    v_mfma_f32_32x32x16_bf16 v[16:31], v[76:79], v[184:187], v[16:31]
    buffer_load_dwordx4 v226, s[4:7], s43 offen sc1 lds
    buffer_load_dwordx4 v227, s[72:75], s43 offen offset:1024 sc1 lds
    s_waitcnt lgkmcnt(4)
    v_mad_u32_u16 v223, v222, s39, v248 op_sel:[1,0,0,0]
    v_mad_u32_u16 v222, v222, s39, v248
    v_mfma_f32_32x32x16_bf16 v[32:47], v[72:75], v[188:191], v[32:47]
    v_add_u32 v224, s49, v251
    ds_read_b32 v224, v224
    v_mfma_f32_32x32x16_bf16 v[48:63], v[76:79], v[188:191], v[48:63]
    s_waitcnt vmcnt(4) lgkmcnt(1)
    v_mfma_f32_32x32x16_bf16 v[0:15], v[80:83], v[176:179], v[0:15]
    ds_read_b64_tr_b16 v[184:185], v246 offset:2048
    ds_read_b64_tr_b16 v[186:187], v246 offset:2560
    ds_read_b64_tr_b16 v[188:189], v247 offset:2048
    ds_read_b64_tr_b16 v[190:191], v247 offset:2560
    s_mov_b32 m0, s68
    v_mfma_f32_32x32x16_bf16 v[16:31], v[84:87], v[176:179], v[16:31]
    buffer_load_dwordx4 v222, s[4:7], s44 offen sc1 lds
    buffer_load_dwordx4 v223, s[72:75], s44 offen offset:1024 sc1 lds
    s_waitcnt lgkmcnt(4)
    v_mad_u32_u16 v225, v224, s39, v248 op_sel:[1,0,0,0]
    v_mad_u32_u16 v224, v224, s39, v248
    v_mfma_f32_32x32x16_bf16 v[32:47], v[80:83], v[180:183], v[32:47]
    v_add_u32 v226, s50, v251
    ds_read_b32 v226, v226
    v_mul_f32 v242, v0, v144
    v_fma_f32 v238, v8, v160, -v238
    v_fmac_f32 v242, v1, v145
    v_fmac_f32 v238, v9, v161
    v_fmac_f32 v242, v2, v146
    v_mfma_f32_32x32x16_bf16 v[48:63], v[84:87], v[180:183], v[48:63]
    s_setprio 0
    v_fmac_f32 v238, v10, v162
    v_fmac_f32 v242, v3, v147
    v_fmac_f32 v238, v11, v163
    v_fmac_f32 v242, v4, v148
    v_fmac_f32 v238, v12, v164
    v_fmac_f32 v242, v5, v149
    v_fmac_f32 v238, v13, v165
    v_fmac_f32 v242, v6, v150
    v_fmac_f32 v238, v14, v166
    v_fmac_f32 v242, v7, v151
    v_fmac_f32 v238, v15, v167
    v_fmac_f32 v236, v16, v112
    v_mul_f32 v244, v24, v160
    v_fmac_f32 v236, v17, v113
    v_fmac_f32 v244, v25, v161
    v_fmac_f32 v236, v18, v114
    v_fmac_f32 v244, v26, v162
    v_fmac_f32 v236, v19, v115
    v_fmac_f32 v244, v27, v163
    v_fmac_f32 v236, v20, v116
    v_fmac_f32 v244, v28, v164
    v_fmac_f32 v236, v21, v117
    v_fmac_f32 v244, v29, v165
    v_fmac_f32 v236, v22, v118
    v_fmac_f32 v244, v30, v166
    v_fmac_f32 v236, v23, v119
    v_fmac_f32 v244, v31, v167
    v_mul_f32 v243, v32, v152
    v_fma_f32 v239, v40, v168, -v239
    v_fmac_f32 v243, v33, v153
    v_fmac_f32 v239, v41, v169
    v_fmac_f32 v243, v34, v154
    v_fmac_f32 v239, v42, v170
    v_fmac_f32 v243, v35, v155
    v_fmac_f32 v239, v43, v171
    v_fmac_f32 v243, v36, v156
    v_fmac_f32 v239, v44, v172
    v_fmac_f32 v243, v37, v157
    v_fmac_f32 v239, v45, v173
    v_fmac_f32 v243, v38, v158
    v_fmac_f32 v239, v46, v174
    v_fmac_f32 v243, v39, v159
    v_fmac_f32 v239, v47, v175
    v_fmac_f32 v237, v48, v120
    v_mul_f32 v245, v56, v168
    v_fmac_f32 v237, v49, v121
    v_fmac_f32 v245, v57, v169
    v_fmac_f32 v237, v50, v122
    v_fmac_f32 v245, v58, v170
    v_fmac_f32 v237, v51, v123
    s_setprio 1
    s_waitcnt vmcnt(4) lgkmcnt(1)
    v_mfma_f32_32x32x16_bf16 v[0:15], v[64:67], v[184:187], 0
    ds_read_b64_tr_b16 v[176:177], v246 offset:4096
    ds_read_b64_tr_b16 v[178:179], v246 offset:4608
    ds_read_b64_tr_b16 v[180:181], v247 offset:4096
    ds_read_b64_tr_b16 v[182:183], v247 offset:4608
    v_fmac_f32 v245, v59, v171
    v_fmac_f32 v237, v52, v124
    s_mov_b32 m0, s69
    v_mfma_f32_32x32x16_bf16 v[16:31], v[68:71], v[184:187], 0
    buffer_load_dwordx4 v224, s[4:7], s45 offen sc1 lds
    buffer_load_dwordx4 v225, s[72:75], s45 offen offset:1024 sc1 lds
    s_waitcnt lgkmcnt(4)
    v_mad_u32_u16 v227, v226, s39, v248 op_sel:[1,0,0,0]
    v_mad_u32_u16 v226, v226, s39, v248
    v_fmac_f32 v245, v60, v172
    v_fmac_f32 v237, v53, v125
    v_mfma_f32_32x32x16_bf16 v[32:47], v[64:67], v[188:191], 0
    v_add_u32 v228, s51, v251
    ds_read_b32 v228, v228
    v_fmac_f32 v245, v61, v173
    v_fmac_f32 v237, v54, v126
    v_fmac_f32 v245, v62, v174
    v_fmac_f32 v237, v55, v127
    v_fmac_f32 v245, v63, v175
    v_mfma_f32_32x32x16_bf16 v[48:63], v[68:71], v[188:191], 0
    v_permlane32_swap_b32 v242, v234
    v_permlane32_swap_b32 v243, v235
    v_add_f32 v242, v242, v234
    v_add_f32 v243, v243, v235
    s_waitcnt vmcnt(4) lgkmcnt(1)
    v_mfma_f32_32x32x16_bf16 v[0:15], v[72:75], v[176:179], v[0:15]
    ds_read_b64_tr_b16 v[184:185], v246 offset:6144
    ds_read_b64_tr_b16 v[186:187], v246 offset:6656
    ds_read_b64_tr_b16 v[188:189], v247 offset:6144
    ds_read_b64_tr_b16 v[190:191], v247 offset:6656
    v_cvt_pk_bf16_f32 v242, v242, v243
    ds_write_b32 v230, v242 offset:512
    s_mov_b32 m0, s70
    v_mfma_f32_32x32x16_bf16 v[16:31], v[76:79], v[176:179], v[16:31]
    buffer_load_dwordx4 v226, s[4:7], s46 offen sc1 lds
    buffer_load_dwordx4 v227, s[72:75], s46 offen offset:1024 sc1 lds
    s_waitcnt lgkmcnt(5)
    v_mad_u32_u16 v229, v228, s39, v248 op_sel:[1,0,0,0]
    v_mad_u32_u16 v228, v228, s39, v248
    s_sub_u32 s26, s48, s29
    s_mov_b32 s29, s48
    v_mfma_f32_32x32x16_bf16 v[32:47], v[72:75], v[180:183], v[32:47]
    s_mov_b32 s30, s3
    s_cmp_lg_u32 s36, 0
    s_cselect_b32 s56, s33, 0
    s_mov_b32 s32, s31
    s_mov_b32 s31, s35
    v_mfma_f32_32x32x16_bf16 v[48:63], v[76:79], v[180:183], v[48:63]
    s_waitcnt vmcnt(4) lgkmcnt(1)
    v_mfma_f32_32x32x16_bf16 v[0:15], v[80:83], v[184:187], v[0:15]
    ds_read_b64_tr_b16 v[176:177], v246 offset:0
    ds_read_b64_tr_b16 v[178:179], v246 offset:512
    ds_read_b64_tr_b16 v[180:181], v247 offset:0
    ds_read_b64_tr_b16 v[182:183], v247 offset:512
    s_mov_b32 m0, s71
    v_mfma_f32_32x32x16_bf16 v[16:31], v[84:87], v[184:187], v[16:31]
    buffer_load_dwordx4 v228, s[4:7], s47 offen sc1 lds
    buffer_load_dwordx4 v229, s[72:75], s47 offen offset:1024 sc1 lds
    v_mfma_f32_32x32x16_bf16 v[32:47], v[80:83], v[188:191], v[32:47]
    s_nop 2
    v_mul_f32 v242, v0, v144
    v_fma_f32 v240, v8, v160, -v240
    v_fmac_f32 v242, v1, v145
    v_fmac_f32 v240, v9, v161
    v_fmac_f32 v242, v2, v146
    v_fmac_f32 v240, v10, v162
    v_fmac_f32 v242, v3, v147
    v_mfma_f32_32x32x16_bf16 v[48:63], v[84:87], v[188:191], v[48:63]
    s_setprio 0
    v_fmac_f32 v240, v11, v163
    v_fmac_f32 v242, v4, v148
    v_fmac_f32 v240, v12, v164
    v_fmac_f32 v242, v5, v149
    v_fmac_f32 v240, v13, v165
    v_fmac_f32 v242, v6, v150
    v_fmac_f32 v240, v14, v166
    v_fmac_f32 v242, v7, v151
    v_fmac_f32 v240, v15, v167
    v_add_u32 v249, s26, v249
    v_add_u32 v250, s26, v250
    v_fma_f32 v244, v16, v160, -v244
    v_fmac_f32 v236, v24, v112
    v_fmac_f32 v244, v17, v161
    v_fmac_f32 v236, v25, v113
    v_fmac_f32 v244, v18, v162
    v_fmac_f32 v236, v26, v114
    v_fmac_f32 v244, v19, v163
    v_fmac_f32 v236, v27, v115
    v_fmac_f32 v244, v20, v164
    v_fmac_f32 v236, v28, v116
    v_fmac_f32 v244, v21, v165
    v_fmac_f32 v236, v29, v117
    v_fmac_f32 v244, v22, v166
    v_fmac_f32 v236, v30, v118
    v_fmac_f32 v244, v23, v167
    v_fmac_f32 v236, v31, v119
    ds_read_b64_tr_b16 v[0:1], v249 offset:0
    ds_read_b64_tr_b16 v[2:3], v249 offset:128
    ds_read_b128 v[4:7], v250 offset:0
    ds_read_b128 v[8:11], v250 offset:16
    ds_read_b128 v[12:15], v250 offset:384
    ds_read_b128 v[16:19], v250 offset:400
    v_mul_f32 v243, v32, v152
    v_fma_f32 v241, v40, v168, -v241
    v_fmac_f32 v243, v33, v153
    v_fmac_f32 v241, v41, v169
    v_fmac_f32 v243, v34, v154
    v_fmac_f32 v241, v42, v170
    v_fmac_f32 v243, v35, v155
    v_fmac_f32 v241, v43, v171
    v_fmac_f32 v243, v36, v156
    v_fmac_f32 v241, v44, v172
    v_fmac_f32 v243, v37, v157
    v_fmac_f32 v241, v45, v173
    v_fmac_f32 v243, v38, v158
    v_fmac_f32 v241, v46, v174
    v_fmac_f32 v243, v39, v159
    v_fmac_f32 v241, v47, v175
    ds_read_b64_tr_b16 v[20:21], v249 offset:512
    ds_read_b64_tr_b16 v[22:23], v249 offset:640
    ds_read_b128 v[24:27], v250 offset:64
    ds_read_b128 v[28:31], v250 offset:80
    ds_read_b128 v[32:35], v250 offset:448
    ds_read_b128 v[36:39], v250 offset:464
    v_fma_f32 v245, v48, v168, -v245
    v_fmac_f32 v237, v56, v120
    v_fmac_f32 v245, v49, v169
    v_fmac_f32 v237, v57, v121
    v_fmac_f32 v245, v50, v170
    v_fmac_f32 v237, v58, v122
    v_fmac_f32 v245, v51, v171
    v_fmac_f32 v237, v59, v123
    v_fmac_f32 v245, v52, v172
    v_fmac_f32 v237, v60, v124
    v_fmac_f32 v245, v53, v173
    v_fmac_f32 v237, v61, v125
    v_fmac_f32 v245, v54, v174
    v_fmac_f32 v237, v62, v126
    v_fmac_f32 v245, v55, v175
    v_fmac_f32 v237, v63, v127
    s_cmp_eq_u32 s56, 2
    s_cbranch_scc1 K2_U21
    s_cmp_eq_u32 s56, 3
    s_cbranch_scc1 K2_U31
    s_branch K2_DSP1
K2_PAD_SW:
    s_branch K2_HOP
K2_DSP0:
    s_cmp_eq_u32 s56, 1
    s_cbranch_scc1 K2_U10
    s_cmp_eq_u32 s56, 4
    s_cbranch_scc1 K2_U40
    s_branch K2_SWITCH
K2_DSP1:
    s_cmp_eq_u32 s56, 1
    s_cbranch_scc1 K2_U11
    s_cmp_eq_u32 s56, 4
    s_cbranch_scc1 K2_U41
    s_branch K2_TAIL
K2_SWITCH:
    v_permlane32_swap_b32 v242, v236
    v_permlane32_swap_b32 v243, v237
    v_permlane32_swap_b32 v244, v238
    v_permlane32_swap_b32 v245, v239
    v_permlane32_swap_b32 v240, v241
    v_add_f32 v242, v242, v236
    v_add_f32 v243, v243, v237
    v_add_f32 v244, v244, v238
    v_add_f32 v245, v245, v239
    v_add_f32 v240, -v240, -v241
    s_set_gpr_idx_on s32, gpr_idx(DST)
    s_nop 0
    v_cvt_pk_bf16_f32 v195, v242, v243
    v_cvt_pk_bf16_f32 v196, v244, v245
    v_cvt_pk_bf16_f32 v197, v240, v240
    s_set_gpr_idx_off
    s_cmp_eq_u32 s36, 0
    s_cbranch_scc1 K2_TAIL2
    v_lshlrev_b32 v254, 3, v252
    v_lshl_add_u32 v230, v252, 1, s35
    v_lshrrev_b32 v231, 6, v252
    v_mul_u32_u24 v231, 126, v231
    s_mov_b32 s58, 7127040
    buffer_load_dwordx4 v[152:155], v254, s[8:11], s58 offen offset:0 sc1
    buffer_load_dwordx4 v[156:159], v254, s[8:11], s58 offen offset:1024 sc1
    s_mov_b32 s58, 7122944
    buffer_load_dwordx4 v[120:123], v254, s[8:11], s58 offen offset:0 sc1
    buffer_load_dwordx4 v[124:127], v254, s[8:11], s58 offen offset:1024 sc1
    s_mov_b32 s58, 7129088
    buffer_load_dwordx4 v[168:171], v254, s[8:11], s58 offen offset:0 sc1
    buffer_load_dwordx4 v[172:175], v254, s[8:11], s58 offen offset:1024 sc1
    s_movk_i32 s40, 128
    s_movk_i32 s41, 384
    s_movk_i32 s42, 640
    s_movk_i32 s43, 896
    v_lshlrev_b32 v96, 16, v104
    v_and_b32 v97, 0xffff0000, v104
    v_lshlrev_b32 v98, 16, v105
    v_and_b32 v99, 0xffff0000, v105
    v_lshlrev_b32 v100, 16, v106
    v_and_b32 v101, 0xffff0000, v106
    v_lshlrev_b32 v102, 16, v107
    v_and_b32 v103, 0xffff0000, v107
    v_lshlrev_b32 v104, 16, v108
    v_and_b32 v105, 0xffff0000, v108
    v_lshlrev_b32 v106, 16, v109
    v_and_b32 v107, 0xffff0000, v109
    v_lshlrev_b32 v108, 16, v110
    v_and_b32 v109, 0xffff0000, v110
    v_lshlrev_b32 v110, 16, v111
    v_and_b32 v111, 0xffff0000, v111
    v_lshlrev_b32 v128, 16, v136
    v_and_b32 v129, 0xffff0000, v136
    v_lshlrev_b32 v130, 16, v137
    v_and_b32 v131, 0xffff0000, v137
    v_lshlrev_b32 v132, 16, v138
    v_and_b32 v133, 0xffff0000, v138
    v_lshlrev_b32 v134, 16, v139
    v_and_b32 v135, 0xffff0000, v139
    v_lshlrev_b32 v136, 16, v140
    v_and_b32 v137, 0xffff0000, v140
    v_lshlrev_b32 v138, 16, v141
    v_and_b32 v139, 0xffff0000, v141
    v_lshlrev_b32 v140, 16, v142
    v_and_b32 v141, 0xffff0000, v142
    v_lshlrev_b32 v142, 16, v143
    v_and_b32 v143, 0xffff0000, v143
    s_waitcnt vmcnt(0)
    v_lshlrev_b32 v144, 16, v152
    v_and_b32 v145, 0xffff0000, v152
    v_lshlrev_b32 v146, 16, v153
    v_and_b32 v147, 0xffff0000, v153
    v_lshlrev_b32 v148, 16, v154
    v_and_b32 v149, 0xffff0000, v154
    v_lshlrev_b32 v150, 16, v155
    v_and_b32 v151, 0xffff0000, v155
    v_lshlrev_b32 v152, 16, v156
    v_and_b32 v153, 0xffff0000, v156
    v_lshlrev_b32 v154, 16, v157
    v_and_b32 v155, 0xffff0000, v157
    v_lshlrev_b32 v156, 16, v158
    v_and_b32 v157, 0xffff0000, v158
    v_lshlrev_b32 v158, 16, v159
    v_and_b32 v159, 0xffff0000, v159
    v_lshlrev_b32 v112, 16, v120
    v_and_b32 v113, 0xffff0000, v120
    v_lshlrev_b32 v114, 16, v121
    v_and_b32 v115, 0xffff0000, v121
    v_lshlrev_b32 v116, 16, v122
    v_and_b32 v117, 0xffff0000, v122
    v_lshlrev_b32 v118, 16, v123
    v_and_b32 v119, 0xffff0000, v123
    v_lshlrev_b32 v120, 16, v124
    v_and_b32 v121, 0xffff0000, v124
    v_lshlrev_b32 v122, 16, v125
    v_and_b32 v123, 0xffff0000, v125
    v_lshlrev_b32 v124, 16, v126
    v_and_b32 v125, 0xffff0000, v126
    v_lshlrev_b32 v126, 16, v127
    v_and_b32 v127, 0xffff0000, v127
    v_lshlrev_b32 v160, 16, v168
    v_and_b32 v161, 0xffff0000, v168
    v_lshlrev_b32 v162, 16, v169
    v_and_b32 v163, 0xffff0000, v169
    v_lshlrev_b32 v164, 16, v170
    v_and_b32 v165, 0xffff0000, v170
    v_lshlrev_b32 v166, 16, v171
    v_and_b32 v167, 0xffff0000, v171
    v_lshlrev_b32 v168, 16, v172
    v_and_b32 v169, 0xffff0000, v172
    v_lshlrev_b32 v170, 16, v173
    v_and_b32 v171, 0xffff0000, v173
    v_lshlrev_b32 v172, 16, v174
    v_and_b32 v173, 0xffff0000, v174
    v_lshlrev_b32 v174, 16, v175
    v_and_b32 v175, 0xffff0000, v175
K2_SW2:
    s_mov_b32 s29, s48
    s_mov_b32 s32, s31
    s_mov_b32 s30, s3
    s_mov_b32 s31, s35
    s_cmp_eq_u32 s33, 2
    s_cbranch_scc1 K2_U21
    s_cmp_eq_u32 s33, 3
    s_cbranch_scc1 K2_U31
    s_cmp_eq_u32 s33, 1
    s_cbranch_scc1 K2_U11
    s_branch K2_U41
K2_dum_4:
    v_mov_b32 v232, -1
    s_mov_b32 m0, 163712
    s_mov_b64 exec, 1
    buffer_load_dwordx4 v232, s[16:19], 0 offen lds
    buffer_load_dwordx4 v232, s[16:19], 0 offen lds
    s_mov_b64 exec, -1
    s_branch K2_back_6
K2_nul_10:
    s_mov_b32 s58, 63
    s_mov_b32 s36, 0
    s_branch K2_back_13
K2_spin_11:
    s_sub_u32 s27, s27, 1
    s_cbranch_scc1 K2_END
    v_lshl_add_u32 v233, v252, 1, s53
    ds_read_b32 v233, v233
    s_waitcnt lgkmcnt(0)
    s_branch K2_chk_12
K2_dyn_8:
    v_mov_b32 v254, 163648
    v_mov_b32 v255, 1
    v_lshl_add_u32 v233, v252, 1, s53
    s_mov_b64 exec, 1
    ds_add_rtn_u32 v232, v254, v255
    s_mov_b64 exec, -1
    ds_read_b32 v233, v233
    s_waitcnt lgkmcnt(0)
    v_readfirstlane_b32 s58, v232
    s_nop 0
    s_cmp_lt_u32 s58, s22
    s_cbranch_scc0 K2_nul_10
    s_and_b32 s59, s58, 7
    s_lshr_b32 s60, s58, 3
K2_chk_12:
    v_readlane_b32 s61, v233, s59
    s_nop 0
    s_cmp_gt_u32 s61, s60
    s_cbranch_scc0 K2_spin_11
K2_back_13:
    s_mov_b32 s34, 1
    s_branch K2_back_9
K2_ew_17:
    v_lshlrev_b32 v254, 3, v252
    s_mov_b64 vcc, -1
    s_mov_b32 s58, 7120896
    buffer_load_dwordx4 v[104:107], v254, s[8:11], s58 offen offset:0 sc1
    buffer_load_dwordx4 v[108:111], v254, s[8:11], s58 offen offset:1024 sc1
    s_mov_b32 s58, 7124992
    buffer_load_dwordx4 v[136:139], v254, s[8:11], s58 offen offset:0 sc1
    buffer_load_dwordx4 v[140:143], v254, s[8:11], s58 offen offset:1024 sc1
    s_branch K2_back_18
K2_dum_19:
    v_mov_b32 v232, -1
    s_mov_b32 m0, 163712
    s_mov_b64 exec, 1
    buffer_load_dwordx4 v232, s[16:19], 0 offen lds
    buffer_load_dwordx4 v232, s[16:19], 0 offen lds
    s_mov_b64 exec, -1
    s_branch K2_back_21
K2_rlx_23:
    s_waitcnt vmcnt(10) lgkmcnt(1)
    s_branch K2_back_24
K2_rlx_25:
    s_waitcnt vmcnt(8) lgkmcnt(1)
    s_branch K2_back_26
K2_nul_29:
    s_mov_b32 s58, 63
    s_mov_b32 s36, 0
    s_branch K2_back_32
K2_spin_30:
    s_sub_u32 s27, s27, 1
    s_cbranch_scc1 K2_END
    v_lshl_add_u32 v233, v252, 1, s53
    ds_read_b32 v233, v233
    s_waitcnt lgkmcnt(0)
    s_branch K2_chk_31
K2_dyn_27:
    v_mov_b32 v254, 163648
    v_mov_b32 v255, 1
    v_lshl_add_u32 v233, v252, 1, s53
    s_mov_b64 exec, 1
    ds_add_rtn_u32 v232, v254, v255
    s_mov_b64 exec, -1
    ds_read_b32 v233, v233
    s_waitcnt lgkmcnt(0)
    v_readfirstlane_b32 s58, v232
    s_nop 0
    s_cmp_lt_u32 s58, s22
    s_cbranch_scc0 K2_nul_29
    s_and_b32 s59, s58, 7
    s_lshr_b32 s60, s58, 3
K2_chk_31:
    v_readlane_b32 s61, v233, s59
    s_nop 0
    s_cmp_gt_u32 s61, s60
    s_cbranch_scc0 K2_spin_30
K2_back_32:
    s_mov_b32 s34, 1
    s_branch K2_back_28
K2_ew_36:
    v_lshlrev_b32 v254, 3, v252
    s_mov_b64 vcc, -1
    s_mov_b32 s58, 7120896
    buffer_load_dwordx4 v[104:107], v254, s[8:11], s58 offen offset:0 sc1
    buffer_load_dwordx4 v[108:111], v254, s[8:11], s58 offen offset:1024 sc1
    s_mov_b32 s58, 7124992
    buffer_load_dwordx4 v[136:139], v254, s[8:11], s58 offen offset:0 sc1
    buffer_load_dwordx4 v[140:143], v254, s[8:11], s58 offen offset:1024 sc1
    s_branch K2_back_37
K2_dum_38:
    v_mov_b32 v232, -1
    s_mov_b32 m0, 163712
    s_mov_b64 exec, 1
    buffer_load_dwordx4 v232, s[16:19], 0 offen lds
    buffer_load_dwordx4 v232, s[16:19], 0 offen lds
    s_mov_b64 exec, -1
    s_branch K2_back_40
K2_rlx_42:
    s_waitcnt vmcnt(8) lgkmcnt(1)
    s_branch K2_back_43
K2_rlx_44:
    s_waitcnt vmcnt(8) lgkmcnt(1)
    s_branch K2_back_45
K2_nul_46:
    s_mov_b32 s58, 63
    s_mov_b32 s36, 0
    s_branch K2_back_49
K2_spin_47:
    s_sub_u32 s27, s27, 1
    s_cbranch_scc1 K2_END
    v_lshl_add_u32 v233, v252, 1, s53
    ds_read_b32 v233, v233
    s_waitcnt lgkmcnt(0)
    s_branch K2_chk_48
K2_nul_53:
    s_mov_b32 s58, 63
    s_mov_b32 s36, 0
    s_branch K2_back_56
K2_spin_54:
    s_sub_u32 s27, s27, 1
    s_cbranch_scc1 K2_END
    v_lshl_add_u32 v233, v252, 1, s53
    ds_read_b32 v233, v233
    s_waitcnt lgkmcnt(0)
    s_branch K2_chk_55
K2_PAD_TL:
    s_branch K2_HOP
K2_TAIL2:
    v_lshlrev_b32 v229, 3, v252
    s_mul_i32 s58, s20, 20480
    s_add_u32 s58, s58, 6946816
    s_mul_i32 s59, s20, 8224
    buffer_load_dwordx4 v[96:99], v229, s[8:11], s58 offen offset:0 sc1
    buffer_load_dwordx4 v[100:103], v229, s[8:11], s58 offen offset:1024 sc1
    buffer_load_dwordx4 v[104:107], v229, s[8:11], s58 offen offset:2048 sc1
    buffer_load_dwordx4 v[108:111], v229, s[8:11], s58 offen offset:3072 sc1
    s_add_u32 s58, s58, 4096
    buffer_load_dwordx4 v[112:115], v229, s[8:11], s58 offen offset:0 sc1
    buffer_load_dwordx4 v[116:119], v229, s[8:11], s58 offen offset:1024 sc1
    buffer_load_dwordx4 v[120:123], v229, s[8:11], s58 offen offset:2048 sc1
    buffer_load_dwordx4 v[124:127], v229, s[8:11], s58 offen offset:3072 sc1
    v_lshl_add_u32 v228, v252, 1, s59
    v_lshrrev_b32 v226, 6, v252
    v_mul_u32_u24 v226, 126, v226
    v_sub_u32 v226, v228, v226
    s_branch K2_TAIL3
K2_TAIL:
    v_lshlrev_b32 v229, 3, v252
    s_mul_i32 s58, s20, 20480
    s_add_u32 s58, s58, 6946816
    s_mul_i32 s59, s20, 8224
    buffer_load_dwordx4 v[96:99], v229, s[8:11], s58 offen offset:0 sc1
    v_permlane32_swap_b32 v242, v236
    v_permlane32_swap_b32 v243, v237
    buffer_load_dwordx4 v[100:103], v229, s[8:11], s58 offen offset:1024 sc1
    v_permlane32_swap_b32 v244, v238
    v_permlane32_swap_b32 v245, v239
    buffer_load_dwordx4 v[104:107], v229, s[8:11], s58 offen offset:2048 sc1
    v_permlane32_swap_b32 v240, v241
    v_add_f32 v242, v242, v236
    buffer_load_dwordx4 v[108:111], v229, s[8:11], s58 offen offset:3072 sc1
    v_add_f32 v243, v243, v237
    v_add_f32 v244, v244, v238
    s_add_u32 s58, s58, 4096
    buffer_load_dwordx4 v[112:115], v229, s[8:11], s58 offen offset:0 sc1
    v_add_f32 v245, v245, v239
    v_add_f32 v240, -v240, -v241
    buffer_load_dwordx4 v[116:119], v229, s[8:11], s58 offen offset:1024 sc1
    v_sub_u32 v241, v230, v231
    v_cvt_pk_bf16_f32 v242, v242, v243
    buffer_load_dwordx4 v[120:123], v229, s[8:11], s58 offen offset:2048 sc1
    v_cvt_pk_bf16_f32 v244, v244, v245
    v_cvt_pk_bf16_f32 v240, v240, v240
    buffer_load_dwordx4 v[124:127], v229, s[8:11], s58 offen offset:3072 sc1
    ds_write_b32 v230, v242 offset:768
    ds_write_b32 v230, v244 offset:1024
    ds_write_b16 v241, v240 offset:1280
    v_lshl_add_u32 v228, v252, 1, s59
    v_lshrrev_b32 v226, 6, v252
    v_mul_u32_u24 v226, 126, v226
    v_sub_u32 v226, v228, v226
K2_TAIL3:
    s_waitcnt vmcnt(8)
    ds_write_b32 v228, v192 offset:0
    ds_write_b32 v228, v193 offset:256
    ds_write_b32 v228, v194 offset:512
    s_add_u32 s58, s58, 4096
    buffer_load_dwordx4 v[128:131], v229, s[8:11], s58 offen offset:0 sc1
    v_bfe_u32 v48, v252, 1, 4
    v_lshrrev_b32 v49, 5, v252
    ds_write_b32 v228, v195 offset:768
    ds_write_b32 v228, v196 offset:1024
    ds_write_b16 v226, v197 offset:1280
    buffer_load_dwordx4 v[132:135], v229, s[8:11], s58 offen offset:1024 sc1
    v_lshrrev_b32 v55, 3, v48
    v_lshlrev_b32 v52, 4, v49
    ds_write_b32 v228, v198 offset:1536
    ds_write_b32 v228, v199 offset:1792
    ds_write_b32 v228, v200 offset:2048
    buffer_load_dwordx4 v[136:139], v229, s[8:11], s58 offen offset:2048 sc1
    v_lshl_add_u32 v54, v55, 2, v48
    v_and_b32 v54, 7, v54
    ds_write_b32 v228, v201 offset:2304
    ds_write_b32 v228, v202 offset:2560
    ds_write_b16 v226, v203 offset:2816
    buffer_load_dwordx4 v[140:143], v229, s[8:11], s58 offen offset:3072 sc1
    v_and_b32 v50, 7, v48
    v_mul_u32_u24 v50, 8224, v50
    ds_write_b32 v228, v204 offset:3072
    ds_write_b32 v228, v205 offset:3328
    ds_write_b32 v228, v206 offset:3584
    s_add_u32 s58, s58, 4096
    buffer_load_dwordx4 v[144:147], v229, s[8:11], s58 offen offset:0 sc1
    v_mul_u32_u24 v51, 1536, v55
    v_add_u32 v50, v50, v51
    ds_write_b32 v228, v207 offset:3840
    ds_write_b32 v228, v208 offset:4096
    ds_write_b16 v226, v209 offset:4352
    buffer_load_dwordx4 v[148:151], v229, s[8:11], s58 offen offset:1024 sc1
    v_add_u32 v222, v50, v52
    v_mul_u32_u24 v51, 8224, v54
    ds_write_b32 v228, v210 offset:4608
    ds_write_b32 v228, v211 offset:4864
    ds_write_b32 v228, v212 offset:5120
    buffer_load_dwordx4 v[152:155], v229, s[8:11], s58 offen offset:2048 sc1
    v_add_u32 v232, v51, v52
    v_lshl_add_u32 v247, v55, 7, v232
    ds_write_b32 v228, v213 offset:5376
    ds_write_b32 v228, v214 offset:5632
    ds_write_b16 v226, v215 offset:5888
    buffer_load_dwordx4 v[156:159], v229, s[8:11], s58 offen offset:3072 sc1
    v_mul_u32_u24 v53, 192, v48
    v_and_b32 v53, 0xc0, v53
    ds_write_b32 v228, v216 offset:6144
    ds_write_b32 v228, v217 offset:6400
    ds_write_b32 v228, v218 offset:6656
    s_add_u32 s58, s58, 4096
    buffer_load_dwordx4 v[160:163], v229, s[8:11], s58 offen offset:0 sc1
    v_add_u32 v53, v53, v52
    v_mul_u32_u24 v51, 2400, v48
    ds_write_b32 v228, v219 offset:6912
    ds_write_b32 v228, v220 offset:7168
    ds_write_b16 v226, v221 offset:7424
    buffer_load_dwordx4 v[164:167], v229, s[8:11], s58 offen offset:1024 sc1
    s_mov_b32 s60, 65536
    v_add3_u32 v223, v51, v53, s60
    buffer_load_dwordx4 v[168:171], v229, s[8:11], s58 offen offset:2048 sc1
    v_mul_u32_u24 v51, 2400, v54
    s_mov_b32 s60, 142336
    buffer_load_dwordx4 v[172:175], v229, s[8:11], s58 offen offset:3072 sc1
    v_add3_u32 v225, v51, v53, s60
    v_lshl_add_u32 v248, v55, 7, v225
    s_lshl_b32 s60, s20, 5
    v_lshl_add_u32 v49, v49, 3, s60
    s_mov_b32 s60, 65536
    v_add3_u32 v255, v51, v49, s60
    v_lshl_add_u32 v246, v55, 9, v255
    v_bfe_u32 v53, v48, 2, 1
    v_lshl_add_u32 v49, v53, 4, v49
    v_add_u32 v254, v50, v49
    s_and_b32 s64, s55, s28
    s_waitcnt lgkmcnt(0)
    s_barrier
    s_cmp_eq_u32 s64, 0
    s_cbranch_scc1 K2_MULTI
    s_setprio 3
    ds_read_b128 v[48:51], v222 offset:0
    ds_read_b128 v[52:55], v222 offset:64
    ds_read_b128 v[56:59], v222 offset:896
    ds_read_b128 v[60:63], v222 offset:960
    ds_read_b128 v[64:67], v223 offset:0
    ds_read_b128 v[68:71], v223 offset:64
    ds_read_b128 v[72:75], v223 offset:896
    ds_read_b128 v[76:79], v223 offset:960
    ds_read_b128 v[80:83], v222 offset:3072
    ds_read_b128 v[84:87], v222 offset:3136
    ds_read_b128 v[88:91], v222 offset:3968
    s_waitcnt vmcnt(19) lgkmcnt(9)
    v_mfma_f32_16x16x32_bf16 v[0:3], v[96:99], v[48:51], 0
    ds_read_b128 v[92:95], v222 offset:4032
    s_waitcnt vmcnt(18)
    v_mfma_f32_16x16x32_bf16 v[0:3], v[100:103], v[52:55], v[0:3]
    ds_read_b128 v[48:51], v223 offset:38400
    s_waitcnt vmcnt(17) lgkmcnt(9)
    v_mfma_f32_16x16x32_bf16 v[0:3], v[104:107], v[56:59], v[0:3]
    s_bfe_u32 s60, s20, 0x10002
    s_lshl_b32 s60, s60, 4
    ds_read_b128 v[52:55], v223 offset:38464
    s_waitcnt vmcnt(16)
    v_mfma_f32_16x16x32_bf16 v[0:3], v[108:111], v[60:63], v[0:3]
    s_add_u32 s59, s59, s60
    v_add_u32 v228, s59, v229
    ds_read_b128 v[56:59], v223 offset:39296
    s_waitcnt vmcnt(15) lgkmcnt(9)
    v_mfma_f32_16x16x32_bf16 v[0:3], v[112:115], v[64:67], v[0:3]
    s_mul_i32 s60, s20, 2400
    s_add_u32 s60, s60, 65536
    ds_read_b128 v[60:63], v223 offset:39360
    s_waitcnt vmcnt(14)
    v_mfma_f32_16x16x32_bf16 v[0:3], v[116:119], v[68:71], v[0:3]
    v_add_u32 v249, s60, v229
    s_mov_b32 s63, 0xbfb8aa3b
    ds_read_b128 v[64:67], v232 offset:6144
    s_waitcnt vmcnt(13) lgkmcnt(9)
    v_mfma_f32_16x16x32_bf16 v[0:3], v[120:123], v[72:75], v[0:3]
    s_add_u32 s40, s20, s21
    s_lshl_b32 s40, s40, 10
    ds_read_b128 v[68:71], v232 offset:6208
    s_waitcnt vmcnt(12)
    v_mfma_f32_16x16x32_bf16 v[0:3], v[124:127], v[76:79], v[0:3]
    s_add_u32 s41, s40, 8192
    s_add_u32 s42, s40, 16384
    ds_read_b128 v[72:75], v232 offset:7040
    s_waitcnt lgkmcnt(9)
    v_mfma_f32_16x16x32_bf16 v[16:19], v[96:99], v[80:83], 0
    s_add_u32 s43, s40, 24576
    s_add_u32 s44, s40, 32768
    ds_read_b128 v[76:79], v232 offset:7104
    v_mfma_f32_16x16x32_bf16 v[16:19], v[100:103], v[84:87], v[16:19]
    ds_read_b128 v[80:83], v225 offset:0
    s_waitcnt lgkmcnt(9)
    v_mfma_f32_16x16x32_bf16 v[16:19], v[104:107], v[88:91], v[16:19]
    ds_read_b128 v[84:87], v225 offset:64
    v_mfma_f32_16x16x32_bf16 v[16:19], v[108:111], v[92:95], v[16:19]
    v_mul_f32 v204, s63, v0
    v_mul_f32 v205, s63, v1
    ds_read_b128 v[88:91], v225 offset:896
    s_waitcnt lgkmcnt(9)
    v_mfma_f32_16x16x32_bf16 v[16:19], v[112:115], v[48:51], v[16:19]
    v_mul_f32 v206, s63, v2
    ds_read_b128 v[92:95], v225 offset:960
    v_mfma_f32_16x16x32_bf16 v[16:19], v[116:119], v[52:55], v[16:19]
    v_mul_f32 v207, s63, v3
    ds_read_b128 v[48:51], v222 offset:128
    s_waitcnt lgkmcnt(9)
    v_mfma_f32_16x16x32_bf16 v[16:19], v[120:123], v[56:59], v[16:19]
    v_exp_f32 v204, v204
    ds_read_b128 v[52:55], v222 offset:384
    v_mfma_f32_16x16x32_bf16 v[16:19], v[124:127], v[60:63], v[16:19]
    v_exp_f32 v205, v205
    ds_read_b128 v[56:59], v222 offset:256
    s_waitcnt lgkmcnt(9)
    v_mfma_f32_16x16x32_bf16 v[32:35], v[96:99], v[64:67], 0
    v_exp_f32 v206, v206
    ds_read_b128 v[60:63], v222 offset:192
    v_mfma_f32_16x16x32_bf16 v[32:35], v[100:103], v[68:71], v[32:35]
    v_exp_f32 v207, v207
    s_setprio 2
    ds_read_b128 v[64:67], v222 offset:448
    s_waitcnt lgkmcnt(9)
    v_mfma_f32_16x16x32_bf16 v[32:35], v[104:107], v[72:75], v[32:35]
    v_add_f32 v204, 1.0, v204
    ds_read_b128 v[68:71], v222 offset:320
    v_mfma_f32_16x16x32_bf16 v[32:35], v[108:111], v[76:79], v[32:35]
    v_add_f32 v205, 1.0, v205
    v_add_f32 v206, 1.0, v206
    ds_read_b128 v[72:75], v222 offset:640
    s_waitcnt lgkmcnt(9)
    v_mfma_f32_16x16x32_bf16 v[32:35], v[112:115], v[80:83], v[32:35]
    v_add_f32 v207, 1.0, v207
    ds_read_b128 v[76:79], v222 offset:512
    v_mfma_f32_16x16x32_bf16 v[32:35], v[116:119], v[84:87], v[32:35]
    v_rcp_f32 v204, v204
    ds_read_b128 v[80:83], v222 offset:768
    s_waitcnt lgkmcnt(9)
    v_mfma_f32_16x16x32_bf16 v[32:35], v[120:123], v[88:91], v[32:35]
    v_rcp_f32 v205, v205
    ds_read_b128 v[84:87], v222 offset:704
    v_mfma_f32_16x16x32_bf16 v[32:35], v[124:127], v[92:95], v[32:35]
    v_rcp_f32 v206, v206
    ds_read_b128 v[88:91], v222 offset:576
    s_waitcnt vmcnt(11) lgkmcnt(9)
    v_mfma_f32_16x16x32_bf16 v[4:7], v[128:131], v[48:51], 0
    v_rcp_f32 v207, v207
    ds_read_b128 v[92:95], v222 offset:832
    v_mfma_f32_16x16x32_bf16 v[8:11], v[128:131], v[52:55], 0
    v_cvt_pk_bf16_f32 v176, v0, v1
    ds_read_b128 v[48:51], v222 offset:1024
    s_waitcnt lgkmcnt(9)
    v_mfma_f32_16x16x32_bf16 v[12:15], v[128:131], v[56:59], 0
    v_cvt_pk_bf16_f32 v177, v2, v3
    ds_read_b128 v[52:55], v222 offset:1280
    s_waitcnt vmcnt(10)
    v_mfma_f32_16x16x32_bf16 v[4:7], v[132:135], v[60:63], v[4:7]
    v_mul_f32 v208, s63, v16
    v_mul_f32 v209, s63, v17
    ds_read_b128 v[56:59], v222 offset:1152
    s_waitcnt lgkmcnt(9)
    v_mfma_f32_16x16x32_bf16 v[8:11], v[132:135], v[64:67], v[8:11]
    v_mul_f32 v210, s63, v18
    ds_read_b128 v[60:63], v222 offset:1088
    v_mfma_f32_16x16x32_bf16 v[12:15], v[132:135], v[68:71], v[12:15]
    v_mul_f32 v211, s63, v19
    ds_read_b128 v[64:67], v222 offset:1344
    s_waitcnt vmcnt(9) lgkmcnt(9)
    v_mfma_f32_16x16x32_bf16 v[4:7], v[136:139], v[72:75], v[4:7]
    v_exp_f32 v208, v208
    ds_read_b128 v[68:71], v222 offset:1216
    v_mfma_f32_16x16x32_bf16 v[8:11], v[136:139], v[76:79], v[8:11]
    v_exp_f32 v209, v209
    ds_read_b128 v[72:75], v223 offset:128
    s_waitcnt lgkmcnt(9)
    v_mfma_f32_16x16x32_bf16 v[12:15], v[136:139], v[80:83], v[12:15]
    v_exp_f32 v210, v210
    ds_read_b128 v[76:79], v223 offset:384
    s_waitcnt vmcnt(8)
    v_mfma_f32_16x16x32_bf16 v[4:7], v[140:143], v[84:87], v[4:7]
    v_exp_f32 v211, v211
    ds_read_b128 v[80:83], v223 offset:256
    s_waitcnt lgkmcnt(9)
    v_mfma_f32_16x16x32_bf16 v[8:11], v[140:143], v[88:91], v[8:11]
    v_add_f32 v208, 1.0, v208
    ds_read_b128 v[84:87], v223 offset:192
    v_mfma_f32_16x16x32_bf16 v[12:15], v[140:143], v[92:95], v[12:15]
    v_add_f32 v209, 1.0, v209
    v_add_f32 v210, 1.0, v210
    ds_read_b128 v[88:91], v223 offset:448
    s_waitcnt vmcnt(7) lgkmcnt(9)
    v_mfma_f32_16x16x32_bf16 v[4:7], v[144:147], v[48:51], v[4:7]
    v_add_f32 v211, 1.0, v211
    s_setprio 1
    ds_read_b128 v[92:95], v223 offset:320
    v_mfma_f32_16x16x32_bf16 v[8:11], v[144:147], v[52:55], v[8:11]
    v_rcp_f32 v208, v208
    ds_read_b128 v[48:51], v223 offset:640
    s_waitcnt lgkmcnt(9)
    v_mfma_f32_16x16x32_bf16 v[12:15], v[144:147], v[56:59], v[12:15]
    v_rcp_f32 v209, v209
    ds_read_b128 v[52:55], v223 offset:512
    s_waitcnt vmcnt(6)
    v_mfma_f32_16x16x32_bf16 v[4:7], v[148:151], v[60:63], v[4:7]
    v_rcp_f32 v210, v210
    ds_read_b128 v[56:59], v223 offset:768
    s_waitcnt lgkmcnt(9)
    v_mfma_f32_16x16x32_bf16 v[8:11], v[148:151], v[64:67], v[8:11]
    v_rcp_f32 v211, v211
    ds_read_b128 v[60:63], v223 offset:704
    v_mfma_f32_16x16x32_bf16 v[12:15], v[148:151], v[68:71], v[12:15]
K2_PAD_T2:
    s_cbranch_execz K2_HOP
    v_cvt_pk_bf16_f32 v184, v16, v17
    ds_read_b128 v[64:67], v223 offset:576
    s_waitcnt vmcnt(5) lgkmcnt(9)
    v_mfma_f32_16x16x32_bf16 v[4:7], v[152:155], v[72:75], v[4:7]
    v_cvt_pk_bf16_f32 v185, v18, v19
    ds_read_b128 v[68:71], v223 offset:832
    v_mfma_f32_16x16x32_bf16 v[8:11], v[152:155], v[76:79], v[8:11]
    v_mul_f32 v212, s63, v32
    v_mul_f32 v213, s63, v33
    ds_read_b128 v[72:75], v223 offset:1024
    s_waitcnt lgkmcnt(9)
    v_mfma_f32_16x16x32_bf16 v[12:15], v[152:155], v[80:83], v[12:15]
    v_mul_f32 v214, s63, v34
    ds_read_b128 v[76:79], v223 offset:1280
    s_waitcnt vmcnt(4)
    v_mfma_f32_16x16x32_bf16 v[4:7], v[156:159], v[84:87], v[4:7]
    v_mul_f32 v215, s63, v35
    ds_read_b128 v[80:83], v223 offset:1152
    s_waitcnt lgkmcnt(9)
    v_mfma_f32_16x16x32_bf16 v[8:11], v[156:159], v[88:91], v[8:11]
    v_exp_f32 v212, v212
    ds_read_b128 v[84:87], v223 offset:1088
    v_mfma_f32_16x16x32_bf16 v[12:15], v[156:159], v[92:95], v[12:15]
    v_exp_f32 v213, v213
    ds_read_b128 v[88:91], v223 offset:1344
    s_waitcnt vmcnt(3) lgkmcnt(9)
    v_mfma_f32_16x16x32_bf16 v[4:7], v[160:163], v[48:51], v[4:7]
    v_exp_f32 v214, v214
    ds_read_b128 v[92:95], v223 offset:1216
    v_mfma_f32_16x16x32_bf16 v[8:11], v[160:163], v[52:55], v[8:11]
    v_exp_f32 v215, v215
    ds_read_b128 v[48:51], v222 offset:3200
    s_waitcnt lgkmcnt(9)
    v_mfma_f32_16x16x32_bf16 v[12:15], v[160:163], v[56:59], v[12:15]
    v_add_f32 v212, 1.0, v212
    ds_read_b128 v[52:55], v222 offset:3456
    s_waitcnt vmcnt(2)
    v_mfma_f32_16x16x32_bf16 v[4:7], v[164:167], v[60:63], v[4:7]
    v_add_f32 v213, 1.0, v213
    v_add_f32 v214, 1.0, v214
    ds_read_b128 v[56:59], v222 offset:3328
    s_waitcnt lgkmcnt(9)
    v_mfma_f32_16x16x32_bf16 v[8:11], v[164:167], v[64:67], v[8:11]
    v_add_f32 v215, 1.0, v215
    ds_read_b128 v[60:63], v222 offset:3264
    v_mfma_f32_16x16x32_bf16 v[12:15], v[164:167], v[68:71], v[12:15]
    v_rcp_f32 v212, v212
    s_setprio 0
    ds_read_b128 v[64:67], v222 offset:3520
    s_waitcnt vmcnt(1) lgkmcnt(9)
    v_mfma_f32_16x16x32_bf16 v[4:7], v[168:171], v[72:75], v[4:7]
    v_rcp_f32 v213, v213
    ds_read_b128 v[68:71], v222 offset:3392
    v_mfma_f32_16x16x32_bf16 v[8:11], v[168:171], v[76:79], v[8:11]
    v_rcp_f32 v214, v214
    ds_read_b128 v[72:75], v222 offset:3712
    s_waitcnt lgkmcnt(9)
    v_mfma_f32_16x16x32_bf16 v[12:15], v[168:171], v[80:83], v[12:15]
    v_rcp_f32 v215, v215
    ds_read_b128 v[76:79], v222 offset:3584
    s_waitcnt vmcnt(0)
    v_mfma_f32_16x16x32_bf16 v[4:7], v[172:175], v[84:87], v[4:7]
    v_cvt_pk_bf16_f32 v220, v32, v33
    ds_read_b128 v[80:83], v222 offset:3840
    s_waitcnt lgkmcnt(9)
    v_mfma_f32_16x16x32_bf16 v[8:11], v[172:175], v[88:91], v[8:11]
    v_cvt_pk_bf16_f32 v221, v34, v35
    ds_read_b128 v[84:87], v222 offset:3776
    v_mfma_f32_16x16x32_bf16 v[12:15], v[172:175], v[92:95], v[12:15]
    ds_read_b128 v[88:91], v222 offset:3648
    s_waitcnt lgkmcnt(9)
    v_mfma_f32_16x16x32_bf16 v[20:23], v[128:131], v[48:51], 0
    ds_read_b128 v[92:95], v222 offset:3904
    v_mfma_f32_16x16x32_bf16 v[24:27], v[128:131], v[52:55], 0
    ds_read_b128 v[48:51], v222 offset:4096
    s_waitcnt lgkmcnt(9)
    v_mfma_f32_16x16x32_bf16 v[28:31], v[128:131], v[56:59], 0
    s_barrier
    s_setprio 3
    ds_read_b128 v[52:55], v222 offset:4352
    v_mfma_f32_16x16x32_bf16 v[20:23], v[132:135], v[60:63], v[20:23]
    v_mul_f32 v4, v4, v204
    ds_read_b128 v[56:59], v222 offset:4224
    s_waitcnt lgkmcnt(9)
    v_mfma_f32_16x16x32_bf16 v[24:27], v[132:135], v[64:67], v[24:27]
    v_mul_f32 v5, v5, v205
    ds_read_b128 v[60:63], v222 offset:4160
    v_mfma_f32_16x16x32_bf16 v[28:31], v[132:135], v[68:71], v[28:31]
    v_mul_f32 v6, v6, v206
    ds_read_b128 v[64:67], v222 offset:4416
    s_waitcnt lgkmcnt(9)
    v_mfma_f32_16x16x32_bf16 v[20:23], v[136:139], v[72:75], v[20:23]
    v_mul_f32 v7, v7, v207
    ds_read_b128 v[68:71], v222 offset:4288
    v_mfma_f32_16x16x32_bf16 v[24:27], v[136:139], v[76:79], v[24:27]
    v_cvt_pk_bf16_f32 v178, v4, v5
    ds_read_b128 v[72:75], v223 offset:38528
    s_waitcnt lgkmcnt(9)
    v_mfma_f32_16x16x32_bf16 v[28:31], v[136:139], v[80:83], v[28:31]
    v_cvt_pk_bf16_f32 v179, v6, v7
    ds_read_b128 v[76:79], v223 offset:38784
    v_mfma_f32_16x16x32_bf16 v[20:23], v[140:143], v[84:87], v[20:23]
    v_mul_f32 v8, v8, v204
    ds_read_b128 v[80:83], v223 offset:38656
    s_waitcnt lgkmcnt(9)
    v_mfma_f32_16x16x32_bf16 v[24:27], v[140:143], v[88:91], v[24:27]
    v_mul_f32 v9, v9, v205
    ds_read_b128 v[84:87], v223 offset:38592
    v_mfma_f32_16x16x32_bf16 v[28:31], v[140:143], v[92:95], v[28:31]
    v_mul_f32 v10, v10, v206
    ds_read_b128 v[88:91], v223 offset:38848
    s_waitcnt lgkmcnt(9)
    v_mfma_f32_16x16x32_bf16 v[20:23], v[144:147], v[48:51], v[20:23]
    v_mul_f32 v11, v11, v207
    s_setprio 2
    ds_read_b128 v[92:95], v223 offset:38720
    v_mfma_f32_16x16x32_bf16 v[24:27], v[144:147], v[52:55], v[24:27]
    v_cvt_pk_bf16_f32 v180, v8, v9
    ds_read_b128 v[48:51], v223 offset:39040
    s_waitcnt lgkmcnt(9)
    v_mfma_f32_16x16x32_bf16 v[28:31], v[144:147], v[56:59], v[28:31]
    v_cvt_pk_bf16_f32 v181, v10, v11
    ds_read_b128 v[52:55], v223 offset:38912
    v_mfma_f32_16x16x32_bf16 v[20:23], v[148:151], v[60:63], v[20:23]
    v_mul_f32 v12, v12, v204
    ds_read_b128 v[56:59], v223 offset:39168
    s_waitcnt lgkmcnt(9)
    v_mfma_f32_16x16x32_bf16 v[24:27], v[148:151], v[64:67], v[24:27]
    v_mul_f32 v13, v13, v205
    ds_read_b128 v[60:63], v223 offset:39104
    v_mfma_f32_16x16x32_bf16 v[28:31], v[148:151], v[68:71], v[28:31]
    v_mul_f32 v14, v14, v206
    ds_read_b128 v[64:67], v223 offset:38976
    s_waitcnt lgkmcnt(9)
    v_mfma_f32_16x16x32_bf16 v[20:23], v[152:155], v[72:75], v[20:23]
    v_mul_f32 v15, v15, v207
    ds_read_b128 v[68:71], v223 offset:39232
    v_mfma_f32_16x16x32_bf16 v[24:27], v[152:155], v[76:79], v[24:27]
    v_cvt_pk_bf16_f32 v182, v12, v13
    ds_read_b128 v[72:75], v223 offset:39424
    s_waitcnt lgkmcnt(9)
    v_mfma_f32_16x16x32_bf16 v[28:31], v[152:155], v[80:83], v[28:31]
    v_cvt_pk_bf16_f32 v183, v14, v15
    ds_read_b128 v[76:79], v223 offset:39680
    v_mfma_f32_16x16x32_bf16 v[20:23], v[156:159], v[84:87], v[20:23]
    ds_write_b64 v254, v[176:177] offset:0
    ds_write_b64 v254, v[178:179] offset:256
    ds_write_b64 v254, v[180:181] offset:512
    ds_write_b64 v254, v[182:183] offset:768
    ds_write_b64 v255, v[220:221] offset:0
    ds_read_b128 v[80:83], v223 offset:39552
    s_waitcnt lgkmcnt(14)
    v_mfma_f32_16x16x32_bf16 v[24:27], v[156:159], v[88:91], v[24:27]
    ds_read_b128 v[84:87], v223 offset:39488
    v_mfma_f32_16x16x32_bf16 v[28:31], v[156:159], v[92:95], v[28:31]
    s_setprio 1
    ds_read_b128 v[88:91], v223 offset:39744
    s_waitcnt lgkmcnt(14)
    v_mfma_f32_16x16x32_bf16 v[20:23], v[160:163], v[48:51], v[20:23]
    ds_read_b128 v[92:95], v223 offset:39616
    v_mfma_f32_16x16x32_bf16 v[24:27], v[160:163], v[52:55], v[24:27]
    ds_read_b128 v[48:51], v247 offset:6272
    s_waitcnt lgkmcnt(14)
    v_mfma_f32_16x16x32_bf16 v[28:31], v[160:163], v[56:59], v[28:31]
    ds_read_b128 v[52:55], v232 offset:6528
    v_mfma_f32_16x16x32_bf16 v[20:23], v[164:167], v[60:63], v[20:23]
    ds_read_b128 v[56:59], v247 offset:6336
    s_waitcnt lgkmcnt(14)
    v_mfma_f32_16x16x32_bf16 v[24:27], v[164:167], v[64:67], v[24:27]
    ds_read_b128 v[60:63], v232 offset:6592
    v_mfma_f32_16x16x32_bf16 v[28:31], v[164:167], v[68:71], v[28:31]
    ds_read_b128 v[64:67], v247 offset:6784
    s_waitcnt lgkmcnt(14)
    v_mfma_f32_16x16x32_bf16 v[20:23], v[168:171], v[72:75], v[20:23]
    ds_read_b128 v[68:71], v232 offset:6656
    v_mfma_f32_16x16x32_bf16 v[24:27], v[168:171], v[76:79], v[24:27]
    ds_read_b128 v[72:75], v247 offset:6848
    s_waitcnt lgkmcnt(9)
    v_mfma_f32_16x16x32_bf16 v[28:31], v[168:171], v[80:83], v[28:31]
    ds_read_b128 v[76:79], v232 offset:6720
    v_mfma_f32_16x16x32_bf16 v[20:23], v[172:175], v[84:87], v[20:23]
    s_setprio 0
    ds_read_b128 v[80:83], v247 offset:7168
    s_waitcnt lgkmcnt(9)
    v_mfma_f32_16x16x32_bf16 v[24:27], v[172:175], v[88:91], v[24:27]
    ds_read_b128 v[84:87], v232 offset:7424
    v_mfma_f32_16x16x32_bf16 v[28:31], v[172:175], v[92:95], v[28:31]
    ds_read_b128 v[88:91], v247 offset:7232
    s_waitcnt lgkmcnt(9)
    v_mfma_f32_16x16x32_bf16 v[36:39], v[128:131], v[48:51], 0
    ds_read_b128 v[92:95], v232 offset:7488
    v_mfma_f32_16x16x32_bf16 v[40:43], v[128:131], v[52:55], 0
    ds_read_b128 v[48:51], v248 offset:128
    s_waitcnt lgkmcnt(9)
    v_mfma_f32_16x16x32_bf16 v[36:39], v[132:135], v[56:59], v[36:39]
    s_barrier
    ds_read_b128 v[192:195], v228 offset:0
    ds_read_b128 v[196:199], v228 offset:1536
    s_setprio 3
    ds_read_b128 v[52:55], v225 offset:384
    v_mfma_f32_16x16x32_bf16 v[40:43], v[132:135], v[60:63], v[40:43]
    v_mul_f32 v20, v20, v208
    v_mul_f32 v21, v21, v209
    ds_read_b128 v[56:59], v248 offset:192
    s_waitcnt lgkmcnt(11)
    v_mfma_f32_16x16x32_bf16 v[36:39], v[136:139], v[64:67], v[36:39]
    v_mul_f32 v22, v22, v210
    ds_read_b128 v[60:63], v225 offset:448
    v_mfma_f32_16x16x32_bf16 v[40:43], v[136:139], v[68:71], v[40:43]
    v_mul_f32 v23, v23, v211
    ds_read_b128 v[64:67], v248 offset:640
    s_waitcnt lgkmcnt(11)
    v_mfma_f32_16x16x32_bf16 v[36:39], v[140:143], v[72:75], v[36:39]
    v_cvt_pk_bf16_f32 v186, v20, v21
    ds_read_b128 v[68:71], v225 offset:512
    v_mfma_f32_16x16x32_bf16 v[40:43], v[140:143], v[76:79], v[40:43]
    v_cvt_pk_bf16_f32 v187, v22, v23
    ds_read_b128 v[72:75], v248 offset:704
    s_waitcnt lgkmcnt(11)
    v_mfma_f32_16x16x32_bf16 v[36:39], v[144:147], v[80:83], v[36:39]
    v_mul_f32 v24, v24, v208
    v_mul_f32 v25, v25, v209
    s_waitcnt lgkmcnt(6)
    buffer_store_dwordx4 v[192:195], v229, s[12:15], s40 offen sc1
    buffer_store_dwordx4 v[196:199], v229, s[12:15], s41 offen sc1
    s_setprio 2
    ds_read_b128 v[76:79], v225 offset:576
    v_mfma_f32_16x16x32_bf16 v[40:43], v[144:147], v[84:87], v[40:43]
    v_mul_f32 v26, v26, v210
    ds_read_b128 v[80:83], v248 offset:1024
    v_mfma_f32_16x16x32_bf16 v[36:39], v[148:151], v[88:91], v[36:39]
    v_mul_f32 v27, v27, v211
    ds_read_b128 v[84:87], v225 offset:1280
    v_mfma_f32_16x16x32_bf16 v[40:43], v[148:151], v[92:95], v[40:43]
    v_cvt_pk_bf16_f32 v188, v24, v25
    ds_read_b128 v[88:91], v248 offset:1088
    s_waitcnt lgkmcnt(9)
    v_mfma_f32_16x16x32_bf16 v[36:39], v[152:155], v[48:51], v[36:39]
    v_cvt_pk_bf16_f32 v189, v26, v27
    ds_read_b128 v[92:95], v225 offset:1344
    v_mfma_f32_16x16x32_bf16 v[40:43], v[152:155], v[52:55], v[40:43]
    v_mul_f32 v28, v28, v208
    v_mul_f32 v29, v29, v209
    s_waitcnt lgkmcnt(8)
    v_mfma_f32_16x16x32_bf16 v[36:39], v[156:159], v[56:59], v[36:39]
    v_mul_f32 v30, v30, v210
    v_mfma_f32_16x16x32_bf16 v[40:43], v[156:159], v[60:63], v[40:43]
    v_mul_f32 v31, v31, v211
    s_setprio 1
    s_waitcnt lgkmcnt(6)
    v_mfma_f32_16x16x32_bf16 v[36:39], v[160:163], v[64:67], v[36:39]
    v_cvt_pk_bf16_f32 v190, v28, v29
    v_mfma_f32_16x16x32_bf16 v[40:43], v[160:163], v[68:71], v[40:43]
    v_cvt_pk_bf16_f32 v191, v30, v31
    s_waitcnt lgkmcnt(4)
    v_mfma_f32_16x16x32_bf16 v[36:39], v[164:167], v[72:75], v[36:39]
    ds_write_b64 v254, v[184:185] offset:3072
    ds_write_b64 v254, v[186:187] offset:3328
    ds_write_b64 v254, v[188:189] offset:3584
    ds_write_b64 v254, v[190:191] offset:3840
    v_mfma_f32_16x16x32_bf16 v[40:43], v[164:167], v[76:79], v[40:43]
    s_waitcnt lgkmcnt(6)
    v_mfma_f32_16x16x32_bf16 v[36:39], v[168:171], v[80:83], v[36:39]
    v_mfma_f32_16x16x32_bf16 v[40:43], v[168:171], v[84:87], v[40:43]
    s_setprio 0
    s_waitcnt lgkmcnt(4)
    v_mfma_f32_16x16x32_bf16 v[36:39], v[172:175], v[88:91], v[36:39]
    v_mfma_f32_16x16x32_bf16 v[40:43], v[172:175], v[92:95], v[40:43]
    s_nop 6
    v_mul_f32 v36, v36, v212
    v_mul_f32 v37, v37, v213
    v_mul_f32 v38, v38, v214
    v_mul_f32 v39, v39, v215
    v_cvt_pk_bf16_f32 v178, v36, v37
    v_cvt_pk_bf16_f32 v179, v38, v39
    v_mul_f32 v40, v40, v212
    v_mul_f32 v41, v41, v213
    v_mul_f32 v42, v42, v214
    v_mul_f32 v43, v43, v215
    v_cvt_pk_bf16_f32 v180, v40, v41
    v_cvt_pk_bf16_f32 v181, v42, v43
    ds_write_b64 v246, v[178:179] offset:256
    ds_write_b64 v255, v[180:181] offset:512
    s_waitcnt lgkmcnt(0)
    s_barrier
    ds_read_b128 v[192:195], v228 offset:3072
    ds_read_b128 v[196:199], v228 offset:4608
    ds_read_b128 v[200:203], v249
    s_waitcnt lgkmcnt(1)
    buffer_store_dwordx4 v[192:195], v229, s[12:15], s42 offen sc1
    buffer_store_dwordx4 v[196:199], v229, s[12:15], s43 offen sc1
K2_LASTROW:
    s_add_u32 s59, s20, 32
    s_cmp_ge_u32 s59, s22
    s_cbranch_scc1 K2_FIN
    s_waitcnt lgkmcnt(0)
    buffer_store_dwordx4 v[200:203], v229, s[12:15], s44 offen sc1
K2_FIN:
    s_endpgm
K2_MULTI:
    ds_read_b128 v[48:51], v222 offset:0
    ds_read_b128 v[52:55], v222 offset:64
    ds_read_b128 v[56:59], v222 offset:896
    ds_read_b128 v[60:63], v222 offset:960
    ds_read_b128 v[64:67], v223 offset:0
    ds_read_b128 v[68:71], v223 offset:64
    ds_read_b128 v[72:75], v223 offset:896
    ds_read_b128 v[76:79], v223 offset:960
    ds_read_b128 v[80:83], v222 offset:3072
    ds_read_b128 v[84:87], v222 offset:3136
    ds_read_b128 v[88:91], v222 offset:3968
    s_waitcnt vmcnt(19) lgkmcnt(9)
    v_mfma_f32_16x16x32_bf16 v[0:3], v[96:99], v[48:51], 0
    ds_read_b128 v[92:95], v222 offset:4032
    s_waitcnt vmcnt(18)
    v_mfma_f32_16x16x32_bf16 v[0:3], v[100:103], v[52:55], v[0:3]
    ds_read_b128 v[48:51], v223 offset:38400
    s_waitcnt vmcnt(17) lgkmcnt(9)
    v_mfma_f32_16x16x32_bf16 v[0:3], v[104:107], v[56:59], v[0:3]
    ds_read_b128 v[52:55], v223 offset:38464
    s_waitcnt vmcnt(16)
    v_mfma_f32_16x16x32_bf16 v[0:3], v[108:111], v[60:63], v[0:3]
    ds_read_b128 v[56:59], v223 offset:39296
    s_waitcnt vmcnt(15) lgkmcnt(9)
    v_mfma_f32_16x16x32_bf16 v[0:3], v[112:115], v[64:67], v[0:3]
    ds_read_b128 v[60:63], v223 offset:39360
    s_waitcnt vmcnt(14)
    v_mfma_f32_16x16x32_bf16 v[0:3], v[116:119], v[68:71], v[0:3]
    ds_read_b128 v[64:67], v232 offset:6144
    s_waitcnt vmcnt(13) lgkmcnt(9)
    v_mfma_f32_16x16x32_bf16 v[0:3], v[120:123], v[72:75], v[0:3]
    ds_read_b128 v[68:71], v232 offset:6208
    s_waitcnt vmcnt(12)
    v_mfma_f32_16x16x32_bf16 v[0:3], v[124:127], v[76:79], v[0:3]
    ds_read_b128 v[72:75], v232 offset:7040
    s_waitcnt lgkmcnt(9)
    v_mfma_f32_16x16x32_bf16 v[16:19], v[96:99], v[80:83], 0
    ds_read_b128 v[76:79], v232 offset:7104
    v_mfma_f32_16x16x32_bf16 v[16:19], v[100:103], v[84:87], v[16:19]
    ds_read_b128 v[80:83], v225 offset:0
    s_waitcnt lgkmcnt(9)
    v_mfma_f32_16x16x32_bf16 v[16:19], v[104:107], v[88:91], v[16:19]
    ds_read_b128 v[84:87], v225 offset:64
    v_mfma_f32_16x16x32_bf16 v[16:19], v[108:111], v[92:95], v[16:19]
    ds_read_b128 v[88:91], v225 offset:896
    s_waitcnt lgkmcnt(9)
    v_mfma_f32_16x16x32_bf16 v[16:19], v[112:115], v[48:51], v[16:19]
    ds_read_b128 v[92:95], v225 offset:960
    v_mfma_f32_16x16x32_bf16 v[16:19], v[116:119], v[52:55], v[16:19]
    ds_read_b128 v[48:51], v222 offset:128
    s_waitcnt lgkmcnt(9)
    v_mfma_f32_16x16x32_bf16 v[16:19], v[120:123], v[56:59], v[16:19]
    ds_read_b128 v[52:55], v222 offset:384
    v_mfma_f32_16x16x32_bf16 v[16:19], v[124:127], v[60:63], v[16:19]
    ds_read_b128 v[56:59], v222 offset:256
    s_waitcnt lgkmcnt(9)
    v_mfma_f32_16x16x32_bf16 v[32:35], v[96:99], v[64:67], 0
    ds_read_b128 v[60:63], v222 offset:192
    v_mfma_f32_16x16x32_bf16 v[32:35], v[100:103], v[68:71], v[32:35]
    ds_read_b128 v[64:67], v222 offset:448
    s_waitcnt lgkmcnt(9)
    v_mfma_f32_16x16x32_bf16 v[32:35], v[104:107], v[72:75], v[32:35]
    ds_read_b128 v[68:71], v222 offset:320
    v_mfma_f32_16x16x32_bf16 v[32:35], v[108:111], v[76:79], v[32:35]
    ds_read_b128 v[72:75], v222 offset:640
    s_waitcnt lgkmcnt(9)
    v_mfma_f32_16x16x32_bf16 v[32:35], v[112:115], v[80:83], v[32:35]
    ds_read_b128 v[76:79], v222 offset:512
    v_mfma_f32_16x16x32_bf16 v[32:35], v[116:119], v[84:87], v[32:35]
    ds_read_b128 v[80:83], v222 offset:768
    s_waitcnt lgkmcnt(9)
    v_mfma_f32_16x16x32_bf16 v[32:35], v[120:123], v[88:91], v[32:35]
    ds_read_b128 v[84:87], v222 offset:704
    v_mfma_f32_16x16x32_bf16 v[32:35], v[124:127], v[92:95], v[32:35]
    ds_read_b128 v[88:91], v222 offset:576
    s_waitcnt vmcnt(11) lgkmcnt(9)
    v_mfma_f32_16x16x32_bf16 v[4:7], v[128:131], v[48:51], 0
    ds_read_b128 v[92:95], v222 offset:832
    v_mfma_f32_16x16x32_bf16 v[8:11], v[128:131], v[52:55], 0
    ds_read_b128 v[48:51], v222 offset:1024
    s_waitcnt lgkmcnt(9)
    v_mfma_f32_16x16x32_bf16 v[12:15], v[128:131], v[56:59], 0
    ds_read_b128 v[52:55], v222 offset:1280
    s_waitcnt vmcnt(10)
    v_mfma_f32_16x16x32_bf16 v[4:7], v[132:135], v[60:63], v[4:7]
    ds_read_b128 v[56:59], v222 offset:1152
    s_waitcnt lgkmcnt(9)
    v_mfma_f32_16x16x32_bf16 v[8:11], v[132:135], v[64:67], v[8:11]
    ds_read_b128 v[60:63], v222 offset:1088
    v_mfma_f32_16x16x32_bf16 v[12:15], v[132:135], v[68:71], v[12:15]
    ds_read_b128 v[64:67], v222 offset:1344
    s_waitcnt vmcnt(9) lgkmcnt(9)
    v_mfma_f32_16x16x32_bf16 v[4:7], v[136:139], v[72:75], v[4:7]
    ds_read_b128 v[68:71], v222 offset:1216
    v_mfma_f32_16x16x32_bf16 v[8:11], v[136:139], v[76:79], v[8:11]
    ds_read_b128 v[72:75], v223 offset:128
    s_waitcnt lgkmcnt(9)
    v_mfma_f32_16x16x32_bf16 v[12:15], v[136:139], v[80:83], v[12:15]
    ds_read_b128 v[76:79], v223 offset:384
    s_waitcnt vmcnt(8)
    v_mfma_f32_16x16x32_bf16 v[4:7], v[140:143], v[84:87], v[4:7]
    ds_read_b128 v[80:83], v223 offset:256
    s_waitcnt lgkmcnt(9)
    v_mfma_f32_16x16x32_bf16 v[8:11], v[140:143], v[88:91], v[8:11]
    ds_read_b128 v[84:87], v223 offset:192
    v_mfma_f32_16x16x32_bf16 v[12:15], v[140:143], v[92:95], v[12:15]
    ds_read_b128 v[88:91], v223 offset:448
    s_waitcnt vmcnt(7) lgkmcnt(9)
    v_mfma_f32_16x16x32_bf16 v[4:7], v[144:147], v[48:51], v[4:7]
    ds_read_b128 v[92:95], v223 offset:320
    v_mfma_f32_16x16x32_bf16 v[8:11], v[144:147], v[52:55], v[8:11]
    ds_read_b128 v[48:51], v223 offset:640
    s_waitcnt lgkmcnt(9)
    v_mfma_f32_16x16x32_bf16 v[12:15], v[144:147], v[56:59], v[12:15]
    ds_read_b128 v[52:55], v223 offset:512
    s_waitcnt vmcnt(6)
    v_mfma_f32_16x16x32_bf16 v[4:7], v[148:151], v[60:63], v[4:7]
    ds_read_b128 v[56:59], v223 offset:768
    s_waitcnt lgkmcnt(9)
    v_mfma_f32_16x16x32_bf16 v[8:11], v[148:151], v[64:67], v[8:11]
    ds_read_b128 v[60:63], v223 offset:704
    v_mfma_f32_16x16x32_bf16 v[12:15], v[148:151], v[68:71], v[12:15]
    ds_read_b128 v[64:67], v223 offset:576
    s_waitcnt vmcnt(5) lgkmcnt(9)
    v_mfma_f32_16x16x32_bf16 v[4:7], v[152:155], v[72:75], v[4:7]
    ds_read_b128 v[68:71], v223 offset:832
    v_mfma_f32_16x16x32_bf16 v[8:11], v[152:155], v[76:79], v[8:11]
    ds_read_b128 v[72:75], v223 offset:1024
    s_waitcnt lgkmcnt(9)
    v_mfma_f32_16x16x32_bf16 v[12:15], v[152:155], v[80:83], v[12:15]
    ds_read_b128 v[76:79], v223 offset:1280
    s_waitcnt vmcnt(4)
    v_mfma_f32_16x16x32_bf16 v[4:7], v[156:159], v[84:87], v[4:7]
    ds_read_b128 v[80:83], v223 offset:1152
    s_waitcnt lgkmcnt(9)
    v_mfma_f32_16x16x32_bf16 v[8:11], v[156:159], v[88:91], v[8:11]
    ds_read_b128 v[84:87], v223 offset:1088
    v_mfma_f32_16x16x32_bf16 v[12:15], v[156:159], v[92:95], v[12:15]
    ds_read_b128 v[88:91], v223 offset:1344
    s_waitcnt vmcnt(3) lgkmcnt(9)
    v_mfma_f32_16x16x32_bf16 v[4:7], v[160:163], v[48:51], v[4:7]
    ds_read_b128 v[92:95], v223 offset:1216
    v_mfma_f32_16x16x32_bf16 v[8:11], v[160:163], v[52:55], v[8:11]
    ds_read_b128 v[48:51], v222 offset:3200
    s_waitcnt lgkmcnt(9)
    v_mfma_f32_16x16x32_bf16 v[12:15], v[160:163], v[56:59], v[12:15]
    ds_read_b128 v[52:55], v222 offset:3456
    s_waitcnt vmcnt(2)
    v_mfma_f32_16x16x32_bf16 v[4:7], v[164:167], v[60:63], v[4:7]
    ds_read_b128 v[56:59], v222 offset:3328
    s_waitcnt lgkmcnt(9)
    v_mfma_f32_16x16x32_bf16 v[8:11], v[164:167], v[64:67], v[8:11]
    ds_read_b128 v[60:63], v222 offset:3264
    v_mfma_f32_16x16x32_bf16 v[12:15], v[164:167], v[68:71], v[12:15]
    ds_read_b128 v[64:67], v222 offset:3520
    s_waitcnt vmcnt(1) lgkmcnt(9)
    v_mfma_f32_16x16x32_bf16 v[4:7], v[168:171], v[72:75], v[4:7]
    ds_read_b128 v[68:71], v222 offset:3392
    v_mfma_f32_16x16x32_bf16 v[8:11], v[168:171], v[76:79], v[8:11]
    ds_read_b128 v[72:75], v222 offset:3712
    s_waitcnt lgkmcnt(9)
    v_mfma_f32_16x16x32_bf16 v[12:15], v[168:171], v[80:83], v[12:15]
    ds_read_b128 v[76:79], v222 offset:3584
    s_waitcnt vmcnt(0)
    v_mfma_f32_16x16x32_bf16 v[4:7], v[172:175], v[84:87], v[4:7]
    ds_read_b128 v[80:83], v222 offset:3840
    s_waitcnt lgkmcnt(9)
    v_mfma_f32_16x16x32_bf16 v[8:11], v[172:175], v[88:91], v[8:11]
    ds_read_b128 v[84:87], v222 offset:3776
    v_mfma_f32_16x16x32_bf16 v[12:15], v[172:175], v[92:95], v[12:15]
    ds_read_b128 v[88:91], v222 offset:3648
    s_waitcnt lgkmcnt(9)
    v_mfma_f32_16x16x32_bf16 v[20:23], v[128:131], v[48:51], 0
    ds_read_b128 v[92:95], v222 offset:3904
    v_mfma_f32_16x16x32_bf16 v[24:27], v[128:131], v[52:55], 0
    ds_read_b128 v[48:51], v222 offset:4096
    s_waitcnt lgkmcnt(9)
    v_mfma_f32_16x16x32_bf16 v[28:31], v[128:131], v[56:59], 0
    ds_read_b128 v[52:55], v222 offset:4352
    v_mfma_f32_16x16x32_bf16 v[20:23], v[132:135], v[60:63], v[20:23]
    ds_read_b128 v[56:59], v222 offset:4224
    s_waitcnt lgkmcnt(9)
    v_mfma_f32_16x16x32_bf16 v[24:27], v[132:135], v[64:67], v[24:27]
    ds_read_b128 v[60:63], v222 offset:4160
    v_mfma_f32_16x16x32_bf16 v[28:31], v[132:135], v[68:71], v[28:31]
    ds_read_b128 v[64:67], v222 offset:4416
    s_waitcnt lgkmcnt(9)
    v_mfma_f32_16x16x32_bf16 v[20:23], v[136:139], v[72:75], v[20:23]
    ds_read_b128 v[68:71], v222 offset:4288
    v_mfma_f32_16x16x32_bf16 v[24:27], v[136:139], v[76:79], v[24:27]
    ds_read_b128 v[72:75], v223 offset:38528
    s_waitcnt lgkmcnt(9)
    v_mfma_f32_16x16x32_bf16 v[28:31], v[136:139], v[80:83], v[28:31]
    ds_read_b128 v[76:79], v223 offset:38784
    v_mfma_f32_16x16x32_bf16 v[20:23], v[140:143], v[84:87], v[20:23]
    ds_read_b128 v[80:83], v223 offset:38656
    s_waitcnt lgkmcnt(9)
    v_mfma_f32_16x16x32_bf16 v[24:27], v[140:143], v[88:91], v[24:27]
    ds_read_b128 v[84:87], v223 offset:38592
    v_mfma_f32_16x16x32_bf16 v[28:31], v[140:143], v[92:95], v[28:31]
    ds_read_b128 v[88:91], v223 offset:38848
    s_waitcnt lgkmcnt(9)
    v_mfma_f32_16x16x32_bf16 v[20:23], v[144:147], v[48:51], v[20:23]
    ds_read_b128 v[92:95], v223 offset:38720
    v_mfma_f32_16x16x32_bf16 v[24:27], v[144:147], v[52:55], v[24:27]
    ds_read_b128 v[48:51], v223 offset:39040
    s_waitcnt lgkmcnt(9)
    v_mfma_f32_16x16x32_bf16 v[28:31], v[144:147], v[56:59], v[28:31]
    ds_read_b128 v[52:55], v223 offset:38912
    v_mfma_f32_16x16x32_bf16 v[20:23], v[148:151], v[60:63], v[20:23]
    ds_read_b128 v[56:59], v223 offset:39168
    s_waitcnt lgkmcnt(9)
    v_mfma_f32_16x16x32_bf16 v[24:27], v[148:151], v[64:67], v[24:27]
    ds_read_b128 v[60:63], v223 offset:39104
    v_mfma_f32_16x16x32_bf16 v[28:31], v[148:151], v[68:71], v[28:31]
    ds_read_b128 v[64:67], v223 offset:38976
    s_waitcnt lgkmcnt(9)
    v_mfma_f32_16x16x32_bf16 v[20:23], v[152:155], v[72:75], v[20:23]
    ds_read_b128 v[68:71], v223 offset:39232
    v_mfma_f32_16x16x32_bf16 v[24:27], v[152:155], v[76:79], v[24:27]
    ds_read_b128 v[72:75], v223 offset:39424
    s_waitcnt lgkmcnt(9)
    v_mfma_f32_16x16x32_bf16 v[28:31], v[152:155], v[80:83], v[28:31]
    ds_read_b128 v[76:79], v223 offset:39680
    v_mfma_f32_16x16x32_bf16 v[20:23], v[156:159], v[84:87], v[20:23]
    ds_read_b128 v[80:83], v223 offset:39552
    s_waitcnt lgkmcnt(9)
    v_mfma_f32_16x16x32_bf16 v[24:27], v[156:159], v[88:91], v[24:27]
    ds_read_b128 v[84:87], v223 offset:39488
    v_mfma_f32_16x16x32_bf16 v[28:31], v[156:159], v[92:95], v[28:31]
    ds_read_b128 v[88:91], v223 offset:39744
    s_waitcnt lgkmcnt(9)
    v_mfma_f32_16x16x32_bf16 v[20:23], v[160:163], v[48:51], v[20:23]
    ds_read_b128 v[92:95], v223 offset:39616
    v_mfma_f32_16x16x32_bf16 v[24:27], v[160:163], v[52:55], v[24:27]
    ds_read_b128 v[48:51], v247 offset:6272
    s_waitcnt lgkmcnt(9)
    v_mfma_f32_16x16x32_bf16 v[28:31], v[160:163], v[56:59], v[28:31]
    ds_read_b128 v[52:55], v232 offset:6528
    v_mfma_f32_16x16x32_bf16 v[20:23], v[164:167], v[60:63], v[20:23]
    ds_read_b128 v[56:59], v247 offset:6336
    s_waitcnt lgkmcnt(9)
    v_mfma_f32_16x16x32_bf16 v[24:27], v[164:167], v[64:67], v[24:27]
    ds_read_b128 v[60:63], v232 offset:6592
    v_mfma_f32_16x16x32_bf16 v[28:31], v[164:167], v[68:71], v[28:31]
    ds_read_b128 v[64:67], v247 offset:6784
    s_waitcnt lgkmcnt(9)
    v_mfma_f32_16x16x32_bf16 v[20:23], v[168:171], v[72:75], v[20:23]
    ds_read_b128 v[68:71], v232 offset:6656
    v_mfma_f32_16x16x32_bf16 v[24:27], v[168:171], v[76:79], v[24:27]
    ds_read_b128 v[72:75], v247 offset:6848
    s_waitcnt lgkmcnt(9)
    v_mfma_f32_16x16x32_bf16 v[28:31], v[168:171], v[80:83], v[28:31]
    ds_read_b128 v[76:79], v232 offset:6720
    v_mfma_f32_16x16x32_bf16 v[20:23], v[172:175], v[84:87], v[20:23]
    ds_read_b128 v[80:83], v247 offset:7168
    s_waitcnt lgkmcnt(9)
    v_mfma_f32_16x16x32_bf16 v[24:27], v[172:175], v[88:91], v[24:27]
    ds_read_b128 v[84:87], v232 offset:7424
    v_mfma_f32_16x16x32_bf16 v[28:31], v[172:175], v[92:95], v[28:31]
    ds_read_b128 v[88:91], v247 offset:7232
    s_waitcnt lgkmcnt(9)
    v_mfma_f32_16x16x32_bf16 v[36:39], v[128:131], v[48:51], 0
    ds_read_b128 v[92:95], v232 offset:7488
    v_mfma_f32_16x16x32_bf16 v[40:43], v[128:131], v[52:55], 0
    ds_read_b128 v[48:51], v248 offset:128
    s_waitcnt lgkmcnt(9)
    v_mfma_f32_16x16x32_bf16 v[36:39], v[132:135], v[56:59], v[36:39]
    ds_read_b128 v[52:55], v225 offset:384
    v_mfma_f32_16x16x32_bf16 v[40:43], v[132:135], v[60:63], v[40:43]
    ds_read_b128 v[56:59], v248 offset:192
    s_waitcnt lgkmcnt(9)
    v_mfma_f32_16x16x32_bf16 v[36:39], v[136:139], v[64:67], v[36:39]
    ds_read_b128 v[60:63], v225 offset:448
    v_mfma_f32_16x16x32_bf16 v[40:43], v[136:139], v[68:71], v[40:43]
    ds_read_b128 v[64:67], v248 offset:640
    s_waitcnt lgkmcnt(9)
    v_mfma_f32_16x16x32_bf16 v[36:39], v[140:143], v[72:75], v[36:39]
    ds_read_b128 v[68:71], v225 offset:512
    v_mfma_f32_16x16x32_bf16 v[40:43], v[140:143], v[76:79], v[40:43]
    ds_read_b128 v[72:75], v248 offset:704
    s_waitcnt lgkmcnt(9)
    v_mfma_f32_16x16x32_bf16 v[36:39], v[144:147], v[80:83], v[36:39]
    ds_read_b128 v[76:79], v225 offset:576
    v_mfma_f32_16x16x32_bf16 v[40:43], v[144:147], v[84:87], v[40:43]
    ds_read_b128 v[80:83], v248 offset:1024
    s_waitcnt lgkmcnt(9)
    v_mfma_f32_16x16x32_bf16 v[36:39], v[148:151], v[88:91], v[36:39]
    ds_read_b128 v[84:87], v225 offset:1280
    v_mfma_f32_16x16x32_bf16 v[40:43], v[148:151], v[92:95], v[40:43]
    ds_read_b128 v[88:91], v248 offset:1088
    s_waitcnt lgkmcnt(9)
    v_mfma_f32_16x16x32_bf16 v[36:39], v[152:155], v[48:51], v[36:39]
    ds_read_b128 v[92:95], v225 offset:1344
    v_mfma_f32_16x16x32_bf16 v[40:43], v[152:155], v[52:55], v[40:43]
    s_waitcnt lgkmcnt(8)
    v_mfma_f32_16x16x32_bf16 v[36:39], v[156:159], v[56:59], v[36:39]
    v_mfma_f32_16x16x32_bf16 v[40:43], v[156:159], v[60:63], v[40:43]
    s_waitcnt lgkmcnt(6)
    v_mfma_f32_16x16x32_bf16 v[36:39], v[160:163], v[64:67], v[36:39]
    v_mfma_f32_16x16x32_bf16 v[40:43], v[160:163], v[68:71], v[40:43]
    s_waitcnt lgkmcnt(4)
    v_mfma_f32_16x16x32_bf16 v[36:39], v[164:167], v[72:75], v[36:39]
    v_mfma_f32_16x16x32_bf16 v[40:43], v[164:167], v[76:79], v[40:43]
    s_waitcnt lgkmcnt(2)
    v_mfma_f32_16x16x32_bf16 v[36:39], v[168:171], v[80:83], v[36:39]
    v_mfma_f32_16x16x32_bf16 v[40:43], v[168:171], v[84:87], v[40:43]
    s_waitcnt lgkmcnt(0)
    v_mfma_f32_16x16x32_bf16 v[36:39], v[172:175], v[88:91], v[36:39]
    v_mfma_f32_16x16x32_bf16 v[40:43], v[172:175], v[92:95], v[40:43]
    s_lshl_b32 s60, s54, 9
    s_lshl_b32 s61, s20, 6
    s_add_u32 s60, s60, s61
    s_mul_i32 s60, s60, 192
    s_add_u32 s60, s60, 10485760
    v_mul_u32_u24 v227, 96, v252
    s_cmp_lg_u32 s28, 0
    s_cbranch_scc1 K2_NOACC
    buffer_load_dwordx4 v[48:51], v227, s[8:11], s60 offen offset:0
    buffer_load_dwordx4 v[52:55], v227, s[8:11], s60 offen offset:16
    buffer_load_dwordx4 v[56:59], v227, s[8:11], s60 offen offset:32
    buffer_load_dwordx4 v[60:63], v227, s[8:11], s60 offen offset:48
    buffer_load_dwordx4 v[64:67], v227, s[8:11], s60 offen offset:64
    buffer_load_dwordx4 v[68:71], v227, s[8:11], s60 offen offset:80
    buffer_load_dwordx4 v[72:75], v227, s[8:11], s60 offen offset:96
    buffer_load_dwordx4 v[76:79], v227, s[8:11], s60 offen offset:112
    buffer_load_dwordx4 v[80:83], v227, s[8:11], s60 offen offset:128
    buffer_load_dwordx4 v[84:87], v227, s[8:11], s60 offen offset:144
    buffer_load_dwordx4 v[88:91], v227, s[8:11], s60 offen offset:160
    s_waitcnt vmcnt(0)
    v_add_f32 v0, v0, v48
    v_add_f32 v1, v1, v49
    v_add_f32 v2, v2, v50
    v_add_f32 v3, v3, v51
    v_add_f32 v4, v4, v52
    v_add_f32 v5, v5, v53
    v_add_f32 v6, v6, v54
    v_add_f32 v7, v7, v55
    v_add_f32 v8, v8, v56
    v_add_f32 v9, v9, v57
    v_add_f32 v10, v10, v58
    v_add_f32 v11, v11, v59
    v_add_f32 v12, v12, v60
    v_add_f32 v13, v13, v61
    v_add_f32 v14, v14, v62
    v_add_f32 v15, v15, v63
    v_add_f32 v16, v16, v64
    v_add_f32 v17, v17, v65
    v_add_f32 v18, v18, v66
    v_add_f32 v19, v19, v67
    v_add_f32 v20, v20, v68
    v_add_f32 v21, v21, v69
    v_add_f32 v22, v22, v70
    v_add_f32 v23, v23, v71
    v_add_f32 v24, v24, v72
    v_add_f32 v25, v25, v73
    v_add_f32 v26, v26, v74
    v_add_f32 v27, v27, v75
    v_add_f32 v28, v28, v76
    v_add_f32 v29, v29, v77
    v_add_f32 v30, v30, v78
    v_add_f32 v31, v31, v79
    v_add_f32 v32, v32, v80
    v_add_f32 v33, v33, v81
    v_add_f32 v34, v34, v82
    v_add_f32 v35, v35, v83
    v_add_f32 v36, v36, v84
    v_add_f32 v37, v37, v85
    v_add_f32 v38, v38, v86
    v_add_f32 v39, v39, v87
    v_add_f32 v40, v40, v88
    v_add_f32 v41, v41, v89
    v_add_f32 v42, v42, v90
    v_add_f32 v43, v43, v91
K2_NOACC:
    s_barrier
    s_cmp_eq_u32 s55, 0
    s_cbranch_scc1 K2_SPILL
    s_bfe_u32 s60, s20, 0x10002
    s_lshl_b32 s60, s60, 4
    s_add_u32 s59, s59, s60
    v_add_u32 v228, s59, v229
    s_mul_i32 s60, s20, 2400
    s_add_u32 s60, s60, 65536
    v_add_u32 v249, s60, v229
    s_mov_b32 s63, 0xbfb8aa3b
    s_add_u32 s40, s20, s21
    s_lshl_b32 s40, s40, 10
    s_add_u32 s41, s40, 8192
    s_add_u32 s42, s40, 16384
    s_add_u32 s43, s40, 24576
    s_add_u32 s44, s40, 32768
    v_mul_f32 v204, s63, v0
    v_mul_f32 v205, s63, v1
    v_mul_f32 v206, s63, v2
    v_mul_f32 v207, s63, v3
    v_exp_f32 v204, v204
    v_exp_f32 v205, v205
    v_exp_f32 v206, v206
    v_exp_f32 v207, v207
    v_add_f32 v204, 1.0, v204
    v_add_f32 v205, 1.0, v205
    v_add_f32 v206, 1.0, v206
    v_add_f32 v207, 1.0, v207
    v_rcp_f32 v204, v204
    v_rcp_f32 v205, v205
    v_rcp_f32 v206, v206
    v_rcp_f32 v207, v207
    v_cvt_pk_bf16_f32 v176, v0, v1
    v_cvt_pk_bf16_f32 v177, v2, v3
    v_mul_f32 v4, v4, v204
    v_mul_f32 v5, v5, v205
    v_mul_f32 v6, v6, v206
    v_mul_f32 v7, v7, v207
    v_cvt_pk_bf16_f32 v178, v4, v5
    v_cvt_pk_bf16_f32 v179, v6, v7
    v_mul_f32 v8, v8, v204
    v_mul_f32 v9, v9, v205
    v_mul_f32 v10, v10, v206
    v_mul_f32 v11, v11, v207
    v_cvt_pk_bf16_f32 v180, v8, v9
    v_cvt_pk_bf16_f32 v181, v10, v11
    v_mul_f32 v12, v12, v204
    v_mul_f32 v13, v13, v205
    v_mul_f32 v14, v14, v206
    v_mul_f32 v15, v15, v207
    v_cvt_pk_bf16_f32 v182, v12, v13
    v_cvt_pk_bf16_f32 v183, v14, v15
    ds_write_b64 v254, v[176:177] offset:0
    ds_write_b64 v254, v[178:179] offset:256
    ds_write_b64 v254, v[180:181] offset:512
    ds_write_b64 v254, v[182:183] offset:768
    s_waitcnt lgkmcnt(0)
    s_barrier
    ds_read_b128 v[192:195], v228 offset:0
    ds_read_b128 v[196:199], v228 offset:1536
    s_waitcnt lgkmcnt(0)
    buffer_store_dwordx4 v[192:195], v229, s[12:15], s40 offen sc1
    buffer_store_dwordx4 v[196:199], v229, s[12:15], s41 offen sc1
    v_mul_f32 v208, s63, v16
    v_mul_f32 v209, s63, v17
    v_mul_f32 v210, s63, v18
    v_mul_f32 v211, s63, v19
    v_exp_f32 v208, v208
    v_exp_f32 v209, v209
    v_exp_f32 v210, v210
    v_exp_f32 v211, v211
    v_add_f32 v208, 1.0, v208
    v_add_f32 v209, 1.0, v209
    v_add_f32 v210, 1.0, v210
    v_add_f32 v211, 1.0, v211
    v_rcp_f32 v208, v208
    v_rcp_f32 v209, v209
    v_rcp_f32 v210, v210
    v_rcp_f32 v211, v211
    v_cvt_pk_bf16_f32 v184, v16, v17
    v_cvt_pk_bf16_f32 v185, v18, v19
    v_mul_f32 v20, v20, v208
    v_mul_f32 v21, v21, v209
    v_mul_f32 v22, v22, v210
    v_mul_f32 v23, v23, v211
    v_cvt_pk_bf16_f32 v186, v20, v21
    v_cvt_pk_bf16_f32 v187, v22, v23
    v_mul_f32 v24, v24, v208
    v_mul_f32 v25, v25, v209
    v_mul_f32 v26, v26, v210
    v_mul_f32 v27, v27, v211
    v_cvt_pk_bf16_f32 v188, v24, v25
    v_cvt_pk_bf16_f32 v189, v26, v27
    v_mul_f32 v28, v28, v208
    v_mul_f32 v29, v29, v209
    v_mul_f32 v30, v30, v210
    v_mul_f32 v31, v31, v211
    v_cvt_pk_bf16_f32 v190, v28, v29
    v_cvt_pk_bf16_f32 v191, v30, v31
    ds_write_b64 v254, v[184:185] offset:3072
    ds_write_b64 v254, v[186:187] offset:3328
    ds_write_b64 v254, v[188:189] offset:3584
    ds_write_b64 v254, v[190:191] offset:3840
    s_waitcnt lgkmcnt(0)
    s_barrier
    ds_read_b128 v[192:195], v228 offset:3072
    ds_read_b128 v[196:199], v228 offset:4608
    s_waitcnt lgkmcnt(0)
    buffer_store_dwordx4 v[192:195], v229, s[12:15], s42 offen sc1
    buffer_store_dwordx4 v[196:199], v229, s[12:15], s43 offen sc1
    v_mul_f32 v212, s63, v32
    v_mul_f32 v213, s63, v33
    v_mul_f32 v214, s63, v34
    v_mul_f32 v215, s63, v35
    v_exp_f32 v212, v212
    v_exp_f32 v213, v213
    v_exp_f32 v214, v214
    v_exp_f32 v215, v215
    v_add_f32 v212, 1.0, v212
    v_add_f32 v213, 1.0, v213
    v_add_f32 v214, 1.0, v214
    v_add_f32 v215, 1.0, v215
    v_rcp_f32 v212, v212
    v_rcp_f32 v213, v213
    v_rcp_f32 v214, v214
    v_rcp_f32 v215, v215
    v_cvt_pk_bf16_f32 v220, v32, v33
    v_cvt_pk_bf16_f32 v221, v34, v35
    v_mul_f32 v36, v36, v212
    v_mul_f32 v37, v37, v213
    v_mul_f32 v38, v38, v214
    v_mul_f32 v39, v39, v215
    v_cvt_pk_bf16_f32 v178, v36, v37
    v_cvt_pk_bf16_f32 v179, v38, v39
    v_mul_f32 v40, v40, v212
    v_mul_f32 v41, v41, v213
    v_mul_f32 v42, v42, v214
    v_mul_f32 v43, v43, v215
    v_cvt_pk_bf16_f32 v180, v40, v41
    v_cvt_pk_bf16_f32 v181, v42, v43
    ds_write_b64 v255, v[220:221] offset:0
    ds_write_b64 v246, v[178:179] offset:256
    ds_write_b64 v255, v[180:181] offset:512
    s_waitcnt lgkmcnt(0)
    s_barrier
    ds_read_b128 v[200:203], v249
    s_branch K2_LASTROW
K2_SPILL:
    buffer_store_dwordx4 v[0:3], v227, s[8:11], s60 offen offset:0
    buffer_store_dwordx4 v[4:7], v227, s[8:11], s60 offen offset:16
    buffer_store_dwordx4 v[8:11], v227, s[8:11], s60 offen offset:32
    buffer_store_dwordx4 v[12:15], v227, s[8:11], s60 offen offset:48
    buffer_store_dwordx4 v[16:19], v227, s[8:11], s60 offen offset:64
    buffer_store_dwordx4 v[20:23], v227, s[8:11], s60 offen offset:80
    buffer_store_dwordx4 v[24:27], v227, s[8:11], s60 offen offset:96
    buffer_store_dwordx4 v[28:31], v227, s[8:11], s60 offen offset:112
    buffer_store_dwordx4 v[32:35], v227, s[8:11], s60 offen offset:128
    buffer_store_dwordx4 v[36:39], v227, s[8:11], s60 offen offset:144
    buffer_store_dwordx4 v[40:43], v227, s[8:11], s60 offen offset:160
    s_mov_b32 s28, 0
    s_waitcnt vmcnt(0)
    s_cmp_lt_u32 s24, s25
    s_cbranch_scc1 K2_LOAD
    s_add_u32 s23, s23, 20
    s_branch K2_WINDOW
K2_WINDOW:
    s_mov_b32 s24, 0
    s_mov_b32 s25, 1
K2_LOAD:
    v_mbcnt_lo_u32_b32 v176, -1, 0
    v_mbcnt_hi_u32_b32 v176, -1, v176
    s_lshl_b32 s58, s20, 6
    v_add_u32 v177, s58, v176
    v_lshlrev_b32 v70, 4, v176
    s_mov_b32 s58, 7110656
    buffer_load_dwordx4 v[136:139], v70, s[8:11], s58 offen offset:0 sc1
    buffer_load_dwordx4 v[140:143], v70, s[8:11], s58 offen offset:1024 sc1
    s_mov_b32 s58, 7112704
    buffer_load_dwordx4 v[144:147], v70, s[8:11], s58 offen offset:0 sc1
    buffer_load_dwordx4 v[148:151], v70, s[8:11], s58 offen offset:1024 sc1
    s_mov_b32 s58, 7114752
    buffer_load_dwordx4 v[152:155], v70, s[8:11], s58 offen offset:0 sc1
    buffer_load_dwordx4 v[156:159], v70, s[8:11], s58 offen offset:1024 sc1
    s_mov_b32 s58, 7116800
    buffer_load_dwordx4 v[160:163], v70, s[8:11], s58 offen offset:0 sc1
    buffer_load_dwordx4 v[164:167], v70, s[8:11], s58 offen offset:1024 sc1
    s_mov_b32 s58, 7118848
    buffer_load_dwordx4 v[168:171], v70, s[8:11], s58 offen offset:0 sc1
    buffer_load_dwordx4 v[172:175], v70, s[8:11], s58 offen offset:1024 sc1
    v_mul_u32_u24 v76, 437, v177
    v_lshrrev_b32 v76, 16, v76
    v_mul_u32_u24 v76, 150, v76
    v_sub_u32 v76, v177, v76
    v_mov_b32 v80, -1
    v_mov_b32 v77, 1.0
    v_cmp_gt_u32 vcc, 48, v76
    v_lshlrev_b32 v78, 4, v177
    v_add_u32 v78, 65536, v78
    v_cndmask_b32 v80, v80, 0, vcc
    v_cmp_gt_u32 vcc, 12, v76
    v_add_u32 v79, 64800, v78
    s_nop 0
    v_cndmask_b32 v80, v80, v77, vcc
    v_cmp_gt_u32 vcc, 450, v177
    v_mov_b32 v81, v80
    v_mov_b32 v82, v80
    v_mov_b32 v83, v80
    s_mov_b64 exec, vcc
    ds_write_b128 v78, v[80:83] offset:0
    ds_write_b128 v78, v[80:83] offset:7200
    ds_write_b128 v78, v[80:83] offset:14400
    ds_write_b128 v78, v[80:83] offset:21600
    ds_write_b128 v78, v[80:83] offset:28800
    ds_write_b128 v78, v[80:83] offset:36000
    ds_write_b128 v78, v[80:83] offset:43200
    ds_write_b128 v78, v[80:83] offset:50400
    ds_write_b128 v78, v[80:83] offset:57600
    ds_write_b128 v79, v[80:83] offset:0
    ds_write_b128 v79, v[80:83] offset:7200
    ds_write_b128 v79, v[80:83] offset:14400
    ds_write_b128 v79, v[80:83] offset:21600
    v_cmp_gt_u32 vcc, 268, v177
    s_nop 0
    s_cbranch_vccz K2_NOCL
    s_mov_b64 exec, vcc
    ds_write_b128 v79, v[80:83] offset:28800
K2_NOCL:
    s_mov_b64 exec, -1
    s_cmp_lg_u32 s20, 7
    s_cbranch_scc1 K2_NOH
    v_mov_b32 v76, 0
    v_mov_b32 v77, -1
    v_lshlrev_b32 v78, 2, v176
    v_add_u32 v78, 163424, v78
    s_mov_b64 exec, 0x1ff
    ds_write_b32 v78, v76 offset:192
    s_mov_b64 exec, 0xff
    ds_write_b32 v78, v77 offset:256
    s_mov_b64 exec, -1
    s_cmp_lg_u32 s24, 0
    s_cbranch_scc1 K2_NOH
    s_mov_b32 exec_hi, 0xffff
    ds_write_b32 v78, v76
    s_mov_b64 exec, 0x3f
    ds_write_b32 v78, v76 offset:228
    s_mov_b64 exec, -1
K2_NOH:
    s_waitcnt lgkmcnt(0)
    s_barrier
    s_branch K2_CELLS
K2_LD_GEN:
    s_mov_b64 exec, s[42:43]
    s_cbranch_execz K2_LD_DONE
    buffer_load_dwordx4 v[4:7], v182, s[8:11], 0 offen sc1
    s_mov_b64 exec, s[44:45]
    s_cbranch_execz K2_LD_DONE
    buffer_load_dwordx4 v[8:11], v183, s[8:11], 0 offen sc1
    s_mov_b64 exec, s[46:47]
    s_cbranch_execz K2_LD_DONE
    buffer_load_dwordx4 v[12:15], v184, s[8:11], 0 offen sc1
    s_mov_b64 exec, s[48:49]
    s_cbranch_execz K2_LD_DONE
    buffer_load_dwordx4 v[16:19], v181, s[8:11], 0 offen offset:128 sc1
    s_mov_b64 exec, s[50:51]
    s_cbranch_execz K2_LD_DONE
    buffer_load_dwordx4 v[20:23], v181, s[8:11], 0 offen offset:160 sc1
    s_mov_b64 exec, s[90:91]
    s_cbranch_execz K2_LD_DONE
    buffer_load_dwordx4 v[24:27], v181, s[8:11], 0 offen offset:192 sc1
    s_mov_b64 exec, s[92:93]
    s_cbranch_execz K2_LD_DONE
    buffer_load_dwordx4 v[28:31], v181, s[8:11], 0 offen offset:224 sc1
    s_mov_b64 exec, s[94:95]
    s_cbranch_execz K2_LD_DONE
    buffer_load_dwordx4 v[32:35], v181, s[8:11], 0 offen offset:256 sc1
    s_mov_b64 exec, s[96:97]
    s_cbranch_execz K2_LD_DONE
    buffer_load_dwordx4 v[36:39], v181, s[8:11], 0 offen offset:288 sc1
    s_branch K2_LD_DONE
K2_WLATE:
    s_waitcnt vmcnt(0)
    s_branch K2_WUNP
K2_FLGLD:
    buffer_load_dwordx4 v[84:87], v72, s[8:11], s64 offen sc1
    s_mov_b32 s62, 0
    s_branch K2_FLGL2
K2_FLGCK:
    s_cmp_lg_u32 s24, 0
    s_cbranch_scc1 K2_FLGOK
    s_waitcnt vmcnt(0)
K2_FLGW:
    v_xor_b32 v84, s2, v84
    v_xor_b32 v85, s2, v85
    v_xor_b32 v86, s2, v86
    v_xor_b32 v87, s2, v87
    v_or3_b32 v84, v84, v85, v86
    v_or_b32 v84, v84, v87
    v_cmp_ne_u32 vcc, 0, v84
    s_nop 0
    s_cbranch_vccz K2_FLGY
    s_sub_u32 s60, s60, 1
    s_cbranch_scc1 K2_END
    buffer_load_dwordx4 v[84:87], v72, s[8:11], s64 offen sc1
    s_waitcnt vmcnt(0)
    s_branch K2_FLGW
K2_FLGY:
    s_cmp_lg_u32 s54, 0
    s_cbranch_scc1 K2_FLGOK
    v_mov_b32 v84, s2
    v_mov_b32 v85, 7178240
    s_mov_b64 exec, 1
    buffer_store_dword v84, v85, s[8:11], 0 offen sc1
    s_mov_b64 exec, -1
    s_branch K2_FLGOK
K2_RT0:
    s_sub_u32 s60, s60, 1
    s_cbranch_scc1 K2_END
    buffer_load_dwordx4 v[0:3], v181, s[8:11], 0 offen offset:0 sc1
    s_waitcnt vmcnt(0)
    s_branch K2_CK0
K2_RT1:
    s_sub_u32 s60, s60, 1
    s_cbranch_scc1 K2_END
    buffer_load_dwordx4 v[4:7], v182, s[8:11], 0 offen sc1
    s_waitcnt vmcnt(0)
    s_branch K2_CK1
K2_RT2:
    s_sub_u32 s60, s60, 1
    s_cbranch_scc1 K2_END
    buffer_load_dwordx4 v[8:11], v183, s[8:11], 0 offen sc1
    s_waitcnt vmcnt(0)
    s_branch K2_CK2
K2_RT3:
    s_sub_u32 s60, s60, 1
    s_cbranch_scc1 K2_END
    buffer_load_dwordx4 v[12:15], v184, s[8:11], 0 offen sc1
    s_waitcnt vmcnt(0)
    s_branch K2_CK3
K2_RT4:
    s_sub_u32 s60, s60, 1
    s_cbranch_scc1 K2_END
    buffer_load_dwordx4 v[16:19], v181, s[8:11], 0 offen offset:128 sc1
    s_waitcnt vmcnt(0)
    s_branch K2_CK4
K2_RT5:
    s_sub_u32 s60, s60, 1
    s_cbranch_scc1 K2_END
    buffer_load_dwordx4 v[20:23], v181, s[8:11], 0 offen offset:160 sc1
    s_waitcnt vmcnt(0)
    s_branch K2_CK5
K2_RT6:
    s_sub_u32 s60, s60, 1
    s_cbranch_scc1 K2_END
    buffer_load_dwordx4 v[24:27], v181, s[8:11], 0 offen offset:192 sc1
    s_waitcnt vmcnt(0)
    s_branch K2_CK6
K2_RT7:
    s_sub_u32 s60, s60, 1
    s_cbranch_scc1 K2_END
    buffer_load_dwordx4 v[28:31], v181, s[8:11], 0 offen offset:224 sc1
    s_waitcnt vmcnt(0)
    s_branch K2_CK7
K2_RT8:
    s_sub_u32 s60, s60, 1
    s_cbranch_scc1 K2_END
    buffer_load_dwordx4 v[32:35], v181, s[8:11], 0 offen offset:256 sc1
    s_waitcnt vmcnt(0)
    s_branch K2_CK8
K2_RT9:
    s_sub_u32 s60, s60, 1
    s_cbranch_scc1 K2_END
    buffer_load_dwordx4 v[36:39], v181, s[8:11], 0 offen offset:288 sc1
    s_waitcnt vmcnt(0)
    s_branch K2_CK9
K2_RK_LOAD:
    s_waitcnt vmcnt(0)
    s_mov_b64 exec, s[40:41]
    s_cbranch_execz K2_RK_B
    v_lshrrev_b32 v50, 24, v3
    buffer_load_dword v40, v179, s[8:11], s66 offen offset:0
    v_mad_u32_u24 v50, v50, s58, v202
    v_and_b32 v3, 0xffffff, v3
    s_mov_b64 exec, s[42:43]
    s_cbranch_execz K2_RK_B
    v_lshrrev_b32 v51, 24, v7
    buffer_load_dword v41, v185, s[8:11], s66 offen
    v_mad_u32_u24 v51, v51, s58, v202
    v_and_b32 v7, 0xffffff, v7
    s_mov_b64 exec, s[44:45]
    s_cbranch_execz K2_RK_B
    v_lshrrev_b32 v52, 24, v11
    buffer_load_dword v42, v186, s[8:11], s66 offen
    v_mad_u32_u24 v52, v52, s58, v202
    v_and_b32 v11, 0xffffff, v11
    s_mov_b64 exec, s[46:47]
    s_cbranch_execz K2_RK_B
    v_lshrrev_b32 v53, 24, v15
    buffer_load_dword v43, v187, s[8:11], s66 offen
    v_mad_u32_u24 v53, v53, s58, v202
    v_and_b32 v15, 0xffffff, v15
    s_mov_b64 exec, s[48:49]
    s_cbranch_execz K2_RK_B
    v_lshrrev_b32 v54, 24, v19
    buffer_load_dword v44, v179, s[8:11], s66 offen offset:32
    v_mad_u32_u24 v54, v54, s58, v202
    v_and_b32 v19, 0xffffff, v19
    s_mov_b64 exec, s[50:51]
    s_cbranch_execz K2_RK_B
    v_lshrrev_b32 v55, 24, v23
    buffer_load_dword v45, v179, s[8:11], s66 offen offset:40
    v_mad_u32_u24 v55, v55, s58, v202
    v_and_b32 v23, 0xffffff, v23
    s_mov_b64 exec, s[90:91]
    s_cbranch_execz K2_RK_B
    v_lshrrev_b32 v56, 24, v27
    buffer_load_dword v46, v179, s[8:11], s66 offen offset:48
    v_mad_u32_u24 v56, v56, s58, v202
    v_and_b32 v27, 0xffffff, v27
    s_mov_b64 exec, s[92:93]
    s_cbranch_execz K2_RK_B
    v_lshrrev_b32 v57, 24, v31
    buffer_load_dword v47, v179, s[8:11], s66 offen offset:56
    v_mad_u32_u24 v57, v57, s58, v202
    v_and_b32 v31, 0xffffff, v31
    s_mov_b64 exec, s[94:95]
    s_cbranch_execz K2_RK_B
    v_lshrrev_b32 v58, 24, v35
    buffer_load_dword v48, v179, s[8:11], s66 offen offset:64
    v_mad_u32_u24 v58, v58, s58, v202
    v_and_b32 v35, 0xffffff, v35
    s_mov_b64 exec, s[96:97]
    s_cbranch_execz K2_RK_B
    v_lshrrev_b32 v59, 24, v39
    buffer_load_dword v49, v179, s[8:11], s66 offen offset:72
    v_mad_u32_u24 v59, v59, s58, v202
    v_and_b32 v39, 0xffffff, v39
K2_RK_B:
    s_mov_b64 exec, -1
    s_mul_i32 s62, s24, 48
    s_waitcnt vmcnt(0)
    v_subrev_u32 v40, s62, v40
    v_subrev_u32 v41, s62, v41
    v_subrev_u32 v42, s62, v42
    v_subrev_u32 v43, s62, v43
    v_subrev_u32 v44, s62, v44
    v_subrev_u32 v45, s62, v45
    v_subrev_u32 v46, s62, v46
    v_subrev_u32 v47, s62, v47
    v_subrev_u32 v48, s62, v48
    v_subrev_u32 v49, s62, v49
    s_branch K2_RK_DONE
K2_PAD_OV:
    s_branch K2_HOP
K2_OV:
    s_cmp_lg_u32 s24, 0
    s_cbranch_scc1 K2_OB
    s_cmp_eq_u32 s22, 39
    s_cselect_b32 s63, 5, 2
    s_flbit_i32_b32 s56, s58
    s_sub_u32 s56, 31, s56
    s_bitset0_b32 s58, s56
    s_sub_u32 s57, s56, 1
    v_mov_b32 v198, 0
    v_mov_b32 v206, s57
K2_OVL:
    s_mov_b64 exec, -1
    s_ff1_i32_b32 s61, s58
    s_bitset0_b32 s58, s61
    v_readfirstlane_b32 s62, v206
    s_nop 0
    s_sub_u32 s62, s62, s61
    s_lshl_b32 s61, s62, 1
    v_cmp_lt_i32 vcc, s61, v180
    s_cmp_eq_u32 s62, 1
    s_cselect_b64 vcc, s[42:43], vcc
    s_cmp_eq_u32 s62, 2
    s_cselect_b64 vcc, s[44:45], vcc
    s_cmp_eq_u32 s62, 3
    s_cselect_b64 vcc, s[46:47], vcc
    s_lshl_b32 s61, s62, 2
    s_set_gpr_idx_on s62, gpr_idx(SRC0)
    s_nop 0
    v_mov_b32 v204, v40
    v_mov_b32 v205, v50
    s_set_gpr_idx_idx s61
    s_nop 0
    v_mov_b32 v208, v0
    v_mov_b32 v209, v1
    v_mov_b32 v210, v2
    v_mov_b32 v211, v3
    s_set_gpr_idx_off
    s_mov_b64 exec, vcc
    v_subrev_u32 v192, 48, v204
    v_mov_b32 v197, 163656
    v_cmp_gt_u32 vcc, 16, v192
    s_mov_b32 s62, 0
    s_mov_b64 exec, vcc
    s_cbranch_execz K2_OVN
K2_OP:
    ds_cmpst_rtn_b32 v200, v197, v198, v205
    s_cmp_ge_u32 s62, 2
    s_cselect_b32 s65, 2400, 0
    s_cselect_b32 s26, 32, 0
    s_sub_u32 s65, 161536, s65
    s_lshl_b32 s61, s62, 4
    s_sub_u32 s61, s61, s26
    v_mov_b32 v199, s65
    v_add_u32 v203, s61, v192
    s_waitcnt lgkmcnt(0)
    v_cmp_eq_u32 vcc, 0, v200
    v_cmp_eq_u32 s[56:57], v200, v205
    s_nop 0
    s_or_b64 vcc, vcc, s[56:57]
    s_andn2_b64 s[56:57], exec, vcc
    s_mov_b64 exec, vcc
    v_lshl_add_u32 v194, v203, 5, v199
    v_lshl_add_u32 v195, v203, 2, v199
    v_lshrrev_b32 v193, 3, v203
    v_mad_i32_i24 v196, v193, -16, v195
    v_and_b32 v193, 1, v193
    v_mad_i32_i24 v196, v193, -14, v196
    ds_write_b32 v194, v211 offset:864
    ds_write_b16 v195, v208 offset:194
    ds_write_b16_d16_hi v195, v208 offset:386
    ds_write_b16_d16_hi v195, v209 offset:578
    ds_write_b16 v196, v210 offset:768
    s_mov_b64 exec, s[56:57]
    s_cbranch_execz K2_OVN
    v_add_u32 v197, 4, v197
    s_add_u32 s62, s62, 1
    s_cmp_lt_u32 s62, s63
    s_cbranch_scc1 K2_OP
K2_OVN:
    s_cmp_lg_u32 s58, 0
    s_cbranch_scc1 K2_OVL
    s_mov_b64 exec, -1
    s_branch K2_OB
K2_BIG:
    s_cmp_lg_u32 s24, 0
    s_cbranch_scc1 K2_TOK
    s_mov_b64 s[62:63], vcc
    s_bcnt1_i32_b64 s60, vcc
    s_cmp_eq_u32 s22, 39
    s_cselect_b32 s61, 5, 2
    s_cmp_gt_u32 s60, s61
    s_cbranch_scc1 K2_SLOW
    v_cmp_lt_u32 vcc, 64, v193
    s_nop 0
    s_cbranch_vccnz K2_SLOW
    v_mov_b32 v197, 163656
    ds_read_b32 v203, v197
    ds_read_b32 v204, v197 offset:4
    ds_read_b32 v205, v197 offset:8
    ds_read_b32 v206, v197 offset:12
    ds_read_b32 v207, v197 offset:16
    v_and_b32 v197, 0x3ffff, v195
    s_movk_i32 s26, 64
    s_waitcnt lgkmcnt(0)
    v_cmp_eq_u32 vcc, v204, v197
    v_mov_b32 v194, 134217728
    s_nop 0
    v_cndmask_b32 v198, v198, v194, vcc
    v_cmp_eq_u32 vcc, v205, v197
    v_mov_b32 v194, 268435456
    s_nop 0
    v_cndmask_b32 v198, v198, v194, vcc
    v_cmp_eq_u32 vcc, v206, v197
    v_mov_b32 v194, 402653184
    s_nop 0
    v_cndmask_b32 v198, v198, v194, vcc
    v_cmp_eq_u32 vcc, v207, v197
    v_mov_b32 v194, 536870912
    s_nop 0
    v_cndmask_b32 v198, v198, v194, vcc
    s_branch K2_TOK
K2_SLOW:
    v_mov_b32 v197, v193
    s_nop 1
    v_max_u32_dpp v197, v197, v197 row_shr:1 row_mask:0xf bank_mask:0xf bound_ctrl:0
    s_nop 1
    v_max_u32_dpp v197, v197, v197 row_shr:2 row_mask:0xf bank_mask:0xf bound_ctrl:0
    s_nop 1
    v_max_u32_dpp v197, v197, v197 row_shr:4 row_mask:0xf bank_mask:0xf bound_ctrl:0
    s_nop 1
    v_max_u32_dpp v197, v197, v197 row_shr:8 row_mask:0xf bank_mask:0xf bound_ctrl:0
    s_nop 1
    v_max_u32_dpp v197, v197, v197 row_bcast:15 row_mask:0xa bank_mask:0xf
    s_nop 1
    v_max_u32_dpp v197, v197, v197 row_bcast:31 row_mask:0xc bank_mask:0xf
    s_nop 0
    v_readlane_b32 s25, v197, 63
    s_nop 0
    s_add_u32 s25, s25, 47
    s_mul_i32 s25, s25, 43691
    s_lshr_b32 s25, s25, 21
    s_mov_b64 exec, s[40:41]
    s_cbranch_execz K2_SV_DONE
    buffer_store_dword v40, v179, s[8:11], s66 offen offset:0
    s_mov_b64 exec, s[42:43]
    s_cbranch_execz K2_SV_DONE
    buffer_store_dword v41, v185, s[8:11], s66 offen
    s_mov_b64 exec, s[44:45]
    s_cbranch_execz K2_SV_DONE
    buffer_store_dword v42, v186, s[8:11], s66 offen
    s_mov_b64 exec, s[46:47]
    s_cbranch_execz K2_SV_DONE
    buffer_store_dword v43, v187, s[8:11], s66 offen
    s_mov_b64 exec, s[48:49]
    s_cbranch_execz K2_SV_DONE
    buffer_store_dword v44, v179, s[8:11], s66 offen offset:32
    s_mov_b64 exec, s[50:51]
    s_cbranch_execz K2_SV_DONE
    buffer_store_dword v45, v179, s[8:11], s66 offen offset:40
    s_mov_b64 exec, s[90:91]
    s_cbranch_execz K2_SV_DONE
    buffer_store_dword v46, v179, s[8:11], s66 offen offset:48
    s_mov_b64 exec, s[92:93]
    s_cbranch_execz K2_SV_DONE
    buffer_store_dword v47, v179, s[8:11], s66 offen offset:56
    s_mov_b64 exec, s[94:95]
    s_cbranch_execz K2_SV_DONE
    buffer_store_dword v48, v179, s[8:11], s66 offen offset:64
    s_mov_b64 exec, s[96:97]
    s_cbranch_execz K2_SV_DONE
    buffer_store_dword v49, v179, s[8:11], s66 offen offset:72
K2_SV_DONE:
    s_mov_b64 exec, -1
    s_branch K2_TOK
K2_rare_1:
    s_cmp_eq_u32 s33, 4
    s_cbranch_scc1 K2_four_3
    s_mov_b32 s49, s48
    s_mov_b32 s51, s48
    s_add_u32 s45, s44, 256
    s_add_u32 s46, s44, 512
    s_add_u32 s47, s44, 768
    s_branch K2_back_2
K2_four_3:
    s_add_u32 s50, s48, 64
    s_lshr_b32 s51, s3, 27
    s_mov_b32 s66, 161536
    s_cmp_ge_u32 s51, 2
    s_cselect_b32 s66, 159072, s66
    s_mul_i32 s51, s51, 32
    s_add_u32 s51, s51, s66
    s_mov_b32 s46, s44
    s_mov_b32 s47, s44
    s_branch K2_back_2
K2_a4_5:
    s_lshr_b32 s65, s3, 27
    s_mov_b32 s66, 161536
    s_cmp_ge_u32 s65, 2
    s_cselect_b32 s66, 158112, s66
    s_mul_i32 s65, s65, 512
    s_add_u32 s65, s65, s66
    v_add_u32 v232, s65, v230
    ds_read_b32 v232, v232
    s_add_u32 m0, s65, 864
    s_waitcnt lgkmcnt(0)
    v_or_b32 v232, v232, v231
    buffer_load_dwordx4 v232, s[16:19], 0 offen  lds
    s_branch K2_b4_7
K2_rare_14:
    s_cmp_eq_u32 s33, 4
    s_cbranch_scc1 K2_four_16
    s_mov_b32 s49, s48
    s_mov_b32 s51, s48
    s_add_u32 s45, s44, 256
    s_add_u32 s46, s44, 512
    s_add_u32 s47, s44, 768
    s_branch K2_back_15
K2_four_16:
    s_add_u32 s50, s48, 64
    s_lshr_b32 s51, s3, 27
    s_mov_b32 s66, 161536
    s_cmp_ge_u32 s51, 2
    s_cselect_b32 s66, 159072, s66
    s_mul_i32 s51, s51, 32
    s_add_u32 s51, s51, s66
    s_mov_b32 s46, s44
    s_mov_b32 s47, s44
    s_branch K2_back_15
K2_a4_20:
    s_lshr_b32 s65, s3, 27
    s_mov_b32 s66, 161536
    s_cmp_ge_u32 s65, 2
    s_cselect_b32 s66, 158112, s66
    s_mul_i32 s65, s65, 512
    s_add_u32 s65, s65, s66
    v_add_u32 v232, s65, v230
    ds_read_b32 v232, v232
    s_add_u32 m0, s65, 864
    s_waitcnt lgkmcnt(0)
    v_or_b32 v232, v232, v231
    buffer_load_dwordx4 v232, s[16:19], 0 offen  lds
    s_branch K2_b4_22
K2_rare_33:
    s_cmp_eq_u32 s33, 4
    s_cbranch_scc1 K2_four_35
    s_mov_b32 s49, s48
    s_mov_b32 s51, s48
    s_add_u32 s45, s44, 256
    s_add_u32 s46, s44, 512
    s_add_u32 s47, s44, 768
    s_branch K2_back_34
K2_four_35:
    s_add_u32 s50, s48, 64
    s_lshr_b32 s51, s3, 27
    s_mov_b32 s66, 161536
    s_cmp_ge_u32 s51, 2
    s_cselect_b32 s66, 159072, s66
    s_mul_i32 s51, s51, 32
    s_add_u32 s51, s51, s66
    s_mov_b32 s46, s44
    s_mov_b32 s47, s44
    s_branch K2_back_34
K2_a4_39:
    s_lshr_b32 s65, s3, 27
    s_mov_b32 s66, 161536
    s_cmp_ge_u32 s65, 2
    s_cselect_b32 s66, 158112, s66
    s_mul_i32 s65, s65, 512
    s_add_u32 s65, s65, s66
    v_add_u32 v232, s65, v230
    ds_read_b32 v232, v232
    s_add_u32 m0, s65, 864
    s_waitcnt lgkmcnt(0)
    v_or_b32 v232, v232, v231
    buffer_load_dwordx4 v232, s[16:19], 0 offen  lds
    s_branch K2_b4_41
K2_rare_50:
    s_cmp_eq_u32 s33, 4
    s_cbranch_scc1 K2_four_52
    s_mov_b32 s49, s48
    s_mov_b32 s51, s48
    s_add_u32 s45, s44, 256
    s_add_u32 s46, s44, 512
    s_add_u32 s47, s44, 768
    s_branch K2_back_51
K2_four_52:
    s_add_u32 s50, s48, 64
    s_lshr_b32 s51, s3, 27
    s_mov_b32 s66, 161536
    s_cmp_ge_u32 s51, 2
    s_cselect_b32 s66, 159072, s66
    s_mul_i32 s51, s51, 32
    s_add_u32 s51, s51, s66
    s_mov_b32 s46, s44
    s_mov_b32 s47, s44
    s_branch K2_back_51
K2_rare_57:
    s_cmp_eq_u32 s33, 4
    s_cbranch_scc1 K2_four_59
    s_mov_b32 s49, s48
    s_mov_b32 s51, s48
    s_add_u32 s45, s44, 256
    s_add_u32 s46, s44, 512
    s_add_u32 s47, s44, 768
    s_branch K2_back_58
K2_four_59:
    s_add_u32 s50, s48, 64
    s_lshr_b32 s51, s3, 27
    s_mov_b32 s66, 161536
    s_cmp_ge_u32 s51, 2
    s_cselect_b32 s66, 159072, s66
    s_mul_i32 s51, s51, 32
    s_add_u32 s51, s51, s66
    s_mov_b32 s46, s44
    s_mov_b32 s47, s44
    s_branch K2_back_58
K2_U10:
    s_setprio 1
    s_add_u32 s38, s38, 1
    v_mov_b32 v254, s52
    v_mov_b32 v255, s38
    s_lshl_b32 s58, s38, 3
    s_add_u32 s58, s58, s20
    s_mov_b64 exec, 1
    ds_write_b32 v254, v255
    s_mov_b64 exec, -1
    s_cmp_lt_u32 s58, s22
    s_cbranch_scc0 K2_dyn_60
K2_back_61:
    s_waitcnt lgkmcnt(7)
    v_lshlrev_b32 v40, 16, v0
    v_and_b32 v41, 0xffff0000, v0
    v_lshlrev_b32 v42, 16, v1
    v_and_b32 v43, 0xffff0000, v1
    v_lshlrev_b32 v44, 16, v2
    v_and_b32 v45, 0xffff0000, v2
    v_lshlrev_b32 v46, 16, v3
    v_and_b32 v47, 0xffff0000, v3
    v_mul_f32 v4, v40, v4
    v_mul_f32 v5, v41, v5
    v_mul_f32 v6, v42, v6
    v_mul_f32 v7, v43, v7
    v_mul_f32 v8, v44, v8
    v_mul_f32 v9, v45, v9
    v_mul_f32 v10, v46, v10
    v_mul_f32 v11, v47, v11
    v_cvt_pk_bf16_f32 v64, v4, v5
    v_cvt_pk_bf16_f32 v65, v6, v7
    v_cvt_pk_bf16_f32 v66, v8, v9
    v_cvt_pk_bf16_f32 v67, v10, v11
    v_mul_f32 v12, v40, v12
    v_mul_f32 v13, v41, v13
    v_mul_f32 v14, v42, v14
    v_mul_f32 v15, v43, v15
    v_mul_f32 v16, v44, v16
    v_mul_f32 v17, v45, v17
    v_mul_f32 v18, v46, v18
    v_mul_f32 v19, v47, v19
    v_cvt_pk_bf16_f32 v68, v12, v13
    v_cvt_pk_bf16_f32 v69, v14, v15
    v_cvt_pk_bf16_f32 v70, v16, v17
    v_cvt_pk_bf16_f32 v71, v18, v19
    v_readlane_b32 s3, v253, s58
    s_lshl_b32 s44, s34, 7
    s_lshl_b32 s60, s58, 5
    s_and_b32 s48, s3, 0x3ffff
    s_bfe_u32 s33, s3, 0x30012
    s_sub_u32 s60, s60, s48
    s_and_b32 s60, s60, 0xff
    s_add_u32 s60, s60, s48
    s_mul_i32 s35, s38, 6
    s_cmp_eq_u32 s34, 0
    s_cselect_b32 s35, s35, s60
    s_mov_b32 s45, s44
    s_add_u32 s47, s44, 256
    s_add_u32 s49, s48, 32
    s_add_u32 s60, s48, 64
    s_cmp_eq_u32 s33, 3
    s_cselect_b32 s46, s44, s47
    s_cselect_b32 s50, s60, s48
    s_cselect_b32 s51, s48, s49
    s_sub_u32 s60, s33, 2
    s_cmp_lt_u32 s60, 2
    s_cbranch_scc0 K2_rare_66
K2_back_67:
    v_add_u32 v233, s48, v230
    ds_read_b32 v232, v233
    ds_read_b32 v233, v233 offset:1024
    v_add_u32 v222, s48, v251
    ds_read_b32 v222, v222
    v_add_u32 v224, s49, v251
    ds_read_b32 v224, v224
    v_add_u32 v226, s50, v251
    ds_read_b32 v226, v226
    v_add_u32 v228, s51, v251
    ds_read_b32 v228, v228
    s_waitcnt lgkmcnt(4)
    v_or_b32 v232, v232, v231
    v_or_b32 v233, v233, v231
    s_cmp_lg_u32 s34, 0
    s_cbranch_scc1 K2_dum_69
    s_add_u32 m0, s48, 864
    s_add_u32 s65, s48, 1888
    buffer_load_dwordx4 v232, s[16:19], 0 offen  lds
    s_mov_b32 m0, s65
    s_mov_b32 exec_hi, 0
    buffer_load_dwordx4 v233, s[16:19], 0 offen  lds
    s_cmp_eq_u32 s33, 4
    s_cbranch_scc1 K2_a4_70
K2_b4_72:
    s_mov_b32 exec_hi, -1
K2_back_71:
    s_waitcnt lgkmcnt(3)
    v_mad_u32_u16 v223, v222, s39, v248 op_sel:[1,0,0,0]
    v_mad_u32_u16 v222, v222, s39, v248
    s_waitcnt lgkmcnt(2)
    v_mad_u32_u16 v225, v224, s39, v248 op_sel:[1,0,0,0]
    v_mad_u32_u16 v224, v224, s39, v248
    s_waitcnt lgkmcnt(1)
    v_mad_u32_u16 v227, v226, s39, v248 op_sel:[1,0,0,0]
    v_mad_u32_u16 v226, v226, s39, v248
    s_waitcnt lgkmcnt(0)
    v_mad_u32_u16 v229, v228, s39, v248 op_sel:[1,0,0,0]
    v_mad_u32_u16 v228, v228, s39, v248
    s_waitcnt vmcnt(6)
    v_mfma_f32_32x32x16_bf16 v[0:15], v[64:67], v[176:179], 0
    ds_read_b64_tr_b16 v[184:185], v246 offset:2048
    ds_read_b64_tr_b16 v[186:187], v246 offset:2560
    ds_read_b64_tr_b16 v[188:189], v247 offset:2048
    ds_read_b64_tr_b16 v[190:191], v247 offset:2560
    s_mov_b32 m0, s68
    v_mfma_f32_32x32x16_bf16 v[16:31], v[68:71], v[176:179], 0
    buffer_load_dwordx4 v222, s[4:7], s44 offen sc1 lds
    buffer_load_dwordx4 v223, s[72:75], s44 offen offset:1024 sc1 lds
    v_permlane32_swap_b32 v242, v236
    v_permlane32_swap_b32 v243, v237
    v_mfma_f32_32x32x16_bf16 v[32:47], v[64:67], v[180:183], 0
    v_permlane32_swap_b32 v244, v238
    v_permlane32_swap_b32 v245, v239
    v_permlane32_swap_b32 v240, v241
    v_add_f32 v242, v242, v236
    v_mfma_f32_32x32x16_bf16 v[48:63], v[68:71], v[180:183], 0
    s_setprio 0
    v_add_f32 v243, v243, v237
    v_add_f32 v244, v244, v238
    v_add_f32 v245, v245, v239
    v_add_f32 v240, -v240, -v241
    s_set_gpr_idx_on s32, gpr_idx(DST)
    s_nop 0
    v_cvt_pk_bf16_f32 v195, v242, v243
    v_cvt_pk_bf16_f32 v196, v244, v245
    v_cvt_pk_bf16_f32 v197, v240, v240
    s_set_gpr_idx_off
    v_mul_f32 v234, v0, v96
    v_mul_f32 v236, v8, v128
    v_fmac_f32 v234, v1, v97
    v_fmac_f32 v236, v9, v129
    v_fmac_f32 v234, v2, v98
    v_fmac_f32 v236, v10, v130
    v_fmac_f32 v234, v3, v99
    v_fmac_f32 v236, v11, v131
    v_fmac_f32 v234, v4, v100
    v_fmac_f32 v236, v12, v132
    v_fmac_f32 v234, v5, v101
    v_fmac_f32 v236, v13, v133
    v_fmac_f32 v234, v6, v102
    v_fmac_f32 v236, v14, v134
    v_fmac_f32 v234, v7, v103
    v_fmac_f32 v236, v15, v135
    v_mul_f32 v238, v16, v128
    v_mul_f32 v240, v24, v128
    v_fmac_f32 v238, v17, v129
    v_fmac_f32 v240, v25, v129
    v_fmac_f32 v238, v18, v130
    v_fmac_f32 v240, v26, v130
    v_fmac_f32 v238, v19, v131
    v_fmac_f32 v240, v27, v131
    v_fmac_f32 v238, v20, v132
    v_fmac_f32 v240, v28, v132
    v_fmac_f32 v238, v21, v133
    v_fmac_f32 v240, v29, v133
    v_fmac_f32 v238, v22, v134
    v_fmac_f32 v240, v30, v134
    v_fmac_f32 v238, v23, v135
    v_fmac_f32 v240, v31, v135
    v_mul_f32 v235, v32, v104
    v_mul_f32 v237, v40, v136
    v_fmac_f32 v235, v33, v105
    v_fmac_f32 v237, v41, v137
    v_fmac_f32 v235, v34, v106
    v_fmac_f32 v237, v42, v138
    v_fmac_f32 v235, v35, v107
    v_fmac_f32 v237, v43, v139
    v_fmac_f32 v235, v36, v108
    v_fmac_f32 v237, v44, v140
    v_fmac_f32 v235, v37, v109
    v_fmac_f32 v237, v45, v141
    v_fmac_f32 v235, v38, v110
    v_fmac_f32 v237, v46, v142
    v_fmac_f32 v235, v39, v111
    v_fmac_f32 v237, v47, v143
    v_mul_f32 v239, v48, v136
    v_mul_f32 v241, v56, v136
    v_fmac_f32 v239, v49, v137
    v_fmac_f32 v241, v57, v137
    v_fmac_f32 v239, v50, v138
    v_fmac_f32 v241, v58, v138
    v_fmac_f32 v239, v51, v139
    v_fmac_f32 v241, v59, v139
    v_fmac_f32 v239, v52, v140
    v_fmac_f32 v241, v60, v140
    v_fmac_f32 v239, v53, v141
    v_fmac_f32 v241, v61, v141
    v_fmac_f32 v239, v54, v142
    v_fmac_f32 v241, v62, v142
    v_fmac_f32 v239, v55, v143
    v_fmac_f32 v241, v63, v143
    s_setprio 1
    s_waitcnt vmcnt(6) lgkmcnt(0)
    v_mfma_f32_32x32x16_bf16 v[0:15], v[64:67], v[184:187], 0
    ds_read_b64_tr_b16 v[176:177], v246 offset:4096
    ds_read_b64_tr_b16 v[178:179], v246 offset:4608
    ds_read_b64_tr_b16 v[180:181], v247 offset:4096
    ds_read_b64_tr_b16 v[182:183], v247 offset:4608
    s_mov_b32 m0, s69
    v_mfma_f32_32x32x16_bf16 v[16:31], v[68:71], v[184:187], 0
    buffer_load_dwordx4 v224, s[4:7], s45 offen sc1 lds
    buffer_load_dwordx4 v225, s[72:75], s45 offen offset:1024 sc1 lds
    v_permlane32_swap_b32 v234, v236
    v_permlane32_swap_b32 v235, v237
    v_mfma_f32_32x32x16_bf16 v[32:47], v[64:67], v[188:191], 0
    v_permlane32_swap_b32 v240, v238
    v_permlane32_swap_b32 v241, v239
    v_add_f32 v234, v234, v236
    v_add_f32 v235, v235, v237
    v_add_f32 v240, v240, v238
    v_mfma_f32_32x32x16_bf16 v[48:63], v[68:71], v[188:191], 0
    s_setprio 0
    v_add_f32 v241, v241, v239
    s_set_gpr_idx_on s31, gpr_idx(DST)
    s_nop 0
    v_cvt_pk_bf16_f32 v192, v234, v235
    v_cvt_pk_bf16_f32 v193, v240, v241
    s_set_gpr_idx_off
    v_mul_f32 v234, v0, v144
    v_mul_f32 v236, v8, v112
    v_fmac_f32 v234, v1, v145
    v_fmac_f32 v236, v9, v113
    v_fmac_f32 v234, v2, v146
    v_fmac_f32 v236, v10, v114
    v_fmac_f32 v234, v3, v147
    v_fmac_f32 v236, v11, v115
    v_fmac_f32 v234, v4, v148
    v_fmac_f32 v236, v12, v116
    v_fmac_f32 v234, v5, v149
    v_fmac_f32 v236, v13, v117
    v_fmac_f32 v234, v6, v150
    v_fmac_f32 v236, v14, v118
    v_fmac_f32 v234, v7, v151
    v_fmac_f32 v236, v15, v119
    v_mul_f32 v238, v16, v160
    v_mul_f32 v240, v24, v160
    v_fmac_f32 v238, v17, v161
    v_fmac_f32 v240, v25, v161
    v_fmac_f32 v238, v18, v162
    v_fmac_f32 v240, v26, v162
    v_fmac_f32 v238, v19, v163
    v_fmac_f32 v240, v27, v163
    v_fmac_f32 v238, v20, v164
    v_fmac_f32 v240, v28, v164
    v_fmac_f32 v238, v21, v165
    v_fmac_f32 v240, v29, v165
    v_fmac_f32 v238, v22, v166
    v_fmac_f32 v240, v30, v166
    v_fmac_f32 v238, v23, v167
    v_fmac_f32 v240, v31, v167
    v_mul_f32 v235, v32, v152
    v_mul_f32 v237, v40, v120
    v_fmac_f32 v235, v33, v153
    v_fmac_f32 v237, v41, v121
    v_fmac_f32 v235, v34, v154
    v_fmac_f32 v237, v42, v122
    v_fmac_f32 v235, v35, v155
    v_fmac_f32 v237, v43, v123
    v_fmac_f32 v235, v36, v156
    v_fmac_f32 v237, v44, v124
    v_fmac_f32 v235, v37, v157
    v_fmac_f32 v237, v45, v125
    v_fmac_f32 v235, v38, v158
    v_fmac_f32 v237, v46, v126
    v_fmac_f32 v235, v39, v159
    v_fmac_f32 v237, v47, v127
    v_mul_f32 v239, v48, v168
    v_mul_f32 v241, v56, v168
    v_fmac_f32 v239, v49, v169
    v_fmac_f32 v241, v57, v169
    v_fmac_f32 v239, v50, v170
    v_fmac_f32 v241, v58, v170
    v_fmac_f32 v239, v51, v171
    v_fmac_f32 v241, v59, v171
    v_fmac_f32 v239, v52, v172
    v_fmac_f32 v241, v60, v172
    v_fmac_f32 v239, v53, v173
    v_fmac_f32 v241, v61, v173
    v_fmac_f32 v239, v54, v174
    v_fmac_f32 v241, v62, v174
    v_fmac_f32 v239, v55, v175
    v_fmac_f32 v241, v63, v175
    s_setprio 1
    s_waitcnt vmcnt(6) lgkmcnt(0)
    v_mfma_f32_32x32x16_bf16 v[0:15], v[64:67], v[176:179], 0
    ds_read_b64_tr_b16 v[184:185], v246 offset:6144
    ds_read_b64_tr_b16 v[186:187], v246 offset:6656
    ds_read_b64_tr_b16 v[188:189], v247 offset:6144
    ds_read_b64_tr_b16 v[190:191], v247 offset:6656
    s_cmp_lg_u32 s34, 0
    s_cbranch_scc1 K2_ew_73
K2_back_74:
    s_mov_b32 m0, s70
    v_mfma_f32_32x32x16_bf16 v[16:31], v[68:71], v[176:179], 0
    buffer_load_dwordx4 v226, s[4:7], s46 offen sc1 lds
    buffer_load_dwordx4 v227, s[72:75], s46 offen offset:1024 sc1 lds
    s_sub_u32 s26, s48, s29
    s_mov_b32 s29, s48
    s_mov_b32 s30, s3
    s_cmp_eq_u32 s34, 0
    s_cselect_b32 s56, s33, 0
    v_mfma_f32_32x32x16_bf16 v[32:47], v[64:67], v[180:183], 0
    v_mfma_f32_32x32x16_bf16 v[48:63], v[68:71], v[180:183], 0
    s_setprio 0
    v_mul_f32 v242, v0, v144
    v_fma_f32 v238, v8, v160, -v238
    v_fmac_f32 v242, v1, v145
    v_fmac_f32 v238, v9, v161
    v_fmac_f32 v242, v2, v146
    v_fmac_f32 v238, v10, v162
    v_fmac_f32 v242, v3, v147
    v_fmac_f32 v238, v11, v163
    v_fmac_f32 v242, v4, v148
    v_fmac_f32 v238, v12, v164
    v_fmac_f32 v242, v5, v149
    v_fmac_f32 v238, v13, v165
    v_fmac_f32 v242, v6, v150
    v_fmac_f32 v238, v14, v166
    v_fmac_f32 v242, v7, v151
    v_fmac_f32 v238, v15, v167
    v_fmac_f32 v236, v16, v112
    v_mul_f32 v244, v24, v160
    v_fmac_f32 v236, v17, v113
    v_fmac_f32 v244, v25, v161
    v_fmac_f32 v236, v18, v114
    v_fmac_f32 v244, v26, v162
    v_fmac_f32 v236, v19, v115
    v_fmac_f32 v244, v27, v163
    v_fmac_f32 v236, v20, v116
    v_fmac_f32 v244, v28, v164
    v_fmac_f32 v236, v21, v117
    v_fmac_f32 v244, v29, v165
    v_fmac_f32 v236, v22, v118
    v_fmac_f32 v244, v30, v166
    v_fmac_f32 v236, v23, v119
    v_fmac_f32 v244, v31, v167
    v_mul_f32 v243, v32, v152
    v_fma_f32 v239, v40, v168, -v239
    v_fmac_f32 v243, v33, v153
    v_fmac_f32 v239, v41, v169
    v_fmac_f32 v243, v34, v154
    v_fmac_f32 v239, v42, v170
    v_fmac_f32 v243, v35, v155
    v_fmac_f32 v239, v43, v171
    v_fmac_f32 v243, v36, v156
    v_fmac_f32 v239, v44, v172
    v_fmac_f32 v243, v37, v157
    v_fmac_f32 v239, v45, v173
    v_fmac_f32 v243, v38, v158
    v_fmac_f32 v239, v46, v174
    v_fmac_f32 v243, v39, v159
    v_fmac_f32 v239, v47, v175
    v_fmac_f32 v237, v48, v120
    v_mul_f32 v245, v56, v168
    v_fmac_f32 v237, v49, v121
    v_fmac_f32 v245, v57, v169
    v_fmac_f32 v237, v50, v122
    v_fmac_f32 v245, v58, v170
    v_fmac_f32 v237, v51, v123
    v_fmac_f32 v245, v59, v171
    v_fmac_f32 v237, v52, v124
    v_fmac_f32 v245, v60, v172
    v_fmac_f32 v237, v53, v125
    v_fmac_f32 v245, v61, v173
    v_fmac_f32 v237, v54, v126
    v_fmac_f32 v245, v62, v174
    v_fmac_f32 v237, v55, v127
    v_fmac_f32 v245, v63, v175
    s_setprio 1
    s_waitcnt vmcnt(4) lgkmcnt(0)
    v_mfma_f32_32x32x16_bf16 v[0:15], v[64:67], v[184:187], 0
    ds_read_b64_tr_b16 v[176:177], v246 offset:0
    ds_read_b64_tr_b16 v[178:179], v246 offset:512
    ds_read_b64_tr_b16 v[180:181], v247 offset:0
    ds_read_b64_tr_b16 v[182:183], v247 offset:512
    s_mov_b32 m0, s71
    v_mfma_f32_32x32x16_bf16 v[16:31], v[68:71], v[184:187], 0
    buffer_load_dwordx4 v228, s[4:7], s47 offen sc1 lds
    buffer_load_dwordx4 v229, s[72:75], s47 offen offset:1024 sc1 lds
    v_permlane32_swap_b32 v242, v234
    v_permlane32_swap_b32 v243, v235
    v_add_f32 v242, v242, v234
    v_mfma_f32_32x32x16_bf16 v[32:47], v[64:67], v[188:191], 0
    v_add_f32 v243, v243, v235
    s_set_gpr_idx_on s31, gpr_idx(DST)
    s_nop 0
    v_cvt_pk_bf16_f32 v194, v242, v243
    s_set_gpr_idx_off
    s_mov_b32 s32, s31
    s_mov_b32 s31, s35
    v_mfma_f32_32x32x16_bf16 v[48:63], v[68:71], v[188:191], 0
    s_setprio 0
    v_mul_f32 v242, v0, v144
    v_fma_f32 v240, v8, v160, -v240
    v_fmac_f32 v242, v1, v145
    v_fmac_f32 v240, v9, v161
    v_fmac_f32 v242, v2, v146
    v_fmac_f32 v240, v10, v162
    v_fmac_f32 v242, v3, v147
    v_fmac_f32 v240, v11, v163
    v_fmac_f32 v242, v4, v148
    v_fmac_f32 v240, v12, v164
    v_fmac_f32 v242, v5, v149
    v_fmac_f32 v240, v13, v165
    v_fmac_f32 v242, v6, v150
    v_fmac_f32 v240, v14, v166
    v_fmac_f32 v242, v7, v151
    v_fmac_f32 v240, v15, v167
    v_add_u32 v249, s26, v249
    v_add_u32 v250, s26, v250
    v_fma_f32 v244, v16, v160, -v244
    v_fmac_f32 v236, v24, v112
    v_fmac_f32 v244, v17, v161
    v_fmac_f32 v236, v25, v113
    v_fmac_f32 v244, v18, v162
    v_fmac_f32 v236, v26, v114
    v_fmac_f32 v244, v19, v163
    v_fmac_f32 v236, v27, v115
    v_fmac_f32 v244, v20, v164
    v_fmac_f32 v236, v28, v116
    v_fmac_f32 v244, v21, v165
    v_fmac_f32 v236, v29, v117
    v_fmac_f32 v244, v22, v166
    v_fmac_f32 v236, v30, v118
    v_fmac_f32 v244, v23, v167
    v_fmac_f32 v236, v31, v119
    ds_read_b64_tr_b16 v[0:1], v249 offset:0
    ds_read_b64_tr_b16 v[2:3], v249 offset:128
    ds_read_b128 v[4:7], v250 offset:0
    ds_read_b128 v[8:11], v250 offset:16
    ds_read_b128 v[12:15], v250 offset:384
    ds_read_b128 v[16:19], v250 offset:400
    v_mul_f32 v243, v32, v152
    v_fma_f32 v241, v40, v168, -v241
    v_fmac_f32 v243, v33, v153
    v_fmac_f32 v241, v41, v169
    v_fmac_f32 v243, v34, v154
    v_fmac_f32 v241, v42, v170
    v_fmac_f32 v243, v35, v155
    v_fmac_f32 v241, v43, v171
    v_fmac_f32 v243, v36, v156
    v_fmac_f32 v241, v44, v172
    v_fmac_f32 v243, v37, v157
    v_fmac_f32 v241, v45, v173
    v_fmac_f32 v243, v38, v158
    v_fmac_f32 v241, v46, v174
    v_fmac_f32 v243, v39, v159
    v_fmac_f32 v241, v47, v175
    ds_read_b64_tr_b16 v[20:21], v249 offset:512
    ds_read_b64_tr_b16 v[22:23], v249 offset:640
    ds_read_b128 v[24:27], v250 offset:64
    ds_read_b128 v[28:31], v250 offset:80
    ds_read_b128 v[32:35], v250 offset:448
    ds_read_b128 v[36:39], v250 offset:464
    v_fma_f32 v245, v48, v168, -v245
    v_fmac_f32 v237, v56, v120
    v_fmac_f32 v245, v49, v169
    v_fmac_f32 v237, v57, v121
    v_fmac_f32 v245, v50, v170
    v_fmac_f32 v237, v58, v122
    v_fmac_f32 v245, v51, v171
    v_fmac_f32 v237, v59, v123
    v_fmac_f32 v245, v52, v172
    v_fmac_f32 v237, v60, v124
    v_fmac_f32 v245, v53, v173
    v_fmac_f32 v237, v61, v125
    v_fmac_f32 v245, v54, v174
    v_fmac_f32 v237, v62, v126
    v_fmac_f32 v245, v55, v175
    v_fmac_f32 v237, v63, v127
    s_cmp_eq_u32 s56, 2
    s_cbranch_scc1 K2_U20
    s_cmp_eq_u32 s56, 3
    s_cbranch_scc1 K2_U30
    s_branch K2_DSP0
K2_U40:
    s_setprio 1
    s_waitcnt lgkmcnt(6)
    v_lshlrev_b32 v40, 16, v0
    v_and_b32 v41, 0xffff0000, v0
    v_lshlrev_b32 v42, 16, v1
    v_and_b32 v43, 0xffff0000, v1
    v_lshlrev_b32 v44, 16, v2
    v_and_b32 v45, 0xffff0000, v2
    v_lshlrev_b32 v46, 16, v3
    v_and_b32 v47, 0xffff0000, v3
    v_mul_f32 v4, v40, v4
    v_mul_f32 v5, v41, v5
    v_mul_f32 v6, v42, v6
    v_mul_f32 v7, v43, v7
    v_mul_f32 v8, v44, v8
    v_mul_f32 v9, v45, v9
    v_mul_f32 v10, v46, v10
    v_mul_f32 v11, v47, v11
    v_cvt_pk_bf16_f32 v64, v4, v5
    v_cvt_pk_bf16_f32 v65, v6, v7
    v_cvt_pk_bf16_f32 v66, v8, v9
    v_cvt_pk_bf16_f32 v67, v10, v11
    v_mul_f32 v12, v40, v12
    v_mul_f32 v13, v41, v13
    v_mul_f32 v14, v42, v14
    v_mul_f32 v15, v43, v15
    v_mul_f32 v16, v44, v16
    v_mul_f32 v17, v45, v17
    v_mul_f32 v18, v46, v18
    v_mul_f32 v19, v47, v19
    v_cvt_pk_bf16_f32 v68, v12, v13
    v_cvt_pk_bf16_f32 v69, v14, v15
    v_cvt_pk_bf16_f32 v70, v16, v17
    v_cvt_pk_bf16_f32 v71, v18, v19
    ds_read_b64_tr_b16 v[0:1], v249 offset:1024
    ds_read_b64_tr_b16 v[2:3], v249 offset:1152
    ds_read_b128 v[4:7], v250 offset:128
    ds_read_b128 v[8:11], v250 offset:144
    ds_read_b128 v[12:15], v250 offset:512
    ds_read_b128 v[16:19], v250 offset:528
    s_waitcnt lgkmcnt(6)
    v_lshlrev_b32 v48, 16, v20
    v_and_b32 v49, 0xffff0000, v20
    v_lshlrev_b32 v50, 16, v21
    v_and_b32 v51, 0xffff0000, v21
    v_lshlrev_b32 v52, 16, v22
    v_and_b32 v53, 0xffff0000, v22
    v_lshlrev_b32 v54, 16, v23
    v_and_b32 v55, 0xffff0000, v23
    v_mul_f32 v24, v48, v24
    v_mul_f32 v25, v49, v25
    v_mul_f32 v26, v50, v26
    v_mul_f32 v27, v51, v27
    v_mul_f32 v28, v52, v28
    v_mul_f32 v29, v53, v29
    v_mul_f32 v30, v54, v30
    v_mul_f32 v31, v55, v31
    v_cvt_pk_bf16_f32 v72, v24, v25
    v_cvt_pk_bf16_f32 v73, v26, v27
    v_cvt_pk_bf16_f32 v74, v28, v29
    v_cvt_pk_bf16_f32 v75, v30, v31
    v_mul_f32 v32, v48, v32
    v_mul_f32 v33, v49, v33
    v_mul_f32 v34, v50, v34
    v_mul_f32 v35, v51, v35
    v_mul_f32 v36, v52, v36
    v_mul_f32 v37, v53, v37
    v_mul_f32 v38, v54, v38
    v_mul_f32 v39, v55, v39
    v_cvt_pk_bf16_f32 v76, v32, v33
    v_cvt_pk_bf16_f32 v77, v34, v35
    v_cvt_pk_bf16_f32 v78, v36, v37
    v_cvt_pk_bf16_f32 v79, v38, v39
    s_lshr_b32 s65, s30, 27
    s_mov_b32 s66, 161536
    s_cmp_ge_u32 s65, 2
    s_cselect_b32 s66, 158112, s66
    s_mul_i32 s65, s65, 512
    s_add_u32 s65, s65, s66
    s_sub_u32 s65, s65, s29
    v_add_u32 v56, s65, v249
    s_lshr_b32 s65, s30, 27
    s_mov_b32 s66, 161536
    s_cmp_ge_u32 s65, 2
    s_cselect_b32 s66, 159008, s66
    s_mul_i32 s65, s65, 64
    s_add_u32 s65, s65, s66
    s_sub_u32 s65, s65, s29
    v_add_u32 v57, s65, v250
    ds_read_b64_tr_b16 v[20:21], v56 offset:0
    ds_read_b64_tr_b16 v[22:23], v56 offset:128
    ds_read_b128 v[24:27], v57 offset:0
    ds_read_b128 v[28:31], v57 offset:16
    ds_read_b128 v[32:35], v57 offset:384
    ds_read_b128 v[36:39], v57 offset:400
    s_waitcnt lgkmcnt(10)
    v_lshlrev_b32 v40, 16, v0
    v_and_b32 v41, 0xffff0000, v0
    v_lshlrev_b32 v42, 16, v1
    v_and_b32 v43, 0xffff0000, v1
    v_lshlrev_b32 v44, 16, v2
    v_and_b32 v45, 0xffff0000, v2
    v_lshlrev_b32 v46, 16, v3
    v_and_b32 v47, 0xffff0000, v3
    s_waitcnt lgkmcnt(8)
    v_mul_f32 v4, v40, v4
    v_mul_f32 v5, v41, v5
    v_mul_f32 v6, v42, v6
    v_mul_f32 v7, v43, v7
    v_mul_f32 v8, v44, v8
    v_mul_f32 v9, v45, v9
    v_mul_f32 v10, v46, v10
    v_mul_f32 v11, v47, v11
    v_cvt_pk_bf16_f32 v80, v4, v5
    v_cvt_pk_bf16_f32 v81, v6, v7
    v_cvt_pk_bf16_f32 v82, v8, v9
    v_cvt_pk_bf16_f32 v83, v10, v11
    s_waitcnt lgkmcnt(6)
    v_mul_f32 v12, v40, v12
    v_mul_f32 v13, v41, v13
    v_mul_f32 v14, v42, v14
    v_mul_f32 v15, v43, v15
    v_mul_f32 v16, v44, v16
    v_mul_f32 v17, v45, v17
    v_mul_f32 v18, v46, v18
    v_mul_f32 v19, v47, v19
    v_cvt_pk_bf16_f32 v84, v12, v13
    v_cvt_pk_bf16_f32 v85, v14, v15
    v_cvt_pk_bf16_f32 v86, v16, v17
    v_cvt_pk_bf16_f32 v87, v18, v19
    s_waitcnt lgkmcnt(4)
    v_lshlrev_b32 v48, 16, v20
    v_and_b32 v49, 0xffff0000, v20
    v_lshlrev_b32 v50, 16, v21
    v_and_b32 v51, 0xffff0000, v21
    v_lshlrev_b32 v52, 16, v22
    v_and_b32 v53, 0xffff0000, v22
    v_lshlrev_b32 v54, 16, v23
    v_and_b32 v55, 0xffff0000, v23
    s_waitcnt lgkmcnt(2)
    v_mul_f32 v24, v48, v24
    v_mul_f32 v25, v49, v25
    v_mul_f32 v26, v50, v26
    v_mul_f32 v27, v51, v27
    v_mul_f32 v28, v52, v28
    v_mul_f32 v29, v53, v29
    v_mul_f32 v30, v54, v30
    v_mul_f32 v31, v55, v31
    v_cvt_pk_bf16_f32 v88, v24, v25
    v_cvt_pk_bf16_f32 v89, v26, v27
    v_cvt_pk_bf16_f32 v90, v28, v29
    v_cvt_pk_bf16_f32 v91, v30, v31
    s_waitcnt lgkmcnt(0)
    v_mul_f32 v32, v48, v32
    v_mul_f32 v33, v49, v33
    v_mul_f32 v34, v50, v34
    v_mul_f32 v35, v51, v35
    v_mul_f32 v36, v52, v36
    v_mul_f32 v37, v53, v37
    v_mul_f32 v38, v54, v38
    v_mul_f32 v39, v55, v39
    v_cvt_pk_bf16_f32 v92, v32, v33
    v_cvt_pk_bf16_f32 v93, v34, v35
    v_cvt_pk_bf16_f32 v94, v36, v37
    v_cvt_pk_bf16_f32 v95, v38, v39
    s_waitcnt vmcnt(4)
    v_mfma_f32_32x32x16_bf16 v[0:15], v[64:67], v[176:179], 0
    ds_read_b64_tr_b16 v[184:185], v246 offset:2048
    ds_read_b64_tr_b16 v[186:187], v246 offset:2560
    ds_read_b64_tr_b16 v[188:189], v247 offset:2048
    ds_read_b64_tr_b16 v[190:191], v247 offset:2560
    s_mov_b32 m0, s68
    v_mfma_f32_32x32x16_bf16 v[16:31], v[68:71], v[176:179], 0
    buffer_load_dwordx4 v222, s[4:7], s41 offen sc1 lds
    buffer_load_dwordx4 v223, s[72:75], s41 offen offset:1024 sc1 lds
    v_permlane32_swap_b32 v242, v236
    v_permlane32_swap_b32 v243, v237
    s_add_u32 s38, s38, 1
    v_mfma_f32_32x32x16_bf16 v[32:47], v[64:67], v[180:183], 0
    v_permlane32_swap_b32 v244, v238
    v_permlane32_swap_b32 v245, v239
    v_permlane32_swap_b32 v240, v241
    v_add_f32 v242, v242, v236
    v_mfma_f32_32x32x16_bf16 v[48:63], v[68:71], v[180:183], 0
    v_add_f32 v243, v243, v237
    v_add_f32 v244, v244, v238
    v_add_f32 v245, v245, v239
    v_add_f32 v240, -v240, -v241
    v_mov_b32 v254, s52
    v_mov_b32 v255, s38
    s_waitcnt vmcnt(4) lgkmcnt(0)
    v_mfma_f32_32x32x16_bf16 v[0:15], v[72:75], v[184:187], v[0:15]
    ds_read_b64_tr_b16 v[176:177], v246 offset:4096
    ds_read_b64_tr_b16 v[178:179], v246 offset:4608
    ds_read_b64_tr_b16 v[180:181], v247 offset:4096
    ds_read_b64_tr_b16 v[182:183], v247 offset:4608
    s_lshl_b32 s58, s38, 3
    s_add_u32 s58, s58, s20
    s_mov_b32 m0, s69
    v_mfma_f32_32x32x16_bf16 v[16:31], v[76:79], v[184:187], v[16:31]
    buffer_load_dwordx4 v224, s[4:7], s41 offen sc1 lds
    buffer_load_dwordx4 v225, s[72:75], s41 offen offset:1024 sc1 lds
    s_set_gpr_idx_on s32, gpr_idx(DST)
    s_nop 0
    v_cvt_pk_bf16_f32 v195, v242, v243
    v_cvt_pk_bf16_f32 v196, v244, v245
    v_cvt_pk_bf16_f32 v197, v240, v240
    s_set_gpr_idx_off
    s_mov_b64 exec, 1
    ds_write_b32 v254, v255
    s_mov_b64 exec, -1
    s_cmp_lt_u32 s58, s22
    s_cbranch_scc0 K2_dyn_75
K2_back_76:
    v_readlane_b32 s3, v253, s58
    s_lshl_b32 s44, s34, 7
    s_lshl_b32 s60, s58, 5
    s_and_b32 s48, s3, 0x3ffff
    s_bfe_u32 s33, s3, 0x30012
    s_sub_u32 s60, s60, s48
    s_and_b32 s60, s60, 0xff
    s_add_u32 s60, s60, s48
    s_mul_i32 s35, s38, 6
    s_cmp_eq_u32 s34, 0
    s_cselect_b32 s35, s35, s60
    s_mov_b32 s45, s44
    s_add_u32 s47, s44, 256
    s_add_u32 s49, s48, 32
    s_add_u32 s60, s48, 64
    s_cmp_eq_u32 s33, 3
    s_cselect_b32 s46, s44, s47
    s_cselect_b32 s50, s60, s48
    s_cselect_b32 s51, s48, s49
    s_sub_u32 s60, s33, 2
    s_cmp_lt_u32 s60, 2
    s_cbranch_scc0 K2_rare_81
K2_back_82:
    v_mfma_f32_32x32x16_bf16 v[32:47], v[72:75], v[188:191], v[32:47]
    v_add_u32 v233, s48, v230
    ds_read_b32 v232, v233
    ds_read_b32 v233, v233 offset:1024
    v_mfma_f32_32x32x16_bf16 v[48:63], v[76:79], v[188:191], v[48:63]
    s_waitcnt vmcnt(4) lgkmcnt(3)
    v_mfma_f32_32x32x16_bf16 v[0:15], v[80:83], v[176:179], v[0:15]
    ds_read_b64_tr_b16 v[184:185], v246 offset:6144
    ds_read_b64_tr_b16 v[186:187], v246 offset:6656
    ds_read_b64_tr_b16 v[188:189], v247 offset:6144
    ds_read_b64_tr_b16 v[190:191], v247 offset:6656
    s_mov_b32 m0, s70
    v_mfma_f32_32x32x16_bf16 v[16:31], v[84:87], v[176:179], v[16:31]
    buffer_load_dwordx4 v226, s[4:7], s41 offen sc1 lds
    buffer_load_dwordx4 v227, s[72:75], s41 offen offset:1024 sc1 lds
    v_mfma_f32_32x32x16_bf16 v[32:47], v[80:83], v[180:183], v[32:47]
    v_mfma_f32_32x32x16_bf16 v[48:63], v[84:87], v[180:183], v[48:63]
    s_waitcnt lgkmcnt(4)
    v_or_b32 v232, v232, v231
    v_or_b32 v233, v233, v231
    s_cmp_lg_u32 s34, 0
    s_cbranch_scc1 K2_dum_86
    s_add_u32 m0, s48, 864
    s_add_u32 s65, s48, 1888
    buffer_load_dwordx4 v232, s[16:19], 0 offen  lds
    s_mov_b32 m0, s65
    s_mov_b32 exec_hi, 0
    buffer_load_dwordx4 v233, s[16:19], 0 offen  lds
    s_cmp_eq_u32 s33, 4
    s_cbranch_scc1 K2_a4_87
K2_b4_89:
    s_mov_b32 exec_hi, -1
K2_back_88:
    s_waitcnt vmcnt(6) lgkmcnt(0)
    v_mfma_f32_32x32x16_bf16 v[0:15], v[88:91], v[184:187], v[0:15]
    ds_read_b64_tr_b16 v[176:177], v246 offset:0
    ds_read_b64_tr_b16 v[178:179], v246 offset:512
    ds_read_b64_tr_b16 v[180:181], v247 offset:0
    ds_read_b64_tr_b16 v[182:183], v247 offset:512
    s_mov_b32 m0, s71
    v_mfma_f32_32x32x16_bf16 v[16:31], v[92:95], v[184:187], v[16:31]
    buffer_load_dwordx4 v228, s[4:7], s41 offen sc1 lds
    buffer_load_dwordx4 v229, s[72:75], s41 offen offset:1024 sc1 lds
    v_mfma_f32_32x32x16_bf16 v[32:47], v[88:91], v[188:191], v[32:47]
    s_nop 2
    v_mul_f32 v234, v0, v96
    v_mul_f32 v236, v8, v128
    v_fmac_f32 v234, v1, v97
    v_fmac_f32 v236, v9, v129
    v_fmac_f32 v234, v2, v98
    v_fmac_f32 v236, v10, v130
    v_fmac_f32 v234, v3, v99
    v_mfma_f32_32x32x16_bf16 v[48:63], v[92:95], v[188:191], v[48:63]
    s_setprio 0
    v_fmac_f32 v236, v11, v131
    v_fmac_f32 v234, v4, v100
    v_fmac_f32 v236, v12, v132
    v_fmac_f32 v234, v5, v101
    v_fmac_f32 v236, v13, v133
    v_fmac_f32 v234, v6, v102
    v_fmac_f32 v236, v14, v134
    v_fmac_f32 v234, v7, v103
    v_fmac_f32 v236, v15, v135
    v_mul_f32 v238, v16, v128
    v_mul_f32 v240, v24, v128
    v_fmac_f32 v238, v17, v129
    v_fmac_f32 v240, v25, v129
    v_fmac_f32 v238, v18, v130
    v_fmac_f32 v240, v26, v130
    v_fmac_f32 v238, v19, v131
    v_fmac_f32 v240, v27, v131
    v_fmac_f32 v238, v20, v132
    v_fmac_f32 v240, v28, v132
    v_fmac_f32 v238, v21, v133
    v_fmac_f32 v240, v29, v133
    v_fmac_f32 v238, v22, v134
    v_fmac_f32 v240, v30, v134
    v_fmac_f32 v238, v23, v135
    v_fmac_f32 v240, v31, v135
    v_mul_f32 v235, v32, v104
    v_mul_f32 v237, v40, v136
    v_fmac_f32 v235, v33, v105
    v_fmac_f32 v237, v41, v137
    v_fmac_f32 v235, v34, v106
    v_fmac_f32 v237, v42, v138
    v_fmac_f32 v235, v35, v107
    v_fmac_f32 v237, v43, v139
    v_fmac_f32 v235, v36, v108
    v_fmac_f32 v237, v44, v140
    v_fmac_f32 v235, v37, v109
    v_fmac_f32 v237, v45, v141
    v_fmac_f32 v235, v38, v110
    v_fmac_f32 v237, v46, v142
    v_fmac_f32 v235, v39, v111
    v_fmac_f32 v237, v47, v143
    v_mul_f32 v239, v48, v136
    v_mul_f32 v241, v56, v136
    s_setprio 1
    s_waitcnt vmcnt(6) lgkmcnt(0)
    v_mfma_f32_32x32x16_bf16 v[0:15], v[64:67], v[176:179], 0
    ds_read_b64_tr_b16 v[184:185], v246 offset:2048
    ds_read_b64_tr_b16 v[186:187], v246 offset:2560
    ds_read_b64_tr_b16 v[188:189], v247 offset:2048
    ds_read_b64_tr_b16 v[190:191], v247 offset:2560
    v_fmac_f32 v239, v49, v137
    v_fmac_f32 v241, v57, v137
    s_mov_b32 m0, s68
    v_mfma_f32_32x32x16_bf16 v[16:31], v[68:71], v[176:179], 0
    buffer_load_dwordx4 v222, s[4:7], s42 offen sc1 lds
    buffer_load_dwordx4 v223, s[72:75], s42 offen offset:1024 sc1 lds
    v_fmac_f32 v239, v50, v138
    v_fmac_f32 v241, v58, v138
    v_fmac_f32 v239, v51, v139
    v_fmac_f32 v241, v59, v139
    v_fmac_f32 v239, v52, v140
    v_mfma_f32_32x32x16_bf16 v[32:47], v[64:67], v[180:183], 0
    v_fmac_f32 v241, v60, v140
    v_fmac_f32 v239, v53, v141
    v_fmac_f32 v241, v61, v141
    v_fmac_f32 v239, v54, v142
    v_fmac_f32 v241, v62, v142
    v_fmac_f32 v239, v55, v143
    v_fmac_f32 v241, v63, v143
    v_mfma_f32_32x32x16_bf16 v[48:63], v[68:71], v[180:183], 0
    v_permlane32_swap_b32 v234, v236
    v_permlane32_swap_b32 v235, v237
    v_permlane32_swap_b32 v240, v238
    s_waitcnt vmcnt(6) lgkmcnt(0)
    v_mfma_f32_32x32x16_bf16 v[0:15], v[72:75], v[184:187], v[0:15]
    ds_read_b64_tr_b16 v[176:177], v246 offset:4096
    ds_read_b64_tr_b16 v[178:179], v246 offset:4608
    ds_read_b64_tr_b16 v[180:181], v247 offset:4096
    ds_read_b64_tr_b16 v[182:183], v247 offset:4608
    v_permlane32_swap_b32 v241, v239
    s_mov_b32 m0, s69
    v_mfma_f32_32x32x16_bf16 v[16:31], v[76:79], v[184:187], v[16:31]
    buffer_load_dwordx4 v224, s[4:7], s42 offen sc1 lds
    buffer_load_dwordx4 v225, s[72:75], s42 offen offset:1024 sc1 lds
    v_add_f32 v234, v234, v236
    v_add_f32 v235, v235, v237
    v_add_f32 v240, v240, v238
    v_add_f32 v241, v241, v239
    v_mfma_f32_32x32x16_bf16 v[32:47], v[72:75], v[188:191], v[32:47]
    s_set_gpr_idx_on s31, gpr_idx(DST)
    s_nop 0
    v_cvt_pk_bf16_f32 v192, v234, v235
    v_cvt_pk_bf16_f32 v193, v240, v241
    s_set_gpr_idx_off
    v_mfma_f32_32x32x16_bf16 v[48:63], v[76:79], v[188:191], v[48:63]
    s_waitcnt vmcnt(4) lgkmcnt(0)
    v_mfma_f32_32x32x16_bf16 v[0:15], v[80:83], v[176:179], v[0:15]
    ds_read_b64_tr_b16 v[184:185], v246 offset:6144
    ds_read_b64_tr_b16 v[186:187], v246 offset:6656
    ds_read_b64_tr_b16 v[188:189], v247 offset:6144
    ds_read_b64_tr_b16 v[190:191], v247 offset:6656
    s_mov_b32 m0, s70
    v_mfma_f32_32x32x16_bf16 v[16:31], v[84:87], v[176:179], v[16:31]
    buffer_load_dwordx4 v226, s[4:7], s42 offen sc1 lds
    buffer_load_dwordx4 v227, s[72:75], s42 offen offset:1024 sc1 lds
    v_mfma_f32_32x32x16_bf16 v[32:47], v[80:83], v[180:183], v[32:47]
    v_mfma_f32_32x32x16_bf16 v[48:63], v[84:87], v[180:183], v[48:63]
    s_waitcnt vmcnt(4) lgkmcnt(0)
    v_mfma_f32_32x32x16_bf16 v[0:15], v[88:91], v[184:187], v[0:15]
    ds_read_b64_tr_b16 v[176:177], v246 offset:0
    ds_read_b64_tr_b16 v[178:179], v246 offset:512
    ds_read_b64_tr_b16 v[180:181], v247 offset:0
    ds_read_b64_tr_b16 v[182:183], v247 offset:512
    s_mov_b32 m0, s71
    v_mfma_f32_32x32x16_bf16 v[16:31], v[92:95], v[184:187], v[16:31]
    buffer_load_dwordx4 v228, s[4:7], s42 offen sc1 lds
    buffer_load_dwordx4 v229, s[72:75], s42 offen offset:1024 sc1 lds
    v_mfma_f32_32x32x16_bf16 v[32:47], v[88:91], v[188:191], v[32:47]
    s_nop 2
    v_mul_f32 v234, v0, v144
    v_mul_f32 v236, v8, v112
    v_fmac_f32 v234, v1, v145
    v_fmac_f32 v236, v9, v113
    v_fmac_f32 v234, v2, v146
    v_fmac_f32 v236, v10, v114
    v_fmac_f32 v234, v3, v147
    v_mfma_f32_32x32x16_bf16 v[48:63], v[92:95], v[188:191], v[48:63]
    s_setprio 0
    v_fmac_f32 v236, v11, v115
    v_fmac_f32 v234, v4, v148
    v_fmac_f32 v236, v12, v116
    v_fmac_f32 v234, v5, v149
    v_fmac_f32 v236, v13, v117
    v_fmac_f32 v234, v6, v150
    v_fmac_f32 v236, v14, v118
    v_fmac_f32 v234, v7, v151
    v_fmac_f32 v236, v15, v119
    v_mul_f32 v238, v16, v160
    v_mul_f32 v240, v24, v160
    v_fmac_f32 v238, v17, v161
    v_fmac_f32 v240, v25, v161
    v_fmac_f32 v238, v18, v162
    v_fmac_f32 v240, v26, v162
    v_fmac_f32 v238, v19, v163
    v_fmac_f32 v240, v27, v163
    v_fmac_f32 v238, v20, v164
    v_fmac_f32 v240, v28, v164
    v_fmac_f32 v238, v21, v165
    v_fmac_f32 v240, v29, v165
    v_fmac_f32 v238, v22, v166
    v_fmac_f32 v240, v30, v166
    v_fmac_f32 v238, v23, v167
    v_fmac_f32 v240, v31, v167
    v_mul_f32 v235, v32, v152
    v_mul_f32 v237, v40, v120
    v_fmac_f32 v235, v33, v153
    v_fmac_f32 v237, v41, v121
    v_fmac_f32 v235, v34, v154
    v_fmac_f32 v237, v42, v122
    v_fmac_f32 v235, v35, v155
    v_fmac_f32 v237, v43, v123
    v_fmac_f32 v235, v36, v156
    v_fmac_f32 v237, v44, v124
    v_fmac_f32 v235, v37, v157
    v_fmac_f32 v237, v45, v125
    v_fmac_f32 v235, v38, v158
    v_fmac_f32 v237, v46, v126
    v_fmac_f32 v235, v39, v159
    v_fmac_f32 v237, v47, v127
    v_mul_f32 v239, v48, v168
    v_mul_f32 v241, v56, v168
    s_setprio 1
    s_waitcnt vmcnt(4) lgkmcnt(0)
    v_mfma_f32_32x32x16_bf16 v[0:15], v[64:67], v[176:179], 0
    ds_read_b64_tr_b16 v[184:185], v246 offset:2048
    ds_read_b64_tr_b16 v[186:187], v246 offset:2560
    ds_read_b64_tr_b16 v[188:189], v247 offset:2048
    ds_read_b64_tr_b16 v[190:191], v247 offset:2560
    v_fmac_f32 v239, v49, v169
    v_fmac_f32 v241, v57, v169
    s_mov_b32 m0, s68
    v_mfma_f32_32x32x16_bf16 v[16:31], v[68:71], v[176:179], 0
    buffer_load_dwordx4 v222, s[4:7], s43 offen sc1 lds
    buffer_load_dwordx4 v223, s[72:75], s43 offen offset:1024 sc1 lds
    v_fmac_f32 v239, v50, v170
    v_fmac_f32 v241, v58, v170
    v_fmac_f32 v239, v51, v171
    v_fmac_f32 v241, v59, v171
    v_fmac_f32 v239, v52, v172
    v_mfma_f32_32x32x16_bf16 v[32:47], v[64:67], v[180:183], 0
    v_fmac_f32 v241, v60, v172
    v_fmac_f32 v239, v53, v173
    v_fmac_f32 v241, v61, v173
    v_fmac_f32 v239, v54, v174
    v_fmac_f32 v241, v62, v174
    v_fmac_f32 v239, v55, v175
    v_fmac_f32 v241, v63, v175
    v_mfma_f32_32x32x16_bf16 v[48:63], v[68:71], v[180:183], 0
    s_waitcnt vmcnt(4) lgkmcnt(0)
    v_mfma_f32_32x32x16_bf16 v[0:15], v[72:75], v[184:187], v[0:15]
    ds_read_b64_tr_b16 v[176:177], v246 offset:4096
    ds_read_b64_tr_b16 v[178:179], v246 offset:4608
    ds_read_b64_tr_b16 v[180:181], v247 offset:4096
    ds_read_b64_tr_b16 v[182:183], v247 offset:4608
    s_mov_b32 m0, s69
    v_mfma_f32_32x32x16_bf16 v[16:31], v[76:79], v[184:187], v[16:31]
    buffer_load_dwordx4 v224, s[4:7], s43 offen sc1 lds
    buffer_load_dwordx4 v225, s[72:75], s43 offen offset:1024 sc1 lds
    v_mfma_f32_32x32x16_bf16 v[32:47], v[72:75], v[188:191], v[32:47]
    v_mfma_f32_32x32x16_bf16 v[48:63], v[76:79], v[188:191], v[48:63]
    s_waitcnt vmcnt(4) lgkmcnt(0)
    v_mfma_f32_32x32x16_bf16 v[0:15], v[80:83], v[176:179], v[0:15]
    ds_read_b64_tr_b16 v[184:185], v246 offset:6144
    ds_read_b64_tr_b16 v[186:187], v246 offset:6656
    ds_read_b64_tr_b16 v[188:189], v247 offset:6144
    ds_read_b64_tr_b16 v[190:191], v247 offset:6656
    s_mov_b32 m0, s70
    v_mfma_f32_32x32x16_bf16 v[16:31], v[84:87], v[176:179], v[16:31]
    buffer_load_dwordx4 v226, s[4:7], s43 offen sc1 lds
    buffer_load_dwordx4 v227, s[72:75], s43 offen offset:1024 sc1 lds
    v_mfma_f32_32x32x16_bf16 v[32:47], v[80:83], v[180:183], v[32:47]
    v_add_u32 v222, s48, v251
    ds_read_b32 v222, v222
    v_mfma_f32_32x32x16_bf16 v[48:63], v[84:87], v[180:183], v[48:63]
    s_waitcnt vmcnt(4) lgkmcnt(1)
    v_mfma_f32_32x32x16_bf16 v[0:15], v[88:91], v[184:187], v[0:15]
    ds_read_b64_tr_b16 v[176:177], v246 offset:0
    ds_read_b64_tr_b16 v[178:179], v246 offset:512
    ds_read_b64_tr_b16 v[180:181], v247 offset:0
    ds_read_b64_tr_b16 v[182:183], v247 offset:512
    s_mov_b32 m0, s71
    v_mfma_f32_32x32x16_bf16 v[16:31], v[92:95], v[184:187], v[16:31]
    buffer_load_dwordx4 v228, s[4:7], s43 offen sc1 lds
    buffer_load_dwordx4 v229, s[72:75], s43 offen offset:1024 sc1 lds
    s_waitcnt lgkmcnt(4)
    v_mad_u32_u16 v223, v222, s39, v248 op_sel:[1,0,0,0]
    v_mad_u32_u16 v222, v222, s39, v248
    v_mfma_f32_32x32x16_bf16 v[32:47], v[88:91], v[188:191], v[32:47]
    v_add_u32 v224, s49, v251
    ds_read_b32 v224, v224
    v_mul_f32 v242, v0, v144
    v_fma_f32 v238, v8, v160, -v238
    v_fmac_f32 v242, v1, v145
    v_fmac_f32 v238, v9, v161
    v_fmac_f32 v242, v2, v146
    v_mfma_f32_32x32x16_bf16 v[48:63], v[92:95], v[188:191], v[48:63]
    s_setprio 0
    v_fmac_f32 v238, v10, v162
    v_fmac_f32 v242, v3, v147
    v_fmac_f32 v238, v11, v163
    v_fmac_f32 v242, v4, v148
    v_fmac_f32 v238, v12, v164
    v_fmac_f32 v242, v5, v149
    v_fmac_f32 v238, v13, v165
    v_fmac_f32 v242, v6, v150
    v_fmac_f32 v238, v14, v166
    v_fmac_f32 v242, v7, v151
    v_fmac_f32 v238, v15, v167
    v_fmac_f32 v236, v16, v112
    v_mul_f32 v244, v24, v160
    v_fmac_f32 v236, v17, v113
    v_fmac_f32 v244, v25, v161
    v_fmac_f32 v236, v18, v114
    v_fmac_f32 v244, v26, v162
    v_fmac_f32 v236, v19, v115
    v_fmac_f32 v244, v27, v163
    v_fmac_f32 v236, v20, v116
    v_fmac_f32 v244, v28, v164
    v_fmac_f32 v236, v21, v117
    v_fmac_f32 v244, v29, v165
    v_fmac_f32 v236, v22, v118
    v_fmac_f32 v244, v30, v166
    v_fmac_f32 v236, v23, v119
    v_fmac_f32 v244, v31, v167
    v_mul_f32 v243, v32, v152
    v_fma_f32 v239, v40, v168, -v239
    v_fmac_f32 v243, v33, v153
    v_fmac_f32 v239, v41, v169
    v_fmac_f32 v243, v34, v154
    v_fmac_f32 v239, v42, v170
    v_fmac_f32 v243, v35, v155
    v_fmac_f32 v239, v43, v171
    v_fmac_f32 v243, v36, v156
    v_fmac_f32 v239, v44, v172
    v_fmac_f32 v243, v37, v157
    v_fmac_f32 v239, v45, v173
    v_fmac_f32 v243, v38, v158
    v_fmac_f32 v239, v46, v174
    v_fmac_f32 v243, v39, v159
    v_fmac_f32 v239, v47, v175
    v_fmac_f32 v237, v48, v120
    v_mul_f32 v245, v56, v168
    v_fmac_f32 v237, v49, v121
    v_fmac_f32 v245, v57, v169
    v_fmac_f32 v237, v50, v122
    v_fmac_f32 v245, v58, v170
    v_fmac_f32 v237, v51, v123
    v_fmac_f32 v245, v59, v171
    v_fmac_f32 v237, v52, v124
    s_setprio 1
    s_waitcnt vmcnt(4) lgkmcnt(1)
    v_mfma_f32_32x32x16_bf16 v[0:15], v[64:67], v[176:179], 0
    ds_read_b64_tr_b16 v[184:185], v246 offset:2048
    ds_read_b64_tr_b16 v[186:187], v246 offset:2560
    ds_read_b64_tr_b16 v[188:189], v247 offset:2048
    ds_read_b64_tr_b16 v[190:191], v247 offset:2560
    s_cmp_lg_u32 s34, 0
    s_cbranch_scc1 K2_ew_84
K2_back_85:
    s_mov_b32 m0, s68
    v_mfma_f32_32x32x16_bf16 v[16:31], v[68:71], v[176:179], 0
    buffer_load_dwordx4 v222, s[4:7], s44 offen sc1 lds
    buffer_load_dwordx4 v223, s[72:75], s44 offen offset:1024 sc1 lds
    s_waitcnt lgkmcnt(4)
    v_mad_u32_u16 v225, v224, s39, v248 op_sel:[1,0,0,0]
    v_mad_u32_u16 v224, v224, s39, v248
    v_fmac_f32 v245, v60, v172
    v_fmac_f32 v237, v53, v125
    v_mfma_f32_32x32x16_bf16 v[32:47], v[64:67], v[180:183], 0
    v_add_u32 v226, s50, v251
    ds_read_b32 v226, v226
    v_fmac_f32 v245, v61, v173
    v_fmac_f32 v237, v54, v126
    v_fmac_f32 v245, v62, v174
    v_fmac_f32 v237, v55, v127
    v_fmac_f32 v245, v63, v175
    v_mfma_f32_32x32x16_bf16 v[48:63], v[68:71], v[180:183], 0
    v_permlane32_swap_b32 v242, v234
    v_permlane32_swap_b32 v243, v235
    v_add_f32 v242, v242, v234
    v_add_f32 v243, v243, v235
    s_waitcnt vmcnt(4) lgkmcnt(1)
    v_mfma_f32_32x32x16_bf16 v[0:15], v[72:75], v[184:187], v[0:15]
    ds_read_b64_tr_b16 v[176:177], v246 offset:4096
    ds_read_b64_tr_b16 v[178:179], v246 offset:4608
    ds_read_b64_tr_b16 v[180:181], v247 offset:4096
    ds_read_b64_tr_b16 v[182:183], v247 offset:4608
    s_mov_b32 m0, s69
    v_mfma_f32_32x32x16_bf16 v[16:31], v[76:79], v[184:187], v[16:31]
    buffer_load_dwordx4 v224, s[4:7], s45 offen sc1 lds
    buffer_load_dwordx4 v225, s[72:75], s45 offen offset:1024 sc1 lds
    s_waitcnt lgkmcnt(4)
    v_mad_u32_u16 v227, v226, s39, v248 op_sel:[1,0,0,0]
    v_mad_u32_u16 v226, v226, s39, v248
    v_mfma_f32_32x32x16_bf16 v[32:47], v[72:75], v[188:191], v[32:47]
    v_add_u32 v228, s51, v251
    ds_read_b32 v228, v228
    s_set_gpr_idx_on s31, gpr_idx(DST)
    s_nop 0
    v_cvt_pk_bf16_f32 v194, v242, v243
    s_set_gpr_idx_off
    v_mfma_f32_32x32x16_bf16 v[48:63], v[76:79], v[188:191], v[48:63]
    s_waitcnt vmcnt(4) lgkmcnt(1)
    v_mfma_f32_32x32x16_bf16 v[0:15], v[80:83], v[176:179], v[0:15]
    ds_read_b64_tr_b16 v[184:185], v246 offset:6144
    ds_read_b64_tr_b16 v[186:187], v246 offset:6656
    ds_read_b64_tr_b16 v[188:189], v247 offset:6144
    ds_read_b64_tr_b16 v[190:191], v247 offset:6656
    s_mov_b32 s32, s31
    s_mov_b32 s31, s35
    s_mov_b32 m0, s70
    v_mfma_f32_32x32x16_bf16 v[16:31], v[84:87], v[176:179], v[16:31]
    buffer_load_dwordx4 v226, s[4:7], s46 offen sc1 lds
    buffer_load_dwordx4 v227, s[72:75], s46 offen offset:1024 sc1 lds
    s_waitcnt lgkmcnt(4)
    v_mad_u32_u16 v229, v228, s39, v248 op_sel:[1,0,0,0]
    v_mad_u32_u16 v228, v228, s39, v248
    s_sub_u32 s26, s48, s29
    s_mov_b32 s29, s48
    v_mfma_f32_32x32x16_bf16 v[32:47], v[80:83], v[180:183], v[32:47]
    s_mov_b32 s30, s3
    s_cmp_eq_u32 s34, 0
    s_cselect_b32 s56, s33, 0
    v_mfma_f32_32x32x16_bf16 v[48:63], v[84:87], v[180:183], v[48:63]
    s_waitcnt vmcnt(4) lgkmcnt(0)
    v_mfma_f32_32x32x16_bf16 v[0:15], v[88:91], v[184:187], v[0:15]
    ds_read_b64_tr_b16 v[176:177], v246 offset:0
    ds_read_b64_tr_b16 v[178:179], v246 offset:512
    ds_read_b64_tr_b16 v[180:181], v247 offset:0
    ds_read_b64_tr_b16 v[182:183], v247 offset:512
    s_mov_b32 m0, s71
    v_mfma_f32_32x32x16_bf16 v[16:31], v[92:95], v[184:187], v[16:31]
    buffer_load_dwordx4 v228, s[4:7], s47 offen sc1 lds
    buffer_load_dwordx4 v229, s[72:75], s47 offen offset:1024 sc1 lds
    v_mfma_f32_32x32x16_bf16 v[32:47], v[88:91], v[188:191], v[32:47]
    s_nop 2
    v_mul_f32 v242, v0, v144
    v_fma_f32 v240, v8, v160, -v240
    v_fmac_f32 v242, v1, v145
    v_fmac_f32 v240, v9, v161
    v_fmac_f32 v242, v2, v146
    v_fmac_f32 v240, v10, v162
    v_fmac_f32 v242, v3, v147
    v_mfma_f32_32x32x16_bf16 v[48:63], v[92:95], v[188:191], v[48:63]
    s_setprio 0
    v_fmac_f32 v240, v11, v163
    v_fmac_f32 v242, v4, v148
    v_fmac_f32 v240, v12, v164
    v_fmac_f32 v242, v5, v149
    v_fmac_f32 v240, v13, v165
    v_fmac_f32 v242, v6, v150
    v_fmac_f32 v240, v14, v166
    v_fmac_f32 v242, v7, v151
    v_fmac_f32 v240, v15, v167
    v_add_u32 v249, s26, v249
    v_add_u32 v250, s26, v250
    v_fma_f32 v244, v16, v160, -v244
    v_fmac_f32 v236, v24, v112
    v_fmac_f32 v244, v17, v161
    v_fmac_f32 v236, v25, v113
    v_fmac_f32 v244, v18, v162
    v_fmac_f32 v236, v26, v114
    v_fmac_f32 v244, v19, v163
    v_fmac_f32 v236, v27, v115
    v_fmac_f32 v244, v20, v164
    v_fmac_f32 v236, v28, v116
    v_fmac_f32 v244, v21, v165
    v_fmac_f32 v236, v29, v117
    v_fmac_f32 v244, v22, v166
    v_fmac_f32 v236, v30, v118
    v_fmac_f32 v244, v23, v167
    v_fmac_f32 v236, v31, v119
    ds_read_b64_tr_b16 v[0:1], v249 offset:0
    ds_read_b64_tr_b16 v[2:3], v249 offset:128
    ds_read_b128 v[4:7], v250 offset:0
    ds_read_b128 v[8:11], v250 offset:16
    ds_read_b128 v[12:15], v250 offset:384
    ds_read_b128 v[16:19], v250 offset:400
    v_mul_f32 v243, v32, v152
    v_fma_f32 v241, v40, v168, -v241
    v_fmac_f32 v243, v33, v153
    v_fmac_f32 v241, v41, v169
    v_fmac_f32 v243, v34, v154
    v_fmac_f32 v241, v42, v170
    v_fmac_f32 v243, v35, v155
    v_fmac_f32 v241, v43, v171
    v_fmac_f32 v243, v36, v156
    v_fmac_f32 v241, v44, v172
    v_fmac_f32 v243, v37, v157
    v_fmac_f32 v241, v45, v173
    v_fmac_f32 v243, v38, v158
    v_fmac_f32 v241, v46, v174
    v_fmac_f32 v243, v39, v159
    v_fmac_f32 v241, v47, v175
    ds_read_b64_tr_b16 v[20:21], v249 offset:512
    ds_read_b64_tr_b16 v[22:23], v249 offset:640
    ds_read_b128 v[24:27], v250 offset:64
    ds_read_b128 v[28:31], v250 offset:80
    ds_read_b128 v[32:35], v250 offset:448
    ds_read_b128 v[36:39], v250 offset:464
    v_fma_f32 v245, v48, v168, -v245
    v_fmac_f32 v237, v56, v120
    v_fmac_f32 v245, v49, v169
    v_fmac_f32 v237, v57, v121
    v_fmac_f32 v245, v50, v170
    v_fmac_f32 v237, v58, v122
    v_fmac_f32 v245, v51, v171
    v_fmac_f32 v237, v59, v123
    v_fmac_f32 v245, v52, v172
    v_fmac_f32 v237, v60, v124
    v_fmac_f32 v245, v53, v173
    v_fmac_f32 v237, v61, v125
    v_fmac_f32 v245, v54, v174
    v_fmac_f32 v237, v62, v126
    v_fmac_f32 v245, v55, v175
    v_fmac_f32 v237, v63, v127
    s_cmp_eq_u32 s56, 2
    s_cbranch_scc1 K2_U20
    s_cmp_eq_u32 s56, 3
    s_cbranch_scc1 K2_U30
    s_branch K2_DSP0
K2_U11:
    s_setprio 1
    v_mov_b32 v254, 163648
    v_mov_b32 v255, 1
    v_lshl_add_u32 v233, v252, 1, s53
    s_mov_b64 exec, 1
    ds_add_rtn_u32 v232, v254, v255
    s_mov_b64 exec, -1
    ds_read_b32 v233, v233
    s_waitcnt lgkmcnt(8)
    v_lshlrev_b32 v40, 16, v0
    v_and_b32 v41, 0xffff0000, v0
    v_lshlrev_b32 v42, 16, v1
    v_and_b32 v43, 0xffff0000, v1
    v_lshlrev_b32 v44, 16, v2
    v_and_b32 v45, 0xffff0000, v2
    v_lshlrev_b32 v46, 16, v3
    v_and_b32 v47, 0xffff0000, v3
    v_mul_f32 v4, v40, v4
    v_mul_f32 v5, v41, v5
    v_mul_f32 v6, v42, v6
    v_mul_f32 v7, v43, v7
    v_mul_f32 v8, v44, v8
    v_mul_f32 v9, v45, v9
    v_mul_f32 v10, v46, v10
    v_mul_f32 v11, v47, v11
    v_cvt_pk_bf16_f32 v64, v4, v5
    v_cvt_pk_bf16_f32 v65, v6, v7
    v_cvt_pk_bf16_f32 v66, v8, v9
    v_cvt_pk_bf16_f32 v67, v10, v11
    v_mul_f32 v12, v40, v12
    v_mul_f32 v13, v41, v13
    v_mul_f32 v14, v42, v14
    v_mul_f32 v15, v43, v15
    v_mul_f32 v16, v44, v16
    v_mul_f32 v17, v45, v17
    v_mul_f32 v18, v46, v18
    v_mul_f32 v19, v47, v19
    v_cvt_pk_bf16_f32 v68, v12, v13
    v_cvt_pk_bf16_f32 v69, v14, v15
    v_cvt_pk_bf16_f32 v70, v16, v17
    v_cvt_pk_bf16_f32 v71, v18, v19
    s_waitcnt lgkmcnt(0)
    v_readfirstlane_b32 s58, v232
    s_nop 0
    s_cmp_lt_u32 s58, s22
    s_cbranch_scc0 K2_nul_90
    s_and_b32 s59, s58, 7
    s_lshr_b32 s60, s58, 3
K2_chk_92:
    v_readlane_b32 s61, v233, s59
    s_nop 0
    s_cmp_gt_u32 s61, s60
    s_cbranch_scc0 K2_spin_91
K2_back_93:
    v_readlane_b32 s3, v253, s58
    s_lshl_b32 s44, s34, 7
    s_lshl_b32 s60, s58, 5
    s_and_b32 s48, s3, 0x3ffff
    s_bfe_u32 s33, s3, 0x30012
    s_sub_u32 s60, s60, s48
    s_and_b32 s60, s60, 0xff
    s_add_u32 s35, s60, s48
    s_mov_b32 s45, s44
    s_add_u32 s47, s44, 256
    s_add_u32 s49, s48, 32
    s_add_u32 s60, s48, 64
    s_cmp_eq_u32 s33, 3
    s_cselect_b32 s46, s44, s47
    s_cselect_b32 s50, s60, s48
    s_cselect_b32 s51, s48, s49
    s_sub_u32 s60, s33, 2
    s_cmp_lt_u32 s60, 2
    s_cbranch_scc0 K2_rare_94
K2_back_95:
    v_add_u32 v222, s48, v251
    ds_read_b32 v222, v222
    v_add_u32 v224, s49, v251
    ds_read_b32 v224, v224
    v_add_u32 v226, s50, v251
    ds_read_b32 v226, v226
    v_add_u32 v228, s51, v251
    ds_read_b32 v228, v228
    s_waitcnt lgkmcnt(3)
    v_mad_u32_u16 v223, v222, s39, v248 op_sel:[1,0,0,0]
    v_mad_u32_u16 v222, v222, s39, v248
    s_waitcnt lgkmcnt(2)
    v_mad_u32_u16 v225, v224, s39, v248 op_sel:[1,0,0,0]
    v_mad_u32_u16 v224, v224, s39, v248
    s_waitcnt lgkmcnt(1)
    v_mad_u32_u16 v227, v226, s39, v248 op_sel:[1,0,0,0]
    v_mad_u32_u16 v226, v226, s39, v248
    s_waitcnt lgkmcnt(0)
    v_mad_u32_u16 v229, v228, s39, v248 op_sel:[1,0,0,0]
    v_mad_u32_u16 v228, v228, s39, v248
    s_waitcnt vmcnt(4)
    v_mfma_f32_32x32x16_bf16 v[0:15], v[64:67], v[176:179], 0
    ds_read_b64_tr_b16 v[184:185], v246 offset:2048
    ds_read_b64_tr_b16 v[186:187], v246 offset:2560
    ds_read_b64_tr_b16 v[188:189], v247 offset:2048
    ds_read_b64_tr_b16 v[190:191], v247 offset:2560
    s_mov_b32 m0, s68
    v_mfma_f32_32x32x16_bf16 v[16:31], v[68:71], v[176:179], 0
    buffer_load_dwordx4 v222, s[4:7], s44 offen sc1 lds
    buffer_load_dwordx4 v223, s[72:75], s44 offen offset:1024 sc1 lds
    v_permlane32_swap_b32 v242, v236
    v_permlane32_swap_b32 v243, v237
    v_mfma_f32_32x32x16_bf16 v[32:47], v[64:67], v[180:183], 0
    v_permlane32_swap_b32 v244, v238
    v_permlane32_swap_b32 v245, v239
    v_permlane32_swap_b32 v240, v241
    v_add_f32 v242, v242, v236
    v_mfma_f32_32x32x16_bf16 v[48:63], v[68:71], v[180:183], 0
    s_setprio 0
    v_add_f32 v243, v243, v237
    v_add_f32 v244, v244, v238
    v_add_f32 v245, v245, v239
    v_add_f32 v240, -v240, -v241
    v_sub_u32 v241, v230, v231
    v_cvt_pk_bf16_f32 v242, v242, v243
    v_cvt_pk_bf16_f32 v244, v244, v245
    v_cvt_pk_bf16_f32 v240, v240, v240
    ds_write_b32 v230, v242 offset:768
    ds_write_b32 v230, v244 offset:1024
    ds_write_b16 v241, v240 offset:1280
    v_mul_f32 v234, v0, v96
    v_mul_f32 v236, v8, v128
    v_fmac_f32 v234, v1, v97
    v_fmac_f32 v236, v9, v129
    v_fmac_f32 v234, v2, v98
    v_fmac_f32 v236, v10, v130
    v_fmac_f32 v234, v3, v99
    v_fmac_f32 v236, v11, v131
    v_fmac_f32 v234, v4, v100
    v_fmac_f32 v236, v12, v132
    v_fmac_f32 v234, v5, v101
    v_fmac_f32 v236, v13, v133
    v_fmac_f32 v234, v6, v102
    v_fmac_f32 v236, v14, v134
    v_fmac_f32 v234, v7, v103
    v_fmac_f32 v236, v15, v135
    v_mul_f32 v238, v16, v128
    v_mul_f32 v240, v24, v128
    v_fmac_f32 v238, v17, v129
    v_fmac_f32 v240, v25, v129
    v_fmac_f32 v238, v18, v130
    v_fmac_f32 v240, v26, v130
    v_fmac_f32 v238, v19, v131
    v_fmac_f32 v240, v27, v131
    v_fmac_f32 v238, v20, v132
    v_fmac_f32 v240, v28, v132
    v_fmac_f32 v238, v21, v133
    v_fmac_f32 v240, v29, v133
    v_fmac_f32 v238, v22, v134
    v_fmac_f32 v240, v30, v134
    v_fmac_f32 v238, v23, v135
    v_fmac_f32 v240, v31, v135
    v_mul_f32 v235, v32, v104
    v_mul_f32 v237, v40, v136
    v_fmac_f32 v235, v33, v105
    v_fmac_f32 v237, v41, v137
    v_fmac_f32 v235, v34, v106
    v_fmac_f32 v237, v42, v138
    v_fmac_f32 v235, v35, v107
    v_fmac_f32 v237, v43, v139
    v_fmac_f32 v235, v36, v108
    v_fmac_f32 v237, v44, v140
    v_fmac_f32 v235, v37, v109
    v_fmac_f32 v237, v45, v141
    v_fmac_f32 v235, v38, v110
    v_fmac_f32 v237, v46, v142
    v_fmac_f32 v235, v39, v111
    v_fmac_f32 v237, v47, v143
    v_mul_f32 v239, v48, v136
    v_mul_f32 v241, v56, v136
    v_fmac_f32 v239, v49, v137
    v_fmac_f32 v241, v57, v137
    v_fmac_f32 v239, v50, v138
    v_fmac_f32 v241, v58, v138
    v_fmac_f32 v239, v51, v139
    v_fmac_f32 v241, v59, v139
    v_fmac_f32 v239, v52, v140
    v_fmac_f32 v241, v60, v140
    v_fmac_f32 v239, v53, v141
    v_fmac_f32 v241, v61, v141
    v_fmac_f32 v239, v54, v142
    v_fmac_f32 v241, v62, v142
    v_fmac_f32 v239, v55, v143
    v_fmac_f32 v241, v63, v143
    s_setprio 1
    s_waitcnt vmcnt(4) lgkmcnt(3)
    v_mfma_f32_32x32x16_bf16 v[0:15], v[64:67], v[184:187], 0
    ds_read_b64_tr_b16 v[176:177], v246 offset:4096
    ds_read_b64_tr_b16 v[178:179], v246 offset:4608
    ds_read_b64_tr_b16 v[180:181], v247 offset:4096
    ds_read_b64_tr_b16 v[182:183], v247 offset:4608
    s_mov_b32 m0, s69
    v_mfma_f32_32x32x16_bf16 v[16:31], v[68:71], v[184:187], 0
    buffer_load_dwordx4 v224, s[4:7], s45 offen sc1 lds
    buffer_load_dwordx4 v225, s[72:75], s45 offen offset:1024 sc1 lds
    v_permlane32_swap_b32 v234, v236
    v_permlane32_swap_b32 v235, v237
    v_mfma_f32_32x32x16_bf16 v[32:47], v[64:67], v[188:191], 0
    v_permlane32_swap_b32 v240, v238
    v_permlane32_swap_b32 v241, v239
    v_lshl_add_u32 v230, v252, 1, s31
    v_add_f32 v234, v234, v236
    v_add_f32 v235, v235, v237
    v_mfma_f32_32x32x16_bf16 v[48:63], v[68:71], v[188:191], 0
    s_setprio 0
    v_add_f32 v240, v240, v238
    v_add_f32 v241, v241, v239
    v_cvt_pk_bf16_f32 v234, v234, v235
    v_cvt_pk_bf16_f32 v240, v240, v241
    ds_write_b32 v230, v234 offset:0
    ds_write_b32 v230, v240 offset:256
    v_mul_f32 v234, v0, v144
    v_mul_f32 v236, v8, v112
    v_fmac_f32 v234, v1, v145
    v_fmac_f32 v236, v9, v113
    v_fmac_f32 v234, v2, v146
    v_fmac_f32 v236, v10, v114
    v_fmac_f32 v234, v3, v147
    v_fmac_f32 v236, v11, v115
    v_fmac_f32 v234, v4, v148
    v_fmac_f32 v236, v12, v116
    v_fmac_f32 v234, v5, v149
    v_fmac_f32 v236, v13, v117
    v_fmac_f32 v234, v6, v150
    v_fmac_f32 v236, v14, v118
    v_fmac_f32 v234, v7, v151
    v_fmac_f32 v236, v15, v119
    v_mul_f32 v238, v16, v160
    v_mul_f32 v240, v24, v160
    v_fmac_f32 v238, v17, v161
    v_fmac_f32 v240, v25, v161
    v_fmac_f32 v238, v18, v162
    v_fmac_f32 v240, v26, v162
    v_fmac_f32 v238, v19, v163
    v_fmac_f32 v240, v27, v163
    v_fmac_f32 v238, v20, v164
    v_fmac_f32 v240, v28, v164
    v_fmac_f32 v238, v21, v165
    v_fmac_f32 v240, v29, v165
    v_fmac_f32 v238, v22, v166
    v_fmac_f32 v240, v30, v166
    v_fmac_f32 v238, v23, v167
    v_fmac_f32 v240, v31, v167
    v_mul_f32 v235, v32, v152
    v_mul_f32 v237, v40, v120
    v_fmac_f32 v235, v33, v153
    v_fmac_f32 v237, v41, v121
    v_fmac_f32 v235, v34, v154
    v_fmac_f32 v237, v42, v122
    v_fmac_f32 v235, v35, v155
    v_fmac_f32 v237, v43, v123
    v_fmac_f32 v235, v36, v156
    v_fmac_f32 v237, v44, v124
    v_fmac_f32 v235, v37, v157
    v_fmac_f32 v237, v45, v125
    v_fmac_f32 v235, v38, v158
    v_fmac_f32 v237, v46, v126
    v_fmac_f32 v235, v39, v159
    v_fmac_f32 v237, v47, v127
    v_mul_f32 v239, v48, v168
    v_mul_f32 v241, v56, v168
    v_fmac_f32 v239, v49, v169
    v_fmac_f32 v241, v57, v169
    v_fmac_f32 v239, v50, v170
    v_fmac_f32 v241, v58, v170
    v_fmac_f32 v239, v51, v171
    v_fmac_f32 v241, v59, v171
    v_fmac_f32 v239, v52, v172
    v_fmac_f32 v241, v60, v172
    v_fmac_f32 v239, v53, v173
    v_fmac_f32 v241, v61, v173
    v_fmac_f32 v239, v54, v174
    v_fmac_f32 v241, v62, v174
    v_fmac_f32 v239, v55, v175
    v_fmac_f32 v241, v63, v175
    s_setprio 1
    s_waitcnt vmcnt(4) lgkmcnt(2)
    v_mfma_f32_32x32x16_bf16 v[0:15], v[64:67], v[176:179], 0
    ds_read_b64_tr_b16 v[184:185], v246 offset:6144
    ds_read_b64_tr_b16 v[186:187], v246 offset:6656
    ds_read_b64_tr_b16 v[188:189], v247 offset:6144
    ds_read_b64_tr_b16 v[190:191], v247 offset:6656
    s_mov_b32 s32, s31
    s_mov_b32 s31, s35
    s_mov_b32 m0, s70
    v_mfma_f32_32x32x16_bf16 v[16:31], v[68:71], v[176:179], 0
    buffer_load_dwordx4 v226, s[4:7], s46 offen sc1 lds
    buffer_load_dwordx4 v227, s[72:75], s46 offen offset:1024 sc1 lds
    s_sub_u32 s26, s48, s29
    s_mov_b32 s29, s48
    s_mov_b32 s30, s3
    s_cmp_lg_u32 s36, 0
    s_cselect_b32 s56, s33, 0
    v_mfma_f32_32x32x16_bf16 v[32:47], v[64:67], v[180:183], 0
    v_mfma_f32_32x32x16_bf16 v[48:63], v[68:71], v[180:183], 0
    s_setprio 0
    v_mul_f32 v242, v0, v144
    v_fma_f32 v238, v8, v160, -v238
    v_fmac_f32 v242, v1, v145
    v_fmac_f32 v238, v9, v161
    v_fmac_f32 v242, v2, v146
    v_fmac_f32 v238, v10, v162
    v_fmac_f32 v242, v3, v147
    v_fmac_f32 v238, v11, v163
    v_fmac_f32 v242, v4, v148
    v_fmac_f32 v238, v12, v164
    v_fmac_f32 v242, v5, v149
    v_fmac_f32 v238, v13, v165
    v_fmac_f32 v242, v6, v150
    v_fmac_f32 v238, v14, v166
    v_fmac_f32 v242, v7, v151
    v_fmac_f32 v238, v15, v167
    v_fmac_f32 v236, v16, v112
    v_mul_f32 v244, v24, v160
    v_fmac_f32 v236, v17, v113
    v_fmac_f32 v244, v25, v161
    v_fmac_f32 v236, v18, v114
    v_fmac_f32 v244, v26, v162
    v_fmac_f32 v236, v19, v115
    v_fmac_f32 v244, v27, v163
    v_fmac_f32 v236, v20, v116
    v_fmac_f32 v244, v28, v164
    v_fmac_f32 v236, v21, v117
    v_fmac_f32 v244, v29, v165
    v_fmac_f32 v236, v22, v118
    v_fmac_f32 v244, v30, v166
    v_fmac_f32 v236, v23, v119
    v_fmac_f32 v244, v31, v167
    v_mul_f32 v243, v32, v152
    v_fma_f32 v239, v40, v168, -v239
    v_fmac_f32 v243, v33, v153
    v_fmac_f32 v239, v41, v169
    v_fmac_f32 v243, v34, v154
    v_fmac_f32 v239, v42, v170
    v_fmac_f32 v243, v35, v155
    v_fmac_f32 v239, v43, v171
    v_fmac_f32 v243, v36, v156
    v_fmac_f32 v239, v44, v172
    v_fmac_f32 v243, v37, v157
    v_fmac_f32 v239, v45, v173
    v_fmac_f32 v243, v38, v158
    v_fmac_f32 v239, v46, v174
    v_fmac_f32 v243, v39, v159
    v_fmac_f32 v239, v47, v175
    v_fmac_f32 v237, v48, v120
    v_mul_f32 v245, v56, v168
    v_fmac_f32 v237, v49, v121
    v_fmac_f32 v245, v57, v169
    v_fmac_f32 v237, v50, v122
    v_fmac_f32 v245, v58, v170
    v_fmac_f32 v237, v51, v123
    v_fmac_f32 v245, v59, v171
    v_fmac_f32 v237, v52, v124
    v_fmac_f32 v245, v60, v172
    v_fmac_f32 v237, v53, v125
    v_fmac_f32 v245, v61, v173
    v_fmac_f32 v237, v54, v126
    v_fmac_f32 v245, v62, v174
    v_fmac_f32 v237, v55, v127
    v_fmac_f32 v245, v63, v175
    s_setprio 1
    s_waitcnt vmcnt(4) lgkmcnt(0)
    v_mfma_f32_32x32x16_bf16 v[0:15], v[64:67], v[184:187], 0
    ds_read_b64_tr_b16 v[176:177], v246 offset:0
    ds_read_b64_tr_b16 v[178:179], v246 offset:512
    ds_read_b64_tr_b16 v[180:181], v247 offset:0
    ds_read_b64_tr_b16 v[182:183], v247 offset:512
    s_mov_b32 m0, s71
    v_mfma_f32_32x32x16_bf16 v[16:31], v[68:71], v[184:187], 0
    buffer_load_dwordx4 v228, s[4:7], s47 offen sc1 lds
    buffer_load_dwordx4 v229, s[72:75], s47 offen offset:1024 sc1 lds
    v_permlane32_swap_b32 v242, v234
    v_permlane32_swap_b32 v243, v235
    v_add_f32 v242, v242, v234
    v_mfma_f32_32x32x16_bf16 v[32:47], v[64:67], v[188:191], 0
    v_add_f32 v243, v243, v235
    v_cvt_pk_bf16_f32 v242, v242, v243
    ds_write_b32 v230, v242 offset:512
    v_mfma_f32_32x32x16_bf16 v[48:63], v[68:71], v[188:191], 0
    s_setprio 0
    v_mul_f32 v242, v0, v144
    v_fma_f32 v240, v8, v160, -v240
    v_fmac_f32 v242, v1, v145
    v_fmac_f32 v240, v9, v161
    v_fmac_f32 v242, v2, v146
    v_fmac_f32 v240, v10, v162
    v_fmac_f32 v242, v3, v147
    v_fmac_f32 v240, v11, v163
    v_fmac_f32 v242, v4, v148
    v_fmac_f32 v240, v12, v164
    v_fmac_f32 v242, v5, v149
    v_fmac_f32 v240, v13, v165
    v_fmac_f32 v242, v6, v150
    v_fmac_f32 v240, v14, v166
    v_fmac_f32 v242, v7, v151
    v_fmac_f32 v240, v15, v167
    v_add_u32 v249, s26, v249
    v_add_u32 v250, s26, v250
    v_fma_f32 v244, v16, v160, -v244
    v_fmac_f32 v236, v24, v112
    v_fmac_f32 v244, v17, v161
    v_fmac_f32 v236, v25, v113
    v_fmac_f32 v244, v18, v162
    v_fmac_f32 v236, v26, v114
    v_fmac_f32 v244, v19, v163
    v_fmac_f32 v236, v27, v115
    v_fmac_f32 v244, v20, v164
    v_fmac_f32 v236, v28, v116
    v_fmac_f32 v244, v21, v165
    v_fmac_f32 v236, v29, v117
    v_fmac_f32 v244, v22, v166
    v_fmac_f32 v236, v30, v118
    v_fmac_f32 v244, v23, v167
    v_fmac_f32 v236, v31, v119
    ds_read_b64_tr_b16 v[0:1], v249 offset:0
    ds_read_b64_tr_b16 v[2:3], v249 offset:128
    ds_read_b128 v[4:7], v250 offset:0
    ds_read_b128 v[8:11], v250 offset:16
    ds_read_b128 v[12:15], v250 offset:384
    ds_read_b128 v[16:19], v250 offset:400
    v_mul_f32 v243, v32, v152
    v_fma_f32 v241, v40, v168, -v241
    v_fmac_f32 v243, v33, v153
    v_fmac_f32 v241, v41, v169
    v_fmac_f32 v243, v34, v154
    v_fmac_f32 v241, v42, v170
    v_fmac_f32 v243, v35, v155
    v_fmac_f32 v241, v43, v171
    v_fmac_f32 v243, v36, v156
    v_fmac_f32 v241, v44, v172
    v_fmac_f32 v243, v37, v157
    v_fmac_f32 v241, v45, v173
    v_fmac_f32 v243, v38, v158
    v_fmac_f32 v241, v46, v174
    v_fmac_f32 v243, v39, v159
    v_fmac_f32 v241, v47, v175
    ds_read_b64_tr_b16 v[20:21], v249 offset:512
    ds_read_b64_tr_b16 v[22:23], v249 offset:640
    ds_read_b128 v[24:27], v250 offset:64
    ds_read_b128 v[28:31], v250 offset:80
    ds_read_b128 v[32:35], v250 offset:448
    ds_read_b128 v[36:39], v250 offset:464
    v_fma_f32 v245, v48, v168, -v245
    v_fmac_f32 v237, v56, v120
    v_fmac_f32 v245, v49, v169
    v_fmac_f32 v237, v57, v121
    v_fmac_f32 v245, v50, v170
    v_fmac_f32 v237, v58, v122
    v_fmac_f32 v245, v51, v171
    v_fmac_f32 v237, v59, v123
    v_fmac_f32 v245, v52, v172
    v_fmac_f32 v237, v60, v124
    v_fmac_f32 v245, v53, v173
    v_fmac_f32 v237, v61, v125
    v_fmac_f32 v245, v54, v174
    v_fmac_f32 v237, v62, v126
    v_fmac_f32 v245, v55, v175
    v_fmac_f32 v237, v63, v127
    s_cmp_eq_u32 s56, 2
    s_cbranch_scc1 K2_U21
    s_cmp_eq_u32 s56, 3
    s_cbranch_scc1 K2_U31
    s_branch K2_DSP1
K2_U41:
    s_setprio 1
    s_waitcnt lgkmcnt(6)
    v_lshlrev_b32 v40, 16, v0
    v_and_b32 v41, 0xffff0000, v0
    v_lshlrev_b32 v42, 16, v1
    v_and_b32 v43, 0xffff0000, v1
    v_lshlrev_b32 v44, 16, v2
    v_and_b32 v45, 0xffff0000, v2
    v_lshlrev_b32 v46, 16, v3
    v_and_b32 v47, 0xffff0000, v3
    v_mul_f32 v4, v40, v4
    v_mul_f32 v5, v41, v5
    v_mul_f32 v6, v42, v6
    v_mul_f32 v7, v43, v7
    v_mul_f32 v8, v44, v8
    v_mul_f32 v9, v45, v9
    v_mul_f32 v10, v46, v10
    v_mul_f32 v11, v47, v11
    v_cvt_pk_bf16_f32 v64, v4, v5
    v_cvt_pk_bf16_f32 v65, v6, v7
    v_cvt_pk_bf16_f32 v66, v8, v9
    v_cvt_pk_bf16_f32 v67, v10, v11
    v_mul_f32 v12, v40, v12
    v_mul_f32 v13, v41, v13
    v_mul_f32 v14, v42, v14
    v_mul_f32 v15, v43, v15
    v_mul_f32 v16, v44, v16
    v_mul_f32 v17, v45, v17
    v_mul_f32 v18, v46, v18
    v_mul_f32 v19, v47, v19
    v_cvt_pk_bf16_f32 v68, v12, v13
    v_cvt_pk_bf16_f32 v69, v14, v15
    v_cvt_pk_bf16_f32 v70, v16, v17
    v_cvt_pk_bf16_f32 v71, v18, v19
    ds_read_b64_tr_b16 v[0:1], v249 offset:1024
    ds_read_b64_tr_b16 v[2:3], v249 offset:1152
    ds_read_b128 v[4:7], v250 offset:128
    ds_read_b128 v[8:11], v250 offset:144
    ds_read_b128 v[12:15], v250 offset:512
    ds_read_b128 v[16:19], v250 offset:528
    s_waitcnt lgkmcnt(6)
    v_lshlrev_b32 v48, 16, v20
    v_and_b32 v49, 0xffff0000, v20
    v_lshlrev_b32 v50, 16, v21
    v_and_b32 v51, 0xffff0000, v21
    v_lshlrev_b32 v52, 16, v22
    v_and_b32 v53, 0xffff0000, v22
    v_lshlrev_b32 v54, 16, v23
    v_and_b32 v55, 0xffff0000, v23
    v_mul_f32 v24, v48, v24
    v_mul_f32 v25, v49, v25
    v_mul_f32 v26, v50, v26
    v_mul_f32 v27, v51, v27
    v_mul_f32 v28, v52, v28
    v_mul_f32 v29, v53, v29
    v_mul_f32 v30, v54, v30
    v_mul_f32 v31, v55, v31
    v_cvt_pk_bf16_f32 v72, v24, v25
    v_cvt_pk_bf16_f32 v73, v26, v27
    v_cvt_pk_bf16_f32 v74, v28, v29
    v_cvt_pk_bf16_f32 v75, v30, v31
    v_mul_f32 v32, v48, v32
    v_mul_f32 v33, v49, v33
    v_mul_f32 v34, v50, v34
    v_mul_f32 v35, v51, v35
    v_mul_f32 v36, v52, v36
    v_mul_f32 v37, v53, v37
    v_mul_f32 v38, v54, v38
    v_mul_f32 v39, v55, v39
    v_cvt_pk_bf16_f32 v76, v32, v33
    v_cvt_pk_bf16_f32 v77, v34, v35
    v_cvt_pk_bf16_f32 v78, v36, v37
    v_cvt_pk_bf16_f32 v79, v38, v39
    s_lshr_b32 s65, s30, 27
    s_mov_b32 s66, 161536
    s_cmp_ge_u32 s65, 2
    s_cselect_b32 s66, 158112, s66
    s_mul_i32 s65, s65, 512
    s_add_u32 s65, s65, s66
    s_sub_u32 s65, s65, s29
    v_add_u32 v56, s65, v249
    s_lshr_b32 s65, s30, 27
    s_mov_b32 s66, 161536
    s_cmp_ge_u32 s65, 2
    s_cselect_b32 s66, 159008, s66
    s_mul_i32 s65, s65, 64
    s_add_u32 s65, s65, s66
    s_sub_u32 s65, s65, s29
    v_add_u32 v57, s65, v250
    ds_read_b64_tr_b16 v[20:21], v56 offset:0
    ds_read_b64_tr_b16 v[22:23], v56 offset:128
    ds_read_b128 v[24:27], v57 offset:0
    ds_read_b128 v[28:31], v57 offset:16
    ds_read_b128 v[32:35], v57 offset:384
    ds_read_b128 v[36:39], v57 offset:400
    s_waitcnt lgkmcnt(10)
    v_lshlrev_b32 v40, 16, v0
    v_and_b32 v41, 0xffff0000, v0
    v_lshlrev_b32 v42, 16, v1
    v_and_b32 v43, 0xffff0000, v1
    v_lshlrev_b32 v44, 16, v2
    v_and_b32 v45, 0xffff0000, v2
    v_lshlrev_b32 v46, 16, v3
    v_and_b32 v47, 0xffff0000, v3
    s_waitcnt lgkmcnt(8)
    v_mul_f32 v4, v40, v4
    v_mul_f32 v5, v41, v5
    v_mul_f32 v6, v42, v6
    v_mul_f32 v7, v43, v7
    v_mul_f32 v8, v44, v8
    v_mul_f32 v9, v45, v9
    v_mul_f32 v10, v46, v10
    v_mul_f32 v11, v47, v11
    v_cvt_pk_bf16_f32 v80, v4, v5
    v_cvt_pk_bf16_f32 v81, v6, v7
    v_cvt_pk_bf16_f32 v82, v8, v9
    v_cvt_pk_bf16_f32 v83, v10, v11
    s_waitcnt lgkmcnt(6)
    v_mul_f32 v12, v40, v12
    v_mul_f32 v13, v41, v13
    v_mul_f32 v14, v42, v14
    v_mul_f32 v15, v43, v15
    v_mul_f32 v16, v44, v16
    v_mul_f32 v17, v45, v17
    v_mul_f32 v18, v46, v18
    v_mul_f32 v19, v47, v19
    v_cvt_pk_bf16_f32 v84, v12, v13
    v_cvt_pk_bf16_f32 v85, v14, v15
    v_cvt_pk_bf16_f32 v86, v16, v17
    v_cvt_pk_bf16_f32 v87, v18, v19
    s_waitcnt lgkmcnt(4)
    v_lshlrev_b32 v48, 16, v20
    v_and_b32 v49, 0xffff0000, v20
    v_lshlrev_b32 v50, 16, v21
    v_and_b32 v51, 0xffff0000, v21
    v_lshlrev_b32 v52, 16, v22
    v_and_b32 v53, 0xffff0000, v22
    v_lshlrev_b32 v54, 16, v23
    v_and_b32 v55, 0xffff0000, v23
    s_waitcnt lgkmcnt(2)
    v_mul_f32 v24, v48, v24
    v_mul_f32 v25, v49, v25
    v_mul_f32 v26, v50, v26
    v_mul_f32 v27, v51, v27
    v_mul_f32 v28, v52, v28
    v_mul_f32 v29, v53, v29
    v_mul_f32 v30, v54, v30
    v_mul_f32 v31, v55, v31
    v_cvt_pk_bf16_f32 v88, v24, v25
    v_cvt_pk_bf16_f32 v89, v26, v27
    v_cvt_pk_bf16_f32 v90, v28, v29
    v_cvt_pk_bf16_f32 v91, v30, v31
    s_waitcnt lgkmcnt(0)
    v_mul_f32 v32, v48, v32
    v_mul_f32 v33, v49, v33
    v_mul_f32 v34, v50, v34
    v_mul_f32 v35, v51, v35
    v_mul_f32 v36, v52, v36
    v_mul_f32 v37, v53, v37
    v_mul_f32 v38, v54, v38
    v_mul_f32 v39, v55, v39
    v_cvt_pk_bf16_f32 v92, v32, v33
    v_cvt_pk_bf16_f32 v93, v34, v35
    v_cvt_pk_bf16_f32 v94, v36, v37
    v_cvt_pk_bf16_f32 v95, v38, v39
    s_waitcnt vmcnt(4)
    v_mfma_f32_32x32x16_bf16 v[0:15], v[64:67], v[176:179], 0
    ds_read_b64_tr_b16 v[184:185], v246 offset:2048
    ds_read_b64_tr_b16 v[186:187], v246 offset:2560
    ds_read_b64_tr_b16 v[188:189], v247 offset:2048
    ds_read_b64_tr_b16 v[190:191], v247 offset:2560
    s_mov_b32 m0, s68
    v_mfma_f32_32x32x16_bf16 v[16:31], v[68:71], v[176:179], 0
    buffer_load_dwordx4 v222, s[4:7], s41 offen sc1 lds
    buffer_load_dwordx4 v223, s[72:75], s41 offen offset:1024 sc1 lds
    v_permlane32_swap_b32 v242, v236
    v_permlane32_swap_b32 v243, v237
    v_mov_b32 v254, 163648
    v_mfma_f32_32x32x16_bf16 v[32:47], v[64:67], v[180:183], 0
    v_permlane32_swap_b32 v244, v238
    v_permlane32_swap_b32 v245, v239
    v_permlane32_swap_b32 v240, v241
    v_add_f32 v242, v242, v236
    v_mfma_f32_32x32x16_bf16 v[48:63], v[68:71], v[180:183], 0
    v_add_f32 v243, v243, v237
    v_add_f32 v244, v244, v238
    v_add_f32 v245, v245, v239
    v_add_f32 v240, -v240, -v241
    v_sub_u32 v241, v230, v231
    v_cvt_pk_bf16_f32 v242, v242, v243
    v_mov_b32 v255, 1
    v_lshl_add_u32 v233, v252, 1, s53
    s_mov_b64 exec, 1
    ds_add_rtn_u32 v232, v254, v255
    s_mov_b64 exec, -1
    ds_read_b32 v233, v233
    s_waitcnt vmcnt(4) lgkmcnt(2)
    v_mfma_f32_32x32x16_bf16 v[0:15], v[72:75], v[184:187], v[0:15]
    ds_read_b64_tr_b16 v[176:177], v246 offset:4096
    ds_read_b64_tr_b16 v[178:179], v246 offset:4608
    ds_read_b64_tr_b16 v[180:181], v247 offset:4096
    ds_read_b64_tr_b16 v[182:183], v247 offset:4608
    v_cvt_pk_bf16_f32 v244, v244, v245
    v_cvt_pk_bf16_f32 v240, v240, v240
    s_mov_b32 m0, s69
    v_mfma_f32_32x32x16_bf16 v[16:31], v[76:79], v[184:187], v[16:31]
    buffer_load_dwordx4 v224, s[4:7], s41 offen sc1 lds
    buffer_load_dwordx4 v225, s[72:75], s41 offen offset:1024 sc1 lds
    ds_write_b32 v230, v242 offset:768
    ds_write_b32 v230, v244 offset:1024
    ds_write_b16 v241, v240 offset:1280
    s_waitcnt lgkmcnt(7)
    v_readfirstlane_b32 s58, v232
    v_mfma_f32_32x32x16_bf16 v[32:47], v[72:75], v[188:191], v[32:47]
    s_cmp_lt_u32 s58, s22
    s_cbranch_scc0 K2_nul_97
    s_and_b32 s59, s58, 7
    s_lshr_b32 s60, s58, 3
K2_chk_99:
    v_readlane_b32 s61, v233, s59
    s_nop 0
    s_cmp_gt_u32 s61, s60
    s_cbranch_scc0 K2_spin_98
K2_back_100:
    v_mfma_f32_32x32x16_bf16 v[48:63], v[76:79], v[188:191], v[48:63]
    v_readlane_b32 s3, v253, s58
    s_lshl_b32 s44, s34, 7
    s_lshl_b32 s60, s58, 5
    s_and_b32 s48, s3, 0x3ffff
    s_bfe_u32 s33, s3, 0x30012
    s_sub_u32 s60, s60, s48
    s_waitcnt vmcnt(4) lgkmcnt(3)
    v_mfma_f32_32x32x16_bf16 v[0:15], v[80:83], v[176:179], v[0:15]
    ds_read_b64_tr_b16 v[184:185], v246 offset:6144
    ds_read_b64_tr_b16 v[186:187], v246 offset:6656
    ds_read_b64_tr_b16 v[188:189], v247 offset:6144
    ds_read_b64_tr_b16 v[190:191], v247 offset:6656
    s_and_b32 s60, s60, 0xff
    s_add_u32 s35, s60, s48
    s_mov_b32 m0, s70
    v_mfma_f32_32x32x16_bf16 v[16:31], v[84:87], v[176:179], v[16:31]
    buffer_load_dwordx4 v226, s[4:7], s41 offen sc1 lds
    buffer_load_dwordx4 v227, s[72:75], s41 offen offset:1024 sc1 lds
    s_mov_b32 s45, s44
    s_add_u32 s47, s44, 256
    s_add_u32 s49, s48, 32
    s_add_u32 s60, s48, 64
    v_mfma_f32_32x32x16_bf16 v[32:47], v[80:83], v[180:183], v[32:47]
    s_cmp_eq_u32 s33, 3
    s_cselect_b32 s46, s44, s47
    s_cselect_b32 s50, s60, s48
    s_cselect_b32 s51, s48, s49
    s_sub_u32 s60, s33, 2
    s_cmp_lt_u32 s60, 2
    s_cbranch_scc0 K2_rare_101
K2_back_102:
    v_mfma_f32_32x32x16_bf16 v[48:63], v[84:87], v[180:183], v[48:63]
    s_waitcnt vmcnt(4) lgkmcnt(0)
    v_mfma_f32_32x32x16_bf16 v[0:15], v[88:91], v[184:187], v[0:15]
    ds_read_b64_tr_b16 v[176:177], v246 offset:0
    ds_read_b64_tr_b16 v[178:179], v246 offset:512
    ds_read_b64_tr_b16 v[180:181], v247 offset:0
    ds_read_b64_tr_b16 v[182:183], v247 offset:512
    s_mov_b32 m0, s71
    v_mfma_f32_32x32x16_bf16 v[16:31], v[92:95], v[184:187], v[16:31]
    buffer_load_dwordx4 v228, s[4:7], s41 offen sc1 lds
    buffer_load_dwordx4 v229, s[72:75], s41 offen offset:1024 sc1 lds
    v_mfma_f32_32x32x16_bf16 v[32:47], v[88:91], v[188:191], v[32:47]
    s_nop 2
    v_mul_f32 v234, v0, v96
    v_mul_f32 v236, v8, v128
    v_fmac_f32 v234, v1, v97
    v_fmac_f32 v236, v9, v129
    v_fmac_f32 v234, v2, v98
    v_fmac_f32 v236, v10, v130
    v_fmac_f32 v234, v3, v99
    v_mfma_f32_32x32x16_bf16 v[48:63], v[92:95], v[188:191], v[48:63]
    s_setprio 0
    v_fmac_f32 v236, v11, v131
    v_fmac_f32 v234, v4, v100
    v_fmac_f32 v236, v12, v132
    v_fmac_f32 v234, v5, v101
    v_fmac_f32 v236, v13, v133
    v_fmac_f32 v234, v6, v102
    v_fmac_f32 v236, v14, v134
    v_fmac_f32 v234, v7, v103
    v_fmac_f32 v236, v15, v135
    v_mul_f32 v238, v16, v128
    v_mul_f32 v240, v24, v128
    v_fmac_f32 v238, v17, v129
    v_fmac_f32 v240, v25, v129
    v_fmac_f32 v238, v18, v130
    v_fmac_f32 v240, v26, v130
    v_fmac_f32 v238, v19, v131
    v_fmac_f32 v240, v27, v131
    v_fmac_f32 v238, v20, v132
    v_fmac_f32 v240, v28, v132
    v_fmac_f32 v238, v21, v133
    v_fmac_f32 v240, v29, v133
    v_fmac_f32 v238, v22, v134
    v_fmac_f32 v240, v30, v134
    v_fmac_f32 v238, v23, v135
    v_fmac_f32 v240, v31, v135
    v_mul_f32 v235, v32, v104
    v_mul_f32 v237, v40, v136
    v_fmac_f32 v235, v33, v105
    v_fmac_f32 v237, v41, v137
    v_fmac_f32 v235, v34, v106
    v_fmac_f32 v237, v42, v138
    v_fmac_f32 v235, v35, v107
    v_fmac_f32 v237, v43, v139
    v_fmac_f32 v235, v36, v108
    v_fmac_f32 v237, v44, v140
    v_fmac_f32 v235, v37, v109
    v_fmac_f32 v237, v45, v141
    v_fmac_f32 v235, v38, v110
    v_fmac_f32 v237, v46, v142
    v_fmac_f32 v235, v39, v111
    v_fmac_f32 v237, v47, v143
    v_mul_f32 v239, v48, v136
    v_mul_f32 v241, v56, v136
    s_setprio 1
    s_waitcnt vmcnt(4) lgkmcnt(0)
    v_mfma_f32_32x32x16_bf16 v[0:15], v[64:67], v[176:179], 0
    ds_read_b64_tr_b16 v[184:185], v246 offset:2048
    ds_read_b64_tr_b16 v[186:187], v246 offset:2560
    ds_read_b64_tr_b16 v[188:189], v247 offset:2048
    ds_read_b64_tr_b16 v[190:191], v247 offset:2560
    v_fmac_f32 v239, v49, v137
    v_fmac_f32 v241, v57, v137
    s_mov_b32 m0, s68
    v_mfma_f32_32x32x16_bf16 v[16:31], v[68:71], v[176:179], 0
    buffer_load_dwordx4 v222, s[4:7], s42 offen sc1 lds
    buffer_load_dwordx4 v223, s[72:75], s42 offen offset:1024 sc1 lds
    v_fmac_f32 v239, v50, v138
    v_fmac_f32 v241, v58, v138
    v_fmac_f32 v239, v51, v139
    v_fmac_f32 v241, v59, v139
    v_fmac_f32 v239, v52, v140
    v_mfma_f32_32x32x16_bf16 v[32:47], v[64:67], v[180:183], 0
    v_fmac_f32 v241, v60, v140
    v_fmac_f32 v239, v53, v141
    v_fmac_f32 v241, v61, v141
    v_fmac_f32 v239, v54, v142
    v_fmac_f32 v241, v62, v142
    v_fmac_f32 v239, v55, v143
    v_fmac_f32 v241, v63, v143
    v_mfma_f32_32x32x16_bf16 v[48:63], v[68:71], v[180:183], 0
    v_permlane32_swap_b32 v234, v236
    v_permlane32_swap_b32 v235, v237
    v_permlane32_swap_b32 v240, v238
    s_waitcnt vmcnt(4) lgkmcnt(0)
    v_mfma_f32_32x32x16_bf16 v[0:15], v[72:75], v[184:187], v[0:15]
    ds_read_b64_tr_b16 v[176:177], v246 offset:4096
    ds_read_b64_tr_b16 v[178:179], v246 offset:4608
    ds_read_b64_tr_b16 v[180:181], v247 offset:4096
    ds_read_b64_tr_b16 v[182:183], v247 offset:4608
    v_permlane32_swap_b32 v241, v239
    s_mov_b32 m0, s69
    v_mfma_f32_32x32x16_bf16 v[16:31], v[76:79], v[184:187], v[16:31]
    buffer_load_dwordx4 v224, s[4:7], s42 offen sc1 lds
    buffer_load_dwordx4 v225, s[72:75], s42 offen offset:1024 sc1 lds
    v_lshl_add_u32 v230, v252, 1, s31
    v_add_f32 v234, v234, v236
    v_add_f32 v235, v235, v237
    v_add_f32 v240, v240, v238
    v_add_f32 v241, v241, v239
    v_mfma_f32_32x32x16_bf16 v[32:47], v[72:75], v[188:191], v[32:47]
    v_cvt_pk_bf16_f32 v234, v234, v235
    v_cvt_pk_bf16_f32 v240, v240, v241
    ds_write_b32 v230, v234 offset:0
    ds_write_b32 v230, v240 offset:256
    v_mfma_f32_32x32x16_bf16 v[48:63], v[76:79], v[188:191], v[48:63]
    s_waitcnt vmcnt(4) lgkmcnt(2)
    v_mfma_f32_32x32x16_bf16 v[0:15], v[80:83], v[176:179], v[0:15]
    ds_read_b64_tr_b16 v[184:185], v246 offset:6144
    ds_read_b64_tr_b16 v[186:187], v246 offset:6656
    ds_read_b64_tr_b16 v[188:189], v247 offset:6144
    ds_read_b64_tr_b16 v[190:191], v247 offset:6656
    s_mov_b32 m0, s70
    v_mfma_f32_32x32x16_bf16 v[16:31], v[84:87], v[176:179], v[16:31]
    buffer_load_dwordx4 v226, s[4:7], s42 offen sc1 lds
    buffer_load_dwordx4 v227, s[72:75], s42 offen offset:1024 sc1 lds
    v_mfma_f32_32x32x16_bf16 v[32:47], v[80:83], v[180:183], v[32:47]
    v_mfma_f32_32x32x16_bf16 v[48:63], v[84:87], v[180:183], v[48:63]
    s_waitcnt vmcnt(4) lgkmcnt(0)
    v_mfma_f32_32x32x16_bf16 v[0:15], v[88:91], v[184:187], v[0:15]
    ds_read_b64_tr_b16 v[176:177], v246 offset:0
    ds_read_b64_tr_b16 v[178:179], v246 offset:512
    ds_read_b64_tr_b16 v[180:181], v247 offset:0
    ds_read_b64_tr_b16 v[182:183], v247 offset:512
    s_mov_b32 m0, s71
    v_mfma_f32_32x32x16_bf16 v[16:31], v[92:95], v[184:187], v[16:31]
    buffer_load_dwordx4 v228, s[4:7], s42 offen sc1 lds
    buffer_load_dwordx4 v229, s[72:75], s42 offen offset:1024 sc1 lds
    v_mfma_f32_32x32x16_bf16 v[32:47], v[88:91], v[188:191], v[32:47]
    s_nop 2
    v_mul_f32 v234, v0, v144
    v_mul_f32 v236, v8, v112
    v_fmac_f32 v234, v1, v145
    v_fmac_f32 v236, v9, v113
    v_fmac_f32 v234, v2, v146
    v_fmac_f32 v236, v10, v114
    v_fmac_f32 v234, v3, v147
    v_mfma_f32_32x32x16_bf16 v[48:63], v[92:95], v[188:191], v[48:63]
    s_setprio 0
    v_fmac_f32 v236, v11, v115
    v_fmac_f32 v234, v4, v148
    v_fmac_f32 v236, v12, v116
    v_fmac_f32 v234, v5, v149
    v_fmac_f32 v236, v13, v117
    v_fmac_f32 v234, v6, v150
    v_fmac_f32 v236, v14, v118
    v_fmac_f32 v234, v7, v151
    v_fmac_f32 v236, v15, v119
    v_mul_f32 v238, v16, v160
    v_mul_f32 v240, v24, v160
    v_fmac_f32 v238, v17, v161
    v_fmac_f32 v240, v25, v161
    v_fmac_f32 v238, v18, v162
    v_fmac_f32 v240, v26, v162
    v_fmac_f32 v238, v19, v163
    v_fmac_f32 v240, v27, v163
    v_fmac_f32 v238, v20, v164
    v_fmac_f32 v240, v28, v164
    v_fmac_f32 v238, v21, v165
    v_fmac_f32 v240, v29, v165
    v_fmac_f32 v238, v22, v166
    v_fmac_f32 v240, v30, v166
    v_fmac_f32 v238, v23, v167
    v_fmac_f32 v240, v31, v167
    v_mul_f32 v235, v32, v152
    v_mul_f32 v237, v40, v120
    v_fmac_f32 v235, v33, v153
    v_fmac_f32 v237, v41, v121
    v_fmac_f32 v235, v34, v154
    v_fmac_f32 v237, v42, v122
    v_fmac_f32 v235, v35, v155
    v_fmac_f32 v237, v43, v123
    v_fmac_f32 v235, v36, v156
    v_fmac_f32 v237, v44, v124
    v_fmac_f32 v235, v37, v157
    v_fmac_f32 v237, v45, v125
    v_fmac_f32 v235, v38, v158
    v_fmac_f32 v237, v46, v126
    v_fmac_f32 v235, v39, v159
    v_fmac_f32 v237, v47, v127
    v_mul_f32 v239, v48, v168
    v_mul_f32 v241, v56, v168
    s_setprio 1
    s_waitcnt vmcnt(4) lgkmcnt(0)
    v_mfma_f32_32x32x16_bf16 v[0:15], v[64:67], v[176:179], 0
    ds_read_b64_tr_b16 v[184:185], v246 offset:2048
    ds_read_b64_tr_b16 v[186:187], v246 offset:2560
    ds_read_b64_tr_b16 v[188:189], v247 offset:2048
    ds_read_b64_tr_b16 v[190:191], v247 offset:2560
    v_fmac_f32 v239, v49, v169
    v_fmac_f32 v241, v57, v169
    s_mov_b32 m0, s68
    v_mfma_f32_32x32x16_bf16 v[16:31], v[68:71], v[176:179], 0
    buffer_load_dwordx4 v222, s[4:7], s43 offen sc1 lds
    buffer_load_dwordx4 v223, s[72:75], s43 offen offset:1024 sc1 lds
    v_fmac_f32 v239, v50, v170
    v_fmac_f32 v241, v58, v170
    v_fmac_f32 v239, v51, v171
    v_fmac_f32 v241, v59, v171
    v_fmac_f32 v239, v52, v172
    v_mfma_f32_32x32x16_bf16 v[32:47], v[64:67], v[180:183], 0
    v_fmac_f32 v241, v60, v172
    v_fmac_f32 v239, v53, v173
    v_fmac_f32 v241, v61, v173
    v_fmac_f32 v239, v54, v174
    v_fmac_f32 v241, v62, v174
    v_fmac_f32 v239, v55, v175
    v_fmac_f32 v241, v63, v175
    v_mfma_f32_32x32x16_bf16 v[48:63], v[68:71], v[180:183], 0
    s_waitcnt vmcnt(4) lgkmcnt(0)
    v_mfma_f32_32x32x16_bf16 v[0:15], v[72:75], v[184:187], v[0:15]
    ds_read_b64_tr_b16 v[176:177], v246 offset:4096
    ds_read_b64_tr_b16 v[178:179], v246 offset:4608
    ds_read_b64_tr_b16 v[180:181], v247 offset:4096
    ds_read_b64_tr_b16 v[182:183], v247 offset:4608
    s_mov_b32 m0, s69
    v_mfma_f32_32x32x16_bf16 v[16:31], v[76:79], v[184:187], v[16:31]
    buffer_load_dwordx4 v224, s[4:7], s43 offen sc1 lds
    buffer_load_dwordx4 v225, s[72:75], s43 offen offset:1024 sc1 lds
    v_mfma_f32_32x32x16_bf16 v[32:47], v[72:75], v[188:191], v[32:47]
    v_mfma_f32_32x32x16_bf16 v[48:63], v[76:79], v[188:191], v[48:63]
    s_waitcnt vmcnt(4) lgkmcnt(0)
    v_mfma_f32_32x32x16_bf16 v[0:15], v[80:83], v[176:179], v[0:15]
    ds_read_b64_tr_b16 v[184:185], v246 offset:6144
    ds_read_b64_tr_b16 v[186:187], v246 offset:6656
    ds_read_b64_tr_b16 v[188:189], v247 offset:6144
    ds_read_b64_tr_b16 v[190:191], v247 offset:6656
    s_mov_b32 m0, s70
    v_mfma_f32_32x32x16_bf16 v[16:31], v[84:87], v[176:179], v[16:31]
    buffer_load_dwordx4 v226, s[4:7], s43 offen sc1 lds
    buffer_load_dwordx4 v227, s[72:75], s43 offen offset:1024 sc1 lds
    v_mfma_f32_32x32x16_bf16 v[32:47], v[80:83], v[180:183], v[32:47]
    v_add_u32 v222, s48, v251
    ds_read_b32 v222, v222
    v_mfma_f32_32x32x16_bf16 v[48:63], v[84:87], v[180:183], v[48:63]
    s_waitcnt vmcnt(4) lgkmcnt(1)
    v_mfma_f32_32x32x16_bf16 v[0:15], v[88:91], v[184:187], v[0:15]
    ds_read_b64_tr_b16 v[176:177], v246 offset:0
    ds_read_b64_tr_b16 v[178:179], v246 offset:512
    ds_read_b64_tr_b16 v[180:181], v247 offset:0
    ds_read_b64_tr_b16 v[182:183], v247 offset:512
    s_mov_b32 m0, s71
    v_mfma_f32_32x32x16_bf16 v[16:31], v[92:95], v[184:187], v[16:31]
    buffer_load_dwordx4 v228, s[4:7], s43 offen sc1 lds
    buffer_load_dwordx4 v229, s[72:75], s43 offen offset:1024 sc1 lds
    s_waitcnt lgkmcnt(4)
    v_mad_u32_u16 v223, v222, s39, v248 op_sel:[1,0,0,0]
    v_mad_u32_u16 v222, v222, s39, v248
    v_mfma_f32_32x32x16_bf16 v[32:47], v[88:91], v[188:191], v[32:47]
    v_add_u32 v224, s49, v251
    ds_read_b32 v224, v224
    v_mul_f32 v242, v0, v144
    v_fma_f32 v238, v8, v160, -v238
    v_fmac_f32 v242, v1, v145
    v_fmac_f32 v238, v9, v161
    v_fmac_f32 v242, v2, v146
    v_mfma_f32_32x32x16_bf16 v[48:63], v[92:95], v[188:191], v[48:63]
    s_setprio 0
    v_fmac_f32 v238, v10, v162
    v_fmac_f32 v242, v3, v147
    v_fmac_f32 v238, v11, v163
    v_fmac_f32 v242, v4, v148
    v_fmac_f32 v238, v12, v164
    v_fmac_f32 v242, v5, v149
    v_fmac_f32 v238, v13, v165
    v_fmac_f32 v242, v6, v150
    v_fmac_f32 v238, v14, v166
    v_fmac_f32 v242, v7, v151
    v_fmac_f32 v238, v15, v167
    v_fmac_f32 v236, v16, v112
    v_mul_f32 v244, v24, v160
    v_fmac_f32 v236, v17, v113
    v_fmac_f32 v244, v25, v161
    v_fmac_f32 v236, v18, v114
    v_fmac_f32 v244, v26, v162
    v_fmac_f32 v236, v19, v115
    v_fmac_f32 v244, v27, v163
    v_fmac_f32 v236, v20, v116
    v_fmac_f32 v244, v28, v164
    v_fmac_f32 v236, v21, v117
    v_fmac_f32 v244, v29, v165
    v_fmac_f32 v236, v22, v118
    v_fmac_f32 v244, v30, v166
    v_fmac_f32 v236, v23, v119
    v_fmac_f32 v244, v31, v167
    v_mul_f32 v243, v32, v152
    v_fma_f32 v239, v40, v168, -v239
    v_fmac_f32 v243, v33, v153
    v_fmac_f32 v239, v41, v169
    v_fmac_f32 v243, v34, v154
    v_fmac_f32 v239, v42, v170
    v_fmac_f32 v243, v35, v155
    v_fmac_f32 v239, v43, v171
    v_fmac_f32 v243, v36, v156
    v_fmac_f32 v239, v44, v172
    v_fmac_f32 v243, v37, v157
    v_fmac_f32 v239, v45, v173
    v_fmac_f32 v243, v38, v158
    v_fmac_f32 v239, v46, v174
    v_fmac_f32 v243, v39, v159
    v_fmac_f32 v239, v47, v175
    v_fmac_f32 v237, v48, v120
    v_mul_f32 v245, v56, v168
    v_fmac_f32 v237, v49, v121
    v_fmac_f32 v245, v57, v169
    v_fmac_f32 v237, v50, v122
    v_fmac_f32 v245, v58, v170
    v_fmac_f32 v237, v51, v123
    s_setprio 1
    s_waitcnt vmcnt(4) lgkmcnt(1)
    v_mfma_f32_32x32x16_bf16 v[0:15], v[64:67], v[176:179], 0
    ds_read_b64_tr_b16 v[184:185], v246 offset:2048
    ds_read_b64_tr_b16 v[186:187], v246 offset:2560
    ds_read_b64_tr_b16 v[188:189], v247 offset:2048
    ds_read_b64_tr_b16 v[190:191], v247 offset:2560
    v_fmac_f32 v245, v59, v171
    v_fmac_f32 v237, v52, v124
    s_mov_b32 m0, s68
    v_mfma_f32_32x32x16_bf16 v[16:31], v[68:71], v[176:179], 0
    buffer_load_dwordx4 v222, s[4:7], s44 offen sc1 lds
    buffer_load_dwordx4 v223, s[72:75], s44 offen offset:1024 sc1 lds
    s_waitcnt lgkmcnt(4)
    v_mad_u32_u16 v225, v224, s39, v248 op_sel:[1,0,0,0]
    v_mad_u32_u16 v224, v224, s39, v248
    v_fmac_f32 v245, v60, v172
    v_fmac_f32 v237, v53, v125
    v_mfma_f32_32x32x16_bf16 v[32:47], v[64:67], v[180:183], 0
    v_add_u32 v226, s50, v251
    ds_read_b32 v226, v226
    v_fmac_f32 v245, v61, v173
    v_fmac_f32 v237, v54, v126
    v_fmac_f32 v245, v62, v174
    v_fmac_f32 v237, v55, v127
    v_fmac_f32 v245, v63, v175
    v_mfma_f32_32x32x16_bf16 v[48:63], v[68:71], v[180:183], 0
    v_permlane32_swap_b32 v242, v234
    v_permlane32_swap_b32 v243, v235
    v_add_f32 v242, v242, v234
    v_add_f32 v243, v243, v235
    s_waitcnt vmcnt(4) lgkmcnt(1)
    v_mfma_f32_32x32x16_bf16 v[0:15], v[72:75], v[184:187], v[0:15]
    ds_read_b64_tr_b16 v[176:177], v246 offset:4096
    ds_read_b64_tr_b16 v[178:179], v246 offset:4608
    ds_read_b64_tr_b16 v[180:181], v247 offset:4096
    ds_read_b64_tr_b16 v[182:183], v247 offset:4608
    v_cvt_pk_bf16_f32 v242, v242, v243
    ds_write_b32 v230, v242 offset:512
    s_mov_b32 m0, s69
    v_mfma_f32_32x32x16_bf16 v[16:31], v[76:79], v[184:187], v[16:31]
    buffer_load_dwordx4 v224, s[4:7], s45 offen sc1 lds
    buffer_load_dwordx4 v225, s[72:75], s45 offen offset:1024 sc1 lds
    s_waitcnt lgkmcnt(5)
    v_mad_u32_u16 v227, v226, s39, v248 op_sel:[1,0,0,0]
    v_mad_u32_u16 v226, v226, s39, v248
    v_mfma_f32_32x32x16_bf16 v[32:47], v[72:75], v[188:191], v[32:47]
    v_add_u32 v228, s51, v251
    ds_read_b32 v228, v228
    v_mfma_f32_32x32x16_bf16 v[48:63], v[76:79], v[188:191], v[48:63]
    s_waitcnt vmcnt(4) lgkmcnt(2)
    v_mfma_f32_32x32x16_bf16 v[0:15], v[80:83], v[176:179], v[0:15]
    ds_read_b64_tr_b16 v[184:185], v246 offset:6144
    ds_read_b64_tr_b16 v[186:187], v246 offset:6656
    ds_read_b64_tr_b16 v[188:189], v247 offset:6144
    ds_read_b64_tr_b16 v[190:191], v247 offset:6656
    s_mov_b32 s32, s31
    s_mov_b32 s31, s35
    s_mov_b32 m0, s70
    v_mfma_f32_32x32x16_bf16 v[16:31], v[84:87], v[176:179], v[16:31]
    buffer_load_dwordx4 v226, s[4:7], s46 offen sc1 lds
    buffer_load_dwordx4 v227, s[72:75], s46 offen offset:1024 sc1 lds
    s_waitcnt lgkmcnt(4)
    v_mad_u32_u16 v229, v228, s39, v248 op_sel:[1,0,0,0]
    v_mad_u32_u16 v228, v228, s39, v248
    s_sub_u32 s26, s48, s29
    s_mov_b32 s29, s48
    v_mfma_f32_32x32x16_bf16 v[32:47], v[80:83], v[180:183], v[32:47]
    s_mov_b32 s30, s3
    s_cmp_lg_u32 s36, 0
    s_cselect_b32 s56, s33, 0
    v_mfma_f32_32x32x16_bf16 v[48:63], v[84:87], v[180:183], v[48:63]
    s_waitcnt vmcnt(4) lgkmcnt(0)
    v_mfma_f32_32x32x16_bf16 v[0:15], v[88:91], v[184:187], v[0:15]
    ds_read_b64_tr_b16 v[176:177], v246 offset:0
    ds_read_b64_tr_b16 v[178:179], v246 offset:512
    ds_read_b64_tr_b16 v[180:181], v247 offset:0
    ds_read_b64_tr_b16 v[182:183], v247 offset:512
    s_mov_b32 m0, s71
    v_mfma_f32_32x32x16_bf16 v[16:31], v[92:95], v[184:187], v[16:31]
    buffer_load_dwordx4 v228, s[4:7], s47 offen sc1 lds
    buffer_load_dwordx4 v229, s[72:75], s47 offen offset:1024 sc1 lds
    v_mfma_f32_32x32x16_bf16 v[32:47], v[88:91], v[188:191], v[32:47]
    s_nop 2
    v_mul_f32 v242, v0, v144
    v_fma_f32 v240, v8, v160, -v240
    v_fmac_f32 v242, v1, v145
    v_fmac_f32 v240, v9, v161
    v_fmac_f32 v242, v2, v146
    v_fmac_f32 v240, v10, v162
    v_fmac_f32 v242, v3, v147
    v_mfma_f32_32x32x16_bf16 v[48:63], v[92:95], v[188:191], v[48:63]
    s_setprio 0
    v_fmac_f32 v240, v11, v163
    v_fmac_f32 v242, v4, v148
    v_fmac_f32 v240, v12, v164
    v_fmac_f32 v242, v5, v149
    v_fmac_f32 v240, v13, v165
    v_fmac_f32 v242, v6, v150
    v_fmac_f32 v240, v14, v166
    v_fmac_f32 v242, v7, v151
    v_fmac_f32 v240, v15, v167
    v_add_u32 v249, s26, v249
    v_add_u32 v250, s26, v250
    v_fma_f32 v244, v16, v160, -v244
    v_fmac_f32 v236, v24, v112
    v_fmac_f32 v244, v17, v161
    v_fmac_f32 v236, v25, v113
    v_fmac_f32 v244, v18, v162
    v_fmac_f32 v236, v26, v114
    v_fmac_f32 v244, v19, v163
    v_fmac_f32 v236, v27, v115
    v_fmac_f32 v244, v20, v164
    v_fmac_f32 v236, v28, v116
    v_fmac_f32 v244, v21, v165
    v_fmac_f32 v236, v29, v117
    v_fmac_f32 v244, v22, v166
    v_fmac_f32 v236, v30, v118
    v_fmac_f32 v244, v23, v167
    v_fmac_f32 v236, v31, v119
    ds_read_b64_tr_b16 v[0:1], v249 offset:0
    ds_read_b64_tr_b16 v[2:3], v249 offset:128
    ds_read_b128 v[4:7], v250 offset:0
    ds_read_b128 v[8:11], v250 offset:16
    ds_read_b128 v[12:15], v250 offset:384
    ds_read_b128 v[16:19], v250 offset:400
    v_mul_f32 v243, v32, v152
    v_fma_f32 v241, v40, v168, -v241
    v_fmac_f32 v243, v33, v153
    v_fmac_f32 v241, v41, v169
    v_fmac_f32 v243, v34, v154
    v_fmac_f32 v241, v42, v170
    v_fmac_f32 v243, v35, v155
    v_fmac_f32 v241, v43, v171
    v_fmac_f32 v243, v36, v156
    v_fmac_f32 v241, v44, v172
    v_fmac_f32 v243, v37, v157
    v_fmac_f32 v241, v45, v173
    v_fmac_f32 v243, v38, v158
    v_fmac_f32 v241, v46, v174
    v_fmac_f32 v243, v39, v159
    v_fmac_f32 v241, v47, v175
    ds_read_b64_tr_b16 v[20:21], v249 offset:512
    ds_read_b64_tr_b16 v[22:23], v249 offset:640
    ds_read_b128 v[24:27], v250 offset:64
    ds_read_b128 v[28:31], v250 offset:80
    ds_read_b128 v[32:35], v250 offset:448
    ds_read_b128 v[36:39], v250 offset:464
    v_fma_f32 v245, v48, v168, -v245
    v_fmac_f32 v237, v56, v120
    v_fmac_f32 v245, v49, v169
    v_fmac_f32 v237, v57, v121
    v_fmac_f32 v245, v50, v170
    v_fmac_f32 v237, v58, v122
    v_fmac_f32 v245, v51, v171
    v_fmac_f32 v237, v59, v123
    v_fmac_f32 v245, v52, v172
    v_fmac_f32 v237, v60, v124
    v_fmac_f32 v245, v53, v173
    v_fmac_f32 v237, v61, v125
    v_fmac_f32 v245, v54, v174
    v_fmac_f32 v237, v62, v126
    v_fmac_f32 v245, v55, v175
    v_fmac_f32 v237, v63, v127
    s_cmp_eq_u32 s56, 2
    s_cbranch_scc1 K2_U21
    s_cmp_eq_u32 s56, 3
    s_cbranch_scc1 K2_U31
    s_branch K2_DSP1
K2_nul_62:
    s_mov_b32 s58, 63
    s_mov_b32 s36, 0
    s_branch K2_back_65
K2_spin_63:
    s_sub_u32 s27, s27, 1
    s_cbranch_scc1 K2_END
    v_lshl_add_u32 v233, v252, 1, s53
    ds_read_b32 v233, v233
    s_waitcnt lgkmcnt(0)
    s_branch K2_chk_64
K2_dyn_60:
    v_mov_b32 v254, 163648
    v_mov_b32 v255, 1
    v_lshl_add_u32 v233, v252, 1, s53
    s_mov_b64 exec, 1
    ds_add_rtn_u32 v232, v254, v255
    s_mov_b64 exec, -1
    ds_read_b32 v233, v233
    s_waitcnt lgkmcnt(0)
    v_readfirstlane_b32 s58, v232
    s_nop 0
    s_cmp_lt_u32 s58, s22
    s_cbranch_scc0 K2_nul_62
    s_and_b32 s59, s58, 7
    s_lshr_b32 s60, s58, 3
K2_chk_64:
    v_readlane_b32 s61, v233, s59
    s_nop 0
    s_cmp_gt_u32 s61, s60
    s_cbranch_scc0 K2_spin_63
K2_back_65:
    s_mov_b32 s34, 1
    s_branch K2_back_61
K2_rare_66:
    s_cmp_eq_u32 s33, 4
    s_cbranch_scc1 K2_four_68
    s_mov_b32 s49, s48
    s_mov_b32 s51, s48
    s_add_u32 s45, s44, 256
    s_add_u32 s46, s44, 512
    s_add_u32 s47, s44, 768
    s_branch K2_back_67
K2_four_68:
    s_add_u32 s50, s48, 64
    s_lshr_b32 s51, s3, 27
    s_mov_b32 s66, 161536
    s_cmp_ge_u32 s51, 2
    s_cselect_b32 s66, 159072, s66
    s_mul_i32 s51, s51, 32
    s_add_u32 s51, s51, s66
    s_mov_b32 s46, s44
    s_mov_b32 s47, s44
    s_branch K2_back_67
K2_dum_69:
    v_mov_b32 v232, -1
    s_mov_b32 m0, 163712
    s_mov_b64 exec, 1
    buffer_load_dwordx4 v232, s[16:19], 0 offen lds
    buffer_load_dwordx4 v232, s[16:19], 0 offen lds
    s_mov_b64 exec, -1
    s_branch K2_back_71
K2_a4_70:
    s_lshr_b32 s65, s3, 27
    s_mov_b32 s66, 161536
    s_cmp_ge_u32 s65, 2
    s_cselect_b32 s66, 158112, s66
    s_mul_i32 s65, s65, 512
    s_add_u32 s65, s65, s66
    v_add_u32 v232, s65, v230
    ds_read_b32 v232, v232
    s_add_u32 m0, s65, 864
    s_waitcnt lgkmcnt(0)
    v_or_b32 v232, v232, v231
    buffer_load_dwordx4 v232, s[16:19], 0 offen  lds
    s_branch K2_b4_72
K2_ew_73:
    v_lshlrev_b32 v254, 3, v252
    s_mov_b64 vcc, -1
    s_mov_b32 s58, 7120896
    buffer_load_dwordx4 v[104:107], v254, s[8:11], s58 offen offset:0 sc1
    buffer_load_dwordx4 v[108:111], v254, s[8:11], s58 offen offset:1024 sc1
    s_mov_b32 s58, 7124992
    buffer_load_dwordx4 v[136:139], v254, s[8:11], s58 offen offset:0 sc1
    buffer_load_dwordx4 v[140:143], v254, s[8:11], s58 offen offset:1024 sc1
    s_waitcnt vmcnt(0)
    s_branch K2_back_74
K2_nul_77:
    s_mov_b32 s58, 63
    s_mov_b32 s36, 0
    s_branch K2_back_80
K2_spin_78:
    s_sub_u32 s27, s27, 1
    s_cbranch_scc1 K2_END
    v_lshl_add_u32 v233, v252, 1, s53
    ds_read_b32 v233, v233
    s_waitcnt lgkmcnt(0)
    s_branch K2_chk_79
K2_dyn_75:
    v_mov_b32 v254, 163648
    v_mov_b32 v255, 1
    v_lshl_add_u32 v233, v252, 1, s53
    s_mov_b64 exec, 1
    ds_add_rtn_u32 v232, v254, v255
    s_mov_b64 exec, -1
    ds_read_b32 v233, v233
    s_waitcnt lgkmcnt(0)
    v_readfirstlane_b32 s58, v232
    s_nop 0
    s_cmp_lt_u32 s58, s22
    s_cbranch_scc0 K2_nul_77
    s_and_b32 s59, s58, 7
    s_lshr_b32 s60, s58, 3
K2_chk_79:
    v_readlane_b32 s61, v233, s59
    s_nop 0
    s_cmp_gt_u32 s61, s60
    s_cbranch_scc0 K2_spin_78
K2_back_80:
    s_mov_b32 s34, 1
    s_branch K2_back_76
K2_rare_81:
    s_cmp_eq_u32 s33, 4
    s_cbranch_scc1 K2_four_83
    s_mov_b32 s49, s48
    s_mov_b32 s51, s48
    s_add_u32 s45, s44, 256
    s_add_u32 s46, s44, 512
    s_add_u32 s47, s44, 768
    s_branch K2_back_82
K2_four_83:
    s_add_u32 s50, s48, 64
    s_lshr_b32 s51, s3, 27
    s_mov_b32 s66, 161536
    s_cmp_ge_u32 s51, 2
    s_cselect_b32 s66, 159072, s66
    s_mul_i32 s51, s51, 32
    s_add_u32 s51, s51, s66
    s_mov_b32 s46, s44
    s_mov_b32 s47, s44
    s_branch K2_back_82
K2_ew_84:
    v_lshlrev_b32 v254, 3, v252
    s_mov_b64 vcc, -1
    s_mov_b32 s58, 7120896
    buffer_load_dwordx4 v[104:107], v254, s[8:11], s58 offen offset:0 sc1
    buffer_load_dwordx4 v[108:111], v254, s[8:11], s58 offen offset:1024 sc1
    s_mov_b32 s58, 7124992
    buffer_load_dwordx4 v[136:139], v254, s[8:11], s58 offen offset:0 sc1
    buffer_load_dwordx4 v[140:143], v254, s[8:11], s58 offen offset:1024 sc1
    s_branch K2_back_85
K2_dum_86:
    v_mov_b32 v232, -1
    s_mov_b32 m0, 163712
    s_mov_b64 exec, 1
    buffer_load_dwordx4 v232, s[16:19], 0 offen lds
    buffer_load_dwordx4 v232, s[16:19], 0 offen lds
    s_mov_b64 exec, -1
    s_branch K2_back_88
K2_a4_87:
    s_lshr_b32 s65, s3, 27
    s_mov_b32 s66, 161536
    s_cmp_ge_u32 s65, 2
    s_cselect_b32 s66, 158112, s66
    s_mul_i32 s65, s65, 512
    s_add_u32 s65, s65, s66
    v_add_u32 v232, s65, v230
    ds_read_b32 v232, v232
    s_add_u32 m0, s65, 864
    s_waitcnt lgkmcnt(0)
    v_or_b32 v232, v232, v231
    buffer_load_dwordx4 v232, s[16:19], 0 offen  lds
    s_branch K2_b4_89
K2_nul_90:
    s_mov_b32 s58, 63
    s_mov_b32 s36, 0
    s_branch K2_back_93
K2_spin_91:
    s_sub_u32 s27, s27, 1
    s_cbranch_scc1 K2_END
    v_lshl_add_u32 v233, v252, 1, s53
    ds_read_b32 v233, v233
    s_waitcnt lgkmcnt(0)
    s_branch K2_chk_92
K2_rare_94:
    s_cmp_eq_u32 s33, 4
    s_cbranch_scc1 K2_four_96
    s_mov_b32 s49, s48
    s_mov_b32 s51, s48
    s_add_u32 s45, s44, 256
    s_add_u32 s46, s44, 512
    s_add_u32 s47, s44, 768
    s_branch K2_back_95
K2_four_96:
    s_add_u32 s50, s48, 64
    s_lshr_b32 s51, s3, 27
    s_mov_b32 s66, 161536
    s_cmp_ge_u32 s51, 2
    s_cselect_b32 s66, 159072, s66
    s_mul_i32 s51, s51, 32
    s_add_u32 s51, s51, s66
    s_mov_b32 s46, s44
    s_mov_b32 s47, s44
    s_branch K2_back_95
K2_nul_97:
    s_mov_b32 s58, 63
    s_mov_b32 s36, 0
    s_branch K2_back_100
K2_spin_98:
    s_sub_u32 s27, s27, 1
    s_cbranch_scc1 K2_END
    v_lshl_add_u32 v233, v252, 1, s53
    ds_read_b32 v233, v233
    s_waitcnt lgkmcnt(0)
    s_branch K2_chk_99
K2_rare_101:
    s_cmp_eq_u32 s33, 4
    s_cbranch_scc1 K2_four_103
    s_mov_b32 s49, s48
    s_mov_b32 s51, s48
    s_add_u32 s45, s44, 256
    s_add_u32 s46, s44, 512
    s_add_u32 s47, s44, 768
    s_branch K2_back_102
K2_four_103:
    s_add_u32 s50, s48, 64
    s_lshr_b32 s51, s3, 27
    s_mov_b32 s66, 161536
    s_cmp_ge_u32 s51, 2
    s_cselect_b32 s66, 159072, s66
    s_mul_i32 s51, s51, 32
    s_add_u32 s51, s51, s66
    s_mov_b32 s46, s44
    s_mov_b32 s47, s44
    s_branch K2_back_102
K2_END:
    s_endpgm
.section .rodata,"a"
.p2align 6
.amdhsa_kernel standalone__tensor_product_equiv_equiformer__graph_kernel
  .amdhsa_next_free_vgpr 256
  .amdhsa_next_free_sgpr 102
  .amdhsa_accum_offset 256
  .amdhsa_group_segment_fixed_size 0
  .amdhsa_kernarg_size 96
  .amdhsa_user_sgpr_count 2
  .amdhsa_user_sgpr_kernarg_segment_ptr 1
  .amdhsa_system_sgpr_workgroup_id_x 1
  .amdhsa_float_denorm_mode_32 3
.end_amdhsa_kernel
```

```asm
; @launch grid=(256,1,1) block=(512,1,1) lds=163840
.amdgcn_target "amdgcn-amd-amdhsa--gfx950"
.text
.globl standalone__tensor_product_equiv_equiformer__graph_kernel
.p2align 8
.type standalone__tensor_product_equiv_equiformer__graph_kernel,@function
standalone__tensor_product_equiv_equiformer__graph_kernel:
    s_cmp_ge_u32 s2, 256
    s_cbranch_scc1 K2_END
    s_load_dwordx16 s[80:95], s[0:1], 0
    s_load_dwordx4 s[96:99], s[0:1], 72
    s_load_dwordx2 s[100:101], s[0:1], 88
    v_lshrrev_b32 v1, 6, v0
    s_mov_b32 s54, s2
    v_readfirstlane_b32 s20, v1
    s_mov_b64 exec, 0
    s_cmp_eq_u32 s20, 0
    s_cbranch_scc1 K2_PAD_S1
    s_cmp_eq_u32 s20, 1
    s_cbranch_scc1 K2_PAD_S2
    s_cmp_eq_u32 s20, 5
    s_cbranch_scc1 K2_PAD_H1
    s_cmp_eq_u32 s20, 6
    s_cbranch_scc1 K2_PAD_H2
    s_cmp_eq_u32 s20, 2
    s_cbranch_scc1 K2_PAD_H3
KS_HOP0:
    s_mov_b64 exec, -1
    v_and_b32 v8, 63, v0
    v_lshlrev_b32 v9, 4, v8
    v_mov_b32 v6, 0
    v_lshlrev_b32 v5, 4, v0
    v_mul_u32_u24 v4, 24, v0
    s_mul_i32 s64, s2, 5120
    s_mul_i32 s65, s2, 7680
    v_mov_b32 v176, v8
    v_mov_b32 v177, v0
    s_mul_i32 s21, s2, 625
    s_add_u32 s22, s21, 640
    s_add_u32 s21, s21, 15
    s_lshr_b32 s21, s21, 4
    s_lshr_b32 s22, s22, 4
    s_sub_u32 s22, s22, s21
    s_movk_i32 s39, 1024
    s_lshl_b32 s37, s20, 13
    s_mov_b32 s53, 160672
    s_lshl_b32 s52, s20, 2
    s_add_u32 s52, s52, s53
    s_add_u32 s68, s37, 0
    s_add_u32 s69, s37, 2048
    s_add_u32 s70, s37, 4096
    s_add_u32 s71, s37, 6144
    s_waitcnt lgkmcnt(0)
    s_mov_b32 s8, s100
    s_and_b32 s9, s101, 0xffff
    s_mov_b32 s10, 37748736
    s_mov_b32 s11, 0x20000
    s_cmp_lg_u32 s20, 7
    s_cbranch_scc1 KS_NOTAG
    s_mov_b32 s24, 7178240
    s_mov_b64 exec, 1
    buffer_load_dword v14, v6, s[8:11], s24 offen sc1
    s_mov_b64 exec, -1
    s_barrier
    v_mov_b32 v76, 0
    v_mov_b32 v77, -1
    v_lshlrev_b32 v78, 2, v8
    v_add_u32 v78, 160480, v78
    s_mov_b64 exec, 0x1ff
    ds_write_b32 v78, v76 offset:192
    s_mov_b64 exec, 0xff
    ds_write_b32 v78, v77 offset:256
    s_mov_b64 exec, -1
    s_mov_b32 exec_hi, 0xffff
    ds_write_b32 v78, v76
    s_mov_b64 exec, 0x3f
    ds_write_b32 v78, v76 offset:228
    s_mov_b64 exec, -1
    s_mov_b64 exec, 1
    v_mov_b32 v12, 160784
    s_mov_b32 s24, 1664525
    s_waitcnt vmcnt(0)
    v_mul_lo_u32 v14, v14, s24
    v_add_u32 v14, 1013904223, v14
    ds_write_b32 v12, v14
KS_TAGOK2:
    s_mov_b64 exec, -1
    s_waitcnt lgkmcnt(0)
    s_barrier
    s_branch KS_B3
KS_H0:
    s_barrier
    s_branch KS_HELP
K2_PAD_S1:
    s_branch KS_HOP0
KS_NOTAG:
    s_cmp_ge_u32 s20, 5
    s_cbranch_scc1 KS_HELP
    s_cmp_ge_u32 s2, 250
    s_cbranch_scc1 KS_IDLE
    s_mov_b32 s40, s88
    s_and_b32 s41, s89, 0xffff
    s_mov_b32 s42, 1280000
    s_mov_b32 s43, 0x20000
    buffer_load_dwordx4 v[12:15], v5, s[40:43], s64 offen
    s_mov_b32 s44, s86
    s_and_b32 s45, s87, 0xffff
    s_mov_b32 s46, 1280000
    s_mov_b32 s47, 0x20000
    s_mov_b32 s48, s82
    s_and_b32 s49, s83, 0xffff
    s_mov_b32 s50, 1920000
    s_mov_b32 s51, 0x20000
    buffer_load_dwordx4 v[16:19], v5, s[44:47], s64 offen
    buffer_load_dwordx4 v[20:23], v4, s[48:51], s65 offen
    buffer_load_dwordx2 v[24:25], v4, s[48:51], s65 offen offset:16
    v_lshlrev_b32 v2, 2, v0
    s_lshl_b32 s64, s64, 3
    v_lshl_add_u32 v3, v0, 7, s64
    v_mov_b32 v7, 1
    s_cmp_eq_u32 s20, 4
    s_cbranch_scc1 KS_NOCLR
    ds_write_b32 v2, v6
KS_NOCLR:
    s_waitcnt lgkmcnt(0)
    s_barrier
    s_mov_b64 exec, 0
    s_cmp_eq_u32 s20, 0
    s_cbranch_scc1 K2_PAD_B3
    s_cmp_eq_u32 s20, 1
    s_cbranch_scc1 K2_PAD_LD
    s_cmp_eq_u32 s20, 2
    s_cbranch_scc1 K2_PAD_NW
    s_cmp_eq_u32 s20, 3
    s_cbranch_scc1 K2_PAD_SC
    s_cmp_eq_u32 s20, 4
    s_cbranch_scc1 K2_PAD_SD
KS_HOP:
    s_mov_b64 exec, -1
    s_mov_b32 s58, 429497
    s_movk_i32 s59, 625
    s_waitcnt vmcnt(3)
    v_mul_u32_u24 v28, s58, v12
    v_lshrrev_b32 v32, 27, v28
    v_bfe_u32 v36, v28, 24, 3
    v_lshlrev_b32 v32, 2, v32
    v_lshl_or_b32 v32, v36, 7, v32
    ds_add_rtn_u32 v36, v32, v7
    v_mul_u32_u24 v29, s58, v13
    v_lshrrev_b32 v33, 27, v29
    v_bfe_u32 v37, v29, 24, 3
    v_lshlrev_b32 v33, 2, v33
    v_lshl_or_b32 v33, v37, 7, v33
    ds_add_rtn_u32 v37, v33, v7
    v_mul_u32_u24 v30, s58, v14
    v_lshrrev_b32 v34, 27, v30
    v_bfe_u32 v38, v30, 24, 3
    v_lshlrev_b32 v34, 2, v34
    v_lshl_or_b32 v34, v38, 7, v34
    ds_add_rtn_u32 v38, v34, v7
    v_mul_u32_u24 v31, s58, v15
    v_lshrrev_b32 v35, 27, v31
    v_bfe_u32 v39, v31, 24, 3
    v_lshlrev_b32 v35, 2, v35
    v_lshl_or_b32 v35, v39, 7, v35
    ds_add_rtn_u32 v39, v35, v7
    v_lshrrev_b32 v28, 24, v28
    v_mad_u32_u24 v28, v28, s59, 15
    v_lshrrev_b32 v28, 4, v28
    v_sub_u32 v28, v12, v28
    v_add_u32 v12, 0, v3
    v_lshl_or_b32 v28, v28, 26, v12
    v_lshrrev_b32 v29, 24, v29
    v_mad_u32_u24 v29, v29, s59, 15
    v_lshrrev_b32 v29, 4, v29
    v_sub_u32 v29, v13, v29
    v_add_u32 v13, 32, v3
    v_lshl_or_b32 v29, v29, 26, v13
    v_lshrrev_b32 v30, 24, v30
    v_mad_u32_u24 v30, v30, s59, 15
    v_lshrrev_b32 v30, 4, v30
    v_sub_u32 v30, v14, v30
    v_add_u32 v14, 64, v3
    v_lshl_or_b32 v30, v30, 26, v14
    v_lshrrev_b32 v31, 24, v31
    v_mad_u32_u24 v31, v31, s59, 15
    v_lshrrev_b32 v31, 4, v31
    v_sub_u32 v31, v15, v31
    v_add_u32 v15, 96, v3
    v_lshl_or_b32 v31, v31, 26, v15
K2_PAD_S2:
    s_cbranch_execz KS_HOP0
    v_mov_b32 v59, 160784
    s_mul_i32 s65, s2, 1152
    s_add_u32 s65, s65, 6291456
    s_mul_i32 s64, s2, 20608
    s_waitcnt lgkmcnt(0)
    s_barrier
    ds_read_b128 v[40:43], v9
    ds_read_b32 v59, v59
    s_waitcnt lgkmcnt(1)
    v_add_u32 v45, v40, v41
    v_add_u32 v46, v45, v42
    v_add_u32 v47, v46, v43
    v_mov_b32 v58, v47
    s_nop 1
    v_add_u32_dpp v58, v58, v58 row_shr:1 row_mask:0xf bank_mask:0xf bound_ctrl:0
    s_nop 1
    v_add_u32_dpp v58, v58, v58 row_shr:2 row_mask:0xf bank_mask:0xf bound_ctrl:0
    s_nop 1
    v_add_u32_dpp v58, v58, v58 row_shr:4 row_mask:0xf bank_mask:0xf bound_ctrl:0
    s_nop 1
    v_add_u32_dpp v58, v58, v58 row_shr:8 row_mask:0xf bank_mask:0xf bound_ctrl:0
    s_nop 1
    v_add_u32_dpp v58, v58, v58 row_bcast:15 row_mask:0xa bank_mask:0xf
    s_nop 1
    v_add_u32_dpp v58, v58, v58 row_bcast:31 row_mask:0xc bank_mask:0xf
    v_sub_u32 v48, v58, v47
    v_add_u32 v49, v48, v40
    v_add_u32 v50, v48, v45
    v_add_u32 v51, v48, v46
    ds_write_b128 v9, v[48:51] offset:1024
    s_waitcnt vmcnt(0) lgkmcnt(1)
    s_cmp_lg_u32 s20, 4
    s_cbranch_scc1 KS_NOPUB
    v_lshl_or_b32 v56, v49, 11, v48
    v_lshl_or_b32 v57, v51, 11, v50
    v_lshl_or_b32 v56, v59, 22, v56
    v_lshl_or_b32 v57, v59, 22, v57
    buffer_store_dwordx4 v[56:59], v9, s[8:11], s65 offen sc1
KS_NOPUB:
    s_waitcnt lgkmcnt(0)
    ds_read_b32 v32, v32 offset:1024
    ds_read_b32 v33, v33 offset:1024
    ds_read_b32 v34, v34 offset:1024
    ds_read_b32 v35, v35 offset:1024
    v_and_b32 v60, 0xffff, v59
    v_and_b32 v61, 0xffff0000, v59
    s_mov_b32 s58, 0xffff0000
    v_mov_b32 v40, v20
    v_lshl_or_b32 v41, v21, 16, v60
    v_or_b32 v42, v61, v16
    v_mov_b32 v43, v28
    v_alignbit_b32 v44, v22, v21, 16
    v_and_or_b32 v45, v22, s58, v60
    v_or_b32 v46, v61, v17
    v_mov_b32 v47, v29
    v_mov_b32 v48, v23
    v_lshl_or_b32 v49, v24, 16, v60
    v_or_b32 v50, v61, v18
    v_mov_b32 v51, v30
    v_alignbit_b32 v52, v25, v24, 16
    v_and_or_b32 v53, v25, s58, v60
    v_or_b32 v54, v61, v19
    v_mov_b32 v55, v31
    s_waitcnt lgkmcnt(0)
    v_add_lshl_u32 v32, v32, v36, 4
    ds_write_b128 v32, v[40:43] offset:2048
    v_add_lshl_u32 v33, v33, v37, 4
    ds_write_b128 v33, v[44:47] offset:2048
    v_add_lshl_u32 v34, v34, v38, 4
    ds_write_b128 v34, v[48:51] offset:2048
    v_add_lshl_u32 v35, v35, v39, 4
    ds_write_b128 v35, v[52:55] offset:2048
    s_waitcnt lgkmcnt(0)
    s_barrier
    ds_read_b128 v[12:15], v5 offset:2048
    ds_read_b128 v[16:19], v5 offset:7168
    ds_read_b128 v[20:23], v5 offset:12288
    ds_read_b128 v[24:27], v5 offset:17408
    s_waitcnt lgkmcnt(3)
    buffer_store_dwordx4 v[12:15], v5, s[8:11], s64 offen sc1
    s_add_u32 s64, s64, 5120
    s_waitcnt lgkmcnt(2)
    buffer_store_dwordx4 v[16:19], v5, s[8:11], s64 offen sc1
    s_add_u32 s64, s64, 5120
    s_waitcnt lgkmcnt(1)
    buffer_store_dwordx4 v[20:23], v5, s[8:11], s64 offen sc1
    s_add_u32 s64, s64, 5120
    s_waitcnt lgkmcnt(0)
    buffer_store_dwordx4 v[24:27], v5, s[8:11], s64 offen sc1
    s_branch KS_JOIN
K2_PAD_B3:
    s_branch KS_HOP
KS_B3:
    v_mov_b32 v59, 160784
    ds_read_b32 v59, v59
    s_waitcnt lgkmcnt(0)
    s_barrier
KS_JOIN:
    v_readfirstlane_b32 s2, v59
    s_mov_b32 s23, 0
    s_mov_b32 s28, 1
    s_mov_b32 s24, 0
    s_mov_b32 s25, 1
K2_CELLS:
    v_lshrrev_b32 v178, 1, v177
    v_min_u32 v178, 249, v178
    v_mul_u32_u24 v72, 1152, v178
    s_and_b32 s58, s54, 7
    s_lshl_b32 s58, s58, 7
    s_lshr_b32 s59, s54, 5
    s_lshl_b32 s59, s59, 4
    s_add_u32 s67, s58, s59
    s_add_u32 s67, s67, 6291456
    buffer_load_dwordx4 v[76:79], v72, s[8:11], s67 offen sc1
    s_cmp_eq_u32 s28, 0
    s_cbranch_scc1 K2_NOSRD
    s_mov_b32 s4, s80
    s_and_b32 s5, s81, 0xffff
    s_mov_b32 s6, 10240000
    s_mov_b32 s7, 0x20000
    s_mov_b32 s12, s96
    s_and_b32 s13, s97, 0xffff
    s_mov_b32 s14, 10240000
    s_mov_b32 s15, 0x20000
    s_mov_b32 s16, s84
    s_and_b32 s17, s85, 0xffff
    s_mov_b32 s18, 10240000
    s_mov_b32 s19, 0x20000
    s_sub_u32 s80, s80, 1024
    s_subb_u32 s81, s81, 0
    s_mov_b32 s72, s80
    s_and_b32 s73, s81, 0xffff
    s_mov_b32 s74, 10241024
    s_mov_b32 s75, 0x20000
    s_mov_b64 exec, 0
    s_cmp_eq_u32 s20, 0
    s_cbranch_scc1 K2_PAD_U20
    s_cmp_eq_u32 s20, 1
    s_cbranch_scc1 K2_PAD_U30
    s_cmp_eq_u32 s20, 2
    s_cbranch_scc1 K2_PAD_U21
    s_cmp_eq_u32 s20, 3
    s_cbranch_scc1 K2_PAD_U31
    s_cmp_eq_u32 s20, 4
    s_cbranch_scc1 K2_PAD_SW
    s_cmp_eq_u32 s20, 5
    s_cbranch_scc1 K2_PAD_TL
    s_cmp_eq_u32 s20, 6
    s_cbranch_scc1 K2_PAD_T2
    s_cmp_eq_u32 s20, 7
    s_cbranch_scc1 K2_PAD_OV
K2_HOP:
    s_mov_b64 exec, -1
K2_NOSRD:
    v_and_b32 v84, 15, v176
    v_lshrrev_b32 v85, 5, v176
    v_bfe_u32 v86, v176, 4, 1
    v_lshrrev_b32 v87, 2, v84
    v_and_b32 v88, 3, v84
    v_lshl_add_u32 v89, v85, 3, v87
    v_lshl_add_u32 v90, v87, 1, v85
    v_lshlrev_b32 v249, 5, v90
    v_lshl_add_u32 v249, v88, 3, v249
    v_add_u32 v249, 480, v249
    v_lshrrev_b32 v90, 3, v84
    v_lshl_add_u32 v90, v90, 1, v86
    v_mul_u32_u24 v250, 96, v90
    v_and_b32 v91, 7, v84
    v_lshl_add_u32 v91, v91, 1, v85
    v_lshl_add_u32 v250, v91, 1, v250
    v_lshrrev_b32 v90, 1, v88
    v_lshl_add_u32 v90, v86, 1, v90
    v_bfe_u32 v91, v87, 1, 1
    v_lshlrev_b32 v91, 2, v91
    v_xor_b32 v90, v90, v91
    v_lshlrev_b32 v90, 4, v90
    v_lshl_add_u32 v90, v89, 7, v90
    v_and_b32 v91, 1, v88
    v_lshl_add_u32 v90, v91, 3, v90
    v_add_u32 v246, s37, v90
    v_xor_b32 v247, 64, v246
    v_lshrrev_b32 v90, 3, v176
    v_lshlrev_b32 v251, 2, v90
    v_add_u32 v251, 384, v251
    v_bfe_u32 v90, v90, 1, 1
    v_lshlrev_b32 v90, 2, v90
    v_and_b32 v91, 7, v176
    v_xor_b32 v90, v90, v91
    v_lshlrev_b32 v248, 4, v90
    v_lshlrev_b32 v252, 1, v176
    v_and_b32 v231, 1, v176
    v_lshlrev_b32 v231, 4, v231
    v_lshrrev_b32 v90, 1, v176
    v_lshlrev_b32 v90, 5, v90
    v_add_u32 v230, 480, v90
    s_lshl_b32 s59, s2, 22
    s_mov_b32 s60, 0x40000
    s_bfe_u32 s61, s54, 0x10004
    s_bfe_u32 s62, s54, 0x10003
    s_add_u32 s63, s61, s62
    s_mul_i32 s62, s62, 11
    s_sub_u32 s64, 11, s62
    v_cmp_gt_u32 vcc, 500, v177
    s_nop 0
    s_mov_b64 s[56:57], vcc
K2_POLL:
    s_waitcnt vmcnt(0)
    v_xor_b32 v73, s59, v76
    v_xor_b32 v74, s59, v77
    v_or_b32 v73, v73, v74
    v_xor_b32 v74, s2, v79
    v_lshrrev_b32 v73, 22, v73
    v_or_b32 v73, v73, v74
    v_cmp_ne_u32 vcc, 0, v73
    s_nop 0
    s_cbranch_vccz K2_POLLED
    s_sub_u32 s60, s60, 1
    s_cbranch_scc1 K2_END
    s_mov_b64 exec, vcc
    buffer_load_dwordx4 v[76:79], v72, s[8:11], s67 offen sc1
    s_mov_b64 exec, -1
    s_branch K2_POLL
K2_PAD_LD:
    s_branch KS_HOP
K2_POLLED:
    s_set_gpr_idx_on s61, gpr_idx(SRC0)
    s_nop 0
    v_bfe_u32 v179, v76, s62, 11
    s_set_gpr_idx_idx s63
    s_nop 0
    v_bfe_u32 v73, v76, s64, 11
    s_set_gpr_idx_off
    v_sub_u32 v73, v73, v179
    v_cndmask_b32 v73, 0, v73, s[56:57]
    v_and_b32 v1, 1, v177
    v_add_u32 v1, s23, v1
    v_sub_u32 v180, v73, v1
    v_add_u32 v179, v179, v1
    v_mul_u32_u24 v181, 20608, v178
    v_lshl_add_u32 v181, v179, 4, v181
    v_cmp_lt_i32 s[40:41], 0, v180
    v_add_u32 v182, 32, v181
    s_mov_b32 s65, 0
    s_mov_b64 exec, s[40:41]
    buffer_load_dwordx4 v[0:3], v181, s[8:11], 0 offen offset:0 sc1
    s_mov_b64 exec, -1
    v_cmp_lt_i32 s[42:43], 2, v180
    v_cmp_lt_i32 s[44:45], 4, v180
    v_cmp_lt_i32 s[46:47], 6, v180
    v_cmp_lt_i32 s[48:49], 8, v180
    v_cmp_lt_i32 s[50:51], 10, v180
    v_cmp_lt_i32 s[90:91], 12, v180
    v_cmp_lt_i32 s[92:93], 14, v180
    v_cmp_lt_i32 s[94:95], 16, v180
    v_cmp_lt_i32 s[96:97], 18, v180
    v_add_u32 v183, 64, v181
    v_add_u32 v184, 96, v181
    v_subrev_u32 v62, 1, v180
    v_ashrrev_i32 v62, 1, v62
    v_med3_i32 v62, v62, 0, 9
    s_cmp_eq_u64 s[42:43], 0
    s_cbranch_scc1 K2_LD_DONE
    v_mov_b32 v63, v62
    s_nop 1
    v_add_u32_dpp v63, v63, v63 row_shr:1 row_mask:0xf bank_mask:0xf bound_ctrl:0
    s_nop 1
    v_add_u32_dpp v63, v63, v63 row_shr:2 row_mask:0xf bank_mask:0xf bound_ctrl:0
    s_nop 1
    v_add_u32_dpp v63, v63, v63 row_shr:4 row_mask:0xf bank_mask:0xf bound_ctrl:0
    s_nop 1
    v_add_u32_dpp v63, v63, v63 row_shr:8 row_mask:0xf bank_mask:0xf bound_ctrl:0
    s_nop 1
    v_add_u32_dpp v63, v63, v63 row_bcast:15 row_mask:0xa bank_mask:0xf
    s_nop 1
    v_add_u32_dpp v63, v63, v63 row_bcast:31 row_mask:0xc bank_mask:0xf
    s_lshl_b32 s58, s20, 10
    s_add_u32 s58, s58, 45056
    v_readlane_b32 s59, v63, 63
    v_sub_u32 v63, v63, v62
    v_lshl_add_u32 v64, v63, 2, s58
    v_lshlrev_b32 v63, 5, v63
    v_sub_u32 v63, v182, v63
    s_cmp_gt_u32 s59, 189
    s_cbranch_scc1 K2_LD_GEN
    s_mov_b64 exec, s[42:43]
    s_cbranch_execz K2_LD_L
    ds_write_b32 v64, v63 offset:0
    s_mov_b64 exec, s[44:45]
    s_cbranch_execz K2_LD_L
    ds_write_b32 v64, v63 offset:4
    s_mov_b64 exec, s[46:47]
    s_cbranch_execz K2_LD_L
    ds_write_b32 v64, v63 offset:8
    s_mov_b64 exec, s[48:49]
    s_cbranch_execz K2_LD_L
    ds_write_b32 v64, v63 offset:12
    s_mov_b64 exec, s[50:51]
    s_cbranch_execz K2_LD_L
    ds_write_b32 v64, v63 offset:16
    s_mov_b64 exec, s[90:91]
    s_cbranch_execz K2_LD_L
    ds_write_b32 v64, v63 offset:20
    s_mov_b64 exec, s[92:93]
    s_cbranch_execz K2_LD_L
    ds_write_b32 v64, v63 offset:24
    s_mov_b64 exec, s[94:95]
    s_cbranch_execz K2_LD_L
    ds_write_b32 v64, v63 offset:28
    s_mov_b64 exec, s[96:97]
    s_cbranch_execz K2_LD_L
    ds_write_b32 v64, v63 offset:32
K2_LD_L:
    s_mov_b64 exec, -1
    v_lshl_add_u32 v63, v176, 2, s58
    v_lshlrev_b32 v62, 5, v176
    s_waitcnt lgkmcnt(0)
    ds_read_b32 v64, v63 offset:0
    ds_read_b32 v65, v63 offset:252
    ds_read_b32 v66, v63 offset:504
    s_min_u32 s60, s59, 63
    s_sub_u32 s59, s59, s60
    s_bfm_b64 s[42:43], s60, 0
    s_min_u32 s60, s59, 63
    s_sub_u32 s59, s59, s60
    s_bfm_b64 s[44:45], s60, 0
    s_min_u32 s60, s59, 63
    s_sub_u32 s59, s59, s60
    s_bfm_b64 s[46:47], s60, 0
    s_mov_b64 s[48:49], 0
    s_mov_b32 s65, 1
    s_mov_b32 s60, 0
    s_waitcnt lgkmcnt(2)
    v_add3_u32 v182, v62, v64, s60
    s_mov_b64 exec, s[42:43]
    buffer_load_dwordx4 v[4:7], v182, s[8:11], 0 offen sc1
    s_mov_b32 s60, 2016
    s_waitcnt lgkmcnt(1)
    v_add3_u32 v183, v62, v65, s60
    s_mov_b64 exec, s[44:45]
    buffer_load_dwordx4 v[8:11], v183, s[8:11], 0 offen sc1
    s_mov_b32 s60, 4032
    s_waitcnt lgkmcnt(0)
    v_add3_u32 v184, v62, v66, s60
    s_mov_b64 exec, s[46:47]
    buffer_load_dwordx4 v[12:15], v184, s[8:11], 0 offen sc1
K2_LD_DONE:
    s_mov_b64 exec, -1
    s_cmp_eq_u32 s28, 0
    s_cbranch_scc1 K2_WLATE
    v_lshrrev_b32 v60, 6, v252
    v_bfe_u32 v61, v252, 3, 2
    v_lshl_add_u32 v60, v60, 2, v61
    v_mul_u32_u24 v60, 640, v60
    v_bfe_u32 v61, v252, 5, 1
    v_lshl_add_u32 v60, v61, 5, v60
    v_and_b32 v61, 6, v252
    v_lshl_add_u32 v60, v61, 2, v60
    v_add_u32 v60, 24576, v60
    ds_read_b64_tr_b16 v[136:137], v60 offset:0
    ds_read_b64_tr_b16 v[138:139], v60 offset:5120
    ds_read_b64_tr_b16 v[140:141], v60 offset:64
    ds_read_b64_tr_b16 v[142:143], v60 offset:5184
    ds_read_b64_tr_b16 v[144:145], v60 offset:128
    ds_read_b64_tr_b16 v[146:147], v60 offset:5248
    ds_read_b64_tr_b16 v[148:149], v60 offset:192
    ds_read_b64_tr_b16 v[150:151], v60 offset:5312
    ds_read_b64_tr_b16 v[152:153], v60 offset:256
    ds_read_b64_tr_b16 v[154:155], v60 offset:5376
    ds_read_b64_tr_b16 v[156:157], v60 offset:320
    ds_read_b64_tr_b16 v[158:159], v60 offset:5440
    ds_read_b64_tr_b16 v[160:161], v60 offset:384
    ds_read_b64_tr_b16 v[162:163], v60 offset:5504
    ds_read_b64_tr_b16 v[164:165], v60 offset:448
    ds_read_b64_tr_b16 v[166:167], v60 offset:5568
    ds_read_b64_tr_b16 v[168:169], v60 offset:512
    ds_read_b64_tr_b16 v[170:171], v60 offset:5632
    ds_read_b64_tr_b16 v[172:173], v60 offset:576
    ds_read_b64_tr_b16 v[174:175], v60 offset:5696
    s_waitcnt lgkmcnt(0)
K2_WUNP:
    v_lshlrev_b32 v96, 16, v136
    v_and_b32 v97, 0xffff0000, v136
    v_lshlrev_b32 v98, 16, v137
    v_and_b32 v99, 0xffff0000, v137
    v_lshlrev_b32 v100, 16, v138
    v_and_b32 v101, 0xffff0000, v138
    v_lshlrev_b32 v102, 16, v139
    v_and_b32 v103, 0xffff0000, v139
    v_lshlrev_b32 v104, 16, v140
    v_and_b32 v105, 0xffff0000, v140
    v_lshlrev_b32 v106, 16, v141
    v_and_b32 v107, 0xffff0000, v141
    v_lshlrev_b32 v108, 16, v142
    v_and_b32 v109, 0xffff0000, v142
    v_lshlrev_b32 v110, 16, v143
    v_and_b32 v111, 0xffff0000, v143
    v_lshlrev_b32 v112, 16, v144
    v_and_b32 v113, 0xffff0000, v144
    v_lshlrev_b32 v114, 16, v145
    v_and_b32 v115, 0xffff0000, v145
    v_lshlrev_b32 v116, 16, v146
    v_and_b32 v117, 0xffff0000, v146
    v_lshlrev_b32 v118, 16, v147
    v_and_b32 v119, 0xffff0000, v147
    v_lshlrev_b32 v120, 16, v148
    v_and_b32 v121, 0xffff0000, v148
    v_lshlrev_b32 v122, 16, v149
    v_and_b32 v123, 0xffff0000, v149
    v_lshlrev_b32 v124, 16, v150
    v_and_b32 v125, 0xffff0000, v150
    v_lshlrev_b32 v126, 16, v151
    v_and_b32 v127, 0xffff0000, v151
    v_lshlrev_b32 v128, 16, v152
    v_and_b32 v129, 0xffff0000, v152
    v_lshlrev_b32 v130, 16, v153
    v_and_b32 v131, 0xffff0000, v153
    v_lshlrev_b32 v132, 16, v154
    v_and_b32 v133, 0xffff0000, v154
    v_lshlrev_b32 v134, 16, v155
    v_and_b32 v135, 0xffff0000, v155
    v_lshlrev_b32 v136, 16, v156
    v_and_b32 v137, 0xffff0000, v156
    v_lshlrev_b32 v138, 16, v157
    v_and_b32 v139, 0xffff0000, v157
    v_lshlrev_b32 v140, 16, v158
    v_and_b32 v141, 0xffff0000, v158
    v_lshlrev_b32 v142, 16, v159
    v_and_b32 v143, 0xffff0000, v159
    v_lshlrev_b32 v144, 16, v160
    v_and_b32 v145, 0xffff0000, v160
    v_lshlrev_b32 v146, 16, v161
    v_and_b32 v147, 0xffff0000, v161
    v_lshlrev_b32 v148, 16, v162
    v_and_b32 v149, 0xffff0000, v162
    v_lshlrev_b32 v150, 16, v163
    v_and_b32 v151, 0xffff0000, v163
    v_lshlrev_b32 v152, 16, v164
    v_and_b32 v153, 0xffff0000, v164
    v_lshlrev_b32 v154, 16, v165
    v_and_b32 v155, 0xffff0000, v165
    v_lshlrev_b32 v156, 16, v166
    v_and_b32 v157, 0xffff0000, v166
    v_lshlrev_b32 v158, 16, v167
    v_and_b32 v159, 0xffff0000, v167
    v_lshlrev_b32 v160, 16, v168
    v_and_b32 v161, 0xffff0000, v168
    v_lshlrev_b32 v162, 16, v169
    v_and_b32 v163, 0xffff0000, v169
    v_lshlrev_b32 v164, 16, v170
    v_and_b32 v165, 0xffff0000, v170
    v_lshlrev_b32 v166, 16, v171
    v_and_b32 v167, 0xffff0000, v171
    v_lshlrev_b32 v168, 16, v172
    v_and_b32 v169, 0xffff0000, v172
    v_lshlrev_b32 v170, 16, v173
    v_and_b32 v171, 0xffff0000, v173
    v_lshlrev_b32 v172, 16, v174
    v_and_b32 v173, 0xffff0000, v174
    v_lshlrev_b32 v174, 16, v175
    v_and_b32 v175, 0xffff0000, v175
K2_NOWRAW:
K2_PAD_NW:
    s_cbranch_execz KS_HOP
    v_lshrrev_b32 v179, 2, v181
    v_lshrrev_b32 v185, 2, v182
    v_lshrrev_b32 v186, 2, v183
    v_lshrrev_b32 v187, 2, v184
    s_mov_b32 s66, 7340032
    v_mov_b32 v201, 1
    s_movk_i32 s58, 520
    s_movk_i32 s59, 2080
    s_mov_b32 s60, 0x40000
    s_mov_b32 s61, 0xffff
    v_mov_b32 v202, 65536
    s_cmp_lg_u32 s24, 0
    s_cbranch_scc1 K2_RK_LOAD
    v_cmp_lt_i32 vcc, 20, v180
    s_nop 0
    s_cbranch_vccz K2_NOMORE
    v_mov_b32 v61, 160708
    ds_write_b32 v61, v201
K2_NOMORE:
    v_lshlrev_b32 v72, 4, v176
    s_mov_b32 s64, 7176192
    s_mov_b32 s62, 82176
    s_cmp_eq_u32 s65, 0
    s_waitcnt vmcnt(3)
    s_cbranch_scc0 K2_ARR
    s_waitcnt vmcnt(0)
K2_ARR:
    s_mov_b64 exec, s[40:41]
    s_cbranch_execz K2_RK_A
K2_CK0:
    v_bfi_b32 v192, s61, v1, v2
    v_lshrrev_b32 v50, 24, v3
    v_cmp_ne_u32 vcc, s2, v192
    v_add_u32 v40, 160480, v50
    s_cbranch_vccnz K2_RT0
    ds_add_rtn_u32 v40, v40, v201
    v_mad_u32_u24 v50, v50, s58, v202
    s_mov_b64 exec, s[42:43]
    s_cbranch_execz K2_RK_A
    s_waitcnt vmcnt(2)
K2_CK1:
    v_bfi_b32 v192, s61, v5, v6
    v_lshrrev_b32 v51, 24, v7
    v_cmp_ne_u32 vcc, s2, v192
    v_add_u32 v41, 160480, v51
    s_cbranch_vccnz K2_RT1
    ds_add_rtn_u32 v41, v41, v201
    v_mad_u32_u24 v51, v51, s58, v202
    s_mov_b64 exec, s[44:45]
    s_cbranch_execz K2_RK_A
    s_waitcnt vmcnt(1)
K2_CK2:
    v_bfi_b32 v192, s61, v9, v10
    v_lshrrev_b32 v52, 24, v11
    v_cmp_ne_u32 vcc, s2, v192
    v_add_u32 v42, 160480, v52
    s_cbranch_vccnz K2_RT2
    ds_add_rtn_u32 v42, v42, v201
    v_mad_u32_u24 v52, v52, s58, v202
    s_mov_b64 exec, s[46:47]
    s_cbranch_execz K2_RK_A
    s_waitcnt vmcnt(0)
K2_CK3:
    v_bfi_b32 v192, s61, v13, v14
    v_lshrrev_b32 v53, 24, v15
    v_cmp_ne_u32 vcc, s2, v192
    v_add_u32 v43, 160480, v53
    s_cbranch_vccnz K2_RT3
    ds_add_rtn_u32 v43, v43, v201
    v_mad_u32_u24 v53, v53, s58, v202
    s_mov_b64 exec, s[48:49]
    s_cbranch_execz K2_RK_A
K2_CK4:
    v_bfi_b32 v192, s61, v17, v18
    v_lshrrev_b32 v54, 24, v19
    v_cmp_ne_u32 vcc, s2, v192
    v_add_u32 v44, 160480, v54
    s_cbranch_vccnz K2_RT4
    ds_add_rtn_u32 v44, v44, v201
    v_mad_u32_u24 v54, v54, s58, v202
    s_mov_b64 exec, s[50:51]
    s_cbranch_execz K2_RK_A
K2_CK5:
    v_bfi_b32 v192, s61, v21, v22
    v_lshrrev_b32 v55, 24, v23
    v_cmp_ne_u32 vcc, s2, v192
    v_add_u32 v45, 160480, v55
    s_cbranch_vccnz K2_RT5
    ds_add_rtn_u32 v45, v45, v201
    v_mad_u32_u24 v55, v55, s58, v202
    s_mov_b64 exec, s[90:91]
    s_cbranch_execz K2_RK_A
K2_CK6:
    v_bfi_b32 v192, s61, v25, v26
    v_lshrrev_b32 v56, 24, v27
    v_cmp_ne_u32 vcc, s2, v192
    v_add_u32 v46, 160480, v56
    s_cbranch_vccnz K2_RT6
    ds_add_rtn_u32 v46, v46, v201
    v_mad_u32_u24 v56, v56, s58, v202
    s_mov_b64 exec, s[92:93]
    s_cbranch_execz K2_RK_A
K2_CK7:
    v_bfi_b32 v192, s61, v29, v30
    v_lshrrev_b32 v57, 24, v31
    v_cmp_ne_u32 vcc, s2, v192
    v_add_u32 v47, 160480, v57
    s_cbranch_vccnz K2_RT7
    ds_add_rtn_u32 v47, v47, v201
    v_mad_u32_u24 v57, v57, s58, v202
    s_mov_b64 exec, s[94:95]
    s_cbranch_execz K2_RK_A
K2_CK8:
    v_bfi_b32 v192, s61, v33, v34
    v_lshrrev_b32 v58, 24, v35
    v_cmp_ne_u32 vcc, s2, v192
    v_add_u32 v48, 160480, v58
    s_cbranch_vccnz K2_RT8
    ds_add_rtn_u32 v48, v48, v201
    v_mad_u32_u24 v58, v58, s58, v202
    s_mov_b64 exec, s[96:97]
    s_cbranch_execz K2_RK_A
K2_CK9:
    v_bfi_b32 v192, s61, v37, v38
    v_lshrrev_b32 v59, 24, v39
    v_cmp_ne_u32 vcc, s2, v192
    v_add_u32 v49, 160480, v59
    s_cbranch_vccnz K2_RT9
    ds_add_rtn_u32 v49, v49, v201
    v_mad_u32_u24 v59, v59, s58, v202
K2_RK_A:
    s_mov_b64 exec, -1
    s_cmp_eq_u32 s20, 7
    s_cbranch_scc1 K2_FLGLD
K2_FLGL2:
    s_mov_b64 exec, s[40:41]
    s_cbranch_execz K2_TP
    v_cmp_gt_u32 vcc, s62, v50
    v_and_b32 v3, 0xffffff, v3
    s_mov_b64 exec, vcc
    buffer_load_dword v245, v3, s[16:19], 0 offen
    s_mov_b64 exec, s[42:43]
    s_cbranch_execz K2_TP
    v_cmp_gt_u32 vcc, s62, v51
    v_and_b32 v7, 0xffffff, v7
    s_mov_b64 exec, vcc
    buffer_load_dword v245, v7, s[16:19], 0 offen
    s_mov_b64 exec, s[44:45]
    s_cbranch_execz K2_TP
    v_cmp_gt_u32 vcc, s62, v52
    v_and_b32 v11, 0xffffff, v11
    s_mov_b64 exec, vcc
    buffer_load_dword v245, v11, s[16:19], 0 offen
    s_mov_b64 exec, s[46:47]
    s_cbranch_execz K2_TP
    v_cmp_gt_u32 vcc, s62, v53
    v_and_b32 v15, 0xffffff, v15
    s_mov_b64 exec, vcc
    buffer_load_dword v245, v15, s[16:19], 0 offen
    s_mov_b64 exec, s[48:49]
    s_cbranch_execz K2_TP
    v_cmp_gt_u32 vcc, s62, v54
    v_and_b32 v19, 0xffffff, v19
    s_mov_b64 exec, vcc
    buffer_load_dword v245, v19, s[16:19], 0 offen
    s_mov_b64 exec, s[50:51]
    s_cbranch_execz K2_TP
    v_cmp_gt_u32 vcc, s62, v55
    v_and_b32 v23, 0xffffff, v23
    s_mov_b64 exec, vcc
    buffer_load_dword v245, v23, s[16:19], 0 offen
    s_mov_b64 exec, s[90:91]
    s_cbranch_execz K2_TP
    v_cmp_gt_u32 vcc, s62, v56
    v_and_b32 v27, 0xffffff, v27
    s_mov_b64 exec, vcc
    buffer_load_dword v245, v27, s[16:19], 0 offen
    s_mov_b64 exec, s[92:93]
    s_cbranch_execz K2_TP
    v_cmp_gt_u32 vcc, s62, v57
    v_and_b32 v31, 0xffffff, v31
    s_mov_b64 exec, vcc
    buffer_load_dword v245, v31, s[16:19], 0 offen
    s_mov_b64 exec, s[94:95]
    s_cbranch_execz K2_TP
    v_cmp_gt_u32 vcc, s62, v58
    v_and_b32 v35, 0xffffff, v35
    s_mov_b64 exec, vcc
    buffer_load_dword v245, v35, s[16:19], 0 offen
    s_mov_b64 exec, s[96:97]
    s_cbranch_execz K2_TP
    v_cmp_gt_u32 vcc, s62, v59
    v_and_b32 v39, 0xffffff, v39
    s_mov_b64 exec, vcc
    buffer_load_dword v245, v39, s[16:19], 0 offen
K2_TP:
    s_mov_b64 exec, -1
K2_RK_DONE:
K2_PAD_SC:
    s_cbranch_execz KS_HOP
    s_mul_i32 s67, s24, 48
    s_mov_b32 s58, 1
    s_waitcnt lgkmcnt(0)
    s_mov_b64 exec, s[40:41]
    s_cbranch_execz K2_SC_DONE
    v_cmpx_gt_u32 vcc, 48, v40
    v_lshl_add_u32 v194, v40, 5, v50
    v_lshl_add_u32 v195, v40, 1, v50
    ds_write_b32 v194, v3 offset:480
    ds_write_b16 v195, v0 offset:96
    ds_write_b16_d16_hi v195, v0 offset:192
    ds_write_b16_d16_hi v195, v1 offset:288
    ds_write_b16 v195, v2 offset:384
    s_cmp_lg_u64 exec, s[40:41]
    s_addc_u32 s58, s58, s58
    s_mov_b64 exec, s[42:43]
    s_cbranch_execz K2_SC_DONE
    v_cmpx_gt_u32 vcc, 48, v41
    v_lshl_add_u32 v194, v41, 5, v51
    v_lshl_add_u32 v195, v41, 1, v51
    ds_write_b32 v194, v7 offset:480
    ds_write_b16 v195, v4 offset:96
    ds_write_b16_d16_hi v195, v4 offset:192
    ds_write_b16_d16_hi v195, v5 offset:288
    ds_write_b16 v195, v6 offset:384
    s_cmp_lg_u64 exec, s[42:43]
    s_addc_u32 s58, s58, s58
    s_mov_b64 exec, s[44:45]
    s_cbranch_execz K2_SC_DONE
    v_cmpx_gt_u32 vcc, 48, v42
    v_lshl_add_u32 v194, v42, 5, v52
    v_lshl_add_u32 v195, v42, 1, v52
    ds_write_b32 v194, v11 offset:480
    ds_write_b16 v195, v8 offset:96
    ds_write_b16_d16_hi v195, v8 offset:192
    ds_write_b16_d16_hi v195, v9 offset:288
    ds_write_b16 v195, v10 offset:384
    s_cmp_lg_u64 exec, s[44:45]
    s_addc_u32 s58, s58, s58
    s_mov_b64 exec, s[46:47]
    s_cbranch_execz K2_SC_DONE
    v_cmpx_gt_u32 vcc, 48, v43
    v_lshl_add_u32 v194, v43, 5, v53
    v_lshl_add_u32 v195, v43, 1, v53
    ds_write_b32 v194, v15 offset:480
    ds_write_b16 v195, v12 offset:96
    ds_write_b16_d16_hi v195, v12 offset:192
    ds_write_b16_d16_hi v195, v13 offset:288
    ds_write_b16 v195, v14 offset:384
    s_cmp_lg_u64 exec, s[46:47]
    s_addc_u32 s58, s58, s58
    s_mov_b64 exec, s[48:49]
    s_cbranch_execz K2_SC_DONE
    v_cmpx_gt_u32 vcc, 48, v44
    v_lshl_add_u32 v194, v44, 5, v54
    v_lshl_add_u32 v195, v44, 1, v54
    ds_write_b32 v194, v19 offset:480
    ds_write_b16 v195, v16 offset:96
    ds_write_b16_d16_hi v195, v16 offset:192
    ds_write_b16_d16_hi v195, v17 offset:288
    ds_write_b16 v195, v18 offset:384
    s_cmp_lg_u64 exec, s[48:49]
    s_addc_u32 s58, s58, s58
    s_mov_b64 exec, s[50:51]
    s_cbranch_execz K2_SC_DONE
    v_cmpx_gt_u32 vcc, 48, v45
    v_lshl_add_u32 v194, v45, 5, v55
    v_lshl_add_u32 v195, v45, 1, v55
    ds_write_b32 v194, v23 offset:480
    ds_write_b16 v195, v20 offset:96
    ds_write_b16_d16_hi v195, v20 offset:192
    ds_write_b16_d16_hi v195, v21 offset:288
    ds_write_b16 v195, v22 offset:384
    s_cmp_lg_u64 exec, s[50:51]
    s_addc_u32 s58, s58, s58
    s_mov_b64 exec, s[90:91]
    s_cbranch_execz K2_SC_DONE
    v_cmpx_gt_u32 vcc, 48, v46
    v_lshl_add_u32 v194, v46, 5, v56
    v_lshl_add_u32 v195, v46, 1, v56
    ds_write_b32 v194, v27 offset:480
    ds_write_b16 v195, v24 offset:96
    ds_write_b16_d16_hi v195, v24 offset:192
    ds_write_b16_d16_hi v195, v25 offset:288
    ds_write_b16 v195, v26 offset:384
    s_cmp_lg_u64 exec, s[90:91]
    s_addc_u32 s58, s58, s58
    s_mov_b64 exec, s[92:93]
    s_cbranch_execz K2_SC_DONE
    v_cmpx_gt_u32 vcc, 48, v47
    v_lshl_add_u32 v194, v47, 5, v57
    v_lshl_add_u32 v195, v47, 1, v57
    ds_write_b32 v194, v31 offset:480
    ds_write_b16 v195, v28 offset:96
    ds_write_b16_d16_hi v195, v28 offset:192
    ds_write_b16_d16_hi v195, v29 offset:288
    ds_write_b16 v195, v30 offset:384
    s_cmp_lg_u64 exec, s[92:93]
    s_addc_u32 s58, s58, s58
    s_mov_b64 exec, s[94:95]
    s_cbranch_execz K2_SC_DONE
    v_cmpx_gt_u32 vcc, 48, v48
    v_lshl_add_u32 v194, v48, 5, v58
    v_lshl_add_u32 v195, v48, 1, v58
    ds_write_b32 v194, v35 offset:480
    ds_write_b16 v195, v32 offset:96
    ds_write_b16_d16_hi v195, v32 offset:192
    ds_write_b16_d16_hi v195, v33 offset:288
    ds_write_b16 v195, v34 offset:384
    s_cmp_lg_u64 exec, s[94:95]
    s_addc_u32 s58, s58, s58
    s_mov_b64 exec, s[96:97]
    s_cbranch_execz K2_SC_DONE
    v_cmpx_gt_u32 vcc, 48, v49
    v_lshl_add_u32 v194, v49, 5, v59
    v_lshl_add_u32 v195, v49, 1, v59
    ds_write_b32 v194, v39 offset:480
    ds_write_b16 v195, v36 offset:96
    ds_write_b16_d16_hi v195, v36 offset:192
    ds_write_b16_d16_hi v195, v37 offset:288
    ds_write_b16 v195, v38 offset:384
    s_cmp_lg_u64 exec, s[96:97]
    s_addc_u32 s58, s58, s58
K2_SC_DONE:
    s_mov_b64 exec, -1
K2_PAD_SD:
    s_cbranch_execz KS_HOP
    s_bcnt1_i32_b32 s61, s58
    s_cmp_gt_u32 s61, 1
    s_cbranch_scc1 K2_OV
K2_OB:
    v_lshlrev_b32 v192, 2, v176
    v_add_u32 v192, 160480, v192
    v_mov_b32 v200, 160708
    v_mov_b32 v198, 0
    s_movk_i32 s26, 48
    s_cmp_eq_u32 s20, 7
    s_cbranch_scc1 K2_FLGCK
K2_FLGOK:
    s_waitcnt lgkmcnt(0)
    s_barrier
    ds_read_b32 v193, v192
    ds_read_b32 v200, v200
    v_cmp_gt_u32 s[56:57], s22, v176
    v_mad_u32_u24 v195, v176, s59, v202
    s_waitcnt lgkmcnt(0)
    v_cndmask_b32 v193, 0, v193, s[56:57]
    v_readfirstlane_b32 s27, v200
    v_cmp_lt_u32 vcc, 48, v193
    s_nop 0
    s_cbranch_vccnz K2_BIG
K2_TOK:
    v_subrev_u32 v194, s67, v193
    v_max_i32 v194, 1, v194
    v_min_i32 v194, s26, v194
    v_add_u32 v194, 15, v194
    v_lshrrev_b32 v194, 4, v194
    v_lshl_or_b32 v195, v194, 18, v195
    v_or_b32 v195, v195, v198
    v_mov_b32 v197, 422496
    v_cndmask_b32 v253, v197, v195, s[56:57]
    s_movk_i32 s40, 0
    s_movk_i32 s41, 256
    s_movk_i32 s42, 512
    s_movk_i32 s43, 768
    s_add_u32 s24, s24, 1
    s_cmp_ge_u32 s24, s25
    s_cselect_b32 s55, 1, 0
    s_cmp_eq_u32 s27, 0
    s_cselect_b32 s55, s55, 0
    s_mov_b32 s27, 0x400000
    s_mov_b32 s38, 0
    s_mov_b32 s34, 0
    s_mov_b32 s35, 0
    s_mov_b32 s36, 1
    s_mov_b32 s31, 0
    s_mov_b32 s58, s20
    v_readlane_b32 s3, v253, s58
    s_lshl_b32 s44, s34, 7
    s_and_b32 s48, s3, 0x3ffff
    s_bfe_u32 s33, s3, 0x30012
    s_mul_i32 s35, s38, 6
    s_cmp_eq_u32 s34, 0
    s_cselect_b32 s35, s35, s48
    s_mov_b32 s45, s44
    s_add_u32 s47, s44, 256
    s_add_u32 s49, s48, 32
    s_add_u32 s60, s48, 64
    s_cmp_eq_u32 s33, 3
    s_cselect_b32 s46, s44, s47
    s_cselect_b32 s50, s60, s48
    s_cselect_b32 s51, s48, s49
    s_sub_u32 s60, s33, 2
    s_cmp_lt_u32 s60, 2
    s_cbranch_scc0 K2_rare_1
K2_back_2:
    v_add_u32 v233, s48, v230
    ds_read_b32 v232, v233
    ds_read_b32 v233, v233 offset:1024
    v_add_u32 v222, s48, v251
    ds_read_b32 v222, v222
    v_add_u32 v224, s49, v251
    ds_read_b32 v224, v224
    v_add_u32 v226, s50, v251
    ds_read_b32 v226, v226
    v_add_u32 v228, s51, v251
    ds_read_b32 v228, v228
    s_waitcnt lgkmcnt(4)
    v_or_b32 v232, v232, v231
    v_or_b32 v233, v233, v231
    s_cmp_lg_u32 s34, 0
    s_cbranch_scc1 K2_dum_4
    s_add_u32 m0, s48, 480
    s_add_u32 s65, s48, 1504
    buffer_load_dwordx4 v232, s[16:19], 0 offen  lds
    s_mov_b32 m0, s65
    s_mov_b32 exec_hi, 0
    buffer_load_dwordx4 v233, s[16:19], 0 offen  lds
    s_cmp_eq_u32 s33, 4
    s_cbranch_scc1 K2_a4_5
K2_b4_7:
    s_mov_b32 exec_hi, -1
K2_back_6:
    s_waitcnt lgkmcnt(3)
    v_mad_u32_u16 v223, v222, s39, v248 op_sel:[1,0,0,0]
    v_mad_u32_u16 v222, v222, s39, v248
    s_waitcnt lgkmcnt(2)
    v_mad_u32_u16 v225, v224, s39, v248 op_sel:[1,0,0,0]
    v_mad_u32_u16 v224, v224, s39, v248
    s_waitcnt lgkmcnt(1)
    v_mad_u32_u16 v227, v226, s39, v248 op_sel:[1,0,0,0]
    v_mad_u32_u16 v226, v226, s39, v248
    s_waitcnt lgkmcnt(0)
    v_mad_u32_u16 v229, v228, s39, v248 op_sel:[1,0,0,0]
    v_mad_u32_u16 v228, v228, s39, v248
    s_mov_b32 m0, s68
    s_nop 0
    buffer_load_dwordx4 v222, s[4:7], s44 offen sc1 lds
    buffer_load_dwordx4 v223, s[72:75], s44 offen offset:1024 sc1 lds
    s_mov_b32 m0, s69
    s_nop 0
    buffer_load_dwordx4 v224, s[4:7], s45 offen sc1 lds
    buffer_load_dwordx4 v225, s[72:75], s45 offen offset:1024 sc1 lds
    s_mov_b32 m0, s70
    s_nop 0
    buffer_load_dwordx4 v226, s[4:7], s46 offen sc1 lds
    buffer_load_dwordx4 v227, s[72:75], s46 offen offset:1024 sc1 lds
    s_mov_b32 m0, s71
    s_nop 0
    buffer_load_dwordx4 v228, s[4:7], s47 offen sc1 lds
    buffer_load_dwordx4 v229, s[72:75], s47 offen offset:1024 sc1 lds
    v_add_u32 v249, s48, v249
    v_add_u32 v250, s48, v250
    s_waitcnt vmcnt(6)
    ds_read_b64_tr_b16 v[176:177], v246 offset:0
    ds_read_b64_tr_b16 v[178:179], v246 offset:512
    ds_read_b64_tr_b16 v[180:181], v247 offset:0
    ds_read_b64_tr_b16 v[182:183], v247 offset:512
    ds_read_b64_tr_b16 v[0:1], v249 offset:0
    ds_read_b64_tr_b16 v[2:3], v249 offset:256
    ds_read_u16_d16_hi v16, v250 offset:0
    ds_read_b64_tr_b16 v[4:5], v249 offset:512
    ds_read_b64_tr_b16 v[6:7], v249 offset:768
    ds_read_u16_d16_hi v17, v250 offset:32
    s_mov_b32 s29, s48
    s_mov_b32 s32, s31
    s_mov_b32 s30, s3
    s_mov_b32 s31, s35
    s_cmp_eq_u32 s33, 2
    s_cbranch_scc1 K2_U20
    s_cmp_eq_u32 s33, 3
    s_cbranch_scc1 K2_U30
    s_cmp_eq_u32 s33, 1
    s_cbranch_scc1 K2_U10
    s_branch K2_U40
K2_PAD_H1:
    s_branch KS_HOP0
KS_HELP:
    s_mov_b32 s30, 0
    s_cmp_eq_u32 s20, 6
    s_cbranch_scc1 KS_RAW
    s_mov_b32 s30, 2
    s_cmp_ge_u32 s2, 170
    s_cbranch_scc1 KS_NOW
    s_mov_b32 s30, 1
    v_and_b32 v1, 15, v8
    v_lshrrev_b32 v3, 4, v8
    s_cmp_ge_u32 s2, 160
    s_cbranch_scc1 K1_WT
    s_cmp_ge_u32 s2, 64
    s_cbranch_scc1 K1_S1
    s_lshr_b32 s24, s2, 3
    s_and_b32 s25, s2, 7
    s_lshr_b32 s26, s25, 2
    s_bfe_u32 s27, s25, 0x10001
    s_and_b32 s28, s25, 1
    s_mov_b32 s60, s92
    s_and_b32 s61, s93, 0xffff
    s_mov_b32 s62, 65536
    s_mov_b32 s63, 0x20000
    s_branch K1_SC
K1_S1:
    s_sub_u32 s29, s2, 64
    s_mul_i32 s24, s29, 43
    s_lshr_b32 s24, s24, 9
    s_mul_i32 s25, s24, 12
    s_sub_u32 s25, s29, s25
    s_cmp_ge_u32 s25, 6
    s_cselect_b32 s26, 1, 0
    s_mul_i32 s27, s26, 6
    s_sub_u32 s27, s25, s27
    s_lshr_b32 s27, s27, 1
    s_and_b32 s28, s25, 1
    s_add_u32 s25, s25, 8
    s_mov_b32 s60, s94
    s_and_b32 s61, s95, 0xffff
    s_mov_b32 s62, 98304
    s_mov_b32 s63, 0x20000
K1_SC:
    s_lshl_b32 s27, s27, 7
    s_lshl_b32 s26, s26, 6
    s_lshl_b32 s28, s28, 4
    s_add_u32 s27, s27, s26
    s_add_u32 s27, s27, s28
    s_lshl_b32 s27, s27, 8
    s_lshl_b32 s26, s24, 5
    s_add_u32 s27, s27, s26
    s_add_u32 s29, s27, 8192
    v_lshlrev_b32 v3, 10, v3
    v_lshl_add_u32 v3, v1, 1, v3
    buffer_load_ushort v64, v3, s[60:63], s27 offen offset:0
    buffer_load_ushort v65, v3, s[60:63], s29 offen offset:0
    buffer_load_ushort v66, v3, s[60:63], s27 offen offset:256
    buffer_load_ushort v67, v3, s[60:63], s29 offen offset:256
    buffer_load_ushort v68, v3, s[60:63], s27 offen offset:512
    buffer_load_ushort v69, v3, s[60:63], s29 offen offset:512
    buffer_load_ushort v70, v3, s[60:63], s27 offen offset:768
    buffer_load_ushort v71, v3, s[60:63], s29 offen offset:768
    s_mul_i32 s24, s24, 20
    s_add_u32 s24, s24, s25
    s_lshl_b32 s24, s24, 10
    s_add_u32 s24, s24, 6946816
    s_branch K1_GO
K1_WT:
    s_sub_u32 s24, s2, 160
    s_lshr_b32 s27, s24, 1
    s_and_b32 s28, s24, 1
    s_lshl_b32 s27, s27, 8
    s_lshl_b32 s28, s28, 6
    s_add_u32 s27, s27, s28
    s_add_u32 s29, s27, 10240
    s_mov_b32 s60, s90
    s_and_b32 s61, s91, 0xffff
    s_mov_b32 s62, 20480
    s_mov_b32 s63, 0x20000
    v_and_b32 v1, 31, v8
    v_lshrrev_b32 v3, 5, v8
    v_mul_u32_u24 v3, 5120, v3
    v_lshl_add_u32 v3, v1, 1, v3
    buffer_load_ushort v64, v3, s[60:63], s27 offen offset:0
    buffer_load_ushort v65, v3, s[60:63], s27 offen offset:1280
    buffer_load_ushort v66, v3, s[60:63], s27 offen offset:2560
    buffer_load_ushort v67, v3, s[60:63], s27 offen offset:3840
    buffer_load_ushort v68, v3, s[60:63], s29 offen offset:0
    buffer_load_ushort v69, v3, s[60:63], s29 offen offset:1280
    buffer_load_ushort v70, v3, s[60:63], s29 offen offset:2560
    buffer_load_ushort v71, v3, s[60:63], s29 offen offset:3840
    s_lshl_b32 s24, s24, 10
    s_add_u32 s24, s24, 7110656
K1_GO:
KS_NOW:
    s_barrier
K2_PAD_H2:
    s_cbranch_execz KS_HOP0
KS_FILL:
    v_subrev_u32 v76, 320, v0
    v_mov_b32 v80, -1
    v_mov_b32 v77, 0x3f803f80
    v_cmp_gt_u32 vcc, 24, v76
    v_lshlrev_b32 v78, 4, v76
    v_add_u32 v78, 65536, v78
    v_cndmask_b32 v80, v80, 0, vcc
    v_cmp_gt_u32 vcc, 6, v76
    v_add_u32 v79, 56160, v78
    s_nop 0
    v_cndmask_b32 v80, v80, v77, vcc
    v_cmp_gt_u32 vcc, 94, v76
    v_mov_b32 v81, v80
    v_mov_b32 v82, v80
    v_mov_b32 v83, v80
    s_mov_b64 s[56:57], vcc
    ds_write_b128 v78, v[80:83] offset:0
    ds_write_b128 v78, v[80:83] offset:2080
    ds_write_b128 v78, v[80:83] offset:4160
    ds_write_b128 v78, v[80:83] offset:6240
    ds_write_b128 v78, v[80:83] offset:8320
    ds_write_b128 v78, v[80:83] offset:10400
    ds_write_b128 v78, v[80:83] offset:12480
    ds_write_b128 v78, v[80:83] offset:14560
    ds_write_b128 v78, v[80:83] offset:16640
    ds_write_b128 v78, v[80:83] offset:18720
    ds_write_b128 v78, v[80:83] offset:20800
    ds_write_b128 v78, v[80:83] offset:22880
    ds_write_b128 v78, v[80:83] offset:24960
    ds_write_b128 v78, v[80:83] offset:27040
    ds_write_b128 v78, v[80:83] offset:29120
    ds_write_b128 v78, v[80:83] offset:31200
    ds_write_b128 v78, v[80:83] offset:33280
    ds_write_b128 v78, v[80:83] offset:35360
    ds_write_b128 v78, v[80:83] offset:37440
    ds_write_b128 v78, v[80:83] offset:39520
    ds_write_b128 v78, v[80:83] offset:41600
    ds_write_b128 v78, v[80:83] offset:43680
    ds_write_b128 v78, v[80:83] offset:45760
    ds_write_b128 v78, v[80:83] offset:47840
    ds_write_b128 v78, v[80:83] offset:49920
    ds_write_b128 v78, v[80:83] offset:52000
    ds_write_b128 v78, v[80:83] offset:54080
    ds_write_b128 v79, v[80:83] offset:0
    ds_write_b128 v79, v[80:83] offset:2080
    ds_write_b128 v79, v[80:83] offset:4160
    ds_write_b128 v79, v[80:83] offset:6240
    ds_write_b128 v79, v[80:83] offset:8320
    ds_write_b128 v79, v[80:83] offset:10400
    ds_write_b128 v79, v[80:83] offset:12480
    ds_write_b128 v79, v[80:83] offset:14560
    ds_write_b128 v79, v[80:83] offset:16640
    ds_write_b128 v79, v[80:83] offset:18720
    ds_write_b128 v79, v[80:83] offset:20800
    ds_write_b128 v79, v[80:83] offset:22880
    ds_write_b128 v79, v[80:83] offset:24960
    v_mov_b32 v59, 160784
    s_barrier
    ds_read_b32 v59, v59
    s_mov_b64 exec, s[56:57]
    ds_write_b128 v79, v[80:83] offset:27040
    s_mov_b64 exec, -1
    s_waitcnt vmcnt(0) lgkmcnt(0)
    s_cmp_eq_u32 s30, 0
    s_cbranch_scc1 KS_B3
    s_cmp_eq_u32 s30, 2
    s_cbranch_scc1 KS_NOST
    v_lshl_or_b32 v40, v65, 16, v64
    v_lshl_or_b32 v41, v67, 16, v66
    v_lshl_or_b32 v42, v69, 16, v68
    v_lshl_or_b32 v43, v71, 16, v70
    buffer_store_dwordx4 v[40:43], v9, s[8:11], s24 offen sc1
KS_NOST:
    s_waitcnt lgkmcnt(0)
    s_barrier
    s_lshl_b32 s24, s2, 2
    s_add_u32 s24, s24, 7176192
    s_mov_b64 exec, 1
    s_waitcnt vmcnt(0)
    buffer_store_dword v59, v6, s[8:11], s24 offen sc1
    s_mov_b64 exec, -1
    s_branch KS_JOIN
K2_PAD_H3:
    s_branch KS_HOP0
KS_RAW:
    s_barrier
    s_mov_b32 s60, s90
    s_and_b32 s61, s91, 0xffff
    s_mov_b32 s62, 20480
    s_mov_b32 s63, 0x20000
    v_lshrrev_b32 v10, 3, v8
    v_and_b32 v11, 7, v8
    v_lshlrev_b32 v10, 8, v10
    v_lshl_add_u32 v10, v11, 4, v10
    s_mov_b32 m0, 24576
    s_movk_i32 s24, 0
    buffer_load_dwordx4 v10, s[60:63], s24 offen lds
    s_mov_b32 m0, 25600
    s_movk_i32 s24, 2048
    buffer_load_dwordx4 v10, s[60:63], s24 offen lds
    s_mov_b32 m0, 26624
    s_movk_i32 s24, 4096
    buffer_load_dwordx4 v10, s[60:63], s24 offen lds
    s_mov_b32 m0, 27648
    s_movk_i32 s24, 6144
    buffer_load_dwordx4 v10, s[60:63], s24 offen lds
    s_mov_b32 m0, 28672
    s_movk_i32 s24, 8192
    buffer_load_dwordx4 v10, s[60:63], s24 offen lds
    s_mov_b32 m0, 29696
    s_movk_i32 s24, 10240
    buffer_load_dwordx4 v10, s[60:63], s24 offen lds
    s_mov_b32 m0, 30720
    s_movk_i32 s24, 12288
    buffer_load_dwordx4 v10, s[60:63], s24 offen lds
    s_mov_b32 m0, 31744
    s_movk_i32 s24, 14336
    buffer_load_dwordx4 v10, s[60:63], s24 offen lds
    s_mov_b32 m0, 32768
    s_movk_i32 s24, 16384
    buffer_load_dwordx4 v10, s[60:63], s24 offen lds
    s_mov_b32 m0, 33792
    s_movk_i32 s24, 18432
    buffer_load_dwordx4 v10, s[60:63], s24 offen lds
    s_mov_b32 m0, 150240
    s_movk_i32 s24, 128
    buffer_load_dwordx4 v10, s[60:63], s24 offen lds
    s_mov_b32 m0, 151264
    s_movk_i32 s24, 2176
    buffer_load_dwordx4 v10, s[60:63], s24 offen lds
    s_mov_b32 m0, 152288
    s_movk_i32 s24, 4224
    buffer_load_dwordx4 v10, s[60:63], s24 offen lds
    s_mov_b32 m0, 153312
    s_movk_i32 s24, 6272
    buffer_load_dwordx4 v10, s[60:63], s24 offen lds
    s_mov_b32 m0, 154336
    s_movk_i32 s24, 8320
    buffer_load_dwordx4 v10, s[60:63], s24 offen lds
    s_mov_b32 m0, 155360
    s_movk_i32 s24, 10368
    buffer_load_dwordx4 v10, s[60:63], s24 offen lds
    s_mov_b32 m0, 156384
    s_movk_i32 s24, 12416
    buffer_load_dwordx4 v10, s[60:63], s24 offen lds
    s_mov_b32 m0, 157408
    s_movk_i32 s24, 14464
    buffer_load_dwordx4 v10, s[60:63], s24 offen lds
    s_mov_b32 m0, 158432
    s_movk_i32 s24, 16512
    buffer_load_dwordx4 v10, s[60:63], s24 offen lds
    s_mov_b32 m0, 159456
    s_movk_i32 s24, 18560
    buffer_load_dwordx4 v10, s[60:63], s24 offen lds
    s_branch KS_FILL
KS_IDLE:
    s_barrier
    s_barrier
    s_branch KS_B3
K2_PAD_U20:
    s_branch K2_HOP
K2_U20:
    s_setprio 1
    s_waitcnt lgkmcnt(0)
    v_lshlrev_b32 v20, 16, v0
    v_and_b32 v21, 0xffff0000, v0
    v_lshlrev_b32 v22, 16, v1
    v_and_b32 v23, 0xffff0000, v1
    v_lshlrev_b32 v24, 16, v2
    v_and_b32 v25, 0xffff0000, v2
    v_lshlrev_b32 v26, 16, v3
    v_and_b32 v27, 0xffff0000, v3
    v_mul_f32_dpp v36, v16, v20 row_newbcast:0 row_mask:0xf bank_mask:0xf
    v_mul_f32_dpp v37, v16, v21 row_newbcast:1 row_mask:0xf bank_mask:0xf
    v_mul_f32_dpp v38, v16, v22 row_newbcast:2 row_mask:0xf bank_mask:0xf
    v_mul_f32_dpp v39, v16, v23 row_newbcast:3 row_mask:0xf bank_mask:0xf
    v_mul_f32_dpp v40, v16, v24 row_newbcast:4 row_mask:0xf bank_mask:0xf
    v_mul_f32_dpp v41, v16, v25 row_newbcast:5 row_mask:0xf bank_mask:0xf
    v_mul_f32_dpp v42, v16, v26 row_newbcast:6 row_mask:0xf bank_mask:0xf
    v_mul_f32_dpp v43, v16, v27 row_newbcast:7 row_mask:0xf bank_mask:0xf
    v_cvt_pk_bf16_f32 v64, v36, v37
    v_cvt_pk_bf16_f32 v65, v38, v39
    v_cvt_pk_bf16_f32 v66, v40, v41
    v_cvt_pk_bf16_f32 v67, v42, v43
    v_mul_f32_dpp v44, v16, v20 row_newbcast:8 row_mask:0xf bank_mask:0xf
    v_mul_f32_dpp v45, v16, v21 row_newbcast:9 row_mask:0xf bank_mask:0xf
    v_mul_f32_dpp v46, v16, v22 row_newbcast:10 row_mask:0xf bank_mask:0xf
    v_mul_f32_dpp v47, v16, v23 row_newbcast:11 row_mask:0xf bank_mask:0xf
    v_mul_f32_dpp v48, v16, v24 row_newbcast:12 row_mask:0xf bank_mask:0xf
    v_mul_f32_dpp v49, v16, v25 row_newbcast:13 row_mask:0xf bank_mask:0xf
    v_mul_f32_dpp v50, v16, v26 row_newbcast:14 row_mask:0xf bank_mask:0xf
    v_mul_f32_dpp v51, v16, v27 row_newbcast:15 row_mask:0xf bank_mask:0xf
    v_cvt_pk_bf16_f32 v68, v44, v45
    v_cvt_pk_bf16_f32 v69, v46, v47
    v_cvt_pk_bf16_f32 v70, v48, v49
    v_cvt_pk_bf16_f32 v71, v50, v51
    v_lshlrev_b32 v28, 16, v4
    v_and_b32 v29, 0xffff0000, v4
    v_lshlrev_b32 v30, 16, v5
    v_and_b32 v31, 0xffff0000, v5
    v_lshlrev_b32 v32, 16, v6
    v_and_b32 v33, 0xffff0000, v6
    v_lshlrev_b32 v34, 16, v7
    v_and_b32 v35, 0xffff0000, v7
    v_mul_f32_dpp v36, v17, v28 row_newbcast:0 row_mask:0xf bank_mask:0xf
    v_mul_f32_dpp v37, v17, v29 row_newbcast:1 row_mask:0xf bank_mask:0xf
    v_mul_f32_dpp v38, v17, v30 row_newbcast:2 row_mask:0xf bank_mask:0xf
    v_mul_f32_dpp v39, v17, v31 row_newbcast:3 row_mask:0xf bank_mask:0xf
    v_mul_f32_dpp v40, v17, v32 row_newbcast:4 row_mask:0xf bank_mask:0xf
    v_mul_f32_dpp v41, v17, v33 row_newbcast:5 row_mask:0xf bank_mask:0xf
    v_mul_f32_dpp v42, v17, v34 row_newbcast:6 row_mask:0xf bank_mask:0xf
    v_mul_f32_dpp v43, v17, v35 row_newbcast:7 row_mask:0xf bank_mask:0xf
    v_cvt_pk_bf16_f32 v72, v36, v37
    v_cvt_pk_bf16_f32 v73, v38, v39
    v_cvt_pk_bf16_f32 v74, v40, v41
    v_cvt_pk_bf16_f32 v75, v42, v43
    v_mul_f32_dpp v44, v17, v28 row_newbcast:8 row_mask:0xf bank_mask:0xf
    v_mul_f32_dpp v45, v17, v29 row_newbcast:9 row_mask:0xf bank_mask:0xf
    v_mul_f32_dpp v46, v17, v30 row_newbcast:10 row_mask:0xf bank_mask:0xf
    v_mul_f32_dpp v47, v17, v31 row_newbcast:11 row_mask:0xf bank_mask:0xf
    v_mul_f32_dpp v48, v17, v32 row_newbcast:12 row_mask:0xf bank_mask:0xf
    v_mul_f32_dpp v49, v17, v33 row_newbcast:13 row_mask:0xf bank_mask:0xf
    v_mul_f32_dpp v50, v17, v34 row_newbcast:14 row_mask:0xf bank_mask:0xf
    v_mul_f32_dpp v51, v17, v35 row_newbcast:15 row_mask:0xf bank_mask:0xf
    v_cvt_pk_bf16_f32 v76, v44, v45
    v_cvt_pk_bf16_f32 v77, v46, v47
    v_cvt_pk_bf16_f32 v78, v48, v49
    v_cvt_pk_bf16_f32 v79, v50, v51
    s_waitcnt vmcnt(4)
    v_mfma_f32_32x32x16_bf16 v[0:15], v[64:67], v[176:179], 0
    ds_read_b64_tr_b16 v[184:185], v246 offset:2048
    ds_read_b64_tr_b16 v[186:187], v246 offset:2560
    ds_read_b64_tr_b16 v[188:189], v247 offset:2048
    ds_read_b64_tr_b16 v[190:191], v247 offset:2560
    s_mov_b32 m0, s68
    v_mfma_f32_32x32x16_bf16 v[16:31], v[68:71], v[176:179], 0
    buffer_load_dwordx4 v222, s[4:7], s42 offen sc1 lds
    buffer_load_dwordx4 v223, s[72:75], s42 offen offset:1024 sc1 lds
    v_permlane32_swap_b32 v242, v236
    v_permlane32_swap_b32 v243, v237
    s_add_u32 s38, s38, 1
    v_mfma_f32_32x32x16_bf16 v[32:47], v[64:67], v[180:183], 0
    v_permlane32_swap_b32 v244, v238
    v_permlane32_swap_b32 v245, v239
    v_permlane32_swap_b32 v240, v241
    v_add_f32 v242, v242, v236
    v_mfma_f32_32x32x16_bf16 v[48:63], v[68:71], v[180:183], 0
    v_add_f32 v243, v243, v237
    v_add_f32 v244, v244, v238
    v_add_f32 v245, v245, v239
    v_add_f32 v240, -v240, -v241
    v_mov_b32 v254, s52
    v_mov_b32 v255, s38
    s_waitcnt vmcnt(4) lgkmcnt(0)
    v_mfma_f32_32x32x16_bf16 v[0:15], v[72:75], v[184:187], v[0:15]
    ds_read_b64_tr_b16 v[176:177], v246 offset:4096
    ds_read_b64_tr_b16 v[178:179], v246 offset:4608
    ds_read_b64_tr_b16 v[180:181], v247 offset:4096
    ds_read_b64_tr_b16 v[182:183], v247 offset:4608
    s_lshl_b32 s58, s38, 3
    s_add_u32 s58, s58, s20
    s_mov_b32 m0, s69
    v_mfma_f32_32x32x16_bf16 v[16:31], v[76:79], v[184:187], v[16:31]
    buffer_load_dwordx4 v224, s[4:7], s42 offen sc1 lds
    buffer_load_dwordx4 v225, s[72:75], s42 offen offset:1024 sc1 lds
    s_set_gpr_idx_on s32, gpr_idx(DST)
    s_nop 0
    v_cvt_pk_bf16_f32 v195, v242, v243
    v_cvt_pk_bf16_f32 v196, v244, v245
    v_cvt_pk_bf16_f32 v197, v240, v240
    s_set_gpr_idx_off
    s_mov_b64 exec, 1
    ds_write_b32 v254, v255
    s_mov_b64 exec, -1
    s_cmp_lt_u32 s58, s22
    s_cbranch_scc0 K2_dyn_8
K2_back_9:
    v_readlane_b32 s3, v253, s58
    s_lshl_b32 s44, s34, 7
    s_and_b32 s48, s3, 0x3ffff
    s_bfe_u32 s33, s3, 0x30012
    s_mul_i32 s35, s38, 6
    s_cmp_eq_u32 s34, 0
    s_cselect_b32 s35, s35, s48
    s_mov_b32 s45, s44
    s_add_u32 s47, s44, 256
    s_add_u32 s49, s48, 32
    s_add_u32 s60, s48, 64
    s_cmp_eq_u32 s33, 3
    s_cselect_b32 s46, s44, s47
    s_cselect_b32 s50, s60, s48
    s_cselect_b32 s51, s48, s49
    s_sub_u32 s60, s33, 2
    s_cmp_lt_u32 s60, 2
    s_cbranch_scc0 K2_rare_14
K2_back_15:
    v_mfma_f32_32x32x16_bf16 v[32:47], v[72:75], v[188:191], v[32:47]
    v_add_u32 v233, s48, v230
    ds_read_b32 v232, v233
    ds_read_b32 v233, v233 offset:1024
    v_mul_f32 v234, v0, v96
    v_mul_f32 v236, v8, v128
    v_fmac_f32 v234, v1, v97
    v_fmac_f32 v236, v9, v129
    v_mfma_f32_32x32x16_bf16 v[48:63], v[76:79], v[188:191], v[48:63]
    s_setprio 0
    v_fmac_f32 v234, v2, v98
    v_fmac_f32 v236, v10, v130
    v_fmac_f32 v234, v3, v99
    v_fmac_f32 v236, v11, v131
    v_fmac_f32 v234, v4, v100
    v_fmac_f32 v236, v12, v132
    v_fmac_f32 v234, v5, v101
    v_fmac_f32 v236, v13, v133
    v_fmac_f32 v234, v6, v102
    v_fmac_f32 v236, v14, v134
    v_fmac_f32 v234, v7, v103
    v_fmac_f32 v236, v15, v135
    v_mul_f32 v238, v16, v128
    v_mul_f32 v240, v24, v128
    v_fmac_f32 v238, v17, v129
    v_fmac_f32 v240, v25, v129
    v_fmac_f32 v238, v18, v130
    v_fmac_f32 v240, v26, v130
    v_fmac_f32 v238, v19, v131
    v_fmac_f32 v240, v27, v131
    v_fmac_f32 v238, v20, v132
    v_fmac_f32 v240, v28, v132
    v_fmac_f32 v238, v21, v133
    v_fmac_f32 v240, v29, v133
    v_fmac_f32 v238, v22, v134
    v_fmac_f32 v240, v30, v134
    v_fmac_f32 v238, v23, v135
    v_fmac_f32 v240, v31, v135
    v_mul_f32 v235, v32, v104
    v_mul_f32 v237, v40, v136
    v_fmac_f32 v235, v33, v105
    v_fmac_f32 v237, v41, v137
    v_fmac_f32 v235, v34, v106
    v_fmac_f32 v237, v42, v138
    v_fmac_f32 v235, v35, v107
    v_fmac_f32 v237, v43, v139
    v_fmac_f32 v235, v36, v108
    v_fmac_f32 v237, v44, v140
    v_fmac_f32 v235, v37, v109
    v_fmac_f32 v237, v45, v141
    v_fmac_f32 v235, v38, v110
    v_fmac_f32 v237, v46, v142
    v_fmac_f32 v235, v39, v111
    v_fmac_f32 v237, v47, v143
    v_mul_f32 v239, v48, v136
    v_mul_f32 v241, v56, v136
    v_fmac_f32 v239, v49, v137
    v_fmac_f32 v241, v57, v137
    s_setprio 1
    s_waitcnt vmcnt(4) lgkmcnt(3)
    v_mfma_f32_32x32x16_bf16 v[0:15], v[64:67], v[176:179], 0
    ds_read_b64_tr_b16 v[184:185], v246 offset:6144
    ds_read_b64_tr_b16 v[186:187], v246 offset:6656
    ds_read_b64_tr_b16 v[188:189], v247 offset:6144
    ds_read_b64_tr_b16 v[190:191], v247 offset:6656
    v_fmac_f32 v239, v50, v138
    v_fmac_f32 v241, v58, v138
    s_mov_b32 m0, s70
    v_mfma_f32_32x32x16_bf16 v[16:31], v[68:71], v[176:179], 0
    buffer_load_dwordx4 v222, s[4:7], s43 offen sc1 lds
    buffer_load_dwordx4 v223, s[72:75], s43 offen offset:1024 sc1 lds
    v_fmac_f32 v239, v51, v139
    v_fmac_f32 v241, v59, v139
    v_fmac_f32 v239, v52, v140
    v_fmac_f32 v241, v60, v140
    v_fmac_f32 v239, v53, v141
    v_mfma_f32_32x32x16_bf16 v[32:47], v[64:67], v[180:183], 0
    v_add_u32 v222, s48, v251
    ds_read_b32 v222, v222
    v_fmac_f32 v241, v61, v141
    v_fmac_f32 v239, v54, v142
    v_fmac_f32 v241, v62, v142
    v_fmac_f32 v239, v55, v143
    v_fmac_f32 v241, v63, v143
    v_mfma_f32_32x32x16_bf16 v[48:63], v[68:71], v[180:183], 0
    v_permlane32_swap_b32 v234, v236
    v_permlane32_swap_b32 v235, v237
    v_permlane32_swap_b32 v240, v238
    s_waitcnt lgkmcnt(5)
    v_or_b32 v232, v232, v231
    v_or_b32 v233, v233, v231
    s_cmp_lg_u32 s34, 0
    s_cbranch_scc1 K2_dum_17
    s_add_u32 m0, s48, 480
    s_add_u32 s65, s48, 1504
    buffer_load_dwordx4 v232, s[16:19], 0 offen  lds
    s_mov_b32 m0, s65
    s_mov_b32 exec_hi, 0
    buffer_load_dwordx4 v233, s[16:19], 0 offen  lds
    s_cmp_eq_u32 s33, 4
    s_cbranch_scc1 K2_a4_18
K2_b4_20:
    s_mov_b32 exec_hi, -1
K2_back_19:
    s_waitcnt vmcnt(6) lgkmcnt(1)
    v_mfma_f32_32x32x16_bf16 v[0:15], v[72:75], v[184:187], v[0:15]
    ds_read_b64_tr_b16 v[176:177], v246 offset:0
    ds_read_b64_tr_b16 v[178:179], v246 offset:512
    ds_read_b64_tr_b16 v[180:181], v247 offset:0
    ds_read_b64_tr_b16 v[182:183], v247 offset:512
    v_permlane32_swap_b32 v241, v239
    s_mov_b32 m0, s71
    v_mfma_f32_32x32x16_bf16 v[16:31], v[76:79], v[184:187], v[16:31]
    buffer_load_dwordx4 v224, s[4:7], s43 offen sc1 lds
    buffer_load_dwordx4 v225, s[72:75], s43 offen offset:1024 sc1 lds
    s_waitcnt lgkmcnt(4)
    v_mad_u32_u16 v223, v222, s39, v248 op_sel:[1,0,0,0]
    v_mad_u32_u16 v222, v222, s39, v248
    v_add_f32 v234, v234, v236
    v_add_f32 v235, v235, v237
    v_add_f32 v240, v240, v238
    v_add_f32 v241, v241, v239
    s_set_gpr_idx_on s31, gpr_idx(DST)
    s_nop 0
    v_cvt_pk_bf16_f32 v192, v234, v235
    v_cvt_pk_bf16_f32 v193, v240, v241
    s_set_gpr_idx_off
    v_mfma_f32_32x32x16_bf16 v[32:47], v[72:75], v[188:191], v[32:47]
    v_add_u32 v224, s49, v251
    ds_read_b32 v224, v224
    v_mul_f32 v234, v0, v144
    v_mul_f32 v236, v8, v112
    v_fmac_f32 v234, v1, v145
    v_fmac_f32 v236, v9, v113
    v_fmac_f32 v234, v2, v146
    v_mfma_f32_32x32x16_bf16 v[48:63], v[76:79], v[188:191], v[48:63]
    s_setprio 0
    v_fmac_f32 v236, v10, v114
    v_fmac_f32 v234, v3, v147
    v_fmac_f32 v236, v11, v115
    v_fmac_f32 v234, v4, v148
    v_fmac_f32 v236, v12, v116
    v_fmac_f32 v234, v5, v149
    v_fmac_f32 v236, v13, v117
    v_fmac_f32 v234, v6, v150
    v_fmac_f32 v236, v14, v118
    v_fmac_f32 v234, v7, v151
    v_fmac_f32 v236, v15, v119
    v_mul_f32 v238, v16, v160
    v_mul_f32 v240, v24, v160
    v_fmac_f32 v238, v17, v161
    v_fmac_f32 v240, v25, v161
    v_fmac_f32 v238, v18, v162
    v_fmac_f32 v240, v26, v162
    v_fmac_f32 v238, v19, v163
    v_fmac_f32 v240, v27, v163
    v_fmac_f32 v238, v20, v164
    v_fmac_f32 v240, v28, v164
    v_fmac_f32 v238, v21, v165
    v_fmac_f32 v240, v29, v165
    v_fmac_f32 v238, v22, v166
    v_fmac_f32 v240, v30, v166
    v_fmac_f32 v238, v23, v167
    v_fmac_f32 v240, v31, v167
    v_mul_f32 v235, v32, v152
    v_mul_f32 v237, v40, v120
    v_fmac_f32 v235, v33, v153
    v_fmac_f32 v237, v41, v121
    v_fmac_f32 v235, v34, v154
    v_fmac_f32 v237, v42, v122
    v_fmac_f32 v235, v35, v155
    v_fmac_f32 v237, v43, v123
    v_fmac_f32 v235, v36, v156
    v_fmac_f32 v237, v44, v124
    v_fmac_f32 v235, v37, v157
    v_fmac_f32 v237, v45, v125
    v_fmac_f32 v235, v38, v158
    v_fmac_f32 v237, v46, v126
    v_fmac_f32 v235, v39, v159
    v_fmac_f32 v237, v47, v127
    v_mul_f32 v239, v48, v168
    v_mul_f32 v241, v56, v168
    v_fmac_f32 v239, v49, v169
    v_fmac_f32 v241, v57, v169
    v_fmac_f32 v239, v50, v170
    v_fmac_f32 v241, v58, v170
    v_fmac_f32 v239, v51, v171
    s_setprio 1
    s_waitcnt vmcnt(6) lgkmcnt(1)
    v_mfma_f32_32x32x16_bf16 v[0:15], v[64:67], v[176:179], 0
    ds_read_b64_tr_b16 v[184:185], v246 offset:2048
    ds_read_b64_tr_b16 v[186:187], v246 offset:2560
    ds_read_b64_tr_b16 v[188:189], v247 offset:2048
    ds_read_b64_tr_b16 v[190:191], v247 offset:2560
    v_fmac_f32 v241, v59, v171
    v_fmac_f32 v239, v52, v172
    s_mov_b32 m0, s68
    v_mfma_f32_32x32x16_bf16 v[16:31], v[68:71], v[176:179], 0
    buffer_load_dwordx4 v222, s[4:7], s44 offen sc1 lds
    buffer_load_dwordx4 v223, s[72:75], s44 offen offset:1024 sc1 lds
    s_waitcnt lgkmcnt(4)
    v_mad_u32_u16 v225, v224, s39, v248 op_sel:[1,0,0,0]
    v_mad_u32_u16 v224, v224, s39, v248
    v_fmac_f32 v241, v60, v172
    v_fmac_f32 v239, v53, v173
    v_mfma_f32_32x32x16_bf16 v[32:47], v[64:67], v[180:183], 0
    v_add_u32 v226, s50, v251
    ds_read_b32 v226, v226
    v_fmac_f32 v241, v61, v173
    v_fmac_f32 v239, v54, v174
    v_fmac_f32 v241, v62, v174
    v_fmac_f32 v239, v55, v175
    v_fmac_f32 v241, v63, v175
    v_mfma_f32_32x32x16_bf16 v[48:63], v[68:71], v[180:183], 0
    s_waitcnt vmcnt(6) lgkmcnt(1)
    v_mfma_f32_32x32x16_bf16 v[0:15], v[72:75], v[184:187], v[0:15]
    ds_read_b64_tr_b16 v[176:177], v246 offset:4096
    ds_read_b64_tr_b16 v[178:179], v246 offset:4608
    ds_read_b64_tr_b16 v[180:181], v247 offset:4096
    ds_read_b64_tr_b16 v[182:183], v247 offset:4608
    s_mov_b32 m0, s69
    v_mfma_f32_32x32x16_bf16 v[16:31], v[76:79], v[184:187], v[16:31]
    buffer_load_dwordx4 v224, s[4:7], s45 offen sc1 lds
    buffer_load_dwordx4 v225, s[72:75], s45 offen offset:1024 sc1 lds
    s_waitcnt lgkmcnt(4)
    v_mad_u32_u16 v227, v226, s39, v248 op_sel:[1,0,0,0]
    v_mad_u32_u16 v226, v226, s39, v248
    v_mfma_f32_32x32x16_bf16 v[32:47], v[72:75], v[188:191], v[32:47]
    v_add_u32 v228, s51, v251
    ds_read_b32 v228, v228
    v_mul_f32 v242, v0, v144
    v_fma_f32 v238, v8, v160, -v238
    v_fmac_f32 v242, v1, v145
    v_fmac_f32 v238, v9, v161
    v_fmac_f32 v242, v2, v146
    v_mfma_f32_32x32x16_bf16 v[48:63], v[76:79], v[188:191], v[48:63]
    s_setprio 0
    v_fmac_f32 v238, v10, v162
    v_fmac_f32 v242, v3, v147
    v_fmac_f32 v238, v11, v163
    v_fmac_f32 v242, v4, v148
    v_fmac_f32 v238, v12, v164
    v_fmac_f32 v242, v5, v149
    v_fmac_f32 v238, v13, v165
    v_fmac_f32 v242, v6, v150
    v_fmac_f32 v238, v14, v166
    v_fmac_f32 v242, v7, v151
    v_fmac_f32 v238, v15, v167
    v_fmac_f32 v236, v16, v112
    v_mul_f32 v244, v24, v160
    v_fmac_f32 v236, v17, v113
    v_fmac_f32 v244, v25, v161
    v_fmac_f32 v236, v18, v114
    v_fmac_f32 v244, v26, v162
    v_fmac_f32 v236, v19, v115
    v_fmac_f32 v244, v27, v163
    v_fmac_f32 v236, v20, v116
    v_fmac_f32 v244, v28, v164
    v_fmac_f32 v236, v21, v117
    v_fmac_f32 v244, v29, v165
    v_fmac_f32 v236, v22, v118
    v_fmac_f32 v244, v30, v166
    v_fmac_f32 v236, v23, v119
    v_fmac_f32 v244, v31, v167
    v_mul_f32 v243, v32, v152
    v_fma_f32 v239, v40, v168, -v239
    v_fmac_f32 v243, v33, v153
    v_fmac_f32 v239, v41, v169
    v_fmac_f32 v243, v34, v154
    v_fmac_f32 v239, v42, v170
    v_fmac_f32 v243, v35, v155
    v_fmac_f32 v239, v43, v171
    v_fmac_f32 v243, v36, v156
    v_fmac_f32 v239, v44, v172
    v_fmac_f32 v243, v37, v157
    v_fmac_f32 v239, v45, v173
    v_fmac_f32 v243, v38, v158
    v_fmac_f32 v239, v46, v174
    v_fmac_f32 v243, v39, v159
    v_fmac_f32 v239, v47, v175
    v_fmac_f32 v237, v48, v120
    v_mul_f32 v245, v56, v168
    v_fmac_f32 v237, v49, v121
    v_fmac_f32 v245, v57, v169
    v_fmac_f32 v237, v50, v122
    s_setprio 1
    s_waitcnt vmcnt(4) lgkmcnt(1)
    v_mfma_f32_32x32x16_bf16 v[0:15], v[64:67], v[176:179], 0
    ds_read_b64_tr_b16 v[184:185], v246 offset:6144
    ds_read_b64_tr_b16 v[186:187], v246 offset:6656
    ds_read_b64_tr_b16 v[188:189], v247 offset:6144
    ds_read_b64_tr_b16 v[190:191], v247 offset:6656
    v_fmac_f32 v245, v58, v170
    v_fmac_f32 v237, v51, v123
    s_mov_b32 m0, s70
    v_mfma_f32_32x32x16_bf16 v[16:31], v[68:71], v[176:179], 0
    buffer_load_dwordx4 v226, s[4:7], s46 offen sc1 lds
    buffer_load_dwordx4 v227, s[72:75], s46 offen offset:1024 sc1 lds
    s_waitcnt lgkmcnt(4)
    v_mad_u32_u16 v229, v228, s39, v248 op_sel:[1,0,0,0]
    v_mad_u32_u16 v228, v228, s39, v248
    v_fmac_f32 v245, v59, v171
    v_fmac_f32 v237, v52, v124
    v_mfma_f32_32x32x16_bf16 v[32:47], v[64:67], v[180:183], 0
    v_fmac_f32 v245, v60, v172
    v_fmac_f32 v237, v53, v125
    v_fmac_f32 v245, v61, v173
    v_fmac_f32 v237, v54, v126
    v_fmac_f32 v245, v62, v174
    v_fmac_f32 v237, v55, v127
    v_fmac_f32 v245, v63, v175
    v_mfma_f32_32x32x16_bf16 v[48:63], v[68:71], v[180:183], 0
    v_permlane32_swap_b32 v242, v234
    v_permlane32_swap_b32 v243, v235
    v_add_f32 v242, v242, v234
    v_add_f32 v243, v243, v235
    s_waitcnt vmcnt(4) lgkmcnt(0)
    v_mfma_f32_32x32x16_bf16 v[0:15], v[72:75], v[184:187], v[0:15]
    ds_read_b64_tr_b16 v[176:177], v246 offset:0
    ds_read_b64_tr_b16 v[178:179], v246 offset:512
    ds_read_b64_tr_b16 v[180:181], v247 offset:0
    ds_read_b64_tr_b16 v[182:183], v247 offset:512
    s_sub_u32 s26, s48, s29
    s_mov_b32 s29, s48
    s_mov_b32 m0, s71
    v_mfma_f32_32x32x16_bf16 v[16:31], v[76:79], v[184:187], v[16:31]
    buffer_load_dwordx4 v228, s[4:7], s47 offen sc1 lds
    buffer_load_dwordx4 v229, s[72:75], s47 offen offset:1024 sc1 lds
    s_set_gpr_idx_on s31, gpr_idx(DST)
    s_nop 0
    v_cvt_pk_bf16_f32 v194, v242, v243
    s_set_gpr_idx_off
    s_mov_b32 s30, s3
    s_cmp_eq_u32 s34, 0
    s_cselect_b32 s56, s33, 0
    v_mfma_f32_32x32x16_bf16 v[32:47], v[72:75], v[188:191], v[32:47]
    s_mov_b32 s32, s31
    s_mov_b32 s31, s35
    v_mul_f32 v242, v0, v144
    v_fma_f32 v240, v8, v160, -v240
    v_fmac_f32 v242, v1, v145
    v_fmac_f32 v240, v9, v161
    v_fmac_f32 v242, v2, v146
    v_mfma_f32_32x32x16_bf16 v[48:63], v[76:79], v[188:191], v[48:63]
    s_setprio 0
    v_fmac_f32 v240, v10, v162
    v_fmac_f32 v242, v3, v147
    v_fmac_f32 v240, v11, v163
    v_fmac_f32 v242, v4, v148
    v_fmac_f32 v240, v12, v164
    v_fmac_f32 v242, v5, v149
    v_fmac_f32 v240, v13, v165
    v_fmac_f32 v242, v6, v150
    v_fmac_f32 v240, v14, v166
    v_fmac_f32 v242, v7, v151
    v_fmac_f32 v240, v15, v167
    v_add_u32 v249, s26, v249
    v_add_u32 v250, s26, v250
    v_fma_f32 v244, v16, v160, -v244
    v_fmac_f32 v236, v24, v112
    v_fmac_f32 v244, v17, v161
    v_fmac_f32 v236, v25, v113
    v_fmac_f32 v244, v18, v162
    v_fmac_f32 v236, v26, v114
    v_fmac_f32 v244, v19, v163
    v_fmac_f32 v236, v27, v115
    v_fmac_f32 v244, v20, v164
    v_fmac_f32 v236, v28, v116
    v_fmac_f32 v244, v21, v165
    v_fmac_f32 v236, v29, v117
    v_fmac_f32 v244, v22, v166
    v_fmac_f32 v236, v30, v118
    v_fmac_f32 v244, v23, v167
    v_fmac_f32 v236, v31, v119
    ds_read_b64_tr_b16 v[0:1], v249 offset:0
    ds_read_b64_tr_b16 v[2:3], v249 offset:256
    ds_read_u16_d16_hi v16, v250 offset:0
    v_mul_f32 v243, v32, v152
    v_fma_f32 v241, v40, v168, -v241
    v_fmac_f32 v243, v33, v153
    v_fmac_f32 v241, v41, v169
    v_fmac_f32 v243, v34, v154
    v_fmac_f32 v241, v42, v170
    v_fmac_f32 v243, v35, v155
    v_fmac_f32 v241, v43, v171
    v_fmac_f32 v243, v36, v156
    v_fmac_f32 v241, v44, v172
    v_fmac_f32 v243, v37, v157
    v_fmac_f32 v241, v45, v173
    v_fmac_f32 v243, v38, v158
    v_fmac_f32 v241, v46, v174
    v_fmac_f32 v243, v39, v159
    v_fmac_f32 v241, v47, v175
    ds_read_b64_tr_b16 v[4:5], v249 offset:512
    ds_read_b64_tr_b16 v[6:7], v249 offset:768
    ds_read_u16_d16_hi v17, v250 offset:32
    v_fma_f32 v245, v48, v168, -v245
    v_fmac_f32 v237, v56, v120
    v_fmac_f32 v245, v49, v169
    v_fmac_f32 v237, v57, v121
    v_fmac_f32 v245, v50, v170
    v_fmac_f32 v237, v58, v122
    v_fmac_f32 v245, v51, v171
    v_fmac_f32 v237, v59, v123
    v_fmac_f32 v245, v52, v172
    v_fmac_f32 v237, v60, v124
    v_fmac_f32 v245, v53, v173
    v_fmac_f32 v237, v61, v125
    v_fmac_f32 v245, v54, v174
    v_fmac_f32 v237, v62, v126
    v_fmac_f32 v245, v55, v175
    v_fmac_f32 v237, v63, v127
    s_cmp_eq_u32 s56, 2
    s_cbranch_scc1 K2_U20
    s_cmp_eq_u32 s56, 3
    s_cbranch_scc1 K2_U30
    s_branch K2_DSP0
K2_PAD_U30:
    s_branch K2_HOP
K2_U30:
    s_setprio 1
    ds_read_b64_tr_b16 v[8:9], v249 offset:1024
    ds_read_b64_tr_b16 v[10:11], v249 offset:1280
    ds_read_u16_d16_hi v18, v250 offset:64
    s_waitcnt lgkmcnt(3)
    v_lshlrev_b32 v20, 16, v0
    v_and_b32 v21, 0xffff0000, v0
    v_lshlrev_b32 v22, 16, v1
    v_and_b32 v23, 0xffff0000, v1
    v_lshlrev_b32 v24, 16, v2
    v_and_b32 v25, 0xffff0000, v2
    v_lshlrev_b32 v26, 16, v3
    v_and_b32 v27, 0xffff0000, v3
    v_mul_f32_dpp v36, v16, v20 row_newbcast:0 row_mask:0xf bank_mask:0xf
    v_mul_f32_dpp v37, v16, v21 row_newbcast:1 row_mask:0xf bank_mask:0xf
    v_mul_f32_dpp v38, v16, v22 row_newbcast:2 row_mask:0xf bank_mask:0xf
    v_mul_f32_dpp v39, v16, v23 row_newbcast:3 row_mask:0xf bank_mask:0xf
    v_mul_f32_dpp v40, v16, v24 row_newbcast:4 row_mask:0xf bank_mask:0xf
    v_mul_f32_dpp v41, v16, v25 row_newbcast:5 row_mask:0xf bank_mask:0xf
    v_mul_f32_dpp v42, v16, v26 row_newbcast:6 row_mask:0xf bank_mask:0xf
    v_mul_f32_dpp v43, v16, v27 row_newbcast:7 row_mask:0xf bank_mask:0xf
    v_cvt_pk_bf16_f32 v64, v36, v37
    v_cvt_pk_bf16_f32 v65, v38, v39
    v_cvt_pk_bf16_f32 v66, v40, v41
    v_cvt_pk_bf16_f32 v67, v42, v43
    v_mul_f32_dpp v44, v16, v20 row_newbcast:8 row_mask:0xf bank_mask:0xf
    v_mul_f32_dpp v45, v16, v21 row_newbcast:9 row_mask:0xf bank_mask:0xf
    v_mul_f32_dpp v46, v16, v22 row_newbcast:10 row_mask:0xf bank_mask:0xf
    v_mul_f32_dpp v47, v16, v23 row_newbcast:11 row_mask:0xf bank_mask:0xf
    v_mul_f32_dpp v48, v16, v24 row_newbcast:12 row_mask:0xf bank_mask:0xf
    v_mul_f32_dpp v49, v16, v25 row_newbcast:13 row_mask:0xf bank_mask:0xf
    v_mul_f32_dpp v50, v16, v26 row_newbcast:14 row_mask:0xf bank_mask:0xf
    v_mul_f32_dpp v51, v16, v27 row_newbcast:15 row_mask:0xf bank_mask:0xf
    v_cvt_pk_bf16_f32 v68, v44, v45
    v_cvt_pk_bf16_f32 v69, v46, v47
    v_cvt_pk_bf16_f32 v70, v48, v49
    v_cvt_pk_bf16_f32 v71, v50, v51
    v_lshlrev_b32 v28, 16, v4
    v_and_b32 v29, 0xffff0000, v4
    v_lshlrev_b32 v30, 16, v5
    v_and_b32 v31, 0xffff0000, v5
    v_lshlrev_b32 v32, 16, v6
    v_and_b32 v33, 0xffff0000, v6
    v_lshlrev_b32 v34, 16, v7
    v_and_b32 v35, 0xffff0000, v7
    v_mul_f32_dpp v36, v17, v28 row_newbcast:0 row_mask:0xf bank_mask:0xf
    v_mul_f32_dpp v37, v17, v29 row_newbcast:1 row_mask:0xf bank_mask:0xf
    v_mul_f32_dpp v38, v17, v30 row_newbcast:2 row_mask:0xf bank_mask:0xf
    v_mul_f32_dpp v39, v17, v31 row_newbcast:3 row_mask:0xf bank_mask:0xf
    v_mul_f32_dpp v40, v17, v32 row_newbcast:4 row_mask:0xf bank_mask:0xf
    v_mul_f32_dpp v41, v17, v33 row_newbcast:5 row_mask:0xf bank_mask:0xf
    v_mul_f32_dpp v42, v17, v34 row_newbcast:6 row_mask:0xf bank_mask:0xf
    v_mul_f32_dpp v43, v17, v35 row_newbcast:7 row_mask:0xf bank_mask:0xf
    v_cvt_pk_bf16_f32 v72, v36, v37
    v_cvt_pk_bf16_f32 v73, v38, v39
    v_cvt_pk_bf16_f32 v74, v40, v41
    v_cvt_pk_bf16_f32 v75, v42, v43
    v_mul_f32_dpp v44, v17, v28 row_newbcast:8 row_mask:0xf bank_mask:0xf
    v_mul_f32_dpp v45, v17, v29 row_newbcast:9 row_mask:0xf bank_mask:0xf
    v_mul_f32_dpp v46, v17, v30 row_newbcast:10 row_mask:0xf bank_mask:0xf
    v_mul_f32_dpp v47, v17, v31 row_newbcast:11 row_mask:0xf bank_mask:0xf
    v_mul_f32_dpp v48, v17, v32 row_newbcast:12 row_mask:0xf bank_mask:0xf
    v_mul_f32_dpp v49, v17, v33 row_newbcast:13 row_mask:0xf bank_mask:0xf
    v_mul_f32_dpp v50, v17, v34 row_newbcast:14 row_mask:0xf bank_mask:0xf
    v_mul_f32_dpp v51, v17, v35 row_newbcast:15 row_mask:0xf bank_mask:0xf
    v_cvt_pk_bf16_f32 v76, v44, v45
    v_cvt_pk_bf16_f32 v77, v46, v47
    v_cvt_pk_bf16_f32 v78, v48, v49
    v_cvt_pk_bf16_f32 v79, v50, v51
    s_waitcnt lgkmcnt(0)
    v_lshlrev_b32 v20, 16, v8
    v_and_b32 v21, 0xffff0000, v8
    v_lshlrev_b32 v22, 16, v9
    v_and_b32 v23, 0xffff0000, v9
    v_lshlrev_b32 v24, 16, v10
    v_and_b32 v25, 0xffff0000, v10
    v_lshlrev_b32 v26, 16, v11
    v_and_b32 v27, 0xffff0000, v11
    v_mul_f32_dpp v36, v18, v20 row_newbcast:0 row_mask:0xf bank_mask:0xf
    v_mul_f32_dpp v37, v18, v21 row_newbcast:1 row_mask:0xf bank_mask:0xf
    v_mul_f32_dpp v38, v18, v22 row_newbcast:2 row_mask:0xf bank_mask:0xf
    v_mul_f32_dpp v39, v18, v23 row_newbcast:3 row_mask:0xf bank_mask:0xf
    v_mul_f32_dpp v40, v18, v24 row_newbcast:4 row_mask:0xf bank_mask:0xf
    v_mul_f32_dpp v41, v18, v25 row_newbcast:5 row_mask:0xf bank_mask:0xf
    v_mul_f32_dpp v42, v18, v26 row_newbcast:6 row_mask:0xf bank_mask:0xf
    v_mul_f32_dpp v43, v18, v27 row_newbcast:7 row_mask:0xf bank_mask:0xf
    v_cvt_pk_bf16_f32 v80, v36, v37
    v_cvt_pk_bf16_f32 v81, v38, v39
    v_cvt_pk_bf16_f32 v82, v40, v41
    v_cvt_pk_bf16_f32 v83, v42, v43
    v_mul_f32_dpp v44, v18, v20 row_newbcast:8 row_mask:0xf bank_mask:0xf
    v_mul_f32_dpp v45, v18, v21 row_newbcast:9 row_mask:0xf bank_mask:0xf
    v_mul_f32_dpp v46, v18, v22 row_newbcast:10 row_mask:0xf bank_mask:0xf
    v_mul_f32_dpp v47, v18, v23 row_newbcast:11 row_mask:0xf bank_mask:0xf
    v_mul_f32_dpp v48, v18, v24 row_newbcast:12 row_mask:0xf bank_mask:0xf
    v_mul_f32_dpp v49, v18, v25 row_newbcast:13 row_mask:0xf bank_mask:0xf
    v_mul_f32_dpp v50, v18, v26 row_newbcast:14 row_mask:0xf bank_mask:0xf
    v_mul_f32_dpp v51, v18, v27 row_newbcast:15 row_mask:0xf bank_mask:0xf
    v_cvt_pk_bf16_f32 v84, v44, v45
    v_cvt_pk_bf16_f32 v85, v46, v47
    v_cvt_pk_bf16_f32 v86, v48, v49
    v_cvt_pk_bf16_f32 v87, v50, v51
    s_waitcnt vmcnt(4)
    v_mfma_f32_32x32x16_bf16 v[0:15], v[64:67], v[176:179], 0
    ds_read_b64_tr_b16 v[184:185], v246 offset:2048
    ds_read_b64_tr_b16 v[186:187], v246 offset:2560
    ds_read_b64_tr_b16 v[188:189], v247 offset:2048
    ds_read_b64_tr_b16 v[190:191], v247 offset:2560
    s_mov_b32 m0, s68
    v_mfma_f32_32x32x16_bf16 v[16:31], v[68:71], v[176:179], 0
    buffer_load_dwordx4 v224, s[4:7], s41 offen sc1 lds
    buffer_load_dwordx4 v225, s[72:75], s41 offen offset:1024 sc1 lds
    v_permlane32_swap_b32 v242, v236
    v_permlane32_swap_b32 v243, v237
    s_add_u32 s38, s38, 1
    v_mfma_f32_32x32x16_bf16 v[32:47], v[64:67], v[180:183], 0
    v_permlane32_swap_b32 v244, v238
    v_permlane32_swap_b32 v245, v239
    v_permlane32_swap_b32 v240, v241
    v_add_f32 v242, v242, v236
    v_mfma_f32_32x32x16_bf16 v[48:63], v[68:71], v[180:183], 0
    v_add_f32 v243, v243, v237
    v_add_f32 v244, v244, v238
    v_add_f32 v245, v245, v239
    v_add_f32 v240, -v240, -v241
    v_mov_b32 v254, s52
    v_mov_b32 v255, s38
    s_waitcnt vmcnt(4) lgkmcnt(0)
    v_mfma_f32_32x32x16_bf16 v[0:15], v[72:75], v[184:187], v[0:15]
    ds_read_b64_tr_b16 v[176:177], v246 offset:4096
    ds_read_b64_tr_b16 v[178:179], v246 offset:4608
    ds_read_b64_tr_b16 v[180:181], v247 offset:4096
    ds_read_b64_tr_b16 v[182:183], v247 offset:4608
    s_lshl_b32 s58, s38, 3
    s_add_u32 s58, s58, s20
    s_mov_b32 m0, s69
    v_mfma_f32_32x32x16_bf16 v[16:31], v[76:79], v[184:187], v[16:31]
    buffer_load_dwordx4 v226, s[4:7], s41 offen sc1 lds
    buffer_load_dwordx4 v227, s[72:75], s41 offen offset:1024 sc1 lds
    s_set_gpr_idx_on s32, gpr_idx(DST)
    s_nop 0
    v_cvt_pk_bf16_f32 v195, v242, v243
    v_cvt_pk_bf16_f32 v196, v244, v245
    v_cvt_pk_bf16_f32 v197, v240, v240
    s_set_gpr_idx_off
    s_mov_b64 exec, 1
    ds_write_b32 v254, v255
    s_mov_b64 exec, -1
    s_cmp_lt_u32 s58, s22
    s_cbranch_scc0 K2_dyn_21
K2_back_22:
    v_readlane_b32 s3, v253, s58
    s_lshl_b32 s44, s34, 7
    s_and_b32 s48, s3, 0x3ffff
    s_bfe_u32 s33, s3, 0x30012
    s_mul_i32 s35, s38, 6
    s_cmp_eq_u32 s34, 0
    s_cselect_b32 s35, s35, s48
    s_mov_b32 s45, s44
    s_add_u32 s47, s44, 256
    s_add_u32 s49, s48, 32
    s_add_u32 s60, s48, 64
    s_cmp_eq_u32 s33, 3
    s_cselect_b32 s46, s44, s47
    s_cselect_b32 s50, s60, s48
    s_cselect_b32 s51, s48, s49
    s_sub_u32 s60, s33, 2
    s_cmp_lt_u32 s60, 2
    s_cbranch_scc0 K2_rare_27
K2_back_28:
    v_mfma_f32_32x32x16_bf16 v[32:47], v[72:75], v[188:191], v[32:47]
    v_add_u32 v233, s48, v230
    ds_read_b32 v232, v233
    ds_read_b32 v233, v233 offset:1024
    v_mfma_f32_32x32x16_bf16 v[48:63], v[76:79], v[188:191], v[48:63]
    s_waitcnt vmcnt(4) lgkmcnt(3)
    v_mfma_f32_32x32x16_bf16 v[0:15], v[80:83], v[176:179], v[0:15]
    ds_read_b64_tr_b16 v[184:185], v246 offset:6144
    ds_read_b64_tr_b16 v[186:187], v246 offset:6656
    ds_read_b64_tr_b16 v[188:189], v247 offset:6144
    ds_read_b64_tr_b16 v[190:191], v247 offset:6656
    s_mov_b32 m0, s70
    v_mfma_f32_32x32x16_bf16 v[16:31], v[84:87], v[176:179], v[16:31]
    buffer_load_dwordx4 v222, s[4:7], s42 offen sc1 lds
    buffer_load_dwordx4 v223, s[72:75], s42 offen offset:1024 sc1 lds
    v_mfma_f32_32x32x16_bf16 v[32:47], v[80:83], v[180:183], v[32:47]
    s_nop 2
    v_mul_f32 v234, v0, v96
    v_mul_f32 v236, v8, v128
    v_fmac_f32 v234, v1, v97
    v_fmac_f32 v236, v9, v129
    v_fmac_f32 v234, v2, v98
    v_fmac_f32 v236, v10, v130
    v_fmac_f32 v234, v3, v99
    v_mfma_f32_32x32x16_bf16 v[48:63], v[84:87], v[180:183], v[48:63]
    s_setprio 0
    s_waitcnt lgkmcnt(4)
    v_or_b32 v232, v232, v231
    v_or_b32 v233, v233, v231
    s_cmp_lg_u32 s34, 0
    s_cbranch_scc1 K2_dum_30
    s_add_u32 m0, s48, 480
    s_add_u32 s65, s48, 1504
    buffer_load_dwordx4 v232, s[16:19], 0 offen  lds
    s_mov_b32 m0, s65
    s_mov_b32 exec_hi, 0
    buffer_load_dwordx4 v233, s[16:19], 0 offen  lds
    s_cmp_eq_u32 s33, 4
    s_cbranch_scc1 K2_a4_31
K2_b4_33:
    s_mov_b32 exec_hi, -1
K2_back_32:
    v_fmac_f32 v236, v11, v131
    v_fmac_f32 v234, v4, v100
    v_fmac_f32 v236, v12, v132
    v_fmac_f32 v234, v5, v101
    v_fmac_f32 v236, v13, v133
    v_fmac_f32 v234, v6, v102
    v_fmac_f32 v236, v14, v134
    v_fmac_f32 v234, v7, v103
    v_fmac_f32 v236, v15, v135
    v_mul_f32 v238, v16, v128
    v_mul_f32 v240, v24, v128
    v_fmac_f32 v238, v17, v129
    v_fmac_f32 v240, v25, v129
    v_fmac_f32 v238, v18, v130
    v_fmac_f32 v240, v26, v130
    v_fmac_f32 v238, v19, v131
    v_fmac_f32 v240, v27, v131
    v_fmac_f32 v238, v20, v132
    v_fmac_f32 v240, v28, v132
    v_fmac_f32 v238, v21, v133
    v_fmac_f32 v240, v29, v133
    v_fmac_f32 v238, v22, v134
    v_fmac_f32 v240, v30, v134
    v_fmac_f32 v238, v23, v135
    v_fmac_f32 v240, v31, v135
    v_mul_f32 v235, v32, v104
    v_mul_f32 v237, v40, v136
    v_fmac_f32 v235, v33, v105
    v_fmac_f32 v237, v41, v137
    v_fmac_f32 v235, v34, v106
    v_fmac_f32 v237, v42, v138
    v_fmac_f32 v235, v35, v107
    v_fmac_f32 v237, v43, v139
    v_fmac_f32 v235, v36, v108
    v_fmac_f32 v237, v44, v140
    v_fmac_f32 v235, v37, v109
    v_fmac_f32 v237, v45, v141
    v_fmac_f32 v235, v38, v110
    v_fmac_f32 v237, v46, v142
    v_fmac_f32 v235, v39, v111
    v_fmac_f32 v237, v47, v143
    v_mul_f32 v239, v48, v136
    v_mul_f32 v241, v56, v136
    s_setprio 1
    s_waitcnt vmcnt(6) lgkmcnt(0)
    v_mfma_f32_32x32x16_bf16 v[0:15], v[64:67], v[184:187], 0
    ds_read_b64_tr_b16 v[176:177], v246 offset:0
    ds_read_b64_tr_b16 v[178:179], v246 offset:512
    ds_read_b64_tr_b16 v[180:181], v247 offset:0
    ds_read_b64_tr_b16 v[182:183], v247 offset:512
    v_fmac_f32 v239, v49, v137
    v_fmac_f32 v241, v57, v137
    s_mov_b32 m0, s71
    v_mfma_f32_32x32x16_bf16 v[16:31], v[68:71], v[184:187], 0
    buffer_load_dwordx4 v224, s[4:7], s42 offen sc1 lds
    buffer_load_dwordx4 v225, s[72:75], s42 offen offset:1024 sc1 lds
    v_fmac_f32 v239, v50, v138
    v_fmac_f32 v241, v58, v138
    v_fmac_f32 v239, v51, v139
    v_fmac_f32 v241, v59, v139
    v_fmac_f32 v239, v52, v140
    v_mfma_f32_32x32x16_bf16 v[32:47], v[64:67], v[188:191], 0
    v_fmac_f32 v241, v60, v140
    v_fmac_f32 v239, v53, v141
    v_fmac_f32 v241, v61, v141
    v_fmac_f32 v239, v54, v142
    v_fmac_f32 v241, v62, v142
    v_fmac_f32 v239, v55, v143
    v_fmac_f32 v241, v63, v143
    v_mfma_f32_32x32x16_bf16 v[48:63], v[68:71], v[188:191], 0
    v_permlane32_swap_b32 v234, v236
    v_permlane32_swap_b32 v235, v237
    v_permlane32_swap_b32 v240, v238
    s_waitcnt vmcnt(6) lgkmcnt(0)
    v_mfma_f32_32x32x16_bf16 v[0:15], v[72:75], v[176:179], v[0:15]
    ds_read_b64_tr_b16 v[184:185], v246 offset:2048
    ds_read_b64_tr_b16 v[186:187], v246 offset:2560
    ds_read_b64_tr_b16 v[188:189], v247 offset:2048
    ds_read_b64_tr_b16 v[190:191], v247 offset:2560
    v_permlane32_swap_b32 v241, v239
    s_mov_b32 m0, s68
    v_mfma_f32_32x32x16_bf16 v[16:31], v[76:79], v[176:179], v[16:31]
    buffer_load_dwordx4 v226, s[4:7], s42 offen sc1 lds
    buffer_load_dwordx4 v227, s[72:75], s42 offen offset:1024 sc1 lds
    v_add_f32 v234, v234, v236
    v_add_f32 v235, v235, v237
    v_add_f32 v240, v240, v238
    v_add_f32 v241, v241, v239
    v_mfma_f32_32x32x16_bf16 v[32:47], v[72:75], v[180:183], v[32:47]
    s_set_gpr_idx_on s31, gpr_idx(DST)
    s_nop 0
    v_cvt_pk_bf16_f32 v192, v234, v235
    v_cvt_pk_bf16_f32 v193, v240, v241
    s_set_gpr_idx_off
    v_mfma_f32_32x32x16_bf16 v[48:63], v[76:79], v[180:183], v[48:63]
    s_waitcnt vmcnt(6) lgkmcnt(0)
    v_mfma_f32_32x32x16_bf16 v[0:15], v[80:83], v[184:187], v[0:15]
    ds_read_b64_tr_b16 v[176:177], v246 offset:4096
    ds_read_b64_tr_b16 v[178:179], v246 offset:4608
    ds_read_b64_tr_b16 v[180:181], v247 offset:4096
    ds_read_b64_tr_b16 v[182:183], v247 offset:4608
    s_mov_b32 m0, s69
    v_mfma_f32_32x32x16_bf16 v[16:31], v[84:87], v[184:187], v[16:31]
    buffer_load_dwordx4 v222, s[4:7], s43 offen sc1 lds
    buffer_load_dwordx4 v223, s[72:75], s43 offen offset:1024 sc1 lds
    v_mfma_f32_32x32x16_bf16 v[32:47], v[80:83], v[188:191], v[32:47]
    s_nop 2
    v_mul_f32 v234, v0, v144
    v_mul_f32 v236, v8, v112
    v_fmac_f32 v234, v1, v145
    v_fmac_f32 v236, v9, v113
    v_fmac_f32 v234, v2, v146
    v_fmac_f32 v236, v10, v114
    v_fmac_f32 v234, v3, v147
    v_mfma_f32_32x32x16_bf16 v[48:63], v[84:87], v[188:191], v[48:63]
    s_setprio 0
    v_fmac_f32 v236, v11, v115
    v_fmac_f32 v234, v4, v148
    v_fmac_f32 v236, v12, v116
    v_fmac_f32 v234, v5, v149
    v_fmac_f32 v236, v13, v117
    v_fmac_f32 v234, v6, v150
    v_fmac_f32 v236, v14, v118
    v_fmac_f32 v234, v7, v151
    v_fmac_f32 v236, v15, v119
    v_mul_f32 v238, v16, v160
    v_mul_f32 v240, v24, v160
    v_fmac_f32 v238, v17, v161
    v_fmac_f32 v240, v25, v161
    v_fmac_f32 v238, v18, v162
    v_fmac_f32 v240, v26, v162
    v_fmac_f32 v238, v19, v163
    v_fmac_f32 v240, v27, v163
    v_fmac_f32 v238, v20, v164
    v_fmac_f32 v240, v28, v164
    v_fmac_f32 v238, v21, v165
    v_fmac_f32 v240, v29, v165
    v_fmac_f32 v238, v22, v166
    v_fmac_f32 v240, v30, v166
    v_fmac_f32 v238, v23, v167
    v_fmac_f32 v240, v31, v167
    v_mul_f32 v235, v32, v152
    v_mul_f32 v237, v40, v120
    v_fmac_f32 v235, v33, v153
    v_fmac_f32 v237, v41, v121
    v_fmac_f32 v235, v34, v154
    v_fmac_f32 v237, v42, v122
    v_fmac_f32 v235, v35, v155
    v_fmac_f32 v237, v43, v123
    v_fmac_f32 v235, v36, v156
    v_fmac_f32 v237, v44, v124
    v_fmac_f32 v235, v37, v157
    v_fmac_f32 v237, v45, v125
    v_fmac_f32 v235, v38, v158
    v_fmac_f32 v237, v46, v126
    v_fmac_f32 v235, v39, v159
    v_fmac_f32 v237, v47, v127
    v_mul_f32 v239, v48, v168
    v_mul_f32 v241, v56, v168
    v_fmac_f32 v239, v49, v169
    v_fmac_f32 v241, v57, v169
    s_setprio 1
    s_waitcnt vmcnt(4) lgkmcnt(0)
    v_mfma_f32_32x32x16_bf16 v[0:15], v[64:67], v[176:179], 0
    ds_read_b64_tr_b16 v[184:185], v246 offset:6144
    ds_read_b64_tr_b16 v[186:187], v246 offset:6656
    ds_read_b64_tr_b16 v[188:189], v247 offset:6144
    ds_read_b64_tr_b16 v[190:191], v247 offset:6656
    v_fmac_f32 v239, v50, v170
    v_fmac_f32 v241, v58, v170
    s_mov_b32 m0, s70
    v_mfma_f32_32x32x16_bf16 v[16:31], v[68:71], v[176:179], 0
    buffer_load_dwordx4 v224, s[4:7], s43 offen sc1 lds
    buffer_load_dwordx4 v225, s[72:75], s43 offen offset:1024 sc1 lds
    v_fmac_f32 v239, v51, v171
    v_fmac_f32 v241, v59, v171
    v_fmac_f32 v239, v52, v172
    v_fmac_f32 v241, v60, v172
    v_fmac_f32 v239, v53, v173
    v_mfma_f32_32x32x16_bf16 v[32:47], v[64:67], v[180:183], 0
    v_add_u32 v222, s48, v251
    ds_read_b32 v222, v222
    v_fmac_f32 v241, v61, v173
    v_fmac_f32 v239, v54, v174
    v_fmac_f32 v241, v62, v174
    v_fmac_f32 v239, v55, v175
    v_fmac_f32 v241, v63, v175
    v_mfma_f32_32x32x16_bf16 v[48:63], v[68:71], v[180:183], 0
    s_waitcnt vmcnt(4) lgkmcnt(1)
    v_mfma_f32_32x32x16_bf16 v[0:15], v[72:75], v[184:187], v[0:15]
    ds_read_b64_tr_b16 v[176:177], v246 offset:0
    ds_read_b64_tr_b16 v[178:179], v246 offset:512
    ds_read_b64_tr_b16 v[180:181], v247 offset:0
    ds_read_b64_tr_b16 v[182:183], v247 offset:512
    s_mov_b32 m0, s71
    v_mfma_f32_32x32x16_bf16 v[16:31], v[76:79], v[184:187], v[16:31]
    buffer_load_dwordx4 v226, s[4:7], s43 offen sc1 lds
    buffer_load_dwordx4 v227, s[72:75], s43 offen offset:1024 sc1 lds
    s_waitcnt lgkmcnt(4)
    v_mad_u32_u16 v223, v222, s39, v248 op_sel:[1,0,0,0]
    v_mad_u32_u16 v222, v222, s39, v248
    v_mfma_f32_32x32x16_bf16 v[32:47], v[72:75], v[188:191], v[32:47]
    v_add_u32 v224, s49, v251
    ds_read_b32 v224, v224
    v_mfma_f32_32x32x16_bf16 v[48:63], v[76:79], v[188:191], v[48:63]
    s_waitcnt vmcnt(4) lgkmcnt(1)
    v_mfma_f32_32x32x16_bf16 v[0:15], v[80:83], v[176:179], v[0:15]
    ds_read_b64_tr_b16 v[184:185], v246 offset:2048
    ds_read_b64_tr_b16 v[186:187], v246 offset:2560
    ds_read_b64_tr_b16 v[188:189], v247 offset:2048
    ds_read_b64_tr_b16 v[190:191], v247 offset:2560
    s_mov_b32 m0, s68
    v_mfma_f32_32x32x16_bf16 v[16:31], v[84:87], v[176:179], v[16:31]
    buffer_load_dwordx4 v222, s[4:7], s44 offen sc1 lds
    buffer_load_dwordx4 v223, s[72:75], s44 offen offset:1024 sc1 lds
    s_waitcnt lgkmcnt(4)
    v_mad_u32_u16 v225, v224, s39, v248 op_sel:[1,0,0,0]
    v_mad_u32_u16 v224, v224, s39, v248
    v_mfma_f32_32x32x16_bf16 v[32:47], v[80:83], v[180:183], v[32:47]
    v_add_u32 v226, s50, v251
    ds_read_b32 v226, v226
    v_mul_f32 v242, v0, v144
    v_fma_f32 v238, v8, v160, -v238
    v_fmac_f32 v242, v1, v145
    v_fmac_f32 v238, v9, v161
    v_fmac_f32 v242, v2, v146
    v_mfma_f32_32x32x16_bf16 v[48:63], v[84:87], v[180:183], v[48:63]
    s_setprio 0
    v_fmac_f32 v238, v10, v162
    v_fmac_f32 v242, v3, v147
    v_fmac_f32 v238, v11, v163
    v_fmac_f32 v242, v4, v148
    v_fmac_f32 v238, v12, v164
    v_fmac_f32 v242, v5, v149
    v_fmac_f32 v238, v13, v165
    v_fmac_f32 v242, v6, v150
    v_fmac_f32 v238, v14, v166
    v_fmac_f32 v242, v7, v151
    v_fmac_f32 v238, v15, v167
    v_fmac_f32 v236, v16, v112
    v_mul_f32 v244, v24, v160
    v_fmac_f32 v236, v17, v113
    v_fmac_f32 v244, v25, v161
    v_fmac_f32 v236, v18, v114
    v_fmac_f32 v244, v26, v162
    v_fmac_f32 v236, v19, v115
    v_fmac_f32 v244, v27, v163
    v_fmac_f32 v236, v20, v116
    v_fmac_f32 v244, v28, v164
    v_fmac_f32 v236, v21, v117
    v_fmac_f32 v244, v29, v165
    v_fmac_f32 v236, v22, v118
    v_fmac_f32 v244, v30, v166
    v_fmac_f32 v236, v23, v119
    v_fmac_f32 v244, v31, v167
    v_mul_f32 v243, v32, v152
    v_fma_f32 v239, v40, v168, -v239
    v_fmac_f32 v243, v33, v153
    v_fmac_f32 v239, v41, v169
    v_fmac_f32 v243, v34, v154
    v_fmac_f32 v239, v42, v170
    v_fmac_f32 v243, v35, v155
    v_fmac_f32 v239, v43, v171
    v_fmac_f32 v243, v36, v156
    v_fmac_f32 v239, v44, v172
    v_fmac_f32 v243, v37, v157
    v_fmac_f32 v239, v45, v173
    v_fmac_f32 v243, v38, v158
    v_fmac_f32 v239, v46, v174
    v_fmac_f32 v243, v39, v159
    v_fmac_f32 v239, v47, v175
    v_fmac_f32 v237, v48, v120
    v_mul_f32 v245, v56, v168
    v_fmac_f32 v237, v49, v121
    v_fmac_f32 v245, v57, v169
    v_fmac_f32 v237, v50, v122
    v_fmac_f32 v245, v58, v170
    v_fmac_f32 v237, v51, v123
    s_setprio 1
    s_waitcnt vmcnt(4) lgkmcnt(1)
    v_mfma_f32_32x32x16_bf16 v[0:15], v[64:67], v[184:187], 0
    ds_read_b64_tr_b16 v[176:177], v246 offset:4096
    ds_read_b64_tr_b16 v[178:179], v246 offset:4608
    ds_read_b64_tr_b16 v[180:181], v247 offset:4096
    ds_read_b64_tr_b16 v[182:183], v247 offset:4608
    v_fmac_f32 v245, v59, v171
    v_fmac_f32 v237, v52, v124
    s_mov_b32 m0, s69
    v_mfma_f32_32x32x16_bf16 v[16:31], v[68:71], v[184:187], 0
    buffer_load_dwordx4 v224, s[4:7], s45 offen sc1 lds
    buffer_load_dwordx4 v225, s[72:75], s45 offen offset:1024 sc1 lds
    s_waitcnt lgkmcnt(4)
    v_mad_u32_u16 v227, v226, s39, v248 op_sel:[1,0,0,0]
    v_mad_u32_u16 v226, v226, s39, v248
    v_fmac_f32 v245, v60, v172
    v_fmac_f32 v237, v53, v125
    v_mfma_f32_32x32x16_bf16 v[32:47], v[64:67], v[188:191], 0
    v_add_u32 v228, s51, v251
    ds_read_b32 v228, v228
    v_fmac_f32 v245, v61, v173
    v_fmac_f32 v237, v54, v126
    v_fmac_f32 v245, v62, v174
    v_fmac_f32 v237, v55, v127
    v_fmac_f32 v245, v63, v175
    v_mfma_f32_32x32x16_bf16 v[48:63], v[68:71], v[188:191], 0
    v_permlane32_swap_b32 v242, v234
    v_permlane32_swap_b32 v243, v235
    v_add_f32 v242, v242, v234
    v_add_f32 v243, v243, v235
    s_waitcnt vmcnt(4) lgkmcnt(1)
    v_mfma_f32_32x32x16_bf16 v[0:15], v[72:75], v[176:179], v[0:15]
    ds_read_b64_tr_b16 v[184:185], v246 offset:6144
    ds_read_b64_tr_b16 v[186:187], v246 offset:6656
    ds_read_b64_tr_b16 v[188:189], v247 offset:6144
    ds_read_b64_tr_b16 v[190:191], v247 offset:6656
    s_mov_b32 m0, s70
    v_mfma_f32_32x32x16_bf16 v[16:31], v[76:79], v[176:179], v[16:31]
    buffer_load_dwordx4 v226, s[4:7], s46 offen sc1 lds
    buffer_load_dwordx4 v227, s[72:75], s46 offen offset:1024 sc1 lds
    s_waitcnt lgkmcnt(4)
    v_mad_u32_u16 v229, v228, s39, v248 op_sel:[1,0,0,0]
    v_mad_u32_u16 v228, v228, s39, v248
    s_sub_u32 s26, s48, s29
    s_mov_b32 s29, s48
    v_mfma_f32_32x32x16_bf16 v[32:47], v[72:75], v[180:183], v[32:47]
    s_set_gpr_idx_on s31, gpr_idx(DST)
    s_nop 0
    v_cvt_pk_bf16_f32 v194, v242, v243
    s_set_gpr_idx_off
    s_mov_b32 s30, s3
    s_cmp_eq_u32 s34, 0
    s_cselect_b32 s56, s33, 0
    s_mov_b32 s32, s31
    v_mfma_f32_32x32x16_bf16 v[48:63], v[76:79], v[180:183], v[48:63]
    s_mov_b32 s31, s35
    s_waitcnt vmcnt(4) lgkmcnt(0)
    v_mfma_f32_32x32x16_bf16 v[0:15], v[80:83], v[184:187], v[0:15]
    ds_read_b64_tr_b16 v[176:177], v246 offset:0
    ds_read_b64_tr_b16 v[178:179], v246 offset:512
    ds_read_b64_tr_b16 v[180:181], v247 offset:0
    ds_read_b64_tr_b16 v[182:183], v247 offset:512
    s_mov_b32 m0, s71
    v_mfma_f32_32x32x16_bf16 v[16:31], v[84:87], v[184:187], v[16:31]
    buffer_load_dwordx4 v228, s[4:7], s47 offen sc1 lds
    buffer_load_dwordx4 v229, s[72:75], s47 offen offset:1024 sc1 lds
    v_mfma_f32_32x32x16_bf16 v[32:47], v[80:83], v[188:191], v[32:47]
    s_nop 2
    v_mul_f32 v242, v0, v144
    v_fma_f32 v240, v8, v160, -v240
    v_fmac_f32 v242, v1, v145
    v_fmac_f32 v240, v9, v161
    v_fmac_f32 v242, v2, v146
    v_fmac_f32 v240, v10, v162
    v_fmac_f32 v242, v3, v147
    v_mfma_f32_32x32x16_bf16 v[48:63], v[84:87], v[188:191], v[48:63]
    s_setprio 0
    v_fmac_f32 v240, v11, v163
    v_fmac_f32 v242, v4, v148
    v_fmac_f32 v240, v12, v164
    v_fmac_f32 v242, v5, v149
    v_fmac_f32 v240, v13, v165
    v_fmac_f32 v242, v6, v150
    v_fmac_f32 v240, v14, v166
    v_fmac_f32 v242, v7, v151
    v_fmac_f32 v240, v15, v167
    v_add_u32 v249, s26, v249
    v_add_u32 v250, s26, v250
    v_fma_f32 v244, v16, v160, -v244
    v_fmac_f32 v236, v24, v112
    v_fmac_f32 v244, v17, v161
    v_fmac_f32 v236, v25, v113
    v_fmac_f32 v244, v18, v162
    v_fmac_f32 v236, v26, v114
    v_fmac_f32 v244, v19, v163
    v_fmac_f32 v236, v27, v115
    v_fmac_f32 v244, v20, v164
    v_fmac_f32 v236, v28, v116
    v_fmac_f32 v244, v21, v165
    v_fmac_f32 v236, v29, v117
    v_fmac_f32 v244, v22, v166
    v_fmac_f32 v236, v30, v118
    v_fmac_f32 v244, v23, v167
    v_fmac_f32 v236, v31, v119
    ds_read_b64_tr_b16 v[0:1], v249 offset:0
    ds_read_b64_tr_b16 v[2:3], v249 offset:256
    ds_read_u16_d16_hi v16, v250 offset:0
    v_mul_f32 v243, v32, v152
    v_fma_f32 v241, v40, v168, -v241
    v_fmac_f32 v243, v33, v153
    v_fmac_f32 v241, v41, v169
    v_fmac_f32 v243, v34, v154
    v_fmac_f32 v241, v42, v170
    v_fmac_f32 v243, v35, v155
    v_fmac_f32 v241, v43, v171
    v_fmac_f32 v243, v36, v156
    v_fmac_f32 v241, v44, v172
    v_fmac_f32 v243, v37, v157
    v_fmac_f32 v241, v45, v173
    v_fmac_f32 v243, v38, v158
    v_fmac_f32 v241, v46, v174
    v_fmac_f32 v243, v39, v159
    v_fmac_f32 v241, v47, v175
    ds_read_b64_tr_b16 v[4:5], v249 offset:512
    ds_read_b64_tr_b16 v[6:7], v249 offset:768
    ds_read_u16_d16_hi v17, v250 offset:32
    v_fma_f32 v245, v48, v168, -v245
    v_fmac_f32 v237, v56, v120
    v_fmac_f32 v245, v49, v169
    v_fmac_f32 v237, v57, v121
    v_fmac_f32 v245, v50, v170
    v_fmac_f32 v237, v58, v122
    v_fmac_f32 v245, v51, v171
    v_fmac_f32 v237, v59, v123
    v_fmac_f32 v245, v52, v172
    v_fmac_f32 v237, v60, v124
    v_fmac_f32 v245, v53, v173
    v_fmac_f32 v237, v61, v125
    v_fmac_f32 v245, v54, v174
    v_fmac_f32 v237, v62, v126
    v_fmac_f32 v245, v55, v175
    v_fmac_f32 v237, v63, v127
    s_cmp_eq_u32 s56, 2
    s_cbranch_scc1 K2_U20
    s_cmp_eq_u32 s56, 3
    s_cbranch_scc1 K2_U30
    s_branch K2_DSP0
K2_PAD_U21:
    s_branch K2_HOP
K2_U21:
    s_setprio 1
    s_waitcnt lgkmcnt(0)
    v_lshlrev_b32 v20, 16, v0
    v_and_b32 v21, 0xffff0000, v0
    v_lshlrev_b32 v22, 16, v1
    v_and_b32 v23, 0xffff0000, v1
    v_lshlrev_b32 v24, 16, v2
    v_and_b32 v25, 0xffff0000, v2
    v_lshlrev_b32 v26, 16, v3
    v_and_b32 v27, 0xffff0000, v3
    v_mul_f32_dpp v36, v16, v20 row_newbcast:0 row_mask:0xf bank_mask:0xf
    v_mul_f32_dpp v37, v16, v21 row_newbcast:1 row_mask:0xf bank_mask:0xf
    v_mul_f32_dpp v38, v16, v22 row_newbcast:2 row_mask:0xf bank_mask:0xf
    v_mul_f32_dpp v39, v16, v23 row_newbcast:3 row_mask:0xf bank_mask:0xf
    v_mul_f32_dpp v40, v16, v24 row_newbcast:4 row_mask:0xf bank_mask:0xf
    v_mul_f32_dpp v41, v16, v25 row_newbcast:5 row_mask:0xf bank_mask:0xf
    v_mul_f32_dpp v42, v16, v26 row_newbcast:6 row_mask:0xf bank_mask:0xf
    v_mul_f32_dpp v43, v16, v27 row_newbcast:7 row_mask:0xf bank_mask:0xf
    v_cvt_pk_bf16_f32 v64, v36, v37
    v_cvt_pk_bf16_f32 v65, v38, v39
    v_cvt_pk_bf16_f32 v66, v40, v41
    v_cvt_pk_bf16_f32 v67, v42, v43
    v_mul_f32_dpp v44, v16, v20 row_newbcast:8 row_mask:0xf bank_mask:0xf
    v_mul_f32_dpp v45, v16, v21 row_newbcast:9 row_mask:0xf bank_mask:0xf
    v_mul_f32_dpp v46, v16, v22 row_newbcast:10 row_mask:0xf bank_mask:0xf
    v_mul_f32_dpp v47, v16, v23 row_newbcast:11 row_mask:0xf bank_mask:0xf
    v_mul_f32_dpp v48, v16, v24 row_newbcast:12 row_mask:0xf bank_mask:0xf
    v_mul_f32_dpp v49, v16, v25 row_newbcast:13 row_mask:0xf bank_mask:0xf
    v_mul_f32_dpp v50, v16, v26 row_newbcast:14 row_mask:0xf bank_mask:0xf
    v_mul_f32_dpp v51, v16, v27 row_newbcast:15 row_mask:0xf bank_mask:0xf
    v_cvt_pk_bf16_f32 v68, v44, v45
    v_cvt_pk_bf16_f32 v69, v46, v47
    v_cvt_pk_bf16_f32 v70, v48, v49
    v_cvt_pk_bf16_f32 v71, v50, v51
    v_lshlrev_b32 v28, 16, v4
    v_and_b32 v29, 0xffff0000, v4
    v_lshlrev_b32 v30, 16, v5
    v_and_b32 v31, 0xffff0000, v5
    v_lshlrev_b32 v32, 16, v6
    v_and_b32 v33, 0xffff0000, v6
    v_lshlrev_b32 v34, 16, v7
    v_and_b32 v35, 0xffff0000, v7
    v_mul_f32_dpp v36, v17, v28 row_newbcast:0 row_mask:0xf bank_mask:0xf
    v_mul_f32_dpp v37, v17, v29 row_newbcast:1 row_mask:0xf bank_mask:0xf
    v_mul_f32_dpp v38, v17, v30 row_newbcast:2 row_mask:0xf bank_mask:0xf
    v_mul_f32_dpp v39, v17, v31 row_newbcast:3 row_mask:0xf bank_mask:0xf
    v_mul_f32_dpp v40, v17, v32 row_newbcast:4 row_mask:0xf bank_mask:0xf
    v_mul_f32_dpp v41, v17, v33 row_newbcast:5 row_mask:0xf bank_mask:0xf
    v_mul_f32_dpp v42, v17, v34 row_newbcast:6 row_mask:0xf bank_mask:0xf
    v_mul_f32_dpp v43, v17, v35 row_newbcast:7 row_mask:0xf bank_mask:0xf
    v_cvt_pk_bf16_f32 v72, v36, v37
    v_cvt_pk_bf16_f32 v73, v38, v39
    v_cvt_pk_bf16_f32 v74, v40, v41
    v_cvt_pk_bf16_f32 v75, v42, v43
    v_mul_f32_dpp v44, v17, v28 row_newbcast:8 row_mask:0xf bank_mask:0xf
    v_mul_f32_dpp v45, v17, v29 row_newbcast:9 row_mask:0xf bank_mask:0xf
    v_mul_f32_dpp v46, v17, v30 row_newbcast:10 row_mask:0xf bank_mask:0xf
    v_mul_f32_dpp v47, v17, v31 row_newbcast:11 row_mask:0xf bank_mask:0xf
    v_mul_f32_dpp v48, v17, v32 row_newbcast:12 row_mask:0xf bank_mask:0xf
    v_mul_f32_dpp v49, v17, v33 row_newbcast:13 row_mask:0xf bank_mask:0xf
    v_mul_f32_dpp v50, v17, v34 row_newbcast:14 row_mask:0xf bank_mask:0xf
    v_mul_f32_dpp v51, v17, v35 row_newbcast:15 row_mask:0xf bank_mask:0xf
    v_cvt_pk_bf16_f32 v76, v44, v45
    v_cvt_pk_bf16_f32 v77, v46, v47
    v_cvt_pk_bf16_f32 v78, v48, v49
    v_cvt_pk_bf16_f32 v79, v50, v51
    s_waitcnt vmcnt(4)
    v_mfma_f32_32x32x16_bf16 v[0:15], v[64:67], v[176:179], 0
    ds_read_b64_tr_b16 v[184:185], v246 offset:2048
    ds_read_b64_tr_b16 v[186:187], v246 offset:2560
    ds_read_b64_tr_b16 v[188:189], v247 offset:2048
    ds_read_b64_tr_b16 v[190:191], v247 offset:2560
    s_mov_b32 m0, s68
    v_mfma_f32_32x32x16_bf16 v[16:31], v[68:71], v[176:179], 0
    buffer_load_dwordx4 v222, s[4:7], s42 offen sc1 lds
    buffer_load_dwordx4 v223, s[72:75], s42 offen offset:1024 sc1 lds
    v_permlane32_swap_b32 v242, v236
    v_permlane32_swap_b32 v243, v237
    v_mov_b32 v254, 160704
    v_mfma_f32_32x32x16_bf16 v[32:47], v[64:67], v[180:183], 0
    v_permlane32_swap_b32 v244, v238
    v_permlane32_swap_b32 v245, v239
    v_permlane32_swap_b32 v240, v241
    v_add_f32 v242, v242, v236
    v_mfma_f32_32x32x16_bf16 v[48:63], v[68:71], v[180:183], 0
    v_add_f32 v243, v243, v237
    v_add_f32 v244, v244, v238
    v_add_f32 v245, v245, v239
    v_add_f32 v240, -v240, -v241
    v_sub_u32 v241, v230, v231
    v_cvt_pk_bf16_f32 v242, v242, v243
    v_mov_b32 v255, 1
    v_lshl_add_u32 v233, v252, 1, s53
    s_mov_b64 exec, 1
    ds_add_rtn_u32 v232, v254, v255
    s_mov_b64 exec, -1
    ds_read_b32 v233, v233
    s_waitcnt vmcnt(4) lgkmcnt(2)
    v_mfma_f32_32x32x16_bf16 v[0:15], v[72:75], v[184:187], v[0:15]
    ds_read_b64_tr_b16 v[176:177], v246 offset:4096
    ds_read_b64_tr_b16 v[178:179], v246 offset:4608
    ds_read_b64_tr_b16 v[180:181], v247 offset:4096
    ds_read_b64_tr_b16 v[182:183], v247 offset:4608
    v_cvt_pk_bf16_f32 v244, v244, v245
    v_cvt_pk_bf16_f32 v240, v240, v240
    s_mov_b32 m0, s69
    v_mfma_f32_32x32x16_bf16 v[16:31], v[76:79], v[184:187], v[16:31]
    buffer_load_dwordx4 v224, s[4:7], s42 offen sc1 lds
    buffer_load_dwordx4 v225, s[72:75], s42 offen offset:1024 sc1 lds
    ds_write_b32 v230, v242 offset:768
    ds_write_b32 v230, v244 offset:1024
    ds_write_b16 v241, v240 offset:1280
    s_waitcnt lgkmcnt(7)
    v_readfirstlane_b32 s58, v232
    v_mfma_f32_32x32x16_bf16 v[32:47], v[72:75], v[188:191], v[32:47]
    s_cmp_lt_u32 s58, s22
    s_cbranch_scc0 K2_nul_34
    s_and_b32 s59, s58, 7
    s_lshr_b32 s60, s58, 3
K2_chk_36:
    v_readlane_b32 s61, v233, s59
    s_nop 0
    s_cmp_gt_u32 s61, s60
    s_cbranch_scc0 K2_spin_35
K2_back_37:
    v_mfma_f32_32x32x16_bf16 v[48:63], v[76:79], v[188:191], v[48:63]
    s_setprio 0
    v_readlane_b32 s3, v253, s58
    s_lshl_b32 s44, s34, 7
    s_and_b32 s48, s3, 0x3ffff
    s_bfe_u32 s33, s3, 0x30012
    s_mov_b32 s35, s48
    s_mov_b32 s45, s44
    v_mul_f32 v234, v0, v96
    v_mul_f32 v236, v8, v128
    v_fmac_f32 v234, v1, v97
    v_fmac_f32 v236, v9, v129
    v_fmac_f32 v234, v2, v98
    v_fmac_f32 v236, v10, v130
    v_fmac_f32 v234, v3, v99
    v_fmac_f32 v236, v11, v131
    v_fmac_f32 v234, v4, v100
    v_fmac_f32 v236, v12, v132
    v_fmac_f32 v234, v5, v101
    v_fmac_f32 v236, v13, v133
    v_fmac_f32 v234, v6, v102
    v_fmac_f32 v236, v14, v134
    v_fmac_f32 v234, v7, v103
    v_fmac_f32 v236, v15, v135
    v_mul_f32 v238, v16, v128
    v_mul_f32 v240, v24, v128
    v_fmac_f32 v238, v17, v129
    v_fmac_f32 v240, v25, v129
    v_fmac_f32 v238, v18, v130
    v_fmac_f32 v240, v26, v130
    v_fmac_f32 v238, v19, v131
    v_fmac_f32 v240, v27, v131
    v_fmac_f32 v238, v20, v132
    v_fmac_f32 v240, v28, v132
    v_fmac_f32 v238, v21, v133
    v_fmac_f32 v240, v29, v133
    v_fmac_f32 v238, v22, v134
    v_fmac_f32 v240, v30, v134
    v_fmac_f32 v238, v23, v135
    v_fmac_f32 v240, v31, v135
    v_mul_f32 v235, v32, v104
    v_mul_f32 v237, v40, v136
    v_fmac_f32 v235, v33, v105
    v_fmac_f32 v237, v41, v137
    v_fmac_f32 v235, v34, v106
    v_fmac_f32 v237, v42, v138
    v_fmac_f32 v235, v35, v107
    v_fmac_f32 v237, v43, v139
    v_fmac_f32 v235, v36, v108
    v_fmac_f32 v237, v44, v140
    v_fmac_f32 v235, v37, v109
    v_fmac_f32 v237, v45, v141
    v_fmac_f32 v235, v38, v110
    v_fmac_f32 v237, v46, v142
    v_fmac_f32 v235, v39, v111
    v_fmac_f32 v237, v47, v143
    v_mul_f32 v239, v48, v136
    v_mul_f32 v241, v56, v136
    v_fmac_f32 v239, v49, v137
    v_fmac_f32 v241, v57, v137
    s_setprio 1
    s_waitcnt vmcnt(4) lgkmcnt(3)
    v_mfma_f32_32x32x16_bf16 v[0:15], v[64:67], v[176:179], 0
    ds_read_b64_tr_b16 v[184:185], v246 offset:6144
    ds_read_b64_tr_b16 v[186:187], v246 offset:6656
    ds_read_b64_tr_b16 v[188:189], v247 offset:6144
    ds_read_b64_tr_b16 v[190:191], v247 offset:6656
    v_fmac_f32 v239, v50, v138
    v_fmac_f32 v241, v58, v138
    s_mov_b32 m0, s70
    v_mfma_f32_32x32x16_bf16 v[16:31], v[68:71], v[176:179], 0
    buffer_load_dwordx4 v222, s[4:7], s43 offen sc1 lds
    buffer_load_dwordx4 v223, s[72:75], s43 offen offset:1024 sc1 lds
    v_fmac_f32 v239, v51, v139
    v_fmac_f32 v241, v59, v139
    v_fmac_f32 v239, v52, v140
    v_fmac_f32 v241, v60, v140
    v_fmac_f32 v239, v53, v141
    v_mfma_f32_32x32x16_bf16 v[32:47], v[64:67], v[180:183], 0
    s_add_u32 s47, s44, 256
    s_add_u32 s49, s48, 32
    s_add_u32 s60, s48, 64
    s_cmp_eq_u32 s33, 3
    s_cselect_b32 s46, s44, s47
    s_cselect_b32 s50, s60, s48
    s_cselect_b32 s51, s48, s49
    s_sub_u32 s60, s33, 2
    s_cmp_lt_u32 s60, 2
    s_cbranch_scc0 K2_rare_38
K2_back_39:
    v_add_u32 v222, s48, v251
    ds_read_b32 v222, v222
    v_fmac_f32 v241, v61, v141
    v_fmac_f32 v239, v54, v142
    v_fmac_f32 v241, v62, v142
    v_fmac_f32 v239, v55, v143
    v_fmac_f32 v241, v63, v143
    v_mfma_f32_32x32x16_bf16 v[48:63], v[68:71], v[180:183], 0
    v_permlane32_swap_b32 v234, v236
    v_permlane32_swap_b32 v235, v237
    v_permlane32_swap_b32 v240, v238
    s_waitcnt vmcnt(4) lgkmcnt(1)
    v_mfma_f32_32x32x16_bf16 v[0:15], v[72:75], v[184:187], v[0:15]
    ds_read_b64_tr_b16 v[176:177], v246 offset:0
    ds_read_b64_tr_b16 v[178:179], v246 offset:512
    ds_read_b64_tr_b16 v[180:181], v247 offset:0
    ds_read_b64_tr_b16 v[182:183], v247 offset:512
    v_permlane32_swap_b32 v241, v239
    s_mov_b32 m0, s71
    v_mfma_f32_32x32x16_bf16 v[16:31], v[76:79], v[184:187], v[16:31]
    buffer_load_dwordx4 v224, s[4:7], s43 offen sc1 lds
    buffer_load_dwordx4 v225, s[72:75], s43 offen offset:1024 sc1 lds
    s_waitcnt lgkmcnt(4)
    v_mad_u32_u16 v223, v222, s39, v248 op_sel:[1,0,0,0]
    v_mad_u32_u16 v222, v222, s39, v248
    v_lshl_add_u32 v230, v252, 1, s31
    v_add_f32 v234, v234, v236
    v_add_f32 v235, v235, v237
    v_add_f32 v240, v240, v238
    v_add_f32 v241, v241, v239
    v_cvt_pk_bf16_f32 v234, v234, v235
    v_cvt_pk_bf16_f32 v240, v240, v241
    ds_write_b32 v230, v234 offset:0
    ds_write_b32 v230, v240 offset:256
    v_mfma_f32_32x32x16_bf16 v[32:47], v[72:75], v[188:191], v[32:47]
    v_add_u32 v224, s49, v251
    ds_read_b32 v224, v224
    v_mul_f32 v234, v0, v144
    v_mul_f32 v236, v8, v112
    v_fmac_f32 v234, v1, v145
    v_fmac_f32 v236, v9, v113
    v_fmac_f32 v234, v2, v146
    v_mfma_f32_32x32x16_bf16 v[48:63], v[76:79], v[188:191], v[48:63]
    s_setprio 0
    v_fmac_f32 v236, v10, v114
    v_fmac_f32 v234, v3, v147
    v_fmac_f32 v236, v11, v115
    v_fmac_f32 v234, v4, v148
    v_fmac_f32 v236, v12, v116
    v_fmac_f32 v234, v5, v149
    v_fmac_f32 v236, v13, v117
    v_fmac_f32 v234, v6, v150
    v_fmac_f32 v236, v14, v118
    v_fmac_f32 v234, v7, v151
    v_fmac_f32 v236, v15, v119
    v_mul_f32 v238, v16, v160
    v_mul_f32 v240, v24, v160
    v_fmac_f32 v238, v17, v161
    v_fmac_f32 v240, v25, v161
    v_fmac_f32 v238, v18, v162
    v_fmac_f32 v240, v26, v162
    v_fmac_f32 v238, v19, v163
    v_fmac_f32 v240, v27, v163
    v_fmac_f32 v238, v20, v164
    v_fmac_f32 v240, v28, v164
    v_fmac_f32 v238, v21, v165
    v_fmac_f32 v240, v29, v165
    v_fmac_f32 v238, v22, v166
    v_fmac_f32 v240, v30, v166
    v_fmac_f32 v238, v23, v167
    v_fmac_f32 v240, v31, v167
    v_mul_f32 v235, v32, v152
    v_mul_f32 v237, v40, v120
    v_fmac_f32 v235, v33, v153
    v_fmac_f32 v237, v41, v121
    v_fmac_f32 v235, v34, v154
    v_fmac_f32 v237, v42, v122
    v_fmac_f32 v235, v35, v155
    v_fmac_f32 v237, v43, v123
    v_fmac_f32 v235, v36, v156
    v_fmac_f32 v237, v44, v124
    v_fmac_f32 v235, v37, v157
    v_fmac_f32 v237, v45, v125
    v_fmac_f32 v235, v38, v158
    v_fmac_f32 v237, v46, v126
    v_fmac_f32 v235, v39, v159
    v_fmac_f32 v237, v47, v127
    v_mul_f32 v239, v48, v168
    v_mul_f32 v241, v56, v168
    v_fmac_f32 v239, v49, v169
    v_fmac_f32 v241, v57, v169
    v_fmac_f32 v239, v50, v170
    v_fmac_f32 v241, v58, v170
    v_fmac_f32 v239, v51, v171
    s_setprio 1
    s_waitcnt vmcnt(4) lgkmcnt(3)
    v_mfma_f32_32x32x16_bf16 v[0:15], v[64:67], v[176:179], 0
    ds_read_b64_tr_b16 v[184:185], v246 offset:2048
    ds_read_b64_tr_b16 v[186:187], v246 offset:2560
    ds_read_b64_tr_b16 v[188:189], v247 offset:2048
    ds_read_b64_tr_b16 v[190:191], v247 offset:2560
    v_fmac_f32 v241, v59, v171
    v_fmac_f32 v239, v52, v172
    s_mov_b32 m0, s68
    v_mfma_f32_32x32x16_bf16 v[16:31], v[68:71], v[176:179], 0
    buffer_load_dwordx4 v222, s[4:7], s44 offen sc1 lds
    buffer_load_dwordx4 v223, s[72:75], s44 offen offset:1024 sc1 lds
    s_waitcnt lgkmcnt(4)
    v_mad_u32_u16 v225, v224, s39, v248 op_sel:[1,0,0,0]
    v_mad_u32_u16 v224, v224, s39, v248
    v_fmac_f32 v241, v60, v172
    v_fmac_f32 v239, v53, v173
    v_mfma_f32_32x32x16_bf16 v[32:47], v[64:67], v[180:183], 0
    v_add_u32 v226, s50, v251
    ds_read_b32 v226, v226
    v_fmac_f32 v241, v61, v173
    v_fmac_f32 v239, v54, v174
    v_fmac_f32 v241, v62, v174
    v_fmac_f32 v239, v55, v175
    v_fmac_f32 v241, v63, v175
    v_mfma_f32_32x32x16_bf16 v[48:63], v[68:71], v[180:183], 0
    s_waitcnt vmcnt(4) lgkmcnt(1)
    v_mfma_f32_32x32x16_bf16 v[0:15], v[72:75], v[184:187], v[0:15]
    ds_read_b64_tr_b16 v[176:177], v246 offset:4096
    ds_read_b64_tr_b16 v[178:179], v246 offset:4608
    ds_read_b64_tr_b16 v[180:181], v247 offset:4096
    ds_read_b64_tr_b16 v[182:183], v247 offset:4608
    s_mov_b32 m0, s69
    v_mfma_f32_32x32x16_bf16 v[16:31], v[76:79], v[184:187], v[16:31]
    buffer_load_dwordx4 v224, s[4:7], s45 offen sc1 lds
    buffer_load_dwordx4 v225, s[72:75], s45 offen offset:1024 sc1 lds
    s_waitcnt lgkmcnt(4)
    v_mad_u32_u16 v227, v226, s39, v248 op_sel:[1,0,0,0]
    v_mad_u32_u16 v226, v226, s39, v248
    v_mfma_f32_32x32x16_bf16 v[32:47], v[72:75], v[188:191], v[32:47]
    v_add_u32 v228, s51, v251
    ds_read_b32 v228, v228
    v_mul_f32 v242, v0, v144
    v_fma_f32 v238, v8, v160, -v238
    v_fmac_f32 v242, v1, v145
    v_fmac_f32 v238, v9, v161
    v_fmac_f32 v242, v2, v146
    v_mfma_f32_32x32x16_bf16 v[48:63], v[76:79], v[188:191], v[48:63]
    s_setprio 0
    v_fmac_f32 v238, v10, v162
    v_fmac_f32 v242, v3, v147
    v_fmac_f32 v238, v11, v163
    v_fmac_f32 v242, v4, v148
    v_fmac_f32 v238, v12, v164
    v_fmac_f32 v242, v5, v149
    v_fmac_f32 v238, v13, v165
    v_fmac_f32 v242, v6, v150
    v_fmac_f32 v238, v14, v166
    v_fmac_f32 v242, v7, v151
    v_fmac_f32 v238, v15, v167
    v_fmac_f32 v236, v16, v112
    v_mul_f32 v244, v24, v160
    v_fmac_f32 v236, v17, v113
    v_fmac_f32 v244, v25, v161
    v_fmac_f32 v236, v18, v114
    v_fmac_f32 v244, v26, v162
    v_fmac_f32 v236, v19, v115
    v_fmac_f32 v244, v27, v163
    v_fmac_f32 v236, v20, v116
    v_fmac_f32 v244, v28, v164
    v_fmac_f32 v236, v21, v117
    v_fmac_f32 v244, v29, v165
    v_fmac_f32 v236, v22, v118
    v_fmac_f32 v244, v30, v166
    v_fmac_f32 v236, v23, v119
    v_fmac_f32 v244, v31, v167
    v_mul_f32 v243, v32, v152
    v_fma_f32 v239, v40, v168, -v239
    v_fmac_f32 v243, v33, v153
    v_fmac_f32 v239, v41, v169
    v_fmac_f32 v243, v34, v154
    v_fmac_f32 v239, v42, v170
    v_fmac_f32 v243, v35, v155
    v_fmac_f32 v239, v43, v171
    v_fmac_f32 v243, v36, v156
    v_fmac_f32 v239, v44, v172
    v_fmac_f32 v243, v37, v157
    v_fmac_f32 v239, v45, v173
    v_fmac_f32 v243, v38, v158
    v_fmac_f32 v239, v46, v174
    v_fmac_f32 v243, v39, v159
    v_fmac_f32 v239, v47, v175
    v_fmac_f32 v237, v48, v120
    v_mul_f32 v245, v56, v168
    v_fmac_f32 v237, v49, v121
    v_fmac_f32 v245, v57, v169
    v_fmac_f32 v237, v50, v122
    s_setprio 1
    s_waitcnt vmcnt(4) lgkmcnt(1)
    v_mfma_f32_32x32x16_bf16 v[0:15], v[64:67], v[176:179], 0
    ds_read_b64_tr_b16 v[184:185], v246 offset:6144
    ds_read_b64_tr_b16 v[186:187], v246 offset:6656
    ds_read_b64_tr_b16 v[188:189], v247 offset:6144
    ds_read_b64_tr_b16 v[190:191], v247 offset:6656
    v_fmac_f32 v245, v58, v170
    v_fmac_f32 v237, v51, v123
    s_mov_b32 m0, s70
    v_mfma_f32_32x32x16_bf16 v[16:31], v[68:71], v[176:179], 0
    buffer_load_dwordx4 v226, s[4:7], s46 offen sc1 lds
    buffer_load_dwordx4 v227, s[72:75], s46 offen offset:1024 sc1 lds
    s_waitcnt lgkmcnt(4)
    v_mad_u32_u16 v229, v228, s39, v248 op_sel:[1,0,0,0]
    v_mad_u32_u16 v228, v228, s39, v248
    v_fmac_f32 v245, v59, v171
    v_fmac_f32 v237, v52, v124
    v_mfma_f32_32x32x16_bf16 v[32:47], v[64:67], v[180:183], 0
    v_fmac_f32 v245, v60, v172
    v_fmac_f32 v237, v53, v125
    v_fmac_f32 v245, v61, v173
    v_fmac_f32 v237, v54, v126
    v_fmac_f32 v245, v62, v174
    v_fmac_f32 v237, v55, v127
    v_fmac_f32 v245, v63, v175
    v_mfma_f32_32x32x16_bf16 v[48:63], v[68:71], v[180:183], 0
    v_permlane32_swap_b32 v242, v234
    v_permlane32_swap_b32 v243, v235
    v_add_f32 v242, v242, v234
    v_add_f32 v243, v243, v235
    s_waitcnt vmcnt(4) lgkmcnt(0)
    v_mfma_f32_32x32x16_bf16 v[0:15], v[72:75], v[184:187], v[0:15]
    ds_read_b64_tr_b16 v[176:177], v246 offset:0
    ds_read_b64_tr_b16 v[178:179], v246 offset:512
    ds_read_b64_tr_b16 v[180:181], v247 offset:0
    ds_read_b64_tr_b16 v[182:183], v247 offset:512
    v_cvt_pk_bf16_f32 v242, v242, v243
    ds_write_b32 v230, v242 offset:512
    s_mov_b32 m0, s71
    v_mfma_f32_32x32x16_bf16 v[16:31], v[76:79], v[184:187], v[16:31]
    buffer_load_dwordx4 v228, s[4:7], s47 offen sc1 lds
    buffer_load_dwordx4 v229, s[72:75], s47 offen offset:1024 sc1 lds
    s_sub_u32 s26, s48, s29
    s_mov_b32 s29, s48
    s_mov_b32 s30, s3
    s_cmp_lg_u32 s36, 0
    s_cselect_b32 s56, s33, 0
    v_mfma_f32_32x32x16_bf16 v[32:47], v[72:75], v[188:191], v[32:47]
    s_mov_b32 s32, s31
    s_mov_b32 s31, s35
    v_mul_f32 v242, v0, v144
    v_fma_f32 v240, v8, v160, -v240
    v_fmac_f32 v242, v1, v145
    v_fmac_f32 v240, v9, v161
    v_fmac_f32 v242, v2, v146
    v_mfma_f32_32x32x16_bf16 v[48:63], v[76:79], v[188:191], v[48:63]
    s_setprio 0
    v_fmac_f32 v240, v10, v162
    v_fmac_f32 v242, v3, v147
    v_fmac_f32 v240, v11, v163
    v_fmac_f32 v242, v4, v148
    v_fmac_f32 v240, v12, v164
    v_fmac_f32 v242, v5, v149
    v_fmac_f32 v240, v13, v165
    v_fmac_f32 v242, v6, v150
    v_fmac_f32 v240, v14, v166
    v_fmac_f32 v242, v7, v151
    v_fmac_f32 v240, v15, v167
    v_add_u32 v249, s26, v249
    v_add_u32 v250, s26, v250
    v_fma_f32 v244, v16, v160, -v244
    v_fmac_f32 v236, v24, v112
    v_fmac_f32 v244, v17, v161
    v_fmac_f32 v236, v25, v113
    v_fmac_f32 v244, v18, v162
    v_fmac_f32 v236, v26, v114
    v_fmac_f32 v244, v19, v163
    v_fmac_f32 v236, v27, v115
    v_fmac_f32 v244, v20, v164
    v_fmac_f32 v236, v28, v116
    v_fmac_f32 v244, v21, v165
    v_fmac_f32 v236, v29, v117
    v_fmac_f32 v244, v22, v166
    v_fmac_f32 v236, v30, v118
    v_fmac_f32 v244, v23, v167
    v_fmac_f32 v236, v31, v119
    ds_read_b64_tr_b16 v[0:1], v249 offset:0
    ds_read_b64_tr_b16 v[2:3], v249 offset:256
    ds_read_u16_d16_hi v16, v250 offset:0
    v_mul_f32 v243, v32, v152
    v_fma_f32 v241, v40, v168, -v241
    v_fmac_f32 v243, v33, v153
    v_fmac_f32 v241, v41, v169
    v_fmac_f32 v243, v34, v154
    v_fmac_f32 v241, v42, v170
    v_fmac_f32 v243, v35, v155
    v_fmac_f32 v241, v43, v171
    v_fmac_f32 v243, v36, v156
    v_fmac_f32 v241, v44, v172
    v_fmac_f32 v243, v37, v157
    v_fmac_f32 v241, v45, v173
    v_fmac_f32 v243, v38, v158
    v_fmac_f32 v241, v46, v174
    v_fmac_f32 v243, v39, v159
    v_fmac_f32 v241, v47, v175
    ds_read_b64_tr_b16 v[4:5], v249 offset:512
    ds_read_b64_tr_b16 v[6:7], v249 offset:768
    ds_read_u16_d16_hi v17, v250 offset:32
    v_fma_f32 v245, v48, v168, -v245
    v_fmac_f32 v237, v56, v120
    v_fmac_f32 v245, v49, v169
    v_fmac_f32 v237, v57, v121
    v_fmac_f32 v245, v50, v170
    v_fmac_f32 v237, v58, v122
    v_fmac_f32 v245, v51, v171
    v_fmac_f32 v237, v59, v123
    v_fmac_f32 v245, v52, v172
    v_fmac_f32 v237, v60, v124
    v_fmac_f32 v245, v53, v173
    v_fmac_f32 v237, v61, v125
    v_fmac_f32 v245, v54, v174
    v_fmac_f32 v237, v62, v126
    v_fmac_f32 v245, v55, v175
    v_fmac_f32 v237, v63, v127
    s_cmp_eq_u32 s56, 2
    s_cbranch_scc1 K2_U21
    s_cmp_eq_u32 s56, 3
    s_cbranch_scc1 K2_U31
    s_branch K2_DSP1
K2_PAD_U31:
    s_branch K2_HOP
K2_U31:
    s_setprio 1
    ds_read_b64_tr_b16 v[8:9], v249 offset:1024
    ds_read_b64_tr_b16 v[10:11], v249 offset:1280
    ds_read_u16_d16_hi v18, v250 offset:64
    s_waitcnt lgkmcnt(3)
    v_lshlrev_b32 v20, 16, v0
    v_and_b32 v21, 0xffff0000, v0
    v_lshlrev_b32 v22, 16, v1
    v_and_b32 v23, 0xffff0000, v1
    v_lshlrev_b32 v24, 16, v2
    v_and_b32 v25, 0xffff0000, v2
    v_lshlrev_b32 v26, 16, v3
    v_and_b32 v27, 0xffff0000, v3
    v_mul_f32_dpp v36, v16, v20 row_newbcast:0 row_mask:0xf bank_mask:0xf
    v_mul_f32_dpp v37, v16, v21 row_newbcast:1 row_mask:0xf bank_mask:0xf
    v_mul_f32_dpp v38, v16, v22 row_newbcast:2 row_mask:0xf bank_mask:0xf
    v_mul_f32_dpp v39, v16, v23 row_newbcast:3 row_mask:0xf bank_mask:0xf
    v_mul_f32_dpp v40, v16, v24 row_newbcast:4 row_mask:0xf bank_mask:0xf
    v_mul_f32_dpp v41, v16, v25 row_newbcast:5 row_mask:0xf bank_mask:0xf
    v_mul_f32_dpp v42, v16, v26 row_newbcast:6 row_mask:0xf bank_mask:0xf
    v_mul_f32_dpp v43, v16, v27 row_newbcast:7 row_mask:0xf bank_mask:0xf
    v_cvt_pk_bf16_f32 v64, v36, v37
    v_cvt_pk_bf16_f32 v65, v38, v39
    v_cvt_pk_bf16_f32 v66, v40, v41
    v_cvt_pk_bf16_f32 v67, v42, v43
    v_mul_f32_dpp v44, v16, v20 row_newbcast:8 row_mask:0xf bank_mask:0xf
    v_mul_f32_dpp v45, v16, v21 row_newbcast:9 row_mask:0xf bank_mask:0xf
    v_mul_f32_dpp v46, v16, v22 row_newbcast:10 row_mask:0xf bank_mask:0xf
    v_mul_f32_dpp v47, v16, v23 row_newbcast:11 row_mask:0xf bank_mask:0xf
    v_mul_f32_dpp v48, v16, v24 row_newbcast:12 row_mask:0xf bank_mask:0xf
    v_mul_f32_dpp v49, v16, v25 row_newbcast:13 row_mask:0xf bank_mask:0xf
    v_mul_f32_dpp v50, v16, v26 row_newbcast:14 row_mask:0xf bank_mask:0xf
    v_mul_f32_dpp v51, v16, v27 row_newbcast:15 row_mask:0xf bank_mask:0xf
    v_cvt_pk_bf16_f32 v68, v44, v45
    v_cvt_pk_bf16_f32 v69, v46, v47
    v_cvt_pk_bf16_f32 v70, v48, v49
    v_cvt_pk_bf16_f32 v71, v50, v51
    v_lshlrev_b32 v28, 16, v4
    v_and_b32 v29, 0xffff0000, v4
    v_lshlrev_b32 v30, 16, v5
    v_and_b32 v31, 0xffff0000, v5
    v_lshlrev_b32 v32, 16, v6
    v_and_b32 v33, 0xffff0000, v6
    v_lshlrev_b32 v34, 16, v7
    v_and_b32 v35, 0xffff0000, v7
    v_mul_f32_dpp v36, v17, v28 row_newbcast:0 row_mask:0xf bank_mask:0xf
    v_mul_f32_dpp v37, v17, v29 row_newbcast:1 row_mask:0xf bank_mask:0xf
    v_mul_f32_dpp v38, v17, v30 row_newbcast:2 row_mask:0xf bank_mask:0xf
    v_mul_f32_dpp v39, v17, v31 row_newbcast:3 row_mask:0xf bank_mask:0xf
    v_mul_f32_dpp v40, v17, v32 row_newbcast:4 row_mask:0xf bank_mask:0xf
    v_mul_f32_dpp v41, v17, v33 row_newbcast:5 row_mask:0xf bank_mask:0xf
    v_mul_f32_dpp v42, v17, v34 row_newbcast:6 row_mask:0xf bank_mask:0xf
    v_mul_f32_dpp v43, v17, v35 row_newbcast:7 row_mask:0xf bank_mask:0xf
    v_cvt_pk_bf16_f32 v72, v36, v37
    v_cvt_pk_bf16_f32 v73, v38, v39
    v_cvt_pk_bf16_f32 v74, v40, v41
    v_cvt_pk_bf16_f32 v75, v42, v43
    v_mul_f32_dpp v44, v17, v28 row_newbcast:8 row_mask:0xf bank_mask:0xf
    v_mul_f32_dpp v45, v17, v29 row_newbcast:9 row_mask:0xf bank_mask:0xf
    v_mul_f32_dpp v46, v17, v30 row_newbcast:10 row_mask:0xf bank_mask:0xf
    v_mul_f32_dpp v47, v17, v31 row_newbcast:11 row_mask:0xf bank_mask:0xf
    v_mul_f32_dpp v48, v17, v32 row_newbcast:12 row_mask:0xf bank_mask:0xf
    v_mul_f32_dpp v49, v17, v33 row_newbcast:13 row_mask:0xf bank_mask:0xf
    v_mul_f32_dpp v50, v17, v34 row_newbcast:14 row_mask:0xf bank_mask:0xf
    v_mul_f32_dpp v51, v17, v35 row_newbcast:15 row_mask:0xf bank_mask:0xf
    v_cvt_pk_bf16_f32 v76, v44, v45
    v_cvt_pk_bf16_f32 v77, v46, v47
    v_cvt_pk_bf16_f32 v78, v48, v49
    v_cvt_pk_bf16_f32 v79, v50, v51
    s_waitcnt lgkmcnt(0)
    v_lshlrev_b32 v20, 16, v8
    v_and_b32 v21, 0xffff0000, v8
    v_lshlrev_b32 v22, 16, v9
    v_and_b32 v23, 0xffff0000, v9
    v_lshlrev_b32 v24, 16, v10
    v_and_b32 v25, 0xffff0000, v10
    v_lshlrev_b32 v26, 16, v11
    v_and_b32 v27, 0xffff0000, v11
    v_mul_f32_dpp v36, v18, v20 row_newbcast:0 row_mask:0xf bank_mask:0xf
    v_mul_f32_dpp v37, v18, v21 row_newbcast:1 row_mask:0xf bank_mask:0xf
    v_mul_f32_dpp v38, v18, v22 row_newbcast:2 row_mask:0xf bank_mask:0xf
    v_mul_f32_dpp v39, v18, v23 row_newbcast:3 row_mask:0xf bank_mask:0xf
    v_mul_f32_dpp v40, v18, v24 row_newbcast:4 row_mask:0xf bank_mask:0xf
    v_mul_f32_dpp v41, v18, v25 row_newbcast:5 row_mask:0xf bank_mask:0xf
    v_mul_f32_dpp v42, v18, v26 row_newbcast:6 row_mask:0xf bank_mask:0xf
    v_mul_f32_dpp v43, v18, v27 row_newbcast:7 row_mask:0xf bank_mask:0xf
    v_cvt_pk_bf16_f32 v80, v36, v37
    v_cvt_pk_bf16_f32 v81, v38, v39
    v_cvt_pk_bf16_f32 v82, v40, v41
    v_cvt_pk_bf16_f32 v83, v42, v43
    v_mul_f32_dpp v44, v18, v20 row_newbcast:8 row_mask:0xf bank_mask:0xf
    v_mul_f32_dpp v45, v18, v21 row_newbcast:9 row_mask:0xf bank_mask:0xf
    v_mul_f32_dpp v46, v18, v22 row_newbcast:10 row_mask:0xf bank_mask:0xf
    v_mul_f32_dpp v47, v18, v23 row_newbcast:11 row_mask:0xf bank_mask:0xf
    v_mul_f32_dpp v48, v18, v24 row_newbcast:12 row_mask:0xf bank_mask:0xf
    v_mul_f32_dpp v49, v18, v25 row_newbcast:13 row_mask:0xf bank_mask:0xf
    v_mul_f32_dpp v50, v18, v26 row_newbcast:14 row_mask:0xf bank_mask:0xf
    v_mul_f32_dpp v51, v18, v27 row_newbcast:15 row_mask:0xf bank_mask:0xf
    v_cvt_pk_bf16_f32 v84, v44, v45
    v_cvt_pk_bf16_f32 v85, v46, v47
    v_cvt_pk_bf16_f32 v86, v48, v49
    v_cvt_pk_bf16_f32 v87, v50, v51
    s_waitcnt vmcnt(4)
    v_mfma_f32_32x32x16_bf16 v[0:15], v[64:67], v[176:179], 0
    ds_read_b64_tr_b16 v[184:185], v246 offset:2048
    ds_read_b64_tr_b16 v[186:187], v246 offset:2560
    ds_read_b64_tr_b16 v[188:189], v247 offset:2048
    ds_read_b64_tr_b16 v[190:191], v247 offset:2560
    s_mov_b32 m0, s68
    v_mfma_f32_32x32x16_bf16 v[16:31], v[68:71], v[176:179], 0
    buffer_load_dwordx4 v224, s[4:7], s41 offen sc1 lds
    buffer_load_dwordx4 v225, s[72:75], s41 offen offset:1024 sc1 lds
    v_permlane32_swap_b32 v242, v236
    v_permlane32_swap_b32 v243, v237
    v_mov_b32 v254, 160704
    v_mfma_f32_32x32x16_bf16 v[32:47], v[64:67], v[180:183], 0
    v_permlane32_swap_b32 v244, v238
    v_permlane32_swap_b32 v245, v239
    v_permlane32_swap_b32 v240, v241
    v_add_f32 v242, v242, v236
    v_mfma_f32_32x32x16_bf16 v[48:63], v[68:71], v[180:183], 0
    v_add_f32 v243, v243, v237
    v_add_f32 v244, v244, v238
    v_add_f32 v245, v245, v239
    v_add_f32 v240, -v240, -v241
    v_sub_u32 v241, v230, v231
    v_cvt_pk_bf16_f32 v242, v242, v243
    v_mov_b32 v255, 1
    v_lshl_add_u32 v233, v252, 1, s53
    s_mov_b64 exec, 1
    ds_add_rtn_u32 v232, v254, v255
    s_mov_b64 exec, -1
    ds_read_b32 v233, v233
    s_waitcnt vmcnt(4) lgkmcnt(2)
    v_mfma_f32_32x32x16_bf16 v[0:15], v[72:75], v[184:187], v[0:15]
    ds_read_b64_tr_b16 v[176:177], v246 offset:4096
    ds_read_b64_tr_b16 v[178:179], v246 offset:4608
    ds_read_b64_tr_b16 v[180:181], v247 offset:4096
    ds_read_b64_tr_b16 v[182:183], v247 offset:4608
    v_cvt_pk_bf16_f32 v244, v244, v245
    v_cvt_pk_bf16_f32 v240, v240, v240
    s_mov_b32 m0, s69
    v_mfma_f32_32x32x16_bf16 v[16:31], v[76:79], v[184:187], v[16:31]
    buffer_load_dwordx4 v226, s[4:7], s41 offen sc1 lds
    buffer_load_dwordx4 v227, s[72:75], s41 offen offset:1024 sc1 lds
    ds_write_b32 v230, v242 offset:768
    ds_write_b32 v230, v244 offset:1024
    ds_write_b16 v241, v240 offset:1280
    s_waitcnt lgkmcnt(7)
    v_readfirstlane_b32 s58, v232
    v_mfma_f32_32x32x16_bf16 v[32:47], v[72:75], v[188:191], v[32:47]
    s_cmp_lt_u32 s58, s22
    s_cbranch_scc0 K2_nul_41
    s_and_b32 s59, s58, 7
    s_lshr_b32 s60, s58, 3
K2_chk_43:
    v_readlane_b32 s61, v233, s59
    s_nop 0
    s_cmp_gt_u32 s61, s60
    s_cbranch_scc0 K2_spin_42
K2_back_44:
    v_mfma_f32_32x32x16_bf16 v[48:63], v[76:79], v[188:191], v[48:63]
    v_readlane_b32 s3, v253, s58
    s_lshl_b32 s44, s34, 7
    s_and_b32 s48, s3, 0x3ffff
    s_bfe_u32 s33, s3, 0x30012
    s_mov_b32 s35, s48
    s_mov_b32 s45, s44
    s_waitcnt vmcnt(4) lgkmcnt(3)
    v_mfma_f32_32x32x16_bf16 v[0:15], v[80:83], v[176:179], v[0:15]
    ds_read_b64_tr_b16 v[184:185], v246 offset:6144
    ds_read_b64_tr_b16 v[186:187], v246 offset:6656
    ds_read_b64_tr_b16 v[188:189], v247 offset:6144
    ds_read_b64_tr_b16 v[190:191], v247 offset:6656
    s_add_u32 s47, s44, 256
    s_add_u32 s49, s48, 32
    s_mov_b32 m0, s70
    v_mfma_f32_32x32x16_bf16 v[16:31], v[84:87], v[176:179], v[16:31]
    buffer_load_dwordx4 v222, s[4:7], s42 offen sc1 lds
    buffer_load_dwordx4 v223, s[72:75], s42 offen offset:1024 sc1 lds
    s_add_u32 s60, s48, 64
    s_cmp_eq_u32 s33, 3
    s_cselect_b32 s46, s44, s47
    s_cselect_b32 s50, s60, s48
    s_cselect_b32 s51, s48, s49
    v_mfma_f32_32x32x16_bf16 v[32:47], v[80:83], v[180:183], v[32:47]
    s_sub_u32 s60, s33, 2
    s_cmp_lt_u32 s60, 2
    s_cbranch_scc0 K2_rare_45
K2_back_46:
    v_mul_f32 v234, v0, v96
    v_mul_f32 v236, v8, v128
    v_fmac_f32 v234, v1, v97
    v_fmac_f32 v236, v9, v129
    v_mfma_f32_32x32x16_bf16 v[48:63], v[84:87], v[180:183], v[48:63]
    s_setprio 0
    v_fmac_f32 v234, v2, v98
    v_fmac_f32 v236, v10, v130
    v_fmac_f32 v234, v3, v99
    v_fmac_f32 v236, v11, v131
    v_fmac_f32 v234, v4, v100
    v_fmac_f32 v236, v12, v132
    v_fmac_f32 v234, v5, v101
    v_fmac_f32 v236, v13, v133
    v_fmac_f32 v234, v6, v102
    v_fmac_f32 v236, v14, v134
    v_fmac_f32 v234, v7, v103
    v_fmac_f32 v236, v15, v135
    v_mul_f32 v238, v16, v128
    v_mul_f32 v240, v24, v128
    v_fmac_f32 v238, v17, v129
    v_fmac_f32 v240, v25, v129
    v_fmac_f32 v238, v18, v130
    v_fmac_f32 v240, v26, v130
    v_fmac_f32 v238, v19, v131
    v_fmac_f32 v240, v27, v131
    v_fmac_f32 v238, v20, v132
    v_fmac_f32 v240, v28, v132
    v_fmac_f32 v238, v21, v133
    v_fmac_f32 v240, v29, v133
    v_fmac_f32 v238, v22, v134
    v_fmac_f32 v240, v30, v134
    v_fmac_f32 v238, v23, v135
    v_fmac_f32 v240, v31, v135
    v_mul_f32 v235, v32, v104
    v_mul_f32 v237, v40, v136
    v_fmac_f32 v235, v33, v105
    v_fmac_f32 v237, v41, v137
    v_fmac_f32 v235, v34, v106
    v_fmac_f32 v237, v42, v138
    v_fmac_f32 v235, v35, v107
    v_fmac_f32 v237, v43, v139
    v_fmac_f32 v235, v36, v108
    v_fmac_f32 v237, v44, v140
    v_fmac_f32 v235, v37, v109
    v_fmac_f32 v237, v45, v141
    v_fmac_f32 v235, v38, v110
    v_fmac_f32 v237, v46, v142
    v_fmac_f32 v235, v39, v111
    v_fmac_f32 v237, v47, v143
    v_mul_f32 v239, v48, v136
    v_mul_f32 v241, v56, v136
    s_setprio 1
    s_waitcnt vmcnt(4) lgkmcnt(0)
    v_mfma_f32_32x32x16_bf16 v[0:15], v[64:67], v[184:187], 0
    ds_read_b64_tr_b16 v[176:177], v246 offset:0
    ds_read_b64_tr_b16 v[178:179], v246 offset:512
    ds_read_b64_tr_b16 v[180:181], v247 offset:0
    ds_read_b64_tr_b16 v[182:183], v247 offset:512
    v_fmac_f32 v239, v49, v137
    v_fmac_f32 v241, v57, v137
    s_mov_b32 m0, s71
    v_mfma_f32_32x32x16_bf16 v[16:31], v[68:71], v[184:187], 0
    buffer_load_dwordx4 v224, s[4:7], s42 offen sc1 lds
    buffer_load_dwordx4 v225, s[72:75], s42 offen offset:1024 sc1 lds
    v_fmac_f32 v239, v50, v138
    v_fmac_f32 v241, v58, v138
    v_fmac_f32 v239, v51, v139
    v_fmac_f32 v241, v59, v139
    v_fmac_f32 v239, v52, v140
    v_mfma_f32_32x32x16_bf16 v[32:47], v[64:67], v[188:191], 0
    v_fmac_f32 v241, v60, v140
    v_fmac_f32 v239, v53, v141
    v_fmac_f32 v241, v61, v141
    v_fmac_f32 v239, v54, v142
    v_fmac_f32 v241, v62, v142
    v_fmac_f32 v239, v55, v143
    v_fmac_f32 v241, v63, v143
    v_mfma_f32_32x32x16_bf16 v[48:63], v[68:71], v[188:191], 0
    v_permlane32_swap_b32 v234, v236
    v_permlane32_swap_b32 v235, v237
    v_permlane32_swap_b32 v240, v238
    s_waitcnt vmcnt(4) lgkmcnt(0)
    v_mfma_f32_32x32x16_bf16 v[0:15], v[72:75], v[176:179], v[0:15]
    ds_read_b64_tr_b16 v[184:185], v246 offset:2048
    ds_read_b64_tr_b16 v[186:187], v246 offset:2560
    ds_read_b64_tr_b16 v[188:189], v247 offset:2048
    ds_read_b64_tr_b16 v[190:191], v247 offset:2560
    v_permlane32_swap_b32 v241, v239
    s_mov_b32 m0, s68
    v_mfma_f32_32x32x16_bf16 v[16:31], v[76:79], v[176:179], v[16:31]
    buffer_load_dwordx4 v226, s[4:7], s42 offen sc1 lds
    buffer_load_dwordx4 v227, s[72:75], s42 offen offset:1024 sc1 lds
    v_lshl_add_u32 v230, v252, 1, s31
    v_add_f32 v234, v234, v236
    v_add_f32 v235, v235, v237
    v_add_f32 v240, v240, v238
    v_add_f32 v241, v241, v239
    v_mfma_f32_32x32x16_bf16 v[32:47], v[72:75], v[180:183], v[32:47]
    v_cvt_pk_bf16_f32 v234, v234, v235
    v_cvt_pk_bf16_f32 v240, v240, v241
    ds_write_b32 v230, v234 offset:0
    ds_write_b32 v230, v240 offset:256
    v_mfma_f32_32x32x16_bf16 v[48:63], v[76:79], v[180:183], v[48:63]
    s_waitcnt vmcnt(4) lgkmcnt(2)
    v_mfma_f32_32x32x16_bf16 v[0:15], v[80:83], v[184:187], v[0:15]
    ds_read_b64_tr_b16 v[176:177], v246 offset:4096
    ds_read_b64_tr_b16 v[178:179], v246 offset:4608
    ds_read_b64_tr_b16 v[180:181], v247 offset:4096
    ds_read_b64_tr_b16 v[182:183], v247 offset:4608
    s_mov_b32 m0, s69
    v_mfma_f32_32x32x16_bf16 v[16:31], v[84:87], v[184:187], v[16:31]
    buffer_load_dwordx4 v222, s[4:7], s43 offen sc1 lds
    buffer_load_dwordx4 v223, s[72:75], s43 offen offset:1024 sc1 lds
    v_mfma_f32_32x32x16_bf16 v[32:47], v[80:83], v[188:191], v[32:47]
    s_nop 2
    v_mul_f32 v234, v0, v144
    v_mul_f32 v236, v8, v112
    v_fmac_f32 v234, v1, v145
    v_fmac_f32 v236, v9, v113
    v_fmac_f32 v234, v2, v146
    v_fmac_f32 v236, v10, v114
    v_fmac_f32 v234, v3, v147
    v_mfma_f32_32x32x16_bf16 v[48:63], v[84:87], v[188:191], v[48:63]
    s_setprio 0
    v_fmac_f32 v236, v11, v115
    v_fmac_f32 v234, v4, v148
    v_fmac_f32 v236, v12, v116
    v_fmac_f32 v234, v5, v149
    v_fmac_f32 v236, v13, v117
    v_fmac_f32 v234, v6, v150
    v_fmac_f32 v236, v14, v118
    v_fmac_f32 v234, v7, v151
    v_fmac_f32 v236, v15, v119
    v_mul_f32 v238, v16, v160
    v_mul_f32 v240, v24, v160
    v_fmac_f32 v238, v17, v161
    v_fmac_f32 v240, v25, v161
    v_fmac_f32 v238, v18, v162
    v_fmac_f32 v240, v26, v162
    v_fmac_f32 v238, v19, v163
    v_fmac_f32 v240, v27, v163
    v_fmac_f32 v238, v20, v164
    v_fmac_f32 v240, v28, v164
    v_fmac_f32 v238, v21, v165
    v_fmac_f32 v240, v29, v165
    v_fmac_f32 v238, v22, v166
    v_fmac_f32 v240, v30, v166
    v_fmac_f32 v238, v23, v167
    v_fmac_f32 v240, v31, v167
    v_mul_f32 v235, v32, v152
    v_mul_f32 v237, v40, v120
    v_fmac_f32 v235, v33, v153
    v_fmac_f32 v237, v41, v121
    v_fmac_f32 v235, v34, v154
    v_fmac_f32 v237, v42, v122
    v_fmac_f32 v235, v35, v155
    v_fmac_f32 v237, v43, v123
    v_fmac_f32 v235, v36, v156
    v_fmac_f32 v237, v44, v124
    v_fmac_f32 v235, v37, v157
    v_fmac_f32 v237, v45, v125
    v_fmac_f32 v235, v38, v158
    v_fmac_f32 v237, v46, v126
    v_fmac_f32 v235, v39, v159
    v_fmac_f32 v237, v47, v127
    v_mul_f32 v239, v48, v168
    v_mul_f32 v241, v56, v168
    v_fmac_f32 v239, v49, v169
    v_fmac_f32 v241, v57, v169
    s_setprio 1
    s_waitcnt vmcnt(4) lgkmcnt(0)
    v_mfma_f32_32x32x16_bf16 v[0:15], v[64:67], v[176:179], 0
    ds_read_b64_tr_b16 v[184:185], v246 offset:6144
    ds_read_b64_tr_b16 v[186:187], v246 offset:6656
    ds_read_b64_tr_b16 v[188:189], v247 offset:6144
    ds_read_b64_tr_b16 v[190:191], v247 offset:6656
    v_fmac_f32 v239, v50, v170
    v_fmac_f32 v241, v58, v170
    s_mov_b32 m0, s70
    v_mfma_f32_32x32x16_bf16 v[16:31], v[68:71], v[176:179], 0
    buffer_load_dwordx4 v224, s[4:7], s43 offen sc1 lds
    buffer_load_dwordx4 v225, s[72:75], s43 offen offset:1024 sc1 lds
    v_fmac_f32 v239, v51, v171
    v_fmac_f32 v241, v59, v171
    v_fmac_f32 v239, v52, v172
    v_fmac_f32 v241, v60, v172
    v_fmac_f32 v239, v53, v173
    v_mfma_f32_32x32x16_bf16 v[32:47], v[64:67], v[180:183], 0
    v_add_u32 v222, s48, v251
    ds_read_b32 v222, v222
    v_fmac_f32 v241, v61, v173
    v_fmac_f32 v239, v54, v174
    v_fmac_f32 v241, v62, v174
    v_fmac_f32 v239, v55, v175
    v_fmac_f32 v241, v63, v175
    v_mfma_f32_32x32x16_bf16 v[48:63], v[68:71], v[180:183], 0
    s_waitcnt vmcnt(4) lgkmcnt(1)
    v_mfma_f32_32x32x16_bf16 v[0:15], v[72:75], v[184:187], v[0:15]
    ds_read_b64_tr_b16 v[176:177], v246 offset:0
    ds_read_b64_tr_b16 v[178:179], v246 offset:512
    ds_read_b64_tr_b16 v[180:181], v247 offset:0
    ds_read_b64_tr_b16 v[182:183], v247 offset:512
    s_mov_b32 m0, s71
    v_mfma_f32_32x32x16_bf16 v[16:31], v[76:79], v[184:187], v[16:31]
    buffer_load_dwordx4 v226, s[4:7], s43 offen sc1 lds
    buffer_load_dwordx4 v227, s[72:75], s43 offen offset:1024 sc1 lds
    s_waitcnt lgkmcnt(4)
    v_mad_u32_u16 v223, v222, s39, v248 op_sel:[1,0,0,0]
    v_mad_u32_u16 v222, v222, s39, v248
    v_mfma_f32_32x32x16_bf16 v[32:47], v[72:75], v[188:191], v[32:47]
    v_add_u32 v224, s49, v251
    ds_read_b32 v224, v224
    v_mfma_f32_32x32x16_bf16 v[48:63], v[76:79], v[188:191], v[48:63]
    s_waitcnt vmcnt(4) lgkmcnt(1)
    v_mfma_f32_32x32x16_bf16 v[0:15], v[80:83], v[176:179], v[0:15]
    ds_read_b64_tr_b16 v[184:185], v246 offset:2048
    ds_read_b64_tr_b16 v[186:187], v246 offset:2560
    ds_read_b64_tr_b16 v[188:189], v247 offset:2048
    ds_read_b64_tr_b16 v[190:191], v247 offset:2560
    s_mov_b32 m0, s68
    v_mfma_f32_32x32x16_bf16 v[16:31], v[84:87], v[176:179], v[16:31]
    buffer_load_dwordx4 v222, s[4:7], s44 offen sc1 lds
    buffer_load_dwordx4 v223, s[72:75], s44 offen offset:1024 sc1 lds
    s_waitcnt lgkmcnt(4)
    v_mad_u32_u16 v225, v224, s39, v248 op_sel:[1,0,0,0]
    v_mad_u32_u16 v224, v224, s39, v248
    v_mfma_f32_32x32x16_bf16 v[32:47], v[80:83], v[180:183], v[32:47]
    v_add_u32 v226, s50, v251
    ds_read_b32 v226, v226
    v_mul_f32 v242, v0, v144
    v_fma_f32 v238, v8, v160, -v238
    v_fmac_f32 v242, v1, v145
    v_fmac_f32 v238, v9, v161
    v_fmac_f32 v242, v2, v146
    v_mfma_f32_32x32x16_bf16 v[48:63], v[84:87], v[180:183], v[48:63]
    s_setprio 0
    v_fmac_f32 v238, v10, v162
    v_fmac_f32 v242, v3, v147
    v_fmac_f32 v238, v11, v163
    v_fmac_f32 v242, v4, v148
    v_fmac_f32 v238, v12, v164
    v_fmac_f32 v242, v5, v149
    v_fmac_f32 v238, v13, v165
    v_fmac_f32 v242, v6, v150
    v_fmac_f32 v238, v14, v166
    v_fmac_f32 v242, v7, v151
    v_fmac_f32 v238, v15, v167
    v_fmac_f32 v236, v16, v112
    v_mul_f32 v244, v24, v160
    v_fmac_f32 v236, v17, v113
    v_fmac_f32 v244, v25, v161
    v_fmac_f32 v236, v18, v114
    v_fmac_f32 v244, v26, v162
    v_fmac_f32 v236, v19, v115
    v_fmac_f32 v244, v27, v163
    v_fmac_f32 v236, v20, v116
    v_fmac_f32 v244, v28, v164
    v_fmac_f32 v236, v21, v117
    v_fmac_f32 v244, v29, v165
    v_fmac_f32 v236, v22, v118
    v_fmac_f32 v244, v30, v166
    v_fmac_f32 v236, v23, v119
    v_fmac_f32 v244, v31, v167
    v_mul_f32 v243, v32, v152
    v_fma_f32 v239, v40, v168, -v239
    v_fmac_f32 v243, v33, v153
    v_fmac_f32 v239, v41, v169
    v_fmac_f32 v243, v34, v154
    v_fmac_f32 v239, v42, v170
    v_fmac_f32 v243, v35, v155
    v_fmac_f32 v239, v43, v171
    v_fmac_f32 v243, v36, v156
    v_fmac_f32 v239, v44, v172
    v_fmac_f32 v243, v37, v157
    v_fmac_f32 v239, v45, v173
    v_fmac_f32 v243, v38, v158
    v_fmac_f32 v239, v46, v174
    v_fmac_f32 v243, v39, v159
    v_fmac_f32 v239, v47, v175
    v_fmac_f32 v237, v48, v120
    v_mul_f32 v245, v56, v168
    v_fmac_f32 v237, v49, v121
    v_fmac_f32 v245, v57, v169
    v_fmac_f32 v237, v50, v122
    v_fmac_f32 v245, v58, v170
    v_fmac_f32 v237, v51, v123
    s_setprio 1
    s_waitcnt vmcnt(4) lgkmcnt(1)
    v_mfma_f32_32x32x16_bf16 v[0:15], v[64:67], v[184:187], 0
    ds_read_b64_tr_b16 v[176:177], v246 offset:4096
    ds_read_b64_tr_b16 v[178:179], v246 offset:4608
    ds_read_b64_tr_b16 v[180:181], v247 offset:4096
    ds_read_b64_tr_b16 v[182:183], v247 offset:4608
    v_fmac_f32 v245, v59, v171
    v_fmac_f32 v237, v52, v124
    s_mov_b32 m0, s69
    v_mfma_f32_32x32x16_bf16 v[16:31], v[68:71], v[184:187], 0
    buffer_load_dwordx4 v224, s[4:7], s45 offen sc1 lds
    buffer_load_dwordx4 v225, s[72:75], s45 offen offset:1024 sc1 lds
    s_waitcnt lgkmcnt(4)
    v_mad_u32_u16 v227, v226, s39, v248 op_sel:[1,0,0,0]
    v_mad_u32_u16 v226, v226, s39, v248
    v_fmac_f32 v245, v60, v172
    v_fmac_f32 v237, v53, v125
    v_mfma_f32_32x32x16_bf16 v[32:47], v[64:67], v[188:191], 0
    v_add_u32 v228, s51, v251
    ds_read_b32 v228, v228
    v_fmac_f32 v245, v61, v173
    v_fmac_f32 v237, v54, v126
    v_fmac_f32 v245, v62, v174
    v_fmac_f32 v237, v55, v127
    v_fmac_f32 v245, v63, v175
    v_mfma_f32_32x32x16_bf16 v[48:63], v[68:71], v[188:191], 0
    v_permlane32_swap_b32 v242, v234
    v_permlane32_swap_b32 v243, v235
    v_add_f32 v242, v242, v234
    v_add_f32 v243, v243, v235
    s_waitcnt vmcnt(4) lgkmcnt(1)
    v_mfma_f32_32x32x16_bf16 v[0:15], v[72:75], v[176:179], v[0:15]
    ds_read_b64_tr_b16 v[184:185], v246 offset:6144
    ds_read_b64_tr_b16 v[186:187], v246 offset:6656
    ds_read_b64_tr_b16 v[188:189], v247 offset:6144
    ds_read_b64_tr_b16 v[190:191], v247 offset:6656
    v_cvt_pk_bf16_f32 v242, v242, v243
    ds_write_b32 v230, v242 offset:512
    s_mov_b32 m0, s70
    v_mfma_f32_32x32x16_bf16 v[16:31], v[76:79], v[176:179], v[16:31]
    buffer_load_dwordx4 v226, s[4:7], s46 offen sc1 lds
    buffer_load_dwordx4 v227, s[72:75], s46 offen offset:1024 sc1 lds
    s_waitcnt lgkmcnt(5)
    v_mad_u32_u16 v229, v228, s39, v248 op_sel:[1,0,0,0]
    v_mad_u32_u16 v228, v228, s39, v248
    s_sub_u32 s26, s48, s29
    s_mov_b32 s29, s48
    v_mfma_f32_32x32x16_bf16 v[32:47], v[72:75], v[180:183], v[32:47]
    s_mov_b32 s30, s3
    s_cmp_lg_u32 s36, 0
    s_cselect_b32 s56, s33, 0
    s_mov_b32 s32, s31
    s_mov_b32 s31, s35
    v_mfma_f32_32x32x16_bf16 v[48:63], v[76:79], v[180:183], v[48:63]
    s_waitcnt vmcnt(4) lgkmcnt(1)
    v_mfma_f32_32x32x16_bf16 v[0:15], v[80:83], v[184:187], v[0:15]
    ds_read_b64_tr_b16 v[176:177], v246 offset:0
    ds_read_b64_tr_b16 v[178:179], v246 offset:512
    ds_read_b64_tr_b16 v[180:181], v247 offset:0
    ds_read_b64_tr_b16 v[182:183], v247 offset:512
    s_mov_b32 m0, s71
    v_mfma_f32_32x32x16_bf16 v[16:31], v[84:87], v[184:187], v[16:31]
    buffer_load_dwordx4 v228, s[4:7], s47 offen sc1 lds
    buffer_load_dwordx4 v229, s[72:75], s47 offen offset:1024 sc1 lds
    v_mfma_f32_32x32x16_bf16 v[32:47], v[80:83], v[188:191], v[32:47]
    s_nop 2
    v_mul_f32 v242, v0, v144
    v_fma_f32 v240, v8, v160, -v240
    v_fmac_f32 v242, v1, v145
    v_fmac_f32 v240, v9, v161
    v_fmac_f32 v242, v2, v146
    v_fmac_f32 v240, v10, v162
    v_fmac_f32 v242, v3, v147
    v_mfma_f32_32x32x16_bf16 v[48:63], v[84:87], v[188:191], v[48:63]
    s_setprio 0
    v_fmac_f32 v240, v11, v163
    v_fmac_f32 v242, v4, v148
    v_fmac_f32 v240, v12, v164
    v_fmac_f32 v242, v5, v149
    v_fmac_f32 v240, v13, v165
    v_fmac_f32 v242, v6, v150
    v_fmac_f32 v240, v14, v166
    v_fmac_f32 v242, v7, v151
    v_fmac_f32 v240, v15, v167
    v_add_u32 v249, s26, v249
    v_add_u32 v250, s26, v250
    v_fma_f32 v244, v16, v160, -v244
    v_fmac_f32 v236, v24, v112
    v_fmac_f32 v244, v17, v161
    v_fmac_f32 v236, v25, v113
    v_fmac_f32 v244, v18, v162
    v_fmac_f32 v236, v26, v114
    v_fmac_f32 v244, v19, v163
    v_fmac_f32 v236, v27, v115
    v_fmac_f32 v244, v20, v164
    v_fmac_f32 v236, v28, v116
    v_fmac_f32 v244, v21, v165
    v_fmac_f32 v236, v29, v117
    v_fmac_f32 v244, v22, v166
    v_fmac_f32 v236, v30, v118
    v_fmac_f32 v244, v23, v167
    v_fmac_f32 v236, v31, v119
    ds_read_b64_tr_b16 v[0:1], v249 offset:0
    ds_read_b64_tr_b16 v[2:3], v249 offset:256
    ds_read_u16_d16_hi v16, v250 offset:0
    v_mul_f32 v243, v32, v152
    v_fma_f32 v241, v40, v168, -v241
    v_fmac_f32 v243, v33, v153
    v_fmac_f32 v241, v41, v169
    v_fmac_f32 v243, v34, v154
    v_fmac_f32 v241, v42, v170
    v_fmac_f32 v243, v35, v155
    v_fmac_f32 v241, v43, v171
    v_fmac_f32 v243, v36, v156
    v_fmac_f32 v241, v44, v172
    v_fmac_f32 v243, v37, v157
    v_fmac_f32 v241, v45, v173
    v_fmac_f32 v243, v38, v158
    v_fmac_f32 v241, v46, v174
    v_fmac_f32 v243, v39, v159
    v_fmac_f32 v241, v47, v175
    ds_read_b64_tr_b16 v[4:5], v249 offset:512
    ds_read_b64_tr_b16 v[6:7], v249 offset:768
    ds_read_u16_d16_hi v17, v250 offset:32
    v_fma_f32 v245, v48, v168, -v245
    v_fmac_f32 v237, v56, v120
    v_fmac_f32 v245, v49, v169
    v_fmac_f32 v237, v57, v121
    v_fmac_f32 v245, v50, v170
    v_fmac_f32 v237, v58, v122
    v_fmac_f32 v245, v51, v171
    v_fmac_f32 v237, v59, v123
    v_fmac_f32 v245, v52, v172
    v_fmac_f32 v237, v60, v124
    v_fmac_f32 v245, v53, v173
    v_fmac_f32 v237, v61, v125
    v_fmac_f32 v245, v54, v174
    v_fmac_f32 v237, v62, v126
    v_fmac_f32 v245, v55, v175
    v_fmac_f32 v237, v63, v127
    s_cmp_eq_u32 s56, 2
    s_cbranch_scc1 K2_U21
    s_cmp_eq_u32 s56, 3
    s_cbranch_scc1 K2_U31
    s_branch K2_DSP1
K2_PAD_SW:
    s_branch K2_HOP
K2_DSP0:
    s_cmp_eq_u32 s56, 1
    s_cbranch_scc1 K2_U10
    s_cmp_eq_u32 s56, 4
    s_cbranch_scc1 K2_U40
    s_branch K2_SWITCH
K2_DSP1:
    s_cmp_eq_u32 s56, 1
    s_cbranch_scc1 K2_U11
    s_cmp_eq_u32 s56, 4
    s_cbranch_scc1 K2_U41
    s_branch K2_TAIL
K2_SWITCH:
    v_permlane32_swap_b32 v242, v236
    v_permlane32_swap_b32 v243, v237
    v_permlane32_swap_b32 v244, v238
    v_permlane32_swap_b32 v245, v239
    v_permlane32_swap_b32 v240, v241
    v_add_f32 v242, v242, v236
    v_add_f32 v243, v243, v237
    v_add_f32 v244, v244, v238
    v_add_f32 v245, v245, v239
    v_add_f32 v240, -v240, -v241
    s_set_gpr_idx_on s32, gpr_idx(DST)
    s_nop 0
    v_cvt_pk_bf16_f32 v195, v242, v243
    v_cvt_pk_bf16_f32 v196, v244, v245
    v_cvt_pk_bf16_f32 v197, v240, v240
    s_set_gpr_idx_off
    s_cmp_eq_u32 s36, 0
    s_cbranch_scc1 K2_TAIL2
    v_lshl_add_u32 v230, v252, 1, s35
    v_lshrrev_b32 v231, 6, v252
    v_mul_u32_u24 v231, 126, v231
    v_lshrrev_b32 v254, 6, v252
    v_bfe_u32 v255, v252, 3, 2
    v_lshl_add_u32 v254, v254, 2, v255
    v_mul_u32_u24 v254, 640, v254
    v_bfe_u32 v255, v252, 5, 1
    v_lshl_add_u32 v254, v255, 5, v254
    v_and_b32 v255, 6, v252
    v_lshl_add_u32 v254, v255, 2, v254
    v_add_u32 v254, 150240, v254
    ds_read_b64_tr_b16 v[104:105], v254 offset:0
    ds_read_b64_tr_b16 v[106:107], v254 offset:5120
    ds_read_b64_tr_b16 v[108:109], v254 offset:64
    ds_read_b64_tr_b16 v[110:111], v254 offset:5184
    ds_read_b64_tr_b16 v[120:121], v254 offset:128
    ds_read_b64_tr_b16 v[122:123], v254 offset:5248
    ds_read_b64_tr_b16 v[124:125], v254 offset:192
    ds_read_b64_tr_b16 v[126:127], v254 offset:5312
    ds_read_b64_tr_b16 v[136:137], v254 offset:256
    ds_read_b64_tr_b16 v[138:139], v254 offset:5376
    ds_read_b64_tr_b16 v[140:141], v254 offset:320
    ds_read_b64_tr_b16 v[142:143], v254 offset:5440
    ds_read_b64_tr_b16 v[152:153], v254 offset:384
    ds_read_b64_tr_b16 v[154:155], v254 offset:5504
    ds_read_b64_tr_b16 v[156:157], v254 offset:448
    ds_read_b64_tr_b16 v[158:159], v254 offset:5568
    ds_read_b64_tr_b16 v[168:169], v254 offset:512
    ds_read_b64_tr_b16 v[170:171], v254 offset:5632
    ds_read_b64_tr_b16 v[172:173], v254 offset:576
    ds_read_b64_tr_b16 v[174:175], v254 offset:5696
    s_movk_i32 s40, 128
    s_movk_i32 s41, 384
    s_movk_i32 s42, 640
    s_movk_i32 s43, 896
    s_waitcnt lgkmcnt(15)
    v_lshlrev_b32 v96, 16, v104
    v_and_b32 v97, 0xffff0000, v104
    v_lshlrev_b32 v98, 16, v105
    v_and_b32 v99, 0xffff0000, v105
    v_lshlrev_b32 v100, 16, v106
    v_and_b32 v101, 0xffff0000, v106
    v_lshlrev_b32 v102, 16, v107
    v_and_b32 v103, 0xffff0000, v107
    v_lshlrev_b32 v104, 16, v108
    v_and_b32 v105, 0xffff0000, v108
    v_lshlrev_b32 v106, 16, v109
    v_and_b32 v107, 0xffff0000, v109
    v_lshlrev_b32 v108, 16, v110
    v_and_b32 v109, 0xffff0000, v110
    v_lshlrev_b32 v110, 16, v111
    v_and_b32 v111, 0xffff0000, v111
    s_waitcnt lgkmcnt(12)
    v_lshlrev_b32 v112, 16, v120
    v_and_b32 v113, 0xffff0000, v120
    v_lshlrev_b32 v114, 16, v121
    v_and_b32 v115, 0xffff0000, v121
    v_lshlrev_b32 v116, 16, v122
    v_and_b32 v117, 0xffff0000, v122
    v_lshlrev_b32 v118, 16, v123
    v_and_b32 v119, 0xffff0000, v123
    v_lshlrev_b32 v120, 16, v124
    v_and_b32 v121, 0xffff0000, v124
    v_lshlrev_b32 v122, 16, v125
    v_and_b32 v123, 0xffff0000, v125
    v_lshlrev_b32 v124, 16, v126
    v_and_b32 v125, 0xffff0000, v126
    v_lshlrev_b32 v126, 16, v127
    v_and_b32 v127, 0xffff0000, v127
    s_waitcnt lgkmcnt(8)
    v_lshlrev_b32 v128, 16, v136
    v_and_b32 v129, 0xffff0000, v136
    v_lshlrev_b32 v130, 16, v137
    v_and_b32 v131, 0xffff0000, v137
    v_lshlrev_b32 v132, 16, v138
    v_and_b32 v133, 0xffff0000, v138
    v_lshlrev_b32 v134, 16, v139
    v_and_b32 v135, 0xffff0000, v139
    v_lshlrev_b32 v136, 16, v140
    v_and_b32 v137, 0xffff0000, v140
    v_lshlrev_b32 v138, 16, v141
    v_and_b32 v139, 0xffff0000, v141
    v_lshlrev_b32 v140, 16, v142
    v_and_b32 v141, 0xffff0000, v142
    v_lshlrev_b32 v142, 16, v143
    v_and_b32 v143, 0xffff0000, v143
    s_waitcnt lgkmcnt(4)
    v_lshlrev_b32 v144, 16, v152
    v_and_b32 v145, 0xffff0000, v152
    v_lshlrev_b32 v146, 16, v153
    v_and_b32 v147, 0xffff0000, v153
    v_lshlrev_b32 v148, 16, v154
    v_and_b32 v149, 0xffff0000, v154
    v_lshlrev_b32 v150, 16, v155
    v_and_b32 v151, 0xffff0000, v155
    v_lshlrev_b32 v152, 16, v156
    v_and_b32 v153, 0xffff0000, v156
    v_lshlrev_b32 v154, 16, v157
    v_and_b32 v155, 0xffff0000, v157
    v_lshlrev_b32 v156, 16, v158
    v_and_b32 v157, 0xffff0000, v158
    v_lshlrev_b32 v158, 16, v159
    v_and_b32 v159, 0xffff0000, v159
    s_waitcnt lgkmcnt(0)
    v_lshlrev_b32 v160, 16, v168
    v_and_b32 v161, 0xffff0000, v168
    v_lshlrev_b32 v162, 16, v169
    v_and_b32 v163, 0xffff0000, v169
    v_lshlrev_b32 v164, 16, v170
    v_and_b32 v165, 0xffff0000, v170
    v_lshlrev_b32 v166, 16, v171
    v_and_b32 v167, 0xffff0000, v171
    v_lshlrev_b32 v168, 16, v172
    v_and_b32 v169, 0xffff0000, v172
    v_lshlrev_b32 v170, 16, v173
    v_and_b32 v171, 0xffff0000, v173
    v_lshlrev_b32 v172, 16, v174
    v_and_b32 v173, 0xffff0000, v174
    v_lshlrev_b32 v174, 16, v175
    v_and_b32 v175, 0xffff0000, v175
    s_mov_b32 s29, s48
    s_mov_b32 s32, s31
    s_mov_b32 s30, s3
    s_mov_b32 s31, s35
    s_cmp_eq_u32 s33, 2
    s_cbranch_scc1 K2_U21
    s_cmp_eq_u32 s33, 3
    s_cbranch_scc1 K2_U31
    s_cmp_eq_u32 s33, 1
    s_cbranch_scc1 K2_U11
    s_branch K2_U41
K2_dum_4:
    v_mov_b32 v232, -1
    s_mov_b32 m0, 160768
    s_mov_b64 exec, 1
    buffer_load_dwordx4 v232, s[16:19], 0 offen lds
    buffer_load_dwordx4 v232, s[16:19], 0 offen lds
    s_mov_b64 exec, -1
    s_branch K2_back_6
K2_nul_10:
    s_mov_b32 s58, 63
    s_mov_b32 s36, 0
    s_branch K2_back_13
K2_spin_11:
    s_sub_u32 s27, s27, 1
    s_cbranch_scc1 K2_END
    v_lshl_add_u32 v233, v252, 1, s53
    ds_read_b32 v233, v233
    s_waitcnt lgkmcnt(0)
    s_branch K2_chk_12
K2_dyn_8:
    v_mov_b32 v254, 160704
    v_mov_b32 v255, 1
    v_lshl_add_u32 v233, v252, 1, s53
    s_mov_b64 exec, 1
    ds_add_rtn_u32 v232, v254, v255
    s_mov_b64 exec, -1
    ds_read_b32 v233, v233
    s_waitcnt lgkmcnt(0)
    v_readfirstlane_b32 s58, v232
    s_nop 0
    s_cmp_lt_u32 s58, s22
    s_cbranch_scc0 K2_nul_10
    s_and_b32 s59, s58, 7
    s_lshr_b32 s60, s58, 3
K2_chk_12:
    v_readlane_b32 s61, v233, s59
    s_nop 0
    s_cmp_gt_u32 s61, s60
    s_cbranch_scc0 K2_spin_11
K2_back_13:
    s_mov_b32 s34, 1
    s_branch K2_back_9
K2_dum_17:
    v_mov_b32 v232, -1
    s_mov_b32 m0, 160768
    s_mov_b64 exec, 1
    buffer_load_dwordx4 v232, s[16:19], 0 offen lds
    buffer_load_dwordx4 v232, s[16:19], 0 offen lds
    s_mov_b64 exec, -1
    s_branch K2_back_19
K2_nul_23:
    s_mov_b32 s58, 63
    s_mov_b32 s36, 0
    s_branch K2_back_26
K2_spin_24:
    s_sub_u32 s27, s27, 1
    s_cbranch_scc1 K2_END
    v_lshl_add_u32 v233, v252, 1, s53
    ds_read_b32 v233, v233
    s_waitcnt lgkmcnt(0)
    s_branch K2_chk_25
K2_dyn_21:
    v_mov_b32 v254, 160704
    v_mov_b32 v255, 1
    v_lshl_add_u32 v233, v252, 1, s53
    s_mov_b64 exec, 1
    ds_add_rtn_u32 v232, v254, v255
    s_mov_b64 exec, -1
    ds_read_b32 v233, v233
    s_waitcnt lgkmcnt(0)
    v_readfirstlane_b32 s58, v232
    s_nop 0
    s_cmp_lt_u32 s58, s22
    s_cbranch_scc0 K2_nul_23
    s_and_b32 s59, s58, 7
    s_lshr_b32 s60, s58, 3
K2_chk_25:
    v_readlane_b32 s61, v233, s59
    s_nop 0
    s_cmp_gt_u32 s61, s60
    s_cbranch_scc0 K2_spin_24
K2_back_26:
    s_mov_b32 s34, 1
    s_branch K2_back_22
K2_dum_30:
    v_mov_b32 v232, -1
    s_mov_b32 m0, 160768
    s_mov_b64 exec, 1
    buffer_load_dwordx4 v232, s[16:19], 0 offen lds
    buffer_load_dwordx4 v232, s[16:19], 0 offen lds
    s_mov_b64 exec, -1
    s_branch K2_back_32
K2_nul_34:
    s_mov_b32 s58, 63
    s_mov_b32 s36, 0
    s_branch K2_back_37
K2_spin_35:
    s_sub_u32 s27, s27, 1
    s_cbranch_scc1 K2_END
    v_lshl_add_u32 v233, v252, 1, s53
    ds_read_b32 v233, v233
    s_waitcnt lgkmcnt(0)
    s_branch K2_chk_36
K2_nul_41:
    s_mov_b32 s58, 63
    s_mov_b32 s36, 0
    s_branch K2_back_44
K2_spin_42:
    s_sub_u32 s27, s27, 1
    s_cbranch_scc1 K2_END
    v_lshl_add_u32 v233, v252, 1, s53
    ds_read_b32 v233, v233
    s_waitcnt lgkmcnt(0)
    s_branch K2_chk_43
K2_PAD_TL:
    s_branch K2_HOP
K2_TAIL2:
    v_lshlrev_b32 v229, 3, v252
    s_mul_i32 s58, s20, 20480
    s_add_u32 s58, s58, 6946816
    s_mul_i32 s59, s20, 8224
    buffer_load_dwordx4 v[96:99], v229, s[8:11], s58 offen offset:0 sc1
    buffer_load_dwordx4 v[100:103], v229, s[8:11], s58 offen offset:1024 sc1
    buffer_load_dwordx4 v[104:107], v229, s[8:11], s58 offen offset:2048 sc1
    buffer_load_dwordx4 v[108:111], v229, s[8:11], s58 offen offset:3072 sc1
    s_add_u32 s58, s58, 4096
    buffer_load_dwordx4 v[112:115], v229, s[8:11], s58 offen offset:0 sc1
    buffer_load_dwordx4 v[116:119], v229, s[8:11], s58 offen offset:1024 sc1
    buffer_load_dwordx4 v[120:123], v229, s[8:11], s58 offen offset:2048 sc1
    buffer_load_dwordx4 v[124:127], v229, s[8:11], s58 offen offset:3072 sc1
    v_lshl_add_u32 v228, v252, 1, s59
    v_lshrrev_b32 v226, 6, v252
    v_mul_u32_u24 v226, 126, v226
    v_sub_u32 v226, v228, v226
    s_branch K2_TAIL3
K2_TAIL:
    v_lshlrev_b32 v229, 3, v252
    s_mul_i32 s58, s20, 20480
    s_add_u32 s58, s58, 6946816
    s_mul_i32 s59, s20, 8224
    buffer_load_dwordx4 v[96:99], v229, s[8:11], s58 offen offset:0 sc1
    v_permlane32_swap_b32 v242, v236
    v_permlane32_swap_b32 v243, v237
    buffer_load_dwordx4 v[100:103], v229, s[8:11], s58 offen offset:1024 sc1
    v_permlane32_swap_b32 v244, v238
    v_permlane32_swap_b32 v245, v239
    buffer_load_dwordx4 v[104:107], v229, s[8:11], s58 offen offset:2048 sc1
    v_permlane32_swap_b32 v240, v241
    v_add_f32 v242, v242, v236
    buffer_load_dwordx4 v[108:111], v229, s[8:11], s58 offen offset:3072 sc1
    v_add_f32 v243, v243, v237
    v_add_f32 v244, v244, v238
    s_add_u32 s58, s58, 4096
    buffer_load_dwordx4 v[112:115], v229, s[8:11], s58 offen offset:0 sc1
    v_add_f32 v245, v245, v239
    v_add_f32 v240, -v240, -v241
    buffer_load_dwordx4 v[116:119], v229, s[8:11], s58 offen offset:1024 sc1
    v_sub_u32 v241, v230, v231
    v_cvt_pk_bf16_f32 v242, v242, v243
    buffer_load_dwordx4 v[120:123], v229, s[8:11], s58 offen offset:2048 sc1
    v_cvt_pk_bf16_f32 v244, v244, v245
    v_cvt_pk_bf16_f32 v240, v240, v240
    buffer_load_dwordx4 v[124:127], v229, s[8:11], s58 offen offset:3072 sc1
    ds_write_b32 v230, v242 offset:768
    ds_write_b32 v230, v244 offset:1024
    ds_write_b16 v241, v240 offset:1280
    v_lshl_add_u32 v228, v252, 1, s59
    v_lshrrev_b32 v226, 6, v252
    v_mul_u32_u24 v226, 126, v226
    v_sub_u32 v226, v228, v226
K2_TAIL3:
    s_waitcnt vmcnt(8)
    ds_write_b32 v228, v192 offset:0
    ds_write_b32 v228, v193 offset:256
    ds_write_b32 v228, v194 offset:512
    s_add_u32 s58, s58, 4096
    buffer_load_dwordx4 v[128:131], v229, s[8:11], s58 offen offset:0 sc1
    v_bfe_u32 v48, v252, 1, 4
    v_lshrrev_b32 v49, 5, v252
    ds_write_b32 v228, v195 offset:768
    ds_write_b32 v228, v196 offset:1024
    ds_write_b16 v226, v197 offset:1280
    buffer_load_dwordx4 v[132:135], v229, s[8:11], s58 offen offset:1024 sc1
    v_lshrrev_b32 v55, 3, v48
    v_lshlrev_b32 v52, 4, v49
    ds_write_b32 v228, v198 offset:1536
    ds_write_b32 v228, v199 offset:1792
    ds_write_b32 v228, v200 offset:2048
    buffer_load_dwordx4 v[136:139], v229, s[8:11], s58 offen offset:2048 sc1
    v_lshl_add_u32 v54, v55, 2, v48
    v_and_b32 v54, 7, v54
    ds_write_b32 v228, v201 offset:2304
    ds_write_b32 v228, v202 offset:2560
    ds_write_b16 v226, v203 offset:2816
    buffer_load_dwordx4 v[140:143], v229, s[8:11], s58 offen offset:3072 sc1
    v_and_b32 v50, 7, v48
    v_mul_u32_u24 v50, 8224, v50
    ds_write_b32 v228, v204 offset:3072
    ds_write_b32 v228, v205 offset:3328
    ds_write_b32 v228, v206 offset:3584
    s_add_u32 s58, s58, 4096
    buffer_load_dwordx4 v[144:147], v229, s[8:11], s58 offen offset:0 sc1
    v_mul_u32_u24 v51, 1536, v55
    v_add_u32 v50, v50, v51
    ds_write_b32 v228, v207 offset:3840
    ds_write_b32 v228, v208 offset:4096
    ds_write_b16 v226, v209 offset:4352
    buffer_load_dwordx4 v[148:151], v229, s[8:11], s58 offen offset:1024 sc1
    v_add_u32 v222, v50, v52
    v_mul_u32_u24 v51, 8224, v54
    ds_write_b32 v228, v210 offset:4608
    ds_write_b32 v228, v211 offset:4864
    ds_write_b32 v228, v212 offset:5120
    buffer_load_dwordx4 v[152:155], v229, s[8:11], s58 offen offset:2048 sc1
    v_add_u32 v232, v51, v52
    v_lshl_add_u32 v247, v55, 7, v232
    ds_write_b32 v228, v213 offset:5376
    ds_write_b32 v228, v214 offset:5632
    ds_write_b16 v226, v215 offset:5888
    buffer_load_dwordx4 v[156:159], v229, s[8:11], s58 offen offset:3072 sc1
    v_mul_u32_u24 v51, 2080, v48
    s_mov_b32 s60, 65536
    ds_write_b32 v228, v216 offset:6144
    ds_write_b32 v228, v217 offset:6400
    ds_write_b32 v228, v218 offset:6656
    s_add_u32 s58, s58, 4096
    buffer_load_dwordx4 v[160:163], v229, s[8:11], s58 offen offset:0 sc1
    v_add3_u32 v223, v51, v52, s60
    v_mul_u32_u24 v51, 2080, v54
    ds_write_b32 v228, v219 offset:6912
    ds_write_b32 v228, v220 offset:7168
    ds_write_b16 v226, v221 offset:7424
    buffer_load_dwordx4 v[164:167], v229, s[8:11], s58 offen offset:1024 sc1
    s_mov_b32 s60, 132096
    v_add3_u32 v225, v51, v52, s60
    buffer_load_dwordx4 v[168:171], v229, s[8:11], s58 offen offset:2048 sc1
    v_lshl_add_u32 v248, v55, 7, v225
    s_lshl_b32 s60, s20, 5
    buffer_load_dwordx4 v[172:175], v229, s[8:11], s58 offen offset:3072 sc1
    v_lshl_add_u32 v49, v49, 3, s60
    s_mov_b32 s60, 65536
    v_add3_u32 v255, v51, v49, s60
    v_lshl_add_u32 v246, v55, 9, v255
    v_bfe_u32 v53, v48, 2, 1
    v_lshl_add_u32 v49, v53, 4, v49
    v_add_u32 v254, v50, v49
    s_and_b32 s64, s55, s28
    s_waitcnt lgkmcnt(0)
    s_barrier
    s_cmp_eq_u32 s64, 0
    s_cbranch_scc1 K2_MULTI
    s_setprio 3
    ds_read_b128 v[48:51], v222 offset:0
    ds_read_b128 v[52:55], v222 offset:64
    ds_read_b128 v[56:59], v222 offset:896
    ds_read_b128 v[60:63], v222 offset:960
    ds_read_b128 v[64:67], v223 offset:0
    ds_read_b128 v[68:71], v223 offset:64
    ds_read_b128 v[72:75], v223 offset:896
    ds_read_b128 v[76:79], v223 offset:960
    ds_read_b128 v[80:83], v222 offset:3072
    ds_read_b128 v[84:87], v222 offset:3136
    ds_read_b128 v[88:91], v222 offset:3968
    s_waitcnt vmcnt(19) lgkmcnt(9)
    v_mfma_f32_16x16x32_bf16 v[0:3], v[96:99], v[48:51], 0
    ds_read_b128 v[92:95], v222 offset:4032
    s_waitcnt vmcnt(18)
    v_mfma_f32_16x16x32_bf16 v[0:3], v[100:103], v[52:55], v[0:3]
    ds_read_b128 v[48:51], v223 offset:33280
    s_waitcnt vmcnt(17) lgkmcnt(9)
    v_mfma_f32_16x16x32_bf16 v[0:3], v[104:107], v[56:59], v[0:3]
    s_bfe_u32 s60, s20, 0x10002
    s_lshl_b32 s60, s60, 4
    ds_read_b128 v[52:55], v223 offset:33344
    s_waitcnt vmcnt(16)
    v_mfma_f32_16x16x32_bf16 v[0:3], v[108:111], v[60:63], v[0:3]
    s_add_u32 s59, s59, s60
    v_add_u32 v228, s59, v229
    ds_read_b128 v[56:59], v223 offset:34176
    s_waitcnt vmcnt(15) lgkmcnt(9)
    v_mfma_f32_16x16x32_bf16 v[0:3], v[112:115], v[64:67], v[0:3]
    s_mul_i32 s60, s20, 2080
    s_add_u32 s60, s60, 65536
    ds_read_b128 v[60:63], v223 offset:34240
    s_waitcnt vmcnt(14)
    v_mfma_f32_16x16x32_bf16 v[0:3], v[116:119], v[68:71], v[0:3]
    v_add_u32 v249, s60, v229
    s_mov_b32 s63, 0xbfb8aa3b
    ds_read_b128 v[64:67], v232 offset:6144
    s_waitcnt vmcnt(13) lgkmcnt(9)
    v_mfma_f32_16x16x32_bf16 v[0:3], v[120:123], v[72:75], v[0:3]
    s_add_u32 s40, s20, s21
    s_lshl_b32 s40, s40, 10
    ds_read_b128 v[68:71], v232 offset:6208
    s_waitcnt vmcnt(12)
    v_mfma_f32_16x16x32_bf16 v[0:3], v[124:127], v[76:79], v[0:3]
    s_add_u32 s41, s40, 8192
    s_add_u32 s42, s40, 16384
    ds_read_b128 v[72:75], v232 offset:7040
    s_waitcnt lgkmcnt(9)
    v_mfma_f32_16x16x32_bf16 v[16:19], v[96:99], v[80:83], 0
    s_add_u32 s43, s40, 24576
    s_add_u32 s44, s40, 32768
    ds_read_b128 v[76:79], v232 offset:7104
    v_mfma_f32_16x16x32_bf16 v[16:19], v[100:103], v[84:87], v[16:19]
    ds_read_b128 v[80:83], v225 offset:0
    s_waitcnt lgkmcnt(9)
    v_mfma_f32_16x16x32_bf16 v[16:19], v[104:107], v[88:91], v[16:19]
    ds_read_b128 v[84:87], v225 offset:64
    v_mfma_f32_16x16x32_bf16 v[16:19], v[108:111], v[92:95], v[16:19]
    v_mul_f32 v204, s63, v0
    v_mul_f32 v205, s63, v1
    ds_read_b128 v[88:91], v225 offset:896
    s_waitcnt lgkmcnt(9)
    v_mfma_f32_16x16x32_bf16 v[16:19], v[112:115], v[48:51], v[16:19]
    v_mul_f32 v206, s63, v2
    ds_read_b128 v[92:95], v225 offset:960
    v_mfma_f32_16x16x32_bf16 v[16:19], v[116:119], v[52:55], v[16:19]
    v_mul_f32 v207, s63, v3
    ds_read_b128 v[48:51], v222 offset:128
    s_waitcnt lgkmcnt(9)
    v_mfma_f32_16x16x32_bf16 v[16:19], v[120:123], v[56:59], v[16:19]
    v_exp_f32 v204, v204
    ds_read_b128 v[52:55], v222 offset:384
    v_mfma_f32_16x16x32_bf16 v[16:19], v[124:127], v[60:63], v[16:19]
    v_exp_f32 v205, v205
    ds_read_b128 v[56:59], v222 offset:256
    s_waitcnt lgkmcnt(9)
    v_mfma_f32_16x16x32_bf16 v[32:35], v[96:99], v[64:67], 0
    v_exp_f32 v206, v206
    ds_read_b128 v[60:63], v222 offset:192
    v_mfma_f32_16x16x32_bf16 v[32:35], v[100:103], v[68:71], v[32:35]
    v_exp_f32 v207, v207
    s_setprio 2
    ds_read_b128 v[64:67], v222 offset:448
    s_waitcnt lgkmcnt(9)
    v_mfma_f32_16x16x32_bf16 v[32:35], v[104:107], v[72:75], v[32:35]
    v_add_f32 v204, 1.0, v204
    ds_read_b128 v[68:71], v222 offset:320
    v_mfma_f32_16x16x32_bf16 v[32:35], v[108:111], v[76:79], v[32:35]
    v_add_f32 v205, 1.0, v205
    v_add_f32 v206, 1.0, v206
    ds_read_b128 v[72:75], v222 offset:640
    s_waitcnt lgkmcnt(9)
    v_mfma_f32_16x16x32_bf16 v[32:35], v[112:115], v[80:83], v[32:35]
    v_add_f32 v207, 1.0, v207
    ds_read_b128 v[76:79], v222 offset:512
    v_mfma_f32_16x16x32_bf16 v[32:35], v[116:119], v[84:87], v[32:35]
    v_rcp_f32 v204, v204
    ds_read_b128 v[80:83], v222 offset:768
    s_waitcnt lgkmcnt(9)
    v_mfma_f32_16x16x32_bf16 v[32:35], v[120:123], v[88:91], v[32:35]
    v_rcp_f32 v205, v205
    ds_read_b128 v[84:87], v222 offset:704
    v_mfma_f32_16x16x32_bf16 v[32:35], v[124:127], v[92:95], v[32:35]
    v_rcp_f32 v206, v206
    ds_read_b128 v[88:91], v222 offset:576
    s_waitcnt vmcnt(11) lgkmcnt(9)
    v_mfma_f32_16x16x32_bf16 v[4:7], v[128:131], v[48:51], 0
    v_rcp_f32 v207, v207
    ds_read_b128 v[92:95], v222 offset:832
    v_mfma_f32_16x16x32_bf16 v[8:11], v[128:131], v[52:55], 0
    v_cvt_pk_bf16_f32 v176, v0, v1
    ds_read_b128 v[48:51], v222 offset:1024
    s_waitcnt lgkmcnt(9)
    v_mfma_f32_16x16x32_bf16 v[12:15], v[128:131], v[56:59], 0
    v_cvt_pk_bf16_f32 v177, v2, v3
    ds_read_b128 v[52:55], v222 offset:1280
    s_waitcnt vmcnt(10)
    v_mfma_f32_16x16x32_bf16 v[4:7], v[132:135], v[60:63], v[4:7]
    v_mul_f32 v208, s63, v16
    v_mul_f32 v209, s63, v17
    ds_read_b128 v[56:59], v222 offset:1152
    s_waitcnt lgkmcnt(9)
    v_mfma_f32_16x16x32_bf16 v[8:11], v[132:135], v[64:67], v[8:11]
    v_mul_f32 v210, s63, v18
    ds_read_b128 v[60:63], v222 offset:1088
    v_mfma_f32_16x16x32_bf16 v[12:15], v[132:135], v[68:71], v[12:15]
    v_mul_f32 v211, s63, v19
    ds_read_b128 v[64:67], v222 offset:1344
    s_waitcnt vmcnt(9) lgkmcnt(9)
    v_mfma_f32_16x16x32_bf16 v[4:7], v[136:139], v[72:75], v[4:7]
    v_exp_f32 v208, v208
    ds_read_b128 v[68:71], v222 offset:1216
    v_mfma_f32_16x16x32_bf16 v[8:11], v[136:139], v[76:79], v[8:11]
    v_exp_f32 v209, v209
    ds_read_b128 v[72:75], v223 offset:128
    s_waitcnt lgkmcnt(9)
    v_mfma_f32_16x16x32_bf16 v[12:15], v[136:139], v[80:83], v[12:15]
    v_exp_f32 v210, v210
    ds_read_b128 v[76:79], v223 offset:384
    s_waitcnt vmcnt(8)
    v_mfma_f32_16x16x32_bf16 v[4:7], v[140:143], v[84:87], v[4:7]
    v_exp_f32 v211, v211
    ds_read_b128 v[80:83], v223 offset:256
    s_waitcnt lgkmcnt(9)
    v_mfma_f32_16x16x32_bf16 v[8:11], v[140:143], v[88:91], v[8:11]
    v_add_f32 v208, 1.0, v208
    ds_read_b128 v[84:87], v223 offset:192
    v_mfma_f32_16x16x32_bf16 v[12:15], v[140:143], v[92:95], v[12:15]
    v_add_f32 v209, 1.0, v209
    v_add_f32 v210, 1.0, v210
    ds_read_b128 v[88:91], v223 offset:448
    s_waitcnt vmcnt(7) lgkmcnt(9)
    v_mfma_f32_16x16x32_bf16 v[4:7], v[144:147], v[48:51], v[4:7]
    v_add_f32 v211, 1.0, v211
    s_setprio 1
    ds_read_b128 v[92:95], v223 offset:320
    v_mfma_f32_16x16x32_bf16 v[8:11], v[144:147], v[52:55], v[8:11]
    v_rcp_f32 v208, v208
    ds_read_b128 v[48:51], v223 offset:640
    s_waitcnt lgkmcnt(9)
    v_mfma_f32_16x16x32_bf16 v[12:15], v[144:147], v[56:59], v[12:15]
    v_rcp_f32 v209, v209
    ds_read_b128 v[52:55], v223 offset:512
    s_waitcnt vmcnt(6)
    v_mfma_f32_16x16x32_bf16 v[4:7], v[148:151], v[60:63], v[4:7]
    v_rcp_f32 v210, v210
    ds_read_b128 v[56:59], v223 offset:768
    s_waitcnt lgkmcnt(9)
    v_mfma_f32_16x16x32_bf16 v[8:11], v[148:151], v[64:67], v[8:11]
    v_rcp_f32 v211, v211
    ds_read_b128 v[60:63], v223 offset:704
    v_mfma_f32_16x16x32_bf16 v[12:15], v[148:151], v[68:71], v[12:15]
K2_PAD_T2:
    s_cbranch_execz K2_HOP
    v_cvt_pk_bf16_f32 v184, v16, v17
    ds_read_b128 v[64:67], v223 offset:576
    s_waitcnt vmcnt(5) lgkmcnt(9)
    v_mfma_f32_16x16x32_bf16 v[4:7], v[152:155], v[72:75], v[4:7]
    v_cvt_pk_bf16_f32 v185, v18, v19
    ds_read_b128 v[68:71], v223 offset:832
    v_mfma_f32_16x16x32_bf16 v[8:11], v[152:155], v[76:79], v[8:11]
    v_mul_f32 v212, s63, v32
    v_mul_f32 v213, s63, v33
    ds_read_b128 v[72:75], v223 offset:1024
    s_waitcnt lgkmcnt(9)
    v_mfma_f32_16x16x32_bf16 v[12:15], v[152:155], v[80:83], v[12:15]
    v_mul_f32 v214, s63, v34
    ds_read_b128 v[76:79], v223 offset:1280
    s_waitcnt vmcnt(4)
    v_mfma_f32_16x16x32_bf16 v[4:7], v[156:159], v[84:87], v[4:7]
    v_mul_f32 v215, s63, v35
    ds_read_b128 v[80:83], v223 offset:1152
    s_waitcnt lgkmcnt(9)
    v_mfma_f32_16x16x32_bf16 v[8:11], v[156:159], v[88:91], v[8:11]
    v_exp_f32 v212, v212
    ds_read_b128 v[84:87], v223 offset:1088
    v_mfma_f32_16x16x32_bf16 v[12:15], v[156:159], v[92:95], v[12:15]
    v_exp_f32 v213, v213
    ds_read_b128 v[88:91], v223 offset:1344
    s_waitcnt vmcnt(3) lgkmcnt(9)
    v_mfma_f32_16x16x32_bf16 v[4:7], v[160:163], v[48:51], v[4:7]
    v_exp_f32 v214, v214
    ds_read_b128 v[92:95], v223 offset:1216
    v_mfma_f32_16x16x32_bf16 v[8:11], v[160:163], v[52:55], v[8:11]
    v_exp_f32 v215, v215
    ds_read_b128 v[48:51], v222 offset:3200
    s_waitcnt lgkmcnt(9)
    v_mfma_f32_16x16x32_bf16 v[12:15], v[160:163], v[56:59], v[12:15]
    v_add_f32 v212, 1.0, v212
    ds_read_b128 v[52:55], v222 offset:3456
    s_waitcnt vmcnt(2)
    v_mfma_f32_16x16x32_bf16 v[4:7], v[164:167], v[60:63], v[4:7]
    v_add_f32 v213, 1.0, v213
    v_add_f32 v214, 1.0, v214
    ds_read_b128 v[56:59], v222 offset:3328
    s_waitcnt lgkmcnt(9)
    v_mfma_f32_16x16x32_bf16 v[8:11], v[164:167], v[64:67], v[8:11]
    v_add_f32 v215, 1.0, v215
    ds_read_b128 v[60:63], v222 offset:3264
    v_mfma_f32_16x16x32_bf16 v[12:15], v[164:167], v[68:71], v[12:15]
    v_rcp_f32 v212, v212
    s_setprio 0
    ds_read_b128 v[64:67], v222 offset:3520
    s_waitcnt vmcnt(1) lgkmcnt(9)
    v_mfma_f32_16x16x32_bf16 v[4:7], v[168:171], v[72:75], v[4:7]
    v_rcp_f32 v213, v213
    ds_read_b128 v[68:71], v222 offset:3392
    v_mfma_f32_16x16x32_bf16 v[8:11], v[168:171], v[76:79], v[8:11]
    v_rcp_f32 v214, v214
    ds_read_b128 v[72:75], v222 offset:3712
    s_waitcnt lgkmcnt(9)
    v_mfma_f32_16x16x32_bf16 v[12:15], v[168:171], v[80:83], v[12:15]
    v_rcp_f32 v215, v215
    ds_read_b128 v[76:79], v222 offset:3584
    s_waitcnt vmcnt(0)
    v_mfma_f32_16x16x32_bf16 v[4:7], v[172:175], v[84:87], v[4:7]
    v_cvt_pk_bf16_f32 v220, v32, v33
    ds_read_b128 v[80:83], v222 offset:3840
    s_waitcnt lgkmcnt(9)
    v_mfma_f32_16x16x32_bf16 v[8:11], v[172:175], v[88:91], v[8:11]
    v_cvt_pk_bf16_f32 v221, v34, v35
    ds_read_b128 v[84:87], v222 offset:3776
    v_mfma_f32_16x16x32_bf16 v[12:15], v[172:175], v[92:95], v[12:15]
    ds_read_b128 v[88:91], v222 offset:3648
    s_waitcnt lgkmcnt(9)
    v_mfma_f32_16x16x32_bf16 v[20:23], v[128:131], v[48:51], 0
    ds_read_b128 v[92:95], v222 offset:3904
    v_mfma_f32_16x16x32_bf16 v[24:27], v[128:131], v[52:55], 0
    ds_read_b128 v[48:51], v222 offset:4096
    s_waitcnt lgkmcnt(9)
    v_mfma_f32_16x16x32_bf16 v[28:31], v[128:131], v[56:59], 0
    s_barrier
    s_setprio 3
    ds_read_b128 v[52:55], v222 offset:4352
    v_mfma_f32_16x16x32_bf16 v[20:23], v[132:135], v[60:63], v[20:23]
    v_mul_f32 v4, v4, v204
    ds_read_b128 v[56:59], v222 offset:4224
    s_waitcnt lgkmcnt(9)
    v_mfma_f32_16x16x32_bf16 v[24:27], v[132:135], v[64:67], v[24:27]
    v_mul_f32 v5, v5, v205
    ds_read_b128 v[60:63], v222 offset:4160
    v_mfma_f32_16x16x32_bf16 v[28:31], v[132:135], v[68:71], v[28:31]
    v_mul_f32 v6, v6, v206
    ds_read_b128 v[64:67], v222 offset:4416
    s_waitcnt lgkmcnt(9)
    v_mfma_f32_16x16x32_bf16 v[20:23], v[136:139], v[72:75], v[20:23]
    v_mul_f32 v7, v7, v207
    ds_read_b128 v[68:71], v222 offset:4288
    v_mfma_f32_16x16x32_bf16 v[24:27], v[136:139], v[76:79], v[24:27]
    v_cvt_pk_bf16_f32 v178, v4, v5
    ds_read_b128 v[72:75], v223 offset:33408
    s_waitcnt lgkmcnt(9)
    v_mfma_f32_16x16x32_bf16 v[28:31], v[136:139], v[80:83], v[28:31]
    v_cvt_pk_bf16_f32 v179, v6, v7
    ds_read_b128 v[76:79], v223 offset:33664
    v_mfma_f32_16x16x32_bf16 v[20:23], v[140:143], v[84:87], v[20:23]
    v_mul_f32 v8, v8, v204
    ds_read_b128 v[80:83], v223 offset:33536
    s_waitcnt lgkmcnt(9)
    v_mfma_f32_16x16x32_bf16 v[24:27], v[140:143], v[88:91], v[24:27]
    v_mul_f32 v9, v9, v205
    ds_read_b128 v[84:87], v223 offset:33472
    v_mfma_f32_16x16x32_bf16 v[28:31], v[140:143], v[92:95], v[28:31]
    v_mul_f32 v10, v10, v206
    ds_read_b128 v[88:91], v223 offset:33728
    s_waitcnt lgkmcnt(9)
    v_mfma_f32_16x16x32_bf16 v[20:23], v[144:147], v[48:51], v[20:23]
    v_mul_f32 v11, v11, v207
    s_setprio 2
    ds_read_b128 v[92:95], v223 offset:33600
    v_mfma_f32_16x16x32_bf16 v[24:27], v[144:147], v[52:55], v[24:27]
    v_cvt_pk_bf16_f32 v180, v8, v9
    ds_read_b128 v[48:51], v223 offset:33920
    s_waitcnt lgkmcnt(9)
    v_mfma_f32_16x16x32_bf16 v[28:31], v[144:147], v[56:59], v[28:31]
    v_cvt_pk_bf16_f32 v181, v10, v11
    ds_read_b128 v[52:55], v223 offset:33792
    v_mfma_f32_16x16x32_bf16 v[20:23], v[148:151], v[60:63], v[20:23]
    v_mul_f32 v12, v12, v204
    ds_read_b128 v[56:59], v223 offset:34048
    s_waitcnt lgkmcnt(9)
    v_mfma_f32_16x16x32_bf16 v[24:27], v[148:151], v[64:67], v[24:27]
    v_mul_f32 v13, v13, v205
    ds_read_b128 v[60:63], v223 offset:33984
    v_mfma_f32_16x16x32_bf16 v[28:31], v[148:151], v[68:71], v[28:31]
    v_mul_f32 v14, v14, v206
    ds_read_b128 v[64:67], v223 offset:33856
    s_waitcnt lgkmcnt(9)
    v_mfma_f32_16x16x32_bf16 v[20:23], v[152:155], v[72:75], v[20:23]
    v_mul_f32 v15, v15, v207
    ds_read_b128 v[68:71], v223 offset:34112
    v_mfma_f32_16x16x32_bf16 v[24:27], v[152:155], v[76:79], v[24:27]
    v_cvt_pk_bf16_f32 v182, v12, v13
    ds_read_b128 v[72:75], v223 offset:34304
    s_waitcnt lgkmcnt(9)
    v_mfma_f32_16x16x32_bf16 v[28:31], v[152:155], v[80:83], v[28:31]
    v_cvt_pk_bf16_f32 v183, v14, v15
    ds_read_b128 v[76:79], v223 offset:34560
    v_mfma_f32_16x16x32_bf16 v[20:23], v[156:159], v[84:87], v[20:23]
    ds_write_b64 v254, v[176:177] offset:0
    ds_write_b64 v254, v[178:179] offset:256
    ds_write_b64 v254, v[180:181] offset:512
    ds_write_b64 v254, v[182:183] offset:768
    ds_write_b64 v255, v[220:221] offset:0
    ds_read_b128 v[80:83], v223 offset:34432
    s_waitcnt lgkmcnt(14)
    v_mfma_f32_16x16x32_bf16 v[24:27], v[156:159], v[88:91], v[24:27]
    ds_read_b128 v[84:87], v223 offset:34368
    v_mfma_f32_16x16x32_bf16 v[28:31], v[156:159], v[92:95], v[28:31]
    s_setprio 1
    ds_read_b128 v[88:91], v223 offset:34624
    s_waitcnt lgkmcnt(14)
    v_mfma_f32_16x16x32_bf16 v[20:23], v[160:163], v[48:51], v[20:23]
    ds_read_b128 v[92:95], v223 offset:34496
    v_mfma_f32_16x16x32_bf16 v[24:27], v[160:163], v[52:55], v[24:27]
    ds_read_b128 v[48:51], v247 offset:6272
    s_waitcnt lgkmcnt(14)
    v_mfma_f32_16x16x32_bf16 v[28:31], v[160:163], v[56:59], v[28:31]
    ds_read_b128 v[52:55], v232 offset:6528
    v_mfma_f32_16x16x32_bf16 v[20:23], v[164:167], v[60:63], v[20:23]
    ds_read_b128 v[56:59], v247 offset:6336
    s_waitcnt lgkmcnt(14)
    v_mfma_f32_16x16x32_bf16 v[24:27], v[164:167], v[64:67], v[24:27]
    ds_read_b128 v[60:63], v232 offset:6592
    v_mfma_f32_16x16x32_bf16 v[28:31], v[164:167], v[68:71], v[28:31]
    ds_read_b128 v[64:67], v247 offset:6784
    s_waitcnt lgkmcnt(14)
    v_mfma_f32_16x16x32_bf16 v[20:23], v[168:171], v[72:75], v[20:23]
    ds_read_b128 v[68:71], v232 offset:6656
    v_mfma_f32_16x16x32_bf16 v[24:27], v[168:171], v[76:79], v[24:27]
    ds_read_b128 v[72:75], v247 offset:6848
    s_waitcnt lgkmcnt(9)
    v_mfma_f32_16x16x32_bf16 v[28:31], v[168:171], v[80:83], v[28:31]
    ds_read_b128 v[76:79], v232 offset:6720
    v_mfma_f32_16x16x32_bf16 v[20:23], v[172:175], v[84:87], v[20:23]
    s_setprio 0
    ds_read_b128 v[80:83], v247 offset:7168
    s_waitcnt lgkmcnt(9)
    v_mfma_f32_16x16x32_bf16 v[24:27], v[172:175], v[88:91], v[24:27]
    ds_read_b128 v[84:87], v232 offset:7424
    v_mfma_f32_16x16x32_bf16 v[28:31], v[172:175], v[92:95], v[28:31]
    ds_read_b128 v[88:91], v247 offset:7232
    s_waitcnt lgkmcnt(9)
    v_mfma_f32_16x16x32_bf16 v[36:39], v[128:131], v[48:51], 0
    ds_read_b128 v[92:95], v232 offset:7488
    v_mfma_f32_16x16x32_bf16 v[40:43], v[128:131], v[52:55], 0
    ds_read_b128 v[48:51], v248 offset:128
    s_waitcnt lgkmcnt(9)
    v_mfma_f32_16x16x32_bf16 v[36:39], v[132:135], v[56:59], v[36:39]
    s_barrier
    ds_read_b128 v[192:195], v228 offset:0
    ds_read_b128 v[196:199], v228 offset:1536
    s_setprio 3
    ds_read_b128 v[52:55], v225 offset:384
    v_mfma_f32_16x16x32_bf16 v[40:43], v[132:135], v[60:63], v[40:43]
    v_mul_f32 v20, v20, v208
    v_mul_f32 v21, v21, v209
    ds_read_b128 v[56:59], v248 offset:192
    s_waitcnt lgkmcnt(11)
    v_mfma_f32_16x16x32_bf16 v[36:39], v[136:139], v[64:67], v[36:39]
    v_mul_f32 v22, v22, v210
    ds_read_b128 v[60:63], v225 offset:448
    v_mfma_f32_16x16x32_bf16 v[40:43], v[136:139], v[68:71], v[40:43]
    v_mul_f32 v23, v23, v211
    ds_read_b128 v[64:67], v248 offset:640
    s_waitcnt lgkmcnt(11)
    v_mfma_f32_16x16x32_bf16 v[36:39], v[140:143], v[72:75], v[36:39]
    v_cvt_pk_bf16_f32 v186, v20, v21
    ds_read_b128 v[68:71], v225 offset:512
    v_mfma_f32_16x16x32_bf16 v[40:43], v[140:143], v[76:79], v[40:43]
    v_cvt_pk_bf16_f32 v187, v22, v23
    ds_read_b128 v[72:75], v248 offset:704
    s_waitcnt lgkmcnt(11)
    v_mfma_f32_16x16x32_bf16 v[36:39], v[144:147], v[80:83], v[36:39]
    v_mul_f32 v24, v24, v208
    v_mul_f32 v25, v25, v209
    s_waitcnt lgkmcnt(6)
    buffer_store_dwordx4 v[192:195], v229, s[12:15], s40 offen sc1
    buffer_store_dwordx4 v[196:199], v229, s[12:15], s41 offen sc1
    s_setprio 2
    ds_read_b128 v[76:79], v225 offset:576
    v_mfma_f32_16x16x32_bf16 v[40:43], v[144:147], v[84:87], v[40:43]
    v_mul_f32 v26, v26, v210
    ds_read_b128 v[80:83], v248 offset:1024
    v_mfma_f32_16x16x32_bf16 v[36:39], v[148:151], v[88:91], v[36:39]
    v_mul_f32 v27, v27, v211
    ds_read_b128 v[84:87], v225 offset:1280
    v_mfma_f32_16x16x32_bf16 v[40:43], v[148:151], v[92:95], v[40:43]
    v_cvt_pk_bf16_f32 v188, v24, v25
    ds_read_b128 v[88:91], v248 offset:1088
    s_waitcnt lgkmcnt(9)
    v_mfma_f32_16x16x32_bf16 v[36:39], v[152:155], v[48:51], v[36:39]
    v_cvt_pk_bf16_f32 v189, v26, v27
    ds_read_b128 v[92:95], v225 offset:1344
    v_mfma_f32_16x16x32_bf16 v[40:43], v[152:155], v[52:55], v[40:43]
    v_mul_f32 v28, v28, v208
    v_mul_f32 v29, v29, v209
    s_waitcnt lgkmcnt(8)
    v_mfma_f32_16x16x32_bf16 v[36:39], v[156:159], v[56:59], v[36:39]
    v_mul_f32 v30, v30, v210
    v_mfma_f32_16x16x32_bf16 v[40:43], v[156:159], v[60:63], v[40:43]
    v_mul_f32 v31, v31, v211
    s_setprio 1
    s_waitcnt lgkmcnt(6)
    v_mfma_f32_16x16x32_bf16 v[36:39], v[160:163], v[64:67], v[36:39]
    v_cvt_pk_bf16_f32 v190, v28, v29
    v_mfma_f32_16x16x32_bf16 v[40:43], v[160:163], v[68:71], v[40:43]
    v_cvt_pk_bf16_f32 v191, v30, v31
    s_waitcnt lgkmcnt(4)
    v_mfma_f32_16x16x32_bf16 v[36:39], v[164:167], v[72:75], v[36:39]
    ds_write_b64 v254, v[184:185] offset:3072
    ds_write_b64 v254, v[186:187] offset:3328
    ds_write_b64 v254, v[188:189] offset:3584
    ds_write_b64 v254, v[190:191] offset:3840
    v_mfma_f32_16x16x32_bf16 v[40:43], v[164:167], v[76:79], v[40:43]
    s_waitcnt lgkmcnt(6)
    v_mfma_f32_16x16x32_bf16 v[36:39], v[168:171], v[80:83], v[36:39]
    v_mfma_f32_16x16x32_bf16 v[40:43], v[168:171], v[84:87], v[40:43]
    s_setprio 0
    s_waitcnt lgkmcnt(4)
    v_mfma_f32_16x16x32_bf16 v[36:39], v[172:175], v[88:91], v[36:39]
    v_mfma_f32_16x16x32_bf16 v[40:43], v[172:175], v[92:95], v[40:43]
    s_nop 6
    v_mul_f32 v36, v36, v212
    v_mul_f32 v37, v37, v213
    v_mul_f32 v38, v38, v214
    v_mul_f32 v39, v39, v215
    v_cvt_pk_bf16_f32 v178, v36, v37
    v_cvt_pk_bf16_f32 v179, v38, v39
    v_mul_f32 v40, v40, v212
    v_mul_f32 v41, v41, v213
    v_mul_f32 v42, v42, v214
    v_mul_f32 v43, v43, v215
    v_cvt_pk_bf16_f32 v180, v40, v41
    v_cvt_pk_bf16_f32 v181, v42, v43
    ds_write_b64 v246, v[178:179] offset:256
    ds_write_b64 v255, v[180:181] offset:512
    s_waitcnt lgkmcnt(0)
    s_barrier
    ds_read_b128 v[192:195], v228 offset:3072
    ds_read_b128 v[196:199], v228 offset:4608
    ds_read_b128 v[200:203], v249
    s_waitcnt lgkmcnt(1)
    buffer_store_dwordx4 v[192:195], v229, s[12:15], s42 offen sc1
    buffer_store_dwordx4 v[196:199], v229, s[12:15], s43 offen sc1
K2_LASTROW:
    s_add_u32 s59, s20, 32
    s_cmp_ge_u32 s59, s22
    s_cbranch_scc1 K2_FIN
    s_waitcnt lgkmcnt(0)
    buffer_store_dwordx4 v[200:203], v229, s[12:15], s44 offen sc1
K2_FIN:
    s_endpgm
K2_MULTI:
    ds_read_b128 v[48:51], v222 offset:0
    ds_read_b128 v[52:55], v222 offset:64
    ds_read_b128 v[56:59], v222 offset:896
    ds_read_b128 v[60:63], v222 offset:960
    ds_read_b128 v[64:67], v223 offset:0
    ds_read_b128 v[68:71], v223 offset:64
    ds_read_b128 v[72:75], v223 offset:896
    ds_read_b128 v[76:79], v223 offset:960
    ds_read_b128 v[80:83], v222 offset:3072
    ds_read_b128 v[84:87], v222 offset:3136
    ds_read_b128 v[88:91], v222 offset:3968
    s_waitcnt vmcnt(19) lgkmcnt(9)
    v_mfma_f32_16x16x32_bf16 v[0:3], v[96:99], v[48:51], 0
    ds_read_b128 v[92:95], v222 offset:4032
    s_waitcnt vmcnt(18)
    v_mfma_f32_16x16x32_bf16 v[0:3], v[100:103], v[52:55], v[0:3]
    ds_read_b128 v[48:51], v223 offset:33280
    s_waitcnt vmcnt(17) lgkmcnt(9)
    v_mfma_f32_16x16x32_bf16 v[0:3], v[104:107], v[56:59], v[0:3]
    ds_read_b128 v[52:55], v223 offset:33344
    s_waitcnt vmcnt(16)
    v_mfma_f32_16x16x32_bf16 v[0:3], v[108:111], v[60:63], v[0:3]
    ds_read_b128 v[56:59], v223 offset:34176
    s_waitcnt vmcnt(15) lgkmcnt(9)
    v_mfma_f32_16x16x32_bf16 v[0:3], v[112:115], v[64:67], v[0:3]
    ds_read_b128 v[60:63], v223 offset:34240
    s_waitcnt vmcnt(14)
    v_mfma_f32_16x16x32_bf16 v[0:3], v[116:119], v[68:71], v[0:3]
    ds_read_b128 v[64:67], v232 offset:6144
    s_waitcnt vmcnt(13) lgkmcnt(9)
    v_mfma_f32_16x16x32_bf16 v[0:3], v[120:123], v[72:75], v[0:3]
    ds_read_b128 v[68:71], v232 offset:6208
    s_waitcnt vmcnt(12)
    v_mfma_f32_16x16x32_bf16 v[0:3], v[124:127], v[76:79], v[0:3]
    ds_read_b128 v[72:75], v232 offset:7040
    s_waitcnt lgkmcnt(9)
    v_mfma_f32_16x16x32_bf16 v[16:19], v[96:99], v[80:83], 0
    ds_read_b128 v[76:79], v232 offset:7104
    v_mfma_f32_16x16x32_bf16 v[16:19], v[100:103], v[84:87], v[16:19]
    ds_read_b128 v[80:83], v225 offset:0
    s_waitcnt lgkmcnt(9)
    v_mfma_f32_16x16x32_bf16 v[16:19], v[104:107], v[88:91], v[16:19]
    ds_read_b128 v[84:87], v225 offset:64
    v_mfma_f32_16x16x32_bf16 v[16:19], v[108:111], v[92:95], v[16:19]
    ds_read_b128 v[88:91], v225 offset:896
    s_waitcnt lgkmcnt(9)
    v_mfma_f32_16x16x32_bf16 v[16:19], v[112:115], v[48:51], v[16:19]
    ds_read_b128 v[92:95], v225 offset:960
    v_mfma_f32_16x16x32_bf16 v[16:19], v[116:119], v[52:55], v[16:19]
    ds_read_b128 v[48:51], v222 offset:128
    s_waitcnt lgkmcnt(9)
    v_mfma_f32_16x16x32_bf16 v[16:19], v[120:123], v[56:59], v[16:19]
    ds_read_b128 v[52:55], v222 offset:384
    v_mfma_f32_16x16x32_bf16 v[16:19], v[124:127], v[60:63], v[16:19]
    ds_read_b128 v[56:59], v222 offset:256
    s_waitcnt lgkmcnt(9)
    v_mfma_f32_16x16x32_bf16 v[32:35], v[96:99], v[64:67], 0
    ds_read_b128 v[60:63], v222 offset:192
    v_mfma_f32_16x16x32_bf16 v[32:35], v[100:103], v[68:71], v[32:35]
    ds_read_b128 v[64:67], v222 offset:448
    s_waitcnt lgkmcnt(9)
    v_mfma_f32_16x16x32_bf16 v[32:35], v[104:107], v[72:75], v[32:35]
    ds_read_b128 v[68:71], v222 offset:320
    v_mfma_f32_16x16x32_bf16 v[32:35], v[108:111], v[76:79], v[32:35]
    ds_read_b128 v[72:75], v222 offset:640
    s_waitcnt lgkmcnt(9)
    v_mfma_f32_16x16x32_bf16 v[32:35], v[112:115], v[80:83], v[32:35]
    ds_read_b128 v[76:79], v222 offset:512
    v_mfma_f32_16x16x32_bf16 v[32:35], v[116:119], v[84:87], v[32:35]
    ds_read_b128 v[80:83], v222 offset:768
    s_waitcnt lgkmcnt(9)
    v_mfma_f32_16x16x32_bf16 v[32:35], v[120:123], v[88:91], v[32:35]
    ds_read_b128 v[84:87], v222 offset:704
    v_mfma_f32_16x16x32_bf16 v[32:35], v[124:127], v[92:95], v[32:35]
    ds_read_b128 v[88:91], v222 offset:576
    s_waitcnt vmcnt(11) lgkmcnt(9)
    v_mfma_f32_16x16x32_bf16 v[4:7], v[128:131], v[48:51], 0
    ds_read_b128 v[92:95], v222 offset:832
    v_mfma_f32_16x16x32_bf16 v[8:11], v[128:131], v[52:55], 0
    ds_read_b128 v[48:51], v222 offset:1024
    s_waitcnt lgkmcnt(9)
    v_mfma_f32_16x16x32_bf16 v[12:15], v[128:131], v[56:59], 0
    ds_read_b128 v[52:55], v222 offset:1280
    s_waitcnt vmcnt(10)
    v_mfma_f32_16x16x32_bf16 v[4:7], v[132:135], v[60:63], v[4:7]
    ds_read_b128 v[56:59], v222 offset:1152
    s_waitcnt lgkmcnt(9)
    v_mfma_f32_16x16x32_bf16 v[8:11], v[132:135], v[64:67], v[8:11]
    ds_read_b128 v[60:63], v222 offset:1088
    v_mfma_f32_16x16x32_bf16 v[12:15], v[132:135], v[68:71], v[12:15]
    ds_read_b128 v[64:67], v222 offset:1344
    s_waitcnt vmcnt(9) lgkmcnt(9)
    v_mfma_f32_16x16x32_bf16 v[4:7], v[136:139], v[72:75], v[4:7]
    ds_read_b128 v[68:71], v222 offset:1216
    v_mfma_f32_16x16x32_bf16 v[8:11], v[136:139], v[76:79], v[8:11]
    ds_read_b128 v[72:75], v223 offset:128
    s_waitcnt lgkmcnt(9)
    v_mfma_f32_16x16x32_bf16 v[12:15], v[136:139], v[80:83], v[12:15]
    ds_read_b128 v[76:79], v223 offset:384
    s_waitcnt vmcnt(8)
    v_mfma_f32_16x16x32_bf16 v[4:7], v[140:143], v[84:87], v[4:7]
    ds_read_b128 v[80:83], v223 offset:256
    s_waitcnt lgkmcnt(9)
    v_mfma_f32_16x16x32_bf16 v[8:11], v[140:143], v[88:91], v[8:11]
    ds_read_b128 v[84:87], v223 offset:192
    v_mfma_f32_16x16x32_bf16 v[12:15], v[140:143], v[92:95], v[12:15]
    ds_read_b128 v[88:91], v223 offset:448
    s_waitcnt vmcnt(7) lgkmcnt(9)
    v_mfma_f32_16x16x32_bf16 v[4:7], v[144:147], v[48:51], v[4:7]
    ds_read_b128 v[92:95], v223 offset:320
    v_mfma_f32_16x16x32_bf16 v[8:11], v[144:147], v[52:55], v[8:11]
    ds_read_b128 v[48:51], v223 offset:640
    s_waitcnt lgkmcnt(9)
    v_mfma_f32_16x16x32_bf16 v[12:15], v[144:147], v[56:59], v[12:15]
    ds_read_b128 v[52:55], v223 offset:512
    s_waitcnt vmcnt(6)
    v_mfma_f32_16x16x32_bf16 v[4:7], v[148:151], v[60:63], v[4:7]
    ds_read_b128 v[56:59], v223 offset:768
    s_waitcnt lgkmcnt(9)
    v_mfma_f32_16x16x32_bf16 v[8:11], v[148:151], v[64:67], v[8:11]
    ds_read_b128 v[60:63], v223 offset:704
    v_mfma_f32_16x16x32_bf16 v[12:15], v[148:151], v[68:71], v[12:15]
    ds_read_b128 v[64:67], v223 offset:576
    s_waitcnt vmcnt(5) lgkmcnt(9)
    v_mfma_f32_16x16x32_bf16 v[4:7], v[152:155], v[72:75], v[4:7]
    ds_read_b128 v[68:71], v223 offset:832
    v_mfma_f32_16x16x32_bf16 v[8:11], v[152:155], v[76:79], v[8:11]
    ds_read_b128 v[72:75], v223 offset:1024
    s_waitcnt lgkmcnt(9)
    v_mfma_f32_16x16x32_bf16 v[12:15], v[152:155], v[80:83], v[12:15]
    ds_read_b128 v[76:79], v223 offset:1280
    s_waitcnt vmcnt(4)
    v_mfma_f32_16x16x32_bf16 v[4:7], v[156:159], v[84:87], v[4:7]
    ds_read_b128 v[80:83], v223 offset:1152
    s_waitcnt lgkmcnt(9)
    v_mfma_f32_16x16x32_bf16 v[8:11], v[156:159], v[88:91], v[8:11]
    ds_read_b128 v[84:87], v223 offset:1088
    v_mfma_f32_16x16x32_bf16 v[12:15], v[156:159], v[92:95], v[12:15]
    ds_read_b128 v[88:91], v223 offset:1344
    s_waitcnt vmcnt(3) lgkmcnt(9)
    v_mfma_f32_16x16x32_bf16 v[4:7], v[160:163], v[48:51], v[4:7]
    ds_read_b128 v[92:95], v223 offset:1216
    v_mfma_f32_16x16x32_bf16 v[8:11], v[160:163], v[52:55], v[8:11]
    ds_read_b128 v[48:51], v222 offset:3200
    s_waitcnt lgkmcnt(9)
    v_mfma_f32_16x16x32_bf16 v[12:15], v[160:163], v[56:59], v[12:15]
    ds_read_b128 v[52:55], v222 offset:3456
    s_waitcnt vmcnt(2)
    v_mfma_f32_16x16x32_bf16 v[4:7], v[164:167], v[60:63], v[4:7]
    ds_read_b128 v[56:59], v222 offset:3328
    s_waitcnt lgkmcnt(9)
    v_mfma_f32_16x16x32_bf16 v[8:11], v[164:167], v[64:67], v[8:11]
    ds_read_b128 v[60:63], v222 offset:3264
    v_mfma_f32_16x16x32_bf16 v[12:15], v[164:167], v[68:71], v[12:15]
    ds_read_b128 v[64:67], v222 offset:3520
    s_waitcnt vmcnt(1) lgkmcnt(9)
    v_mfma_f32_16x16x32_bf16 v[4:7], v[168:171], v[72:75], v[4:7]
    ds_read_b128 v[68:71], v222 offset:3392
    v_mfma_f32_16x16x32_bf16 v[8:11], v[168:171], v[76:79], v[8:11]
    ds_read_b128 v[72:75], v222 offset:3712
    s_waitcnt lgkmcnt(9)
    v_mfma_f32_16x16x32_bf16 v[12:15], v[168:171], v[80:83], v[12:15]
    ds_read_b128 v[76:79], v222 offset:3584
    s_waitcnt vmcnt(0)
    v_mfma_f32_16x16x32_bf16 v[4:7], v[172:175], v[84:87], v[4:7]
    ds_read_b128 v[80:83], v222 offset:3840
    s_waitcnt lgkmcnt(9)
    v_mfma_f32_16x16x32_bf16 v[8:11], v[172:175], v[88:91], v[8:11]
    ds_read_b128 v[84:87], v222 offset:3776
    v_mfma_f32_16x16x32_bf16 v[12:15], v[172:175], v[92:95], v[12:15]
    ds_read_b128 v[88:91], v222 offset:3648
    s_waitcnt lgkmcnt(9)
    v_mfma_f32_16x16x32_bf16 v[20:23], v[128:131], v[48:51], 0
    ds_read_b128 v[92:95], v222 offset:3904
    v_mfma_f32_16x16x32_bf16 v[24:27], v[128:131], v[52:55], 0
    ds_read_b128 v[48:51], v222 offset:4096
    s_waitcnt lgkmcnt(9)
    v_mfma_f32_16x16x32_bf16 v[28:31], v[128:131], v[56:59], 0
    ds_read_b128 v[52:55], v222 offset:4352
    v_mfma_f32_16x16x32_bf16 v[20:23], v[132:135], v[60:63], v[20:23]
    ds_read_b128 v[56:59], v222 offset:4224
    s_waitcnt lgkmcnt(9)
    v_mfma_f32_16x16x32_bf16 v[24:27], v[132:135], v[64:67], v[24:27]
    ds_read_b128 v[60:63], v222 offset:4160
    v_mfma_f32_16x16x32_bf16 v[28:31], v[132:135], v[68:71], v[28:31]
    ds_read_b128 v[64:67], v222 offset:4416
    s_waitcnt lgkmcnt(9)
    v_mfma_f32_16x16x32_bf16 v[20:23], v[136:139], v[72:75], v[20:23]
    ds_read_b128 v[68:71], v222 offset:4288
    v_mfma_f32_16x16x32_bf16 v[24:27], v[136:139], v[76:79], v[24:27]
    ds_read_b128 v[72:75], v223 offset:33408
    s_waitcnt lgkmcnt(9)
    v_mfma_f32_16x16x32_bf16 v[28:31], v[136:139], v[80:83], v[28:31]
    ds_read_b128 v[76:79], v223 offset:33664
    v_mfma_f32_16x16x32_bf16 v[20:23], v[140:143], v[84:87], v[20:23]
    ds_read_b128 v[80:83], v223 offset:33536
    s_waitcnt lgkmcnt(9)
    v_mfma_f32_16x16x32_bf16 v[24:27], v[140:143], v[88:91], v[24:27]
    ds_read_b128 v[84:87], v223 offset:33472
    v_mfma_f32_16x16x32_bf16 v[28:31], v[140:143], v[92:95], v[28:31]
    ds_read_b128 v[88:91], v223 offset:33728
    s_waitcnt lgkmcnt(9)
    v_mfma_f32_16x16x32_bf16 v[20:23], v[144:147], v[48:51], v[20:23]
    ds_read_b128 v[92:95], v223 offset:33600
    v_mfma_f32_16x16x32_bf16 v[24:27], v[144:147], v[52:55], v[24:27]
    ds_read_b128 v[48:51], v223 offset:33920
    s_waitcnt lgkmcnt(9)
    v_mfma_f32_16x16x32_bf16 v[28:31], v[144:147], v[56:59], v[28:31]
    ds_read_b128 v[52:55], v223 offset:33792
    v_mfma_f32_16x16x32_bf16 v[20:23], v[148:151], v[60:63], v[20:23]
    ds_read_b128 v[56:59], v223 offset:34048
    s_waitcnt lgkmcnt(9)
    v_mfma_f32_16x16x32_bf16 v[24:27], v[148:151], v[64:67], v[24:27]
    ds_read_b128 v[60:63], v223 offset:33984
    v_mfma_f32_16x16x32_bf16 v[28:31], v[148:151], v[68:71], v[28:31]
    ds_read_b128 v[64:67], v223 offset:33856
    s_waitcnt lgkmcnt(9)
    v_mfma_f32_16x16x32_bf16 v[20:23], v[152:155], v[72:75], v[20:23]
    ds_read_b128 v[68:71], v223 offset:34112
    v_mfma_f32_16x16x32_bf16 v[24:27], v[152:155], v[76:79], v[24:27]
    ds_read_b128 v[72:75], v223 offset:34304
    s_waitcnt lgkmcnt(9)
    v_mfma_f32_16x16x32_bf16 v[28:31], v[152:155], v[80:83], v[28:31]
    ds_read_b128 v[76:79], v223 offset:34560
    v_mfma_f32_16x16x32_bf16 v[20:23], v[156:159], v[84:87], v[20:23]
    ds_read_b128 v[80:83], v223 offset:34432
    s_waitcnt lgkmcnt(9)
    v_mfma_f32_16x16x32_bf16 v[24:27], v[156:159], v[88:91], v[24:27]
    ds_read_b128 v[84:87], v223 offset:34368
    v_mfma_f32_16x16x32_bf16 v[28:31], v[156:159], v[92:95], v[28:31]
    ds_read_b128 v[88:91], v223 offset:34624
    s_waitcnt lgkmcnt(9)
    v_mfma_f32_16x16x32_bf16 v[20:23], v[160:163], v[48:51], v[20:23]
    ds_read_b128 v[92:95], v223 offset:34496
    v_mfma_f32_16x16x32_bf16 v[24:27], v[160:163], v[52:55], v[24:27]
    ds_read_b128 v[48:51], v247 offset:6272
    s_waitcnt lgkmcnt(9)
    v_mfma_f32_16x16x32_bf16 v[28:31], v[160:163], v[56:59], v[28:31]
    ds_read_b128 v[52:55], v232 offset:6528
    v_mfma_f32_16x16x32_bf16 v[20:23], v[164:167], v[60:63], v[20:23]
    ds_read_b128 v[56:59], v247 offset:6336
    s_waitcnt lgkmcnt(9)
    v_mfma_f32_16x16x32_bf16 v[24:27], v[164:167], v[64:67], v[24:27]
    ds_read_b128 v[60:63], v232 offset:6592
    v_mfma_f32_16x16x32_bf16 v[28:31], v[164:167], v[68:71], v[28:31]
    ds_read_b128 v[64:67], v247 offset:6784
    s_waitcnt lgkmcnt(9)
    v_mfma_f32_16x16x32_bf16 v[20:23], v[168:171], v[72:75], v[20:23]
    ds_read_b128 v[68:71], v232 offset:6656
    v_mfma_f32_16x16x32_bf16 v[24:27], v[168:171], v[76:79], v[24:27]
    ds_read_b128 v[72:75], v247 offset:6848
    s_waitcnt lgkmcnt(9)
    v_mfma_f32_16x16x32_bf16 v[28:31], v[168:171], v[80:83], v[28:31]
    ds_read_b128 v[76:79], v232 offset:6720
    v_mfma_f32_16x16x32_bf16 v[20:23], v[172:175], v[84:87], v[20:23]
    ds_read_b128 v[80:83], v247 offset:7168
    s_waitcnt lgkmcnt(9)
    v_mfma_f32_16x16x32_bf16 v[24:27], v[172:175], v[88:91], v[24:27]
    ds_read_b128 v[84:87], v232 offset:7424
    v_mfma_f32_16x16x32_bf16 v[28:31], v[172:175], v[92:95], v[28:31]
    ds_read_b128 v[88:91], v247 offset:7232
    s_waitcnt lgkmcnt(9)
    v_mfma_f32_16x16x32_bf16 v[36:39], v[128:131], v[48:51], 0
    ds_read_b128 v[92:95], v232 offset:7488
    v_mfma_f32_16x16x32_bf16 v[40:43], v[128:131], v[52:55], 0
    ds_read_b128 v[48:51], v248 offset:128
    s_waitcnt lgkmcnt(9)
    v_mfma_f32_16x16x32_bf16 v[36:39], v[132:135], v[56:59], v[36:39]
    ds_read_b128 v[52:55], v225 offset:384
    v_mfma_f32_16x16x32_bf16 v[40:43], v[132:135], v[60:63], v[40:43]
    ds_read_b128 v[56:59], v248 offset:192
    s_waitcnt lgkmcnt(9)
    v_mfma_f32_16x16x32_bf16 v[36:39], v[136:139], v[64:67], v[36:39]
    ds_read_b128 v[60:63], v225 offset:448
    v_mfma_f32_16x16x32_bf16 v[40:43], v[136:139], v[68:71], v[40:43]
    ds_read_b128 v[64:67], v248 offset:640
    s_waitcnt lgkmcnt(9)
    v_mfma_f32_16x16x32_bf16 v[36:39], v[140:143], v[72:75], v[36:39]
    ds_read_b128 v[68:71], v225 offset:512
    v_mfma_f32_16x16x32_bf16 v[40:43], v[140:143], v[76:79], v[40:43]
    ds_read_b128 v[72:75], v248 offset:704
    s_waitcnt lgkmcnt(9)
    v_mfma_f32_16x16x32_bf16 v[36:39], v[144:147], v[80:83], v[36:39]
    ds_read_b128 v[76:79], v225 offset:576
    v_mfma_f32_16x16x32_bf16 v[40:43], v[144:147], v[84:87], v[40:43]
    ds_read_b128 v[80:83], v248 offset:1024
    s_waitcnt lgkmcnt(9)
    v_mfma_f32_16x16x32_bf16 v[36:39], v[148:151], v[88:91], v[36:39]
    ds_read_b128 v[84:87], v225 offset:1280
    v_mfma_f32_16x16x32_bf16 v[40:43], v[148:151], v[92:95], v[40:43]
    ds_read_b128 v[88:91], v248 offset:1088
    s_waitcnt lgkmcnt(9)
    v_mfma_f32_16x16x32_bf16 v[36:39], v[152:155], v[48:51], v[36:39]
    ds_read_b128 v[92:95], v225 offset:1344
    v_mfma_f32_16x16x32_bf16 v[40:43], v[152:155], v[52:55], v[40:43]
    s_waitcnt lgkmcnt(8)
    v_mfma_f32_16x16x32_bf16 v[36:39], v[156:159], v[56:59], v[36:39]
    v_mfma_f32_16x16x32_bf16 v[40:43], v[156:159], v[60:63], v[40:43]
    s_waitcnt lgkmcnt(6)
    v_mfma_f32_16x16x32_bf16 v[36:39], v[160:163], v[64:67], v[36:39]
    v_mfma_f32_16x16x32_bf16 v[40:43], v[160:163], v[68:71], v[40:43]
    s_waitcnt lgkmcnt(4)
    v_mfma_f32_16x16x32_bf16 v[36:39], v[164:167], v[72:75], v[36:39]
    v_mfma_f32_16x16x32_bf16 v[40:43], v[164:167], v[76:79], v[40:43]
    s_waitcnt lgkmcnt(2)
    v_mfma_f32_16x16x32_bf16 v[36:39], v[168:171], v[80:83], v[36:39]
    v_mfma_f32_16x16x32_bf16 v[40:43], v[168:171], v[84:87], v[40:43]
    s_waitcnt lgkmcnt(0)
    v_mfma_f32_16x16x32_bf16 v[36:39], v[172:175], v[88:91], v[36:39]
    v_mfma_f32_16x16x32_bf16 v[40:43], v[172:175], v[92:95], v[40:43]
    s_lshl_b32 s60, s54, 9
    s_lshl_b32 s61, s20, 6
    s_add_u32 s60, s60, s61
    s_mul_i32 s60, s60, 192
    s_add_u32 s60, s60, 10485760
    v_mul_u32_u24 v227, 96, v252
    s_cmp_lg_u32 s28, 0
    s_cbranch_scc1 K2_NOACC
    buffer_load_dwordx4 v[48:51], v227, s[8:11], s60 offen offset:0
    buffer_load_dwordx4 v[52:55], v227, s[8:11], s60 offen offset:16
    buffer_load_dwordx4 v[56:59], v227, s[8:11], s60 offen offset:32
    buffer_load_dwordx4 v[60:63], v227, s[8:11], s60 offen offset:48
    buffer_load_dwordx4 v[64:67], v227, s[8:11], s60 offen offset:64
    buffer_load_dwordx4 v[68:71], v227, s[8:11], s60 offen offset:80
    buffer_load_dwordx4 v[72:75], v227, s[8:11], s60 offen offset:96
    buffer_load_dwordx4 v[76:79], v227, s[8:11], s60 offen offset:112
    buffer_load_dwordx4 v[80:83], v227, s[8:11], s60 offen offset:128
    buffer_load_dwordx4 v[84:87], v227, s[8:11], s60 offen offset:144
    buffer_load_dwordx4 v[88:91], v227, s[8:11], s60 offen offset:160
    s_waitcnt vmcnt(0)
    v_add_f32 v0, v0, v48
    v_add_f32 v1, v1, v49
    v_add_f32 v2, v2, v50
    v_add_f32 v3, v3, v51
    v_add_f32 v4, v4, v52
    v_add_f32 v5, v5, v53
    v_add_f32 v6, v6, v54
    v_add_f32 v7, v7, v55
    v_add_f32 v8, v8, v56
    v_add_f32 v9, v9, v57
    v_add_f32 v10, v10, v58
    v_add_f32 v11, v11, v59
    v_add_f32 v12, v12, v60
    v_add_f32 v13, v13, v61
    v_add_f32 v14, v14, v62
    v_add_f32 v15, v15, v63
    v_add_f32 v16, v16, v64
    v_add_f32 v17, v17, v65
    v_add_f32 v18, v18, v66
    v_add_f32 v19, v19, v67
    v_add_f32 v20, v20, v68
    v_add_f32 v21, v21, v69
    v_add_f32 v22, v22, v70
    v_add_f32 v23, v23, v71
    v_add_f32 v24, v24, v72
    v_add_f32 v25, v25, v73
    v_add_f32 v26, v26, v74
    v_add_f32 v27, v27, v75
    v_add_f32 v28, v28, v76
    v_add_f32 v29, v29, v77
    v_add_f32 v30, v30, v78
    v_add_f32 v31, v31, v79
    v_add_f32 v32, v32, v80
    v_add_f32 v33, v33, v81
    v_add_f32 v34, v34, v82
    v_add_f32 v35, v35, v83
    v_add_f32 v36, v36, v84
    v_add_f32 v37, v37, v85
    v_add_f32 v38, v38, v86
    v_add_f32 v39, v39, v87
    v_add_f32 v40, v40, v88
    v_add_f32 v41, v41, v89
    v_add_f32 v42, v42, v90
    v_add_f32 v43, v43, v91
K2_NOACC:
    s_barrier
    s_cmp_eq_u32 s55, 0
    s_cbranch_scc1 K2_SPILL
    s_bfe_u32 s60, s20, 0x10002
    s_lshl_b32 s60, s60, 4
    s_add_u32 s59, s59, s60
    v_add_u32 v228, s59, v229
    s_mul_i32 s60, s20, 2080
    s_add_u32 s60, s60, 65536
    v_add_u32 v249, s60, v229
    s_mov_b32 s63, 0xbfb8aa3b
    s_add_u32 s40, s20, s21
    s_lshl_b32 s40, s40, 10
    s_add_u32 s41, s40, 8192
    s_add_u32 s42, s40, 16384
    s_add_u32 s43, s40, 24576
    s_add_u32 s44, s40, 32768
    v_mul_f32 v204, s63, v0
    v_mul_f32 v205, s63, v1
    v_mul_f32 v206, s63, v2
    v_mul_f32 v207, s63, v3
    v_exp_f32 v204, v204
    v_exp_f32 v205, v205
    v_exp_f32 v206, v206
    v_exp_f32 v207, v207
    v_add_f32 v204, 1.0, v204
    v_add_f32 v205, 1.0, v205
    v_add_f32 v206, 1.0, v206
    v_add_f32 v207, 1.0, v207
    v_rcp_f32 v204, v204
    v_rcp_f32 v205, v205
    v_rcp_f32 v206, v206
    v_rcp_f32 v207, v207
    v_cvt_pk_bf16_f32 v176, v0, v1
    v_cvt_pk_bf16_f32 v177, v2, v3
    v_mul_f32 v4, v4, v204
    v_mul_f32 v5, v5, v205
    v_mul_f32 v6, v6, v206
    v_mul_f32 v7, v7, v207
    v_cvt_pk_bf16_f32 v178, v4, v5
    v_cvt_pk_bf16_f32 v179, v6, v7
    v_mul_f32 v8, v8, v204
    v_mul_f32 v9, v9, v205
    v_mul_f32 v10, v10, v206
    v_mul_f32 v11, v11, v207
    v_cvt_pk_bf16_f32 v180, v8, v9
    v_cvt_pk_bf16_f32 v181, v10, v11
    v_mul_f32 v12, v12, v204
    v_mul_f32 v13, v13, v205
    v_mul_f32 v14, v14, v206
    v_mul_f32 v15, v15, v207
    v_cvt_pk_bf16_f32 v182, v12, v13
    v_cvt_pk_bf16_f32 v183, v14, v15
    ds_write_b64 v254, v[176:177] offset:0
    ds_write_b64 v254, v[178:179] offset:256
    ds_write_b64 v254, v[180:181] offset:512
    ds_write_b64 v254, v[182:183] offset:768
    s_waitcnt lgkmcnt(0)
    s_barrier
    ds_read_b128 v[192:195], v228 offset:0
    ds_read_b128 v[196:199], v228 offset:1536
    s_waitcnt lgkmcnt(0)
    buffer_store_dwordx4 v[192:195], v229, s[12:15], s40 offen sc1
    buffer_store_dwordx4 v[196:199], v229, s[12:15], s41 offen sc1
    v_mul_f32 v208, s63, v16
    v_mul_f32 v209, s63, v17
    v_mul_f32 v210, s63, v18
    v_mul_f32 v211, s63, v19
    v_exp_f32 v208, v208
    v_exp_f32 v209, v209
    v_exp_f32 v210, v210
    v_exp_f32 v211, v211
    v_add_f32 v208, 1.0, v208
    v_add_f32 v209, 1.0, v209
    v_add_f32 v210, 1.0, v210
    v_add_f32 v211, 1.0, v211
    v_rcp_f32 v208, v208
    v_rcp_f32 v209, v209
    v_rcp_f32 v210, v210
    v_rcp_f32 v211, v211
    v_cvt_pk_bf16_f32 v184, v16, v17
    v_cvt_pk_bf16_f32 v185, v18, v19
    v_mul_f32 v20, v20, v208
    v_mul_f32 v21, v21, v209
    v_mul_f32 v22, v22, v210
    v_mul_f32 v23, v23, v211
    v_cvt_pk_bf16_f32 v186, v20, v21
    v_cvt_pk_bf16_f32 v187, v22, v23
    v_mul_f32 v24, v24, v208
    v_mul_f32 v25, v25, v209
    v_mul_f32 v26, v26, v210
    v_mul_f32 v27, v27, v211
    v_cvt_pk_bf16_f32 v188, v24, v25
    v_cvt_pk_bf16_f32 v189, v26, v27
    v_mul_f32 v28, v28, v208
    v_mul_f32 v29, v29, v209
    v_mul_f32 v30, v30, v210
    v_mul_f32 v31, v31, v211
    v_cvt_pk_bf16_f32 v190, v28, v29
    v_cvt_pk_bf16_f32 v191, v30, v31
    ds_write_b64 v254, v[184:185] offset:3072
    ds_write_b64 v254, v[186:187] offset:3328
    ds_write_b64 v254, v[188:189] offset:3584
    ds_write_b64 v254, v[190:191] offset:3840
    s_waitcnt lgkmcnt(0)
    s_barrier
    ds_read_b128 v[192:195], v228 offset:3072
    ds_read_b128 v[196:199], v228 offset:4608
    s_waitcnt lgkmcnt(0)
    buffer_store_dwordx4 v[192:195], v229, s[12:15], s42 offen sc1
    buffer_store_dwordx4 v[196:199], v229, s[12:15], s43 offen sc1
    v_mul_f32 v212, s63, v32
    v_mul_f32 v213, s63, v33
    v_mul_f32 v214, s63, v34
    v_mul_f32 v215, s63, v35
    v_exp_f32 v212, v212
    v_exp_f32 v213, v213
    v_exp_f32 v214, v214
    v_exp_f32 v215, v215
    v_add_f32 v212, 1.0, v212
    v_add_f32 v213, 1.0, v213
    v_add_f32 v214, 1.0, v214
    v_add_f32 v215, 1.0, v215
    v_rcp_f32 v212, v212
    v_rcp_f32 v213, v213
    v_rcp_f32 v214, v214
    v_rcp_f32 v215, v215
    v_cvt_pk_bf16_f32 v220, v32, v33
    v_cvt_pk_bf16_f32 v221, v34, v35
    v_mul_f32 v36, v36, v212
    v_mul_f32 v37, v37, v213
    v_mul_f32 v38, v38, v214
    v_mul_f32 v39, v39, v215
    v_cvt_pk_bf16_f32 v178, v36, v37
    v_cvt_pk_bf16_f32 v179, v38, v39
    v_mul_f32 v40, v40, v212
    v_mul_f32 v41, v41, v213
    v_mul_f32 v42, v42, v214
    v_mul_f32 v43, v43, v215
    v_cvt_pk_bf16_f32 v180, v40, v41
    v_cvt_pk_bf16_f32 v181, v42, v43
    ds_write_b64 v255, v[220:221] offset:0
    ds_write_b64 v246, v[178:179] offset:256
    ds_write_b64 v255, v[180:181] offset:512
    s_waitcnt lgkmcnt(0)
    s_barrier
    ds_read_b128 v[200:203], v249
    s_branch K2_LASTROW
K2_SPILL:
    buffer_store_dwordx4 v[0:3], v227, s[8:11], s60 offen offset:0
    buffer_store_dwordx4 v[4:7], v227, s[8:11], s60 offen offset:16
    buffer_store_dwordx4 v[8:11], v227, s[8:11], s60 offen offset:32
    buffer_store_dwordx4 v[12:15], v227, s[8:11], s60 offen offset:48
    buffer_store_dwordx4 v[16:19], v227, s[8:11], s60 offen offset:64
    buffer_store_dwordx4 v[20:23], v227, s[8:11], s60 offen offset:80
    buffer_store_dwordx4 v[24:27], v227, s[8:11], s60 offen offset:96
    buffer_store_dwordx4 v[28:31], v227, s[8:11], s60 offen offset:112
    buffer_store_dwordx4 v[32:35], v227, s[8:11], s60 offen offset:128
    buffer_store_dwordx4 v[36:39], v227, s[8:11], s60 offen offset:144
    buffer_store_dwordx4 v[40:43], v227, s[8:11], s60 offen offset:160
    s_mov_b32 s28, 0
    s_waitcnt vmcnt(0)
    s_cmp_lt_u32 s24, s25
    s_cbranch_scc1 K2_LOAD
    s_add_u32 s23, s23, 20
    s_branch K2_WINDOW
K2_WINDOW:
    s_mov_b32 s24, 0
    s_mov_b32 s25, 1
K2_LOAD:
    v_mbcnt_lo_u32_b32 v176, -1, 0
    v_mbcnt_hi_u32_b32 v176, -1, v176
    s_lshl_b32 s58, s20, 6
    v_add_u32 v177, s58, v176
    v_lshlrev_b32 v70, 4, v176
    s_mov_b32 s58, 7110656
    buffer_load_dwordx4 v[136:139], v70, s[8:11], s58 offen offset:0 sc1
    buffer_load_dwordx4 v[140:143], v70, s[8:11], s58 offen offset:1024 sc1
    s_mov_b32 s58, 7112704
    buffer_load_dwordx4 v[144:147], v70, s[8:11], s58 offen offset:0 sc1
    buffer_load_dwordx4 v[148:151], v70, s[8:11], s58 offen offset:1024 sc1
    s_mov_b32 s58, 7114752
    buffer_load_dwordx4 v[152:155], v70, s[8:11], s58 offen offset:0 sc1
    buffer_load_dwordx4 v[156:159], v70, s[8:11], s58 offen offset:1024 sc1
    s_mov_b32 s58, 7116800
    buffer_load_dwordx4 v[160:163], v70, s[8:11], s58 offen offset:0 sc1
    buffer_load_dwordx4 v[164:167], v70, s[8:11], s58 offen offset:1024 sc1
    s_mov_b32 s58, 7118848
    buffer_load_dwordx4 v[168:171], v70, s[8:11], s58 offen offset:0 sc1
    buffer_load_dwordx4 v[172:175], v70, s[8:11], s58 offen offset:1024 sc1
    v_and_b32 v76, 127, v177
    v_mov_b32 v80, -1
    v_mov_b32 v77, 0x3f803f80
    v_cmp_gt_u32 vcc, 24, v76
    v_lshlrev_b32 v78, 4, v76
    v_add_u32 v78, 65536, v78
    v_cndmask_b32 v80, v80, 0, vcc
    v_cmp_gt_u32 vcc, 6, v76
    v_add_u32 v79, 56160, v78
    s_nop 0
    v_cndmask_b32 v80, v80, v77, vcc
    v_cmp_gt_u32 vcc, 94, v76
    v_mov_b32 v81, v80
    v_mov_b32 v82, v80
    v_mov_b32 v83, v80
    s_mov_b64 s[56:57], vcc
    v_lshrrev_b32 v76, 7, v177
    v_mul_u32_u24 v76, 2080, v76
    v_add_u32 v78, v78, v76
    ds_write_b128 v78, v[80:83] offset:0
    ds_write_b128 v78, v[80:83] offset:8320
    ds_write_b128 v78, v[80:83] offset:16640
    ds_write_b128 v78, v[80:83] offset:24960
    ds_write_b128 v78, v[80:83] offset:33280
    ds_write_b128 v78, v[80:83] offset:41600
    ds_write_b128 v78, v[80:83] offset:49920
    v_add_u32 v78, 58240, v78
    ds_write_b128 v78, v[80:83] offset:0
    ds_write_b128 v78, v[80:83] offset:8320
    ds_write_b128 v78, v[80:83] offset:16640
    s_cmp_ge_u32 s20, 2
    s_cbranch_scc1 K2_NOCL
    s_mov_b64 exec, s[56:57]
    ds_write_b128 v79, v[80:83] offset:27040
    s_mov_b64 exec, -1
K2_NOCL:
    s_cmp_lg_u32 s20, 7
    s_cbranch_scc1 K2_NOH
    v_mov_b32 v76, 0
    v_mov_b32 v77, -1
    v_lshlrev_b32 v78, 2, v176
    v_add_u32 v78, 160480, v78
    s_mov_b64 exec, 0x1ff
    ds_write_b32 v78, v76 offset:192
    s_mov_b64 exec, 0xff
    ds_write_b32 v78, v77 offset:256
    s_mov_b64 exec, -1
    s_cmp_lg_u32 s24, 0
    s_cbranch_scc1 K2_NOH
    s_mov_b32 exec_hi, 0xffff
    ds_write_b32 v78, v76
    s_mov_b64 exec, 0x3f
    ds_write_b32 v78, v76 offset:228
    s_mov_b64 exec, -1
K2_NOH:
    s_waitcnt lgkmcnt(0)
    s_barrier
    s_branch K2_CELLS
K2_LD_GEN:
    s_mov_b64 exec, s[42:43]
    s_cbranch_execz K2_LD_DONE
    buffer_load_dwordx4 v[4:7], v182, s[8:11], 0 offen sc1
    s_mov_b64 exec, s[44:45]
    s_cbranch_execz K2_LD_DONE
    buffer_load_dwordx4 v[8:11], v183, s[8:11], 0 offen sc1
    s_mov_b64 exec, s[46:47]
    s_cbranch_execz K2_LD_DONE
    buffer_load_dwordx4 v[12:15], v184, s[8:11], 0 offen sc1
    s_mov_b64 exec, s[48:49]
    s_cbranch_execz K2_LD_DONE
    buffer_load_dwordx4 v[16:19], v181, s[8:11], 0 offen offset:128 sc1
    s_mov_b64 exec, s[50:51]
    s_cbranch_execz K2_LD_DONE
    buffer_load_dwordx4 v[20:23], v181, s[8:11], 0 offen offset:160 sc1
    s_mov_b64 exec, s[90:91]
    s_cbranch_execz K2_LD_DONE
    buffer_load_dwordx4 v[24:27], v181, s[8:11], 0 offen offset:192 sc1
    s_mov_b64 exec, s[92:93]
    s_cbranch_execz K2_LD_DONE
    buffer_load_dwordx4 v[28:31], v181, s[8:11], 0 offen offset:224 sc1
    s_mov_b64 exec, s[94:95]
    s_cbranch_execz K2_LD_DONE
    buffer_load_dwordx4 v[32:35], v181, s[8:11], 0 offen offset:256 sc1
    s_mov_b64 exec, s[96:97]
    s_cbranch_execz K2_LD_DONE
    buffer_load_dwordx4 v[36:39], v181, s[8:11], 0 offen offset:288 sc1
    s_branch K2_LD_DONE
K2_WLATE:
    s_waitcnt vmcnt(0)
    s_branch K2_WUNP
K2_FLGLD:
    buffer_load_dwordx4 v[84:87], v72, s[8:11], s64 offen sc1
    s_mov_b32 s62, 0
    s_branch K2_FLGL2
K2_FLGCK:
    s_cmp_lg_u32 s24, 0
    s_cbranch_scc1 K2_FLGOK
    s_waitcnt vmcnt(0)
K2_FLGW:
    v_xor_b32 v84, s2, v84
    v_xor_b32 v85, s2, v85
    v_xor_b32 v86, s2, v86
    v_xor_b32 v87, s2, v87
    v_or3_b32 v84, v84, v85, v86
    v_or_b32 v84, v84, v87
    v_cmp_ne_u32 vcc, 0, v84
    s_nop 0
    s_cbranch_vccz K2_FLGY
    s_sub_u32 s60, s60, 1
    s_cbranch_scc1 K2_END
    buffer_load_dwordx4 v[84:87], v72, s[8:11], s64 offen sc1
    s_waitcnt vmcnt(0)
    s_branch K2_FLGW
K2_FLGY:
    s_cmp_lg_u32 s54, 0
    s_cbranch_scc1 K2_FLGOK
    v_mov_b32 v84, s2
    v_mov_b32 v85, 7178240
    s_mov_b64 exec, 1
    buffer_store_dword v84, v85, s[8:11], 0 offen sc1
    s_mov_b64 exec, -1
    s_branch K2_FLGOK
K2_RT0:
    s_sub_u32 s60, s60, 1
    s_cbranch_scc1 K2_END
    buffer_load_dwordx4 v[0:3], v181, s[8:11], 0 offen offset:0 sc1
    s_waitcnt vmcnt(0)
    s_branch K2_CK0
K2_RT1:
    s_sub_u32 s60, s60, 1
    s_cbranch_scc1 K2_END
    buffer_load_dwordx4 v[4:7], v182, s[8:11], 0 offen sc1
    s_waitcnt vmcnt(0)
    s_branch K2_CK1
K2_RT2:
    s_sub_u32 s60, s60, 1
    s_cbranch_scc1 K2_END
    buffer_load_dwordx4 v[8:11], v183, s[8:11], 0 offen sc1
    s_waitcnt vmcnt(0)
    s_branch K2_CK2
K2_RT3:
    s_sub_u32 s60, s60, 1
    s_cbranch_scc1 K2_END
    buffer_load_dwordx4 v[12:15], v184, s[8:11], 0 offen sc1
    s_waitcnt vmcnt(0)
    s_branch K2_CK3
K2_RT4:
    s_sub_u32 s60, s60, 1
    s_cbranch_scc1 K2_END
    buffer_load_dwordx4 v[16:19], v181, s[8:11], 0 offen offset:128 sc1
    s_waitcnt vmcnt(0)
    s_branch K2_CK4
K2_RT5:
    s_sub_u32 s60, s60, 1
    s_cbranch_scc1 K2_END
    buffer_load_dwordx4 v[20:23], v181, s[8:11], 0 offen offset:160 sc1
    s_waitcnt vmcnt(0)
    s_branch K2_CK5
K2_RT6:
    s_sub_u32 s60, s60, 1
    s_cbranch_scc1 K2_END
    buffer_load_dwordx4 v[24:27], v181, s[8:11], 0 offen offset:192 sc1
    s_waitcnt vmcnt(0)
    s_branch K2_CK6
K2_RT7:
    s_sub_u32 s60, s60, 1
    s_cbranch_scc1 K2_END
    buffer_load_dwordx4 v[28:31], v181, s[8:11], 0 offen offset:224 sc1
    s_waitcnt vmcnt(0)
    s_branch K2_CK7
K2_RT8:
    s_sub_u32 s60, s60, 1
    s_cbranch_scc1 K2_END
    buffer_load_dwordx4 v[32:35], v181, s[8:11], 0 offen offset:256 sc1
    s_waitcnt vmcnt(0)
    s_branch K2_CK8
K2_RT9:
    s_sub_u32 s60, s60, 1
    s_cbranch_scc1 K2_END
    buffer_load_dwordx4 v[36:39], v181, s[8:11], 0 offen offset:288 sc1
    s_waitcnt vmcnt(0)
    s_branch K2_CK9
K2_RK_LOAD:
    s_waitcnt vmcnt(0)
    s_mov_b64 exec, s[40:41]
    s_cbranch_execz K2_RK_B
    v_lshrrev_b32 v50, 24, v3
    buffer_load_dword v40, v179, s[8:11], s66 offen offset:0
    v_mad_u32_u24 v50, v50, s58, v202
    v_and_b32 v3, 0xffffff, v3
    s_mov_b64 exec, s[42:43]
    s_cbranch_execz K2_RK_B
    v_lshrrev_b32 v51, 24, v7
    buffer_load_dword v41, v185, s[8:11], s66 offen
    v_mad_u32_u24 v51, v51, s58, v202
    v_and_b32 v7, 0xffffff, v7
    s_mov_b64 exec, s[44:45]
    s_cbranch_execz K2_RK_B
    v_lshrrev_b32 v52, 24, v11
    buffer_load_dword v42, v186, s[8:11], s66 offen
    v_mad_u32_u24 v52, v52, s58, v202
    v_and_b32 v11, 0xffffff, v11
    s_mov_b64 exec, s[46:47]
    s_cbranch_execz K2_RK_B
    v_lshrrev_b32 v53, 24, v15
    buffer_load_dword v43, v187, s[8:11], s66 offen
    v_mad_u32_u24 v53, v53, s58, v202
    v_and_b32 v15, 0xffffff, v15
    s_mov_b64 exec, s[48:49]
    s_cbranch_execz K2_RK_B
    v_lshrrev_b32 v54, 24, v19
    buffer_load_dword v44, v179, s[8:11], s66 offen offset:32
    v_mad_u32_u24 v54, v54, s58, v202
    v_and_b32 v19, 0xffffff, v19
    s_mov_b64 exec, s[50:51]
    s_cbranch_execz K2_RK_B
    v_lshrrev_b32 v55, 24, v23
    buffer_load_dword v45, v179, s[8:11], s66 offen offset:40
    v_mad_u32_u24 v55, v55, s58, v202
    v_and_b32 v23, 0xffffff, v23
    s_mov_b64 exec, s[90:91]
    s_cbranch_execz K2_RK_B
    v_lshrrev_b32 v56, 24, v27
    buffer_load_dword v46, v179, s[8:11], s66 offen offset:48
    v_mad_u32_u24 v56, v56, s58, v202
    v_and_b32 v27, 0xffffff, v27
    s_mov_b64 exec, s[92:93]
    s_cbranch_execz K2_RK_B
    v_lshrrev_b32 v57, 24, v31
    buffer_load_dword v47, v179, s[8:11], s66 offen offset:56
    v_mad_u32_u24 v57, v57, s58, v202
    v_and_b32 v31, 0xffffff, v31
    s_mov_b64 exec, s[94:95]
    s_cbranch_execz K2_RK_B
    v_lshrrev_b32 v58, 24, v35
    buffer_load_dword v48, v179, s[8:11], s66 offen offset:64
    v_mad_u32_u24 v58, v58, s58, v202
    v_and_b32 v35, 0xffffff, v35
    s_mov_b64 exec, s[96:97]
    s_cbranch_execz K2_RK_B
    v_lshrrev_b32 v59, 24, v39
    buffer_load_dword v49, v179, s[8:11], s66 offen offset:72
    v_mad_u32_u24 v59, v59, s58, v202
    v_and_b32 v39, 0xffffff, v39
K2_RK_B:
    s_mov_b64 exec, -1
    s_mul_i32 s62, s24, 48
    s_waitcnt vmcnt(0)
    v_subrev_u32 v40, s62, v40
    v_subrev_u32 v41, s62, v41
    v_subrev_u32 v42, s62, v42
    v_subrev_u32 v43, s62, v43
    v_subrev_u32 v44, s62, v44
    v_subrev_u32 v45, s62, v45
    v_subrev_u32 v46, s62, v46
    v_subrev_u32 v47, s62, v47
    v_subrev_u32 v48, s62, v48
    v_subrev_u32 v49, s62, v49
    s_branch K2_RK_DONE
K2_PAD_OV:
    s_branch K2_HOP
K2_OV:
    s_cmp_lg_u32 s24, 0
    s_cbranch_scc1 K2_OB
    s_cmp_eq_u32 s22, 39
    s_cselect_b32 s63, 5, 2
    s_flbit_i32_b32 s56, s58
    s_sub_u32 s56, 31, s56
    s_bitset0_b32 s58, s56
    s_sub_u32 s57, s56, 1
    v_mov_b32 v198, 0
    v_mov_b32 v206, s57
K2_OVL:
    s_mov_b64 exec, -1
    s_ff1_i32_b32 s61, s58
    s_bitset0_b32 s58, s61
    v_readfirstlane_b32 s62, v206
    s_nop 0
    s_sub_u32 s62, s62, s61
    s_lshl_b32 s61, s62, 1
    v_cmp_lt_i32 vcc, s61, v180
    s_cmp_eq_u32 s62, 1
    s_cselect_b64 vcc, s[42:43], vcc
    s_cmp_eq_u32 s62, 2
    s_cselect_b64 vcc, s[44:45], vcc
    s_cmp_eq_u32 s62, 3
    s_cselect_b64 vcc, s[46:47], vcc
    s_lshl_b32 s61, s62, 2
    s_set_gpr_idx_on s62, gpr_idx(SRC0)
    s_nop 0
    v_mov_b32 v204, v40
    v_mov_b32 v205, v50
    s_set_gpr_idx_idx s61
    s_nop 0
    v_mov_b32 v208, v0
    v_mov_b32 v209, v1
    v_mov_b32 v210, v2
    v_mov_b32 v211, v3
    s_set_gpr_idx_off
    s_mov_b64 exec, vcc
    v_subrev_u32 v192, 48, v204
    v_mov_b32 v197, 160712
    v_cmp_gt_u32 vcc, 16, v192
    s_mov_b32 s62, 0
    s_mov_b64 exec, vcc
    s_cbranch_execz K2_OVN
K2_OP:
    ds_cmpst_rtn_b32 v200, v197, v198, v205
    s_cmp_ge_u32 s62, 2
    s_cselect_b32 s65, 2080, 0
    s_cselect_b32 s26, 32, 0
    s_sub_u32 s65, 148736, s65
    s_lshl_b32 s61, s62, 4
    s_sub_u32 s61, s61, s26
    v_mov_b32 v199, s65
    v_add_u32 v203, s61, v192
    s_waitcnt lgkmcnt(0)
    v_cmp_eq_u32 vcc, 0, v200
    v_cmp_eq_u32 s[56:57], v200, v205
    s_nop 0
    s_or_b64 vcc, vcc, s[56:57]
    s_andn2_b64 s[56:57], exec, vcc
    s_mov_b64 exec, vcc
    v_lshl_add_u32 v194, v203, 5, v199
    v_lshl_add_u32 v195, v203, 1, v199
    ds_write_b32 v194, v211 offset:480
    ds_write_b16 v195, v208 offset:96
    ds_write_b16_d16_hi v195, v208 offset:192
    ds_write_b16_d16_hi v195, v209 offset:288
    ds_write_b16 v195, v210 offset:384
    s_mov_b64 exec, s[56:57]
    s_cbranch_execz K2_OVN
    v_add_u32 v197, 4, v197
    s_add_u32 s62, s62, 1
    s_cmp_lt_u32 s62, s63
    s_cbranch_scc1 K2_OP
K2_OVN:
    s_cmp_lg_u32 s58, 0
    s_cbranch_scc1 K2_OVL
    s_mov_b64 exec, -1
    s_branch K2_OB
K2_BIG:
    s_cmp_lg_u32 s24, 0
    s_cbranch_scc1 K2_TOK
    s_mov_b64 s[62:63], vcc
    s_bcnt1_i32_b64 s60, vcc
    s_cmp_eq_u32 s22, 39
    s_cselect_b32 s61, 5, 2
    s_cmp_gt_u32 s60, s61
    s_cbranch_scc1 K2_SLOW
    v_cmp_lt_u32 vcc, 64, v193
    s_nop 0
    s_cbranch_vccnz K2_SLOW
    v_mov_b32 v197, 160712
    ds_read_b32 v203, v197
    ds_read_b32 v204, v197 offset:4
    ds_read_b32 v205, v197 offset:8
    ds_read_b32 v206, v197 offset:12
    ds_read_b32 v207, v197 offset:16
    v_and_b32 v197, 0x3ffff, v195
    s_movk_i32 s26, 64
    s_waitcnt lgkmcnt(0)
    v_cmp_eq_u32 vcc, v204, v197
    v_mov_b32 v194, 134217728
    s_nop 0
    v_cndmask_b32 v198, v198, v194, vcc
    v_cmp_eq_u32 vcc, v205, v197
    v_mov_b32 v194, 268435456
    s_nop 0
    v_cndmask_b32 v198, v198, v194, vcc
    v_cmp_eq_u32 vcc, v206, v197
    v_mov_b32 v194, 402653184
    s_nop 0
    v_cndmask_b32 v198, v198, v194, vcc
    v_cmp_eq_u32 vcc, v207, v197
    v_mov_b32 v194, 536870912
    s_nop 0
    v_cndmask_b32 v198, v198, v194, vcc
    s_branch K2_TOK
K2_SLOW:
    v_mov_b32 v197, v193
    s_nop 1
    v_max_u32_dpp v197, v197, v197 row_shr:1 row_mask:0xf bank_mask:0xf bound_ctrl:0
    s_nop 1
    v_max_u32_dpp v197, v197, v197 row_shr:2 row_mask:0xf bank_mask:0xf bound_ctrl:0
    s_nop 1
    v_max_u32_dpp v197, v197, v197 row_shr:4 row_mask:0xf bank_mask:0xf bound_ctrl:0
    s_nop 1
    v_max_u32_dpp v197, v197, v197 row_shr:8 row_mask:0xf bank_mask:0xf bound_ctrl:0
    s_nop 1
    v_max_u32_dpp v197, v197, v197 row_bcast:15 row_mask:0xa bank_mask:0xf
    s_nop 1
    v_max_u32_dpp v197, v197, v197 row_bcast:31 row_mask:0xc bank_mask:0xf
    s_nop 0
    v_readlane_b32 s25, v197, 63
    s_nop 0
    s_add_u32 s25, s25, 47
    s_mul_i32 s25, s25, 43691
    s_lshr_b32 s25, s25, 21
    s_mov_b64 exec, s[40:41]
    s_cbranch_execz K2_SV_DONE
    buffer_store_dword v40, v179, s[8:11], s66 offen offset:0
    s_mov_b64 exec, s[42:43]
    s_cbranch_execz K2_SV_DONE
    buffer_store_dword v41, v185, s[8:11], s66 offen
    s_mov_b64 exec, s[44:45]
    s_cbranch_execz K2_SV_DONE
    buffer_store_dword v42, v186, s[8:11], s66 offen
    s_mov_b64 exec, s[46:47]
    s_cbranch_execz K2_SV_DONE
    buffer_store_dword v43, v187, s[8:11], s66 offen
    s_mov_b64 exec, s[48:49]
    s_cbranch_execz K2_SV_DONE
    buffer_store_dword v44, v179, s[8:11], s66 offen offset:32
    s_mov_b64 exec, s[50:51]
    s_cbranch_execz K2_SV_DONE
    buffer_store_dword v45, v179, s[8:11], s66 offen offset:40
    s_mov_b64 exec, s[90:91]
    s_cbranch_execz K2_SV_DONE
    buffer_store_dword v46, v179, s[8:11], s66 offen offset:48
    s_mov_b64 exec, s[92:93]
    s_cbranch_execz K2_SV_DONE
    buffer_store_dword v47, v179, s[8:11], s66 offen offset:56
    s_mov_b64 exec, s[94:95]
    s_cbranch_execz K2_SV_DONE
    buffer_store_dword v48, v179, s[8:11], s66 offen offset:64
    s_mov_b64 exec, s[96:97]
    s_cbranch_execz K2_SV_DONE
    buffer_store_dword v49, v179, s[8:11], s66 offen offset:72
K2_SV_DONE:
    s_mov_b64 exec, -1
    s_branch K2_TOK
K2_rare_1:
    s_cmp_eq_u32 s33, 4
    s_cbranch_scc1 K2_four_3
    s_mov_b32 s49, s48
    s_mov_b32 s51, s48
    s_add_u32 s45, s44, 256
    s_add_u32 s46, s44, 512
    s_add_u32 s47, s44, 768
    s_branch K2_back_2
K2_four_3:
    s_add_u32 s50, s48, 64
    s_lshr_b32 s51, s3, 27
    s_mov_b32 s66, 148736
    s_cmp_ge_u32 s51, 2
    s_cselect_b32 s66, 146592, s66
    s_mul_i32 s51, s51, 32
    s_add_u32 s51, s51, s66
    s_mov_b32 s46, s44
    s_mov_b32 s47, s44
    s_branch K2_back_2
K2_a4_5:
    s_lshr_b32 s65, s3, 27
    s_mov_b32 s66, 148736
    s_cmp_ge_u32 s65, 2
    s_cselect_b32 s66, 145632, s66
    s_mul_i32 s65, s65, 512
    s_add_u32 s65, s65, s66
    v_add_u32 v232, s65, v230
    ds_read_b32 v232, v232
    s_add_u32 m0, s65, 480
    s_waitcnt lgkmcnt(0)
    v_or_b32 v232, v232, v231
    buffer_load_dwordx4 v232, s[16:19], 0 offen  lds
    s_branch K2_b4_7
K2_rare_14:
    s_cmp_eq_u32 s33, 4
    s_cbranch_scc1 K2_four_16
    s_mov_b32 s49, s48
    s_mov_b32 s51, s48
    s_add_u32 s45, s44, 256
    s_add_u32 s46, s44, 512
    s_add_u32 s47, s44, 768
    s_branch K2_back_15
K2_four_16:
    s_add_u32 s50, s48, 64
    s_lshr_b32 s51, s3, 27
    s_mov_b32 s66, 148736
    s_cmp_ge_u32 s51, 2
    s_cselect_b32 s66, 146592, s66
    s_mul_i32 s51, s51, 32
    s_add_u32 s51, s51, s66
    s_mov_b32 s46, s44
    s_mov_b32 s47, s44
    s_branch K2_back_15
K2_a4_18:
    s_lshr_b32 s65, s3, 27
    s_mov_b32 s66, 148736
    s_cmp_ge_u32 s65, 2
    s_cselect_b32 s66, 145632, s66
    s_mul_i32 s65, s65, 512
    s_add_u32 s65, s65, s66
    v_add_u32 v232, s65, v230
    ds_read_b32 v232, v232
    s_add_u32 m0, s65, 480
    s_waitcnt lgkmcnt(0)
    v_or_b32 v232, v232, v231
    buffer_load_dwordx4 v232, s[16:19], 0 offen  lds
    s_branch K2_b4_20
K2_rare_27:
    s_cmp_eq_u32 s33, 4
    s_cbranch_scc1 K2_four_29
    s_mov_b32 s49, s48
    s_mov_b32 s51, s48
    s_add_u32 s45, s44, 256
    s_add_u32 s46, s44, 512
    s_add_u32 s47, s44, 768
    s_branch K2_back_28
K2_four_29:
    s_add_u32 s50, s48, 64
    s_lshr_b32 s51, s3, 27
    s_mov_b32 s66, 148736
    s_cmp_ge_u32 s51, 2
    s_cselect_b32 s66, 146592, s66
    s_mul_i32 s51, s51, 32
    s_add_u32 s51, s51, s66
    s_mov_b32 s46, s44
    s_mov_b32 s47, s44
    s_branch K2_back_28
K2_a4_31:
    s_lshr_b32 s65, s3, 27
    s_mov_b32 s66, 148736
    s_cmp_ge_u32 s65, 2
    s_cselect_b32 s66, 145632, s66
    s_mul_i32 s65, s65, 512
    s_add_u32 s65, s65, s66
    v_add_u32 v232, s65, v230
    ds_read_b32 v232, v232
    s_add_u32 m0, s65, 480
    s_waitcnt lgkmcnt(0)
    v_or_b32 v232, v232, v231
    buffer_load_dwordx4 v232, s[16:19], 0 offen  lds
    s_branch K2_b4_33
K2_rare_38:
    s_cmp_eq_u32 s33, 4
    s_cbranch_scc1 K2_four_40
    s_mov_b32 s49, s48
    s_mov_b32 s51, s48
    s_add_u32 s45, s44, 256
    s_add_u32 s46, s44, 512
    s_add_u32 s47, s44, 768
    s_branch K2_back_39
K2_four_40:
    s_add_u32 s50, s48, 64
    s_lshr_b32 s51, s3, 27
    s_mov_b32 s66, 148736
    s_cmp_ge_u32 s51, 2
    s_cselect_b32 s66, 146592, s66
    s_mul_i32 s51, s51, 32
    s_add_u32 s51, s51, s66
    s_mov_b32 s46, s44
    s_mov_b32 s47, s44
    s_branch K2_back_39
K2_rare_45:
    s_cmp_eq_u32 s33, 4
    s_cbranch_scc1 K2_four_47
    s_mov_b32 s49, s48
    s_mov_b32 s51, s48
    s_add_u32 s45, s44, 256
    s_add_u32 s46, s44, 512
    s_add_u32 s47, s44, 768
    s_branch K2_back_46
K2_four_47:
    s_add_u32 s50, s48, 64
    s_lshr_b32 s51, s3, 27
    s_mov_b32 s66, 148736
    s_cmp_ge_u32 s51, 2
    s_cselect_b32 s66, 146592, s66
    s_mul_i32 s51, s51, 32
    s_add_u32 s51, s51, s66
    s_mov_b32 s46, s44
    s_mov_b32 s47, s44
    s_branch K2_back_46
K2_U10:
    s_setprio 1
    s_add_u32 s38, s38, 1
    v_mov_b32 v254, s52
    v_mov_b32 v255, s38
    s_lshl_b32 s58, s38, 3
    s_add_u32 s58, s58, s20
    s_mov_b64 exec, 1
    ds_write_b32 v254, v255
    s_mov_b64 exec, -1
    s_cmp_lt_u32 s58, s22
    s_cbranch_scc0 K2_dyn_48
K2_back_49:
    s_waitcnt lgkmcnt(4)
    v_lshlrev_b32 v20, 16, v0
    v_and_b32 v21, 0xffff0000, v0
    v_lshlrev_b32 v22, 16, v1
    v_and_b32 v23, 0xffff0000, v1
    v_lshlrev_b32 v24, 16, v2
    v_and_b32 v25, 0xffff0000, v2
    v_lshlrev_b32 v26, 16, v3
    v_and_b32 v27, 0xffff0000, v3
    v_mul_f32_dpp v36, v16, v20 row_newbcast:0 row_mask:0xf bank_mask:0xf
    v_mul_f32_dpp v37, v16, v21 row_newbcast:1 row_mask:0xf bank_mask:0xf
    v_mul_f32_dpp v38, v16, v22 row_newbcast:2 row_mask:0xf bank_mask:0xf
    v_mul_f32_dpp v39, v16, v23 row_newbcast:3 row_mask:0xf bank_mask:0xf
    v_mul_f32_dpp v40, v16, v24 row_newbcast:4 row_mask:0xf bank_mask:0xf
    v_mul_f32_dpp v41, v16, v25 row_newbcast:5 row_mask:0xf bank_mask:0xf
    v_mul_f32_dpp v42, v16, v26 row_newbcast:6 row_mask:0xf bank_mask:0xf
    v_mul_f32_dpp v43, v16, v27 row_newbcast:7 row_mask:0xf bank_mask:0xf
    v_cvt_pk_bf16_f32 v64, v36, v37
    v_cvt_pk_bf16_f32 v65, v38, v39
    v_cvt_pk_bf16_f32 v66, v40, v41
    v_cvt_pk_bf16_f32 v67, v42, v43
    v_mul_f32_dpp v44, v16, v20 row_newbcast:8 row_mask:0xf bank_mask:0xf
    v_mul_f32_dpp v45, v16, v21 row_newbcast:9 row_mask:0xf bank_mask:0xf
    v_mul_f32_dpp v46, v16, v22 row_newbcast:10 row_mask:0xf bank_mask:0xf
    v_mul_f32_dpp v47, v16, v23 row_newbcast:11 row_mask:0xf bank_mask:0xf
    v_mul_f32_dpp v48, v16, v24 row_newbcast:12 row_mask:0xf bank_mask:0xf
    v_mul_f32_dpp v49, v16, v25 row_newbcast:13 row_mask:0xf bank_mask:0xf
    v_mul_f32_dpp v50, v16, v26 row_newbcast:14 row_mask:0xf bank_mask:0xf
    v_mul_f32_dpp v51, v16, v27 row_newbcast:15 row_mask:0xf bank_mask:0xf
    v_cvt_pk_bf16_f32 v68, v44, v45
    v_cvt_pk_bf16_f32 v69, v46, v47
    v_cvt_pk_bf16_f32 v70, v48, v49
    v_cvt_pk_bf16_f32 v71, v50, v51
    v_readlane_b32 s3, v253, s58
    s_lshl_b32 s44, s34, 7
    s_and_b32 s48, s3, 0x3ffff
    s_bfe_u32 s33, s3, 0x30012
    s_mul_i32 s35, s38, 6
    s_cmp_eq_u32 s34, 0
    s_cselect_b32 s35, s35, s48
    s_mov_b32 s45, s44
    s_add_u32 s47, s44, 256
    s_add_u32 s49, s48, 32
    s_add_u32 s60, s48, 64
    s_cmp_eq_u32 s33, 3
    s_cselect_b32 s46, s44, s47
    s_cselect_b32 s50, s60, s48
    s_cselect_b32 s51, s48, s49
    s_sub_u32 s60, s33, 2
    s_cmp_lt_u32 s60, 2
    s_cbranch_scc0 K2_rare_54
K2_back_55:
    v_add_u32 v233, s48, v230
    ds_read_b32 v232, v233
    ds_read_b32 v233, v233 offset:1024
    v_add_u32 v222, s48, v251
    ds_read_b32 v222, v222
    v_add_u32 v224, s49, v251
    ds_read_b32 v224, v224
    v_add_u32 v226, s50, v251
    ds_read_b32 v226, v226
    v_add_u32 v228, s51, v251
    ds_read_b32 v228, v228
    s_waitcnt lgkmcnt(4)
    v_or_b32 v232, v232, v231
    v_or_b32 v233, v233, v231
    s_cmp_lg_u32 s34, 0
    s_cbranch_scc1 K2_dum_57
    s_add_u32 m0, s48, 480
    s_add_u32 s65, s48, 1504
    buffer_load_dwordx4 v232, s[16:19], 0 offen  lds
    s_mov_b32 m0, s65
    s_mov_b32 exec_hi, 0
    buffer_load_dwordx4 v233, s[16:19], 0 offen  lds
    s_cmp_eq_u32 s33, 4
    s_cbranch_scc1 K2_a4_58
K2_b4_60:
    s_mov_b32 exec_hi, -1
K2_back_59:
    s_waitcnt lgkmcnt(3)
    v_mad_u32_u16 v223, v222, s39, v248 op_sel:[1,0,0,0]
    v_mad_u32_u16 v222, v222, s39, v248
    s_waitcnt lgkmcnt(2)
    v_mad_u32_u16 v225, v224, s39, v248 op_sel:[1,0,0,0]
    v_mad_u32_u16 v224, v224, s39, v248
    s_waitcnt lgkmcnt(1)
    v_mad_u32_u16 v227, v226, s39, v248 op_sel:[1,0,0,0]
    v_mad_u32_u16 v226, v226, s39, v248
    s_waitcnt lgkmcnt(0)
    v_mad_u32_u16 v229, v228, s39, v248 op_sel:[1,0,0,0]
    v_mad_u32_u16 v228, v228, s39, v248
    s_waitcnt vmcnt(6)
    v_mfma_f32_32x32x16_bf16 v[0:15], v[64:67], v[176:179], 0
    ds_read_b64_tr_b16 v[184:185], v246 offset:2048
    ds_read_b64_tr_b16 v[186:187], v246 offset:2560
    ds_read_b64_tr_b16 v[188:189], v247 offset:2048
    ds_read_b64_tr_b16 v[190:191], v247 offset:2560
    s_mov_b32 m0, s68
    v_mfma_f32_32x32x16_bf16 v[16:31], v[68:71], v[176:179], 0
    buffer_load_dwordx4 v222, s[4:7], s44 offen sc1 lds
    buffer_load_dwordx4 v223, s[72:75], s44 offen offset:1024 sc1 lds
    v_permlane32_swap_b32 v242, v236
    v_permlane32_swap_b32 v243, v237
    v_mfma_f32_32x32x16_bf16 v[32:47], v[64:67], v[180:183], 0
    v_permlane32_swap_b32 v244, v238
    v_permlane32_swap_b32 v245, v239
    v_permlane32_swap_b32 v240, v241
    v_add_f32 v242, v242, v236
    v_mfma_f32_32x32x16_bf16 v[48:63], v[68:71], v[180:183], 0
    s_setprio 0
    v_add_f32 v243, v243, v237
    v_add_f32 v244, v244, v238
    v_add_f32 v245, v245, v239
    v_add_f32 v240, -v240, -v241
    s_set_gpr_idx_on s32, gpr_idx(DST)
    s_nop 0
    v_cvt_pk_bf16_f32 v195, v242, v243
    v_cvt_pk_bf16_f32 v196, v244, v245
    v_cvt_pk_bf16_f32 v197, v240, v240
    s_set_gpr_idx_off
    v_mul_f32 v234, v0, v96
    v_mul_f32 v236, v8, v128
    v_fmac_f32 v234, v1, v97
    v_fmac_f32 v236, v9, v129
    v_fmac_f32 v234, v2, v98
    v_fmac_f32 v236, v10, v130
    v_fmac_f32 v234, v3, v99
    v_fmac_f32 v236, v11, v131
    v_fmac_f32 v234, v4, v100
    v_fmac_f32 v236, v12, v132
    v_fmac_f32 v234, v5, v101
    v_fmac_f32 v236, v13, v133
    v_fmac_f32 v234, v6, v102
    v_fmac_f32 v236, v14, v134
    v_fmac_f32 v234, v7, v103
    v_fmac_f32 v236, v15, v135
    v_mul_f32 v238, v16, v128
    v_mul_f32 v240, v24, v128
    v_fmac_f32 v238, v17, v129
    v_fmac_f32 v240, v25, v129
    v_fmac_f32 v238, v18, v130
    v_fmac_f32 v240, v26, v130
    v_fmac_f32 v238, v19, v131
    v_fmac_f32 v240, v27, v131
    v_fmac_f32 v238, v20, v132
    v_fmac_f32 v240, v28, v132
    v_fmac_f32 v238, v21, v133
    v_fmac_f32 v240, v29, v133
    v_fmac_f32 v238, v22, v134
    v_fmac_f32 v240, v30, v134
    v_fmac_f32 v238, v23, v135
    v_fmac_f32 v240, v31, v135
    v_mul_f32 v235, v32, v104
    v_mul_f32 v237, v40, v136
    v_fmac_f32 v235, v33, v105
    v_fmac_f32 v237, v41, v137
    v_fmac_f32 v235, v34, v106
    v_fmac_f32 v237, v42, v138
    v_fmac_f32 v235, v35, v107
    v_fmac_f32 v237, v43, v139
    v_fmac_f32 v235, v36, v108
    v_fmac_f32 v237, v44, v140
    v_fmac_f32 v235, v37, v109
    v_fmac_f32 v237, v45, v141
    v_fmac_f32 v235, v38, v110
    v_fmac_f32 v237, v46, v142
    v_fmac_f32 v235, v39, v111
    v_fmac_f32 v237, v47, v143
    v_mul_f32 v239, v48, v136
    v_mul_f32 v241, v56, v136
    v_fmac_f32 v239, v49, v137
    v_fmac_f32 v241, v57, v137
    v_fmac_f32 v239, v50, v138
    v_fmac_f32 v241, v58, v138
    v_fmac_f32 v239, v51, v139
    v_fmac_f32 v241, v59, v139
    v_fmac_f32 v239, v52, v140
    v_fmac_f32 v241, v60, v140
    v_fmac_f32 v239, v53, v141
    v_fmac_f32 v241, v61, v141
    v_fmac_f32 v239, v54, v142
    v_fmac_f32 v241, v62, v142
    v_fmac_f32 v239, v55, v143
    v_fmac_f32 v241, v63, v143
    s_setprio 1
    s_waitcnt vmcnt(6) lgkmcnt(0)
    v_mfma_f32_32x32x16_bf16 v[0:15], v[64:67], v[184:187], 0
    ds_read_b64_tr_b16 v[176:177], v246 offset:4096
    ds_read_b64_tr_b16 v[178:179], v246 offset:4608
    ds_read_b64_tr_b16 v[180:181], v247 offset:4096
    ds_read_b64_tr_b16 v[182:183], v247 offset:4608
    s_mov_b32 m0, s69
    v_mfma_f32_32x32x16_bf16 v[16:31], v[68:71], v[184:187], 0
    buffer_load_dwordx4 v224, s[4:7], s45 offen sc1 lds
    buffer_load_dwordx4 v225, s[72:75], s45 offen offset:1024 sc1 lds
    v_permlane32_swap_b32 v234, v236
    v_permlane32_swap_b32 v235, v237
    v_mfma_f32_32x32x16_bf16 v[32:47], v[64:67], v[188:191], 0
    v_permlane32_swap_b32 v240, v238
    v_permlane32_swap_b32 v241, v239
    v_add_f32 v234, v234, v236
    v_add_f32 v235, v235, v237
    v_add_f32 v240, v240, v238
    v_mfma_f32_32x32x16_bf16 v[48:63], v[68:71], v[188:191], 0
    s_setprio 0
    v_add_f32 v241, v241, v239
    s_set_gpr_idx_on s31, gpr_idx(DST)
    s_nop 0
    v_cvt_pk_bf16_f32 v192, v234, v235
    v_cvt_pk_bf16_f32 v193, v240, v241
    s_set_gpr_idx_off
    v_mul_f32 v234, v0, v144
    v_mul_f32 v236, v8, v112
    v_fmac_f32 v234, v1, v145
    v_fmac_f32 v236, v9, v113
    v_fmac_f32 v234, v2, v146
    v_fmac_f32 v236, v10, v114
    v_fmac_f32 v234, v3, v147
    v_fmac_f32 v236, v11, v115
    v_fmac_f32 v234, v4, v148
    v_fmac_f32 v236, v12, v116
    v_fmac_f32 v234, v5, v149
    v_fmac_f32 v236, v13, v117
    v_fmac_f32 v234, v6, v150
    v_fmac_f32 v236, v14, v118
    v_fmac_f32 v234, v7, v151
    v_fmac_f32 v236, v15, v119
    v_mul_f32 v238, v16, v160
    v_mul_f32 v240, v24, v160
    v_fmac_f32 v238, v17, v161
    v_fmac_f32 v240, v25, v161
    v_fmac_f32 v238, v18, v162
    v_fmac_f32 v240, v26, v162
    v_fmac_f32 v238, v19, v163
    v_fmac_f32 v240, v27, v163
    v_fmac_f32 v238, v20, v164
    v_fmac_f32 v240, v28, v164
    v_fmac_f32 v238, v21, v165
    v_fmac_f32 v240, v29, v165
    v_fmac_f32 v238, v22, v166
    v_fmac_f32 v240, v30, v166
    v_fmac_f32 v238, v23, v167
    v_fmac_f32 v240, v31, v167
    v_mul_f32 v235, v32, v152
    v_mul_f32 v237, v40, v120
    v_fmac_f32 v235, v33, v153
    v_fmac_f32 v237, v41, v121
    v_fmac_f32 v235, v34, v154
    v_fmac_f32 v237, v42, v122
    v_fmac_f32 v235, v35, v155
    v_fmac_f32 v237, v43, v123
    v_fmac_f32 v235, v36, v156
    v_fmac_f32 v237, v44, v124
    v_fmac_f32 v235, v37, v157
    v_fmac_f32 v237, v45, v125
    v_fmac_f32 v235, v38, v158
    v_fmac_f32 v237, v46, v126
    v_fmac_f32 v235, v39, v159
    v_fmac_f32 v237, v47, v127
    v_mul_f32 v239, v48, v168
    v_mul_f32 v241, v56, v168
    v_fmac_f32 v239, v49, v169
    v_fmac_f32 v241, v57, v169
    v_fmac_f32 v239, v50, v170
    v_fmac_f32 v241, v58, v170
    v_fmac_f32 v239, v51, v171
    v_fmac_f32 v241, v59, v171
    v_fmac_f32 v239, v52, v172
    v_fmac_f32 v241, v60, v172
    v_fmac_f32 v239, v53, v173
    v_fmac_f32 v241, v61, v173
    v_fmac_f32 v239, v54, v174
    v_fmac_f32 v241, v62, v174
    v_fmac_f32 v239, v55, v175
    v_fmac_f32 v241, v63, v175
    s_setprio 1
    s_waitcnt vmcnt(6) lgkmcnt(0)
    v_mfma_f32_32x32x16_bf16 v[0:15], v[64:67], v[176:179], 0
    ds_read_b64_tr_b16 v[184:185], v246 offset:6144
    ds_read_b64_tr_b16 v[186:187], v246 offset:6656
    ds_read_b64_tr_b16 v[188:189], v247 offset:6144
    ds_read_b64_tr_b16 v[190:191], v247 offset:6656
    s_mov_b32 m0, s70
    v_mfma_f32_32x32x16_bf16 v[16:31], v[68:71], v[176:179], 0
    buffer_load_dwordx4 v226, s[4:7], s46 offen sc1 lds
    buffer_load_dwordx4 v227, s[72:75], s46 offen offset:1024 sc1 lds
    s_sub_u32 s26, s48, s29
    s_mov_b32 s29, s48
    s_mov_b32 s30, s3
    s_cmp_eq_u32 s34, 0
    s_cselect_b32 s56, s33, 0
    v_mfma_f32_32x32x16_bf16 v[32:47], v[64:67], v[180:183], 0
    v_mfma_f32_32x32x16_bf16 v[48:63], v[68:71], v[180:183], 0
    s_setprio 0
    v_mul_f32 v242, v0, v144
    v_fma_f32 v238, v8, v160, -v238
    v_fmac_f32 v242, v1, v145
    v_fmac_f32 v238, v9, v161
    v_fmac_f32 v242, v2, v146
    v_fmac_f32 v238, v10, v162
    v_fmac_f32 v242, v3, v147
    v_fmac_f32 v238, v11, v163
    v_fmac_f32 v242, v4, v148
    v_fmac_f32 v238, v12, v164
    v_fmac_f32 v242, v5, v149
    v_fmac_f32 v238, v13, v165
    v_fmac_f32 v242, v6, v150
    v_fmac_f32 v238, v14, v166
    v_fmac_f32 v242, v7, v151
    v_fmac_f32 v238, v15, v167
    v_fmac_f32 v236, v16, v112
    v_mul_f32 v244, v24, v160
    v_fmac_f32 v236, v17, v113
    v_fmac_f32 v244, v25, v161
    v_fmac_f32 v236, v18, v114
    v_fmac_f32 v244, v26, v162
    v_fmac_f32 v236, v19, v115
    v_fmac_f32 v244, v27, v163
    v_fmac_f32 v236, v20, v116
    v_fmac_f32 v244, v28, v164
    v_fmac_f32 v236, v21, v117
    v_fmac_f32 v244, v29, v165
    v_fmac_f32 v236, v22, v118
    v_fmac_f32 v244, v30, v166
    v_fmac_f32 v236, v23, v119
    v_fmac_f32 v244, v31, v167
    v_mul_f32 v243, v32, v152
    v_fma_f32 v239, v40, v168, -v239
    v_fmac_f32 v243, v33, v153
    v_fmac_f32 v239, v41, v169
    v_fmac_f32 v243, v34, v154
    v_fmac_f32 v239, v42, v170
    v_fmac_f32 v243, v35, v155
    v_fmac_f32 v239, v43, v171
    v_fmac_f32 v243, v36, v156
    v_fmac_f32 v239, v44, v172
    v_fmac_f32 v243, v37, v157
    v_fmac_f32 v239, v45, v173
    v_fmac_f32 v243, v38, v158
    v_fmac_f32 v239, v46, v174
    v_fmac_f32 v243, v39, v159
    v_fmac_f32 v239, v47, v175
    v_fmac_f32 v237, v48, v120
    v_mul_f32 v245, v56, v168
    v_fmac_f32 v237, v49, v121
    v_fmac_f32 v245, v57, v169
    v_fmac_f32 v237, v50, v122
    v_fmac_f32 v245, v58, v170
    v_fmac_f32 v237, v51, v123
    v_fmac_f32 v245, v59, v171
    v_fmac_f32 v237, v52, v124
    v_fmac_f32 v245, v60, v172
    v_fmac_f32 v237, v53, v125
    v_fmac_f32 v245, v61, v173
    v_fmac_f32 v237, v54, v126
    v_fmac_f32 v245, v62, v174
    v_fmac_f32 v237, v55, v127
    v_fmac_f32 v245, v63, v175
    s_setprio 1
    s_waitcnt vmcnt(4) lgkmcnt(0)
    v_mfma_f32_32x32x16_bf16 v[0:15], v[64:67], v[184:187], 0
    ds_read_b64_tr_b16 v[176:177], v246 offset:0
    ds_read_b64_tr_b16 v[178:179], v246 offset:512
    ds_read_b64_tr_b16 v[180:181], v247 offset:0
    ds_read_b64_tr_b16 v[182:183], v247 offset:512
    s_mov_b32 m0, s71
    v_mfma_f32_32x32x16_bf16 v[16:31], v[68:71], v[184:187], 0
    buffer_load_dwordx4 v228, s[4:7], s47 offen sc1 lds
    buffer_load_dwordx4 v229, s[72:75], s47 offen offset:1024 sc1 lds
    v_permlane32_swap_b32 v242, v234
    v_permlane32_swap_b32 v243, v235
    v_add_f32 v242, v242, v234
    v_mfma_f32_32x32x16_bf16 v[32:47], v[64:67], v[188:191], 0
    v_add_f32 v243, v243, v235
    s_set_gpr_idx_on s31, gpr_idx(DST)
    s_nop 0
    v_cvt_pk_bf16_f32 v194, v242, v243
    s_set_gpr_idx_off
    s_mov_b32 s32, s31
    s_mov_b32 s31, s35
    v_mfma_f32_32x32x16_bf16 v[48:63], v[68:71], v[188:191], 0
    s_setprio 0
    v_mul_f32 v242, v0, v144
    v_fma_f32 v240, v8, v160, -v240
    v_fmac_f32 v242, v1, v145
    v_fmac_f32 v240, v9, v161
    v_fmac_f32 v242, v2, v146
    v_fmac_f32 v240, v10, v162
    v_fmac_f32 v242, v3, v147
    v_fmac_f32 v240, v11, v163
    v_fmac_f32 v242, v4, v148
    v_fmac_f32 v240, v12, v164
    v_fmac_f32 v242, v5, v149
    v_fmac_f32 v240, v13, v165
    v_fmac_f32 v242, v6, v150
    v_fmac_f32 v240, v14, v166
    v_fmac_f32 v242, v7, v151
    v_fmac_f32 v240, v15, v167
    v_add_u32 v249, s26, v249
    v_add_u32 v250, s26, v250
    v_fma_f32 v244, v16, v160, -v244
    v_fmac_f32 v236, v24, v112
    v_fmac_f32 v244, v17, v161
    v_fmac_f32 v236, v25, v113
    v_fmac_f32 v244, v18, v162
    v_fmac_f32 v236, v26, v114
    v_fmac_f32 v244, v19, v163
    v_fmac_f32 v236, v27, v115
    v_fmac_f32 v244, v20, v164
    v_fmac_f32 v236, v28, v116
    v_fmac_f32 v244, v21, v165
    v_fmac_f32 v236, v29, v117
    v_fmac_f32 v244, v22, v166
    v_fmac_f32 v236, v30, v118
    v_fmac_f32 v244, v23, v167
    v_fmac_f32 v236, v31, v119
    ds_read_b64_tr_b16 v[0:1], v249 offset:0
    ds_read_b64_tr_b16 v[2:3], v249 offset:256
    ds_read_u16_d16_hi v16, v250 offset:0
    v_mul_f32 v243, v32, v152
    v_fma_f32 v241, v40, v168, -v241
    v_fmac_f32 v243, v33, v153
    v_fmac_f32 v241, v41, v169
    v_fmac_f32 v243, v34, v154
    v_fmac_f32 v241, v42, v170
    v_fmac_f32 v243, v35, v155
    v_fmac_f32 v241, v43, v171
    v_fmac_f32 v243, v36, v156
    v_fmac_f32 v241, v44, v172
    v_fmac_f32 v243, v37, v157
    v_fmac_f32 v241, v45, v173
    v_fmac_f32 v243, v38, v158
    v_fmac_f32 v241, v46, v174
    v_fmac_f32 v243, v39, v159
    v_fmac_f32 v241, v47, v175
    ds_read_b64_tr_b16 v[4:5], v249 offset:512
    ds_read_b64_tr_b16 v[6:7], v249 offset:768
    ds_read_u16_d16_hi v17, v250 offset:32
    v_fma_f32 v245, v48, v168, -v245
    v_fmac_f32 v237, v56, v120
    v_fmac_f32 v245, v49, v169
    v_fmac_f32 v237, v57, v121
    v_fmac_f32 v245, v50, v170
    v_fmac_f32 v237, v58, v122
    v_fmac_f32 v245, v51, v171
    v_fmac_f32 v237, v59, v123
    v_fmac_f32 v245, v52, v172
    v_fmac_f32 v237, v60, v124
    v_fmac_f32 v245, v53, v173
    v_fmac_f32 v237, v61, v125
    v_fmac_f32 v245, v54, v174
    v_fmac_f32 v237, v62, v126
    v_fmac_f32 v245, v55, v175
    v_fmac_f32 v237, v63, v127
    s_cmp_eq_u32 s56, 2
    s_cbranch_scc1 K2_U20
    s_cmp_eq_u32 s56, 3
    s_cbranch_scc1 K2_U30
    s_branch K2_DSP0
K2_U40:
    s_setprio 1
    ds_read_b64_tr_b16 v[8:9], v249 offset:1024
    ds_read_b64_tr_b16 v[10:11], v249 offset:1280
    ds_read_u16_d16_hi v18, v250 offset:64
    s_lshr_b32 s65, s30, 27
    s_mov_b32 s66, 148736
    s_cmp_ge_u32 s65, 2
    s_cselect_b32 s66, 145632, s66
    s_mul_i32 s65, s65, 512
    s_add_u32 s65, s65, s66
    s_sub_u32 s65, s65, s29
    v_add_u32 v56, s65, v249
    s_lshr_b32 s65, s30, 27
    s_mov_b32 s66, 148736
    s_cmp_ge_u32 s65, 2
    s_cselect_b32 s66, 146592, s66
    s_mul_i32 s65, s65, 32
    s_add_u32 s65, s65, s66
    s_sub_u32 s65, s65, s29
    v_add_u32 v57, s65, v250
    ds_read_b64_tr_b16 v[12:13], v56 offset:0
    ds_read_b64_tr_b16 v[14:15], v56 offset:256
    ds_read_u16_d16_hi v19, v57 offset:0
    s_waitcnt lgkmcnt(6)
    v_lshlrev_b32 v20, 16, v0
    v_and_b32 v21, 0xffff0000, v0
    v_lshlrev_b32 v22, 16, v1
    v_and_b32 v23, 0xffff0000, v1
    v_lshlrev_b32 v24, 16, v2
    v_and_b32 v25, 0xffff0000, v2
    v_lshlrev_b32 v26, 16, v3
    v_and_b32 v27, 0xffff0000, v3
    v_mul_f32_dpp v36, v16, v20 row_newbcast:0 row_mask:0xf bank_mask:0xf
    v_mul_f32_dpp v37, v16, v21 row_newbcast:1 row_mask:0xf bank_mask:0xf
    v_mul_f32_dpp v38, v16, v22 row_newbcast:2 row_mask:0xf bank_mask:0xf
    v_mul_f32_dpp v39, v16, v23 row_newbcast:3 row_mask:0xf bank_mask:0xf
    v_mul_f32_dpp v40, v16, v24 row_newbcast:4 row_mask:0xf bank_mask:0xf
    v_mul_f32_dpp v41, v16, v25 row_newbcast:5 row_mask:0xf bank_mask:0xf
    v_mul_f32_dpp v42, v16, v26 row_newbcast:6 row_mask:0xf bank_mask:0xf
    v_mul_f32_dpp v43, v16, v27 row_newbcast:7 row_mask:0xf bank_mask:0xf
    v_cvt_pk_bf16_f32 v64, v36, v37
    v_cvt_pk_bf16_f32 v65, v38, v39
    v_cvt_pk_bf16_f32 v66, v40, v41
    v_cvt_pk_bf16_f32 v67, v42, v43
    v_mul_f32_dpp v44, v16, v20 row_newbcast:8 row_mask:0xf bank_mask:0xf
    v_mul_f32_dpp v45, v16, v21 row_newbcast:9 row_mask:0xf bank_mask:0xf
    v_mul_f32_dpp v46, v16, v22 row_newbcast:10 row_mask:0xf bank_mask:0xf
    v_mul_f32_dpp v47, v16, v23 row_newbcast:11 row_mask:0xf bank_mask:0xf
    v_mul_f32_dpp v48, v16, v24 row_newbcast:12 row_mask:0xf bank_mask:0xf
    v_mul_f32_dpp v49, v16, v25 row_newbcast:13 row_mask:0xf bank_mask:0xf
    v_mul_f32_dpp v50, v16, v26 row_newbcast:14 row_mask:0xf bank_mask:0xf
    v_mul_f32_dpp v51, v16, v27 row_newbcast:15 row_mask:0xf bank_mask:0xf
    v_cvt_pk_bf16_f32 v68, v44, v45
    v_cvt_pk_bf16_f32 v69, v46, v47
    v_cvt_pk_bf16_f32 v70, v48, v49
    v_cvt_pk_bf16_f32 v71, v50, v51
    v_lshlrev_b32 v28, 16, v4
    v_and_b32 v29, 0xffff0000, v4
    v_lshlrev_b32 v30, 16, v5
    v_and_b32 v31, 0xffff0000, v5
    v_lshlrev_b32 v32, 16, v6
    v_and_b32 v33, 0xffff0000, v6
    v_lshlrev_b32 v34, 16, v7
    v_and_b32 v35, 0xffff0000, v7
    v_mul_f32_dpp v36, v17, v28 row_newbcast:0 row_mask:0xf bank_mask:0xf
    v_mul_f32_dpp v37, v17, v29 row_newbcast:1 row_mask:0xf bank_mask:0xf
    v_mul_f32_dpp v38, v17, v30 row_newbcast:2 row_mask:0xf bank_mask:0xf
    v_mul_f32_dpp v39, v17, v31 row_newbcast:3 row_mask:0xf bank_mask:0xf
    v_mul_f32_dpp v40, v17, v32 row_newbcast:4 row_mask:0xf bank_mask:0xf
    v_mul_f32_dpp v41, v17, v33 row_newbcast:5 row_mask:0xf bank_mask:0xf
    v_mul_f32_dpp v42, v17, v34 row_newbcast:6 row_mask:0xf bank_mask:0xf
    v_mul_f32_dpp v43, v17, v35 row_newbcast:7 row_mask:0xf bank_mask:0xf
    v_cvt_pk_bf16_f32 v72, v36, v37
    v_cvt_pk_bf16_f32 v73, v38, v39
    v_cvt_pk_bf16_f32 v74, v40, v41
    v_cvt_pk_bf16_f32 v75, v42, v43
    v_mul_f32_dpp v44, v17, v28 row_newbcast:8 row_mask:0xf bank_mask:0xf
    v_mul_f32_dpp v45, v17, v29 row_newbcast:9 row_mask:0xf bank_mask:0xf
    v_mul_f32_dpp v46, v17, v30 row_newbcast:10 row_mask:0xf bank_mask:0xf
    v_mul_f32_dpp v47, v17, v31 row_newbcast:11 row_mask:0xf bank_mask:0xf
    v_mul_f32_dpp v48, v17, v32 row_newbcast:12 row_mask:0xf bank_mask:0xf
    v_mul_f32_dpp v49, v17, v33 row_newbcast:13 row_mask:0xf bank_mask:0xf
    v_mul_f32_dpp v50, v17, v34 row_newbcast:14 row_mask:0xf bank_mask:0xf
    v_mul_f32_dpp v51, v17, v35 row_newbcast:15 row_mask:0xf bank_mask:0xf
    v_cvt_pk_bf16_f32 v76, v44, v45
    v_cvt_pk_bf16_f32 v77, v46, v47
    v_cvt_pk_bf16_f32 v78, v48, v49
    v_cvt_pk_bf16_f32 v79, v50, v51
    s_waitcnt lgkmcnt(3)
    v_lshlrev_b32 v20, 16, v8
    v_and_b32 v21, 0xffff0000, v8
    v_lshlrev_b32 v22, 16, v9
    v_and_b32 v23, 0xffff0000, v9
    v_lshlrev_b32 v24, 16, v10
    v_and_b32 v25, 0xffff0000, v10
    v_lshlrev_b32 v26, 16, v11
    v_and_b32 v27, 0xffff0000, v11
    v_mul_f32_dpp v36, v18, v20 row_newbcast:0 row_mask:0xf bank_mask:0xf
    v_mul_f32_dpp v37, v18, v21 row_newbcast:1 row_mask:0xf bank_mask:0xf
    v_mul_f32_dpp v38, v18, v22 row_newbcast:2 row_mask:0xf bank_mask:0xf
    v_mul_f32_dpp v39, v18, v23 row_newbcast:3 row_mask:0xf bank_mask:0xf
    v_mul_f32_dpp v40, v18, v24 row_newbcast:4 row_mask:0xf bank_mask:0xf
    v_mul_f32_dpp v41, v18, v25 row_newbcast:5 row_mask:0xf bank_mask:0xf
    v_mul_f32_dpp v42, v18, v26 row_newbcast:6 row_mask:0xf bank_mask:0xf
    v_mul_f32_dpp v43, v18, v27 row_newbcast:7 row_mask:0xf bank_mask:0xf
    v_cvt_pk_bf16_f32 v80, v36, v37
    v_cvt_pk_bf16_f32 v81, v38, v39
    v_cvt_pk_bf16_f32 v82, v40, v41
    v_cvt_pk_bf16_f32 v83, v42, v43
    v_mul_f32_dpp v44, v18, v20 row_newbcast:8 row_mask:0xf bank_mask:0xf
    v_mul_f32_dpp v45, v18, v21 row_newbcast:9 row_mask:0xf bank_mask:0xf
    v_mul_f32_dpp v46, v18, v22 row_newbcast:10 row_mask:0xf bank_mask:0xf
    v_mul_f32_dpp v47, v18, v23 row_newbcast:11 row_mask:0xf bank_mask:0xf
    v_mul_f32_dpp v48, v18, v24 row_newbcast:12 row_mask:0xf bank_mask:0xf
    v_mul_f32_dpp v49, v18, v25 row_newbcast:13 row_mask:0xf bank_mask:0xf
    v_mul_f32_dpp v50, v18, v26 row_newbcast:14 row_mask:0xf bank_mask:0xf
    v_mul_f32_dpp v51, v18, v27 row_newbcast:15 row_mask:0xf bank_mask:0xf
    v_cvt_pk_bf16_f32 v84, v44, v45
    v_cvt_pk_bf16_f32 v85, v46, v47
    v_cvt_pk_bf16_f32 v86, v48, v49
    v_cvt_pk_bf16_f32 v87, v50, v51
    s_waitcnt lgkmcnt(0)
    v_lshlrev_b32 v28, 16, v12
    v_and_b32 v29, 0xffff0000, v12
    v_lshlrev_b32 v30, 16, v13
    v_and_b32 v31, 0xffff0000, v13
    v_lshlrev_b32 v32, 16, v14
    v_and_b32 v33, 0xffff0000, v14
    v_lshlrev_b32 v34, 16, v15
    v_and_b32 v35, 0xffff0000, v15
    v_mul_f32_dpp v36, v19, v28 row_newbcast:0 row_mask:0xf bank_mask:0xf
    v_mul_f32_dpp v37, v19, v29 row_newbcast:1 row_mask:0xf bank_mask:0xf
    v_mul_f32_dpp v38, v19, v30 row_newbcast:2 row_mask:0xf bank_mask:0xf
    v_mul_f32_dpp v39, v19, v31 row_newbcast:3 row_mask:0xf bank_mask:0xf
    v_mul_f32_dpp v40, v19, v32 row_newbcast:4 row_mask:0xf bank_mask:0xf
    v_mul_f32_dpp v41, v19, v33 row_newbcast:5 row_mask:0xf bank_mask:0xf
    v_mul_f32_dpp v42, v19, v34 row_newbcast:6 row_mask:0xf bank_mask:0xf
    v_mul_f32_dpp v43, v19, v35 row_newbcast:7 row_mask:0xf bank_mask:0xf
    v_cvt_pk_bf16_f32 v88, v36, v37
    v_cvt_pk_bf16_f32 v89, v38, v39
    v_cvt_pk_bf16_f32 v90, v40, v41
    v_cvt_pk_bf16_f32 v91, v42, v43
    v_mul_f32_dpp v44, v19, v28 row_newbcast:8 row_mask:0xf bank_mask:0xf
    v_mul_f32_dpp v45, v19, v29 row_newbcast:9 row_mask:0xf bank_mask:0xf
    v_mul_f32_dpp v46, v19, v30 row_newbcast:10 row_mask:0xf bank_mask:0xf
    v_mul_f32_dpp v47, v19, v31 row_newbcast:11 row_mask:0xf bank_mask:0xf
    v_mul_f32_dpp v48, v19, v32 row_newbcast:12 row_mask:0xf bank_mask:0xf
    v_mul_f32_dpp v49, v19, v33 row_newbcast:13 row_mask:0xf bank_mask:0xf
    v_mul_f32_dpp v50, v19, v34 row_newbcast:14 row_mask:0xf bank_mask:0xf
    v_mul_f32_dpp v51, v19, v35 row_newbcast:15 row_mask:0xf bank_mask:0xf
    v_cvt_pk_bf16_f32 v92, v44, v45
    v_cvt_pk_bf16_f32 v93, v46, v47
    v_cvt_pk_bf16_f32 v94, v48, v49
    v_cvt_pk_bf16_f32 v95, v50, v51
    s_waitcnt vmcnt(4)
    v_mfma_f32_32x32x16_bf16 v[0:15], v[64:67], v[176:179], 0
    ds_read_b64_tr_b16 v[184:185], v246 offset:2048
    ds_read_b64_tr_b16 v[186:187], v246 offset:2560
    ds_read_b64_tr_b16 v[188:189], v247 offset:2048
    ds_read_b64_tr_b16 v[190:191], v247 offset:2560
    s_mov_b32 m0, s68
    v_mfma_f32_32x32x16_bf16 v[16:31], v[68:71], v[176:179], 0
    buffer_load_dwordx4 v222, s[4:7], s41 offen sc1 lds
    buffer_load_dwordx4 v223, s[72:75], s41 offen offset:1024 sc1 lds
    v_permlane32_swap_b32 v242, v236
    v_permlane32_swap_b32 v243, v237
    s_add_u32 s38, s38, 1
    v_mfma_f32_32x32x16_bf16 v[32:47], v[64:67], v[180:183], 0
    v_permlane32_swap_b32 v244, v238
    v_permlane32_swap_b32 v245, v239
    v_permlane32_swap_b32 v240, v241
    v_add_f32 v242, v242, v236
    v_mfma_f32_32x32x16_bf16 v[48:63], v[68:71], v[180:183], 0
    v_add_f32 v243, v243, v237
    v_add_f32 v244, v244, v238
    v_add_f32 v245, v245, v239
    v_add_f32 v240, -v240, -v241
    v_mov_b32 v254, s52
    v_mov_b32 v255, s38
    s_waitcnt vmcnt(4) lgkmcnt(0)
    v_mfma_f32_32x32x16_bf16 v[0:15], v[72:75], v[184:187], v[0:15]
    ds_read_b64_tr_b16 v[176:177], v246 offset:4096
    ds_read_b64_tr_b16 v[178:179], v246 offset:4608
    ds_read_b64_tr_b16 v[180:181], v247 offset:4096
    ds_read_b64_tr_b16 v[182:183], v247 offset:4608
    s_lshl_b32 s58, s38, 3
    s_add_u32 s58, s58, s20
    s_mov_b32 m0, s69
    v_mfma_f32_32x32x16_bf16 v[16:31], v[76:79], v[184:187], v[16:31]
    buffer_load_dwordx4 v224, s[4:7], s41 offen sc1 lds
    buffer_load_dwordx4 v225, s[72:75], s41 offen offset:1024 sc1 lds
    s_set_gpr_idx_on s32, gpr_idx(DST)
    s_nop 0
    v_cvt_pk_bf16_f32 v195, v242, v243
    v_cvt_pk_bf16_f32 v196, v244, v245
    v_cvt_pk_bf16_f32 v197, v240, v240
    s_set_gpr_idx_off
    s_mov_b64 exec, 1
    ds_write_b32 v254, v255
    s_mov_b64 exec, -1
    s_cmp_lt_u32 s58, s22
    s_cbranch_scc0 K2_dyn_61
K2_back_62:
    v_readlane_b32 s3, v253, s58
    s_lshl_b32 s44, s34, 7
    s_and_b32 s48, s3, 0x3ffff
    s_bfe_u32 s33, s3, 0x30012
    s_mul_i32 s35, s38, 6
    s_cmp_eq_u32 s34, 0
    s_cselect_b32 s35, s35, s48
    s_mov_b32 s45, s44
    s_add_u32 s47, s44, 256
    s_add_u32 s49, s48, 32
    s_add_u32 s60, s48, 64
    s_cmp_eq_u32 s33, 3
    s_cselect_b32 s46, s44, s47
    s_cselect_b32 s50, s60, s48
    s_cselect_b32 s51, s48, s49
    s_sub_u32 s60, s33, 2
    s_cmp_lt_u32 s60, 2
    s_cbranch_scc0 K2_rare_67
K2_back_68:
    v_mfma_f32_32x32x16_bf16 v[32:47], v[72:75], v[188:191], v[32:47]
    v_add_u32 v233, s48, v230
    ds_read_b32 v232, v233
    ds_read_b32 v233, v233 offset:1024
    v_mfma_f32_32x32x16_bf16 v[48:63], v[76:79], v[188:191], v[48:63]
    s_waitcnt vmcnt(4) lgkmcnt(3)
    v_mfma_f32_32x32x16_bf16 v[0:15], v[80:83], v[176:179], v[0:15]
    ds_read_b64_tr_b16 v[184:185], v246 offset:6144
    ds_read_b64_tr_b16 v[186:187], v246 offset:6656
    ds_read_b64_tr_b16 v[188:189], v247 offset:6144
    ds_read_b64_tr_b16 v[190:191], v247 offset:6656
    s_mov_b32 m0, s70
    v_mfma_f32_32x32x16_bf16 v[16:31], v[84:87], v[176:179], v[16:31]
    buffer_load_dwordx4 v226, s[4:7], s41 offen sc1 lds
    buffer_load_dwordx4 v227, s[72:75], s41 offen offset:1024 sc1 lds
    v_mfma_f32_32x32x16_bf16 v[32:47], v[80:83], v[180:183], v[32:47]
    v_mfma_f32_32x32x16_bf16 v[48:63], v[84:87], v[180:183], v[48:63]
    s_waitcnt lgkmcnt(4)
    v_or_b32 v232, v232, v231
    v_or_b32 v233, v233, v231
    s_cmp_lg_u32 s34, 0
    s_cbranch_scc1 K2_dum_70
    s_add_u32 m0, s48, 480
    s_add_u32 s65, s48, 1504
    buffer_load_dwordx4 v232, s[16:19], 0 offen  lds
    s_mov_b32 m0, s65
    s_mov_b32 exec_hi, 0
    buffer_load_dwordx4 v233, s[16:19], 0 offen  lds
    s_cmp_eq_u32 s33, 4
    s_cbranch_scc1 K2_a4_71
K2_b4_73:
    s_mov_b32 exec_hi, -1
K2_back_72:
    s_waitcnt vmcnt(6) lgkmcnt(0)
    v_mfma_f32_32x32x16_bf16 v[0:15], v[88:91], v[184:187], v[0:15]
    ds_read_b64_tr_b16 v[176:177], v246 offset:0
    ds_read_b64_tr_b16 v[178:179], v246 offset:512
    ds_read_b64_tr_b16 v[180:181], v247 offset:0
    ds_read_b64_tr_b16 v[182:183], v247 offset:512
    s_mov_b32 m0, s71
    v_mfma_f32_32x32x16_bf16 v[16:31], v[92:95], v[184:187], v[16:31]
    buffer_load_dwordx4 v228, s[4:7], s41 offen sc1 lds
    buffer_load_dwordx4 v229, s[72:75], s41 offen offset:1024 sc1 lds
    v_mfma_f32_32x32x16_bf16 v[32:47], v[88:91], v[188:191], v[32:47]
    s_nop 2
    v_mul_f32 v234, v0, v96
    v_mul_f32 v236, v8, v128
    v_fmac_f32 v234, v1, v97
    v_fmac_f32 v236, v9, v129
    v_fmac_f32 v234, v2, v98
    v_fmac_f32 v236, v10, v130
    v_fmac_f32 v234, v3, v99
    v_mfma_f32_32x32x16_bf16 v[48:63], v[92:95], v[188:191], v[48:63]
    s_setprio 0
    v_fmac_f32 v236, v11, v131
    v_fmac_f32 v234, v4, v100
    v_fmac_f32 v236, v12, v132
    v_fmac_f32 v234, v5, v101
    v_fmac_f32 v236, v13, v133
    v_fmac_f32 v234, v6, v102
    v_fmac_f32 v236, v14, v134
    v_fmac_f32 v234, v7, v103
    v_fmac_f32 v236, v15, v135
    v_mul_f32 v238, v16, v128
    v_mul_f32 v240, v24, v128
    v_fmac_f32 v238, v17, v129
    v_fmac_f32 v240, v25, v129
    v_fmac_f32 v238, v18, v130
    v_fmac_f32 v240, v26, v130
    v_fmac_f32 v238, v19, v131
    v_fmac_f32 v240, v27, v131
    v_fmac_f32 v238, v20, v132
    v_fmac_f32 v240, v28, v132
    v_fmac_f32 v238, v21, v133
    v_fmac_f32 v240, v29, v133
    v_fmac_f32 v238, v22, v134
    v_fmac_f32 v240, v30, v134
    v_fmac_f32 v238, v23, v135
    v_fmac_f32 v240, v31, v135
    v_mul_f32 v235, v32, v104
    v_mul_f32 v237, v40, v136
    v_fmac_f32 v235, v33, v105
    v_fmac_f32 v237, v41, v137
    v_fmac_f32 v235, v34, v106
    v_fmac_f32 v237, v42, v138
    v_fmac_f32 v235, v35, v107
    v_fmac_f32 v237, v43, v139
    v_fmac_f32 v235, v36, v108
    v_fmac_f32 v237, v44, v140
    v_fmac_f32 v235, v37, v109
    v_fmac_f32 v237, v45, v141
    v_fmac_f32 v235, v38, v110
    v_fmac_f32 v237, v46, v142
    v_fmac_f32 v235, v39, v111
    v_fmac_f32 v237, v47, v143
    v_mul_f32 v239, v48, v136
    v_mul_f32 v241, v56, v136
    s_setprio 1
    s_waitcnt vmcnt(6) lgkmcnt(0)
    v_mfma_f32_32x32x16_bf16 v[0:15], v[64:67], v[176:179], 0
    ds_read_b64_tr_b16 v[184:185], v246 offset:2048
    ds_read_b64_tr_b16 v[186:187], v246 offset:2560
    ds_read_b64_tr_b16 v[188:189], v247 offset:2048
    ds_read_b64_tr_b16 v[190:191], v247 offset:2560
    v_fmac_f32 v239, v49, v137
    v_fmac_f32 v241, v57, v137
    s_mov_b32 m0, s68
    v_mfma_f32_32x32x16_bf16 v[16:31], v[68:71], v[176:179], 0
    buffer_load_dwordx4 v222, s[4:7], s42 offen sc1 lds
    buffer_load_dwordx4 v223, s[72:75], s42 offen offset:1024 sc1 lds
    v_fmac_f32 v239, v50, v138
    v_fmac_f32 v241, v58, v138
    v_fmac_f32 v239, v51, v139
    v_fmac_f32 v241, v59, v139
    v_fmac_f32 v239, v52, v140
    v_mfma_f32_32x32x16_bf16 v[32:47], v[64:67], v[180:183], 0
    v_fmac_f32 v241, v60, v140
    v_fmac_f32 v239, v53, v141
    v_fmac_f32 v241, v61, v141
    v_fmac_f32 v239, v54, v142
    v_fmac_f32 v241, v62, v142
    v_fmac_f32 v239, v55, v143
    v_fmac_f32 v241, v63, v143
    v_mfma_f32_32x32x16_bf16 v[48:63], v[68:71], v[180:183], 0
    v_permlane32_swap_b32 v234, v236
    v_permlane32_swap_b32 v235, v237
    v_permlane32_swap_b32 v240, v238
    s_waitcnt vmcnt(6) lgkmcnt(0)
    v_mfma_f32_32x32x16_bf16 v[0:15], v[72:75], v[184:187], v[0:15]
    ds_read_b64_tr_b16 v[176:177], v246 offset:4096
    ds_read_b64_tr_b16 v[178:179], v246 offset:4608
    ds_read_b64_tr_b16 v[180:181], v247 offset:4096
    ds_read_b64_tr_b16 v[182:183], v247 offset:4608
    v_permlane32_swap_b32 v241, v239
    s_mov_b32 m0, s69
    v_mfma_f32_32x32x16_bf16 v[16:31], v[76:79], v[184:187], v[16:31]
    buffer_load_dwordx4 v224, s[4:7], s42 offen sc1 lds
    buffer_load_dwordx4 v225, s[72:75], s42 offen offset:1024 sc1 lds
    v_add_f32 v234, v234, v236
    v_add_f32 v235, v235, v237
    v_add_f32 v240, v240, v238
    v_add_f32 v241, v241, v239
    v_mfma_f32_32x32x16_bf16 v[32:47], v[72:75], v[188:191], v[32:47]
    s_set_gpr_idx_on s31, gpr_idx(DST)
    s_nop 0
    v_cvt_pk_bf16_f32 v192, v234, v235
    v_cvt_pk_bf16_f32 v193, v240, v241
    s_set_gpr_idx_off
    v_mfma_f32_32x32x16_bf16 v[48:63], v[76:79], v[188:191], v[48:63]
    s_waitcnt vmcnt(4) lgkmcnt(0)
    v_mfma_f32_32x32x16_bf16 v[0:15], v[80:83], v[176:179], v[0:15]
    ds_read_b64_tr_b16 v[184:185], v246 offset:6144
    ds_read_b64_tr_b16 v[186:187], v246 offset:6656
    ds_read_b64_tr_b16 v[188:189], v247 offset:6144
    ds_read_b64_tr_b16 v[190:191], v247 offset:6656
    s_mov_b32 m0, s70
    v_mfma_f32_32x32x16_bf16 v[16:31], v[84:87], v[176:179], v[16:31]
    buffer_load_dwordx4 v226, s[4:7], s42 offen sc1 lds
    buffer_load_dwordx4 v227, s[72:75], s42 offen offset:1024 sc1 lds
    v_mfma_f32_32x32x16_bf16 v[32:47], v[80:83], v[180:183], v[32:47]
    v_mfma_f32_32x32x16_bf16 v[48:63], v[84:87], v[180:183], v[48:63]
    s_waitcnt vmcnt(4) lgkmcnt(0)
    v_mfma_f32_32x32x16_bf16 v[0:15], v[88:91], v[184:187], v[0:15]
    ds_read_b64_tr_b16 v[176:177], v246 offset:0
    ds_read_b64_tr_b16 v[178:179], v246 offset:512
    ds_read_b64_tr_b16 v[180:181], v247 offset:0
    ds_read_b64_tr_b16 v[182:183], v247 offset:512
    s_mov_b32 m0, s71
    v_mfma_f32_32x32x16_bf16 v[16:31], v[92:95], v[184:187], v[16:31]
    buffer_load_dwordx4 v228, s[4:7], s42 offen sc1 lds
    buffer_load_dwordx4 v229, s[72:75], s42 offen offset:1024 sc1 lds
    v_mfma_f32_32x32x16_bf16 v[32:47], v[88:91], v[188:191], v[32:47]
    s_nop 2
    v_mul_f32 v234, v0, v144
    v_mul_f32 v236, v8, v112
    v_fmac_f32 v234, v1, v145
    v_fmac_f32 v236, v9, v113
    v_fmac_f32 v234, v2, v146
    v_fmac_f32 v236, v10, v114
    v_fmac_f32 v234, v3, v147
    v_mfma_f32_32x32x16_bf16 v[48:63], v[92:95], v[188:191], v[48:63]
    s_setprio 0
    v_fmac_f32 v236, v11, v115
    v_fmac_f32 v234, v4, v148
    v_fmac_f32 v236, v12, v116
    v_fmac_f32 v234, v5, v149
    v_fmac_f32 v236, v13, v117
    v_fmac_f32 v234, v6, v150
    v_fmac_f32 v236, v14, v118
    v_fmac_f32 v234, v7, v151
    v_fmac_f32 v236, v15, v119
    v_mul_f32 v238, v16, v160
    v_mul_f32 v240, v24, v160
    v_fmac_f32 v238, v17, v161
    v_fmac_f32 v240, v25, v161
    v_fmac_f32 v238, v18, v162
    v_fmac_f32 v240, v26, v162
    v_fmac_f32 v238, v19, v163
    v_fmac_f32 v240, v27, v163
    v_fmac_f32 v238, v20, v164
    v_fmac_f32 v240, v28, v164
    v_fmac_f32 v238, v21, v165
    v_fmac_f32 v240, v29, v165
    v_fmac_f32 v238, v22, v166
    v_fmac_f32 v240, v30, v166
    v_fmac_f32 v238, v23, v167
    v_fmac_f32 v240, v31, v167
    v_mul_f32 v235, v32, v152
    v_mul_f32 v237, v40, v120
    v_fmac_f32 v235, v33, v153
    v_fmac_f32 v237, v41, v121
    v_fmac_f32 v235, v34, v154
    v_fmac_f32 v237, v42, v122
    v_fmac_f32 v235, v35, v155
    v_fmac_f32 v237, v43, v123
    v_fmac_f32 v235, v36, v156
    v_fmac_f32 v237, v44, v124
    v_fmac_f32 v235, v37, v157
    v_fmac_f32 v237, v45, v125
    v_fmac_f32 v235, v38, v158
    v_fmac_f32 v237, v46, v126
    v_fmac_f32 v235, v39, v159
    v_fmac_f32 v237, v47, v127
    v_mul_f32 v239, v48, v168
    v_mul_f32 v241, v56, v168
    s_setprio 1
    s_waitcnt vmcnt(4) lgkmcnt(0)
    v_mfma_f32_32x32x16_bf16 v[0:15], v[64:67], v[176:179], 0
    ds_read_b64_tr_b16 v[184:185], v246 offset:2048
    ds_read_b64_tr_b16 v[186:187], v246 offset:2560
    ds_read_b64_tr_b16 v[188:189], v247 offset:2048
    ds_read_b64_tr_b16 v[190:191], v247 offset:2560
    v_fmac_f32 v239, v49, v169
    v_fmac_f32 v241, v57, v169
    s_mov_b32 m0, s68
    v_mfma_f32_32x32x16_bf16 v[16:31], v[68:71], v[176:179], 0
    buffer_load_dwordx4 v222, s[4:7], s43 offen sc1 lds
    buffer_load_dwordx4 v223, s[72:75], s43 offen offset:1024 sc1 lds
    v_fmac_f32 v239, v50, v170
    v_fmac_f32 v241, v58, v170
    v_fmac_f32 v239, v51, v171
    v_fmac_f32 v241, v59, v171
    v_fmac_f32 v239, v52, v172
    v_mfma_f32_32x32x16_bf16 v[32:47], v[64:67], v[180:183], 0
    v_fmac_f32 v241, v60, v172
    v_fmac_f32 v239, v53, v173
    v_fmac_f32 v241, v61, v173
    v_fmac_f32 v239, v54, v174
    v_fmac_f32 v241, v62, v174
    v_fmac_f32 v239, v55, v175
    v_fmac_f32 v241, v63, v175
    v_mfma_f32_32x32x16_bf16 v[48:63], v[68:71], v[180:183], 0
    s_waitcnt vmcnt(4) lgkmcnt(0)
    v_mfma_f32_32x32x16_bf16 v[0:15], v[72:75], v[184:187], v[0:15]
    ds_read_b64_tr_b16 v[176:177], v246 offset:4096
    ds_read_b64_tr_b16 v[178:179], v246 offset:4608
    ds_read_b64_tr_b16 v[180:181], v247 offset:4096
    ds_read_b64_tr_b16 v[182:183], v247 offset:4608
    s_mov_b32 m0, s69
    v_mfma_f32_32x32x16_bf16 v[16:31], v[76:79], v[184:187], v[16:31]
    buffer_load_dwordx4 v224, s[4:7], s43 offen sc1 lds
    buffer_load_dwordx4 v225, s[72:75], s43 offen offset:1024 sc1 lds
    v_mfma_f32_32x32x16_bf16 v[32:47], v[72:75], v[188:191], v[32:47]
    v_mfma_f32_32x32x16_bf16 v[48:63], v[76:79], v[188:191], v[48:63]
    s_waitcnt vmcnt(4) lgkmcnt(0)
    v_mfma_f32_32x32x16_bf16 v[0:15], v[80:83], v[176:179], v[0:15]
    ds_read_b64_tr_b16 v[184:185], v246 offset:6144
    ds_read_b64_tr_b16 v[186:187], v246 offset:6656
    ds_read_b64_tr_b16 v[188:189], v247 offset:6144
    ds_read_b64_tr_b16 v[190:191], v247 offset:6656
    s_mov_b32 m0, s70
    v_mfma_f32_32x32x16_bf16 v[16:31], v[84:87], v[176:179], v[16:31]
    buffer_load_dwordx4 v226, s[4:7], s43 offen sc1 lds
    buffer_load_dwordx4 v227, s[72:75], s43 offen offset:1024 sc1 lds
    v_mfma_f32_32x32x16_bf16 v[32:47], v[80:83], v[180:183], v[32:47]
    v_add_u32 v222, s48, v251
    ds_read_b32 v222, v222
    v_mfma_f32_32x32x16_bf16 v[48:63], v[84:87], v[180:183], v[48:63]
    s_waitcnt vmcnt(4) lgkmcnt(1)
    v_mfma_f32_32x32x16_bf16 v[0:15], v[88:91], v[184:187], v[0:15]
    ds_read_b64_tr_b16 v[176:177], v246 offset:0
    ds_read_b64_tr_b16 v[178:179], v246 offset:512
    ds_read_b64_tr_b16 v[180:181], v247 offset:0
    ds_read_b64_tr_b16 v[182:183], v247 offset:512
    s_mov_b32 m0, s71
    v_mfma_f32_32x32x16_bf16 v[16:31], v[92:95], v[184:187], v[16:31]
    buffer_load_dwordx4 v228, s[4:7], s43 offen sc1 lds
    buffer_load_dwordx4 v229, s[72:75], s43 offen offset:1024 sc1 lds
    s_waitcnt lgkmcnt(4)
    v_mad_u32_u16 v223, v222, s39, v248 op_sel:[1,0,0,0]
    v_mad_u32_u16 v222, v222, s39, v248
    v_mfma_f32_32x32x16_bf16 v[32:47], v[88:91], v[188:191], v[32:47]
    v_add_u32 v224, s49, v251
    ds_read_b32 v224, v224
    v_mul_f32 v242, v0, v144
    v_fma_f32 v238, v8, v160, -v238
    v_fmac_f32 v242, v1, v145
    v_fmac_f32 v238, v9, v161
    v_fmac_f32 v242, v2, v146
    v_mfma_f32_32x32x16_bf16 v[48:63], v[92:95], v[188:191], v[48:63]
    s_setprio 0
    v_fmac_f32 v238, v10, v162
    v_fmac_f32 v242, v3, v147
    v_fmac_f32 v238, v11, v163
    v_fmac_f32 v242, v4, v148
    v_fmac_f32 v238, v12, v164
    v_fmac_f32 v242, v5, v149
    v_fmac_f32 v238, v13, v165
    v_fmac_f32 v242, v6, v150
    v_fmac_f32 v238, v14, v166
    v_fmac_f32 v242, v7, v151
    v_fmac_f32 v238, v15, v167
    v_fmac_f32 v236, v16, v112
    v_mul_f32 v244, v24, v160
    v_fmac_f32 v236, v17, v113
    v_fmac_f32 v244, v25, v161
    v_fmac_f32 v236, v18, v114
    v_fmac_f32 v244, v26, v162
    v_fmac_f32 v236, v19, v115
    v_fmac_f32 v244, v27, v163
    v_fmac_f32 v236, v20, v116
    v_fmac_f32 v244, v28, v164
    v_fmac_f32 v236, v21, v117
    v_fmac_f32 v244, v29, v165
    v_fmac_f32 v236, v22, v118
    v_fmac_f32 v244, v30, v166
    v_fmac_f32 v236, v23, v119
    v_fmac_f32 v244, v31, v167
    v_mul_f32 v243, v32, v152
    v_fma_f32 v239, v40, v168, -v239
    v_fmac_f32 v243, v33, v153
    v_fmac_f32 v239, v41, v169
    v_fmac_f32 v243, v34, v154
    v_fmac_f32 v239, v42, v170
    v_fmac_f32 v243, v35, v155
    v_fmac_f32 v239, v43, v171
    v_fmac_f32 v243, v36, v156
    v_fmac_f32 v239, v44, v172
    v_fmac_f32 v243, v37, v157
    v_fmac_f32 v239, v45, v173
    v_fmac_f32 v243, v38, v158
    v_fmac_f32 v239, v46, v174
    v_fmac_f32 v243, v39, v159
    v_fmac_f32 v239, v47, v175
    v_fmac_f32 v237, v48, v120
    v_mul_f32 v245, v56, v168
    v_fmac_f32 v237, v49, v121
    v_fmac_f32 v245, v57, v169
    v_fmac_f32 v237, v50, v122
    v_fmac_f32 v245, v58, v170
    v_fmac_f32 v237, v51, v123
    s_setprio 1
    s_waitcnt vmcnt(4) lgkmcnt(1)
    v_mfma_f32_32x32x16_bf16 v[0:15], v[64:67], v[176:179], 0
    ds_read_b64_tr_b16 v[184:185], v246 offset:2048
    ds_read_b64_tr_b16 v[186:187], v246 offset:2560
    ds_read_b64_tr_b16 v[188:189], v247 offset:2048
    ds_read_b64_tr_b16 v[190:191], v247 offset:2560
    v_fmac_f32 v245, v59, v171
    v_fmac_f32 v237, v52, v124
    s_mov_b32 m0, s68
    v_mfma_f32_32x32x16_bf16 v[16:31], v[68:71], v[176:179], 0
    buffer_load_dwordx4 v222, s[4:7], s44 offen sc1 lds
    buffer_load_dwordx4 v223, s[72:75], s44 offen offset:1024 sc1 lds
    s_waitcnt lgkmcnt(4)
    v_mad_u32_u16 v225, v224, s39, v248 op_sel:[1,0,0,0]
    v_mad_u32_u16 v224, v224, s39, v248
    v_fmac_f32 v245, v60, v172
    v_fmac_f32 v237, v53, v125
    v_mfma_f32_32x32x16_bf16 v[32:47], v[64:67], v[180:183], 0
    v_add_u32 v226, s50, v251
    ds_read_b32 v226, v226
    v_fmac_f32 v245, v61, v173
    v_fmac_f32 v237, v54, v126
    v_fmac_f32 v245, v62, v174
    v_fmac_f32 v237, v55, v127
    v_fmac_f32 v245, v63, v175
    v_mfma_f32_32x32x16_bf16 v[48:63], v[68:71], v[180:183], 0
    v_permlane32_swap_b32 v242, v234
    v_permlane32_swap_b32 v243, v235
    v_add_f32 v242, v242, v234
    v_add_f32 v243, v243, v235
    s_waitcnt vmcnt(4) lgkmcnt(1)
    v_mfma_f32_32x32x16_bf16 v[0:15], v[72:75], v[184:187], v[0:15]
    ds_read_b64_tr_b16 v[176:177], v246 offset:4096
    ds_read_b64_tr_b16 v[178:179], v246 offset:4608
    ds_read_b64_tr_b16 v[180:181], v247 offset:4096
    ds_read_b64_tr_b16 v[182:183], v247 offset:4608
    s_mov_b32 m0, s69
    v_mfma_f32_32x32x16_bf16 v[16:31], v[76:79], v[184:187], v[16:31]
    buffer_load_dwordx4 v224, s[4:7], s45 offen sc1 lds
    buffer_load_dwordx4 v225, s[72:75], s45 offen offset:1024 sc1 lds
    s_waitcnt lgkmcnt(4)
    v_mad_u32_u16 v227, v226, s39, v248 op_sel:[1,0,0,0]
    v_mad_u32_u16 v226, v226, s39, v248
    v_mfma_f32_32x32x16_bf16 v[32:47], v[72:75], v[188:191], v[32:47]
    v_add_u32 v228, s51, v251
    ds_read_b32 v228, v228
    s_set_gpr_idx_on s31, gpr_idx(DST)
    s_nop 0
    v_cvt_pk_bf16_f32 v194, v242, v243
    s_set_gpr_idx_off
    v_mfma_f32_32x32x16_bf16 v[48:63], v[76:79], v[188:191], v[48:63]
    s_waitcnt vmcnt(4) lgkmcnt(1)
    v_mfma_f32_32x32x16_bf16 v[0:15], v[80:83], v[176:179], v[0:15]
    ds_read_b64_tr_b16 v[184:185], v246 offset:6144
    ds_read_b64_tr_b16 v[186:187], v246 offset:6656
    ds_read_b64_tr_b16 v[188:189], v247 offset:6144
    ds_read_b64_tr_b16 v[190:191], v247 offset:6656
    s_mov_b32 s32, s31
    s_mov_b32 s31, s35
    s_mov_b32 m0, s70
    v_mfma_f32_32x32x16_bf16 v[16:31], v[84:87], v[176:179], v[16:31]
    buffer_load_dwordx4 v226, s[4:7], s46 offen sc1 lds
    buffer_load_dwordx4 v227, s[72:75], s46 offen offset:1024 sc1 lds
    s_waitcnt lgkmcnt(4)
    v_mad_u32_u16 v229, v228, s39, v248 op_sel:[1,0,0,0]
    v_mad_u32_u16 v228, v228, s39, v248
    s_sub_u32 s26, s48, s29
    s_mov_b32 s29, s48
    v_mfma_f32_32x32x16_bf16 v[32:47], v[80:83], v[180:183], v[32:47]
    s_mov_b32 s30, s3
    s_cmp_eq_u32 s34, 0
    s_cselect_b32 s56, s33, 0
    v_mfma_f32_32x32x16_bf16 v[48:63], v[84:87], v[180:183], v[48:63]
    s_waitcnt vmcnt(4) lgkmcnt(0)
    v_mfma_f32_32x32x16_bf16 v[0:15], v[88:91], v[184:187], v[0:15]
    ds_read_b64_tr_b16 v[176:177], v246 offset:0
    ds_read_b64_tr_b16 v[178:179], v246 offset:512
    ds_read_b64_tr_b16 v[180:181], v247 offset:0
    ds_read_b64_tr_b16 v[182:183], v247 offset:512
    s_mov_b32 m0, s71
    v_mfma_f32_32x32x16_bf16 v[16:31], v[92:95], v[184:187], v[16:31]
    buffer_load_dwordx4 v228, s[4:7], s47 offen sc1 lds
    buffer_load_dwordx4 v229, s[72:75], s47 offen offset:1024 sc1 lds
    v_mfma_f32_32x32x16_bf16 v[32:47], v[88:91], v[188:191], v[32:47]
    s_nop 2
    v_mul_f32 v242, v0, v144
    v_fma_f32 v240, v8, v160, -v240
    v_fmac_f32 v242, v1, v145
    v_fmac_f32 v240, v9, v161
    v_fmac_f32 v242, v2, v146
    v_fmac_f32 v240, v10, v162
    v_fmac_f32 v242, v3, v147
    v_mfma_f32_32x32x16_bf16 v[48:63], v[92:95], v[188:191], v[48:63]
    s_setprio 0
    v_fmac_f32 v240, v11, v163
    v_fmac_f32 v242, v4, v148
    v_fmac_f32 v240, v12, v164
    v_fmac_f32 v242, v5, v149
    v_fmac_f32 v240, v13, v165
    v_fmac_f32 v242, v6, v150
    v_fmac_f32 v240, v14, v166
    v_fmac_f32 v242, v7, v151
    v_fmac_f32 v240, v15, v167
    v_add_u32 v249, s26, v249
    v_add_u32 v250, s26, v250
    v_fma_f32 v244, v16, v160, -v244
    v_fmac_f32 v236, v24, v112
    v_fmac_f32 v244, v17, v161
    v_fmac_f32 v236, v25, v113
    v_fmac_f32 v244, v18, v162
    v_fmac_f32 v236, v26, v114
    v_fmac_f32 v244, v19, v163
    v_fmac_f32 v236, v27, v115
    v_fmac_f32 v244, v20, v164
    v_fmac_f32 v236, v28, v116
    v_fmac_f32 v244, v21, v165
    v_fmac_f32 v236, v29, v117
    v_fmac_f32 v244, v22, v166
    v_fmac_f32 v236, v30, v118
    v_fmac_f32 v244, v23, v167
    v_fmac_f32 v236, v31, v119
    ds_read_b64_tr_b16 v[0:1], v249 offset:0
    ds_read_b64_tr_b16 v[2:3], v249 offset:256
    ds_read_u16_d16_hi v16, v250 offset:0
    v_mul_f32 v243, v32, v152
    v_fma_f32 v241, v40, v168, -v241
    v_fmac_f32 v243, v33, v153
    v_fmac_f32 v241, v41, v169
    v_fmac_f32 v243, v34, v154
    v_fmac_f32 v241, v42, v170
    v_fmac_f32 v243, v35, v155
    v_fmac_f32 v241, v43, v171
    v_fmac_f32 v243, v36, v156
    v_fmac_f32 v241, v44, v172
    v_fmac_f32 v243, v37, v157
    v_fmac_f32 v241, v45, v173
    v_fmac_f32 v243, v38, v158
    v_fmac_f32 v241, v46, v174
    v_fmac_f32 v243, v39, v159
    v_fmac_f32 v241, v47, v175
    ds_read_b64_tr_b16 v[4:5], v249 offset:512
    ds_read_b64_tr_b16 v[6:7], v249 offset:768
    ds_read_u16_d16_hi v17, v250 offset:32
    v_fma_f32 v245, v48, v168, -v245
    v_fmac_f32 v237, v56, v120
    v_fmac_f32 v245, v49, v169
    v_fmac_f32 v237, v57, v121
    v_fmac_f32 v245, v50, v170
    v_fmac_f32 v237, v58, v122
    v_fmac_f32 v245, v51, v171
    v_fmac_f32 v237, v59, v123
    v_fmac_f32 v245, v52, v172
    v_fmac_f32 v237, v60, v124
    v_fmac_f32 v245, v53, v173
    v_fmac_f32 v237, v61, v125
    v_fmac_f32 v245, v54, v174
    v_fmac_f32 v237, v62, v126
    v_fmac_f32 v245, v55, v175
    v_fmac_f32 v237, v63, v127
    s_cmp_eq_u32 s56, 2
    s_cbranch_scc1 K2_U20
    s_cmp_eq_u32 s56, 3
    s_cbranch_scc1 K2_U30
    s_branch K2_DSP0
K2_U11:
    s_setprio 1
    v_mov_b32 v254, 160704
    v_mov_b32 v255, 1
    v_lshl_add_u32 v233, v252, 1, s53
    s_mov_b64 exec, 1
    ds_add_rtn_u32 v232, v254, v255
    s_mov_b64 exec, -1
    ds_read_b32 v233, v233
    s_waitcnt lgkmcnt(5)
    v_lshlrev_b32 v20, 16, v0
    v_and_b32 v21, 0xffff0000, v0
    v_lshlrev_b32 v22, 16, v1
    v_and_b32 v23, 0xffff0000, v1
    v_lshlrev_b32 v24, 16, v2
    v_and_b32 v25, 0xffff0000, v2
    v_lshlrev_b32 v26, 16, v3
    v_and_b32 v27, 0xffff0000, v3
    v_mul_f32_dpp v36, v16, v20 row_newbcast:0 row_mask:0xf bank_mask:0xf
    v_mul_f32_dpp v37, v16, v21 row_newbcast:1 row_mask:0xf bank_mask:0xf
    v_mul_f32_dpp v38, v16, v22 row_newbcast:2 row_mask:0xf bank_mask:0xf
    v_mul_f32_dpp v39, v16, v23 row_newbcast:3 row_mask:0xf bank_mask:0xf
    v_mul_f32_dpp v40, v16, v24 row_newbcast:4 row_mask:0xf bank_mask:0xf
    v_mul_f32_dpp v41, v16, v25 row_newbcast:5 row_mask:0xf bank_mask:0xf
    v_mul_f32_dpp v42, v16, v26 row_newbcast:6 row_mask:0xf bank_mask:0xf
    v_mul_f32_dpp v43, v16, v27 row_newbcast:7 row_mask:0xf bank_mask:0xf
    v_cvt_pk_bf16_f32 v64, v36, v37
    v_cvt_pk_bf16_f32 v65, v38, v39
    v_cvt_pk_bf16_f32 v66, v40, v41
    v_cvt_pk_bf16_f32 v67, v42, v43
    v_mul_f32_dpp v44, v16, v20 row_newbcast:8 row_mask:0xf bank_mask:0xf
    v_mul_f32_dpp v45, v16, v21 row_newbcast:9 row_mask:0xf bank_mask:0xf
    v_mul_f32_dpp v46, v16, v22 row_newbcast:10 row_mask:0xf bank_mask:0xf
    v_mul_f32_dpp v47, v16, v23 row_newbcast:11 row_mask:0xf bank_mask:0xf
    v_mul_f32_dpp v48, v16, v24 row_newbcast:12 row_mask:0xf bank_mask:0xf
    v_mul_f32_dpp v49, v16, v25 row_newbcast:13 row_mask:0xf bank_mask:0xf
    v_mul_f32_dpp v50, v16, v26 row_newbcast:14 row_mask:0xf bank_mask:0xf
    v_mul_f32_dpp v51, v16, v27 row_newbcast:15 row_mask:0xf bank_mask:0xf
    v_cvt_pk_bf16_f32 v68, v44, v45
    v_cvt_pk_bf16_f32 v69, v46, v47
    v_cvt_pk_bf16_f32 v70, v48, v49
    v_cvt_pk_bf16_f32 v71, v50, v51
    s_waitcnt lgkmcnt(0)
    v_readfirstlane_b32 s58, v232
    s_nop 0
    s_cmp_lt_u32 s58, s22
    s_cbranch_scc0 K2_nul_74
    s_and_b32 s59, s58, 7
    s_lshr_b32 s60, s58, 3
K2_chk_76:
    v_readlane_b32 s61, v233, s59
    s_nop 0
    s_cmp_gt_u32 s61, s60
    s_cbranch_scc0 K2_spin_75
K2_back_77:
    v_readlane_b32 s3, v253, s58
    s_lshl_b32 s44, s34, 7
    s_and_b32 s48, s3, 0x3ffff
    s_bfe_u32 s33, s3, 0x30012
    s_mov_b32 s35, s48
    s_mov_b32 s45, s44
    s_add_u32 s47, s44, 256
    s_add_u32 s49, s48, 32
    s_add_u32 s60, s48, 64
    s_cmp_eq_u32 s33, 3
    s_cselect_b32 s46, s44, s47
    s_cselect_b32 s50, s60, s48
    s_cselect_b32 s51, s48, s49
    s_sub_u32 s60, s33, 2
    s_cmp_lt_u32 s60, 2
    s_cbranch_scc0 K2_rare_78
K2_back_79:
    v_add_u32 v222, s48, v251
    ds_read_b32 v222, v222
    v_add_u32 v224, s49, v251
    ds_read_b32 v224, v224
    v_add_u32 v226, s50, v251
    ds_read_b32 v226, v226
    v_add_u32 v228, s51, v251
    ds_read_b32 v228, v228
    s_waitcnt lgkmcnt(3)
    v_mad_u32_u16 v223, v222, s39, v248 op_sel:[1,0,0,0]
    v_mad_u32_u16 v222, v222, s39, v248
    s_waitcnt lgkmcnt(2)
    v_mad_u32_u16 v225, v224, s39, v248 op_sel:[1,0,0,0]
    v_mad_u32_u16 v224, v224, s39, v248
    s_waitcnt lgkmcnt(1)
    v_mad_u32_u16 v227, v226, s39, v248 op_sel:[1,0,0,0]
    v_mad_u32_u16 v226, v226, s39, v248
    s_waitcnt lgkmcnt(0)
    v_mad_u32_u16 v229, v228, s39, v248 op_sel:[1,0,0,0]
    v_mad_u32_u16 v228, v228, s39, v248
    s_waitcnt vmcnt(4)
    v_mfma_f32_32x32x16_bf16 v[0:15], v[64:67], v[176:179], 0
    ds_read_b64_tr_b16 v[184:185], v246 offset:2048
    ds_read_b64_tr_b16 v[186:187], v246 offset:2560
    ds_read_b64_tr_b16 v[188:189], v247 offset:2048
    ds_read_b64_tr_b16 v[190:191], v247 offset:2560
    s_mov_b32 m0, s68
    v_mfma_f32_32x32x16_bf16 v[16:31], v[68:71], v[176:179], 0
    buffer_load_dwordx4 v222, s[4:7], s44 offen sc1 lds
    buffer_load_dwordx4 v223, s[72:75], s44 offen offset:1024 sc1 lds
    v_permlane32_swap_b32 v242, v236
    v_permlane32_swap_b32 v243, v237
    v_mfma_f32_32x32x16_bf16 v[32:47], v[64:67], v[180:183], 0
    v_permlane32_swap_b32 v244, v238
    v_permlane32_swap_b32 v245, v239
    v_permlane32_swap_b32 v240, v241
    v_add_f32 v242, v242, v236
    v_mfma_f32_32x32x16_bf16 v[48:63], v[68:71], v[180:183], 0
    s_setprio 0
    v_add_f32 v243, v243, v237
    v_add_f32 v244, v244, v238
    v_add_f32 v245, v245, v239
    v_add_f32 v240, -v240, -v241
    v_sub_u32 v241, v230, v231
    v_cvt_pk_bf16_f32 v242, v242, v243
    v_cvt_pk_bf16_f32 v244, v244, v245
    v_cvt_pk_bf16_f32 v240, v240, v240
    ds_write_b32 v230, v242 offset:768
    ds_write_b32 v230, v244 offset:1024
    ds_write_b16 v241, v240 offset:1280
    v_mul_f32 v234, v0, v96
    v_mul_f32 v236, v8, v128
    v_fmac_f32 v234, v1, v97
    v_fmac_f32 v236, v9, v129
    v_fmac_f32 v234, v2, v98
    v_fmac_f32 v236, v10, v130
    v_fmac_f32 v234, v3, v99
    v_fmac_f32 v236, v11, v131
    v_fmac_f32 v234, v4, v100
    v_fmac_f32 v236, v12, v132
    v_fmac_f32 v234, v5, v101
    v_fmac_f32 v236, v13, v133
    v_fmac_f32 v234, v6, v102
    v_fmac_f32 v236, v14, v134
    v_fmac_f32 v234, v7, v103
    v_fmac_f32 v236, v15, v135
    v_mul_f32 v238, v16, v128
    v_mul_f32 v240, v24, v128
    v_fmac_f32 v238, v17, v129
    v_fmac_f32 v240, v25, v129
    v_fmac_f32 v238, v18, v130
    v_fmac_f32 v240, v26, v130
    v_fmac_f32 v238, v19, v131
    v_fmac_f32 v240, v27, v131
    v_fmac_f32 v238, v20, v132
    v_fmac_f32 v240, v28, v132
    v_fmac_f32 v238, v21, v133
    v_fmac_f32 v240, v29, v133
    v_fmac_f32 v238, v22, v134
    v_fmac_f32 v240, v30, v134
    v_fmac_f32 v238, v23, v135
    v_fmac_f32 v240, v31, v135
    v_mul_f32 v235, v32, v104
    v_mul_f32 v237, v40, v136
    v_fmac_f32 v235, v33, v105
    v_fmac_f32 v237, v41, v137
    v_fmac_f32 v235, v34, v106
    v_fmac_f32 v237, v42, v138
    v_fmac_f32 v235, v35, v107
    v_fmac_f32 v237, v43, v139
    v_fmac_f32 v235, v36, v108
    v_fmac_f32 v237, v44, v140
    v_fmac_f32 v235, v37, v109
    v_fmac_f32 v237, v45, v141
    v_fmac_f32 v235, v38, v110
    v_fmac_f32 v237, v46, v142
    v_fmac_f32 v235, v39, v111
    v_fmac_f32 v237, v47, v143
    v_mul_f32 v239, v48, v136
    v_mul_f32 v241, v56, v136
    v_fmac_f32 v239, v49, v137
    v_fmac_f32 v241, v57, v137
    v_fmac_f32 v239, v50, v138
    v_fmac_f32 v241, v58, v138
    v_fmac_f32 v239, v51, v139
    v_fmac_f32 v241, v59, v139
    v_fmac_f32 v239, v52, v140
    v_fmac_f32 v241, v60, v140
    v_fmac_f32 v239, v53, v141
    v_fmac_f32 v241, v61, v141
    v_fmac_f32 v239, v54, v142
    v_fmac_f32 v241, v62, v142
    v_fmac_f32 v239, v55, v143
    v_fmac_f32 v241, v63, v143
    s_setprio 1
    s_waitcnt vmcnt(4) lgkmcnt(3)
    v_mfma_f32_32x32x16_bf16 v[0:15], v[64:67], v[184:187], 0
    ds_read_b64_tr_b16 v[176:177], v246 offset:4096
    ds_read_b64_tr_b16 v[178:179], v246 offset:4608
    ds_read_b64_tr_b16 v[180:181], v247 offset:4096
    ds_read_b64_tr_b16 v[182:183], v247 offset:4608
    s_mov_b32 m0, s69
    v_mfma_f32_32x32x16_bf16 v[16:31], v[68:71], v[184:187], 0
    buffer_load_dwordx4 v224, s[4:7], s45 offen sc1 lds
    buffer_load_dwordx4 v225, s[72:75], s45 offen offset:1024 sc1 lds
    v_permlane32_swap_b32 v234, v236
    v_permlane32_swap_b32 v235, v237
    v_mfma_f32_32x32x16_bf16 v[32:47], v[64:67], v[188:191], 0
    v_permlane32_swap_b32 v240, v238
    v_permlane32_swap_b32 v241, v239
    v_lshl_add_u32 v230, v252, 1, s31
    v_add_f32 v234, v234, v236
    v_add_f32 v235, v235, v237
    v_mfma_f32_32x32x16_bf16 v[48:63], v[68:71], v[188:191], 0
    s_setprio 0
    v_add_f32 v240, v240, v238
    v_add_f32 v241, v241, v239
    v_cvt_pk_bf16_f32 v234, v234, v235
    v_cvt_pk_bf16_f32 v240, v240, v241
    ds_write_b32 v230, v234 offset:0
    ds_write_b32 v230, v240 offset:256
    v_mul_f32 v234, v0, v144
    v_mul_f32 v236, v8, v112
    v_fmac_f32 v234, v1, v145
    v_fmac_f32 v236, v9, v113
    v_fmac_f32 v234, v2, v146
    v_fmac_f32 v236, v10, v114
    v_fmac_f32 v234, v3, v147
    v_fmac_f32 v236, v11, v115
    v_fmac_f32 v234, v4, v148
    v_fmac_f32 v236, v12, v116
    v_fmac_f32 v234, v5, v149
    v_fmac_f32 v236, v13, v117
    v_fmac_f32 v234, v6, v150
    v_fmac_f32 v236, v14, v118
    v_fmac_f32 v234, v7, v151
    v_fmac_f32 v236, v15, v119
    v_mul_f32 v238, v16, v160
    v_mul_f32 v240, v24, v160
    v_fmac_f32 v238, v17, v161
    v_fmac_f32 v240, v25, v161
    v_fmac_f32 v238, v18, v162
    v_fmac_f32 v240, v26, v162
    v_fmac_f32 v238, v19, v163
    v_fmac_f32 v240, v27, v163
    v_fmac_f32 v238, v20, v164
    v_fmac_f32 v240, v28, v164
    v_fmac_f32 v238, v21, v165
    v_fmac_f32 v240, v29, v165
    v_fmac_f32 v238, v22, v166
    v_fmac_f32 v240, v30, v166
    v_fmac_f32 v238, v23, v167
    v_fmac_f32 v240, v31, v167
    v_mul_f32 v235, v32, v152
    v_mul_f32 v237, v40, v120
    v_fmac_f32 v235, v33, v153
    v_fmac_f32 v237, v41, v121
    v_fmac_f32 v235, v34, v154
    v_fmac_f32 v237, v42, v122
    v_fmac_f32 v235, v35, v155
    v_fmac_f32 v237, v43, v123
    v_fmac_f32 v235, v36, v156
    v_fmac_f32 v237, v44, v124
    v_fmac_f32 v235, v37, v157
    v_fmac_f32 v237, v45, v125
    v_fmac_f32 v235, v38, v158
    v_fmac_f32 v237, v46, v126
    v_fmac_f32 v235, v39, v159
    v_fmac_f32 v237, v47, v127
    v_mul_f32 v239, v48, v168
    v_mul_f32 v241, v56, v168
    v_fmac_f32 v239, v49, v169
    v_fmac_f32 v241, v57, v169
    v_fmac_f32 v239, v50, v170
    v_fmac_f32 v241, v58, v170
    v_fmac_f32 v239, v51, v171
    v_fmac_f32 v241, v59, v171
    v_fmac_f32 v239, v52, v172
    v_fmac_f32 v241, v60, v172
    v_fmac_f32 v239, v53, v173
    v_fmac_f32 v241, v61, v173
    v_fmac_f32 v239, v54, v174
    v_fmac_f32 v241, v62, v174
    v_fmac_f32 v239, v55, v175
    v_fmac_f32 v241, v63, v175
    s_setprio 1
    s_waitcnt vmcnt(4) lgkmcnt(2)
    v_mfma_f32_32x32x16_bf16 v[0:15], v[64:67], v[176:179], 0
    ds_read_b64_tr_b16 v[184:185], v246 offset:6144
    ds_read_b64_tr_b16 v[186:187], v246 offset:6656
    ds_read_b64_tr_b16 v[188:189], v247 offset:6144
    ds_read_b64_tr_b16 v[190:191], v247 offset:6656
    s_mov_b32 s32, s31
    s_mov_b32 s31, s35
    s_mov_b32 m0, s70
    v_mfma_f32_32x32x16_bf16 v[16:31], v[68:71], v[176:179], 0
    buffer_load_dwordx4 v226, s[4:7], s46 offen sc1 lds
    buffer_load_dwordx4 v227, s[72:75], s46 offen offset:1024 sc1 lds
    s_sub_u32 s26, s48, s29
    s_mov_b32 s29, s48
    s_mov_b32 s30, s3
    s_cmp_lg_u32 s36, 0
    s_cselect_b32 s56, s33, 0
    v_mfma_f32_32x32x16_bf16 v[32:47], v[64:67], v[180:183], 0
    v_mfma_f32_32x32x16_bf16 v[48:63], v[68:71], v[180:183], 0
    s_setprio 0
    v_mul_f32 v242, v0, v144
    v_fma_f32 v238, v8, v160, -v238
    v_fmac_f32 v242, v1, v145
    v_fmac_f32 v238, v9, v161
    v_fmac_f32 v242, v2, v146
    v_fmac_f32 v238, v10, v162
    v_fmac_f32 v242, v3, v147
    v_fmac_f32 v238, v11, v163
    v_fmac_f32 v242, v4, v148
    v_fmac_f32 v238, v12, v164
    v_fmac_f32 v242, v5, v149
    v_fmac_f32 v238, v13, v165
    v_fmac_f32 v242, v6, v150
    v_fmac_f32 v238, v14, v166
    v_fmac_f32 v242, v7, v151
    v_fmac_f32 v238, v15, v167
    v_fmac_f32 v236, v16, v112
    v_mul_f32 v244, v24, v160
    v_fmac_f32 v236, v17, v113
    v_fmac_f32 v244, v25, v161
    v_fmac_f32 v236, v18, v114
    v_fmac_f32 v244, v26, v162
    v_fmac_f32 v236, v19, v115
    v_fmac_f32 v244, v27, v163
    v_fmac_f32 v236, v20, v116
    v_fmac_f32 v244, v28, v164
    v_fmac_f32 v236, v21, v117
    v_fmac_f32 v244, v29, v165
    v_fmac_f32 v236, v22, v118
    v_fmac_f32 v244, v30, v166
    v_fmac_f32 v236, v23, v119
    v_fmac_f32 v244, v31, v167
    v_mul_f32 v243, v32, v152
    v_fma_f32 v239, v40, v168, -v239
    v_fmac_f32 v243, v33, v153
    v_fmac_f32 v239, v41, v169
    v_fmac_f32 v243, v34, v154
    v_fmac_f32 v239, v42, v170
    v_fmac_f32 v243, v35, v155
    v_fmac_f32 v239, v43, v171
    v_fmac_f32 v243, v36, v156
    v_fmac_f32 v239, v44, v172
    v_fmac_f32 v243, v37, v157
    v_fmac_f32 v239, v45, v173
    v_fmac_f32 v243, v38, v158
    v_fmac_f32 v239, v46, v174
    v_fmac_f32 v243, v39, v159
    v_fmac_f32 v239, v47, v175
    v_fmac_f32 v237, v48, v120
    v_mul_f32 v245, v56, v168
    v_fmac_f32 v237, v49, v121
    v_fmac_f32 v245, v57, v169
    v_fmac_f32 v237, v50, v122
    v_fmac_f32 v245, v58, v170
    v_fmac_f32 v237, v51, v123
    v_fmac_f32 v245, v59, v171
    v_fmac_f32 v237, v52, v124
    v_fmac_f32 v245, v60, v172
    v_fmac_f32 v237, v53, v125
    v_fmac_f32 v245, v61, v173
    v_fmac_f32 v237, v54, v126
    v_fmac_f32 v245, v62, v174
    v_fmac_f32 v237, v55, v127
    v_fmac_f32 v245, v63, v175
    s_setprio 1
    s_waitcnt vmcnt(4) lgkmcnt(0)
    v_mfma_f32_32x32x16_bf16 v[0:15], v[64:67], v[184:187], 0
    ds_read_b64_tr_b16 v[176:177], v246 offset:0
    ds_read_b64_tr_b16 v[178:179], v246 offset:512
    ds_read_b64_tr_b16 v[180:181], v247 offset:0
    ds_read_b64_tr_b16 v[182:183], v247 offset:512
    s_mov_b32 m0, s71
    v_mfma_f32_32x32x16_bf16 v[16:31], v[68:71], v[184:187], 0
    buffer_load_dwordx4 v228, s[4:7], s47 offen sc1 lds
    buffer_load_dwordx4 v229, s[72:75], s47 offen offset:1024 sc1 lds
    v_permlane32_swap_b32 v242, v234
    v_permlane32_swap_b32 v243, v235
    v_add_f32 v242, v242, v234
    v_mfma_f32_32x32x16_bf16 v[32:47], v[64:67], v[188:191], 0
    v_add_f32 v243, v243, v235
    v_cvt_pk_bf16_f32 v242, v242, v243
    ds_write_b32 v230, v242 offset:512
    v_mfma_f32_32x32x16_bf16 v[48:63], v[68:71], v[188:191], 0
    s_setprio 0
    v_mul_f32 v242, v0, v144
    v_fma_f32 v240, v8, v160, -v240
    v_fmac_f32 v242, v1, v145
    v_fmac_f32 v240, v9, v161
    v_fmac_f32 v242, v2, v146
    v_fmac_f32 v240, v10, v162
    v_fmac_f32 v242, v3, v147
    v_fmac_f32 v240, v11, v163
    v_fmac_f32 v242, v4, v148
    v_fmac_f32 v240, v12, v164
    v_fmac_f32 v242, v5, v149
    v_fmac_f32 v240, v13, v165
    v_fmac_f32 v242, v6, v150
    v_fmac_f32 v240, v14, v166
    v_fmac_f32 v242, v7, v151
    v_fmac_f32 v240, v15, v167
    v_add_u32 v249, s26, v249
    v_add_u32 v250, s26, v250
    v_fma_f32 v244, v16, v160, -v244
    v_fmac_f32 v236, v24, v112
    v_fmac_f32 v244, v17, v161
    v_fmac_f32 v236, v25, v113
    v_fmac_f32 v244, v18, v162
    v_fmac_f32 v236, v26, v114
    v_fmac_f32 v244, v19, v163
    v_fmac_f32 v236, v27, v115
    v_fmac_f32 v244, v20, v164
    v_fmac_f32 v236, v28, v116
    v_fmac_f32 v244, v21, v165
    v_fmac_f32 v236, v29, v117
    v_fmac_f32 v244, v22, v166
    v_fmac_f32 v236, v30, v118
    v_fmac_f32 v244, v23, v167
    v_fmac_f32 v236, v31, v119
    ds_read_b64_tr_b16 v[0:1], v249 offset:0
    ds_read_b64_tr_b16 v[2:3], v249 offset:256
    ds_read_u16_d16_hi v16, v250 offset:0
    v_mul_f32 v243, v32, v152
    v_fma_f32 v241, v40, v168, -v241
    v_fmac_f32 v243, v33, v153
    v_fmac_f32 v241, v41, v169
    v_fmac_f32 v243, v34, v154
    v_fmac_f32 v241, v42, v170
    v_fmac_f32 v243, v35, v155
    v_fmac_f32 v241, v43, v171
    v_fmac_f32 v243, v36, v156
    v_fmac_f32 v241, v44, v172
    v_fmac_f32 v243, v37, v157
    v_fmac_f32 v241, v45, v173
    v_fmac_f32 v243, v38, v158
    v_fmac_f32 v241, v46, v174
    v_fmac_f32 v243, v39, v159
    v_fmac_f32 v241, v47, v175
    ds_read_b64_tr_b16 v[4:5], v249 offset:512
    ds_read_b64_tr_b16 v[6:7], v249 offset:768
    ds_read_u16_d16_hi v17, v250 offset:32
    v_fma_f32 v245, v48, v168, -v245
    v_fmac_f32 v237, v56, v120
    v_fmac_f32 v245, v49, v169
    v_fmac_f32 v237, v57, v121
    v_fmac_f32 v245, v50, v170
    v_fmac_f32 v237, v58, v122
    v_fmac_f32 v245, v51, v171
    v_fmac_f32 v237, v59, v123
    v_fmac_f32 v245, v52, v172
    v_fmac_f32 v237, v60, v124
    v_fmac_f32 v245, v53, v173
    v_fmac_f32 v237, v61, v125
    v_fmac_f32 v245, v54, v174
    v_fmac_f32 v237, v62, v126
    v_fmac_f32 v245, v55, v175
    v_fmac_f32 v237, v63, v127
    s_cmp_eq_u32 s56, 2
    s_cbranch_scc1 K2_U21
    s_cmp_eq_u32 s56, 3
    s_cbranch_scc1 K2_U31
    s_branch K2_DSP1
K2_U41:
    s_setprio 1
    ds_read_b64_tr_b16 v[8:9], v249 offset:1024
    ds_read_b64_tr_b16 v[10:11], v249 offset:1280
    ds_read_u16_d16_hi v18, v250 offset:64
    s_lshr_b32 s65, s30, 27
    s_mov_b32 s66, 148736
    s_cmp_ge_u32 s65, 2
    s_cselect_b32 s66, 145632, s66
    s_mul_i32 s65, s65, 512
    s_add_u32 s65, s65, s66
    s_sub_u32 s65, s65, s29
    v_add_u32 v56, s65, v249
    s_lshr_b32 s65, s30, 27
    s_mov_b32 s66, 148736
    s_cmp_ge_u32 s65, 2
    s_cselect_b32 s66, 146592, s66
    s_mul_i32 s65, s65, 32
    s_add_u32 s65, s65, s66
    s_sub_u32 s65, s65, s29
    v_add_u32 v57, s65, v250
    ds_read_b64_tr_b16 v[12:13], v56 offset:0
    ds_read_b64_tr_b16 v[14:15], v56 offset:256
    ds_read_u16_d16_hi v19, v57 offset:0
    s_waitcnt lgkmcnt(6)
    v_lshlrev_b32 v20, 16, v0
    v_and_b32 v21, 0xffff0000, v0
    v_lshlrev_b32 v22, 16, v1
    v_and_b32 v23, 0xffff0000, v1
    v_lshlrev_b32 v24, 16, v2
    v_and_b32 v25, 0xffff0000, v2
    v_lshlrev_b32 v26, 16, v3
    v_and_b32 v27, 0xffff0000, v3
    v_mul_f32_dpp v36, v16, v20 row_newbcast:0 row_mask:0xf bank_mask:0xf
    v_mul_f32_dpp v37, v16, v21 row_newbcast:1 row_mask:0xf bank_mask:0xf
    v_mul_f32_dpp v38, v16, v22 row_newbcast:2 row_mask:0xf bank_mask:0xf
    v_mul_f32_dpp v39, v16, v23 row_newbcast:3 row_mask:0xf bank_mask:0xf
    v_mul_f32_dpp v40, v16, v24 row_newbcast:4 row_mask:0xf bank_mask:0xf
    v_mul_f32_dpp v41, v16, v25 row_newbcast:5 row_mask:0xf bank_mask:0xf
    v_mul_f32_dpp v42, v16, v26 row_newbcast:6 row_mask:0xf bank_mask:0xf
    v_mul_f32_dpp v43, v16, v27 row_newbcast:7 row_mask:0xf bank_mask:0xf
    v_cvt_pk_bf16_f32 v64, v36, v37
    v_cvt_pk_bf16_f32 v65, v38, v39
    v_cvt_pk_bf16_f32 v66, v40, v41
    v_cvt_pk_bf16_f32 v67, v42, v43
    v_mul_f32_dpp v44, v16, v20 row_newbcast:8 row_mask:0xf bank_mask:0xf
    v_mul_f32_dpp v45, v16, v21 row_newbcast:9 row_mask:0xf bank_mask:0xf
    v_mul_f32_dpp v46, v16, v22 row_newbcast:10 row_mask:0xf bank_mask:0xf
    v_mul_f32_dpp v47, v16, v23 row_newbcast:11 row_mask:0xf bank_mask:0xf
    v_mul_f32_dpp v48, v16, v24 row_newbcast:12 row_mask:0xf bank_mask:0xf
    v_mul_f32_dpp v49, v16, v25 row_newbcast:13 row_mask:0xf bank_mask:0xf
    v_mul_f32_dpp v50, v16, v26 row_newbcast:14 row_mask:0xf bank_mask:0xf
    v_mul_f32_dpp v51, v16, v27 row_newbcast:15 row_mask:0xf bank_mask:0xf
    v_cvt_pk_bf16_f32 v68, v44, v45
    v_cvt_pk_bf16_f32 v69, v46, v47
    v_cvt_pk_bf16_f32 v70, v48, v49
    v_cvt_pk_bf16_f32 v71, v50, v51
    v_lshlrev_b32 v28, 16, v4
    v_and_b32 v29, 0xffff0000, v4
    v_lshlrev_b32 v30, 16, v5
    v_and_b32 v31, 0xffff0000, v5
    v_lshlrev_b32 v32, 16, v6
    v_and_b32 v33, 0xffff0000, v6
    v_lshlrev_b32 v34, 16, v7
    v_and_b32 v35, 0xffff0000, v7
    v_mul_f32_dpp v36, v17, v28 row_newbcast:0 row_mask:0xf bank_mask:0xf
    v_mul_f32_dpp v37, v17, v29 row_newbcast:1 row_mask:0xf bank_mask:0xf
    v_mul_f32_dpp v38, v17, v30 row_newbcast:2 row_mask:0xf bank_mask:0xf
    v_mul_f32_dpp v39, v17, v31 row_newbcast:3 row_mask:0xf bank_mask:0xf
    v_mul_f32_dpp v40, v17, v32 row_newbcast:4 row_mask:0xf bank_mask:0xf
    v_mul_f32_dpp v41, v17, v33 row_newbcast:5 row_mask:0xf bank_mask:0xf
    v_mul_f32_dpp v42, v17, v34 row_newbcast:6 row_mask:0xf bank_mask:0xf
    v_mul_f32_dpp v43, v17, v35 row_newbcast:7 row_mask:0xf bank_mask:0xf
    v_cvt_pk_bf16_f32 v72, v36, v37
    v_cvt_pk_bf16_f32 v73, v38, v39
    v_cvt_pk_bf16_f32 v74, v40, v41
    v_cvt_pk_bf16_f32 v75, v42, v43
    v_mul_f32_dpp v44, v17, v28 row_newbcast:8 row_mask:0xf bank_mask:0xf
    v_mul_f32_dpp v45, v17, v29 row_newbcast:9 row_mask:0xf bank_mask:0xf
    v_mul_f32_dpp v46, v17, v30 row_newbcast:10 row_mask:0xf bank_mask:0xf
    v_mul_f32_dpp v47, v17, v31 row_newbcast:11 row_mask:0xf bank_mask:0xf
    v_mul_f32_dpp v48, v17, v32 row_newbcast:12 row_mask:0xf bank_mask:0xf
    v_mul_f32_dpp v49, v17, v33 row_newbcast:13 row_mask:0xf bank_mask:0xf
    v_mul_f32_dpp v50, v17, v34 row_newbcast:14 row_mask:0xf bank_mask:0xf
    v_mul_f32_dpp v51, v17, v35 row_newbcast:15 row_mask:0xf bank_mask:0xf
    v_cvt_pk_bf16_f32 v76, v44, v45
    v_cvt_pk_bf16_f32 v77, v46, v47
    v_cvt_pk_bf16_f32 v78, v48, v49
    v_cvt_pk_bf16_f32 v79, v50, v51
    s_waitcnt lgkmcnt(3)
    v_lshlrev_b32 v20, 16, v8
    v_and_b32 v21, 0xffff0000, v8
    v_lshlrev_b32 v22, 16, v9
    v_and_b32 v23, 0xffff0000, v9
    v_lshlrev_b32 v24, 16, v10
    v_and_b32 v25, 0xffff0000, v10
    v_lshlrev_b32 v26, 16, v11
    v_and_b32 v27, 0xffff0000, v11
    v_mul_f32_dpp v36, v18, v20 row_newbcast:0 row_mask:0xf bank_mask:0xf
    v_mul_f32_dpp v37, v18, v21 row_newbcast:1 row_mask:0xf bank_mask:0xf
    v_mul_f32_dpp v38, v18, v22 row_newbcast:2 row_mask:0xf bank_mask:0xf
    v_mul_f32_dpp v39, v18, v23 row_newbcast:3 row_mask:0xf bank_mask:0xf
    v_mul_f32_dpp v40, v18, v24 row_newbcast:4 row_mask:0xf bank_mask:0xf
    v_mul_f32_dpp v41, v18, v25 row_newbcast:5 row_mask:0xf bank_mask:0xf
    v_mul_f32_dpp v42, v18, v26 row_newbcast:6 row_mask:0xf bank_mask:0xf
    v_mul_f32_dpp v43, v18, v27 row_newbcast:7 row_mask:0xf bank_mask:0xf
    v_cvt_pk_bf16_f32 v80, v36, v37
    v_cvt_pk_bf16_f32 v81, v38, v39
    v_cvt_pk_bf16_f32 v82, v40, v41
    v_cvt_pk_bf16_f32 v83, v42, v43
    v_mul_f32_dpp v44, v18, v20 row_newbcast:8 row_mask:0xf bank_mask:0xf
    v_mul_f32_dpp v45, v18, v21 row_newbcast:9 row_mask:0xf bank_mask:0xf
    v_mul_f32_dpp v46, v18, v22 row_newbcast:10 row_mask:0xf bank_mask:0xf
    v_mul_f32_dpp v47, v18, v23 row_newbcast:11 row_mask:0xf bank_mask:0xf
    v_mul_f32_dpp v48, v18, v24 row_newbcast:12 row_mask:0xf bank_mask:0xf
    v_mul_f32_dpp v49, v18, v25 row_newbcast:13 row_mask:0xf bank_mask:0xf
    v_mul_f32_dpp v50, v18, v26 row_newbcast:14 row_mask:0xf bank_mask:0xf
    v_mul_f32_dpp v51, v18, v27 row_newbcast:15 row_mask:0xf bank_mask:0xf
    v_cvt_pk_bf16_f32 v84, v44, v45
    v_cvt_pk_bf16_f32 v85, v46, v47
    v_cvt_pk_bf16_f32 v86, v48, v49
    v_cvt_pk_bf16_f32 v87, v50, v51
    s_waitcnt lgkmcnt(0)
    v_lshlrev_b32 v28, 16, v12
    v_and_b32 v29, 0xffff0000, v12
    v_lshlrev_b32 v30, 16, v13
    v_and_b32 v31, 0xffff0000, v13
    v_lshlrev_b32 v32, 16, v14
    v_and_b32 v33, 0xffff0000, v14
    v_lshlrev_b32 v34, 16, v15
    v_and_b32 v35, 0xffff0000, v15
    v_mul_f32_dpp v36, v19, v28 row_newbcast:0 row_mask:0xf bank_mask:0xf
    v_mul_f32_dpp v37, v19, v29 row_newbcast:1 row_mask:0xf bank_mask:0xf
    v_mul_f32_dpp v38, v19, v30 row_newbcast:2 row_mask:0xf bank_mask:0xf
    v_mul_f32_dpp v39, v19, v31 row_newbcast:3 row_mask:0xf bank_mask:0xf
    v_mul_f32_dpp v40, v19, v32 row_newbcast:4 row_mask:0xf bank_mask:0xf
    v_mul_f32_dpp v41, v19, v33 row_newbcast:5 row_mask:0xf bank_mask:0xf
    v_mul_f32_dpp v42, v19, v34 row_newbcast:6 row_mask:0xf bank_mask:0xf
    v_mul_f32_dpp v43, v19, v35 row_newbcast:7 row_mask:0xf bank_mask:0xf
    v_cvt_pk_bf16_f32 v88, v36, v37
    v_cvt_pk_bf16_f32 v89, v38, v39
    v_cvt_pk_bf16_f32 v90, v40, v41
    v_cvt_pk_bf16_f32 v91, v42, v43
    v_mul_f32_dpp v44, v19, v28 row_newbcast:8 row_mask:0xf bank_mask:0xf
    v_mul_f32_dpp v45, v19, v29 row_newbcast:9 row_mask:0xf bank_mask:0xf
    v_mul_f32_dpp v46, v19, v30 row_newbcast:10 row_mask:0xf bank_mask:0xf
    v_mul_f32_dpp v47, v19, v31 row_newbcast:11 row_mask:0xf bank_mask:0xf
    v_mul_f32_dpp v48, v19, v32 row_newbcast:12 row_mask:0xf bank_mask:0xf
    v_mul_f32_dpp v49, v19, v33 row_newbcast:13 row_mask:0xf bank_mask:0xf
    v_mul_f32_dpp v50, v19, v34 row_newbcast:14 row_mask:0xf bank_mask:0xf
    v_mul_f32_dpp v51, v19, v35 row_newbcast:15 row_mask:0xf bank_mask:0xf
    v_cvt_pk_bf16_f32 v92, v44, v45
    v_cvt_pk_bf16_f32 v93, v46, v47
    v_cvt_pk_bf16_f32 v94, v48, v49
    v_cvt_pk_bf16_f32 v95, v50, v51
    s_waitcnt vmcnt(4)
    v_mfma_f32_32x32x16_bf16 v[0:15], v[64:67], v[176:179], 0
    ds_read_b64_tr_b16 v[184:185], v246 offset:2048
    ds_read_b64_tr_b16 v[186:187], v246 offset:2560
    ds_read_b64_tr_b16 v[188:189], v247 offset:2048
    ds_read_b64_tr_b16 v[190:191], v247 offset:2560
    s_mov_b32 m0, s68
    v_mfma_f32_32x32x16_bf16 v[16:31], v[68:71], v[176:179], 0
    buffer_load_dwordx4 v222, s[4:7], s41 offen sc1 lds
    buffer_load_dwordx4 v223, s[72:75], s41 offen offset:1024 sc1 lds
    v_permlane32_swap_b32 v242, v236
    v_permlane32_swap_b32 v243, v237
    v_mov_b32 v254, 160704
    v_mfma_f32_32x32x16_bf16 v[32:47], v[64:67], v[180:183], 0
    v_permlane32_swap_b32 v244, v238
    v_permlane32_swap_b32 v245, v239
    v_permlane32_swap_b32 v240, v241
    v_add_f32 v242, v242, v236
    v_mfma_f32_32x32x16_bf16 v[48:63], v[68:71], v[180:183], 0
    v_add_f32 v243, v243, v237
    v_add_f32 v244, v244, v238
    v_add_f32 v245, v245, v239
    v_add_f32 v240, -v240, -v241
    v_sub_u32 v241, v230, v231
    v_cvt_pk_bf16_f32 v242, v242, v243
    v_mov_b32 v255, 1
    v_lshl_add_u32 v233, v252, 1, s53
    s_mov_b64 exec, 1
    ds_add_rtn_u32 v232, v254, v255
    s_mov_b64 exec, -1
    ds_read_b32 v233, v233
    s_waitcnt vmcnt(4) lgkmcnt(2)
    v_mfma_f32_32x32x16_bf16 v[0:15], v[72:75], v[184:187], v[0:15]
    ds_read_b64_tr_b16 v[176:177], v246 offset:4096
    ds_read_b64_tr_b16 v[178:179], v246 offset:4608
    ds_read_b64_tr_b16 v[180:181], v247 offset:4096
    ds_read_b64_tr_b16 v[182:183], v247 offset:4608
    v_cvt_pk_bf16_f32 v244, v244, v245
    v_cvt_pk_bf16_f32 v240, v240, v240
    s_mov_b32 m0, s69
    v_mfma_f32_32x32x16_bf16 v[16:31], v[76:79], v[184:187], v[16:31]
    buffer_load_dwordx4 v224, s[4:7], s41 offen sc1 lds
    buffer_load_dwordx4 v225, s[72:75], s41 offen offset:1024 sc1 lds
    ds_write_b32 v230, v242 offset:768
    ds_write_b32 v230, v244 offset:1024
    ds_write_b16 v241, v240 offset:1280
    s_waitcnt lgkmcnt(7)
    v_readfirstlane_b32 s58, v232
    v_mfma_f32_32x32x16_bf16 v[32:47], v[72:75], v[188:191], v[32:47]
    s_cmp_lt_u32 s58, s22
    s_cbranch_scc0 K2_nul_81
    s_and_b32 s59, s58, 7
    s_lshr_b32 s60, s58, 3
K2_chk_83:
    v_readlane_b32 s61, v233, s59
    s_nop 0
    s_cmp_gt_u32 s61, s60
    s_cbranch_scc0 K2_spin_82
K2_back_84:
    v_mfma_f32_32x32x16_bf16 v[48:63], v[76:79], v[188:191], v[48:63]
    v_readlane_b32 s3, v253, s58
    s_lshl_b32 s44, s34, 7
    s_and_b32 s48, s3, 0x3ffff
    s_bfe_u32 s33, s3, 0x30012
    s_mov_b32 s35, s48
    s_mov_b32 s45, s44
    s_waitcnt vmcnt(4) lgkmcnt(3)
    v_mfma_f32_32x32x16_bf16 v[0:15], v[80:83], v[176:179], v[0:15]
    ds_read_b64_tr_b16 v[184:185], v246 offset:6144
    ds_read_b64_tr_b16 v[186:187], v246 offset:6656
    ds_read_b64_tr_b16 v[188:189], v247 offset:6144
    ds_read_b64_tr_b16 v[190:191], v247 offset:6656
    s_add_u32 s47, s44, 256
    s_add_u32 s49, s48, 32
    s_mov_b32 m0, s70
    v_mfma_f32_32x32x16_bf16 v[16:31], v[84:87], v[176:179], v[16:31]
    buffer_load_dwordx4 v226, s[4:7], s41 offen sc1 lds
    buffer_load_dwordx4 v227, s[72:75], s41 offen offset:1024 sc1 lds
    s_add_u32 s60, s48, 64
    s_cmp_eq_u32 s33, 3
    s_cselect_b32 s46, s44, s47
    s_cselect_b32 s50, s60, s48
    s_cselect_b32 s51, s48, s49
    v_mfma_f32_32x32x16_bf16 v[32:47], v[80:83], v[180:183], v[32:47]
    s_sub_u32 s60, s33, 2
    s_cmp_lt_u32 s60, 2
    s_cbranch_scc0 K2_rare_85
K2_back_86:
    v_mfma_f32_32x32x16_bf16 v[48:63], v[84:87], v[180:183], v[48:63]
    s_waitcnt vmcnt(4) lgkmcnt(0)
    v_mfma_f32_32x32x16_bf16 v[0:15], v[88:91], v[184:187], v[0:15]
    ds_read_b64_tr_b16 v[176:177], v246 offset:0
    ds_read_b64_tr_b16 v[178:179], v246 offset:512
    ds_read_b64_tr_b16 v[180:181], v247 offset:0
    ds_read_b64_tr_b16 v[182:183], v247 offset:512
    s_mov_b32 m0, s71
    v_mfma_f32_32x32x16_bf16 v[16:31], v[92:95], v[184:187], v[16:31]
    buffer_load_dwordx4 v228, s[4:7], s41 offen sc1 lds
    buffer_load_dwordx4 v229, s[72:75], s41 offen offset:1024 sc1 lds
    v_mfma_f32_32x32x16_bf16 v[32:47], v[88:91], v[188:191], v[32:47]
    s_nop 2
    v_mul_f32 v234, v0, v96
    v_mul_f32 v236, v8, v128
    v_fmac_f32 v234, v1, v97
    v_fmac_f32 v236, v9, v129
    v_fmac_f32 v234, v2, v98
    v_fmac_f32 v236, v10, v130
    v_fmac_f32 v234, v3, v99
    v_mfma_f32_32x32x16_bf16 v[48:63], v[92:95], v[188:191], v[48:63]
    s_setprio 0
    v_fmac_f32 v236, v11, v131
    v_fmac_f32 v234, v4, v100
    v_fmac_f32 v236, v12, v132
    v_fmac_f32 v234, v5, v101
    v_fmac_f32 v236, v13, v133
    v_fmac_f32 v234, v6, v102
    v_fmac_f32 v236, v14, v134
    v_fmac_f32 v234, v7, v103
    v_fmac_f32 v236, v15, v135
    v_mul_f32 v238, v16, v128
    v_mul_f32 v240, v24, v128
    v_fmac_f32 v238, v17, v129
    v_fmac_f32 v240, v25, v129
    v_fmac_f32 v238, v18, v130
    v_fmac_f32 v240, v26, v130
    v_fmac_f32 v238, v19, v131
    v_fmac_f32 v240, v27, v131
    v_fmac_f32 v238, v20, v132
    v_fmac_f32 v240, v28, v132
    v_fmac_f32 v238, v21, v133
    v_fmac_f32 v240, v29, v133
    v_fmac_f32 v238, v22, v134
    v_fmac_f32 v240, v30, v134
    v_fmac_f32 v238, v23, v135
    v_fmac_f32 v240, v31, v135
    v_mul_f32 v235, v32, v104
    v_mul_f32 v237, v40, v136
    v_fmac_f32 v235, v33, v105
    v_fmac_f32 v237, v41, v137
    v_fmac_f32 v235, v34, v106
    v_fmac_f32 v237, v42, v138
    v_fmac_f32 v235, v35, v107
    v_fmac_f32 v237, v43, v139
    v_fmac_f32 v235, v36, v108
    v_fmac_f32 v237, v44, v140
    v_fmac_f32 v235, v37, v109
    v_fmac_f32 v237, v45, v141
    v_fmac_f32 v235, v38, v110
    v_fmac_f32 v237, v46, v142
    v_fmac_f32 v235, v39, v111
    v_fmac_f32 v237, v47, v143
    v_mul_f32 v239, v48, v136
    v_mul_f32 v241, v56, v136
    s_setprio 1
    s_waitcnt vmcnt(4) lgkmcnt(0)
    v_mfma_f32_32x32x16_bf16 v[0:15], v[64:67], v[176:179], 0
    ds_read_b64_tr_b16 v[184:185], v246 offset:2048
    ds_read_b64_tr_b16 v[186:187], v246 offset:2560
    ds_read_b64_tr_b16 v[188:189], v247 offset:2048
    ds_read_b64_tr_b16 v[190:191], v247 offset:2560
    v_fmac_f32 v239, v49, v137
    v_fmac_f32 v241, v57, v137
    s_mov_b32 m0, s68
    v_mfma_f32_32x32x16_bf16 v[16:31], v[68:71], v[176:179], 0
    buffer_load_dwordx4 v222, s[4:7], s42 offen sc1 lds
    buffer_load_dwordx4 v223, s[72:75], s42 offen offset:1024 sc1 lds
    v_fmac_f32 v239, v50, v138
    v_fmac_f32 v241, v58, v138
    v_fmac_f32 v239, v51, v139
    v_fmac_f32 v241, v59, v139
    v_fmac_f32 v239, v52, v140
    v_mfma_f32_32x32x16_bf16 v[32:47], v[64:67], v[180:183], 0
    v_fmac_f32 v241, v60, v140
    v_fmac_f32 v239, v53, v141
    v_fmac_f32 v241, v61, v141
    v_fmac_f32 v239, v54, v142
    v_fmac_f32 v241, v62, v142
    v_fmac_f32 v239, v55, v143
    v_fmac_f32 v241, v63, v143
    v_mfma_f32_32x32x16_bf16 v[48:63], v[68:71], v[180:183], 0
    v_permlane32_swap_b32 v234, v236
    v_permlane32_swap_b32 v235, v237
    v_permlane32_swap_b32 v240, v238
    s_waitcnt vmcnt(4) lgkmcnt(0)
    v_mfma_f32_32x32x16_bf16 v[0:15], v[72:75], v[184:187], v[0:15]
    ds_read_b64_tr_b16 v[176:177], v246 offset:4096
    ds_read_b64_tr_b16 v[178:179], v246 offset:4608
    ds_read_b64_tr_b16 v[180:181], v247 offset:4096
    ds_read_b64_tr_b16 v[182:183], v247 offset:4608
    v_permlane32_swap_b32 v241, v239
    s_mov_b32 m0, s69
    v_mfma_f32_32x32x16_bf16 v[16:31], v[76:79], v[184:187], v[16:31]
    buffer_load_dwordx4 v224, s[4:7], s42 offen sc1 lds
    buffer_load_dwordx4 v225, s[72:75], s42 offen offset:1024 sc1 lds
    v_lshl_add_u32 v230, v252, 1, s31
    v_add_f32 v234, v234, v236
    v_add_f32 v235, v235, v237
    v_add_f32 v240, v240, v238
    v_add_f32 v241, v241, v239
    v_mfma_f32_32x32x16_bf16 v[32:47], v[72:75], v[188:191], v[32:47]
    v_cvt_pk_bf16_f32 v234, v234, v235
    v_cvt_pk_bf16_f32 v240, v240, v241
    ds_write_b32 v230, v234 offset:0
    ds_write_b32 v230, v240 offset:256
    v_mfma_f32_32x32x16_bf16 v[48:63], v[76:79], v[188:191], v[48:63]
    s_waitcnt vmcnt(4) lgkmcnt(2)
    v_mfma_f32_32x32x16_bf16 v[0:15], v[80:83], v[176:179], v[0:15]
    ds_read_b64_tr_b16 v[184:185], v246 offset:6144
    ds_read_b64_tr_b16 v[186:187], v246 offset:6656
    ds_read_b64_tr_b16 v[188:189], v247 offset:6144
    ds_read_b64_tr_b16 v[190:191], v247 offset:6656
    s_mov_b32 m0, s70
    v_mfma_f32_32x32x16_bf16 v[16:31], v[84:87], v[176:179], v[16:31]
    buffer_load_dwordx4 v226, s[4:7], s42 offen sc1 lds
    buffer_load_dwordx4 v227, s[72:75], s42 offen offset:1024 sc1 lds
    v_mfma_f32_32x32x16_bf16 v[32:47], v[80:83], v[180:183], v[32:47]
    v_mfma_f32_32x32x16_bf16 v[48:63], v[84:87], v[180:183], v[48:63]
    s_waitcnt vmcnt(4) lgkmcnt(0)
    v_mfma_f32_32x32x16_bf16 v[0:15], v[88:91], v[184:187], v[0:15]
    ds_read_b64_tr_b16 v[176:177], v246 offset:0
    ds_read_b64_tr_b16 v[178:179], v246 offset:512
    ds_read_b64_tr_b16 v[180:181], v247 offset:0
    ds_read_b64_tr_b16 v[182:183], v247 offset:512
    s_mov_b32 m0, s71
    v_mfma_f32_32x32x16_bf16 v[16:31], v[92:95], v[184:187], v[16:31]
    buffer_load_dwordx4 v228, s[4:7], s42 offen sc1 lds
    buffer_load_dwordx4 v229, s[72:75], s42 offen offset:1024 sc1 lds
    v_mfma_f32_32x32x16_bf16 v[32:47], v[88:91], v[188:191], v[32:47]
    s_nop 2
    v_mul_f32 v234, v0, v144
    v_mul_f32 v236, v8, v112
    v_fmac_f32 v234, v1, v145
    v_fmac_f32 v236, v9, v113
    v_fmac_f32 v234, v2, v146
    v_fmac_f32 v236, v10, v114
    v_fmac_f32 v234, v3, v147
    v_mfma_f32_32x32x16_bf16 v[48:63], v[92:95], v[188:191], v[48:63]
    s_setprio 0
    v_fmac_f32 v236, v11, v115
    v_fmac_f32 v234, v4, v148
    v_fmac_f32 v236, v12, v116
    v_fmac_f32 v234, v5, v149
    v_fmac_f32 v236, v13, v117
    v_fmac_f32 v234, v6, v150
    v_fmac_f32 v236, v14, v118
    v_fmac_f32 v234, v7, v151
    v_fmac_f32 v236, v15, v119
    v_mul_f32 v238, v16, v160
    v_mul_f32 v240, v24, v160
    v_fmac_f32 v238, v17, v161
    v_fmac_f32 v240, v25, v161
    v_fmac_f32 v238, v18, v162
    v_fmac_f32 v240, v26, v162
    v_fmac_f32 v238, v19, v163
    v_fmac_f32 v240, v27, v163
    v_fmac_f32 v238, v20, v164
    v_fmac_f32 v240, v28, v164
    v_fmac_f32 v238, v21, v165
    v_fmac_f32 v240, v29, v165
    v_fmac_f32 v238, v22, v166
    v_fmac_f32 v240, v30, v166
    v_fmac_f32 v238, v23, v167
    v_fmac_f32 v240, v31, v167
    v_mul_f32 v235, v32, v152
    v_mul_f32 v237, v40, v120
    v_fmac_f32 v235, v33, v153
    v_fmac_f32 v237, v41, v121
    v_fmac_f32 v235, v34, v154
    v_fmac_f32 v237, v42, v122
    v_fmac_f32 v235, v35, v155
    v_fmac_f32 v237, v43, v123
    v_fmac_f32 v235, v36, v156
    v_fmac_f32 v237, v44, v124
    v_fmac_f32 v235, v37, v157
    v_fmac_f32 v237, v45, v125
    v_fmac_f32 v235, v38, v158
    v_fmac_f32 v237, v46, v126
    v_fmac_f32 v235, v39, v159
    v_fmac_f32 v237, v47, v127
    v_mul_f32 v239, v48, v168
    v_mul_f32 v241, v56, v168
    s_setprio 1
    s_waitcnt vmcnt(4) lgkmcnt(0)
    v_mfma_f32_32x32x16_bf16 v[0:15], v[64:67], v[176:179], 0
    ds_read_b64_tr_b16 v[184:185], v246 offset:2048
    ds_read_b64_tr_b16 v[186:187], v246 offset:2560
    ds_read_b64_tr_b16 v[188:189], v247 offset:2048
    ds_read_b64_tr_b16 v[190:191], v247 offset:2560
    v_fmac_f32 v239, v49, v169
    v_fmac_f32 v241, v57, v169
    s_mov_b32 m0, s68
    v_mfma_f32_32x32x16_bf16 v[16:31], v[68:71], v[176:179], 0
    buffer_load_dwordx4 v222, s[4:7], s43 offen sc1 lds
    buffer_load_dwordx4 v223, s[72:75], s43 offen offset:1024 sc1 lds
    v_fmac_f32 v239, v50, v170
    v_fmac_f32 v241, v58, v170
    v_fmac_f32 v239, v51, v171
    v_fmac_f32 v241, v59, v171
    v_fmac_f32 v239, v52, v172
    v_mfma_f32_32x32x16_bf16 v[32:47], v[64:67], v[180:183], 0
    v_fmac_f32 v241, v60, v172
    v_fmac_f32 v239, v53, v173
    v_fmac_f32 v241, v61, v173
    v_fmac_f32 v239, v54, v174
    v_fmac_f32 v241, v62, v174
    v_fmac_f32 v239, v55, v175
    v_fmac_f32 v241, v63, v175
    v_mfma_f32_32x32x16_bf16 v[48:63], v[68:71], v[180:183], 0
    s_waitcnt vmcnt(4) lgkmcnt(0)
    v_mfma_f32_32x32x16_bf16 v[0:15], v[72:75], v[184:187], v[0:15]
    ds_read_b64_tr_b16 v[176:177], v246 offset:4096
    ds_read_b64_tr_b16 v[178:179], v246 offset:4608
    ds_read_b64_tr_b16 v[180:181], v247 offset:4096
    ds_read_b64_tr_b16 v[182:183], v247 offset:4608
    s_mov_b32 m0, s69
    v_mfma_f32_32x32x16_bf16 v[16:31], v[76:79], v[184:187], v[16:31]
    buffer_load_dwordx4 v224, s[4:7], s43 offen sc1 lds
    buffer_load_dwordx4 v225, s[72:75], s43 offen offset:1024 sc1 lds
    v_mfma_f32_32x32x16_bf16 v[32:47], v[72:75], v[188:191], v[32:47]
    v_mfma_f32_32x32x16_bf16 v[48:63], v[76:79], v[188:191], v[48:63]
    s_waitcnt vmcnt(4) lgkmcnt(0)
    v_mfma_f32_32x32x16_bf16 v[0:15], v[80:83], v[176:179], v[0:15]
    ds_read_b64_tr_b16 v[184:185], v246 offset:6144
    ds_read_b64_tr_b16 v[186:187], v246 offset:6656
    ds_read_b64_tr_b16 v[188:189], v247 offset:6144
    ds_read_b64_tr_b16 v[190:191], v247 offset:6656
    s_mov_b32 m0, s70
    v_mfma_f32_32x32x16_bf16 v[16:31], v[84:87], v[176:179], v[16:31]
    buffer_load_dwordx4 v226, s[4:7], s43 offen sc1 lds
    buffer_load_dwordx4 v227, s[72:75], s43 offen offset:1024 sc1 lds
    v_mfma_f32_32x32x16_bf16 v[32:47], v[80:83], v[180:183], v[32:47]
    v_add_u32 v222, s48, v251
    ds_read_b32 v222, v222
    v_mfma_f32_32x32x16_bf16 v[48:63], v[84:87], v[180:183], v[48:63]
    s_waitcnt vmcnt(4) lgkmcnt(1)
    v_mfma_f32_32x32x16_bf16 v[0:15], v[88:91], v[184:187], v[0:15]
    ds_read_b64_tr_b16 v[176:177], v246 offset:0
    ds_read_b64_tr_b16 v[178:179], v246 offset:512
    ds_read_b64_tr_b16 v[180:181], v247 offset:0
    ds_read_b64_tr_b16 v[182:183], v247 offset:512
    s_mov_b32 m0, s71
    v_mfma_f32_32x32x16_bf16 v[16:31], v[92:95], v[184:187], v[16:31]
    buffer_load_dwordx4 v228, s[4:7], s43 offen sc1 lds
    buffer_load_dwordx4 v229, s[72:75], s43 offen offset:1024 sc1 lds
    s_waitcnt lgkmcnt(4)
    v_mad_u32_u16 v223, v222, s39, v248 op_sel:[1,0,0,0]
    v_mad_u32_u16 v222, v222, s39, v248
    v_mfma_f32_32x32x16_bf16 v[32:47], v[88:91], v[188:191], v[32:47]
    v_add_u32 v224, s49, v251
    ds_read_b32 v224, v224
    v_mul_f32 v242, v0, v144
    v_fma_f32 v238, v8, v160, -v238
    v_fmac_f32 v242, v1, v145
    v_fmac_f32 v238, v9, v161
    v_fmac_f32 v242, v2, v146
    v_mfma_f32_32x32x16_bf16 v[48:63], v[92:95], v[188:191], v[48:63]
    s_setprio 0
    v_fmac_f32 v238, v10, v162
    v_fmac_f32 v242, v3, v147
    v_fmac_f32 v238, v11, v163
    v_fmac_f32 v242, v4, v148
    v_fmac_f32 v238, v12, v164
    v_fmac_f32 v242, v5, v149
    v_fmac_f32 v238, v13, v165
    v_fmac_f32 v242, v6, v150
    v_fmac_f32 v238, v14, v166
    v_fmac_f32 v242, v7, v151
    v_fmac_f32 v238, v15, v167
    v_fmac_f32 v236, v16, v112
    v_mul_f32 v244, v24, v160
    v_fmac_f32 v236, v17, v113
    v_fmac_f32 v244, v25, v161
    v_fmac_f32 v236, v18, v114
    v_fmac_f32 v244, v26, v162
    v_fmac_f32 v236, v19, v115
    v_fmac_f32 v244, v27, v163
    v_fmac_f32 v236, v20, v116
    v_fmac_f32 v244, v28, v164
    v_fmac_f32 v236, v21, v117
    v_fmac_f32 v244, v29, v165
    v_fmac_f32 v236, v22, v118
    v_fmac_f32 v244, v30, v166
    v_fmac_f32 v236, v23, v119
    v_fmac_f32 v244, v31, v167
    v_mul_f32 v243, v32, v152
    v_fma_f32 v239, v40, v168, -v239
    v_fmac_f32 v243, v33, v153
    v_fmac_f32 v239, v41, v169
    v_fmac_f32 v243, v34, v154
    v_fmac_f32 v239, v42, v170
    v_fmac_f32 v243, v35, v155
    v_fmac_f32 v239, v43, v171
    v_fmac_f32 v243, v36, v156
    v_fmac_f32 v239, v44, v172
    v_fmac_f32 v243, v37, v157
    v_fmac_f32 v239, v45, v173
    v_fmac_f32 v243, v38, v158
    v_fmac_f32 v239, v46, v174
    v_fmac_f32 v243, v39, v159
    v_fmac_f32 v239, v47, v175
    v_fmac_f32 v237, v48, v120
    v_mul_f32 v245, v56, v168
    v_fmac_f32 v237, v49, v121
    v_fmac_f32 v245, v57, v169
    v_fmac_f32 v237, v50, v122
    v_fmac_f32 v245, v58, v170
    v_fmac_f32 v237, v51, v123
    s_setprio 1
    s_waitcnt vmcnt(4) lgkmcnt(1)
    v_mfma_f32_32x32x16_bf16 v[0:15], v[64:67], v[176:179], 0
    ds_read_b64_tr_b16 v[184:185], v246 offset:2048
    ds_read_b64_tr_b16 v[186:187], v246 offset:2560
    ds_read_b64_tr_b16 v[188:189], v247 offset:2048
    ds_read_b64_tr_b16 v[190:191], v247 offset:2560
    v_fmac_f32 v245, v59, v171
    v_fmac_f32 v237, v52, v124
    s_mov_b32 m0, s68
    v_mfma_f32_32x32x16_bf16 v[16:31], v[68:71], v[176:179], 0
    buffer_load_dwordx4 v222, s[4:7], s44 offen sc1 lds
    buffer_load_dwordx4 v223, s[72:75], s44 offen offset:1024 sc1 lds
    s_waitcnt lgkmcnt(4)
    v_mad_u32_u16 v225, v224, s39, v248 op_sel:[1,0,0,0]
    v_mad_u32_u16 v224, v224, s39, v248
    v_fmac_f32 v245, v60, v172
    v_fmac_f32 v237, v53, v125
    v_mfma_f32_32x32x16_bf16 v[32:47], v[64:67], v[180:183], 0
    v_add_u32 v226, s50, v251
    ds_read_b32 v226, v226
    v_fmac_f32 v245, v61, v173
    v_fmac_f32 v237, v54, v126
    v_fmac_f32 v245, v62, v174
    v_fmac_f32 v237, v55, v127
    v_fmac_f32 v245, v63, v175
    v_mfma_f32_32x32x16_bf16 v[48:63], v[68:71], v[180:183], 0
    v_permlane32_swap_b32 v242, v234
    v_permlane32_swap_b32 v243, v235
    v_add_f32 v242, v242, v234
    v_add_f32 v243, v243, v235
    s_waitcnt vmcnt(4) lgkmcnt(1)
    v_mfma_f32_32x32x16_bf16 v[0:15], v[72:75], v[184:187], v[0:15]
    ds_read_b64_tr_b16 v[176:177], v246 offset:4096
    ds_read_b64_tr_b16 v[178:179], v246 offset:4608
    ds_read_b64_tr_b16 v[180:181], v247 offset:4096
    ds_read_b64_tr_b16 v[182:183], v247 offset:4608
    v_cvt_pk_bf16_f32 v242, v242, v243
    ds_write_b32 v230, v242 offset:512
    s_mov_b32 m0, s69
    v_mfma_f32_32x32x16_bf16 v[16:31], v[76:79], v[184:187], v[16:31]
    buffer_load_dwordx4 v224, s[4:7], s45 offen sc1 lds
    buffer_load_dwordx4 v225, s[72:75], s45 offen offset:1024 sc1 lds
    s_waitcnt lgkmcnt(5)
    v_mad_u32_u16 v227, v226, s39, v248 op_sel:[1,0,0,0]
    v_mad_u32_u16 v226, v226, s39, v248
    v_mfma_f32_32x32x16_bf16 v[32:47], v[72:75], v[188:191], v[32:47]
    v_add_u32 v228, s51, v251
    ds_read_b32 v228, v228
    v_mfma_f32_32x32x16_bf16 v[48:63], v[76:79], v[188:191], v[48:63]
    s_waitcnt vmcnt(4) lgkmcnt(2)
    v_mfma_f32_32x32x16_bf16 v[0:15], v[80:83], v[176:179], v[0:15]
    ds_read_b64_tr_b16 v[184:185], v246 offset:6144
    ds_read_b64_tr_b16 v[186:187], v246 offset:6656
    ds_read_b64_tr_b16 v[188:189], v247 offset:6144
    ds_read_b64_tr_b16 v[190:191], v247 offset:6656
    s_mov_b32 s32, s31
    s_mov_b32 s31, s35
    s_mov_b32 m0, s70
    v_mfma_f32_32x32x16_bf16 v[16:31], v[84:87], v[176:179], v[16:31]
    buffer_load_dwordx4 v226, s[4:7], s46 offen sc1 lds
    buffer_load_dwordx4 v227, s[72:75], s46 offen offset:1024 sc1 lds
    s_waitcnt lgkmcnt(4)
    v_mad_u32_u16 v229, v228, s39, v248 op_sel:[1,0,0,0]
    v_mad_u32_u16 v228, v228, s39, v248
    s_sub_u32 s26, s48, s29
    s_mov_b32 s29, s48
    v_mfma_f32_32x32x16_bf16 v[32:47], v[80:83], v[180:183], v[32:47]
    s_mov_b32 s30, s3
    s_cmp_lg_u32 s36, 0
    s_cselect_b32 s56, s33, 0
    v_mfma_f32_32x32x16_bf16 v[48:63], v[84:87], v[180:183], v[48:63]
    s_waitcnt vmcnt(4) lgkmcnt(0)
    v_mfma_f32_32x32x16_bf16 v[0:15], v[88:91], v[184:187], v[0:15]
    ds_read_b64_tr_b16 v[176:177], v246 offset:0
    ds_read_b64_tr_b16 v[178:179], v246 offset:512
    ds_read_b64_tr_b16 v[180:181], v247 offset:0
    ds_read_b64_tr_b16 v[182:183], v247 offset:512
    s_mov_b32 m0, s71
    v_mfma_f32_32x32x16_bf16 v[16:31], v[92:95], v[184:187], v[16:31]
    buffer_load_dwordx4 v228, s[4:7], s47 offen sc1 lds
    buffer_load_dwordx4 v229, s[72:75], s47 offen offset:1024 sc1 lds
    v_mfma_f32_32x32x16_bf16 v[32:47], v[88:91], v[188:191], v[32:47]
    s_nop 2
    v_mul_f32 v242, v0, v144
    v_fma_f32 v240, v8, v160, -v240
    v_fmac_f32 v242, v1, v145
    v_fmac_f32 v240, v9, v161
    v_fmac_f32 v242, v2, v146
    v_fmac_f32 v240, v10, v162
    v_fmac_f32 v242, v3, v147
    v_mfma_f32_32x32x16_bf16 v[48:63], v[92:95], v[188:191], v[48:63]
    s_setprio 0
    v_fmac_f32 v240, v11, v163
    v_fmac_f32 v242, v4, v148
    v_fmac_f32 v240, v12, v164
    v_fmac_f32 v242, v5, v149
    v_fmac_f32 v240, v13, v165
    v_fmac_f32 v242, v6, v150
    v_fmac_f32 v240, v14, v166
    v_fmac_f32 v242, v7, v151
    v_fmac_f32 v240, v15, v167
    v_add_u32 v249, s26, v249
    v_add_u32 v250, s26, v250
    v_fma_f32 v244, v16, v160, -v244
    v_fmac_f32 v236, v24, v112
    v_fmac_f32 v244, v17, v161
    v_fmac_f32 v236, v25, v113
    v_fmac_f32 v244, v18, v162
    v_fmac_f32 v236, v26, v114
    v_fmac_f32 v244, v19, v163
    v_fmac_f32 v236, v27, v115
    v_fmac_f32 v244, v20, v164
    v_fmac_f32 v236, v28, v116
    v_fmac_f32 v244, v21, v165
    v_fmac_f32 v236, v29, v117
    v_fmac_f32 v244, v22, v166
    v_fmac_f32 v236, v30, v118
    v_fmac_f32 v244, v23, v167
    v_fmac_f32 v236, v31, v119
    ds_read_b64_tr_b16 v[0:1], v249 offset:0
    ds_read_b64_tr_b16 v[2:3], v249 offset:256
    ds_read_u16_d16_hi v16, v250 offset:0
    v_mul_f32 v243, v32, v152
    v_fma_f32 v241, v40, v168, -v241
    v_fmac_f32 v243, v33, v153
    v_fmac_f32 v241, v41, v169
    v_fmac_f32 v243, v34, v154
    v_fmac_f32 v241, v42, v170
    v_fmac_f32 v243, v35, v155
    v_fmac_f32 v241, v43, v171
    v_fmac_f32 v243, v36, v156
    v_fmac_f32 v241, v44, v172
    v_fmac_f32 v243, v37, v157
    v_fmac_f32 v241, v45, v173
    v_fmac_f32 v243, v38, v158
    v_fmac_f32 v241, v46, v174
    v_fmac_f32 v243, v39, v159
    v_fmac_f32 v241, v47, v175
    ds_read_b64_tr_b16 v[4:5], v249 offset:512
    ds_read_b64_tr_b16 v[6:7], v249 offset:768
    ds_read_u16_d16_hi v17, v250 offset:32
    v_fma_f32 v245, v48, v168, -v245
    v_fmac_f32 v237, v56, v120
    v_fmac_f32 v245, v49, v169
    v_fmac_f32 v237, v57, v121
    v_fmac_f32 v245, v50, v170
    v_fmac_f32 v237, v58, v122
    v_fmac_f32 v245, v51, v171
    v_fmac_f32 v237, v59, v123
    v_fmac_f32 v245, v52, v172
    v_fmac_f32 v237, v60, v124
    v_fmac_f32 v245, v53, v173
    v_fmac_f32 v237, v61, v125
    v_fmac_f32 v245, v54, v174
    v_fmac_f32 v237, v62, v126
    v_fmac_f32 v245, v55, v175
    v_fmac_f32 v237, v63, v127
    s_cmp_eq_u32 s56, 2
    s_cbranch_scc1 K2_U21
    s_cmp_eq_u32 s56, 3
    s_cbranch_scc1 K2_U31
    s_branch K2_DSP1
K2_nul_50:
    s_mov_b32 s58, 63
    s_mov_b32 s36, 0
    s_branch K2_back_53
K2_spin_51:
    s_sub_u32 s27, s27, 1
    s_cbranch_scc1 K2_END
    v_lshl_add_u32 v233, v252, 1, s53
    ds_read_b32 v233, v233
    s_waitcnt lgkmcnt(0)
    s_branch K2_chk_52
K2_dyn_48:
    v_mov_b32 v254, 160704
    v_mov_b32 v255, 1
    v_lshl_add_u32 v233, v252, 1, s53
    s_mov_b64 exec, 1
    ds_add_rtn_u32 v232, v254, v255
    s_mov_b64 exec, -1
    ds_read_b32 v233, v233
    s_waitcnt lgkmcnt(0)
    v_readfirstlane_b32 s58, v232
    s_nop 0
    s_cmp_lt_u32 s58, s22
    s_cbranch_scc0 K2_nul_50
    s_and_b32 s59, s58, 7
    s_lshr_b32 s60, s58, 3
K2_chk_52:
    v_readlane_b32 s61, v233, s59
    s_nop 0
    s_cmp_gt_u32 s61, s60
    s_cbranch_scc0 K2_spin_51
K2_back_53:
    s_mov_b32 s34, 1
    s_branch K2_back_49
K2_rare_54:
    s_cmp_eq_u32 s33, 4
    s_cbranch_scc1 K2_four_56
    s_mov_b32 s49, s48
    s_mov_b32 s51, s48
    s_add_u32 s45, s44, 256
    s_add_u32 s46, s44, 512
    s_add_u32 s47, s44, 768
    s_branch K2_back_55
K2_four_56:
    s_add_u32 s50, s48, 64
    s_lshr_b32 s51, s3, 27
    s_mov_b32 s66, 148736
    s_cmp_ge_u32 s51, 2
    s_cselect_b32 s66, 146592, s66
    s_mul_i32 s51, s51, 32
    s_add_u32 s51, s51, s66
    s_mov_b32 s46, s44
    s_mov_b32 s47, s44
    s_branch K2_back_55
K2_dum_57:
    v_mov_b32 v232, -1
    s_mov_b32 m0, 160768
    s_mov_b64 exec, 1
    buffer_load_dwordx4 v232, s[16:19], 0 offen lds
    buffer_load_dwordx4 v232, s[16:19], 0 offen lds
    s_mov_b64 exec, -1
    s_branch K2_back_59
K2_a4_58:
    s_lshr_b32 s65, s3, 27
    s_mov_b32 s66, 148736
    s_cmp_ge_u32 s65, 2
    s_cselect_b32 s66, 145632, s66
    s_mul_i32 s65, s65, 512
    s_add_u32 s65, s65, s66
    v_add_u32 v232, s65, v230
    ds_read_b32 v232, v232
    s_add_u32 m0, s65, 480
    s_waitcnt lgkmcnt(0)
    v_or_b32 v232, v232, v231
    buffer_load_dwordx4 v232, s[16:19], 0 offen  lds
    s_branch K2_b4_60
K2_nul_63:
    s_mov_b32 s58, 63
    s_mov_b32 s36, 0
    s_branch K2_back_66
K2_spin_64:
    s_sub_u32 s27, s27, 1
    s_cbranch_scc1 K2_END
    v_lshl_add_u32 v233, v252, 1, s53
    ds_read_b32 v233, v233
    s_waitcnt lgkmcnt(0)
    s_branch K2_chk_65
K2_dyn_61:
    v_mov_b32 v254, 160704
    v_mov_b32 v255, 1
    v_lshl_add_u32 v233, v252, 1, s53
    s_mov_b64 exec, 1
    ds_add_rtn_u32 v232, v254, v255
    s_mov_b64 exec, -1
    ds_read_b32 v233, v233
    s_waitcnt lgkmcnt(0)
    v_readfirstlane_b32 s58, v232
    s_nop 0
    s_cmp_lt_u32 s58, s22
    s_cbranch_scc0 K2_nul_63
    s_and_b32 s59, s58, 7
    s_lshr_b32 s60, s58, 3
K2_chk_65:
    v_readlane_b32 s61, v233, s59
    s_nop 0
    s_cmp_gt_u32 s61, s60
    s_cbranch_scc0 K2_spin_64
K2_back_66:
    s_mov_b32 s34, 1
    s_branch K2_back_62
K2_rare_67:
    s_cmp_eq_u32 s33, 4
    s_cbranch_scc1 K2_four_69
    s_mov_b32 s49, s48
    s_mov_b32 s51, s48
    s_add_u32 s45, s44, 256
    s_add_u32 s46, s44, 512
    s_add_u32 s47, s44, 768
    s_branch K2_back_68
K2_four_69:
    s_add_u32 s50, s48, 64
    s_lshr_b32 s51, s3, 27
    s_mov_b32 s66, 148736
    s_cmp_ge_u32 s51, 2
    s_cselect_b32 s66, 146592, s66
    s_mul_i32 s51, s51, 32
    s_add_u32 s51, s51, s66
    s_mov_b32 s46, s44
    s_mov_b32 s47, s44
    s_branch K2_back_68
K2_dum_70:
    v_mov_b32 v232, -1
    s_mov_b32 m0, 160768
    s_mov_b64 exec, 1
    buffer_load_dwordx4 v232, s[16:19], 0 offen lds
    buffer_load_dwordx4 v232, s[16:19], 0 offen lds
    s_mov_b64 exec, -1
    s_branch K2_back_72
K2_a4_71:
    s_lshr_b32 s65, s3, 27
    s_mov_b32 s66, 148736
    s_cmp_ge_u32 s65, 2
    s_cselect_b32 s66, 145632, s66
    s_mul_i32 s65, s65, 512
    s_add_u32 s65, s65, s66
    v_add_u32 v232, s65, v230
    ds_read_b32 v232, v232
    s_add_u32 m0, s65, 480
    s_waitcnt lgkmcnt(0)
    v_or_b32 v232, v232, v231
    buffer_load_dwordx4 v232, s[16:19], 0 offen  lds
    s_branch K2_b4_73
K2_nul_74:
    s_mov_b32 s58, 63
    s_mov_b32 s36, 0
    s_branch K2_back_77
K2_spin_75:
    s_sub_u32 s27, s27, 1
    s_cbranch_scc1 K2_END
    v_lshl_add_u32 v233, v252, 1, s53
    ds_read_b32 v233, v233
    s_waitcnt lgkmcnt(0)
    s_branch K2_chk_76
K2_rare_78:
    s_cmp_eq_u32 s33, 4
    s_cbranch_scc1 K2_four_80
    s_mov_b32 s49, s48
    s_mov_b32 s51, s48
    s_add_u32 s45, s44, 256
    s_add_u32 s46, s44, 512
    s_add_u32 s47, s44, 768
    s_branch K2_back_79
K2_four_80:
    s_add_u32 s50, s48, 64
    s_lshr_b32 s51, s3, 27
    s_mov_b32 s66, 148736
    s_cmp_ge_u32 s51, 2
    s_cselect_b32 s66, 146592, s66
    s_mul_i32 s51, s51, 32
    s_add_u32 s51, s51, s66
    s_mov_b32 s46, s44
    s_mov_b32 s47, s44
    s_branch K2_back_79
K2_nul_81:
    s_mov_b32 s58, 63
    s_mov_b32 s36, 0
    s_branch K2_back_84
K2_spin_82:
    s_sub_u32 s27, s27, 1
    s_cbranch_scc1 K2_END
    v_lshl_add_u32 v233, v252, 1, s53
    ds_read_b32 v233, v233
    s_waitcnt lgkmcnt(0)
    s_branch K2_chk_83
K2_rare_85:
    s_cmp_eq_u32 s33, 4
    s_cbranch_scc1 K2_four_87
    s_mov_b32 s49, s48
    s_mov_b32 s51, s48
    s_add_u32 s45, s44, 256
    s_add_u32 s46, s44, 512
    s_add_u32 s47, s44, 768
    s_branch K2_back_86
K2_four_87:
    s_add_u32 s50, s48, 64
    s_lshr_b32 s51, s3, 27
    s_mov_b32 s66, 148736
    s_cmp_ge_u32 s51, 2
    s_cselect_b32 s66, 146592, s66
    s_mul_i32 s51, s51, 32
    s_add_u32 s51, s51, s66
    s_mov_b32 s46, s44
    s_mov_b32 s47, s44
    s_branch K2_back_86
K2_END:
    s_endpgm
.section .rodata,"a"
.p2align 6
.amdhsa_kernel standalone__tensor_product_equiv_equiformer__graph_kernel
  .amdhsa_next_free_vgpr 256
  .amdhsa_next_free_sgpr 102
  .amdhsa_accum_offset 256
  .amdhsa_group_segment_fixed_size 0
  .amdhsa_kernarg_size 96
  .amdhsa_user_sgpr_count 2
  .amdhsa_user_sgpr_kernarg_segment_ptr 1
  .amdhsa_system_sgpr_workgroup_id_x 1
  .amdhsa_float_denorm_mode_32 3
.end_amdhsa_kernel
```

```asm
; @launch grid=(256,1,1) block=(512,1,1) lds=163840
.amdgcn_target "amdgcn-amd-amdhsa--gfx950"
.text
.globl standalone__tensor_product_equiv_equiformer__graph_kernel
.p2align 8
.type standalone__tensor_product_equiv_equiformer__graph_kernel,@function
standalone__tensor_product_equiv_equiformer__graph_kernel:
    s_cmp_ge_u32 s2, 256
    s_cbranch_scc1 K2_END
    s_load_dwordx16 s[80:95], s[0:1], 0
    s_load_dwordx4 s[96:99], s[0:1], 72
    s_load_dwordx2 s[100:101], s[0:1], 88
    v_lshrrev_b32 v1, 6, v0
    s_mov_b32 s54, s2
    v_readfirstlane_b32 s20, v1
    s_mov_b64 exec, 0
    s_cmp_eq_u32 s20, 0
    s_cbranch_scc1 K2_PAD_S1
    s_cmp_eq_u32 s20, 1
    s_cbranch_scc1 K2_PAD_S2
    s_cmp_eq_u32 s20, 5
    s_cbranch_scc1 K2_PAD_H1
    s_cmp_eq_u32 s20, 6
    s_cbranch_scc1 K2_PAD_H2
    s_cmp_eq_u32 s20, 2
    s_cbranch_scc1 K2_PAD_H3
KS_HOP0:
    s_mov_b64 exec, -1
    v_and_b32 v8, 63, v0
    v_lshlrev_b32 v9, 4, v8
    v_mov_b32 v6, 0
    v_lshlrev_b32 v5, 4, v0
    v_mul_u32_u24 v4, 24, v0
    s_mul_i32 s64, s2, 5120
    s_mul_i32 s65, s2, 7680
    v_mov_b32 v176, v8
    v_mov_b32 v177, v0
    s_mul_i32 s21, s2, 625
    s_add_u32 s22, s21, 640
    s_add_u32 s21, s21, 15
    s_lshr_b32 s21, s21, 4
    s_lshr_b32 s22, s22, 4
    s_sub_u32 s22, s22, s21
    s_movk_i32 s39, 1024
    s_lshl_b32 s37, s20, 13
    s_mov_b32 s53, 163264
    s_lshl_b32 s52, s20, 2
    s_add_u32 s52, s52, s53
    s_add_u32 s68, s37, 0
    s_add_u32 s69, s37, 2048
    s_add_u32 s70, s37, 4096
    s_add_u32 s71, s37, 6144
    s_waitcnt lgkmcnt(0)
    s_mov_b32 s8, s100
    s_and_b32 s9, s101, 0xffff
    s_mov_b32 s10, 37748736
    s_mov_b32 s11, 0x20000
    s_cmp_lg_u32 s20, 7
    s_cbranch_scc1 KS_NOTAG
    s_mov_b32 s24, 7178240
    s_mov_b64 exec, 1
    buffer_load_dword v14, v6, s[8:11], s24 offen sc1
    s_mov_b64 exec, -1
    s_barrier
    v_mov_b32 v76, 0
    v_mov_b32 v77, -1
    v_lshlrev_b32 v78, 2, v8
    v_add_u32 v78, 163072, v78
    s_mov_b64 exec, 0x1ff
    ds_write_b32 v78, v76 offset:192
    s_mov_b64 exec, 0xff
    ds_write_b32 v78, v77 offset:256
    s_mov_b64 exec, -1
    s_mov_b32 exec_hi, 0xffff
    ds_write_b32 v78, v76
    s_mov_b64 exec, 1
    ds_write_b32 v78, v76 offset:228
    s_mov_b64 exec, -1
    v_add_u32 v85, 16, v8
    v_lshlrev_b32 v84, 5, v8
    v_lshrrev_b32 v85, 6, v85
    v_mul_u32_u24 v85, 1532, v85
    v_sub_u32 v84, v84, v85
    v_mov_b32 v85, -1
    v_add_u32 v84, 107648, v84
    v_add_u32 v86, 41600, v84
    ds_write_b32 v84, v85 offset:0
    ds_write_b32 v84, v85 offset:2080
    ds_write_b32 v84, v85 offset:4160
    ds_write_b32 v84, v85 offset:6240
    ds_write_b32 v84, v85 offset:8320
    ds_write_b32 v84, v85 offset:10400
    ds_write_b32 v84, v85 offset:12480
    ds_write_b32 v84, v85 offset:14560
    ds_write_b32 v84, v85 offset:16640
    ds_write_b32 v84, v85 offset:18720
    ds_write_b32 v84, v85 offset:20800
    ds_write_b32 v84, v85 offset:22880
    ds_write_b32 v84, v85 offset:24960
    ds_write_b32 v84, v85 offset:27040
    ds_write_b32 v84, v85 offset:29120
    ds_write_b32 v84, v85 offset:31200
    ds_write_b32 v84, v85 offset:33280
    ds_write_b32 v84, v85 offset:35360
    ds_write_b32 v84, v85 offset:37440
    ds_write_b32 v84, v85 offset:39520
    s_mov_b64 exec, 1
    v_mov_b32 v12, 163376
    s_mov_b32 s24, 1664525
    s_waitcnt vmcnt(0)
    v_mul_lo_u32 v14, v14, s24
    v_add_u32 v14, 1013904223, v14
    ds_write_b32 v12, v14
KS_TAGOK2:
    s_mov_b64 exec, -1
    s_waitcnt lgkmcnt(0)
    s_barrier
    s_branch KS_B3
KS_H0:
    s_barrier
    s_branch KS_HELP
K2_PAD_S1:
    s_branch KS_HOP0
KS_NOTAG:
    s_cmp_ge_u32 s20, 5
    s_cbranch_scc1 KS_HELP
    s_cmp_ge_u32 s2, 250
    s_cbranch_scc1 KS_IDLE
    s_mov_b32 s40, s88
    s_and_b32 s41, s89, 0xffff
    s_mov_b32 s42, 1280000
    s_mov_b32 s43, 0x20000
    buffer_load_dwordx4 v[12:15], v5, s[40:43], s64 offen
    s_mov_b32 s44, s86
    s_and_b32 s45, s87, 0xffff
    s_mov_b32 s46, 1280000
    s_mov_b32 s47, 0x20000
    s_mov_b32 s48, s82
    s_and_b32 s49, s83, 0xffff
    s_mov_b32 s50, 1920000
    s_mov_b32 s51, 0x20000
    buffer_load_dwordx4 v[16:19], v5, s[44:47], s64 offen
    buffer_load_dwordx4 v[20:23], v4, s[48:51], s65 offen
    buffer_load_dwordx2 v[24:25], v4, s[48:51], s65 offen offset:16
    v_lshlrev_b32 v2, 2, v0
    s_lshl_b32 s64, s64, 3
    v_lshl_add_u32 v3, v0, 7, s64
    v_mov_b32 v7, 1
    s_cmp_eq_u32 s20, 4
    s_cbranch_scc1 KS_NOCLR
    ds_write_b32 v2, v6
KS_NOCLR:
    s_waitcnt lgkmcnt(0)
    s_barrier
    s_mov_b64 exec, 0
    s_cmp_eq_u32 s20, 0
    s_cbranch_scc1 K2_PAD_B3
    s_cmp_eq_u32 s20, 1
    s_cbranch_scc1 K2_PAD_LD
    s_cmp_eq_u32 s20, 2
    s_cbranch_scc1 K2_PAD_NW
    s_cmp_eq_u32 s20, 3
    s_cbranch_scc1 K2_PAD_SC
    s_cmp_eq_u32 s20, 4
    s_cbranch_scc1 K2_PAD_SD
KS_HOP:
    s_mov_b64 exec, -1
    s_mov_b32 s58, 429497
    s_movk_i32 s59, 625
    s_waitcnt vmcnt(3)
    v_mul_u32_u24 v28, s58, v12
    v_lshrrev_b32 v32, 27, v28
    v_bfe_u32 v36, v28, 24, 3
    v_lshlrev_b32 v32, 2, v32
    v_lshl_or_b32 v32, v36, 7, v32
    ds_add_rtn_u32 v36, v32, v7
    v_mul_u32_u24 v29, s58, v13
    v_lshrrev_b32 v33, 27, v29
    v_bfe_u32 v37, v29, 24, 3
    v_lshlrev_b32 v33, 2, v33
    v_lshl_or_b32 v33, v37, 7, v33
    ds_add_rtn_u32 v37, v33, v7
    v_mul_u32_u24 v30, s58, v14
    v_lshrrev_b32 v34, 27, v30
    v_bfe_u32 v38, v30, 24, 3
    v_lshlrev_b32 v34, 2, v34
    v_lshl_or_b32 v34, v38, 7, v34
    ds_add_rtn_u32 v38, v34, v7
    v_mul_u32_u24 v31, s58, v15
    v_lshrrev_b32 v35, 27, v31
    v_bfe_u32 v39, v31, 24, 3
    v_lshlrev_b32 v35, 2, v35
    v_lshl_or_b32 v35, v39, 7, v35
    ds_add_rtn_u32 v39, v35, v7
    v_lshrrev_b32 v28, 24, v28
    v_mad_u32_u24 v28, v28, s59, 15
    v_lshrrev_b32 v28, 4, v28
    v_sub_u32 v28, v12, v28
    v_add_u32 v12, 0, v3
    v_lshl_or_b32 v28, v28, 26, v12
    v_lshrrev_b32 v29, 24, v29
    v_mad_u32_u24 v29, v29, s59, 15
    v_lshrrev_b32 v29, 4, v29
    v_sub_u32 v29, v13, v29
    v_add_u32 v13, 32, v3
    v_lshl_or_b32 v29, v29, 26, v13
    v_lshrrev_b32 v30, 24, v30
    v_mad_u32_u24 v30, v30, s59, 15
    v_lshrrev_b32 v30, 4, v30
    v_sub_u32 v30, v14, v30
    v_add_u32 v14, 64, v3
    v_lshl_or_b32 v30, v30, 26, v14
    v_lshrrev_b32 v31, 24, v31
    v_mad_u32_u24 v31, v31, s59, 15
    v_lshrrev_b32 v31, 4, v31
    v_sub_u32 v31, v15, v31
    v_add_u32 v15, 96, v3
    v_lshl_or_b32 v31, v31, 26, v15
K2_PAD_S2:
    s_cbranch_execz KS_HOP0
    v_mov_b32 v59, 163376
    s_mul_i32 s65, s2, 1152
    s_add_u32 s65, s65, 6291456
    s_mul_i32 s64, s2, 20608
    s_waitcnt lgkmcnt(0)
    s_barrier
    ds_read_b128 v[40:43], v9
    ds_read_b32 v59, v59
    s_waitcnt lgkmcnt(1)
    v_add_u32 v45, v40, v41
    v_add_u32 v46, v45, v42
    v_add_u32 v47, v46, v43
    v_mov_b32 v58, v47
    s_nop 1
    v_add_u32_dpp v58, v58, v58 row_shr:1 row_mask:0xf bank_mask:0xf bound_ctrl:0
    s_nop 1
    v_add_u32_dpp v58, v58, v58 row_shr:2 row_mask:0xf bank_mask:0xf bound_ctrl:0
    s_nop 1
    v_add_u32_dpp v58, v58, v58 row_shr:4 row_mask:0xf bank_mask:0xf bound_ctrl:0
    s_nop 1
    v_add_u32_dpp v58, v58, v58 row_shr:8 row_mask:0xf bank_mask:0xf bound_ctrl:0
    s_nop 1
    v_add_u32_dpp v58, v58, v58 row_bcast:15 row_mask:0xa bank_mask:0xf
    s_nop 1
    v_add_u32_dpp v58, v58, v58 row_bcast:31 row_mask:0xc bank_mask:0xf
    v_sub_u32 v48, v58, v47
    v_add_u32 v49, v48, v40
    v_add_u32 v50, v48, v45
    v_add_u32 v51, v48, v46
    ds_write_b128 v9, v[48:51] offset:1024
    s_waitcnt vmcnt(0) lgkmcnt(1)
    s_cmp_lg_u32 s20, 4
    s_cbranch_scc1 KS_NOPUB
    v_lshl_or_b32 v56, v49, 11, v48
    v_lshl_or_b32 v57, v51, 11, v50
    v_lshl_or_b32 v56, v59, 22, v56
    v_lshl_or_b32 v57, v59, 22, v57
    buffer_store_dwordx4 v[56:59], v9, s[8:11], s65 offen sc1
KS_NOPUB:
    s_waitcnt lgkmcnt(0)
    ds_read_b32 v32, v32 offset:1024
    ds_read_b32 v33, v33 offset:1024
    ds_read_b32 v34, v34 offset:1024
    ds_read_b32 v35, v35 offset:1024
    v_and_b32 v60, 0xffff, v59
    v_and_b32 v61, 0xffff0000, v59
    s_mov_b32 s58, 0xffff0000
    v_mov_b32 v40, v20
    v_lshl_or_b32 v41, v21, 16, v60
    v_or_b32 v42, v61, v16
    v_mov_b32 v43, v28
    v_alignbit_b32 v44, v22, v21, 16
    v_and_or_b32 v45, v22, s58, v60
    v_or_b32 v46, v61, v17
    v_mov_b32 v47, v29
    v_mov_b32 v48, v23
    v_lshl_or_b32 v49, v24, 16, v60
    v_or_b32 v50, v61, v18
    v_mov_b32 v51, v30
    v_alignbit_b32 v52, v25, v24, 16
    v_and_or_b32 v53, v25, s58, v60
    v_or_b32 v54, v61, v19
    v_mov_b32 v55, v31
    s_waitcnt lgkmcnt(0)
    v_add_lshl_u32 v32, v32, v36, 4
    ds_write_b128 v32, v[40:43] offset:2048
    v_add_lshl_u32 v33, v33, v37, 4
    ds_write_b128 v33, v[44:47] offset:2048
    v_add_lshl_u32 v34, v34, v38, 4
    ds_write_b128 v34, v[48:51] offset:2048
    v_add_lshl_u32 v35, v35, v39, 4
    ds_write_b128 v35, v[52:55] offset:2048
    s_waitcnt lgkmcnt(0)
    s_barrier
    ds_read_b128 v[12:15], v5 offset:2048
    ds_read_b128 v[16:19], v5 offset:7168
    ds_read_b128 v[20:23], v5 offset:12288
    ds_read_b128 v[24:27], v5 offset:17408
    s_waitcnt lgkmcnt(3)
    buffer_store_dwordx4 v[12:15], v5, s[8:11], s64 offen sc1
    s_add_u32 s64, s64, 5120
    s_waitcnt lgkmcnt(2)
    buffer_store_dwordx4 v[16:19], v5, s[8:11], s64 offen sc1
    s_add_u32 s64, s64, 5120
    s_waitcnt lgkmcnt(1)
    buffer_store_dwordx4 v[20:23], v5, s[8:11], s64 offen sc1
    s_add_u32 s64, s64, 5120
    s_waitcnt lgkmcnt(0)
    buffer_store_dwordx4 v[24:27], v5, s[8:11], s64 offen sc1
    s_branch KS_JOIN
K2_PAD_B3:
    s_branch KS_HOP
KS_B3:
    v_mov_b32 v59, 163376
    ds_read_b32 v59, v59
    s_waitcnt lgkmcnt(0)
    s_barrier
KS_JOIN:
    v_readfirstlane_b32 s2, v59
    s_mov_b32 s23, 0
    s_mov_b32 s28, 1
    s_mov_b32 s24, 0
    s_mov_b32 s25, 1
K2_CELLS:
    v_lshrrev_b32 v178, 1, v177
    v_min_u32 v178, 249, v178
    v_mul_u32_u24 v72, 1152, v178
    s_and_b32 s58, s54, 7
    s_lshl_b32 s58, s58, 7
    s_lshr_b32 s59, s54, 5
    s_lshl_b32 s59, s59, 4
    s_add_u32 s67, s58, s59
    s_add_u32 s67, s67, 6291456
    buffer_load_dwordx4 v[76:79], v72, s[8:11], s67 offen sc1
    s_cmp_eq_u32 s28, 0
    s_cbranch_scc1 K2_NOSRD
    s_mov_b32 s4, s80
    s_and_b32 s5, s81, 0xffff
    s_mov_b32 s6, 10240000
    s_mov_b32 s7, 0x20000
    s_mov_b32 s12, s96
    s_and_b32 s13, s97, 0xffff
    s_mov_b32 s14, 10240000
    s_mov_b32 s15, 0x20000
    s_mov_b32 s16, s84
    s_and_b32 s17, s85, 0xffff
    s_mov_b32 s18, 10240000
    s_mov_b32 s19, 0x20000
    s_sub_u32 s80, s80, 1024
    s_subb_u32 s81, s81, 0
    s_mov_b32 s72, s80
    s_and_b32 s73, s81, 0xffff
    s_mov_b32 s74, 10241024
    s_mov_b32 s75, 0x20000
    s_mov_b64 exec, 0
    s_cmp_eq_u32 s20, 0
    s_cbranch_scc1 K2_PAD_U20
    s_cmp_eq_u32 s20, 1
    s_cbranch_scc1 K2_PAD_U30
    s_cmp_eq_u32 s20, 2
    s_cbranch_scc1 K2_PAD_U21
    s_cmp_eq_u32 s20, 3
    s_cbranch_scc1 K2_PAD_U31
    s_cmp_eq_u32 s20, 4
    s_cbranch_scc1 K2_PAD_SW
    s_cmp_eq_u32 s20, 5
    s_cbranch_scc1 K2_PAD_TL
    s_cmp_eq_u32 s20, 6
    s_cbranch_scc1 K2_PAD_T2
K2_HOP:
    s_mov_b64 exec, -1
K2_NOSRD:
    v_and_b32 v84, 15, v176
    v_lshrrev_b32 v85, 5, v176
    v_bfe_u32 v86, v176, 4, 1
    v_lshrrev_b32 v87, 2, v84
    v_and_b32 v88, 3, v84
    v_lshl_add_u32 v89, v85, 3, v87
    v_lshl_add_u32 v90, v87, 1, v85
    v_lshlrev_b32 v249, 5, v90
    v_lshl_add_u32 v249, v88, 3, v249
    v_add_u32 v249, 512, v249
    v_lshrrev_b32 v90, 3, v84
    v_lshl_add_u32 v90, v90, 1, v86
    v_sub_u32 v90, v90, 1 clamp
    v_lshlrev_b32 v250, 7, v90
    v_and_b32 v91, 7, v84
    v_lshl_add_u32 v91, v91, 1, v85
    v_lshl_add_u32 v250, v91, 1, v250
    v_lshrrev_b32 v90, 1, v88
    v_lshl_add_u32 v90, v86, 1, v90
    v_bfe_u32 v91, v87, 1, 1
    v_lshlrev_b32 v91, 2, v91
    v_xor_b32 v90, v90, v91
    v_lshlrev_b32 v90, 4, v90
    v_lshl_add_u32 v90, v89, 7, v90
    v_and_b32 v91, 1, v88
    v_lshl_add_u32 v90, v91, 3, v90
    v_add_u32 v246, s37, v90
    v_xor_b32 v247, 64, v246
    v_lshrrev_b32 v90, 3, v176
    v_lshlrev_b32 v251, 2, v90
    v_add_u32 v251, 384, v251
    v_bfe_u32 v90, v90, 1, 1
    v_lshlrev_b32 v90, 2, v90
    v_and_b32 v91, 7, v176
    v_xor_b32 v90, v90, v91
    v_lshlrev_b32 v248, 4, v90
    v_lshlrev_b32 v252, 1, v176
    v_and_b32 v231, 1, v176
    v_lshlrev_b32 v231, 4, v231
    v_lshrrev_b32 v90, 1, v176
    v_lshlrev_b32 v90, 5, v90
    v_add_u32 v230, 512, v90
    s_lshl_b32 s59, s2, 22
    s_mov_b32 s60, 0x40000
    s_bfe_u32 s61, s54, 0x10004
    s_bfe_u32 s62, s54, 0x10003
    s_add_u32 s63, s61, s62
    s_mul_i32 s62, s62, 11
    s_sub_u32 s64, 11, s62
    v_cmp_gt_u32 vcc, 500, v177
    s_nop 0
    s_mov_b64 s[56:57], vcc
K2_POLL:
    s_waitcnt vmcnt(0)
    v_xor_b32 v73, s59, v76
    v_xor_b32 v74, s59, v77
    v_or_b32 v73, v73, v74
    v_xor_b32 v74, s2, v79
    v_lshrrev_b32 v73, 22, v73
    v_or_b32 v73, v73, v74
    v_cmp_ne_u32 vcc, 0, v73
    s_nop 0
    s_cbranch_vccz K2_POLLED
    s_sub_u32 s60, s60, 1
    s_cbranch_scc1 K2_END
    s_mov_b64 exec, vcc
    buffer_load_dwordx4 v[76:79], v72, s[8:11], s67 offen sc1
    s_mov_b64 exec, -1
    s_branch K2_POLL
K2_PAD_LD:
    s_branch KS_HOP
K2_POLLED:
    s_set_gpr_idx_on s61, gpr_idx(SRC0)
    s_nop 0
    v_bfe_u32 v179, v76, s62, 11
    s_set_gpr_idx_idx s63
    s_nop 0
    v_bfe_u32 v73, v76, s64, 11
    s_set_gpr_idx_off
    v_sub_u32 v73, v73, v179
    v_cndmask_b32 v73, 0, v73, s[56:57]
    v_and_b32 v1, 1, v177
    v_add_u32 v1, s23, v1
    v_sub_u32 v180, v73, v1
    v_add_u32 v179, v179, v1
    v_mul_u32_u24 v181, 20608, v178
    v_lshl_add_u32 v181, v179, 4, v181
    v_cmp_lt_i32 s[40:41], 0, v180
    v_add_u32 v182, 32, v181
    s_mov_b32 s65, 0
    s_mov_b64 exec, s[40:41]
    buffer_load_dwordx4 v[0:3], v181, s[8:11], 0 offen offset:0 sc1
    s_mov_b64 exec, -1
    v_cmp_lt_i32 s[42:43], 2, v180
    v_cmp_lt_i32 s[44:45], 4, v180
    v_cmp_lt_i32 s[46:47], 6, v180
    v_cmp_lt_i32 s[48:49], 8, v180
    v_cmp_lt_i32 s[50:51], 10, v180
    v_cmp_lt_i32 s[90:91], 12, v180
    v_cmp_lt_i32 s[92:93], 14, v180
    v_cmp_lt_i32 s[94:95], 16, v180
    v_cmp_lt_i32 s[96:97], 18, v180
    v_add_u32 v183, 64, v181
    v_add_u32 v184, 96, v181
    v_subrev_u32 v62, 1, v180
    v_ashrrev_i32 v62, 1, v62
    v_med3_i32 v62, v62, 0, 9
    s_cmp_eq_u64 s[42:43], 0
    s_cbranch_scc1 K2_LD_DONE
    v_mov_b32 v63, v62
    s_nop 1
    v_add_u32_dpp v63, v63, v63 row_shr:1 row_mask:0xf bank_mask:0xf bound_ctrl:0
    s_nop 1
    v_add_u32_dpp v63, v63, v63 row_shr:2 row_mask:0xf bank_mask:0xf bound_ctrl:0
    s_nop 1
    v_add_u32_dpp v63, v63, v63 row_shr:4 row_mask:0xf bank_mask:0xf bound_ctrl:0
    s_nop 1
    v_add_u32_dpp v63, v63, v63 row_shr:8 row_mask:0xf bank_mask:0xf bound_ctrl:0
    s_nop 1
    v_add_u32_dpp v63, v63, v63 row_bcast:15 row_mask:0xa bank_mask:0xf
    s_nop 1
    v_add_u32_dpp v63, v63, v63 row_bcast:31 row_mask:0xc bank_mask:0xf
    s_lshl_b32 s58, s20, 10
    s_add_u32 s58, s58, 45056
    v_readlane_b32 s59, v63, 63
    v_sub_u32 v63, v63, v62
    v_lshl_add_u32 v64, v63, 2, s58
    v_lshlrev_b32 v63, 5, v63
    v_sub_u32 v63, v182, v63
    s_cmp_gt_u32 s59, 189
    s_cbranch_scc1 K2_LD_GEN
    s_mov_b64 exec, s[42:43]
    s_cbranch_execz K2_LD_L
    ds_write_b32 v64, v63 offset:0
    s_mov_b64 exec, s[44:45]
    s_cbranch_execz K2_LD_L
    ds_write_b32 v64, v63 offset:4
    s_mov_b64 exec, s[46:47]
    s_cbranch_execz K2_LD_L
    ds_write_b32 v64, v63 offset:8
    s_mov_b64 exec, s[48:49]
    s_cbranch_execz K2_LD_L
    ds_write_b32 v64, v63 offset:12
    s_mov_b64 exec, s[50:51]
    s_cbranch_execz K2_LD_L
    ds_write_b32 v64, v63 offset:16
    s_mov_b64 exec, s[90:91]
    s_cbranch_execz K2_LD_L
    ds_write_b32 v64, v63 offset:20
    s_mov_b64 exec, s[92:93]
    s_cbranch_execz K2_LD_L
    ds_write_b32 v64, v63 offset:24
    s_mov_b64 exec, s[94:95]
    s_cbranch_execz K2_LD_L
    ds_write_b32 v64, v63 offset:28
    s_mov_b64 exec, s[96:97]
    s_cbranch_execz K2_LD_L
    ds_write_b32 v64, v63 offset:32
K2_LD_L:
    s_mov_b64 exec, -1
    v_lshl_add_u32 v63, v176, 2, s58
    v_lshlrev_b32 v62, 5, v176
    s_waitcnt lgkmcnt(0)
    ds_read_b32 v64, v63 offset:0
    ds_read_b32 v65, v63 offset:252
    ds_read_b32 v66, v63 offset:504
    s_min_u32 s60, s59, 63
    s_sub_u32 s59, s59, s60
    s_bfm_b64 s[42:43], s60, 0
    s_min_u32 s60, s59, 63
    s_sub_u32 s59, s59, s60
    s_bfm_b64 s[44:45], s60, 0
    s_min_u32 s60, s59, 63
    s_sub_u32 s59, s59, s60
    s_bfm_b64 s[46:47], s60, 0
    s_mov_b64 s[48:49], 0
    s_mov_b32 s65, 1
    s_mov_b32 s60, 0
    s_waitcnt lgkmcnt(2)
    v_add3_u32 v182, v62, v64, s60
    s_mov_b64 exec, s[42:43]
    buffer_load_dwordx4 v[4:7], v182, s[8:11], 0 offen sc1
    s_mov_b32 s60, 2016
    s_waitcnt lgkmcnt(1)
    v_add3_u32 v183, v62, v65, s60
    s_mov_b64 exec, s[44:45]
    buffer_load_dwordx4 v[8:11], v183, s[8:11], 0 offen sc1
    s_mov_b32 s60, 4032
    s_waitcnt lgkmcnt(0)
    v_add3_u32 v184, v62, v66, s60
    s_mov_b64 exec, s[46:47]
    buffer_load_dwordx4 v[12:15], v184, s[8:11], 0 offen sc1
K2_LD_DONE:
    s_mov_b64 exec, -1
    s_cmp_eq_u32 s28, 0
    s_cbranch_scc1 K2_WLATE
    v_lshrrev_b32 v60, 6, v252
    v_bfe_u32 v61, v252, 3, 2
    v_lshl_add_u32 v60, v60, 2, v61
    v_mul_u32_u24 v60, 640, v60
    v_bfe_u32 v61, v252, 5, 1
    v_lshl_add_u32 v60, v61, 5, v60
    v_and_b32 v61, 6, v252
    v_lshl_add_u32 v60, v61, 2, v60
    v_add_u32 v60, 24576, v60
    ds_read_b64_tr_b16 v[136:137], v60 offset:0
    ds_read_b64_tr_b16 v[138:139], v60 offset:5120
    ds_read_b64_tr_b16 v[140:141], v60 offset:64
    ds_read_b64_tr_b16 v[142:143], v60 offset:5184
    ds_read_b64_tr_b16 v[144:145], v60 offset:128
    ds_read_b64_tr_b16 v[146:147], v60 offset:5248
    ds_read_b64_tr_b16 v[148:149], v60 offset:192
    ds_read_b64_tr_b16 v[150:151], v60 offset:5312
    ds_read_b64_tr_b16 v[152:153], v60 offset:256
    ds_read_b64_tr_b16 v[154:155], v60 offset:5376
    ds_read_b64_tr_b16 v[156:157], v60 offset:320
    ds_read_b64_tr_b16 v[158:159], v60 offset:5440
    ds_read_b64_tr_b16 v[160:161], v60 offset:384
    ds_read_b64_tr_b16 v[162:163], v60 offset:5504
    ds_read_b64_tr_b16 v[164:165], v60 offset:448
    ds_read_b64_tr_b16 v[166:167], v60 offset:5568
    ds_read_b64_tr_b16 v[168:169], v60 offset:512
    ds_read_b64_tr_b16 v[170:171], v60 offset:5632
    ds_read_b64_tr_b16 v[172:173], v60 offset:576
    ds_read_b64_tr_b16 v[174:175], v60 offset:5696
    s_waitcnt lgkmcnt(0)
K2_WUNP:
    v_lshlrev_b32 v96, 16, v136
    v_and_b32 v97, 0xffff0000, v136
    v_lshlrev_b32 v98, 16, v137
    v_and_b32 v99, 0xffff0000, v137
    v_lshlrev_b32 v100, 16, v138
    v_and_b32 v101, 0xffff0000, v138
    v_lshlrev_b32 v102, 16, v139
    v_and_b32 v103, 0xffff0000, v139
    v_lshlrev_b32 v104, 16, v140
    v_and_b32 v105, 0xffff0000, v140
    v_lshlrev_b32 v106, 16, v141
    v_and_b32 v107, 0xffff0000, v141
    v_lshlrev_b32 v108, 16, v142
    v_and_b32 v109, 0xffff0000, v142
    v_lshlrev_b32 v110, 16, v143
    v_and_b32 v111, 0xffff0000, v143
    v_lshlrev_b32 v112, 16, v144
    v_and_b32 v113, 0xffff0000, v144
    v_lshlrev_b32 v114, 16, v145
    v_and_b32 v115, 0xffff0000, v145
    v_lshlrev_b32 v116, 16, v146
    v_and_b32 v117, 0xffff0000, v146
    v_lshlrev_b32 v118, 16, v147
    v_and_b32 v119, 0xffff0000, v147
    v_lshlrev_b32 v120, 16, v148
    v_and_b32 v121, 0xffff0000, v148
    v_lshlrev_b32 v122, 16, v149
    v_and_b32 v123, 0xffff0000, v149
    v_lshlrev_b32 v124, 16, v150
    v_and_b32 v125, 0xffff0000, v150
    v_lshlrev_b32 v126, 16, v151
    v_and_b32 v127, 0xffff0000, v151
    v_lshlrev_b32 v128, 16, v152
    v_and_b32 v129, 0xffff0000, v152
    v_lshlrev_b32 v130, 16, v153
    v_and_b32 v131, 0xffff0000, v153
    v_lshlrev_b32 v132, 16, v154
    v_and_b32 v133, 0xffff0000, v154
    v_lshlrev_b32 v134, 16, v155
    v_and_b32 v135, 0xffff0000, v155
    v_lshlrev_b32 v136, 16, v156
    v_and_b32 v137, 0xffff0000, v156
    v_lshlrev_b32 v138, 16, v157
    v_and_b32 v139, 0xffff0000, v157
    v_lshlrev_b32 v140, 16, v158
    v_and_b32 v141, 0xffff0000, v158
    v_lshlrev_b32 v142, 16, v159
    v_and_b32 v143, 0xffff0000, v159
    v_lshlrev_b32 v144, 16, v160
    v_and_b32 v145, 0xffff0000, v160
    v_lshlrev_b32 v146, 16, v161
    v_and_b32 v147, 0xffff0000, v161
    v_lshlrev_b32 v148, 16, v162
    v_and_b32 v149, 0xffff0000, v162
    v_lshlrev_b32 v150, 16, v163
    v_and_b32 v151, 0xffff0000, v163
    v_lshlrev_b32 v152, 16, v164
    v_and_b32 v153, 0xffff0000, v164
    v_lshlrev_b32 v154, 16, v165
    v_and_b32 v155, 0xffff0000, v165
    v_lshlrev_b32 v156, 16, v166
    v_and_b32 v157, 0xffff0000, v166
    v_lshlrev_b32 v158, 16, v167
    v_and_b32 v159, 0xffff0000, v167
    v_lshlrev_b32 v160, 16, v168
    v_and_b32 v161, 0xffff0000, v168
    v_lshlrev_b32 v162, 16, v169
    v_and_b32 v163, 0xffff0000, v169
    v_lshlrev_b32 v164, 16, v170
    v_and_b32 v165, 0xffff0000, v170
    v_lshlrev_b32 v166, 16, v171
    v_and_b32 v167, 0xffff0000, v171
    v_lshlrev_b32 v168, 16, v172
    v_and_b32 v169, 0xffff0000, v172
    v_lshlrev_b32 v170, 16, v173
    v_and_b32 v171, 0xffff0000, v173
    v_lshlrev_b32 v172, 16, v174
    v_and_b32 v173, 0xffff0000, v174
    v_lshlrev_b32 v174, 16, v175
    v_and_b32 v175, 0xffff0000, v175
K2_NOWRAW:
K2_PAD_NW:
    s_cbranch_execz KS_HOP
    v_lshrrev_b32 v179, 2, v181
    v_lshrrev_b32 v185, 2, v182
    v_lshrrev_b32 v186, 2, v183
    v_lshrrev_b32 v187, 2, v184
    s_mov_b32 s66, 7340032
    v_mov_b32 v201, 1
    s_movk_i32 s58, 520
    s_movk_i32 s59, 2080
    s_mov_b32 s60, 0x40000
    s_mov_b32 s61, 0xffff
    v_mov_b32 v202, 65536
    s_cmp_lg_u32 s24, 0
    s_cbranch_scc1 K2_RK_LOAD
    v_cmp_lt_i32 vcc, 20, v180
    s_nop 0
    s_cbranch_vccz K2_NOMORE
    v_mov_b32 v61, 163300
    ds_write_b32 v61, v201
K2_NOMORE:
    v_lshlrev_b32 v72, 4, v176
    s_mov_b32 s64, 7176192
    s_mov_b32 s62, 82176
    s_cmp_eq_u32 s65, 0
    s_waitcnt vmcnt(3)
    s_cbranch_scc0 K2_ARR
    s_waitcnt vmcnt(0)
K2_ARR:
    s_mov_b64 exec, s[40:41]
    s_cbranch_execz K2_RK_A
K2_CK0:
    v_bfi_b32 v192, s61, v1, v2
    v_lshrrev_b32 v50, 24, v3
    v_cmp_ne_u32 vcc, s2, v192
    v_add_u32 v40, 163072, v50
    s_cbranch_vccnz K2_RT0
    ds_add_rtn_u32 v40, v40, v201
    v_mad_u32_u24 v50, v50, s58, v202
    s_mov_b64 exec, s[42:43]
    s_cbranch_execz K2_RK_A
    s_waitcnt vmcnt(2)
K2_CK1:
    v_bfi_b32 v192, s61, v5, v6
    v_lshrrev_b32 v51, 24, v7
    v_cmp_ne_u32 vcc, s2, v192
    v_add_u32 v41, 163072, v51
    s_cbranch_vccnz K2_RT1
    ds_add_rtn_u32 v41, v41, v201
    v_mad_u32_u24 v51, v51, s58, v202
    s_mov_b64 exec, s[44:45]
    s_cbranch_execz K2_RK_A
    s_waitcnt vmcnt(1)
K2_CK2:
    v_bfi_b32 v192, s61, v9, v10
    v_lshrrev_b32 v52, 24, v11
    v_cmp_ne_u32 vcc, s2, v192
    v_add_u32 v42, 163072, v52
    s_cbranch_vccnz K2_RT2
    ds_add_rtn_u32 v42, v42, v201
    v_mad_u32_u24 v52, v52, s58, v202
    s_mov_b64 exec, s[46:47]
    s_cbranch_execz K2_RK_A
    s_waitcnt vmcnt(0)
K2_CK3:
    v_bfi_b32 v192, s61, v13, v14
    v_lshrrev_b32 v53, 24, v15
    v_cmp_ne_u32 vcc, s2, v192
    v_add_u32 v43, 163072, v53
    s_cbranch_vccnz K2_RT3
    ds_add_rtn_u32 v43, v43, v201
    v_mad_u32_u24 v53, v53, s58, v202
    s_mov_b64 exec, s[48:49]
    s_cbranch_execz K2_RK_A
K2_CK4:
    v_bfi_b32 v192, s61, v17, v18
    v_lshrrev_b32 v54, 24, v19
    v_cmp_ne_u32 vcc, s2, v192
    v_add_u32 v44, 163072, v54
    s_cbranch_vccnz K2_RT4
    ds_add_rtn_u32 v44, v44, v201
    v_mad_u32_u24 v54, v54, s58, v202
    s_mov_b64 exec, s[50:51]
    s_cbranch_execz K2_RK_A
K2_CK5:
    v_bfi_b32 v192, s61, v21, v22
    v_lshrrev_b32 v55, 24, v23
    v_cmp_ne_u32 vcc, s2, v192
    v_add_u32 v45, 163072, v55
    s_cbranch_vccnz K2_RT5
    ds_add_rtn_u32 v45, v45, v201
    v_mad_u32_u24 v55, v55, s58, v202
    s_mov_b64 exec, s[90:91]
    s_cbranch_execz K2_RK_A
K2_CK6:
    v_bfi_b32 v192, s61, v25, v26
    v_lshrrev_b32 v56, 24, v27
    v_cmp_ne_u32 vcc, s2, v192
    v_add_u32 v46, 163072, v56
    s_cbranch_vccnz K2_RT6
    ds_add_rtn_u32 v46, v46, v201
    v_mad_u32_u24 v56, v56, s58, v202
    s_mov_b64 exec, s[92:93]
    s_cbranch_execz K2_RK_A
K2_CK7:
    v_bfi_b32 v192, s61, v29, v30
    v_lshrrev_b32 v57, 24, v31
    v_cmp_ne_u32 vcc, s2, v192
    v_add_u32 v47, 163072, v57
    s_cbranch_vccnz K2_RT7
    ds_add_rtn_u32 v47, v47, v201
    v_mad_u32_u24 v57, v57, s58, v202
    s_mov_b64 exec, s[94:95]
    s_cbranch_execz K2_RK_A
K2_CK8:
    v_bfi_b32 v192, s61, v33, v34
    v_lshrrev_b32 v58, 24, v35
    v_cmp_ne_u32 vcc, s2, v192
    v_add_u32 v48, 163072, v58
    s_cbranch_vccnz K2_RT8
    ds_add_rtn_u32 v48, v48, v201
    v_mad_u32_u24 v58, v58, s58, v202
    s_mov_b64 exec, s[96:97]
    s_cbranch_execz K2_RK_A
K2_CK9:
    v_bfi_b32 v192, s61, v37, v38
    v_lshrrev_b32 v59, 24, v39
    v_cmp_ne_u32 vcc, s2, v192
    v_add_u32 v49, 163072, v59
    s_cbranch_vccnz K2_RT9
    ds_add_rtn_u32 v49, v49, v201
    v_mad_u32_u24 v59, v59, s58, v202
K2_RK_A:
    s_mov_b64 exec, -1
    s_cmp_eq_u32 s20, 7
    s_cbranch_scc1 K2_FLGLD
K2_FLGL2:
    s_mov_b64 exec, s[40:41]
    s_cbranch_execz K2_TP
    v_cmp_gt_u32 vcc, s62, v50
    v_and_b32 v3, 0xffffff, v3
    s_mov_b64 exec, vcc
    buffer_load_dword v245, v3, s[16:19], 0 offen
    s_mov_b64 exec, s[42:43]
    s_cbranch_execz K2_TP
    v_cmp_gt_u32 vcc, s62, v51
    v_and_b32 v7, 0xffffff, v7
    s_mov_b64 exec, vcc
    buffer_load_dword v245, v7, s[16:19], 0 offen
    s_mov_b64 exec, s[44:45]
    s_cbranch_execz K2_TP
    v_cmp_gt_u32 vcc, s62, v52
    v_and_b32 v11, 0xffffff, v11
    s_mov_b64 exec, vcc
    buffer_load_dword v245, v11, s[16:19], 0 offen
    s_mov_b64 exec, s[46:47]
    s_cbranch_execz K2_TP
    v_cmp_gt_u32 vcc, s62, v53
    v_and_b32 v15, 0xffffff, v15
    s_mov_b64 exec, vcc
    buffer_load_dword v245, v15, s[16:19], 0 offen
    s_mov_b64 exec, s[48:49]
    s_cbranch_execz K2_TP
    v_cmp_gt_u32 vcc, s62, v54
    v_and_b32 v19, 0xffffff, v19
    s_mov_b64 exec, vcc
    buffer_load_dword v245, v19, s[16:19], 0 offen
    s_mov_b64 exec, s[50:51]
    s_cbranch_execz K2_TP
    v_cmp_gt_u32 vcc, s62, v55
    v_and_b32 v23, 0xffffff, v23
    s_mov_b64 exec, vcc
    buffer_load_dword v245, v23, s[16:19], 0 offen
    s_mov_b64 exec, s[90:91]
    s_cbranch_execz K2_TP
    v_cmp_gt_u32 vcc, s62, v56
    v_and_b32 v27, 0xffffff, v27
    s_mov_b64 exec, vcc
    buffer_load_dword v245, v27, s[16:19], 0 offen
    s_mov_b64 exec, s[92:93]
    s_cbranch_execz K2_TP
    v_cmp_gt_u32 vcc, s62, v57
    v_and_b32 v31, 0xffffff, v31
    s_mov_b64 exec, vcc
    buffer_load_dword v245, v31, s[16:19], 0 offen
    s_mov_b64 exec, s[94:95]
    s_cbranch_execz K2_TP
    v_cmp_gt_u32 vcc, s62, v58
    v_and_b32 v35, 0xffffff, v35
    s_mov_b64 exec, vcc
    buffer_load_dword v245, v35, s[16:19], 0 offen
    s_mov_b64 exec, s[96:97]
    s_cbranch_execz K2_TP
    v_cmp_gt_u32 vcc, s62, v59
    v_and_b32 v39, 0xffffff, v39
    s_mov_b64 exec, vcc
    buffer_load_dword v245, v39, s[16:19], 0 offen
K2_TP:
    s_mov_b64 exec, -1
K2_RK_DONE:
K2_PAD_SC:
    s_cbranch_execz KS_HOP
    s_mul_i32 s67, s24, 48
    s_movk_i32 s58, -1532
    s_waitcnt lgkmcnt(0)
    s_mov_b64 exec, s[40:41]
    s_cbranch_execz K2_SC_DONE
    v_cmpx_gt_u32 vcc, 64, v40
    v_add_u32 v193, 16, v40
    v_lshl_add_u32 v195, v40, 1, v50
    v_lshrrev_b32 v193, 6, v193
    v_lshl_add_u32 v194, v40, 5, v50
    ds_write_b16 v195, v0
    v_mad_i32_i24 v194, v193, s58, v194
    ds_write_b16_d16_hi v195, v0 offset:128
    ds_write_b16_d16_hi v195, v1 offset:256
    ds_write_b16 v195, v2 offset:384
    ds_write_b32 v194, v3 offset:512
    s_mov_b64 exec, s[42:43]
    s_cbranch_execz K2_SC_DONE
    v_cmpx_gt_u32 vcc, 64, v41
    v_add_u32 v193, 16, v41
    v_lshl_add_u32 v195, v41, 1, v51
    v_lshrrev_b32 v193, 6, v193
    v_lshl_add_u32 v194, v41, 5, v51
    ds_write_b16 v195, v4
    v_mad_i32_i24 v194, v193, s58, v194
    ds_write_b16_d16_hi v195, v4 offset:128
    ds_write_b16_d16_hi v195, v5 offset:256
    ds_write_b16 v195, v6 offset:384
    ds_write_b32 v194, v7 offset:512
    s_mov_b64 exec, s[44:45]
    s_cbranch_execz K2_SC_DONE
    v_cmpx_gt_u32 vcc, 64, v42
    v_add_u32 v193, 16, v42
    v_lshl_add_u32 v195, v42, 1, v52
    v_lshrrev_b32 v193, 6, v193
    v_lshl_add_u32 v194, v42, 5, v52
    ds_write_b16 v195, v8
    v_mad_i32_i24 v194, v193, s58, v194
    ds_write_b16_d16_hi v195, v8 offset:128
    ds_write_b16_d16_hi v195, v9 offset:256
    ds_write_b16 v195, v10 offset:384
    ds_write_b32 v194, v11 offset:512
    s_mov_b64 exec, s[46:47]
    s_cbranch_execz K2_SC_DONE
    v_cmpx_gt_u32 vcc, 64, v43
    v_add_u32 v193, 16, v43
    v_lshl_add_u32 v195, v43, 1, v53
    v_lshrrev_b32 v193, 6, v193
    v_lshl_add_u32 v194, v43, 5, v53
    ds_write_b16 v195, v12
    v_mad_i32_i24 v194, v193, s58, v194
    ds_write_b16_d16_hi v195, v12 offset:128
    ds_write_b16_d16_hi v195, v13 offset:256
    ds_write_b16 v195, v14 offset:384
    ds_write_b32 v194, v15 offset:512
    s_mov_b64 exec, s[48:49]
    s_cbranch_execz K2_SC_DONE
    v_cmpx_gt_u32 vcc, 64, v44
    v_add_u32 v193, 16, v44
    v_lshl_add_u32 v195, v44, 1, v54
    v_lshrrev_b32 v193, 6, v193
    v_lshl_add_u32 v194, v44, 5, v54
    ds_write_b16 v195, v16
    v_mad_i32_i24 v194, v193, s58, v194
    ds_write_b16_d16_hi v195, v16 offset:128
    ds_write_b16_d16_hi v195, v17 offset:256
    ds_write_b16 v195, v18 offset:384
    ds_write_b32 v194, v19 offset:512
    s_mov_b64 exec, s[50:51]
    s_cbranch_execz K2_SC_DONE
    v_cmpx_gt_u32 vcc, 64, v45
    v_add_u32 v193, 16, v45
    v_lshl_add_u32 v195, v45, 1, v55
    v_lshrrev_b32 v193, 6, v193
    v_lshl_add_u32 v194, v45, 5, v55
    ds_write_b16 v195, v20
    v_mad_i32_i24 v194, v193, s58, v194
    ds_write_b16_d16_hi v195, v20 offset:128
    ds_write_b16_d16_hi v195, v21 offset:256
    ds_write_b16 v195, v22 offset:384
    ds_write_b32 v194, v23 offset:512
    s_mov_b64 exec, s[90:91]
    s_cbranch_execz K2_SC_DONE
    v_cmpx_gt_u32 vcc, 64, v46
    v_add_u32 v193, 16, v46
    v_lshl_add_u32 v195, v46, 1, v56
    v_lshrrev_b32 v193, 6, v193
    v_lshl_add_u32 v194, v46, 5, v56
    ds_write_b16 v195, v24
    v_mad_i32_i24 v194, v193, s58, v194
    ds_write_b16_d16_hi v195, v24 offset:128
    ds_write_b16_d16_hi v195, v25 offset:256
    ds_write_b16 v195, v26 offset:384
    ds_write_b32 v194, v27 offset:512
    s_mov_b64 exec, s[92:93]
    s_cbranch_execz K2_SC_DONE
    v_cmpx_gt_u32 vcc, 64, v47
    v_add_u32 v193, 16, v47
    v_lshl_add_u32 v195, v47, 1, v57
    v_lshrrev_b32 v193, 6, v193
    v_lshl_add_u32 v194, v47, 5, v57
    ds_write_b16 v195, v28
    v_mad_i32_i24 v194, v193, s58, v194
    ds_write_b16_d16_hi v195, v28 offset:128
    ds_write_b16_d16_hi v195, v29 offset:256
    ds_write_b16 v195, v30 offset:384
    ds_write_b32 v194, v31 offset:512
    s_mov_b64 exec, s[94:95]
    s_cbranch_execz K2_SC_DONE
    v_cmpx_gt_u32 vcc, 64, v48
    v_add_u32 v193, 16, v48
    v_lshl_add_u32 v195, v48, 1, v58
    v_lshrrev_b32 v193, 6, v193
    v_lshl_add_u32 v194, v48, 5, v58
    ds_write_b16 v195, v32
    v_mad_i32_i24 v194, v193, s58, v194
    ds_write_b16_d16_hi v195, v32 offset:128
    ds_write_b16_d16_hi v195, v33 offset:256
    ds_write_b16 v195, v34 offset:384
    ds_write_b32 v194, v35 offset:512
    s_mov_b64 exec, s[96:97]
    s_cbranch_execz K2_SC_DONE
    v_cmpx_gt_u32 vcc, 64, v49
    v_add_u32 v193, 16, v49
    v_lshl_add_u32 v195, v49, 1, v59
    v_lshrrev_b32 v193, 6, v193
    v_lshl_add_u32 v194, v49, 5, v59
    ds_write_b16 v195, v36
    v_mad_i32_i24 v194, v193, s58, v194
    ds_write_b16_d16_hi v195, v36 offset:128
    ds_write_b16_d16_hi v195, v37 offset:256
    ds_write_b16 v195, v38 offset:384
    ds_write_b32 v194, v39 offset:512
K2_SC_DONE:
    s_mov_b64 exec, -1
K2_PAD_SD:
    s_cbranch_execz KS_HOP
    v_lshlrev_b32 v192, 2, v176
    v_add_u32 v192, 163072, v192
    v_mov_b32 v200, 163300
    s_cmp_eq_u32 s24, 0
    s_cselect_b32 s26, 64, 48
    s_cmp_eq_u32 s20, 7
    s_cbranch_scc1 K2_FLGCK
K2_FLGOK:
    s_waitcnt lgkmcnt(0)
    s_barrier
    ds_read_b32 v193, v192
    ds_read_b32 v200, v200
    v_cmp_gt_u32 s[56:57], s22, v176
    v_mad_u32_u24 v195, v176, s59, v202
    s_waitcnt lgkmcnt(0)
    v_cndmask_b32 v193, 0, v193, s[56:57]
    v_readfirstlane_b32 s27, v200
    v_cmp_lt_u32 s[62:63], 48, v193
    v_cmp_lt_u32 vcc, 64, v193
    s_bcnt1_i32_b64 s60, s[62:63]
    v_mbcnt_lo_u32_b32 v198, s62, 0
    v_mbcnt_hi_u32_b32 v198, s63, v198
    s_cbranch_vccnz K2_BIG
    s_cmp_gt_u32 s60, 8
    s_cbranch_scc1 K2_BIG
K2_TOK:
    v_subrev_u32 v194, s67, v193
    v_max_i32 v194, 1, v194
    v_min_i32 v194, s26, v194
    v_add_u32 v194, 15, v194
    v_lshrrev_b32 v194, 4, v194
    v_lshl_or_b32 v195, v194, 18, v195
    v_lshl_or_b32 v195, v198, 27, v195
    v_mov_b32 v197, 425088
    v_cndmask_b32 v253, v197, v195, s[56:57]
    s_movk_i32 s40, 0
    s_movk_i32 s41, 256
    s_movk_i32 s42, 512
    s_movk_i32 s43, 768
    s_add_u32 s24, s24, 1
    s_cmp_ge_u32 s24, s25
    s_cselect_b32 s55, 1, 0
    s_cmp_eq_u32 s27, 0
    s_cselect_b32 s55, s55, 0
    s_mov_b32 s27, 0x400000
    s_mov_b32 s38, 0
    s_mov_b32 s34, 0
    s_mov_b32 s35, 0
    s_mov_b32 s36, 1
    s_mov_b32 s31, 0
    s_mov_b32 s58, s20
    v_readlane_b32 s3, v253, s58
    s_lshl_b32 s44, s34, 7
    s_and_b32 s48, s3, 0x3ffff
    s_bfe_u32 s33, s3, 0x30012
    s_mul_i32 s35, s38, 6
    s_cmp_eq_u32 s34, 0
    s_cselect_b32 s35, s35, s48
    s_mov_b32 s45, s44
    s_add_u32 s47, s44, 256
    s_add_u32 s49, s48, 32
    s_add_u32 s60, s48, 64
    s_cmp_eq_u32 s33, 3
    s_cselect_b32 s46, s44, s47
    s_cselect_b32 s50, s60, s48
    s_cselect_b32 s51, s48, s49
    s_sub_u32 s60, s33, 2
    s_cmp_lt_u32 s60, 2
    s_cbranch_scc0 K2_rare_1
K2_back_2:
    v_add_u32 v233, s48, v230
    ds_read_b32 v232, v233
    ds_read_b32 v233, v233 offset:1024
    v_add_u32 v222, s48, v251
    ds_read_b32 v222, v222
    v_add_u32 v224, s49, v251
    ds_read_b32 v224, v224
    v_add_u32 v226, s50, v251
    ds_read_b32 v226, v226
    v_add_u32 v228, s51, v251
    ds_read_b32 v228, v228
    s_waitcnt lgkmcnt(4)
    v_or_b32 v232, v232, v231
    v_or_b32 v233, v233, v231
    s_cmp_lg_u32 s34, 0
    s_cbranch_scc1 K2_dum_4
    s_cmp_eq_u32 s33, 4
    s_cbranch_scc1 K2_a4_5
K2_b4_7:
    s_add_u32 m0, s48, 512
    s_add_u32 s65, s48, 1536
    buffer_load_dwordx4 v232, s[16:19], 0 offen  lds
    s_mov_b32 m0, s65
    s_mov_b32 exec_hi, 0
    buffer_load_dwordx4 v233, s[16:19], 0 offen  lds
    s_mov_b32 exec_hi, -1
K2_back_6:
    s_waitcnt lgkmcnt(3)
    v_mad_u32_u16 v223, v222, s39, v248 op_sel:[1,0,0,0]
    v_mad_u32_u16 v222, v222, s39, v248
    s_waitcnt lgkmcnt(2)
    v_mad_u32_u16 v225, v224, s39, v248 op_sel:[1,0,0,0]
    v_mad_u32_u16 v224, v224, s39, v248
    s_waitcnt lgkmcnt(1)
    v_mad_u32_u16 v227, v226, s39, v248 op_sel:[1,0,0,0]
    v_mad_u32_u16 v226, v226, s39, v248
    s_waitcnt lgkmcnt(0)
    v_mad_u32_u16 v229, v228, s39, v248 op_sel:[1,0,0,0]
    v_mad_u32_u16 v228, v228, s39, v248
    s_mov_b32 m0, s68
    s_nop 0
    buffer_load_dwordx4 v222, s[4:7], s44 offen sc1 lds
    buffer_load_dwordx4 v223, s[72:75], s44 offen offset:1024 sc1 lds
    s_mov_b32 m0, s69
    s_nop 0
    buffer_load_dwordx4 v224, s[4:7], s45 offen sc1 lds
    buffer_load_dwordx4 v225, s[72:75], s45 offen offset:1024 sc1 lds
    s_mov_b32 m0, s70
    s_nop 0
    buffer_load_dwordx4 v226, s[4:7], s46 offen sc1 lds
    buffer_load_dwordx4 v227, s[72:75], s46 offen offset:1024 sc1 lds
    s_mov_b32 m0, s71
    s_nop 0
    buffer_load_dwordx4 v228, s[4:7], s47 offen sc1 lds
    buffer_load_dwordx4 v229, s[72:75], s47 offen offset:1024 sc1 lds
    v_add_u32 v249, s48, v249
    v_add_u32 v250, s48, v250
    s_waitcnt vmcnt(6)
    ds_read_b64_tr_b16 v[176:177], v246 offset:0
    ds_read_b64_tr_b16 v[178:179], v246 offset:512
    ds_read_b64_tr_b16 v[180:181], v247 offset:0
    ds_read_b64_tr_b16 v[182:183], v247 offset:512
    ds_read_b64_tr_b16 v[0:1], v249 offset:0
    ds_read_b64_tr_b16 v[2:3], v249 offset:256
    ds_read_u16_d16_hi v16, v250 offset:0
    ds_read_b64_tr_b16 v[4:5], v249 offset:512
    ds_read_b64_tr_b16 v[6:7], v249 offset:768
    ds_read_u16_d16_hi v17, v250 offset:32
    s_mov_b32 s29, s48
    s_mov_b32 s32, s31
    s_mov_b32 s30, s3
    s_mov_b32 s31, s35
    s_cmp_eq_u32 s33, 2
    s_cbranch_scc1 K2_U20
    s_cmp_eq_u32 s33, 3
    s_cbranch_scc1 K2_U30
    s_cmp_eq_u32 s33, 1
    s_cbranch_scc1 K2_U10
    s_branch K2_U40
K2_PAD_H1:
    s_branch KS_HOP0
KS_HELP:
    s_mov_b32 s30, 0
    s_cmp_eq_u32 s20, 6
    s_cbranch_scc1 KS_RAW
    s_mov_b32 s30, 2
    s_cmp_ge_u32 s2, 170
    s_cbranch_scc1 KS_NOW
    s_mov_b32 s30, 1
    v_and_b32 v1, 15, v8
    v_lshrrev_b32 v3, 4, v8
    s_cmp_ge_u32 s2, 160
    s_cbranch_scc1 K1_WT
    s_cmp_ge_u32 s2, 64
    s_cbranch_scc1 K1_S1
    s_lshr_b32 s24, s2, 3
    s_and_b32 s25, s2, 7
    s_lshr_b32 s26, s25, 2
    s_bfe_u32 s27, s25, 0x10001
    s_and_b32 s28, s25, 1
    s_mov_b32 s60, s92
    s_and_b32 s61, s93, 0xffff
    s_mov_b32 s62, 65536
    s_mov_b32 s63, 0x20000
    s_branch K1_SC
K1_S1:
    s_sub_u32 s29, s2, 64
    s_mul_i32 s24, s29, 43
    s_lshr_b32 s24, s24, 9
    s_mul_i32 s25, s24, 12
    s_sub_u32 s25, s29, s25
    s_cmp_ge_u32 s25, 6
    s_cselect_b32 s26, 1, 0
    s_mul_i32 s27, s26, 6
    s_sub_u32 s27, s25, s27
    s_lshr_b32 s27, s27, 1
    s_and_b32 s28, s25, 1
    s_add_u32 s25, s25, 8
    s_mov_b32 s60, s94
    s_and_b32 s61, s95, 0xffff
    s_mov_b32 s62, 98304
    s_mov_b32 s63, 0x20000
K1_SC:
    s_lshl_b32 s27, s27, 7
    s_lshl_b32 s26, s26, 6
    s_lshl_b32 s28, s28, 4
    s_add_u32 s27, s27, s26
    s_add_u32 s27, s27, s28
    s_lshl_b32 s27, s27, 8
    s_lshl_b32 s26, s24, 5
    s_add_u32 s27, s27, s26
    s_add_u32 s29, s27, 8192
    v_lshlrev_b32 v3, 10, v3
    v_lshl_add_u32 v3, v1, 1, v3
    buffer_load_ushort v64, v3, s[60:63], s27 offen offset:0
    buffer_load_ushort v65, v3, s[60:63], s29 offen offset:0
    buffer_load_ushort v66, v3, s[60:63], s27 offen offset:256
    buffer_load_ushort v67, v3, s[60:63], s29 offen offset:256
    buffer_load_ushort v68, v3, s[60:63], s27 offen offset:512
    buffer_load_ushort v69, v3, s[60:63], s29 offen offset:512
    buffer_load_ushort v70, v3, s[60:63], s27 offen offset:768
    buffer_load_ushort v71, v3, s[60:63], s29 offen offset:768
    s_mul_i32 s24, s24, 20
    s_add_u32 s24, s24, s25
    s_lshl_b32 s24, s24, 10
    s_add_u32 s24, s24, 6946816
    s_branch K1_GO
K1_WT:
    s_sub_u32 s24, s2, 160
    s_lshr_b32 s27, s24, 1
    s_and_b32 s28, s24, 1
    s_lshl_b32 s27, s27, 8
    s_lshl_b32 s28, s28, 6
    s_add_u32 s27, s27, s28
    s_add_u32 s29, s27, 10240
    s_mov_b32 s60, s90
    s_and_b32 s61, s91, 0xffff
    s_mov_b32 s62, 20480
    s_mov_b32 s63, 0x20000
    v_and_b32 v1, 31, v8
    v_lshrrev_b32 v3, 5, v8
    v_mul_u32_u24 v3, 5120, v3
    v_lshl_add_u32 v3, v1, 1, v3
    buffer_load_ushort v64, v3, s[60:63], s27 offen offset:0
    buffer_load_ushort v65, v3, s[60:63], s27 offen offset:1280
    buffer_load_ushort v66, v3, s[60:63], s27 offen offset:2560
    buffer_load_ushort v67, v3, s[60:63], s27 offen offset:3840
    buffer_load_ushort v68, v3, s[60:63], s29 offen offset:0
    buffer_load_ushort v69, v3, s[60:63], s29 offen offset:1280
    buffer_load_ushort v70, v3, s[60:63], s29 offen offset:2560
    buffer_load_ushort v71, v3, s[60:63], s29 offen offset:3840
    s_lshl_b32 s24, s24, 10
    s_add_u32 s24, s24, 7110656
K1_GO:
KS_NOW:
    s_barrier
K2_PAD_H2:
    s_cbranch_execz KS_HOP0
    v_and_b32 v76, 31, v8
    v_lshrrev_b32 v77, 5, v8
    v_cmp_le_u32 vcc, 24, v76
    v_mul_u32_u24 v77, 2080, v77
    v_lshl_add_u32 v78, v76, 4, v77
    v_cndmask_b32 v80, 0, -1, vcc
    v_add_u32 v78, 65536, v78
    v_mov_b32 v81, v80
    v_mov_b32 v82, v80
    v_mov_b32 v83, v80
    v_add_u32 v79, 41600, v78
    ds_write_b128 v78, v[80:83] offset:0
    ds_write_b128 v78, v[80:83] offset:4160
    ds_write_b128 v78, v[80:83] offset:8320
    ds_write_b128 v78, v[80:83] offset:12480
    ds_write_b128 v78, v[80:83] offset:16640
    ds_write_b128 v78, v[80:83] offset:20800
    ds_write_b128 v78, v[80:83] offset:24960
    ds_write_b128 v78, v[80:83] offset:29120
    ds_write_b128 v78, v[80:83] offset:33280
    ds_write_b128 v78, v[80:83] offset:37440
    ds_write_b128 v79, v[80:83] offset:0
    ds_write_b128 v79, v[80:83] offset:4160
    ds_write_b128 v79, v[80:83] offset:8320
    ds_write_b128 v79, v[80:83] offset:12480
    ds_write_b128 v79, v[80:83] offset:16640
    ds_write_b128 v79, v[80:83] offset:20800
    ds_write_b128 v79, v[80:83] offset:24960
    ds_write_b128 v79, v[80:83] offset:29120
    ds_write_b128 v79, v[80:83] offset:33280
    ds_write_b128 v79, v[80:83] offset:37440
KS_FILL:
    v_mov_b32 v59, 163376
    s_barrier
    ds_read_b32 v59, v59
    s_waitcnt vmcnt(0) lgkmcnt(0)
    s_cmp_eq_u32 s30, 0
    s_cbranch_scc1 KS_B3
    s_cmp_eq_u32 s30, 2
    s_cbranch_scc1 KS_NOST
    v_lshl_or_b32 v40, v65, 16, v64
    v_lshl_or_b32 v41, v67, 16, v66
    v_lshl_or_b32 v42, v69, 16, v68
    v_lshl_or_b32 v43, v71, 16, v70
    buffer_store_dwordx4 v[40:43], v9, s[8:11], s24 offen sc1
KS_NOST:
    s_waitcnt lgkmcnt(0)
    s_barrier
    s_lshl_b32 s24, s2, 2
    s_add_u32 s24, s24, 7176192
    s_mov_b64 exec, 1
    s_waitcnt vmcnt(0)
    buffer_store_dword v59, v6, s[8:11], s24 offen sc1
    s_mov_b64 exec, -1
    s_branch KS_JOIN
K2_PAD_H3:
    s_branch KS_HOP0
KS_RAW:
    s_barrier
    s_mov_b32 s60, s90
    s_and_b32 s61, s91, 0xffff
    s_mov_b32 s62, 20480
    s_mov_b32 s63, 0x20000
    v_lshrrev_b32 v10, 3, v8
    v_and_b32 v11, 7, v8
    v_lshlrev_b32 v10, 8, v10
    v_lshl_add_u32 v10, v11, 4, v10
    s_mov_b32 m0, 24576
    s_movk_i32 s24, 0
    buffer_load_dwordx4 v10, s[60:63], s24 offen lds
    s_mov_b32 m0, 25600
    s_movk_i32 s24, 2048
    buffer_load_dwordx4 v10, s[60:63], s24 offen lds
    s_mov_b32 m0, 26624
    s_movk_i32 s24, 4096
    buffer_load_dwordx4 v10, s[60:63], s24 offen lds
    s_mov_b32 m0, 27648
    s_movk_i32 s24, 6144
    buffer_load_dwordx4 v10, s[60:63], s24 offen lds
    s_mov_b32 m0, 28672
    s_movk_i32 s24, 8192
    buffer_load_dwordx4 v10, s[60:63], s24 offen lds
    s_mov_b32 m0, 29696
    s_movk_i32 s24, 10240
    buffer_load_dwordx4 v10, s[60:63], s24 offen lds
    s_mov_b32 m0, 30720
    s_movk_i32 s24, 12288
    buffer_load_dwordx4 v10, s[60:63], s24 offen lds
    s_mov_b32 m0, 31744
    s_movk_i32 s24, 14336
    buffer_load_dwordx4 v10, s[60:63], s24 offen lds
    s_mov_b32 m0, 32768
    s_movk_i32 s24, 16384
    buffer_load_dwordx4 v10, s[60:63], s24 offen lds
    s_mov_b32 m0, 33792
    s_movk_i32 s24, 18432
    buffer_load_dwordx4 v10, s[60:63], s24 offen lds
    s_mov_b32 m0, 152832
    s_movk_i32 s24, 128
    buffer_load_dwordx4 v10, s[60:63], s24 offen lds
    s_mov_b32 m0, 153856
    s_movk_i32 s24, 2176
    buffer_load_dwordx4 v10, s[60:63], s24 offen lds
    s_mov_b32 m0, 154880
    s_movk_i32 s24, 4224
    buffer_load_dwordx4 v10, s[60:63], s24 offen lds
    s_mov_b32 m0, 155904
    s_movk_i32 s24, 6272
    buffer_load_dwordx4 v10, s[60:63], s24 offen lds
    s_mov_b32 m0, 156928
    s_movk_i32 s24, 8320
    buffer_load_dwordx4 v10, s[60:63], s24 offen lds
    s_mov_b32 m0, 157952
    s_movk_i32 s24, 10368
    buffer_load_dwordx4 v10, s[60:63], s24 offen lds
    s_mov_b32 m0, 158976
    s_movk_i32 s24, 12416
    buffer_load_dwordx4 v10, s[60:63], s24 offen lds
    s_mov_b32 m0, 160000
    s_movk_i32 s24, 14464
    buffer_load_dwordx4 v10, s[60:63], s24 offen lds
    s_mov_b32 m0, 161024
    s_movk_i32 s24, 16512
    buffer_load_dwordx4 v10, s[60:63], s24 offen lds
    s_mov_b32 m0, 162048
    s_movk_i32 s24, 18560
    buffer_load_dwordx4 v10, s[60:63], s24 offen lds
    v_add_u32 v85, 16, v8
    v_lshlrev_b32 v84, 5, v8
    v_lshrrev_b32 v85, 6, v85
    v_mul_u32_u24 v85, 1532, v85
    v_sub_u32 v84, v84, v85
    v_mov_b32 v85, -1
    v_add_u32 v84, 66048, v84
    v_add_u32 v86, 41600, v84
    ds_write_b32 v84, v85 offset:0
    ds_write_b32 v84, v85 offset:2080
    ds_write_b32 v84, v85 offset:4160
    ds_write_b32 v84, v85 offset:6240
    ds_write_b32 v84, v85 offset:8320
    ds_write_b32 v84, v85 offset:10400
    ds_write_b32 v84, v85 offset:12480
    ds_write_b32 v84, v85 offset:14560
    ds_write_b32 v84, v85 offset:16640
    ds_write_b32 v84, v85 offset:18720
    ds_write_b32 v84, v85 offset:20800
    ds_write_b32 v84, v85 offset:22880
    ds_write_b32 v84, v85 offset:24960
    ds_write_b32 v84, v85 offset:27040
    ds_write_b32 v84, v85 offset:29120
    ds_write_b32 v84, v85 offset:31200
    ds_write_b32 v84, v85 offset:33280
    ds_write_b32 v84, v85 offset:35360
    ds_write_b32 v84, v85 offset:37440
    ds_write_b32 v84, v85 offset:39520
    s_branch KS_FILL
KS_IDLE:
    s_barrier
    s_barrier
    s_branch KS_B3
K2_PAD_U20:
    s_branch K2_HOP
K2_U20:
    s_setprio 1
    s_waitcnt lgkmcnt(0)
    v_lshlrev_b32 v20, 16, v0
    v_and_b32 v21, 0xffff0000, v0
    v_lshlrev_b32 v22, 16, v1
    v_and_b32 v23, 0xffff0000, v1
    v_lshlrev_b32 v24, 16, v2
    v_and_b32 v25, 0xffff0000, v2
    v_lshlrev_b32 v26, 16, v3
    v_and_b32 v27, 0xffff0000, v3
    v_mul_f32_dpp v36, v16, v20 row_newbcast:8 row_mask:0xf bank_mask:0xf
    v_mul_f32_dpp v37, v16, v21 row_newbcast:9 row_mask:0xf bank_mask:0xf
    v_mul_f32_dpp v38, v16, v22 row_newbcast:10 row_mask:0xf bank_mask:0xf
    v_mul_f32_dpp v39, v16, v23 row_newbcast:11 row_mask:0xf bank_mask:0xf
    v_mul_f32_dpp v40, v16, v24 row_newbcast:12 row_mask:0xf bank_mask:0xf
    v_mul_f32_dpp v41, v16, v25 row_newbcast:13 row_mask:0xf bank_mask:0xf
    v_mul_f32_dpp v42, v16, v26 row_newbcast:14 row_mask:0xf bank_mask:0xf
    v_mul_f32_dpp v43, v16, v27 row_newbcast:15 row_mask:0xf bank_mask:0xf
    v_cvt_pk_bf16_f32 v68, v36, v37
    v_cvt_pk_bf16_f32 v69, v38, v39
    v_cvt_pk_bf16_f32 v70, v40, v41
    v_cvt_pk_bf16_f32 v71, v42, v43
    v_mul_f32_dpp v20, v16, v20 row_newbcast:0 row_mask:0xa bank_mask:0xf
    v_mul_f32_dpp v21, v16, v21 row_newbcast:1 row_mask:0xa bank_mask:0xf
    v_mul_f32_dpp v22, v16, v22 row_newbcast:2 row_mask:0xa bank_mask:0xf
    v_mul_f32_dpp v23, v16, v23 row_newbcast:3 row_mask:0xa bank_mask:0xf
    v_mul_f32_dpp v24, v16, v24 row_newbcast:4 row_mask:0xa bank_mask:0xf
    v_mul_f32_dpp v25, v16, v25 row_newbcast:5 row_mask:0xa bank_mask:0xf
    v_mul_f32_dpp v26, v16, v26 row_newbcast:6 row_mask:0xa bank_mask:0xf
    v_mul_f32_dpp v27, v16, v27 row_newbcast:7 row_mask:0xa bank_mask:0xf
    v_cvt_pk_bf16_f32 v64, v20, v21
    v_cvt_pk_bf16_f32 v65, v22, v23
    v_cvt_pk_bf16_f32 v66, v24, v25
    v_cvt_pk_bf16_f32 v67, v26, v27
    v_lshlrev_b32 v28, 16, v4
    v_and_b32 v29, 0xffff0000, v4
    v_lshlrev_b32 v30, 16, v5
    v_and_b32 v31, 0xffff0000, v5
    v_lshlrev_b32 v32, 16, v6
    v_and_b32 v33, 0xffff0000, v6
    v_lshlrev_b32 v34, 16, v7
    v_and_b32 v35, 0xffff0000, v7
    v_mul_f32_dpp v36, v17, v28 row_newbcast:8 row_mask:0xf bank_mask:0xf
    v_mul_f32_dpp v37, v17, v29 row_newbcast:9 row_mask:0xf bank_mask:0xf
    v_mul_f32_dpp v38, v17, v30 row_newbcast:10 row_mask:0xf bank_mask:0xf
    v_mul_f32_dpp v39, v17, v31 row_newbcast:11 row_mask:0xf bank_mask:0xf
    v_mul_f32_dpp v40, v17, v32 row_newbcast:12 row_mask:0xf bank_mask:0xf
    v_mul_f32_dpp v41, v17, v33 row_newbcast:13 row_mask:0xf bank_mask:0xf
    v_mul_f32_dpp v42, v17, v34 row_newbcast:14 row_mask:0xf bank_mask:0xf
    v_mul_f32_dpp v43, v17, v35 row_newbcast:15 row_mask:0xf bank_mask:0xf
    v_cvt_pk_bf16_f32 v76, v36, v37
    v_cvt_pk_bf16_f32 v77, v38, v39
    v_cvt_pk_bf16_f32 v78, v40, v41
    v_cvt_pk_bf16_f32 v79, v42, v43
    v_mul_f32_dpp v28, v17, v28 row_newbcast:0 row_mask:0xa bank_mask:0xf
    v_mul_f32_dpp v29, v17, v29 row_newbcast:1 row_mask:0xa bank_mask:0xf
    v_mul_f32_dpp v30, v17, v30 row_newbcast:2 row_mask:0xa bank_mask:0xf
    v_mul_f32_dpp v31, v17, v31 row_newbcast:3 row_mask:0xa bank_mask:0xf
    v_mul_f32_dpp v32, v17, v32 row_newbcast:4 row_mask:0xa bank_mask:0xf
    v_mul_f32_dpp v33, v17, v33 row_newbcast:5 row_mask:0xa bank_mask:0xf
    v_mul_f32_dpp v34, v17, v34 row_newbcast:6 row_mask:0xa bank_mask:0xf
    v_mul_f32_dpp v35, v17, v35 row_newbcast:7 row_mask:0xa bank_mask:0xf
    v_cvt_pk_bf16_f32 v72, v28, v29
    v_cvt_pk_bf16_f32 v73, v30, v31
    v_cvt_pk_bf16_f32 v74, v32, v33
    v_cvt_pk_bf16_f32 v75, v34, v35
    s_waitcnt vmcnt(4)
    v_mfma_f32_32x32x16_bf16 v[0:15], v[64:67], v[176:179], 0
    ds_read_b64_tr_b16 v[184:185], v246 offset:2048
    ds_read_b64_tr_b16 v[186:187], v246 offset:2560
    ds_read_b64_tr_b16 v[188:189], v247 offset:2048
    ds_read_b64_tr_b16 v[190:191], v247 offset:2560
    s_mov_b32 m0, s68
    v_mfma_f32_32x32x16_bf16 v[16:31], v[68:71], v[176:179], 0
    buffer_load_dwordx4 v222, s[4:7], s42 offen sc1 lds
    buffer_load_dwordx4 v223, s[72:75], s42 offen offset:1024 sc1 lds
    v_permlane32_swap_b32 v242, v236
    v_permlane32_swap_b32 v243, v237
    s_add_u32 s38, s38, 1
    v_mfma_f32_32x32x16_bf16 v[32:47], v[64:67], v[180:183], 0
    v_permlane32_swap_b32 v244, v238
    v_permlane32_swap_b32 v245, v239
    v_permlane32_swap_b32 v240, v241
    v_add_f32 v242, v242, v236
    v_mfma_f32_32x32x16_bf16 v[48:63], v[68:71], v[180:183], 0
    v_add_f32 v243, v243, v237
    v_add_f32 v244, v244, v238
    v_add_f32 v245, v245, v239
    v_add_f32 v240, -v240, -v241
    v_mov_b32 v254, s52
    v_mov_b32 v255, s38
    s_waitcnt vmcnt(4) lgkmcnt(0)
    v_mfma_f32_32x32x16_bf16 v[0:15], v[72:75], v[184:187], v[0:15]
    ds_read_b64_tr_b16 v[176:177], v246 offset:4096
    ds_read_b64_tr_b16 v[178:179], v246 offset:4608
    ds_read_b64_tr_b16 v[180:181], v247 offset:4096
    ds_read_b64_tr_b16 v[182:183], v247 offset:4608
    s_lshl_b32 s58, s38, 3
    s_add_u32 s58, s58, s20
    s_mov_b32 m0, s69
    v_mfma_f32_32x32x16_bf16 v[16:31], v[76:79], v[184:187], v[16:31]
    buffer_load_dwordx4 v224, s[4:7], s42 offen sc1 lds
    buffer_load_dwordx4 v225, s[72:75], s42 offen offset:1024 sc1 lds
    s_set_gpr_idx_on s32, gpr_idx(DST)
    s_nop 0
    v_cvt_pk_bf16_f32 v195, v242, v243
    v_cvt_pk_bf16_f32 v196, v244, v245
    v_cvt_pk_bf16_f32 v197, v240, v240
    s_set_gpr_idx_off
    s_mov_b64 exec, 1
    ds_write_b32 v254, v255
    s_mov_b64 exec, -1
    s_cmp_lt_u32 s58, s22
    s_cbranch_scc0 K2_dyn_8
K2_back_9:
    v_readlane_b32 s3, v253, s58
    s_lshl_b32 s44, s34, 7
    s_and_b32 s48, s3, 0x3ffff
    s_bfe_u32 s33, s3, 0x30012
    s_mul_i32 s35, s38, 6
    s_cmp_eq_u32 s34, 0
    s_cselect_b32 s35, s35, s48
    s_mov_b32 s45, s44
    s_add_u32 s47, s44, 256
    s_add_u32 s49, s48, 32
    s_add_u32 s60, s48, 64
    s_cmp_eq_u32 s33, 3
    s_cselect_b32 s46, s44, s47
    s_cselect_b32 s50, s60, s48
    s_cselect_b32 s51, s48, s49
    s_sub_u32 s60, s33, 2
    s_cmp_lt_u32 s60, 2
    s_cbranch_scc0 K2_rare_14
K2_back_15:
    v_mfma_f32_32x32x16_bf16 v[32:47], v[72:75], v[188:191], v[32:47]
    v_add_u32 v233, s48, v230
    ds_read_b32 v232, v233
    ds_read_b32 v233, v233 offset:1024
    v_mul_f32 v234, v0, v96
    v_mul_f32 v236, v8, v128
    v_fmac_f32 v234, v1, v97
    v_fmac_f32 v236, v9, v129
    v_mfma_f32_32x32x16_bf16 v[48:63], v[76:79], v[188:191], v[48:63]
    s_setprio 0
    v_fmac_f32 v234, v2, v98
    v_fmac_f32 v236, v10, v130
    v_fmac_f32 v234, v3, v99
    v_fmac_f32 v236, v11, v131
    v_fmac_f32 v234, v4, v100
    v_fmac_f32 v236, v12, v132
    v_fmac_f32 v234, v5, v101
    v_fmac_f32 v236, v13, v133
    v_fmac_f32 v234, v6, v102
    v_fmac_f32 v236, v14, v134
    v_fmac_f32 v234, v7, v103
    v_fmac_f32 v236, v15, v135
    v_mul_f32 v238, v16, v128
    v_mul_f32 v240, v24, v128
    v_fmac_f32 v238, v17, v129
    v_fmac_f32 v240, v25, v129
    v_fmac_f32 v238, v18, v130
    v_fmac_f32 v240, v26, v130
    v_fmac_f32 v238, v19, v131
    v_fmac_f32 v240, v27, v131
    v_fmac_f32 v238, v20, v132
    v_fmac_f32 v240, v28, v132
    v_fmac_f32 v238, v21, v133
    v_fmac_f32 v240, v29, v133
    v_fmac_f32 v238, v22, v134
    v_fmac_f32 v240, v30, v134
    v_fmac_f32 v238, v23, v135
    v_fmac_f32 v240, v31, v135
    v_mul_f32 v235, v32, v104
    v_mul_f32 v237, v40, v136
    v_fmac_f32 v235, v33, v105
    v_fmac_f32 v237, v41, v137
    v_fmac_f32 v235, v34, v106
    v_fmac_f32 v237, v42, v138
    v_fmac_f32 v235, v35, v107
    v_fmac_f32 v237, v43, v139
    v_fmac_f32 v235, v36, v108
    v_fmac_f32 v237, v44, v140
    v_fmac_f32 v235, v37, v109
    v_fmac_f32 v237, v45, v141
    v_fmac_f32 v235, v38, v110
    v_fmac_f32 v237, v46, v142
    v_fmac_f32 v235, v39, v111
    v_fmac_f32 v237, v47, v143
    v_mul_f32 v239, v48, v136
    v_mul_f32 v241, v56, v136
    v_fmac_f32 v239, v49, v137
    v_fmac_f32 v241, v57, v137
    s_setprio 1
    s_waitcnt vmcnt(4) lgkmcnt(3)
    v_mfma_f32_32x32x16_bf16 v[0:15], v[64:67], v[176:179], 0
    ds_read_b64_tr_b16 v[184:185], v246 offset:6144
    ds_read_b64_tr_b16 v[186:187], v246 offset:6656
    ds_read_b64_tr_b16 v[188:189], v247 offset:6144
    ds_read_b64_tr_b16 v[190:191], v247 offset:6656
    v_fmac_f32 v239, v50, v138
    v_fmac_f32 v241, v58, v138
    s_mov_b32 m0, s70
    v_mfma_f32_32x32x16_bf16 v[16:31], v[68:71], v[176:179], 0
    buffer_load_dwordx4 v222, s[4:7], s43 offen sc1 lds
    buffer_load_dwordx4 v223, s[72:75], s43 offen offset:1024 sc1 lds
    v_fmac_f32 v239, v51, v139
    v_fmac_f32 v241, v59, v139
    v_fmac_f32 v239, v52, v140
    v_fmac_f32 v241, v60, v140
    v_fmac_f32 v239, v53, v141
    v_mfma_f32_32x32x16_bf16 v[32:47], v[64:67], v[180:183], 0
    v_add_u32 v222, s48, v251
    ds_read_b32 v222, v222
    v_fmac_f32 v241, v61, v141
    v_fmac_f32 v239, v54, v142
    v_fmac_f32 v241, v62, v142
    v_fmac_f32 v239, v55, v143
    v_fmac_f32 v241, v63, v143
    v_mfma_f32_32x32x16_bf16 v[48:63], v[68:71], v[180:183], 0
    v_permlane32_swap_b32 v234, v236
    v_permlane32_swap_b32 v235, v237
    v_permlane32_swap_b32 v240, v238
    s_waitcnt lgkmcnt(5)
    v_or_b32 v232, v232, v231
    v_or_b32 v233, v233, v231
    s_cmp_lg_u32 s34, 0
    s_cbranch_scc1 K2_dum_17
    s_cmp_eq_u32 s33, 4
    s_cbranch_scc1 K2_a4_18
K2_b4_20:
    s_add_u32 m0, s48, 512
    s_add_u32 s65, s48, 1536
    buffer_load_dwordx4 v232, s[16:19], 0 offen  lds
    s_mov_b32 m0, s65
    s_mov_b32 exec_hi, 0
    buffer_load_dwordx4 v233, s[16:19], 0 offen  lds
    s_mov_b32 exec_hi, -1
K2_back_19:
    s_waitcnt vmcnt(6) lgkmcnt(1)
    v_mfma_f32_32x32x16_bf16 v[0:15], v[72:75], v[184:187], v[0:15]
    ds_read_b64_tr_b16 v[176:177], v246 offset:0
    ds_read_b64_tr_b16 v[178:179], v246 offset:512
    ds_read_b64_tr_b16 v[180:181], v247 offset:0
    ds_read_b64_tr_b16 v[182:183], v247 offset:512
    v_permlane32_swap_b32 v241, v239
    s_mov_b32 m0, s71
    v_mfma_f32_32x32x16_bf16 v[16:31], v[76:79], v[184:187], v[16:31]
    buffer_load_dwordx4 v224, s[4:7], s43 offen sc1 lds
    buffer_load_dwordx4 v225, s[72:75], s43 offen offset:1024 sc1 lds
    s_waitcnt lgkmcnt(4)
    v_mad_u32_u16 v223, v222, s39, v248 op_sel:[1,0,0,0]
    v_mad_u32_u16 v222, v222, s39, v248
    v_add_f32 v234, v234, v236
    v_add_f32 v235, v235, v237
    v_add_f32 v240, v240, v238
    v_add_f32 v241, v241, v239
    s_set_gpr_idx_on s31, gpr_idx(DST)
    s_nop 0
    v_cvt_pk_bf16_f32 v192, v234, v235
    v_cvt_pk_bf16_f32 v193, v240, v241
    s_set_gpr_idx_off
    v_mfma_f32_32x32x16_bf16 v[32:47], v[72:75], v[188:191], v[32:47]
    v_add_u32 v224, s49, v251
    ds_read_b32 v224, v224
    v_mul_f32 v234, v0, v144
    v_mul_f32 v236, v8, v112
    v_fmac_f32 v234, v1, v145
    v_fmac_f32 v236, v9, v113
    v_fmac_f32 v234, v2, v146
    v_mfma_f32_32x32x16_bf16 v[48:63], v[76:79], v[188:191], v[48:63]
    s_setprio 0
    v_fmac_f32 v236, v10, v114
    v_fmac_f32 v234, v3, v147
    v_fmac_f32 v236, v11, v115
    v_fmac_f32 v234, v4, v148
    v_fmac_f32 v236, v12, v116
    v_fmac_f32 v234, v5, v149
    v_fmac_f32 v236, v13, v117
    v_fmac_f32 v234, v6, v150
    v_fmac_f32 v236, v14, v118
    v_fmac_f32 v234, v7, v151
    v_fmac_f32 v236, v15, v119
    v_mul_f32 v238, v16, v160
    v_mul_f32 v240, v24, v160
    v_fmac_f32 v238, v17, v161
    v_fmac_f32 v240, v25, v161
    v_fmac_f32 v238, v18, v162
    v_fmac_f32 v240, v26, v162
    v_fmac_f32 v238, v19, v163
    v_fmac_f32 v240, v27, v163
    v_fmac_f32 v238, v20, v164
    v_fmac_f32 v240, v28, v164
    v_fmac_f32 v238, v21, v165
    v_fmac_f32 v240, v29, v165
    v_fmac_f32 v238, v22, v166
    v_fmac_f32 v240, v30, v166
    v_fmac_f32 v238, v23, v167
    v_fmac_f32 v240, v31, v167
    v_mul_f32 v235, v32, v152
    v_mul_f32 v237, v40, v120
    v_fmac_f32 v235, v33, v153
    v_fmac_f32 v237, v41, v121
    v_fmac_f32 v235, v34, v154
    v_fmac_f32 v237, v42, v122
    v_fmac_f32 v235, v35, v155
    v_fmac_f32 v237, v43, v123
    v_fmac_f32 v235, v36, v156
    v_fmac_f32 v237, v44, v124
    v_fmac_f32 v235, v37, v157
    v_fmac_f32 v237, v45, v125
    v_fmac_f32 v235, v38, v158
    v_fmac_f32 v237, v46, v126
    v_fmac_f32 v235, v39, v159
    v_fmac_f32 v237, v47, v127
    v_mul_f32 v239, v48, v168
    v_mul_f32 v241, v56, v168
    v_fmac_f32 v239, v49, v169
    v_fmac_f32 v241, v57, v169
    v_fmac_f32 v239, v50, v170
    v_fmac_f32 v241, v58, v170
    v_fmac_f32 v239, v51, v171
    s_setprio 1
    s_waitcnt vmcnt(6) lgkmcnt(1)
    v_mfma_f32_32x32x16_bf16 v[0:15], v[64:67], v[176:179], 0
    ds_read_b64_tr_b16 v[184:185], v246 offset:2048
    ds_read_b64_tr_b16 v[186:187], v246 offset:2560
    ds_read_b64_tr_b16 v[188:189], v247 offset:2048
    ds_read_b64_tr_b16 v[190:191], v247 offset:2560
    v_fmac_f32 v241, v59, v171
    v_fmac_f32 v239, v52, v172
    s_mov_b32 m0, s68
    v_mfma_f32_32x32x16_bf16 v[16:31], v[68:71], v[176:179], 0
    buffer_load_dwordx4 v222, s[4:7], s44 offen sc1 lds
    buffer_load_dwordx4 v223, s[72:75], s44 offen offset:1024 sc1 lds
    s_waitcnt lgkmcnt(4)
    v_mad_u32_u16 v225, v224, s39, v248 op_sel:[1,0,0,0]
    v_mad_u32_u16 v224, v224, s39, v248
    v_fmac_f32 v241, v60, v172
    v_fmac_f32 v239, v53, v173
    v_mfma_f32_32x32x16_bf16 v[32:47], v[64:67], v[180:183], 0
    v_add_u32 v226, s50, v251
    ds_read_b32 v226, v226
    v_fmac_f32 v241, v61, v173
    v_fmac_f32 v239, v54, v174
    v_fmac_f32 v241, v62, v174
    v_fmac_f32 v239, v55, v175
    v_fmac_f32 v241, v63, v175
    v_mfma_f32_32x32x16_bf16 v[48:63], v[68:71], v[180:183], 0
    s_waitcnt vmcnt(6) lgkmcnt(1)
    v_mfma_f32_32x32x16_bf16 v[0:15], v[72:75], v[184:187], v[0:15]
    ds_read_b64_tr_b16 v[176:177], v246 offset:4096
    ds_read_b64_tr_b16 v[178:179], v246 offset:4608
    ds_read_b64_tr_b16 v[180:181], v247 offset:4096
    ds_read_b64_tr_b16 v[182:183], v247 offset:4608
    s_mov_b32 m0, s69
    v_mfma_f32_32x32x16_bf16 v[16:31], v[76:79], v[184:187], v[16:31]
    buffer_load_dwordx4 v224, s[4:7], s45 offen sc1 lds
    buffer_load_dwordx4 v225, s[72:75], s45 offen offset:1024 sc1 lds
    s_waitcnt lgkmcnt(4)
    v_mad_u32_u16 v227, v226, s39, v248 op_sel:[1,0,0,0]
    v_mad_u32_u16 v226, v226, s39, v248
    v_mfma_f32_32x32x16_bf16 v[32:47], v[72:75], v[188:191], v[32:47]
    v_add_u32 v228, s51, v251
    ds_read_b32 v228, v228
    v_mul_f32 v242, v0, v144
    v_fma_f32 v238, v8, v160, -v238
    v_fmac_f32 v242, v1, v145
    v_fmac_f32 v238, v9, v161
    v_fmac_f32 v242, v2, v146
    v_mfma_f32_32x32x16_bf16 v[48:63], v[76:79], v[188:191], v[48:63]
    s_setprio 0
    v_fmac_f32 v238, v10, v162
    v_fmac_f32 v242, v3, v147
    v_fmac_f32 v238, v11, v163
    v_fmac_f32 v242, v4, v148
    v_fmac_f32 v238, v12, v164
    v_fmac_f32 v242, v5, v149
    v_fmac_f32 v238, v13, v165
    v_fmac_f32 v242, v6, v150
    v_fmac_f32 v238, v14, v166
    v_fmac_f32 v242, v7, v151
    v_fmac_f32 v238, v15, v167
    v_fmac_f32 v236, v16, v112
    v_mul_f32 v244, v24, v160
    v_fmac_f32 v236, v17, v113
    v_fmac_f32 v244, v25, v161
    v_fmac_f32 v236, v18, v114
    v_fmac_f32 v244, v26, v162
    v_fmac_f32 v236, v19, v115
    v_fmac_f32 v244, v27, v163
    v_fmac_f32 v236, v20, v116
    v_fmac_f32 v244, v28, v164
    v_fmac_f32 v236, v21, v117
    v_fmac_f32 v244, v29, v165
    v_fmac_f32 v236, v22, v118
    v_fmac_f32 v244, v30, v166
    v_fmac_f32 v236, v23, v119
    v_fmac_f32 v244, v31, v167
    v_mul_f32 v243, v32, v152
    v_fma_f32 v239, v40, v168, -v239
    v_fmac_f32 v243, v33, v153
    v_fmac_f32 v239, v41, v169
    v_fmac_f32 v243, v34, v154
    v_fmac_f32 v239, v42, v170
    v_fmac_f32 v243, v35, v155
    v_fmac_f32 v239, v43, v171
    v_fmac_f32 v243, v36, v156
    v_fmac_f32 v239, v44, v172
    v_fmac_f32 v243, v37, v157
    v_fmac_f32 v239, v45, v173
    v_fmac_f32 v243, v38, v158
    v_fmac_f32 v239, v46, v174
    v_fmac_f32 v243, v39, v159
    v_fmac_f32 v239, v47, v175
    v_fmac_f32 v237, v48, v120
    v_mul_f32 v245, v56, v168
    v_fmac_f32 v237, v49, v121
    v_fmac_f32 v245, v57, v169
    v_fmac_f32 v237, v50, v122
    s_setprio 1
    s_waitcnt vmcnt(4) lgkmcnt(1)
    v_mfma_f32_32x32x16_bf16 v[0:15], v[64:67], v[176:179], 0
    ds_read_b64_tr_b16 v[184:185], v246 offset:6144
    ds_read_b64_tr_b16 v[186:187], v246 offset:6656
    ds_read_b64_tr_b16 v[188:189], v247 offset:6144
    ds_read_b64_tr_b16 v[190:191], v247 offset:6656
    v_fmac_f32 v245, v58, v170
    v_fmac_f32 v237, v51, v123
    s_mov_b32 m0, s70
    v_mfma_f32_32x32x16_bf16 v[16:31], v[68:71], v[176:179], 0
    buffer_load_dwordx4 v226, s[4:7], s46 offen sc1 lds
    buffer_load_dwordx4 v227, s[72:75], s46 offen offset:1024 sc1 lds
    s_waitcnt lgkmcnt(4)
    v_mad_u32_u16 v229, v228, s39, v248 op_sel:[1,0,0,0]
    v_mad_u32_u16 v228, v228, s39, v248
    v_fmac_f32 v245, v59, v171
    v_fmac_f32 v237, v52, v124
    v_mfma_f32_32x32x16_bf16 v[32:47], v[64:67], v[180:183], 0
    v_fmac_f32 v245, v60, v172
    v_fmac_f32 v237, v53, v125
    v_fmac_f32 v245, v61, v173
    v_fmac_f32 v237, v54, v126
    v_fmac_f32 v245, v62, v174
    v_fmac_f32 v237, v55, v127
    v_fmac_f32 v245, v63, v175
    v_mfma_f32_32x32x16_bf16 v[48:63], v[68:71], v[180:183], 0
    v_permlane32_swap_b32 v242, v234
    v_permlane32_swap_b32 v243, v235
    v_add_f32 v242, v242, v234
    v_add_f32 v243, v243, v235
    s_waitcnt vmcnt(4) lgkmcnt(0)
    v_mfma_f32_32x32x16_bf16 v[0:15], v[72:75], v[184:187], v[0:15]
    ds_read_b64_tr_b16 v[176:177], v246 offset:0
    ds_read_b64_tr_b16 v[178:179], v246 offset:512
    ds_read_b64_tr_b16 v[180:181], v247 offset:0
    ds_read_b64_tr_b16 v[182:183], v247 offset:512
    s_sub_u32 s26, s48, s29
    s_mov_b32 s29, s48
    s_mov_b32 m0, s71
    v_mfma_f32_32x32x16_bf16 v[16:31], v[76:79], v[184:187], v[16:31]
    buffer_load_dwordx4 v228, s[4:7], s47 offen sc1 lds
    buffer_load_dwordx4 v229, s[72:75], s47 offen offset:1024 sc1 lds
    s_set_gpr_idx_on s31, gpr_idx(DST)
    s_nop 0
    v_cvt_pk_bf16_f32 v194, v242, v243
    s_set_gpr_idx_off
    s_mov_b32 s30, s3
    s_cmp_eq_u32 s34, 0
    s_cselect_b32 s56, s33, 0
    v_mfma_f32_32x32x16_bf16 v[32:47], v[72:75], v[188:191], v[32:47]
    s_mov_b32 s32, s31
    s_mov_b32 s31, s35
    v_mul_f32 v242, v0, v144
    v_fma_f32 v240, v8, v160, -v240
    v_fmac_f32 v242, v1, v145
    v_fmac_f32 v240, v9, v161
    v_fmac_f32 v242, v2, v146
    v_mfma_f32_32x32x16_bf16 v[48:63], v[76:79], v[188:191], v[48:63]
    s_setprio 0
    v_fmac_f32 v240, v10, v162
    v_fmac_f32 v242, v3, v147
    v_fmac_f32 v240, v11, v163
    v_fmac_f32 v242, v4, v148
    v_fmac_f32 v240, v12, v164
    v_fmac_f32 v242, v5, v149
    v_fmac_f32 v240, v13, v165
    v_fmac_f32 v242, v6, v150
    v_fmac_f32 v240, v14, v166
    v_fmac_f32 v242, v7, v151
    v_fmac_f32 v240, v15, v167
    v_add_u32 v249, s26, v249
    v_add_u32 v250, s26, v250
    v_fma_f32 v244, v16, v160, -v244
    v_fmac_f32 v236, v24, v112
    v_fmac_f32 v244, v17, v161
    v_fmac_f32 v236, v25, v113
    v_fmac_f32 v244, v18, v162
    v_fmac_f32 v236, v26, v114
    v_fmac_f32 v244, v19, v163
    v_fmac_f32 v236, v27, v115
    v_fmac_f32 v244, v20, v164
    v_fmac_f32 v236, v28, v116
    v_fmac_f32 v244, v21, v165
    v_fmac_f32 v236, v29, v117
    v_fmac_f32 v244, v22, v166
    v_fmac_f32 v236, v30, v118
    v_fmac_f32 v244, v23, v167
    v_fmac_f32 v236, v31, v119
    ds_read_b64_tr_b16 v[0:1], v249 offset:0
    ds_read_b64_tr_b16 v[2:3], v249 offset:256
    ds_read_u16_d16_hi v16, v250 offset:0
    v_mul_f32 v243, v32, v152
    v_fma_f32 v241, v40, v168, -v241
    v_fmac_f32 v243, v33, v153
    v_fmac_f32 v241, v41, v169
    v_fmac_f32 v243, v34, v154
    v_fmac_f32 v241, v42, v170
    v_fmac_f32 v243, v35, v155
    v_fmac_f32 v241, v43, v171
    v_fmac_f32 v243, v36, v156
    v_fmac_f32 v241, v44, v172
    v_fmac_f32 v243, v37, v157
    v_fmac_f32 v241, v45, v173
    v_fmac_f32 v243, v38, v158
    v_fmac_f32 v241, v46, v174
    v_fmac_f32 v243, v39, v159
    v_fmac_f32 v241, v47, v175
    ds_read_b64_tr_b16 v[4:5], v249 offset:512
    ds_read_b64_tr_b16 v[6:7], v249 offset:768
    ds_read_u16_d16_hi v17, v250 offset:32
    v_fma_f32 v245, v48, v168, -v245
    v_fmac_f32 v237, v56, v120
    v_fmac_f32 v245, v49, v169
    v_fmac_f32 v237, v57, v121
    v_fmac_f32 v245, v50, v170
    v_fmac_f32 v237, v58, v122
    v_fmac_f32 v245, v51, v171
    v_fmac_f32 v237, v59, v123
    v_fmac_f32 v245, v52, v172
    v_fmac_f32 v237, v60, v124
    v_fmac_f32 v245, v53, v173
    v_fmac_f32 v237, v61, v125
    v_fmac_f32 v245, v54, v174
    v_fmac_f32 v237, v62, v126
    v_fmac_f32 v245, v55, v175
    v_fmac_f32 v237, v63, v127
    s_cmp_eq_u32 s56, 2
    s_cbranch_scc1 K2_U20
    s_cmp_eq_u32 s56, 3
    s_cbranch_scc1 K2_U30
    s_branch K2_DSP0
K2_PAD_U30:
    s_branch K2_HOP
K2_U30:
    s_setprio 1
    ds_read_b64_tr_b16 v[8:9], v249 offset:1024
    ds_read_b64_tr_b16 v[10:11], v249 offset:1280
    ds_read_u16_d16_hi v18, v250 offset:64
    s_waitcnt lgkmcnt(3)
    v_lshlrev_b32 v20, 16, v0
    v_and_b32 v21, 0xffff0000, v0
    v_lshlrev_b32 v22, 16, v1
    v_and_b32 v23, 0xffff0000, v1
    v_lshlrev_b32 v24, 16, v2
    v_and_b32 v25, 0xffff0000, v2
    v_lshlrev_b32 v26, 16, v3
    v_and_b32 v27, 0xffff0000, v3
    v_mul_f32_dpp v36, v16, v20 row_newbcast:8 row_mask:0xf bank_mask:0xf
    v_mul_f32_dpp v37, v16, v21 row_newbcast:9 row_mask:0xf bank_mask:0xf
    v_mul_f32_dpp v38, v16, v22 row_newbcast:10 row_mask:0xf bank_mask:0xf
    v_mul_f32_dpp v39, v16, v23 row_newbcast:11 row_mask:0xf bank_mask:0xf
    v_mul_f32_dpp v40, v16, v24 row_newbcast:12 row_mask:0xf bank_mask:0xf
    v_mul_f32_dpp v41, v16, v25 row_newbcast:13 row_mask:0xf bank_mask:0xf
    v_mul_f32_dpp v42, v16, v26 row_newbcast:14 row_mask:0xf bank_mask:0xf
    v_mul_f32_dpp v43, v16, v27 row_newbcast:15 row_mask:0xf bank_mask:0xf
    v_cvt_pk_bf16_f32 v68, v36, v37
    v_cvt_pk_bf16_f32 v69, v38, v39
    v_cvt_pk_bf16_f32 v70, v40, v41
    v_cvt_pk_bf16_f32 v71, v42, v43
    v_mul_f32_dpp v20, v16, v20 row_newbcast:0 row_mask:0xa bank_mask:0xf
    v_mul_f32_dpp v21, v16, v21 row_newbcast:1 row_mask:0xa bank_mask:0xf
    v_mul_f32_dpp v22, v16, v22 row_newbcast:2 row_mask:0xa bank_mask:0xf
    v_mul_f32_dpp v23, v16, v23 row_newbcast:3 row_mask:0xa bank_mask:0xf
    v_mul_f32_dpp v24, v16, v24 row_newbcast:4 row_mask:0xa bank_mask:0xf
    v_mul_f32_dpp v25, v16, v25 row_newbcast:5 row_mask:0xa bank_mask:0xf
    v_mul_f32_dpp v26, v16, v26 row_newbcast:6 row_mask:0xa bank_mask:0xf
    v_mul_f32_dpp v27, v16, v27 row_newbcast:7 row_mask:0xa bank_mask:0xf
    v_cvt_pk_bf16_f32 v64, v20, v21
    v_cvt_pk_bf16_f32 v65, v22, v23
    v_cvt_pk_bf16_f32 v66, v24, v25
    v_cvt_pk_bf16_f32 v67, v26, v27
    v_lshlrev_b32 v28, 16, v4
    v_and_b32 v29, 0xffff0000, v4
    v_lshlrev_b32 v30, 16, v5
    v_and_b32 v31, 0xffff0000, v5
    v_lshlrev_b32 v32, 16, v6
    v_and_b32 v33, 0xffff0000, v6
    v_lshlrev_b32 v34, 16, v7
    v_and_b32 v35, 0xffff0000, v7
    v_mul_f32_dpp v36, v17, v28 row_newbcast:8 row_mask:0xf bank_mask:0xf
    v_mul_f32_dpp v37, v17, v29 row_newbcast:9 row_mask:0xf bank_mask:0xf
    v_mul_f32_dpp v38, v17, v30 row_newbcast:10 row_mask:0xf bank_mask:0xf
    v_mul_f32_dpp v39, v17, v31 row_newbcast:11 row_mask:0xf bank_mask:0xf
    v_mul_f32_dpp v40, v17, v32 row_newbcast:12 row_mask:0xf bank_mask:0xf
    v_mul_f32_dpp v41, v17, v33 row_newbcast:13 row_mask:0xf bank_mask:0xf
    v_mul_f32_dpp v42, v17, v34 row_newbcast:14 row_mask:0xf bank_mask:0xf
    v_mul_f32_dpp v43, v17, v35 row_newbcast:15 row_mask:0xf bank_mask:0xf
    v_cvt_pk_bf16_f32 v76, v36, v37
    v_cvt_pk_bf16_f32 v77, v38, v39
    v_cvt_pk_bf16_f32 v78, v40, v41
    v_cvt_pk_bf16_f32 v79, v42, v43
    v_mul_f32_dpp v28, v17, v28 row_newbcast:0 row_mask:0xa bank_mask:0xf
    v_mul_f32_dpp v29, v17, v29 row_newbcast:1 row_mask:0xa bank_mask:0xf
    v_mul_f32_dpp v30, v17, v30 row_newbcast:2 row_mask:0xa bank_mask:0xf
    v_mul_f32_dpp v31, v17, v31 row_newbcast:3 row_mask:0xa bank_mask:0xf
    v_mul_f32_dpp v32, v17, v32 row_newbcast:4 row_mask:0xa bank_mask:0xf
    v_mul_f32_dpp v33, v17, v33 row_newbcast:5 row_mask:0xa bank_mask:0xf
    v_mul_f32_dpp v34, v17, v34 row_newbcast:6 row_mask:0xa bank_mask:0xf
    v_mul_f32_dpp v35, v17, v35 row_newbcast:7 row_mask:0xa bank_mask:0xf
    v_cvt_pk_bf16_f32 v72, v28, v29
    v_cvt_pk_bf16_f32 v73, v30, v31
    v_cvt_pk_bf16_f32 v74, v32, v33
    v_cvt_pk_bf16_f32 v75, v34, v35
    s_waitcnt lgkmcnt(0)
    v_lshlrev_b32 v20, 16, v8
    v_and_b32 v21, 0xffff0000, v8
    v_lshlrev_b32 v22, 16, v9
    v_and_b32 v23, 0xffff0000, v9
    v_lshlrev_b32 v24, 16, v10
    v_and_b32 v25, 0xffff0000, v10
    v_lshlrev_b32 v26, 16, v11
    v_and_b32 v27, 0xffff0000, v11
    v_mul_f32_dpp v36, v18, v20 row_newbcast:8 row_mask:0xf bank_mask:0xf
    v_mul_f32_dpp v37, v18, v21 row_newbcast:9 row_mask:0xf bank_mask:0xf
    v_mul_f32_dpp v38, v18, v22 row_newbcast:10 row_mask:0xf bank_mask:0xf
    v_mul_f32_dpp v39, v18, v23 row_newbcast:11 row_mask:0xf bank_mask:0xf
    v_mul_f32_dpp v40, v18, v24 row_newbcast:12 row_mask:0xf bank_mask:0xf
    v_mul_f32_dpp v41, v18, v25 row_newbcast:13 row_mask:0xf bank_mask:0xf
    v_mul_f32_dpp v42, v18, v26 row_newbcast:14 row_mask:0xf bank_mask:0xf
    v_mul_f32_dpp v43, v18, v27 row_newbcast:15 row_mask:0xf bank_mask:0xf
    v_cvt_pk_bf16_f32 v84, v36, v37
    v_cvt_pk_bf16_f32 v85, v38, v39
    v_cvt_pk_bf16_f32 v86, v40, v41
    v_cvt_pk_bf16_f32 v87, v42, v43
    v_mul_f32_dpp v20, v18, v20 row_newbcast:0 row_mask:0xa bank_mask:0xf
    v_mul_f32_dpp v21, v18, v21 row_newbcast:1 row_mask:0xa bank_mask:0xf
    v_mul_f32_dpp v22, v18, v22 row_newbcast:2 row_mask:0xa bank_mask:0xf
    v_mul_f32_dpp v23, v18, v23 row_newbcast:3 row_mask:0xa bank_mask:0xf
    v_mul_f32_dpp v24, v18, v24 row_newbcast:4 row_mask:0xa bank_mask:0xf
    v_mul_f32_dpp v25, v18, v25 row_newbcast:5 row_mask:0xa bank_mask:0xf
    v_mul_f32_dpp v26, v18, v26 row_newbcast:6 row_mask:0xa bank_mask:0xf
    v_mul_f32_dpp v27, v18, v27 row_newbcast:7 row_mask:0xa bank_mask:0xf
    v_cvt_pk_bf16_f32 v80, v20, v21
    v_cvt_pk_bf16_f32 v81, v22, v23
    v_cvt_pk_bf16_f32 v82, v24, v25
    v_cvt_pk_bf16_f32 v83, v26, v27
    s_waitcnt vmcnt(4)
    v_mfma_f32_32x32x16_bf16 v[0:15], v[64:67], v[176:179], 0
    ds_read_b64_tr_b16 v[184:185], v246 offset:2048
    ds_read_b64_tr_b16 v[186:187], v246 offset:2560
    ds_read_b64_tr_b16 v[188:189], v247 offset:2048
    ds_read_b64_tr_b16 v[190:191], v247 offset:2560
    s_mov_b32 m0, s68
    v_mfma_f32_32x32x16_bf16 v[16:31], v[68:71], v[176:179], 0
    buffer_load_dwordx4 v224, s[4:7], s41 offen sc1 lds
    buffer_load_dwordx4 v225, s[72:75], s41 offen offset:1024 sc1 lds
    v_permlane32_swap_b32 v242, v236
    v_permlane32_swap_b32 v243, v237
    s_add_u32 s38, s38, 1
    v_mfma_f32_32x32x16_bf16 v[32:47], v[64:67], v[180:183], 0
    v_permlane32_swap_b32 v244, v238
    v_permlane32_swap_b32 v245, v239
    v_permlane32_swap_b32 v240, v241
    v_add_f32 v242, v242, v236
    v_mfma_f32_32x32x16_bf16 v[48:63], v[68:71], v[180:183], 0
    v_add_f32 v243, v243, v237
    v_add_f32 v244, v244, v238
    v_add_f32 v245, v245, v239
    v_add_f32 v240, -v240, -v241
    v_mov_b32 v254, s52
    v_mov_b32 v255, s38
    s_waitcnt vmcnt(4) lgkmcnt(0)
    v_mfma_f32_32x32x16_bf16 v[0:15], v[72:75], v[184:187], v[0:15]
    ds_read_b64_tr_b16 v[176:177], v246 offset:4096
    ds_read_b64_tr_b16 v[178:179], v246 offset:4608
    ds_read_b64_tr_b16 v[180:181], v247 offset:4096
    ds_read_b64_tr_b16 v[182:183], v247 offset:4608
    s_lshl_b32 s58, s38, 3
    s_add_u32 s58, s58, s20
    s_mov_b32 m0, s69
    v_mfma_f32_32x32x16_bf16 v[16:31], v[76:79], v[184:187], v[16:31]
    buffer_load_dwordx4 v226, s[4:7], s41 offen sc1 lds
    buffer_load_dwordx4 v227, s[72:75], s41 offen offset:1024 sc1 lds
    s_set_gpr_idx_on s32, gpr_idx(DST)
    s_nop 0
    v_cvt_pk_bf16_f32 v195, v242, v243
    v_cvt_pk_bf16_f32 v196, v244, v245
    v_cvt_pk_bf16_f32 v197, v240, v240
    s_set_gpr_idx_off
    s_mov_b64 exec, 1
    ds_write_b32 v254, v255
    s_mov_b64 exec, -1
    s_cmp_lt_u32 s58, s22
    s_cbranch_scc0 K2_dyn_21
K2_back_22:
    v_readlane_b32 s3, v253, s58
    s_lshl_b32 s44, s34, 7
    s_and_b32 s48, s3, 0x3ffff
    s_bfe_u32 s33, s3, 0x30012
    s_mul_i32 s35, s38, 6
    s_cmp_eq_u32 s34, 0
    s_cselect_b32 s35, s35, s48
    s_mov_b32 s45, s44
    s_add_u32 s47, s44, 256
    s_add_u32 s49, s48, 32
    s_add_u32 s60, s48, 64
    s_cmp_eq_u32 s33, 3
    s_cselect_b32 s46, s44, s47
    s_cselect_b32 s50, s60, s48
    s_cselect_b32 s51, s48, s49
    s_sub_u32 s60, s33, 2
    s_cmp_lt_u32 s60, 2
    s_cbranch_scc0 K2_rare_27
K2_back_28:
    v_mfma_f32_32x32x16_bf16 v[32:47], v[72:75], v[188:191], v[32:47]
    v_add_u32 v233, s48, v230
    ds_read_b32 v232, v233
    ds_read_b32 v233, v233 offset:1024
    v_mfma_f32_32x32x16_bf16 v[48:63], v[76:79], v[188:191], v[48:63]
    s_waitcnt vmcnt(4) lgkmcnt(3)
    v_mfma_f32_32x32x16_bf16 v[0:15], v[80:83], v[176:179], v[0:15]
    ds_read_b64_tr_b16 v[184:185], v246 offset:6144
    ds_read_b64_tr_b16 v[186:187], v246 offset:6656
    ds_read_b64_tr_b16 v[188:189], v247 offset:6144
    ds_read_b64_tr_b16 v[190:191], v247 offset:6656
    s_mov_b32 m0, s70
    v_mfma_f32_32x32x16_bf16 v[16:31], v[84:87], v[176:179], v[16:31]
    buffer_load_dwordx4 v222, s[4:7], s42 offen sc1 lds
    buffer_load_dwordx4 v223, s[72:75], s42 offen offset:1024 sc1 lds
    v_mfma_f32_32x32x16_bf16 v[32:47], v[80:83], v[180:183], v[32:47]
    s_nop 2
    v_mul_f32 v234, v0, v96
    v_mul_f32 v236, v8, v128
    v_fmac_f32 v234, v1, v97
    v_fmac_f32 v236, v9, v129
    v_fmac_f32 v234, v2, v98
    v_fmac_f32 v236, v10, v130
    v_fmac_f32 v234, v3, v99
    v_mfma_f32_32x32x16_bf16 v[48:63], v[84:87], v[180:183], v[48:63]
    s_setprio 0
    s_waitcnt lgkmcnt(4)
    v_or_b32 v232, v232, v231
    v_or_b32 v233, v233, v231
    s_cmp_lg_u32 s34, 0
    s_cbranch_scc1 K2_dum_30
    s_cmp_eq_u32 s33, 4
    s_cbranch_scc1 K2_a4_31
K2_b4_33:
    s_add_u32 m0, s48, 512
    s_add_u32 s65, s48, 1536
    buffer_load_dwordx4 v232, s[16:19], 0 offen  lds
    s_mov_b32 m0, s65
    s_mov_b32 exec_hi, 0
    buffer_load_dwordx4 v233, s[16:19], 0 offen  lds
    s_mov_b32 exec_hi, -1
K2_back_32:
    v_fmac_f32 v236, v11, v131
    v_fmac_f32 v234, v4, v100
    v_fmac_f32 v236, v12, v132
    v_fmac_f32 v234, v5, v101
    v_fmac_f32 v236, v13, v133
    v_fmac_f32 v234, v6, v102
    v_fmac_f32 v236, v14, v134
    v_fmac_f32 v234, v7, v103
    v_fmac_f32 v236, v15, v135
    v_mul_f32 v238, v16, v128
    v_mul_f32 v240, v24, v128
    v_fmac_f32 v238, v17, v129
    v_fmac_f32 v240, v25, v129
    v_fmac_f32 v238, v18, v130
    v_fmac_f32 v240, v26, v130
    v_fmac_f32 v238, v19, v131
    v_fmac_f32 v240, v27, v131
    v_fmac_f32 v238, v20, v132
    v_fmac_f32 v240, v28, v132
    v_fmac_f32 v238, v21, v133
    v_fmac_f32 v240, v29, v133
    v_fmac_f32 v238, v22, v134
    v_fmac_f32 v240, v30, v134
    v_fmac_f32 v238, v23, v135
    v_fmac_f32 v240, v31, v135
    v_mul_f32 v235, v32, v104
    v_mul_f32 v237, v40, v136
    v_fmac_f32 v235, v33, v105
    v_fmac_f32 v237, v41, v137
    v_fmac_f32 v235, v34, v106
    v_fmac_f32 v237, v42, v138
    v_fmac_f32 v235, v35, v107
    v_fmac_f32 v237, v43, v139
    v_fmac_f32 v235, v36, v108
    v_fmac_f32 v237, v44, v140
    v_fmac_f32 v235, v37, v109
    v_fmac_f32 v237, v45, v141
    v_fmac_f32 v235, v38, v110
    v_fmac_f32 v237, v46, v142
    v_fmac_f32 v235, v39, v111
    v_fmac_f32 v237, v47, v143
    v_mul_f32 v239, v48, v136
    v_mul_f32 v241, v56, v136
    s_setprio 1
    s_waitcnt vmcnt(6) lgkmcnt(0)
    v_mfma_f32_32x32x16_bf16 v[0:15], v[64:67], v[184:187], 0
    ds_read_b64_tr_b16 v[176:177], v246 offset:0
    ds_read_b64_tr_b16 v[178:179], v246 offset:512
    ds_read_b64_tr_b16 v[180:181], v247 offset:0
    ds_read_b64_tr_b16 v[182:183], v247 offset:512
    v_fmac_f32 v239, v49, v137
    v_fmac_f32 v241, v57, v137
    s_mov_b32 m0, s71
    v_mfma_f32_32x32x16_bf16 v[16:31], v[68:71], v[184:187], 0
    buffer_load_dwordx4 v224, s[4:7], s42 offen sc1 lds
    buffer_load_dwordx4 v225, s[72:75], s42 offen offset:1024 sc1 lds
    v_fmac_f32 v239, v50, v138
    v_fmac_f32 v241, v58, v138
    v_fmac_f32 v239, v51, v139
    v_fmac_f32 v241, v59, v139
    v_fmac_f32 v239, v52, v140
    v_mfma_f32_32x32x16_bf16 v[32:47], v[64:67], v[188:191], 0
    v_fmac_f32 v241, v60, v140
    v_fmac_f32 v239, v53, v141
    v_fmac_f32 v241, v61, v141
    v_fmac_f32 v239, v54, v142
    v_fmac_f32 v241, v62, v142
    v_fmac_f32 v239, v55, v143
    v_fmac_f32 v241, v63, v143
    v_mfma_f32_32x32x16_bf16 v[48:63], v[68:71], v[188:191], 0
    v_permlane32_swap_b32 v234, v236
    v_permlane32_swap_b32 v235, v237
    v_permlane32_swap_b32 v240, v238
    s_waitcnt vmcnt(6) lgkmcnt(0)
    v_mfma_f32_32x32x16_bf16 v[0:15], v[72:75], v[176:179], v[0:15]
    ds_read_b64_tr_b16 v[184:185], v246 offset:2048
    ds_read_b64_tr_b16 v[186:187], v246 offset:2560
    ds_read_b64_tr_b16 v[188:189], v247 offset:2048
    ds_read_b64_tr_b16 v[190:191], v247 offset:2560
    v_permlane32_swap_b32 v241, v239
    s_mov_b32 m0, s68
    v_mfma_f32_32x32x16_bf16 v[16:31], v[76:79], v[176:179], v[16:31]
    buffer_load_dwordx4 v226, s[4:7], s42 offen sc1 lds
    buffer_load_dwordx4 v227, s[72:75], s42 offen offset:1024 sc1 lds
    v_add_f32 v234, v234, v236
    v_add_f32 v235, v235, v237
    v_add_f32 v240, v240, v238
    v_add_f32 v241, v241, v239
    v_mfma_f32_32x32x16_bf16 v[32:47], v[72:75], v[180:183], v[32:47]
    s_set_gpr_idx_on s31, gpr_idx(DST)
    s_nop 0
    v_cvt_pk_bf16_f32 v192, v234, v235
    v_cvt_pk_bf16_f32 v193, v240, v241
    s_set_gpr_idx_off
    v_mfma_f32_32x32x16_bf16 v[48:63], v[76:79], v[180:183], v[48:63]
    s_waitcnt vmcnt(6) lgkmcnt(0)
    v_mfma_f32_32x32x16_bf16 v[0:15], v[80:83], v[184:187], v[0:15]
    ds_read_b64_tr_b16 v[176:177], v246 offset:4096
    ds_read_b64_tr_b16 v[178:179], v246 offset:4608
    ds_read_b64_tr_b16 v[180:181], v247 offset:4096
    ds_read_b64_tr_b16 v[182:183], v247 offset:4608
    s_mov_b32 m0, s69
    v_mfma_f32_32x32x16_bf16 v[16:31], v[84:87], v[184:187], v[16:31]
    buffer_load_dwordx4 v222, s[4:7], s43 offen sc1 lds
    buffer_load_dwordx4 v223, s[72:75], s43 offen offset:1024 sc1 lds
    v_mfma_f32_32x32x16_bf16 v[32:47], v[80:83], v[188:191], v[32:47]
    s_nop 2
    v_mul_f32 v234, v0, v144
    v_mul_f32 v236, v8, v112
    v_fmac_f32 v234, v1, v145
    v_fmac_f32 v236, v9, v113
    v_fmac_f32 v234, v2, v146
    v_fmac_f32 v236, v10, v114
    v_fmac_f32 v234, v3, v147
    v_mfma_f32_32x32x16_bf16 v[48:63], v[84:87], v[188:191], v[48:63]
    s_setprio 0
    v_fmac_f32 v236, v11, v115
    v_fmac_f32 v234, v4, v148
    v_fmac_f32 v236, v12, v116
    v_fmac_f32 v234, v5, v149
    v_fmac_f32 v236, v13, v117
    v_fmac_f32 v234, v6, v150
    v_fmac_f32 v236, v14, v118
    v_fmac_f32 v234, v7, v151
    v_fmac_f32 v236, v15, v119
    v_mul_f32 v238, v16, v160
    v_mul_f32 v240, v24, v160
    v_fmac_f32 v238, v17, v161
    v_fmac_f32 v240, v25, v161
    v_fmac_f32 v238, v18, v162
    v_fmac_f32 v240, v26, v162
    v_fmac_f32 v238, v19, v163
    v_fmac_f32 v240, v27, v163
    v_fmac_f32 v238, v20, v164
    v_fmac_f32 v240, v28, v164
    v_fmac_f32 v238, v21, v165
    v_fmac_f32 v240, v29, v165
    v_fmac_f32 v238, v22, v166
    v_fmac_f32 v240, v30, v166
    v_fmac_f32 v238, v23, v167
    v_fmac_f32 v240, v31, v167
    v_mul_f32 v235, v32, v152
    v_mul_f32 v237, v40, v120
    v_fmac_f32 v235, v33, v153
    v_fmac_f32 v237, v41, v121
    v_fmac_f32 v235, v34, v154
    v_fmac_f32 v237, v42, v122
    v_fmac_f32 v235, v35, v155
    v_fmac_f32 v237, v43, v123
    v_fmac_f32 v235, v36, v156
    v_fmac_f32 v237, v44, v124
    v_fmac_f32 v235, v37, v157
    v_fmac_f32 v237, v45, v125
    v_fmac_f32 v235, v38, v158
    v_fmac_f32 v237, v46, v126
    v_fmac_f32 v235, v39, v159
    v_fmac_f32 v237, v47, v127
    v_mul_f32 v239, v48, v168
    v_mul_f32 v241, v56, v168
    v_fmac_f32 v239, v49, v169
    v_fmac_f32 v241, v57, v169
    s_setprio 1
    s_waitcnt vmcnt(4) lgkmcnt(0)
    v_mfma_f32_32x32x16_bf16 v[0:15], v[64:67], v[176:179], 0
    ds_read_b64_tr_b16 v[184:185], v246 offset:6144
    ds_read_b64_tr_b16 v[186:187], v246 offset:6656
    ds_read_b64_tr_b16 v[188:189], v247 offset:6144
    ds_read_b64_tr_b16 v[190:191], v247 offset:6656
    v_fmac_f32 v239, v50, v170
    v_fmac_f32 v241, v58, v170
    s_mov_b32 m0, s70
    v_mfma_f32_32x32x16_bf16 v[16:31], v[68:71], v[176:179], 0
    buffer_load_dwordx4 v224, s[4:7], s43 offen sc1 lds
    buffer_load_dwordx4 v225, s[72:75], s43 offen offset:1024 sc1 lds
    v_fmac_f32 v239, v51, v171
    v_fmac_f32 v241, v59, v171
    v_fmac_f32 v239, v52, v172
    v_fmac_f32 v241, v60, v172
    v_fmac_f32 v239, v53, v173
    v_mfma_f32_32x32x16_bf16 v[32:47], v[64:67], v[180:183], 0
    v_add_u32 v222, s48, v251
    ds_read_b32 v222, v222
    v_fmac_f32 v241, v61, v173
    v_fmac_f32 v239, v54, v174
    v_fmac_f32 v241, v62, v174
    v_fmac_f32 v239, v55, v175
    v_fmac_f32 v241, v63, v175
    v_mfma_f32_32x32x16_bf16 v[48:63], v[68:71], v[180:183], 0
    s_waitcnt vmcnt(4) lgkmcnt(1)
    v_mfma_f32_32x32x16_bf16 v[0:15], v[72:75], v[184:187], v[0:15]
    ds_read_b64_tr_b16 v[176:177], v246 offset:0
    ds_read_b64_tr_b16 v[178:179], v246 offset:512
    ds_read_b64_tr_b16 v[180:181], v247 offset:0
    ds_read_b64_tr_b16 v[182:183], v247 offset:512
    s_mov_b32 m0, s71
    v_mfma_f32_32x32x16_bf16 v[16:31], v[76:79], v[184:187], v[16:31]
    buffer_load_dwordx4 v226, s[4:7], s43 offen sc1 lds
    buffer_load_dwordx4 v227, s[72:75], s43 offen offset:1024 sc1 lds
    s_waitcnt lgkmcnt(4)
    v_mad_u32_u16 v223, v222, s39, v248 op_sel:[1,0,0,0]
    v_mad_u32_u16 v222, v222, s39, v248
    v_mfma_f32_32x32x16_bf16 v[32:47], v[72:75], v[188:191], v[32:47]
    v_add_u32 v224, s49, v251
    ds_read_b32 v224, v224
    v_mfma_f32_32x32x16_bf16 v[48:63], v[76:79], v[188:191], v[48:63]
    s_waitcnt vmcnt(4) lgkmcnt(1)
    v_mfma_f32_32x32x16_bf16 v[0:15], v[80:83], v[176:179], v[0:15]
    ds_read_b64_tr_b16 v[184:185], v246 offset:2048
    ds_read_b64_tr_b16 v[186:187], v246 offset:2560
    ds_read_b64_tr_b16 v[188:189], v247 offset:2048
    ds_read_b64_tr_b16 v[190:191], v247 offset:2560
    s_mov_b32 m0, s68
    v_mfma_f32_32x32x16_bf16 v[16:31], v[84:87], v[176:179], v[16:31]
    buffer_load_dwordx4 v222, s[4:7], s44 offen sc1 lds
    buffer_load_dwordx4 v223, s[72:75], s44 offen offset:1024 sc1 lds
    s_waitcnt lgkmcnt(4)
    v_mad_u32_u16 v225, v224, s39, v248 op_sel:[1,0,0,0]
    v_mad_u32_u16 v224, v224, s39, v248
    v_mfma_f32_32x32x16_bf16 v[32:47], v[80:83], v[180:183], v[32:47]
    v_add_u32 v226, s50, v251
    ds_read_b32 v226, v226
    v_mul_f32 v242, v0, v144
    v_fma_f32 v238, v8, v160, -v238
    v_fmac_f32 v242, v1, v145
    v_fmac_f32 v238, v9, v161
    v_fmac_f32 v242, v2, v146
    v_mfma_f32_32x32x16_bf16 v[48:63], v[84:87], v[180:183], v[48:63]
    s_setprio 0
    v_fmac_f32 v238, v10, v162
    v_fmac_f32 v242, v3, v147
    v_fmac_f32 v238, v11, v163
    v_fmac_f32 v242, v4, v148
    v_fmac_f32 v238, v12, v164
    v_fmac_f32 v242, v5, v149
    v_fmac_f32 v238, v13, v165
    v_fmac_f32 v242, v6, v150
    v_fmac_f32 v238, v14, v166
    v_fmac_f32 v242, v7, v151
    v_fmac_f32 v238, v15, v167
    v_fmac_f32 v236, v16, v112
    v_mul_f32 v244, v24, v160
    v_fmac_f32 v236, v17, v113
    v_fmac_f32 v244, v25, v161
    v_fmac_f32 v236, v18, v114
    v_fmac_f32 v244, v26, v162
    v_fmac_f32 v236, v19, v115
    v_fmac_f32 v244, v27, v163
    v_fmac_f32 v236, v20, v116
    v_fmac_f32 v244, v28, v164
    v_fmac_f32 v236, v21, v117
    v_fmac_f32 v244, v29, v165
    v_fmac_f32 v236, v22, v118
    v_fmac_f32 v244, v30, v166
    v_fmac_f32 v236, v23, v119
    v_fmac_f32 v244, v31, v167
    v_mul_f32 v243, v32, v152
    v_fma_f32 v239, v40, v168, -v239
    v_fmac_f32 v243, v33, v153
    v_fmac_f32 v239, v41, v169
    v_fmac_f32 v243, v34, v154
    v_fmac_f32 v239, v42, v170
    v_fmac_f32 v243, v35, v155
    v_fmac_f32 v239, v43, v171
    v_fmac_f32 v243, v36, v156
    v_fmac_f32 v239, v44, v172
    v_fmac_f32 v243, v37, v157
    v_fmac_f32 v239, v45, v173
    v_fmac_f32 v243, v38, v158
    v_fmac_f32 v239, v46, v174
    v_fmac_f32 v243, v39, v159
    v_fmac_f32 v239, v47, v175
    v_fmac_f32 v237, v48, v120
    v_mul_f32 v245, v56, v168
    v_fmac_f32 v237, v49, v121
    v_fmac_f32 v245, v57, v169
    v_fmac_f32 v237, v50, v122
    v_fmac_f32 v245, v58, v170
    v_fmac_f32 v237, v51, v123
    s_setprio 1
    s_waitcnt vmcnt(4) lgkmcnt(1)
    v_mfma_f32_32x32x16_bf16 v[0:15], v[64:67], v[184:187], 0
    ds_read_b64_tr_b16 v[176:177], v246 offset:4096
    ds_read_b64_tr_b16 v[178:179], v246 offset:4608
    ds_read_b64_tr_b16 v[180:181], v247 offset:4096
    ds_read_b64_tr_b16 v[182:183], v247 offset:4608
    v_fmac_f32 v245, v59, v171
    v_fmac_f32 v237, v52, v124
    s_mov_b32 m0, s69
    v_mfma_f32_32x32x16_bf16 v[16:31], v[68:71], v[184:187], 0
    buffer_load_dwordx4 v224, s[4:7], s45 offen sc1 lds
    buffer_load_dwordx4 v225, s[72:75], s45 offen offset:1024 sc1 lds
    s_waitcnt lgkmcnt(4)
    v_mad_u32_u16 v227, v226, s39, v248 op_sel:[1,0,0,0]
    v_mad_u32_u16 v226, v226, s39, v248
    v_fmac_f32 v245, v60, v172
    v_fmac_f32 v237, v53, v125
    v_mfma_f32_32x32x16_bf16 v[32:47], v[64:67], v[188:191], 0
    v_add_u32 v228, s51, v251
    ds_read_b32 v228, v228
    v_fmac_f32 v245, v61, v173
    v_fmac_f32 v237, v54, v126
    v_fmac_f32 v245, v62, v174
    v_fmac_f32 v237, v55, v127
    v_fmac_f32 v245, v63, v175
    v_mfma_f32_32x32x16_bf16 v[48:63], v[68:71], v[188:191], 0
    v_permlane32_swap_b32 v242, v234
    v_permlane32_swap_b32 v243, v235
    v_add_f32 v242, v242, v234
    v_add_f32 v243, v243, v235
    s_waitcnt vmcnt(4) lgkmcnt(1)
    v_mfma_f32_32x32x16_bf16 v[0:15], v[72:75], v[176:179], v[0:15]
    ds_read_b64_tr_b16 v[184:185], v246 offset:6144
    ds_read_b64_tr_b16 v[186:187], v246 offset:6656
    ds_read_b64_tr_b16 v[188:189], v247 offset:6144
    ds_read_b64_tr_b16 v[190:191], v247 offset:6656
    s_mov_b32 m0, s70
    v_mfma_f32_32x32x16_bf16 v[16:31], v[76:79], v[176:179], v[16:31]
    buffer_load_dwordx4 v226, s[4:7], s46 offen sc1 lds
    buffer_load_dwordx4 v227, s[72:75], s46 offen offset:1024 sc1 lds
    s_waitcnt lgkmcnt(4)
    v_mad_u32_u16 v229, v228, s39, v248 op_sel:[1,0,0,0]
    v_mad_u32_u16 v228, v228, s39, v248
    s_sub_u32 s26, s48, s29
    s_mov_b32 s29, s48
    v_mfma_f32_32x32x16_bf16 v[32:47], v[72:75], v[180:183], v[32:47]
    s_set_gpr_idx_on s31, gpr_idx(DST)
    s_nop 0
    v_cvt_pk_bf16_f32 v194, v242, v243
    s_set_gpr_idx_off
    s_mov_b32 s30, s3
    s_cmp_eq_u32 s34, 0
    s_cselect_b32 s56, s33, 0
    s_mov_b32 s32, s31
    v_mfma_f32_32x32x16_bf16 v[48:63], v[76:79], v[180:183], v[48:63]
    s_mov_b32 s31, s35
    s_waitcnt vmcnt(4) lgkmcnt(0)
    v_mfma_f32_32x32x16_bf16 v[0:15], v[80:83], v[184:187], v[0:15]
    ds_read_b64_tr_b16 v[176:177], v246 offset:0
    ds_read_b64_tr_b16 v[178:179], v246 offset:512
    ds_read_b64_tr_b16 v[180:181], v247 offset:0
    ds_read_b64_tr_b16 v[182:183], v247 offset:512
    s_mov_b32 m0, s71
    v_mfma_f32_32x32x16_bf16 v[16:31], v[84:87], v[184:187], v[16:31]
    buffer_load_dwordx4 v228, s[4:7], s47 offen sc1 lds
    buffer_load_dwordx4 v229, s[72:75], s47 offen offset:1024 sc1 lds
    v_mfma_f32_32x32x16_bf16 v[32:47], v[80:83], v[188:191], v[32:47]
    s_nop 2
    v_mul_f32 v242, v0, v144
    v_fma_f32 v240, v8, v160, -v240
    v_fmac_f32 v242, v1, v145
    v_fmac_f32 v240, v9, v161
    v_fmac_f32 v242, v2, v146
    v_fmac_f32 v240, v10, v162
    v_fmac_f32 v242, v3, v147
    v_mfma_f32_32x32x16_bf16 v[48:63], v[84:87], v[188:191], v[48:63]
    s_setprio 0
    v_fmac_f32 v240, v11, v163
    v_fmac_f32 v242, v4, v148
    v_fmac_f32 v240, v12, v164
    v_fmac_f32 v242, v5, v149
    v_fmac_f32 v240, v13, v165
    v_fmac_f32 v242, v6, v150
    v_fmac_f32 v240, v14, v166
    v_fmac_f32 v242, v7, v151
    v_fmac_f32 v240, v15, v167
    v_add_u32 v249, s26, v249
    v_add_u32 v250, s26, v250
    v_fma_f32 v244, v16, v160, -v244
    v_fmac_f32 v236, v24, v112
    v_fmac_f32 v244, v17, v161
    v_fmac_f32 v236, v25, v113
    v_fmac_f32 v244, v18, v162
    v_fmac_f32 v236, v26, v114
    v_fmac_f32 v244, v19, v163
    v_fmac_f32 v236, v27, v115
    v_fmac_f32 v244, v20, v164
    v_fmac_f32 v236, v28, v116
    v_fmac_f32 v244, v21, v165
    v_fmac_f32 v236, v29, v117
    v_fmac_f32 v244, v22, v166
    v_fmac_f32 v236, v30, v118
    v_fmac_f32 v244, v23, v167
    v_fmac_f32 v236, v31, v119
    ds_read_b64_tr_b16 v[0:1], v249 offset:0
    ds_read_b64_tr_b16 v[2:3], v249 offset:256
    ds_read_u16_d16_hi v16, v250 offset:0
    v_mul_f32 v243, v32, v152
    v_fma_f32 v241, v40, v168, -v241
    v_fmac_f32 v243, v33, v153
    v_fmac_f32 v241, v41, v169
    v_fmac_f32 v243, v34, v154
    v_fmac_f32 v241, v42, v170
    v_fmac_f32 v243, v35, v155
    v_fmac_f32 v241, v43, v171
    v_fmac_f32 v243, v36, v156
    v_fmac_f32 v241, v44, v172
    v_fmac_f32 v243, v37, v157
    v_fmac_f32 v241, v45, v173
    v_fmac_f32 v243, v38, v158
    v_fmac_f32 v241, v46, v174
    v_fmac_f32 v243, v39, v159
    v_fmac_f32 v241, v47, v175
    ds_read_b64_tr_b16 v[4:5], v249 offset:512
    ds_read_b64_tr_b16 v[6:7], v249 offset:768
    ds_read_u16_d16_hi v17, v250 offset:32
    v_fma_f32 v245, v48, v168, -v245
    v_fmac_f32 v237, v56, v120
    v_fmac_f32 v245, v49, v169
    v_fmac_f32 v237, v57, v121
    v_fmac_f32 v245, v50, v170
    v_fmac_f32 v237, v58, v122
    v_fmac_f32 v245, v51, v171
    v_fmac_f32 v237, v59, v123
    v_fmac_f32 v245, v52, v172
    v_fmac_f32 v237, v60, v124
    v_fmac_f32 v245, v53, v173
    v_fmac_f32 v237, v61, v125
    v_fmac_f32 v245, v54, v174
    v_fmac_f32 v237, v62, v126
    v_fmac_f32 v245, v55, v175
    v_fmac_f32 v237, v63, v127
    s_cmp_eq_u32 s56, 2
    s_cbranch_scc1 K2_U20
    s_cmp_eq_u32 s56, 3
    s_cbranch_scc1 K2_U30
    s_branch K2_DSP0
K2_PAD_U21:
    s_branch K2_HOP
K2_U21:
    s_setprio 1
    s_waitcnt lgkmcnt(0)
    v_lshlrev_b32 v20, 16, v0
    v_and_b32 v21, 0xffff0000, v0
    v_lshlrev_b32 v22, 16, v1
    v_and_b32 v23, 0xffff0000, v1
    v_lshlrev_b32 v24, 16, v2
    v_and_b32 v25, 0xffff0000, v2
    v_lshlrev_b32 v26, 16, v3
    v_and_b32 v27, 0xffff0000, v3
    v_mul_f32_dpp v36, v16, v20 row_newbcast:8 row_mask:0xf bank_mask:0xf
    v_mul_f32_dpp v37, v16, v21 row_newbcast:9 row_mask:0xf bank_mask:0xf
    v_mul_f32_dpp v38, v16, v22 row_newbcast:10 row_mask:0xf bank_mask:0xf
    v_mul_f32_dpp v39, v16, v23 row_newbcast:11 row_mask:0xf bank_mask:0xf
    v_mul_f32_dpp v40, v16, v24 row_newbcast:12 row_mask:0xf bank_mask:0xf
    v_mul_f32_dpp v41, v16, v25 row_newbcast:13 row_mask:0xf bank_mask:0xf
    v_mul_f32_dpp v42, v16, v26 row_newbcast:14 row_mask:0xf bank_mask:0xf
    v_mul_f32_dpp v43, v16, v27 row_newbcast:15 row_mask:0xf bank_mask:0xf
    v_cvt_pk_bf16_f32 v68, v36, v37
    v_cvt_pk_bf16_f32 v69, v38, v39
    v_cvt_pk_bf16_f32 v70, v40, v41
    v_cvt_pk_bf16_f32 v71, v42, v43
    v_mul_f32_dpp v20, v16, v20 row_newbcast:0 row_mask:0xa bank_mask:0xf
    v_mul_f32_dpp v21, v16, v21 row_newbcast:1 row_mask:0xa bank_mask:0xf
    v_mul_f32_dpp v22, v16, v22 row_newbcast:2 row_mask:0xa bank_mask:0xf
    v_mul_f32_dpp v23, v16, v23 row_newbcast:3 row_mask:0xa bank_mask:0xf
    v_mul_f32_dpp v24, v16, v24 row_newbcast:4 row_mask:0xa bank_mask:0xf
    v_mul_f32_dpp v25, v16, v25 row_newbcast:5 row_mask:0xa bank_mask:0xf
    v_mul_f32_dpp v26, v16, v26 row_newbcast:6 row_mask:0xa bank_mask:0xf
    v_mul_f32_dpp v27, v16, v27 row_newbcast:7 row_mask:0xa bank_mask:0xf
    v_cvt_pk_bf16_f32 v64, v20, v21
    v_cvt_pk_bf16_f32 v65, v22, v23
    v_cvt_pk_bf16_f32 v66, v24, v25
    v_cvt_pk_bf16_f32 v67, v26, v27
    v_lshlrev_b32 v28, 16, v4
    v_and_b32 v29, 0xffff0000, v4
    v_lshlrev_b32 v30, 16, v5
    v_and_b32 v31, 0xffff0000, v5
    v_lshlrev_b32 v32, 16, v6
    v_and_b32 v33, 0xffff0000, v6
    v_lshlrev_b32 v34, 16, v7
    v_and_b32 v35, 0xffff0000, v7
    v_mul_f32_dpp v36, v17, v28 row_newbcast:8 row_mask:0xf bank_mask:0xf
    v_mul_f32_dpp v37, v17, v29 row_newbcast:9 row_mask:0xf bank_mask:0xf
    v_mul_f32_dpp v38, v17, v30 row_newbcast:10 row_mask:0xf bank_mask:0xf
    v_mul_f32_dpp v39, v17, v31 row_newbcast:11 row_mask:0xf bank_mask:0xf
    v_mul_f32_dpp v40, v17, v32 row_newbcast:12 row_mask:0xf bank_mask:0xf
    v_mul_f32_dpp v41, v17, v33 row_newbcast:13 row_mask:0xf bank_mask:0xf
    v_mul_f32_dpp v42, v17, v34 row_newbcast:14 row_mask:0xf bank_mask:0xf
    v_mul_f32_dpp v43, v17, v35 row_newbcast:15 row_mask:0xf bank_mask:0xf
    v_cvt_pk_bf16_f32 v76, v36, v37
    v_cvt_pk_bf16_f32 v77, v38, v39
    v_cvt_pk_bf16_f32 v78, v40, v41
    v_cvt_pk_bf16_f32 v79, v42, v43
    v_mul_f32_dpp v28, v17, v28 row_newbcast:0 row_mask:0xa bank_mask:0xf
    v_mul_f32_dpp v29, v17, v29 row_newbcast:1 row_mask:0xa bank_mask:0xf
    v_mul_f32_dpp v30, v17, v30 row_newbcast:2 row_mask:0xa bank_mask:0xf
    v_mul_f32_dpp v31, v17, v31 row_newbcast:3 row_mask:0xa bank_mask:0xf
    v_mul_f32_dpp v32, v17, v32 row_newbcast:4 row_mask:0xa bank_mask:0xf
    v_mul_f32_dpp v33, v17, v33 row_newbcast:5 row_mask:0xa bank_mask:0xf
    v_mul_f32_dpp v34, v17, v34 row_newbcast:6 row_mask:0xa bank_mask:0xf
    v_mul_f32_dpp v35, v17, v35 row_newbcast:7 row_mask:0xa bank_mask:0xf
    v_cvt_pk_bf16_f32 v72, v28, v29
    v_cvt_pk_bf16_f32 v73, v30, v31
    v_cvt_pk_bf16_f32 v74, v32, v33
    v_cvt_pk_bf16_f32 v75, v34, v35
    s_waitcnt vmcnt(4)
    v_mfma_f32_32x32x16_bf16 v[0:15], v[64:67], v[176:179], 0
    ds_read_b64_tr_b16 v[184:185], v246 offset:2048
    ds_read_b64_tr_b16 v[186:187], v246 offset:2560
    ds_read_b64_tr_b16 v[188:189], v247 offset:2048
    ds_read_b64_tr_b16 v[190:191], v247 offset:2560
    s_mov_b32 m0, s68
    v_mfma_f32_32x32x16_bf16 v[16:31], v[68:71], v[176:179], 0
    buffer_load_dwordx4 v222, s[4:7], s42 offen sc1 lds
    buffer_load_dwordx4 v223, s[72:75], s42 offen offset:1024 sc1 lds
    v_permlane32_swap_b32 v242, v236
    v_permlane32_swap_b32 v243, v237
    v_mov_b32 v254, 163296
    v_mfma_f32_32x32x16_bf16 v[32:47], v[64:67], v[180:183], 0
    v_permlane32_swap_b32 v244, v238
    v_permlane32_swap_b32 v245, v239
    v_permlane32_swap_b32 v240, v241
    v_add_f32 v242, v242, v236
    v_mfma_f32_32x32x16_bf16 v[48:63], v[68:71], v[180:183], 0
    v_add_f32 v243, v243, v237
    v_add_f32 v244, v244, v238
    v_add_f32 v245, v245, v239
    v_add_f32 v240, -v240, -v241
    v_sub_u32 v241, v230, v231
    v_cvt_pk_bf16_f32 v242, v242, v243
    v_mov_b32 v255, 1
    v_lshl_add_u32 v233, v252, 1, s53
    s_mov_b64 exec, 1
    ds_add_rtn_u32 v232, v254, v255
    s_mov_b64 exec, -1
    ds_read_b32 v233, v233
    s_waitcnt vmcnt(4) lgkmcnt(2)
    v_mfma_f32_32x32x16_bf16 v[0:15], v[72:75], v[184:187], v[0:15]
    ds_read_b64_tr_b16 v[176:177], v246 offset:4096
    ds_read_b64_tr_b16 v[178:179], v246 offset:4608
    ds_read_b64_tr_b16 v[180:181], v247 offset:4096
    ds_read_b64_tr_b16 v[182:183], v247 offset:4608
    v_cvt_pk_bf16_f32 v244, v244, v245
    v_cvt_pk_bf16_f32 v240, v240, v240
    s_mov_b32 m0, s69
    v_mfma_f32_32x32x16_bf16 v[16:31], v[76:79], v[184:187], v[16:31]
    buffer_load_dwordx4 v224, s[4:7], s42 offen sc1 lds
    buffer_load_dwordx4 v225, s[72:75], s42 offen offset:1024 sc1 lds
    ds_write_b32 v230, v242 offset:768
    ds_write_b32 v230, v244 offset:1024
    ds_write_b16 v241, v240 offset:1280
    s_waitcnt lgkmcnt(7)
    v_readfirstlane_b32 s58, v232
    v_mfma_f32_32x32x16_bf16 v[32:47], v[72:75], v[188:191], v[32:47]
    s_cmp_lt_u32 s58, s22
    s_cbranch_scc0 K2_nul_34
    s_and_b32 s59, s58, 7
    s_lshr_b32 s60, s58, 3
K2_chk_36:
    v_readlane_b32 s61, v233, s59
    s_nop 0
    s_cmp_gt_u32 s61, s60
    s_cbranch_scc0 K2_spin_35
K2_back_37:
    v_mfma_f32_32x32x16_bf16 v[48:63], v[76:79], v[188:191], v[48:63]
    s_setprio 0
    v_readlane_b32 s3, v253, s58
    s_lshl_b32 s44, s34, 7
    s_and_b32 s48, s3, 0x3ffff
    s_bfe_u32 s33, s3, 0x30012
    s_mov_b32 s35, s48
    s_mov_b32 s45, s44
    v_mul_f32 v234, v0, v96
    v_mul_f32 v236, v8, v128
    v_fmac_f32 v234, v1, v97
    v_fmac_f32 v236, v9, v129
    v_fmac_f32 v234, v2, v98
    v_fmac_f32 v236, v10, v130
    v_fmac_f32 v234, v3, v99
    v_fmac_f32 v236, v11, v131
    v_fmac_f32 v234, v4, v100
    v_fmac_f32 v236, v12, v132
    v_fmac_f32 v234, v5, v101
    v_fmac_f32 v236, v13, v133
    v_fmac_f32 v234, v6, v102
    v_fmac_f32 v236, v14, v134
    v_fmac_f32 v234, v7, v103
    v_fmac_f32 v236, v15, v135
    v_mul_f32 v238, v16, v128
    v_mul_f32 v240, v24, v128
    v_fmac_f32 v238, v17, v129
    v_fmac_f32 v240, v25, v129
    v_fmac_f32 v238, v18, v130
    v_fmac_f32 v240, v26, v130
    v_fmac_f32 v238, v19, v131
    v_fmac_f32 v240, v27, v131
    v_fmac_f32 v238, v20, v132
    v_fmac_f32 v240, v28, v132
    v_fmac_f32 v238, v21, v133
    v_fmac_f32 v240, v29, v133
    v_fmac_f32 v238, v22, v134
    v_fmac_f32 v240, v30, v134
    v_fmac_f32 v238, v23, v135
    v_fmac_f32 v240, v31, v135
    v_mul_f32 v235, v32, v104
    v_mul_f32 v237, v40, v136
    v_fmac_f32 v235, v33, v105
    v_fmac_f32 v237, v41, v137
    v_fmac_f32 v235, v34, v106
    v_fmac_f32 v237, v42, v138
    v_fmac_f32 v235, v35, v107
    v_fmac_f32 v237, v43, v139
    v_fmac_f32 v235, v36, v108
    v_fmac_f32 v237, v44, v140
    v_fmac_f32 v235, v37, v109
    v_fmac_f32 v237, v45, v141
    v_fmac_f32 v235, v38, v110
    v_fmac_f32 v237, v46, v142
    v_fmac_f32 v235, v39, v111
    v_fmac_f32 v237, v47, v143
    v_mul_f32 v239, v48, v136
    v_mul_f32 v241, v56, v136
    v_fmac_f32 v239, v49, v137
    v_fmac_f32 v241, v57, v137
    s_setprio 1
    s_waitcnt vmcnt(4) lgkmcnt(3)
    v_mfma_f32_32x32x16_bf16 v[0:15], v[64:67], v[176:179], 0
    ds_read_b64_tr_b16 v[184:185], v246 offset:6144
    ds_read_b64_tr_b16 v[186:187], v246 offset:6656
    ds_read_b64_tr_b16 v[188:189], v247 offset:6144
    ds_read_b64_tr_b16 v[190:191], v247 offset:6656
    v_fmac_f32 v239, v50, v138
    v_fmac_f32 v241, v58, v138
    s_mov_b32 m0, s70
    v_mfma_f32_32x32x16_bf16 v[16:31], v[68:71], v[176:179], 0
    buffer_load_dwordx4 v222, s[4:7], s43 offen sc1 lds
    buffer_load_dwordx4 v223, s[72:75], s43 offen offset:1024 sc1 lds
    v_fmac_f32 v239, v51, v139
    v_fmac_f32 v241, v59, v139
    v_fmac_f32 v239, v52, v140
    v_fmac_f32 v241, v60, v140
    v_fmac_f32 v239, v53, v141
    v_mfma_f32_32x32x16_bf16 v[32:47], v[64:67], v[180:183], 0
    s_add_u32 s47, s44, 256
    s_add_u32 s49, s48, 32
    s_add_u32 s60, s48, 64
    s_cmp_eq_u32 s33, 3
    s_cselect_b32 s46, s44, s47
    s_cselect_b32 s50, s60, s48
    s_cselect_b32 s51, s48, s49
    s_sub_u32 s60, s33, 2
    s_cmp_lt_u32 s60, 2
    s_cbranch_scc0 K2_rare_38
K2_back_39:
    v_add_u32 v222, s48, v251
    ds_read_b32 v222, v222
    v_fmac_f32 v241, v61, v141
    v_fmac_f32 v239, v54, v142
    v_fmac_f32 v241, v62, v142
    v_fmac_f32 v239, v55, v143
    v_fmac_f32 v241, v63, v143
    v_mfma_f32_32x32x16_bf16 v[48:63], v[68:71], v[180:183], 0
    v_permlane32_swap_b32 v234, v236
    v_permlane32_swap_b32 v235, v237
    v_permlane32_swap_b32 v240, v238
    s_waitcnt vmcnt(4) lgkmcnt(1)
    v_mfma_f32_32x32x16_bf16 v[0:15], v[72:75], v[184:187], v[0:15]
    ds_read_b64_tr_b16 v[176:177], v246 offset:0
    ds_read_b64_tr_b16 v[178:179], v246 offset:512
    ds_read_b64_tr_b16 v[180:181], v247 offset:0
    ds_read_b64_tr_b16 v[182:183], v247 offset:512
    v_permlane32_swap_b32 v241, v239
    s_mov_b32 m0, s71
    v_mfma_f32_32x32x16_bf16 v[16:31], v[76:79], v[184:187], v[16:31]
    buffer_load_dwordx4 v224, s[4:7], s43 offen sc1 lds
    buffer_load_dwordx4 v225, s[72:75], s43 offen offset:1024 sc1 lds
    s_waitcnt lgkmcnt(4)
    v_mad_u32_u16 v223, v222, s39, v248 op_sel:[1,0,0,0]
    v_mad_u32_u16 v222, v222, s39, v248
    v_lshl_add_u32 v230, v252, 1, s31
    v_add_f32 v234, v234, v236
    v_add_f32 v235, v235, v237
    v_add_f32 v240, v240, v238
    v_add_f32 v241, v241, v239
    v_cvt_pk_bf16_f32 v234, v234, v235
    v_cvt_pk_bf16_f32 v240, v240, v241
    ds_write_b32 v230, v234 offset:0
    ds_write_b32 v230, v240 offset:256
    v_mfma_f32_32x32x16_bf16 v[32:47], v[72:75], v[188:191], v[32:47]
    v_add_u32 v224, s49, v251
    ds_read_b32 v224, v224
    v_mul_f32 v234, v0, v144
    v_mul_f32 v236, v8, v112
    v_fmac_f32 v234, v1, v145
    v_fmac_f32 v236, v9, v113
    v_fmac_f32 v234, v2, v146
    v_mfma_f32_32x32x16_bf16 v[48:63], v[76:79], v[188:191], v[48:63]
    s_setprio 0
    v_fmac_f32 v236, v10, v114
    v_fmac_f32 v234, v3, v147
    v_fmac_f32 v236, v11, v115
    v_fmac_f32 v234, v4, v148
    v_fmac_f32 v236, v12, v116
    v_fmac_f32 v234, v5, v149
    v_fmac_f32 v236, v13, v117
    v_fmac_f32 v234, v6, v150
    v_fmac_f32 v236, v14, v118
    v_fmac_f32 v234, v7, v151
    v_fmac_f32 v236, v15, v119
    v_mul_f32 v238, v16, v160
    v_mul_f32 v240, v24, v160
    v_fmac_f32 v238, v17, v161
    v_fmac_f32 v240, v25, v161
    v_fmac_f32 v238, v18, v162
    v_fmac_f32 v240, v26, v162
    v_fmac_f32 v238, v19, v163
    v_fmac_f32 v240, v27, v163
    v_fmac_f32 v238, v20, v164
    v_fmac_f32 v240, v28, v164
    v_fmac_f32 v238, v21, v165
    v_fmac_f32 v240, v29, v165
    v_fmac_f32 v238, v22, v166
    v_fmac_f32 v240, v30, v166
    v_fmac_f32 v238, v23, v167
    v_fmac_f32 v240, v31, v167
    v_mul_f32 v235, v32, v152
    v_mul_f32 v237, v40, v120
    v_fmac_f32 v235, v33, v153
    v_fmac_f32 v237, v41, v121
    v_fmac_f32 v235, v34, v154
    v_fmac_f32 v237, v42, v122
    v_fmac_f32 v235, v35, v155
    v_fmac_f32 v237, v43, v123
    v_fmac_f32 v235, v36, v156
    v_fmac_f32 v237, v44, v124
    v_fmac_f32 v235, v37, v157
    v_fmac_f32 v237, v45, v125
    v_fmac_f32 v235, v38, v158
    v_fmac_f32 v237, v46, v126
    v_fmac_f32 v235, v39, v159
    v_fmac_f32 v237, v47, v127
    v_mul_f32 v239, v48, v168
    v_mul_f32 v241, v56, v168
    v_fmac_f32 v239, v49, v169
    v_fmac_f32 v241, v57, v169
    v_fmac_f32 v239, v50, v170
    v_fmac_f32 v241, v58, v170
    v_fmac_f32 v239, v51, v171
    s_setprio 1
    s_waitcnt vmcnt(4) lgkmcnt(3)
    v_mfma_f32_32x32x16_bf16 v[0:15], v[64:67], v[176:179], 0
    ds_read_b64_tr_b16 v[184:185], v246 offset:2048
    ds_read_b64_tr_b16 v[186:187], v246 offset:2560
    ds_read_b64_tr_b16 v[188:189], v247 offset:2048
    ds_read_b64_tr_b16 v[190:191], v247 offset:2560
    v_fmac_f32 v241, v59, v171
    v_fmac_f32 v239, v52, v172
    s_mov_b32 m0, s68
    v_mfma_f32_32x32x16_bf16 v[16:31], v[68:71], v[176:179], 0
    buffer_load_dwordx4 v222, s[4:7], s44 offen sc1 lds
    buffer_load_dwordx4 v223, s[72:75], s44 offen offset:1024 sc1 lds
    s_waitcnt lgkmcnt(4)
    v_mad_u32_u16 v225, v224, s39, v248 op_sel:[1,0,0,0]
    v_mad_u32_u16 v224, v224, s39, v248
    v_fmac_f32 v241, v60, v172
    v_fmac_f32 v239, v53, v173
    v_mfma_f32_32x32x16_bf16 v[32:47], v[64:67], v[180:183], 0
    v_add_u32 v226, s50, v251
    ds_read_b32 v226, v226
    v_fmac_f32 v241, v61, v173
    v_fmac_f32 v239, v54, v174
    v_fmac_f32 v241, v62, v174
    v_fmac_f32 v239, v55, v175
    v_fmac_f32 v241, v63, v175
    v_mfma_f32_32x32x16_bf16 v[48:63], v[68:71], v[180:183], 0
    s_waitcnt vmcnt(4) lgkmcnt(1)
    v_mfma_f32_32x32x16_bf16 v[0:15], v[72:75], v[184:187], v[0:15]
    ds_read_b64_tr_b16 v[176:177], v246 offset:4096
    ds_read_b64_tr_b16 v[178:179], v246 offset:4608
    ds_read_b64_tr_b16 v[180:181], v247 offset:4096
    ds_read_b64_tr_b16 v[182:183], v247 offset:4608
    s_mov_b32 m0, s69
    v_mfma_f32_32x32x16_bf16 v[16:31], v[76:79], v[184:187], v[16:31]
    buffer_load_dwordx4 v224, s[4:7], s45 offen sc1 lds
    buffer_load_dwordx4 v225, s[72:75], s45 offen offset:1024 sc1 lds
    s_waitcnt lgkmcnt(4)
    v_mad_u32_u16 v227, v226, s39, v248 op_sel:[1,0,0,0]
    v_mad_u32_u16 v226, v226, s39, v248
    v_mfma_f32_32x32x16_bf16 v[32:47], v[72:75], v[188:191], v[32:47]
    v_add_u32 v228, s51, v251
    ds_read_b32 v228, v228
    v_mul_f32 v242, v0, v144
    v_fma_f32 v238, v8, v160, -v238
    v_fmac_f32 v242, v1, v145
    v_fmac_f32 v238, v9, v161
    v_fmac_f32 v242, v2, v146
    v_mfma_f32_32x32x16_bf16 v[48:63], v[76:79], v[188:191], v[48:63]
    s_setprio 0
    v_fmac_f32 v238, v10, v162
    v_fmac_f32 v242, v3, v147
    v_fmac_f32 v238, v11, v163
    v_fmac_f32 v242, v4, v148
    v_fmac_f32 v238, v12, v164
    v_fmac_f32 v242, v5, v149
    v_fmac_f32 v238, v13, v165
    v_fmac_f32 v242, v6, v150
    v_fmac_f32 v238, v14, v166
    v_fmac_f32 v242, v7, v151
    v_fmac_f32 v238, v15, v167
    v_fmac_f32 v236, v16, v112
    v_mul_f32 v244, v24, v160
    v_fmac_f32 v236, v17, v113
    v_fmac_f32 v244, v25, v161
    v_fmac_f32 v236, v18, v114
    v_fmac_f32 v244, v26, v162
    v_fmac_f32 v236, v19, v115
    v_fmac_f32 v244, v27, v163
    v_fmac_f32 v236, v20, v116
    v_fmac_f32 v244, v28, v164
    v_fmac_f32 v236, v21, v117
    v_fmac_f32 v244, v29, v165
    v_fmac_f32 v236, v22, v118
    v_fmac_f32 v244, v30, v166
    v_fmac_f32 v236, v23, v119
    v_fmac_f32 v244, v31, v167
    v_mul_f32 v243, v32, v152
    v_fma_f32 v239, v40, v168, -v239
    v_fmac_f32 v243, v33, v153
    v_fmac_f32 v239, v41, v169
    v_fmac_f32 v243, v34, v154
    v_fmac_f32 v239, v42, v170
    v_fmac_f32 v243, v35, v155
    v_fmac_f32 v239, v43, v171
    v_fmac_f32 v243, v36, v156
    v_fmac_f32 v239, v44, v172
    v_fmac_f32 v243, v37, v157
    v_fmac_f32 v239, v45, v173
    v_fmac_f32 v243, v38, v158
    v_fmac_f32 v239, v46, v174
    v_fmac_f32 v243, v39, v159
    v_fmac_f32 v239, v47, v175
    v_fmac_f32 v237, v48, v120
    v_mul_f32 v245, v56, v168
    v_fmac_f32 v237, v49, v121
    v_fmac_f32 v245, v57, v169
    v_fmac_f32 v237, v50, v122
    s_setprio 1
    s_waitcnt vmcnt(4) lgkmcnt(1)
    v_mfma_f32_32x32x16_bf16 v[0:15], v[64:67], v[176:179], 0
    ds_read_b64_tr_b16 v[184:185], v246 offset:6144
    ds_read_b64_tr_b16 v[186:187], v246 offset:6656
    ds_read_b64_tr_b16 v[188:189], v247 offset:6144
    ds_read_b64_tr_b16 v[190:191], v247 offset:6656
    v_fmac_f32 v245, v58, v170
    v_fmac_f32 v237, v51, v123
    s_mov_b32 m0, s70
    v_mfma_f32_32x32x16_bf16 v[16:31], v[68:71], v[176:179], 0
    buffer_load_dwordx4 v226, s[4:7], s46 offen sc1 lds
    buffer_load_dwordx4 v227, s[72:75], s46 offen offset:1024 sc1 lds
    s_waitcnt lgkmcnt(4)
    v_mad_u32_u16 v229, v228, s39, v248 op_sel:[1,0,0,0]
    v_mad_u32_u16 v228, v228, s39, v248
    v_fmac_f32 v245, v59, v171
    v_fmac_f32 v237, v52, v124
    v_mfma_f32_32x32x16_bf16 v[32:47], v[64:67], v[180:183], 0
    v_fmac_f32 v245, v60, v172
    v_fmac_f32 v237, v53, v125
    v_fmac_f32 v245, v61, v173
    v_fmac_f32 v237, v54, v126
    v_fmac_f32 v245, v62, v174
    v_fmac_f32 v237, v55, v127
    v_fmac_f32 v245, v63, v175
    v_mfma_f32_32x32x16_bf16 v[48:63], v[68:71], v[180:183], 0
    v_permlane32_swap_b32 v242, v234
    v_permlane32_swap_b32 v243, v235
    v_add_f32 v242, v242, v234
    v_add_f32 v243, v243, v235
    s_waitcnt vmcnt(4) lgkmcnt(0)
    v_mfma_f32_32x32x16_bf16 v[0:15], v[72:75], v[184:187], v[0:15]
    ds_read_b64_tr_b16 v[176:177], v246 offset:0
    ds_read_b64_tr_b16 v[178:179], v246 offset:512
    ds_read_b64_tr_b16 v[180:181], v247 offset:0
    ds_read_b64_tr_b16 v[182:183], v247 offset:512
    v_cvt_pk_bf16_f32 v242, v242, v243
    ds_write_b32 v230, v242 offset:512
    s_mov_b32 m0, s71
    v_mfma_f32_32x32x16_bf16 v[16:31], v[76:79], v[184:187], v[16:31]
    buffer_load_dwordx4 v228, s[4:7], s47 offen sc1 lds
    buffer_load_dwordx4 v229, s[72:75], s47 offen offset:1024 sc1 lds
    s_sub_u32 s26, s48, s29
    s_mov_b32 s29, s48
    s_mov_b32 s30, s3
    s_cmp_lg_u32 s36, 0
    s_cselect_b32 s56, s33, 0
    v_mfma_f32_32x32x16_bf16 v[32:47], v[72:75], v[188:191], v[32:47]
    s_mov_b32 s32, s31
    s_mov_b32 s31, s35
    v_mul_f32 v242, v0, v144
    v_fma_f32 v240, v8, v160, -v240
    v_fmac_f32 v242, v1, v145
    v_fmac_f32 v240, v9, v161
    v_fmac_f32 v242, v2, v146
    v_mfma_f32_32x32x16_bf16 v[48:63], v[76:79], v[188:191], v[48:63]
    s_setprio 0
    v_fmac_f32 v240, v10, v162
    v_fmac_f32 v242, v3, v147
    v_fmac_f32 v240, v11, v163
    v_fmac_f32 v242, v4, v148
    v_fmac_f32 v240, v12, v164
    v_fmac_f32 v242, v5, v149
    v_fmac_f32 v240, v13, v165
    v_fmac_f32 v242, v6, v150
    v_fmac_f32 v240, v14, v166
    v_fmac_f32 v242, v7, v151
    v_fmac_f32 v240, v15, v167
    v_add_u32 v249, s26, v249
    v_add_u32 v250, s26, v250
    v_fma_f32 v244, v16, v160, -v244
    v_fmac_f32 v236, v24, v112
    v_fmac_f32 v244, v17, v161
    v_fmac_f32 v236, v25, v113
    v_fmac_f32 v244, v18, v162
    v_fmac_f32 v236, v26, v114
    v_fmac_f32 v244, v19, v163
    v_fmac_f32 v236, v27, v115
    v_fmac_f32 v244, v20, v164
    v_fmac_f32 v236, v28, v116
    v_fmac_f32 v244, v21, v165
    v_fmac_f32 v236, v29, v117
    v_fmac_f32 v244, v22, v166
    v_fmac_f32 v236, v30, v118
    v_fmac_f32 v244, v23, v167
    v_fmac_f32 v236, v31, v119
    ds_read_b64_tr_b16 v[0:1], v249 offset:0
    ds_read_b64_tr_b16 v[2:3], v249 offset:256
    ds_read_u16_d16_hi v16, v250 offset:0
    v_mul_f32 v243, v32, v152
    v_fma_f32 v241, v40, v168, -v241
    v_fmac_f32 v243, v33, v153
    v_fmac_f32 v241, v41, v169
    v_fmac_f32 v243, v34, v154
    v_fmac_f32 v241, v42, v170
    v_fmac_f32 v243, v35, v155
    v_fmac_f32 v241, v43, v171
    v_fmac_f32 v243, v36, v156
    v_fmac_f32 v241, v44, v172
    v_fmac_f32 v243, v37, v157
    v_fmac_f32 v241, v45, v173
    v_fmac_f32 v243, v38, v158
    v_fmac_f32 v241, v46, v174
    v_fmac_f32 v243, v39, v159
    v_fmac_f32 v241, v47, v175
    ds_read_b64_tr_b16 v[4:5], v249 offset:512
    ds_read_b64_tr_b16 v[6:7], v249 offset:768
    ds_read_u16_d16_hi v17, v250 offset:32
    v_fma_f32 v245, v48, v168, -v245
    v_fmac_f32 v237, v56, v120
    v_fmac_f32 v245, v49, v169
    v_fmac_f32 v237, v57, v121
    v_fmac_f32 v245, v50, v170
    v_fmac_f32 v237, v58, v122
    v_fmac_f32 v245, v51, v171
    v_fmac_f32 v237, v59, v123
    v_fmac_f32 v245, v52, v172
    v_fmac_f32 v237, v60, v124
    v_fmac_f32 v245, v53, v173
    v_fmac_f32 v237, v61, v125
    v_fmac_f32 v245, v54, v174
    v_fmac_f32 v237, v62, v126
    v_fmac_f32 v245, v55, v175
    v_fmac_f32 v237, v63, v127
    s_cmp_eq_u32 s56, 2
    s_cbranch_scc1 K2_U21
    s_cmp_eq_u32 s56, 3
    s_cbranch_scc1 K2_U31
    s_branch K2_DSP1
K2_PAD_U31:
    s_branch K2_HOP
K2_U31:
    s_setprio 1
    ds_read_b64_tr_b16 v[8:9], v249 offset:1024
    ds_read_b64_tr_b16 v[10:11], v249 offset:1280
    ds_read_u16_d16_hi v18, v250 offset:64
    s_waitcnt lgkmcnt(3)
    v_lshlrev_b32 v20, 16, v0
    v_and_b32 v21, 0xffff0000, v0
    v_lshlrev_b32 v22, 16, v1
    v_and_b32 v23, 0xffff0000, v1
    v_lshlrev_b32 v24, 16, v2
    v_and_b32 v25, 0xffff0000, v2
    v_lshlrev_b32 v26, 16, v3
    v_and_b32 v27, 0xffff0000, v3
    v_mul_f32_dpp v36, v16, v20 row_newbcast:8 row_mask:0xf bank_mask:0xf
    v_mul_f32_dpp v37, v16, v21 row_newbcast:9 row_mask:0xf bank_mask:0xf
    v_mul_f32_dpp v38, v16, v22 row_newbcast:10 row_mask:0xf bank_mask:0xf
    v_mul_f32_dpp v39, v16, v23 row_newbcast:11 row_mask:0xf bank_mask:0xf
    v_mul_f32_dpp v40, v16, v24 row_newbcast:12 row_mask:0xf bank_mask:0xf
    v_mul_f32_dpp v41, v16, v25 row_newbcast:13 row_mask:0xf bank_mask:0xf
    v_mul_f32_dpp v42, v16, v26 row_newbcast:14 row_mask:0xf bank_mask:0xf
    v_mul_f32_dpp v43, v16, v27 row_newbcast:15 row_mask:0xf bank_mask:0xf
    v_cvt_pk_bf16_f32 v68, v36, v37
    v_cvt_pk_bf16_f32 v69, v38, v39
    v_cvt_pk_bf16_f32 v70, v40, v41
    v_cvt_pk_bf16_f32 v71, v42, v43
    v_mul_f32_dpp v20, v16, v20 row_newbcast:0 row_mask:0xa bank_mask:0xf
    v_mul_f32_dpp v21, v16, v21 row_newbcast:1 row_mask:0xa bank_mask:0xf
    v_mul_f32_dpp v22, v16, v22 row_newbcast:2 row_mask:0xa bank_mask:0xf
    v_mul_f32_dpp v23, v16, v23 row_newbcast:3 row_mask:0xa bank_mask:0xf
    v_mul_f32_dpp v24, v16, v24 row_newbcast:4 row_mask:0xa bank_mask:0xf
    v_mul_f32_dpp v25, v16, v25 row_newbcast:5 row_mask:0xa bank_mask:0xf
    v_mul_f32_dpp v26, v16, v26 row_newbcast:6 row_mask:0xa bank_mask:0xf
    v_mul_f32_dpp v27, v16, v27 row_newbcast:7 row_mask:0xa bank_mask:0xf
    v_cvt_pk_bf16_f32 v64, v20, v21
    v_cvt_pk_bf16_f32 v65, v22, v23
    v_cvt_pk_bf16_f32 v66, v24, v25
    v_cvt_pk_bf16_f32 v67, v26, v27
    v_lshlrev_b32 v28, 16, v4
    v_and_b32 v29, 0xffff0000, v4
    v_lshlrev_b32 v30, 16, v5
    v_and_b32 v31, 0xffff0000, v5
    v_lshlrev_b32 v32, 16, v6
    v_and_b32 v33, 0xffff0000, v6
    v_lshlrev_b32 v34, 16, v7
    v_and_b32 v35, 0xffff0000, v7
    v_mul_f32_dpp v36, v17, v28 row_newbcast:8 row_mask:0xf bank_mask:0xf
    v_mul_f32_dpp v37, v17, v29 row_newbcast:9 row_mask:0xf bank_mask:0xf
    v_mul_f32_dpp v38, v17, v30 row_newbcast:10 row_mask:0xf bank_mask:0xf
    v_mul_f32_dpp v39, v17, v31 row_newbcast:11 row_mask:0xf bank_mask:0xf
    v_mul_f32_dpp v40, v17, v32 row_newbcast:12 row_mask:0xf bank_mask:0xf
    v_mul_f32_dpp v41, v17, v33 row_newbcast:13 row_mask:0xf bank_mask:0xf
    v_mul_f32_dpp v42, v17, v34 row_newbcast:14 row_mask:0xf bank_mask:0xf
    v_mul_f32_dpp v43, v17, v35 row_newbcast:15 row_mask:0xf bank_mask:0xf
    v_cvt_pk_bf16_f32 v76, v36, v37
    v_cvt_pk_bf16_f32 v77, v38, v39
    v_cvt_pk_bf16_f32 v78, v40, v41
    v_cvt_pk_bf16_f32 v79, v42, v43
    v_mul_f32_dpp v28, v17, v28 row_newbcast:0 row_mask:0xa bank_mask:0xf
    v_mul_f32_dpp v29, v17, v29 row_newbcast:1 row_mask:0xa bank_mask:0xf
    v_mul_f32_dpp v30, v17, v30 row_newbcast:2 row_mask:0xa bank_mask:0xf
    v_mul_f32_dpp v31, v17, v31 row_newbcast:3 row_mask:0xa bank_mask:0xf
    v_mul_f32_dpp v32, v17, v32 row_newbcast:4 row_mask:0xa bank_mask:0xf
    v_mul_f32_dpp v33, v17, v33 row_newbcast:5 row_mask:0xa bank_mask:0xf
    v_mul_f32_dpp v34, v17, v34 row_newbcast:6 row_mask:0xa bank_mask:0xf
    v_mul_f32_dpp v35, v17, v35 row_newbcast:7 row_mask:0xa bank_mask:0xf
    v_cvt_pk_bf16_f32 v72, v28, v29
    v_cvt_pk_bf16_f32 v73, v30, v31
    v_cvt_pk_bf16_f32 v74, v32, v33
    v_cvt_pk_bf16_f32 v75, v34, v35
    s_waitcnt lgkmcnt(0)
    v_lshlrev_b32 v20, 16, v8
    v_and_b32 v21, 0xffff0000, v8
    v_lshlrev_b32 v22, 16, v9
    v_and_b32 v23, 0xffff0000, v9
    v_lshlrev_b32 v24, 16, v10
    v_and_b32 v25, 0xffff0000, v10
    v_lshlrev_b32 v26, 16, v11
    v_and_b32 v27, 0xffff0000, v11
    v_mul_f32_dpp v36, v18, v20 row_newbcast:8 row_mask:0xf bank_mask:0xf
    v_mul_f32_dpp v37, v18, v21 row_newbcast:9 row_mask:0xf bank_mask:0xf
    v_mul_f32_dpp v38, v18, v22 row_newbcast:10 row_mask:0xf bank_mask:0xf
    v_mul_f32_dpp v39, v18, v23 row_newbcast:11 row_mask:0xf bank_mask:0xf
    v_mul_f32_dpp v40, v18, v24 row_newbcast:12 row_mask:0xf bank_mask:0xf
    v_mul_f32_dpp v41, v18, v25 row_newbcast:13 row_mask:0xf bank_mask:0xf
    v_mul_f32_dpp v42, v18, v26 row_newbcast:14 row_mask:0xf bank_mask:0xf
    v_mul_f32_dpp v43, v18, v27 row_newbcast:15 row_mask:0xf bank_mask:0xf
    v_cvt_pk_bf16_f32 v84, v36, v37
    v_cvt_pk_bf16_f32 v85, v38, v39
    v_cvt_pk_bf16_f32 v86, v40, v41
    v_cvt_pk_bf16_f32 v87, v42, v43
    v_mul_f32_dpp v20, v18, v20 row_newbcast:0 row_mask:0xa bank_mask:0xf
    v_mul_f32_dpp v21, v18, v21 row_newbcast:1 row_mask:0xa bank_mask:0xf
    v_mul_f32_dpp v22, v18, v22 row_newbcast:2 row_mask:0xa bank_mask:0xf
    v_mul_f32_dpp v23, v18, v23 row_newbcast:3 row_mask:0xa bank_mask:0xf
    v_mul_f32_dpp v24, v18, v24 row_newbcast:4 row_mask:0xa bank_mask:0xf
    v_mul_f32_dpp v25, v18, v25 row_newbcast:5 row_mask:0xa bank_mask:0xf
    v_mul_f32_dpp v26, v18, v26 row_newbcast:6 row_mask:0xa bank_mask:0xf
    v_mul_f32_dpp v27, v18, v27 row_newbcast:7 row_mask:0xa bank_mask:0xf
    v_cvt_pk_bf16_f32 v80, v20, v21
    v_cvt_pk_bf16_f32 v81, v22, v23
    v_cvt_pk_bf16_f32 v82, v24, v25
    v_cvt_pk_bf16_f32 v83, v26, v27
    s_waitcnt vmcnt(4)
    v_mfma_f32_32x32x16_bf16 v[0:15], v[64:67], v[176:179], 0
    ds_read_b64_tr_b16 v[184:185], v246 offset:2048
    ds_read_b64_tr_b16 v[186:187], v246 offset:2560
    ds_read_b64_tr_b16 v[188:189], v247 offset:2048
    ds_read_b64_tr_b16 v[190:191], v247 offset:2560
    s_mov_b32 m0, s68
    v_mfma_f32_32x32x16_bf16 v[16:31], v[68:71], v[176:179], 0
    buffer_load_dwordx4 v224, s[4:7], s41 offen sc1 lds
    buffer_load_dwordx4 v225, s[72:75], s41 offen offset:1024 sc1 lds
    v_permlane32_swap_b32 v242, v236
    v_permlane32_swap_b32 v243, v237
    v_mov_b32 v254, 163296
    v_mfma_f32_32x32x16_bf16 v[32:47], v[64:67], v[180:183], 0
    v_permlane32_swap_b32 v244, v238
    v_permlane32_swap_b32 v245, v239
    v_permlane32_swap_b32 v240, v241
    v_add_f32 v242, v242, v236
    v_mfma_f32_32x32x16_bf16 v[48:63], v[68:71], v[180:183], 0
    v_add_f32 v243, v243, v237
    v_add_f32 v244, v244, v238
    v_add_f32 v245, v245, v239
    v_add_f32 v240, -v240, -v241
    v_sub_u32 v241, v230, v231
    v_cvt_pk_bf16_f32 v242, v242, v243
    v_mov_b32 v255, 1
    v_lshl_add_u32 v233, v252, 1, s53
    s_mov_b64 exec, 1
    ds_add_rtn_u32 v232, v254, v255
    s_mov_b64 exec, -1
    ds_read_b32 v233, v233
    s_waitcnt vmcnt(4) lgkmcnt(2)
    v_mfma_f32_32x32x16_bf16 v[0:15], v[72:75], v[184:187], v[0:15]
    ds_read_b64_tr_b16 v[176:177], v246 offset:4096
    ds_read_b64_tr_b16 v[178:179], v246 offset:4608
    ds_read_b64_tr_b16 v[180:181], v247 offset:4096
    ds_read_b64_tr_b16 v[182:183], v247 offset:4608
    v_cvt_pk_bf16_f32 v244, v244, v245
    v_cvt_pk_bf16_f32 v240, v240, v240
    s_mov_b32 m0, s69
    v_mfma_f32_32x32x16_bf16 v[16:31], v[76:79], v[184:187], v[16:31]
    buffer_load_dwordx4 v226, s[4:7], s41 offen sc1 lds
    buffer_load_dwordx4 v227, s[72:75], s41 offen offset:1024 sc1 lds
    ds_write_b32 v230, v242 offset:768
    ds_write_b32 v230, v244 offset:1024
    ds_write_b16 v241, v240 offset:1280
    s_waitcnt lgkmcnt(7)
    v_readfirstlane_b32 s58, v232
    v_mfma_f32_32x32x16_bf16 v[32:47], v[72:75], v[188:191], v[32:47]
    s_cmp_lt_u32 s58, s22
    s_cbranch_scc0 K2_nul_41
    s_and_b32 s59, s58, 7
    s_lshr_b32 s60, s58, 3
K2_chk_43:
    v_readlane_b32 s61, v233, s59
    s_nop 0
    s_cmp_gt_u32 s61, s60
    s_cbranch_scc0 K2_spin_42
K2_back_44:
    v_mfma_f32_32x32x16_bf16 v[48:63], v[76:79], v[188:191], v[48:63]
    v_readlane_b32 s3, v253, s58
    s_lshl_b32 s44, s34, 7
    s_and_b32 s48, s3, 0x3ffff
    s_bfe_u32 s33, s3, 0x30012
    s_mov_b32 s35, s48
    s_mov_b32 s45, s44
    s_waitcnt vmcnt(4) lgkmcnt(3)
    v_mfma_f32_32x32x16_bf16 v[0:15], v[80:83], v[176:179], v[0:15]
    ds_read_b64_tr_b16 v[184:185], v246 offset:6144
    ds_read_b64_tr_b16 v[186:187], v246 offset:6656
    ds_read_b64_tr_b16 v[188:189], v247 offset:6144
    ds_read_b64_tr_b16 v[190:191], v247 offset:6656
    s_add_u32 s47, s44, 256
    s_add_u32 s49, s48, 32
    s_mov_b32 m0, s70
    v_mfma_f32_32x32x16_bf16 v[16:31], v[84:87], v[176:179], v[16:31]
    buffer_load_dwordx4 v222, s[4:7], s42 offen sc1 lds
    buffer_load_dwordx4 v223, s[72:75], s42 offen offset:1024 sc1 lds
    s_add_u32 s60, s48, 64
    s_cmp_eq_u32 s33, 3
    s_cselect_b32 s46, s44, s47
    s_cselect_b32 s50, s60, s48
    s_cselect_b32 s51, s48, s49
    v_mfma_f32_32x32x16_bf16 v[32:47], v[80:83], v[180:183], v[32:47]
    s_sub_u32 s60, s33, 2
    s_cmp_lt_u32 s60, 2
    s_cbranch_scc0 K2_rare_45
K2_back_46:
    v_mul_f32 v234, v0, v96
    v_mul_f32 v236, v8, v128
    v_fmac_f32 v234, v1, v97
    v_fmac_f32 v236, v9, v129
    v_mfma_f32_32x32x16_bf16 v[48:63], v[84:87], v[180:183], v[48:63]
    s_setprio 0
    v_fmac_f32 v234, v2, v98
    v_fmac_f32 v236, v10, v130
    v_fmac_f32 v234, v3, v99
    v_fmac_f32 v236, v11, v131
    v_fmac_f32 v234, v4, v100
    v_fmac_f32 v236, v12, v132
    v_fmac_f32 v234, v5, v101
    v_fmac_f32 v236, v13, v133
    v_fmac_f32 v234, v6, v102
    v_fmac_f32 v236, v14, v134
    v_fmac_f32 v234, v7, v103
    v_fmac_f32 v236, v15, v135
    v_mul_f32 v238, v16, v128
    v_mul_f32 v240, v24, v128
    v_fmac_f32 v238, v17, v129
    v_fmac_f32 v240, v25, v129
    v_fmac_f32 v238, v18, v130
    v_fmac_f32 v240, v26, v130
    v_fmac_f32 v238, v19, v131
    v_fmac_f32 v240, v27, v131
    v_fmac_f32 v238, v20, v132
    v_fmac_f32 v240, v28, v132
    v_fmac_f32 v238, v21, v133
    v_fmac_f32 v240, v29, v133
    v_fmac_f32 v238, v22, v134
    v_fmac_f32 v240, v30, v134
    v_fmac_f32 v238, v23, v135
    v_fmac_f32 v240, v31, v135
    v_mul_f32 v235, v32, v104
    v_mul_f32 v237, v40, v136
    v_fmac_f32 v235, v33, v105
    v_fmac_f32 v237, v41, v137
    v_fmac_f32 v235, v34, v106
    v_fmac_f32 v237, v42, v138
    v_fmac_f32 v235, v35, v107
    v_fmac_f32 v237, v43, v139
    v_fmac_f32 v235, v36, v108
    v_fmac_f32 v237, v44, v140
    v_fmac_f32 v235, v37, v109
    v_fmac_f32 v237, v45, v141
    v_fmac_f32 v235, v38, v110
    v_fmac_f32 v237, v46, v142
    v_fmac_f32 v235, v39, v111
    v_fmac_f32 v237, v47, v143
    v_mul_f32 v239, v48, v136
    v_mul_f32 v241, v56, v136
    s_setprio 1
    s_waitcnt vmcnt(4) lgkmcnt(0)
    v_mfma_f32_32x32x16_bf16 v[0:15], v[64:67], v[184:187], 0
    ds_read_b64_tr_b16 v[176:177], v246 offset:0
    ds_read_b64_tr_b16 v[178:179], v246 offset:512
    ds_read_b64_tr_b16 v[180:181], v247 offset:0
    ds_read_b64_tr_b16 v[182:183], v247 offset:512
    v_fmac_f32 v239, v49, v137
    v_fmac_f32 v241, v57, v137
    s_mov_b32 m0, s71
    v_mfma_f32_32x32x16_bf16 v[16:31], v[68:71], v[184:187], 0
    buffer_load_dwordx4 v224, s[4:7], s42 offen sc1 lds
    buffer_load_dwordx4 v225, s[72:75], s42 offen offset:1024 sc1 lds
    v_fmac_f32 v239, v50, v138
    v_fmac_f32 v241, v58, v138
    v_fmac_f32 v239, v51, v139
    v_fmac_f32 v241, v59, v139
    v_fmac_f32 v239, v52, v140
    v_mfma_f32_32x32x16_bf16 v[32:47], v[64:67], v[188:191], 0
    v_fmac_f32 v241, v60, v140
    v_fmac_f32 v239, v53, v141
    v_fmac_f32 v241, v61, v141
    v_fmac_f32 v239, v54, v142
    v_fmac_f32 v241, v62, v142
    v_fmac_f32 v239, v55, v143
    v_fmac_f32 v241, v63, v143
    v_mfma_f32_32x32x16_bf16 v[48:63], v[68:71], v[188:191], 0
    v_permlane32_swap_b32 v234, v236
    v_permlane32_swap_b32 v235, v237
    v_permlane32_swap_b32 v240, v238
    s_waitcnt vmcnt(4) lgkmcnt(0)
    v_mfma_f32_32x32x16_bf16 v[0:15], v[72:75], v[176:179], v[0:15]
    ds_read_b64_tr_b16 v[184:185], v246 offset:2048
    ds_read_b64_tr_b16 v[186:187], v246 offset:2560
    ds_read_b64_tr_b16 v[188:189], v247 offset:2048
    ds_read_b64_tr_b16 v[190:191], v247 offset:2560
    v_permlane32_swap_b32 v241, v239
    s_mov_b32 m0, s68
    v_mfma_f32_32x32x16_bf16 v[16:31], v[76:79], v[176:179], v[16:31]
    buffer_load_dwordx4 v226, s[4:7], s42 offen sc1 lds
    buffer_load_dwordx4 v227, s[72:75], s42 offen offset:1024 sc1 lds
    v_lshl_add_u32 v230, v252, 1, s31
    v_add_f32 v234, v234, v236
    v_add_f32 v235, v235, v237
    v_add_f32 v240, v240, v238
    v_add_f32 v241, v241, v239
    v_mfma_f32_32x32x16_bf16 v[32:47], v[72:75], v[180:183], v[32:47]
    v_cvt_pk_bf16_f32 v234, v234, v235
    v_cvt_pk_bf16_f32 v240, v240, v241
    ds_write_b32 v230, v234 offset:0
    ds_write_b32 v230, v240 offset:256
    v_mfma_f32_32x32x16_bf16 v[48:63], v[76:79], v[180:183], v[48:63]
    s_waitcnt vmcnt(4) lgkmcnt(2)
    v_mfma_f32_32x32x16_bf16 v[0:15], v[80:83], v[184:187], v[0:15]
    ds_read_b64_tr_b16 v[176:177], v246 offset:4096
    ds_read_b64_tr_b16 v[178:179], v246 offset:4608
    ds_read_b64_tr_b16 v[180:181], v247 offset:4096
    ds_read_b64_tr_b16 v[182:183], v247 offset:4608
    s_mov_b32 m0, s69
    v_mfma_f32_32x32x16_bf16 v[16:31], v[84:87], v[184:187], v[16:31]
    buffer_load_dwordx4 v222, s[4:7], s43 offen sc1 lds
    buffer_load_dwordx4 v223, s[72:75], s43 offen offset:1024 sc1 lds
    v_mfma_f32_32x32x16_bf16 v[32:47], v[80:83], v[188:191], v[32:47]
    s_nop 2
    v_mul_f32 v234, v0, v144
    v_mul_f32 v236, v8, v112
    v_fmac_f32 v234, v1, v145
    v_fmac_f32 v236, v9, v113
    v_fmac_f32 v234, v2, v146
    v_fmac_f32 v236, v10, v114
    v_fmac_f32 v234, v3, v147
    v_mfma_f32_32x32x16_bf16 v[48:63], v[84:87], v[188:191], v[48:63]
    s_setprio 0
    v_fmac_f32 v236, v11, v115
    v_fmac_f32 v234, v4, v148
    v_fmac_f32 v236, v12, v116
    v_fmac_f32 v234, v5, v149
    v_fmac_f32 v236, v13, v117
    v_fmac_f32 v234, v6, v150
    v_fmac_f32 v236, v14, v118
    v_fmac_f32 v234, v7, v151
    v_fmac_f32 v236, v15, v119
    v_mul_f32 v238, v16, v160
    v_mul_f32 v240, v24, v160
    v_fmac_f32 v238, v17, v161
    v_fmac_f32 v240, v25, v161
    v_fmac_f32 v238, v18, v162
    v_fmac_f32 v240, v26, v162
    v_fmac_f32 v238, v19, v163
    v_fmac_f32 v240, v27, v163
    v_fmac_f32 v238, v20, v164
    v_fmac_f32 v240, v28, v164
    v_fmac_f32 v238, v21, v165
    v_fmac_f32 v240, v29, v165
    v_fmac_f32 v238, v22, v166
    v_fmac_f32 v240, v30, v166
    v_fmac_f32 v238, v23, v167
    v_fmac_f32 v240, v31, v167
    v_mul_f32 v235, v32, v152
    v_mul_f32 v237, v40, v120
    v_fmac_f32 v235, v33, v153
    v_fmac_f32 v237, v41, v121
    v_fmac_f32 v235, v34, v154
    v_fmac_f32 v237, v42, v122
    v_fmac_f32 v235, v35, v155
    v_fmac_f32 v237, v43, v123
    v_fmac_f32 v235, v36, v156
    v_fmac_f32 v237, v44, v124
    v_fmac_f32 v235, v37, v157
    v_fmac_f32 v237, v45, v125
    v_fmac_f32 v235, v38, v158
    v_fmac_f32 v237, v46, v126
    v_fmac_f32 v235, v39, v159
    v_fmac_f32 v237, v47, v127
    v_mul_f32 v239, v48, v168
    v_mul_f32 v241, v56, v168
    v_fmac_f32 v239, v49, v169
    v_fmac_f32 v241, v57, v169
    s_setprio 1
    s_waitcnt vmcnt(4) lgkmcnt(0)
    v_mfma_f32_32x32x16_bf16 v[0:15], v[64:67], v[176:179], 0
    ds_read_b64_tr_b16 v[184:185], v246 offset:6144
    ds_read_b64_tr_b16 v[186:187], v246 offset:6656
    ds_read_b64_tr_b16 v[188:189], v247 offset:6144
    ds_read_b64_tr_b16 v[190:191], v247 offset:6656
    v_fmac_f32 v239, v50, v170
    v_fmac_f32 v241, v58, v170
    s_mov_b32 m0, s70
    v_mfma_f32_32x32x16_bf16 v[16:31], v[68:71], v[176:179], 0
    buffer_load_dwordx4 v224, s[4:7], s43 offen sc1 lds
    buffer_load_dwordx4 v225, s[72:75], s43 offen offset:1024 sc1 lds
    v_fmac_f32 v239, v51, v171
    v_fmac_f32 v241, v59, v171
    v_fmac_f32 v239, v52, v172
    v_fmac_f32 v241, v60, v172
    v_fmac_f32 v239, v53, v173
    v_mfma_f32_32x32x16_bf16 v[32:47], v[64:67], v[180:183], 0
    v_add_u32 v222, s48, v251
    ds_read_b32 v222, v222
    v_fmac_f32 v241, v61, v173
    v_fmac_f32 v239, v54, v174
    v_fmac_f32 v241, v62, v174
    v_fmac_f32 v239, v55, v175
    v_fmac_f32 v241, v63, v175
    v_mfma_f32_32x32x16_bf16 v[48:63], v[68:71], v[180:183], 0
    s_waitcnt vmcnt(4) lgkmcnt(1)
    v_mfma_f32_32x32x16_bf16 v[0:15], v[72:75], v[184:187], v[0:15]
    ds_read_b64_tr_b16 v[176:177], v246 offset:0
    ds_read_b64_tr_b16 v[178:179], v246 offset:512
    ds_read_b64_tr_b16 v[180:181], v247 offset:0
    ds_read_b64_tr_b16 v[182:183], v247 offset:512
    s_mov_b32 m0, s71
    v_mfma_f32_32x32x16_bf16 v[16:31], v[76:79], v[184:187], v[16:31]
    buffer_load_dwordx4 v226, s[4:7], s43 offen sc1 lds
    buffer_load_dwordx4 v227, s[72:75], s43 offen offset:1024 sc1 lds
    s_waitcnt lgkmcnt(4)
    v_mad_u32_u16 v223, v222, s39, v248 op_sel:[1,0,0,0]
    v_mad_u32_u16 v222, v222, s39, v248
    v_mfma_f32_32x32x16_bf16 v[32:47], v[72:75], v[188:191], v[32:47]
    v_add_u32 v224, s49, v251
    ds_read_b32 v224, v224
    v_mfma_f32_32x32x16_bf16 v[48:63], v[76:79], v[188:191], v[48:63]
    s_waitcnt vmcnt(4) lgkmcnt(1)
    v_mfma_f32_32x32x16_bf16 v[0:15], v[80:83], v[176:179], v[0:15]
    ds_read_b64_tr_b16 v[184:185], v246 offset:2048
    ds_read_b64_tr_b16 v[186:187], v246 offset:2560
    ds_read_b64_tr_b16 v[188:189], v247 offset:2048
    ds_read_b64_tr_b16 v[190:191], v247 offset:2560
    s_mov_b32 m0, s68
    v_mfma_f32_32x32x16_bf16 v[16:31], v[84:87], v[176:179], v[16:31]
    buffer_load_dwordx4 v222, s[4:7], s44 offen sc1 lds
    buffer_load_dwordx4 v223, s[72:75], s44 offen offset:1024 sc1 lds
    s_waitcnt lgkmcnt(4)
    v_mad_u32_u16 v225, v224, s39, v248 op_sel:[1,0,0,0]
    v_mad_u32_u16 v224, v224, s39, v248
    v_mfma_f32_32x32x16_bf16 v[32:47], v[80:83], v[180:183], v[32:47]
    v_add_u32 v226, s50, v251
    ds_read_b32 v226, v226
    v_mul_f32 v242, v0, v144
    v_fma_f32 v238, v8, v160, -v238
    v_fmac_f32 v242, v1, v145
    v_fmac_f32 v238, v9, v161
    v_fmac_f32 v242, v2, v146
    v_mfma_f32_32x32x16_bf16 v[48:63], v[84:87], v[180:183], v[48:63]
    s_setprio 0
    v_fmac_f32 v238, v10, v162
    v_fmac_f32 v242, v3, v147
    v_fmac_f32 v238, v11, v163
    v_fmac_f32 v242, v4, v148
    v_fmac_f32 v238, v12, v164
    v_fmac_f32 v242, v5, v149
    v_fmac_f32 v238, v13, v165
    v_fmac_f32 v242, v6, v150
    v_fmac_f32 v238, v14, v166
    v_fmac_f32 v242, v7, v151
    v_fmac_f32 v238, v15, v167
    v_fmac_f32 v236, v16, v112
    v_mul_f32 v244, v24, v160
    v_fmac_f32 v236, v17, v113
    v_fmac_f32 v244, v25, v161
    v_fmac_f32 v236, v18, v114
    v_fmac_f32 v244, v26, v162
    v_fmac_f32 v236, v19, v115
    v_fmac_f32 v244, v27, v163
    v_fmac_f32 v236, v20, v116
    v_fmac_f32 v244, v28, v164
    v_fmac_f32 v236, v21, v117
    v_fmac_f32 v244, v29, v165
    v_fmac_f32 v236, v22, v118
    v_fmac_f32 v244, v30, v166
    v_fmac_f32 v236, v23, v119
    v_fmac_f32 v244, v31, v167
    v_mul_f32 v243, v32, v152
    v_fma_f32 v239, v40, v168, -v239
    v_fmac_f32 v243, v33, v153
    v_fmac_f32 v239, v41, v169
    v_fmac_f32 v243, v34, v154
    v_fmac_f32 v239, v42, v170
    v_fmac_f32 v243, v35, v155
    v_fmac_f32 v239, v43, v171
    v_fmac_f32 v243, v36, v156
    v_fmac_f32 v239, v44, v172
    v_fmac_f32 v243, v37, v157
    v_fmac_f32 v239, v45, v173
    v_fmac_f32 v243, v38, v158
    v_fmac_f32 v239, v46, v174
    v_fmac_f32 v243, v39, v159
    v_fmac_f32 v239, v47, v175
    v_fmac_f32 v237, v48, v120
    v_mul_f32 v245, v56, v168
    v_fmac_f32 v237, v49, v121
    v_fmac_f32 v245, v57, v169
    v_fmac_f32 v237, v50, v122
    v_fmac_f32 v245, v58, v170
    v_fmac_f32 v237, v51, v123
    s_setprio 1
    s_waitcnt vmcnt(4) lgkmcnt(1)
    v_mfma_f32_32x32x16_bf16 v[0:15], v[64:67], v[184:187], 0
    ds_read_b64_tr_b16 v[176:177], v246 offset:4096
    ds_read_b64_tr_b16 v[178:179], v246 offset:4608
    ds_read_b64_tr_b16 v[180:181], v247 offset:4096
    ds_read_b64_tr_b16 v[182:183], v247 offset:4608
    v_fmac_f32 v245, v59, v171
    v_fmac_f32 v237, v52, v124
    s_mov_b32 m0, s69
    v_mfma_f32_32x32x16_bf16 v[16:31], v[68:71], v[184:187], 0
    buffer_load_dwordx4 v224, s[4:7], s45 offen sc1 lds
    buffer_load_dwordx4 v225, s[72:75], s45 offen offset:1024 sc1 lds
    s_waitcnt lgkmcnt(4)
    v_mad_u32_u16 v227, v226, s39, v248 op_sel:[1,0,0,0]
    v_mad_u32_u16 v226, v226, s39, v248
    v_fmac_f32 v245, v60, v172
    v_fmac_f32 v237, v53, v125
    v_mfma_f32_32x32x16_bf16 v[32:47], v[64:67], v[188:191], 0
    v_add_u32 v228, s51, v251
    ds_read_b32 v228, v228
    v_fmac_f32 v245, v61, v173
    v_fmac_f32 v237, v54, v126
    v_fmac_f32 v245, v62, v174
    v_fmac_f32 v237, v55, v127
    v_fmac_f32 v245, v63, v175
    v_mfma_f32_32x32x16_bf16 v[48:63], v[68:71], v[188:191], 0
    v_permlane32_swap_b32 v242, v234
    v_permlane32_swap_b32 v243, v235
    v_add_f32 v242, v242, v234
    v_add_f32 v243, v243, v235
    s_waitcnt vmcnt(4) lgkmcnt(1)
    v_mfma_f32_32x32x16_bf16 v[0:15], v[72:75], v[176:179], v[0:15]
    ds_read_b64_tr_b16 v[184:185], v246 offset:6144
    ds_read_b64_tr_b16 v[186:187], v246 offset:6656
    ds_read_b64_tr_b16 v[188:189], v247 offset:6144
    ds_read_b64_tr_b16 v[190:191], v247 offset:6656
    v_cvt_pk_bf16_f32 v242, v242, v243
    ds_write_b32 v230, v242 offset:512
    s_mov_b32 m0, s70
    v_mfma_f32_32x32x16_bf16 v[16:31], v[76:79], v[176:179], v[16:31]
    buffer_load_dwordx4 v226, s[4:7], s46 offen sc1 lds
    buffer_load_dwordx4 v227, s[72:75], s46 offen offset:1024 sc1 lds
    s_waitcnt lgkmcnt(5)
    v_mad_u32_u16 v229, v228, s39, v248 op_sel:[1,0,0,0]
    v_mad_u32_u16 v228, v228, s39, v248
    s_sub_u32 s26, s48, s29
    s_mov_b32 s29, s48
    v_mfma_f32_32x32x16_bf16 v[32:47], v[72:75], v[180:183], v[32:47]
    s_mov_b32 s30, s3
    s_cmp_lg_u32 s36, 0
    s_cselect_b32 s56, s33, 0
    s_mov_b32 s32, s31
    s_mov_b32 s31, s35
    v_mfma_f32_32x32x16_bf16 v[48:63], v[76:79], v[180:183], v[48:63]
    s_waitcnt vmcnt(4) lgkmcnt(1)
    v_mfma_f32_32x32x16_bf16 v[0:15], v[80:83], v[184:187], v[0:15]
    ds_read_b64_tr_b16 v[176:177], v246 offset:0
    ds_read_b64_tr_b16 v[178:179], v246 offset:512
    ds_read_b64_tr_b16 v[180:181], v247 offset:0
    ds_read_b64_tr_b16 v[182:183], v247 offset:512
    s_mov_b32 m0, s71
    v_mfma_f32_32x32x16_bf16 v[16:31], v[84:87], v[184:187], v[16:31]
    buffer_load_dwordx4 v228, s[4:7], s47 offen sc1 lds
    buffer_load_dwordx4 v229, s[72:75], s47 offen offset:1024 sc1 lds
    v_mfma_f32_32x32x16_bf16 v[32:47], v[80:83], v[188:191], v[32:47]
    s_nop 2
    v_mul_f32 v242, v0, v144
    v_fma_f32 v240, v8, v160, -v240
    v_fmac_f32 v242, v1, v145
    v_fmac_f32 v240, v9, v161
    v_fmac_f32 v242, v2, v146
    v_fmac_f32 v240, v10, v162
    v_fmac_f32 v242, v3, v147
    v_mfma_f32_32x32x16_bf16 v[48:63], v[84:87], v[188:191], v[48:63]
    s_setprio 0
    v_fmac_f32 v240, v11, v163
    v_fmac_f32 v242, v4, v148
    v_fmac_f32 v240, v12, v164
    v_fmac_f32 v242, v5, v149
    v_fmac_f32 v240, v13, v165
    v_fmac_f32 v242, v6, v150
    v_fmac_f32 v240, v14, v166
    v_fmac_f32 v242, v7, v151
    v_fmac_f32 v240, v15, v167
    v_add_u32 v249, s26, v249
    v_add_u32 v250, s26, v250
    v_fma_f32 v244, v16, v160, -v244
    v_fmac_f32 v236, v24, v112
    v_fmac_f32 v244, v17, v161
    v_fmac_f32 v236, v25, v113
    v_fmac_f32 v244, v18, v162
    v_fmac_f32 v236, v26, v114
    v_fmac_f32 v244, v19, v163
    v_fmac_f32 v236, v27, v115
    v_fmac_f32 v244, v20, v164
    v_fmac_f32 v236, v28, v116
    v_fmac_f32 v244, v21, v165
    v_fmac_f32 v236, v29, v117
    v_fmac_f32 v244, v22, v166
    v_fmac_f32 v236, v30, v118
    v_fmac_f32 v244, v23, v167
    v_fmac_f32 v236, v31, v119
    ds_read_b64_tr_b16 v[0:1], v249 offset:0
    ds_read_b64_tr_b16 v[2:3], v249 offset:256
    ds_read_u16_d16_hi v16, v250 offset:0
    v_mul_f32 v243, v32, v152
    v_fma_f32 v241, v40, v168, -v241
    v_fmac_f32 v243, v33, v153
    v_fmac_f32 v241, v41, v169
    v_fmac_f32 v243, v34, v154
    v_fmac_f32 v241, v42, v170
    v_fmac_f32 v243, v35, v155
    v_fmac_f32 v241, v43, v171
    v_fmac_f32 v243, v36, v156
    v_fmac_f32 v241, v44, v172
    v_fmac_f32 v243, v37, v157
    v_fmac_f32 v241, v45, v173
    v_fmac_f32 v243, v38, v158
    v_fmac_f32 v241, v46, v174
    v_fmac_f32 v243, v39, v159
    v_fmac_f32 v241, v47, v175
    ds_read_b64_tr_b16 v[4:5], v249 offset:512
    ds_read_b64_tr_b16 v[6:7], v249 offset:768
    ds_read_u16_d16_hi v17, v250 offset:32
    v_fma_f32 v245, v48, v168, -v245
    v_fmac_f32 v237, v56, v120
    v_fmac_f32 v245, v49, v169
    v_fmac_f32 v237, v57, v121
    v_fmac_f32 v245, v50, v170
    v_fmac_f32 v237, v58, v122
    v_fmac_f32 v245, v51, v171
    v_fmac_f32 v237, v59, v123
    v_fmac_f32 v245, v52, v172
    v_fmac_f32 v237, v60, v124
    v_fmac_f32 v245, v53, v173
    v_fmac_f32 v237, v61, v125
    v_fmac_f32 v245, v54, v174
    v_fmac_f32 v237, v62, v126
    v_fmac_f32 v245, v55, v175
    v_fmac_f32 v237, v63, v127
    s_cmp_eq_u32 s56, 2
    s_cbranch_scc1 K2_U21
    s_cmp_eq_u32 s56, 3
    s_cbranch_scc1 K2_U31
    s_branch K2_DSP1
K2_PAD_SW:
    s_branch K2_HOP
K2_DSP0:
    s_cmp_eq_u32 s56, 1
    s_cbranch_scc1 K2_U10
    s_cmp_eq_u32 s56, 4
    s_cbranch_scc1 K2_U40
    s_branch K2_SWITCH
K2_DSP1:
    s_cmp_eq_u32 s56, 1
    s_cbranch_scc1 K2_U11
    s_cmp_eq_u32 s56, 4
    s_cbranch_scc1 K2_U41
    s_branch K2_TAIL
K2_SWITCH:
    v_permlane32_swap_b32 v242, v236
    v_permlane32_swap_b32 v243, v237
    v_permlane32_swap_b32 v244, v238
    v_permlane32_swap_b32 v245, v239
    v_permlane32_swap_b32 v240, v241
    v_add_f32 v242, v242, v236
    v_add_f32 v243, v243, v237
    v_add_f32 v244, v244, v238
    v_add_f32 v245, v245, v239
    v_add_f32 v240, -v240, -v241
    s_set_gpr_idx_on s32, gpr_idx(DST)
    s_nop 0
    v_cvt_pk_bf16_f32 v195, v242, v243
    v_cvt_pk_bf16_f32 v196, v244, v245
    v_cvt_pk_bf16_f32 v197, v240, v240
    s_set_gpr_idx_off
    s_cmp_eq_u32 s36, 0
    s_cbranch_scc1 K2_TAIL2
    v_lshl_add_u32 v230, v252, 1, s35
    v_lshrrev_b32 v231, 6, v252
    v_mul_u32_u24 v231, 126, v231
    v_lshrrev_b32 v254, 6, v252
    v_bfe_u32 v255, v252, 3, 2
    v_lshl_add_u32 v254, v254, 2, v255
    v_mul_u32_u24 v254, 640, v254
    v_bfe_u32 v255, v252, 5, 1
    v_lshl_add_u32 v254, v255, 5, v254
    v_and_b32 v255, 6, v252
    v_lshl_add_u32 v254, v255, 2, v254
    v_add_u32 v254, 152832, v254
    ds_read_b64_tr_b16 v[104:105], v254 offset:0
    ds_read_b64_tr_b16 v[106:107], v254 offset:5120
    ds_read_b64_tr_b16 v[108:109], v254 offset:64
    ds_read_b64_tr_b16 v[110:111], v254 offset:5184
    ds_read_b64_tr_b16 v[120:121], v254 offset:128
    ds_read_b64_tr_b16 v[122:123], v254 offset:5248
    ds_read_b64_tr_b16 v[124:125], v254 offset:192
    ds_read_b64_tr_b16 v[126:127], v254 offset:5312
    ds_read_b64_tr_b16 v[136:137], v254 offset:256
    ds_read_b64_tr_b16 v[138:139], v254 offset:5376
    ds_read_b64_tr_b16 v[140:141], v254 offset:320
    ds_read_b64_tr_b16 v[142:143], v254 offset:5440
    ds_read_b64_tr_b16 v[152:153], v254 offset:384
    ds_read_b64_tr_b16 v[154:155], v254 offset:5504
    ds_read_b64_tr_b16 v[156:157], v254 offset:448
    ds_read_b64_tr_b16 v[158:159], v254 offset:5568
    ds_read_b64_tr_b16 v[168:169], v254 offset:512
    ds_read_b64_tr_b16 v[170:171], v254 offset:5632
    ds_read_b64_tr_b16 v[172:173], v254 offset:576
    ds_read_b64_tr_b16 v[174:175], v254 offset:5696
    s_movk_i32 s40, 128
    s_movk_i32 s41, 384
    s_movk_i32 s42, 640
    s_movk_i32 s43, 896
    s_waitcnt lgkmcnt(15)
    v_lshlrev_b32 v96, 16, v104
    v_and_b32 v97, 0xffff0000, v104
    v_lshlrev_b32 v98, 16, v105
    v_and_b32 v99, 0xffff0000, v105
    v_lshlrev_b32 v100, 16, v106
    v_and_b32 v101, 0xffff0000, v106
    v_lshlrev_b32 v102, 16, v107
    v_and_b32 v103, 0xffff0000, v107
    v_lshlrev_b32 v104, 16, v108
    v_and_b32 v105, 0xffff0000, v108
    v_lshlrev_b32 v106, 16, v109
    v_and_b32 v107, 0xffff0000, v109
    v_lshlrev_b32 v108, 16, v110
    v_and_b32 v109, 0xffff0000, v110
    v_lshlrev_b32 v110, 16, v111
    v_and_b32 v111, 0xffff0000, v111
    s_waitcnt lgkmcnt(12)
    v_lshlrev_b32 v112, 16, v120
    v_and_b32 v113, 0xffff0000, v120
    v_lshlrev_b32 v114, 16, v121
    v_and_b32 v115, 0xffff0000, v121
    v_lshlrev_b32 v116, 16, v122
    v_and_b32 v117, 0xffff0000, v122
    v_lshlrev_b32 v118, 16, v123
    v_and_b32 v119, 0xffff0000, v123
    v_lshlrev_b32 v120, 16, v124
    v_and_b32 v121, 0xffff0000, v124
    v_lshlrev_b32 v122, 16, v125
    v_and_b32 v123, 0xffff0000, v125
    v_lshlrev_b32 v124, 16, v126
    v_and_b32 v125, 0xffff0000, v126
    v_lshlrev_b32 v126, 16, v127
    v_and_b32 v127, 0xffff0000, v127
    s_waitcnt lgkmcnt(8)
    v_lshlrev_b32 v128, 16, v136
    v_and_b32 v129, 0xffff0000, v136
    v_lshlrev_b32 v130, 16, v137
    v_and_b32 v131, 0xffff0000, v137
    v_lshlrev_b32 v132, 16, v138
    v_and_b32 v133, 0xffff0000, v138
    v_lshlrev_b32 v134, 16, v139
    v_and_b32 v135, 0xffff0000, v139
    v_lshlrev_b32 v136, 16, v140
    v_and_b32 v137, 0xffff0000, v140
    v_lshlrev_b32 v138, 16, v141
    v_and_b32 v139, 0xffff0000, v141
    v_lshlrev_b32 v140, 16, v142
    v_and_b32 v141, 0xffff0000, v142
    v_lshlrev_b32 v142, 16, v143
    v_and_b32 v143, 0xffff0000, v143
    s_waitcnt lgkmcnt(4)
    v_lshlrev_b32 v144, 16, v152
    v_and_b32 v145, 0xffff0000, v152
    v_lshlrev_b32 v146, 16, v153
    v_and_b32 v147, 0xffff0000, v153
    v_lshlrev_b32 v148, 16, v154
    v_and_b32 v149, 0xffff0000, v154
    v_lshlrev_b32 v150, 16, v155
    v_and_b32 v151, 0xffff0000, v155
    v_lshlrev_b32 v152, 16, v156
    v_and_b32 v153, 0xffff0000, v156
    v_lshlrev_b32 v154, 16, v157
    v_and_b32 v155, 0xffff0000, v157
    v_lshlrev_b32 v156, 16, v158
    v_and_b32 v157, 0xffff0000, v158
    v_lshlrev_b32 v158, 16, v159
    v_and_b32 v159, 0xffff0000, v159
    s_waitcnt lgkmcnt(0)
    v_lshlrev_b32 v160, 16, v168
    v_and_b32 v161, 0xffff0000, v168
    v_lshlrev_b32 v162, 16, v169
    v_and_b32 v163, 0xffff0000, v169
    v_lshlrev_b32 v164, 16, v170
    v_and_b32 v165, 0xffff0000, v170
    v_lshlrev_b32 v166, 16, v171
    v_and_b32 v167, 0xffff0000, v171
    v_lshlrev_b32 v168, 16, v172
    v_and_b32 v169, 0xffff0000, v172
    v_lshlrev_b32 v170, 16, v173
    v_and_b32 v171, 0xffff0000, v173
    v_lshlrev_b32 v172, 16, v174
    v_and_b32 v173, 0xffff0000, v174
    v_lshlrev_b32 v174, 16, v175
    v_and_b32 v175, 0xffff0000, v175
    s_mov_b32 s29, s48
    s_mov_b32 s32, s31
    s_mov_b32 s30, s3
    s_mov_b32 s31, s35
    s_cmp_eq_u32 s33, 2
    s_cbranch_scc1 K2_U21
    s_cmp_eq_u32 s33, 3
    s_cbranch_scc1 K2_U31
    s_cmp_eq_u32 s33, 1
    s_cbranch_scc1 K2_U11
    s_branch K2_U41
K2_dum_4:
    v_mov_b32 v232, -1
    s_mov_b32 m0, 163360
    s_mov_b64 exec, 1
    buffer_load_dwordx4 v232, s[16:19], 0 offen lds
    buffer_load_dwordx4 v232, s[16:19], 0 offen lds
    s_mov_b64 exec, -1
    s_branch K2_back_6
K2_nul_10:
    s_mov_b32 s58, 63
    s_mov_b32 s36, 0
    s_branch K2_back_13
K2_spin_11:
    s_sub_u32 s27, s27, 1
    s_cbranch_scc1 K2_END
    v_lshl_add_u32 v233, v252, 1, s53
    ds_read_b32 v233, v233
    s_waitcnt lgkmcnt(0)
    s_branch K2_chk_12
K2_dyn_8:
    v_mov_b32 v254, 163296
    v_mov_b32 v255, 1
    v_lshl_add_u32 v233, v252, 1, s53
    s_mov_b64 exec, 1
    ds_add_rtn_u32 v232, v254, v255
    s_mov_b64 exec, -1
    ds_read_b32 v233, v233
    s_waitcnt lgkmcnt(0)
    v_readfirstlane_b32 s58, v232
    s_nop 0
    s_cmp_lt_u32 s58, s22
    s_cbranch_scc0 K2_nul_10
    s_and_b32 s59, s58, 7
    s_lshr_b32 s60, s58, 3
K2_chk_12:
    v_readlane_b32 s61, v233, s59
    s_nop 0
    s_cmp_gt_u32 s61, s60
    s_cbranch_scc0 K2_spin_11
K2_back_13:
    s_mov_b32 s34, 1
    s_branch K2_back_9
K2_dum_17:
    v_mov_b32 v232, -1
    s_mov_b32 m0, 163360
    s_mov_b64 exec, 1
    buffer_load_dwordx4 v232, s[16:19], 0 offen lds
    buffer_load_dwordx4 v232, s[16:19], 0 offen lds
    s_mov_b64 exec, -1
    s_branch K2_back_19
K2_nul_23:
    s_mov_b32 s58, 63
    s_mov_b32 s36, 0
    s_branch K2_back_26
K2_spin_24:
    s_sub_u32 s27, s27, 1
    s_cbranch_scc1 K2_END
    v_lshl_add_u32 v233, v252, 1, s53
    ds_read_b32 v233, v233
    s_waitcnt lgkmcnt(0)
    s_branch K2_chk_25
K2_dyn_21:
    v_mov_b32 v254, 163296
    v_mov_b32 v255, 1
    v_lshl_add_u32 v233, v252, 1, s53
    s_mov_b64 exec, 1
    ds_add_rtn_u32 v232, v254, v255
    s_mov_b64 exec, -1
    ds_read_b32 v233, v233
    s_waitcnt lgkmcnt(0)
    v_readfirstlane_b32 s58, v232
    s_nop 0
    s_cmp_lt_u32 s58, s22
    s_cbranch_scc0 K2_nul_23
    s_and_b32 s59, s58, 7
    s_lshr_b32 s60, s58, 3
K2_chk_25:
    v_readlane_b32 s61, v233, s59
    s_nop 0
    s_cmp_gt_u32 s61, s60
    s_cbranch_scc0 K2_spin_24
K2_back_26:
    s_mov_b32 s34, 1
    s_branch K2_back_22
K2_dum_30:
    v_mov_b32 v232, -1
    s_mov_b32 m0, 163360
    s_mov_b64 exec, 1
    buffer_load_dwordx4 v232, s[16:19], 0 offen lds
    buffer_load_dwordx4 v232, s[16:19], 0 offen lds
    s_mov_b64 exec, -1
    s_branch K2_back_32
K2_nul_34:
    s_mov_b32 s58, 63
    s_mov_b32 s36, 0
    s_branch K2_back_37
K2_spin_35:
    s_sub_u32 s27, s27, 1
    s_cbranch_scc1 K2_END
    v_lshl_add_u32 v233, v252, 1, s53
    ds_read_b32 v233, v233
    s_waitcnt lgkmcnt(0)
    s_branch K2_chk_36
K2_nul_41:
    s_mov_b32 s58, 63
    s_mov_b32 s36, 0
    s_branch K2_back_44
K2_spin_42:
    s_sub_u32 s27, s27, 1
    s_cbranch_scc1 K2_END
    v_lshl_add_u32 v233, v252, 1, s53
    ds_read_b32 v233, v233
    s_waitcnt lgkmcnt(0)
    s_branch K2_chk_43
K2_PAD_TL:
    s_branch K2_HOP
K2_TAIL2:
    v_lshlrev_b32 v229, 3, v252
    s_mul_i32 s58, s20, 20480
    s_add_u32 s58, s58, 6946816
    s_mul_i32 s59, s20, 8224
    buffer_load_dwordx4 v[96:99], v229, s[8:11], s58 offen offset:0 sc1
    buffer_load_dwordx4 v[100:103], v229, s[8:11], s58 offen offset:1024 sc1
    buffer_load_dwordx4 v[104:107], v229, s[8:11], s58 offen offset:2048 sc1
    buffer_load_dwordx4 v[108:111], v229, s[8:11], s58 offen offset:3072 sc1
    s_add_u32 s58, s58, 4096
    buffer_load_dwordx4 v[112:115], v229, s[8:11], s58 offen offset:0 sc1
    buffer_load_dwordx4 v[116:119], v229, s[8:11], s58 offen offset:1024 sc1
    buffer_load_dwordx4 v[120:123], v229, s[8:11], s58 offen offset:2048 sc1
    buffer_load_dwordx4 v[124:127], v229, s[8:11], s58 offen offset:3072 sc1
    v_lshl_add_u32 v228, v252, 1, s59
    v_lshrrev_b32 v226, 6, v252
    v_mul_u32_u24 v226, 126, v226
    v_sub_u32 v226, v228, v226
    s_branch K2_TAIL3
K2_TAIL:
    v_lshlrev_b32 v229, 3, v252
    s_mul_i32 s58, s20, 20480
    s_add_u32 s58, s58, 6946816
    s_mul_i32 s59, s20, 8224
    buffer_load_dwordx4 v[96:99], v229, s[8:11], s58 offen offset:0 sc1
    v_permlane32_swap_b32 v242, v236
    v_permlane32_swap_b32 v243, v237
    buffer_load_dwordx4 v[100:103], v229, s[8:11], s58 offen offset:1024 sc1
    v_permlane32_swap_b32 v244, v238
    v_permlane32_swap_b32 v245, v239
    buffer_load_dwordx4 v[104:107], v229, s[8:11], s58 offen offset:2048 sc1
    v_permlane32_swap_b32 v240, v241
    v_add_f32 v242, v242, v236
    buffer_load_dwordx4 v[108:111], v229, s[8:11], s58 offen offset:3072 sc1
    v_add_f32 v243, v243, v237
    v_add_f32 v244, v244, v238
    s_add_u32 s58, s58, 4096
    buffer_load_dwordx4 v[112:115], v229, s[8:11], s58 offen offset:0 sc1
    v_add_f32 v245, v245, v239
    v_add_f32 v240, -v240, -v241
    buffer_load_dwordx4 v[116:119], v229, s[8:11], s58 offen offset:1024 sc1
    v_sub_u32 v241, v230, v231
    v_cvt_pk_bf16_f32 v242, v242, v243
    buffer_load_dwordx4 v[120:123], v229, s[8:11], s58 offen offset:2048 sc1
    v_cvt_pk_bf16_f32 v244, v244, v245
    v_cvt_pk_bf16_f32 v240, v240, v240
    buffer_load_dwordx4 v[124:127], v229, s[8:11], s58 offen offset:3072 sc1
    ds_write_b32 v230, v242 offset:768
    ds_write_b32 v230, v244 offset:1024
    ds_write_b16 v241, v240 offset:1280
    v_lshl_add_u32 v228, v252, 1, s59
    v_lshrrev_b32 v226, 6, v252
    v_mul_u32_u24 v226, 126, v226
    v_sub_u32 v226, v228, v226
K2_TAIL3:
    s_waitcnt vmcnt(8)
    ds_write_b32 v228, v192 offset:0
    ds_write_b32 v228, v193 offset:256
    ds_write_b32 v228, v194 offset:512
    s_add_u32 s58, s58, 4096
    buffer_load_dwordx4 v[128:131], v229, s[8:11], s58 offen offset:0 sc1
    v_bfe_u32 v48, v252, 1, 4
    v_lshrrev_b32 v49, 5, v252
    ds_write_b32 v228, v195 offset:768
    ds_write_b32 v228, v196 offset:1024
    ds_write_b16 v226, v197 offset:1280
    buffer_load_dwordx4 v[132:135], v229, s[8:11], s58 offen offset:1024 sc1
    v_lshrrev_b32 v55, 3, v48
    v_lshlrev_b32 v52, 4, v49
    ds_write_b32 v228, v198 offset:1536
    ds_write_b32 v228, v199 offset:1792
    ds_write_b32 v228, v200 offset:2048
    buffer_load_dwordx4 v[136:139], v229, s[8:11], s58 offen offset:2048 sc1
    v_lshl_add_u32 v54, v55, 2, v48
    v_and_b32 v54, 7, v54
    ds_write_b32 v228, v201 offset:2304
    ds_write_b32 v228, v202 offset:2560
    ds_write_b16 v226, v203 offset:2816
    buffer_load_dwordx4 v[140:143], v229, s[8:11], s58 offen offset:3072 sc1
    v_and_b32 v50, 7, v48
    v_mul_u32_u24 v50, 8224, v50
    ds_write_b32 v228, v204 offset:3072
    ds_write_b32 v228, v205 offset:3328
    ds_write_b32 v228, v206 offset:3584
    s_add_u32 s58, s58, 4096
    buffer_load_dwordx4 v[144:147], v229, s[8:11], s58 offen offset:0 sc1
    v_mul_u32_u24 v51, 1536, v55
    v_add_u32 v50, v50, v51
    ds_write_b32 v228, v207 offset:3840
    ds_write_b32 v228, v208 offset:4096
    ds_write_b16 v226, v209 offset:4352
    buffer_load_dwordx4 v[148:151], v229, s[8:11], s58 offen offset:1024 sc1
    v_add_u32 v222, v50, v52
    v_mul_u32_u24 v51, 8224, v54
    ds_write_b32 v228, v210 offset:4608
    ds_write_b32 v228, v211 offset:4864
    ds_write_b32 v228, v212 offset:5120
    buffer_load_dwordx4 v[152:155], v229, s[8:11], s58 offen offset:2048 sc1
    v_add_u32 v232, v51, v52
    v_lshl_add_u32 v247, v55, 7, v232
    ds_write_b32 v228, v213 offset:5376
    ds_write_b32 v228, v214 offset:5632
    ds_write_b16 v226, v215 offset:5888
    buffer_load_dwordx4 v[156:159], v229, s[8:11], s58 offen offset:3072 sc1
    v_mul_u32_u24 v51, 2080, v48
    s_mov_b32 s60, 65536
    ds_write_b32 v228, v216 offset:6144
    ds_write_b32 v228, v217 offset:6400
    ds_write_b32 v228, v218 offset:6656
    s_add_u32 s58, s58, 4096
    buffer_load_dwordx4 v[160:163], v229, s[8:11], s58 offen offset:0 sc1
    v_add3_u32 v223, v51, v52, s60
    v_mul_u32_u24 v51, 2080, v54
    ds_write_b32 v228, v219 offset:6912
    ds_write_b32 v228, v220 offset:7168
    ds_write_b16 v226, v221 offset:7424
    buffer_load_dwordx4 v[164:167], v229, s[8:11], s58 offen offset:1024 sc1
    s_mov_b32 s60, 132096
    v_add3_u32 v225, v51, v52, s60
    buffer_load_dwordx4 v[168:171], v229, s[8:11], s58 offen offset:2048 sc1
    v_lshl_add_u32 v248, v55, 7, v225
    s_lshl_b32 s60, s20, 5
    buffer_load_dwordx4 v[172:175], v229, s[8:11], s58 offen offset:3072 sc1
    v_lshl_add_u32 v49, v49, 3, s60
    s_mov_b32 s60, 65536
    v_add3_u32 v255, v51, v49, s60
    v_lshl_add_u32 v246, v55, 9, v255
    v_bfe_u32 v53, v48, 2, 1
    v_lshl_add_u32 v49, v53, 4, v49
    v_add_u32 v254, v50, v49
    s_and_b32 s64, s55, s28
    s_waitcnt lgkmcnt(0)
    s_barrier
    s_cmp_eq_u32 s64, 0
    s_cbranch_scc1 K2_MULTI
    s_setprio 3
    ds_read_b128 v[48:51], v222 offset:0
    ds_read_b128 v[52:55], v222 offset:64
    ds_read_b128 v[56:59], v222 offset:896
    ds_read_b128 v[60:63], v222 offset:960
    ds_read_b128 v[64:67], v223 offset:0
    ds_read_b128 v[68:71], v223 offset:64
    ds_read_b128 v[72:75], v223 offset:896
    ds_read_b128 v[76:79], v223 offset:960
    ds_read_b128 v[80:83], v222 offset:3072
    ds_read_b128 v[84:87], v222 offset:3136
    ds_read_b128 v[88:91], v222 offset:3968
    s_waitcnt vmcnt(19) lgkmcnt(9)
    v_mfma_f32_16x16x32_bf16 v[0:3], v[96:99], v[48:51], 0
    ds_read_b128 v[92:95], v222 offset:4032
    s_waitcnt vmcnt(18)
    v_mfma_f32_16x16x32_bf16 v[0:3], v[100:103], v[52:55], v[0:3]
    ds_read_b128 v[48:51], v223 offset:33280
    s_waitcnt vmcnt(17) lgkmcnt(9)
    v_mfma_f32_16x16x32_bf16 v[0:3], v[104:107], v[56:59], v[0:3]
    s_bfe_u32 s60, s20, 0x10002
    s_lshl_b32 s60, s60, 4
    ds_read_b128 v[52:55], v223 offset:33344
    s_waitcnt vmcnt(16)
    v_mfma_f32_16x16x32_bf16 v[0:3], v[108:111], v[60:63], v[0:3]
    s_add_u32 s59, s59, s60
    v_add_u32 v228, s59, v229
    ds_read_b128 v[56:59], v223 offset:34176
    s_waitcnt vmcnt(15) lgkmcnt(9)
    v_mfma_f32_16x16x32_bf16 v[0:3], v[112:115], v[64:67], v[0:3]
    s_mul_i32 s60, s20, 2080
    s_add_u32 s60, s60, 65536
    ds_read_b128 v[60:63], v223 offset:34240
    s_waitcnt vmcnt(14)
    v_mfma_f32_16x16x32_bf16 v[0:3], v[116:119], v[68:71], v[0:3]
    v_add_u32 v249, s60, v229
    s_mov_b32 s63, 0xbfb8aa3b
    ds_read_b128 v[64:67], v232 offset:6144
    s_waitcnt vmcnt(13) lgkmcnt(9)
    v_mfma_f32_16x16x32_bf16 v[0:3], v[120:123], v[72:75], v[0:3]
    s_add_u32 s40, s20, s21
    s_lshl_b32 s40, s40, 10
    ds_read_b128 v[68:71], v232 offset:6208
    s_waitcnt vmcnt(12)
    v_mfma_f32_16x16x32_bf16 v[0:3], v[124:127], v[76:79], v[0:3]
    s_add_u32 s41, s40, 8192
    s_add_u32 s42, s40, 16384
    ds_read_b128 v[72:75], v232 offset:7040
    s_waitcnt lgkmcnt(9)
    v_mfma_f32_16x16x32_bf16 v[16:19], v[96:99], v[80:83], 0
    s_add_u32 s43, s40, 24576
    s_add_u32 s44, s40, 32768
    ds_read_b128 v[76:79], v232 offset:7104
    v_mfma_f32_16x16x32_bf16 v[16:19], v[100:103], v[84:87], v[16:19]
    ds_read_b128 v[80:83], v225 offset:0
    s_waitcnt lgkmcnt(9)
    v_mfma_f32_16x16x32_bf16 v[16:19], v[104:107], v[88:91], v[16:19]
    ds_read_b128 v[84:87], v225 offset:64
    v_mfma_f32_16x16x32_bf16 v[16:19], v[108:111], v[92:95], v[16:19]
    v_mul_f32 v204, s63, v0
    v_mul_f32 v205, s63, v1
    ds_read_b128 v[88:91], v225 offset:896
    s_waitcnt lgkmcnt(9)
    v_mfma_f32_16x16x32_bf16 v[16:19], v[112:115], v[48:51], v[16:19]
    v_mul_f32 v206, s63, v2
    ds_read_b128 v[92:95], v225 offset:960
    v_mfma_f32_16x16x32_bf16 v[16:19], v[116:119], v[52:55], v[16:19]
    v_mul_f32 v207, s63, v3
    ds_read_b128 v[48:51], v222 offset:128
    s_waitcnt lgkmcnt(9)
    v_mfma_f32_16x16x32_bf16 v[16:19], v[120:123], v[56:59], v[16:19]
    v_exp_f32 v204, v204
    ds_read_b128 v[52:55], v222 offset:384
    v_mfma_f32_16x16x32_bf16 v[16:19], v[124:127], v[60:63], v[16:19]
    v_exp_f32 v205, v205
    ds_read_b128 v[56:59], v222 offset:256
    s_waitcnt lgkmcnt(9)
    v_mfma_f32_16x16x32_bf16 v[32:35], v[96:99], v[64:67], 0
    v_exp_f32 v206, v206
    ds_read_b128 v[60:63], v222 offset:192
    v_mfma_f32_16x16x32_bf16 v[32:35], v[100:103], v[68:71], v[32:35]
    v_exp_f32 v207, v207
    s_setprio 2
    ds_read_b128 v[64:67], v222 offset:448
    s_waitcnt lgkmcnt(9)
    v_mfma_f32_16x16x32_bf16 v[32:35], v[104:107], v[72:75], v[32:35]
    v_add_f32 v204, 1.0, v204
    ds_read_b128 v[68:71], v222 offset:320
    v_mfma_f32_16x16x32_bf16 v[32:35], v[108:111], v[76:79], v[32:35]
    v_add_f32 v205, 1.0, v205
    v_add_f32 v206, 1.0, v206
    ds_read_b128 v[72:75], v222 offset:640
    s_waitcnt lgkmcnt(9)
    v_mfma_f32_16x16x32_bf16 v[32:35], v[112:115], v[80:83], v[32:35]
    v_add_f32 v207, 1.0, v207
    ds_read_b128 v[76:79], v222 offset:512
    v_mfma_f32_16x16x32_bf16 v[32:35], v[116:119], v[84:87], v[32:35]
    v_rcp_f32 v204, v204
    ds_read_b128 v[80:83], v222 offset:768
    s_waitcnt lgkmcnt(9)
    v_mfma_f32_16x16x32_bf16 v[32:35], v[120:123], v[88:91], v[32:35]
    v_rcp_f32 v205, v205
    ds_read_b128 v[84:87], v222 offset:704
    v_mfma_f32_16x16x32_bf16 v[32:35], v[124:127], v[92:95], v[32:35]
    v_rcp_f32 v206, v206
    ds_read_b128 v[88:91], v222 offset:576
    s_waitcnt vmcnt(11) lgkmcnt(9)
    v_mfma_f32_16x16x32_bf16 v[4:7], v[128:131], v[48:51], 0
    v_rcp_f32 v207, v207
    ds_read_b128 v[92:95], v222 offset:832
    v_mfma_f32_16x16x32_bf16 v[8:11], v[128:131], v[52:55], 0
    v_cvt_pk_bf16_f32 v176, v0, v1
    ds_read_b128 v[48:51], v222 offset:1024
    s_waitcnt lgkmcnt(9)
    v_mfma_f32_16x16x32_bf16 v[12:15], v[128:131], v[56:59], 0
    v_cvt_pk_bf16_f32 v177, v2, v3
    ds_read_b128 v[52:55], v222 offset:1280
    s_waitcnt vmcnt(10)
    v_mfma_f32_16x16x32_bf16 v[4:7], v[132:135], v[60:63], v[4:7]
    v_mul_f32 v208, s63, v16
    v_mul_f32 v209, s63, v17
    ds_read_b128 v[56:59], v222 offset:1152
    s_waitcnt lgkmcnt(9)
    v_mfma_f32_16x16x32_bf16 v[8:11], v[132:135], v[64:67], v[8:11]
    v_mul_f32 v210, s63, v18
    ds_read_b128 v[60:63], v222 offset:1088
    v_mfma_f32_16x16x32_bf16 v[12:15], v[132:135], v[68:71], v[12:15]
    v_mul_f32 v211, s63, v19
    ds_read_b128 v[64:67], v222 offset:1344
    s_waitcnt vmcnt(9) lgkmcnt(9)
    v_mfma_f32_16x16x32_bf16 v[4:7], v[136:139], v[72:75], v[4:7]
    v_exp_f32 v208, v208
    ds_read_b128 v[68:71], v222 offset:1216
    v_mfma_f32_16x16x32_bf16 v[8:11], v[136:139], v[76:79], v[8:11]
    v_exp_f32 v209, v209
    ds_read_b128 v[72:75], v223 offset:128
    s_waitcnt lgkmcnt(9)
    v_mfma_f32_16x16x32_bf16 v[12:15], v[136:139], v[80:83], v[12:15]
    v_exp_f32 v210, v210
    ds_read_b128 v[76:79], v223 offset:384
    s_waitcnt vmcnt(8)
    v_mfma_f32_16x16x32_bf16 v[4:7], v[140:143], v[84:87], v[4:7]
    v_exp_f32 v211, v211
    ds_read_b128 v[80:83], v223 offset:256
    s_waitcnt lgkmcnt(9)
    v_mfma_f32_16x16x32_bf16 v[8:11], v[140:143], v[88:91], v[8:11]
    v_add_f32 v208, 1.0, v208
    ds_read_b128 v[84:87], v223 offset:192
    v_mfma_f32_16x16x32_bf16 v[12:15], v[140:143], v[92:95], v[12:15]
    v_add_f32 v209, 1.0, v209
    v_add_f32 v210, 1.0, v210
    ds_read_b128 v[88:91], v223 offset:448
    s_waitcnt vmcnt(7) lgkmcnt(9)
    v_mfma_f32_16x16x32_bf16 v[4:7], v[144:147], v[48:51], v[4:7]
    v_add_f32 v211, 1.0, v211
    s_setprio 1
    ds_read_b128 v[92:95], v223 offset:320
    v_mfma_f32_16x16x32_bf16 v[8:11], v[144:147], v[52:55], v[8:11]
    v_rcp_f32 v208, v208
    ds_read_b128 v[48:51], v223 offset:640
    s_waitcnt lgkmcnt(9)
    v_mfma_f32_16x16x32_bf16 v[12:15], v[144:147], v[56:59], v[12:15]
    v_rcp_f32 v209, v209
    ds_read_b128 v[52:55], v223 offset:512
    s_waitcnt vmcnt(6)
    v_mfma_f32_16x16x32_bf16 v[4:7], v[148:151], v[60:63], v[4:7]
    v_rcp_f32 v210, v210
    ds_read_b128 v[56:59], v223 offset:768
    s_waitcnt lgkmcnt(9)
    v_mfma_f32_16x16x32_bf16 v[8:11], v[148:151], v[64:67], v[8:11]
    v_rcp_f32 v211, v211
    ds_read_b128 v[60:63], v223 offset:704
    v_mfma_f32_16x16x32_bf16 v[12:15], v[148:151], v[68:71], v[12:15]
K2_PAD_T2:
    s_cbranch_execz K2_HOP
    v_cvt_pk_bf16_f32 v184, v16, v17
    ds_read_b128 v[64:67], v223 offset:576
    s_waitcnt vmcnt(5) lgkmcnt(9)
    v_mfma_f32_16x16x32_bf16 v[4:7], v[152:155], v[72:75], v[4:7]
    v_cvt_pk_bf16_f32 v185, v18, v19
    ds_read_b128 v[68:71], v223 offset:832
    v_mfma_f32_16x16x32_bf16 v[8:11], v[152:155], v[76:79], v[8:11]
    v_mul_f32 v212, s63, v32
    v_mul_f32 v213, s63, v33
    ds_read_b128 v[72:75], v223 offset:1024
    s_waitcnt lgkmcnt(9)
    v_mfma_f32_16x16x32_bf16 v[12:15], v[152:155], v[80:83], v[12:15]
    v_mul_f32 v214, s63, v34
    ds_read_b128 v[76:79], v223 offset:1280
    s_waitcnt vmcnt(4)
    v_mfma_f32_16x16x32_bf16 v[4:7], v[156:159], v[84:87], v[4:7]
    v_mul_f32 v215, s63, v35
    ds_read_b128 v[80:83], v223 offset:1152
    s_waitcnt lgkmcnt(9)
    v_mfma_f32_16x16x32_bf16 v[8:11], v[156:159], v[88:91], v[8:11]
    v_exp_f32 v212, v212
    ds_read_b128 v[84:87], v223 offset:1088
    v_mfma_f32_16x16x32_bf16 v[12:15], v[156:159], v[92:95], v[12:15]
    v_exp_f32 v213, v213
    ds_read_b128 v[88:91], v223 offset:1344
    s_waitcnt vmcnt(3) lgkmcnt(9)
    v_mfma_f32_16x16x32_bf16 v[4:7], v[160:163], v[48:51], v[4:7]
    v_exp_f32 v214, v214
    ds_read_b128 v[92:95], v223 offset:1216
    v_mfma_f32_16x16x32_bf16 v[8:11], v[160:163], v[52:55], v[8:11]
    v_exp_f32 v215, v215
    ds_read_b128 v[48:51], v222 offset:3200
    s_waitcnt lgkmcnt(9)
    v_mfma_f32_16x16x32_bf16 v[12:15], v[160:163], v[56:59], v[12:15]
    v_add_f32 v212, 1.0, v212
    ds_read_b128 v[52:55], v222 offset:3456
    s_waitcnt vmcnt(2)
    v_mfma_f32_16x16x32_bf16 v[4:7], v[164:167], v[60:63], v[4:7]
    v_add_f32 v213, 1.0, v213
    v_add_f32 v214, 1.0, v214
    ds_read_b128 v[56:59], v222 offset:3328
    s_waitcnt lgkmcnt(9)
    v_mfma_f32_16x16x32_bf16 v[8:11], v[164:167], v[64:67], v[8:11]
    v_add_f32 v215, 1.0, v215
    ds_read_b128 v[60:63], v222 offset:3264
    v_mfma_f32_16x16x32_bf16 v[12:15], v[164:167], v[68:71], v[12:15]
    v_rcp_f32 v212, v212
    s_setprio 0
    ds_read_b128 v[64:67], v222 offset:3520
    s_waitcnt vmcnt(1) lgkmcnt(9)
    v_mfma_f32_16x16x32_bf16 v[4:7], v[168:171], v[72:75], v[4:7]
    v_rcp_f32 v213, v213
    ds_read_b128 v[68:71], v222 offset:3392
    v_mfma_f32_16x16x32_bf16 v[8:11], v[168:171], v[76:79], v[8:11]
    v_rcp_f32 v214, v214
    ds_read_b128 v[72:75], v222 offset:3712
    s_waitcnt lgkmcnt(9)
    v_mfma_f32_16x16x32_bf16 v[12:15], v[168:171], v[80:83], v[12:15]
    v_rcp_f32 v215, v215
    ds_read_b128 v[76:79], v222 offset:3584
    s_waitcnt vmcnt(0)
    v_mfma_f32_16x16x32_bf16 v[4:7], v[172:175], v[84:87], v[4:7]
    v_cvt_pk_bf16_f32 v220, v32, v33
    ds_read_b128 v[80:83], v222 offset:3840
    s_waitcnt lgkmcnt(9)
    v_mfma_f32_16x16x32_bf16 v[8:11], v[172:175], v[88:91], v[8:11]
    v_cvt_pk_bf16_f32 v221, v34, v35
    ds_read_b128 v[84:87], v222 offset:3776
    v_mfma_f32_16x16x32_bf16 v[12:15], v[172:175], v[92:95], v[12:15]
    ds_read_b128 v[88:91], v222 offset:3648
    s_waitcnt lgkmcnt(9)
    v_mfma_f32_16x16x32_bf16 v[20:23], v[128:131], v[48:51], 0
    ds_read_b128 v[92:95], v222 offset:3904
    v_mfma_f32_16x16x32_bf16 v[24:27], v[128:131], v[52:55], 0
    ds_read_b128 v[48:51], v222 offset:4096
    s_waitcnt lgkmcnt(9)
    v_mfma_f32_16x16x32_bf16 v[28:31], v[128:131], v[56:59], 0
    s_barrier
    s_setprio 3
    ds_read_b128 v[52:55], v222 offset:4352
    v_mfma_f32_16x16x32_bf16 v[20:23], v[132:135], v[60:63], v[20:23]
    v_mul_f32 v4, v4, v204
    ds_read_b128 v[56:59], v222 offset:4224
    s_waitcnt lgkmcnt(9)
    v_mfma_f32_16x16x32_bf16 v[24:27], v[132:135], v[64:67], v[24:27]
    v_mul_f32 v5, v5, v205
    ds_read_b128 v[60:63], v222 offset:4160
    v_mfma_f32_16x16x32_bf16 v[28:31], v[132:135], v[68:71], v[28:31]
    v_mul_f32 v6, v6, v206
    ds_read_b128 v[64:67], v222 offset:4416
    s_waitcnt lgkmcnt(9)
    v_mfma_f32_16x16x32_bf16 v[20:23], v[136:139], v[72:75], v[20:23]
    v_mul_f32 v7, v7, v207
    ds_read_b128 v[68:71], v222 offset:4288
    v_mfma_f32_16x16x32_bf16 v[24:27], v[136:139], v[76:79], v[24:27]
    v_cvt_pk_bf16_f32 v178, v4, v5
    ds_read_b128 v[72:75], v223 offset:33408
    s_waitcnt lgkmcnt(9)
    v_mfma_f32_16x16x32_bf16 v[28:31], v[136:139], v[80:83], v[28:31]
    v_cvt_pk_bf16_f32 v179, v6, v7
    ds_read_b128 v[76:79], v223 offset:33664
    v_mfma_f32_16x16x32_bf16 v[20:23], v[140:143], v[84:87], v[20:23]
    v_mul_f32 v8, v8, v204
    ds_read_b128 v[80:83], v223 offset:33536
    s_waitcnt lgkmcnt(9)
    v_mfma_f32_16x16x32_bf16 v[24:27], v[140:143], v[88:91], v[24:27]
    v_mul_f32 v9, v9, v205
    ds_read_b128 v[84:87], v223 offset:33472
    v_mfma_f32_16x16x32_bf16 v[28:31], v[140:143], v[92:95], v[28:31]
    v_mul_f32 v10, v10, v206
    ds_read_b128 v[88:91], v223 offset:33728
    s_waitcnt lgkmcnt(9)
    v_mfma_f32_16x16x32_bf16 v[20:23], v[144:147], v[48:51], v[20:23]
    v_mul_f32 v11, v11, v207
    s_setprio 2
    ds_read_b128 v[92:95], v223 offset:33600
    v_mfma_f32_16x16x32_bf16 v[24:27], v[144:147], v[52:55], v[24:27]
    v_cvt_pk_bf16_f32 v180, v8, v9
    ds_read_b128 v[48:51], v223 offset:33920
    s_waitcnt lgkmcnt(9)
    v_mfma_f32_16x16x32_bf16 v[28:31], v[144:147], v[56:59], v[28:31]
    v_cvt_pk_bf16_f32 v181, v10, v11
    ds_read_b128 v[52:55], v223 offset:33792
    v_mfma_f32_16x16x32_bf16 v[20:23], v[148:151], v[60:63], v[20:23]
    v_mul_f32 v12, v12, v204
    ds_read_b128 v[56:59], v223 offset:34048
    s_waitcnt lgkmcnt(9)
    v_mfma_f32_16x16x32_bf16 v[24:27], v[148:151], v[64:67], v[24:27]
    v_mul_f32 v13, v13, v205
    ds_read_b128 v[60:63], v223 offset:33984
    v_mfma_f32_16x16x32_bf16 v[28:31], v[148:151], v[68:71], v[28:31]
    v_mul_f32 v14, v14, v206
    ds_read_b128 v[64:67], v223 offset:33856
    s_waitcnt lgkmcnt(9)
    v_mfma_f32_16x16x32_bf16 v[20:23], v[152:155], v[72:75], v[20:23]
    v_mul_f32 v15, v15, v207
    ds_read_b128 v[68:71], v223 offset:34112
    v_mfma_f32_16x16x32_bf16 v[24:27], v[152:155], v[76:79], v[24:27]
    v_cvt_pk_bf16_f32 v182, v12, v13
    ds_read_b128 v[72:75], v223 offset:34304
    s_waitcnt lgkmcnt(9)
    v_mfma_f32_16x16x32_bf16 v[28:31], v[152:155], v[80:83], v[28:31]
    v_cvt_pk_bf16_f32 v183, v14, v15
    ds_read_b128 v[76:79], v223 offset:34560
    v_mfma_f32_16x16x32_bf16 v[20:23], v[156:159], v[84:87], v[20:23]
    ds_write_b64 v254, v[176:177] offset:0
    ds_write_b64 v254, v[178:179] offset:256
    ds_write_b64 v254, v[180:181] offset:512
    ds_write_b64 v254, v[182:183] offset:768
    ds_write_b64 v255, v[220:221] offset:0
    ds_read_b128 v[80:83], v223 offset:34432
    s_waitcnt lgkmcnt(14)
    v_mfma_f32_16x16x32_bf16 v[24:27], v[156:159], v[88:91], v[24:27]
    ds_read_b128 v[84:87], v223 offset:34368
    v_mfma_f32_16x16x32_bf16 v[28:31], v[156:159], v[92:95], v[28:31]
    s_setprio 1
    ds_read_b128 v[88:91], v223 offset:34624
    s_waitcnt lgkmcnt(14)
    v_mfma_f32_16x16x32_bf16 v[20:23], v[160:163], v[48:51], v[20:23]
    ds_read_b128 v[92:95], v223 offset:34496
    v_mfma_f32_16x16x32_bf16 v[24:27], v[160:163], v[52:55], v[24:27]
    ds_read_b128 v[48:51], v247 offset:6272
    s_waitcnt lgkmcnt(14)
    v_mfma_f32_16x16x32_bf16 v[28:31], v[160:163], v[56:59], v[28:31]
    ds_read_b128 v[52:55], v232 offset:6528
    v_mfma_f32_16x16x32_bf16 v[20:23], v[164:167], v[60:63], v[20:23]
    ds_read_b128 v[56:59], v247 offset:6336
    s_waitcnt lgkmcnt(14)
    v_mfma_f32_16x16x32_bf16 v[24:27], v[164:167], v[64:67], v[24:27]
    ds_read_b128 v[60:63], v232 offset:6592
    v_mfma_f32_16x16x32_bf16 v[28:31], v[164:167], v[68:71], v[28:31]
    ds_read_b128 v[64:67], v247 offset:6784
    s_waitcnt lgkmcnt(14)
    v_mfma_f32_16x16x32_bf16 v[20:23], v[168:171], v[72:75], v[20:23]
    ds_read_b128 v[68:71], v232 offset:6656
    v_mfma_f32_16x16x32_bf16 v[24:27], v[168:171], v[76:79], v[24:27]
    ds_read_b128 v[72:75], v247 offset:6848
    s_waitcnt lgkmcnt(9)
    v_mfma_f32_16x16x32_bf16 v[28:31], v[168:171], v[80:83], v[28:31]
    ds_read_b128 v[76:79], v232 offset:6720
    v_mfma_f32_16x16x32_bf16 v[20:23], v[172:175], v[84:87], v[20:23]
    s_setprio 0
    ds_read_b128 v[80:83], v247 offset:7168
    s_waitcnt lgkmcnt(9)
    v_mfma_f32_16x16x32_bf16 v[24:27], v[172:175], v[88:91], v[24:27]
    ds_read_b128 v[84:87], v232 offset:7424
    v_mfma_f32_16x16x32_bf16 v[28:31], v[172:175], v[92:95], v[28:31]
    ds_read_b128 v[88:91], v247 offset:7232
    s_waitcnt lgkmcnt(9)
    v_mfma_f32_16x16x32_bf16 v[36:39], v[128:131], v[48:51], 0
    ds_read_b128 v[92:95], v232 offset:7488
    v_mfma_f32_16x16x32_bf16 v[40:43], v[128:131], v[52:55], 0
    ds_read_b128 v[48:51], v248 offset:128
    s_waitcnt lgkmcnt(9)
    v_mfma_f32_16x16x32_bf16 v[36:39], v[132:135], v[56:59], v[36:39]
    s_barrier
    ds_read_b128 v[192:195], v228 offset:0
    ds_read_b128 v[196:199], v228 offset:1536
    s_setprio 3
    ds_read_b128 v[52:55], v225 offset:384
    v_mfma_f32_16x16x32_bf16 v[40:43], v[132:135], v[60:63], v[40:43]
    v_mul_f32 v20, v20, v208
    v_mul_f32 v21, v21, v209
    ds_read_b128 v[56:59], v248 offset:192
    s_waitcnt lgkmcnt(11)
    v_mfma_f32_16x16x32_bf16 v[36:39], v[136:139], v[64:67], v[36:39]
    v_mul_f32 v22, v22, v210
    ds_read_b128 v[60:63], v225 offset:448
    v_mfma_f32_16x16x32_bf16 v[40:43], v[136:139], v[68:71], v[40:43]
    v_mul_f32 v23, v23, v211
    ds_read_b128 v[64:67], v248 offset:640
    s_waitcnt lgkmcnt(11)
    v_mfma_f32_16x16x32_bf16 v[36:39], v[140:143], v[72:75], v[36:39]
    v_cvt_pk_bf16_f32 v186, v20, v21
    ds_read_b128 v[68:71], v225 offset:512
    v_mfma_f32_16x16x32_bf16 v[40:43], v[140:143], v[76:79], v[40:43]
    v_cvt_pk_bf16_f32 v187, v22, v23
    ds_read_b128 v[72:75], v248 offset:704
    s_waitcnt lgkmcnt(11)
    v_mfma_f32_16x16x32_bf16 v[36:39], v[144:147], v[80:83], v[36:39]
    v_mul_f32 v24, v24, v208
    v_mul_f32 v25, v25, v209
    s_waitcnt lgkmcnt(6)
    buffer_store_dwordx4 v[192:195], v229, s[12:15], s40 offen sc1
    buffer_store_dwordx4 v[196:199], v229, s[12:15], s41 offen sc1
    s_setprio 2
    ds_read_b128 v[76:79], v225 offset:576
    v_mfma_f32_16x16x32_bf16 v[40:43], v[144:147], v[84:87], v[40:43]
    v_mul_f32 v26, v26, v210
    ds_read_b128 v[80:83], v248 offset:1024
    v_mfma_f32_16x16x32_bf16 v[36:39], v[148:151], v[88:91], v[36:39]
    v_mul_f32 v27, v27, v211
    ds_read_b128 v[84:87], v225 offset:1280
    v_mfma_f32_16x16x32_bf16 v[40:43], v[148:151], v[92:95], v[40:43]
    v_cvt_pk_bf16_f32 v188, v24, v25
    ds_read_b128 v[88:91], v248 offset:1088
    s_waitcnt lgkmcnt(9)
    v_mfma_f32_16x16x32_bf16 v[36:39], v[152:155], v[48:51], v[36:39]
    v_cvt_pk_bf16_f32 v189, v26, v27
    ds_read_b128 v[92:95], v225 offset:1344
    v_mfma_f32_16x16x32_bf16 v[40:43], v[152:155], v[52:55], v[40:43]
    v_mul_f32 v28, v28, v208
    v_mul_f32 v29, v29, v209
    s_waitcnt lgkmcnt(8)
    v_mfma_f32_16x16x32_bf16 v[36:39], v[156:159], v[56:59], v[36:39]
    v_mul_f32 v30, v30, v210
    v_mfma_f32_16x16x32_bf16 v[40:43], v[156:159], v[60:63], v[40:43]
    v_mul_f32 v31, v31, v211
    s_setprio 1
    s_waitcnt lgkmcnt(6)
    v_mfma_f32_16x16x32_bf16 v[36:39], v[160:163], v[64:67], v[36:39]
    v_cvt_pk_bf16_f32 v190, v28, v29
    v_mfma_f32_16x16x32_bf16 v[40:43], v[160:163], v[68:71], v[40:43]
    v_cvt_pk_bf16_f32 v191, v30, v31
    s_waitcnt lgkmcnt(4)
    v_mfma_f32_16x16x32_bf16 v[36:39], v[164:167], v[72:75], v[36:39]
    ds_write_b64 v254, v[184:185] offset:3072
    ds_write_b64 v254, v[186:187] offset:3328
    ds_write_b64 v254, v[188:189] offset:3584
    ds_write_b64 v254, v[190:191] offset:3840
    v_mfma_f32_16x16x32_bf16 v[40:43], v[164:167], v[76:79], v[40:43]
    s_waitcnt lgkmcnt(6)
    v_mfma_f32_16x16x32_bf16 v[36:39], v[168:171], v[80:83], v[36:39]
    v_mfma_f32_16x16x32_bf16 v[40:43], v[168:171], v[84:87], v[40:43]
    s_setprio 0
    s_waitcnt lgkmcnt(4)
    v_mfma_f32_16x16x32_bf16 v[36:39], v[172:175], v[88:91], v[36:39]
    v_mfma_f32_16x16x32_bf16 v[40:43], v[172:175], v[92:95], v[40:43]
    s_nop 6
    v_mul_f32 v36, v36, v212
    v_mul_f32 v37, v37, v213
    v_mul_f32 v38, v38, v214
    v_mul_f32 v39, v39, v215
    v_cvt_pk_bf16_f32 v178, v36, v37
    v_cvt_pk_bf16_f32 v179, v38, v39
    v_mul_f32 v40, v40, v212
    v_mul_f32 v41, v41, v213
    v_mul_f32 v42, v42, v214
    v_mul_f32 v43, v43, v215
    v_cvt_pk_bf16_f32 v180, v40, v41
    v_cvt_pk_bf16_f32 v181, v42, v43
    ds_write_b64 v246, v[178:179] offset:256
    ds_write_b64 v255, v[180:181] offset:512
    s_waitcnt lgkmcnt(0)
    s_barrier
    ds_read_b128 v[192:195], v228 offset:3072
    ds_read_b128 v[196:199], v228 offset:4608
    ds_read_b128 v[200:203], v249
    s_waitcnt lgkmcnt(1)
    buffer_store_dwordx4 v[192:195], v229, s[12:15], s42 offen sc1
    buffer_store_dwordx4 v[196:199], v229, s[12:15], s43 offen sc1
K2_LASTROW:
    s_add_u32 s59, s20, 32
    s_cmp_ge_u32 s59, s22
    s_cbranch_scc1 K2_FIN
    s_waitcnt lgkmcnt(0)
    buffer_store_dwordx4 v[200:203], v229, s[12:15], s44 offen sc1
K2_FIN:
    s_endpgm
K2_MULTI:
    ds_read_b128 v[48:51], v222 offset:0
    ds_read_b128 v[52:55], v222 offset:64
    ds_read_b128 v[56:59], v222 offset:896
    ds_read_b128 v[60:63], v222 offset:960
    ds_read_b128 v[64:67], v223 offset:0
    ds_read_b128 v[68:71], v223 offset:64
    ds_read_b128 v[72:75], v223 offset:896
    ds_read_b128 v[76:79], v223 offset:960
    ds_read_b128 v[80:83], v222 offset:3072
    ds_read_b128 v[84:87], v222 offset:3136
    ds_read_b128 v[88:91], v222 offset:3968
    s_waitcnt vmcnt(19) lgkmcnt(9)
    v_mfma_f32_16x16x32_bf16 v[0:3], v[96:99], v[48:51], 0
    ds_read_b128 v[92:95], v222 offset:4032
    s_waitcnt vmcnt(18)
    v_mfma_f32_16x16x32_bf16 v[0:3], v[100:103], v[52:55], v[0:3]
    ds_read_b128 v[48:51], v223 offset:33280
    s_waitcnt vmcnt(17) lgkmcnt(9)
    v_mfma_f32_16x16x32_bf16 v[0:3], v[104:107], v[56:59], v[0:3]
    ds_read_b128 v[52:55], v223 offset:33344
    s_waitcnt vmcnt(16)
    v_mfma_f32_16x16x32_bf16 v[0:3], v[108:111], v[60:63], v[0:3]
    ds_read_b128 v[56:59], v223 offset:34176
    s_waitcnt vmcnt(15) lgkmcnt(9)
    v_mfma_f32_16x16x32_bf16 v[0:3], v[112:115], v[64:67], v[0:3]
    ds_read_b128 v[60:63], v223 offset:34240
    s_waitcnt vmcnt(14)
    v_mfma_f32_16x16x32_bf16 v[0:3], v[116:119], v[68:71], v[0:3]
    ds_read_b128 v[64:67], v232 offset:6144
    s_waitcnt vmcnt(13) lgkmcnt(9)
    v_mfma_f32_16x16x32_bf16 v[0:3], v[120:123], v[72:75], v[0:3]
    ds_read_b128 v[68:71], v232 offset:6208
    s_waitcnt vmcnt(12)
    v_mfma_f32_16x16x32_bf16 v[0:3], v[124:127], v[76:79], v[0:3]
    ds_read_b128 v[72:75], v232 offset:7040
    s_waitcnt lgkmcnt(9)
    v_mfma_f32_16x16x32_bf16 v[16:19], v[96:99], v[80:83], 0
    ds_read_b128 v[76:79], v232 offset:7104
    v_mfma_f32_16x16x32_bf16 v[16:19], v[100:103], v[84:87], v[16:19]
    ds_read_b128 v[80:83], v225 offset:0
    s_waitcnt lgkmcnt(9)
    v_mfma_f32_16x16x32_bf16 v[16:19], v[104:107], v[88:91], v[16:19]
    ds_read_b128 v[84:87], v225 offset:64
    v_mfma_f32_16x16x32_bf16 v[16:19], v[108:111], v[92:95], v[16:19]
    ds_read_b128 v[88:91], v225 offset:896
    s_waitcnt lgkmcnt(9)
    v_mfma_f32_16x16x32_bf16 v[16:19], v[112:115], v[48:51], v[16:19]
    ds_read_b128 v[92:95], v225 offset:960
    v_mfma_f32_16x16x32_bf16 v[16:19], v[116:119], v[52:55], v[16:19]
    ds_read_b128 v[48:51], v222 offset:128
    s_waitcnt lgkmcnt(9)
    v_mfma_f32_16x16x32_bf16 v[16:19], v[120:123], v[56:59], v[16:19]
    ds_read_b128 v[52:55], v222 offset:384
    v_mfma_f32_16x16x32_bf16 v[16:19], v[124:127], v[60:63], v[16:19]
    ds_read_b128 v[56:59], v222 offset:256
    s_waitcnt lgkmcnt(9)
    v_mfma_f32_16x16x32_bf16 v[32:35], v[96:99], v[64:67], 0
    ds_read_b128 v[60:63], v222 offset:192
    v_mfma_f32_16x16x32_bf16 v[32:35], v[100:103], v[68:71], v[32:35]
    ds_read_b128 v[64:67], v222 offset:448
    s_waitcnt lgkmcnt(9)
    v_mfma_f32_16x16x32_bf16 v[32:35], v[104:107], v[72:75], v[32:35]
    ds_read_b128 v[68:71], v222 offset:320
    v_mfma_f32_16x16x32_bf16 v[32:35], v[108:111], v[76:79], v[32:35]
    ds_read_b128 v[72:75], v222 offset:640
    s_waitcnt lgkmcnt(9)
    v_mfma_f32_16x16x32_bf16 v[32:35], v[112:115], v[80:83], v[32:35]
    ds_read_b128 v[76:79], v222 offset:512
    v_mfma_f32_16x16x32_bf16 v[32:35], v[116:119], v[84:87], v[32:35]
    ds_read_b128 v[80:83], v222 offset:768
    s_waitcnt lgkmcnt(9)
    v_mfma_f32_16x16x32_bf16 v[32:35], v[120:123], v[88:91], v[32:35]
    ds_read_b128 v[84:87], v222 offset:704
    v_mfma_f32_16x16x32_bf16 v[32:35], v[124:127], v[92:95], v[32:35]
    ds_read_b128 v[88:91], v222 offset:576
    s_waitcnt vmcnt(11) lgkmcnt(9)
    v_mfma_f32_16x16x32_bf16 v[4:7], v[128:131], v[48:51], 0
    ds_read_b128 v[92:95], v222 offset:832
    v_mfma_f32_16x16x32_bf16 v[8:11], v[128:131], v[52:55], 0
    ds_read_b128 v[48:51], v222 offset:1024
    s_waitcnt lgkmcnt(9)
    v_mfma_f32_16x16x32_bf16 v[12:15], v[128:131], v[56:59], 0
    ds_read_b128 v[52:55], v222 offset:1280
    s_waitcnt vmcnt(10)
    v_mfma_f32_16x16x32_bf16 v[4:7], v[132:135], v[60:63], v[4:7]
    ds_read_b128 v[56:59], v222 offset:1152
    s_waitcnt lgkmcnt(9)
    v_mfma_f32_16x16x32_bf16 v[8:11], v[132:135], v[64:67], v[8:11]
    ds_read_b128 v[60:63], v222 offset:1088
    v_mfma_f32_16x16x32_bf16 v[12:15], v[132:135], v[68:71], v[12:15]
    ds_read_b128 v[64:67], v222 offset:1344
    s_waitcnt vmcnt(9) lgkmcnt(9)
    v_mfma_f32_16x16x32_bf16 v[4:7], v[136:139], v[72:75], v[4:7]
    ds_read_b128 v[68:71], v222 offset:1216
    v_mfma_f32_16x16x32_bf16 v[8:11], v[136:139], v[76:79], v[8:11]
    ds_read_b128 v[72:75], v223 offset:128
    s_waitcnt lgkmcnt(9)
    v_mfma_f32_16x16x32_bf16 v[12:15], v[136:139], v[80:83], v[12:15]
    ds_read_b128 v[76:79], v223 offset:384
    s_waitcnt vmcnt(8)
    v_mfma_f32_16x16x32_bf16 v[4:7], v[140:143], v[84:87], v[4:7]
    ds_read_b128 v[80:83], v223 offset:256
    s_waitcnt lgkmcnt(9)
    v_mfma_f32_16x16x32_bf16 v[8:11], v[140:143], v[88:91], v[8:11]
    ds_read_b128 v[84:87], v223 offset:192
    v_mfma_f32_16x16x32_bf16 v[12:15], v[140:143], v[92:95], v[12:15]
    ds_read_b128 v[88:91], v223 offset:448
    s_waitcnt vmcnt(7) lgkmcnt(9)
    v_mfma_f32_16x16x32_bf16 v[4:7], v[144:147], v[48:51], v[4:7]
    ds_read_b128 v[92:95], v223 offset:320
    v_mfma_f32_16x16x32_bf16 v[8:11], v[144:147], v[52:55], v[8:11]
    ds_read_b128 v[48:51], v223 offset:640
    s_waitcnt lgkmcnt(9)
    v_mfma_f32_16x16x32_bf16 v[12:15], v[144:147], v[56:59], v[12:15]
    ds_read_b128 v[52:55], v223 offset:512
    s_waitcnt vmcnt(6)
    v_mfma_f32_16x16x32_bf16 v[4:7], v[148:151], v[60:63], v[4:7]
    ds_read_b128 v[56:59], v223 offset:768
    s_waitcnt lgkmcnt(9)
    v_mfma_f32_16x16x32_bf16 v[8:11], v[148:151], v[64:67], v[8:11]
    ds_read_b128 v[60:63], v223 offset:704
    v_mfma_f32_16x16x32_bf16 v[12:15], v[148:151], v[68:71], v[12:15]
    ds_read_b128 v[64:67], v223 offset:576
    s_waitcnt vmcnt(5) lgkmcnt(9)
    v_mfma_f32_16x16x32_bf16 v[4:7], v[152:155], v[72:75], v[4:7]
    ds_read_b128 v[68:71], v223 offset:832
    v_mfma_f32_16x16x32_bf16 v[8:11], v[152:155], v[76:79], v[8:11]
    ds_read_b128 v[72:75], v223 offset:1024
    s_waitcnt lgkmcnt(9)
    v_mfma_f32_16x16x32_bf16 v[12:15], v[152:155], v[80:83], v[12:15]
    ds_read_b128 v[76:79], v223 offset:1280
    s_waitcnt vmcnt(4)
    v_mfma_f32_16x16x32_bf16 v[4:7], v[156:159], v[84:87], v[4:7]
    ds_read_b128 v[80:83], v223 offset:1152
    s_waitcnt lgkmcnt(9)
    v_mfma_f32_16x16x32_bf16 v[8:11], v[156:159], v[88:91], v[8:11]
    ds_read_b128 v[84:87], v223 offset:1088
    v_mfma_f32_16x16x32_bf16 v[12:15], v[156:159], v[92:95], v[12:15]
    ds_read_b128 v[88:91], v223 offset:1344
    s_waitcnt vmcnt(3) lgkmcnt(9)
    v_mfma_f32_16x16x32_bf16 v[4:7], v[160:163], v[48:51], v[4:7]
    ds_read_b128 v[92:95], v223 offset:1216
    v_mfma_f32_16x16x32_bf16 v[8:11], v[160:163], v[52:55], v[8:11]
    ds_read_b128 v[48:51], v222 offset:3200
    s_waitcnt lgkmcnt(9)
    v_mfma_f32_16x16x32_bf16 v[12:15], v[160:163], v[56:59], v[12:15]
    ds_read_b128 v[52:55], v222 offset:3456
    s_waitcnt vmcnt(2)
    v_mfma_f32_16x16x32_bf16 v[4:7], v[164:167], v[60:63], v[4:7]
    ds_read_b128 v[56:59], v222 offset:3328
    s_waitcnt lgkmcnt(9)
    v_mfma_f32_16x16x32_bf16 v[8:11], v[164:167], v[64:67], v[8:11]
    ds_read_b128 v[60:63], v222 offset:3264
    v_mfma_f32_16x16x32_bf16 v[12:15], v[164:167], v[68:71], v[12:15]
    ds_read_b128 v[64:67], v222 offset:3520
    s_waitcnt vmcnt(1) lgkmcnt(9)
    v_mfma_f32_16x16x32_bf16 v[4:7], v[168:171], v[72:75], v[4:7]
    ds_read_b128 v[68:71], v222 offset:3392
    v_mfma_f32_16x16x32_bf16 v[8:11], v[168:171], v[76:79], v[8:11]
    ds_read_b128 v[72:75], v222 offset:3712
    s_waitcnt lgkmcnt(9)
    v_mfma_f32_16x16x32_bf16 v[12:15], v[168:171], v[80:83], v[12:15]
    ds_read_b128 v[76:79], v222 offset:3584
    s_waitcnt vmcnt(0)
    v_mfma_f32_16x16x32_bf16 v[4:7], v[172:175], v[84:87], v[4:7]
    ds_read_b128 v[80:83], v222 offset:3840
    s_waitcnt lgkmcnt(9)
    v_mfma_f32_16x16x32_bf16 v[8:11], v[172:175], v[88:91], v[8:11]
    ds_read_b128 v[84:87], v222 offset:3776
    v_mfma_f32_16x16x32_bf16 v[12:15], v[172:175], v[92:95], v[12:15]
    ds_read_b128 v[88:91], v222 offset:3648
    s_waitcnt lgkmcnt(9)
    v_mfma_f32_16x16x32_bf16 v[20:23], v[128:131], v[48:51], 0
    ds_read_b128 v[92:95], v222 offset:3904
    v_mfma_f32_16x16x32_bf16 v[24:27], v[128:131], v[52:55], 0
    ds_read_b128 v[48:51], v222 offset:4096
    s_waitcnt lgkmcnt(9)
    v_mfma_f32_16x16x32_bf16 v[28:31], v[128:131], v[56:59], 0
    ds_read_b128 v[52:55], v222 offset:4352
    v_mfma_f32_16x16x32_bf16 v[20:23], v[132:135], v[60:63], v[20:23]
    ds_read_b128 v[56:59], v222 offset:4224
    s_waitcnt lgkmcnt(9)
    v_mfma_f32_16x16x32_bf16 v[24:27], v[132:135], v[64:67], v[24:27]
    ds_read_b128 v[60:63], v222 offset:4160
    v_mfma_f32_16x16x32_bf16 v[28:31], v[132:135], v[68:71], v[28:31]
    ds_read_b128 v[64:67], v222 offset:4416
    s_waitcnt lgkmcnt(9)
    v_mfma_f32_16x16x32_bf16 v[20:23], v[136:139], v[72:75], v[20:23]
    ds_read_b128 v[68:71], v222 offset:4288
    v_mfma_f32_16x16x32_bf16 v[24:27], v[136:139], v[76:79], v[24:27]
    ds_read_b128 v[72:75], v223 offset:33408
    s_waitcnt lgkmcnt(9)
    v_mfma_f32_16x16x32_bf16 v[28:31], v[136:139], v[80:83], v[28:31]
    ds_read_b128 v[76:79], v223 offset:33664
    v_mfma_f32_16x16x32_bf16 v[20:23], v[140:143], v[84:87], v[20:23]
    ds_read_b128 v[80:83], v223 offset:33536
    s_waitcnt lgkmcnt(9)
    v_mfma_f32_16x16x32_bf16 v[24:27], v[140:143], v[88:91], v[24:27]
    ds_read_b128 v[84:87], v223 offset:33472
    v_mfma_f32_16x16x32_bf16 v[28:31], v[140:143], v[92:95], v[28:31]
    ds_read_b128 v[88:91], v223 offset:33728
    s_waitcnt lgkmcnt(9)
    v_mfma_f32_16x16x32_bf16 v[20:23], v[144:147], v[48:51], v[20:23]
    ds_read_b128 v[92:95], v223 offset:33600
    v_mfma_f32_16x16x32_bf16 v[24:27], v[144:147], v[52:55], v[24:27]
    ds_read_b128 v[48:51], v223 offset:33920
    s_waitcnt lgkmcnt(9)
    v_mfma_f32_16x16x32_bf16 v[28:31], v[144:147], v[56:59], v[28:31]
    ds_read_b128 v[52:55], v223 offset:33792
    v_mfma_f32_16x16x32_bf16 v[20:23], v[148:151], v[60:63], v[20:23]
    ds_read_b128 v[56:59], v223 offset:34048
    s_waitcnt lgkmcnt(9)
    v_mfma_f32_16x16x32_bf16 v[24:27], v[148:151], v[64:67], v[24:27]
    ds_read_b128 v[60:63], v223 offset:33984
    v_mfma_f32_16x16x32_bf16 v[28:31], v[148:151], v[68:71], v[28:31]
    ds_read_b128 v[64:67], v223 offset:33856
    s_waitcnt lgkmcnt(9)
    v_mfma_f32_16x16x32_bf16 v[20:23], v[152:155], v[72:75], v[20:23]
    ds_read_b128 v[68:71], v223 offset:34112
    v_mfma_f32_16x16x32_bf16 v[24:27], v[152:155], v[76:79], v[24:27]
    ds_read_b128 v[72:75], v223 offset:34304
    s_waitcnt lgkmcnt(9)
    v_mfma_f32_16x16x32_bf16 v[28:31], v[152:155], v[80:83], v[28:31]
    ds_read_b128 v[76:79], v223 offset:34560
    v_mfma_f32_16x16x32_bf16 v[20:23], v[156:159], v[84:87], v[20:23]
    ds_read_b128 v[80:83], v223 offset:34432
    s_waitcnt lgkmcnt(9)
    v_mfma_f32_16x16x32_bf16 v[24:27], v[156:159], v[88:91], v[24:27]
    ds_read_b128 v[84:87], v223 offset:34368
    v_mfma_f32_16x16x32_bf16 v[28:31], v[156:159], v[92:95], v[28:31]
    ds_read_b128 v[88:91], v223 offset:34624
    s_waitcnt lgkmcnt(9)
    v_mfma_f32_16x16x32_bf16 v[20:23], v[160:163], v[48:51], v[20:23]
    ds_read_b128 v[92:95], v223 offset:34496
    v_mfma_f32_16x16x32_bf16 v[24:27], v[160:163], v[52:55], v[24:27]
    ds_read_b128 v[48:51], v247 offset:6272
    s_waitcnt lgkmcnt(9)
    v_mfma_f32_16x16x32_bf16 v[28:31], v[160:163], v[56:59], v[28:31]
    ds_read_b128 v[52:55], v232 offset:6528
    v_mfma_f32_16x16x32_bf16 v[20:23], v[164:167], v[60:63], v[20:23]
    ds_read_b128 v[56:59], v247 offset:6336
    s_waitcnt lgkmcnt(9)
    v_mfma_f32_16x16x32_bf16 v[24:27], v[164:167], v[64:67], v[24:27]
    ds_read_b128 v[60:63], v232 offset:6592
    v_mfma_f32_16x16x32_bf16 v[28:31], v[164:167], v[68:71], v[28:31]
    ds_read_b128 v[64:67], v247 offset:6784
    s_waitcnt lgkmcnt(9)
    v_mfma_f32_16x16x32_bf16 v[20:23], v[168:171], v[72:75], v[20:23]
    ds_read_b128 v[68:71], v232 offset:6656
    v_mfma_f32_16x16x32_bf16 v[24:27], v[168:171], v[76:79], v[24:27]
    ds_read_b128 v[72:75], v247 offset:6848
    s_waitcnt lgkmcnt(9)
    v_mfma_f32_16x16x32_bf16 v[28:31], v[168:171], v[80:83], v[28:31]
    ds_read_b128 v[76:79], v232 offset:6720
    v_mfma_f32_16x16x32_bf16 v[20:23], v[172:175], v[84:87], v[20:23]
    ds_read_b128 v[80:83], v247 offset:7168
    s_waitcnt lgkmcnt(9)
    v_mfma_f32_16x16x32_bf16 v[24:27], v[172:175], v[88:91], v[24:27]
    ds_read_b128 v[84:87], v232 offset:7424
    v_mfma_f32_16x16x32_bf16 v[28:31], v[172:175], v[92:95], v[28:31]
    ds_read_b128 v[88:91], v247 offset:7232
    s_waitcnt lgkmcnt(9)
    v_mfma_f32_16x16x32_bf16 v[36:39], v[128:131], v[48:51], 0
    ds_read_b128 v[92:95], v232 offset:7488
    v_mfma_f32_16x16x32_bf16 v[40:43], v[128:131], v[52:55], 0
    ds_read_b128 v[48:51], v248 offset:128
    s_waitcnt lgkmcnt(9)
    v_mfma_f32_16x16x32_bf16 v[36:39], v[132:135], v[56:59], v[36:39]
    ds_read_b128 v[52:55], v225 offset:384
    v_mfma_f32_16x16x32_bf16 v[40:43], v[132:135], v[60:63], v[40:43]
    ds_read_b128 v[56:59], v248 offset:192
    s_waitcnt lgkmcnt(9)
    v_mfma_f32_16x16x32_bf16 v[36:39], v[136:139], v[64:67], v[36:39]
    ds_read_b128 v[60:63], v225 offset:448
    v_mfma_f32_16x16x32_bf16 v[40:43], v[136:139], v[68:71], v[40:43]
    ds_read_b128 v[64:67], v248 offset:640
    s_waitcnt lgkmcnt(9)
    v_mfma_f32_16x16x32_bf16 v[36:39], v[140:143], v[72:75], v[36:39]
    ds_read_b128 v[68:71], v225 offset:512
    v_mfma_f32_16x16x32_bf16 v[40:43], v[140:143], v[76:79], v[40:43]
    ds_read_b128 v[72:75], v248 offset:704
    s_waitcnt lgkmcnt(9)
    v_mfma_f32_16x16x32_bf16 v[36:39], v[144:147], v[80:83], v[36:39]
    ds_read_b128 v[76:79], v225 offset:576
    v_mfma_f32_16x16x32_bf16 v[40:43], v[144:147], v[84:87], v[40:43]
    ds_read_b128 v[80:83], v248 offset:1024
    s_waitcnt lgkmcnt(9)
    v_mfma_f32_16x16x32_bf16 v[36:39], v[148:151], v[88:91], v[36:39]
    ds_read_b128 v[84:87], v225 offset:1280
    v_mfma_f32_16x16x32_bf16 v[40:43], v[148:151], v[92:95], v[40:43]
    ds_read_b128 v[88:91], v248 offset:1088
    s_waitcnt lgkmcnt(9)
    v_mfma_f32_16x16x32_bf16 v[36:39], v[152:155], v[48:51], v[36:39]
    ds_read_b128 v[92:95], v225 offset:1344
    v_mfma_f32_16x16x32_bf16 v[40:43], v[152:155], v[52:55], v[40:43]
    s_waitcnt lgkmcnt(8)
    v_mfma_f32_16x16x32_bf16 v[36:39], v[156:159], v[56:59], v[36:39]
    v_mfma_f32_16x16x32_bf16 v[40:43], v[156:159], v[60:63], v[40:43]
    s_waitcnt lgkmcnt(6)
    v_mfma_f32_16x16x32_bf16 v[36:39], v[160:163], v[64:67], v[36:39]
    v_mfma_f32_16x16x32_bf16 v[40:43], v[160:163], v[68:71], v[40:43]
    s_waitcnt lgkmcnt(4)
    v_mfma_f32_16x16x32_bf16 v[36:39], v[164:167], v[72:75], v[36:39]
    v_mfma_f32_16x16x32_bf16 v[40:43], v[164:167], v[76:79], v[40:43]
    s_waitcnt lgkmcnt(2)
    v_mfma_f32_16x16x32_bf16 v[36:39], v[168:171], v[80:83], v[36:39]
    v_mfma_f32_16x16x32_bf16 v[40:43], v[168:171], v[84:87], v[40:43]
    s_waitcnt lgkmcnt(0)
    v_mfma_f32_16x16x32_bf16 v[36:39], v[172:175], v[88:91], v[36:39]
    v_mfma_f32_16x16x32_bf16 v[40:43], v[172:175], v[92:95], v[40:43]
    s_lshl_b32 s60, s54, 9
    s_lshl_b32 s61, s20, 6
    s_add_u32 s60, s60, s61
    s_mul_i32 s60, s60, 192
    s_add_u32 s60, s60, 10485760
    v_mul_u32_u24 v227, 96, v252
    s_cmp_lg_u32 s28, 0
    s_cbranch_scc1 K2_NOACC
    buffer_load_dwordx4 v[48:51], v227, s[8:11], s60 offen offset:0
    buffer_load_dwordx4 v[52:55], v227, s[8:11], s60 offen offset:16
    buffer_load_dwordx4 v[56:59], v227, s[8:11], s60 offen offset:32
    buffer_load_dwordx4 v[60:63], v227, s[8:11], s60 offen offset:48
    buffer_load_dwordx4 v[64:67], v227, s[8:11], s60 offen offset:64
    buffer_load_dwordx4 v[68:71], v227, s[8:11], s60 offen offset:80
    buffer_load_dwordx4 v[72:75], v227, s[8:11], s60 offen offset:96
    buffer_load_dwordx4 v[76:79], v227, s[8:11], s60 offen offset:112
    buffer_load_dwordx4 v[80:83], v227, s[8:11], s60 offen offset:128
    buffer_load_dwordx4 v[84:87], v227, s[8:11], s60 offen offset:144
    buffer_load_dwordx4 v[88:91], v227, s[8:11], s60 offen offset:160
    s_waitcnt vmcnt(0)
    v_add_f32 v0, v0, v48
    v_add_f32 v1, v1, v49
    v_add_f32 v2, v2, v50
    v_add_f32 v3, v3, v51
    v_add_f32 v4, v4, v52
    v_add_f32 v5, v5, v53
    v_add_f32 v6, v6, v54
    v_add_f32 v7, v7, v55
    v_add_f32 v8, v8, v56
    v_add_f32 v9, v9, v57
    v_add_f32 v10, v10, v58
    v_add_f32 v11, v11, v59
    v_add_f32 v12, v12, v60
    v_add_f32 v13, v13, v61
    v_add_f32 v14, v14, v62
    v_add_f32 v15, v15, v63
    v_add_f32 v16, v16, v64
    v_add_f32 v17, v17, v65
    v_add_f32 v18, v18, v66
    v_add_f32 v19, v19, v67
    v_add_f32 v20, v20, v68
    v_add_f32 v21, v21, v69
    v_add_f32 v22, v22, v70
    v_add_f32 v23, v23, v71
    v_add_f32 v24, v24, v72
    v_add_f32 v25, v25, v73
    v_add_f32 v26, v26, v74
    v_add_f32 v27, v27, v75
    v_add_f32 v28, v28, v76
    v_add_f32 v29, v29, v77
    v_add_f32 v30, v30, v78
    v_add_f32 v31, v31, v79
    v_add_f32 v32, v32, v80
    v_add_f32 v33, v33, v81
    v_add_f32 v34, v34, v82
    v_add_f32 v35, v35, v83
    v_add_f32 v36, v36, v84
    v_add_f32 v37, v37, v85
    v_add_f32 v38, v38, v86
    v_add_f32 v39, v39, v87
    v_add_f32 v40, v40, v88
    v_add_f32 v41, v41, v89
    v_add_f32 v42, v42, v90
    v_add_f32 v43, v43, v91
K2_NOACC:
    s_barrier
    s_cmp_eq_u32 s55, 0
    s_cbranch_scc1 K2_SPILL
    s_bfe_u32 s60, s20, 0x10002
    s_lshl_b32 s60, s60, 4
    s_add_u32 s59, s59, s60
    v_add_u32 v228, s59, v229
    s_mul_i32 s60, s20, 2080
    s_add_u32 s60, s60, 65536
    v_add_u32 v249, s60, v229
    s_mov_b32 s63, 0xbfb8aa3b
    s_add_u32 s40, s20, s21
    s_lshl_b32 s40, s40, 10
    s_add_u32 s41, s40, 8192
    s_add_u32 s42, s40, 16384
    s_add_u32 s43, s40, 24576
    s_add_u32 s44, s40, 32768
    v_mul_f32 v204, s63, v0
    v_mul_f32 v205, s63, v1
    v_mul_f32 v206, s63, v2
    v_mul_f32 v207, s63, v3
    v_exp_f32 v204, v204
    v_exp_f32 v205, v205
    v_exp_f32 v206, v206
    v_exp_f32 v207, v207
    v_add_f32 v204, 1.0, v204
    v_add_f32 v205, 1.0, v205
    v_add_f32 v206, 1.0, v206
    v_add_f32 v207, 1.0, v207
    v_rcp_f32 v204, v204
    v_rcp_f32 v205, v205
    v_rcp_f32 v206, v206
    v_rcp_f32 v207, v207
    v_cvt_pk_bf16_f32 v176, v0, v1
    v_cvt_pk_bf16_f32 v177, v2, v3
    v_mul_f32 v4, v4, v204
    v_mul_f32 v5, v5, v205
    v_mul_f32 v6, v6, v206
    v_mul_f32 v7, v7, v207
    v_cvt_pk_bf16_f32 v178, v4, v5
    v_cvt_pk_bf16_f32 v179, v6, v7
    v_mul_f32 v8, v8, v204
    v_mul_f32 v9, v9, v205
    v_mul_f32 v10, v10, v206
    v_mul_f32 v11, v11, v207
    v_cvt_pk_bf16_f32 v180, v8, v9
    v_cvt_pk_bf16_f32 v181, v10, v11
    v_mul_f32 v12, v12, v204
    v_mul_f32 v13, v13, v205
    v_mul_f32 v14, v14, v206
    v_mul_f32 v15, v15, v207
    v_cvt_pk_bf16_f32 v182, v12, v13
    v_cvt_pk_bf16_f32 v183, v14, v15
    ds_write_b64 v254, v[176:177] offset:0
    ds_write_b64 v254, v[178:179] offset:256
    ds_write_b64 v254, v[180:181] offset:512
    ds_write_b64 v254, v[182:183] offset:768
    s_waitcnt lgkmcnt(0)
    s_barrier
    ds_read_b128 v[192:195], v228 offset:0
    ds_read_b128 v[196:199], v228 offset:1536
    s_waitcnt lgkmcnt(0)
    buffer_store_dwordx4 v[192:195], v229, s[12:15], s40 offen sc1
    buffer_store_dwordx4 v[196:199], v229, s[12:15], s41 offen sc1
    v_mul_f32 v208, s63, v16
    v_mul_f32 v209, s63, v17
    v_mul_f32 v210, s63, v18
    v_mul_f32 v211, s63, v19
    v_exp_f32 v208, v208
    v_exp_f32 v209, v209
    v_exp_f32 v210, v210
    v_exp_f32 v211, v211
    v_add_f32 v208, 1.0, v208
    v_add_f32 v209, 1.0, v209
    v_add_f32 v210, 1.0, v210
    v_add_f32 v211, 1.0, v211
    v_rcp_f32 v208, v208
    v_rcp_f32 v209, v209
    v_rcp_f32 v210, v210
    v_rcp_f32 v211, v211
    v_cvt_pk_bf16_f32 v184, v16, v17
    v_cvt_pk_bf16_f32 v185, v18, v19
    v_mul_f32 v20, v20, v208
    v_mul_f32 v21, v21, v209
    v_mul_f32 v22, v22, v210
    v_mul_f32 v23, v23, v211
    v_cvt_pk_bf16_f32 v186, v20, v21
    v_cvt_pk_bf16_f32 v187, v22, v23
    v_mul_f32 v24, v24, v208
    v_mul_f32 v25, v25, v209
    v_mul_f32 v26, v26, v210
    v_mul_f32 v27, v27, v211
    v_cvt_pk_bf16_f32 v188, v24, v25
    v_cvt_pk_bf16_f32 v189, v26, v27
    v_mul_f32 v28, v28, v208
    v_mul_f32 v29, v29, v209
    v_mul_f32 v30, v30, v210
    v_mul_f32 v31, v31, v211
    v_cvt_pk_bf16_f32 v190, v28, v29
    v_cvt_pk_bf16_f32 v191, v30, v31
    ds_write_b64 v254, v[184:185] offset:3072
    ds_write_b64 v254, v[186:187] offset:3328
    ds_write_b64 v254, v[188:189] offset:3584
    ds_write_b64 v254, v[190:191] offset:3840
    s_waitcnt lgkmcnt(0)
    s_barrier
    ds_read_b128 v[192:195], v228 offset:3072
    ds_read_b128 v[196:199], v228 offset:4608
    s_waitcnt lgkmcnt(0)
    buffer_store_dwordx4 v[192:195], v229, s[12:15], s42 offen sc1
    buffer_store_dwordx4 v[196:199], v229, s[12:15], s43 offen sc1
    v_mul_f32 v212, s63, v32
    v_mul_f32 v213, s63, v33
    v_mul_f32 v214, s63, v34
    v_mul_f32 v215, s63, v35
    v_exp_f32 v212, v212
    v_exp_f32 v213, v213
    v_exp_f32 v214, v214
    v_exp_f32 v215, v215
    v_add_f32 v212, 1.0, v212
    v_add_f32 v213, 1.0, v213
    v_add_f32 v214, 1.0, v214
    v_add_f32 v215, 1.0, v215
    v_rcp_f32 v212, v212
    v_rcp_f32 v213, v213
    v_rcp_f32 v214, v214
    v_rcp_f32 v215, v215
    v_cvt_pk_bf16_f32 v220, v32, v33
    v_cvt_pk_bf16_f32 v221, v34, v35
    v_mul_f32 v36, v36, v212
    v_mul_f32 v37, v37, v213
    v_mul_f32 v38, v38, v214
    v_mul_f32 v39, v39, v215
    v_cvt_pk_bf16_f32 v178, v36, v37
    v_cvt_pk_bf16_f32 v179, v38, v39
    v_mul_f32 v40, v40, v212
    v_mul_f32 v41, v41, v213
    v_mul_f32 v42, v42, v214
    v_mul_f32 v43, v43, v215
    v_cvt_pk_bf16_f32 v180, v40, v41
    v_cvt_pk_bf16_f32 v181, v42, v43
    ds_write_b64 v255, v[220:221] offset:0
    ds_write_b64 v246, v[178:179] offset:256
    ds_write_b64 v255, v[180:181] offset:512
    s_waitcnt lgkmcnt(0)
    s_barrier
    ds_read_b128 v[200:203], v249
    s_branch K2_LASTROW
K2_SPILL:
    buffer_store_dwordx4 v[0:3], v227, s[8:11], s60 offen offset:0
    buffer_store_dwordx4 v[4:7], v227, s[8:11], s60 offen offset:16
    buffer_store_dwordx4 v[8:11], v227, s[8:11], s60 offen offset:32
    buffer_store_dwordx4 v[12:15], v227, s[8:11], s60 offen offset:48
    buffer_store_dwordx4 v[16:19], v227, s[8:11], s60 offen offset:64
    buffer_store_dwordx4 v[20:23], v227, s[8:11], s60 offen offset:80
    buffer_store_dwordx4 v[24:27], v227, s[8:11], s60 offen offset:96
    buffer_store_dwordx4 v[28:31], v227, s[8:11], s60 offen offset:112
    buffer_store_dwordx4 v[32:35], v227, s[8:11], s60 offen offset:128
    buffer_store_dwordx4 v[36:39], v227, s[8:11], s60 offen offset:144
    buffer_store_dwordx4 v[40:43], v227, s[8:11], s60 offen offset:160
    s_mov_b32 s28, 0
    s_waitcnt vmcnt(0)
    s_cmp_lt_u32 s24, s25
    s_cbranch_scc1 K2_LOAD
    s_add_u32 s23, s23, 20
    s_branch K2_WINDOW
K2_WINDOW:
    s_mov_b32 s24, 0
    s_mov_b32 s25, 1
K2_LOAD:
    v_mbcnt_lo_u32_b32 v176, -1, 0
    v_mbcnt_hi_u32_b32 v176, -1, v176
    s_lshl_b32 s58, s20, 6
    v_add_u32 v177, s58, v176
    v_lshlrev_b32 v70, 4, v176
    s_mov_b32 s58, 7110656
    buffer_load_dwordx4 v[136:139], v70, s[8:11], s58 offen offset:0 sc1
    buffer_load_dwordx4 v[140:143], v70, s[8:11], s58 offen offset:1024 sc1
    s_mov_b32 s58, 7112704
    buffer_load_dwordx4 v[144:147], v70, s[8:11], s58 offen offset:0 sc1
    buffer_load_dwordx4 v[148:151], v70, s[8:11], s58 offen offset:1024 sc1
    s_mov_b32 s58, 7114752
    buffer_load_dwordx4 v[152:155], v70, s[8:11], s58 offen offset:0 sc1
    buffer_load_dwordx4 v[156:159], v70, s[8:11], s58 offen offset:1024 sc1
    s_mov_b32 s58, 7116800
    buffer_load_dwordx4 v[160:163], v70, s[8:11], s58 offen offset:0 sc1
    buffer_load_dwordx4 v[164:167], v70, s[8:11], s58 offen offset:1024 sc1
    s_mov_b32 s58, 7118848
    buffer_load_dwordx4 v[168:171], v70, s[8:11], s58 offen offset:0 sc1
    buffer_load_dwordx4 v[172:175], v70, s[8:11], s58 offen offset:1024 sc1
    s_mul_i32 s58, s20, 10400
    s_add_u32 s58, s58, 65536
    s_add_u32 s59, s58, 512
    v_and_b32 v76, 31, v176
    v_lshrrev_b32 v77, 5, v176
    v_cmp_le_u32 vcc, 24, v76
    v_mul_u32_u24 v77, 2080, v77
    v_lshl_add_u32 v78, v76, 4, v77
    v_cndmask_b32 v80, 0, -1, vcc
    v_add_u32 v78, s58, v78
    v_mov_b32 v81, v80
    v_mov_b32 v82, v80
    v_mov_b32 v83, v80
    v_add_u32 v85, 16, v176
    v_lshlrev_b32 v84, 5, v176
    v_lshrrev_b32 v85, 6, v85
    v_mul_u32_u24 v85, 1532, v85
    v_sub_u32 v84, v84, v85
    v_mov_b32 v85, -1
    v_add_u32 v84, s59, v84
    ds_write_b32 v84, v85 offset:0
    ds_write_b32 v84, v85 offset:2080
    ds_write_b32 v84, v85 offset:4160
    ds_write_b32 v84, v85 offset:6240
    ds_write_b32 v84, v85 offset:8320
    s_mov_b32 exec_hi, 0
    ds_write_b128 v78, v[80:83] offset:0
    ds_write_b128 v78, v[80:83] offset:2080
    ds_write_b128 v78, v[80:83] offset:4160
    ds_write_b128 v78, v[80:83] offset:6240
    ds_write_b128 v78, v[80:83] offset:8320
    s_mov_b32 exec_hi, -1
    s_cmp_lg_u32 s20, 7
    s_cbranch_scc1 K2_NOH
    v_mov_b32 v76, 0
    v_mov_b32 v77, -1
    v_lshlrev_b32 v78, 2, v176
    v_add_u32 v78, 163072, v78
    s_mov_b64 exec, 0x1ff
    ds_write_b32 v78, v76 offset:192
    s_mov_b64 exec, 0xff
    ds_write_b32 v78, v77 offset:256
    s_mov_b64 exec, -1
    s_cmp_lg_u32 s24, 0
    s_cbranch_scc1 K2_NOH
    s_mov_b32 exec_hi, 0xffff
    ds_write_b32 v78, v76
    s_mov_b64 exec, 1
    ds_write_b32 v78, v76 offset:228
    s_mov_b64 exec, -1
K2_NOH:
    s_waitcnt lgkmcnt(0)
    s_barrier
    s_branch K2_CELLS
K2_LD_GEN:
    s_mov_b64 exec, s[42:43]
    s_cbranch_execz K2_LD_DONE
    buffer_load_dwordx4 v[4:7], v182, s[8:11], 0 offen sc1
    s_mov_b64 exec, s[44:45]
    s_cbranch_execz K2_LD_DONE
    buffer_load_dwordx4 v[8:11], v183, s[8:11], 0 offen sc1
    s_mov_b64 exec, s[46:47]
    s_cbranch_execz K2_LD_DONE
    buffer_load_dwordx4 v[12:15], v184, s[8:11], 0 offen sc1
    s_mov_b64 exec, s[48:49]
    s_cbranch_execz K2_LD_DONE
    buffer_load_dwordx4 v[16:19], v181, s[8:11], 0 offen offset:128 sc1
    s_mov_b64 exec, s[50:51]
    s_cbranch_execz K2_LD_DONE
    buffer_load_dwordx4 v[20:23], v181, s[8:11], 0 offen offset:160 sc1
    s_mov_b64 exec, s[90:91]
    s_cbranch_execz K2_LD_DONE
    buffer_load_dwordx4 v[24:27], v181, s[8:11], 0 offen offset:192 sc1
    s_mov_b64 exec, s[92:93]
    s_cbranch_execz K2_LD_DONE
    buffer_load_dwordx4 v[28:31], v181, s[8:11], 0 offen offset:224 sc1
    s_mov_b64 exec, s[94:95]
    s_cbranch_execz K2_LD_DONE
    buffer_load_dwordx4 v[32:35], v181, s[8:11], 0 offen offset:256 sc1
    s_mov_b64 exec, s[96:97]
    s_cbranch_execz K2_LD_DONE
    buffer_load_dwordx4 v[36:39], v181, s[8:11], 0 offen offset:288 sc1
    s_branch K2_LD_DONE
K2_WLATE:
    s_waitcnt vmcnt(0)
    s_branch K2_WUNP
K2_FLGLD:
    buffer_load_dwordx4 v[84:87], v72, s[8:11], s64 offen sc1
    s_mov_b32 s62, 0
    s_branch K2_FLGL2
K2_FLGCK:
    s_cmp_lg_u32 s24, 0
    s_cbranch_scc1 K2_FLGOK
    s_waitcnt vmcnt(0)
K2_FLGW:
    v_xor_b32 v84, s2, v84
    v_xor_b32 v85, s2, v85
    v_xor_b32 v86, s2, v86
    v_xor_b32 v87, s2, v87
    v_or3_b32 v84, v84, v85, v86
    v_or_b32 v84, v84, v87
    v_cmp_ne_u32 vcc, 0, v84
    s_nop 0
    s_cbranch_vccz K2_FLGY
    s_sub_u32 s60, s60, 1
    s_cbranch_scc1 K2_END
    buffer_load_dwordx4 v[84:87], v72, s[8:11], s64 offen sc1
    s_waitcnt vmcnt(0)
    s_branch K2_FLGW
K2_FLGY:
    s_cmp_lg_u32 s54, 0
    s_cbranch_scc1 K2_FLGOK
    v_mov_b32 v84, s2
    v_mov_b32 v85, 7178240
    s_mov_b64 exec, 1
    buffer_store_dword v84, v85, s[8:11], 0 offen sc1
    s_mov_b64 exec, -1
    s_branch K2_FLGOK
K2_RT0:
    s_sub_u32 s60, s60, 1
    s_cbranch_scc1 K2_END
    buffer_load_dwordx4 v[0:3], v181, s[8:11], 0 offen offset:0 sc1
    s_waitcnt vmcnt(0)
    s_branch K2_CK0
K2_RT1:
    s_sub_u32 s60, s60, 1
    s_cbranch_scc1 K2_END
    buffer_load_dwordx4 v[4:7], v182, s[8:11], 0 offen sc1
    s_waitcnt vmcnt(0)
    s_branch K2_CK1
K2_RT2:
    s_sub_u32 s60, s60, 1
    s_cbranch_scc1 K2_END
    buffer_load_dwordx4 v[8:11], v183, s[8:11], 0 offen sc1
    s_waitcnt vmcnt(0)
    s_branch K2_CK2
K2_RT3:
    s_sub_u32 s60, s60, 1
    s_cbranch_scc1 K2_END
    buffer_load_dwordx4 v[12:15], v184, s[8:11], 0 offen sc1
    s_waitcnt vmcnt(0)
    s_branch K2_CK3
K2_RT4:
    s_sub_u32 s60, s60, 1
    s_cbranch_scc1 K2_END
    buffer_load_dwordx4 v[16:19], v181, s[8:11], 0 offen offset:128 sc1
    s_waitcnt vmcnt(0)
    s_branch K2_CK4
K2_RT5:
    s_sub_u32 s60, s60, 1
    s_cbranch_scc1 K2_END
    buffer_load_dwordx4 v[20:23], v181, s[8:11], 0 offen offset:160 sc1
    s_waitcnt vmcnt(0)
    s_branch K2_CK5
K2_RT6:
    s_sub_u32 s60, s60, 1
    s_cbranch_scc1 K2_END
    buffer_load_dwordx4 v[24:27], v181, s[8:11], 0 offen offset:192 sc1
    s_waitcnt vmcnt(0)
    s_branch K2_CK6
K2_RT7:
    s_sub_u32 s60, s60, 1
    s_cbranch_scc1 K2_END
    buffer_load_dwordx4 v[28:31], v181, s[8:11], 0 offen offset:224 sc1
    s_waitcnt vmcnt(0)
    s_branch K2_CK7
K2_RT8:
    s_sub_u32 s60, s60, 1
    s_cbranch_scc1 K2_END
    buffer_load_dwordx4 v[32:35], v181, s[8:11], 0 offen offset:256 sc1
    s_waitcnt vmcnt(0)
    s_branch K2_CK8
K2_RT9:
    s_sub_u32 s60, s60, 1
    s_cbranch_scc1 K2_END
    buffer_load_dwordx4 v[36:39], v181, s[8:11], 0 offen offset:288 sc1
    s_waitcnt vmcnt(0)
    s_branch K2_CK9
K2_RK_LOAD:
    s_waitcnt vmcnt(0)
    s_mov_b64 exec, s[40:41]
    s_cbranch_execz K2_RK_B
    v_lshrrev_b32 v50, 24, v3
    buffer_load_dword v40, v179, s[8:11], s66 offen offset:0
    v_mad_u32_u24 v50, v50, s58, v202
    v_and_b32 v3, 0xffffff, v3
    s_mov_b64 exec, s[42:43]
    s_cbranch_execz K2_RK_B
    v_lshrrev_b32 v51, 24, v7
    buffer_load_dword v41, v185, s[8:11], s66 offen
    v_mad_u32_u24 v51, v51, s58, v202
    v_and_b32 v7, 0xffffff, v7
    s_mov_b64 exec, s[44:45]
    s_cbranch_execz K2_RK_B
    v_lshrrev_b32 v52, 24, v11
    buffer_load_dword v42, v186, s[8:11], s66 offen
    v_mad_u32_u24 v52, v52, s58, v202
    v_and_b32 v11, 0xffffff, v11
    s_mov_b64 exec, s[46:47]
    s_cbranch_execz K2_RK_B
    v_lshrrev_b32 v53, 24, v15
    buffer_load_dword v43, v187, s[8:11], s66 offen
    v_mad_u32_u24 v53, v53, s58, v202
    v_and_b32 v15, 0xffffff, v15
    s_mov_b64 exec, s[48:49]
    s_cbranch_execz K2_RK_B
    v_lshrrev_b32 v54, 24, v19
    buffer_load_dword v44, v179, s[8:11], s66 offen offset:32
    v_mad_u32_u24 v54, v54, s58, v202
    v_and_b32 v19, 0xffffff, v19
    s_mov_b64 exec, s[50:51]
    s_cbranch_execz K2_RK_B
    v_lshrrev_b32 v55, 24, v23
    buffer_load_dword v45, v179, s[8:11], s66 offen offset:40
    v_mad_u32_u24 v55, v55, s58, v202
    v_and_b32 v23, 0xffffff, v23
    s_mov_b64 exec, s[90:91]
    s_cbranch_execz K2_RK_B
    v_lshrrev_b32 v56, 24, v27
    buffer_load_dword v46, v179, s[8:11], s66 offen offset:48
    v_mad_u32_u24 v56, v56, s58, v202
    v_and_b32 v27, 0xffffff, v27
    s_mov_b64 exec, s[92:93]
    s_cbranch_execz K2_RK_B
    v_lshrrev_b32 v57, 24, v31
    buffer_load_dword v47, v179, s[8:11], s66 offen offset:56
    v_mad_u32_u24 v57, v57, s58, v202
    v_and_b32 v31, 0xffffff, v31
    s_mov_b64 exec, s[94:95]
    s_cbranch_execz K2_RK_B
    v_lshrrev_b32 v58, 24, v35
    buffer_load_dword v48, v179, s[8:11], s66 offen offset:64
    v_mad_u32_u24 v58, v58, s58, v202
    v_and_b32 v35, 0xffffff, v35
    s_mov_b64 exec, s[96:97]
    s_cbranch_execz K2_RK_B
    v_lshrrev_b32 v59, 24, v39
    buffer_load_dword v49, v179, s[8:11], s66 offen offset:72
    v_mad_u32_u24 v59, v59, s58, v202
    v_and_b32 v39, 0xffffff, v39
K2_RK_B:
    s_mov_b64 exec, -1
    s_mul_i32 s62, s24, 48
    s_waitcnt vmcnt(0)
    v_subrev_u32 v40, s62, v40
    v_subrev_u32 v41, s62, v41
    v_subrev_u32 v42, s62, v42
    v_subrev_u32 v43, s62, v43
    v_subrev_u32 v44, s62, v44
    v_subrev_u32 v45, s62, v45
    v_subrev_u32 v46, s62, v46
    v_subrev_u32 v47, s62, v47
    v_subrev_u32 v48, s62, v48
    v_subrev_u32 v49, s62, v49
    s_branch K2_RK_DONE
K2_BIG:
    s_cmp_lg_u32 s24, 0
    s_cbranch_scc1 K2_TOK
    s_movk_i32 s26, 48
    v_mov_b32 v197, v193
    s_nop 1
    v_max_u32_dpp v197, v197, v197 row_shr:1 row_mask:0xf bank_mask:0xf bound_ctrl:0
    s_nop 1
    v_max_u32_dpp v197, v197, v197 row_shr:2 row_mask:0xf bank_mask:0xf bound_ctrl:0
    s_nop 1
    v_max_u32_dpp v197, v197, v197 row_shr:4 row_mask:0xf bank_mask:0xf bound_ctrl:0
    s_nop 1
    v_max_u32_dpp v197, v197, v197 row_shr:8 row_mask:0xf bank_mask:0xf bound_ctrl:0
    s_nop 1
    v_max_u32_dpp v197, v197, v197 row_bcast:15 row_mask:0xa bank_mask:0xf
    s_nop 1
    v_max_u32_dpp v197, v197, v197 row_bcast:31 row_mask:0xc bank_mask:0xf
    s_nop 0
    v_readlane_b32 s25, v197, 63
    s_nop 0
    s_add_u32 s25, s25, 47
    s_mul_i32 s25, s25, 43691
    s_lshr_b32 s25, s25, 21
    s_mov_b64 exec, s[40:41]
    s_cbranch_execz K2_SV_DONE
    buffer_store_dword v40, v179, s[8:11], s66 offen offset:0
    s_mov_b64 exec, s[42:43]
    s_cbranch_execz K2_SV_DONE
    buffer_store_dword v41, v185, s[8:11], s66 offen
    s_mov_b64 exec, s[44:45]
    s_cbranch_execz K2_SV_DONE
    buffer_store_dword v42, v186, s[8:11], s66 offen
    s_mov_b64 exec, s[46:47]
    s_cbranch_execz K2_SV_DONE
    buffer_store_dword v43, v187, s[8:11], s66 offen
    s_mov_b64 exec, s[48:49]
    s_cbranch_execz K2_SV_DONE
    buffer_store_dword v44, v179, s[8:11], s66 offen offset:32
    s_mov_b64 exec, s[50:51]
    s_cbranch_execz K2_SV_DONE
    buffer_store_dword v45, v179, s[8:11], s66 offen offset:40
    s_mov_b64 exec, s[90:91]
    s_cbranch_execz K2_SV_DONE
    buffer_store_dword v46, v179, s[8:11], s66 offen offset:48
    s_mov_b64 exec, s[92:93]
    s_cbranch_execz K2_SV_DONE
    buffer_store_dword v47, v179, s[8:11], s66 offen offset:56
    s_mov_b64 exec, s[94:95]
    s_cbranch_execz K2_SV_DONE
    buffer_store_dword v48, v179, s[8:11], s66 offen offset:64
    s_mov_b64 exec, s[96:97]
    s_cbranch_execz K2_SV_DONE
    buffer_store_dword v49, v179, s[8:11], s66 offen offset:72
K2_SV_DONE:
    s_mov_b64 exec, -1
    s_branch K2_TOK
K2_rare_1:
    s_cmp_eq_u32 s33, 4
    s_cbranch_scc1 K2_four_3
    s_mov_b32 s49, s48
    s_mov_b32 s51, s48
    s_add_u32 s45, s44, 256
    s_add_u32 s46, s44, 512
    s_add_u32 s47, s44, 768
    s_branch K2_back_2
K2_four_3:
    s_add_u32 s50, s48, 64
    s_add_u32 s51, s48, 96
    s_mov_b32 s46, s44
    s_mov_b32 s47, s44
    s_branch K2_back_2
K2_a4_5:
    v_add_u32 v254, s48, v230
    ds_read_b32 v254, v254 offset:4
    s_lshr_b32 s65, s3, 27
    s_mul_i32 s66, s22, 2080
    s_lshl_b32 s65, s65, 9
    s_add_u32 s65, s65, s66
    s_add_u32 s65, s65, 65536
    s_mov_b32 m0, s65
    s_mov_b32 exec_hi, 0
    s_waitcnt lgkmcnt(0)
    v_or_b32 v254, v254, v231
    buffer_load_dwordx4 v254, s[16:19], 0 offen  lds
    s_mov_b32 exec_hi, -1
    s_branch K2_b4_7
K2_rare_14:
    s_cmp_eq_u32 s33, 4
    s_cbranch_scc1 K2_four_16
    s_mov_b32 s49, s48
    s_mov_b32 s51, s48
    s_add_u32 s45, s44, 256
    s_add_u32 s46, s44, 512
    s_add_u32 s47, s44, 768
    s_branch K2_back_15
K2_four_16:
    s_add_u32 s50, s48, 64
    s_add_u32 s51, s48, 96
    s_mov_b32 s46, s44
    s_mov_b32 s47, s44
    s_branch K2_back_15
K2_a4_18:
    v_add_u32 v254, s48, v230
    ds_read_b32 v254, v254 offset:4
    s_lshr_b32 s65, s3, 27
    s_mul_i32 s66, s22, 2080
    s_lshl_b32 s65, s65, 9
    s_add_u32 s65, s65, s66
    s_add_u32 s65, s65, 65536
    s_mov_b32 m0, s65
    s_mov_b32 exec_hi, 0
    s_waitcnt lgkmcnt(0)
    v_or_b32 v254, v254, v231
    buffer_load_dwordx4 v254, s[16:19], 0 offen  lds
    s_mov_b32 exec_hi, -1
    s_branch K2_b4_20
K2_rare_27:
    s_cmp_eq_u32 s33, 4
    s_cbranch_scc1 K2_four_29
    s_mov_b32 s49, s48
    s_mov_b32 s51, s48
    s_add_u32 s45, s44, 256
    s_add_u32 s46, s44, 512
    s_add_u32 s47, s44, 768
    s_branch K2_back_28
K2_four_29:
    s_add_u32 s50, s48, 64
    s_add_u32 s51, s48, 96
    s_mov_b32 s46, s44
    s_mov_b32 s47, s44
    s_branch K2_back_28
K2_a4_31:
    v_add_u32 v254, s48, v230
    ds_read_b32 v254, v254 offset:4
    s_lshr_b32 s65, s3, 27
    s_mul_i32 s66, s22, 2080
    s_lshl_b32 s65, s65, 9
    s_add_u32 s65, s65, s66
    s_add_u32 s65, s65, 65536
    s_mov_b32 m0, s65
    s_mov_b32 exec_hi, 0
    s_waitcnt lgkmcnt(0)
    v_or_b32 v254, v254, v231
    buffer_load_dwordx4 v254, s[16:19], 0 offen  lds
    s_mov_b32 exec_hi, -1
    s_branch K2_b4_33
K2_rare_38:
    s_cmp_eq_u32 s33, 4
    s_cbranch_scc1 K2_four_40
    s_mov_b32 s49, s48
    s_mov_b32 s51, s48
    s_add_u32 s45, s44, 256
    s_add_u32 s46, s44, 512
    s_add_u32 s47, s44, 768
    s_branch K2_back_39
K2_four_40:
    s_add_u32 s50, s48, 64
    s_add_u32 s51, s48, 96
    s_mov_b32 s46, s44
    s_mov_b32 s47, s44
    s_branch K2_back_39
K2_rare_45:
    s_cmp_eq_u32 s33, 4
    s_cbranch_scc1 K2_four_47
    s_mov_b32 s49, s48
    s_mov_b32 s51, s48
    s_add_u32 s45, s44, 256
    s_add_u32 s46, s44, 512
    s_add_u32 s47, s44, 768
    s_branch K2_back_46
K2_four_47:
    s_add_u32 s50, s48, 64
    s_add_u32 s51, s48, 96
    s_mov_b32 s46, s44
    s_mov_b32 s47, s44
    s_branch K2_back_46
K2_U10:
    s_setprio 1
    s_add_u32 s38, s38, 1
    v_mov_b32 v254, s52
    v_mov_b32 v255, s38
    s_lshl_b32 s58, s38, 3
    s_add_u32 s58, s58, s20
    s_mov_b64 exec, 1
    ds_write_b32 v254, v255
    s_mov_b64 exec, -1
    s_cmp_lt_u32 s58, s22
    s_cbranch_scc0 K2_dyn_48
K2_back_49:
    s_waitcnt lgkmcnt(4)
    v_lshlrev_b32 v20, 16, v0
    v_and_b32 v21, 0xffff0000, v0
    v_lshlrev_b32 v22, 16, v1
    v_and_b32 v23, 0xffff0000, v1
    v_lshlrev_b32 v24, 16, v2
    v_and_b32 v25, 0xffff0000, v2
    v_lshlrev_b32 v26, 16, v3
    v_and_b32 v27, 0xffff0000, v3
    v_mul_f32_dpp v36, v16, v20 row_newbcast:8 row_mask:0xf bank_mask:0xf
    v_mul_f32_dpp v37, v16, v21 row_newbcast:9 row_mask:0xf bank_mask:0xf
    v_mul_f32_dpp v38, v16, v22 row_newbcast:10 row_mask:0xf bank_mask:0xf
    v_mul_f32_dpp v39, v16, v23 row_newbcast:11 row_mask:0xf bank_mask:0xf
    v_mul_f32_dpp v40, v16, v24 row_newbcast:12 row_mask:0xf bank_mask:0xf
    v_mul_f32_dpp v41, v16, v25 row_newbcast:13 row_mask:0xf bank_mask:0xf
    v_mul_f32_dpp v42, v16, v26 row_newbcast:14 row_mask:0xf bank_mask:0xf
    v_mul_f32_dpp v43, v16, v27 row_newbcast:15 row_mask:0xf bank_mask:0xf
    v_cvt_pk_bf16_f32 v68, v36, v37
    v_cvt_pk_bf16_f32 v69, v38, v39
    v_cvt_pk_bf16_f32 v70, v40, v41
    v_cvt_pk_bf16_f32 v71, v42, v43
    v_mul_f32_dpp v20, v16, v20 row_newbcast:0 row_mask:0xa bank_mask:0xf
    v_mul_f32_dpp v21, v16, v21 row_newbcast:1 row_mask:0xa bank_mask:0xf
    v_mul_f32_dpp v22, v16, v22 row_newbcast:2 row_mask:0xa bank_mask:0xf
    v_mul_f32_dpp v23, v16, v23 row_newbcast:3 row_mask:0xa bank_mask:0xf
    v_mul_f32_dpp v24, v16, v24 row_newbcast:4 row_mask:0xa bank_mask:0xf
    v_mul_f32_dpp v25, v16, v25 row_newbcast:5 row_mask:0xa bank_mask:0xf
    v_mul_f32_dpp v26, v16, v26 row_newbcast:6 row_mask:0xa bank_mask:0xf
    v_mul_f32_dpp v27, v16, v27 row_newbcast:7 row_mask:0xa bank_mask:0xf
    v_cvt_pk_bf16_f32 v64, v20, v21
    v_cvt_pk_bf16_f32 v65, v22, v23
    v_cvt_pk_bf16_f32 v66, v24, v25
    v_cvt_pk_bf16_f32 v67, v26, v27
    v_readlane_b32 s3, v253, s58
    s_lshl_b32 s44, s34, 7
    s_and_b32 s48, s3, 0x3ffff
    s_bfe_u32 s33, s3, 0x30012
    s_mul_i32 s35, s38, 6
    s_cmp_eq_u32 s34, 0
    s_cselect_b32 s35, s35, s48
    s_mov_b32 s45, s44
    s_add_u32 s47, s44, 256
    s_add_u32 s49, s48, 32
    s_add_u32 s60, s48, 64
    s_cmp_eq_u32 s33, 3
    s_cselect_b32 s46, s44, s47
    s_cselect_b32 s50, s60, s48
    s_cselect_b32 s51, s48, s49
    s_sub_u32 s60, s33, 2
    s_cmp_lt_u32 s60, 2
    s_cbranch_scc0 K2_rare_54
K2_back_55:
    v_add_u32 v233, s48, v230
    ds_read_b32 v232, v233
    ds_read_b32 v233, v233 offset:1024
    v_add_u32 v222, s48, v251
    ds_read_b32 v222, v222
    v_add_u32 v224, s49, v251
    ds_read_b32 v224, v224
    v_add_u32 v226, s50, v251
    ds_read_b32 v226, v226
    v_add_u32 v228, s51, v251
    ds_read_b32 v228, v228
    s_waitcnt lgkmcnt(4)
    v_or_b32 v232, v232, v231
    v_or_b32 v233, v233, v231
    s_cmp_lg_u32 s34, 0
    s_cbranch_scc1 K2_dum_57
    s_cmp_eq_u32 s33, 4
    s_cbranch_scc1 K2_a4_58
K2_b4_60:
    s_add_u32 m0, s48, 512
    s_add_u32 s65, s48, 1536
    buffer_load_dwordx4 v232, s[16:19], 0 offen  lds
    s_mov_b32 m0, s65
    s_mov_b32 exec_hi, 0
    buffer_load_dwordx4 v233, s[16:19], 0 offen  lds
    s_mov_b32 exec_hi, -1
K2_back_59:
    s_waitcnt lgkmcnt(3)
    v_mad_u32_u16 v223, v222, s39, v248 op_sel:[1,0,0,0]
    v_mad_u32_u16 v222, v222, s39, v248
    s_waitcnt lgkmcnt(2)
    v_mad_u32_u16 v225, v224, s39, v248 op_sel:[1,0,0,0]
    v_mad_u32_u16 v224, v224, s39, v248
    s_waitcnt lgkmcnt(1)
    v_mad_u32_u16 v227, v226, s39, v248 op_sel:[1,0,0,0]
    v_mad_u32_u16 v226, v226, s39, v248
    s_waitcnt lgkmcnt(0)
    v_mad_u32_u16 v229, v228, s39, v248 op_sel:[1,0,0,0]
    v_mad_u32_u16 v228, v228, s39, v248
    s_waitcnt vmcnt(6)
    v_mfma_f32_32x32x16_bf16 v[0:15], v[64:67], v[176:179], 0
    ds_read_b64_tr_b16 v[184:185], v246 offset:2048
    ds_read_b64_tr_b16 v[186:187], v246 offset:2560
    ds_read_b64_tr_b16 v[188:189], v247 offset:2048
    ds_read_b64_tr_b16 v[190:191], v247 offset:2560
    s_mov_b32 m0, s68
    v_mfma_f32_32x32x16_bf16 v[16:31], v[68:71], v[176:179], 0
    buffer_load_dwordx4 v222, s[4:7], s44 offen sc1 lds
    buffer_load_dwordx4 v223, s[72:75], s44 offen offset:1024 sc1 lds
    v_permlane32_swap_b32 v242, v236
    v_permlane32_swap_b32 v243, v237
    v_mfma_f32_32x32x16_bf16 v[32:47], v[64:67], v[180:183], 0
    v_permlane32_swap_b32 v244, v238
    v_permlane32_swap_b32 v245, v239
    v_permlane32_swap_b32 v240, v241
    v_add_f32 v242, v242, v236
    v_mfma_f32_32x32x16_bf16 v[48:63], v[68:71], v[180:183], 0
    s_setprio 0
    v_add_f32 v243, v243, v237
    v_add_f32 v244, v244, v238
    v_add_f32 v245, v245, v239
    v_add_f32 v240, -v240, -v241
    s_set_gpr_idx_on s32, gpr_idx(DST)
    s_nop 0
    v_cvt_pk_bf16_f32 v195, v242, v243
    v_cvt_pk_bf16_f32 v196, v244, v245
    v_cvt_pk_bf16_f32 v197, v240, v240
    s_set_gpr_idx_off
    v_mul_f32 v234, v0, v96
    v_mul_f32 v236, v8, v128
    v_fmac_f32 v234, v1, v97
    v_fmac_f32 v236, v9, v129
    v_fmac_f32 v234, v2, v98
    v_fmac_f32 v236, v10, v130
    v_fmac_f32 v234, v3, v99
    v_fmac_f32 v236, v11, v131
    v_fmac_f32 v234, v4, v100
    v_fmac_f32 v236, v12, v132
    v_fmac_f32 v234, v5, v101
    v_fmac_f32 v236, v13, v133
    v_fmac_f32 v234, v6, v102
    v_fmac_f32 v236, v14, v134
    v_fmac_f32 v234, v7, v103
    v_fmac_f32 v236, v15, v135
    v_mul_f32 v238, v16, v128
    v_mul_f32 v240, v24, v128
    v_fmac_f32 v238, v17, v129
    v_fmac_f32 v240, v25, v129
    v_fmac_f32 v238, v18, v130
    v_fmac_f32 v240, v26, v130
    v_fmac_f32 v238, v19, v131
    v_fmac_f32 v240, v27, v131
    v_fmac_f32 v238, v20, v132
    v_fmac_f32 v240, v28, v132
    v_fmac_f32 v238, v21, v133
    v_fmac_f32 v240, v29, v133
    v_fmac_f32 v238, v22, v134
    v_fmac_f32 v240, v30, v134
    v_fmac_f32 v238, v23, v135
    v_fmac_f32 v240, v31, v135
    v_mul_f32 v235, v32, v104
    v_mul_f32 v237, v40, v136
    v_fmac_f32 v235, v33, v105
    v_fmac_f32 v237, v41, v137
    v_fmac_f32 v235, v34, v106
    v_fmac_f32 v237, v42, v138
    v_fmac_f32 v235, v35, v107
    v_fmac_f32 v237, v43, v139
    v_fmac_f32 v235, v36, v108
    v_fmac_f32 v237, v44, v140
    v_fmac_f32 v235, v37, v109
    v_fmac_f32 v237, v45, v141
    v_fmac_f32 v235, v38, v110
    v_fmac_f32 v237, v46, v142
    v_fmac_f32 v235, v39, v111
    v_fmac_f32 v237, v47, v143
    v_mul_f32 v239, v48, v136
    v_mul_f32 v241, v56, v136
    v_fmac_f32 v239, v49, v137
    v_fmac_f32 v241, v57, v137
    v_fmac_f32 v239, v50, v138
    v_fmac_f32 v241, v58, v138
    v_fmac_f32 v239, v51, v139
    v_fmac_f32 v241, v59, v139
    v_fmac_f32 v239, v52, v140
    v_fmac_f32 v241, v60, v140
    v_fmac_f32 v239, v53, v141
    v_fmac_f32 v241, v61, v141
    v_fmac_f32 v239, v54, v142
    v_fmac_f32 v241, v62, v142
    v_fmac_f32 v239, v55, v143
    v_fmac_f32 v241, v63, v143
    s_setprio 1
    s_waitcnt vmcnt(6) lgkmcnt(0)
    v_mfma_f32_32x32x16_bf16 v[0:15], v[64:67], v[184:187], 0
    ds_read_b64_tr_b16 v[176:177], v246 offset:4096
    ds_read_b64_tr_b16 v[178:179], v246 offset:4608
    ds_read_b64_tr_b16 v[180:181], v247 offset:4096
    ds_read_b64_tr_b16 v[182:183], v247 offset:4608
    s_mov_b32 m0, s69
    v_mfma_f32_32x32x16_bf16 v[16:31], v[68:71], v[184:187], 0
    buffer_load_dwordx4 v224, s[4:7], s45 offen sc1 lds
    buffer_load_dwordx4 v225, s[72:75], s45 offen offset:1024 sc1 lds
    v_permlane32_swap_b32 v234, v236
    v_permlane32_swap_b32 v235, v237
    v_mfma_f32_32x32x16_bf16 v[32:47], v[64:67], v[188:191], 0
    v_permlane32_swap_b32 v240, v238
    v_permlane32_swap_b32 v241, v239
    v_add_f32 v234, v234, v236
    v_add_f32 v235, v235, v237
    v_add_f32 v240, v240, v238
    v_mfma_f32_32x32x16_bf16 v[48:63], v[68:71], v[188:191], 0
    s_setprio 0
    v_add_f32 v241, v241, v239
    s_set_gpr_idx_on s31, gpr_idx(DST)
    s_nop 0
    v_cvt_pk_bf16_f32 v192, v234, v235
    v_cvt_pk_bf16_f32 v193, v240, v241
    s_set_gpr_idx_off
    v_mul_f32 v234, v0, v144
    v_mul_f32 v236, v8, v112
    v_fmac_f32 v234, v1, v145
    v_fmac_f32 v236, v9, v113
    v_fmac_f32 v234, v2, v146
    v_fmac_f32 v236, v10, v114
    v_fmac_f32 v234, v3, v147
    v_fmac_f32 v236, v11, v115
    v_fmac_f32 v234, v4, v148
    v_fmac_f32 v236, v12, v116
    v_fmac_f32 v234, v5, v149
    v_fmac_f32 v236, v13, v117
    v_fmac_f32 v234, v6, v150
    v_fmac_f32 v236, v14, v118
    v_fmac_f32 v234, v7, v151
    v_fmac_f32 v236, v15, v119
    v_mul_f32 v238, v16, v160
    v_mul_f32 v240, v24, v160
    v_fmac_f32 v238, v17, v161
    v_fmac_f32 v240, v25, v161
    v_fmac_f32 v238, v18, v162
    v_fmac_f32 v240, v26, v162
    v_fmac_f32 v238, v19, v163
    v_fmac_f32 v240, v27, v163
    v_fmac_f32 v238, v20, v164
    v_fmac_f32 v240, v28, v164
    v_fmac_f32 v238, v21, v165
    v_fmac_f32 v240, v29, v165
    v_fmac_f32 v238, v22, v166
    v_fmac_f32 v240, v30, v166
    v_fmac_f32 v238, v23, v167
    v_fmac_f32 v240, v31, v167
    v_mul_f32 v235, v32, v152
    v_mul_f32 v237, v40, v120
    v_fmac_f32 v235, v33, v153
    v_fmac_f32 v237, v41, v121
    v_fmac_f32 v235, v34, v154
    v_fmac_f32 v237, v42, v122
    v_fmac_f32 v235, v35, v155
    v_fmac_f32 v237, v43, v123
    v_fmac_f32 v235, v36, v156
    v_fmac_f32 v237, v44, v124
    v_fmac_f32 v235, v37, v157
    v_fmac_f32 v237, v45, v125
    v_fmac_f32 v235, v38, v158
    v_fmac_f32 v237, v46, v126
    v_fmac_f32 v235, v39, v159
    v_fmac_f32 v237, v47, v127
    v_mul_f32 v239, v48, v168
    v_mul_f32 v241, v56, v168
    v_fmac_f32 v239, v49, v169
    v_fmac_f32 v241, v57, v169
    v_fmac_f32 v239, v50, v170
    v_fmac_f32 v241, v58, v170
    v_fmac_f32 v239, v51, v171
    v_fmac_f32 v241, v59, v171
    v_fmac_f32 v239, v52, v172
    v_fmac_f32 v241, v60, v172
    v_fmac_f32 v239, v53, v173
    v_fmac_f32 v241, v61, v173
    v_fmac_f32 v239, v54, v174
    v_fmac_f32 v241, v62, v174
    v_fmac_f32 v239, v55, v175
    v_fmac_f32 v241, v63, v175
    s_setprio 1
    s_waitcnt vmcnt(6) lgkmcnt(0)
    v_mfma_f32_32x32x16_bf16 v[0:15], v[64:67], v[176:179], 0
    ds_read_b64_tr_b16 v[184:185], v246 offset:6144
    ds_read_b64_tr_b16 v[186:187], v246 offset:6656
    ds_read_b64_tr_b16 v[188:189], v247 offset:6144
    ds_read_b64_tr_b16 v[190:191], v247 offset:6656
    s_mov_b32 m0, s70
    v_mfma_f32_32x32x16_bf16 v[16:31], v[68:71], v[176:179], 0
    buffer_load_dwordx4 v226, s[4:7], s46 offen sc1 lds
    buffer_load_dwordx4 v227, s[72:75], s46 offen offset:1024 sc1 lds
    s_sub_u32 s26, s48, s29
    s_mov_b32 s29, s48
    s_mov_b32 s30, s3
    s_cmp_eq_u32 s34, 0
    s_cselect_b32 s56, s33, 0
    v_mfma_f32_32x32x16_bf16 v[32:47], v[64:67], v[180:183], 0
    v_mfma_f32_32x32x16_bf16 v[48:63], v[68:71], v[180:183], 0
    s_setprio 0
    v_mul_f32 v242, v0, v144
    v_fma_f32 v238, v8, v160, -v238
    v_fmac_f32 v242, v1, v145
    v_fmac_f32 v238, v9, v161
    v_fmac_f32 v242, v2, v146
    v_fmac_f32 v238, v10, v162
    v_fmac_f32 v242, v3, v147
    v_fmac_f32 v238, v11, v163
    v_fmac_f32 v242, v4, v148
    v_fmac_f32 v238, v12, v164
    v_fmac_f32 v242, v5, v149
    v_fmac_f32 v238, v13, v165
    v_fmac_f32 v242, v6, v150
    v_fmac_f32 v238, v14, v166
    v_fmac_f32 v242, v7, v151
    v_fmac_f32 v238, v15, v167
    v_fmac_f32 v236, v16, v112
    v_mul_f32 v244, v24, v160
    v_fmac_f32 v236, v17, v113
    v_fmac_f32 v244, v25, v161
    v_fmac_f32 v236, v18, v114
    v_fmac_f32 v244, v26, v162
    v_fmac_f32 v236, v19, v115
    v_fmac_f32 v244, v27, v163
    v_fmac_f32 v236, v20, v116
    v_fmac_f32 v244, v28, v164
    v_fmac_f32 v236, v21, v117
    v_fmac_f32 v244, v29, v165
    v_fmac_f32 v236, v22, v118
    v_fmac_f32 v244, v30, v166
    v_fmac_f32 v236, v23, v119
    v_fmac_f32 v244, v31, v167
    v_mul_f32 v243, v32, v152
    v_fma_f32 v239, v40, v168, -v239
    v_fmac_f32 v243, v33, v153
    v_fmac_f32 v239, v41, v169
    v_fmac_f32 v243, v34, v154
    v_fmac_f32 v239, v42, v170
    v_fmac_f32 v243, v35, v155
    v_fmac_f32 v239, v43, v171
    v_fmac_f32 v243, v36, v156
    v_fmac_f32 v239, v44, v172
    v_fmac_f32 v243, v37, v157
    v_fmac_f32 v239, v45, v173
    v_fmac_f32 v243, v38, v158
    v_fmac_f32 v239, v46, v174
    v_fmac_f32 v243, v39, v159
    v_fmac_f32 v239, v47, v175
    v_fmac_f32 v237, v48, v120
    v_mul_f32 v245, v56, v168
    v_fmac_f32 v237, v49, v121
    v_fmac_f32 v245, v57, v169
    v_fmac_f32 v237, v50, v122
    v_fmac_f32 v245, v58, v170
    v_fmac_f32 v237, v51, v123
    v_fmac_f32 v245, v59, v171
    v_fmac_f32 v237, v52, v124
    v_fmac_f32 v245, v60, v172
    v_fmac_f32 v237, v53, v125
    v_fmac_f32 v245, v61, v173
    v_fmac_f32 v237, v54, v126
    v_fmac_f32 v245, v62, v174
    v_fmac_f32 v237, v55, v127
    v_fmac_f32 v245, v63, v175
    s_setprio 1
    s_waitcnt vmcnt(4) lgkmcnt(0)
    v_mfma_f32_32x32x16_bf16 v[0:15], v[64:67], v[184:187], 0
    ds_read_b64_tr_b16 v[176:177], v246 offset:0
    ds_read_b64_tr_b16 v[178:179], v246 offset:512
    ds_read_b64_tr_b16 v[180:181], v247 offset:0
    ds_read_b64_tr_b16 v[182:183], v247 offset:512
    s_mov_b32 m0, s71
    v_mfma_f32_32x32x16_bf16 v[16:31], v[68:71], v[184:187], 0
    buffer_load_dwordx4 v228, s[4:7], s47 offen sc1 lds
    buffer_load_dwordx4 v229, s[72:75], s47 offen offset:1024 sc1 lds
    v_permlane32_swap_b32 v242, v234
    v_permlane32_swap_b32 v243, v235
    v_add_f32 v242, v242, v234
    v_mfma_f32_32x32x16_bf16 v[32:47], v[64:67], v[188:191], 0
    v_add_f32 v243, v243, v235
    s_set_gpr_idx_on s31, gpr_idx(DST)
    s_nop 0
    v_cvt_pk_bf16_f32 v194, v242, v243
    s_set_gpr_idx_off
    s_mov_b32 s32, s31
    s_mov_b32 s31, s35
    v_mfma_f32_32x32x16_bf16 v[48:63], v[68:71], v[188:191], 0
    s_setprio 0
    v_mul_f32 v242, v0, v144
    v_fma_f32 v240, v8, v160, -v240
    v_fmac_f32 v242, v1, v145
    v_fmac_f32 v240, v9, v161
    v_fmac_f32 v242, v2, v146
    v_fmac_f32 v240, v10, v162
    v_fmac_f32 v242, v3, v147
    v_fmac_f32 v240, v11, v163
    v_fmac_f32 v242, v4, v148
    v_fmac_f32 v240, v12, v164
    v_fmac_f32 v242, v5, v149
    v_fmac_f32 v240, v13, v165
    v_fmac_f32 v242, v6, v150
    v_fmac_f32 v240, v14, v166
    v_fmac_f32 v242, v7, v151
    v_fmac_f32 v240, v15, v167
    v_add_u32 v249, s26, v249
    v_add_u32 v250, s26, v250
    v_fma_f32 v244, v16, v160, -v244
    v_fmac_f32 v236, v24, v112
    v_fmac_f32 v244, v17, v161
    v_fmac_f32 v236, v25, v113
    v_fmac_f32 v244, v18, v162
    v_fmac_f32 v236, v26, v114
    v_fmac_f32 v244, v19, v163
    v_fmac_f32 v236, v27, v115
    v_fmac_f32 v244, v20, v164
    v_fmac_f32 v236, v28, v116
    v_fmac_f32 v244, v21, v165
    v_fmac_f32 v236, v29, v117
    v_fmac_f32 v244, v22, v166
    v_fmac_f32 v236, v30, v118
    v_fmac_f32 v244, v23, v167
    v_fmac_f32 v236, v31, v119
    ds_read_b64_tr_b16 v[0:1], v249 offset:0
    ds_read_b64_tr_b16 v[2:3], v249 offset:256
    ds_read_u16_d16_hi v16, v250 offset:0
    v_mul_f32 v243, v32, v152
    v_fma_f32 v241, v40, v168, -v241
    v_fmac_f32 v243, v33, v153
    v_fmac_f32 v241, v41, v169
    v_fmac_f32 v243, v34, v154
    v_fmac_f32 v241, v42, v170
    v_fmac_f32 v243, v35, v155
    v_fmac_f32 v241, v43, v171
    v_fmac_f32 v243, v36, v156
    v_fmac_f32 v241, v44, v172
    v_fmac_f32 v243, v37, v157
    v_fmac_f32 v241, v45, v173
    v_fmac_f32 v243, v38, v158
    v_fmac_f32 v241, v46, v174
    v_fmac_f32 v243, v39, v159
    v_fmac_f32 v241, v47, v175
    ds_read_b64_tr_b16 v[4:5], v249 offset:512
    ds_read_b64_tr_b16 v[6:7], v249 offset:768
    ds_read_u16_d16_hi v17, v250 offset:32
    v_fma_f32 v245, v48, v168, -v245
    v_fmac_f32 v237, v56, v120
    v_fmac_f32 v245, v49, v169
    v_fmac_f32 v237, v57, v121
    v_fmac_f32 v245, v50, v170
    v_fmac_f32 v237, v58, v122
    v_fmac_f32 v245, v51, v171
    v_fmac_f32 v237, v59, v123
    v_fmac_f32 v245, v52, v172
    v_fmac_f32 v237, v60, v124
    v_fmac_f32 v245, v53, v173
    v_fmac_f32 v237, v61, v125
    v_fmac_f32 v245, v54, v174
    v_fmac_f32 v237, v62, v126
    v_fmac_f32 v245, v55, v175
    v_fmac_f32 v237, v63, v127
    s_cmp_eq_u32 s56, 2
    s_cbranch_scc1 K2_U20
    s_cmp_eq_u32 s56, 3
    s_cbranch_scc1 K2_U30
    s_branch K2_DSP0
K2_U40:
    s_setprio 1
    ds_read_b64_tr_b16 v[8:9], v249 offset:1024
    ds_read_b64_tr_b16 v[10:11], v249 offset:1280
    ds_read_u16_d16_hi v18, v250 offset:64
    s_lshr_b32 s65, s30, 27
    s_mul_i32 s66, s22, 2080
    s_lshl_b32 s65, s65, 9
    s_add_u32 s65, s65, s66
    s_add_u32 s65, s65, 65536
    s_sub_u32 s65, s65, s29
    s_sub_u32 s65, s65, 512
    v_add_u32 v56, s65, v249
    ds_read_b64_tr_b16 v[12:13], v56 offset:0
    ds_read_b64_tr_b16 v[14:15], v56 offset:256
    ds_read_u16_d16_hi v19, v250 offset:96
    s_waitcnt lgkmcnt(6)
    v_lshlrev_b32 v20, 16, v0
    v_and_b32 v21, 0xffff0000, v0
    v_lshlrev_b32 v22, 16, v1
    v_and_b32 v23, 0xffff0000, v1
    v_lshlrev_b32 v24, 16, v2
    v_and_b32 v25, 0xffff0000, v2
    v_lshlrev_b32 v26, 16, v3
    v_and_b32 v27, 0xffff0000, v3
    v_mul_f32_dpp v36, v16, v20 row_newbcast:8 row_mask:0xf bank_mask:0xf
    v_mul_f32_dpp v37, v16, v21 row_newbcast:9 row_mask:0xf bank_mask:0xf
    v_mul_f32_dpp v38, v16, v22 row_newbcast:10 row_mask:0xf bank_mask:0xf
    v_mul_f32_dpp v39, v16, v23 row_newbcast:11 row_mask:0xf bank_mask:0xf
    v_mul_f32_dpp v40, v16, v24 row_newbcast:12 row_mask:0xf bank_mask:0xf
    v_mul_f32_dpp v41, v16, v25 row_newbcast:13 row_mask:0xf bank_mask:0xf
    v_mul_f32_dpp v42, v16, v26 row_newbcast:14 row_mask:0xf bank_mask:0xf
    v_mul_f32_dpp v43, v16, v27 row_newbcast:15 row_mask:0xf bank_mask:0xf
    v_cvt_pk_bf16_f32 v68, v36, v37
    v_cvt_pk_bf16_f32 v69, v38, v39
    v_cvt_pk_bf16_f32 v70, v40, v41
    v_cvt_pk_bf16_f32 v71, v42, v43
    v_mul_f32_dpp v20, v16, v20 row_newbcast:0 row_mask:0xa bank_mask:0xf
    v_mul_f32_dpp v21, v16, v21 row_newbcast:1 row_mask:0xa bank_mask:0xf
    v_mul_f32_dpp v22, v16, v22 row_newbcast:2 row_mask:0xa bank_mask:0xf
    v_mul_f32_dpp v23, v16, v23 row_newbcast:3 row_mask:0xa bank_mask:0xf
    v_mul_f32_dpp v24, v16, v24 row_newbcast:4 row_mask:0xa bank_mask:0xf
    v_mul_f32_dpp v25, v16, v25 row_newbcast:5 row_mask:0xa bank_mask:0xf
    v_mul_f32_dpp v26, v16, v26 row_newbcast:6 row_mask:0xa bank_mask:0xf
    v_mul_f32_dpp v27, v16, v27 row_newbcast:7 row_mask:0xa bank_mask:0xf
    v_cvt_pk_bf16_f32 v64, v20, v21
    v_cvt_pk_bf16_f32 v65, v22, v23
    v_cvt_pk_bf16_f32 v66, v24, v25
    v_cvt_pk_bf16_f32 v67, v26, v27
    v_lshlrev_b32 v28, 16, v4
    v_and_b32 v29, 0xffff0000, v4
    v_lshlrev_b32 v30, 16, v5
    v_and_b32 v31, 0xffff0000, v5
    v_lshlrev_b32 v32, 16, v6
    v_and_b32 v33, 0xffff0000, v6
    v_lshlrev_b32 v34, 16, v7
    v_and_b32 v35, 0xffff0000, v7
    v_mul_f32_dpp v36, v17, v28 row_newbcast:8 row_mask:0xf bank_mask:0xf
    v_mul_f32_dpp v37, v17, v29 row_newbcast:9 row_mask:0xf bank_mask:0xf
    v_mul_f32_dpp v38, v17, v30 row_newbcast:10 row_mask:0xf bank_mask:0xf
    v_mul_f32_dpp v39, v17, v31 row_newbcast:11 row_mask:0xf bank_mask:0xf
    v_mul_f32_dpp v40, v17, v32 row_newbcast:12 row_mask:0xf bank_mask:0xf
    v_mul_f32_dpp v41, v17, v33 row_newbcast:13 row_mask:0xf bank_mask:0xf
    v_mul_f32_dpp v42, v17, v34 row_newbcast:14 row_mask:0xf bank_mask:0xf
    v_mul_f32_dpp v43, v17, v35 row_newbcast:15 row_mask:0xf bank_mask:0xf
    v_cvt_pk_bf16_f32 v76, v36, v37
    v_cvt_pk_bf16_f32 v77, v38, v39
    v_cvt_pk_bf16_f32 v78, v40, v41
    v_cvt_pk_bf16_f32 v79, v42, v43
    v_mul_f32_dpp v28, v17, v28 row_newbcast:0 row_mask:0xa bank_mask:0xf
    v_mul_f32_dpp v29, v17, v29 row_newbcast:1 row_mask:0xa bank_mask:0xf
    v_mul_f32_dpp v30, v17, v30 row_newbcast:2 row_mask:0xa bank_mask:0xf
    v_mul_f32_dpp v31, v17, v31 row_newbcast:3 row_mask:0xa bank_mask:0xf
    v_mul_f32_dpp v32, v17, v32 row_newbcast:4 row_mask:0xa bank_mask:0xf
    v_mul_f32_dpp v33, v17, v33 row_newbcast:5 row_mask:0xa bank_mask:0xf
    v_mul_f32_dpp v34, v17, v34 row_newbcast:6 row_mask:0xa bank_mask:0xf
    v_mul_f32_dpp v35, v17, v35 row_newbcast:7 row_mask:0xa bank_mask:0xf
    v_cvt_pk_bf16_f32 v72, v28, v29
    v_cvt_pk_bf16_f32 v73, v30, v31
    v_cvt_pk_bf16_f32 v74, v32, v33
    v_cvt_pk_bf16_f32 v75, v34, v35
    s_waitcnt lgkmcnt(3)
    v_lshlrev_b32 v20, 16, v8
    v_and_b32 v21, 0xffff0000, v8
    v_lshlrev_b32 v22, 16, v9
    v_and_b32 v23, 0xffff0000, v9
    v_lshlrev_b32 v24, 16, v10
    v_and_b32 v25, 0xffff0000, v10
    v_lshlrev_b32 v26, 16, v11
    v_and_b32 v27, 0xffff0000, v11
    v_mul_f32_dpp v36, v18, v20 row_newbcast:8 row_mask:0xf bank_mask:0xf
    v_mul_f32_dpp v37, v18, v21 row_newbcast:9 row_mask:0xf bank_mask:0xf
    v_mul_f32_dpp v38, v18, v22 row_newbcast:10 row_mask:0xf bank_mask:0xf
    v_mul_f32_dpp v39, v18, v23 row_newbcast:11 row_mask:0xf bank_mask:0xf
    v_mul_f32_dpp v40, v18, v24 row_newbcast:12 row_mask:0xf bank_mask:0xf
    v_mul_f32_dpp v41, v18, v25 row_newbcast:13 row_mask:0xf bank_mask:0xf
    v_mul_f32_dpp v42, v18, v26 row_newbcast:14 row_mask:0xf bank_mask:0xf
    v_mul_f32_dpp v43, v18, v27 row_newbcast:15 row_mask:0xf bank_mask:0xf
    v_cvt_pk_bf16_f32 v84, v36, v37
    v_cvt_pk_bf16_f32 v85, v38, v39
    v_cvt_pk_bf16_f32 v86, v40, v41
    v_cvt_pk_bf16_f32 v87, v42, v43
    v_mul_f32_dpp v20, v18, v20 row_newbcast:0 row_mask:0xa bank_mask:0xf
    v_mul_f32_dpp v21, v18, v21 row_newbcast:1 row_mask:0xa bank_mask:0xf
    v_mul_f32_dpp v22, v18, v22 row_newbcast:2 row_mask:0xa bank_mask:0xf
    v_mul_f32_dpp v23, v18, v23 row_newbcast:3 row_mask:0xa bank_mask:0xf
    v_mul_f32_dpp v24, v18, v24 row_newbcast:4 row_mask:0xa bank_mask:0xf
    v_mul_f32_dpp v25, v18, v25 row_newbcast:5 row_mask:0xa bank_mask:0xf
    v_mul_f32_dpp v26, v18, v26 row_newbcast:6 row_mask:0xa bank_mask:0xf
    v_mul_f32_dpp v27, v18, v27 row_newbcast:7 row_mask:0xa bank_mask:0xf
    v_cvt_pk_bf16_f32 v80, v20, v21
    v_cvt_pk_bf16_f32 v81, v22, v23
    v_cvt_pk_bf16_f32 v82, v24, v25
    v_cvt_pk_bf16_f32 v83, v26, v27
    s_waitcnt lgkmcnt(0)
    v_lshlrev_b32 v28, 16, v12
    v_and_b32 v29, 0xffff0000, v12
    v_lshlrev_b32 v30, 16, v13
    v_and_b32 v31, 0xffff0000, v13
    v_lshlrev_b32 v32, 16, v14
    v_and_b32 v33, 0xffff0000, v14
    v_lshlrev_b32 v34, 16, v15
    v_and_b32 v35, 0xffff0000, v15
    v_mul_f32_dpp v36, v19, v28 row_newbcast:8 row_mask:0xf bank_mask:0xf
    v_mul_f32_dpp v37, v19, v29 row_newbcast:9 row_mask:0xf bank_mask:0xf
    v_mul_f32_dpp v38, v19, v30 row_newbcast:10 row_mask:0xf bank_mask:0xf
    v_mul_f32_dpp v39, v19, v31 row_newbcast:11 row_mask:0xf bank_mask:0xf
    v_mul_f32_dpp v40, v19, v32 row_newbcast:12 row_mask:0xf bank_mask:0xf
    v_mul_f32_dpp v41, v19, v33 row_newbcast:13 row_mask:0xf bank_mask:0xf
    v_mul_f32_dpp v42, v19, v34 row_newbcast:14 row_mask:0xf bank_mask:0xf
    v_mul_f32_dpp v43, v19, v35 row_newbcast:15 row_mask:0xf bank_mask:0xf
    v_cvt_pk_bf16_f32 v92, v36, v37
    v_cvt_pk_bf16_f32 v93, v38, v39
    v_cvt_pk_bf16_f32 v94, v40, v41
    v_cvt_pk_bf16_f32 v95, v42, v43
    v_mul_f32_dpp v28, v19, v28 row_newbcast:0 row_mask:0xa bank_mask:0xf
    v_mul_f32_dpp v29, v19, v29 row_newbcast:1 row_mask:0xa bank_mask:0xf
    v_mul_f32_dpp v30, v19, v30 row_newbcast:2 row_mask:0xa bank_mask:0xf
    v_mul_f32_dpp v31, v19, v31 row_newbcast:3 row_mask:0xa bank_mask:0xf
    v_mul_f32_dpp v32, v19, v32 row_newbcast:4 row_mask:0xa bank_mask:0xf
    v_mul_f32_dpp v33, v19, v33 row_newbcast:5 row_mask:0xa bank_mask:0xf
    v_mul_f32_dpp v34, v19, v34 row_newbcast:6 row_mask:0xa bank_mask:0xf
    v_mul_f32_dpp v35, v19, v35 row_newbcast:7 row_mask:0xa bank_mask:0xf
    v_cvt_pk_bf16_f32 v88, v28, v29
    v_cvt_pk_bf16_f32 v89, v30, v31
    v_cvt_pk_bf16_f32 v90, v32, v33
    v_cvt_pk_bf16_f32 v91, v34, v35
    s_waitcnt vmcnt(4)
    v_mfma_f32_32x32x16_bf16 v[0:15], v[64:67], v[176:179], 0
    ds_read_b64_tr_b16 v[184:185], v246 offset:2048
    ds_read_b64_tr_b16 v[186:187], v246 offset:2560
    ds_read_b64_tr_b16 v[188:189], v247 offset:2048
    ds_read_b64_tr_b16 v[190:191], v247 offset:2560
    s_mov_b32 m0, s68
    v_mfma_f32_32x32x16_bf16 v[16:31], v[68:71], v[176:179], 0
    buffer_load_dwordx4 v222, s[4:7], s41 offen sc1 lds
    buffer_load_dwordx4 v223, s[72:75], s41 offen offset:1024 sc1 lds
    v_permlane32_swap_b32 v242, v236
    v_permlane32_swap_b32 v243, v237
    s_add_u32 s38, s38, 1
    v_mfma_f32_32x32x16_bf16 v[32:47], v[64:67], v[180:183], 0
    v_permlane32_swap_b32 v244, v238
    v_permlane32_swap_b32 v245, v239
    v_permlane32_swap_b32 v240, v241
    v_add_f32 v242, v242, v236
    v_mfma_f32_32x32x16_bf16 v[48:63], v[68:71], v[180:183], 0
    v_add_f32 v243, v243, v237
    v_add_f32 v244, v244, v238
    v_add_f32 v245, v245, v239
    v_add_f32 v240, -v240, -v241
    v_mov_b32 v254, s52
    v_mov_b32 v255, s38
    s_waitcnt vmcnt(4) lgkmcnt(0)
    v_mfma_f32_32x32x16_bf16 v[0:15], v[72:75], v[184:187], v[0:15]
    ds_read_b64_tr_b16 v[176:177], v246 offset:4096
    ds_read_b64_tr_b16 v[178:179], v246 offset:4608
    ds_read_b64_tr_b16 v[180:181], v247 offset:4096
    ds_read_b64_tr_b16 v[182:183], v247 offset:4608
    s_lshl_b32 s58, s38, 3
    s_add_u32 s58, s58, s20
    s_mov_b32 m0, s69
    v_mfma_f32_32x32x16_bf16 v[16:31], v[76:79], v[184:187], v[16:31]
    buffer_load_dwordx4 v224, s[4:7], s41 offen sc1 lds
    buffer_load_dwordx4 v225, s[72:75], s41 offen offset:1024 sc1 lds
    s_set_gpr_idx_on s32, gpr_idx(DST)
    s_nop 0
    v_cvt_pk_bf16_f32 v195, v242, v243
    v_cvt_pk_bf16_f32 v196, v244, v245
    v_cvt_pk_bf16_f32 v197, v240, v240
    s_set_gpr_idx_off
    s_mov_b64 exec, 1
    ds_write_b32 v254, v255
    s_mov_b64 exec, -1
    s_cmp_lt_u32 s58, s22
    s_cbranch_scc0 K2_dyn_61
K2_back_62:
    v_readlane_b32 s3, v253, s58
    s_lshl_b32 s44, s34, 7
    s_and_b32 s48, s3, 0x3ffff
    s_bfe_u32 s33, s3, 0x30012
    s_mul_i32 s35, s38, 6
    s_cmp_eq_u32 s34, 0
    s_cselect_b32 s35, s35, s48
    s_mov_b32 s45, s44
    s_add_u32 s47, s44, 256
    s_add_u32 s49, s48, 32
    s_add_u32 s60, s48, 64
    s_cmp_eq_u32 s33, 3
    s_cselect_b32 s46, s44, s47
    s_cselect_b32 s50, s60, s48
    s_cselect_b32 s51, s48, s49
    s_sub_u32 s60, s33, 2
    s_cmp_lt_u32 s60, 2
    s_cbranch_scc0 K2_rare_67
K2_back_68:
    v_mfma_f32_32x32x16_bf16 v[32:47], v[72:75], v[188:191], v[32:47]
    v_add_u32 v233, s48, v230
    ds_read_b32 v232, v233
    ds_read_b32 v233, v233 offset:1024
    v_mfma_f32_32x32x16_bf16 v[48:63], v[76:79], v[188:191], v[48:63]
    s_waitcnt vmcnt(4) lgkmcnt(3)
    v_mfma_f32_32x32x16_bf16 v[0:15], v[80:83], v[176:179], v[0:15]
    ds_read_b64_tr_b16 v[184:185], v246 offset:6144
    ds_read_b64_tr_b16 v[186:187], v246 offset:6656
    ds_read_b64_tr_b16 v[188:189], v247 offset:6144
    ds_read_b64_tr_b16 v[190:191], v247 offset:6656
    s_mov_b32 m0, s70
    v_mfma_f32_32x32x16_bf16 v[16:31], v[84:87], v[176:179], v[16:31]
    buffer_load_dwordx4 v226, s[4:7], s41 offen sc1 lds
    buffer_load_dwordx4 v227, s[72:75], s41 offen offset:1024 sc1 lds
    v_mfma_f32_32x32x16_bf16 v[32:47], v[80:83], v[180:183], v[32:47]
    v_mfma_f32_32x32x16_bf16 v[48:63], v[84:87], v[180:183], v[48:63]
    s_waitcnt lgkmcnt(4)
    v_or_b32 v232, v232, v231
    v_or_b32 v233, v233, v231
    s_cmp_lg_u32 s34, 0
    s_cbranch_scc1 K2_dum_70
    s_cmp_eq_u32 s33, 4
    s_cbranch_scc1 K2_a4_71
K2_b4_73:
    s_add_u32 m0, s48, 512
    s_add_u32 s65, s48, 1536
    buffer_load_dwordx4 v232, s[16:19], 0 offen  lds
    s_mov_b32 m0, s65
    s_mov_b32 exec_hi, 0
    buffer_load_dwordx4 v233, s[16:19], 0 offen  lds
    s_mov_b32 exec_hi, -1
K2_back_72:
    s_waitcnt vmcnt(6) lgkmcnt(0)
    v_mfma_f32_32x32x16_bf16 v[0:15], v[88:91], v[184:187], v[0:15]
    ds_read_b64_tr_b16 v[176:177], v246 offset:0
    ds_read_b64_tr_b16 v[178:179], v246 offset:512
    ds_read_b64_tr_b16 v[180:181], v247 offset:0
    ds_read_b64_tr_b16 v[182:183], v247 offset:512
    s_mov_b32 m0, s71
    v_mfma_f32_32x32x16_bf16 v[16:31], v[92:95], v[184:187], v[16:31]
    buffer_load_dwordx4 v228, s[4:7], s41 offen sc1 lds
    buffer_load_dwordx4 v229, s[72:75], s41 offen offset:1024 sc1 lds
    v_mfma_f32_32x32x16_bf16 v[32:47], v[88:91], v[188:191], v[32:47]
    s_nop 2
    v_mul_f32 v234, v0, v96
    v_mul_f32 v236, v8, v128
    v_fmac_f32 v234, v1, v97
    v_fmac_f32 v236, v9, v129
    v_fmac_f32 v234, v2, v98
    v_fmac_f32 v236, v10, v130
    v_fmac_f32 v234, v3, v99
    v_mfma_f32_32x32x16_bf16 v[48:63], v[92:95], v[188:191], v[48:63]
    s_setprio 0
    v_fmac_f32 v236, v11, v131
    v_fmac_f32 v234, v4, v100
    v_fmac_f32 v236, v12, v132
    v_fmac_f32 v234, v5, v101
    v_fmac_f32 v236, v13, v133
    v_fmac_f32 v234, v6, v102
    v_fmac_f32 v236, v14, v134
    v_fmac_f32 v234, v7, v103
    v_fmac_f32 v236, v15, v135
    v_mul_f32 v238, v16, v128
    v_mul_f32 v240, v24, v128
    v_fmac_f32 v238, v17, v129
    v_fmac_f32 v240, v25, v129
    v_fmac_f32 v238, v18, v130
    v_fmac_f32 v240, v26, v130
    v_fmac_f32 v238, v19, v131
    v_fmac_f32 v240, v27, v131
    v_fmac_f32 v238, v20, v132
    v_fmac_f32 v240, v28, v132
    v_fmac_f32 v238, v21, v133
    v_fmac_f32 v240, v29, v133
    v_fmac_f32 v238, v22, v134
    v_fmac_f32 v240, v30, v134
    v_fmac_f32 v238, v23, v135
    v_fmac_f32 v240, v31, v135
    v_mul_f32 v235, v32, v104
    v_mul_f32 v237, v40, v136
    v_fmac_f32 v235, v33, v105
    v_fmac_f32 v237, v41, v137
    v_fmac_f32 v235, v34, v106
    v_fmac_f32 v237, v42, v138
    v_fmac_f32 v235, v35, v107
    v_fmac_f32 v237, v43, v139
    v_fmac_f32 v235, v36, v108
    v_fmac_f32 v237, v44, v140
    v_fmac_f32 v235, v37, v109
    v_fmac_f32 v237, v45, v141
    v_fmac_f32 v235, v38, v110
    v_fmac_f32 v237, v46, v142
    v_fmac_f32 v235, v39, v111
    v_fmac_f32 v237, v47, v143
    v_mul_f32 v239, v48, v136
    v_mul_f32 v241, v56, v136
    s_setprio 1
    s_waitcnt vmcnt(6) lgkmcnt(0)
    v_mfma_f32_32x32x16_bf16 v[0:15], v[64:67], v[176:179], 0
    ds_read_b64_tr_b16 v[184:185], v246 offset:2048
    ds_read_b64_tr_b16 v[186:187], v246 offset:2560
    ds_read_b64_tr_b16 v[188:189], v247 offset:2048
    ds_read_b64_tr_b16 v[190:191], v247 offset:2560
    v_fmac_f32 v239, v49, v137
    v_fmac_f32 v241, v57, v137
    s_mov_b32 m0, s68
    v_mfma_f32_32x32x16_bf16 v[16:31], v[68:71], v[176:179], 0
    buffer_load_dwordx4 v222, s[4:7], s42 offen sc1 lds
    buffer_load_dwordx4 v223, s[72:75], s42 offen offset:1024 sc1 lds
    v_fmac_f32 v239, v50, v138
    v_fmac_f32 v241, v58, v138
    v_fmac_f32 v239, v51, v139
    v_fmac_f32 v241, v59, v139
    v_fmac_f32 v239, v52, v140
    v_mfma_f32_32x32x16_bf16 v[32:47], v[64:67], v[180:183], 0
    v_fmac_f32 v241, v60, v140
    v_fmac_f32 v239, v53, v141
    v_fmac_f32 v241, v61, v141
    v_fmac_f32 v239, v54, v142
    v_fmac_f32 v241, v62, v142
    v_fmac_f32 v239, v55, v143
    v_fmac_f32 v241, v63, v143
    v_mfma_f32_32x32x16_bf16 v[48:63], v[68:71], v[180:183], 0
    v_permlane32_swap_b32 v234, v236
    v_permlane32_swap_b32 v235, v237
    v_permlane32_swap_b32 v240, v238
    s_waitcnt vmcnt(6) lgkmcnt(0)
    v_mfma_f32_32x32x16_bf16 v[0:15], v[72:75], v[184:187], v[0:15]
    ds_read_b64_tr_b16 v[176:177], v246 offset:4096
    ds_read_b64_tr_b16 v[178:179], v246 offset:4608
    ds_read_b64_tr_b16 v[180:181], v247 offset:4096
    ds_read_b64_tr_b16 v[182:183], v247 offset:4608
    v_permlane32_swap_b32 v241, v239
    s_mov_b32 m0, s69
    v_mfma_f32_32x32x16_bf16 v[16:31], v[76:79], v[184:187], v[16:31]
    buffer_load_dwordx4 v224, s[4:7], s42 offen sc1 lds
    buffer_load_dwordx4 v225, s[72:75], s42 offen offset:1024 sc1 lds
    v_add_f32 v234, v234, v236
    v_add_f32 v235, v235, v237
    v_add_f32 v240, v240, v238
    v_add_f32 v241, v241, v239
    v_mfma_f32_32x32x16_bf16 v[32:47], v[72:75], v[188:191], v[32:47]
    s_set_gpr_idx_on s31, gpr_idx(DST)
    s_nop 0
    v_cvt_pk_bf16_f32 v192, v234, v235
    v_cvt_pk_bf16_f32 v193, v240, v241
    s_set_gpr_idx_off
    v_mfma_f32_32x32x16_bf16 v[48:63], v[76:79], v[188:191], v[48:63]
    s_waitcnt vmcnt(4) lgkmcnt(0)
    v_mfma_f32_32x32x16_bf16 v[0:15], v[80:83], v[176:179], v[0:15]
    ds_read_b64_tr_b16 v[184:185], v246 offset:6144
    ds_read_b64_tr_b16 v[186:187], v246 offset:6656
    ds_read_b64_tr_b16 v[188:189], v247 offset:6144
    ds_read_b64_tr_b16 v[190:191], v247 offset:6656
    s_mov_b32 m0, s70
    v_mfma_f32_32x32x16_bf16 v[16:31], v[84:87], v[176:179], v[16:31]
    buffer_load_dwordx4 v226, s[4:7], s42 offen sc1 lds
    buffer_load_dwordx4 v227, s[72:75], s42 offen offset:1024 sc1 lds
    v_mfma_f32_32x32x16_bf16 v[32:47], v[80:83], v[180:183], v[32:47]
    v_mfma_f32_32x32x16_bf16 v[48:63], v[84:87], v[180:183], v[48:63]
    s_waitcnt vmcnt(4) lgkmcnt(0)
    v_mfma_f32_32x32x16_bf16 v[0:15], v[88:91], v[184:187], v[0:15]
    ds_read_b64_tr_b16 v[176:177], v246 offset:0
    ds_read_b64_tr_b16 v[178:179], v246 offset:512
    ds_read_b64_tr_b16 v[180:181], v247 offset:0
    ds_read_b64_tr_b16 v[182:183], v247 offset:512
    s_mov_b32 m0, s71
    v_mfma_f32_32x32x16_bf16 v[16:31], v[92:95], v[184:187], v[16:31]
    buffer_load_dwordx4 v228, s[4:7], s42 offen sc1 lds
    buffer_load_dwordx4 v229, s[72:75], s42 offen offset:1024 sc1 lds
    v_mfma_f32_32x32x16_bf16 v[32:47], v[88:91], v[188:191], v[32:47]
    s_nop 2
    v_mul_f32 v234, v0, v144
    v_mul_f32 v236, v8, v112
    v_fmac_f32 v234, v1, v145
    v_fmac_f32 v236, v9, v113
    v_fmac_f32 v234, v2, v146
    v_fmac_f32 v236, v10, v114
    v_fmac_f32 v234, v3, v147
    v_mfma_f32_32x32x16_bf16 v[48:63], v[92:95], v[188:191], v[48:63]
    s_setprio 0
    v_fmac_f32 v236, v11, v115
    v_fmac_f32 v234, v4, v148
    v_fmac_f32 v236, v12, v116
    v_fmac_f32 v234, v5, v149
    v_fmac_f32 v236, v13, v117
    v_fmac_f32 v234, v6, v150
    v_fmac_f32 v236, v14, v118
    v_fmac_f32 v234, v7, v151
    v_fmac_f32 v236, v15, v119
    v_mul_f32 v238, v16, v160
    v_mul_f32 v240, v24, v160
    v_fmac_f32 v238, v17, v161
    v_fmac_f32 v240, v25, v161
    v_fmac_f32 v238, v18, v162
    v_fmac_f32 v240, v26, v162
    v_fmac_f32 v238, v19, v163
    v_fmac_f32 v240, v27, v163
    v_fmac_f32 v238, v20, v164
    v_fmac_f32 v240, v28, v164
    v_fmac_f32 v238, v21, v165
    v_fmac_f32 v240, v29, v165
    v_fmac_f32 v238, v22, v166
    v_fmac_f32 v240, v30, v166
    v_fmac_f32 v238, v23, v167
    v_fmac_f32 v240, v31, v167
    v_mul_f32 v235, v32, v152
    v_mul_f32 v237, v40, v120
    v_fmac_f32 v235, v33, v153
    v_fmac_f32 v237, v41, v121
    v_fmac_f32 v235, v34, v154
    v_fmac_f32 v237, v42, v122
    v_fmac_f32 v235, v35, v155
    v_fmac_f32 v237, v43, v123
    v_fmac_f32 v235, v36, v156
    v_fmac_f32 v237, v44, v124
    v_fmac_f32 v235, v37, v157
    v_fmac_f32 v237, v45, v125
    v_fmac_f32 v235, v38, v158
    v_fmac_f32 v237, v46, v126
    v_fmac_f32 v235, v39, v159
    v_fmac_f32 v237, v47, v127
    v_mul_f32 v239, v48, v168
    v_mul_f32 v241, v56, v168
    s_setprio 1
    s_waitcnt vmcnt(4) lgkmcnt(0)
    v_mfma_f32_32x32x16_bf16 v[0:15], v[64:67], v[176:179], 0
    ds_read_b64_tr_b16 v[184:185], v246 offset:2048
    ds_read_b64_tr_b16 v[186:187], v246 offset:2560
    ds_read_b64_tr_b16 v[188:189], v247 offset:2048
    ds_read_b64_tr_b16 v[190:191], v247 offset:2560
    v_fmac_f32 v239, v49, v169
    v_fmac_f32 v241, v57, v169
    s_mov_b32 m0, s68
    v_mfma_f32_32x32x16_bf16 v[16:31], v[68:71], v[176:179], 0
    buffer_load_dwordx4 v222, s[4:7], s43 offen sc1 lds
    buffer_load_dwordx4 v223, s[72:75], s43 offen offset:1024 sc1 lds
    v_fmac_f32 v239, v50, v170
    v_fmac_f32 v241, v58, v170
    v_fmac_f32 v239, v51, v171
    v_fmac_f32 v241, v59, v171
    v_fmac_f32 v239, v52, v172
    v_mfma_f32_32x32x16_bf16 v[32:47], v[64:67], v[180:183], 0
    v_fmac_f32 v241, v60, v172
    v_fmac_f32 v239, v53, v173
    v_fmac_f32 v241, v61, v173
    v_fmac_f32 v239, v54, v174
    v_fmac_f32 v241, v62, v174
    v_fmac_f32 v239, v55, v175
    v_fmac_f32 v241, v63, v175
    v_mfma_f32_32x32x16_bf16 v[48:63], v[68:71], v[180:183], 0
    s_waitcnt vmcnt(4) lgkmcnt(0)
    v_mfma_f32_32x32x16_bf16 v[0:15], v[72:75], v[184:187], v[0:15]
    ds_read_b64_tr_b16 v[176:177], v246 offset:4096
    ds_read_b64_tr_b16 v[178:179], v246 offset:4608
    ds_read_b64_tr_b16 v[180:181], v247 offset:4096
    ds_read_b64_tr_b16 v[182:183], v247 offset:4608
    s_mov_b32 m0, s69
    v_mfma_f32_32x32x16_bf16 v[16:31], v[76:79], v[184:187], v[16:31]
    buffer_load_dwordx4 v224, s[4:7], s43 offen sc1 lds
    buffer_load_dwordx4 v225, s[72:75], s43 offen offset:1024 sc1 lds
    v_mfma_f32_32x32x16_bf16 v[32:47], v[72:75], v[188:191], v[32:47]
    v_mfma_f32_32x32x16_bf16 v[48:63], v[76:79], v[188:191], v[48:63]
    s_waitcnt vmcnt(4) lgkmcnt(0)
    v_mfma_f32_32x32x16_bf16 v[0:15], v[80:83], v[176:179], v[0:15]
    ds_read_b64_tr_b16 v[184:185], v246 offset:6144
    ds_read_b64_tr_b16 v[186:187], v246 offset:6656
    ds_read_b64_tr_b16 v[188:189], v247 offset:6144
    ds_read_b64_tr_b16 v[190:191], v247 offset:6656
    s_mov_b32 m0, s70
    v_mfma_f32_32x32x16_bf16 v[16:31], v[84:87], v[176:179], v[16:31]
    buffer_load_dwordx4 v226, s[4:7], s43 offen sc1 lds
    buffer_load_dwordx4 v227, s[72:75], s43 offen offset:1024 sc1 lds
    v_mfma_f32_32x32x16_bf16 v[32:47], v[80:83], v[180:183], v[32:47]
    v_add_u32 v222, s48, v251
    ds_read_b32 v222, v222
    v_mfma_f32_32x32x16_bf16 v[48:63], v[84:87], v[180:183], v[48:63]
    s_waitcnt vmcnt(4) lgkmcnt(1)
    v_mfma_f32_32x32x16_bf16 v[0:15], v[88:91], v[184:187], v[0:15]
    ds_read_b64_tr_b16 v[176:177], v246 offset:0
    ds_read_b64_tr_b16 v[178:179], v246 offset:512
    ds_read_b64_tr_b16 v[180:181], v247 offset:0
    ds_read_b64_tr_b16 v[182:183], v247 offset:512
    s_mov_b32 m0, s71
    v_mfma_f32_32x32x16_bf16 v[16:31], v[92:95], v[184:187], v[16:31]
    buffer_load_dwordx4 v228, s[4:7], s43 offen sc1 lds
    buffer_load_dwordx4 v229, s[72:75], s43 offen offset:1024 sc1 lds
    s_waitcnt lgkmcnt(4)
    v_mad_u32_u16 v223, v222, s39, v248 op_sel:[1,0,0,0]
    v_mad_u32_u16 v222, v222, s39, v248
    v_mfma_f32_32x32x16_bf16 v[32:47], v[88:91], v[188:191], v[32:47]
    v_add_u32 v224, s49, v251
    ds_read_b32 v224, v224
    v_mul_f32 v242, v0, v144
    v_fma_f32 v238, v8, v160, -v238
    v_fmac_f32 v242, v1, v145
    v_fmac_f32 v238, v9, v161
    v_fmac_f32 v242, v2, v146
    v_mfma_f32_32x32x16_bf16 v[48:63], v[92:95], v[188:191], v[48:63]
    s_setprio 0
    v_fmac_f32 v238, v10, v162
    v_fmac_f32 v242, v3, v147
    v_fmac_f32 v238, v11, v163
    v_fmac_f32 v242, v4, v148
    v_fmac_f32 v238, v12, v164
    v_fmac_f32 v242, v5, v149
    v_fmac_f32 v238, v13, v165
    v_fmac_f32 v242, v6, v150
    v_fmac_f32 v238, v14, v166
    v_fmac_f32 v242, v7, v151
    v_fmac_f32 v238, v15, v167
    v_fmac_f32 v236, v16, v112
    v_mul_f32 v244, v24, v160
    v_fmac_f32 v236, v17, v113
    v_fmac_f32 v244, v25, v161
    v_fmac_f32 v236, v18, v114
    v_fmac_f32 v244, v26, v162
    v_fmac_f32 v236, v19, v115
    v_fmac_f32 v244, v27, v163
    v_fmac_f32 v236, v20, v116
    v_fmac_f32 v244, v28, v164
    v_fmac_f32 v236, v21, v117
    v_fmac_f32 v244, v29, v165
    v_fmac_f32 v236, v22, v118
    v_fmac_f32 v244, v30, v166
    v_fmac_f32 v236, v23, v119
    v_fmac_f32 v244, v31, v167
    v_mul_f32 v243, v32, v152
    v_fma_f32 v239, v40, v168, -v239
    v_fmac_f32 v243, v33, v153
    v_fmac_f32 v239, v41, v169
    v_fmac_f32 v243, v34, v154
    v_fmac_f32 v239, v42, v170
    v_fmac_f32 v243, v35, v155
    v_fmac_f32 v239, v43, v171
    v_fmac_f32 v243, v36, v156
    v_fmac_f32 v239, v44, v172
    v_fmac_f32 v243, v37, v157
    v_fmac_f32 v239, v45, v173
    v_fmac_f32 v243, v38, v158
    v_fmac_f32 v239, v46, v174
    v_fmac_f32 v243, v39, v159
    v_fmac_f32 v239, v47, v175
    v_fmac_f32 v237, v48, v120
    v_mul_f32 v245, v56, v168
    v_fmac_f32 v237, v49, v121
    v_fmac_f32 v245, v57, v169
    v_fmac_f32 v237, v50, v122
    v_fmac_f32 v245, v58, v170
    v_fmac_f32 v237, v51, v123
    s_setprio 1
    s_waitcnt vmcnt(4) lgkmcnt(1)
    v_mfma_f32_32x32x16_bf16 v[0:15], v[64:67], v[176:179], 0
    ds_read_b64_tr_b16 v[184:185], v246 offset:2048
    ds_read_b64_tr_b16 v[186:187], v246 offset:2560
    ds_read_b64_tr_b16 v[188:189], v247 offset:2048
    ds_read_b64_tr_b16 v[190:191], v247 offset:2560
    v_fmac_f32 v245, v59, v171
    v_fmac_f32 v237, v52, v124
    s_mov_b32 m0, s68
    v_mfma_f32_32x32x16_bf16 v[16:31], v[68:71], v[176:179], 0
    buffer_load_dwordx4 v222, s[4:7], s44 offen sc1 lds
    buffer_load_dwordx4 v223, s[72:75], s44 offen offset:1024 sc1 lds
    s_waitcnt lgkmcnt(4)
    v_mad_u32_u16 v225, v224, s39, v248 op_sel:[1,0,0,0]
    v_mad_u32_u16 v224, v224, s39, v248
    v_fmac_f32 v245, v60, v172
    v_fmac_f32 v237, v53, v125
    v_mfma_f32_32x32x16_bf16 v[32:47], v[64:67], v[180:183], 0
    v_add_u32 v226, s50, v251
    ds_read_b32 v226, v226
    v_fmac_f32 v245, v61, v173
    v_fmac_f32 v237, v54, v126
    v_fmac_f32 v245, v62, v174
    v_fmac_f32 v237, v55, v127
    v_fmac_f32 v245, v63, v175
    v_mfma_f32_32x32x16_bf16 v[48:63], v[68:71], v[180:183], 0
    v_permlane32_swap_b32 v242, v234
    v_permlane32_swap_b32 v243, v235
    v_add_f32 v242, v242, v234
    v_add_f32 v243, v243, v235
    s_waitcnt vmcnt(4) lgkmcnt(1)
    v_mfma_f32_32x32x16_bf16 v[0:15], v[72:75], v[184:187], v[0:15]
    ds_read_b64_tr_b16 v[176:177], v246 offset:4096
    ds_read_b64_tr_b16 v[178:179], v246 offset:4608
    ds_read_b64_tr_b16 v[180:181], v247 offset:4096
    ds_read_b64_tr_b16 v[182:183], v247 offset:4608
    s_mov_b32 m0, s69
    v_mfma_f32_32x32x16_bf16 v[16:31], v[76:79], v[184:187], v[16:31]
    buffer_load_dwordx4 v224, s[4:7], s45 offen sc1 lds
    buffer_load_dwordx4 v225, s[72:75], s45 offen offset:1024 sc1 lds
    s_waitcnt lgkmcnt(4)
    v_mad_u32_u16 v227, v226, s39, v248 op_sel:[1,0,0,0]
    v_mad_u32_u16 v226, v226, s39, v248
    v_mfma_f32_32x32x16_bf16 v[32:47], v[72:75], v[188:191], v[32:47]
    v_add_u32 v228, s51, v251
    ds_read_b32 v228, v228
    s_set_gpr_idx_on s31, gpr_idx(DST)
    s_nop 0
    v_cvt_pk_bf16_f32 v194, v242, v243
    s_set_gpr_idx_off
    v_mfma_f32_32x32x16_bf16 v[48:63], v[76:79], v[188:191], v[48:63]
    s_waitcnt vmcnt(4) lgkmcnt(1)
    v_mfma_f32_32x32x16_bf16 v[0:15], v[80:83], v[176:179], v[0:15]
    ds_read_b64_tr_b16 v[184:185], v246 offset:6144
    ds_read_b64_tr_b16 v[186:187], v246 offset:6656
    ds_read_b64_tr_b16 v[188:189], v247 offset:6144
    ds_read_b64_tr_b16 v[190:191], v247 offset:6656
    s_mov_b32 s32, s31
    s_mov_b32 s31, s35
    s_mov_b32 m0, s70
    v_mfma_f32_32x32x16_bf16 v[16:31], v[84:87], v[176:179], v[16:31]
    buffer_load_dwordx4 v226, s[4:7], s46 offen sc1 lds
    buffer_load_dwordx4 v227, s[72:75], s46 offen offset:1024 sc1 lds
    s_waitcnt lgkmcnt(4)
    v_mad_u32_u16 v229, v228, s39, v248 op_sel:[1,0,0,0]
    v_mad_u32_u16 v228, v228, s39, v248
    s_sub_u32 s26, s48, s29
    s_mov_b32 s29, s48
    v_mfma_f32_32x32x16_bf16 v[32:47], v[80:83], v[180:183], v[32:47]
    s_mov_b32 s30, s3
    s_cmp_eq_u32 s34, 0
    s_cselect_b32 s56, s33, 0
    v_mfma_f32_32x32x16_bf16 v[48:63], v[84:87], v[180:183], v[48:63]
    s_waitcnt vmcnt(4) lgkmcnt(0)
    v_mfma_f32_32x32x16_bf16 v[0:15], v[88:91], v[184:187], v[0:15]
    ds_read_b64_tr_b16 v[176:177], v246 offset:0
    ds_read_b64_tr_b16 v[178:179], v246 offset:512
    ds_read_b64_tr_b16 v[180:181], v247 offset:0
    ds_read_b64_tr_b16 v[182:183], v247 offset:512
    s_mov_b32 m0, s71
    v_mfma_f32_32x32x16_bf16 v[16:31], v[92:95], v[184:187], v[16:31]
    buffer_load_dwordx4 v228, s[4:7], s47 offen sc1 lds
    buffer_load_dwordx4 v229, s[72:75], s47 offen offset:1024 sc1 lds
    v_mfma_f32_32x32x16_bf16 v[32:47], v[88:91], v[188:191], v[32:47]
    s_nop 2
    v_mul_f32 v242, v0, v144
    v_fma_f32 v240, v8, v160, -v240
    v_fmac_f32 v242, v1, v145
    v_fmac_f32 v240, v9, v161
    v_fmac_f32 v242, v2, v146
    v_fmac_f32 v240, v10, v162
    v_fmac_f32 v242, v3, v147
    v_mfma_f32_32x32x16_bf16 v[48:63], v[92:95], v[188:191], v[48:63]
    s_setprio 0
    v_fmac_f32 v240, v11, v163
    v_fmac_f32 v242, v4, v148
    v_fmac_f32 v240, v12, v164
    v_fmac_f32 v242, v5, v149
    v_fmac_f32 v240, v13, v165
    v_fmac_f32 v242, v6, v150
    v_fmac_f32 v240, v14, v166
    v_fmac_f32 v242, v7, v151
    v_fmac_f32 v240, v15, v167
    v_add_u32 v249, s26, v249
    v_add_u32 v250, s26, v250
    v_fma_f32 v244, v16, v160, -v244
    v_fmac_f32 v236, v24, v112
    v_fmac_f32 v244, v17, v161
    v_fmac_f32 v236, v25, v113
    v_fmac_f32 v244, v18, v162
    v_fmac_f32 v236, v26, v114
    v_fmac_f32 v244, v19, v163
    v_fmac_f32 v236, v27, v115
    v_fmac_f32 v244, v20, v164
    v_fmac_f32 v236, v28, v116
    v_fmac_f32 v244, v21, v165
    v_fmac_f32 v236, v29, v117
    v_fmac_f32 v244, v22, v166
    v_fmac_f32 v236, v30, v118
    v_fmac_f32 v244, v23, v167
    v_fmac_f32 v236, v31, v119
    ds_read_b64_tr_b16 v[0:1], v249 offset:0
    ds_read_b64_tr_b16 v[2:3], v249 offset:256
    ds_read_u16_d16_hi v16, v250 offset:0
    v_mul_f32 v243, v32, v152
    v_fma_f32 v241, v40, v168, -v241
    v_fmac_f32 v243, v33, v153
    v_fmac_f32 v241, v41, v169
    v_fmac_f32 v243, v34, v154
    v_fmac_f32 v241, v42, v170
    v_fmac_f32 v243, v35, v155
    v_fmac_f32 v241, v43, v171
    v_fmac_f32 v243, v36, v156
    v_fmac_f32 v241, v44, v172
    v_fmac_f32 v243, v37, v157
    v_fmac_f32 v241, v45, v173
    v_fmac_f32 v243, v38, v158
    v_fmac_f32 v241, v46, v174
    v_fmac_f32 v243, v39, v159
    v_fmac_f32 v241, v47, v175
    ds_read_b64_tr_b16 v[4:5], v249 offset:512
    ds_read_b64_tr_b16 v[6:7], v249 offset:768
    ds_read_u16_d16_hi v17, v250 offset:32
    v_fma_f32 v245, v48, v168, -v245
    v_fmac_f32 v237, v56, v120
    v_fmac_f32 v245, v49, v169
    v_fmac_f32 v237, v57, v121
    v_fmac_f32 v245, v50, v170
    v_fmac_f32 v237, v58, v122
    v_fmac_f32 v245, v51, v171
    v_fmac_f32 v237, v59, v123
    v_fmac_f32 v245, v52, v172
    v_fmac_f32 v237, v60, v124
    v_fmac_f32 v245, v53, v173
    v_fmac_f32 v237, v61, v125
    v_fmac_f32 v245, v54, v174
    v_fmac_f32 v237, v62, v126
    v_fmac_f32 v245, v55, v175
    v_fmac_f32 v237, v63, v127
    s_cmp_eq_u32 s56, 2
    s_cbranch_scc1 K2_U20
    s_cmp_eq_u32 s56, 3
    s_cbranch_scc1 K2_U30
    s_branch K2_DSP0
K2_U11:
    s_setprio 1
    v_mov_b32 v254, 163296
    v_mov_b32 v255, 1
    v_lshl_add_u32 v233, v252, 1, s53
    s_mov_b64 exec, 1
    ds_add_rtn_u32 v232, v254, v255
    s_mov_b64 exec, -1
    ds_read_b32 v233, v233
    s_waitcnt lgkmcnt(5)
    v_lshlrev_b32 v20, 16, v0
    v_and_b32 v21, 0xffff0000, v0
    v_lshlrev_b32 v22, 16, v1
    v_and_b32 v23, 0xffff0000, v1
    v_lshlrev_b32 v24, 16, v2
    v_and_b32 v25, 0xffff0000, v2
    v_lshlrev_b32 v26, 16, v3
    v_and_b32 v27, 0xffff0000, v3
    v_mul_f32_dpp v36, v16, v20 row_newbcast:8 row_mask:0xf bank_mask:0xf
    v_mul_f32_dpp v37, v16, v21 row_newbcast:9 row_mask:0xf bank_mask:0xf
    v_mul_f32_dpp v38, v16, v22 row_newbcast:10 row_mask:0xf bank_mask:0xf
    v_mul_f32_dpp v39, v16, v23 row_newbcast:11 row_mask:0xf bank_mask:0xf
    v_mul_f32_dpp v40, v16, v24 row_newbcast:12 row_mask:0xf bank_mask:0xf
    v_mul_f32_dpp v41, v16, v25 row_newbcast:13 row_mask:0xf bank_mask:0xf
    v_mul_f32_dpp v42, v16, v26 row_newbcast:14 row_mask:0xf bank_mask:0xf
    v_mul_f32_dpp v43, v16, v27 row_newbcast:15 row_mask:0xf bank_mask:0xf
    v_cvt_pk_bf16_f32 v68, v36, v37
    v_cvt_pk_bf16_f32 v69, v38, v39
    v_cvt_pk_bf16_f32 v70, v40, v41
    v_cvt_pk_bf16_f32 v71, v42, v43
    v_mul_f32_dpp v20, v16, v20 row_newbcast:0 row_mask:0xa bank_mask:0xf
    v_mul_f32_dpp v21, v16, v21 row_newbcast:1 row_mask:0xa bank_mask:0xf
    v_mul_f32_dpp v22, v16, v22 row_newbcast:2 row_mask:0xa bank_mask:0xf
    v_mul_f32_dpp v23, v16, v23 row_newbcast:3 row_mask:0xa bank_mask:0xf
    v_mul_f32_dpp v24, v16, v24 row_newbcast:4 row_mask:0xa bank_mask:0xf
    v_mul_f32_dpp v25, v16, v25 row_newbcast:5 row_mask:0xa bank_mask:0xf
    v_mul_f32_dpp v26, v16, v26 row_newbcast:6 row_mask:0xa bank_mask:0xf
    v_mul_f32_dpp v27, v16, v27 row_newbcast:7 row_mask:0xa bank_mask:0xf
    v_cvt_pk_bf16_f32 v64, v20, v21
    v_cvt_pk_bf16_f32 v65, v22, v23
    v_cvt_pk_bf16_f32 v66, v24, v25
    v_cvt_pk_bf16_f32 v67, v26, v27
    s_waitcnt lgkmcnt(0)
    v_readfirstlane_b32 s58, v232
    s_nop 0
    s_cmp_lt_u32 s58, s22
    s_cbranch_scc0 K2_nul_74
    s_and_b32 s59, s58, 7
    s_lshr_b32 s60, s58, 3
K2_chk_76:
    v_readlane_b32 s61, v233, s59
    s_nop 0
    s_cmp_gt_u32 s61, s60
    s_cbranch_scc0 K2_spin_75
K2_back_77:
    v_readlane_b32 s3, v253, s58
    s_lshl_b32 s44, s34, 7
    s_and_b32 s48, s3, 0x3ffff
    s_bfe_u32 s33, s3, 0x30012
    s_mov_b32 s35, s48
    s_mov_b32 s45, s44
    s_add_u32 s47, s44, 256
    s_add_u32 s49, s48, 32
    s_add_u32 s60, s48, 64
    s_cmp_eq_u32 s33, 3
    s_cselect_b32 s46, s44, s47
    s_cselect_b32 s50, s60, s48
    s_cselect_b32 s51, s48, s49
    s_sub_u32 s60, s33, 2
    s_cmp_lt_u32 s60, 2
    s_cbranch_scc0 K2_rare_78
K2_back_79:
    v_add_u32 v222, s48, v251
    ds_read_b32 v222, v222
    v_add_u32 v224, s49, v251
    ds_read_b32 v224, v224
    v_add_u32 v226, s50, v251
    ds_read_b32 v226, v226
    v_add_u32 v228, s51, v251
    ds_read_b32 v228, v228
    s_waitcnt lgkmcnt(3)
    v_mad_u32_u16 v223, v222, s39, v248 op_sel:[1,0,0,0]
    v_mad_u32_u16 v222, v222, s39, v248
    s_waitcnt lgkmcnt(2)
    v_mad_u32_u16 v225, v224, s39, v248 op_sel:[1,0,0,0]
    v_mad_u32_u16 v224, v224, s39, v248
    s_waitcnt lgkmcnt(1)
    v_mad_u32_u16 v227, v226, s39, v248 op_sel:[1,0,0,0]
    v_mad_u32_u16 v226, v226, s39, v248
    s_waitcnt lgkmcnt(0)
    v_mad_u32_u16 v229, v228, s39, v248 op_sel:[1,0,0,0]
    v_mad_u32_u16 v228, v228, s39, v248
    s_waitcnt vmcnt(4)
    v_mfma_f32_32x32x16_bf16 v[0:15], v[64:67], v[176:179], 0
    ds_read_b64_tr_b16 v[184:185], v246 offset:2048
    ds_read_b64_tr_b16 v[186:187], v246 offset:2560
    ds_read_b64_tr_b16 v[188:189], v247 offset:2048
    ds_read_b64_tr_b16 v[190:191], v247 offset:2560
    s_mov_b32 m0, s68
    v_mfma_f32_32x32x16_bf16 v[16:31], v[68:71], v[176:179], 0
    buffer_load_dwordx4 v222, s[4:7], s44 offen sc1 lds
    buffer_load_dwordx4 v223, s[72:75], s44 offen offset:1024 sc1 lds
    v_permlane32_swap_b32 v242, v236
    v_permlane32_swap_b32 v243, v237
    v_mfma_f32_32x32x16_bf16 v[32:47], v[64:67], v[180:183], 0
    v_permlane32_swap_b32 v244, v238
    v_permlane32_swap_b32 v245, v239
    v_permlane32_swap_b32 v240, v241
    v_add_f32 v242, v242, v236
    v_mfma_f32_32x32x16_bf16 v[48:63], v[68:71], v[180:183], 0
    s_setprio 0
    v_add_f32 v243, v243, v237
    v_add_f32 v244, v244, v238
    v_add_f32 v245, v245, v239
    v_add_f32 v240, -v240, -v241
    v_sub_u32 v241, v230, v231
    v_cvt_pk_bf16_f32 v242, v242, v243
    v_cvt_pk_bf16_f32 v244, v244, v245
    v_cvt_pk_bf16_f32 v240, v240, v240
    ds_write_b32 v230, v242 offset:768
    ds_write_b32 v230, v244 offset:1024
    ds_write_b16 v241, v240 offset:1280
    v_mul_f32 v234, v0, v96
    v_mul_f32 v236, v8, v128
    v_fmac_f32 v234, v1, v97
    v_fmac_f32 v236, v9, v129
    v_fmac_f32 v234, v2, v98
    v_fmac_f32 v236, v10, v130
    v_fmac_f32 v234, v3, v99
    v_fmac_f32 v236, v11, v131
    v_fmac_f32 v234, v4, v100
    v_fmac_f32 v236, v12, v132
    v_fmac_f32 v234, v5, v101
    v_fmac_f32 v236, v13, v133
    v_fmac_f32 v234, v6, v102
    v_fmac_f32 v236, v14, v134
    v_fmac_f32 v234, v7, v103
    v_fmac_f32 v236, v15, v135
    v_mul_f32 v238, v16, v128
    v_mul_f32 v240, v24, v128
    v_fmac_f32 v238, v17, v129
    v_fmac_f32 v240, v25, v129
    v_fmac_f32 v238, v18, v130
    v_fmac_f32 v240, v26, v130
    v_fmac_f32 v238, v19, v131
    v_fmac_f32 v240, v27, v131
    v_fmac_f32 v238, v20, v132
    v_fmac_f32 v240, v28, v132
    v_fmac_f32 v238, v21, v133
    v_fmac_f32 v240, v29, v133
    v_fmac_f32 v238, v22, v134
    v_fmac_f32 v240, v30, v134
    v_fmac_f32 v238, v23, v135
    v_fmac_f32 v240, v31, v135
    v_mul_f32 v235, v32, v104
    v_mul_f32 v237, v40, v136
    v_fmac_f32 v235, v33, v105
    v_fmac_f32 v237, v41, v137
    v_fmac_f32 v235, v34, v106
    v_fmac_f32 v237, v42, v138
    v_fmac_f32 v235, v35, v107
    v_fmac_f32 v237, v43, v139
    v_fmac_f32 v235, v36, v108
    v_fmac_f32 v237, v44, v140
    v_fmac_f32 v235, v37, v109
    v_fmac_f32 v237, v45, v141
    v_fmac_f32 v235, v38, v110
    v_fmac_f32 v237, v46, v142
    v_fmac_f32 v235, v39, v111
    v_fmac_f32 v237, v47, v143
    v_mul_f32 v239, v48, v136
    v_mul_f32 v241, v56, v136
    v_fmac_f32 v239, v49, v137
    v_fmac_f32 v241, v57, v137
    v_fmac_f32 v239, v50, v138
    v_fmac_f32 v241, v58, v138
    v_fmac_f32 v239, v51, v139
    v_fmac_f32 v241, v59, v139
    v_fmac_f32 v239, v52, v140
    v_fmac_f32 v241, v60, v140
    v_fmac_f32 v239, v53, v141
    v_fmac_f32 v241, v61, v141
    v_fmac_f32 v239, v54, v142
    v_fmac_f32 v241, v62, v142
    v_fmac_f32 v239, v55, v143
    v_fmac_f32 v241, v63, v143
    s_setprio 1
    s_waitcnt vmcnt(4) lgkmcnt(3)
    v_mfma_f32_32x32x16_bf16 v[0:15], v[64:67], v[184:187], 0
    ds_read_b64_tr_b16 v[176:177], v246 offset:4096
    ds_read_b64_tr_b16 v[178:179], v246 offset:4608
    ds_read_b64_tr_b16 v[180:181], v247 offset:4096
    ds_read_b64_tr_b16 v[182:183], v247 offset:4608
    s_mov_b32 m0, s69
    v_mfma_f32_32x32x16_bf16 v[16:31], v[68:71], v[184:187], 0
    buffer_load_dwordx4 v224, s[4:7], s45 offen sc1 lds
    buffer_load_dwordx4 v225, s[72:75], s45 offen offset:1024 sc1 lds
    v_permlane32_swap_b32 v234, v236
    v_permlane32_swap_b32 v235, v237
    v_mfma_f32_32x32x16_bf16 v[32:47], v[64:67], v[188:191], 0
    v_permlane32_swap_b32 v240, v238
    v_permlane32_swap_b32 v241, v239
    v_lshl_add_u32 v230, v252, 1, s31
    v_add_f32 v234, v234, v236
    v_add_f32 v235, v235, v237
    v_mfma_f32_32x32x16_bf16 v[48:63], v[68:71], v[188:191], 0
    s_setprio 0
    v_add_f32 v240, v240, v238
    v_add_f32 v241, v241, v239
    v_cvt_pk_bf16_f32 v234, v234, v235
    v_cvt_pk_bf16_f32 v240, v240, v241
    ds_write_b32 v230, v234 offset:0
    ds_write_b32 v230, v240 offset:256
    v_mul_f32 v234, v0, v144
    v_mul_f32 v236, v8, v112
    v_fmac_f32 v234, v1, v145
    v_fmac_f32 v236, v9, v113
    v_fmac_f32 v234, v2, v146
    v_fmac_f32 v236, v10, v114
    v_fmac_f32 v234, v3, v147
    v_fmac_f32 v236, v11, v115
    v_fmac_f32 v234, v4, v148
    v_fmac_f32 v236, v12, v116
    v_fmac_f32 v234, v5, v149
    v_fmac_f32 v236, v13, v117
    v_fmac_f32 v234, v6, v150
    v_fmac_f32 v236, v14, v118
    v_fmac_f32 v234, v7, v151
    v_fmac_f32 v236, v15, v119
    v_mul_f32 v238, v16, v160
    v_mul_f32 v240, v24, v160
    v_fmac_f32 v238, v17, v161
    v_fmac_f32 v240, v25, v161
    v_fmac_f32 v238, v18, v162
    v_fmac_f32 v240, v26, v162
    v_fmac_f32 v238, v19, v163
    v_fmac_f32 v240, v27, v163
    v_fmac_f32 v238, v20, v164
    v_fmac_f32 v240, v28, v164
    v_fmac_f32 v238, v21, v165
    v_fmac_f32 v240, v29, v165
    v_fmac_f32 v238, v22, v166
    v_fmac_f32 v240, v30, v166
    v_fmac_f32 v238, v23, v167
    v_fmac_f32 v240, v31, v167
    v_mul_f32 v235, v32, v152
    v_mul_f32 v237, v40, v120
    v_fmac_f32 v235, v33, v153
    v_fmac_f32 v237, v41, v121
    v_fmac_f32 v235, v34, v154
    v_fmac_f32 v237, v42, v122
    v_fmac_f32 v235, v35, v155
    v_fmac_f32 v237, v43, v123
    v_fmac_f32 v235, v36, v156
    v_fmac_f32 v237, v44, v124
    v_fmac_f32 v235, v37, v157
    v_fmac_f32 v237, v45, v125
    v_fmac_f32 v235, v38, v158
    v_fmac_f32 v237, v46, v126
    v_fmac_f32 v235, v39, v159
    v_fmac_f32 v237, v47, v127
    v_mul_f32 v239, v48, v168
    v_mul_f32 v241, v56, v168
    v_fmac_f32 v239, v49, v169
    v_fmac_f32 v241, v57, v169
    v_fmac_f32 v239, v50, v170
    v_fmac_f32 v241, v58, v170
    v_fmac_f32 v239, v51, v171
    v_fmac_f32 v241, v59, v171
    v_fmac_f32 v239, v52, v172
    v_fmac_f32 v241, v60, v172
    v_fmac_f32 v239, v53, v173
    v_fmac_f32 v241, v61, v173
    v_fmac_f32 v239, v54, v174
    v_fmac_f32 v241, v62, v174
    v_fmac_f32 v239, v55, v175
    v_fmac_f32 v241, v63, v175
    s_setprio 1
    s_waitcnt vmcnt(4) lgkmcnt(2)
    v_mfma_f32_32x32x16_bf16 v[0:15], v[64:67], v[176:179], 0
    ds_read_b64_tr_b16 v[184:185], v246 offset:6144
    ds_read_b64_tr_b16 v[186:187], v246 offset:6656
    ds_read_b64_tr_b16 v[188:189], v247 offset:6144
    ds_read_b64_tr_b16 v[190:191], v247 offset:6656
    s_mov_b32 s32, s31
    s_mov_b32 s31, s35
    s_mov_b32 m0, s70
    v_mfma_f32_32x32x16_bf16 v[16:31], v[68:71], v[176:179], 0
    buffer_load_dwordx4 v226, s[4:7], s46 offen sc1 lds
    buffer_load_dwordx4 v227, s[72:75], s46 offen offset:1024 sc1 lds
    s_sub_u32 s26, s48, s29
    s_mov_b32 s29, s48
    s_mov_b32 s30, s3
    s_cmp_lg_u32 s36, 0
    s_cselect_b32 s56, s33, 0
    v_mfma_f32_32x32x16_bf16 v[32:47], v[64:67], v[180:183], 0
    v_mfma_f32_32x32x16_bf16 v[48:63], v[68:71], v[180:183], 0
    s_setprio 0
    v_mul_f32 v242, v0, v144
    v_fma_f32 v238, v8, v160, -v238
    v_fmac_f32 v242, v1, v145
    v_fmac_f32 v238, v9, v161
    v_fmac_f32 v242, v2, v146
    v_fmac_f32 v238, v10, v162
    v_fmac_f32 v242, v3, v147
    v_fmac_f32 v238, v11, v163
    v_fmac_f32 v242, v4, v148
    v_fmac_f32 v238, v12, v164
    v_fmac_f32 v242, v5, v149
    v_fmac_f32 v238, v13, v165
    v_fmac_f32 v242, v6, v150
    v_fmac_f32 v238, v14, v166
    v_fmac_f32 v242, v7, v151
    v_fmac_f32 v238, v15, v167
    v_fmac_f32 v236, v16, v112
    v_mul_f32 v244, v24, v160
    v_fmac_f32 v236, v17, v113
    v_fmac_f32 v244, v25, v161
    v_fmac_f32 v236, v18, v114
    v_fmac_f32 v244, v26, v162
    v_fmac_f32 v236, v19, v115
    v_fmac_f32 v244, v27, v163
    v_fmac_f32 v236, v20, v116
    v_fmac_f32 v244, v28, v164
    v_fmac_f32 v236, v21, v117
    v_fmac_f32 v244, v29, v165
    v_fmac_f32 v236, v22, v118
    v_fmac_f32 v244, v30, v166
    v_fmac_f32 v236, v23, v119
    v_fmac_f32 v244, v31, v167
    v_mul_f32 v243, v32, v152
    v_fma_f32 v239, v40, v168, -v239
    v_fmac_f32 v243, v33, v153
    v_fmac_f32 v239, v41, v169
    v_fmac_f32 v243, v34, v154
    v_fmac_f32 v239, v42, v170
    v_fmac_f32 v243, v35, v155
    v_fmac_f32 v239, v43, v171
    v_fmac_f32 v243, v36, v156
    v_fmac_f32 v239, v44, v172
    v_fmac_f32 v243, v37, v157
    v_fmac_f32 v239, v45, v173
    v_fmac_f32 v243, v38, v158
    v_fmac_f32 v239, v46, v174
    v_fmac_f32 v243, v39, v159
    v_fmac_f32 v239, v47, v175
    v_fmac_f32 v237, v48, v120
    v_mul_f32 v245, v56, v168
    v_fmac_f32 v237, v49, v121
    v_fmac_f32 v245, v57, v169
    v_fmac_f32 v237, v50, v122
    v_fmac_f32 v245, v58, v170
    v_fmac_f32 v237, v51, v123
    v_fmac_f32 v245, v59, v171
    v_fmac_f32 v237, v52, v124
    v_fmac_f32 v245, v60, v172
    v_fmac_f32 v237, v53, v125
    v_fmac_f32 v245, v61, v173
    v_fmac_f32 v237, v54, v126
    v_fmac_f32 v245, v62, v174
    v_fmac_f32 v237, v55, v127
    v_fmac_f32 v245, v63, v175
    s_setprio 1
    s_waitcnt vmcnt(4) lgkmcnt(0)
    v_mfma_f32_32x32x16_bf16 v[0:15], v[64:67], v[184:187], 0
    ds_read_b64_tr_b16 v[176:177], v246 offset:0
    ds_read_b64_tr_b16 v[178:179], v246 offset:512
    ds_read_b64_tr_b16 v[180:181], v247 offset:0
    ds_read_b64_tr_b16 v[182:183], v247 offset:512
    s_mov_b32 m0, s71
    v_mfma_f32_32x32x16_bf16 v[16:31], v[68:71], v[184:187], 0
    buffer_load_dwordx4 v228, s[4:7], s47 offen sc1 lds
    buffer_load_dwordx4 v229, s[72:75], s47 offen offset:1024 sc1 lds
    v_permlane32_swap_b32 v242, v234
    v_permlane32_swap_b32 v243, v235
    v_add_f32 v242, v242, v234
    v_mfma_f32_32x32x16_bf16 v[32:47], v[64:67], v[188:191], 0
    v_add_f32 v243, v243, v235
    v_cvt_pk_bf16_f32 v242, v242, v243
    ds_write_b32 v230, v242 offset:512
    v_mfma_f32_32x32x16_bf16 v[48:63], v[68:71], v[188:191], 0
    s_setprio 0
    v_mul_f32 v242, v0, v144
    v_fma_f32 v240, v8, v160, -v240
    v_fmac_f32 v242, v1, v145
    v_fmac_f32 v240, v9, v161
    v_fmac_f32 v242, v2, v146
    v_fmac_f32 v240, v10, v162
    v_fmac_f32 v242, v3, v147
    v_fmac_f32 v240, v11, v163
    v_fmac_f32 v242, v4, v148
    v_fmac_f32 v240, v12, v164
    v_fmac_f32 v242, v5, v149
    v_fmac_f32 v240, v13, v165
    v_fmac_f32 v242, v6, v150
    v_fmac_f32 v240, v14, v166
    v_fmac_f32 v242, v7, v151
    v_fmac_f32 v240, v15, v167
    v_add_u32 v249, s26, v249
    v_add_u32 v250, s26, v250
    v_fma_f32 v244, v16, v160, -v244
    v_fmac_f32 v236, v24, v112
    v_fmac_f32 v244, v17, v161
    v_fmac_f32 v236, v25, v113
    v_fmac_f32 v244, v18, v162
    v_fmac_f32 v236, v26, v114
    v_fmac_f32 v244, v19, v163
    v_fmac_f32 v236, v27, v115
    v_fmac_f32 v244, v20, v164
    v_fmac_f32 v236, v28, v116
    v_fmac_f32 v244, v21, v165
    v_fmac_f32 v236, v29, v117
    v_fmac_f32 v244, v22, v166
    v_fmac_f32 v236, v30, v118
    v_fmac_f32 v244, v23, v167
    v_fmac_f32 v236, v31, v119
    ds_read_b64_tr_b16 v[0:1], v249 offset:0
    ds_read_b64_tr_b16 v[2:3], v249 offset:256
    ds_read_u16_d16_hi v16, v250 offset:0
    v_mul_f32 v243, v32, v152
    v_fma_f32 v241, v40, v168, -v241
    v_fmac_f32 v243, v33, v153
    v_fmac_f32 v241, v41, v169
    v_fmac_f32 v243, v34, v154
    v_fmac_f32 v241, v42, v170
    v_fmac_f32 v243, v35, v155
    v_fmac_f32 v241, v43, v171
    v_fmac_f32 v243, v36, v156
    v_fmac_f32 v241, v44, v172
    v_fmac_f32 v243, v37, v157
    v_fmac_f32 v241, v45, v173
    v_fmac_f32 v243, v38, v158
    v_fmac_f32 v241, v46, v174
    v_fmac_f32 v243, v39, v159
    v_fmac_f32 v241, v47, v175
    ds_read_b64_tr_b16 v[4:5], v249 offset:512
    ds_read_b64_tr_b16 v[6:7], v249 offset:768
    ds_read_u16_d16_hi v17, v250 offset:32
    v_fma_f32 v245, v48, v168, -v245
    v_fmac_f32 v237, v56, v120
    v_fmac_f32 v245, v49, v169
    v_fmac_f32 v237, v57, v121
    v_fmac_f32 v245, v50, v170
    v_fmac_f32 v237, v58, v122
    v_fmac_f32 v245, v51, v171
    v_fmac_f32 v237, v59, v123
    v_fmac_f32 v245, v52, v172
    v_fmac_f32 v237, v60, v124
    v_fmac_f32 v245, v53, v173
    v_fmac_f32 v237, v61, v125
    v_fmac_f32 v245, v54, v174
    v_fmac_f32 v237, v62, v126
    v_fmac_f32 v245, v55, v175
    v_fmac_f32 v237, v63, v127
    s_cmp_eq_u32 s56, 2
    s_cbranch_scc1 K2_U21
    s_cmp_eq_u32 s56, 3
    s_cbranch_scc1 K2_U31
    s_branch K2_DSP1
K2_U41:
    s_setprio 1
    ds_read_b64_tr_b16 v[8:9], v249 offset:1024
    ds_read_b64_tr_b16 v[10:11], v249 offset:1280
    ds_read_u16_d16_hi v18, v250 offset:64
    s_lshr_b32 s65, s30, 27
    s_mul_i32 s66, s22, 2080
    s_lshl_b32 s65, s65, 9
    s_add_u32 s65, s65, s66
    s_add_u32 s65, s65, 65536
    s_sub_u32 s65, s65, s29
    s_sub_u32 s65, s65, 512
    v_add_u32 v56, s65, v249
    ds_read_b64_tr_b16 v[12:13], v56 offset:0
    ds_read_b64_tr_b16 v[14:15], v56 offset:256
    ds_read_u16_d16_hi v19, v250 offset:96
    s_waitcnt lgkmcnt(6)
    v_lshlrev_b32 v20, 16, v0
    v_and_b32 v21, 0xffff0000, v0
    v_lshlrev_b32 v22, 16, v1
    v_and_b32 v23, 0xffff0000, v1
    v_lshlrev_b32 v24, 16, v2
    v_and_b32 v25, 0xffff0000, v2
    v_lshlrev_b32 v26, 16, v3
    v_and_b32 v27, 0xffff0000, v3
    v_mul_f32_dpp v36, v16, v20 row_newbcast:8 row_mask:0xf bank_mask:0xf
    v_mul_f32_dpp v37, v16, v21 row_newbcast:9 row_mask:0xf bank_mask:0xf
    v_mul_f32_dpp v38, v16, v22 row_newbcast:10 row_mask:0xf bank_mask:0xf
    v_mul_f32_dpp v39, v16, v23 row_newbcast:11 row_mask:0xf bank_mask:0xf
    v_mul_f32_dpp v40, v16, v24 row_newbcast:12 row_mask:0xf bank_mask:0xf
    v_mul_f32_dpp v41, v16, v25 row_newbcast:13 row_mask:0xf bank_mask:0xf
    v_mul_f32_dpp v42, v16, v26 row_newbcast:14 row_mask:0xf bank_mask:0xf
    v_mul_f32_dpp v43, v16, v27 row_newbcast:15 row_mask:0xf bank_mask:0xf
    v_cvt_pk_bf16_f32 v68, v36, v37
    v_cvt_pk_bf16_f32 v69, v38, v39
    v_cvt_pk_bf16_f32 v70, v40, v41
    v_cvt_pk_bf16_f32 v71, v42, v43
    v_mul_f32_dpp v20, v16, v20 row_newbcast:0 row_mask:0xa bank_mask:0xf
    v_mul_f32_dpp v21, v16, v21 row_newbcast:1 row_mask:0xa bank_mask:0xf
    v_mul_f32_dpp v22, v16, v22 row_newbcast:2 row_mask:0xa bank_mask:0xf
    v_mul_f32_dpp v23, v16, v23 row_newbcast:3 row_mask:0xa bank_mask:0xf
    v_mul_f32_dpp v24, v16, v24 row_newbcast:4 row_mask:0xa bank_mask:0xf
    v_mul_f32_dpp v25, v16, v25 row_newbcast:5 row_mask:0xa bank_mask:0xf
    v_mul_f32_dpp v26, v16, v26 row_newbcast:6 row_mask:0xa bank_mask:0xf
    v_mul_f32_dpp v27, v16, v27 row_newbcast:7 row_mask:0xa bank_mask:0xf
    v_cvt_pk_bf16_f32 v64, v20, v21
    v_cvt_pk_bf16_f32 v65, v22, v23
    v_cvt_pk_bf16_f32 v66, v24, v25
    v_cvt_pk_bf16_f32 v67, v26, v27
    v_lshlrev_b32 v28, 16, v4
    v_and_b32 v29, 0xffff0000, v4
    v_lshlrev_b32 v30, 16, v5
    v_and_b32 v31, 0xffff0000, v5
    v_lshlrev_b32 v32, 16, v6
    v_and_b32 v33, 0xffff0000, v6
    v_lshlrev_b32 v34, 16, v7
    v_and_b32 v35, 0xffff0000, v7
    v_mul_f32_dpp v36, v17, v28 row_newbcast:8 row_mask:0xf bank_mask:0xf
    v_mul_f32_dpp v37, v17, v29 row_newbcast:9 row_mask:0xf bank_mask:0xf
    v_mul_f32_dpp v38, v17, v30 row_newbcast:10 row_mask:0xf bank_mask:0xf
    v_mul_f32_dpp v39, v17, v31 row_newbcast:11 row_mask:0xf bank_mask:0xf
    v_mul_f32_dpp v40, v17, v32 row_newbcast:12 row_mask:0xf bank_mask:0xf
    v_mul_f32_dpp v41, v17, v33 row_newbcast:13 row_mask:0xf bank_mask:0xf
    v_mul_f32_dpp v42, v17, v34 row_newbcast:14 row_mask:0xf bank_mask:0xf
    v_mul_f32_dpp v43, v17, v35 row_newbcast:15 row_mask:0xf bank_mask:0xf
    v_cvt_pk_bf16_f32 v76, v36, v37
    v_cvt_pk_bf16_f32 v77, v38, v39
    v_cvt_pk_bf16_f32 v78, v40, v41
    v_cvt_pk_bf16_f32 v79, v42, v43
    v_mul_f32_dpp v28, v17, v28 row_newbcast:0 row_mask:0xa bank_mask:0xf
    v_mul_f32_dpp v29, v17, v29 row_newbcast:1 row_mask:0xa bank_mask:0xf
    v_mul_f32_dpp v30, v17, v30 row_newbcast:2 row_mask:0xa bank_mask:0xf
    v_mul_f32_dpp v31, v17, v31 row_newbcast:3 row_mask:0xa bank_mask:0xf
    v_mul_f32_dpp v32, v17, v32 row_newbcast:4 row_mask:0xa bank_mask:0xf
    v_mul_f32_dpp v33, v17, v33 row_newbcast:5 row_mask:0xa bank_mask:0xf
    v_mul_f32_dpp v34, v17, v34 row_newbcast:6 row_mask:0xa bank_mask:0xf
    v_mul_f32_dpp v35, v17, v35 row_newbcast:7 row_mask:0xa bank_mask:0xf
    v_cvt_pk_bf16_f32 v72, v28, v29
    v_cvt_pk_bf16_f32 v73, v30, v31
    v_cvt_pk_bf16_f32 v74, v32, v33
    v_cvt_pk_bf16_f32 v75, v34, v35
    s_waitcnt lgkmcnt(3)
    v_lshlrev_b32 v20, 16, v8
    v_and_b32 v21, 0xffff0000, v8
    v_lshlrev_b32 v22, 16, v9
    v_and_b32 v23, 0xffff0000, v9
    v_lshlrev_b32 v24, 16, v10
    v_and_b32 v25, 0xffff0000, v10
    v_lshlrev_b32 v26, 16, v11
    v_and_b32 v27, 0xffff0000, v11
    v_mul_f32_dpp v36, v18, v20 row_newbcast:8 row_mask:0xf bank_mask:0xf
    v_mul_f32_dpp v37, v18, v21 row_newbcast:9 row_mask:0xf bank_mask:0xf
    v_mul_f32_dpp v38, v18, v22 row_newbcast:10 row_mask:0xf bank_mask:0xf
    v_mul_f32_dpp v39, v18, v23 row_newbcast:11 row_mask:0xf bank_mask:0xf
    v_mul_f32_dpp v40, v18, v24 row_newbcast:12 row_mask:0xf bank_mask:0xf
    v_mul_f32_dpp v41, v18, v25 row_newbcast:13 row_mask:0xf bank_mask:0xf
    v_mul_f32_dpp v42, v18, v26 row_newbcast:14 row_mask:0xf bank_mask:0xf
    v_mul_f32_dpp v43, v18, v27 row_newbcast:15 row_mask:0xf bank_mask:0xf
    v_cvt_pk_bf16_f32 v84, v36, v37
    v_cvt_pk_bf16_f32 v85, v38, v39
    v_cvt_pk_bf16_f32 v86, v40, v41
    v_cvt_pk_bf16_f32 v87, v42, v43
    v_mul_f32_dpp v20, v18, v20 row_newbcast:0 row_mask:0xa bank_mask:0xf
    v_mul_f32_dpp v21, v18, v21 row_newbcast:1 row_mask:0xa bank_mask:0xf
    v_mul_f32_dpp v22, v18, v22 row_newbcast:2 row_mask:0xa bank_mask:0xf
    v_mul_f32_dpp v23, v18, v23 row_newbcast:3 row_mask:0xa bank_mask:0xf
    v_mul_f32_dpp v24, v18, v24 row_newbcast:4 row_mask:0xa bank_mask:0xf
    v_mul_f32_dpp v25, v18, v25 row_newbcast:5 row_mask:0xa bank_mask:0xf
    v_mul_f32_dpp v26, v18, v26 row_newbcast:6 row_mask:0xa bank_mask:0xf
    v_mul_f32_dpp v27, v18, v27 row_newbcast:7 row_mask:0xa bank_mask:0xf
    v_cvt_pk_bf16_f32 v80, v20, v21
    v_cvt_pk_bf16_f32 v81, v22, v23
    v_cvt_pk_bf16_f32 v82, v24, v25
    v_cvt_pk_bf16_f32 v83, v26, v27
    s_waitcnt lgkmcnt(0)
    v_lshlrev_b32 v28, 16, v12
    v_and_b32 v29, 0xffff0000, v12
    v_lshlrev_b32 v30, 16, v13
    v_and_b32 v31, 0xffff0000, v13
    v_lshlrev_b32 v32, 16, v14
    v_and_b32 v33, 0xffff0000, v14
    v_lshlrev_b32 v34, 16, v15
    v_and_b32 v35, 0xffff0000, v15
    v_mul_f32_dpp v36, v19, v28 row_newbcast:8 row_mask:0xf bank_mask:0xf
    v_mul_f32_dpp v37, v19, v29 row_newbcast:9 row_mask:0xf bank_mask:0xf
    v_mul_f32_dpp v38, v19, v30 row_newbcast:10 row_mask:0xf bank_mask:0xf
    v_mul_f32_dpp v39, v19, v31 row_newbcast:11 row_mask:0xf bank_mask:0xf
    v_mul_f32_dpp v40, v19, v32 row_newbcast:12 row_mask:0xf bank_mask:0xf
    v_mul_f32_dpp v41, v19, v33 row_newbcast:13 row_mask:0xf bank_mask:0xf
    v_mul_f32_dpp v42, v19, v34 row_newbcast:14 row_mask:0xf bank_mask:0xf
    v_mul_f32_dpp v43, v19, v35 row_newbcast:15 row_mask:0xf bank_mask:0xf
    v_cvt_pk_bf16_f32 v92, v36, v37
    v_cvt_pk_bf16_f32 v93, v38, v39
    v_cvt_pk_bf16_f32 v94, v40, v41
    v_cvt_pk_bf16_f32 v95, v42, v43
    v_mul_f32_dpp v28, v19, v28 row_newbcast:0 row_mask:0xa bank_mask:0xf
    v_mul_f32_dpp v29, v19, v29 row_newbcast:1 row_mask:0xa bank_mask:0xf
    v_mul_f32_dpp v30, v19, v30 row_newbcast:2 row_mask:0xa bank_mask:0xf
    v_mul_f32_dpp v31, v19, v31 row_newbcast:3 row_mask:0xa bank_mask:0xf
    v_mul_f32_dpp v32, v19, v32 row_newbcast:4 row_mask:0xa bank_mask:0xf
    v_mul_f32_dpp v33, v19, v33 row_newbcast:5 row_mask:0xa bank_mask:0xf
    v_mul_f32_dpp v34, v19, v34 row_newbcast:6 row_mask:0xa bank_mask:0xf
    v_mul_f32_dpp v35, v19, v35 row_newbcast:7 row_mask:0xa bank_mask:0xf
    v_cvt_pk_bf16_f32 v88, v28, v29
    v_cvt_pk_bf16_f32 v89, v30, v31
    v_cvt_pk_bf16_f32 v90, v32, v33
    v_cvt_pk_bf16_f32 v91, v34, v35
    s_waitcnt vmcnt(4)
    v_mfma_f32_32x32x16_bf16 v[0:15], v[64:67], v[176:179], 0
    ds_read_b64_tr_b16 v[184:185], v246 offset:2048
    ds_read_b64_tr_b16 v[186:187], v246 offset:2560
    ds_read_b64_tr_b16 v[188:189], v247 offset:2048
    ds_read_b64_tr_b16 v[190:191], v247 offset:2560
    s_mov_b32 m0, s68
    v_mfma_f32_32x32x16_bf16 v[16:31], v[68:71], v[176:179], 0
    buffer_load_dwordx4 v222, s[4:7], s41 offen sc1 lds
    buffer_load_dwordx4 v223, s[72:75], s41 offen offset:1024 sc1 lds
    v_permlane32_swap_b32 v242, v236
    v_permlane32_swap_b32 v243, v237
    v_mov_b32 v254, 163296
    v_mfma_f32_32x32x16_bf16 v[32:47], v[64:67], v[180:183], 0
    v_permlane32_swap_b32 v244, v238
    v_permlane32_swap_b32 v245, v239
    v_permlane32_swap_b32 v240, v241
    v_add_f32 v242, v242, v236
    v_mfma_f32_32x32x16_bf16 v[48:63], v[68:71], v[180:183], 0
    v_add_f32 v243, v243, v237
    v_add_f32 v244, v244, v238
    v_add_f32 v245, v245, v239
    v_add_f32 v240, -v240, -v241
    v_sub_u32 v241, v230, v231
    v_cvt_pk_bf16_f32 v242, v242, v243
    v_mov_b32 v255, 1
    v_lshl_add_u32 v233, v252, 1, s53
    s_mov_b64 exec, 1
    ds_add_rtn_u32 v232, v254, v255
    s_mov_b64 exec, -1
    ds_read_b32 v233, v233
    s_waitcnt vmcnt(4) lgkmcnt(2)
    v_mfma_f32_32x32x16_bf16 v[0:15], v[72:75], v[184:187], v[0:15]
    ds_read_b64_tr_b16 v[176:177], v246 offset:4096
    ds_read_b64_tr_b16 v[178:179], v246 offset:4608
    ds_read_b64_tr_b16 v[180:181], v247 offset:4096
    ds_read_b64_tr_b16 v[182:183], v247 offset:4608
    v_cvt_pk_bf16_f32 v244, v244, v245
    v_cvt_pk_bf16_f32 v240, v240, v240
    s_mov_b32 m0, s69
    v_mfma_f32_32x32x16_bf16 v[16:31], v[76:79], v[184:187], v[16:31]
    buffer_load_dwordx4 v224, s[4:7], s41 offen sc1 lds
    buffer_load_dwordx4 v225, s[72:75], s41 offen offset:1024 sc1 lds
    ds_write_b32 v230, v242 offset:768
    ds_write_b32 v230, v244 offset:1024
    ds_write_b16 v241, v240 offset:1280
    s_waitcnt lgkmcnt(7)
    v_readfirstlane_b32 s58, v232
    v_mfma_f32_32x32x16_bf16 v[32:47], v[72:75], v[188:191], v[32:47]
    s_cmp_lt_u32 s58, s22
    s_cbranch_scc0 K2_nul_81
    s_and_b32 s59, s58, 7
    s_lshr_b32 s60, s58, 3
K2_chk_83:
    v_readlane_b32 s61, v233, s59
    s_nop 0
    s_cmp_gt_u32 s61, s60
    s_cbranch_scc0 K2_spin_82
K2_back_84:
    v_mfma_f32_32x32x16_bf16 v[48:63], v[76:79], v[188:191], v[48:63]
    v_readlane_b32 s3, v253, s58
    s_lshl_b32 s44, s34, 7
    s_and_b32 s48, s3, 0x3ffff
    s_bfe_u32 s33, s3, 0x30012
    s_mov_b32 s35, s48
    s_mov_b32 s45, s44
    s_waitcnt vmcnt(4) lgkmcnt(3)
    v_mfma_f32_32x32x16_bf16 v[0:15], v[80:83], v[176:179], v[0:15]
    ds_read_b64_tr_b16 v[184:185], v246 offset:6144
    ds_read_b64_tr_b16 v[186:187], v246 offset:6656
    ds_read_b64_tr_b16 v[188:189], v247 offset:6144
    ds_read_b64_tr_b16 v[190:191], v247 offset:6656
    s_add_u32 s47, s44, 256
    s_add_u32 s49, s48, 32
    s_mov_b32 m0, s70
    v_mfma_f32_32x32x16_bf16 v[16:31], v[84:87], v[176:179], v[16:31]
    buffer_load_dwordx4 v226, s[4:7], s41 offen sc1 lds
    buffer_load_dwordx4 v227, s[72:75], s41 offen offset:1024 sc1 lds
    s_add_u32 s60, s48, 64
    s_cmp_eq_u32 s33, 3
    s_cselect_b32 s46, s44, s47
    s_cselect_b32 s50, s60, s48
    s_cselect_b32 s51, s48, s49
    v_mfma_f32_32x32x16_bf16 v[32:47], v[80:83], v[180:183], v[32:47]
    s_sub_u32 s60, s33, 2
    s_cmp_lt_u32 s60, 2
    s_cbranch_scc0 K2_rare_85
K2_back_86:
    v_mfma_f32_32x32x16_bf16 v[48:63], v[84:87], v[180:183], v[48:63]
    s_waitcnt vmcnt(4) lgkmcnt(0)
    v_mfma_f32_32x32x16_bf16 v[0:15], v[88:91], v[184:187], v[0:15]
    ds_read_b64_tr_b16 v[176:177], v246 offset:0
    ds_read_b64_tr_b16 v[178:179], v246 offset:512
    ds_read_b64_tr_b16 v[180:181], v247 offset:0
    ds_read_b64_tr_b16 v[182:183], v247 offset:512
    s_mov_b32 m0, s71
    v_mfma_f32_32x32x16_bf16 v[16:31], v[92:95], v[184:187], v[16:31]
    buffer_load_dwordx4 v228, s[4:7], s41 offen sc1 lds
    buffer_load_dwordx4 v229, s[72:75], s41 offen offset:1024 sc1 lds
    v_mfma_f32_32x32x16_bf16 v[32:47], v[88:91], v[188:191], v[32:47]
    s_nop 2
    v_mul_f32 v234, v0, v96
    v_mul_f32 v236, v8, v128
    v_fmac_f32 v234, v1, v97
    v_fmac_f32 v236, v9, v129
    v_fmac_f32 v234, v2, v98
    v_fmac_f32 v236, v10, v130
    v_fmac_f32 v234, v3, v99
    v_mfma_f32_32x32x16_bf16 v[48:63], v[92:95], v[188:191], v[48:63]
    s_setprio 0
    v_fmac_f32 v236, v11, v131
    v_fmac_f32 v234, v4, v100
    v_fmac_f32 v236, v12, v132
    v_fmac_f32 v234, v5, v101
    v_fmac_f32 v236, v13, v133
    v_fmac_f32 v234, v6, v102
    v_fmac_f32 v236, v14, v134
    v_fmac_f32 v234, v7, v103
    v_fmac_f32 v236, v15, v135
    v_mul_f32 v238, v16, v128
    v_mul_f32 v240, v24, v128
    v_fmac_f32 v238, v17, v129
    v_fmac_f32 v240, v25, v129
    v_fmac_f32 v238, v18, v130
    v_fmac_f32 v240, v26, v130
    v_fmac_f32 v238, v19, v131
    v_fmac_f32 v240, v27, v131
    v_fmac_f32 v238, v20, v132
    v_fmac_f32 v240, v28, v132
    v_fmac_f32 v238, v21, v133
    v_fmac_f32 v240, v29, v133
    v_fmac_f32 v238, v22, v134
    v_fmac_f32 v240, v30, v134
    v_fmac_f32 v238, v23, v135
    v_fmac_f32 v240, v31, v135
    v_mul_f32 v235, v32, v104
    v_mul_f32 v237, v40, v136
    v_fmac_f32 v235, v33, v105
    v_fmac_f32 v237, v41, v137
    v_fmac_f32 v235, v34, v106
    v_fmac_f32 v237, v42, v138
    v_fmac_f32 v235, v35, v107
    v_fmac_f32 v237, v43, v139
    v_fmac_f32 v235, v36, v108
    v_fmac_f32 v237, v44, v140
    v_fmac_f32 v235, v37, v109
    v_fmac_f32 v237, v45, v141
    v_fmac_f32 v235, v38, v110
    v_fmac_f32 v237, v46, v142
    v_fmac_f32 v235, v39, v111
    v_fmac_f32 v237, v47, v143
    v_mul_f32 v239, v48, v136
    v_mul_f32 v241, v56, v136
    s_setprio 1
    s_waitcnt vmcnt(4) lgkmcnt(0)
    v_mfma_f32_32x32x16_bf16 v[0:15], v[64:67], v[176:179], 0
    ds_read_b64_tr_b16 v[184:185], v246 offset:2048
    ds_read_b64_tr_b16 v[186:187], v246 offset:2560
    ds_read_b64_tr_b16 v[188:189], v247 offset:2048
    ds_read_b64_tr_b16 v[190:191], v247 offset:2560
    v_fmac_f32 v239, v49, v137
    v_fmac_f32 v241, v57, v137
    s_mov_b32 m0, s68
    v_mfma_f32_32x32x16_bf16 v[16:31], v[68:71], v[176:179], 0
    buffer_load_dwordx4 v222, s[4:7], s42 offen sc1 lds
    buffer_load_dwordx4 v223, s[72:75], s42 offen offset:1024 sc1 lds
    v_fmac_f32 v239, v50, v138
    v_fmac_f32 v241, v58, v138
    v_fmac_f32 v239, v51, v139
    v_fmac_f32 v241, v59, v139
    v_fmac_f32 v239, v52, v140
    v_mfma_f32_32x32x16_bf16 v[32:47], v[64:67], v[180:183], 0
    v_fmac_f32 v241, v60, v140
    v_fmac_f32 v239, v53, v141
    v_fmac_f32 v241, v61, v141
    v_fmac_f32 v239, v54, v142
    v_fmac_f32 v241, v62, v142
    v_fmac_f32 v239, v55, v143
    v_fmac_f32 v241, v63, v143
    v_mfma_f32_32x32x16_bf16 v[48:63], v[68:71], v[180:183], 0
    v_permlane32_swap_b32 v234, v236
    v_permlane32_swap_b32 v235, v237
    v_permlane32_swap_b32 v240, v238
    s_waitcnt vmcnt(4) lgkmcnt(0)
    v_mfma_f32_32x32x16_bf16 v[0:15], v[72:75], v[184:187], v[0:15]
    ds_read_b64_tr_b16 v[176:177], v246 offset:4096
    ds_read_b64_tr_b16 v[178:179], v246 offset:4608
    ds_read_b64_tr_b16 v[180:181], v247 offset:4096
    ds_read_b64_tr_b16 v[182:183], v247 offset:4608
    v_permlane32_swap_b32 v241, v239
    s_mov_b32 m0, s69
    v_mfma_f32_32x32x16_bf16 v[16:31], v[76:79], v[184:187], v[16:31]
    buffer_load_dwordx4 v224, s[4:7], s42 offen sc1 lds
    buffer_load_dwordx4 v225, s[72:75], s42 offen offset:1024 sc1 lds
    v_lshl_add_u32 v230, v252, 1, s31
    v_add_f32 v234, v234, v236
    v_add_f32 v235, v235, v237
    v_add_f32 v240, v240, v238
    v_add_f32 v241, v241, v239
    v_mfma_f32_32x32x16_bf16 v[32:47], v[72:75], v[188:191], v[32:47]
    v_cvt_pk_bf16_f32 v234, v234, v235
    v_cvt_pk_bf16_f32 v240, v240, v241
    ds_write_b32 v230, v234 offset:0
    ds_write_b32 v230, v240 offset:256
    v_mfma_f32_32x32x16_bf16 v[48:63], v[76:79], v[188:191], v[48:63]
    s_waitcnt vmcnt(4) lgkmcnt(2)
    v_mfma_f32_32x32x16_bf16 v[0:15], v[80:83], v[176:179], v[0:15]
    ds_read_b64_tr_b16 v[184:185], v246 offset:6144
    ds_read_b64_tr_b16 v[186:187], v246 offset:6656
    ds_read_b64_tr_b16 v[188:189], v247 offset:6144
    ds_read_b64_tr_b16 v[190:191], v247 offset:6656
    s_mov_b32 m0, s70
    v_mfma_f32_32x32x16_bf16 v[16:31], v[84:87], v[176:179], v[16:31]
    buffer_load_dwordx4 v226, s[4:7], s42 offen sc1 lds
    buffer_load_dwordx4 v227, s[72:75], s42 offen offset:1024 sc1 lds
    v_mfma_f32_32x32x16_bf16 v[32:47], v[80:83], v[180:183], v[32:47]
    v_mfma_f32_32x32x16_bf16 v[48:63], v[84:87], v[180:183], v[48:63]
    s_waitcnt vmcnt(4) lgkmcnt(0)
    v_mfma_f32_32x32x16_bf16 v[0:15], v[88:91], v[184:187], v[0:15]
    ds_read_b64_tr_b16 v[176:177], v246 offset:0
    ds_read_b64_tr_b16 v[178:179], v246 offset:512
    ds_read_b64_tr_b16 v[180:181], v247 offset:0
    ds_read_b64_tr_b16 v[182:183], v247 offset:512
    s_mov_b32 m0, s71
    v_mfma_f32_32x32x16_bf16 v[16:31], v[92:95], v[184:187], v[16:31]
    buffer_load_dwordx4 v228, s[4:7], s42 offen sc1 lds
    buffer_load_dwordx4 v229, s[72:75], s42 offen offset:1024 sc1 lds
    v_mfma_f32_32x32x16_bf16 v[32:47], v[88:91], v[188:191], v[32:47]
    s_nop 2
    v_mul_f32 v234, v0, v144
    v_mul_f32 v236, v8, v112
    v_fmac_f32 v234, v1, v145
    v_fmac_f32 v236, v9, v113
    v_fmac_f32 v234, v2, v146
    v_fmac_f32 v236, v10, v114
    v_fmac_f32 v234, v3, v147
    v_mfma_f32_32x32x16_bf16 v[48:63], v[92:95], v[188:191], v[48:63]
    s_setprio 0
    v_fmac_f32 v236, v11, v115
    v_fmac_f32 v234, v4, v148
    v_fmac_f32 v236, v12, v116
    v_fmac_f32 v234, v5, v149
    v_fmac_f32 v236, v13, v117
    v_fmac_f32 v234, v6, v150
    v_fmac_f32 v236, v14, v118
    v_fmac_f32 v234, v7, v151
    v_fmac_f32 v236, v15, v119
    v_mul_f32 v238, v16, v160
    v_mul_f32 v240, v24, v160
    v_fmac_f32 v238, v17, v161
    v_fmac_f32 v240, v25, v161
    v_fmac_f32 v238, v18, v162
    v_fmac_f32 v240, v26, v162
    v_fmac_f32 v238, v19, v163
    v_fmac_f32 v240, v27, v163
    v_fmac_f32 v238, v20, v164
    v_fmac_f32 v240, v28, v164
    v_fmac_f32 v238, v21, v165
    v_fmac_f32 v240, v29, v165
    v_fmac_f32 v238, v22, v166
    v_fmac_f32 v240, v30, v166
    v_fmac_f32 v238, v23, v167
    v_fmac_f32 v240, v31, v167
    v_mul_f32 v235, v32, v152
    v_mul_f32 v237, v40, v120
    v_fmac_f32 v235, v33, v153
    v_fmac_f32 v237, v41, v121
    v_fmac_f32 v235, v34, v154
    v_fmac_f32 v237, v42, v122
    v_fmac_f32 v235, v35, v155
    v_fmac_f32 v237, v43, v123
    v_fmac_f32 v235, v36, v156
    v_fmac_f32 v237, v44, v124
    v_fmac_f32 v235, v37, v157
    v_fmac_f32 v237, v45, v125
    v_fmac_f32 v235, v38, v158
    v_fmac_f32 v237, v46, v126
    v_fmac_f32 v235, v39, v159
    v_fmac_f32 v237, v47, v127
    v_mul_f32 v239, v48, v168
    v_mul_f32 v241, v56, v168
    s_setprio 1
    s_waitcnt vmcnt(4) lgkmcnt(0)
    v_mfma_f32_32x32x16_bf16 v[0:15], v[64:67], v[176:179], 0
    ds_read_b64_tr_b16 v[184:185], v246 offset:2048
    ds_read_b64_tr_b16 v[186:187], v246 offset:2560
    ds_read_b64_tr_b16 v[188:189], v247 offset:2048
    ds_read_b64_tr_b16 v[190:191], v247 offset:2560
    v_fmac_f32 v239, v49, v169
    v_fmac_f32 v241, v57, v169
    s_mov_b32 m0, s68
    v_mfma_f32_32x32x16_bf16 v[16:31], v[68:71], v[176:179], 0
    buffer_load_dwordx4 v222, s[4:7], s43 offen sc1 lds
    buffer_load_dwordx4 v223, s[72:75], s43 offen offset:1024 sc1 lds
    v_fmac_f32 v239, v50, v170
    v_fmac_f32 v241, v58, v170
    v_fmac_f32 v239, v51, v171
    v_fmac_f32 v241, v59, v171
    v_fmac_f32 v239, v52, v172
    v_mfma_f32_32x32x16_bf16 v[32:47], v[64:67], v[180:183], 0
    v_fmac_f32 v241, v60, v172
    v_fmac_f32 v239, v53, v173
    v_fmac_f32 v241, v61, v173
    v_fmac_f32 v239, v54, v174
    v_fmac_f32 v241, v62, v174
    v_fmac_f32 v239, v55, v175
    v_fmac_f32 v241, v63, v175
    v_mfma_f32_32x32x16_bf16 v[48:63], v[68:71], v[180:183], 0
    s_waitcnt vmcnt(4) lgkmcnt(0)
    v_mfma_f32_32x32x16_bf16 v[0:15], v[72:75], v[184:187], v[0:15]
    ds_read_b64_tr_b16 v[176:177], v246 offset:4096
    ds_read_b64_tr_b16 v[178:179], v246 offset:4608
    ds_read_b64_tr_b16 v[180:181], v247 offset:4096
    ds_read_b64_tr_b16 v[182:183], v247 offset:4608
    s_mov_b32 m0, s69
    v_mfma_f32_32x32x16_bf16 v[16:31], v[76:79], v[184:187], v[16:31]
    buffer_load_dwordx4 v224, s[4:7], s43 offen sc1 lds
    buffer_load_dwordx4 v225, s[72:75], s43 offen offset:1024 sc1 lds
    v_mfma_f32_32x32x16_bf16 v[32:47], v[72:75], v[188:191], v[32:47]
    v_mfma_f32_32x32x16_bf16 v[48:63], v[76:79], v[188:191], v[48:63]
    s_waitcnt vmcnt(4) lgkmcnt(0)
    v_mfma_f32_32x32x16_bf16 v[0:15], v[80:83], v[176:179], v[0:15]
    ds_read_b64_tr_b16 v[184:185], v246 offset:6144
    ds_read_b64_tr_b16 v[186:187], v246 offset:6656
    ds_read_b64_tr_b16 v[188:189], v247 offset:6144
    ds_read_b64_tr_b16 v[190:191], v247 offset:6656
    s_mov_b32 m0, s70
    v_mfma_f32_32x32x16_bf16 v[16:31], v[84:87], v[176:179], v[16:31]
    buffer_load_dwordx4 v226, s[4:7], s43 offen sc1 lds
    buffer_load_dwordx4 v227, s[72:75], s43 offen offset:1024 sc1 lds
    v_mfma_f32_32x32x16_bf16 v[32:47], v[80:83], v[180:183], v[32:47]
    v_add_u32 v222, s48, v251
    ds_read_b32 v222, v222
    v_mfma_f32_32x32x16_bf16 v[48:63], v[84:87], v[180:183], v[48:63]
    s_waitcnt vmcnt(4) lgkmcnt(1)
    v_mfma_f32_32x32x16_bf16 v[0:15], v[88:91], v[184:187], v[0:15]
    ds_read_b64_tr_b16 v[176:177], v246 offset:0
    ds_read_b64_tr_b16 v[178:179], v246 offset:512
    ds_read_b64_tr_b16 v[180:181], v247 offset:0
    ds_read_b64_tr_b16 v[182:183], v247 offset:512
    s_mov_b32 m0, s71
    v_mfma_f32_32x32x16_bf16 v[16:31], v[92:95], v[184:187], v[16:31]
    buffer_load_dwordx4 v228, s[4:7], s43 offen sc1 lds
    buffer_load_dwordx4 v229, s[72:75], s43 offen offset:1024 sc1 lds
    s_waitcnt lgkmcnt(4)
    v_mad_u32_u16 v223, v222, s39, v248 op_sel:[1,0,0,0]
    v_mad_u32_u16 v222, v222, s39, v248
    v_mfma_f32_32x32x16_bf16 v[32:47], v[88:91], v[188:191], v[32:47]
    v_add_u32 v224, s49, v251
    ds_read_b32 v224, v224
    v_mul_f32 v242, v0, v144
    v_fma_f32 v238, v8, v160, -v238
    v_fmac_f32 v242, v1, v145
    v_fmac_f32 v238, v9, v161
    v_fmac_f32 v242, v2, v146
    v_mfma_f32_32x32x16_bf16 v[48:63], v[92:95], v[188:191], v[48:63]
    s_setprio 0
    v_fmac_f32 v238, v10, v162
    v_fmac_f32 v242, v3, v147
    v_fmac_f32 v238, v11, v163
    v_fmac_f32 v242, v4, v148
    v_fmac_f32 v238, v12, v164
    v_fmac_f32 v242, v5, v149
    v_fmac_f32 v238, v13, v165
    v_fmac_f32 v242, v6, v150
    v_fmac_f32 v238, v14, v166
    v_fmac_f32 v242, v7, v151
    v_fmac_f32 v238, v15, v167
    v_fmac_f32 v236, v16, v112
    v_mul_f32 v244, v24, v160
    v_fmac_f32 v236, v17, v113
    v_fmac_f32 v244, v25, v161
    v_fmac_f32 v236, v18, v114
    v_fmac_f32 v244, v26, v162
    v_fmac_f32 v236, v19, v115
    v_fmac_f32 v244, v27, v163
    v_fmac_f32 v236, v20, v116
    v_fmac_f32 v244, v28, v164
    v_fmac_f32 v236, v21, v117
    v_fmac_f32 v244, v29, v165
    v_fmac_f32 v236, v22, v118
    v_fmac_f32 v244, v30, v166
    v_fmac_f32 v236, v23, v119
    v_fmac_f32 v244, v31, v167
    v_mul_f32 v243, v32, v152
    v_fma_f32 v239, v40, v168, -v239
    v_fmac_f32 v243, v33, v153
    v_fmac_f32 v239, v41, v169
    v_fmac_f32 v243, v34, v154
    v_fmac_f32 v239, v42, v170
    v_fmac_f32 v243, v35, v155
    v_fmac_f32 v239, v43, v171
    v_fmac_f32 v243, v36, v156
    v_fmac_f32 v239, v44, v172
    v_fmac_f32 v243, v37, v157
    v_fmac_f32 v239, v45, v173
    v_fmac_f32 v243, v38, v158
    v_fmac_f32 v239, v46, v174
    v_fmac_f32 v243, v39, v159
    v_fmac_f32 v239, v47, v175
    v_fmac_f32 v237, v48, v120
    v_mul_f32 v245, v56, v168
    v_fmac_f32 v237, v49, v121
    v_fmac_f32 v245, v57, v169
    v_fmac_f32 v237, v50, v122
    v_fmac_f32 v245, v58, v170
    v_fmac_f32 v237, v51, v123
    s_setprio 1
    s_waitcnt vmcnt(4) lgkmcnt(1)
    v_mfma_f32_32x32x16_bf16 v[0:15], v[64:67], v[176:179], 0
    ds_read_b64_tr_b16 v[184:185], v246 offset:2048
    ds_read_b64_tr_b16 v[186:187], v246 offset:2560
    ds_read_b64_tr_b16 v[188:189], v247 offset:2048
    ds_read_b64_tr_b16 v[190:191], v247 offset:2560
    v_fmac_f32 v245, v59, v171
    v_fmac_f32 v237, v52, v124
    s_mov_b32 m0, s68
    v_mfma_f32_32x32x16_bf16 v[16:31], v[68:71], v[176:179], 0
    buffer_load_dwordx4 v222, s[4:7], s44 offen sc1 lds
    buffer_load_dwordx4 v223, s[72:75], s44 offen offset:1024 sc1 lds
    s_waitcnt lgkmcnt(4)
    v_mad_u32_u16 v225, v224, s39, v248 op_sel:[1,0,0,0]
    v_mad_u32_u16 v224, v224, s39, v248
    v_fmac_f32 v245, v60, v172
    v_fmac_f32 v237, v53, v125
    v_mfma_f32_32x32x16_bf16 v[32:47], v[64:67], v[180:183], 0
    v_add_u32 v226, s50, v251
    ds_read_b32 v226, v226
    v_fmac_f32 v245, v61, v173
    v_fmac_f32 v237, v54, v126
    v_fmac_f32 v245, v62, v174
    v_fmac_f32 v237, v55, v127
    v_fmac_f32 v245, v63, v175
    v_mfma_f32_32x32x16_bf16 v[48:63], v[68:71], v[180:183], 0
    v_permlane32_swap_b32 v242, v234
    v_permlane32_swap_b32 v243, v235
    v_add_f32 v242, v242, v234
    v_add_f32 v243, v243, v235
    s_waitcnt vmcnt(4) lgkmcnt(1)
    v_mfma_f32_32x32x16_bf16 v[0:15], v[72:75], v[184:187], v[0:15]
    ds_read_b64_tr_b16 v[176:177], v246 offset:4096
    ds_read_b64_tr_b16 v[178:179], v246 offset:4608
    ds_read_b64_tr_b16 v[180:181], v247 offset:4096
    ds_read_b64_tr_b16 v[182:183], v247 offset:4608
    v_cvt_pk_bf16_f32 v242, v242, v243
    ds_write_b32 v230, v242 offset:512
    s_mov_b32 m0, s69
    v_mfma_f32_32x32x16_bf16 v[16:31], v[76:79], v[184:187], v[16:31]
    buffer_load_dwordx4 v224, s[4:7], s45 offen sc1 lds
    buffer_load_dwordx4 v225, s[72:75], s45 offen offset:1024 sc1 lds
    s_waitcnt lgkmcnt(5)
    v_mad_u32_u16 v227, v226, s39, v248 op_sel:[1,0,0,0]
    v_mad_u32_u16 v226, v226, s39, v248
    v_mfma_f32_32x32x16_bf16 v[32:47], v[72:75], v[188:191], v[32:47]
    v_add_u32 v228, s51, v251
    ds_read_b32 v228, v228
    v_mfma_f32_32x32x16_bf16 v[48:63], v[76:79], v[188:191], v[48:63]
    s_waitcnt vmcnt(4) lgkmcnt(2)
    v_mfma_f32_32x32x16_bf16 v[0:15], v[80:83], v[176:179], v[0:15]
    ds_read_b64_tr_b16 v[184:185], v246 offset:6144
    ds_read_b64_tr_b16 v[186:187], v246 offset:6656
    ds_read_b64_tr_b16 v[188:189], v247 offset:6144
    ds_read_b64_tr_b16 v[190:191], v247 offset:6656
    s_mov_b32 s32, s31
    s_mov_b32 s31, s35
    s_mov_b32 m0, s70
    v_mfma_f32_32x32x16_bf16 v[16:31], v[84:87], v[176:179], v[16:31]
    buffer_load_dwordx4 v226, s[4:7], s46 offen sc1 lds
    buffer_load_dwordx4 v227, s[72:75], s46 offen offset:1024 sc1 lds
    s_waitcnt lgkmcnt(4)
    v_mad_u32_u16 v229, v228, s39, v248 op_sel:[1,0,0,0]
    v_mad_u32_u16 v228, v228, s39, v248
    s_sub_u32 s26, s48, s29
    s_mov_b32 s29, s48
    v_mfma_f32_32x32x16_bf16 v[32:47], v[80:83], v[180:183], v[32:47]
    s_mov_b32 s30, s3
    s_cmp_lg_u32 s36, 0
    s_cselect_b32 s56, s33, 0
    v_mfma_f32_32x32x16_bf16 v[48:63], v[84:87], v[180:183], v[48:63]
    s_waitcnt vmcnt(4) lgkmcnt(0)
    v_mfma_f32_32x32x16_bf16 v[0:15], v[88:91], v[184:187], v[0:15]
    ds_read_b64_tr_b16 v[176:177], v246 offset:0
    ds_read_b64_tr_b16 v[178:179], v246 offset:512
    ds_read_b64_tr_b16 v[180:181], v247 offset:0
    ds_read_b64_tr_b16 v[182:183], v247 offset:512
    s_mov_b32 m0, s71
    v_mfma_f32_32x32x16_bf16 v[16:31], v[92:95], v[184:187], v[16:31]
    buffer_load_dwordx4 v228, s[4:7], s47 offen sc1 lds
    buffer_load_dwordx4 v229, s[72:75], s47 offen offset:1024 sc1 lds
    v_mfma_f32_32x32x16_bf16 v[32:47], v[88:91], v[188:191], v[32:47]
    s_nop 2
    v_mul_f32 v242, v0, v144
    v_fma_f32 v240, v8, v160, -v240
    v_fmac_f32 v242, v1, v145
    v_fmac_f32 v240, v9, v161
    v_fmac_f32 v242, v2, v146
    v_fmac_f32 v240, v10, v162
    v_fmac_f32 v242, v3, v147
    v_mfma_f32_32x32x16_bf16 v[48:63], v[92:95], v[188:191], v[48:63]
    s_setprio 0
    v_fmac_f32 v240, v11, v163
    v_fmac_f32 v242, v4, v148
    v_fmac_f32 v240, v12, v164
    v_fmac_f32 v242, v5, v149
    v_fmac_f32 v240, v13, v165
    v_fmac_f32 v242, v6, v150
    v_fmac_f32 v240, v14, v166
    v_fmac_f32 v242, v7, v151
    v_fmac_f32 v240, v15, v167
    v_add_u32 v249, s26, v249
    v_add_u32 v250, s26, v250
    v_fma_f32 v244, v16, v160, -v244
    v_fmac_f32 v236, v24, v112
    v_fmac_f32 v244, v17, v161
    v_fmac_f32 v236, v25, v113
    v_fmac_f32 v244, v18, v162
    v_fmac_f32 v236, v26, v114
    v_fmac_f32 v244, v19, v163
    v_fmac_f32 v236, v27, v115
    v_fmac_f32 v244, v20, v164
    v_fmac_f32 v236, v28, v116
    v_fmac_f32 v244, v21, v165
    v_fmac_f32 v236, v29, v117
    v_fmac_f32 v244, v22, v166
    v_fmac_f32 v236, v30, v118
    v_fmac_f32 v244, v23, v167
    v_fmac_f32 v236, v31, v119
    ds_read_b64_tr_b16 v[0:1], v249 offset:0
    ds_read_b64_tr_b16 v[2:3], v249 offset:256
    ds_read_u16_d16_hi v16, v250 offset:0
    v_mul_f32 v243, v32, v152
    v_fma_f32 v241, v40, v168, -v241
    v_fmac_f32 v243, v33, v153
    v_fmac_f32 v241, v41, v169
    v_fmac_f32 v243, v34, v154
    v_fmac_f32 v241, v42, v170
    v_fmac_f32 v243, v35, v155
    v_fmac_f32 v241, v43, v171
    v_fmac_f32 v243, v36, v156
    v_fmac_f32 v241, v44, v172
    v_fmac_f32 v243, v37, v157
    v_fmac_f32 v241, v45, v173
    v_fmac_f32 v243, v38, v158
    v_fmac_f32 v241, v46, v174
    v_fmac_f32 v243, v39, v159
    v_fmac_f32 v241, v47, v175
    ds_read_b64_tr_b16 v[4:5], v249 offset:512
    ds_read_b64_tr_b16 v[6:7], v249 offset:768
    ds_read_u16_d16_hi v17, v250 offset:32
    v_fma_f32 v245, v48, v168, -v245
    v_fmac_f32 v237, v56, v120
    v_fmac_f32 v245, v49, v169
    v_fmac_f32 v237, v57, v121
    v_fmac_f32 v245, v50, v170
    v_fmac_f32 v237, v58, v122
    v_fmac_f32 v245, v51, v171
    v_fmac_f32 v237, v59, v123
    v_fmac_f32 v245, v52, v172
    v_fmac_f32 v237, v60, v124
    v_fmac_f32 v245, v53, v173
    v_fmac_f32 v237, v61, v125
    v_fmac_f32 v245, v54, v174
    v_fmac_f32 v237, v62, v126
    v_fmac_f32 v245, v55, v175
    v_fmac_f32 v237, v63, v127
    s_cmp_eq_u32 s56, 2
    s_cbranch_scc1 K2_U21
    s_cmp_eq_u32 s56, 3
    s_cbranch_scc1 K2_U31
    s_branch K2_DSP1
K2_nul_50:
    s_mov_b32 s58, 63
    s_mov_b32 s36, 0
    s_branch K2_back_53
K2_spin_51:
    s_sub_u32 s27, s27, 1
    s_cbranch_scc1 K2_END
    v_lshl_add_u32 v233, v252, 1, s53
    ds_read_b32 v233, v233
    s_waitcnt lgkmcnt(0)
    s_branch K2_chk_52
K2_dyn_48:
    v_mov_b32 v254, 163296
    v_mov_b32 v255, 1
    v_lshl_add_u32 v233, v252, 1, s53
    s_mov_b64 exec, 1
    ds_add_rtn_u32 v232, v254, v255
    s_mov_b64 exec, -1
    ds_read_b32 v233, v233
    s_waitcnt lgkmcnt(0)
    v_readfirstlane_b32 s58, v232
    s_nop 0
    s_cmp_lt_u32 s58, s22
    s_cbranch_scc0 K2_nul_50
    s_and_b32 s59, s58, 7
    s_lshr_b32 s60, s58, 3
K2_chk_52:
    v_readlane_b32 s61, v233, s59
    s_nop 0
    s_cmp_gt_u32 s61, s60
    s_cbranch_scc0 K2_spin_51
K2_back_53:
    s_mov_b32 s34, 1
    s_branch K2_back_49
K2_rare_54:
    s_cmp_eq_u32 s33, 4
    s_cbranch_scc1 K2_four_56
    s_mov_b32 s49, s48
    s_mov_b32 s51, s48
    s_add_u32 s45, s44, 256
    s_add_u32 s46, s44, 512
    s_add_u32 s47, s44, 768
    s_branch K2_back_55
K2_four_56:
    s_add_u32 s50, s48, 64
    s_add_u32 s51, s48, 96
    s_mov_b32 s46, s44
    s_mov_b32 s47, s44
    s_branch K2_back_55
K2_dum_57:
    v_mov_b32 v232, -1
    s_mov_b32 m0, 163360
    s_mov_b64 exec, 1
    buffer_load_dwordx4 v232, s[16:19], 0 offen lds
    buffer_load_dwordx4 v232, s[16:19], 0 offen lds
    s_mov_b64 exec, -1
    s_branch K2_back_59
K2_a4_58:
    v_add_u32 v254, s48, v230
    ds_read_b32 v254, v254 offset:4
    s_lshr_b32 s65, s3, 27
    s_mul_i32 s66, s22, 2080
    s_lshl_b32 s65, s65, 9
    s_add_u32 s65, s65, s66
    s_add_u32 s65, s65, 65536
    s_mov_b32 m0, s65
    s_mov_b32 exec_hi, 0
    s_waitcnt lgkmcnt(0)
    v_or_b32 v254, v254, v231
    buffer_load_dwordx4 v254, s[16:19], 0 offen  lds
    s_mov_b32 exec_hi, -1
    s_branch K2_b4_60
K2_nul_63:
    s_mov_b32 s58, 63
    s_mov_b32 s36, 0
    s_branch K2_back_66
K2_spin_64:
    s_sub_u32 s27, s27, 1
    s_cbranch_scc1 K2_END
    v_lshl_add_u32 v233, v252, 1, s53
    ds_read_b32 v233, v233
    s_waitcnt lgkmcnt(0)
    s_branch K2_chk_65
K2_dyn_61:
    v_mov_b32 v254, 163296
    v_mov_b32 v255, 1
    v_lshl_add_u32 v233, v252, 1, s53
    s_mov_b64 exec, 1
    ds_add_rtn_u32 v232, v254, v255
    s_mov_b64 exec, -1
    ds_read_b32 v233, v233
    s_waitcnt lgkmcnt(0)
    v_readfirstlane_b32 s58, v232
    s_nop 0
    s_cmp_lt_u32 s58, s22
    s_cbranch_scc0 K2_nul_63
    s_and_b32 s59, s58, 7
    s_lshr_b32 s60, s58, 3
K2_chk_65:
    v_readlane_b32 s61, v233, s59
    s_nop 0
    s_cmp_gt_u32 s61, s60
    s_cbranch_scc0 K2_spin_64
K2_back_66:
    s_mov_b32 s34, 1
    s_branch K2_back_62
K2_rare_67:
    s_cmp_eq_u32 s33, 4
    s_cbranch_scc1 K2_four_69
    s_mov_b32 s49, s48
    s_mov_b32 s51, s48
    s_add_u32 s45, s44, 256
    s_add_u32 s46, s44, 512
    s_add_u32 s47, s44, 768
    s_branch K2_back_68
K2_four_69:
    s_add_u32 s50, s48, 64
    s_add_u32 s51, s48, 96
    s_mov_b32 s46, s44
    s_mov_b32 s47, s44
    s_branch K2_back_68
K2_dum_70:
    v_mov_b32 v232, -1
    s_mov_b32 m0, 163360
    s_mov_b64 exec, 1
    buffer_load_dwordx4 v232, s[16:19], 0 offen lds
    buffer_load_dwordx4 v232, s[16:19], 0 offen lds
    s_mov_b64 exec, -1
    s_branch K2_back_72
K2_a4_71:
    v_add_u32 v254, s48, v230
    ds_read_b32 v254, v254 offset:4
    s_lshr_b32 s65, s3, 27
    s_mul_i32 s66, s22, 2080
    s_lshl_b32 s65, s65, 9
    s_add_u32 s65, s65, s66
    s_add_u32 s65, s65, 65536
    s_mov_b32 m0, s65
    s_mov_b32 exec_hi, 0
    s_waitcnt lgkmcnt(0)
    v_or_b32 v254, v254, v231
    buffer_load_dwordx4 v254, s[16:19], 0 offen  lds
    s_mov_b32 exec_hi, -1
    s_branch K2_b4_73
K2_nul_74:
    s_mov_b32 s58, 63
    s_mov_b32 s36, 0
    s_branch K2_back_77
K2_spin_75:
    s_sub_u32 s27, s27, 1
    s_cbranch_scc1 K2_END
    v_lshl_add_u32 v233, v252, 1, s53
    ds_read_b32 v233, v233
    s_waitcnt lgkmcnt(0)
    s_branch K2_chk_76
K2_rare_78:
    s_cmp_eq_u32 s33, 4
    s_cbranch_scc1 K2_four_80
    s_mov_b32 s49, s48
    s_mov_b32 s51, s48
    s_add_u32 s45, s44, 256
    s_add_u32 s46, s44, 512
    s_add_u32 s47, s44, 768
    s_branch K2_back_79
K2_four_80:
    s_add_u32 s50, s48, 64
    s_add_u32 s51, s48, 96
    s_mov_b32 s46, s44
    s_mov_b32 s47, s44
    s_branch K2_back_79
K2_nul_81:
    s_mov_b32 s58, 63
    s_mov_b32 s36, 0
    s_branch K2_back_84
K2_spin_82:
    s_sub_u32 s27, s27, 1
    s_cbranch_scc1 K2_END
    v_lshl_add_u32 v233, v252, 1, s53
    ds_read_b32 v233, v233
    s_waitcnt lgkmcnt(0)
    s_branch K2_chk_83
K2_rare_85:
    s_cmp_eq_u32 s33, 4
    s_cbranch_scc1 K2_four_87
    s_mov_b32 s49, s48
    s_mov_b32 s51, s48
    s_add_u32 s45, s44, 256
    s_add_u32 s46, s44, 512
    s_add_u32 s47, s44, 768
    s_branch K2_back_86
K2_four_87:
    s_add_u32 s50, s48, 64
    s_add_u32 s51, s48, 96
    s_mov_b32 s46, s44
    s_mov_b32 s47, s44
    s_branch K2_back_86
K2_END:
    s_endpgm
.section .rodata,"a"
.p2align 6
.amdhsa_kernel standalone__tensor_product_equiv_equiformer__graph_kernel
  .amdhsa_next_free_vgpr 256
  .amdhsa_next_free_sgpr 102
  .amdhsa_accum_offset 256
  .amdhsa_group_segment_fixed_size 0
  .amdhsa_kernarg_size 96
  .amdhsa_user_sgpr_count 2
  .amdhsa_user_sgpr_kernarg_segment_ptr 1
  .amdhsa_system_sgpr_workgroup_id_x 1
  .amdhsa_float_denorm_mode_32 3
.end_amdhsa_kernel
```

```asm
; @launch grid=(256,1,1) block=(512,1,1) lds=163840
.amdgcn_target "amdgcn-amd-amdhsa--gfx950"
.text
.globl standalone__tensor_product_equiv_equiformer__graph_kernel
.p2align 8
.type standalone__tensor_product_equiv_equiformer__graph_kernel,@function
standalone__tensor_product_equiv_equiformer__graph_kernel:
    s_cmp_ge_u32 s2, 256
    s_cbranch_scc1 K2_END
    s_load_dwordx16 s[80:95], s[0:1], 0
    s_load_dwordx4 s[96:99], s[0:1], 72
    s_load_dwordx2 s[100:101], s[0:1], 88
    v_lshrrev_b32 v1, 6, v0
    s_mov_b32 s54, s2
    v_readfirstlane_b32 s20, v1
    s_mov_b64 exec, 0
    s_cmp_eq_u32 s20, 0
    s_cbranch_scc1 K2_PAD_S1
    s_cmp_eq_u32 s20, 1
    s_cbranch_scc1 K2_PAD_S2
    s_cmp_eq_u32 s20, 5
    s_cbranch_scc1 K2_PAD_H1
    s_cmp_eq_u32 s20, 6
    s_cbranch_scc1 K2_PAD_H2
    s_cmp_eq_u32 s20, 2
    s_cbranch_scc1 K2_PAD_H3
KS_HOP0:
    s_mov_b64 exec, -1
    v_and_b32 v8, 63, v0
    v_lshlrev_b32 v9, 4, v8
    v_mov_b32 v6, 0
    v_lshlrev_b32 v5, 4, v0
    v_mul_u32_u24 v4, 24, v0
    s_mul_i32 s64, s2, 5120
    s_mul_i32 s65, s2, 7680
    v_mov_b32 v176, v8
    v_mov_b32 v177, v0
    s_mul_i32 s21, s2, 625
    s_add_u32 s22, s21, 640
    s_add_u32 s21, s21, 15
    s_lshr_b32 s21, s21, 4
    s_lshr_b32 s22, s22, 4
    s_sub_u32 s22, s22, s21
    s_movk_i32 s39, 1024
    s_lshl_b32 s37, s20, 13
    s_mov_b32 s53, 163264
    s_lshl_b32 s52, s20, 2
    s_add_u32 s52, s52, s53
    s_add_u32 s68, s37, 0
    s_add_u32 s69, s37, 2048
    s_add_u32 s70, s37, 4096
    s_add_u32 s71, s37, 6144
    s_waitcnt lgkmcnt(0)
    s_mov_b32 s8, s100
    s_and_b32 s9, s101, 0xffff
    s_mov_b32 s10, 37748736
    s_mov_b32 s11, 0x20000
    s_cmp_lg_u32 s20, 7
    s_cbranch_scc1 KS_NOTAG
    s_mov_b32 s24, 7178240
    s_mov_b64 exec, 1
    buffer_load_dword v14, v6, s[8:11], s24 offen sc1
    s_mov_b64 exec, -1
    s_barrier
    v_mov_b32 v76, 0
    v_mov_b32 v77, -1
    v_lshlrev_b32 v78, 2, v8
    v_add_u32 v78, 163072, v78
    s_mov_b64 exec, 0x1ff
    ds_write_b32 v78, v76 offset:192
    s_mov_b64 exec, 0xff
    ds_write_b32 v78, v77 offset:256
    s_mov_b64 exec, -1
    s_mov_b32 exec_hi, 0xffff
    ds_write_b32 v78, v76
    s_mov_b64 exec, 1
    ds_write_b32 v78, v76 offset:228
    s_mov_b64 exec, -1
    s_mov_b64 exec, 1
    v_mov_b32 v12, 163376
    s_mov_b32 s24, 1664525
    s_waitcnt vmcnt(0)
    v_mul_lo_u32 v14, v14, s24
    v_add_u32 v14, 1013904223, v14
    ds_write_b32 v12, v14
KS_TAGOK2:
    s_mov_b64 exec, -1
    s_waitcnt lgkmcnt(0)
    s_barrier
    s_branch KS_B3
KS_H0:
    s_barrier
    s_branch KS_HELP
K2_PAD_S1:
    s_branch KS_HOP0
KS_NOTAG:
    s_cmp_ge_u32 s20, 5
    s_cbranch_scc1 KS_HELP
    s_cmp_ge_u32 s2, 250
    s_cbranch_scc1 KS_IDLE
    s_mov_b32 s40, s88
    s_and_b32 s41, s89, 0xffff
    s_mov_b32 s42, 1280000
    s_mov_b32 s43, 0x20000
    buffer_load_dwordx4 v[12:15], v5, s[40:43], s64 offen
    s_mov_b32 s44, s86
    s_and_b32 s45, s87, 0xffff
    s_mov_b32 s46, 1280000
    s_mov_b32 s47, 0x20000
    s_mov_b32 s48, s82
    s_and_b32 s49, s83, 0xffff
    s_mov_b32 s50, 1920000
    s_mov_b32 s51, 0x20000
    buffer_load_dwordx4 v[16:19], v5, s[44:47], s64 offen
    buffer_load_dwordx4 v[20:23], v4, s[48:51], s65 offen
    buffer_load_dwordx2 v[24:25], v4, s[48:51], s65 offen offset:16
    v_lshlrev_b32 v2, 2, v0
    s_lshl_b32 s64, s64, 3
    v_lshl_add_u32 v3, v0, 7, s64
    v_mov_b32 v7, 1
    s_cmp_eq_u32 s20, 4
    s_cbranch_scc1 KS_NOCLR
    ds_write_b32 v2, v6
KS_NOCLR:
    s_waitcnt lgkmcnt(0)
    s_barrier
    s_mov_b64 exec, 0
    s_cmp_eq_u32 s20, 0
    s_cbranch_scc1 K2_PAD_B3
    s_cmp_eq_u32 s20, 1
    s_cbranch_scc1 K2_PAD_LD
    s_cmp_eq_u32 s20, 2
    s_cbranch_scc1 K2_PAD_NW
    s_cmp_eq_u32 s20, 3
    s_cbranch_scc1 K2_PAD_SC
    s_cmp_eq_u32 s20, 4
    s_cbranch_scc1 K2_PAD_SD
KS_HOP:
    s_mov_b64 exec, -1
    s_mov_b32 s58, 429497
    s_movk_i32 s59, 625
    s_waitcnt vmcnt(3)
    v_mul_u32_u24 v28, s58, v12
    v_lshrrev_b32 v32, 27, v28
    v_bfe_u32 v36, v28, 24, 3
    v_lshlrev_b32 v32, 2, v32
    v_lshl_or_b32 v32, v36, 7, v32
    ds_add_rtn_u32 v36, v32, v7
    v_mul_u32_u24 v29, s58, v13
    v_lshrrev_b32 v33, 27, v29
    v_bfe_u32 v37, v29, 24, 3
    v_lshlrev_b32 v33, 2, v33
    v_lshl_or_b32 v33, v37, 7, v33
    ds_add_rtn_u32 v37, v33, v7
    v_mul_u32_u24 v30, s58, v14
    v_lshrrev_b32 v34, 27, v30
    v_bfe_u32 v38, v30, 24, 3
    v_lshlrev_b32 v34, 2, v34
    v_lshl_or_b32 v34, v38, 7, v34
    ds_add_rtn_u32 v38, v34, v7
    v_mul_u32_u24 v31, s58, v15
    v_lshrrev_b32 v35, 27, v31
    v_bfe_u32 v39, v31, 24, 3
    v_lshlrev_b32 v35, 2, v35
    v_lshl_or_b32 v35, v39, 7, v35
    ds_add_rtn_u32 v39, v35, v7
    v_lshrrev_b32 v28, 24, v28
    v_mad_u32_u24 v28, v28, s59, 15
    v_lshrrev_b32 v28, 4, v28
    v_sub_u32 v28, v12, v28
    v_add_u32 v12, 0, v3
    v_lshl_or_b32 v28, v28, 26, v12
    v_lshrrev_b32 v29, 24, v29
    v_mad_u32_u24 v29, v29, s59, 15
    v_lshrrev_b32 v29, 4, v29
    v_sub_u32 v29, v13, v29
    v_add_u32 v13, 32, v3
    v_lshl_or_b32 v29, v29, 26, v13
    v_lshrrev_b32 v30, 24, v30
    v_mad_u32_u24 v30, v30, s59, 15
    v_lshrrev_b32 v30, 4, v30
    v_sub_u32 v30, v14, v30
    v_add_u32 v14, 64, v3
    v_lshl_or_b32 v30, v30, 26, v14
    v_lshrrev_b32 v31, 24, v31
    v_mad_u32_u24 v31, v31, s59, 15
    v_lshrrev_b32 v31, 4, v31
    v_sub_u32 v31, v15, v31
    v_add_u32 v15, 96, v3
    v_lshl_or_b32 v31, v31, 26, v15
K2_PAD_S2:
    s_cbranch_execz KS_HOP0
    v_mov_b32 v59, 163376
    s_mul_i32 s65, s2, 1152
    s_add_u32 s65, s65, 6291456
    s_mul_i32 s64, s2, 20608
    s_waitcnt lgkmcnt(0)
    s_barrier
    ds_read_b128 v[40:43], v9
    ds_read_b32 v59, v59
    s_waitcnt lgkmcnt(1)
    v_add_u32 v45, v40, v41
    v_add_u32 v46, v45, v42
    v_add_u32 v47, v46, v43
    v_mov_b32 v58, v47
    s_nop 1
    v_add_u32_dpp v58, v58, v58 row_shr:1 row_mask:0xf bank_mask:0xf bound_ctrl:0
    s_nop 1
    v_add_u32_dpp v58, v58, v58 row_shr:2 row_mask:0xf bank_mask:0xf bound_ctrl:0
    s_nop 1
    v_add_u32_dpp v58, v58, v58 row_shr:4 row_mask:0xf bank_mask:0xf bound_ctrl:0
    s_nop 1
    v_add_u32_dpp v58, v58, v58 row_shr:8 row_mask:0xf bank_mask:0xf bound_ctrl:0
    s_nop 1
    v_add_u32_dpp v58, v58, v58 row_bcast:15 row_mask:0xa bank_mask:0xf
    s_nop 1
    v_add_u32_dpp v58, v58, v58 row_bcast:31 row_mask:0xc bank_mask:0xf
    v_sub_u32 v48, v58, v47
    v_add_u32 v49, v48, v40
    v_add_u32 v50, v48, v45
    v_add_u32 v51, v48, v46
    ds_write_b128 v9, v[48:51] offset:1024
    s_waitcnt vmcnt(0) lgkmcnt(1)
    s_cmp_lg_u32 s20, 4
    s_cbranch_scc1 KS_NOPUB
    v_lshl_or_b32 v56, v49, 11, v48
    v_lshl_or_b32 v57, v51, 11, v50
    v_lshl_or_b32 v56, v59, 22, v56
    v_lshl_or_b32 v57, v59, 22, v57
    buffer_store_dwordx4 v[56:59], v9, s[8:11], s65 offen sc1
KS_NOPUB:
    s_waitcnt lgkmcnt(0)
    ds_read_b32 v32, v32 offset:1024
    ds_read_b32 v33, v33 offset:1024
    ds_read_b32 v34, v34 offset:1024
    ds_read_b32 v35, v35 offset:1024
    v_and_b32 v60, 0xffff, v59
    v_and_b32 v61, 0xffff0000, v59
    s_mov_b32 s58, 0xffff0000
    v_mov_b32 v40, v20
    v_lshl_or_b32 v41, v21, 16, v60
    v_or_b32 v42, v61, v16
    v_mov_b32 v43, v28
    v_alignbit_b32 v44, v22, v21, 16
    v_and_or_b32 v45, v22, s58, v60
    v_or_b32 v46, v61, v17
    v_mov_b32 v47, v29
    v_mov_b32 v48, v23
    v_lshl_or_b32 v49, v24, 16, v60
    v_or_b32 v50, v61, v18
    v_mov_b32 v51, v30
    v_alignbit_b32 v52, v25, v24, 16
    v_and_or_b32 v53, v25, s58, v60
    v_or_b32 v54, v61, v19
    v_mov_b32 v55, v31
    s_waitcnt lgkmcnt(0)
    v_add_lshl_u32 v32, v32, v36, 4
    ds_write_b128 v32, v[40:43] offset:2048
    v_add_lshl_u32 v33, v33, v37, 4
    ds_write_b128 v33, v[44:47] offset:2048
    v_add_lshl_u32 v34, v34, v38, 4
    ds_write_b128 v34, v[48:51] offset:2048
    v_add_lshl_u32 v35, v35, v39, 4
    ds_write_b128 v35, v[52:55] offset:2048
    s_waitcnt lgkmcnt(0)
    s_barrier
    ds_read_b128 v[12:15], v5 offset:2048
    ds_read_b128 v[16:19], v5 offset:7168
    ds_read_b128 v[20:23], v5 offset:12288
    ds_read_b128 v[24:27], v5 offset:17408
    s_waitcnt lgkmcnt(3)
    buffer_store_dwordx4 v[12:15], v5, s[8:11], s64 offen sc1
    s_add_u32 s64, s64, 5120
    s_waitcnt lgkmcnt(2)
    buffer_store_dwordx4 v[16:19], v5, s[8:11], s64 offen sc1
    s_add_u32 s64, s64, 5120
    s_waitcnt lgkmcnt(1)
    buffer_store_dwordx4 v[20:23], v5, s[8:11], s64 offen sc1
    s_add_u32 s64, s64, 5120
    s_waitcnt lgkmcnt(0)
    buffer_store_dwordx4 v[24:27], v5, s[8:11], s64 offen sc1
    s_branch KS_JOIN
K2_PAD_B3:
    s_branch KS_HOP
KS_B3:
    v_mov_b32 v59, 163376
    ds_read_b32 v59, v59
    s_waitcnt lgkmcnt(0)
    s_barrier
KS_JOIN:
    v_readfirstlane_b32 s2, v59
    s_mov_b32 s23, 0
    s_mov_b32 s28, 1
    s_mov_b32 s24, 0
    s_mov_b32 s25, 1
K2_CELLS:
    v_lshrrev_b32 v178, 1, v177
    v_min_u32 v178, 249, v178
    v_mul_u32_u24 v72, 1152, v178
    s_and_b32 s58, s54, 7
    s_lshl_b32 s58, s58, 7
    s_lshr_b32 s59, s54, 5
    s_lshl_b32 s59, s59, 4
    s_add_u32 s67, s58, s59
    s_add_u32 s67, s67, 6291456
    buffer_load_dwordx4 v[76:79], v72, s[8:11], s67 offen sc1
    s_cmp_eq_u32 s28, 0
    s_cbranch_scc1 K2_NOSRD
    s_mov_b32 s4, s80
    s_and_b32 s5, s81, 0xffff
    s_mov_b32 s6, 10240000
    s_mov_b32 s7, 0x20000
    s_mov_b32 s12, s96
    s_and_b32 s13, s97, 0xffff
    s_mov_b32 s14, 10240000
    s_mov_b32 s15, 0x20000
    s_mov_b32 s16, s84
    s_and_b32 s17, s85, 0xffff
    s_mov_b32 s18, 10240000
    s_mov_b32 s19, 0x20000
    s_sub_u32 s80, s80, 1024
    s_subb_u32 s81, s81, 0
    s_mov_b32 s72, s80
    s_and_b32 s73, s81, 0xffff
    s_mov_b32 s74, 10241024
    s_mov_b32 s75, 0x20000
    s_mov_b64 exec, 0
    s_cmp_eq_u32 s20, 0
    s_cbranch_scc1 K2_PAD_U20
    s_cmp_eq_u32 s20, 1
    s_cbranch_scc1 K2_PAD_U30
    s_cmp_eq_u32 s20, 2
    s_cbranch_scc1 K2_PAD_U21
    s_cmp_eq_u32 s20, 3
    s_cbranch_scc1 K2_PAD_U31
    s_cmp_eq_u32 s20, 4
    s_cbranch_scc1 K2_PAD_SW
    s_cmp_eq_u32 s20, 5
    s_cbranch_scc1 K2_PAD_TL
    s_cmp_eq_u32 s20, 6
    s_cbranch_scc1 K2_PAD_T2
K2_HOP:
    s_mov_b64 exec, -1
K2_NOSRD:
    v_and_b32 v84, 15, v176
    v_lshrrev_b32 v85, 5, v176
    v_bfe_u32 v86, v176, 4, 1
    v_lshrrev_b32 v87, 2, v84
    v_and_b32 v88, 3, v84
    v_lshl_add_u32 v89, v85, 3, v87
    v_lshl_add_u32 v90, v87, 1, v85
    v_lshlrev_b32 v249, 5, v90
    v_lshl_add_u32 v249, v88, 3, v249
    v_add_u32 v249, 512, v249
    v_lshrrev_b32 v90, 3, v84
    v_lshl_add_u32 v90, v90, 1, v86
    v_sub_u32 v90, v90, 1 clamp
    v_lshlrev_b32 v250, 7, v90
    v_and_b32 v91, 7, v84
    v_lshl_add_u32 v91, v91, 1, v85
    v_lshl_add_u32 v250, v91, 1, v250
    v_lshrrev_b32 v90, 1, v88
    v_lshl_add_u32 v90, v86, 1, v90
    v_bfe_u32 v91, v87, 1, 1
    v_lshlrev_b32 v91, 2, v91
    v_xor_b32 v90, v90, v91
    v_lshlrev_b32 v90, 4, v90
    v_lshl_add_u32 v90, v89, 7, v90
    v_and_b32 v91, 1, v88
    v_lshl_add_u32 v90, v91, 3, v90
    v_add_u32 v246, s37, v90
    v_xor_b32 v247, 64, v246
    v_lshrrev_b32 v90, 3, v176
    v_lshlrev_b32 v251, 2, v90
    v_add_u32 v251, 384, v251
    v_bfe_u32 v90, v90, 1, 1
    v_lshlrev_b32 v90, 2, v90
    v_and_b32 v91, 7, v176
    v_xor_b32 v90, v90, v91
    v_lshlrev_b32 v248, 4, v90
    v_lshlrev_b32 v252, 1, v176
    v_and_b32 v231, 1, v176
    v_lshlrev_b32 v231, 4, v231
    v_lshrrev_b32 v90, 1, v176
    v_lshlrev_b32 v90, 5, v90
    v_add_u32 v230, 512, v90
    s_lshl_b32 s59, s2, 22
    s_mov_b32 s60, 0x40000
    s_bfe_u32 s61, s54, 0x10004
    s_bfe_u32 s62, s54, 0x10003
    s_add_u32 s63, s61, s62
    s_mul_i32 s62, s62, 11
    s_sub_u32 s64, 11, s62
    v_cmp_gt_u32 vcc, 500, v177
    s_nop 0
    s_mov_b64 s[56:57], vcc
K2_POLL:
    s_waitcnt vmcnt(0)
    v_xor_b32 v73, s59, v76
    v_xor_b32 v74, s59, v77
    v_or_b32 v73, v73, v74
    v_xor_b32 v74, s2, v79
    v_lshrrev_b32 v73, 22, v73
    v_or_b32 v73, v73, v74
    v_cmp_ne_u32 vcc, 0, v73
    s_nop 0
    s_cbranch_vccz K2_POLLED
    s_sub_u32 s60, s60, 1
    s_cbranch_scc1 K2_END
    s_mov_b64 exec, vcc
    buffer_load_dwordx4 v[76:79], v72, s[8:11], s67 offen sc1
    s_mov_b64 exec, -1
    s_branch K2_POLL
K2_PAD_LD:
    s_branch KS_HOP
K2_POLLED:
    s_set_gpr_idx_on s61, gpr_idx(SRC0)
    s_nop 0
    v_bfe_u32 v179, v76, s62, 11
    s_set_gpr_idx_idx s63
    s_nop 0
    v_bfe_u32 v73, v76, s64, 11
    s_set_gpr_idx_off
    v_sub_u32 v73, v73, v179
    v_cndmask_b32 v73, 0, v73, s[56:57]
    v_and_b32 v1, 1, v177
    v_add_u32 v1, s23, v1
    v_sub_u32 v180, v73, v1
    v_add_u32 v179, v179, v1
    v_mul_u32_u24 v181, 20608, v178
    v_lshl_add_u32 v181, v179, 4, v181
    v_cmp_lt_i32 s[40:41], 0, v180
    v_add_u32 v182, 32, v181
    s_mov_b32 s65, 0
    s_mov_b64 exec, s[40:41]
    buffer_load_dwordx4 v[0:3], v181, s[8:11], 0 offen offset:0 sc1
    s_mov_b64 exec, -1
    v_cmp_lt_i32 s[42:43], 2, v180
    v_cmp_lt_i32 s[44:45], 4, v180
    v_cmp_lt_i32 s[46:47], 6, v180
    v_cmp_lt_i32 s[48:49], 8, v180
    v_cmp_lt_i32 s[50:51], 10, v180
    v_cmp_lt_i32 s[90:91], 12, v180
    v_cmp_lt_i32 s[92:93], 14, v180
    v_cmp_lt_i32 s[94:95], 16, v180
    v_cmp_lt_i32 s[96:97], 18, v180
    v_add_u32 v183, 64, v181
    v_add_u32 v184, 96, v181
    v_subrev_u32 v62, 1, v180
    v_ashrrev_i32 v62, 1, v62
    v_med3_i32 v62, v62, 0, 9
    s_cmp_eq_u64 s[42:43], 0
    s_cbranch_scc1 K2_LD_DONE
    v_mov_b32 v63, v62
    s_nop 1
    v_add_u32_dpp v63, v63, v63 row_shr:1 row_mask:0xf bank_mask:0xf bound_ctrl:0
    s_nop 1
    v_add_u32_dpp v63, v63, v63 row_shr:2 row_mask:0xf bank_mask:0xf bound_ctrl:0
    s_nop 1
    v_add_u32_dpp v63, v63, v63 row_shr:4 row_mask:0xf bank_mask:0xf bound_ctrl:0
    s_nop 1
    v_add_u32_dpp v63, v63, v63 row_shr:8 row_mask:0xf bank_mask:0xf bound_ctrl:0
    s_nop 1
    v_add_u32_dpp v63, v63, v63 row_bcast:15 row_mask:0xa bank_mask:0xf
    s_nop 1
    v_add_u32_dpp v63, v63, v63 row_bcast:31 row_mask:0xc bank_mask:0xf
    s_lshl_b32 s58, s20, 10
    s_add_u32 s58, s58, 45056
    v_readlane_b32 s59, v63, 63
    v_sub_u32 v63, v63, v62
    v_lshl_add_u32 v64, v63, 2, s58
    v_lshlrev_b32 v63, 5, v63
    v_sub_u32 v63, v182, v63
    s_cmp_gt_u32 s59, 189
    s_cbranch_scc1 K2_LD_GEN
    s_mov_b64 exec, s[42:43]
    s_cbranch_execz K2_LD_L
    ds_write_b32 v64, v63 offset:0
    s_mov_b64 exec, s[44:45]
    s_cbranch_execz K2_LD_L
    ds_write_b32 v64, v63 offset:4
    s_mov_b64 exec, s[46:47]
    s_cbranch_execz K2_LD_L
    ds_write_b32 v64, v63 offset:8
    s_mov_b64 exec, s[48:49]
    s_cbranch_execz K2_LD_L
    ds_write_b32 v64, v63 offset:12
    s_mov_b64 exec, s[50:51]
    s_cbranch_execz K2_LD_L
    ds_write_b32 v64, v63 offset:16
    s_mov_b64 exec, s[90:91]
    s_cbranch_execz K2_LD_L
    ds_write_b32 v64, v63 offset:20
    s_mov_b64 exec, s[92:93]
    s_cbranch_execz K2_LD_L
    ds_write_b32 v64, v63 offset:24
    s_mov_b64 exec, s[94:95]
    s_cbranch_execz K2_LD_L
    ds_write_b32 v64, v63 offset:28
    s_mov_b64 exec, s[96:97]
    s_cbranch_execz K2_LD_L
    ds_write_b32 v64, v63 offset:32
K2_LD_L:
    s_mov_b64 exec, -1
    v_lshl_add_u32 v63, v176, 2, s58
    v_lshlrev_b32 v62, 5, v176
    s_waitcnt lgkmcnt(0)
    ds_read_b32 v64, v63 offset:0
    ds_read_b32 v65, v63 offset:252
    ds_read_b32 v66, v63 offset:504
    s_min_u32 s60, s59, 63
    s_sub_u32 s59, s59, s60
    s_bfm_b64 s[42:43], s60, 0
    s_min_u32 s60, s59, 63
    s_sub_u32 s59, s59, s60
    s_bfm_b64 s[44:45], s60, 0
    s_min_u32 s60, s59, 63
    s_sub_u32 s59, s59, s60
    s_bfm_b64 s[46:47], s60, 0
    s_mov_b64 s[48:49], 0
    s_mov_b32 s65, 1
    s_mov_b32 s60, 0
    s_waitcnt lgkmcnt(2)
    v_add3_u32 v182, v62, v64, s60
    s_mov_b64 exec, s[42:43]
    buffer_load_dwordx4 v[4:7], v182, s[8:11], 0 offen sc1
    s_mov_b32 s60, 2016
    s_waitcnt lgkmcnt(1)
    v_add3_u32 v183, v62, v65, s60
    s_mov_b64 exec, s[44:45]
    buffer_load_dwordx4 v[8:11], v183, s[8:11], 0 offen sc1
    s_mov_b32 s60, 4032
    s_waitcnt lgkmcnt(0)
    v_add3_u32 v184, v62, v66, s60
    s_mov_b64 exec, s[46:47]
    buffer_load_dwordx4 v[12:15], v184, s[8:11], 0 offen sc1
K2_LD_DONE:
    s_mov_b64 exec, -1
    s_cmp_eq_u32 s28, 0
    s_cbranch_scc1 K2_WLATE
    v_lshrrev_b32 v60, 6, v252
    v_bfe_u32 v61, v252, 3, 2
    v_lshl_add_u32 v60, v60, 2, v61
    v_mul_u32_u24 v60, 640, v60
    v_bfe_u32 v61, v252, 5, 1
    v_lshl_add_u32 v60, v61, 5, v60
    v_and_b32 v61, 6, v252
    v_lshl_add_u32 v60, v61, 2, v60
    v_add_u32 v60, 24576, v60
    ds_read_b64_tr_b16 v[136:137], v60 offset:0
    ds_read_b64_tr_b16 v[138:139], v60 offset:5120
    ds_read_b64_tr_b16 v[140:141], v60 offset:64
    ds_read_b64_tr_b16 v[142:143], v60 offset:5184
    ds_read_b64_tr_b16 v[144:145], v60 offset:128
    ds_read_b64_tr_b16 v[146:147], v60 offset:5248
    ds_read_b64_tr_b16 v[148:149], v60 offset:192
    ds_read_b64_tr_b16 v[150:151], v60 offset:5312
    ds_read_b64_tr_b16 v[152:153], v60 offset:256
    ds_read_b64_tr_b16 v[154:155], v60 offset:5376
    ds_read_b64_tr_b16 v[156:157], v60 offset:320
    ds_read_b64_tr_b16 v[158:159], v60 offset:5440
    ds_read_b64_tr_b16 v[160:161], v60 offset:384
    ds_read_b64_tr_b16 v[162:163], v60 offset:5504
    ds_read_b64_tr_b16 v[164:165], v60 offset:448
    ds_read_b64_tr_b16 v[166:167], v60 offset:5568
    ds_read_b64_tr_b16 v[168:169], v60 offset:512
    ds_read_b64_tr_b16 v[170:171], v60 offset:5632
    ds_read_b64_tr_b16 v[172:173], v60 offset:576
    ds_read_b64_tr_b16 v[174:175], v60 offset:5696
    s_waitcnt lgkmcnt(0)
K2_WUNP:
    v_lshlrev_b32 v96, 16, v136
    v_and_b32 v97, 0xffff0000, v136
    v_lshlrev_b32 v98, 16, v137
    v_and_b32 v99, 0xffff0000, v137
    v_lshlrev_b32 v100, 16, v138
    v_and_b32 v101, 0xffff0000, v138
    v_lshlrev_b32 v102, 16, v139
    v_and_b32 v103, 0xffff0000, v139
    v_lshlrev_b32 v104, 16, v140
    v_and_b32 v105, 0xffff0000, v140
    v_lshlrev_b32 v106, 16, v141
    v_and_b32 v107, 0xffff0000, v141
    v_lshlrev_b32 v108, 16, v142
    v_and_b32 v109, 0xffff0000, v142
    v_lshlrev_b32 v110, 16, v143
    v_and_b32 v111, 0xffff0000, v143
    v_lshlrev_b32 v112, 16, v144
    v_and_b32 v113, 0xffff0000, v144
    v_lshlrev_b32 v114, 16, v145
    v_and_b32 v115, 0xffff0000, v145
    v_lshlrev_b32 v116, 16, v146
    v_and_b32 v117, 0xffff0000, v146
    v_lshlrev_b32 v118, 16, v147
    v_and_b32 v119, 0xffff0000, v147
    v_lshlrev_b32 v120, 16, v148
    v_and_b32 v121, 0xffff0000, v148
    v_lshlrev_b32 v122, 16, v149
    v_and_b32 v123, 0xffff0000, v149
    v_lshlrev_b32 v124, 16, v150
    v_and_b32 v125, 0xffff0000, v150
    v_lshlrev_b32 v126, 16, v151
    v_and_b32 v127, 0xffff0000, v151
    v_lshlrev_b32 v128, 16, v152
    v_and_b32 v129, 0xffff0000, v152
    v_lshlrev_b32 v130, 16, v153
    v_and_b32 v131, 0xffff0000, v153
    v_lshlrev_b32 v132, 16, v154
    v_and_b32 v133, 0xffff0000, v154
    v_lshlrev_b32 v134, 16, v155
    v_and_b32 v135, 0xffff0000, v155
    v_lshlrev_b32 v136, 16, v156
    v_and_b32 v137, 0xffff0000, v156
    v_lshlrev_b32 v138, 16, v157
    v_and_b32 v139, 0xffff0000, v157
    v_lshlrev_b32 v140, 16, v158
    v_and_b32 v141, 0xffff0000, v158
    v_lshlrev_b32 v142, 16, v159
    v_and_b32 v143, 0xffff0000, v159
    v_lshlrev_b32 v144, 16, v160
    v_and_b32 v145, 0xffff0000, v160
    v_lshlrev_b32 v146, 16, v161
    v_and_b32 v147, 0xffff0000, v161
    v_lshlrev_b32 v148, 16, v162
    v_and_b32 v149, 0xffff0000, v162
    v_lshlrev_b32 v150, 16, v163
    v_and_b32 v151, 0xffff0000, v163
    v_lshlrev_b32 v152, 16, v164
    v_and_b32 v153, 0xffff0000, v164
    v_lshlrev_b32 v154, 16, v165
    v_and_b32 v155, 0xffff0000, v165
    v_lshlrev_b32 v156, 16, v166
    v_and_b32 v157, 0xffff0000, v166
    v_lshlrev_b32 v158, 16, v167
    v_and_b32 v159, 0xffff0000, v167
    v_lshlrev_b32 v160, 16, v168
    v_and_b32 v161, 0xffff0000, v168
    v_lshlrev_b32 v162, 16, v169
    v_and_b32 v163, 0xffff0000, v169
    v_lshlrev_b32 v164, 16, v170
    v_and_b32 v165, 0xffff0000, v170
    v_lshlrev_b32 v166, 16, v171
    v_and_b32 v167, 0xffff0000, v171
    v_lshlrev_b32 v168, 16, v172
    v_and_b32 v169, 0xffff0000, v172
    v_lshlrev_b32 v170, 16, v173
    v_and_b32 v171, 0xffff0000, v173
    v_lshlrev_b32 v172, 16, v174
    v_and_b32 v173, 0xffff0000, v174
    v_lshlrev_b32 v174, 16, v175
    v_and_b32 v175, 0xffff0000, v175
K2_NOWRAW:
K2_PAD_NW:
    s_cbranch_execz KS_HOP
    v_lshrrev_b32 v179, 2, v181
    v_lshrrev_b32 v185, 2, v182
    v_lshrrev_b32 v186, 2, v183
    v_lshrrev_b32 v187, 2, v184
    s_mov_b32 s66, 7340032
    v_mov_b32 v201, 1
    s_movk_i32 s58, 520
    s_movk_i32 s59, 2080
    s_mov_b32 s60, 0x40000
    s_mov_b32 s61, 0xffff
    v_mov_b32 v202, 65536
    s_cmp_lg_u32 s24, 0
    s_cbranch_scc1 K2_RK_LOAD
    v_cmp_lt_i32 vcc, 20, v180
    s_nop 0
    s_cbranch_vccz K2_NOMORE
    v_mov_b32 v61, 163300
    ds_write_b32 v61, v201
K2_NOMORE:
    s_mov_b32 s62, 82176
    s_cmp_eq_u32 s65, 0
    s_waitcnt vmcnt(3)
    s_cbranch_scc0 K2_ARR
    s_waitcnt vmcnt(0)
K2_ARR:
    s_mov_b64 exec, s[40:41]
    s_cbranch_execz K2_RK_A
K2_CK0:
    v_bfi_b32 v192, s61, v1, v2
    v_lshrrev_b32 v50, 24, v3
    v_cmp_ne_u32 vcc, s2, v192
    v_add_u32 v40, 163072, v50
    s_cbranch_vccnz K2_RT0
    ds_add_rtn_u32 v40, v40, v201
    v_mad_u32_u24 v50, v50, s58, v202
    s_mov_b64 exec, s[42:43]
    s_cbranch_execz K2_RK_A
    s_waitcnt vmcnt(2)
K2_CK1:
    v_bfi_b32 v192, s61, v5, v6
    v_lshrrev_b32 v51, 24, v7
    v_cmp_ne_u32 vcc, s2, v192
    v_add_u32 v41, 163072, v51
    s_cbranch_vccnz K2_RT1
    ds_add_rtn_u32 v41, v41, v201
    v_mad_u32_u24 v51, v51, s58, v202
    s_mov_b64 exec, s[44:45]
    s_cbranch_execz K2_RK_A
    s_waitcnt vmcnt(1)
K2_CK2:
    v_bfi_b32 v192, s61, v9, v10
    v_lshrrev_b32 v52, 24, v11
    v_cmp_ne_u32 vcc, s2, v192
    v_add_u32 v42, 163072, v52
    s_cbranch_vccnz K2_RT2
    ds_add_rtn_u32 v42, v42, v201
    v_mad_u32_u24 v52, v52, s58, v202
    s_mov_b64 exec, s[46:47]
    s_cbranch_execz K2_RK_A
    s_waitcnt vmcnt(0)
K2_CK3:
    v_bfi_b32 v192, s61, v13, v14
    v_lshrrev_b32 v53, 24, v15
    v_cmp_ne_u32 vcc, s2, v192
    v_add_u32 v43, 163072, v53
    s_cbranch_vccnz K2_RT3
    ds_add_rtn_u32 v43, v43, v201
    v_mad_u32_u24 v53, v53, s58, v202
    s_mov_b64 exec, s[48:49]
    s_cbranch_execz K2_RK_A
K2_CK4:
    v_bfi_b32 v192, s61, v17, v18
    v_lshrrev_b32 v54, 24, v19
    v_cmp_ne_u32 vcc, s2, v192
    v_add_u32 v44, 163072, v54
    s_cbranch_vccnz K2_RT4
    ds_add_rtn_u32 v44, v44, v201
    v_mad_u32_u24 v54, v54, s58, v202
    s_mov_b64 exec, s[50:51]
    s_cbranch_execz K2_RK_A
K2_CK5:
    v_bfi_b32 v192, s61, v21, v22
    v_lshrrev_b32 v55, 24, v23
    v_cmp_ne_u32 vcc, s2, v192
    v_add_u32 v45, 163072, v55
    s_cbranch_vccnz K2_RT5
    ds_add_rtn_u32 v45, v45, v201
    v_mad_u32_u24 v55, v55, s58, v202
    s_mov_b64 exec, s[90:91]
    s_cbranch_execz K2_RK_A
K2_CK6:
    v_bfi_b32 v192, s61, v25, v26
    v_lshrrev_b32 v56, 24, v27
    v_cmp_ne_u32 vcc, s2, v192
    v_add_u32 v46, 163072, v56
    s_cbranch_vccnz K2_RT6
    ds_add_rtn_u32 v46, v46, v201
    v_mad_u32_u24 v56, v56, s58, v202
    s_mov_b64 exec, s[92:93]
    s_cbranch_execz K2_RK_A
K2_CK7:
    v_bfi_b32 v192, s61, v29, v30
    v_lshrrev_b32 v57, 24, v31
    v_cmp_ne_u32 vcc, s2, v192
    v_add_u32 v47, 163072, v57
    s_cbranch_vccnz K2_RT7
    ds_add_rtn_u32 v47, v47, v201
    v_mad_u32_u24 v57, v57, s58, v202
    s_mov_b64 exec, s[94:95]
    s_cbranch_execz K2_RK_A
K2_CK8:
    v_bfi_b32 v192, s61, v33, v34
    v_lshrrev_b32 v58, 24, v35
    v_cmp_ne_u32 vcc, s2, v192
    v_add_u32 v48, 163072, v58
    s_cbranch_vccnz K2_RT8
    ds_add_rtn_u32 v48, v48, v201
    v_mad_u32_u24 v58, v58, s58, v202
    s_mov_b64 exec, s[96:97]
    s_cbranch_execz K2_RK_A
K2_CK9:
    v_bfi_b32 v192, s61, v37, v38
    v_lshrrev_b32 v59, 24, v39
    v_cmp_ne_u32 vcc, s2, v192
    v_add_u32 v49, 163072, v59
    s_cbranch_vccnz K2_RT9
    ds_add_rtn_u32 v49, v49, v201
    v_mad_u32_u24 v59, v59, s58, v202
K2_RK_A:
    s_mov_b64 exec, -1
    s_mov_b64 exec, s[40:41]
    s_cbranch_execz K2_TP
    v_cmp_gt_u32 vcc, s62, v50
    v_and_b32 v3, 0xffffff, v3
    s_mov_b64 exec, vcc
    buffer_load_dword v245, v3, s[16:19], 0 offen
    s_mov_b64 exec, s[42:43]
    s_cbranch_execz K2_TP
    v_cmp_gt_u32 vcc, s62, v51
    v_and_b32 v7, 0xffffff, v7
    s_mov_b64 exec, vcc
    buffer_load_dword v245, v7, s[16:19], 0 offen
    s_mov_b64 exec, s[44:45]
    s_cbranch_execz K2_TP
    v_cmp_gt_u32 vcc, s62, v52
    v_and_b32 v11, 0xffffff, v11
    s_mov_b64 exec, vcc
    buffer_load_dword v245, v11, s[16:19], 0 offen
    s_mov_b64 exec, s[46:47]
    s_cbranch_execz K2_TP
    v_cmp_gt_u32 vcc, s62, v53
    v_and_b32 v15, 0xffffff, v15
    s_mov_b64 exec, vcc
    buffer_load_dword v245, v15, s[16:19], 0 offen
    s_mov_b64 exec, s[48:49]
    s_cbranch_execz K2_TP
    v_cmp_gt_u32 vcc, s62, v54
    v_and_b32 v19, 0xffffff, v19
    s_mov_b64 exec, vcc
    buffer_load_dword v245, v19, s[16:19], 0 offen
    s_mov_b64 exec, s[50:51]
    s_cbranch_execz K2_TP
    v_cmp_gt_u32 vcc, s62, v55
    v_and_b32 v23, 0xffffff, v23
    s_mov_b64 exec, vcc
    buffer_load_dword v245, v23, s[16:19], 0 offen
    s_mov_b64 exec, s[90:91]
    s_cbranch_execz K2_TP
    v_cmp_gt_u32 vcc, s62, v56
    v_and_b32 v27, 0xffffff, v27
    s_mov_b64 exec, vcc
    buffer_load_dword v245, v27, s[16:19], 0 offen
    s_mov_b64 exec, s[92:93]
    s_cbranch_execz K2_TP
    v_cmp_gt_u32 vcc, s62, v57
    v_and_b32 v31, 0xffffff, v31
    s_mov_b64 exec, vcc
    buffer_load_dword v245, v31, s[16:19], 0 offen
    s_mov_b64 exec, s[94:95]
    s_cbranch_execz K2_TP
    v_cmp_gt_u32 vcc, s62, v58
    v_and_b32 v35, 0xffffff, v35
    s_mov_b64 exec, vcc
    buffer_load_dword v245, v35, s[16:19], 0 offen
    s_mov_b64 exec, s[96:97]
    s_cbranch_execz K2_TP
    v_cmp_gt_u32 vcc, s62, v59
    v_and_b32 v39, 0xffffff, v39
    s_mov_b64 exec, vcc
    buffer_load_dword v245, v39, s[16:19], 0 offen
K2_TP:
    s_mov_b64 exec, -1
K2_RK_DONE:
K2_PAD_SC:
    s_cbranch_execz KS_HOP
    s_mul_i32 s67, s24, 48
    s_movk_i32 s58, -1532
    s_waitcnt lgkmcnt(0)
    s_mov_b64 exec, s[40:41]
    s_cbranch_execz K2_SC_DONE
    v_cmpx_gt_u32 vcc, 64, v40
    v_add_u32 v193, 16, v40
    v_lshl_add_u32 v195, v40, 1, v50
    v_lshrrev_b32 v193, 6, v193
    v_lshl_add_u32 v194, v40, 5, v50
    ds_write_b16 v195, v0
    v_mad_i32_i24 v194, v193, s58, v194
    ds_write_b16_d16_hi v195, v0 offset:128
    ds_write_b16_d16_hi v195, v1 offset:256
    ds_write_b16 v195, v2 offset:384
    ds_write_b32 v194, v3 offset:512
    s_mov_b64 exec, s[42:43]
    s_cbranch_execz K2_SC_DONE
    v_cmpx_gt_u32 vcc, 64, v41
    v_add_u32 v193, 16, v41
    v_lshl_add_u32 v195, v41, 1, v51
    v_lshrrev_b32 v193, 6, v193
    v_lshl_add_u32 v194, v41, 5, v51
    ds_write_b16 v195, v4
    v_mad_i32_i24 v194, v193, s58, v194
    ds_write_b16_d16_hi v195, v4 offset:128
    ds_write_b16_d16_hi v195, v5 offset:256
    ds_write_b16 v195, v6 offset:384
    ds_write_b32 v194, v7 offset:512
    s_mov_b64 exec, s[44:45]
    s_cbranch_execz K2_SC_DONE
    v_cmpx_gt_u32 vcc, 64, v42
    v_add_u32 v193, 16, v42
    v_lshl_add_u32 v195, v42, 1, v52
    v_lshrrev_b32 v193, 6, v193
    v_lshl_add_u32 v194, v42, 5, v52
    ds_write_b16 v195, v8
    v_mad_i32_i24 v194, v193, s58, v194
    ds_write_b16_d16_hi v195, v8 offset:128
    ds_write_b16_d16_hi v195, v9 offset:256
    ds_write_b16 v195, v10 offset:384
    ds_write_b32 v194, v11 offset:512
    s_mov_b64 exec, s[46:47]
    s_cbranch_execz K2_SC_DONE
    v_cmpx_gt_u32 vcc, 64, v43
    v_add_u32 v193, 16, v43
    v_lshl_add_u32 v195, v43, 1, v53
    v_lshrrev_b32 v193, 6, v193
    v_lshl_add_u32 v194, v43, 5, v53
    ds_write_b16 v195, v12
    v_mad_i32_i24 v194, v193, s58, v194
    ds_write_b16_d16_hi v195, v12 offset:128
    ds_write_b16_d16_hi v195, v13 offset:256
    ds_write_b16 v195, v14 offset:384
    ds_write_b32 v194, v15 offset:512
    s_mov_b64 exec, s[48:49]
    s_cbranch_execz K2_SC_DONE
    v_cmpx_gt_u32 vcc, 64, v44
    v_add_u32 v193, 16, v44
    v_lshl_add_u32 v195, v44, 1, v54
    v_lshrrev_b32 v193, 6, v193
    v_lshl_add_u32 v194, v44, 5, v54
    ds_write_b16 v195, v16
    v_mad_i32_i24 v194, v193, s58, v194
    ds_write_b16_d16_hi v195, v16 offset:128
    ds_write_b16_d16_hi v195, v17 offset:256
    ds_write_b16 v195, v18 offset:384
    ds_write_b32 v194, v19 offset:512
    s_mov_b64 exec, s[50:51]
    s_cbranch_execz K2_SC_DONE
    v_cmpx_gt_u32 vcc, 64, v45
    v_add_u32 v193, 16, v45
    v_lshl_add_u32 v195, v45, 1, v55
    v_lshrrev_b32 v193, 6, v193
    v_lshl_add_u32 v194, v45, 5, v55
    ds_write_b16 v195, v20
    v_mad_i32_i24 v194, v193, s58, v194
    ds_write_b16_d16_hi v195, v20 offset:128
    ds_write_b16_d16_hi v195, v21 offset:256
    ds_write_b16 v195, v22 offset:384
    ds_write_b32 v194, v23 offset:512
    s_mov_b64 exec, s[90:91]
    s_cbranch_execz K2_SC_DONE
    v_cmpx_gt_u32 vcc, 64, v46
    v_add_u32 v193, 16, v46
    v_lshl_add_u32 v195, v46, 1, v56
    v_lshrrev_b32 v193, 6, v193
    v_lshl_add_u32 v194, v46, 5, v56
    ds_write_b16 v195, v24
    v_mad_i32_i24 v194, v193, s58, v194
    ds_write_b16_d16_hi v195, v24 offset:128
    ds_write_b16_d16_hi v195, v25 offset:256
    ds_write_b16 v195, v26 offset:384
    ds_write_b32 v194, v27 offset:512
    s_mov_b64 exec, s[92:93]
    s_cbranch_execz K2_SC_DONE
    v_cmpx_gt_u32 vcc, 64, v47
    v_add_u32 v193, 16, v47
    v_lshl_add_u32 v195, v47, 1, v57
    v_lshrrev_b32 v193, 6, v193
    v_lshl_add_u32 v194, v47, 5, v57
    ds_write_b16 v195, v28
    v_mad_i32_i24 v194, v193, s58, v194
    ds_write_b16_d16_hi v195, v28 offset:128
    ds_write_b16_d16_hi v195, v29 offset:256
    ds_write_b16 v195, v30 offset:384
    ds_write_b32 v194, v31 offset:512
    s_mov_b64 exec, s[94:95]
    s_cbranch_execz K2_SC_DONE
    v_cmpx_gt_u32 vcc, 64, v48
    v_add_u32 v193, 16, v48
    v_lshl_add_u32 v195, v48, 1, v58
    v_lshrrev_b32 v193, 6, v193
    v_lshl_add_u32 v194, v48, 5, v58
    ds_write_b16 v195, v32
    v_mad_i32_i24 v194, v193, s58, v194
    ds_write_b16_d16_hi v195, v32 offset:128
    ds_write_b16_d16_hi v195, v33 offset:256
    ds_write_b16 v195, v34 offset:384
    ds_write_b32 v194, v35 offset:512
    s_mov_b64 exec, s[96:97]
    s_cbranch_execz K2_SC_DONE
    v_cmpx_gt_u32 vcc, 64, v49
    v_add_u32 v193, 16, v49
    v_lshl_add_u32 v195, v49, 1, v59
    v_lshrrev_b32 v193, 6, v193
    v_lshl_add_u32 v194, v49, 5, v59
    ds_write_b16 v195, v36
    v_mad_i32_i24 v194, v193, s58, v194
    ds_write_b16_d16_hi v195, v36 offset:128
    ds_write_b16_d16_hi v195, v37 offset:256
    ds_write_b16 v195, v38 offset:384
    ds_write_b32 v194, v39 offset:512
K2_SC_DONE:
    s_mov_b64 exec, -1
K2_PAD_SD:
    s_cbranch_execz KS_HOP
    v_lshlrev_b32 v192, 2, v176
    v_add_u32 v192, 163072, v192
    v_mov_b32 v200, 163300
    s_cmp_eq_u32 s24, 0
    s_cselect_b32 s26, 64, 48
    s_waitcnt lgkmcnt(0)
    s_barrier
    ds_read_b32 v193, v192
    ds_read_b32 v200, v200
    v_cmp_gt_u32 s[56:57], s22, v176
    v_mad_u32_u24 v195, v176, s59, v202
    s_waitcnt lgkmcnt(0)
    v_cndmask_b32 v193, 0, v193, s[56:57]
    v_readfirstlane_b32 s27, v200
    v_cmp_lt_u32 s[62:63], 48, v193
    v_cmp_lt_u32 vcc, 64, v193
    s_bcnt1_i32_b64 s60, s[62:63]
    v_mbcnt_lo_u32_b32 v198, s62, 0
    v_mbcnt_hi_u32_b32 v198, s63, v198
    s_cbranch_vccnz K2_BIG
    s_cmp_gt_u32 s60, 8
    s_cbranch_scc1 K2_BIG
K2_TOK:
    v_subrev_u32 v194, s67, v193
    v_max_i32 v194, 1, v194
    v_min_i32 v194, s26, v194
    v_add_u32 v194, 15, v194
    v_lshrrev_b32 v194, 4, v194
    v_lshl_or_b32 v195, v194, 18, v195
    v_lshl_or_b32 v195, v198, 27, v195
    v_mov_b32 v197, 425088
    v_cndmask_b32 v253, v197, v195, s[56:57]
    s_movk_i32 s40, 0
    s_movk_i32 s41, 256
    s_movk_i32 s42, 512
    s_movk_i32 s43, 768
    s_add_u32 s24, s24, 1
    s_cmp_ge_u32 s24, s25
    s_cselect_b32 s55, 1, 0
    s_cmp_eq_u32 s27, 0
    s_cselect_b32 s55, s55, 0
    s_mov_b32 s27, 0x400000
    s_mov_b32 s38, 0
    s_mov_b32 s34, 0
    s_mov_b32 s35, 0
    s_mov_b32 s36, 1
    s_mov_b32 s31, 0
    s_mov_b32 s58, s20
    v_readlane_b32 s3, v253, s58
    s_lshl_b32 s44, s34, 7
    s_and_b32 s48, s3, 0x3ffff
    s_bfe_u32 s33, s3, 0x30012
    s_mul_i32 s35, s38, 6
    s_cmp_eq_u32 s34, 0
    s_cselect_b32 s35, s35, s48
    s_mov_b32 s45, s44
    s_add_u32 s47, s44, 256
    s_add_u32 s49, s48, 32
    s_add_u32 s60, s48, 64
    s_cmp_eq_u32 s33, 3
    s_cselect_b32 s46, s44, s47
    s_cselect_b32 s50, s60, s48
    s_cselect_b32 s51, s48, s49
    s_sub_u32 s60, s33, 2
    s_cmp_lt_u32 s60, 2
    s_cbranch_scc0 K2_rare_1
K2_back_2:
    v_add_u32 v233, s48, v230
    ds_read_b32 v232, v233
    ds_read_b32 v233, v233 offset:1024
    v_add_u32 v222, s48, v251
    ds_read_b32 v222, v222
    v_add_u32 v224, s49, v251
    ds_read_b32 v224, v224
    v_add_u32 v226, s50, v251
    ds_read_b32 v226, v226
    v_add_u32 v228, s51, v251
    ds_read_b32 v228, v228
    s_waitcnt lgkmcnt(4)
    v_or_b32 v232, v232, v231
    v_or_b32 v233, v233, v231
    s_cmp_lg_u32 s34, 0
    s_cbranch_scc1 K2_dum_4
    s_cmp_eq_u32 s33, 4
    s_cbranch_scc1 K2_a4_5
K2_b4_7:
    s_add_u32 m0, s48, 512
    s_add_u32 s65, s48, 1536
    buffer_load_dwordx4 v232, s[16:19], 0 offen  lds
    s_mov_b32 m0, s65
    s_mov_b32 exec_hi, 0
    buffer_load_dwordx4 v233, s[16:19], 0 offen  lds
    s_mov_b32 exec_hi, -1
K2_back_6:
    s_waitcnt lgkmcnt(3)
    v_mad_u32_u16 v223, v222, s39, v248 op_sel:[1,0,0,0]
    v_mad_u32_u16 v222, v222, s39, v248
    s_waitcnt lgkmcnt(2)
    v_mad_u32_u16 v225, v224, s39, v248 op_sel:[1,0,0,0]
    v_mad_u32_u16 v224, v224, s39, v248
    s_waitcnt lgkmcnt(1)
    v_mad_u32_u16 v227, v226, s39, v248 op_sel:[1,0,0,0]
    v_mad_u32_u16 v226, v226, s39, v248
    s_waitcnt lgkmcnt(0)
    v_mad_u32_u16 v229, v228, s39, v248 op_sel:[1,0,0,0]
    v_mad_u32_u16 v228, v228, s39, v248
    s_mov_b32 m0, s68
    s_nop 0
    buffer_load_dwordx4 v222, s[4:7], s44 offen sc1 lds
    buffer_load_dwordx4 v223, s[72:75], s44 offen offset:1024 sc1 lds
    s_mov_b32 m0, s69
    s_nop 0
    buffer_load_dwordx4 v224, s[4:7], s45 offen sc1 lds
    buffer_load_dwordx4 v225, s[72:75], s45 offen offset:1024 sc1 lds
    s_mov_b32 m0, s70
    s_nop 0
    buffer_load_dwordx4 v226, s[4:7], s46 offen sc1 lds
    buffer_load_dwordx4 v227, s[72:75], s46 offen offset:1024 sc1 lds
    s_mov_b32 m0, s71
    s_nop 0
    buffer_load_dwordx4 v228, s[4:7], s47 offen sc1 lds
    buffer_load_dwordx4 v229, s[72:75], s47 offen offset:1024 sc1 lds
    v_add_u32 v249, s48, v249
    v_add_u32 v250, s48, v250
    s_waitcnt vmcnt(6)
    ds_read_b64_tr_b16 v[176:177], v246 offset:0
    ds_read_b64_tr_b16 v[178:179], v246 offset:512
    ds_read_b64_tr_b16 v[180:181], v247 offset:0
    ds_read_b64_tr_b16 v[182:183], v247 offset:512
    ds_read_b64_tr_b16 v[0:1], v249 offset:0
    ds_read_b64_tr_b16 v[2:3], v249 offset:256
    ds_read_u16_d16_hi v16, v250 offset:0
    ds_read_b64_tr_b16 v[4:5], v249 offset:512
    ds_read_b64_tr_b16 v[6:7], v249 offset:768
    ds_read_u16_d16_hi v17, v250 offset:32
    s_mov_b32 s29, s48
    s_mov_b32 s32, s31
    s_mov_b32 s30, s3
    s_mov_b32 s31, s35
    s_cmp_eq_u32 s33, 2
    s_cbranch_scc1 K2_U20
    s_cmp_eq_u32 s33, 3
    s_cbranch_scc1 K2_U30
    s_cmp_eq_u32 s33, 1
    s_cbranch_scc1 K2_U10
    s_branch K2_U40
K2_PAD_H1:
    s_branch KS_HOP0
KS_HELP:
    s_mov_b32 s30, 0
    s_cmp_eq_u32 s20, 6
    s_cbranch_scc1 KS_RAW
    s_mov_b32 s30, 2
    s_cmp_ge_u32 s2, 170
    s_cbranch_scc1 KS_NOW
    s_mov_b32 s30, 1
    v_and_b32 v1, 15, v8
    v_lshrrev_b32 v3, 4, v8
    s_cmp_ge_u32 s2, 160
    s_cbranch_scc1 K1_WT
    s_cmp_ge_u32 s2, 64
    s_cbranch_scc1 K1_S1
    s_lshr_b32 s24, s2, 3
    s_and_b32 s25, s2, 7
    s_lshr_b32 s26, s25, 2
    s_bfe_u32 s27, s25, 0x10001
    s_and_b32 s28, s25, 1
    s_mov_b32 s60, s92
    s_and_b32 s61, s93, 0xffff
    s_mov_b32 s62, 65536
    s_mov_b32 s63, 0x20000
    s_branch K1_SC
K1_S1:
    s_sub_u32 s29, s2, 64
    s_mul_i32 s24, s29, 43
    s_lshr_b32 s24, s24, 9
    s_mul_i32 s25, s24, 12
    s_sub_u32 s25, s29, s25
    s_cmp_ge_u32 s25, 6
    s_cselect_b32 s26, 1, 0
    s_mul_i32 s27, s26, 6
    s_sub_u32 s27, s25, s27
    s_lshr_b32 s27, s27, 1
    s_and_b32 s28, s25, 1
    s_add_u32 s25, s25, 8
    s_mov_b32 s60, s94
    s_and_b32 s61, s95, 0xffff
    s_mov_b32 s62, 98304
    s_mov_b32 s63, 0x20000
K1_SC:
    s_lshl_b32 s27, s27, 7
    s_lshl_b32 s26, s26, 6
    s_lshl_b32 s28, s28, 4
    s_add_u32 s27, s27, s26
    s_add_u32 s27, s27, s28
    s_lshl_b32 s27, s27, 8
    s_lshl_b32 s26, s24, 5
    s_add_u32 s27, s27, s26
    s_add_u32 s29, s27, 8192
    v_lshlrev_b32 v3, 10, v3
    v_lshl_add_u32 v3, v1, 1, v3
    buffer_load_ushort v64, v3, s[60:63], s27 offen offset:0
    buffer_load_ushort v65, v3, s[60:63], s29 offen offset:0
    buffer_load_ushort v66, v3, s[60:63], s27 offen offset:256
    buffer_load_ushort v67, v3, s[60:63], s29 offen offset:256
    buffer_load_ushort v68, v3, s[60:63], s27 offen offset:512
    buffer_load_ushort v69, v3, s[60:63], s29 offen offset:512
    buffer_load_ushort v70, v3, s[60:63], s27 offen offset:768
    buffer_load_ushort v71, v3, s[60:63], s29 offen offset:768
    s_mul_i32 s24, s24, 20
    s_add_u32 s24, s24, s25
    s_lshl_b32 s24, s24, 10
    s_add_u32 s24, s24, 6946816
    s_branch K1_GO
K1_WT:
    s_sub_u32 s24, s2, 160
    s_lshr_b32 s27, s24, 1
    s_and_b32 s28, s24, 1
    s_lshl_b32 s27, s27, 8
    s_lshl_b32 s28, s28, 6
    s_add_u32 s27, s27, s28
    s_add_u32 s29, s27, 10240
    s_mov_b32 s60, s90
    s_and_b32 s61, s91, 0xffff
    s_mov_b32 s62, 20480
    s_mov_b32 s63, 0x20000
    v_and_b32 v1, 31, v8
    v_lshrrev_b32 v3, 5, v8
    v_mul_u32_u24 v3, 5120, v3
    v_lshl_add_u32 v3, v1, 1, v3
    buffer_load_ushort v64, v3, s[60:63], s27 offen offset:0
    buffer_load_ushort v65, v3, s[60:63], s27 offen offset:1280
    buffer_load_ushort v66, v3, s[60:63], s27 offen offset:2560
    buffer_load_ushort v67, v3, s[60:63], s27 offen offset:3840
    buffer_load_ushort v68, v3, s[60:63], s29 offen offset:0
    buffer_load_ushort v69, v3, s[60:63], s29 offen offset:1280
    buffer_load_ushort v70, v3, s[60:63], s29 offen offset:2560
    buffer_load_ushort v71, v3, s[60:63], s29 offen offset:3840
    s_lshl_b32 s24, s24, 10
    s_add_u32 s24, s24, 7110656
K1_GO:
KS_NOW:
    s_barrier
K2_PAD_H2:
    s_cbranch_execz KS_HOP0
    v_and_b32 v76, 31, v8
    v_lshrrev_b32 v77, 5, v8
    v_cmp_le_u32 vcc, 24, v76
    v_mul_u32_u24 v77, 2080, v77
    v_lshl_add_u32 v78, v76, 4, v77
    v_cndmask_b32 v80, 0, -1, vcc
    v_add_u32 v78, 65536, v78
    v_mov_b32 v81, v80
    v_mov_b32 v82, v80
    v_mov_b32 v83, v80
    v_add_u32 v79, 41600, v78
    ds_write_b128 v78, v[80:83] offset:0
    ds_write_b128 v78, v[80:83] offset:4160
    ds_write_b128 v78, v[80:83] offset:8320
    ds_write_b128 v78, v[80:83] offset:12480
    ds_write_b128 v78, v[80:83] offset:16640
    ds_write_b128 v78, v[80:83] offset:20800
    ds_write_b128 v78, v[80:83] offset:24960
    ds_write_b128 v78, v[80:83] offset:29120
    ds_write_b128 v78, v[80:83] offset:33280
    ds_write_b128 v78, v[80:83] offset:37440
    ds_write_b128 v79, v[80:83] offset:0
    ds_write_b128 v79, v[80:83] offset:4160
    ds_write_b128 v79, v[80:83] offset:8320
    ds_write_b128 v79, v[80:83] offset:12480
    ds_write_b128 v79, v[80:83] offset:16640
    ds_write_b128 v79, v[80:83] offset:20800
    ds_write_b128 v79, v[80:83] offset:24960
    ds_write_b128 v79, v[80:83] offset:29120
    ds_write_b128 v79, v[80:83] offset:33280
    ds_write_b128 v79, v[80:83] offset:37440
KS_FILL:
    v_mov_b32 v59, 163376
    s_barrier
    ds_read_b32 v59, v59
    s_waitcnt vmcnt(0) lgkmcnt(0)
    s_cmp_eq_u32 s30, 0
    s_cbranch_scc1 KS_B3
    s_cmp_eq_u32 s30, 2
    s_cbranch_scc1 KS_NOST
    v_lshl_or_b32 v40, v65, 16, v64
    v_lshl_or_b32 v41, v67, 16, v66
    v_lshl_or_b32 v42, v69, 16, v68
    v_lshl_or_b32 v43, v71, 16, v70
    buffer_store_dwordx4 v[40:43], v9, s[8:11], s24 offen sc1
KS_NOST:
    s_waitcnt lgkmcnt(0)
    s_barrier
    s_lshl_b32 s24, s2, 2
    s_add_u32 s24, s24, 7176192
    s_mov_b64 exec, 1
    s_waitcnt vmcnt(0)
    buffer_store_dword v59, v6, s[8:11], s24 offen sc1
    s_mov_b64 exec, -1
    s_branch KS_JOIN
K2_PAD_H3:
    s_branch KS_HOP0
KS_RAW:
    s_barrier
    s_mov_b32 s60, s90
    s_and_b32 s61, s91, 0xffff
    s_mov_b32 s62, 20480
    s_mov_b32 s63, 0x20000
    v_lshrrev_b32 v10, 3, v8
    v_and_b32 v11, 7, v8
    v_lshlrev_b32 v10, 8, v10
    v_lshl_add_u32 v10, v11, 4, v10
    s_mov_b32 m0, 24576
    s_movk_i32 s24, 0
    buffer_load_dwordx4 v10, s[60:63], s24 offen lds
    s_mov_b32 m0, 25600
    s_movk_i32 s24, 2048
    buffer_load_dwordx4 v10, s[60:63], s24 offen lds
    s_mov_b32 m0, 26624
    s_movk_i32 s24, 4096
    buffer_load_dwordx4 v10, s[60:63], s24 offen lds
    s_mov_b32 m0, 27648
    s_movk_i32 s24, 6144
    buffer_load_dwordx4 v10, s[60:63], s24 offen lds
    s_mov_b32 m0, 28672
    s_movk_i32 s24, 8192
    buffer_load_dwordx4 v10, s[60:63], s24 offen lds
    s_mov_b32 m0, 29696
    s_movk_i32 s24, 10240
    buffer_load_dwordx4 v10, s[60:63], s24 offen lds
    s_mov_b32 m0, 30720
    s_movk_i32 s24, 12288
    buffer_load_dwordx4 v10, s[60:63], s24 offen lds
    s_mov_b32 m0, 31744
    s_movk_i32 s24, 14336
    buffer_load_dwordx4 v10, s[60:63], s24 offen lds
    s_mov_b32 m0, 32768
    s_movk_i32 s24, 16384
    buffer_load_dwordx4 v10, s[60:63], s24 offen lds
    s_mov_b32 m0, 33792
    s_movk_i32 s24, 18432
    buffer_load_dwordx4 v10, s[60:63], s24 offen lds
    s_mov_b32 m0, 152832
    s_movk_i32 s24, 128
    buffer_load_dwordx4 v10, s[60:63], s24 offen lds
    s_mov_b32 m0, 153856
    s_movk_i32 s24, 2176
    buffer_load_dwordx4 v10, s[60:63], s24 offen lds
    s_mov_b32 m0, 154880
    s_movk_i32 s24, 4224
    buffer_load_dwordx4 v10, s[60:63], s24 offen lds
    s_mov_b32 m0, 155904
    s_movk_i32 s24, 6272
    buffer_load_dwordx4 v10, s[60:63], s24 offen lds
    s_mov_b32 m0, 156928
    s_movk_i32 s24, 8320
    buffer_load_dwordx4 v10, s[60:63], s24 offen lds
    s_mov_b32 m0, 157952
    s_movk_i32 s24, 10368
    buffer_load_dwordx4 v10, s[60:63], s24 offen lds
    s_mov_b32 m0, 158976
    s_movk_i32 s24, 12416
    buffer_load_dwordx4 v10, s[60:63], s24 offen lds
    s_mov_b32 m0, 160000
    s_movk_i32 s24, 14464
    buffer_load_dwordx4 v10, s[60:63], s24 offen lds
    s_mov_b32 m0, 161024
    s_movk_i32 s24, 16512
    buffer_load_dwordx4 v10, s[60:63], s24 offen lds
    s_mov_b32 m0, 162048
    s_movk_i32 s24, 18560
    buffer_load_dwordx4 v10, s[60:63], s24 offen lds
    v_add_u32 v85, 16, v8
    v_lshlrev_b32 v84, 5, v8
    v_lshrrev_b32 v85, 6, v85
    v_mul_u32_u24 v85, 1532, v85
    v_sub_u32 v84, v84, v85
    v_mov_b32 v85, -1
    v_add_u32 v84, 66048, v84
    v_add_u32 v86, 41600, v84
    ds_write_b32 v84, v85 offset:0
    ds_write_b32 v84, v85 offset:2080
    ds_write_b32 v84, v85 offset:4160
    ds_write_b32 v84, v85 offset:6240
    ds_write_b32 v84, v85 offset:8320
    ds_write_b32 v84, v85 offset:10400
    ds_write_b32 v84, v85 offset:12480
    ds_write_b32 v84, v85 offset:14560
    ds_write_b32 v84, v85 offset:16640
    ds_write_b32 v84, v85 offset:18720
    ds_write_b32 v84, v85 offset:20800
    ds_write_b32 v84, v85 offset:22880
    ds_write_b32 v84, v85 offset:24960
    ds_write_b32 v84, v85 offset:27040
    ds_write_b32 v84, v85 offset:29120
    ds_write_b32 v84, v85 offset:31200
    ds_write_b32 v84, v85 offset:33280
    ds_write_b32 v84, v85 offset:35360
    ds_write_b32 v84, v85 offset:37440
    ds_write_b32 v84, v85 offset:39520
    ds_write_b32 v86, v85 offset:0
    ds_write_b32 v86, v85 offset:2080
    ds_write_b32 v86, v85 offset:4160
    ds_write_b32 v86, v85 offset:6240
    ds_write_b32 v86, v85 offset:8320
    ds_write_b32 v86, v85 offset:10400
    ds_write_b32 v86, v85 offset:12480
    ds_write_b32 v86, v85 offset:14560
    ds_write_b32 v86, v85 offset:16640
    ds_write_b32 v86, v85 offset:18720
    ds_write_b32 v86, v85 offset:20800
    ds_write_b32 v86, v85 offset:22880
    ds_write_b32 v86, v85 offset:24960
    ds_write_b32 v86, v85 offset:27040
    ds_write_b32 v86, v85 offset:29120
    ds_write_b32 v86, v85 offset:31200
    ds_write_b32 v86, v85 offset:33280
    ds_write_b32 v86, v85 offset:35360
    ds_write_b32 v86, v85 offset:37440
    ds_write_b32 v86, v85 offset:39520
    s_branch KS_FILL
KS_IDLE:
    s_barrier
    s_barrier
    s_branch KS_B3
K2_PAD_U20:
    s_branch K2_HOP
K2_U20:
    s_setprio 1
    s_waitcnt lgkmcnt(0)
    v_lshlrev_b32 v20, 16, v0
    v_and_b32 v21, 0xffff0000, v0
    v_lshlrev_b32 v22, 16, v1
    v_and_b32 v23, 0xffff0000, v1
    v_lshlrev_b32 v24, 16, v2
    v_and_b32 v25, 0xffff0000, v2
    v_lshlrev_b32 v26, 16, v3
    v_and_b32 v27, 0xffff0000, v3
    v_mul_f32_dpp v36, v16, v20 row_newbcast:8 row_mask:0xf bank_mask:0xf
    v_mul_f32_dpp v37, v16, v21 row_newbcast:9 row_mask:0xf bank_mask:0xf
    v_mul_f32_dpp v38, v16, v22 row_newbcast:10 row_mask:0xf bank_mask:0xf
    v_mul_f32_dpp v39, v16, v23 row_newbcast:11 row_mask:0xf bank_mask:0xf
    v_mul_f32_dpp v40, v16, v24 row_newbcast:12 row_mask:0xf bank_mask:0xf
    v_mul_f32_dpp v41, v16, v25 row_newbcast:13 row_mask:0xf bank_mask:0xf
    v_mul_f32_dpp v42, v16, v26 row_newbcast:14 row_mask:0xf bank_mask:0xf
    v_mul_f32_dpp v43, v16, v27 row_newbcast:15 row_mask:0xf bank_mask:0xf
    v_cvt_pk_bf16_f32 v68, v36, v37
    v_cvt_pk_bf16_f32 v69, v38, v39
    v_cvt_pk_bf16_f32 v70, v40, v41
    v_cvt_pk_bf16_f32 v71, v42, v43
    v_mul_f32_dpp v20, v16, v20 row_newbcast:0 row_mask:0xa bank_mask:0xf
    v_mul_f32_dpp v21, v16, v21 row_newbcast:1 row_mask:0xa bank_mask:0xf
    v_mul_f32_dpp v22, v16, v22 row_newbcast:2 row_mask:0xa bank_mask:0xf
    v_mul_f32_dpp v23, v16, v23 row_newbcast:3 row_mask:0xa bank_mask:0xf
    v_mul_f32_dpp v24, v16, v24 row_newbcast:4 row_mask:0xa bank_mask:0xf
    v_mul_f32_dpp v25, v16, v25 row_newbcast:5 row_mask:0xa bank_mask:0xf
    v_mul_f32_dpp v26, v16, v26 row_newbcast:6 row_mask:0xa bank_mask:0xf
    v_mul_f32_dpp v27, v16, v27 row_newbcast:7 row_mask:0xa bank_mask:0xf
    v_cvt_pk_bf16_f32 v64, v20, v21
    v_cvt_pk_bf16_f32 v65, v22, v23
    v_cvt_pk_bf16_f32 v66, v24, v25
    v_cvt_pk_bf16_f32 v67, v26, v27
    v_lshlrev_b32 v28, 16, v4
    v_and_b32 v29, 0xffff0000, v4
    v_lshlrev_b32 v30, 16, v5
    v_and_b32 v31, 0xffff0000, v5
    v_lshlrev_b32 v32, 16, v6
    v_and_b32 v33, 0xffff0000, v6
    v_lshlrev_b32 v34, 16, v7
    v_and_b32 v35, 0xffff0000, v7
    v_mul_f32_dpp v36, v17, v28 row_newbcast:8 row_mask:0xf bank_mask:0xf
    v_mul_f32_dpp v37, v17, v29 row_newbcast:9 row_mask:0xf bank_mask:0xf
    v_mul_f32_dpp v38, v17, v30 row_newbcast:10 row_mask:0xf bank_mask:0xf
    v_mul_f32_dpp v39, v17, v31 row_newbcast:11 row_mask:0xf bank_mask:0xf
    v_mul_f32_dpp v40, v17, v32 row_newbcast:12 row_mask:0xf bank_mask:0xf
    v_mul_f32_dpp v41, v17, v33 row_newbcast:13 row_mask:0xf bank_mask:0xf
    v_mul_f32_dpp v42, v17, v34 row_newbcast:14 row_mask:0xf bank_mask:0xf
    v_mul_f32_dpp v43, v17, v35 row_newbcast:15 row_mask:0xf bank_mask:0xf
    v_cvt_pk_bf16_f32 v76, v36, v37
    v_cvt_pk_bf16_f32 v77, v38, v39
    v_cvt_pk_bf16_f32 v78, v40, v41
    v_cvt_pk_bf16_f32 v79, v42, v43
    v_mul_f32_dpp v28, v17, v28 row_newbcast:0 row_mask:0xa bank_mask:0xf
    v_mul_f32_dpp v29, v17, v29 row_newbcast:1 row_mask:0xa bank_mask:0xf
    v_mul_f32_dpp v30, v17, v30 row_newbcast:2 row_mask:0xa bank_mask:0xf
    v_mul_f32_dpp v31, v17, v31 row_newbcast:3 row_mask:0xa bank_mask:0xf
    v_mul_f32_dpp v32, v17, v32 row_newbcast:4 row_mask:0xa bank_mask:0xf
    v_mul_f32_dpp v33, v17, v33 row_newbcast:5 row_mask:0xa bank_mask:0xf
    v_mul_f32_dpp v34, v17, v34 row_newbcast:6 row_mask:0xa bank_mask:0xf
    v_mul_f32_dpp v35, v17, v35 row_newbcast:7 row_mask:0xa bank_mask:0xf
    v_cvt_pk_bf16_f32 v72, v28, v29
    v_cvt_pk_bf16_f32 v73, v30, v31
    v_cvt_pk_bf16_f32 v74, v32, v33
    v_cvt_pk_bf16_f32 v75, v34, v35
    s_waitcnt vmcnt(4)
    v_mfma_f32_32x32x16_bf16 v[0:15], v[64:67], v[176:179], 0
    ds_read_b64_tr_b16 v[184:185], v246 offset:2048
    ds_read_b64_tr_b16 v[186:187], v246 offset:2560
    ds_read_b64_tr_b16 v[188:189], v247 offset:2048
    ds_read_b64_tr_b16 v[190:191], v247 offset:2560
    s_mov_b32 m0, s68
    v_mfma_f32_32x32x16_bf16 v[16:31], v[68:71], v[176:179], 0
    buffer_load_dwordx4 v222, s[4:7], s42 offen sc1 lds
    buffer_load_dwordx4 v223, s[72:75], s42 offen offset:1024 sc1 lds
    v_permlane32_swap_b32 v242, v236
    v_permlane32_swap_b32 v243, v237
    s_add_u32 s38, s38, 1
    v_mfma_f32_32x32x16_bf16 v[32:47], v[64:67], v[180:183], 0
    v_permlane32_swap_b32 v244, v238
    v_permlane32_swap_b32 v245, v239
    v_permlane32_swap_b32 v240, v241
    v_add_f32 v242, v242, v236
    v_mfma_f32_32x32x16_bf16 v[48:63], v[68:71], v[180:183], 0
    v_add_f32 v243, v243, v237
    v_add_f32 v244, v244, v238
    v_add_f32 v245, v245, v239
    v_add_f32 v240, -v240, -v241
    v_mov_b32 v254, s52
    v_mov_b32 v255, s38
    s_waitcnt vmcnt(4) lgkmcnt(0)
    v_mfma_f32_32x32x16_bf16 v[0:15], v[72:75], v[184:187], v[0:15]
    ds_read_b64_tr_b16 v[176:177], v246 offset:4096
    ds_read_b64_tr_b16 v[178:179], v246 offset:4608
    ds_read_b64_tr_b16 v[180:181], v247 offset:4096
    ds_read_b64_tr_b16 v[182:183], v247 offset:4608
    s_lshl_b32 s58, s38, 3
    s_add_u32 s58, s58, s20
    s_mov_b32 m0, s69
    v_mfma_f32_32x32x16_bf16 v[16:31], v[76:79], v[184:187], v[16:31]
    buffer_load_dwordx4 v224, s[4:7], s42 offen sc1 lds
    buffer_load_dwordx4 v225, s[72:75], s42 offen offset:1024 sc1 lds
    s_set_gpr_idx_on s32, gpr_idx(DST)
    s_nop 0
    v_cvt_pk_bf16_f32 v195, v242, v243
    v_cvt_pk_bf16_f32 v196, v244, v245
    v_cvt_pk_bf16_f32 v197, v240, v240
    s_set_gpr_idx_off
    s_mov_b64 exec, 1
    ds_write_b32 v254, v255
    s_mov_b64 exec, -1
    s_cmp_lt_u32 s58, s22
    s_cbranch_scc0 K2_dyn_8
K2_back_9:
    v_readlane_b32 s3, v253, s58
    s_lshl_b32 s44, s34, 7
    s_and_b32 s48, s3, 0x3ffff
    s_bfe_u32 s33, s3, 0x30012
    s_mul_i32 s35, s38, 6
    s_cmp_eq_u32 s34, 0
    s_cselect_b32 s35, s35, s48
    s_mov_b32 s45, s44
    s_add_u32 s47, s44, 256
    s_add_u32 s49, s48, 32
    s_add_u32 s60, s48, 64
    s_cmp_eq_u32 s33, 3
    s_cselect_b32 s46, s44, s47
    s_cselect_b32 s50, s60, s48
    s_cselect_b32 s51, s48, s49
    s_sub_u32 s60, s33, 2
    s_cmp_lt_u32 s60, 2
    s_cbranch_scc0 K2_rare_14
K2_back_15:
    v_mfma_f32_32x32x16_bf16 v[32:47], v[72:75], v[188:191], v[32:47]
    v_add_u32 v233, s48, v230
    ds_read_b32 v232, v233
    ds_read_b32 v233, v233 offset:1024
    v_mul_f32 v234, v0, v96
    v_mul_f32 v236, v8, v128
    v_fmac_f32 v234, v1, v97
    v_fmac_f32 v236, v9, v129
    v_mfma_f32_32x32x16_bf16 v[48:63], v[76:79], v[188:191], v[48:63]
    s_setprio 0
    v_fmac_f32 v234, v2, v98
    v_fmac_f32 v236, v10, v130
    v_fmac_f32 v234, v3, v99
    v_fmac_f32 v236, v11, v131
    v_fmac_f32 v234, v4, v100
    v_fmac_f32 v236, v12, v132
    v_fmac_f32 v234, v5, v101
    v_fmac_f32 v236, v13, v133
    v_fmac_f32 v234, v6, v102
    v_fmac_f32 v236, v14, v134
    v_fmac_f32 v234, v7, v103
    v_fmac_f32 v236, v15, v135
    v_mul_f32 v238, v16, v128
    v_mul_f32 v240, v24, v128
    v_fmac_f32 v238, v17, v129
    v_fmac_f32 v240, v25, v129
    v_fmac_f32 v238, v18, v130
    v_fmac_f32 v240, v26, v130
    v_fmac_f32 v238, v19, v131
    v_fmac_f32 v240, v27, v131
    v_fmac_f32 v238, v20, v132
    v_fmac_f32 v240, v28, v132
    v_fmac_f32 v238, v21, v133
    v_fmac_f32 v240, v29, v133
    v_fmac_f32 v238, v22, v134
    v_fmac_f32 v240, v30, v134
    v_fmac_f32 v238, v23, v135
    v_fmac_f32 v240, v31, v135
    v_mul_f32 v235, v32, v104
    v_mul_f32 v237, v40, v136
    v_fmac_f32 v235, v33, v105
    v_fmac_f32 v237, v41, v137
    v_fmac_f32 v235, v34, v106
    v_fmac_f32 v237, v42, v138
    v_fmac_f32 v235, v35, v107
    v_fmac_f32 v237, v43, v139
    v_fmac_f32 v235, v36, v108
    v_fmac_f32 v237, v44, v140
    v_fmac_f32 v235, v37, v109
    v_fmac_f32 v237, v45, v141
    v_fmac_f32 v235, v38, v110
    v_fmac_f32 v237, v46, v142
    v_fmac_f32 v235, v39, v111
    v_fmac_f32 v237, v47, v143
    v_mul_f32 v239, v48, v136
    v_mul_f32 v241, v56, v136
    v_fmac_f32 v239, v49, v137
    v_fmac_f32 v241, v57, v137
    s_setprio 1
    s_waitcnt vmcnt(4) lgkmcnt(3)
    v_mfma_f32_32x32x16_bf16 v[0:15], v[64:67], v[176:179], 0
    ds_read_b64_tr_b16 v[184:185], v246 offset:6144
    ds_read_b64_tr_b16 v[186:187], v246 offset:6656
    ds_read_b64_tr_b16 v[188:189], v247 offset:6144
    ds_read_b64_tr_b16 v[190:191], v247 offset:6656
    v_fmac_f32 v239, v50, v138
    v_fmac_f32 v241, v58, v138
    s_mov_b32 m0, s70
    v_mfma_f32_32x32x16_bf16 v[16:31], v[68:71], v[176:179], 0
    buffer_load_dwordx4 v222, s[4:7], s43 offen sc1 lds
    buffer_load_dwordx4 v223, s[72:75], s43 offen offset:1024 sc1 lds
    v_fmac_f32 v239, v51, v139
    v_fmac_f32 v241, v59, v139
    v_fmac_f32 v239, v52, v140
    v_fmac_f32 v241, v60, v140
    v_fmac_f32 v239, v53, v141
    v_mfma_f32_32x32x16_bf16 v[32:47], v[64:67], v[180:183], 0
    v_add_u32 v222, s48, v251
    ds_read_b32 v222, v222
    v_fmac_f32 v241, v61, v141
    v_fmac_f32 v239, v54, v142
    v_fmac_f32 v241, v62, v142
    v_fmac_f32 v239, v55, v143
    v_fmac_f32 v241, v63, v143
    v_mfma_f32_32x32x16_bf16 v[48:63], v[68:71], v[180:183], 0
    v_permlane32_swap_b32 v234, v236
    v_permlane32_swap_b32 v235, v237
    v_permlane32_swap_b32 v240, v238
    s_waitcnt lgkmcnt(5)
    v_or_b32 v232, v232, v231
    v_or_b32 v233, v233, v231
    s_cmp_lg_u32 s34, 0
    s_cbranch_scc1 K2_dum_17
    s_cmp_eq_u32 s33, 4
    s_cbranch_scc1 K2_a4_18
K2_b4_20:
    s_add_u32 m0, s48, 512
    s_add_u32 s65, s48, 1536
    buffer_load_dwordx4 v232, s[16:19], 0 offen  lds
    s_mov_b32 m0, s65
    s_mov_b32 exec_hi, 0
    buffer_load_dwordx4 v233, s[16:19], 0 offen  lds
    s_mov_b32 exec_hi, -1
K2_back_19:
    s_waitcnt vmcnt(6) lgkmcnt(1)
    v_mfma_f32_32x32x16_bf16 v[0:15], v[72:75], v[184:187], v[0:15]
    ds_read_b64_tr_b16 v[176:177], v246 offset:0
    ds_read_b64_tr_b16 v[178:179], v246 offset:512
    ds_read_b64_tr_b16 v[180:181], v247 offset:0
    ds_read_b64_tr_b16 v[182:183], v247 offset:512
    v_permlane32_swap_b32 v241, v239
    s_mov_b32 m0, s71
    v_mfma_f32_32x32x16_bf16 v[16:31], v[76:79], v[184:187], v[16:31]
    buffer_load_dwordx4 v224, s[4:7], s43 offen sc1 lds
    buffer_load_dwordx4 v225, s[72:75], s43 offen offset:1024 sc1 lds
    s_waitcnt lgkmcnt(4)
    v_mad_u32_u16 v223, v222, s39, v248 op_sel:[1,0,0,0]
    v_mad_u32_u16 v222, v222, s39, v248
    v_add_f32 v234, v234, v236
    v_add_f32 v235, v235, v237
    v_add_f32 v240, v240, v238
    v_add_f32 v241, v241, v239
    s_set_gpr_idx_on s31, gpr_idx(DST)
    s_nop 0
    v_cvt_pk_bf16_f32 v192, v234, v235
    v_cvt_pk_bf16_f32 v193, v240, v241
    s_set_gpr_idx_off
    v_mfma_f32_32x32x16_bf16 v[32:47], v[72:75], v[188:191], v[32:47]
    v_add_u32 v224, s49, v251
    ds_read_b32 v224, v224
    v_mul_f32 v234, v0, v144
    v_mul_f32 v236, v8, v112
    v_fmac_f32 v234, v1, v145
    v_fmac_f32 v236, v9, v113
    v_fmac_f32 v234, v2, v146
    v_mfma_f32_32x32x16_bf16 v[48:63], v[76:79], v[188:191], v[48:63]
    s_setprio 0
    v_fmac_f32 v236, v10, v114
    v_fmac_f32 v234, v3, v147
    v_fmac_f32 v236, v11, v115
    v_fmac_f32 v234, v4, v148
    v_fmac_f32 v236, v12, v116
    v_fmac_f32 v234, v5, v149
    v_fmac_f32 v236, v13, v117
    v_fmac_f32 v234, v6, v150
    v_fmac_f32 v236, v14, v118
    v_fmac_f32 v234, v7, v151
    v_fmac_f32 v236, v15, v119
    v_mul_f32 v238, v16, v160
    v_mul_f32 v240, v24, v160
    v_fmac_f32 v238, v17, v161
    v_fmac_f32 v240, v25, v161
    v_fmac_f32 v238, v18, v162
    v_fmac_f32 v240, v26, v162
    v_fmac_f32 v238, v19, v163
    v_fmac_f32 v240, v27, v163
    v_fmac_f32 v238, v20, v164
    v_fmac_f32 v240, v28, v164
    v_fmac_f32 v238, v21, v165
    v_fmac_f32 v240, v29, v165
    v_fmac_f32 v238, v22, v166
    v_fmac_f32 v240, v30, v166
    v_fmac_f32 v238, v23, v167
    v_fmac_f32 v240, v31, v167
    v_mul_f32 v235, v32, v152
    v_mul_f32 v237, v40, v120
    v_fmac_f32 v235, v33, v153
    v_fmac_f32 v237, v41, v121
    v_fmac_f32 v235, v34, v154
    v_fmac_f32 v237, v42, v122
    v_fmac_f32 v235, v35, v155
    v_fmac_f32 v237, v43, v123
    v_fmac_f32 v235, v36, v156
    v_fmac_f32 v237, v44, v124
    v_fmac_f32 v235, v37, v157
    v_fmac_f32 v237, v45, v125
    v_fmac_f32 v235, v38, v158
    v_fmac_f32 v237, v46, v126
    v_fmac_f32 v235, v39, v159
    v_fmac_f32 v237, v47, v127
    v_mul_f32 v239, v48, v168
    v_mul_f32 v241, v56, v168
    v_fmac_f32 v239, v49, v169
    v_fmac_f32 v241, v57, v169
    v_fmac_f32 v239, v50, v170
    v_fmac_f32 v241, v58, v170
    v_fmac_f32 v239, v51, v171
    s_setprio 1
    s_waitcnt vmcnt(6) lgkmcnt(1)
    v_mfma_f32_32x32x16_bf16 v[0:15], v[64:67], v[176:179], 0
    ds_read_b64_tr_b16 v[184:185], v246 offset:2048
    ds_read_b64_tr_b16 v[186:187], v246 offset:2560
    ds_read_b64_tr_b16 v[188:189], v247 offset:2048
    ds_read_b64_tr_b16 v[190:191], v247 offset:2560
    v_fmac_f32 v241, v59, v171
    v_fmac_f32 v239, v52, v172
    s_mov_b32 m0, s68
    v_mfma_f32_32x32x16_bf16 v[16:31], v[68:71], v[176:179], 0
    buffer_load_dwordx4 v222, s[4:7], s44 offen sc1 lds
    buffer_load_dwordx4 v223, s[72:75], s44 offen offset:1024 sc1 lds
    s_waitcnt lgkmcnt(4)
    v_mad_u32_u16 v225, v224, s39, v248 op_sel:[1,0,0,0]
    v_mad_u32_u16 v224, v224, s39, v248
    v_fmac_f32 v241, v60, v172
    v_fmac_f32 v239, v53, v173
    v_mfma_f32_32x32x16_bf16 v[32:47], v[64:67], v[180:183], 0
    v_add_u32 v226, s50, v251
    ds_read_b32 v226, v226
    v_fmac_f32 v241, v61, v173
    v_fmac_f32 v239, v54, v174
    v_fmac_f32 v241, v62, v174
    v_fmac_f32 v239, v55, v175
    v_fmac_f32 v241, v63, v175
    v_mfma_f32_32x32x16_bf16 v[48:63], v[68:71], v[180:183], 0
    s_waitcnt vmcnt(6) lgkmcnt(1)
    v_mfma_f32_32x32x16_bf16 v[0:15], v[72:75], v[184:187], v[0:15]
    ds_read_b64_tr_b16 v[176:177], v246 offset:4096
    ds_read_b64_tr_b16 v[178:179], v246 offset:4608
    ds_read_b64_tr_b16 v[180:181], v247 offset:4096
    ds_read_b64_tr_b16 v[182:183], v247 offset:4608
    s_mov_b32 m0, s69
    v_mfma_f32_32x32x16_bf16 v[16:31], v[76:79], v[184:187], v[16:31]
    buffer_load_dwordx4 v224, s[4:7], s45 offen sc1 lds
    buffer_load_dwordx4 v225, s[72:75], s45 offen offset:1024 sc1 lds
    s_waitcnt lgkmcnt(4)
    v_mad_u32_u16 v227, v226, s39, v248 op_sel:[1,0,0,0]
    v_mad_u32_u16 v226, v226, s39, v248
    v_mfma_f32_32x32x16_bf16 v[32:47], v[72:75], v[188:191], v[32:47]
    v_add_u32 v228, s51, v251
    ds_read_b32 v228, v228
    v_mul_f32 v242, v0, v144
    v_fma_f32 v238, v8, v160, -v238
    v_fmac_f32 v242, v1, v145
    v_fmac_f32 v238, v9, v161
    v_fmac_f32 v242, v2, v146
    v_mfma_f32_32x32x16_bf16 v[48:63], v[76:79], v[188:191], v[48:63]
    s_setprio 0
    v_fmac_f32 v238, v10, v162
    v_fmac_f32 v242, v3, v147
    v_fmac_f32 v238, v11, v163
    v_fmac_f32 v242, v4, v148
    v_fmac_f32 v238, v12, v164
    v_fmac_f32 v242, v5, v149
    v_fmac_f32 v238, v13, v165
    v_fmac_f32 v242, v6, v150
    v_fmac_f32 v238, v14, v166
    v_fmac_f32 v242, v7, v151
    v_fmac_f32 v238, v15, v167
    v_fmac_f32 v236, v16, v112
    v_mul_f32 v244, v24, v160
    v_fmac_f32 v236, v17, v113
    v_fmac_f32 v244, v25, v161
    v_fmac_f32 v236, v18, v114
    v_fmac_f32 v244, v26, v162
    v_fmac_f32 v236, v19, v115
    v_fmac_f32 v244, v27, v163
    v_fmac_f32 v236, v20, v116
    v_fmac_f32 v244, v28, v164
    v_fmac_f32 v236, v21, v117
    v_fmac_f32 v244, v29, v165
    v_fmac_f32 v236, v22, v118
    v_fmac_f32 v244, v30, v166
    v_fmac_f32 v236, v23, v119
    v_fmac_f32 v244, v31, v167
    v_mul_f32 v243, v32, v152
    v_fma_f32 v239, v40, v168, -v239
    v_fmac_f32 v243, v33, v153
    v_fmac_f32 v239, v41, v169
    v_fmac_f32 v243, v34, v154
    v_fmac_f32 v239, v42, v170
    v_fmac_f32 v243, v35, v155
    v_fmac_f32 v239, v43, v171
    v_fmac_f32 v243, v36, v156
    v_fmac_f32 v239, v44, v172
    v_fmac_f32 v243, v37, v157
    v_fmac_f32 v239, v45, v173
    v_fmac_f32 v243, v38, v158
    v_fmac_f32 v239, v46, v174
    v_fmac_f32 v243, v39, v159
    v_fmac_f32 v239, v47, v175
    v_fmac_f32 v237, v48, v120
    v_mul_f32 v245, v56, v168
    v_fmac_f32 v237, v49, v121
    v_fmac_f32 v245, v57, v169
    v_fmac_f32 v237, v50, v122
    s_setprio 1
    s_waitcnt vmcnt(4) lgkmcnt(1)
    v_mfma_f32_32x32x16_bf16 v[0:15], v[64:67], v[176:179], 0
    ds_read_b64_tr_b16 v[184:185], v246 offset:6144
    ds_read_b64_tr_b16 v[186:187], v246 offset:6656
    ds_read_b64_tr_b16 v[188:189], v247 offset:6144
    ds_read_b64_tr_b16 v[190:191], v247 offset:6656
    v_fmac_f32 v245, v58, v170
    v_fmac_f32 v237, v51, v123
    s_mov_b32 m0, s70
    v_mfma_f32_32x32x16_bf16 v[16:31], v[68:71], v[176:179], 0
    buffer_load_dwordx4 v226, s[4:7], s46 offen sc1 lds
    buffer_load_dwordx4 v227, s[72:75], s46 offen offset:1024 sc1 lds
    s_waitcnt lgkmcnt(4)
    v_mad_u32_u16 v229, v228, s39, v248 op_sel:[1,0,0,0]
    v_mad_u32_u16 v228, v228, s39, v248
    v_fmac_f32 v245, v59, v171
    v_fmac_f32 v237, v52, v124
    v_mfma_f32_32x32x16_bf16 v[32:47], v[64:67], v[180:183], 0
    v_fmac_f32 v245, v60, v172
    v_fmac_f32 v237, v53, v125
    v_fmac_f32 v245, v61, v173
    v_fmac_f32 v237, v54, v126
    v_fmac_f32 v245, v62, v174
    v_fmac_f32 v237, v55, v127
    v_fmac_f32 v245, v63, v175
    v_mfma_f32_32x32x16_bf16 v[48:63], v[68:71], v[180:183], 0
    v_permlane32_swap_b32 v242, v234
    v_permlane32_swap_b32 v243, v235
    v_add_f32 v242, v242, v234
    v_add_f32 v243, v243, v235
    s_waitcnt vmcnt(4) lgkmcnt(0)
    v_mfma_f32_32x32x16_bf16 v[0:15], v[72:75], v[184:187], v[0:15]
    ds_read_b64_tr_b16 v[176:177], v246 offset:0
    ds_read_b64_tr_b16 v[178:179], v246 offset:512
    ds_read_b64_tr_b16 v[180:181], v247 offset:0
    ds_read_b64_tr_b16 v[182:183], v247 offset:512
    s_sub_u32 s26, s48, s29
    s_mov_b32 s29, s48
    s_mov_b32 m0, s71
    v_mfma_f32_32x32x16_bf16 v[16:31], v[76:79], v[184:187], v[16:31]
    buffer_load_dwordx4 v228, s[4:7], s47 offen sc1 lds
    buffer_load_dwordx4 v229, s[72:75], s47 offen offset:1024 sc1 lds
    s_set_gpr_idx_on s31, gpr_idx(DST)
    s_nop 0
    v_cvt_pk_bf16_f32 v194, v242, v243
    s_set_gpr_idx_off
    s_mov_b32 s30, s3
    s_cmp_eq_u32 s34, 0
    s_cselect_b32 s56, s33, 0
    v_mfma_f32_32x32x16_bf16 v[32:47], v[72:75], v[188:191], v[32:47]
    s_mov_b32 s32, s31
    s_mov_b32 s31, s35
    v_mul_f32 v242, v0, v144
    v_fma_f32 v240, v8, v160, -v240
    v_fmac_f32 v242, v1, v145
    v_fmac_f32 v240, v9, v161
    v_fmac_f32 v242, v2, v146
    v_mfma_f32_32x32x16_bf16 v[48:63], v[76:79], v[188:191], v[48:63]
    s_setprio 0
    v_fmac_f32 v240, v10, v162
    v_fmac_f32 v242, v3, v147
    v_fmac_f32 v240, v11, v163
    v_fmac_f32 v242, v4, v148
    v_fmac_f32 v240, v12, v164
    v_fmac_f32 v242, v5, v149
    v_fmac_f32 v240, v13, v165
    v_fmac_f32 v242, v6, v150
    v_fmac_f32 v240, v14, v166
    v_fmac_f32 v242, v7, v151
    v_fmac_f32 v240, v15, v167
    v_add_u32 v249, s26, v249
    v_add_u32 v250, s26, v250
    v_fma_f32 v244, v16, v160, -v244
    v_fmac_f32 v236, v24, v112
    v_fmac_f32 v244, v17, v161
    v_fmac_f32 v236, v25, v113
    v_fmac_f32 v244, v18, v162
    v_fmac_f32 v236, v26, v114
    v_fmac_f32 v244, v19, v163
    v_fmac_f32 v236, v27, v115
    v_fmac_f32 v244, v20, v164
    v_fmac_f32 v236, v28, v116
    v_fmac_f32 v244, v21, v165
    v_fmac_f32 v236, v29, v117
    v_fmac_f32 v244, v22, v166
    v_fmac_f32 v236, v30, v118
    v_fmac_f32 v244, v23, v167
    v_fmac_f32 v236, v31, v119
    ds_read_b64_tr_b16 v[0:1], v249 offset:0
    ds_read_b64_tr_b16 v[2:3], v249 offset:256
    ds_read_u16_d16_hi v16, v250 offset:0
    v_mul_f32 v243, v32, v152
    v_fma_f32 v241, v40, v168, -v241
    v_fmac_f32 v243, v33, v153
    v_fmac_f32 v241, v41, v169
    v_fmac_f32 v243, v34, v154
    v_fmac_f32 v241, v42, v170
    v_fmac_f32 v243, v35, v155
    v_fmac_f32 v241, v43, v171
    v_fmac_f32 v243, v36, v156
    v_fmac_f32 v241, v44, v172
    v_fmac_f32 v243, v37, v157
    v_fmac_f32 v241, v45, v173
    v_fmac_f32 v243, v38, v158
    v_fmac_f32 v241, v46, v174
    v_fmac_f32 v243, v39, v159
    v_fmac_f32 v241, v47, v175
    ds_read_b64_tr_b16 v[4:5], v249 offset:512
    ds_read_b64_tr_b16 v[6:7], v249 offset:768
    ds_read_u16_d16_hi v17, v250 offset:32
    v_fma_f32 v245, v48, v168, -v245
    v_fmac_f32 v237, v56, v120
    v_fmac_f32 v245, v49, v169
    v_fmac_f32 v237, v57, v121
    v_fmac_f32 v245, v50, v170
    v_fmac_f32 v237, v58, v122
    v_fmac_f32 v245, v51, v171
    v_fmac_f32 v237, v59, v123
    v_fmac_f32 v245, v52, v172
    v_fmac_f32 v237, v60, v124
    v_fmac_f32 v245, v53, v173
    v_fmac_f32 v237, v61, v125
    v_fmac_f32 v245, v54, v174
    v_fmac_f32 v237, v62, v126
    v_fmac_f32 v245, v55, v175
    v_fmac_f32 v237, v63, v127
    s_cmp_eq_u32 s56, 2
    s_cbranch_scc1 K2_U20
    s_cmp_eq_u32 s56, 3
    s_cbranch_scc1 K2_U30
    s_branch K2_DSP0
K2_PAD_U30:
    s_branch K2_HOP
K2_U30:
    s_setprio 1
    ds_read_b64_tr_b16 v[8:9], v249 offset:1024
    ds_read_b64_tr_b16 v[10:11], v249 offset:1280
    ds_read_u16_d16_hi v18, v250 offset:64
    s_waitcnt lgkmcnt(3)
    v_lshlrev_b32 v20, 16, v0
    v_and_b32 v21, 0xffff0000, v0
    v_lshlrev_b32 v22, 16, v1
    v_and_b32 v23, 0xffff0000, v1
    v_lshlrev_b32 v24, 16, v2
    v_and_b32 v25, 0xffff0000, v2
    v_lshlrev_b32 v26, 16, v3
    v_and_b32 v27, 0xffff0000, v3
    v_mul_f32_dpp v36, v16, v20 row_newbcast:8 row_mask:0xf bank_mask:0xf
    v_mul_f32_dpp v37, v16, v21 row_newbcast:9 row_mask:0xf bank_mask:0xf
    v_mul_f32_dpp v38, v16, v22 row_newbcast:10 row_mask:0xf bank_mask:0xf
    v_mul_f32_dpp v39, v16, v23 row_newbcast:11 row_mask:0xf bank_mask:0xf
    v_mul_f32_dpp v40, v16, v24 row_newbcast:12 row_mask:0xf bank_mask:0xf
    v_mul_f32_dpp v41, v16, v25 row_newbcast:13 row_mask:0xf bank_mask:0xf
    v_mul_f32_dpp v42, v16, v26 row_newbcast:14 row_mask:0xf bank_mask:0xf
    v_mul_f32_dpp v43, v16, v27 row_newbcast:15 row_mask:0xf bank_mask:0xf
    v_cvt_pk_bf16_f32 v68, v36, v37
    v_cvt_pk_bf16_f32 v69, v38, v39
    v_cvt_pk_bf16_f32 v70, v40, v41
    v_cvt_pk_bf16_f32 v71, v42, v43
    v_mul_f32_dpp v20, v16, v20 row_newbcast:0 row_mask:0xa bank_mask:0xf
    v_mul_f32_dpp v21, v16, v21 row_newbcast:1 row_mask:0xa bank_mask:0xf
    v_mul_f32_dpp v22, v16, v22 row_newbcast:2 row_mask:0xa bank_mask:0xf
    v_mul_f32_dpp v23, v16, v23 row_newbcast:3 row_mask:0xa bank_mask:0xf
    v_mul_f32_dpp v24, v16, v24 row_newbcast:4 row_mask:0xa bank_mask:0xf
    v_mul_f32_dpp v25, v16, v25 row_newbcast:5 row_mask:0xa bank_mask:0xf
    v_mul_f32_dpp v26, v16, v26 row_newbcast:6 row_mask:0xa bank_mask:0xf
    v_mul_f32_dpp v27, v16, v27 row_newbcast:7 row_mask:0xa bank_mask:0xf
    v_cvt_pk_bf16_f32 v64, v20, v21
    v_cvt_pk_bf16_f32 v65, v22, v23
    v_cvt_pk_bf16_f32 v66, v24, v25
    v_cvt_pk_bf16_f32 v67, v26, v27
    v_lshlrev_b32 v28, 16, v4
    v_and_b32 v29, 0xffff0000, v4
    v_lshlrev_b32 v30, 16, v5
    v_and_b32 v31, 0xffff0000, v5
    v_lshlrev_b32 v32, 16, v6
    v_and_b32 v33, 0xffff0000, v6
    v_lshlrev_b32 v34, 16, v7
    v_and_b32 v35, 0xffff0000, v7
    v_mul_f32_dpp v36, v17, v28 row_newbcast:8 row_mask:0xf bank_mask:0xf
    v_mul_f32_dpp v37, v17, v29 row_newbcast:9 row_mask:0xf bank_mask:0xf
    v_mul_f32_dpp v38, v17, v30 row_newbcast:10 row_mask:0xf bank_mask:0xf
    v_mul_f32_dpp v39, v17, v31 row_newbcast:11 row_mask:0xf bank_mask:0xf
    v_mul_f32_dpp v40, v17, v32 row_newbcast:12 row_mask:0xf bank_mask:0xf
    v_mul_f32_dpp v41, v17, v33 row_newbcast:13 row_mask:0xf bank_mask:0xf
    v_mul_f32_dpp v42, v17, v34 row_newbcast:14 row_mask:0xf bank_mask:0xf
    v_mul_f32_dpp v43, v17, v35 row_newbcast:15 row_mask:0xf bank_mask:0xf
    v_cvt_pk_bf16_f32 v76, v36, v37
    v_cvt_pk_bf16_f32 v77, v38, v39
    v_cvt_pk_bf16_f32 v78, v40, v41
    v_cvt_pk_bf16_f32 v79, v42, v43
    v_mul_f32_dpp v28, v17, v28 row_newbcast:0 row_mask:0xa bank_mask:0xf
    v_mul_f32_dpp v29, v17, v29 row_newbcast:1 row_mask:0xa bank_mask:0xf
    v_mul_f32_dpp v30, v17, v30 row_newbcast:2 row_mask:0xa bank_mask:0xf
    v_mul_f32_dpp v31, v17, v31 row_newbcast:3 row_mask:0xa bank_mask:0xf
    v_mul_f32_dpp v32, v17, v32 row_newbcast:4 row_mask:0xa bank_mask:0xf
    v_mul_f32_dpp v33, v17, v33 row_newbcast:5 row_mask:0xa bank_mask:0xf
    v_mul_f32_dpp v34, v17, v34 row_newbcast:6 row_mask:0xa bank_mask:0xf
    v_mul_f32_dpp v35, v17, v35 row_newbcast:7 row_mask:0xa bank_mask:0xf
    v_cvt_pk_bf16_f32 v72, v28, v29
    v_cvt_pk_bf16_f32 v73, v30, v31
    v_cvt_pk_bf16_f32 v74, v32, v33
    v_cvt_pk_bf16_f32 v75, v34, v35
    s_waitcnt lgkmcnt(0)
    v_lshlrev_b32 v20, 16, v8
    v_and_b32 v21, 0xffff0000, v8
    v_lshlrev_b32 v22, 16, v9
    v_and_b32 v23, 0xffff0000, v9
    v_lshlrev_b32 v24, 16, v10
    v_and_b32 v25, 0xffff0000, v10
    v_lshlrev_b32 v26, 16, v11
    v_and_b32 v27, 0xffff0000, v11
    v_mul_f32_dpp v36, v18, v20 row_newbcast:8 row_mask:0xf bank_mask:0xf
    v_mul_f32_dpp v37, v18, v21 row_newbcast:9 row_mask:0xf bank_mask:0xf
    v_mul_f32_dpp v38, v18, v22 row_newbcast:10 row_mask:0xf bank_mask:0xf
    v_mul_f32_dpp v39, v18, v23 row_newbcast:11 row_mask:0xf bank_mask:0xf
    v_mul_f32_dpp v40, v18, v24 row_newbcast:12 row_mask:0xf bank_mask:0xf
    v_mul_f32_dpp v41, v18, v25 row_newbcast:13 row_mask:0xf bank_mask:0xf
    v_mul_f32_dpp v42, v18, v26 row_newbcast:14 row_mask:0xf bank_mask:0xf
    v_mul_f32_dpp v43, v18, v27 row_newbcast:15 row_mask:0xf bank_mask:0xf
    v_cvt_pk_bf16_f32 v84, v36, v37
    v_cvt_pk_bf16_f32 v85, v38, v39
    v_cvt_pk_bf16_f32 v86, v40, v41
    v_cvt_pk_bf16_f32 v87, v42, v43
    v_mul_f32_dpp v20, v18, v20 row_newbcast:0 row_mask:0xa bank_mask:0xf
    v_mul_f32_dpp v21, v18, v21 row_newbcast:1 row_mask:0xa bank_mask:0xf
    v_mul_f32_dpp v22, v18, v22 row_newbcast:2 row_mask:0xa bank_mask:0xf
    v_mul_f32_dpp v23, v18, v23 row_newbcast:3 row_mask:0xa bank_mask:0xf
    v_mul_f32_dpp v24, v18, v24 row_newbcast:4 row_mask:0xa bank_mask:0xf
    v_mul_f32_dpp v25, v18, v25 row_newbcast:5 row_mask:0xa bank_mask:0xf
    v_mul_f32_dpp v26, v18, v26 row_newbcast:6 row_mask:0xa bank_mask:0xf
    v_mul_f32_dpp v27, v18, v27 row_newbcast:7 row_mask:0xa bank_mask:0xf
    v_cvt_pk_bf16_f32 v80, v20, v21
    v_cvt_pk_bf16_f32 v81, v22, v23
    v_cvt_pk_bf16_f32 v82, v24, v25
    v_cvt_pk_bf16_f32 v83, v26, v27
    s_waitcnt vmcnt(4)
    v_mfma_f32_32x32x16_bf16 v[0:15], v[64:67], v[176:179], 0
    ds_read_b64_tr_b16 v[184:185], v246 offset:2048
    ds_read_b64_tr_b16 v[186:187], v246 offset:2560
    ds_read_b64_tr_b16 v[188:189], v247 offset:2048
    ds_read_b64_tr_b16 v[190:191], v247 offset:2560
    s_mov_b32 m0, s68
    v_mfma_f32_32x32x16_bf16 v[16:31], v[68:71], v[176:179], 0
    buffer_load_dwordx4 v224, s[4:7], s41 offen sc1 lds
    buffer_load_dwordx4 v225, s[72:75], s41 offen offset:1024 sc1 lds
    v_permlane32_swap_b32 v242, v236
    v_permlane32_swap_b32 v243, v237
    s_add_u32 s38, s38, 1
    v_mfma_f32_32x32x16_bf16 v[32:47], v[64:67], v[180:183], 0
    v_permlane32_swap_b32 v244, v238
    v_permlane32_swap_b32 v245, v239
    v_permlane32_swap_b32 v240, v241
    v_add_f32 v242, v242, v236
    v_mfma_f32_32x32x16_bf16 v[48:63], v[68:71], v[180:183], 0
    v_add_f32 v243, v243, v237
    v_add_f32 v244, v244, v238
    v_add_f32 v245, v245, v239
    v_add_f32 v240, -v240, -v241
    v_mov_b32 v254, s52
    v_mov_b32 v255, s38
    s_waitcnt vmcnt(4) lgkmcnt(0)
    v_mfma_f32_32x32x16_bf16 v[0:15], v[72:75], v[184:187], v[0:15]
    ds_read_b64_tr_b16 v[176:177], v246 offset:4096
    ds_read_b64_tr_b16 v[178:179], v246 offset:4608
    ds_read_b64_tr_b16 v[180:181], v247 offset:4096
    ds_read_b64_tr_b16 v[182:183], v247 offset:4608
    s_lshl_b32 s58, s38, 3
    s_add_u32 s58, s58, s20
    s_mov_b32 m0, s69
    v_mfma_f32_32x32x16_bf16 v[16:31], v[76:79], v[184:187], v[16:31]
    buffer_load_dwordx4 v226, s[4:7], s41 offen sc1 lds
    buffer_load_dwordx4 v227, s[72:75], s41 offen offset:1024 sc1 lds
    s_set_gpr_idx_on s32, gpr_idx(DST)
    s_nop 0
    v_cvt_pk_bf16_f32 v195, v242, v243
    v_cvt_pk_bf16_f32 v196, v244, v245
    v_cvt_pk_bf16_f32 v197, v240, v240
    s_set_gpr_idx_off
    s_mov_b64 exec, 1
    ds_write_b32 v254, v255
    s_mov_b64 exec, -1
    s_cmp_lt_u32 s58, s22
    s_cbranch_scc0 K2_dyn_21
K2_back_22:
    v_readlane_b32 s3, v253, s58
    s_lshl_b32 s44, s34, 7
    s_and_b32 s48, s3, 0x3ffff
    s_bfe_u32 s33, s3, 0x30012
    s_mul_i32 s35, s38, 6
    s_cmp_eq_u32 s34, 0
    s_cselect_b32 s35, s35, s48
    s_mov_b32 s45, s44
    s_add_u32 s47, s44, 256
    s_add_u32 s49, s48, 32
    s_add_u32 s60, s48, 64
    s_cmp_eq_u32 s33, 3
    s_cselect_b32 s46, s44, s47
    s_cselect_b32 s50, s60, s48
    s_cselect_b32 s51, s48, s49
    s_sub_u32 s60, s33, 2
    s_cmp_lt_u32 s60, 2
    s_cbranch_scc0 K2_rare_27
K2_back_28:
    v_mfma_f32_32x32x16_bf16 v[32:47], v[72:75], v[188:191], v[32:47]
    v_add_u32 v233, s48, v230
    ds_read_b32 v232, v233
    ds_read_b32 v233, v233 offset:1024
    v_mfma_f32_32x32x16_bf16 v[48:63], v[76:79], v[188:191], v[48:63]
    s_waitcnt vmcnt(4) lgkmcnt(3)
    v_mfma_f32_32x32x16_bf16 v[0:15], v[80:83], v[176:179], v[0:15]
    ds_read_b64_tr_b16 v[184:185], v246 offset:6144
    ds_read_b64_tr_b16 v[186:187], v246 offset:6656
    ds_read_b64_tr_b16 v[188:189], v247 offset:6144
    ds_read_b64_tr_b16 v[190:191], v247 offset:6656
    s_mov_b32 m0, s70
    v_mfma_f32_32x32x16_bf16 v[16:31], v[84:87], v[176:179], v[16:31]
    buffer_load_dwordx4 v222, s[4:7], s42 offen sc1 lds
    buffer_load_dwordx4 v223, s[72:75], s42 offen offset:1024 sc1 lds
    v_mfma_f32_32x32x16_bf16 v[32:47], v[80:83], v[180:183], v[32:47]
    s_nop 2
    v_mul_f32 v234, v0, v96
    v_mul_f32 v236, v8, v128
    v_fmac_f32 v234, v1, v97
    v_fmac_f32 v236, v9, v129
    v_fmac_f32 v234, v2, v98
    v_fmac_f32 v236, v10, v130
    v_fmac_f32 v234, v3, v99
    v_mfma_f32_32x32x16_bf16 v[48:63], v[84:87], v[180:183], v[48:63]
    s_setprio 0
    s_waitcnt lgkmcnt(4)
    v_or_b32 v232, v232, v231
    v_or_b32 v233, v233, v231
    s_cmp_lg_u32 s34, 0
    s_cbranch_scc1 K2_dum_30
    s_cmp_eq_u32 s33, 4
    s_cbranch_scc1 K2_a4_31
K2_b4_33:
    s_add_u32 m0, s48, 512
    s_add_u32 s65, s48, 1536
    buffer_load_dwordx4 v232, s[16:19], 0 offen  lds
    s_mov_b32 m0, s65
    s_mov_b32 exec_hi, 0
    buffer_load_dwordx4 v233, s[16:19], 0 offen  lds
    s_mov_b32 exec_hi, -1
K2_back_32:
    v_fmac_f32 v236, v11, v131
    v_fmac_f32 v234, v4, v100
    v_fmac_f32 v236, v12, v132
    v_fmac_f32 v234, v5, v101
    v_fmac_f32 v236, v13, v133
    v_fmac_f32 v234, v6, v102
    v_fmac_f32 v236, v14, v134
    v_fmac_f32 v234, v7, v103
    v_fmac_f32 v236, v15, v135
    v_mul_f32 v238, v16, v128
    v_mul_f32 v240, v24, v128
    v_fmac_f32 v238, v17, v129
    v_fmac_f32 v240, v25, v129
    v_fmac_f32 v238, v18, v130
    v_fmac_f32 v240, v26, v130
    v_fmac_f32 v238, v19, v131
    v_fmac_f32 v240, v27, v131
    v_fmac_f32 v238, v20, v132
    v_fmac_f32 v240, v28, v132
    v_fmac_f32 v238, v21, v133
    v_fmac_f32 v240, v29, v133
    v_fmac_f32 v238, v22, v134
    v_fmac_f32 v240, v30, v134
    v_fmac_f32 v238, v23, v135
    v_fmac_f32 v240, v31, v135
    v_mul_f32 v235, v32, v104
    v_mul_f32 v237, v40, v136
    v_fmac_f32 v235, v33, v105
    v_fmac_f32 v237, v41, v137
    v_fmac_f32 v235, v34, v106
    v_fmac_f32 v237, v42, v138
    v_fmac_f32 v235, v35, v107
    v_fmac_f32 v237, v43, v139
    v_fmac_f32 v235, v36, v108
    v_fmac_f32 v237, v44, v140
    v_fmac_f32 v235, v37, v109
    v_fmac_f32 v237, v45, v141
    v_fmac_f32 v235, v38, v110
    v_fmac_f32 v237, v46, v142
    v_fmac_f32 v235, v39, v111
    v_fmac_f32 v237, v47, v143
    v_mul_f32 v239, v48, v136
    v_mul_f32 v241, v56, v136
    s_setprio 1
    s_waitcnt vmcnt(6) lgkmcnt(0)
    v_mfma_f32_32x32x16_bf16 v[0:15], v[64:67], v[184:187], 0
    ds_read_b64_tr_b16 v[176:177], v246 offset:0
    ds_read_b64_tr_b16 v[178:179], v246 offset:512
    ds_read_b64_tr_b16 v[180:181], v247 offset:0
    ds_read_b64_tr_b16 v[182:183], v247 offset:512
    v_fmac_f32 v239, v49, v137
    v_fmac_f32 v241, v57, v137
    s_mov_b32 m0, s71
    v_mfma_f32_32x32x16_bf16 v[16:31], v[68:71], v[184:187], 0
    buffer_load_dwordx4 v224, s[4:7], s42 offen sc1 lds
    buffer_load_dwordx4 v225, s[72:75], s42 offen offset:1024 sc1 lds
    v_fmac_f32 v239, v50, v138
    v_fmac_f32 v241, v58, v138
    v_fmac_f32 v239, v51, v139
    v_fmac_f32 v241, v59, v139
    v_fmac_f32 v239, v52, v140
    v_mfma_f32_32x32x16_bf16 v[32:47], v[64:67], v[188:191], 0
    v_fmac_f32 v241, v60, v140
    v_fmac_f32 v239, v53, v141
    v_fmac_f32 v241, v61, v141
    v_fmac_f32 v239, v54, v142
    v_fmac_f32 v241, v62, v142
    v_fmac_f32 v239, v55, v143
    v_fmac_f32 v241, v63, v143
    v_mfma_f32_32x32x16_bf16 v[48:63], v[68:71], v[188:191], 0
    v_permlane32_swap_b32 v234, v236
    v_permlane32_swap_b32 v235, v237
    v_permlane32_swap_b32 v240, v238
    s_waitcnt vmcnt(6) lgkmcnt(0)
    v_mfma_f32_32x32x16_bf16 v[0:15], v[72:75], v[176:179], v[0:15]
    ds_read_b64_tr_b16 v[184:185], v246 offset:2048
    ds_read_b64_tr_b16 v[186:187], v246 offset:2560
    ds_read_b64_tr_b16 v[188:189], v247 offset:2048
    ds_read_b64_tr_b16 v[190:191], v247 offset:2560
    v_permlane32_swap_b32 v241, v239
    s_mov_b32 m0, s68
    v_mfma_f32_32x32x16_bf16 v[16:31], v[76:79], v[176:179], v[16:31]
    buffer_load_dwordx4 v226, s[4:7], s42 offen sc1 lds
    buffer_load_dwordx4 v227, s[72:75], s42 offen offset:1024 sc1 lds
    v_add_f32 v234, v234, v236
    v_add_f32 v235, v235, v237
    v_add_f32 v240, v240, v238
    v_add_f32 v241, v241, v239
    v_mfma_f32_32x32x16_bf16 v[32:47], v[72:75], v[180:183], v[32:47]
    s_set_gpr_idx_on s31, gpr_idx(DST)
    s_nop 0
    v_cvt_pk_bf16_f32 v192, v234, v235
    v_cvt_pk_bf16_f32 v193, v240, v241
    s_set_gpr_idx_off
    v_mfma_f32_32x32x16_bf16 v[48:63], v[76:79], v[180:183], v[48:63]
    s_waitcnt vmcnt(6) lgkmcnt(0)
    v_mfma_f32_32x32x16_bf16 v[0:15], v[80:83], v[184:187], v[0:15]
    ds_read_b64_tr_b16 v[176:177], v246 offset:4096
    ds_read_b64_tr_b16 v[178:179], v246 offset:4608
    ds_read_b64_tr_b16 v[180:181], v247 offset:4096
    ds_read_b64_tr_b16 v[182:183], v247 offset:4608
    s_mov_b32 m0, s69
    v_mfma_f32_32x32x16_bf16 v[16:31], v[84:87], v[184:187], v[16:31]
    buffer_load_dwordx4 v222, s[4:7], s43 offen sc1 lds
    buffer_load_dwordx4 v223, s[72:75], s43 offen offset:1024 sc1 lds
    v_mfma_f32_32x32x16_bf16 v[32:47], v[80:83], v[188:191], v[32:47]
    s_nop 2
    v_mul_f32 v234, v0, v144
    v_mul_f32 v236, v8, v112
    v_fmac_f32 v234, v1, v145
    v_fmac_f32 v236, v9, v113
    v_fmac_f32 v234, v2, v146
    v_fmac_f32 v236, v10, v114
    v_fmac_f32 v234, v3, v147
    v_mfma_f32_32x32x16_bf16 v[48:63], v[84:87], v[188:191], v[48:63]
    s_setprio 0
    v_fmac_f32 v236, v11, v115
    v_fmac_f32 v234, v4, v148
    v_fmac_f32 v236, v12, v116
    v_fmac_f32 v234, v5, v149
    v_fmac_f32 v236, v13, v117
    v_fmac_f32 v234, v6, v150
    v_fmac_f32 v236, v14, v118
    v_fmac_f32 v234, v7, v151
    v_fmac_f32 v236, v15, v119
    v_mul_f32 v238, v16, v160
    v_mul_f32 v240, v24, v160
    v_fmac_f32 v238, v17, v161
    v_fmac_f32 v240, v25, v161
    v_fmac_f32 v238, v18, v162
    v_fmac_f32 v240, v26, v162
    v_fmac_f32 v238, v19, v163
    v_fmac_f32 v240, v27, v163
    v_fmac_f32 v238, v20, v164
    v_fmac_f32 v240, v28, v164
    v_fmac_f32 v238, v21, v165
    v_fmac_f32 v240, v29, v165
    v_fmac_f32 v238, v22, v166
    v_fmac_f32 v240, v30, v166
    v_fmac_f32 v238, v23, v167
    v_fmac_f32 v240, v31, v167
    v_mul_f32 v235, v32, v152
    v_mul_f32 v237, v40, v120
    v_fmac_f32 v235, v33, v153
    v_fmac_f32 v237, v41, v121
    v_fmac_f32 v235, v34, v154
    v_fmac_f32 v237, v42, v122
    v_fmac_f32 v235, v35, v155
    v_fmac_f32 v237, v43, v123
    v_fmac_f32 v235, v36, v156
    v_fmac_f32 v237, v44, v124
    v_fmac_f32 v235, v37, v157
    v_fmac_f32 v237, v45, v125
    v_fmac_f32 v235, v38, v158
    v_fmac_f32 v237, v46, v126
    v_fmac_f32 v235, v39, v159
    v_fmac_f32 v237, v47, v127
    v_mul_f32 v239, v48, v168
    v_mul_f32 v241, v56, v168
    v_fmac_f32 v239, v49, v169
    v_fmac_f32 v241, v57, v169
    s_setprio 1
    s_waitcnt vmcnt(4) lgkmcnt(0)
    v_mfma_f32_32x32x16_bf16 v[0:15], v[64:67], v[176:179], 0
    ds_read_b64_tr_b16 v[184:185], v246 offset:6144
    ds_read_b64_tr_b16 v[186:187], v246 offset:6656
    ds_read_b64_tr_b16 v[188:189], v247 offset:6144
    ds_read_b64_tr_b16 v[190:191], v247 offset:6656
    v_fmac_f32 v239, v50, v170
    v_fmac_f32 v241, v58, v170
    s_mov_b32 m0, s70
    v_mfma_f32_32x32x16_bf16 v[16:31], v[68:71], v[176:179], 0
    buffer_load_dwordx4 v224, s[4:7], s43 offen sc1 lds
    buffer_load_dwordx4 v225, s[72:75], s43 offen offset:1024 sc1 lds
    v_fmac_f32 v239, v51, v171
    v_fmac_f32 v241, v59, v171
    v_fmac_f32 v239, v52, v172
    v_fmac_f32 v241, v60, v172
    v_fmac_f32 v239, v53, v173
    v_mfma_f32_32x32x16_bf16 v[32:47], v[64:67], v[180:183], 0
    v_add_u32 v222, s48, v251
    ds_read_b32 v222, v222
    v_fmac_f32 v241, v61, v173
    v_fmac_f32 v239, v54, v174
    v_fmac_f32 v241, v62, v174
    v_fmac_f32 v239, v55, v175
    v_fmac_f32 v241, v63, v175
    v_mfma_f32_32x32x16_bf16 v[48:63], v[68:71], v[180:183], 0
    s_waitcnt vmcnt(4) lgkmcnt(1)
    v_mfma_f32_32x32x16_bf16 v[0:15], v[72:75], v[184:187], v[0:15]
    ds_read_b64_tr_b16 v[176:177], v246 offset:0
    ds_read_b64_tr_b16 v[178:179], v246 offset:512
    ds_read_b64_tr_b16 v[180:181], v247 offset:0
    ds_read_b64_tr_b16 v[182:183], v247 offset:512
    s_mov_b32 m0, s71
    v_mfma_f32_32x32x16_bf16 v[16:31], v[76:79], v[184:187], v[16:31]
    buffer_load_dwordx4 v226, s[4:7], s43 offen sc1 lds
    buffer_load_dwordx4 v227, s[72:75], s43 offen offset:1024 sc1 lds
    s_waitcnt lgkmcnt(4)
    v_mad_u32_u16 v223, v222, s39, v248 op_sel:[1,0,0,0]
    v_mad_u32_u16 v222, v222, s39, v248
    v_mfma_f32_32x32x16_bf16 v[32:47], v[72:75], v[188:191], v[32:47]
    v_add_u32 v224, s49, v251
    ds_read_b32 v224, v224
    v_mfma_f32_32x32x16_bf16 v[48:63], v[76:79], v[188:191], v[48:63]
    s_waitcnt vmcnt(4) lgkmcnt(1)
    v_mfma_f32_32x32x16_bf16 v[0:15], v[80:83], v[176:179], v[0:15]
    ds_read_b64_tr_b16 v[184:185], v246 offset:2048
    ds_read_b64_tr_b16 v[186:187], v246 offset:2560
    ds_read_b64_tr_b16 v[188:189], v247 offset:2048
    ds_read_b64_tr_b16 v[190:191], v247 offset:2560
    s_mov_b32 m0, s68
    v_mfma_f32_32x32x16_bf16 v[16:31], v[84:87], v[176:179], v[16:31]
    buffer_load_dwordx4 v222, s[4:7], s44 offen sc1 lds
    buffer_load_dwordx4 v223, s[72:75], s44 offen offset:1024 sc1 lds
    s_waitcnt lgkmcnt(4)
    v_mad_u32_u16 v225, v224, s39, v248 op_sel:[1,0,0,0]
    v_mad_u32_u16 v224, v224, s39, v248
    v_mfma_f32_32x32x16_bf16 v[32:47], v[80:83], v[180:183], v[32:47]
    v_add_u32 v226, s50, v251
    ds_read_b32 v226, v226
    v_mul_f32 v242, v0, v144
    v_fma_f32 v238, v8, v160, -v238
    v_fmac_f32 v242, v1, v145
    v_fmac_f32 v238, v9, v161
    v_fmac_f32 v242, v2, v146
    v_mfma_f32_32x32x16_bf16 v[48:63], v[84:87], v[180:183], v[48:63]
    s_setprio 0
    v_fmac_f32 v238, v10, v162
    v_fmac_f32 v242, v3, v147
    v_fmac_f32 v238, v11, v163
    v_fmac_f32 v242, v4, v148
    v_fmac_f32 v238, v12, v164
    v_fmac_f32 v242, v5, v149
    v_fmac_f32 v238, v13, v165
    v_fmac_f32 v242, v6, v150
    v_fmac_f32 v238, v14, v166
    v_fmac_f32 v242, v7, v151
    v_fmac_f32 v238, v15, v167
    v_fmac_f32 v236, v16, v112
    v_mul_f32 v244, v24, v160
    v_fmac_f32 v236, v17, v113
    v_fmac_f32 v244, v25, v161
    v_fmac_f32 v236, v18, v114
    v_fmac_f32 v244, v26, v162
    v_fmac_f32 v236, v19, v115
    v_fmac_f32 v244, v27, v163
    v_fmac_f32 v236, v20, v116
    v_fmac_f32 v244, v28, v164
    v_fmac_f32 v236, v21, v117
    v_fmac_f32 v244, v29, v165
    v_fmac_f32 v236, v22, v118
    v_fmac_f32 v244, v30, v166
    v_fmac_f32 v236, v23, v119
    v_fmac_f32 v244, v31, v167
    v_mul_f32 v243, v32, v152
    v_fma_f32 v239, v40, v168, -v239
    v_fmac_f32 v243, v33, v153
    v_fmac_f32 v239, v41, v169
    v_fmac_f32 v243, v34, v154
    v_fmac_f32 v239, v42, v170
    v_fmac_f32 v243, v35, v155
    v_fmac_f32 v239, v43, v171
    v_fmac_f32 v243, v36, v156
    v_fmac_f32 v239, v44, v172
    v_fmac_f32 v243, v37, v157
    v_fmac_f32 v239, v45, v173
    v_fmac_f32 v243, v38, v158
    v_fmac_f32 v239, v46, v174
    v_fmac_f32 v243, v39, v159
    v_fmac_f32 v239, v47, v175
    v_fmac_f32 v237, v48, v120
    v_mul_f32 v245, v56, v168
    v_fmac_f32 v237, v49, v121
    v_fmac_f32 v245, v57, v169
    v_fmac_f32 v237, v50, v122
    v_fmac_f32 v245, v58, v170
    v_fmac_f32 v237, v51, v123
    s_setprio 1
    s_waitcnt vmcnt(4) lgkmcnt(1)
    v_mfma_f32_32x32x16_bf16 v[0:15], v[64:67], v[184:187], 0
    ds_read_b64_tr_b16 v[176:177], v246 offset:4096
    ds_read_b64_tr_b16 v[178:179], v246 offset:4608
    ds_read_b64_tr_b16 v[180:181], v247 offset:4096
    ds_read_b64_tr_b16 v[182:183], v247 offset:4608
    v_fmac_f32 v245, v59, v171
    v_fmac_f32 v237, v52, v124
    s_mov_b32 m0, s69
    v_mfma_f32_32x32x16_bf16 v[16:31], v[68:71], v[184:187], 0
    buffer_load_dwordx4 v224, s[4:7], s45 offen sc1 lds
    buffer_load_dwordx4 v225, s[72:75], s45 offen offset:1024 sc1 lds
    s_waitcnt lgkmcnt(4)
    v_mad_u32_u16 v227, v226, s39, v248 op_sel:[1,0,0,0]
    v_mad_u32_u16 v226, v226, s39, v248
    v_fmac_f32 v245, v60, v172
    v_fmac_f32 v237, v53, v125
    v_mfma_f32_32x32x16_bf16 v[32:47], v[64:67], v[188:191], 0
    v_add_u32 v228, s51, v251
    ds_read_b32 v228, v228
    v_fmac_f32 v245, v61, v173
    v_fmac_f32 v237, v54, v126
    v_fmac_f32 v245, v62, v174
    v_fmac_f32 v237, v55, v127
    v_fmac_f32 v245, v63, v175
    v_mfma_f32_32x32x16_bf16 v[48:63], v[68:71], v[188:191], 0
    v_permlane32_swap_b32 v242, v234
    v_permlane32_swap_b32 v243, v235
    v_add_f32 v242, v242, v234
    v_add_f32 v243, v243, v235
    s_waitcnt vmcnt(4) lgkmcnt(1)
    v_mfma_f32_32x32x16_bf16 v[0:15], v[72:75], v[176:179], v[0:15]
    ds_read_b64_tr_b16 v[184:185], v246 offset:6144
    ds_read_b64_tr_b16 v[186:187], v246 offset:6656
    ds_read_b64_tr_b16 v[188:189], v247 offset:6144
    ds_read_b64_tr_b16 v[190:191], v247 offset:6656
    s_mov_b32 m0, s70
    v_mfma_f32_32x32x16_bf16 v[16:31], v[76:79], v[176:179], v[16:31]
    buffer_load_dwordx4 v226, s[4:7], s46 offen sc1 lds
    buffer_load_dwordx4 v227, s[72:75], s46 offen offset:1024 sc1 lds
    s_waitcnt lgkmcnt(4)
    v_mad_u32_u16 v229, v228, s39, v248 op_sel:[1,0,0,0]
    v_mad_u32_u16 v228, v228, s39, v248
    s_sub_u32 s26, s48, s29
    s_mov_b32 s29, s48
    v_mfma_f32_32x32x16_bf16 v[32:47], v[72:75], v[180:183], v[32:47]
    s_set_gpr_idx_on s31, gpr_idx(DST)
    s_nop 0
    v_cvt_pk_bf16_f32 v194, v242, v243
    s_set_gpr_idx_off
    s_mov_b32 s30, s3
    s_cmp_eq_u32 s34, 0
    s_cselect_b32 s56, s33, 0
    s_mov_b32 s32, s31
    v_mfma_f32_32x32x16_bf16 v[48:63], v[76:79], v[180:183], v[48:63]
    s_mov_b32 s31, s35
    s_waitcnt vmcnt(4) lgkmcnt(0)
    v_mfma_f32_32x32x16_bf16 v[0:15], v[80:83], v[184:187], v[0:15]
    ds_read_b64_tr_b16 v[176:177], v246 offset:0
    ds_read_b64_tr_b16 v[178:179], v246 offset:512
    ds_read_b64_tr_b16 v[180:181], v247 offset:0
    ds_read_b64_tr_b16 v[182:183], v247 offset:512
    s_mov_b32 m0, s71
    v_mfma_f32_32x32x16_bf16 v[16:31], v[84:87], v[184:187], v[16:31]
    buffer_load_dwordx4 v228, s[4:7], s47 offen sc1 lds
    buffer_load_dwordx4 v229, s[72:75], s47 offen offset:1024 sc1 lds
    v_mfma_f32_32x32x16_bf16 v[32:47], v[80:83], v[188:191], v[32:47]
    s_nop 2
    v_mul_f32 v242, v0, v144
    v_fma_f32 v240, v8, v160, -v240
    v_fmac_f32 v242, v1, v145
    v_fmac_f32 v240, v9, v161
    v_fmac_f32 v242, v2, v146
    v_fmac_f32 v240, v10, v162
    v_fmac_f32 v242, v3, v147
    v_mfma_f32_32x32x16_bf16 v[48:63], v[84:87], v[188:191], v[48:63]
    s_setprio 0
    v_fmac_f32 v240, v11, v163
    v_fmac_f32 v242, v4, v148
    v_fmac_f32 v240, v12, v164
    v_fmac_f32 v242, v5, v149
    v_fmac_f32 v240, v13, v165
    v_fmac_f32 v242, v6, v150
    v_fmac_f32 v240, v14, v166
    v_fmac_f32 v242, v7, v151
    v_fmac_f32 v240, v15, v167
    v_add_u32 v249, s26, v249
    v_add_u32 v250, s26, v250
    v_fma_f32 v244, v16, v160, -v244
    v_fmac_f32 v236, v24, v112
    v_fmac_f32 v244, v17, v161
    v_fmac_f32 v236, v25, v113
    v_fmac_f32 v244, v18, v162
    v_fmac_f32 v236, v26, v114
    v_fmac_f32 v244, v19, v163
    v_fmac_f32 v236, v27, v115
    v_fmac_f32 v244, v20, v164
    v_fmac_f32 v236, v28, v116
    v_fmac_f32 v244, v21, v165
    v_fmac_f32 v236, v29, v117
    v_fmac_f32 v244, v22, v166
    v_fmac_f32 v236, v30, v118
    v_fmac_f32 v244, v23, v167
    v_fmac_f32 v236, v31, v119
    ds_read_b64_tr_b16 v[0:1], v249 offset:0
    ds_read_b64_tr_b16 v[2:3], v249 offset:256
    ds_read_u16_d16_hi v16, v250 offset:0
    v_mul_f32 v243, v32, v152
    v_fma_f32 v241, v40, v168, -v241
    v_fmac_f32 v243, v33, v153
    v_fmac_f32 v241, v41, v169
    v_fmac_f32 v243, v34, v154
    v_fmac_f32 v241, v42, v170
    v_fmac_f32 v243, v35, v155
    v_fmac_f32 v241, v43, v171
    v_fmac_f32 v243, v36, v156
    v_fmac_f32 v241, v44, v172
    v_fmac_f32 v243, v37, v157
    v_fmac_f32 v241, v45, v173
    v_fmac_f32 v243, v38, v158
    v_fmac_f32 v241, v46, v174
    v_fmac_f32 v243, v39, v159
    v_fmac_f32 v241, v47, v175
    ds_read_b64_tr_b16 v[4:5], v249 offset:512
    ds_read_b64_tr_b16 v[6:7], v249 offset:768
    ds_read_u16_d16_hi v17, v250 offset:32
    v_fma_f32 v245, v48, v168, -v245
    v_fmac_f32 v237, v56, v120
    v_fmac_f32 v245, v49, v169
    v_fmac_f32 v237, v57, v121
    v_fmac_f32 v245, v50, v170
    v_fmac_f32 v237, v58, v122
    v_fmac_f32 v245, v51, v171
    v_fmac_f32 v237, v59, v123
    v_fmac_f32 v245, v52, v172
    v_fmac_f32 v237, v60, v124
    v_fmac_f32 v245, v53, v173
    v_fmac_f32 v237, v61, v125
    v_fmac_f32 v245, v54, v174
    v_fmac_f32 v237, v62, v126
    v_fmac_f32 v245, v55, v175
    v_fmac_f32 v237, v63, v127
    s_cmp_eq_u32 s56, 2
    s_cbranch_scc1 K2_U20
    s_cmp_eq_u32 s56, 3
    s_cbranch_scc1 K2_U30
    s_branch K2_DSP0
K2_PAD_U21:
    s_branch K2_HOP
K2_U21:
    s_setprio 1
    s_waitcnt lgkmcnt(0)
    v_lshlrev_b32 v20, 16, v0
    v_and_b32 v21, 0xffff0000, v0
    v_lshlrev_b32 v22, 16, v1
    v_and_b32 v23, 0xffff0000, v1
    v_lshlrev_b32 v24, 16, v2
    v_and_b32 v25, 0xffff0000, v2
    v_lshlrev_b32 v26, 16, v3
    v_and_b32 v27, 0xffff0000, v3
    v_mul_f32_dpp v36, v16, v20 row_newbcast:8 row_mask:0xf bank_mask:0xf
    v_mul_f32_dpp v37, v16, v21 row_newbcast:9 row_mask:0xf bank_mask:0xf
    v_mul_f32_dpp v38, v16, v22 row_newbcast:10 row_mask:0xf bank_mask:0xf
    v_mul_f32_dpp v39, v16, v23 row_newbcast:11 row_mask:0xf bank_mask:0xf
    v_mul_f32_dpp v40, v16, v24 row_newbcast:12 row_mask:0xf bank_mask:0xf
    v_mul_f32_dpp v41, v16, v25 row_newbcast:13 row_mask:0xf bank_mask:0xf
    v_mul_f32_dpp v42, v16, v26 row_newbcast:14 row_mask:0xf bank_mask:0xf
    v_mul_f32_dpp v43, v16, v27 row_newbcast:15 row_mask:0xf bank_mask:0xf
    v_cvt_pk_bf16_f32 v68, v36, v37
    v_cvt_pk_bf16_f32 v69, v38, v39
    v_cvt_pk_bf16_f32 v70, v40, v41
    v_cvt_pk_bf16_f32 v71, v42, v43
    v_mul_f32_dpp v20, v16, v20 row_newbcast:0 row_mask:0xa bank_mask:0xf
    v_mul_f32_dpp v21, v16, v21 row_newbcast:1 row_mask:0xa bank_mask:0xf
    v_mul_f32_dpp v22, v16, v22 row_newbcast:2 row_mask:0xa bank_mask:0xf
    v_mul_f32_dpp v23, v16, v23 row_newbcast:3 row_mask:0xa bank_mask:0xf
    v_mul_f32_dpp v24, v16, v24 row_newbcast:4 row_mask:0xa bank_mask:0xf
    v_mul_f32_dpp v25, v16, v25 row_newbcast:5 row_mask:0xa bank_mask:0xf
    v_mul_f32_dpp v26, v16, v26 row_newbcast:6 row_mask:0xa bank_mask:0xf
    v_mul_f32_dpp v27, v16, v27 row_newbcast:7 row_mask:0xa bank_mask:0xf
    v_cvt_pk_bf16_f32 v64, v20, v21
    v_cvt_pk_bf16_f32 v65, v22, v23
    v_cvt_pk_bf16_f32 v66, v24, v25
    v_cvt_pk_bf16_f32 v67, v26, v27
    v_lshlrev_b32 v28, 16, v4
    v_and_b32 v29, 0xffff0000, v4
    v_lshlrev_b32 v30, 16, v5
    v_and_b32 v31, 0xffff0000, v5
    v_lshlrev_b32 v32, 16, v6
    v_and_b32 v33, 0xffff0000, v6
    v_lshlrev_b32 v34, 16, v7
    v_and_b32 v35, 0xffff0000, v7
    v_mul_f32_dpp v36, v17, v28 row_newbcast:8 row_mask:0xf bank_mask:0xf
    v_mul_f32_dpp v37, v17, v29 row_newbcast:9 row_mask:0xf bank_mask:0xf
    v_mul_f32_dpp v38, v17, v30 row_newbcast:10 row_mask:0xf bank_mask:0xf
    v_mul_f32_dpp v39, v17, v31 row_newbcast:11 row_mask:0xf bank_mask:0xf
    v_mul_f32_dpp v40, v17, v32 row_newbcast:12 row_mask:0xf bank_mask:0xf
    v_mul_f32_dpp v41, v17, v33 row_newbcast:13 row_mask:0xf bank_mask:0xf
    v_mul_f32_dpp v42, v17, v34 row_newbcast:14 row_mask:0xf bank_mask:0xf
    v_mul_f32_dpp v43, v17, v35 row_newbcast:15 row_mask:0xf bank_mask:0xf
    v_cvt_pk_bf16_f32 v76, v36, v37
    v_cvt_pk_bf16_f32 v77, v38, v39
    v_cvt_pk_bf16_f32 v78, v40, v41
    v_cvt_pk_bf16_f32 v79, v42, v43
    v_mul_f32_dpp v28, v17, v28 row_newbcast:0 row_mask:0xa bank_mask:0xf
    v_mul_f32_dpp v29, v17, v29 row_newbcast:1 row_mask:0xa bank_mask:0xf
    v_mul_f32_dpp v30, v17, v30 row_newbcast:2 row_mask:0xa bank_mask:0xf
    v_mul_f32_dpp v31, v17, v31 row_newbcast:3 row_mask:0xa bank_mask:0xf
    v_mul_f32_dpp v32, v17, v32 row_newbcast:4 row_mask:0xa bank_mask:0xf
    v_mul_f32_dpp v33, v17, v33 row_newbcast:5 row_mask:0xa bank_mask:0xf
    v_mul_f32_dpp v34, v17, v34 row_newbcast:6 row_mask:0xa bank_mask:0xf
    v_mul_f32_dpp v35, v17, v35 row_newbcast:7 row_mask:0xa bank_mask:0xf
    v_cvt_pk_bf16_f32 v72, v28, v29
    v_cvt_pk_bf16_f32 v73, v30, v31
    v_cvt_pk_bf16_f32 v74, v32, v33
    v_cvt_pk_bf16_f32 v75, v34, v35
    s_waitcnt vmcnt(4)
    v_mfma_f32_32x32x16_bf16 v[0:15], v[64:67], v[176:179], 0
    ds_read_b64_tr_b16 v[184:185], v246 offset:2048
    ds_read_b64_tr_b16 v[186:187], v246 offset:2560
    ds_read_b64_tr_b16 v[188:189], v247 offset:2048
    ds_read_b64_tr_b16 v[190:191], v247 offset:2560
    s_mov_b32 m0, s68
    v_mfma_f32_32x32x16_bf16 v[16:31], v[68:71], v[176:179], 0
    buffer_load_dwordx4 v222, s[4:7], s42 offen sc1 lds
    buffer_load_dwordx4 v223, s[72:75], s42 offen offset:1024 sc1 lds
    v_permlane32_swap_b32 v242, v236
    v_permlane32_swap_b32 v243, v237
    v_mov_b32 v254, 163296
    v_mfma_f32_32x32x16_bf16 v[32:47], v[64:67], v[180:183], 0
    v_permlane32_swap_b32 v244, v238
    v_permlane32_swap_b32 v245, v239
    v_permlane32_swap_b32 v240, v241
    v_add_f32 v242, v242, v236
    v_mfma_f32_32x32x16_bf16 v[48:63], v[68:71], v[180:183], 0
    v_add_f32 v243, v243, v237
    v_add_f32 v244, v244, v238
    v_add_f32 v245, v245, v239
    v_add_f32 v240, -v240, -v241
    v_sub_u32 v241, v230, v231
    v_cvt_pk_bf16_f32 v242, v242, v243
    v_mov_b32 v255, 1
    v_lshl_add_u32 v233, v252, 1, s53
    s_mov_b64 exec, 1
    ds_add_rtn_u32 v232, v254, v255
    s_mov_b64 exec, -1
    ds_read_b32 v233, v233
    s_waitcnt vmcnt(4) lgkmcnt(2)
    v_mfma_f32_32x32x16_bf16 v[0:15], v[72:75], v[184:187], v[0:15]
    ds_read_b64_tr_b16 v[176:177], v246 offset:4096
    ds_read_b64_tr_b16 v[178:179], v246 offset:4608
    ds_read_b64_tr_b16 v[180:181], v247 offset:4096
    ds_read_b64_tr_b16 v[182:183], v247 offset:4608
    v_cvt_pk_bf16_f32 v244, v244, v245
    v_cvt_pk_bf16_f32 v240, v240, v240
    s_mov_b32 m0, s69
    v_mfma_f32_32x32x16_bf16 v[16:31], v[76:79], v[184:187], v[16:31]
    buffer_load_dwordx4 v224, s[4:7], s42 offen sc1 lds
    buffer_load_dwordx4 v225, s[72:75], s42 offen offset:1024 sc1 lds
    ds_write_b32 v230, v242 offset:768
    ds_write_b32 v230, v244 offset:1024
    ds_write_b16 v241, v240 offset:1280
    s_waitcnt lgkmcnt(7)
    v_readfirstlane_b32 s58, v232
    v_mfma_f32_32x32x16_bf16 v[32:47], v[72:75], v[188:191], v[32:47]
    s_cmp_lt_u32 s58, s22
    s_cbranch_scc0 K2_nul_34
    s_and_b32 s59, s58, 7
    s_lshr_b32 s60, s58, 3
K2_chk_36:
    v_readlane_b32 s61, v233, s59
    s_nop 0
    s_cmp_gt_u32 s61, s60
    s_cbranch_scc0 K2_spin_35
K2_back_37:
    v_mfma_f32_32x32x16_bf16 v[48:63], v[76:79], v[188:191], v[48:63]
    s_setprio 0
    v_readlane_b32 s3, v253, s58
    s_lshl_b32 s44, s34, 7
    s_and_b32 s48, s3, 0x3ffff
    s_bfe_u32 s33, s3, 0x30012
    s_mov_b32 s35, s48
    s_mov_b32 s45, s44
    v_mul_f32 v234, v0, v96
    v_mul_f32 v236, v8, v128
    v_fmac_f32 v234, v1, v97
    v_fmac_f32 v236, v9, v129
    v_fmac_f32 v234, v2, v98
    v_fmac_f32 v236, v10, v130
    v_fmac_f32 v234, v3, v99
    v_fmac_f32 v236, v11, v131
    v_fmac_f32 v234, v4, v100
    v_fmac_f32 v236, v12, v132
    v_fmac_f32 v234, v5, v101
    v_fmac_f32 v236, v13, v133
    v_fmac_f32 v234, v6, v102
    v_fmac_f32 v236, v14, v134
    v_fmac_f32 v234, v7, v103
    v_fmac_f32 v236, v15, v135
    v_mul_f32 v238, v16, v128
    v_mul_f32 v240, v24, v128
    v_fmac_f32 v238, v17, v129
    v_fmac_f32 v240, v25, v129
    v_fmac_f32 v238, v18, v130
    v_fmac_f32 v240, v26, v130
    v_fmac_f32 v238, v19, v131
    v_fmac_f32 v240, v27, v131
    v_fmac_f32 v238, v20, v132
    v_fmac_f32 v240, v28, v132
    v_fmac_f32 v238, v21, v133
    v_fmac_f32 v240, v29, v133
    v_fmac_f32 v238, v22, v134
    v_fmac_f32 v240, v30, v134
    v_fmac_f32 v238, v23, v135
    v_fmac_f32 v240, v31, v135
    v_mul_f32 v235, v32, v104
    v_mul_f32 v237, v40, v136
    v_fmac_f32 v235, v33, v105
    v_fmac_f32 v237, v41, v137
    v_fmac_f32 v235, v34, v106
    v_fmac_f32 v237, v42, v138
    v_fmac_f32 v235, v35, v107
    v_fmac_f32 v237, v43, v139
    v_fmac_f32 v235, v36, v108
    v_fmac_f32 v237, v44, v140
    v_fmac_f32 v235, v37, v109
    v_fmac_f32 v237, v45, v141
    v_fmac_f32 v235, v38, v110
    v_fmac_f32 v237, v46, v142
    v_fmac_f32 v235, v39, v111
    v_fmac_f32 v237, v47, v143
    v_mul_f32 v239, v48, v136
    v_mul_f32 v241, v56, v136
    v_fmac_f32 v239, v49, v137
    v_fmac_f32 v241, v57, v137
    s_setprio 1
    s_waitcnt vmcnt(4) lgkmcnt(3)
    v_mfma_f32_32x32x16_bf16 v[0:15], v[64:67], v[176:179], 0
    ds_read_b64_tr_b16 v[184:185], v246 offset:6144
    ds_read_b64_tr_b16 v[186:187], v246 offset:6656
    ds_read_b64_tr_b16 v[188:189], v247 offset:6144
    ds_read_b64_tr_b16 v[190:191], v247 offset:6656
    v_fmac_f32 v239, v50, v138
    v_fmac_f32 v241, v58, v138
    s_mov_b32 m0, s70
    v_mfma_f32_32x32x16_bf16 v[16:31], v[68:71], v[176:179], 0
    buffer_load_dwordx4 v222, s[4:7], s43 offen sc1 lds
    buffer_load_dwordx4 v223, s[72:75], s43 offen offset:1024 sc1 lds
    v_fmac_f32 v239, v51, v139
    v_fmac_f32 v241, v59, v139
    v_fmac_f32 v239, v52, v140
    v_fmac_f32 v241, v60, v140
    v_fmac_f32 v239, v53, v141
    v_mfma_f32_32x32x16_bf16 v[32:47], v[64:67], v[180:183], 0
    s_add_u32 s47, s44, 256
    s_add_u32 s49, s48, 32
    s_add_u32 s60, s48, 64
    s_cmp_eq_u32 s33, 3
    s_cselect_b32 s46, s44, s47
    s_cselect_b32 s50, s60, s48
    s_cselect_b32 s51, s48, s49
    s_sub_u32 s60, s33, 2
    s_cmp_lt_u32 s60, 2
    s_cbranch_scc0 K2_rare_38
K2_back_39:
    v_add_u32 v222, s48, v251
    ds_read_b32 v222, v222
    v_fmac_f32 v241, v61, v141
    v_fmac_f32 v239, v54, v142
    v_fmac_f32 v241, v62, v142
    v_fmac_f32 v239, v55, v143
    v_fmac_f32 v241, v63, v143
    v_mfma_f32_32x32x16_bf16 v[48:63], v[68:71], v[180:183], 0
    v_permlane32_swap_b32 v234, v236
    v_permlane32_swap_b32 v235, v237
    v_permlane32_swap_b32 v240, v238
    s_waitcnt vmcnt(4) lgkmcnt(1)
    v_mfma_f32_32x32x16_bf16 v[0:15], v[72:75], v[184:187], v[0:15]
    ds_read_b64_tr_b16 v[176:177], v246 offset:0
    ds_read_b64_tr_b16 v[178:179], v246 offset:512
    ds_read_b64_tr_b16 v[180:181], v247 offset:0
    ds_read_b64_tr_b16 v[182:183], v247 offset:512
    v_permlane32_swap_b32 v241, v239
    s_mov_b32 m0, s71
    v_mfma_f32_32x32x16_bf16 v[16:31], v[76:79], v[184:187], v[16:31]
    buffer_load_dwordx4 v224, s[4:7], s43 offen sc1 lds
    buffer_load_dwordx4 v225, s[72:75], s43 offen offset:1024 sc1 lds
    s_waitcnt lgkmcnt(4)
    v_mad_u32_u16 v223, v222, s39, v248 op_sel:[1,0,0,0]
    v_mad_u32_u16 v222, v222, s39, v248
    v_lshl_add_u32 v230, v252, 1, s31
    v_add_f32 v234, v234, v236
    v_add_f32 v235, v235, v237
    v_add_f32 v240, v240, v238
    v_add_f32 v241, v241, v239
    v_cvt_pk_bf16_f32 v234, v234, v235
    v_cvt_pk_bf16_f32 v240, v240, v241
    ds_write_b32 v230, v234 offset:0
    ds_write_b32 v230, v240 offset:256
    v_mfma_f32_32x32x16_bf16 v[32:47], v[72:75], v[188:191], v[32:47]
    v_add_u32 v224, s49, v251
    ds_read_b32 v224, v224
    v_mul_f32 v234, v0, v144
    v_mul_f32 v236, v8, v112
    v_fmac_f32 v234, v1, v145
    v_fmac_f32 v236, v9, v113
    v_fmac_f32 v234, v2, v146
    v_mfma_f32_32x32x16_bf16 v[48:63], v[76:79], v[188:191], v[48:63]
    s_setprio 0
    v_fmac_f32 v236, v10, v114
    v_fmac_f32 v234, v3, v147
    v_fmac_f32 v236, v11, v115
    v_fmac_f32 v234, v4, v148
    v_fmac_f32 v236, v12, v116
    v_fmac_f32 v234, v5, v149
    v_fmac_f32 v236, v13, v117
    v_fmac_f32 v234, v6, v150
    v_fmac_f32 v236, v14, v118
    v_fmac_f32 v234, v7, v151
    v_fmac_f32 v236, v15, v119
    v_mul_f32 v238, v16, v160
    v_mul_f32 v240, v24, v160
    v_fmac_f32 v238, v17, v161
    v_fmac_f32 v240, v25, v161
    v_fmac_f32 v238, v18, v162
    v_fmac_f32 v240, v26, v162
    v_fmac_f32 v238, v19, v163
    v_fmac_f32 v240, v27, v163
    v_fmac_f32 v238, v20, v164
    v_fmac_f32 v240, v28, v164
    v_fmac_f32 v238, v21, v165
    v_fmac_f32 v240, v29, v165
    v_fmac_f32 v238, v22, v166
    v_fmac_f32 v240, v30, v166
    v_fmac_f32 v238, v23, v167
    v_fmac_f32 v240, v31, v167
    v_mul_f32 v235, v32, v152
    v_mul_f32 v237, v40, v120
    v_fmac_f32 v235, v33, v153
    v_fmac_f32 v237, v41, v121
    v_fmac_f32 v235, v34, v154
    v_fmac_f32 v237, v42, v122
    v_fmac_f32 v235, v35, v155
    v_fmac_f32 v237, v43, v123
    v_fmac_f32 v235, v36, v156
    v_fmac_f32 v237, v44, v124
    v_fmac_f32 v235, v37, v157
    v_fmac_f32 v237, v45, v125
    v_fmac_f32 v235, v38, v158
    v_fmac_f32 v237, v46, v126
    v_fmac_f32 v235, v39, v159
    v_fmac_f32 v237, v47, v127
    v_mul_f32 v239, v48, v168
    v_mul_f32 v241, v56, v168
    v_fmac_f32 v239, v49, v169
    v_fmac_f32 v241, v57, v169
    v_fmac_f32 v239, v50, v170
    v_fmac_f32 v241, v58, v170
    v_fmac_f32 v239, v51, v171
    s_setprio 1
    s_waitcnt vmcnt(4) lgkmcnt(3)
    v_mfma_f32_32x32x16_bf16 v[0:15], v[64:67], v[176:179], 0
    ds_read_b64_tr_b16 v[184:185], v246 offset:2048
    ds_read_b64_tr_b16 v[186:187], v246 offset:2560
    ds_read_b64_tr_b16 v[188:189], v247 offset:2048
    ds_read_b64_tr_b16 v[190:191], v247 offset:2560
    v_fmac_f32 v241, v59, v171
    v_fmac_f32 v239, v52, v172
    s_mov_b32 m0, s68
    v_mfma_f32_32x32x16_bf16 v[16:31], v[68:71], v[176:179], 0
    buffer_load_dwordx4 v222, s[4:7], s44 offen sc1 lds
    buffer_load_dwordx4 v223, s[72:75], s44 offen offset:1024 sc1 lds
    s_waitcnt lgkmcnt(4)
    v_mad_u32_u16 v225, v224, s39, v248 op_sel:[1,0,0,0]
    v_mad_u32_u16 v224, v224, s39, v248
    v_fmac_f32 v241, v60, v172
    v_fmac_f32 v239, v53, v173
    v_mfma_f32_32x32x16_bf16 v[32:47], v[64:67], v[180:183], 0
    v_add_u32 v226, s50, v251
    ds_read_b32 v226, v226
    v_fmac_f32 v241, v61, v173
    v_fmac_f32 v239, v54, v174
    v_fmac_f32 v241, v62, v174
    v_fmac_f32 v239, v55, v175
    v_fmac_f32 v241, v63, v175
    v_mfma_f32_32x32x16_bf16 v[48:63], v[68:71], v[180:183], 0
    s_waitcnt vmcnt(4) lgkmcnt(1)
    v_mfma_f32_32x32x16_bf16 v[0:15], v[72:75], v[184:187], v[0:15]
    ds_read_b64_tr_b16 v[176:177], v246 offset:4096
    ds_read_b64_tr_b16 v[178:179], v246 offset:4608
    ds_read_b64_tr_b16 v[180:181], v247 offset:4096
    ds_read_b64_tr_b16 v[182:183], v247 offset:4608
    s_mov_b32 m0, s69
    v_mfma_f32_32x32x16_bf16 v[16:31], v[76:79], v[184:187], v[16:31]
    buffer_load_dwordx4 v224, s[4:7], s45 offen sc1 lds
    buffer_load_dwordx4 v225, s[72:75], s45 offen offset:1024 sc1 lds
    s_waitcnt lgkmcnt(4)
    v_mad_u32_u16 v227, v226, s39, v248 op_sel:[1,0,0,0]
    v_mad_u32_u16 v226, v226, s39, v248
    v_mfma_f32_32x32x16_bf16 v[32:47], v[72:75], v[188:191], v[32:47]
    v_add_u32 v228, s51, v251
    ds_read_b32 v228, v228
    v_mul_f32 v242, v0, v144
    v_fma_f32 v238, v8, v160, -v238
    v_fmac_f32 v242, v1, v145
    v_fmac_f32 v238, v9, v161
    v_fmac_f32 v242, v2, v146
    v_mfma_f32_32x32x16_bf16 v[48:63], v[76:79], v[188:191], v[48:63]
    s_setprio 0
    v_fmac_f32 v238, v10, v162
    v_fmac_f32 v242, v3, v147
    v_fmac_f32 v238, v11, v163
    v_fmac_f32 v242, v4, v148
    v_fmac_f32 v238, v12, v164
    v_fmac_f32 v242, v5, v149
    v_fmac_f32 v238, v13, v165
    v_fmac_f32 v242, v6, v150
    v_fmac_f32 v238, v14, v166
    v_fmac_f32 v242, v7, v151
    v_fmac_f32 v238, v15, v167
    v_fmac_f32 v236, v16, v112
    v_mul_f32 v244, v24, v160
    v_fmac_f32 v236, v17, v113
    v_fmac_f32 v244, v25, v161
    v_fmac_f32 v236, v18, v114
    v_fmac_f32 v244, v26, v162
    v_fmac_f32 v236, v19, v115
    v_fmac_f32 v244, v27, v163
    v_fmac_f32 v236, v20, v116
    v_fmac_f32 v244, v28, v164
    v_fmac_f32 v236, v21, v117
    v_fmac_f32 v244, v29, v165
    v_fmac_f32 v236, v22, v118
    v_fmac_f32 v244, v30, v166
    v_fmac_f32 v236, v23, v119
    v_fmac_f32 v244, v31, v167
    v_mul_f32 v243, v32, v152
    v_fma_f32 v239, v40, v168, -v239
    v_fmac_f32 v243, v33, v153
    v_fmac_f32 v239, v41, v169
    v_fmac_f32 v243, v34, v154
    v_fmac_f32 v239, v42, v170
    v_fmac_f32 v243, v35, v155
    v_fmac_f32 v239, v43, v171
    v_fmac_f32 v243, v36, v156
    v_fmac_f32 v239, v44, v172
    v_fmac_f32 v243, v37, v157
    v_fmac_f32 v239, v45, v173
    v_fmac_f32 v243, v38, v158
    v_fmac_f32 v239, v46, v174
    v_fmac_f32 v243, v39, v159
    v_fmac_f32 v239, v47, v175
    v_fmac_f32 v237, v48, v120
    v_mul_f32 v245, v56, v168
    v_fmac_f32 v237, v49, v121
    v_fmac_f32 v245, v57, v169
    v_fmac_f32 v237, v50, v122
    s_setprio 1
    s_waitcnt vmcnt(4) lgkmcnt(1)
    v_mfma_f32_32x32x16_bf16 v[0:15], v[64:67], v[176:179], 0
    ds_read_b64_tr_b16 v[184:185], v246 offset:6144
    ds_read_b64_tr_b16 v[186:187], v246 offset:6656
    ds_read_b64_tr_b16 v[188:189], v247 offset:6144
    ds_read_b64_tr_b16 v[190:191], v247 offset:6656
    v_fmac_f32 v245, v58, v170
    v_fmac_f32 v237, v51, v123
    s_mov_b32 m0, s70
    v_mfma_f32_32x32x16_bf16 v[16:31], v[68:71], v[176:179], 0
    buffer_load_dwordx4 v226, s[4:7], s46 offen sc1 lds
    buffer_load_dwordx4 v227, s[72:75], s46 offen offset:1024 sc1 lds
    s_waitcnt lgkmcnt(4)
    v_mad_u32_u16 v229, v228, s39, v248 op_sel:[1,0,0,0]
    v_mad_u32_u16 v228, v228, s39, v248
    v_fmac_f32 v245, v59, v171
    v_fmac_f32 v237, v52, v124
    v_mfma_f32_32x32x16_bf16 v[32:47], v[64:67], v[180:183], 0
    v_fmac_f32 v245, v60, v172
    v_fmac_f32 v237, v53, v125
    v_fmac_f32 v245, v61, v173
    v_fmac_f32 v237, v54, v126
    v_fmac_f32 v245, v62, v174
    v_fmac_f32 v237, v55, v127
    v_fmac_f32 v245, v63, v175
    v_mfma_f32_32x32x16_bf16 v[48:63], v[68:71], v[180:183], 0
    v_permlane32_swap_b32 v242, v234
    v_permlane32_swap_b32 v243, v235
    v_add_f32 v242, v242, v234
    v_add_f32 v243, v243, v235
    s_waitcnt vmcnt(4) lgkmcnt(0)
    v_mfma_f32_32x32x16_bf16 v[0:15], v[72:75], v[184:187], v[0:15]
    ds_read_b64_tr_b16 v[176:177], v246 offset:0
    ds_read_b64_tr_b16 v[178:179], v246 offset:512
    ds_read_b64_tr_b16 v[180:181], v247 offset:0
    ds_read_b64_tr_b16 v[182:183], v247 offset:512
    v_cvt_pk_bf16_f32 v242, v242, v243
    ds_write_b32 v230, v242 offset:512
    s_mov_b32 m0, s71
    v_mfma_f32_32x32x16_bf16 v[16:31], v[76:79], v[184:187], v[16:31]
    buffer_load_dwordx4 v228, s[4:7], s47 offen sc1 lds
    buffer_load_dwordx4 v229, s[72:75], s47 offen offset:1024 sc1 lds
    s_sub_u32 s26, s48, s29
    s_mov_b32 s29, s48
    s_mov_b32 s30, s3
    s_cmp_lg_u32 s36, 0
    s_cselect_b32 s56, s33, 0
    v_mfma_f32_32x32x16_bf16 v[32:47], v[72:75], v[188:191], v[32:47]
    s_mov_b32 s32, s31
    s_mov_b32 s31, s35
    v_mul_f32 v242, v0, v144
    v_fma_f32 v240, v8, v160, -v240
    v_fmac_f32 v242, v1, v145
    v_fmac_f32 v240, v9, v161
    v_fmac_f32 v242, v2, v146
    v_mfma_f32_32x32x16_bf16 v[48:63], v[76:79], v[188:191], v[48:63]
    s_setprio 0
    v_fmac_f32 v240, v10, v162
    v_fmac_f32 v242, v3, v147
    v_fmac_f32 v240, v11, v163
    v_fmac_f32 v242, v4, v148
    v_fmac_f32 v240, v12, v164
    v_fmac_f32 v242, v5, v149
    v_fmac_f32 v240, v13, v165
    v_fmac_f32 v242, v6, v150
    v_fmac_f32 v240, v14, v166
    v_fmac_f32 v242, v7, v151
    v_fmac_f32 v240, v15, v167
    v_add_u32 v249, s26, v249
    v_add_u32 v250, s26, v250
    v_fma_f32 v244, v16, v160, -v244
    v_fmac_f32 v236, v24, v112
    v_fmac_f32 v244, v17, v161
    v_fmac_f32 v236, v25, v113
    v_fmac_f32 v244, v18, v162
    v_fmac_f32 v236, v26, v114
    v_fmac_f32 v244, v19, v163
    v_fmac_f32 v236, v27, v115
    v_fmac_f32 v244, v20, v164
    v_fmac_f32 v236, v28, v116
    v_fmac_f32 v244, v21, v165
    v_fmac_f32 v236, v29, v117
    v_fmac_f32 v244, v22, v166
    v_fmac_f32 v236, v30, v118
    v_fmac_f32 v244, v23, v167
    v_fmac_f32 v236, v31, v119
    ds_read_b64_tr_b16 v[0:1], v249 offset:0
    ds_read_b64_tr_b16 v[2:3], v249 offset:256
    ds_read_u16_d16_hi v16, v250 offset:0
    v_mul_f32 v243, v32, v152
    v_fma_f32 v241, v40, v168, -v241
    v_fmac_f32 v243, v33, v153
    v_fmac_f32 v241, v41, v169
    v_fmac_f32 v243, v34, v154
    v_fmac_f32 v241, v42, v170
    v_fmac_f32 v243, v35, v155
    v_fmac_f32 v241, v43, v171
    v_fmac_f32 v243, v36, v156
    v_fmac_f32 v241, v44, v172
    v_fmac_f32 v243, v37, v157
    v_fmac_f32 v241, v45, v173
    v_fmac_f32 v243, v38, v158
    v_fmac_f32 v241, v46, v174
    v_fmac_f32 v243, v39, v159
    v_fmac_f32 v241, v47, v175
    ds_read_b64_tr_b16 v[4:5], v249 offset:512
    ds_read_b64_tr_b16 v[6:7], v249 offset:768
    ds_read_u16_d16_hi v17, v250 offset:32
    v_fma_f32 v245, v48, v168, -v245
    v_fmac_f32 v237, v56, v120
    v_fmac_f32 v245, v49, v169
    v_fmac_f32 v237, v57, v121
    v_fmac_f32 v245, v50, v170
    v_fmac_f32 v237, v58, v122
    v_fmac_f32 v245, v51, v171
    v_fmac_f32 v237, v59, v123
    v_fmac_f32 v245, v52, v172
    v_fmac_f32 v237, v60, v124
    v_fmac_f32 v245, v53, v173
    v_fmac_f32 v237, v61, v125
    v_fmac_f32 v245, v54, v174
    v_fmac_f32 v237, v62, v126
    v_fmac_f32 v245, v55, v175
    v_fmac_f32 v237, v63, v127
    s_cmp_eq_u32 s56, 2
    s_cbranch_scc1 K2_U21
    s_cmp_eq_u32 s56, 3
    s_cbranch_scc1 K2_U31
    s_branch K2_DSP1
K2_PAD_U31:
    s_branch K2_HOP
K2_U31:
    s_setprio 1
    ds_read_b64_tr_b16 v[8:9], v249 offset:1024
    ds_read_b64_tr_b16 v[10:11], v249 offset:1280
    ds_read_u16_d16_hi v18, v250 offset:64
    s_waitcnt lgkmcnt(3)
    v_lshlrev_b32 v20, 16, v0
    v_and_b32 v21, 0xffff0000, v0
    v_lshlrev_b32 v22, 16, v1
    v_and_b32 v23, 0xffff0000, v1
    v_lshlrev_b32 v24, 16, v2
    v_and_b32 v25, 0xffff0000, v2
    v_lshlrev_b32 v26, 16, v3
    v_and_b32 v27, 0xffff0000, v3
    v_mul_f32_dpp v36, v16, v20 row_newbcast:8 row_mask:0xf bank_mask:0xf
    v_mul_f32_dpp v37, v16, v21 row_newbcast:9 row_mask:0xf bank_mask:0xf
    v_mul_f32_dpp v38, v16, v22 row_newbcast:10 row_mask:0xf bank_mask:0xf
    v_mul_f32_dpp v39, v16, v23 row_newbcast:11 row_mask:0xf bank_mask:0xf
    v_mul_f32_dpp v40, v16, v24 row_newbcast:12 row_mask:0xf bank_mask:0xf
    v_mul_f32_dpp v41, v16, v25 row_newbcast:13 row_mask:0xf bank_mask:0xf
    v_mul_f32_dpp v42, v16, v26 row_newbcast:14 row_mask:0xf bank_mask:0xf
    v_mul_f32_dpp v43, v16, v27 row_newbcast:15 row_mask:0xf bank_mask:0xf
    v_cvt_pk_bf16_f32 v68, v36, v37
    v_cvt_pk_bf16_f32 v69, v38, v39
    v_cvt_pk_bf16_f32 v70, v40, v41
    v_cvt_pk_bf16_f32 v71, v42, v43
    v_mul_f32_dpp v20, v16, v20 row_newbcast:0 row_mask:0xa bank_mask:0xf
    v_mul_f32_dpp v21, v16, v21 row_newbcast:1 row_mask:0xa bank_mask:0xf
    v_mul_f32_dpp v22, v16, v22 row_newbcast:2 row_mask:0xa bank_mask:0xf
    v_mul_f32_dpp v23, v16, v23 row_newbcast:3 row_mask:0xa bank_mask:0xf
    v_mul_f32_dpp v24, v16, v24 row_newbcast:4 row_mask:0xa bank_mask:0xf
    v_mul_f32_dpp v25, v16, v25 row_newbcast:5 row_mask:0xa bank_mask:0xf
    v_mul_f32_dpp v26, v16, v26 row_newbcast:6 row_mask:0xa bank_mask:0xf
    v_mul_f32_dpp v27, v16, v27 row_newbcast:7 row_mask:0xa bank_mask:0xf
    v_cvt_pk_bf16_f32 v64, v20, v21
    v_cvt_pk_bf16_f32 v65, v22, v23
    v_cvt_pk_bf16_f32 v66, v24, v25
    v_cvt_pk_bf16_f32 v67, v26, v27
    v_lshlrev_b32 v28, 16, v4
    v_and_b32 v29, 0xffff0000, v4
    v_lshlrev_b32 v30, 16, v5
    v_and_b32 v31, 0xffff0000, v5
    v_lshlrev_b32 v32, 16, v6
    v_and_b32 v33, 0xffff0000, v6
    v_lshlrev_b32 v34, 16, v7
    v_and_b32 v35, 0xffff0000, v7
    v_mul_f32_dpp v36, v17, v28 row_newbcast:8 row_mask:0xf bank_mask:0xf
    v_mul_f32_dpp v37, v17, v29 row_newbcast:9 row_mask:0xf bank_mask:0xf
    v_mul_f32_dpp v38, v17, v30 row_newbcast:10 row_mask:0xf bank_mask:0xf
    v_mul_f32_dpp v39, v17, v31 row_newbcast:11 row_mask:0xf bank_mask:0xf
    v_mul_f32_dpp v40, v17, v32 row_newbcast:12 row_mask:0xf bank_mask:0xf
    v_mul_f32_dpp v41, v17, v33 row_newbcast:13 row_mask:0xf bank_mask:0xf
    v_mul_f32_dpp v42, v17, v34 row_newbcast:14 row_mask:0xf bank_mask:0xf
    v_mul_f32_dpp v43, v17, v35 row_newbcast:15 row_mask:0xf bank_mask:0xf
    v_cvt_pk_bf16_f32 v76, v36, v37
    v_cvt_pk_bf16_f32 v77, v38, v39
    v_cvt_pk_bf16_f32 v78, v40, v41
    v_cvt_pk_bf16_f32 v79, v42, v43
    v_mul_f32_dpp v28, v17, v28 row_newbcast:0 row_mask:0xa bank_mask:0xf
    v_mul_f32_dpp v29, v17, v29 row_newbcast:1 row_mask:0xa bank_mask:0xf
    v_mul_f32_dpp v30, v17, v30 row_newbcast:2 row_mask:0xa bank_mask:0xf
    v_mul_f32_dpp v31, v17, v31 row_newbcast:3 row_mask:0xa bank_mask:0xf
    v_mul_f32_dpp v32, v17, v32 row_newbcast:4 row_mask:0xa bank_mask:0xf
    v_mul_f32_dpp v33, v17, v33 row_newbcast:5 row_mask:0xa bank_mask:0xf
    v_mul_f32_dpp v34, v17, v34 row_newbcast:6 row_mask:0xa bank_mask:0xf
    v_mul_f32_dpp v35, v17, v35 row_newbcast:7 row_mask:0xa bank_mask:0xf
    v_cvt_pk_bf16_f32 v72, v28, v29
    v_cvt_pk_bf16_f32 v73, v30, v31
    v_cvt_pk_bf16_f32 v74, v32, v33
    v_cvt_pk_bf16_f32 v75, v34, v35
    s_waitcnt lgkmcnt(0)
    v_lshlrev_b32 v20, 16, v8
    v_and_b32 v21, 0xffff0000, v8
    v_lshlrev_b32 v22, 16, v9
    v_and_b32 v23, 0xffff0000, v9
    v_lshlrev_b32 v24, 16, v10
    v_and_b32 v25, 0xffff0000, v10
    v_lshlrev_b32 v26, 16, v11
    v_and_b32 v27, 0xffff0000, v11
    v_mul_f32_dpp v36, v18, v20 row_newbcast:8 row_mask:0xf bank_mask:0xf
    v_mul_f32_dpp v37, v18, v21 row_newbcast:9 row_mask:0xf bank_mask:0xf
    v_mul_f32_dpp v38, v18, v22 row_newbcast:10 row_mask:0xf bank_mask:0xf
    v_mul_f32_dpp v39, v18, v23 row_newbcast:11 row_mask:0xf bank_mask:0xf
    v_mul_f32_dpp v40, v18, v24 row_newbcast:12 row_mask:0xf bank_mask:0xf
    v_mul_f32_dpp v41, v18, v25 row_newbcast:13 row_mask:0xf bank_mask:0xf
    v_mul_f32_dpp v42, v18, v26 row_newbcast:14 row_mask:0xf bank_mask:0xf
    v_mul_f32_dpp v43, v18, v27 row_newbcast:15 row_mask:0xf bank_mask:0xf
    v_cvt_pk_bf16_f32 v84, v36, v37
    v_cvt_pk_bf16_f32 v85, v38, v39
    v_cvt_pk_bf16_f32 v86, v40, v41
    v_cvt_pk_bf16_f32 v87, v42, v43
    v_mul_f32_dpp v20, v18, v20 row_newbcast:0 row_mask:0xa bank_mask:0xf
    v_mul_f32_dpp v21, v18, v21 row_newbcast:1 row_mask:0xa bank_mask:0xf
    v_mul_f32_dpp v22, v18, v22 row_newbcast:2 row_mask:0xa bank_mask:0xf
    v_mul_f32_dpp v23, v18, v23 row_newbcast:3 row_mask:0xa bank_mask:0xf
    v_mul_f32_dpp v24, v18, v24 row_newbcast:4 row_mask:0xa bank_mask:0xf
    v_mul_f32_dpp v25, v18, v25 row_newbcast:5 row_mask:0xa bank_mask:0xf
    v_mul_f32_dpp v26, v18, v26 row_newbcast:6 row_mask:0xa bank_mask:0xf
    v_mul_f32_dpp v27, v18, v27 row_newbcast:7 row_mask:0xa bank_mask:0xf
    v_cvt_pk_bf16_f32 v80, v20, v21
    v_cvt_pk_bf16_f32 v81, v22, v23
    v_cvt_pk_bf16_f32 v82, v24, v25
    v_cvt_pk_bf16_f32 v83, v26, v27
    s_waitcnt vmcnt(4)
    v_mfma_f32_32x32x16_bf16 v[0:15], v[64:67], v[176:179], 0
    ds_read_b64_tr_b16 v[184:185], v246 offset:2048
    ds_read_b64_tr_b16 v[186:187], v246 offset:2560
    ds_read_b64_tr_b16 v[188:189], v247 offset:2048
    ds_read_b64_tr_b16 v[190:191], v247 offset:2560
    s_mov_b32 m0, s68
    v_mfma_f32_32x32x16_bf16 v[16:31], v[68:71], v[176:179], 0
    buffer_load_dwordx4 v224, s[4:7], s41 offen sc1 lds
    buffer_load_dwordx4 v225, s[72:75], s41 offen offset:1024 sc1 lds
    v_permlane32_swap_b32 v242, v236
    v_permlane32_swap_b32 v243, v237
    v_mov_b32 v254, 163296
    v_mfma_f32_32x32x16_bf16 v[32:47], v[64:67], v[180:183], 0
    v_permlane32_swap_b32 v244, v238
    v_permlane32_swap_b32 v245, v239
    v_permlane32_swap_b32 v240, v241
    v_add_f32 v242, v242, v236
    v_mfma_f32_32x32x16_bf16 v[48:63], v[68:71], v[180:183], 0
    v_add_f32 v243, v243, v237
    v_add_f32 v244, v244, v238
    v_add_f32 v245, v245, v239
    v_add_f32 v240, -v240, -v241
    v_sub_u32 v241, v230, v231
    v_cvt_pk_bf16_f32 v242, v242, v243
    v_mov_b32 v255, 1
    v_lshl_add_u32 v233, v252, 1, s53
    s_mov_b64 exec, 1
    ds_add_rtn_u32 v232, v254, v255
    s_mov_b64 exec, -1
    ds_read_b32 v233, v233
    s_waitcnt vmcnt(4) lgkmcnt(2)
    v_mfma_f32_32x32x16_bf16 v[0:15], v[72:75], v[184:187], v[0:15]
    ds_read_b64_tr_b16 v[176:177], v246 offset:4096
    ds_read_b64_tr_b16 v[178:179], v246 offset:4608
    ds_read_b64_tr_b16 v[180:181], v247 offset:4096
    ds_read_b64_tr_b16 v[182:183], v247 offset:4608
    v_cvt_pk_bf16_f32 v244, v244, v245
    v_cvt_pk_bf16_f32 v240, v240, v240
    s_mov_b32 m0, s69
    v_mfma_f32_32x32x16_bf16 v[16:31], v[76:79], v[184:187], v[16:31]
    buffer_load_dwordx4 v226, s[4:7], s41 offen sc1 lds
    buffer_load_dwordx4 v227, s[72:75], s41 offen offset:1024 sc1 lds
    ds_write_b32 v230, v242 offset:768
    ds_write_b32 v230, v244 offset:1024
    ds_write_b16 v241, v240 offset:1280
    s_waitcnt lgkmcnt(7)
    v_readfirstlane_b32 s58, v232
    v_mfma_f32_32x32x16_bf16 v[32:47], v[72:75], v[188:191], v[32:47]
    s_cmp_lt_u32 s58, s22
    s_cbranch_scc0 K2_nul_41
    s_and_b32 s59, s58, 7
    s_lshr_b32 s60, s58, 3
K2_chk_43:
    v_readlane_b32 s61, v233, s59
    s_nop 0
    s_cmp_gt_u32 s61, s60
    s_cbranch_scc0 K2_spin_42
K2_back_44:
    v_mfma_f32_32x32x16_bf16 v[48:63], v[76:79], v[188:191], v[48:63]
    v_readlane_b32 s3, v253, s58
    s_lshl_b32 s44, s34, 7
    s_and_b32 s48, s3, 0x3ffff
    s_bfe_u32 s33, s3, 0x30012
    s_mov_b32 s35, s48
    s_mov_b32 s45, s44
    s_waitcnt vmcnt(4) lgkmcnt(3)
    v_mfma_f32_32x32x16_bf16 v[0:15], v[80:83], v[176:179], v[0:15]
    ds_read_b64_tr_b16 v[184:185], v246 offset:6144
    ds_read_b64_tr_b16 v[186:187], v246 offset:6656
    ds_read_b64_tr_b16 v[188:189], v247 offset:6144
    ds_read_b64_tr_b16 v[190:191], v247 offset:6656
    s_add_u32 s47, s44, 256
    s_add_u32 s49, s48, 32
    s_mov_b32 m0, s70
    v_mfma_f32_32x32x16_bf16 v[16:31], v[84:87], v[176:179], v[16:31]
    buffer_load_dwordx4 v222, s[4:7], s42 offen sc1 lds
    buffer_load_dwordx4 v223, s[72:75], s42 offen offset:1024 sc1 lds
    s_add_u32 s60, s48, 64
    s_cmp_eq_u32 s33, 3
    s_cselect_b32 s46, s44, s47
    s_cselect_b32 s50, s60, s48
    s_cselect_b32 s51, s48, s49
    v_mfma_f32_32x32x16_bf16 v[32:47], v[80:83], v[180:183], v[32:47]
    s_sub_u32 s60, s33, 2
    s_cmp_lt_u32 s60, 2
    s_cbranch_scc0 K2_rare_45
K2_back_46:
    v_mul_f32 v234, v0, v96
    v_mul_f32 v236, v8, v128
    v_fmac_f32 v234, v1, v97
    v_fmac_f32 v236, v9, v129
    v_mfma_f32_32x32x16_bf16 v[48:63], v[84:87], v[180:183], v[48:63]
    s_setprio 0
    v_fmac_f32 v234, v2, v98
    v_fmac_f32 v236, v10, v130
    v_fmac_f32 v234, v3, v99
    v_fmac_f32 v236, v11, v131
    v_fmac_f32 v234, v4, v100
    v_fmac_f32 v236, v12, v132
    v_fmac_f32 v234, v5, v101
    v_fmac_f32 v236, v13, v133
    v_fmac_f32 v234, v6, v102
    v_fmac_f32 v236, v14, v134
    v_fmac_f32 v234, v7, v103
    v_fmac_f32 v236, v15, v135
    v_mul_f32 v238, v16, v128
    v_mul_f32 v240, v24, v128
    v_fmac_f32 v238, v17, v129
    v_fmac_f32 v240, v25, v129
    v_fmac_f32 v238, v18, v130
    v_fmac_f32 v240, v26, v130
    v_fmac_f32 v238, v19, v131
    v_fmac_f32 v240, v27, v131
    v_fmac_f32 v238, v20, v132
    v_fmac_f32 v240, v28, v132
    v_fmac_f32 v238, v21, v133
    v_fmac_f32 v240, v29, v133
    v_fmac_f32 v238, v22, v134
    v_fmac_f32 v240, v30, v134
    v_fmac_f32 v238, v23, v135
    v_fmac_f32 v240, v31, v135
    v_mul_f32 v235, v32, v104
    v_mul_f32 v237, v40, v136
    v_fmac_f32 v235, v33, v105
    v_fmac_f32 v237, v41, v137
    v_fmac_f32 v235, v34, v106
    v_fmac_f32 v237, v42, v138
    v_fmac_f32 v235, v35, v107
    v_fmac_f32 v237, v43, v139
    v_fmac_f32 v235, v36, v108
    v_fmac_f32 v237, v44, v140
    v_fmac_f32 v235, v37, v109
    v_fmac_f32 v237, v45, v141
    v_fmac_f32 v235, v38, v110
    v_fmac_f32 v237, v46, v142
    v_fmac_f32 v235, v39, v111
    v_fmac_f32 v237, v47, v143
    v_mul_f32 v239, v48, v136
    v_mul_f32 v241, v56, v136
    s_setprio 1
    s_waitcnt vmcnt(4) lgkmcnt(0)
    v_mfma_f32_32x32x16_bf16 v[0:15], v[64:67], v[184:187], 0
    ds_read_b64_tr_b16 v[176:177], v246 offset:0
    ds_read_b64_tr_b16 v[178:179], v246 offset:512
    ds_read_b64_tr_b16 v[180:181], v247 offset:0
    ds_read_b64_tr_b16 v[182:183], v247 offset:512
    v_fmac_f32 v239, v49, v137
    v_fmac_f32 v241, v57, v137
    s_mov_b32 m0, s71
    v_mfma_f32_32x32x16_bf16 v[16:31], v[68:71], v[184:187], 0
    buffer_load_dwordx4 v224, s[4:7], s42 offen sc1 lds
    buffer_load_dwordx4 v225, s[72:75], s42 offen offset:1024 sc1 lds
    v_fmac_f32 v239, v50, v138
    v_fmac_f32 v241, v58, v138
    v_fmac_f32 v239, v51, v139
    v_fmac_f32 v241, v59, v139
    v_fmac_f32 v239, v52, v140
    v_mfma_f32_32x32x16_bf16 v[32:47], v[64:67], v[188:191], 0
    v_fmac_f32 v241, v60, v140
    v_fmac_f32 v239, v53, v141
    v_fmac_f32 v241, v61, v141
    v_fmac_f32 v239, v54, v142
    v_fmac_f32 v241, v62, v142
    v_fmac_f32 v239, v55, v143
    v_fmac_f32 v241, v63, v143
    v_mfma_f32_32x32x16_bf16 v[48:63], v[68:71], v[188:191], 0
    v_permlane32_swap_b32 v234, v236
    v_permlane32_swap_b32 v235, v237
    v_permlane32_swap_b32 v240, v238
    s_waitcnt vmcnt(4) lgkmcnt(0)
    v_mfma_f32_32x32x16_bf16 v[0:15], v[72:75], v[176:179], v[0:15]
    ds_read_b64_tr_b16 v[184:185], v246 offset:2048
    ds_read_b64_tr_b16 v[186:187], v246 offset:2560
    ds_read_b64_tr_b16 v[188:189], v247 offset:2048
    ds_read_b64_tr_b16 v[190:191], v247 offset:2560
    v_permlane32_swap_b32 v241, v239
    s_mov_b32 m0, s68
    v_mfma_f32_32x32x16_bf16 v[16:31], v[76:79], v[176:179], v[16:31]
    buffer_load_dwordx4 v226, s[4:7], s42 offen sc1 lds
    buffer_load_dwordx4 v227, s[72:75], s42 offen offset:1024 sc1 lds
    v_lshl_add_u32 v230, v252, 1, s31
    v_add_f32 v234, v234, v236
    v_add_f32 v235, v235, v237
    v_add_f32 v240, v240, v238
    v_add_f32 v241, v241, v239
    v_mfma_f32_32x32x16_bf16 v[32:47], v[72:75], v[180:183], v[32:47]
    v_cvt_pk_bf16_f32 v234, v234, v235
    v_cvt_pk_bf16_f32 v240, v240, v241
    ds_write_b32 v230, v234 offset:0
    ds_write_b32 v230, v240 offset:256
    v_mfma_f32_32x32x16_bf16 v[48:63], v[76:79], v[180:183], v[48:63]
    s_waitcnt vmcnt(4) lgkmcnt(2)
    v_mfma_f32_32x32x16_bf16 v[0:15], v[80:83], v[184:187], v[0:15]
    ds_read_b64_tr_b16 v[176:177], v246 offset:4096
    ds_read_b64_tr_b16 v[178:179], v246 offset:4608
    ds_read_b64_tr_b16 v[180:181], v247 offset:4096
    ds_read_b64_tr_b16 v[182:183], v247 offset:4608
    s_mov_b32 m0, s69
    v_mfma_f32_32x32x16_bf16 v[16:31], v[84:87], v[184:187], v[16:31]
    buffer_load_dwordx4 v222, s[4:7], s43 offen sc1 lds
    buffer_load_dwordx4 v223, s[72:75], s43 offen offset:1024 sc1 lds
    v_mfma_f32_32x32x16_bf16 v[32:47], v[80:83], v[188:191], v[32:47]
    s_nop 2
    v_mul_f32 v234, v0, v144
    v_mul_f32 v236, v8, v112
    v_fmac_f32 v234, v1, v145
    v_fmac_f32 v236, v9, v113
    v_fmac_f32 v234, v2, v146
    v_fmac_f32 v236, v10, v114
    v_fmac_f32 v234, v3, v147
    v_mfma_f32_32x32x16_bf16 v[48:63], v[84:87], v[188:191], v[48:63]
    s_setprio 0
    v_fmac_f32 v236, v11, v115
    v_fmac_f32 v234, v4, v148
    v_fmac_f32 v236, v12, v116
    v_fmac_f32 v234, v5, v149
    v_fmac_f32 v236, v13, v117
    v_fmac_f32 v234, v6, v150
    v_fmac_f32 v236, v14, v118
    v_fmac_f32 v234, v7, v151
    v_fmac_f32 v236, v15, v119
    v_mul_f32 v238, v16, v160
    v_mul_f32 v240, v24, v160
    v_fmac_f32 v238, v17, v161
    v_fmac_f32 v240, v25, v161
    v_fmac_f32 v238, v18, v162
    v_fmac_f32 v240, v26, v162
    v_fmac_f32 v238, v19, v163
    v_fmac_f32 v240, v27, v163
    v_fmac_f32 v238, v20, v164
    v_fmac_f32 v240, v28, v164
    v_fmac_f32 v238, v21, v165
    v_fmac_f32 v240, v29, v165
    v_fmac_f32 v238, v22, v166
    v_fmac_f32 v240, v30, v166
    v_fmac_f32 v238, v23, v167
    v_fmac_f32 v240, v31, v167
    v_mul_f32 v235, v32, v152
    v_mul_f32 v237, v40, v120
    v_fmac_f32 v235, v33, v153
    v_fmac_f32 v237, v41, v121
    v_fmac_f32 v235, v34, v154
    v_fmac_f32 v237, v42, v122
    v_fmac_f32 v235, v35, v155
    v_fmac_f32 v237, v43, v123
    v_fmac_f32 v235, v36, v156
    v_fmac_f32 v237, v44, v124
    v_fmac_f32 v235, v37, v157
    v_fmac_f32 v237, v45, v125
    v_fmac_f32 v235, v38, v158
    v_fmac_f32 v237, v46, v126
    v_fmac_f32 v235, v39, v159
    v_fmac_f32 v237, v47, v127
    v_mul_f32 v239, v48, v168
    v_mul_f32 v241, v56, v168
    v_fmac_f32 v239, v49, v169
    v_fmac_f32 v241, v57, v169
    s_setprio 1
    s_waitcnt vmcnt(4) lgkmcnt(0)
    v_mfma_f32_32x32x16_bf16 v[0:15], v[64:67], v[176:179], 0
    ds_read_b64_tr_b16 v[184:185], v246 offset:6144
    ds_read_b64_tr_b16 v[186:187], v246 offset:6656
    ds_read_b64_tr_b16 v[188:189], v247 offset:6144
    ds_read_b64_tr_b16 v[190:191], v247 offset:6656
    v_fmac_f32 v239, v50, v170
    v_fmac_f32 v241, v58, v170
    s_mov_b32 m0, s70
    v_mfma_f32_32x32x16_bf16 v[16:31], v[68:71], v[176:179], 0
    buffer_load_dwordx4 v224, s[4:7], s43 offen sc1 lds
    buffer_load_dwordx4 v225, s[72:75], s43 offen offset:1024 sc1 lds
    v_fmac_f32 v239, v51, v171
    v_fmac_f32 v241, v59, v171
    v_fmac_f32 v239, v52, v172
    v_fmac_f32 v241, v60, v172
    v_fmac_f32 v239, v53, v173
    v_mfma_f32_32x32x16_bf16 v[32:47], v[64:67], v[180:183], 0
    v_add_u32 v222, s48, v251
    ds_read_b32 v222, v222
    v_fmac_f32 v241, v61, v173
    v_fmac_f32 v239, v54, v174
    v_fmac_f32 v241, v62, v174
    v_fmac_f32 v239, v55, v175
    v_fmac_f32 v241, v63, v175
    v_mfma_f32_32x32x16_bf16 v[48:63], v[68:71], v[180:183], 0
    s_waitcnt vmcnt(4) lgkmcnt(1)
    v_mfma_f32_32x32x16_bf16 v[0:15], v[72:75], v[184:187], v[0:15]
    ds_read_b64_tr_b16 v[176:177], v246 offset:0
    ds_read_b64_tr_b16 v[178:179], v246 offset:512
    ds_read_b64_tr_b16 v[180:181], v247 offset:0
    ds_read_b64_tr_b16 v[182:183], v247 offset:512
    s_mov_b32 m0, s71
    v_mfma_f32_32x32x16_bf16 v[16:31], v[76:79], v[184:187], v[16:31]
    buffer_load_dwordx4 v226, s[4:7], s43 offen sc1 lds
    buffer_load_dwordx4 v227, s[72:75], s43 offen offset:1024 sc1 lds
    s_waitcnt lgkmcnt(4)
    v_mad_u32_u16 v223, v222, s39, v248 op_sel:[1,0,0,0]
    v_mad_u32_u16 v222, v222, s39, v248
    v_mfma_f32_32x32x16_bf16 v[32:47], v[72:75], v[188:191], v[32:47]
    v_add_u32 v224, s49, v251
    ds_read_b32 v224, v224
    v_mfma_f32_32x32x16_bf16 v[48:63], v[76:79], v[188:191], v[48:63]
    s_waitcnt vmcnt(4) lgkmcnt(1)
    v_mfma_f32_32x32x16_bf16 v[0:15], v[80:83], v[176:179], v[0:15]
    ds_read_b64_tr_b16 v[184:185], v246 offset:2048
    ds_read_b64_tr_b16 v[186:187], v246 offset:2560
    ds_read_b64_tr_b16 v[188:189], v247 offset:2048
    ds_read_b64_tr_b16 v[190:191], v247 offset:2560
    s_mov_b32 m0, s68
    v_mfma_f32_32x32x16_bf16 v[16:31], v[84:87], v[176:179], v[16:31]
    buffer_load_dwordx4 v222, s[4:7], s44 offen sc1 lds
    buffer_load_dwordx4 v223, s[72:75], s44 offen offset:1024 sc1 lds
    s_waitcnt lgkmcnt(4)
    v_mad_u32_u16 v225, v224, s39, v248 op_sel:[1,0,0,0]
    v_mad_u32_u16 v224, v224, s39, v248
    v_mfma_f32_32x32x16_bf16 v[32:47], v[80:83], v[180:183], v[32:47]
    v_add_u32 v226, s50, v251
    ds_read_b32 v226, v226
    v_mul_f32 v242, v0, v144
    v_fma_f32 v238, v8, v160, -v238
    v_fmac_f32 v242, v1, v145
    v_fmac_f32 v238, v9, v161
    v_fmac_f32 v242, v2, v146
    v_mfma_f32_32x32x16_bf16 v[48:63], v[84:87], v[180:183], v[48:63]
    s_setprio 0
    v_fmac_f32 v238, v10, v162
    v_fmac_f32 v242, v3, v147
    v_fmac_f32 v238, v11, v163
    v_fmac_f32 v242, v4, v148
    v_fmac_f32 v238, v12, v164
    v_fmac_f32 v242, v5, v149
    v_fmac_f32 v238, v13, v165
    v_fmac_f32 v242, v6, v150
    v_fmac_f32 v238, v14, v166
    v_fmac_f32 v242, v7, v151
    v_fmac_f32 v238, v15, v167
    v_fmac_f32 v236, v16, v112
    v_mul_f32 v244, v24, v160
    v_fmac_f32 v236, v17, v113
    v_fmac_f32 v244, v25, v161
    v_fmac_f32 v236, v18, v114
    v_fmac_f32 v244, v26, v162
    v_fmac_f32 v236, v19, v115
    v_fmac_f32 v244, v27, v163
    v_fmac_f32 v236, v20, v116
    v_fmac_f32 v244, v28, v164
    v_fmac_f32 v236, v21, v117
    v_fmac_f32 v244, v29, v165
    v_fmac_f32 v236, v22, v118
    v_fmac_f32 v244, v30, v166
    v_fmac_f32 v236, v23, v119
    v_fmac_f32 v244, v31, v167
    v_mul_f32 v243, v32, v152
    v_fma_f32 v239, v40, v168, -v239
    v_fmac_f32 v243, v33, v153
    v_fmac_f32 v239, v41, v169
    v_fmac_f32 v243, v34, v154
    v_fmac_f32 v239, v42, v170
    v_fmac_f32 v243, v35, v155
    v_fmac_f32 v239, v43, v171
    v_fmac_f32 v243, v36, v156
    v_fmac_f32 v239, v44, v172
    v_fmac_f32 v243, v37, v157
    v_fmac_f32 v239, v45, v173
    v_fmac_f32 v243, v38, v158
    v_fmac_f32 v239, v46, v174
    v_fmac_f32 v243, v39, v159
    v_fmac_f32 v239, v47, v175
    v_fmac_f32 v237, v48, v120
    v_mul_f32 v245, v56, v168
    v_fmac_f32 v237, v49, v121
    v_fmac_f32 v245, v57, v169
    v_fmac_f32 v237, v50, v122
    v_fmac_f32 v245, v58, v170
    v_fmac_f32 v237, v51, v123
    s_setprio 1
    s_waitcnt vmcnt(4) lgkmcnt(1)
    v_mfma_f32_32x32x16_bf16 v[0:15], v[64:67], v[184:187], 0
    ds_read_b64_tr_b16 v[176:177], v246 offset:4096
    ds_read_b64_tr_b16 v[178:179], v246 offset:4608
    ds_read_b64_tr_b16 v[180:181], v247 offset:4096
    ds_read_b64_tr_b16 v[182:183], v247 offset:4608
    v_fmac_f32 v245, v59, v171
    v_fmac_f32 v237, v52, v124
    s_mov_b32 m0, s69
    v_mfma_f32_32x32x16_bf16 v[16:31], v[68:71], v[184:187], 0
    buffer_load_dwordx4 v224, s[4:7], s45 offen sc1 lds
    buffer_load_dwordx4 v225, s[72:75], s45 offen offset:1024 sc1 lds
    s_waitcnt lgkmcnt(4)
    v_mad_u32_u16 v227, v226, s39, v248 op_sel:[1,0,0,0]
    v_mad_u32_u16 v226, v226, s39, v248
    v_fmac_f32 v245, v60, v172
    v_fmac_f32 v237, v53, v125
    v_mfma_f32_32x32x16_bf16 v[32:47], v[64:67], v[188:191], 0
    v_add_u32 v228, s51, v251
    ds_read_b32 v228, v228
    v_fmac_f32 v245, v61, v173
    v_fmac_f32 v237, v54, v126
    v_fmac_f32 v245, v62, v174
    v_fmac_f32 v237, v55, v127
    v_fmac_f32 v245, v63, v175
    v_mfma_f32_32x32x16_bf16 v[48:63], v[68:71], v[188:191], 0
    v_permlane32_swap_b32 v242, v234
    v_permlane32_swap_b32 v243, v235
    v_add_f32 v242, v242, v234
    v_add_f32 v243, v243, v235
    s_waitcnt vmcnt(4) lgkmcnt(1)
    v_mfma_f32_32x32x16_bf16 v[0:15], v[72:75], v[176:179], v[0:15]
    ds_read_b64_tr_b16 v[184:185], v246 offset:6144
    ds_read_b64_tr_b16 v[186:187], v246 offset:6656
    ds_read_b64_tr_b16 v[188:189], v247 offset:6144
    ds_read_b64_tr_b16 v[190:191], v247 offset:6656
    v_cvt_pk_bf16_f32 v242, v242, v243
    ds_write_b32 v230, v242 offset:512
    s_mov_b32 m0, s70
    v_mfma_f32_32x32x16_bf16 v[16:31], v[76:79], v[176:179], v[16:31]
    buffer_load_dwordx4 v226, s[4:7], s46 offen sc1 lds
    buffer_load_dwordx4 v227, s[72:75], s46 offen offset:1024 sc1 lds
    s_waitcnt lgkmcnt(5)
    v_mad_u32_u16 v229, v228, s39, v248 op_sel:[1,0,0,0]
    v_mad_u32_u16 v228, v228, s39, v248
    s_sub_u32 s26, s48, s29
    s_mov_b32 s29, s48
    v_mfma_f32_32x32x16_bf16 v[32:47], v[72:75], v[180:183], v[32:47]
    s_mov_b32 s30, s3
    s_cmp_lg_u32 s36, 0
    s_cselect_b32 s56, s33, 0
    s_mov_b32 s32, s31
    s_mov_b32 s31, s35
    v_mfma_f32_32x32x16_bf16 v[48:63], v[76:79], v[180:183], v[48:63]
    s_waitcnt vmcnt(4) lgkmcnt(1)
    v_mfma_f32_32x32x16_bf16 v[0:15], v[80:83], v[184:187], v[0:15]
    ds_read_b64_tr_b16 v[176:177], v246 offset:0
    ds_read_b64_tr_b16 v[178:179], v246 offset:512
    ds_read_b64_tr_b16 v[180:181], v247 offset:0
    ds_read_b64_tr_b16 v[182:183], v247 offset:512
    s_mov_b32 m0, s71
    v_mfma_f32_32x32x16_bf16 v[16:31], v[84:87], v[184:187], v[16:31]
    buffer_load_dwordx4 v228, s[4:7], s47 offen sc1 lds
    buffer_load_dwordx4 v229, s[72:75], s47 offen offset:1024 sc1 lds
    v_mfma_f32_32x32x16_bf16 v[32:47], v[80:83], v[188:191], v[32:47]
    s_nop 2
    v_mul_f32 v242, v0, v144
    v_fma_f32 v240, v8, v160, -v240
    v_fmac_f32 v242, v1, v145
    v_fmac_f32 v240, v9, v161
    v_fmac_f32 v242, v2, v146
    v_fmac_f32 v240, v10, v162
    v_fmac_f32 v242, v3, v147
    v_mfma_f32_32x32x16_bf16 v[48:63], v[84:87], v[188:191], v[48:63]
    s_setprio 0
    v_fmac_f32 v240, v11, v163
    v_fmac_f32 v242, v4, v148
    v_fmac_f32 v240, v12, v164
    v_fmac_f32 v242, v5, v149
    v_fmac_f32 v240, v13, v165
    v_fmac_f32 v242, v6, v150
    v_fmac_f32 v240, v14, v166
    v_fmac_f32 v242, v7, v151
    v_fmac_f32 v240, v15, v167
    v_add_u32 v249, s26, v249
    v_add_u32 v250, s26, v250
    v_fma_f32 v244, v16, v160, -v244
    v_fmac_f32 v236, v24, v112
    v_fmac_f32 v244, v17, v161
    v_fmac_f32 v236, v25, v113
    v_fmac_f32 v244, v18, v162
    v_fmac_f32 v236, v26, v114
    v_fmac_f32 v244, v19, v163
    v_fmac_f32 v236, v27, v115
    v_fmac_f32 v244, v20, v164
    v_fmac_f32 v236, v28, v116
    v_fmac_f32 v244, v21, v165
    v_fmac_f32 v236, v29, v117
    v_fmac_f32 v244, v22, v166
    v_fmac_f32 v236, v30, v118
    v_fmac_f32 v244, v23, v167
    v_fmac_f32 v236, v31, v119
    ds_read_b64_tr_b16 v[0:1], v249 offset:0
    ds_read_b64_tr_b16 v[2:3], v249 offset:256
    ds_read_u16_d16_hi v16, v250 offset:0
    v_mul_f32 v243, v32, v152
    v_fma_f32 v241, v40, v168, -v241
    v_fmac_f32 v243, v33, v153
    v_fmac_f32 v241, v41, v169
    v_fmac_f32 v243, v34, v154
    v_fmac_f32 v241, v42, v170
    v_fmac_f32 v243, v35, v155
    v_fmac_f32 v241, v43, v171
    v_fmac_f32 v243, v36, v156
    v_fmac_f32 v241, v44, v172
    v_fmac_f32 v243, v37, v157
    v_fmac_f32 v241, v45, v173
    v_fmac_f32 v243, v38, v158
    v_fmac_f32 v241, v46, v174
    v_fmac_f32 v243, v39, v159
    v_fmac_f32 v241, v47, v175
    ds_read_b64_tr_b16 v[4:5], v249 offset:512
    ds_read_b64_tr_b16 v[6:7], v249 offset:768
    ds_read_u16_d16_hi v17, v250 offset:32
    v_fma_f32 v245, v48, v168, -v245
    v_fmac_f32 v237, v56, v120
    v_fmac_f32 v245, v49, v169
    v_fmac_f32 v237, v57, v121
    v_fmac_f32 v245, v50, v170
    v_fmac_f32 v237, v58, v122
    v_fmac_f32 v245, v51, v171
    v_fmac_f32 v237, v59, v123
    v_fmac_f32 v245, v52, v172
    v_fmac_f32 v237, v60, v124
    v_fmac_f32 v245, v53, v173
    v_fmac_f32 v237, v61, v125
    v_fmac_f32 v245, v54, v174
    v_fmac_f32 v237, v62, v126
    v_fmac_f32 v245, v55, v175
    v_fmac_f32 v237, v63, v127
    s_cmp_eq_u32 s56, 2
    s_cbranch_scc1 K2_U21
    s_cmp_eq_u32 s56, 3
    s_cbranch_scc1 K2_U31
    s_branch K2_DSP1
K2_PAD_SW:
    s_branch K2_HOP
K2_DSP0:
    s_cmp_eq_u32 s56, 1
    s_cbranch_scc1 K2_U10
    s_cmp_eq_u32 s56, 4
    s_cbranch_scc1 K2_U40
    s_branch K2_SWITCH
K2_DSP1:
    s_cmp_eq_u32 s56, 1
    s_cbranch_scc1 K2_U11
    s_cmp_eq_u32 s56, 4
    s_cbranch_scc1 K2_U41
    s_branch K2_TAIL
K2_SWITCH:
    v_lshlrev_b32 v60, 3, v252
    s_mov_b32 s64, 7176192
    buffer_load_dwordx4 v[56:59], v60, s[8:11], s64 offen sc1
    v_permlane32_swap_b32 v242, v236
    v_permlane32_swap_b32 v243, v237
    v_permlane32_swap_b32 v244, v238
    v_permlane32_swap_b32 v245, v239
    v_permlane32_swap_b32 v240, v241
    v_add_f32 v242, v242, v236
    v_add_f32 v243, v243, v237
    v_add_f32 v244, v244, v238
    v_add_f32 v245, v245, v239
    v_add_f32 v240, -v240, -v241
    s_set_gpr_idx_on s32, gpr_idx(DST)
    s_nop 0
    v_cvt_pk_bf16_f32 v195, v242, v243
    v_cvt_pk_bf16_f32 v196, v244, v245
    v_cvt_pk_bf16_f32 v197, v240, v240
    s_set_gpr_idx_off
    v_lshl_add_u32 v230, v252, 1, s35
    v_lshrrev_b32 v231, 6, v252
    v_mul_u32_u24 v231, 126, v231
    v_lshrrev_b32 v254, 6, v252
    v_bfe_u32 v255, v252, 3, 2
    v_lshl_add_u32 v254, v254, 2, v255
    v_mul_u32_u24 v254, 640, v254
    v_bfe_u32 v255, v252, 5, 1
    v_lshl_add_u32 v254, v255, 5, v254
    v_and_b32 v255, 6, v252
    v_lshl_add_u32 v254, v255, 2, v254
    v_add_u32 v254, 152832, v254
    ds_read_b64_tr_b16 v[104:105], v254 offset:0
    ds_read_b64_tr_b16 v[106:107], v254 offset:5120
    ds_read_b64_tr_b16 v[108:109], v254 offset:64
    ds_read_b64_tr_b16 v[110:111], v254 offset:5184
    ds_read_b64_tr_b16 v[120:121], v254 offset:128
    ds_read_b64_tr_b16 v[122:123], v254 offset:5248
    ds_read_b64_tr_b16 v[124:125], v254 offset:192
    ds_read_b64_tr_b16 v[126:127], v254 offset:5312
    ds_read_b64_tr_b16 v[136:137], v254 offset:256
    ds_read_b64_tr_b16 v[138:139], v254 offset:5376
    ds_read_b64_tr_b16 v[140:141], v254 offset:320
    ds_read_b64_tr_b16 v[142:143], v254 offset:5440
    ds_read_b64_tr_b16 v[152:153], v254 offset:384
    ds_read_b64_tr_b16 v[154:155], v254 offset:5504
    ds_read_b64_tr_b16 v[156:157], v254 offset:448
    ds_read_b64_tr_b16 v[158:159], v254 offset:5568
    ds_read_b64_tr_b16 v[168:169], v254 offset:512
    ds_read_b64_tr_b16 v[170:171], v254 offset:5632
    ds_read_b64_tr_b16 v[172:173], v254 offset:576
    ds_read_b64_tr_b16 v[174:175], v254 offset:5696
    s_movk_i32 s40, 128
    s_movk_i32 s41, 384
    s_movk_i32 s42, 640
    s_movk_i32 s43, 896
    s_waitcnt lgkmcnt(15)
    v_lshlrev_b32 v96, 16, v104
    v_and_b32 v97, 0xffff0000, v104
    v_lshlrev_b32 v98, 16, v105
    v_and_b32 v99, 0xffff0000, v105
    v_lshlrev_b32 v100, 16, v106
    v_and_b32 v101, 0xffff0000, v106
    v_lshlrev_b32 v102, 16, v107
    v_and_b32 v103, 0xffff0000, v107
    v_lshlrev_b32 v104, 16, v108
    v_and_b32 v105, 0xffff0000, v108
    v_lshlrev_b32 v106, 16, v109
    v_and_b32 v107, 0xffff0000, v109
    v_lshlrev_b32 v108, 16, v110
    v_and_b32 v109, 0xffff0000, v110
    v_lshlrev_b32 v110, 16, v111
    v_and_b32 v111, 0xffff0000, v111
    s_waitcnt lgkmcnt(12)
    v_lshlrev_b32 v112, 16, v120
    v_and_b32 v113, 0xffff0000, v120
    v_lshlrev_b32 v114, 16, v121
    v_and_b32 v115, 0xffff0000, v121
    v_lshlrev_b32 v116, 16, v122
    v_and_b32 v117, 0xffff0000, v122
    v_lshlrev_b32 v118, 16, v123
    v_and_b32 v119, 0xffff0000, v123
    v_lshlrev_b32 v120, 16, v124
    v_and_b32 v121, 0xffff0000, v124
    v_lshlrev_b32 v122, 16, v125
    v_and_b32 v123, 0xffff0000, v125
    v_lshlrev_b32 v124, 16, v126
    v_and_b32 v125, 0xffff0000, v126
    v_lshlrev_b32 v126, 16, v127
    v_and_b32 v127, 0xffff0000, v127
    s_waitcnt lgkmcnt(8)
    v_lshlrev_b32 v128, 16, v136
    v_and_b32 v129, 0xffff0000, v136
    v_lshlrev_b32 v130, 16, v137
    v_and_b32 v131, 0xffff0000, v137
    v_lshlrev_b32 v132, 16, v138
    v_and_b32 v133, 0xffff0000, v138
    v_lshlrev_b32 v134, 16, v139
    v_and_b32 v135, 0xffff0000, v139
    v_lshlrev_b32 v136, 16, v140
    v_and_b32 v137, 0xffff0000, v140
    v_lshlrev_b32 v138, 16, v141
    v_and_b32 v139, 0xffff0000, v141
    v_lshlrev_b32 v140, 16, v142
    v_and_b32 v141, 0xffff0000, v142
    v_lshlrev_b32 v142, 16, v143
    v_and_b32 v143, 0xffff0000, v143
    s_waitcnt lgkmcnt(4)
    v_lshlrev_b32 v144, 16, v152
    v_and_b32 v145, 0xffff0000, v152
    v_lshlrev_b32 v146, 16, v153
    v_and_b32 v147, 0xffff0000, v153
    v_lshlrev_b32 v148, 16, v154
    v_and_b32 v149, 0xffff0000, v154
    v_lshlrev_b32 v150, 16, v155
    v_and_b32 v151, 0xffff0000, v155
    v_lshlrev_b32 v152, 16, v156
    v_and_b32 v153, 0xffff0000, v156
    v_lshlrev_b32 v154, 16, v157
    v_and_b32 v155, 0xffff0000, v157
    v_lshlrev_b32 v156, 16, v158
    v_and_b32 v157, 0xffff0000, v158
    v_lshlrev_b32 v158, 16, v159
    v_and_b32 v159, 0xffff0000, v159
    s_waitcnt lgkmcnt(0)
    v_lshlrev_b32 v160, 16, v168
    v_and_b32 v161, 0xffff0000, v168
    v_lshlrev_b32 v162, 16, v169
    v_and_b32 v163, 0xffff0000, v169
    v_lshlrev_b32 v164, 16, v170
    v_and_b32 v165, 0xffff0000, v170
    v_lshlrev_b32 v166, 16, v171
    v_and_b32 v167, 0xffff0000, v171
    v_lshlrev_b32 v168, 16, v172
    v_and_b32 v169, 0xffff0000, v172
    v_lshlrev_b32 v170, 16, v173
    v_and_b32 v171, 0xffff0000, v173
    v_lshlrev_b32 v172, 16, v174
    v_and_b32 v173, 0xffff0000, v174
    v_lshlrev_b32 v174, 16, v175
    v_and_b32 v175, 0xffff0000, v175
K2_FLGW:
    s_or_b32 s58, s54, s20
    s_waitcnt vmcnt(0)
    v_xor_b32 v56, s2, v56
    v_xor_b32 v57, s2, v57
    v_xor_b32 v58, s2, v58
    v_xor_b32 v59, s2, v59
    v_or3_b32 v56, v56, v57, v58
    v_or_b32 v56, v56, v59
    v_cmp_ne_u32 vcc, 0, v56
    s_nop 0
    s_cbranch_vccnz K2_FLGR
    s_cmp_eq_u32 s58, 0
    s_cbranch_scc1 K2_FLGY
K2_FLGOK:
    s_cmp_eq_u32 s36, 0
    s_cbranch_scc1 K2_TAIL2
    s_mov_b32 s29, s48
    s_mov_b32 s32, s31
    s_mov_b32 s30, s3
    s_mov_b32 s31, s35
    s_cmp_eq_u32 s33, 2
    s_cbranch_scc1 K2_U21
    s_cmp_eq_u32 s33, 3
    s_cbranch_scc1 K2_U31
    s_cmp_eq_u32 s33, 1
    s_cbranch_scc1 K2_U11
    s_branch K2_U41
K2_dum_4:
    v_mov_b32 v232, -1
    s_mov_b32 m0, 163360
    s_mov_b64 exec, 1
    buffer_load_dwordx4 v232, s[16:19], 0 offen lds
    buffer_load_dwordx4 v232, s[16:19], 0 offen lds
    s_mov_b64 exec, -1
    s_branch K2_back_6
K2_nul_10:
    s_mov_b32 s58, 63
    s_mov_b32 s36, 0
    s_branch K2_back_13
K2_spin_11:
    s_sub_u32 s27, s27, 1
    s_cbranch_scc1 K2_END
    v_lshl_add_u32 v233, v252, 1, s53
    ds_read_b32 v233, v233
    s_waitcnt lgkmcnt(0)
    s_branch K2_chk_12
K2_dyn_8:
    v_mov_b32 v254, 163296
    v_mov_b32 v255, 1
    v_lshl_add_u32 v233, v252, 1, s53
    s_mov_b64 exec, 1
    ds_add_rtn_u32 v232, v254, v255
    s_mov_b64 exec, -1
    ds_read_b32 v233, v233
    s_waitcnt lgkmcnt(0)
    v_readfirstlane_b32 s58, v232
    s_nop 0
    s_cmp_lt_u32 s58, s22
    s_cbranch_scc0 K2_nul_10
    s_and_b32 s59, s58, 7
    s_lshr_b32 s60, s58, 3
K2_chk_12:
    v_readlane_b32 s61, v233, s59
    s_nop 0
    s_cmp_gt_u32 s61, s60
    s_cbranch_scc0 K2_spin_11
K2_back_13:
    s_mov_b32 s34, 1
    s_branch K2_back_9
K2_dum_17:
    v_mov_b32 v232, -1
    s_mov_b32 m0, 163360
    s_mov_b64 exec, 1
    buffer_load_dwordx4 v232, s[16:19], 0 offen lds
    buffer_load_dwordx4 v232, s[16:19], 0 offen lds
    s_mov_b64 exec, -1
    s_branch K2_back_19
K2_nul_23:
    s_mov_b32 s58, 63
    s_mov_b32 s36, 0
    s_branch K2_back_26
K2_spin_24:
    s_sub_u32 s27, s27, 1
    s_cbranch_scc1 K2_END
    v_lshl_add_u32 v233, v252, 1, s53
    ds_read_b32 v233, v233
    s_waitcnt lgkmcnt(0)
    s_branch K2_chk_25
K2_dyn_21:
    v_mov_b32 v254, 163296
    v_mov_b32 v255, 1
    v_lshl_add_u32 v233, v252, 1, s53
    s_mov_b64 exec, 1
    ds_add_rtn_u32 v232, v254, v255
    s_mov_b64 exec, -1
    ds_read_b32 v233, v233
    s_waitcnt lgkmcnt(0)
    v_readfirstlane_b32 s58, v232
    s_nop 0
    s_cmp_lt_u32 s58, s22
    s_cbranch_scc0 K2_nul_23
    s_and_b32 s59, s58, 7
    s_lshr_b32 s60, s58, 3
K2_chk_25:
    v_readlane_b32 s61, v233, s59
    s_nop 0
    s_cmp_gt_u32 s61, s60
    s_cbranch_scc0 K2_spin_24
K2_back_26:
    s_mov_b32 s34, 1
    s_branch K2_back_22
K2_dum_30:
    v_mov_b32 v232, -1
    s_mov_b32 m0, 163360
    s_mov_b64 exec, 1
    buffer_load_dwordx4 v232, s[16:19], 0 offen lds
    buffer_load_dwordx4 v232, s[16:19], 0 offen lds
    s_mov_b64 exec, -1
    s_branch K2_back_32
K2_nul_34:
    s_mov_b32 s58, 63
    s_mov_b32 s36, 0
    s_branch K2_back_37
K2_spin_35:
    s_sub_u32 s27, s27, 1
    s_cbranch_scc1 K2_END
    v_lshl_add_u32 v233, v252, 1, s53
    ds_read_b32 v233, v233
    s_waitcnt lgkmcnt(0)
    s_branch K2_chk_36
K2_nul_41:
    s_mov_b32 s58, 63
    s_mov_b32 s36, 0
    s_branch K2_back_44
K2_spin_42:
    s_sub_u32 s27, s27, 1
    s_cbranch_scc1 K2_END
    v_lshl_add_u32 v233, v252, 1, s53
    ds_read_b32 v233, v233
    s_waitcnt lgkmcnt(0)
    s_branch K2_chk_43
K2_PAD_TL:
    s_branch K2_HOP
K2_TAIL2:
    v_lshlrev_b32 v229, 3, v252
    s_mul_i32 s58, s20, 20480
    s_add_u32 s58, s58, 6946816
    s_mul_i32 s59, s20, 8224
    buffer_load_dwordx4 v[96:99], v229, s[8:11], s58 offen offset:0 sc1
    buffer_load_dwordx4 v[100:103], v229, s[8:11], s58 offen offset:1024 sc1
    buffer_load_dwordx4 v[104:107], v229, s[8:11], s58 offen offset:2048 sc1
    buffer_load_dwordx4 v[108:111], v229, s[8:11], s58 offen offset:3072 sc1
    s_add_u32 s58, s58, 4096
    buffer_load_dwordx4 v[112:115], v229, s[8:11], s58 offen offset:0 sc1
    buffer_load_dwordx4 v[116:119], v229, s[8:11], s58 offen offset:1024 sc1
    buffer_load_dwordx4 v[120:123], v229, s[8:11], s58 offen offset:2048 sc1
    buffer_load_dwordx4 v[124:127], v229, s[8:11], s58 offen offset:3072 sc1
    v_lshl_add_u32 v228, v252, 1, s59
    v_lshrrev_b32 v226, 6, v252
    v_mul_u32_u24 v226, 126, v226
    v_sub_u32 v226, v228, v226
    s_branch K2_TAIL3
K2_TAIL:
    v_lshlrev_b32 v229, 3, v252
    s_mul_i32 s58, s20, 20480
    s_add_u32 s58, s58, 6946816
    s_mul_i32 s59, s20, 8224
    buffer_load_dwordx4 v[96:99], v229, s[8:11], s58 offen offset:0 sc1
    v_permlane32_swap_b32 v242, v236
    v_permlane32_swap_b32 v243, v237
    buffer_load_dwordx4 v[100:103], v229, s[8:11], s58 offen offset:1024 sc1
    v_permlane32_swap_b32 v244, v238
    v_permlane32_swap_b32 v245, v239
    buffer_load_dwordx4 v[104:107], v229, s[8:11], s58 offen offset:2048 sc1
    v_permlane32_swap_b32 v240, v241
    v_add_f32 v242, v242, v236
    buffer_load_dwordx4 v[108:111], v229, s[8:11], s58 offen offset:3072 sc1
    v_add_f32 v243, v243, v237
    v_add_f32 v244, v244, v238
    s_add_u32 s58, s58, 4096
    buffer_load_dwordx4 v[112:115], v229, s[8:11], s58 offen offset:0 sc1
    v_add_f32 v245, v245, v239
    v_add_f32 v240, -v240, -v241
    buffer_load_dwordx4 v[116:119], v229, s[8:11], s58 offen offset:1024 sc1
    v_sub_u32 v241, v230, v231
    v_cvt_pk_bf16_f32 v242, v242, v243
    buffer_load_dwordx4 v[120:123], v229, s[8:11], s58 offen offset:2048 sc1
    v_cvt_pk_bf16_f32 v244, v244, v245
    v_cvt_pk_bf16_f32 v240, v240, v240
    buffer_load_dwordx4 v[124:127], v229, s[8:11], s58 offen offset:3072 sc1
    ds_write_b32 v230, v242 offset:768
    ds_write_b32 v230, v244 offset:1024
    ds_write_b16 v241, v240 offset:1280
    v_lshl_add_u32 v228, v252, 1, s59
    v_lshrrev_b32 v226, 6, v252
    v_mul_u32_u24 v226, 126, v226
    v_sub_u32 v226, v228, v226
K2_TAIL3:
    s_waitcnt vmcnt(8)
    ds_write_b32 v228, v192 offset:0
    ds_write_b32 v228, v193 offset:256
    ds_write_b32 v228, v194 offset:512
    s_add_u32 s58, s58, 4096
    buffer_load_dwordx4 v[128:131], v229, s[8:11], s58 offen offset:0 sc1
    v_bfe_u32 v48, v252, 1, 4
    v_lshrrev_b32 v49, 5, v252
    ds_write_b32 v228, v195 offset:768
    ds_write_b32 v228, v196 offset:1024
    ds_write_b16 v226, v197 offset:1280
    buffer_load_dwordx4 v[132:135], v229, s[8:11], s58 offen offset:1024 sc1
    v_lshrrev_b32 v55, 3, v48
    v_lshlrev_b32 v52, 4, v49
    ds_write_b32 v228, v198 offset:1536
    ds_write_b32 v228, v199 offset:1792
    ds_write_b32 v228, v200 offset:2048
    buffer_load_dwordx4 v[136:139], v229, s[8:11], s58 offen offset:2048 sc1
    v_lshl_add_u32 v54, v55, 2, v48
    v_and_b32 v54, 7, v54
    ds_write_b32 v228, v201 offset:2304
    ds_write_b32 v228, v202 offset:2560
    ds_write_b16 v226, v203 offset:2816
    buffer_load_dwordx4 v[140:143], v229, s[8:11], s58 offen offset:3072 sc1
    v_and_b32 v50, 7, v48
    v_mul_u32_u24 v50, 8224, v50
    ds_write_b32 v228, v204 offset:3072
    ds_write_b32 v228, v205 offset:3328
    ds_write_b32 v228, v206 offset:3584
    s_add_u32 s58, s58, 4096
    buffer_load_dwordx4 v[144:147], v229, s[8:11], s58 offen offset:0 sc1
    v_mul_u32_u24 v51, 1536, v55
    v_add_u32 v50, v50, v51
    ds_write_b32 v228, v207 offset:3840
    ds_write_b32 v228, v208 offset:4096
    ds_write_b16 v226, v209 offset:4352
    buffer_load_dwordx4 v[148:151], v229, s[8:11], s58 offen offset:1024 sc1
    v_add_u32 v222, v50, v52
    v_mul_u32_u24 v51, 8224, v54
    ds_write_b32 v228, v210 offset:4608
    ds_write_b32 v228, v211 offset:4864
    ds_write_b32 v228, v212 offset:5120
    buffer_load_dwordx4 v[152:155], v229, s[8:11], s58 offen offset:2048 sc1
    v_add_u32 v232, v51, v52
    v_lshl_add_u32 v247, v55, 7, v232
    ds_write_b32 v228, v213 offset:5376
    ds_write_b32 v228, v214 offset:5632
    ds_write_b16 v226, v215 offset:5888
    buffer_load_dwordx4 v[156:159], v229, s[8:11], s58 offen offset:3072 sc1
    v_mul_u32_u24 v51, 2080, v48
    s_mov_b32 s60, 65536
    ds_write_b32 v228, v216 offset:6144
    ds_write_b32 v228, v217 offset:6400
    ds_write_b32 v228, v218 offset:6656
    s_add_u32 s58, s58, 4096
    buffer_load_dwordx4 v[160:163], v229, s[8:11], s58 offen offset:0 sc1
    v_add3_u32 v223, v51, v52, s60
    v_mul_u32_u24 v51, 2080, v54
    ds_write_b32 v228, v219 offset:6912
    ds_write_b32 v228, v220 offset:7168
    ds_write_b16 v226, v221 offset:7424
    buffer_load_dwordx4 v[164:167], v229, s[8:11], s58 offen offset:1024 sc1
    s_mov_b32 s60, 132096
    v_add3_u32 v225, v51, v52, s60
    buffer_load_dwordx4 v[168:171], v229, s[8:11], s58 offen offset:2048 sc1
    v_lshl_add_u32 v248, v55, 7, v225
    s_lshl_b32 s60, s20, 5
    buffer_load_dwordx4 v[172:175], v229, s[8:11], s58 offen offset:3072 sc1
    v_lshl_add_u32 v49, v49, 3, s60
    s_mov_b32 s60, 65536
    v_add3_u32 v255, v51, v49, s60
    v_lshl_add_u32 v246, v55, 9, v255
    v_bfe_u32 v53, v48, 2, 1
    v_lshl_add_u32 v49, v53, 4, v49
    v_add_u32 v254, v50, v49
    s_and_b32 s64, s55, s28
    s_waitcnt lgkmcnt(0)
    s_barrier
    s_cmp_eq_u32 s64, 0
    s_cbranch_scc1 K2_MULTI
    s_setprio 3
    ds_read_b128 v[48:51], v222 offset:0
    ds_read_b128 v[52:55], v222 offset:64
    ds_read_b128 v[56:59], v222 offset:896
    ds_read_b128 v[60:63], v222 offset:960
    ds_read_b128 v[64:67], v223 offset:0
    ds_read_b128 v[68:71], v223 offset:64
    ds_read_b128 v[72:75], v223 offset:896
    ds_read_b128 v[76:79], v223 offset:960
    ds_read_b128 v[80:83], v222 offset:3072
    ds_read_b128 v[84:87], v222 offset:3136
    ds_read_b128 v[88:91], v222 offset:3968
    s_waitcnt vmcnt(19) lgkmcnt(9)
    v_mfma_f32_16x16x32_bf16 v[0:3], v[96:99], v[48:51], 0
    ds_read_b128 v[92:95], v222 offset:4032
    s_waitcnt vmcnt(18)
    v_mfma_f32_16x16x32_bf16 v[0:3], v[100:103], v[52:55], v[0:3]
    ds_read_b128 v[48:51], v223 offset:33280
    s_waitcnt vmcnt(17) lgkmcnt(9)
    v_mfma_f32_16x16x32_bf16 v[0:3], v[104:107], v[56:59], v[0:3]
    s_bfe_u32 s60, s20, 0x10002
    s_lshl_b32 s60, s60, 4
    ds_read_b128 v[52:55], v223 offset:33344
    s_waitcnt vmcnt(16)
    v_mfma_f32_16x16x32_bf16 v[0:3], v[108:111], v[60:63], v[0:3]
    s_add_u32 s59, s59, s60
    v_add_u32 v228, s59, v229
    ds_read_b128 v[56:59], v223 offset:34176
    s_waitcnt vmcnt(15) lgkmcnt(9)
    v_mfma_f32_16x16x32_bf16 v[0:3], v[112:115], v[64:67], v[0:3]
    s_mul_i32 s60, s20, 2080
    s_add_u32 s60, s60, 65536
    ds_read_b128 v[60:63], v223 offset:34240
    s_waitcnt vmcnt(14)
    v_mfma_f32_16x16x32_bf16 v[0:3], v[116:119], v[68:71], v[0:3]
    v_add_u32 v249, s60, v229
    s_mov_b32 s63, 0xbfb8aa3b
    ds_read_b128 v[64:67], v232 offset:6144
    s_waitcnt vmcnt(13) lgkmcnt(9)
    v_mfma_f32_16x16x32_bf16 v[0:3], v[120:123], v[72:75], v[0:3]
    s_add_u32 s40, s20, s21
    s_lshl_b32 s40, s40, 10
    ds_read_b128 v[68:71], v232 offset:6208
    s_waitcnt vmcnt(12)
    v_mfma_f32_16x16x32_bf16 v[0:3], v[124:127], v[76:79], v[0:3]
    s_add_u32 s41, s40, 8192
    s_add_u32 s42, s40, 16384
    ds_read_b128 v[72:75], v232 offset:7040
    s_waitcnt lgkmcnt(9)
    v_mfma_f32_16x16x32_bf16 v[16:19], v[96:99], v[80:83], 0
    s_add_u32 s43, s40, 24576
    s_add_u32 s44, s40, 32768
    ds_read_b128 v[76:79], v232 offset:7104
    v_mfma_f32_16x16x32_bf16 v[16:19], v[100:103], v[84:87], v[16:19]
    ds_read_b128 v[80:83], v225 offset:0
    s_waitcnt lgkmcnt(9)
    v_mfma_f32_16x16x32_bf16 v[16:19], v[104:107], v[88:91], v[16:19]
    ds_read_b128 v[84:87], v225 offset:64
    v_mfma_f32_16x16x32_bf16 v[16:19], v[108:111], v[92:95], v[16:19]
    v_mul_f32 v204, s63, v0
    v_mul_f32 v205, s63, v1
    ds_read_b128 v[88:91], v225 offset:896
    s_waitcnt lgkmcnt(9)
    v_mfma_f32_16x16x32_bf16 v[16:19], v[112:115], v[48:51], v[16:19]
    v_mul_f32 v206, s63, v2
    ds_read_b128 v[92:95], v225 offset:960
    v_mfma_f32_16x16x32_bf16 v[16:19], v[116:119], v[52:55], v[16:19]
    v_mul_f32 v207, s63, v3
    ds_read_b128 v[48:51], v222 offset:128
    s_waitcnt lgkmcnt(9)
    v_mfma_f32_16x16x32_bf16 v[16:19], v[120:123], v[56:59], v[16:19]
    v_exp_f32 v204, v204
    ds_read_b128 v[52:55], v222 offset:384
    v_mfma_f32_16x16x32_bf16 v[16:19], v[124:127], v[60:63], v[16:19]
    v_exp_f32 v205, v205
    ds_read_b128 v[56:59], v222 offset:256
    s_waitcnt lgkmcnt(9)
    v_mfma_f32_16x16x32_bf16 v[32:35], v[96:99], v[64:67], 0
    v_exp_f32 v206, v206
    ds_read_b128 v[60:63], v222 offset:192
    v_mfma_f32_16x16x32_bf16 v[32:35], v[100:103], v[68:71], v[32:35]
    v_exp_f32 v207, v207
    s_setprio 2
    ds_read_b128 v[64:67], v222 offset:448
    s_waitcnt lgkmcnt(9)
    v_mfma_f32_16x16x32_bf16 v[32:35], v[104:107], v[72:75], v[32:35]
    v_add_f32 v204, 1.0, v204
    ds_read_b128 v[68:71], v222 offset:320
    v_mfma_f32_16x16x32_bf16 v[32:35], v[108:111], v[76:79], v[32:35]
    v_add_f32 v205, 1.0, v205
    v_add_f32 v206, 1.0, v206
    ds_read_b128 v[72:75], v222 offset:640
    s_waitcnt lgkmcnt(9)
    v_mfma_f32_16x16x32_bf16 v[32:35], v[112:115], v[80:83], v[32:35]
    v_add_f32 v207, 1.0, v207
    ds_read_b128 v[76:79], v222 offset:512
    v_mfma_f32_16x16x32_bf16 v[32:35], v[116:119], v[84:87], v[32:35]
    v_rcp_f32 v204, v204
    ds_read_b128 v[80:83], v222 offset:768
    s_waitcnt lgkmcnt(9)
    v_mfma_f32_16x16x32_bf16 v[32:35], v[120:123], v[88:91], v[32:35]
    v_rcp_f32 v205, v205
    ds_read_b128 v[84:87], v222 offset:704
    v_mfma_f32_16x16x32_bf16 v[32:35], v[124:127], v[92:95], v[32:35]
    v_rcp_f32 v206, v206
    ds_read_b128 v[88:91], v222 offset:576
    s_waitcnt vmcnt(11) lgkmcnt(9)
    v_mfma_f32_16x16x32_bf16 v[4:7], v[128:131], v[48:51], 0
    v_rcp_f32 v207, v207
    ds_read_b128 v[92:95], v222 offset:832
    v_mfma_f32_16x16x32_bf16 v[8:11], v[128:131], v[52:55], 0
    v_cvt_pk_bf16_f32 v176, v0, v1
    ds_read_b128 v[48:51], v222 offset:1024
    s_waitcnt lgkmcnt(9)
    v_mfma_f32_16x16x32_bf16 v[12:15], v[128:131], v[56:59], 0
    v_cvt_pk_bf16_f32 v177, v2, v3
    ds_read_b128 v[52:55], v222 offset:1280
    s_waitcnt vmcnt(10)
    v_mfma_f32_16x16x32_bf16 v[4:7], v[132:135], v[60:63], v[4:7]
    v_mul_f32 v208, s63, v16
    v_mul_f32 v209, s63, v17
    ds_read_b128 v[56:59], v222 offset:1152
    s_waitcnt lgkmcnt(9)
    v_mfma_f32_16x16x32_bf16 v[8:11], v[132:135], v[64:67], v[8:11]
    v_mul_f32 v210, s63, v18
    ds_read_b128 v[60:63], v222 offset:1088
    v_mfma_f32_16x16x32_bf16 v[12:15], v[132:135], v[68:71], v[12:15]
    v_mul_f32 v211, s63, v19
    ds_read_b128 v[64:67], v222 offset:1344
    s_waitcnt vmcnt(9) lgkmcnt(9)
    v_mfma_f32_16x16x32_bf16 v[4:7], v[136:139], v[72:75], v[4:7]
    v_exp_f32 v208, v208
    ds_read_b128 v[68:71], v222 offset:1216
    v_mfma_f32_16x16x32_bf16 v[8:11], v[136:139], v[76:79], v[8:11]
    v_exp_f32 v209, v209
    ds_read_b128 v[72:75], v223 offset:128
    s_waitcnt lgkmcnt(9)
    v_mfma_f32_16x16x32_bf16 v[12:15], v[136:139], v[80:83], v[12:15]
    v_exp_f32 v210, v210
    ds_read_b128 v[76:79], v223 offset:384
    s_waitcnt vmcnt(8)
    v_mfma_f32_16x16x32_bf16 v[4:7], v[140:143], v[84:87], v[4:7]
    v_exp_f32 v211, v211
    ds_read_b128 v[80:83], v223 offset:256
    s_waitcnt lgkmcnt(9)
    v_mfma_f32_16x16x32_bf16 v[8:11], v[140:143], v[88:91], v[8:11]
    v_add_f32 v208, 1.0, v208
    ds_read_b128 v[84:87], v223 offset:192
    v_mfma_f32_16x16x32_bf16 v[12:15], v[140:143], v[92:95], v[12:15]
    v_add_f32 v209, 1.0, v209
    v_add_f32 v210, 1.0, v210
    ds_read_b128 v[88:91], v223 offset:448
    s_waitcnt vmcnt(7) lgkmcnt(9)
    v_mfma_f32_16x16x32_bf16 v[4:7], v[144:147], v[48:51], v[4:7]
    v_add_f32 v211, 1.0, v211
    s_setprio 1
    ds_read_b128 v[92:95], v223 offset:320
    v_mfma_f32_16x16x32_bf16 v[8:11], v[144:147], v[52:55], v[8:11]
    v_rcp_f32 v208, v208
    ds_read_b128 v[48:51], v223 offset:640
    s_waitcnt lgkmcnt(9)
    v_mfma_f32_16x16x32_bf16 v[12:15], v[144:147], v[56:59], v[12:15]
    v_rcp_f32 v209, v209
    ds_read_b128 v[52:55], v223 offset:512
    s_waitcnt vmcnt(6)
    v_mfma_f32_16x16x32_bf16 v[4:7], v[148:151], v[60:63], v[4:7]
    v_rcp_f32 v210, v210
    ds_read_b128 v[56:59], v223 offset:768
    s_waitcnt lgkmcnt(9)
    v_mfma_f32_16x16x32_bf16 v[8:11], v[148:151], v[64:67], v[8:11]
    v_rcp_f32 v211, v211
    ds_read_b128 v[60:63], v223 offset:704
    v_mfma_f32_16x16x32_bf16 v[12:15], v[148:151], v[68:71], v[12:15]
K2_PAD_T2:
    s_cbranch_execz K2_HOP
    v_cvt_pk_bf16_f32 v184, v16, v17
    ds_read_b128 v[64:67], v223 offset:576
    s_waitcnt vmcnt(5) lgkmcnt(9)
    v_mfma_f32_16x16x32_bf16 v[4:7], v[152:155], v[72:75], v[4:7]
    v_cvt_pk_bf16_f32 v185, v18, v19
    ds_read_b128 v[68:71], v223 offset:832
    v_mfma_f32_16x16x32_bf16 v[8:11], v[152:155], v[76:79], v[8:11]
    v_mul_f32 v212, s63, v32
    v_mul_f32 v213, s63, v33
    ds_read_b128 v[72:75], v223 offset:1024
    s_waitcnt lgkmcnt(9)
    v_mfma_f32_16x16x32_bf16 v[12:15], v[152:155], v[80:83], v[12:15]
    v_mul_f32 v214, s63, v34
    ds_read_b128 v[76:79], v223 offset:1280
    s_waitcnt vmcnt(4)
    v_mfma_f32_16x16x32_bf16 v[4:7], v[156:159], v[84:87], v[4:7]
    v_mul_f32 v215, s63, v35
    ds_read_b128 v[80:83], v223 offset:1152
    s_waitcnt lgkmcnt(9)
    v_mfma_f32_16x16x32_bf16 v[8:11], v[156:159], v[88:91], v[8:11]
    v_exp_f32 v212, v212
    ds_read_b128 v[84:87], v223 offset:1088
    v_mfma_f32_16x16x32_bf16 v[12:15], v[156:159], v[92:95], v[12:15]
    v_exp_f32 v213, v213
    ds_read_b128 v[88:91], v223 offset:1344
    s_waitcnt vmcnt(3) lgkmcnt(9)
    v_mfma_f32_16x16x32_bf16 v[4:7], v[160:163], v[48:51], v[4:7]
    v_exp_f32 v214, v214
    ds_read_b128 v[92:95], v223 offset:1216
    v_mfma_f32_16x16x32_bf16 v[8:11], v[160:163], v[52:55], v[8:11]
    v_exp_f32 v215, v215
    ds_read_b128 v[48:51], v222 offset:3200
    s_waitcnt lgkmcnt(9)
    v_mfma_f32_16x16x32_bf16 v[12:15], v[160:163], v[56:59], v[12:15]
    v_add_f32 v212, 1.0, v212
    ds_read_b128 v[52:55], v222 offset:3456
    s_waitcnt vmcnt(2)
    v_mfma_f32_16x16x32_bf16 v[4:7], v[164:167], v[60:63], v[4:7]
    v_add_f32 v213, 1.0, v213
    v_add_f32 v214, 1.0, v214
    ds_read_b128 v[56:59], v222 offset:3328
    s_waitcnt lgkmcnt(9)
    v_mfma_f32_16x16x32_bf16 v[8:11], v[164:167], v[64:67], v[8:11]
    v_add_f32 v215, 1.0, v215
    ds_read_b128 v[60:63], v222 offset:3264
    v_mfma_f32_16x16x32_bf16 v[12:15], v[164:167], v[68:71], v[12:15]
    v_rcp_f32 v212, v212
    s_setprio 0
    ds_read_b128 v[64:67], v222 offset:3520
    s_waitcnt vmcnt(1) lgkmcnt(9)
    v_mfma_f32_16x16x32_bf16 v[4:7], v[168:171], v[72:75], v[4:7]
    v_rcp_f32 v213, v213
    ds_read_b128 v[68:71], v222 offset:3392
    v_mfma_f32_16x16x32_bf16 v[8:11], v[168:171], v[76:79], v[8:11]
    v_rcp_f32 v214, v214
    ds_read_b128 v[72:75], v222 offset:3712
    s_waitcnt lgkmcnt(9)
    v_mfma_f32_16x16x32_bf16 v[12:15], v[168:171], v[80:83], v[12:15]
    v_rcp_f32 v215, v215
    ds_read_b128 v[76:79], v222 offset:3584
    s_waitcnt vmcnt(0)
    v_mfma_f32_16x16x32_bf16 v[4:7], v[172:175], v[84:87], v[4:7]
    v_cvt_pk_bf16_f32 v220, v32, v33
    ds_read_b128 v[80:83], v222 offset:3840
    s_waitcnt lgkmcnt(9)
    v_mfma_f32_16x16x32_bf16 v[8:11], v[172:175], v[88:91], v[8:11]
    v_cvt_pk_bf16_f32 v221, v34, v35
    ds_read_b128 v[84:87], v222 offset:3776
    v_mfma_f32_16x16x32_bf16 v[12:15], v[172:175], v[92:95], v[12:15]
    ds_read_b128 v[88:91], v222 offset:3648
    s_waitcnt lgkmcnt(9)
    v_mfma_f32_16x16x32_bf16 v[20:23], v[128:131], v[48:51], 0
    ds_read_b128 v[92:95], v222 offset:3904
    v_mfma_f32_16x16x32_bf16 v[24:27], v[128:131], v[52:55], 0
    ds_read_b128 v[48:51], v222 offset:4096
    s_waitcnt lgkmcnt(9)
    v_mfma_f32_16x16x32_bf16 v[28:31], v[128:131], v[56:59], 0
    s_barrier
    s_setprio 3
    ds_read_b128 v[52:55], v222 offset:4352
    v_mfma_f32_16x16x32_bf16 v[20:23], v[132:135], v[60:63], v[20:23]
    v_mul_f32 v4, v4, v204
    ds_read_b128 v[56:59], v222 offset:4224
    s_waitcnt lgkmcnt(9)
    v_mfma_f32_16x16x32_bf16 v[24:27], v[132:135], v[64:67], v[24:27]
    v_mul_f32 v5, v5, v205
    ds_read_b128 v[60:63], v222 offset:4160
    v_mfma_f32_16x16x32_bf16 v[28:31], v[132:135], v[68:71], v[28:31]
    v_mul_f32 v6, v6, v206
    ds_read_b128 v[64:67], v222 offset:4416
    s_waitcnt lgkmcnt(9)
    v_mfma_f32_16x16x32_bf16 v[20:23], v[136:139], v[72:75], v[20:23]
    v_mul_f32 v7, v7, v207
    ds_read_b128 v[68:71], v222 offset:4288
    v_mfma_f32_16x16x32_bf16 v[24:27], v[136:139], v[76:79], v[24:27]
    v_cvt_pk_bf16_f32 v178, v4, v5
    ds_read_b128 v[72:75], v223 offset:33408
    s_waitcnt lgkmcnt(9)
    v_mfma_f32_16x16x32_bf16 v[28:31], v[136:139], v[80:83], v[28:31]
    v_cvt_pk_bf16_f32 v179, v6, v7
    ds_read_b128 v[76:79], v223 offset:33664
    v_mfma_f32_16x16x32_bf16 v[20:23], v[140:143], v[84:87], v[20:23]
    v_mul_f32 v8, v8, v204
    ds_read_b128 v[80:83], v223 offset:33536
    s_waitcnt lgkmcnt(9)
    v_mfma_f32_16x16x32_bf16 v[24:27], v[140:143], v[88:91], v[24:27]
    v_mul_f32 v9, v9, v205
    ds_read_b128 v[84:87], v223 offset:33472
    v_mfma_f32_16x16x32_bf16 v[28:31], v[140:143], v[92:95], v[28:31]
    v_mul_f32 v10, v10, v206
    ds_read_b128 v[88:91], v223 offset:33728
    s_waitcnt lgkmcnt(9)
    v_mfma_f32_16x16x32_bf16 v[20:23], v[144:147], v[48:51], v[20:23]
    v_mul_f32 v11, v11, v207
    s_setprio 2
    ds_read_b128 v[92:95], v223 offset:33600
    v_mfma_f32_16x16x32_bf16 v[24:27], v[144:147], v[52:55], v[24:27]
    v_cvt_pk_bf16_f32 v180, v8, v9
    ds_read_b128 v[48:51], v223 offset:33920
    s_waitcnt lgkmcnt(9)
    v_mfma_f32_16x16x32_bf16 v[28:31], v[144:147], v[56:59], v[28:31]
    v_cvt_pk_bf16_f32 v181, v10, v11
    ds_read_b128 v[52:55], v223 offset:33792
    v_mfma_f32_16x16x32_bf16 v[20:23], v[148:151], v[60:63], v[20:23]
    v_mul_f32 v12, v12, v204
    ds_read_b128 v[56:59], v223 offset:34048
    s_waitcnt lgkmcnt(9)
    v_mfma_f32_16x16x32_bf16 v[24:27], v[148:151], v[64:67], v[24:27]
    v_mul_f32 v13, v13, v205
    ds_read_b128 v[60:63], v223 offset:33984
    v_mfma_f32_16x16x32_bf16 v[28:31], v[148:151], v[68:71], v[28:31]
    v_mul_f32 v14, v14, v206
    ds_read_b128 v[64:67], v223 offset:33856
    s_waitcnt lgkmcnt(9)
    v_mfma_f32_16x16x32_bf16 v[20:23], v[152:155], v[72:75], v[20:23]
    v_mul_f32 v15, v15, v207
    ds_read_b128 v[68:71], v223 offset:34112
    v_mfma_f32_16x16x32_bf16 v[24:27], v[152:155], v[76:79], v[24:27]
    v_cvt_pk_bf16_f32 v182, v12, v13
    ds_read_b128 v[72:75], v223 offset:34304
    s_waitcnt lgkmcnt(9)
    v_mfma_f32_16x16x32_bf16 v[28:31], v[152:155], v[80:83], v[28:31]
    v_cvt_pk_bf16_f32 v183, v14, v15
    ds_read_b128 v[76:79], v223 offset:34560
    v_mfma_f32_16x16x32_bf16 v[20:23], v[156:159], v[84:87], v[20:23]
    ds_write_b64 v254, v[176:177] offset:0
    ds_write_b64 v254, v[178:179] offset:256
    ds_write_b64 v254, v[180:181] offset:512
    ds_write_b64 v254, v[182:183] offset:768
    ds_write_b64 v255, v[220:221] offset:0
    ds_read_b128 v[80:83], v223 offset:34432
    s_waitcnt lgkmcnt(14)
    v_mfma_f32_16x16x32_bf16 v[24:27], v[156:159], v[88:91], v[24:27]
    ds_read_b128 v[84:87], v223 offset:34368
    v_mfma_f32_16x16x32_bf16 v[28:31], v[156:159], v[92:95], v[28:31]
    s_setprio 1
    ds_read_b128 v[88:91], v223 offset:34624
    s_waitcnt lgkmcnt(14)
    v_mfma_f32_16x16x32_bf16 v[20:23], v[160:163], v[48:51], v[20:23]
    ds_read_b128 v[92:95], v223 offset:34496
    v_mfma_f32_16x16x32_bf16 v[24:27], v[160:163], v[52:55], v[24:27]
    ds_read_b128 v[48:51], v247 offset:6272
    s_waitcnt lgkmcnt(14)
    v_mfma_f32_16x16x32_bf16 v[28:31], v[160:163], v[56:59], v[28:31]
    ds_read_b128 v[52:55], v232 offset:6528
    v_mfma_f32_16x16x32_bf16 v[20:23], v[164:167], v[60:63], v[20:23]
    ds_read_b128 v[56:59], v247 offset:6336
    s_waitcnt lgkmcnt(14)
    v_mfma_f32_16x16x32_bf16 v[24:27], v[164:167], v[64:67], v[24:27]
    ds_read_b128 v[60:63], v232 offset:6592
    v_mfma_f32_16x16x32_bf16 v[28:31], v[164:167], v[68:71], v[28:31]
    ds_read_b128 v[64:67], v247 offset:6784
    s_waitcnt lgkmcnt(14)
    v_mfma_f32_16x16x32_bf16 v[20:23], v[168:171], v[72:75], v[20:23]
    ds_read_b128 v[68:71], v232 offset:6656
    v_mfma_f32_16x16x32_bf16 v[24:27], v[168:171], v[76:79], v[24:27]
    ds_read_b128 v[72:75], v247 offset:6848
    s_waitcnt lgkmcnt(9)
    v_mfma_f32_16x16x32_bf16 v[28:31], v[168:171], v[80:83], v[28:31]
    ds_read_b128 v[76:79], v232 offset:6720
    v_mfma_f32_16x16x32_bf16 v[20:23], v[172:175], v[84:87], v[20:23]
    s_setprio 0
    ds_read_b128 v[80:83], v247 offset:7168
    s_waitcnt lgkmcnt(9)
    v_mfma_f32_16x16x32_bf16 v[24:27], v[172:175], v[88:91], v[24:27]
    ds_read_b128 v[84:87], v232 offset:7424
    v_mfma_f32_16x16x32_bf16 v[28:31], v[172:175], v[92:95], v[28:31]
    ds_read_b128 v[88:91], v247 offset:7232
    s_waitcnt lgkmcnt(9)
    v_mfma_f32_16x16x32_bf16 v[36:39], v[128:131], v[48:51], 0
    ds_read_b128 v[92:95], v232 offset:7488
    v_mfma_f32_16x16x32_bf16 v[40:43], v[128:131], v[52:55], 0
    ds_read_b128 v[48:51], v248 offset:128
    s_waitcnt lgkmcnt(9)
    v_mfma_f32_16x16x32_bf16 v[36:39], v[132:135], v[56:59], v[36:39]
    s_barrier
    ds_read_b128 v[192:195], v228 offset:0
    ds_read_b128 v[196:199], v228 offset:1536
    s_setprio 3
    ds_read_b128 v[52:55], v225 offset:384
    v_mfma_f32_16x16x32_bf16 v[40:43], v[132:135], v[60:63], v[40:43]
    v_mul_f32 v20, v20, v208
    v_mul_f32 v21, v21, v209
    ds_read_b128 v[56:59], v248 offset:192
    s_waitcnt lgkmcnt(11)
    v_mfma_f32_16x16x32_bf16 v[36:39], v[136:139], v[64:67], v[36:39]
    v_mul_f32 v22, v22, v210
    ds_read_b128 v[60:63], v225 offset:448
    v_mfma_f32_16x16x32_bf16 v[40:43], v[136:139], v[68:71], v[40:43]
    v_mul_f32 v23, v23, v211
    ds_read_b128 v[64:67], v248 offset:640
    s_waitcnt lgkmcnt(11)
    v_mfma_f32_16x16x32_bf16 v[36:39], v[140:143], v[72:75], v[36:39]
    v_cvt_pk_bf16_f32 v186, v20, v21
    ds_read_b128 v[68:71], v225 offset:512
    v_mfma_f32_16x16x32_bf16 v[40:43], v[140:143], v[76:79], v[40:43]
    v_cvt_pk_bf16_f32 v187, v22, v23
    ds_read_b128 v[72:75], v248 offset:704
    s_waitcnt lgkmcnt(11)
    v_mfma_f32_16x16x32_bf16 v[36:39], v[144:147], v[80:83], v[36:39]
    v_mul_f32 v24, v24, v208
    v_mul_f32 v25, v25, v209
    s_waitcnt lgkmcnt(6)
    buffer_store_dwordx4 v[192:195], v229, s[12:15], s40 offen sc1
    buffer_store_dwordx4 v[196:199], v229, s[12:15], s41 offen sc1
    s_setprio 2
    ds_read_b128 v[76:79], v225 offset:576
    v_mfma_f32_16x16x32_bf16 v[40:43], v[144:147], v[84:87], v[40:43]
    v_mul_f32 v26, v26, v210
    ds_read_b128 v[80:83], v248 offset:1024
    v_mfma_f32_16x16x32_bf16 v[36:39], v[148:151], v[88:91], v[36:39]
    v_mul_f32 v27, v27, v211
    ds_read_b128 v[84:87], v225 offset:1280
    v_mfma_f32_16x16x32_bf16 v[40:43], v[148:151], v[92:95], v[40:43]
    v_cvt_pk_bf16_f32 v188, v24, v25
    ds_read_b128 v[88:91], v248 offset:1088
    s_waitcnt lgkmcnt(9)
    v_mfma_f32_16x16x32_bf16 v[36:39], v[152:155], v[48:51], v[36:39]
    v_cvt_pk_bf16_f32 v189, v26, v27
    ds_read_b128 v[92:95], v225 offset:1344
    v_mfma_f32_16x16x32_bf16 v[40:43], v[152:155], v[52:55], v[40:43]
    v_mul_f32 v28, v28, v208
    v_mul_f32 v29, v29, v209
    s_waitcnt lgkmcnt(8)
    v_mfma_f32_16x16x32_bf16 v[36:39], v[156:159], v[56:59], v[36:39]
    v_mul_f32 v30, v30, v210
    v_mfma_f32_16x16x32_bf16 v[40:43], v[156:159], v[60:63], v[40:43]
    v_mul_f32 v31, v31, v211
    s_setprio 1
    s_waitcnt lgkmcnt(6)
    v_mfma_f32_16x16x32_bf16 v[36:39], v[160:163], v[64:67], v[36:39]
    v_cvt_pk_bf16_f32 v190, v28, v29
    v_mfma_f32_16x16x32_bf16 v[40:43], v[160:163], v[68:71], v[40:43]
    v_cvt_pk_bf16_f32 v191, v30, v31
    s_waitcnt lgkmcnt(4)
    v_mfma_f32_16x16x32_bf16 v[36:39], v[164:167], v[72:75], v[36:39]
    ds_write_b64 v254, v[184:185] offset:3072
    ds_write_b64 v254, v[186:187] offset:3328
    ds_write_b64 v254, v[188:189] offset:3584
    ds_write_b64 v254, v[190:191] offset:3840
    v_mfma_f32_16x16x32_bf16 v[40:43], v[164:167], v[76:79], v[40:43]
    s_waitcnt lgkmcnt(6)
    v_mfma_f32_16x16x32_bf16 v[36:39], v[168:171], v[80:83], v[36:39]
    v_mfma_f32_16x16x32_bf16 v[40:43], v[168:171], v[84:87], v[40:43]
    s_setprio 0
    s_waitcnt lgkmcnt(4)
    v_mfma_f32_16x16x32_bf16 v[36:39], v[172:175], v[88:91], v[36:39]
    v_mfma_f32_16x16x32_bf16 v[40:43], v[172:175], v[92:95], v[40:43]
    s_nop 6
    v_mul_f32 v36, v36, v212
    v_mul_f32 v37, v37, v213
    v_mul_f32 v38, v38, v214
    v_mul_f32 v39, v39, v215
    v_cvt_pk_bf16_f32 v178, v36, v37
    v_cvt_pk_bf16_f32 v179, v38, v39
    v_mul_f32 v40, v40, v212
    v_mul_f32 v41, v41, v213
    v_mul_f32 v42, v42, v214
    v_mul_f32 v43, v43, v215
    v_cvt_pk_bf16_f32 v180, v40, v41
    v_cvt_pk_bf16_f32 v181, v42, v43
    ds_write_b64 v246, v[178:179] offset:256
    ds_write_b64 v255, v[180:181] offset:512
    s_waitcnt lgkmcnt(0)
    s_barrier
    ds_read_b128 v[192:195], v228 offset:3072
    ds_read_b128 v[196:199], v228 offset:4608
    ds_read_b128 v[200:203], v249
    s_waitcnt lgkmcnt(1)
    buffer_store_dwordx4 v[192:195], v229, s[12:15], s42 offen sc1
    buffer_store_dwordx4 v[196:199], v229, s[12:15], s43 offen sc1
K2_LASTROW:
    s_add_u32 s59, s20, 32
    s_cmp_ge_u32 s59, s22
    s_cbranch_scc1 K2_FIN
    s_waitcnt lgkmcnt(0)
    buffer_store_dwordx4 v[200:203], v229, s[12:15], s44 offen sc1
K2_FIN:
    s_endpgm
K2_MULTI:
    ds_read_b128 v[48:51], v222 offset:0
    ds_read_b128 v[52:55], v222 offset:64
    ds_read_b128 v[56:59], v222 offset:896
    ds_read_b128 v[60:63], v222 offset:960
    ds_read_b128 v[64:67], v223 offset:0
    ds_read_b128 v[68:71], v223 offset:64
    ds_read_b128 v[72:75], v223 offset:896
    ds_read_b128 v[76:79], v223 offset:960
    ds_read_b128 v[80:83], v222 offset:3072
    ds_read_b128 v[84:87], v222 offset:3136
    ds_read_b128 v[88:91], v222 offset:3968
    s_waitcnt vmcnt(19) lgkmcnt(9)
    v_mfma_f32_16x16x32_bf16 v[0:3], v[96:99], v[48:51], 0
    ds_read_b128 v[92:95], v222 offset:4032
    s_waitcnt vmcnt(18)
    v_mfma_f32_16x16x32_bf16 v[0:3], v[100:103], v[52:55], v[0:3]
    ds_read_b128 v[48:51], v223 offset:33280
    s_waitcnt vmcnt(17) lgkmcnt(9)
    v_mfma_f32_16x16x32_bf16 v[0:3], v[104:107], v[56:59], v[0:3]
    ds_read_b128 v[52:55], v223 offset:33344
    s_waitcnt vmcnt(16)
    v_mfma_f32_16x16x32_bf16 v[0:3], v[108:111], v[60:63], v[0:3]
    ds_read_b128 v[56:59], v223 offset:34176
    s_waitcnt vmcnt(15) lgkmcnt(9)
    v_mfma_f32_16x16x32_bf16 v[0:3], v[112:115], v[64:67], v[0:3]
    ds_read_b128 v[60:63], v223 offset:34240
    s_waitcnt vmcnt(14)
    v_mfma_f32_16x16x32_bf16 v[0:3], v[116:119], v[68:71], v[0:3]
    ds_read_b128 v[64:67], v232 offset:6144
    s_waitcnt vmcnt(13) lgkmcnt(9)
    v_mfma_f32_16x16x32_bf16 v[0:3], v[120:123], v[72:75], v[0:3]
    ds_read_b128 v[68:71], v232 offset:6208
    s_waitcnt vmcnt(12)
    v_mfma_f32_16x16x32_bf16 v[0:3], v[124:127], v[76:79], v[0:3]
    ds_read_b128 v[72:75], v232 offset:7040
    s_waitcnt lgkmcnt(9)
    v_mfma_f32_16x16x32_bf16 v[16:19], v[96:99], v[80:83], 0
    ds_read_b128 v[76:79], v232 offset:7104
    v_mfma_f32_16x16x32_bf16 v[16:19], v[100:103], v[84:87], v[16:19]
    ds_read_b128 v[80:83], v225 offset:0
    s_waitcnt lgkmcnt(9)
    v_mfma_f32_16x16x32_bf16 v[16:19], v[104:107], v[88:91], v[16:19]
    ds_read_b128 v[84:87], v225 offset:64
    v_mfma_f32_16x16x32_bf16 v[16:19], v[108:111], v[92:95], v[16:19]
    ds_read_b128 v[88:91], v225 offset:896
    s_waitcnt lgkmcnt(9)
    v_mfma_f32_16x16x32_bf16 v[16:19], v[112:115], v[48:51], v[16:19]
    ds_read_b128 v[92:95], v225 offset:960
    v_mfma_f32_16x16x32_bf16 v[16:19], v[116:119], v[52:55], v[16:19]
    ds_read_b128 v[48:51], v222 offset:128
    s_waitcnt lgkmcnt(9)
    v_mfma_f32_16x16x32_bf16 v[16:19], v[120:123], v[56:59], v[16:19]
    ds_read_b128 v[52:55], v222 offset:384
    v_mfma_f32_16x16x32_bf16 v[16:19], v[124:127], v[60:63], v[16:19]
    ds_read_b128 v[56:59], v222 offset:256
    s_waitcnt lgkmcnt(9)
    v_mfma_f32_16x16x32_bf16 v[32:35], v[96:99], v[64:67], 0
    ds_read_b128 v[60:63], v222 offset:192
    v_mfma_f32_16x16x32_bf16 v[32:35], v[100:103], v[68:71], v[32:35]
    ds_read_b128 v[64:67], v222 offset:448
    s_waitcnt lgkmcnt(9)
    v_mfma_f32_16x16x32_bf16 v[32:35], v[104:107], v[72:75], v[32:35]
    ds_read_b128 v[68:71], v222 offset:320
    v_mfma_f32_16x16x32_bf16 v[32:35], v[108:111], v[76:79], v[32:35]
    ds_read_b128 v[72:75], v222 offset:640
    s_waitcnt lgkmcnt(9)
    v_mfma_f32_16x16x32_bf16 v[32:35], v[112:115], v[80:83], v[32:35]
    ds_read_b128 v[76:79], v222 offset:512
    v_mfma_f32_16x16x32_bf16 v[32:35], v[116:119], v[84:87], v[32:35]
    ds_read_b128 v[80:83], v222 offset:768
    s_waitcnt lgkmcnt(9)
    v_mfma_f32_16x16x32_bf16 v[32:35], v[120:123], v[88:91], v[32:35]
    ds_read_b128 v[84:87], v222 offset:704
    v_mfma_f32_16x16x32_bf16 v[32:35], v[124:127], v[92:95], v[32:35]
    ds_read_b128 v[88:91], v222 offset:576
    s_waitcnt vmcnt(11) lgkmcnt(9)
    v_mfma_f32_16x16x32_bf16 v[4:7], v[128:131], v[48:51], 0
    ds_read_b128 v[92:95], v222 offset:832
    v_mfma_f32_16x16x32_bf16 v[8:11], v[128:131], v[52:55], 0
    ds_read_b128 v[48:51], v222 offset:1024
    s_waitcnt lgkmcnt(9)
    v_mfma_f32_16x16x32_bf16 v[12:15], v[128:131], v[56:59], 0
    ds_read_b128 v[52:55], v222 offset:1280
    s_waitcnt vmcnt(10)
    v_mfma_f32_16x16x32_bf16 v[4:7], v[132:135], v[60:63], v[4:7]
    ds_read_b128 v[56:59], v222 offset:1152
    s_waitcnt lgkmcnt(9)
    v_mfma_f32_16x16x32_bf16 v[8:11], v[132:135], v[64:67], v[8:11]
    ds_read_b128 v[60:63], v222 offset:1088
    v_mfma_f32_16x16x32_bf16 v[12:15], v[132:135], v[68:71], v[12:15]
    ds_read_b128 v[64:67], v222 offset:1344
    s_waitcnt vmcnt(9) lgkmcnt(9)
    v_mfma_f32_16x16x32_bf16 v[4:7], v[136:139], v[72:75], v[4:7]
    ds_read_b128 v[68:71], v222 offset:1216
    v_mfma_f32_16x16x32_bf16 v[8:11], v[136:139], v[76:79], v[8:11]
    ds_read_b128 v[72:75], v223 offset:128
    s_waitcnt lgkmcnt(9)
    v_mfma_f32_16x16x32_bf16 v[12:15], v[136:139], v[80:83], v[12:15]
    ds_read_b128 v[76:79], v223 offset:384
    s_waitcnt vmcnt(8)
    v_mfma_f32_16x16x32_bf16 v[4:7], v[140:143], v[84:87], v[4:7]
    ds_read_b128 v[80:83], v223 offset:256
    s_waitcnt lgkmcnt(9)
    v_mfma_f32_16x16x32_bf16 v[8:11], v[140:143], v[88:91], v[8:11]
    ds_read_b128 v[84:87], v223 offset:192
    v_mfma_f32_16x16x32_bf16 v[12:15], v[140:143], v[92:95], v[12:15]
    ds_read_b128 v[88:91], v223 offset:448
    s_waitcnt vmcnt(7) lgkmcnt(9)
    v_mfma_f32_16x16x32_bf16 v[4:7], v[144:147], v[48:51], v[4:7]
    ds_read_b128 v[92:95], v223 offset:320
    v_mfma_f32_16x16x32_bf16 v[8:11], v[144:147], v[52:55], v[8:11]
    ds_read_b128 v[48:51], v223 offset:640
    s_waitcnt lgkmcnt(9)
    v_mfma_f32_16x16x32_bf16 v[12:15], v[144:147], v[56:59], v[12:15]
    ds_read_b128 v[52:55], v223 offset:512
    s_waitcnt vmcnt(6)
    v_mfma_f32_16x16x32_bf16 v[4:7], v[148:151], v[60:63], v[4:7]
    ds_read_b128 v[56:59], v223 offset:768
    s_waitcnt lgkmcnt(9)
    v_mfma_f32_16x16x32_bf16 v[8:11], v[148:151], v[64:67], v[8:11]
    ds_read_b128 v[60:63], v223 offset:704
    v_mfma_f32_16x16x32_bf16 v[12:15], v[148:151], v[68:71], v[12:15]
    ds_read_b128 v[64:67], v223 offset:576
    s_waitcnt vmcnt(5) lgkmcnt(9)
    v_mfma_f32_16x16x32_bf16 v[4:7], v[152:155], v[72:75], v[4:7]
    ds_read_b128 v[68:71], v223 offset:832
    v_mfma_f32_16x16x32_bf16 v[8:11], v[152:155], v[76:79], v[8:11]
    ds_read_b128 v[72:75], v223 offset:1024
    s_waitcnt lgkmcnt(9)
    v_mfma_f32_16x16x32_bf16 v[12:15], v[152:155], v[80:83], v[12:15]
    ds_read_b128 v[76:79], v223 offset:1280
    s_waitcnt vmcnt(4)
    v_mfma_f32_16x16x32_bf16 v[4:7], v[156:159], v[84:87], v[4:7]
    ds_read_b128 v[80:83], v223 offset:1152
    s_waitcnt lgkmcnt(9)
    v_mfma_f32_16x16x32_bf16 v[8:11], v[156:159], v[88:91], v[8:11]
    ds_read_b128 v[84:87], v223 offset:1088
    v_mfma_f32_16x16x32_bf16 v[12:15], v[156:159], v[92:95], v[12:15]
    ds_read_b128 v[88:91], v223 offset:1344
    s_waitcnt vmcnt(3) lgkmcnt(9)
    v_mfma_f32_16x16x32_bf16 v[4:7], v[160:163], v[48:51], v[4:7]
    ds_read_b128 v[92:95], v223 offset:1216
    v_mfma_f32_16x16x32_bf16 v[8:11], v[160:163], v[52:55], v[8:11]
    ds_read_b128 v[48:51], v222 offset:3200
    s_waitcnt lgkmcnt(9)
    v_mfma_f32_16x16x32_bf16 v[12:15], v[160:163], v[56:59], v[12:15]
    ds_read_b128 v[52:55], v222 offset:3456
    s_waitcnt vmcnt(2)
    v_mfma_f32_16x16x32_bf16 v[4:7], v[164:167], v[60:63], v[4:7]
    ds_read_b128 v[56:59], v222 offset:3328
    s_waitcnt lgkmcnt(9)
    v_mfma_f32_16x16x32_bf16 v[8:11], v[164:167], v[64:67], v[8:11]
    ds_read_b128 v[60:63], v222 offset:3264
    v_mfma_f32_16x16x32_bf16 v[12:15], v[164:167], v[68:71], v[12:15]
    ds_read_b128 v[64:67], v222 offset:3520
    s_waitcnt vmcnt(1) lgkmcnt(9)
    v_mfma_f32_16x16x32_bf16 v[4:7], v[168:171], v[72:75], v[4:7]
    ds_read_b128 v[68:71], v222 offset:3392
    v_mfma_f32_16x16x32_bf16 v[8:11], v[168:171], v[76:79], v[8:11]
    ds_read_b128 v[72:75], v222 offset:3712
    s_waitcnt lgkmcnt(9)
    v_mfma_f32_16x16x32_bf16 v[12:15], v[168:171], v[80:83], v[12:15]
    ds_read_b128 v[76:79], v222 offset:3584
    s_waitcnt vmcnt(0)
    v_mfma_f32_16x16x32_bf16 v[4:7], v[172:175], v[84:87], v[4:7]
    ds_read_b128 v[80:83], v222 offset:3840
    s_waitcnt lgkmcnt(9)
    v_mfma_f32_16x16x32_bf16 v[8:11], v[172:175], v[88:91], v[8:11]
    ds_read_b128 v[84:87], v222 offset:3776
    v_mfma_f32_16x16x32_bf16 v[12:15], v[172:175], v[92:95], v[12:15]
    ds_read_b128 v[88:91], v222 offset:3648
    s_waitcnt lgkmcnt(9)
    v_mfma_f32_16x16x32_bf16 v[20:23], v[128:131], v[48:51], 0
    ds_read_b128 v[92:95], v222 offset:3904
    v_mfma_f32_16x16x32_bf16 v[24:27], v[128:131], v[52:55], 0
    ds_read_b128 v[48:51], v222 offset:4096
    s_waitcnt lgkmcnt(9)
    v_mfma_f32_16x16x32_bf16 v[28:31], v[128:131], v[56:59], 0
    ds_read_b128 v[52:55], v222 offset:4352
    v_mfma_f32_16x16x32_bf16 v[20:23], v[132:135], v[60:63], v[20:23]
    ds_read_b128 v[56:59], v222 offset:4224
    s_waitcnt lgkmcnt(9)
    v_mfma_f32_16x16x32_bf16 v[24:27], v[132:135], v[64:67], v[24:27]
    ds_read_b128 v[60:63], v222 offset:4160
    v_mfma_f32_16x16x32_bf16 v[28:31], v[132:135], v[68:71], v[28:31]
    ds_read_b128 v[64:67], v222 offset:4416
    s_waitcnt lgkmcnt(9)
    v_mfma_f32_16x16x32_bf16 v[20:23], v[136:139], v[72:75], v[20:23]
    ds_read_b128 v[68:71], v222 offset:4288
    v_mfma_f32_16x16x32_bf16 v[24:27], v[136:139], v[76:79], v[24:27]
    ds_read_b128 v[72:75], v223 offset:33408
    s_waitcnt lgkmcnt(9)
    v_mfma_f32_16x16x32_bf16 v[28:31], v[136:139], v[80:83], v[28:31]
    ds_read_b128 v[76:79], v223 offset:33664
    v_mfma_f32_16x16x32_bf16 v[20:23], v[140:143], v[84:87], v[20:23]
    ds_read_b128 v[80:83], v223 offset:33536
    s_waitcnt lgkmcnt(9)
    v_mfma_f32_16x16x32_bf16 v[24:27], v[140:143], v[88:91], v[24:27]
    ds_read_b128 v[84:87], v223 offset:33472
    v_mfma_f32_16x16x32_bf16 v[28:31], v[140:143], v[92:95], v[28:31]
    ds_read_b128 v[88:91], v223 offset:33728
    s_waitcnt lgkmcnt(9)
    v_mfma_f32_16x16x32_bf16 v[20:23], v[144:147], v[48:51], v[20:23]
    ds_read_b128 v[92:95], v223 offset:33600
    v_mfma_f32_16x16x32_bf16 v[24:27], v[144:147], v[52:55], v[24:27]
    ds_read_b128 v[48:51], v223 offset:33920
    s_waitcnt lgkmcnt(9)
    v_mfma_f32_16x16x32_bf16 v[28:31], v[144:147], v[56:59], v[28:31]
    ds_read_b128 v[52:55], v223 offset:33792
    v_mfma_f32_16x16x32_bf16 v[20:23], v[148:151], v[60:63], v[20:23]
    ds_read_b128 v[56:59], v223 offset:34048
    s_waitcnt lgkmcnt(9)
    v_mfma_f32_16x16x32_bf16 v[24:27], v[148:151], v[64:67], v[24:27]
    ds_read_b128 v[60:63], v223 offset:33984
    v_mfma_f32_16x16x32_bf16 v[28:31], v[148:151], v[68:71], v[28:31]
    ds_read_b128 v[64:67], v223 offset:33856
    s_waitcnt lgkmcnt(9)
    v_mfma_f32_16x16x32_bf16 v[20:23], v[152:155], v[72:75], v[20:23]
    ds_read_b128 v[68:71], v223 offset:34112
    v_mfma_f32_16x16x32_bf16 v[24:27], v[152:155], v[76:79], v[24:27]
    ds_read_b128 v[72:75], v223 offset:34304
    s_waitcnt lgkmcnt(9)
    v_mfma_f32_16x16x32_bf16 v[28:31], v[152:155], v[80:83], v[28:31]
    ds_read_b128 v[76:79], v223 offset:34560
    v_mfma_f32_16x16x32_bf16 v[20:23], v[156:159], v[84:87], v[20:23]
    ds_read_b128 v[80:83], v223 offset:34432
    s_waitcnt lgkmcnt(9)
    v_mfma_f32_16x16x32_bf16 v[24:27], v[156:159], v[88:91], v[24:27]
    ds_read_b128 v[84:87], v223 offset:34368
    v_mfma_f32_16x16x32_bf16 v[28:31], v[156:159], v[92:95], v[28:31]
    ds_read_b128 v[88:91], v223 offset:34624
    s_waitcnt lgkmcnt(9)
    v_mfma_f32_16x16x32_bf16 v[20:23], v[160:163], v[48:51], v[20:23]
    ds_read_b128 v[92:95], v223 offset:34496
    v_mfma_f32_16x16x32_bf16 v[24:27], v[160:163], v[52:55], v[24:27]
    ds_read_b128 v[48:51], v247 offset:6272
    s_waitcnt lgkmcnt(9)
    v_mfma_f32_16x16x32_bf16 v[28:31], v[160:163], v[56:59], v[28:31]
    ds_read_b128 v[52:55], v232 offset:6528
    v_mfma_f32_16x16x32_bf16 v[20:23], v[164:167], v[60:63], v[20:23]
    ds_read_b128 v[56:59], v247 offset:6336
    s_waitcnt lgkmcnt(9)
    v_mfma_f32_16x16x32_bf16 v[24:27], v[164:167], v[64:67], v[24:27]
    ds_read_b128 v[60:63], v232 offset:6592
    v_mfma_f32_16x16x32_bf16 v[28:31], v[164:167], v[68:71], v[28:31]
    ds_read_b128 v[64:67], v247 offset:6784
    s_waitcnt lgkmcnt(9)
    v_mfma_f32_16x16x32_bf16 v[20:23], v[168:171], v[72:75], v[20:23]
    ds_read_b128 v[68:71], v232 offset:6656
    v_mfma_f32_16x16x32_bf16 v[24:27], v[168:171], v[76:79], v[24:27]
    ds_read_b128 v[72:75], v247 offset:6848
    s_waitcnt lgkmcnt(9)
    v_mfma_f32_16x16x32_bf16 v[28:31], v[168:171], v[80:83], v[28:31]
    ds_read_b128 v[76:79], v232 offset:6720
    v_mfma_f32_16x16x32_bf16 v[20:23], v[172:175], v[84:87], v[20:23]
    ds_read_b128 v[80:83], v247 offset:7168
    s_waitcnt lgkmcnt(9)
    v_mfma_f32_16x16x32_bf16 v[24:27], v[172:175], v[88:91], v[24:27]
    ds_read_b128 v[84:87], v232 offset:7424
    v_mfma_f32_16x16x32_bf16 v[28:31], v[172:175], v[92:95], v[28:31]
    ds_read_b128 v[88:91], v247 offset:7232
    s_waitcnt lgkmcnt(9)
    v_mfma_f32_16x16x32_bf16 v[36:39], v[128:131], v[48:51], 0
    ds_read_b128 v[92:95], v232 offset:7488
    v_mfma_f32_16x16x32_bf16 v[40:43], v[128:131], v[52:55], 0
    ds_read_b128 v[48:51], v248 offset:128
    s_waitcnt lgkmcnt(9)
    v_mfma_f32_16x16x32_bf16 v[36:39], v[132:135], v[56:59], v[36:39]
    ds_read_b128 v[52:55], v225 offset:384
    v_mfma_f32_16x16x32_bf16 v[40:43], v[132:135], v[60:63], v[40:43]
    ds_read_b128 v[56:59], v248 offset:192
    s_waitcnt lgkmcnt(9)
    v_mfma_f32_16x16x32_bf16 v[36:39], v[136:139], v[64:67], v[36:39]
    ds_read_b128 v[60:63], v225 offset:448
    v_mfma_f32_16x16x32_bf16 v[40:43], v[136:139], v[68:71], v[40:43]
    ds_read_b128 v[64:67], v248 offset:640
    s_waitcnt lgkmcnt(9)
    v_mfma_f32_16x16x32_bf16 v[36:39], v[140:143], v[72:75], v[36:39]
    ds_read_b128 v[68:71], v225 offset:512
    v_mfma_f32_16x16x32_bf16 v[40:43], v[140:143], v[76:79], v[40:43]
    ds_read_b128 v[72:75], v248 offset:704
    s_waitcnt lgkmcnt(9)
    v_mfma_f32_16x16x32_bf16 v[36:39], v[144:147], v[80:83], v[36:39]
    ds_read_b128 v[76:79], v225 offset:576
    v_mfma_f32_16x16x32_bf16 v[40:43], v[144:147], v[84:87], v[40:43]
    ds_read_b128 v[80:83], v248 offset:1024
    s_waitcnt lgkmcnt(9)
    v_mfma_f32_16x16x32_bf16 v[36:39], v[148:151], v[88:91], v[36:39]
    ds_read_b128 v[84:87], v225 offset:1280
    v_mfma_f32_16x16x32_bf16 v[40:43], v[148:151], v[92:95], v[40:43]
    ds_read_b128 v[88:91], v248 offset:1088
    s_waitcnt lgkmcnt(9)
    v_mfma_f32_16x16x32_bf16 v[36:39], v[152:155], v[48:51], v[36:39]
    ds_read_b128 v[92:95], v225 offset:1344
    v_mfma_f32_16x16x32_bf16 v[40:43], v[152:155], v[52:55], v[40:43]
    s_waitcnt lgkmcnt(8)
    v_mfma_f32_16x16x32_bf16 v[36:39], v[156:159], v[56:59], v[36:39]
    v_mfma_f32_16x16x32_bf16 v[40:43], v[156:159], v[60:63], v[40:43]
    s_waitcnt lgkmcnt(6)
    v_mfma_f32_16x16x32_bf16 v[36:39], v[160:163], v[64:67], v[36:39]
    v_mfma_f32_16x16x32_bf16 v[40:43], v[160:163], v[68:71], v[40:43]
    s_waitcnt lgkmcnt(4)
    v_mfma_f32_16x16x32_bf16 v[36:39], v[164:167], v[72:75], v[36:39]
    v_mfma_f32_16x16x32_bf16 v[40:43], v[164:167], v[76:79], v[40:43]
    s_waitcnt lgkmcnt(2)
    v_mfma_f32_16x16x32_bf16 v[36:39], v[168:171], v[80:83], v[36:39]
    v_mfma_f32_16x16x32_bf16 v[40:43], v[168:171], v[84:87], v[40:43]
    s_waitcnt lgkmcnt(0)
    v_mfma_f32_16x16x32_bf16 v[36:39], v[172:175], v[88:91], v[36:39]
    v_mfma_f32_16x16x32_bf16 v[40:43], v[172:175], v[92:95], v[40:43]
    s_lshl_b32 s60, s54, 9
    s_lshl_b32 s61, s20, 6
    s_add_u32 s60, s60, s61
    s_mul_i32 s60, s60, 192
    s_add_u32 s60, s60, 10485760
    v_mul_u32_u24 v227, 96, v252
    s_cmp_lg_u32 s28, 0
    s_cbranch_scc1 K2_NOACC
    buffer_load_dwordx4 v[48:51], v227, s[8:11], s60 offen offset:0
    buffer_load_dwordx4 v[52:55], v227, s[8:11], s60 offen offset:16
    buffer_load_dwordx4 v[56:59], v227, s[8:11], s60 offen offset:32
    buffer_load_dwordx4 v[60:63], v227, s[8:11], s60 offen offset:48
    buffer_load_dwordx4 v[64:67], v227, s[8:11], s60 offen offset:64
    buffer_load_dwordx4 v[68:71], v227, s[8:11], s60 offen offset:80
    buffer_load_dwordx4 v[72:75], v227, s[8:11], s60 offen offset:96
    buffer_load_dwordx4 v[76:79], v227, s[8:11], s60 offen offset:112
    buffer_load_dwordx4 v[80:83], v227, s[8:11], s60 offen offset:128
    buffer_load_dwordx4 v[84:87], v227, s[8:11], s60 offen offset:144
    buffer_load_dwordx4 v[88:91], v227, s[8:11], s60 offen offset:160
    s_waitcnt vmcnt(0)
    v_add_f32 v0, v0, v48
    v_add_f32 v1, v1, v49
    v_add_f32 v2, v2, v50
    v_add_f32 v3, v3, v51
    v_add_f32 v4, v4, v52
    v_add_f32 v5, v5, v53
    v_add_f32 v6, v6, v54
    v_add_f32 v7, v7, v55
    v_add_f32 v8, v8, v56
    v_add_f32 v9, v9, v57
    v_add_f32 v10, v10, v58
    v_add_f32 v11, v11, v59
    v_add_f32 v12, v12, v60
    v_add_f32 v13, v13, v61
    v_add_f32 v14, v14, v62
    v_add_f32 v15, v15, v63
    v_add_f32 v16, v16, v64
    v_add_f32 v17, v17, v65
    v_add_f32 v18, v18, v66
    v_add_f32 v19, v19, v67
    v_add_f32 v20, v20, v68
    v_add_f32 v21, v21, v69
    v_add_f32 v22, v22, v70
    v_add_f32 v23, v23, v71
    v_add_f32 v24, v24, v72
    v_add_f32 v25, v25, v73
    v_add_f32 v26, v26, v74
    v_add_f32 v27, v27, v75
    v_add_f32 v28, v28, v76
    v_add_f32 v29, v29, v77
    v_add_f32 v30, v30, v78
    v_add_f32 v31, v31, v79
    v_add_f32 v32, v32, v80
    v_add_f32 v33, v33, v81
    v_add_f32 v34, v34, v82
    v_add_f32 v35, v35, v83
    v_add_f32 v36, v36, v84
    v_add_f32 v37, v37, v85
    v_add_f32 v38, v38, v86
    v_add_f32 v39, v39, v87
    v_add_f32 v40, v40, v88
    v_add_f32 v41, v41, v89
    v_add_f32 v42, v42, v90
    v_add_f32 v43, v43, v91
K2_NOACC:
    s_barrier
    s_cmp_eq_u32 s55, 0
    s_cbranch_scc1 K2_SPILL
    s_bfe_u32 s60, s20, 0x10002
    s_lshl_b32 s60, s60, 4
    s_add_u32 s59, s59, s60
    v_add_u32 v228, s59, v229
    s_mul_i32 s60, s20, 2080
    s_add_u32 s60, s60, 65536
    v_add_u32 v249, s60, v229
    s_mov_b32 s63, 0xbfb8aa3b
    s_add_u32 s40, s20, s21
    s_lshl_b32 s40, s40, 10
    s_add_u32 s41, s40, 8192
    s_add_u32 s42, s40, 16384
    s_add_u32 s43, s40, 24576
    s_add_u32 s44, s40, 32768
    v_mul_f32 v204, s63, v0
    v_mul_f32 v205, s63, v1
    v_mul_f32 v206, s63, v2
    v_mul_f32 v207, s63, v3
    v_exp_f32 v204, v204
    v_exp_f32 v205, v205
    v_exp_f32 v206, v206
    v_exp_f32 v207, v207
    v_add_f32 v204, 1.0, v204
    v_add_f32 v205, 1.0, v205
    v_add_f32 v206, 1.0, v206
    v_add_f32 v207, 1.0, v207
    v_rcp_f32 v204, v204
    v_rcp_f32 v205, v205
    v_rcp_f32 v206, v206
    v_rcp_f32 v207, v207
    v_cvt_pk_bf16_f32 v176, v0, v1
    v_cvt_pk_bf16_f32 v177, v2, v3
    v_mul_f32 v4, v4, v204
    v_mul_f32 v5, v5, v205
    v_mul_f32 v6, v6, v206
    v_mul_f32 v7, v7, v207
    v_cvt_pk_bf16_f32 v178, v4, v5
    v_cvt_pk_bf16_f32 v179, v6, v7
    v_mul_f32 v8, v8, v204
    v_mul_f32 v9, v9, v205
    v_mul_f32 v10, v10, v206
    v_mul_f32 v11, v11, v207
    v_cvt_pk_bf16_f32 v180, v8, v9
    v_cvt_pk_bf16_f32 v181, v10, v11
    v_mul_f32 v12, v12, v204
    v_mul_f32 v13, v13, v205
    v_mul_f32 v14, v14, v206
    v_mul_f32 v15, v15, v207
    v_cvt_pk_bf16_f32 v182, v12, v13
    v_cvt_pk_bf16_f32 v183, v14, v15
    ds_write_b64 v254, v[176:177] offset:0
    ds_write_b64 v254, v[178:179] offset:256
    ds_write_b64 v254, v[180:181] offset:512
    ds_write_b64 v254, v[182:183] offset:768
    s_waitcnt lgkmcnt(0)
    s_barrier
    ds_read_b128 v[192:195], v228 offset:0
    ds_read_b128 v[196:199], v228 offset:1536
    s_waitcnt lgkmcnt(0)
    buffer_store_dwordx4 v[192:195], v229, s[12:15], s40 offen sc1
    buffer_store_dwordx4 v[196:199], v229, s[12:15], s41 offen sc1
    v_mul_f32 v208, s63, v16
    v_mul_f32 v209, s63, v17
    v_mul_f32 v210, s63, v18
    v_mul_f32 v211, s63, v19
    v_exp_f32 v208, v208
    v_exp_f32 v209, v209
    v_exp_f32 v210, v210
    v_exp_f32 v211, v211
    v_add_f32 v208, 1.0, v208
    v_add_f32 v209, 1.0, v209
    v_add_f32 v210, 1.0, v210
    v_add_f32 v211, 1.0, v211
    v_rcp_f32 v208, v208
    v_rcp_f32 v209, v209
    v_rcp_f32 v210, v210
    v_rcp_f32 v211, v211
    v_cvt_pk_bf16_f32 v184, v16, v17
    v_cvt_pk_bf16_f32 v185, v18, v19
    v_mul_f32 v20, v20, v208
    v_mul_f32 v21, v21, v209
    v_mul_f32 v22, v22, v210
    v_mul_f32 v23, v23, v211
    v_cvt_pk_bf16_f32 v186, v20, v21
    v_cvt_pk_bf16_f32 v187, v22, v23
    v_mul_f32 v24, v24, v208
    v_mul_f32 v25, v25, v209
    v_mul_f32 v26, v26, v210
    v_mul_f32 v27, v27, v211
    v_cvt_pk_bf16_f32 v188, v24, v25
    v_cvt_pk_bf16_f32 v189, v26, v27
    v_mul_f32 v28, v28, v208
    v_mul_f32 v29, v29, v209
    v_mul_f32 v30, v30, v210
    v_mul_f32 v31, v31, v211
    v_cvt_pk_bf16_f32 v190, v28, v29
    v_cvt_pk_bf16_f32 v191, v30, v31
    ds_write_b64 v254, v[184:185] offset:3072
    ds_write_b64 v254, v[186:187] offset:3328
    ds_write_b64 v254, v[188:189] offset:3584
    ds_write_b64 v254, v[190:191] offset:3840
    s_waitcnt lgkmcnt(0)
    s_barrier
    ds_read_b128 v[192:195], v228 offset:3072
    ds_read_b128 v[196:199], v228 offset:4608
    s_waitcnt lgkmcnt(0)
    buffer_store_dwordx4 v[192:195], v229, s[12:15], s42 offen sc1
    buffer_store_dwordx4 v[196:199], v229, s[12:15], s43 offen sc1
    v_mul_f32 v212, s63, v32
    v_mul_f32 v213, s63, v33
    v_mul_f32 v214, s63, v34
    v_mul_f32 v215, s63, v35
    v_exp_f32 v212, v212
    v_exp_f32 v213, v213
    v_exp_f32 v214, v214
    v_exp_f32 v215, v215
    v_add_f32 v212, 1.0, v212
    v_add_f32 v213, 1.0, v213
    v_add_f32 v214, 1.0, v214
    v_add_f32 v215, 1.0, v215
    v_rcp_f32 v212, v212
    v_rcp_f32 v213, v213
    v_rcp_f32 v214, v214
    v_rcp_f32 v215, v215
    v_cvt_pk_bf16_f32 v220, v32, v33
    v_cvt_pk_bf16_f32 v221, v34, v35
    v_mul_f32 v36, v36, v212
    v_mul_f32 v37, v37, v213
    v_mul_f32 v38, v38, v214
    v_mul_f32 v39, v39, v215
    v_cvt_pk_bf16_f32 v178, v36, v37
    v_cvt_pk_bf16_f32 v179, v38, v39
    v_mul_f32 v40, v40, v212
    v_mul_f32 v41, v41, v213
    v_mul_f32 v42, v42, v214
    v_mul_f32 v43, v43, v215
    v_cvt_pk_bf16_f32 v180, v40, v41
    v_cvt_pk_bf16_f32 v181, v42, v43
    ds_write_b64 v255, v[220:221] offset:0
    ds_write_b64 v246, v[178:179] offset:256
    ds_write_b64 v255, v[180:181] offset:512
    s_waitcnt lgkmcnt(0)
    s_barrier
    ds_read_b128 v[200:203], v249
    s_branch K2_LASTROW
K2_SPILL:
    buffer_store_dwordx4 v[0:3], v227, s[8:11], s60 offen offset:0
    buffer_store_dwordx4 v[4:7], v227, s[8:11], s60 offen offset:16
    buffer_store_dwordx4 v[8:11], v227, s[8:11], s60 offen offset:32
    buffer_store_dwordx4 v[12:15], v227, s[8:11], s60 offen offset:48
    buffer_store_dwordx4 v[16:19], v227, s[8:11], s60 offen offset:64
    buffer_store_dwordx4 v[20:23], v227, s[8:11], s60 offen offset:80
    buffer_store_dwordx4 v[24:27], v227, s[8:11], s60 offen offset:96
    buffer_store_dwordx4 v[28:31], v227, s[8:11], s60 offen offset:112
    buffer_store_dwordx4 v[32:35], v227, s[8:11], s60 offen offset:128
    buffer_store_dwordx4 v[36:39], v227, s[8:11], s60 offen offset:144
    buffer_store_dwordx4 v[40:43], v227, s[8:11], s60 offen offset:160
    s_mov_b32 s28, 0
    s_waitcnt vmcnt(0)
    s_cmp_lt_u32 s24, s25
    s_cbranch_scc1 K2_LOAD
    s_add_u32 s23, s23, 20
    s_branch K2_WINDOW
K2_WINDOW:
    s_mov_b32 s24, 0
    s_mov_b32 s25, 1
K2_LOAD:
    v_mbcnt_lo_u32_b32 v176, -1, 0
    v_mbcnt_hi_u32_b32 v176, -1, v176
    s_lshl_b32 s58, s20, 6
    v_add_u32 v177, s58, v176
    v_lshlrev_b32 v70, 4, v176
    s_mov_b32 s58, 7110656
    buffer_load_dwordx4 v[136:139], v70, s[8:11], s58 offen offset:0 sc1
    buffer_load_dwordx4 v[140:143], v70, s[8:11], s58 offen offset:1024 sc1
    s_mov_b32 s58, 7112704
    buffer_load_dwordx4 v[144:147], v70, s[8:11], s58 offen offset:0 sc1
    buffer_load_dwordx4 v[148:151], v70, s[8:11], s58 offen offset:1024 sc1
    s_mov_b32 s58, 7114752
    buffer_load_dwordx4 v[152:155], v70, s[8:11], s58 offen offset:0 sc1
    buffer_load_dwordx4 v[156:159], v70, s[8:11], s58 offen offset:1024 sc1
    s_mov_b32 s58, 7116800
    buffer_load_dwordx4 v[160:163], v70, s[8:11], s58 offen offset:0 sc1
    buffer_load_dwordx4 v[164:167], v70, s[8:11], s58 offen offset:1024 sc1
    s_mov_b32 s58, 7118848
    buffer_load_dwordx4 v[168:171], v70, s[8:11], s58 offen offset:0 sc1
    buffer_load_dwordx4 v[172:175], v70, s[8:11], s58 offen offset:1024 sc1
    s_mul_i32 s58, s20, 10400
    s_add_u32 s58, s58, 65536
    s_add_u32 s59, s58, 512
    v_and_b32 v76, 31, v176
    v_lshrrev_b32 v77, 5, v176
    v_cmp_le_u32 vcc, 24, v76
    v_mul_u32_u24 v77, 2080, v77
    v_lshl_add_u32 v78, v76, 4, v77
    v_cndmask_b32 v80, 0, -1, vcc
    v_add_u32 v78, s58, v78
    v_mov_b32 v81, v80
    v_mov_b32 v82, v80
    v_mov_b32 v83, v80
    v_add_u32 v85, 16, v176
    v_lshlrev_b32 v84, 5, v176
    v_lshrrev_b32 v85, 6, v85
    v_mul_u32_u24 v85, 1532, v85
    v_sub_u32 v84, v84, v85
    v_mov_b32 v85, -1
    v_add_u32 v84, s59, v84
    ds_write_b32 v84, v85 offset:0
    ds_write_b32 v84, v85 offset:2080
    ds_write_b32 v84, v85 offset:4160
    ds_write_b32 v84, v85 offset:6240
    ds_write_b32 v84, v85 offset:8320
    s_mov_b32 exec_hi, 0
    ds_write_b128 v78, v[80:83] offset:0
    ds_write_b128 v78, v[80:83] offset:2080
    ds_write_b128 v78, v[80:83] offset:4160
    ds_write_b128 v78, v[80:83] offset:6240
    ds_write_b128 v78, v[80:83] offset:8320
    s_mov_b32 exec_hi, -1
    s_cmp_lg_u32 s20, 7
    s_cbranch_scc1 K2_NOH
    v_mov_b32 v76, 0
    v_mov_b32 v77, -1
    v_lshlrev_b32 v78, 2, v176
    v_add_u32 v78, 163072, v78
    s_mov_b64 exec, 0x1ff
    ds_write_b32 v78, v76 offset:192
    s_mov_b64 exec, 0xff
    ds_write_b32 v78, v77 offset:256
    s_mov_b64 exec, -1
    s_cmp_lg_u32 s24, 0
    s_cbranch_scc1 K2_NOH
    s_mov_b32 exec_hi, 0xffff
    ds_write_b32 v78, v76
    s_mov_b64 exec, 1
    ds_write_b32 v78, v76 offset:228
    s_mov_b64 exec, -1
K2_NOH:
    s_waitcnt lgkmcnt(0)
    s_barrier
    s_branch K2_CELLS
K2_LD_GEN:
    s_mov_b64 exec, s[42:43]
    s_cbranch_execz K2_LD_DONE
    buffer_load_dwordx4 v[4:7], v182, s[8:11], 0 offen sc1
    s_mov_b64 exec, s[44:45]
    s_cbranch_execz K2_LD_DONE
    buffer_load_dwordx4 v[8:11], v183, s[8:11], 0 offen sc1
    s_mov_b64 exec, s[46:47]
    s_cbranch_execz K2_LD_DONE
    buffer_load_dwordx4 v[12:15], v184, s[8:11], 0 offen sc1
    s_mov_b64 exec, s[48:49]
    s_cbranch_execz K2_LD_DONE
    buffer_load_dwordx4 v[16:19], v181, s[8:11], 0 offen offset:128 sc1
    s_mov_b64 exec, s[50:51]
    s_cbranch_execz K2_LD_DONE
    buffer_load_dwordx4 v[20:23], v181, s[8:11], 0 offen offset:160 sc1
    s_mov_b64 exec, s[90:91]
    s_cbranch_execz K2_LD_DONE
    buffer_load_dwordx4 v[24:27], v181, s[8:11], 0 offen offset:192 sc1
    s_mov_b64 exec, s[92:93]
    s_cbranch_execz K2_LD_DONE
    buffer_load_dwordx4 v[28:31], v181, s[8:11], 0 offen offset:224 sc1
    s_mov_b64 exec, s[94:95]
    s_cbranch_execz K2_LD_DONE
    buffer_load_dwordx4 v[32:35], v181, s[8:11], 0 offen offset:256 sc1
    s_mov_b64 exec, s[96:97]
    s_cbranch_execz K2_LD_DONE
    buffer_load_dwordx4 v[36:39], v181, s[8:11], 0 offen offset:288 sc1
    s_branch K2_LD_DONE
K2_WLATE:
    s_waitcnt vmcnt(0)
    s_branch K2_WUNP
K2_RT0:
    s_sub_u32 s60, s60, 1
    s_cbranch_scc1 K2_END
    buffer_load_dwordx4 v[0:3], v181, s[8:11], 0 offen offset:0 sc1
    s_waitcnt vmcnt(0)
    s_branch K2_CK0
K2_RT1:
    s_sub_u32 s60, s60, 1
    s_cbranch_scc1 K2_END
    buffer_load_dwordx4 v[4:7], v182, s[8:11], 0 offen sc1
    s_waitcnt vmcnt(0)
    s_branch K2_CK1
K2_RT2:
    s_sub_u32 s60, s60, 1
    s_cbranch_scc1 K2_END
    buffer_load_dwordx4 v[8:11], v183, s[8:11], 0 offen sc1
    s_waitcnt vmcnt(0)
    s_branch K2_CK2
K2_RT3:
    s_sub_u32 s60, s60, 1
    s_cbranch_scc1 K2_END
    buffer_load_dwordx4 v[12:15], v184, s[8:11], 0 offen sc1
    s_waitcnt vmcnt(0)
    s_branch K2_CK3
K2_RT4:
    s_sub_u32 s60, s60, 1
    s_cbranch_scc1 K2_END
    buffer_load_dwordx4 v[16:19], v181, s[8:11], 0 offen offset:128 sc1
    s_waitcnt vmcnt(0)
    s_branch K2_CK4
K2_RT5:
    s_sub_u32 s60, s60, 1
    s_cbranch_scc1 K2_END
    buffer_load_dwordx4 v[20:23], v181, s[8:11], 0 offen offset:160 sc1
    s_waitcnt vmcnt(0)
    s_branch K2_CK5
K2_RT6:
    s_sub_u32 s60, s60, 1
    s_cbranch_scc1 K2_END
    buffer_load_dwordx4 v[24:27], v181, s[8:11], 0 offen offset:192 sc1
    s_waitcnt vmcnt(0)
    s_branch K2_CK6
K2_RT7:
    s_sub_u32 s60, s60, 1
    s_cbranch_scc1 K2_END
    buffer_load_dwordx4 v[28:31], v181, s[8:11], 0 offen offset:224 sc1
    s_waitcnt vmcnt(0)
    s_branch K2_CK7
K2_RT8:
    s_sub_u32 s60, s60, 1
    s_cbranch_scc1 K2_END
    buffer_load_dwordx4 v[32:35], v181, s[8:11], 0 offen offset:256 sc1
    s_waitcnt vmcnt(0)
    s_branch K2_CK8
K2_RT9:
    s_sub_u32 s60, s60, 1
    s_cbranch_scc1 K2_END
    buffer_load_dwordx4 v[36:39], v181, s[8:11], 0 offen offset:288 sc1
    s_waitcnt vmcnt(0)
    s_branch K2_CK9
K2_RK_LOAD:
    s_waitcnt vmcnt(0)
    s_mov_b64 exec, s[40:41]
    s_cbranch_execz K2_RK_B
    v_lshrrev_b32 v50, 24, v3
    buffer_load_dword v40, v179, s[8:11], s66 offen offset:0
    v_mad_u32_u24 v50, v50, s58, v202
    v_and_b32 v3, 0xffffff, v3
    s_mov_b64 exec, s[42:43]
    s_cbranch_execz K2_RK_B
    v_lshrrev_b32 v51, 24, v7
    buffer_load_dword v41, v185, s[8:11], s66 offen
    v_mad_u32_u24 v51, v51, s58, v202
    v_and_b32 v7, 0xffffff, v7
    s_mov_b64 exec, s[44:45]
    s_cbranch_execz K2_RK_B
    v_lshrrev_b32 v52, 24, v11
    buffer_load_dword v42, v186, s[8:11], s66 offen
    v_mad_u32_u24 v52, v52, s58, v202
    v_and_b32 v11, 0xffffff, v11
    s_mov_b64 exec, s[46:47]
    s_cbranch_execz K2_RK_B
    v_lshrrev_b32 v53, 24, v15
    buffer_load_dword v43, v187, s[8:11], s66 offen
    v_mad_u32_u24 v53, v53, s58, v202
    v_and_b32 v15, 0xffffff, v15
    s_mov_b64 exec, s[48:49]
    s_cbranch_execz K2_RK_B
    v_lshrrev_b32 v54, 24, v19
    buffer_load_dword v44, v179, s[8:11], s66 offen offset:32
    v_mad_u32_u24 v54, v54, s58, v202
    v_and_b32 v19, 0xffffff, v19
    s_mov_b64 exec, s[50:51]
    s_cbranch_execz K2_RK_B
    v_lshrrev_b32 v55, 24, v23
    buffer_load_dword v45, v179, s[8:11], s66 offen offset:40
    v_mad_u32_u24 v55, v55, s58, v202
    v_and_b32 v23, 0xffffff, v23
    s_mov_b64 exec, s[90:91]
    s_cbranch_execz K2_RK_B
    v_lshrrev_b32 v56, 24, v27
    buffer_load_dword v46, v179, s[8:11], s66 offen offset:48
    v_mad_u32_u24 v56, v56, s58, v202
    v_and_b32 v27, 0xffffff, v27
    s_mov_b64 exec, s[92:93]
    s_cbranch_execz K2_RK_B
    v_lshrrev_b32 v57, 24, v31
    buffer_load_dword v47, v179, s[8:11], s66 offen offset:56
    v_mad_u32_u24 v57, v57, s58, v202
    v_and_b32 v31, 0xffffff, v31
    s_mov_b64 exec, s[94:95]
    s_cbranch_execz K2_RK_B
    v_lshrrev_b32 v58, 24, v35
    buffer_load_dword v48, v179, s[8:11], s66 offen offset:64
    v_mad_u32_u24 v58, v58, s58, v202
    v_and_b32 v35, 0xffffff, v35
    s_mov_b64 exec, s[96:97]
    s_cbranch_execz K2_RK_B
    v_lshrrev_b32 v59, 24, v39
    buffer_load_dword v49, v179, s[8:11], s66 offen offset:72
    v_mad_u32_u24 v59, v59, s58, v202
    v_and_b32 v39, 0xffffff, v39
K2_RK_B:
    s_mov_b64 exec, -1
    s_mul_i32 s62, s24, 48
    s_waitcnt vmcnt(0)
    v_subrev_u32 v40, s62, v40
    v_subrev_u32 v41, s62, v41
    v_subrev_u32 v42, s62, v42
    v_subrev_u32 v43, s62, v43
    v_subrev_u32 v44, s62, v44
    v_subrev_u32 v45, s62, v45
    v_subrev_u32 v46, s62, v46
    v_subrev_u32 v47, s62, v47
    v_subrev_u32 v48, s62, v48
    v_subrev_u32 v49, s62, v49
    s_branch K2_RK_DONE
K2_BIG:
    s_cmp_lg_u32 s24, 0
    s_cbranch_scc1 K2_TOK
    s_movk_i32 s26, 48
    v_mov_b32 v197, v193
    s_nop 1
    v_max_u32_dpp v197, v197, v197 row_shr:1 row_mask:0xf bank_mask:0xf bound_ctrl:0
    s_nop 1
    v_max_u32_dpp v197, v197, v197 row_shr:2 row_mask:0xf bank_mask:0xf bound_ctrl:0
    s_nop 1
    v_max_u32_dpp v197, v197, v197 row_shr:4 row_mask:0xf bank_mask:0xf bound_ctrl:0
    s_nop 1
    v_max_u32_dpp v197, v197, v197 row_shr:8 row_mask:0xf bank_mask:0xf bound_ctrl:0
    s_nop 1
    v_max_u32_dpp v197, v197, v197 row_bcast:15 row_mask:0xa bank_mask:0xf
    s_nop 1
    v_max_u32_dpp v197, v197, v197 row_bcast:31 row_mask:0xc bank_mask:0xf
    s_nop 0
    v_readlane_b32 s25, v197, 63
    s_nop 0
    s_add_u32 s25, s25, 47
    s_mul_i32 s25, s25, 43691
    s_lshr_b32 s25, s25, 21
    s_mov_b64 exec, s[40:41]
    s_cbranch_execz K2_SV_DONE
    buffer_store_dword v40, v179, s[8:11], s66 offen offset:0
    s_mov_b64 exec, s[42:43]
    s_cbranch_execz K2_SV_DONE
    buffer_store_dword v41, v185, s[8:11], s66 offen
    s_mov_b64 exec, s[44:45]
    s_cbranch_execz K2_SV_DONE
    buffer_store_dword v42, v186, s[8:11], s66 offen
    s_mov_b64 exec, s[46:47]
    s_cbranch_execz K2_SV_DONE
    buffer_store_dword v43, v187, s[8:11], s66 offen
    s_mov_b64 exec, s[48:49]
    s_cbranch_execz K2_SV_DONE
    buffer_store_dword v44, v179, s[8:11], s66 offen offset:32
    s_mov_b64 exec, s[50:51]
    s_cbranch_execz K2_SV_DONE
    buffer_store_dword v45, v179, s[8:11], s66 offen offset:40
    s_mov_b64 exec, s[90:91]
    s_cbranch_execz K2_SV_DONE
    buffer_store_dword v46, v179, s[8:11], s66 offen offset:48
    s_mov_b64 exec, s[92:93]
    s_cbranch_execz K2_SV_DONE
    buffer_store_dword v47, v179, s[8:11], s66 offen offset:56
    s_mov_b64 exec, s[94:95]
    s_cbranch_execz K2_SV_DONE
    buffer_store_dword v48, v179, s[8:11], s66 offen offset:64
    s_mov_b64 exec, s[96:97]
    s_cbranch_execz K2_SV_DONE
    buffer_store_dword v49, v179, s[8:11], s66 offen offset:72
K2_SV_DONE:
    s_mov_b64 exec, -1
    s_branch K2_TOK
K2_rare_1:
    s_cmp_eq_u32 s33, 4
    s_cbranch_scc1 K2_four_3
    s_mov_b32 s49, s48
    s_mov_b32 s51, s48
    s_add_u32 s45, s44, 256
    s_add_u32 s46, s44, 512
    s_add_u32 s47, s44, 768
    s_branch K2_back_2
K2_four_3:
    s_add_u32 s50, s48, 64
    s_add_u32 s51, s48, 96
    s_mov_b32 s46, s44
    s_mov_b32 s47, s44
    s_branch K2_back_2
K2_a4_5:
    v_add_u32 v254, s48, v230
    ds_read_b32 v254, v254 offset:4
    s_lshr_b32 s65, s3, 27
    s_mul_i32 s66, s22, 2080
    s_lshl_b32 s65, s65, 9
    s_add_u32 s65, s65, s66
    s_add_u32 s65, s65, 65536
    s_mov_b32 m0, s65
    s_mov_b32 exec_hi, 0
    s_waitcnt lgkmcnt(0)
    v_or_b32 v254, v254, v231
    buffer_load_dwordx4 v254, s[16:19], 0 offen  lds
    s_mov_b32 exec_hi, -1
    s_branch K2_b4_7
K2_rare_14:
    s_cmp_eq_u32 s33, 4
    s_cbranch_scc1 K2_four_16
    s_mov_b32 s49, s48
    s_mov_b32 s51, s48
    s_add_u32 s45, s44, 256
    s_add_u32 s46, s44, 512
    s_add_u32 s47, s44, 768
    s_branch K2_back_15
K2_four_16:
    s_add_u32 s50, s48, 64
    s_add_u32 s51, s48, 96
    s_mov_b32 s46, s44
    s_mov_b32 s47, s44
    s_branch K2_back_15
K2_a4_18:
    v_add_u32 v254, s48, v230
    ds_read_b32 v254, v254 offset:4
    s_lshr_b32 s65, s3, 27
    s_mul_i32 s66, s22, 2080
    s_lshl_b32 s65, s65, 9
    s_add_u32 s65, s65, s66
    s_add_u32 s65, s65, 65536
    s_mov_b32 m0, s65
    s_mov_b32 exec_hi, 0
    s_waitcnt lgkmcnt(0)
    v_or_b32 v254, v254, v231
    buffer_load_dwordx4 v254, s[16:19], 0 offen  lds
    s_mov_b32 exec_hi, -1
    s_branch K2_b4_20
K2_rare_27:
    s_cmp_eq_u32 s33, 4
    s_cbranch_scc1 K2_four_29
    s_mov_b32 s49, s48
    s_mov_b32 s51, s48
    s_add_u32 s45, s44, 256
    s_add_u32 s46, s44, 512
    s_add_u32 s47, s44, 768
    s_branch K2_back_28
K2_four_29:
    s_add_u32 s50, s48, 64
    s_add_u32 s51, s48, 96
    s_mov_b32 s46, s44
    s_mov_b32 s47, s44
    s_branch K2_back_28
K2_a4_31:
    v_add_u32 v254, s48, v230
    ds_read_b32 v254, v254 offset:4
    s_lshr_b32 s65, s3, 27
    s_mul_i32 s66, s22, 2080
    s_lshl_b32 s65, s65, 9
    s_add_u32 s65, s65, s66
    s_add_u32 s65, s65, 65536
    s_mov_b32 m0, s65
    s_mov_b32 exec_hi, 0
    s_waitcnt lgkmcnt(0)
    v_or_b32 v254, v254, v231
    buffer_load_dwordx4 v254, s[16:19], 0 offen  lds
    s_mov_b32 exec_hi, -1
    s_branch K2_b4_33
K2_rare_38:
    s_cmp_eq_u32 s33, 4
    s_cbranch_scc1 K2_four_40
    s_mov_b32 s49, s48
    s_mov_b32 s51, s48
    s_add_u32 s45, s44, 256
    s_add_u32 s46, s44, 512
    s_add_u32 s47, s44, 768
    s_branch K2_back_39
K2_four_40:
    s_add_u32 s50, s48, 64
    s_add_u32 s51, s48, 96
    s_mov_b32 s46, s44
    s_mov_b32 s47, s44
    s_branch K2_back_39
K2_rare_45:
    s_cmp_eq_u32 s33, 4
    s_cbranch_scc1 K2_four_47
    s_mov_b32 s49, s48
    s_mov_b32 s51, s48
    s_add_u32 s45, s44, 256
    s_add_u32 s46, s44, 512
    s_add_u32 s47, s44, 768
    s_branch K2_back_46
K2_four_47:
    s_add_u32 s50, s48, 64
    s_add_u32 s51, s48, 96
    s_mov_b32 s46, s44
    s_mov_b32 s47, s44
    s_branch K2_back_46
K2_U10:
    s_setprio 1
    s_add_u32 s38, s38, 1
    v_mov_b32 v254, s52
    v_mov_b32 v255, s38
    s_lshl_b32 s58, s38, 3
    s_add_u32 s58, s58, s20
    s_mov_b64 exec, 1
    ds_write_b32 v254, v255
    s_mov_b64 exec, -1
    s_cmp_lt_u32 s58, s22
    s_cbranch_scc0 K2_dyn_48
K2_back_49:
    s_waitcnt lgkmcnt(4)
    v_lshlrev_b32 v20, 16, v0
    v_and_b32 v21, 0xffff0000, v0
    v_lshlrev_b32 v22, 16, v1
    v_and_b32 v23, 0xffff0000, v1
    v_lshlrev_b32 v24, 16, v2
    v_and_b32 v25, 0xffff0000, v2
    v_lshlrev_b32 v26, 16, v3
    v_and_b32 v27, 0xffff0000, v3
    v_mul_f32_dpp v36, v16, v20 row_newbcast:8 row_mask:0xf bank_mask:0xf
    v_mul_f32_dpp v37, v16, v21 row_newbcast:9 row_mask:0xf bank_mask:0xf
    v_mul_f32_dpp v38, v16, v22 row_newbcast:10 row_mask:0xf bank_mask:0xf
    v_mul_f32_dpp v39, v16, v23 row_newbcast:11 row_mask:0xf bank_mask:0xf
    v_mul_f32_dpp v40, v16, v24 row_newbcast:12 row_mask:0xf bank_mask:0xf
    v_mul_f32_dpp v41, v16, v25 row_newbcast:13 row_mask:0xf bank_mask:0xf
    v_mul_f32_dpp v42, v16, v26 row_newbcast:14 row_mask:0xf bank_mask:0xf
    v_mul_f32_dpp v43, v16, v27 row_newbcast:15 row_mask:0xf bank_mask:0xf
    v_cvt_pk_bf16_f32 v68, v36, v37
    v_cvt_pk_bf16_f32 v69, v38, v39
    v_cvt_pk_bf16_f32 v70, v40, v41
    v_cvt_pk_bf16_f32 v71, v42, v43
    v_mul_f32_dpp v20, v16, v20 row_newbcast:0 row_mask:0xa bank_mask:0xf
    v_mul_f32_dpp v21, v16, v21 row_newbcast:1 row_mask:0xa bank_mask:0xf
    v_mul_f32_dpp v22, v16, v22 row_newbcast:2 row_mask:0xa bank_mask:0xf
    v_mul_f32_dpp v23, v16, v23 row_newbcast:3 row_mask:0xa bank_mask:0xf
    v_mul_f32_dpp v24, v16, v24 row_newbcast:4 row_mask:0xa bank_mask:0xf
    v_mul_f32_dpp v25, v16, v25 row_newbcast:5 row_mask:0xa bank_mask:0xf
    v_mul_f32_dpp v26, v16, v26 row_newbcast:6 row_mask:0xa bank_mask:0xf
    v_mul_f32_dpp v27, v16, v27 row_newbcast:7 row_mask:0xa bank_mask:0xf
    v_cvt_pk_bf16_f32 v64, v20, v21
    v_cvt_pk_bf16_f32 v65, v22, v23
    v_cvt_pk_bf16_f32 v66, v24, v25
    v_cvt_pk_bf16_f32 v67, v26, v27
    v_readlane_b32 s3, v253, s58
    s_lshl_b32 s44, s34, 7
    s_and_b32 s48, s3, 0x3ffff
    s_bfe_u32 s33, s3, 0x30012
    s_mul_i32 s35, s38, 6
    s_cmp_eq_u32 s34, 0
    s_cselect_b32 s35, s35, s48
    s_mov_b32 s45, s44
    s_add_u32 s47, s44, 256
    s_add_u32 s49, s48, 32
    s_add_u32 s60, s48, 64
    s_cmp_eq_u32 s33, 3
    s_cselect_b32 s46, s44, s47
    s_cselect_b32 s50, s60, s48
    s_cselect_b32 s51, s48, s49
    s_sub_u32 s60, s33, 2
    s_cmp_lt_u32 s60, 2
    s_cbranch_scc0 K2_rare_54
K2_back_55:
    v_add_u32 v233, s48, v230
    ds_read_b32 v232, v233
    ds_read_b32 v233, v233 offset:1024
    v_add_u32 v222, s48, v251
    ds_read_b32 v222, v222
    v_add_u32 v224, s49, v251
    ds_read_b32 v224, v224
    v_add_u32 v226, s50, v251
    ds_read_b32 v226, v226
    v_add_u32 v228, s51, v251
    ds_read_b32 v228, v228
    s_waitcnt lgkmcnt(4)
    v_or_b32 v232, v232, v231
    v_or_b32 v233, v233, v231
    s_cmp_lg_u32 s34, 0
    s_cbranch_scc1 K2_dum_57
    s_cmp_eq_u32 s33, 4
    s_cbranch_scc1 K2_a4_58
K2_b4_60:
    s_add_u32 m0, s48, 512
    s_add_u32 s65, s48, 1536
    buffer_load_dwordx4 v232, s[16:19], 0 offen  lds
    s_mov_b32 m0, s65
    s_mov_b32 exec_hi, 0
    buffer_load_dwordx4 v233, s[16:19], 0 offen  lds
    s_mov_b32 exec_hi, -1
K2_back_59:
    s_waitcnt lgkmcnt(3)
    v_mad_u32_u16 v223, v222, s39, v248 op_sel:[1,0,0,0]
    v_mad_u32_u16 v222, v222, s39, v248
    s_waitcnt lgkmcnt(2)
    v_mad_u32_u16 v225, v224, s39, v248 op_sel:[1,0,0,0]
    v_mad_u32_u16 v224, v224, s39, v248
    s_waitcnt lgkmcnt(1)
    v_mad_u32_u16 v227, v226, s39, v248 op_sel:[1,0,0,0]
    v_mad_u32_u16 v226, v226, s39, v248
    s_waitcnt lgkmcnt(0)
    v_mad_u32_u16 v229, v228, s39, v248 op_sel:[1,0,0,0]
    v_mad_u32_u16 v228, v228, s39, v248
    s_waitcnt vmcnt(6)
    v_mfma_f32_32x32x16_bf16 v[0:15], v[64:67], v[176:179], 0
    ds_read_b64_tr_b16 v[184:185], v246 offset:2048
    ds_read_b64_tr_b16 v[186:187], v246 offset:2560
    ds_read_b64_tr_b16 v[188:189], v247 offset:2048
    ds_read_b64_tr_b16 v[190:191], v247 offset:2560
    s_mov_b32 m0, s68
    v_mfma_f32_32x32x16_bf16 v[16:31], v[68:71], v[176:179], 0
    buffer_load_dwordx4 v222, s[4:7], s44 offen sc1 lds
    buffer_load_dwordx4 v223, s[72:75], s44 offen offset:1024 sc1 lds
    v_permlane32_swap_b32 v242, v236
    v_permlane32_swap_b32 v243, v237
    v_mfma_f32_32x32x16_bf16 v[32:47], v[64:67], v[180:183], 0
    v_permlane32_swap_b32 v244, v238
    v_permlane32_swap_b32 v245, v239
    v_permlane32_swap_b32 v240, v241
    v_add_f32 v242, v242, v236
    v_mfma_f32_32x32x16_bf16 v[48:63], v[68:71], v[180:183], 0
    s_setprio 0
    v_add_f32 v243, v243, v237
    v_add_f32 v244, v244, v238
    v_add_f32 v245, v245, v239
    v_add_f32 v240, -v240, -v241
    s_set_gpr_idx_on s32, gpr_idx(DST)
    s_nop 0
    v_cvt_pk_bf16_f32 v195, v242, v243
    v_cvt_pk_bf16_f32 v196, v244, v245
    v_cvt_pk_bf16_f32 v197, v240, v240
    s_set_gpr_idx_off
    v_mul_f32 v234, v0, v96
    v_mul_f32 v236, v8, v128
    v_fmac_f32 v234, v1, v97
    v_fmac_f32 v236, v9, v129
    v_fmac_f32 v234, v2, v98
    v_fmac_f32 v236, v10, v130
    v_fmac_f32 v234, v3, v99
    v_fmac_f32 v236, v11, v131
    v_fmac_f32 v234, v4, v100
    v_fmac_f32 v236, v12, v132
    v_fmac_f32 v234, v5, v101
    v_fmac_f32 v236, v13, v133
    v_fmac_f32 v234, v6, v102
    v_fmac_f32 v236, v14, v134
    v_fmac_f32 v234, v7, v103
    v_fmac_f32 v236, v15, v135
    v_mul_f32 v238, v16, v128
    v_mul_f32 v240, v24, v128
    v_fmac_f32 v238, v17, v129
    v_fmac_f32 v240, v25, v129
    v_fmac_f32 v238, v18, v130
    v_fmac_f32 v240, v26, v130
    v_fmac_f32 v238, v19, v131
    v_fmac_f32 v240, v27, v131
    v_fmac_f32 v238, v20, v132
    v_fmac_f32 v240, v28, v132
    v_fmac_f32 v238, v21, v133
    v_fmac_f32 v240, v29, v133
    v_fmac_f32 v238, v22, v134
    v_fmac_f32 v240, v30, v134
    v_fmac_f32 v238, v23, v135
    v_fmac_f32 v240, v31, v135
    v_mul_f32 v235, v32, v104
    v_mul_f32 v237, v40, v136
    v_fmac_f32 v235, v33, v105
    v_fmac_f32 v237, v41, v137
    v_fmac_f32 v235, v34, v106
    v_fmac_f32 v237, v42, v138
    v_fmac_f32 v235, v35, v107
    v_fmac_f32 v237, v43, v139
    v_fmac_f32 v235, v36, v108
    v_fmac_f32 v237, v44, v140
    v_fmac_f32 v235, v37, v109
    v_fmac_f32 v237, v45, v141
    v_fmac_f32 v235, v38, v110
    v_fmac_f32 v237, v46, v142
    v_fmac_f32 v235, v39, v111
    v_fmac_f32 v237, v47, v143
    v_mul_f32 v239, v48, v136
    v_mul_f32 v241, v56, v136
    v_fmac_f32 v239, v49, v137
    v_fmac_f32 v241, v57, v137
    v_fmac_f32 v239, v50, v138
    v_fmac_f32 v241, v58, v138
    v_fmac_f32 v239, v51, v139
    v_fmac_f32 v241, v59, v139
    v_fmac_f32 v239, v52, v140
    v_fmac_f32 v241, v60, v140
    v_fmac_f32 v239, v53, v141
    v_fmac_f32 v241, v61, v141
    v_fmac_f32 v239, v54, v142
    v_fmac_f32 v241, v62, v142
    v_fmac_f32 v239, v55, v143
    v_fmac_f32 v241, v63, v143
    s_setprio 1
    s_waitcnt vmcnt(6) lgkmcnt(0)
    v_mfma_f32_32x32x16_bf16 v[0:15], v[64:67], v[184:187], 0
    ds_read_b64_tr_b16 v[176:177], v246 offset:4096
    ds_read_b64_tr_b16 v[178:179], v246 offset:4608
    ds_read_b64_tr_b16 v[180:181], v247 offset:4096
    ds_read_b64_tr_b16 v[182:183], v247 offset:4608
    s_mov_b32 m0, s69
    v_mfma_f32_32x32x16_bf16 v[16:31], v[68:71], v[184:187], 0
    buffer_load_dwordx4 v224, s[4:7], s45 offen sc1 lds
    buffer_load_dwordx4 v225, s[72:75], s45 offen offset:1024 sc1 lds
    v_permlane32_swap_b32 v234, v236
    v_permlane32_swap_b32 v235, v237
    v_mfma_f32_32x32x16_bf16 v[32:47], v[64:67], v[188:191], 0
    v_permlane32_swap_b32 v240, v238
    v_permlane32_swap_b32 v241, v239
    v_add_f32 v234, v234, v236
    v_add_f32 v235, v235, v237
    v_add_f32 v240, v240, v238
    v_mfma_f32_32x32x16_bf16 v[48:63], v[68:71], v[188:191], 0
    s_setprio 0
    v_add_f32 v241, v241, v239
    s_set_gpr_idx_on s31, gpr_idx(DST)
    s_nop 0
    v_cvt_pk_bf16_f32 v192, v234, v235
    v_cvt_pk_bf16_f32 v193, v240, v241
    s_set_gpr_idx_off
    v_mul_f32 v234, v0, v144
    v_mul_f32 v236, v8, v112
    v_fmac_f32 v234, v1, v145
    v_fmac_f32 v236, v9, v113
    v_fmac_f32 v234, v2, v146
    v_fmac_f32 v236, v10, v114
    v_fmac_f32 v234, v3, v147
    v_fmac_f32 v236, v11, v115
    v_fmac_f32 v234, v4, v148
    v_fmac_f32 v236, v12, v116
    v_fmac_f32 v234, v5, v149
    v_fmac_f32 v236, v13, v117
    v_fmac_f32 v234, v6, v150
    v_fmac_f32 v236, v14, v118
    v_fmac_f32 v234, v7, v151
    v_fmac_f32 v236, v15, v119
    v_mul_f32 v238, v16, v160
    v_mul_f32 v240, v24, v160
    v_fmac_f32 v238, v17, v161
    v_fmac_f32 v240, v25, v161
    v_fmac_f32 v238, v18, v162
    v_fmac_f32 v240, v26, v162
    v_fmac_f32 v238, v19, v163
    v_fmac_f32 v240, v27, v163
    v_fmac_f32 v238, v20, v164
    v_fmac_f32 v240, v28, v164
    v_fmac_f32 v238, v21, v165
    v_fmac_f32 v240, v29, v165
    v_fmac_f32 v238, v22, v166
    v_fmac_f32 v240, v30, v166
    v_fmac_f32 v238, v23, v167
    v_fmac_f32 v240, v31, v167
    v_mul_f32 v235, v32, v152
    v_mul_f32 v237, v40, v120
    v_fmac_f32 v235, v33, v153
    v_fmac_f32 v237, v41, v121
    v_fmac_f32 v235, v34, v154
    v_fmac_f32 v237, v42, v122
    v_fmac_f32 v235, v35, v155
    v_fmac_f32 v237, v43, v123
    v_fmac_f32 v235, v36, v156
    v_fmac_f32 v237, v44, v124
    v_fmac_f32 v235, v37, v157
    v_fmac_f32 v237, v45, v125
    v_fmac_f32 v235, v38, v158
    v_fmac_f32 v237, v46, v126
    v_fmac_f32 v235, v39, v159
    v_fmac_f32 v237, v47, v127
    v_mul_f32 v239, v48, v168
    v_mul_f32 v241, v56, v168
    v_fmac_f32 v239, v49, v169
    v_fmac_f32 v241, v57, v169
    v_fmac_f32 v239, v50, v170
    v_fmac_f32 v241, v58, v170
    v_fmac_f32 v239, v51, v171
    v_fmac_f32 v241, v59, v171
    v_fmac_f32 v239, v52, v172
    v_fmac_f32 v241, v60, v172
    v_fmac_f32 v239, v53, v173
    v_fmac_f32 v241, v61, v173
    v_fmac_f32 v239, v54, v174
    v_fmac_f32 v241, v62, v174
    v_fmac_f32 v239, v55, v175
    v_fmac_f32 v241, v63, v175
    s_setprio 1
    s_waitcnt vmcnt(6) lgkmcnt(0)
    v_mfma_f32_32x32x16_bf16 v[0:15], v[64:67], v[176:179], 0
    ds_read_b64_tr_b16 v[184:185], v246 offset:6144
    ds_read_b64_tr_b16 v[186:187], v246 offset:6656
    ds_read_b64_tr_b16 v[188:189], v247 offset:6144
    ds_read_b64_tr_b16 v[190:191], v247 offset:6656
    s_mov_b32 m0, s70
    v_mfma_f32_32x32x16_bf16 v[16:31], v[68:71], v[176:179], 0
    buffer_load_dwordx4 v226, s[4:7], s46 offen sc1 lds
    buffer_load_dwordx4 v227, s[72:75], s46 offen offset:1024 sc1 lds
    s_sub_u32 s26, s48, s29
    s_mov_b32 s29, s48
    s_mov_b32 s30, s3
    s_cmp_eq_u32 s34, 0
    s_cselect_b32 s56, s33, 0
    v_mfma_f32_32x32x16_bf16 v[32:47], v[64:67], v[180:183], 0
    v_mfma_f32_32x32x16_bf16 v[48:63], v[68:71], v[180:183], 0
    s_setprio 0
    v_mul_f32 v242, v0, v144
    v_fma_f32 v238, v8, v160, -v238
    v_fmac_f32 v242, v1, v145
    v_fmac_f32 v238, v9, v161
    v_fmac_f32 v242, v2, v146
    v_fmac_f32 v238, v10, v162
    v_fmac_f32 v242, v3, v147
    v_fmac_f32 v238, v11, v163
    v_fmac_f32 v242, v4, v148
    v_fmac_f32 v238, v12, v164
    v_fmac_f32 v242, v5, v149
    v_fmac_f32 v238, v13, v165
    v_fmac_f32 v242, v6, v150
    v_fmac_f32 v238, v14, v166
    v_fmac_f32 v242, v7, v151
    v_fmac_f32 v238, v15, v167
    v_fmac_f32 v236, v16, v112
    v_mul_f32 v244, v24, v160
    v_fmac_f32 v236, v17, v113
    v_fmac_f32 v244, v25, v161
    v_fmac_f32 v236, v18, v114
    v_fmac_f32 v244, v26, v162
    v_fmac_f32 v236, v19, v115
    v_fmac_f32 v244, v27, v163
    v_fmac_f32 v236, v20, v116
    v_fmac_f32 v244, v28, v164
    v_fmac_f32 v236, v21, v117
    v_fmac_f32 v244, v29, v165
    v_fmac_f32 v236, v22, v118
    v_fmac_f32 v244, v30, v166
    v_fmac_f32 v236, v23, v119
    v_fmac_f32 v244, v31, v167
    v_mul_f32 v243, v32, v152
    v_fma_f32 v239, v40, v168, -v239
    v_fmac_f32 v243, v33, v153
    v_fmac_f32 v239, v41, v169
    v_fmac_f32 v243, v34, v154
    v_fmac_f32 v239, v42, v170
    v_fmac_f32 v243, v35, v155
    v_fmac_f32 v239, v43, v171
    v_fmac_f32 v243, v36, v156
    v_fmac_f32 v239, v44, v172
    v_fmac_f32 v243, v37, v157
    v_fmac_f32 v239, v45, v173
    v_fmac_f32 v243, v38, v158
    v_fmac_f32 v239, v46, v174
    v_fmac_f32 v243, v39, v159
    v_fmac_f32 v239, v47, v175
    v_fmac_f32 v237, v48, v120
    v_mul_f32 v245, v56, v168
    v_fmac_f32 v237, v49, v121
    v_fmac_f32 v245, v57, v169
    v_fmac_f32 v237, v50, v122
    v_fmac_f32 v245, v58, v170
    v_fmac_f32 v237, v51, v123
    v_fmac_f32 v245, v59, v171
    v_fmac_f32 v237, v52, v124
    v_fmac_f32 v245, v60, v172
    v_fmac_f32 v237, v53, v125
    v_fmac_f32 v245, v61, v173
    v_fmac_f32 v237, v54, v126
    v_fmac_f32 v245, v62, v174
    v_fmac_f32 v237, v55, v127
    v_fmac_f32 v245, v63, v175
    s_setprio 1
    s_waitcnt vmcnt(4) lgkmcnt(0)
    v_mfma_f32_32x32x16_bf16 v[0:15], v[64:67], v[184:187], 0
    ds_read_b64_tr_b16 v[176:177], v246 offset:0
    ds_read_b64_tr_b16 v[178:179], v246 offset:512
    ds_read_b64_tr_b16 v[180:181], v247 offset:0
    ds_read_b64_tr_b16 v[182:183], v247 offset:512
    s_mov_b32 m0, s71
    v_mfma_f32_32x32x16_bf16 v[16:31], v[68:71], v[184:187], 0
    buffer_load_dwordx4 v228, s[4:7], s47 offen sc1 lds
    buffer_load_dwordx4 v229, s[72:75], s47 offen offset:1024 sc1 lds
    v_permlane32_swap_b32 v242, v234
    v_permlane32_swap_b32 v243, v235
    v_add_f32 v242, v242, v234
    v_mfma_f32_32x32x16_bf16 v[32:47], v[64:67], v[188:191], 0
    v_add_f32 v243, v243, v235
    s_set_gpr_idx_on s31, gpr_idx(DST)
    s_nop 0
    v_cvt_pk_bf16_f32 v194, v242, v243
    s_set_gpr_idx_off
    s_mov_b32 s32, s31
    s_mov_b32 s31, s35
    v_mfma_f32_32x32x16_bf16 v[48:63], v[68:71], v[188:191], 0
    s_setprio 0
    v_mul_f32 v242, v0, v144
    v_fma_f32 v240, v8, v160, -v240
    v_fmac_f32 v242, v1, v145
    v_fmac_f32 v240, v9, v161
    v_fmac_f32 v242, v2, v146
    v_fmac_f32 v240, v10, v162
    v_fmac_f32 v242, v3, v147
    v_fmac_f32 v240, v11, v163
    v_fmac_f32 v242, v4, v148
    v_fmac_f32 v240, v12, v164
    v_fmac_f32 v242, v5, v149
    v_fmac_f32 v240, v13, v165
    v_fmac_f32 v242, v6, v150
    v_fmac_f32 v240, v14, v166
    v_fmac_f32 v242, v7, v151
    v_fmac_f32 v240, v15, v167
    v_add_u32 v249, s26, v249
    v_add_u32 v250, s26, v250
    v_fma_f32 v244, v16, v160, -v244
    v_fmac_f32 v236, v24, v112
    v_fmac_f32 v244, v17, v161
    v_fmac_f32 v236, v25, v113
    v_fmac_f32 v244, v18, v162
    v_fmac_f32 v236, v26, v114
    v_fmac_f32 v244, v19, v163
    v_fmac_f32 v236, v27, v115
    v_fmac_f32 v244, v20, v164
    v_fmac_f32 v236, v28, v116
    v_fmac_f32 v244, v21, v165
    v_fmac_f32 v236, v29, v117
    v_fmac_f32 v244, v22, v166
    v_fmac_f32 v236, v30, v118
    v_fmac_f32 v244, v23, v167
    v_fmac_f32 v236, v31, v119
    ds_read_b64_tr_b16 v[0:1], v249 offset:0
    ds_read_b64_tr_b16 v[2:3], v249 offset:256
    ds_read_u16_d16_hi v16, v250 offset:0
    v_mul_f32 v243, v32, v152
    v_fma_f32 v241, v40, v168, -v241
    v_fmac_f32 v243, v33, v153
    v_fmac_f32 v241, v41, v169
    v_fmac_f32 v243, v34, v154
    v_fmac_f32 v241, v42, v170
    v_fmac_f32 v243, v35, v155
    v_fmac_f32 v241, v43, v171
    v_fmac_f32 v243, v36, v156
    v_fmac_f32 v241, v44, v172
    v_fmac_f32 v243, v37, v157
    v_fmac_f32 v241, v45, v173
    v_fmac_f32 v243, v38, v158
    v_fmac_f32 v241, v46, v174
    v_fmac_f32 v243, v39, v159
    v_fmac_f32 v241, v47, v175
    ds_read_b64_tr_b16 v[4:5], v249 offset:512
    ds_read_b64_tr_b16 v[6:7], v249 offset:768
    ds_read_u16_d16_hi v17, v250 offset:32
    v_fma_f32 v245, v48, v168, -v245
    v_fmac_f32 v237, v56, v120
    v_fmac_f32 v245, v49, v169
    v_fmac_f32 v237, v57, v121
    v_fmac_f32 v245, v50, v170
    v_fmac_f32 v237, v58, v122
    v_fmac_f32 v245, v51, v171
    v_fmac_f32 v237, v59, v123
    v_fmac_f32 v245, v52, v172
    v_fmac_f32 v237, v60, v124
    v_fmac_f32 v245, v53, v173
    v_fmac_f32 v237, v61, v125
    v_fmac_f32 v245, v54, v174
    v_fmac_f32 v237, v62, v126
    v_fmac_f32 v245, v55, v175
    v_fmac_f32 v237, v63, v127
    s_cmp_eq_u32 s56, 2
    s_cbranch_scc1 K2_U20
    s_cmp_eq_u32 s56, 3
    s_cbranch_scc1 K2_U30
    s_branch K2_DSP0
K2_U40:
    s_setprio 1
    ds_read_b64_tr_b16 v[8:9], v249 offset:1024
    ds_read_b64_tr_b16 v[10:11], v249 offset:1280
    ds_read_u16_d16_hi v18, v250 offset:64
    s_lshr_b32 s65, s30, 27
    s_mul_i32 s66, s22, 2080
    s_lshl_b32 s65, s65, 9
    s_add_u32 s65, s65, s66
    s_add_u32 s65, s65, 65536
    s_sub_u32 s65, s65, s29
    s_sub_u32 s65, s65, 512
    v_add_u32 v56, s65, v249
    ds_read_b64_tr_b16 v[12:13], v56 offset:0
    ds_read_b64_tr_b16 v[14:15], v56 offset:256
    ds_read_u16_d16_hi v19, v250 offset:96
    s_waitcnt lgkmcnt(6)
    v_lshlrev_b32 v20, 16, v0
    v_and_b32 v21, 0xffff0000, v0
    v_lshlrev_b32 v22, 16, v1
    v_and_b32 v23, 0xffff0000, v1
    v_lshlrev_b32 v24, 16, v2
    v_and_b32 v25, 0xffff0000, v2
    v_lshlrev_b32 v26, 16, v3
    v_and_b32 v27, 0xffff0000, v3
    v_mul_f32_dpp v36, v16, v20 row_newbcast:8 row_mask:0xf bank_mask:0xf
    v_mul_f32_dpp v37, v16, v21 row_newbcast:9 row_mask:0xf bank_mask:0xf
    v_mul_f32_dpp v38, v16, v22 row_newbcast:10 row_mask:0xf bank_mask:0xf
    v_mul_f32_dpp v39, v16, v23 row_newbcast:11 row_mask:0xf bank_mask:0xf
    v_mul_f32_dpp v40, v16, v24 row_newbcast:12 row_mask:0xf bank_mask:0xf
    v_mul_f32_dpp v41, v16, v25 row_newbcast:13 row_mask:0xf bank_mask:0xf
    v_mul_f32_dpp v42, v16, v26 row_newbcast:14 row_mask:0xf bank_mask:0xf
    v_mul_f32_dpp v43, v16, v27 row_newbcast:15 row_mask:0xf bank_mask:0xf
    v_cvt_pk_bf16_f32 v68, v36, v37
    v_cvt_pk_bf16_f32 v69, v38, v39
    v_cvt_pk_bf16_f32 v70, v40, v41
    v_cvt_pk_bf16_f32 v71, v42, v43
    v_mul_f32_dpp v20, v16, v20 row_newbcast:0 row_mask:0xa bank_mask:0xf
    v_mul_f32_dpp v21, v16, v21 row_newbcast:1 row_mask:0xa bank_mask:0xf
    v_mul_f32_dpp v22, v16, v22 row_newbcast:2 row_mask:0xa bank_mask:0xf
    v_mul_f32_dpp v23, v16, v23 row_newbcast:3 row_mask:0xa bank_mask:0xf
    v_mul_f32_dpp v24, v16, v24 row_newbcast:4 row_mask:0xa bank_mask:0xf
    v_mul_f32_dpp v25, v16, v25 row_newbcast:5 row_mask:0xa bank_mask:0xf
    v_mul_f32_dpp v26, v16, v26 row_newbcast:6 row_mask:0xa bank_mask:0xf
    v_mul_f32_dpp v27, v16, v27 row_newbcast:7 row_mask:0xa bank_mask:0xf
    v_cvt_pk_bf16_f32 v64, v20, v21
    v_cvt_pk_bf16_f32 v65, v22, v23
    v_cvt_pk_bf16_f32 v66, v24, v25
    v_cvt_pk_bf16_f32 v67, v26, v27
    v_lshlrev_b32 v28, 16, v4
    v_and_b32 v29, 0xffff0000, v4
    v_lshlrev_b32 v30, 16, v5
    v_and_b32 v31, 0xffff0000, v5
    v_lshlrev_b32 v32, 16, v6
    v_and_b32 v33, 0xffff0000, v6
    v_lshlrev_b32 v34, 16, v7
    v_and_b32 v35, 0xffff0000, v7
    v_mul_f32_dpp v36, v17, v28 row_newbcast:8 row_mask:0xf bank_mask:0xf
    v_mul_f32_dpp v37, v17, v29 row_newbcast:9 row_mask:0xf bank_mask:0xf
    v_mul_f32_dpp v38, v17, v30 row_newbcast:10 row_mask:0xf bank_mask:0xf
    v_mul_f32_dpp v39, v17, v31 row_newbcast:11 row_mask:0xf bank_mask:0xf
    v_mul_f32_dpp v40, v17, v32 row_newbcast:12 row_mask:0xf bank_mask:0xf
    v_mul_f32_dpp v41, v17, v33 row_newbcast:13 row_mask:0xf bank_mask:0xf
    v_mul_f32_dpp v42, v17, v34 row_newbcast:14 row_mask:0xf bank_mask:0xf
    v_mul_f32_dpp v43, v17, v35 row_newbcast:15 row_mask:0xf bank_mask:0xf
    v_cvt_pk_bf16_f32 v76, v36, v37
    v_cvt_pk_bf16_f32 v77, v38, v39
    v_cvt_pk_bf16_f32 v78, v40, v41
    v_cvt_pk_bf16_f32 v79, v42, v43
    v_mul_f32_dpp v28, v17, v28 row_newbcast:0 row_mask:0xa bank_mask:0xf
    v_mul_f32_dpp v29, v17, v29 row_newbcast:1 row_mask:0xa bank_mask:0xf
    v_mul_f32_dpp v30, v17, v30 row_newbcast:2 row_mask:0xa bank_mask:0xf
    v_mul_f32_dpp v31, v17, v31 row_newbcast:3 row_mask:0xa bank_mask:0xf
    v_mul_f32_dpp v32, v17, v32 row_newbcast:4 row_mask:0xa bank_mask:0xf
    v_mul_f32_dpp v33, v17, v33 row_newbcast:5 row_mask:0xa bank_mask:0xf
    v_mul_f32_dpp v34, v17, v34 row_newbcast:6 row_mask:0xa bank_mask:0xf
    v_mul_f32_dpp v35, v17, v35 row_newbcast:7 row_mask:0xa bank_mask:0xf
    v_cvt_pk_bf16_f32 v72, v28, v29
    v_cvt_pk_bf16_f32 v73, v30, v31
    v_cvt_pk_bf16_f32 v74, v32, v33
    v_cvt_pk_bf16_f32 v75, v34, v35
    s_waitcnt lgkmcnt(3)
    v_lshlrev_b32 v20, 16, v8
    v_and_b32 v21, 0xffff0000, v8
    v_lshlrev_b32 v22, 16, v9
    v_and_b32 v23, 0xffff0000, v9
    v_lshlrev_b32 v24, 16, v10
    v_and_b32 v25, 0xffff0000, v10
    v_lshlrev_b32 v26, 16, v11
    v_and_b32 v27, 0xffff0000, v11
    v_mul_f32_dpp v36, v18, v20 row_newbcast:8 row_mask:0xf bank_mask:0xf
    v_mul_f32_dpp v37, v18, v21 row_newbcast:9 row_mask:0xf bank_mask:0xf
    v_mul_f32_dpp v38, v18, v22 row_newbcast:10 row_mask:0xf bank_mask:0xf
    v_mul_f32_dpp v39, v18, v23 row_newbcast:11 row_mask:0xf bank_mask:0xf
    v_mul_f32_dpp v40, v18, v24 row_newbcast:12 row_mask:0xf bank_mask:0xf
    v_mul_f32_dpp v41, v18, v25 row_newbcast:13 row_mask:0xf bank_mask:0xf
    v_mul_f32_dpp v42, v18, v26 row_newbcast:14 row_mask:0xf bank_mask:0xf
    v_mul_f32_dpp v43, v18, v27 row_newbcast:15 row_mask:0xf bank_mask:0xf
    v_cvt_pk_bf16_f32 v84, v36, v37
    v_cvt_pk_bf16_f32 v85, v38, v39
    v_cvt_pk_bf16_f32 v86, v40, v41
    v_cvt_pk_bf16_f32 v87, v42, v43
    v_mul_f32_dpp v20, v18, v20 row_newbcast:0 row_mask:0xa bank_mask:0xf
    v_mul_f32_dpp v21, v18, v21 row_newbcast:1 row_mask:0xa bank_mask:0xf
    v_mul_f32_dpp v22, v18, v22 row_newbcast:2 row_mask:0xa bank_mask:0xf
    v_mul_f32_dpp v23, v18, v23 row_newbcast:3 row_mask:0xa bank_mask:0xf
    v_mul_f32_dpp v24, v18, v24 row_newbcast:4 row_mask:0xa bank_mask:0xf
    v_mul_f32_dpp v25, v18, v25 row_newbcast:5 row_mask:0xa bank_mask:0xf
    v_mul_f32_dpp v26, v18, v26 row_newbcast:6 row_mask:0xa bank_mask:0xf
    v_mul_f32_dpp v27, v18, v27 row_newbcast:7 row_mask:0xa bank_mask:0xf
    v_cvt_pk_bf16_f32 v80, v20, v21
    v_cvt_pk_bf16_f32 v81, v22, v23
    v_cvt_pk_bf16_f32 v82, v24, v25
    v_cvt_pk_bf16_f32 v83, v26, v27
    s_waitcnt lgkmcnt(0)
    v_lshlrev_b32 v28, 16, v12
    v_and_b32 v29, 0xffff0000, v12
    v_lshlrev_b32 v30, 16, v13
    v_and_b32 v31, 0xffff0000, v13
    v_lshlrev_b32 v32, 16, v14
    v_and_b32 v33, 0xffff0000, v14
    v_lshlrev_b32 v34, 16, v15
    v_and_b32 v35, 0xffff0000, v15
    v_mul_f32_dpp v36, v19, v28 row_newbcast:8 row_mask:0xf bank_mask:0xf
    v_mul_f32_dpp v37, v19, v29 row_newbcast:9 row_mask:0xf bank_mask:0xf
    v_mul_f32_dpp v38, v19, v30 row_newbcast:10 row_mask:0xf bank_mask:0xf
    v_mul_f32_dpp v39, v19, v31 row_newbcast:11 row_mask:0xf bank_mask:0xf
    v_mul_f32_dpp v40, v19, v32 row_newbcast:12 row_mask:0xf bank_mask:0xf
    v_mul_f32_dpp v41, v19, v33 row_newbcast:13 row_mask:0xf bank_mask:0xf
    v_mul_f32_dpp v42, v19, v34 row_newbcast:14 row_mask:0xf bank_mask:0xf
    v_mul_f32_dpp v43, v19, v35 row_newbcast:15 row_mask:0xf bank_mask:0xf
    v_cvt_pk_bf16_f32 v92, v36, v37
    v_cvt_pk_bf16_f32 v93, v38, v39
    v_cvt_pk_bf16_f32 v94, v40, v41
    v_cvt_pk_bf16_f32 v95, v42, v43
    v_mul_f32_dpp v28, v19, v28 row_newbcast:0 row_mask:0xa bank_mask:0xf
    v_mul_f32_dpp v29, v19, v29 row_newbcast:1 row_mask:0xa bank_mask:0xf
    v_mul_f32_dpp v30, v19, v30 row_newbcast:2 row_mask:0xa bank_mask:0xf
    v_mul_f32_dpp v31, v19, v31 row_newbcast:3 row_mask:0xa bank_mask:0xf
    v_mul_f32_dpp v32, v19, v32 row_newbcast:4 row_mask:0xa bank_mask:0xf
    v_mul_f32_dpp v33, v19, v33 row_newbcast:5 row_mask:0xa bank_mask:0xf
    v_mul_f32_dpp v34, v19, v34 row_newbcast:6 row_mask:0xa bank_mask:0xf
    v_mul_f32_dpp v35, v19, v35 row_newbcast:7 row_mask:0xa bank_mask:0xf
    v_cvt_pk_bf16_f32 v88, v28, v29
    v_cvt_pk_bf16_f32 v89, v30, v31
    v_cvt_pk_bf16_f32 v90, v32, v33
    v_cvt_pk_bf16_f32 v91, v34, v35
    s_waitcnt vmcnt(4)
    v_mfma_f32_32x32x16_bf16 v[0:15], v[64:67], v[176:179], 0
    ds_read_b64_tr_b16 v[184:185], v246 offset:2048
    ds_read_b64_tr_b16 v[186:187], v246 offset:2560
    ds_read_b64_tr_b16 v[188:189], v247 offset:2048
    ds_read_b64_tr_b16 v[190:191], v247 offset:2560
    s_mov_b32 m0, s68
    v_mfma_f32_32x32x16_bf16 v[16:31], v[68:71], v[176:179], 0
    buffer_load_dwordx4 v222, s[4:7], s41 offen sc1 lds
    buffer_load_dwordx4 v223, s[72:75], s41 offen offset:1024 sc1 lds
    v_permlane32_swap_b32 v242, v236
    v_permlane32_swap_b32 v243, v237
    s_add_u32 s38, s38, 1
    v_mfma_f32_32x32x16_bf16 v[32:47], v[64:67], v[180:183], 0
    v_permlane32_swap_b32 v244, v238
    v_permlane32_swap_b32 v245, v239
    v_permlane32_swap_b32 v240, v241
    v_add_f32 v242, v242, v236
    v_mfma_f32_32x32x16_bf16 v[48:63], v[68:71], v[180:183], 0
    v_add_f32 v243, v243, v237
    v_add_f32 v244, v244, v238
    v_add_f32 v245, v245, v239
    v_add_f32 v240, -v240, -v241
    v_mov_b32 v254, s52
    v_mov_b32 v255, s38
    s_waitcnt vmcnt(4) lgkmcnt(0)
    v_mfma_f32_32x32x16_bf16 v[0:15], v[72:75], v[184:187], v[0:15]
    ds_read_b64_tr_b16 v[176:177], v246 offset:4096
    ds_read_b64_tr_b16 v[178:179], v246 offset:4608
    ds_read_b64_tr_b16 v[180:181], v247 offset:4096
    ds_read_b64_tr_b16 v[182:183], v247 offset:4608
    s_lshl_b32 s58, s38, 3
    s_add_u32 s58, s58, s20
    s_mov_b32 m0, s69
    v_mfma_f32_32x32x16_bf16 v[16:31], v[76:79], v[184:187], v[16:31]
    buffer_load_dwordx4 v224, s[4:7], s41 offen sc1 lds
    buffer_load_dwordx4 v225, s[72:75], s41 offen offset:1024 sc1 lds
    s_set_gpr_idx_on s32, gpr_idx(DST)
    s_nop 0
    v_cvt_pk_bf16_f32 v195, v242, v243
    v_cvt_pk_bf16_f32 v196, v244, v245
    v_cvt_pk_bf16_f32 v197, v240, v240
    s_set_gpr_idx_off
    s_mov_b64 exec, 1
    ds_write_b32 v254, v255
    s_mov_b64 exec, -1
    s_cmp_lt_u32 s58, s22
    s_cbranch_scc0 K2_dyn_61
K2_back_62:
    v_readlane_b32 s3, v253, s58
    s_lshl_b32 s44, s34, 7
    s_and_b32 s48, s3, 0x3ffff
    s_bfe_u32 s33, s3, 0x30012
    s_mul_i32 s35, s38, 6
    s_cmp_eq_u32 s34, 0
    s_cselect_b32 s35, s35, s48
    s_mov_b32 s45, s44
    s_add_u32 s47, s44, 256
    s_add_u32 s49, s48, 32
    s_add_u32 s60, s48, 64
    s_cmp_eq_u32 s33, 3
    s_cselect_b32 s46, s44, s47
    s_cselect_b32 s50, s60, s48
    s_cselect_b32 s51, s48, s49
    s_sub_u32 s60, s33, 2
    s_cmp_lt_u32 s60, 2
    s_cbranch_scc0 K2_rare_67
K2_back_68:
    v_mfma_f32_32x32x16_bf16 v[32:47], v[72:75], v[188:191], v[32:47]
    v_add_u32 v233, s48, v230
    ds_read_b32 v232, v233
    ds_read_b32 v233, v233 offset:1024
    v_mfma_f32_32x32x16_bf16 v[48:63], v[76:79], v[188:191], v[48:63]
    s_waitcnt vmcnt(4) lgkmcnt(3)
    v_mfma_f32_32x32x16_bf16 v[0:15], v[80:83], v[176:179], v[0:15]
    ds_read_b64_tr_b16 v[184:185], v246 offset:6144
    ds_read_b64_tr_b16 v[186:187], v246 offset:6656
    ds_read_b64_tr_b16 v[188:189], v247 offset:6144
    ds_read_b64_tr_b16 v[190:191], v247 offset:6656
    s_mov_b32 m0, s70
    v_mfma_f32_32x32x16_bf16 v[16:31], v[84:87], v[176:179], v[16:31]
    buffer_load_dwordx4 v226, s[4:7], s41 offen sc1 lds
    buffer_load_dwordx4 v227, s[72:75], s41 offen offset:1024 sc1 lds
    v_mfma_f32_32x32x16_bf16 v[32:47], v[80:83], v[180:183], v[32:47]
    v_mfma_f32_32x32x16_bf16 v[48:63], v[84:87], v[180:183], v[48:63]
    s_waitcnt lgkmcnt(4)
    v_or_b32 v232, v232, v231
    v_or_b32 v233, v233, v231
    s_cmp_lg_u32 s34, 0
    s_cbranch_scc1 K2_dum_70
    s_cmp_eq_u32 s33, 4
    s_cbranch_scc1 K2_a4_71
K2_b4_73:
    s_add_u32 m0, s48, 512
    s_add_u32 s65, s48, 1536
    buffer_load_dwordx4 v232, s[16:19], 0 offen  lds
    s_mov_b32 m0, s65
    s_mov_b32 exec_hi, 0
    buffer_load_dwordx4 v233, s[16:19], 0 offen  lds
    s_mov_b32 exec_hi, -1
K2_back_72:
    s_waitcnt vmcnt(6) lgkmcnt(0)
    v_mfma_f32_32x32x16_bf16 v[0:15], v[88:91], v[184:187], v[0:15]
    ds_read_b64_tr_b16 v[176:177], v246 offset:0
    ds_read_b64_tr_b16 v[178:179], v246 offset:512
    ds_read_b64_tr_b16 v[180:181], v247 offset:0
    ds_read_b64_tr_b16 v[182:183], v247 offset:512
    s_mov_b32 m0, s71
    v_mfma_f32_32x32x16_bf16 v[16:31], v[92:95], v[184:187], v[16:31]
    buffer_load_dwordx4 v228, s[4:7], s41 offen sc1 lds
    buffer_load_dwordx4 v229, s[72:75], s41 offen offset:1024 sc1 lds
    v_mfma_f32_32x32x16_bf16 v[32:47], v[88:91], v[188:191], v[32:47]
    s_nop 2
    v_mul_f32 v234, v0, v96
    v_mul_f32 v236, v8, v128
    v_fmac_f32 v234, v1, v97
    v_fmac_f32 v236, v9, v129
    v_fmac_f32 v234, v2, v98
    v_fmac_f32 v236, v10, v130
    v_fmac_f32 v234, v3, v99
    v_mfma_f32_32x32x16_bf16 v[48:63], v[92:95], v[188:191], v[48:63]
    s_setprio 0
    v_fmac_f32 v236, v11, v131
    v_fmac_f32 v234, v4, v100
    v_fmac_f32 v236, v12, v132
    v_fmac_f32 v234, v5, v101
    v_fmac_f32 v236, v13, v133
    v_fmac_f32 v234, v6, v102
    v_fmac_f32 v236, v14, v134
    v_fmac_f32 v234, v7, v103
    v_fmac_f32 v236, v15, v135
    v_mul_f32 v238, v16, v128
    v_mul_f32 v240, v24, v128
    v_fmac_f32 v238, v17, v129
    v_fmac_f32 v240, v25, v129
    v_fmac_f32 v238, v18, v130
    v_fmac_f32 v240, v26, v130
    v_fmac_f32 v238, v19, v131
    v_fmac_f32 v240, v27, v131
    v_fmac_f32 v238, v20, v132
    v_fmac_f32 v240, v28, v132
    v_fmac_f32 v238, v21, v133
    v_fmac_f32 v240, v29, v133
    v_fmac_f32 v238, v22, v134
    v_fmac_f32 v240, v30, v134
    v_fmac_f32 v238, v23, v135
    v_fmac_f32 v240, v31, v135
    v_mul_f32 v235, v32, v104
    v_mul_f32 v237, v40, v136
    v_fmac_f32 v235, v33, v105
    v_fmac_f32 v237, v41, v137
    v_fmac_f32 v235, v34, v106
    v_fmac_f32 v237, v42, v138
    v_fmac_f32 v235, v35, v107
    v_fmac_f32 v237, v43, v139
    v_fmac_f32 v235, v36, v108
    v_fmac_f32 v237, v44, v140
    v_fmac_f32 v235, v37, v109
    v_fmac_f32 v237, v45, v141
    v_fmac_f32 v235, v38, v110
    v_fmac_f32 v237, v46, v142
    v_fmac_f32 v235, v39, v111
    v_fmac_f32 v237, v47, v143
    v_mul_f32 v239, v48, v136
    v_mul_f32 v241, v56, v136
    s_setprio 1
    s_waitcnt vmcnt(6) lgkmcnt(0)
    v_mfma_f32_32x32x16_bf16 v[0:15], v[64:67], v[176:179], 0
    ds_read_b64_tr_b16 v[184:185], v246 offset:2048
    ds_read_b64_tr_b16 v[186:187], v246 offset:2560
    ds_read_b64_tr_b16 v[188:189], v247 offset:2048
    ds_read_b64_tr_b16 v[190:191], v247 offset:2560
    v_fmac_f32 v239, v49, v137
    v_fmac_f32 v241, v57, v137
    s_mov_b32 m0, s68
    v_mfma_f32_32x32x16_bf16 v[16:31], v[68:71], v[176:179], 0
    buffer_load_dwordx4 v222, s[4:7], s42 offen sc1 lds
    buffer_load_dwordx4 v223, s[72:75], s42 offen offset:1024 sc1 lds
    v_fmac_f32 v239, v50, v138
    v_fmac_f32 v241, v58, v138
    v_fmac_f32 v239, v51, v139
    v_fmac_f32 v241, v59, v139
    v_fmac_f32 v239, v52, v140
    v_mfma_f32_32x32x16_bf16 v[32:47], v[64:67], v[180:183], 0
    v_fmac_f32 v241, v60, v140
    v_fmac_f32 v239, v53, v141
    v_fmac_f32 v241, v61, v141
    v_fmac_f32 v239, v54, v142
    v_fmac_f32 v241, v62, v142
    v_fmac_f32 v239, v55, v143
    v_fmac_f32 v241, v63, v143
    v_mfma_f32_32x32x16_bf16 v[48:63], v[68:71], v[180:183], 0
    v_permlane32_swap_b32 v234, v236
    v_permlane32_swap_b32 v235, v237
    v_permlane32_swap_b32 v240, v238
    s_waitcnt vmcnt(6) lgkmcnt(0)
    v_mfma_f32_32x32x16_bf16 v[0:15], v[72:75], v[184:187], v[0:15]
    ds_read_b64_tr_b16 v[176:177], v246 offset:4096
    ds_read_b64_tr_b16 v[178:179], v246 offset:4608
    ds_read_b64_tr_b16 v[180:181], v247 offset:4096
    ds_read_b64_tr_b16 v[182:183], v247 offset:4608
    v_permlane32_swap_b32 v241, v239
    s_mov_b32 m0, s69
    v_mfma_f32_32x32x16_bf16 v[16:31], v[76:79], v[184:187], v[16:31]
    buffer_load_dwordx4 v224, s[4:7], s42 offen sc1 lds
    buffer_load_dwordx4 v225, s[72:75], s42 offen offset:1024 sc1 lds
    v_add_f32 v234, v234, v236
    v_add_f32 v235, v235, v237
    v_add_f32 v240, v240, v238
    v_add_f32 v241, v241, v239
    v_mfma_f32_32x32x16_bf16 v[32:47], v[72:75], v[188:191], v[32:47]
    s_set_gpr_idx_on s31, gpr_idx(DST)
    s_nop 0
    v_cvt_pk_bf16_f32 v192, v234, v235
    v_cvt_pk_bf16_f32 v193, v240, v241
    s_set_gpr_idx_off
    v_mfma_f32_32x32x16_bf16 v[48:63], v[76:79], v[188:191], v[48:63]
    s_waitcnt vmcnt(4) lgkmcnt(0)
    v_mfma_f32_32x32x16_bf16 v[0:15], v[80:83], v[176:179], v[0:15]
    ds_read_b64_tr_b16 v[184:185], v246 offset:6144
    ds_read_b64_tr_b16 v[186:187], v246 offset:6656
    ds_read_b64_tr_b16 v[188:189], v247 offset:6144
    ds_read_b64_tr_b16 v[190:191], v247 offset:6656
    s_mov_b32 m0, s70
    v_mfma_f32_32x32x16_bf16 v[16:31], v[84:87], v[176:179], v[16:31]
    buffer_load_dwordx4 v226, s[4:7], s42 offen sc1 lds
    buffer_load_dwordx4 v227, s[72:75], s42 offen offset:1024 sc1 lds
    v_mfma_f32_32x32x16_bf16 v[32:47], v[80:83], v[180:183], v[32:47]
    v_mfma_f32_32x32x16_bf16 v[48:63], v[84:87], v[180:183], v[48:63]
    s_waitcnt vmcnt(4) lgkmcnt(0)
    v_mfma_f32_32x32x16_bf16 v[0:15], v[88:91], v[184:187], v[0:15]
    ds_read_b64_tr_b16 v[176:177], v246 offset:0
    ds_read_b64_tr_b16 v[178:179], v246 offset:512
    ds_read_b64_tr_b16 v[180:181], v247 offset:0
    ds_read_b64_tr_b16 v[182:183], v247 offset:512
    s_mov_b32 m0, s71
    v_mfma_f32_32x32x16_bf16 v[16:31], v[92:95], v[184:187], v[16:31]
    buffer_load_dwordx4 v228, s[4:7], s42 offen sc1 lds
    buffer_load_dwordx4 v229, s[72:75], s42 offen offset:1024 sc1 lds
    v_mfma_f32_32x32x16_bf16 v[32:47], v[88:91], v[188:191], v[32:47]
    s_nop 2
    v_mul_f32 v234, v0, v144
    v_mul_f32 v236, v8, v112
    v_fmac_f32 v234, v1, v145
    v_fmac_f32 v236, v9, v113
    v_fmac_f32 v234, v2, v146
    v_fmac_f32 v236, v10, v114
    v_fmac_f32 v234, v3, v147
    v_mfma_f32_32x32x16_bf16 v[48:63], v[92:95], v[188:191], v[48:63]
    s_setprio 0
    v_fmac_f32 v236, v11, v115
    v_fmac_f32 v234, v4, v148
    v_fmac_f32 v236, v12, v116
    v_fmac_f32 v234, v5, v149
    v_fmac_f32 v236, v13, v117
    v_fmac_f32 v234, v6, v150
    v_fmac_f32 v236, v14, v118
    v_fmac_f32 v234, v7, v151
    v_fmac_f32 v236, v15, v119
    v_mul_f32 v238, v16, v160
    v_mul_f32 v240, v24, v160
    v_fmac_f32 v238, v17, v161
    v_fmac_f32 v240, v25, v161
    v_fmac_f32 v238, v18, v162
    v_fmac_f32 v240, v26, v162
    v_fmac_f32 v238, v19, v163
    v_fmac_f32 v240, v27, v163
    v_fmac_f32 v238, v20, v164
    v_fmac_f32 v240, v28, v164
    v_fmac_f32 v238, v21, v165
    v_fmac_f32 v240, v29, v165
    v_fmac_f32 v238, v22, v166
    v_fmac_f32 v240, v30, v166
    v_fmac_f32 v238, v23, v167
    v_fmac_f32 v240, v31, v167
    v_mul_f32 v235, v32, v152
    v_mul_f32 v237, v40, v120
    v_fmac_f32 v235, v33, v153
    v_fmac_f32 v237, v41, v121
    v_fmac_f32 v235, v34, v154
    v_fmac_f32 v237, v42, v122
    v_fmac_f32 v235, v35, v155
    v_fmac_f32 v237, v43, v123
    v_fmac_f32 v235, v36, v156
    v_fmac_f32 v237, v44, v124
    v_fmac_f32 v235, v37, v157
    v_fmac_f32 v237, v45, v125
    v_fmac_f32 v235, v38, v158
    v_fmac_f32 v237, v46, v126
    v_fmac_f32 v235, v39, v159
    v_fmac_f32 v237, v47, v127
    v_mul_f32 v239, v48, v168
    v_mul_f32 v241, v56, v168
    s_setprio 1
    s_waitcnt vmcnt(4) lgkmcnt(0)
    v_mfma_f32_32x32x16_bf16 v[0:15], v[64:67], v[176:179], 0
    ds_read_b64_tr_b16 v[184:185], v246 offset:2048
    ds_read_b64_tr_b16 v[186:187], v246 offset:2560
    ds_read_b64_tr_b16 v[188:189], v247 offset:2048
    ds_read_b64_tr_b16 v[190:191], v247 offset:2560
    v_fmac_f32 v239, v49, v169
    v_fmac_f32 v241, v57, v169
    s_mov_b32 m0, s68
    v_mfma_f32_32x32x16_bf16 v[16:31], v[68:71], v[176:179], 0
    buffer_load_dwordx4 v222, s[4:7], s43 offen sc1 lds
    buffer_load_dwordx4 v223, s[72:75], s43 offen offset:1024 sc1 lds
    v_fmac_f32 v239, v50, v170
    v_fmac_f32 v241, v58, v170
    v_fmac_f32 v239, v51, v171
    v_fmac_f32 v241, v59, v171
    v_fmac_f32 v239, v52, v172
    v_mfma_f32_32x32x16_bf16 v[32:47], v[64:67], v[180:183], 0
    v_fmac_f32 v241, v60, v172
    v_fmac_f32 v239, v53, v173
    v_fmac_f32 v241, v61, v173
    v_fmac_f32 v239, v54, v174
    v_fmac_f32 v241, v62, v174
    v_fmac_f32 v239, v55, v175
    v_fmac_f32 v241, v63, v175
    v_mfma_f32_32x32x16_bf16 v[48:63], v[68:71], v[180:183], 0
    s_waitcnt vmcnt(4) lgkmcnt(0)
    v_mfma_f32_32x32x16_bf16 v[0:15], v[72:75], v[184:187], v[0:15]
    ds_read_b64_tr_b16 v[176:177], v246 offset:4096
    ds_read_b64_tr_b16 v[178:179], v246 offset:4608
    ds_read_b64_tr_b16 v[180:181], v247 offset:4096
    ds_read_b64_tr_b16 v[182:183], v247 offset:4608
    s_mov_b32 m0, s69
    v_mfma_f32_32x32x16_bf16 v[16:31], v[76:79], v[184:187], v[16:31]
    buffer_load_dwordx4 v224, s[4:7], s43 offen sc1 lds
    buffer_load_dwordx4 v225, s[72:75], s43 offen offset:1024 sc1 lds
    v_mfma_f32_32x32x16_bf16 v[32:47], v[72:75], v[188:191], v[32:47]
    v_mfma_f32_32x32x16_bf16 v[48:63], v[76:79], v[188:191], v[48:63]
    s_waitcnt vmcnt(4) lgkmcnt(0)
    v_mfma_f32_32x32x16_bf16 v[0:15], v[80:83], v[176:179], v[0:15]
    ds_read_b64_tr_b16 v[184:185], v246 offset:6144
    ds_read_b64_tr_b16 v[186:187], v246 offset:6656
    ds_read_b64_tr_b16 v[188:189], v247 offset:6144
    ds_read_b64_tr_b16 v[190:191], v247 offset:6656
    s_mov_b32 m0, s70
    v_mfma_f32_32x32x16_bf16 v[16:31], v[84:87], v[176:179], v[16:31]
    buffer_load_dwordx4 v226, s[4:7], s43 offen sc1 lds
    buffer_load_dwordx4 v227, s[72:75], s43 offen offset:1024 sc1 lds
    v_mfma_f32_32x32x16_bf16 v[32:47], v[80:83], v[180:183], v[32:47]
    v_add_u32 v222, s48, v251
    ds_read_b32 v222, v222
    v_mfma_f32_32x32x16_bf16 v[48:63], v[84:87], v[180:183], v[48:63]
    s_waitcnt vmcnt(4) lgkmcnt(1)
    v_mfma_f32_32x32x16_bf16 v[0:15], v[88:91], v[184:187], v[0:15]
    ds_read_b64_tr_b16 v[176:177], v246 offset:0
    ds_read_b64_tr_b16 v[178:179], v246 offset:512
    ds_read_b64_tr_b16 v[180:181], v247 offset:0
    ds_read_b64_tr_b16 v[182:183], v247 offset:512
    s_mov_b32 m0, s71
    v_mfma_f32_32x32x16_bf16 v[16:31], v[92:95], v[184:187], v[16:31]
    buffer_load_dwordx4 v228, s[4:7], s43 offen sc1 lds
    buffer_load_dwordx4 v229, s[72:75], s43 offen offset:1024 sc1 lds
    s_waitcnt lgkmcnt(4)
    v_mad_u32_u16 v223, v222, s39, v248 op_sel:[1,0,0,0]
    v_mad_u32_u16 v222, v222, s39, v248
    v_mfma_f32_32x32x16_bf16 v[32:47], v[88:91], v[188:191], v[32:47]
    v_add_u32 v224, s49, v251
    ds_read_b32 v224, v224
    v_mul_f32 v242, v0, v144
    v_fma_f32 v238, v8, v160, -v238
    v_fmac_f32 v242, v1, v145
    v_fmac_f32 v238, v9, v161
    v_fmac_f32 v242, v2, v146
    v_mfma_f32_32x32x16_bf16 v[48:63], v[92:95], v[188:191], v[48:63]
    s_setprio 0
    v_fmac_f32 v238, v10, v162
    v_fmac_f32 v242, v3, v147
    v_fmac_f32 v238, v11, v163
    v_fmac_f32 v242, v4, v148
    v_fmac_f32 v238, v12, v164
    v_fmac_f32 v242, v5, v149
    v_fmac_f32 v238, v13, v165
    v_fmac_f32 v242, v6, v150
    v_fmac_f32 v238, v14, v166
    v_fmac_f32 v242, v7, v151
    v_fmac_f32 v238, v15, v167
    v_fmac_f32 v236, v16, v112
    v_mul_f32 v244, v24, v160
    v_fmac_f32 v236, v17, v113
    v_fmac_f32 v244, v25, v161
    v_fmac_f32 v236, v18, v114
    v_fmac_f32 v244, v26, v162
    v_fmac_f32 v236, v19, v115
    v_fmac_f32 v244, v27, v163
    v_fmac_f32 v236, v20, v116
    v_fmac_f32 v244, v28, v164
    v_fmac_f32 v236, v21, v117
    v_fmac_f32 v244, v29, v165
    v_fmac_f32 v236, v22, v118
    v_fmac_f32 v244, v30, v166
    v_fmac_f32 v236, v23, v119
    v_fmac_f32 v244, v31, v167
    v_mul_f32 v243, v32, v152
    v_fma_f32 v239, v40, v168, -v239
    v_fmac_f32 v243, v33, v153
    v_fmac_f32 v239, v41, v169
    v_fmac_f32 v243, v34, v154
    v_fmac_f32 v239, v42, v170
    v_fmac_f32 v243, v35, v155
    v_fmac_f32 v239, v43, v171
    v_fmac_f32 v243, v36, v156
    v_fmac_f32 v239, v44, v172
    v_fmac_f32 v243, v37, v157
    v_fmac_f32 v239, v45, v173
    v_fmac_f32 v243, v38, v158
    v_fmac_f32 v239, v46, v174
    v_fmac_f32 v243, v39, v159
    v_fmac_f32 v239, v47, v175
    v_fmac_f32 v237, v48, v120
    v_mul_f32 v245, v56, v168
    v_fmac_f32 v237, v49, v121
    v_fmac_f32 v245, v57, v169
    v_fmac_f32 v237, v50, v122
    v_fmac_f32 v245, v58, v170
    v_fmac_f32 v237, v51, v123
    s_setprio 1
    s_waitcnt vmcnt(4) lgkmcnt(1)
    v_mfma_f32_32x32x16_bf16 v[0:15], v[64:67], v[176:179], 0
    ds_read_b64_tr_b16 v[184:185], v246 offset:2048
    ds_read_b64_tr_b16 v[186:187], v246 offset:2560
    ds_read_b64_tr_b16 v[188:189], v247 offset:2048
    ds_read_b64_tr_b16 v[190:191], v247 offset:2560
    v_fmac_f32 v245, v59, v171
    v_fmac_f32 v237, v52, v124
    s_mov_b32 m0, s68
    v_mfma_f32_32x32x16_bf16 v[16:31], v[68:71], v[176:179], 0
    buffer_load_dwordx4 v222, s[4:7], s44 offen sc1 lds
    buffer_load_dwordx4 v223, s[72:75], s44 offen offset:1024 sc1 lds
    s_waitcnt lgkmcnt(4)
    v_mad_u32_u16 v225, v224, s39, v248 op_sel:[1,0,0,0]
    v_mad_u32_u16 v224, v224, s39, v248
    v_fmac_f32 v245, v60, v172
    v_fmac_f32 v237, v53, v125
    v_mfma_f32_32x32x16_bf16 v[32:47], v[64:67], v[180:183], 0
    v_add_u32 v226, s50, v251
    ds_read_b32 v226, v226
    v_fmac_f32 v245, v61, v173
    v_fmac_f32 v237, v54, v126
    v_fmac_f32 v245, v62, v174
    v_fmac_f32 v237, v55, v127
    v_fmac_f32 v245, v63, v175
    v_mfma_f32_32x32x16_bf16 v[48:63], v[68:71], v[180:183], 0
    v_permlane32_swap_b32 v242, v234
    v_permlane32_swap_b32 v243, v235
    v_add_f32 v242, v242, v234
    v_add_f32 v243, v243, v235
    s_waitcnt vmcnt(4) lgkmcnt(1)
    v_mfma_f32_32x32x16_bf16 v[0:15], v[72:75], v[184:187], v[0:15]
    ds_read_b64_tr_b16 v[176:177], v246 offset:4096
    ds_read_b64_tr_b16 v[178:179], v246 offset:4608
    ds_read_b64_tr_b16 v[180:181], v247 offset:4096
    ds_read_b64_tr_b16 v[182:183], v247 offset:4608
    s_mov_b32 m0, s69
    v_mfma_f32_32x32x16_bf16 v[16:31], v[76:79], v[184:187], v[16:31]
    buffer_load_dwordx4 v224, s[4:7], s45 offen sc1 lds
    buffer_load_dwordx4 v225, s[72:75], s45 offen offset:1024 sc1 lds
    s_waitcnt lgkmcnt(4)
    v_mad_u32_u16 v227, v226, s39, v248 op_sel:[1,0,0,0]
    v_mad_u32_u16 v226, v226, s39, v248
    v_mfma_f32_32x32x16_bf16 v[32:47], v[72:75], v[188:191], v[32:47]
    v_add_u32 v228, s51, v251
    ds_read_b32 v228, v228
    s_set_gpr_idx_on s31, gpr_idx(DST)
    s_nop 0
    v_cvt_pk_bf16_f32 v194, v242, v243
    s_set_gpr_idx_off
    v_mfma_f32_32x32x16_bf16 v[48:63], v[76:79], v[188:191], v[48:63]
    s_waitcnt vmcnt(4) lgkmcnt(1)
    v_mfma_f32_32x32x16_bf16 v[0:15], v[80:83], v[176:179], v[0:15]
    ds_read_b64_tr_b16 v[184:185], v246 offset:6144
    ds_read_b64_tr_b16 v[186:187], v246 offset:6656
    ds_read_b64_tr_b16 v[188:189], v247 offset:6144
    ds_read_b64_tr_b16 v[190:191], v247 offset:6656
    s_mov_b32 s32, s31
    s_mov_b32 s31, s35
    s_mov_b32 m0, s70
    v_mfma_f32_32x32x16_bf16 v[16:31], v[84:87], v[176:179], v[16:31]
    buffer_load_dwordx4 v226, s[4:7], s46 offen sc1 lds
    buffer_load_dwordx4 v227, s[72:75], s46 offen offset:1024 sc1 lds
    s_waitcnt lgkmcnt(4)
    v_mad_u32_u16 v229, v228, s39, v248 op_sel:[1,0,0,0]
    v_mad_u32_u16 v228, v228, s39, v248
    s_sub_u32 s26, s48, s29
    s_mov_b32 s29, s48
    v_mfma_f32_32x32x16_bf16 v[32:47], v[80:83], v[180:183], v[32:47]
    s_mov_b32 s30, s3
    s_cmp_eq_u32 s34, 0
    s_cselect_b32 s56, s33, 0
    v_mfma_f32_32x32x16_bf16 v[48:63], v[84:87], v[180:183], v[48:63]
    s_waitcnt vmcnt(4) lgkmcnt(0)
    v_mfma_f32_32x32x16_bf16 v[0:15], v[88:91], v[184:187], v[0:15]
    ds_read_b64_tr_b16 v[176:177], v246 offset:0
    ds_read_b64_tr_b16 v[178:179], v246 offset:512
    ds_read_b64_tr_b16 v[180:181], v247 offset:0
    ds_read_b64_tr_b16 v[182:183], v247 offset:512
    s_mov_b32 m0, s71
    v_mfma_f32_32x32x16_bf16 v[16:31], v[92:95], v[184:187], v[16:31]
    buffer_load_dwordx4 v228, s[4:7], s47 offen sc1 lds
    buffer_load_dwordx4 v229, s[72:75], s47 offen offset:1024 sc1 lds
    v_mfma_f32_32x32x16_bf16 v[32:47], v[88:91], v[188:191], v[32:47]
    s_nop 2
    v_mul_f32 v242, v0, v144
    v_fma_f32 v240, v8, v160, -v240
    v_fmac_f32 v242, v1, v145
    v_fmac_f32 v240, v9, v161
    v_fmac_f32 v242, v2, v146
    v_fmac_f32 v240, v10, v162
    v_fmac_f32 v242, v3, v147
    v_mfma_f32_32x32x16_bf16 v[48:63], v[92:95], v[188:191], v[48:63]
    s_setprio 0
    v_fmac_f32 v240, v11, v163
    v_fmac_f32 v242, v4, v148
    v_fmac_f32 v240, v12, v164
    v_fmac_f32 v242, v5, v149
    v_fmac_f32 v240, v13, v165
    v_fmac_f32 v242, v6, v150
    v_fmac_f32 v240, v14, v166
    v_fmac_f32 v242, v7, v151
    v_fmac_f32 v240, v15, v167
    v_add_u32 v249, s26, v249
    v_add_u32 v250, s26, v250
    v_fma_f32 v244, v16, v160, -v244
    v_fmac_f32 v236, v24, v112
    v_fmac_f32 v244, v17, v161
    v_fmac_f32 v236, v25, v113
    v_fmac_f32 v244, v18, v162
    v_fmac_f32 v236, v26, v114
    v_fmac_f32 v244, v19, v163
    v_fmac_f32 v236, v27, v115
    v_fmac_f32 v244, v20, v164
    v_fmac_f32 v236, v28, v116
    v_fmac_f32 v244, v21, v165
    v_fmac_f32 v236, v29, v117
    v_fmac_f32 v244, v22, v166
    v_fmac_f32 v236, v30, v118
    v_fmac_f32 v244, v23, v167
    v_fmac_f32 v236, v31, v119
    ds_read_b64_tr_b16 v[0:1], v249 offset:0
    ds_read_b64_tr_b16 v[2:3], v249 offset:256
    ds_read_u16_d16_hi v16, v250 offset:0
    v_mul_f32 v243, v32, v152
    v_fma_f32 v241, v40, v168, -v241
    v_fmac_f32 v243, v33, v153
    v_fmac_f32 v241, v41, v169
    v_fmac_f32 v243, v34, v154
    v_fmac_f32 v241, v42, v170
    v_fmac_f32 v243, v35, v155
    v_fmac_f32 v241, v43, v171
    v_fmac_f32 v243, v36, v156
    v_fmac_f32 v241, v44, v172
    v_fmac_f32 v243, v37, v157
    v_fmac_f32 v241, v45, v173
    v_fmac_f32 v243, v38, v158
    v_fmac_f32 v241, v46, v174
    v_fmac_f32 v243, v39, v159
    v_fmac_f32 v241, v47, v175
    ds_read_b64_tr_b16 v[4:5], v249 offset:512
    ds_read_b64_tr_b16 v[6:7], v249 offset:768
    ds_read_u16_d16_hi v17, v250 offset:32
    v_fma_f32 v245, v48, v168, -v245
    v_fmac_f32 v237, v56, v120
    v_fmac_f32 v245, v49, v169
    v_fmac_f32 v237, v57, v121
    v_fmac_f32 v245, v50, v170
    v_fmac_f32 v237, v58, v122
    v_fmac_f32 v245, v51, v171
    v_fmac_f32 v237, v59, v123
    v_fmac_f32 v245, v52, v172
    v_fmac_f32 v237, v60, v124
    v_fmac_f32 v245, v53, v173
    v_fmac_f32 v237, v61, v125
    v_fmac_f32 v245, v54, v174
    v_fmac_f32 v237, v62, v126
    v_fmac_f32 v245, v55, v175
    v_fmac_f32 v237, v63, v127
    s_cmp_eq_u32 s56, 2
    s_cbranch_scc1 K2_U20
    s_cmp_eq_u32 s56, 3
    s_cbranch_scc1 K2_U30
    s_branch K2_DSP0
K2_U11:
    s_setprio 1
    v_mov_b32 v254, 163296
    v_mov_b32 v255, 1
    v_lshl_add_u32 v233, v252, 1, s53
    s_mov_b64 exec, 1
    ds_add_rtn_u32 v232, v254, v255
    s_mov_b64 exec, -1
    ds_read_b32 v233, v233
    s_waitcnt lgkmcnt(5)
    v_lshlrev_b32 v20, 16, v0
    v_and_b32 v21, 0xffff0000, v0
    v_lshlrev_b32 v22, 16, v1
    v_and_b32 v23, 0xffff0000, v1
    v_lshlrev_b32 v24, 16, v2
    v_and_b32 v25, 0xffff0000, v2
    v_lshlrev_b32 v26, 16, v3
    v_and_b32 v27, 0xffff0000, v3
    v_mul_f32_dpp v36, v16, v20 row_newbcast:8 row_mask:0xf bank_mask:0xf
    v_mul_f32_dpp v37, v16, v21 row_newbcast:9 row_mask:0xf bank_mask:0xf
    v_mul_f32_dpp v38, v16, v22 row_newbcast:10 row_mask:0xf bank_mask:0xf
    v_mul_f32_dpp v39, v16, v23 row_newbcast:11 row_mask:0xf bank_mask:0xf
    v_mul_f32_dpp v40, v16, v24 row_newbcast:12 row_mask:0xf bank_mask:0xf
    v_mul_f32_dpp v41, v16, v25 row_newbcast:13 row_mask:0xf bank_mask:0xf
    v_mul_f32_dpp v42, v16, v26 row_newbcast:14 row_mask:0xf bank_mask:0xf
    v_mul_f32_dpp v43, v16, v27 row_newbcast:15 row_mask:0xf bank_mask:0xf
    v_cvt_pk_bf16_f32 v68, v36, v37
    v_cvt_pk_bf16_f32 v69, v38, v39
    v_cvt_pk_bf16_f32 v70, v40, v41
    v_cvt_pk_bf16_f32 v71, v42, v43
    v_mul_f32_dpp v20, v16, v20 row_newbcast:0 row_mask:0xa bank_mask:0xf
    v_mul_f32_dpp v21, v16, v21 row_newbcast:1 row_mask:0xa bank_mask:0xf
    v_mul_f32_dpp v22, v16, v22 row_newbcast:2 row_mask:0xa bank_mask:0xf
    v_mul_f32_dpp v23, v16, v23 row_newbcast:3 row_mask:0xa bank_mask:0xf
    v_mul_f32_dpp v24, v16, v24 row_newbcast:4 row_mask:0xa bank_mask:0xf
    v_mul_f32_dpp v25, v16, v25 row_newbcast:5 row_mask:0xa bank_mask:0xf
    v_mul_f32_dpp v26, v16, v26 row_newbcast:6 row_mask:0xa bank_mask:0xf
    v_mul_f32_dpp v27, v16, v27 row_newbcast:7 row_mask:0xa bank_mask:0xf
    v_cvt_pk_bf16_f32 v64, v20, v21
    v_cvt_pk_bf16_f32 v65, v22, v23
    v_cvt_pk_bf16_f32 v66, v24, v25
    v_cvt_pk_bf16_f32 v67, v26, v27
    s_waitcnt lgkmcnt(0)
    v_readfirstlane_b32 s58, v232
    s_nop 0
    s_cmp_lt_u32 s58, s22
    s_cbranch_scc0 K2_nul_74
    s_and_b32 s59, s58, 7
    s_lshr_b32 s60, s58, 3
K2_chk_76:
    v_readlane_b32 s61, v233, s59
    s_nop 0
    s_cmp_gt_u32 s61, s60
    s_cbranch_scc0 K2_spin_75
K2_back_77:
    v_readlane_b32 s3, v253, s58
    s_lshl_b32 s44, s34, 7
    s_and_b32 s48, s3, 0x3ffff
    s_bfe_u32 s33, s3, 0x30012
    s_mov_b32 s35, s48
    s_mov_b32 s45, s44
    s_add_u32 s47, s44, 256
    s_add_u32 s49, s48, 32
    s_add_u32 s60, s48, 64
    s_cmp_eq_u32 s33, 3
    s_cselect_b32 s46, s44, s47
    s_cselect_b32 s50, s60, s48
    s_cselect_b32 s51, s48, s49
    s_sub_u32 s60, s33, 2
    s_cmp_lt_u32 s60, 2
    s_cbranch_scc0 K2_rare_78
K2_back_79:
    v_add_u32 v222, s48, v251
    ds_read_b32 v222, v222
    v_add_u32 v224, s49, v251
    ds_read_b32 v224, v224
    v_add_u32 v226, s50, v251
    ds_read_b32 v226, v226
    v_add_u32 v228, s51, v251
    ds_read_b32 v228, v228
    s_waitcnt lgkmcnt(3)
    v_mad_u32_u16 v223, v222, s39, v248 op_sel:[1,0,0,0]
    v_mad_u32_u16 v222, v222, s39, v248
    s_waitcnt lgkmcnt(2)
    v_mad_u32_u16 v225, v224, s39, v248 op_sel:[1,0,0,0]
    v_mad_u32_u16 v224, v224, s39, v248
    s_waitcnt lgkmcnt(1)
    v_mad_u32_u16 v227, v226, s39, v248 op_sel:[1,0,0,0]
    v_mad_u32_u16 v226, v226, s39, v248
    s_waitcnt lgkmcnt(0)
    v_mad_u32_u16 v229, v228, s39, v248 op_sel:[1,0,0,0]
    v_mad_u32_u16 v228, v228, s39, v248
    s_waitcnt vmcnt(4)
    v_mfma_f32_32x32x16_bf16 v[0:15], v[64:67], v[176:179], 0
    ds_read_b64_tr_b16 v[184:185], v246 offset:2048
    ds_read_b64_tr_b16 v[186:187], v246 offset:2560
    ds_read_b64_tr_b16 v[188:189], v247 offset:2048
    ds_read_b64_tr_b16 v[190:191], v247 offset:2560
    s_mov_b32 m0, s68
    v_mfma_f32_32x32x16_bf16 v[16:31], v[68:71], v[176:179], 0
    buffer_load_dwordx4 v222, s[4:7], s44 offen sc1 lds
    buffer_load_dwordx4 v223, s[72:75], s44 offen offset:1024 sc1 lds
    v_permlane32_swap_b32 v242, v236
    v_permlane32_swap_b32 v243, v237
    v_mfma_f32_32x32x16_bf16 v[32:47], v[64:67], v[180:183], 0
    v_permlane32_swap_b32 v244, v238
    v_permlane32_swap_b32 v245, v239
    v_permlane32_swap_b32 v240, v241
    v_add_f32 v242, v242, v236
    v_mfma_f32_32x32x16_bf16 v[48:63], v[68:71], v[180:183], 0
    s_setprio 0
    v_add_f32 v243, v243, v237
    v_add_f32 v244, v244, v238
    v_add_f32 v245, v245, v239
    v_add_f32 v240, -v240, -v241
    v_sub_u32 v241, v230, v231
    v_cvt_pk_bf16_f32 v242, v242, v243
    v_cvt_pk_bf16_f32 v244, v244, v245
    v_cvt_pk_bf16_f32 v240, v240, v240
    ds_write_b32 v230, v242 offset:768
    ds_write_b32 v230, v244 offset:1024
    ds_write_b16 v241, v240 offset:1280
    v_mul_f32 v234, v0, v96
    v_mul_f32 v236, v8, v128
    v_fmac_f32 v234, v1, v97
    v_fmac_f32 v236, v9, v129
    v_fmac_f32 v234, v2, v98
    v_fmac_f32 v236, v10, v130
    v_fmac_f32 v234, v3, v99
    v_fmac_f32 v236, v11, v131
    v_fmac_f32 v234, v4, v100
    v_fmac_f32 v236, v12, v132
    v_fmac_f32 v234, v5, v101
    v_fmac_f32 v236, v13, v133
    v_fmac_f32 v234, v6, v102
    v_fmac_f32 v236, v14, v134
    v_fmac_f32 v234, v7, v103
    v_fmac_f32 v236, v15, v135
    v_mul_f32 v238, v16, v128
    v_mul_f32 v240, v24, v128
    v_fmac_f32 v238, v17, v129
    v_fmac_f32 v240, v25, v129
    v_fmac_f32 v238, v18, v130
    v_fmac_f32 v240, v26, v130
    v_fmac_f32 v238, v19, v131
    v_fmac_f32 v240, v27, v131
    v_fmac_f32 v238, v20, v132
    v_fmac_f32 v240, v28, v132
    v_fmac_f32 v238, v21, v133
    v_fmac_f32 v240, v29, v133
    v_fmac_f32 v238, v22, v134
    v_fmac_f32 v240, v30, v134
    v_fmac_f32 v238, v23, v135
    v_fmac_f32 v240, v31, v135
    v_mul_f32 v235, v32, v104
    v_mul_f32 v237, v40, v136
    v_fmac_f32 v235, v33, v105
    v_fmac_f32 v237, v41, v137
    v_fmac_f32 v235, v34, v106
    v_fmac_f32 v237, v42, v138
    v_fmac_f32 v235, v35, v107
    v_fmac_f32 v237, v43, v139
    v_fmac_f32 v235, v36, v108
    v_fmac_f32 v237, v44, v140
    v_fmac_f32 v235, v37, v109
    v_fmac_f32 v237, v45, v141
    v_fmac_f32 v235, v38, v110
    v_fmac_f32 v237, v46, v142
    v_fmac_f32 v235, v39, v111
    v_fmac_f32 v237, v47, v143
    v_mul_f32 v239, v48, v136
    v_mul_f32 v241, v56, v136
    v_fmac_f32 v239, v49, v137
    v_fmac_f32 v241, v57, v137
    v_fmac_f32 v239, v50, v138
    v_fmac_f32 v241, v58, v138
    v_fmac_f32 v239, v51, v139
    v_fmac_f32 v241, v59, v139
    v_fmac_f32 v239, v52, v140
    v_fmac_f32 v241, v60, v140
    v_fmac_f32 v239, v53, v141
    v_fmac_f32 v241, v61, v141
    v_fmac_f32 v239, v54, v142
    v_fmac_f32 v241, v62, v142
    v_fmac_f32 v239, v55, v143
    v_fmac_f32 v241, v63, v143
    s_setprio 1
    s_waitcnt vmcnt(4) lgkmcnt(3)
    v_mfma_f32_32x32x16_bf16 v[0:15], v[64:67], v[184:187], 0
    ds_read_b64_tr_b16 v[176:177], v246 offset:4096
    ds_read_b64_tr_b16 v[178:179], v246 offset:4608
    ds_read_b64_tr_b16 v[180:181], v247 offset:4096
    ds_read_b64_tr_b16 v[182:183], v247 offset:4608
    s_mov_b32 m0, s69
    v_mfma_f32_32x32x16_bf16 v[16:31], v[68:71], v[184:187], 0
    buffer_load_dwordx4 v224, s[4:7], s45 offen sc1 lds
    buffer_load_dwordx4 v225, s[72:75], s45 offen offset:1024 sc1 lds
    v_permlane32_swap_b32 v234, v236
    v_permlane32_swap_b32 v235, v237
    v_mfma_f32_32x32x16_bf16 v[32:47], v[64:67], v[188:191], 0
    v_permlane32_swap_b32 v240, v238
    v_permlane32_swap_b32 v241, v239
    v_lshl_add_u32 v230, v252, 1, s31
    v_add_f32 v234, v234, v236
    v_add_f32 v235, v235, v237
    v_mfma_f32_32x32x16_bf16 v[48:63], v[68:71], v[188:191], 0
    s_setprio 0
    v_add_f32 v240, v240, v238
    v_add_f32 v241, v241, v239
    v_cvt_pk_bf16_f32 v234, v234, v235
    v_cvt_pk_bf16_f32 v240, v240, v241
    ds_write_b32 v230, v234 offset:0
    ds_write_b32 v230, v240 offset:256
    v_mul_f32 v234, v0, v144
    v_mul_f32 v236, v8, v112
    v_fmac_f32 v234, v1, v145
    v_fmac_f32 v236, v9, v113
    v_fmac_f32 v234, v2, v146
    v_fmac_f32 v236, v10, v114
    v_fmac_f32 v234, v3, v147
    v_fmac_f32 v236, v11, v115
    v_fmac_f32 v234, v4, v148
    v_fmac_f32 v236, v12, v116
    v_fmac_f32 v234, v5, v149
    v_fmac_f32 v236, v13, v117
    v_fmac_f32 v234, v6, v150
    v_fmac_f32 v236, v14, v118
    v_fmac_f32 v234, v7, v151
    v_fmac_f32 v236, v15, v119
    v_mul_f32 v238, v16, v160
    v_mul_f32 v240, v24, v160
    v_fmac_f32 v238, v17, v161
    v_fmac_f32 v240, v25, v161
    v_fmac_f32 v238, v18, v162
    v_fmac_f32 v240, v26, v162
    v_fmac_f32 v238, v19, v163
    v_fmac_f32 v240, v27, v163
    v_fmac_f32 v238, v20, v164
    v_fmac_f32 v240, v28, v164
    v_fmac_f32 v238, v21, v165
    v_fmac_f32 v240, v29, v165
    v_fmac_f32 v238, v22, v166
    v_fmac_f32 v240, v30, v166
    v_fmac_f32 v238, v23, v167
    v_fmac_f32 v240, v31, v167
    v_mul_f32 v235, v32, v152
    v_mul_f32 v237, v40, v120
    v_fmac_f32 v235, v33, v153
    v_fmac_f32 v237, v41, v121
    v_fmac_f32 v235, v34, v154
    v_fmac_f32 v237, v42, v122
    v_fmac_f32 v235, v35, v155
    v_fmac_f32 v237, v43, v123
    v_fmac_f32 v235, v36, v156
    v_fmac_f32 v237, v44, v124
    v_fmac_f32 v235, v37, v157
    v_fmac_f32 v237, v45, v125
    v_fmac_f32 v235, v38, v158
    v_fmac_f32 v237, v46, v126
    v_fmac_f32 v235, v39, v159
    v_fmac_f32 v237, v47, v127
    v_mul_f32 v239, v48, v168
    v_mul_f32 v241, v56, v168
    v_fmac_f32 v239, v49, v169
    v_fmac_f32 v241, v57, v169
    v_fmac_f32 v239, v50, v170
    v_fmac_f32 v241, v58, v170
    v_fmac_f32 v239, v51, v171
    v_fmac_f32 v241, v59, v171
    v_fmac_f32 v239, v52, v172
    v_fmac_f32 v241, v60, v172
    v_fmac_f32 v239, v53, v173
    v_fmac_f32 v241, v61, v173
    v_fmac_f32 v239, v54, v174
    v_fmac_f32 v241, v62, v174
    v_fmac_f32 v239, v55, v175
    v_fmac_f32 v241, v63, v175
    s_setprio 1
    s_waitcnt vmcnt(4) lgkmcnt(2)
    v_mfma_f32_32x32x16_bf16 v[0:15], v[64:67], v[176:179], 0
    ds_read_b64_tr_b16 v[184:185], v246 offset:6144
    ds_read_b64_tr_b16 v[186:187], v246 offset:6656
    ds_read_b64_tr_b16 v[188:189], v247 offset:6144
    ds_read_b64_tr_b16 v[190:191], v247 offset:6656
    s_mov_b32 s32, s31
    s_mov_b32 s31, s35
    s_mov_b32 m0, s70
    v_mfma_f32_32x32x16_bf16 v[16:31], v[68:71], v[176:179], 0
    buffer_load_dwordx4 v226, s[4:7], s46 offen sc1 lds
    buffer_load_dwordx4 v227, s[72:75], s46 offen offset:1024 sc1 lds
    s_sub_u32 s26, s48, s29
    s_mov_b32 s29, s48
    s_mov_b32 s30, s3
    s_cmp_lg_u32 s36, 0
    s_cselect_b32 s56, s33, 0
    v_mfma_f32_32x32x16_bf16 v[32:47], v[64:67], v[180:183], 0
    v_mfma_f32_32x32x16_bf16 v[48:63], v[68:71], v[180:183], 0
    s_setprio 0
    v_mul_f32 v242, v0, v144
    v_fma_f32 v238, v8, v160, -v238
    v_fmac_f32 v242, v1, v145
    v_fmac_f32 v238, v9, v161
    v_fmac_f32 v242, v2, v146
    v_fmac_f32 v238, v10, v162
    v_fmac_f32 v242, v3, v147
    v_fmac_f32 v238, v11, v163
    v_fmac_f32 v242, v4, v148
    v_fmac_f32 v238, v12, v164
    v_fmac_f32 v242, v5, v149
    v_fmac_f32 v238, v13, v165
    v_fmac_f32 v242, v6, v150
    v_fmac_f32 v238, v14, v166
    v_fmac_f32 v242, v7, v151
    v_fmac_f32 v238, v15, v167
    v_fmac_f32 v236, v16, v112
    v_mul_f32 v244, v24, v160
    v_fmac_f32 v236, v17, v113
    v_fmac_f32 v244, v25, v161
    v_fmac_f32 v236, v18, v114
    v_fmac_f32 v244, v26, v162
    v_fmac_f32 v236, v19, v115
    v_fmac_f32 v244, v27, v163
    v_fmac_f32 v236, v20, v116
    v_fmac_f32 v244, v28, v164
    v_fmac_f32 v236, v21, v117
    v_fmac_f32 v244, v29, v165
    v_fmac_f32 v236, v22, v118
    v_fmac_f32 v244, v30, v166
    v_fmac_f32 v236, v23, v119
    v_fmac_f32 v244, v31, v167
    v_mul_f32 v243, v32, v152
    v_fma_f32 v239, v40, v168, -v239
    v_fmac_f32 v243, v33, v153
    v_fmac_f32 v239, v41, v169
    v_fmac_f32 v243, v34, v154
    v_fmac_f32 v239, v42, v170
    v_fmac_f32 v243, v35, v155
    v_fmac_f32 v239, v43, v171
    v_fmac_f32 v243, v36, v156
    v_fmac_f32 v239, v44, v172
    v_fmac_f32 v243, v37, v157
    v_fmac_f32 v239, v45, v173
    v_fmac_f32 v243, v38, v158
    v_fmac_f32 v239, v46, v174
    v_fmac_f32 v243, v39, v159
    v_fmac_f32 v239, v47, v175
    v_fmac_f32 v237, v48, v120
    v_mul_f32 v245, v56, v168
    v_fmac_f32 v237, v49, v121
    v_fmac_f32 v245, v57, v169
    v_fmac_f32 v237, v50, v122
    v_fmac_f32 v245, v58, v170
    v_fmac_f32 v237, v51, v123
    v_fmac_f32 v245, v59, v171
    v_fmac_f32 v237, v52, v124
    v_fmac_f32 v245, v60, v172
    v_fmac_f32 v237, v53, v125
    v_fmac_f32 v245, v61, v173
    v_fmac_f32 v237, v54, v126
    v_fmac_f32 v245, v62, v174
    v_fmac_f32 v237, v55, v127
    v_fmac_f32 v245, v63, v175
    s_setprio 1
    s_waitcnt vmcnt(4) lgkmcnt(0)
    v_mfma_f32_32x32x16_bf16 v[0:15], v[64:67], v[184:187], 0
    ds_read_b64_tr_b16 v[176:177], v246 offset:0
    ds_read_b64_tr_b16 v[178:179], v246 offset:512
    ds_read_b64_tr_b16 v[180:181], v247 offset:0
    ds_read_b64_tr_b16 v[182:183], v247 offset:512
    s_mov_b32 m0, s71
    v_mfma_f32_32x32x16_bf16 v[16:31], v[68:71], v[184:187], 0
    buffer_load_dwordx4 v228, s[4:7], s47 offen sc1 lds
    buffer_load_dwordx4 v229, s[72:75], s47 offen offset:1024 sc1 lds
    v_permlane32_swap_b32 v242, v234
    v_permlane32_swap_b32 v243, v235
    v_add_f32 v242, v242, v234
    v_mfma_f32_32x32x16_bf16 v[32:47], v[64:67], v[188:191], 0
    v_add_f32 v243, v243, v235
    v_cvt_pk_bf16_f32 v242, v242, v243
    ds_write_b32 v230, v242 offset:512
    v_mfma_f32_32x32x16_bf16 v[48:63], v[68:71], v[188:191], 0
    s_setprio 0
    v_mul_f32 v242, v0, v144
    v_fma_f32 v240, v8, v160, -v240
    v_fmac_f32 v242, v1, v145
    v_fmac_f32 v240, v9, v161
    v_fmac_f32 v242, v2, v146
    v_fmac_f32 v240, v10, v162
    v_fmac_f32 v242, v3, v147
    v_fmac_f32 v240, v11, v163
    v_fmac_f32 v242, v4, v148
    v_fmac_f32 v240, v12, v164
    v_fmac_f32 v242, v5, v149
    v_fmac_f32 v240, v13, v165
    v_fmac_f32 v242, v6, v150
    v_fmac_f32 v240, v14, v166
    v_fmac_f32 v242, v7, v151
    v_fmac_f32 v240, v15, v167
    v_add_u32 v249, s26, v249
    v_add_u32 v250, s26, v250
    v_fma_f32 v244, v16, v160, -v244
    v_fmac_f32 v236, v24, v112
    v_fmac_f32 v244, v17, v161
    v_fmac_f32 v236, v25, v113
    v_fmac_f32 v244, v18, v162
    v_fmac_f32 v236, v26, v114
    v_fmac_f32 v244, v19, v163
    v_fmac_f32 v236, v27, v115
    v_fmac_f32 v244, v20, v164
    v_fmac_f32 v236, v28, v116
    v_fmac_f32 v244, v21, v165
    v_fmac_f32 v236, v29, v117
    v_fmac_f32 v244, v22, v166
    v_fmac_f32 v236, v30, v118
    v_fmac_f32 v244, v23, v167
    v_fmac_f32 v236, v31, v119
    ds_read_b64_tr_b16 v[0:1], v249 offset:0
    ds_read_b64_tr_b16 v[2:3], v249 offset:256
    ds_read_u16_d16_hi v16, v250 offset:0
    v_mul_f32 v243, v32, v152
    v_fma_f32 v241, v40, v168, -v241
    v_fmac_f32 v243, v33, v153
    v_fmac_f32 v241, v41, v169
    v_fmac_f32 v243, v34, v154
    v_fmac_f32 v241, v42, v170
    v_fmac_f32 v243, v35, v155
    v_fmac_f32 v241, v43, v171
    v_fmac_f32 v243, v36, v156
    v_fmac_f32 v241, v44, v172
    v_fmac_f32 v243, v37, v157
    v_fmac_f32 v241, v45, v173
    v_fmac_f32 v243, v38, v158
    v_fmac_f32 v241, v46, v174
    v_fmac_f32 v243, v39, v159
    v_fmac_f32 v241, v47, v175
    ds_read_b64_tr_b16 v[4:5], v249 offset:512
    ds_read_b64_tr_b16 v[6:7], v249 offset:768
    ds_read_u16_d16_hi v17, v250 offset:32
    v_fma_f32 v245, v48, v168, -v245
    v_fmac_f32 v237, v56, v120
    v_fmac_f32 v245, v49, v169
    v_fmac_f32 v237, v57, v121
    v_fmac_f32 v245, v50, v170
    v_fmac_f32 v237, v58, v122
    v_fmac_f32 v245, v51, v171
    v_fmac_f32 v237, v59, v123
    v_fmac_f32 v245, v52, v172
    v_fmac_f32 v237, v60, v124
    v_fmac_f32 v245, v53, v173
    v_fmac_f32 v237, v61, v125
    v_fmac_f32 v245, v54, v174
    v_fmac_f32 v237, v62, v126
    v_fmac_f32 v245, v55, v175
    v_fmac_f32 v237, v63, v127
    s_cmp_eq_u32 s56, 2
    s_cbranch_scc1 K2_U21
    s_cmp_eq_u32 s56, 3
    s_cbranch_scc1 K2_U31
    s_branch K2_DSP1
K2_U41:
    s_setprio 1
    ds_read_b64_tr_b16 v[8:9], v249 offset:1024
    ds_read_b64_tr_b16 v[10:11], v249 offset:1280
    ds_read_u16_d16_hi v18, v250 offset:64
    s_lshr_b32 s65, s30, 27
    s_mul_i32 s66, s22, 2080
    s_lshl_b32 s65, s65, 9
    s_add_u32 s65, s65, s66
    s_add_u32 s65, s65, 65536
    s_sub_u32 s65, s65, s29
    s_sub_u32 s65, s65, 512
    v_add_u32 v56, s65, v249
    ds_read_b64_tr_b16 v[12:13], v56 offset:0
    ds_read_b64_tr_b16 v[14:15], v56 offset:256
    ds_read_u16_d16_hi v19, v250 offset:96
    s_waitcnt lgkmcnt(6)
    v_lshlrev_b32 v20, 16, v0
    v_and_b32 v21, 0xffff0000, v0
    v_lshlrev_b32 v22, 16, v1
    v_and_b32 v23, 0xffff0000, v1
    v_lshlrev_b32 v24, 16, v2
    v_and_b32 v25, 0xffff0000, v2
    v_lshlrev_b32 v26, 16, v3
    v_and_b32 v27, 0xffff0000, v3
    v_mul_f32_dpp v36, v16, v20 row_newbcast:8 row_mask:0xf bank_mask:0xf
    v_mul_f32_dpp v37, v16, v21 row_newbcast:9 row_mask:0xf bank_mask:0xf
    v_mul_f32_dpp v38, v16, v22 row_newbcast:10 row_mask:0xf bank_mask:0xf
    v_mul_f32_dpp v39, v16, v23 row_newbcast:11 row_mask:0xf bank_mask:0xf
    v_mul_f32_dpp v40, v16, v24 row_newbcast:12 row_mask:0xf bank_mask:0xf
    v_mul_f32_dpp v41, v16, v25 row_newbcast:13 row_mask:0xf bank_mask:0xf
    v_mul_f32_dpp v42, v16, v26 row_newbcast:14 row_mask:0xf bank_mask:0xf
    v_mul_f32_dpp v43, v16, v27 row_newbcast:15 row_mask:0xf bank_mask:0xf
    v_cvt_pk_bf16_f32 v68, v36, v37
    v_cvt_pk_bf16_f32 v69, v38, v39
    v_cvt_pk_bf16_f32 v70, v40, v41
    v_cvt_pk_bf16_f32 v71, v42, v43
    v_mul_f32_dpp v20, v16, v20 row_newbcast:0 row_mask:0xa bank_mask:0xf
    v_mul_f32_dpp v21, v16, v21 row_newbcast:1 row_mask:0xa bank_mask:0xf
    v_mul_f32_dpp v22, v16, v22 row_newbcast:2 row_mask:0xa bank_mask:0xf
    v_mul_f32_dpp v23, v16, v23 row_newbcast:3 row_mask:0xa bank_mask:0xf
    v_mul_f32_dpp v24, v16, v24 row_newbcast:4 row_mask:0xa bank_mask:0xf
    v_mul_f32_dpp v25, v16, v25 row_newbcast:5 row_mask:0xa bank_mask:0xf
    v_mul_f32_dpp v26, v16, v26 row_newbcast:6 row_mask:0xa bank_mask:0xf
    v_mul_f32_dpp v27, v16, v27 row_newbcast:7 row_mask:0xa bank_mask:0xf
    v_cvt_pk_bf16_f32 v64, v20, v21
    v_cvt_pk_bf16_f32 v65, v22, v23
    v_cvt_pk_bf16_f32 v66, v24, v25
    v_cvt_pk_bf16_f32 v67, v26, v27
    v_lshlrev_b32 v28, 16, v4
    v_and_b32 v29, 0xffff0000, v4
    v_lshlrev_b32 v30, 16, v5
    v_and_b32 v31, 0xffff0000, v5
    v_lshlrev_b32 v32, 16, v6
    v_and_b32 v33, 0xffff0000, v6
    v_lshlrev_b32 v34, 16, v7
    v_and_b32 v35, 0xffff0000, v7
    v_mul_f32_dpp v36, v17, v28 row_newbcast:8 row_mask:0xf bank_mask:0xf
    v_mul_f32_dpp v37, v17, v29 row_newbcast:9 row_mask:0xf bank_mask:0xf
    v_mul_f32_dpp v38, v17, v30 row_newbcast:10 row_mask:0xf bank_mask:0xf
    v_mul_f32_dpp v39, v17, v31 row_newbcast:11 row_mask:0xf bank_mask:0xf
    v_mul_f32_dpp v40, v17, v32 row_newbcast:12 row_mask:0xf bank_mask:0xf
    v_mul_f32_dpp v41, v17, v33 row_newbcast:13 row_mask:0xf bank_mask:0xf
    v_mul_f32_dpp v42, v17, v34 row_newbcast:14 row_mask:0xf bank_mask:0xf
    v_mul_f32_dpp v43, v17, v35 row_newbcast:15 row_mask:0xf bank_mask:0xf
    v_cvt_pk_bf16_f32 v76, v36, v37
    v_cvt_pk_bf16_f32 v77, v38, v39
    v_cvt_pk_bf16_f32 v78, v40, v41
    v_cvt_pk_bf16_f32 v79, v42, v43
    v_mul_f32_dpp v28, v17, v28 row_newbcast:0 row_mask:0xa bank_mask:0xf
    v_mul_f32_dpp v29, v17, v29 row_newbcast:1 row_mask:0xa bank_mask:0xf
    v_mul_f32_dpp v30, v17, v30 row_newbcast:2 row_mask:0xa bank_mask:0xf
    v_mul_f32_dpp v31, v17, v31 row_newbcast:3 row_mask:0xa bank_mask:0xf
    v_mul_f32_dpp v32, v17, v32 row_newbcast:4 row_mask:0xa bank_mask:0xf
    v_mul_f32_dpp v33, v17, v33 row_newbcast:5 row_mask:0xa bank_mask:0xf
    v_mul_f32_dpp v34, v17, v34 row_newbcast:6 row_mask:0xa bank_mask:0xf
    v_mul_f32_dpp v35, v17, v35 row_newbcast:7 row_mask:0xa bank_mask:0xf
    v_cvt_pk_bf16_f32 v72, v28, v29
    v_cvt_pk_bf16_f32 v73, v30, v31
    v_cvt_pk_bf16_f32 v74, v32, v33
    v_cvt_pk_bf16_f32 v75, v34, v35
    s_waitcnt lgkmcnt(3)
    v_lshlrev_b32 v20, 16, v8
    v_and_b32 v21, 0xffff0000, v8
    v_lshlrev_b32 v22, 16, v9
    v_and_b32 v23, 0xffff0000, v9
    v_lshlrev_b32 v24, 16, v10
    v_and_b32 v25, 0xffff0000, v10
    v_lshlrev_b32 v26, 16, v11
    v_and_b32 v27, 0xffff0000, v11
    v_mul_f32_dpp v36, v18, v20 row_newbcast:8 row_mask:0xf bank_mask:0xf
    v_mul_f32_dpp v37, v18, v21 row_newbcast:9 row_mask:0xf bank_mask:0xf
    v_mul_f32_dpp v38, v18, v22 row_newbcast:10 row_mask:0xf bank_mask:0xf
    v_mul_f32_dpp v39, v18, v23 row_newbcast:11 row_mask:0xf bank_mask:0xf
    v_mul_f32_dpp v40, v18, v24 row_newbcast:12 row_mask:0xf bank_mask:0xf
    v_mul_f32_dpp v41, v18, v25 row_newbcast:13 row_mask:0xf bank_mask:0xf
    v_mul_f32_dpp v42, v18, v26 row_newbcast:14 row_mask:0xf bank_mask:0xf
    v_mul_f32_dpp v43, v18, v27 row_newbcast:15 row_mask:0xf bank_mask:0xf
    v_cvt_pk_bf16_f32 v84, v36, v37
    v_cvt_pk_bf16_f32 v85, v38, v39
    v_cvt_pk_bf16_f32 v86, v40, v41
    v_cvt_pk_bf16_f32 v87, v42, v43
    v_mul_f32_dpp v20, v18, v20 row_newbcast:0 row_mask:0xa bank_mask:0xf
    v_mul_f32_dpp v21, v18, v21 row_newbcast:1 row_mask:0xa bank_mask:0xf
    v_mul_f32_dpp v22, v18, v22 row_newbcast:2 row_mask:0xa bank_mask:0xf
    v_mul_f32_dpp v23, v18, v23 row_newbcast:3 row_mask:0xa bank_mask:0xf
    v_mul_f32_dpp v24, v18, v24 row_newbcast:4 row_mask:0xa bank_mask:0xf
    v_mul_f32_dpp v25, v18, v25 row_newbcast:5 row_mask:0xa bank_mask:0xf
    v_mul_f32_dpp v26, v18, v26 row_newbcast:6 row_mask:0xa bank_mask:0xf
    v_mul_f32_dpp v27, v18, v27 row_newbcast:7 row_mask:0xa bank_mask:0xf
    v_cvt_pk_bf16_f32 v80, v20, v21
    v_cvt_pk_bf16_f32 v81, v22, v23
    v_cvt_pk_bf16_f32 v82, v24, v25
    v_cvt_pk_bf16_f32 v83, v26, v27
    s_waitcnt lgkmcnt(0)
    v_lshlrev_b32 v28, 16, v12
    v_and_b32 v29, 0xffff0000, v12
    v_lshlrev_b32 v30, 16, v13
    v_and_b32 v31, 0xffff0000, v13
    v_lshlrev_b32 v32, 16, v14
    v_and_b32 v33, 0xffff0000, v14
    v_lshlrev_b32 v34, 16, v15
    v_and_b32 v35, 0xffff0000, v15
    v_mul_f32_dpp v36, v19, v28 row_newbcast:8 row_mask:0xf bank_mask:0xf
    v_mul_f32_dpp v37, v19, v29 row_newbcast:9 row_mask:0xf bank_mask:0xf
    v_mul_f32_dpp v38, v19, v30 row_newbcast:10 row_mask:0xf bank_mask:0xf
    v_mul_f32_dpp v39, v19, v31 row_newbcast:11 row_mask:0xf bank_mask:0xf
    v_mul_f32_dpp v40, v19, v32 row_newbcast:12 row_mask:0xf bank_mask:0xf
    v_mul_f32_dpp v41, v19, v33 row_newbcast:13 row_mask:0xf bank_mask:0xf
    v_mul_f32_dpp v42, v19, v34 row_newbcast:14 row_mask:0xf bank_mask:0xf
    v_mul_f32_dpp v43, v19, v35 row_newbcast:15 row_mask:0xf bank_mask:0xf
    v_cvt_pk_bf16_f32 v92, v36, v37
    v_cvt_pk_bf16_f32 v93, v38, v39
    v_cvt_pk_bf16_f32 v94, v40, v41
    v_cvt_pk_bf16_f32 v95, v42, v43
    v_mul_f32_dpp v28, v19, v28 row_newbcast:0 row_mask:0xa bank_mask:0xf
    v_mul_f32_dpp v29, v19, v29 row_newbcast:1 row_mask:0xa bank_mask:0xf
    v_mul_f32_dpp v30, v19, v30 row_newbcast:2 row_mask:0xa bank_mask:0xf
    v_mul_f32_dpp v31, v19, v31 row_newbcast:3 row_mask:0xa bank_mask:0xf
    v_mul_f32_dpp v32, v19, v32 row_newbcast:4 row_mask:0xa bank_mask:0xf
    v_mul_f32_dpp v33, v19, v33 row_newbcast:5 row_mask:0xa bank_mask:0xf
    v_mul_f32_dpp v34, v19, v34 row_newbcast:6 row_mask:0xa bank_mask:0xf
    v_mul_f32_dpp v35, v19, v35 row_newbcast:7 row_mask:0xa bank_mask:0xf
    v_cvt_pk_bf16_f32 v88, v28, v29
    v_cvt_pk_bf16_f32 v89, v30, v31
    v_cvt_pk_bf16_f32 v90, v32, v33
    v_cvt_pk_bf16_f32 v91, v34, v35
    s_waitcnt vmcnt(4)
    v_mfma_f32_32x32x16_bf16 v[0:15], v[64:67], v[176:179], 0
    ds_read_b64_tr_b16 v[184:185], v246 offset:2048
    ds_read_b64_tr_b16 v[186:187], v246 offset:2560
    ds_read_b64_tr_b16 v[188:189], v247 offset:2048
    ds_read_b64_tr_b16 v[190:191], v247 offset:2560
    s_mov_b32 m0, s68
    v_mfma_f32_32x32x16_bf16 v[16:31], v[68:71], v[176:179], 0
    buffer_load_dwordx4 v222, s[4:7], s41 offen sc1 lds
    buffer_load_dwordx4 v223, s[72:75], s41 offen offset:1024 sc1 lds
    v_permlane32_swap_b32 v242, v236
    v_permlane32_swap_b32 v243, v237
    v_mov_b32 v254, 163296
    v_mfma_f32_32x32x16_bf16 v[32:47], v[64:67], v[180:183], 0
    v_permlane32_swap_b32 v244, v238
    v_permlane32_swap_b32 v245, v239
    v_permlane32_swap_b32 v240, v241
    v_add_f32 v242, v242, v236
    v_mfma_f32_32x32x16_bf16 v[48:63], v[68:71], v[180:183], 0
    v_add_f32 v243, v243, v237
    v_add_f32 v244, v244, v238
    v_add_f32 v245, v245, v239
    v_add_f32 v240, -v240, -v241
    v_sub_u32 v241, v230, v231
    v_cvt_pk_bf16_f32 v242, v242, v243
    v_mov_b32 v255, 1
    v_lshl_add_u32 v233, v252, 1, s53
    s_mov_b64 exec, 1
    ds_add_rtn_u32 v232, v254, v255
    s_mov_b64 exec, -1
    ds_read_b32 v233, v233
    s_waitcnt vmcnt(4) lgkmcnt(2)
    v_mfma_f32_32x32x16_bf16 v[0:15], v[72:75], v[184:187], v[0:15]
    ds_read_b64_tr_b16 v[176:177], v246 offset:4096
    ds_read_b64_tr_b16 v[178:179], v246 offset:4608
    ds_read_b64_tr_b16 v[180:181], v247 offset:4096
    ds_read_b64_tr_b16 v[182:183], v247 offset:4608
    v_cvt_pk_bf16_f32 v244, v244, v245
    v_cvt_pk_bf16_f32 v240, v240, v240
    s_mov_b32 m0, s69
    v_mfma_f32_32x32x16_bf16 v[16:31], v[76:79], v[184:187], v[16:31]
    buffer_load_dwordx4 v224, s[4:7], s41 offen sc1 lds
    buffer_load_dwordx4 v225, s[72:75], s41 offen offset:1024 sc1 lds
    ds_write_b32 v230, v242 offset:768
    ds_write_b32 v230, v244 offset:1024
    ds_write_b16 v241, v240 offset:1280
    s_waitcnt lgkmcnt(7)
    v_readfirstlane_b32 s58, v232
    v_mfma_f32_32x32x16_bf16 v[32:47], v[72:75], v[188:191], v[32:47]
    s_cmp_lt_u32 s58, s22
    s_cbranch_scc0 K2_nul_81
    s_and_b32 s59, s58, 7
    s_lshr_b32 s60, s58, 3
K2_chk_83:
    v_readlane_b32 s61, v233, s59
    s_nop 0
    s_cmp_gt_u32 s61, s60
    s_cbranch_scc0 K2_spin_82
K2_back_84:
    v_mfma_f32_32x32x16_bf16 v[48:63], v[76:79], v[188:191], v[48:63]
    v_readlane_b32 s3, v253, s58
    s_lshl_b32 s44, s34, 7
    s_and_b32 s48, s3, 0x3ffff
    s_bfe_u32 s33, s3, 0x30012
    s_mov_b32 s35, s48
    s_mov_b32 s45, s44
    s_waitcnt vmcnt(4) lgkmcnt(3)
    v_mfma_f32_32x32x16_bf16 v[0:15], v[80:83], v[176:179], v[0:15]
    ds_read_b64_tr_b16 v[184:185], v246 offset:6144
    ds_read_b64_tr_b16 v[186:187], v246 offset:6656
    ds_read_b64_tr_b16 v[188:189], v247 offset:6144
    ds_read_b64_tr_b16 v[190:191], v247 offset:6656
    s_add_u32 s47, s44, 256
    s_add_u32 s49, s48, 32
    s_mov_b32 m0, s70
    v_mfma_f32_32x32x16_bf16 v[16:31], v[84:87], v[176:179], v[16:31]
    buffer_load_dwordx4 v226, s[4:7], s41 offen sc1 lds
    buffer_load_dwordx4 v227, s[72:75], s41 offen offset:1024 sc1 lds
    s_add_u32 s60, s48, 64
    s_cmp_eq_u32 s33, 3
    s_cselect_b32 s46, s44, s47
    s_cselect_b32 s50, s60, s48
    s_cselect_b32 s51, s48, s49
    v_mfma_f32_32x32x16_bf16 v[32:47], v[80:83], v[180:183], v[32:47]
    s_sub_u32 s60, s33, 2
    s_cmp_lt_u32 s60, 2
    s_cbranch_scc0 K2_rare_85
K2_back_86:
    v_mfma_f32_32x32x16_bf16 v[48:63], v[84:87], v[180:183], v[48:63]
    s_waitcnt vmcnt(4) lgkmcnt(0)
    v_mfma_f32_32x32x16_bf16 v[0:15], v[88:91], v[184:187], v[0:15]
    ds_read_b64_tr_b16 v[176:177], v246 offset:0
    ds_read_b64_tr_b16 v[178:179], v246 offset:512
    ds_read_b64_tr_b16 v[180:181], v247 offset:0
    ds_read_b64_tr_b16 v[182:183], v247 offset:512
    s_mov_b32 m0, s71
    v_mfma_f32_32x32x16_bf16 v[16:31], v[92:95], v[184:187], v[16:31]
    buffer_load_dwordx4 v228, s[4:7], s41 offen sc1 lds
    buffer_load_dwordx4 v229, s[72:75], s41 offen offset:1024 sc1 lds
    v_mfma_f32_32x32x16_bf16 v[32:47], v[88:91], v[188:191], v[32:47]
    s_nop 2
    v_mul_f32 v234, v0, v96
    v_mul_f32 v236, v8, v128
    v_fmac_f32 v234, v1, v97
    v_fmac_f32 v236, v9, v129
    v_fmac_f32 v234, v2, v98
    v_fmac_f32 v236, v10, v130
    v_fmac_f32 v234, v3, v99
    v_mfma_f32_32x32x16_bf16 v[48:63], v[92:95], v[188:191], v[48:63]
    s_setprio 0
    v_fmac_f32 v236, v11, v131
    v_fmac_f32 v234, v4, v100
    v_fmac_f32 v236, v12, v132
    v_fmac_f32 v234, v5, v101
    v_fmac_f32 v236, v13, v133
    v_fmac_f32 v234, v6, v102
    v_fmac_f32 v236, v14, v134
    v_fmac_f32 v234, v7, v103
    v_fmac_f32 v236, v15, v135
    v_mul_f32 v238, v16, v128
    v_mul_f32 v240, v24, v128
    v_fmac_f32 v238, v17, v129
    v_fmac_f32 v240, v25, v129
    v_fmac_f32 v238, v18, v130
    v_fmac_f32 v240, v26, v130
    v_fmac_f32 v238, v19, v131
    v_fmac_f32 v240, v27, v131
    v_fmac_f32 v238, v20, v132
    v_fmac_f32 v240, v28, v132
    v_fmac_f32 v238, v21, v133
    v_fmac_f32 v240, v29, v133
    v_fmac_f32 v238, v22, v134
    v_fmac_f32 v240, v30, v134
    v_fmac_f32 v238, v23, v135
    v_fmac_f32 v240, v31, v135
    v_mul_f32 v235, v32, v104
    v_mul_f32 v237, v40, v136
    v_fmac_f32 v235, v33, v105
    v_fmac_f32 v237, v41, v137
    v_fmac_f32 v235, v34, v106
    v_fmac_f32 v237, v42, v138
    v_fmac_f32 v235, v35, v107
    v_fmac_f32 v237, v43, v139
    v_fmac_f32 v235, v36, v108
    v_fmac_f32 v237, v44, v140
    v_fmac_f32 v235, v37, v109
    v_fmac_f32 v237, v45, v141
    v_fmac_f32 v235, v38, v110
    v_fmac_f32 v237, v46, v142
    v_fmac_f32 v235, v39, v111
    v_fmac_f32 v237, v47, v143
    v_mul_f32 v239, v48, v136
    v_mul_f32 v241, v56, v136
    s_setprio 1
    s_waitcnt vmcnt(4) lgkmcnt(0)
    v_mfma_f32_32x32x16_bf16 v[0:15], v[64:67], v[176:179], 0
    ds_read_b64_tr_b16 v[184:185], v246 offset:2048
    ds_read_b64_tr_b16 v[186:187], v246 offset:2560
    ds_read_b64_tr_b16 v[188:189], v247 offset:2048
    ds_read_b64_tr_b16 v[190:191], v247 offset:2560
    v_fmac_f32 v239, v49, v137
    v_fmac_f32 v241, v57, v137
    s_mov_b32 m0, s68
    v_mfma_f32_32x32x16_bf16 v[16:31], v[68:71], v[176:179], 0
    buffer_load_dwordx4 v222, s[4:7], s42 offen sc1 lds
    buffer_load_dwordx4 v223, s[72:75], s42 offen offset:1024 sc1 lds
    v_fmac_f32 v239, v50, v138
    v_fmac_f32 v241, v58, v138
    v_fmac_f32 v239, v51, v139
    v_fmac_f32 v241, v59, v139
    v_fmac_f32 v239, v52, v140
    v_mfma_f32_32x32x16_bf16 v[32:47], v[64:67], v[180:183], 0
    v_fmac_f32 v241, v60, v140
    v_fmac_f32 v239, v53, v141
    v_fmac_f32 v241, v61, v141
    v_fmac_f32 v239, v54, v142
    v_fmac_f32 v241, v62, v142
    v_fmac_f32 v239, v55, v143
    v_fmac_f32 v241, v63, v143
    v_mfma_f32_32x32x16_bf16 v[48:63], v[68:71], v[180:183], 0
    v_permlane32_swap_b32 v234, v236
    v_permlane32_swap_b32 v235, v237
    v_permlane32_swap_b32 v240, v238
    s_waitcnt vmcnt(4) lgkmcnt(0)
    v_mfma_f32_32x32x16_bf16 v[0:15], v[72:75], v[184:187], v[0:15]
    ds_read_b64_tr_b16 v[176:177], v246 offset:4096
    ds_read_b64_tr_b16 v[178:179], v246 offset:4608
    ds_read_b64_tr_b16 v[180:181], v247 offset:4096
    ds_read_b64_tr_b16 v[182:183], v247 offset:4608
    v_permlane32_swap_b32 v241, v239
    s_mov_b32 m0, s69
    v_mfma_f32_32x32x16_bf16 v[16:31], v[76:79], v[184:187], v[16:31]
    buffer_load_dwordx4 v224, s[4:7], s42 offen sc1 lds
    buffer_load_dwordx4 v225, s[72:75], s42 offen offset:1024 sc1 lds
    v_lshl_add_u32 v230, v252, 1, s31
    v_add_f32 v234, v234, v236
    v_add_f32 v235, v235, v237
    v_add_f32 v240, v240, v238
    v_add_f32 v241, v241, v239
    v_mfma_f32_32x32x16_bf16 v[32:47], v[72:75], v[188:191], v[32:47]
    v_cvt_pk_bf16_f32 v234, v234, v235
    v_cvt_pk_bf16_f32 v240, v240, v241
    ds_write_b32 v230, v234 offset:0
    ds_write_b32 v230, v240 offset:256
    v_mfma_f32_32x32x16_bf16 v[48:63], v[76:79], v[188:191], v[48:63]
    s_waitcnt vmcnt(4) lgkmcnt(2)
    v_mfma_f32_32x32x16_bf16 v[0:15], v[80:83], v[176:179], v[0:15]
    ds_read_b64_tr_b16 v[184:185], v246 offset:6144
    ds_read_b64_tr_b16 v[186:187], v246 offset:6656
    ds_read_b64_tr_b16 v[188:189], v247 offset:6144
    ds_read_b64_tr_b16 v[190:191], v247 offset:6656
    s_mov_b32 m0, s70
    v_mfma_f32_32x32x16_bf16 v[16:31], v[84:87], v[176:179], v[16:31]
    buffer_load_dwordx4 v226, s[4:7], s42 offen sc1 lds
    buffer_load_dwordx4 v227, s[72:75], s42 offen offset:1024 sc1 lds
    v_mfma_f32_32x32x16_bf16 v[32:47], v[80:83], v[180:183], v[32:47]
    v_mfma_f32_32x32x16_bf16 v[48:63], v[84:87], v[180:183], v[48:63]
    s_waitcnt vmcnt(4) lgkmcnt(0)
    v_mfma_f32_32x32x16_bf16 v[0:15], v[88:91], v[184:187], v[0:15]
    ds_read_b64_tr_b16 v[176:177], v246 offset:0
    ds_read_b64_tr_b16 v[178:179], v246 offset:512
    ds_read_b64_tr_b16 v[180:181], v247 offset:0
    ds_read_b64_tr_b16 v[182:183], v247 offset:512
    s_mov_b32 m0, s71
    v_mfma_f32_32x32x16_bf16 v[16:31], v[92:95], v[184:187], v[16:31]
    buffer_load_dwordx4 v228, s[4:7], s42 offen sc1 lds
    buffer_load_dwordx4 v229, s[72:75], s42 offen offset:1024 sc1 lds
    v_mfma_f32_32x32x16_bf16 v[32:47], v[88:91], v[188:191], v[32:47]
    s_nop 2
    v_mul_f32 v234, v0, v144
    v_mul_f32 v236, v8, v112
    v_fmac_f32 v234, v1, v145
    v_fmac_f32 v236, v9, v113
    v_fmac_f32 v234, v2, v146
    v_fmac_f32 v236, v10, v114
    v_fmac_f32 v234, v3, v147
    v_mfma_f32_32x32x16_bf16 v[48:63], v[92:95], v[188:191], v[48:63]
    s_setprio 0
    v_fmac_f32 v236, v11, v115
    v_fmac_f32 v234, v4, v148
    v_fmac_f32 v236, v12, v116
    v_fmac_f32 v234, v5, v149
    v_fmac_f32 v236, v13, v117
    v_fmac_f32 v234, v6, v150
    v_fmac_f32 v236, v14, v118
    v_fmac_f32 v234, v7, v151
    v_fmac_f32 v236, v15, v119
    v_mul_f32 v238, v16, v160
    v_mul_f32 v240, v24, v160
    v_fmac_f32 v238, v17, v161
    v_fmac_f32 v240, v25, v161
    v_fmac_f32 v238, v18, v162
    v_fmac_f32 v240, v26, v162
    v_fmac_f32 v238, v19, v163
    v_fmac_f32 v240, v27, v163
    v_fmac_f32 v238, v20, v164
    v_fmac_f32 v240, v28, v164
    v_fmac_f32 v238, v21, v165
    v_fmac_f32 v240, v29, v165
    v_fmac_f32 v238, v22, v166
    v_fmac_f32 v240, v30, v166
    v_fmac_f32 v238, v23, v167
    v_fmac_f32 v240, v31, v167
    v_mul_f32 v235, v32, v152
    v_mul_f32 v237, v40, v120
    v_fmac_f32 v235, v33, v153
    v_fmac_f32 v237, v41, v121
    v_fmac_f32 v235, v34, v154
    v_fmac_f32 v237, v42, v122
    v_fmac_f32 v235, v35, v155
    v_fmac_f32 v237, v43, v123
    v_fmac_f32 v235, v36, v156
    v_fmac_f32 v237, v44, v124
    v_fmac_f32 v235, v37, v157
    v_fmac_f32 v237, v45, v125
    v_fmac_f32 v235, v38, v158
    v_fmac_f32 v237, v46, v126
    v_fmac_f32 v235, v39, v159
    v_fmac_f32 v237, v47, v127
    v_mul_f32 v239, v48, v168
    v_mul_f32 v241, v56, v168
    s_setprio 1
    s_waitcnt vmcnt(4) lgkmcnt(0)
    v_mfma_f32_32x32x16_bf16 v[0:15], v[64:67], v[176:179], 0
    ds_read_b64_tr_b16 v[184:185], v246 offset:2048
    ds_read_b64_tr_b16 v[186:187], v246 offset:2560
    ds_read_b64_tr_b16 v[188:189], v247 offset:2048
    ds_read_b64_tr_b16 v[190:191], v247 offset:2560
    v_fmac_f32 v239, v49, v169
    v_fmac_f32 v241, v57, v169
    s_mov_b32 m0, s68
    v_mfma_f32_32x32x16_bf16 v[16:31], v[68:71], v[176:179], 0
    buffer_load_dwordx4 v222, s[4:7], s43 offen sc1 lds
    buffer_load_dwordx4 v223, s[72:75], s43 offen offset:1024 sc1 lds
    v_fmac_f32 v239, v50, v170
    v_fmac_f32 v241, v58, v170
    v_fmac_f32 v239, v51, v171
    v_fmac_f32 v241, v59, v171
    v_fmac_f32 v239, v52, v172
    v_mfma_f32_32x32x16_bf16 v[32:47], v[64:67], v[180:183], 0
    v_fmac_f32 v241, v60, v172
    v_fmac_f32 v239, v53, v173
    v_fmac_f32 v241, v61, v173
    v_fmac_f32 v239, v54, v174
    v_fmac_f32 v241, v62, v174
    v_fmac_f32 v239, v55, v175
    v_fmac_f32 v241, v63, v175
    v_mfma_f32_32x32x16_bf16 v[48:63], v[68:71], v[180:183], 0
    s_waitcnt vmcnt(4) lgkmcnt(0)
    v_mfma_f32_32x32x16_bf16 v[0:15], v[72:75], v[184:187], v[0:15]
    ds_read_b64_tr_b16 v[176:177], v246 offset:4096
    ds_read_b64_tr_b16 v[178:179], v246 offset:4608
    ds_read_b64_tr_b16 v[180:181], v247 offset:4096
    ds_read_b64_tr_b16 v[182:183], v247 offset:4608
    s_mov_b32 m0, s69
    v_mfma_f32_32x32x16_bf16 v[16:31], v[76:79], v[184:187], v[16:31]
    buffer_load_dwordx4 v224, s[4:7], s43 offen sc1 lds
    buffer_load_dwordx4 v225, s[72:75], s43 offen offset:1024 sc1 lds
    v_mfma_f32_32x32x16_bf16 v[32:47], v[72:75], v[188:191], v[32:47]
    v_mfma_f32_32x32x16_bf16 v[48:63], v[76:79], v[188:191], v[48:63]
    s_waitcnt vmcnt(4) lgkmcnt(0)
    v_mfma_f32_32x32x16_bf16 v[0:15], v[80:83], v[176:179], v[0:15]
    ds_read_b64_tr_b16 v[184:185], v246 offset:6144
    ds_read_b64_tr_b16 v[186:187], v246 offset:6656
    ds_read_b64_tr_b16 v[188:189], v247 offset:6144
    ds_read_b64_tr_b16 v[190:191], v247 offset:6656
    s_mov_b32 m0, s70
    v_mfma_f32_32x32x16_bf16 v[16:31], v[84:87], v[176:179], v[16:31]
    buffer_load_dwordx4 v226, s[4:7], s43 offen sc1 lds
    buffer_load_dwordx4 v227, s[72:75], s43 offen offset:1024 sc1 lds
    v_mfma_f32_32x32x16_bf16 v[32:47], v[80:83], v[180:183], v[32:47]
    v_add_u32 v222, s48, v251
    ds_read_b32 v222, v222
    v_mfma_f32_32x32x16_bf16 v[48:63], v[84:87], v[180:183], v[48:63]
    s_waitcnt vmcnt(4) lgkmcnt(1)
    v_mfma_f32_32x32x16_bf16 v[0:15], v[88:91], v[184:187], v[0:15]
    ds_read_b64_tr_b16 v[176:177], v246 offset:0
    ds_read_b64_tr_b16 v[178:179], v246 offset:512
    ds_read_b64_tr_b16 v[180:181], v247 offset:0
    ds_read_b64_tr_b16 v[182:183], v247 offset:512
    s_mov_b32 m0, s71
    v_mfma_f32_32x32x16_bf16 v[16:31], v[92:95], v[184:187], v[16:31]
    buffer_load_dwordx4 v228, s[4:7], s43 offen sc1 lds
    buffer_load_dwordx4 v229, s[72:75], s43 offen offset:1024 sc1 lds
    s_waitcnt lgkmcnt(4)
    v_mad_u32_u16 v223, v222, s39, v248 op_sel:[1,0,0,0]
    v_mad_u32_u16 v222, v222, s39, v248
    v_mfma_f32_32x32x16_bf16 v[32:47], v[88:91], v[188:191], v[32:47]
    v_add_u32 v224, s49, v251
    ds_read_b32 v224, v224
    v_mul_f32 v242, v0, v144
    v_fma_f32 v238, v8, v160, -v238
    v_fmac_f32 v242, v1, v145
    v_fmac_f32 v238, v9, v161
    v_fmac_f32 v242, v2, v146
    v_mfma_f32_32x32x16_bf16 v[48:63], v[92:95], v[188:191], v[48:63]
    s_setprio 0
    v_fmac_f32 v238, v10, v162
    v_fmac_f32 v242, v3, v147
    v_fmac_f32 v238, v11, v163
    v_fmac_f32 v242, v4, v148
    v_fmac_f32 v238, v12, v164
    v_fmac_f32 v242, v5, v149
    v_fmac_f32 v238, v13, v165
    v_fmac_f32 v242, v6, v150
    v_fmac_f32 v238, v14, v166
    v_fmac_f32 v242, v7, v151
    v_fmac_f32 v238, v15, v167
    v_fmac_f32 v236, v16, v112
    v_mul_f32 v244, v24, v160
    v_fmac_f32 v236, v17, v113
    v_fmac_f32 v244, v25, v161
    v_fmac_f32 v236, v18, v114
    v_fmac_f32 v244, v26, v162
    v_fmac_f32 v236, v19, v115
    v_fmac_f32 v244, v27, v163
    v_fmac_f32 v236, v20, v116
    v_fmac_f32 v244, v28, v164
    v_fmac_f32 v236, v21, v117
    v_fmac_f32 v244, v29, v165
    v_fmac_f32 v236, v22, v118
    v_fmac_f32 v244, v30, v166
    v_fmac_f32 v236, v23, v119
    v_fmac_f32 v244, v31, v167
    v_mul_f32 v243, v32, v152
    v_fma_f32 v239, v40, v168, -v239
    v_fmac_f32 v243, v33, v153
    v_fmac_f32 v239, v41, v169
    v_fmac_f32 v243, v34, v154
    v_fmac_f32 v239, v42, v170
    v_fmac_f32 v243, v35, v155
    v_fmac_f32 v239, v43, v171
    v_fmac_f32 v243, v36, v156
    v_fmac_f32 v239, v44, v172
    v_fmac_f32 v243, v37, v157
    v_fmac_f32 v239, v45, v173
    v_fmac_f32 v243, v38, v158
    v_fmac_f32 v239, v46, v174
    v_fmac_f32 v243, v39, v159
    v_fmac_f32 v239, v47, v175
    v_fmac_f32 v237, v48, v120
    v_mul_f32 v245, v56, v168
    v_fmac_f32 v237, v49, v121
    v_fmac_f32 v245, v57, v169
    v_fmac_f32 v237, v50, v122
    v_fmac_f32 v245, v58, v170
    v_fmac_f32 v237, v51, v123
    s_setprio 1
    s_waitcnt vmcnt(4) lgkmcnt(1)
    v_mfma_f32_32x32x16_bf16 v[0:15], v[64:67], v[176:179], 0
    ds_read_b64_tr_b16 v[184:185], v246 offset:2048
    ds_read_b64_tr_b16 v[186:187], v246 offset:2560
    ds_read_b64_tr_b16 v[188:189], v247 offset:2048
    ds_read_b64_tr_b16 v[190:191], v247 offset:2560
    v_fmac_f32 v245, v59, v171
    v_fmac_f32 v237, v52, v124
    s_mov_b32 m0, s68
    v_mfma_f32_32x32x16_bf16 v[16:31], v[68:71], v[176:179], 0
    buffer_load_dwordx4 v222, s[4:7], s44 offen sc1 lds
    buffer_load_dwordx4 v223, s[72:75], s44 offen offset:1024 sc1 lds
    s_waitcnt lgkmcnt(4)
    v_mad_u32_u16 v225, v224, s39, v248 op_sel:[1,0,0,0]
    v_mad_u32_u16 v224, v224, s39, v248
    v_fmac_f32 v245, v60, v172
    v_fmac_f32 v237, v53, v125
    v_mfma_f32_32x32x16_bf16 v[32:47], v[64:67], v[180:183], 0
    v_add_u32 v226, s50, v251
    ds_read_b32 v226, v226
    v_fmac_f32 v245, v61, v173
    v_fmac_f32 v237, v54, v126
    v_fmac_f32 v245, v62, v174
    v_fmac_f32 v237, v55, v127
    v_fmac_f32 v245, v63, v175
    v_mfma_f32_32x32x16_bf16 v[48:63], v[68:71], v[180:183], 0
    v_permlane32_swap_b32 v242, v234
    v_permlane32_swap_b32 v243, v235
    v_add_f32 v242, v242, v234
    v_add_f32 v243, v243, v235
    s_waitcnt vmcnt(4) lgkmcnt(1)
    v_mfma_f32_32x32x16_bf16 v[0:15], v[72:75], v[184:187], v[0:15]
    ds_read_b64_tr_b16 v[176:177], v246 offset:4096
    ds_read_b64_tr_b16 v[178:179], v246 offset:4608
    ds_read_b64_tr_b16 v[180:181], v247 offset:4096
    ds_read_b64_tr_b16 v[182:183], v247 offset:4608
    v_cvt_pk_bf16_f32 v242, v242, v243
    ds_write_b32 v230, v242 offset:512
    s_mov_b32 m0, s69
    v_mfma_f32_32x32x16_bf16 v[16:31], v[76:79], v[184:187], v[16:31]
    buffer_load_dwordx4 v224, s[4:7], s45 offen sc1 lds
    buffer_load_dwordx4 v225, s[72:75], s45 offen offset:1024 sc1 lds
    s_waitcnt lgkmcnt(5)
    v_mad_u32_u16 v227, v226, s39, v248 op_sel:[1,0,0,0]
    v_mad_u32_u16 v226, v226, s39, v248
    v_mfma_f32_32x32x16_bf16 v[32:47], v[72:75], v[188:191], v[32:47]
    v_add_u32 v228, s51, v251
    ds_read_b32 v228, v228
    v_mfma_f32_32x32x16_bf16 v[48:63], v[76:79], v[188:191], v[48:63]
    s_waitcnt vmcnt(4) lgkmcnt(2)
    v_mfma_f32_32x32x16_bf16 v[0:15], v[80:83], v[176:179], v[0:15]
    ds_read_b64_tr_b16 v[184:185], v246 offset:6144
    ds_read_b64_tr_b16 v[186:187], v246 offset:6656
    ds_read_b64_tr_b16 v[188:189], v247 offset:6144
    ds_read_b64_tr_b16 v[190:191], v247 offset:6656
    s_mov_b32 s32, s31
    s_mov_b32 s31, s35
    s_mov_b32 m0, s70
    v_mfma_f32_32x32x16_bf16 v[16:31], v[84:87], v[176:179], v[16:31]
    buffer_load_dwordx4 v226, s[4:7], s46 offen sc1 lds
    buffer_load_dwordx4 v227, s[72:75], s46 offen offset:1024 sc1 lds
    s_waitcnt lgkmcnt(4)
    v_mad_u32_u16 v229, v228, s39, v248 op_sel:[1,0,0,0]
    v_mad_u32_u16 v228, v228, s39, v248
    s_sub_u32 s26, s48, s29
    s_mov_b32 s29, s48
    v_mfma_f32_32x32x16_bf16 v[32:47], v[80:83], v[180:183], v[32:47]
    s_mov_b32 s30, s3
    s_cmp_lg_u32 s36, 0
    s_cselect_b32 s56, s33, 0
    v_mfma_f32_32x32x16_bf16 v[48:63], v[84:87], v[180:183], v[48:63]
    s_waitcnt vmcnt(4) lgkmcnt(0)
    v_mfma_f32_32x32x16_bf16 v[0:15], v[88:91], v[184:187], v[0:15]
    ds_read_b64_tr_b16 v[176:177], v246 offset:0
    ds_read_b64_tr_b16 v[178:179], v246 offset:512
    ds_read_b64_tr_b16 v[180:181], v247 offset:0
    ds_read_b64_tr_b16 v[182:183], v247 offset:512
    s_mov_b32 m0, s71
    v_mfma_f32_32x32x16_bf16 v[16:31], v[92:95], v[184:187], v[16:31]
    buffer_load_dwordx4 v228, s[4:7], s47 offen sc1 lds
    buffer_load_dwordx4 v229, s[72:75], s47 offen offset:1024 sc1 lds
    v_mfma_f32_32x32x16_bf16 v[32:47], v[88:91], v[188:191], v[32:47]
    s_nop 2
    v_mul_f32 v242, v0, v144
    v_fma_f32 v240, v8, v160, -v240
    v_fmac_f32 v242, v1, v145
    v_fmac_f32 v240, v9, v161
    v_fmac_f32 v242, v2, v146
    v_fmac_f32 v240, v10, v162
    v_fmac_f32 v242, v3, v147
    v_mfma_f32_32x32x16_bf16 v[48:63], v[92:95], v[188:191], v[48:63]
    s_setprio 0
    v_fmac_f32 v240, v11, v163
    v_fmac_f32 v242, v4, v148
    v_fmac_f32 v240, v12, v164
    v_fmac_f32 v242, v5, v149
    v_fmac_f32 v240, v13, v165
    v_fmac_f32 v242, v6, v150
    v_fmac_f32 v240, v14, v166
    v_fmac_f32 v242, v7, v151
    v_fmac_f32 v240, v15, v167
    v_add_u32 v249, s26, v249
    v_add_u32 v250, s26, v250
    v_fma_f32 v244, v16, v160, -v244
    v_fmac_f32 v236, v24, v112
    v_fmac_f32 v244, v17, v161
    v_fmac_f32 v236, v25, v113
    v_fmac_f32 v244, v18, v162
    v_fmac_f32 v236, v26, v114
    v_fmac_f32 v244, v19, v163
    v_fmac_f32 v236, v27, v115
    v_fmac_f32 v244, v20, v164
    v_fmac_f32 v236, v28, v116
    v_fmac_f32 v244, v21, v165
    v_fmac_f32 v236, v29, v117
    v_fmac_f32 v244, v22, v166
    v_fmac_f32 v236, v30, v118
    v_fmac_f32 v244, v23, v167
    v_fmac_f32 v236, v31, v119
    ds_read_b64_tr_b16 v[0:1], v249 offset:0
    ds_read_b64_tr_b16 v[2:3], v249 offset:256
    ds_read_u16_d16_hi v16, v250 offset:0
    v_mul_f32 v243, v32, v152
    v_fma_f32 v241, v40, v168, -v241
    v_fmac_f32 v243, v33, v153
    v_fmac_f32 v241, v41, v169
    v_fmac_f32 v243, v34, v154
    v_fmac_f32 v241, v42, v170
    v_fmac_f32 v243, v35, v155
    v_fmac_f32 v241, v43, v171
    v_fmac_f32 v243, v36, v156
    v_fmac_f32 v241, v44, v172
    v_fmac_f32 v243, v37, v157
    v_fmac_f32 v241, v45, v173
    v_fmac_f32 v243, v38, v158
    v_fmac_f32 v241, v46, v174
    v_fmac_f32 v243, v39, v159
    v_fmac_f32 v241, v47, v175
    ds_read_b64_tr_b16 v[4:5], v249 offset:512
    ds_read_b64_tr_b16 v[6:7], v249 offset:768
    ds_read_u16_d16_hi v17, v250 offset:32
    v_fma_f32 v245, v48, v168, -v245
    v_fmac_f32 v237, v56, v120
    v_fmac_f32 v245, v49, v169
    v_fmac_f32 v237, v57, v121
    v_fmac_f32 v245, v50, v170
    v_fmac_f32 v237, v58, v122
    v_fmac_f32 v245, v51, v171
    v_fmac_f32 v237, v59, v123
    v_fmac_f32 v245, v52, v172
    v_fmac_f32 v237, v60, v124
    v_fmac_f32 v245, v53, v173
    v_fmac_f32 v237, v61, v125
    v_fmac_f32 v245, v54, v174
    v_fmac_f32 v237, v62, v126
    v_fmac_f32 v245, v55, v175
    v_fmac_f32 v237, v63, v127
    s_cmp_eq_u32 s56, 2
    s_cbranch_scc1 K2_U21
    s_cmp_eq_u32 s56, 3
    s_cbranch_scc1 K2_U31
    s_branch K2_DSP1
K2_FLGR:
    s_sub_u32 s27, s27, 16
    s_cbranch_scc1 K2_END
    buffer_load_dwordx4 v[56:59], v60, s[8:11], s64 offen sc1
    s_branch K2_FLGW
K2_FLGY:
    v_mov_b32 v56, s2
    v_mov_b32 v57, 7178240
    s_mov_b64 exec, 1
    buffer_store_dword v56, v57, s[8:11], 0 offen sc1
    s_mov_b64 exec, -1
    s_branch K2_FLGOK
K2_nul_50:
    s_mov_b32 s58, 63
    s_mov_b32 s36, 0
    s_branch K2_back_53
K2_spin_51:
    s_sub_u32 s27, s27, 1
    s_cbranch_scc1 K2_END
    v_lshl_add_u32 v233, v252, 1, s53
    ds_read_b32 v233, v233
    s_waitcnt lgkmcnt(0)
    s_branch K2_chk_52
K2_dyn_48:
    v_mov_b32 v254, 163296
    v_mov_b32 v255, 1
    v_lshl_add_u32 v233, v252, 1, s53
    s_mov_b64 exec, 1
    ds_add_rtn_u32 v232, v254, v255
    s_mov_b64 exec, -1
    ds_read_b32 v233, v233
    s_waitcnt lgkmcnt(0)
    v_readfirstlane_b32 s58, v232
    s_nop 0
    s_cmp_lt_u32 s58, s22
    s_cbranch_scc0 K2_nul_50
    s_and_b32 s59, s58, 7
    s_lshr_b32 s60, s58, 3
K2_chk_52:
    v_readlane_b32 s61, v233, s59
    s_nop 0
    s_cmp_gt_u32 s61, s60
    s_cbranch_scc0 K2_spin_51
K2_back_53:
    s_mov_b32 s34, 1
    s_branch K2_back_49
K2_rare_54:
    s_cmp_eq_u32 s33, 4
    s_cbranch_scc1 K2_four_56
    s_mov_b32 s49, s48
    s_mov_b32 s51, s48
    s_add_u32 s45, s44, 256
    s_add_u32 s46, s44, 512
    s_add_u32 s47, s44, 768
    s_branch K2_back_55
K2_four_56:
    s_add_u32 s50, s48, 64
    s_add_u32 s51, s48, 96
    s_mov_b32 s46, s44
    s_mov_b32 s47, s44
    s_branch K2_back_55
K2_dum_57:
    v_mov_b32 v232, -1
    s_mov_b32 m0, 163360
    s_mov_b64 exec, 1
    buffer_load_dwordx4 v232, s[16:19], 0 offen lds
    buffer_load_dwordx4 v232, s[16:19], 0 offen lds
    s_mov_b64 exec, -1
    s_branch K2_back_59
K2_a4_58:
    v_add_u32 v254, s48, v230
    ds_read_b32 v254, v254 offset:4
    s_lshr_b32 s65, s3, 27
    s_mul_i32 s66, s22, 2080
    s_lshl_b32 s65, s65, 9
    s_add_u32 s65, s65, s66
    s_add_u32 s65, s65, 65536
    s_mov_b32 m0, s65
    s_mov_b32 exec_hi, 0
    s_waitcnt lgkmcnt(0)
    v_or_b32 v254, v254, v231
    buffer_load_dwordx4 v254, s[16:19], 0 offen  lds
    s_mov_b32 exec_hi, -1
    s_branch K2_b4_60
K2_nul_63:
    s_mov_b32 s58, 63
    s_mov_b32 s36, 0
    s_branch K2_back_66
K2_spin_64:
    s_sub_u32 s27, s27, 1
    s_cbranch_scc1 K2_END
    v_lshl_add_u32 v233, v252, 1, s53
    ds_read_b32 v233, v233
    s_waitcnt lgkmcnt(0)
    s_branch K2_chk_65
K2_dyn_61:
    v_mov_b32 v254, 163296
    v_mov_b32 v255, 1
    v_lshl_add_u32 v233, v252, 1, s53
    s_mov_b64 exec, 1
    ds_add_rtn_u32 v232, v254, v255
    s_mov_b64 exec, -1
    ds_read_b32 v233, v233
    s_waitcnt lgkmcnt(0)
    v_readfirstlane_b32 s58, v232
    s_nop 0
    s_cmp_lt_u32 s58, s22
    s_cbranch_scc0 K2_nul_63
    s_and_b32 s59, s58, 7
    s_lshr_b32 s60, s58, 3
K2_chk_65:
    v_readlane_b32 s61, v233, s59
    s_nop 0
    s_cmp_gt_u32 s61, s60
    s_cbranch_scc0 K2_spin_64
K2_back_66:
    s_mov_b32 s34, 1
    s_branch K2_back_62
K2_rare_67:
    s_cmp_eq_u32 s33, 4
    s_cbranch_scc1 K2_four_69
    s_mov_b32 s49, s48
    s_mov_b32 s51, s48
    s_add_u32 s45, s44, 256
    s_add_u32 s46, s44, 512
    s_add_u32 s47, s44, 768
    s_branch K2_back_68
K2_four_69:
    s_add_u32 s50, s48, 64
    s_add_u32 s51, s48, 96
    s_mov_b32 s46, s44
    s_mov_b32 s47, s44
    s_branch K2_back_68
K2_dum_70:
    v_mov_b32 v232, -1
    s_mov_b32 m0, 163360
    s_mov_b64 exec, 1
    buffer_load_dwordx4 v232, s[16:19], 0 offen lds
    buffer_load_dwordx4 v232, s[16:19], 0 offen lds
    s_mov_b64 exec, -1
    s_branch K2_back_72
K2_a4_71:
    v_add_u32 v254, s48, v230
    ds_read_b32 v254, v254 offset:4
    s_lshr_b32 s65, s3, 27
    s_mul_i32 s66, s22, 2080
    s_lshl_b32 s65, s65, 9
    s_add_u32 s65, s65, s66
    s_add_u32 s65, s65, 65536
    s_mov_b32 m0, s65
    s_mov_b32 exec_hi, 0
    s_waitcnt lgkmcnt(0)
    v_or_b32 v254, v254, v231
    buffer_load_dwordx4 v254, s[16:19], 0 offen  lds
    s_mov_b32 exec_hi, -1
    s_branch K2_b4_73
K2_nul_74:
    s_mov_b32 s58, 63
    s_mov_b32 s36, 0
    s_branch K2_back_77
K2_spin_75:
    s_sub_u32 s27, s27, 1
    s_cbranch_scc1 K2_END
    v_lshl_add_u32 v233, v252, 1, s53
    ds_read_b32 v233, v233
    s_waitcnt lgkmcnt(0)
    s_branch K2_chk_76
K2_rare_78:
    s_cmp_eq_u32 s33, 4
    s_cbranch_scc1 K2_four_80
    s_mov_b32 s49, s48
    s_mov_b32 s51, s48
    s_add_u32 s45, s44, 256
    s_add_u32 s46, s44, 512
    s_add_u32 s47, s44, 768
    s_branch K2_back_79
K2_four_80:
    s_add_u32 s50, s48, 64
    s_add_u32 s51, s48, 96
    s_mov_b32 s46, s44
    s_mov_b32 s47, s44
    s_branch K2_back_79
K2_nul_81:
    s_mov_b32 s58, 63
    s_mov_b32 s36, 0
    s_branch K2_back_84
K2_spin_82:
    s_sub_u32 s27, s27, 1
    s_cbranch_scc1 K2_END
    v_lshl_add_u32 v233, v252, 1, s53
    ds_read_b32 v233, v233
    s_waitcnt lgkmcnt(0)
    s_branch K2_chk_83
K2_rare_85:
    s_cmp_eq_u32 s33, 4
    s_cbranch_scc1 K2_four_87
    s_mov_b32 s49, s48
    s_mov_b32 s51, s48
    s_add_u32 s45, s44, 256
    s_add_u32 s46, s44, 512
    s_add_u32 s47, s44, 768
    s_branch K2_back_86
K2_four_87:
    s_add_u32 s50, s48, 64
    s_add_u32 s51, s48, 96
    s_mov_b32 s46, s44
    s_mov_b32 s47, s44
    s_branch K2_back_86
K2_END:
    s_endpgm
.section .rodata,"a"
.p2align 6
.amdhsa_kernel standalone__tensor_product_equiv_equiformer__graph_kernel
  .amdhsa_next_free_vgpr 256
  .amdhsa_next_free_sgpr 102
  .amdhsa_accum_offset 256
  .amdhsa_group_segment_fixed_size 0
  .amdhsa_kernarg_size 96
  .amdhsa_user_sgpr_count 2
  .amdhsa_user_sgpr_kernarg_segment_ptr 1
  .amdhsa_system_sgpr_workgroup_id_x 1
  .amdhsa_float_denorm_mode_32 3
.end_amdhsa_kernel
```

```asm
; @launch grid=(256,1,1) block=(512,1,1) lds=163840
.amdgcn_target "amdgcn-amd-amdhsa--gfx950"
.text
.globl standalone__tensor_product_equiv_equiformer__graph_kernel
.p2align 8
.type standalone__tensor_product_equiv_equiformer__graph_kernel,@function
standalone__tensor_product_equiv_equiformer__graph_kernel:
    s_cmp_ge_u32 s2, 256
    s_cbranch_scc1 K2_END
    s_load_dwordx16 s[80:95], s[0:1], 0
    s_load_dwordx4 s[96:99], s[0:1], 72
    s_load_dwordx2 s[100:101], s[0:1], 88
    v_lshrrev_b32 v1, 6, v0
    s_mov_b32 s54, s2
    v_readfirstlane_b32 s20, v1
    s_mov_b64 exec, 0
    s_cmp_eq_u32 s20, 0
    s_cbranch_scc1 K2_PAD_S1
    s_cmp_eq_u32 s20, 1
    s_cbranch_scc1 K2_PAD_S2
    s_cmp_eq_u32 s20, 5
    s_cbranch_scc1 K2_PAD_H1
    s_cmp_eq_u32 s20, 6
    s_cbranch_scc1 K2_PAD_H2
    s_cmp_eq_u32 s20, 2
    s_cbranch_scc1 K2_PAD_H3
KS_HOP0:
    s_mov_b64 exec, -1
    v_and_b32 v8, 63, v0
    v_lshlrev_b32 v9, 4, v8
    v_mov_b32 v6, 0
    v_lshlrev_b32 v5, 4, v0
    v_mul_u32_u24 v4, 24, v0
    s_mul_i32 s64, s2, 5120
    s_mul_i32 s65, s2, 7680
    v_mov_b32 v176, v8
    v_mov_b32 v177, v0
    s_mul_i32 s21, s2, 625
    s_add_u32 s22, s21, 640
    s_add_u32 s21, s21, 15
    s_lshr_b32 s21, s21, 4
    s_lshr_b32 s22, s22, 4
    s_sub_u32 s22, s22, s21
    s_movk_i32 s39, 1024
    s_lshl_b32 s37, s20, 13
    s_mov_b32 s53, 163264
    s_lshl_b32 s52, s20, 2
    s_add_u32 s52, s52, s53
    s_add_u32 s68, s37, 0
    s_add_u32 s69, s37, 2048
    s_add_u32 s70, s37, 4096
    s_add_u32 s71, s37, 6144
    s_waitcnt lgkmcnt(0)
    s_mov_b32 s8, s100
    s_and_b32 s9, s101, 0xffff
    s_mov_b32 s10, 37748736
    s_mov_b32 s11, 0x20000
    s_cmp_lg_u32 s20, 7
    s_cbranch_scc1 KS_NOTAG
    s_mov_b32 s24, 7178240
    s_mov_b64 exec, 1
    buffer_load_dword v14, v6, s[8:11], s24 offen sc1
    s_mov_b64 exec, -1
    s_barrier
    v_mov_b32 v76, 0
    v_mov_b32 v77, -1
    v_lshlrev_b32 v78, 2, v8
    v_add_u32 v78, 163072, v78
    s_mov_b64 exec, 0x1ff
    ds_write_b32 v78, v76 offset:192
    s_mov_b64 exec, 0xff
    ds_write_b32 v78, v77 offset:256
    s_mov_b64 exec, -1
    s_mov_b32 exec_hi, 0xffff
    ds_write_b32 v78, v76
    s_mov_b64 exec, 1
    ds_write_b32 v78, v76 offset:228
    s_mov_b64 exec, -1
    s_mov_b64 exec, 1
    v_mov_b32 v12, 163376
    s_mov_b32 s24, 1664525
    s_waitcnt vmcnt(0)
    v_mul_lo_u32 v14, v14, s24
    v_add_u32 v14, 1013904223, v14
    ds_write_b32 v12, v14
KS_TAGOK2:
    s_mov_b64 exec, -1
    s_waitcnt lgkmcnt(0)
    s_barrier
    s_branch KS_B3
KS_H0:
    s_barrier
    s_branch KS_HELP
K2_PAD_S1:
    s_branch KS_HOP0
KS_NOTAG:
    s_cmp_ge_u32 s20, 5
    s_cbranch_scc1 KS_HELP
    s_cmp_ge_u32 s2, 250
    s_cbranch_scc1 KS_IDLE
    s_mov_b32 s40, s88
    s_and_b32 s41, s89, 0xffff
    s_mov_b32 s42, 1280000
    s_mov_b32 s43, 0x20000
    buffer_load_dwordx4 v[12:15], v5, s[40:43], s64 offen
    s_mov_b32 s44, s86
    s_and_b32 s45, s87, 0xffff
    s_mov_b32 s46, 1280000
    s_mov_b32 s47, 0x20000
    s_mov_b32 s48, s82
    s_and_b32 s49, s83, 0xffff
    s_mov_b32 s50, 1920000
    s_mov_b32 s51, 0x20000
    buffer_load_dwordx4 v[16:19], v5, s[44:47], s64 offen
    buffer_load_dwordx4 v[20:23], v4, s[48:51], s65 offen
    buffer_load_dwordx2 v[24:25], v4, s[48:51], s65 offen offset:16
    v_lshlrev_b32 v2, 2, v0
    s_lshl_b32 s64, s64, 3
    v_lshl_add_u32 v3, v0, 7, s64
    v_mov_b32 v7, 1
    s_cmp_eq_u32 s20, 4
    s_cbranch_scc1 KS_NOCLR
    ds_write_b32 v2, v6
KS_NOCLR:
    s_waitcnt lgkmcnt(0)
    s_barrier
    s_mov_b64 exec, 0
    s_cmp_eq_u32 s20, 0
    s_cbranch_scc1 K2_PAD_B3
    s_cmp_eq_u32 s20, 1
    s_cbranch_scc1 K2_PAD_LD
    s_cmp_eq_u32 s20, 2
    s_cbranch_scc1 K2_PAD_NW
    s_cmp_eq_u32 s20, 3
    s_cbranch_scc1 K2_PAD_SC
    s_cmp_eq_u32 s20, 4
    s_cbranch_scc1 K2_PAD_SD
KS_HOP:
    s_mov_b64 exec, -1
    s_mov_b32 s58, 429497
    s_movk_i32 s59, 625
    s_waitcnt vmcnt(3)
    v_mul_u32_u24 v28, s58, v12
    v_lshrrev_b32 v32, 27, v28
    v_bfe_u32 v36, v28, 24, 3
    v_lshlrev_b32 v32, 2, v32
    v_lshl_or_b32 v32, v36, 7, v32
    ds_add_rtn_u32 v36, v32, v7
    v_mul_u32_u24 v29, s58, v13
    v_lshrrev_b32 v33, 27, v29
    v_bfe_u32 v37, v29, 24, 3
    v_lshlrev_b32 v33, 2, v33
    v_lshl_or_b32 v33, v37, 7, v33
    ds_add_rtn_u32 v37, v33, v7
    v_mul_u32_u24 v30, s58, v14
    v_lshrrev_b32 v34, 27, v30
    v_bfe_u32 v38, v30, 24, 3
    v_lshlrev_b32 v34, 2, v34
    v_lshl_or_b32 v34, v38, 7, v34
    ds_add_rtn_u32 v38, v34, v7
    v_mul_u32_u24 v31, s58, v15
    v_lshrrev_b32 v35, 27, v31
    v_bfe_u32 v39, v31, 24, 3
    v_lshlrev_b32 v35, 2, v35
    v_lshl_or_b32 v35, v39, 7, v35
    ds_add_rtn_u32 v39, v35, v7
    v_lshrrev_b32 v28, 24, v28
    v_mad_u32_u24 v28, v28, s59, 15
    v_lshrrev_b32 v28, 4, v28
    v_sub_u32 v28, v12, v28
    v_add_u32 v12, 0, v3
    v_lshl_or_b32 v28, v28, 26, v12
    v_lshrrev_b32 v29, 24, v29
    v_mad_u32_u24 v29, v29, s59, 15
    v_lshrrev_b32 v29, 4, v29
    v_sub_u32 v29, v13, v29
    v_add_u32 v13, 32, v3
    v_lshl_or_b32 v29, v29, 26, v13
    v_lshrrev_b32 v30, 24, v30
    v_mad_u32_u24 v30, v30, s59, 15
    v_lshrrev_b32 v30, 4, v30
    v_sub_u32 v30, v14, v30
    v_add_u32 v14, 64, v3
    v_lshl_or_b32 v30, v30, 26, v14
    v_lshrrev_b32 v31, 24, v31
    v_mad_u32_u24 v31, v31, s59, 15
    v_lshrrev_b32 v31, 4, v31
    v_sub_u32 v31, v15, v31
    v_add_u32 v15, 96, v3
    v_lshl_or_b32 v31, v31, 26, v15
K2_PAD_S2:
    s_cbranch_execz KS_HOP0
    v_mov_b32 v59, 163376
    s_mul_i32 s65, s2, 1152
    s_add_u32 s65, s65, 6291456
    s_mul_i32 s64, s2, 20608
    s_waitcnt lgkmcnt(0)
    s_barrier
    ds_read_b128 v[40:43], v9
    ds_read_b32 v59, v59
    s_waitcnt lgkmcnt(1)
    v_add_u32 v45, v40, v41
    v_add_u32 v46, v45, v42
    v_add_u32 v47, v46, v43
    v_mov_b32 v58, v47
    s_nop 1
    v_add_u32_dpp v58, v58, v58 row_shr:1 row_mask:0xf bank_mask:0xf bound_ctrl:0
    s_nop 1
    v_add_u32_dpp v58, v58, v58 row_shr:2 row_mask:0xf bank_mask:0xf bound_ctrl:0
    s_nop 1
    v_add_u32_dpp v58, v58, v58 row_shr:4 row_mask:0xf bank_mask:0xf bound_ctrl:0
    s_nop 1
    v_add_u32_dpp v58, v58, v58 row_shr:8 row_mask:0xf bank_mask:0xf bound_ctrl:0
    s_nop 1
    v_add_u32_dpp v58, v58, v58 row_bcast:15 row_mask:0xa bank_mask:0xf
    s_nop 1
    v_add_u32_dpp v58, v58, v58 row_bcast:31 row_mask:0xc bank_mask:0xf
    v_sub_u32 v48, v58, v47
    v_add_u32 v49, v48, v40
    v_add_u32 v50, v48, v45
    v_add_u32 v51, v48, v46
    ds_write_b128 v9, v[48:51] offset:1024
    s_waitcnt vmcnt(0) lgkmcnt(1)
    s_cmp_lg_u32 s20, 4
    s_cbranch_scc1 KS_NOPUB
    v_lshl_or_b32 v56, v49, 11, v48
    v_lshl_or_b32 v57, v51, 11, v50
    v_lshl_or_b32 v56, v59, 22, v56
    v_lshl_or_b32 v57, v59, 22, v57
    buffer_store_dwordx4 v[56:59], v9, s[8:11], s65 offen sc1
KS_NOPUB:
    s_waitcnt lgkmcnt(0)
    ds_read_b32 v32, v32 offset:1024
    ds_read_b32 v33, v33 offset:1024
    ds_read_b32 v34, v34 offset:1024
    ds_read_b32 v35, v35 offset:1024
    v_and_b32 v60, 0xffff, v59
    v_and_b32 v61, 0xffff0000, v59
    s_mov_b32 s58, 0xffff0000
    v_mov_b32 v40, v20
    v_lshl_or_b32 v41, v21, 16, v60
    v_or_b32 v42, v61, v16
    v_mov_b32 v43, v28
    v_alignbit_b32 v44, v22, v21, 16
    v_and_or_b32 v45, v22, s58, v60
    v_or_b32 v46, v61, v17
    v_mov_b32 v47, v29
    v_mov_b32 v48, v23
    v_lshl_or_b32 v49, v24, 16, v60
    v_or_b32 v50, v61, v18
    v_mov_b32 v51, v30
    v_alignbit_b32 v52, v25, v24, 16
    v_and_or_b32 v53, v25, s58, v60
    v_or_b32 v54, v61, v19
    v_mov_b32 v55, v31
    s_waitcnt lgkmcnt(0)
    v_add_lshl_u32 v32, v32, v36, 4
    ds_write_b128 v32, v[40:43] offset:2048
    v_add_lshl_u32 v33, v33, v37, 4
    ds_write_b128 v33, v[44:47] offset:2048
    v_add_lshl_u32 v34, v34, v38, 4
    ds_write_b128 v34, v[48:51] offset:2048
    v_add_lshl_u32 v35, v35, v39, 4
    ds_write_b128 v35, v[52:55] offset:2048
    s_waitcnt lgkmcnt(0)
    s_barrier
    ds_read_b128 v[12:15], v5 offset:2048
    ds_read_b128 v[16:19], v5 offset:7168
    ds_read_b128 v[20:23], v5 offset:12288
    ds_read_b128 v[24:27], v5 offset:17408
    s_waitcnt lgkmcnt(3)
    buffer_store_dwordx4 v[12:15], v5, s[8:11], s64 offen sc1
    s_add_u32 s64, s64, 5120
    s_waitcnt lgkmcnt(2)
    buffer_store_dwordx4 v[16:19], v5, s[8:11], s64 offen sc1
    s_add_u32 s64, s64, 5120
    s_waitcnt lgkmcnt(1)
    buffer_store_dwordx4 v[20:23], v5, s[8:11], s64 offen sc1
    s_add_u32 s64, s64, 5120
    s_waitcnt lgkmcnt(0)
    buffer_store_dwordx4 v[24:27], v5, s[8:11], s64 offen sc1
    s_branch KS_JOIN
K2_PAD_B3:
    s_branch KS_HOP
KS_B3:
    v_mov_b32 v59, 163376
    ds_read_b32 v59, v59
    s_waitcnt lgkmcnt(0)
    s_barrier
KS_JOIN:
    v_readfirstlane_b32 s2, v59
    s_mov_b32 s23, 0
    s_mov_b32 s28, 1
    s_mov_b32 s24, 0
    s_mov_b32 s25, 1
K2_CELLS:
    v_lshrrev_b32 v178, 1, v177
    v_min_u32 v178, 249, v178
    v_mul_u32_u24 v72, 1152, v178
    s_and_b32 s58, s54, 7
    s_lshl_b32 s58, s58, 7
    s_lshr_b32 s59, s54, 5
    s_lshl_b32 s59, s59, 4
    s_add_u32 s67, s58, s59
    s_add_u32 s67, s67, 6291456
    buffer_load_dwordx4 v[76:79], v72, s[8:11], s67 offen sc1
    s_cmp_eq_u32 s28, 0
    s_cbranch_scc1 K2_NOSRD
    s_mov_b32 s4, s80
    s_and_b32 s5, s81, 0xffff
    s_mov_b32 s6, 10240000
    s_mov_b32 s7, 0x20000
    s_mov_b32 s12, s96
    s_and_b32 s13, s97, 0xffff
    s_mov_b32 s14, 10240000
    s_mov_b32 s15, 0x20000
    s_mov_b32 s16, s84
    s_and_b32 s17, s85, 0xffff
    s_mov_b32 s18, 10240000
    s_mov_b32 s19, 0x20000
    s_sub_u32 s80, s80, 1024
    s_subb_u32 s81, s81, 0
    s_mov_b32 s72, s80
    s_and_b32 s73, s81, 0xffff
    s_mov_b32 s74, 10241024
    s_mov_b32 s75, 0x20000
    s_mov_b64 exec, 0
    s_cmp_eq_u32 s20, 0
    s_cbranch_scc1 K2_PAD_U20
    s_cmp_eq_u32 s20, 1
    s_cbranch_scc1 K2_PAD_U30
    s_cmp_eq_u32 s20, 2
    s_cbranch_scc1 K2_PAD_U21
    s_cmp_eq_u32 s20, 3
    s_cbranch_scc1 K2_PAD_U31
    s_cmp_eq_u32 s20, 4
    s_cbranch_scc1 K2_PAD_SW
    s_cmp_eq_u32 s20, 5
    s_cbranch_scc1 K2_PAD_TL
    s_cmp_eq_u32 s20, 6
    s_cbranch_scc1 K2_PAD_T2
K2_HOP:
    s_mov_b64 exec, -1
K2_NOSRD:
    v_and_b32 v84, 15, v176
    v_lshrrev_b32 v85, 5, v176
    v_bfe_u32 v86, v176, 4, 1
    v_lshrrev_b32 v87, 2, v84
    v_and_b32 v88, 3, v84
    v_lshl_add_u32 v89, v85, 2, v87
    v_lshlrev_b32 v249, 6, v89
    v_lshl_add_u32 v249, v88, 3, v249
    v_add_u32 v249, 512, v249
    v_lshrrev_b32 v90, 3, v84
    v_lshl_add_u32 v90, v90, 1, v86
    v_sub_u32 v90, v90, 1 clamp
    v_lshlrev_b32 v250, 7, v90
    v_lshl_add_u32 v91, v85, 2, v88
    v_lshl_add_u32 v250, v91, 2, v250
    v_and_b32 v91, 1, v87
    v_lshl_add_u32 v250, v91, 1, v250
    v_lshrrev_b32 v90, 1, v88
    v_lshl_add_u32 v90, v86, 1, v90
    v_bfe_u32 v91, v87, 1, 1
    v_lshlrev_b32 v91, 2, v91
    v_xor_b32 v90, v90, v91
    v_lshlrev_b32 v90, 4, v90
    v_lshl_add_u32 v90, v89, 7, v90
    v_and_b32 v91, 1, v88
    v_lshl_add_u32 v90, v91, 3, v90
    v_add_u32 v246, s37, v90
    v_xor_b32 v247, 64, v246
    v_lshrrev_b32 v90, 3, v176
    v_lshlrev_b32 v251, 2, v90
    v_add_u32 v251, 384, v251
    v_bfe_u32 v90, v90, 1, 1
    v_lshlrev_b32 v90, 2, v90
    v_and_b32 v91, 7, v176
    v_xor_b32 v90, v90, v91
    v_lshlrev_b32 v248, 4, v90
    v_lshlrev_b32 v252, 1, v176
    v_and_b32 v231, 1, v176
    v_lshlrev_b32 v231, 4, v231
    v_lshrrev_b32 v90, 1, v176
    v_lshlrev_b32 v90, 5, v90
    v_add_u32 v230, 512, v90
    s_lshl_b32 s59, s2, 22
    s_mov_b32 s60, 0x40000
    s_bfe_u32 s61, s54, 0x10004
    s_bfe_u32 s62, s54, 0x10003
    s_add_u32 s63, s61, s62
    s_mul_i32 s62, s62, 11
    s_sub_u32 s64, 11, s62
    v_cmp_gt_u32 vcc, 500, v177
    s_nop 0
    s_mov_b64 s[56:57], vcc
K2_POLL:
    s_waitcnt vmcnt(0)
    v_xor_b32 v73, s59, v76
    v_xor_b32 v74, s59, v77
    v_or_b32 v73, v73, v74
    v_xor_b32 v74, s2, v79
    v_lshrrev_b32 v73, 22, v73
    v_or_b32 v73, v73, v74
    v_cmp_ne_u32 vcc, 0, v73
    s_nop 0
    s_cbranch_vccz K2_POLLED
    s_sub_u32 s60, s60, 1
    s_cbranch_scc1 K2_END
    s_mov_b64 exec, vcc
    buffer_load_dwordx4 v[76:79], v72, s[8:11], s67 offen sc1
    s_mov_b64 exec, -1
    s_branch K2_POLL
K2_PAD_LD:
    s_branch KS_HOP
K2_POLLED:
    s_set_gpr_idx_on s61, gpr_idx(SRC0)
    s_nop 0
    v_bfe_u32 v179, v76, s62, 11
    s_set_gpr_idx_idx s63
    s_nop 0
    v_bfe_u32 v73, v76, s64, 11
    s_set_gpr_idx_off
    v_sub_u32 v73, v73, v179
    v_cndmask_b32 v73, 0, v73, s[56:57]
    v_and_b32 v1, 1, v177
    v_add_u32 v1, s23, v1
    v_sub_u32 v180, v73, v1
    v_add_u32 v179, v179, v1
    v_mul_u32_u24 v181, 20608, v178
    v_lshl_add_u32 v181, v179, 4, v181
    v_cmp_lt_i32 s[40:41], 0, v180
    v_add_u32 v182, 32, v181
    s_mov_b32 s65, 0
    s_mov_b64 exec, s[40:41]
    buffer_load_dwordx4 v[0:3], v181, s[8:11], 0 offen offset:0 sc1
    s_mov_b64 exec, -1
    v_cmp_lt_i32 s[42:43], 2, v180
    v_cmp_lt_i32 s[44:45], 4, v180
    v_cmp_lt_i32 s[46:47], 6, v180
    v_cmp_lt_i32 s[48:49], 8, v180
    v_cmp_lt_i32 s[50:51], 10, v180
    v_cmp_lt_i32 s[90:91], 12, v180
    v_cmp_lt_i32 s[92:93], 14, v180
    v_cmp_lt_i32 s[94:95], 16, v180
    v_cmp_lt_i32 s[96:97], 18, v180
    v_add_u32 v183, 64, v181
    v_add_u32 v184, 96, v181
    v_subrev_u32 v62, 1, v180
    v_ashrrev_i32 v62, 1, v62
    v_med3_i32 v62, v62, 0, 9
    s_cmp_eq_u64 s[42:43], 0
    s_cbranch_scc1 K2_LD_DONE
    v_mov_b32 v63, v62
    s_nop 1
    v_add_u32_dpp v63, v63, v63 row_shr:1 row_mask:0xf bank_mask:0xf bound_ctrl:0
    s_nop 1
    v_add_u32_dpp v63, v63, v63 row_shr:2 row_mask:0xf bank_mask:0xf bound_ctrl:0
    s_nop 1
    v_add_u32_dpp v63, v63, v63 row_shr:4 row_mask:0xf bank_mask:0xf bound_ctrl:0
    s_nop 1
    v_add_u32_dpp v63, v63, v63 row_shr:8 row_mask:0xf bank_mask:0xf bound_ctrl:0
    s_nop 1
    v_add_u32_dpp v63, v63, v63 row_bcast:15 row_mask:0xa bank_mask:0xf
    s_nop 1
    v_add_u32_dpp v63, v63, v63 row_bcast:31 row_mask:0xc bank_mask:0xf
    s_lshl_b32 s58, s20, 10
    s_add_u32 s58, s58, 45056
    v_readlane_b32 s59, v63, 63
    v_sub_u32 v63, v63, v62
    v_lshl_add_u32 v64, v63, 2, s58
    v_lshlrev_b32 v63, 5, v63
    v_sub_u32 v63, v182, v63
    s_cmp_gt_u32 s59, 189
    s_cbranch_scc1 K2_LD_GEN
    s_mov_b64 exec, s[42:43]
    s_cbranch_execz K2_LD_L
    ds_write_b32 v64, v63 offset:0
    s_mov_b64 exec, s[44:45]
    s_cbranch_execz K2_LD_L
    ds_write_b32 v64, v63 offset:4
    s_mov_b64 exec, s[46:47]
    s_cbranch_execz K2_LD_L
    ds_write_b32 v64, v63 offset:8
    s_mov_b64 exec, s[48:49]
    s_cbranch_execz K2_LD_L
    ds_write_b32 v64, v63 offset:12
    s_mov_b64 exec, s[50:51]
    s_cbranch_execz K2_LD_L
    ds_write_b32 v64, v63 offset:16
    s_mov_b64 exec, s[90:91]
    s_cbranch_execz K2_LD_L
    ds_write_b32 v64, v63 offset:20
    s_mov_b64 exec, s[92:93]
    s_cbranch_execz K2_LD_L
    ds_write_b32 v64, v63 offset:24
    s_mov_b64 exec, s[94:95]
    s_cbranch_execz K2_LD_L
    ds_write_b32 v64, v63 offset:28
    s_mov_b64 exec, s[96:97]
    s_cbranch_execz K2_LD_L
    ds_write_b32 v64, v63 offset:32
K2_LD_L:
    s_mov_b64 exec, -1
    v_lshl_add_u32 v63, v176, 2, s58
    v_lshlrev_b32 v62, 5, v176
    s_waitcnt lgkmcnt(0)
    ds_read_b32 v64, v63 offset:0
    ds_read_b32 v65, v63 offset:252
    ds_read_b32 v66, v63 offset:504
    s_min_u32 s60, s59, 63
    s_sub_u32 s59, s59, s60
    s_bfm_b64 s[42:43], s60, 0
    s_min_u32 s60, s59, 63
    s_sub_u32 s59, s59, s60
    s_bfm_b64 s[44:45], s60, 0
    s_min_u32 s60, s59, 63
    s_sub_u32 s59, s59, s60
    s_bfm_b64 s[46:47], s60, 0
    s_mov_b64 s[48:49], 0
    s_mov_b32 s65, 1
    s_mov_b32 s60, 0
    s_waitcnt lgkmcnt(2)
    v_add3_u32 v182, v62, v64, s60
    s_mov_b64 exec, s[42:43]
    buffer_load_dwordx4 v[4:7], v182, s[8:11], 0 offen sc1
    s_mov_b32 s60, 2016
    s_waitcnt lgkmcnt(1)
    v_add3_u32 v183, v62, v65, s60
    s_mov_b64 exec, s[44:45]
    buffer_load_dwordx4 v[8:11], v183, s[8:11], 0 offen sc1
    s_mov_b32 s60, 4032
    s_waitcnt lgkmcnt(0)
    v_add3_u32 v184, v62, v66, s60
    s_mov_b64 exec, s[46:47]
    buffer_load_dwordx4 v[12:15], v184, s[8:11], 0 offen sc1
K2_LD_DONE:
    s_mov_b64 exec, -1
    s_cmp_eq_u32 s28, 0
    s_cbranch_scc1 K2_WLATE
    v_lshrrev_b32 v60, 6, v252
    v_bfe_u32 v61, v252, 3, 2
    v_lshl_add_u32 v60, v60, 2, v61
    v_mul_u32_u24 v60, 640, v60
    v_bfe_u32 v61, v252, 5, 1
    v_lshl_add_u32 v60, v61, 5, v60
    v_and_b32 v61, 6, v252
    v_lshl_add_u32 v60, v61, 2, v60
    v_add_u32 v60, 24576, v60
    ds_read_b64_tr_b16 v[136:137], v60 offset:0
    ds_read_b64_tr_b16 v[138:139], v60 offset:5120
    ds_read_b64_tr_b16 v[140:141], v60 offset:64
    ds_read_b64_tr_b16 v[142:143], v60 offset:5184
    ds_read_b64_tr_b16 v[144:145], v60 offset:128
    ds_read_b64_tr_b16 v[146:147], v60 offset:5248
    ds_read_b64_tr_b16 v[148:149], v60 offset:192
    ds_read_b64_tr_b16 v[150:151], v60 offset:5312
    ds_read_b64_tr_b16 v[152:153], v60 offset:256
    ds_read_b64_tr_b16 v[154:155], v60 offset:5376
    ds_read_b64_tr_b16 v[156:157], v60 offset:320
    ds_read_b64_tr_b16 v[158:159], v60 offset:5440
    ds_read_b64_tr_b16 v[160:161], v60 offset:384
    ds_read_b64_tr_b16 v[162:163], v60 offset:5504
    ds_read_b64_tr_b16 v[164:165], v60 offset:448
    ds_read_b64_tr_b16 v[166:167], v60 offset:5568
    ds_read_b64_tr_b16 v[168:169], v60 offset:512
    ds_read_b64_tr_b16 v[170:171], v60 offset:5632
    ds_read_b64_tr_b16 v[172:173], v60 offset:576
    ds_read_b64_tr_b16 v[174:175], v60 offset:5696
    s_waitcnt lgkmcnt(0)
K2_WUNP:
    v_lshlrev_b32 v96, 16, v136
    v_and_b32 v97, 0xffff0000, v136
    v_lshlrev_b32 v98, 16, v137
    v_and_b32 v99, 0xffff0000, v137
    v_lshlrev_b32 v100, 16, v138
    v_and_b32 v101, 0xffff0000, v138
    v_lshlrev_b32 v102, 16, v139
    v_and_b32 v103, 0xffff0000, v139
    v_lshlrev_b32 v104, 16, v140
    v_and_b32 v105, 0xffff0000, v140
    v_lshlrev_b32 v106, 16, v141
    v_and_b32 v107, 0xffff0000, v141
    v_lshlrev_b32 v108, 16, v142
    v_and_b32 v109, 0xffff0000, v142
    v_lshlrev_b32 v110, 16, v143
    v_and_b32 v111, 0xffff0000, v143
    v_lshlrev_b32 v112, 16, v144
    v_and_b32 v113, 0xffff0000, v144
    v_lshlrev_b32 v114, 16, v145
    v_and_b32 v115, 0xffff0000, v145
    v_lshlrev_b32 v116, 16, v146
    v_and_b32 v117, 0xffff0000, v146
    v_lshlrev_b32 v118, 16, v147
    v_and_b32 v119, 0xffff0000, v147
    v_lshlrev_b32 v120, 16, v148
    v_and_b32 v121, 0xffff0000, v148
    v_lshlrev_b32 v122, 16, v149
    v_and_b32 v123, 0xffff0000, v149
    v_lshlrev_b32 v124, 16, v150
    v_and_b32 v125, 0xffff0000, v150
    v_lshlrev_b32 v126, 16, v151
    v_and_b32 v127, 0xffff0000, v151
    v_lshlrev_b32 v128, 16, v152
    v_and_b32 v129, 0xffff0000, v152
    v_lshlrev_b32 v130, 16, v153
    v_and_b32 v131, 0xffff0000, v153
    v_lshlrev_b32 v132, 16, v154
    v_and_b32 v133, 0xffff0000, v154
    v_lshlrev_b32 v134, 16, v155
    v_and_b32 v135, 0xffff0000, v155
    v_lshlrev_b32 v136, 16, v156
    v_and_b32 v137, 0xffff0000, v156
    v_lshlrev_b32 v138, 16, v157
    v_and_b32 v139, 0xffff0000, v157
    v_lshlrev_b32 v140, 16, v158
    v_and_b32 v141, 0xffff0000, v158
    v_lshlrev_b32 v142, 16, v159
    v_and_b32 v143, 0xffff0000, v159
    v_lshlrev_b32 v144, 16, v160
    v_and_b32 v145, 0xffff0000, v160
    v_lshlrev_b32 v146, 16, v161
    v_and_b32 v147, 0xffff0000, v161
    v_lshlrev_b32 v148, 16, v162
    v_and_b32 v149, 0xffff0000, v162
    v_lshlrev_b32 v150, 16, v163
    v_and_b32 v151, 0xffff0000, v163
    v_lshlrev_b32 v152, 16, v164
    v_and_b32 v153, 0xffff0000, v164
    v_lshlrev_b32 v154, 16, v165
    v_and_b32 v155, 0xffff0000, v165
    v_lshlrev_b32 v156, 16, v166
    v_and_b32 v157, 0xffff0000, v166
    v_lshlrev_b32 v158, 16, v167
    v_and_b32 v159, 0xffff0000, v167
    v_lshlrev_b32 v160, 16, v168
    v_and_b32 v161, 0xffff0000, v168
    v_lshlrev_b32 v162, 16, v169
    v_and_b32 v163, 0xffff0000, v169
    v_lshlrev_b32 v164, 16, v170
    v_and_b32 v165, 0xffff0000, v170
    v_lshlrev_b32 v166, 16, v171
    v_and_b32 v167, 0xffff0000, v171
    v_lshlrev_b32 v168, 16, v172
    v_and_b32 v169, 0xffff0000, v172
    v_lshlrev_b32 v170, 16, v173
    v_and_b32 v171, 0xffff0000, v173
    v_lshlrev_b32 v172, 16, v174
    v_and_b32 v173, 0xffff0000, v174
    v_lshlrev_b32 v174, 16, v175
    v_and_b32 v175, 0xffff0000, v175
K2_NOWRAW:
K2_PAD_NW:
    s_cbranch_execz KS_HOP
    v_lshrrev_b32 v179, 2, v181
    v_lshrrev_b32 v185, 2, v182
    v_lshrrev_b32 v186, 2, v183
    v_lshrrev_b32 v187, 2, v184
    s_mov_b32 s66, 7340032
    v_mov_b32 v201, 1
    s_movk_i32 s58, 520
    s_movk_i32 s59, 2080
    s_mov_b32 s60, 0x40000
    s_mov_b32 s61, 0xffff
    v_mov_b32 v202, 65536
    s_cmp_lg_u32 s24, 0
    s_cbranch_scc1 K2_RK_LOAD
    v_cmp_lt_i32 vcc, 20, v180
    s_nop 0
    s_cbranch_vccz K2_NOMORE
    v_mov_b32 v61, 163300
    ds_write_b32 v61, v201
K2_NOMORE:
    s_mov_b32 s62, 82176
    s_cmp_eq_u32 s65, 0
    s_waitcnt vmcnt(3)
    s_cbranch_scc0 K2_ARR
    s_waitcnt vmcnt(0)
K2_ARR:
    s_mov_b64 exec, s[40:41]
    s_cbranch_execz K2_RK_A
K2_CK0:
    v_bfi_b32 v192, s61, v1, v2
    v_lshrrev_b32 v50, 24, v3
    v_cmp_ne_u32 vcc, s2, v192
    v_add_u32 v40, 163072, v50
    s_cbranch_vccnz K2_RT0
    ds_add_rtn_u32 v40, v40, v201
    v_mad_u32_u24 v50, v50, s58, v202
    s_mov_b64 exec, s[42:43]
    s_cbranch_execz K2_RK_A
    s_waitcnt vmcnt(2)
K2_CK1:
    v_bfi_b32 v192, s61, v5, v6
    v_lshrrev_b32 v51, 24, v7
    v_cmp_ne_u32 vcc, s2, v192
    v_add_u32 v41, 163072, v51
    s_cbranch_vccnz K2_RT1
    ds_add_rtn_u32 v41, v41, v201
    v_mad_u32_u24 v51, v51, s58, v202
    s_mov_b64 exec, s[44:45]
    s_cbranch_execz K2_RK_A
    s_waitcnt vmcnt(1)
K2_CK2:
    v_bfi_b32 v192, s61, v9, v10
    v_lshrrev_b32 v52, 24, v11
    v_cmp_ne_u32 vcc, s2, v192
    v_add_u32 v42, 163072, v52
    s_cbranch_vccnz K2_RT2
    ds_add_rtn_u32 v42, v42, v201
    v_mad_u32_u24 v52, v52, s58, v202
    s_mov_b64 exec, s[46:47]
    s_cbranch_execz K2_RK_A
    s_waitcnt vmcnt(0)
K2_CK3:
    v_bfi_b32 v192, s61, v13, v14
    v_lshrrev_b32 v53, 24, v15
    v_cmp_ne_u32 vcc, s2, v192
    v_add_u32 v43, 163072, v53
    s_cbranch_vccnz K2_RT3
    ds_add_rtn_u32 v43, v43, v201
    v_mad_u32_u24 v53, v53, s58, v202
    s_mov_b64 exec, s[48:49]
    s_cbranch_execz K2_RK_A
K2_CK4:
    v_bfi_b32 v192, s61, v17, v18
    v_lshrrev_b32 v54, 24, v19
    v_cmp_ne_u32 vcc, s2, v192
    v_add_u32 v44, 163072, v54
    s_cbranch_vccnz K2_RT4
    ds_add_rtn_u32 v44, v44, v201
    v_mad_u32_u24 v54, v54, s58, v202
    s_mov_b64 exec, s[50:51]
    s_cbranch_execz K2_RK_A
K2_CK5:
    v_bfi_b32 v192, s61, v21, v22
    v_lshrrev_b32 v55, 24, v23
    v_cmp_ne_u32 vcc, s2, v192
    v_add_u32 v45, 163072, v55
    s_cbranch_vccnz K2_RT5
    ds_add_rtn_u32 v45, v45, v201
    v_mad_u32_u24 v55, v55, s58, v202
    s_mov_b64 exec, s[90:91]
    s_cbranch_execz K2_RK_A
K2_CK6:
    v_bfi_b32 v192, s61, v25, v26
    v_lshrrev_b32 v56, 24, v27
    v_cmp_ne_u32 vcc, s2, v192
    v_add_u32 v46, 163072, v56
    s_cbranch_vccnz K2_RT6
    ds_add_rtn_u32 v46, v46, v201
    v_mad_u32_u24 v56, v56, s58, v202
    s_mov_b64 exec, s[92:93]
    s_cbranch_execz K2_RK_A
K2_CK7:
    v_bfi_b32 v192, s61, v29, v30
    v_lshrrev_b32 v57, 24, v31
    v_cmp_ne_u32 vcc, s2, v192
    v_add_u32 v47, 163072, v57
    s_cbranch_vccnz K2_RT7
    ds_add_rtn_u32 v47, v47, v201
    v_mad_u32_u24 v57, v57, s58, v202
    s_mov_b64 exec, s[94:95]
    s_cbranch_execz K2_RK_A
K2_CK8:
    v_bfi_b32 v192, s61, v33, v34
    v_lshrrev_b32 v58, 24, v35
    v_cmp_ne_u32 vcc, s2, v192
    v_add_u32 v48, 163072, v58
    s_cbranch_vccnz K2_RT8
    ds_add_rtn_u32 v48, v48, v201
    v_mad_u32_u24 v58, v58, s58, v202
    s_mov_b64 exec, s[96:97]
    s_cbranch_execz K2_RK_A
K2_CK9:
    v_bfi_b32 v192, s61, v37, v38
    v_lshrrev_b32 v59, 24, v39
    v_cmp_ne_u32 vcc, s2, v192
    v_add_u32 v49, 163072, v59
    s_cbranch_vccnz K2_RT9
    ds_add_rtn_u32 v49, v49, v201
    v_mad_u32_u24 v59, v59, s58, v202
K2_RK_A:
    s_mov_b64 exec, -1
    s_mov_b64 exec, s[40:41]
    s_cbranch_execz K2_TP
    v_cmp_gt_u32 vcc, s62, v50
    v_and_b32 v3, 0xffffff, v3
    s_mov_b64 exec, vcc
    buffer_load_dword v245, v3, s[16:19], 0 offen
    s_mov_b64 exec, s[42:43]
    s_cbranch_execz K2_TP
    v_cmp_gt_u32 vcc, s62, v51
    v_and_b32 v7, 0xffffff, v7
    s_mov_b64 exec, vcc
    buffer_load_dword v245, v7, s[16:19], 0 offen
    s_mov_b64 exec, s[44:45]
    s_cbranch_execz K2_TP
    v_cmp_gt_u32 vcc, s62, v52
    v_and_b32 v11, 0xffffff, v11
    s_mov_b64 exec, vcc
    buffer_load_dword v245, v11, s[16:19], 0 offen
    s_mov_b64 exec, s[46:47]
    s_cbranch_execz K2_TP
    v_cmp_gt_u32 vcc, s62, v53
    v_and_b32 v15, 0xffffff, v15
    s_mov_b64 exec, vcc
    buffer_load_dword v245, v15, s[16:19], 0 offen
    s_mov_b64 exec, s[48:49]
    s_cbranch_execz K2_TP
    v_cmp_gt_u32 vcc, s62, v54
    v_and_b32 v19, 0xffffff, v19
    s_mov_b64 exec, vcc
    buffer_load_dword v245, v19, s[16:19], 0 offen
    s_mov_b64 exec, s[50:51]
    s_cbranch_execz K2_TP
    v_cmp_gt_u32 vcc, s62, v55
    v_and_b32 v23, 0xffffff, v23
    s_mov_b64 exec, vcc
    buffer_load_dword v245, v23, s[16:19], 0 offen
    s_mov_b64 exec, s[90:91]
    s_cbranch_execz K2_TP
    v_cmp_gt_u32 vcc, s62, v56
    v_and_b32 v27, 0xffffff, v27
    s_mov_b64 exec, vcc
    buffer_load_dword v245, v27, s[16:19], 0 offen
    s_mov_b64 exec, s[92:93]
    s_cbranch_execz K2_TP
    v_cmp_gt_u32 vcc, s62, v57
    v_and_b32 v31, 0xffffff, v31
    s_mov_b64 exec, vcc
    buffer_load_dword v245, v31, s[16:19], 0 offen
    s_mov_b64 exec, s[94:95]
    s_cbranch_execz K2_TP
    v_cmp_gt_u32 vcc, s62, v58
    v_and_b32 v35, 0xffffff, v35
    s_mov_b64 exec, vcc
    buffer_load_dword v245, v35, s[16:19], 0 offen
    s_mov_b64 exec, s[96:97]
    s_cbranch_execz K2_TP
    v_cmp_gt_u32 vcc, s62, v59
    v_and_b32 v39, 0xffffff, v39
    s_mov_b64 exec, vcc
    buffer_load_dword v245, v39, s[16:19], 0 offen
K2_TP:
    s_mov_b64 exec, -1
K2_RK_DONE:
K2_PAD_SC:
    s_cbranch_execz KS_HOP
    s_mul_i32 s67, s24, 48
    s_movk_i32 s58, -1532
    s_waitcnt lgkmcnt(0)
    s_mov_b64 exec, s[40:41]
    s_cbranch_execz K2_SC_DONE
    v_cmpx_gt_u32 vcc, 64, v40
    v_bfe_u32 v194, v40, 3, 1
    v_add_u32 v193, 16, v40
    v_lshl_or_b32 v194, v40, 1, v194
    v_bfi_b32 v194, 15, v194, v40
    v_lshrrev_b32 v193, 6, v193
    v_lshl_add_u32 v195, v194, 1, v50
    v_lshl_add_u32 v194, v194, 5, v50
    ds_write_b16 v195, v0
    v_mad_i32_i24 v194, v193, s58, v194
    ds_write_b16_d16_hi v195, v0 offset:128
    ds_write_b16_d16_hi v195, v1 offset:256
    ds_write_b16 v195, v2 offset:384
    ds_write_b32 v194, v3 offset:512
    s_mov_b64 exec, s[42:43]
    s_cbranch_execz K2_SC_DONE
    v_cmpx_gt_u32 vcc, 64, v41
    v_bfe_u32 v194, v41, 3, 1
    v_add_u32 v193, 16, v41
    v_lshl_or_b32 v194, v41, 1, v194
    v_bfi_b32 v194, 15, v194, v41
    v_lshrrev_b32 v193, 6, v193
    v_lshl_add_u32 v195, v194, 1, v51
    v_lshl_add_u32 v194, v194, 5, v51
    ds_write_b16 v195, v4
    v_mad_i32_i24 v194, v193, s58, v194
    ds_write_b16_d16_hi v195, v4 offset:128
    ds_write_b16_d16_hi v195, v5 offset:256
    ds_write_b16 v195, v6 offset:384
    ds_write_b32 v194, v7 offset:512
    s_mov_b64 exec, s[44:45]
    s_cbranch_execz K2_SC_DONE
    v_cmpx_gt_u32 vcc, 64, v42
    v_bfe_u32 v194, v42, 3, 1
    v_add_u32 v193, 16, v42
    v_lshl_or_b32 v194, v42, 1, v194
    v_bfi_b32 v194, 15, v194, v42
    v_lshrrev_b32 v193, 6, v193
    v_lshl_add_u32 v195, v194, 1, v52
    v_lshl_add_u32 v194, v194, 5, v52
    ds_write_b16 v195, v8
    v_mad_i32_i24 v194, v193, s58, v194
    ds_write_b16_d16_hi v195, v8 offset:128
    ds_write_b16_d16_hi v195, v9 offset:256
    ds_write_b16 v195, v10 offset:384
    ds_write_b32 v194, v11 offset:512
    s_mov_b64 exec, s[46:47]
    s_cbranch_execz K2_SC_DONE
    v_cmpx_gt_u32 vcc, 64, v43
    v_bfe_u32 v194, v43, 3, 1
    v_add_u32 v193, 16, v43
    v_lshl_or_b32 v194, v43, 1, v194
    v_bfi_b32 v194, 15, v194, v43
    v_lshrrev_b32 v193, 6, v193
    v_lshl_add_u32 v195, v194, 1, v53
    v_lshl_add_u32 v194, v194, 5, v53
    ds_write_b16 v195, v12
    v_mad_i32_i24 v194, v193, s58, v194
    ds_write_b16_d16_hi v195, v12 offset:128
    ds_write_b16_d16_hi v195, v13 offset:256
    ds_write_b16 v195, v14 offset:384
    ds_write_b32 v194, v15 offset:512
    s_mov_b64 exec, s[48:49]
    s_cbranch_execz K2_SC_DONE
    v_cmpx_gt_u32 vcc, 64, v44
    v_bfe_u32 v194, v44, 3, 1
    v_add_u32 v193, 16, v44
    v_lshl_or_b32 v194, v44, 1, v194
    v_bfi_b32 v194, 15, v194, v44
    v_lshrrev_b32 v193, 6, v193
    v_lshl_add_u32 v195, v194, 1, v54
    v_lshl_add_u32 v194, v194, 5, v54
    ds_write_b16 v195, v16
    v_mad_i32_i24 v194, v193, s58, v194
    ds_write_b16_d16_hi v195, v16 offset:128
    ds_write_b16_d16_hi v195, v17 offset:256
    ds_write_b16 v195, v18 offset:384
    ds_write_b32 v194, v19 offset:512
    s_mov_b64 exec, s[50:51]
    s_cbranch_execz K2_SC_DONE
    v_cmpx_gt_u32 vcc, 64, v45
    v_bfe_u32 v194, v45, 3, 1
    v_add_u32 v193, 16, v45
    v_lshl_or_b32 v194, v45, 1, v194
    v_bfi_b32 v194, 15, v194, v45
    v_lshrrev_b32 v193, 6, v193
    v_lshl_add_u32 v195, v194, 1, v55
    v_lshl_add_u32 v194, v194, 5, v55
    ds_write_b16 v195, v20
    v_mad_i32_i24 v194, v193, s58, v194
    ds_write_b16_d16_hi v195, v20 offset:128
    ds_write_b16_d16_hi v195, v21 offset:256
    ds_write_b16 v195, v22 offset:384
    ds_write_b32 v194, v23 offset:512
    s_mov_b64 exec, s[90:91]
    s_cbranch_execz K2_SC_DONE
    v_cmpx_gt_u32 vcc, 64, v46
    v_bfe_u32 v194, v46, 3, 1
    v_add_u32 v193, 16, v46
    v_lshl_or_b32 v194, v46, 1, v194
    v_bfi_b32 v194, 15, v194, v46
    v_lshrrev_b32 v193, 6, v193
    v_lshl_add_u32 v195, v194, 1, v56
    v_lshl_add_u32 v194, v194, 5, v56
    ds_write_b16 v195, v24
    v_mad_i32_i24 v194, v193, s58, v194
    ds_write_b16_d16_hi v195, v24 offset:128
    ds_write_b16_d16_hi v195, v25 offset:256
    ds_write_b16 v195, v26 offset:384
    ds_write_b32 v194, v27 offset:512
    s_mov_b64 exec, s[92:93]
    s_cbranch_execz K2_SC_DONE
    v_cmpx_gt_u32 vcc, 64, v47
    v_bfe_u32 v194, v47, 3, 1
    v_add_u32 v193, 16, v47
    v_lshl_or_b32 v194, v47, 1, v194
    v_bfi_b32 v194, 15, v194, v47
    v_lshrrev_b32 v193, 6, v193
    v_lshl_add_u32 v195, v194, 1, v57
    v_lshl_add_u32 v194, v194, 5, v57
    ds_write_b16 v195, v28
    v_mad_i32_i24 v194, v193, s58, v194
    ds_write_b16_d16_hi v195, v28 offset:128
    ds_write_b16_d16_hi v195, v29 offset:256
    ds_write_b16 v195, v30 offset:384
    ds_write_b32 v194, v31 offset:512
    s_mov_b64 exec, s[94:95]
    s_cbranch_execz K2_SC_DONE
    v_cmpx_gt_u32 vcc, 64, v48
    v_bfe_u32 v194, v48, 3, 1
    v_add_u32 v193, 16, v48
    v_lshl_or_b32 v194, v48, 1, v194
    v_bfi_b32 v194, 15, v194, v48
    v_lshrrev_b32 v193, 6, v193
    v_lshl_add_u32 v195, v194, 1, v58
    v_lshl_add_u32 v194, v194, 5, v58
    ds_write_b16 v195, v32
    v_mad_i32_i24 v194, v193, s58, v194
    ds_write_b16_d16_hi v195, v32 offset:128
    ds_write_b16_d16_hi v195, v33 offset:256
    ds_write_b16 v195, v34 offset:384
    ds_write_b32 v194, v35 offset:512
    s_mov_b64 exec, s[96:97]
    s_cbranch_execz K2_SC_DONE
    v_cmpx_gt_u32 vcc, 64, v49
    v_bfe_u32 v194, v49, 3, 1
    v_add_u32 v193, 16, v49
    v_lshl_or_b32 v194, v49, 1, v194
    v_bfi_b32 v194, 15, v194, v49
    v_lshrrev_b32 v193, 6, v193
    v_lshl_add_u32 v195, v194, 1, v59
    v_lshl_add_u32 v194, v194, 5, v59
    ds_write_b16 v195, v36
    v_mad_i32_i24 v194, v193, s58, v194
    ds_write_b16_d16_hi v195, v36 offset:128
    ds_write_b16_d16_hi v195, v37 offset:256
    ds_write_b16 v195, v38 offset:384
    ds_write_b32 v194, v39 offset:512
K2_SC_DONE:
    s_mov_b64 exec, -1
K2_PAD_SD:
    s_cbranch_execz KS_HOP
    v_lshlrev_b32 v192, 2, v176
    v_add_u32 v192, 163072, v192
    v_mov_b32 v200, 163300
    s_cmp_eq_u32 s24, 0
    s_cselect_b32 s26, 64, 48
    s_waitcnt lgkmcnt(0)
    s_barrier
    ds_read_b32 v193, v192
    ds_read_b32 v200, v200
    v_cmp_gt_u32 s[56:57], s22, v176
    v_mad_u32_u24 v195, v176, s59, v202
    s_waitcnt lgkmcnt(0)
    v_cndmask_b32 v193, 0, v193, s[56:57]
    v_readfirstlane_b32 s27, v200
    v_cmp_lt_u32 s[62:63], 48, v193
    v_cmp_lt_u32 vcc, 64, v193
    s_bcnt1_i32_b64 s60, s[62:63]
    v_mbcnt_lo_u32_b32 v198, s62, 0
    v_mbcnt_hi_u32_b32 v198, s63, v198
    s_cbranch_vccnz K2_BIG
    s_cmp_gt_u32 s60, 8
    s_cbranch_scc1 K2_BIG
K2_TOK:
    v_subrev_u32 v194, s67, v193
    v_max_i32 v194, 1, v194
    v_min_i32 v194, s26, v194
    v_add_u32 v194, 15, v194
    v_lshrrev_b32 v194, 3, v194
    v_lshl_or_b32 v195, v194, 18, v195
    v_lshl_or_b32 v195, v198, 27, v195
    v_mov_b32 v197, 949376
    v_cndmask_b32 v253, v197, v195, s[56:57]
    s_movk_i32 s40, 0
    s_movk_i32 s41, 256
    s_movk_i32 s42, 512
    s_movk_i32 s43, 768
    s_add_u32 s24, s24, 1
    s_cmp_ge_u32 s24, s25
    s_cselect_b32 s55, 1, 0
    s_cmp_eq_u32 s27, 0
    s_cselect_b32 s55, s55, 0
    s_mov_b32 s27, 0x400000
    s_mov_b32 s38, 0
    s_mov_b32 s34, 0
    s_mov_b32 s35, 0
    s_mov_b32 s36, 1
    s_mov_b32 s31, 0
    s_mov_b32 s58, s20
    v_readlane_b32 s3, v253, s58
    s_lshl_b32 s44, s34, 7
    s_and_b32 s48, s3, 0x3ffff
    s_bfe_u32 s33, s3, 0x30013
    s_mul_i32 s35, s38, 6
    s_cmp_eq_u32 s34, 0
    s_cselect_b32 s35, s35, s48
    s_mov_b32 s45, s44
    s_add_u32 s47, s44, 256
    s_add_u32 s49, s48, 32
    s_add_u32 s60, s48, 64
    s_cmp_eq_u32 s33, 3
    s_cselect_b32 s46, s44, s47
    s_cselect_b32 s50, s60, s48
    s_cselect_b32 s51, s48, s49
    s_sub_u32 s60, s33, 2
    s_cmp_lt_u32 s60, 2
    s_cbranch_scc0 K2_rare_1
K2_back_2:
    v_add_u32 v233, s48, v230
    ds_read_b32 v232, v233
    ds_read_b32 v233, v233 offset:1024
    v_add_u32 v222, s48, v251
    ds_read_b32 v222, v222
    v_add_u32 v224, s49, v251
    ds_read_b32 v224, v224
    v_add_u32 v226, s50, v251
    ds_read_b32 v226, v226
    v_add_u32 v228, s51, v251
    ds_read_b32 v228, v228
    s_waitcnt lgkmcnt(4)
    v_or_b32 v232, v232, v231
    v_or_b32 v233, v233, v231
    s_cmp_lg_u32 s34, 0
    s_cbranch_scc1 K2_dum_4
    s_cmp_eq_u32 s33, 4
    s_cbranch_scc1 K2_a4_5
K2_b4_7:
    s_add_u32 m0, s48, 512
    s_add_u32 s65, s48, 1536
    buffer_load_dwordx4 v232, s[16:19], 0 offen  lds
    s_mov_b32 m0, s65
    s_mov_b32 exec_hi, 0
    buffer_load_dwordx4 v233, s[16:19], 0 offen  lds
    s_mov_b32 exec_hi, -1
K2_back_6:
    s_waitcnt lgkmcnt(3)
    v_mad_u32_u16 v223, v222, s39, v248 op_sel:[1,0,0,0]
    v_mad_u32_u16 v222, v222, s39, v248
    s_waitcnt lgkmcnt(2)
    v_mad_u32_u16 v225, v224, s39, v248 op_sel:[1,0,0,0]
    v_mad_u32_u16 v224, v224, s39, v248
    s_waitcnt lgkmcnt(1)
    v_mad_u32_u16 v227, v226, s39, v248 op_sel:[1,0,0,0]
    v_mad_u32_u16 v226, v226, s39, v248
    s_waitcnt lgkmcnt(0)
    v_mad_u32_u16 v229, v228, s39, v248 op_sel:[1,0,0,0]
    v_mad_u32_u16 v228, v228, s39, v248
    s_mov_b32 m0, s68
    s_nop 0
    buffer_load_dwordx4 v222, s[4:7], s44 offen sc1 lds
    buffer_load_dwordx4 v223, s[72:75], s44 offen offset:1024 sc1 lds
    s_mov_b32 m0, s69
    s_nop 0
    buffer_load_dwordx4 v224, s[4:7], s45 offen sc1 lds
    buffer_load_dwordx4 v225, s[72:75], s45 offen offset:1024 sc1 lds
    s_mov_b32 m0, s70
    s_nop 0
    buffer_load_dwordx4 v226, s[4:7], s46 offen sc1 lds
    buffer_load_dwordx4 v227, s[72:75], s46 offen offset:1024 sc1 lds
    s_mov_b32 m0, s71
    s_nop 0
    buffer_load_dwordx4 v228, s[4:7], s47 offen sc1 lds
    buffer_load_dwordx4 v229, s[72:75], s47 offen offset:1024 sc1 lds
    v_add_u32 v249, s48, v249
    v_add_u32 v250, s48, v250
    s_waitcnt vmcnt(6)
    ds_read_b64_tr_b16 v[176:177], v246 offset:0
    ds_read_b64_tr_b16 v[178:179], v246 offset:1024
    ds_read_b64_tr_b16 v[180:181], v247 offset:0
    ds_read_b64_tr_b16 v[182:183], v247 offset:1024
    ds_read_b64_tr_b16 v[0:1], v249 offset:0
    ds_read_b64_tr_b16 v[2:3], v249 offset:32
    ds_read_u16_d16_hi v16, v250 offset:0
    ds_read_b64_tr_b16 v[4:5], v249 offset:512
    ds_read_b64_tr_b16 v[6:7], v249 offset:544
    ds_read_u16_d16_hi v17, v250 offset:32
    s_mov_b32 s29, s48
    s_mov_b32 s32, s31
    s_mov_b32 s30, s3
    s_mov_b32 s31, s35
    s_bfe_u32 s56, s3, 0x40012
    s_cmp_eq_u32 s56, 5
    s_cbranch_scc1 K2_U20
    s_cmp_eq_u32 s56, 6
    s_cbranch_scc1 K2_U3h0
    s_branch K2_DSP0
K2_PAD_H1:
    s_branch KS_HOP0
KS_HELP:
    s_mov_b32 s30, 0
    s_cmp_eq_u32 s20, 6
    s_cbranch_scc1 KS_RAW
    s_mov_b32 s30, 2
    s_cmp_ge_u32 s2, 170
    s_cbranch_scc1 KS_NOW
    s_mov_b32 s30, 1
    v_and_b32 v1, 15, v8
    v_lshrrev_b32 v3, 4, v8
    s_cmp_ge_u32 s2, 160
    s_cbranch_scc1 K1_WT
    s_cmp_ge_u32 s2, 64
    s_cbranch_scc1 K1_S1
    s_lshr_b32 s24, s2, 3
    s_and_b32 s25, s2, 7
    s_lshr_b32 s26, s25, 2
    s_bfe_u32 s27, s25, 0x10001
    s_and_b32 s28, s25, 1
    s_mov_b32 s60, s92
    s_and_b32 s61, s93, 0xffff
    s_mov_b32 s62, 65536
    s_mov_b32 s63, 0x20000
    s_branch K1_SC
K1_S1:
    s_sub_u32 s29, s2, 64
    s_mul_i32 s24, s29, 43
    s_lshr_b32 s24, s24, 9
    s_mul_i32 s25, s24, 12
    s_sub_u32 s25, s29, s25
    s_cmp_ge_u32 s25, 6
    s_cselect_b32 s26, 1, 0
    s_mul_i32 s27, s26, 6
    s_sub_u32 s27, s25, s27
    s_lshr_b32 s27, s27, 1
    s_and_b32 s28, s25, 1
    s_add_u32 s25, s25, 8
    s_mov_b32 s60, s94
    s_and_b32 s61, s95, 0xffff
    s_mov_b32 s62, 98304
    s_mov_b32 s63, 0x20000
K1_SC:
    s_lshl_b32 s27, s27, 7
    s_lshl_b32 s26, s26, 6
    s_lshl_b32 s28, s28, 4
    s_add_u32 s27, s27, s26
    s_add_u32 s27, s27, s28
    s_lshl_b32 s27, s27, 8
    s_lshl_b32 s26, s24, 5
    s_add_u32 s27, s27, s26
    s_add_u32 s29, s27, 8192
    v_lshlrev_b32 v3, 10, v3
    v_lshl_add_u32 v3, v1, 1, v3
    buffer_load_ushort v64, v3, s[60:63], s27 offen offset:0
    buffer_load_ushort v65, v3, s[60:63], s29 offen offset:0
    buffer_load_ushort v66, v3, s[60:63], s27 offen offset:256
    buffer_load_ushort v67, v3, s[60:63], s29 offen offset:256
    buffer_load_ushort v68, v3, s[60:63], s27 offen offset:512
    buffer_load_ushort v69, v3, s[60:63], s29 offen offset:512
    buffer_load_ushort v70, v3, s[60:63], s27 offen offset:768
    buffer_load_ushort v71, v3, s[60:63], s29 offen offset:768
    s_mul_i32 s24, s24, 20
    s_add_u32 s24, s24, s25
    s_lshl_b32 s24, s24, 10
    s_add_u32 s24, s24, 6946816
    s_branch K1_GO
K1_WT:
    s_sub_u32 s24, s2, 160
    s_lshr_b32 s27, s24, 1
    s_and_b32 s28, s24, 1
    s_lshl_b32 s27, s27, 8
    s_lshl_b32 s28, s28, 6
    s_add_u32 s27, s27, s28
    s_add_u32 s29, s27, 10240
    s_mov_b32 s60, s90
    s_and_b32 s61, s91, 0xffff
    s_mov_b32 s62, 20480
    s_mov_b32 s63, 0x20000
    v_and_b32 v1, 31, v8
    v_lshrrev_b32 v3, 5, v8
    v_mul_u32_u24 v3, 5120, v3
    v_lshl_add_u32 v3, v1, 1, v3
    buffer_load_ushort v64, v3, s[60:63], s27 offen offset:0
    buffer_load_ushort v65, v3, s[60:63], s27 offen offset:1280
    buffer_load_ushort v66, v3, s[60:63], s27 offen offset:2560
    buffer_load_ushort v67, v3, s[60:63], s27 offen offset:3840
    buffer_load_ushort v68, v3, s[60:63], s29 offen offset:0
    buffer_load_ushort v69, v3, s[60:63], s29 offen offset:1280
    buffer_load_ushort v70, v3, s[60:63], s29 offen offset:2560
    buffer_load_ushort v71, v3, s[60:63], s29 offen offset:3840
    s_lshl_b32 s24, s24, 10
    s_add_u32 s24, s24, 7110656
K1_GO:
KS_NOW:
    s_barrier
K2_PAD_H2:
    s_cbranch_execz KS_HOP0
    v_and_b32 v76, 31, v8
    v_lshrrev_b32 v77, 5, v8
    v_cmp_le_u32 vcc, 24, v76
    v_mul_u32_u24 v77, 2080, v77
    v_lshl_add_u32 v78, v76, 4, v77
    v_cndmask_b32 v80, 0, -1, vcc
    v_add_u32 v78, 65536, v78
    v_mov_b32 v81, v80
    v_mov_b32 v82, v80
    v_mov_b32 v83, v80
    v_add_u32 v79, 41600, v78
    ds_write_b128 v78, v[80:83] offset:0
    ds_write_b128 v78, v[80:83] offset:4160
    ds_write_b128 v78, v[80:83] offset:8320
    ds_write_b128 v78, v[80:83] offset:12480
    ds_write_b128 v78, v[80:83] offset:16640
    ds_write_b128 v78, v[80:83] offset:20800
    ds_write_b128 v78, v[80:83] offset:24960
    ds_write_b128 v78, v[80:83] offset:29120
    ds_write_b128 v78, v[80:83] offset:33280
    ds_write_b128 v78, v[80:83] offset:37440
    ds_write_b128 v79, v[80:83] offset:0
    ds_write_b128 v79, v[80:83] offset:4160
    ds_write_b128 v79, v[80:83] offset:8320
    ds_write_b128 v79, v[80:83] offset:12480
    ds_write_b128 v79, v[80:83] offset:16640
    ds_write_b128 v79, v[80:83] offset:20800
    ds_write_b128 v79, v[80:83] offset:24960
    ds_write_b128 v79, v[80:83] offset:29120
    ds_write_b128 v79, v[80:83] offset:33280
    ds_write_b128 v79, v[80:83] offset:37440
KS_FILL:
    v_mov_b32 v59, 163376
    s_barrier
    ds_read_b32 v59, v59
    s_waitcnt vmcnt(0) lgkmcnt(0)
    s_cmp_eq_u32 s30, 0
    s_cbranch_scc1 KS_B3
    s_cmp_eq_u32 s30, 2
    s_cbranch_scc1 KS_NOST
    v_lshl_or_b32 v40, v65, 16, v64
    v_lshl_or_b32 v41, v67, 16, v66
    v_lshl_or_b32 v42, v69, 16, v68
    v_lshl_or_b32 v43, v71, 16, v70
    buffer_store_dwordx4 v[40:43], v9, s[8:11], s24 offen sc1
KS_NOST:
    s_waitcnt lgkmcnt(0)
    s_barrier
    s_lshl_b32 s24, s2, 2
    s_add_u32 s24, s24, 7176192
    s_mov_b64 exec, 1
    s_waitcnt vmcnt(0)
    buffer_store_dword v59, v6, s[8:11], s24 offen sc1
    s_mov_b64 exec, -1
    s_branch KS_JOIN
K2_PAD_H3:
    s_branch KS_HOP0
KS_RAW:
    s_barrier
    s_mov_b32 s60, s90
    s_and_b32 s61, s91, 0xffff
    s_mov_b32 s62, 20480
    s_mov_b32 s63, 0x20000
    v_lshrrev_b32 v10, 3, v8
    v_and_b32 v11, 7, v8
    v_lshlrev_b32 v10, 8, v10
    v_lshl_add_u32 v10, v11, 4, v10
    s_mov_b32 m0, 24576
    s_movk_i32 s24, 0
    buffer_load_dwordx4 v10, s[60:63], s24 offen lds
    s_mov_b32 m0, 25600
    s_movk_i32 s24, 2048
    buffer_load_dwordx4 v10, s[60:63], s24 offen lds
    s_mov_b32 m0, 26624
    s_movk_i32 s24, 4096
    buffer_load_dwordx4 v10, s[60:63], s24 offen lds
    s_mov_b32 m0, 27648
    s_movk_i32 s24, 6144
    buffer_load_dwordx4 v10, s[60:63], s24 offen lds
    s_mov_b32 m0, 28672
    s_movk_i32 s24, 8192
    buffer_load_dwordx4 v10, s[60:63], s24 offen lds
    s_mov_b32 m0, 29696
    s_movk_i32 s24, 10240
    buffer_load_dwordx4 v10, s[60:63], s24 offen lds
    s_mov_b32 m0, 30720
    s_movk_i32 s24, 12288
    buffer_load_dwordx4 v10, s[60:63], s24 offen lds
    s_mov_b32 m0, 31744
    s_movk_i32 s24, 14336
    buffer_load_dwordx4 v10, s[60:63], s24 offen lds
    s_mov_b32 m0, 32768
    s_movk_i32 s24, 16384
    buffer_load_dwordx4 v10, s[60:63], s24 offen lds
    s_mov_b32 m0, 33792
    s_movk_i32 s24, 18432
    buffer_load_dwordx4 v10, s[60:63], s24 offen lds
    s_mov_b32 m0, 152832
    s_movk_i32 s24, 128
    buffer_load_dwordx4 v10, s[60:63], s24 offen lds
    s_mov_b32 m0, 153856
    s_movk_i32 s24, 2176
    buffer_load_dwordx4 v10, s[60:63], s24 offen lds
    s_mov_b32 m0, 154880
    s_movk_i32 s24, 4224
    buffer_load_dwordx4 v10, s[60:63], s24 offen lds
    s_mov_b32 m0, 155904
    s_movk_i32 s24, 6272
    buffer_load_dwordx4 v10, s[60:63], s24 offen lds
    s_mov_b32 m0, 156928
    s_movk_i32 s24, 8320
    buffer_load_dwordx4 v10, s[60:63], s24 offen lds
    s_mov_b32 m0, 157952
    s_movk_i32 s24, 10368
    buffer_load_dwordx4 v10, s[60:63], s24 offen lds
    s_mov_b32 m0, 158976
    s_movk_i32 s24, 12416
    buffer_load_dwordx4 v10, s[60:63], s24 offen lds
    s_mov_b32 m0, 160000
    s_movk_i32 s24, 14464
    buffer_load_dwordx4 v10, s[60:63], s24 offen lds
    s_mov_b32 m0, 161024
    s_movk_i32 s24, 16512
    buffer_load_dwordx4 v10, s[60:63], s24 offen lds
    s_mov_b32 m0, 162048
    s_movk_i32 s24, 18560
    buffer_load_dwordx4 v10, s[60:63], s24 offen lds
    v_add_u32 v85, 16, v8
    v_lshlrev_b32 v84, 5, v8
    v_lshrrev_b32 v85, 6, v85
    v_mul_u32_u24 v85, 1532, v85
    v_sub_u32 v84, v84, v85
    v_mov_b32 v85, -1
    v_add_u32 v84, 66048, v84
    v_add_u32 v86, 41600, v84
    ds_write_b32 v84, v85 offset:0
    ds_write_b32 v84, v85 offset:2080
    ds_write_b32 v84, v85 offset:4160
    ds_write_b32 v84, v85 offset:6240
    ds_write_b32 v84, v85 offset:8320
    ds_write_b32 v84, v85 offset:10400
    ds_write_b32 v84, v85 offset:12480
    ds_write_b32 v84, v85 offset:14560
    ds_write_b32 v84, v85 offset:16640
    ds_write_b32 v84, v85 offset:18720
    ds_write_b32 v84, v85 offset:20800
    ds_write_b32 v84, v85 offset:22880
    ds_write_b32 v84, v85 offset:24960
    ds_write_b32 v84, v85 offset:27040
    ds_write_b32 v84, v85 offset:29120
    ds_write_b32 v84, v85 offset:31200
    ds_write_b32 v84, v85 offset:33280
    ds_write_b32 v84, v85 offset:35360
    ds_write_b32 v84, v85 offset:37440
    ds_write_b32 v84, v85 offset:39520
    ds_write_b32 v86, v85 offset:0
    ds_write_b32 v86, v85 offset:2080
    ds_write_b32 v86, v85 offset:4160
    ds_write_b32 v86, v85 offset:6240
    ds_write_b32 v86, v85 offset:8320
    ds_write_b32 v86, v85 offset:10400
    ds_write_b32 v86, v85 offset:12480
    ds_write_b32 v86, v85 offset:14560
    ds_write_b32 v86, v85 offset:16640
    ds_write_b32 v86, v85 offset:18720
    ds_write_b32 v86, v85 offset:20800
    ds_write_b32 v86, v85 offset:22880
    ds_write_b32 v86, v85 offset:24960
    ds_write_b32 v86, v85 offset:27040
    ds_write_b32 v86, v85 offset:29120
    ds_write_b32 v86, v85 offset:31200
    ds_write_b32 v86, v85 offset:33280
    ds_write_b32 v86, v85 offset:35360
    ds_write_b32 v86, v85 offset:37440
    ds_write_b32 v86, v85 offset:39520
    s_branch KS_FILL
KS_IDLE:
    s_barrier
    s_barrier
    s_branch KS_B3
K2_PAD_U20:
    s_branch K2_HOP
K2_U20:
    s_setprio 1
    s_waitcnt lgkmcnt(0)
    v_lshlrev_b32 v20, 16, v0
    v_and_b32 v21, 0xffff0000, v0
    v_lshlrev_b32 v22, 16, v1
    v_and_b32 v23, 0xffff0000, v1
    v_lshlrev_b32 v24, 16, v2
    v_and_b32 v25, 0xffff0000, v2
    v_lshlrev_b32 v26, 16, v3
    v_and_b32 v27, 0xffff0000, v3
    v_mul_f32_dpp v36, v16, v20 row_newbcast:8 row_mask:0xf bank_mask:0xf
    v_mul_f32_dpp v37, v16, v21 row_newbcast:9 row_mask:0xf bank_mask:0xf
    v_mul_f32_dpp v38, v16, v22 row_newbcast:10 row_mask:0xf bank_mask:0xf
    v_mul_f32_dpp v39, v16, v23 row_newbcast:11 row_mask:0xf bank_mask:0xf
    v_mul_f32_dpp v40, v16, v24 row_newbcast:12 row_mask:0xf bank_mask:0xf
    v_mul_f32_dpp v41, v16, v25 row_newbcast:13 row_mask:0xf bank_mask:0xf
    v_mul_f32_dpp v42, v16, v26 row_newbcast:14 row_mask:0xf bank_mask:0xf
    v_mul_f32_dpp v43, v16, v27 row_newbcast:15 row_mask:0xf bank_mask:0xf
    v_cvt_pk_bf16_f32 v68, v36, v37
    v_cvt_pk_bf16_f32 v69, v38, v39
    v_cvt_pk_bf16_f32 v70, v40, v41
    v_cvt_pk_bf16_f32 v71, v42, v43
    v_mul_f32_dpp v20, v16, v20 row_newbcast:0 row_mask:0xa bank_mask:0xf
    v_mul_f32_dpp v21, v16, v21 row_newbcast:1 row_mask:0xa bank_mask:0xf
    v_mul_f32_dpp v22, v16, v22 row_newbcast:2 row_mask:0xa bank_mask:0xf
    v_mul_f32_dpp v23, v16, v23 row_newbcast:3 row_mask:0xa bank_mask:0xf
    v_mul_f32_dpp v24, v16, v24 row_newbcast:4 row_mask:0xa bank_mask:0xf
    v_mul_f32_dpp v25, v16, v25 row_newbcast:5 row_mask:0xa bank_mask:0xf
    v_mul_f32_dpp v26, v16, v26 row_newbcast:6 row_mask:0xa bank_mask:0xf
    v_mul_f32_dpp v27, v16, v27 row_newbcast:7 row_mask:0xa bank_mask:0xf
    v_cvt_pk_bf16_f32 v64, v20, v21
    v_cvt_pk_bf16_f32 v65, v22, v23
    v_cvt_pk_bf16_f32 v66, v24, v25
    v_cvt_pk_bf16_f32 v67, v26, v27
    v_lshlrev_b32 v28, 16, v4
    v_and_b32 v29, 0xffff0000, v4
    v_lshlrev_b32 v30, 16, v5
    v_and_b32 v31, 0xffff0000, v5
    v_lshlrev_b32 v32, 16, v6
    v_and_b32 v33, 0xffff0000, v6
    v_lshlrev_b32 v34, 16, v7
    v_and_b32 v35, 0xffff0000, v7
    v_mul_f32_dpp v36, v17, v28 row_newbcast:8 row_mask:0xf bank_mask:0xf
    v_mul_f32_dpp v37, v17, v29 row_newbcast:9 row_mask:0xf bank_mask:0xf
    v_mul_f32_dpp v38, v17, v30 row_newbcast:10 row_mask:0xf bank_mask:0xf
    v_mul_f32_dpp v39, v17, v31 row_newbcast:11 row_mask:0xf bank_mask:0xf
    v_mul_f32_dpp v40, v17, v32 row_newbcast:12 row_mask:0xf bank_mask:0xf
    v_mul_f32_dpp v41, v17, v33 row_newbcast:13 row_mask:0xf bank_mask:0xf
    v_mul_f32_dpp v42, v17, v34 row_newbcast:14 row_mask:0xf bank_mask:0xf
    v_mul_f32_dpp v43, v17, v35 row_newbcast:15 row_mask:0xf bank_mask:0xf
    v_cvt_pk_bf16_f32 v76, v36, v37
    v_cvt_pk_bf16_f32 v77, v38, v39
    v_cvt_pk_bf16_f32 v78, v40, v41
    v_cvt_pk_bf16_f32 v79, v42, v43
    v_mul_f32_dpp v28, v17, v28 row_newbcast:0 row_mask:0xa bank_mask:0xf
    v_mul_f32_dpp v29, v17, v29 row_newbcast:1 row_mask:0xa bank_mask:0xf
    v_mul_f32_dpp v30, v17, v30 row_newbcast:2 row_mask:0xa bank_mask:0xf
    v_mul_f32_dpp v31, v17, v31 row_newbcast:3 row_mask:0xa bank_mask:0xf
    v_mul_f32_dpp v32, v17, v32 row_newbcast:4 row_mask:0xa bank_mask:0xf
    v_mul_f32_dpp v33, v17, v33 row_newbcast:5 row_mask:0xa bank_mask:0xf
    v_mul_f32_dpp v34, v17, v34 row_newbcast:6 row_mask:0xa bank_mask:0xf
    v_mul_f32_dpp v35, v17, v35 row_newbcast:7 row_mask:0xa bank_mask:0xf
    v_cvt_pk_bf16_f32 v72, v28, v29
    v_cvt_pk_bf16_f32 v73, v30, v31
    v_cvt_pk_bf16_f32 v74, v32, v33
    v_cvt_pk_bf16_f32 v75, v34, v35
    s_waitcnt vmcnt(4)
    v_mfma_f32_32x32x16_bf16 v[0:15], v[64:67], v[176:179], 0
    ds_read_b64_tr_b16 v[184:185], v246 offset:2048
    ds_read_b64_tr_b16 v[186:187], v246 offset:3072
    ds_read_b64_tr_b16 v[188:189], v247 offset:2048
    ds_read_b64_tr_b16 v[190:191], v247 offset:3072
    s_mov_b32 m0, s68
    v_mfma_f32_32x32x16_bf16 v[16:31], v[68:71], v[176:179], 0
    buffer_load_dwordx4 v222, s[4:7], s42 offen sc1 lds
    buffer_load_dwordx4 v223, s[72:75], s42 offen offset:1024 sc1 lds
    v_permlane32_swap_b32 v242, v236
    v_permlane32_swap_b32 v243, v237
    s_add_u32 s38, s38, 1
    v_mfma_f32_32x32x16_bf16 v[32:47], v[64:67], v[180:183], 0
    v_permlane32_swap_b32 v244, v238
    v_permlane32_swap_b32 v245, v239
    v_permlane32_swap_b32 v240, v241
    v_add_f32 v242, v242, v236
    v_mfma_f32_32x32x16_bf16 v[48:63], v[68:71], v[180:183], 0
    v_add_f32 v243, v243, v237
    v_add_f32 v244, v244, v238
    v_add_f32 v245, v245, v239
    v_add_f32 v240, -v240, -v241
    v_mov_b32 v254, s52
    v_mov_b32 v255, s38
    s_waitcnt vmcnt(4) lgkmcnt(0)
    v_mfma_f32_32x32x16_bf16 v[0:15], v[72:75], v[184:187], v[0:15]
    ds_read_b64_tr_b16 v[176:177], v246 offset:4096
    ds_read_b64_tr_b16 v[178:179], v246 offset:5120
    ds_read_b64_tr_b16 v[180:181], v247 offset:4096
    ds_read_b64_tr_b16 v[182:183], v247 offset:5120
    s_lshl_b32 s58, s38, 3
    s_add_u32 s58, s58, s20
    s_mov_b32 m0, s69
    v_mfma_f32_32x32x16_bf16 v[16:31], v[76:79], v[184:187], v[16:31]
    buffer_load_dwordx4 v224, s[4:7], s42 offen sc1 lds
    buffer_load_dwordx4 v225, s[72:75], s42 offen offset:1024 sc1 lds
    s_set_gpr_idx_on s32, gpr_idx(DST)
    s_nop 0
    v_cvt_pk_bf16_f32 v195, v242, v243
    v_cvt_pk_bf16_f32 v196, v244, v245
    v_cvt_pk_bf16_f32 v197, v240, v240
    s_set_gpr_idx_off
    s_mov_b64 exec, 1
    ds_write_b32 v254, v255
    s_mov_b64 exec, -1
    s_cmp_lt_u32 s58, s22
    s_cbranch_scc0 K2_dyn_8
K2_back_9:
    v_readlane_b32 s3, v253, s58
    s_lshl_b32 s44, s34, 7
    s_and_b32 s48, s3, 0x3ffff
    s_bfe_u32 s33, s3, 0x30013
    s_mul_i32 s35, s38, 6
    s_cmp_eq_u32 s34, 0
    s_cselect_b32 s35, s35, s48
    s_mov_b32 s45, s44
    s_add_u32 s47, s44, 256
    s_add_u32 s49, s48, 32
    s_add_u32 s60, s48, 64
    s_cmp_eq_u32 s33, 3
    s_cselect_b32 s46, s44, s47
    s_cselect_b32 s50, s60, s48
    s_cselect_b32 s51, s48, s49
    s_sub_u32 s60, s33, 2
    s_cmp_lt_u32 s60, 2
    s_cbranch_scc0 K2_rare_14
K2_back_15:
    v_mfma_f32_32x32x16_bf16 v[32:47], v[72:75], v[188:191], v[32:47]
    v_add_u32 v233, s48, v230
    ds_read_b32 v232, v233
    ds_read_b32 v233, v233 offset:1024
    v_mul_f32 v234, v0, v96
    v_mul_f32 v236, v8, v128
    v_fmac_f32 v234, v1, v97
    v_fmac_f32 v236, v9, v129
    v_mfma_f32_32x32x16_bf16 v[48:63], v[76:79], v[188:191], v[48:63]
    s_setprio 0
    v_fmac_f32 v234, v2, v98
    v_fmac_f32 v236, v10, v130
    v_fmac_f32 v234, v3, v99
    v_fmac_f32 v236, v11, v131
    v_fmac_f32 v234, v4, v100
    v_fmac_f32 v236, v12, v132
    v_fmac_f32 v234, v5, v101
    v_fmac_f32 v236, v13, v133
    v_fmac_f32 v234, v6, v102
    v_fmac_f32 v236, v14, v134
    v_fmac_f32 v234, v7, v103
    v_fmac_f32 v236, v15, v135
    v_mul_f32 v238, v16, v128
    v_mul_f32 v240, v24, v128
    v_fmac_f32 v238, v17, v129
    v_fmac_f32 v240, v25, v129
    v_fmac_f32 v238, v18, v130
    v_fmac_f32 v240, v26, v130
    v_fmac_f32 v238, v19, v131
    v_fmac_f32 v240, v27, v131
    v_fmac_f32 v238, v20, v132
    v_fmac_f32 v240, v28, v132
    v_fmac_f32 v238, v21, v133
    v_fmac_f32 v240, v29, v133
    v_fmac_f32 v238, v22, v134
    v_fmac_f32 v240, v30, v134
    v_fmac_f32 v238, v23, v135
    v_fmac_f32 v240, v31, v135
    v_mul_f32 v235, v32, v104
    v_mul_f32 v237, v40, v136
    v_fmac_f32 v235, v33, v105
    v_fmac_f32 v237, v41, v137
    v_fmac_f32 v235, v34, v106
    v_fmac_f32 v237, v42, v138
    v_fmac_f32 v235, v35, v107
    v_fmac_f32 v237, v43, v139
    v_fmac_f32 v235, v36, v108
    v_fmac_f32 v237, v44, v140
    v_fmac_f32 v235, v37, v109
    v_fmac_f32 v237, v45, v141
    v_fmac_f32 v235, v38, v110
    v_fmac_f32 v237, v46, v142
    v_fmac_f32 v235, v39, v111
    v_fmac_f32 v237, v47, v143
    v_mul_f32 v239, v48, v136
    v_mul_f32 v241, v56, v136
    v_fmac_f32 v239, v49, v137
    v_fmac_f32 v241, v57, v137
    s_setprio 1
    s_waitcnt vmcnt(4) lgkmcnt(3)
    v_mfma_f32_32x32x16_bf16 v[0:15], v[64:67], v[176:179], 0
    ds_read_b64_tr_b16 v[184:185], v246 offset:6144
    ds_read_b64_tr_b16 v[186:187], v246 offset:7168
    ds_read_b64_tr_b16 v[188:189], v247 offset:6144
    ds_read_b64_tr_b16 v[190:191], v247 offset:7168
    v_fmac_f32 v239, v50, v138
    v_fmac_f32 v241, v58, v138
    s_mov_b32 m0, s70
    v_mfma_f32_32x32x16_bf16 v[16:31], v[68:71], v[176:179], 0
    buffer_load_dwordx4 v222, s[4:7], s43 offen sc1 lds
    buffer_load_dwordx4 v223, s[72:75], s43 offen offset:1024 sc1 lds
    v_fmac_f32 v239, v51, v139
    v_fmac_f32 v241, v59, v139
    v_fmac_f32 v239, v52, v140
    v_fmac_f32 v241, v60, v140
    v_fmac_f32 v239, v53, v141
    v_mfma_f32_32x32x16_bf16 v[32:47], v[64:67], v[180:183], 0
    v_add_u32 v222, s48, v251
    ds_read_b32 v222, v222
    v_fmac_f32 v241, v61, v141
    v_fmac_f32 v239, v54, v142
    v_fmac_f32 v241, v62, v142
    v_fmac_f32 v239, v55, v143
    v_fmac_f32 v241, v63, v143
    v_mfma_f32_32x32x16_bf16 v[48:63], v[68:71], v[180:183], 0
    v_permlane32_swap_b32 v234, v236
    v_permlane32_swap_b32 v235, v237
    v_permlane32_swap_b32 v240, v238
    s_waitcnt lgkmcnt(5)
    v_or_b32 v232, v232, v231
    v_or_b32 v233, v233, v231
    s_cmp_lg_u32 s34, 0
    s_cbranch_scc1 K2_dum_17
    s_cmp_eq_u32 s33, 4
    s_cbranch_scc1 K2_a4_18
K2_b4_20:
    s_add_u32 m0, s48, 512
    s_add_u32 s65, s48, 1536
    buffer_load_dwordx4 v232, s[16:19], 0 offen  lds
    s_mov_b32 m0, s65
    s_mov_b32 exec_hi, 0
    buffer_load_dwordx4 v233, s[16:19], 0 offen  lds
    s_mov_b32 exec_hi, -1
K2_back_19:
    s_waitcnt vmcnt(6) lgkmcnt(1)
    v_mfma_f32_32x32x16_bf16 v[0:15], v[72:75], v[184:187], v[0:15]
    ds_read_b64_tr_b16 v[176:177], v246 offset:0
    ds_read_b64_tr_b16 v[178:179], v246 offset:1024
    ds_read_b64_tr_b16 v[180:181], v247 offset:0
    ds_read_b64_tr_b16 v[182:183], v247 offset:1024
    v_permlane32_swap_b32 v241, v239
    s_mov_b32 m0, s71
    v_mfma_f32_32x32x16_bf16 v[16:31], v[76:79], v[184:187], v[16:31]
    buffer_load_dwordx4 v224, s[4:7], s43 offen sc1 lds
    buffer_load_dwordx4 v225, s[72:75], s43 offen offset:1024 sc1 lds
    s_waitcnt lgkmcnt(4)
    v_mad_u32_u16 v223, v222, s39, v248 op_sel:[1,0,0,0]
    v_mad_u32_u16 v222, v222, s39, v248
    v_add_f32 v234, v234, v236
    v_add_f32 v235, v235, v237
    v_add_f32 v240, v240, v238
    v_add_f32 v241, v241, v239
    s_set_gpr_idx_on s31, gpr_idx(DST)
    s_nop 0
    v_cvt_pk_bf16_f32 v192, v234, v235
    v_cvt_pk_bf16_f32 v193, v240, v241
    s_set_gpr_idx_off
    v_mfma_f32_32x32x16_bf16 v[32:47], v[72:75], v[188:191], v[32:47]
    v_add_u32 v224, s49, v251
    ds_read_b32 v224, v224
    v_mul_f32 v234, v0, v144
    v_mul_f32 v236, v8, v112
    v_fmac_f32 v234, v1, v145
    v_fmac_f32 v236, v9, v113
    v_fmac_f32 v234, v2, v146
    v_mfma_f32_32x32x16_bf16 v[48:63], v[76:79], v[188:191], v[48:63]
    s_setprio 0
    v_fmac_f32 v236, v10, v114
    v_fmac_f32 v234, v3, v147
    v_fmac_f32 v236, v11, v115
    v_fmac_f32 v234, v4, v148
    v_fmac_f32 v236, v12, v116
    v_fmac_f32 v234, v5, v149
    v_fmac_f32 v236, v13, v117
    v_fmac_f32 v234, v6, v150
    v_fmac_f32 v236, v14, v118
    v_fmac_f32 v234, v7, v151
    v_fmac_f32 v236, v15, v119
    v_mul_f32 v238, v16, v160
    v_mul_f32 v240, v24, v160
    v_fmac_f32 v238, v17, v161
    v_fmac_f32 v240, v25, v161
    v_fmac_f32 v238, v18, v162
    v_fmac_f32 v240, v26, v162
    v_fmac_f32 v238, v19, v163
    v_fmac_f32 v240, v27, v163
    v_fmac_f32 v238, v20, v164
    v_fmac_f32 v240, v28, v164
    v_fmac_f32 v238, v21, v165
    v_fmac_f32 v240, v29, v165
    v_fmac_f32 v238, v22, v166
    v_fmac_f32 v240, v30, v166
    v_fmac_f32 v238, v23, v167
    v_fmac_f32 v240, v31, v167
    v_mul_f32 v235, v32, v152
    v_mul_f32 v237, v40, v120
    v_fmac_f32 v235, v33, v153
    v_fmac_f32 v237, v41, v121
    v_fmac_f32 v235, v34, v154
    v_fmac_f32 v237, v42, v122
    v_fmac_f32 v235, v35, v155
    v_fmac_f32 v237, v43, v123
    v_fmac_f32 v235, v36, v156
    v_fmac_f32 v237, v44, v124
    v_fmac_f32 v235, v37, v157
    v_fmac_f32 v237, v45, v125
    v_fmac_f32 v235, v38, v158
    v_fmac_f32 v237, v46, v126
    v_fmac_f32 v235, v39, v159
    v_fmac_f32 v237, v47, v127
    v_mul_f32 v239, v48, v168
    v_mul_f32 v241, v56, v168
    v_fmac_f32 v239, v49, v169
    v_fmac_f32 v241, v57, v169
    v_fmac_f32 v239, v50, v170
    v_fmac_f32 v241, v58, v170
    v_fmac_f32 v239, v51, v171
    s_setprio 1
    s_waitcnt vmcnt(6) lgkmcnt(1)
    v_mfma_f32_32x32x16_bf16 v[0:15], v[64:67], v[176:179], 0
    ds_read_b64_tr_b16 v[184:185], v246 offset:2048
    ds_read_b64_tr_b16 v[186:187], v246 offset:3072
    ds_read_b64_tr_b16 v[188:189], v247 offset:2048
    ds_read_b64_tr_b16 v[190:191], v247 offset:3072
    v_fmac_f32 v241, v59, v171
    v_fmac_f32 v239, v52, v172
    s_mov_b32 m0, s68
    v_mfma_f32_32x32x16_bf16 v[16:31], v[68:71], v[176:179], 0
    buffer_load_dwordx4 v222, s[4:7], s44 offen sc1 lds
    buffer_load_dwordx4 v223, s[72:75], s44 offen offset:1024 sc1 lds
    s_waitcnt lgkmcnt(4)
    v_mad_u32_u16 v225, v224, s39, v248 op_sel:[1,0,0,0]
    v_mad_u32_u16 v224, v224, s39, v248
    v_fmac_f32 v241, v60, v172
    v_fmac_f32 v239, v53, v173
    v_mfma_f32_32x32x16_bf16 v[32:47], v[64:67], v[180:183], 0
    v_add_u32 v226, s50, v251
    ds_read_b32 v226, v226
    v_fmac_f32 v241, v61, v173
    v_fmac_f32 v239, v54, v174
    v_fmac_f32 v241, v62, v174
    v_fmac_f32 v239, v55, v175
    v_fmac_f32 v241, v63, v175
    v_mfma_f32_32x32x16_bf16 v[48:63], v[68:71], v[180:183], 0
    s_waitcnt vmcnt(6) lgkmcnt(1)
    v_mfma_f32_32x32x16_bf16 v[0:15], v[72:75], v[184:187], v[0:15]
    ds_read_b64_tr_b16 v[176:177], v246 offset:4096
    ds_read_b64_tr_b16 v[178:179], v246 offset:5120
    ds_read_b64_tr_b16 v[180:181], v247 offset:4096
    ds_read_b64_tr_b16 v[182:183], v247 offset:5120
    s_mov_b32 m0, s69
    v_mfma_f32_32x32x16_bf16 v[16:31], v[76:79], v[184:187], v[16:31]
    buffer_load_dwordx4 v224, s[4:7], s45 offen sc1 lds
    buffer_load_dwordx4 v225, s[72:75], s45 offen offset:1024 sc1 lds
    s_waitcnt lgkmcnt(4)
    v_mad_u32_u16 v227, v226, s39, v248 op_sel:[1,0,0,0]
    v_mad_u32_u16 v226, v226, s39, v248
    v_mfma_f32_32x32x16_bf16 v[32:47], v[72:75], v[188:191], v[32:47]
    v_add_u32 v228, s51, v251
    ds_read_b32 v228, v228
    v_mul_f32 v242, v0, v144
    v_fma_f32 v238, v8, v160, -v238
    v_fmac_f32 v242, v1, v145
    v_fmac_f32 v238, v9, v161
    v_fmac_f32 v242, v2, v146
    v_mfma_f32_32x32x16_bf16 v[48:63], v[76:79], v[188:191], v[48:63]
    s_setprio 0
    v_fmac_f32 v238, v10, v162
    v_fmac_f32 v242, v3, v147
    v_fmac_f32 v238, v11, v163
    v_fmac_f32 v242, v4, v148
    v_fmac_f32 v238, v12, v164
    v_fmac_f32 v242, v5, v149
    v_fmac_f32 v238, v13, v165
    v_fmac_f32 v242, v6, v150
    v_fmac_f32 v238, v14, v166
    v_fmac_f32 v242, v7, v151
    v_fmac_f32 v238, v15, v167
    v_fmac_f32 v236, v16, v112
    v_mul_f32 v244, v24, v160
    v_fmac_f32 v236, v17, v113
    v_fmac_f32 v244, v25, v161
    v_fmac_f32 v236, v18, v114
    v_fmac_f32 v244, v26, v162
    v_fmac_f32 v236, v19, v115
    v_fmac_f32 v244, v27, v163
    v_fmac_f32 v236, v20, v116
    v_fmac_f32 v244, v28, v164
    v_fmac_f32 v236, v21, v117
    v_fmac_f32 v244, v29, v165
    v_fmac_f32 v236, v22, v118
    v_fmac_f32 v244, v30, v166
    v_fmac_f32 v236, v23, v119
    v_fmac_f32 v244, v31, v167
    v_mul_f32 v243, v32, v152
    v_fma_f32 v239, v40, v168, -v239
    v_fmac_f32 v243, v33, v153
    v_fmac_f32 v239, v41, v169
    v_fmac_f32 v243, v34, v154
    v_fmac_f32 v239, v42, v170
    v_fmac_f32 v243, v35, v155
    v_fmac_f32 v239, v43, v171
    v_fmac_f32 v243, v36, v156
    v_fmac_f32 v239, v44, v172
    v_fmac_f32 v243, v37, v157
    v_fmac_f32 v239, v45, v173
    v_fmac_f32 v243, v38, v158
    v_fmac_f32 v239, v46, v174
    v_fmac_f32 v243, v39, v159
    v_fmac_f32 v239, v47, v175
    v_fmac_f32 v237, v48, v120
    v_mul_f32 v245, v56, v168
    v_fmac_f32 v237, v49, v121
    v_fmac_f32 v245, v57, v169
    v_fmac_f32 v237, v50, v122
    s_setprio 1
    s_waitcnt vmcnt(4) lgkmcnt(1)
    v_mfma_f32_32x32x16_bf16 v[0:15], v[64:67], v[176:179], 0
    ds_read_b64_tr_b16 v[184:185], v246 offset:6144
    ds_read_b64_tr_b16 v[186:187], v246 offset:7168
    ds_read_b64_tr_b16 v[188:189], v247 offset:6144
    ds_read_b64_tr_b16 v[190:191], v247 offset:7168
    v_fmac_f32 v245, v58, v170
    v_fmac_f32 v237, v51, v123
    s_mov_b32 m0, s70
    v_mfma_f32_32x32x16_bf16 v[16:31], v[68:71], v[176:179], 0
    buffer_load_dwordx4 v226, s[4:7], s46 offen sc1 lds
    buffer_load_dwordx4 v227, s[72:75], s46 offen offset:1024 sc1 lds
    s_waitcnt lgkmcnt(4)
    v_mad_u32_u16 v229, v228, s39, v248 op_sel:[1,0,0,0]
    v_mad_u32_u16 v228, v228, s39, v248
    v_fmac_f32 v245, v59, v171
    v_fmac_f32 v237, v52, v124
    v_mfma_f32_32x32x16_bf16 v[32:47], v[64:67], v[180:183], 0
    v_fmac_f32 v245, v60, v172
    v_fmac_f32 v237, v53, v125
    v_fmac_f32 v245, v61, v173
    v_fmac_f32 v237, v54, v126
    v_fmac_f32 v245, v62, v174
    v_fmac_f32 v237, v55, v127
    v_fmac_f32 v245, v63, v175
    v_mfma_f32_32x32x16_bf16 v[48:63], v[68:71], v[180:183], 0
    v_permlane32_swap_b32 v242, v234
    v_permlane32_swap_b32 v243, v235
    v_add_f32 v242, v242, v234
    v_add_f32 v243, v243, v235
    s_waitcnt vmcnt(4) lgkmcnt(0)
    v_mfma_f32_32x32x16_bf16 v[0:15], v[72:75], v[184:187], v[0:15]
    ds_read_b64_tr_b16 v[176:177], v246 offset:0
    ds_read_b64_tr_b16 v[178:179], v246 offset:1024
    ds_read_b64_tr_b16 v[180:181], v247 offset:0
    ds_read_b64_tr_b16 v[182:183], v247 offset:1024
    s_sub_u32 s26, s48, s29
    s_mov_b32 s29, s48
    s_mov_b32 m0, s71
    v_mfma_f32_32x32x16_bf16 v[16:31], v[76:79], v[184:187], v[16:31]
    buffer_load_dwordx4 v228, s[4:7], s47 offen sc1 lds
    buffer_load_dwordx4 v229, s[72:75], s47 offen offset:1024 sc1 lds
    s_set_gpr_idx_on s31, gpr_idx(DST)
    s_nop 0
    v_cvt_pk_bf16_f32 v194, v242, v243
    s_set_gpr_idx_off
    s_mov_b32 s30, s3
    s_bfe_u32 s56, s3, 0x40012
    s_cmp_eq_u32 s34, 0
    s_cselect_b32 s56, s56, 0
    v_mfma_f32_32x32x16_bf16 v[32:47], v[72:75], v[188:191], v[32:47]
    s_mov_b32 s32, s31
    s_mov_b32 s31, s35
    v_mul_f32 v242, v0, v144
    v_fma_f32 v240, v8, v160, -v240
    v_fmac_f32 v242, v1, v145
    v_fmac_f32 v240, v9, v161
    v_fmac_f32 v242, v2, v146
    v_mfma_f32_32x32x16_bf16 v[48:63], v[76:79], v[188:191], v[48:63]
    s_setprio 0
    v_fmac_f32 v240, v10, v162
    v_fmac_f32 v242, v3, v147
    v_fmac_f32 v240, v11, v163
    v_fmac_f32 v242, v4, v148
    v_fmac_f32 v240, v12, v164
    v_fmac_f32 v242, v5, v149
    v_fmac_f32 v240, v13, v165
    v_fmac_f32 v242, v6, v150
    v_fmac_f32 v240, v14, v166
    v_fmac_f32 v242, v7, v151
    v_fmac_f32 v240, v15, v167
    v_add_u32 v249, s26, v249
    v_add_u32 v250, s26, v250
    v_fma_f32 v244, v16, v160, -v244
    v_fmac_f32 v236, v24, v112
    v_fmac_f32 v244, v17, v161
    v_fmac_f32 v236, v25, v113
    v_fmac_f32 v244, v18, v162
    v_fmac_f32 v236, v26, v114
    v_fmac_f32 v244, v19, v163
    v_fmac_f32 v236, v27, v115
    v_fmac_f32 v244, v20, v164
    v_fmac_f32 v236, v28, v116
    v_fmac_f32 v244, v21, v165
    v_fmac_f32 v236, v29, v117
    v_fmac_f32 v244, v22, v166
    v_fmac_f32 v236, v30, v118
    v_fmac_f32 v244, v23, v167
    v_fmac_f32 v236, v31, v119
    ds_read_b64_tr_b16 v[0:1], v249 offset:0
    ds_read_b64_tr_b16 v[2:3], v249 offset:32
    ds_read_u16_d16_hi v16, v250 offset:0
    v_mul_f32 v243, v32, v152
    v_fma_f32 v241, v40, v168, -v241
    v_fmac_f32 v243, v33, v153
    v_fmac_f32 v241, v41, v169
    v_fmac_f32 v243, v34, v154
    v_fmac_f32 v241, v42, v170
    v_fmac_f32 v243, v35, v155
    v_fmac_f32 v241, v43, v171
    v_fmac_f32 v243, v36, v156
    v_fmac_f32 v241, v44, v172
    v_fmac_f32 v243, v37, v157
    v_fmac_f32 v241, v45, v173
    v_fmac_f32 v243, v38, v158
    v_fmac_f32 v241, v46, v174
    v_fmac_f32 v243, v39, v159
    v_fmac_f32 v241, v47, v175
    ds_read_b64_tr_b16 v[4:5], v249 offset:512
    ds_read_b64_tr_b16 v[6:7], v249 offset:544
    ds_read_u16_d16_hi v17, v250 offset:32
    v_fma_f32 v245, v48, v168, -v245
    v_fmac_f32 v237, v56, v120
    v_fmac_f32 v245, v49, v169
    v_fmac_f32 v237, v57, v121
    v_fmac_f32 v245, v50, v170
    v_fmac_f32 v237, v58, v122
    v_fmac_f32 v245, v51, v171
    v_fmac_f32 v237, v59, v123
    v_fmac_f32 v245, v52, v172
    v_fmac_f32 v237, v60, v124
    v_fmac_f32 v245, v53, v173
    v_fmac_f32 v237, v61, v125
    v_fmac_f32 v245, v54, v174
    v_fmac_f32 v237, v62, v126
    v_fmac_f32 v245, v55, v175
    v_fmac_f32 v237, v63, v127
    s_cmp_eq_u32 s56, 5
    s_cbranch_scc1 K2_U20
    s_cmp_eq_u32 s56, 6
    s_cbranch_scc1 K2_U3h0
    s_branch K2_DSP0
K2_PAD_U30:
    s_branch K2_HOP
K2_U3h0:
    s_setprio 1
    ds_read_b64_tr_b16 v[8:9], v249 offset:1024
    ds_read_u16_d16_hi v18, v250 offset:64
    s_waitcnt lgkmcnt(2)
    v_lshlrev_b32 v20, 16, v0
    v_and_b32 v21, 0xffff0000, v0
    v_lshlrev_b32 v22, 16, v1
    v_and_b32 v23, 0xffff0000, v1
    v_lshlrev_b32 v24, 16, v2
    v_and_b32 v25, 0xffff0000, v2
    v_lshlrev_b32 v26, 16, v3
    v_and_b32 v27, 0xffff0000, v3
    v_mul_f32_dpp v36, v16, v20 row_newbcast:8 row_mask:0xf bank_mask:0xf
    v_mul_f32_dpp v37, v16, v21 row_newbcast:9 row_mask:0xf bank_mask:0xf
    v_mul_f32_dpp v38, v16, v22 row_newbcast:10 row_mask:0xf bank_mask:0xf
    v_mul_f32_dpp v39, v16, v23 row_newbcast:11 row_mask:0xf bank_mask:0xf
    v_mul_f32_dpp v40, v16, v24 row_newbcast:12 row_mask:0xf bank_mask:0xf
    v_mul_f32_dpp v41, v16, v25 row_newbcast:13 row_mask:0xf bank_mask:0xf
    v_mul_f32_dpp v42, v16, v26 row_newbcast:14 row_mask:0xf bank_mask:0xf
    v_mul_f32_dpp v43, v16, v27 row_newbcast:15 row_mask:0xf bank_mask:0xf
    v_cvt_pk_bf16_f32 v68, v36, v37
    v_cvt_pk_bf16_f32 v69, v38, v39
    v_cvt_pk_bf16_f32 v70, v40, v41
    v_cvt_pk_bf16_f32 v71, v42, v43
    v_mul_f32_dpp v20, v16, v20 row_newbcast:0 row_mask:0xa bank_mask:0xf
    v_mul_f32_dpp v21, v16, v21 row_newbcast:1 row_mask:0xa bank_mask:0xf
    v_mul_f32_dpp v22, v16, v22 row_newbcast:2 row_mask:0xa bank_mask:0xf
    v_mul_f32_dpp v23, v16, v23 row_newbcast:3 row_mask:0xa bank_mask:0xf
    v_mul_f32_dpp v24, v16, v24 row_newbcast:4 row_mask:0xa bank_mask:0xf
    v_mul_f32_dpp v25, v16, v25 row_newbcast:5 row_mask:0xa bank_mask:0xf
    v_mul_f32_dpp v26, v16, v26 row_newbcast:6 row_mask:0xa bank_mask:0xf
    v_mul_f32_dpp v27, v16, v27 row_newbcast:7 row_mask:0xa bank_mask:0xf
    v_cvt_pk_bf16_f32 v64, v20, v21
    v_cvt_pk_bf16_f32 v65, v22, v23
    v_cvt_pk_bf16_f32 v66, v24, v25
    v_cvt_pk_bf16_f32 v67, v26, v27
    v_lshlrev_b32 v28, 16, v4
    v_and_b32 v29, 0xffff0000, v4
    v_lshlrev_b32 v30, 16, v5
    v_and_b32 v31, 0xffff0000, v5
    v_lshlrev_b32 v32, 16, v6
    v_and_b32 v33, 0xffff0000, v6
    v_lshlrev_b32 v34, 16, v7
    v_and_b32 v35, 0xffff0000, v7
    v_mul_f32_dpp v36, v17, v28 row_newbcast:8 row_mask:0xf bank_mask:0xf
    v_mul_f32_dpp v37, v17, v29 row_newbcast:9 row_mask:0xf bank_mask:0xf
    v_mul_f32_dpp v38, v17, v30 row_newbcast:10 row_mask:0xf bank_mask:0xf
    v_mul_f32_dpp v39, v17, v31 row_newbcast:11 row_mask:0xf bank_mask:0xf
    v_mul_f32_dpp v40, v17, v32 row_newbcast:12 row_mask:0xf bank_mask:0xf
    v_mul_f32_dpp v41, v17, v33 row_newbcast:13 row_mask:0xf bank_mask:0xf
    v_mul_f32_dpp v42, v17, v34 row_newbcast:14 row_mask:0xf bank_mask:0xf
    v_mul_f32_dpp v43, v17, v35 row_newbcast:15 row_mask:0xf bank_mask:0xf
    v_cvt_pk_bf16_f32 v76, v36, v37
    v_cvt_pk_bf16_f32 v77, v38, v39
    v_cvt_pk_bf16_f32 v78, v40, v41
    v_cvt_pk_bf16_f32 v79, v42, v43
    v_mul_f32_dpp v28, v17, v28 row_newbcast:0 row_mask:0xa bank_mask:0xf
    v_mul_f32_dpp v29, v17, v29 row_newbcast:1 row_mask:0xa bank_mask:0xf
    v_mul_f32_dpp v30, v17, v30 row_newbcast:2 row_mask:0xa bank_mask:0xf
    v_mul_f32_dpp v31, v17, v31 row_newbcast:3 row_mask:0xa bank_mask:0xf
    v_mul_f32_dpp v32, v17, v32 row_newbcast:4 row_mask:0xa bank_mask:0xf
    v_mul_f32_dpp v33, v17, v33 row_newbcast:5 row_mask:0xa bank_mask:0xf
    v_mul_f32_dpp v34, v17, v34 row_newbcast:6 row_mask:0xa bank_mask:0xf
    v_mul_f32_dpp v35, v17, v35 row_newbcast:7 row_mask:0xa bank_mask:0xf
    v_cvt_pk_bf16_f32 v72, v28, v29
    v_cvt_pk_bf16_f32 v73, v30, v31
    v_cvt_pk_bf16_f32 v74, v32, v33
    v_cvt_pk_bf16_f32 v75, v34, v35
    s_waitcnt lgkmcnt(0)
    v_lshlrev_b32 v20, 16, v8
    v_and_b32 v21, 0xffff0000, v8
    v_lshlrev_b32 v22, 16, v9
    v_and_b32 v23, 0xffff0000, v9
    v_mul_f32_dpp v36, v18, v20 row_newbcast:8 row_mask:0xf bank_mask:0xf
    v_mul_f32_dpp v37, v18, v21 row_newbcast:9 row_mask:0xf bank_mask:0xf
    v_mul_f32_dpp v38, v18, v22 row_newbcast:10 row_mask:0xf bank_mask:0xf
    v_mul_f32_dpp v39, v18, v23 row_newbcast:11 row_mask:0xf bank_mask:0xf
    v_cvt_pk_bf16_f32 v84, v36, v37
    v_cvt_pk_bf16_f32 v85, v38, v39
    v_mul_f32_dpp v20, v18, v20 row_newbcast:0 row_mask:0xa bank_mask:0xf
    v_mul_f32_dpp v21, v18, v21 row_newbcast:1 row_mask:0xa bank_mask:0xf
    v_mul_f32_dpp v22, v18, v22 row_newbcast:2 row_mask:0xa bank_mask:0xf
    v_mul_f32_dpp v23, v18, v23 row_newbcast:3 row_mask:0xa bank_mask:0xf
    v_cvt_pk_bf16_f32 v80, v20, v21
    v_cvt_pk_bf16_f32 v81, v22, v23
    s_waitcnt vmcnt(4)
    v_mfma_f32_32x32x16_bf16 v[0:15], v[64:67], v[176:179], 0
    ds_read_b64_tr_b16 v[184:185], v246 offset:2048
    ds_read_b64_tr_b16 v[186:187], v246 offset:3072
    ds_read_b64_tr_b16 v[188:189], v247 offset:2048
    ds_read_b64_tr_b16 v[190:191], v247 offset:3072
    s_mov_b32 m0, s68
    v_mfma_f32_32x32x16_bf16 v[16:31], v[68:71], v[176:179], 0
    buffer_load_dwordx4 v224, s[4:7], s41 offen sc1 lds
    buffer_load_dwordx4 v225, s[72:75], s41 offen offset:1024 sc1 lds
    v_permlane32_swap_b32 v242, v236
    v_permlane32_swap_b32 v243, v237
    s_add_u32 s38, s38, 1
    v_mfma_f32_32x32x16_bf16 v[32:47], v[64:67], v[180:183], 0
    v_permlane32_swap_b32 v244, v238
    v_permlane32_swap_b32 v245, v239
    v_permlane32_swap_b32 v240, v241
    v_add_f32 v242, v242, v236
    v_mfma_f32_32x32x16_bf16 v[48:63], v[68:71], v[180:183], 0
    v_add_f32 v243, v243, v237
    v_add_f32 v244, v244, v238
    v_add_f32 v245, v245, v239
    v_add_f32 v240, -v240, -v241
    v_mov_b32 v254, s52
    v_mov_b32 v255, s38
    s_waitcnt vmcnt(4) lgkmcnt(0)
    v_mfma_f32_32x32x16_bf16 v[0:15], v[72:75], v[184:187], v[0:15]
    ds_read_b64_tr_b16 v[176:177], v246 offset:4096
    ds_read_b64_tr_b16 v[180:181], v247 offset:4096
    s_lshl_b32 s58, s38, 3
    s_add_u32 s58, s58, s20
    s_mov_b32 m0, s69
    v_mfma_f32_32x32x16_bf16 v[16:31], v[76:79], v[184:187], v[16:31]
    buffer_load_dwordx4 v226, s[4:7], s41 offen sc1 lds
    s_set_gpr_idx_on s32, gpr_idx(DST)
    s_nop 0
    v_cvt_pk_bf16_f32 v195, v242, v243
    v_cvt_pk_bf16_f32 v196, v244, v245
    v_cvt_pk_bf16_f32 v197, v240, v240
    s_set_gpr_idx_off
    s_mov_b64 exec, 1
    ds_write_b32 v254, v255
    s_mov_b64 exec, -1
    s_cmp_lt_u32 s58, s22
    s_cbranch_scc0 K2_dyn_21
K2_back_22:
    v_readlane_b32 s3, v253, s58
    s_lshl_b32 s44, s34, 7
    s_and_b32 s48, s3, 0x3ffff
    s_bfe_u32 s33, s3, 0x30013
    s_mul_i32 s35, s38, 6
    s_cmp_eq_u32 s34, 0
    s_cselect_b32 s35, s35, s48
    s_mov_b32 s45, s44
    s_add_u32 s47, s44, 256
    s_add_u32 s49, s48, 32
    s_add_u32 s60, s48, 64
    s_cmp_eq_u32 s33, 3
    s_cselect_b32 s46, s44, s47
    s_cselect_b32 s50, s60, s48
    s_cselect_b32 s51, s48, s49
    s_sub_u32 s60, s33, 2
    s_cmp_lt_u32 s60, 2
    s_cbranch_scc0 K2_rare_27
K2_back_28:
    v_mfma_f32_32x32x16_bf16 v[32:47], v[72:75], v[188:191], v[32:47]
    v_add_u32 v233, s48, v230
    ds_read_b32 v232, v233
    ds_read_b32 v233, v233 offset:1024
    v_mfma_f32_32x32x16_bf16 v[48:63], v[76:79], v[188:191], v[48:63]
    s_waitcnt vmcnt(3) lgkmcnt(3)
    v_mfma_f32_32x32x8_bf16 v[0:15], v[80:81], v[176:177], v[0:15]
    ds_read_b64_tr_b16 v[184:185], v246 offset:6144
    ds_read_b64_tr_b16 v[186:187], v246 offset:7168
    ds_read_b64_tr_b16 v[188:189], v247 offset:6144
    ds_read_b64_tr_b16 v[190:191], v247 offset:7168
    s_mov_b32 m0, s70
    v_mfma_f32_32x32x8_bf16 v[16:31], v[84:85], v[176:177], v[16:31]
    buffer_load_dwordx4 v222, s[4:7], s42 offen sc1 lds
    buffer_load_dwordx4 v223, s[72:75], s42 offen offset:1024 sc1 lds
    v_mfma_f32_32x32x8_bf16 v[32:47], v[80:81], v[180:181], v[32:47]
    s_nop 2
    v_mul_f32 v234, v0, v96
    v_mul_f32 v236, v8, v128
    v_fmac_f32 v234, v1, v97
    v_fmac_f32 v236, v9, v129
    v_fmac_f32 v234, v2, v98
    v_fmac_f32 v236, v10, v130
    v_fmac_f32 v234, v3, v99
    v_mfma_f32_32x32x8_bf16 v[48:63], v[84:85], v[180:181], v[48:63]
    s_setprio 0
    s_waitcnt lgkmcnt(4)
    v_or_b32 v232, v232, v231
    v_or_b32 v233, v233, v231
    s_cmp_lg_u32 s34, 0
    s_cbranch_scc1 K2_dum_30
    s_cmp_eq_u32 s33, 4
    s_cbranch_scc1 K2_a4_31
K2_b4_33:
    s_add_u32 m0, s48, 512
    s_add_u32 s65, s48, 1536
    buffer_load_dwordx4 v232, s[16:19], 0 offen  lds
    s_mov_b32 m0, s65
    s_mov_b32 exec_hi, 0
    buffer_load_dwordx4 v233, s[16:19], 0 offen  lds
    s_mov_b32 exec_hi, -1
K2_back_32:
    v_fmac_f32 v236, v11, v131
    v_fmac_f32 v234, v4, v100
    v_fmac_f32 v236, v12, v132
    v_fmac_f32 v234, v5, v101
    v_fmac_f32 v236, v13, v133
    v_fmac_f32 v234, v6, v102
    v_fmac_f32 v236, v14, v134
    v_fmac_f32 v234, v7, v103
    v_fmac_f32 v236, v15, v135
    v_mul_f32 v238, v16, v128
    v_mul_f32 v240, v24, v128
    v_fmac_f32 v238, v17, v129
    v_fmac_f32 v240, v25, v129
    v_fmac_f32 v238, v18, v130
    v_fmac_f32 v240, v26, v130
    v_fmac_f32 v238, v19, v131
    v_fmac_f32 v240, v27, v131
    v_fmac_f32 v238, v20, v132
    v_fmac_f32 v240, v28, v132
    v_fmac_f32 v238, v21, v133
    v_fmac_f32 v240, v29, v133
    v_fmac_f32 v238, v22, v134
    v_fmac_f32 v240, v30, v134
    v_fmac_f32 v238, v23, v135
    v_fmac_f32 v240, v31, v135
    v_mul_f32 v235, v32, v104
    v_mul_f32 v237, v40, v136
    v_fmac_f32 v235, v33, v105
    v_fmac_f32 v237, v41, v137
    v_fmac_f32 v235, v34, v106
    v_fmac_f32 v237, v42, v138
    v_fmac_f32 v235, v35, v107
    v_fmac_f32 v237, v43, v139
    v_fmac_f32 v235, v36, v108
    v_fmac_f32 v237, v44, v140
    v_fmac_f32 v235, v37, v109
    v_fmac_f32 v237, v45, v141
    v_fmac_f32 v235, v38, v110
    v_fmac_f32 v237, v46, v142
    v_fmac_f32 v235, v39, v111
    v_fmac_f32 v237, v47, v143
    v_mul_f32 v239, v48, v136
    v_mul_f32 v241, v56, v136
    s_setprio 1
    s_waitcnt vmcnt(5) lgkmcnt(0)
    v_mfma_f32_32x32x16_bf16 v[0:15], v[64:67], v[184:187], 0
    ds_read_b64_tr_b16 v[176:177], v246 offset:0
    ds_read_b64_tr_b16 v[178:179], v246 offset:1024
    ds_read_b64_tr_b16 v[180:181], v247 offset:0
    ds_read_b64_tr_b16 v[182:183], v247 offset:1024
    v_fmac_f32 v239, v49, v137
    v_fmac_f32 v241, v57, v137
    s_mov_b32 m0, s71
    v_mfma_f32_32x32x16_bf16 v[16:31], v[68:71], v[184:187], 0
    buffer_load_dwordx4 v224, s[4:7], s42 offen sc1 lds
    buffer_load_dwordx4 v225, s[72:75], s42 offen offset:1024 sc1 lds
    v_fmac_f32 v239, v50, v138
    v_fmac_f32 v241, v58, v138
    v_fmac_f32 v239, v51, v139
    v_fmac_f32 v241, v59, v139
    v_fmac_f32 v239, v52, v140
    v_mfma_f32_32x32x16_bf16 v[32:47], v[64:67], v[188:191], 0
    v_fmac_f32 v241, v60, v140
    v_fmac_f32 v239, v53, v141
    v_fmac_f32 v241, v61, v141
    v_fmac_f32 v239, v54, v142
    v_fmac_f32 v241, v62, v142
    v_fmac_f32 v239, v55, v143
    v_fmac_f32 v241, v63, v143
    v_mfma_f32_32x32x16_bf16 v[48:63], v[68:71], v[188:191], 0
    v_permlane32_swap_b32 v234, v236
    v_permlane32_swap_b32 v235, v237
    v_permlane32_swap_b32 v240, v238
    s_waitcnt vmcnt(6) lgkmcnt(0)
    v_mfma_f32_32x32x16_bf16 v[0:15], v[72:75], v[176:179], v[0:15]
    ds_read_b64_tr_b16 v[184:185], v246 offset:2048
    ds_read_b64_tr_b16 v[188:189], v247 offset:2048
    v_permlane32_swap_b32 v241, v239
    v_add_f32 v234, v234, v236
    v_add_f32 v235, v235, v237
    s_mov_b32 m0, s68
    v_mfma_f32_32x32x16_bf16 v[16:31], v[76:79], v[176:179], v[16:31]
    buffer_load_dwordx4 v226, s[4:7], s42 offen sc1 lds
    v_add_f32 v240, v240, v238
    v_add_f32 v241, v241, v239
    s_set_gpr_idx_on s31, gpr_idx(DST)
    s_nop 0
    v_cvt_pk_bf16_f32 v192, v234, v235
    v_cvt_pk_bf16_f32 v193, v240, v241
    s_set_gpr_idx_off
    v_mfma_f32_32x32x16_bf16 v[32:47], v[72:75], v[180:183], v[32:47]
    v_mfma_f32_32x32x16_bf16 v[48:63], v[76:79], v[180:183], v[48:63]
    s_waitcnt vmcnt(5) lgkmcnt(0)
    v_mfma_f32_32x32x8_bf16 v[0:15], v[80:81], v[184:185], v[0:15]
    ds_read_b64_tr_b16 v[176:177], v246 offset:4096
    ds_read_b64_tr_b16 v[178:179], v246 offset:5120
    ds_read_b64_tr_b16 v[180:181], v247 offset:4096
    ds_read_b64_tr_b16 v[182:183], v247 offset:5120
    s_mov_b32 m0, s69
    v_mfma_f32_32x32x8_bf16 v[16:31], v[84:85], v[184:185], v[16:31]
    buffer_load_dwordx4 v222, s[4:7], s43 offen sc1 lds
    buffer_load_dwordx4 v223, s[72:75], s43 offen offset:1024 sc1 lds
    v_mfma_f32_32x32x8_bf16 v[32:47], v[80:81], v[188:189], v[32:47]
    s_nop 2
    v_mul_f32 v234, v0, v144
    v_mul_f32 v236, v8, v112
    v_fmac_f32 v234, v1, v145
    v_fmac_f32 v236, v9, v113
    v_fmac_f32 v234, v2, v146
    v_fmac_f32 v236, v10, v114
    v_fmac_f32 v234, v3, v147
    v_mfma_f32_32x32x8_bf16 v[48:63], v[84:85], v[188:189], v[48:63]
    s_setprio 0
    v_fmac_f32 v236, v11, v115
    v_fmac_f32 v234, v4, v148
    v_fmac_f32 v236, v12, v116
    v_fmac_f32 v234, v5, v149
    v_fmac_f32 v236, v13, v117
    v_fmac_f32 v234, v6, v150
    v_fmac_f32 v236, v14, v118
    v_fmac_f32 v234, v7, v151
    v_fmac_f32 v236, v15, v119
    v_mul_f32 v238, v16, v160
    v_mul_f32 v240, v24, v160
    v_fmac_f32 v238, v17, v161
    v_fmac_f32 v240, v25, v161
    v_fmac_f32 v238, v18, v162
    v_fmac_f32 v240, v26, v162
    v_fmac_f32 v238, v19, v163
    v_fmac_f32 v240, v27, v163
    v_fmac_f32 v238, v20, v164
    v_fmac_f32 v240, v28, v164
    v_fmac_f32 v238, v21, v165
    v_fmac_f32 v240, v29, v165
    v_fmac_f32 v238, v22, v166
    v_fmac_f32 v240, v30, v166
    v_fmac_f32 v238, v23, v167
    v_fmac_f32 v240, v31, v167
    v_mul_f32 v235, v32, v152
    v_mul_f32 v237, v40, v120
    v_fmac_f32 v235, v33, v153
    v_fmac_f32 v237, v41, v121
    v_fmac_f32 v235, v34, v154
    v_fmac_f32 v237, v42, v122
    v_fmac_f32 v235, v35, v155
    v_fmac_f32 v237, v43, v123
    v_fmac_f32 v235, v36, v156
    v_fmac_f32 v237, v44, v124
    v_fmac_f32 v235, v37, v157
    v_fmac_f32 v237, v45, v125
    v_fmac_f32 v235, v38, v158
    v_fmac_f32 v237, v46, v126
    v_fmac_f32 v235, v39, v159
    v_fmac_f32 v237, v47, v127
    v_mul_f32 v239, v48, v168
    v_mul_f32 v241, v56, v168
    v_fmac_f32 v239, v49, v169
    v_fmac_f32 v241, v57, v169
    s_setprio 1
    s_waitcnt vmcnt(3) lgkmcnt(0)
    v_mfma_f32_32x32x16_bf16 v[0:15], v[64:67], v[176:179], 0
    ds_read_b64_tr_b16 v[184:185], v246 offset:6144
    ds_read_b64_tr_b16 v[186:187], v246 offset:7168
    ds_read_b64_tr_b16 v[188:189], v247 offset:6144
    ds_read_b64_tr_b16 v[190:191], v247 offset:7168
    v_fmac_f32 v239, v50, v170
    v_fmac_f32 v241, v58, v170
    s_mov_b32 m0, s70
    v_mfma_f32_32x32x16_bf16 v[16:31], v[68:71], v[176:179], 0
    buffer_load_dwordx4 v224, s[4:7], s43 offen sc1 lds
    buffer_load_dwordx4 v225, s[72:75], s43 offen offset:1024 sc1 lds
    v_fmac_f32 v239, v51, v171
    v_fmac_f32 v241, v59, v171
    v_fmac_f32 v239, v52, v172
    v_fmac_f32 v241, v60, v172
    v_fmac_f32 v239, v53, v173
    v_mfma_f32_32x32x16_bf16 v[32:47], v[64:67], v[180:183], 0
    v_add_u32 v222, s48, v251
    ds_read_b32 v222, v222
    v_fmac_f32 v241, v61, v173
    v_fmac_f32 v239, v54, v174
    v_fmac_f32 v241, v62, v174
    v_fmac_f32 v239, v55, v175
    v_fmac_f32 v241, v63, v175
    v_mfma_f32_32x32x16_bf16 v[48:63], v[68:71], v[180:183], 0
    s_waitcnt vmcnt(4) lgkmcnt(1)
    v_mfma_f32_32x32x16_bf16 v[0:15], v[72:75], v[184:187], v[0:15]
    ds_read_b64_tr_b16 v[176:177], v246 offset:0
    ds_read_b64_tr_b16 v[180:181], v247 offset:0
    s_mov_b32 m0, s71
    v_mfma_f32_32x32x16_bf16 v[16:31], v[76:79], v[184:187], v[16:31]
    buffer_load_dwordx4 v226, s[4:7], s43 offen sc1 lds
    s_waitcnt lgkmcnt(2)
    v_mad_u32_u16 v223, v222, s39, v248 op_sel:[1,0,0,0]
    v_mad_u32_u16 v222, v222, s39, v248
    v_mfma_f32_32x32x16_bf16 v[32:47], v[72:75], v[188:191], v[32:47]
    v_add_u32 v224, s49, v251
    ds_read_b32 v224, v224
    v_mfma_f32_32x32x16_bf16 v[48:63], v[76:79], v[188:191], v[48:63]
    s_waitcnt vmcnt(3) lgkmcnt(1)
    v_mfma_f32_32x32x8_bf16 v[0:15], v[80:81], v[176:177], v[0:15]
    ds_read_b64_tr_b16 v[184:185], v246 offset:2048
    ds_read_b64_tr_b16 v[186:187], v246 offset:3072
    ds_read_b64_tr_b16 v[188:189], v247 offset:2048
    ds_read_b64_tr_b16 v[190:191], v247 offset:3072
    s_mov_b32 m0, s68
    v_mfma_f32_32x32x8_bf16 v[16:31], v[84:85], v[176:177], v[16:31]
    buffer_load_dwordx4 v222, s[4:7], s44 offen sc1 lds
    buffer_load_dwordx4 v223, s[72:75], s44 offen offset:1024 sc1 lds
    s_waitcnt lgkmcnt(4)
    v_mad_u32_u16 v225, v224, s39, v248 op_sel:[1,0,0,0]
    v_mad_u32_u16 v224, v224, s39, v248
    v_mfma_f32_32x32x8_bf16 v[32:47], v[80:81], v[180:181], v[32:47]
    v_add_u32 v226, s50, v251
    ds_read_b32 v226, v226
    v_mul_f32 v242, v0, v144
    v_fma_f32 v238, v8, v160, -v238
    v_fmac_f32 v242, v1, v145
    v_fmac_f32 v238, v9, v161
    v_fmac_f32 v242, v2, v146
    v_mfma_f32_32x32x8_bf16 v[48:63], v[84:85], v[180:181], v[48:63]
    s_setprio 0
    v_fmac_f32 v238, v10, v162
    v_fmac_f32 v242, v3, v147
    v_fmac_f32 v238, v11, v163
    v_fmac_f32 v242, v4, v148
    v_fmac_f32 v238, v12, v164
    v_fmac_f32 v242, v5, v149
    v_fmac_f32 v238, v13, v165
    v_fmac_f32 v242, v6, v150
    v_fmac_f32 v238, v14, v166
    v_fmac_f32 v242, v7, v151
    v_fmac_f32 v238, v15, v167
    v_fmac_f32 v236, v16, v112
    v_mul_f32 v244, v24, v160
    v_fmac_f32 v236, v17, v113
    v_fmac_f32 v244, v25, v161
    v_fmac_f32 v236, v18, v114
    v_fmac_f32 v244, v26, v162
    v_fmac_f32 v236, v19, v115
    v_fmac_f32 v244, v27, v163
    v_fmac_f32 v236, v20, v116
    v_fmac_f32 v244, v28, v164
    v_fmac_f32 v236, v21, v117
    v_fmac_f32 v244, v29, v165
    v_fmac_f32 v236, v22, v118
    v_fmac_f32 v244, v30, v166
    v_fmac_f32 v236, v23, v119
    v_fmac_f32 v244, v31, v167
    v_mul_f32 v243, v32, v152
    v_fma_f32 v239, v40, v168, -v239
    v_fmac_f32 v243, v33, v153
    v_fmac_f32 v239, v41, v169
    v_fmac_f32 v243, v34, v154
    v_fmac_f32 v239, v42, v170
    v_fmac_f32 v243, v35, v155
    v_fmac_f32 v239, v43, v171
    v_fmac_f32 v243, v36, v156
    v_fmac_f32 v239, v44, v172
    v_fmac_f32 v243, v37, v157
    v_fmac_f32 v239, v45, v173
    v_fmac_f32 v243, v38, v158
    v_fmac_f32 v239, v46, v174
    v_fmac_f32 v243, v39, v159
    v_fmac_f32 v239, v47, v175
    v_fmac_f32 v237, v48, v120
    v_mul_f32 v245, v56, v168
    v_fmac_f32 v237, v49, v121
    v_fmac_f32 v245, v57, v169
    v_fmac_f32 v237, v50, v122
    v_fmac_f32 v245, v58, v170
    v_fmac_f32 v237, v51, v123
    s_setprio 1
    s_waitcnt vmcnt(3) lgkmcnt(1)
    v_mfma_f32_32x32x16_bf16 v[0:15], v[64:67], v[184:187], 0
    ds_read_b64_tr_b16 v[176:177], v246 offset:4096
    ds_read_b64_tr_b16 v[178:179], v246 offset:5120
    ds_read_b64_tr_b16 v[180:181], v247 offset:4096
    ds_read_b64_tr_b16 v[182:183], v247 offset:5120
    v_fmac_f32 v245, v59, v171
    v_fmac_f32 v237, v52, v124
    s_mov_b32 m0, s69
    v_mfma_f32_32x32x16_bf16 v[16:31], v[68:71], v[184:187], 0
    buffer_load_dwordx4 v224, s[4:7], s45 offen sc1 lds
    buffer_load_dwordx4 v225, s[72:75], s45 offen offset:1024 sc1 lds
    s_waitcnt lgkmcnt(4)
    v_mad_u32_u16 v227, v226, s39, v248 op_sel:[1,0,0,0]
    v_mad_u32_u16 v226, v226, s39, v248
    v_fmac_f32 v245, v60, v172
    v_fmac_f32 v237, v53, v125
    v_mfma_f32_32x32x16_bf16 v[32:47], v[64:67], v[188:191], 0
    v_add_u32 v228, s51, v251
    ds_read_b32 v228, v228
    v_fmac_f32 v245, v61, v173
    v_fmac_f32 v237, v54, v126
    v_fmac_f32 v245, v62, v174
    v_fmac_f32 v237, v55, v127
    v_fmac_f32 v245, v63, v175
    v_mfma_f32_32x32x16_bf16 v[48:63], v[68:71], v[188:191], 0
    v_permlane32_swap_b32 v242, v234
    v_permlane32_swap_b32 v243, v235
    v_add_f32 v242, v242, v234
    v_add_f32 v243, v243, v235
    s_waitcnt vmcnt(4) lgkmcnt(1)
    v_mfma_f32_32x32x16_bf16 v[0:15], v[72:75], v[176:179], v[0:15]
    ds_read_b64_tr_b16 v[184:185], v246 offset:6144
    ds_read_b64_tr_b16 v[188:189], v247 offset:6144
    s_set_gpr_idx_on s31, gpr_idx(DST)
    s_nop 0
    v_cvt_pk_bf16_f32 v194, v242, v243
    s_set_gpr_idx_off
    s_mov_b32 s32, s31
    s_mov_b32 m0, s70
    v_mfma_f32_32x32x16_bf16 v[16:31], v[76:79], v[176:179], v[16:31]
    buffer_load_dwordx4 v226, s[4:7], s46 offen sc1 lds
    buffer_load_dwordx4 v227, s[72:75], s46 offen offset:1024 sc1 lds
    s_waitcnt lgkmcnt(2)
    v_mad_u32_u16 v229, v228, s39, v248 op_sel:[1,0,0,0]
    v_mad_u32_u16 v228, v228, s39, v248
    s_sub_u32 s26, s48, s29
    s_mov_b32 s29, s48
    v_mfma_f32_32x32x16_bf16 v[32:47], v[72:75], v[180:183], v[32:47]
    s_mov_b32 s30, s3
    s_bfe_u32 s56, s3, 0x40012
    s_cmp_eq_u32 s34, 0
    s_cselect_b32 s56, s56, 0
    s_mov_b32 s31, s35
    v_mfma_f32_32x32x16_bf16 v[48:63], v[76:79], v[180:183], v[48:63]
    s_waitcnt vmcnt(4) lgkmcnt(0)
    v_mfma_f32_32x32x8_bf16 v[0:15], v[80:81], v[184:185], v[0:15]
    ds_read_b64_tr_b16 v[176:177], v246 offset:0
    ds_read_b64_tr_b16 v[178:179], v246 offset:1024
    ds_read_b64_tr_b16 v[180:181], v247 offset:0
    ds_read_b64_tr_b16 v[182:183], v247 offset:1024
    s_mov_b32 m0, s71
    v_mfma_f32_32x32x8_bf16 v[16:31], v[84:85], v[184:185], v[16:31]
    buffer_load_dwordx4 v228, s[4:7], s47 offen sc1 lds
    buffer_load_dwordx4 v229, s[72:75], s47 offen offset:1024 sc1 lds
    v_mfma_f32_32x32x8_bf16 v[32:47], v[80:81], v[188:189], v[32:47]
    s_nop 2
    v_mul_f32 v242, v0, v144
    v_fma_f32 v240, v8, v160, -v240
    v_fmac_f32 v242, v1, v145
    v_fmac_f32 v240, v9, v161
    v_fmac_f32 v242, v2, v146
    v_fmac_f32 v240, v10, v162
    v_fmac_f32 v242, v3, v147
    v_mfma_f32_32x32x8_bf16 v[48:63], v[84:85], v[188:189], v[48:63]
    s_setprio 0
    v_fmac_f32 v240, v11, v163
    v_fmac_f32 v242, v4, v148
    v_fmac_f32 v240, v12, v164
    v_fmac_f32 v242, v5, v149
    v_fmac_f32 v240, v13, v165
    v_fmac_f32 v242, v6, v150
    v_fmac_f32 v240, v14, v166
    v_fmac_f32 v242, v7, v151
    v_fmac_f32 v240, v15, v167
    v_add_u32 v249, s26, v249
    v_add_u32 v250, s26, v250
    v_fma_f32 v244, v16, v160, -v244
    v_fmac_f32 v236, v24, v112
    v_fmac_f32 v244, v17, v161
    v_fmac_f32 v236, v25, v113
    v_fmac_f32 v244, v18, v162
    v_fmac_f32 v236, v26, v114
    v_fmac_f32 v244, v19, v163
    v_fmac_f32 v236, v27, v115
    v_fmac_f32 v244, v20, v164
    v_fmac_f32 v236, v28, v116
    v_fmac_f32 v244, v21, v165
    v_fmac_f32 v236, v29, v117
    v_fmac_f32 v244, v22, v166
    v_fmac_f32 v236, v30, v118
    v_fmac_f32 v244, v23, v167
    v_fmac_f32 v236, v31, v119
    ds_read_b64_tr_b16 v[0:1], v249 offset:0
    ds_read_b64_tr_b16 v[2:3], v249 offset:32
    ds_read_u16_d16_hi v16, v250 offset:0
    v_mul_f32 v243, v32, v152
    v_fma_f32 v241, v40, v168, -v241
    v_fmac_f32 v243, v33, v153
    v_fmac_f32 v241, v41, v169
    v_fmac_f32 v243, v34, v154
    v_fmac_f32 v241, v42, v170
    v_fmac_f32 v243, v35, v155
    v_fmac_f32 v241, v43, v171
    v_fmac_f32 v243, v36, v156
    v_fmac_f32 v241, v44, v172
    v_fmac_f32 v243, v37, v157
    v_fmac_f32 v241, v45, v173
    v_fmac_f32 v243, v38, v158
    v_fmac_f32 v241, v46, v174
    v_fmac_f32 v243, v39, v159
    v_fmac_f32 v241, v47, v175
    ds_read_b64_tr_b16 v[4:5], v249 offset:512
    ds_read_b64_tr_b16 v[6:7], v249 offset:544
    ds_read_u16_d16_hi v17, v250 offset:32
    v_fma_f32 v245, v48, v168, -v245
    v_fmac_f32 v237, v56, v120
    v_fmac_f32 v245, v49, v169
    v_fmac_f32 v237, v57, v121
    v_fmac_f32 v245, v50, v170
    v_fmac_f32 v237, v58, v122
    v_fmac_f32 v245, v51, v171
    v_fmac_f32 v237, v59, v123
    v_fmac_f32 v245, v52, v172
    v_fmac_f32 v237, v60, v124
    v_fmac_f32 v245, v53, v173
    v_fmac_f32 v237, v61, v125
    v_fmac_f32 v245, v54, v174
    v_fmac_f32 v237, v62, v126
    v_fmac_f32 v245, v55, v175
    v_fmac_f32 v237, v63, v127
    s_cmp_eq_u32 s56, 5
    s_cbranch_scc1 K2_U20
    s_cmp_eq_u32 s56, 6
    s_cbranch_scc1 K2_U3h0
    s_branch K2_DSP0
K2_U30:
    s_setprio 1
    ds_read_b64_tr_b16 v[8:9], v249 offset:1024
    ds_read_b64_tr_b16 v[10:11], v249 offset:1056
    ds_read_u16_d16_hi v18, v250 offset:64
    s_waitcnt lgkmcnt(3)
    v_lshlrev_b32 v20, 16, v0
    v_and_b32 v21, 0xffff0000, v0
    v_lshlrev_b32 v22, 16, v1
    v_and_b32 v23, 0xffff0000, v1
    v_lshlrev_b32 v24, 16, v2
    v_and_b32 v25, 0xffff0000, v2
    v_lshlrev_b32 v26, 16, v3
    v_and_b32 v27, 0xffff0000, v3
    v_mul_f32_dpp v36, v16, v20 row_newbcast:8 row_mask:0xf bank_mask:0xf
    v_mul_f32_dpp v37, v16, v21 row_newbcast:9 row_mask:0xf bank_mask:0xf
    v_mul_f32_dpp v38, v16, v22 row_newbcast:10 row_mask:0xf bank_mask:0xf
    v_mul_f32_dpp v39, v16, v23 row_newbcast:11 row_mask:0xf bank_mask:0xf
    v_mul_f32_dpp v40, v16, v24 row_newbcast:12 row_mask:0xf bank_mask:0xf
    v_mul_f32_dpp v41, v16, v25 row_newbcast:13 row_mask:0xf bank_mask:0xf
    v_mul_f32_dpp v42, v16, v26 row_newbcast:14 row_mask:0xf bank_mask:0xf
    v_mul_f32_dpp v43, v16, v27 row_newbcast:15 row_mask:0xf bank_mask:0xf
    v_cvt_pk_bf16_f32 v68, v36, v37
    v_cvt_pk_bf16_f32 v69, v38, v39
    v_cvt_pk_bf16_f32 v70, v40, v41
    v_cvt_pk_bf16_f32 v71, v42, v43
    v_mul_f32_dpp v20, v16, v20 row_newbcast:0 row_mask:0xa bank_mask:0xf
    v_mul_f32_dpp v21, v16, v21 row_newbcast:1 row_mask:0xa bank_mask:0xf
    v_mul_f32_dpp v22, v16, v22 row_newbcast:2 row_mask:0xa bank_mask:0xf
    v_mul_f32_dpp v23, v16, v23 row_newbcast:3 row_mask:0xa bank_mask:0xf
    v_mul_f32_dpp v24, v16, v24 row_newbcast:4 row_mask:0xa bank_mask:0xf
    v_mul_f32_dpp v25, v16, v25 row_newbcast:5 row_mask:0xa bank_mask:0xf
    v_mul_f32_dpp v26, v16, v26 row_newbcast:6 row_mask:0xa bank_mask:0xf
    v_mul_f32_dpp v27, v16, v27 row_newbcast:7 row_mask:0xa bank_mask:0xf
    v_cvt_pk_bf16_f32 v64, v20, v21
    v_cvt_pk_bf16_f32 v65, v22, v23
    v_cvt_pk_bf16_f32 v66, v24, v25
    v_cvt_pk_bf16_f32 v67, v26, v27
    v_lshlrev_b32 v28, 16, v4
    v_and_b32 v29, 0xffff0000, v4
    v_lshlrev_b32 v30, 16, v5
    v_and_b32 v31, 0xffff0000, v5
    v_lshlrev_b32 v32, 16, v6
    v_and_b32 v33, 0xffff0000, v6
    v_lshlrev_b32 v34, 16, v7
    v_and_b32 v35, 0xffff0000, v7
    v_mul_f32_dpp v36, v17, v28 row_newbcast:8 row_mask:0xf bank_mask:0xf
    v_mul_f32_dpp v37, v17, v29 row_newbcast:9 row_mask:0xf bank_mask:0xf
    v_mul_f32_dpp v38, v17, v30 row_newbcast:10 row_mask:0xf bank_mask:0xf
    v_mul_f32_dpp v39, v17, v31 row_newbcast:11 row_mask:0xf bank_mask:0xf
    v_mul_f32_dpp v40, v17, v32 row_newbcast:12 row_mask:0xf bank_mask:0xf
    v_mul_f32_dpp v41, v17, v33 row_newbcast:13 row_mask:0xf bank_mask:0xf
    v_mul_f32_dpp v42, v17, v34 row_newbcast:14 row_mask:0xf bank_mask:0xf
    v_mul_f32_dpp v43, v17, v35 row_newbcast:15 row_mask:0xf bank_mask:0xf
    v_cvt_pk_bf16_f32 v76, v36, v37
    v_cvt_pk_bf16_f32 v77, v38, v39
    v_cvt_pk_bf16_f32 v78, v40, v41
    v_cvt_pk_bf16_f32 v79, v42, v43
    v_mul_f32_dpp v28, v17, v28 row_newbcast:0 row_mask:0xa bank_mask:0xf
    v_mul_f32_dpp v29, v17, v29 row_newbcast:1 row_mask:0xa bank_mask:0xf
    v_mul_f32_dpp v30, v17, v30 row_newbcast:2 row_mask:0xa bank_mask:0xf
    v_mul_f32_dpp v31, v17, v31 row_newbcast:3 row_mask:0xa bank_mask:0xf
    v_mul_f32_dpp v32, v17, v32 row_newbcast:4 row_mask:0xa bank_mask:0xf
    v_mul_f32_dpp v33, v17, v33 row_newbcast:5 row_mask:0xa bank_mask:0xf
    v_mul_f32_dpp v34, v17, v34 row_newbcast:6 row_mask:0xa bank_mask:0xf
    v_mul_f32_dpp v35, v17, v35 row_newbcast:7 row_mask:0xa bank_mask:0xf
    v_cvt_pk_bf16_f32 v72, v28, v29
    v_cvt_pk_bf16_f32 v73, v30, v31
    v_cvt_pk_bf16_f32 v74, v32, v33
    v_cvt_pk_bf16_f32 v75, v34, v35
    s_waitcnt lgkmcnt(0)
    v_lshlrev_b32 v20, 16, v8
    v_and_b32 v21, 0xffff0000, v8
    v_lshlrev_b32 v22, 16, v9
    v_and_b32 v23, 0xffff0000, v9
    v_lshlrev_b32 v24, 16, v10
    v_and_b32 v25, 0xffff0000, v10
    v_lshlrev_b32 v26, 16, v11
    v_and_b32 v27, 0xffff0000, v11
    v_mul_f32_dpp v36, v18, v20 row_newbcast:8 row_mask:0xf bank_mask:0xf
    v_mul_f32_dpp v37, v18, v21 row_newbcast:9 row_mask:0xf bank_mask:0xf
    v_mul_f32_dpp v38, v18, v22 row_newbcast:10 row_mask:0xf bank_mask:0xf
    v_mul_f32_dpp v39, v18, v23 row_newbcast:11 row_mask:0xf bank_mask:0xf
    v_mul_f32_dpp v40, v18, v24 row_newbcast:12 row_mask:0xf bank_mask:0xf
    v_mul_f32_dpp v41, v18, v25 row_newbcast:13 row_mask:0xf bank_mask:0xf
    v_mul_f32_dpp v42, v18, v26 row_newbcast:14 row_mask:0xf bank_mask:0xf
    v_mul_f32_dpp v43, v18, v27 row_newbcast:15 row_mask:0xf bank_mask:0xf
    v_cvt_pk_bf16_f32 v84, v36, v37
    v_cvt_pk_bf16_f32 v85, v38, v39
    v_cvt_pk_bf16_f32 v86, v40, v41
    v_cvt_pk_bf16_f32 v87, v42, v43
    v_mul_f32_dpp v20, v18, v20 row_newbcast:0 row_mask:0xa bank_mask:0xf
    v_mul_f32_dpp v21, v18, v21 row_newbcast:1 row_mask:0xa bank_mask:0xf
    v_mul_f32_dpp v22, v18, v22 row_newbcast:2 row_mask:0xa bank_mask:0xf
    v_mul_f32_dpp v23, v18, v23 row_newbcast:3 row_mask:0xa bank_mask:0xf
    v_mul_f32_dpp v24, v18, v24 row_newbcast:4 row_mask:0xa bank_mask:0xf
    v_mul_f32_dpp v25, v18, v25 row_newbcast:5 row_mask:0xa bank_mask:0xf
    v_mul_f32_dpp v26, v18, v26 row_newbcast:6 row_mask:0xa bank_mask:0xf
    v_mul_f32_dpp v27, v18, v27 row_newbcast:7 row_mask:0xa bank_mask:0xf
    v_cvt_pk_bf16_f32 v80, v20, v21
    v_cvt_pk_bf16_f32 v81, v22, v23
    v_cvt_pk_bf16_f32 v82, v24, v25
    v_cvt_pk_bf16_f32 v83, v26, v27
    s_waitcnt vmcnt(4)
    v_mfma_f32_32x32x16_bf16 v[0:15], v[64:67], v[176:179], 0
    ds_read_b64_tr_b16 v[184:185], v246 offset:2048
    ds_read_b64_tr_b16 v[186:187], v246 offset:3072
    ds_read_b64_tr_b16 v[188:189], v247 offset:2048
    ds_read_b64_tr_b16 v[190:191], v247 offset:3072
    s_mov_b32 m0, s68
    v_mfma_f32_32x32x16_bf16 v[16:31], v[68:71], v[176:179], 0
    buffer_load_dwordx4 v224, s[4:7], s41 offen sc1 lds
    buffer_load_dwordx4 v225, s[72:75], s41 offen offset:1024 sc1 lds
    v_permlane32_swap_b32 v242, v236
    v_permlane32_swap_b32 v243, v237
    s_add_u32 s38, s38, 1
    v_mfma_f32_32x32x16_bf16 v[32:47], v[64:67], v[180:183], 0
    v_permlane32_swap_b32 v244, v238
    v_permlane32_swap_b32 v245, v239
    v_permlane32_swap_b32 v240, v241
    v_add_f32 v242, v242, v236
    v_mfma_f32_32x32x16_bf16 v[48:63], v[68:71], v[180:183], 0
    v_add_f32 v243, v243, v237
    v_add_f32 v244, v244, v238
    v_add_f32 v245, v245, v239
    v_add_f32 v240, -v240, -v241
    v_mov_b32 v254, s52
    v_mov_b32 v255, s38
    s_waitcnt vmcnt(4) lgkmcnt(0)
    v_mfma_f32_32x32x16_bf16 v[0:15], v[72:75], v[184:187], v[0:15]
    ds_read_b64_tr_b16 v[176:177], v246 offset:4096
    ds_read_b64_tr_b16 v[178:179], v246 offset:5120
    ds_read_b64_tr_b16 v[180:181], v247 offset:4096
    ds_read_b64_tr_b16 v[182:183], v247 offset:5120
    s_lshl_b32 s58, s38, 3
    s_add_u32 s58, s58, s20
    s_mov_b32 m0, s69
    v_mfma_f32_32x32x16_bf16 v[16:31], v[76:79], v[184:187], v[16:31]
    buffer_load_dwordx4 v226, s[4:7], s41 offen sc1 lds
    buffer_load_dwordx4 v227, s[72:75], s41 offen offset:1024 sc1 lds
    s_set_gpr_idx_on s32, gpr_idx(DST)
    s_nop 0
    v_cvt_pk_bf16_f32 v195, v242, v243
    v_cvt_pk_bf16_f32 v196, v244, v245
    v_cvt_pk_bf16_f32 v197, v240, v240
    s_set_gpr_idx_off
    s_mov_b64 exec, 1
    ds_write_b32 v254, v255
    s_mov_b64 exec, -1
    s_cmp_lt_u32 s58, s22
    s_cbranch_scc0 K2_dyn_34
K2_back_35:
    v_readlane_b32 s3, v253, s58
    s_lshl_b32 s44, s34, 7
    s_and_b32 s48, s3, 0x3ffff
    s_bfe_u32 s33, s3, 0x30013
    s_mul_i32 s35, s38, 6
    s_cmp_eq_u32 s34, 0
    s_cselect_b32 s35, s35, s48
    s_mov_b32 s45, s44
    s_add_u32 s47, s44, 256
    s_add_u32 s49, s48, 32
    s_add_u32 s60, s48, 64
    s_cmp_eq_u32 s33, 3
    s_cselect_b32 s46, s44, s47
    s_cselect_b32 s50, s60, s48
    s_cselect_b32 s51, s48, s49
    s_sub_u32 s60, s33, 2
    s_cmp_lt_u32 s60, 2
    s_cbranch_scc0 K2_rare_40
K2_back_41:
    v_mfma_f32_32x32x16_bf16 v[32:47], v[72:75], v[188:191], v[32:47]
    v_add_u32 v233, s48, v230
    ds_read_b32 v232, v233
    ds_read_b32 v233, v233 offset:1024
    v_mfma_f32_32x32x16_bf16 v[48:63], v[76:79], v[188:191], v[48:63]
    s_waitcnt vmcnt(4) lgkmcnt(3)
    v_mfma_f32_32x32x16_bf16 v[0:15], v[80:83], v[176:179], v[0:15]
    ds_read_b64_tr_b16 v[184:185], v246 offset:6144
    ds_read_b64_tr_b16 v[186:187], v246 offset:7168
    ds_read_b64_tr_b16 v[188:189], v247 offset:6144
    ds_read_b64_tr_b16 v[190:191], v247 offset:7168
    s_mov_b32 m0, s70
    v_mfma_f32_32x32x16_bf16 v[16:31], v[84:87], v[176:179], v[16:31]
    buffer_load_dwordx4 v222, s[4:7], s42 offen sc1 lds
    buffer_load_dwordx4 v223, s[72:75], s42 offen offset:1024 sc1 lds
    v_mfma_f32_32x32x16_bf16 v[32:47], v[80:83], v[180:183], v[32:47]
    s_nop 2
    v_mul_f32 v234, v0, v96
    v_mul_f32 v236, v8, v128
    v_fmac_f32 v234, v1, v97
    v_fmac_f32 v236, v9, v129
    v_fmac_f32 v234, v2, v98
    v_fmac_f32 v236, v10, v130
    v_fmac_f32 v234, v3, v99
    v_mfma_f32_32x32x16_bf16 v[48:63], v[84:87], v[180:183], v[48:63]
    s_setprio 0
    s_waitcnt lgkmcnt(4)
    v_or_b32 v232, v232, v231
    v_or_b32 v233, v233, v231
    s_cmp_lg_u32 s34, 0
    s_cbranch_scc1 K2_dum_43
    s_cmp_eq_u32 s33, 4
    s_cbranch_scc1 K2_a4_44
K2_b4_46:
    s_add_u32 m0, s48, 512
    s_add_u32 s65, s48, 1536
    buffer_load_dwordx4 v232, s[16:19], 0 offen  lds
    s_mov_b32 m0, s65
    s_mov_b32 exec_hi, 0
    buffer_load_dwordx4 v233, s[16:19], 0 offen  lds
    s_mov_b32 exec_hi, -1
K2_back_45:
    v_fmac_f32 v236, v11, v131
    v_fmac_f32 v234, v4, v100
    v_fmac_f32 v236, v12, v132
    v_fmac_f32 v234, v5, v101
    v_fmac_f32 v236, v13, v133
    v_fmac_f32 v234, v6, v102
    v_fmac_f32 v236, v14, v134
    v_fmac_f32 v234, v7, v103
    v_fmac_f32 v236, v15, v135
    v_mul_f32 v238, v16, v128
    v_mul_f32 v240, v24, v128
    v_fmac_f32 v238, v17, v129
    v_fmac_f32 v240, v25, v129
    v_fmac_f32 v238, v18, v130
    v_fmac_f32 v240, v26, v130
    v_fmac_f32 v238, v19, v131
    v_fmac_f32 v240, v27, v131
    v_fmac_f32 v238, v20, v132
    v_fmac_f32 v240, v28, v132
    v_fmac_f32 v238, v21, v133
    v_fmac_f32 v240, v29, v133
    v_fmac_f32 v238, v22, v134
    v_fmac_f32 v240, v30, v134
    v_fmac_f32 v238, v23, v135
    v_fmac_f32 v240, v31, v135
    v_mul_f32 v235, v32, v104
    v_mul_f32 v237, v40, v136
    v_fmac_f32 v235, v33, v105
    v_fmac_f32 v237, v41, v137
    v_fmac_f32 v235, v34, v106
    v_fmac_f32 v237, v42, v138
    v_fmac_f32 v235, v35, v107
    v_fmac_f32 v237, v43, v139
    v_fmac_f32 v235, v36, v108
    v_fmac_f32 v237, v44, v140
    v_fmac_f32 v235, v37, v109
    v_fmac_f32 v237, v45, v141
    v_fmac_f32 v235, v38, v110
    v_fmac_f32 v237, v46, v142
    v_fmac_f32 v235, v39, v111
    v_fmac_f32 v237, v47, v143
    v_mul_f32 v239, v48, v136
    v_mul_f32 v241, v56, v136
    s_setprio 1
    s_waitcnt vmcnt(6) lgkmcnt(0)
    v_mfma_f32_32x32x16_bf16 v[0:15], v[64:67], v[184:187], 0
    ds_read_b64_tr_b16 v[176:177], v246 offset:0
    ds_read_b64_tr_b16 v[178:179], v246 offset:1024
    ds_read_b64_tr_b16 v[180:181], v247 offset:0
    ds_read_b64_tr_b16 v[182:183], v247 offset:1024
    v_fmac_f32 v239, v49, v137
    v_fmac_f32 v241, v57, v137
    s_mov_b32 m0, s71
    v_mfma_f32_32x32x16_bf16 v[16:31], v[68:71], v[184:187], 0
    buffer_load_dwordx4 v224, s[4:7], s42 offen sc1 lds
    buffer_load_dwordx4 v225, s[72:75], s42 offen offset:1024 sc1 lds
    v_fmac_f32 v239, v50, v138
    v_fmac_f32 v241, v58, v138
    v_fmac_f32 v239, v51, v139
    v_fmac_f32 v241, v59, v139
    v_fmac_f32 v239, v52, v140
    v_mfma_f32_32x32x16_bf16 v[32:47], v[64:67], v[188:191], 0
    v_fmac_f32 v241, v60, v140
    v_fmac_f32 v239, v53, v141
    v_fmac_f32 v241, v61, v141
    v_fmac_f32 v239, v54, v142
    v_fmac_f32 v241, v62, v142
    v_fmac_f32 v239, v55, v143
    v_fmac_f32 v241, v63, v143
    v_mfma_f32_32x32x16_bf16 v[48:63], v[68:71], v[188:191], 0
    v_permlane32_swap_b32 v234, v236
    v_permlane32_swap_b32 v235, v237
    v_permlane32_swap_b32 v240, v238
    s_waitcnt vmcnt(6) lgkmcnt(0)
    v_mfma_f32_32x32x16_bf16 v[0:15], v[72:75], v[176:179], v[0:15]
    ds_read_b64_tr_b16 v[184:185], v246 offset:2048
    ds_read_b64_tr_b16 v[186:187], v246 offset:3072
    ds_read_b64_tr_b16 v[188:189], v247 offset:2048
    ds_read_b64_tr_b16 v[190:191], v247 offset:3072
    v_permlane32_swap_b32 v241, v239
    s_mov_b32 m0, s68
    v_mfma_f32_32x32x16_bf16 v[16:31], v[76:79], v[176:179], v[16:31]
    buffer_load_dwordx4 v226, s[4:7], s42 offen sc1 lds
    buffer_load_dwordx4 v227, s[72:75], s42 offen offset:1024 sc1 lds
    v_add_f32 v234, v234, v236
    v_add_f32 v235, v235, v237
    v_add_f32 v240, v240, v238
    v_add_f32 v241, v241, v239
    v_mfma_f32_32x32x16_bf16 v[32:47], v[72:75], v[180:183], v[32:47]
    s_set_gpr_idx_on s31, gpr_idx(DST)
    s_nop 0
    v_cvt_pk_bf16_f32 v192, v234, v235
    v_cvt_pk_bf16_f32 v193, v240, v241
    s_set_gpr_idx_off
    v_mfma_f32_32x32x16_bf16 v[48:63], v[76:79], v[180:183], v[48:63]
    s_waitcnt vmcnt(6) lgkmcnt(0)
    v_mfma_f32_32x32x16_bf16 v[0:15], v[80:83], v[184:187], v[0:15]
    ds_read_b64_tr_b16 v[176:177], v246 offset:4096
    ds_read_b64_tr_b16 v[178:179], v246 offset:5120
    ds_read_b64_tr_b16 v[180:181], v247 offset:4096
    ds_read_b64_tr_b16 v[182:183], v247 offset:5120
    s_mov_b32 m0, s69
    v_mfma_f32_32x32x16_bf16 v[16:31], v[84:87], v[184:187], v[16:31]
    buffer_load_dwordx4 v222, s[4:7], s43 offen sc1 lds
    buffer_load_dwordx4 v223, s[72:75], s43 offen offset:1024 sc1 lds
    v_mfma_f32_32x32x16_bf16 v[32:47], v[80:83], v[188:191], v[32:47]
    s_nop 2
    v_mul_f32 v234, v0, v144
    v_mul_f32 v236, v8, v112
    v_fmac_f32 v234, v1, v145
    v_fmac_f32 v236, v9, v113
    v_fmac_f32 v234, v2, v146
    v_fmac_f32 v236, v10, v114
    v_fmac_f32 v234, v3, v147
    v_mfma_f32_32x32x16_bf16 v[48:63], v[84:87], v[188:191], v[48:63]
    s_setprio 0
    v_fmac_f32 v236, v11, v115
    v_fmac_f32 v234, v4, v148
    v_fmac_f32 v236, v12, v116
    v_fmac_f32 v234, v5, v149
    v_fmac_f32 v236, v13, v117
    v_fmac_f32 v234, v6, v150
    v_fmac_f32 v236, v14, v118
    v_fmac_f32 v234, v7, v151
    v_fmac_f32 v236, v15, v119
    v_mul_f32 v238, v16, v160
    v_mul_f32 v240, v24, v160
    v_fmac_f32 v238, v17, v161
    v_fmac_f32 v240, v25, v161
    v_fmac_f32 v238, v18, v162
    v_fmac_f32 v240, v26, v162
    v_fmac_f32 v238, v19, v163
    v_fmac_f32 v240, v27, v163
    v_fmac_f32 v238, v20, v164
    v_fmac_f32 v240, v28, v164
    v_fmac_f32 v238, v21, v165
    v_fmac_f32 v240, v29, v165
    v_fmac_f32 v238, v22, v166
    v_fmac_f32 v240, v30, v166
    v_fmac_f32 v238, v23, v167
    v_fmac_f32 v240, v31, v167
    v_mul_f32 v235, v32, v152
    v_mul_f32 v237, v40, v120
    v_fmac_f32 v235, v33, v153
    v_fmac_f32 v237, v41, v121
    v_fmac_f32 v235, v34, v154
    v_fmac_f32 v237, v42, v122
    v_fmac_f32 v235, v35, v155
    v_fmac_f32 v237, v43, v123
    v_fmac_f32 v235, v36, v156
    v_fmac_f32 v237, v44, v124
    v_fmac_f32 v235, v37, v157
    v_fmac_f32 v237, v45, v125
    v_fmac_f32 v235, v38, v158
    v_fmac_f32 v237, v46, v126
    v_fmac_f32 v235, v39, v159
    v_fmac_f32 v237, v47, v127
    v_mul_f32 v239, v48, v168
    v_mul_f32 v241, v56, v168
    v_fmac_f32 v239, v49, v169
    v_fmac_f32 v241, v57, v169
    s_setprio 1
    s_waitcnt vmcnt(4) lgkmcnt(0)
    v_mfma_f32_32x32x16_bf16 v[0:15], v[64:67], v[176:179], 0
    ds_read_b64_tr_b16 v[184:185], v246 offset:6144
    ds_read_b64_tr_b16 v[186:187], v246 offset:7168
    ds_read_b64_tr_b16 v[188:189], v247 offset:6144
    ds_read_b64_tr_b16 v[190:191], v247 offset:7168
    v_fmac_f32 v239, v50, v170
    v_fmac_f32 v241, v58, v170
    s_mov_b32 m0, s70
    v_mfma_f32_32x32x16_bf16 v[16:31], v[68:71], v[176:179], 0
    buffer_load_dwordx4 v224, s[4:7], s43 offen sc1 lds
    buffer_load_dwordx4 v225, s[72:75], s43 offen offset:1024 sc1 lds
    v_fmac_f32 v239, v51, v171
    v_fmac_f32 v241, v59, v171
    v_fmac_f32 v239, v52, v172
    v_fmac_f32 v241, v60, v172
    v_fmac_f32 v239, v53, v173
    v_mfma_f32_32x32x16_bf16 v[32:47], v[64:67], v[180:183], 0
    v_add_u32 v222, s48, v251
    ds_read_b32 v222, v222
    v_fmac_f32 v241, v61, v173
    v_fmac_f32 v239, v54, v174
    v_fmac_f32 v241, v62, v174
    v_fmac_f32 v239, v55, v175
    v_fmac_f32 v241, v63, v175
    v_mfma_f32_32x32x16_bf16 v[48:63], v[68:71], v[180:183], 0
    s_waitcnt vmcnt(4) lgkmcnt(1)
    v_mfma_f32_32x32x16_bf16 v[0:15], v[72:75], v[184:187], v[0:15]
    ds_read_b64_tr_b16 v[176:177], v246 offset:0
    ds_read_b64_tr_b16 v[178:179], v246 offset:1024
    ds_read_b64_tr_b16 v[180:181], v247 offset:0
    ds_read_b64_tr_b16 v[182:183], v247 offset:1024
    s_mov_b32 m0, s71
    v_mfma_f32_32x32x16_bf16 v[16:31], v[76:79], v[184:187], v[16:31]
    buffer_load_dwordx4 v226, s[4:7], s43 offen sc1 lds
    buffer_load_dwordx4 v227, s[72:75], s43 offen offset:1024 sc1 lds
    s_waitcnt lgkmcnt(4)
    v_mad_u32_u16 v223, v222, s39, v248 op_sel:[1,0,0,0]
    v_mad_u32_u16 v222, v222, s39, v248
    v_mfma_f32_32x32x16_bf16 v[32:47], v[72:75], v[188:191], v[32:47]
    v_add_u32 v224, s49, v251
    ds_read_b32 v224, v224
    v_mfma_f32_32x32x16_bf16 v[48:63], v[76:79], v[188:191], v[48:63]
    s_waitcnt vmcnt(4) lgkmcnt(1)
    v_mfma_f32_32x32x16_bf16 v[0:15], v[80:83], v[176:179], v[0:15]
    ds_read_b64_tr_b16 v[184:185], v246 offset:2048
    ds_read_b64_tr_b16 v[186:187], v246 offset:3072
    ds_read_b64_tr_b16 v[188:189], v247 offset:2048
    ds_read_b64_tr_b16 v[190:191], v247 offset:3072
    s_mov_b32 m0, s68
    v_mfma_f32_32x32x16_bf16 v[16:31], v[84:87], v[176:179], v[16:31]
    buffer_load_dwordx4 v222, s[4:7], s44 offen sc1 lds
    buffer_load_dwordx4 v223, s[72:75], s44 offen offset:1024 sc1 lds
    s_waitcnt lgkmcnt(4)
    v_mad_u32_u16 v225, v224, s39, v248 op_sel:[1,0,0,0]
    v_mad_u32_u16 v224, v224, s39, v248
    v_mfma_f32_32x32x16_bf16 v[32:47], v[80:83], v[180:183], v[32:47]
    v_add_u32 v226, s50, v251
    ds_read_b32 v226, v226
    v_mul_f32 v242, v0, v144
    v_fma_f32 v238, v8, v160, -v238
    v_fmac_f32 v242, v1, v145
    v_fmac_f32 v238, v9, v161
    v_fmac_f32 v242, v2, v146
    v_mfma_f32_32x32x16_bf16 v[48:63], v[84:87], v[180:183], v[48:63]
    s_setprio 0
    v_fmac_f32 v238, v10, v162
    v_fmac_f32 v242, v3, v147
    v_fmac_f32 v238, v11, v163
    v_fmac_f32 v242, v4, v148
    v_fmac_f32 v238, v12, v164
    v_fmac_f32 v242, v5, v149
    v_fmac_f32 v238, v13, v165
    v_fmac_f32 v242, v6, v150
    v_fmac_f32 v238, v14, v166
    v_fmac_f32 v242, v7, v151
    v_fmac_f32 v238, v15, v167
    v_fmac_f32 v236, v16, v112
    v_mul_f32 v244, v24, v160
    v_fmac_f32 v236, v17, v113
    v_fmac_f32 v244, v25, v161
    v_fmac_f32 v236, v18, v114
    v_fmac_f32 v244, v26, v162
    v_fmac_f32 v236, v19, v115
    v_fmac_f32 v244, v27, v163
    v_fmac_f32 v236, v20, v116
    v_fmac_f32 v244, v28, v164
    v_fmac_f32 v236, v21, v117
    v_fmac_f32 v244, v29, v165
    v_fmac_f32 v236, v22, v118
    v_fmac_f32 v244, v30, v166
    v_fmac_f32 v236, v23, v119
    v_fmac_f32 v244, v31, v167
    v_mul_f32 v243, v32, v152
    v_fma_f32 v239, v40, v168, -v239
    v_fmac_f32 v243, v33, v153
    v_fmac_f32 v239, v41, v169
    v_fmac_f32 v243, v34, v154
    v_fmac_f32 v239, v42, v170
    v_fmac_f32 v243, v35, v155
    v_fmac_f32 v239, v43, v171
    v_fmac_f32 v243, v36, v156
    v_fmac_f32 v239, v44, v172
    v_fmac_f32 v243, v37, v157
    v_fmac_f32 v239, v45, v173
    v_fmac_f32 v243, v38, v158
    v_fmac_f32 v239, v46, v174
    v_fmac_f32 v243, v39, v159
    v_fmac_f32 v239, v47, v175
    v_fmac_f32 v237, v48, v120
    v_mul_f32 v245, v56, v168
    v_fmac_f32 v237, v49, v121
    v_fmac_f32 v245, v57, v169
    v_fmac_f32 v237, v50, v122
    v_fmac_f32 v245, v58, v170
    v_fmac_f32 v237, v51, v123
    s_setprio 1
    s_waitcnt vmcnt(4) lgkmcnt(1)
    v_mfma_f32_32x32x16_bf16 v[0:15], v[64:67], v[184:187], 0
    ds_read_b64_tr_b16 v[176:177], v246 offset:4096
    ds_read_b64_tr_b16 v[178:179], v246 offset:5120
    ds_read_b64_tr_b16 v[180:181], v247 offset:4096
    ds_read_b64_tr_b16 v[182:183], v247 offset:5120
    v_fmac_f32 v245, v59, v171
    v_fmac_f32 v237, v52, v124
    s_mov_b32 m0, s69
    v_mfma_f32_32x32x16_bf16 v[16:31], v[68:71], v[184:187], 0
    buffer_load_dwordx4 v224, s[4:7], s45 offen sc1 lds
    buffer_load_dwordx4 v225, s[72:75], s45 offen offset:1024 sc1 lds
    s_waitcnt lgkmcnt(4)
    v_mad_u32_u16 v227, v226, s39, v248 op_sel:[1,0,0,0]
    v_mad_u32_u16 v226, v226, s39, v248
    v_fmac_f32 v245, v60, v172
    v_fmac_f32 v237, v53, v125
    v_mfma_f32_32x32x16_bf16 v[32:47], v[64:67], v[188:191], 0
    v_add_u32 v228, s51, v251
    ds_read_b32 v228, v228
    v_fmac_f32 v245, v61, v173
    v_fmac_f32 v237, v54, v126
    v_fmac_f32 v245, v62, v174
    v_fmac_f32 v237, v55, v127
    v_fmac_f32 v245, v63, v175
    v_mfma_f32_32x32x16_bf16 v[48:63], v[68:71], v[188:191], 0
    v_permlane32_swap_b32 v242, v234
    v_permlane32_swap_b32 v243, v235
    v_add_f32 v242, v242, v234
    v_add_f32 v243, v243, v235
    s_waitcnt vmcnt(4) lgkmcnt(1)
    v_mfma_f32_32x32x16_bf16 v[0:15], v[72:75], v[176:179], v[0:15]
    ds_read_b64_tr_b16 v[184:185], v246 offset:6144
    ds_read_b64_tr_b16 v[186:187], v246 offset:7168
    ds_read_b64_tr_b16 v[188:189], v247 offset:6144
    ds_read_b64_tr_b16 v[190:191], v247 offset:7168
    s_mov_b32 m0, s70
    v_mfma_f32_32x32x16_bf16 v[16:31], v[76:79], v[176:179], v[16:31]
    buffer_load_dwordx4 v226, s[4:7], s46 offen sc1 lds
    buffer_load_dwordx4 v227, s[72:75], s46 offen offset:1024 sc1 lds
    s_waitcnt lgkmcnt(4)
    v_mad_u32_u16 v229, v228, s39, v248 op_sel:[1,0,0,0]
    v_mad_u32_u16 v228, v228, s39, v248
    s_sub_u32 s26, s48, s29
    s_mov_b32 s29, s48
    v_mfma_f32_32x32x16_bf16 v[32:47], v[72:75], v[180:183], v[32:47]
    s_set_gpr_idx_on s31, gpr_idx(DST)
    s_nop 0
    v_cvt_pk_bf16_f32 v194, v242, v243
    s_set_gpr_idx_off
    s_mov_b32 s30, s3
    s_bfe_u32 s56, s3, 0x40012
    s_cmp_eq_u32 s34, 0
    s_cselect_b32 s56, s56, 0
    v_mfma_f32_32x32x16_bf16 v[48:63], v[76:79], v[180:183], v[48:63]
    s_mov_b32 s32, s31
    s_mov_b32 s31, s35
    s_waitcnt vmcnt(4) lgkmcnt(0)
    v_mfma_f32_32x32x16_bf16 v[0:15], v[80:83], v[184:187], v[0:15]
    ds_read_b64_tr_b16 v[176:177], v246 offset:0
    ds_read_b64_tr_b16 v[178:179], v246 offset:1024
    ds_read_b64_tr_b16 v[180:181], v247 offset:0
    ds_read_b64_tr_b16 v[182:183], v247 offset:1024
    s_mov_b32 m0, s71
    v_mfma_f32_32x32x16_bf16 v[16:31], v[84:87], v[184:187], v[16:31]
    buffer_load_dwordx4 v228, s[4:7], s47 offen sc1 lds
    buffer_load_dwordx4 v229, s[72:75], s47 offen offset:1024 sc1 lds
    v_mfma_f32_32x32x16_bf16 v[32:47], v[80:83], v[188:191], v[32:47]
    s_nop 2
    v_mul_f32 v242, v0, v144
    v_fma_f32 v240, v8, v160, -v240
    v_fmac_f32 v242, v1, v145
    v_fmac_f32 v240, v9, v161
    v_fmac_f32 v242, v2, v146
    v_fmac_f32 v240, v10, v162
    v_fmac_f32 v242, v3, v147
    v_mfma_f32_32x32x16_bf16 v[48:63], v[84:87], v[188:191], v[48:63]
    s_setprio 0
    v_fmac_f32 v240, v11, v163
    v_fmac_f32 v242, v4, v148
    v_fmac_f32 v240, v12, v164
    v_fmac_f32 v242, v5, v149
    v_fmac_f32 v240, v13, v165
    v_fmac_f32 v242, v6, v150
    v_fmac_f32 v240, v14, v166
    v_fmac_f32 v242, v7, v151
    v_fmac_f32 v240, v15, v167
    v_add_u32 v249, s26, v249
    v_add_u32 v250, s26, v250
    v_fma_f32 v244, v16, v160, -v244
    v_fmac_f32 v236, v24, v112
    v_fmac_f32 v244, v17, v161
    v_fmac_f32 v236, v25, v113
    v_fmac_f32 v244, v18, v162
    v_fmac_f32 v236, v26, v114
    v_fmac_f32 v244, v19, v163
    v_fmac_f32 v236, v27, v115
    v_fmac_f32 v244, v20, v164
    v_fmac_f32 v236, v28, v116
    v_fmac_f32 v244, v21, v165
    v_fmac_f32 v236, v29, v117
    v_fmac_f32 v244, v22, v166
    v_fmac_f32 v236, v30, v118
    v_fmac_f32 v244, v23, v167
    v_fmac_f32 v236, v31, v119
    ds_read_b64_tr_b16 v[0:1], v249 offset:0
    ds_read_b64_tr_b16 v[2:3], v249 offset:32
    ds_read_u16_d16_hi v16, v250 offset:0
    v_mul_f32 v243, v32, v152
    v_fma_f32 v241, v40, v168, -v241
    v_fmac_f32 v243, v33, v153
    v_fmac_f32 v241, v41, v169
    v_fmac_f32 v243, v34, v154
    v_fmac_f32 v241, v42, v170
    v_fmac_f32 v243, v35, v155
    v_fmac_f32 v241, v43, v171
    v_fmac_f32 v243, v36, v156
    v_fmac_f32 v241, v44, v172
    v_fmac_f32 v243, v37, v157
    v_fmac_f32 v241, v45, v173
    v_fmac_f32 v243, v38, v158
    v_fmac_f32 v241, v46, v174
    v_fmac_f32 v243, v39, v159
    v_fmac_f32 v241, v47, v175
    ds_read_b64_tr_b16 v[4:5], v249 offset:512
    ds_read_b64_tr_b16 v[6:7], v249 offset:544
    ds_read_u16_d16_hi v17, v250 offset:32
    v_fma_f32 v245, v48, v168, -v245
    v_fmac_f32 v237, v56, v120
    v_fmac_f32 v245, v49, v169
    v_fmac_f32 v237, v57, v121
    v_fmac_f32 v245, v50, v170
    v_fmac_f32 v237, v58, v122
    v_fmac_f32 v245, v51, v171
    v_fmac_f32 v237, v59, v123
    v_fmac_f32 v245, v52, v172
    v_fmac_f32 v237, v60, v124
    v_fmac_f32 v245, v53, v173
    v_fmac_f32 v237, v61, v125
    v_fmac_f32 v245, v54, v174
    v_fmac_f32 v237, v62, v126
    v_fmac_f32 v245, v55, v175
    v_fmac_f32 v237, v63, v127
    s_cmp_eq_u32 s56, 5
    s_cbranch_scc1 K2_U20
    s_cmp_eq_u32 s56, 6
    s_cbranch_scc1 K2_U3h0
    s_branch K2_DSP0
K2_PAD_U21:
    s_branch K2_HOP
K2_U21:
    s_setprio 1
    s_waitcnt lgkmcnt(0)
    v_lshlrev_b32 v20, 16, v0
    v_and_b32 v21, 0xffff0000, v0
    v_lshlrev_b32 v22, 16, v1
    v_and_b32 v23, 0xffff0000, v1
    v_lshlrev_b32 v24, 16, v2
    v_and_b32 v25, 0xffff0000, v2
    v_lshlrev_b32 v26, 16, v3
    v_and_b32 v27, 0xffff0000, v3
    v_mul_f32_dpp v36, v16, v20 row_newbcast:8 row_mask:0xf bank_mask:0xf
    v_mul_f32_dpp v37, v16, v21 row_newbcast:9 row_mask:0xf bank_mask:0xf
    v_mul_f32_dpp v38, v16, v22 row_newbcast:10 row_mask:0xf bank_mask:0xf
    v_mul_f32_dpp v39, v16, v23 row_newbcast:11 row_mask:0xf bank_mask:0xf
    v_mul_f32_dpp v40, v16, v24 row_newbcast:12 row_mask:0xf bank_mask:0xf
    v_mul_f32_dpp v41, v16, v25 row_newbcast:13 row_mask:0xf bank_mask:0xf
    v_mul_f32_dpp v42, v16, v26 row_newbcast:14 row_mask:0xf bank_mask:0xf
    v_mul_f32_dpp v43, v16, v27 row_newbcast:15 row_mask:0xf bank_mask:0xf
    v_cvt_pk_bf16_f32 v68, v36, v37
    v_cvt_pk_bf16_f32 v69, v38, v39
    v_cvt_pk_bf16_f32 v70, v40, v41
    v_cvt_pk_bf16_f32 v71, v42, v43
    v_mul_f32_dpp v20, v16, v20 row_newbcast:0 row_mask:0xa bank_mask:0xf
    v_mul_f32_dpp v21, v16, v21 row_newbcast:1 row_mask:0xa bank_mask:0xf
    v_mul_f32_dpp v22, v16, v22 row_newbcast:2 row_mask:0xa bank_mask:0xf
    v_mul_f32_dpp v23, v16, v23 row_newbcast:3 row_mask:0xa bank_mask:0xf
    v_mul_f32_dpp v24, v16, v24 row_newbcast:4 row_mask:0xa bank_mask:0xf
    v_mul_f32_dpp v25, v16, v25 row_newbcast:5 row_mask:0xa bank_mask:0xf
    v_mul_f32_dpp v26, v16, v26 row_newbcast:6 row_mask:0xa bank_mask:0xf
    v_mul_f32_dpp v27, v16, v27 row_newbcast:7 row_mask:0xa bank_mask:0xf
    v_cvt_pk_bf16_f32 v64, v20, v21
    v_cvt_pk_bf16_f32 v65, v22, v23
    v_cvt_pk_bf16_f32 v66, v24, v25
    v_cvt_pk_bf16_f32 v67, v26, v27
    v_lshlrev_b32 v28, 16, v4
    v_and_b32 v29, 0xffff0000, v4
    v_lshlrev_b32 v30, 16, v5
    v_and_b32 v31, 0xffff0000, v5
    v_lshlrev_b32 v32, 16, v6
    v_and_b32 v33, 0xffff0000, v6
    v_lshlrev_b32 v34, 16, v7
    v_and_b32 v35, 0xffff0000, v7
    v_mul_f32_dpp v36, v17, v28 row_newbcast:8 row_mask:0xf bank_mask:0xf
    v_mul_f32_dpp v37, v17, v29 row_newbcast:9 row_mask:0xf bank_mask:0xf
    v_mul_f32_dpp v38, v17, v30 row_newbcast:10 row_mask:0xf bank_mask:0xf
    v_mul_f32_dpp v39, v17, v31 row_newbcast:11 row_mask:0xf bank_mask:0xf
    v_mul_f32_dpp v40, v17, v32 row_newbcast:12 row_mask:0xf bank_mask:0xf
    v_mul_f32_dpp v41, v17, v33 row_newbcast:13 row_mask:0xf bank_mask:0xf
    v_mul_f32_dpp v42, v17, v34 row_newbcast:14 row_mask:0xf bank_mask:0xf
    v_mul_f32_dpp v43, v17, v35 row_newbcast:15 row_mask:0xf bank_mask:0xf
    v_cvt_pk_bf16_f32 v76, v36, v37
    v_cvt_pk_bf16_f32 v77, v38, v39
    v_cvt_pk_bf16_f32 v78, v40, v41
    v_cvt_pk_bf16_f32 v79, v42, v43
    v_mul_f32_dpp v28, v17, v28 row_newbcast:0 row_mask:0xa bank_mask:0xf
    v_mul_f32_dpp v29, v17, v29 row_newbcast:1 row_mask:0xa bank_mask:0xf
    v_mul_f32_dpp v30, v17, v30 row_newbcast:2 row_mask:0xa bank_mask:0xf
    v_mul_f32_dpp v31, v17, v31 row_newbcast:3 row_mask:0xa bank_mask:0xf
    v_mul_f32_dpp v32, v17, v32 row_newbcast:4 row_mask:0xa bank_mask:0xf
    v_mul_f32_dpp v33, v17, v33 row_newbcast:5 row_mask:0xa bank_mask:0xf
    v_mul_f32_dpp v34, v17, v34 row_newbcast:6 row_mask:0xa bank_mask:0xf
    v_mul_f32_dpp v35, v17, v35 row_newbcast:7 row_mask:0xa bank_mask:0xf
    v_cvt_pk_bf16_f32 v72, v28, v29
    v_cvt_pk_bf16_f32 v73, v30, v31
    v_cvt_pk_bf16_f32 v74, v32, v33
    v_cvt_pk_bf16_f32 v75, v34, v35
    s_waitcnt vmcnt(4)
    v_mfma_f32_32x32x16_bf16 v[0:15], v[64:67], v[176:179], 0
    ds_read_b64_tr_b16 v[184:185], v246 offset:2048
    ds_read_b64_tr_b16 v[186:187], v246 offset:3072
    ds_read_b64_tr_b16 v[188:189], v247 offset:2048
    ds_read_b64_tr_b16 v[190:191], v247 offset:3072
    s_mov_b32 m0, s68
    v_mfma_f32_32x32x16_bf16 v[16:31], v[68:71], v[176:179], 0
    buffer_load_dwordx4 v222, s[4:7], s42 offen sc1 lds
    buffer_load_dwordx4 v223, s[72:75], s42 offen offset:1024 sc1 lds
    v_permlane32_swap_b32 v242, v236
    v_permlane32_swap_b32 v243, v237
    v_mov_b32 v254, 163296
    v_mfma_f32_32x32x16_bf16 v[32:47], v[64:67], v[180:183], 0
    v_permlane32_swap_b32 v244, v238
    v_permlane32_swap_b32 v245, v239
    v_permlane32_swap_b32 v240, v241
    v_add_f32 v242, v242, v236
    v_mfma_f32_32x32x16_bf16 v[48:63], v[68:71], v[180:183], 0
    v_add_f32 v243, v243, v237
    v_add_f32 v244, v244, v238
    v_add_f32 v245, v245, v239
    v_add_f32 v240, -v240, -v241
    v_sub_u32 v241, v230, v231
    v_cvt_pk_bf16_f32 v242, v242, v243
    v_mov_b32 v255, 1
    v_lshl_add_u32 v233, v252, 1, s53
    s_mov_b64 exec, 1
    ds_add_rtn_u32 v232, v254, v255
    s_mov_b64 exec, -1
    ds_read_b32 v233, v233
    s_waitcnt vmcnt(4) lgkmcnt(2)
    v_mfma_f32_32x32x16_bf16 v[0:15], v[72:75], v[184:187], v[0:15]
    ds_read_b64_tr_b16 v[176:177], v246 offset:4096
    ds_read_b64_tr_b16 v[178:179], v246 offset:5120
    ds_read_b64_tr_b16 v[180:181], v247 offset:4096
    ds_read_b64_tr_b16 v[182:183], v247 offset:5120
    v_cvt_pk_bf16_f32 v244, v244, v245
    v_cvt_pk_bf16_f32 v240, v240, v240
    s_mov_b32 m0, s69
    v_mfma_f32_32x32x16_bf16 v[16:31], v[76:79], v[184:187], v[16:31]
    buffer_load_dwordx4 v224, s[4:7], s42 offen sc1 lds
    buffer_load_dwordx4 v225, s[72:75], s42 offen offset:1024 sc1 lds
    ds_write_b32 v230, v242 offset:768
    ds_write_b32 v230, v244 offset:1024
    ds_write_b16 v241, v240 offset:1280
    s_waitcnt lgkmcnt(7)
    v_readfirstlane_b32 s58, v232
    v_mfma_f32_32x32x16_bf16 v[32:47], v[72:75], v[188:191], v[32:47]
    s_cmp_lt_u32 s58, s22
    s_cbranch_scc0 K2_nul_47
    s_and_b32 s59, s58, 7
    s_lshr_b32 s60, s58, 3
K2_chk_49:
    v_readlane_b32 s61, v233, s59
    s_nop 0
    s_cmp_gt_u32 s61, s60
    s_cbranch_scc0 K2_spin_48
K2_back_50:
    v_mfma_f32_32x32x16_bf16 v[48:63], v[76:79], v[188:191], v[48:63]
    s_setprio 0
    v_readlane_b32 s3, v253, s58
    s_lshl_b32 s44, s34, 7
    s_and_b32 s48, s3, 0x3ffff
    s_bfe_u32 s33, s3, 0x30013
    s_mov_b32 s35, s48
    s_mov_b32 s45, s44
    v_mul_f32 v234, v0, v96
    v_mul_f32 v236, v8, v128
    v_fmac_f32 v234, v1, v97
    v_fmac_f32 v236, v9, v129
    v_fmac_f32 v234, v2, v98
    v_fmac_f32 v236, v10, v130
    v_fmac_f32 v234, v3, v99
    v_fmac_f32 v236, v11, v131
    v_fmac_f32 v234, v4, v100
    v_fmac_f32 v236, v12, v132
    v_fmac_f32 v234, v5, v101
    v_fmac_f32 v236, v13, v133
    v_fmac_f32 v234, v6, v102
    v_fmac_f32 v236, v14, v134
    v_fmac_f32 v234, v7, v103
    v_fmac_f32 v236, v15, v135
    v_mul_f32 v238, v16, v128
    v_mul_f32 v240, v24, v128
    v_fmac_f32 v238, v17, v129
    v_fmac_f32 v240, v25, v129
    v_fmac_f32 v238, v18, v130
    v_fmac_f32 v240, v26, v130
    v_fmac_f32 v238, v19, v131
    v_fmac_f32 v240, v27, v131
    v_fmac_f32 v238, v20, v132
    v_fmac_f32 v240, v28, v132
    v_fmac_f32 v238, v21, v133
    v_fmac_f32 v240, v29, v133
    v_fmac_f32 v238, v22, v134
    v_fmac_f32 v240, v30, v134
    v_fmac_f32 v238, v23, v135
    v_fmac_f32 v240, v31, v135
    v_mul_f32 v235, v32, v104
    v_mul_f32 v237, v40, v136
    v_fmac_f32 v235, v33, v105
    v_fmac_f32 v237, v41, v137
    v_fmac_f32 v235, v34, v106
    v_fmac_f32 v237, v42, v138
    v_fmac_f32 v235, v35, v107
    v_fmac_f32 v237, v43, v139
    v_fmac_f32 v235, v36, v108
    v_fmac_f32 v237, v44, v140
    v_fmac_f32 v235, v37, v109
    v_fmac_f32 v237, v45, v141
    v_fmac_f32 v235, v38, v110
    v_fmac_f32 v237, v46, v142
    v_fmac_f32 v235, v39, v111
    v_fmac_f32 v237, v47, v143
    v_mul_f32 v239, v48, v136
    v_mul_f32 v241, v56, v136
    v_fmac_f32 v239, v49, v137
    v_fmac_f32 v241, v57, v137
    s_setprio 1
    s_waitcnt vmcnt(4) lgkmcnt(3)
    v_mfma_f32_32x32x16_bf16 v[0:15], v[64:67], v[176:179], 0
    ds_read_b64_tr_b16 v[184:185], v246 offset:6144
    ds_read_b64_tr_b16 v[186:187], v246 offset:7168
    ds_read_b64_tr_b16 v[188:189], v247 offset:6144
    ds_read_b64_tr_b16 v[190:191], v247 offset:7168
    v_fmac_f32 v239, v50, v138
    v_fmac_f32 v241, v58, v138
    s_mov_b32 m0, s70
    v_mfma_f32_32x32x16_bf16 v[16:31], v[68:71], v[176:179], 0
    buffer_load_dwordx4 v222, s[4:7], s43 offen sc1 lds
    buffer_load_dwordx4 v223, s[72:75], s43 offen offset:1024 sc1 lds
    v_fmac_f32 v239, v51, v139
    v_fmac_f32 v241, v59, v139
    v_fmac_f32 v239, v52, v140
    v_fmac_f32 v241, v60, v140
    v_fmac_f32 v239, v53, v141
    v_mfma_f32_32x32x16_bf16 v[32:47], v[64:67], v[180:183], 0
    s_add_u32 s47, s44, 256
    s_add_u32 s49, s48, 32
    s_add_u32 s60, s48, 64
    s_cmp_eq_u32 s33, 3
    s_cselect_b32 s46, s44, s47
    s_cselect_b32 s50, s60, s48
    s_cselect_b32 s51, s48, s49
    s_sub_u32 s60, s33, 2
    s_cmp_lt_u32 s60, 2
    s_cbranch_scc0 K2_rare_51
K2_back_52:
    v_add_u32 v222, s48, v251
    ds_read_b32 v222, v222
    v_fmac_f32 v241, v61, v141
    v_fmac_f32 v239, v54, v142
    v_fmac_f32 v241, v62, v142
    v_fmac_f32 v239, v55, v143
    v_fmac_f32 v241, v63, v143
    v_mfma_f32_32x32x16_bf16 v[48:63], v[68:71], v[180:183], 0
    v_permlane32_swap_b32 v234, v236
    v_permlane32_swap_b32 v235, v237
    v_permlane32_swap_b32 v240, v238
    s_waitcnt vmcnt(4) lgkmcnt(1)
    v_mfma_f32_32x32x16_bf16 v[0:15], v[72:75], v[184:187], v[0:15]
    ds_read_b64_tr_b16 v[176:177], v246 offset:0
    ds_read_b64_tr_b16 v[178:179], v246 offset:1024
    ds_read_b64_tr_b16 v[180:181], v247 offset:0
    ds_read_b64_tr_b16 v[182:183], v247 offset:1024
    v_permlane32_swap_b32 v241, v239
    s_mov_b32 m0, s71
    v_mfma_f32_32x32x16_bf16 v[16:31], v[76:79], v[184:187], v[16:31]
    buffer_load_dwordx4 v224, s[4:7], s43 offen sc1 lds
    buffer_load_dwordx4 v225, s[72:75], s43 offen offset:1024 sc1 lds
    s_waitcnt lgkmcnt(4)
    v_mad_u32_u16 v223, v222, s39, v248 op_sel:[1,0,0,0]
    v_mad_u32_u16 v222, v222, s39, v248
    v_lshl_add_u32 v230, v252, 1, s31
    v_add_f32 v234, v234, v236
    v_add_f32 v235, v235, v237
    v_add_f32 v240, v240, v238
    v_add_f32 v241, v241, v239
    v_cvt_pk_bf16_f32 v234, v234, v235
    v_cvt_pk_bf16_f32 v240, v240, v241
    ds_write_b32 v230, v234 offset:0
    ds_write_b32 v230, v240 offset:256
    v_mfma_f32_32x32x16_bf16 v[32:47], v[72:75], v[188:191], v[32:47]
    v_add_u32 v224, s49, v251
    ds_read_b32 v224, v224
    v_mul_f32 v234, v0, v144
    v_mul_f32 v236, v8, v112
    v_fmac_f32 v234, v1, v145
    v_fmac_f32 v236, v9, v113
    v_fmac_f32 v234, v2, v146
    v_mfma_f32_32x32x16_bf16 v[48:63], v[76:79], v[188:191], v[48:63]
    s_setprio 0
    v_fmac_f32 v236, v10, v114
    v_fmac_f32 v234, v3, v147
    v_fmac_f32 v236, v11, v115
    v_fmac_f32 v234, v4, v148
    v_fmac_f32 v236, v12, v116
    v_fmac_f32 v234, v5, v149
    v_fmac_f32 v236, v13, v117
    v_fmac_f32 v234, v6, v150
    v_fmac_f32 v236, v14, v118
    v_fmac_f32 v234, v7, v151
    v_fmac_f32 v236, v15, v119
    v_mul_f32 v238, v16, v160
    v_mul_f32 v240, v24, v160
    v_fmac_f32 v238, v17, v161
    v_fmac_f32 v240, v25, v161
    v_fmac_f32 v238, v18, v162
    v_fmac_f32 v240, v26, v162
    v_fmac_f32 v238, v19, v163
    v_fmac_f32 v240, v27, v163
    v_fmac_f32 v238, v20, v164
    v_fmac_f32 v240, v28, v164
    v_fmac_f32 v238, v21, v165
    v_fmac_f32 v240, v29, v165
    v_fmac_f32 v238, v22, v166
    v_fmac_f32 v240, v30, v166
    v_fmac_f32 v238, v23, v167
    v_fmac_f32 v240, v31, v167
    v_mul_f32 v235, v32, v152
    v_mul_f32 v237, v40, v120
    v_fmac_f32 v235, v33, v153
    v_fmac_f32 v237, v41, v121
    v_fmac_f32 v235, v34, v154
    v_fmac_f32 v237, v42, v122
    v_fmac_f32 v235, v35, v155
    v_fmac_f32 v237, v43, v123
    v_fmac_f32 v235, v36, v156
    v_fmac_f32 v237, v44, v124
    v_fmac_f32 v235, v37, v157
    v_fmac_f32 v237, v45, v125
    v_fmac_f32 v235, v38, v158
    v_fmac_f32 v237, v46, v126
    v_fmac_f32 v235, v39, v159
    v_fmac_f32 v237, v47, v127
    v_mul_f32 v239, v48, v168
    v_mul_f32 v241, v56, v168
    v_fmac_f32 v239, v49, v169
    v_fmac_f32 v241, v57, v169
    v_fmac_f32 v239, v50, v170
    v_fmac_f32 v241, v58, v170
    v_fmac_f32 v239, v51, v171
    s_setprio 1
    s_waitcnt vmcnt(4) lgkmcnt(3)
    v_mfma_f32_32x32x16_bf16 v[0:15], v[64:67], v[176:179], 0
    ds_read_b64_tr_b16 v[184:185], v246 offset:2048
    ds_read_b64_tr_b16 v[186:187], v246 offset:3072
    ds_read_b64_tr_b16 v[188:189], v247 offset:2048
    ds_read_b64_tr_b16 v[190:191], v247 offset:3072
    v_fmac_f32 v241, v59, v171
    v_fmac_f32 v239, v52, v172
    s_mov_b32 m0, s68
    v_mfma_f32_32x32x16_bf16 v[16:31], v[68:71], v[176:179], 0
    buffer_load_dwordx4 v222, s[4:7], s44 offen sc1 lds
    buffer_load_dwordx4 v223, s[72:75], s44 offen offset:1024 sc1 lds
    s_waitcnt lgkmcnt(4)
    v_mad_u32_u16 v225, v224, s39, v248 op_sel:[1,0,0,0]
    v_mad_u32_u16 v224, v224, s39, v248
    v_fmac_f32 v241, v60, v172
    v_fmac_f32 v239, v53, v173
    v_mfma_f32_32x32x16_bf16 v[32:47], v[64:67], v[180:183], 0
    v_add_u32 v226, s50, v251
    ds_read_b32 v226, v226
    v_fmac_f32 v241, v61, v173
    v_fmac_f32 v239, v54, v174
    v_fmac_f32 v241, v62, v174
    v_fmac_f32 v239, v55, v175
    v_fmac_f32 v241, v63, v175
    v_mfma_f32_32x32x16_bf16 v[48:63], v[68:71], v[180:183], 0
    s_waitcnt vmcnt(4) lgkmcnt(1)
    v_mfma_f32_32x32x16_bf16 v[0:15], v[72:75], v[184:187], v[0:15]
    ds_read_b64_tr_b16 v[176:177], v246 offset:4096
    ds_read_b64_tr_b16 v[178:179], v246 offset:5120
    ds_read_b64_tr_b16 v[180:181], v247 offset:4096
    ds_read_b64_tr_b16 v[182:183], v247 offset:5120
    s_mov_b32 m0, s69
    v_mfma_f32_32x32x16_bf16 v[16:31], v[76:79], v[184:187], v[16:31]
    buffer_load_dwordx4 v224, s[4:7], s45 offen sc1 lds
    buffer_load_dwordx4 v225, s[72:75], s45 offen offset:1024 sc1 lds
    s_waitcnt lgkmcnt(4)
    v_mad_u32_u16 v227, v226, s39, v248 op_sel:[1,0,0,0]
    v_mad_u32_u16 v226, v226, s39, v248
    v_mfma_f32_32x32x16_bf16 v[32:47], v[72:75], v[188:191], v[32:47]
    v_add_u32 v228, s51, v251
    ds_read_b32 v228, v228
    v_mul_f32 v242, v0, v144
    v_fma_f32 v238, v8, v160, -v238
    v_fmac_f32 v242, v1, v145
    v_fmac_f32 v238, v9, v161
    v_fmac_f32 v242, v2, v146
    v_mfma_f32_32x32x16_bf16 v[48:63], v[76:79], v[188:191], v[48:63]
    s_setprio 0
    v_fmac_f32 v238, v10, v162
    v_fmac_f32 v242, v3, v147
    v_fmac_f32 v238, v11, v163
    v_fmac_f32 v242, v4, v148
    v_fmac_f32 v238, v12, v164
    v_fmac_f32 v242, v5, v149
    v_fmac_f32 v238, v13, v165
    v_fmac_f32 v242, v6, v150
    v_fmac_f32 v238, v14, v166
    v_fmac_f32 v242, v7, v151
    v_fmac_f32 v238, v15, v167
    v_fmac_f32 v236, v16, v112
    v_mul_f32 v244, v24, v160
    v_fmac_f32 v236, v17, v113
    v_fmac_f32 v244, v25, v161
    v_fmac_f32 v236, v18, v114
    v_fmac_f32 v244, v26, v162
    v_fmac_f32 v236, v19, v115
    v_fmac_f32 v244, v27, v163
    v_fmac_f32 v236, v20, v116
    v_fmac_f32 v244, v28, v164
    v_fmac_f32 v236, v21, v117
    v_fmac_f32 v244, v29, v165
    v_fmac_f32 v236, v22, v118
    v_fmac_f32 v244, v30, v166
    v_fmac_f32 v236, v23, v119
    v_fmac_f32 v244, v31, v167
    v_mul_f32 v243, v32, v152
    v_fma_f32 v239, v40, v168, -v239
    v_fmac_f32 v243, v33, v153
    v_fmac_f32 v239, v41, v169
    v_fmac_f32 v243, v34, v154
    v_fmac_f32 v239, v42, v170
    v_fmac_f32 v243, v35, v155
    v_fmac_f32 v239, v43, v171
    v_fmac_f32 v243, v36, v156
    v_fmac_f32 v239, v44, v172
    v_fmac_f32 v243, v37, v157
    v_fmac_f32 v239, v45, v173
    v_fmac_f32 v243, v38, v158
    v_fmac_f32 v239, v46, v174
    v_fmac_f32 v243, v39, v159
    v_fmac_f32 v239, v47, v175
    v_fmac_f32 v237, v48, v120
    v_mul_f32 v245, v56, v168
    v_fmac_f32 v237, v49, v121
    v_fmac_f32 v245, v57, v169
    v_fmac_f32 v237, v50, v122
    s_setprio 1
    s_waitcnt vmcnt(4) lgkmcnt(1)
    v_mfma_f32_32x32x16_bf16 v[0:15], v[64:67], v[176:179], 0
    ds_read_b64_tr_b16 v[184:185], v246 offset:6144
    ds_read_b64_tr_b16 v[186:187], v246 offset:7168
    ds_read_b64_tr_b16 v[188:189], v247 offset:6144
    ds_read_b64_tr_b16 v[190:191], v247 offset:7168
    v_fmac_f32 v245, v58, v170
    v_fmac_f32 v237, v51, v123
    s_mov_b32 m0, s70
    v_mfma_f32_32x32x16_bf16 v[16:31], v[68:71], v[176:179], 0
    buffer_load_dwordx4 v226, s[4:7], s46 offen sc1 lds
    buffer_load_dwordx4 v227, s[72:75], s46 offen offset:1024 sc1 lds
    s_waitcnt lgkmcnt(4)
    v_mad_u32_u16 v229, v228, s39, v248 op_sel:[1,0,0,0]
    v_mad_u32_u16 v228, v228, s39, v248
    v_fmac_f32 v245, v59, v171
    v_fmac_f32 v237, v52, v124
    v_mfma_f32_32x32x16_bf16 v[32:47], v[64:67], v[180:183], 0
    v_fmac_f32 v245, v60, v172
    v_fmac_f32 v237, v53, v125
    v_fmac_f32 v245, v61, v173
    v_fmac_f32 v237, v54, v126
    v_fmac_f32 v245, v62, v174
    v_fmac_f32 v237, v55, v127
    v_fmac_f32 v245, v63, v175
    v_mfma_f32_32x32x16_bf16 v[48:63], v[68:71], v[180:183], 0
    v_permlane32_swap_b32 v242, v234
    v_permlane32_swap_b32 v243, v235
    v_add_f32 v242, v242, v234
    v_add_f32 v243, v243, v235
    s_waitcnt vmcnt(4) lgkmcnt(0)
    v_mfma_f32_32x32x16_bf16 v[0:15], v[72:75], v[184:187], v[0:15]
    ds_read_b64_tr_b16 v[176:177], v246 offset:0
    ds_read_b64_tr_b16 v[178:179], v246 offset:1024
    ds_read_b64_tr_b16 v[180:181], v247 offset:0
    ds_read_b64_tr_b16 v[182:183], v247 offset:1024
    v_cvt_pk_bf16_f32 v242, v242, v243
    ds_write_b32 v230, v242 offset:512
    s_mov_b32 m0, s71
    v_mfma_f32_32x32x16_bf16 v[16:31], v[76:79], v[184:187], v[16:31]
    buffer_load_dwordx4 v228, s[4:7], s47 offen sc1 lds
    buffer_load_dwordx4 v229, s[72:75], s47 offen offset:1024 sc1 lds
    s_sub_u32 s26, s48, s29
    s_mov_b32 s29, s48
    s_mov_b32 s30, s3
    s_bfe_u32 s56, s3, 0x40012
    s_cmp_lg_u32 s36, 0
    s_cselect_b32 s56, s56, 0
    v_mfma_f32_32x32x16_bf16 v[32:47], v[72:75], v[188:191], v[32:47]
    s_mov_b32 s32, s31
    s_mov_b32 s31, s35
    v_mul_f32 v242, v0, v144
    v_fma_f32 v240, v8, v160, -v240
    v_fmac_f32 v242, v1, v145
    v_fmac_f32 v240, v9, v161
    v_fmac_f32 v242, v2, v146
    v_mfma_f32_32x32x16_bf16 v[48:63], v[76:79], v[188:191], v[48:63]
    s_setprio 0
    v_fmac_f32 v240, v10, v162
    v_fmac_f32 v242, v3, v147
    v_fmac_f32 v240, v11, v163
    v_fmac_f32 v242, v4, v148
    v_fmac_f32 v240, v12, v164
    v_fmac_f32 v242, v5, v149
    v_fmac_f32 v240, v13, v165
    v_fmac_f32 v242, v6, v150
    v_fmac_f32 v240, v14, v166
    v_fmac_f32 v242, v7, v151
    v_fmac_f32 v240, v15, v167
    v_add_u32 v249, s26, v249
    v_add_u32 v250, s26, v250
    v_fma_f32 v244, v16, v160, -v244
    v_fmac_f32 v236, v24, v112
    v_fmac_f32 v244, v17, v161
    v_fmac_f32 v236, v25, v113
    v_fmac_f32 v244, v18, v162
    v_fmac_f32 v236, v26, v114
    v_fmac_f32 v244, v19, v163
    v_fmac_f32 v236, v27, v115
    v_fmac_f32 v244, v20, v164
    v_fmac_f32 v236, v28, v116
    v_fmac_f32 v244, v21, v165
    v_fmac_f32 v236, v29, v117
    v_fmac_f32 v244, v22, v166
    v_fmac_f32 v236, v30, v118
    v_fmac_f32 v244, v23, v167
    v_fmac_f32 v236, v31, v119
    ds_read_b64_tr_b16 v[0:1], v249 offset:0
    ds_read_b64_tr_b16 v[2:3], v249 offset:32
    ds_read_u16_d16_hi v16, v250 offset:0
    v_mul_f32 v243, v32, v152
    v_fma_f32 v241, v40, v168, -v241
    v_fmac_f32 v243, v33, v153
    v_fmac_f32 v241, v41, v169
    v_fmac_f32 v243, v34, v154
    v_fmac_f32 v241, v42, v170
    v_fmac_f32 v243, v35, v155
    v_fmac_f32 v241, v43, v171
    v_fmac_f32 v243, v36, v156
    v_fmac_f32 v241, v44, v172
    v_fmac_f32 v243, v37, v157
    v_fmac_f32 v241, v45, v173
    v_fmac_f32 v243, v38, v158
    v_fmac_f32 v241, v46, v174
    v_fmac_f32 v243, v39, v159
    v_fmac_f32 v241, v47, v175
    ds_read_b64_tr_b16 v[4:5], v249 offset:512
    ds_read_b64_tr_b16 v[6:7], v249 offset:544
    ds_read_u16_d16_hi v17, v250 offset:32
    v_fma_f32 v245, v48, v168, -v245
    v_fmac_f32 v237, v56, v120
    v_fmac_f32 v245, v49, v169
    v_fmac_f32 v237, v57, v121
    v_fmac_f32 v245, v50, v170
    v_fmac_f32 v237, v58, v122
    v_fmac_f32 v245, v51, v171
    v_fmac_f32 v237, v59, v123
    v_fmac_f32 v245, v52, v172
    v_fmac_f32 v237, v60, v124
    v_fmac_f32 v245, v53, v173
    v_fmac_f32 v237, v61, v125
    v_fmac_f32 v245, v54, v174
    v_fmac_f32 v237, v62, v126
    v_fmac_f32 v245, v55, v175
    v_fmac_f32 v237, v63, v127
    s_cmp_eq_u32 s56, 5
    s_cbranch_scc1 K2_U21
    s_cmp_eq_u32 s56, 6
    s_cbranch_scc1 K2_U3h1
    s_branch K2_DSP1
K2_PAD_U31:
    s_branch K2_HOP
K2_U3h1:
    s_setprio 1
    ds_read_b64_tr_b16 v[8:9], v249 offset:1024
    ds_read_u16_d16_hi v18, v250 offset:64
    s_waitcnt lgkmcnt(2)
    v_lshlrev_b32 v20, 16, v0
    v_and_b32 v21, 0xffff0000, v0
    v_lshlrev_b32 v22, 16, v1
    v_and_b32 v23, 0xffff0000, v1
    v_lshlrev_b32 v24, 16, v2
    v_and_b32 v25, 0xffff0000, v2
    v_lshlrev_b32 v26, 16, v3
    v_and_b32 v27, 0xffff0000, v3
    v_mul_f32_dpp v36, v16, v20 row_newbcast:8 row_mask:0xf bank_mask:0xf
    v_mul_f32_dpp v37, v16, v21 row_newbcast:9 row_mask:0xf bank_mask:0xf
    v_mul_f32_dpp v38, v16, v22 row_newbcast:10 row_mask:0xf bank_mask:0xf
    v_mul_f32_dpp v39, v16, v23 row_newbcast:11 row_mask:0xf bank_mask:0xf
    v_mul_f32_dpp v40, v16, v24 row_newbcast:12 row_mask:0xf bank_mask:0xf
    v_mul_f32_dpp v41, v16, v25 row_newbcast:13 row_mask:0xf bank_mask:0xf
    v_mul_f32_dpp v42, v16, v26 row_newbcast:14 row_mask:0xf bank_mask:0xf
    v_mul_f32_dpp v43, v16, v27 row_newbcast:15 row_mask:0xf bank_mask:0xf
    v_cvt_pk_bf16_f32 v68, v36, v37
    v_cvt_pk_bf16_f32 v69, v38, v39
    v_cvt_pk_bf16_f32 v70, v40, v41
    v_cvt_pk_bf16_f32 v71, v42, v43
    v_mul_f32_dpp v20, v16, v20 row_newbcast:0 row_mask:0xa bank_mask:0xf
    v_mul_f32_dpp v21, v16, v21 row_newbcast:1 row_mask:0xa bank_mask:0xf
    v_mul_f32_dpp v22, v16, v22 row_newbcast:2 row_mask:0xa bank_mask:0xf
    v_mul_f32_dpp v23, v16, v23 row_newbcast:3 row_mask:0xa bank_mask:0xf
    v_mul_f32_dpp v24, v16, v24 row_newbcast:4 row_mask:0xa bank_mask:0xf
    v_mul_f32_dpp v25, v16, v25 row_newbcast:5 row_mask:0xa bank_mask:0xf
    v_mul_f32_dpp v26, v16, v26 row_newbcast:6 row_mask:0xa bank_mask:0xf
    v_mul_f32_dpp v27, v16, v27 row_newbcast:7 row_mask:0xa bank_mask:0xf
    v_cvt_pk_bf16_f32 v64, v20, v21
    v_cvt_pk_bf16_f32 v65, v22, v23
    v_cvt_pk_bf16_f32 v66, v24, v25
    v_cvt_pk_bf16_f32 v67, v26, v27
    v_lshlrev_b32 v28, 16, v4
    v_and_b32 v29, 0xffff0000, v4
    v_lshlrev_b32 v30, 16, v5
    v_and_b32 v31, 0xffff0000, v5
    v_lshlrev_b32 v32, 16, v6
    v_and_b32 v33, 0xffff0000, v6
    v_lshlrev_b32 v34, 16, v7
    v_and_b32 v35, 0xffff0000, v7
    v_mul_f32_dpp v36, v17, v28 row_newbcast:8 row_mask:0xf bank_mask:0xf
    v_mul_f32_dpp v37, v17, v29 row_newbcast:9 row_mask:0xf bank_mask:0xf
    v_mul_f32_dpp v38, v17, v30 row_newbcast:10 row_mask:0xf bank_mask:0xf
    v_mul_f32_dpp v39, v17, v31 row_newbcast:11 row_mask:0xf bank_mask:0xf
    v_mul_f32_dpp v40, v17, v32 row_newbcast:12 row_mask:0xf bank_mask:0xf
    v_mul_f32_dpp v41, v17, v33 row_newbcast:13 row_mask:0xf bank_mask:0xf
    v_mul_f32_dpp v42, v17, v34 row_newbcast:14 row_mask:0xf bank_mask:0xf
    v_mul_f32_dpp v43, v17, v35 row_newbcast:15 row_mask:0xf bank_mask:0xf
    v_cvt_pk_bf16_f32 v76, v36, v37
    v_cvt_pk_bf16_f32 v77, v38, v39
    v_cvt_pk_bf16_f32 v78, v40, v41
    v_cvt_pk_bf16_f32 v79, v42, v43
    v_mul_f32_dpp v28, v17, v28 row_newbcast:0 row_mask:0xa bank_mask:0xf
    v_mul_f32_dpp v29, v17, v29 row_newbcast:1 row_mask:0xa bank_mask:0xf
    v_mul_f32_dpp v30, v17, v30 row_newbcast:2 row_mask:0xa bank_mask:0xf
    v_mul_f32_dpp v31, v17, v31 row_newbcast:3 row_mask:0xa bank_mask:0xf
    v_mul_f32_dpp v32, v17, v32 row_newbcast:4 row_mask:0xa bank_mask:0xf
    v_mul_f32_dpp v33, v17, v33 row_newbcast:5 row_mask:0xa bank_mask:0xf
    v_mul_f32_dpp v34, v17, v34 row_newbcast:6 row_mask:0xa bank_mask:0xf
    v_mul_f32_dpp v35, v17, v35 row_newbcast:7 row_mask:0xa bank_mask:0xf
    v_cvt_pk_bf16_f32 v72, v28, v29
    v_cvt_pk_bf16_f32 v73, v30, v31
    v_cvt_pk_bf16_f32 v74, v32, v33
    v_cvt_pk_bf16_f32 v75, v34, v35
    s_waitcnt lgkmcnt(0)
    v_lshlrev_b32 v20, 16, v8
    v_and_b32 v21, 0xffff0000, v8
    v_lshlrev_b32 v22, 16, v9
    v_and_b32 v23, 0xffff0000, v9
    v_mul_f32_dpp v36, v18, v20 row_newbcast:8 row_mask:0xf bank_mask:0xf
    v_mul_f32_dpp v37, v18, v21 row_newbcast:9 row_mask:0xf bank_mask:0xf
    v_mul_f32_dpp v38, v18, v22 row_newbcast:10 row_mask:0xf bank_mask:0xf
    v_mul_f32_dpp v39, v18, v23 row_newbcast:11 row_mask:0xf bank_mask:0xf
    v_cvt_pk_bf16_f32 v84, v36, v37
    v_cvt_pk_bf16_f32 v85, v38, v39
    v_mul_f32_dpp v20, v18, v20 row_newbcast:0 row_mask:0xa bank_mask:0xf
    v_mul_f32_dpp v21, v18, v21 row_newbcast:1 row_mask:0xa bank_mask:0xf
    v_mul_f32_dpp v22, v18, v22 row_newbcast:2 row_mask:0xa bank_mask:0xf
    v_mul_f32_dpp v23, v18, v23 row_newbcast:3 row_mask:0xa bank_mask:0xf
    v_cvt_pk_bf16_f32 v80, v20, v21
    v_cvt_pk_bf16_f32 v81, v22, v23
    s_waitcnt vmcnt(4)
    v_mfma_f32_32x32x16_bf16 v[0:15], v[64:67], v[176:179], 0
    ds_read_b64_tr_b16 v[184:185], v246 offset:2048
    ds_read_b64_tr_b16 v[186:187], v246 offset:3072
    ds_read_b64_tr_b16 v[188:189], v247 offset:2048
    ds_read_b64_tr_b16 v[190:191], v247 offset:3072
    s_mov_b32 m0, s68
    v_mfma_f32_32x32x16_bf16 v[16:31], v[68:71], v[176:179], 0
    buffer_load_dwordx4 v224, s[4:7], s41 offen sc1 lds
    buffer_load_dwordx4 v225, s[72:75], s41 offen offset:1024 sc1 lds
    v_permlane32_swap_b32 v242, v236
    v_permlane32_swap_b32 v243, v237
    v_mov_b32 v254, 163296
    v_mfma_f32_32x32x16_bf16 v[32:47], v[64:67], v[180:183], 0
    v_permlane32_swap_b32 v244, v238
    v_permlane32_swap_b32 v245, v239
    v_permlane32_swap_b32 v240, v241
    v_add_f32 v242, v242, v236
    v_mfma_f32_32x32x16_bf16 v[48:63], v[68:71], v[180:183], 0
    v_add_f32 v243, v243, v237
    v_add_f32 v244, v244, v238
    v_add_f32 v245, v245, v239
    v_add_f32 v240, -v240, -v241
    v_sub_u32 v241, v230, v231
    v_cvt_pk_bf16_f32 v242, v242, v243
    v_mov_b32 v255, 1
    v_lshl_add_u32 v233, v252, 1, s53
    s_mov_b64 exec, 1
    ds_add_rtn_u32 v232, v254, v255
    s_mov_b64 exec, -1
    ds_read_b32 v233, v233
    s_waitcnt vmcnt(4) lgkmcnt(2)
    v_mfma_f32_32x32x16_bf16 v[0:15], v[72:75], v[184:187], v[0:15]
    ds_read_b64_tr_b16 v[176:177], v246 offset:4096
    ds_read_b64_tr_b16 v[180:181], v247 offset:4096
    v_cvt_pk_bf16_f32 v244, v244, v245
    v_cvt_pk_bf16_f32 v240, v240, v240
    ds_write_b32 v230, v242 offset:768
    ds_write_b32 v230, v244 offset:1024
    s_mov_b32 m0, s69
    v_mfma_f32_32x32x16_bf16 v[16:31], v[76:79], v[184:187], v[16:31]
    buffer_load_dwordx4 v226, s[4:7], s41 offen sc1 lds
    ds_write_b16 v241, v240 offset:1280
    s_waitcnt lgkmcnt(5)
    v_readfirstlane_b32 s58, v232
    v_mfma_f32_32x32x16_bf16 v[32:47], v[72:75], v[188:191], v[32:47]
    s_cmp_lt_u32 s58, s22
    s_cbranch_scc0 K2_nul_54
    s_and_b32 s59, s58, 7
    s_lshr_b32 s60, s58, 3
K2_chk_56:
    v_readlane_b32 s61, v233, s59
    s_nop 0
    s_cmp_gt_u32 s61, s60
    s_cbranch_scc0 K2_spin_55
K2_back_57:
    v_mfma_f32_32x32x16_bf16 v[48:63], v[76:79], v[188:191], v[48:63]
    v_readlane_b32 s3, v253, s58
    s_lshl_b32 s44, s34, 7
    s_and_b32 s48, s3, 0x3ffff
    s_bfe_u32 s33, s3, 0x30013
    s_mov_b32 s35, s48
    s_mov_b32 s45, s44
    s_waitcnt vmcnt(3) lgkmcnt(3)
    v_mfma_f32_32x32x8_bf16 v[0:15], v[80:81], v[176:177], v[0:15]
    ds_read_b64_tr_b16 v[184:185], v246 offset:6144
    ds_read_b64_tr_b16 v[186:187], v246 offset:7168
    ds_read_b64_tr_b16 v[188:189], v247 offset:6144
    ds_read_b64_tr_b16 v[190:191], v247 offset:7168
    s_add_u32 s47, s44, 256
    s_add_u32 s49, s48, 32
    s_mov_b32 m0, s70
    v_mfma_f32_32x32x8_bf16 v[16:31], v[84:85], v[176:177], v[16:31]
    buffer_load_dwordx4 v222, s[4:7], s42 offen sc1 lds
    buffer_load_dwordx4 v223, s[72:75], s42 offen offset:1024 sc1 lds
    s_add_u32 s60, s48, 64
    s_cmp_eq_u32 s33, 3
    s_cselect_b32 s46, s44, s47
    s_cselect_b32 s50, s60, s48
    s_cselect_b32 s51, s48, s49
    v_mfma_f32_32x32x8_bf16 v[32:47], v[80:81], v[180:181], v[32:47]
    s_sub_u32 s60, s33, 2
    s_cmp_lt_u32 s60, 2
    s_cbranch_scc0 K2_rare_58
K2_back_59:
    v_mul_f32 v234, v0, v96
    v_mul_f32 v236, v8, v128
    v_fmac_f32 v234, v1, v97
    v_fmac_f32 v236, v9, v129
    v_mfma_f32_32x32x8_bf16 v[48:63], v[84:85], v[180:181], v[48:63]
    s_setprio 0
    v_fmac_f32 v234, v2, v98
    v_fmac_f32 v236, v10, v130
    v_fmac_f32 v234, v3, v99
    v_fmac_f32 v236, v11, v131
    v_fmac_f32 v234, v4, v100
    v_fmac_f32 v236, v12, v132
    v_fmac_f32 v234, v5, v101
    v_fmac_f32 v236, v13, v133
    v_fmac_f32 v234, v6, v102
    v_fmac_f32 v236, v14, v134
    v_fmac_f32 v234, v7, v103
    v_fmac_f32 v236, v15, v135
    v_mul_f32 v238, v16, v128
    v_mul_f32 v240, v24, v128
    v_fmac_f32 v238, v17, v129
    v_fmac_f32 v240, v25, v129
    v_fmac_f32 v238, v18, v130
    v_fmac_f32 v240, v26, v130
    v_fmac_f32 v238, v19, v131
    v_fmac_f32 v240, v27, v131
    v_fmac_f32 v238, v20, v132
    v_fmac_f32 v240, v28, v132
    v_fmac_f32 v238, v21, v133
    v_fmac_f32 v240, v29, v133
    v_fmac_f32 v238, v22, v134
    v_fmac_f32 v240, v30, v134
    v_fmac_f32 v238, v23, v135
    v_fmac_f32 v240, v31, v135
    v_mul_f32 v235, v32, v104
    v_mul_f32 v237, v40, v136
    v_fmac_f32 v235, v33, v105
    v_fmac_f32 v237, v41, v137
    v_fmac_f32 v235, v34, v106
    v_fmac_f32 v237, v42, v138
    v_fmac_f32 v235, v35, v107
    v_fmac_f32 v237, v43, v139
    v_fmac_f32 v235, v36, v108
    v_fmac_f32 v237, v44, v140
    v_fmac_f32 v235, v37, v109
    v_fmac_f32 v237, v45, v141
    v_fmac_f32 v235, v38, v110
    v_fmac_f32 v237, v46, v142
    v_fmac_f32 v235, v39, v111
    v_fmac_f32 v237, v47, v143
    v_mul_f32 v239, v48, v136
    v_mul_f32 v241, v56, v136
    s_setprio 1
    s_waitcnt vmcnt(3) lgkmcnt(0)
    v_mfma_f32_32x32x16_bf16 v[0:15], v[64:67], v[184:187], 0
    ds_read_b64_tr_b16 v[176:177], v246 offset:0
    ds_read_b64_tr_b16 v[178:179], v246 offset:1024
    ds_read_b64_tr_b16 v[180:181], v247 offset:0
    ds_read_b64_tr_b16 v[182:183], v247 offset:1024
    v_fmac_f32 v239, v49, v137
    v_fmac_f32 v241, v57, v137
    s_mov_b32 m0, s71
    v_mfma_f32_32x32x16_bf16 v[16:31], v[68:71], v[184:187], 0
    buffer_load_dwordx4 v224, s[4:7], s42 offen sc1 lds
    buffer_load_dwordx4 v225, s[72:75], s42 offen offset:1024 sc1 lds
    v_fmac_f32 v239, v50, v138
    v_fmac_f32 v241, v58, v138
    v_fmac_f32 v239, v51, v139
    v_fmac_f32 v241, v59, v139
    v_fmac_f32 v239, v52, v140
    v_mfma_f32_32x32x16_bf16 v[32:47], v[64:67], v[188:191], 0
    v_fmac_f32 v241, v60, v140
    v_fmac_f32 v239, v53, v141
    v_fmac_f32 v241, v61, v141
    v_fmac_f32 v239, v54, v142
    v_fmac_f32 v241, v62, v142
    v_fmac_f32 v239, v55, v143
    v_fmac_f32 v241, v63, v143
    v_mfma_f32_32x32x16_bf16 v[48:63], v[68:71], v[188:191], 0
    v_permlane32_swap_b32 v234, v236
    v_permlane32_swap_b32 v235, v237
    v_permlane32_swap_b32 v240, v238
    s_waitcnt vmcnt(4) lgkmcnt(0)
    v_mfma_f32_32x32x16_bf16 v[0:15], v[72:75], v[176:179], v[0:15]
    ds_read_b64_tr_b16 v[184:185], v246 offset:2048
    ds_read_b64_tr_b16 v[188:189], v247 offset:2048
    v_permlane32_swap_b32 v241, v239
    v_lshl_add_u32 v230, v252, 1, s31
    v_add_f32 v234, v234, v236
    s_mov_b32 m0, s68
    v_mfma_f32_32x32x16_bf16 v[16:31], v[76:79], v[176:179], v[16:31]
    buffer_load_dwordx4 v226, s[4:7], s42 offen sc1 lds
    v_add_f32 v235, v235, v237
    v_add_f32 v240, v240, v238
    v_add_f32 v241, v241, v239
    v_cvt_pk_bf16_f32 v234, v234, v235
    v_cvt_pk_bf16_f32 v240, v240, v241
    ds_write_b32 v230, v234 offset:0
    v_mfma_f32_32x32x16_bf16 v[32:47], v[72:75], v[180:183], v[32:47]
    ds_write_b32 v230, v240 offset:256
    v_mfma_f32_32x32x16_bf16 v[48:63], v[76:79], v[180:183], v[48:63]
    s_waitcnt vmcnt(3) lgkmcnt(2)
    v_mfma_f32_32x32x8_bf16 v[0:15], v[80:81], v[184:185], v[0:15]
    ds_read_b64_tr_b16 v[176:177], v246 offset:4096
    ds_read_b64_tr_b16 v[178:179], v246 offset:5120
    ds_read_b64_tr_b16 v[180:181], v247 offset:4096
    ds_read_b64_tr_b16 v[182:183], v247 offset:5120
    s_mov_b32 m0, s69
    v_mfma_f32_32x32x8_bf16 v[16:31], v[84:85], v[184:185], v[16:31]
    buffer_load_dwordx4 v222, s[4:7], s43 offen sc1 lds
    buffer_load_dwordx4 v223, s[72:75], s43 offen offset:1024 sc1 lds
    v_mfma_f32_32x32x8_bf16 v[32:47], v[80:81], v[188:189], v[32:47]
    s_nop 2
    v_mul_f32 v234, v0, v144
    v_mul_f32 v236, v8, v112
    v_fmac_f32 v234, v1, v145
    v_fmac_f32 v236, v9, v113
    v_fmac_f32 v234, v2, v146
    v_fmac_f32 v236, v10, v114
    v_fmac_f32 v234, v3, v147
    v_mfma_f32_32x32x8_bf16 v[48:63], v[84:85], v[188:189], v[48:63]
    s_setprio 0
    v_fmac_f32 v236, v11, v115
    v_fmac_f32 v234, v4, v148
    v_fmac_f32 v236, v12, v116
    v_fmac_f32 v234, v5, v149
    v_fmac_f32 v236, v13, v117
    v_fmac_f32 v234, v6, v150
    v_fmac_f32 v236, v14, v118
    v_fmac_f32 v234, v7, v151
    v_fmac_f32 v236, v15, v119
    v_mul_f32 v238, v16, v160
    v_mul_f32 v240, v24, v160
    v_fmac_f32 v238, v17, v161
    v_fmac_f32 v240, v25, v161
    v_fmac_f32 v238, v18, v162
    v_fmac_f32 v240, v26, v162
    v_fmac_f32 v238, v19, v163
    v_fmac_f32 v240, v27, v163
    v_fmac_f32 v238, v20, v164
    v_fmac_f32 v240, v28, v164
    v_fmac_f32 v238, v21, v165
    v_fmac_f32 v240, v29, v165
    v_fmac_f32 v238, v22, v166
    v_fmac_f32 v240, v30, v166
    v_fmac_f32 v238, v23, v167
    v_fmac_f32 v240, v31, v167
    v_mul_f32 v235, v32, v152
    v_mul_f32 v237, v40, v120
    v_fmac_f32 v235, v33, v153
    v_fmac_f32 v237, v41, v121
    v_fmac_f32 v235, v34, v154
    v_fmac_f32 v237, v42, v122
    v_fmac_f32 v235, v35, v155
    v_fmac_f32 v237, v43, v123
    v_fmac_f32 v235, v36, v156
    v_fmac_f32 v237, v44, v124
    v_fmac_f32 v235, v37, v157
    v_fmac_f32 v237, v45, v125
    v_fmac_f32 v235, v38, v158
    v_fmac_f32 v237, v46, v126
    v_fmac_f32 v235, v39, v159
    v_fmac_f32 v237, v47, v127
    v_mul_f32 v239, v48, v168
    v_mul_f32 v241, v56, v168
    v_fmac_f32 v239, v49, v169
    v_fmac_f32 v241, v57, v169
    s_setprio 1
    s_waitcnt vmcnt(3) lgkmcnt(0)
    v_mfma_f32_32x32x16_bf16 v[0:15], v[64:67], v[176:179], 0
    ds_read_b64_tr_b16 v[184:185], v246 offset:6144
    ds_read_b64_tr_b16 v[186:187], v246 offset:7168
    ds_read_b64_tr_b16 v[188:189], v247 offset:6144
    ds_read_b64_tr_b16 v[190:191], v247 offset:7168
    v_fmac_f32 v239, v50, v170
    v_fmac_f32 v241, v58, v170
    s_mov_b32 m0, s70
    v_mfma_f32_32x32x16_bf16 v[16:31], v[68:71], v[176:179], 0
    buffer_load_dwordx4 v224, s[4:7], s43 offen sc1 lds
    buffer_load_dwordx4 v225, s[72:75], s43 offen offset:1024 sc1 lds
    v_fmac_f32 v239, v51, v171
    v_fmac_f32 v241, v59, v171
    v_fmac_f32 v239, v52, v172
    v_fmac_f32 v241, v60, v172
    v_fmac_f32 v239, v53, v173
    v_mfma_f32_32x32x16_bf16 v[32:47], v[64:67], v[180:183], 0
    v_add_u32 v222, s48, v251
    ds_read_b32 v222, v222
    v_fmac_f32 v241, v61, v173
    v_fmac_f32 v239, v54, v174
    v_fmac_f32 v241, v62, v174
    v_fmac_f32 v239, v55, v175
    v_fmac_f32 v241, v63, v175
    v_mfma_f32_32x32x16_bf16 v[48:63], v[68:71], v[180:183], 0
    s_waitcnt vmcnt(4) lgkmcnt(1)
    v_mfma_f32_32x32x16_bf16 v[0:15], v[72:75], v[184:187], v[0:15]
    ds_read_b64_tr_b16 v[176:177], v246 offset:0
    ds_read_b64_tr_b16 v[180:181], v247 offset:0
    s_mov_b32 m0, s71
    v_mfma_f32_32x32x16_bf16 v[16:31], v[76:79], v[184:187], v[16:31]
    buffer_load_dwordx4 v226, s[4:7], s43 offen sc1 lds
    s_waitcnt lgkmcnt(2)
    v_mad_u32_u16 v223, v222, s39, v248 op_sel:[1,0,0,0]
    v_mad_u32_u16 v222, v222, s39, v248
    v_mfma_f32_32x32x16_bf16 v[32:47], v[72:75], v[188:191], v[32:47]
    v_add_u32 v224, s49, v251
    ds_read_b32 v224, v224
    v_mfma_f32_32x32x16_bf16 v[48:63], v[76:79], v[188:191], v[48:63]
    s_waitcnt vmcnt(3) lgkmcnt(1)
    v_mfma_f32_32x32x8_bf16 v[0:15], v[80:81], v[176:177], v[0:15]
    ds_read_b64_tr_b16 v[184:185], v246 offset:2048
    ds_read_b64_tr_b16 v[186:187], v246 offset:3072
    ds_read_b64_tr_b16 v[188:189], v247 offset:2048
    ds_read_b64_tr_b16 v[190:191], v247 offset:3072
    s_mov_b32 m0, s68
    v_mfma_f32_32x32x8_bf16 v[16:31], v[84:85], v[176:177], v[16:31]
    buffer_load_dwordx4 v222, s[4:7], s44 offen sc1 lds
    buffer_load_dwordx4 v223, s[72:75], s44 offen offset:1024 sc1 lds
    s_waitcnt lgkmcnt(4)
    v_mad_u32_u16 v225, v224, s39, v248 op_sel:[1,0,0,0]
    v_mad_u32_u16 v224, v224, s39, v248
    v_mfma_f32_32x32x8_bf16 v[32:47], v[80:81], v[180:181], v[32:47]
    v_add_u32 v226, s50, v251
    ds_read_b32 v226, v226
    v_mul_f32 v242, v0, v144
    v_fma_f32 v238, v8, v160, -v238
    v_fmac_f32 v242, v1, v145
    v_fmac_f32 v238, v9, v161
    v_fmac_f32 v242, v2, v146
    v_mfma_f32_32x32x8_bf16 v[48:63], v[84:85], v[180:181], v[48:63]
    s_setprio 0
    v_fmac_f32 v238, v10, v162
    v_fmac_f32 v242, v3, v147
    v_fmac_f32 v238, v11, v163
    v_fmac_f32 v242, v4, v148
    v_fmac_f32 v238, v12, v164
    v_fmac_f32 v242, v5, v149
    v_fmac_f32 v238, v13, v165
    v_fmac_f32 v242, v6, v150
    v_fmac_f32 v238, v14, v166
    v_fmac_f32 v242, v7, v151
    v_fmac_f32 v238, v15, v167
    v_fmac_f32 v236, v16, v112
    v_mul_f32 v244, v24, v160
    v_fmac_f32 v236, v17, v113
    v_fmac_f32 v244, v25, v161
    v_fmac_f32 v236, v18, v114
    v_fmac_f32 v244, v26, v162
    v_fmac_f32 v236, v19, v115
    v_fmac_f32 v244, v27, v163
    v_fmac_f32 v236, v20, v116
    v_fmac_f32 v244, v28, v164
    v_fmac_f32 v236, v21, v117
    v_fmac_f32 v244, v29, v165
    v_fmac_f32 v236, v22, v118
    v_fmac_f32 v244, v30, v166
    v_fmac_f32 v236, v23, v119
    v_fmac_f32 v244, v31, v167
    v_mul_f32 v243, v32, v152
    v_fma_f32 v239, v40, v168, -v239
    v_fmac_f32 v243, v33, v153
    v_fmac_f32 v239, v41, v169
    v_fmac_f32 v243, v34, v154
    v_fmac_f32 v239, v42, v170
    v_fmac_f32 v243, v35, v155
    v_fmac_f32 v239, v43, v171
    v_fmac_f32 v243, v36, v156
    v_fmac_f32 v239, v44, v172
    v_fmac_f32 v243, v37, v157
    v_fmac_f32 v239, v45, v173
    v_fmac_f32 v243, v38, v158
    v_fmac_f32 v239, v46, v174
    v_fmac_f32 v243, v39, v159
    v_fmac_f32 v239, v47, v175
    v_fmac_f32 v237, v48, v120
    v_mul_f32 v245, v56, v168
    v_fmac_f32 v237, v49, v121
    v_fmac_f32 v245, v57, v169
    v_fmac_f32 v237, v50, v122
    v_fmac_f32 v245, v58, v170
    v_fmac_f32 v237, v51, v123
    s_setprio 1
    s_waitcnt vmcnt(3) lgkmcnt(1)
    v_mfma_f32_32x32x16_bf16 v[0:15], v[64:67], v[184:187], 0
    ds_read_b64_tr_b16 v[176:177], v246 offset:4096
    ds_read_b64_tr_b16 v[178:179], v246 offset:5120
    ds_read_b64_tr_b16 v[180:181], v247 offset:4096
    ds_read_b64_tr_b16 v[182:183], v247 offset:5120
    v_fmac_f32 v245, v59, v171
    v_fmac_f32 v237, v52, v124
    s_mov_b32 m0, s69
    v_mfma_f32_32x32x16_bf16 v[16:31], v[68:71], v[184:187], 0
    buffer_load_dwordx4 v224, s[4:7], s45 offen sc1 lds
    buffer_load_dwordx4 v225, s[72:75], s45 offen offset:1024 sc1 lds
    s_waitcnt lgkmcnt(4)
    v_mad_u32_u16 v227, v226, s39, v248 op_sel:[1,0,0,0]
    v_mad_u32_u16 v226, v226, s39, v248
    v_fmac_f32 v245, v60, v172
    v_fmac_f32 v237, v53, v125
    v_mfma_f32_32x32x16_bf16 v[32:47], v[64:67], v[188:191], 0
    v_add_u32 v228, s51, v251
    ds_read_b32 v228, v228
    v_fmac_f32 v245, v61, v173
    v_fmac_f32 v237, v54, v126
    v_fmac_f32 v245, v62, v174
    v_fmac_f32 v237, v55, v127
    v_fmac_f32 v245, v63, v175
    v_mfma_f32_32x32x16_bf16 v[48:63], v[68:71], v[188:191], 0
    v_permlane32_swap_b32 v242, v234
    v_permlane32_swap_b32 v243, v235
    v_add_f32 v242, v242, v234
    v_add_f32 v243, v243, v235
    s_waitcnt vmcnt(4) lgkmcnt(1)
    v_mfma_f32_32x32x16_bf16 v[0:15], v[72:75], v[176:179], v[0:15]
    ds_read_b64_tr_b16 v[184:185], v246 offset:6144
    ds_read_b64_tr_b16 v[188:189], v247 offset:6144
    v_cvt_pk_bf16_f32 v242, v242, v243
    ds_write_b32 v230, v242 offset:512
    s_mov_b32 s32, s31
    s_mov_b32 s31, s35
    s_mov_b32 m0, s70
    v_mfma_f32_32x32x16_bf16 v[16:31], v[76:79], v[176:179], v[16:31]
    buffer_load_dwordx4 v226, s[4:7], s46 offen sc1 lds
    buffer_load_dwordx4 v227, s[72:75], s46 offen offset:1024 sc1 lds
    s_waitcnt lgkmcnt(3)
    v_mad_u32_u16 v229, v228, s39, v248 op_sel:[1,0,0,0]
    v_mad_u32_u16 v228, v228, s39, v248
    s_sub_u32 s26, s48, s29
    s_mov_b32 s29, s48
    v_mfma_f32_32x32x16_bf16 v[32:47], v[72:75], v[180:183], v[32:47]
    s_mov_b32 s30, s3
    s_bfe_u32 s56, s3, 0x40012
    s_cmp_lg_u32 s36, 0
    s_cselect_b32 s56, s56, 0
    v_mfma_f32_32x32x16_bf16 v[48:63], v[76:79], v[180:183], v[48:63]
    s_waitcnt vmcnt(4) lgkmcnt(1)
    v_mfma_f32_32x32x8_bf16 v[0:15], v[80:81], v[184:185], v[0:15]
    ds_read_b64_tr_b16 v[176:177], v246 offset:0
    ds_read_b64_tr_b16 v[178:179], v246 offset:1024
    ds_read_b64_tr_b16 v[180:181], v247 offset:0
    ds_read_b64_tr_b16 v[182:183], v247 offset:1024
    s_mov_b32 m0, s71
    v_mfma_f32_32x32x8_bf16 v[16:31], v[84:85], v[184:185], v[16:31]
    buffer_load_dwordx4 v228, s[4:7], s47 offen sc1 lds
    buffer_load_dwordx4 v229, s[72:75], s47 offen offset:1024 sc1 lds
    v_mfma_f32_32x32x8_bf16 v[32:47], v[80:81], v[188:189], v[32:47]
    s_nop 2
    v_mul_f32 v242, v0, v144
    v_fma_f32 v240, v8, v160, -v240
    v_fmac_f32 v242, v1, v145
    v_fmac_f32 v240, v9, v161
    v_fmac_f32 v242, v2, v146
    v_fmac_f32 v240, v10, v162
    v_fmac_f32 v242, v3, v147
    v_mfma_f32_32x32x8_bf16 v[48:63], v[84:85], v[188:189], v[48:63]
    s_setprio 0
    v_fmac_f32 v240, v11, v163
    v_fmac_f32 v242, v4, v148
    v_fmac_f32 v240, v12, v164
    v_fmac_f32 v242, v5, v149
    v_fmac_f32 v240, v13, v165
    v_fmac_f32 v242, v6, v150
    v_fmac_f32 v240, v14, v166
    v_fmac_f32 v242, v7, v151
    v_fmac_f32 v240, v15, v167
    v_add_u32 v249, s26, v249
    v_add_u32 v250, s26, v250
    v_fma_f32 v244, v16, v160, -v244
    v_fmac_f32 v236, v24, v112
    v_fmac_f32 v244, v17, v161
    v_fmac_f32 v236, v25, v113
    v_fmac_f32 v244, v18, v162
    v_fmac_f32 v236, v26, v114
    v_fmac_f32 v244, v19, v163
    v_fmac_f32 v236, v27, v115
    v_fmac_f32 v244, v20, v164
    v_fmac_f32 v236, v28, v116
    v_fmac_f32 v244, v21, v165
    v_fmac_f32 v236, v29, v117
    v_fmac_f32 v244, v22, v166
    v_fmac_f32 v236, v30, v118
    v_fmac_f32 v244, v23, v167
    v_fmac_f32 v236, v31, v119
    ds_read_b64_tr_b16 v[0:1], v249 offset:0
    ds_read_b64_tr_b16 v[2:3], v249 offset:32
    ds_read_u16_d16_hi v16, v250 offset:0
    v_mul_f32 v243, v32, v152
    v_fma_f32 v241, v40, v168, -v241
    v_fmac_f32 v243, v33, v153
    v_fmac_f32 v241, v41, v169
    v_fmac_f32 v243, v34, v154
    v_fmac_f32 v241, v42, v170
    v_fmac_f32 v243, v35, v155
    v_fmac_f32 v241, v43, v171
    v_fmac_f32 v243, v36, v156
    v_fmac_f32 v241, v44, v172
    v_fmac_f32 v243, v37, v157
    v_fmac_f32 v241, v45, v173
    v_fmac_f32 v243, v38, v158
    v_fmac_f32 v241, v46, v174
    v_fmac_f32 v243, v39, v159
    v_fmac_f32 v241, v47, v175
    ds_read_b64_tr_b16 v[4:5], v249 offset:512
    ds_read_b64_tr_b16 v[6:7], v249 offset:544
    ds_read_u16_d16_hi v17, v250 offset:32
    v_fma_f32 v245, v48, v168, -v245
    v_fmac_f32 v237, v56, v120
    v_fmac_f32 v245, v49, v169
    v_fmac_f32 v237, v57, v121
    v_fmac_f32 v245, v50, v170
    v_fmac_f32 v237, v58, v122
    v_fmac_f32 v245, v51, v171
    v_fmac_f32 v237, v59, v123
    v_fmac_f32 v245, v52, v172
    v_fmac_f32 v237, v60, v124
    v_fmac_f32 v245, v53, v173
    v_fmac_f32 v237, v61, v125
    v_fmac_f32 v245, v54, v174
    v_fmac_f32 v237, v62, v126
    v_fmac_f32 v245, v55, v175
    v_fmac_f32 v237, v63, v127
    s_cmp_eq_u32 s56, 5
    s_cbranch_scc1 K2_U21
    s_cmp_eq_u32 s56, 6
    s_cbranch_scc1 K2_U3h1
    s_branch K2_DSP1
K2_U31:
    s_setprio 1
    ds_read_b64_tr_b16 v[8:9], v249 offset:1024
    ds_read_b64_tr_b16 v[10:11], v249 offset:1056
    ds_read_u16_d16_hi v18, v250 offset:64
    s_waitcnt lgkmcnt(3)
    v_lshlrev_b32 v20, 16, v0
    v_and_b32 v21, 0xffff0000, v0
    v_lshlrev_b32 v22, 16, v1
    v_and_b32 v23, 0xffff0000, v1
    v_lshlrev_b32 v24, 16, v2
    v_and_b32 v25, 0xffff0000, v2
    v_lshlrev_b32 v26, 16, v3
    v_and_b32 v27, 0xffff0000, v3
    v_mul_f32_dpp v36, v16, v20 row_newbcast:8 row_mask:0xf bank_mask:0xf
    v_mul_f32_dpp v37, v16, v21 row_newbcast:9 row_mask:0xf bank_mask:0xf
    v_mul_f32_dpp v38, v16, v22 row_newbcast:10 row_mask:0xf bank_mask:0xf
    v_mul_f32_dpp v39, v16, v23 row_newbcast:11 row_mask:0xf bank_mask:0xf
    v_mul_f32_dpp v40, v16, v24 row_newbcast:12 row_mask:0xf bank_mask:0xf
    v_mul_f32_dpp v41, v16, v25 row_newbcast:13 row_mask:0xf bank_mask:0xf
    v_mul_f32_dpp v42, v16, v26 row_newbcast:14 row_mask:0xf bank_mask:0xf
    v_mul_f32_dpp v43, v16, v27 row_newbcast:15 row_mask:0xf bank_mask:0xf
    v_cvt_pk_bf16_f32 v68, v36, v37
    v_cvt_pk_bf16_f32 v69, v38, v39
    v_cvt_pk_bf16_f32 v70, v40, v41
    v_cvt_pk_bf16_f32 v71, v42, v43
    v_mul_f32_dpp v20, v16, v20 row_newbcast:0 row_mask:0xa bank_mask:0xf
    v_mul_f32_dpp v21, v16, v21 row_newbcast:1 row_mask:0xa bank_mask:0xf
    v_mul_f32_dpp v22, v16, v22 row_newbcast:2 row_mask:0xa bank_mask:0xf
    v_mul_f32_dpp v23, v16, v23 row_newbcast:3 row_mask:0xa bank_mask:0xf
    v_mul_f32_dpp v24, v16, v24 row_newbcast:4 row_mask:0xa bank_mask:0xf
    v_mul_f32_dpp v25, v16, v25 row_newbcast:5 row_mask:0xa bank_mask:0xf
    v_mul_f32_dpp v26, v16, v26 row_newbcast:6 row_mask:0xa bank_mask:0xf
    v_mul_f32_dpp v27, v16, v27 row_newbcast:7 row_mask:0xa bank_mask:0xf
    v_cvt_pk_bf16_f32 v64, v20, v21
    v_cvt_pk_bf16_f32 v65, v22, v23
    v_cvt_pk_bf16_f32 v66, v24, v25
    v_cvt_pk_bf16_f32 v67, v26, v27
    v_lshlrev_b32 v28, 16, v4
    v_and_b32 v29, 0xffff0000, v4
    v_lshlrev_b32 v30, 16, v5
    v_and_b32 v31, 0xffff0000, v5
    v_lshlrev_b32 v32, 16, v6
    v_and_b32 v33, 0xffff0000, v6
    v_lshlrev_b32 v34, 16, v7
    v_and_b32 v35, 0xffff0000, v7
    v_mul_f32_dpp v36, v17, v28 row_newbcast:8 row_mask:0xf bank_mask:0xf
    v_mul_f32_dpp v37, v17, v29 row_newbcast:9 row_mask:0xf bank_mask:0xf
    v_mul_f32_dpp v38, v17, v30 row_newbcast:10 row_mask:0xf bank_mask:0xf
    v_mul_f32_dpp v39, v17, v31 row_newbcast:11 row_mask:0xf bank_mask:0xf
    v_mul_f32_dpp v40, v17, v32 row_newbcast:12 row_mask:0xf bank_mask:0xf
    v_mul_f32_dpp v41, v17, v33 row_newbcast:13 row_mask:0xf bank_mask:0xf
    v_mul_f32_dpp v42, v17, v34 row_newbcast:14 row_mask:0xf bank_mask:0xf
    v_mul_f32_dpp v43, v17, v35 row_newbcast:15 row_mask:0xf bank_mask:0xf
    v_cvt_pk_bf16_f32 v76, v36, v37
    v_cvt_pk_bf16_f32 v77, v38, v39
    v_cvt_pk_bf16_f32 v78, v40, v41
    v_cvt_pk_bf16_f32 v79, v42, v43
    v_mul_f32_dpp v28, v17, v28 row_newbcast:0 row_mask:0xa bank_mask:0xf
    v_mul_f32_dpp v29, v17, v29 row_newbcast:1 row_mask:0xa bank_mask:0xf
    v_mul_f32_dpp v30, v17, v30 row_newbcast:2 row_mask:0xa bank_mask:0xf
    v_mul_f32_dpp v31, v17, v31 row_newbcast:3 row_mask:0xa bank_mask:0xf
    v_mul_f32_dpp v32, v17, v32 row_newbcast:4 row_mask:0xa bank_mask:0xf
    v_mul_f32_dpp v33, v17, v33 row_newbcast:5 row_mask:0xa bank_mask:0xf
    v_mul_f32_dpp v34, v17, v34 row_newbcast:6 row_mask:0xa bank_mask:0xf
    v_mul_f32_dpp v35, v17, v35 row_newbcast:7 row_mask:0xa bank_mask:0xf
    v_cvt_pk_bf16_f32 v72, v28, v29
    v_cvt_pk_bf16_f32 v73, v30, v31
    v_cvt_pk_bf16_f32 v74, v32, v33
    v_cvt_pk_bf16_f32 v75, v34, v35
    s_waitcnt lgkmcnt(0)
    v_lshlrev_b32 v20, 16, v8
    v_and_b32 v21, 0xffff0000, v8
    v_lshlrev_b32 v22, 16, v9
    v_and_b32 v23, 0xffff0000, v9
    v_lshlrev_b32 v24, 16, v10
    v_and_b32 v25, 0xffff0000, v10
    v_lshlrev_b32 v26, 16, v11
    v_and_b32 v27, 0xffff0000, v11
    v_mul_f32_dpp v36, v18, v20 row_newbcast:8 row_mask:0xf bank_mask:0xf
    v_mul_f32_dpp v37, v18, v21 row_newbcast:9 row_mask:0xf bank_mask:0xf
    v_mul_f32_dpp v38, v18, v22 row_newbcast:10 row_mask:0xf bank_mask:0xf
    v_mul_f32_dpp v39, v18, v23 row_newbcast:11 row_mask:0xf bank_mask:0xf
    v_mul_f32_dpp v40, v18, v24 row_newbcast:12 row_mask:0xf bank_mask:0xf
    v_mul_f32_dpp v41, v18, v25 row_newbcast:13 row_mask:0xf bank_mask:0xf
    v_mul_f32_dpp v42, v18, v26 row_newbcast:14 row_mask:0xf bank_mask:0xf
    v_mul_f32_dpp v43, v18, v27 row_newbcast:15 row_mask:0xf bank_mask:0xf
    v_cvt_pk_bf16_f32 v84, v36, v37
    v_cvt_pk_bf16_f32 v85, v38, v39
    v_cvt_pk_bf16_f32 v86, v40, v41
    v_cvt_pk_bf16_f32 v87, v42, v43
    v_mul_f32_dpp v20, v18, v20 row_newbcast:0 row_mask:0xa bank_mask:0xf
    v_mul_f32_dpp v21, v18, v21 row_newbcast:1 row_mask:0xa bank_mask:0xf
    v_mul_f32_dpp v22, v18, v22 row_newbcast:2 row_mask:0xa bank_mask:0xf
    v_mul_f32_dpp v23, v18, v23 row_newbcast:3 row_mask:0xa bank_mask:0xf
    v_mul_f32_dpp v24, v18, v24 row_newbcast:4 row_mask:0xa bank_mask:0xf
    v_mul_f32_dpp v25, v18, v25 row_newbcast:5 row_mask:0xa bank_mask:0xf
    v_mul_f32_dpp v26, v18, v26 row_newbcast:6 row_mask:0xa bank_mask:0xf
    v_mul_f32_dpp v27, v18, v27 row_newbcast:7 row_mask:0xa bank_mask:0xf
    v_cvt_pk_bf16_f32 v80, v20, v21
    v_cvt_pk_bf16_f32 v81, v22, v23
    v_cvt_pk_bf16_f32 v82, v24, v25
    v_cvt_pk_bf16_f32 v83, v26, v27
    s_waitcnt vmcnt(4)
    v_mfma_f32_32x32x16_bf16 v[0:15], v[64:67], v[176:179], 0
    ds_read_b64_tr_b16 v[184:185], v246 offset:2048
    ds_read_b64_tr_b16 v[186:187], v246 offset:3072
    ds_read_b64_tr_b16 v[188:189], v247 offset:2048
    ds_read_b64_tr_b16 v[190:191], v247 offset:3072
    s_mov_b32 m0, s68
    v_mfma_f32_32x32x16_bf16 v[16:31], v[68:71], v[176:179], 0
    buffer_load_dwordx4 v224, s[4:7], s41 offen sc1 lds
    buffer_load_dwordx4 v225, s[72:75], s41 offen offset:1024 sc1 lds
    v_permlane32_swap_b32 v242, v236
    v_permlane32_swap_b32 v243, v237
    v_mov_b32 v254, 163296
    v_mfma_f32_32x32x16_bf16 v[32:47], v[64:67], v[180:183], 0
    v_permlane32_swap_b32 v244, v238
    v_permlane32_swap_b32 v245, v239
    v_permlane32_swap_b32 v240, v241
    v_add_f32 v242, v242, v236
    v_mfma_f32_32x32x16_bf16 v[48:63], v[68:71], v[180:183], 0
    v_add_f32 v243, v243, v237
    v_add_f32 v244, v244, v238
    v_add_f32 v245, v245, v239
    v_add_f32 v240, -v240, -v241
    v_sub_u32 v241, v230, v231
    v_cvt_pk_bf16_f32 v242, v242, v243
    v_mov_b32 v255, 1
    v_lshl_add_u32 v233, v252, 1, s53
    s_mov_b64 exec, 1
    ds_add_rtn_u32 v232, v254, v255
    s_mov_b64 exec, -1
    ds_read_b32 v233, v233
    s_waitcnt vmcnt(4) lgkmcnt(2)
    v_mfma_f32_32x32x16_bf16 v[0:15], v[72:75], v[184:187], v[0:15]
    ds_read_b64_tr_b16 v[176:177], v246 offset:4096
    ds_read_b64_tr_b16 v[178:179], v246 offset:5120
    ds_read_b64_tr_b16 v[180:181], v247 offset:4096
    ds_read_b64_tr_b16 v[182:183], v247 offset:5120
    v_cvt_pk_bf16_f32 v244, v244, v245
    v_cvt_pk_bf16_f32 v240, v240, v240
    s_mov_b32 m0, s69
    v_mfma_f32_32x32x16_bf16 v[16:31], v[76:79], v[184:187], v[16:31]
    buffer_load_dwordx4 v226, s[4:7], s41 offen sc1 lds
    buffer_load_dwordx4 v227, s[72:75], s41 offen offset:1024 sc1 lds
    ds_write_b32 v230, v242 offset:768
    ds_write_b32 v230, v244 offset:1024
    ds_write_b16 v241, v240 offset:1280
    s_waitcnt lgkmcnt(7)
    v_readfirstlane_b32 s58, v232
    v_mfma_f32_32x32x16_bf16 v[32:47], v[72:75], v[188:191], v[32:47]
    s_cmp_lt_u32 s58, s22
    s_cbranch_scc0 K2_nul_61
    s_and_b32 s59, s58, 7
    s_lshr_b32 s60, s58, 3
K2_chk_63:
    v_readlane_b32 s61, v233, s59
    s_nop 0
    s_cmp_gt_u32 s61, s60
    s_cbranch_scc0 K2_spin_62
K2_back_64:
    v_mfma_f32_32x32x16_bf16 v[48:63], v[76:79], v[188:191], v[48:63]
    v_readlane_b32 s3, v253, s58
    s_lshl_b32 s44, s34, 7
    s_and_b32 s48, s3, 0x3ffff
    s_bfe_u32 s33, s3, 0x30013
    s_mov_b32 s35, s48
    s_mov_b32 s45, s44
    s_waitcnt vmcnt(4) lgkmcnt(3)
    v_mfma_f32_32x32x16_bf16 v[0:15], v[80:83], v[176:179], v[0:15]
    ds_read_b64_tr_b16 v[184:185], v246 offset:6144
    ds_read_b64_tr_b16 v[186:187], v246 offset:7168
    ds_read_b64_tr_b16 v[188:189], v247 offset:6144
    ds_read_b64_tr_b16 v[190:191], v247 offset:7168
    s_add_u32 s47, s44, 256
    s_add_u32 s49, s48, 32
    s_mov_b32 m0, s70
    v_mfma_f32_32x32x16_bf16 v[16:31], v[84:87], v[176:179], v[16:31]
    buffer_load_dwordx4 v222, s[4:7], s42 offen sc1 lds
    buffer_load_dwordx4 v223, s[72:75], s42 offen offset:1024 sc1 lds
    s_add_u32 s60, s48, 64
    s_cmp_eq_u32 s33, 3
    s_cselect_b32 s46, s44, s47
    s_cselect_b32 s50, s60, s48
    s_cselect_b32 s51, s48, s49
    v_mfma_f32_32x32x16_bf16 v[32:47], v[80:83], v[180:183], v[32:47]
    s_sub_u32 s60, s33, 2
    s_cmp_lt_u32 s60, 2
    s_cbranch_scc0 K2_rare_65
K2_back_66:
    v_mul_f32 v234, v0, v96
    v_mul_f32 v236, v8, v128
    v_fmac_f32 v234, v1, v97
    v_fmac_f32 v236, v9, v129
    v_mfma_f32_32x32x16_bf16 v[48:63], v[84:87], v[180:183], v[48:63]
    s_setprio 0
    v_fmac_f32 v234, v2, v98
    v_fmac_f32 v236, v10, v130
    v_fmac_f32 v234, v3, v99
    v_fmac_f32 v236, v11, v131
    v_fmac_f32 v234, v4, v100
    v_fmac_f32 v236, v12, v132
    v_fmac_f32 v234, v5, v101
    v_fmac_f32 v236, v13, v133
    v_fmac_f32 v234, v6, v102
    v_fmac_f32 v236, v14, v134
    v_fmac_f32 v234, v7, v103
    v_fmac_f32 v236, v15, v135
    v_mul_f32 v238, v16, v128
    v_mul_f32 v240, v24, v128
    v_fmac_f32 v238, v17, v129
    v_fmac_f32 v240, v25, v129
    v_fmac_f32 v238, v18, v130
    v_fmac_f32 v240, v26, v130
    v_fmac_f32 v238, v19, v131
    v_fmac_f32 v240, v27, v131
    v_fmac_f32 v238, v20, v132
    v_fmac_f32 v240, v28, v132
    v_fmac_f32 v238, v21, v133
    v_fmac_f32 v240, v29, v133
    v_fmac_f32 v238, v22, v134
    v_fmac_f32 v240, v30, v134
    v_fmac_f32 v238, v23, v135
    v_fmac_f32 v240, v31, v135
    v_mul_f32 v235, v32, v104
    v_mul_f32 v237, v40, v136
    v_fmac_f32 v235, v33, v105
    v_fmac_f32 v237, v41, v137
    v_fmac_f32 v235, v34, v106
    v_fmac_f32 v237, v42, v138
    v_fmac_f32 v235, v35, v107
    v_fmac_f32 v237, v43, v139
    v_fmac_f32 v235, v36, v108
    v_fmac_f32 v237, v44, v140
    v_fmac_f32 v235, v37, v109
    v_fmac_f32 v237, v45, v141
    v_fmac_f32 v235, v38, v110
    v_fmac_f32 v237, v46, v142
    v_fmac_f32 v235, v39, v111
    v_fmac_f32 v237, v47, v143
    v_mul_f32 v239, v48, v136
    v_mul_f32 v241, v56, v136
    s_setprio 1
    s_waitcnt vmcnt(4) lgkmcnt(0)
    v_mfma_f32_32x32x16_bf16 v[0:15], v[64:67], v[184:187], 0
    ds_read_b64_tr_b16 v[176:177], v246 offset:0
    ds_read_b64_tr_b16 v[178:179], v246 offset:1024
    ds_read_b64_tr_b16 v[180:181], v247 offset:0
    ds_read_b64_tr_b16 v[182:183], v247 offset:1024
    v_fmac_f32 v239, v49, v137
    v_fmac_f32 v241, v57, v137
    s_mov_b32 m0, s71
    v_mfma_f32_32x32x16_bf16 v[16:31], v[68:71], v[184:187], 0
    buffer_load_dwordx4 v224, s[4:7], s42 offen sc1 lds
    buffer_load_dwordx4 v225, s[72:75], s42 offen offset:1024 sc1 lds
    v_fmac_f32 v239, v50, v138
    v_fmac_f32 v241, v58, v138
    v_fmac_f32 v239, v51, v139
    v_fmac_f32 v241, v59, v139
    v_fmac_f32 v239, v52, v140
    v_mfma_f32_32x32x16_bf16 v[32:47], v[64:67], v[188:191], 0
    v_fmac_f32 v241, v60, v140
    v_fmac_f32 v239, v53, v141
    v_fmac_f32 v241, v61, v141
    v_fmac_f32 v239, v54, v142
    v_fmac_f32 v241, v62, v142
    v_fmac_f32 v239, v55, v143
    v_fmac_f32 v241, v63, v143
    v_mfma_f32_32x32x16_bf16 v[48:63], v[68:71], v[188:191], 0
    v_permlane32_swap_b32 v234, v236
    v_permlane32_swap_b32 v235, v237
    v_permlane32_swap_b32 v240, v238
    s_waitcnt vmcnt(4) lgkmcnt(0)
    v_mfma_f32_32x32x16_bf16 v[0:15], v[72:75], v[176:179], v[0:15]
    ds_read_b64_tr_b16 v[184:185], v246 offset:2048
    ds_read_b64_tr_b16 v[186:187], v246 offset:3072
    ds_read_b64_tr_b16 v[188:189], v247 offset:2048
    ds_read_b64_tr_b16 v[190:191], v247 offset:3072
    v_permlane32_swap_b32 v241, v239
    s_mov_b32 m0, s68
    v_mfma_f32_32x32x16_bf16 v[16:31], v[76:79], v[176:179], v[16:31]
    buffer_load_dwordx4 v226, s[4:7], s42 offen sc1 lds
    buffer_load_dwordx4 v227, s[72:75], s42 offen offset:1024 sc1 lds
    v_lshl_add_u32 v230, v252, 1, s31
    v_add_f32 v234, v234, v236
    v_add_f32 v235, v235, v237
    v_add_f32 v240, v240, v238
    v_add_f32 v241, v241, v239
    v_mfma_f32_32x32x16_bf16 v[32:47], v[72:75], v[180:183], v[32:47]
    v_cvt_pk_bf16_f32 v234, v234, v235
    v_cvt_pk_bf16_f32 v240, v240, v241
    ds_write_b32 v230, v234 offset:0
    ds_write_b32 v230, v240 offset:256
    v_mfma_f32_32x32x16_bf16 v[48:63], v[76:79], v[180:183], v[48:63]
    s_waitcnt vmcnt(4) lgkmcnt(2)
    v_mfma_f32_32x32x16_bf16 v[0:15], v[80:83], v[184:187], v[0:15]
    ds_read_b64_tr_b16 v[176:177], v246 offset:4096
    ds_read_b64_tr_b16 v[178:179], v246 offset:5120
    ds_read_b64_tr_b16 v[180:181], v247 offset:4096
    ds_read_b64_tr_b16 v[182:183], v247 offset:5120
    s_mov_b32 m0, s69
    v_mfma_f32_32x32x16_bf16 v[16:31], v[84:87], v[184:187], v[16:31]
    buffer_load_dwordx4 v222, s[4:7], s43 offen sc1 lds
    buffer_load_dwordx4 v223, s[72:75], s43 offen offset:1024 sc1 lds
    v_mfma_f32_32x32x16_bf16 v[32:47], v[80:83], v[188:191], v[32:47]
    s_nop 2
    v_mul_f32 v234, v0, v144
    v_mul_f32 v236, v8, v112
    v_fmac_f32 v234, v1, v145
    v_fmac_f32 v236, v9, v113
    v_fmac_f32 v234, v2, v146
    v_fmac_f32 v236, v10, v114
    v_fmac_f32 v234, v3, v147
    v_mfma_f32_32x32x16_bf16 v[48:63], v[84:87], v[188:191], v[48:63]
    s_setprio 0
    v_fmac_f32 v236, v11, v115
    v_fmac_f32 v234, v4, v148
    v_fmac_f32 v236, v12, v116
    v_fmac_f32 v234, v5, v149
    v_fmac_f32 v236, v13, v117
    v_fmac_f32 v234, v6, v150
    v_fmac_f32 v236, v14, v118
    v_fmac_f32 v234, v7, v151
    v_fmac_f32 v236, v15, v119
    v_mul_f32 v238, v16, v160
    v_mul_f32 v240, v24, v160
    v_fmac_f32 v238, v17, v161
    v_fmac_f32 v240, v25, v161
    v_fmac_f32 v238, v18, v162
    v_fmac_f32 v240, v26, v162
    v_fmac_f32 v238, v19, v163
    v_fmac_f32 v240, v27, v163
    v_fmac_f32 v238, v20, v164
    v_fmac_f32 v240, v28, v164
    v_fmac_f32 v238, v21, v165
    v_fmac_f32 v240, v29, v165
    v_fmac_f32 v238, v22, v166
    v_fmac_f32 v240, v30, v166
    v_fmac_f32 v238, v23, v167
    v_fmac_f32 v240, v31, v167
    v_mul_f32 v235, v32, v152
    v_mul_f32 v237, v40, v120
    v_fmac_f32 v235, v33, v153
    v_fmac_f32 v237, v41, v121
    v_fmac_f32 v235, v34, v154
    v_fmac_f32 v237, v42, v122
    v_fmac_f32 v235, v35, v155
    v_fmac_f32 v237, v43, v123
    v_fmac_f32 v235, v36, v156
    v_fmac_f32 v237, v44, v124
    v_fmac_f32 v235, v37, v157
    v_fmac_f32 v237, v45, v125
    v_fmac_f32 v235, v38, v158
    v_fmac_f32 v237, v46, v126
    v_fmac_f32 v235, v39, v159
    v_fmac_f32 v237, v47, v127
    v_mul_f32 v239, v48, v168
    v_mul_f32 v241, v56, v168
    v_fmac_f32 v239, v49, v169
    v_fmac_f32 v241, v57, v169
    s_setprio 1
    s_waitcnt vmcnt(4) lgkmcnt(0)
    v_mfma_f32_32x32x16_bf16 v[0:15], v[64:67], v[176:179], 0
    ds_read_b64_tr_b16 v[184:185], v246 offset:6144
    ds_read_b64_tr_b16 v[186:187], v246 offset:7168
    ds_read_b64_tr_b16 v[188:189], v247 offset:6144
    ds_read_b64_tr_b16 v[190:191], v247 offset:7168
    v_fmac_f32 v239, v50, v170
    v_fmac_f32 v241, v58, v170
    s_mov_b32 m0, s70
    v_mfma_f32_32x32x16_bf16 v[16:31], v[68:71], v[176:179], 0
    buffer_load_dwordx4 v224, s[4:7], s43 offen sc1 lds
    buffer_load_dwordx4 v225, s[72:75], s43 offen offset:1024 sc1 lds
    v_fmac_f32 v239, v51, v171
    v_fmac_f32 v241, v59, v171
    v_fmac_f32 v239, v52, v172
    v_fmac_f32 v241, v60, v172
    v_fmac_f32 v239, v53, v173
    v_mfma_f32_32x32x16_bf16 v[32:47], v[64:67], v[180:183], 0
    v_add_u32 v222, s48, v251
    ds_read_b32 v222, v222
    v_fmac_f32 v241, v61, v173
    v_fmac_f32 v239, v54, v174
    v_fmac_f32 v241, v62, v174
    v_fmac_f32 v239, v55, v175
    v_fmac_f32 v241, v63, v175
    v_mfma_f32_32x32x16_bf16 v[48:63], v[68:71], v[180:183], 0
    s_waitcnt vmcnt(4) lgkmcnt(1)
    v_mfma_f32_32x32x16_bf16 v[0:15], v[72:75], v[184:187], v[0:15]
    ds_read_b64_tr_b16 v[176:177], v246 offset:0
    ds_read_b64_tr_b16 v[178:179], v246 offset:1024
    ds_read_b64_tr_b16 v[180:181], v247 offset:0
    ds_read_b64_tr_b16 v[182:183], v247 offset:1024
    s_mov_b32 m0, s71
    v_mfma_f32_32x32x16_bf16 v[16:31], v[76:79], v[184:187], v[16:31]
    buffer_load_dwordx4 v226, s[4:7], s43 offen sc1 lds
    buffer_load_dwordx4 v227, s[72:75], s43 offen offset:1024 sc1 lds
    s_waitcnt lgkmcnt(4)
    v_mad_u32_u16 v223, v222, s39, v248 op_sel:[1,0,0,0]
    v_mad_u32_u16 v222, v222, s39, v248
    v_mfma_f32_32x32x16_bf16 v[32:47], v[72:75], v[188:191], v[32:47]
    v_add_u32 v224, s49, v251
    ds_read_b32 v224, v224
    v_mfma_f32_32x32x16_bf16 v[48:63], v[76:79], v[188:191], v[48:63]
    s_waitcnt vmcnt(4) lgkmcnt(1)
    v_mfma_f32_32x32x16_bf16 v[0:15], v[80:83], v[176:179], v[0:15]
    ds_read_b64_tr_b16 v[184:185], v246 offset:2048
    ds_read_b64_tr_b16 v[186:187], v246 offset:3072
    ds_read_b64_tr_b16 v[188:189], v247 offset:2048
    ds_read_b64_tr_b16 v[190:191], v247 offset:3072
    s_mov_b32 m0, s68
    v_mfma_f32_32x32x16_bf16 v[16:31], v[84:87], v[176:179], v[16:31]
    buffer_load_dwordx4 v222, s[4:7], s44 offen sc1 lds
    buffer_load_dwordx4 v223, s[72:75], s44 offen offset:1024 sc1 lds
    s_waitcnt lgkmcnt(4)
    v_mad_u32_u16 v225, v224, s39, v248 op_sel:[1,0,0,0]
    v_mad_u32_u16 v224, v224, s39, v248
    v_mfma_f32_32x32x16_bf16 v[32:47], v[80:83], v[180:183], v[32:47]
    v_add_u32 v226, s50, v251
    ds_read_b32 v226, v226
    v_mul_f32 v242, v0, v144
    v_fma_f32 v238, v8, v160, -v238
    v_fmac_f32 v242, v1, v145
    v_fmac_f32 v238, v9, v161
    v_fmac_f32 v242, v2, v146
    v_mfma_f32_32x32x16_bf16 v[48:63], v[84:87], v[180:183], v[48:63]
    s_setprio 0
    v_fmac_f32 v238, v10, v162
    v_fmac_f32 v242, v3, v147
    v_fmac_f32 v238, v11, v163
    v_fmac_f32 v242, v4, v148
    v_fmac_f32 v238, v12, v164
    v_fmac_f32 v242, v5, v149
    v_fmac_f32 v238, v13, v165
    v_fmac_f32 v242, v6, v150
    v_fmac_f32 v238, v14, v166
    v_fmac_f32 v242, v7, v151
    v_fmac_f32 v238, v15, v167
    v_fmac_f32 v236, v16, v112
    v_mul_f32 v244, v24, v160
    v_fmac_f32 v236, v17, v113
    v_fmac_f32 v244, v25, v161
    v_fmac_f32 v236, v18, v114
    v_fmac_f32 v244, v26, v162
    v_fmac_f32 v236, v19, v115
    v_fmac_f32 v244, v27, v163
    v_fmac_f32 v236, v20, v116
    v_fmac_f32 v244, v28, v164
    v_fmac_f32 v236, v21, v117
    v_fmac_f32 v244, v29, v165
    v_fmac_f32 v236, v22, v118
    v_fmac_f32 v244, v30, v166
    v_fmac_f32 v236, v23, v119
    v_fmac_f32 v244, v31, v167
    v_mul_f32 v243, v32, v152
    v_fma_f32 v239, v40, v168, -v239
    v_fmac_f32 v243, v33, v153
    v_fmac_f32 v239, v41, v169
    v_fmac_f32 v243, v34, v154
    v_fmac_f32 v239, v42, v170
    v_fmac_f32 v243, v35, v155
    v_fmac_f32 v239, v43, v171
    v_fmac_f32 v243, v36, v156
    v_fmac_f32 v239, v44, v172
    v_fmac_f32 v243, v37, v157
    v_fmac_f32 v239, v45, v173
    v_fmac_f32 v243, v38, v158
    v_fmac_f32 v239, v46, v174
    v_fmac_f32 v243, v39, v159
    v_fmac_f32 v239, v47, v175
    v_fmac_f32 v237, v48, v120
    v_mul_f32 v245, v56, v168
    v_fmac_f32 v237, v49, v121
    v_fmac_f32 v245, v57, v169
    v_fmac_f32 v237, v50, v122
    v_fmac_f32 v245, v58, v170
    v_fmac_f32 v237, v51, v123
    s_setprio 1
    s_waitcnt vmcnt(4) lgkmcnt(1)
    v_mfma_f32_32x32x16_bf16 v[0:15], v[64:67], v[184:187], 0
    ds_read_b64_tr_b16 v[176:177], v246 offset:4096
    ds_read_b64_tr_b16 v[178:179], v246 offset:5120
    ds_read_b64_tr_b16 v[180:181], v247 offset:4096
    ds_read_b64_tr_b16 v[182:183], v247 offset:5120
    v_fmac_f32 v245, v59, v171
    v_fmac_f32 v237, v52, v124
    s_mov_b32 m0, s69
    v_mfma_f32_32x32x16_bf16 v[16:31], v[68:71], v[184:187], 0
    buffer_load_dwordx4 v224, s[4:7], s45 offen sc1 lds
    buffer_load_dwordx4 v225, s[72:75], s45 offen offset:1024 sc1 lds
    s_waitcnt lgkmcnt(4)
    v_mad_u32_u16 v227, v226, s39, v248 op_sel:[1,0,0,0]
    v_mad_u32_u16 v226, v226, s39, v248
    v_fmac_f32 v245, v60, v172
    v_fmac_f32 v237, v53, v125
    v_mfma_f32_32x32x16_bf16 v[32:47], v[64:67], v[188:191], 0
    v_add_u32 v228, s51, v251
    ds_read_b32 v228, v228
    v_fmac_f32 v245, v61, v173
    v_fmac_f32 v237, v54, v126
    v_fmac_f32 v245, v62, v174
    v_fmac_f32 v237, v55, v127
    v_fmac_f32 v245, v63, v175
    v_mfma_f32_32x32x16_bf16 v[48:63], v[68:71], v[188:191], 0
    v_permlane32_swap_b32 v242, v234
    v_permlane32_swap_b32 v243, v235
    v_add_f32 v242, v242, v234
    v_add_f32 v243, v243, v235
    s_waitcnt vmcnt(4) lgkmcnt(1)
    v_mfma_f32_32x32x16_bf16 v[0:15], v[72:75], v[176:179], v[0:15]
    ds_read_b64_tr_b16 v[184:185], v246 offset:6144
    ds_read_b64_tr_b16 v[186:187], v246 offset:7168
    ds_read_b64_tr_b16 v[188:189], v247 offset:6144
    ds_read_b64_tr_b16 v[190:191], v247 offset:7168
    v_cvt_pk_bf16_f32 v242, v242, v243
    ds_write_b32 v230, v242 offset:512
    s_mov_b32 m0, s70
    v_mfma_f32_32x32x16_bf16 v[16:31], v[76:79], v[176:179], v[16:31]
    buffer_load_dwordx4 v226, s[4:7], s46 offen sc1 lds
    buffer_load_dwordx4 v227, s[72:75], s46 offen offset:1024 sc1 lds
    s_waitcnt lgkmcnt(5)
    v_mad_u32_u16 v229, v228, s39, v248 op_sel:[1,0,0,0]
    v_mad_u32_u16 v228, v228, s39, v248
    s_sub_u32 s26, s48, s29
    s_mov_b32 s29, s48
    v_mfma_f32_32x32x16_bf16 v[32:47], v[72:75], v[180:183], v[32:47]
    s_mov_b32 s30, s3
    s_bfe_u32 s56, s3, 0x40012
    s_cmp_lg_u32 s36, 0
    s_cselect_b32 s56, s56, 0
    s_mov_b32 s32, s31
    s_mov_b32 s31, s35
    v_mfma_f32_32x32x16_bf16 v[48:63], v[76:79], v[180:183], v[48:63]
    s_waitcnt vmcnt(4) lgkmcnt(1)
    v_mfma_f32_32x32x16_bf16 v[0:15], v[80:83], v[184:187], v[0:15]
    ds_read_b64_tr_b16 v[176:177], v246 offset:0
    ds_read_b64_tr_b16 v[178:179], v246 offset:1024
    ds_read_b64_tr_b16 v[180:181], v247 offset:0
    ds_read_b64_tr_b16 v[182:183], v247 offset:1024
    s_mov_b32 m0, s71
    v_mfma_f32_32x32x16_bf16 v[16:31], v[84:87], v[184:187], v[16:31]
    buffer_load_dwordx4 v228, s[4:7], s47 offen sc1 lds
    buffer_load_dwordx4 v229, s[72:75], s47 offen offset:1024 sc1 lds
    v_mfma_f32_32x32x16_bf16 v[32:47], v[80:83], v[188:191], v[32:47]
    s_nop 2
    v_mul_f32 v242, v0, v144
    v_fma_f32 v240, v8, v160, -v240
    v_fmac_f32 v242, v1, v145
    v_fmac_f32 v240, v9, v161
    v_fmac_f32 v242, v2, v146
    v_fmac_f32 v240, v10, v162
    v_fmac_f32 v242, v3, v147
    v_mfma_f32_32x32x16_bf16 v[48:63], v[84:87], v[188:191], v[48:63]
    s_setprio 0
    v_fmac_f32 v240, v11, v163
    v_fmac_f32 v242, v4, v148
    v_fmac_f32 v240, v12, v164
    v_fmac_f32 v242, v5, v149
    v_fmac_f32 v240, v13, v165
    v_fmac_f32 v242, v6, v150
    v_fmac_f32 v240, v14, v166
    v_fmac_f32 v242, v7, v151
    v_fmac_f32 v240, v15, v167
    v_add_u32 v249, s26, v249
    v_add_u32 v250, s26, v250
    v_fma_f32 v244, v16, v160, -v244
    v_fmac_f32 v236, v24, v112
    v_fmac_f32 v244, v17, v161
    v_fmac_f32 v236, v25, v113
    v_fmac_f32 v244, v18, v162
    v_fmac_f32 v236, v26, v114
    v_fmac_f32 v244, v19, v163
    v_fmac_f32 v236, v27, v115
    v_fmac_f32 v244, v20, v164
    v_fmac_f32 v236, v28, v116
    v_fmac_f32 v244, v21, v165
    v_fmac_f32 v236, v29, v117
    v_fmac_f32 v244, v22, v166
    v_fmac_f32 v236, v30, v118
    v_fmac_f32 v244, v23, v167
    v_fmac_f32 v236, v31, v119
    ds_read_b64_tr_b16 v[0:1], v249 offset:0
    ds_read_b64_tr_b16 v[2:3], v249 offset:32
    ds_read_u16_d16_hi v16, v250 offset:0
    v_mul_f32 v243, v32, v152
    v_fma_f32 v241, v40, v168, -v241
    v_fmac_f32 v243, v33, v153
    v_fmac_f32 v241, v41, v169
    v_fmac_f32 v243, v34, v154
    v_fmac_f32 v241, v42, v170
    v_fmac_f32 v243, v35, v155
    v_fmac_f32 v241, v43, v171
    v_fmac_f32 v243, v36, v156
    v_fmac_f32 v241, v44, v172
    v_fmac_f32 v243, v37, v157
    v_fmac_f32 v241, v45, v173
    v_fmac_f32 v243, v38, v158
    v_fmac_f32 v241, v46, v174
    v_fmac_f32 v243, v39, v159
    v_fmac_f32 v241, v47, v175
    ds_read_b64_tr_b16 v[4:5], v249 offset:512
    ds_read_b64_tr_b16 v[6:7], v249 offset:544
    ds_read_u16_d16_hi v17, v250 offset:32
    v_fma_f32 v245, v48, v168, -v245
    v_fmac_f32 v237, v56, v120
    v_fmac_f32 v245, v49, v169
    v_fmac_f32 v237, v57, v121
    v_fmac_f32 v245, v50, v170
    v_fmac_f32 v237, v58, v122
    v_fmac_f32 v245, v51, v171
    v_fmac_f32 v237, v59, v123
    v_fmac_f32 v245, v52, v172
    v_fmac_f32 v237, v60, v124
    v_fmac_f32 v245, v53, v173
    v_fmac_f32 v237, v61, v125
    v_fmac_f32 v245, v54, v174
    v_fmac_f32 v237, v62, v126
    v_fmac_f32 v245, v55, v175
    v_fmac_f32 v237, v63, v127
    s_cmp_eq_u32 s56, 5
    s_cbranch_scc1 K2_U21
    s_cmp_eq_u32 s56, 6
    s_cbranch_scc1 K2_U3h1
    s_branch K2_DSP1
K2_PAD_SW:
    s_branch K2_HOP
K2_DSP0:
    s_cmp_eq_u32 s56, 4
    s_cbranch_scc1 K2_U20
    s_cmp_eq_u32 s56, 7
    s_cbranch_scc1 K2_U30
    s_cmp_gt_u32 s56, 7
    s_cbranch_scc1 K2_U40
    s_cmp_lg_u32 s56, 0
    s_cbranch_scc1 K2_U10
    s_branch K2_SWITCH
K2_DSP1:
    s_cmp_eq_u32 s56, 4
    s_cbranch_scc1 K2_U21
    s_cmp_eq_u32 s56, 7
    s_cbranch_scc1 K2_U31
    s_cmp_gt_u32 s56, 7
    s_cbranch_scc1 K2_U41
    s_cmp_lg_u32 s56, 0
    s_cbranch_scc1 K2_U11
    s_branch K2_TAIL
K2_SWITCH:
    v_lshlrev_b32 v60, 3, v252
    s_mov_b32 s64, 7176192
    buffer_load_dwordx4 v[56:59], v60, s[8:11], s64 offen sc1
    v_permlane32_swap_b32 v242, v236
    v_permlane32_swap_b32 v243, v237
    v_permlane32_swap_b32 v244, v238
    v_permlane32_swap_b32 v245, v239
    v_permlane32_swap_b32 v240, v241
    v_add_f32 v242, v242, v236
    v_add_f32 v243, v243, v237
    v_add_f32 v244, v244, v238
    v_add_f32 v245, v245, v239
    v_add_f32 v240, -v240, -v241
    s_set_gpr_idx_on s32, gpr_idx(DST)
    s_nop 0
    v_cvt_pk_bf16_f32 v195, v242, v243
    v_cvt_pk_bf16_f32 v196, v244, v245
    v_cvt_pk_bf16_f32 v197, v240, v240
    s_set_gpr_idx_off
    v_lshl_add_u32 v230, v252, 1, s35
    v_lshrrev_b32 v231, 6, v252
    v_mul_u32_u24 v231, 126, v231
    v_lshrrev_b32 v254, 6, v252
    v_bfe_u32 v255, v252, 3, 2
    v_lshl_add_u32 v254, v254, 2, v255
    v_mul_u32_u24 v254, 640, v254
    v_bfe_u32 v255, v252, 5, 1
    v_lshl_add_u32 v254, v255, 5, v254
    v_and_b32 v255, 6, v252
    v_lshl_add_u32 v254, v255, 2, v254
    v_add_u32 v254, 152832, v254
    ds_read_b64_tr_b16 v[104:105], v254 offset:0
    ds_read_b64_tr_b16 v[106:107], v254 offset:5120
    ds_read_b64_tr_b16 v[108:109], v254 offset:64
    ds_read_b64_tr_b16 v[110:111], v254 offset:5184
    ds_read_b64_tr_b16 v[120:121], v254 offset:128
    ds_read_b64_tr_b16 v[122:123], v254 offset:5248
    ds_read_b64_tr_b16 v[124:125], v254 offset:192
    ds_read_b64_tr_b16 v[126:127], v254 offset:5312
    ds_read_b64_tr_b16 v[136:137], v254 offset:256
    ds_read_b64_tr_b16 v[138:139], v254 offset:5376
    ds_read_b64_tr_b16 v[140:141], v254 offset:320
    ds_read_b64_tr_b16 v[142:143], v254 offset:5440
    ds_read_b64_tr_b16 v[152:153], v254 offset:384
    ds_read_b64_tr_b16 v[154:155], v254 offset:5504
    ds_read_b64_tr_b16 v[156:157], v254 offset:448
    ds_read_b64_tr_b16 v[158:159], v254 offset:5568
    ds_read_b64_tr_b16 v[168:169], v254 offset:512
    ds_read_b64_tr_b16 v[170:171], v254 offset:5632
    ds_read_b64_tr_b16 v[172:173], v254 offset:576
    ds_read_b64_tr_b16 v[174:175], v254 offset:5696
    s_movk_i32 s40, 128
    s_movk_i32 s41, 384
    s_movk_i32 s42, 640
    s_movk_i32 s43, 896
    s_waitcnt lgkmcnt(15)
    v_lshlrev_b32 v96, 16, v104
    v_and_b32 v97, 0xffff0000, v104
    v_lshlrev_b32 v98, 16, v105
    v_and_b32 v99, 0xffff0000, v105
    v_lshlrev_b32 v100, 16, v106
    v_and_b32 v101, 0xffff0000, v106
    v_lshlrev_b32 v102, 16, v107
    v_and_b32 v103, 0xffff0000, v107
    v_lshlrev_b32 v104, 16, v108
    v_and_b32 v105, 0xffff0000, v108
    v_lshlrev_b32 v106, 16, v109
    v_and_b32 v107, 0xffff0000, v109
    v_lshlrev_b32 v108, 16, v110
    v_and_b32 v109, 0xffff0000, v110
    v_lshlrev_b32 v110, 16, v111
    v_and_b32 v111, 0xffff0000, v111
    s_waitcnt lgkmcnt(12)
    v_lshlrev_b32 v112, 16, v120
    v_and_b32 v113, 0xffff0000, v120
    v_lshlrev_b32 v114, 16, v121
    v_and_b32 v115, 0xffff0000, v121
    v_lshlrev_b32 v116, 16, v122
    v_and_b32 v117, 0xffff0000, v122
    v_lshlrev_b32 v118, 16, v123
    v_and_b32 v119, 0xffff0000, v123
    v_lshlrev_b32 v120, 16, v124
    v_and_b32 v121, 0xffff0000, v124
    v_lshlrev_b32 v122, 16, v125
    v_and_b32 v123, 0xffff0000, v125
    v_lshlrev_b32 v124, 16, v126
    v_and_b32 v125, 0xffff0000, v126
    v_lshlrev_b32 v126, 16, v127
    v_and_b32 v127, 0xffff0000, v127
    s_waitcnt lgkmcnt(8)
    v_lshlrev_b32 v128, 16, v136
    v_and_b32 v129, 0xffff0000, v136
    v_lshlrev_b32 v130, 16, v137
    v_and_b32 v131, 0xffff0000, v137
    v_lshlrev_b32 v132, 16, v138
    v_and_b32 v133, 0xffff0000, v138
    v_lshlrev_b32 v134, 16, v139
    v_and_b32 v135, 0xffff0000, v139
    v_lshlrev_b32 v136, 16, v140
    v_and_b32 v137, 0xffff0000, v140
    v_lshlrev_b32 v138, 16, v141
    v_and_b32 v139, 0xffff0000, v141
    v_lshlrev_b32 v140, 16, v142
    v_and_b32 v141, 0xffff0000, v142
    v_lshlrev_b32 v142, 16, v143
    v_and_b32 v143, 0xffff0000, v143
    s_waitcnt lgkmcnt(4)
    v_lshlrev_b32 v144, 16, v152
    v_and_b32 v145, 0xffff0000, v152
    v_lshlrev_b32 v146, 16, v153
    v_and_b32 v147, 0xffff0000, v153
    v_lshlrev_b32 v148, 16, v154
    v_and_b32 v149, 0xffff0000, v154
    v_lshlrev_b32 v150, 16, v155
    v_and_b32 v151, 0xffff0000, v155
    v_lshlrev_b32 v152, 16, v156
    v_and_b32 v153, 0xffff0000, v156
    v_lshlrev_b32 v154, 16, v157
    v_and_b32 v155, 0xffff0000, v157
    v_lshlrev_b32 v156, 16, v158
    v_and_b32 v157, 0xffff0000, v158
    v_lshlrev_b32 v158, 16, v159
    v_and_b32 v159, 0xffff0000, v159
    s_waitcnt lgkmcnt(0)
    v_lshlrev_b32 v160, 16, v168
    v_and_b32 v161, 0xffff0000, v168
    v_lshlrev_b32 v162, 16, v169
    v_and_b32 v163, 0xffff0000, v169
    v_lshlrev_b32 v164, 16, v170
    v_and_b32 v165, 0xffff0000, v170
    v_lshlrev_b32 v166, 16, v171
    v_and_b32 v167, 0xffff0000, v171
    v_lshlrev_b32 v168, 16, v172
    v_and_b32 v169, 0xffff0000, v172
    v_lshlrev_b32 v170, 16, v173
    v_and_b32 v171, 0xffff0000, v173
    v_lshlrev_b32 v172, 16, v174
    v_and_b32 v173, 0xffff0000, v174
    v_lshlrev_b32 v174, 16, v175
    v_and_b32 v175, 0xffff0000, v175
K2_FLGW:
    s_or_b32 s58, s54, s20
    s_waitcnt vmcnt(0)
    v_xor_b32 v56, s2, v56
    v_xor_b32 v57, s2, v57
    v_xor_b32 v58, s2, v58
    v_xor_b32 v59, s2, v59
    v_or3_b32 v56, v56, v57, v58
    v_or_b32 v56, v56, v59
    v_cmp_ne_u32 vcc, 0, v56
    s_nop 0
    s_cbranch_vccnz K2_FLGR
    s_cmp_eq_u32 s58, 0
    s_cbranch_scc1 K2_FLGY
K2_FLGOK:
    s_cmp_eq_u32 s36, 0
    s_cbranch_scc1 K2_TAIL2
    s_mov_b32 s29, s48
    s_mov_b32 s32, s31
    s_mov_b32 s30, s3
    s_mov_b32 s31, s35
    s_bfe_u32 s56, s3, 0x40012
    s_cmp_eq_u32 s56, 5
    s_cbranch_scc1 K2_U21
    s_cmp_eq_u32 s56, 6
    s_cbranch_scc1 K2_U3h1
    s_branch K2_DSP1
K2_dum_4:
    v_mov_b32 v232, -1
    s_mov_b32 m0, 163360
    s_mov_b64 exec, 1
    buffer_load_dwordx4 v232, s[16:19], 0 offen lds
    buffer_load_dwordx4 v232, s[16:19], 0 offen lds
    s_mov_b64 exec, -1
    s_branch K2_back_6
K2_nul_10:
    s_mov_b32 s58, 63
    s_mov_b32 s36, 0
    s_branch K2_back_13
K2_spin_11:
    s_sub_u32 s27, s27, 1
    s_cbranch_scc1 K2_END
    v_lshl_add_u32 v233, v252, 1, s53
    ds_read_b32 v233, v233
    s_waitcnt lgkmcnt(0)
    s_branch K2_chk_12
K2_dyn_8:
    v_mov_b32 v254, 163296
    v_mov_b32 v255, 1
    v_lshl_add_u32 v233, v252, 1, s53
    s_mov_b64 exec, 1
    ds_add_rtn_u32 v232, v254, v255
    s_mov_b64 exec, -1
    ds_read_b32 v233, v233
    s_waitcnt lgkmcnt(0)
    v_readfirstlane_b32 s58, v232
    s_nop 0
    s_cmp_lt_u32 s58, s22
    s_cbranch_scc0 K2_nul_10
    s_and_b32 s59, s58, 7
    s_lshr_b32 s60, s58, 3
K2_chk_12:
    v_readlane_b32 s61, v233, s59
    s_nop 0
    s_cmp_gt_u32 s61, s60
    s_cbranch_scc0 K2_spin_11
K2_back_13:
    s_mov_b32 s34, 1
    s_branch K2_back_9
K2_dum_17:
    v_mov_b32 v232, -1
    s_mov_b32 m0, 163360
    s_mov_b64 exec, 1
    buffer_load_dwordx4 v232, s[16:19], 0 offen lds
    buffer_load_dwordx4 v232, s[16:19], 0 offen lds
    s_mov_b64 exec, -1
    s_branch K2_back_19
K2_nul_23:
    s_mov_b32 s58, 63
    s_mov_b32 s36, 0
    s_branch K2_back_26
K2_spin_24:
    s_sub_u32 s27, s27, 1
    s_cbranch_scc1 K2_END
    v_lshl_add_u32 v233, v252, 1, s53
    ds_read_b32 v233, v233
    s_waitcnt lgkmcnt(0)
    s_branch K2_chk_25
K2_dyn_21:
    v_mov_b32 v254, 163296
    v_mov_b32 v255, 1
    v_lshl_add_u32 v233, v252, 1, s53
    s_mov_b64 exec, 1
    ds_add_rtn_u32 v232, v254, v255
    s_mov_b64 exec, -1
    ds_read_b32 v233, v233
    s_waitcnt lgkmcnt(0)
    v_readfirstlane_b32 s58, v232
    s_nop 0
    s_cmp_lt_u32 s58, s22
    s_cbranch_scc0 K2_nul_23
    s_and_b32 s59, s58, 7
    s_lshr_b32 s60, s58, 3
K2_chk_25:
    v_readlane_b32 s61, v233, s59
    s_nop 0
    s_cmp_gt_u32 s61, s60
    s_cbranch_scc0 K2_spin_24
K2_back_26:
    s_mov_b32 s34, 1
    s_branch K2_back_22
K2_dum_30:
    v_mov_b32 v232, -1
    s_mov_b32 m0, 163360
    s_mov_b64 exec, 1
    buffer_load_dwordx4 v232, s[16:19], 0 offen lds
    buffer_load_dwordx4 v232, s[16:19], 0 offen lds
    s_mov_b64 exec, -1
    s_branch K2_back_32
K2_nul_36:
    s_mov_b32 s58, 63
    s_mov_b32 s36, 0
    s_branch K2_back_39
K2_spin_37:
    s_sub_u32 s27, s27, 1
    s_cbranch_scc1 K2_END
    v_lshl_add_u32 v233, v252, 1, s53
    ds_read_b32 v233, v233
    s_waitcnt lgkmcnt(0)
    s_branch K2_chk_38
K2_dyn_34:
    v_mov_b32 v254, 163296
    v_mov_b32 v255, 1
    v_lshl_add_u32 v233, v252, 1, s53
    s_mov_b64 exec, 1
    ds_add_rtn_u32 v232, v254, v255
    s_mov_b64 exec, -1
    ds_read_b32 v233, v233
    s_waitcnt lgkmcnt(0)
    v_readfirstlane_b32 s58, v232
    s_nop 0
    s_cmp_lt_u32 s58, s22
    s_cbranch_scc0 K2_nul_36
    s_and_b32 s59, s58, 7
    s_lshr_b32 s60, s58, 3
K2_chk_38:
    v_readlane_b32 s61, v233, s59
    s_nop 0
    s_cmp_gt_u32 s61, s60
    s_cbranch_scc0 K2_spin_37
K2_back_39:
    s_mov_b32 s34, 1
    s_branch K2_back_35
K2_dum_43:
    v_mov_b32 v232, -1
    s_mov_b32 m0, 163360
    s_mov_b64 exec, 1
    buffer_load_dwordx4 v232, s[16:19], 0 offen lds
    buffer_load_dwordx4 v232, s[16:19], 0 offen lds
    s_mov_b64 exec, -1
    s_branch K2_back_45
K2_nul_47:
    s_mov_b32 s58, 63
    s_mov_b32 s36, 0
    s_branch K2_back_50
K2_spin_48:
    s_sub_u32 s27, s27, 1
    s_cbranch_scc1 K2_END
    v_lshl_add_u32 v233, v252, 1, s53
    ds_read_b32 v233, v233
    s_waitcnt lgkmcnt(0)
    s_branch K2_chk_49
K2_nul_54:
    s_mov_b32 s58, 63
    s_mov_b32 s36, 0
    s_branch K2_back_57
K2_spin_55:
    s_sub_u32 s27, s27, 1
    s_cbranch_scc1 K2_END
    v_lshl_add_u32 v233, v252, 1, s53
    ds_read_b32 v233, v233
    s_waitcnt lgkmcnt(0)
    s_branch K2_chk_56
K2_nul_61:
    s_mov_b32 s58, 63
    s_mov_b32 s36, 0
    s_branch K2_back_64
K2_spin_62:
    s_sub_u32 s27, s27, 1
    s_cbranch_scc1 K2_END
    v_lshl_add_u32 v233, v252, 1, s53
    ds_read_b32 v233, v233
    s_waitcnt lgkmcnt(0)
    s_branch K2_chk_63
K2_PAD_TL:
    s_branch K2_HOP
K2_TAIL2:
    v_lshlrev_b32 v229, 3, v252
    s_mul_i32 s58, s20, 20480
    s_add_u32 s58, s58, 6946816
    s_mul_i32 s59, s20, 8224
    buffer_load_dwordx4 v[96:99], v229, s[8:11], s58 offen offset:0 sc1
    buffer_load_dwordx4 v[100:103], v229, s[8:11], s58 offen offset:1024 sc1
    buffer_load_dwordx4 v[104:107], v229, s[8:11], s58 offen offset:2048 sc1
    buffer_load_dwordx4 v[108:111], v229, s[8:11], s58 offen offset:3072 sc1
    s_add_u32 s58, s58, 4096
    buffer_load_dwordx4 v[112:115], v229, s[8:11], s58 offen offset:0 sc1
    buffer_load_dwordx4 v[116:119], v229, s[8:11], s58 offen offset:1024 sc1
    buffer_load_dwordx4 v[120:123], v229, s[8:11], s58 offen offset:2048 sc1
    buffer_load_dwordx4 v[124:127], v229, s[8:11], s58 offen offset:3072 sc1
    v_lshl_add_u32 v228, v252, 1, s59
    v_lshrrev_b32 v226, 6, v252
    v_mul_u32_u24 v226, 126, v226
    v_sub_u32 v226, v228, v226
    s_branch K2_TAIL3
K2_TAIL:
    v_lshlrev_b32 v229, 3, v252
    s_mul_i32 s58, s20, 20480
    s_add_u32 s58, s58, 6946816
    s_mul_i32 s59, s20, 8224
    buffer_load_dwordx4 v[96:99], v229, s[8:11], s58 offen offset:0 sc1
    v_permlane32_swap_b32 v242, v236
    v_permlane32_swap_b32 v243, v237
    buffer_load_dwordx4 v[100:103], v229, s[8:11], s58 offen offset:1024 sc1
    v_permlane32_swap_b32 v244, v238
    v_permlane32_swap_b32 v245, v239
    buffer_load_dwordx4 v[104:107], v229, s[8:11], s58 offen offset:2048 sc1
    v_permlane32_swap_b32 v240, v241
    v_add_f32 v242, v242, v236
    buffer_load_dwordx4 v[108:111], v229, s[8:11], s58 offen offset:3072 sc1
    v_add_f32 v243, v243, v237
    v_add_f32 v244, v244, v238
    s_add_u32 s58, s58, 4096
    buffer_load_dwordx4 v[112:115], v229, s[8:11], s58 offen offset:0 sc1
    v_add_f32 v245, v245, v239
    v_add_f32 v240, -v240, -v241
    buffer_load_dwordx4 v[116:119], v229, s[8:11], s58 offen offset:1024 sc1
    v_sub_u32 v241, v230, v231
    v_cvt_pk_bf16_f32 v242, v242, v243
    buffer_load_dwordx4 v[120:123], v229, s[8:11], s58 offen offset:2048 sc1
    v_cvt_pk_bf16_f32 v244, v244, v245
    v_cvt_pk_bf16_f32 v240, v240, v240
    buffer_load_dwordx4 v[124:127], v229, s[8:11], s58 offen offset:3072 sc1
    ds_write_b32 v230, v242 offset:768
    ds_write_b32 v230, v244 offset:1024
    ds_write_b16 v241, v240 offset:1280
    v_lshl_add_u32 v228, v252, 1, s59
    v_lshrrev_b32 v226, 6, v252
    v_mul_u32_u24 v226, 126, v226
    v_sub_u32 v226, v228, v226
K2_TAIL3:
    s_waitcnt vmcnt(8)
    ds_write_b32 v228, v192 offset:0
    ds_write_b32 v228, v193 offset:256
    ds_write_b32 v228, v194 offset:512
    s_add_u32 s58, s58, 4096
    buffer_load_dwordx4 v[128:131], v229, s[8:11], s58 offen offset:0 sc1
    v_bfe_u32 v48, v252, 1, 4
    v_lshrrev_b32 v49, 5, v252
    ds_write_b32 v228, v195 offset:768
    ds_write_b32 v228, v196 offset:1024
    ds_write_b16 v226, v197 offset:1280
    buffer_load_dwordx4 v[132:135], v229, s[8:11], s58 offen offset:1024 sc1
    v_lshrrev_b32 v55, 3, v48
    v_lshlrev_b32 v52, 4, v49
    ds_write_b32 v228, v198 offset:1536
    ds_write_b32 v228, v199 offset:1792
    ds_write_b32 v228, v200 offset:2048
    buffer_load_dwordx4 v[136:139], v229, s[8:11], s58 offen offset:2048 sc1
    v_lshl_add_u32 v54, v55, 2, v48
    v_and_b32 v54, 7, v54
    ds_write_b32 v228, v201 offset:2304
    ds_write_b32 v228, v202 offset:2560
    ds_write_b16 v226, v203 offset:2816
    buffer_load_dwordx4 v[140:143], v229, s[8:11], s58 offen offset:3072 sc1
    v_and_b32 v50, 7, v48
    v_mul_u32_u24 v50, 8224, v50
    ds_write_b32 v228, v204 offset:3072
    ds_write_b32 v228, v205 offset:3328
    ds_write_b32 v228, v206 offset:3584
    s_add_u32 s58, s58, 4096
    buffer_load_dwordx4 v[144:147], v229, s[8:11], s58 offen offset:0 sc1
    v_mul_u32_u24 v51, 1536, v55
    v_add_u32 v50, v50, v51
    ds_write_b32 v228, v207 offset:3840
    ds_write_b32 v228, v208 offset:4096
    ds_write_b16 v226, v209 offset:4352
    buffer_load_dwordx4 v[148:151], v229, s[8:11], s58 offen offset:1024 sc1
    v_add_u32 v222, v50, v52
    v_mul_u32_u24 v51, 8224, v54
    ds_write_b32 v228, v210 offset:4608
    ds_write_b32 v228, v211 offset:4864
    ds_write_b32 v228, v212 offset:5120
    buffer_load_dwordx4 v[152:155], v229, s[8:11], s58 offen offset:2048 sc1
    v_add_u32 v232, v51, v52
    v_lshl_add_u32 v247, v55, 7, v232
    ds_write_b32 v228, v213 offset:5376
    ds_write_b32 v228, v214 offset:5632
    ds_write_b16 v226, v215 offset:5888
    buffer_load_dwordx4 v[156:159], v229, s[8:11], s58 offen offset:3072 sc1
    v_mul_u32_u24 v51, 2080, v48
    s_mov_b32 s60, 65536
    ds_write_b32 v228, v216 offset:6144
    ds_write_b32 v228, v217 offset:6400
    ds_write_b32 v228, v218 offset:6656
    s_add_u32 s58, s58, 4096
    buffer_load_dwordx4 v[160:163], v229, s[8:11], s58 offen offset:0 sc1
    v_add3_u32 v223, v51, v52, s60
    v_mul_u32_u24 v51, 2080, v54
    ds_write_b32 v228, v219 offset:6912
    ds_write_b32 v228, v220 offset:7168
    ds_write_b16 v226, v221 offset:7424
    buffer_load_dwordx4 v[164:167], v229, s[8:11], s58 offen offset:1024 sc1
    s_mov_b32 s60, 132096
    v_add3_u32 v225, v51, v52, s60
    buffer_load_dwordx4 v[168:171], v229, s[8:11], s58 offen offset:2048 sc1
    v_lshl_add_u32 v248, v55, 7, v225
    s_lshl_b32 s60, s20, 5
    buffer_load_dwordx4 v[172:175], v229, s[8:11], s58 offen offset:3072 sc1
    v_lshl_add_u32 v49, v49, 3, s60
    s_mov_b32 s60, 65536
    v_add3_u32 v255, v51, v49, s60
    v_lshl_add_u32 v246, v55, 9, v255
    v_bfe_u32 v53, v48, 2, 1
    v_lshl_add_u32 v49, v53, 4, v49
    v_add_u32 v254, v50, v49
    s_and_b32 s64, s55, s28
    s_waitcnt lgkmcnt(0)
    s_barrier
    s_cmp_eq_u32 s64, 0
    s_cbranch_scc1 K2_MULTI
    s_setprio 3
    ds_read_b128 v[48:51], v222 offset:0
    ds_read_b128 v[52:55], v222 offset:64
    ds_read_b128 v[56:59], v222 offset:896
    ds_read_b128 v[60:63], v222 offset:960
    ds_read_b128 v[64:67], v223 offset:0
    ds_read_b128 v[68:71], v223 offset:64
    ds_read_b128 v[72:75], v223 offset:896
    ds_read_b128 v[76:79], v223 offset:960
    ds_read_b128 v[80:83], v222 offset:3072
    ds_read_b128 v[84:87], v222 offset:3136
    ds_read_b128 v[88:91], v222 offset:3968
    s_waitcnt vmcnt(19) lgkmcnt(9)
    v_mfma_f32_16x16x32_bf16 v[0:3], v[96:99], v[48:51], 0
    ds_read_b128 v[92:95], v222 offset:4032
    s_waitcnt vmcnt(18)
    v_mfma_f32_16x16x32_bf16 v[0:3], v[100:103], v[52:55], v[0:3]
    ds_read_b128 v[48:51], v223 offset:33280
    s_waitcnt vmcnt(17) lgkmcnt(9)
    v_mfma_f32_16x16x32_bf16 v[0:3], v[104:107], v[56:59], v[0:3]
    s_bfe_u32 s60, s20, 0x10002
    s_lshl_b32 s60, s60, 4
    ds_read_b128 v[52:55], v223 offset:33344
    s_waitcnt vmcnt(16)
    v_mfma_f32_16x16x32_bf16 v[0:3], v[108:111], v[60:63], v[0:3]
    s_add_u32 s59, s59, s60
    v_add_u32 v228, s59, v229
    ds_read_b128 v[56:59], v223 offset:34176
    s_waitcnt vmcnt(15) lgkmcnt(9)
    v_mfma_f32_16x16x32_bf16 v[0:3], v[112:115], v[64:67], v[0:3]
    s_mul_i32 s60, s20, 2080
    s_add_u32 s60, s60, 65536
    ds_read_b128 v[60:63], v223 offset:34240
    s_waitcnt vmcnt(14)
    v_mfma_f32_16x16x32_bf16 v[0:3], v[116:119], v[68:71], v[0:3]
    v_add_u32 v249, s60, v229
    s_mov_b32 s63, 0xbfb8aa3b
    ds_read_b128 v[64:67], v232 offset:6144
    s_waitcnt vmcnt(13) lgkmcnt(9)
    v_mfma_f32_16x16x32_bf16 v[0:3], v[120:123], v[72:75], v[0:3]
    s_add_u32 s40, s20, s21
    s_lshl_b32 s40, s40, 10
    ds_read_b128 v[68:71], v232 offset:6208
    s_waitcnt vmcnt(12)
    v_mfma_f32_16x16x32_bf16 v[0:3], v[124:127], v[76:79], v[0:3]
    s_add_u32 s41, s40, 8192
    s_add_u32 s42, s40, 16384
    ds_read_b128 v[72:75], v232 offset:7040
    s_waitcnt lgkmcnt(9)
    v_mfma_f32_16x16x32_bf16 v[16:19], v[96:99], v[80:83], 0
    s_add_u32 s43, s40, 24576
    s_add_u32 s44, s40, 32768
    ds_read_b128 v[76:79], v232 offset:7104
    v_mfma_f32_16x16x32_bf16 v[16:19], v[100:103], v[84:87], v[16:19]
    ds_read_b128 v[80:83], v225 offset:0
    s_waitcnt lgkmcnt(9)
    v_mfma_f32_16x16x32_bf16 v[16:19], v[104:107], v[88:91], v[16:19]
    ds_read_b128 v[84:87], v225 offset:64
    v_mfma_f32_16x16x32_bf16 v[16:19], v[108:111], v[92:95], v[16:19]
    v_mul_f32 v204, s63, v0
    v_mul_f32 v205, s63, v1
    ds_read_b128 v[88:91], v225 offset:896
    s_waitcnt lgkmcnt(9)
    v_mfma_f32_16x16x32_bf16 v[16:19], v[112:115], v[48:51], v[16:19]
    v_mul_f32 v206, s63, v2
    ds_read_b128 v[92:95], v225 offset:960
    v_mfma_f32_16x16x32_bf16 v[16:19], v[116:119], v[52:55], v[16:19]
    v_mul_f32 v207, s63, v3
    ds_read_b128 v[48:51], v222 offset:128
    s_waitcnt lgkmcnt(9)
    v_mfma_f32_16x16x32_bf16 v[16:19], v[120:123], v[56:59], v[16:19]
    v_exp_f32 v204, v204
    ds_read_b128 v[52:55], v222 offset:384
    v_mfma_f32_16x16x32_bf16 v[16:19], v[124:127], v[60:63], v[16:19]
    v_exp_f32 v205, v205
    ds_read_b128 v[56:59], v222 offset:256
    s_waitcnt lgkmcnt(9)
    v_mfma_f32_16x16x32_bf16 v[32:35], v[96:99], v[64:67], 0
    v_exp_f32 v206, v206
    ds_read_b128 v[60:63], v222 offset:192
    v_mfma_f32_16x16x32_bf16 v[32:35], v[100:103], v[68:71], v[32:35]
    v_exp_f32 v207, v207
    s_setprio 2
    ds_read_b128 v[64:67], v222 offset:448
    s_waitcnt lgkmcnt(9)
    v_mfma_f32_16x16x32_bf16 v[32:35], v[104:107], v[72:75], v[32:35]
    v_add_f32 v204, 1.0, v204
    ds_read_b128 v[68:71], v222 offset:320
    v_mfma_f32_16x16x32_bf16 v[32:35], v[108:111], v[76:79], v[32:35]
    v_add_f32 v205, 1.0, v205
    v_add_f32 v206, 1.0, v206
    ds_read_b128 v[72:75], v222 offset:640
    s_waitcnt lgkmcnt(9)
    v_mfma_f32_16x16x32_bf16 v[32:35], v[112:115], v[80:83], v[32:35]
    v_add_f32 v207, 1.0, v207
    ds_read_b128 v[76:79], v222 offset:512
    v_mfma_f32_16x16x32_bf16 v[32:35], v[116:119], v[84:87], v[32:35]
    v_rcp_f32 v204, v204
    ds_read_b128 v[80:83], v222 offset:768
    s_waitcnt lgkmcnt(9)
    v_mfma_f32_16x16x32_bf16 v[32:35], v[120:123], v[88:91], v[32:35]
    v_rcp_f32 v205, v205
    ds_read_b128 v[84:87], v222 offset:704
    v_mfma_f32_16x16x32_bf16 v[32:35], v[124:127], v[92:95], v[32:35]
    v_rcp_f32 v206, v206
    ds_read_b128 v[88:91], v222 offset:576
    s_waitcnt vmcnt(11) lgkmcnt(9)
    v_mfma_f32_16x16x32_bf16 v[4:7], v[128:131], v[48:51], 0
    v_rcp_f32 v207, v207
    ds_read_b128 v[92:95], v222 offset:832
    v_mfma_f32_16x16x32_bf16 v[8:11], v[128:131], v[52:55], 0
    v_cvt_pk_bf16_f32 v176, v0, v1
    ds_read_b128 v[48:51], v222 offset:1024
    s_waitcnt lgkmcnt(9)
    v_mfma_f32_16x16x32_bf16 v[12:15], v[128:131], v[56:59], 0
    v_cvt_pk_bf16_f32 v177, v2, v3
    ds_read_b128 v[52:55], v222 offset:1280
    s_waitcnt vmcnt(10)
    v_mfma_f32_16x16x32_bf16 v[4:7], v[132:135], v[60:63], v[4:7]
    v_mul_f32 v208, s63, v16
    v_mul_f32 v209, s63, v17
    ds_read_b128 v[56:59], v222 offset:1152
    s_waitcnt lgkmcnt(9)
    v_mfma_f32_16x16x32_bf16 v[8:11], v[132:135], v[64:67], v[8:11]
    v_mul_f32 v210, s63, v18
    ds_read_b128 v[60:63], v222 offset:1088
    v_mfma_f32_16x16x32_bf16 v[12:15], v[132:135], v[68:71], v[12:15]
    v_mul_f32 v211, s63, v19
    ds_read_b128 v[64:67], v222 offset:1344
    s_waitcnt vmcnt(9) lgkmcnt(9)
    v_mfma_f32_16x16x32_bf16 v[4:7], v[136:139], v[72:75], v[4:7]
    v_exp_f32 v208, v208
    ds_read_b128 v[68:71], v222 offset:1216
    v_mfma_f32_16x16x32_bf16 v[8:11], v[136:139], v[76:79], v[8:11]
    v_exp_f32 v209, v209
    ds_read_b128 v[72:75], v223 offset:128
    s_waitcnt lgkmcnt(9)
    v_mfma_f32_16x16x32_bf16 v[12:15], v[136:139], v[80:83], v[12:15]
    v_exp_f32 v210, v210
    ds_read_b128 v[76:79], v223 offset:384
    s_waitcnt vmcnt(8)
    v_mfma_f32_16x16x32_bf16 v[4:7], v[140:143], v[84:87], v[4:7]
    v_exp_f32 v211, v211
    ds_read_b128 v[80:83], v223 offset:256
    s_waitcnt lgkmcnt(9)
    v_mfma_f32_16x16x32_bf16 v[8:11], v[140:143], v[88:91], v[8:11]
    v_add_f32 v208, 1.0, v208
    ds_read_b128 v[84:87], v223 offset:192
    v_mfma_f32_16x16x32_bf16 v[12:15], v[140:143], v[92:95], v[12:15]
    v_add_f32 v209, 1.0, v209
    v_add_f32 v210, 1.0, v210
    ds_read_b128 v[88:91], v223 offset:448
    s_waitcnt vmcnt(7) lgkmcnt(9)
    v_mfma_f32_16x16x32_bf16 v[4:7], v[144:147], v[48:51], v[4:7]
    v_add_f32 v211, 1.0, v211
    s_setprio 1
    ds_read_b128 v[92:95], v223 offset:320
    v_mfma_f32_16x16x32_bf16 v[8:11], v[144:147], v[52:55], v[8:11]
    v_rcp_f32 v208, v208
    ds_read_b128 v[48:51], v223 offset:640
    s_waitcnt lgkmcnt(9)
    v_mfma_f32_16x16x32_bf16 v[12:15], v[144:147], v[56:59], v[12:15]
    v_rcp_f32 v209, v209
    ds_read_b128 v[52:55], v223 offset:512
    s_waitcnt vmcnt(6)
    v_mfma_f32_16x16x32_bf16 v[4:7], v[148:151], v[60:63], v[4:7]
    v_rcp_f32 v210, v210
    ds_read_b128 v[56:59], v223 offset:768
    s_waitcnt lgkmcnt(9)
    v_mfma_f32_16x16x32_bf16 v[8:11], v[148:151], v[64:67], v[8:11]
    v_rcp_f32 v211, v211
    ds_read_b128 v[60:63], v223 offset:704
    v_mfma_f32_16x16x32_bf16 v[12:15], v[148:151], v[68:71], v[12:15]
K2_PAD_T2:
    s_cbranch_execz K2_HOP
    v_cvt_pk_bf16_f32 v184, v16, v17
    ds_read_b128 v[64:67], v223 offset:576
    s_waitcnt vmcnt(5) lgkmcnt(9)
    v_mfma_f32_16x16x32_bf16 v[4:7], v[152:155], v[72:75], v[4:7]
    v_cvt_pk_bf16_f32 v185, v18, v19
    ds_read_b128 v[68:71], v223 offset:832
    v_mfma_f32_16x16x32_bf16 v[8:11], v[152:155], v[76:79], v[8:11]
    v_mul_f32 v212, s63, v32
    v_mul_f32 v213, s63, v33
    ds_read_b128 v[72:75], v223 offset:1024
    s_waitcnt lgkmcnt(9)
    v_mfma_f32_16x16x32_bf16 v[12:15], v[152:155], v[80:83], v[12:15]
    v_mul_f32 v214, s63, v34
    ds_read_b128 v[76:79], v223 offset:1280
    s_waitcnt vmcnt(4)
    v_mfma_f32_16x16x32_bf16 v[4:7], v[156:159], v[84:87], v[4:7]
    v_mul_f32 v215, s63, v35
    ds_read_b128 v[80:83], v223 offset:1152
    s_waitcnt lgkmcnt(9)
    v_mfma_f32_16x16x32_bf16 v[8:11], v[156:159], v[88:91], v[8:11]
    v_exp_f32 v212, v212
    ds_read_b128 v[84:87], v223 offset:1088
    v_mfma_f32_16x16x32_bf16 v[12:15], v[156:159], v[92:95], v[12:15]
    v_exp_f32 v213, v213
    ds_read_b128 v[88:91], v223 offset:1344
    s_waitcnt vmcnt(3) lgkmcnt(9)
    v_mfma_f32_16x16x32_bf16 v[4:7], v[160:163], v[48:51], v[4:7]
    v_exp_f32 v214, v214
    ds_read_b128 v[92:95], v223 offset:1216
    v_mfma_f32_16x16x32_bf16 v[8:11], v[160:163], v[52:55], v[8:11]
    v_exp_f32 v215, v215
    ds_read_b128 v[48:51], v222 offset:3200
    s_waitcnt lgkmcnt(9)
    v_mfma_f32_16x16x32_bf16 v[12:15], v[160:163], v[56:59], v[12:15]
    v_add_f32 v212, 1.0, v212
    ds_read_b128 v[52:55], v222 offset:3456
    s_waitcnt vmcnt(2)
    v_mfma_f32_16x16x32_bf16 v[4:7], v[164:167], v[60:63], v[4:7]
    v_add_f32 v213, 1.0, v213
    v_add_f32 v214, 1.0, v214
    ds_read_b128 v[56:59], v222 offset:3328
    s_waitcnt lgkmcnt(9)
    v_mfma_f32_16x16x32_bf16 v[8:11], v[164:167], v[64:67], v[8:11]
    v_add_f32 v215, 1.0, v215
    ds_read_b128 v[60:63], v222 offset:3264
    v_mfma_f32_16x16x32_bf16 v[12:15], v[164:167], v[68:71], v[12:15]
    v_rcp_f32 v212, v212
    s_setprio 0
    ds_read_b128 v[64:67], v222 offset:3520
    s_waitcnt vmcnt(1) lgkmcnt(9)
    v_mfma_f32_16x16x32_bf16 v[4:7], v[168:171], v[72:75], v[4:7]
    v_rcp_f32 v213, v213
    ds_read_b128 v[68:71], v222 offset:3392
    v_mfma_f32_16x16x32_bf16 v[8:11], v[168:171], v[76:79], v[8:11]
    v_rcp_f32 v214, v214
    ds_read_b128 v[72:75], v222 offset:3712
    s_waitcnt lgkmcnt(9)
    v_mfma_f32_16x16x32_bf16 v[12:15], v[168:171], v[80:83], v[12:15]
    v_rcp_f32 v215, v215
    ds_read_b128 v[76:79], v222 offset:3584
    s_waitcnt vmcnt(0)
    v_mfma_f32_16x16x32_bf16 v[4:7], v[172:175], v[84:87], v[4:7]
    v_cvt_pk_bf16_f32 v220, v32, v33
    ds_read_b128 v[80:83], v222 offset:3840
    s_waitcnt lgkmcnt(9)
    v_mfma_f32_16x16x32_bf16 v[8:11], v[172:175], v[88:91], v[8:11]
    v_cvt_pk_bf16_f32 v221, v34, v35
    ds_read_b128 v[84:87], v222 offset:3776
    v_mfma_f32_16x16x32_bf16 v[12:15], v[172:175], v[92:95], v[12:15]
    ds_read_b128 v[88:91], v222 offset:3648
    s_waitcnt lgkmcnt(9)
    v_mfma_f32_16x16x32_bf16 v[20:23], v[128:131], v[48:51], 0
    ds_read_b128 v[92:95], v222 offset:3904
    v_mfma_f32_16x16x32_bf16 v[24:27], v[128:131], v[52:55], 0
    ds_read_b128 v[48:51], v222 offset:4096
    s_waitcnt lgkmcnt(9)
    v_mfma_f32_16x16x32_bf16 v[28:31], v[128:131], v[56:59], 0
    s_barrier
    s_setprio 3
    ds_read_b128 v[52:55], v222 offset:4352
    v_mfma_f32_16x16x32_bf16 v[20:23], v[132:135], v[60:63], v[20:23]
    v_mul_f32 v4, v4, v204
    ds_read_b128 v[56:59], v222 offset:4224
    s_waitcnt lgkmcnt(9)
    v_mfma_f32_16x16x32_bf16 v[24:27], v[132:135], v[64:67], v[24:27]
    v_mul_f32 v5, v5, v205
    ds_read_b128 v[60:63], v222 offset:4160
    v_mfma_f32_16x16x32_bf16 v[28:31], v[132:135], v[68:71], v[28:31]
    v_mul_f32 v6, v6, v206
    ds_read_b128 v[64:67], v222 offset:4416
    s_waitcnt lgkmcnt(9)
    v_mfma_f32_16x16x32_bf16 v[20:23], v[136:139], v[72:75], v[20:23]
    v_mul_f32 v7, v7, v207
    ds_read_b128 v[68:71], v222 offset:4288
    v_mfma_f32_16x16x32_bf16 v[24:27], v[136:139], v[76:79], v[24:27]
    v_cvt_pk_bf16_f32 v178, v4, v5
    ds_read_b128 v[72:75], v223 offset:33408
    s_waitcnt lgkmcnt(9)
    v_mfma_f32_16x16x32_bf16 v[28:31], v[136:139], v[80:83], v[28:31]
    v_cvt_pk_bf16_f32 v179, v6, v7
    ds_read_b128 v[76:79], v223 offset:33664
    v_mfma_f32_16x16x32_bf16 v[20:23], v[140:143], v[84:87], v[20:23]
    v_mul_f32 v8, v8, v204
    ds_read_b128 v[80:83], v223 offset:33536
    s_waitcnt lgkmcnt(9)
    v_mfma_f32_16x16x32_bf16 v[24:27], v[140:143], v[88:91], v[24:27]
    v_mul_f32 v9, v9, v205
    ds_read_b128 v[84:87], v223 offset:33472
    v_mfma_f32_16x16x32_bf16 v[28:31], v[140:143], v[92:95], v[28:31]
    v_mul_f32 v10, v10, v206
    ds_read_b128 v[88:91], v223 offset:33728
    s_waitcnt lgkmcnt(9)
    v_mfma_f32_16x16x32_bf16 v[20:23], v[144:147], v[48:51], v[20:23]
    v_mul_f32 v11, v11, v207
    s_setprio 2
    ds_read_b128 v[92:95], v223 offset:33600
    v_mfma_f32_16x16x32_bf16 v[24:27], v[144:147], v[52:55], v[24:27]
    v_cvt_pk_bf16_f32 v180, v8, v9
    ds_read_b128 v[48:51], v223 offset:33920
    s_waitcnt lgkmcnt(9)
    v_mfma_f32_16x16x32_bf16 v[28:31], v[144:147], v[56:59], v[28:31]
    v_cvt_pk_bf16_f32 v181, v10, v11
    ds_read_b128 v[52:55], v223 offset:33792
    v_mfma_f32_16x16x32_bf16 v[20:23], v[148:151], v[60:63], v[20:23]
    v_mul_f32 v12, v12, v204
    ds_read_b128 v[56:59], v223 offset:34048
    s_waitcnt lgkmcnt(9)
    v_mfma_f32_16x16x32_bf16 v[24:27], v[148:151], v[64:67], v[24:27]
    v_mul_f32 v13, v13, v205
    ds_read_b128 v[60:63], v223 offset:33984
    v_mfma_f32_16x16x32_bf16 v[28:31], v[148:151], v[68:71], v[28:31]
    v_mul_f32 v14, v14, v206
    ds_read_b128 v[64:67], v223 offset:33856
    s_waitcnt lgkmcnt(9)
    v_mfma_f32_16x16x32_bf16 v[20:23], v[152:155], v[72:75], v[20:23]
    v_mul_f32 v15, v15, v207
    ds_read_b128 v[68:71], v223 offset:34112
    v_mfma_f32_16x16x32_bf16 v[24:27], v[152:155], v[76:79], v[24:27]
    v_cvt_pk_bf16_f32 v182, v12, v13
    ds_read_b128 v[72:75], v223 offset:34304
    s_waitcnt lgkmcnt(9)
    v_mfma_f32_16x16x32_bf16 v[28:31], v[152:155], v[80:83], v[28:31]
    v_cvt_pk_bf16_f32 v183, v14, v15
    ds_read_b128 v[76:79], v223 offset:34560
    v_mfma_f32_16x16x32_bf16 v[20:23], v[156:159], v[84:87], v[20:23]
    ds_write_b64 v254, v[176:177] offset:0
    ds_write_b64 v254, v[178:179] offset:256
    ds_write_b64 v254, v[180:181] offset:512
    ds_write_b64 v254, v[182:183] offset:768
    ds_write_b64 v255, v[220:221] offset:0
    ds_read_b128 v[80:83], v223 offset:34432
    s_waitcnt lgkmcnt(14)
    v_mfma_f32_16x16x32_bf16 v[24:27], v[156:159], v[88:91], v[24:27]
    ds_read_b128 v[84:87], v223 offset:34368
    v_mfma_f32_16x16x32_bf16 v[28:31], v[156:159], v[92:95], v[28:31]
    s_setprio 1
    ds_read_b128 v[88:91], v223 offset:34624
    s_waitcnt lgkmcnt(14)
    v_mfma_f32_16x16x32_bf16 v[20:23], v[160:163], v[48:51], v[20:23]
    ds_read_b128 v[92:95], v223 offset:34496
    v_mfma_f32_16x16x32_bf16 v[24:27], v[160:163], v[52:55], v[24:27]
    ds_read_b128 v[48:51], v247 offset:6272
    s_waitcnt lgkmcnt(14)
    v_mfma_f32_16x16x32_bf16 v[28:31], v[160:163], v[56:59], v[28:31]
    ds_read_b128 v[52:55], v232 offset:6528
    v_mfma_f32_16x16x32_bf16 v[20:23], v[164:167], v[60:63], v[20:23]
    ds_read_b128 v[56:59], v247 offset:6336
    s_waitcnt lgkmcnt(14)
    v_mfma_f32_16x16x32_bf16 v[24:27], v[164:167], v[64:67], v[24:27]
    ds_read_b128 v[60:63], v232 offset:6592
    v_mfma_f32_16x16x32_bf16 v[28:31], v[164:167], v[68:71], v[28:31]
    ds_read_b128 v[64:67], v247 offset:6784
    s_waitcnt lgkmcnt(14)
    v_mfma_f32_16x16x32_bf16 v[20:23], v[168:171], v[72:75], v[20:23]
    ds_read_b128 v[68:71], v232 offset:6656
    v_mfma_f32_16x16x32_bf16 v[24:27], v[168:171], v[76:79], v[24:27]
    ds_read_b128 v[72:75], v247 offset:6848
    s_waitcnt lgkmcnt(9)
    v_mfma_f32_16x16x32_bf16 v[28:31], v[168:171], v[80:83], v[28:31]
    ds_read_b128 v[76:79], v232 offset:6720
    v_mfma_f32_16x16x32_bf16 v[20:23], v[172:175], v[84:87], v[20:23]
    s_setprio 0
    ds_read_b128 v[80:83], v247 offset:7168
    s_waitcnt lgkmcnt(9)
    v_mfma_f32_16x16x32_bf16 v[24:27], v[172:175], v[88:91], v[24:27]
    ds_read_b128 v[84:87], v232 offset:7424
    v_mfma_f32_16x16x32_bf16 v[28:31], v[172:175], v[92:95], v[28:31]
    ds_read_b128 v[88:91], v247 offset:7232
    s_waitcnt lgkmcnt(9)
    v_mfma_f32_16x16x32_bf16 v[36:39], v[128:131], v[48:51], 0
    ds_read_b128 v[92:95], v232 offset:7488
    v_mfma_f32_16x16x32_bf16 v[40:43], v[128:131], v[52:55], 0
    ds_read_b128 v[48:51], v248 offset:128
    s_waitcnt lgkmcnt(9)
    v_mfma_f32_16x16x32_bf16 v[36:39], v[132:135], v[56:59], v[36:39]
    s_barrier
    ds_read_b128 v[192:195], v228 offset:0
    ds_read_b128 v[196:199], v228 offset:1536
    s_setprio 3
    ds_read_b128 v[52:55], v225 offset:384
    v_mfma_f32_16x16x32_bf16 v[40:43], v[132:135], v[60:63], v[40:43]
    v_mul_f32 v20, v20, v208
    v_mul_f32 v21, v21, v209
    ds_read_b128 v[56:59], v248 offset:192
    s_waitcnt lgkmcnt(11)
    v_mfma_f32_16x16x32_bf16 v[36:39], v[136:139], v[64:67], v[36:39]
    v_mul_f32 v22, v22, v210
    ds_read_b128 v[60:63], v225 offset:448
    v_mfma_f32_16x16x32_bf16 v[40:43], v[136:139], v[68:71], v[40:43]
    v_mul_f32 v23, v23, v211
    ds_read_b128 v[64:67], v248 offset:640
    s_waitcnt lgkmcnt(11)
    v_mfma_f32_16x16x32_bf16 v[36:39], v[140:143], v[72:75], v[36:39]
    v_cvt_pk_bf16_f32 v186, v20, v21
    ds_read_b128 v[68:71], v225 offset:512
    v_mfma_f32_16x16x32_bf16 v[40:43], v[140:143], v[76:79], v[40:43]
    v_cvt_pk_bf16_f32 v187, v22, v23
    ds_read_b128 v[72:75], v248 offset:704
    s_waitcnt lgkmcnt(11)
    v_mfma_f32_16x16x32_bf16 v[36:39], v[144:147], v[80:83], v[36:39]
    v_mul_f32 v24, v24, v208
    v_mul_f32 v25, v25, v209
    s_waitcnt lgkmcnt(6)
    buffer_store_dwordx4 v[192:195], v229, s[12:15], s40 offen sc1
    buffer_store_dwordx4 v[196:199], v229, s[12:15], s41 offen sc1
    s_setprio 2
    ds_read_b128 v[76:79], v225 offset:576
    v_mfma_f32_16x16x32_bf16 v[40:43], v[144:147], v[84:87], v[40:43]
    v_mul_f32 v26, v26, v210
    ds_read_b128 v[80:83], v248 offset:1024
    v_mfma_f32_16x16x32_bf16 v[36:39], v[148:151], v[88:91], v[36:39]
    v_mul_f32 v27, v27, v211
    ds_read_b128 v[84:87], v225 offset:1280
    v_mfma_f32_16x16x32_bf16 v[40:43], v[148:151], v[92:95], v[40:43]
    v_cvt_pk_bf16_f32 v188, v24, v25
    ds_read_b128 v[88:91], v248 offset:1088
    s_waitcnt lgkmcnt(9)
    v_mfma_f32_16x16x32_bf16 v[36:39], v[152:155], v[48:51], v[36:39]
    v_cvt_pk_bf16_f32 v189, v26, v27
    ds_read_b128 v[92:95], v225 offset:1344
    v_mfma_f32_16x16x32_bf16 v[40:43], v[152:155], v[52:55], v[40:43]
    v_mul_f32 v28, v28, v208
    v_mul_f32 v29, v29, v209
    s_waitcnt lgkmcnt(8)
    v_mfma_f32_16x16x32_bf16 v[36:39], v[156:159], v[56:59], v[36:39]
    v_mul_f32 v30, v30, v210
    v_mfma_f32_16x16x32_bf16 v[40:43], v[156:159], v[60:63], v[40:43]
    v_mul_f32 v31, v31, v211
    s_setprio 1
    s_waitcnt lgkmcnt(6)
    v_mfma_f32_16x16x32_bf16 v[36:39], v[160:163], v[64:67], v[36:39]
    v_cvt_pk_bf16_f32 v190, v28, v29
    v_mfma_f32_16x16x32_bf16 v[40:43], v[160:163], v[68:71], v[40:43]
    v_cvt_pk_bf16_f32 v191, v30, v31
    s_waitcnt lgkmcnt(4)
    v_mfma_f32_16x16x32_bf16 v[36:39], v[164:167], v[72:75], v[36:39]
    ds_write_b64 v254, v[184:185] offset:3072
    ds_write_b64 v254, v[186:187] offset:3328
    ds_write_b64 v254, v[188:189] offset:3584
    ds_write_b64 v254, v[190:191] offset:3840
    v_mfma_f32_16x16x32_bf16 v[40:43], v[164:167], v[76:79], v[40:43]
    s_waitcnt lgkmcnt(6)
    v_mfma_f32_16x16x32_bf16 v[36:39], v[168:171], v[80:83], v[36:39]
    v_mfma_f32_16x16x32_bf16 v[40:43], v[168:171], v[84:87], v[40:43]
    s_setprio 0
    s_waitcnt lgkmcnt(4)
    v_mfma_f32_16x16x32_bf16 v[36:39], v[172:175], v[88:91], v[36:39]
    v_mfma_f32_16x16x32_bf16 v[40:43], v[172:175], v[92:95], v[40:43]
    s_nop 6
    v_mul_f32 v36, v36, v212
    v_mul_f32 v37, v37, v213
    v_mul_f32 v38, v38, v214
    v_mul_f32 v39, v39, v215
    v_cvt_pk_bf16_f32 v178, v36, v37
    v_cvt_pk_bf16_f32 v179, v38, v39
    v_mul_f32 v40, v40, v212
    v_mul_f32 v41, v41, v213
    v_mul_f32 v42, v42, v214
    v_mul_f32 v43, v43, v215
    v_cvt_pk_bf16_f32 v180, v40, v41
    v_cvt_pk_bf16_f32 v181, v42, v43
    ds_write_b64 v246, v[178:179] offset:256
    ds_write_b64 v255, v[180:181] offset:512
    s_waitcnt lgkmcnt(0)
    s_barrier
    ds_read_b128 v[192:195], v228 offset:3072
    ds_read_b128 v[196:199], v228 offset:4608
    ds_read_b128 v[200:203], v249
    s_waitcnt lgkmcnt(1)
    buffer_store_dwordx4 v[192:195], v229, s[12:15], s42 offen sc1
    buffer_store_dwordx4 v[196:199], v229, s[12:15], s43 offen sc1
K2_LASTROW:
    s_add_u32 s59, s20, 32
    s_cmp_ge_u32 s59, s22
    s_cbranch_scc1 K2_FIN
    s_waitcnt lgkmcnt(0)
    buffer_store_dwordx4 v[200:203], v229, s[12:15], s44 offen sc1
K2_FIN:
    s_endpgm
K2_MULTI:
    ds_read_b128 v[48:51], v222 offset:0
    ds_read_b128 v[52:55], v222 offset:64
    ds_read_b128 v[56:59], v222 offset:896
    ds_read_b128 v[60:63], v222 offset:960
    ds_read_b128 v[64:67], v223 offset:0
    ds_read_b128 v[68:71], v223 offset:64
    ds_read_b128 v[72:75], v223 offset:896
    ds_read_b128 v[76:79], v223 offset:960
    ds_read_b128 v[80:83], v222 offset:3072
    ds_read_b128 v[84:87], v222 offset:3136
    ds_read_b128 v[88:91], v222 offset:3968
    s_waitcnt vmcnt(19) lgkmcnt(9)
    v_mfma_f32_16x16x32_bf16 v[0:3], v[96:99], v[48:51], 0
    ds_read_b128 v[92:95], v222 offset:4032
    s_waitcnt vmcnt(18)
    v_mfma_f32_16x16x32_bf16 v[0:3], v[100:103], v[52:55], v[0:3]
    ds_read_b128 v[48:51], v223 offset:33280
    s_waitcnt vmcnt(17) lgkmcnt(9)
    v_mfma_f32_16x16x32_bf16 v[0:3], v[104:107], v[56:59], v[0:3]
    ds_read_b128 v[52:55], v223 offset:33344
    s_waitcnt vmcnt(16)
    v_mfma_f32_16x16x32_bf16 v[0:3], v[108:111], v[60:63], v[0:3]
    ds_read_b128 v[56:59], v223 offset:34176
    s_waitcnt vmcnt(15) lgkmcnt(9)
    v_mfma_f32_16x16x32_bf16 v[0:3], v[112:115], v[64:67], v[0:3]
    ds_read_b128 v[60:63], v223 offset:34240
    s_waitcnt vmcnt(14)
    v_mfma_f32_16x16x32_bf16 v[0:3], v[116:119], v[68:71], v[0:3]
    ds_read_b128 v[64:67], v232 offset:6144
    s_waitcnt vmcnt(13) lgkmcnt(9)
    v_mfma_f32_16x16x32_bf16 v[0:3], v[120:123], v[72:75], v[0:3]
    ds_read_b128 v[68:71], v232 offset:6208
    s_waitcnt vmcnt(12)
    v_mfma_f32_16x16x32_bf16 v[0:3], v[124:127], v[76:79], v[0:3]
    ds_read_b128 v[72:75], v232 offset:7040
    s_waitcnt lgkmcnt(9)
    v_mfma_f32_16x16x32_bf16 v[16:19], v[96:99], v[80:83], 0
    ds_read_b128 v[76:79], v232 offset:7104
    v_mfma_f32_16x16x32_bf16 v[16:19], v[100:103], v[84:87], v[16:19]
    ds_read_b128 v[80:83], v225 offset:0
    s_waitcnt lgkmcnt(9)
    v_mfma_f32_16x16x32_bf16 v[16:19], v[104:107], v[88:91], v[16:19]
    ds_read_b128 v[84:87], v225 offset:64
    v_mfma_f32_16x16x32_bf16 v[16:19], v[108:111], v[92:95], v[16:19]
    ds_read_b128 v[88:91], v225 offset:896
    s_waitcnt lgkmcnt(9)
    v_mfma_f32_16x16x32_bf16 v[16:19], v[112:115], v[48:51], v[16:19]
    ds_read_b128 v[92:95], v225 offset:960
    v_mfma_f32_16x16x32_bf16 v[16:19], v[116:119], v[52:55], v[16:19]
    ds_read_b128 v[48:51], v222 offset:128
    s_waitcnt lgkmcnt(9)
    v_mfma_f32_16x16x32_bf16 v[16:19], v[120:123], v[56:59], v[16:19]
    ds_read_b128 v[52:55], v222 offset:384
    v_mfma_f32_16x16x32_bf16 v[16:19], v[124:127], v[60:63], v[16:19]
    ds_read_b128 v[56:59], v222 offset:256
    s_waitcnt lgkmcnt(9)
    v_mfma_f32_16x16x32_bf16 v[32:35], v[96:99], v[64:67], 0
    ds_read_b128 v[60:63], v222 offset:192
    v_mfma_f32_16x16x32_bf16 v[32:35], v[100:103], v[68:71], v[32:35]
    ds_read_b128 v[64:67], v222 offset:448
    s_waitcnt lgkmcnt(9)
    v_mfma_f32_16x16x32_bf16 v[32:35], v[104:107], v[72:75], v[32:35]
    ds_read_b128 v[68:71], v222 offset:320
    v_mfma_f32_16x16x32_bf16 v[32:35], v[108:111], v[76:79], v[32:35]
    ds_read_b128 v[72:75], v222 offset:640
    s_waitcnt lgkmcnt(9)
    v_mfma_f32_16x16x32_bf16 v[32:35], v[112:115], v[80:83], v[32:35]
    ds_read_b128 v[76:79], v222 offset:512
    v_mfma_f32_16x16x32_bf16 v[32:35], v[116:119], v[84:87], v[32:35]
    ds_read_b128 v[80:83], v222 offset:768
    s_waitcnt lgkmcnt(9)
    v_mfma_f32_16x16x32_bf16 v[32:35], v[120:123], v[88:91], v[32:35]
    ds_read_b128 v[84:87], v222 offset:704
    v_mfma_f32_16x16x32_bf16 v[32:35], v[124:127], v[92:95], v[32:35]
    ds_read_b128 v[88:91], v222 offset:576
    s_waitcnt vmcnt(11) lgkmcnt(9)
    v_mfma_f32_16x16x32_bf16 v[4:7], v[128:131], v[48:51], 0
    ds_read_b128 v[92:95], v222 offset:832
    v_mfma_f32_16x16x32_bf16 v[8:11], v[128:131], v[52:55], 0
    ds_read_b128 v[48:51], v222 offset:1024
    s_waitcnt lgkmcnt(9)
    v_mfma_f32_16x16x32_bf16 v[12:15], v[128:131], v[56:59], 0
    ds_read_b128 v[52:55], v222 offset:1280
    s_waitcnt vmcnt(10)
    v_mfma_f32_16x16x32_bf16 v[4:7], v[132:135], v[60:63], v[4:7]
    ds_read_b128 v[56:59], v222 offset:1152
    s_waitcnt lgkmcnt(9)
    v_mfma_f32_16x16x32_bf16 v[8:11], v[132:135], v[64:67], v[8:11]
    ds_read_b128 v[60:63], v222 offset:1088
    v_mfma_f32_16x16x32_bf16 v[12:15], v[132:135], v[68:71], v[12:15]
    ds_read_b128 v[64:67], v222 offset:1344
    s_waitcnt vmcnt(9) lgkmcnt(9)
    v_mfma_f32_16x16x32_bf16 v[4:7], v[136:139], v[72:75], v[4:7]
    ds_read_b128 v[68:71], v222 offset:1216
    v_mfma_f32_16x16x32_bf16 v[8:11], v[136:139], v[76:79], v[8:11]
    ds_read_b128 v[72:75], v223 offset:128
    s_waitcnt lgkmcnt(9)
    v_mfma_f32_16x16x32_bf16 v[12:15], v[136:139], v[80:83], v[12:15]
    ds_read_b128 v[76:79], v223 offset:384
    s_waitcnt vmcnt(8)
    v_mfma_f32_16x16x32_bf16 v[4:7], v[140:143], v[84:87], v[4:7]
    ds_read_b128 v[80:83], v223 offset:256
    s_waitcnt lgkmcnt(9)
    v_mfma_f32_16x16x32_bf16 v[8:11], v[140:143], v[88:91], v[8:11]
    ds_read_b128 v[84:87], v223 offset:192
    v_mfma_f32_16x16x32_bf16 v[12:15], v[140:143], v[92:95], v[12:15]
    ds_read_b128 v[88:91], v223 offset:448
    s_waitcnt vmcnt(7) lgkmcnt(9)
    v_mfma_f32_16x16x32_bf16 v[4:7], v[144:147], v[48:51], v[4:7]
    ds_read_b128 v[92:95], v223 offset:320
    v_mfma_f32_16x16x32_bf16 v[8:11], v[144:147], v[52:55], v[8:11]
    ds_read_b128 v[48:51], v223 offset:640
    s_waitcnt lgkmcnt(9)
    v_mfma_f32_16x16x32_bf16 v[12:15], v[144:147], v[56:59], v[12:15]
    ds_read_b128 v[52:55], v223 offset:512
    s_waitcnt vmcnt(6)
    v_mfma_f32_16x16x32_bf16 v[4:7], v[148:151], v[60:63], v[4:7]
    ds_read_b128 v[56:59], v223 offset:768
    s_waitcnt lgkmcnt(9)
    v_mfma_f32_16x16x32_bf16 v[8:11], v[148:151], v[64:67], v[8:11]
    ds_read_b128 v[60:63], v223 offset:704
    v_mfma_f32_16x16x32_bf16 v[12:15], v[148:151], v[68:71], v[12:15]
    ds_read_b128 v[64:67], v223 offset:576
    s_waitcnt vmcnt(5) lgkmcnt(9)
    v_mfma_f32_16x16x32_bf16 v[4:7], v[152:155], v[72:75], v[4:7]
    ds_read_b128 v[68:71], v223 offset:832
    v_mfma_f32_16x16x32_bf16 v[8:11], v[152:155], v[76:79], v[8:11]
    ds_read_b128 v[72:75], v223 offset:1024
    s_waitcnt lgkmcnt(9)
    v_mfma_f32_16x16x32_bf16 v[12:15], v[152:155], v[80:83], v[12:15]
    ds_read_b128 v[76:79], v223 offset:1280
    s_waitcnt vmcnt(4)
    v_mfma_f32_16x16x32_bf16 v[4:7], v[156:159], v[84:87], v[4:7]
    ds_read_b128 v[80:83], v223 offset:1152
    s_waitcnt lgkmcnt(9)
    v_mfma_f32_16x16x32_bf16 v[8:11], v[156:159], v[88:91], v[8:11]
    ds_read_b128 v[84:87], v223 offset:1088
    v_mfma_f32_16x16x32_bf16 v[12:15], v[156:159], v[92:95], v[12:15]
    ds_read_b128 v[88:91], v223 offset:1344
    s_waitcnt vmcnt(3) lgkmcnt(9)
    v_mfma_f32_16x16x32_bf16 v[4:7], v[160:163], v[48:51], v[4:7]
    ds_read_b128 v[92:95], v223 offset:1216
    v_mfma_f32_16x16x32_bf16 v[8:11], v[160:163], v[52:55], v[8:11]
    ds_read_b128 v[48:51], v222 offset:3200
    s_waitcnt lgkmcnt(9)
    v_mfma_f32_16x16x32_bf16 v[12:15], v[160:163], v[56:59], v[12:15]
    ds_read_b128 v[52:55], v222 offset:3456
    s_waitcnt vmcnt(2)
    v_mfma_f32_16x16x32_bf16 v[4:7], v[164:167], v[60:63], v[4:7]
    ds_read_b128 v[56:59], v222 offset:3328
    s_waitcnt lgkmcnt(9)
    v_mfma_f32_16x16x32_bf16 v[8:11], v[164:167], v[64:67], v[8:11]
    ds_read_b128 v[60:63], v222 offset:3264
    v_mfma_f32_16x16x32_bf16 v[12:15], v[164:167], v[68:71], v[12:15]
    ds_read_b128 v[64:67], v222 offset:3520
    s_waitcnt vmcnt(1) lgkmcnt(9)
    v_mfma_f32_16x16x32_bf16 v[4:7], v[168:171], v[72:75], v[4:7]
    ds_read_b128 v[68:71], v222 offset:3392
    v_mfma_f32_16x16x32_bf16 v[8:11], v[168:171], v[76:79], v[8:11]
    ds_read_b128 v[72:75], v222 offset:3712
    s_waitcnt lgkmcnt(9)
    v_mfma_f32_16x16x32_bf16 v[12:15], v[168:171], v[80:83], v[12:15]
    ds_read_b128 v[76:79], v222 offset:3584
    s_waitcnt vmcnt(0)
    v_mfma_f32_16x16x32_bf16 v[4:7], v[172:175], v[84:87], v[4:7]
    ds_read_b128 v[80:83], v222 offset:3840
    s_waitcnt lgkmcnt(9)
    v_mfma_f32_16x16x32_bf16 v[8:11], v[172:175], v[88:91], v[8:11]
    ds_read_b128 v[84:87], v222 offset:3776
    v_mfma_f32_16x16x32_bf16 v[12:15], v[172:175], v[92:95], v[12:15]
    ds_read_b128 v[88:91], v222 offset:3648
    s_waitcnt lgkmcnt(9)
    v_mfma_f32_16x16x32_bf16 v[20:23], v[128:131], v[48:51], 0
    ds_read_b128 v[92:95], v222 offset:3904
    v_mfma_f32_16x16x32_bf16 v[24:27], v[128:131], v[52:55], 0
    ds_read_b128 v[48:51], v222 offset:4096
    s_waitcnt lgkmcnt(9)
    v_mfma_f32_16x16x32_bf16 v[28:31], v[128:131], v[56:59], 0
    ds_read_b128 v[52:55], v222 offset:4352
    v_mfma_f32_16x16x32_bf16 v[20:23], v[132:135], v[60:63], v[20:23]
    ds_read_b128 v[56:59], v222 offset:4224
    s_waitcnt lgkmcnt(9)
    v_mfma_f32_16x16x32_bf16 v[24:27], v[132:135], v[64:67], v[24:27]
    ds_read_b128 v[60:63], v222 offset:4160
    v_mfma_f32_16x16x32_bf16 v[28:31], v[132:135], v[68:71], v[28:31]
    ds_read_b128 v[64:67], v222 offset:4416
    s_waitcnt lgkmcnt(9)
    v_mfma_f32_16x16x32_bf16 v[20:23], v[136:139], v[72:75], v[20:23]
    ds_read_b128 v[68:71], v222 offset:4288
    v_mfma_f32_16x16x32_bf16 v[24:27], v[136:139], v[76:79], v[24:27]
    ds_read_b128 v[72:75], v223 offset:33408
    s_waitcnt lgkmcnt(9)
    v_mfma_f32_16x16x32_bf16 v[28:31], v[136:139], v[80:83], v[28:31]
    ds_read_b128 v[76:79], v223 offset:33664
    v_mfma_f32_16x16x32_bf16 v[20:23], v[140:143], v[84:87], v[20:23]
    ds_read_b128 v[80:83], v223 offset:33536
    s_waitcnt lgkmcnt(9)
    v_mfma_f32_16x16x32_bf16 v[24:27], v[140:143], v[88:91], v[24:27]
    ds_read_b128 v[84:87], v223 offset:33472
    v_mfma_f32_16x16x32_bf16 v[28:31], v[140:143], v[92:95], v[28:31]
    ds_read_b128 v[88:91], v223 offset:33728
    s_waitcnt lgkmcnt(9)
    v_mfma_f32_16x16x32_bf16 v[20:23], v[144:147], v[48:51], v[20:23]
    ds_read_b128 v[92:95], v223 offset:33600
    v_mfma_f32_16x16x32_bf16 v[24:27], v[144:147], v[52:55], v[24:27]
    ds_read_b128 v[48:51], v223 offset:33920
    s_waitcnt lgkmcnt(9)
    v_mfma_f32_16x16x32_bf16 v[28:31], v[144:147], v[56:59], v[28:31]
    ds_read_b128 v[52:55], v223 offset:33792
    v_mfma_f32_16x16x32_bf16 v[20:23], v[148:151], v[60:63], v[20:23]
    ds_read_b128 v[56:59], v223 offset:34048
    s_waitcnt lgkmcnt(9)
    v_mfma_f32_16x16x32_bf16 v[24:27], v[148:151], v[64:67], v[24:27]
    ds_read_b128 v[60:63], v223 offset:33984
    v_mfma_f32_16x16x32_bf16 v[28:31], v[148:151], v[68:71], v[28:31]
    ds_read_b128 v[64:67], v223 offset:33856
    s_waitcnt lgkmcnt(9)
    v_mfma_f32_16x16x32_bf16 v[20:23], v[152:155], v[72:75], v[20:23]
    ds_read_b128 v[68:71], v223 offset:34112
    v_mfma_f32_16x16x32_bf16 v[24:27], v[152:155], v[76:79], v[24:27]
    ds_read_b128 v[72:75], v223 offset:34304
    s_waitcnt lgkmcnt(9)
    v_mfma_f32_16x16x32_bf16 v[28:31], v[152:155], v[80:83], v[28:31]
    ds_read_b128 v[76:79], v223 offset:34560
    v_mfma_f32_16x16x32_bf16 v[20:23], v[156:159], v[84:87], v[20:23]
    ds_read_b128 v[80:83], v223 offset:34432
    s_waitcnt lgkmcnt(9)
    v_mfma_f32_16x16x32_bf16 v[24:27], v[156:159], v[88:91], v[24:27]
    ds_read_b128 v[84:87], v223 offset:34368
    v_mfma_f32_16x16x32_bf16 v[28:31], v[156:159], v[92:95], v[28:31]
    ds_read_b128 v[88:91], v223 offset:34624
    s_waitcnt lgkmcnt(9)
    v_mfma_f32_16x16x32_bf16 v[20:23], v[160:163], v[48:51], v[20:23]
    ds_read_b128 v[92:95], v223 offset:34496
    v_mfma_f32_16x16x32_bf16 v[24:27], v[160:163], v[52:55], v[24:27]
    ds_read_b128 v[48:51], v247 offset:6272
    s_waitcnt lgkmcnt(9)
    v_mfma_f32_16x16x32_bf16 v[28:31], v[160:163], v[56:59], v[28:31]
    ds_read_b128 v[52:55], v232 offset:6528
    v_mfma_f32_16x16x32_bf16 v[20:23], v[164:167], v[60:63], v[20:23]
    ds_read_b128 v[56:59], v247 offset:6336
    s_waitcnt lgkmcnt(9)
    v_mfma_f32_16x16x32_bf16 v[24:27], v[164:167], v[64:67], v[24:27]
    ds_read_b128 v[60:63], v232 offset:6592
    v_mfma_f32_16x16x32_bf16 v[28:31], v[164:167], v[68:71], v[28:31]
    ds_read_b128 v[64:67], v247 offset:6784
    s_waitcnt lgkmcnt(9)
    v_mfma_f32_16x16x32_bf16 v[20:23], v[168:171], v[72:75], v[20:23]
    ds_read_b128 v[68:71], v232 offset:6656
    v_mfma_f32_16x16x32_bf16 v[24:27], v[168:171], v[76:79], v[24:27]
    ds_read_b128 v[72:75], v247 offset:6848
    s_waitcnt lgkmcnt(9)
    v_mfma_f32_16x16x32_bf16 v[28:31], v[168:171], v[80:83], v[28:31]
    ds_read_b128 v[76:79], v232 offset:6720
    v_mfma_f32_16x16x32_bf16 v[20:23], v[172:175], v[84:87], v[20:23]
    ds_read_b128 v[80:83], v247 offset:7168
    s_waitcnt lgkmcnt(9)
    v_mfma_f32_16x16x32_bf16 v[24:27], v[172:175], v[88:91], v[24:27]
    ds_read_b128 v[84:87], v232 offset:7424
    v_mfma_f32_16x16x32_bf16 v[28:31], v[172:175], v[92:95], v[28:31]
    ds_read_b128 v[88:91], v247 offset:7232
    s_waitcnt lgkmcnt(9)
    v_mfma_f32_16x16x32_bf16 v[36:39], v[128:131], v[48:51], 0
    ds_read_b128 v[92:95], v232 offset:7488
    v_mfma_f32_16x16x32_bf16 v[40:43], v[128:131], v[52:55], 0
    ds_read_b128 v[48:51], v248 offset:128
    s_waitcnt lgkmcnt(9)
    v_mfma_f32_16x16x32_bf16 v[36:39], v[132:135], v[56:59], v[36:39]
    ds_read_b128 v[52:55], v225 offset:384
    v_mfma_f32_16x16x32_bf16 v[40:43], v[132:135], v[60:63], v[40:43]
    ds_read_b128 v[56:59], v248 offset:192
    s_waitcnt lgkmcnt(9)
    v_mfma_f32_16x16x32_bf16 v[36:39], v[136:139], v[64:67], v[36:39]
    ds_read_b128 v[60:63], v225 offset:448
    v_mfma_f32_16x16x32_bf16 v[40:43], v[136:139], v[68:71], v[40:43]
    ds_read_b128 v[64:67], v248 offset:640
    s_waitcnt lgkmcnt(9)
    v_mfma_f32_16x16x32_bf16 v[36:39], v[140:143], v[72:75], v[36:39]
    ds_read_b128 v[68:71], v225 offset:512
    v_mfma_f32_16x16x32_bf16 v[40:43], v[140:143], v[76:79], v[40:43]
    ds_read_b128 v[72:75], v248 offset:704
    s_waitcnt lgkmcnt(9)
    v_mfma_f32_16x16x32_bf16 v[36:39], v[144:147], v[80:83], v[36:39]
    ds_read_b128 v[76:79], v225 offset:576
    v_mfma_f32_16x16x32_bf16 v[40:43], v[144:147], v[84:87], v[40:43]
    ds_read_b128 v[80:83], v248 offset:1024
    s_waitcnt lgkmcnt(9)
    v_mfma_f32_16x16x32_bf16 v[36:39], v[148:151], v[88:91], v[36:39]
    ds_read_b128 v[84:87], v225 offset:1280
    v_mfma_f32_16x16x32_bf16 v[40:43], v[148:151], v[92:95], v[40:43]
    ds_read_b128 v[88:91], v248 offset:1088
    s_waitcnt lgkmcnt(9)
    v_mfma_f32_16x16x32_bf16 v[36:39], v[152:155], v[48:51], v[36:39]
    ds_read_b128 v[92:95], v225 offset:1344
    v_mfma_f32_16x16x32_bf16 v[40:43], v[152:155], v[52:55], v[40:43]
    s_waitcnt lgkmcnt(8)
    v_mfma_f32_16x16x32_bf16 v[36:39], v[156:159], v[56:59], v[36:39]
    v_mfma_f32_16x16x32_bf16 v[40:43], v[156:159], v[60:63], v[40:43]
    s_waitcnt lgkmcnt(6)
    v_mfma_f32_16x16x32_bf16 v[36:39], v[160:163], v[64:67], v[36:39]
    v_mfma_f32_16x16x32_bf16 v[40:43], v[160:163], v[68:71], v[40:43]
    s_waitcnt lgkmcnt(4)
    v_mfma_f32_16x16x32_bf16 v[36:39], v[164:167], v[72:75], v[36:39]
    v_mfma_f32_16x16x32_bf16 v[40:43], v[164:167], v[76:79], v[40:43]
    s_waitcnt lgkmcnt(2)
    v_mfma_f32_16x16x32_bf16 v[36:39], v[168:171], v[80:83], v[36:39]
    v_mfma_f32_16x16x32_bf16 v[40:43], v[168:171], v[84:87], v[40:43]
    s_waitcnt lgkmcnt(0)
    v_mfma_f32_16x16x32_bf16 v[36:39], v[172:175], v[88:91], v[36:39]
    v_mfma_f32_16x16x32_bf16 v[40:43], v[172:175], v[92:95], v[40:43]
    s_lshl_b32 s60, s54, 9
    s_lshl_b32 s61, s20, 6
    s_add_u32 s60, s60, s61
    s_mul_i32 s60, s60, 192
    s_add_u32 s60, s60, 10485760
    v_mul_u32_u24 v227, 96, v252
    s_cmp_lg_u32 s28, 0
    s_cbranch_scc1 K2_NOACC
    buffer_load_dwordx4 v[48:51], v227, s[8:11], s60 offen offset:0
    buffer_load_dwordx4 v[52:55], v227, s[8:11], s60 offen offset:16
    buffer_load_dwordx4 v[56:59], v227, s[8:11], s60 offen offset:32
    buffer_load_dwordx4 v[60:63], v227, s[8:11], s60 offen offset:48
    buffer_load_dwordx4 v[64:67], v227, s[8:11], s60 offen offset:64
    buffer_load_dwordx4 v[68:71], v227, s[8:11], s60 offen offset:80
    buffer_load_dwordx4 v[72:75], v227, s[8:11], s60 offen offset:96
    buffer_load_dwordx4 v[76:79], v227, s[8:11], s60 offen offset:112
    buffer_load_dwordx4 v[80:83], v227, s[8:11], s60 offen offset:128
    buffer_load_dwordx4 v[84:87], v227, s[8:11], s60 offen offset:144
    buffer_load_dwordx4 v[88:91], v227, s[8:11], s60 offen offset:160
    s_waitcnt vmcnt(0)
    v_add_f32 v0, v0, v48
    v_add_f32 v1, v1, v49
    v_add_f32 v2, v2, v50
    v_add_f32 v3, v3, v51
    v_add_f32 v4, v4, v52
    v_add_f32 v5, v5, v53
    v_add_f32 v6, v6, v54
    v_add_f32 v7, v7, v55
    v_add_f32 v8, v8, v56
    v_add_f32 v9, v9, v57
    v_add_f32 v10, v10, v58
    v_add_f32 v11, v11, v59
    v_add_f32 v12, v12, v60
    v_add_f32 v13, v13, v61
    v_add_f32 v14, v14, v62
    v_add_f32 v15, v15, v63
    v_add_f32 v16, v16, v64
    v_add_f32 v17, v17, v65
    v_add_f32 v18, v18, v66
    v_add_f32 v19, v19, v67
    v_add_f32 v20, v20, v68
    v_add_f32 v21, v21, v69
    v_add_f32 v22, v22, v70
    v_add_f32 v23, v23, v71
    v_add_f32 v24, v24, v72
    v_add_f32 v25, v25, v73
    v_add_f32 v26, v26, v74
    v_add_f32 v27, v27, v75
    v_add_f32 v28, v28, v76
    v_add_f32 v29, v29, v77
    v_add_f32 v30, v30, v78
    v_add_f32 v31, v31, v79
    v_add_f32 v32, v32, v80
    v_add_f32 v33, v33, v81
    v_add_f32 v34, v34, v82
    v_add_f32 v35, v35, v83
    v_add_f32 v36, v36, v84
    v_add_f32 v37, v37, v85
    v_add_f32 v38, v38, v86
    v_add_f32 v39, v39, v87
    v_add_f32 v40, v40, v88
    v_add_f32 v41, v41, v89
    v_add_f32 v42, v42, v90
    v_add_f32 v43, v43, v91
K2_NOACC:
    s_barrier
    s_cmp_eq_u32 s55, 0
    s_cbranch_scc1 K2_SPILL
    s_bfe_u32 s60, s20, 0x10002
    s_lshl_b32 s60, s60, 4
    s_add_u32 s59, s59, s60
    v_add_u32 v228, s59, v229
    s_mul_i32 s60, s20, 2080
    s_add_u32 s60, s60, 65536
    v_add_u32 v249, s60, v229
    s_mov_b32 s63, 0xbfb8aa3b
    s_add_u32 s40, s20, s21
    s_lshl_b32 s40, s40, 10
    s_add_u32 s41, s40, 8192
    s_add_u32 s42, s40, 16384
    s_add_u32 s43, s40, 24576
    s_add_u32 s44, s40, 32768
    v_mul_f32 v204, s63, v0
    v_mul_f32 v205, s63, v1
    v_mul_f32 v206, s63, v2
    v_mul_f32 v207, s63, v3
    v_exp_f32 v204, v204
    v_exp_f32 v205, v205
    v_exp_f32 v206, v206
    v_exp_f32 v207, v207
    v_add_f32 v204, 1.0, v204
    v_add_f32 v205, 1.0, v205
    v_add_f32 v206, 1.0, v206
    v_add_f32 v207, 1.0, v207
    v_rcp_f32 v204, v204
    v_rcp_f32 v205, v205
    v_rcp_f32 v206, v206
    v_rcp_f32 v207, v207
    v_cvt_pk_bf16_f32 v176, v0, v1
    v_cvt_pk_bf16_f32 v177, v2, v3
    v_mul_f32 v4, v4, v204
    v_mul_f32 v5, v5, v205
    v_mul_f32 v6, v6, v206
    v_mul_f32 v7, v7, v207
    v_cvt_pk_bf16_f32 v178, v4, v5
    v_cvt_pk_bf16_f32 v179, v6, v7
    v_mul_f32 v8, v8, v204
    v_mul_f32 v9, v9, v205
    v_mul_f32 v10, v10, v206
    v_mul_f32 v11, v11, v207
    v_cvt_pk_bf16_f32 v180, v8, v9
    v_cvt_pk_bf16_f32 v181, v10, v11
    v_mul_f32 v12, v12, v204
    v_mul_f32 v13, v13, v205
    v_mul_f32 v14, v14, v206
    v_mul_f32 v15, v15, v207
    v_cvt_pk_bf16_f32 v182, v12, v13
    v_cvt_pk_bf16_f32 v183, v14, v15
    ds_write_b64 v254, v[176:177] offset:0
    ds_write_b64 v254, v[178:179] offset:256
    ds_write_b64 v254, v[180:181] offset:512
    ds_write_b64 v254, v[182:183] offset:768
    s_waitcnt lgkmcnt(0)
    s_barrier
    ds_read_b128 v[192:195], v228 offset:0
    ds_read_b128 v[196:199], v228 offset:1536
    s_waitcnt lgkmcnt(0)
    buffer_store_dwordx4 v[192:195], v229, s[12:15], s40 offen sc1
    buffer_store_dwordx4 v[196:199], v229, s[12:15], s41 offen sc1
    v_mul_f32 v208, s63, v16
    v_mul_f32 v209, s63, v17
    v_mul_f32 v210, s63, v18
    v_mul_f32 v211, s63, v19
    v_exp_f32 v208, v208
    v_exp_f32 v209, v209
    v_exp_f32 v210, v210
    v_exp_f32 v211, v211
    v_add_f32 v208, 1.0, v208
    v_add_f32 v209, 1.0, v209
    v_add_f32 v210, 1.0, v210
    v_add_f32 v211, 1.0, v211
    v_rcp_f32 v208, v208
    v_rcp_f32 v209, v209
    v_rcp_f32 v210, v210
    v_rcp_f32 v211, v211
    v_cvt_pk_bf16_f32 v184, v16, v17
    v_cvt_pk_bf16_f32 v185, v18, v19
    v_mul_f32 v20, v20, v208
    v_mul_f32 v21, v21, v209
    v_mul_f32 v22, v22, v210
    v_mul_f32 v23, v23, v211
    v_cvt_pk_bf16_f32 v186, v20, v21
    v_cvt_pk_bf16_f32 v187, v22, v23
    v_mul_f32 v24, v24, v208
    v_mul_f32 v25, v25, v209
    v_mul_f32 v26, v26, v210
    v_mul_f32 v27, v27, v211
    v_cvt_pk_bf16_f32 v188, v24, v25
    v_cvt_pk_bf16_f32 v189, v26, v27
    v_mul_f32 v28, v28, v208
    v_mul_f32 v29, v29, v209
    v_mul_f32 v30, v30, v210
    v_mul_f32 v31, v31, v211
    v_cvt_pk_bf16_f32 v190, v28, v29
    v_cvt_pk_bf16_f32 v191, v30, v31
    ds_write_b64 v254, v[184:185] offset:3072
    ds_write_b64 v254, v[186:187] offset:3328
    ds_write_b64 v254, v[188:189] offset:3584
    ds_write_b64 v254, v[190:191] offset:3840
    s_waitcnt lgkmcnt(0)
    s_barrier
    ds_read_b128 v[192:195], v228 offset:3072
    ds_read_b128 v[196:199], v228 offset:4608
    s_waitcnt lgkmcnt(0)
    buffer_store_dwordx4 v[192:195], v229, s[12:15], s42 offen sc1
    buffer_store_dwordx4 v[196:199], v229, s[12:15], s43 offen sc1
    v_mul_f32 v212, s63, v32
    v_mul_f32 v213, s63, v33
    v_mul_f32 v214, s63, v34
    v_mul_f32 v215, s63, v35
    v_exp_f32 v212, v212
    v_exp_f32 v213, v213
    v_exp_f32 v214, v214
    v_exp_f32 v215, v215
    v_add_f32 v212, 1.0, v212
    v_add_f32 v213, 1.0, v213
    v_add_f32 v214, 1.0, v214
    v_add_f32 v215, 1.0, v215
    v_rcp_f32 v212, v212
    v_rcp_f32 v213, v213
    v_rcp_f32 v214, v214
    v_rcp_f32 v215, v215
    v_cvt_pk_bf16_f32 v220, v32, v33
    v_cvt_pk_bf16_f32 v221, v34, v35
    v_mul_f32 v36, v36, v212
    v_mul_f32 v37, v37, v213
    v_mul_f32 v38, v38, v214
    v_mul_f32 v39, v39, v215
    v_cvt_pk_bf16_f32 v178, v36, v37
    v_cvt_pk_bf16_f32 v179, v38, v39
    v_mul_f32 v40, v40, v212
    v_mul_f32 v41, v41, v213
    v_mul_f32 v42, v42, v214
    v_mul_f32 v43, v43, v215
    v_cvt_pk_bf16_f32 v180, v40, v41
    v_cvt_pk_bf16_f32 v181, v42, v43
    ds_write_b64 v255, v[220:221] offset:0
    ds_write_b64 v246, v[178:179] offset:256
    ds_write_b64 v255, v[180:181] offset:512
    s_waitcnt lgkmcnt(0)
    s_barrier
    ds_read_b128 v[200:203], v249
    s_branch K2_LASTROW
K2_SPILL:
    buffer_store_dwordx4 v[0:3], v227, s[8:11], s60 offen offset:0
    buffer_store_dwordx4 v[4:7], v227, s[8:11], s60 offen offset:16
    buffer_store_dwordx4 v[8:11], v227, s[8:11], s60 offen offset:32
    buffer_store_dwordx4 v[12:15], v227, s[8:11], s60 offen offset:48
    buffer_store_dwordx4 v[16:19], v227, s[8:11], s60 offen offset:64
    buffer_store_dwordx4 v[20:23], v227, s[8:11], s60 offen offset:80
    buffer_store_dwordx4 v[24:27], v227, s[8:11], s60 offen offset:96
    buffer_store_dwordx4 v[28:31], v227, s[8:11], s60 offen offset:112
    buffer_store_dwordx4 v[32:35], v227, s[8:11], s60 offen offset:128
    buffer_store_dwordx4 v[36:39], v227, s[8:11], s60 offen offset:144
    buffer_store_dwordx4 v[40:43], v227, s[8:11], s60 offen offset:160
    s_mov_b32 s28, 0
    s_waitcnt vmcnt(0)
    s_cmp_lt_u32 s24, s25
    s_cbranch_scc1 K2_LOAD
    s_add_u32 s23, s23, 20
    s_branch K2_WINDOW
K2_WINDOW:
    s_mov_b32 s24, 0
    s_mov_b32 s25, 1
K2_LOAD:
    v_mbcnt_lo_u32_b32 v176, -1, 0
    v_mbcnt_hi_u32_b32 v176, -1, v176
    s_lshl_b32 s58, s20, 6
    v_add_u32 v177, s58, v176
    v_lshlrev_b32 v70, 4, v176
    s_mov_b32 s58, 7110656
    buffer_load_dwordx4 v[136:139], v70, s[8:11], s58 offen offset:0 sc1
    buffer_load_dwordx4 v[140:143], v70, s[8:11], s58 offen offset:1024 sc1
    s_mov_b32 s58, 7112704
    buffer_load_dwordx4 v[144:147], v70, s[8:11], s58 offen offset:0 sc1
    buffer_load_dwordx4 v[148:151], v70, s[8:11], s58 offen offset:1024 sc1
    s_mov_b32 s58, 7114752
    buffer_load_dwordx4 v[152:155], v70, s[8:11], s58 offen offset:0 sc1
    buffer_load_dwordx4 v[156:159], v70, s[8:11], s58 offen offset:1024 sc1
    s_mov_b32 s58, 7116800
    buffer_load_dwordx4 v[160:163], v70, s[8:11], s58 offen offset:0 sc1
    buffer_load_dwordx4 v[164:167], v70, s[8:11], s58 offen offset:1024 sc1
    s_mov_b32 s58, 7118848
    buffer_load_dwordx4 v[168:171], v70, s[8:11], s58 offen offset:0 sc1
    buffer_load_dwordx4 v[172:175], v70, s[8:11], s58 offen offset:1024 sc1
    s_mul_i32 s58, s20, 10400
    s_add_u32 s58, s58, 65536
    s_add_u32 s59, s58, 512
    v_and_b32 v76, 31, v176
    v_lshrrev_b32 v77, 5, v176
    v_cmp_le_u32 vcc, 24, v76
    v_mul_u32_u24 v77, 2080, v77
    v_lshl_add_u32 v78, v76, 4, v77
    v_cndmask_b32 v80, 0, -1, vcc
    v_add_u32 v78, s58, v78
    v_mov_b32 v81, v80
    v_mov_b32 v82, v80
    v_mov_b32 v83, v80
    v_add_u32 v85, 16, v176
    v_lshlrev_b32 v84, 5, v176
    v_lshrrev_b32 v85, 6, v85
    v_mul_u32_u24 v85, 1532, v85
    v_sub_u32 v84, v84, v85
    v_mov_b32 v85, -1
    v_add_u32 v84, s59, v84
    ds_write_b32 v84, v85 offset:0
    ds_write_b32 v84, v85 offset:2080
    ds_write_b32 v84, v85 offset:4160
    ds_write_b32 v84, v85 offset:6240
    ds_write_b32 v84, v85 offset:8320
    s_mov_b32 exec_hi, 0
    ds_write_b128 v78, v[80:83] offset:0
    ds_write_b128 v78, v[80:83] offset:2080
    ds_write_b128 v78, v[80:83] offset:4160
    ds_write_b128 v78, v[80:83] offset:6240
    ds_write_b128 v78, v[80:83] offset:8320
    s_mov_b32 exec_hi, -1
    s_cmp_lg_u32 s20, 7
    s_cbranch_scc1 K2_NOH
    v_mov_b32 v76, 0
    v_mov_b32 v77, -1
    v_lshlrev_b32 v78, 2, v176
    v_add_u32 v78, 163072, v78
    s_mov_b64 exec, 0x1ff
    ds_write_b32 v78, v76 offset:192
    s_mov_b64 exec, 0xff
    ds_write_b32 v78, v77 offset:256
    s_mov_b64 exec, -1
    s_cmp_lg_u32 s24, 0
    s_cbranch_scc1 K2_NOH
    s_mov_b32 exec_hi, 0xffff
    ds_write_b32 v78, v76
    s_mov_b64 exec, 1
    ds_write_b32 v78, v76 offset:228
    s_mov_b64 exec, -1
K2_NOH:
    s_waitcnt lgkmcnt(0)
    s_barrier
    s_branch K2_CELLS
K2_LD_GEN:
    s_mov_b64 exec, s[42:43]
    s_cbranch_execz K2_LD_DONE
    buffer_load_dwordx4 v[4:7], v182, s[8:11], 0 offen sc1
    s_mov_b64 exec, s[44:45]
    s_cbranch_execz K2_LD_DONE
    buffer_load_dwordx4 v[8:11], v183, s[8:11], 0 offen sc1
    s_mov_b64 exec, s[46:47]
    s_cbranch_execz K2_LD_DONE
    buffer_load_dwordx4 v[12:15], v184, s[8:11], 0 offen sc1
    s_mov_b64 exec, s[48:49]
    s_cbranch_execz K2_LD_DONE
    buffer_load_dwordx4 v[16:19], v181, s[8:11], 0 offen offset:128 sc1
    s_mov_b64 exec, s[50:51]
    s_cbranch_execz K2_LD_DONE
    buffer_load_dwordx4 v[20:23], v181, s[8:11], 0 offen offset:160 sc1
    s_mov_b64 exec, s[90:91]
    s_cbranch_execz K2_LD_DONE
    buffer_load_dwordx4 v[24:27], v181, s[8:11], 0 offen offset:192 sc1
    s_mov_b64 exec, s[92:93]
    s_cbranch_execz K2_LD_DONE
    buffer_load_dwordx4 v[28:31], v181, s[8:11], 0 offen offset:224 sc1
    s_mov_b64 exec, s[94:95]
    s_cbranch_execz K2_LD_DONE
    buffer_load_dwordx4 v[32:35], v181, s[8:11], 0 offen offset:256 sc1
    s_mov_b64 exec, s[96:97]
    s_cbranch_execz K2_LD_DONE
    buffer_load_dwordx4 v[36:39], v181, s[8:11], 0 offen offset:288 sc1
    s_branch K2_LD_DONE
K2_WLATE:
    s_waitcnt vmcnt(0)
    s_branch K2_WUNP
K2_RT0:
    s_sub_u32 s60, s60, 1
    s_cbranch_scc1 K2_END
    buffer_load_dwordx4 v[0:3], v181, s[8:11], 0 offen offset:0 sc1
    s_waitcnt vmcnt(0)
    s_branch K2_CK0
K2_RT1:
    s_sub_u32 s60, s60, 1
    s_cbranch_scc1 K2_END
    buffer_load_dwordx4 v[4:7], v182, s[8:11], 0 offen sc1
    s_waitcnt vmcnt(0)
    s_branch K2_CK1
K2_RT2:
    s_sub_u32 s60, s60, 1
    s_cbranch_scc1 K2_END
    buffer_load_dwordx4 v[8:11], v183, s[8:11], 0 offen sc1
    s_waitcnt vmcnt(0)
    s_branch K2_CK2
K2_RT3:
    s_sub_u32 s60, s60, 1
    s_cbranch_scc1 K2_END
    buffer_load_dwordx4 v[12:15], v184, s[8:11], 0 offen sc1
    s_waitcnt vmcnt(0)
    s_branch K2_CK3
K2_RT4:
    s_sub_u32 s60, s60, 1
    s_cbranch_scc1 K2_END
    buffer_load_dwordx4 v[16:19], v181, s[8:11], 0 offen offset:128 sc1
    s_waitcnt vmcnt(0)
    s_branch K2_CK4
K2_RT5:
    s_sub_u32 s60, s60, 1
    s_cbranch_scc1 K2_END
    buffer_load_dwordx4 v[20:23], v181, s[8:11], 0 offen offset:160 sc1
    s_waitcnt vmcnt(0)
    s_branch K2_CK5
K2_RT6:
    s_sub_u32 s60, s60, 1
    s_cbranch_scc1 K2_END
    buffer_load_dwordx4 v[24:27], v181, s[8:11], 0 offen offset:192 sc1
    s_waitcnt vmcnt(0)
    s_branch K2_CK6
K2_RT7:
    s_sub_u32 s60, s60, 1
    s_cbranch_scc1 K2_END
    buffer_load_dwordx4 v[28:31], v181, s[8:11], 0 offen offset:224 sc1
    s_waitcnt vmcnt(0)
    s_branch K2_CK7
K2_RT8:
    s_sub_u32 s60, s60, 1
    s_cbranch_scc1 K2_END
    buffer_load_dwordx4 v[32:35], v181, s[8:11], 0 offen offset:256 sc1
    s_waitcnt vmcnt(0)
    s_branch K2_CK8
K2_RT9:
    s_sub_u32 s60, s60, 1
    s_cbranch_scc1 K2_END
    buffer_load_dwordx4 v[36:39], v181, s[8:11], 0 offen offset:288 sc1
    s_waitcnt vmcnt(0)
    s_branch K2_CK9
K2_RK_LOAD:
    s_waitcnt vmcnt(0)
    s_mov_b64 exec, s[40:41]
    s_cbranch_execz K2_RK_B
    v_lshrrev_b32 v50, 24, v3
    buffer_load_dword v40, v179, s[8:11], s66 offen offset:0
    v_mad_u32_u24 v50, v50, s58, v202
    v_and_b32 v3, 0xffffff, v3
    s_mov_b64 exec, s[42:43]
    s_cbranch_execz K2_RK_B
    v_lshrrev_b32 v51, 24, v7
    buffer_load_dword v41, v185, s[8:11], s66 offen
    v_mad_u32_u24 v51, v51, s58, v202
    v_and_b32 v7, 0xffffff, v7
    s_mov_b64 exec, s[44:45]
    s_cbranch_execz K2_RK_B
    v_lshrrev_b32 v52, 24, v11
    buffer_load_dword v42, v186, s[8:11], s66 offen
    v_mad_u32_u24 v52, v52, s58, v202
    v_and_b32 v11, 0xffffff, v11
    s_mov_b64 exec, s[46:47]
    s_cbranch_execz K2_RK_B
    v_lshrrev_b32 v53, 24, v15
    buffer_load_dword v43, v187, s[8:11], s66 offen
    v_mad_u32_u24 v53, v53, s58, v202
    v_and_b32 v15, 0xffffff, v15
    s_mov_b64 exec, s[48:49]
    s_cbranch_execz K2_RK_B
    v_lshrrev_b32 v54, 24, v19
    buffer_load_dword v44, v179, s[8:11], s66 offen offset:32
    v_mad_u32_u24 v54, v54, s58, v202
    v_and_b32 v19, 0xffffff, v19
    s_mov_b64 exec, s[50:51]
    s_cbranch_execz K2_RK_B
    v_lshrrev_b32 v55, 24, v23
    buffer_load_dword v45, v179, s[8:11], s66 offen offset:40
    v_mad_u32_u24 v55, v55, s58, v202
    v_and_b32 v23, 0xffffff, v23
    s_mov_b64 exec, s[90:91]
    s_cbranch_execz K2_RK_B
    v_lshrrev_b32 v56, 24, v27
    buffer_load_dword v46, v179, s[8:11], s66 offen offset:48
    v_mad_u32_u24 v56, v56, s58, v202
    v_and_b32 v27, 0xffffff, v27
    s_mov_b64 exec, s[92:93]
    s_cbranch_execz K2_RK_B
    v_lshrrev_b32 v57, 24, v31
    buffer_load_dword v47, v179, s[8:11], s66 offen offset:56
    v_mad_u32_u24 v57, v57, s58, v202
    v_and_b32 v31, 0xffffff, v31
    s_mov_b64 exec, s[94:95]
    s_cbranch_execz K2_RK_B
    v_lshrrev_b32 v58, 24, v35
    buffer_load_dword v48, v179, s[8:11], s66 offen offset:64
    v_mad_u32_u24 v58, v58, s58, v202
    v_and_b32 v35, 0xffffff, v35
    s_mov_b64 exec, s[96:97]
    s_cbranch_execz K2_RK_B
    v_lshrrev_b32 v59, 24, v39
    buffer_load_dword v49, v179, s[8:11], s66 offen offset:72
    v_mad_u32_u24 v59, v59, s58, v202
    v_and_b32 v39, 0xffffff, v39
K2_RK_B:
    s_mov_b64 exec, -1
    s_mul_i32 s62, s24, 48
    s_waitcnt vmcnt(0)
    v_subrev_u32 v40, s62, v40
    v_subrev_u32 v41, s62, v41
    v_subrev_u32 v42, s62, v42
    v_subrev_u32 v43, s62, v43
    v_subrev_u32 v44, s62, v44
    v_subrev_u32 v45, s62, v45
    v_subrev_u32 v46, s62, v46
    v_subrev_u32 v47, s62, v47
    v_subrev_u32 v48, s62, v48
    v_subrev_u32 v49, s62, v49
    s_branch K2_RK_DONE
K2_BIG:
    s_cmp_lg_u32 s24, 0
    s_cbranch_scc1 K2_TOK
    s_movk_i32 s26, 48
    v_mov_b32 v197, v193
    s_nop 1
    v_max_u32_dpp v197, v197, v197 row_shr:1 row_mask:0xf bank_mask:0xf bound_ctrl:0
    s_nop 1
    v_max_u32_dpp v197, v197, v197 row_shr:2 row_mask:0xf bank_mask:0xf bound_ctrl:0
    s_nop 1
    v_max_u32_dpp v197, v197, v197 row_shr:4 row_mask:0xf bank_mask:0xf bound_ctrl:0
    s_nop 1
    v_max_u32_dpp v197, v197, v197 row_shr:8 row_mask:0xf bank_mask:0xf bound_ctrl:0
    s_nop 1
    v_max_u32_dpp v197, v197, v197 row_bcast:15 row_mask:0xa bank_mask:0xf
    s_nop 1
    v_max_u32_dpp v197, v197, v197 row_bcast:31 row_mask:0xc bank_mask:0xf
    s_nop 0
    v_readlane_b32 s25, v197, 63
    s_nop 0
    s_add_u32 s25, s25, 47
    s_mul_i32 s25, s25, 43691
    s_lshr_b32 s25, s25, 21
    s_mov_b64 exec, s[40:41]
    s_cbranch_execz K2_SV_DONE
    buffer_store_dword v40, v179, s[8:11], s66 offen offset:0
    s_mov_b64 exec, s[42:43]
    s_cbranch_execz K2_SV_DONE
    buffer_store_dword v41, v185, s[8:11], s66 offen
    s_mov_b64 exec, s[44:45]
    s_cbranch_execz K2_SV_DONE
    buffer_store_dword v42, v186, s[8:11], s66 offen
    s_mov_b64 exec, s[46:47]
    s_cbranch_execz K2_SV_DONE
    buffer_store_dword v43, v187, s[8:11], s66 offen
    s_mov_b64 exec, s[48:49]
    s_cbranch_execz K2_SV_DONE
    buffer_store_dword v44, v179, s[8:11], s66 offen offset:32
    s_mov_b64 exec, s[50:51]
    s_cbranch_execz K2_SV_DONE
    buffer_store_dword v45, v179, s[8:11], s66 offen offset:40
    s_mov_b64 exec, s[90:91]
    s_cbranch_execz K2_SV_DONE
    buffer_store_dword v46, v179, s[8:11], s66 offen offset:48
    s_mov_b64 exec, s[92:93]
    s_cbranch_execz K2_SV_DONE
    buffer_store_dword v47, v179, s[8:11], s66 offen offset:56
    s_mov_b64 exec, s[94:95]
    s_cbranch_execz K2_SV_DONE
    buffer_store_dword v48, v179, s[8:11], s66 offen offset:64
    s_mov_b64 exec, s[96:97]
    s_cbranch_execz K2_SV_DONE
    buffer_store_dword v49, v179, s[8:11], s66 offen offset:72
K2_SV_DONE:
    s_mov_b64 exec, -1
    s_branch K2_TOK
K2_rare_1:
    s_cmp_eq_u32 s33, 4
    s_cbranch_scc1 K2_four_3
    s_mov_b32 s49, s48
    s_mov_b32 s51, s48
    s_add_u32 s45, s44, 256
    s_add_u32 s46, s44, 512
    s_add_u32 s47, s44, 768
    s_branch K2_back_2
K2_four_3:
    s_add_u32 s50, s48, 64
    s_add_u32 s51, s48, 96
    s_mov_b32 s46, s44
    s_mov_b32 s47, s44
    s_branch K2_back_2
K2_a4_5:
    v_add_u32 v254, s48, v230
    ds_read_b32 v254, v254 offset:4
    s_lshr_b32 s65, s3, 27
    s_mul_i32 s66, s22, 2080
    s_lshl_b32 s65, s65, 9
    s_add_u32 s65, s65, s66
    s_add_u32 s65, s65, 65536
    s_mov_b32 m0, s65
    s_mov_b32 exec_hi, 0
    s_waitcnt lgkmcnt(0)
    v_or_b32 v254, v254, v231
    buffer_load_dwordx4 v254, s[16:19], 0 offen  lds
    s_mov_b32 exec_hi, -1
    s_branch K2_b4_7
K2_rare_14:
    s_cmp_eq_u32 s33, 4
    s_cbranch_scc1 K2_four_16
    s_mov_b32 s49, s48
    s_mov_b32 s51, s48
    s_add_u32 s45, s44, 256
    s_add_u32 s46, s44, 512
    s_add_u32 s47, s44, 768
    s_branch K2_back_15
K2_four_16:
    s_add_u32 s50, s48, 64
    s_add_u32 s51, s48, 96
    s_mov_b32 s46, s44
    s_mov_b32 s47, s44
    s_branch K2_back_15
K2_a4_18:
    v_add_u32 v254, s48, v230
    ds_read_b32 v254, v254 offset:4
    s_lshr_b32 s65, s3, 27
    s_mul_i32 s66, s22, 2080
    s_lshl_b32 s65, s65, 9
    s_add_u32 s65, s65, s66
    s_add_u32 s65, s65, 65536
    s_mov_b32 m0, s65
    s_mov_b32 exec_hi, 0
    s_waitcnt lgkmcnt(0)
    v_or_b32 v254, v254, v231
    buffer_load_dwordx4 v254, s[16:19], 0 offen  lds
    s_mov_b32 exec_hi, -1
    s_branch K2_b4_20
K2_rare_27:
    s_cmp_eq_u32 s33, 4
    s_cbranch_scc1 K2_four_29
    s_mov_b32 s49, s48
    s_mov_b32 s51, s48
    s_add_u32 s45, s44, 256
    s_add_u32 s46, s44, 512
    s_add_u32 s47, s44, 768
    s_branch K2_back_28
K2_four_29:
    s_add_u32 s50, s48, 64
    s_add_u32 s51, s48, 96
    s_mov_b32 s46, s44
    s_mov_b32 s47, s44
    s_branch K2_back_28
K2_a4_31:
    v_add_u32 v254, s48, v230
    ds_read_b32 v254, v254 offset:4
    s_lshr_b32 s65, s3, 27
    s_mul_i32 s66, s22, 2080
    s_lshl_b32 s65, s65, 9
    s_add_u32 s65, s65, s66
    s_add_u32 s65, s65, 65536
    s_mov_b32 m0, s65
    s_mov_b32 exec_hi, 0
    s_waitcnt lgkmcnt(0)
    v_or_b32 v254, v254, v231
    buffer_load_dwordx4 v254, s[16:19], 0 offen  lds
    s_mov_b32 exec_hi, -1
    s_branch K2_b4_33
K2_rare_40:
    s_cmp_eq_u32 s33, 4
    s_cbranch_scc1 K2_four_42
    s_mov_b32 s49, s48
    s_mov_b32 s51, s48
    s_add_u32 s45, s44, 256
    s_add_u32 s46, s44, 512
    s_add_u32 s47, s44, 768
    s_branch K2_back_41
K2_four_42:
    s_add_u32 s50, s48, 64
    s_add_u32 s51, s48, 96
    s_mov_b32 s46, s44
    s_mov_b32 s47, s44
    s_branch K2_back_41
K2_a4_44:
    v_add_u32 v254, s48, v230
    ds_read_b32 v254, v254 offset:4
    s_lshr_b32 s65, s3, 27
    s_mul_i32 s66, s22, 2080
    s_lshl_b32 s65, s65, 9
    s_add_u32 s65, s65, s66
    s_add_u32 s65, s65, 65536
    s_mov_b32 m0, s65
    s_mov_b32 exec_hi, 0
    s_waitcnt lgkmcnt(0)
    v_or_b32 v254, v254, v231
    buffer_load_dwordx4 v254, s[16:19], 0 offen  lds
    s_mov_b32 exec_hi, -1
    s_branch K2_b4_46
K2_rare_51:
    s_cmp_eq_u32 s33, 4
    s_cbranch_scc1 K2_four_53
    s_mov_b32 s49, s48
    s_mov_b32 s51, s48
    s_add_u32 s45, s44, 256
    s_add_u32 s46, s44, 512
    s_add_u32 s47, s44, 768
    s_branch K2_back_52
K2_four_53:
    s_add_u32 s50, s48, 64
    s_add_u32 s51, s48, 96
    s_mov_b32 s46, s44
    s_mov_b32 s47, s44
    s_branch K2_back_52
K2_rare_58:
    s_cmp_eq_u32 s33, 4
    s_cbranch_scc1 K2_four_60
    s_mov_b32 s49, s48
    s_mov_b32 s51, s48
    s_add_u32 s45, s44, 256
    s_add_u32 s46, s44, 512
    s_add_u32 s47, s44, 768
    s_branch K2_back_59
K2_four_60:
    s_add_u32 s50, s48, 64
    s_add_u32 s51, s48, 96
    s_mov_b32 s46, s44
    s_mov_b32 s47, s44
    s_branch K2_back_59
K2_rare_65:
    s_cmp_eq_u32 s33, 4
    s_cbranch_scc1 K2_four_67
    s_mov_b32 s49, s48
    s_mov_b32 s51, s48
    s_add_u32 s45, s44, 256
    s_add_u32 s46, s44, 512
    s_add_u32 s47, s44, 768
    s_branch K2_back_66
K2_four_67:
    s_add_u32 s50, s48, 64
    s_add_u32 s51, s48, 96
    s_mov_b32 s46, s44
    s_mov_b32 s47, s44
    s_branch K2_back_66
K2_U10:
    s_setprio 1
    s_add_u32 s38, s38, 1
    v_mov_b32 v254, s52
    v_mov_b32 v255, s38
    s_lshl_b32 s58, s38, 3
    s_add_u32 s58, s58, s20
    s_mov_b64 exec, 1
    ds_write_b32 v254, v255
    s_mov_b64 exec, -1
    s_cmp_lt_u32 s58, s22
    s_cbranch_scc0 K2_dyn_68
K2_back_69:
    s_waitcnt lgkmcnt(4)
    v_lshlrev_b32 v20, 16, v0
    v_and_b32 v21, 0xffff0000, v0
    v_lshlrev_b32 v22, 16, v1
    v_and_b32 v23, 0xffff0000, v1
    v_lshlrev_b32 v24, 16, v2
    v_and_b32 v25, 0xffff0000, v2
    v_lshlrev_b32 v26, 16, v3
    v_and_b32 v27, 0xffff0000, v3
    v_mul_f32_dpp v36, v16, v20 row_newbcast:8 row_mask:0xf bank_mask:0xf
    v_mul_f32_dpp v37, v16, v21 row_newbcast:9 row_mask:0xf bank_mask:0xf
    v_mul_f32_dpp v38, v16, v22 row_newbcast:10 row_mask:0xf bank_mask:0xf
    v_mul_f32_dpp v39, v16, v23 row_newbcast:11 row_mask:0xf bank_mask:0xf
    v_mul_f32_dpp v40, v16, v24 row_newbcast:12 row_mask:0xf bank_mask:0xf
    v_mul_f32_dpp v41, v16, v25 row_newbcast:13 row_mask:0xf bank_mask:0xf
    v_mul_f32_dpp v42, v16, v26 row_newbcast:14 row_mask:0xf bank_mask:0xf
    v_mul_f32_dpp v43, v16, v27 row_newbcast:15 row_mask:0xf bank_mask:0xf
    v_cvt_pk_bf16_f32 v68, v36, v37
    v_cvt_pk_bf16_f32 v69, v38, v39
    v_cvt_pk_bf16_f32 v70, v40, v41
    v_cvt_pk_bf16_f32 v71, v42, v43
    v_mul_f32_dpp v20, v16, v20 row_newbcast:0 row_mask:0xa bank_mask:0xf
    v_mul_f32_dpp v21, v16, v21 row_newbcast:1 row_mask:0xa bank_mask:0xf
    v_mul_f32_dpp v22, v16, v22 row_newbcast:2 row_mask:0xa bank_mask:0xf
    v_mul_f32_dpp v23, v16, v23 row_newbcast:3 row_mask:0xa bank_mask:0xf
    v_mul_f32_dpp v24, v16, v24 row_newbcast:4 row_mask:0xa bank_mask:0xf
    v_mul_f32_dpp v25, v16, v25 row_newbcast:5 row_mask:0xa bank_mask:0xf
    v_mul_f32_dpp v26, v16, v26 row_newbcast:6 row_mask:0xa bank_mask:0xf
    v_mul_f32_dpp v27, v16, v27 row_newbcast:7 row_mask:0xa bank_mask:0xf
    v_cvt_pk_bf16_f32 v64, v20, v21
    v_cvt_pk_bf16_f32 v65, v22, v23
    v_cvt_pk_bf16_f32 v66, v24, v25
    v_cvt_pk_bf16_f32 v67, v26, v27
    v_readlane_b32 s3, v253, s58
    s_lshl_b32 s44, s34, 7
    s_and_b32 s48, s3, 0x3ffff
    s_bfe_u32 s33, s3, 0x30013
    s_mul_i32 s35, s38, 6
    s_cmp_eq_u32 s34, 0
    s_cselect_b32 s35, s35, s48
    s_mov_b32 s45, s44
    s_add_u32 s47, s44, 256
    s_add_u32 s49, s48, 32
    s_add_u32 s60, s48, 64
    s_cmp_eq_u32 s33, 3
    s_cselect_b32 s46, s44, s47
    s_cselect_b32 s50, s60, s48
    s_cselect_b32 s51, s48, s49
    s_sub_u32 s60, s33, 2
    s_cmp_lt_u32 s60, 2
    s_cbranch_scc0 K2_rare_74
K2_back_75:
    v_add_u32 v233, s48, v230
    ds_read_b32 v232, v233
    ds_read_b32 v233, v233 offset:1024
    v_add_u32 v222, s48, v251
    ds_read_b32 v222, v222
    v_add_u32 v224, s49, v251
    ds_read_b32 v224, v224
    v_add_u32 v226, s50, v251
    ds_read_b32 v226, v226
    v_add_u32 v228, s51, v251
    ds_read_b32 v228, v228
    s_waitcnt lgkmcnt(4)
    v_or_b32 v232, v232, v231
    v_or_b32 v233, v233, v231
    s_cmp_lg_u32 s34, 0
    s_cbranch_scc1 K2_dum_77
    s_cmp_eq_u32 s33, 4
    s_cbranch_scc1 K2_a4_78
K2_b4_80:
    s_add_u32 m0, s48, 512
    s_add_u32 s65, s48, 1536
    buffer_load_dwordx4 v232, s[16:19], 0 offen  lds
    s_mov_b32 m0, s65
    s_mov_b32 exec_hi, 0
    buffer_load_dwordx4 v233, s[16:19], 0 offen  lds
    s_mov_b32 exec_hi, -1
K2_back_79:
    s_waitcnt lgkmcnt(3)
    v_mad_u32_u16 v223, v222, s39, v248 op_sel:[1,0,0,0]
    v_mad_u32_u16 v222, v222, s39, v248
    s_waitcnt lgkmcnt(2)
    v_mad_u32_u16 v225, v224, s39, v248 op_sel:[1,0,0,0]
    v_mad_u32_u16 v224, v224, s39, v248
    s_waitcnt lgkmcnt(1)
    v_mad_u32_u16 v227, v226, s39, v248 op_sel:[1,0,0,0]
    v_mad_u32_u16 v226, v226, s39, v248
    s_waitcnt lgkmcnt(0)
    v_mad_u32_u16 v229, v228, s39, v248 op_sel:[1,0,0,0]
    v_mad_u32_u16 v228, v228, s39, v248
    s_waitcnt vmcnt(6)
    v_mfma_f32_32x32x16_bf16 v[0:15], v[64:67], v[176:179], 0
    ds_read_b64_tr_b16 v[184:185], v246 offset:2048
    ds_read_b64_tr_b16 v[186:187], v246 offset:3072
    ds_read_b64_tr_b16 v[188:189], v247 offset:2048
    ds_read_b64_tr_b16 v[190:191], v247 offset:3072
    s_mov_b32 m0, s68
    v_mfma_f32_32x32x16_bf16 v[16:31], v[68:71], v[176:179], 0
    buffer_load_dwordx4 v222, s[4:7], s44 offen sc1 lds
    buffer_load_dwordx4 v223, s[72:75], s44 offen offset:1024 sc1 lds
    v_permlane32_swap_b32 v242, v236
    v_permlane32_swap_b32 v243, v237
    v_mfma_f32_32x32x16_bf16 v[32:47], v[64:67], v[180:183], 0
    v_permlane32_swap_b32 v244, v238
    v_permlane32_swap_b32 v245, v239
    v_permlane32_swap_b32 v240, v241
    v_add_f32 v242, v242, v236
    v_mfma_f32_32x32x16_bf16 v[48:63], v[68:71], v[180:183], 0
    s_setprio 0
    v_add_f32 v243, v243, v237
    v_add_f32 v244, v244, v238
    v_add_f32 v245, v245, v239
    v_add_f32 v240, -v240, -v241
    s_set_gpr_idx_on s32, gpr_idx(DST)
    s_nop 0
    v_cvt_pk_bf16_f32 v195, v242, v243
    v_cvt_pk_bf16_f32 v196, v244, v245
    v_cvt_pk_bf16_f32 v197, v240, v240
    s_set_gpr_idx_off
    v_mul_f32 v234, v0, v96
    v_mul_f32 v236, v8, v128
    v_fmac_f32 v234, v1, v97
    v_fmac_f32 v236, v9, v129
    v_fmac_f32 v234, v2, v98
    v_fmac_f32 v236, v10, v130
    v_fmac_f32 v234, v3, v99
    v_fmac_f32 v236, v11, v131
    v_fmac_f32 v234, v4, v100
    v_fmac_f32 v236, v12, v132
    v_fmac_f32 v234, v5, v101
    v_fmac_f32 v236, v13, v133
    v_fmac_f32 v234, v6, v102
    v_fmac_f32 v236, v14, v134
    v_fmac_f32 v234, v7, v103
    v_fmac_f32 v236, v15, v135
    v_mul_f32 v238, v16, v128
    v_mul_f32 v240, v24, v128
    v_fmac_f32 v238, v17, v129
    v_fmac_f32 v240, v25, v129
    v_fmac_f32 v238, v18, v130
    v_fmac_f32 v240, v26, v130
    v_fmac_f32 v238, v19, v131
    v_fmac_f32 v240, v27, v131
    v_fmac_f32 v238, v20, v132
    v_fmac_f32 v240, v28, v132
    v_fmac_f32 v238, v21, v133
    v_fmac_f32 v240, v29, v133
    v_fmac_f32 v238, v22, v134
    v_fmac_f32 v240, v30, v134
    v_fmac_f32 v238, v23, v135
    v_fmac_f32 v240, v31, v135
    v_mul_f32 v235, v32, v104
    v_mul_f32 v237, v40, v136
    v_fmac_f32 v235, v33, v105
    v_fmac_f32 v237, v41, v137
    v_fmac_f32 v235, v34, v106
    v_fmac_f32 v237, v42, v138
    v_fmac_f32 v235, v35, v107
    v_fmac_f32 v237, v43, v139
    v_fmac_f32 v235, v36, v108
    v_fmac_f32 v237, v44, v140
    v_fmac_f32 v235, v37, v109
    v_fmac_f32 v237, v45, v141
    v_fmac_f32 v235, v38, v110
    v_fmac_f32 v237, v46, v142
    v_fmac_f32 v235, v39, v111
    v_fmac_f32 v237, v47, v143
    v_mul_f32 v239, v48, v136
    v_mul_f32 v241, v56, v136
    v_fmac_f32 v239, v49, v137
    v_fmac_f32 v241, v57, v137
    v_fmac_f32 v239, v50, v138
    v_fmac_f32 v241, v58, v138
    v_fmac_f32 v239, v51, v139
    v_fmac_f32 v241, v59, v139
    v_fmac_f32 v239, v52, v140
    v_fmac_f32 v241, v60, v140
    v_fmac_f32 v239, v53, v141
    v_fmac_f32 v241, v61, v141
    v_fmac_f32 v239, v54, v142
    v_fmac_f32 v241, v62, v142
    v_fmac_f32 v239, v55, v143
    v_fmac_f32 v241, v63, v143
    s_setprio 1
    s_waitcnt vmcnt(6) lgkmcnt(0)
    v_mfma_f32_32x32x16_bf16 v[0:15], v[64:67], v[184:187], 0
    ds_read_b64_tr_b16 v[176:177], v246 offset:4096
    ds_read_b64_tr_b16 v[178:179], v246 offset:5120
    ds_read_b64_tr_b16 v[180:181], v247 offset:4096
    ds_read_b64_tr_b16 v[182:183], v247 offset:5120
    s_mov_b32 m0, s69
    v_mfma_f32_32x32x16_bf16 v[16:31], v[68:71], v[184:187], 0
    buffer_load_dwordx4 v224, s[4:7], s45 offen sc1 lds
    buffer_load_dwordx4 v225, s[72:75], s45 offen offset:1024 sc1 lds
    v_permlane32_swap_b32 v234, v236
    v_permlane32_swap_b32 v235, v237
    v_mfma_f32_32x32x16_bf16 v[32:47], v[64:67], v[188:191], 0
    v_permlane32_swap_b32 v240, v238
    v_permlane32_swap_b32 v241, v239
    v_add_f32 v234, v234, v236
    v_add_f32 v235, v235, v237
    v_add_f32 v240, v240, v238
    v_mfma_f32_32x32x16_bf16 v[48:63], v[68:71], v[188:191], 0
    s_setprio 0
    v_add_f32 v241, v241, v239
    s_set_gpr_idx_on s31, gpr_idx(DST)
    s_nop 0
    v_cvt_pk_bf16_f32 v192, v234, v235
    v_cvt_pk_bf16_f32 v193, v240, v241
    s_set_gpr_idx_off
    v_mul_f32 v234, v0, v144
    v_mul_f32 v236, v8, v112
    v_fmac_f32 v234, v1, v145
    v_fmac_f32 v236, v9, v113
    v_fmac_f32 v234, v2, v146
    v_fmac_f32 v236, v10, v114
    v_fmac_f32 v234, v3, v147
    v_fmac_f32 v236, v11, v115
    v_fmac_f32 v234, v4, v148
    v_fmac_f32 v236, v12, v116
    v_fmac_f32 v234, v5, v149
    v_fmac_f32 v236, v13, v117
    v_fmac_f32 v234, v6, v150
    v_fmac_f32 v236, v14, v118
    v_fmac_f32 v234, v7, v151
    v_fmac_f32 v236, v15, v119
    v_mul_f32 v238, v16, v160
    v_mul_f32 v240, v24, v160
    v_fmac_f32 v238, v17, v161
    v_fmac_f32 v240, v25, v161
    v_fmac_f32 v238, v18, v162
    v_fmac_f32 v240, v26, v162
    v_fmac_f32 v238, v19, v163
    v_fmac_f32 v240, v27, v163
    v_fmac_f32 v238, v20, v164
    v_fmac_f32 v240, v28, v164
    v_fmac_f32 v238, v21, v165
    v_fmac_f32 v240, v29, v165
    v_fmac_f32 v238, v22, v166
    v_fmac_f32 v240, v30, v166
    v_fmac_f32 v238, v23, v167
    v_fmac_f32 v240, v31, v167
    v_mul_f32 v235, v32, v152
    v_mul_f32 v237, v40, v120
    v_fmac_f32 v235, v33, v153
    v_fmac_f32 v237, v41, v121
    v_fmac_f32 v235, v34, v154
    v_fmac_f32 v237, v42, v122
    v_fmac_f32 v235, v35, v155
    v_fmac_f32 v237, v43, v123
    v_fmac_f32 v235, v36, v156
    v_fmac_f32 v237, v44, v124
    v_fmac_f32 v235, v37, v157
    v_fmac_f32 v237, v45, v125
    v_fmac_f32 v235, v38, v158
    v_fmac_f32 v237, v46, v126
    v_fmac_f32 v235, v39, v159
    v_fmac_f32 v237, v47, v127
    v_mul_f32 v239, v48, v168
    v_mul_f32 v241, v56, v168
    v_fmac_f32 v239, v49, v169
    v_fmac_f32 v241, v57, v169
    v_fmac_f32 v239, v50, v170
    v_fmac_f32 v241, v58, v170
    v_fmac_f32 v239, v51, v171
    v_fmac_f32 v241, v59, v171
    v_fmac_f32 v239, v52, v172
    v_fmac_f32 v241, v60, v172
    v_fmac_f32 v239, v53, v173
    v_fmac_f32 v241, v61, v173
    v_fmac_f32 v239, v54, v174
    v_fmac_f32 v241, v62, v174
    v_fmac_f32 v239, v55, v175
    v_fmac_f32 v241, v63, v175
    s_setprio 1
    s_waitcnt vmcnt(6) lgkmcnt(0)
    v_mfma_f32_32x32x16_bf16 v[0:15], v[64:67], v[176:179], 0
    ds_read_b64_tr_b16 v[184:185], v246 offset:6144
    ds_read_b64_tr_b16 v[186:187], v246 offset:7168
    ds_read_b64_tr_b16 v[188:189], v247 offset:6144
    ds_read_b64_tr_b16 v[190:191], v247 offset:7168
    s_mov_b32 m0, s70
    v_mfma_f32_32x32x16_bf16 v[16:31], v[68:71], v[176:179], 0
    buffer_load_dwordx4 v226, s[4:7], s46 offen sc1 lds
    buffer_load_dwordx4 v227, s[72:75], s46 offen offset:1024 sc1 lds
    s_sub_u32 s26, s48, s29
    s_mov_b32 s29, s48
    s_mov_b32 s30, s3
    s_bfe_u32 s56, s3, 0x40012
    v_mfma_f32_32x32x16_bf16 v[32:47], v[64:67], v[180:183], 0
    s_cmp_eq_u32 s34, 0
    s_cselect_b32 s56, s56, 0
    v_mfma_f32_32x32x16_bf16 v[48:63], v[68:71], v[180:183], 0
    s_setprio 0
    v_mul_f32 v242, v0, v144
    v_fma_f32 v238, v8, v160, -v238
    v_fmac_f32 v242, v1, v145
    v_fmac_f32 v238, v9, v161
    v_fmac_f32 v242, v2, v146
    v_fmac_f32 v238, v10, v162
    v_fmac_f32 v242, v3, v147
    v_fmac_f32 v238, v11, v163
    v_fmac_f32 v242, v4, v148
    v_fmac_f32 v238, v12, v164
    v_fmac_f32 v242, v5, v149
    v_fmac_f32 v238, v13, v165
    v_fmac_f32 v242, v6, v150
    v_fmac_f32 v238, v14, v166
    v_fmac_f32 v242, v7, v151
    v_fmac_f32 v238, v15, v167
    v_fmac_f32 v236, v16, v112
    v_mul_f32 v244, v24, v160
    v_fmac_f32 v236, v17, v113
    v_fmac_f32 v244, v25, v161
    v_fmac_f32 v236, v18, v114
    v_fmac_f32 v244, v26, v162
    v_fmac_f32 v236, v19, v115
    v_fmac_f32 v244, v27, v163
    v_fmac_f32 v236, v20, v116
    v_fmac_f32 v244, v28, v164
    v_fmac_f32 v236, v21, v117
    v_fmac_f32 v244, v29, v165
    v_fmac_f32 v236, v22, v118
    v_fmac_f32 v244, v30, v166
    v_fmac_f32 v236, v23, v119
    v_fmac_f32 v244, v31, v167
    v_mul_f32 v243, v32, v152
    v_fma_f32 v239, v40, v168, -v239
    v_fmac_f32 v243, v33, v153
    v_fmac_f32 v239, v41, v169
    v_fmac_f32 v243, v34, v154
    v_fmac_f32 v239, v42, v170
    v_fmac_f32 v243, v35, v155
    v_fmac_f32 v239, v43, v171
    v_fmac_f32 v243, v36, v156
    v_fmac_f32 v239, v44, v172
    v_fmac_f32 v243, v37, v157
    v_fmac_f32 v239, v45, v173
    v_fmac_f32 v243, v38, v158
    v_fmac_f32 v239, v46, v174
    v_fmac_f32 v243, v39, v159
    v_fmac_f32 v239, v47, v175
    v_fmac_f32 v237, v48, v120
    v_mul_f32 v245, v56, v168
    v_fmac_f32 v237, v49, v121
    v_fmac_f32 v245, v57, v169
    v_fmac_f32 v237, v50, v122
    v_fmac_f32 v245, v58, v170
    v_fmac_f32 v237, v51, v123
    v_fmac_f32 v245, v59, v171
    v_fmac_f32 v237, v52, v124
    v_fmac_f32 v245, v60, v172
    v_fmac_f32 v237, v53, v125
    v_fmac_f32 v245, v61, v173
    v_fmac_f32 v237, v54, v126
    v_fmac_f32 v245, v62, v174
    v_fmac_f32 v237, v55, v127
    v_fmac_f32 v245, v63, v175
    s_setprio 1
    s_waitcnt vmcnt(4) lgkmcnt(0)
    v_mfma_f32_32x32x16_bf16 v[0:15], v[64:67], v[184:187], 0
    ds_read_b64_tr_b16 v[176:177], v246 offset:0
    ds_read_b64_tr_b16 v[178:179], v246 offset:1024
    ds_read_b64_tr_b16 v[180:181], v247 offset:0
    ds_read_b64_tr_b16 v[182:183], v247 offset:1024
    s_mov_b32 m0, s71
    v_mfma_f32_32x32x16_bf16 v[16:31], v[68:71], v[184:187], 0
    buffer_load_dwordx4 v228, s[4:7], s47 offen sc1 lds
    buffer_load_dwordx4 v229, s[72:75], s47 offen offset:1024 sc1 lds
    v_permlane32_swap_b32 v242, v234
    v_permlane32_swap_b32 v243, v235
    v_add_f32 v242, v242, v234
    v_mfma_f32_32x32x16_bf16 v[32:47], v[64:67], v[188:191], 0
    v_add_f32 v243, v243, v235
    s_set_gpr_idx_on s31, gpr_idx(DST)
    s_nop 0
    v_cvt_pk_bf16_f32 v194, v242, v243
    s_set_gpr_idx_off
    s_mov_b32 s32, s31
    s_mov_b32 s31, s35
    v_mfma_f32_32x32x16_bf16 v[48:63], v[68:71], v[188:191], 0
    s_setprio 0
    v_mul_f32 v242, v0, v144
    v_fma_f32 v240, v8, v160, -v240
    v_fmac_f32 v242, v1, v145
    v_fmac_f32 v240, v9, v161
    v_fmac_f32 v242, v2, v146
    v_fmac_f32 v240, v10, v162
    v_fmac_f32 v242, v3, v147
    v_fmac_f32 v240, v11, v163
    v_fmac_f32 v242, v4, v148
    v_fmac_f32 v240, v12, v164
    v_fmac_f32 v242, v5, v149
    v_fmac_f32 v240, v13, v165
    v_fmac_f32 v242, v6, v150
    v_fmac_f32 v240, v14, v166
    v_fmac_f32 v242, v7, v151
    v_fmac_f32 v240, v15, v167
    v_add_u32 v249, s26, v249
    v_add_u32 v250, s26, v250
    v_fma_f32 v244, v16, v160, -v244
    v_fmac_f32 v236, v24, v112
    v_fmac_f32 v244, v17, v161
    v_fmac_f32 v236, v25, v113
    v_fmac_f32 v244, v18, v162
    v_fmac_f32 v236, v26, v114
    v_fmac_f32 v244, v19, v163
    v_fmac_f32 v236, v27, v115
    v_fmac_f32 v244, v20, v164
    v_fmac_f32 v236, v28, v116
    v_fmac_f32 v244, v21, v165
    v_fmac_f32 v236, v29, v117
    v_fmac_f32 v244, v22, v166
    v_fmac_f32 v236, v30, v118
    v_fmac_f32 v244, v23, v167
    v_fmac_f32 v236, v31, v119
    ds_read_b64_tr_b16 v[0:1], v249 offset:0
    ds_read_b64_tr_b16 v[2:3], v249 offset:32
    ds_read_u16_d16_hi v16, v250 offset:0
    v_mul_f32 v243, v32, v152
    v_fma_f32 v241, v40, v168, -v241
    v_fmac_f32 v243, v33, v153
    v_fmac_f32 v241, v41, v169
    v_fmac_f32 v243, v34, v154
    v_fmac_f32 v241, v42, v170
    v_fmac_f32 v243, v35, v155
    v_fmac_f32 v241, v43, v171
    v_fmac_f32 v243, v36, v156
    v_fmac_f32 v241, v44, v172
    v_fmac_f32 v243, v37, v157
    v_fmac_f32 v241, v45, v173
    v_fmac_f32 v243, v38, v158
    v_fmac_f32 v241, v46, v174
    v_fmac_f32 v243, v39, v159
    v_fmac_f32 v241, v47, v175
    ds_read_b64_tr_b16 v[4:5], v249 offset:512
    ds_read_b64_tr_b16 v[6:7], v249 offset:544
    ds_read_u16_d16_hi v17, v250 offset:32
    v_fma_f32 v245, v48, v168, -v245
    v_fmac_f32 v237, v56, v120
    v_fmac_f32 v245, v49, v169
    v_fmac_f32 v237, v57, v121
    v_fmac_f32 v245, v50, v170
    v_fmac_f32 v237, v58, v122
    v_fmac_f32 v245, v51, v171
    v_fmac_f32 v237, v59, v123
    v_fmac_f32 v245, v52, v172
    v_fmac_f32 v237, v60, v124
    v_fmac_f32 v245, v53, v173
    v_fmac_f32 v237, v61, v125
    v_fmac_f32 v245, v54, v174
    v_fmac_f32 v237, v62, v126
    v_fmac_f32 v245, v55, v175
    v_fmac_f32 v237, v63, v127
    s_cmp_eq_u32 s56, 5
    s_cbranch_scc1 K2_U20
    s_cmp_eq_u32 s56, 6
    s_cbranch_scc1 K2_U3h0
    s_branch K2_DSP0
K2_U40:
    s_setprio 1
    ds_read_b64_tr_b16 v[8:9], v249 offset:1024
    ds_read_b64_tr_b16 v[10:11], v249 offset:1056
    ds_read_u16_d16_hi v18, v250 offset:64
    s_lshr_b32 s65, s30, 27
    s_mul_i32 s66, s22, 2080
    s_lshl_b32 s65, s65, 9
    s_add_u32 s65, s65, s66
    s_add_u32 s65, s65, 65536
    s_sub_u32 s65, s65, s29
    s_sub_u32 s65, s65, 512
    v_add_u32 v56, s65, v249
    ds_read_b64_tr_b16 v[12:13], v56 offset:0
    ds_read_b64_tr_b16 v[14:15], v56 offset:32
    ds_read_u16_d16_hi v19, v250 offset:96
    s_waitcnt lgkmcnt(6)
    v_lshlrev_b32 v20, 16, v0
    v_and_b32 v21, 0xffff0000, v0
    v_lshlrev_b32 v22, 16, v1
    v_and_b32 v23, 0xffff0000, v1
    v_lshlrev_b32 v24, 16, v2
    v_and_b32 v25, 0xffff0000, v2
    v_lshlrev_b32 v26, 16, v3
    v_and_b32 v27, 0xffff0000, v3
    v_mul_f32_dpp v36, v16, v20 row_newbcast:8 row_mask:0xf bank_mask:0xf
    v_mul_f32_dpp v37, v16, v21 row_newbcast:9 row_mask:0xf bank_mask:0xf
    v_mul_f32_dpp v38, v16, v22 row_newbcast:10 row_mask:0xf bank_mask:0xf
    v_mul_f32_dpp v39, v16, v23 row_newbcast:11 row_mask:0xf bank_mask:0xf
    v_mul_f32_dpp v40, v16, v24 row_newbcast:12 row_mask:0xf bank_mask:0xf
    v_mul_f32_dpp v41, v16, v25 row_newbcast:13 row_mask:0xf bank_mask:0xf
    v_mul_f32_dpp v42, v16, v26 row_newbcast:14 row_mask:0xf bank_mask:0xf
    v_mul_f32_dpp v43, v16, v27 row_newbcast:15 row_mask:0xf bank_mask:0xf
    v_cvt_pk_bf16_f32 v68, v36, v37
    v_cvt_pk_bf16_f32 v69, v38, v39
    v_cvt_pk_bf16_f32 v70, v40, v41
    v_cvt_pk_bf16_f32 v71, v42, v43
    v_mul_f32_dpp v20, v16, v20 row_newbcast:0 row_mask:0xa bank_mask:0xf
    v_mul_f32_dpp v21, v16, v21 row_newbcast:1 row_mask:0xa bank_mask:0xf
    v_mul_f32_dpp v22, v16, v22 row_newbcast:2 row_mask:0xa bank_mask:0xf
    v_mul_f32_dpp v23, v16, v23 row_newbcast:3 row_mask:0xa bank_mask:0xf
    v_mul_f32_dpp v24, v16, v24 row_newbcast:4 row_mask:0xa bank_mask:0xf
    v_mul_f32_dpp v25, v16, v25 row_newbcast:5 row_mask:0xa bank_mask:0xf
    v_mul_f32_dpp v26, v16, v26 row_newbcast:6 row_mask:0xa bank_mask:0xf
    v_mul_f32_dpp v27, v16, v27 row_newbcast:7 row_mask:0xa bank_mask:0xf
    v_cvt_pk_bf16_f32 v64, v20, v21
    v_cvt_pk_bf16_f32 v65, v22, v23
    v_cvt_pk_bf16_f32 v66, v24, v25
    v_cvt_pk_bf16_f32 v67, v26, v27
    v_lshlrev_b32 v28, 16, v4
    v_and_b32 v29, 0xffff0000, v4
    v_lshlrev_b32 v30, 16, v5
    v_and_b32 v31, 0xffff0000, v5
    v_lshlrev_b32 v32, 16, v6
    v_and_b32 v33, 0xffff0000, v6
    v_lshlrev_b32 v34, 16, v7
    v_and_b32 v35, 0xffff0000, v7
    v_mul_f32_dpp v36, v17, v28 row_newbcast:8 row_mask:0xf bank_mask:0xf
    v_mul_f32_dpp v37, v17, v29 row_newbcast:9 row_mask:0xf bank_mask:0xf
    v_mul_f32_dpp v38, v17, v30 row_newbcast:10 row_mask:0xf bank_mask:0xf
    v_mul_f32_dpp v39, v17, v31 row_newbcast:11 row_mask:0xf bank_mask:0xf
    v_mul_f32_dpp v40, v17, v32 row_newbcast:12 row_mask:0xf bank_mask:0xf
    v_mul_f32_dpp v41, v17, v33 row_newbcast:13 row_mask:0xf bank_mask:0xf
    v_mul_f32_dpp v42, v17, v34 row_newbcast:14 row_mask:0xf bank_mask:0xf
    v_mul_f32_dpp v43, v17, v35 row_newbcast:15 row_mask:0xf bank_mask:0xf
    v_cvt_pk_bf16_f32 v76, v36, v37
    v_cvt_pk_bf16_f32 v77, v38, v39
    v_cvt_pk_bf16_f32 v78, v40, v41
    v_cvt_pk_bf16_f32 v79, v42, v43
    v_mul_f32_dpp v28, v17, v28 row_newbcast:0 row_mask:0xa bank_mask:0xf
    v_mul_f32_dpp v29, v17, v29 row_newbcast:1 row_mask:0xa bank_mask:0xf
    v_mul_f32_dpp v30, v17, v30 row_newbcast:2 row_mask:0xa bank_mask:0xf
    v_mul_f32_dpp v31, v17, v31 row_newbcast:3 row_mask:0xa bank_mask:0xf
    v_mul_f32_dpp v32, v17, v32 row_newbcast:4 row_mask:0xa bank_mask:0xf
    v_mul_f32_dpp v33, v17, v33 row_newbcast:5 row_mask:0xa bank_mask:0xf
    v_mul_f32_dpp v34, v17, v34 row_newbcast:6 row_mask:0xa bank_mask:0xf
    v_mul_f32_dpp v35, v17, v35 row_newbcast:7 row_mask:0xa bank_mask:0xf
    v_cvt_pk_bf16_f32 v72, v28, v29
    v_cvt_pk_bf16_f32 v73, v30, v31
    v_cvt_pk_bf16_f32 v74, v32, v33
    v_cvt_pk_bf16_f32 v75, v34, v35
    s_waitcnt lgkmcnt(3)
    v_lshlrev_b32 v20, 16, v8
    v_and_b32 v21, 0xffff0000, v8
    v_lshlrev_b32 v22, 16, v9
    v_and_b32 v23, 0xffff0000, v9
    v_lshlrev_b32 v24, 16, v10
    v_and_b32 v25, 0xffff0000, v10
    v_lshlrev_b32 v26, 16, v11
    v_and_b32 v27, 0xffff0000, v11
    v_mul_f32_dpp v36, v18, v20 row_newbcast:8 row_mask:0xf bank_mask:0xf
    v_mul_f32_dpp v37, v18, v21 row_newbcast:9 row_mask:0xf bank_mask:0xf
    v_mul_f32_dpp v38, v18, v22 row_newbcast:10 row_mask:0xf bank_mask:0xf
    v_mul_f32_dpp v39, v18, v23 row_newbcast:11 row_mask:0xf bank_mask:0xf
    v_mul_f32_dpp v40, v18, v24 row_newbcast:12 row_mask:0xf bank_mask:0xf
    v_mul_f32_dpp v41, v18, v25 row_newbcast:13 row_mask:0xf bank_mask:0xf
    v_mul_f32_dpp v42, v18, v26 row_newbcast:14 row_mask:0xf bank_mask:0xf
    v_mul_f32_dpp v43, v18, v27 row_newbcast:15 row_mask:0xf bank_mask:0xf
    v_cvt_pk_bf16_f32 v84, v36, v37
    v_cvt_pk_bf16_f32 v85, v38, v39
    v_cvt_pk_bf16_f32 v86, v40, v41
    v_cvt_pk_bf16_f32 v87, v42, v43
    v_mul_f32_dpp v20, v18, v20 row_newbcast:0 row_mask:0xa bank_mask:0xf
    v_mul_f32_dpp v21, v18, v21 row_newbcast:1 row_mask:0xa bank_mask:0xf
    v_mul_f32_dpp v22, v18, v22 row_newbcast:2 row_mask:0xa bank_mask:0xf
    v_mul_f32_dpp v23, v18, v23 row_newbcast:3 row_mask:0xa bank_mask:0xf
    v_mul_f32_dpp v24, v18, v24 row_newbcast:4 row_mask:0xa bank_mask:0xf
    v_mul_f32_dpp v25, v18, v25 row_newbcast:5 row_mask:0xa bank_mask:0xf
    v_mul_f32_dpp v26, v18, v26 row_newbcast:6 row_mask:0xa bank_mask:0xf
    v_mul_f32_dpp v27, v18, v27 row_newbcast:7 row_mask:0xa bank_mask:0xf
    v_cvt_pk_bf16_f32 v80, v20, v21
    v_cvt_pk_bf16_f32 v81, v22, v23
    v_cvt_pk_bf16_f32 v82, v24, v25
    v_cvt_pk_bf16_f32 v83, v26, v27
    s_waitcnt lgkmcnt(0)
    v_lshlrev_b32 v28, 16, v12
    v_and_b32 v29, 0xffff0000, v12
    v_lshlrev_b32 v30, 16, v13
    v_and_b32 v31, 0xffff0000, v13
    v_lshlrev_b32 v32, 16, v14
    v_and_b32 v33, 0xffff0000, v14
    v_lshlrev_b32 v34, 16, v15
    v_and_b32 v35, 0xffff0000, v15
    v_mul_f32_dpp v36, v19, v28 row_newbcast:8 row_mask:0xf bank_mask:0xf
    v_mul_f32_dpp v37, v19, v29 row_newbcast:9 row_mask:0xf bank_mask:0xf
    v_mul_f32_dpp v38, v19, v30 row_newbcast:10 row_mask:0xf bank_mask:0xf
    v_mul_f32_dpp v39, v19, v31 row_newbcast:11 row_mask:0xf bank_mask:0xf
    v_mul_f32_dpp v40, v19, v32 row_newbcast:12 row_mask:0xf bank_mask:0xf
    v_mul_f32_dpp v41, v19, v33 row_newbcast:13 row_mask:0xf bank_mask:0xf
    v_mul_f32_dpp v42, v19, v34 row_newbcast:14 row_mask:0xf bank_mask:0xf
    v_mul_f32_dpp v43, v19, v35 row_newbcast:15 row_mask:0xf bank_mask:0xf
    v_cvt_pk_bf16_f32 v92, v36, v37
    v_cvt_pk_bf16_f32 v93, v38, v39
    v_cvt_pk_bf16_f32 v94, v40, v41
    v_cvt_pk_bf16_f32 v95, v42, v43
    v_mul_f32_dpp v28, v19, v28 row_newbcast:0 row_mask:0xa bank_mask:0xf
    v_mul_f32_dpp v29, v19, v29 row_newbcast:1 row_mask:0xa bank_mask:0xf
    v_mul_f32_dpp v30, v19, v30 row_newbcast:2 row_mask:0xa bank_mask:0xf
    v_mul_f32_dpp v31, v19, v31 row_newbcast:3 row_mask:0xa bank_mask:0xf
    v_mul_f32_dpp v32, v19, v32 row_newbcast:4 row_mask:0xa bank_mask:0xf
    v_mul_f32_dpp v33, v19, v33 row_newbcast:5 row_mask:0xa bank_mask:0xf
    v_mul_f32_dpp v34, v19, v34 row_newbcast:6 row_mask:0xa bank_mask:0xf
    v_mul_f32_dpp v35, v19, v35 row_newbcast:7 row_mask:0xa bank_mask:0xf
    v_cvt_pk_bf16_f32 v88, v28, v29
    v_cvt_pk_bf16_f32 v89, v30, v31
    v_cvt_pk_bf16_f32 v90, v32, v33
    v_cvt_pk_bf16_f32 v91, v34, v35
    s_waitcnt vmcnt(4)
    v_mfma_f32_32x32x16_bf16 v[0:15], v[64:67], v[176:179], 0
    ds_read_b64_tr_b16 v[184:185], v246 offset:2048
    ds_read_b64_tr_b16 v[186:187], v246 offset:3072
    ds_read_b64_tr_b16 v[188:189], v247 offset:2048
    ds_read_b64_tr_b16 v[190:191], v247 offset:3072
    s_mov_b32 m0, s68
    v_mfma_f32_32x32x16_bf16 v[16:31], v[68:71], v[176:179], 0
    buffer_load_dwordx4 v222, s[4:7], s41 offen sc1 lds
    buffer_load_dwordx4 v223, s[72:75], s41 offen offset:1024 sc1 lds
    v_permlane32_swap_b32 v242, v236
    v_permlane32_swap_b32 v243, v237
    s_add_u32 s38, s38, 1
    v_mfma_f32_32x32x16_bf16 v[32:47], v[64:67], v[180:183], 0
    v_permlane32_swap_b32 v244, v238
    v_permlane32_swap_b32 v245, v239
    v_permlane32_swap_b32 v240, v241
    v_add_f32 v242, v242, v236
    v_mfma_f32_32x32x16_bf16 v[48:63], v[68:71], v[180:183], 0
    v_add_f32 v243, v243, v237
    v_add_f32 v244, v244, v238
    v_add_f32 v245, v245, v239
    v_add_f32 v240, -v240, -v241
    v_mov_b32 v254, s52
    v_mov_b32 v255, s38
    s_waitcnt vmcnt(4) lgkmcnt(0)
    v_mfma_f32_32x32x16_bf16 v[0:15], v[72:75], v[184:187], v[0:15]
    ds_read_b64_tr_b16 v[176:177], v246 offset:4096
    ds_read_b64_tr_b16 v[178:179], v246 offset:5120
    ds_read_b64_tr_b16 v[180:181], v247 offset:4096
    ds_read_b64_tr_b16 v[182:183], v247 offset:5120
    s_lshl_b32 s58, s38, 3
    s_add_u32 s58, s58, s20
    s_mov_b32 m0, s69
    v_mfma_f32_32x32x16_bf16 v[16:31], v[76:79], v[184:187], v[16:31]
    buffer_load_dwordx4 v224, s[4:7], s41 offen sc1 lds
    buffer_load_dwordx4 v225, s[72:75], s41 offen offset:1024 sc1 lds
    s_set_gpr_idx_on s32, gpr_idx(DST)
    s_nop 0
    v_cvt_pk_bf16_f32 v195, v242, v243
    v_cvt_pk_bf16_f32 v196, v244, v245
    v_cvt_pk_bf16_f32 v197, v240, v240
    s_set_gpr_idx_off
    s_mov_b64 exec, 1
    ds_write_b32 v254, v255
    s_mov_b64 exec, -1
    s_cmp_lt_u32 s58, s22
    s_cbranch_scc0 K2_dyn_81
K2_back_82:
    v_readlane_b32 s3, v253, s58
    s_lshl_b32 s44, s34, 7
    s_and_b32 s48, s3, 0x3ffff
    s_bfe_u32 s33, s3, 0x30013
    s_mul_i32 s35, s38, 6
    s_cmp_eq_u32 s34, 0
    s_cselect_b32 s35, s35, s48
    s_mov_b32 s45, s44
    s_add_u32 s47, s44, 256
    s_add_u32 s49, s48, 32
    s_add_u32 s60, s48, 64
    s_cmp_eq_u32 s33, 3
    s_cselect_b32 s46, s44, s47
    s_cselect_b32 s50, s60, s48
    s_cselect_b32 s51, s48, s49
    s_sub_u32 s60, s33, 2
    s_cmp_lt_u32 s60, 2
    s_cbranch_scc0 K2_rare_87
K2_back_88:
    v_mfma_f32_32x32x16_bf16 v[32:47], v[72:75], v[188:191], v[32:47]
    v_add_u32 v233, s48, v230
    ds_read_b32 v232, v233
    ds_read_b32 v233, v233 offset:1024
    v_mfma_f32_32x32x16_bf16 v[48:63], v[76:79], v[188:191], v[48:63]
    s_waitcnt vmcnt(4) lgkmcnt(3)
    v_mfma_f32_32x32x16_bf16 v[0:15], v[80:83], v[176:179], v[0:15]
    ds_read_b64_tr_b16 v[184:185], v246 offset:6144
    ds_read_b64_tr_b16 v[186:187], v246 offset:7168
    ds_read_b64_tr_b16 v[188:189], v247 offset:6144
    ds_read_b64_tr_b16 v[190:191], v247 offset:7168
    s_mov_b32 m0, s70
    v_mfma_f32_32x32x16_bf16 v[16:31], v[84:87], v[176:179], v[16:31]
    buffer_load_dwordx4 v226, s[4:7], s41 offen sc1 lds
    buffer_load_dwordx4 v227, s[72:75], s41 offen offset:1024 sc1 lds
    v_mfma_f32_32x32x16_bf16 v[32:47], v[80:83], v[180:183], v[32:47]
    v_mfma_f32_32x32x16_bf16 v[48:63], v[84:87], v[180:183], v[48:63]
    s_waitcnt lgkmcnt(4)
    v_or_b32 v232, v232, v231
    v_or_b32 v233, v233, v231
    s_cmp_lg_u32 s34, 0
    s_cbranch_scc1 K2_dum_90
    s_cmp_eq_u32 s33, 4
    s_cbranch_scc1 K2_a4_91
K2_b4_93:
    s_add_u32 m0, s48, 512
    s_add_u32 s65, s48, 1536
    buffer_load_dwordx4 v232, s[16:19], 0 offen  lds
    s_mov_b32 m0, s65
    s_mov_b32 exec_hi, 0
    buffer_load_dwordx4 v233, s[16:19], 0 offen  lds
    s_mov_b32 exec_hi, -1
K2_back_92:
    s_waitcnt vmcnt(6) lgkmcnt(0)
    v_mfma_f32_32x32x16_bf16 v[0:15], v[88:91], v[184:187], v[0:15]
    ds_read_b64_tr_b16 v[176:177], v246 offset:0
    ds_read_b64_tr_b16 v[178:179], v246 offset:1024
    ds_read_b64_tr_b16 v[180:181], v247 offset:0
    ds_read_b64_tr_b16 v[182:183], v247 offset:1024
    s_mov_b32 m0, s71
    v_mfma_f32_32x32x16_bf16 v[16:31], v[92:95], v[184:187], v[16:31]
    buffer_load_dwordx4 v228, s[4:7], s41 offen sc1 lds
    buffer_load_dwordx4 v229, s[72:75], s41 offen offset:1024 sc1 lds
    v_mfma_f32_32x32x16_bf16 v[32:47], v[88:91], v[188:191], v[32:47]
    s_nop 2
    v_mul_f32 v234, v0, v96
    v_mul_f32 v236, v8, v128
    v_fmac_f32 v234, v1, v97
    v_fmac_f32 v236, v9, v129
    v_fmac_f32 v234, v2, v98
    v_fmac_f32 v236, v10, v130
    v_fmac_f32 v234, v3, v99
    v_mfma_f32_32x32x16_bf16 v[48:63], v[92:95], v[188:191], v[48:63]
    s_setprio 0
    v_fmac_f32 v236, v11, v131
    v_fmac_f32 v234, v4, v100
    v_fmac_f32 v236, v12, v132
    v_fmac_f32 v234, v5, v101
    v_fmac_f32 v236, v13, v133
    v_fmac_f32 v234, v6, v102
    v_fmac_f32 v236, v14, v134
    v_fmac_f32 v234, v7, v103
    v_fmac_f32 v236, v15, v135
    v_mul_f32 v238, v16, v128
    v_mul_f32 v240, v24, v128
    v_fmac_f32 v238, v17, v129
    v_fmac_f32 v240, v25, v129
    v_fmac_f32 v238, v18, v130
    v_fmac_f32 v240, v26, v130
    v_fmac_f32 v238, v19, v131
    v_fmac_f32 v240, v27, v131
    v_fmac_f32 v238, v20, v132
    v_fmac_f32 v240, v28, v132
    v_fmac_f32 v238, v21, v133
    v_fmac_f32 v240, v29, v133
    v_fmac_f32 v238, v22, v134
    v_fmac_f32 v240, v30, v134
    v_fmac_f32 v238, v23, v135
    v_fmac_f32 v240, v31, v135
    v_mul_f32 v235, v32, v104
    v_mul_f32 v237, v40, v136
    v_fmac_f32 v235, v33, v105
    v_fmac_f32 v237, v41, v137
    v_fmac_f32 v235, v34, v106
    v_fmac_f32 v237, v42, v138
    v_fmac_f32 v235, v35, v107
    v_fmac_f32 v237, v43, v139
    v_fmac_f32 v235, v36, v108
    v_fmac_f32 v237, v44, v140
    v_fmac_f32 v235, v37, v109
    v_fmac_f32 v237, v45, v141
    v_fmac_f32 v235, v38, v110
    v_fmac_f32 v237, v46, v142
    v_fmac_f32 v235, v39, v111
    v_fmac_f32 v237, v47, v143
    v_mul_f32 v239, v48, v136
    v_mul_f32 v241, v56, v136
    s_setprio 1
    s_waitcnt vmcnt(6) lgkmcnt(0)
    v_mfma_f32_32x32x16_bf16 v[0:15], v[64:67], v[176:179], 0
    ds_read_b64_tr_b16 v[184:185], v246 offset:2048
    ds_read_b64_tr_b16 v[186:187], v246 offset:3072
    ds_read_b64_tr_b16 v[188:189], v247 offset:2048
    ds_read_b64_tr_b16 v[190:191], v247 offset:3072
    v_fmac_f32 v239, v49, v137
    v_fmac_f32 v241, v57, v137
    s_mov_b32 m0, s68
    v_mfma_f32_32x32x16_bf16 v[16:31], v[68:71], v[176:179], 0
    buffer_load_dwordx4 v222, s[4:7], s42 offen sc1 lds
    buffer_load_dwordx4 v223, s[72:75], s42 offen offset:1024 sc1 lds
    v_fmac_f32 v239, v50, v138
    v_fmac_f32 v241, v58, v138
    v_fmac_f32 v239, v51, v139
    v_fmac_f32 v241, v59, v139
    v_fmac_f32 v239, v52, v140
    v_mfma_f32_32x32x16_bf16 v[32:47], v[64:67], v[180:183], 0
    v_fmac_f32 v241, v60, v140
    v_fmac_f32 v239, v53, v141
    v_fmac_f32 v241, v61, v141
    v_fmac_f32 v239, v54, v142
    v_fmac_f32 v241, v62, v142
    v_fmac_f32 v239, v55, v143
    v_fmac_f32 v241, v63, v143
    v_mfma_f32_32x32x16_bf16 v[48:63], v[68:71], v[180:183], 0
    v_permlane32_swap_b32 v234, v236
    v_permlane32_swap_b32 v235, v237
    v_permlane32_swap_b32 v240, v238
    s_waitcnt vmcnt(6) lgkmcnt(0)
    v_mfma_f32_32x32x16_bf16 v[0:15], v[72:75], v[184:187], v[0:15]
    ds_read_b64_tr_b16 v[176:177], v246 offset:4096
    ds_read_b64_tr_b16 v[178:179], v246 offset:5120
    ds_read_b64_tr_b16 v[180:181], v247 offset:4096
    ds_read_b64_tr_b16 v[182:183], v247 offset:5120
    v_permlane32_swap_b32 v241, v239
    s_mov_b32 m0, s69
    v_mfma_f32_32x32x16_bf16 v[16:31], v[76:79], v[184:187], v[16:31]
    buffer_load_dwordx4 v224, s[4:7], s42 offen sc1 lds
    buffer_load_dwordx4 v225, s[72:75], s42 offen offset:1024 sc1 lds
    v_add_f32 v234, v234, v236
    v_add_f32 v235, v235, v237
    v_add_f32 v240, v240, v238
    v_add_f32 v241, v241, v239
    v_mfma_f32_32x32x16_bf16 v[32:47], v[72:75], v[188:191], v[32:47]
    s_set_gpr_idx_on s31, gpr_idx(DST)
    s_nop 0
    v_cvt_pk_bf16_f32 v192, v234, v235
    v_cvt_pk_bf16_f32 v193, v240, v241
    s_set_gpr_idx_off
    v_mfma_f32_32x32x16_bf16 v[48:63], v[76:79], v[188:191], v[48:63]
    s_waitcnt vmcnt(4) lgkmcnt(0)
    v_mfma_f32_32x32x16_bf16 v[0:15], v[80:83], v[176:179], v[0:15]
    ds_read_b64_tr_b16 v[184:185], v246 offset:6144
    ds_read_b64_tr_b16 v[186:187], v246 offset:7168
    ds_read_b64_tr_b16 v[188:189], v247 offset:6144
    ds_read_b64_tr_b16 v[190:191], v247 offset:7168
    s_mov_b32 m0, s70
    v_mfma_f32_32x32x16_bf16 v[16:31], v[84:87], v[176:179], v[16:31]
    buffer_load_dwordx4 v226, s[4:7], s42 offen sc1 lds
    buffer_load_dwordx4 v227, s[72:75], s42 offen offset:1024 sc1 lds
    v_mfma_f32_32x32x16_bf16 v[32:47], v[80:83], v[180:183], v[32:47]
    v_mfma_f32_32x32x16_bf16 v[48:63], v[84:87], v[180:183], v[48:63]
    s_waitcnt vmcnt(4) lgkmcnt(0)
    v_mfma_f32_32x32x16_bf16 v[0:15], v[88:91], v[184:187], v[0:15]
    ds_read_b64_tr_b16 v[176:177], v246 offset:0
    ds_read_b64_tr_b16 v[178:179], v246 offset:1024
    ds_read_b64_tr_b16 v[180:181], v247 offset:0
    ds_read_b64_tr_b16 v[182:183], v247 offset:1024
    s_mov_b32 m0, s71
    v_mfma_f32_32x32x16_bf16 v[16:31], v[92:95], v[184:187], v[16:31]
    buffer_load_dwordx4 v228, s[4:7], s42 offen sc1 lds
    buffer_load_dwordx4 v229, s[72:75], s42 offen offset:1024 sc1 lds
    v_mfma_f32_32x32x16_bf16 v[32:47], v[88:91], v[188:191], v[32:47]
    s_nop 2
    v_mul_f32 v234, v0, v144
    v_mul_f32 v236, v8, v112
    v_fmac_f32 v234, v1, v145
    v_fmac_f32 v236, v9, v113
    v_fmac_f32 v234, v2, v146
    v_fmac_f32 v236, v10, v114
    v_fmac_f32 v234, v3, v147
    v_mfma_f32_32x32x16_bf16 v[48:63], v[92:95], v[188:191], v[48:63]
    s_setprio 0
    v_fmac_f32 v236, v11, v115
    v_fmac_f32 v234, v4, v148
    v_fmac_f32 v236, v12, v116
    v_fmac_f32 v234, v5, v149
    v_fmac_f32 v236, v13, v117
    v_fmac_f32 v234, v6, v150
    v_fmac_f32 v236, v14, v118
    v_fmac_f32 v234, v7, v151
    v_fmac_f32 v236, v15, v119
    v_mul_f32 v238, v16, v160
    v_mul_f32 v240, v24, v160
    v_fmac_f32 v238, v17, v161
    v_fmac_f32 v240, v25, v161
    v_fmac_f32 v238, v18, v162
    v_fmac_f32 v240, v26, v162
    v_fmac_f32 v238, v19, v163
    v_fmac_f32 v240, v27, v163
    v_fmac_f32 v238, v20, v164
    v_fmac_f32 v240, v28, v164
    v_fmac_f32 v238, v21, v165
    v_fmac_f32 v240, v29, v165
    v_fmac_f32 v238, v22, v166
    v_fmac_f32 v240, v30, v166
    v_fmac_f32 v238, v23, v167
    v_fmac_f32 v240, v31, v167
    v_mul_f32 v235, v32, v152
    v_mul_f32 v237, v40, v120
    v_fmac_f32 v235, v33, v153
    v_fmac_f32 v237, v41, v121
    v_fmac_f32 v235, v34, v154
    v_fmac_f32 v237, v42, v122
    v_fmac_f32 v235, v35, v155
    v_fmac_f32 v237, v43, v123
    v_fmac_f32 v235, v36, v156
    v_fmac_f32 v237, v44, v124
    v_fmac_f32 v235, v37, v157
    v_fmac_f32 v237, v45, v125
    v_fmac_f32 v235, v38, v158
    v_fmac_f32 v237, v46, v126
    v_fmac_f32 v235, v39, v159
    v_fmac_f32 v237, v47, v127
    v_mul_f32 v239, v48, v168
    v_mul_f32 v241, v56, v168
    s_setprio 1
    s_waitcnt vmcnt(4) lgkmcnt(0)
    v_mfma_f32_32x32x16_bf16 v[0:15], v[64:67], v[176:179], 0
    ds_read_b64_tr_b16 v[184:185], v246 offset:2048
    ds_read_b64_tr_b16 v[186:187], v246 offset:3072
    ds_read_b64_tr_b16 v[188:189], v247 offset:2048
    ds_read_b64_tr_b16 v[190:191], v247 offset:3072
    v_fmac_f32 v239, v49, v169
    v_fmac_f32 v241, v57, v169
    s_mov_b32 m0, s68
    v_mfma_f32_32x32x16_bf16 v[16:31], v[68:71], v[176:179], 0
    buffer_load_dwordx4 v222, s[4:7], s43 offen sc1 lds
    buffer_load_dwordx4 v223, s[72:75], s43 offen offset:1024 sc1 lds
    v_fmac_f32 v239, v50, v170
    v_fmac_f32 v241, v58, v170
    v_fmac_f32 v239, v51, v171
    v_fmac_f32 v241, v59, v171
    v_fmac_f32 v239, v52, v172
    v_mfma_f32_32x32x16_bf16 v[32:47], v[64:67], v[180:183], 0
    v_fmac_f32 v241, v60, v172
    v_fmac_f32 v239, v53, v173
    v_fmac_f32 v241, v61, v173
    v_fmac_f32 v239, v54, v174
    v_fmac_f32 v241, v62, v174
    v_fmac_f32 v239, v55, v175
    v_fmac_f32 v241, v63, v175
    v_mfma_f32_32x32x16_bf16 v[48:63], v[68:71], v[180:183], 0
    s_waitcnt vmcnt(4) lgkmcnt(0)
    v_mfma_f32_32x32x16_bf16 v[0:15], v[72:75], v[184:187], v[0:15]
    ds_read_b64_tr_b16 v[176:177], v246 offset:4096
    ds_read_b64_tr_b16 v[178:179], v246 offset:5120
    ds_read_b64_tr_b16 v[180:181], v247 offset:4096
    ds_read_b64_tr_b16 v[182:183], v247 offset:5120
    s_mov_b32 m0, s69
    v_mfma_f32_32x32x16_bf16 v[16:31], v[76:79], v[184:187], v[16:31]
    buffer_load_dwordx4 v224, s[4:7], s43 offen sc1 lds
    buffer_load_dwordx4 v225, s[72:75], s43 offen offset:1024 sc1 lds
    v_mfma_f32_32x32x16_bf16 v[32:47], v[72:75], v[188:191], v[32:47]
    v_mfma_f32_32x32x16_bf16 v[48:63], v[76:79], v[188:191], v[48:63]
    s_waitcnt vmcnt(4) lgkmcnt(0)
    v_mfma_f32_32x32x16_bf16 v[0:15], v[80:83], v[176:179], v[0:15]
    ds_read_b64_tr_b16 v[184:185], v246 offset:6144
    ds_read_b64_tr_b16 v[186:187], v246 offset:7168
    ds_read_b64_tr_b16 v[188:189], v247 offset:6144
    ds_read_b64_tr_b16 v[190:191], v247 offset:7168
    s_mov_b32 m0, s70
    v_mfma_f32_32x32x16_bf16 v[16:31], v[84:87], v[176:179], v[16:31]
    buffer_load_dwordx4 v226, s[4:7], s43 offen sc1 lds
    buffer_load_dwordx4 v227, s[72:75], s43 offen offset:1024 sc1 lds
    v_mfma_f32_32x32x16_bf16 v[32:47], v[80:83], v[180:183], v[32:47]
    v_add_u32 v222, s48, v251
    ds_read_b32 v222, v222
    v_mfma_f32_32x32x16_bf16 v[48:63], v[84:87], v[180:183], v[48:63]
    s_waitcnt vmcnt(4) lgkmcnt(1)
    v_mfma_f32_32x32x16_bf16 v[0:15], v[88:91], v[184:187], v[0:15]
    ds_read_b64_tr_b16 v[176:177], v246 offset:0
    ds_read_b64_tr_b16 v[178:179], v246 offset:1024
    ds_read_b64_tr_b16 v[180:181], v247 offset:0
    ds_read_b64_tr_b16 v[182:183], v247 offset:1024
    s_mov_b32 m0, s71
    v_mfma_f32_32x32x16_bf16 v[16:31], v[92:95], v[184:187], v[16:31]
    buffer_load_dwordx4 v228, s[4:7], s43 offen sc1 lds
    buffer_load_dwordx4 v229, s[72:75], s43 offen offset:1024 sc1 lds
    s_waitcnt lgkmcnt(4)
    v_mad_u32_u16 v223, v222, s39, v248 op_sel:[1,0,0,0]
    v_mad_u32_u16 v222, v222, s39, v248
    v_mfma_f32_32x32x16_bf16 v[32:47], v[88:91], v[188:191], v[32:47]
    v_add_u32 v224, s49, v251
    ds_read_b32 v224, v224
    v_mul_f32 v242, v0, v144
    v_fma_f32 v238, v8, v160, -v238
    v_fmac_f32 v242, v1, v145
    v_fmac_f32 v238, v9, v161
    v_fmac_f32 v242, v2, v146
    v_mfma_f32_32x32x16_bf16 v[48:63], v[92:95], v[188:191], v[48:63]
    s_setprio 0
    v_fmac_f32 v238, v10, v162
    v_fmac_f32 v242, v3, v147
    v_fmac_f32 v238, v11, v163
    v_fmac_f32 v242, v4, v148
    v_fmac_f32 v238, v12, v164
    v_fmac_f32 v242, v5, v149
    v_fmac_f32 v238, v13, v165
    v_fmac_f32 v242, v6, v150
    v_fmac_f32 v238, v14, v166
    v_fmac_f32 v242, v7, v151
    v_fmac_f32 v238, v15, v167
    v_fmac_f32 v236, v16, v112
    v_mul_f32 v244, v24, v160
    v_fmac_f32 v236, v17, v113
    v_fmac_f32 v244, v25, v161
    v_fmac_f32 v236, v18, v114
    v_fmac_f32 v244, v26, v162
    v_fmac_f32 v236, v19, v115
    v_fmac_f32 v244, v27, v163
    v_fmac_f32 v236, v20, v116
    v_fmac_f32 v244, v28, v164
    v_fmac_f32 v236, v21, v117
    v_fmac_f32 v244, v29, v165
    v_fmac_f32 v236, v22, v118
    v_fmac_f32 v244, v30, v166
    v_fmac_f32 v236, v23, v119
    v_fmac_f32 v244, v31, v167
    v_mul_f32 v243, v32, v152
    v_fma_f32 v239, v40, v168, -v239
    v_fmac_f32 v243, v33, v153
    v_fmac_f32 v239, v41, v169
    v_fmac_f32 v243, v34, v154
    v_fmac_f32 v239, v42, v170
    v_fmac_f32 v243, v35, v155
    v_fmac_f32 v239, v43, v171
    v_fmac_f32 v243, v36, v156
    v_fmac_f32 v239, v44, v172
    v_fmac_f32 v243, v37, v157
    v_fmac_f32 v239, v45, v173
    v_fmac_f32 v243, v38, v158
    v_fmac_f32 v239, v46, v174
    v_fmac_f32 v243, v39, v159
    v_fmac_f32 v239, v47, v175
    v_fmac_f32 v237, v48, v120
    v_mul_f32 v245, v56, v168
    v_fmac_f32 v237, v49, v121
    v_fmac_f32 v245, v57, v169
    v_fmac_f32 v237, v50, v122
    v_fmac_f32 v245, v58, v170
    v_fmac_f32 v237, v51, v123
    s_setprio 1
    s_waitcnt vmcnt(4) lgkmcnt(1)
    v_mfma_f32_32x32x16_bf16 v[0:15], v[64:67], v[176:179], 0
    ds_read_b64_tr_b16 v[184:185], v246 offset:2048
    ds_read_b64_tr_b16 v[186:187], v246 offset:3072
    ds_read_b64_tr_b16 v[188:189], v247 offset:2048
    ds_read_b64_tr_b16 v[190:191], v247 offset:3072
    v_fmac_f32 v245, v59, v171
    v_fmac_f32 v237, v52, v124
    s_mov_b32 m0, s68
    v_mfma_f32_32x32x16_bf16 v[16:31], v[68:71], v[176:179], 0
    buffer_load_dwordx4 v222, s[4:7], s44 offen sc1 lds
    buffer_load_dwordx4 v223, s[72:75], s44 offen offset:1024 sc1 lds
    s_waitcnt lgkmcnt(4)
    v_mad_u32_u16 v225, v224, s39, v248 op_sel:[1,0,0,0]
    v_mad_u32_u16 v224, v224, s39, v248
    v_fmac_f32 v245, v60, v172
    v_fmac_f32 v237, v53, v125
    v_mfma_f32_32x32x16_bf16 v[32:47], v[64:67], v[180:183], 0
    v_add_u32 v226, s50, v251
    ds_read_b32 v226, v226
    v_fmac_f32 v245, v61, v173
    v_fmac_f32 v237, v54, v126
    v_fmac_f32 v245, v62, v174
    v_fmac_f32 v237, v55, v127
    v_fmac_f32 v245, v63, v175
    v_mfma_f32_32x32x16_bf16 v[48:63], v[68:71], v[180:183], 0
    v_permlane32_swap_b32 v242, v234
    v_permlane32_swap_b32 v243, v235
    v_add_f32 v242, v242, v234
    v_add_f32 v243, v243, v235
    s_waitcnt vmcnt(4) lgkmcnt(1)
    v_mfma_f32_32x32x16_bf16 v[0:15], v[72:75], v[184:187], v[0:15]
    ds_read_b64_tr_b16 v[176:177], v246 offset:4096
    ds_read_b64_tr_b16 v[178:179], v246 offset:5120
    ds_read_b64_tr_b16 v[180:181], v247 offset:4096
    ds_read_b64_tr_b16 v[182:183], v247 offset:5120
    s_mov_b32 m0, s69
    v_mfma_f32_32x32x16_bf16 v[16:31], v[76:79], v[184:187], v[16:31]
    buffer_load_dwordx4 v224, s[4:7], s45 offen sc1 lds
    buffer_load_dwordx4 v225, s[72:75], s45 offen offset:1024 sc1 lds
    s_waitcnt lgkmcnt(4)
    v_mad_u32_u16 v227, v226, s39, v248 op_sel:[1,0,0,0]
    v_mad_u32_u16 v226, v226, s39, v248
    v_mfma_f32_32x32x16_bf16 v[32:47], v[72:75], v[188:191], v[32:47]
    v_add_u32 v228, s51, v251
    ds_read_b32 v228, v228
    s_set_gpr_idx_on s31, gpr_idx(DST)
    s_nop 0
    v_cvt_pk_bf16_f32 v194, v242, v243
    s_set_gpr_idx_off
    v_mfma_f32_32x32x16_bf16 v[48:63], v[76:79], v[188:191], v[48:63]
    s_waitcnt vmcnt(4) lgkmcnt(1)
    v_mfma_f32_32x32x16_bf16 v[0:15], v[80:83], v[176:179], v[0:15]
    ds_read_b64_tr_b16 v[184:185], v246 offset:6144
    ds_read_b64_tr_b16 v[186:187], v246 offset:7168
    ds_read_b64_tr_b16 v[188:189], v247 offset:6144
    ds_read_b64_tr_b16 v[190:191], v247 offset:7168
    s_mov_b32 s32, s31
    s_mov_b32 s31, s35
    s_mov_b32 m0, s70
    v_mfma_f32_32x32x16_bf16 v[16:31], v[84:87], v[176:179], v[16:31]
    buffer_load_dwordx4 v226, s[4:7], s46 offen sc1 lds
    buffer_load_dwordx4 v227, s[72:75], s46 offen offset:1024 sc1 lds
    s_waitcnt lgkmcnt(4)
    v_mad_u32_u16 v229, v228, s39, v248 op_sel:[1,0,0,0]
    v_mad_u32_u16 v228, v228, s39, v248
    s_sub_u32 s26, s48, s29
    s_mov_b32 s29, s48
    v_mfma_f32_32x32x16_bf16 v[32:47], v[80:83], v[180:183], v[32:47]
    s_mov_b32 s30, s3
    s_bfe_u32 s56, s3, 0x40012
    s_cmp_eq_u32 s34, 0
    s_cselect_b32 s56, s56, 0
    v_mfma_f32_32x32x16_bf16 v[48:63], v[84:87], v[180:183], v[48:63]
    s_waitcnt vmcnt(4) lgkmcnt(0)
    v_mfma_f32_32x32x16_bf16 v[0:15], v[88:91], v[184:187], v[0:15]
    ds_read_b64_tr_b16 v[176:177], v246 offset:0
    ds_read_b64_tr_b16 v[178:179], v246 offset:1024
    ds_read_b64_tr_b16 v[180:181], v247 offset:0
    ds_read_b64_tr_b16 v[182:183], v247 offset:1024
    s_mov_b32 m0, s71
    v_mfma_f32_32x32x16_bf16 v[16:31], v[92:95], v[184:187], v[16:31]
    buffer_load_dwordx4 v228, s[4:7], s47 offen sc1 lds
    buffer_load_dwordx4 v229, s[72:75], s47 offen offset:1024 sc1 lds
    v_mfma_f32_32x32x16_bf16 v[32:47], v[88:91], v[188:191], v[32:47]
    s_nop 2
    v_mul_f32 v242, v0, v144
    v_fma_f32 v240, v8, v160, -v240
    v_fmac_f32 v242, v1, v145
    v_fmac_f32 v240, v9, v161
    v_fmac_f32 v242, v2, v146
    v_fmac_f32 v240, v10, v162
    v_fmac_f32 v242, v3, v147
    v_mfma_f32_32x32x16_bf16 v[48:63], v[92:95], v[188:191], v[48:63]
    s_setprio 0
    v_fmac_f32 v240, v11, v163
    v_fmac_f32 v242, v4, v148
    v_fmac_f32 v240, v12, v164
    v_fmac_f32 v242, v5, v149
    v_fmac_f32 v240, v13, v165
    v_fmac_f32 v242, v6, v150
    v_fmac_f32 v240, v14, v166
    v_fmac_f32 v242, v7, v151
    v_fmac_f32 v240, v15, v167
    v_add_u32 v249, s26, v249
    v_add_u32 v250, s26, v250
    v_fma_f32 v244, v16, v160, -v244
    v_fmac_f32 v236, v24, v112
    v_fmac_f32 v244, v17, v161
    v_fmac_f32 v236, v25, v113
    v_fmac_f32 v244, v18, v162
    v_fmac_f32 v236, v26, v114
    v_fmac_f32 v244, v19, v163
    v_fmac_f32 v236, v27, v115
    v_fmac_f32 v244, v20, v164
    v_fmac_f32 v236, v28, v116
    v_fmac_f32 v244, v21, v165
    v_fmac_f32 v236, v29, v117
    v_fmac_f32 v244, v22, v166
    v_fmac_f32 v236, v30, v118
    v_fmac_f32 v244, v23, v167
    v_fmac_f32 v236, v31, v119
    ds_read_b64_tr_b16 v[0:1], v249 offset:0
    ds_read_b64_tr_b16 v[2:3], v249 offset:32
    ds_read_u16_d16_hi v16, v250 offset:0
    v_mul_f32 v243, v32, v152
    v_fma_f32 v241, v40, v168, -v241
    v_fmac_f32 v243, v33, v153
    v_fmac_f32 v241, v41, v169
    v_fmac_f32 v243, v34, v154
    v_fmac_f32 v241, v42, v170
    v_fmac_f32 v243, v35, v155
    v_fmac_f32 v241, v43, v171
    v_fmac_f32 v243, v36, v156
    v_fmac_f32 v241, v44, v172
    v_fmac_f32 v243, v37, v157
    v_fmac_f32 v241, v45, v173
    v_fmac_f32 v243, v38, v158
    v_fmac_f32 v241, v46, v174
    v_fmac_f32 v243, v39, v159
    v_fmac_f32 v241, v47, v175
    ds_read_b64_tr_b16 v[4:5], v249 offset:512
    ds_read_b64_tr_b16 v[6:7], v249 offset:544
    ds_read_u16_d16_hi v17, v250 offset:32
    v_fma_f32 v245, v48, v168, -v245
    v_fmac_f32 v237, v56, v120
    v_fmac_f32 v245, v49, v169
    v_fmac_f32 v237, v57, v121
    v_fmac_f32 v245, v50, v170
    v_fmac_f32 v237, v58, v122
    v_fmac_f32 v245, v51, v171
    v_fmac_f32 v237, v59, v123
    v_fmac_f32 v245, v52, v172
    v_fmac_f32 v237, v60, v124
    v_fmac_f32 v245, v53, v173
    v_fmac_f32 v237, v61, v125
    v_fmac_f32 v245, v54, v174
    v_fmac_f32 v237, v62, v126
    v_fmac_f32 v245, v55, v175
    v_fmac_f32 v237, v63, v127
    s_cmp_eq_u32 s56, 5
    s_cbranch_scc1 K2_U20
    s_cmp_eq_u32 s56, 6
    s_cbranch_scc1 K2_U3h0
    s_branch K2_DSP0
K2_U11:
    s_setprio 1
    v_mov_b32 v254, 163296
    v_mov_b32 v255, 1
    v_lshl_add_u32 v233, v252, 1, s53
    s_mov_b64 exec, 1
    ds_add_rtn_u32 v232, v254, v255
    s_mov_b64 exec, -1
    ds_read_b32 v233, v233
    s_waitcnt lgkmcnt(5)
    v_lshlrev_b32 v20, 16, v0
    v_and_b32 v21, 0xffff0000, v0
    v_lshlrev_b32 v22, 16, v1
    v_and_b32 v23, 0xffff0000, v1
    v_lshlrev_b32 v24, 16, v2
    v_and_b32 v25, 0xffff0000, v2
    v_lshlrev_b32 v26, 16, v3
    v_and_b32 v27, 0xffff0000, v3
    v_mul_f32_dpp v36, v16, v20 row_newbcast:8 row_mask:0xf bank_mask:0xf
    v_mul_f32_dpp v37, v16, v21 row_newbcast:9 row_mask:0xf bank_mask:0xf
    v_mul_f32_dpp v38, v16, v22 row_newbcast:10 row_mask:0xf bank_mask:0xf
    v_mul_f32_dpp v39, v16, v23 row_newbcast:11 row_mask:0xf bank_mask:0xf
    v_mul_f32_dpp v40, v16, v24 row_newbcast:12 row_mask:0xf bank_mask:0xf
    v_mul_f32_dpp v41, v16, v25 row_newbcast:13 row_mask:0xf bank_mask:0xf
    v_mul_f32_dpp v42, v16, v26 row_newbcast:14 row_mask:0xf bank_mask:0xf
    v_mul_f32_dpp v43, v16, v27 row_newbcast:15 row_mask:0xf bank_mask:0xf
    v_cvt_pk_bf16_f32 v68, v36, v37
    v_cvt_pk_bf16_f32 v69, v38, v39
    v_cvt_pk_bf16_f32 v70, v40, v41
    v_cvt_pk_bf16_f32 v71, v42, v43
    v_mul_f32_dpp v20, v16, v20 row_newbcast:0 row_mask:0xa bank_mask:0xf
    v_mul_f32_dpp v21, v16, v21 row_newbcast:1 row_mask:0xa bank_mask:0xf
    v_mul_f32_dpp v22, v16, v22 row_newbcast:2 row_mask:0xa bank_mask:0xf
    v_mul_f32_dpp v23, v16, v23 row_newbcast:3 row_mask:0xa bank_mask:0xf
    v_mul_f32_dpp v24, v16, v24 row_newbcast:4 row_mask:0xa bank_mask:0xf
    v_mul_f32_dpp v25, v16, v25 row_newbcast:5 row_mask:0xa bank_mask:0xf
    v_mul_f32_dpp v26, v16, v26 row_newbcast:6 row_mask:0xa bank_mask:0xf
    v_mul_f32_dpp v27, v16, v27 row_newbcast:7 row_mask:0xa bank_mask:0xf
    v_cvt_pk_bf16_f32 v64, v20, v21
    v_cvt_pk_bf16_f32 v65, v22, v23
    v_cvt_pk_bf16_f32 v66, v24, v25
    v_cvt_pk_bf16_f32 v67, v26, v27
    s_waitcnt lgkmcnt(0)
    v_readfirstlane_b32 s58, v232
    s_nop 0
    s_cmp_lt_u32 s58, s22
    s_cbranch_scc0 K2_nul_94
    s_and_b32 s59, s58, 7
    s_lshr_b32 s60, s58, 3
K2_chk_96:
    v_readlane_b32 s61, v233, s59
    s_nop 0
    s_cmp_gt_u32 s61, s60
    s_cbranch_scc0 K2_spin_95
K2_back_97:
    v_readlane_b32 s3, v253, s58
    s_lshl_b32 s44, s34, 7
    s_and_b32 s48, s3, 0x3ffff
    s_bfe_u32 s33, s3, 0x30013
    s_mov_b32 s35, s48
    s_mov_b32 s45, s44
    s_add_u32 s47, s44, 256
    s_add_u32 s49, s48, 32
    s_add_u32 s60, s48, 64
    s_cmp_eq_u32 s33, 3
    s_cselect_b32 s46, s44, s47
    s_cselect_b32 s50, s60, s48
    s_cselect_b32 s51, s48, s49
    s_sub_u32 s60, s33, 2
    s_cmp_lt_u32 s60, 2
    s_cbranch_scc0 K2_rare_98
K2_back_99:
    v_add_u32 v222, s48, v251
    ds_read_b32 v222, v222
    v_add_u32 v224, s49, v251
    ds_read_b32 v224, v224
    v_add_u32 v226, s50, v251
    ds_read_b32 v226, v226
    v_add_u32 v228, s51, v251
    ds_read_b32 v228, v228
    s_waitcnt lgkmcnt(3)
    v_mad_u32_u16 v223, v222, s39, v248 op_sel:[1,0,0,0]
    v_mad_u32_u16 v222, v222, s39, v248
    s_waitcnt lgkmcnt(2)
    v_mad_u32_u16 v225, v224, s39, v248 op_sel:[1,0,0,0]
    v_mad_u32_u16 v224, v224, s39, v248
    s_waitcnt lgkmcnt(1)
    v_mad_u32_u16 v227, v226, s39, v248 op_sel:[1,0,0,0]
    v_mad_u32_u16 v226, v226, s39, v248
    s_waitcnt lgkmcnt(0)
    v_mad_u32_u16 v229, v228, s39, v248 op_sel:[1,0,0,0]
    v_mad_u32_u16 v228, v228, s39, v248
    s_waitcnt vmcnt(4)
    v_mfma_f32_32x32x16_bf16 v[0:15], v[64:67], v[176:179], 0
    ds_read_b64_tr_b16 v[184:185], v246 offset:2048
    ds_read_b64_tr_b16 v[186:187], v246 offset:3072
    ds_read_b64_tr_b16 v[188:189], v247 offset:2048
    ds_read_b64_tr_b16 v[190:191], v247 offset:3072
    s_mov_b32 m0, s68
    v_mfma_f32_32x32x16_bf16 v[16:31], v[68:71], v[176:179], 0
    buffer_load_dwordx4 v222, s[4:7], s44 offen sc1 lds
    buffer_load_dwordx4 v223, s[72:75], s44 offen offset:1024 sc1 lds
    v_permlane32_swap_b32 v242, v236
    v_permlane32_swap_b32 v243, v237
    v_mfma_f32_32x32x16_bf16 v[32:47], v[64:67], v[180:183], 0
    v_permlane32_swap_b32 v244, v238
    v_permlane32_swap_b32 v245, v239
    v_permlane32_swap_b32 v240, v241
    v_add_f32 v242, v242, v236
    v_mfma_f32_32x32x16_bf16 v[48:63], v[68:71], v[180:183], 0
    s_setprio 0
    v_add_f32 v243, v243, v237
    v_add_f32 v244, v244, v238
    v_add_f32 v245, v245, v239
    v_add_f32 v240, -v240, -v241
    v_sub_u32 v241, v230, v231
    v_cvt_pk_bf16_f32 v242, v242, v243
    v_cvt_pk_bf16_f32 v244, v244, v245
    v_cvt_pk_bf16_f32 v240, v240, v240
    ds_write_b32 v230, v242 offset:768
    ds_write_b32 v230, v244 offset:1024
    ds_write_b16 v241, v240 offset:1280
    v_mul_f32 v234, v0, v96
    v_mul_f32 v236, v8, v128
    v_fmac_f32 v234, v1, v97
    v_fmac_f32 v236, v9, v129
    v_fmac_f32 v234, v2, v98
    v_fmac_f32 v236, v10, v130
    v_fmac_f32 v234, v3, v99
    v_fmac_f32 v236, v11, v131
    v_fmac_f32 v234, v4, v100
    v_fmac_f32 v236, v12, v132
    v_fmac_f32 v234, v5, v101
    v_fmac_f32 v236, v13, v133
    v_fmac_f32 v234, v6, v102
    v_fmac_f32 v236, v14, v134
    v_fmac_f32 v234, v7, v103
    v_fmac_f32 v236, v15, v135
    v_mul_f32 v238, v16, v128
    v_mul_f32 v240, v24, v128
    v_fmac_f32 v238, v17, v129
    v_fmac_f32 v240, v25, v129
    v_fmac_f32 v238, v18, v130
    v_fmac_f32 v240, v26, v130
    v_fmac_f32 v238, v19, v131
    v_fmac_f32 v240, v27, v131
    v_fmac_f32 v238, v20, v132
    v_fmac_f32 v240, v28, v132
    v_fmac_f32 v238, v21, v133
    v_fmac_f32 v240, v29, v133
    v_fmac_f32 v238, v22, v134
    v_fmac_f32 v240, v30, v134
    v_fmac_f32 v238, v23, v135
    v_fmac_f32 v240, v31, v135
    v_mul_f32 v235, v32, v104
    v_mul_f32 v237, v40, v136
    v_fmac_f32 v235, v33, v105
    v_fmac_f32 v237, v41, v137
    v_fmac_f32 v235, v34, v106
    v_fmac_f32 v237, v42, v138
    v_fmac_f32 v235, v35, v107
    v_fmac_f32 v237, v43, v139
    v_fmac_f32 v235, v36, v108
    v_fmac_f32 v237, v44, v140
    v_fmac_f32 v235, v37, v109
    v_fmac_f32 v237, v45, v141
    v_fmac_f32 v235, v38, v110
    v_fmac_f32 v237, v46, v142
    v_fmac_f32 v235, v39, v111
    v_fmac_f32 v237, v47, v143
    v_mul_f32 v239, v48, v136
    v_mul_f32 v241, v56, v136
    v_fmac_f32 v239, v49, v137
    v_fmac_f32 v241, v57, v137
    v_fmac_f32 v239, v50, v138
    v_fmac_f32 v241, v58, v138
    v_fmac_f32 v239, v51, v139
    v_fmac_f32 v241, v59, v139
    v_fmac_f32 v239, v52, v140
    v_fmac_f32 v241, v60, v140
    v_fmac_f32 v239, v53, v141
    v_fmac_f32 v241, v61, v141
    v_fmac_f32 v239, v54, v142
    v_fmac_f32 v241, v62, v142
    v_fmac_f32 v239, v55, v143
    v_fmac_f32 v241, v63, v143
    s_setprio 1
    s_waitcnt vmcnt(4) lgkmcnt(3)
    v_mfma_f32_32x32x16_bf16 v[0:15], v[64:67], v[184:187], 0
    ds_read_b64_tr_b16 v[176:177], v246 offset:4096
    ds_read_b64_tr_b16 v[178:179], v246 offset:5120
    ds_read_b64_tr_b16 v[180:181], v247 offset:4096
    ds_read_b64_tr_b16 v[182:183], v247 offset:5120
    s_mov_b32 m0, s69
    v_mfma_f32_32x32x16_bf16 v[16:31], v[68:71], v[184:187], 0
    buffer_load_dwordx4 v224, s[4:7], s45 offen sc1 lds
    buffer_load_dwordx4 v225, s[72:75], s45 offen offset:1024 sc1 lds
    v_permlane32_swap_b32 v234, v236
    v_permlane32_swap_b32 v235, v237
    v_mfma_f32_32x32x16_bf16 v[32:47], v[64:67], v[188:191], 0
    v_permlane32_swap_b32 v240, v238
    v_permlane32_swap_b32 v241, v239
    v_lshl_add_u32 v230, v252, 1, s31
    v_add_f32 v234, v234, v236
    v_add_f32 v235, v235, v237
    v_mfma_f32_32x32x16_bf16 v[48:63], v[68:71], v[188:191], 0
    s_setprio 0
    v_add_f32 v240, v240, v238
    v_add_f32 v241, v241, v239
    v_cvt_pk_bf16_f32 v234, v234, v235
    v_cvt_pk_bf16_f32 v240, v240, v241
    ds_write_b32 v230, v234 offset:0
    ds_write_b32 v230, v240 offset:256
    v_mul_f32 v234, v0, v144
    v_mul_f32 v236, v8, v112
    v_fmac_f32 v234, v1, v145
    v_fmac_f32 v236, v9, v113
    v_fmac_f32 v234, v2, v146
    v_fmac_f32 v236, v10, v114
    v_fmac_f32 v234, v3, v147
    v_fmac_f32 v236, v11, v115
    v_fmac_f32 v234, v4, v148
    v_fmac_f32 v236, v12, v116
    v_fmac_f32 v234, v5, v149
    v_fmac_f32 v236, v13, v117
    v_fmac_f32 v234, v6, v150
    v_fmac_f32 v236, v14, v118
    v_fmac_f32 v234, v7, v151
    v_fmac_f32 v236, v15, v119
    v_mul_f32 v238, v16, v160
    v_mul_f32 v240, v24, v160
    v_fmac_f32 v238, v17, v161
    v_fmac_f32 v240, v25, v161
    v_fmac_f32 v238, v18, v162
    v_fmac_f32 v240, v26, v162
    v_fmac_f32 v238, v19, v163
    v_fmac_f32 v240, v27, v163
    v_fmac_f32 v238, v20, v164
    v_fmac_f32 v240, v28, v164
    v_fmac_f32 v238, v21, v165
    v_fmac_f32 v240, v29, v165
    v_fmac_f32 v238, v22, v166
    v_fmac_f32 v240, v30, v166
    v_fmac_f32 v238, v23, v167
    v_fmac_f32 v240, v31, v167
    v_mul_f32 v235, v32, v152
    v_mul_f32 v237, v40, v120
    v_fmac_f32 v235, v33, v153
    v_fmac_f32 v237, v41, v121
    v_fmac_f32 v235, v34, v154
    v_fmac_f32 v237, v42, v122
    v_fmac_f32 v235, v35, v155
    v_fmac_f32 v237, v43, v123
    v_fmac_f32 v235, v36, v156
    v_fmac_f32 v237, v44, v124
    v_fmac_f32 v235, v37, v157
    v_fmac_f32 v237, v45, v125
    v_fmac_f32 v235, v38, v158
    v_fmac_f32 v237, v46, v126
    v_fmac_f32 v235, v39, v159
    v_fmac_f32 v237, v47, v127
    v_mul_f32 v239, v48, v168
    v_mul_f32 v241, v56, v168
    v_fmac_f32 v239, v49, v169
    v_fmac_f32 v241, v57, v169
    v_fmac_f32 v239, v50, v170
    v_fmac_f32 v241, v58, v170
    v_fmac_f32 v239, v51, v171
    v_fmac_f32 v241, v59, v171
    v_fmac_f32 v239, v52, v172
    v_fmac_f32 v241, v60, v172
    v_fmac_f32 v239, v53, v173
    v_fmac_f32 v241, v61, v173
    v_fmac_f32 v239, v54, v174
    v_fmac_f32 v241, v62, v174
    v_fmac_f32 v239, v55, v175
    v_fmac_f32 v241, v63, v175
    s_setprio 1
    s_waitcnt vmcnt(4) lgkmcnt(2)
    v_mfma_f32_32x32x16_bf16 v[0:15], v[64:67], v[176:179], 0
    ds_read_b64_tr_b16 v[184:185], v246 offset:6144
    ds_read_b64_tr_b16 v[186:187], v246 offset:7168
    ds_read_b64_tr_b16 v[188:189], v247 offset:6144
    ds_read_b64_tr_b16 v[190:191], v247 offset:7168
    s_mov_b32 s32, s31
    s_mov_b32 s31, s35
    s_mov_b32 m0, s70
    v_mfma_f32_32x32x16_bf16 v[16:31], v[68:71], v[176:179], 0
    buffer_load_dwordx4 v226, s[4:7], s46 offen sc1 lds
    buffer_load_dwordx4 v227, s[72:75], s46 offen offset:1024 sc1 lds
    s_sub_u32 s26, s48, s29
    s_mov_b32 s29, s48
    s_mov_b32 s30, s3
    s_bfe_u32 s56, s3, 0x40012
    v_mfma_f32_32x32x16_bf16 v[32:47], v[64:67], v[180:183], 0
    s_cmp_lg_u32 s36, 0
    s_cselect_b32 s56, s56, 0
    v_mfma_f32_32x32x16_bf16 v[48:63], v[68:71], v[180:183], 0
    s_setprio 0
    v_mul_f32 v242, v0, v144
    v_fma_f32 v238, v8, v160, -v238
    v_fmac_f32 v242, v1, v145
    v_fmac_f32 v238, v9, v161
    v_fmac_f32 v242, v2, v146
    v_fmac_f32 v238, v10, v162
    v_fmac_f32 v242, v3, v147
    v_fmac_f32 v238, v11, v163
    v_fmac_f32 v242, v4, v148
    v_fmac_f32 v238, v12, v164
    v_fmac_f32 v242, v5, v149
    v_fmac_f32 v238, v13, v165
    v_fmac_f32 v242, v6, v150
    v_fmac_f32 v238, v14, v166
    v_fmac_f32 v242, v7, v151
    v_fmac_f32 v238, v15, v167
    v_fmac_f32 v236, v16, v112
    v_mul_f32 v244, v24, v160
    v_fmac_f32 v236, v17, v113
    v_fmac_f32 v244, v25, v161
    v_fmac_f32 v236, v18, v114
    v_fmac_f32 v244, v26, v162
    v_fmac_f32 v236, v19, v115
    v_fmac_f32 v244, v27, v163
    v_fmac_f32 v236, v20, v116
    v_fmac_f32 v244, v28, v164
    v_fmac_f32 v236, v21, v117
    v_fmac_f32 v244, v29, v165
    v_fmac_f32 v236, v22, v118
    v_fmac_f32 v244, v30, v166
    v_fmac_f32 v236, v23, v119
    v_fmac_f32 v244, v31, v167
    v_mul_f32 v243, v32, v152
    v_fma_f32 v239, v40, v168, -v239
    v_fmac_f32 v243, v33, v153
    v_fmac_f32 v239, v41, v169
    v_fmac_f32 v243, v34, v154
    v_fmac_f32 v239, v42, v170
    v_fmac_f32 v243, v35, v155
    v_fmac_f32 v239, v43, v171
    v_fmac_f32 v243, v36, v156
    v_fmac_f32 v239, v44, v172
    v_fmac_f32 v243, v37, v157
    v_fmac_f32 v239, v45, v173
    v_fmac_f32 v243, v38, v158
    v_fmac_f32 v239, v46, v174
    v_fmac_f32 v243, v39, v159
    v_fmac_f32 v239, v47, v175
    v_fmac_f32 v237, v48, v120
    v_mul_f32 v245, v56, v168
    v_fmac_f32 v237, v49, v121
    v_fmac_f32 v245, v57, v169
    v_fmac_f32 v237, v50, v122
    v_fmac_f32 v245, v58, v170
    v_fmac_f32 v237, v51, v123
    v_fmac_f32 v245, v59, v171
    v_fmac_f32 v237, v52, v124
    v_fmac_f32 v245, v60, v172
    v_fmac_f32 v237, v53, v125
    v_fmac_f32 v245, v61, v173
    v_fmac_f32 v237, v54, v126
    v_fmac_f32 v245, v62, v174
    v_fmac_f32 v237, v55, v127
    v_fmac_f32 v245, v63, v175
    s_setprio 1
    s_waitcnt vmcnt(4) lgkmcnt(0)
    v_mfma_f32_32x32x16_bf16 v[0:15], v[64:67], v[184:187], 0
    ds_read_b64_tr_b16 v[176:177], v246 offset:0
    ds_read_b64_tr_b16 v[178:179], v246 offset:1024
    ds_read_b64_tr_b16 v[180:181], v247 offset:0
    ds_read_b64_tr_b16 v[182:183], v247 offset:1024
    s_mov_b32 m0, s71
    v_mfma_f32_32x32x16_bf16 v[16:31], v[68:71], v[184:187], 0
    buffer_load_dwordx4 v228, s[4:7], s47 offen sc1 lds
    buffer_load_dwordx4 v229, s[72:75], s47 offen offset:1024 sc1 lds
    v_permlane32_swap_b32 v242, v234
    v_permlane32_swap_b32 v243, v235
    v_add_f32 v242, v242, v234
    v_mfma_f32_32x32x16_bf16 v[32:47], v[64:67], v[188:191], 0
    v_add_f32 v243, v243, v235
    v_cvt_pk_bf16_f32 v242, v242, v243
    ds_write_b32 v230, v242 offset:512
    v_mfma_f32_32x32x16_bf16 v[48:63], v[68:71], v[188:191], 0
    s_setprio 0
    v_mul_f32 v242, v0, v144
    v_fma_f32 v240, v8, v160, -v240
    v_fmac_f32 v242, v1, v145
    v_fmac_f32 v240, v9, v161
    v_fmac_f32 v242, v2, v146
    v_fmac_f32 v240, v10, v162
    v_fmac_f32 v242, v3, v147
    v_fmac_f32 v240, v11, v163
    v_fmac_f32 v242, v4, v148
    v_fmac_f32 v240, v12, v164
    v_fmac_f32 v242, v5, v149
    v_fmac_f32 v240, v13, v165
    v_fmac_f32 v242, v6, v150
    v_fmac_f32 v240, v14, v166
    v_fmac_f32 v242, v7, v151
    v_fmac_f32 v240, v15, v167
    v_add_u32 v249, s26, v249
    v_add_u32 v250, s26, v250
    v_fma_f32 v244, v16, v160, -v244
    v_fmac_f32 v236, v24, v112
    v_fmac_f32 v244, v17, v161
    v_fmac_f32 v236, v25, v113
    v_fmac_f32 v244, v18, v162
    v_fmac_f32 v236, v26, v114
    v_fmac_f32 v244, v19, v163
    v_fmac_f32 v236, v27, v115
    v_fmac_f32 v244, v20, v164
    v_fmac_f32 v236, v28, v116
    v_fmac_f32 v244, v21, v165
    v_fmac_f32 v236, v29, v117
    v_fmac_f32 v244, v22, v166
    v_fmac_f32 v236, v30, v118
    v_fmac_f32 v244, v23, v167
    v_fmac_f32 v236, v31, v119
    ds_read_b64_tr_b16 v[0:1], v249 offset:0
    ds_read_b64_tr_b16 v[2:3], v249 offset:32
    ds_read_u16_d16_hi v16, v250 offset:0
    v_mul_f32 v243, v32, v152
    v_fma_f32 v241, v40, v168, -v241
    v_fmac_f32 v243, v33, v153
    v_fmac_f32 v241, v41, v169
    v_fmac_f32 v243, v34, v154
    v_fmac_f32 v241, v42, v170
    v_fmac_f32 v243, v35, v155
    v_fmac_f32 v241, v43, v171
    v_fmac_f32 v243, v36, v156
    v_fmac_f32 v241, v44, v172
    v_fmac_f32 v243, v37, v157
    v_fmac_f32 v241, v45, v173
    v_fmac_f32 v243, v38, v158
    v_fmac_f32 v241, v46, v174
    v_fmac_f32 v243, v39, v159
    v_fmac_f32 v241, v47, v175
    ds_read_b64_tr_b16 v[4:5], v249 offset:512
    ds_read_b64_tr_b16 v[6:7], v249 offset:544
    ds_read_u16_d16_hi v17, v250 offset:32
    v_fma_f32 v245, v48, v168, -v245
    v_fmac_f32 v237, v56, v120
    v_fmac_f32 v245, v49, v169
    v_fmac_f32 v237, v57, v121
    v_fmac_f32 v245, v50, v170
    v_fmac_f32 v237, v58, v122
    v_fmac_f32 v245, v51, v171
    v_fmac_f32 v237, v59, v123
    v_fmac_f32 v245, v52, v172
    v_fmac_f32 v237, v60, v124
    v_fmac_f32 v245, v53, v173
    v_fmac_f32 v237, v61, v125
    v_fmac_f32 v245, v54, v174
    v_fmac_f32 v237, v62, v126
    v_fmac_f32 v245, v55, v175
    v_fmac_f32 v237, v63, v127
    s_cmp_eq_u32 s56, 5
    s_cbranch_scc1 K2_U21
    s_cmp_eq_u32 s56, 6
    s_cbranch_scc1 K2_U3h1
    s_branch K2_DSP1
K2_U41:
    s_setprio 1
    ds_read_b64_tr_b16 v[8:9], v249 offset:1024
    ds_read_b64_tr_b16 v[10:11], v249 offset:1056
    ds_read_u16_d16_hi v18, v250 offset:64
    s_lshr_b32 s65, s30, 27
    s_mul_i32 s66, s22, 2080
    s_lshl_b32 s65, s65, 9
    s_add_u32 s65, s65, s66
    s_add_u32 s65, s65, 65536
    s_sub_u32 s65, s65, s29
    s_sub_u32 s65, s65, 512
    v_add_u32 v56, s65, v249
    ds_read_b64_tr_b16 v[12:13], v56 offset:0
    ds_read_b64_tr_b16 v[14:15], v56 offset:32
    ds_read_u16_d16_hi v19, v250 offset:96
    s_waitcnt lgkmcnt(6)
    v_lshlrev_b32 v20, 16, v0
    v_and_b32 v21, 0xffff0000, v0
    v_lshlrev_b32 v22, 16, v1
    v_and_b32 v23, 0xffff0000, v1
    v_lshlrev_b32 v24, 16, v2
    v_and_b32 v25, 0xffff0000, v2
    v_lshlrev_b32 v26, 16, v3
    v_and_b32 v27, 0xffff0000, v3
    v_mul_f32_dpp v36, v16, v20 row_newbcast:8 row_mask:0xf bank_mask:0xf
    v_mul_f32_dpp v37, v16, v21 row_newbcast:9 row_mask:0xf bank_mask:0xf
    v_mul_f32_dpp v38, v16, v22 row_newbcast:10 row_mask:0xf bank_mask:0xf
    v_mul_f32_dpp v39, v16, v23 row_newbcast:11 row_mask:0xf bank_mask:0xf
    v_mul_f32_dpp v40, v16, v24 row_newbcast:12 row_mask:0xf bank_mask:0xf
    v_mul_f32_dpp v41, v16, v25 row_newbcast:13 row_mask:0xf bank_mask:0xf
    v_mul_f32_dpp v42, v16, v26 row_newbcast:14 row_mask:0xf bank_mask:0xf
    v_mul_f32_dpp v43, v16, v27 row_newbcast:15 row_mask:0xf bank_mask:0xf
    v_cvt_pk_bf16_f32 v68, v36, v37
    v_cvt_pk_bf16_f32 v69, v38, v39
    v_cvt_pk_bf16_f32 v70, v40, v41
    v_cvt_pk_bf16_f32 v71, v42, v43
    v_mul_f32_dpp v20, v16, v20 row_newbcast:0 row_mask:0xa bank_mask:0xf
    v_mul_f32_dpp v21, v16, v21 row_newbcast:1 row_mask:0xa bank_mask:0xf
    v_mul_f32_dpp v22, v16, v22 row_newbcast:2 row_mask:0xa bank_mask:0xf
    v_mul_f32_dpp v23, v16, v23 row_newbcast:3 row_mask:0xa bank_mask:0xf
    v_mul_f32_dpp v24, v16, v24 row_newbcast:4 row_mask:0xa bank_mask:0xf
    v_mul_f32_dpp v25, v16, v25 row_newbcast:5 row_mask:0xa bank_mask:0xf
    v_mul_f32_dpp v26, v16, v26 row_newbcast:6 row_mask:0xa bank_mask:0xf
    v_mul_f32_dpp v27, v16, v27 row_newbcast:7 row_mask:0xa bank_mask:0xf
    v_cvt_pk_bf16_f32 v64, v20, v21
    v_cvt_pk_bf16_f32 v65, v22, v23
    v_cvt_pk_bf16_f32 v66, v24, v25
    v_cvt_pk_bf16_f32 v67, v26, v27
    v_lshlrev_b32 v28, 16, v4
    v_and_b32 v29, 0xffff0000, v4
    v_lshlrev_b32 v30, 16, v5
    v_and_b32 v31, 0xffff0000, v5
    v_lshlrev_b32 v32, 16, v6
    v_and_b32 v33, 0xffff0000, v6
    v_lshlrev_b32 v34, 16, v7
    v_and_b32 v35, 0xffff0000, v7
    v_mul_f32_dpp v36, v17, v28 row_newbcast:8 row_mask:0xf bank_mask:0xf
    v_mul_f32_dpp v37, v17, v29 row_newbcast:9 row_mask:0xf bank_mask:0xf
    v_mul_f32_dpp v38, v17, v30 row_newbcast:10 row_mask:0xf bank_mask:0xf
    v_mul_f32_dpp v39, v17, v31 row_newbcast:11 row_mask:0xf bank_mask:0xf
    v_mul_f32_dpp v40, v17, v32 row_newbcast:12 row_mask:0xf bank_mask:0xf
    v_mul_f32_dpp v41, v17, v33 row_newbcast:13 row_mask:0xf bank_mask:0xf
    v_mul_f32_dpp v42, v17, v34 row_newbcast:14 row_mask:0xf bank_mask:0xf
    v_mul_f32_dpp v43, v17, v35 row_newbcast:15 row_mask:0xf bank_mask:0xf
    v_cvt_pk_bf16_f32 v76, v36, v37
    v_cvt_pk_bf16_f32 v77, v38, v39
    v_cvt_pk_bf16_f32 v78, v40, v41
    v_cvt_pk_bf16_f32 v79, v42, v43
    v_mul_f32_dpp v28, v17, v28 row_newbcast:0 row_mask:0xa bank_mask:0xf
    v_mul_f32_dpp v29, v17, v29 row_newbcast:1 row_mask:0xa bank_mask:0xf
    v_mul_f32_dpp v30, v17, v30 row_newbcast:2 row_mask:0xa bank_mask:0xf
    v_mul_f32_dpp v31, v17, v31 row_newbcast:3 row_mask:0xa bank_mask:0xf
    v_mul_f32_dpp v32, v17, v32 row_newbcast:4 row_mask:0xa bank_mask:0xf
    v_mul_f32_dpp v33, v17, v33 row_newbcast:5 row_mask:0xa bank_mask:0xf
    v_mul_f32_dpp v34, v17, v34 row_newbcast:6 row_mask:0xa bank_mask:0xf
    v_mul_f32_dpp v35, v17, v35 row_newbcast:7 row_mask:0xa bank_mask:0xf
    v_cvt_pk_bf16_f32 v72, v28, v29
    v_cvt_pk_bf16_f32 v73, v30, v31
    v_cvt_pk_bf16_f32 v74, v32, v33
    v_cvt_pk_bf16_f32 v75, v34, v35
    s_waitcnt lgkmcnt(3)
    v_lshlrev_b32 v20, 16, v8
    v_and_b32 v21, 0xffff0000, v8
    v_lshlrev_b32 v22, 16, v9
    v_and_b32 v23, 0xffff0000, v9
    v_lshlrev_b32 v24, 16, v10
    v_and_b32 v25, 0xffff0000, v10
    v_lshlrev_b32 v26, 16, v11
    v_and_b32 v27, 0xffff0000, v11
    v_mul_f32_dpp v36, v18, v20 row_newbcast:8 row_mask:0xf bank_mask:0xf
    v_mul_f32_dpp v37, v18, v21 row_newbcast:9 row_mask:0xf bank_mask:0xf
    v_mul_f32_dpp v38, v18, v22 row_newbcast:10 row_mask:0xf bank_mask:0xf
    v_mul_f32_dpp v39, v18, v23 row_newbcast:11 row_mask:0xf bank_mask:0xf
    v_mul_f32_dpp v40, v18, v24 row_newbcast:12 row_mask:0xf bank_mask:0xf
    v_mul_f32_dpp v41, v18, v25 row_newbcast:13 row_mask:0xf bank_mask:0xf
    v_mul_f32_dpp v42, v18, v26 row_newbcast:14 row_mask:0xf bank_mask:0xf
    v_mul_f32_dpp v43, v18, v27 row_newbcast:15 row_mask:0xf bank_mask:0xf
    v_cvt_pk_bf16_f32 v84, v36, v37
    v_cvt_pk_bf16_f32 v85, v38, v39
    v_cvt_pk_bf16_f32 v86, v40, v41
    v_cvt_pk_bf16_f32 v87, v42, v43
    v_mul_f32_dpp v20, v18, v20 row_newbcast:0 row_mask:0xa bank_mask:0xf
    v_mul_f32_dpp v21, v18, v21 row_newbcast:1 row_mask:0xa bank_mask:0xf
    v_mul_f32_dpp v22, v18, v22 row_newbcast:2 row_mask:0xa bank_mask:0xf
    v_mul_f32_dpp v23, v18, v23 row_newbcast:3 row_mask:0xa bank_mask:0xf
    v_mul_f32_dpp v24, v18, v24 row_newbcast:4 row_mask:0xa bank_mask:0xf
    v_mul_f32_dpp v25, v18, v25 row_newbcast:5 row_mask:0xa bank_mask:0xf
    v_mul_f32_dpp v26, v18, v26 row_newbcast:6 row_mask:0xa bank_mask:0xf
    v_mul_f32_dpp v27, v18, v27 row_newbcast:7 row_mask:0xa bank_mask:0xf
    v_cvt_pk_bf16_f32 v80, v20, v21
    v_cvt_pk_bf16_f32 v81, v22, v23
    v_cvt_pk_bf16_f32 v82, v24, v25
    v_cvt_pk_bf16_f32 v83, v26, v27
    s_waitcnt lgkmcnt(0)
    v_lshlrev_b32 v28, 16, v12
    v_and_b32 v29, 0xffff0000, v12
    v_lshlrev_b32 v30, 16, v13
    v_and_b32 v31, 0xffff0000, v13
    v_lshlrev_b32 v32, 16, v14
    v_and_b32 v33, 0xffff0000, v14
    v_lshlrev_b32 v34, 16, v15
    v_and_b32 v35, 0xffff0000, v15
    v_mul_f32_dpp v36, v19, v28 row_newbcast:8 row_mask:0xf bank_mask:0xf
    v_mul_f32_dpp v37, v19, v29 row_newbcast:9 row_mask:0xf bank_mask:0xf
    v_mul_f32_dpp v38, v19, v30 row_newbcast:10 row_mask:0xf bank_mask:0xf
    v_mul_f32_dpp v39, v19, v31 row_newbcast:11 row_mask:0xf bank_mask:0xf
    v_mul_f32_dpp v40, v19, v32 row_newbcast:12 row_mask:0xf bank_mask:0xf
    v_mul_f32_dpp v41, v19, v33 row_newbcast:13 row_mask:0xf bank_mask:0xf
    v_mul_f32_dpp v42, v19, v34 row_newbcast:14 row_mask:0xf bank_mask:0xf
    v_mul_f32_dpp v43, v19, v35 row_newbcast:15 row_mask:0xf bank_mask:0xf
    v_cvt_pk_bf16_f32 v92, v36, v37
    v_cvt_pk_bf16_f32 v93, v38, v39
    v_cvt_pk_bf16_f32 v94, v40, v41
    v_cvt_pk_bf16_f32 v95, v42, v43
    v_mul_f32_dpp v28, v19, v28 row_newbcast:0 row_mask:0xa bank_mask:0xf
    v_mul_f32_dpp v29, v19, v29 row_newbcast:1 row_mask:0xa bank_mask:0xf
    v_mul_f32_dpp v30, v19, v30 row_newbcast:2 row_mask:0xa bank_mask:0xf
    v_mul_f32_dpp v31, v19, v31 row_newbcast:3 row_mask:0xa bank_mask:0xf
    v_mul_f32_dpp v32, v19, v32 row_newbcast:4 row_mask:0xa bank_mask:0xf
    v_mul_f32_dpp v33, v19, v33 row_newbcast:5 row_mask:0xa bank_mask:0xf
    v_mul_f32_dpp v34, v19, v34 row_newbcast:6 row_mask:0xa bank_mask:0xf
    v_mul_f32_dpp v35, v19, v35 row_newbcast:7 row_mask:0xa bank_mask:0xf
    v_cvt_pk_bf16_f32 v88, v28, v29
    v_cvt_pk_bf16_f32 v89, v30, v31
    v_cvt_pk_bf16_f32 v90, v32, v33
    v_cvt_pk_bf16_f32 v91, v34, v35
    s_waitcnt vmcnt(4)
    v_mfma_f32_32x32x16_bf16 v[0:15], v[64:67], v[176:179], 0
    ds_read_b64_tr_b16 v[184:185], v246 offset:2048
    ds_read_b64_tr_b16 v[186:187], v246 offset:3072
    ds_read_b64_tr_b16 v[188:189], v247 offset:2048
    ds_read_b64_tr_b16 v[190:191], v247 offset:3072
    s_mov_b32 m0, s68
    v_mfma_f32_32x32x16_bf16 v[16:31], v[68:71], v[176:179], 0
    buffer_load_dwordx4 v222, s[4:7], s41 offen sc1 lds
    buffer_load_dwordx4 v223, s[72:75], s41 offen offset:1024 sc1 lds
    v_permlane32_swap_b32 v242, v236
    v_permlane32_swap_b32 v243, v237
    v_mov_b32 v254, 163296
    v_mfma_f32_32x32x16_bf16 v[32:47], v[64:67], v[180:183], 0
    v_permlane32_swap_b32 v244, v238
    v_permlane32_swap_b32 v245, v239
    v_permlane32_swap_b32 v240, v241
    v_add_f32 v242, v242, v236
    v_mfma_f32_32x32x16_bf16 v[48:63], v[68:71], v[180:183], 0
    v_add_f32 v243, v243, v237
    v_add_f32 v244, v244, v238
    v_add_f32 v245, v245, v239
    v_add_f32 v240, -v240, -v241
    v_sub_u32 v241, v230, v231
    v_cvt_pk_bf16_f32 v242, v242, v243
    v_mov_b32 v255, 1
    v_lshl_add_u32 v233, v252, 1, s53
    s_mov_b64 exec, 1
    ds_add_rtn_u32 v232, v254, v255
    s_mov_b64 exec, -1
    ds_read_b32 v233, v233
    s_waitcnt vmcnt(4) lgkmcnt(2)
    v_mfma_f32_32x32x16_bf16 v[0:15], v[72:75], v[184:187], v[0:15]
    ds_read_b64_tr_b16 v[176:177], v246 offset:4096
    ds_read_b64_tr_b16 v[178:179], v246 offset:5120
    ds_read_b64_tr_b16 v[180:181], v247 offset:4096
    ds_read_b64_tr_b16 v[182:183], v247 offset:5120
    v_cvt_pk_bf16_f32 v244, v244, v245
    v_cvt_pk_bf16_f32 v240, v240, v240
    s_mov_b32 m0, s69
    v_mfma_f32_32x32x16_bf16 v[16:31], v[76:79], v[184:187], v[16:31]
    buffer_load_dwordx4 v224, s[4:7], s41 offen sc1 lds
    buffer_load_dwordx4 v225, s[72:75], s41 offen offset:1024 sc1 lds
    ds_write_b32 v230, v242 offset:768
    ds_write_b32 v230, v244 offset:1024
    ds_write_b16 v241, v240 offset:1280
    s_waitcnt lgkmcnt(7)
    v_readfirstlane_b32 s58, v232
    v_mfma_f32_32x32x16_bf16 v[32:47], v[72:75], v[188:191], v[32:47]
    s_cmp_lt_u32 s58, s22
    s_cbranch_scc0 K2_nul_101
    s_and_b32 s59, s58, 7
    s_lshr_b32 s60, s58, 3
K2_chk_103:
    v_readlane_b32 s61, v233, s59
    s_nop 0
    s_cmp_gt_u32 s61, s60
    s_cbranch_scc0 K2_spin_102
K2_back_104:
    v_mfma_f32_32x32x16_bf16 v[48:63], v[76:79], v[188:191], v[48:63]
    v_readlane_b32 s3, v253, s58
    s_lshl_b32 s44, s34, 7
    s_and_b32 s48, s3, 0x3ffff
    s_bfe_u32 s33, s3, 0x30013
    s_mov_b32 s35, s48
    s_mov_b32 s45, s44
    s_waitcnt vmcnt(4) lgkmcnt(3)
    v_mfma_f32_32x32x16_bf16 v[0:15], v[80:83], v[176:179], v[0:15]
    ds_read_b64_tr_b16 v[184:185], v246 offset:6144
    ds_read_b64_tr_b16 v[186:187], v246 offset:7168
    ds_read_b64_tr_b16 v[188:189], v247 offset:6144
    ds_read_b64_tr_b16 v[190:191], v247 offset:7168
    s_add_u32 s47, s44, 256
    s_add_u32 s49, s48, 32
    s_mov_b32 m0, s70
    v_mfma_f32_32x32x16_bf16 v[16:31], v[84:87], v[176:179], v[16:31]
    buffer_load_dwordx4 v226, s[4:7], s41 offen sc1 lds
    buffer_load_dwordx4 v227, s[72:75], s41 offen offset:1024 sc1 lds
    s_add_u32 s60, s48, 64
    s_cmp_eq_u32 s33, 3
    s_cselect_b32 s46, s44, s47
    s_cselect_b32 s50, s60, s48
    s_cselect_b32 s51, s48, s49
    v_mfma_f32_32x32x16_bf16 v[32:47], v[80:83], v[180:183], v[32:47]
    s_sub_u32 s60, s33, 2
    s_cmp_lt_u32 s60, 2
    s_cbranch_scc0 K2_rare_105
K2_back_106:
    v_mfma_f32_32x32x16_bf16 v[48:63], v[84:87], v[180:183], v[48:63]
    s_waitcnt vmcnt(4) lgkmcnt(0)
    v_mfma_f32_32x32x16_bf16 v[0:15], v[88:91], v[184:187], v[0:15]
    ds_read_b64_tr_b16 v[176:177], v246 offset:0
    ds_read_b64_tr_b16 v[178:179], v246 offset:1024
    ds_read_b64_tr_b16 v[180:181], v247 offset:0
    ds_read_b64_tr_b16 v[182:183], v247 offset:1024
    s_mov_b32 m0, s71
    v_mfma_f32_32x32x16_bf16 v[16:31], v[92:95], v[184:187], v[16:31]
    buffer_load_dwordx4 v228, s[4:7], s41 offen sc1 lds
    buffer_load_dwordx4 v229, s[72:75], s41 offen offset:1024 sc1 lds
    v_mfma_f32_32x32x16_bf16 v[32:47], v[88:91], v[188:191], v[32:47]
    s_nop 2
    v_mul_f32 v234, v0, v96
    v_mul_f32 v236, v8, v128
    v_fmac_f32 v234, v1, v97
    v_fmac_f32 v236, v9, v129
    v_fmac_f32 v234, v2, v98
    v_fmac_f32 v236, v10, v130
    v_fmac_f32 v234, v3, v99
    v_mfma_f32_32x32x16_bf16 v[48:63], v[92:95], v[188:191], v[48:63]
    s_setprio 0
    v_fmac_f32 v236, v11, v131
    v_fmac_f32 v234, v4, v100
    v_fmac_f32 v236, v12, v132
    v_fmac_f32 v234, v5, v101
    v_fmac_f32 v236, v13, v133
    v_fmac_f32 v234, v6, v102
    v_fmac_f32 v236, v14, v134
    v_fmac_f32 v234, v7, v103
    v_fmac_f32 v236, v15, v135
    v_mul_f32 v238, v16, v128
    v_mul_f32 v240, v24, v128
    v_fmac_f32 v238, v17, v129
    v_fmac_f32 v240, v25, v129
    v_fmac_f32 v238, v18, v130
    v_fmac_f32 v240, v26, v130
    v_fmac_f32 v238, v19, v131
    v_fmac_f32 v240, v27, v131
    v_fmac_f32 v238, v20, v132
    v_fmac_f32 v240, v28, v132
    v_fmac_f32 v238, v21, v133
    v_fmac_f32 v240, v29, v133
    v_fmac_f32 v238, v22, v134
    v_fmac_f32 v240, v30, v134
    v_fmac_f32 v238, v23, v135
    v_fmac_f32 v240, v31, v135
    v_mul_f32 v235, v32, v104
    v_mul_f32 v237, v40, v136
    v_fmac_f32 v235, v33, v105
    v_fmac_f32 v237, v41, v137
    v_fmac_f32 v235, v34, v106
    v_fmac_f32 v237, v42, v138
    v_fmac_f32 v235, v35, v107
    v_fmac_f32 v237, v43, v139
    v_fmac_f32 v235, v36, v108
    v_fmac_f32 v237, v44, v140
    v_fmac_f32 v235, v37, v109
    v_fmac_f32 v237, v45, v141
    v_fmac_f32 v235, v38, v110
    v_fmac_f32 v237, v46, v142
    v_fmac_f32 v235, v39, v111
    v_fmac_f32 v237, v47, v143
    v_mul_f32 v239, v48, v136
    v_mul_f32 v241, v56, v136
    s_setprio 1
    s_waitcnt vmcnt(4) lgkmcnt(0)
    v_mfma_f32_32x32x16_bf16 v[0:15], v[64:67], v[176:179], 0
    ds_read_b64_tr_b16 v[184:185], v246 offset:2048
    ds_read_b64_tr_b16 v[186:187], v246 offset:3072
    ds_read_b64_tr_b16 v[188:189], v247 offset:2048
    ds_read_b64_tr_b16 v[190:191], v247 offset:3072
    v_fmac_f32 v239, v49, v137
    v_fmac_f32 v241, v57, v137
    s_mov_b32 m0, s68
    v_mfma_f32_32x32x16_bf16 v[16:31], v[68:71], v[176:179], 0
    buffer_load_dwordx4 v222, s[4:7], s42 offen sc1 lds
    buffer_load_dwordx4 v223, s[72:75], s42 offen offset:1024 sc1 lds
    v_fmac_f32 v239, v50, v138
    v_fmac_f32 v241, v58, v138
    v_fmac_f32 v239, v51, v139
    v_fmac_f32 v241, v59, v139
    v_fmac_f32 v239, v52, v140
    v_mfma_f32_32x32x16_bf16 v[32:47], v[64:67], v[180:183], 0
    v_fmac_f32 v241, v60, v140
    v_fmac_f32 v239, v53, v141
    v_fmac_f32 v241, v61, v141
    v_fmac_f32 v239, v54, v142
    v_fmac_f32 v241, v62, v142
    v_fmac_f32 v239, v55, v143
    v_fmac_f32 v241, v63, v143
    v_mfma_f32_32x32x16_bf16 v[48:63], v[68:71], v[180:183], 0
    v_permlane32_swap_b32 v234, v236
    v_permlane32_swap_b32 v235, v237
    v_permlane32_swap_b32 v240, v238
    s_waitcnt vmcnt(4) lgkmcnt(0)
    v_mfma_f32_32x32x16_bf16 v[0:15], v[72:75], v[184:187], v[0:15]
    ds_read_b64_tr_b16 v[176:177], v246 offset:4096
    ds_read_b64_tr_b16 v[178:179], v246 offset:5120
    ds_read_b64_tr_b16 v[180:181], v247 offset:4096
    ds_read_b64_tr_b16 v[182:183], v247 offset:5120
    v_permlane32_swap_b32 v241, v239
    s_mov_b32 m0, s69
    v_mfma_f32_32x32x16_bf16 v[16:31], v[76:79], v[184:187], v[16:31]
    buffer_load_dwordx4 v224, s[4:7], s42 offen sc1 lds
    buffer_load_dwordx4 v225, s[72:75], s42 offen offset:1024 sc1 lds
    v_lshl_add_u32 v230, v252, 1, s31
    v_add_f32 v234, v234, v236
    v_add_f32 v235, v235, v237
    v_add_f32 v240, v240, v238
    v_add_f32 v241, v241, v239
    v_mfma_f32_32x32x16_bf16 v[32:47], v[72:75], v[188:191], v[32:47]
    v_cvt_pk_bf16_f32 v234, v234, v235
    v_cvt_pk_bf16_f32 v240, v240, v241
    ds_write_b32 v230, v234 offset:0
    ds_write_b32 v230, v240 offset:256
    v_mfma_f32_32x32x16_bf16 v[48:63], v[76:79], v[188:191], v[48:63]
    s_waitcnt vmcnt(4) lgkmcnt(2)
    v_mfma_f32_32x32x16_bf16 v[0:15], v[80:83], v[176:179], v[0:15]
    ds_read_b64_tr_b16 v[184:185], v246 offset:6144
    ds_read_b64_tr_b16 v[186:187], v246 offset:7168
    ds_read_b64_tr_b16 v[188:189], v247 offset:6144
    ds_read_b64_tr_b16 v[190:191], v247 offset:7168
    s_mov_b32 m0, s70
    v_mfma_f32_32x32x16_bf16 v[16:31], v[84:87], v[176:179], v[16:31]
    buffer_load_dwordx4 v226, s[4:7], s42 offen sc1 lds
    buffer_load_dwordx4 v227, s[72:75], s42 offen offset:1024 sc1 lds
    v_mfma_f32_32x32x16_bf16 v[32:47], v[80:83], v[180:183], v[32:47]
    v_mfma_f32_32x32x16_bf16 v[48:63], v[84:87], v[180:183], v[48:63]
    s_waitcnt vmcnt(4) lgkmcnt(0)
    v_mfma_f32_32x32x16_bf16 v[0:15], v[88:91], v[184:187], v[0:15]
    ds_read_b64_tr_b16 v[176:177], v246 offset:0
    ds_read_b64_tr_b16 v[178:179], v246 offset:1024
    ds_read_b64_tr_b16 v[180:181], v247 offset:0
    ds_read_b64_tr_b16 v[182:183], v247 offset:1024
    s_mov_b32 m0, s71
    v_mfma_f32_32x32x16_bf16 v[16:31], v[92:95], v[184:187], v[16:31]
    buffer_load_dwordx4 v228, s[4:7], s42 offen sc1 lds
    buffer_load_dwordx4 v229, s[72:75], s42 offen offset:1024 sc1 lds
    v_mfma_f32_32x32x16_bf16 v[32:47], v[88:91], v[188:191], v[32:47]
    s_nop 2
    v_mul_f32 v234, v0, v144
    v_mul_f32 v236, v8, v112
    v_fmac_f32 v234, v1, v145
    v_fmac_f32 v236, v9, v113
    v_fmac_f32 v234, v2, v146
    v_fmac_f32 v236, v10, v114
    v_fmac_f32 v234, v3, v147
    v_mfma_f32_32x32x16_bf16 v[48:63], v[92:95], v[188:191], v[48:63]
    s_setprio 0
    v_fmac_f32 v236, v11, v115
    v_fmac_f32 v234, v4, v148
    v_fmac_f32 v236, v12, v116
    v_fmac_f32 v234, v5, v149
    v_fmac_f32 v236, v13, v117
    v_fmac_f32 v234, v6, v150
    v_fmac_f32 v236, v14, v118
    v_fmac_f32 v234, v7, v151
    v_fmac_f32 v236, v15, v119
    v_mul_f32 v238, v16, v160
    v_mul_f32 v240, v24, v160
    v_fmac_f32 v238, v17, v161
    v_fmac_f32 v240, v25, v161
    v_fmac_f32 v238, v18, v162
    v_fmac_f32 v240, v26, v162
    v_fmac_f32 v238, v19, v163
    v_fmac_f32 v240, v27, v163
    v_fmac_f32 v238, v20, v164
    v_fmac_f32 v240, v28, v164
    v_fmac_f32 v238, v21, v165
    v_fmac_f32 v240, v29, v165
    v_fmac_f32 v238, v22, v166
    v_fmac_f32 v240, v30, v166
    v_fmac_f32 v238, v23, v167
    v_fmac_f32 v240, v31, v167
    v_mul_f32 v235, v32, v152
    v_mul_f32 v237, v40, v120
    v_fmac_f32 v235, v33, v153
    v_fmac_f32 v237, v41, v121
    v_fmac_f32 v235, v34, v154
    v_fmac_f32 v237, v42, v122
    v_fmac_f32 v235, v35, v155
    v_fmac_f32 v237, v43, v123
    v_fmac_f32 v235, v36, v156
    v_fmac_f32 v237, v44, v124
    v_fmac_f32 v235, v37, v157
    v_fmac_f32 v237, v45, v125
    v_fmac_f32 v235, v38, v158
    v_fmac_f32 v237, v46, v126
    v_fmac_f32 v235, v39, v159
    v_fmac_f32 v237, v47, v127
    v_mul_f32 v239, v48, v168
    v_mul_f32 v241, v56, v168
    s_setprio 1
    s_waitcnt vmcnt(4) lgkmcnt(0)
    v_mfma_f32_32x32x16_bf16 v[0:15], v[64:67], v[176:179], 0
    ds_read_b64_tr_b16 v[184:185], v246 offset:2048
    ds_read_b64_tr_b16 v[186:187], v246 offset:3072
    ds_read_b64_tr_b16 v[188:189], v247 offset:2048
    ds_read_b64_tr_b16 v[190:191], v247 offset:3072
    v_fmac_f32 v239, v49, v169
    v_fmac_f32 v241, v57, v169
    s_mov_b32 m0, s68
    v_mfma_f32_32x32x16_bf16 v[16:31], v[68:71], v[176:179], 0
    buffer_load_dwordx4 v222, s[4:7], s43 offen sc1 lds
    buffer_load_dwordx4 v223, s[72:75], s43 offen offset:1024 sc1 lds
    v_fmac_f32 v239, v50, v170
    v_fmac_f32 v241, v58, v170
    v_fmac_f32 v239, v51, v171
    v_fmac_f32 v241, v59, v171
    v_fmac_f32 v239, v52, v172
    v_mfma_f32_32x32x16_bf16 v[32:47], v[64:67], v[180:183], 0
    v_fmac_f32 v241, v60, v172
    v_fmac_f32 v239, v53, v173
    v_fmac_f32 v241, v61, v173
    v_fmac_f32 v239, v54, v174
    v_fmac_f32 v241, v62, v174
    v_fmac_f32 v239, v55, v175
    v_fmac_f32 v241, v63, v175
    v_mfma_f32_32x32x16_bf16 v[48:63], v[68:71], v[180:183], 0
    s_waitcnt vmcnt(4) lgkmcnt(0)
    v_mfma_f32_32x32x16_bf16 v[0:15], v[72:75], v[184:187], v[0:15]
    ds_read_b64_tr_b16 v[176:177], v246 offset:4096
    ds_read_b64_tr_b16 v[178:179], v246 offset:5120
    ds_read_b64_tr_b16 v[180:181], v247 offset:4096
    ds_read_b64_tr_b16 v[182:183], v247 offset:5120
    s_mov_b32 m0, s69
    v_mfma_f32_32x32x16_bf16 v[16:31], v[76:79], v[184:187], v[16:31]
    buffer_load_dwordx4 v224, s[4:7], s43 offen sc1 lds
    buffer_load_dwordx4 v225, s[72:75], s43 offen offset:1024 sc1 lds
    v_mfma_f32_32x32x16_bf16 v[32:47], v[72:75], v[188:191], v[32:47]
    v_mfma_f32_32x32x16_bf16 v[48:63], v[76:79], v[188:191], v[48:63]
    s_waitcnt vmcnt(4) lgkmcnt(0)
    v_mfma_f32_32x32x16_bf16 v[0:15], v[80:83], v[176:179], v[0:15]
    ds_read_b64_tr_b16 v[184:185], v246 offset:6144
    ds_read_b64_tr_b16 v[186:187], v246 offset:7168
    ds_read_b64_tr_b16 v[188:189], v247 offset:6144
    ds_read_b64_tr_b16 v[190:191], v247 offset:7168
    s_mov_b32 m0, s70
    v_mfma_f32_32x32x16_bf16 v[16:31], v[84:87], v[176:179], v[16:31]
    buffer_load_dwordx4 v226, s[4:7], s43 offen sc1 lds
    buffer_load_dwordx4 v227, s[72:75], s43 offen offset:1024 sc1 lds
    v_mfma_f32_32x32x16_bf16 v[32:47], v[80:83], v[180:183], v[32:47]
    v_add_u32 v222, s48, v251
    ds_read_b32 v222, v222
    v_mfma_f32_32x32x16_bf16 v[48:63], v[84:87], v[180:183], v[48:63]
    s_waitcnt vmcnt(4) lgkmcnt(1)
    v_mfma_f32_32x32x16_bf16 v[0:15], v[88:91], v[184:187], v[0:15]
    ds_read_b64_tr_b16 v[176:177], v246 offset:0
    ds_read_b64_tr_b16 v[178:179], v246 offset:1024
    ds_read_b64_tr_b16 v[180:181], v247 offset:0
    ds_read_b64_tr_b16 v[182:183], v247 offset:1024
    s_mov_b32 m0, s71
    v_mfma_f32_32x32x16_bf16 v[16:31], v[92:95], v[184:187], v[16:31]
    buffer_load_dwordx4 v228, s[4:7], s43 offen sc1 lds
    buffer_load_dwordx4 v229, s[72:75], s43 offen offset:1024 sc1 lds
    s_waitcnt lgkmcnt(4)
    v_mad_u32_u16 v223, v222, s39, v248 op_sel:[1,0,0,0]
    v_mad_u32_u16 v222, v222, s39, v248
    v_mfma_f32_32x32x16_bf16 v[32:47], v[88:91], v[188:191], v[32:47]
    v_add_u32 v224, s49, v251
    ds_read_b32 v224, v224
    v_mul_f32 v242, v0, v144
    v_fma_f32 v238, v8, v160, -v238
    v_fmac_f32 v242, v1, v145
    v_fmac_f32 v238, v9, v161
    v_fmac_f32 v242, v2, v146
    v_mfma_f32_32x32x16_bf16 v[48:63], v[92:95], v[188:191], v[48:63]
    s_setprio 0
    v_fmac_f32 v238, v10, v162
    v_fmac_f32 v242, v3, v147
    v_fmac_f32 v238, v11, v163
    v_fmac_f32 v242, v4, v148
    v_fmac_f32 v238, v12, v164
    v_fmac_f32 v242, v5, v149
    v_fmac_f32 v238, v13, v165
    v_fmac_f32 v242, v6, v150
    v_fmac_f32 v238, v14, v166
    v_fmac_f32 v242, v7, v151
    v_fmac_f32 v238, v15, v167
    v_fmac_f32 v236, v16, v112
    v_mul_f32 v244, v24, v160
    v_fmac_f32 v236, v17, v113
    v_fmac_f32 v244, v25, v161
    v_fmac_f32 v236, v18, v114
    v_fmac_f32 v244, v26, v162
    v_fmac_f32 v236, v19, v115
    v_fmac_f32 v244, v27, v163
    v_fmac_f32 v236, v20, v116
    v_fmac_f32 v244, v28, v164
    v_fmac_f32 v236, v21, v117
    v_fmac_f32 v244, v29, v165
    v_fmac_f32 v236, v22, v118
    v_fmac_f32 v244, v30, v166
    v_fmac_f32 v236, v23, v119
    v_fmac_f32 v244, v31, v167
    v_mul_f32 v243, v32, v152
    v_fma_f32 v239, v40, v168, -v239
    v_fmac_f32 v243, v33, v153
    v_fmac_f32 v239, v41, v169
    v_fmac_f32 v243, v34, v154
    v_fmac_f32 v239, v42, v170
    v_fmac_f32 v243, v35, v155
    v_fmac_f32 v239, v43, v171
    v_fmac_f32 v243, v36, v156
    v_fmac_f32 v239, v44, v172
    v_fmac_f32 v243, v37, v157
    v_fmac_f32 v239, v45, v173
    v_fmac_f32 v243, v38, v158
    v_fmac_f32 v239, v46, v174
    v_fmac_f32 v243, v39, v159
    v_fmac_f32 v239, v47, v175
    v_fmac_f32 v237, v48, v120
    v_mul_f32 v245, v56, v168
    v_fmac_f32 v237, v49, v121
    v_fmac_f32 v245, v57, v169
    v_fmac_f32 v237, v50, v122
    v_fmac_f32 v245, v58, v170
    v_fmac_f32 v237, v51, v123
    s_setprio 1
    s_waitcnt vmcnt(4) lgkmcnt(1)
    v_mfma_f32_32x32x16_bf16 v[0:15], v[64:67], v[176:179], 0
    ds_read_b64_tr_b16 v[184:185], v246 offset:2048
    ds_read_b64_tr_b16 v[186:187], v246 offset:3072
    ds_read_b64_tr_b16 v[188:189], v247 offset:2048
    ds_read_b64_tr_b16 v[190:191], v247 offset:3072
    v_fmac_f32 v245, v59, v171
    v_fmac_f32 v237, v52, v124
    s_mov_b32 m0, s68
    v_mfma_f32_32x32x16_bf16 v[16:31], v[68:71], v[176:179], 0
    buffer_load_dwordx4 v222, s[4:7], s44 offen sc1 lds
    buffer_load_dwordx4 v223, s[72:75], s44 offen offset:1024 sc1 lds
    s_waitcnt lgkmcnt(4)
    v_mad_u32_u16 v225, v224, s39, v248 op_sel:[1,0,0,0]
    v_mad_u32_u16 v224, v224, s39, v248
    v_fmac_f32 v245, v60, v172
    v_fmac_f32 v237, v53, v125
    v_mfma_f32_32x32x16_bf16 v[32:47], v[64:67], v[180:183], 0
    v_add_u32 v226, s50, v251
    ds_read_b32 v226, v226
    v_fmac_f32 v245, v61, v173
    v_fmac_f32 v237, v54, v126
    v_fmac_f32 v245, v62, v174
    v_fmac_f32 v237, v55, v127
    v_fmac_f32 v245, v63, v175
    v_mfma_f32_32x32x16_bf16 v[48:63], v[68:71], v[180:183], 0
    v_permlane32_swap_b32 v242, v234
    v_permlane32_swap_b32 v243, v235
    v_add_f32 v242, v242, v234
    v_add_f32 v243, v243, v235
    s_waitcnt vmcnt(4) lgkmcnt(1)
    v_mfma_f32_32x32x16_bf16 v[0:15], v[72:75], v[184:187], v[0:15]
    ds_read_b64_tr_b16 v[176:177], v246 offset:4096
    ds_read_b64_tr_b16 v[178:179], v246 offset:5120
    ds_read_b64_tr_b16 v[180:181], v247 offset:4096
    ds_read_b64_tr_b16 v[182:183], v247 offset:5120
    v_cvt_pk_bf16_f32 v242, v242, v243
    ds_write_b32 v230, v242 offset:512
    s_mov_b32 m0, s69
    v_mfma_f32_32x32x16_bf16 v[16:31], v[76:79], v[184:187], v[16:31]
    buffer_load_dwordx4 v224, s[4:7], s45 offen sc1 lds
    buffer_load_dwordx4 v225, s[72:75], s45 offen offset:1024 sc1 lds
    s_waitcnt lgkmcnt(5)
    v_mad_u32_u16 v227, v226, s39, v248 op_sel:[1,0,0,0]
    v_mad_u32_u16 v226, v226, s39, v248
    v_mfma_f32_32x32x16_bf16 v[32:47], v[72:75], v[188:191], v[32:47]
    v_add_u32 v228, s51, v251
    ds_read_b32 v228, v228
    v_mfma_f32_32x32x16_bf16 v[48:63], v[76:79], v[188:191], v[48:63]
    s_waitcnt vmcnt(4) lgkmcnt(2)
    v_mfma_f32_32x32x16_bf16 v[0:15], v[80:83], v[176:179], v[0:15]
    ds_read_b64_tr_b16 v[184:185], v246 offset:6144
    ds_read_b64_tr_b16 v[186:187], v246 offset:7168
    ds_read_b64_tr_b16 v[188:189], v247 offset:6144
    ds_read_b64_tr_b16 v[190:191], v247 offset:7168
    s_mov_b32 s32, s31
    s_mov_b32 s31, s35
    s_mov_b32 m0, s70
    v_mfma_f32_32x32x16_bf16 v[16:31], v[84:87], v[176:179], v[16:31]
    buffer_load_dwordx4 v226, s[4:7], s46 offen sc1 lds
    buffer_load_dwordx4 v227, s[72:75], s46 offen offset:1024 sc1 lds
    s_waitcnt lgkmcnt(4)
    v_mad_u32_u16 v229, v228, s39, v248 op_sel:[1,0,0,0]
    v_mad_u32_u16 v228, v228, s39, v248
    s_sub_u32 s26, s48, s29
    s_mov_b32 s29, s48
    v_mfma_f32_32x32x16_bf16 v[32:47], v[80:83], v[180:183], v[32:47]
    s_mov_b32 s30, s3
    s_bfe_u32 s56, s3, 0x40012
    s_cmp_lg_u32 s36, 0
    s_cselect_b32 s56, s56, 0
    v_mfma_f32_32x32x16_bf16 v[48:63], v[84:87], v[180:183], v[48:63]
    s_waitcnt vmcnt(4) lgkmcnt(0)
    v_mfma_f32_32x32x16_bf16 v[0:15], v[88:91], v[184:187], v[0:15]
    ds_read_b64_tr_b16 v[176:177], v246 offset:0
    ds_read_b64_tr_b16 v[178:179], v246 offset:1024
    ds_read_b64_tr_b16 v[180:181], v247 offset:0
    ds_read_b64_tr_b16 v[182:183], v247 offset:1024
    s_mov_b32 m0, s71
    v_mfma_f32_32x32x16_bf16 v[16:31], v[92:95], v[184:187], v[16:31]
    buffer_load_dwordx4 v228, s[4:7], s47 offen sc1 lds
    buffer_load_dwordx4 v229, s[72:75], s47 offen offset:1024 sc1 lds
    v_mfma_f32_32x32x16_bf16 v[32:47], v[88:91], v[188:191], v[32:47]
    s_nop 2
    v_mul_f32 v242, v0, v144
    v_fma_f32 v240, v8, v160, -v240
    v_fmac_f32 v242, v1, v145
    v_fmac_f32 v240, v9, v161
    v_fmac_f32 v242, v2, v146
    v_fmac_f32 v240, v10, v162
    v_fmac_f32 v242, v3, v147
    v_mfma_f32_32x32x16_bf16 v[48:63], v[92:95], v[188:191], v[48:63]
    s_setprio 0
    v_fmac_f32 v240, v11, v163
    v_fmac_f32 v242, v4, v148
    v_fmac_f32 v240, v12, v164
    v_fmac_f32 v242, v5, v149
    v_fmac_f32 v240, v13, v165
    v_fmac_f32 v242, v6, v150
    v_fmac_f32 v240, v14, v166
    v_fmac_f32 v242, v7, v151
    v_fmac_f32 v240, v15, v167
    v_add_u32 v249, s26, v249
    v_add_u32 v250, s26, v250
    v_fma_f32 v244, v16, v160, -v244
    v_fmac_f32 v236, v24, v112
    v_fmac_f32 v244, v17, v161
    v_fmac_f32 v236, v25, v113
    v_fmac_f32 v244, v18, v162
    v_fmac_f32 v236, v26, v114
    v_fmac_f32 v244, v19, v163
    v_fmac_f32 v236, v27, v115
    v_fmac_f32 v244, v20, v164
    v_fmac_f32 v236, v28, v116
    v_fmac_f32 v244, v21, v165
    v_fmac_f32 v236, v29, v117
    v_fmac_f32 v244, v22, v166
    v_fmac_f32 v236, v30, v118
    v_fmac_f32 v244, v23, v167
    v_fmac_f32 v236, v31, v119
    ds_read_b64_tr_b16 v[0:1], v249 offset:0
    ds_read_b64_tr_b16 v[2:3], v249 offset:32
    ds_read_u16_d16_hi v16, v250 offset:0
    v_mul_f32 v243, v32, v152
    v_fma_f32 v241, v40, v168, -v241
    v_fmac_f32 v243, v33, v153
    v_fmac_f32 v241, v41, v169
    v_fmac_f32 v243, v34, v154
    v_fmac_f32 v241, v42, v170
    v_fmac_f32 v243, v35, v155
    v_fmac_f32 v241, v43, v171
    v_fmac_f32 v243, v36, v156
    v_fmac_f32 v241, v44, v172
    v_fmac_f32 v243, v37, v157
    v_fmac_f32 v241, v45, v173
    v_fmac_f32 v243, v38, v158
    v_fmac_f32 v241, v46, v174
    v_fmac_f32 v243, v39, v159
    v_fmac_f32 v241, v47, v175
    ds_read_b64_tr_b16 v[4:5], v249 offset:512
    ds_read_b64_tr_b16 v[6:7], v249 offset:544
    ds_read_u16_d16_hi v17, v250 offset:32
    v_fma_f32 v245, v48, v168, -v245
    v_fmac_f32 v237, v56, v120
    v_fmac_f32 v245, v49, v169
    v_fmac_f32 v237, v57, v121
    v_fmac_f32 v245, v50, v170
    v_fmac_f32 v237, v58, v122
    v_fmac_f32 v245, v51, v171
    v_fmac_f32 v237, v59, v123
    v_fmac_f32 v245, v52, v172
    v_fmac_f32 v237, v60, v124
    v_fmac_f32 v245, v53, v173
    v_fmac_f32 v237, v61, v125
    v_fmac_f32 v245, v54, v174
    v_fmac_f32 v237, v62, v126
    v_fmac_f32 v245, v55, v175
    v_fmac_f32 v237, v63, v127
    s_cmp_eq_u32 s56, 5
    s_cbranch_scc1 K2_U21
    s_cmp_eq_u32 s56, 6
    s_cbranch_scc1 K2_U3h1
    s_branch K2_DSP1
K2_FLGR:
    s_sub_u32 s27, s27, 16
    s_cbranch_scc1 K2_END
    buffer_load_dwordx4 v[56:59], v60, s[8:11], s64 offen sc1
    s_branch K2_FLGW
K2_FLGY:
    v_mov_b32 v56, s2
    v_mov_b32 v57, 7178240
    s_mov_b64 exec, 1
    buffer_store_dword v56, v57, s[8:11], 0 offen sc1
    s_mov_b64 exec, -1
    s_branch K2_FLGOK
K2_nul_70:
    s_mov_b32 s58, 63
    s_mov_b32 s36, 0
    s_branch K2_back_73
K2_spin_71:
    s_sub_u32 s27, s27, 1
    s_cbranch_scc1 K2_END
    v_lshl_add_u32 v233, v252, 1, s53
    ds_read_b32 v233, v233
    s_waitcnt lgkmcnt(0)
    s_branch K2_chk_72
K2_dyn_68:
    v_mov_b32 v254, 163296
    v_mov_b32 v255, 1
    v_lshl_add_u32 v233, v252, 1, s53
    s_mov_b64 exec, 1
    ds_add_rtn_u32 v232, v254, v255
    s_mov_b64 exec, -1
    ds_read_b32 v233, v233
    s_waitcnt lgkmcnt(0)
    v_readfirstlane_b32 s58, v232
    s_nop 0
    s_cmp_lt_u32 s58, s22
    s_cbranch_scc0 K2_nul_70
    s_and_b32 s59, s58, 7
    s_lshr_b32 s60, s58, 3
K2_chk_72:
    v_readlane_b32 s61, v233, s59
    s_nop 0
    s_cmp_gt_u32 s61, s60
    s_cbranch_scc0 K2_spin_71
K2_back_73:
    s_mov_b32 s34, 1
    s_branch K2_back_69
K2_rare_74:
    s_cmp_eq_u32 s33, 4
    s_cbranch_scc1 K2_four_76
    s_mov_b32 s49, s48
    s_mov_b32 s51, s48
    s_add_u32 s45, s44, 256
    s_add_u32 s46, s44, 512
    s_add_u32 s47, s44, 768
    s_branch K2_back_75
K2_four_76:
    s_add_u32 s50, s48, 64
    s_add_u32 s51, s48, 96
    s_mov_b32 s46, s44
    s_mov_b32 s47, s44
    s_branch K2_back_75
K2_dum_77:
    v_mov_b32 v232, -1
    s_mov_b32 m0, 163360
    s_mov_b64 exec, 1
    buffer_load_dwordx4 v232, s[16:19], 0 offen lds
    buffer_load_dwordx4 v232, s[16:19], 0 offen lds
    s_mov_b64 exec, -1
    s_branch K2_back_79
K2_a4_78:
    v_add_u32 v254, s48, v230
    ds_read_b32 v254, v254 offset:4
    s_lshr_b32 s65, s3, 27
    s_mul_i32 s66, s22, 2080
    s_lshl_b32 s65, s65, 9
    s_add_u32 s65, s65, s66
    s_add_u32 s65, s65, 65536
    s_mov_b32 m0, s65
    s_mov_b32 exec_hi, 0
    s_waitcnt lgkmcnt(0)
    v_or_b32 v254, v254, v231
    buffer_load_dwordx4 v254, s[16:19], 0 offen  lds
    s_mov_b32 exec_hi, -1
    s_branch K2_b4_80
K2_nul_83:
    s_mov_b32 s58, 63
    s_mov_b32 s36, 0
    s_branch K2_back_86
K2_spin_84:
    s_sub_u32 s27, s27, 1
    s_cbranch_scc1 K2_END
    v_lshl_add_u32 v233, v252, 1, s53
    ds_read_b32 v233, v233
    s_waitcnt lgkmcnt(0)
    s_branch K2_chk_85
K2_dyn_81:
    v_mov_b32 v254, 163296
    v_mov_b32 v255, 1
    v_lshl_add_u32 v233, v252, 1, s53
    s_mov_b64 exec, 1
    ds_add_rtn_u32 v232, v254, v255
    s_mov_b64 exec, -1
    ds_read_b32 v233, v233
    s_waitcnt lgkmcnt(0)
    v_readfirstlane_b32 s58, v232
    s_nop 0
    s_cmp_lt_u32 s58, s22
    s_cbranch_scc0 K2_nul_83
    s_and_b32 s59, s58, 7
    s_lshr_b32 s60, s58, 3
K2_chk_85:
    v_readlane_b32 s61, v233, s59
    s_nop 0
    s_cmp_gt_u32 s61, s60
    s_cbranch_scc0 K2_spin_84
K2_back_86:
    s_mov_b32 s34, 1
    s_branch K2_back_82
K2_rare_87:
    s_cmp_eq_u32 s33, 4
    s_cbranch_scc1 K2_four_89
    s_mov_b32 s49, s48
    s_mov_b32 s51, s48
    s_add_u32 s45, s44, 256
    s_add_u32 s46, s44, 512
    s_add_u32 s47, s44, 768
    s_branch K2_back_88
K2_four_89:
    s_add_u32 s50, s48, 64
    s_add_u32 s51, s48, 96
    s_mov_b32 s46, s44
    s_mov_b32 s47, s44
    s_branch K2_back_88
K2_dum_90:
    v_mov_b32 v232, -1
    s_mov_b32 m0, 163360
    s_mov_b64 exec, 1
    buffer_load_dwordx4 v232, s[16:19], 0 offen lds
    buffer_load_dwordx4 v232, s[16:19], 0 offen lds
    s_mov_b64 exec, -1
    s_branch K2_back_92
K2_a4_91:
    v_add_u32 v254, s48, v230
    ds_read_b32 v254, v254 offset:4
    s_lshr_b32 s65, s3, 27
    s_mul_i32 s66, s22, 2080
    s_lshl_b32 s65, s65, 9
    s_add_u32 s65, s65, s66
    s_add_u32 s65, s65, 65536
    s_mov_b32 m0, s65
    s_mov_b32 exec_hi, 0
    s_waitcnt lgkmcnt(0)
    v_or_b32 v254, v254, v231
    buffer_load_dwordx4 v254, s[16:19], 0 offen  lds
    s_mov_b32 exec_hi, -1
    s_branch K2_b4_93
K2_nul_94:
    s_mov_b32 s58, 63
    s_mov_b32 s36, 0
    s_branch K2_back_97
K2_spin_95:
    s_sub_u32 s27, s27, 1
    s_cbranch_scc1 K2_END
    v_lshl_add_u32 v233, v252, 1, s53
    ds_read_b32 v233, v233
    s_waitcnt lgkmcnt(0)
    s_branch K2_chk_96
K2_rare_98:
    s_cmp_eq_u32 s33, 4
    s_cbranch_scc1 K2_four_100
    s_mov_b32 s49, s48
    s_mov_b32 s51, s48
    s_add_u32 s45, s44, 256
    s_add_u32 s46, s44, 512
    s_add_u32 s47, s44, 768
    s_branch K2_back_99
K2_four_100:
    s_add_u32 s50, s48, 64
    s_add_u32 s51, s48, 96
    s_mov_b32 s46, s44
    s_mov_b32 s47, s44
    s_branch K2_back_99
K2_nul_101:
    s_mov_b32 s58, 63
    s_mov_b32 s36, 0
    s_branch K2_back_104
K2_spin_102:
    s_sub_u32 s27, s27, 1
    s_cbranch_scc1 K2_END
    v_lshl_add_u32 v233, v252, 1, s53
    ds_read_b32 v233, v233
    s_waitcnt lgkmcnt(0)
    s_branch K2_chk_103
K2_rare_105:
    s_cmp_eq_u32 s33, 4
    s_cbranch_scc1 K2_four_107
    s_mov_b32 s49, s48
    s_mov_b32 s51, s48
    s_add_u32 s45, s44, 256
    s_add_u32 s46, s44, 512
    s_add_u32 s47, s44, 768
    s_branch K2_back_106
K2_four_107:
    s_add_u32 s50, s48, 64
    s_add_u32 s51, s48, 96
    s_mov_b32 s46, s44
    s_mov_b32 s47, s44
    s_branch K2_back_106
K2_END:
    s_endpgm
.section .rodata,"a"
.p2align 6
.amdhsa_kernel standalone__tensor_product_equiv_equiformer__graph_kernel
  .amdhsa_next_free_vgpr 256
  .amdhsa_next_free_sgpr 102
  .amdhsa_accum_offset 256
  .amdhsa_group_segment_fixed_size 0
  .amdhsa_kernarg_size 96
  .amdhsa_user_sgpr_count 2
  .amdhsa_user_sgpr_kernarg_segment_ptr 1
  .amdhsa_system_sgpr_workgroup_id_x 1
  .amdhsa_float_denorm_mode_32 3
.end_amdhsa_kernel
```

```asm
; @launch grid=(256,1,1) block=(512,1,1) lds=163840
.amdgcn_target "amdgcn-amd-amdhsa--gfx950"
.text
.globl standalone__tensor_product_equiv_equiformer__graph_kernel
.p2align 8
.type standalone__tensor_product_equiv_equiformer__graph_kernel,@function
standalone__tensor_product_equiv_equiformer__graph_kernel:
    s_cmp_ge_u32 s2, 256
    s_cbranch_scc1 K2_END
    s_load_dwordx16 s[80:95], s[0:1], 0
    s_load_dwordx4 s[96:99], s[0:1], 72
    s_load_dwordx2 s[100:101], s[0:1], 88
    v_lshrrev_b32 v1, 6, v0
    s_mov_b32 s54, s2
    v_readfirstlane_b32 s20, v1
    s_mov_b64 exec, 0
    s_cmp_eq_u32 s20, 0
    s_cbranch_scc1 K2_PAD_S1
    s_cmp_eq_u32 s20, 1
    s_cbranch_scc1 K2_PAD_S2
    s_cmp_eq_u32 s20, 5
    s_cbranch_scc1 K2_PAD_H1
    s_cmp_eq_u32 s20, 6
    s_cbranch_scc1 K2_PAD_H2
    s_cmp_eq_u32 s20, 2
    s_cbranch_scc1 K2_PAD_H3
KS_HOP0:
    s_mov_b64 exec, -1
    v_and_b32 v8, 63, v0
    v_lshlrev_b32 v9, 4, v8
    v_mov_b32 v6, 0
    v_lshlrev_b32 v5, 4, v0
    v_mul_u32_u24 v4, 24, v0
    s_mul_i32 s64, s2, 5120
    s_mul_i32 s65, s2, 7680
    v_mov_b32 v176, v8
    v_mov_b32 v177, v0
    s_mul_i32 s21, s2, 625
    s_add_u32 s22, s21, 640
    s_add_u32 s21, s21, 15
    s_lshr_b32 s21, s21, 4
    s_lshr_b32 s22, s22, 4
    s_sub_u32 s22, s22, s21
    s_movk_i32 s39, 1024
    s_lshl_b32 s37, s20, 13
    s_mov_b32 s53, 163264
    s_lshl_b32 s52, s20, 2
    s_add_u32 s52, s52, s53
    s_add_u32 s68, s37, 0
    s_add_u32 s69, s37, 2048
    s_add_u32 s70, s37, 4096
    s_add_u32 s71, s37, 6144
    s_waitcnt lgkmcnt(0)
    s_mov_b32 s8, s100
    s_and_b32 s9, s101, 0xffff
    s_mov_b32 s10, 37748736
    s_mov_b32 s11, 0x20000
    s_cmp_lg_u32 s20, 7
    s_cbranch_scc1 KS_NOTAG
    s_mov_b32 s24, 7178240
    s_mov_b64 exec, 1
    buffer_load_dword v14, v6, s[8:11], s24 offen sc1
    s_mov_b64 exec, -1
    s_barrier
    v_mov_b32 v76, 0
    v_mov_b32 v77, -1
    v_lshlrev_b32 v78, 2, v8
    v_add_u32 v78, 163072, v78
    s_mov_b64 exec, 0x1ff
    ds_write_b32 v78, v76 offset:192
    s_mov_b32 exec_lo, -1
    ds_write_b32 v78, v77 offset:256
    s_mov_b64 exec, -1
    s_mov_b32 exec_hi, 0xffff
    ds_write_b32 v78, v76
    s_mov_b64 exec, 1
    ds_write_b32 v78, v76 offset:228
    s_mov_b64 exec, -1
    s_mov_b64 exec, 1
    v_mov_b32 v12, 163456
    s_mov_b32 s24, 1664525
    s_waitcnt vmcnt(0)
    v_mul_lo_u32 v14, v14, s24
    v_add_u32 v14, 1013904223, v14
    ds_write_b32 v12, v14
KS_TAGOK2:
    s_mov_b64 exec, -1
    s_waitcnt lgkmcnt(0)
    s_barrier
    s_branch KS_B3
KS_H0:
    s_barrier
    s_branch KS_HELP
K2_PAD_S1:
    s_branch KS_HOP0
KS_NOTAG:
    s_cmp_ge_u32 s20, 5
    s_cbranch_scc1 KS_HELP
    s_cmp_ge_u32 s2, 250
    s_cbranch_scc1 KS_IDLE
    s_mov_b32 s40, s88
    s_and_b32 s41, s89, 0xffff
    s_mov_b32 s42, 1280000
    s_mov_b32 s43, 0x20000
    buffer_load_dwordx4 v[12:15], v5, s[40:43], s64 offen
    s_mov_b32 s44, s86
    s_and_b32 s45, s87, 0xffff
    s_mov_b32 s46, 1280000
    s_mov_b32 s47, 0x20000
    s_mov_b32 s48, s82
    s_and_b32 s49, s83, 0xffff
    s_mov_b32 s50, 1920000
    s_mov_b32 s51, 0x20000
    buffer_load_dwordx4 v[16:19], v5, s[44:47], s64 offen
    buffer_load_dwordx4 v[20:23], v4, s[48:51], s65 offen
    buffer_load_dwordx2 v[24:25], v4, s[48:51], s65 offen offset:16
    v_lshlrev_b32 v2, 2, v0
    s_lshl_b32 s64, s64, 3
    v_lshl_add_u32 v3, v0, 7, s64
    v_mov_b32 v7, 1
    s_cmp_eq_u32 s20, 4
    s_cbranch_scc1 KS_NOCLR
    ds_write_b32 v2, v6
KS_NOCLR:
    s_waitcnt lgkmcnt(0)
    s_barrier
    s_mov_b64 exec, 0
    s_cmp_eq_u32 s20, 0
    s_cbranch_scc1 K2_PAD_B3
    s_cmp_eq_u32 s20, 1
    s_cbranch_scc1 K2_PAD_LD
    s_cmp_eq_u32 s20, 2
    s_cbranch_scc1 K2_PAD_NW
    s_cmp_eq_u32 s20, 3
    s_cbranch_scc1 K2_PAD_SC
    s_cmp_eq_u32 s20, 4
    s_cbranch_scc1 K2_PAD_SD
KS_HOP:
    s_mov_b64 exec, -1
    s_mov_b32 s58, 429497
    s_movk_i32 s59, 625
    s_waitcnt vmcnt(3)
    v_mul_u32_u24 v28, s58, v12
    v_lshrrev_b32 v32, 27, v28
    v_bfe_u32 v36, v28, 24, 3
    v_lshlrev_b32 v32, 2, v32
    v_lshl_or_b32 v32, v36, 7, v32
    ds_add_rtn_u32 v36, v32, v7
    v_mul_u32_u24 v29, s58, v13
    v_lshrrev_b32 v33, 27, v29
    v_bfe_u32 v37, v29, 24, 3
    v_lshlrev_b32 v33, 2, v33
    v_lshl_or_b32 v33, v37, 7, v33
    ds_add_rtn_u32 v37, v33, v7
    v_mul_u32_u24 v30, s58, v14
    v_lshrrev_b32 v34, 27, v30
    v_bfe_u32 v38, v30, 24, 3
    v_lshlrev_b32 v34, 2, v34
    v_lshl_or_b32 v34, v38, 7, v34
    ds_add_rtn_u32 v38, v34, v7
    v_mul_u32_u24 v31, s58, v15
    v_lshrrev_b32 v35, 27, v31
    v_bfe_u32 v39, v31, 24, 3
    v_lshlrev_b32 v35, 2, v35
    v_lshl_or_b32 v35, v39, 7, v35
    ds_add_rtn_u32 v39, v35, v7
    v_lshrrev_b32 v28, 24, v28
    v_mad_u32_u24 v28, v28, s59, 15
    v_lshrrev_b32 v28, 4, v28
    v_sub_u32 v28, v12, v28
    v_add_u32 v12, 0, v3
    v_lshl_or_b32 v28, v28, 26, v12
    v_lshrrev_b32 v29, 24, v29
    v_mad_u32_u24 v29, v29, s59, 15
    v_lshrrev_b32 v29, 4, v29
    v_sub_u32 v29, v13, v29
    v_add_u32 v13, 32, v3
    v_lshl_or_b32 v29, v29, 26, v13
    v_lshrrev_b32 v30, 24, v30
    v_mad_u32_u24 v30, v30, s59, 15
    v_lshrrev_b32 v30, 4, v30
    v_sub_u32 v30, v14, v30
    v_add_u32 v14, 64, v3
    v_lshl_or_b32 v30, v30, 26, v14
    v_lshrrev_b32 v31, 24, v31
    v_mad_u32_u24 v31, v31, s59, 15
    v_lshrrev_b32 v31, 4, v31
    v_sub_u32 v31, v15, v31
    v_add_u32 v15, 96, v3
    v_lshl_or_b32 v31, v31, 26, v15
K2_PAD_S2:
    s_cbranch_execz KS_HOP0
    v_mov_b32 v59, 163456
    s_mul_i32 s65, s2, 1152
    s_add_u32 s65, s65, 6291456
    s_mul_i32 s64, s2, 20608
    s_waitcnt lgkmcnt(0)
    s_barrier
    ds_read_b128 v[40:43], v9
    ds_read_b32 v59, v59
    s_waitcnt lgkmcnt(1)
    v_add_u32 v45, v40, v41
    v_add_u32 v46, v45, v42
    v_add_u32 v47, v46, v43
    v_mov_b32 v58, v47
    s_nop 1
    v_add_u32_dpp v58, v58, v58 row_shr:1 row_mask:0xf bank_mask:0xf bound_ctrl:0
    s_nop 1
    v_add_u32_dpp v58, v58, v58 row_shr:2 row_mask:0xf bank_mask:0xf bound_ctrl:0
    s_nop 1
    v_add_u32_dpp v58, v58, v58 row_shr:4 row_mask:0xf bank_mask:0xf bound_ctrl:0
    s_nop 1
    v_add_u32_dpp v58, v58, v58 row_shr:8 row_mask:0xf bank_mask:0xf bound_ctrl:0
    s_nop 1
    v_add_u32_dpp v58, v58, v58 row_bcast:15 row_mask:0xa bank_mask:0xf
    s_nop 1
    v_add_u32_dpp v58, v58, v58 row_bcast:31 row_mask:0xc bank_mask:0xf
    v_sub_u32 v48, v58, v47
    v_add_u32 v49, v48, v40
    v_add_u32 v50, v48, v45
    v_add_u32 v51, v48, v46
    ds_write_b128 v9, v[48:51] offset:1024
    s_waitcnt vmcnt(0) lgkmcnt(1)
    s_cmp_lg_u32 s20, 4
    s_cbranch_scc1 KS_NOPUB
    v_lshl_or_b32 v56, v49, 11, v48
    v_lshl_or_b32 v57, v51, 11, v50
    v_lshl_or_b32 v56, v59, 22, v56
    v_lshl_or_b32 v57, v59, 22, v57
    buffer_store_dwordx4 v[56:59], v9, s[8:11], s65 offen sc1
KS_NOPUB:
    s_waitcnt lgkmcnt(0)
    ds_read_b32 v32, v32 offset:1024
    ds_read_b32 v33, v33 offset:1024
    ds_read_b32 v34, v34 offset:1024
    ds_read_b32 v35, v35 offset:1024
    v_and_b32 v60, 0xffff, v59
    v_and_b32 v61, 0xffff0000, v59
    s_mov_b32 s58, 0xffff0000
    v_mov_b32 v40, v20
    v_lshl_or_b32 v41, v21, 16, v60
    v_or_b32 v42, v61, v16
    v_mov_b32 v43, v28
    v_alignbit_b32 v44, v22, v21, 16
    v_and_or_b32 v45, v22, s58, v60
    v_or_b32 v46, v61, v17
    v_mov_b32 v47, v29
    v_mov_b32 v48, v23
    v_lshl_or_b32 v49, v24, 16, v60
    v_or_b32 v50, v61, v18
    v_mov_b32 v51, v30
    v_alignbit_b32 v52, v25, v24, 16
    v_and_or_b32 v53, v25, s58, v60
    v_or_b32 v54, v61, v19
    v_mov_b32 v55, v31
    s_waitcnt lgkmcnt(0)
    v_add_lshl_u32 v32, v32, v36, 4
    ds_write_b128 v32, v[40:43] offset:2048
    v_add_lshl_u32 v33, v33, v37, 4
    ds_write_b128 v33, v[44:47] offset:2048
    v_add_lshl_u32 v34, v34, v38, 4
    ds_write_b128 v34, v[48:51] offset:2048
    v_add_lshl_u32 v35, v35, v39, 4
    ds_write_b128 v35, v[52:55] offset:2048
    s_waitcnt lgkmcnt(0)
    s_barrier
    ds_read_b128 v[12:15], v5 offset:2048
    ds_read_b128 v[16:19], v5 offset:7168
    ds_read_b128 v[20:23], v5 offset:12288
    ds_read_b128 v[24:27], v5 offset:17408
    s_waitcnt lgkmcnt(3)
    buffer_store_dwordx4 v[12:15], v5, s[8:11], s64 offen sc1
    s_add_u32 s64, s64, 5120
    s_waitcnt lgkmcnt(2)
    buffer_store_dwordx4 v[16:19], v5, s[8:11], s64 offen sc1
    s_add_u32 s64, s64, 5120
    s_waitcnt lgkmcnt(1)
    buffer_store_dwordx4 v[20:23], v5, s[8:11], s64 offen sc1
    s_add_u32 s64, s64, 5120
    s_waitcnt lgkmcnt(0)
    buffer_store_dwordx4 v[24:27], v5, s[8:11], s64 offen sc1
    s_branch KS_JOIN
K2_PAD_B3:
    s_branch KS_HOP
KS_B3:
    v_mov_b32 v59, 163456
    ds_read_b32 v59, v59
    s_waitcnt lgkmcnt(0)
    s_barrier
KS_JOIN:
    v_readfirstlane_b32 s2, v59
    s_mov_b32 s23, 0
    s_mov_b32 s28, 1
    s_mov_b32 s24, 0
    s_mov_b32 s25, 1
K2_CELLS:
    v_lshrrev_b32 v178, 1, v177
    v_min_u32 v178, 249, v178
    v_mul_u32_u24 v72, 1152, v178
    s_and_b32 s58, s54, 7
    s_lshl_b32 s58, s58, 7
    s_lshr_b32 s59, s54, 5
    s_lshl_b32 s59, s59, 4
    s_add_u32 s67, s58, s59
    s_add_u32 s67, s67, 6291456
    buffer_load_dwordx4 v[76:79], v72, s[8:11], s67 offen sc1
    s_cmp_eq_u32 s28, 0
    s_cbranch_scc1 K2_NOSRD
    s_mov_b32 s4, s80
    s_and_b32 s5, s81, 0xffff
    s_mov_b32 s6, 10240000
    s_mov_b32 s7, 0x20000
    s_mov_b32 s12, s96
    s_and_b32 s13, s97, 0xffff
    s_mov_b32 s14, 10240000
    s_mov_b32 s15, 0x20000
    s_mov_b32 s16, s84
    s_and_b32 s17, s85, 0xffff
    s_mov_b32 s18, 10240000
    s_mov_b32 s19, 0x20000
    s_sub_u32 s80, s80, 1024
    s_subb_u32 s81, s81, 0
    s_mov_b32 s72, s80
    s_and_b32 s73, s81, 0xffff
    s_mov_b32 s74, 10241024
    s_mov_b32 s75, 0x20000
    s_mov_b64 exec, 0
    s_cmp_eq_u32 s20, 0
    s_cbranch_scc1 K2_PAD_U20
    s_cmp_eq_u32 s20, 1
    s_cbranch_scc1 K2_PAD_U30
    s_cmp_eq_u32 s20, 2
    s_cbranch_scc1 K2_PAD_U21
    s_cmp_eq_u32 s20, 3
    s_cbranch_scc1 K2_PAD_U31
    s_cmp_eq_u32 s20, 4
    s_cbranch_scc1 K2_PAD_SW
    s_cmp_eq_u32 s20, 5
    s_cbranch_scc1 K2_PAD_TL
    s_cmp_eq_u32 s20, 6
    s_cbranch_scc1 K2_PAD_T2
K2_HOP:
    s_mov_b64 exec, -1
K2_NOSRD:
    v_and_b32 v84, 15, v176
    v_lshrrev_b32 v85, 5, v176
    v_bfe_u32 v86, v176, 4, 1
    v_lshrrev_b32 v87, 2, v84
    v_and_b32 v88, 3, v84
    v_lshl_add_u32 v89, v85, 2, v87
    v_lshlrev_b32 v249, 6, v89
    v_lshl_add_u32 v249, v88, 3, v249
    v_add_u32 v249, 512, v249
    v_lshrrev_b32 v90, 3, v84
    v_lshl_add_u32 v90, v90, 1, v86
    v_sub_u32 v90, v90, 1 clamp
    v_lshlrev_b32 v250, 1, v90
    v_lshl_add_u32 v91, v85, 2, v88
    v_lshl_add_u32 v250, v91, 4, v250
    v_and_b32 v91, 1, v87
    v_lshl_add_u32 v250, v91, 3, v250
    v_lshrrev_b32 v90, 1, v88
    v_lshl_add_u32 v90, v86, 1, v90
    v_bfe_u32 v91, v87, 1, 1
    v_lshlrev_b32 v91, 2, v91
    v_xor_b32 v90, v90, v91
    v_lshlrev_b32 v90, 4, v90
    v_lshl_add_u32 v90, v89, 7, v90
    v_and_b32 v91, 1, v88
    v_lshl_add_u32 v90, v91, 3, v90
    v_add_u32 v246, s37, v90
    v_xor_b32 v247, 64, v246
    v_lshrrev_b32 v90, 3, v176
    v_lshlrev_b32 v251, 4, v90
    v_bfe_u32 v90, v90, 1, 1
    v_lshlrev_b32 v90, 2, v90
    v_and_b32 v91, 7, v176
    v_xor_b32 v90, v90, v91
    v_lshlrev_b32 v248, 4, v90
    v_lshlrev_b32 v252, 1, v176
    v_and_b32 v231, 1, v176
    v_lshlrev_b32 v231, 4, v231
    v_lshrrev_b32 v90, 1, v176
    v_lshlrev_b32 v90, 5, v90
    v_add_u32 v230, 512, v90
    s_lshl_b32 s59, s2, 22
    s_mov_b32 s60, 0x40000
    s_bfe_u32 s61, s54, 0x10004
    s_bfe_u32 s62, s54, 0x10003
    s_add_u32 s63, s61, s62
    s_mul_i32 s62, s62, 11
    s_sub_u32 s64, 11, s62
    v_cmp_gt_u32 vcc, 500, v177
    s_nop 0
    s_mov_b64 s[56:57], vcc
K2_POLL:
    s_waitcnt vmcnt(0)
    v_xor_b32 v73, s59, v76
    v_xor_b32 v74, s59, v77
    v_or_b32 v73, v73, v74
    v_xor_b32 v74, s2, v79
    v_lshrrev_b32 v73, 22, v73
    v_or_b32 v73, v73, v74
    v_cmp_ne_u32 vcc, 0, v73
    s_nop 0
    s_cbranch_vccz K2_POLLED
    s_sub_u32 s60, s60, 1
    s_cbranch_scc1 K2_END
    s_mov_b64 exec, vcc
    buffer_load_dwordx4 v[76:79], v72, s[8:11], s67 offen sc1
    s_mov_b64 exec, -1
    s_branch K2_POLL
K2_PAD_LD:
    s_branch KS_HOP
K2_POLLED:
    s_set_gpr_idx_on s61, gpr_idx(SRC0)
    s_nop 0
    v_bfe_u32 v179, v76, s62, 11
    s_set_gpr_idx_idx s63
    s_nop 0
    v_bfe_u32 v73, v76, s64, 11
    s_set_gpr_idx_off
    v_sub_u32 v73, v73, v179
    v_cndmask_b32 v73, 0, v73, s[56:57]
    v_and_b32 v1, 1, v177
    v_add_u32 v1, s23, v1
    v_sub_u32 v180, v73, v1
    v_add_u32 v179, v179, v1
    v_mul_u32_u24 v181, 20608, v178
    v_lshl_add_u32 v181, v179, 4, v181
    v_cmp_lt_i32 s[40:41], 0, v180
    v_add_u32 v182, 32, v181
    s_mov_b32 s65, 0
    s_mov_b64 exec, s[40:41]
    buffer_load_dwordx4 v[0:3], v181, s[8:11], 0 offen offset:0 sc1
    s_mov_b64 exec, -1
    v_cmp_lt_i32 s[42:43], 2, v180
    v_cmp_lt_i32 s[44:45], 4, v180
    v_cmp_lt_i32 s[46:47], 6, v180
    v_cmp_lt_i32 s[48:49], 8, v180
    v_cmp_lt_i32 s[50:51], 10, v180
    v_cmp_lt_i32 s[90:91], 12, v180
    v_cmp_lt_i32 s[92:93], 14, v180
    v_cmp_lt_i32 s[94:95], 16, v180
    v_cmp_lt_i32 s[96:97], 18, v180
    v_add_u32 v183, 64, v181
    v_add_u32 v184, 96, v181
    v_subrev_u32 v62, 1, v180
    v_ashrrev_i32 v62, 1, v62
    v_med3_i32 v62, v62, 0, 9
    s_cmp_eq_u64 s[42:43], 0
    s_cbranch_scc1 K2_LD_DONE
    v_mov_b32 v63, v62
    s_nop 1
    v_add_u32_dpp v63, v63, v63 row_shr:1 row_mask:0xf bank_mask:0xf bound_ctrl:0
    s_nop 1
    v_add_u32_dpp v63, v63, v63 row_shr:2 row_mask:0xf bank_mask:0xf bound_ctrl:0
    s_nop 1
    v_add_u32_dpp v63, v63, v63 row_shr:4 row_mask:0xf bank_mask:0xf bound_ctrl:0
    s_nop 1
    v_add_u32_dpp v63, v63, v63 row_shr:8 row_mask:0xf bank_mask:0xf bound_ctrl:0
    s_nop 1
    v_add_u32_dpp v63, v63, v63 row_bcast:15 row_mask:0xa bank_mask:0xf
    s_nop 1
    v_add_u32_dpp v63, v63, v63 row_bcast:31 row_mask:0xc bank_mask:0xf
    s_lshl_b32 s58, s20, 10
    s_add_u32 s58, s58, 45056
    v_readlane_b32 s59, v63, 63
    v_sub_u32 v63, v63, v62
    v_lshl_add_u32 v64, v63, 2, s58
    v_lshlrev_b32 v63, 5, v63
    v_sub_u32 v63, v182, v63
    s_cmp_gt_u32 s59, 189
    s_cbranch_scc1 K2_LD_GEN
    s_mov_b64 exec, s[42:43]
    s_cbranch_execz K2_LD_L
    ds_write_b32 v64, v63 offset:0
    s_mov_b64 exec, s[44:45]
    s_cbranch_execz K2_LD_L
    ds_write_b32 v64, v63 offset:4
    s_mov_b64 exec, s[46:47]
    s_cbranch_execz K2_LD_L
    ds_write_b32 v64, v63 offset:8
    s_mov_b64 exec, s[48:49]
    s_cbranch_execz K2_LD_L
    ds_write_b32 v64, v63 offset:12
    s_mov_b64 exec, s[50:51]
    s_cbranch_execz K2_LD_L
    ds_write_b32 v64, v63 offset:16
    s_mov_b64 exec, s[90:91]
    s_cbranch_execz K2_LD_L
    ds_write_b32 v64, v63 offset:20
    s_mov_b64 exec, s[92:93]
    s_cbranch_execz K2_LD_L
    ds_write_b32 v64, v63 offset:24
    s_mov_b64 exec, s[94:95]
    s_cbranch_execz K2_LD_L
    ds_write_b32 v64, v63 offset:28
    s_mov_b64 exec, s[96:97]
    s_cbranch_execz K2_LD_L
    ds_write_b32 v64, v63 offset:32
K2_LD_L:
    s_mov_b64 exec, -1
    v_lshl_add_u32 v63, v176, 2, s58
    v_lshlrev_b32 v62, 5, v176
    s_waitcnt lgkmcnt(0)
    ds_read_b32 v64, v63 offset:0
    ds_read_b32 v65, v63 offset:252
    ds_read_b32 v66, v63 offset:504
    s_min_u32 s60, s59, 63
    s_sub_u32 s59, s59, s60
    s_bfm_b64 s[42:43], s60, 0
    s_min_u32 s60, s59, 63
    s_sub_u32 s59, s59, s60
    s_bfm_b64 s[44:45], s60, 0
    s_min_u32 s60, s59, 63
    s_sub_u32 s59, s59, s60
    s_bfm_b64 s[46:47], s60, 0
    s_mov_b64 s[48:49], 0
    s_mov_b32 s65, 1
    s_mov_b32 s60, 0
    s_waitcnt lgkmcnt(2)
    v_add3_u32 v182, v62, v64, s60
    s_mov_b64 exec, s[42:43]
    buffer_load_dwordx4 v[4:7], v182, s[8:11], 0 offen sc1
    s_mov_b32 s60, 2016
    s_waitcnt lgkmcnt(1)
    v_add3_u32 v183, v62, v65, s60
    s_mov_b64 exec, s[44:45]
    buffer_load_dwordx4 v[8:11], v183, s[8:11], 0 offen sc1
    s_mov_b32 s60, 4032
    s_waitcnt lgkmcnt(0)
    v_add3_u32 v184, v62, v66, s60
    s_mov_b64 exec, s[46:47]
    buffer_load_dwordx4 v[12:15], v184, s[8:11], 0 offen sc1
K2_LD_DONE:
    s_mov_b64 exec, -1
    s_cmp_eq_u32 s28, 0
    s_cbranch_scc1 K2_WLATE
    v_lshrrev_b32 v60, 6, v252
    v_bfe_u32 v61, v252, 3, 2
    v_lshl_add_u32 v60, v60, 2, v61
    v_mul_u32_u24 v60, 640, v60
    v_bfe_u32 v61, v252, 5, 1
    v_lshl_add_u32 v60, v61, 5, v60
    v_and_b32 v61, 6, v252
    v_lshl_add_u32 v60, v61, 2, v60
    v_add_u32 v60, 24576, v60
    ds_read_b64_tr_b16 v[136:137], v60 offset:0
    ds_read_b64_tr_b16 v[138:139], v60 offset:5120
    ds_read_b64_tr_b16 v[140:141], v60 offset:64
    ds_read_b64_tr_b16 v[142:143], v60 offset:5184
    ds_read_b64_tr_b16 v[144:145], v60 offset:128
    ds_read_b64_tr_b16 v[146:147], v60 offset:5248
    ds_read_b64_tr_b16 v[148:149], v60 offset:192
    ds_read_b64_tr_b16 v[150:151], v60 offset:5312
    ds_read_b64_tr_b16 v[152:153], v60 offset:256
    ds_read_b64_tr_b16 v[154:155], v60 offset:5376
    ds_read_b64_tr_b16 v[156:157], v60 offset:320
    ds_read_b64_tr_b16 v[158:159], v60 offset:5440
    ds_read_b64_tr_b16 v[160:161], v60 offset:384
    ds_read_b64_tr_b16 v[162:163], v60 offset:5504
    ds_read_b64_tr_b16 v[164:165], v60 offset:448
    ds_read_b64_tr_b16 v[166:167], v60 offset:5568
    ds_read_b64_tr_b16 v[168:169], v60 offset:512
    ds_read_b64_tr_b16 v[170:171], v60 offset:5632
    ds_read_b64_tr_b16 v[172:173], v60 offset:576
    ds_read_b64_tr_b16 v[174:175], v60 offset:5696
    s_waitcnt lgkmcnt(0)
K2_WUNP:
    v_lshlrev_b32 v96, 16, v136
    v_and_b32 v97, 0xffff0000, v136
    v_lshlrev_b32 v98, 16, v137
    v_and_b32 v99, 0xffff0000, v137
    v_lshlrev_b32 v100, 16, v138
    v_and_b32 v101, 0xffff0000, v138
    v_lshlrev_b32 v102, 16, v139
    v_and_b32 v103, 0xffff0000, v139
    v_lshlrev_b32 v104, 16, v140
    v_and_b32 v105, 0xffff0000, v140
    v_lshlrev_b32 v106, 16, v141
    v_and_b32 v107, 0xffff0000, v141
    v_lshlrev_b32 v108, 16, v142
    v_and_b32 v109, 0xffff0000, v142
    v_lshlrev_b32 v110, 16, v143
    v_and_b32 v111, 0xffff0000, v143
    v_lshlrev_b32 v112, 16, v144
    v_and_b32 v113, 0xffff0000, v144
    v_lshlrev_b32 v114, 16, v145
    v_and_b32 v115, 0xffff0000, v145
    v_lshlrev_b32 v116, 16, v146
    v_and_b32 v117, 0xffff0000, v146
    v_lshlrev_b32 v118, 16, v147
    v_and_b32 v119, 0xffff0000, v147
    v_lshlrev_b32 v120, 16, v148
    v_and_b32 v121, 0xffff0000, v148
    v_lshlrev_b32 v122, 16, v149
    v_and_b32 v123, 0xffff0000, v149
    v_lshlrev_b32 v124, 16, v150
    v_and_b32 v125, 0xffff0000, v150
    v_lshlrev_b32 v126, 16, v151
    v_and_b32 v127, 0xffff0000, v151
    v_lshlrev_b32 v128, 16, v152
    v_and_b32 v129, 0xffff0000, v152
    v_lshlrev_b32 v130, 16, v153
    v_and_b32 v131, 0xffff0000, v153
    v_lshlrev_b32 v132, 16, v154
    v_and_b32 v133, 0xffff0000, v154
    v_lshlrev_b32 v134, 16, v155
    v_and_b32 v135, 0xffff0000, v155
    v_lshlrev_b32 v136, 16, v156
    v_and_b32 v137, 0xffff0000, v156
    v_lshlrev_b32 v138, 16, v157
    v_and_b32 v139, 0xffff0000, v157
    v_lshlrev_b32 v140, 16, v158
    v_and_b32 v141, 0xffff0000, v158
    v_lshlrev_b32 v142, 16, v159
    v_and_b32 v143, 0xffff0000, v159
    v_lshlrev_b32 v144, 16, v160
    v_and_b32 v145, 0xffff0000, v160
    v_lshlrev_b32 v146, 16, v161
    v_and_b32 v147, 0xffff0000, v161
    v_lshlrev_b32 v148, 16, v162
    v_and_b32 v149, 0xffff0000, v162
    v_lshlrev_b32 v150, 16, v163
    v_and_b32 v151, 0xffff0000, v163
    v_lshlrev_b32 v152, 16, v164
    v_and_b32 v153, 0xffff0000, v164
    v_lshlrev_b32 v154, 16, v165
    v_and_b32 v155, 0xffff0000, v165
    v_lshlrev_b32 v156, 16, v166
    v_and_b32 v157, 0xffff0000, v166
    v_lshlrev_b32 v158, 16, v167
    v_and_b32 v159, 0xffff0000, v167
    v_lshlrev_b32 v160, 16, v168
    v_and_b32 v161, 0xffff0000, v168
    v_lshlrev_b32 v162, 16, v169
    v_and_b32 v163, 0xffff0000, v169
    v_lshlrev_b32 v164, 16, v170
    v_and_b32 v165, 0xffff0000, v170
    v_lshlrev_b32 v166, 16, v171
    v_and_b32 v167, 0xffff0000, v171
    v_lshlrev_b32 v168, 16, v172
    v_and_b32 v169, 0xffff0000, v172
    v_lshlrev_b32 v170, 16, v173
    v_and_b32 v171, 0xffff0000, v173
    v_lshlrev_b32 v172, 16, v174
    v_and_b32 v173, 0xffff0000, v174
    v_lshlrev_b32 v174, 16, v175
    v_and_b32 v175, 0xffff0000, v175
K2_NOWRAW:
K2_PAD_NW:
    s_cbranch_execz KS_HOP
    v_lshrrev_b32 v179, 2, v181
    v_lshrrev_b32 v185, 2, v182
    v_lshrrev_b32 v186, 2, v183
    v_lshrrev_b32 v187, 2, v184
    s_mov_b32 s66, 7340032
    v_mov_b32 v201, 1
    s_movk_i32 s58, 520
    s_movk_i32 s59, 2080
    s_mov_b32 s60, 0x40000
    s_mov_b32 s61, 0xffff
    v_mov_b32 v202, 65536
    s_cmp_lg_u32 s24, 0
    s_cbranch_scc1 K2_RK_LOAD
    v_cmp_lt_i32 vcc, 20, v180
    s_nop 0
    s_cbranch_vccz K2_NOMORE
    v_mov_b32 v61, 163300
    ds_write_b32 v61, v201
K2_NOMORE:
    s_mov_b32 s62, 82176
    s_cmp_eq_u32 s65, 0
    s_waitcnt vmcnt(3)
    s_cbranch_scc0 K2_ARR
    s_waitcnt vmcnt(0)
K2_ARR:
    s_mov_b64 exec, s[40:41]
    s_cbranch_execz K2_RK_A
K2_CK0:
    v_bfi_b32 v192, s61, v1, v2
    v_lshrrev_b32 v50, 24, v3
    v_cmp_ne_u32 vcc, s2, v192
    v_add_u32 v40, 163072, v50
    s_cbranch_vccnz K2_RT0
    ds_add_rtn_u32 v40, v40, v201
    v_mad_u32_u24 v50, v50, s58, v202
    s_mov_b64 exec, s[42:43]
    s_cbranch_execz K2_RK_A
    s_waitcnt vmcnt(2)
K2_CK1:
    v_bfi_b32 v192, s61, v5, v6
    v_lshrrev_b32 v51, 24, v7
    v_cmp_ne_u32 vcc, s2, v192
    v_add_u32 v41, 163072, v51
    s_cbranch_vccnz K2_RT1
    ds_add_rtn_u32 v41, v41, v201
    v_mad_u32_u24 v51, v51, s58, v202
    s_mov_b64 exec, s[44:45]
    s_cbranch_execz K2_RK_A
    s_waitcnt vmcnt(1)
K2_CK2:
    v_bfi_b32 v192, s61, v9, v10
    v_lshrrev_b32 v52, 24, v11
    v_cmp_ne_u32 vcc, s2, v192
    v_add_u32 v42, 163072, v52
    s_cbranch_vccnz K2_RT2
    ds_add_rtn_u32 v42, v42, v201
    v_mad_u32_u24 v52, v52, s58, v202
    s_mov_b64 exec, s[46:47]
    s_cbranch_execz K2_RK_A
    s_waitcnt vmcnt(0)
K2_CK3:
    v_bfi_b32 v192, s61, v13, v14
    v_lshrrev_b32 v53, 24, v15
    v_cmp_ne_u32 vcc, s2, v192
    v_add_u32 v43, 163072, v53
    s_cbranch_vccnz K2_RT3
    ds_add_rtn_u32 v43, v43, v201
    v_mad_u32_u24 v53, v53, s58, v202
    s_mov_b64 exec, s[48:49]
    s_cbranch_execz K2_RK_A
K2_CK4:
    v_bfi_b32 v192, s61, v17, v18
    v_lshrrev_b32 v54, 24, v19
    v_cmp_ne_u32 vcc, s2, v192
    v_add_u32 v44, 163072, v54
    s_cbranch_vccnz K2_RT4
    ds_add_rtn_u32 v44, v44, v201
    v_mad_u32_u24 v54, v54, s58, v202
    s_mov_b64 exec, s[50:51]
    s_cbranch_execz K2_RK_A
K2_CK5:
    v_bfi_b32 v192, s61, v21, v22
    v_lshrrev_b32 v55, 24, v23
    v_cmp_ne_u32 vcc, s2, v192
    v_add_u32 v45, 163072, v55
    s_cbranch_vccnz K2_RT5
    ds_add_rtn_u32 v45, v45, v201
    v_mad_u32_u24 v55, v55, s58, v202
    s_mov_b64 exec, s[90:91]
    s_cbranch_execz K2_RK_A
K2_CK6:
    v_bfi_b32 v192, s61, v25, v26
    v_lshrrev_b32 v56, 24, v27
    v_cmp_ne_u32 vcc, s2, v192
    v_add_u32 v46, 163072, v56
    s_cbranch_vccnz K2_RT6
    ds_add_rtn_u32 v46, v46, v201
    v_mad_u32_u24 v56, v56, s58, v202
    s_mov_b64 exec, s[92:93]
    s_cbranch_execz K2_RK_A
K2_CK7:
    v_bfi_b32 v192, s61, v29, v30
    v_lshrrev_b32 v57, 24, v31
    v_cmp_ne_u32 vcc, s2, v192
    v_add_u32 v47, 163072, v57
    s_cbranch_vccnz K2_RT7
    ds_add_rtn_u32 v47, v47, v201
    v_mad_u32_u24 v57, v57, s58, v202
    s_mov_b64 exec, s[94:95]
    s_cbranch_execz K2_RK_A
K2_CK8:
    v_bfi_b32 v192, s61, v33, v34
    v_lshrrev_b32 v58, 24, v35
    v_cmp_ne_u32 vcc, s2, v192
    v_add_u32 v48, 163072, v58
    s_cbranch_vccnz K2_RT8
    ds_add_rtn_u32 v48, v48, v201
    v_mad_u32_u24 v58, v58, s58, v202
    s_mov_b64 exec, s[96:97]
    s_cbranch_execz K2_RK_A
K2_CK9:
    v_bfi_b32 v192, s61, v37, v38
    v_lshrrev_b32 v59, 24, v39
    v_cmp_ne_u32 vcc, s2, v192
    v_add_u32 v49, 163072, v59
    s_cbranch_vccnz K2_RT9
    ds_add_rtn_u32 v49, v49, v201
    v_mad_u32_u24 v59, v59, s58, v202
K2_RK_A:
    s_mov_b64 exec, -1
    s_mov_b64 exec, s[40:41]
    s_cbranch_execz K2_TP
    v_cmp_gt_u32 vcc, s62, v50
    v_and_b32 v3, 0xffffff, v3
    s_mov_b64 exec, vcc
    buffer_load_dword v245, v3, s[16:19], 0 offen
    s_mov_b64 exec, s[42:43]
    s_cbranch_execz K2_TP
    v_cmp_gt_u32 vcc, s62, v51
    v_and_b32 v7, 0xffffff, v7
    s_mov_b64 exec, vcc
    buffer_load_dword v245, v7, s[16:19], 0 offen
    s_mov_b64 exec, s[44:45]
    s_cbranch_execz K2_TP
    v_cmp_gt_u32 vcc, s62, v52
    v_and_b32 v11, 0xffffff, v11
    s_mov_b64 exec, vcc
    buffer_load_dword v245, v11, s[16:19], 0 offen
    s_mov_b64 exec, s[46:47]
    s_cbranch_execz K2_TP
    v_cmp_gt_u32 vcc, s62, v53
    v_and_b32 v15, 0xffffff, v15
    s_mov_b64 exec, vcc
    buffer_load_dword v245, v15, s[16:19], 0 offen
    s_mov_b64 exec, s[48:49]
    s_cbranch_execz K2_TP
    v_cmp_gt_u32 vcc, s62, v54
    v_and_b32 v19, 0xffffff, v19
    s_mov_b64 exec, vcc
    buffer_load_dword v245, v19, s[16:19], 0 offen
    s_mov_b64 exec, s[50:51]
    s_cbranch_execz K2_TP
    v_cmp_gt_u32 vcc, s62, v55
    v_and_b32 v23, 0xffffff, v23
    s_mov_b64 exec, vcc
    buffer_load_dword v245, v23, s[16:19], 0 offen
    s_mov_b64 exec, s[90:91]
    s_cbranch_execz K2_TP
    v_cmp_gt_u32 vcc, s62, v56
    v_and_b32 v27, 0xffffff, v27
    s_mov_b64 exec, vcc
    buffer_load_dword v245, v27, s[16:19], 0 offen
    s_mov_b64 exec, s[92:93]
    s_cbranch_execz K2_TP
    v_cmp_gt_u32 vcc, s62, v57
    v_and_b32 v31, 0xffffff, v31
    s_mov_b64 exec, vcc
    buffer_load_dword v245, v31, s[16:19], 0 offen
    s_mov_b64 exec, s[94:95]
    s_cbranch_execz K2_TP
    v_cmp_gt_u32 vcc, s62, v58
    v_and_b32 v35, 0xffffff, v35
    s_mov_b64 exec, vcc
    buffer_load_dword v245, v35, s[16:19], 0 offen
    s_mov_b64 exec, s[96:97]
    s_cbranch_execz K2_TP
    v_cmp_gt_u32 vcc, s62, v59
    v_and_b32 v39, 0xffffff, v39
    s_mov_b64 exec, vcc
    buffer_load_dword v245, v39, s[16:19], 0 offen
K2_TP:
    s_mov_b64 exec, -1
K2_RK_DONE:
K2_PAD_SC:
    s_cbranch_execz KS_HOP
    s_mul_i32 s67, s24, 48
    s_movk_i32 s58, -1532
    s_waitcnt lgkmcnt(0)
    s_mov_b64 exec, s[40:41]
    s_cbranch_execz K2_SC_DONE
    v_cmpx_gt_u32 vcc, 64, v40
    v_bfe_u32 v194, v40, 3, 1
    v_add_u32 v193, 16, v40
    v_lshl_or_b32 v194, v40, 1, v194
    v_bfi_b32 v194, 15, v194, v40
    v_lshrrev_b32 v193, 6, v193
    v_alignbit_b32 v1, v2, v1, 16
    v_lshl_add_u32 v195, v194, 3, v50
    v_lshl_add_u32 v194, v194, 5, v50
    ds_write_b64 v195, v[0:1]
    v_mad_i32_i24 v194, v193, s58, v194
    ds_write_b32 v194, v3 offset:512
    s_mov_b64 exec, s[42:43]
    s_cbranch_execz K2_SC_DONE
    v_cmpx_gt_u32 vcc, 64, v41
    v_bfe_u32 v194, v41, 3, 1
    v_add_u32 v193, 16, v41
    v_lshl_or_b32 v194, v41, 1, v194
    v_bfi_b32 v194, 15, v194, v41
    v_lshrrev_b32 v193, 6, v193
    v_alignbit_b32 v5, v6, v5, 16
    v_lshl_add_u32 v195, v194, 3, v51
    v_lshl_add_u32 v194, v194, 5, v51
    ds_write_b64 v195, v[4:5]
    v_mad_i32_i24 v194, v193, s58, v194
    ds_write_b32 v194, v7 offset:512
    s_mov_b64 exec, s[44:45]
    s_cbranch_execz K2_SC_DONE
    v_cmpx_gt_u32 vcc, 64, v42
    v_bfe_u32 v194, v42, 3, 1
    v_add_u32 v193, 16, v42
    v_lshl_or_b32 v194, v42, 1, v194
    v_bfi_b32 v194, 15, v194, v42
    v_lshrrev_b32 v193, 6, v193
    v_alignbit_b32 v9, v10, v9, 16
    v_lshl_add_u32 v195, v194, 3, v52
    v_lshl_add_u32 v194, v194, 5, v52
    ds_write_b64 v195, v[8:9]
    v_mad_i32_i24 v194, v193, s58, v194
    ds_write_b32 v194, v11 offset:512
    s_mov_b64 exec, s[46:47]
    s_cbranch_execz K2_SC_DONE
    v_cmpx_gt_u32 vcc, 64, v43
    v_bfe_u32 v194, v43, 3, 1
    v_add_u32 v193, 16, v43
    v_lshl_or_b32 v194, v43, 1, v194
    v_bfi_b32 v194, 15, v194, v43
    v_lshrrev_b32 v193, 6, v193
    v_alignbit_b32 v13, v14, v13, 16
    v_lshl_add_u32 v195, v194, 3, v53
    v_lshl_add_u32 v194, v194, 5, v53
    ds_write_b64 v195, v[12:13]
    v_mad_i32_i24 v194, v193, s58, v194
    ds_write_b32 v194, v15 offset:512
    s_mov_b64 exec, s[48:49]
    s_cbranch_execz K2_SC_DONE
    v_cmpx_gt_u32 vcc, 64, v44
    v_bfe_u32 v194, v44, 3, 1
    v_add_u32 v193, 16, v44
    v_lshl_or_b32 v194, v44, 1, v194
    v_bfi_b32 v194, 15, v194, v44
    v_lshrrev_b32 v193, 6, v193
    v_alignbit_b32 v17, v18, v17, 16
    v_lshl_add_u32 v195, v194, 3, v54
    v_lshl_add_u32 v194, v194, 5, v54
    ds_write_b64 v195, v[16:17]
    v_mad_i32_i24 v194, v193, s58, v194
    ds_write_b32 v194, v19 offset:512
    s_mov_b64 exec, s[50:51]
    s_cbranch_execz K2_SC_DONE
    v_cmpx_gt_u32 vcc, 64, v45
    v_bfe_u32 v194, v45, 3, 1
    v_add_u32 v193, 16, v45
    v_lshl_or_b32 v194, v45, 1, v194
    v_bfi_b32 v194, 15, v194, v45
    v_lshrrev_b32 v193, 6, v193
    v_alignbit_b32 v21, v22, v21, 16
    v_lshl_add_u32 v195, v194, 3, v55
    v_lshl_add_u32 v194, v194, 5, v55
    ds_write_b64 v195, v[20:21]
    v_mad_i32_i24 v194, v193, s58, v194
    ds_write_b32 v194, v23 offset:512
    s_mov_b64 exec, s[90:91]
    s_cbranch_execz K2_SC_DONE
    v_cmpx_gt_u32 vcc, 64, v46
    v_bfe_u32 v194, v46, 3, 1
    v_add_u32 v193, 16, v46
    v_lshl_or_b32 v194, v46, 1, v194
    v_bfi_b32 v194, 15, v194, v46
    v_lshrrev_b32 v193, 6, v193
    v_alignbit_b32 v25, v26, v25, 16
    v_lshl_add_u32 v195, v194, 3, v56
    v_lshl_add_u32 v194, v194, 5, v56
    ds_write_b64 v195, v[24:25]
    v_mad_i32_i24 v194, v193, s58, v194
    ds_write_b32 v194, v27 offset:512
    s_mov_b64 exec, s[92:93]
    s_cbranch_execz K2_SC_DONE
    v_cmpx_gt_u32 vcc, 64, v47
    v_bfe_u32 v194, v47, 3, 1
    v_add_u32 v193, 16, v47
    v_lshl_or_b32 v194, v47, 1, v194
    v_bfi_b32 v194, 15, v194, v47
    v_lshrrev_b32 v193, 6, v193
    v_alignbit_b32 v29, v30, v29, 16
    v_lshl_add_u32 v195, v194, 3, v57
    v_lshl_add_u32 v194, v194, 5, v57
    ds_write_b64 v195, v[28:29]
    v_mad_i32_i24 v194, v193, s58, v194
    ds_write_b32 v194, v31 offset:512
    s_mov_b64 exec, s[94:95]
    s_cbranch_execz K2_SC_DONE
    v_cmpx_gt_u32 vcc, 64, v48
    v_bfe_u32 v194, v48, 3, 1
    v_add_u32 v193, 16, v48
    v_lshl_or_b32 v194, v48, 1, v194
    v_bfi_b32 v194, 15, v194, v48
    v_lshrrev_b32 v193, 6, v193
    v_alignbit_b32 v33, v34, v33, 16
    v_lshl_add_u32 v195, v194, 3, v58
    v_lshl_add_u32 v194, v194, 5, v58
    ds_write_b64 v195, v[32:33]
    v_mad_i32_i24 v194, v193, s58, v194
    ds_write_b32 v194, v35 offset:512
    s_mov_b64 exec, s[96:97]
    s_cbranch_execz K2_SC_DONE
    v_cmpx_gt_u32 vcc, 64, v49
    v_bfe_u32 v194, v49, 3, 1
    v_add_u32 v193, 16, v49
    v_lshl_or_b32 v194, v49, 1, v194
    v_bfi_b32 v194, 15, v194, v49
    v_lshrrev_b32 v193, 6, v193
    v_alignbit_b32 v37, v38, v37, 16
    v_lshl_add_u32 v195, v194, 3, v59
    v_lshl_add_u32 v194, v194, 5, v59
    ds_write_b64 v195, v[36:37]
    v_mad_i32_i24 v194, v193, s58, v194
    ds_write_b32 v194, v39 offset:512
K2_SC_DONE:
    s_mov_b64 exec, -1
K2_PAD_SD:
    s_cbranch_execz KS_HOP
    v_lshlrev_b32 v192, 2, v176
    v_add_u32 v192, 163072, v192
    v_mov_b32 v200, 163300
    s_cmp_eq_u32 s24, 0
    s_cselect_b32 s26, 64, 48
    s_waitcnt lgkmcnt(0)
    s_barrier
    ds_read_b32 v193, v192
    ds_read_b32 v200, v200
    v_cmp_gt_u32 s[56:57], s22, v176
    v_mad_u32_u24 v195, v176, s59, v202
    s_waitcnt lgkmcnt(0)
    v_cndmask_b32 v193, 0, v193, s[56:57]
    v_readfirstlane_b32 s27, v200
    v_cmp_lt_u32 s[62:63], 48, v193
    v_cmp_lt_u32 vcc, 64, v193
    s_bcnt1_i32_b64 s60, s[62:63]
    v_mbcnt_lo_u32_b32 v198, s62, 0
    v_mbcnt_hi_u32_b32 v198, s63, v198
    s_cbranch_vccnz K2_BIG
    s_cmp_gt_u32 s60, 8
    s_cbranch_scc1 K2_BIG
K2_TOK:
    v_subrev_u32 v194, s67, v193
    v_max_i32 v194, 1, v194
    v_min_i32 v194, s26, v194
    v_add_u32 v194, 15, v194
    v_lshrrev_b32 v194, 3, v194
    v_lshl_or_b32 v195, v194, 18, v195
    v_lshl_or_b32 v195, v198, 27, v195
    v_mov_b32 v197, 949760
    v_cndmask_b32 v253, v197, v195, s[56:57]
    s_movk_i32 s40, 0
    s_movk_i32 s41, 256
    s_movk_i32 s42, 512
    s_movk_i32 s43, 768
    s_add_u32 s24, s24, 1
    s_cmp_ge_u32 s24, s25
    s_cselect_b32 s55, 1, 0
    s_cmp_eq_u32 s27, 0
    s_cselect_b32 s55, s55, 0
    s_mov_b32 s27, 0x400000
    s_mov_b32 s38, 0
    s_mov_b32 s34, 0
    s_mov_b32 s35, 0
    s_mov_b32 s36, 1
    s_mov_b32 s31, 0
    s_mov_b32 s58, s20
    v_readlane_b32 s3, v253, s58
    s_lshl_b32 s44, s34, 7
    s_and_b32 s48, s3, 0x3ffff
    s_bfe_u32 s33, s3, 0x30013
    s_mul_i32 s35, s38, 6
    s_cmp_eq_u32 s34, 0
    s_cselect_b32 s35, s35, s48
    s_mov_b32 s45, s44
    s_add_u32 s47, s44, 256
    s_add_u32 s49, s48, 128
    s_add_u32 s60, s48, 256
    s_cmp_eq_u32 s33, 3
    s_cselect_b32 s46, s44, s47
    s_cselect_b32 s50, s60, s48
    s_cselect_b32 s51, s48, s49
    s_sub_u32 s60, s33, 2
    s_cmp_lt_u32 s60, 2
    s_cbranch_scc0 K2_rare_1
K2_back_2:
    v_add_u32 v233, s48, v230
    ds_read_b32 v232, v233
    ds_read_b32 v233, v233 offset:1024
    v_add_u32 v222, s48, v251
    ds_read2_b32 v[222:223], v222 offset0:1 offset1:3
    v_add_u32 v224, s49, v251
    ds_read2_b32 v[224:225], v224 offset0:1 offset1:3
    v_add_u32 v226, s50, v251
    ds_read2_b32 v[226:227], v226 offset0:1 offset1:3
    v_add_u32 v228, s51, v251
    ds_read2_b32 v[228:229], v228 offset0:1 offset1:3
    s_waitcnt lgkmcnt(4)
    v_or_b32 v232, v232, v231
    v_or_b32 v233, v233, v231
    s_cmp_lg_u32 s34, 0
    s_cbranch_scc1 K2_dum_4
    s_cmp_eq_u32 s33, 4
    s_cbranch_scc1 K2_a4_5
K2_b4_7:
    s_add_u32 m0, s48, 512
    s_add_u32 s65, s48, 1536
    buffer_load_dwordx4 v232, s[16:19], 0 offen  lds
    s_mov_b32 m0, s65
    s_mov_b32 exec_hi, 0
    buffer_load_dwordx4 v233, s[16:19], 0 offen  lds
    s_mov_b32 exec_hi, -1
K2_back_6:
    s_waitcnt lgkmcnt(3)
    v_mad_u32_u16 v222, v222, s39, v248 op_sel:[1,0,0,0]
    v_mad_u32_u16 v223, v223, s39, v248 op_sel:[1,0,0,0]
    s_waitcnt lgkmcnt(2)
    v_mad_u32_u16 v224, v224, s39, v248 op_sel:[1,0,0,0]
    v_mad_u32_u16 v225, v225, s39, v248 op_sel:[1,0,0,0]
    s_waitcnt lgkmcnt(1)
    v_mad_u32_u16 v226, v226, s39, v248 op_sel:[1,0,0,0]
    v_mad_u32_u16 v227, v227, s39, v248 op_sel:[1,0,0,0]
    s_waitcnt lgkmcnt(0)
    v_mad_u32_u16 v228, v228, s39, v248 op_sel:[1,0,0,0]
    v_mad_u32_u16 v229, v229, s39, v248 op_sel:[1,0,0,0]
    s_mov_b32 m0, s68
    s_nop 0
    buffer_load_dwordx4 v222, s[4:7], s44 offen sc1 lds
    buffer_load_dwordx4 v223, s[72:75], s44 offen offset:1024 sc1 lds
    s_mov_b32 m0, s69
    s_nop 0
    buffer_load_dwordx4 v224, s[4:7], s45 offen sc1 lds
    buffer_load_dwordx4 v225, s[72:75], s45 offen offset:1024 sc1 lds
    s_mov_b32 m0, s70
    s_nop 0
    buffer_load_dwordx4 v226, s[4:7], s46 offen sc1 lds
    buffer_load_dwordx4 v227, s[72:75], s46 offen offset:1024 sc1 lds
    s_mov_b32 m0, s71
    s_nop 0
    buffer_load_dwordx4 v228, s[4:7], s47 offen sc1 lds
    buffer_load_dwordx4 v229, s[72:75], s47 offen offset:1024 sc1 lds
    v_add_u32 v249, s48, v249
    v_add_u32 v250, s48, v250
    s_waitcnt vmcnt(6)
    ds_read_b64_tr_b16 v[176:177], v246 offset:0
    ds_read_b64_tr_b16 v[178:179], v246 offset:1024
    ds_read_b64_tr_b16 v[180:181], v247 offset:0
    ds_read_b64_tr_b16 v[182:183], v247 offset:1024
    ds_read_b64_tr_b16 v[0:1], v249 offset:0
    ds_read_b64_tr_b16 v[2:3], v249 offset:32
    ds_read_u16_d16_hi v16, v250 offset:0
    ds_read_b64_tr_b16 v[4:5], v249 offset:512
    ds_read_b64_tr_b16 v[6:7], v249 offset:544
    ds_read_u16_d16_hi v17, v250 offset:128
    s_mov_b32 s29, s48
    s_mov_b32 s32, s31
    s_mov_b32 s30, s3
    s_mov_b32 s31, s35
    s_bfe_u32 s56, s3, 0x40012
    s_cmp_eq_u32 s56, 5
    s_cbranch_scc1 K2_U20
    s_cmp_eq_u32 s56, 6
    s_cbranch_scc1 K2_U3h0
    s_branch K2_DSP0
K2_PAD_H1:
    s_branch KS_HOP0
KS_HELP:
    s_mov_b32 s30, 0
    s_cmp_eq_u32 s20, 6
    s_cbranch_scc1 KS_RAW
    s_mov_b32 s30, 2
    s_cmp_ge_u32 s2, 170
    s_cbranch_scc1 KS_NOW
    s_mov_b32 s30, 1
    v_and_b32 v1, 15, v8
    v_lshrrev_b32 v3, 4, v8
    s_cmp_ge_u32 s2, 160
    s_cbranch_scc1 K1_WT
    s_cmp_ge_u32 s2, 64
    s_cbranch_scc1 K1_S1
    s_lshr_b32 s24, s2, 3
    s_and_b32 s25, s2, 7
    s_lshr_b32 s26, s25, 2
    s_bfe_u32 s27, s25, 0x10001
    s_and_b32 s28, s25, 1
    s_mov_b32 s60, s92
    s_and_b32 s61, s93, 0xffff
    s_mov_b32 s62, 65536
    s_mov_b32 s63, 0x20000
    s_branch K1_SC
K1_S1:
    s_sub_u32 s29, s2, 64
    s_mul_i32 s24, s29, 43
    s_lshr_b32 s24, s24, 9
    s_mul_i32 s25, s24, 12
    s_sub_u32 s25, s29, s25
    s_cmp_ge_u32 s25, 6
    s_cselect_b32 s26, 1, 0
    s_mul_i32 s27, s26, 6
    s_sub_u32 s27, s25, s27
    s_lshr_b32 s27, s27, 1
    s_and_b32 s28, s25, 1
    s_add_u32 s25, s25, 8
    s_mov_b32 s60, s94
    s_and_b32 s61, s95, 0xffff
    s_mov_b32 s62, 98304
    s_mov_b32 s63, 0x20000
K1_SC:
    s_lshl_b32 s27, s27, 7
    s_lshl_b32 s26, s26, 6
    s_lshl_b32 s28, s28, 4
    s_add_u32 s27, s27, s26
    s_add_u32 s27, s27, s28
    s_lshl_b32 s27, s27, 8
    s_lshl_b32 s26, s24, 5
    s_add_u32 s27, s27, s26
    s_add_u32 s29, s27, 8192
    v_lshlrev_b32 v3, 10, v3
    v_lshl_add_u32 v3, v1, 1, v3
    buffer_load_ushort v64, v3, s[60:63], s27 offen offset:0
    buffer_load_ushort v65, v3, s[60:63], s29 offen offset:0
    buffer_load_ushort v66, v3, s[60:63], s27 offen offset:256
    buffer_load_ushort v67, v3, s[60:63], s29 offen offset:256
    buffer_load_ushort v68, v3, s[60:63], s27 offen offset:512
    buffer_load_ushort v69, v3, s[60:63], s29 offen offset:512
    buffer_load_ushort v70, v3, s[60:63], s27 offen offset:768
    buffer_load_ushort v71, v3, s[60:63], s29 offen offset:768
    s_mul_i32 s24, s24, 20
    s_add_u32 s24, s24, s25
    s_lshl_b32 s24, s24, 10
    s_add_u32 s24, s24, 6946816
    s_branch K1_GO
K1_WT:
    s_sub_u32 s24, s2, 160
    s_lshr_b32 s27, s24, 1
    s_and_b32 s28, s24, 1
    s_lshl_b32 s27, s27, 8
    s_lshl_b32 s28, s28, 6
    s_add_u32 s27, s27, s28
    s_add_u32 s29, s27, 10240
    s_mov_b32 s60, s90
    s_and_b32 s61, s91, 0xffff
    s_mov_b32 s62, 20480
    s_mov_b32 s63, 0x20000
    v_and_b32 v1, 31, v8
    v_lshrrev_b32 v3, 5, v8
    v_mul_u32_u24 v3, 5120, v3
    v_lshl_add_u32 v3, v1, 1, v3
    buffer_load_ushort v64, v3, s[60:63], s27 offen offset:0
    buffer_load_ushort v65, v3, s[60:63], s27 offen offset:1280
    buffer_load_ushort v66, v3, s[60:63], s27 offen offset:2560
    buffer_load_ushort v67, v3, s[60:63], s27 offen offset:3840
    buffer_load_ushort v68, v3, s[60:63], s29 offen offset:0
    buffer_load_ushort v69, v3, s[60:63], s29 offen offset:1280
    buffer_load_ushort v70, v3, s[60:63], s29 offen offset:2560
    buffer_load_ushort v71, v3, s[60:63], s29 offen offset:3840
    s_lshl_b32 s24, s24, 10
    s_add_u32 s24, s24, 7110656
K1_GO:
KS_NOW:
    s_barrier
K2_PAD_H2:
    s_cbranch_execz KS_HOP0
    v_and_b32 v76, 31, v8
    v_lshrrev_b32 v77, 5, v8
    v_mov_b32 v80, 0
    v_mul_u32_u24 v77, 2080, v77
    v_mov_b32 v81, 0xffff0000
    v_lshl_add_u32 v78, v76, 4, v77
    v_mov_b32 v82, 0
    v_add_u32 v78, 65536, v78
    v_mov_b32 v83, v81
    v_add_u32 v79, 41600, v78
    ds_write_b128 v78, v[80:83] offset:0
    ds_write_b128 v78, v[80:83] offset:4160
    ds_write_b128 v78, v[80:83] offset:8320
    ds_write_b128 v78, v[80:83] offset:12480
    ds_write_b128 v78, v[80:83] offset:16640
    ds_write_b128 v78, v[80:83] offset:20800
    ds_write_b128 v78, v[80:83] offset:24960
    ds_write_b128 v78, v[80:83] offset:29120
    ds_write_b128 v78, v[80:83] offset:33280
    ds_write_b128 v78, v[80:83] offset:37440
    ds_write_b128 v79, v[80:83] offset:0
    ds_write_b128 v79, v[80:83] offset:4160
    ds_write_b128 v79, v[80:83] offset:8320
    ds_write_b128 v79, v[80:83] offset:12480
    ds_write_b128 v79, v[80:83] offset:16640
    ds_write_b128 v79, v[80:83] offset:20800
    ds_write_b128 v79, v[80:83] offset:24960
    ds_write_b128 v79, v[80:83] offset:29120
    ds_write_b128 v79, v[80:83] offset:33280
    ds_write_b128 v79, v[80:83] offset:37440
KS_FILL:
    v_mov_b32 v59, 163456
    s_barrier
    ds_read_b32 v59, v59
    s_waitcnt vmcnt(0) lgkmcnt(0)
    s_cmp_eq_u32 s30, 0
    s_cbranch_scc1 KS_B3
    s_cmp_eq_u32 s30, 2
    s_cbranch_scc1 KS_NOST
    v_lshl_or_b32 v40, v65, 16, v64
    v_lshl_or_b32 v41, v67, 16, v66
    v_lshl_or_b32 v42, v69, 16, v68
    v_lshl_or_b32 v43, v71, 16, v70
    buffer_store_dwordx4 v[40:43], v9, s[8:11], s24 offen sc1
KS_NOST:
    s_waitcnt lgkmcnt(0)
    s_barrier
    s_lshl_b32 s24, s2, 2
    s_add_u32 s24, s24, 7176192
    s_mov_b64 exec, 1
    s_waitcnt vmcnt(0)
    buffer_store_dword v59, v6, s[8:11], s24 offen sc1
    s_mov_b64 exec, -1
    s_branch KS_JOIN
K2_PAD_H3:
    s_branch KS_HOP0
KS_RAW:
    s_barrier
    s_mov_b32 s60, s90
    s_and_b32 s61, s91, 0xffff
    s_mov_b32 s62, 20480
    s_mov_b32 s63, 0x20000
    v_lshrrev_b32 v10, 3, v8
    v_and_b32 v11, 7, v8
    v_lshlrev_b32 v10, 8, v10
    v_lshl_add_u32 v10, v11, 4, v10
    s_mov_b32 m0, 24576
    s_movk_i32 s24, 0
    buffer_load_dwordx4 v10, s[60:63], s24 offen lds
    s_mov_b32 m0, 25600
    s_movk_i32 s24, 2048
    buffer_load_dwordx4 v10, s[60:63], s24 offen lds
    s_mov_b32 m0, 26624
    s_movk_i32 s24, 4096
    buffer_load_dwordx4 v10, s[60:63], s24 offen lds
    s_mov_b32 m0, 27648
    s_movk_i32 s24, 6144
    buffer_load_dwordx4 v10, s[60:63], s24 offen lds
    s_mov_b32 m0, 28672
    s_movk_i32 s24, 8192
    buffer_load_dwordx4 v10, s[60:63], s24 offen lds
    s_mov_b32 m0, 29696
    s_movk_i32 s24, 10240
    buffer_load_dwordx4 v10, s[60:63], s24 offen lds
    s_mov_b32 m0, 30720
    s_movk_i32 s24, 12288
    buffer_load_dwordx4 v10, s[60:63], s24 offen lds
    s_mov_b32 m0, 31744
    s_movk_i32 s24, 14336
    buffer_load_dwordx4 v10, s[60:63], s24 offen lds
    s_mov_b32 m0, 32768
    s_movk_i32 s24, 16384
    buffer_load_dwordx4 v10, s[60:63], s24 offen lds
    s_mov_b32 m0, 33792
    s_movk_i32 s24, 18432
    buffer_load_dwordx4 v10, s[60:63], s24 offen lds
    s_mov_b32 m0, 152832
    s_movk_i32 s24, 128
    buffer_load_dwordx4 v10, s[60:63], s24 offen lds
    s_mov_b32 m0, 153856
    s_movk_i32 s24, 2176
    buffer_load_dwordx4 v10, s[60:63], s24 offen lds
    s_mov_b32 m0, 154880
    s_movk_i32 s24, 4224
    buffer_load_dwordx4 v10, s[60:63], s24 offen lds
    s_mov_b32 m0, 155904
    s_movk_i32 s24, 6272
    buffer_load_dwordx4 v10, s[60:63], s24 offen lds
    s_mov_b32 m0, 156928
    s_movk_i32 s24, 8320
    buffer_load_dwordx4 v10, s[60:63], s24 offen lds
    s_mov_b32 m0, 157952
    s_movk_i32 s24, 10368
    buffer_load_dwordx4 v10, s[60:63], s24 offen lds
    s_mov_b32 m0, 158976
    s_movk_i32 s24, 12416
    buffer_load_dwordx4 v10, s[60:63], s24 offen lds
    s_mov_b32 m0, 160000
    s_movk_i32 s24, 14464
    buffer_load_dwordx4 v10, s[60:63], s24 offen lds
    s_mov_b32 m0, 161024
    s_movk_i32 s24, 16512
    buffer_load_dwordx4 v10, s[60:63], s24 offen lds
    s_mov_b32 m0, 162048
    s_movk_i32 s24, 18560
    buffer_load_dwordx4 v10, s[60:63], s24 offen lds
    v_add_u32 v85, 16, v8
    v_lshlrev_b32 v84, 5, v8
    v_lshrrev_b32 v85, 6, v85
    v_mul_u32_u24 v85, 1532, v85
    v_sub_u32 v84, v84, v85
    v_mov_b32 v85, -1
    v_add_u32 v84, 66048, v84
    v_add_u32 v86, 41600, v84
    ds_write_b32 v84, v85 offset:0
    ds_write_b32 v84, v85 offset:2080
    ds_write_b32 v84, v85 offset:4160
    ds_write_b32 v84, v85 offset:6240
    ds_write_b32 v84, v85 offset:8320
    ds_write_b32 v84, v85 offset:10400
    ds_write_b32 v84, v85 offset:12480
    ds_write_b32 v84, v85 offset:14560
    ds_write_b32 v84, v85 offset:16640
    ds_write_b32 v84, v85 offset:18720
    ds_write_b32 v84, v85 offset:20800
    ds_write_b32 v84, v85 offset:22880
    ds_write_b32 v84, v85 offset:24960
    ds_write_b32 v84, v85 offset:27040
    ds_write_b32 v84, v85 offset:29120
    ds_write_b32 v84, v85 offset:31200
    ds_write_b32 v84, v85 offset:33280
    ds_write_b32 v84, v85 offset:35360
    ds_write_b32 v84, v85 offset:37440
    ds_write_b32 v84, v85 offset:39520
    ds_write_b32 v86, v85 offset:0
    ds_write_b32 v86, v85 offset:2080
    ds_write_b32 v86, v85 offset:4160
    ds_write_b32 v86, v85 offset:6240
    ds_write_b32 v86, v85 offset:8320
    ds_write_b32 v86, v85 offset:10400
    ds_write_b32 v86, v85 offset:12480
    ds_write_b32 v86, v85 offset:14560
    ds_write_b32 v86, v85 offset:16640
    ds_write_b32 v86, v85 offset:18720
    ds_write_b32 v86, v85 offset:20800
    ds_write_b32 v86, v85 offset:22880
    ds_write_b32 v86, v85 offset:24960
    ds_write_b32 v86, v85 offset:27040
    ds_write_b32 v86, v85 offset:29120
    ds_write_b32 v86, v85 offset:31200
    ds_write_b32 v86, v85 offset:33280
    ds_write_b32 v86, v85 offset:35360
    ds_write_b32 v86, v85 offset:37440
    ds_write_b32 v86, v85 offset:39520
    s_branch KS_FILL
KS_IDLE:
    s_barrier
    s_barrier
    s_branch KS_B3
K2_PAD_U20:
    s_branch K2_HOP
K2_U20:
    s_setprio 1
    s_waitcnt lgkmcnt(0)
    v_lshlrev_b32 v20, 16, v0
    v_and_b32 v21, 0xffff0000, v0
    v_lshlrev_b32 v22, 16, v1
    v_and_b32 v23, 0xffff0000, v1
    v_lshlrev_b32 v24, 16, v2
    v_and_b32 v25, 0xffff0000, v2
    v_lshlrev_b32 v26, 16, v3
    v_and_b32 v27, 0xffff0000, v3
    v_mul_f32_dpp v36, v16, v20 row_newbcast:8 row_mask:0xf bank_mask:0xf
    v_mul_f32_dpp v37, v16, v21 row_newbcast:9 row_mask:0xf bank_mask:0xf
    v_mul_f32_dpp v38, v16, v22 row_newbcast:10 row_mask:0xf bank_mask:0xf
    v_mul_f32_dpp v39, v16, v23 row_newbcast:11 row_mask:0xf bank_mask:0xf
    v_mul_f32_dpp v40, v16, v24 row_newbcast:12 row_mask:0xf bank_mask:0xf
    v_mul_f32_dpp v41, v16, v25 row_newbcast:13 row_mask:0xf bank_mask:0xf
    v_mul_f32_dpp v42, v16, v26 row_newbcast:14 row_mask:0xf bank_mask:0xf
    v_mul_f32_dpp v43, v16, v27 row_newbcast:15 row_mask:0xf bank_mask:0xf
    v_cvt_pk_bf16_f32 v68, v36, v37
    v_cvt_pk_bf16_f32 v69, v38, v39
    v_cvt_pk_bf16_f32 v70, v40, v41
    v_cvt_pk_bf16_f32 v71, v42, v43
    v_mul_f32_dpp v20, v16, v20 row_newbcast:0 row_mask:0xa bank_mask:0xf
    v_mul_f32_dpp v21, v16, v21 row_newbcast:1 row_mask:0xa bank_mask:0xf
    v_mul_f32_dpp v22, v16, v22 row_newbcast:2 row_mask:0xa bank_mask:0xf
    v_mul_f32_dpp v23, v16, v23 row_newbcast:3 row_mask:0xa bank_mask:0xf
    v_mul_f32_dpp v24, v16, v24 row_newbcast:4 row_mask:0xa bank_mask:0xf
    v_mul_f32_dpp v25, v16, v25 row_newbcast:5 row_mask:0xa bank_mask:0xf
    v_mul_f32_dpp v26, v16, v26 row_newbcast:6 row_mask:0xa bank_mask:0xf
    v_mul_f32_dpp v27, v16, v27 row_newbcast:7 row_mask:0xa bank_mask:0xf
    v_cvt_pk_bf16_f32 v64, v20, v21
    v_cvt_pk_bf16_f32 v65, v22, v23
    v_cvt_pk_bf16_f32 v66, v24, v25
    v_cvt_pk_bf16_f32 v67, v26, v27
    v_lshlrev_b32 v28, 16, v4
    v_and_b32 v29, 0xffff0000, v4
    v_lshlrev_b32 v30, 16, v5
    v_and_b32 v31, 0xffff0000, v5
    v_lshlrev_b32 v32, 16, v6
    v_and_b32 v33, 0xffff0000, v6
    v_lshlrev_b32 v34, 16, v7
    v_and_b32 v35, 0xffff0000, v7
    v_mul_f32_dpp v36, v17, v28 row_newbcast:8 row_mask:0xf bank_mask:0xf
    v_mul_f32_dpp v37, v17, v29 row_newbcast:9 row_mask:0xf bank_mask:0xf
    v_mul_f32_dpp v38, v17, v30 row_newbcast:10 row_mask:0xf bank_mask:0xf
    v_mul_f32_dpp v39, v17, v31 row_newbcast:11 row_mask:0xf bank_mask:0xf
    v_mul_f32_dpp v40, v17, v32 row_newbcast:12 row_mask:0xf bank_mask:0xf
    v_mul_f32_dpp v41, v17, v33 row_newbcast:13 row_mask:0xf bank_mask:0xf
    v_mul_f32_dpp v42, v17, v34 row_newbcast:14 row_mask:0xf bank_mask:0xf
    v_mul_f32_dpp v43, v17, v35 row_newbcast:15 row_mask:0xf bank_mask:0xf
    v_cvt_pk_bf16_f32 v76, v36, v37
    v_cvt_pk_bf16_f32 v77, v38, v39
    v_cvt_pk_bf16_f32 v78, v40, v41
    v_cvt_pk_bf16_f32 v79, v42, v43
    v_mul_f32_dpp v28, v17, v28 row_newbcast:0 row_mask:0xa bank_mask:0xf
    v_mul_f32_dpp v29, v17, v29 row_newbcast:1 row_mask:0xa bank_mask:0xf
    v_mul_f32_dpp v30, v17, v30 row_newbcast:2 row_mask:0xa bank_mask:0xf
    v_mul_f32_dpp v31, v17, v31 row_newbcast:3 row_mask:0xa bank_mask:0xf
    v_mul_f32_dpp v32, v17, v32 row_newbcast:4 row_mask:0xa bank_mask:0xf
    v_mul_f32_dpp v33, v17, v33 row_newbcast:5 row_mask:0xa bank_mask:0xf
    v_mul_f32_dpp v34, v17, v34 row_newbcast:6 row_mask:0xa bank_mask:0xf
    v_mul_f32_dpp v35, v17, v35 row_newbcast:7 row_mask:0xa bank_mask:0xf
    v_cvt_pk_bf16_f32 v72, v28, v29
    v_cvt_pk_bf16_f32 v73, v30, v31
    v_cvt_pk_bf16_f32 v74, v32, v33
    v_cvt_pk_bf16_f32 v75, v34, v35
    s_waitcnt vmcnt(4)
    v_mfma_f32_32x32x16_bf16 v[0:15], v[64:67], v[176:179], 0
    ds_read_b64_tr_b16 v[184:185], v246 offset:2048
    ds_read_b64_tr_b16 v[186:187], v246 offset:3072
    ds_read_b64_tr_b16 v[188:189], v247 offset:2048
    ds_read_b64_tr_b16 v[190:191], v247 offset:3072
    s_mov_b32 m0, s68
    v_mfma_f32_32x32x16_bf16 v[16:31], v[68:71], v[176:179], 0
    buffer_load_dwordx4 v222, s[4:7], s42 offen sc1 lds
    buffer_load_dwordx4 v223, s[72:75], s42 offen offset:1024 sc1 lds
    v_permlane32_swap_b32 v242, v236
    v_permlane32_swap_b32 v243, v237
    s_add_u32 s38, s38, 1
    v_mfma_f32_32x32x16_bf16 v[32:47], v[64:67], v[180:183], 0
    v_permlane32_swap_b32 v244, v238
    v_permlane32_swap_b32 v245, v239
    v_permlane32_swap_b32 v240, v241
    v_add_f32 v242, v242, v236
    v_mfma_f32_32x32x16_bf16 v[48:63], v[68:71], v[180:183], 0
    v_add_f32 v243, v243, v237
    v_add_f32 v244, v244, v238
    v_add_f32 v245, v245, v239
    v_add_f32 v240, -v240, -v241
    v_mov_b32 v254, s52
    v_mov_b32 v255, s38
    s_waitcnt vmcnt(4) lgkmcnt(0)
    v_mfma_f32_32x32x16_bf16 v[0:15], v[72:75], v[184:187], v[0:15]
    ds_read_b64_tr_b16 v[176:177], v246 offset:4096
    ds_read_b64_tr_b16 v[178:179], v246 offset:5120
    ds_read_b64_tr_b16 v[180:181], v247 offset:4096
    ds_read_b64_tr_b16 v[182:183], v247 offset:5120
    s_lshl_b32 s58, s38, 3
    s_add_u32 s58, s58, s20
    s_mov_b32 m0, s69
    v_mfma_f32_32x32x16_bf16 v[16:31], v[76:79], v[184:187], v[16:31]
    buffer_load_dwordx4 v224, s[4:7], s42 offen sc1 lds
    buffer_load_dwordx4 v225, s[72:75], s42 offen offset:1024 sc1 lds
    s_set_gpr_idx_on s32, gpr_idx(DST)
    s_nop 0
    v_cvt_pk_bf16_f32 v195, v242, v243
    v_cvt_pk_bf16_f32 v196, v244, v245
    v_cvt_pk_bf16_f32 v197, v240, v240
    s_set_gpr_idx_off
    s_mov_b64 exec, 1
    ds_write_b32 v254, v255
    s_mov_b64 exec, -1
    s_cmp_lt_u32 s58, s22
    s_cbranch_scc0 K2_dyn_8
K2_back_9:
    v_readlane_b32 s3, v253, s58
    s_lshl_b32 s44, s34, 7
    s_and_b32 s48, s3, 0x3ffff
    s_bfe_u32 s33, s3, 0x30013
    s_mul_i32 s35, s38, 6
    s_cmp_eq_u32 s34, 0
    s_cselect_b32 s35, s35, s48
    s_mov_b32 s45, s44
    s_add_u32 s47, s44, 256
    s_add_u32 s49, s48, 128
    s_add_u32 s60, s48, 256
    s_cmp_eq_u32 s33, 3
    s_cselect_b32 s46, s44, s47
    s_cselect_b32 s50, s60, s48
    s_cselect_b32 s51, s48, s49
    s_sub_u32 s60, s33, 2
    s_cmp_lt_u32 s60, 2
    s_cbranch_scc0 K2_rare_14
K2_back_15:
    v_mfma_f32_32x32x16_bf16 v[32:47], v[72:75], v[188:191], v[32:47]
    v_add_u32 v233, s48, v230
    ds_read_b32 v232, v233
    ds_read_b32 v233, v233 offset:1024
    v_mul_f32 v234, v0, v96
    v_mul_f32 v236, v8, v128
    v_fmac_f32 v234, v1, v97
    v_fmac_f32 v236, v9, v129
    v_mfma_f32_32x32x16_bf16 v[48:63], v[76:79], v[188:191], v[48:63]
    s_setprio 0
    v_fmac_f32 v234, v2, v98
    v_fmac_f32 v236, v10, v130
    v_fmac_f32 v234, v3, v99
    v_fmac_f32 v236, v11, v131
    v_fmac_f32 v234, v4, v100
    v_fmac_f32 v236, v12, v132
    v_fmac_f32 v234, v5, v101
    v_fmac_f32 v236, v13, v133
    v_fmac_f32 v234, v6, v102
    v_fmac_f32 v236, v14, v134
    v_fmac_f32 v234, v7, v103
    v_fmac_f32 v236, v15, v135
    v_mul_f32 v238, v16, v128
    v_mul_f32 v240, v24, v128
    v_fmac_f32 v238, v17, v129
    v_fmac_f32 v240, v25, v129
    v_fmac_f32 v238, v18, v130
    v_fmac_f32 v240, v26, v130
    v_fmac_f32 v238, v19, v131
    v_fmac_f32 v240, v27, v131
    v_fmac_f32 v238, v20, v132
    v_fmac_f32 v240, v28, v132
    v_fmac_f32 v238, v21, v133
    v_fmac_f32 v240, v29, v133
    v_fmac_f32 v238, v22, v134
    v_fmac_f32 v240, v30, v134
    v_fmac_f32 v238, v23, v135
    v_fmac_f32 v240, v31, v135
    v_mul_f32 v235, v32, v104
    v_mul_f32 v237, v40, v136
    v_fmac_f32 v235, v33, v105
    v_fmac_f32 v237, v41, v137
    v_fmac_f32 v235, v34, v106
    v_fmac_f32 v237, v42, v138
    v_fmac_f32 v235, v35, v107
    v_fmac_f32 v237, v43, v139
    v_fmac_f32 v235, v36, v108
    v_fmac_f32 v237, v44, v140
    v_fmac_f32 v235, v37, v109
    v_fmac_f32 v237, v45, v141
    v_fmac_f32 v235, v38, v110
    v_fmac_f32 v237, v46, v142
    v_fmac_f32 v235, v39, v111
    v_fmac_f32 v237, v47, v143
    v_mul_f32 v239, v48, v136
    v_mul_f32 v241, v56, v136
    v_fmac_f32 v239, v49, v137
    v_fmac_f32 v241, v57, v137
    s_setprio 1
    s_waitcnt vmcnt(4) lgkmcnt(3)
    v_mfma_f32_32x32x16_bf16 v[0:15], v[64:67], v[176:179], 0
    ds_read_b64_tr_b16 v[184:185], v246 offset:6144
    ds_read_b64_tr_b16 v[186:187], v246 offset:7168
    ds_read_b64_tr_b16 v[188:189], v247 offset:6144
    ds_read_b64_tr_b16 v[190:191], v247 offset:7168
    v_fmac_f32 v239, v50, v138
    v_fmac_f32 v241, v58, v138
    s_mov_b32 m0, s70
    v_mfma_f32_32x32x16_bf16 v[16:31], v[68:71], v[176:179], 0
    buffer_load_dwordx4 v222, s[4:7], s43 offen sc1 lds
    buffer_load_dwordx4 v223, s[72:75], s43 offen offset:1024 sc1 lds
    v_fmac_f32 v239, v51, v139
    v_fmac_f32 v241, v59, v139
    v_fmac_f32 v239, v52, v140
    v_fmac_f32 v241, v60, v140
    v_fmac_f32 v239, v53, v141
    v_mfma_f32_32x32x16_bf16 v[32:47], v[64:67], v[180:183], 0
    v_add_u32 v222, s48, v251
    ds_read2_b32 v[222:223], v222 offset0:1 offset1:3
    v_fmac_f32 v241, v61, v141
    v_fmac_f32 v239, v54, v142
    v_fmac_f32 v241, v62, v142
    v_fmac_f32 v239, v55, v143
    v_fmac_f32 v241, v63, v143
    v_mfma_f32_32x32x16_bf16 v[48:63], v[68:71], v[180:183], 0
    v_permlane32_swap_b32 v234, v236
    v_permlane32_swap_b32 v235, v237
    v_permlane32_swap_b32 v240, v238
    s_waitcnt lgkmcnt(5)
    v_or_b32 v232, v232, v231
    v_or_b32 v233, v233, v231
    s_cmp_lg_u32 s34, 0
    s_cbranch_scc1 K2_dum_17
    s_cmp_eq_u32 s33, 4
    s_cbranch_scc1 K2_a4_18
K2_b4_20:
    s_add_u32 m0, s48, 512
    s_add_u32 s65, s48, 1536
    buffer_load_dwordx4 v232, s[16:19], 0 offen  lds
    s_mov_b32 m0, s65
    s_mov_b32 exec_hi, 0
    buffer_load_dwordx4 v233, s[16:19], 0 offen  lds
    s_mov_b32 exec_hi, -1
K2_back_19:
    s_waitcnt vmcnt(6) lgkmcnt(1)
    v_mfma_f32_32x32x16_bf16 v[0:15], v[72:75], v[184:187], v[0:15]
    ds_read_b64_tr_b16 v[176:177], v246 offset:0
    ds_read_b64_tr_b16 v[178:179], v246 offset:1024
    ds_read_b64_tr_b16 v[180:181], v247 offset:0
    ds_read_b64_tr_b16 v[182:183], v247 offset:1024
    v_permlane32_swap_b32 v241, v239
    s_mov_b32 m0, s71
    v_mfma_f32_32x32x16_bf16 v[16:31], v[76:79], v[184:187], v[16:31]
    buffer_load_dwordx4 v224, s[4:7], s43 offen sc1 lds
    buffer_load_dwordx4 v225, s[72:75], s43 offen offset:1024 sc1 lds
    s_waitcnt lgkmcnt(4)
    v_mad_u32_u16 v222, v222, s39, v248 op_sel:[1,0,0,0]
    v_mad_u32_u16 v223, v223, s39, v248 op_sel:[1,0,0,0]
    v_add_f32 v234, v234, v236
    v_add_f32 v235, v235, v237
    v_add_f32 v240, v240, v238
    v_add_f32 v241, v241, v239
    s_set_gpr_idx_on s31, gpr_idx(DST)
    s_nop 0
    v_cvt_pk_bf16_f32 v192, v234, v235
    v_cvt_pk_bf16_f32 v193, v240, v241
    s_set_gpr_idx_off
    v_mfma_f32_32x32x16_bf16 v[32:47], v[72:75], v[188:191], v[32:47]
    v_add_u32 v224, s49, v251
    ds_read2_b32 v[224:225], v224 offset0:1 offset1:3
    v_mul_f32 v234, v0, v144
    v_mul_f32 v236, v8, v112
    v_fmac_f32 v234, v1, v145
    v_fmac_f32 v236, v9, v113
    v_fmac_f32 v234, v2, v146
    v_mfma_f32_32x32x16_bf16 v[48:63], v[76:79], v[188:191], v[48:63]
    s_setprio 0
    v_fmac_f32 v236, v10, v114
    v_fmac_f32 v234, v3, v147
    v_fmac_f32 v236, v11, v115
    v_fmac_f32 v234, v4, v148
    v_fmac_f32 v236, v12, v116
    v_fmac_f32 v234, v5, v149
    v_fmac_f32 v236, v13, v117
    v_fmac_f32 v234, v6, v150
    v_fmac_f32 v236, v14, v118
    v_fmac_f32 v234, v7, v151
    v_fmac_f32 v236, v15, v119
    v_mul_f32 v238, v16, v160
    v_mul_f32 v240, v24, v160
    v_fmac_f32 v238, v17, v161
    v_fmac_f32 v240, v25, v161
    v_fmac_f32 v238, v18, v162
    v_fmac_f32 v240, v26, v162
    v_fmac_f32 v238, v19, v163
    v_fmac_f32 v240, v27, v163
    v_fmac_f32 v238, v20, v164
    v_fmac_f32 v240, v28, v164
    v_fmac_f32 v238, v21, v165
    v_fmac_f32 v240, v29, v165
    v_fmac_f32 v238, v22, v166
    v_fmac_f32 v240, v30, v166
    v_fmac_f32 v238, v23, v167
    v_fmac_f32 v240, v31, v167
    v_mul_f32 v235, v32, v152
    v_mul_f32 v237, v40, v120
    v_fmac_f32 v235, v33, v153
    v_fmac_f32 v237, v41, v121
    v_fmac_f32 v235, v34, v154
    v_fmac_f32 v237, v42, v122
    v_fmac_f32 v235, v35, v155
    v_fmac_f32 v237, v43, v123
    v_fmac_f32 v235, v36, v156
    v_fmac_f32 v237, v44, v124
    v_fmac_f32 v235, v37, v157
    v_fmac_f32 v237, v45, v125
    v_fmac_f32 v235, v38, v158
    v_fmac_f32 v237, v46, v126
    v_fmac_f32 v235, v39, v159
    v_fmac_f32 v237, v47, v127
    v_mul_f32 v239, v48, v168
    v_mul_f32 v241, v56, v168
    v_fmac_f32 v239, v49, v169
    v_fmac_f32 v241, v57, v169
    v_fmac_f32 v239, v50, v170
    v_fmac_f32 v241, v58, v170
    v_fmac_f32 v239, v51, v171
    s_setprio 1
    s_waitcnt vmcnt(6) lgkmcnt(1)
    v_mfma_f32_32x32x16_bf16 v[0:15], v[64:67], v[176:179], 0
    ds_read_b64_tr_b16 v[184:185], v246 offset:2048
    ds_read_b64_tr_b16 v[186:187], v246 offset:3072
    ds_read_b64_tr_b16 v[188:189], v247 offset:2048
    ds_read_b64_tr_b16 v[190:191], v247 offset:3072
    v_fmac_f32 v241, v59, v171
    v_fmac_f32 v239, v52, v172
    s_mov_b32 m0, s68
    v_mfma_f32_32x32x16_bf16 v[16:31], v[68:71], v[176:179], 0
    buffer_load_dwordx4 v222, s[4:7], s44 offen sc1 lds
    buffer_load_dwordx4 v223, s[72:75], s44 offen offset:1024 sc1 lds
    s_waitcnt lgkmcnt(4)
    v_mad_u32_u16 v224, v224, s39, v248 op_sel:[1,0,0,0]
    v_mad_u32_u16 v225, v225, s39, v248 op_sel:[1,0,0,0]
    v_fmac_f32 v241, v60, v172
    v_fmac_f32 v239, v53, v173
    v_mfma_f32_32x32x16_bf16 v[32:47], v[64:67], v[180:183], 0
    v_add_u32 v226, s50, v251
    ds_read2_b32 v[226:227], v226 offset0:1 offset1:3
    v_fmac_f32 v241, v61, v173
    v_fmac_f32 v239, v54, v174
    v_fmac_f32 v241, v62, v174
    v_fmac_f32 v239, v55, v175
    v_fmac_f32 v241, v63, v175
    v_mfma_f32_32x32x16_bf16 v[48:63], v[68:71], v[180:183], 0
    s_waitcnt vmcnt(6) lgkmcnt(1)
    v_mfma_f32_32x32x16_bf16 v[0:15], v[72:75], v[184:187], v[0:15]
    ds_read_b64_tr_b16 v[176:177], v246 offset:4096
    ds_read_b64_tr_b16 v[178:179], v246 offset:5120
    ds_read_b64_tr_b16 v[180:181], v247 offset:4096
    ds_read_b64_tr_b16 v[182:183], v247 offset:5120
    s_mov_b32 m0, s69
    v_mfma_f32_32x32x16_bf16 v[16:31], v[76:79], v[184:187], v[16:31]
    buffer_load_dwordx4 v224, s[4:7], s45 offen sc1 lds
    buffer_load_dwordx4 v225, s[72:75], s45 offen offset:1024 sc1 lds
    s_waitcnt lgkmcnt(4)
    v_mad_u32_u16 v226, v226, s39, v248 op_sel:[1,0,0,0]
    v_mad_u32_u16 v227, v227, s39, v248 op_sel:[1,0,0,0]
    v_mfma_f32_32x32x16_bf16 v[32:47], v[72:75], v[188:191], v[32:47]
    v_add_u32 v228, s51, v251
    ds_read2_b32 v[228:229], v228 offset0:1 offset1:3
    v_mul_f32 v242, v0, v144
    v_fma_f32 v238, v8, v160, -v238
    v_fmac_f32 v242, v1, v145
    v_fmac_f32 v238, v9, v161
    v_fmac_f32 v242, v2, v146
    v_mfma_f32_32x32x16_bf16 v[48:63], v[76:79], v[188:191], v[48:63]
    s_setprio 0
    v_fmac_f32 v238, v10, v162
    v_fmac_f32 v242, v3, v147
    v_fmac_f32 v238, v11, v163
    v_fmac_f32 v242, v4, v148
    v_fmac_f32 v238, v12, v164
    v_fmac_f32 v242, v5, v149
    v_fmac_f32 v238, v13, v165
    v_fmac_f32 v242, v6, v150
    v_fmac_f32 v238, v14, v166
    v_fmac_f32 v242, v7, v151
    v_fmac_f32 v238, v15, v167
    v_fmac_f32 v236, v16, v112
    v_mul_f32 v244, v24, v160
    v_fmac_f32 v236, v17, v113
    v_fmac_f32 v244, v25, v161
    v_fmac_f32 v236, v18, v114
    v_fmac_f32 v244, v26, v162
    v_fmac_f32 v236, v19, v115
    v_fmac_f32 v244, v27, v163
    v_fmac_f32 v236, v20, v116
    v_fmac_f32 v244, v28, v164
    v_fmac_f32 v236, v21, v117
    v_fmac_f32 v244, v29, v165
    v_fmac_f32 v236, v22, v118
    v_fmac_f32 v244, v30, v166
    v_fmac_f32 v236, v23, v119
    v_fmac_f32 v244, v31, v167
    v_mul_f32 v243, v32, v152
    v_fma_f32 v239, v40, v168, -v239
    v_fmac_f32 v243, v33, v153
    v_fmac_f32 v239, v41, v169
    v_fmac_f32 v243, v34, v154
    v_fmac_f32 v239, v42, v170
    v_fmac_f32 v243, v35, v155
    v_fmac_f32 v239, v43, v171
    v_fmac_f32 v243, v36, v156
    v_fmac_f32 v239, v44, v172
    v_fmac_f32 v243, v37, v157
    v_fmac_f32 v239, v45, v173
    v_fmac_f32 v243, v38, v158
    v_fmac_f32 v239, v46, v174
    v_fmac_f32 v243, v39, v159
    v_fmac_f32 v239, v47, v175
    v_fmac_f32 v237, v48, v120
    v_mul_f32 v245, v56, v168
    v_fmac_f32 v237, v49, v121
    v_fmac_f32 v245, v57, v169
    v_fmac_f32 v237, v50, v122
    s_setprio 1
    s_waitcnt vmcnt(4) lgkmcnt(1)
    v_mfma_f32_32x32x16_bf16 v[0:15], v[64:67], v[176:179], 0
    ds_read_b64_tr_b16 v[184:185], v246 offset:6144
    ds_read_b64_tr_b16 v[186:187], v246 offset:7168
    ds_read_b64_tr_b16 v[188:189], v247 offset:6144
    ds_read_b64_tr_b16 v[190:191], v247 offset:7168
    v_fmac_f32 v245, v58, v170
    v_fmac_f32 v237, v51, v123
    s_mov_b32 m0, s70
    v_mfma_f32_32x32x16_bf16 v[16:31], v[68:71], v[176:179], 0
    buffer_load_dwordx4 v226, s[4:7], s46 offen sc1 lds
    buffer_load_dwordx4 v227, s[72:75], s46 offen offset:1024 sc1 lds
    s_waitcnt lgkmcnt(4)
    v_mad_u32_u16 v228, v228, s39, v248 op_sel:[1,0,0,0]
    v_mad_u32_u16 v229, v229, s39, v248 op_sel:[1,0,0,0]
    v_fmac_f32 v245, v59, v171
    v_fmac_f32 v237, v52, v124
    v_mfma_f32_32x32x16_bf16 v[32:47], v[64:67], v[180:183], 0
    v_fmac_f32 v245, v60, v172
    v_fmac_f32 v237, v53, v125
    v_fmac_f32 v245, v61, v173
    v_fmac_f32 v237, v54, v126
    v_fmac_f32 v245, v62, v174
    v_fmac_f32 v237, v55, v127
    v_fmac_f32 v245, v63, v175
    v_mfma_f32_32x32x16_bf16 v[48:63], v[68:71], v[180:183], 0
    v_permlane32_swap_b32 v242, v234
    v_permlane32_swap_b32 v243, v235
    v_add_f32 v242, v242, v234
    v_add_f32 v243, v243, v235
    s_waitcnt vmcnt(4) lgkmcnt(0)
    v_mfma_f32_32x32x16_bf16 v[0:15], v[72:75], v[184:187], v[0:15]
    ds_read_b64_tr_b16 v[176:177], v246 offset:0
    ds_read_b64_tr_b16 v[178:179], v246 offset:1024
    ds_read_b64_tr_b16 v[180:181], v247 offset:0
    ds_read_b64_tr_b16 v[182:183], v247 offset:1024
    s_sub_u32 s26, s48, s29
    s_mov_b32 s29, s48
    s_mov_b32 m0, s71
    v_mfma_f32_32x32x16_bf16 v[16:31], v[76:79], v[184:187], v[16:31]
    buffer_load_dwordx4 v228, s[4:7], s47 offen sc1 lds
    buffer_load_dwordx4 v229, s[72:75], s47 offen offset:1024 sc1 lds
    s_set_gpr_idx_on s31, gpr_idx(DST)
    s_nop 0
    v_cvt_pk_bf16_f32 v194, v242, v243
    s_set_gpr_idx_off
    s_mov_b32 s30, s3
    s_bfe_u32 s56, s3, 0x40012
    s_cmp_eq_u32 s34, 0
    s_cselect_b32 s56, s56, 0
    v_mfma_f32_32x32x16_bf16 v[32:47], v[72:75], v[188:191], v[32:47]
    s_mov_b32 s32, s31
    s_mov_b32 s31, s35
    v_mul_f32 v242, v0, v144
    v_fma_f32 v240, v8, v160, -v240
    v_fmac_f32 v242, v1, v145
    v_fmac_f32 v240, v9, v161
    v_fmac_f32 v242, v2, v146
    v_mfma_f32_32x32x16_bf16 v[48:63], v[76:79], v[188:191], v[48:63]
    s_setprio 0
    v_fmac_f32 v240, v10, v162
    v_fmac_f32 v242, v3, v147
    v_fmac_f32 v240, v11, v163
    v_fmac_f32 v242, v4, v148
    v_fmac_f32 v240, v12, v164
    v_fmac_f32 v242, v5, v149
    v_fmac_f32 v240, v13, v165
    v_fmac_f32 v242, v6, v150
    v_fmac_f32 v240, v14, v166
    v_fmac_f32 v242, v7, v151
    v_fmac_f32 v240, v15, v167
    v_add_u32 v249, s26, v249
    v_add_u32 v250, s26, v250
    v_fma_f32 v244, v16, v160, -v244
    v_fmac_f32 v236, v24, v112
    v_fmac_f32 v244, v17, v161
    v_fmac_f32 v236, v25, v113
    v_fmac_f32 v244, v18, v162
    v_fmac_f32 v236, v26, v114
    v_fmac_f32 v244, v19, v163
    v_fmac_f32 v236, v27, v115
    v_fmac_f32 v244, v20, v164
    v_fmac_f32 v236, v28, v116
    v_fmac_f32 v244, v21, v165
    v_fmac_f32 v236, v29, v117
    v_fmac_f32 v244, v22, v166
    v_fmac_f32 v236, v30, v118
    v_fmac_f32 v244, v23, v167
    v_fmac_f32 v236, v31, v119
    ds_read_b64_tr_b16 v[0:1], v249 offset:0
    ds_read_b64_tr_b16 v[2:3], v249 offset:32
    ds_read_u16_d16_hi v16, v250 offset:0
    v_mul_f32 v243, v32, v152
    v_fma_f32 v241, v40, v168, -v241
    v_fmac_f32 v243, v33, v153
    v_fmac_f32 v241, v41, v169
    v_fmac_f32 v243, v34, v154
    v_fmac_f32 v241, v42, v170
    v_fmac_f32 v243, v35, v155
    v_fmac_f32 v241, v43, v171
    v_fmac_f32 v243, v36, v156
    v_fmac_f32 v241, v44, v172
    v_fmac_f32 v243, v37, v157
    v_fmac_f32 v241, v45, v173
    v_fmac_f32 v243, v38, v158
    v_fmac_f32 v241, v46, v174
    v_fmac_f32 v243, v39, v159
    v_fmac_f32 v241, v47, v175
    ds_read_b64_tr_b16 v[4:5], v249 offset:512
    ds_read_b64_tr_b16 v[6:7], v249 offset:544
    ds_read_u16_d16_hi v17, v250 offset:128
    v_fma_f32 v245, v48, v168, -v245
    v_fmac_f32 v237, v56, v120
    v_fmac_f32 v245, v49, v169
    v_fmac_f32 v237, v57, v121
    v_fmac_f32 v245, v50, v170
    v_fmac_f32 v237, v58, v122
    v_fmac_f32 v245, v51, v171
    v_fmac_f32 v237, v59, v123
    v_fmac_f32 v245, v52, v172
    v_fmac_f32 v237, v60, v124
    v_fmac_f32 v245, v53, v173
    v_fmac_f32 v237, v61, v125
    v_fmac_f32 v245, v54, v174
    v_fmac_f32 v237, v62, v126
    v_fmac_f32 v245, v55, v175
    v_fmac_f32 v237, v63, v127
    s_cmp_eq_u32 s56, 5
    s_cbranch_scc1 K2_U20
    s_cmp_eq_u32 s56, 6
    s_cbranch_scc1 K2_U3h0
    s_branch K2_DSP0
K2_PAD_U30:
    s_branch K2_HOP
K2_U3h0:
    s_setprio 1
    ds_read_b64_tr_b16 v[8:9], v249 offset:1024
    ds_read_u16_d16_hi v18, v250 offset:256
    s_waitcnt lgkmcnt(2)
    v_lshlrev_b32 v20, 16, v0
    v_and_b32 v21, 0xffff0000, v0
    v_lshlrev_b32 v22, 16, v1
    v_and_b32 v23, 0xffff0000, v1
    v_lshlrev_b32 v24, 16, v2
    v_and_b32 v25, 0xffff0000, v2
    v_lshlrev_b32 v26, 16, v3
    v_and_b32 v27, 0xffff0000, v3
    v_mul_f32_dpp v36, v16, v20 row_newbcast:8 row_mask:0xf bank_mask:0xf
    v_mul_f32_dpp v37, v16, v21 row_newbcast:9 row_mask:0xf bank_mask:0xf
    v_mul_f32_dpp v38, v16, v22 row_newbcast:10 row_mask:0xf bank_mask:0xf
    v_mul_f32_dpp v39, v16, v23 row_newbcast:11 row_mask:0xf bank_mask:0xf
    v_mul_f32_dpp v40, v16, v24 row_newbcast:12 row_mask:0xf bank_mask:0xf
    v_mul_f32_dpp v41, v16, v25 row_newbcast:13 row_mask:0xf bank_mask:0xf
    v_mul_f32_dpp v42, v16, v26 row_newbcast:14 row_mask:0xf bank_mask:0xf
    v_mul_f32_dpp v43, v16, v27 row_newbcast:15 row_mask:0xf bank_mask:0xf
    v_cvt_pk_bf16_f32 v68, v36, v37
    v_cvt_pk_bf16_f32 v69, v38, v39
    v_cvt_pk_bf16_f32 v70, v40, v41
    v_cvt_pk_bf16_f32 v71, v42, v43
    v_mul_f32_dpp v20, v16, v20 row_newbcast:0 row_mask:0xa bank_mask:0xf
    v_mul_f32_dpp v21, v16, v21 row_newbcast:1 row_mask:0xa bank_mask:0xf
    v_mul_f32_dpp v22, v16, v22 row_newbcast:2 row_mask:0xa bank_mask:0xf
    v_mul_f32_dpp v23, v16, v23 row_newbcast:3 row_mask:0xa bank_mask:0xf
    v_mul_f32_dpp v24, v16, v24 row_newbcast:4 row_mask:0xa bank_mask:0xf
    v_mul_f32_dpp v25, v16, v25 row_newbcast:5 row_mask:0xa bank_mask:0xf
    v_mul_f32_dpp v26, v16, v26 row_newbcast:6 row_mask:0xa bank_mask:0xf
    v_mul_f32_dpp v27, v16, v27 row_newbcast:7 row_mask:0xa bank_mask:0xf
    v_cvt_pk_bf16_f32 v64, v20, v21
    v_cvt_pk_bf16_f32 v65, v22, v23
    v_cvt_pk_bf16_f32 v66, v24, v25
    v_cvt_pk_bf16_f32 v67, v26, v27
    v_lshlrev_b32 v28, 16, v4
    v_and_b32 v29, 0xffff0000, v4
    v_lshlrev_b32 v30, 16, v5
    v_and_b32 v31, 0xffff0000, v5
    v_lshlrev_b32 v32, 16, v6
    v_and_b32 v33, 0xffff0000, v6
    v_lshlrev_b32 v34, 16, v7
    v_and_b32 v35, 0xffff0000, v7
    v_mul_f32_dpp v36, v17, v28 row_newbcast:8 row_mask:0xf bank_mask:0xf
    v_mul_f32_dpp v37, v17, v29 row_newbcast:9 row_mask:0xf bank_mask:0xf
    v_mul_f32_dpp v38, v17, v30 row_newbcast:10 row_mask:0xf bank_mask:0xf
    v_mul_f32_dpp v39, v17, v31 row_newbcast:11 row_mask:0xf bank_mask:0xf
    v_mul_f32_dpp v40, v17, v32 row_newbcast:12 row_mask:0xf bank_mask:0xf
    v_mul_f32_dpp v41, v17, v33 row_newbcast:13 row_mask:0xf bank_mask:0xf
    v_mul_f32_dpp v42, v17, v34 row_newbcast:14 row_mask:0xf bank_mask:0xf
    v_mul_f32_dpp v43, v17, v35 row_newbcast:15 row_mask:0xf bank_mask:0xf
    v_cvt_pk_bf16_f32 v76, v36, v37
    v_cvt_pk_bf16_f32 v77, v38, v39
    v_cvt_pk_bf16_f32 v78, v40, v41
    v_cvt_pk_bf16_f32 v79, v42, v43
    v_mul_f32_dpp v28, v17, v28 row_newbcast:0 row_mask:0xa bank_mask:0xf
    v_mul_f32_dpp v29, v17, v29 row_newbcast:1 row_mask:0xa bank_mask:0xf
    v_mul_f32_dpp v30, v17, v30 row_newbcast:2 row_mask:0xa bank_mask:0xf
    v_mul_f32_dpp v31, v17, v31 row_newbcast:3 row_mask:0xa bank_mask:0xf
    v_mul_f32_dpp v32, v17, v32 row_newbcast:4 row_mask:0xa bank_mask:0xf
    v_mul_f32_dpp v33, v17, v33 row_newbcast:5 row_mask:0xa bank_mask:0xf
    v_mul_f32_dpp v34, v17, v34 row_newbcast:6 row_mask:0xa bank_mask:0xf
    v_mul_f32_dpp v35, v17, v35 row_newbcast:7 row_mask:0xa bank_mask:0xf
    v_cvt_pk_bf16_f32 v72, v28, v29
    v_cvt_pk_bf16_f32 v73, v30, v31
    v_cvt_pk_bf16_f32 v74, v32, v33
    v_cvt_pk_bf16_f32 v75, v34, v35
    s_waitcnt lgkmcnt(0)
    v_lshlrev_b32 v20, 16, v8
    v_and_b32 v21, 0xffff0000, v8
    v_lshlrev_b32 v22, 16, v9
    v_and_b32 v23, 0xffff0000, v9
    v_mul_f32_dpp v36, v18, v20 row_newbcast:8 row_mask:0xf bank_mask:0xf
    v_mul_f32_dpp v37, v18, v21 row_newbcast:9 row_mask:0xf bank_mask:0xf
    v_mul_f32_dpp v38, v18, v22 row_newbcast:10 row_mask:0xf bank_mask:0xf
    v_mul_f32_dpp v39, v18, v23 row_newbcast:11 row_mask:0xf bank_mask:0xf
    v_cvt_pk_bf16_f32 v84, v36, v37
    v_cvt_pk_bf16_f32 v85, v38, v39
    v_mul_f32_dpp v20, v18, v20 row_newbcast:0 row_mask:0xa bank_mask:0xf
    v_mul_f32_dpp v21, v18, v21 row_newbcast:1 row_mask:0xa bank_mask:0xf
    v_mul_f32_dpp v22, v18, v22 row_newbcast:2 row_mask:0xa bank_mask:0xf
    v_mul_f32_dpp v23, v18, v23 row_newbcast:3 row_mask:0xa bank_mask:0xf
    v_cvt_pk_bf16_f32 v80, v20, v21
    v_cvt_pk_bf16_f32 v81, v22, v23
    s_waitcnt vmcnt(4)
    v_mfma_f32_32x32x16_bf16 v[0:15], v[64:67], v[176:179], 0
    ds_read_b64_tr_b16 v[184:185], v246 offset:2048
    ds_read_b64_tr_b16 v[186:187], v246 offset:3072
    ds_read_b64_tr_b16 v[188:189], v247 offset:2048
    ds_read_b64_tr_b16 v[190:191], v247 offset:3072
    s_mov_b32 m0, s68
    v_mfma_f32_32x32x16_bf16 v[16:31], v[68:71], v[176:179], 0
    buffer_load_dwordx4 v224, s[4:7], s41 offen sc1 lds
    buffer_load_dwordx4 v225, s[72:75], s41 offen offset:1024 sc1 lds
    v_permlane32_swap_b32 v242, v236
    v_permlane32_swap_b32 v243, v237
    s_add_u32 s38, s38, 1
    v_mfma_f32_32x32x16_bf16 v[32:47], v[64:67], v[180:183], 0
    v_permlane32_swap_b32 v244, v238
    v_permlane32_swap_b32 v245, v239
    v_permlane32_swap_b32 v240, v241
    v_add_f32 v242, v242, v236
    v_mfma_f32_32x32x16_bf16 v[48:63], v[68:71], v[180:183], 0
    v_add_f32 v243, v243, v237
    v_add_f32 v244, v244, v238
    v_add_f32 v245, v245, v239
    v_add_f32 v240, -v240, -v241
    v_mov_b32 v254, s52
    v_mov_b32 v255, s38
    s_waitcnt vmcnt(4) lgkmcnt(0)
    v_mfma_f32_32x32x16_bf16 v[0:15], v[72:75], v[184:187], v[0:15]
    ds_read_b64_tr_b16 v[176:177], v246 offset:4096
    ds_read_b64_tr_b16 v[180:181], v247 offset:4096
    s_lshl_b32 s58, s38, 3
    s_add_u32 s58, s58, s20
    s_mov_b32 m0, s69
    v_mfma_f32_32x32x16_bf16 v[16:31], v[76:79], v[184:187], v[16:31]
    buffer_load_dwordx4 v226, s[4:7], s41 offen sc1 lds
    s_set_gpr_idx_on s32, gpr_idx(DST)
    s_nop 0
    v_cvt_pk_bf16_f32 v195, v242, v243
    v_cvt_pk_bf16_f32 v196, v244, v245
    v_cvt_pk_bf16_f32 v197, v240, v240
    s_set_gpr_idx_off
    s_mov_b64 exec, 1
    ds_write_b32 v254, v255
    s_mov_b64 exec, -1
    s_cmp_lt_u32 s58, s22
    s_cbranch_scc0 K2_dyn_21
K2_back_22:
    v_readlane_b32 s3, v253, s58
    s_lshl_b32 s44, s34, 7
    s_and_b32 s48, s3, 0x3ffff
    s_bfe_u32 s33, s3, 0x30013
    s_mul_i32 s35, s38, 6
    s_cmp_eq_u32 s34, 0
    s_cselect_b32 s35, s35, s48
    s_mov_b32 s45, s44
    s_add_u32 s47, s44, 256
    s_add_u32 s49, s48, 128
    s_add_u32 s60, s48, 256
    s_cmp_eq_u32 s33, 3
    s_cselect_b32 s46, s44, s47
    s_cselect_b32 s50, s60, s48
    s_cselect_b32 s51, s48, s49
    s_sub_u32 s60, s33, 2
    s_cmp_lt_u32 s60, 2
    s_cbranch_scc0 K2_rare_27
K2_back_28:
    v_mfma_f32_32x32x16_bf16 v[32:47], v[72:75], v[188:191], v[32:47]
    v_add_u32 v233, s48, v230
    ds_read_b32 v232, v233
    ds_read_b32 v233, v233 offset:1024
    v_mfma_f32_32x32x16_bf16 v[48:63], v[76:79], v[188:191], v[48:63]
    s_waitcnt vmcnt(3) lgkmcnt(3)
    v_mfma_f32_32x32x8_bf16 v[0:15], v[80:81], v[176:177], v[0:15]
    ds_read_b64_tr_b16 v[184:185], v246 offset:6144
    ds_read_b64_tr_b16 v[186:187], v246 offset:7168
    ds_read_b64_tr_b16 v[188:189], v247 offset:6144
    ds_read_b64_tr_b16 v[190:191], v247 offset:7168
    s_mov_b32 m0, s70
    v_mfma_f32_32x32x8_bf16 v[16:31], v[84:85], v[176:177], v[16:31]
    buffer_load_dwordx4 v222, s[4:7], s42 offen sc1 lds
    buffer_load_dwordx4 v223, s[72:75], s42 offen offset:1024 sc1 lds
    v_mfma_f32_32x32x8_bf16 v[32:47], v[80:81], v[180:181], v[32:47]
    s_nop 2
    v_mul_f32 v234, v0, v96
    v_mul_f32 v236, v8, v128
    v_fmac_f32 v234, v1, v97
    v_fmac_f32 v236, v9, v129
    v_fmac_f32 v234, v2, v98
    v_fmac_f32 v236, v10, v130
    v_fmac_f32 v234, v3, v99
    v_mfma_f32_32x32x8_bf16 v[48:63], v[84:85], v[180:181], v[48:63]
    s_setprio 0
    s_waitcnt lgkmcnt(4)
    v_or_b32 v232, v232, v231
    v_or_b32 v233, v233, v231
    s_cmp_lg_u32 s34, 0
    s_cbranch_scc1 K2_dum_30
    s_cmp_eq_u32 s33, 4
    s_cbranch_scc1 K2_a4_31
K2_b4_33:
    s_add_u32 m0, s48, 512
    s_add_u32 s65, s48, 1536
    buffer_load_dwordx4 v232, s[16:19], 0 offen  lds
    s_mov_b32 m0, s65
    s_mov_b32 exec_hi, 0
    buffer_load_dwordx4 v233, s[16:19], 0 offen  lds
    s_mov_b32 exec_hi, -1
K2_back_32:
    v_fmac_f32 v236, v11, v131
    v_fmac_f32 v234, v4, v100
    v_fmac_f32 v236, v12, v132
    v_fmac_f32 v234, v5, v101
    v_fmac_f32 v236, v13, v133
    v_fmac_f32 v234, v6, v102
    v_fmac_f32 v236, v14, v134
    v_fmac_f32 v234, v7, v103
    v_fmac_f32 v236, v15, v135
    v_mul_f32 v238, v16, v128
    v_mul_f32 v240, v24, v128
    v_fmac_f32 v238, v17, v129
    v_fmac_f32 v240, v25, v129
    v_fmac_f32 v238, v18, v130
    v_fmac_f32 v240, v26, v130
    v_fmac_f32 v238, v19, v131
    v_fmac_f32 v240, v27, v131
    v_fmac_f32 v238, v20, v132
    v_fmac_f32 v240, v28, v132
    v_fmac_f32 v238, v21, v133
    v_fmac_f32 v240, v29, v133
    v_fmac_f32 v238, v22, v134
    v_fmac_f32 v240, v30, v134
    v_fmac_f32 v238, v23, v135
    v_fmac_f32 v240, v31, v135
    v_mul_f32 v235, v32, v104
    v_mul_f32 v237, v40, v136
    v_fmac_f32 v235, v33, v105
    v_fmac_f32 v237, v41, v137
    v_fmac_f32 v235, v34, v106
    v_fmac_f32 v237, v42, v138
    v_fmac_f32 v235, v35, v107
    v_fmac_f32 v237, v43, v139
    v_fmac_f32 v235, v36, v108
    v_fmac_f32 v237, v44, v140
    v_fmac_f32 v235, v37, v109
    v_fmac_f32 v237, v45, v141
    v_fmac_f32 v235, v38, v110
    v_fmac_f32 v237, v46, v142
    v_fmac_f32 v235, v39, v111
    v_fmac_f32 v237, v47, v143
    v_mul_f32 v239, v48, v136
    v_mul_f32 v241, v56, v136
    s_setprio 1
    s_waitcnt vmcnt(5) lgkmcnt(0)
    v_mfma_f32_32x32x16_bf16 v[0:15], v[64:67], v[184:187], 0
    ds_read_b64_tr_b16 v[176:177], v246 offset:0
    ds_read_b64_tr_b16 v[178:179], v246 offset:1024
    ds_read_b64_tr_b16 v[180:181], v247 offset:0
    ds_read_b64_tr_b16 v[182:183], v247 offset:1024
    v_fmac_f32 v239, v49, v137
    v_fmac_f32 v241, v57, v137
    s_mov_b32 m0, s71
    v_mfma_f32_32x32x16_bf16 v[16:31], v[68:71], v[184:187], 0
    buffer_load_dwordx4 v224, s[4:7], s42 offen sc1 lds
    buffer_load_dwordx4 v225, s[72:75], s42 offen offset:1024 sc1 lds
    v_fmac_f32 v239, v50, v138
    v_fmac_f32 v241, v58, v138
    v_fmac_f32 v239, v51, v139
    v_fmac_f32 v241, v59, v139
    v_fmac_f32 v239, v52, v140
    v_mfma_f32_32x32x16_bf16 v[32:47], v[64:67], v[188:191], 0
    v_fmac_f32 v241, v60, v140
    v_fmac_f32 v239, v53, v141
    v_fmac_f32 v241, v61, v141
    v_fmac_f32 v239, v54, v142
    v_fmac_f32 v241, v62, v142
    v_fmac_f32 v239, v55, v143
    v_fmac_f32 v241, v63, v143
    v_mfma_f32_32x32x16_bf16 v[48:63], v[68:71], v[188:191], 0
    v_permlane32_swap_b32 v234, v236
    v_permlane32_swap_b32 v235, v237
    v_permlane32_swap_b32 v240, v238
    s_waitcnt vmcnt(6) lgkmcnt(0)
    v_mfma_f32_32x32x16_bf16 v[0:15], v[72:75], v[176:179], v[0:15]
    ds_read_b64_tr_b16 v[184:185], v246 offset:2048
    ds_read_b64_tr_b16 v[188:189], v247 offset:2048
    v_permlane32_swap_b32 v241, v239
    v_add_f32 v234, v234, v236
    v_add_f32 v235, v235, v237
    s_mov_b32 m0, s68
    v_mfma_f32_32x32x16_bf16 v[16:31], v[76:79], v[176:179], v[16:31]
    buffer_load_dwordx4 v226, s[4:7], s42 offen sc1 lds
    v_add_f32 v240, v240, v238
    v_add_f32 v241, v241, v239
    s_set_gpr_idx_on s31, gpr_idx(DST)
    s_nop 0
    v_cvt_pk_bf16_f32 v192, v234, v235
    v_cvt_pk_bf16_f32 v193, v240, v241
    s_set_gpr_idx_off
    v_mfma_f32_32x32x16_bf16 v[32:47], v[72:75], v[180:183], v[32:47]
    v_mfma_f32_32x32x16_bf16 v[48:63], v[76:79], v[180:183], v[48:63]
    s_waitcnt vmcnt(5) lgkmcnt(0)
    v_mfma_f32_32x32x8_bf16 v[0:15], v[80:81], v[184:185], v[0:15]
    ds_read_b64_tr_b16 v[176:177], v246 offset:4096
    ds_read_b64_tr_b16 v[178:179], v246 offset:5120
    ds_read_b64_tr_b16 v[180:181], v247 offset:4096
    ds_read_b64_tr_b16 v[182:183], v247 offset:5120
    s_mov_b32 m0, s69
    v_mfma_f32_32x32x8_bf16 v[16:31], v[84:85], v[184:185], v[16:31]
    buffer_load_dwordx4 v222, s[4:7], s43 offen sc1 lds
    buffer_load_dwordx4 v223, s[72:75], s43 offen offset:1024 sc1 lds
    v_mfma_f32_32x32x8_bf16 v[32:47], v[80:81], v[188:189], v[32:47]
    s_nop 2
    v_mul_f32 v234, v0, v144
    v_mul_f32 v236, v8, v112
    v_fmac_f32 v234, v1, v145
    v_fmac_f32 v236, v9, v113
    v_fmac_f32 v234, v2, v146
    v_fmac_f32 v236, v10, v114
    v_fmac_f32 v234, v3, v147
    v_mfma_f32_32x32x8_bf16 v[48:63], v[84:85], v[188:189], v[48:63]
    s_setprio 0
    v_fmac_f32 v236, v11, v115
    v_fmac_f32 v234, v4, v148
    v_fmac_f32 v236, v12, v116
    v_fmac_f32 v234, v5, v149
    v_fmac_f32 v236, v13, v117
    v_fmac_f32 v234, v6, v150
    v_fmac_f32 v236, v14, v118
    v_fmac_f32 v234, v7, v151
    v_fmac_f32 v236, v15, v119
    v_mul_f32 v238, v16, v160
    v_mul_f32 v240, v24, v160
    v_fmac_f32 v238, v17, v161
    v_fmac_f32 v240, v25, v161
    v_fmac_f32 v238, v18, v162
    v_fmac_f32 v240, v26, v162
    v_fmac_f32 v238, v19, v163
    v_fmac_f32 v240, v27, v163
    v_fmac_f32 v238, v20, v164
    v_fmac_f32 v240, v28, v164
    v_fmac_f32 v238, v21, v165
    v_fmac_f32 v240, v29, v165
    v_fmac_f32 v238, v22, v166
    v_fmac_f32 v240, v30, v166
    v_fmac_f32 v238, v23, v167
    v_fmac_f32 v240, v31, v167
    v_mul_f32 v235, v32, v152
    v_mul_f32 v237, v40, v120
    v_fmac_f32 v235, v33, v153
    v_fmac_f32 v237, v41, v121
    v_fmac_f32 v235, v34, v154
    v_fmac_f32 v237, v42, v122
    v_fmac_f32 v235, v35, v155
    v_fmac_f32 v237, v43, v123
    v_fmac_f32 v235, v36, v156
    v_fmac_f32 v237, v44, v124
    v_fmac_f32 v235, v37, v157
    v_fmac_f32 v237, v45, v125
    v_fmac_f32 v235, v38, v158
    v_fmac_f32 v237, v46, v126
    v_fmac_f32 v235, v39, v159
    v_fmac_f32 v237, v47, v127
    v_mul_f32 v239, v48, v168
    v_mul_f32 v241, v56, v168
    v_fmac_f32 v239, v49, v169
    v_fmac_f32 v241, v57, v169
    s_setprio 1
    s_waitcnt vmcnt(3) lgkmcnt(0)
    v_mfma_f32_32x32x16_bf16 v[0:15], v[64:67], v[176:179], 0
    ds_read_b64_tr_b16 v[184:185], v246 offset:6144
    ds_read_b64_tr_b16 v[186:187], v246 offset:7168
    ds_read_b64_tr_b16 v[188:189], v247 offset:6144
    ds_read_b64_tr_b16 v[190:191], v247 offset:7168
    v_fmac_f32 v239, v50, v170
    v_fmac_f32 v241, v58, v170
    s_mov_b32 m0, s70
    v_mfma_f32_32x32x16_bf16 v[16:31], v[68:71], v[176:179], 0
    buffer_load_dwordx4 v224, s[4:7], s43 offen sc1 lds
    buffer_load_dwordx4 v225, s[72:75], s43 offen offset:1024 sc1 lds
    v_fmac_f32 v239, v51, v171
    v_fmac_f32 v241, v59, v171
    v_fmac_f32 v239, v52, v172
    v_fmac_f32 v241, v60, v172
    v_fmac_f32 v239, v53, v173
    v_mfma_f32_32x32x16_bf16 v[32:47], v[64:67], v[180:183], 0
    v_add_u32 v222, s48, v251
    ds_read2_b32 v[222:223], v222 offset0:1 offset1:3
    v_fmac_f32 v241, v61, v173
    v_fmac_f32 v239, v54, v174
    v_fmac_f32 v241, v62, v174
    v_fmac_f32 v239, v55, v175
    v_fmac_f32 v241, v63, v175
    v_mfma_f32_32x32x16_bf16 v[48:63], v[68:71], v[180:183], 0
    s_waitcnt vmcnt(4) lgkmcnt(1)
    v_mfma_f32_32x32x16_bf16 v[0:15], v[72:75], v[184:187], v[0:15]
    ds_read_b64_tr_b16 v[176:177], v246 offset:0
    ds_read_b64_tr_b16 v[180:181], v247 offset:0
    s_mov_b32 m0, s71
    v_mfma_f32_32x32x16_bf16 v[16:31], v[76:79], v[184:187], v[16:31]
    buffer_load_dwordx4 v226, s[4:7], s43 offen sc1 lds
    s_waitcnt lgkmcnt(2)
    v_mad_u32_u16 v222, v222, s39, v248 op_sel:[1,0,0,0]
    v_mad_u32_u16 v223, v223, s39, v248 op_sel:[1,0,0,0]
    v_mfma_f32_32x32x16_bf16 v[32:47], v[72:75], v[188:191], v[32:47]
    v_add_u32 v224, s49, v251
    ds_read2_b32 v[224:225], v224 offset0:1 offset1:3
    v_mfma_f32_32x32x16_bf16 v[48:63], v[76:79], v[188:191], v[48:63]
    s_waitcnt vmcnt(3) lgkmcnt(1)
    v_mfma_f32_32x32x8_bf16 v[0:15], v[80:81], v[176:177], v[0:15]
    ds_read_b64_tr_b16 v[184:185], v246 offset:2048
    ds_read_b64_tr_b16 v[186:187], v246 offset:3072
    ds_read_b64_tr_b16 v[188:189], v247 offset:2048
    ds_read_b64_tr_b16 v[190:191], v247 offset:3072
    s_mov_b32 m0, s68
    v_mfma_f32_32x32x8_bf16 v[16:31], v[84:85], v[176:177], v[16:31]
    buffer_load_dwordx4 v222, s[4:7], s44 offen sc1 lds
    buffer_load_dwordx4 v223, s[72:75], s44 offen offset:1024 sc1 lds
    s_waitcnt lgkmcnt(4)
    v_mad_u32_u16 v224, v224, s39, v248 op_sel:[1,0,0,0]
    v_mad_u32_u16 v225, v225, s39, v248 op_sel:[1,0,0,0]
    v_mfma_f32_32x32x8_bf16 v[32:47], v[80:81], v[180:181], v[32:47]
    v_add_u32 v226, s50, v251
    ds_read2_b32 v[226:227], v226 offset0:1 offset1:3
    v_mul_f32 v242, v0, v144
    v_fma_f32 v238, v8, v160, -v238
    v_fmac_f32 v242, v1, v145
    v_fmac_f32 v238, v9, v161
    v_fmac_f32 v242, v2, v146
    v_mfma_f32_32x32x8_bf16 v[48:63], v[84:85], v[180:181], v[48:63]
    s_setprio 0
    v_fmac_f32 v238, v10, v162
    v_fmac_f32 v242, v3, v147
    v_fmac_f32 v238, v11, v163
    v_fmac_f32 v242, v4, v148
    v_fmac_f32 v238, v12, v164
    v_fmac_f32 v242, v5, v149
    v_fmac_f32 v238, v13, v165
    v_fmac_f32 v242, v6, v150
    v_fmac_f32 v238, v14, v166
    v_fmac_f32 v242, v7, v151
    v_fmac_f32 v238, v15, v167
    v_fmac_f32 v236, v16, v112
    v_mul_f32 v244, v24, v160
    v_fmac_f32 v236, v17, v113
    v_fmac_f32 v244, v25, v161
    v_fmac_f32 v236, v18, v114
    v_fmac_f32 v244, v26, v162
    v_fmac_f32 v236, v19, v115
    v_fmac_f32 v244, v27, v163
    v_fmac_f32 v236, v20, v116
    v_fmac_f32 v244, v28, v164
    v_fmac_f32 v236, v21, v117
    v_fmac_f32 v244, v29, v165
    v_fmac_f32 v236, v22, v118
    v_fmac_f32 v244, v30, v166
    v_fmac_f32 v236, v23, v119
    v_fmac_f32 v244, v31, v167
    v_mul_f32 v243, v32, v152
    v_fma_f32 v239, v40, v168, -v239
    v_fmac_f32 v243, v33, v153
    v_fmac_f32 v239, v41, v169
    v_fmac_f32 v243, v34, v154
    v_fmac_f32 v239, v42, v170
    v_fmac_f32 v243, v35, v155
    v_fmac_f32 v239, v43, v171
    v_fmac_f32 v243, v36, v156
    v_fmac_f32 v239, v44, v172
    v_fmac_f32 v243, v37, v157
    v_fmac_f32 v239, v45, v173
    v_fmac_f32 v243, v38, v158
    v_fmac_f32 v239, v46, v174
    v_fmac_f32 v243, v39, v159
    v_fmac_f32 v239, v47, v175
    v_fmac_f32 v237, v48, v120
    v_mul_f32 v245, v56, v168
    v_fmac_f32 v237, v49, v121
    v_fmac_f32 v245, v57, v169
    v_fmac_f32 v237, v50, v122
    v_fmac_f32 v245, v58, v170
    v_fmac_f32 v237, v51, v123
    s_setprio 1
    s_waitcnt vmcnt(3) lgkmcnt(1)
    v_mfma_f32_32x32x16_bf16 v[0:15], v[64:67], v[184:187], 0
    ds_read_b64_tr_b16 v[176:177], v246 offset:4096
    ds_read_b64_tr_b16 v[178:179], v246 offset:5120
    ds_read_b64_tr_b16 v[180:181], v247 offset:4096
    ds_read_b64_tr_b16 v[182:183], v247 offset:5120
    v_fmac_f32 v245, v59, v171
    v_fmac_f32 v237, v52, v124
    s_mov_b32 m0, s69
    v_mfma_f32_32x32x16_bf16 v[16:31], v[68:71], v[184:187], 0
    buffer_load_dwordx4 v224, s[4:7], s45 offen sc1 lds
    buffer_load_dwordx4 v225, s[72:75], s45 offen offset:1024 sc1 lds
    s_waitcnt lgkmcnt(4)
    v_mad_u32_u16 v226, v226, s39, v248 op_sel:[1,0,0,0]
    v_mad_u32_u16 v227, v227, s39, v248 op_sel:[1,0,0,0]
    v_fmac_f32 v245, v60, v172
    v_fmac_f32 v237, v53, v125
    v_mfma_f32_32x32x16_bf16 v[32:47], v[64:67], v[188:191], 0
    v_add_u32 v228, s51, v251
    ds_read2_b32 v[228:229], v228 offset0:1 offset1:3
    v_fmac_f32 v245, v61, v173
    v_fmac_f32 v237, v54, v126
    v_fmac_f32 v245, v62, v174
    v_fmac_f32 v237, v55, v127
    v_fmac_f32 v245, v63, v175
    v_mfma_f32_32x32x16_bf16 v[48:63], v[68:71], v[188:191], 0
    v_permlane32_swap_b32 v242, v234
    v_permlane32_swap_b32 v243, v235
    v_add_f32 v242, v242, v234
    v_add_f32 v243, v243, v235
    s_waitcnt vmcnt(4) lgkmcnt(1)
    v_mfma_f32_32x32x16_bf16 v[0:15], v[72:75], v[176:179], v[0:15]
    ds_read_b64_tr_b16 v[184:185], v246 offset:6144
    ds_read_b64_tr_b16 v[188:189], v247 offset:6144
    s_set_gpr_idx_on s31, gpr_idx(DST)
    s_nop 0
    v_cvt_pk_bf16_f32 v194, v242, v243
    s_set_gpr_idx_off
    s_mov_b32 s32, s31
    s_mov_b32 m0, s70
    v_mfma_f32_32x32x16_bf16 v[16:31], v[76:79], v[176:179], v[16:31]
    buffer_load_dwordx4 v226, s[4:7], s46 offen sc1 lds
    buffer_load_dwordx4 v227, s[72:75], s46 offen offset:1024 sc1 lds
    s_waitcnt lgkmcnt(2)
    v_mad_u32_u16 v228, v228, s39, v248 op_sel:[1,0,0,0]
    v_mad_u32_u16 v229, v229, s39, v248 op_sel:[1,0,0,0]
    s_sub_u32 s26, s48, s29
    s_mov_b32 s29, s48
    v_mfma_f32_32x32x16_bf16 v[32:47], v[72:75], v[180:183], v[32:47]
    s_mov_b32 s30, s3
    s_bfe_u32 s56, s3, 0x40012
    s_cmp_eq_u32 s34, 0
    s_cselect_b32 s56, s56, 0
    s_mov_b32 s31, s35
    v_mfma_f32_32x32x16_bf16 v[48:63], v[76:79], v[180:183], v[48:63]
    s_waitcnt vmcnt(4) lgkmcnt(0)
    v_mfma_f32_32x32x8_bf16 v[0:15], v[80:81], v[184:185], v[0:15]
    ds_read_b64_tr_b16 v[176:177], v246 offset:0
    ds_read_b64_tr_b16 v[178:179], v246 offset:1024
    ds_read_b64_tr_b16 v[180:181], v247 offset:0
    ds_read_b64_tr_b16 v[182:183], v247 offset:1024
    s_mov_b32 m0, s71
    v_mfma_f32_32x32x8_bf16 v[16:31], v[84:85], v[184:185], v[16:31]
    buffer_load_dwordx4 v228, s[4:7], s47 offen sc1 lds
    buffer_load_dwordx4 v229, s[72:75], s47 offen offset:1024 sc1 lds
    v_mfma_f32_32x32x8_bf16 v[32:47], v[80:81], v[188:189], v[32:47]
    s_nop 2
    v_mul_f32 v242, v0, v144
    v_fma_f32 v240, v8, v160, -v240
    v_fmac_f32 v242, v1, v145
    v_fmac_f32 v240, v9, v161
    v_fmac_f32 v242, v2, v146
    v_fmac_f32 v240, v10, v162
    v_fmac_f32 v242, v3, v147
    v_mfma_f32_32x32x8_bf16 v[48:63], v[84:85], v[188:189], v[48:63]
    s_setprio 0
    v_fmac_f32 v240, v11, v163
    v_fmac_f32 v242, v4, v148
    v_fmac_f32 v240, v12, v164
    v_fmac_f32 v242, v5, v149
    v_fmac_f32 v240, v13, v165
    v_fmac_f32 v242, v6, v150
    v_fmac_f32 v240, v14, v166
    v_fmac_f32 v242, v7, v151
    v_fmac_f32 v240, v15, v167
    v_add_u32 v249, s26, v249
    v_add_u32 v250, s26, v250
    v_fma_f32 v244, v16, v160, -v244
    v_fmac_f32 v236, v24, v112
    v_fmac_f32 v244, v17, v161
    v_fmac_f32 v236, v25, v113
    v_fmac_f32 v244, v18, v162
    v_fmac_f32 v236, v26, v114
    v_fmac_f32 v244, v19, v163
    v_fmac_f32 v236, v27, v115
    v_fmac_f32 v244, v20, v164
    v_fmac_f32 v236, v28, v116
    v_fmac_f32 v244, v21, v165
    v_fmac_f32 v236, v29, v117
    v_fmac_f32 v244, v22, v166
    v_fmac_f32 v236, v30, v118
    v_fmac_f32 v244, v23, v167
    v_fmac_f32 v236, v31, v119
    ds_read_b64_tr_b16 v[0:1], v249 offset:0
    ds_read_b64_tr_b16 v[2:3], v249 offset:32
    ds_read_u16_d16_hi v16, v250 offset:0
    v_mul_f32 v243, v32, v152
    v_fma_f32 v241, v40, v168, -v241
    v_fmac_f32 v243, v33, v153
    v_fmac_f32 v241, v41, v169
    v_fmac_f32 v243, v34, v154
    v_fmac_f32 v241, v42, v170
    v_fmac_f32 v243, v35, v155
    v_fmac_f32 v241, v43, v171
    v_fmac_f32 v243, v36, v156
    v_fmac_f32 v241, v44, v172
    v_fmac_f32 v243, v37, v157
    v_fmac_f32 v241, v45, v173
    v_fmac_f32 v243, v38, v158
    v_fmac_f32 v241, v46, v174
    v_fmac_f32 v243, v39, v159
    v_fmac_f32 v241, v47, v175
    ds_read_b64_tr_b16 v[4:5], v249 offset:512
    ds_read_b64_tr_b16 v[6:7], v249 offset:544
    ds_read_u16_d16_hi v17, v250 offset:128
    v_fma_f32 v245, v48, v168, -v245
    v_fmac_f32 v237, v56, v120
    v_fmac_f32 v245, v49, v169
    v_fmac_f32 v237, v57, v121
    v_fmac_f32 v245, v50, v170
    v_fmac_f32 v237, v58, v122
    v_fmac_f32 v245, v51, v171
    v_fmac_f32 v237, v59, v123
    v_fmac_f32 v245, v52, v172
    v_fmac_f32 v237, v60, v124
    v_fmac_f32 v245, v53, v173
    v_fmac_f32 v237, v61, v125
    v_fmac_f32 v245, v54, v174
    v_fmac_f32 v237, v62, v126
    v_fmac_f32 v245, v55, v175
    v_fmac_f32 v237, v63, v127
    s_cmp_eq_u32 s56, 5
    s_cbranch_scc1 K2_U20
    s_cmp_eq_u32 s56, 6
    s_cbranch_scc1 K2_U3h0
    s_branch K2_DSP0
K2_U30:
    s_setprio 1
    ds_read_b64_tr_b16 v[8:9], v249 offset:1024
    ds_read_b64_tr_b16 v[10:11], v249 offset:1056
    ds_read_u16_d16_hi v18, v250 offset:256
    s_waitcnt lgkmcnt(3)
    v_lshlrev_b32 v20, 16, v0
    v_and_b32 v21, 0xffff0000, v0
    v_lshlrev_b32 v22, 16, v1
    v_and_b32 v23, 0xffff0000, v1
    v_lshlrev_b32 v24, 16, v2
    v_and_b32 v25, 0xffff0000, v2
    v_lshlrev_b32 v26, 16, v3
    v_and_b32 v27, 0xffff0000, v3
    v_mul_f32_dpp v36, v16, v20 row_newbcast:8 row_mask:0xf bank_mask:0xf
    v_mul_f32_dpp v37, v16, v21 row_newbcast:9 row_mask:0xf bank_mask:0xf
    v_mul_f32_dpp v38, v16, v22 row_newbcast:10 row_mask:0xf bank_mask:0xf
    v_mul_f32_dpp v39, v16, v23 row_newbcast:11 row_mask:0xf bank_mask:0xf
    v_mul_f32_dpp v40, v16, v24 row_newbcast:12 row_mask:0xf bank_mask:0xf
    v_mul_f32_dpp v41, v16, v25 row_newbcast:13 row_mask:0xf bank_mask:0xf
    v_mul_f32_dpp v42, v16, v26 row_newbcast:14 row_mask:0xf bank_mask:0xf
    v_mul_f32_dpp v43, v16, v27 row_newbcast:15 row_mask:0xf bank_mask:0xf
    v_cvt_pk_bf16_f32 v68, v36, v37
    v_cvt_pk_bf16_f32 v69, v38, v39
    v_cvt_pk_bf16_f32 v70, v40, v41
    v_cvt_pk_bf16_f32 v71, v42, v43
    v_mul_f32_dpp v20, v16, v20 row_newbcast:0 row_mask:0xa bank_mask:0xf
    v_mul_f32_dpp v21, v16, v21 row_newbcast:1 row_mask:0xa bank_mask:0xf
    v_mul_f32_dpp v22, v16, v22 row_newbcast:2 row_mask:0xa bank_mask:0xf
    v_mul_f32_dpp v23, v16, v23 row_newbcast:3 row_mask:0xa bank_mask:0xf
    v_mul_f32_dpp v24, v16, v24 row_newbcast:4 row_mask:0xa bank_mask:0xf
    v_mul_f32_dpp v25, v16, v25 row_newbcast:5 row_mask:0xa bank_mask:0xf
    v_mul_f32_dpp v26, v16, v26 row_newbcast:6 row_mask:0xa bank_mask:0xf
    v_mul_f32_dpp v27, v16, v27 row_newbcast:7 row_mask:0xa bank_mask:0xf
    v_cvt_pk_bf16_f32 v64, v20, v21
    v_cvt_pk_bf16_f32 v65, v22, v23
    v_cvt_pk_bf16_f32 v66, v24, v25
    v_cvt_pk_bf16_f32 v67, v26, v27
    v_lshlrev_b32 v28, 16, v4
    v_and_b32 v29, 0xffff0000, v4
    v_lshlrev_b32 v30, 16, v5
    v_and_b32 v31, 0xffff0000, v5
    v_lshlrev_b32 v32, 16, v6
    v_and_b32 v33, 0xffff0000, v6
    v_lshlrev_b32 v34, 16, v7
    v_and_b32 v35, 0xffff0000, v7
    v_mul_f32_dpp v36, v17, v28 row_newbcast:8 row_mask:0xf bank_mask:0xf
    v_mul_f32_dpp v37, v17, v29 row_newbcast:9 row_mask:0xf bank_mask:0xf
    v_mul_f32_dpp v38, v17, v30 row_newbcast:10 row_mask:0xf bank_mask:0xf
    v_mul_f32_dpp v39, v17, v31 row_newbcast:11 row_mask:0xf bank_mask:0xf
    v_mul_f32_dpp v40, v17, v32 row_newbcast:12 row_mask:0xf bank_mask:0xf
    v_mul_f32_dpp v41, v17, v33 row_newbcast:13 row_mask:0xf bank_mask:0xf
    v_mul_f32_dpp v42, v17, v34 row_newbcast:14 row_mask:0xf bank_mask:0xf
    v_mul_f32_dpp v43, v17, v35 row_newbcast:15 row_mask:0xf bank_mask:0xf
    v_cvt_pk_bf16_f32 v76, v36, v37
    v_cvt_pk_bf16_f32 v77, v38, v39
    v_cvt_pk_bf16_f32 v78, v40, v41
    v_cvt_pk_bf16_f32 v79, v42, v43
    v_mul_f32_dpp v28, v17, v28 row_newbcast:0 row_mask:0xa bank_mask:0xf
    v_mul_f32_dpp v29, v17, v29 row_newbcast:1 row_mask:0xa bank_mask:0xf
    v_mul_f32_dpp v30, v17, v30 row_newbcast:2 row_mask:0xa bank_mask:0xf
    v_mul_f32_dpp v31, v17, v31 row_newbcast:3 row_mask:0xa bank_mask:0xf
    v_mul_f32_dpp v32, v17, v32 row_newbcast:4 row_mask:0xa bank_mask:0xf
    v_mul_f32_dpp v33, v17, v33 row_newbcast:5 row_mask:0xa bank_mask:0xf
    v_mul_f32_dpp v34, v17, v34 row_newbcast:6 row_mask:0xa bank_mask:0xf
    v_mul_f32_dpp v35, v17, v35 row_newbcast:7 row_mask:0xa bank_mask:0xf
    v_cvt_pk_bf16_f32 v72, v28, v29
    v_cvt_pk_bf16_f32 v73, v30, v31
    v_cvt_pk_bf16_f32 v74, v32, v33
    v_cvt_pk_bf16_f32 v75, v34, v35
    s_waitcnt lgkmcnt(0)
    v_lshlrev_b32 v20, 16, v8
    v_and_b32 v21, 0xffff0000, v8
    v_lshlrev_b32 v22, 16, v9
    v_and_b32 v23, 0xffff0000, v9
    v_lshlrev_b32 v24, 16, v10
    v_and_b32 v25, 0xffff0000, v10
    v_lshlrev_b32 v26, 16, v11
    v_and_b32 v27, 0xffff0000, v11
    v_mul_f32_dpp v36, v18, v20 row_newbcast:8 row_mask:0xf bank_mask:0xf
    v_mul_f32_dpp v37, v18, v21 row_newbcast:9 row_mask:0xf bank_mask:0xf
    v_mul_f32_dpp v38, v18, v22 row_newbcast:10 row_mask:0xf bank_mask:0xf
    v_mul_f32_dpp v39, v18, v23 row_newbcast:11 row_mask:0xf bank_mask:0xf
    v_mul_f32_dpp v40, v18, v24 row_newbcast:12 row_mask:0xf bank_mask:0xf
    v_mul_f32_dpp v41, v18, v25 row_newbcast:13 row_mask:0xf bank_mask:0xf
    v_mul_f32_dpp v42, v18, v26 row_newbcast:14 row_mask:0xf bank_mask:0xf
    v_mul_f32_dpp v43, v18, v27 row_newbcast:15 row_mask:0xf bank_mask:0xf
    v_cvt_pk_bf16_f32 v84, v36, v37
    v_cvt_pk_bf16_f32 v85, v38, v39
    v_cvt_pk_bf16_f32 v86, v40, v41
    v_cvt_pk_bf16_f32 v87, v42, v43
    v_mul_f32_dpp v20, v18, v20 row_newbcast:0 row_mask:0xa bank_mask:0xf
    v_mul_f32_dpp v21, v18, v21 row_newbcast:1 row_mask:0xa bank_mask:0xf
    v_mul_f32_dpp v22, v18, v22 row_newbcast:2 row_mask:0xa bank_mask:0xf
    v_mul_f32_dpp v23, v18, v23 row_newbcast:3 row_mask:0xa bank_mask:0xf
    v_mul_f32_dpp v24, v18, v24 row_newbcast:4 row_mask:0xa bank_mask:0xf
    v_mul_f32_dpp v25, v18, v25 row_newbcast:5 row_mask:0xa bank_mask:0xf
    v_mul_f32_dpp v26, v18, v26 row_newbcast:6 row_mask:0xa bank_mask:0xf
    v_mul_f32_dpp v27, v18, v27 row_newbcast:7 row_mask:0xa bank_mask:0xf
    v_cvt_pk_bf16_f32 v80, v20, v21
    v_cvt_pk_bf16_f32 v81, v22, v23
    v_cvt_pk_bf16_f32 v82, v24, v25
    v_cvt_pk_bf16_f32 v83, v26, v27
    s_waitcnt vmcnt(4)
    v_mfma_f32_32x32x16_bf16 v[0:15], v[64:67], v[176:179], 0
    ds_read_b64_tr_b16 v[184:185], v246 offset:2048
    ds_read_b64_tr_b16 v[186:187], v246 offset:3072
    ds_read_b64_tr_b16 v[188:189], v247 offset:2048
    ds_read_b64_tr_b16 v[190:191], v247 offset:3072
    s_mov_b32 m0, s68
    v_mfma_f32_32x32x16_bf16 v[16:31], v[68:71], v[176:179], 0
    buffer_load_dwordx4 v224, s[4:7], s41 offen sc1 lds
    buffer_load_dwordx4 v225, s[72:75], s41 offen offset:1024 sc1 lds
    v_permlane32_swap_b32 v242, v236
    v_permlane32_swap_b32 v243, v237
    s_add_u32 s38, s38, 1
    v_mfma_f32_32x32x16_bf16 v[32:47], v[64:67], v[180:183], 0
    v_permlane32_swap_b32 v244, v238
    v_permlane32_swap_b32 v245, v239
    v_permlane32_swap_b32 v240, v241
    v_add_f32 v242, v242, v236
    v_mfma_f32_32x32x16_bf16 v[48:63], v[68:71], v[180:183], 0
    v_add_f32 v243, v243, v237
    v_add_f32 v244, v244, v238
    v_add_f32 v245, v245, v239
    v_add_f32 v240, -v240, -v241
    v_mov_b32 v254, s52
    v_mov_b32 v255, s38
    s_waitcnt vmcnt(4) lgkmcnt(0)
    v_mfma_f32_32x32x16_bf16 v[0:15], v[72:75], v[184:187], v[0:15]
    ds_read_b64_tr_b16 v[176:177], v246 offset:4096
    ds_read_b64_tr_b16 v[178:179], v246 offset:5120
    ds_read_b64_tr_b16 v[180:181], v247 offset:4096
    ds_read_b64_tr_b16 v[182:183], v247 offset:5120
    s_lshl_b32 s58, s38, 3
    s_add_u32 s58, s58, s20
    s_mov_b32 m0, s69
    v_mfma_f32_32x32x16_bf16 v[16:31], v[76:79], v[184:187], v[16:31]
    buffer_load_dwordx4 v226, s[4:7], s41 offen sc1 lds
    buffer_load_dwordx4 v227, s[72:75], s41 offen offset:1024 sc1 lds
    s_set_gpr_idx_on s32, gpr_idx(DST)
    s_nop 0
    v_cvt_pk_bf16_f32 v195, v242, v243
    v_cvt_pk_bf16_f32 v196, v244, v245
    v_cvt_pk_bf16_f32 v197, v240, v240
    s_set_gpr_idx_off
    s_mov_b64 exec, 1
    ds_write_b32 v254, v255
    s_mov_b64 exec, -1
    s_cmp_lt_u32 s58, s22
    s_cbranch_scc0 K2_dyn_34
K2_back_35:
    v_readlane_b32 s3, v253, s58
    s_lshl_b32 s44, s34, 7
    s_and_b32 s48, s3, 0x3ffff
    s_bfe_u32 s33, s3, 0x30013
    s_mul_i32 s35, s38, 6
    s_cmp_eq_u32 s34, 0
    s_cselect_b32 s35, s35, s48
    s_mov_b32 s45, s44
    s_add_u32 s47, s44, 256
    s_add_u32 s49, s48, 128
    s_add_u32 s60, s48, 256
    s_cmp_eq_u32 s33, 3
    s_cselect_b32 s46, s44, s47
    s_cselect_b32 s50, s60, s48
    s_cselect_b32 s51, s48, s49
    s_sub_u32 s60, s33, 2
    s_cmp_lt_u32 s60, 2
    s_cbranch_scc0 K2_rare_40
K2_back_41:
    v_mfma_f32_32x32x16_bf16 v[32:47], v[72:75], v[188:191], v[32:47]
    v_add_u32 v233, s48, v230
    ds_read_b32 v232, v233
    ds_read_b32 v233, v233 offset:1024
    v_mfma_f32_32x32x16_bf16 v[48:63], v[76:79], v[188:191], v[48:63]
    s_waitcnt vmcnt(4) lgkmcnt(3)
    v_mfma_f32_32x32x16_bf16 v[0:15], v[80:83], v[176:179], v[0:15]
    ds_read_b64_tr_b16 v[184:185], v246 offset:6144
    ds_read_b64_tr_b16 v[186:187], v246 offset:7168
    ds_read_b64_tr_b16 v[188:189], v247 offset:6144
    ds_read_b64_tr_b16 v[190:191], v247 offset:7168
    s_mov_b32 m0, s70
    v_mfma_f32_32x32x16_bf16 v[16:31], v[84:87], v[176:179], v[16:31]
    buffer_load_dwordx4 v222, s[4:7], s42 offen sc1 lds
    buffer_load_dwordx4 v223, s[72:75], s42 offen offset:1024 sc1 lds
    v_mfma_f32_32x32x16_bf16 v[32:47], v[80:83], v[180:183], v[32:47]
    s_nop 2
    v_mul_f32 v234, v0, v96
    v_mul_f32 v236, v8, v128
    v_fmac_f32 v234, v1, v97
    v_fmac_f32 v236, v9, v129
    v_fmac_f32 v234, v2, v98
    v_fmac_f32 v236, v10, v130
    v_fmac_f32 v234, v3, v99
    v_mfma_f32_32x32x16_bf16 v[48:63], v[84:87], v[180:183], v[48:63]
    s_setprio 0
    s_waitcnt lgkmcnt(4)
    v_or_b32 v232, v232, v231
    v_or_b32 v233, v233, v231
    s_cmp_lg_u32 s34, 0
    s_cbranch_scc1 K2_dum_43
    s_cmp_eq_u32 s33, 4
    s_cbranch_scc1 K2_a4_44
K2_b4_46:
    s_add_u32 m0, s48, 512
    s_add_u32 s65, s48, 1536
    buffer_load_dwordx4 v232, s[16:19], 0 offen  lds
    s_mov_b32 m0, s65
    s_mov_b32 exec_hi, 0
    buffer_load_dwordx4 v233, s[16:19], 0 offen  lds
    s_mov_b32 exec_hi, -1
K2_back_45:
    v_fmac_f32 v236, v11, v131
    v_fmac_f32 v234, v4, v100
    v_fmac_f32 v236, v12, v132
    v_fmac_f32 v234, v5, v101
    v_fmac_f32 v236, v13, v133
    v_fmac_f32 v234, v6, v102
    v_fmac_f32 v236, v14, v134
    v_fmac_f32 v234, v7, v103
    v_fmac_f32 v236, v15, v135
    v_mul_f32 v238, v16, v128
    v_mul_f32 v240, v24, v128
    v_fmac_f32 v238, v17, v129
    v_fmac_f32 v240, v25, v129
    v_fmac_f32 v238, v18, v130
    v_fmac_f32 v240, v26, v130
    v_fmac_f32 v238, v19, v131
    v_fmac_f32 v240, v27, v131
    v_fmac_f32 v238, v20, v132
    v_fmac_f32 v240, v28, v132
    v_fmac_f32 v238, v21, v133
    v_fmac_f32 v240, v29, v133
    v_fmac_f32 v238, v22, v134
    v_fmac_f32 v240, v30, v134
    v_fmac_f32 v238, v23, v135
    v_fmac_f32 v240, v31, v135
    v_mul_f32 v235, v32, v104
    v_mul_f32 v237, v40, v136
    v_fmac_f32 v235, v33, v105
    v_fmac_f32 v237, v41, v137
    v_fmac_f32 v235, v34, v106
    v_fmac_f32 v237, v42, v138
    v_fmac_f32 v235, v35, v107
    v_fmac_f32 v237, v43, v139
    v_fmac_f32 v235, v36, v108
    v_fmac_f32 v237, v44, v140
    v_fmac_f32 v235, v37, v109
    v_fmac_f32 v237, v45, v141
    v_fmac_f32 v235, v38, v110
    v_fmac_f32 v237, v46, v142
    v_fmac_f32 v235, v39, v111
    v_fmac_f32 v237, v47, v143
    v_mul_f32 v239, v48, v136
    v_mul_f32 v241, v56, v136
    s_setprio 1
    s_waitcnt vmcnt(6) lgkmcnt(0)
    v_mfma_f32_32x32x16_bf16 v[0:15], v[64:67], v[184:187], 0
    ds_read_b64_tr_b16 v[176:177], v246 offset:0
    ds_read_b64_tr_b16 v[178:179], v246 offset:1024
    ds_read_b64_tr_b16 v[180:181], v247 offset:0
    ds_read_b64_tr_b16 v[182:183], v247 offset:1024
    v_fmac_f32 v239, v49, v137
    v_fmac_f32 v241, v57, v137
    s_mov_b32 m0, s71
    v_mfma_f32_32x32x16_bf16 v[16:31], v[68:71], v[184:187], 0
    buffer_load_dwordx4 v224, s[4:7], s42 offen sc1 lds
    buffer_load_dwordx4 v225, s[72:75], s42 offen offset:1024 sc1 lds
    v_fmac_f32 v239, v50, v138
    v_fmac_f32 v241, v58, v138
    v_fmac_f32 v239, v51, v139
    v_fmac_f32 v241, v59, v139
    v_fmac_f32 v239, v52, v140
    v_mfma_f32_32x32x16_bf16 v[32:47], v[64:67], v[188:191], 0
    v_fmac_f32 v241, v60, v140
    v_fmac_f32 v239, v53, v141
    v_fmac_f32 v241, v61, v141
    v_fmac_f32 v239, v54, v142
    v_fmac_f32 v241, v62, v142
    v_fmac_f32 v239, v55, v143
    v_fmac_f32 v241, v63, v143
    v_mfma_f32_32x32x16_bf16 v[48:63], v[68:71], v[188:191], 0
    v_permlane32_swap_b32 v234, v236
    v_permlane32_swap_b32 v235, v237
    v_permlane32_swap_b32 v240, v238
    s_waitcnt vmcnt(6) lgkmcnt(0)
    v_mfma_f32_32x32x16_bf16 v[0:15], v[72:75], v[176:179], v[0:15]
    ds_read_b64_tr_b16 v[184:185], v246 offset:2048
    ds_read_b64_tr_b16 v[186:187], v246 offset:3072
    ds_read_b64_tr_b16 v[188:189], v247 offset:2048
    ds_read_b64_tr_b16 v[190:191], v247 offset:3072
    v_permlane32_swap_b32 v241, v239
    s_mov_b32 m0, s68
    v_mfma_f32_32x32x16_bf16 v[16:31], v[76:79], v[176:179], v[16:31]
    buffer_load_dwordx4 v226, s[4:7], s42 offen sc1 lds
    buffer_load_dwordx4 v227, s[72:75], s42 offen offset:1024 sc1 lds
    v_add_f32 v234, v234, v236
    v_add_f32 v235, v235, v237
    v_add_f32 v240, v240, v238
    v_add_f32 v241, v241, v239
    v_mfma_f32_32x32x16_bf16 v[32:47], v[72:75], v[180:183], v[32:47]
    s_set_gpr_idx_on s31, gpr_idx(DST)
    s_nop 0
    v_cvt_pk_bf16_f32 v192, v234, v235
    v_cvt_pk_bf16_f32 v193, v240, v241
    s_set_gpr_idx_off
    v_mfma_f32_32x32x16_bf16 v[48:63], v[76:79], v[180:183], v[48:63]
    s_waitcnt vmcnt(6) lgkmcnt(0)
    v_mfma_f32_32x32x16_bf16 v[0:15], v[80:83], v[184:187], v[0:15]
    ds_read_b64_tr_b16 v[176:177], v246 offset:4096
    ds_read_b64_tr_b16 v[178:179], v246 offset:5120
    ds_read_b64_tr_b16 v[180:181], v247 offset:4096
    ds_read_b64_tr_b16 v[182:183], v247 offset:5120
    s_mov_b32 m0, s69
    v_mfma_f32_32x32x16_bf16 v[16:31], v[84:87], v[184:187], v[16:31]
    buffer_load_dwordx4 v222, s[4:7], s43 offen sc1 lds
    buffer_load_dwordx4 v223, s[72:75], s43 offen offset:1024 sc1 lds
    v_mfma_f32_32x32x16_bf16 v[32:47], v[80:83], v[188:191], v[32:47]
    s_nop 2
    v_mul_f32 v234, v0, v144
    v_mul_f32 v236, v8, v112
    v_fmac_f32 v234, v1, v145
    v_fmac_f32 v236, v9, v113
    v_fmac_f32 v234, v2, v146
    v_fmac_f32 v236, v10, v114
    v_fmac_f32 v234, v3, v147
    v_mfma_f32_32x32x16_bf16 v[48:63], v[84:87], v[188:191], v[48:63]
    s_setprio 0
    v_fmac_f32 v236, v11, v115
    v_fmac_f32 v234, v4, v148
    v_fmac_f32 v236, v12, v116
    v_fmac_f32 v234, v5, v149
    v_fmac_f32 v236, v13, v117
    v_fmac_f32 v234, v6, v150
    v_fmac_f32 v236, v14, v118
    v_fmac_f32 v234, v7, v151
    v_fmac_f32 v236, v15, v119
    v_mul_f32 v238, v16, v160
    v_mul_f32 v240, v24, v160
    v_fmac_f32 v238, v17, v161
    v_fmac_f32 v240, v25, v161
    v_fmac_f32 v238, v18, v162
    v_fmac_f32 v240, v26, v162
    v_fmac_f32 v238, v19, v163
    v_fmac_f32 v240, v27, v163
    v_fmac_f32 v238, v20, v164
    v_fmac_f32 v240, v28, v164
    v_fmac_f32 v238, v21, v165
    v_fmac_f32 v240, v29, v165
    v_fmac_f32 v238, v22, v166
    v_fmac_f32 v240, v30, v166
    v_fmac_f32 v238, v23, v167
    v_fmac_f32 v240, v31, v167
    v_mul_f32 v235, v32, v152
    v_mul_f32 v237, v40, v120
    v_fmac_f32 v235, v33, v153
    v_fmac_f32 v237, v41, v121
    v_fmac_f32 v235, v34, v154
    v_fmac_f32 v237, v42, v122
    v_fmac_f32 v235, v35, v155
    v_fmac_f32 v237, v43, v123
    v_fmac_f32 v235, v36, v156
    v_fmac_f32 v237, v44, v124
    v_fmac_f32 v235, v37, v157
    v_fmac_f32 v237, v45, v125
    v_fmac_f32 v235, v38, v158
    v_fmac_f32 v237, v46, v126
    v_fmac_f32 v235, v39, v159
    v_fmac_f32 v237, v47, v127
    v_mul_f32 v239, v48, v168
    v_mul_f32 v241, v56, v168
    v_fmac_f32 v239, v49, v169
    v_fmac_f32 v241, v57, v169
    s_setprio 1
    s_waitcnt vmcnt(4) lgkmcnt(0)
    v_mfma_f32_32x32x16_bf16 v[0:15], v[64:67], v[176:179], 0
    ds_read_b64_tr_b16 v[184:185], v246 offset:6144
    ds_read_b64_tr_b16 v[186:187], v246 offset:7168
    ds_read_b64_tr_b16 v[188:189], v247 offset:6144
    ds_read_b64_tr_b16 v[190:191], v247 offset:7168
    v_fmac_f32 v239, v50, v170
    v_fmac_f32 v241, v58, v170
    s_mov_b32 m0, s70
    v_mfma_f32_32x32x16_bf16 v[16:31], v[68:71], v[176:179], 0
    buffer_load_dwordx4 v224, s[4:7], s43 offen sc1 lds
    buffer_load_dwordx4 v225, s[72:75], s43 offen offset:1024 sc1 lds
    v_fmac_f32 v239, v51, v171
    v_fmac_f32 v241, v59, v171
    v_fmac_f32 v239, v52, v172
    v_fmac_f32 v241, v60, v172
    v_fmac_f32 v239, v53, v173
    v_mfma_f32_32x32x16_bf16 v[32:47], v[64:67], v[180:183], 0
    v_add_u32 v222, s48, v251
    ds_read2_b32 v[222:223], v222 offset0:1 offset1:3
    v_fmac_f32 v241, v61, v173
    v_fmac_f32 v239, v54, v174
    v_fmac_f32 v241, v62, v174
    v_fmac_f32 v239, v55, v175
    v_fmac_f32 v241, v63, v175
    v_mfma_f32_32x32x16_bf16 v[48:63], v[68:71], v[180:183], 0
    s_waitcnt vmcnt(4) lgkmcnt(1)
    v_mfma_f32_32x32x16_bf16 v[0:15], v[72:75], v[184:187], v[0:15]
    ds_read_b64_tr_b16 v[176:177], v246 offset:0
    ds_read_b64_tr_b16 v[178:179], v246 offset:1024
    ds_read_b64_tr_b16 v[180:181], v247 offset:0
    ds_read_b64_tr_b16 v[182:183], v247 offset:1024
    s_mov_b32 m0, s71
    v_mfma_f32_32x32x16_bf16 v[16:31], v[76:79], v[184:187], v[16:31]
    buffer_load_dwordx4 v226, s[4:7], s43 offen sc1 lds
    buffer_load_dwordx4 v227, s[72:75], s43 offen offset:1024 sc1 lds
    s_waitcnt lgkmcnt(4)
    v_mad_u32_u16 v222, v222, s39, v248 op_sel:[1,0,0,0]
    v_mad_u32_u16 v223, v223, s39, v248 op_sel:[1,0,0,0]
    v_mfma_f32_32x32x16_bf16 v[32:47], v[72:75], v[188:191], v[32:47]
    v_add_u32 v224, s49, v251
    ds_read2_b32 v[224:225], v224 offset0:1 offset1:3
    v_mfma_f32_32x32x16_bf16 v[48:63], v[76:79], v[188:191], v[48:63]
    s_waitcnt vmcnt(4) lgkmcnt(1)
    v_mfma_f32_32x32x16_bf16 v[0:15], v[80:83], v[176:179], v[0:15]
    ds_read_b64_tr_b16 v[184:185], v246 offset:2048
    ds_read_b64_tr_b16 v[186:187], v246 offset:3072
    ds_read_b64_tr_b16 v[188:189], v247 offset:2048
    ds_read_b64_tr_b16 v[190:191], v247 offset:3072
    s_mov_b32 m0, s68
    v_mfma_f32_32x32x16_bf16 v[16:31], v[84:87], v[176:179], v[16:31]
    buffer_load_dwordx4 v222, s[4:7], s44 offen sc1 lds
    buffer_load_dwordx4 v223, s[72:75], s44 offen offset:1024 sc1 lds
    s_waitcnt lgkmcnt(4)
    v_mad_u32_u16 v224, v224, s39, v248 op_sel:[1,0,0,0]
    v_mad_u32_u16 v225, v225, s39, v248 op_sel:[1,0,0,0]
    v_mfma_f32_32x32x16_bf16 v[32:47], v[80:83], v[180:183], v[32:47]
    v_add_u32 v226, s50, v251
    ds_read2_b32 v[226:227], v226 offset0:1 offset1:3
    v_mul_f32 v242, v0, v144
    v_fma_f32 v238, v8, v160, -v238
    v_fmac_f32 v242, v1, v145
    v_fmac_f32 v238, v9, v161
    v_fmac_f32 v242, v2, v146
    v_mfma_f32_32x32x16_bf16 v[48:63], v[84:87], v[180:183], v[48:63]
    s_setprio 0
    v_fmac_f32 v238, v10, v162
    v_fmac_f32 v242, v3, v147
    v_fmac_f32 v238, v11, v163
    v_fmac_f32 v242, v4, v148
    v_fmac_f32 v238, v12, v164
    v_fmac_f32 v242, v5, v149
    v_fmac_f32 v238, v13, v165
    v_fmac_f32 v242, v6, v150
    v_fmac_f32 v238, v14, v166
    v_fmac_f32 v242, v7, v151
    v_fmac_f32 v238, v15, v167
    v_fmac_f32 v236, v16, v112
    v_mul_f32 v244, v24, v160
    v_fmac_f32 v236, v17, v113
    v_fmac_f32 v244, v25, v161
    v_fmac_f32 v236, v18, v114
    v_fmac_f32 v244, v26, v162
    v_fmac_f32 v236, v19, v115
    v_fmac_f32 v244, v27, v163
    v_fmac_f32 v236, v20, v116
    v_fmac_f32 v244, v28, v164
    v_fmac_f32 v236, v21, v117
    v_fmac_f32 v244, v29, v165
    v_fmac_f32 v236, v22, v118
    v_fmac_f32 v244, v30, v166
    v_fmac_f32 v236, v23, v119
    v_fmac_f32 v244, v31, v167
    v_mul_f32 v243, v32, v152
    v_fma_f32 v239, v40, v168, -v239
    v_fmac_f32 v243, v33, v153
    v_fmac_f32 v239, v41, v169
    v_fmac_f32 v243, v34, v154
    v_fmac_f32 v239, v42, v170
    v_fmac_f32 v243, v35, v155
    v_fmac_f32 v239, v43, v171
    v_fmac_f32 v243, v36, v156
    v_fmac_f32 v239, v44, v172
    v_fmac_f32 v243, v37, v157
    v_fmac_f32 v239, v45, v173
    v_fmac_f32 v243, v38, v158
    v_fmac_f32 v239, v46, v174
    v_fmac_f32 v243, v39, v159
    v_fmac_f32 v239, v47, v175
    v_fmac_f32 v237, v48, v120
    v_mul_f32 v245, v56, v168
    v_fmac_f32 v237, v49, v121
    v_fmac_f32 v245, v57, v169
    v_fmac_f32 v237, v50, v122
    v_fmac_f32 v245, v58, v170
    v_fmac_f32 v237, v51, v123
    s_setprio 1
    s_waitcnt vmcnt(4) lgkmcnt(1)
    v_mfma_f32_32x32x16_bf16 v[0:15], v[64:67], v[184:187], 0
    ds_read_b64_tr_b16 v[176:177], v246 offset:4096
    ds_read_b64_tr_b16 v[178:179], v246 offset:5120
    ds_read_b64_tr_b16 v[180:181], v247 offset:4096
    ds_read_b64_tr_b16 v[182:183], v247 offset:5120
    v_fmac_f32 v245, v59, v171
    v_fmac_f32 v237, v52, v124
    s_mov_b32 m0, s69
    v_mfma_f32_32x32x16_bf16 v[16:31], v[68:71], v[184:187], 0
    buffer_load_dwordx4 v224, s[4:7], s45 offen sc1 lds
    buffer_load_dwordx4 v225, s[72:75], s45 offen offset:1024 sc1 lds
    s_waitcnt lgkmcnt(4)
    v_mad_u32_u16 v226, v226, s39, v248 op_sel:[1,0,0,0]
    v_mad_u32_u16 v227, v227, s39, v248 op_sel:[1,0,0,0]
    v_fmac_f32 v245, v60, v172
    v_fmac_f32 v237, v53, v125
    v_mfma_f32_32x32x16_bf16 v[32:47], v[64:67], v[188:191], 0
    v_add_u32 v228, s51, v251
    ds_read2_b32 v[228:229], v228 offset0:1 offset1:3
    v_fmac_f32 v245, v61, v173
    v_fmac_f32 v237, v54, v126
    v_fmac_f32 v245, v62, v174
    v_fmac_f32 v237, v55, v127
    v_fmac_f32 v245, v63, v175
    v_mfma_f32_32x32x16_bf16 v[48:63], v[68:71], v[188:191], 0
    v_permlane32_swap_b32 v242, v234
    v_permlane32_swap_b32 v243, v235
    v_add_f32 v242, v242, v234
    v_add_f32 v243, v243, v235
    s_waitcnt vmcnt(4) lgkmcnt(1)
    v_mfma_f32_32x32x16_bf16 v[0:15], v[72:75], v[176:179], v[0:15]
    ds_read_b64_tr_b16 v[184:185], v246 offset:6144
    ds_read_b64_tr_b16 v[186:187], v246 offset:7168
    ds_read_b64_tr_b16 v[188:189], v247 offset:6144
    ds_read_b64_tr_b16 v[190:191], v247 offset:7168
    s_mov_b32 m0, s70
    v_mfma_f32_32x32x16_bf16 v[16:31], v[76:79], v[176:179], v[16:31]
    buffer_load_dwordx4 v226, s[4:7], s46 offen sc1 lds
    buffer_load_dwordx4 v227, s[72:75], s46 offen offset:1024 sc1 lds
    s_waitcnt lgkmcnt(4)
    v_mad_u32_u16 v228, v228, s39, v248 op_sel:[1,0,0,0]
    v_mad_u32_u16 v229, v229, s39, v248 op_sel:[1,0,0,0]
    s_sub_u32 s26, s48, s29
    s_mov_b32 s29, s48
    v_mfma_f32_32x32x16_bf16 v[32:47], v[72:75], v[180:183], v[32:47]
    s_set_gpr_idx_on s31, gpr_idx(DST)
    s_nop 0
    v_cvt_pk_bf16_f32 v194, v242, v243
    s_set_gpr_idx_off
    s_mov_b32 s30, s3
    s_bfe_u32 s56, s3, 0x40012
    s_cmp_eq_u32 s34, 0
    s_cselect_b32 s56, s56, 0
    v_mfma_f32_32x32x16_bf16 v[48:63], v[76:79], v[180:183], v[48:63]
    s_mov_b32 s32, s31
    s_mov_b32 s31, s35
    s_waitcnt vmcnt(4) lgkmcnt(0)
    v_mfma_f32_32x32x16_bf16 v[0:15], v[80:83], v[184:187], v[0:15]
    ds_read_b64_tr_b16 v[176:177], v246 offset:0
    ds_read_b64_tr_b16 v[178:179], v246 offset:1024
    ds_read_b64_tr_b16 v[180:181], v247 offset:0
    ds_read_b64_tr_b16 v[182:183], v247 offset:1024
    s_mov_b32 m0, s71
    v_mfma_f32_32x32x16_bf16 v[16:31], v[84:87], v[184:187], v[16:31]
    buffer_load_dwordx4 v228, s[4:7], s47 offen sc1 lds
    buffer_load_dwordx4 v229, s[72:75], s47 offen offset:1024 sc1 lds
    v_mfma_f32_32x32x16_bf16 v[32:47], v[80:83], v[188:191], v[32:47]
    s_nop 2
    v_mul_f32 v242, v0, v144
    v_fma_f32 v240, v8, v160, -v240
    v_fmac_f32 v242, v1, v145
    v_fmac_f32 v240, v9, v161
    v_fmac_f32 v242, v2, v146
    v_fmac_f32 v240, v10, v162
    v_fmac_f32 v242, v3, v147
    v_mfma_f32_32x32x16_bf16 v[48:63], v[84:87], v[188:191], v[48:63]
    s_setprio 0
    v_fmac_f32 v240, v11, v163
    v_fmac_f32 v242, v4, v148
    v_fmac_f32 v240, v12, v164
    v_fmac_f32 v242, v5, v149
    v_fmac_f32 v240, v13, v165
    v_fmac_f32 v242, v6, v150
    v_fmac_f32 v240, v14, v166
    v_fmac_f32 v242, v7, v151
    v_fmac_f32 v240, v15, v167
    v_add_u32 v249, s26, v249
    v_add_u32 v250, s26, v250
    v_fma_f32 v244, v16, v160, -v244
    v_fmac_f32 v236, v24, v112
    v_fmac_f32 v244, v17, v161
    v_fmac_f32 v236, v25, v113
    v_fmac_f32 v244, v18, v162
    v_fmac_f32 v236, v26, v114
    v_fmac_f32 v244, v19, v163
    v_fmac_f32 v236, v27, v115
    v_fmac_f32 v244, v20, v164
    v_fmac_f32 v236, v28, v116
    v_fmac_f32 v244, v21, v165
    v_fmac_f32 v236, v29, v117
    v_fmac_f32 v244, v22, v166
    v_fmac_f32 v236, v30, v118
    v_fmac_f32 v244, v23, v167
    v_fmac_f32 v236, v31, v119
    ds_read_b64_tr_b16 v[0:1], v249 offset:0
    ds_read_b64_tr_b16 v[2:3], v249 offset:32
    ds_read_u16_d16_hi v16, v250 offset:0
    v_mul_f32 v243, v32, v152
    v_fma_f32 v241, v40, v168, -v241
    v_fmac_f32 v243, v33, v153
    v_fmac_f32 v241, v41, v169
    v_fmac_f32 v243, v34, v154
    v_fmac_f32 v241, v42, v170
    v_fmac_f32 v243, v35, v155
    v_fmac_f32 v241, v43, v171
    v_fmac_f32 v243, v36, v156
    v_fmac_f32 v241, v44, v172
    v_fmac_f32 v243, v37, v157
    v_fmac_f32 v241, v45, v173
    v_fmac_f32 v243, v38, v158
    v_fmac_f32 v241, v46, v174
    v_fmac_f32 v243, v39, v159
    v_fmac_f32 v241, v47, v175
    ds_read_b64_tr_b16 v[4:5], v249 offset:512
    ds_read_b64_tr_b16 v[6:7], v249 offset:544
    ds_read_u16_d16_hi v17, v250 offset:128
    v_fma_f32 v245, v48, v168, -v245
    v_fmac_f32 v237, v56, v120
    v_fmac_f32 v245, v49, v169
    v_fmac_f32 v237, v57, v121
    v_fmac_f32 v245, v50, v170
    v_fmac_f32 v237, v58, v122
    v_fmac_f32 v245, v51, v171
    v_fmac_f32 v237, v59, v123
    v_fmac_f32 v245, v52, v172
    v_fmac_f32 v237, v60, v124
    v_fmac_f32 v245, v53, v173
    v_fmac_f32 v237, v61, v125
    v_fmac_f32 v245, v54, v174
    v_fmac_f32 v237, v62, v126
    v_fmac_f32 v245, v55, v175
    v_fmac_f32 v237, v63, v127
    s_cmp_eq_u32 s56, 5
    s_cbranch_scc1 K2_U20
    s_cmp_eq_u32 s56, 6
    s_cbranch_scc1 K2_U3h0
    s_branch K2_DSP0
K2_PAD_U21:
    s_branch K2_HOP
K2_U21:
    s_setprio 1
    s_waitcnt lgkmcnt(0)
    v_lshlrev_b32 v20, 16, v0
    v_and_b32 v21, 0xffff0000, v0
    v_lshlrev_b32 v22, 16, v1
    v_and_b32 v23, 0xffff0000, v1
    v_lshlrev_b32 v24, 16, v2
    v_and_b32 v25, 0xffff0000, v2
    v_lshlrev_b32 v26, 16, v3
    v_and_b32 v27, 0xffff0000, v3
    v_mul_f32_dpp v36, v16, v20 row_newbcast:8 row_mask:0xf bank_mask:0xf
    v_mul_f32_dpp v37, v16, v21 row_newbcast:9 row_mask:0xf bank_mask:0xf
    v_mul_f32_dpp v38, v16, v22 row_newbcast:10 row_mask:0xf bank_mask:0xf
    v_mul_f32_dpp v39, v16, v23 row_newbcast:11 row_mask:0xf bank_mask:0xf
    v_mul_f32_dpp v40, v16, v24 row_newbcast:12 row_mask:0xf bank_mask:0xf
    v_mul_f32_dpp v41, v16, v25 row_newbcast:13 row_mask:0xf bank_mask:0xf
    v_mul_f32_dpp v42, v16, v26 row_newbcast:14 row_mask:0xf bank_mask:0xf
    v_mul_f32_dpp v43, v16, v27 row_newbcast:15 row_mask:0xf bank_mask:0xf
    v_cvt_pk_bf16_f32 v68, v36, v37
    v_cvt_pk_bf16_f32 v69, v38, v39
    v_cvt_pk_bf16_f32 v70, v40, v41
    v_cvt_pk_bf16_f32 v71, v42, v43
    v_mul_f32_dpp v20, v16, v20 row_newbcast:0 row_mask:0xa bank_mask:0xf
    v_mul_f32_dpp v21, v16, v21 row_newbcast:1 row_mask:0xa bank_mask:0xf
    v_mul_f32_dpp v22, v16, v22 row_newbcast:2 row_mask:0xa bank_mask:0xf
    v_mul_f32_dpp v23, v16, v23 row_newbcast:3 row_mask:0xa bank_mask:0xf
    v_mul_f32_dpp v24, v16, v24 row_newbcast:4 row_mask:0xa bank_mask:0xf
    v_mul_f32_dpp v25, v16, v25 row_newbcast:5 row_mask:0xa bank_mask:0xf
    v_mul_f32_dpp v26, v16, v26 row_newbcast:6 row_mask:0xa bank_mask:0xf
    v_mul_f32_dpp v27, v16, v27 row_newbcast:7 row_mask:0xa bank_mask:0xf
    v_cvt_pk_bf16_f32 v64, v20, v21
    v_cvt_pk_bf16_f32 v65, v22, v23
    v_cvt_pk_bf16_f32 v66, v24, v25
    v_cvt_pk_bf16_f32 v67, v26, v27
    v_lshlrev_b32 v28, 16, v4
    v_and_b32 v29, 0xffff0000, v4
    v_lshlrev_b32 v30, 16, v5
    v_and_b32 v31, 0xffff0000, v5
    v_lshlrev_b32 v32, 16, v6
    v_and_b32 v33, 0xffff0000, v6
    v_lshlrev_b32 v34, 16, v7
    v_and_b32 v35, 0xffff0000, v7
    v_mul_f32_dpp v36, v17, v28 row_newbcast:8 row_mask:0xf bank_mask:0xf
    v_mul_f32_dpp v37, v17, v29 row_newbcast:9 row_mask:0xf bank_mask:0xf
    v_mul_f32_dpp v38, v17, v30 row_newbcast:10 row_mask:0xf bank_mask:0xf
    v_mul_f32_dpp v39, v17, v31 row_newbcast:11 row_mask:0xf bank_mask:0xf
    v_mul_f32_dpp v40, v17, v32 row_newbcast:12 row_mask:0xf bank_mask:0xf
    v_mul_f32_dpp v41, v17, v33 row_newbcast:13 row_mask:0xf bank_mask:0xf
    v_mul_f32_dpp v42, v17, v34 row_newbcast:14 row_mask:0xf bank_mask:0xf
    v_mul_f32_dpp v43, v17, v35 row_newbcast:15 row_mask:0xf bank_mask:0xf
    v_cvt_pk_bf16_f32 v76, v36, v37
    v_cvt_pk_bf16_f32 v77, v38, v39
    v_cvt_pk_bf16_f32 v78, v40, v41
    v_cvt_pk_bf16_f32 v79, v42, v43
    v_mul_f32_dpp v28, v17, v28 row_newbcast:0 row_mask:0xa bank_mask:0xf
    v_mul_f32_dpp v29, v17, v29 row_newbcast:1 row_mask:0xa bank_mask:0xf
    v_mul_f32_dpp v30, v17, v30 row_newbcast:2 row_mask:0xa bank_mask:0xf
    v_mul_f32_dpp v31, v17, v31 row_newbcast:3 row_mask:0xa bank_mask:0xf
    v_mul_f32_dpp v32, v17, v32 row_newbcast:4 row_mask:0xa bank_mask:0xf
    v_mul_f32_dpp v33, v17, v33 row_newbcast:5 row_mask:0xa bank_mask:0xf
    v_mul_f32_dpp v34, v17, v34 row_newbcast:6 row_mask:0xa bank_mask:0xf
    v_mul_f32_dpp v35, v17, v35 row_newbcast:7 row_mask:0xa bank_mask:0xf
    v_cvt_pk_bf16_f32 v72, v28, v29
    v_cvt_pk_bf16_f32 v73, v30, v31
    v_cvt_pk_bf16_f32 v74, v32, v33
    v_cvt_pk_bf16_f32 v75, v34, v35
    s_waitcnt vmcnt(4)
    v_mfma_f32_32x32x16_bf16 v[0:15], v[64:67], v[176:179], 0
    ds_read_b64_tr_b16 v[184:185], v246 offset:2048
    ds_read_b64_tr_b16 v[186:187], v246 offset:3072
    ds_read_b64_tr_b16 v[188:189], v247 offset:2048
    ds_read_b64_tr_b16 v[190:191], v247 offset:3072
    s_mov_b32 m0, s68
    v_mfma_f32_32x32x16_bf16 v[16:31], v[68:71], v[176:179], 0
    buffer_load_dwordx4 v222, s[4:7], s42 offen sc1 lds
    buffer_load_dwordx4 v223, s[72:75], s42 offen offset:1024 sc1 lds
    v_permlane32_swap_b32 v242, v236
    v_permlane32_swap_b32 v243, v237
    v_mov_b32 v254, 163296
    v_mfma_f32_32x32x16_bf16 v[32:47], v[64:67], v[180:183], 0
    v_permlane32_swap_b32 v244, v238
    v_permlane32_swap_b32 v245, v239
    v_permlane32_swap_b32 v240, v241
    v_add_f32 v242, v242, v236
    v_mfma_f32_32x32x16_bf16 v[48:63], v[68:71], v[180:183], 0
    v_add_f32 v243, v243, v237
    v_add_f32 v244, v244, v238
    v_add_f32 v245, v245, v239
    v_add_f32 v240, -v240, -v241
    v_sub_u32 v241, v230, v231
    v_cvt_pk_bf16_f32 v242, v242, v243
    v_mov_b32 v255, 1
    v_lshl_add_u32 v233, v252, 1, s53
    s_mov_b64 exec, 1
    ds_add_rtn_u32 v232, v254, v255
    s_mov_b64 exec, -1
    ds_read_b32 v233, v233
    s_waitcnt vmcnt(4) lgkmcnt(2)
    v_mfma_f32_32x32x16_bf16 v[0:15], v[72:75], v[184:187], v[0:15]
    ds_read_b64_tr_b16 v[176:177], v246 offset:4096
    ds_read_b64_tr_b16 v[178:179], v246 offset:5120
    ds_read_b64_tr_b16 v[180:181], v247 offset:4096
    ds_read_b64_tr_b16 v[182:183], v247 offset:5120
    v_cvt_pk_bf16_f32 v244, v244, v245
    v_cvt_pk_bf16_f32 v240, v240, v240
    s_mov_b32 m0, s69
    v_mfma_f32_32x32x16_bf16 v[16:31], v[76:79], v[184:187], v[16:31]
    buffer_load_dwordx4 v224, s[4:7], s42 offen sc1 lds
    buffer_load_dwordx4 v225, s[72:75], s42 offen offset:1024 sc1 lds
    ds_write_b32 v230, v242 offset:768
    ds_write_b32 v230, v244 offset:1024
    ds_write_b16 v241, v240 offset:1280
    s_waitcnt lgkmcnt(7)
    v_readfirstlane_b32 s58, v232
    v_mfma_f32_32x32x16_bf16 v[32:47], v[72:75], v[188:191], v[32:47]
    s_cmp_lt_u32 s58, s22
    s_cbranch_scc0 K2_nul_47
    s_and_b32 s59, s58, 7
    s_lshr_b32 s60, s58, 3
K2_chk_49:
    v_readlane_b32 s61, v233, s59
    s_nop 0
    s_cmp_gt_u32 s61, s60
    s_cbranch_scc0 K2_spin_48
K2_back_50:
    v_mfma_f32_32x32x16_bf16 v[48:63], v[76:79], v[188:191], v[48:63]
    s_setprio 0
    v_readlane_b32 s3, v253, s58
    s_lshl_b32 s44, s34, 7
    s_and_b32 s48, s3, 0x3ffff
    s_bfe_u32 s33, s3, 0x30013
    s_mov_b32 s35, s48
    s_mov_b32 s45, s44
    v_mul_f32 v234, v0, v96
    v_mul_f32 v236, v8, v128
    v_fmac_f32 v234, v1, v97
    v_fmac_f32 v236, v9, v129
    v_fmac_f32 v234, v2, v98
    v_fmac_f32 v236, v10, v130
    v_fmac_f32 v234, v3, v99
    v_fmac_f32 v236, v11, v131
    v_fmac_f32 v234, v4, v100
    v_fmac_f32 v236, v12, v132
    v_fmac_f32 v234, v5, v101
    v_fmac_f32 v236, v13, v133
    v_fmac_f32 v234, v6, v102
    v_fmac_f32 v236, v14, v134
    v_fmac_f32 v234, v7, v103
    v_fmac_f32 v236, v15, v135
    v_mul_f32 v238, v16, v128
    v_mul_f32 v240, v24, v128
    v_fmac_f32 v238, v17, v129
    v_fmac_f32 v240, v25, v129
    v_fmac_f32 v238, v18, v130
    v_fmac_f32 v240, v26, v130
    v_fmac_f32 v238, v19, v131
    v_fmac_f32 v240, v27, v131
    v_fmac_f32 v238, v20, v132
    v_fmac_f32 v240, v28, v132
    v_fmac_f32 v238, v21, v133
    v_fmac_f32 v240, v29, v133
    v_fmac_f32 v238, v22, v134
    v_fmac_f32 v240, v30, v134
    v_fmac_f32 v238, v23, v135
    v_fmac_f32 v240, v31, v135
    v_mul_f32 v235, v32, v104
    v_mul_f32 v237, v40, v136
    v_fmac_f32 v235, v33, v105
    v_fmac_f32 v237, v41, v137
    v_fmac_f32 v235, v34, v106
    v_fmac_f32 v237, v42, v138
    v_fmac_f32 v235, v35, v107
    v_fmac_f32 v237, v43, v139
    v_fmac_f32 v235, v36, v108
    v_fmac_f32 v237, v44, v140
    v_fmac_f32 v235, v37, v109
    v_fmac_f32 v237, v45, v141
    v_fmac_f32 v235, v38, v110
    v_fmac_f32 v237, v46, v142
    v_fmac_f32 v235, v39, v111
    v_fmac_f32 v237, v47, v143
    v_mul_f32 v239, v48, v136
    v_mul_f32 v241, v56, v136
    v_fmac_f32 v239, v49, v137
    v_fmac_f32 v241, v57, v137
    s_setprio 1
    s_waitcnt vmcnt(4) lgkmcnt(3)
    v_mfma_f32_32x32x16_bf16 v[0:15], v[64:67], v[176:179], 0
    ds_read_b64_tr_b16 v[184:185], v246 offset:6144
    ds_read_b64_tr_b16 v[186:187], v246 offset:7168
    ds_read_b64_tr_b16 v[188:189], v247 offset:6144
    ds_read_b64_tr_b16 v[190:191], v247 offset:7168
    v_fmac_f32 v239, v50, v138
    v_fmac_f32 v241, v58, v138
    s_mov_b32 m0, s70
    v_mfma_f32_32x32x16_bf16 v[16:31], v[68:71], v[176:179], 0
    buffer_load_dwordx4 v222, s[4:7], s43 offen sc1 lds
    buffer_load_dwordx4 v223, s[72:75], s43 offen offset:1024 sc1 lds
    v_fmac_f32 v239, v51, v139
    v_fmac_f32 v241, v59, v139
    v_fmac_f32 v239, v52, v140
    v_fmac_f32 v241, v60, v140
    v_fmac_f32 v239, v53, v141
    v_mfma_f32_32x32x16_bf16 v[32:47], v[64:67], v[180:183], 0
    s_add_u32 s47, s44, 256
    s_add_u32 s49, s48, 128
    s_add_u32 s60, s48, 256
    s_cmp_eq_u32 s33, 3
    s_cselect_b32 s46, s44, s47
    s_cselect_b32 s50, s60, s48
    s_cselect_b32 s51, s48, s49
    s_sub_u32 s60, s33, 2
    s_cmp_lt_u32 s60, 2
    s_cbranch_scc0 K2_rare_51
K2_back_52:
    v_add_u32 v222, s48, v251
    ds_read2_b32 v[222:223], v222 offset0:1 offset1:3
    v_fmac_f32 v241, v61, v141
    v_fmac_f32 v239, v54, v142
    v_fmac_f32 v241, v62, v142
    v_fmac_f32 v239, v55, v143
    v_fmac_f32 v241, v63, v143
    v_mfma_f32_32x32x16_bf16 v[48:63], v[68:71], v[180:183], 0
    v_permlane32_swap_b32 v234, v236
    v_permlane32_swap_b32 v235, v237
    v_permlane32_swap_b32 v240, v238
    s_waitcnt vmcnt(4) lgkmcnt(1)
    v_mfma_f32_32x32x16_bf16 v[0:15], v[72:75], v[184:187], v[0:15]
    ds_read_b64_tr_b16 v[176:177], v246 offset:0
    ds_read_b64_tr_b16 v[178:179], v246 offset:1024
    ds_read_b64_tr_b16 v[180:181], v247 offset:0
    ds_read_b64_tr_b16 v[182:183], v247 offset:1024
    v_permlane32_swap_b32 v241, v239
    s_mov_b32 m0, s71
    v_mfma_f32_32x32x16_bf16 v[16:31], v[76:79], v[184:187], v[16:31]
    buffer_load_dwordx4 v224, s[4:7], s43 offen sc1 lds
    buffer_load_dwordx4 v225, s[72:75], s43 offen offset:1024 sc1 lds
    s_waitcnt lgkmcnt(4)
    v_mad_u32_u16 v222, v222, s39, v248 op_sel:[1,0,0,0]
    v_mad_u32_u16 v223, v223, s39, v248 op_sel:[1,0,0,0]
    v_lshl_add_u32 v230, v252, 1, s31
    v_add_f32 v234, v234, v236
    v_add_f32 v235, v235, v237
    v_add_f32 v240, v240, v238
    v_add_f32 v241, v241, v239
    v_cvt_pk_bf16_f32 v234, v234, v235
    v_cvt_pk_bf16_f32 v240, v240, v241
    ds_write_b32 v230, v234 offset:0
    ds_write_b32 v230, v240 offset:256
    v_mfma_f32_32x32x16_bf16 v[32:47], v[72:75], v[188:191], v[32:47]
    v_add_u32 v224, s49, v251
    ds_read2_b32 v[224:225], v224 offset0:1 offset1:3
    v_mul_f32 v234, v0, v144
    v_mul_f32 v236, v8, v112
    v_fmac_f32 v234, v1, v145
    v_fmac_f32 v236, v9, v113
    v_fmac_f32 v234, v2, v146
    v_mfma_f32_32x32x16_bf16 v[48:63], v[76:79], v[188:191], v[48:63]
    s_setprio 0
    v_fmac_f32 v236, v10, v114
    v_fmac_f32 v234, v3, v147
    v_fmac_f32 v236, v11, v115
    v_fmac_f32 v234, v4, v148
    v_fmac_f32 v236, v12, v116
    v_fmac_f32 v234, v5, v149
    v_fmac_f32 v236, v13, v117
    v_fmac_f32 v234, v6, v150
    v_fmac_f32 v236, v14, v118
    v_fmac_f32 v234, v7, v151
    v_fmac_f32 v236, v15, v119
    v_mul_f32 v238, v16, v160
    v_mul_f32 v240, v24, v160
    v_fmac_f32 v238, v17, v161
    v_fmac_f32 v240, v25, v161
    v_fmac_f32 v238, v18, v162
    v_fmac_f32 v240, v26, v162
    v_fmac_f32 v238, v19, v163
    v_fmac_f32 v240, v27, v163
    v_fmac_f32 v238, v20, v164
    v_fmac_f32 v240, v28, v164
    v_fmac_f32 v238, v21, v165
    v_fmac_f32 v240, v29, v165
    v_fmac_f32 v238, v22, v166
    v_fmac_f32 v240, v30, v166
    v_fmac_f32 v238, v23, v167
    v_fmac_f32 v240, v31, v167
    v_mul_f32 v235, v32, v152
    v_mul_f32 v237, v40, v120
    v_fmac_f32 v235, v33, v153
    v_fmac_f32 v237, v41, v121
    v_fmac_f32 v235, v34, v154
    v_fmac_f32 v237, v42, v122
    v_fmac_f32 v235, v35, v155
    v_fmac_f32 v237, v43, v123
    v_fmac_f32 v235, v36, v156
    v_fmac_f32 v237, v44, v124
    v_fmac_f32 v235, v37, v157
    v_fmac_f32 v237, v45, v125
    v_fmac_f32 v235, v38, v158
    v_fmac_f32 v237, v46, v126
    v_fmac_f32 v235, v39, v159
    v_fmac_f32 v237, v47, v127
    v_mul_f32 v239, v48, v168
    v_mul_f32 v241, v56, v168
    v_fmac_f32 v239, v49, v169
    v_fmac_f32 v241, v57, v169
    v_fmac_f32 v239, v50, v170
    v_fmac_f32 v241, v58, v170
    v_fmac_f32 v239, v51, v171
    s_setprio 1
    s_waitcnt vmcnt(4) lgkmcnt(3)
    v_mfma_f32_32x32x16_bf16 v[0:15], v[64:67], v[176:179], 0
    ds_read_b64_tr_b16 v[184:185], v246 offset:2048
    ds_read_b64_tr_b16 v[186:187], v246 offset:3072
    ds_read_b64_tr_b16 v[188:189], v247 offset:2048
    ds_read_b64_tr_b16 v[190:191], v247 offset:3072
    v_fmac_f32 v241, v59, v171
    v_fmac_f32 v239, v52, v172
    s_mov_b32 m0, s68
    v_mfma_f32_32x32x16_bf16 v[16:31], v[68:71], v[176:179], 0
    buffer_load_dwordx4 v222, s[4:7], s44 offen sc1 lds
    buffer_load_dwordx4 v223, s[72:75], s44 offen offset:1024 sc1 lds
    s_waitcnt lgkmcnt(4)
    v_mad_u32_u16 v224, v224, s39, v248 op_sel:[1,0,0,0]
    v_mad_u32_u16 v225, v225, s39, v248 op_sel:[1,0,0,0]
    v_fmac_f32 v241, v60, v172
    v_fmac_f32 v239, v53, v173
    v_mfma_f32_32x32x16_bf16 v[32:47], v[64:67], v[180:183], 0
    v_add_u32 v226, s50, v251
    ds_read2_b32 v[226:227], v226 offset0:1 offset1:3
    v_fmac_f32 v241, v61, v173
    v_fmac_f32 v239, v54, v174
    v_fmac_f32 v241, v62, v174
    v_fmac_f32 v239, v55, v175
    v_fmac_f32 v241, v63, v175
    v_mfma_f32_32x32x16_bf16 v[48:63], v[68:71], v[180:183], 0
    s_waitcnt vmcnt(4) lgkmcnt(1)
    v_mfma_f32_32x32x16_bf16 v[0:15], v[72:75], v[184:187], v[0:15]
    ds_read_b64_tr_b16 v[176:177], v246 offset:4096
    ds_read_b64_tr_b16 v[178:179], v246 offset:5120
    ds_read_b64_tr_b16 v[180:181], v247 offset:4096
    ds_read_b64_tr_b16 v[182:183], v247 offset:5120
    s_mov_b32 m0, s69
    v_mfma_f32_32x32x16_bf16 v[16:31], v[76:79], v[184:187], v[16:31]
    buffer_load_dwordx4 v224, s[4:7], s45 offen sc1 lds
    buffer_load_dwordx4 v225, s[72:75], s45 offen offset:1024 sc1 lds
    s_waitcnt lgkmcnt(4)
    v_mad_u32_u16 v226, v226, s39, v248 op_sel:[1,0,0,0]
    v_mad_u32_u16 v227, v227, s39, v248 op_sel:[1,0,0,0]
    v_mfma_f32_32x32x16_bf16 v[32:47], v[72:75], v[188:191], v[32:47]
    v_add_u32 v228, s51, v251
    ds_read2_b32 v[228:229], v228 offset0:1 offset1:3
    v_mul_f32 v242, v0, v144
    v_fma_f32 v238, v8, v160, -v238
    v_fmac_f32 v242, v1, v145
    v_fmac_f32 v238, v9, v161
    v_fmac_f32 v242, v2, v146
    v_mfma_f32_32x32x16_bf16 v[48:63], v[76:79], v[188:191], v[48:63]
    s_setprio 0
    v_fmac_f32 v238, v10, v162
    v_fmac_f32 v242, v3, v147
    v_fmac_f32 v238, v11, v163
    v_fmac_f32 v242, v4, v148
    v_fmac_f32 v238, v12, v164
    v_fmac_f32 v242, v5, v149
    v_fmac_f32 v238, v13, v165
    v_fmac_f32 v242, v6, v150
    v_fmac_f32 v238, v14, v166
    v_fmac_f32 v242, v7, v151
    v_fmac_f32 v238, v15, v167
    v_fmac_f32 v236, v16, v112
    v_mul_f32 v244, v24, v160
    v_fmac_f32 v236, v17, v113
    v_fmac_f32 v244, v25, v161
    v_fmac_f32 v236, v18, v114
    v_fmac_f32 v244, v26, v162
    v_fmac_f32 v236, v19, v115
    v_fmac_f32 v244, v27, v163
    v_fmac_f32 v236, v20, v116
    v_fmac_f32 v244, v28, v164
    v_fmac_f32 v236, v21, v117
    v_fmac_f32 v244, v29, v165
    v_fmac_f32 v236, v22, v118
    v_fmac_f32 v244, v30, v166
    v_fmac_f32 v236, v23, v119
    v_fmac_f32 v244, v31, v167
    v_mul_f32 v243, v32, v152
    v_fma_f32 v239, v40, v168, -v239
    v_fmac_f32 v243, v33, v153
    v_fmac_f32 v239, v41, v169
    v_fmac_f32 v243, v34, v154
    v_fmac_f32 v239, v42, v170
    v_fmac_f32 v243, v35, v155
    v_fmac_f32 v239, v43, v171
    v_fmac_f32 v243, v36, v156
    v_fmac_f32 v239, v44, v172
    v_fmac_f32 v243, v37, v157
    v_fmac_f32 v239, v45, v173
    v_fmac_f32 v243, v38, v158
    v_fmac_f32 v239, v46, v174
    v_fmac_f32 v243, v39, v159
    v_fmac_f32 v239, v47, v175
    v_fmac_f32 v237, v48, v120
    v_mul_f32 v245, v56, v168
    v_fmac_f32 v237, v49, v121
    v_fmac_f32 v245, v57, v169
    v_fmac_f32 v237, v50, v122
    s_setprio 1
    s_waitcnt vmcnt(4) lgkmcnt(1)
    v_mfma_f32_32x32x16_bf16 v[0:15], v[64:67], v[176:179], 0
    ds_read_b64_tr_b16 v[184:185], v246 offset:6144
    ds_read_b64_tr_b16 v[186:187], v246 offset:7168
    ds_read_b64_tr_b16 v[188:189], v247 offset:6144
    ds_read_b64_tr_b16 v[190:191], v247 offset:7168
    v_fmac_f32 v245, v58, v170
    v_fmac_f32 v237, v51, v123
    s_mov_b32 m0, s70
    v_mfma_f32_32x32x16_bf16 v[16:31], v[68:71], v[176:179], 0
    buffer_load_dwordx4 v226, s[4:7], s46 offen sc1 lds
    buffer_load_dwordx4 v227, s[72:75], s46 offen offset:1024 sc1 lds
    s_waitcnt lgkmcnt(4)
    v_mad_u32_u16 v228, v228, s39, v248 op_sel:[1,0,0,0]
    v_mad_u32_u16 v229, v229, s39, v248 op_sel:[1,0,0,0]
    v_fmac_f32 v245, v59, v171
    v_fmac_f32 v237, v52, v124
    v_mfma_f32_32x32x16_bf16 v[32:47], v[64:67], v[180:183], 0
    v_fmac_f32 v245, v60, v172
    v_fmac_f32 v237, v53, v125
    v_fmac_f32 v245, v61, v173
    v_fmac_f32 v237, v54, v126
    v_fmac_f32 v245, v62, v174
    v_fmac_f32 v237, v55, v127
    v_fmac_f32 v245, v63, v175
    v_mfma_f32_32x32x16_bf16 v[48:63], v[68:71], v[180:183], 0
    v_permlane32_swap_b32 v242, v234
    v_permlane32_swap_b32 v243, v235
    v_add_f32 v242, v242, v234
    v_add_f32 v243, v243, v235
    s_waitcnt vmcnt(4) lgkmcnt(0)
    v_mfma_f32_32x32x16_bf16 v[0:15], v[72:75], v[184:187], v[0:15]
    ds_read_b64_tr_b16 v[176:177], v246 offset:0
    ds_read_b64_tr_b16 v[178:179], v246 offset:1024
    ds_read_b64_tr_b16 v[180:181], v247 offset:0
    ds_read_b64_tr_b16 v[182:183], v247 offset:1024
    v_cvt_pk_bf16_f32 v242, v242, v243
    ds_write_b32 v230, v242 offset:512
    s_mov_b32 m0, s71
    v_mfma_f32_32x32x16_bf16 v[16:31], v[76:79], v[184:187], v[16:31]
    buffer_load_dwordx4 v228, s[4:7], s47 offen sc1 lds
    buffer_load_dwordx4 v229, s[72:75], s47 offen offset:1024 sc1 lds
    s_sub_u32 s26, s48, s29
    s_mov_b32 s29, s48
    s_mov_b32 s30, s3
    s_bfe_u32 s56, s3, 0x40012
    s_cmp_lg_u32 s36, 0
    s_cselect_b32 s56, s56, 0
    v_mfma_f32_32x32x16_bf16 v[32:47], v[72:75], v[188:191], v[32:47]
    s_mov_b32 s32, s31
    s_mov_b32 s31, s35
    v_mul_f32 v242, v0, v144
    v_fma_f32 v240, v8, v160, -v240
    v_fmac_f32 v242, v1, v145
    v_fmac_f32 v240, v9, v161
    v_fmac_f32 v242, v2, v146
    v_mfma_f32_32x32x16_bf16 v[48:63], v[76:79], v[188:191], v[48:63]
    s_setprio 0
    v_fmac_f32 v240, v10, v162
    v_fmac_f32 v242, v3, v147
    v_fmac_f32 v240, v11, v163
    v_fmac_f32 v242, v4, v148
    v_fmac_f32 v240, v12, v164
    v_fmac_f32 v242, v5, v149
    v_fmac_f32 v240, v13, v165
    v_fmac_f32 v242, v6, v150
    v_fmac_f32 v240, v14, v166
    v_fmac_f32 v242, v7, v151
    v_fmac_f32 v240, v15, v167
    v_add_u32 v249, s26, v249
    v_add_u32 v250, s26, v250
    v_fma_f32 v244, v16, v160, -v244
    v_fmac_f32 v236, v24, v112
    v_fmac_f32 v244, v17, v161
    v_fmac_f32 v236, v25, v113
    v_fmac_f32 v244, v18, v162
    v_fmac_f32 v236, v26, v114
    v_fmac_f32 v244, v19, v163
    v_fmac_f32 v236, v27, v115
    v_fmac_f32 v244, v20, v164
    v_fmac_f32 v236, v28, v116
    v_fmac_f32 v244, v21, v165
    v_fmac_f32 v236, v29, v117
    v_fmac_f32 v244, v22, v166
    v_fmac_f32 v236, v30, v118
    v_fmac_f32 v244, v23, v167
    v_fmac_f32 v236, v31, v119
    ds_read_b64_tr_b16 v[0:1], v249 offset:0
    ds_read_b64_tr_b16 v[2:3], v249 offset:32
    ds_read_u16_d16_hi v16, v250 offset:0
    v_mul_f32 v243, v32, v152
    v_fma_f32 v241, v40, v168, -v241
    v_fmac_f32 v243, v33, v153
    v_fmac_f32 v241, v41, v169
    v_fmac_f32 v243, v34, v154
    v_fmac_f32 v241, v42, v170
    v_fmac_f32 v243, v35, v155
    v_fmac_f32 v241, v43, v171
    v_fmac_f32 v243, v36, v156
    v_fmac_f32 v241, v44, v172
    v_fmac_f32 v243, v37, v157
    v_fmac_f32 v241, v45, v173
    v_fmac_f32 v243, v38, v158
    v_fmac_f32 v241, v46, v174
    v_fmac_f32 v243, v39, v159
    v_fmac_f32 v241, v47, v175
    ds_read_b64_tr_b16 v[4:5], v249 offset:512
    ds_read_b64_tr_b16 v[6:7], v249 offset:544
    ds_read_u16_d16_hi v17, v250 offset:128
    v_fma_f32 v245, v48, v168, -v245
    v_fmac_f32 v237, v56, v120
    v_fmac_f32 v245, v49, v169
    v_fmac_f32 v237, v57, v121
    v_fmac_f32 v245, v50, v170
    v_fmac_f32 v237, v58, v122
    v_fmac_f32 v245, v51, v171
    v_fmac_f32 v237, v59, v123
    v_fmac_f32 v245, v52, v172
    v_fmac_f32 v237, v60, v124
    v_fmac_f32 v245, v53, v173
    v_fmac_f32 v237, v61, v125
    v_fmac_f32 v245, v54, v174
    v_fmac_f32 v237, v62, v126
    v_fmac_f32 v245, v55, v175
    v_fmac_f32 v237, v63, v127
    s_cmp_eq_u32 s56, 5
    s_cbranch_scc1 K2_U21
    s_cmp_eq_u32 s56, 6
    s_cbranch_scc1 K2_U3h1
    s_branch K2_DSP1
K2_PAD_U31:
    s_branch K2_HOP
K2_U3h1:
    s_setprio 1
    ds_read_b64_tr_b16 v[8:9], v249 offset:1024
    ds_read_u16_d16_hi v18, v250 offset:256
    s_waitcnt lgkmcnt(2)
    v_lshlrev_b32 v20, 16, v0
    v_and_b32 v21, 0xffff0000, v0
    v_lshlrev_b32 v22, 16, v1
    v_and_b32 v23, 0xffff0000, v1
    v_lshlrev_b32 v24, 16, v2
    v_and_b32 v25, 0xffff0000, v2
    v_lshlrev_b32 v26, 16, v3
    v_and_b32 v27, 0xffff0000, v3
    v_mul_f32_dpp v36, v16, v20 row_newbcast:8 row_mask:0xf bank_mask:0xf
    v_mul_f32_dpp v37, v16, v21 row_newbcast:9 row_mask:0xf bank_mask:0xf
    v_mul_f32_dpp v38, v16, v22 row_newbcast:10 row_mask:0xf bank_mask:0xf
    v_mul_f32_dpp v39, v16, v23 row_newbcast:11 row_mask:0xf bank_mask:0xf
    v_mul_f32_dpp v40, v16, v24 row_newbcast:12 row_mask:0xf bank_mask:0xf
    v_mul_f32_dpp v41, v16, v25 row_newbcast:13 row_mask:0xf bank_mask:0xf
    v_mul_f32_dpp v42, v16, v26 row_newbcast:14 row_mask:0xf bank_mask:0xf
    v_mul_f32_dpp v43, v16, v27 row_newbcast:15 row_mask:0xf bank_mask:0xf
    v_cvt_pk_bf16_f32 v68, v36, v37
    v_cvt_pk_bf16_f32 v69, v38, v39
    v_cvt_pk_bf16_f32 v70, v40, v41
    v_cvt_pk_bf16_f32 v71, v42, v43
    v_mul_f32_dpp v20, v16, v20 row_newbcast:0 row_mask:0xa bank_mask:0xf
    v_mul_f32_dpp v21, v16, v21 row_newbcast:1 row_mask:0xa bank_mask:0xf
    v_mul_f32_dpp v22, v16, v22 row_newbcast:2 row_mask:0xa bank_mask:0xf
    v_mul_f32_dpp v23, v16, v23 row_newbcast:3 row_mask:0xa bank_mask:0xf
    v_mul_f32_dpp v24, v16, v24 row_newbcast:4 row_mask:0xa bank_mask:0xf
    v_mul_f32_dpp v25, v16, v25 row_newbcast:5 row_mask:0xa bank_mask:0xf
    v_mul_f32_dpp v26, v16, v26 row_newbcast:6 row_mask:0xa bank_mask:0xf
    v_mul_f32_dpp v27, v16, v27 row_newbcast:7 row_mask:0xa bank_mask:0xf
    v_cvt_pk_bf16_f32 v64, v20, v21
    v_cvt_pk_bf16_f32 v65, v22, v23
    v_cvt_pk_bf16_f32 v66, v24, v25
    v_cvt_pk_bf16_f32 v67, v26, v27
    v_lshlrev_b32 v28, 16, v4
    v_and_b32 v29, 0xffff0000, v4
    v_lshlrev_b32 v30, 16, v5
    v_and_b32 v31, 0xffff0000, v5
    v_lshlrev_b32 v32, 16, v6
    v_and_b32 v33, 0xffff0000, v6
    v_lshlrev_b32 v34, 16, v7
    v_and_b32 v35, 0xffff0000, v7
    v_mul_f32_dpp v36, v17, v28 row_newbcast:8 row_mask:0xf bank_mask:0xf
    v_mul_f32_dpp v37, v17, v29 row_newbcast:9 row_mask:0xf bank_mask:0xf
    v_mul_f32_dpp v38, v17, v30 row_newbcast:10 row_mask:0xf bank_mask:0xf
    v_mul_f32_dpp v39, v17, v31 row_newbcast:11 row_mask:0xf bank_mask:0xf
    v_mul_f32_dpp v40, v17, v32 row_newbcast:12 row_mask:0xf bank_mask:0xf
    v_mul_f32_dpp v41, v17, v33 row_newbcast:13 row_mask:0xf bank_mask:0xf
    v_mul_f32_dpp v42, v17, v34 row_newbcast:14 row_mask:0xf bank_mask:0xf
    v_mul_f32_dpp v43, v17, v35 row_newbcast:15 row_mask:0xf bank_mask:0xf
    v_cvt_pk_bf16_f32 v76, v36, v37
    v_cvt_pk_bf16_f32 v77, v38, v39
    v_cvt_pk_bf16_f32 v78, v40, v41
    v_cvt_pk_bf16_f32 v79, v42, v43
    v_mul_f32_dpp v28, v17, v28 row_newbcast:0 row_mask:0xa bank_mask:0xf
    v_mul_f32_dpp v29, v17, v29 row_newbcast:1 row_mask:0xa bank_mask:0xf
    v_mul_f32_dpp v30, v17, v30 row_newbcast:2 row_mask:0xa bank_mask:0xf
    v_mul_f32_dpp v31, v17, v31 row_newbcast:3 row_mask:0xa bank_mask:0xf
    v_mul_f32_dpp v32, v17, v32 row_newbcast:4 row_mask:0xa bank_mask:0xf
    v_mul_f32_dpp v33, v17, v33 row_newbcast:5 row_mask:0xa bank_mask:0xf
    v_mul_f32_dpp v34, v17, v34 row_newbcast:6 row_mask:0xa bank_mask:0xf
    v_mul_f32_dpp v35, v17, v35 row_newbcast:7 row_mask:0xa bank_mask:0xf
    v_cvt_pk_bf16_f32 v72, v28, v29
    v_cvt_pk_bf16_f32 v73, v30, v31
    v_cvt_pk_bf16_f32 v74, v32, v33
    v_cvt_pk_bf16_f32 v75, v34, v35
    s_waitcnt lgkmcnt(0)
    v_lshlrev_b32 v20, 16, v8
    v_and_b32 v21, 0xffff0000, v8
    v_lshlrev_b32 v22, 16, v9
    v_and_b32 v23, 0xffff0000, v9
    v_mul_f32_dpp v36, v18, v20 row_newbcast:8 row_mask:0xf bank_mask:0xf
    v_mul_f32_dpp v37, v18, v21 row_newbcast:9 row_mask:0xf bank_mask:0xf
    v_mul_f32_dpp v38, v18, v22 row_newbcast:10 row_mask:0xf bank_mask:0xf
    v_mul_f32_dpp v39, v18, v23 row_newbcast:11 row_mask:0xf bank_mask:0xf
    v_cvt_pk_bf16_f32 v84, v36, v37
    v_cvt_pk_bf16_f32 v85, v38, v39
    v_mul_f32_dpp v20, v18, v20 row_newbcast:0 row_mask:0xa bank_mask:0xf
    v_mul_f32_dpp v21, v18, v21 row_newbcast:1 row_mask:0xa bank_mask:0xf
    v_mul_f32_dpp v22, v18, v22 row_newbcast:2 row_mask:0xa bank_mask:0xf
    v_mul_f32_dpp v23, v18, v23 row_newbcast:3 row_mask:0xa bank_mask:0xf
    v_cvt_pk_bf16_f32 v80, v20, v21
    v_cvt_pk_bf16_f32 v81, v22, v23
    s_waitcnt vmcnt(4)
    v_mfma_f32_32x32x16_bf16 v[0:15], v[64:67], v[176:179], 0
    ds_read_b64_tr_b16 v[184:185], v246 offset:2048
    ds_read_b64_tr_b16 v[186:187], v246 offset:3072
    ds_read_b64_tr_b16 v[188:189], v247 offset:2048
    ds_read_b64_tr_b16 v[190:191], v247 offset:3072
    s_mov_b32 m0, s68
    v_mfma_f32_32x32x16_bf16 v[16:31], v[68:71], v[176:179], 0
    buffer_load_dwordx4 v224, s[4:7], s41 offen sc1 lds
    buffer_load_dwordx4 v225, s[72:75], s41 offen offset:1024 sc1 lds
    v_permlane32_swap_b32 v242, v236
    v_permlane32_swap_b32 v243, v237
    v_mov_b32 v254, 163296
    v_mfma_f32_32x32x16_bf16 v[32:47], v[64:67], v[180:183], 0
    v_permlane32_swap_b32 v244, v238
    v_permlane32_swap_b32 v245, v239
    v_permlane32_swap_b32 v240, v241
    v_add_f32 v242, v242, v236
    v_mfma_f32_32x32x16_bf16 v[48:63], v[68:71], v[180:183], 0
    v_add_f32 v243, v243, v237
    v_add_f32 v244, v244, v238
    v_add_f32 v245, v245, v239
    v_add_f32 v240, -v240, -v241
    v_sub_u32 v241, v230, v231
    v_cvt_pk_bf16_f32 v242, v242, v243
    v_mov_b32 v255, 1
    v_lshl_add_u32 v233, v252, 1, s53
    s_mov_b64 exec, 1
    ds_add_rtn_u32 v232, v254, v255
    s_mov_b64 exec, -1
    ds_read_b32 v233, v233
    s_waitcnt vmcnt(4) lgkmcnt(2)
    v_mfma_f32_32x32x16_bf16 v[0:15], v[72:75], v[184:187], v[0:15]
    ds_read_b64_tr_b16 v[176:177], v246 offset:4096
    ds_read_b64_tr_b16 v[180:181], v247 offset:4096
    v_cvt_pk_bf16_f32 v244, v244, v245
    v_cvt_pk_bf16_f32 v240, v240, v240
    ds_write_b32 v230, v242 offset:768
    ds_write_b32 v230, v244 offset:1024
    s_mov_b32 m0, s69
    v_mfma_f32_32x32x16_bf16 v[16:31], v[76:79], v[184:187], v[16:31]
    buffer_load_dwordx4 v226, s[4:7], s41 offen sc1 lds
    ds_write_b16 v241, v240 offset:1280
    s_waitcnt lgkmcnt(5)
    v_readfirstlane_b32 s58, v232
    v_mfma_f32_32x32x16_bf16 v[32:47], v[72:75], v[188:191], v[32:47]
    s_cmp_lt_u32 s58, s22
    s_cbranch_scc0 K2_nul_54
    s_and_b32 s59, s58, 7
    s_lshr_b32 s60, s58, 3
K2_chk_56:
    v_readlane_b32 s61, v233, s59
    s_nop 0
    s_cmp_gt_u32 s61, s60
    s_cbranch_scc0 K2_spin_55
K2_back_57:
    v_mfma_f32_32x32x16_bf16 v[48:63], v[76:79], v[188:191], v[48:63]
    v_readlane_b32 s3, v253, s58
    s_lshl_b32 s44, s34, 7
    s_and_b32 s48, s3, 0x3ffff
    s_bfe_u32 s33, s3, 0x30013
    s_mov_b32 s35, s48
    s_mov_b32 s45, s44
    s_waitcnt vmcnt(3) lgkmcnt(3)
    v_mfma_f32_32x32x8_bf16 v[0:15], v[80:81], v[176:177], v[0:15]
    ds_read_b64_tr_b16 v[184:185], v246 offset:6144
    ds_read_b64_tr_b16 v[186:187], v246 offset:7168
    ds_read_b64_tr_b16 v[188:189], v247 offset:6144
    ds_read_b64_tr_b16 v[190:191], v247 offset:7168
    s_add_u32 s47, s44, 256
    s_add_u32 s49, s48, 128
    s_mov_b32 m0, s70
    v_mfma_f32_32x32x8_bf16 v[16:31], v[84:85], v[176:177], v[16:31]
    buffer_load_dwordx4 v222, s[4:7], s42 offen sc1 lds
    buffer_load_dwordx4 v223, s[72:75], s42 offen offset:1024 sc1 lds
    s_add_u32 s60, s48, 256
    s_cmp_eq_u32 s33, 3
    s_cselect_b32 s46, s44, s47
    s_cselect_b32 s50, s60, s48
    s_cselect_b32 s51, s48, s49
    v_mfma_f32_32x32x8_bf16 v[32:47], v[80:81], v[180:181], v[32:47]
    s_sub_u32 s60, s33, 2
    s_cmp_lt_u32 s60, 2
    s_cbranch_scc0 K2_rare_58
K2_back_59:
    v_mul_f32 v234, v0, v96
    v_mul_f32 v236, v8, v128
    v_fmac_f32 v234, v1, v97
    v_fmac_f32 v236, v9, v129
    v_mfma_f32_32x32x8_bf16 v[48:63], v[84:85], v[180:181], v[48:63]
    s_setprio 0
    v_fmac_f32 v234, v2, v98
    v_fmac_f32 v236, v10, v130
    v_fmac_f32 v234, v3, v99
    v_fmac_f32 v236, v11, v131
    v_fmac_f32 v234, v4, v100
    v_fmac_f32 v236, v12, v132
    v_fmac_f32 v234, v5, v101
    v_fmac_f32 v236, v13, v133
    v_fmac_f32 v234, v6, v102
    v_fmac_f32 v236, v14, v134
    v_fmac_f32 v234, v7, v103
    v_fmac_f32 v236, v15, v135
    v_mul_f32 v238, v16, v128
    v_mul_f32 v240, v24, v128
    v_fmac_f32 v238, v17, v129
    v_fmac_f32 v240, v25, v129
    v_fmac_f32 v238, v18, v130
    v_fmac_f32 v240, v26, v130
    v_fmac_f32 v238, v19, v131
    v_fmac_f32 v240, v27, v131
    v_fmac_f32 v238, v20, v132
    v_fmac_f32 v240, v28, v132
    v_fmac_f32 v238, v21, v133
    v_fmac_f32 v240, v29, v133
    v_fmac_f32 v238, v22, v134
    v_fmac_f32 v240, v30, v134
    v_fmac_f32 v238, v23, v135
    v_fmac_f32 v240, v31, v135
    v_mul_f32 v235, v32, v104
    v_mul_f32 v237, v40, v136
    v_fmac_f32 v235, v33, v105
    v_fmac_f32 v237, v41, v137
    v_fmac_f32 v235, v34, v106
    v_fmac_f32 v237, v42, v138
    v_fmac_f32 v235, v35, v107
    v_fmac_f32 v237, v43, v139
    v_fmac_f32 v235, v36, v108
    v_fmac_f32 v237, v44, v140
    v_fmac_f32 v235, v37, v109
    v_fmac_f32 v237, v45, v141
    v_fmac_f32 v235, v38, v110
    v_fmac_f32 v237, v46, v142
    v_fmac_f32 v235, v39, v111
    v_fmac_f32 v237, v47, v143
    v_mul_f32 v239, v48, v136
    v_mul_f32 v241, v56, v136
    s_setprio 1
    s_waitcnt vmcnt(3) lgkmcnt(0)
    v_mfma_f32_32x32x16_bf16 v[0:15], v[64:67], v[184:187], 0
    ds_read_b64_tr_b16 v[176:177], v246 offset:0
    ds_read_b64_tr_b16 v[178:179], v246 offset:1024
    ds_read_b64_tr_b16 v[180:181], v247 offset:0
    ds_read_b64_tr_b16 v[182:183], v247 offset:1024
    v_fmac_f32 v239, v49, v137
    v_fmac_f32 v241, v57, v137
    s_mov_b32 m0, s71
    v_mfma_f32_32x32x16_bf16 v[16:31], v[68:71], v[184:187], 0
    buffer_load_dwordx4 v224, s[4:7], s42 offen sc1 lds
    buffer_load_dwordx4 v225, s[72:75], s42 offen offset:1024 sc1 lds
    v_fmac_f32 v239, v50, v138
    v_fmac_f32 v241, v58, v138
    v_fmac_f32 v239, v51, v139
    v_fmac_f32 v241, v59, v139
    v_fmac_f32 v239, v52, v140
    v_mfma_f32_32x32x16_bf16 v[32:47], v[64:67], v[188:191], 0
    v_fmac_f32 v241, v60, v140
    v_fmac_f32 v239, v53, v141
    v_fmac_f32 v241, v61, v141
    v_fmac_f32 v239, v54, v142
    v_fmac_f32 v241, v62, v142
    v_fmac_f32 v239, v55, v143
    v_fmac_f32 v241, v63, v143
    v_mfma_f32_32x32x16_bf16 v[48:63], v[68:71], v[188:191], 0
    v_permlane32_swap_b32 v234, v236
    v_permlane32_swap_b32 v235, v237
    v_permlane32_swap_b32 v240, v238
    s_waitcnt vmcnt(4) lgkmcnt(0)
    v_mfma_f32_32x32x16_bf16 v[0:15], v[72:75], v[176:179], v[0:15]
    ds_read_b64_tr_b16 v[184:185], v246 offset:2048
    ds_read_b64_tr_b16 v[188:189], v247 offset:2048
    v_permlane32_swap_b32 v241, v239
    v_lshl_add_u32 v230, v252, 1, s31
    v_add_f32 v234, v234, v236
    s_mov_b32 m0, s68
    v_mfma_f32_32x32x16_bf16 v[16:31], v[76:79], v[176:179], v[16:31]
    buffer_load_dwordx4 v226, s[4:7], s42 offen sc1 lds
    v_add_f32 v235, v235, v237
    v_add_f32 v240, v240, v238
    v_add_f32 v241, v241, v239
    v_cvt_pk_bf16_f32 v234, v234, v235
    v_cvt_pk_bf16_f32 v240, v240, v241
    ds_write_b32 v230, v234 offset:0
    v_mfma_f32_32x32x16_bf16 v[32:47], v[72:75], v[180:183], v[32:47]
    ds_write_b32 v230, v240 offset:256
    v_mfma_f32_32x32x16_bf16 v[48:63], v[76:79], v[180:183], v[48:63]
    s_waitcnt vmcnt(3) lgkmcnt(2)
    v_mfma_f32_32x32x8_bf16 v[0:15], v[80:81], v[184:185], v[0:15]
    ds_read_b64_tr_b16 v[176:177], v246 offset:4096
    ds_read_b64_tr_b16 v[178:179], v246 offset:5120
    ds_read_b64_tr_b16 v[180:181], v247 offset:4096
    ds_read_b64_tr_b16 v[182:183], v247 offset:5120
    s_mov_b32 m0, s69
    v_mfma_f32_32x32x8_bf16 v[16:31], v[84:85], v[184:185], v[16:31]
    buffer_load_dwordx4 v222, s[4:7], s43 offen sc1 lds
    buffer_load_dwordx4 v223, s[72:75], s43 offen offset:1024 sc1 lds
    v_mfma_f32_32x32x8_bf16 v[32:47], v[80:81], v[188:189], v[32:47]
    s_nop 2
    v_mul_f32 v234, v0, v144
    v_mul_f32 v236, v8, v112
    v_fmac_f32 v234, v1, v145
    v_fmac_f32 v236, v9, v113
    v_fmac_f32 v234, v2, v146
    v_fmac_f32 v236, v10, v114
    v_fmac_f32 v234, v3, v147
    v_mfma_f32_32x32x8_bf16 v[48:63], v[84:85], v[188:189], v[48:63]
    s_setprio 0
    v_fmac_f32 v236, v11, v115
    v_fmac_f32 v234, v4, v148
    v_fmac_f32 v236, v12, v116
    v_fmac_f32 v234, v5, v149
    v_fmac_f32 v236, v13, v117
    v_fmac_f32 v234, v6, v150
    v_fmac_f32 v236, v14, v118
    v_fmac_f32 v234, v7, v151
    v_fmac_f32 v236, v15, v119
    v_mul_f32 v238, v16, v160
    v_mul_f32 v240, v24, v160
    v_fmac_f32 v238, v17, v161
    v_fmac_f32 v240, v25, v161
    v_fmac_f32 v238, v18, v162
    v_fmac_f32 v240, v26, v162
    v_fmac_f32 v238, v19, v163
    v_fmac_f32 v240, v27, v163
    v_fmac_f32 v238, v20, v164
    v_fmac_f32 v240, v28, v164
    v_fmac_f32 v238, v21, v165
    v_fmac_f32 v240, v29, v165
    v_fmac_f32 v238, v22, v166
    v_fmac_f32 v240, v30, v166
    v_fmac_f32 v238, v23, v167
    v_fmac_f32 v240, v31, v167
    v_mul_f32 v235, v32, v152
    v_mul_f32 v237, v40, v120
    v_fmac_f32 v235, v33, v153
    v_fmac_f32 v237, v41, v121
    v_fmac_f32 v235, v34, v154
    v_fmac_f32 v237, v42, v122
    v_fmac_f32 v235, v35, v155
    v_fmac_f32 v237, v43, v123
    v_fmac_f32 v235, v36, v156
    v_fmac_f32 v237, v44, v124
    v_fmac_f32 v235, v37, v157
    v_fmac_f32 v237, v45, v125
    v_fmac_f32 v235, v38, v158
    v_fmac_f32 v237, v46, v126
    v_fmac_f32 v235, v39, v159
    v_fmac_f32 v237, v47, v127
    v_mul_f32 v239, v48, v168
    v_mul_f32 v241, v56, v168
    v_fmac_f32 v239, v49, v169
    v_fmac_f32 v241, v57, v169
    s_setprio 1
    s_waitcnt vmcnt(3) lgkmcnt(0)
    v_mfma_f32_32x32x16_bf16 v[0:15], v[64:67], v[176:179], 0
    ds_read_b64_tr_b16 v[184:185], v246 offset:6144
    ds_read_b64_tr_b16 v[186:187], v246 offset:7168
    ds_read_b64_tr_b16 v[188:189], v247 offset:6144
    ds_read_b64_tr_b16 v[190:191], v247 offset:7168
    v_fmac_f32 v239, v50, v170
    v_fmac_f32 v241, v58, v170
    s_mov_b32 m0, s70
    v_mfma_f32_32x32x16_bf16 v[16:31], v[68:71], v[176:179], 0
    buffer_load_dwordx4 v224, s[4:7], s43 offen sc1 lds
    buffer_load_dwordx4 v225, s[72:75], s43 offen offset:1024 sc1 lds
    v_fmac_f32 v239, v51, v171
    v_fmac_f32 v241, v59, v171
    v_fmac_f32 v239, v52, v172
    v_fmac_f32 v241, v60, v172
    v_fmac_f32 v239, v53, v173
    v_mfma_f32_32x32x16_bf16 v[32:47], v[64:67], v[180:183], 0
    v_add_u32 v222, s48, v251
    ds_read2_b32 v[222:223], v222 offset0:1 offset1:3
    v_fmac_f32 v241, v61, v173
    v_fmac_f32 v239, v54, v174
    v_fmac_f32 v241, v62, v174
    v_fmac_f32 v239, v55, v175
    v_fmac_f32 v241, v63, v175
    v_mfma_f32_32x32x16_bf16 v[48:63], v[68:71], v[180:183], 0
    s_waitcnt vmcnt(4) lgkmcnt(1)
    v_mfma_f32_32x32x16_bf16 v[0:15], v[72:75], v[184:187], v[0:15]
    ds_read_b64_tr_b16 v[176:177], v246 offset:0
    ds_read_b64_tr_b16 v[180:181], v247 offset:0
    s_mov_b32 m0, s71
    v_mfma_f32_32x32x16_bf16 v[16:31], v[76:79], v[184:187], v[16:31]
    buffer_load_dwordx4 v226, s[4:7], s43 offen sc1 lds
    s_waitcnt lgkmcnt(2)
    v_mad_u32_u16 v222, v222, s39, v248 op_sel:[1,0,0,0]
    v_mad_u32_u16 v223, v223, s39, v248 op_sel:[1,0,0,0]
    v_mfma_f32_32x32x16_bf16 v[32:47], v[72:75], v[188:191], v[32:47]
    v_add_u32 v224, s49, v251
    ds_read2_b32 v[224:225], v224 offset0:1 offset1:3
    v_mfma_f32_32x32x16_bf16 v[48:63], v[76:79], v[188:191], v[48:63]
    s_waitcnt vmcnt(3) lgkmcnt(1)
    v_mfma_f32_32x32x8_bf16 v[0:15], v[80:81], v[176:177], v[0:15]
    ds_read_b64_tr_b16 v[184:185], v246 offset:2048
    ds_read_b64_tr_b16 v[186:187], v246 offset:3072
    ds_read_b64_tr_b16 v[188:189], v247 offset:2048
    ds_read_b64_tr_b16 v[190:191], v247 offset:3072
    s_mov_b32 m0, s68
    v_mfma_f32_32x32x8_bf16 v[16:31], v[84:85], v[176:177], v[16:31]
    buffer_load_dwordx4 v222, s[4:7], s44 offen sc1 lds
    buffer_load_dwordx4 v223, s[72:75], s44 offen offset:1024 sc1 lds
    s_waitcnt lgkmcnt(4)
    v_mad_u32_u16 v224, v224, s39, v248 op_sel:[1,0,0,0]
    v_mad_u32_u16 v225, v225, s39, v248 op_sel:[1,0,0,0]
    v_mfma_f32_32x32x8_bf16 v[32:47], v[80:81], v[180:181], v[32:47]
    v_add_u32 v226, s50, v251
    ds_read2_b32 v[226:227], v226 offset0:1 offset1:3
    v_mul_f32 v242, v0, v144
    v_fma_f32 v238, v8, v160, -v238
    v_fmac_f32 v242, v1, v145
    v_fmac_f32 v238, v9, v161
    v_fmac_f32 v242, v2, v146
    v_mfma_f32_32x32x8_bf16 v[48:63], v[84:85], v[180:181], v[48:63]
    s_setprio 0
    v_fmac_f32 v238, v10, v162
    v_fmac_f32 v242, v3, v147
    v_fmac_f32 v238, v11, v163
    v_fmac_f32 v242, v4, v148
    v_fmac_f32 v238, v12, v164
    v_fmac_f32 v242, v5, v149
    v_fmac_f32 v238, v13, v165
    v_fmac_f32 v242, v6, v150
    v_fmac_f32 v238, v14, v166
    v_fmac_f32 v242, v7, v151
    v_fmac_f32 v238, v15, v167
    v_fmac_f32 v236, v16, v112
    v_mul_f32 v244, v24, v160
    v_fmac_f32 v236, v17, v113
    v_fmac_f32 v244, v25, v161
    v_fmac_f32 v236, v18, v114
    v_fmac_f32 v244, v26, v162
    v_fmac_f32 v236, v19, v115
    v_fmac_f32 v244, v27, v163
    v_fmac_f32 v236, v20, v116
    v_fmac_f32 v244, v28, v164
    v_fmac_f32 v236, v21, v117
    v_fmac_f32 v244, v29, v165
    v_fmac_f32 v236, v22, v118
    v_fmac_f32 v244, v30, v166
    v_fmac_f32 v236, v23, v119
    v_fmac_f32 v244, v31, v167
    v_mul_f32 v243, v32, v152
    v_fma_f32 v239, v40, v168, -v239
    v_fmac_f32 v243, v33, v153
    v_fmac_f32 v239, v41, v169
    v_fmac_f32 v243, v34, v154
    v_fmac_f32 v239, v42, v170
    v_fmac_f32 v243, v35, v155
    v_fmac_f32 v239, v43, v171
    v_fmac_f32 v243, v36, v156
    v_fmac_f32 v239, v44, v172
    v_fmac_f32 v243, v37, v157
    v_fmac_f32 v239, v45, v173
    v_fmac_f32 v243, v38, v158
    v_fmac_f32 v239, v46, v174
    v_fmac_f32 v243, v39, v159
    v_fmac_f32 v239, v47, v175
    v_fmac_f32 v237, v48, v120
    v_mul_f32 v245, v56, v168
    v_fmac_f32 v237, v49, v121
    v_fmac_f32 v245, v57, v169
    v_fmac_f32 v237, v50, v122
    v_fmac_f32 v245, v58, v170
    v_fmac_f32 v237, v51, v123
    s_setprio 1
    s_waitcnt vmcnt(3) lgkmcnt(1)
    v_mfma_f32_32x32x16_bf16 v[0:15], v[64:67], v[184:187], 0
    ds_read_b64_tr_b16 v[176:177], v246 offset:4096
    ds_read_b64_tr_b16 v[178:179], v246 offset:5120
    ds_read_b64_tr_b16 v[180:181], v247 offset:4096
    ds_read_b64_tr_b16 v[182:183], v247 offset:5120
    v_fmac_f32 v245, v59, v171
    v_fmac_f32 v237, v52, v124
    s_mov_b32 m0, s69
    v_mfma_f32_32x32x16_bf16 v[16:31], v[68:71], v[184:187], 0
    buffer_load_dwordx4 v224, s[4:7], s45 offen sc1 lds
    buffer_load_dwordx4 v225, s[72:75], s45 offen offset:1024 sc1 lds
    s_waitcnt lgkmcnt(4)
    v_mad_u32_u16 v226, v226, s39, v248 op_sel:[1,0,0,0]
    v_mad_u32_u16 v227, v227, s39, v248 op_sel:[1,0,0,0]
    v_fmac_f32 v245, v60, v172
    v_fmac_f32 v237, v53, v125
    v_mfma_f32_32x32x16_bf16 v[32:47], v[64:67], v[188:191], 0
    v_add_u32 v228, s51, v251
    ds_read2_b32 v[228:229], v228 offset0:1 offset1:3
    v_fmac_f32 v245, v61, v173
    v_fmac_f32 v237, v54, v126
    v_fmac_f32 v245, v62, v174
    v_fmac_f32 v237, v55, v127
    v_fmac_f32 v245, v63, v175
    v_mfma_f32_32x32x16_bf16 v[48:63], v[68:71], v[188:191], 0
    v_permlane32_swap_b32 v242, v234
    v_permlane32_swap_b32 v243, v235
    v_add_f32 v242, v242, v234
    v_add_f32 v243, v243, v235
    s_waitcnt vmcnt(4) lgkmcnt(1)
    v_mfma_f32_32x32x16_bf16 v[0:15], v[72:75], v[176:179], v[0:15]
    ds_read_b64_tr_b16 v[184:185], v246 offset:6144
    ds_read_b64_tr_b16 v[188:189], v247 offset:6144
    v_cvt_pk_bf16_f32 v242, v242, v243
    ds_write_b32 v230, v242 offset:512
    s_mov_b32 s32, s31
    s_mov_b32 s31, s35
    s_mov_b32 m0, s70
    v_mfma_f32_32x32x16_bf16 v[16:31], v[76:79], v[176:179], v[16:31]
    buffer_load_dwordx4 v226, s[4:7], s46 offen sc1 lds
    buffer_load_dwordx4 v227, s[72:75], s46 offen offset:1024 sc1 lds
    s_waitcnt lgkmcnt(3)
    v_mad_u32_u16 v228, v228, s39, v248 op_sel:[1,0,0,0]
    v_mad_u32_u16 v229, v229, s39, v248 op_sel:[1,0,0,0]
    s_sub_u32 s26, s48, s29
    s_mov_b32 s29, s48
    v_mfma_f32_32x32x16_bf16 v[32:47], v[72:75], v[180:183], v[32:47]
    s_mov_b32 s30, s3
    s_bfe_u32 s56, s3, 0x40012
    s_cmp_lg_u32 s36, 0
    s_cselect_b32 s56, s56, 0
    v_mfma_f32_32x32x16_bf16 v[48:63], v[76:79], v[180:183], v[48:63]
    s_waitcnt vmcnt(4) lgkmcnt(1)
    v_mfma_f32_32x32x8_bf16 v[0:15], v[80:81], v[184:185], v[0:15]
    ds_read_b64_tr_b16 v[176:177], v246 offset:0
    ds_read_b64_tr_b16 v[178:179], v246 offset:1024
    ds_read_b64_tr_b16 v[180:181], v247 offset:0
    ds_read_b64_tr_b16 v[182:183], v247 offset:1024
    s_mov_b32 m0, s71
    v_mfma_f32_32x32x8_bf16 v[16:31], v[84:85], v[184:185], v[16:31]
    buffer_load_dwordx4 v228, s[4:7], s47 offen sc1 lds
    buffer_load_dwordx4 v229, s[72:75], s47 offen offset:1024 sc1 lds
    v_mfma_f32_32x32x8_bf16 v[32:47], v[80:81], v[188:189], v[32:47]
    s_nop 2
    v_mul_f32 v242, v0, v144
    v_fma_f32 v240, v8, v160, -v240
    v_fmac_f32 v242, v1, v145
    v_fmac_f32 v240, v9, v161
    v_fmac_f32 v242, v2, v146
    v_fmac_f32 v240, v10, v162
    v_fmac_f32 v242, v3, v147
    v_mfma_f32_32x32x8_bf16 v[48:63], v[84:85], v[188:189], v[48:63]
    s_setprio 0
    v_fmac_f32 v240, v11, v163
    v_fmac_f32 v242, v4, v148
    v_fmac_f32 v240, v12, v164
    v_fmac_f32 v242, v5, v149
    v_fmac_f32 v240, v13, v165
    v_fmac_f32 v242, v6, v150
    v_fmac_f32 v240, v14, v166
    v_fmac_f32 v242, v7, v151
    v_fmac_f32 v240, v15, v167
    v_add_u32 v249, s26, v249
    v_add_u32 v250, s26, v250
    v_fma_f32 v244, v16, v160, -v244
    v_fmac_f32 v236, v24, v112
    v_fmac_f32 v244, v17, v161
    v_fmac_f32 v236, v25, v113
    v_fmac_f32 v244, v18, v162
    v_fmac_f32 v236, v26, v114
    v_fmac_f32 v244, v19, v163
    v_fmac_f32 v236, v27, v115
    v_fmac_f32 v244, v20, v164
    v_fmac_f32 v236, v28, v116
    v_fmac_f32 v244, v21, v165
    v_fmac_f32 v236, v29, v117
    v_fmac_f32 v244, v22, v166
    v_fmac_f32 v236, v30, v118
    v_fmac_f32 v244, v23, v167
    v_fmac_f32 v236, v31, v119
    ds_read_b64_tr_b16 v[0:1], v249 offset:0
    ds_read_b64_tr_b16 v[2:3], v249 offset:32
    ds_read_u16_d16_hi v16, v250 offset:0
    v_mul_f32 v243, v32, v152
    v_fma_f32 v241, v40, v168, -v241
    v_fmac_f32 v243, v33, v153
    v_fmac_f32 v241, v41, v169
    v_fmac_f32 v243, v34, v154
    v_fmac_f32 v241, v42, v170
    v_fmac_f32 v243, v35, v155
    v_fmac_f32 v241, v43, v171
    v_fmac_f32 v243, v36, v156
    v_fmac_f32 v241, v44, v172
    v_fmac_f32 v243, v37, v157
    v_fmac_f32 v241, v45, v173
    v_fmac_f32 v243, v38, v158
    v_fmac_f32 v241, v46, v174
    v_fmac_f32 v243, v39, v159
    v_fmac_f32 v241, v47, v175
    ds_read_b64_tr_b16 v[4:5], v249 offset:512
    ds_read_b64_tr_b16 v[6:7], v249 offset:544
    ds_read_u16_d16_hi v17, v250 offset:128
    v_fma_f32 v245, v48, v168, -v245
    v_fmac_f32 v237, v56, v120
    v_fmac_f32 v245, v49, v169
    v_fmac_f32 v237, v57, v121
    v_fmac_f32 v245, v50, v170
    v_fmac_f32 v237, v58, v122
    v_fmac_f32 v245, v51, v171
    v_fmac_f32 v237, v59, v123
    v_fmac_f32 v245, v52, v172
    v_fmac_f32 v237, v60, v124
    v_fmac_f32 v245, v53, v173
    v_fmac_f32 v237, v61, v125
    v_fmac_f32 v245, v54, v174
    v_fmac_f32 v237, v62, v126
    v_fmac_f32 v245, v55, v175
    v_fmac_f32 v237, v63, v127
    s_cmp_eq_u32 s56, 5
    s_cbranch_scc1 K2_U21
    s_cmp_eq_u32 s56, 6
    s_cbranch_scc1 K2_U3h1
    s_branch K2_DSP1
K2_U31:
    s_setprio 1
    ds_read_b64_tr_b16 v[8:9], v249 offset:1024
    ds_read_b64_tr_b16 v[10:11], v249 offset:1056
    ds_read_u16_d16_hi v18, v250 offset:256
    s_waitcnt lgkmcnt(3)
    v_lshlrev_b32 v20, 16, v0
    v_and_b32 v21, 0xffff0000, v0
    v_lshlrev_b32 v22, 16, v1
    v_and_b32 v23, 0xffff0000, v1
    v_lshlrev_b32 v24, 16, v2
    v_and_b32 v25, 0xffff0000, v2
    v_lshlrev_b32 v26, 16, v3
    v_and_b32 v27, 0xffff0000, v3
    v_mul_f32_dpp v36, v16, v20 row_newbcast:8 row_mask:0xf bank_mask:0xf
    v_mul_f32_dpp v37, v16, v21 row_newbcast:9 row_mask:0xf bank_mask:0xf
    v_mul_f32_dpp v38, v16, v22 row_newbcast:10 row_mask:0xf bank_mask:0xf
    v_mul_f32_dpp v39, v16, v23 row_newbcast:11 row_mask:0xf bank_mask:0xf
    v_mul_f32_dpp v40, v16, v24 row_newbcast:12 row_mask:0xf bank_mask:0xf
    v_mul_f32_dpp v41, v16, v25 row_newbcast:13 row_mask:0xf bank_mask:0xf
    v_mul_f32_dpp v42, v16, v26 row_newbcast:14 row_mask:0xf bank_mask:0xf
    v_mul_f32_dpp v43, v16, v27 row_newbcast:15 row_mask:0xf bank_mask:0xf
    v_cvt_pk_bf16_f32 v68, v36, v37
    v_cvt_pk_bf16_f32 v69, v38, v39
    v_cvt_pk_bf16_f32 v70, v40, v41
    v_cvt_pk_bf16_f32 v71, v42, v43
    v_mul_f32_dpp v20, v16, v20 row_newbcast:0 row_mask:0xa bank_mask:0xf
    v_mul_f32_dpp v21, v16, v21 row_newbcast:1 row_mask:0xa bank_mask:0xf
    v_mul_f32_dpp v22, v16, v22 row_newbcast:2 row_mask:0xa bank_mask:0xf
    v_mul_f32_dpp v23, v16, v23 row_newbcast:3 row_mask:0xa bank_mask:0xf
    v_mul_f32_dpp v24, v16, v24 row_newbcast:4 row_mask:0xa bank_mask:0xf
    v_mul_f32_dpp v25, v16, v25 row_newbcast:5 row_mask:0xa bank_mask:0xf
    v_mul_f32_dpp v26, v16, v26 row_newbcast:6 row_mask:0xa bank_mask:0xf
    v_mul_f32_dpp v27, v16, v27 row_newbcast:7 row_mask:0xa bank_mask:0xf
    v_cvt_pk_bf16_f32 v64, v20, v21
    v_cvt_pk_bf16_f32 v65, v22, v23
    v_cvt_pk_bf16_f32 v66, v24, v25
    v_cvt_pk_bf16_f32 v67, v26, v27
    v_lshlrev_b32 v28, 16, v4
    v_and_b32 v29, 0xffff0000, v4
    v_lshlrev_b32 v30, 16, v5
    v_and_b32 v31, 0xffff0000, v5
    v_lshlrev_b32 v32, 16, v6
    v_and_b32 v33, 0xffff0000, v6
    v_lshlrev_b32 v34, 16, v7
    v_and_b32 v35, 0xffff0000, v7
    v_mul_f32_dpp v36, v17, v28 row_newbcast:8 row_mask:0xf bank_mask:0xf
    v_mul_f32_dpp v37, v17, v29 row_newbcast:9 row_mask:0xf bank_mask:0xf
    v_mul_f32_dpp v38, v17, v30 row_newbcast:10 row_mask:0xf bank_mask:0xf
    v_mul_f32_dpp v39, v17, v31 row_newbcast:11 row_mask:0xf bank_mask:0xf
    v_mul_f32_dpp v40, v17, v32 row_newbcast:12 row_mask:0xf bank_mask:0xf
    v_mul_f32_dpp v41, v17, v33 row_newbcast:13 row_mask:0xf bank_mask:0xf
    v_mul_f32_dpp v42, v17, v34 row_newbcast:14 row_mask:0xf bank_mask:0xf
    v_mul_f32_dpp v43, v17, v35 row_newbcast:15 row_mask:0xf bank_mask:0xf
    v_cvt_pk_bf16_f32 v76, v36, v37
    v_cvt_pk_bf16_f32 v77, v38, v39
    v_cvt_pk_bf16_f32 v78, v40, v41
    v_cvt_pk_bf16_f32 v79, v42, v43
    v_mul_f32_dpp v28, v17, v28 row_newbcast:0 row_mask:0xa bank_mask:0xf
    v_mul_f32_dpp v29, v17, v29 row_newbcast:1 row_mask:0xa bank_mask:0xf
    v_mul_f32_dpp v30, v17, v30 row_newbcast:2 row_mask:0xa bank_mask:0xf
    v_mul_f32_dpp v31, v17, v31 row_newbcast:3 row_mask:0xa bank_mask:0xf
    v_mul_f32_dpp v32, v17, v32 row_newbcast:4 row_mask:0xa bank_mask:0xf
    v_mul_f32_dpp v33, v17, v33 row_newbcast:5 row_mask:0xa bank_mask:0xf
    v_mul_f32_dpp v34, v17, v34 row_newbcast:6 row_mask:0xa bank_mask:0xf
    v_mul_f32_dpp v35, v17, v35 row_newbcast:7 row_mask:0xa bank_mask:0xf
    v_cvt_pk_bf16_f32 v72, v28, v29
    v_cvt_pk_bf16_f32 v73, v30, v31
    v_cvt_pk_bf16_f32 v74, v32, v33
    v_cvt_pk_bf16_f32 v75, v34, v35
    s_waitcnt lgkmcnt(0)
    v_lshlrev_b32 v20, 16, v8
    v_and_b32 v21, 0xffff0000, v8
    v_lshlrev_b32 v22, 16, v9
    v_and_b32 v23, 0xffff0000, v9
    v_lshlrev_b32 v24, 16, v10
    v_and_b32 v25, 0xffff0000, v10
    v_lshlrev_b32 v26, 16, v11
    v_and_b32 v27, 0xffff0000, v11
    v_mul_f32_dpp v36, v18, v20 row_newbcast:8 row_mask:0xf bank_mask:0xf
    v_mul_f32_dpp v37, v18, v21 row_newbcast:9 row_mask:0xf bank_mask:0xf
    v_mul_f32_dpp v38, v18, v22 row_newbcast:10 row_mask:0xf bank_mask:0xf
    v_mul_f32_dpp v39, v18, v23 row_newbcast:11 row_mask:0xf bank_mask:0xf
    v_mul_f32_dpp v40, v18, v24 row_newbcast:12 row_mask:0xf bank_mask:0xf
    v_mul_f32_dpp v41, v18, v25 row_newbcast:13 row_mask:0xf bank_mask:0xf
    v_mul_f32_dpp v42, v18, v26 row_newbcast:14 row_mask:0xf bank_mask:0xf
    v_mul_f32_dpp v43, v18, v27 row_newbcast:15 row_mask:0xf bank_mask:0xf
    v_cvt_pk_bf16_f32 v84, v36, v37
    v_cvt_pk_bf16_f32 v85, v38, v39
    v_cvt_pk_bf16_f32 v86, v40, v41
    v_cvt_pk_bf16_f32 v87, v42, v43
    v_mul_f32_dpp v20, v18, v20 row_newbcast:0 row_mask:0xa bank_mask:0xf
    v_mul_f32_dpp v21, v18, v21 row_newbcast:1 row_mask:0xa bank_mask:0xf
    v_mul_f32_dpp v22, v18, v22 row_newbcast:2 row_mask:0xa bank_mask:0xf
    v_mul_f32_dpp v23, v18, v23 row_newbcast:3 row_mask:0xa bank_mask:0xf
    v_mul_f32_dpp v24, v18, v24 row_newbcast:4 row_mask:0xa bank_mask:0xf
    v_mul_f32_dpp v25, v18, v25 row_newbcast:5 row_mask:0xa bank_mask:0xf
    v_mul_f32_dpp v26, v18, v26 row_newbcast:6 row_mask:0xa bank_mask:0xf
    v_mul_f32_dpp v27, v18, v27 row_newbcast:7 row_mask:0xa bank_mask:0xf
    v_cvt_pk_bf16_f32 v80, v20, v21
    v_cvt_pk_bf16_f32 v81, v22, v23
    v_cvt_pk_bf16_f32 v82, v24, v25
    v_cvt_pk_bf16_f32 v83, v26, v27
    s_waitcnt vmcnt(4)
    v_mfma_f32_32x32x16_bf16 v[0:15], v[64:67], v[176:179], 0
    ds_read_b64_tr_b16 v[184:185], v246 offset:2048
    ds_read_b64_tr_b16 v[186:187], v246 offset:3072
    ds_read_b64_tr_b16 v[188:189], v247 offset:2048
    ds_read_b64_tr_b16 v[190:191], v247 offset:3072
    s_mov_b32 m0, s68
    v_mfma_f32_32x32x16_bf16 v[16:31], v[68:71], v[176:179], 0
    buffer_load_dwordx4 v224, s[4:7], s41 offen sc1 lds
    buffer_load_dwordx4 v225, s[72:75], s41 offen offset:1024 sc1 lds
    v_permlane32_swap_b32 v242, v236
    v_permlane32_swap_b32 v243, v237
    v_mov_b32 v254, 163296
    v_mfma_f32_32x32x16_bf16 v[32:47], v[64:67], v[180:183], 0
    v_permlane32_swap_b32 v244, v238
    v_permlane32_swap_b32 v245, v239
    v_permlane32_swap_b32 v240, v241
    v_add_f32 v242, v242, v236
    v_mfma_f32_32x32x16_bf16 v[48:63], v[68:71], v[180:183], 0
    v_add_f32 v243, v243, v237
    v_add_f32 v244, v244, v238
    v_add_f32 v245, v245, v239
    v_add_f32 v240, -v240, -v241
    v_sub_u32 v241, v230, v231
    v_cvt_pk_bf16_f32 v242, v242, v243
    v_mov_b32 v255, 1
    v_lshl_add_u32 v233, v252, 1, s53
    s_mov_b64 exec, 1
    ds_add_rtn_u32 v232, v254, v255
    s_mov_b64 exec, -1
    ds_read_b32 v233, v233
    s_waitcnt vmcnt(4) lgkmcnt(2)
    v_mfma_f32_32x32x16_bf16 v[0:15], v[72:75], v[184:187], v[0:15]
    ds_read_b64_tr_b16 v[176:177], v246 offset:4096
    ds_read_b64_tr_b16 v[178:179], v246 offset:5120
    ds_read_b64_tr_b16 v[180:181], v247 offset:4096
    ds_read_b64_tr_b16 v[182:183], v247 offset:5120
    v_cvt_pk_bf16_f32 v244, v244, v245
    v_cvt_pk_bf16_f32 v240, v240, v240
    s_mov_b32 m0, s69
    v_mfma_f32_32x32x16_bf16 v[16:31], v[76:79], v[184:187], v[16:31]
    buffer_load_dwordx4 v226, s[4:7], s41 offen sc1 lds
    buffer_load_dwordx4 v227, s[72:75], s41 offen offset:1024 sc1 lds
    ds_write_b32 v230, v242 offset:768
    ds_write_b32 v230, v244 offset:1024
    ds_write_b16 v241, v240 offset:1280
    s_waitcnt lgkmcnt(7)
    v_readfirstlane_b32 s58, v232
    v_mfma_f32_32x32x16_bf16 v[32:47], v[72:75], v[188:191], v[32:47]
    s_cmp_lt_u32 s58, s22
    s_cbranch_scc0 K2_nul_61
    s_and_b32 s59, s58, 7
    s_lshr_b32 s60, s58, 3
K2_chk_63:
    v_readlane_b32 s61, v233, s59
    s_nop 0
    s_cmp_gt_u32 s61, s60
    s_cbranch_scc0 K2_spin_62
K2_back_64:
    v_mfma_f32_32x32x16_bf16 v[48:63], v[76:79], v[188:191], v[48:63]
    v_readlane_b32 s3, v253, s58
    s_lshl_b32 s44, s34, 7
    s_and_b32 s48, s3, 0x3ffff
    s_bfe_u32 s33, s3, 0x30013
    s_mov_b32 s35, s48
    s_mov_b32 s45, s44
    s_waitcnt vmcnt(4) lgkmcnt(3)
    v_mfma_f32_32x32x16_bf16 v[0:15], v[80:83], v[176:179], v[0:15]
    ds_read_b64_tr_b16 v[184:185], v246 offset:6144
    ds_read_b64_tr_b16 v[186:187], v246 offset:7168
    ds_read_b64_tr_b16 v[188:189], v247 offset:6144
    ds_read_b64_tr_b16 v[190:191], v247 offset:7168
    s_add_u32 s47, s44, 256
    s_add_u32 s49, s48, 128
    s_mov_b32 m0, s70
    v_mfma_f32_32x32x16_bf16 v[16:31], v[84:87], v[176:179], v[16:31]
    buffer_load_dwordx4 v222, s[4:7], s42 offen sc1 lds
    buffer_load_dwordx4 v223, s[72:75], s42 offen offset:1024 sc1 lds
    s_add_u32 s60, s48, 256
    s_cmp_eq_u32 s33, 3
    s_cselect_b32 s46, s44, s47
    s_cselect_b32 s50, s60, s48
    s_cselect_b32 s51, s48, s49
    v_mfma_f32_32x32x16_bf16 v[32:47], v[80:83], v[180:183], v[32:47]
    s_sub_u32 s60, s33, 2
    s_cmp_lt_u32 s60, 2
    s_cbranch_scc0 K2_rare_65
K2_back_66:
    v_mul_f32 v234, v0, v96
    v_mul_f32 v236, v8, v128
    v_fmac_f32 v234, v1, v97
    v_fmac_f32 v236, v9, v129
    v_mfma_f32_32x32x16_bf16 v[48:63], v[84:87], v[180:183], v[48:63]
    s_setprio 0
    v_fmac_f32 v234, v2, v98
    v_fmac_f32 v236, v10, v130
    v_fmac_f32 v234, v3, v99
    v_fmac_f32 v236, v11, v131
    v_fmac_f32 v234, v4, v100
    v_fmac_f32 v236, v12, v132
    v_fmac_f32 v234, v5, v101
    v_fmac_f32 v236, v13, v133
    v_fmac_f32 v234, v6, v102
    v_fmac_f32 v236, v14, v134
    v_fmac_f32 v234, v7, v103
    v_fmac_f32 v236, v15, v135
    v_mul_f32 v238, v16, v128
    v_mul_f32 v240, v24, v128
    v_fmac_f32 v238, v17, v129
    v_fmac_f32 v240, v25, v129
    v_fmac_f32 v238, v18, v130
    v_fmac_f32 v240, v26, v130
    v_fmac_f32 v238, v19, v131
    v_fmac_f32 v240, v27, v131
    v_fmac_f32 v238, v20, v132
    v_fmac_f32 v240, v28, v132
    v_fmac_f32 v238, v21, v133
    v_fmac_f32 v240, v29, v133
    v_fmac_f32 v238, v22, v134
    v_fmac_f32 v240, v30, v134
    v_fmac_f32 v238, v23, v135
    v_fmac_f32 v240, v31, v135
    v_mul_f32 v235, v32, v104
    v_mul_f32 v237, v40, v136
    v_fmac_f32 v235, v33, v105
    v_fmac_f32 v237, v41, v137
    v_fmac_f32 v235, v34, v106
    v_fmac_f32 v237, v42, v138
    v_fmac_f32 v235, v35, v107
    v_fmac_f32 v237, v43, v139
    v_fmac_f32 v235, v36, v108
    v_fmac_f32 v237, v44, v140
    v_fmac_f32 v235, v37, v109
    v_fmac_f32 v237, v45, v141
    v_fmac_f32 v235, v38, v110
    v_fmac_f32 v237, v46, v142
    v_fmac_f32 v235, v39, v111
    v_fmac_f32 v237, v47, v143
    v_mul_f32 v239, v48, v136
    v_mul_f32 v241, v56, v136
    s_setprio 1
    s_waitcnt vmcnt(4) lgkmcnt(0)
    v_mfma_f32_32x32x16_bf16 v[0:15], v[64:67], v[184:187], 0
    ds_read_b64_tr_b16 v[176:177], v246 offset:0
    ds_read_b64_tr_b16 v[178:179], v246 offset:1024
    ds_read_b64_tr_b16 v[180:181], v247 offset:0
    ds_read_b64_tr_b16 v[182:183], v247 offset:1024
    v_fmac_f32 v239, v49, v137
    v_fmac_f32 v241, v57, v137
    s_mov_b32 m0, s71
    v_mfma_f32_32x32x16_bf16 v[16:31], v[68:71], v[184:187], 0
    buffer_load_dwordx4 v224, s[4:7], s42 offen sc1 lds
    buffer_load_dwordx4 v225, s[72:75], s42 offen offset:1024 sc1 lds
    v_fmac_f32 v239, v50, v138
    v_fmac_f32 v241, v58, v138
    v_fmac_f32 v239, v51, v139
    v_fmac_f32 v241, v59, v139
    v_fmac_f32 v239, v52, v140
    v_mfma_f32_32x32x16_bf16 v[32:47], v[64:67], v[188:191], 0
    v_fmac_f32 v241, v60, v140
    v_fmac_f32 v239, v53, v141
    v_fmac_f32 v241, v61, v141
    v_fmac_f32 v239, v54, v142
    v_fmac_f32 v241, v62, v142
    v_fmac_f32 v239, v55, v143
    v_fmac_f32 v241, v63, v143
    v_mfma_f32_32x32x16_bf16 v[48:63], v[68:71], v[188:191], 0
    v_permlane32_swap_b32 v234, v236
    v_permlane32_swap_b32 v235, v237
    v_permlane32_swap_b32 v240, v238
    s_waitcnt vmcnt(4) lgkmcnt(0)
    v_mfma_f32_32x32x16_bf16 v[0:15], v[72:75], v[176:179], v[0:15]
    ds_read_b64_tr_b16 v[184:185], v246 offset:2048
    ds_read_b64_tr_b16 v[186:187], v246 offset:3072
    ds_read_b64_tr_b16 v[188:189], v247 offset:2048
    ds_read_b64_tr_b16 v[190:191], v247 offset:3072
    v_permlane32_swap_b32 v241, v239
    s_mov_b32 m0, s68
    v_mfma_f32_32x32x16_bf16 v[16:31], v[76:79], v[176:179], v[16:31]
    buffer_load_dwordx4 v226, s[4:7], s42 offen sc1 lds
    buffer_load_dwordx4 v227, s[72:75], s42 offen offset:1024 sc1 lds
    v_lshl_add_u32 v230, v252, 1, s31
    v_add_f32 v234, v234, v236
    v_add_f32 v235, v235, v237
    v_add_f32 v240, v240, v238
    v_add_f32 v241, v241, v239
    v_mfma_f32_32x32x16_bf16 v[32:47], v[72:75], v[180:183], v[32:47]
    v_cvt_pk_bf16_f32 v234, v234, v235
    v_cvt_pk_bf16_f32 v240, v240, v241
    ds_write_b32 v230, v234 offset:0
    ds_write_b32 v230, v240 offset:256
    v_mfma_f32_32x32x16_bf16 v[48:63], v[76:79], v[180:183], v[48:63]
    s_waitcnt vmcnt(4) lgkmcnt(2)
    v_mfma_f32_32x32x16_bf16 v[0:15], v[80:83], v[184:187], v[0:15]
    ds_read_b64_tr_b16 v[176:177], v246 offset:4096
    ds_read_b64_tr_b16 v[178:179], v246 offset:5120
    ds_read_b64_tr_b16 v[180:181], v247 offset:4096
    ds_read_b64_tr_b16 v[182:183], v247 offset:5120
    s_mov_b32 m0, s69
    v_mfma_f32_32x32x16_bf16 v[16:31], v[84:87], v[184:187], v[16:31]
    buffer_load_dwordx4 v222, s[4:7], s43 offen sc1 lds
    buffer_load_dwordx4 v223, s[72:75], s43 offen offset:1024 sc1 lds
    v_mfma_f32_32x32x16_bf16 v[32:47], v[80:83], v[188:191], v[32:47]
    s_nop 2
    v_mul_f32 v234, v0, v144
    v_mul_f32 v236, v8, v112
    v_fmac_f32 v234, v1, v145
    v_fmac_f32 v236, v9, v113
    v_fmac_f32 v234, v2, v146
    v_fmac_f32 v236, v10, v114
    v_fmac_f32 v234, v3, v147
    v_mfma_f32_32x32x16_bf16 v[48:63], v[84:87], v[188:191], v[48:63]
    s_setprio 0
    v_fmac_f32 v236, v11, v115
    v_fmac_f32 v234, v4, v148
    v_fmac_f32 v236, v12, v116
    v_fmac_f32 v234, v5, v149
    v_fmac_f32 v236, v13, v117
    v_fmac_f32 v234, v6, v150
    v_fmac_f32 v236, v14, v118
    v_fmac_f32 v234, v7, v151
    v_fmac_f32 v236, v15, v119
    v_mul_f32 v238, v16, v160
    v_mul_f32 v240, v24, v160
    v_fmac_f32 v238, v17, v161
    v_fmac_f32 v240, v25, v161
    v_fmac_f32 v238, v18, v162
    v_fmac_f32 v240, v26, v162
    v_fmac_f32 v238, v19, v163
    v_fmac_f32 v240, v27, v163
    v_fmac_f32 v238, v20, v164
    v_fmac_f32 v240, v28, v164
    v_fmac_f32 v238, v21, v165
    v_fmac_f32 v240, v29, v165
    v_fmac_f32 v238, v22, v166
    v_fmac_f32 v240, v30, v166
    v_fmac_f32 v238, v23, v167
    v_fmac_f32 v240, v31, v167
    v_mul_f32 v235, v32, v152
    v_mul_f32 v237, v40, v120
    v_fmac_f32 v235, v33, v153
    v_fmac_f32 v237, v41, v121
    v_fmac_f32 v235, v34, v154
    v_fmac_f32 v237, v42, v122
    v_fmac_f32 v235, v35, v155
    v_fmac_f32 v237, v43, v123
    v_fmac_f32 v235, v36, v156
    v_fmac_f32 v237, v44, v124
    v_fmac_f32 v235, v37, v157
    v_fmac_f32 v237, v45, v125
    v_fmac_f32 v235, v38, v158
    v_fmac_f32 v237, v46, v126
    v_fmac_f32 v235, v39, v159
    v_fmac_f32 v237, v47, v127
    v_mul_f32 v239, v48, v168
    v_mul_f32 v241, v56, v168
    v_fmac_f32 v239, v49, v169
    v_fmac_f32 v241, v57, v169
    s_setprio 1
    s_waitcnt vmcnt(4) lgkmcnt(0)
    v_mfma_f32_32x32x16_bf16 v[0:15], v[64:67], v[176:179], 0
    ds_read_b64_tr_b16 v[184:185], v246 offset:6144
    ds_read_b64_tr_b16 v[186:187], v246 offset:7168
    ds_read_b64_tr_b16 v[188:189], v247 offset:6144
    ds_read_b64_tr_b16 v[190:191], v247 offset:7168
    v_fmac_f32 v239, v50, v170
    v_fmac_f32 v241, v58, v170
    s_mov_b32 m0, s70
    v_mfma_f32_32x32x16_bf16 v[16:31], v[68:71], v[176:179], 0
    buffer_load_dwordx4 v224, s[4:7], s43 offen sc1 lds
    buffer_load_dwordx4 v225, s[72:75], s43 offen offset:1024 sc1 lds
    v_fmac_f32 v239, v51, v171
    v_fmac_f32 v241, v59, v171
    v_fmac_f32 v239, v52, v172
    v_fmac_f32 v241, v60, v172
    v_fmac_f32 v239, v53, v173
    v_mfma_f32_32x32x16_bf16 v[32:47], v[64:67], v[180:183], 0
    v_add_u32 v222, s48, v251
    ds_read2_b32 v[222:223], v222 offset0:1 offset1:3
    v_fmac_f32 v241, v61, v173
    v_fmac_f32 v239, v54, v174
    v_fmac_f32 v241, v62, v174
    v_fmac_f32 v239, v55, v175
    v_fmac_f32 v241, v63, v175
    v_mfma_f32_32x32x16_bf16 v[48:63], v[68:71], v[180:183], 0
    s_waitcnt vmcnt(4) lgkmcnt(1)
    v_mfma_f32_32x32x16_bf16 v[0:15], v[72:75], v[184:187], v[0:15]
    ds_read_b64_tr_b16 v[176:177], v246 offset:0
    ds_read_b64_tr_b16 v[178:179], v246 offset:1024
    ds_read_b64_tr_b16 v[180:181], v247 offset:0
    ds_read_b64_tr_b16 v[182:183], v247 offset:1024
    s_mov_b32 m0, s71
    v_mfma_f32_32x32x16_bf16 v[16:31], v[76:79], v[184:187], v[16:31]
    buffer_load_dwordx4 v226, s[4:7], s43 offen sc1 lds
    buffer_load_dwordx4 v227, s[72:75], s43 offen offset:1024 sc1 lds
    s_waitcnt lgkmcnt(4)
    v_mad_u32_u16 v222, v222, s39, v248 op_sel:[1,0,0,0]
    v_mad_u32_u16 v223, v223, s39, v248 op_sel:[1,0,0,0]
    v_mfma_f32_32x32x16_bf16 v[32:47], v[72:75], v[188:191], v[32:47]
    v_add_u32 v224, s49, v251
    ds_read2_b32 v[224:225], v224 offset0:1 offset1:3
    v_mfma_f32_32x32x16_bf16 v[48:63], v[76:79], v[188:191], v[48:63]
    s_waitcnt vmcnt(4) lgkmcnt(1)
    v_mfma_f32_32x32x16_bf16 v[0:15], v[80:83], v[176:179], v[0:15]
    ds_read_b64_tr_b16 v[184:185], v246 offset:2048
    ds_read_b64_tr_b16 v[186:187], v246 offset:3072
    ds_read_b64_tr_b16 v[188:189], v247 offset:2048
    ds_read_b64_tr_b16 v[190:191], v247 offset:3072
    s_mov_b32 m0, s68
    v_mfma_f32_32x32x16_bf16 v[16:31], v[84:87], v[176:179], v[16:31]
    buffer_load_dwordx4 v222, s[4:7], s44 offen sc1 lds
    buffer_load_dwordx4 v223, s[72:75], s44 offen offset:1024 sc1 lds
    s_waitcnt lgkmcnt(4)
    v_mad_u32_u16 v224, v224, s39, v248 op_sel:[1,0,0,0]
    v_mad_u32_u16 v225, v225, s39, v248 op_sel:[1,0,0,0]
    v_mfma_f32_32x32x16_bf16 v[32:47], v[80:83], v[180:183], v[32:47]
    v_add_u32 v226, s50, v251
    ds_read2_b32 v[226:227], v226 offset0:1 offset1:3
    v_mul_f32 v242, v0, v144
    v_fma_f32 v238, v8, v160, -v238
    v_fmac_f32 v242, v1, v145
    v_fmac_f32 v238, v9, v161
    v_fmac_f32 v242, v2, v146
    v_mfma_f32_32x32x16_bf16 v[48:63], v[84:87], v[180:183], v[48:63]
    s_setprio 0
    v_fmac_f32 v238, v10, v162
    v_fmac_f32 v242, v3, v147
    v_fmac_f32 v238, v11, v163
    v_fmac_f32 v242, v4, v148
    v_fmac_f32 v238, v12, v164
    v_fmac_f32 v242, v5, v149
    v_fmac_f32 v238, v13, v165
    v_fmac_f32 v242, v6, v150
    v_fmac_f32 v238, v14, v166
    v_fmac_f32 v242, v7, v151
    v_fmac_f32 v238, v15, v167
    v_fmac_f32 v236, v16, v112
    v_mul_f32 v244, v24, v160
    v_fmac_f32 v236, v17, v113
    v_fmac_f32 v244, v25, v161
    v_fmac_f32 v236, v18, v114
    v_fmac_f32 v244, v26, v162
    v_fmac_f32 v236, v19, v115
    v_fmac_f32 v244, v27, v163
    v_fmac_f32 v236, v20, v116
    v_fmac_f32 v244, v28, v164
    v_fmac_f32 v236, v21, v117
    v_fmac_f32 v244, v29, v165
    v_fmac_f32 v236, v22, v118
    v_fmac_f32 v244, v30, v166
    v_fmac_f32 v236, v23, v119
    v_fmac_f32 v244, v31, v167
    v_mul_f32 v243, v32, v152
    v_fma_f32 v239, v40, v168, -v239
    v_fmac_f32 v243, v33, v153
    v_fmac_f32 v239, v41, v169
    v_fmac_f32 v243, v34, v154
    v_fmac_f32 v239, v42, v170
    v_fmac_f32 v243, v35, v155
    v_fmac_f32 v239, v43, v171
    v_fmac_f32 v243, v36, v156
    v_fmac_f32 v239, v44, v172
    v_fmac_f32 v243, v37, v157
    v_fmac_f32 v239, v45, v173
    v_fmac_f32 v243, v38, v158
    v_fmac_f32 v239, v46, v174
    v_fmac_f32 v243, v39, v159
    v_fmac_f32 v239, v47, v175
    v_fmac_f32 v237, v48, v120
    v_mul_f32 v245, v56, v168
    v_fmac_f32 v237, v49, v121
    v_fmac_f32 v245, v57, v169
    v_fmac_f32 v237, v50, v122
    v_fmac_f32 v245, v58, v170
    v_fmac_f32 v237, v51, v123
    s_setprio 1
    s_waitcnt vmcnt(4) lgkmcnt(1)
    v_mfma_f32_32x32x16_bf16 v[0:15], v[64:67], v[184:187], 0
    ds_read_b64_tr_b16 v[176:177], v246 offset:4096
    ds_read_b64_tr_b16 v[178:179], v246 offset:5120
    ds_read_b64_tr_b16 v[180:181], v247 offset:4096
    ds_read_b64_tr_b16 v[182:183], v247 offset:5120
    v_fmac_f32 v245, v59, v171
    v_fmac_f32 v237, v52, v124
    s_mov_b32 m0, s69
    v_mfma_f32_32x32x16_bf16 v[16:31], v[68:71], v[184:187], 0
    buffer_load_dwordx4 v224, s[4:7], s45 offen sc1 lds
    buffer_load_dwordx4 v225, s[72:75], s45 offen offset:1024 sc1 lds
    s_waitcnt lgkmcnt(4)
    v_mad_u32_u16 v226, v226, s39, v248 op_sel:[1,0,0,0]
    v_mad_u32_u16 v227, v227, s39, v248 op_sel:[1,0,0,0]
    v_fmac_f32 v245, v60, v172
    v_fmac_f32 v237, v53, v125
    v_mfma_f32_32x32x16_bf16 v[32:47], v[64:67], v[188:191], 0
    v_add_u32 v228, s51, v251
    ds_read2_b32 v[228:229], v228 offset0:1 offset1:3
    v_fmac_f32 v245, v61, v173
    v_fmac_f32 v237, v54, v126
    v_fmac_f32 v245, v62, v174
    v_fmac_f32 v237, v55, v127
    v_fmac_f32 v245, v63, v175
    v_mfma_f32_32x32x16_bf16 v[48:63], v[68:71], v[188:191], 0
    v_permlane32_swap_b32 v242, v234
    v_permlane32_swap_b32 v243, v235
    v_add_f32 v242, v242, v234
    v_add_f32 v243, v243, v235
    s_waitcnt vmcnt(4) lgkmcnt(1)
    v_mfma_f32_32x32x16_bf16 v[0:15], v[72:75], v[176:179], v[0:15]
    ds_read_b64_tr_b16 v[184:185], v246 offset:6144
    ds_read_b64_tr_b16 v[186:187], v246 offset:7168
    ds_read_b64_tr_b16 v[188:189], v247 offset:6144
    ds_read_b64_tr_b16 v[190:191], v247 offset:7168
    v_cvt_pk_bf16_f32 v242, v242, v243
    ds_write_b32 v230, v242 offset:512
    s_mov_b32 m0, s70
    v_mfma_f32_32x32x16_bf16 v[16:31], v[76:79], v[176:179], v[16:31]
    buffer_load_dwordx4 v226, s[4:7], s46 offen sc1 lds
    buffer_load_dwordx4 v227, s[72:75], s46 offen offset:1024 sc1 lds
    s_waitcnt lgkmcnt(5)
    v_mad_u32_u16 v228, v228, s39, v248 op_sel:[1,0,0,0]
    v_mad_u32_u16 v229, v229, s39, v248 op_sel:[1,0,0,0]
    s_sub_u32 s26, s48, s29
    s_mov_b32 s29, s48
    v_mfma_f32_32x32x16_bf16 v[32:47], v[72:75], v[180:183], v[32:47]
    s_mov_b32 s30, s3
    s_bfe_u32 s56, s3, 0x40012
    s_cmp_lg_u32 s36, 0
    s_cselect_b32 s56, s56, 0
    s_mov_b32 s32, s31
    s_mov_b32 s31, s35
    v_mfma_f32_32x32x16_bf16 v[48:63], v[76:79], v[180:183], v[48:63]
    s_waitcnt vmcnt(4) lgkmcnt(1)
    v_mfma_f32_32x32x16_bf16 v[0:15], v[80:83], v[184:187], v[0:15]
    ds_read_b64_tr_b16 v[176:177], v246 offset:0
    ds_read_b64_tr_b16 v[178:179], v246 offset:1024
    ds_read_b64_tr_b16 v[180:181], v247 offset:0
    ds_read_b64_tr_b16 v[182:183], v247 offset:1024
    s_mov_b32 m0, s71
    v_mfma_f32_32x32x16_bf16 v[16:31], v[84:87], v[184:187], v[16:31]
    buffer_load_dwordx4 v228, s[4:7], s47 offen sc1 lds
    buffer_load_dwordx4 v229, s[72:75], s47 offen offset:1024 sc1 lds
    v_mfma_f32_32x32x16_bf16 v[32:47], v[80:83], v[188:191], v[32:47]
    s_nop 2
    v_mul_f32 v242, v0, v144
    v_fma_f32 v240, v8, v160, -v240
    v_fmac_f32 v242, v1, v145
    v_fmac_f32 v240, v9, v161
    v_fmac_f32 v242, v2, v146
    v_fmac_f32 v240, v10, v162
    v_fmac_f32 v242, v3, v147
    v_mfma_f32_32x32x16_bf16 v[48:63], v[84:87], v[188:191], v[48:63]
    s_setprio 0
    v_fmac_f32 v240, v11, v163
    v_fmac_f32 v242, v4, v148
    v_fmac_f32 v240, v12, v164
    v_fmac_f32 v242, v5, v149
    v_fmac_f32 v240, v13, v165
    v_fmac_f32 v242, v6, v150
    v_fmac_f32 v240, v14, v166
    v_fmac_f32 v242, v7, v151
    v_fmac_f32 v240, v15, v167
    v_add_u32 v249, s26, v249
    v_add_u32 v250, s26, v250
    v_fma_f32 v244, v16, v160, -v244
    v_fmac_f32 v236, v24, v112
    v_fmac_f32 v244, v17, v161
    v_fmac_f32 v236, v25, v113
    v_fmac_f32 v244, v18, v162
    v_fmac_f32 v236, v26, v114
    v_fmac_f32 v244, v19, v163
    v_fmac_f32 v236, v27, v115
    v_fmac_f32 v244, v20, v164
    v_fmac_f32 v236, v28, v116
    v_fmac_f32 v244, v21, v165
    v_fmac_f32 v236, v29, v117
    v_fmac_f32 v244, v22, v166
    v_fmac_f32 v236, v30, v118
    v_fmac_f32 v244, v23, v167
    v_fmac_f32 v236, v31, v119
    ds_read_b64_tr_b16 v[0:1], v249 offset:0
    ds_read_b64_tr_b16 v[2:3], v249 offset:32
    ds_read_u16_d16_hi v16, v250 offset:0
    v_mul_f32 v243, v32, v152
    v_fma_f32 v241, v40, v168, -v241
    v_fmac_f32 v243, v33, v153
    v_fmac_f32 v241, v41, v169
    v_fmac_f32 v243, v34, v154
    v_fmac_f32 v241, v42, v170
    v_fmac_f32 v243, v35, v155
    v_fmac_f32 v241, v43, v171
    v_fmac_f32 v243, v36, v156
    v_fmac_f32 v241, v44, v172
    v_fmac_f32 v243, v37, v157
    v_fmac_f32 v241, v45, v173
    v_fmac_f32 v243, v38, v158
    v_fmac_f32 v241, v46, v174
    v_fmac_f32 v243, v39, v159
    v_fmac_f32 v241, v47, v175
    ds_read_b64_tr_b16 v[4:5], v249 offset:512
    ds_read_b64_tr_b16 v[6:7], v249 offset:544
    ds_read_u16_d16_hi v17, v250 offset:128
    v_fma_f32 v245, v48, v168, -v245
    v_fmac_f32 v237, v56, v120
    v_fmac_f32 v245, v49, v169
    v_fmac_f32 v237, v57, v121
    v_fmac_f32 v245, v50, v170
    v_fmac_f32 v237, v58, v122
    v_fmac_f32 v245, v51, v171
    v_fmac_f32 v237, v59, v123
    v_fmac_f32 v245, v52, v172
    v_fmac_f32 v237, v60, v124
    v_fmac_f32 v245, v53, v173
    v_fmac_f32 v237, v61, v125
    v_fmac_f32 v245, v54, v174
    v_fmac_f32 v237, v62, v126
    v_fmac_f32 v245, v55, v175
    v_fmac_f32 v237, v63, v127
    s_cmp_eq_u32 s56, 5
    s_cbranch_scc1 K2_U21
    s_cmp_eq_u32 s56, 6
    s_cbranch_scc1 K2_U3h1
    s_branch K2_DSP1
K2_PAD_SW:
    s_branch K2_HOP
K2_DSP0:
    s_cmp_eq_u32 s56, 4
    s_cbranch_scc1 K2_U20
    s_cmp_eq_u32 s56, 7
    s_cbranch_scc1 K2_U30
    s_cmp_gt_u32 s56, 7
    s_cbranch_scc1 K2_U40
    s_cmp_lg_u32 s56, 0
    s_cbranch_scc1 K2_U10
    s_branch K2_SWITCH
K2_DSP1:
    s_cmp_eq_u32 s56, 4
    s_cbranch_scc1 K2_U21
    s_cmp_eq_u32 s56, 7
    s_cbranch_scc1 K2_U31
    s_cmp_gt_u32 s56, 7
    s_cbranch_scc1 K2_U41
    s_cmp_lg_u32 s56, 0
    s_cbranch_scc1 K2_U11
    s_branch K2_TAIL
K2_SWITCH:
    v_lshlrev_b32 v60, 3, v252
    s_mov_b32 s64, 7176192
    buffer_load_dwordx4 v[56:59], v60, s[8:11], s64 offen sc1
    v_permlane32_swap_b32 v242, v236
    v_permlane32_swap_b32 v243, v237
    v_permlane32_swap_b32 v244, v238
    v_permlane32_swap_b32 v245, v239
    v_permlane32_swap_b32 v240, v241
    v_add_f32 v242, v242, v236
    v_add_f32 v243, v243, v237
    v_add_f32 v244, v244, v238
    v_add_f32 v245, v245, v239
    v_add_f32 v240, -v240, -v241
    s_set_gpr_idx_on s32, gpr_idx(DST)
    s_nop 0
    v_cvt_pk_bf16_f32 v195, v242, v243
    v_cvt_pk_bf16_f32 v196, v244, v245
    v_cvt_pk_bf16_f32 v197, v240, v240
    s_set_gpr_idx_off
    v_lshl_add_u32 v230, v252, 1, s35
    v_lshrrev_b32 v231, 6, v252
    v_mul_u32_u24 v231, 126, v231
    v_lshrrev_b32 v254, 6, v252
    v_bfe_u32 v255, v252, 3, 2
    v_lshl_add_u32 v254, v254, 2, v255
    v_mul_u32_u24 v254, 640, v254
    v_bfe_u32 v255, v252, 5, 1
    v_lshl_add_u32 v254, v255, 5, v254
    v_and_b32 v255, 6, v252
    v_lshl_add_u32 v254, v255, 2, v254
    v_add_u32 v254, 152832, v254
    ds_read_b64_tr_b16 v[104:105], v254 offset:0
    ds_read_b64_tr_b16 v[106:107], v254 offset:5120
    ds_read_b64_tr_b16 v[108:109], v254 offset:64
    ds_read_b64_tr_b16 v[110:111], v254 offset:5184
    ds_read_b64_tr_b16 v[120:121], v254 offset:128
    ds_read_b64_tr_b16 v[122:123], v254 offset:5248
    ds_read_b64_tr_b16 v[124:125], v254 offset:192
    ds_read_b64_tr_b16 v[126:127], v254 offset:5312
    ds_read_b64_tr_b16 v[136:137], v254 offset:256
    ds_read_b64_tr_b16 v[138:139], v254 offset:5376
    ds_read_b64_tr_b16 v[140:141], v254 offset:320
    ds_read_b64_tr_b16 v[142:143], v254 offset:5440
    ds_read_b64_tr_b16 v[152:153], v254 offset:384
    ds_read_b64_tr_b16 v[154:155], v254 offset:5504
    ds_read_b64_tr_b16 v[156:157], v254 offset:448
    ds_read_b64_tr_b16 v[158:159], v254 offset:5568
    ds_read_b64_tr_b16 v[168:169], v254 offset:512
    ds_read_b64_tr_b16 v[170:171], v254 offset:5632
    ds_read_b64_tr_b16 v[172:173], v254 offset:576
    ds_read_b64_tr_b16 v[174:175], v254 offset:5696
    s_movk_i32 s40, 128
    s_movk_i32 s41, 384
    s_movk_i32 s42, 640
    s_movk_i32 s43, 896
    s_waitcnt lgkmcnt(15)
    v_lshlrev_b32 v96, 16, v104
    v_and_b32 v97, 0xffff0000, v104
    v_lshlrev_b32 v98, 16, v105
    v_and_b32 v99, 0xffff0000, v105
    v_lshlrev_b32 v100, 16, v106
    v_and_b32 v101, 0xffff0000, v106
    v_lshlrev_b32 v102, 16, v107
    v_and_b32 v103, 0xffff0000, v107
    v_lshlrev_b32 v104, 16, v108
    v_and_b32 v105, 0xffff0000, v108
    v_lshlrev_b32 v106, 16, v109
    v_and_b32 v107, 0xffff0000, v109
    v_lshlrev_b32 v108, 16, v110
    v_and_b32 v109, 0xffff0000, v110
    v_lshlrev_b32 v110, 16, v111
    v_and_b32 v111, 0xffff0000, v111
    s_waitcnt lgkmcnt(12)
    v_lshlrev_b32 v112, 16, v120
    v_and_b32 v113, 0xffff0000, v120
    v_lshlrev_b32 v114, 16, v121
    v_and_b32 v115, 0xffff0000, v121
    v_lshlrev_b32 v116, 16, v122
    v_and_b32 v117, 0xffff0000, v122
    v_lshlrev_b32 v118, 16, v123
    v_and_b32 v119, 0xffff0000, v123
    v_lshlrev_b32 v120, 16, v124
    v_and_b32 v121, 0xffff0000, v124
    v_lshlrev_b32 v122, 16, v125
    v_and_b32 v123, 0xffff0000, v125
    v_lshlrev_b32 v124, 16, v126
    v_and_b32 v125, 0xffff0000, v126
    v_lshlrev_b32 v126, 16, v127
    v_and_b32 v127, 0xffff0000, v127
    s_waitcnt lgkmcnt(8)
    v_lshlrev_b32 v128, 16, v136
    v_and_b32 v129, 0xffff0000, v136
    v_lshlrev_b32 v130, 16, v137
    v_and_b32 v131, 0xffff0000, v137
    v_lshlrev_b32 v132, 16, v138
    v_and_b32 v133, 0xffff0000, v138
    v_lshlrev_b32 v134, 16, v139
    v_and_b32 v135, 0xffff0000, v139
    v_lshlrev_b32 v136, 16, v140
    v_and_b32 v137, 0xffff0000, v140
    v_lshlrev_b32 v138, 16, v141
    v_and_b32 v139, 0xffff0000, v141
    v_lshlrev_b32 v140, 16, v142
    v_and_b32 v141, 0xffff0000, v142
    v_lshlrev_b32 v142, 16, v143
    v_and_b32 v143, 0xffff0000, v143
    s_waitcnt lgkmcnt(4)
    v_lshlrev_b32 v144, 16, v152
    v_and_b32 v145, 0xffff0000, v152
    v_lshlrev_b32 v146, 16, v153
    v_and_b32 v147, 0xffff0000, v153
    v_lshlrev_b32 v148, 16, v154
    v_and_b32 v149, 0xffff0000, v154
    v_lshlrev_b32 v150, 16, v155
    v_and_b32 v151, 0xffff0000, v155
    v_lshlrev_b32 v152, 16, v156
    v_and_b32 v153, 0xffff0000, v156
    v_lshlrev_b32 v154, 16, v157
    v_and_b32 v155, 0xffff0000, v157
    v_lshlrev_b32 v156, 16, v158
    v_and_b32 v157, 0xffff0000, v158
    v_lshlrev_b32 v158, 16, v159
    v_and_b32 v159, 0xffff0000, v159
    s_waitcnt lgkmcnt(0)
    v_lshlrev_b32 v160, 16, v168
    v_and_b32 v161, 0xffff0000, v168
    v_lshlrev_b32 v162, 16, v169
    v_and_b32 v163, 0xffff0000, v169
    v_lshlrev_b32 v164, 16, v170
    v_and_b32 v165, 0xffff0000, v170
    v_lshlrev_b32 v166, 16, v171
    v_and_b32 v167, 0xffff0000, v171
    v_lshlrev_b32 v168, 16, v172
    v_and_b32 v169, 0xffff0000, v172
    v_lshlrev_b32 v170, 16, v173
    v_and_b32 v171, 0xffff0000, v173
    v_lshlrev_b32 v172, 16, v174
    v_and_b32 v173, 0xffff0000, v174
    v_lshlrev_b32 v174, 16, v175
    v_and_b32 v175, 0xffff0000, v175
K2_FLGW:
    s_or_b32 s58, s54, s20
    s_waitcnt vmcnt(0)
    v_xor_b32 v56, s2, v56
    v_xor_b32 v57, s2, v57
    v_xor_b32 v58, s2, v58
    v_xor_b32 v59, s2, v59
    v_or3_b32 v56, v56, v57, v58
    v_or_b32 v56, v56, v59
    v_cmp_ne_u32 vcc, 0, v56
    s_nop 0
    s_cbranch_vccnz K2_FLGR
    s_cmp_eq_u32 s58, 0
    s_cbranch_scc1 K2_FLGY
K2_FLGOK:
    s_cmp_eq_u32 s36, 0
    s_cbranch_scc1 K2_TAIL2
    s_mov_b32 s29, s48
    s_mov_b32 s32, s31
    s_mov_b32 s30, s3
    s_mov_b32 s31, s35
    s_bfe_u32 s56, s3, 0x40012
    s_cmp_eq_u32 s56, 5
    s_cbranch_scc1 K2_U21
    s_cmp_eq_u32 s56, 6
    s_cbranch_scc1 K2_U3h1
    s_branch K2_DSP1
K2_dum_4:
    v_mov_b32 v232, -1
    s_mov_b32 m0, 163312
    s_mov_b64 exec, 1
    buffer_load_dwordx4 v232, s[16:19], 0 offen lds
    buffer_load_dwordx4 v232, s[16:19], 0 offen lds
    s_mov_b64 exec, -1
    s_branch K2_back_6
K2_nul_10:
    s_mov_b32 s58, 63
    s_mov_b32 s36, 0
    s_branch K2_back_13
K2_spin_11:
    s_sub_u32 s27, s27, 1
    s_cbranch_scc1 K2_END
    v_lshl_add_u32 v233, v252, 1, s53
    ds_read_b32 v233, v233
    s_waitcnt lgkmcnt(0)
    s_branch K2_chk_12
K2_dyn_8:
    v_mov_b32 v254, 163296
    v_mov_b32 v255, 1
    v_lshl_add_u32 v233, v252, 1, s53
    s_mov_b64 exec, 1
    ds_add_rtn_u32 v232, v254, v255
    s_mov_b64 exec, -1
    ds_read_b32 v233, v233
    s_waitcnt lgkmcnt(0)
    v_readfirstlane_b32 s58, v232
    s_nop 0
    s_cmp_lt_u32 s58, s22
    s_cbranch_scc0 K2_nul_10
    s_and_b32 s59, s58, 7
    s_lshr_b32 s60, s58, 3
K2_chk_12:
    v_readlane_b32 s61, v233, s59
    s_nop 0
    s_cmp_gt_u32 s61, s60
    s_cbranch_scc0 K2_spin_11
K2_back_13:
    s_mov_b32 s34, 1
    s_branch K2_back_9
K2_dum_17:
    v_mov_b32 v232, -1
    s_mov_b32 m0, 163312
    s_mov_b64 exec, 1
    buffer_load_dwordx4 v232, s[16:19], 0 offen lds
    buffer_load_dwordx4 v232, s[16:19], 0 offen lds
    s_mov_b64 exec, -1
    s_branch K2_back_19
K2_nul_23:
    s_mov_b32 s58, 63
    s_mov_b32 s36, 0
    s_branch K2_back_26
K2_spin_24:
    s_sub_u32 s27, s27, 1
    s_cbranch_scc1 K2_END
    v_lshl_add_u32 v233, v252, 1, s53
    ds_read_b32 v233, v233
    s_waitcnt lgkmcnt(0)
    s_branch K2_chk_25
K2_dyn_21:
    v_mov_b32 v254, 163296
    v_mov_b32 v255, 1
    v_lshl_add_u32 v233, v252, 1, s53
    s_mov_b64 exec, 1
    ds_add_rtn_u32 v232, v254, v255
    s_mov_b64 exec, -1
    ds_read_b32 v233, v233
    s_waitcnt lgkmcnt(0)
    v_readfirstlane_b32 s58, v232
    s_nop 0
    s_cmp_lt_u32 s58, s22
    s_cbranch_scc0 K2_nul_23
    s_and_b32 s59, s58, 7
    s_lshr_b32 s60, s58, 3
K2_chk_25:
    v_readlane_b32 s61, v233, s59
    s_nop 0
    s_cmp_gt_u32 s61, s60
    s_cbranch_scc0 K2_spin_24
K2_back_26:
    s_mov_b32 s34, 1
    s_branch K2_back_22
K2_dum_30:
    v_mov_b32 v232, -1
    s_mov_b32 m0, 163312
    s_mov_b64 exec, 1
    buffer_load_dwordx4 v232, s[16:19], 0 offen lds
    buffer_load_dwordx4 v232, s[16:19], 0 offen lds
    s_mov_b64 exec, -1
    s_branch K2_back_32
K2_nul_36:
    s_mov_b32 s58, 63
    s_mov_b32 s36, 0
    s_branch K2_back_39
K2_spin_37:
    s_sub_u32 s27, s27, 1
    s_cbranch_scc1 K2_END
    v_lshl_add_u32 v233, v252, 1, s53
    ds_read_b32 v233, v233
    s_waitcnt lgkmcnt(0)
    s_branch K2_chk_38
K2_dyn_34:
    v_mov_b32 v254, 163296
    v_mov_b32 v255, 1
    v_lshl_add_u32 v233, v252, 1, s53
    s_mov_b64 exec, 1
    ds_add_rtn_u32 v232, v254, v255
    s_mov_b64 exec, -1
    ds_read_b32 v233, v233
    s_waitcnt lgkmcnt(0)
    v_readfirstlane_b32 s58, v232
    s_nop 0
    s_cmp_lt_u32 s58, s22
    s_cbranch_scc0 K2_nul_36
    s_and_b32 s59, s58, 7
    s_lshr_b32 s60, s58, 3
K2_chk_38:
    v_readlane_b32 s61, v233, s59
    s_nop 0
    s_cmp_gt_u32 s61, s60
    s_cbranch_scc0 K2_spin_37
K2_back_39:
    s_mov_b32 s34, 1
    s_branch K2_back_35
K2_dum_43:
    v_mov_b32 v232, -1
    s_mov_b32 m0, 163312
    s_mov_b64 exec, 1
    buffer_load_dwordx4 v232, s[16:19], 0 offen lds
    buffer_load_dwordx4 v232, s[16:19], 0 offen lds
    s_mov_b64 exec, -1
    s_branch K2_back_45
K2_nul_47:
    s_mov_b32 s58, 63
    s_mov_b32 s36, 0
    s_branch K2_back_50
K2_spin_48:
    s_sub_u32 s27, s27, 1
    s_cbranch_scc1 K2_END
    v_lshl_add_u32 v233, v252, 1, s53
    ds_read_b32 v233, v233
    s_waitcnt lgkmcnt(0)
    s_branch K2_chk_49
K2_nul_54:
    s_mov_b32 s58, 63
    s_mov_b32 s36, 0
    s_branch K2_back_57
K2_spin_55:
    s_sub_u32 s27, s27, 1
    s_cbranch_scc1 K2_END
    v_lshl_add_u32 v233, v252, 1, s53
    ds_read_b32 v233, v233
    s_waitcnt lgkmcnt(0)
    s_branch K2_chk_56
K2_nul_61:
    s_mov_b32 s58, 63
    s_mov_b32 s36, 0
    s_branch K2_back_64
K2_spin_62:
    s_sub_u32 s27, s27, 1
    s_cbranch_scc1 K2_END
    v_lshl_add_u32 v233, v252, 1, s53
    ds_read_b32 v233, v233
    s_waitcnt lgkmcnt(0)
    s_branch K2_chk_63
K2_PAD_TL:
    s_branch K2_HOP
K2_TAIL2:
    v_lshlrev_b32 v229, 3, v252
    s_mul_i32 s58, s20, 20480
    s_add_u32 s58, s58, 6946816
    s_mul_i32 s59, s20, 8224
    buffer_load_dwordx4 v[96:99], v229, s[8:11], s58 offen offset:0 sc1
    buffer_load_dwordx4 v[100:103], v229, s[8:11], s58 offen offset:1024 sc1
    buffer_load_dwordx4 v[104:107], v229, s[8:11], s58 offen offset:2048 sc1
    buffer_load_dwordx4 v[108:111], v229, s[8:11], s58 offen offset:3072 sc1
    s_add_u32 s58, s58, 4096
    buffer_load_dwordx4 v[128:131], v229, s[8:11], s58 offen offset:0 sc1
    buffer_load_dwordx4 v[132:135], v229, s[8:11], s58 offen offset:1024 sc1
    buffer_load_dwordx4 v[136:139], v229, s[8:11], s58 offen offset:2048 sc1
    buffer_load_dwordx4 v[140:143], v229, s[8:11], s58 offen offset:3072 sc1
    v_lshl_add_u32 v228, v252, 1, s59
    v_lshrrev_b32 v226, 6, v252
    v_mul_u32_u24 v226, 126, v226
    v_sub_u32 v226, v228, v226
    s_branch K2_TAIL3
K2_TAIL:
    v_lshlrev_b32 v229, 3, v252
    s_mul_i32 s58, s20, 20480
    s_add_u32 s58, s58, 6946816
    s_mul_i32 s59, s20, 8224
    buffer_load_dwordx4 v[96:99], v229, s[8:11], s58 offen offset:0 sc1
    v_permlane32_swap_b32 v242, v236
    v_permlane32_swap_b32 v243, v237
    v_permlane32_swap_b32 v244, v238
    buffer_load_dwordx4 v[100:103], v229, s[8:11], s58 offen offset:1024 sc1
    v_permlane32_swap_b32 v245, v239
    v_permlane32_swap_b32 v240, v241
    v_add_f32 v242, v242, v236
    buffer_load_dwordx4 v[104:107], v229, s[8:11], s58 offen offset:2048 sc1
    v_add_f32 v243, v243, v237
    v_add_f32 v244, v244, v238
    v_add_f32 v245, v245, v239
    buffer_load_dwordx4 v[108:111], v229, s[8:11], s58 offen offset:3072 sc1
    v_add_f32 v240, -v240, -v241
    v_sub_u32 v241, v230, v231
    v_cvt_pk_bf16_f32 v242, v242, v243
    s_add_u32 s58, s58, 4096
    buffer_load_dwordx4 v[128:131], v229, s[8:11], s58 offen offset:0 sc1
    v_cvt_pk_bf16_f32 v244, v244, v245
    v_cvt_pk_bf16_f32 v240, v240, v240
    ds_write_b32 v230, v242 offset:768
    buffer_load_dwordx4 v[132:135], v229, s[8:11], s58 offen offset:1024 sc1
    ds_write_b32 v230, v244 offset:1024
    ds_write_b16 v241, v240 offset:1280
    v_lshl_add_u32 v228, v252, 1, s59
    buffer_load_dwordx4 v[136:139], v229, s[8:11], s58 offen offset:2048 sc1
    v_lshrrev_b32 v226, 6, v252
    v_mul_u32_u24 v226, 126, v226
    v_sub_u32 v226, v228, v226
    buffer_load_dwordx4 v[140:143], v229, s[8:11], s58 offen offset:3072 sc1
K2_TAIL3:
    s_waitcnt vmcnt(8)
    ds_write2st64_b32 v228, v192, v193 offset0:0 offset1:1
    ds_write2st64_b32 v228, v194, v195 offset0:2 offset1:3
    s_add_u32 s58, s58, 4096
    buffer_load_dwordx4 v[112:115], v229, s[8:11], s58 offen offset:0 sc1
    v_bfe_u32 v48, v252, 1, 4
    v_lshrrev_b32 v49, 5, v252
    ds_write_b16 v226, v197 offset:1280
    ds_write2st64_b32 v228, v196, v198 offset0:4 offset1:6
    buffer_load_dwordx4 v[116:119], v229, s[8:11], s58 offen offset:1024 sc1
    v_lshrrev_b32 v55, 3, v48
    v_lshlrev_b32 v52, 4, v49
    ds_write2st64_b32 v228, v199, v200 offset0:7 offset1:8
    ds_write2st64_b32 v228, v201, v202 offset0:9 offset1:10
    buffer_load_dwordx4 v[120:123], v229, s[8:11], s58 offen offset:2048 sc1
    v_lshl_add_u32 v54, v55, 2, v48
    v_and_b32 v54, 7, v54
    ds_write_b16 v226, v203 offset:2816
    ds_write2st64_b32 v228, v204, v205 offset0:12 offset1:13
    buffer_load_dwordx4 v[124:127], v229, s[8:11], s58 offen offset:3072 sc1
    v_and_b32 v50, 7, v48
    v_mul_u32_u24 v50, 8224, v50
    ds_write2st64_b32 v228, v206, v207 offset0:14 offset1:15
    ds_write2st64_b32 v228, v208, v210 offset0:16 offset1:18
    s_add_u32 s58, s58, 4096
    buffer_load_dwordx4 v[144:147], v229, s[8:11], s58 offen offset:0 sc1
    v_mul_u32_u24 v51, 1536, v55
    v_add_u32 v50, v50, v51
    ds_write_b16 v226, v209 offset:4352
    ds_write2st64_b32 v228, v211, v212 offset0:19 offset1:20
    buffer_load_dwordx4 v[148:151], v229, s[8:11], s58 offen offset:1024 sc1
    v_add_u32 v222, v50, v52
    v_mul_u32_u24 v51, 8224, v54
    ds_write2st64_b32 v228, v213, v214 offset0:21 offset1:22
    ds_write2st64_b32 v228, v216, v217 offset0:24 offset1:25
    buffer_load_dwordx4 v[152:155], v229, s[8:11], s58 offen offset:2048 sc1
    v_add_u32 v232, v51, v52
    v_lshl_add_u32 v247, v55, 7, v232
    ds_write_b16 v226, v215 offset:5888
    ds_write2st64_b32 v228, v218, v219 offset0:26 offset1:27
    buffer_load_dwordx4 v[156:159], v229, s[8:11], s58 offen offset:3072 sc1
    v_mul_u32_u24 v51, 2080, v48
    s_mov_b32 s60, 65536
    ds_write_b32 v228, v220 offset:7168
    ds_write_b16 v226, v221 offset:7424
    s_add_u32 s58, s58, 4096
    buffer_load_dwordx4 v[160:163], v229, s[8:11], s58 offen offset:0 sc1
    v_add3_u32 v223, v51, v52, s60
    v_mul_u32_u24 v51, 2080, v54
    buffer_load_dwordx4 v[164:167], v229, s[8:11], s58 offen offset:1024 sc1
    s_mov_b32 s60, 132096
    v_add3_u32 v225, v51, v52, s60
    buffer_load_dwordx4 v[168:171], v229, s[8:11], s58 offen offset:2048 sc1
    v_lshl_add_u32 v248, v55, 7, v225
    s_lshl_b32 s60, s20, 5
    buffer_load_dwordx4 v[172:175], v229, s[8:11], s58 offen offset:3072 sc1
    v_lshl_add_u32 v49, v49, 3, s60
    s_mov_b32 s60, 65536
    v_add3_u32 v255, v51, v49, s60
    v_lshl_add_u32 v246, v55, 9, v255
    v_bfe_u32 v53, v48, 2, 1
    v_lshl_add_u32 v49, v53, 4, v49
    v_add_u32 v254, v50, v49
    s_and_b32 s64, s55, s28
    s_waitcnt lgkmcnt(0)
    s_barrier
    s_cmp_eq_u32 s64, 0
    s_cbranch_scc1 K2_MULTI
    s_setprio 3
    ds_read_b128 v[48:51], v222 offset:0
    ds_read_b128 v[52:55], v222 offset:64
    ds_read_b128 v[56:59], v222 offset:896
    ds_read_b128 v[60:63], v222 offset:960
    ds_read_b128 v[64:67], v223 offset:0
    ds_read_b128 v[68:71], v223 offset:64
    ds_read_b128 v[72:75], v223 offset:896
    ds_read_b128 v[76:79], v223 offset:960
    ds_read_b128 v[80:83], v222 offset:3072
    ds_read_b128 v[84:87], v222 offset:3136
    ds_read_b128 v[88:91], v222 offset:3968
    s_waitcnt vmcnt(19) lgkmcnt(9)
    v_mfma_f32_16x16x32_bf16 v[0:3], v[96:99], v[48:51], 0
    ds_read_b128 v[92:95], v222 offset:4032
    s_waitcnt vmcnt(18)
    v_mfma_f32_16x16x32_bf16 v[0:3], v[100:103], v[52:55], v[0:3]
    ds_read_b128 v[48:51], v223 offset:33280
    s_waitcnt vmcnt(17) lgkmcnt(9)
    v_mfma_f32_16x16x32_bf16 v[0:3], v[104:107], v[56:59], v[0:3]
    s_bfe_u32 s60, s20, 0x10002
    s_lshl_b32 s60, s60, 4
    ds_read_b128 v[52:55], v223 offset:33344
    s_waitcnt vmcnt(16)
    v_mfma_f32_16x16x32_bf16 v[0:3], v[108:111], v[60:63], v[0:3]
    s_add_u32 s59, s59, s60
    v_add_u32 v228, s59, v229
    ds_read_b128 v[56:59], v223 offset:34176
    s_waitcnt vmcnt(15) lgkmcnt(9)
    v_mfma_f32_16x16x32_bf16 v[0:3], v[128:131], v[64:67], v[0:3]
    s_mul_i32 s60, s20, 2080
    s_add_u32 s60, s60, 65536
    ds_read_b128 v[60:63], v223 offset:34240
    s_waitcnt vmcnt(14)
    v_mfma_f32_16x16x32_bf16 v[0:3], v[132:135], v[68:71], v[0:3]
    v_add_u32 v249, s60, v229
    s_mov_b32 s63, 0xbfb8aa3b
    ds_read_b128 v[64:67], v232 offset:6144
    s_waitcnt vmcnt(13) lgkmcnt(9)
    v_mfma_f32_16x16x32_bf16 v[0:3], v[136:139], v[72:75], v[0:3]
    s_add_u32 s40, s20, s21
    s_lshl_b32 s40, s40, 10
    ds_read_b128 v[68:71], v232 offset:6208
    s_waitcnt vmcnt(12)
    v_mfma_f32_16x16x32_bf16 v[0:3], v[140:143], v[76:79], v[0:3]
    s_add_u32 s41, s40, 8192
    s_add_u32 s42, s40, 16384
    ds_read_b128 v[72:75], v232 offset:7040
    s_waitcnt lgkmcnt(9)
    v_mfma_f32_16x16x32_bf16 v[16:19], v[96:99], v[80:83], 0
    s_add_u32 s43, s40, 24576
    s_add_u32 s44, s40, 32768
    ds_read_b128 v[76:79], v232 offset:7104
    v_mfma_f32_16x16x32_bf16 v[16:19], v[100:103], v[84:87], v[16:19]
    ds_read_b128 v[80:83], v225 offset:0
    s_waitcnt lgkmcnt(9)
    v_mfma_f32_16x16x32_bf16 v[16:19], v[104:107], v[88:91], v[16:19]
    ds_read_b128 v[84:87], v225 offset:64
    v_mfma_f32_16x16x32_bf16 v[16:19], v[108:111], v[92:95], v[16:19]
    v_mul_f32 v204, s63, v0
    v_mul_f32 v205, s63, v1
    ds_read_b128 v[88:91], v225 offset:896
    s_waitcnt lgkmcnt(9)
    v_mfma_f32_16x16x32_bf16 v[16:19], v[128:131], v[48:51], v[16:19]
    v_mul_f32 v206, s63, v2
    ds_read_b128 v[92:95], v225 offset:960
    v_mfma_f32_16x16x32_bf16 v[16:19], v[132:135], v[52:55], v[16:19]
    v_mul_f32 v207, s63, v3
    ds_read_b128 v[48:51], v222 offset:128
    s_waitcnt lgkmcnt(9)
    v_mfma_f32_16x16x32_bf16 v[16:19], v[136:139], v[56:59], v[16:19]
    v_exp_f32 v204, v204
    ds_read_b128 v[52:55], v222 offset:384
    v_mfma_f32_16x16x32_bf16 v[16:19], v[140:143], v[60:63], v[16:19]
    v_exp_f32 v205, v205
    ds_read_b128 v[56:59], v222 offset:256
    s_waitcnt lgkmcnt(9)
    v_mfma_f32_16x16x32_bf16 v[32:35], v[96:99], v[64:67], 0
    v_exp_f32 v206, v206
    ds_read_b128 v[60:63], v222 offset:192
    v_mfma_f32_16x16x32_bf16 v[32:35], v[100:103], v[68:71], v[32:35]
    v_exp_f32 v207, v207
    s_setprio 2
    ds_read_b128 v[64:67], v222 offset:448
    s_waitcnt lgkmcnt(9)
    v_mfma_f32_16x16x32_bf16 v[32:35], v[104:107], v[72:75], v[32:35]
    v_add_f32 v204, 1.0, v204
    ds_read_b128 v[68:71], v222 offset:320
    v_mfma_f32_16x16x32_bf16 v[32:35], v[108:111], v[76:79], v[32:35]
    v_add_f32 v205, 1.0, v205
    v_add_f32 v206, 1.0, v206
    ds_read_b128 v[72:75], v222 offset:640
    s_waitcnt lgkmcnt(9)
    v_mfma_f32_16x16x32_bf16 v[32:35], v[128:131], v[80:83], v[32:35]
    v_add_f32 v207, 1.0, v207
    ds_read_b128 v[76:79], v222 offset:512
    v_mfma_f32_16x16x32_bf16 v[32:35], v[132:135], v[84:87], v[32:35]
    v_rcp_f32 v204, v204
    ds_read_b128 v[80:83], v222 offset:768
    s_waitcnt lgkmcnt(9)
    v_mfma_f32_16x16x32_bf16 v[32:35], v[136:139], v[88:91], v[32:35]
    v_rcp_f32 v205, v205
    ds_read_b128 v[84:87], v222 offset:704
    v_mfma_f32_16x16x32_bf16 v[32:35], v[140:143], v[92:95], v[32:35]
    v_rcp_f32 v206, v206
    ds_read_b128 v[88:91], v222 offset:576
    s_waitcnt vmcnt(11) lgkmcnt(9)
    v_mfma_f32_16x16x32_bf16 v[4:7], v[112:115], v[48:51], 0
    v_rcp_f32 v207, v207
    ds_read_b128 v[92:95], v222 offset:832
    v_mfma_f32_16x16x32_bf16 v[8:11], v[112:115], v[52:55], 0
    v_cvt_pk_bf16_f32 v176, v0, v1
    ds_read_b128 v[48:51], v222 offset:1024
    s_waitcnt lgkmcnt(9)
    v_mfma_f32_16x16x32_bf16 v[12:15], v[112:115], v[56:59], 0
    v_cvt_pk_bf16_f32 v177, v2, v3
    ds_read_b128 v[52:55], v222 offset:1280
    s_waitcnt vmcnt(10)
    v_mfma_f32_16x16x32_bf16 v[4:7], v[116:119], v[60:63], v[4:7]
    v_mul_f32 v208, s63, v16
    v_mul_f32 v209, s63, v17
    ds_read_b128 v[56:59], v222 offset:1152
    s_waitcnt lgkmcnt(9)
    v_mfma_f32_16x16x32_bf16 v[8:11], v[116:119], v[64:67], v[8:11]
    v_mul_f32 v210, s63, v18
    ds_read_b128 v[60:63], v222 offset:1088
    v_mfma_f32_16x16x32_bf16 v[12:15], v[116:119], v[68:71], v[12:15]
    v_mul_f32 v211, s63, v19
    ds_read_b128 v[64:67], v222 offset:1344
    s_waitcnt vmcnt(9) lgkmcnt(9)
    v_mfma_f32_16x16x32_bf16 v[4:7], v[120:123], v[72:75], v[4:7]
    v_exp_f32 v208, v208
    ds_read_b128 v[68:71], v222 offset:1216
    v_mfma_f32_16x16x32_bf16 v[8:11], v[120:123], v[76:79], v[8:11]
    v_exp_f32 v209, v209
    ds_read_b128 v[72:75], v223 offset:128
    s_waitcnt lgkmcnt(9)
    v_mfma_f32_16x16x32_bf16 v[12:15], v[120:123], v[80:83], v[12:15]
    v_exp_f32 v210, v210
    ds_read_b128 v[76:79], v223 offset:384
    s_waitcnt vmcnt(8)
    v_mfma_f32_16x16x32_bf16 v[4:7], v[124:127], v[84:87], v[4:7]
    v_exp_f32 v211, v211
    ds_read_b128 v[80:83], v223 offset:256
    s_waitcnt lgkmcnt(9)
    v_mfma_f32_16x16x32_bf16 v[8:11], v[124:127], v[88:91], v[8:11]
    v_add_f32 v208, 1.0, v208
    ds_read_b128 v[84:87], v223 offset:192
    v_mfma_f32_16x16x32_bf16 v[12:15], v[124:127], v[92:95], v[12:15]
    v_add_f32 v209, 1.0, v209
    v_add_f32 v210, 1.0, v210
    ds_read_b128 v[88:91], v223 offset:448
    s_waitcnt vmcnt(7) lgkmcnt(9)
    v_mfma_f32_16x16x32_bf16 v[4:7], v[144:147], v[48:51], v[4:7]
    v_add_f32 v211, 1.0, v211
    s_setprio 1
    ds_read_b128 v[92:95], v223 offset:320
    v_mfma_f32_16x16x32_bf16 v[8:11], v[144:147], v[52:55], v[8:11]
    v_rcp_f32 v208, v208
    ds_read_b128 v[48:51], v223 offset:640
    s_waitcnt lgkmcnt(9)
    v_mfma_f32_16x16x32_bf16 v[12:15], v[144:147], v[56:59], v[12:15]
    v_rcp_f32 v209, v209
    ds_read_b128 v[52:55], v223 offset:512
    s_waitcnt vmcnt(6)
    v_mfma_f32_16x16x32_bf16 v[4:7], v[148:151], v[60:63], v[4:7]
    v_rcp_f32 v210, v210
    ds_read_b128 v[56:59], v223 offset:768
    s_waitcnt lgkmcnt(9)
    v_mfma_f32_16x16x32_bf16 v[8:11], v[148:151], v[64:67], v[8:11]
    v_rcp_f32 v211, v211
    ds_read_b128 v[60:63], v223 offset:704
    v_mfma_f32_16x16x32_bf16 v[12:15], v[148:151], v[68:71], v[12:15]
K2_PAD_T2:
    s_cbranch_execz K2_HOP
    v_cvt_pk_bf16_f32 v184, v16, v17
    ds_read_b128 v[64:67], v223 offset:576
    s_waitcnt vmcnt(5) lgkmcnt(9)
    v_mfma_f32_16x16x32_bf16 v[4:7], v[152:155], v[72:75], v[4:7]
    v_cvt_pk_bf16_f32 v185, v18, v19
    ds_read_b128 v[68:71], v223 offset:832
    v_mfma_f32_16x16x32_bf16 v[8:11], v[152:155], v[76:79], v[8:11]
    v_mul_f32 v212, s63, v32
    v_mul_f32 v213, s63, v33
    ds_read_b128 v[72:75], v223 offset:1024
    s_waitcnt lgkmcnt(9)
    v_mfma_f32_16x16x32_bf16 v[12:15], v[152:155], v[80:83], v[12:15]
    v_mul_f32 v214, s63, v34
    ds_read_b128 v[76:79], v223 offset:1280
    s_waitcnt vmcnt(4)
    v_mfma_f32_16x16x32_bf16 v[4:7], v[156:159], v[84:87], v[4:7]
    v_mul_f32 v215, s63, v35
    ds_read_b128 v[80:83], v223 offset:1152
    s_waitcnt lgkmcnt(9)
    v_mfma_f32_16x16x32_bf16 v[8:11], v[156:159], v[88:91], v[8:11]
    v_exp_f32 v212, v212
    ds_read_b128 v[84:87], v223 offset:1088
    v_mfma_f32_16x16x32_bf16 v[12:15], v[156:159], v[92:95], v[12:15]
    v_exp_f32 v213, v213
    ds_read_b128 v[88:91], v223 offset:1344
    s_waitcnt vmcnt(3) lgkmcnt(9)
    v_mfma_f32_16x16x32_bf16 v[4:7], v[160:163], v[48:51], v[4:7]
    v_exp_f32 v214, v214
    ds_read_b128 v[92:95], v223 offset:1216
    v_mfma_f32_16x16x32_bf16 v[8:11], v[160:163], v[52:55], v[8:11]
    v_exp_f32 v215, v215
    ds_read_b128 v[48:51], v222 offset:3200
    s_waitcnt lgkmcnt(9)
    v_mfma_f32_16x16x32_bf16 v[12:15], v[160:163], v[56:59], v[12:15]
    v_add_f32 v212, 1.0, v212
    ds_read_b128 v[52:55], v222 offset:3456
    s_waitcnt vmcnt(2)
    v_mfma_f32_16x16x32_bf16 v[4:7], v[164:167], v[60:63], v[4:7]
    v_add_f32 v213, 1.0, v213
    v_add_f32 v214, 1.0, v214
    ds_read_b128 v[56:59], v222 offset:3328
    s_waitcnt lgkmcnt(9)
    v_mfma_f32_16x16x32_bf16 v[8:11], v[164:167], v[64:67], v[8:11]
    v_add_f32 v215, 1.0, v215
    ds_read_b128 v[60:63], v222 offset:3264
    v_mfma_f32_16x16x32_bf16 v[12:15], v[164:167], v[68:71], v[12:15]
    v_rcp_f32 v212, v212
    s_setprio 0
    ds_read_b128 v[64:67], v222 offset:3520
    s_waitcnt vmcnt(1) lgkmcnt(9)
    v_mfma_f32_16x16x32_bf16 v[4:7], v[168:171], v[72:75], v[4:7]
    v_rcp_f32 v213, v213
    ds_read_b128 v[68:71], v222 offset:3392
    v_mfma_f32_16x16x32_bf16 v[8:11], v[168:171], v[76:79], v[8:11]
    v_rcp_f32 v214, v214
    ds_read_b128 v[72:75], v222 offset:3712
    s_waitcnt lgkmcnt(9)
    v_mfma_f32_16x16x32_bf16 v[12:15], v[168:171], v[80:83], v[12:15]
    v_rcp_f32 v215, v215
    ds_read_b128 v[76:79], v222 offset:3584
    s_waitcnt vmcnt(0)
    v_mfma_f32_16x16x32_bf16 v[4:7], v[172:175], v[84:87], v[4:7]
    v_cvt_pk_bf16_f32 v220, v32, v33
    ds_read_b128 v[80:83], v222 offset:3840
    s_waitcnt lgkmcnt(9)
    v_mfma_f32_16x16x32_bf16 v[8:11], v[172:175], v[88:91], v[8:11]
    v_cvt_pk_bf16_f32 v221, v34, v35
    ds_read_b128 v[84:87], v222 offset:3776
    v_mfma_f32_16x16x32_bf16 v[12:15], v[172:175], v[92:95], v[12:15]
    ds_read_b128 v[88:91], v222 offset:3648
    s_waitcnt lgkmcnt(9)
    v_mfma_f32_16x16x32_bf16 v[20:23], v[112:115], v[48:51], 0
    ds_read_b128 v[92:95], v222 offset:3904
    v_mfma_f32_16x16x32_bf16 v[24:27], v[112:115], v[52:55], 0
    ds_read_b128 v[48:51], v222 offset:4096
    s_waitcnt lgkmcnt(9)
    v_mfma_f32_16x16x32_bf16 v[28:31], v[112:115], v[56:59], 0
    s_barrier
    s_setprio 3
    ds_read_b128 v[52:55], v222 offset:4352
    v_mfma_f32_16x16x32_bf16 v[20:23], v[116:119], v[60:63], v[20:23]
    v_mul_f32 v4, v4, v204
    ds_read_b128 v[56:59], v222 offset:4224
    s_waitcnt lgkmcnt(9)
    v_mfma_f32_16x16x32_bf16 v[24:27], v[116:119], v[64:67], v[24:27]
    v_mul_f32 v5, v5, v205
    ds_read_b128 v[60:63], v222 offset:4160
    v_mfma_f32_16x16x32_bf16 v[28:31], v[116:119], v[68:71], v[28:31]
    v_mul_f32 v6, v6, v206
    ds_read_b128 v[64:67], v222 offset:4416
    s_waitcnt lgkmcnt(9)
    v_mfma_f32_16x16x32_bf16 v[20:23], v[120:123], v[72:75], v[20:23]
    v_mul_f32 v7, v7, v207
    ds_read_b128 v[68:71], v222 offset:4288
    v_mfma_f32_16x16x32_bf16 v[24:27], v[120:123], v[76:79], v[24:27]
    v_cvt_pk_bf16_f32 v178, v4, v5
    ds_read_b128 v[72:75], v223 offset:33408
    s_waitcnt lgkmcnt(9)
    v_mfma_f32_16x16x32_bf16 v[28:31], v[120:123], v[80:83], v[28:31]
    v_cvt_pk_bf16_f32 v179, v6, v7
    ds_read_b128 v[76:79], v223 offset:33664
    v_mfma_f32_16x16x32_bf16 v[20:23], v[124:127], v[84:87], v[20:23]
    v_mul_f32 v8, v8, v204
    ds_read_b128 v[80:83], v223 offset:33536
    s_waitcnt lgkmcnt(9)
    v_mfma_f32_16x16x32_bf16 v[24:27], v[124:127], v[88:91], v[24:27]
    v_mul_f32 v9, v9, v205
    ds_read_b128 v[84:87], v223 offset:33472
    v_mfma_f32_16x16x32_bf16 v[28:31], v[124:127], v[92:95], v[28:31]
    v_mul_f32 v10, v10, v206
    ds_read_b128 v[88:91], v223 offset:33728
    s_waitcnt lgkmcnt(9)
    v_mfma_f32_16x16x32_bf16 v[20:23], v[144:147], v[48:51], v[20:23]
    v_mul_f32 v11, v11, v207
    s_setprio 2
    ds_read_b128 v[92:95], v223 offset:33600
    v_mfma_f32_16x16x32_bf16 v[24:27], v[144:147], v[52:55], v[24:27]
    v_cvt_pk_bf16_f32 v180, v8, v9
    ds_read_b128 v[48:51], v223 offset:33920
    s_waitcnt lgkmcnt(9)
    v_mfma_f32_16x16x32_bf16 v[28:31], v[144:147], v[56:59], v[28:31]
    v_cvt_pk_bf16_f32 v181, v10, v11
    ds_read_b128 v[52:55], v223 offset:33792
    v_mfma_f32_16x16x32_bf16 v[20:23], v[148:151], v[60:63], v[20:23]
    v_mul_f32 v12, v12, v204
    ds_read_b128 v[56:59], v223 offset:34048
    s_waitcnt lgkmcnt(9)
    v_mfma_f32_16x16x32_bf16 v[24:27], v[148:151], v[64:67], v[24:27]
    v_mul_f32 v13, v13, v205
    ds_read_b128 v[60:63], v223 offset:33984
    v_mfma_f32_16x16x32_bf16 v[28:31], v[148:151], v[68:71], v[28:31]
    v_mul_f32 v14, v14, v206
    ds_read_b128 v[64:67], v223 offset:33856
    s_waitcnt lgkmcnt(9)
    v_mfma_f32_16x16x32_bf16 v[20:23], v[152:155], v[72:75], v[20:23]
    v_mul_f32 v15, v15, v207
    ds_read_b128 v[68:71], v223 offset:34112
    v_mfma_f32_16x16x32_bf16 v[24:27], v[152:155], v[76:79], v[24:27]
    v_cvt_pk_bf16_f32 v182, v12, v13
    ds_read_b128 v[72:75], v223 offset:34304
    s_waitcnt lgkmcnt(9)
    v_mfma_f32_16x16x32_bf16 v[28:31], v[152:155], v[80:83], v[28:31]
    v_cvt_pk_bf16_f32 v183, v14, v15
    ds_read_b128 v[76:79], v223 offset:34560
    v_mfma_f32_16x16x32_bf16 v[20:23], v[156:159], v[84:87], v[20:23]
    ds_write_b64 v254, v[176:177] offset:0
    ds_write_b64 v254, v[178:179] offset:256
    ds_write_b64 v254, v[180:181] offset:512
    ds_write_b64 v254, v[182:183] offset:768
    ds_write_b64 v255, v[220:221] offset:0
    ds_read_b128 v[80:83], v223 offset:34432
    s_waitcnt lgkmcnt(14)
    v_mfma_f32_16x16x32_bf16 v[24:27], v[156:159], v[88:91], v[24:27]
    ds_read_b128 v[84:87], v223 offset:34368
    v_mfma_f32_16x16x32_bf16 v[28:31], v[156:159], v[92:95], v[28:31]
    s_setprio 1
    ds_read_b128 v[88:91], v223 offset:34624
    s_waitcnt lgkmcnt(14)
    v_mfma_f32_16x16x32_bf16 v[20:23], v[160:163], v[48:51], v[20:23]
    ds_read_b128 v[92:95], v223 offset:34496
    v_mfma_f32_16x16x32_bf16 v[24:27], v[160:163], v[52:55], v[24:27]
    ds_read_b128 v[48:51], v247 offset:6272
    s_waitcnt lgkmcnt(14)
    v_mfma_f32_16x16x32_bf16 v[28:31], v[160:163], v[56:59], v[28:31]
    ds_read_b128 v[52:55], v232 offset:6528
    v_mfma_f32_16x16x32_bf16 v[20:23], v[164:167], v[60:63], v[20:23]
    ds_read_b128 v[56:59], v247 offset:6336
    s_waitcnt lgkmcnt(14)
    v_mfma_f32_16x16x32_bf16 v[24:27], v[164:167], v[64:67], v[24:27]
    ds_read_b128 v[60:63], v232 offset:6592
    v_mfma_f32_16x16x32_bf16 v[28:31], v[164:167], v[68:71], v[28:31]
    ds_read_b128 v[64:67], v247 offset:6784
    s_waitcnt lgkmcnt(14)
    v_mfma_f32_16x16x32_bf16 v[20:23], v[168:171], v[72:75], v[20:23]
    ds_read_b128 v[68:71], v232 offset:6656
    v_mfma_f32_16x16x32_bf16 v[24:27], v[168:171], v[76:79], v[24:27]
    ds_read_b128 v[72:75], v247 offset:6848
    s_waitcnt lgkmcnt(9)
    v_mfma_f32_16x16x32_bf16 v[28:31], v[168:171], v[80:83], v[28:31]
    ds_read_b128 v[76:79], v232 offset:6720
    v_mfma_f32_16x16x32_bf16 v[20:23], v[172:175], v[84:87], v[20:23]
    s_setprio 0
    ds_read_b128 v[80:83], v247 offset:7168
    s_waitcnt lgkmcnt(9)
    v_mfma_f32_16x16x32_bf16 v[24:27], v[172:175], v[88:91], v[24:27]
    ds_read_b128 v[84:87], v232 offset:7424
    v_mfma_f32_16x16x32_bf16 v[28:31], v[172:175], v[92:95], v[28:31]
    ds_read_b128 v[88:91], v247 offset:7232
    s_waitcnt lgkmcnt(9)
    v_mfma_f32_16x16x32_bf16 v[36:39], v[112:115], v[48:51], 0
    ds_read_b128 v[92:95], v232 offset:7488
    v_mfma_f32_16x16x32_bf16 v[40:43], v[112:115], v[52:55], 0
    ds_read_b128 v[48:51], v248 offset:128
    s_waitcnt lgkmcnt(9)
    v_mfma_f32_16x16x32_bf16 v[36:39], v[116:119], v[56:59], v[36:39]
    s_barrier
    ds_read_b128 v[192:195], v228 offset:0
    ds_read_b128 v[196:199], v228 offset:1536
    s_setprio 3
    ds_read_b128 v[52:55], v225 offset:384
    v_mfma_f32_16x16x32_bf16 v[40:43], v[116:119], v[60:63], v[40:43]
    v_mul_f32 v20, v20, v208
    v_mul_f32 v21, v21, v209
    ds_read_b128 v[56:59], v248 offset:192
    s_waitcnt lgkmcnt(11)
    v_mfma_f32_16x16x32_bf16 v[36:39], v[120:123], v[64:67], v[36:39]
    v_mul_f32 v22, v22, v210
    ds_read_b128 v[60:63], v225 offset:448
    v_mfma_f32_16x16x32_bf16 v[40:43], v[120:123], v[68:71], v[40:43]
    v_mul_f32 v23, v23, v211
    ds_read_b128 v[64:67], v248 offset:640
    s_waitcnt lgkmcnt(11)
    v_mfma_f32_16x16x32_bf16 v[36:39], v[124:127], v[72:75], v[36:39]
    v_cvt_pk_bf16_f32 v186, v20, v21
    ds_read_b128 v[68:71], v225 offset:512
    v_mfma_f32_16x16x32_bf16 v[40:43], v[124:127], v[76:79], v[40:43]
    v_cvt_pk_bf16_f32 v187, v22, v23
    ds_read_b128 v[72:75], v248 offset:704
    s_waitcnt lgkmcnt(11)
    v_mfma_f32_16x16x32_bf16 v[36:39], v[144:147], v[80:83], v[36:39]
    v_mul_f32 v24, v24, v208
    v_mul_f32 v25, v25, v209
    s_waitcnt lgkmcnt(6)
    buffer_store_dwordx4 v[192:195], v229, s[12:15], s40 offen sc1
    buffer_store_dwordx4 v[196:199], v229, s[12:15], s41 offen sc1
    s_setprio 2
    ds_read_b128 v[76:79], v225 offset:576
    v_mfma_f32_16x16x32_bf16 v[40:43], v[144:147], v[84:87], v[40:43]
    v_mul_f32 v26, v26, v210
    ds_read_b128 v[80:83], v248 offset:1024
    v_mfma_f32_16x16x32_bf16 v[36:39], v[148:151], v[88:91], v[36:39]
    v_mul_f32 v27, v27, v211
    ds_read_b128 v[84:87], v225 offset:1280
    v_mfma_f32_16x16x32_bf16 v[40:43], v[148:151], v[92:95], v[40:43]
    v_cvt_pk_bf16_f32 v188, v24, v25
    ds_read_b128 v[88:91], v248 offset:1088
    s_waitcnt lgkmcnt(9)
    v_mfma_f32_16x16x32_bf16 v[36:39], v[152:155], v[48:51], v[36:39]
    v_cvt_pk_bf16_f32 v189, v26, v27
    ds_read_b128 v[92:95], v225 offset:1344
    v_mfma_f32_16x16x32_bf16 v[40:43], v[152:155], v[52:55], v[40:43]
    v_mul_f32 v28, v28, v208
    v_mul_f32 v29, v29, v209
    s_waitcnt lgkmcnt(8)
    v_mfma_f32_16x16x32_bf16 v[36:39], v[156:159], v[56:59], v[36:39]
    v_mul_f32 v30, v30, v210
    v_mfma_f32_16x16x32_bf16 v[40:43], v[156:159], v[60:63], v[40:43]
    v_mul_f32 v31, v31, v211
    s_setprio 1
    s_waitcnt lgkmcnt(6)
    v_mfma_f32_16x16x32_bf16 v[36:39], v[160:163], v[64:67], v[36:39]
    v_cvt_pk_bf16_f32 v190, v28, v29
    v_mfma_f32_16x16x32_bf16 v[40:43], v[160:163], v[68:71], v[40:43]
    v_cvt_pk_bf16_f32 v191, v30, v31
    s_waitcnt lgkmcnt(4)
    v_mfma_f32_16x16x32_bf16 v[36:39], v[164:167], v[72:75], v[36:39]
    ds_write_b64 v254, v[184:185] offset:3072
    ds_write_b64 v254, v[186:187] offset:3328
    ds_write_b64 v254, v[188:189] offset:3584
    ds_write_b64 v254, v[190:191] offset:3840
    v_mfma_f32_16x16x32_bf16 v[40:43], v[164:167], v[76:79], v[40:43]
    s_waitcnt lgkmcnt(6)
    v_mfma_f32_16x16x32_bf16 v[36:39], v[168:171], v[80:83], v[36:39]
    v_mfma_f32_16x16x32_bf16 v[40:43], v[168:171], v[84:87], v[40:43]
    s_setprio 0
    s_waitcnt lgkmcnt(4)
    v_mfma_f32_16x16x32_bf16 v[36:39], v[172:175], v[88:91], v[36:39]
    v_mfma_f32_16x16x32_bf16 v[40:43], v[172:175], v[92:95], v[40:43]
    s_nop 6
    v_mul_f32 v36, v36, v212
    v_mul_f32 v37, v37, v213
    v_mul_f32 v38, v38, v214
    v_mul_f32 v39, v39, v215
    v_cvt_pk_bf16_f32 v178, v36, v37
    v_cvt_pk_bf16_f32 v179, v38, v39
    v_mul_f32 v40, v40, v212
    v_mul_f32 v41, v41, v213
    v_mul_f32 v42, v42, v214
    v_mul_f32 v43, v43, v215
    v_cvt_pk_bf16_f32 v180, v40, v41
    v_cvt_pk_bf16_f32 v181, v42, v43
    ds_write_b64 v246, v[178:179] offset:256
    ds_write_b64 v255, v[180:181] offset:512
    s_waitcnt lgkmcnt(0)
    s_barrier
    ds_read_b128 v[192:195], v228 offset:3072
    ds_read_b128 v[196:199], v228 offset:4608
    ds_read_b128 v[200:203], v249
    s_waitcnt lgkmcnt(1)
    buffer_store_dwordx4 v[192:195], v229, s[12:15], s42 offen sc1
    buffer_store_dwordx4 v[196:199], v229, s[12:15], s43 offen sc1
K2_LASTROW:
    s_add_u32 s59, s20, 32
    s_cmp_ge_u32 s59, s22
    s_cbranch_scc1 K2_FIN
    s_waitcnt lgkmcnt(0)
    buffer_store_dwordx4 v[200:203], v229, s[12:15], s44 offen sc1
K2_FIN:
    s_endpgm
K2_MULTI:
    ds_read_b128 v[48:51], v222 offset:0
    ds_read_b128 v[52:55], v222 offset:64
    ds_read_b128 v[56:59], v222 offset:896
    ds_read_b128 v[60:63], v222 offset:960
    ds_read_b128 v[64:67], v223 offset:0
    ds_read_b128 v[68:71], v223 offset:64
    ds_read_b128 v[72:75], v223 offset:896
    ds_read_b128 v[76:79], v223 offset:960
    ds_read_b128 v[80:83], v222 offset:3072
    ds_read_b128 v[84:87], v222 offset:3136
    ds_read_b128 v[88:91], v222 offset:3968
    s_waitcnt vmcnt(19) lgkmcnt(9)
    v_mfma_f32_16x16x32_bf16 v[0:3], v[96:99], v[48:51], 0
    ds_read_b128 v[92:95], v222 offset:4032
    s_waitcnt vmcnt(18)
    v_mfma_f32_16x16x32_bf16 v[0:3], v[100:103], v[52:55], v[0:3]
    ds_read_b128 v[48:51], v223 offset:33280
    s_waitcnt vmcnt(17) lgkmcnt(9)
    v_mfma_f32_16x16x32_bf16 v[0:3], v[104:107], v[56:59], v[0:3]
    ds_read_b128 v[52:55], v223 offset:33344
    s_waitcnt vmcnt(16)
    v_mfma_f32_16x16x32_bf16 v[0:3], v[108:111], v[60:63], v[0:3]
    ds_read_b128 v[56:59], v223 offset:34176
    s_waitcnt vmcnt(15) lgkmcnt(9)
    v_mfma_f32_16x16x32_bf16 v[0:3], v[128:131], v[64:67], v[0:3]
    ds_read_b128 v[60:63], v223 offset:34240
    s_waitcnt vmcnt(14)
    v_mfma_f32_16x16x32_bf16 v[0:3], v[132:135], v[68:71], v[0:3]
    ds_read_b128 v[64:67], v232 offset:6144
    s_waitcnt vmcnt(13) lgkmcnt(9)
    v_mfma_f32_16x16x32_bf16 v[0:3], v[136:139], v[72:75], v[0:3]
    ds_read_b128 v[68:71], v232 offset:6208
    s_waitcnt vmcnt(12)
    v_mfma_f32_16x16x32_bf16 v[0:3], v[140:143], v[76:79], v[0:3]
    ds_read_b128 v[72:75], v232 offset:7040
    s_waitcnt lgkmcnt(9)
    v_mfma_f32_16x16x32_bf16 v[16:19], v[96:99], v[80:83], 0
    ds_read_b128 v[76:79], v232 offset:7104
    v_mfma_f32_16x16x32_bf16 v[16:19], v[100:103], v[84:87], v[16:19]
    ds_read_b128 v[80:83], v225 offset:0
    s_waitcnt lgkmcnt(9)
    v_mfma_f32_16x16x32_bf16 v[16:19], v[104:107], v[88:91], v[16:19]
    ds_read_b128 v[84:87], v225 offset:64
    v_mfma_f32_16x16x32_bf16 v[16:19], v[108:111], v[92:95], v[16:19]
    ds_read_b128 v[88:91], v225 offset:896
    s_waitcnt lgkmcnt(9)
    v_mfma_f32_16x16x32_bf16 v[16:19], v[128:131], v[48:51], v[16:19]
    ds_read_b128 v[92:95], v225 offset:960
    v_mfma_f32_16x16x32_bf16 v[16:19], v[132:135], v[52:55], v[16:19]
    ds_read_b128 v[48:51], v222 offset:128
    s_waitcnt lgkmcnt(9)
    v_mfma_f32_16x16x32_bf16 v[16:19], v[136:139], v[56:59], v[16:19]
    ds_read_b128 v[52:55], v222 offset:384
    v_mfma_f32_16x16x32_bf16 v[16:19], v[140:143], v[60:63], v[16:19]
    ds_read_b128 v[56:59], v222 offset:256
    s_waitcnt lgkmcnt(9)
    v_mfma_f32_16x16x32_bf16 v[32:35], v[96:99], v[64:67], 0
    ds_read_b128 v[60:63], v222 offset:192
    v_mfma_f32_16x16x32_bf16 v[32:35], v[100:103], v[68:71], v[32:35]
    ds_read_b128 v[64:67], v222 offset:448
    s_waitcnt lgkmcnt(9)
    v_mfma_f32_16x16x32_bf16 v[32:35], v[104:107], v[72:75], v[32:35]
    ds_read_b128 v[68:71], v222 offset:320
    v_mfma_f32_16x16x32_bf16 v[32:35], v[108:111], v[76:79], v[32:35]
    ds_read_b128 v[72:75], v222 offset:640
    s_waitcnt lgkmcnt(9)
    v_mfma_f32_16x16x32_bf16 v[32:35], v[128:131], v[80:83], v[32:35]
    ds_read_b128 v[76:79], v222 offset:512
    v_mfma_f32_16x16x32_bf16 v[32:35], v[132:135], v[84:87], v[32:35]
    ds_read_b128 v[80:83], v222 offset:768
    s_waitcnt lgkmcnt(9)
    v_mfma_f32_16x16x32_bf16 v[32:35], v[136:139], v[88:91], v[32:35]
    ds_read_b128 v[84:87], v222 offset:704
    v_mfma_f32_16x16x32_bf16 v[32:35], v[140:143], v[92:95], v[32:35]
    ds_read_b128 v[88:91], v222 offset:576
    s_waitcnt vmcnt(11) lgkmcnt(9)
    v_mfma_f32_16x16x32_bf16 v[4:7], v[112:115], v[48:51], 0
    ds_read_b128 v[92:95], v222 offset:832
    v_mfma_f32_16x16x32_bf16 v[8:11], v[112:115], v[52:55], 0
    ds_read_b128 v[48:51], v222 offset:1024
    s_waitcnt lgkmcnt(9)
    v_mfma_f32_16x16x32_bf16 v[12:15], v[112:115], v[56:59], 0
    ds_read_b128 v[52:55], v222 offset:1280
    s_waitcnt vmcnt(10)
    v_mfma_f32_16x16x32_bf16 v[4:7], v[116:119], v[60:63], v[4:7]
    ds_read_b128 v[56:59], v222 offset:1152
    s_waitcnt lgkmcnt(9)
    v_mfma_f32_16x16x32_bf16 v[8:11], v[116:119], v[64:67], v[8:11]
    ds_read_b128 v[60:63], v222 offset:1088
    v_mfma_f32_16x16x32_bf16 v[12:15], v[116:119], v[68:71], v[12:15]
    ds_read_b128 v[64:67], v222 offset:1344
    s_waitcnt vmcnt(9) lgkmcnt(9)
    v_mfma_f32_16x16x32_bf16 v[4:7], v[120:123], v[72:75], v[4:7]
    ds_read_b128 v[68:71], v222 offset:1216
    v_mfma_f32_16x16x32_bf16 v[8:11], v[120:123], v[76:79], v[8:11]
    ds_read_b128 v[72:75], v223 offset:128
    s_waitcnt lgkmcnt(9)
    v_mfma_f32_16x16x32_bf16 v[12:15], v[120:123], v[80:83], v[12:15]
    ds_read_b128 v[76:79], v223 offset:384
    s_waitcnt vmcnt(8)
    v_mfma_f32_16x16x32_bf16 v[4:7], v[124:127], v[84:87], v[4:7]
    ds_read_b128 v[80:83], v223 offset:256
    s_waitcnt lgkmcnt(9)
    v_mfma_f32_16x16x32_bf16 v[8:11], v[124:127], v[88:91], v[8:11]
    ds_read_b128 v[84:87], v223 offset:192
    v_mfma_f32_16x16x32_bf16 v[12:15], v[124:127], v[92:95], v[12:15]
    ds_read_b128 v[88:91], v223 offset:448
    s_waitcnt vmcnt(7) lgkmcnt(9)
    v_mfma_f32_16x16x32_bf16 v[4:7], v[144:147], v[48:51], v[4:7]
    ds_read_b128 v[92:95], v223 offset:320
    v_mfma_f32_16x16x32_bf16 v[8:11], v[144:147], v[52:55], v[8:11]
    ds_read_b128 v[48:51], v223 offset:640
    s_waitcnt lgkmcnt(9)
    v_mfma_f32_16x16x32_bf16 v[12:15], v[144:147], v[56:59], v[12:15]
    ds_read_b128 v[52:55], v223 offset:512
    s_waitcnt vmcnt(6)
    v_mfma_f32_16x16x32_bf16 v[4:7], v[148:151], v[60:63], v[4:7]
    ds_read_b128 v[56:59], v223 offset:768
    s_waitcnt lgkmcnt(9)
    v_mfma_f32_16x16x32_bf16 v[8:11], v[148:151], v[64:67], v[8:11]
    ds_read_b128 v[60:63], v223 offset:704
    v_mfma_f32_16x16x32_bf16 v[12:15], v[148:151], v[68:71], v[12:15]
    ds_read_b128 v[64:67], v223 offset:576
    s_waitcnt vmcnt(5) lgkmcnt(9)
    v_mfma_f32_16x16x32_bf16 v[4:7], v[152:155], v[72:75], v[4:7]
    ds_read_b128 v[68:71], v223 offset:832
    v_mfma_f32_16x16x32_bf16 v[8:11], v[152:155], v[76:79], v[8:11]
    ds_read_b128 v[72:75], v223 offset:1024
    s_waitcnt lgkmcnt(9)
    v_mfma_f32_16x16x32_bf16 v[12:15], v[152:155], v[80:83], v[12:15]
    ds_read_b128 v[76:79], v223 offset:1280
    s_waitcnt vmcnt(4)
    v_mfma_f32_16x16x32_bf16 v[4:7], v[156:159], v[84:87], v[4:7]
    ds_read_b128 v[80:83], v223 offset:1152
    s_waitcnt lgkmcnt(9)
    v_mfma_f32_16x16x32_bf16 v[8:11], v[156:159], v[88:91], v[8:11]
    ds_read_b128 v[84:87], v223 offset:1088
    v_mfma_f32_16x16x32_bf16 v[12:15], v[156:159], v[92:95], v[12:15]
    ds_read_b128 v[88:91], v223 offset:1344
    s_waitcnt vmcnt(3) lgkmcnt(9)
    v_mfma_f32_16x16x32_bf16 v[4:7], v[160:163], v[48:51], v[4:7]
    ds_read_b128 v[92:95], v223 offset:1216
    v_mfma_f32_16x16x32_bf16 v[8:11], v[160:163], v[52:55], v[8:11]
    ds_read_b128 v[48:51], v222 offset:3200
    s_waitcnt lgkmcnt(9)
    v_mfma_f32_16x16x32_bf16 v[12:15], v[160:163], v[56:59], v[12:15]
    ds_read_b128 v[52:55], v222 offset:3456
    s_waitcnt vmcnt(2)
    v_mfma_f32_16x16x32_bf16 v[4:7], v[164:167], v[60:63], v[4:7]
    ds_read_b128 v[56:59], v222 offset:3328
    s_waitcnt lgkmcnt(9)
    v_mfma_f32_16x16x32_bf16 v[8:11], v[164:167], v[64:67], v[8:11]
    ds_read_b128 v[60:63], v222 offset:3264
    v_mfma_f32_16x16x32_bf16 v[12:15], v[164:167], v[68:71], v[12:15]
    ds_read_b128 v[64:67], v222 offset:3520
    s_waitcnt vmcnt(1) lgkmcnt(9)
    v_mfma_f32_16x16x32_bf16 v[4:7], v[168:171], v[72:75], v[4:7]
    ds_read_b128 v[68:71], v222 offset:3392
    v_mfma_f32_16x16x32_bf16 v[8:11], v[168:171], v[76:79], v[8:11]
    ds_read_b128 v[72:75], v222 offset:3712
    s_waitcnt lgkmcnt(9)
    v_mfma_f32_16x16x32_bf16 v[12:15], v[168:171], v[80:83], v[12:15]
    ds_read_b128 v[76:79], v222 offset:3584
    s_waitcnt vmcnt(0)
    v_mfma_f32_16x16x32_bf16 v[4:7], v[172:175], v[84:87], v[4:7]
    ds_read_b128 v[80:83], v222 offset:3840
    s_waitcnt lgkmcnt(9)
    v_mfma_f32_16x16x32_bf16 v[8:11], v[172:175], v[88:91], v[8:11]
    ds_read_b128 v[84:87], v222 offset:3776
    v_mfma_f32_16x16x32_bf16 v[12:15], v[172:175], v[92:95], v[12:15]
    ds_read_b128 v[88:91], v222 offset:3648
    s_waitcnt lgkmcnt(9)
    v_mfma_f32_16x16x32_bf16 v[20:23], v[112:115], v[48:51], 0
    ds_read_b128 v[92:95], v222 offset:3904
    v_mfma_f32_16x16x32_bf16 v[24:27], v[112:115], v[52:55], 0
    ds_read_b128 v[48:51], v222 offset:4096
    s_waitcnt lgkmcnt(9)
    v_mfma_f32_16x16x32_bf16 v[28:31], v[112:115], v[56:59], 0
    ds_read_b128 v[52:55], v222 offset:4352
    v_mfma_f32_16x16x32_bf16 v[20:23], v[116:119], v[60:63], v[20:23]
    ds_read_b128 v[56:59], v222 offset:4224
    s_waitcnt lgkmcnt(9)
    v_mfma_f32_16x16x32_bf16 v[24:27], v[116:119], v[64:67], v[24:27]
    ds_read_b128 v[60:63], v222 offset:4160
    v_mfma_f32_16x16x32_bf16 v[28:31], v[116:119], v[68:71], v[28:31]
    ds_read_b128 v[64:67], v222 offset:4416
    s_waitcnt lgkmcnt(9)
    v_mfma_f32_16x16x32_bf16 v[20:23], v[120:123], v[72:75], v[20:23]
    ds_read_b128 v[68:71], v222 offset:4288
    v_mfma_f32_16x16x32_bf16 v[24:27], v[120:123], v[76:79], v[24:27]
    ds_read_b128 v[72:75], v223 offset:33408
    s_waitcnt lgkmcnt(9)
    v_mfma_f32_16x16x32_bf16 v[28:31], v[120:123], v[80:83], v[28:31]
    ds_read_b128 v[76:79], v223 offset:33664
    v_mfma_f32_16x16x32_bf16 v[20:23], v[124:127], v[84:87], v[20:23]
    ds_read_b128 v[80:83], v223 offset:33536
    s_waitcnt lgkmcnt(9)
    v_mfma_f32_16x16x32_bf16 v[24:27], v[124:127], v[88:91], v[24:27]
    ds_read_b128 v[84:87], v223 offset:33472
    v_mfma_f32_16x16x32_bf16 v[28:31], v[124:127], v[92:95], v[28:31]
    ds_read_b128 v[88:91], v223 offset:33728
    s_waitcnt lgkmcnt(9)
    v_mfma_f32_16x16x32_bf16 v[20:23], v[144:147], v[48:51], v[20:23]
    ds_read_b128 v[92:95], v223 offset:33600
    v_mfma_f32_16x16x32_bf16 v[24:27], v[144:147], v[52:55], v[24:27]
    ds_read_b128 v[48:51], v223 offset:33920
    s_waitcnt lgkmcnt(9)
    v_mfma_f32_16x16x32_bf16 v[28:31], v[144:147], v[56:59], v[28:31]
    ds_read_b128 v[52:55], v223 offset:33792
    v_mfma_f32_16x16x32_bf16 v[20:23], v[148:151], v[60:63], v[20:23]
    ds_read_b128 v[56:59], v223 offset:34048
    s_waitcnt lgkmcnt(9)
    v_mfma_f32_16x16x32_bf16 v[24:27], v[148:151], v[64:67], v[24:27]
    ds_read_b128 v[60:63], v223 offset:33984
    v_mfma_f32_16x16x32_bf16 v[28:31], v[148:151], v[68:71], v[28:31]
    ds_read_b128 v[64:67], v223 offset:33856
    s_waitcnt lgkmcnt(9)
    v_mfma_f32_16x16x32_bf16 v[20:23], v[152:155], v[72:75], v[20:23]
    ds_read_b128 v[68:71], v223 offset:34112
    v_mfma_f32_16x16x32_bf16 v[24:27], v[152:155], v[76:79], v[24:27]
    ds_read_b128 v[72:75], v223 offset:34304
    s_waitcnt lgkmcnt(9)
    v_mfma_f32_16x16x32_bf16 v[28:31], v[152:155], v[80:83], v[28:31]
    ds_read_b128 v[76:79], v223 offset:34560
    v_mfma_f32_16x16x32_bf16 v[20:23], v[156:159], v[84:87], v[20:23]
    ds_read_b128 v[80:83], v223 offset:34432
    s_waitcnt lgkmcnt(9)
    v_mfma_f32_16x16x32_bf16 v[24:27], v[156:159], v[88:91], v[24:27]
    ds_read_b128 v[84:87], v223 offset:34368
    v_mfma_f32_16x16x32_bf16 v[28:31], v[156:159], v[92:95], v[28:31]
    ds_read_b128 v[88:91], v223 offset:34624
    s_waitcnt lgkmcnt(9)
    v_mfma_f32_16x16x32_bf16 v[20:23], v[160:163], v[48:51], v[20:23]
    ds_read_b128 v[92:95], v223 offset:34496
    v_mfma_f32_16x16x32_bf16 v[24:27], v[160:163], v[52:55], v[24:27]
    ds_read_b128 v[48:51], v247 offset:6272
    s_waitcnt lgkmcnt(9)
    v_mfma_f32_16x16x32_bf16 v[28:31], v[160:163], v[56:59], v[28:31]
    ds_read_b128 v[52:55], v232 offset:6528
    v_mfma_f32_16x16x32_bf16 v[20:23], v[164:167], v[60:63], v[20:23]
    ds_read_b128 v[56:59], v247 offset:6336
    s_waitcnt lgkmcnt(9)
    v_mfma_f32_16x16x32_bf16 v[24:27], v[164:167], v[64:67], v[24:27]
    ds_read_b128 v[60:63], v232 offset:6592
    v_mfma_f32_16x16x32_bf16 v[28:31], v[164:167], v[68:71], v[28:31]
    ds_read_b128 v[64:67], v247 offset:6784
    s_waitcnt lgkmcnt(9)
    v_mfma_f32_16x16x32_bf16 v[20:23], v[168:171], v[72:75], v[20:23]
    ds_read_b128 v[68:71], v232 offset:6656
    v_mfma_f32_16x16x32_bf16 v[24:27], v[168:171], v[76:79], v[24:27]
    ds_read_b128 v[72:75], v247 offset:6848
    s_waitcnt lgkmcnt(9)
    v_mfma_f32_16x16x32_bf16 v[28:31], v[168:171], v[80:83], v[28:31]
    ds_read_b128 v[76:79], v232 offset:6720
    v_mfma_f32_16x16x32_bf16 v[20:23], v[172:175], v[84:87], v[20:23]
    ds_read_b128 v[80:83], v247 offset:7168
    s_waitcnt lgkmcnt(9)
    v_mfma_f32_16x16x32_bf16 v[24:27], v[172:175], v[88:91], v[24:27]
    ds_read_b128 v[84:87], v232 offset:7424
    v_mfma_f32_16x16x32_bf16 v[28:31], v[172:175], v[92:95], v[28:31]
    ds_read_b128 v[88:91], v247 offset:7232
    s_waitcnt lgkmcnt(9)
    v_mfma_f32_16x16x32_bf16 v[36:39], v[112:115], v[48:51], 0
    ds_read_b128 v[92:95], v232 offset:7488
    v_mfma_f32_16x16x32_bf16 v[40:43], v[112:115], v[52:55], 0
    ds_read_b128 v[48:51], v248 offset:128
    s_waitcnt lgkmcnt(9)
    v_mfma_f32_16x16x32_bf16 v[36:39], v[116:119], v[56:59], v[36:39]
    ds_read_b128 v[52:55], v225 offset:384
    v_mfma_f32_16x16x32_bf16 v[40:43], v[116:119], v[60:63], v[40:43]
    ds_read_b128 v[56:59], v248 offset:192
    s_waitcnt lgkmcnt(9)
    v_mfma_f32_16x16x32_bf16 v[36:39], v[120:123], v[64:67], v[36:39]
    ds_read_b128 v[60:63], v225 offset:448
    v_mfma_f32_16x16x32_bf16 v[40:43], v[120:123], v[68:71], v[40:43]
    ds_read_b128 v[64:67], v248 offset:640
    s_waitcnt lgkmcnt(9)
    v_mfma_f32_16x16x32_bf16 v[36:39], v[124:127], v[72:75], v[36:39]
    ds_read_b128 v[68:71], v225 offset:512
    v_mfma_f32_16x16x32_bf16 v[40:43], v[124:127], v[76:79], v[40:43]
    ds_read_b128 v[72:75], v248 offset:704
    s_waitcnt lgkmcnt(9)
    v_mfma_f32_16x16x32_bf16 v[36:39], v[144:147], v[80:83], v[36:39]
    ds_read_b128 v[76:79], v225 offset:576
    v_mfma_f32_16x16x32_bf16 v[40:43], v[144:147], v[84:87], v[40:43]
    ds_read_b128 v[80:83], v248 offset:1024
    s_waitcnt lgkmcnt(9)
    v_mfma_f32_16x16x32_bf16 v[36:39], v[148:151], v[88:91], v[36:39]
    ds_read_b128 v[84:87], v225 offset:1280
    v_mfma_f32_16x16x32_bf16 v[40:43], v[148:151], v[92:95], v[40:43]
    ds_read_b128 v[88:91], v248 offset:1088
    s_waitcnt lgkmcnt(9)
    v_mfma_f32_16x16x32_bf16 v[36:39], v[152:155], v[48:51], v[36:39]
    ds_read_b128 v[92:95], v225 offset:1344
    v_mfma_f32_16x16x32_bf16 v[40:43], v[152:155], v[52:55], v[40:43]
    s_waitcnt lgkmcnt(8)
    v_mfma_f32_16x16x32_bf16 v[36:39], v[156:159], v[56:59], v[36:39]
    v_mfma_f32_16x16x32_bf16 v[40:43], v[156:159], v[60:63], v[40:43]
    s_waitcnt lgkmcnt(6)
    v_mfma_f32_16x16x32_bf16 v[36:39], v[160:163], v[64:67], v[36:39]
    v_mfma_f32_16x16x32_bf16 v[40:43], v[160:163], v[68:71], v[40:43]
    s_waitcnt lgkmcnt(4)
    v_mfma_f32_16x16x32_bf16 v[36:39], v[164:167], v[72:75], v[36:39]
    v_mfma_f32_16x16x32_bf16 v[40:43], v[164:167], v[76:79], v[40:43]
    s_waitcnt lgkmcnt(2)
    v_mfma_f32_16x16x32_bf16 v[36:39], v[168:171], v[80:83], v[36:39]
    v_mfma_f32_16x16x32_bf16 v[40:43], v[168:171], v[84:87], v[40:43]
    s_waitcnt lgkmcnt(0)
    v_mfma_f32_16x16x32_bf16 v[36:39], v[172:175], v[88:91], v[36:39]
    v_mfma_f32_16x16x32_bf16 v[40:43], v[172:175], v[92:95], v[40:43]
    s_lshl_b32 s60, s54, 9
    s_lshl_b32 s61, s20, 6
    s_add_u32 s60, s60, s61
    s_mul_i32 s60, s60, 192
    s_add_u32 s60, s60, 10485760
    v_mul_u32_u24 v227, 96, v252
    s_cmp_lg_u32 s28, 0
    s_cbranch_scc1 K2_NOACC
    buffer_load_dwordx4 v[48:51], v227, s[8:11], s60 offen offset:0
    buffer_load_dwordx4 v[52:55], v227, s[8:11], s60 offen offset:16
    buffer_load_dwordx4 v[56:59], v227, s[8:11], s60 offen offset:32
    buffer_load_dwordx4 v[60:63], v227, s[8:11], s60 offen offset:48
    buffer_load_dwordx4 v[64:67], v227, s[8:11], s60 offen offset:64
    buffer_load_dwordx4 v[68:71], v227, s[8:11], s60 offen offset:80
    buffer_load_dwordx4 v[72:75], v227, s[8:11], s60 offen offset:96
    buffer_load_dwordx4 v[76:79], v227, s[8:11], s60 offen offset:112
    buffer_load_dwordx4 v[80:83], v227, s[8:11], s60 offen offset:128
    buffer_load_dwordx4 v[84:87], v227, s[8:11], s60 offen offset:144
    buffer_load_dwordx4 v[88:91], v227, s[8:11], s60 offen offset:160
    s_waitcnt vmcnt(0)
    v_add_f32 v0, v0, v48
    v_add_f32 v1, v1, v49
    v_add_f32 v2, v2, v50
    v_add_f32 v3, v3, v51
    v_add_f32 v4, v4, v52
    v_add_f32 v5, v5, v53
    v_add_f32 v6, v6, v54
    v_add_f32 v7, v7, v55
    v_add_f32 v8, v8, v56
    v_add_f32 v9, v9, v57
    v_add_f32 v10, v10, v58
    v_add_f32 v11, v11, v59
    v_add_f32 v12, v12, v60
    v_add_f32 v13, v13, v61
    v_add_f32 v14, v14, v62
    v_add_f32 v15, v15, v63
    v_add_f32 v16, v16, v64
    v_add_f32 v17, v17, v65
    v_add_f32 v18, v18, v66
    v_add_f32 v19, v19, v67
    v_add_f32 v20, v20, v68
    v_add_f32 v21, v21, v69
    v_add_f32 v22, v22, v70
    v_add_f32 v23, v23, v71
    v_add_f32 v24, v24, v72
    v_add_f32 v25, v25, v73
    v_add_f32 v26, v26, v74
    v_add_f32 v27, v27, v75
    v_add_f32 v28, v28, v76
    v_add_f32 v29, v29, v77
    v_add_f32 v30, v30, v78
    v_add_f32 v31, v31, v79
    v_add_f32 v32, v32, v80
    v_add_f32 v33, v33, v81
    v_add_f32 v34, v34, v82
    v_add_f32 v35, v35, v83
    v_add_f32 v36, v36, v84
    v_add_f32 v37, v37, v85
    v_add_f32 v38, v38, v86
    v_add_f32 v39, v39, v87
    v_add_f32 v40, v40, v88
    v_add_f32 v41, v41, v89
    v_add_f32 v42, v42, v90
    v_add_f32 v43, v43, v91
K2_NOACC:
    s_barrier
    s_cmp_eq_u32 s55, 0
    s_cbranch_scc1 K2_SPILL
    s_bfe_u32 s60, s20, 0x10002
    s_lshl_b32 s60, s60, 4
    s_add_u32 s59, s59, s60
    v_add_u32 v228, s59, v229
    s_mul_i32 s60, s20, 2080
    s_add_u32 s60, s60, 65536
    v_add_u32 v249, s60, v229
    s_mov_b32 s63, 0xbfb8aa3b
    s_add_u32 s40, s20, s21
    s_lshl_b32 s40, s40, 10
    s_add_u32 s41, s40, 8192
    s_add_u32 s42, s40, 16384
    s_add_u32 s43, s40, 24576
    s_add_u32 s44, s40, 32768
    v_mul_f32 v204, s63, v0
    v_mul_f32 v205, s63, v1
    v_mul_f32 v206, s63, v2
    v_mul_f32 v207, s63, v3
    v_exp_f32 v204, v204
    v_exp_f32 v205, v205
    v_exp_f32 v206, v206
    v_exp_f32 v207, v207
    v_add_f32 v204, 1.0, v204
    v_add_f32 v205, 1.0, v205
    v_add_f32 v206, 1.0, v206
    v_add_f32 v207, 1.0, v207
    v_rcp_f32 v204, v204
    v_rcp_f32 v205, v205
    v_rcp_f32 v206, v206
    v_rcp_f32 v207, v207
    v_cvt_pk_bf16_f32 v176, v0, v1
    v_cvt_pk_bf16_f32 v177, v2, v3
    v_mul_f32 v4, v4, v204
    v_mul_f32 v5, v5, v205
    v_mul_f32 v6, v6, v206
    v_mul_f32 v7, v7, v207
    v_cvt_pk_bf16_f32 v178, v4, v5
    v_cvt_pk_bf16_f32 v179, v6, v7
    v_mul_f32 v8, v8, v204
    v_mul_f32 v9, v9, v205
    v_mul_f32 v10, v10, v206
    v_mul_f32 v11, v11, v207
    v_cvt_pk_bf16_f32 v180, v8, v9
    v_cvt_pk_bf16_f32 v181, v10, v11
    v_mul_f32 v12, v12, v204
    v_mul_f32 v13, v13, v205
    v_mul_f32 v14, v14, v206
    v_mul_f32 v15, v15, v207
    v_cvt_pk_bf16_f32 v182, v12, v13
    v_cvt_pk_bf16_f32 v183, v14, v15
    ds_write_b64 v254, v[176:177] offset:0
    ds_write_b64 v254, v[178:179] offset:256
    ds_write_b64 v254, v[180:181] offset:512
    ds_write_b64 v254, v[182:183] offset:768
    s_waitcnt lgkmcnt(0)
    s_barrier
    ds_read_b128 v[192:195], v228 offset:0
    ds_read_b128 v[196:199], v228 offset:1536
    s_waitcnt lgkmcnt(0)
    buffer_store_dwordx4 v[192:195], v229, s[12:15], s40 offen sc1
    buffer_store_dwordx4 v[196:199], v229, s[12:15], s41 offen sc1
    v_mul_f32 v208, s63, v16
    v_mul_f32 v209, s63, v17
    v_mul_f32 v210, s63, v18
    v_mul_f32 v211, s63, v19
    v_exp_f32 v208, v208
    v_exp_f32 v209, v209
    v_exp_f32 v210, v210
    v_exp_f32 v211, v211
    v_add_f32 v208, 1.0, v208
    v_add_f32 v209, 1.0, v209
    v_add_f32 v210, 1.0, v210
    v_add_f32 v211, 1.0, v211
    v_rcp_f32 v208, v208
    v_rcp_f32 v209, v209
    v_rcp_f32 v210, v210
    v_rcp_f32 v211, v211
    v_cvt_pk_bf16_f32 v184, v16, v17
    v_cvt_pk_bf16_f32 v185, v18, v19
    v_mul_f32 v20, v20, v208
    v_mul_f32 v21, v21, v209
    v_mul_f32 v22, v22, v210
    v_mul_f32 v23, v23, v211
    v_cvt_pk_bf16_f32 v186, v20, v21
    v_cvt_pk_bf16_f32 v187, v22, v23
    v_mul_f32 v24, v24, v208
    v_mul_f32 v25, v25, v209
    v_mul_f32 v26, v26, v210
    v_mul_f32 v27, v27, v211
    v_cvt_pk_bf16_f32 v188, v24, v25
    v_cvt_pk_bf16_f32 v189, v26, v27
    v_mul_f32 v28, v28, v208
    v_mul_f32 v29, v29, v209
    v_mul_f32 v30, v30, v210
    v_mul_f32 v31, v31, v211
    v_cvt_pk_bf16_f32 v190, v28, v29
    v_cvt_pk_bf16_f32 v191, v30, v31
    ds_write_b64 v254, v[184:185] offset:3072
    ds_write_b64 v254, v[186:187] offset:3328
    ds_write_b64 v254, v[188:189] offset:3584
    ds_write_b64 v254, v[190:191] offset:3840
    s_waitcnt lgkmcnt(0)
    s_barrier
    ds_read_b128 v[192:195], v228 offset:3072
    ds_read_b128 v[196:199], v228 offset:4608
    s_waitcnt lgkmcnt(0)
    buffer_store_dwordx4 v[192:195], v229, s[12:15], s42 offen sc1
    buffer_store_dwordx4 v[196:199], v229, s[12:15], s43 offen sc1
    v_mul_f32 v212, s63, v32
    v_mul_f32 v213, s63, v33
    v_mul_f32 v214, s63, v34
    v_mul_f32 v215, s63, v35
    v_exp_f32 v212, v212
    v_exp_f32 v213, v213
    v_exp_f32 v214, v214
    v_exp_f32 v215, v215
    v_add_f32 v212, 1.0, v212
    v_add_f32 v213, 1.0, v213
    v_add_f32 v214, 1.0, v214
    v_add_f32 v215, 1.0, v215
    v_rcp_f32 v212, v212
    v_rcp_f32 v213, v213
    v_rcp_f32 v214, v214
    v_rcp_f32 v215, v215
    v_cvt_pk_bf16_f32 v220, v32, v33
    v_cvt_pk_bf16_f32 v221, v34, v35
    v_mul_f32 v36, v36, v212
    v_mul_f32 v37, v37, v213
    v_mul_f32 v38, v38, v214
    v_mul_f32 v39, v39, v215
    v_cvt_pk_bf16_f32 v178, v36, v37
    v_cvt_pk_bf16_f32 v179, v38, v39
    v_mul_f32 v40, v40, v212
    v_mul_f32 v41, v41, v213
    v_mul_f32 v42, v42, v214
    v_mul_f32 v43, v43, v215
    v_cvt_pk_bf16_f32 v180, v40, v41
    v_cvt_pk_bf16_f32 v181, v42, v43
    ds_write_b64 v255, v[220:221] offset:0
    ds_write_b64 v246, v[178:179] offset:256
    ds_write_b64 v255, v[180:181] offset:512
    s_waitcnt lgkmcnt(0)
    s_barrier
    ds_read_b128 v[200:203], v249
    s_branch K2_LASTROW
K2_SPILL:
    buffer_store_dwordx4 v[0:3], v227, s[8:11], s60 offen offset:0
    buffer_store_dwordx4 v[4:7], v227, s[8:11], s60 offen offset:16
    buffer_store_dwordx4 v[8:11], v227, s[8:11], s60 offen offset:32
    buffer_store_dwordx4 v[12:15], v227, s[8:11], s60 offen offset:48
    buffer_store_dwordx4 v[16:19], v227, s[8:11], s60 offen offset:64
    buffer_store_dwordx4 v[20:23], v227, s[8:11], s60 offen offset:80
    buffer_store_dwordx4 v[24:27], v227, s[8:11], s60 offen offset:96
    buffer_store_dwordx4 v[28:31], v227, s[8:11], s60 offen offset:112
    buffer_store_dwordx4 v[32:35], v227, s[8:11], s60 offen offset:128
    buffer_store_dwordx4 v[36:39], v227, s[8:11], s60 offen offset:144
    buffer_store_dwordx4 v[40:43], v227, s[8:11], s60 offen offset:160
    s_mov_b32 s28, 0
    s_waitcnt vmcnt(0)
    s_cmp_lt_u32 s24, s25
    s_cbranch_scc1 K2_LOAD
    s_add_u32 s23, s23, 20
    s_branch K2_WINDOW
K2_WINDOW:
    s_mov_b32 s24, 0
    s_mov_b32 s25, 1
K2_LOAD:
    v_mbcnt_lo_u32_b32 v176, -1, 0
    v_mbcnt_hi_u32_b32 v176, -1, v176
    s_lshl_b32 s58, s20, 6
    v_add_u32 v177, s58, v176
    v_lshlrev_b32 v70, 4, v176
    s_mov_b32 s58, 7110656
    buffer_load_dwordx4 v[136:139], v70, s[8:11], s58 offen offset:0 sc1
    buffer_load_dwordx4 v[140:143], v70, s[8:11], s58 offen offset:1024 sc1
    s_mov_b32 s58, 7112704
    buffer_load_dwordx4 v[144:147], v70, s[8:11], s58 offen offset:0 sc1
    buffer_load_dwordx4 v[148:151], v70, s[8:11], s58 offen offset:1024 sc1
    s_mov_b32 s58, 7114752
    buffer_load_dwordx4 v[152:155], v70, s[8:11], s58 offen offset:0 sc1
    buffer_load_dwordx4 v[156:159], v70, s[8:11], s58 offen offset:1024 sc1
    s_mov_b32 s58, 7116800
    buffer_load_dwordx4 v[160:163], v70, s[8:11], s58 offen offset:0 sc1
    buffer_load_dwordx4 v[164:167], v70, s[8:11], s58 offen offset:1024 sc1
    s_mov_b32 s58, 7118848
    buffer_load_dwordx4 v[168:171], v70, s[8:11], s58 offen offset:0 sc1
    buffer_load_dwordx4 v[172:175], v70, s[8:11], s58 offen offset:1024 sc1
    s_mul_i32 s58, s20, 10400
    s_add_u32 s58, s58, 65536
    s_add_u32 s59, s58, 512
    v_and_b32 v76, 31, v176
    v_lshrrev_b32 v77, 5, v176
    v_mov_b32 v80, 0
    v_mul_u32_u24 v77, 2080, v77
    v_mov_b32 v81, 0xffff0000
    v_lshl_add_u32 v78, v76, 4, v77
    v_mov_b32 v82, 0
    v_add_u32 v78, s58, v78
    v_mov_b32 v83, v81
    v_add_u32 v85, 16, v176
    v_lshlrev_b32 v84, 5, v176
    v_lshrrev_b32 v85, 6, v85
    v_mul_u32_u24 v85, 1532, v85
    v_sub_u32 v84, v84, v85
    v_mov_b32 v85, -1
    v_add_u32 v84, s59, v84
    ds_write_b32 v84, v85 offset:0
    ds_write_b32 v84, v85 offset:2080
    ds_write_b32 v84, v85 offset:4160
    ds_write_b32 v84, v85 offset:6240
    ds_write_b32 v84, v85 offset:8320
    s_mov_b32 exec_hi, 0
    ds_write_b128 v78, v[80:83] offset:0
    ds_write_b128 v78, v[80:83] offset:2080
    ds_write_b128 v78, v[80:83] offset:4160
    ds_write_b128 v78, v[80:83] offset:6240
    ds_write_b128 v78, v[80:83] offset:8320
    s_mov_b32 exec_hi, -1
    s_cmp_lg_u32 s20, 7
    s_cbranch_scc1 K2_NOH
    v_mov_b32 v76, 0
    v_mov_b32 v77, -1
    v_lshlrev_b32 v78, 2, v176
    v_add_u32 v78, 163072, v78
    s_mov_b64 exec, 0x1ff
    ds_write_b32 v78, v76 offset:192
    s_mov_b32 exec_lo, -1
    ds_write_b32 v78, v77 offset:256
    s_mov_b64 exec, -1
    s_cmp_lg_u32 s24, 0
    s_cbranch_scc1 K2_NOH
    s_mov_b32 exec_hi, 0xffff
    ds_write_b32 v78, v76
    s_mov_b64 exec, 1
    ds_write_b32 v78, v76 offset:228
    s_mov_b64 exec, -1
K2_NOH:
    s_waitcnt lgkmcnt(0)
    s_barrier
    s_branch K2_CELLS
K2_LD_GEN:
    s_mov_b64 exec, s[42:43]
    s_cbranch_execz K2_LD_DONE
    buffer_load_dwordx4 v[4:7], v182, s[8:11], 0 offen sc1
    s_mov_b64 exec, s[44:45]
    s_cbranch_execz K2_LD_DONE
    buffer_load_dwordx4 v[8:11], v183, s[8:11], 0 offen sc1
    s_mov_b64 exec, s[46:47]
    s_cbranch_execz K2_LD_DONE
    buffer_load_dwordx4 v[12:15], v184, s[8:11], 0 offen sc1
    s_mov_b64 exec, s[48:49]
    s_cbranch_execz K2_LD_DONE
    buffer_load_dwordx4 v[16:19], v181, s[8:11], 0 offen offset:128 sc1
    s_mov_b64 exec, s[50:51]
    s_cbranch_execz K2_LD_DONE
    buffer_load_dwordx4 v[20:23], v181, s[8:11], 0 offen offset:160 sc1
    s_mov_b64 exec, s[90:91]
    s_cbranch_execz K2_LD_DONE
    buffer_load_dwordx4 v[24:27], v181, s[8:11], 0 offen offset:192 sc1
    s_mov_b64 exec, s[92:93]
    s_cbranch_execz K2_LD_DONE
    buffer_load_dwordx4 v[28:31], v181, s[8:11], 0 offen offset:224 sc1
    s_mov_b64 exec, s[94:95]
    s_cbranch_execz K2_LD_DONE
    buffer_load_dwordx4 v[32:35], v181, s[8:11], 0 offen offset:256 sc1
    s_mov_b64 exec, s[96:97]
    s_cbranch_execz K2_LD_DONE
    buffer_load_dwordx4 v[36:39], v181, s[8:11], 0 offen offset:288 sc1
    s_branch K2_LD_DONE
K2_WLATE:
    s_waitcnt vmcnt(0)
    s_branch K2_WUNP
K2_RT0:
    s_sub_u32 s60, s60, 1
    s_cbranch_scc1 K2_END
    buffer_load_dwordx4 v[0:3], v181, s[8:11], 0 offen offset:0 sc1
    s_waitcnt vmcnt(0)
    s_branch K2_CK0
K2_RT1:
    s_sub_u32 s60, s60, 1
    s_cbranch_scc1 K2_END
    buffer_load_dwordx4 v[4:7], v182, s[8:11], 0 offen sc1
    s_waitcnt vmcnt(0)
    s_branch K2_CK1
K2_RT2:
    s_sub_u32 s60, s60, 1
    s_cbranch_scc1 K2_END
    buffer_load_dwordx4 v[8:11], v183, s[8:11], 0 offen sc1
    s_waitcnt vmcnt(0)
    s_branch K2_CK2
K2_RT3:
    s_sub_u32 s60, s60, 1
    s_cbranch_scc1 K2_END
    buffer_load_dwordx4 v[12:15], v184, s[8:11], 0 offen sc1
    s_waitcnt vmcnt(0)
    s_branch K2_CK3
K2_RT4:
    s_sub_u32 s60, s60, 1
    s_cbranch_scc1 K2_END
    buffer_load_dwordx4 v[16:19], v181, s[8:11], 0 offen offset:128 sc1
    s_waitcnt vmcnt(0)
    s_branch K2_CK4
K2_RT5:
    s_sub_u32 s60, s60, 1
    s_cbranch_scc1 K2_END
    buffer_load_dwordx4 v[20:23], v181, s[8:11], 0 offen offset:160 sc1
    s_waitcnt vmcnt(0)
    s_branch K2_CK5
K2_RT6:
    s_sub_u32 s60, s60, 1
    s_cbranch_scc1 K2_END
    buffer_load_dwordx4 v[24:27], v181, s[8:11], 0 offen offset:192 sc1
    s_waitcnt vmcnt(0)
    s_branch K2_CK6
K2_RT7:
    s_sub_u32 s60, s60, 1
    s_cbranch_scc1 K2_END
    buffer_load_dwordx4 v[28:31], v181, s[8:11], 0 offen offset:224 sc1
    s_waitcnt vmcnt(0)
    s_branch K2_CK7
K2_RT8:
    s_sub_u32 s60, s60, 1
    s_cbranch_scc1 K2_END
    buffer_load_dwordx4 v[32:35], v181, s[8:11], 0 offen offset:256 sc1
    s_waitcnt vmcnt(0)
    s_branch K2_CK8
K2_RT9:
    s_sub_u32 s60, s60, 1
    s_cbranch_scc1 K2_END
    buffer_load_dwordx4 v[36:39], v181, s[8:11], 0 offen offset:288 sc1
    s_waitcnt vmcnt(0)
    s_branch K2_CK9
K2_RK_LOAD:
    s_waitcnt vmcnt(0)
    s_mov_b64 exec, s[40:41]
    s_cbranch_execz K2_RK_B
    v_lshrrev_b32 v50, 24, v3
    buffer_load_dword v40, v179, s[8:11], s66 offen offset:0
    v_mad_u32_u24 v50, v50, s58, v202
    v_and_b32 v3, 0xffffff, v3
    s_mov_b64 exec, s[42:43]
    s_cbranch_execz K2_RK_B
    v_lshrrev_b32 v51, 24, v7
    buffer_load_dword v41, v185, s[8:11], s66 offen
    v_mad_u32_u24 v51, v51, s58, v202
    v_and_b32 v7, 0xffffff, v7
    s_mov_b64 exec, s[44:45]
    s_cbranch_execz K2_RK_B
    v_lshrrev_b32 v52, 24, v11
    buffer_load_dword v42, v186, s[8:11], s66 offen
    v_mad_u32_u24 v52, v52, s58, v202
    v_and_b32 v11, 0xffffff, v11
    s_mov_b64 exec, s[46:47]
    s_cbranch_execz K2_RK_B
    v_lshrrev_b32 v53, 24, v15
    buffer_load_dword v43, v187, s[8:11], s66 offen
    v_mad_u32_u24 v53, v53, s58, v202
    v_and_b32 v15, 0xffffff, v15
    s_mov_b64 exec, s[48:49]
    s_cbranch_execz K2_RK_B
    v_lshrrev_b32 v54, 24, v19
    buffer_load_dword v44, v179, s[8:11], s66 offen offset:32
    v_mad_u32_u24 v54, v54, s58, v202
    v_and_b32 v19, 0xffffff, v19
    s_mov_b64 exec, s[50:51]
    s_cbranch_execz K2_RK_B
    v_lshrrev_b32 v55, 24, v23
    buffer_load_dword v45, v179, s[8:11], s66 offen offset:40
    v_mad_u32_u24 v55, v55, s58, v202
    v_and_b32 v23, 0xffffff, v23
    s_mov_b64 exec, s[90:91]
    s_cbranch_execz K2_RK_B
    v_lshrrev_b32 v56, 24, v27
    buffer_load_dword v46, v179, s[8:11], s66 offen offset:48
    v_mad_u32_u24 v56, v56, s58, v202
    v_and_b32 v27, 0xffffff, v27
    s_mov_b64 exec, s[92:93]
    s_cbranch_execz K2_RK_B
    v_lshrrev_b32 v57, 24, v31
    buffer_load_dword v47, v179, s[8:11], s66 offen offset:56
    v_mad_u32_u24 v57, v57, s58, v202
    v_and_b32 v31, 0xffffff, v31
    s_mov_b64 exec, s[94:95]
    s_cbranch_execz K2_RK_B
    v_lshrrev_b32 v58, 24, v35
    buffer_load_dword v48, v179, s[8:11], s66 offen offset:64
    v_mad_u32_u24 v58, v58, s58, v202
    v_and_b32 v35, 0xffffff, v35
    s_mov_b64 exec, s[96:97]
    s_cbranch_execz K2_RK_B
    v_lshrrev_b32 v59, 24, v39
    buffer_load_dword v49, v179, s[8:11], s66 offen offset:72
    v_mad_u32_u24 v59, v59, s58, v202
    v_and_b32 v39, 0xffffff, v39
K2_RK_B:
    s_mov_b64 exec, -1
    s_mul_i32 s62, s24, 48
    s_waitcnt vmcnt(0)
    v_subrev_u32 v40, s62, v40
    v_subrev_u32 v41, s62, v41
    v_subrev_u32 v42, s62, v42
    v_subrev_u32 v43, s62, v43
    v_subrev_u32 v44, s62, v44
    v_subrev_u32 v45, s62, v45
    v_subrev_u32 v46, s62, v46
    v_subrev_u32 v47, s62, v47
    v_subrev_u32 v48, s62, v48
    v_subrev_u32 v49, s62, v49
    s_branch K2_RK_DONE
K2_BIG:
    s_cmp_lg_u32 s24, 0
    s_cbranch_scc1 K2_TOK
    s_movk_i32 s26, 48
    v_mov_b32 v197, v193
    s_nop 1
    v_max_u32_dpp v197, v197, v197 row_shr:1 row_mask:0xf bank_mask:0xf bound_ctrl:0
    s_nop 1
    v_max_u32_dpp v197, v197, v197 row_shr:2 row_mask:0xf bank_mask:0xf bound_ctrl:0
    s_nop 1
    v_max_u32_dpp v197, v197, v197 row_shr:4 row_mask:0xf bank_mask:0xf bound_ctrl:0
    s_nop 1
    v_max_u32_dpp v197, v197, v197 row_shr:8 row_mask:0xf bank_mask:0xf bound_ctrl:0
    s_nop 1
    v_max_u32_dpp v197, v197, v197 row_bcast:15 row_mask:0xa bank_mask:0xf
    s_nop 1
    v_max_u32_dpp v197, v197, v197 row_bcast:31 row_mask:0xc bank_mask:0xf
    s_nop 0
    v_readlane_b32 s25, v197, 63
    s_nop 0
    s_add_u32 s25, s25, 47
    s_mul_i32 s25, s25, 43691
    s_lshr_b32 s25, s25, 21
    s_mov_b64 exec, s[40:41]
    s_cbranch_execz K2_SV_DONE
    buffer_store_dword v40, v179, s[8:11], s66 offen offset:0
    s_mov_b64 exec, s[42:43]
    s_cbranch_execz K2_SV_DONE
    buffer_store_dword v41, v185, s[8:11], s66 offen
    s_mov_b64 exec, s[44:45]
    s_cbranch_execz K2_SV_DONE
    buffer_store_dword v42, v186, s[8:11], s66 offen
    s_mov_b64 exec, s[46:47]
    s_cbranch_execz K2_SV_DONE
    buffer_store_dword v43, v187, s[8:11], s66 offen
    s_mov_b64 exec, s[48:49]
    s_cbranch_execz K2_SV_DONE
    buffer_store_dword v44, v179, s[8:11], s66 offen offset:32
    s_mov_b64 exec, s[50:51]
    s_cbranch_execz K2_SV_DONE
    buffer_store_dword v45, v179, s[8:11], s66 offen offset:40
    s_mov_b64 exec, s[90:91]
    s_cbranch_execz K2_SV_DONE
    buffer_store_dword v46, v179, s[8:11], s66 offen offset:48
    s_mov_b64 exec, s[92:93]
    s_cbranch_execz K2_SV_DONE
    buffer_store_dword v47, v179, s[8:11], s66 offen offset:56
    s_mov_b64 exec, s[94:95]
    s_cbranch_execz K2_SV_DONE
    buffer_store_dword v48, v179, s[8:11], s66 offen offset:64
    s_mov_b64 exec, s[96:97]
    s_cbranch_execz K2_SV_DONE
    buffer_store_dword v49, v179, s[8:11], s66 offen offset:72
K2_SV_DONE:
    s_mov_b64 exec, -1
    s_branch K2_TOK
K2_rare_1:
    s_cmp_eq_u32 s33, 4
    s_cbranch_scc1 K2_four_3
    s_mov_b32 s49, s48
    s_mov_b32 s51, s48
    s_add_u32 s45, s44, 256
    s_add_u32 s46, s44, 512
    s_add_u32 s47, s44, 768
    s_branch K2_back_2
K2_four_3:
    s_add_u32 s50, s48, 256
    s_add_u32 s51, s48, 384
    s_mov_b32 s46, s44
    s_mov_b32 s47, s44
    s_branch K2_back_2
K2_a4_5:
    v_add_u32 v254, s48, v230
    ds_read_b32 v254, v254 offset:4
    s_lshr_b32 s65, s3, 27
    s_mul_i32 s66, s22, 2080
    s_lshl_b32 s65, s65, 9
    s_add_u32 s65, s65, s66
    s_add_u32 s65, s65, 65536
    s_mov_b32 m0, s65
    s_mov_b32 exec_hi, 0
    s_waitcnt lgkmcnt(0)
    v_or_b32 v254, v254, v231
    buffer_load_dwordx4 v254, s[16:19], 0 offen  lds
    s_mov_b32 exec_hi, -1
    s_branch K2_b4_7
K2_rare_14:
    s_cmp_eq_u32 s33, 4
    s_cbranch_scc1 K2_four_16
    s_mov_b32 s49, s48
    s_mov_b32 s51, s48
    s_add_u32 s45, s44, 256
    s_add_u32 s46, s44, 512
    s_add_u32 s47, s44, 768
    s_branch K2_back_15
K2_four_16:
    s_add_u32 s50, s48, 256
    s_add_u32 s51, s48, 384
    s_mov_b32 s46, s44
    s_mov_b32 s47, s44
    s_branch K2_back_15
K2_a4_18:
    v_add_u32 v254, s48, v230
    ds_read_b32 v254, v254 offset:4
    s_lshr_b32 s65, s3, 27
    s_mul_i32 s66, s22, 2080
    s_lshl_b32 s65, s65, 9
    s_add_u32 s65, s65, s66
    s_add_u32 s65, s65, 65536
    s_mov_b32 m0, s65
    s_mov_b32 exec_hi, 0
    s_waitcnt lgkmcnt(0)
    v_or_b32 v254, v254, v231
    buffer_load_dwordx4 v254, s[16:19], 0 offen  lds
    s_mov_b32 exec_hi, -1
    s_branch K2_b4_20
K2_rare_27:
    s_cmp_eq_u32 s33, 4
    s_cbranch_scc1 K2_four_29
    s_mov_b32 s49, s48
    s_mov_b32 s51, s48
    s_add_u32 s45, s44, 256
    s_add_u32 s46, s44, 512
    s_add_u32 s47, s44, 768
    s_branch K2_back_28
K2_four_29:
    s_add_u32 s50, s48, 256
    s_add_u32 s51, s48, 384
    s_mov_b32 s46, s44
    s_mov_b32 s47, s44
    s_branch K2_back_28
K2_a4_31:
    v_add_u32 v254, s48, v230
    ds_read_b32 v254, v254 offset:4
    s_lshr_b32 s65, s3, 27
    s_mul_i32 s66, s22, 2080
    s_lshl_b32 s65, s65, 9
    s_add_u32 s65, s65, s66
    s_add_u32 s65, s65, 65536
    s_mov_b32 m0, s65
    s_mov_b32 exec_hi, 0
    s_waitcnt lgkmcnt(0)
    v_or_b32 v254, v254, v231
    buffer_load_dwordx4 v254, s[16:19], 0 offen  lds
    s_mov_b32 exec_hi, -1
    s_branch K2_b4_33
K2_rare_40:
    s_cmp_eq_u32 s33, 4
    s_cbranch_scc1 K2_four_42
    s_mov_b32 s49, s48
    s_mov_b32 s51, s48
    s_add_u32 s45, s44, 256
    s_add_u32 s46, s44, 512
    s_add_u32 s47, s44, 768
    s_branch K2_back_41
K2_four_42:
    s_add_u32 s50, s48, 256
    s_add_u32 s51, s48, 384
    s_mov_b32 s46, s44
    s_mov_b32 s47, s44
    s_branch K2_back_41
K2_a4_44:
    v_add_u32 v254, s48, v230
    ds_read_b32 v254, v254 offset:4
    s_lshr_b32 s65, s3, 27
    s_mul_i32 s66, s22, 2080
    s_lshl_b32 s65, s65, 9
    s_add_u32 s65, s65, s66
    s_add_u32 s65, s65, 65536
    s_mov_b32 m0, s65
    s_mov_b32 exec_hi, 0
    s_waitcnt lgkmcnt(0)
    v_or_b32 v254, v254, v231
    buffer_load_dwordx4 v254, s[16:19], 0 offen  lds
    s_mov_b32 exec_hi, -1
    s_branch K2_b4_46
K2_rare_51:
    s_cmp_eq_u32 s33, 4
    s_cbranch_scc1 K2_four_53
    s_mov_b32 s49, s48
    s_mov_b32 s51, s48
    s_add_u32 s45, s44, 256
    s_add_u32 s46, s44, 512
    s_add_u32 s47, s44, 768
    s_branch K2_back_52
K2_four_53:
    s_add_u32 s50, s48, 256
    s_add_u32 s51, s48, 384
    s_mov_b32 s46, s44
    s_mov_b32 s47, s44
    s_branch K2_back_52
K2_rare_58:
    s_cmp_eq_u32 s33, 4
    s_cbranch_scc1 K2_four_60
    s_mov_b32 s49, s48
    s_mov_b32 s51, s48
    s_add_u32 s45, s44, 256
    s_add_u32 s46, s44, 512
    s_add_u32 s47, s44, 768
    s_branch K2_back_59
K2_four_60:
    s_add_u32 s50, s48, 256
    s_add_u32 s51, s48, 384
    s_mov_b32 s46, s44
    s_mov_b32 s47, s44
    s_branch K2_back_59
K2_rare_65:
    s_cmp_eq_u32 s33, 4
    s_cbranch_scc1 K2_four_67
    s_mov_b32 s49, s48
    s_mov_b32 s51, s48
    s_add_u32 s45, s44, 256
    s_add_u32 s46, s44, 512
    s_add_u32 s47, s44, 768
    s_branch K2_back_66
K2_four_67:
    s_add_u32 s50, s48, 256
    s_add_u32 s51, s48, 384
    s_mov_b32 s46, s44
    s_mov_b32 s47, s44
    s_branch K2_back_66
K2_U10:
    s_setprio 1
    s_add_u32 s38, s38, 1
    v_mov_b32 v254, s52
    v_mov_b32 v255, s38
    s_lshl_b32 s58, s38, 3
    s_add_u32 s58, s58, s20
    s_mov_b64 exec, 1
    ds_write_b32 v254, v255
    s_mov_b64 exec, -1
    s_cmp_lt_u32 s58, s22
    s_cbranch_scc0 K2_dyn_68
K2_back_69:
    s_waitcnt lgkmcnt(4)
    v_lshlrev_b32 v20, 16, v0
    v_and_b32 v21, 0xffff0000, v0
    v_lshlrev_b32 v22, 16, v1
    v_and_b32 v23, 0xffff0000, v1
    v_lshlrev_b32 v24, 16, v2
    v_and_b32 v25, 0xffff0000, v2
    v_lshlrev_b32 v26, 16, v3
    v_and_b32 v27, 0xffff0000, v3
    v_mul_f32_dpp v36, v16, v20 row_newbcast:8 row_mask:0xf bank_mask:0xf
    v_mul_f32_dpp v37, v16, v21 row_newbcast:9 row_mask:0xf bank_mask:0xf
    v_mul_f32_dpp v38, v16, v22 row_newbcast:10 row_mask:0xf bank_mask:0xf
    v_mul_f32_dpp v39, v16, v23 row_newbcast:11 row_mask:0xf bank_mask:0xf
    v_mul_f32_dpp v40, v16, v24 row_newbcast:12 row_mask:0xf bank_mask:0xf
    v_mul_f32_dpp v41, v16, v25 row_newbcast:13 row_mask:0xf bank_mask:0xf
    v_mul_f32_dpp v42, v16, v26 row_newbcast:14 row_mask:0xf bank_mask:0xf
    v_mul_f32_dpp v43, v16, v27 row_newbcast:15 row_mask:0xf bank_mask:0xf
    v_cvt_pk_bf16_f32 v68, v36, v37
    v_cvt_pk_bf16_f32 v69, v38, v39
    v_cvt_pk_bf16_f32 v70, v40, v41
    v_cvt_pk_bf16_f32 v71, v42, v43
    v_mul_f32_dpp v20, v16, v20 row_newbcast:0 row_mask:0xa bank_mask:0xf
    v_mul_f32_dpp v21, v16, v21 row_newbcast:1 row_mask:0xa bank_mask:0xf
    v_mul_f32_dpp v22, v16, v22 row_newbcast:2 row_mask:0xa bank_mask:0xf
    v_mul_f32_dpp v23, v16, v23 row_newbcast:3 row_mask:0xa bank_mask:0xf
    v_mul_f32_dpp v24, v16, v24 row_newbcast:4 row_mask:0xa bank_mask:0xf
    v_mul_f32_dpp v25, v16, v25 row_newbcast:5 row_mask:0xa bank_mask:0xf
    v_mul_f32_dpp v26, v16, v26 row_newbcast:6 row_mask:0xa bank_mask:0xf
    v_mul_f32_dpp v27, v16, v27 row_newbcast:7 row_mask:0xa bank_mask:0xf
    v_cvt_pk_bf16_f32 v64, v20, v21
    v_cvt_pk_bf16_f32 v65, v22, v23
    v_cvt_pk_bf16_f32 v66, v24, v25
    v_cvt_pk_bf16_f32 v67, v26, v27
    v_readlane_b32 s3, v253, s58
    s_lshl_b32 s44, s34, 7
    s_and_b32 s48, s3, 0x3ffff
    s_bfe_u32 s33, s3, 0x30013
    s_mul_i32 s35, s38, 6
    s_cmp_eq_u32 s34, 0
    s_cselect_b32 s35, s35, s48
    s_mov_b32 s45, s44
    s_add_u32 s47, s44, 256
    s_add_u32 s49, s48, 128
    s_add_u32 s60, s48, 256
    s_cmp_eq_u32 s33, 3
    s_cselect_b32 s46, s44, s47
    s_cselect_b32 s50, s60, s48
    s_cselect_b32 s51, s48, s49
    s_sub_u32 s60, s33, 2
    s_cmp_lt_u32 s60, 2
    s_cbranch_scc0 K2_rare_74
K2_back_75:
    v_add_u32 v233, s48, v230
    ds_read_b32 v232, v233
    ds_read_b32 v233, v233 offset:1024
    v_add_u32 v222, s48, v251
    ds_read2_b32 v[222:223], v222 offset0:1 offset1:3
    v_add_u32 v224, s49, v251
    ds_read2_b32 v[224:225], v224 offset0:1 offset1:3
    v_add_u32 v226, s50, v251
    ds_read2_b32 v[226:227], v226 offset0:1 offset1:3
    v_add_u32 v228, s51, v251
    ds_read2_b32 v[228:229], v228 offset0:1 offset1:3
    s_waitcnt lgkmcnt(4)
    v_or_b32 v232, v232, v231
    v_or_b32 v233, v233, v231
    s_cmp_lg_u32 s34, 0
    s_cbranch_scc1 K2_dum_77
    s_cmp_eq_u32 s33, 4
    s_cbranch_scc1 K2_a4_78
K2_b4_80:
    s_add_u32 m0, s48, 512
    s_add_u32 s65, s48, 1536
    buffer_load_dwordx4 v232, s[16:19], 0 offen  lds
    s_mov_b32 m0, s65
    s_mov_b32 exec_hi, 0
    buffer_load_dwordx4 v233, s[16:19], 0 offen  lds
    s_mov_b32 exec_hi, -1
K2_back_79:
    s_waitcnt lgkmcnt(3)
    v_mad_u32_u16 v222, v222, s39, v248 op_sel:[1,0,0,0]
    v_mad_u32_u16 v223, v223, s39, v248 op_sel:[1,0,0,0]
    s_waitcnt lgkmcnt(2)
    v_mad_u32_u16 v224, v224, s39, v248 op_sel:[1,0,0,0]
    v_mad_u32_u16 v225, v225, s39, v248 op_sel:[1,0,0,0]
    s_waitcnt lgkmcnt(1)
    v_mad_u32_u16 v226, v226, s39, v248 op_sel:[1,0,0,0]
    v_mad_u32_u16 v227, v227, s39, v248 op_sel:[1,0,0,0]
    s_waitcnt lgkmcnt(0)
    v_mad_u32_u16 v228, v228, s39, v248 op_sel:[1,0,0,0]
    v_mad_u32_u16 v229, v229, s39, v248 op_sel:[1,0,0,0]
    s_waitcnt vmcnt(6)
    v_mfma_f32_32x32x16_bf16 v[0:15], v[64:67], v[176:179], 0
    ds_read_b64_tr_b16 v[184:185], v246 offset:2048
    ds_read_b64_tr_b16 v[186:187], v246 offset:3072
    ds_read_b64_tr_b16 v[188:189], v247 offset:2048
    ds_read_b64_tr_b16 v[190:191], v247 offset:3072
    s_mov_b32 m0, s68
    v_mfma_f32_32x32x16_bf16 v[16:31], v[68:71], v[176:179], 0
    buffer_load_dwordx4 v222, s[4:7], s44 offen sc1 lds
    buffer_load_dwordx4 v223, s[72:75], s44 offen offset:1024 sc1 lds
    v_permlane32_swap_b32 v242, v236
    v_permlane32_swap_b32 v243, v237
    v_mfma_f32_32x32x16_bf16 v[32:47], v[64:67], v[180:183], 0
    v_permlane32_swap_b32 v244, v238
    v_permlane32_swap_b32 v245, v239
    v_permlane32_swap_b32 v240, v241
    v_add_f32 v242, v242, v236
    v_mfma_f32_32x32x16_bf16 v[48:63], v[68:71], v[180:183], 0
    s_setprio 0
    v_add_f32 v243, v243, v237
    v_add_f32 v244, v244, v238
    v_add_f32 v245, v245, v239
    v_add_f32 v240, -v240, -v241
    s_set_gpr_idx_on s32, gpr_idx(DST)
    s_nop 0
    v_cvt_pk_bf16_f32 v195, v242, v243
    v_cvt_pk_bf16_f32 v196, v244, v245
    v_cvt_pk_bf16_f32 v197, v240, v240
    s_set_gpr_idx_off
    v_mul_f32 v234, v0, v96
    v_mul_f32 v236, v8, v128
    v_fmac_f32 v234, v1, v97
    v_fmac_f32 v236, v9, v129
    v_fmac_f32 v234, v2, v98
    v_fmac_f32 v236, v10, v130
    v_fmac_f32 v234, v3, v99
    v_fmac_f32 v236, v11, v131
    v_fmac_f32 v234, v4, v100
    v_fmac_f32 v236, v12, v132
    v_fmac_f32 v234, v5, v101
    v_fmac_f32 v236, v13, v133
    v_fmac_f32 v234, v6, v102
    v_fmac_f32 v236, v14, v134
    v_fmac_f32 v234, v7, v103
    v_fmac_f32 v236, v15, v135
    v_mul_f32 v238, v16, v128
    v_mul_f32 v240, v24, v128
    v_fmac_f32 v238, v17, v129
    v_fmac_f32 v240, v25, v129
    v_fmac_f32 v238, v18, v130
    v_fmac_f32 v240, v26, v130
    v_fmac_f32 v238, v19, v131
    v_fmac_f32 v240, v27, v131
    v_fmac_f32 v238, v20, v132
    v_fmac_f32 v240, v28, v132
    v_fmac_f32 v238, v21, v133
    v_fmac_f32 v240, v29, v133
    v_fmac_f32 v238, v22, v134
    v_fmac_f32 v240, v30, v134
    v_fmac_f32 v238, v23, v135
    v_fmac_f32 v240, v31, v135
    v_mul_f32 v235, v32, v104
    v_mul_f32 v237, v40, v136
    v_fmac_f32 v235, v33, v105
    v_fmac_f32 v237, v41, v137
    v_fmac_f32 v235, v34, v106
    v_fmac_f32 v237, v42, v138
    v_fmac_f32 v235, v35, v107
    v_fmac_f32 v237, v43, v139
    v_fmac_f32 v235, v36, v108
    v_fmac_f32 v237, v44, v140
    v_fmac_f32 v235, v37, v109
    v_fmac_f32 v237, v45, v141
    v_fmac_f32 v235, v38, v110
    v_fmac_f32 v237, v46, v142
    v_fmac_f32 v235, v39, v111
    v_fmac_f32 v237, v47, v143
    v_mul_f32 v239, v48, v136
    v_mul_f32 v241, v56, v136
    v_fmac_f32 v239, v49, v137
    v_fmac_f32 v241, v57, v137
    v_fmac_f32 v239, v50, v138
    v_fmac_f32 v241, v58, v138
    v_fmac_f32 v239, v51, v139
    v_fmac_f32 v241, v59, v139
    v_fmac_f32 v239, v52, v140
    v_fmac_f32 v241, v60, v140
    v_fmac_f32 v239, v53, v141
    v_fmac_f32 v241, v61, v141
    v_fmac_f32 v239, v54, v142
    v_fmac_f32 v241, v62, v142
    v_fmac_f32 v239, v55, v143
    v_fmac_f32 v241, v63, v143
    s_setprio 1
    s_waitcnt vmcnt(6) lgkmcnt(0)
    v_mfma_f32_32x32x16_bf16 v[0:15], v[64:67], v[184:187], 0
    ds_read_b64_tr_b16 v[176:177], v246 offset:4096
    ds_read_b64_tr_b16 v[178:179], v246 offset:5120
    ds_read_b64_tr_b16 v[180:181], v247 offset:4096
    ds_read_b64_tr_b16 v[182:183], v247 offset:5120
    s_mov_b32 m0, s69
    v_mfma_f32_32x32x16_bf16 v[16:31], v[68:71], v[184:187], 0
    buffer_load_dwordx4 v224, s[4:7], s45 offen sc1 lds
    buffer_load_dwordx4 v225, s[72:75], s45 offen offset:1024 sc1 lds
    v_permlane32_swap_b32 v234, v236
    v_permlane32_swap_b32 v235, v237
    v_mfma_f32_32x32x16_bf16 v[32:47], v[64:67], v[188:191], 0
    v_permlane32_swap_b32 v240, v238
    v_permlane32_swap_b32 v241, v239
    v_add_f32 v234, v234, v236
    v_add_f32 v235, v235, v237
    v_add_f32 v240, v240, v238
    v_mfma_f32_32x32x16_bf16 v[48:63], v[68:71], v[188:191], 0
    s_setprio 0
    v_add_f32 v241, v241, v239
    s_set_gpr_idx_on s31, gpr_idx(DST)
    s_nop 0
    v_cvt_pk_bf16_f32 v192, v234, v235
    v_cvt_pk_bf16_f32 v193, v240, v241
    s_set_gpr_idx_off
    v_mul_f32 v234, v0, v144
    v_mul_f32 v236, v8, v112
    v_fmac_f32 v234, v1, v145
    v_fmac_f32 v236, v9, v113
    v_fmac_f32 v234, v2, v146
    v_fmac_f32 v236, v10, v114
    v_fmac_f32 v234, v3, v147
    v_fmac_f32 v236, v11, v115
    v_fmac_f32 v234, v4, v148
    v_fmac_f32 v236, v12, v116
    v_fmac_f32 v234, v5, v149
    v_fmac_f32 v236, v13, v117
    v_fmac_f32 v234, v6, v150
    v_fmac_f32 v236, v14, v118
    v_fmac_f32 v234, v7, v151
    v_fmac_f32 v236, v15, v119
    v_mul_f32 v238, v16, v160
    v_mul_f32 v240, v24, v160
    v_fmac_f32 v238, v17, v161
    v_fmac_f32 v240, v25, v161
    v_fmac_f32 v238, v18, v162
    v_fmac_f32 v240, v26, v162
    v_fmac_f32 v238, v19, v163
    v_fmac_f32 v240, v27, v163
    v_fmac_f32 v238, v20, v164
    v_fmac_f32 v240, v28, v164
    v_fmac_f32 v238, v21, v165
    v_fmac_f32 v240, v29, v165
    v_fmac_f32 v238, v22, v166
    v_fmac_f32 v240, v30, v166
    v_fmac_f32 v238, v23, v167
    v_fmac_f32 v240, v31, v167
    v_mul_f32 v235, v32, v152
    v_mul_f32 v237, v40, v120
    v_fmac_f32 v235, v33, v153
    v_fmac_f32 v237, v41, v121
    v_fmac_f32 v235, v34, v154
    v_fmac_f32 v237, v42, v122
    v_fmac_f32 v235, v35, v155
    v_fmac_f32 v237, v43, v123
    v_fmac_f32 v235, v36, v156
    v_fmac_f32 v237, v44, v124
    v_fmac_f32 v235, v37, v157
    v_fmac_f32 v237, v45, v125
    v_fmac_f32 v235, v38, v158
    v_fmac_f32 v237, v46, v126
    v_fmac_f32 v235, v39, v159
    v_fmac_f32 v237, v47, v127
    v_mul_f32 v239, v48, v168
    v_mul_f32 v241, v56, v168
    v_fmac_f32 v239, v49, v169
    v_fmac_f32 v241, v57, v169
    v_fmac_f32 v239, v50, v170
    v_fmac_f32 v241, v58, v170
    v_fmac_f32 v239, v51, v171
    v_fmac_f32 v241, v59, v171
    v_fmac_f32 v239, v52, v172
    v_fmac_f32 v241, v60, v172
    v_fmac_f32 v239, v53, v173
    v_fmac_f32 v241, v61, v173
    v_fmac_f32 v239, v54, v174
    v_fmac_f32 v241, v62, v174
    v_fmac_f32 v239, v55, v175
    v_fmac_f32 v241, v63, v175
    s_setprio 1
    s_waitcnt vmcnt(6) lgkmcnt(0)
    v_mfma_f32_32x32x16_bf16 v[0:15], v[64:67], v[176:179], 0
    ds_read_b64_tr_b16 v[184:185], v246 offset:6144
    ds_read_b64_tr_b16 v[186:187], v246 offset:7168
    ds_read_b64_tr_b16 v[188:189], v247 offset:6144
    ds_read_b64_tr_b16 v[190:191], v247 offset:7168
    s_mov_b32 m0, s70
    v_mfma_f32_32x32x16_bf16 v[16:31], v[68:71], v[176:179], 0
    buffer_load_dwordx4 v226, s[4:7], s46 offen sc1 lds
    buffer_load_dwordx4 v227, s[72:75], s46 offen offset:1024 sc1 lds
    s_sub_u32 s26, s48, s29
    s_mov_b32 s29, s48
    s_mov_b32 s30, s3
    s_bfe_u32 s56, s3, 0x40012
    v_mfma_f32_32x32x16_bf16 v[32:47], v[64:67], v[180:183], 0
    s_cmp_eq_u32 s34, 0
    s_cselect_b32 s56, s56, 0
    v_mfma_f32_32x32x16_bf16 v[48:63], v[68:71], v[180:183], 0
    s_setprio 0
    v_mul_f32 v242, v0, v144
    v_fma_f32 v238, v8, v160, -v238
    v_fmac_f32 v242, v1, v145
    v_fmac_f32 v238, v9, v161
    v_fmac_f32 v242, v2, v146
    v_fmac_f32 v238, v10, v162
    v_fmac_f32 v242, v3, v147
    v_fmac_f32 v238, v11, v163
    v_fmac_f32 v242, v4, v148
    v_fmac_f32 v238, v12, v164
    v_fmac_f32 v242, v5, v149
    v_fmac_f32 v238, v13, v165
    v_fmac_f32 v242, v6, v150
    v_fmac_f32 v238, v14, v166
    v_fmac_f32 v242, v7, v151
    v_fmac_f32 v238, v15, v167
    v_fmac_f32 v236, v16, v112
    v_mul_f32 v244, v24, v160
    v_fmac_f32 v236, v17, v113
    v_fmac_f32 v244, v25, v161
    v_fmac_f32 v236, v18, v114
    v_fmac_f32 v244, v26, v162
    v_fmac_f32 v236, v19, v115
    v_fmac_f32 v244, v27, v163
    v_fmac_f32 v236, v20, v116
    v_fmac_f32 v244, v28, v164
    v_fmac_f32 v236, v21, v117
    v_fmac_f32 v244, v29, v165
    v_fmac_f32 v236, v22, v118
    v_fmac_f32 v244, v30, v166
    v_fmac_f32 v236, v23, v119
    v_fmac_f32 v244, v31, v167
    v_mul_f32 v243, v32, v152
    v_fma_f32 v239, v40, v168, -v239
    v_fmac_f32 v243, v33, v153
    v_fmac_f32 v239, v41, v169
    v_fmac_f32 v243, v34, v154
    v_fmac_f32 v239, v42, v170
    v_fmac_f32 v243, v35, v155
    v_fmac_f32 v239, v43, v171
    v_fmac_f32 v243, v36, v156
    v_fmac_f32 v239, v44, v172
    v_fmac_f32 v243, v37, v157
    v_fmac_f32 v239, v45, v173
    v_fmac_f32 v243, v38, v158
    v_fmac_f32 v239, v46, v174
    v_fmac_f32 v243, v39, v159
    v_fmac_f32 v239, v47, v175
    v_fmac_f32 v237, v48, v120
    v_mul_f32 v245, v56, v168
    v_fmac_f32 v237, v49, v121
    v_fmac_f32 v245, v57, v169
    v_fmac_f32 v237, v50, v122
    v_fmac_f32 v245, v58, v170
    v_fmac_f32 v237, v51, v123
    v_fmac_f32 v245, v59, v171
    v_fmac_f32 v237, v52, v124
    v_fmac_f32 v245, v60, v172
    v_fmac_f32 v237, v53, v125
    v_fmac_f32 v245, v61, v173
    v_fmac_f32 v237, v54, v126
    v_fmac_f32 v245, v62, v174
    v_fmac_f32 v237, v55, v127
    v_fmac_f32 v245, v63, v175
    s_setprio 1
    s_waitcnt vmcnt(4) lgkmcnt(0)
    v_mfma_f32_32x32x16_bf16 v[0:15], v[64:67], v[184:187], 0
    ds_read_b64_tr_b16 v[176:177], v246 offset:0
    ds_read_b64_tr_b16 v[178:179], v246 offset:1024
    ds_read_b64_tr_b16 v[180:181], v247 offset:0
    ds_read_b64_tr_b16 v[182:183], v247 offset:1024
    s_mov_b32 m0, s71
    v_mfma_f32_32x32x16_bf16 v[16:31], v[68:71], v[184:187], 0
    buffer_load_dwordx4 v228, s[4:7], s47 offen sc1 lds
    buffer_load_dwordx4 v229, s[72:75], s47 offen offset:1024 sc1 lds
    v_permlane32_swap_b32 v242, v234
    v_permlane32_swap_b32 v243, v235
    v_add_f32 v242, v242, v234
    v_mfma_f32_32x32x16_bf16 v[32:47], v[64:67], v[188:191], 0
    v_add_f32 v243, v243, v235
    s_set_gpr_idx_on s31, gpr_idx(DST)
    s_nop 0
    v_cvt_pk_bf16_f32 v194, v242, v243
    s_set_gpr_idx_off
    s_mov_b32 s32, s31
    s_mov_b32 s31, s35
    v_mfma_f32_32x32x16_bf16 v[48:63], v[68:71], v[188:191], 0
    s_setprio 0
    v_mul_f32 v242, v0, v144
    v_fma_f32 v240, v8, v160, -v240
    v_fmac_f32 v242, v1, v145
    v_fmac_f32 v240, v9, v161
    v_fmac_f32 v242, v2, v146
    v_fmac_f32 v240, v10, v162
    v_fmac_f32 v242, v3, v147
    v_fmac_f32 v240, v11, v163
    v_fmac_f32 v242, v4, v148
    v_fmac_f32 v240, v12, v164
    v_fmac_f32 v242, v5, v149
    v_fmac_f32 v240, v13, v165
    v_fmac_f32 v242, v6, v150
    v_fmac_f32 v240, v14, v166
    v_fmac_f32 v242, v7, v151
    v_fmac_f32 v240, v15, v167
    v_add_u32 v249, s26, v249
    v_add_u32 v250, s26, v250
    v_fma_f32 v244, v16, v160, -v244
    v_fmac_f32 v236, v24, v112
    v_fmac_f32 v244, v17, v161
    v_fmac_f32 v236, v25, v113
    v_fmac_f32 v244, v18, v162
    v_fmac_f32 v236, v26, v114
    v_fmac_f32 v244, v19, v163
    v_fmac_f32 v236, v27, v115
    v_fmac_f32 v244, v20, v164
    v_fmac_f32 v236, v28, v116
    v_fmac_f32 v244, v21, v165
    v_fmac_f32 v236, v29, v117
    v_fmac_f32 v244, v22, v166
    v_fmac_f32 v236, v30, v118
    v_fmac_f32 v244, v23, v167
    v_fmac_f32 v236, v31, v119
    ds_read_b64_tr_b16 v[0:1], v249 offset:0
    ds_read_b64_tr_b16 v[2:3], v249 offset:32
    ds_read_u16_d16_hi v16, v250 offset:0
    v_mul_f32 v243, v32, v152
    v_fma_f32 v241, v40, v168, -v241
    v_fmac_f32 v243, v33, v153
    v_fmac_f32 v241, v41, v169
    v_fmac_f32 v243, v34, v154
    v_fmac_f32 v241, v42, v170
    v_fmac_f32 v243, v35, v155
    v_fmac_f32 v241, v43, v171
    v_fmac_f32 v243, v36, v156
    v_fmac_f32 v241, v44, v172
    v_fmac_f32 v243, v37, v157
    v_fmac_f32 v241, v45, v173
    v_fmac_f32 v243, v38, v158
    v_fmac_f32 v241, v46, v174
    v_fmac_f32 v243, v39, v159
    v_fmac_f32 v241, v47, v175
    ds_read_b64_tr_b16 v[4:5], v249 offset:512
    ds_read_b64_tr_b16 v[6:7], v249 offset:544
    ds_read_u16_d16_hi v17, v250 offset:128
    v_fma_f32 v245, v48, v168, -v245
    v_fmac_f32 v237, v56, v120
    v_fmac_f32 v245, v49, v169
    v_fmac_f32 v237, v57, v121
    v_fmac_f32 v245, v50, v170
    v_fmac_f32 v237, v58, v122
    v_fmac_f32 v245, v51, v171
    v_fmac_f32 v237, v59, v123
    v_fmac_f32 v245, v52, v172
    v_fmac_f32 v237, v60, v124
    v_fmac_f32 v245, v53, v173
    v_fmac_f32 v237, v61, v125
    v_fmac_f32 v245, v54, v174
    v_fmac_f32 v237, v62, v126
    v_fmac_f32 v245, v55, v175
    v_fmac_f32 v237, v63, v127
    s_cmp_eq_u32 s56, 5
    s_cbranch_scc1 K2_U20
    s_cmp_eq_u32 s56, 6
    s_cbranch_scc1 K2_U3h0
    s_branch K2_DSP0
K2_U40:
    s_setprio 1
    ds_read_b64_tr_b16 v[8:9], v249 offset:1024
    ds_read_b64_tr_b16 v[10:11], v249 offset:1056
    ds_read_u16_d16_hi v18, v250 offset:256
    s_lshr_b32 s65, s30, 27
    s_mul_i32 s66, s22, 2080
    s_lshl_b32 s65, s65, 9
    s_add_u32 s65, s65, s66
    s_add_u32 s65, s65, 65536
    s_sub_u32 s65, s65, s29
    s_sub_u32 s65, s65, 512
    v_add_u32 v56, s65, v249
    ds_read_b64_tr_b16 v[12:13], v56 offset:0
    ds_read_b64_tr_b16 v[14:15], v56 offset:32
    ds_read_u16_d16_hi v19, v250 offset:384
    s_waitcnt lgkmcnt(6)
    v_lshlrev_b32 v20, 16, v0
    v_and_b32 v21, 0xffff0000, v0
    v_lshlrev_b32 v22, 16, v1
    v_and_b32 v23, 0xffff0000, v1
    v_lshlrev_b32 v24, 16, v2
    v_and_b32 v25, 0xffff0000, v2
    v_lshlrev_b32 v26, 16, v3
    v_and_b32 v27, 0xffff0000, v3
    v_mul_f32_dpp v36, v16, v20 row_newbcast:8 row_mask:0xf bank_mask:0xf
    v_mul_f32_dpp v37, v16, v21 row_newbcast:9 row_mask:0xf bank_mask:0xf
    v_mul_f32_dpp v38, v16, v22 row_newbcast:10 row_mask:0xf bank_mask:0xf
    v_mul_f32_dpp v39, v16, v23 row_newbcast:11 row_mask:0xf bank_mask:0xf
    v_mul_f32_dpp v40, v16, v24 row_newbcast:12 row_mask:0xf bank_mask:0xf
    v_mul_f32_dpp v41, v16, v25 row_newbcast:13 row_mask:0xf bank_mask:0xf
    v_mul_f32_dpp v42, v16, v26 row_newbcast:14 row_mask:0xf bank_mask:0xf
    v_mul_f32_dpp v43, v16, v27 row_newbcast:15 row_mask:0xf bank_mask:0xf
    v_cvt_pk_bf16_f32 v68, v36, v37
    v_cvt_pk_bf16_f32 v69, v38, v39
    v_cvt_pk_bf16_f32 v70, v40, v41
    v_cvt_pk_bf16_f32 v71, v42, v43
    v_mul_f32_dpp v20, v16, v20 row_newbcast:0 row_mask:0xa bank_mask:0xf
    v_mul_f32_dpp v21, v16, v21 row_newbcast:1 row_mask:0xa bank_mask:0xf
    v_mul_f32_dpp v22, v16, v22 row_newbcast:2 row_mask:0xa bank_mask:0xf
    v_mul_f32_dpp v23, v16, v23 row_newbcast:3 row_mask:0xa bank_mask:0xf
    v_mul_f32_dpp v24, v16, v24 row_newbcast:4 row_mask:0xa bank_mask:0xf
    v_mul_f32_dpp v25, v16, v25 row_newbcast:5 row_mask:0xa bank_mask:0xf
    v_mul_f32_dpp v26, v16, v26 row_newbcast:6 row_mask:0xa bank_mask:0xf
    v_mul_f32_dpp v27, v16, v27 row_newbcast:7 row_mask:0xa bank_mask:0xf
    v_cvt_pk_bf16_f32 v64, v20, v21
    v_cvt_pk_bf16_f32 v65, v22, v23
    v_cvt_pk_bf16_f32 v66, v24, v25
    v_cvt_pk_bf16_f32 v67, v26, v27
    v_lshlrev_b32 v28, 16, v4
    v_and_b32 v29, 0xffff0000, v4
    v_lshlrev_b32 v30, 16, v5
    v_and_b32 v31, 0xffff0000, v5
    v_lshlrev_b32 v32, 16, v6
    v_and_b32 v33, 0xffff0000, v6
    v_lshlrev_b32 v34, 16, v7
    v_and_b32 v35, 0xffff0000, v7
    v_mul_f32_dpp v36, v17, v28 row_newbcast:8 row_mask:0xf bank_mask:0xf
    v_mul_f32_dpp v37, v17, v29 row_newbcast:9 row_mask:0xf bank_mask:0xf
    v_mul_f32_dpp v38, v17, v30 row_newbcast:10 row_mask:0xf bank_mask:0xf
    v_mul_f32_dpp v39, v17, v31 row_newbcast:11 row_mask:0xf bank_mask:0xf
    v_mul_f32_dpp v40, v17, v32 row_newbcast:12 row_mask:0xf bank_mask:0xf
    v_mul_f32_dpp v41, v17, v33 row_newbcast:13 row_mask:0xf bank_mask:0xf
    v_mul_f32_dpp v42, v17, v34 row_newbcast:14 row_mask:0xf bank_mask:0xf
    v_mul_f32_dpp v43, v17, v35 row_newbcast:15 row_mask:0xf bank_mask:0xf
    v_cvt_pk_bf16_f32 v76, v36, v37
    v_cvt_pk_bf16_f32 v77, v38, v39
    v_cvt_pk_bf16_f32 v78, v40, v41
    v_cvt_pk_bf16_f32 v79, v42, v43
    v_mul_f32_dpp v28, v17, v28 row_newbcast:0 row_mask:0xa bank_mask:0xf
    v_mul_f32_dpp v29, v17, v29 row_newbcast:1 row_mask:0xa bank_mask:0xf
    v_mul_f32_dpp v30, v17, v30 row_newbcast:2 row_mask:0xa bank_mask:0xf
    v_mul_f32_dpp v31, v17, v31 row_newbcast:3 row_mask:0xa bank_mask:0xf
    v_mul_f32_dpp v32, v17, v32 row_newbcast:4 row_mask:0xa bank_mask:0xf
    v_mul_f32_dpp v33, v17, v33 row_newbcast:5 row_mask:0xa bank_mask:0xf
    v_mul_f32_dpp v34, v17, v34 row_newbcast:6 row_mask:0xa bank_mask:0xf
    v_mul_f32_dpp v35, v17, v35 row_newbcast:7 row_mask:0xa bank_mask:0xf
    v_cvt_pk_bf16_f32 v72, v28, v29
    v_cvt_pk_bf16_f32 v73, v30, v31
    v_cvt_pk_bf16_f32 v74, v32, v33
    v_cvt_pk_bf16_f32 v75, v34, v35
    s_waitcnt lgkmcnt(3)
    v_lshlrev_b32 v20, 16, v8
    v_and_b32 v21, 0xffff0000, v8
    v_lshlrev_b32 v22, 16, v9
    v_and_b32 v23, 0xffff0000, v9
    v_lshlrev_b32 v24, 16, v10
    v_and_b32 v25, 0xffff0000, v10
    v_lshlrev_b32 v26, 16, v11
    v_and_b32 v27, 0xffff0000, v11
    v_mul_f32_dpp v36, v18, v20 row_newbcast:8 row_mask:0xf bank_mask:0xf
    v_mul_f32_dpp v37, v18, v21 row_newbcast:9 row_mask:0xf bank_mask:0xf
    v_mul_f32_dpp v38, v18, v22 row_newbcast:10 row_mask:0xf bank_mask:0xf
    v_mul_f32_dpp v39, v18, v23 row_newbcast:11 row_mask:0xf bank_mask:0xf
    v_mul_f32_dpp v40, v18, v24 row_newbcast:12 row_mask:0xf bank_mask:0xf
    v_mul_f32_dpp v41, v18, v25 row_newbcast:13 row_mask:0xf bank_mask:0xf
    v_mul_f32_dpp v42, v18, v26 row_newbcast:14 row_mask:0xf bank_mask:0xf
    v_mul_f32_dpp v43, v18, v27 row_newbcast:15 row_mask:0xf bank_mask:0xf
    v_cvt_pk_bf16_f32 v84, v36, v37
    v_cvt_pk_bf16_f32 v85, v38, v39
    v_cvt_pk_bf16_f32 v86, v40, v41
    v_cvt_pk_bf16_f32 v87, v42, v43
    v_mul_f32_dpp v20, v18, v20 row_newbcast:0 row_mask:0xa bank_mask:0xf
    v_mul_f32_dpp v21, v18, v21 row_newbcast:1 row_mask:0xa bank_mask:0xf
    v_mul_f32_dpp v22, v18, v22 row_newbcast:2 row_mask:0xa bank_mask:0xf
    v_mul_f32_dpp v23, v18, v23 row_newbcast:3 row_mask:0xa bank_mask:0xf
    v_mul_f32_dpp v24, v18, v24 row_newbcast:4 row_mask:0xa bank_mask:0xf
    v_mul_f32_dpp v25, v18, v25 row_newbcast:5 row_mask:0xa bank_mask:0xf
    v_mul_f32_dpp v26, v18, v26 row_newbcast:6 row_mask:0xa bank_mask:0xf
    v_mul_f32_dpp v27, v18, v27 row_newbcast:7 row_mask:0xa bank_mask:0xf
    v_cvt_pk_bf16_f32 v80, v20, v21
    v_cvt_pk_bf16_f32 v81, v22, v23
    v_cvt_pk_bf16_f32 v82, v24, v25
    v_cvt_pk_bf16_f32 v83, v26, v27
    s_waitcnt lgkmcnt(0)
    v_lshlrev_b32 v28, 16, v12
    v_and_b32 v29, 0xffff0000, v12
    v_lshlrev_b32 v30, 16, v13
    v_and_b32 v31, 0xffff0000, v13
    v_lshlrev_b32 v32, 16, v14
    v_and_b32 v33, 0xffff0000, v14
    v_lshlrev_b32 v34, 16, v15
    v_and_b32 v35, 0xffff0000, v15
    v_mul_f32_dpp v36, v19, v28 row_newbcast:8 row_mask:0xf bank_mask:0xf
    v_mul_f32_dpp v37, v19, v29 row_newbcast:9 row_mask:0xf bank_mask:0xf
    v_mul_f32_dpp v38, v19, v30 row_newbcast:10 row_mask:0xf bank_mask:0xf
    v_mul_f32_dpp v39, v19, v31 row_newbcast:11 row_mask:0xf bank_mask:0xf
    v_mul_f32_dpp v40, v19, v32 row_newbcast:12 row_mask:0xf bank_mask:0xf
    v_mul_f32_dpp v41, v19, v33 row_newbcast:13 row_mask:0xf bank_mask:0xf
    v_mul_f32_dpp v42, v19, v34 row_newbcast:14 row_mask:0xf bank_mask:0xf
    v_mul_f32_dpp v43, v19, v35 row_newbcast:15 row_mask:0xf bank_mask:0xf
    v_cvt_pk_bf16_f32 v92, v36, v37
    v_cvt_pk_bf16_f32 v93, v38, v39
    v_cvt_pk_bf16_f32 v94, v40, v41
    v_cvt_pk_bf16_f32 v95, v42, v43
    v_mul_f32_dpp v28, v19, v28 row_newbcast:0 row_mask:0xa bank_mask:0xf
    v_mul_f32_dpp v29, v19, v29 row_newbcast:1 row_mask:0xa bank_mask:0xf
    v_mul_f32_dpp v30, v19, v30 row_newbcast:2 row_mask:0xa bank_mask:0xf
    v_mul_f32_dpp v31, v19, v31 row_newbcast:3 row_mask:0xa bank_mask:0xf
    v_mul_f32_dpp v32, v19, v32 row_newbcast:4 row_mask:0xa bank_mask:0xf
    v_mul_f32_dpp v33, v19, v33 row_newbcast:5 row_mask:0xa bank_mask:0xf
    v_mul_f32_dpp v34, v19, v34 row_newbcast:6 row_mask:0xa bank_mask:0xf
    v_mul_f32_dpp v35, v19, v35 row_newbcast:7 row_mask:0xa bank_mask:0xf
    v_cvt_pk_bf16_f32 v88, v28, v29
    v_cvt_pk_bf16_f32 v89, v30, v31
    v_cvt_pk_bf16_f32 v90, v32, v33
    v_cvt_pk_bf16_f32 v91, v34, v35
    s_waitcnt vmcnt(4)
    v_mfma_f32_32x32x16_bf16 v[0:15], v[64:67], v[176:179], 0
    ds_read_b64_tr_b16 v[184:185], v246 offset:2048
    ds_read_b64_tr_b16 v[186:187], v246 offset:3072
    ds_read_b64_tr_b16 v[188:189], v247 offset:2048
    ds_read_b64_tr_b16 v[190:191], v247 offset:3072
    s_mov_b32 m0, s68
    v_mfma_f32_32x32x16_bf16 v[16:31], v[68:71], v[176:179], 0
    buffer_load_dwordx4 v222, s[4:7], s41 offen sc1 lds
    buffer_load_dwordx4 v223, s[72:75], s41 offen offset:1024 sc1 lds
    v_permlane32_swap_b32 v242, v236
    v_permlane32_swap_b32 v243, v237
    s_add_u32 s38, s38, 1
    v_mfma_f32_32x32x16_bf16 v[32:47], v[64:67], v[180:183], 0
    v_permlane32_swap_b32 v244, v238
    v_permlane32_swap_b32 v245, v239
    v_permlane32_swap_b32 v240, v241
    v_add_f32 v242, v242, v236
    v_mfma_f32_32x32x16_bf16 v[48:63], v[68:71], v[180:183], 0
    v_add_f32 v243, v243, v237
    v_add_f32 v244, v244, v238
    v_add_f32 v245, v245, v239
    v_add_f32 v240, -v240, -v241
    v_mov_b32 v254, s52
    v_mov_b32 v255, s38
    s_waitcnt vmcnt(4) lgkmcnt(0)
    v_mfma_f32_32x32x16_bf16 v[0:15], v[72:75], v[184:187], v[0:15]
    ds_read_b64_tr_b16 v[176:177], v246 offset:4096
    ds_read_b64_tr_b16 v[178:179], v246 offset:5120
    ds_read_b64_tr_b16 v[180:181], v247 offset:4096
    ds_read_b64_tr_b16 v[182:183], v247 offset:5120
    s_lshl_b32 s58, s38, 3
    s_add_u32 s58, s58, s20
    s_mov_b32 m0, s69
    v_mfma_f32_32x32x16_bf16 v[16:31], v[76:79], v[184:187], v[16:31]
    buffer_load_dwordx4 v224, s[4:7], s41 offen sc1 lds
    buffer_load_dwordx4 v225, s[72:75], s41 offen offset:1024 sc1 lds
    s_set_gpr_idx_on s32, gpr_idx(DST)
    s_nop 0
    v_cvt_pk_bf16_f32 v195, v242, v243
    v_cvt_pk_bf16_f32 v196, v244, v245
    v_cvt_pk_bf16_f32 v197, v240, v240
    s_set_gpr_idx_off
    s_mov_b64 exec, 1
    ds_write_b32 v254, v255
    s_mov_b64 exec, -1
    s_cmp_lt_u32 s58, s22
    s_cbranch_scc0 K2_dyn_81
K2_back_82:
    v_readlane_b32 s3, v253, s58
    s_lshl_b32 s44, s34, 7
    s_and_b32 s48, s3, 0x3ffff
    s_bfe_u32 s33, s3, 0x30013
    s_mul_i32 s35, s38, 6
    s_cmp_eq_u32 s34, 0
    s_cselect_b32 s35, s35, s48
    s_mov_b32 s45, s44
    s_add_u32 s47, s44, 256
    s_add_u32 s49, s48, 128
    s_add_u32 s60, s48, 256
    s_cmp_eq_u32 s33, 3
    s_cselect_b32 s46, s44, s47
    s_cselect_b32 s50, s60, s48
    s_cselect_b32 s51, s48, s49
    s_sub_u32 s60, s33, 2
    s_cmp_lt_u32 s60, 2
    s_cbranch_scc0 K2_rare_87
K2_back_88:
    v_mfma_f32_32x32x16_bf16 v[32:47], v[72:75], v[188:191], v[32:47]
    v_add_u32 v233, s48, v230
    ds_read_b32 v232, v233
    ds_read_b32 v233, v233 offset:1024
    v_mfma_f32_32x32x16_bf16 v[48:63], v[76:79], v[188:191], v[48:63]
    s_waitcnt vmcnt(4) lgkmcnt(3)
    v_mfma_f32_32x32x16_bf16 v[0:15], v[80:83], v[176:179], v[0:15]
    ds_read_b64_tr_b16 v[184:185], v246 offset:6144
    ds_read_b64_tr_b16 v[186:187], v246 offset:7168
    ds_read_b64_tr_b16 v[188:189], v247 offset:6144
    ds_read_b64_tr_b16 v[190:191], v247 offset:7168
    s_mov_b32 m0, s70
    v_mfma_f32_32x32x16_bf16 v[16:31], v[84:87], v[176:179], v[16:31]
    buffer_load_dwordx4 v226, s[4:7], s41 offen sc1 lds
    buffer_load_dwordx4 v227, s[72:75], s41 offen offset:1024 sc1 lds
    v_mfma_f32_32x32x16_bf16 v[32:47], v[80:83], v[180:183], v[32:47]
    v_mfma_f32_32x32x16_bf16 v[48:63], v[84:87], v[180:183], v[48:63]
    s_waitcnt lgkmcnt(4)
    v_or_b32 v232, v232, v231
    v_or_b32 v233, v233, v231
    s_cmp_lg_u32 s34, 0
    s_cbranch_scc1 K2_dum_90
    s_cmp_eq_u32 s33, 4
    s_cbranch_scc1 K2_a4_91
K2_b4_93:
    s_add_u32 m0, s48, 512
    s_add_u32 s65, s48, 1536
    buffer_load_dwordx4 v232, s[16:19], 0 offen  lds
    s_mov_b32 m0, s65
    s_mov_b32 exec_hi, 0
    buffer_load_dwordx4 v233, s[16:19], 0 offen  lds
    s_mov_b32 exec_hi, -1
K2_back_92:
    s_waitcnt vmcnt(6) lgkmcnt(0)
    v_mfma_f32_32x32x16_bf16 v[0:15], v[88:91], v[184:187], v[0:15]
    ds_read_b64_tr_b16 v[176:177], v246 offset:0
    ds_read_b64_tr_b16 v[178:179], v246 offset:1024
    ds_read_b64_tr_b16 v[180:181], v247 offset:0
    ds_read_b64_tr_b16 v[182:183], v247 offset:1024
    s_mov_b32 m0, s71
    v_mfma_f32_32x32x16_bf16 v[16:31], v[92:95], v[184:187], v[16:31]
    buffer_load_dwordx4 v228, s[4:7], s41 offen sc1 lds
    buffer_load_dwordx4 v229, s[72:75], s41 offen offset:1024 sc1 lds
    v_mfma_f32_32x32x16_bf16 v[32:47], v[88:91], v[188:191], v[32:47]
    s_nop 2
    v_mul_f32 v234, v0, v96
    v_mul_f32 v236, v8, v128
    v_fmac_f32 v234, v1, v97
    v_fmac_f32 v236, v9, v129
    v_fmac_f32 v234, v2, v98
    v_fmac_f32 v236, v10, v130
    v_fmac_f32 v234, v3, v99
    v_mfma_f32_32x32x16_bf16 v[48:63], v[92:95], v[188:191], v[48:63]
    s_setprio 0
    v_fmac_f32 v236, v11, v131
    v_fmac_f32 v234, v4, v100
    v_fmac_f32 v236, v12, v132
    v_fmac_f32 v234, v5, v101
    v_fmac_f32 v236, v13, v133
    v_fmac_f32 v234, v6, v102
    v_fmac_f32 v236, v14, v134
    v_fmac_f32 v234, v7, v103
    v_fmac_f32 v236, v15, v135
    v_mul_f32 v238, v16, v128
    v_mul_f32 v240, v24, v128
    v_fmac_f32 v238, v17, v129
    v_fmac_f32 v240, v25, v129
    v_fmac_f32 v238, v18, v130
    v_fmac_f32 v240, v26, v130
    v_fmac_f32 v238, v19, v131
    v_fmac_f32 v240, v27, v131
    v_fmac_f32 v238, v20, v132
    v_fmac_f32 v240, v28, v132
    v_fmac_f32 v238, v21, v133
    v_fmac_f32 v240, v29, v133
    v_fmac_f32 v238, v22, v134
    v_fmac_f32 v240, v30, v134
    v_fmac_f32 v238, v23, v135
    v_fmac_f32 v240, v31, v135
    v_mul_f32 v235, v32, v104
    v_mul_f32 v237, v40, v136
    v_fmac_f32 v235, v33, v105
    v_fmac_f32 v237, v41, v137
    v_fmac_f32 v235, v34, v106
    v_fmac_f32 v237, v42, v138
    v_fmac_f32 v235, v35, v107
    v_fmac_f32 v237, v43, v139
    v_fmac_f32 v235, v36, v108
    v_fmac_f32 v237, v44, v140
    v_fmac_f32 v235, v37, v109
    v_fmac_f32 v237, v45, v141
    v_fmac_f32 v235, v38, v110
    v_fmac_f32 v237, v46, v142
    v_fmac_f32 v235, v39, v111
    v_fmac_f32 v237, v47, v143
    v_mul_f32 v239, v48, v136
    v_mul_f32 v241, v56, v136
    s_setprio 1
    s_waitcnt vmcnt(6) lgkmcnt(0)
    v_mfma_f32_32x32x16_bf16 v[0:15], v[64:67], v[176:179], 0
    ds_read_b64_tr_b16 v[184:185], v246 offset:2048
    ds_read_b64_tr_b16 v[186:187], v246 offset:3072
    ds_read_b64_tr_b16 v[188:189], v247 offset:2048
    ds_read_b64_tr_b16 v[190:191], v247 offset:3072
    v_fmac_f32 v239, v49, v137
    v_fmac_f32 v241, v57, v137
    s_mov_b32 m0, s68
    v_mfma_f32_32x32x16_bf16 v[16:31], v[68:71], v[176:179], 0
    buffer_load_dwordx4 v222, s[4:7], s42 offen sc1 lds
    buffer_load_dwordx4 v223, s[72:75], s42 offen offset:1024 sc1 lds
    v_fmac_f32 v239, v50, v138
    v_fmac_f32 v241, v58, v138
    v_fmac_f32 v239, v51, v139
    v_fmac_f32 v241, v59, v139
    v_fmac_f32 v239, v52, v140
    v_mfma_f32_32x32x16_bf16 v[32:47], v[64:67], v[180:183], 0
    v_fmac_f32 v241, v60, v140
    v_fmac_f32 v239, v53, v141
    v_fmac_f32 v241, v61, v141
    v_fmac_f32 v239, v54, v142
    v_fmac_f32 v241, v62, v142
    v_fmac_f32 v239, v55, v143
    v_fmac_f32 v241, v63, v143
    v_mfma_f32_32x32x16_bf16 v[48:63], v[68:71], v[180:183], 0
    v_permlane32_swap_b32 v234, v236
    v_permlane32_swap_b32 v235, v237
    v_permlane32_swap_b32 v240, v238
    s_waitcnt vmcnt(6) lgkmcnt(0)
    v_mfma_f32_32x32x16_bf16 v[0:15], v[72:75], v[184:187], v[0:15]
    ds_read_b64_tr_b16 v[176:177], v246 offset:4096
    ds_read_b64_tr_b16 v[178:179], v246 offset:5120
    ds_read_b64_tr_b16 v[180:181], v247 offset:4096
    ds_read_b64_tr_b16 v[182:183], v247 offset:5120
    v_permlane32_swap_b32 v241, v239
    s_mov_b32 m0, s69
    v_mfma_f32_32x32x16_bf16 v[16:31], v[76:79], v[184:187], v[16:31]
    buffer_load_dwordx4 v224, s[4:7], s42 offen sc1 lds
    buffer_load_dwordx4 v225, s[72:75], s42 offen offset:1024 sc1 lds
    v_add_f32 v234, v234, v236
    v_add_f32 v235, v235, v237
    v_add_f32 v240, v240, v238
    v_add_f32 v241, v241, v239
    v_mfma_f32_32x32x16_bf16 v[32:47], v[72:75], v[188:191], v[32:47]
    s_set_gpr_idx_on s31, gpr_idx(DST)
    s_nop 0
    v_cvt_pk_bf16_f32 v192, v234, v235
    v_cvt_pk_bf16_f32 v193, v240, v241
    s_set_gpr_idx_off
    v_mfma_f32_32x32x16_bf16 v[48:63], v[76:79], v[188:191], v[48:63]
    s_waitcnt vmcnt(4) lgkmcnt(0)
    v_mfma_f32_32x32x16_bf16 v[0:15], v[80:83], v[176:179], v[0:15]
    ds_read_b64_tr_b16 v[184:185], v246 offset:6144
    ds_read_b64_tr_b16 v[186:187], v246 offset:7168
    ds_read_b64_tr_b16 v[188:189], v247 offset:6144
    ds_read_b64_tr_b16 v[190:191], v247 offset:7168
    s_mov_b32 m0, s70
    v_mfma_f32_32x32x16_bf16 v[16:31], v[84:87], v[176:179], v[16:31]
    buffer_load_dwordx4 v226, s[4:7], s42 offen sc1 lds
    buffer_load_dwordx4 v227, s[72:75], s42 offen offset:1024 sc1 lds
    v_mfma_f32_32x32x16_bf16 v[32:47], v[80:83], v[180:183], v[32:47]
    v_mfma_f32_32x32x16_bf16 v[48:63], v[84:87], v[180:183], v[48:63]
    s_waitcnt vmcnt(4) lgkmcnt(0)
    v_mfma_f32_32x32x16_bf16 v[0:15], v[88:91], v[184:187], v[0:15]
    ds_read_b64_tr_b16 v[176:177], v246 offset:0
    ds_read_b64_tr_b16 v[178:179], v246 offset:1024
    ds_read_b64_tr_b16 v[180:181], v247 offset:0
    ds_read_b64_tr_b16 v[182:183], v247 offset:1024
    s_mov_b32 m0, s71
    v_mfma_f32_32x32x16_bf16 v[16:31], v[92:95], v[184:187], v[16:31]
    buffer_load_dwordx4 v228, s[4:7], s42 offen sc1 lds
    buffer_load_dwordx4 v229, s[72:75], s42 offen offset:1024 sc1 lds
    v_mfma_f32_32x32x16_bf16 v[32:47], v[88:91], v[188:191], v[32:47]
    s_nop 2
    v_mul_f32 v234, v0, v144
    v_mul_f32 v236, v8, v112
    v_fmac_f32 v234, v1, v145
    v_fmac_f32 v236, v9, v113
    v_fmac_f32 v234, v2, v146
    v_fmac_f32 v236, v10, v114
    v_fmac_f32 v234, v3, v147
    v_mfma_f32_32x32x16_bf16 v[48:63], v[92:95], v[188:191], v[48:63]
    s_setprio 0
    v_fmac_f32 v236, v11, v115
    v_fmac_f32 v234, v4, v148
    v_fmac_f32 v236, v12, v116
    v_fmac_f32 v234, v5, v149
    v_fmac_f32 v236, v13, v117
    v_fmac_f32 v234, v6, v150
    v_fmac_f32 v236, v14, v118
    v_fmac_f32 v234, v7, v151
    v_fmac_f32 v236, v15, v119
    v_mul_f32 v238, v16, v160
    v_mul_f32 v240, v24, v160
    v_fmac_f32 v238, v17, v161
    v_fmac_f32 v240, v25, v161
    v_fmac_f32 v238, v18, v162
    v_fmac_f32 v240, v26, v162
    v_fmac_f32 v238, v19, v163
    v_fmac_f32 v240, v27, v163
    v_fmac_f32 v238, v20, v164
    v_fmac_f32 v240, v28, v164
    v_fmac_f32 v238, v21, v165
    v_fmac_f32 v240, v29, v165
    v_fmac_f32 v238, v22, v166
    v_fmac_f32 v240, v30, v166
    v_fmac_f32 v238, v23, v167
    v_fmac_f32 v240, v31, v167
    v_mul_f32 v235, v32, v152
    v_mul_f32 v237, v40, v120
    v_fmac_f32 v235, v33, v153
    v_fmac_f32 v237, v41, v121
    v_fmac_f32 v235, v34, v154
    v_fmac_f32 v237, v42, v122
    v_fmac_f32 v235, v35, v155
    v_fmac_f32 v237, v43, v123
    v_fmac_f32 v235, v36, v156
    v_fmac_f32 v237, v44, v124
    v_fmac_f32 v235, v37, v157
    v_fmac_f32 v237, v45, v125
    v_fmac_f32 v235, v38, v158
    v_fmac_f32 v237, v46, v126
    v_fmac_f32 v235, v39, v159
    v_fmac_f32 v237, v47, v127
    v_mul_f32 v239, v48, v168
    v_mul_f32 v241, v56, v168
    s_setprio 1
    s_waitcnt vmcnt(4) lgkmcnt(0)
    v_mfma_f32_32x32x16_bf16 v[0:15], v[64:67], v[176:179], 0
    ds_read_b64_tr_b16 v[184:185], v246 offset:2048
    ds_read_b64_tr_b16 v[186:187], v246 offset:3072
    ds_read_b64_tr_b16 v[188:189], v247 offset:2048
    ds_read_b64_tr_b16 v[190:191], v247 offset:3072
    v_fmac_f32 v239, v49, v169
    v_fmac_f32 v241, v57, v169
    s_mov_b32 m0, s68
    v_mfma_f32_32x32x16_bf16 v[16:31], v[68:71], v[176:179], 0
    buffer_load_dwordx4 v222, s[4:7], s43 offen sc1 lds
    buffer_load_dwordx4 v223, s[72:75], s43 offen offset:1024 sc1 lds
    v_fmac_f32 v239, v50, v170
    v_fmac_f32 v241, v58, v170
    v_fmac_f32 v239, v51, v171
    v_fmac_f32 v241, v59, v171
    v_fmac_f32 v239, v52, v172
    v_mfma_f32_32x32x16_bf16 v[32:47], v[64:67], v[180:183], 0
    v_fmac_f32 v241, v60, v172
    v_fmac_f32 v239, v53, v173
    v_fmac_f32 v241, v61, v173
    v_fmac_f32 v239, v54, v174
    v_fmac_f32 v241, v62, v174
    v_fmac_f32 v239, v55, v175
    v_fmac_f32 v241, v63, v175
    v_mfma_f32_32x32x16_bf16 v[48:63], v[68:71], v[180:183], 0
    s_waitcnt vmcnt(4) lgkmcnt(0)
    v_mfma_f32_32x32x16_bf16 v[0:15], v[72:75], v[184:187], v[0:15]
    ds_read_b64_tr_b16 v[176:177], v246 offset:4096
    ds_read_b64_tr_b16 v[178:179], v246 offset:5120
    ds_read_b64_tr_b16 v[180:181], v247 offset:4096
    ds_read_b64_tr_b16 v[182:183], v247 offset:5120
    s_mov_b32 m0, s69
    v_mfma_f32_32x32x16_bf16 v[16:31], v[76:79], v[184:187], v[16:31]
    buffer_load_dwordx4 v224, s[4:7], s43 offen sc1 lds
    buffer_load_dwordx4 v225, s[72:75], s43 offen offset:1024 sc1 lds
    v_mfma_f32_32x32x16_bf16 v[32:47], v[72:75], v[188:191], v[32:47]
    v_mfma_f32_32x32x16_bf16 v[48:63], v[76:79], v[188:191], v[48:63]
    s_waitcnt vmcnt(4) lgkmcnt(0)
    v_mfma_f32_32x32x16_bf16 v[0:15], v[80:83], v[176:179], v[0:15]
    ds_read_b64_tr_b16 v[184:185], v246 offset:6144
    ds_read_b64_tr_b16 v[186:187], v246 offset:7168
    ds_read_b64_tr_b16 v[188:189], v247 offset:6144
    ds_read_b64_tr_b16 v[190:191], v247 offset:7168
    s_mov_b32 m0, s70
    v_mfma_f32_32x32x16_bf16 v[16:31], v[84:87], v[176:179], v[16:31]
    buffer_load_dwordx4 v226, s[4:7], s43 offen sc1 lds
    buffer_load_dwordx4 v227, s[72:75], s43 offen offset:1024 sc1 lds
    v_mfma_f32_32x32x16_bf16 v[32:47], v[80:83], v[180:183], v[32:47]
    v_add_u32 v222, s48, v251
    ds_read2_b32 v[222:223], v222 offset0:1 offset1:3
    v_mfma_f32_32x32x16_bf16 v[48:63], v[84:87], v[180:183], v[48:63]
    s_waitcnt vmcnt(4) lgkmcnt(1)
    v_mfma_f32_32x32x16_bf16 v[0:15], v[88:91], v[184:187], v[0:15]
    ds_read_b64_tr_b16 v[176:177], v246 offset:0
    ds_read_b64_tr_b16 v[178:179], v246 offset:1024
    ds_read_b64_tr_b16 v[180:181], v247 offset:0
    ds_read_b64_tr_b16 v[182:183], v247 offset:1024
    s_mov_b32 m0, s71
    v_mfma_f32_32x32x16_bf16 v[16:31], v[92:95], v[184:187], v[16:31]
    buffer_load_dwordx4 v228, s[4:7], s43 offen sc1 lds
    buffer_load_dwordx4 v229, s[72:75], s43 offen offset:1024 sc1 lds
    s_waitcnt lgkmcnt(4)
    v_mad_u32_u16 v222, v222, s39, v248 op_sel:[1,0,0,0]
    v_mad_u32_u16 v223, v223, s39, v248 op_sel:[1,0,0,0]
    v_mfma_f32_32x32x16_bf16 v[32:47], v[88:91], v[188:191], v[32:47]
    v_add_u32 v224, s49, v251
    ds_read2_b32 v[224:225], v224 offset0:1 offset1:3
    v_mul_f32 v242, v0, v144
    v_fma_f32 v238, v8, v160, -v238
    v_fmac_f32 v242, v1, v145
    v_fmac_f32 v238, v9, v161
    v_fmac_f32 v242, v2, v146
    v_mfma_f32_32x32x16_bf16 v[48:63], v[92:95], v[188:191], v[48:63]
    s_setprio 0
    v_fmac_f32 v238, v10, v162
    v_fmac_f32 v242, v3, v147
    v_fmac_f32 v238, v11, v163
    v_fmac_f32 v242, v4, v148
    v_fmac_f32 v238, v12, v164
    v_fmac_f32 v242, v5, v149
    v_fmac_f32 v238, v13, v165
    v_fmac_f32 v242, v6, v150
    v_fmac_f32 v238, v14, v166
    v_fmac_f32 v242, v7, v151
    v_fmac_f32 v238, v15, v167
    v_fmac_f32 v236, v16, v112
    v_mul_f32 v244, v24, v160
    v_fmac_f32 v236, v17, v113
    v_fmac_f32 v244, v25, v161
    v_fmac_f32 v236, v18, v114
    v_fmac_f32 v244, v26, v162
    v_fmac_f32 v236, v19, v115
    v_fmac_f32 v244, v27, v163
    v_fmac_f32 v236, v20, v116
    v_fmac_f32 v244, v28, v164
    v_fmac_f32 v236, v21, v117
    v_fmac_f32 v244, v29, v165
    v_fmac_f32 v236, v22, v118
    v_fmac_f32 v244, v30, v166
    v_fmac_f32 v236, v23, v119
    v_fmac_f32 v244, v31, v167
    v_mul_f32 v243, v32, v152
    v_fma_f32 v239, v40, v168, -v239
    v_fmac_f32 v243, v33, v153
    v_fmac_f32 v239, v41, v169
    v_fmac_f32 v243, v34, v154
    v_fmac_f32 v239, v42, v170
    v_fmac_f32 v243, v35, v155
    v_fmac_f32 v239, v43, v171
    v_fmac_f32 v243, v36, v156
    v_fmac_f32 v239, v44, v172
    v_fmac_f32 v243, v37, v157
    v_fmac_f32 v239, v45, v173
    v_fmac_f32 v243, v38, v158
    v_fmac_f32 v239, v46, v174
    v_fmac_f32 v243, v39, v159
    v_fmac_f32 v239, v47, v175
    v_fmac_f32 v237, v48, v120
    v_mul_f32 v245, v56, v168
    v_fmac_f32 v237, v49, v121
    v_fmac_f32 v245, v57, v169
    v_fmac_f32 v237, v50, v122
    v_fmac_f32 v245, v58, v170
    v_fmac_f32 v237, v51, v123
    s_setprio 1
    s_waitcnt vmcnt(4) lgkmcnt(1)
    v_mfma_f32_32x32x16_bf16 v[0:15], v[64:67], v[176:179], 0
    ds_read_b64_tr_b16 v[184:185], v246 offset:2048
    ds_read_b64_tr_b16 v[186:187], v246 offset:3072
    ds_read_b64_tr_b16 v[188:189], v247 offset:2048
    ds_read_b64_tr_b16 v[190:191], v247 offset:3072
    v_fmac_f32 v245, v59, v171
    v_fmac_f32 v237, v52, v124
    s_mov_b32 m0, s68
    v_mfma_f32_32x32x16_bf16 v[16:31], v[68:71], v[176:179], 0
    buffer_load_dwordx4 v222, s[4:7], s44 offen sc1 lds
    buffer_load_dwordx4 v223, s[72:75], s44 offen offset:1024 sc1 lds
    s_waitcnt lgkmcnt(4)
    v_mad_u32_u16 v224, v224, s39, v248 op_sel:[1,0,0,0]
    v_mad_u32_u16 v225, v225, s39, v248 op_sel:[1,0,0,0]
    v_fmac_f32 v245, v60, v172
    v_fmac_f32 v237, v53, v125
    v_mfma_f32_32x32x16_bf16 v[32:47], v[64:67], v[180:183], 0
    v_add_u32 v226, s50, v251
    ds_read2_b32 v[226:227], v226 offset0:1 offset1:3
    v_fmac_f32 v245, v61, v173
    v_fmac_f32 v237, v54, v126
    v_fmac_f32 v245, v62, v174
    v_fmac_f32 v237, v55, v127
    v_fmac_f32 v245, v63, v175
    v_mfma_f32_32x32x16_bf16 v[48:63], v[68:71], v[180:183], 0
    v_permlane32_swap_b32 v242, v234
    v_permlane32_swap_b32 v243, v235
    v_add_f32 v242, v242, v234
    v_add_f32 v243, v243, v235
    s_waitcnt vmcnt(4) lgkmcnt(1)
    v_mfma_f32_32x32x16_bf16 v[0:15], v[72:75], v[184:187], v[0:15]
    ds_read_b64_tr_b16 v[176:177], v246 offset:4096
    ds_read_b64_tr_b16 v[178:179], v246 offset:5120
    ds_read_b64_tr_b16 v[180:181], v247 offset:4096
    ds_read_b64_tr_b16 v[182:183], v247 offset:5120
    s_mov_b32 m0, s69
    v_mfma_f32_32x32x16_bf16 v[16:31], v[76:79], v[184:187], v[16:31]
    buffer_load_dwordx4 v224, s[4:7], s45 offen sc1 lds
    buffer_load_dwordx4 v225, s[72:75], s45 offen offset:1024 sc1 lds
    s_waitcnt lgkmcnt(4)
    v_mad_u32_u16 v226, v226, s39, v248 op_sel:[1,0,0,0]
    v_mad_u32_u16 v227, v227, s39, v248 op_sel:[1,0,0,0]
    v_mfma_f32_32x32x16_bf16 v[32:47], v[72:75], v[188:191], v[32:47]
    v_add_u32 v228, s51, v251
    ds_read2_b32 v[228:229], v228 offset0:1 offset1:3
    s_set_gpr_idx_on s31, gpr_idx(DST)
    s_nop 0
    v_cvt_pk_bf16_f32 v194, v242, v243
    s_set_gpr_idx_off
    v_mfma_f32_32x32x16_bf16 v[48:63], v[76:79], v[188:191], v[48:63]
    s_waitcnt vmcnt(4) lgkmcnt(1)
    v_mfma_f32_32x32x16_bf16 v[0:15], v[80:83], v[176:179], v[0:15]
    ds_read_b64_tr_b16 v[184:185], v246 offset:6144
    ds_read_b64_tr_b16 v[186:187], v246 offset:7168
    ds_read_b64_tr_b16 v[188:189], v247 offset:6144
    ds_read_b64_tr_b16 v[190:191], v247 offset:7168
    s_mov_b32 s32, s31
    s_mov_b32 s31, s35
    s_mov_b32 m0, s70
    v_mfma_f32_32x32x16_bf16 v[16:31], v[84:87], v[176:179], v[16:31]
    buffer_load_dwordx4 v226, s[4:7], s46 offen sc1 lds
    buffer_load_dwordx4 v227, s[72:75], s46 offen offset:1024 sc1 lds
    s_waitcnt lgkmcnt(4)
    v_mad_u32_u16 v228, v228, s39, v248 op_sel:[1,0,0,0]
    v_mad_u32_u16 v229, v229, s39, v248 op_sel:[1,0,0,0]
    s_sub_u32 s26, s48, s29
    s_mov_b32 s29, s48
    v_mfma_f32_32x32x16_bf16 v[32:47], v[80:83], v[180:183], v[32:47]
    s_mov_b32 s30, s3
    s_bfe_u32 s56, s3, 0x40012
    s_cmp_eq_u32 s34, 0
    s_cselect_b32 s56, s56, 0
    v_mfma_f32_32x32x16_bf16 v[48:63], v[84:87], v[180:183], v[48:63]
    s_waitcnt vmcnt(4) lgkmcnt(0)
    v_mfma_f32_32x32x16_bf16 v[0:15], v[88:91], v[184:187], v[0:15]
    ds_read_b64_tr_b16 v[176:177], v246 offset:0
    ds_read_b64_tr_b16 v[178:179], v246 offset:1024
    ds_read_b64_tr_b16 v[180:181], v247 offset:0
    ds_read_b64_tr_b16 v[182:183], v247 offset:1024
    s_mov_b32 m0, s71
    v_mfma_f32_32x32x16_bf16 v[16:31], v[92:95], v[184:187], v[16:31]
    buffer_load_dwordx4 v228, s[4:7], s47 offen sc1 lds
    buffer_load_dwordx4 v229, s[72:75], s47 offen offset:1024 sc1 lds
    v_mfma_f32_32x32x16_bf16 v[32:47], v[88:91], v[188:191], v[32:47]
    s_nop 2
    v_mul_f32 v242, v0, v144
    v_fma_f32 v240, v8, v160, -v240
    v_fmac_f32 v242, v1, v145
    v_fmac_f32 v240, v9, v161
    v_fmac_f32 v242, v2, v146
    v_fmac_f32 v240, v10, v162
    v_fmac_f32 v242, v3, v147
    v_mfma_f32_32x32x16_bf16 v[48:63], v[92:95], v[188:191], v[48:63]
    s_setprio 0
    v_fmac_f32 v240, v11, v163
    v_fmac_f32 v242, v4, v148
    v_fmac_f32 v240, v12, v164
    v_fmac_f32 v242, v5, v149
    v_fmac_f32 v240, v13, v165
    v_fmac_f32 v242, v6, v150
    v_fmac_f32 v240, v14, v166
    v_fmac_f32 v242, v7, v151
    v_fmac_f32 v240, v15, v167
    v_add_u32 v249, s26, v249
    v_add_u32 v250, s26, v250
    v_fma_f32 v244, v16, v160, -v244
    v_fmac_f32 v236, v24, v112
    v_fmac_f32 v244, v17, v161
    v_fmac_f32 v236, v25, v113
    v_fmac_f32 v244, v18, v162
    v_fmac_f32 v236, v26, v114
    v_fmac_f32 v244, v19, v163
    v_fmac_f32 v236, v27, v115
    v_fmac_f32 v244, v20, v164
    v_fmac_f32 v236, v28, v116
    v_fmac_f32 v244, v21, v165
    v_fmac_f32 v236, v29, v117
    v_fmac_f32 v244, v22, v166
    v_fmac_f32 v236, v30, v118
    v_fmac_f32 v244, v23, v167
    v_fmac_f32 v236, v31, v119
    ds_read_b64_tr_b16 v[0:1], v249 offset:0
    ds_read_b64_tr_b16 v[2:3], v249 offset:32
    ds_read_u16_d16_hi v16, v250 offset:0
    v_mul_f32 v243, v32, v152
    v_fma_f32 v241, v40, v168, -v241
    v_fmac_f32 v243, v33, v153
    v_fmac_f32 v241, v41, v169
    v_fmac_f32 v243, v34, v154
    v_fmac_f32 v241, v42, v170
    v_fmac_f32 v243, v35, v155
    v_fmac_f32 v241, v43, v171
    v_fmac_f32 v243, v36, v156
    v_fmac_f32 v241, v44, v172
    v_fmac_f32 v243, v37, v157
    v_fmac_f32 v241, v45, v173
    v_fmac_f32 v243, v38, v158
    v_fmac_f32 v241, v46, v174
    v_fmac_f32 v243, v39, v159
    v_fmac_f32 v241, v47, v175
    ds_read_b64_tr_b16 v[4:5], v249 offset:512
    ds_read_b64_tr_b16 v[6:7], v249 offset:544
    ds_read_u16_d16_hi v17, v250 offset:128
    v_fma_f32 v245, v48, v168, -v245
    v_fmac_f32 v237, v56, v120
    v_fmac_f32 v245, v49, v169
    v_fmac_f32 v237, v57, v121
    v_fmac_f32 v245, v50, v170
    v_fmac_f32 v237, v58, v122
    v_fmac_f32 v245, v51, v171
    v_fmac_f32 v237, v59, v123
    v_fmac_f32 v245, v52, v172
    v_fmac_f32 v237, v60, v124
    v_fmac_f32 v245, v53, v173
    v_fmac_f32 v237, v61, v125
    v_fmac_f32 v245, v54, v174
    v_fmac_f32 v237, v62, v126
    v_fmac_f32 v245, v55, v175
    v_fmac_f32 v237, v63, v127
    s_cmp_eq_u32 s56, 5
    s_cbranch_scc1 K2_U20
    s_cmp_eq_u32 s56, 6
    s_cbranch_scc1 K2_U3h0
    s_branch K2_DSP0
K2_U11:
    s_setprio 1
    v_mov_b32 v254, 163296
    v_mov_b32 v255, 1
    v_lshl_add_u32 v233, v252, 1, s53
    s_mov_b64 exec, 1
    ds_add_rtn_u32 v232, v254, v255
    s_mov_b64 exec, -1
    ds_read_b32 v233, v233
    s_waitcnt lgkmcnt(5)
    v_lshlrev_b32 v20, 16, v0
    v_and_b32 v21, 0xffff0000, v0
    v_lshlrev_b32 v22, 16, v1
    v_and_b32 v23, 0xffff0000, v1
    v_lshlrev_b32 v24, 16, v2
    v_and_b32 v25, 0xffff0000, v2
    v_lshlrev_b32 v26, 16, v3
    v_and_b32 v27, 0xffff0000, v3
    v_mul_f32_dpp v36, v16, v20 row_newbcast:8 row_mask:0xf bank_mask:0xf
    v_mul_f32_dpp v37, v16, v21 row_newbcast:9 row_mask:0xf bank_mask:0xf
    v_mul_f32_dpp v38, v16, v22 row_newbcast:10 row_mask:0xf bank_mask:0xf
    v_mul_f32_dpp v39, v16, v23 row_newbcast:11 row_mask:0xf bank_mask:0xf
    v_mul_f32_dpp v40, v16, v24 row_newbcast:12 row_mask:0xf bank_mask:0xf
    v_mul_f32_dpp v41, v16, v25 row_newbcast:13 row_mask:0xf bank_mask:0xf
    v_mul_f32_dpp v42, v16, v26 row_newbcast:14 row_mask:0xf bank_mask:0xf
    v_mul_f32_dpp v43, v16, v27 row_newbcast:15 row_mask:0xf bank_mask:0xf
    v_cvt_pk_bf16_f32 v68, v36, v37
    v_cvt_pk_bf16_f32 v69, v38, v39
    v_cvt_pk_bf16_f32 v70, v40, v41
    v_cvt_pk_bf16_f32 v71, v42, v43
    v_mul_f32_dpp v20, v16, v20 row_newbcast:0 row_mask:0xa bank_mask:0xf
    v_mul_f32_dpp v21, v16, v21 row_newbcast:1 row_mask:0xa bank_mask:0xf
    v_mul_f32_dpp v22, v16, v22 row_newbcast:2 row_mask:0xa bank_mask:0xf
    v_mul_f32_dpp v23, v16, v23 row_newbcast:3 row_mask:0xa bank_mask:0xf
    v_mul_f32_dpp v24, v16, v24 row_newbcast:4 row_mask:0xa bank_mask:0xf
    v_mul_f32_dpp v25, v16, v25 row_newbcast:5 row_mask:0xa bank_mask:0xf
    v_mul_f32_dpp v26, v16, v26 row_newbcast:6 row_mask:0xa bank_mask:0xf
    v_mul_f32_dpp v27, v16, v27 row_newbcast:7 row_mask:0xa bank_mask:0xf
    v_cvt_pk_bf16_f32 v64, v20, v21
    v_cvt_pk_bf16_f32 v65, v22, v23
    v_cvt_pk_bf16_f32 v66, v24, v25
    v_cvt_pk_bf16_f32 v67, v26, v27
    s_waitcnt lgkmcnt(0)
    v_readfirstlane_b32 s58, v232
    s_nop 0
    s_cmp_lt_u32 s58, s22
    s_cbranch_scc0 K2_nul_94
    s_and_b32 s59, s58, 7
    s_lshr_b32 s60, s58, 3
K2_chk_96:
    v_readlane_b32 s61, v233, s59
    s_nop 0
    s_cmp_gt_u32 s61, s60
    s_cbranch_scc0 K2_spin_95
K2_back_97:
    v_readlane_b32 s3, v253, s58
    s_lshl_b32 s44, s34, 7
    s_and_b32 s48, s3, 0x3ffff
    s_bfe_u32 s33, s3, 0x30013
    s_mov_b32 s35, s48
    s_mov_b32 s45, s44
    s_add_u32 s47, s44, 256
    s_add_u32 s49, s48, 128
    s_add_u32 s60, s48, 256
    s_cmp_eq_u32 s33, 3
    s_cselect_b32 s46, s44, s47
    s_cselect_b32 s50, s60, s48
    s_cselect_b32 s51, s48, s49
    s_sub_u32 s60, s33, 2
    s_cmp_lt_u32 s60, 2
    s_cbranch_scc0 K2_rare_98
K2_back_99:
    v_add_u32 v222, s48, v251
    ds_read2_b32 v[222:223], v222 offset0:1 offset1:3
    v_add_u32 v224, s49, v251
    ds_read2_b32 v[224:225], v224 offset0:1 offset1:3
    v_add_u32 v226, s50, v251
    ds_read2_b32 v[226:227], v226 offset0:1 offset1:3
    v_add_u32 v228, s51, v251
    ds_read2_b32 v[228:229], v228 offset0:1 offset1:3
    s_waitcnt lgkmcnt(3)
    v_mad_u32_u16 v222, v222, s39, v248 op_sel:[1,0,0,0]
    v_mad_u32_u16 v223, v223, s39, v248 op_sel:[1,0,0,0]
    s_waitcnt lgkmcnt(2)
    v_mad_u32_u16 v224, v224, s39, v248 op_sel:[1,0,0,0]
    v_mad_u32_u16 v225, v225, s39, v248 op_sel:[1,0,0,0]
    s_waitcnt lgkmcnt(1)
    v_mad_u32_u16 v226, v226, s39, v248 op_sel:[1,0,0,0]
    v_mad_u32_u16 v227, v227, s39, v248 op_sel:[1,0,0,0]
    s_waitcnt lgkmcnt(0)
    v_mad_u32_u16 v228, v228, s39, v248 op_sel:[1,0,0,0]
    v_mad_u32_u16 v229, v229, s39, v248 op_sel:[1,0,0,0]
    s_waitcnt vmcnt(4)
    v_mfma_f32_32x32x16_bf16 v[0:15], v[64:67], v[176:179], 0
    ds_read_b64_tr_b16 v[184:185], v246 offset:2048
    ds_read_b64_tr_b16 v[186:187], v246 offset:3072
    ds_read_b64_tr_b16 v[188:189], v247 offset:2048
    ds_read_b64_tr_b16 v[190:191], v247 offset:3072
    s_mov_b32 m0, s68
    v_mfma_f32_32x32x16_bf16 v[16:31], v[68:71], v[176:179], 0
    buffer_load_dwordx4 v222, s[4:7], s44 offen sc1 lds
    buffer_load_dwordx4 v223, s[72:75], s44 offen offset:1024 sc1 lds
    v_permlane32_swap_b32 v242, v236
    v_permlane32_swap_b32 v243, v237
    v_mfma_f32_32x32x16_bf16 v[32:47], v[64:67], v[180:183], 0
    v_permlane32_swap_b32 v244, v238
    v_permlane32_swap_b32 v245, v239
    v_permlane32_swap_b32 v240, v241
    v_add_f32 v242, v242, v236
    v_mfma_f32_32x32x16_bf16 v[48:63], v[68:71], v[180:183], 0
    s_setprio 0
    v_add_f32 v243, v243, v237
    v_add_f32 v244, v244, v238
    v_add_f32 v245, v245, v239
    v_add_f32 v240, -v240, -v241
    v_sub_u32 v241, v230, v231
    v_cvt_pk_bf16_f32 v242, v242, v243
    v_cvt_pk_bf16_f32 v244, v244, v245
    v_cvt_pk_bf16_f32 v240, v240, v240
    ds_write_b32 v230, v242 offset:768
    ds_write_b32 v230, v244 offset:1024
    ds_write_b16 v241, v240 offset:1280
    v_mul_f32 v234, v0, v96
    v_mul_f32 v236, v8, v128
    v_fmac_f32 v234, v1, v97
    v_fmac_f32 v236, v9, v129
    v_fmac_f32 v234, v2, v98
    v_fmac_f32 v236, v10, v130
    v_fmac_f32 v234, v3, v99
    v_fmac_f32 v236, v11, v131
    v_fmac_f32 v234, v4, v100
    v_fmac_f32 v236, v12, v132
    v_fmac_f32 v234, v5, v101
    v_fmac_f32 v236, v13, v133
    v_fmac_f32 v234, v6, v102
    v_fmac_f32 v236, v14, v134
    v_fmac_f32 v234, v7, v103
    v_fmac_f32 v236, v15, v135
    v_mul_f32 v238, v16, v128
    v_mul_f32 v240, v24, v128
    v_fmac_f32 v238, v17, v129
    v_fmac_f32 v240, v25, v129
    v_fmac_f32 v238, v18, v130
    v_fmac_f32 v240, v26, v130
    v_fmac_f32 v238, v19, v131
    v_fmac_f32 v240, v27, v131
    v_fmac_f32 v238, v20, v132
    v_fmac_f32 v240, v28, v132
    v_fmac_f32 v238, v21, v133
    v_fmac_f32 v240, v29, v133
    v_fmac_f32 v238, v22, v134
    v_fmac_f32 v240, v30, v134
    v_fmac_f32 v238, v23, v135
    v_fmac_f32 v240, v31, v135
    v_mul_f32 v235, v32, v104
    v_mul_f32 v237, v40, v136
    v_fmac_f32 v235, v33, v105
    v_fmac_f32 v237, v41, v137
    v_fmac_f32 v235, v34, v106
    v_fmac_f32 v237, v42, v138
    v_fmac_f32 v235, v35, v107
    v_fmac_f32 v237, v43, v139
    v_fmac_f32 v235, v36, v108
    v_fmac_f32 v237, v44, v140
    v_fmac_f32 v235, v37, v109
    v_fmac_f32 v237, v45, v141
    v_fmac_f32 v235, v38, v110
    v_fmac_f32 v237, v46, v142
    v_fmac_f32 v235, v39, v111
    v_fmac_f32 v237, v47, v143
    v_mul_f32 v239, v48, v136
    v_mul_f32 v241, v56, v136
    v_fmac_f32 v239, v49, v137
    v_fmac_f32 v241, v57, v137
    v_fmac_f32 v239, v50, v138
    v_fmac_f32 v241, v58, v138
    v_fmac_f32 v239, v51, v139
    v_fmac_f32 v241, v59, v139
    v_fmac_f32 v239, v52, v140
    v_fmac_f32 v241, v60, v140
    v_fmac_f32 v239, v53, v141
    v_fmac_f32 v241, v61, v141
    v_fmac_f32 v239, v54, v142
    v_fmac_f32 v241, v62, v142
    v_fmac_f32 v239, v55, v143
    v_fmac_f32 v241, v63, v143
    s_setprio 1
    s_waitcnt vmcnt(4) lgkmcnt(3)
    v_mfma_f32_32x32x16_bf16 v[0:15], v[64:67], v[184:187], 0
    ds_read_b64_tr_b16 v[176:177], v246 offset:4096
    ds_read_b64_tr_b16 v[178:179], v246 offset:5120
    ds_read_b64_tr_b16 v[180:181], v247 offset:4096
    ds_read_b64_tr_b16 v[182:183], v247 offset:5120
    s_mov_b32 m0, s69
    v_mfma_f32_32x32x16_bf16 v[16:31], v[68:71], v[184:187], 0
    buffer_load_dwordx4 v224, s[4:7], s45 offen sc1 lds
    buffer_load_dwordx4 v225, s[72:75], s45 offen offset:1024 sc1 lds
    v_permlane32_swap_b32 v234, v236
    v_permlane32_swap_b32 v235, v237
    v_mfma_f32_32x32x16_bf16 v[32:47], v[64:67], v[188:191], 0
    v_permlane32_swap_b32 v240, v238
    v_permlane32_swap_b32 v241, v239
    v_lshl_add_u32 v230, v252, 1, s31
    v_add_f32 v234, v234, v236
    v_add_f32 v235, v235, v237
    v_mfma_f32_32x32x16_bf16 v[48:63], v[68:71], v[188:191], 0
    s_setprio 0
    v_add_f32 v240, v240, v238
    v_add_f32 v241, v241, v239
    v_cvt_pk_bf16_f32 v234, v234, v235
    v_cvt_pk_bf16_f32 v240, v240, v241
    ds_write_b32 v230, v234 offset:0
    ds_write_b32 v230, v240 offset:256
    v_mul_f32 v234, v0, v144
    v_mul_f32 v236, v8, v112
    v_fmac_f32 v234, v1, v145
    v_fmac_f32 v236, v9, v113
    v_fmac_f32 v234, v2, v146
    v_fmac_f32 v236, v10, v114
    v_fmac_f32 v234, v3, v147
    v_fmac_f32 v236, v11, v115
    v_fmac_f32 v234, v4, v148
    v_fmac_f32 v236, v12, v116
    v_fmac_f32 v234, v5, v149
    v_fmac_f32 v236, v13, v117
    v_fmac_f32 v234, v6, v150
    v_fmac_f32 v236, v14, v118
    v_fmac_f32 v234, v7, v151
    v_fmac_f32 v236, v15, v119
    v_mul_f32 v238, v16, v160
    v_mul_f32 v240, v24, v160
    v_fmac_f32 v238, v17, v161
    v_fmac_f32 v240, v25, v161
    v_fmac_f32 v238, v18, v162
    v_fmac_f32 v240, v26, v162
    v_fmac_f32 v238, v19, v163
    v_fmac_f32 v240, v27, v163
    v_fmac_f32 v238, v20, v164
    v_fmac_f32 v240, v28, v164
    v_fmac_f32 v238, v21, v165
    v_fmac_f32 v240, v29, v165
    v_fmac_f32 v238, v22, v166
    v_fmac_f32 v240, v30, v166
    v_fmac_f32 v238, v23, v167
    v_fmac_f32 v240, v31, v167
    v_mul_f32 v235, v32, v152
    v_mul_f32 v237, v40, v120
    v_fmac_f32 v235, v33, v153
    v_fmac_f32 v237, v41, v121
    v_fmac_f32 v235, v34, v154
    v_fmac_f32 v237, v42, v122
    v_fmac_f32 v235, v35, v155
    v_fmac_f32 v237, v43, v123
    v_fmac_f32 v235, v36, v156
    v_fmac_f32 v237, v44, v124
    v_fmac_f32 v235, v37, v157
    v_fmac_f32 v237, v45, v125
    v_fmac_f32 v235, v38, v158
    v_fmac_f32 v237, v46, v126
    v_fmac_f32 v235, v39, v159
    v_fmac_f32 v237, v47, v127
    v_mul_f32 v239, v48, v168
    v_mul_f32 v241, v56, v168
    v_fmac_f32 v239, v49, v169
    v_fmac_f32 v241, v57, v169
    v_fmac_f32 v239, v50, v170
    v_fmac_f32 v241, v58, v170
    v_fmac_f32 v239, v51, v171
    v_fmac_f32 v241, v59, v171
    v_fmac_f32 v239, v52, v172
    v_fmac_f32 v241, v60, v172
    v_fmac_f32 v239, v53, v173
    v_fmac_f32 v241, v61, v173
    v_fmac_f32 v239, v54, v174
    v_fmac_f32 v241, v62, v174
    v_fmac_f32 v239, v55, v175
    v_fmac_f32 v241, v63, v175
    s_setprio 1
    s_waitcnt vmcnt(4) lgkmcnt(2)
    v_mfma_f32_32x32x16_bf16 v[0:15], v[64:67], v[176:179], 0
    ds_read_b64_tr_b16 v[184:185], v246 offset:6144
    ds_read_b64_tr_b16 v[186:187], v246 offset:7168
    ds_read_b64_tr_b16 v[188:189], v247 offset:6144
    ds_read_b64_tr_b16 v[190:191], v247 offset:7168
    s_mov_b32 s32, s31
    s_mov_b32 s31, s35
    s_mov_b32 m0, s70
    v_mfma_f32_32x32x16_bf16 v[16:31], v[68:71], v[176:179], 0
    buffer_load_dwordx4 v226, s[4:7], s46 offen sc1 lds
    buffer_load_dwordx4 v227, s[72:75], s46 offen offset:1024 sc1 lds
    s_sub_u32 s26, s48, s29
    s_mov_b32 s29, s48
    s_mov_b32 s30, s3
    s_bfe_u32 s56, s3, 0x40012
    v_mfma_f32_32x32x16_bf16 v[32:47], v[64:67], v[180:183], 0
    s_cmp_lg_u32 s36, 0
    s_cselect_b32 s56, s56, 0
    v_mfma_f32_32x32x16_bf16 v[48:63], v[68:71], v[180:183], 0
    s_setprio 0
    v_mul_f32 v242, v0, v144
    v_fma_f32 v238, v8, v160, -v238
    v_fmac_f32 v242, v1, v145
    v_fmac_f32 v238, v9, v161
    v_fmac_f32 v242, v2, v146
    v_fmac_f32 v238, v10, v162
    v_fmac_f32 v242, v3, v147
    v_fmac_f32 v238, v11, v163
    v_fmac_f32 v242, v4, v148
    v_fmac_f32 v238, v12, v164
    v_fmac_f32 v242, v5, v149
    v_fmac_f32 v238, v13, v165
    v_fmac_f32 v242, v6, v150
    v_fmac_f32 v238, v14, v166
    v_fmac_f32 v242, v7, v151
    v_fmac_f32 v238, v15, v167
    v_fmac_f32 v236, v16, v112
    v_mul_f32 v244, v24, v160
    v_fmac_f32 v236, v17, v113
    v_fmac_f32 v244, v25, v161
    v_fmac_f32 v236, v18, v114
    v_fmac_f32 v244, v26, v162
    v_fmac_f32 v236, v19, v115
    v_fmac_f32 v244, v27, v163
    v_fmac_f32 v236, v20, v116
    v_fmac_f32 v244, v28, v164
    v_fmac_f32 v236, v21, v117
    v_fmac_f32 v244, v29, v165
    v_fmac_f32 v236, v22, v118
    v_fmac_f32 v244, v30, v166
    v_fmac_f32 v236, v23, v119
    v_fmac_f32 v244, v31, v167
    v_mul_f32 v243, v32, v152
    v_fma_f32 v239, v40, v168, -v239
    v_fmac_f32 v243, v33, v153
    v_fmac_f32 v239, v41, v169
    v_fmac_f32 v243, v34, v154
    v_fmac_f32 v239, v42, v170
    v_fmac_f32 v243, v35, v155
    v_fmac_f32 v239, v43, v171
    v_fmac_f32 v243, v36, v156
    v_fmac_f32 v239, v44, v172
    v_fmac_f32 v243, v37, v157
    v_fmac_f32 v239, v45, v173
    v_fmac_f32 v243, v38, v158
    v_fmac_f32 v239, v46, v174
    v_fmac_f32 v243, v39, v159
    v_fmac_f32 v239, v47, v175
    v_fmac_f32 v237, v48, v120
    v_mul_f32 v245, v56, v168
    v_fmac_f32 v237, v49, v121
    v_fmac_f32 v245, v57, v169
    v_fmac_f32 v237, v50, v122
    v_fmac_f32 v245, v58, v170
    v_fmac_f32 v237, v51, v123
    v_fmac_f32 v245, v59, v171
    v_fmac_f32 v237, v52, v124
    v_fmac_f32 v245, v60, v172
    v_fmac_f32 v237, v53, v125
    v_fmac_f32 v245, v61, v173
    v_fmac_f32 v237, v54, v126
    v_fmac_f32 v245, v62, v174
    v_fmac_f32 v237, v55, v127
    v_fmac_f32 v245, v63, v175
    s_setprio 1
    s_waitcnt vmcnt(4) lgkmcnt(0)
    v_mfma_f32_32x32x16_bf16 v[0:15], v[64:67], v[184:187], 0
    ds_read_b64_tr_b16 v[176:177], v246 offset:0
    ds_read_b64_tr_b16 v[178:179], v246 offset:1024
    ds_read_b64_tr_b16 v[180:181], v247 offset:0
    ds_read_b64_tr_b16 v[182:183], v247 offset:1024
    s_mov_b32 m0, s71
    v_mfma_f32_32x32x16_bf16 v[16:31], v[68:71], v[184:187], 0
    buffer_load_dwordx4 v228, s[4:7], s47 offen sc1 lds
    buffer_load_dwordx4 v229, s[72:75], s47 offen offset:1024 sc1 lds
    v_permlane32_swap_b32 v242, v234
    v_permlane32_swap_b32 v243, v235
    v_add_f32 v242, v242, v234
    v_mfma_f32_32x32x16_bf16 v[32:47], v[64:67], v[188:191], 0
    v_add_f32 v243, v243, v235
    v_cvt_pk_bf16_f32 v242, v242, v243
    ds_write_b32 v230, v242 offset:512
    v_mfma_f32_32x32x16_bf16 v[48:63], v[68:71], v[188:191], 0
    s_setprio 0
    v_mul_f32 v242, v0, v144
    v_fma_f32 v240, v8, v160, -v240
    v_fmac_f32 v242, v1, v145
    v_fmac_f32 v240, v9, v161
    v_fmac_f32 v242, v2, v146
    v_fmac_f32 v240, v10, v162
    v_fmac_f32 v242, v3, v147
    v_fmac_f32 v240, v11, v163
    v_fmac_f32 v242, v4, v148
    v_fmac_f32 v240, v12, v164
    v_fmac_f32 v242, v5, v149
    v_fmac_f32 v240, v13, v165
    v_fmac_f32 v242, v6, v150
    v_fmac_f32 v240, v14, v166
    v_fmac_f32 v242, v7, v151
    v_fmac_f32 v240, v15, v167
    v_add_u32 v249, s26, v249
    v_add_u32 v250, s26, v250
    v_fma_f32 v244, v16, v160, -v244
    v_fmac_f32 v236, v24, v112
    v_fmac_f32 v244, v17, v161
    v_fmac_f32 v236, v25, v113
    v_fmac_f32 v244, v18, v162
    v_fmac_f32 v236, v26, v114
    v_fmac_f32 v244, v19, v163
    v_fmac_f32 v236, v27, v115
    v_fmac_f32 v244, v20, v164
    v_fmac_f32 v236, v28, v116
    v_fmac_f32 v244, v21, v165
    v_fmac_f32 v236, v29, v117
    v_fmac_f32 v244, v22, v166
    v_fmac_f32 v236, v30, v118
    v_fmac_f32 v244, v23, v167
    v_fmac_f32 v236, v31, v119
    ds_read_b64_tr_b16 v[0:1], v249 offset:0
    ds_read_b64_tr_b16 v[2:3], v249 offset:32
    ds_read_u16_d16_hi v16, v250 offset:0
    v_mul_f32 v243, v32, v152
    v_fma_f32 v241, v40, v168, -v241
    v_fmac_f32 v243, v33, v153
    v_fmac_f32 v241, v41, v169
    v_fmac_f32 v243, v34, v154
    v_fmac_f32 v241, v42, v170
    v_fmac_f32 v243, v35, v155
    v_fmac_f32 v241, v43, v171
    v_fmac_f32 v243, v36, v156
    v_fmac_f32 v241, v44, v172
    v_fmac_f32 v243, v37, v157
    v_fmac_f32 v241, v45, v173
    v_fmac_f32 v243, v38, v158
    v_fmac_f32 v241, v46, v174
    v_fmac_f32 v243, v39, v159
    v_fmac_f32 v241, v47, v175
    ds_read_b64_tr_b16 v[4:5], v249 offset:512
    ds_read_b64_tr_b16 v[6:7], v249 offset:544
    ds_read_u16_d16_hi v17, v250 offset:128
    v_fma_f32 v245, v48, v168, -v245
    v_fmac_f32 v237, v56, v120
    v_fmac_f32 v245, v49, v169
    v_fmac_f32 v237, v57, v121
    v_fmac_f32 v245, v50, v170
    v_fmac_f32 v237, v58, v122
    v_fmac_f32 v245, v51, v171
    v_fmac_f32 v237, v59, v123
    v_fmac_f32 v245, v52, v172
    v_fmac_f32 v237, v60, v124
    v_fmac_f32 v245, v53, v173
    v_fmac_f32 v237, v61, v125
    v_fmac_f32 v245, v54, v174
    v_fmac_f32 v237, v62, v126
    v_fmac_f32 v245, v55, v175
    v_fmac_f32 v237, v63, v127
    s_cmp_eq_u32 s56, 5
    s_cbranch_scc1 K2_U21
    s_cmp_eq_u32 s56, 6
    s_cbranch_scc1 K2_U3h1
    s_branch K2_DSP1
K2_U41:
    s_setprio 1
    ds_read_b64_tr_b16 v[8:9], v249 offset:1024
    ds_read_b64_tr_b16 v[10:11], v249 offset:1056
    ds_read_u16_d16_hi v18, v250 offset:256
    s_lshr_b32 s65, s30, 27
    s_mul_i32 s66, s22, 2080
    s_lshl_b32 s65, s65, 9
    s_add_u32 s65, s65, s66
    s_add_u32 s65, s65, 65536
    s_sub_u32 s65, s65, s29
    s_sub_u32 s65, s65, 512
    v_add_u32 v56, s65, v249
    ds_read_b64_tr_b16 v[12:13], v56 offset:0
    ds_read_b64_tr_b16 v[14:15], v56 offset:32
    ds_read_u16_d16_hi v19, v250 offset:384
    s_waitcnt lgkmcnt(6)
    v_lshlrev_b32 v20, 16, v0
    v_and_b32 v21, 0xffff0000, v0
    v_lshlrev_b32 v22, 16, v1
    v_and_b32 v23, 0xffff0000, v1
    v_lshlrev_b32 v24, 16, v2
    v_and_b32 v25, 0xffff0000, v2
    v_lshlrev_b32 v26, 16, v3
    v_and_b32 v27, 0xffff0000, v3
    v_mul_f32_dpp v36, v16, v20 row_newbcast:8 row_mask:0xf bank_mask:0xf
    v_mul_f32_dpp v37, v16, v21 row_newbcast:9 row_mask:0xf bank_mask:0xf
    v_mul_f32_dpp v38, v16, v22 row_newbcast:10 row_mask:0xf bank_mask:0xf
    v_mul_f32_dpp v39, v16, v23 row_newbcast:11 row_mask:0xf bank_mask:0xf
    v_mul_f32_dpp v40, v16, v24 row_newbcast:12 row_mask:0xf bank_mask:0xf
    v_mul_f32_dpp v41, v16, v25 row_newbcast:13 row_mask:0xf bank_mask:0xf
    v_mul_f32_dpp v42, v16, v26 row_newbcast:14 row_mask:0xf bank_mask:0xf
    v_mul_f32_dpp v43, v16, v27 row_newbcast:15 row_mask:0xf bank_mask:0xf
    v_cvt_pk_bf16_f32 v68, v36, v37
    v_cvt_pk_bf16_f32 v69, v38, v39
    v_cvt_pk_bf16_f32 v70, v40, v41
    v_cvt_pk_bf16_f32 v71, v42, v43
    v_mul_f32_dpp v20, v16, v20 row_newbcast:0 row_mask:0xa bank_mask:0xf
    v_mul_f32_dpp v21, v16, v21 row_newbcast:1 row_mask:0xa bank_mask:0xf
    v_mul_f32_dpp v22, v16, v22 row_newbcast:2 row_mask:0xa bank_mask:0xf
    v_mul_f32_dpp v23, v16, v23 row_newbcast:3 row_mask:0xa bank_mask:0xf
    v_mul_f32_dpp v24, v16, v24 row_newbcast:4 row_mask:0xa bank_mask:0xf
    v_mul_f32_dpp v25, v16, v25 row_newbcast:5 row_mask:0xa bank_mask:0xf
    v_mul_f32_dpp v26, v16, v26 row_newbcast:6 row_mask:0xa bank_mask:0xf
    v_mul_f32_dpp v27, v16, v27 row_newbcast:7 row_mask:0xa bank_mask:0xf
    v_cvt_pk_bf16_f32 v64, v20, v21
    v_cvt_pk_bf16_f32 v65, v22, v23
    v_cvt_pk_bf16_f32 v66, v24, v25
    v_cvt_pk_bf16_f32 v67, v26, v27
    v_lshlrev_b32 v28, 16, v4
    v_and_b32 v29, 0xffff0000, v4
    v_lshlrev_b32 v30, 16, v5
    v_and_b32 v31, 0xffff0000, v5
    v_lshlrev_b32 v32, 16, v6
    v_and_b32 v33, 0xffff0000, v6
    v_lshlrev_b32 v34, 16, v7
    v_and_b32 v35, 0xffff0000, v7
    v_mul_f32_dpp v36, v17, v28 row_newbcast:8 row_mask:0xf bank_mask:0xf
    v_mul_f32_dpp v37, v17, v29 row_newbcast:9 row_mask:0xf bank_mask:0xf
    v_mul_f32_dpp v38, v17, v30 row_newbcast:10 row_mask:0xf bank_mask:0xf
    v_mul_f32_dpp v39, v17, v31 row_newbcast:11 row_mask:0xf bank_mask:0xf
    v_mul_f32_dpp v40, v17, v32 row_newbcast:12 row_mask:0xf bank_mask:0xf
    v_mul_f32_dpp v41, v17, v33 row_newbcast:13 row_mask:0xf bank_mask:0xf
    v_mul_f32_dpp v42, v17, v34 row_newbcast:14 row_mask:0xf bank_mask:0xf
    v_mul_f32_dpp v43, v17, v35 row_newbcast:15 row_mask:0xf bank_mask:0xf
    v_cvt_pk_bf16_f32 v76, v36, v37
    v_cvt_pk_bf16_f32 v77, v38, v39
    v_cvt_pk_bf16_f32 v78, v40, v41
    v_cvt_pk_bf16_f32 v79, v42, v43
    v_mul_f32_dpp v28, v17, v28 row_newbcast:0 row_mask:0xa bank_mask:0xf
    v_mul_f32_dpp v29, v17, v29 row_newbcast:1 row_mask:0xa bank_mask:0xf
    v_mul_f32_dpp v30, v17, v30 row_newbcast:2 row_mask:0xa bank_mask:0xf
    v_mul_f32_dpp v31, v17, v31 row_newbcast:3 row_mask:0xa bank_mask:0xf
    v_mul_f32_dpp v32, v17, v32 row_newbcast:4 row_mask:0xa bank_mask:0xf
    v_mul_f32_dpp v33, v17, v33 row_newbcast:5 row_mask:0xa bank_mask:0xf
    v_mul_f32_dpp v34, v17, v34 row_newbcast:6 row_mask:0xa bank_mask:0xf
    v_mul_f32_dpp v35, v17, v35 row_newbcast:7 row_mask:0xa bank_mask:0xf
    v_cvt_pk_bf16_f32 v72, v28, v29
    v_cvt_pk_bf16_f32 v73, v30, v31
    v_cvt_pk_bf16_f32 v74, v32, v33
    v_cvt_pk_bf16_f32 v75, v34, v35
    s_waitcnt lgkmcnt(3)
    v_lshlrev_b32 v20, 16, v8
    v_and_b32 v21, 0xffff0000, v8
    v_lshlrev_b32 v22, 16, v9
    v_and_b32 v23, 0xffff0000, v9
    v_lshlrev_b32 v24, 16, v10
    v_and_b32 v25, 0xffff0000, v10
    v_lshlrev_b32 v26, 16, v11
    v_and_b32 v27, 0xffff0000, v11
    v_mul_f32_dpp v36, v18, v20 row_newbcast:8 row_mask:0xf bank_mask:0xf
    v_mul_f32_dpp v37, v18, v21 row_newbcast:9 row_mask:0xf bank_mask:0xf
    v_mul_f32_dpp v38, v18, v22 row_newbcast:10 row_mask:0xf bank_mask:0xf
    v_mul_f32_dpp v39, v18, v23 row_newbcast:11 row_mask:0xf bank_mask:0xf
    v_mul_f32_dpp v40, v18, v24 row_newbcast:12 row_mask:0xf bank_mask:0xf
    v_mul_f32_dpp v41, v18, v25 row_newbcast:13 row_mask:0xf bank_mask:0xf
    v_mul_f32_dpp v42, v18, v26 row_newbcast:14 row_mask:0xf bank_mask:0xf
    v_mul_f32_dpp v43, v18, v27 row_newbcast:15 row_mask:0xf bank_mask:0xf
    v_cvt_pk_bf16_f32 v84, v36, v37
    v_cvt_pk_bf16_f32 v85, v38, v39
    v_cvt_pk_bf16_f32 v86, v40, v41
    v_cvt_pk_bf16_f32 v87, v42, v43
    v_mul_f32_dpp v20, v18, v20 row_newbcast:0 row_mask:0xa bank_mask:0xf
    v_mul_f32_dpp v21, v18, v21 row_newbcast:1 row_mask:0xa bank_mask:0xf
    v_mul_f32_dpp v22, v18, v22 row_newbcast:2 row_mask:0xa bank_mask:0xf
    v_mul_f32_dpp v23, v18, v23 row_newbcast:3 row_mask:0xa bank_mask:0xf
    v_mul_f32_dpp v24, v18, v24 row_newbcast:4 row_mask:0xa bank_mask:0xf
    v_mul_f32_dpp v25, v18, v25 row_newbcast:5 row_mask:0xa bank_mask:0xf
    v_mul_f32_dpp v26, v18, v26 row_newbcast:6 row_mask:0xa bank_mask:0xf
    v_mul_f32_dpp v27, v18, v27 row_newbcast:7 row_mask:0xa bank_mask:0xf
    v_cvt_pk_bf16_f32 v80, v20, v21
    v_cvt_pk_bf16_f32 v81, v22, v23
    v_cvt_pk_bf16_f32 v82, v24, v25
    v_cvt_pk_bf16_f32 v83, v26, v27
    s_waitcnt lgkmcnt(0)
    v_lshlrev_b32 v28, 16, v12
    v_and_b32 v29, 0xffff0000, v12
    v_lshlrev_b32 v30, 16, v13
    v_and_b32 v31, 0xffff0000, v13
    v_lshlrev_b32 v32, 16, v14
    v_and_b32 v33, 0xffff0000, v14
    v_lshlrev_b32 v34, 16, v15
    v_and_b32 v35, 0xffff0000, v15
    v_mul_f32_dpp v36, v19, v28 row_newbcast:8 row_mask:0xf bank_mask:0xf
    v_mul_f32_dpp v37, v19, v29 row_newbcast:9 row_mask:0xf bank_mask:0xf
    v_mul_f32_dpp v38, v19, v30 row_newbcast:10 row_mask:0xf bank_mask:0xf
    v_mul_f32_dpp v39, v19, v31 row_newbcast:11 row_mask:0xf bank_mask:0xf
    v_mul_f32_dpp v40, v19, v32 row_newbcast:12 row_mask:0xf bank_mask:0xf
    v_mul_f32_dpp v41, v19, v33 row_newbcast:13 row_mask:0xf bank_mask:0xf
    v_mul_f32_dpp v42, v19, v34 row_newbcast:14 row_mask:0xf bank_mask:0xf
    v_mul_f32_dpp v43, v19, v35 row_newbcast:15 row_mask:0xf bank_mask:0xf
    v_cvt_pk_bf16_f32 v92, v36, v37
    v_cvt_pk_bf16_f32 v93, v38, v39
    v_cvt_pk_bf16_f32 v94, v40, v41
    v_cvt_pk_bf16_f32 v95, v42, v43
    v_mul_f32_dpp v28, v19, v28 row_newbcast:0 row_mask:0xa bank_mask:0xf
    v_mul_f32_dpp v29, v19, v29 row_newbcast:1 row_mask:0xa bank_mask:0xf
    v_mul_f32_dpp v30, v19, v30 row_newbcast:2 row_mask:0xa bank_mask:0xf
    v_mul_f32_dpp v31, v19, v31 row_newbcast:3 row_mask:0xa bank_mask:0xf
    v_mul_f32_dpp v32, v19, v32 row_newbcast:4 row_mask:0xa bank_mask:0xf
    v_mul_f32_dpp v33, v19, v33 row_newbcast:5 row_mask:0xa bank_mask:0xf
    v_mul_f32_dpp v34, v19, v34 row_newbcast:6 row_mask:0xa bank_mask:0xf
    v_mul_f32_dpp v35, v19, v35 row_newbcast:7 row_mask:0xa bank_mask:0xf
    v_cvt_pk_bf16_f32 v88, v28, v29
    v_cvt_pk_bf16_f32 v89, v30, v31
    v_cvt_pk_bf16_f32 v90, v32, v33
    v_cvt_pk_bf16_f32 v91, v34, v35
    s_waitcnt vmcnt(4)
    v_mfma_f32_32x32x16_bf16 v[0:15], v[64:67], v[176:179], 0
    ds_read_b64_tr_b16 v[184:185], v246 offset:2048
    ds_read_b64_tr_b16 v[186:187], v246 offset:3072
    ds_read_b64_tr_b16 v[188:189], v247 offset:2048
    ds_read_b64_tr_b16 v[190:191], v247 offset:3072
    s_mov_b32 m0, s68
    v_mfma_f32_32x32x16_bf16 v[16:31], v[68:71], v[176:179], 0
    buffer_load_dwordx4 v222, s[4:7], s41 offen sc1 lds
    buffer_load_dwordx4 v223, s[72:75], s41 offen offset:1024 sc1 lds
    v_permlane32_swap_b32 v242, v236
    v_permlane32_swap_b32 v243, v237
    v_mov_b32 v254, 163296
    v_mfma_f32_32x32x16_bf16 v[32:47], v[64:67], v[180:183], 0
    v_permlane32_swap_b32 v244, v238
    v_permlane32_swap_b32 v245, v239
    v_permlane32_swap_b32 v240, v241
    v_add_f32 v242, v242, v236
    v_mfma_f32_32x32x16_bf16 v[48:63], v[68:71], v[180:183], 0
    v_add_f32 v243, v243, v237
    v_add_f32 v244, v244, v238
    v_add_f32 v245, v245, v239
    v_add_f32 v240, -v240, -v241
    v_sub_u32 v241, v230, v231
    v_cvt_pk_bf16_f32 v242, v242, v243
    v_mov_b32 v255, 1
    v_lshl_add_u32 v233, v252, 1, s53
    s_mov_b64 exec, 1
    ds_add_rtn_u32 v232, v254, v255
    s_mov_b64 exec, -1
    ds_read_b32 v233, v233
    s_waitcnt vmcnt(4) lgkmcnt(2)
    v_mfma_f32_32x32x16_bf16 v[0:15], v[72:75], v[184:187], v[0:15]
    ds_read_b64_tr_b16 v[176:177], v246 offset:4096
    ds_read_b64_tr_b16 v[178:179], v246 offset:5120
    ds_read_b64_tr_b16 v[180:181], v247 offset:4096
    ds_read_b64_tr_b16 v[182:183], v247 offset:5120
    v_cvt_pk_bf16_f32 v244, v244, v245
    v_cvt_pk_bf16_f32 v240, v240, v240
    s_mov_b32 m0, s69
    v_mfma_f32_32x32x16_bf16 v[16:31], v[76:79], v[184:187], v[16:31]
    buffer_load_dwordx4 v224, s[4:7], s41 offen sc1 lds
    buffer_load_dwordx4 v225, s[72:75], s41 offen offset:1024 sc1 lds
    ds_write_b32 v230, v242 offset:768
    ds_write_b32 v230, v244 offset:1024
    ds_write_b16 v241, v240 offset:1280
    s_waitcnt lgkmcnt(7)
    v_readfirstlane_b32 s58, v232
    v_mfma_f32_32x32x16_bf16 v[32:47], v[72:75], v[188:191], v[32:47]
    s_cmp_lt_u32 s58, s22
    s_cbranch_scc0 K2_nul_101
    s_and_b32 s59, s58, 7
    s_lshr_b32 s60, s58, 3
K2_chk_103:
    v_readlane_b32 s61, v233, s59
    s_nop 0
    s_cmp_gt_u32 s61, s60
    s_cbranch_scc0 K2_spin_102
K2_back_104:
    v_mfma_f32_32x32x16_bf16 v[48:63], v[76:79], v[188:191], v[48:63]
    v_readlane_b32 s3, v253, s58
    s_lshl_b32 s44, s34, 7
    s_and_b32 s48, s3, 0x3ffff
    s_bfe_u32 s33, s3, 0x30013
    s_mov_b32 s35, s48
    s_mov_b32 s45, s44
    s_waitcnt vmcnt(4) lgkmcnt(3)
    v_mfma_f32_32x32x16_bf16 v[0:15], v[80:83], v[176:179], v[0:15]
    ds_read_b64_tr_b16 v[184:185], v246 offset:6144
    ds_read_b64_tr_b16 v[186:187], v246 offset:7168
    ds_read_b64_tr_b16 v[188:189], v247 offset:6144
    ds_read_b64_tr_b16 v[190:191], v247 offset:7168
    s_add_u32 s47, s44, 256
    s_add_u32 s49, s48, 128
    s_mov_b32 m0, s70
    v_mfma_f32_32x32x16_bf16 v[16:31], v[84:87], v[176:179], v[16:31]
    buffer_load_dwordx4 v226, s[4:7], s41 offen sc1 lds
    buffer_load_dwordx4 v227, s[72:75], s41 offen offset:1024 sc1 lds
    s_add_u32 s60, s48, 256
    s_cmp_eq_u32 s33, 3
    s_cselect_b32 s46, s44, s47
    s_cselect_b32 s50, s60, s48
    s_cselect_b32 s51, s48, s49
    v_mfma_f32_32x32x16_bf16 v[32:47], v[80:83], v[180:183], v[32:47]
    s_sub_u32 s60, s33, 2
    s_cmp_lt_u32 s60, 2
    s_cbranch_scc0 K2_rare_105
K2_back_106:
    v_mfma_f32_32x32x16_bf16 v[48:63], v[84:87], v[180:183], v[48:63]
    s_waitcnt vmcnt(4) lgkmcnt(0)
    v_mfma_f32_32x32x16_bf16 v[0:15], v[88:91], v[184:187], v[0:15]
    ds_read_b64_tr_b16 v[176:177], v246 offset:0
    ds_read_b64_tr_b16 v[178:179], v246 offset:1024
    ds_read_b64_tr_b16 v[180:181], v247 offset:0
    ds_read_b64_tr_b16 v[182:183], v247 offset:1024
    s_mov_b32 m0, s71
    v_mfma_f32_32x32x16_bf16 v[16:31], v[92:95], v[184:187], v[16:31]
    buffer_load_dwordx4 v228, s[4:7], s41 offen sc1 lds
    buffer_load_dwordx4 v229, s[72:75], s41 offen offset:1024 sc1 lds
    v_mfma_f32_32x32x16_bf16 v[32:47], v[88:91], v[188:191], v[32:47]
    s_nop 2
    v_mul_f32 v234, v0, v96
    v_mul_f32 v236, v8, v128
    v_fmac_f32 v234, v1, v97
    v_fmac_f32 v236, v9, v129
    v_fmac_f32 v234, v2, v98
    v_fmac_f32 v236, v10, v130
    v_fmac_f32 v234, v3, v99
    v_mfma_f32_32x32x16_bf16 v[48:63], v[92:95], v[188:191], v[48:63]
    s_setprio 0
    v_fmac_f32 v236, v11, v131
    v_fmac_f32 v234, v4, v100
    v_fmac_f32 v236, v12, v132
    v_fmac_f32 v234, v5, v101
    v_fmac_f32 v236, v13, v133
    v_fmac_f32 v234, v6, v102
    v_fmac_f32 v236, v14, v134
    v_fmac_f32 v234, v7, v103
    v_fmac_f32 v236, v15, v135
    v_mul_f32 v238, v16, v128
    v_mul_f32 v240, v24, v128
    v_fmac_f32 v238, v17, v129
    v_fmac_f32 v240, v25, v129
    v_fmac_f32 v238, v18, v130
    v_fmac_f32 v240, v26, v130
    v_fmac_f32 v238, v19, v131
    v_fmac_f32 v240, v27, v131
    v_fmac_f32 v238, v20, v132
    v_fmac_f32 v240, v28, v132
    v_fmac_f32 v238, v21, v133
    v_fmac_f32 v240, v29, v133
    v_fmac_f32 v238, v22, v134
    v_fmac_f32 v240, v30, v134
    v_fmac_f32 v238, v23, v135
    v_fmac_f32 v240, v31, v135
    v_mul_f32 v235, v32, v104
    v_mul_f32 v237, v40, v136
    v_fmac_f32 v235, v33, v105
    v_fmac_f32 v237, v41, v137
    v_fmac_f32 v235, v34, v106
    v_fmac_f32 v237, v42, v138
    v_fmac_f32 v235, v35, v107
    v_fmac_f32 v237, v43, v139
    v_fmac_f32 v235, v36, v108
    v_fmac_f32 v237, v44, v140
    v_fmac_f32 v235, v37, v109
    v_fmac_f32 v237, v45, v141
    v_fmac_f32 v235, v38, v110
    v_fmac_f32 v237, v46, v142
    v_fmac_f32 v235, v39, v111
    v_fmac_f32 v237, v47, v143
    v_mul_f32 v239, v48, v136
    v_mul_f32 v241, v56, v136
    s_setprio 1
    s_waitcnt vmcnt(4) lgkmcnt(0)
    v_mfma_f32_32x32x16_bf16 v[0:15], v[64:67], v[176:179], 0
    ds_read_b64_tr_b16 v[184:185], v246 offset:2048
    ds_read_b64_tr_b16 v[186:187], v246 offset:3072
    ds_read_b64_tr_b16 v[188:189], v247 offset:2048
    ds_read_b64_tr_b16 v[190:191], v247 offset:3072
    v_fmac_f32 v239, v49, v137
    v_fmac_f32 v241, v57, v137
    s_mov_b32 m0, s68
    v_mfma_f32_32x32x16_bf16 v[16:31], v[68:71], v[176:179], 0
    buffer_load_dwordx4 v222, s[4:7], s42 offen sc1 lds
    buffer_load_dwordx4 v223, s[72:75], s42 offen offset:1024 sc1 lds
    v_fmac_f32 v239, v50, v138
    v_fmac_f32 v241, v58, v138
    v_fmac_f32 v239, v51, v139
    v_fmac_f32 v241, v59, v139
    v_fmac_f32 v239, v52, v140
    v_mfma_f32_32x32x16_bf16 v[32:47], v[64:67], v[180:183], 0
    v_fmac_f32 v241, v60, v140
    v_fmac_f32 v239, v53, v141
    v_fmac_f32 v241, v61, v141
    v_fmac_f32 v239, v54, v142
    v_fmac_f32 v241, v62, v142
    v_fmac_f32 v239, v55, v143
    v_fmac_f32 v241, v63, v143
    v_mfma_f32_32x32x16_bf16 v[48:63], v[68:71], v[180:183], 0
    v_permlane32_swap_b32 v234, v236
    v_permlane32_swap_b32 v235, v237
    v_permlane32_swap_b32 v240, v238
    s_waitcnt vmcnt(4) lgkmcnt(0)
    v_mfma_f32_32x32x16_bf16 v[0:15], v[72:75], v[184:187], v[0:15]
    ds_read_b64_tr_b16 v[176:177], v246 offset:4096
    ds_read_b64_tr_b16 v[178:179], v246 offset:5120
    ds_read_b64_tr_b16 v[180:181], v247 offset:4096
    ds_read_b64_tr_b16 v[182:183], v247 offset:5120
    v_permlane32_swap_b32 v241, v239
    s_mov_b32 m0, s69
    v_mfma_f32_32x32x16_bf16 v[16:31], v[76:79], v[184:187], v[16:31]
    buffer_load_dwordx4 v224, s[4:7], s42 offen sc1 lds
    buffer_load_dwordx4 v225, s[72:75], s42 offen offset:1024 sc1 lds
    v_lshl_add_u32 v230, v252, 1, s31
    v_add_f32 v234, v234, v236
    v_add_f32 v235, v235, v237
    v_add_f32 v240, v240, v238
    v_add_f32 v241, v241, v239
    v_mfma_f32_32x32x16_bf16 v[32:47], v[72:75], v[188:191], v[32:47]
    v_cvt_pk_bf16_f32 v234, v234, v235
    v_cvt_pk_bf16_f32 v240, v240, v241
    ds_write_b32 v230, v234 offset:0
    ds_write_b32 v230, v240 offset:256
    v_mfma_f32_32x32x16_bf16 v[48:63], v[76:79], v[188:191], v[48:63]
    s_waitcnt vmcnt(4) lgkmcnt(2)
    v_mfma_f32_32x32x16_bf16 v[0:15], v[80:83], v[176:179], v[0:15]
    ds_read_b64_tr_b16 v[184:185], v246 offset:6144
    ds_read_b64_tr_b16 v[186:187], v246 offset:7168
    ds_read_b64_tr_b16 v[188:189], v247 offset:6144
    ds_read_b64_tr_b16 v[190:191], v247 offset:7168
    s_mov_b32 m0, s70
    v_mfma_f32_32x32x16_bf16 v[16:31], v[84:87], v[176:179], v[16:31]
    buffer_load_dwordx4 v226, s[4:7], s42 offen sc1 lds
    buffer_load_dwordx4 v227, s[72:75], s42 offen offset:1024 sc1 lds
    v_mfma_f32_32x32x16_bf16 v[32:47], v[80:83], v[180:183], v[32:47]
    v_mfma_f32_32x32x16_bf16 v[48:63], v[84:87], v[180:183], v[48:63]
    s_waitcnt vmcnt(4) lgkmcnt(0)
    v_mfma_f32_32x32x16_bf16 v[0:15], v[88:91], v[184:187], v[0:15]
    ds_read_b64_tr_b16 v[176:177], v246 offset:0
    ds_read_b64_tr_b16 v[178:179], v246 offset:1024
    ds_read_b64_tr_b16 v[180:181], v247 offset:0
    ds_read_b64_tr_b16 v[182:183], v247 offset:1024
    s_mov_b32 m0, s71
    v_mfma_f32_32x32x16_bf16 v[16:31], v[92:95], v[184:187], v[16:31]
    buffer_load_dwordx4 v228, s[4:7], s42 offen sc1 lds
    buffer_load_dwordx4 v229, s[72:75], s42 offen offset:1024 sc1 lds
    v_mfma_f32_32x32x16_bf16 v[32:47], v[88:91], v[188:191], v[32:47]
    s_nop 2
    v_mul_f32 v234, v0, v144
    v_mul_f32 v236, v8, v112
    v_fmac_f32 v234, v1, v145
    v_fmac_f32 v236, v9, v113
    v_fmac_f32 v234, v2, v146
    v_fmac_f32 v236, v10, v114
    v_fmac_f32 v234, v3, v147
    v_mfma_f32_32x32x16_bf16 v[48:63], v[92:95], v[188:191], v[48:63]
    s_setprio 0
    v_fmac_f32 v236, v11, v115
    v_fmac_f32 v234, v4, v148
    v_fmac_f32 v236, v12, v116
    v_fmac_f32 v234, v5, v149
    v_fmac_f32 v236, v13, v117
    v_fmac_f32 v234, v6, v150
    v_fmac_f32 v236, v14, v118
    v_fmac_f32 v234, v7, v151
    v_fmac_f32 v236, v15, v119
    v_mul_f32 v238, v16, v160
    v_mul_f32 v240, v24, v160
    v_fmac_f32 v238, v17, v161
    v_fmac_f32 v240, v25, v161
    v_fmac_f32 v238, v18, v162
    v_fmac_f32 v240, v26, v162
    v_fmac_f32 v238, v19, v163
    v_fmac_f32 v240, v27, v163
    v_fmac_f32 v238, v20, v164
    v_fmac_f32 v240, v28, v164
    v_fmac_f32 v238, v21, v165
    v_fmac_f32 v240, v29, v165
    v_fmac_f32 v238, v22, v166
    v_fmac_f32 v240, v30, v166
    v_fmac_f32 v238, v23, v167
    v_fmac_f32 v240, v31, v167
    v_mul_f32 v235, v32, v152
    v_mul_f32 v237, v40, v120
    v_fmac_f32 v235, v33, v153
    v_fmac_f32 v237, v41, v121
    v_fmac_f32 v235, v34, v154
    v_fmac_f32 v237, v42, v122
    v_fmac_f32 v235, v35, v155
    v_fmac_f32 v237, v43, v123
    v_fmac_f32 v235, v36, v156
    v_fmac_f32 v237, v44, v124
    v_fmac_f32 v235, v37, v157
    v_fmac_f32 v237, v45, v125
    v_fmac_f32 v235, v38, v158
    v_fmac_f32 v237, v46, v126
    v_fmac_f32 v235, v39, v159
    v_fmac_f32 v237, v47, v127
    v_mul_f32 v239, v48, v168
    v_mul_f32 v241, v56, v168
    s_setprio 1
    s_waitcnt vmcnt(4) lgkmcnt(0)
    v_mfma_f32_32x32x16_bf16 v[0:15], v[64:67], v[176:179], 0
    ds_read_b64_tr_b16 v[184:185], v246 offset:2048
    ds_read_b64_tr_b16 v[186:187], v246 offset:3072
    ds_read_b64_tr_b16 v[188:189], v247 offset:2048
    ds_read_b64_tr_b16 v[190:191], v247 offset:3072
    v_fmac_f32 v239, v49, v169
    v_fmac_f32 v241, v57, v169
    s_mov_b32 m0, s68
    v_mfma_f32_32x32x16_bf16 v[16:31], v[68:71], v[176:179], 0
    buffer_load_dwordx4 v222, s[4:7], s43 offen sc1 lds
    buffer_load_dwordx4 v223, s[72:75], s43 offen offset:1024 sc1 lds
    v_fmac_f32 v239, v50, v170
    v_fmac_f32 v241, v58, v170
    v_fmac_f32 v239, v51, v171
    v_fmac_f32 v241, v59, v171
    v_fmac_f32 v239, v52, v172
    v_mfma_f32_32x32x16_bf16 v[32:47], v[64:67], v[180:183], 0
    v_fmac_f32 v241, v60, v172
    v_fmac_f32 v239, v53, v173
    v_fmac_f32 v241, v61, v173
    v_fmac_f32 v239, v54, v174
    v_fmac_f32 v241, v62, v174
    v_fmac_f32 v239, v55, v175
    v_fmac_f32 v241, v63, v175
    v_mfma_f32_32x32x16_bf16 v[48:63], v[68:71], v[180:183], 0
    s_waitcnt vmcnt(4) lgkmcnt(0)
    v_mfma_f32_32x32x16_bf16 v[0:15], v[72:75], v[184:187], v[0:15]
    ds_read_b64_tr_b16 v[176:177], v246 offset:4096
    ds_read_b64_tr_b16 v[178:179], v246 offset:5120
    ds_read_b64_tr_b16 v[180:181], v247 offset:4096
    ds_read_b64_tr_b16 v[182:183], v247 offset:5120
    s_mov_b32 m0, s69
    v_mfma_f32_32x32x16_bf16 v[16:31], v[76:79], v[184:187], v[16:31]
    buffer_load_dwordx4 v224, s[4:7], s43 offen sc1 lds
    buffer_load_dwordx4 v225, s[72:75], s43 offen offset:1024 sc1 lds
    v_mfma_f32_32x32x16_bf16 v[32:47], v[72:75], v[188:191], v[32:47]
    v_mfma_f32_32x32x16_bf16 v[48:63], v[76:79], v[188:191], v[48:63]
    s_waitcnt vmcnt(4) lgkmcnt(0)
    v_mfma_f32_32x32x16_bf16 v[0:15], v[80:83], v[176:179], v[0:15]
    ds_read_b64_tr_b16 v[184:185], v246 offset:6144
    ds_read_b64_tr_b16 v[186:187], v246 offset:7168
    ds_read_b64_tr_b16 v[188:189], v247 offset:6144
    ds_read_b64_tr_b16 v[190:191], v247 offset:7168
    s_mov_b32 m0, s70
    v_mfma_f32_32x32x16_bf16 v[16:31], v[84:87], v[176:179], v[16:31]
    buffer_load_dwordx4 v226, s[4:7], s43 offen sc1 lds
    buffer_load_dwordx4 v227, s[72:75], s43 offen offset:1024 sc1 lds
    v_mfma_f32_32x32x16_bf16 v[32:47], v[80:83], v[180:183], v[32:47]
    v_add_u32 v222, s48, v251
    ds_read2_b32 v[222:223], v222 offset0:1 offset1:3
    v_mfma_f32_32x32x16_bf16 v[48:63], v[84:87], v[180:183], v[48:63]
    s_waitcnt vmcnt(4) lgkmcnt(1)
    v_mfma_f32_32x32x16_bf16 v[0:15], v[88:91], v[184:187], v[0:15]
    ds_read_b64_tr_b16 v[176:177], v246 offset:0
    ds_read_b64_tr_b16 v[178:179], v246 offset:1024
    ds_read_b64_tr_b16 v[180:181], v247 offset:0
    ds_read_b64_tr_b16 v[182:183], v247 offset:1024
    s_mov_b32 m0, s71
    v_mfma_f32_32x32x16_bf16 v[16:31], v[92:95], v[184:187], v[16:31]
    buffer_load_dwordx4 v228, s[4:7], s43 offen sc1 lds
    buffer_load_dwordx4 v229, s[72:75], s43 offen offset:1024 sc1 lds
    s_waitcnt lgkmcnt(4)
    v_mad_u32_u16 v222, v222, s39, v248 op_sel:[1,0,0,0]
    v_mad_u32_u16 v223, v223, s39, v248 op_sel:[1,0,0,0]
    v_mfma_f32_32x32x16_bf16 v[32:47], v[88:91], v[188:191], v[32:47]
    v_add_u32 v224, s49, v251
    ds_read2_b32 v[224:225], v224 offset0:1 offset1:3
    v_mul_f32 v242, v0, v144
    v_fma_f32 v238, v8, v160, -v238
    v_fmac_f32 v242, v1, v145
    v_fmac_f32 v238, v9, v161
    v_fmac_f32 v242, v2, v146
    v_mfma_f32_32x32x16_bf16 v[48:63], v[92:95], v[188:191], v[48:63]
    s_setprio 0
    v_fmac_f32 v238, v10, v162
    v_fmac_f32 v242, v3, v147
    v_fmac_f32 v238, v11, v163
    v_fmac_f32 v242, v4, v148
    v_fmac_f32 v238, v12, v164
    v_fmac_f32 v242, v5, v149
    v_fmac_f32 v238, v13, v165
    v_fmac_f32 v242, v6, v150
    v_fmac_f32 v238, v14, v166
    v_fmac_f32 v242, v7, v151
    v_fmac_f32 v238, v15, v167
    v_fmac_f32 v236, v16, v112
    v_mul_f32 v244, v24, v160
    v_fmac_f32 v236, v17, v113
    v_fmac_f32 v244, v25, v161
    v_fmac_f32 v236, v18, v114
    v_fmac_f32 v244, v26, v162
    v_fmac_f32 v236, v19, v115
    v_fmac_f32 v244, v27, v163
    v_fmac_f32 v236, v20, v116
    v_fmac_f32 v244, v28, v164
    v_fmac_f32 v236, v21, v117
    v_fmac_f32 v244, v29, v165
    v_fmac_f32 v236, v22, v118
    v_fmac_f32 v244, v30, v166
    v_fmac_f32 v236, v23, v119
    v_fmac_f32 v244, v31, v167
    v_mul_f32 v243, v32, v152
    v_fma_f32 v239, v40, v168, -v239
    v_fmac_f32 v243, v33, v153
    v_fmac_f32 v239, v41, v169
    v_fmac_f32 v243, v34, v154
    v_fmac_f32 v239, v42, v170
    v_fmac_f32 v243, v35, v155
    v_fmac_f32 v239, v43, v171
    v_fmac_f32 v243, v36, v156
    v_fmac_f32 v239, v44, v172
    v_fmac_f32 v243, v37, v157
    v_fmac_f32 v239, v45, v173
    v_fmac_f32 v243, v38, v158
    v_fmac_f32 v239, v46, v174
    v_fmac_f32 v243, v39, v159
    v_fmac_f32 v239, v47, v175
    v_fmac_f32 v237, v48, v120
    v_mul_f32 v245, v56, v168
    v_fmac_f32 v237, v49, v121
    v_fmac_f32 v245, v57, v169
    v_fmac_f32 v237, v50, v122
    v_fmac_f32 v245, v58, v170
    v_fmac_f32 v237, v51, v123
    s_setprio 1
    s_waitcnt vmcnt(4) lgkmcnt(1)
    v_mfma_f32_32x32x16_bf16 v[0:15], v[64:67], v[176:179], 0
    ds_read_b64_tr_b16 v[184:185], v246 offset:2048
    ds_read_b64_tr_b16 v[186:187], v246 offset:3072
    ds_read_b64_tr_b16 v[188:189], v247 offset:2048
    ds_read_b64_tr_b16 v[190:191], v247 offset:3072
    v_fmac_f32 v245, v59, v171
    v_fmac_f32 v237, v52, v124
    s_mov_b32 m0, s68
    v_mfma_f32_32x32x16_bf16 v[16:31], v[68:71], v[176:179], 0
    buffer_load_dwordx4 v222, s[4:7], s44 offen sc1 lds
    buffer_load_dwordx4 v223, s[72:75], s44 offen offset:1024 sc1 lds
    s_waitcnt lgkmcnt(4)
    v_mad_u32_u16 v224, v224, s39, v248 op_sel:[1,0,0,0]
    v_mad_u32_u16 v225, v225, s39, v248 op_sel:[1,0,0,0]
    v_fmac_f32 v245, v60, v172
    v_fmac_f32 v237, v53, v125
    v_mfma_f32_32x32x16_bf16 v[32:47], v[64:67], v[180:183], 0
    v_add_u32 v226, s50, v251
    ds_read2_b32 v[226:227], v226 offset0:1 offset1:3
    v_fmac_f32 v245, v61, v173
    v_fmac_f32 v237, v54, v126
    v_fmac_f32 v245, v62, v174
    v_fmac_f32 v237, v55, v127
    v_fmac_f32 v245, v63, v175
    v_mfma_f32_32x32x16_bf16 v[48:63], v[68:71], v[180:183], 0
    v_permlane32_swap_b32 v242, v234
    v_permlane32_swap_b32 v243, v235
    v_add_f32 v242, v242, v234
    v_add_f32 v243, v243, v235
    s_waitcnt vmcnt(4) lgkmcnt(1)
    v_mfma_f32_32x32x16_bf16 v[0:15], v[72:75], v[184:187], v[0:15]
    ds_read_b64_tr_b16 v[176:177], v246 offset:4096
    ds_read_b64_tr_b16 v[178:179], v246 offset:5120
    ds_read_b64_tr_b16 v[180:181], v247 offset:4096
    ds_read_b64_tr_b16 v[182:183], v247 offset:5120
    v_cvt_pk_bf16_f32 v242, v242, v243
    ds_write_b32 v230, v242 offset:512
    s_mov_b32 m0, s69
    v_mfma_f32_32x32x16_bf16 v[16:31], v[76:79], v[184:187], v[16:31]
    buffer_load_dwordx4 v224, s[4:7], s45 offen sc1 lds
    buffer_load_dwordx4 v225, s[72:75], s45 offen offset:1024 sc1 lds
    s_waitcnt lgkmcnt(5)
    v_mad_u32_u16 v226, v226, s39, v248 op_sel:[1,0,0,0]
    v_mad_u32_u16 v227, v227, s39, v248 op_sel:[1,0,0,0]
    v_mfma_f32_32x32x16_bf16 v[32:47], v[72:75], v[188:191], v[32:47]
    v_add_u32 v228, s51, v251
    ds_read2_b32 v[228:229], v228 offset0:1 offset1:3
    v_mfma_f32_32x32x16_bf16 v[48:63], v[76:79], v[188:191], v[48:63]
    s_waitcnt vmcnt(4) lgkmcnt(2)
    v_mfma_f32_32x32x16_bf16 v[0:15], v[80:83], v[176:179], v[0:15]
    ds_read_b64_tr_b16 v[184:185], v246 offset:6144
    ds_read_b64_tr_b16 v[186:187], v246 offset:7168
    ds_read_b64_tr_b16 v[188:189], v247 offset:6144
    ds_read_b64_tr_b16 v[190:191], v247 offset:7168
    s_mov_b32 s32, s31
    s_mov_b32 s31, s35
    s_mov_b32 m0, s70
    v_mfma_f32_32x32x16_bf16 v[16:31], v[84:87], v[176:179], v[16:31]
    buffer_load_dwordx4 v226, s[4:7], s46 offen sc1 lds
    buffer_load_dwordx4 v227, s[72:75], s46 offen offset:1024 sc1 lds
    s_waitcnt lgkmcnt(4)
    v_mad_u32_u16 v228, v228, s39, v248 op_sel:[1,0,0,0]
    v_mad_u32_u16 v229, v229, s39, v248 op_sel:[1,0,0,0]
    s_sub_u32 s26, s48, s29
    s_mov_b32 s29, s48
    v_mfma_f32_32x32x16_bf16 v[32:47], v[80:83], v[180:183], v[32:47]
    s_mov_b32 s30, s3
    s_bfe_u32 s56, s3, 0x40012
    s_cmp_lg_u32 s36, 0
    s_cselect_b32 s56, s56, 0
    v_mfma_f32_32x32x16_bf16 v[48:63], v[84:87], v[180:183], v[48:63]
    s_waitcnt vmcnt(4) lgkmcnt(0)
    v_mfma_f32_32x32x16_bf16 v[0:15], v[88:91], v[184:187], v[0:15]
    ds_read_b64_tr_b16 v[176:177], v246 offset:0
    ds_read_b64_tr_b16 v[178:179], v246 offset:1024
    ds_read_b64_tr_b16 v[180:181], v247 offset:0
    ds_read_b64_tr_b16 v[182:183], v247 offset:1024
    s_mov_b32 m0, s71
    v_mfma_f32_32x32x16_bf16 v[16:31], v[92:95], v[184:187], v[16:31]
    buffer_load_dwordx4 v228, s[4:7], s47 offen sc1 lds
    buffer_load_dwordx4 v229, s[72:75], s47 offen offset:1024 sc1 lds
    v_mfma_f32_32x32x16_bf16 v[32:47], v[88:91], v[188:191], v[32:47]
    s_nop 2
    v_mul_f32 v242, v0, v144
    v_fma_f32 v240, v8, v160, -v240
    v_fmac_f32 v242, v1, v145
    v_fmac_f32 v240, v9, v161
    v_fmac_f32 v242, v2, v146
    v_fmac_f32 v240, v10, v162
    v_fmac_f32 v242, v3, v147
    v_mfma_f32_32x32x16_bf16 v[48:63], v[92:95], v[188:191], v[48:63]
    s_setprio 0
    v_fmac_f32 v240, v11, v163
    v_fmac_f32 v242, v4, v148
    v_fmac_f32 v240, v12, v164
    v_fmac_f32 v242, v5, v149
    v_fmac_f32 v240, v13, v165
    v_fmac_f32 v242, v6, v150
    v_fmac_f32 v240, v14, v166
    v_fmac_f32 v242, v7, v151
    v_fmac_f32 v240, v15, v167
    v_add_u32 v249, s26, v249
    v_add_u32 v250, s26, v250
    v_fma_f32 v244, v16, v160, -v244
    v_fmac_f32 v236, v24, v112
    v_fmac_f32 v244, v17, v161
    v_fmac_f32 v236, v25, v113
    v_fmac_f32 v244, v18, v162
    v_fmac_f32 v236, v26, v114
    v_fmac_f32 v244, v19, v163
    v_fmac_f32 v236, v27, v115
    v_fmac_f32 v244, v20, v164
    v_fmac_f32 v236, v28, v116
    v_fmac_f32 v244, v21, v165
    v_fmac_f32 v236, v29, v117
    v_fmac_f32 v244, v22, v166
    v_fmac_f32 v236, v30, v118
    v_fmac_f32 v244, v23, v167
    v_fmac_f32 v236, v31, v119
    ds_read_b64_tr_b16 v[0:1], v249 offset:0
    ds_read_b64_tr_b16 v[2:3], v249 offset:32
    ds_read_u16_d16_hi v16, v250 offset:0
    v_mul_f32 v243, v32, v152
    v_fma_f32 v241, v40, v168, -v241
    v_fmac_f32 v243, v33, v153
    v_fmac_f32 v241, v41, v169
    v_fmac_f32 v243, v34, v154
    v_fmac_f32 v241, v42, v170
    v_fmac_f32 v243, v35, v155
    v_fmac_f32 v241, v43, v171
    v_fmac_f32 v243, v36, v156
    v_fmac_f32 v241, v44, v172
    v_fmac_f32 v243, v37, v157
    v_fmac_f32 v241, v45, v173
    v_fmac_f32 v243, v38, v158
    v_fmac_f32 v241, v46, v174
    v_fmac_f32 v243, v39, v159
    v_fmac_f32 v241, v47, v175
    ds_read_b64_tr_b16 v[4:5], v249 offset:512
    ds_read_b64_tr_b16 v[6:7], v249 offset:544
    ds_read_u16_d16_hi v17, v250 offset:128
    v_fma_f32 v245, v48, v168, -v245
    v_fmac_f32 v237, v56, v120
    v_fmac_f32 v245, v49, v169
    v_fmac_f32 v237, v57, v121
    v_fmac_f32 v245, v50, v170
    v_fmac_f32 v237, v58, v122
    v_fmac_f32 v245, v51, v171
    v_fmac_f32 v237, v59, v123
    v_fmac_f32 v245, v52, v172
    v_fmac_f32 v237, v60, v124
    v_fmac_f32 v245, v53, v173
    v_fmac_f32 v237, v61, v125
    v_fmac_f32 v245, v54, v174
    v_fmac_f32 v237, v62, v126
    v_fmac_f32 v245, v55, v175
    v_fmac_f32 v237, v63, v127
    s_cmp_eq_u32 s56, 5
    s_cbranch_scc1 K2_U21
    s_cmp_eq_u32 s56, 6
    s_cbranch_scc1 K2_U3h1
    s_branch K2_DSP1
K2_FLGR:
    s_sub_u32 s27, s27, 16
    s_cbranch_scc1 K2_END
    buffer_load_dwordx4 v[56:59], v60, s[8:11], s64 offen sc1
    s_branch K2_FLGW
K2_FLGY:
    v_mov_b32 v56, s2
    v_mov_b32 v57, 7178240
    s_mov_b64 exec, 1
    buffer_store_dword v56, v57, s[8:11], 0 offen sc1
    s_mov_b64 exec, -1
    s_branch K2_FLGOK
K2_nul_70:
    s_mov_b32 s58, 63
    s_mov_b32 s36, 0
    s_branch K2_back_73
K2_spin_71:
    s_sub_u32 s27, s27, 1
    s_cbranch_scc1 K2_END
    v_lshl_add_u32 v233, v252, 1, s53
    ds_read_b32 v233, v233
    s_waitcnt lgkmcnt(0)
    s_branch K2_chk_72
K2_dyn_68:
    v_mov_b32 v254, 163296
    v_mov_b32 v255, 1
    v_lshl_add_u32 v233, v252, 1, s53
    s_mov_b64 exec, 1
    ds_add_rtn_u32 v232, v254, v255
    s_mov_b64 exec, -1
    ds_read_b32 v233, v233
    s_waitcnt lgkmcnt(0)
    v_readfirstlane_b32 s58, v232
    s_nop 0
    s_cmp_lt_u32 s58, s22
    s_cbranch_scc0 K2_nul_70
    s_and_b32 s59, s58, 7
    s_lshr_b32 s60, s58, 3
K2_chk_72:
    v_readlane_b32 s61, v233, s59
    s_nop 0
    s_cmp_gt_u32 s61, s60
    s_cbranch_scc0 K2_spin_71
K2_back_73:
    s_mov_b32 s34, 1
    s_branch K2_back_69
K2_rare_74:
    s_cmp_eq_u32 s33, 4
    s_cbranch_scc1 K2_four_76
    s_mov_b32 s49, s48
    s_mov_b32 s51, s48
    s_add_u32 s45, s44, 256
    s_add_u32 s46, s44, 512
    s_add_u32 s47, s44, 768
    s_branch K2_back_75
K2_four_76:
    s_add_u32 s50, s48, 256
    s_add_u32 s51, s48, 384
    s_mov_b32 s46, s44
    s_mov_b32 s47, s44
    s_branch K2_back_75
K2_dum_77:
    v_mov_b32 v232, -1
    s_mov_b32 m0, 163312
    s_mov_b64 exec, 1
    buffer_load_dwordx4 v232, s[16:19], 0 offen lds
    buffer_load_dwordx4 v232, s[16:19], 0 offen lds
    s_mov_b64 exec, -1
    s_branch K2_back_79
K2_a4_78:
    v_add_u32 v254, s48, v230
    ds_read_b32 v254, v254 offset:4
    s_lshr_b32 s65, s3, 27
    s_mul_i32 s66, s22, 2080
    s_lshl_b32 s65, s65, 9
    s_add_u32 s65, s65, s66
    s_add_u32 s65, s65, 65536
    s_mov_b32 m0, s65
    s_mov_b32 exec_hi, 0
    s_waitcnt lgkmcnt(0)
    v_or_b32 v254, v254, v231
    buffer_load_dwordx4 v254, s[16:19], 0 offen  lds
    s_mov_b32 exec_hi, -1
    s_branch K2_b4_80
K2_nul_83:
    s_mov_b32 s58, 63
    s_mov_b32 s36, 0
    s_branch K2_back_86
K2_spin_84:
    s_sub_u32 s27, s27, 1
    s_cbranch_scc1 K2_END
    v_lshl_add_u32 v233, v252, 1, s53
    ds_read_b32 v233, v233
    s_waitcnt lgkmcnt(0)
    s_branch K2_chk_85
K2_dyn_81:
    v_mov_b32 v254, 163296
    v_mov_b32 v255, 1
    v_lshl_add_u32 v233, v252, 1, s53
    s_mov_b64 exec, 1
    ds_add_rtn_u32 v232, v254, v255
    s_mov_b64 exec, -1
    ds_read_b32 v233, v233
    s_waitcnt lgkmcnt(0)
    v_readfirstlane_b32 s58, v232
    s_nop 0
    s_cmp_lt_u32 s58, s22
    s_cbranch_scc0 K2_nul_83
    s_and_b32 s59, s58, 7
    s_lshr_b32 s60, s58, 3
K2_chk_85:
    v_readlane_b32 s61, v233, s59
    s_nop 0
    s_cmp_gt_u32 s61, s60
    s_cbranch_scc0 K2_spin_84
K2_back_86:
    s_mov_b32 s34, 1
    s_branch K2_back_82
K2_rare_87:
    s_cmp_eq_u32 s33, 4
    s_cbranch_scc1 K2_four_89
    s_mov_b32 s49, s48
    s_mov_b32 s51, s48
    s_add_u32 s45, s44, 256
    s_add_u32 s46, s44, 512
    s_add_u32 s47, s44, 768
    s_branch K2_back_88
K2_four_89:
    s_add_u32 s50, s48, 256
    s_add_u32 s51, s48, 384
    s_mov_b32 s46, s44
    s_mov_b32 s47, s44
    s_branch K2_back_88
K2_dum_90:
    v_mov_b32 v232, -1
    s_mov_b32 m0, 163312
    s_mov_b64 exec, 1
    buffer_load_dwordx4 v232, s[16:19], 0 offen lds
    buffer_load_dwordx4 v232, s[16:19], 0 offen lds
    s_mov_b64 exec, -1
    s_branch K2_back_92
K2_a4_91:
    v_add_u32 v254, s48, v230
    ds_read_b32 v254, v254 offset:4
    s_lshr_b32 s65, s3, 27
    s_mul_i32 s66, s22, 2080
    s_lshl_b32 s65, s65, 9
    s_add_u32 s65, s65, s66
    s_add_u32 s65, s65, 65536
    s_mov_b32 m0, s65
    s_mov_b32 exec_hi, 0
    s_waitcnt lgkmcnt(0)
    v_or_b32 v254, v254, v231
    buffer_load_dwordx4 v254, s[16:19], 0 offen  lds
    s_mov_b32 exec_hi, -1
    s_branch K2_b4_93
K2_nul_94:
    s_mov_b32 s58, 63
    s_mov_b32 s36, 0
    s_branch K2_back_97
K2_spin_95:
    s_sub_u32 s27, s27, 1
    s_cbranch_scc1 K2_END
    v_lshl_add_u32 v233, v252, 1, s53
    ds_read_b32 v233, v233
    s_waitcnt lgkmcnt(0)
    s_branch K2_chk_96
K2_rare_98:
    s_cmp_eq_u32 s33, 4
    s_cbranch_scc1 K2_four_100
    s_mov_b32 s49, s48
    s_mov_b32 s51, s48
    s_add_u32 s45, s44, 256
    s_add_u32 s46, s44, 512
    s_add_u32 s47, s44, 768
    s_branch K2_back_99
K2_four_100:
    s_add_u32 s50, s48, 256
    s_add_u32 s51, s48, 384
    s_mov_b32 s46, s44
    s_mov_b32 s47, s44
    s_branch K2_back_99
K2_nul_101:
    s_mov_b32 s58, 63
    s_mov_b32 s36, 0
    s_branch K2_back_104
K2_spin_102:
    s_sub_u32 s27, s27, 1
    s_cbranch_scc1 K2_END
    v_lshl_add_u32 v233, v252, 1, s53
    ds_read_b32 v233, v233
    s_waitcnt lgkmcnt(0)
    s_branch K2_chk_103
K2_rare_105:
    s_cmp_eq_u32 s33, 4
    s_cbranch_scc1 K2_four_107
    s_mov_b32 s49, s48
    s_mov_b32 s51, s48
    s_add_u32 s45, s44, 256
    s_add_u32 s46, s44, 512
    s_add_u32 s47, s44, 768
    s_branch K2_back_106
K2_four_107:
    s_add_u32 s50, s48, 256
    s_add_u32 s51, s48, 384
    s_mov_b32 s46, s44
    s_mov_b32 s47, s44
    s_branch K2_back_106
K2_END:
    s_endpgm
.section .rodata,"a"
.p2align 6
.amdhsa_kernel standalone__tensor_product_equiv_equiformer__graph_kernel
  .amdhsa_next_free_vgpr 256
  .amdhsa_next_free_sgpr 102
  .amdhsa_accum_offset 256
  .amdhsa_group_segment_fixed_size 0
  .amdhsa_kernarg_size 96
  .amdhsa_user_sgpr_count 2
  .amdhsa_user_sgpr_kernarg_segment_ptr 1
  .amdhsa_system_sgpr_workgroup_id_x 1
  .amdhsa_float_denorm_mode_32 3
.end_amdhsa_kernel
```

```asm
; @launch grid=(256,1,1) block=(512,1,1) lds=163840
.amdgcn_target "amdgcn-amd-amdhsa--gfx950"
.text
.globl standalone__tensor_product_equiv_equiformer__graph_kernel
.p2align 8
.type standalone__tensor_product_equiv_equiformer__graph_kernel,@function
standalone__tensor_product_equiv_equiformer__graph_kernel:
    s_cmp_ge_u32 s2, 256
    s_cbranch_scc1 K2_END
    s_load_dwordx16 s[80:95], s[0:1], 0
    s_load_dwordx4 s[96:99], s[0:1], 72
    s_load_dwordx2 s[100:101], s[0:1], 88
    v_lshrrev_b32 v1, 6, v0
    s_mov_b32 s54, s2
    v_readfirstlane_b32 s20, v1
    s_mov_b64 exec, 0
    s_cmp_eq_u32 s20, 0
    s_cbranch_scc1 K2_PAD_S1
    s_cmp_eq_u32 s20, 1
    s_cbranch_scc1 K2_PAD_S2
    s_cmp_eq_u32 s20, 5
    s_cbranch_scc1 K2_PAD_H1
    s_cmp_eq_u32 s20, 6
    s_cbranch_scc1 K2_PAD_H2
    s_cmp_eq_u32 s20, 2
    s_cbranch_scc1 K2_PAD_H3
KS_HOP0:
    s_mov_b64 exec, -1
    v_and_b32 v8, 63, v0
    v_lshlrev_b32 v9, 4, v8
    v_mov_b32 v6, 0
    v_lshlrev_b32 v5, 4, v0
    v_mul_u32_u24 v4, 24, v0
    s_mul_i32 s64, s2, 5120
    s_mul_i32 s65, s2, 7680
    v_mov_b32 v176, v8
    v_mov_b32 v177, v0
    s_mul_i32 s21, s2, 625
    s_add_u32 s22, s21, 640
    s_add_u32 s21, s21, 15
    s_lshr_b32 s21, s21, 4
    s_lshr_b32 s22, s22, 4
    s_sub_u32 s22, s22, s21
    s_movk_i32 s39, 1024
    s_lshl_b32 s37, s20, 13
    s_mov_b32 s53, 163264
    s_lshl_b32 s52, s20, 2
    s_add_u32 s52, s52, s53
    s_add_u32 s68, s37, 0
    s_add_u32 s69, s37, 2048
    s_add_u32 s70, s37, 4096
    s_add_u32 s71, s37, 6144
    s_waitcnt lgkmcnt(0)
    s_mov_b32 s8, s100
    s_and_b32 s9, s101, 0xffff
    s_mov_b32 s10, 37748736
    s_mov_b32 s11, 0x20000
    s_cmp_lg_u32 s20, 7
    s_cbranch_scc1 KS_NOTAG
    s_mov_b32 s24, 7178240
    s_mov_b64 exec, 1
    buffer_load_dword v14, v6, s[8:11], s24 offen sc1
    s_mov_b64 exec, -1
    s_barrier
    v_mov_b32 v76, 0
    v_mov_b32 v77, -1
    v_lshlrev_b32 v78, 2, v8
    v_add_u32 v78, 163072, v78
    s_mov_b64 exec, 0x1ff
    ds_write_b32 v78, v76 offset:192
    s_mov_b32 exec_lo, -1
    ds_write_b32 v78, v77 offset:256
    s_mov_b64 exec, -1
    s_mov_b32 exec_hi, 0xffff
    ds_write_b32 v78, v76
    s_mov_b64 exec, 1
    ds_write_b32 v78, v76 offset:228
    s_mov_b64 exec, -1
    s_mov_b64 exec, 1
    v_mov_b32 v12, 163456
    s_mov_b32 s24, 1664525
    s_waitcnt vmcnt(0)
    v_mul_lo_u32 v14, v14, s24
    v_add_u32 v14, 1013904223, v14
    ds_write_b32 v12, v14
KS_TAGOK2:
    s_mov_b64 exec, -1
    s_waitcnt lgkmcnt(0)
    s_barrier
    s_branch KS_B3
KS_H0:
    s_barrier
    s_branch KS_HELP
K2_PAD_S1:
    s_branch KS_HOP0
KS_NOTAG:
    s_cmp_ge_u32 s20, 5
    s_cbranch_scc1 KS_HELP
    s_cmp_ge_u32 s2, 250
    s_cbranch_scc1 KS_IDLE
    s_mov_b32 s40, s88
    s_and_b32 s41, s89, 0xffff
    s_mov_b32 s42, 1280000
    s_mov_b32 s43, 0x20000
    buffer_load_dwordx4 v[12:15], v5, s[40:43], s64 offen
    s_mov_b32 s44, s86
    s_and_b32 s45, s87, 0xffff
    s_mov_b32 s46, 1280000
    s_mov_b32 s47, 0x20000
    s_mov_b32 s48, s82
    s_and_b32 s49, s83, 0xffff
    s_mov_b32 s50, 1920000
    s_mov_b32 s51, 0x20000
    buffer_load_dwordx4 v[16:19], v5, s[44:47], s64 offen
    buffer_load_dwordx4 v[20:23], v4, s[48:51], s65 offen
    buffer_load_dwordx2 v[24:25], v4, s[48:51], s65 offen offset:16
    v_lshlrev_b32 v2, 2, v0
    s_lshl_b32 s64, s64, 3
    v_lshl_add_u32 v3, v0, 7, s64
    v_mov_b32 v7, 1
    s_cmp_eq_u32 s20, 4
    s_cbranch_scc1 KS_NOCLR
    ds_write_b32 v2, v6
KS_NOCLR:
    s_waitcnt lgkmcnt(0)
    s_barrier
    s_mov_b64 exec, 0
    s_cmp_eq_u32 s20, 0
    s_cbranch_scc1 K2_PAD_B3
    s_cmp_eq_u32 s20, 1
    s_cbranch_scc1 K2_PAD_LD
    s_cmp_eq_u32 s20, 2
    s_cbranch_scc1 K2_PAD_NW
    s_cmp_eq_u32 s20, 3
    s_cbranch_scc1 K2_PAD_SC
    s_cmp_eq_u32 s20, 4
    s_cbranch_scc1 K2_PAD_SD
KS_HOP:
    s_mov_b64 exec, -1
    s_mov_b32 s58, 429497
    s_movk_i32 s59, 625
    s_waitcnt vmcnt(3)
    v_mul_u32_u24 v28, s58, v12
    v_lshrrev_b32 v32, 27, v28
    v_bfe_u32 v36, v28, 24, 3
    v_lshlrev_b32 v32, 2, v32
    v_lshl_or_b32 v32, v36, 7, v32
    ds_add_rtn_u32 v36, v32, v7
    v_mul_u32_u24 v29, s58, v13
    v_lshrrev_b32 v33, 27, v29
    v_bfe_u32 v37, v29, 24, 3
    v_lshlrev_b32 v33, 2, v33
    v_lshl_or_b32 v33, v37, 7, v33
    ds_add_rtn_u32 v37, v33, v7
    v_mul_u32_u24 v30, s58, v14
    v_lshrrev_b32 v34, 27, v30
    v_bfe_u32 v38, v30, 24, 3
    v_lshlrev_b32 v34, 2, v34
    v_lshl_or_b32 v34, v38, 7, v34
    ds_add_rtn_u32 v38, v34, v7
    v_mul_u32_u24 v31, s58, v15
    v_lshrrev_b32 v35, 27, v31
    v_bfe_u32 v39, v31, 24, 3
    v_lshlrev_b32 v35, 2, v35
    v_lshl_or_b32 v35, v39, 7, v35
    ds_add_rtn_u32 v39, v35, v7
    v_lshrrev_b32 v28, 24, v28
    v_mad_u32_u24 v28, v28, s59, 15
    v_lshrrev_b32 v28, 4, v28
    v_sub_u32 v28, v12, v28
    v_add_u32 v12, 0, v3
    v_lshl_or_b32 v28, v28, 26, v12
    v_lshrrev_b32 v29, 24, v29
    v_mad_u32_u24 v29, v29, s59, 15
    v_lshrrev_b32 v29, 4, v29
    v_sub_u32 v29, v13, v29
    v_add_u32 v13, 32, v3
    v_lshl_or_b32 v29, v29, 26, v13
    v_lshrrev_b32 v30, 24, v30
    v_mad_u32_u24 v30, v30, s59, 15
    v_lshrrev_b32 v30, 4, v30
    v_sub_u32 v30, v14, v30
    v_add_u32 v14, 64, v3
    v_lshl_or_b32 v30, v30, 26, v14
    v_lshrrev_b32 v31, 24, v31
    v_mad_u32_u24 v31, v31, s59, 15
    v_lshrrev_b32 v31, 4, v31
    v_sub_u32 v31, v15, v31
    v_add_u32 v15, 96, v3
    v_lshl_or_b32 v31, v31, 26, v15
K2_PAD_S2:
    s_cbranch_execz KS_HOP0
    v_mov_b32 v59, 163456
    s_mul_i32 s65, s2, 1152
    s_add_u32 s65, s65, 6291456
    s_mul_i32 s64, s2, 20608
    s_waitcnt lgkmcnt(0)
    s_barrier
    ds_read_b128 v[40:43], v9
    ds_read_b32 v59, v59
    s_waitcnt lgkmcnt(1)
    v_add_u32 v45, v40, v41
    v_add_u32 v46, v45, v42
    v_add_u32 v47, v46, v43
    v_mov_b32 v58, v47
    s_nop 1
    v_add_u32_dpp v58, v58, v58 row_shr:1 row_mask:0xf bank_mask:0xf bound_ctrl:0
    s_nop 1
    v_add_u32_dpp v58, v58, v58 row_shr:2 row_mask:0xf bank_mask:0xf bound_ctrl:0
    s_nop 1
    v_add_u32_dpp v58, v58, v58 row_shr:4 row_mask:0xf bank_mask:0xf bound_ctrl:0
    s_nop 1
    v_add_u32_dpp v58, v58, v58 row_shr:8 row_mask:0xf bank_mask:0xf bound_ctrl:0
    s_nop 1
    v_add_u32_dpp v58, v58, v58 row_bcast:15 row_mask:0xa bank_mask:0xf
    s_nop 1
    v_add_u32_dpp v58, v58, v58 row_bcast:31 row_mask:0xc bank_mask:0xf
    v_sub_u32 v48, v58, v47
    v_add_u32 v49, v48, v40
    v_add_u32 v50, v48, v45
    v_add_u32 v51, v48, v46
    ds_write_b128 v9, v[48:51] offset:1024
    s_waitcnt vmcnt(0) lgkmcnt(1)
    s_cmp_lg_u32 s20, 4
    s_cbranch_scc1 KS_NOPUB
    v_lshl_or_b32 v56, v49, 11, v48
    v_lshl_or_b32 v57, v51, 11, v50
    v_lshl_or_b32 v56, v59, 22, v56
    v_lshl_or_b32 v57, v59, 22, v57
    buffer_store_dwordx4 v[56:59], v9, s[8:11], s65 offen sc1
KS_NOPUB:
    s_waitcnt lgkmcnt(0)
    ds_read_b32 v32, v32 offset:1024
    ds_read_b32 v33, v33 offset:1024
    ds_read_b32 v34, v34 offset:1024
    ds_read_b32 v35, v35 offset:1024
    v_and_b32 v60, 0xffff, v59
    v_and_b32 v61, 0xffff0000, v59
    s_mov_b32 s58, 0xffff0000
    v_mov_b32 v40, v20
    v_lshl_or_b32 v41, v21, 16, v60
    v_or_b32 v42, v61, v16
    v_mov_b32 v43, v28
    v_alignbit_b32 v44, v22, v21, 16
    v_and_or_b32 v45, v22, s58, v60
    v_or_b32 v46, v61, v17
    v_mov_b32 v47, v29
    v_mov_b32 v48, v23
    v_lshl_or_b32 v49, v24, 16, v60
    v_or_b32 v50, v61, v18
    v_mov_b32 v51, v30
    v_alignbit_b32 v52, v25, v24, 16
    v_and_or_b32 v53, v25, s58, v60
    v_or_b32 v54, v61, v19
    v_mov_b32 v55, v31
    s_waitcnt lgkmcnt(0)
    v_add_lshl_u32 v32, v32, v36, 4
    ds_write_b128 v32, v[40:43] offset:2048
    v_add_lshl_u32 v33, v33, v37, 4
    ds_write_b128 v33, v[44:47] offset:2048
    v_add_lshl_u32 v34, v34, v38, 4
    ds_write_b128 v34, v[48:51] offset:2048
    v_add_lshl_u32 v35, v35, v39, 4
    ds_write_b128 v35, v[52:55] offset:2048
    s_waitcnt lgkmcnt(0)
    s_barrier
    ds_read_b128 v[12:15], v5 offset:2048
    ds_read_b128 v[16:19], v5 offset:7168
    ds_read_b128 v[20:23], v5 offset:12288
    ds_read_b128 v[24:27], v5 offset:17408
    s_waitcnt lgkmcnt(3)
    buffer_store_dwordx4 v[12:15], v5, s[8:11], s64 offen sc1
    s_add_u32 s64, s64, 5120
    s_waitcnt lgkmcnt(2)
    buffer_store_dwordx4 v[16:19], v5, s[8:11], s64 offen sc1
    s_add_u32 s64, s64, 5120
    s_waitcnt lgkmcnt(1)
    buffer_store_dwordx4 v[20:23], v5, s[8:11], s64 offen sc1
    s_add_u32 s64, s64, 5120
    s_waitcnt lgkmcnt(0)
    buffer_store_dwordx4 v[24:27], v5, s[8:11], s64 offen sc1
    s_branch KS_JOIN
K2_PAD_B3:
    s_branch KS_HOP
KS_B3:
    v_mov_b32 v59, 163456
    ds_read_b32 v59, v59
    s_waitcnt lgkmcnt(0)
    s_barrier
KS_JOIN:
    v_readfirstlane_b32 s2, v59
    s_mov_b32 s23, 0
    s_mov_b32 s28, 1
    s_mov_b32 s24, 0
    s_mov_b32 s25, 1
K2_CELLS:
    v_lshrrev_b32 v178, 1, v177
    v_min_u32 v178, 249, v178
    v_mul_u32_u24 v72, 1152, v178
    s_and_b32 s58, s54, 7
    s_lshl_b32 s58, s58, 7
    s_lshr_b32 s59, s54, 5
    s_lshl_b32 s59, s59, 4
    s_add_u32 s67, s58, s59
    s_add_u32 s67, s67, 6291456
    buffer_load_dwordx4 v[76:79], v72, s[8:11], s67 offen sc1
    s_cmp_eq_u32 s28, 0
    s_cbranch_scc1 K2_NOSRD
    s_mov_b32 s4, s80
    s_and_b32 s5, s81, 0xffff
    s_mov_b32 s6, 10240000
    s_mov_b32 s7, 0x20000
    s_mov_b32 s12, s96
    s_and_b32 s13, s97, 0xffff
    s_mov_b32 s14, 10240000
    s_mov_b32 s15, 0x20000
    s_mov_b32 s16, s84
    s_and_b32 s17, s85, 0xffff
    s_mov_b32 s18, 10240000
    s_mov_b32 s19, 0x20000
    s_sub_u32 s80, s80, 1024
    s_subb_u32 s81, s81, 0
    s_mov_b32 s72, s80
    s_and_b32 s73, s81, 0xffff
    s_mov_b32 s74, 10241024
    s_mov_b32 s75, 0x20000
    s_mov_b64 exec, 0
    s_cmp_eq_u32 s20, 0
    s_cbranch_scc1 K2_PAD_U20
    s_cmp_eq_u32 s20, 1
    s_cbranch_scc1 K2_PAD_U30
    s_cmp_eq_u32 s20, 2
    s_cbranch_scc1 K2_PAD_U21
    s_cmp_eq_u32 s20, 3
    s_cbranch_scc1 K2_PAD_U31
    s_cmp_eq_u32 s20, 4
    s_cbranch_scc1 K2_PAD_SW
    s_cmp_eq_u32 s20, 5
    s_cbranch_scc1 K2_PAD_TL
    s_cmp_eq_u32 s20, 6
    s_cbranch_scc1 K2_PAD_T2
K2_HOP:
    s_mov_b64 exec, -1
K2_NOSRD:
    v_and_b32 v84, 15, v176
    v_lshrrev_b32 v85, 5, v176
    v_bfe_u32 v86, v176, 4, 1
    v_lshrrev_b32 v87, 2, v84
    v_and_b32 v88, 3, v84
    v_lshl_add_u32 v89, v85, 2, v87
    v_lshlrev_b32 v249, 6, v89
    v_lshl_add_u32 v249, v88, 3, v249
    v_add_u32 v249, 512, v249
    v_lshrrev_b32 v90, 3, v84
    v_lshl_add_u32 v90, v90, 1, v86
    v_sub_u32 v90, v90, 1 clamp
    v_lshlrev_b32 v250, 1, v90
    v_lshl_add_u32 v91, v85, 2, v88
    v_lshl_add_u32 v250, v91, 4, v250
    v_and_b32 v91, 1, v87
    v_lshl_add_u32 v250, v91, 3, v250
    v_lshrrev_b32 v90, 1, v88
    v_lshl_add_u32 v90, v86, 1, v90
    v_bfe_u32 v91, v87, 1, 1
    v_lshlrev_b32 v91, 2, v91
    v_xor_b32 v90, v90, v91
    v_lshlrev_b32 v90, 4, v90
    v_lshl_add_u32 v90, v89, 7, v90
    v_and_b32 v91, 1, v88
    v_lshl_add_u32 v90, v91, 3, v90
    v_add_u32 v246, s37, v90
    v_xor_b32 v247, 64, v246
    v_lshrrev_b32 v90, 3, v176
    v_lshlrev_b32 v251, 4, v90
    v_bfe_u32 v90, v90, 1, 1
    v_lshlrev_b32 v90, 2, v90
    v_and_b32 v91, 7, v176
    v_xor_b32 v90, v90, v91
    v_lshlrev_b32 v248, 4, v90
    v_lshlrev_b32 v252, 1, v176
    v_and_b32 v231, 1, v176
    v_lshlrev_b32 v231, 4, v231
    v_lshrrev_b32 v90, 1, v176
    v_lshlrev_b32 v90, 5, v90
    v_add_u32 v230, 512, v90
    s_lshl_b32 s59, s2, 22
    s_mov_b32 s60, 0x40000
    s_bfe_u32 s61, s54, 0x10004
    s_bfe_u32 s62, s54, 0x10003
    s_add_u32 s63, s61, s62
    s_mul_i32 s62, s62, 11
    s_sub_u32 s64, 11, s62
    v_cmp_gt_u32 vcc, 500, v177
    s_nop 0
    s_mov_b64 s[56:57], vcc
K2_POLL:
    s_waitcnt vmcnt(0)
    v_xor_b32 v73, s59, v76
    v_xor_b32 v74, s59, v77
    v_or_b32 v73, v73, v74
    v_xor_b32 v74, s2, v79
    v_lshrrev_b32 v73, 22, v73
    v_or_b32 v73, v73, v74
    v_cmp_ne_u32 vcc, 0, v73
    s_nop 0
    s_cbranch_vccz K2_POLLED
    s_sub_u32 s60, s60, 1
    s_cbranch_scc1 K2_END
    s_mov_b64 exec, vcc
    buffer_load_dwordx4 v[76:79], v72, s[8:11], s67 offen sc1
    s_mov_b64 exec, -1
    s_branch K2_POLL
K2_PAD_LD:
    s_branch KS_HOP
K2_POLLED:
    s_set_gpr_idx_on s61, gpr_idx(SRC0)
    s_nop 0
    v_bfe_u32 v179, v76, s62, 11
    s_set_gpr_idx_idx s63
    s_nop 0
    v_bfe_u32 v73, v76, s64, 11
    s_set_gpr_idx_off
    v_sub_u32 v73, v73, v179
    v_cndmask_b32 v73, 0, v73, s[56:57]
    v_and_b32 v1, 1, v177
    v_add_u32 v1, s23, v1
    v_sub_u32 v180, v73, v1
    v_add_u32 v179, v179, v1
    v_mul_u32_u24 v181, 20608, v178
    v_lshl_add_u32 v181, v179, 4, v181
    v_cmp_lt_i32 s[40:41], 0, v180
    v_add_u32 v182, 32, v181
    s_mov_b32 s65, 0
    s_mov_b64 exec, s[40:41]
    buffer_load_dwordx4 v[0:3], v181, s[8:11], 0 offen offset:0 sc1
    s_mov_b64 exec, -1
    v_cmp_lt_i32 s[42:43], 2, v180
    v_cmp_lt_i32 s[44:45], 4, v180
    v_cmp_lt_i32 s[46:47], 6, v180
    v_cmp_lt_i32 s[48:49], 8, v180
    v_cmp_lt_i32 s[50:51], 10, v180
    v_cmp_lt_i32 s[90:91], 12, v180
    v_cmp_lt_i32 s[92:93], 14, v180
    v_cmp_lt_i32 s[94:95], 16, v180
    v_cmp_lt_i32 s[96:97], 18, v180
    v_add_u32 v183, 64, v181
    v_add_u32 v184, 96, v181
    v_subrev_u32 v62, 1, v180
    v_ashrrev_i32 v62, 1, v62
    v_med3_i32 v62, v62, 0, 9
    s_cmp_eq_u64 s[42:43], 0
    s_cbranch_scc1 K2_LD_DONE
    v_mov_b32 v63, v62
    s_nop 1
    v_add_u32_dpp v63, v63, v63 row_shr:1 row_mask:0xf bank_mask:0xf bound_ctrl:0
    s_nop 1
    v_add_u32_dpp v63, v63, v63 row_shr:2 row_mask:0xf bank_mask:0xf bound_ctrl:0
    s_nop 1
    v_add_u32_dpp v63, v63, v63 row_shr:4 row_mask:0xf bank_mask:0xf bound_ctrl:0
    s_nop 1
    v_add_u32_dpp v63, v63, v63 row_shr:8 row_mask:0xf bank_mask:0xf bound_ctrl:0
    s_nop 1
    v_add_u32_dpp v63, v63, v63 row_bcast:15 row_mask:0xa bank_mask:0xf
    s_nop 1
    v_add_u32_dpp v63, v63, v63 row_bcast:31 row_mask:0xc bank_mask:0xf
    s_lshl_b32 s58, s20, 10
    s_add_u32 s58, s58, 45056
    v_readlane_b32 s59, v63, 63
    v_sub_u32 v63, v63, v62
    v_lshl_add_u32 v64, v63, 2, s58
    v_lshlrev_b32 v63, 5, v63
    v_sub_u32 v63, v182, v63
    s_cmp_gt_u32 s59, 189
    s_cbranch_scc1 K2_LD_GEN
    s_mov_b64 exec, s[42:43]
    s_cbranch_execz K2_LD_L
    ds_write_b32 v64, v63 offset:0
    s_mov_b64 exec, s[44:45]
    s_cbranch_execz K2_LD_L
    ds_write_b32 v64, v63 offset:4
    s_mov_b64 exec, s[46:47]
    s_cbranch_execz K2_LD_L
    ds_write_b32 v64, v63 offset:8
    s_mov_b64 exec, s[48:49]
    s_cbranch_execz K2_LD_L
    ds_write_b32 v64, v63 offset:12
    s_mov_b64 exec, s[50:51]
    s_cbranch_execz K2_LD_L
    ds_write_b32 v64, v63 offset:16
    s_mov_b64 exec, s[90:91]
    s_cbranch_execz K2_LD_L
    ds_write_b32 v64, v63 offset:20
    s_mov_b64 exec, s[92:93]
    s_cbranch_execz K2_LD_L
    ds_write_b32 v64, v63 offset:24
    s_mov_b64 exec, s[94:95]
    s_cbranch_execz K2_LD_L
    ds_write_b32 v64, v63 offset:28
    s_mov_b64 exec, s[96:97]
    s_cbranch_execz K2_LD_L
    ds_write_b32 v64, v63 offset:32
K2_LD_L:
    s_mov_b64 exec, -1
    v_lshl_add_u32 v63, v176, 2, s58
    v_lshlrev_b32 v62, 5, v176
    s_waitcnt lgkmcnt(0)
    ds_read_b32 v64, v63 offset:0
    ds_read_b32 v65, v63 offset:252
    ds_read_b32 v66, v63 offset:504
    s_min_u32 s60, s59, 63
    s_sub_u32 s59, s59, s60
    s_bfm_b64 s[42:43], s60, 0
    s_min_u32 s60, s59, 63
    s_sub_u32 s59, s59, s60
    s_bfm_b64 s[44:45], s60, 0
    s_min_u32 s60, s59, 63
    s_sub_u32 s59, s59, s60
    s_bfm_b64 s[46:47], s60, 0
    s_mov_b64 s[48:49], 0
    s_mov_b32 s65, 1
    s_mov_b32 s60, 0
    s_waitcnt lgkmcnt(2)
    v_add3_u32 v182, v62, v64, s60
    s_mov_b64 exec, s[42:43]
    buffer_load_dwordx4 v[4:7], v182, s[8:11], 0 offen sc1
    s_mov_b32 s60, 2016
    s_waitcnt lgkmcnt(1)
    v_add3_u32 v183, v62, v65, s60
    s_mov_b64 exec, s[44:45]
    buffer_load_dwordx4 v[8:11], v183, s[8:11], 0 offen sc1
    s_mov_b32 s60, 4032
    s_waitcnt lgkmcnt(0)
    v_add3_u32 v184, v62, v66, s60
    s_mov_b64 exec, s[46:47]
    buffer_load_dwordx4 v[12:15], v184, s[8:11], 0 offen sc1
K2_LD_DONE:
    s_mov_b64 exec, -1
    s_cmp_eq_u32 s28, 0
    s_cbranch_scc1 K2_WLATE
    v_lshrrev_b32 v60, 6, v252
    v_bfe_u32 v61, v252, 3, 2
    v_lshl_add_u32 v60, v60, 2, v61
    v_mul_u32_u24 v60, 640, v60
    v_bfe_u32 v61, v252, 5, 1
    v_lshl_add_u32 v60, v61, 5, v60
    v_and_b32 v61, 6, v252
    v_lshl_add_u32 v60, v61, 2, v60
    v_add_u32 v60, 24576, v60
    ds_read_b64_tr_b16 v[136:137], v60 offset:0
    ds_read_b64_tr_b16 v[138:139], v60 offset:5120
    ds_read_b64_tr_b16 v[140:141], v60 offset:64
    ds_read_b64_tr_b16 v[142:143], v60 offset:5184
    ds_read_b64_tr_b16 v[144:145], v60 offset:128
    ds_read_b64_tr_b16 v[146:147], v60 offset:5248
    ds_read_b64_tr_b16 v[148:149], v60 offset:192
    ds_read_b64_tr_b16 v[150:151], v60 offset:5312
    ds_read_b64_tr_b16 v[152:153], v60 offset:256
    ds_read_b64_tr_b16 v[154:155], v60 offset:5376
    ds_read_b64_tr_b16 v[156:157], v60 offset:320
    ds_read_b64_tr_b16 v[158:159], v60 offset:5440
    ds_read_b64_tr_b16 v[160:161], v60 offset:384
    ds_read_b64_tr_b16 v[162:163], v60 offset:5504
    ds_read_b64_tr_b16 v[164:165], v60 offset:448
    ds_read_b64_tr_b16 v[166:167], v60 offset:5568
    ds_read_b64_tr_b16 v[168:169], v60 offset:512
    ds_read_b64_tr_b16 v[170:171], v60 offset:5632
    ds_read_b64_tr_b16 v[172:173], v60 offset:576
    ds_read_b64_tr_b16 v[174:175], v60 offset:5696
    s_waitcnt lgkmcnt(0)
K2_WUNP:
    v_lshlrev_b32 v96, 16, v136
    v_and_b32 v97, 0xffff0000, v136
    v_lshlrev_b32 v98, 16, v137
    v_and_b32 v99, 0xffff0000, v137
    v_lshlrev_b32 v100, 16, v138
    v_and_b32 v101, 0xffff0000, v138
    v_lshlrev_b32 v102, 16, v139
    v_and_b32 v103, 0xffff0000, v139
    v_lshlrev_b32 v104, 16, v140
    v_and_b32 v105, 0xffff0000, v140
    v_lshlrev_b32 v106, 16, v141
    v_and_b32 v107, 0xffff0000, v141
    v_lshlrev_b32 v108, 16, v142
    v_and_b32 v109, 0xffff0000, v142
    v_lshlrev_b32 v110, 16, v143
    v_and_b32 v111, 0xffff0000, v143
    v_lshlrev_b32 v112, 16, v144
    v_and_b32 v113, 0xffff0000, v144
    v_lshlrev_b32 v114, 16, v145
    v_and_b32 v115, 0xffff0000, v145
    v_lshlrev_b32 v116, 16, v146
    v_and_b32 v117, 0xffff0000, v146
    v_lshlrev_b32 v118, 16, v147
    v_and_b32 v119, 0xffff0000, v147
    v_lshlrev_b32 v120, 16, v148
    v_and_b32 v121, 0xffff0000, v148
    v_lshlrev_b32 v122, 16, v149
    v_and_b32 v123, 0xffff0000, v149
    v_lshlrev_b32 v124, 16, v150
    v_and_b32 v125, 0xffff0000, v150
    v_lshlrev_b32 v126, 16, v151
    v_and_b32 v127, 0xffff0000, v151
    v_lshlrev_b32 v128, 16, v152
    v_and_b32 v129, 0xffff0000, v152
    v_lshlrev_b32 v130, 16, v153
    v_and_b32 v131, 0xffff0000, v153
    v_lshlrev_b32 v132, 16, v154
    v_and_b32 v133, 0xffff0000, v154
    v_lshlrev_b32 v134, 16, v155
    v_and_b32 v135, 0xffff0000, v155
    v_lshlrev_b32 v136, 16, v156
    v_and_b32 v137, 0xffff0000, v156
    v_lshlrev_b32 v138, 16, v157
    v_and_b32 v139, 0xffff0000, v157
    v_lshlrev_b32 v140, 16, v158
    v_and_b32 v141, 0xffff0000, v158
    v_lshlrev_b32 v142, 16, v159
    v_and_b32 v143, 0xffff0000, v159
    v_lshlrev_b32 v144, 16, v160
    v_and_b32 v145, 0xffff0000, v160
    v_lshlrev_b32 v146, 16, v161
    v_and_b32 v147, 0xffff0000, v161
    v_lshlrev_b32 v148, 16, v162
    v_and_b32 v149, 0xffff0000, v162
    v_lshlrev_b32 v150, 16, v163
    v_and_b32 v151, 0xffff0000, v163
    v_lshlrev_b32 v152, 16, v164
    v_and_b32 v153, 0xffff0000, v164
    v_lshlrev_b32 v154, 16, v165
    v_and_b32 v155, 0xffff0000, v165
    v_lshlrev_b32 v156, 16, v166
    v_and_b32 v157, 0xffff0000, v166
    v_lshlrev_b32 v158, 16, v167
    v_and_b32 v159, 0xffff0000, v167
    v_lshlrev_b32 v160, 16, v168
    v_and_b32 v161, 0xffff0000, v168
    v_lshlrev_b32 v162, 16, v169
    v_and_b32 v163, 0xffff0000, v169
    v_lshlrev_b32 v164, 16, v170
    v_and_b32 v165, 0xffff0000, v170
    v_lshlrev_b32 v166, 16, v171
    v_and_b32 v167, 0xffff0000, v171
    v_lshlrev_b32 v168, 16, v172
    v_and_b32 v169, 0xffff0000, v172
    v_lshlrev_b32 v170, 16, v173
    v_and_b32 v171, 0xffff0000, v173
    v_lshlrev_b32 v172, 16, v174
    v_and_b32 v173, 0xffff0000, v174
    v_lshlrev_b32 v174, 16, v175
    v_and_b32 v175, 0xffff0000, v175
K2_NOWRAW:
K2_PAD_NW:
    s_cbranch_execz KS_HOP
    v_lshrrev_b32 v179, 2, v181
    v_lshrrev_b32 v185, 2, v182
    v_lshrrev_b32 v186, 2, v183
    v_lshrrev_b32 v187, 2, v184
    s_mov_b32 s66, 7340032
    v_mov_b32 v201, 1
    s_movk_i32 s58, 520
    s_movk_i32 s59, 2080
    s_mov_b32 s60, 0x40000
    s_mov_b32 s61, 0xffff
    v_mov_b32 v202, 65536
    s_cmp_lg_u32 s24, 0
    s_cbranch_scc1 K2_RK_LOAD
    v_cmp_lt_i32 vcc, 20, v180
    s_nop 0
    s_cbranch_vccz K2_NOMORE
    v_mov_b32 v61, 163300
    ds_write_b32 v61, v201
K2_NOMORE:
    s_mov_b32 s62, 82176
    s_cmp_eq_u32 s65, 0
    s_waitcnt vmcnt(3)
    s_cbranch_scc0 K2_ARR
    s_waitcnt vmcnt(0)
K2_ARR:
    s_mov_b64 exec, s[40:41]
    s_cbranch_execz K2_RK_A
K2_CK0:
    v_bfi_b32 v192, s61, v1, v2
    v_lshrrev_b32 v50, 24, v3
    v_cmp_ne_u32 vcc, s2, v192
    v_add_u32 v40, 163072, v50
    s_cbranch_vccnz K2_RT0
    ds_add_rtn_u32 v40, v40, v201
    v_mad_u32_u24 v50, v50, s58, v202
    s_mov_b64 exec, s[42:43]
    s_cbranch_execz K2_RK_A
    s_waitcnt vmcnt(2)
K2_CK1:
    v_bfi_b32 v192, s61, v5, v6
    v_lshrrev_b32 v51, 24, v7
    v_cmp_ne_u32 vcc, s2, v192
    v_add_u32 v41, 163072, v51
    s_cbranch_vccnz K2_RT1
    ds_add_rtn_u32 v41, v41, v201
    v_mad_u32_u24 v51, v51, s58, v202
    s_mov_b64 exec, s[44:45]
    s_cbranch_execz K2_RK_A
    s_waitcnt vmcnt(1)
K2_CK2:
    v_bfi_b32 v192, s61, v9, v10
    v_lshrrev_b32 v52, 24, v11
    v_cmp_ne_u32 vcc, s2, v192
    v_add_u32 v42, 163072, v52
    s_cbranch_vccnz K2_RT2
    ds_add_rtn_u32 v42, v42, v201
    v_mad_u32_u24 v52, v52, s58, v202
    s_mov_b64 exec, s[46:47]
    s_cbranch_execz K2_RK_A
    s_waitcnt vmcnt(0)
K2_CK3:
    v_bfi_b32 v192, s61, v13, v14
    v_lshrrev_b32 v53, 24, v15
    v_cmp_ne_u32 vcc, s2, v192
    v_add_u32 v43, 163072, v53
    s_cbranch_vccnz K2_RT3
    ds_add_rtn_u32 v43, v43, v201
    v_mad_u32_u24 v53, v53, s58, v202
    s_mov_b64 exec, s[48:49]
    s_cbranch_execz K2_RK_A
K2_CK4:
    v_bfi_b32 v192, s61, v17, v18
    v_lshrrev_b32 v54, 24, v19
    v_cmp_ne_u32 vcc, s2, v192
    v_add_u32 v44, 163072, v54
    s_cbranch_vccnz K2_RT4
    ds_add_rtn_u32 v44, v44, v201
    v_mad_u32_u24 v54, v54, s58, v202
    s_mov_b64 exec, s[50:51]
    s_cbranch_execz K2_RK_A
K2_CK5:
    v_bfi_b32 v192, s61, v21, v22
    v_lshrrev_b32 v55, 24, v23
    v_cmp_ne_u32 vcc, s2, v192
    v_add_u32 v45, 163072, v55
    s_cbranch_vccnz K2_RT5
    ds_add_rtn_u32 v45, v45, v201
    v_mad_u32_u24 v55, v55, s58, v202
    s_mov_b64 exec, s[90:91]
    s_cbranch_execz K2_RK_A
K2_CK6:
    v_bfi_b32 v192, s61, v25, v26
    v_lshrrev_b32 v56, 24, v27
    v_cmp_ne_u32 vcc, s2, v192
    v_add_u32 v46, 163072, v56
    s_cbranch_vccnz K2_RT6
    ds_add_rtn_u32 v46, v46, v201
    v_mad_u32_u24 v56, v56, s58, v202
    s_mov_b64 exec, s[92:93]
    s_cbranch_execz K2_RK_A
K2_CK7:
    v_bfi_b32 v192, s61, v29, v30
    v_lshrrev_b32 v57, 24, v31
    v_cmp_ne_u32 vcc, s2, v192
    v_add_u32 v47, 163072, v57
    s_cbranch_vccnz K2_RT7
    ds_add_rtn_u32 v47, v47, v201
    v_mad_u32_u24 v57, v57, s58, v202
    s_mov_b64 exec, s[94:95]
    s_cbranch_execz K2_RK_A
K2_CK8:
    v_bfi_b32 v192, s61, v33, v34
    v_lshrrev_b32 v58, 24, v35
    v_cmp_ne_u32 vcc, s2, v192
    v_add_u32 v48, 163072, v58
    s_cbranch_vccnz K2_RT8
    ds_add_rtn_u32 v48, v48, v201
    v_mad_u32_u24 v58, v58, s58, v202
    s_mov_b64 exec, s[96:97]
    s_cbranch_execz K2_RK_A
K2_CK9:
    v_bfi_b32 v192, s61, v37, v38
    v_lshrrev_b32 v59, 24, v39
    v_cmp_ne_u32 vcc, s2, v192
    v_add_u32 v49, 163072, v59
    s_cbranch_vccnz K2_RT9
    ds_add_rtn_u32 v49, v49, v201
    v_mad_u32_u24 v59, v59, s58, v202
K2_RK_A:
    s_mov_b64 exec, -1
    s_mov_b64 exec, s[40:41]
    s_cbranch_execz K2_TP
    v_cmp_gt_u32 vcc, s62, v50
    v_and_b32 v3, 0xffffff, v3
    s_mov_b64 exec, vcc
    buffer_load_dword v245, v3, s[16:19], 0 offen
    s_mov_b64 exec, s[42:43]
    s_cbranch_execz K2_TP
    v_cmp_gt_u32 vcc, s62, v51
    v_and_b32 v7, 0xffffff, v7
    s_mov_b64 exec, vcc
    buffer_load_dword v245, v7, s[16:19], 0 offen
    s_mov_b64 exec, s[44:45]
    s_cbranch_execz K2_TP
    v_cmp_gt_u32 vcc, s62, v52
    v_and_b32 v11, 0xffffff, v11
    s_mov_b64 exec, vcc
    buffer_load_dword v245, v11, s[16:19], 0 offen
    s_mov_b64 exec, s[46:47]
    s_cbranch_execz K2_TP
    v_cmp_gt_u32 vcc, s62, v53
    v_and_b32 v15, 0xffffff, v15
    s_mov_b64 exec, vcc
    buffer_load_dword v245, v15, s[16:19], 0 offen
    s_mov_b64 exec, s[48:49]
    s_cbranch_execz K2_TP
    v_cmp_gt_u32 vcc, s62, v54
    v_and_b32 v19, 0xffffff, v19
    s_mov_b64 exec, vcc
    buffer_load_dword v245, v19, s[16:19], 0 offen
    s_mov_b64 exec, s[50:51]
    s_cbranch_execz K2_TP
    v_cmp_gt_u32 vcc, s62, v55
    v_and_b32 v23, 0xffffff, v23
    s_mov_b64 exec, vcc
    buffer_load_dword v245, v23, s[16:19], 0 offen
    s_mov_b64 exec, s[90:91]
    s_cbranch_execz K2_TP
    v_cmp_gt_u32 vcc, s62, v56
    v_and_b32 v27, 0xffffff, v27
    s_mov_b64 exec, vcc
    buffer_load_dword v245, v27, s[16:19], 0 offen
    s_mov_b64 exec, s[92:93]
    s_cbranch_execz K2_TP
    v_cmp_gt_u32 vcc, s62, v57
    v_and_b32 v31, 0xffffff, v31
    s_mov_b64 exec, vcc
    buffer_load_dword v245, v31, s[16:19], 0 offen
    s_mov_b64 exec, s[94:95]
    s_cbranch_execz K2_TP
    v_cmp_gt_u32 vcc, s62, v58
    v_and_b32 v35, 0xffffff, v35
    s_mov_b64 exec, vcc
    buffer_load_dword v245, v35, s[16:19], 0 offen
    s_mov_b64 exec, s[96:97]
    s_cbranch_execz K2_TP
    v_cmp_gt_u32 vcc, s62, v59
    v_and_b32 v39, 0xffffff, v39
    s_mov_b64 exec, vcc
    buffer_load_dword v245, v39, s[16:19], 0 offen
K2_TP:
    s_mov_b64 exec, -1
K2_RK_DONE:
K2_PAD_SC:
    s_cbranch_execz KS_HOP
    s_mul_i32 s67, s24, 48
    s_movk_i32 s58, -1532
    s_waitcnt lgkmcnt(0)
    s_mov_b64 exec, s[40:41]
    s_cbranch_execz K2_SC_DONE
    v_cmpx_gt_u32 vcc, 64, v40
    v_bfe_u32 v194, v40, 3, 1
    v_add_u32 v193, 16, v40
    v_lshl_or_b32 v194, v40, 1, v194
    v_bfi_b32 v194, 15, v194, v40
    v_lshrrev_b32 v193, 6, v193
    v_alignbit_b32 v1, v2, v1, 16
    v_lshl_add_u32 v195, v194, 3, v50
    v_lshl_add_u32 v194, v194, 5, v50
    ds_write_b64 v195, v[0:1]
    v_mad_i32_i24 v194, v193, s58, v194
    ds_write_b32 v194, v3 offset:512
    s_mov_b64 exec, s[42:43]
    s_cbranch_execz K2_SC_DONE
    v_cmpx_gt_u32 vcc, 64, v41
    v_bfe_u32 v194, v41, 3, 1
    v_add_u32 v193, 16, v41
    v_lshl_or_b32 v194, v41, 1, v194
    v_bfi_b32 v194, 15, v194, v41
    v_lshrrev_b32 v193, 6, v193
    v_alignbit_b32 v5, v6, v5, 16
    v_lshl_add_u32 v195, v194, 3, v51
    v_lshl_add_u32 v194, v194, 5, v51
    ds_write_b64 v195, v[4:5]
    v_mad_i32_i24 v194, v193, s58, v194
    ds_write_b32 v194, v7 offset:512
    s_mov_b64 exec, s[44:45]
    s_cbranch_execz K2_SC_DONE
    v_cmpx_gt_u32 vcc, 64, v42
    v_bfe_u32 v194, v42, 3, 1
    v_add_u32 v193, 16, v42
    v_lshl_or_b32 v194, v42, 1, v194
    v_bfi_b32 v194, 15, v194, v42
    v_lshrrev_b32 v193, 6, v193
    v_alignbit_b32 v9, v10, v9, 16
    v_lshl_add_u32 v195, v194, 3, v52
    v_lshl_add_u32 v194, v194, 5, v52
    ds_write_b64 v195, v[8:9]
    v_mad_i32_i24 v194, v193, s58, v194
    ds_write_b32 v194, v11 offset:512
    s_mov_b64 exec, s[46:47]
    s_cbranch_execz K2_SC_DONE
    v_cmpx_gt_u32 vcc, 64, v43
    v_bfe_u32 v194, v43, 3, 1
    v_add_u32 v193, 16, v43
    v_lshl_or_b32 v194, v43, 1, v194
    v_bfi_b32 v194, 15, v194, v43
    v_lshrrev_b32 v193, 6, v193
    v_alignbit_b32 v13, v14, v13, 16
    v_lshl_add_u32 v195, v194, 3, v53
    v_lshl_add_u32 v194, v194, 5, v53
    ds_write_b64 v195, v[12:13]
    v_mad_i32_i24 v194, v193, s58, v194
    ds_write_b32 v194, v15 offset:512
    s_mov_b64 exec, s[48:49]
    s_cbranch_execz K2_SC_DONE
    v_cmpx_gt_u32 vcc, 64, v44
    v_bfe_u32 v194, v44, 3, 1
    v_add_u32 v193, 16, v44
    v_lshl_or_b32 v194, v44, 1, v194
    v_bfi_b32 v194, 15, v194, v44
    v_lshrrev_b32 v193, 6, v193
    v_alignbit_b32 v17, v18, v17, 16
    v_lshl_add_u32 v195, v194, 3, v54
    v_lshl_add_u32 v194, v194, 5, v54
    ds_write_b64 v195, v[16:17]
    v_mad_i32_i24 v194, v193, s58, v194
    ds_write_b32 v194, v19 offset:512
    s_mov_b64 exec, s[50:51]
    s_cbranch_execz K2_SC_DONE
    v_cmpx_gt_u32 vcc, 64, v45
    v_bfe_u32 v194, v45, 3, 1
    v_add_u32 v193, 16, v45
    v_lshl_or_b32 v194, v45, 1, v194
    v_bfi_b32 v194, 15, v194, v45
    v_lshrrev_b32 v193, 6, v193
    v_alignbit_b32 v21, v22, v21, 16
    v_lshl_add_u32 v195, v194, 3, v55
    v_lshl_add_u32 v194, v194, 5, v55
    ds_write_b64 v195, v[20:21]
    v_mad_i32_i24 v194, v193, s58, v194
    ds_write_b32 v194, v23 offset:512
    s_mov_b64 exec, s[90:91]
    s_cbranch_execz K2_SC_DONE
    v_cmpx_gt_u32 vcc, 64, v46
    v_bfe_u32 v194, v46, 3, 1
    v_add_u32 v193, 16, v46
    v_lshl_or_b32 v194, v46, 1, v194
    v_bfi_b32 v194, 15, v194, v46
    v_lshrrev_b32 v193, 6, v193
    v_alignbit_b32 v25, v26, v25, 16
    v_lshl_add_u32 v195, v194, 3, v56
    v_lshl_add_u32 v194, v194, 5, v56
    ds_write_b64 v195, v[24:25]
    v_mad_i32_i24 v194, v193, s58, v194
    ds_write_b32 v194, v27 offset:512
    s_mov_b64 exec, s[92:93]
    s_cbranch_execz K2_SC_DONE
    v_cmpx_gt_u32 vcc, 64, v47
    v_bfe_u32 v194, v47, 3, 1
    v_add_u32 v193, 16, v47
    v_lshl_or_b32 v194, v47, 1, v194
    v_bfi_b32 v194, 15, v194, v47
    v_lshrrev_b32 v193, 6, v193
    v_alignbit_b32 v29, v30, v29, 16
    v_lshl_add_u32 v195, v194, 3, v57
    v_lshl_add_u32 v194, v194, 5, v57
    ds_write_b64 v195, v[28:29]
    v_mad_i32_i24 v194, v193, s58, v194
    ds_write_b32 v194, v31 offset:512
    s_mov_b64 exec, s[94:95]
    s_cbranch_execz K2_SC_DONE
    v_cmpx_gt_u32 vcc, 64, v48
    v_bfe_u32 v194, v48, 3, 1
    v_add_u32 v193, 16, v48
    v_lshl_or_b32 v194, v48, 1, v194
    v_bfi_b32 v194, 15, v194, v48
    v_lshrrev_b32 v193, 6, v193
    v_alignbit_b32 v33, v34, v33, 16
    v_lshl_add_u32 v195, v194, 3, v58
    v_lshl_add_u32 v194, v194, 5, v58
    ds_write_b64 v195, v[32:33]
    v_mad_i32_i24 v194, v193, s58, v194
    ds_write_b32 v194, v35 offset:512
    s_mov_b64 exec, s[96:97]
    s_cbranch_execz K2_SC_DONE
    v_cmpx_gt_u32 vcc, 64, v49
    v_bfe_u32 v194, v49, 3, 1
    v_add_u32 v193, 16, v49
    v_lshl_or_b32 v194, v49, 1, v194
    v_bfi_b32 v194, 15, v194, v49
    v_lshrrev_b32 v193, 6, v193
    v_alignbit_b32 v37, v38, v37, 16
    v_lshl_add_u32 v195, v194, 3, v59
    v_lshl_add_u32 v194, v194, 5, v59
    ds_write_b64 v195, v[36:37]
    v_mad_i32_i24 v194, v193, s58, v194
    ds_write_b32 v194, v39 offset:512
K2_SC_DONE:
    s_mov_b64 exec, -1
K2_PAD_SD:
    s_cbranch_execz KS_HOP
    v_lshlrev_b32 v192, 2, v176
    v_add_u32 v192, 163072, v192
    v_mov_b32 v200, 163300
    s_cmp_eq_u32 s24, 0
    s_cselect_b32 s26, 64, 48
    s_waitcnt lgkmcnt(0)
    s_barrier
    ds_read_b32 v193, v192
    ds_read_b32 v200, v200
    v_cmp_gt_u32 s[56:57], s22, v176
    v_mad_u32_u24 v195, v176, s59, v202
    s_waitcnt lgkmcnt(0)
    v_cndmask_b32 v193, 0, v193, s[56:57]
    v_readfirstlane_b32 s27, v200
    v_cmp_lt_u32 s[62:63], 48, v193
    v_cmp_lt_u32 vcc, 64, v193
    s_bcnt1_i32_b64 s60, s[62:63]
    v_mbcnt_lo_u32_b32 v198, s62, 0
    v_mbcnt_hi_u32_b32 v198, s63, v198
    s_cbranch_vccnz K2_BIG
    s_cmp_gt_u32 s60, 8
    s_cbranch_scc1 K2_BIG
K2_TOK:
    v_subrev_u32 v194, s67, v193
    v_max_i32 v194, 1, v194
    v_min_i32 v194, s26, v194
    v_add_u32 v194, 15, v194
    v_lshrrev_b32 v194, 3, v194
    v_lshl_or_b32 v195, v194, 18, v195
    v_lshl_or_b32 v195, v198, 27, v195
    v_mov_b32 v197, 949760
    v_cndmask_b32 v253, v197, v195, s[56:57]
    s_movk_i32 s40, 0
    s_movk_i32 s41, 256
    s_movk_i32 s42, 512
    s_movk_i32 s43, 768
    s_add_u32 s24, s24, 1
    s_cmp_ge_u32 s24, s25
    s_cselect_b32 s55, 1, 0
    s_cmp_eq_u32 s27, 0
    s_cselect_b32 s55, s55, 0
    s_mov_b32 s27, 0x400000
    s_mov_b32 s38, 0
    s_mov_b32 s34, 0
    s_mov_b32 s35, 0
    s_mov_b32 s36, 1
    s_mov_b32 s31, 0
    s_mov_b32 s58, s20
    v_readlane_b32 s3, v253, s58
    s_lshl_b32 s44, s34, 7
    s_and_b32 s48, s3, 0x3ffff
    s_bfe_u32 s33, s3, 0x30013
    s_mul_i32 s35, s38, 6
    s_cmp_eq_u32 s34, 0
    s_cselect_b32 s35, s35, s48
    s_mov_b32 s45, s44
    s_xor_b32 s47, s44, 256
    s_add_u32 s49, s48, 128
    s_add_u32 s60, s48, 256
    s_cmp_eq_u32 s33, 3
    s_cselect_b32 s46, s44, s47
    s_cselect_b32 s50, s60, s48
    s_cselect_b32 s51, s48, s49
    s_sub_u32 s60, s33, 2
    s_cmp_lt_u32 s60, 2
    s_cbranch_scc0 K2_rare_1
K2_back_2:
    v_add_u32 v233, s48, v230
    ds_read_b32 v232, v233
    ds_read_b32 v233, v233 offset:1024
    v_add_u32 v222, s48, v251
    ds_read2_b32 v[222:223], v222 offset0:1 offset1:3
    v_add_u32 v224, s49, v251
    ds_read2_b32 v[224:225], v224 offset0:1 offset1:3
    v_add_u32 v226, s50, v251
    ds_read2_b32 v[226:227], v226 offset0:1 offset1:3
    v_add_u32 v228, s51, v251
    ds_read2_b32 v[228:229], v228 offset0:1 offset1:3
    s_waitcnt lgkmcnt(4)
    v_or_b32 v232, v232, v231
    v_or_b32 v233, v233, v231
    s_cmp_lg_u32 s34, 0
    s_cbranch_scc1 K2_dum_4
    s_cmp_eq_u32 s33, 4
    s_cbranch_scc1 K2_a4_5
K2_b4_7:
    s_add_u32 m0, s48, 512
    s_add_u32 s65, s48, 1536
    buffer_load_dwordx4 v232, s[16:19], 0 offen  lds
    s_mov_b32 m0, s65
    s_mov_b32 exec_hi, 0
    buffer_load_dwordx4 v233, s[16:19], 0 offen  lds
    s_mov_b32 exec_hi, -1
K2_back_6:
    s_waitcnt lgkmcnt(3)
    v_mad_u32_u16 v222, v222, s39, v248 op_sel:[1,0,0,0]
    v_mad_u32_u16 v223, v223, s39, v248 op_sel:[1,0,0,0]
    s_waitcnt lgkmcnt(2)
    v_mad_u32_u16 v224, v224, s39, v248 op_sel:[1,0,0,0]
    v_mad_u32_u16 v225, v225, s39, v248 op_sel:[1,0,0,0]
    s_waitcnt lgkmcnt(1)
    v_mad_u32_u16 v226, v226, s39, v248 op_sel:[1,0,0,0]
    v_mad_u32_u16 v227, v227, s39, v248 op_sel:[1,0,0,0]
    s_waitcnt lgkmcnt(0)
    v_mad_u32_u16 v228, v228, s39, v248 op_sel:[1,0,0,0]
    v_mad_u32_u16 v229, v229, s39, v248 op_sel:[1,0,0,0]
    s_mov_b32 m0, s68
    s_nop 0
    buffer_load_dwordx4 v222, s[4:7], s44 offen sc1 lds
    buffer_load_dwordx4 v223, s[72:75], s44 offen offset:1024 sc1 lds
    s_mov_b32 m0, s69
    s_nop 0
    buffer_load_dwordx4 v224, s[4:7], s45 offen sc1 lds
    buffer_load_dwordx4 v225, s[72:75], s45 offen offset:1024 sc1 lds
    s_mov_b32 m0, s70
    s_nop 0
    buffer_load_dwordx4 v226, s[4:7], s46 offen sc1 lds
    buffer_load_dwordx4 v227, s[72:75], s46 offen offset:1024 sc1 lds
    s_mov_b32 m0, s71
    s_nop 0
    buffer_load_dwordx4 v228, s[4:7], s47 offen sc1 lds
    buffer_load_dwordx4 v229, s[72:75], s47 offen offset:1024 sc1 lds
    v_add_u32 v249, s48, v249
    v_add_u32 v250, s48, v250
    s_waitcnt vmcnt(6)
    ds_read_b64_tr_b16 v[176:177], v246 offset:0
    ds_read_b64_tr_b16 v[178:179], v246 offset:1024
    ds_read_b64_tr_b16 v[180:181], v247 offset:0
    ds_read_b64_tr_b16 v[182:183], v247 offset:1024
    ds_read_b64_tr_b16 v[0:1], v249 offset:0
    ds_read_b64_tr_b16 v[2:3], v249 offset:32
    ds_read_u16_d16_hi v16, v250 offset:0
    ds_read_b64_tr_b16 v[4:5], v249 offset:512
    ds_read_b64_tr_b16 v[6:7], v249 offset:544
    ds_read_u16_d16_hi v17, v250 offset:128
    s_mov_b32 s29, s48
    s_mov_b32 s32, s31
    s_mov_b32 s30, s3
    s_mov_b32 s31, s35
    s_bfe_u32 s56, s3, 0x40012
    s_cmp_eq_u32 s56, 5
    s_cbranch_scc1 K2_U20
    s_cmp_eq_u32 s56, 6
    s_cbranch_scc1 K2_U3h0
    s_branch K2_DSP0
K2_PAD_H1:
    s_branch KS_HOP0
KS_HELP:
    s_mov_b32 s30, 0
    s_cmp_eq_u32 s20, 6
    s_cbranch_scc1 KS_RAW
    s_mov_b32 s30, 2
    s_cmp_ge_u32 s2, 170
    s_cbranch_scc1 KS_NOW
    s_mov_b32 s30, 1
    v_and_b32 v1, 15, v8
    v_lshrrev_b32 v3, 4, v8
    s_cmp_ge_u32 s2, 160
    s_cbranch_scc1 K1_WT
    s_cmp_ge_u32 s2, 64
    s_cbranch_scc1 K1_S1
    s_lshr_b32 s24, s2, 3
    s_and_b32 s25, s2, 7
    s_lshr_b32 s26, s25, 2
    s_bfe_u32 s27, s25, 0x10001
    s_and_b32 s28, s25, 1
    s_mov_b32 s60, s92
    s_and_b32 s61, s93, 0xffff
    s_mov_b32 s62, 65536
    s_mov_b32 s63, 0x20000
    s_branch K1_SC
K1_S1:
    s_sub_u32 s29, s2, 64
    s_mul_i32 s24, s29, 43
    s_lshr_b32 s24, s24, 9
    s_mul_i32 s25, s24, 12
    s_sub_u32 s25, s29, s25
    s_cmp_ge_u32 s25, 6
    s_cselect_b32 s26, 1, 0
    s_mul_i32 s27, s26, 6
    s_sub_u32 s27, s25, s27
    s_lshr_b32 s27, s27, 1
    s_and_b32 s28, s25, 1
    s_add_u32 s25, s25, 8
    s_mov_b32 s60, s94
    s_and_b32 s61, s95, 0xffff
    s_mov_b32 s62, 98304
    s_mov_b32 s63, 0x20000
K1_SC:
    s_lshl_b32 s27, s27, 7
    s_lshl_b32 s26, s26, 6
    s_lshl_b32 s28, s28, 4
    s_add_u32 s27, s27, s26
    s_add_u32 s27, s27, s28
    s_lshl_b32 s27, s27, 8
    s_lshl_b32 s26, s24, 5
    s_add_u32 s27, s27, s26
    s_add_u32 s29, s27, 8192
    v_lshlrev_b32 v3, 10, v3
    v_lshl_add_u32 v3, v1, 1, v3
    buffer_load_ushort v64, v3, s[60:63], s27 offen offset:0
    buffer_load_ushort v65, v3, s[60:63], s29 offen offset:0
    buffer_load_ushort v66, v3, s[60:63], s27 offen offset:256
    buffer_load_ushort v67, v3, s[60:63], s29 offen offset:256
    buffer_load_ushort v68, v3, s[60:63], s27 offen offset:512
    buffer_load_ushort v69, v3, s[60:63], s29 offen offset:512
    buffer_load_ushort v70, v3, s[60:63], s27 offen offset:768
    buffer_load_ushort v71, v3, s[60:63], s29 offen offset:768
    s_mul_i32 s24, s24, 20
    s_add_u32 s24, s24, s25
    s_lshl_b32 s24, s24, 10
    s_add_u32 s24, s24, 6946816
    s_branch K1_GO
K1_WT:
    s_sub_u32 s24, s2, 160
    s_lshr_b32 s27, s24, 1
    s_and_b32 s28, s24, 1
    s_lshl_b32 s27, s27, 8
    s_lshl_b32 s28, s28, 6
    s_add_u32 s27, s27, s28
    s_add_u32 s29, s27, 10240
    s_mov_b32 s60, s90
    s_and_b32 s61, s91, 0xffff
    s_mov_b32 s62, 20480
    s_mov_b32 s63, 0x20000
    v_and_b32 v1, 31, v8
    v_lshrrev_b32 v3, 5, v8
    v_mul_u32_u24 v3, 5120, v3
    v_lshl_add_u32 v3, v1, 1, v3
    buffer_load_ushort v64, v3, s[60:63], s27 offen offset:0
    buffer_load_ushort v65, v3, s[60:63], s27 offen offset:1280
    buffer_load_ushort v66, v3, s[60:63], s27 offen offset:2560
    buffer_load_ushort v67, v3, s[60:63], s27 offen offset:3840
    buffer_load_ushort v68, v3, s[60:63], s29 offen offset:0
    buffer_load_ushort v69, v3, s[60:63], s29 offen offset:1280
    buffer_load_ushort v70, v3, s[60:63], s29 offen offset:2560
    buffer_load_ushort v71, v3, s[60:63], s29 offen offset:3840
    s_lshl_b32 s24, s24, 10
    s_add_u32 s24, s24, 7110656
K1_GO:
KS_NOW:
    s_barrier
K2_PAD_H2:
    s_cbranch_execz KS_HOP0
    v_and_b32 v76, 31, v8
    v_lshrrev_b32 v77, 5, v8
    v_mov_b32 v80, 0
    v_mul_u32_u24 v77, 2080, v77
    v_mov_b32 v81, 0xffff0000
    v_lshl_add_u32 v78, v76, 4, v77
    v_mov_b32 v82, 0
    v_add_u32 v78, 65536, v78
    v_mov_b32 v83, v81
    v_add_u32 v79, 41600, v78
    ds_write_b128 v78, v[80:83] offset:0
    ds_write_b128 v78, v[80:83] offset:4160
    ds_write_b128 v78, v[80:83] offset:8320
    ds_write_b128 v78, v[80:83] offset:12480
    ds_write_b128 v78, v[80:83] offset:16640
    ds_write_b128 v78, v[80:83] offset:20800
    ds_write_b128 v78, v[80:83] offset:24960
    ds_write_b128 v78, v[80:83] offset:29120
    ds_write_b128 v78, v[80:83] offset:33280
    ds_write_b128 v78, v[80:83] offset:37440
    ds_write_b128 v79, v[80:83] offset:0
    ds_write_b128 v79, v[80:83] offset:4160
    ds_write_b128 v79, v[80:83] offset:8320
    ds_write_b128 v79, v[80:83] offset:12480
    ds_write_b128 v79, v[80:83] offset:16640
    ds_write_b128 v79, v[80:83] offset:20800
    ds_write_b128 v79, v[80:83] offset:24960
    ds_write_b128 v79, v[80:83] offset:29120
    ds_write_b128 v79, v[80:83] offset:33280
    ds_write_b128 v79, v[80:83] offset:37440
KS_FILL:
    v_mov_b32 v59, 163456
    s_barrier
    ds_read_b32 v59, v59
    s_waitcnt vmcnt(0) lgkmcnt(0)
    s_cmp_eq_u32 s30, 0
    s_cbranch_scc1 KS_B3
    s_cmp_eq_u32 s30, 2
    s_cbranch_scc1 KS_NOST
    v_lshl_or_b32 v40, v65, 16, v64
    v_lshl_or_b32 v41, v67, 16, v66
    v_lshl_or_b32 v42, v69, 16, v68
    v_lshl_or_b32 v43, v71, 16, v70
    buffer_store_dwordx4 v[40:43], v9, s[8:11], s24 offen sc1
KS_NOST:
    s_waitcnt lgkmcnt(0)
    s_barrier
    s_lshl_b32 s24, s2, 2
    s_add_u32 s24, s24, 7176192
    s_mov_b64 exec, 1
    s_waitcnt vmcnt(0)
    buffer_store_dword v59, v6, s[8:11], s24 offen sc1
    s_mov_b64 exec, -1
    s_branch KS_JOIN
K2_PAD_H3:
    s_branch KS_HOP0
KS_RAW:
    s_barrier
    s_mov_b32 s60, s90
    s_and_b32 s61, s91, 0xffff
    s_mov_b32 s62, 20480
    s_mov_b32 s63, 0x20000
    v_lshrrev_b32 v10, 3, v8
    v_and_b32 v11, 7, v8
    v_lshlrev_b32 v10, 8, v10
    v_lshl_add_u32 v10, v11, 4, v10
    s_mov_b32 m0, 24576
    s_movk_i32 s24, 0
    buffer_load_dwordx4 v10, s[60:63], s24 offen lds
    s_mov_b32 m0, 25600
    s_movk_i32 s24, 2048
    buffer_load_dwordx4 v10, s[60:63], s24 offen lds
    s_mov_b32 m0, 26624
    s_movk_i32 s24, 4096
    buffer_load_dwordx4 v10, s[60:63], s24 offen lds
    s_mov_b32 m0, 27648
    s_movk_i32 s24, 6144
    buffer_load_dwordx4 v10, s[60:63], s24 offen lds
    s_mov_b32 m0, 28672
    s_movk_i32 s24, 8192
    buffer_load_dwordx4 v10, s[60:63], s24 offen lds
    s_mov_b32 m0, 29696
    s_movk_i32 s24, 10240
    buffer_load_dwordx4 v10, s[60:63], s24 offen lds
    s_mov_b32 m0, 30720
    s_movk_i32 s24, 12288
    buffer_load_dwordx4 v10, s[60:63], s24 offen lds
    s_mov_b32 m0, 31744
    s_movk_i32 s24, 14336
    buffer_load_dwordx4 v10, s[60:63], s24 offen lds
    s_mov_b32 m0, 32768
    s_movk_i32 s24, 16384
    buffer_load_dwordx4 v10, s[60:63], s24 offen lds
    s_mov_b32 m0, 33792
    s_movk_i32 s24, 18432
    buffer_load_dwordx4 v10, s[60:63], s24 offen lds
    s_mov_b32 m0, 152832
    s_movk_i32 s24, 128
    buffer_load_dwordx4 v10, s[60:63], s24 offen lds
    s_mov_b32 m0, 153856
    s_movk_i32 s24, 2176
    buffer_load_dwordx4 v10, s[60:63], s24 offen lds
    s_mov_b32 m0, 154880
    s_movk_i32 s24, 4224
    buffer_load_dwordx4 v10, s[60:63], s24 offen lds
    s_mov_b32 m0, 155904
    s_movk_i32 s24, 6272
    buffer_load_dwordx4 v10, s[60:63], s24 offen lds
    s_mov_b32 m0, 156928
    s_movk_i32 s24, 8320
    buffer_load_dwordx4 v10, s[60:63], s24 offen lds
    s_mov_b32 m0, 157952
    s_movk_i32 s24, 10368
    buffer_load_dwordx4 v10, s[60:63], s24 offen lds
    s_mov_b32 m0, 158976
    s_movk_i32 s24, 12416
    buffer_load_dwordx4 v10, s[60:63], s24 offen lds
    s_mov_b32 m0, 160000
    s_movk_i32 s24, 14464
    buffer_load_dwordx4 v10, s[60:63], s24 offen lds
    s_mov_b32 m0, 161024
    s_movk_i32 s24, 16512
    buffer_load_dwordx4 v10, s[60:63], s24 offen lds
    s_mov_b32 m0, 162048
    s_movk_i32 s24, 18560
    buffer_load_dwordx4 v10, s[60:63], s24 offen lds
    v_add_u32 v85, 16, v8
    v_lshlrev_b32 v84, 5, v8
    v_lshrrev_b32 v85, 6, v85
    v_mul_u32_u24 v85, 1532, v85
    v_sub_u32 v84, v84, v85
    v_mov_b32 v85, -1
    v_add_u32 v84, 66048, v84
    v_add_u32 v86, 41600, v84
    ds_write_b32 v84, v85 offset:0
    ds_write_b32 v84, v85 offset:2080
    ds_write_b32 v84, v85 offset:4160
    ds_write_b32 v84, v85 offset:6240
    ds_write_b32 v84, v85 offset:8320
    ds_write_b32 v84, v85 offset:10400
    ds_write_b32 v84, v85 offset:12480
    ds_write_b32 v84, v85 offset:14560
    ds_write_b32 v84, v85 offset:16640
    ds_write_b32 v84, v85 offset:18720
    ds_write_b32 v84, v85 offset:20800
    ds_write_b32 v84, v85 offset:22880
    ds_write_b32 v84, v85 offset:24960
    ds_write_b32 v84, v85 offset:27040
    ds_write_b32 v84, v85 offset:29120
    ds_write_b32 v84, v85 offset:31200
    ds_write_b32 v84, v85 offset:33280
    ds_write_b32 v84, v85 offset:35360
    ds_write_b32 v84, v85 offset:37440
    ds_write_b32 v84, v85 offset:39520
    ds_write_b32 v86, v85 offset:0
    ds_write_b32 v86, v85 offset:2080
    ds_write_b32 v86, v85 offset:4160
    ds_write_b32 v86, v85 offset:6240
    ds_write_b32 v86, v85 offset:8320
    ds_write_b32 v86, v85 offset:10400
    ds_write_b32 v86, v85 offset:12480
    ds_write_b32 v86, v85 offset:14560
    ds_write_b32 v86, v85 offset:16640
    ds_write_b32 v86, v85 offset:18720
    ds_write_b32 v86, v85 offset:20800
    ds_write_b32 v86, v85 offset:22880
    ds_write_b32 v86, v85 offset:24960
    ds_write_b32 v86, v85 offset:27040
    ds_write_b32 v86, v85 offset:29120
    ds_write_b32 v86, v85 offset:31200
    ds_write_b32 v86, v85 offset:33280
    ds_write_b32 v86, v85 offset:35360
    ds_write_b32 v86, v85 offset:37440
    ds_write_b32 v86, v85 offset:39520
    s_branch KS_FILL
KS_IDLE:
    s_barrier
    s_barrier
    s_branch KS_B3
K2_PAD_U20:
    s_branch K2_HOP
K2_U20:
    s_setprio 1
    s_waitcnt lgkmcnt(0)
    v_lshlrev_b32 v20, 16, v0
    v_and_b32 v21, 0xffff0000, v0
    v_lshlrev_b32 v22, 16, v1
    v_and_b32 v23, 0xffff0000, v1
    v_lshlrev_b32 v24, 16, v2
    v_and_b32 v25, 0xffff0000, v2
    v_lshlrev_b32 v26, 16, v3
    v_and_b32 v27, 0xffff0000, v3
    v_mul_f32_dpp v36, v16, v20 row_newbcast:8 row_mask:0xf bank_mask:0xf
    v_mul_f32_dpp v37, v16, v21 row_newbcast:9 row_mask:0xf bank_mask:0xf
    v_mul_f32_dpp v38, v16, v22 row_newbcast:10 row_mask:0xf bank_mask:0xf
    v_mul_f32_dpp v39, v16, v23 row_newbcast:11 row_mask:0xf bank_mask:0xf
    v_mul_f32_dpp v40, v16, v24 row_newbcast:12 row_mask:0xf bank_mask:0xf
    v_mul_f32_dpp v41, v16, v25 row_newbcast:13 row_mask:0xf bank_mask:0xf
    v_mul_f32_dpp v42, v16, v26 row_newbcast:14 row_mask:0xf bank_mask:0xf
    v_mul_f32_dpp v43, v16, v27 row_newbcast:15 row_mask:0xf bank_mask:0xf
    v_cvt_pk_bf16_f32 v68, v36, v37
    v_cvt_pk_bf16_f32 v69, v38, v39
    v_cvt_pk_bf16_f32 v70, v40, v41
    v_cvt_pk_bf16_f32 v71, v42, v43
    v_mul_f32_dpp v20, v16, v20 row_newbcast:0 row_mask:0xa bank_mask:0xf
    v_mul_f32_dpp v21, v16, v21 row_newbcast:1 row_mask:0xa bank_mask:0xf
    v_mul_f32_dpp v22, v16, v22 row_newbcast:2 row_mask:0xa bank_mask:0xf
    v_mul_f32_dpp v23, v16, v23 row_newbcast:3 row_mask:0xa bank_mask:0xf
    v_mul_f32_dpp v24, v16, v24 row_newbcast:4 row_mask:0xa bank_mask:0xf
    v_mul_f32_dpp v25, v16, v25 row_newbcast:5 row_mask:0xa bank_mask:0xf
    v_mul_f32_dpp v26, v16, v26 row_newbcast:6 row_mask:0xa bank_mask:0xf
    v_mul_f32_dpp v27, v16, v27 row_newbcast:7 row_mask:0xa bank_mask:0xf
    v_cvt_pk_bf16_f32 v64, v20, v21
    v_cvt_pk_bf16_f32 v65, v22, v23
    v_cvt_pk_bf16_f32 v66, v24, v25
    v_cvt_pk_bf16_f32 v67, v26, v27
    v_lshlrev_b32 v28, 16, v4
    v_and_b32 v29, 0xffff0000, v4
    v_lshlrev_b32 v30, 16, v5
    v_and_b32 v31, 0xffff0000, v5
    v_lshlrev_b32 v32, 16, v6
    v_and_b32 v33, 0xffff0000, v6
    v_lshlrev_b32 v34, 16, v7
    v_and_b32 v35, 0xffff0000, v7
    v_mul_f32_dpp v36, v17, v28 row_newbcast:8 row_mask:0xf bank_mask:0xf
    v_mul_f32_dpp v37, v17, v29 row_newbcast:9 row_mask:0xf bank_mask:0xf
    v_mul_f32_dpp v38, v17, v30 row_newbcast:10 row_mask:0xf bank_mask:0xf
    v_mul_f32_dpp v39, v17, v31 row_newbcast:11 row_mask:0xf bank_mask:0xf
    v_mul_f32_dpp v40, v17, v32 row_newbcast:12 row_mask:0xf bank_mask:0xf
    v_mul_f32_dpp v41, v17, v33 row_newbcast:13 row_mask:0xf bank_mask:0xf
    v_mul_f32_dpp v42, v17, v34 row_newbcast:14 row_mask:0xf bank_mask:0xf
    v_mul_f32_dpp v43, v17, v35 row_newbcast:15 row_mask:0xf bank_mask:0xf
    v_cvt_pk_bf16_f32 v76, v36, v37
    v_cvt_pk_bf16_f32 v77, v38, v39
    v_cvt_pk_bf16_f32 v78, v40, v41
    v_cvt_pk_bf16_f32 v79, v42, v43
    v_mul_f32_dpp v28, v17, v28 row_newbcast:0 row_mask:0xa bank_mask:0xf
    v_mul_f32_dpp v29, v17, v29 row_newbcast:1 row_mask:0xa bank_mask:0xf
    v_mul_f32_dpp v30, v17, v30 row_newbcast:2 row_mask:0xa bank_mask:0xf
    v_mul_f32_dpp v31, v17, v31 row_newbcast:3 row_mask:0xa bank_mask:0xf
    v_mul_f32_dpp v32, v17, v32 row_newbcast:4 row_mask:0xa bank_mask:0xf
    v_mul_f32_dpp v33, v17, v33 row_newbcast:5 row_mask:0xa bank_mask:0xf
    v_mul_f32_dpp v34, v17, v34 row_newbcast:6 row_mask:0xa bank_mask:0xf
    v_mul_f32_dpp v35, v17, v35 row_newbcast:7 row_mask:0xa bank_mask:0xf
    v_cvt_pk_bf16_f32 v72, v28, v29
    v_cvt_pk_bf16_f32 v73, v30, v31
    v_cvt_pk_bf16_f32 v74, v32, v33
    v_cvt_pk_bf16_f32 v75, v34, v35
    s_waitcnt vmcnt(4)
    v_mfma_f32_32x32x16_bf16 v[0:15], v[64:67], v[176:179], 0
    ds_read_b64_tr_b16 v[184:185], v246 offset:2048
    ds_read_b64_tr_b16 v[186:187], v246 offset:3072
    ds_read_b64_tr_b16 v[188:189], v247 offset:2048
    ds_read_b64_tr_b16 v[190:191], v247 offset:3072
    s_mov_b32 m0, s68
    v_mfma_f32_32x32x16_bf16 v[16:31], v[68:71], v[176:179], 0
    buffer_load_dwordx4 v222, s[4:7], s42 offen sc1 lds
    buffer_load_dwordx4 v223, s[72:75], s42 offen offset:1024 sc1 lds
    v_permlane32_swap_b32 v242, v236
    v_permlane32_swap_b32 v243, v237
    s_add_u32 s38, s38, 1
    v_mfma_f32_32x32x16_bf16 v[32:47], v[64:67], v[180:183], 0
    v_permlane32_swap_b32 v244, v238
    v_permlane32_swap_b32 v245, v239
    v_permlane32_swap_b32 v240, v241
    v_add_f32 v242, v242, v236
    v_mfma_f32_32x32x16_bf16 v[48:63], v[68:71], v[180:183], 0
    v_add_f32 v243, v243, v237
    v_add_f32 v244, v244, v238
    v_add_f32 v245, v245, v239
    v_add_f32 v240, -v240, -v241
    v_mov_b32 v254, s52
    v_mov_b32 v255, s38
    s_waitcnt vmcnt(4) lgkmcnt(0)
    v_mfma_f32_32x32x16_bf16 v[0:15], v[72:75], v[184:187], v[0:15]
    ds_read_b64_tr_b16 v[176:177], v246 offset:4096
    ds_read_b64_tr_b16 v[178:179], v246 offset:5120
    ds_read_b64_tr_b16 v[180:181], v247 offset:4096
    ds_read_b64_tr_b16 v[182:183], v247 offset:5120
    s_lshl_b32 s58, s38, 3
    s_add_u32 s58, s58, s20
    s_mov_b32 m0, s69
    v_mfma_f32_32x32x16_bf16 v[16:31], v[76:79], v[184:187], v[16:31]
    buffer_load_dwordx4 v224, s[4:7], s42 offen sc1 lds
    buffer_load_dwordx4 v225, s[72:75], s42 offen offset:1024 sc1 lds
    s_set_gpr_idx_on s32, gpr_idx(DST)
    s_nop 0
    v_cvt_pk_bf16_f32 v195, v242, v243
    v_cvt_pk_bf16_f32 v196, v244, v245
    v_cvt_pk_bf16_f32 v197, v240, v240
    s_set_gpr_idx_off
    s_mov_b64 exec, 1
    ds_write_b32 v254, v255
    s_mov_b64 exec, -1
    s_cmp_lt_u32 s58, s22
    s_cbranch_scc0 K2_dyn_8
K2_back_9:
    v_readlane_b32 s3, v253, s58
    s_lshl_b32 s44, s34, 7
    s_and_b32 s48, s3, 0x3ffff
    s_bfe_u32 s33, s3, 0x30013
    s_mul_i32 s35, s38, 6
    s_cmp_eq_u32 s34, 0
    s_cselect_b32 s35, s35, s48
    s_mov_b32 s45, s44
    s_xor_b32 s47, s44, 256
    s_add_u32 s49, s48, 128
    s_add_u32 s60, s48, 256
    s_cmp_eq_u32 s33, 3
    s_cselect_b32 s46, s44, s47
    s_cselect_b32 s50, s60, s48
    s_cselect_b32 s51, s48, s49
    s_sub_u32 s60, s33, 2
    s_cmp_lt_u32 s60, 2
    s_cbranch_scc0 K2_rare_14
K2_back_15:
    v_mfma_f32_32x32x16_bf16 v[32:47], v[72:75], v[188:191], v[32:47]
    v_add_u32 v233, s48, v230
    ds_read_b32 v232, v233
    ds_read_b32 v233, v233 offset:1024
    v_mul_f32 v234, v0, v96
    v_mul_f32 v236, v8, v128
    v_fmac_f32 v234, v1, v97
    v_fmac_f32 v236, v9, v129
    v_mfma_f32_32x32x16_bf16 v[48:63], v[76:79], v[188:191], v[48:63]
    s_setprio 0
    v_fmac_f32 v234, v2, v98
    v_fmac_f32 v236, v10, v130
    v_fmac_f32 v234, v3, v99
    v_fmac_f32 v236, v11, v131
    v_fmac_f32 v234, v4, v100
    v_fmac_f32 v236, v12, v132
    v_fmac_f32 v234, v5, v101
    v_fmac_f32 v236, v13, v133
    v_fmac_f32 v234, v6, v102
    v_fmac_f32 v236, v14, v134
    v_fmac_f32 v234, v7, v103
    v_fmac_f32 v236, v15, v135
    v_mul_f32 v238, v16, v128
    v_mul_f32 v240, v24, v128
    v_fmac_f32 v238, v17, v129
    v_fmac_f32 v240, v25, v129
    v_fmac_f32 v238, v18, v130
    v_fmac_f32 v240, v26, v130
    v_fmac_f32 v238, v19, v131
    v_fmac_f32 v240, v27, v131
    v_fmac_f32 v238, v20, v132
    v_fmac_f32 v240, v28, v132
    v_fmac_f32 v238, v21, v133
    v_fmac_f32 v240, v29, v133
    v_fmac_f32 v238, v22, v134
    v_fmac_f32 v240, v30, v134
    v_fmac_f32 v238, v23, v135
    v_fmac_f32 v240, v31, v135
    v_mul_f32 v235, v32, v104
    v_mul_f32 v237, v40, v136
    v_fmac_f32 v235, v33, v105
    v_fmac_f32 v237, v41, v137
    v_fmac_f32 v235, v34, v106
    v_fmac_f32 v237, v42, v138
    v_fmac_f32 v235, v35, v107
    v_fmac_f32 v237, v43, v139
    v_fmac_f32 v235, v36, v108
    v_fmac_f32 v237, v44, v140
    v_fmac_f32 v235, v37, v109
    v_fmac_f32 v237, v45, v141
    v_fmac_f32 v235, v38, v110
    v_fmac_f32 v237, v46, v142
    v_fmac_f32 v235, v39, v111
    v_fmac_f32 v237, v47, v143
    v_mul_f32 v239, v48, v136
    v_mul_f32 v241, v56, v136
    v_fmac_f32 v239, v49, v137
    v_fmac_f32 v241, v57, v137
    s_setprio 1
    s_waitcnt vmcnt(4) lgkmcnt(3)
    v_mfma_f32_32x32x16_bf16 v[0:15], v[64:67], v[176:179], 0
    ds_read_b64_tr_b16 v[184:185], v246 offset:6144
    ds_read_b64_tr_b16 v[186:187], v246 offset:7168
    ds_read_b64_tr_b16 v[188:189], v247 offset:6144
    ds_read_b64_tr_b16 v[190:191], v247 offset:7168
    v_fmac_f32 v239, v50, v138
    v_fmac_f32 v241, v58, v138
    s_mov_b32 m0, s70
    v_mfma_f32_32x32x16_bf16 v[16:31], v[68:71], v[176:179], 0
    buffer_load_dwordx4 v222, s[4:7], s43 offen sc1 lds
    buffer_load_dwordx4 v223, s[72:75], s43 offen offset:1024 sc1 lds
    v_fmac_f32 v239, v51, v139
    v_fmac_f32 v241, v59, v139
    v_fmac_f32 v239, v52, v140
    v_fmac_f32 v241, v60, v140
    v_fmac_f32 v239, v53, v141
    v_mfma_f32_32x32x16_bf16 v[32:47], v[64:67], v[180:183], 0
    v_add_u32 v222, s48, v251
    ds_read2_b32 v[222:223], v222 offset0:1 offset1:3
    v_fmac_f32 v241, v61, v141
    v_fmac_f32 v239, v54, v142
    v_fmac_f32 v241, v62, v142
    v_fmac_f32 v239, v55, v143
    v_fmac_f32 v241, v63, v143
    v_mfma_f32_32x32x16_bf16 v[48:63], v[68:71], v[180:183], 0
    v_permlane32_swap_b32 v234, v236
    v_permlane32_swap_b32 v235, v237
    v_permlane32_swap_b32 v240, v238
    s_waitcnt lgkmcnt(5)
    v_or_b32 v232, v232, v231
    v_or_b32 v233, v233, v231
    s_cmp_lg_u32 s34, 0
    s_cbranch_scc1 K2_dum_17
    s_cmp_eq_u32 s33, 4
    s_cbranch_scc1 K2_a4_18
K2_b4_20:
    s_add_u32 m0, s48, 512
    s_add_u32 s65, s48, 1536
    buffer_load_dwordx4 v232, s[16:19], 0 offen  lds
    s_mov_b32 m0, s65
    s_mov_b32 exec_hi, 0
    buffer_load_dwordx4 v233, s[16:19], 0 offen  lds
    s_mov_b32 exec_hi, -1
K2_back_19:
    s_waitcnt vmcnt(6) lgkmcnt(1)
    v_mfma_f32_32x32x16_bf16 v[0:15], v[72:75], v[184:187], v[0:15]
    ds_read_b64_tr_b16 v[176:177], v246 offset:0
    ds_read_b64_tr_b16 v[178:179], v246 offset:1024
    ds_read_b64_tr_b16 v[180:181], v247 offset:0
    ds_read_b64_tr_b16 v[182:183], v247 offset:1024
    v_permlane32_swap_b32 v241, v239
    s_mov_b32 m0, s71
    v_mfma_f32_32x32x16_bf16 v[16:31], v[76:79], v[184:187], v[16:31]
    buffer_load_dwordx4 v224, s[4:7], s43 offen sc1 lds
    buffer_load_dwordx4 v225, s[72:75], s43 offen offset:1024 sc1 lds
    s_waitcnt lgkmcnt(4)
    v_mad_u32_u16 v222, v222, s39, v248 op_sel:[1,0,0,0]
    v_mad_u32_u16 v223, v223, s39, v248 op_sel:[1,0,0,0]
    v_add_f32 v234, v234, v236
    v_add_f32 v235, v235, v237
    v_add_f32 v240, v240, v238
    v_add_f32 v241, v241, v239
    s_set_gpr_idx_on s31, gpr_idx(DST)
    s_nop 0
    v_cvt_pk_bf16_f32 v192, v234, v235
    v_cvt_pk_bf16_f32 v193, v240, v241
    s_set_gpr_idx_off
    v_mfma_f32_32x32x16_bf16 v[32:47], v[72:75], v[188:191], v[32:47]
    v_add_u32 v224, s49, v251
    ds_read2_b32 v[224:225], v224 offset0:1 offset1:3
    v_mul_f32 v234, v0, v144
    v_mul_f32 v236, v8, v112
    v_fmac_f32 v234, v1, v145
    v_fmac_f32 v236, v9, v113
    v_fmac_f32 v234, v2, v146
    v_mfma_f32_32x32x16_bf16 v[48:63], v[76:79], v[188:191], v[48:63]
    s_setprio 0
    v_fmac_f32 v236, v10, v114
    v_fmac_f32 v234, v3, v147
    v_fmac_f32 v236, v11, v115
    v_fmac_f32 v234, v4, v148
    v_fmac_f32 v236, v12, v116
    v_fmac_f32 v234, v5, v149
    v_fmac_f32 v236, v13, v117
    v_fmac_f32 v234, v6, v150
    v_fmac_f32 v236, v14, v118
    v_fmac_f32 v234, v7, v151
    v_fmac_f32 v236, v15, v119
    v_mul_f32 v238, v16, v160
    v_mul_f32 v240, v24, v160
    v_fmac_f32 v238, v17, v161
    v_fmac_f32 v240, v25, v161
    v_fmac_f32 v238, v18, v162
    v_fmac_f32 v240, v26, v162
    v_fmac_f32 v238, v19, v163
    v_fmac_f32 v240, v27, v163
    v_fmac_f32 v238, v20, v164
    v_fmac_f32 v240, v28, v164
    v_fmac_f32 v238, v21, v165
    v_fmac_f32 v240, v29, v165
    v_fmac_f32 v238, v22, v166
    v_fmac_f32 v240, v30, v166
    v_fmac_f32 v238, v23, v167
    v_fmac_f32 v240, v31, v167
    v_mul_f32 v235, v32, v152
    v_mul_f32 v237, v40, v120
    v_fmac_f32 v235, v33, v153
    v_fmac_f32 v237, v41, v121
    v_fmac_f32 v235, v34, v154
    v_fmac_f32 v237, v42, v122
    v_fmac_f32 v235, v35, v155
    v_fmac_f32 v237, v43, v123
    v_fmac_f32 v235, v36, v156
    v_fmac_f32 v237, v44, v124
    v_fmac_f32 v235, v37, v157
    v_fmac_f32 v237, v45, v125
    v_fmac_f32 v235, v38, v158
    v_fmac_f32 v237, v46, v126
    v_fmac_f32 v235, v39, v159
    v_fmac_f32 v237, v47, v127
    v_mul_f32 v239, v48, v168
    v_mul_f32 v241, v56, v168
    v_fmac_f32 v239, v49, v169
    v_fmac_f32 v241, v57, v169
    v_fmac_f32 v239, v50, v170
    v_fmac_f32 v241, v58, v170
    v_fmac_f32 v239, v51, v171
    s_setprio 1
    s_waitcnt vmcnt(6) lgkmcnt(1)
    v_mfma_f32_32x32x16_bf16 v[0:15], v[64:67], v[176:179], 0
    ds_read_b64_tr_b16 v[184:185], v246 offset:2048
    ds_read_b64_tr_b16 v[186:187], v246 offset:3072
    ds_read_b64_tr_b16 v[188:189], v247 offset:2048
    ds_read_b64_tr_b16 v[190:191], v247 offset:3072
    v_fmac_f32 v241, v59, v171
    v_fmac_f32 v239, v52, v172
    s_mov_b32 m0, s68
    v_mfma_f32_32x32x16_bf16 v[16:31], v[68:71], v[176:179], 0
    buffer_load_dwordx4 v222, s[4:7], s44 offen sc1 lds
    buffer_load_dwordx4 v223, s[72:75], s44 offen offset:1024 sc1 lds
    s_waitcnt lgkmcnt(4)
    v_mad_u32_u16 v224, v224, s39, v248 op_sel:[1,0,0,0]
    v_mad_u32_u16 v225, v225, s39, v248 op_sel:[1,0,0,0]
    v_fmac_f32 v241, v60, v172
    v_fmac_f32 v239, v53, v173
    v_mfma_f32_32x32x16_bf16 v[32:47], v[64:67], v[180:183], 0
    v_add_u32 v226, s50, v251
    ds_read2_b32 v[226:227], v226 offset0:1 offset1:3
    v_fmac_f32 v241, v61, v173
    v_fmac_f32 v239, v54, v174
    v_fmac_f32 v241, v62, v174
    v_fmac_f32 v239, v55, v175
    v_fmac_f32 v241, v63, v175
    v_mfma_f32_32x32x16_bf16 v[48:63], v[68:71], v[180:183], 0
    s_waitcnt vmcnt(6) lgkmcnt(1)
    v_mfma_f32_32x32x16_bf16 v[0:15], v[72:75], v[184:187], v[0:15]
    ds_read_b64_tr_b16 v[176:177], v246 offset:4096
    ds_read_b64_tr_b16 v[178:179], v246 offset:5120
    ds_read_b64_tr_b16 v[180:181], v247 offset:4096
    ds_read_b64_tr_b16 v[182:183], v247 offset:5120
    s_mov_b32 m0, s69
    v_mfma_f32_32x32x16_bf16 v[16:31], v[76:79], v[184:187], v[16:31]
    buffer_load_dwordx4 v224, s[4:7], s45 offen sc1 lds
    buffer_load_dwordx4 v225, s[72:75], s45 offen offset:1024 sc1 lds
    s_waitcnt lgkmcnt(4)
    v_mad_u32_u16 v226, v226, s39, v248 op_sel:[1,0,0,0]
    v_mad_u32_u16 v227, v227, s39, v248 op_sel:[1,0,0,0]
    v_mfma_f32_32x32x16_bf16 v[32:47], v[72:75], v[188:191], v[32:47]
    v_add_u32 v228, s51, v251
    ds_read2_b32 v[228:229], v228 offset0:1 offset1:3
    v_mul_f32 v242, v0, v144
    v_fma_f32 v238, v8, v160, -v238
    v_fmac_f32 v242, v1, v145
    v_fmac_f32 v238, v9, v161
    v_fmac_f32 v242, v2, v146
    v_mfma_f32_32x32x16_bf16 v[48:63], v[76:79], v[188:191], v[48:63]
    s_setprio 0
    v_fmac_f32 v238, v10, v162
    v_fmac_f32 v242, v3, v147
    v_fmac_f32 v238, v11, v163
    v_fmac_f32 v242, v4, v148
    v_fmac_f32 v238, v12, v164
    v_fmac_f32 v242, v5, v149
    v_fmac_f32 v238, v13, v165
    v_fmac_f32 v242, v6, v150
    v_fmac_f32 v238, v14, v166
    v_fmac_f32 v242, v7, v151
    v_fmac_f32 v238, v15, v167
    v_fmac_f32 v236, v16, v112
    v_mul_f32 v244, v24, v160
    v_fmac_f32 v236, v17, v113
    v_fmac_f32 v244, v25, v161
    v_fmac_f32 v236, v18, v114
    v_fmac_f32 v244, v26, v162
    v_fmac_f32 v236, v19, v115
    v_fmac_f32 v244, v27, v163
    v_fmac_f32 v236, v20, v116
    v_fmac_f32 v244, v28, v164
    v_fmac_f32 v236, v21, v117
    v_fmac_f32 v244, v29, v165
    v_fmac_f32 v236, v22, v118
    v_fmac_f32 v244, v30, v166
    v_fmac_f32 v236, v23, v119
    v_fmac_f32 v244, v31, v167
    v_mul_f32 v243, v32, v152
    v_fma_f32 v239, v40, v168, -v239
    v_fmac_f32 v243, v33, v153
    v_fmac_f32 v239, v41, v169
    v_fmac_f32 v243, v34, v154
    v_fmac_f32 v239, v42, v170
    v_fmac_f32 v243, v35, v155
    v_fmac_f32 v239, v43, v171
    v_fmac_f32 v243, v36, v156
    v_fmac_f32 v239, v44, v172
    v_fmac_f32 v243, v37, v157
    v_fmac_f32 v239, v45, v173
    v_fmac_f32 v243, v38, v158
    v_fmac_f32 v239, v46, v174
    v_fmac_f32 v243, v39, v159
    v_fmac_f32 v239, v47, v175
    v_fmac_f32 v237, v48, v120
    v_mul_f32 v245, v56, v168
    v_fmac_f32 v237, v49, v121
    v_fmac_f32 v245, v57, v169
    v_fmac_f32 v237, v50, v122
    s_setprio 1
    s_waitcnt vmcnt(4) lgkmcnt(1)
    v_mfma_f32_32x32x16_bf16 v[0:15], v[64:67], v[176:179], 0
    ds_read_b64_tr_b16 v[184:185], v246 offset:6144
    ds_read_b64_tr_b16 v[186:187], v246 offset:7168
    ds_read_b64_tr_b16 v[188:189], v247 offset:6144
    ds_read_b64_tr_b16 v[190:191], v247 offset:7168
    v_fmac_f32 v245, v58, v170
    v_fmac_f32 v237, v51, v123
    s_mov_b32 m0, s70
    v_mfma_f32_32x32x16_bf16 v[16:31], v[68:71], v[176:179], 0
    buffer_load_dwordx4 v226, s[4:7], s46 offen sc1 lds
    buffer_load_dwordx4 v227, s[72:75], s46 offen offset:1024 sc1 lds
    s_waitcnt lgkmcnt(4)
    v_mad_u32_u16 v228, v228, s39, v248 op_sel:[1,0,0,0]
    v_mad_u32_u16 v229, v229, s39, v248 op_sel:[1,0,0,0]
    v_fmac_f32 v245, v59, v171
    v_fmac_f32 v237, v52, v124
    v_mfma_f32_32x32x16_bf16 v[32:47], v[64:67], v[180:183], 0
    v_fmac_f32 v245, v60, v172
    v_fmac_f32 v237, v53, v125
    v_fmac_f32 v245, v61, v173
    v_fmac_f32 v237, v54, v126
    v_fmac_f32 v245, v62, v174
    v_fmac_f32 v237, v55, v127
    v_fmac_f32 v245, v63, v175
    v_mfma_f32_32x32x16_bf16 v[48:63], v[68:71], v[180:183], 0
    v_permlane32_swap_b32 v242, v234
    v_permlane32_swap_b32 v243, v235
    v_add_f32 v242, v242, v234
    v_add_f32 v243, v243, v235
    s_waitcnt vmcnt(4) lgkmcnt(0)
    v_mfma_f32_32x32x16_bf16 v[0:15], v[72:75], v[184:187], v[0:15]
    ds_read_b64_tr_b16 v[176:177], v246 offset:0
    ds_read_b64_tr_b16 v[178:179], v246 offset:1024
    ds_read_b64_tr_b16 v[180:181], v247 offset:0
    ds_read_b64_tr_b16 v[182:183], v247 offset:1024
    s_sub_u32 s26, s48, s29
    s_mov_b32 s29, s48
    s_mov_b32 m0, s71
    v_mfma_f32_32x32x16_bf16 v[16:31], v[76:79], v[184:187], v[16:31]
    buffer_load_dwordx4 v228, s[4:7], s47 offen sc1 lds
    buffer_load_dwordx4 v229, s[72:75], s47 offen offset:1024 sc1 lds
    s_set_gpr_idx_on s31, gpr_idx(DST)
    s_nop 0
    v_cvt_pk_bf16_f32 v194, v242, v243
    s_set_gpr_idx_off
    s_mov_b32 s30, s3
    s_bfe_u32 s56, s3, 0x40012
    s_cmp_eq_u32 s34, 0
    s_cselect_b32 s56, s56, 0
    v_mfma_f32_32x32x16_bf16 v[32:47], v[72:75], v[188:191], v[32:47]
    s_mov_b32 s32, s31
    s_mov_b32 s31, s35
    v_mul_f32 v242, v0, v144
    v_fma_f32 v240, v8, v160, -v240
    v_fmac_f32 v242, v1, v145
    v_fmac_f32 v240, v9, v161
    v_fmac_f32 v242, v2, v146
    v_mfma_f32_32x32x16_bf16 v[48:63], v[76:79], v[188:191], v[48:63]
    s_setprio 0
    v_fmac_f32 v240, v10, v162
    v_fmac_f32 v242, v3, v147
    v_fmac_f32 v240, v11, v163
    v_fmac_f32 v242, v4, v148
    v_fmac_f32 v240, v12, v164
    v_fmac_f32 v242, v5, v149
    v_fmac_f32 v240, v13, v165
    v_fmac_f32 v242, v6, v150
    v_fmac_f32 v240, v14, v166
    v_fmac_f32 v242, v7, v151
    v_fmac_f32 v240, v15, v167
    v_add_u32 v249, s26, v249
    v_add_u32 v250, s26, v250
    v_fma_f32 v244, v16, v160, -v244
    v_fmac_f32 v236, v24, v112
    v_fmac_f32 v244, v17, v161
    v_fmac_f32 v236, v25, v113
    v_fmac_f32 v244, v18, v162
    v_fmac_f32 v236, v26, v114
    v_fmac_f32 v244, v19, v163
    v_fmac_f32 v236, v27, v115
    v_fmac_f32 v244, v20, v164
    v_fmac_f32 v236, v28, v116
    v_fmac_f32 v244, v21, v165
    v_fmac_f32 v236, v29, v117
    v_fmac_f32 v244, v22, v166
    v_fmac_f32 v236, v30, v118
    v_fmac_f32 v244, v23, v167
    v_fmac_f32 v236, v31, v119
    ds_read_b64_tr_b16 v[0:1], v249 offset:0
    ds_read_b64_tr_b16 v[2:3], v249 offset:32
    ds_read_u16_d16_hi v16, v250 offset:0
    v_mul_f32 v243, v32, v152
    v_fma_f32 v241, v40, v168, -v241
    v_fmac_f32 v243, v33, v153
    v_fmac_f32 v241, v41, v169
    v_fmac_f32 v243, v34, v154
    v_fmac_f32 v241, v42, v170
    v_fmac_f32 v243, v35, v155
    v_fmac_f32 v241, v43, v171
    v_fmac_f32 v243, v36, v156
    v_fmac_f32 v241, v44, v172
    v_fmac_f32 v243, v37, v157
    v_fmac_f32 v241, v45, v173
    v_fmac_f32 v243, v38, v158
    v_fmac_f32 v241, v46, v174
    v_fmac_f32 v243, v39, v159
    v_fmac_f32 v241, v47, v175
    ds_read_b64_tr_b16 v[4:5], v249 offset:512
    ds_read_b64_tr_b16 v[6:7], v249 offset:544
    ds_read_u16_d16_hi v17, v250 offset:128
    v_fma_f32 v245, v48, v168, -v245
    v_fmac_f32 v237, v56, v120
    v_fmac_f32 v245, v49, v169
    v_fmac_f32 v237, v57, v121
    v_fmac_f32 v245, v50, v170
    v_fmac_f32 v237, v58, v122
    v_fmac_f32 v245, v51, v171
    v_fmac_f32 v237, v59, v123
    v_fmac_f32 v245, v52, v172
    v_fmac_f32 v237, v60, v124
    v_fmac_f32 v245, v53, v173
    v_fmac_f32 v237, v61, v125
    v_fmac_f32 v245, v54, v174
    v_fmac_f32 v237, v62, v126
    v_fmac_f32 v245, v55, v175
    v_fmac_f32 v237, v63, v127
    s_cmp_eq_u32 s56, 5
    s_cbranch_scc1 K2_U20
    s_cmp_eq_u32 s56, 6
    s_cbranch_scc1 K2_U3h0
    s_branch K2_DSP0
K2_PAD_U30:
    s_branch K2_HOP
K2_U3h0:
    s_setprio 1
    ds_read_b64_tr_b16 v[8:9], v249 offset:1024
    ds_read_u16_d16_hi v18, v250 offset:256
    s_waitcnt lgkmcnt(2)
    v_lshlrev_b32 v20, 16, v0
    v_and_b32 v21, 0xffff0000, v0
    v_lshlrev_b32 v22, 16, v1
    v_and_b32 v23, 0xffff0000, v1
    v_lshlrev_b32 v24, 16, v2
    v_and_b32 v25, 0xffff0000, v2
    v_lshlrev_b32 v26, 16, v3
    v_and_b32 v27, 0xffff0000, v3
    v_mul_f32_dpp v36, v16, v20 row_newbcast:8 row_mask:0xf bank_mask:0xf
    v_mul_f32_dpp v37, v16, v21 row_newbcast:9 row_mask:0xf bank_mask:0xf
    v_mul_f32_dpp v38, v16, v22 row_newbcast:10 row_mask:0xf bank_mask:0xf
    v_mul_f32_dpp v39, v16, v23 row_newbcast:11 row_mask:0xf bank_mask:0xf
    v_mul_f32_dpp v40, v16, v24 row_newbcast:12 row_mask:0xf bank_mask:0xf
    v_mul_f32_dpp v41, v16, v25 row_newbcast:13 row_mask:0xf bank_mask:0xf
    v_mul_f32_dpp v42, v16, v26 row_newbcast:14 row_mask:0xf bank_mask:0xf
    v_mul_f32_dpp v43, v16, v27 row_newbcast:15 row_mask:0xf bank_mask:0xf
    v_cvt_pk_bf16_f32 v68, v36, v37
    v_cvt_pk_bf16_f32 v69, v38, v39
    v_cvt_pk_bf16_f32 v70, v40, v41
    v_cvt_pk_bf16_f32 v71, v42, v43
    v_mul_f32_dpp v20, v16, v20 row_newbcast:0 row_mask:0xa bank_mask:0xf
    v_mul_f32_dpp v21, v16, v21 row_newbcast:1 row_mask:0xa bank_mask:0xf
    v_mul_f32_dpp v22, v16, v22 row_newbcast:2 row_mask:0xa bank_mask:0xf
    v_mul_f32_dpp v23, v16, v23 row_newbcast:3 row_mask:0xa bank_mask:0xf
    v_mul_f32_dpp v24, v16, v24 row_newbcast:4 row_mask:0xa bank_mask:0xf
    v_mul_f32_dpp v25, v16, v25 row_newbcast:5 row_mask:0xa bank_mask:0xf
    v_mul_f32_dpp v26, v16, v26 row_newbcast:6 row_mask:0xa bank_mask:0xf
    v_mul_f32_dpp v27, v16, v27 row_newbcast:7 row_mask:0xa bank_mask:0xf
    v_cvt_pk_bf16_f32 v64, v20, v21
    v_cvt_pk_bf16_f32 v65, v22, v23
    v_cvt_pk_bf16_f32 v66, v24, v25
    v_cvt_pk_bf16_f32 v67, v26, v27
    v_lshlrev_b32 v28, 16, v4
    v_and_b32 v29, 0xffff0000, v4
    v_lshlrev_b32 v30, 16, v5
    v_and_b32 v31, 0xffff0000, v5
    v_lshlrev_b32 v32, 16, v6
    v_and_b32 v33, 0xffff0000, v6
    v_lshlrev_b32 v34, 16, v7
    v_and_b32 v35, 0xffff0000, v7
    v_mul_f32_dpp v36, v17, v28 row_newbcast:8 row_mask:0xf bank_mask:0xf
    v_mul_f32_dpp v37, v17, v29 row_newbcast:9 row_mask:0xf bank_mask:0xf
    v_mul_f32_dpp v38, v17, v30 row_newbcast:10 row_mask:0xf bank_mask:0xf
    v_mul_f32_dpp v39, v17, v31 row_newbcast:11 row_mask:0xf bank_mask:0xf
    v_mul_f32_dpp v40, v17, v32 row_newbcast:12 row_mask:0xf bank_mask:0xf
    v_mul_f32_dpp v41, v17, v33 row_newbcast:13 row_mask:0xf bank_mask:0xf
    v_mul_f32_dpp v42, v17, v34 row_newbcast:14 row_mask:0xf bank_mask:0xf
    v_mul_f32_dpp v43, v17, v35 row_newbcast:15 row_mask:0xf bank_mask:0xf
    v_cvt_pk_bf16_f32 v76, v36, v37
    v_cvt_pk_bf16_f32 v77, v38, v39
    v_cvt_pk_bf16_f32 v78, v40, v41
    v_cvt_pk_bf16_f32 v79, v42, v43
    v_mul_f32_dpp v28, v17, v28 row_newbcast:0 row_mask:0xa bank_mask:0xf
    v_mul_f32_dpp v29, v17, v29 row_newbcast:1 row_mask:0xa bank_mask:0xf
    v_mul_f32_dpp v30, v17, v30 row_newbcast:2 row_mask:0xa bank_mask:0xf
    v_mul_f32_dpp v31, v17, v31 row_newbcast:3 row_mask:0xa bank_mask:0xf
    v_mul_f32_dpp v32, v17, v32 row_newbcast:4 row_mask:0xa bank_mask:0xf
    v_mul_f32_dpp v33, v17, v33 row_newbcast:5 row_mask:0xa bank_mask:0xf
    v_mul_f32_dpp v34, v17, v34 row_newbcast:6 row_mask:0xa bank_mask:0xf
    v_mul_f32_dpp v35, v17, v35 row_newbcast:7 row_mask:0xa bank_mask:0xf
    v_cvt_pk_bf16_f32 v72, v28, v29
    v_cvt_pk_bf16_f32 v73, v30, v31
    v_cvt_pk_bf16_f32 v74, v32, v33
    v_cvt_pk_bf16_f32 v75, v34, v35
    s_waitcnt lgkmcnt(0)
    v_lshlrev_b32 v20, 16, v8
    v_and_b32 v21, 0xffff0000, v8
    v_lshlrev_b32 v22, 16, v9
    v_and_b32 v23, 0xffff0000, v9
    v_mul_f32_dpp v36, v18, v20 row_newbcast:8 row_mask:0xf bank_mask:0xf
    v_mul_f32_dpp v37, v18, v21 row_newbcast:9 row_mask:0xf bank_mask:0xf
    v_mul_f32_dpp v38, v18, v22 row_newbcast:10 row_mask:0xf bank_mask:0xf
    v_mul_f32_dpp v39, v18, v23 row_newbcast:11 row_mask:0xf bank_mask:0xf
    v_cvt_pk_bf16_f32 v84, v36, v37
    v_cvt_pk_bf16_f32 v85, v38, v39
    v_mul_f32_dpp v20, v18, v20 row_newbcast:0 row_mask:0xa bank_mask:0xf
    v_mul_f32_dpp v21, v18, v21 row_newbcast:1 row_mask:0xa bank_mask:0xf
    v_mul_f32_dpp v22, v18, v22 row_newbcast:2 row_mask:0xa bank_mask:0xf
    v_mul_f32_dpp v23, v18, v23 row_newbcast:3 row_mask:0xa bank_mask:0xf
    v_cvt_pk_bf16_f32 v80, v20, v21
    v_cvt_pk_bf16_f32 v81, v22, v23
    s_waitcnt vmcnt(4)
    v_mfma_f32_32x32x16_bf16 v[0:15], v[64:67], v[176:179], 0
    ds_read_b64_tr_b16 v[184:185], v246 offset:2048
    ds_read_b64_tr_b16 v[186:187], v246 offset:3072
    ds_read_b64_tr_b16 v[188:189], v247 offset:2048
    ds_read_b64_tr_b16 v[190:191], v247 offset:3072
    s_mov_b32 m0, s68
    v_mfma_f32_32x32x16_bf16 v[16:31], v[68:71], v[176:179], 0
    buffer_load_dwordx4 v224, s[4:7], s41 offen sc1 lds
    buffer_load_dwordx4 v225, s[72:75], s41 offen offset:1024 sc1 lds
    v_permlane32_swap_b32 v242, v236
    v_permlane32_swap_b32 v243, v237
    s_add_u32 s38, s38, 1
    v_mfma_f32_32x32x16_bf16 v[32:47], v[64:67], v[180:183], 0
    v_permlane32_swap_b32 v244, v238
    v_permlane32_swap_b32 v245, v239
    v_permlane32_swap_b32 v240, v241
    v_add_f32 v242, v242, v236
    v_mfma_f32_32x32x16_bf16 v[48:63], v[68:71], v[180:183], 0
    v_add_f32 v243, v243, v237
    v_add_f32 v244, v244, v238
    v_add_f32 v245, v245, v239
    v_add_f32 v240, -v240, -v241
    v_mov_b32 v254, s52
    v_mov_b32 v255, s38
    s_waitcnt vmcnt(4) lgkmcnt(0)
    v_mfma_f32_32x32x16_bf16 v[0:15], v[72:75], v[184:187], v[0:15]
    ds_read_b64_tr_b16 v[176:177], v246 offset:4096
    ds_read_b64_tr_b16 v[180:181], v247 offset:4096
    s_lshl_b32 s58, s38, 3
    s_add_u32 s58, s58, s20
    s_mov_b32 m0, s69
    v_mfma_f32_32x32x16_bf16 v[16:31], v[76:79], v[184:187], v[16:31]
    buffer_load_dwordx4 v226, s[4:7], s41 offen sc1 lds
    s_set_gpr_idx_on s32, gpr_idx(DST)
    s_nop 0
    v_cvt_pk_bf16_f32 v195, v242, v243
    v_cvt_pk_bf16_f32 v196, v244, v245
    v_cvt_pk_bf16_f32 v197, v240, v240
    s_set_gpr_idx_off
    s_mov_b64 exec, 1
    ds_write_b32 v254, v255
    s_mov_b64 exec, -1
    s_cmp_lt_u32 s58, s22
    s_cbranch_scc0 K2_dyn_21
K2_back_22:
    v_readlane_b32 s3, v253, s58
    s_lshl_b32 s44, s34, 7
    s_and_b32 s48, s3, 0x3ffff
    s_bfe_u32 s33, s3, 0x30013
    s_mul_i32 s35, s38, 6
    s_cmp_eq_u32 s34, 0
    s_cselect_b32 s35, s35, s48
    s_mov_b32 s45, s44
    s_xor_b32 s47, s44, 256
    s_add_u32 s49, s48, 128
    s_add_u32 s60, s48, 256
    s_cmp_eq_u32 s33, 3
    s_cselect_b32 s46, s44, s47
    s_cselect_b32 s50, s60, s48
    s_cselect_b32 s51, s48, s49
    s_sub_u32 s60, s33, 2
    s_cmp_lt_u32 s60, 2
    s_cbranch_scc0 K2_rare_27
K2_back_28:
    v_mfma_f32_32x32x16_bf16 v[32:47], v[72:75], v[188:191], v[32:47]
    v_add_u32 v233, s48, v230
    ds_read_b32 v232, v233
    ds_read_b32 v233, v233 offset:1024
    v_mfma_f32_32x32x16_bf16 v[48:63], v[76:79], v[188:191], v[48:63]
    s_waitcnt vmcnt(3) lgkmcnt(3)
    v_mfma_f32_32x32x8_bf16 v[0:15], v[80:81], v[176:177], v[0:15]
    ds_read_b64_tr_b16 v[184:185], v246 offset:6144
    ds_read_b64_tr_b16 v[186:187], v246 offset:7168
    ds_read_b64_tr_b16 v[188:189], v247 offset:6144
    ds_read_b64_tr_b16 v[190:191], v247 offset:7168
    s_mov_b32 m0, s70
    v_mfma_f32_32x32x8_bf16 v[16:31], v[84:85], v[176:177], v[16:31]
    buffer_load_dwordx4 v222, s[4:7], s42 offen sc1 lds
    buffer_load_dwordx4 v223, s[72:75], s42 offen offset:1024 sc1 lds
    v_mfma_f32_32x32x8_bf16 v[32:47], v[80:81], v[180:181], v[32:47]
    s_nop 2
    v_mul_f32 v234, v0, v96
    v_mul_f32 v236, v8, v128
    v_fmac_f32 v234, v1, v97
    v_fmac_f32 v236, v9, v129
    v_fmac_f32 v234, v2, v98
    v_fmac_f32 v236, v10, v130
    v_fmac_f32 v234, v3, v99
    v_mfma_f32_32x32x8_bf16 v[48:63], v[84:85], v[180:181], v[48:63]
    s_setprio 0
    s_waitcnt lgkmcnt(4)
    v_or_b32 v232, v232, v231
    v_or_b32 v233, v233, v231
    s_cmp_lg_u32 s34, 0
    s_cbranch_scc1 K2_dum_30
    s_cmp_eq_u32 s33, 4
    s_cbranch_scc1 K2_a4_31
K2_b4_33:
    s_add_u32 m0, s48, 512
    s_add_u32 s65, s48, 1536
    buffer_load_dwordx4 v232, s[16:19], 0 offen  lds
    s_mov_b32 m0, s65
    s_mov_b32 exec_hi, 0
    buffer_load_dwordx4 v233, s[16:19], 0 offen  lds
    s_mov_b32 exec_hi, -1
K2_back_32:
    v_fmac_f32 v236, v11, v131
    v_fmac_f32 v234, v4, v100
    v_fmac_f32 v236, v12, v132
    v_fmac_f32 v234, v5, v101
    v_fmac_f32 v236, v13, v133
    v_fmac_f32 v234, v6, v102
    v_fmac_f32 v236, v14, v134
    v_fmac_f32 v234, v7, v103
    v_fmac_f32 v236, v15, v135
    v_mul_f32 v238, v16, v128
    v_mul_f32 v240, v24, v128
    v_fmac_f32 v238, v17, v129
    v_fmac_f32 v240, v25, v129
    v_fmac_f32 v238, v18, v130
    v_fmac_f32 v240, v26, v130
    v_fmac_f32 v238, v19, v131
    v_fmac_f32 v240, v27, v131
    v_fmac_f32 v238, v20, v132
    v_fmac_f32 v240, v28, v132
    v_fmac_f32 v238, v21, v133
    v_fmac_f32 v240, v29, v133
    v_fmac_f32 v238, v22, v134
    v_fmac_f32 v240, v30, v134
    v_fmac_f32 v238, v23, v135
    v_fmac_f32 v240, v31, v135
    v_mul_f32 v235, v32, v104
    v_mul_f32 v237, v40, v136
    v_fmac_f32 v235, v33, v105
    v_fmac_f32 v237, v41, v137
    v_fmac_f32 v235, v34, v106
    v_fmac_f32 v237, v42, v138
    v_fmac_f32 v235, v35, v107
    v_fmac_f32 v237, v43, v139
    v_fmac_f32 v235, v36, v108
    v_fmac_f32 v237, v44, v140
    v_fmac_f32 v235, v37, v109
    v_fmac_f32 v237, v45, v141
    v_fmac_f32 v235, v38, v110
    v_fmac_f32 v237, v46, v142
    v_fmac_f32 v235, v39, v111
    v_fmac_f32 v237, v47, v143
    v_mul_f32 v239, v48, v136
    v_mul_f32 v241, v56, v136
    s_setprio 1
    s_waitcnt vmcnt(5) lgkmcnt(0)
    v_mfma_f32_32x32x16_bf16 v[0:15], v[64:67], v[184:187], 0
    ds_read_b64_tr_b16 v[176:177], v246 offset:0
    ds_read_b64_tr_b16 v[178:179], v246 offset:1024
    ds_read_b64_tr_b16 v[180:181], v247 offset:0
    ds_read_b64_tr_b16 v[182:183], v247 offset:1024
    v_fmac_f32 v239, v49, v137
    v_fmac_f32 v241, v57, v137
    s_mov_b32 m0, s71
    v_mfma_f32_32x32x16_bf16 v[16:31], v[68:71], v[184:187], 0
    buffer_load_dwordx4 v224, s[4:7], s42 offen sc1 lds
    buffer_load_dwordx4 v225, s[72:75], s42 offen offset:1024 sc1 lds
    v_fmac_f32 v239, v50, v138
    v_fmac_f32 v241, v58, v138
    v_fmac_f32 v239, v51, v139
    v_fmac_f32 v241, v59, v139
    v_fmac_f32 v239, v52, v140
    v_mfma_f32_32x32x16_bf16 v[32:47], v[64:67], v[188:191], 0
    v_fmac_f32 v241, v60, v140
    v_fmac_f32 v239, v53, v141
    v_fmac_f32 v241, v61, v141
    v_fmac_f32 v239, v54, v142
    v_fmac_f32 v241, v62, v142
    v_fmac_f32 v239, v55, v143
    v_fmac_f32 v241, v63, v143
    v_mfma_f32_32x32x16_bf16 v[48:63], v[68:71], v[188:191], 0
    v_permlane32_swap_b32 v234, v236
    v_permlane32_swap_b32 v235, v237
    v_permlane32_swap_b32 v240, v238
    s_waitcnt vmcnt(6) lgkmcnt(0)
    v_mfma_f32_32x32x16_bf16 v[0:15], v[72:75], v[176:179], v[0:15]
    ds_read_b64_tr_b16 v[184:185], v246 offset:2048
    ds_read_b64_tr_b16 v[188:189], v247 offset:2048
    v_permlane32_swap_b32 v241, v239
    v_add_f32 v234, v234, v236
    v_add_f32 v235, v235, v237
    s_mov_b32 m0, s68
    v_mfma_f32_32x32x16_bf16 v[16:31], v[76:79], v[176:179], v[16:31]
    buffer_load_dwordx4 v226, s[4:7], s42 offen sc1 lds
    v_add_f32 v240, v240, v238
    v_add_f32 v241, v241, v239
    s_set_gpr_idx_on s31, gpr_idx(DST)
    s_nop 0
    v_cvt_pk_bf16_f32 v192, v234, v235
    v_cvt_pk_bf16_f32 v193, v240, v241
    s_set_gpr_idx_off
    v_mfma_f32_32x32x16_bf16 v[32:47], v[72:75], v[180:183], v[32:47]
    v_mfma_f32_32x32x16_bf16 v[48:63], v[76:79], v[180:183], v[48:63]
    s_waitcnt vmcnt(5) lgkmcnt(0)
    v_mfma_f32_32x32x8_bf16 v[0:15], v[80:81], v[184:185], v[0:15]
    ds_read_b64_tr_b16 v[176:177], v246 offset:4096
    ds_read_b64_tr_b16 v[178:179], v246 offset:5120
    ds_read_b64_tr_b16 v[180:181], v247 offset:4096
    ds_read_b64_tr_b16 v[182:183], v247 offset:5120
    s_mov_b32 m0, s69
    v_mfma_f32_32x32x8_bf16 v[16:31], v[84:85], v[184:185], v[16:31]
    buffer_load_dwordx4 v222, s[4:7], s43 offen sc1 lds
    buffer_load_dwordx4 v223, s[72:75], s43 offen offset:1024 sc1 lds
    v_mfma_f32_32x32x8_bf16 v[32:47], v[80:81], v[188:189], v[32:47]
    s_nop 2
    v_mul_f32 v234, v0, v144
    v_mul_f32 v236, v8, v112
    v_fmac_f32 v234, v1, v145
    v_fmac_f32 v236, v9, v113
    v_fmac_f32 v234, v2, v146
    v_fmac_f32 v236, v10, v114
    v_fmac_f32 v234, v3, v147
    v_mfma_f32_32x32x8_bf16 v[48:63], v[84:85], v[188:189], v[48:63]
    s_setprio 0
    v_fmac_f32 v236, v11, v115
    v_fmac_f32 v234, v4, v148
    v_fmac_f32 v236, v12, v116
    v_fmac_f32 v234, v5, v149
    v_fmac_f32 v236, v13, v117
    v_fmac_f32 v234, v6, v150
    v_fmac_f32 v236, v14, v118
    v_fmac_f32 v234, v7, v151
    v_fmac_f32 v236, v15, v119
    v_mul_f32 v238, v16, v160
    v_mul_f32 v240, v24, v160
    v_fmac_f32 v238, v17, v161
    v_fmac_f32 v240, v25, v161
    v_fmac_f32 v238, v18, v162
    v_fmac_f32 v240, v26, v162
    v_fmac_f32 v238, v19, v163
    v_fmac_f32 v240, v27, v163
    v_fmac_f32 v238, v20, v164
    v_fmac_f32 v240, v28, v164
    v_fmac_f32 v238, v21, v165
    v_fmac_f32 v240, v29, v165
    v_fmac_f32 v238, v22, v166
    v_fmac_f32 v240, v30, v166
    v_fmac_f32 v238, v23, v167
    v_fmac_f32 v240, v31, v167
    v_mul_f32 v235, v32, v152
    v_mul_f32 v237, v40, v120
    v_fmac_f32 v235, v33, v153
    v_fmac_f32 v237, v41, v121
    v_fmac_f32 v235, v34, v154
    v_fmac_f32 v237, v42, v122
    v_fmac_f32 v235, v35, v155
    v_fmac_f32 v237, v43, v123
    v_fmac_f32 v235, v36, v156
    v_fmac_f32 v237, v44, v124
    v_fmac_f32 v235, v37, v157
    v_fmac_f32 v237, v45, v125
    v_fmac_f32 v235, v38, v158
    v_fmac_f32 v237, v46, v126
    v_fmac_f32 v235, v39, v159
    v_fmac_f32 v237, v47, v127
    v_mul_f32 v239, v48, v168
    v_mul_f32 v241, v56, v168
    v_fmac_f32 v239, v49, v169
    v_fmac_f32 v241, v57, v169
    s_setprio 1
    s_waitcnt vmcnt(3) lgkmcnt(0)
    v_mfma_f32_32x32x16_bf16 v[0:15], v[64:67], v[176:179], 0
    ds_read_b64_tr_b16 v[184:185], v246 offset:6144
    ds_read_b64_tr_b16 v[186:187], v246 offset:7168
    ds_read_b64_tr_b16 v[188:189], v247 offset:6144
    ds_read_b64_tr_b16 v[190:191], v247 offset:7168
    v_fmac_f32 v239, v50, v170
    v_fmac_f32 v241, v58, v170
    s_mov_b32 m0, s70
    v_mfma_f32_32x32x16_bf16 v[16:31], v[68:71], v[176:179], 0
    buffer_load_dwordx4 v224, s[4:7], s43 offen sc1 lds
    buffer_load_dwordx4 v225, s[72:75], s43 offen offset:1024 sc1 lds
    v_fmac_f32 v239, v51, v171
    v_fmac_f32 v241, v59, v171
    v_fmac_f32 v239, v52, v172
    v_fmac_f32 v241, v60, v172
    v_fmac_f32 v239, v53, v173
    v_mfma_f32_32x32x16_bf16 v[32:47], v[64:67], v[180:183], 0
    v_add_u32 v222, s48, v251
    ds_read2_b32 v[222:223], v222 offset0:1 offset1:3
    v_fmac_f32 v241, v61, v173
    v_fmac_f32 v239, v54, v174
    v_fmac_f32 v241, v62, v174
    v_fmac_f32 v239, v55, v175
    v_fmac_f32 v241, v63, v175
    v_mfma_f32_32x32x16_bf16 v[48:63], v[68:71], v[180:183], 0
    s_waitcnt vmcnt(4) lgkmcnt(1)
    v_mfma_f32_32x32x16_bf16 v[0:15], v[72:75], v[184:187], v[0:15]
    ds_read_b64_tr_b16 v[176:177], v246 offset:0
    ds_read_b64_tr_b16 v[180:181], v247 offset:0
    s_mov_b32 m0, s71
    v_mfma_f32_32x32x16_bf16 v[16:31], v[76:79], v[184:187], v[16:31]
    buffer_load_dwordx4 v226, s[4:7], s43 offen sc1 lds
    s_waitcnt lgkmcnt(2)
    v_mad_u32_u16 v222, v222, s39, v248 op_sel:[1,0,0,0]
    v_mad_u32_u16 v223, v223, s39, v248 op_sel:[1,0,0,0]
    v_mfma_f32_32x32x16_bf16 v[32:47], v[72:75], v[188:191], v[32:47]
    v_add_u32 v224, s49, v251
    ds_read2_b32 v[224:225], v224 offset0:1 offset1:3
    v_mfma_f32_32x32x16_bf16 v[48:63], v[76:79], v[188:191], v[48:63]
    s_waitcnt vmcnt(3) lgkmcnt(1)
    v_mfma_f32_32x32x8_bf16 v[0:15], v[80:81], v[176:177], v[0:15]
    ds_read_b64_tr_b16 v[184:185], v246 offset:2048
    ds_read_b64_tr_b16 v[186:187], v246 offset:3072
    ds_read_b64_tr_b16 v[188:189], v247 offset:2048
    ds_read_b64_tr_b16 v[190:191], v247 offset:3072
    s_mov_b32 m0, s68
    v_mfma_f32_32x32x8_bf16 v[16:31], v[84:85], v[176:177], v[16:31]
    buffer_load_dwordx4 v222, s[4:7], s44 offen sc1 lds
    buffer_load_dwordx4 v223, s[72:75], s44 offen offset:1024 sc1 lds
    s_waitcnt lgkmcnt(4)
    v_mad_u32_u16 v224, v224, s39, v248 op_sel:[1,0,0,0]
    v_mad_u32_u16 v225, v225, s39, v248 op_sel:[1,0,0,0]
    v_mfma_f32_32x32x8_bf16 v[32:47], v[80:81], v[180:181], v[32:47]
    v_add_u32 v226, s50, v251
    ds_read2_b32 v[226:227], v226 offset0:1 offset1:3
    v_mul_f32 v242, v0, v144
    v_fma_f32 v238, v8, v160, -v238
    v_fmac_f32 v242, v1, v145
    v_fmac_f32 v238, v9, v161
    v_fmac_f32 v242, v2, v146
    v_mfma_f32_32x32x8_bf16 v[48:63], v[84:85], v[180:181], v[48:63]
    s_setprio 0
    v_fmac_f32 v238, v10, v162
    v_fmac_f32 v242, v3, v147
    v_fmac_f32 v238, v11, v163
    v_fmac_f32 v242, v4, v148
    v_fmac_f32 v238, v12, v164
    v_fmac_f32 v242, v5, v149
    v_fmac_f32 v238, v13, v165
    v_fmac_f32 v242, v6, v150
    v_fmac_f32 v238, v14, v166
    v_fmac_f32 v242, v7, v151
    v_fmac_f32 v238, v15, v167
    v_fmac_f32 v236, v16, v112
    v_mul_f32 v244, v24, v160
    v_fmac_f32 v236, v17, v113
    v_fmac_f32 v244, v25, v161
    v_fmac_f32 v236, v18, v114
    v_fmac_f32 v244, v26, v162
    v_fmac_f32 v236, v19, v115
    v_fmac_f32 v244, v27, v163
    v_fmac_f32 v236, v20, v116
    v_fmac_f32 v244, v28, v164
    v_fmac_f32 v236, v21, v117
    v_fmac_f32 v244, v29, v165
    v_fmac_f32 v236, v22, v118
    v_fmac_f32 v244, v30, v166
    v_fmac_f32 v236, v23, v119
    v_fmac_f32 v244, v31, v167
    v_mul_f32 v243, v32, v152
    v_fma_f32 v239, v40, v168, -v239
    v_fmac_f32 v243, v33, v153
    v_fmac_f32 v239, v41, v169
    v_fmac_f32 v243, v34, v154
    v_fmac_f32 v239, v42, v170
    v_fmac_f32 v243, v35, v155
    v_fmac_f32 v239, v43, v171
    v_fmac_f32 v243, v36, v156
    v_fmac_f32 v239, v44, v172
    v_fmac_f32 v243, v37, v157
    v_fmac_f32 v239, v45, v173
    v_fmac_f32 v243, v38, v158
    v_fmac_f32 v239, v46, v174
    v_fmac_f32 v243, v39, v159
    v_fmac_f32 v239, v47, v175
    v_fmac_f32 v237, v48, v120
    v_mul_f32 v245, v56, v168
    v_fmac_f32 v237, v49, v121
    v_fmac_f32 v245, v57, v169
    v_fmac_f32 v237, v50, v122
    v_fmac_f32 v245, v58, v170
    v_fmac_f32 v237, v51, v123
    s_setprio 1
    s_waitcnt vmcnt(3) lgkmcnt(1)
    v_mfma_f32_32x32x16_bf16 v[0:15], v[64:67], v[184:187], 0
    ds_read_b64_tr_b16 v[176:177], v246 offset:4096
    ds_read_b64_tr_b16 v[178:179], v246 offset:5120
    ds_read_b64_tr_b16 v[180:181], v247 offset:4096
    ds_read_b64_tr_b16 v[182:183], v247 offset:5120
    v_fmac_f32 v245, v59, v171
    v_fmac_f32 v237, v52, v124
    s_mov_b32 m0, s69
    v_mfma_f32_32x32x16_bf16 v[16:31], v[68:71], v[184:187], 0
    buffer_load_dwordx4 v224, s[4:7], s45 offen sc1 lds
    buffer_load_dwordx4 v225, s[72:75], s45 offen offset:1024 sc1 lds
    s_waitcnt lgkmcnt(4)
    v_mad_u32_u16 v226, v226, s39, v248 op_sel:[1,0,0,0]
    v_mad_u32_u16 v227, v227, s39, v248 op_sel:[1,0,0,0]
    v_fmac_f32 v245, v60, v172
    v_fmac_f32 v237, v53, v125
    v_mfma_f32_32x32x16_bf16 v[32:47], v[64:67], v[188:191], 0
    v_add_u32 v228, s51, v251
    ds_read2_b32 v[228:229], v228 offset0:1 offset1:3
    v_fmac_f32 v245, v61, v173
    v_fmac_f32 v237, v54, v126
    v_fmac_f32 v245, v62, v174
    v_fmac_f32 v237, v55, v127
    v_fmac_f32 v245, v63, v175
    v_mfma_f32_32x32x16_bf16 v[48:63], v[68:71], v[188:191], 0
    v_permlane32_swap_b32 v242, v234
    v_permlane32_swap_b32 v243, v235
    v_add_f32 v242, v242, v234
    v_add_f32 v243, v243, v235
    s_waitcnt vmcnt(4) lgkmcnt(1)
    v_mfma_f32_32x32x16_bf16 v[0:15], v[72:75], v[176:179], v[0:15]
    ds_read_b64_tr_b16 v[184:185], v246 offset:6144
    ds_read_b64_tr_b16 v[188:189], v247 offset:6144
    s_set_gpr_idx_on s31, gpr_idx(DST)
    s_nop 0
    v_cvt_pk_bf16_f32 v194, v242, v243
    s_set_gpr_idx_off
    s_mov_b32 s32, s31
    s_mov_b32 m0, s70
    v_mfma_f32_32x32x16_bf16 v[16:31], v[76:79], v[176:179], v[16:31]
    buffer_load_dwordx4 v226, s[4:7], s46 offen sc1 lds
    buffer_load_dwordx4 v227, s[72:75], s46 offen offset:1024 sc1 lds
    s_waitcnt lgkmcnt(2)
    v_mad_u32_u16 v228, v228, s39, v248 op_sel:[1,0,0,0]
    v_mad_u32_u16 v229, v229, s39, v248 op_sel:[1,0,0,0]
    s_sub_u32 s26, s48, s29
    s_mov_b32 s29, s48
    v_mfma_f32_32x32x16_bf16 v[32:47], v[72:75], v[180:183], v[32:47]
    s_mov_b32 s30, s3
    s_bfe_u32 s56, s3, 0x40012
    s_cmp_eq_u32 s34, 0
    s_cselect_b32 s56, s56, 0
    s_mov_b32 s31, s35
    v_mfma_f32_32x32x16_bf16 v[48:63], v[76:79], v[180:183], v[48:63]
    s_waitcnt vmcnt(4) lgkmcnt(0)
    v_mfma_f32_32x32x8_bf16 v[0:15], v[80:81], v[184:185], v[0:15]
    ds_read_b64_tr_b16 v[176:177], v246 offset:0
    ds_read_b64_tr_b16 v[178:179], v246 offset:1024
    ds_read_b64_tr_b16 v[180:181], v247 offset:0
    ds_read_b64_tr_b16 v[182:183], v247 offset:1024
    s_mov_b32 m0, s71
    v_mfma_f32_32x32x8_bf16 v[16:31], v[84:85], v[184:185], v[16:31]
    buffer_load_dwordx4 v228, s[4:7], s47 offen sc1 lds
    buffer_load_dwordx4 v229, s[72:75], s47 offen offset:1024 sc1 lds
    v_mfma_f32_32x32x8_bf16 v[32:47], v[80:81], v[188:189], v[32:47]
    s_nop 2
    v_mul_f32 v242, v0, v144
    v_fma_f32 v240, v8, v160, -v240
    v_fmac_f32 v242, v1, v145
    v_fmac_f32 v240, v9, v161
    v_fmac_f32 v242, v2, v146
    v_fmac_f32 v240, v10, v162
    v_fmac_f32 v242, v3, v147
    v_mfma_f32_32x32x8_bf16 v[48:63], v[84:85], v[188:189], v[48:63]
    s_setprio 0
    v_fmac_f32 v240, v11, v163
    v_fmac_f32 v242, v4, v148
    v_fmac_f32 v240, v12, v164
    v_fmac_f32 v242, v5, v149
    v_fmac_f32 v240, v13, v165
    v_fmac_f32 v242, v6, v150
    v_fmac_f32 v240, v14, v166
    v_fmac_f32 v242, v7, v151
    v_fmac_f32 v240, v15, v167
    v_add_u32 v249, s26, v249
    v_add_u32 v250, s26, v250
    v_fma_f32 v244, v16, v160, -v244
    v_fmac_f32 v236, v24, v112
    v_fmac_f32 v244, v17, v161
    v_fmac_f32 v236, v25, v113
    v_fmac_f32 v244, v18, v162
    v_fmac_f32 v236, v26, v114
    v_fmac_f32 v244, v19, v163
    v_fmac_f32 v236, v27, v115
    v_fmac_f32 v244, v20, v164
    v_fmac_f32 v236, v28, v116
    v_fmac_f32 v244, v21, v165
    v_fmac_f32 v236, v29, v117
    v_fmac_f32 v244, v22, v166
    v_fmac_f32 v236, v30, v118
    v_fmac_f32 v244, v23, v167
    v_fmac_f32 v236, v31, v119
    ds_read_b64_tr_b16 v[0:1], v249 offset:0
    ds_read_b64_tr_b16 v[2:3], v249 offset:32
    ds_read_u16_d16_hi v16, v250 offset:0
    v_mul_f32 v243, v32, v152
    v_fma_f32 v241, v40, v168, -v241
    v_fmac_f32 v243, v33, v153
    v_fmac_f32 v241, v41, v169
    v_fmac_f32 v243, v34, v154
    v_fmac_f32 v241, v42, v170
    v_fmac_f32 v243, v35, v155
    v_fmac_f32 v241, v43, v171
    v_fmac_f32 v243, v36, v156
    v_fmac_f32 v241, v44, v172
    v_fmac_f32 v243, v37, v157
    v_fmac_f32 v241, v45, v173
    v_fmac_f32 v243, v38, v158
    v_fmac_f32 v241, v46, v174
    v_fmac_f32 v243, v39, v159
    v_fmac_f32 v241, v47, v175
    ds_read_b64_tr_b16 v[4:5], v249 offset:512
    ds_read_b64_tr_b16 v[6:7], v249 offset:544
    ds_read_u16_d16_hi v17, v250 offset:128
    v_fma_f32 v245, v48, v168, -v245
    v_fmac_f32 v237, v56, v120
    v_fmac_f32 v245, v49, v169
    v_fmac_f32 v237, v57, v121
    v_fmac_f32 v245, v50, v170
    v_fmac_f32 v237, v58, v122
    v_fmac_f32 v245, v51, v171
    v_fmac_f32 v237, v59, v123
    v_fmac_f32 v245, v52, v172
    v_fmac_f32 v237, v60, v124
    v_fmac_f32 v245, v53, v173
    v_fmac_f32 v237, v61, v125
    v_fmac_f32 v245, v54, v174
    v_fmac_f32 v237, v62, v126
    v_fmac_f32 v245, v55, v175
    v_fmac_f32 v237, v63, v127
    s_cmp_eq_u32 s56, 5
    s_cbranch_scc1 K2_U20
    s_cmp_eq_u32 s56, 6
    s_cbranch_scc1 K2_U3h0
    s_branch K2_DSP0
K2_U30:
    s_setprio 1
    ds_read_b64_tr_b16 v[8:9], v249 offset:1024
    ds_read_b64_tr_b16 v[10:11], v249 offset:1056
    ds_read_u16_d16_hi v18, v250 offset:256
    s_waitcnt lgkmcnt(3)
    v_lshlrev_b32 v20, 16, v0
    v_and_b32 v21, 0xffff0000, v0
    v_lshlrev_b32 v22, 16, v1
    v_and_b32 v23, 0xffff0000, v1
    v_lshlrev_b32 v24, 16, v2
    v_and_b32 v25, 0xffff0000, v2
    v_lshlrev_b32 v26, 16, v3
    v_and_b32 v27, 0xffff0000, v3
    v_mul_f32_dpp v36, v16, v20 row_newbcast:8 row_mask:0xf bank_mask:0xf
    v_mul_f32_dpp v37, v16, v21 row_newbcast:9 row_mask:0xf bank_mask:0xf
    v_mul_f32_dpp v38, v16, v22 row_newbcast:10 row_mask:0xf bank_mask:0xf
    v_mul_f32_dpp v39, v16, v23 row_newbcast:11 row_mask:0xf bank_mask:0xf
    v_mul_f32_dpp v40, v16, v24 row_newbcast:12 row_mask:0xf bank_mask:0xf
    v_mul_f32_dpp v41, v16, v25 row_newbcast:13 row_mask:0xf bank_mask:0xf
    v_mul_f32_dpp v42, v16, v26 row_newbcast:14 row_mask:0xf bank_mask:0xf
    v_mul_f32_dpp v43, v16, v27 row_newbcast:15 row_mask:0xf bank_mask:0xf
    v_cvt_pk_bf16_f32 v68, v36, v37
    v_cvt_pk_bf16_f32 v69, v38, v39
    v_cvt_pk_bf16_f32 v70, v40, v41
    v_cvt_pk_bf16_f32 v71, v42, v43
    v_mul_f32_dpp v20, v16, v20 row_newbcast:0 row_mask:0xa bank_mask:0xf
    v_mul_f32_dpp v21, v16, v21 row_newbcast:1 row_mask:0xa bank_mask:0xf
    v_mul_f32_dpp v22, v16, v22 row_newbcast:2 row_mask:0xa bank_mask:0xf
    v_mul_f32_dpp v23, v16, v23 row_newbcast:3 row_mask:0xa bank_mask:0xf
    v_mul_f32_dpp v24, v16, v24 row_newbcast:4 row_mask:0xa bank_mask:0xf
    v_mul_f32_dpp v25, v16, v25 row_newbcast:5 row_mask:0xa bank_mask:0xf
    v_mul_f32_dpp v26, v16, v26 row_newbcast:6 row_mask:0xa bank_mask:0xf
    v_mul_f32_dpp v27, v16, v27 row_newbcast:7 row_mask:0xa bank_mask:0xf
    v_cvt_pk_bf16_f32 v64, v20, v21
    v_cvt_pk_bf16_f32 v65, v22, v23
    v_cvt_pk_bf16_f32 v66, v24, v25
    v_cvt_pk_bf16_f32 v67, v26, v27
    v_lshlrev_b32 v28, 16, v4
    v_and_b32 v29, 0xffff0000, v4
    v_lshlrev_b32 v30, 16, v5
    v_and_b32 v31, 0xffff0000, v5
    v_lshlrev_b32 v32, 16, v6
    v_and_b32 v33, 0xffff0000, v6
    v_lshlrev_b32 v34, 16, v7
    v_and_b32 v35, 0xffff0000, v7
    v_mul_f32_dpp v36, v17, v28 row_newbcast:8 row_mask:0xf bank_mask:0xf
    v_mul_f32_dpp v37, v17, v29 row_newbcast:9 row_mask:0xf bank_mask:0xf
    v_mul_f32_dpp v38, v17, v30 row_newbcast:10 row_mask:0xf bank_mask:0xf
    v_mul_f32_dpp v39, v17, v31 row_newbcast:11 row_mask:0xf bank_mask:0xf
    v_mul_f32_dpp v40, v17, v32 row_newbcast:12 row_mask:0xf bank_mask:0xf
    v_mul_f32_dpp v41, v17, v33 row_newbcast:13 row_mask:0xf bank_mask:0xf
    v_mul_f32_dpp v42, v17, v34 row_newbcast:14 row_mask:0xf bank_mask:0xf
    v_mul_f32_dpp v43, v17, v35 row_newbcast:15 row_mask:0xf bank_mask:0xf
    v_cvt_pk_bf16_f32 v76, v36, v37
    v_cvt_pk_bf16_f32 v77, v38, v39
    v_cvt_pk_bf16_f32 v78, v40, v41
    v_cvt_pk_bf16_f32 v79, v42, v43
    v_mul_f32_dpp v28, v17, v28 row_newbcast:0 row_mask:0xa bank_mask:0xf
    v_mul_f32_dpp v29, v17, v29 row_newbcast:1 row_mask:0xa bank_mask:0xf
    v_mul_f32_dpp v30, v17, v30 row_newbcast:2 row_mask:0xa bank_mask:0xf
    v_mul_f32_dpp v31, v17, v31 row_newbcast:3 row_mask:0xa bank_mask:0xf
    v_mul_f32_dpp v32, v17, v32 row_newbcast:4 row_mask:0xa bank_mask:0xf
    v_mul_f32_dpp v33, v17, v33 row_newbcast:5 row_mask:0xa bank_mask:0xf
    v_mul_f32_dpp v34, v17, v34 row_newbcast:6 row_mask:0xa bank_mask:0xf
    v_mul_f32_dpp v35, v17, v35 row_newbcast:7 row_mask:0xa bank_mask:0xf
    v_cvt_pk_bf16_f32 v72, v28, v29
    v_cvt_pk_bf16_f32 v73, v30, v31
    v_cvt_pk_bf16_f32 v74, v32, v33
    v_cvt_pk_bf16_f32 v75, v34, v35
    s_waitcnt lgkmcnt(0)
    v_lshlrev_b32 v20, 16, v8
    v_and_b32 v21, 0xffff0000, v8
    v_lshlrev_b32 v22, 16, v9
    v_and_b32 v23, 0xffff0000, v9
    v_lshlrev_b32 v24, 16, v10
    v_and_b32 v25, 0xffff0000, v10
    v_lshlrev_b32 v26, 16, v11
    v_and_b32 v27, 0xffff0000, v11
    v_mul_f32_dpp v36, v18, v20 row_newbcast:8 row_mask:0xf bank_mask:0xf
    v_mul_f32_dpp v37, v18, v21 row_newbcast:9 row_mask:0xf bank_mask:0xf
    v_mul_f32_dpp v38, v18, v22 row_newbcast:10 row_mask:0xf bank_mask:0xf
    v_mul_f32_dpp v39, v18, v23 row_newbcast:11 row_mask:0xf bank_mask:0xf
    v_mul_f32_dpp v40, v18, v24 row_newbcast:12 row_mask:0xf bank_mask:0xf
    v_mul_f32_dpp v41, v18, v25 row_newbcast:13 row_mask:0xf bank_mask:0xf
    v_mul_f32_dpp v42, v18, v26 row_newbcast:14 row_mask:0xf bank_mask:0xf
    v_mul_f32_dpp v43, v18, v27 row_newbcast:15 row_mask:0xf bank_mask:0xf
    v_cvt_pk_bf16_f32 v84, v36, v37
    v_cvt_pk_bf16_f32 v85, v38, v39
    v_cvt_pk_bf16_f32 v86, v40, v41
    v_cvt_pk_bf16_f32 v87, v42, v43
    v_mul_f32_dpp v20, v18, v20 row_newbcast:0 row_mask:0xa bank_mask:0xf
    v_mul_f32_dpp v21, v18, v21 row_newbcast:1 row_mask:0xa bank_mask:0xf
    v_mul_f32_dpp v22, v18, v22 row_newbcast:2 row_mask:0xa bank_mask:0xf
    v_mul_f32_dpp v23, v18, v23 row_newbcast:3 row_mask:0xa bank_mask:0xf
    v_mul_f32_dpp v24, v18, v24 row_newbcast:4 row_mask:0xa bank_mask:0xf
    v_mul_f32_dpp v25, v18, v25 row_newbcast:5 row_mask:0xa bank_mask:0xf
    v_mul_f32_dpp v26, v18, v26 row_newbcast:6 row_mask:0xa bank_mask:0xf
    v_mul_f32_dpp v27, v18, v27 row_newbcast:7 row_mask:0xa bank_mask:0xf
    v_cvt_pk_bf16_f32 v80, v20, v21
    v_cvt_pk_bf16_f32 v81, v22, v23
    v_cvt_pk_bf16_f32 v82, v24, v25
    v_cvt_pk_bf16_f32 v83, v26, v27
    s_waitcnt vmcnt(4)
    v_mfma_f32_32x32x16_bf16 v[0:15], v[64:67], v[176:179], 0
    ds_read_b64_tr_b16 v[184:185], v246 offset:2048
    ds_read_b64_tr_b16 v[186:187], v246 offset:3072
    ds_read_b64_tr_b16 v[188:189], v247 offset:2048
    ds_read_b64_tr_b16 v[190:191], v247 offset:3072
    s_mov_b32 m0, s68
    v_mfma_f32_32x32x16_bf16 v[16:31], v[68:71], v[176:179], 0
    buffer_load_dwordx4 v224, s[4:7], s41 offen sc1 lds
    buffer_load_dwordx4 v225, s[72:75], s41 offen offset:1024 sc1 lds
    v_permlane32_swap_b32 v242, v236
    v_permlane32_swap_b32 v243, v237
    s_add_u32 s38, s38, 1
    v_mfma_f32_32x32x16_bf16 v[32:47], v[64:67], v[180:183], 0
    v_permlane32_swap_b32 v244, v238
    v_permlane32_swap_b32 v245, v239
    v_permlane32_swap_b32 v240, v241
    v_add_f32 v242, v242, v236
    v_mfma_f32_32x32x16_bf16 v[48:63], v[68:71], v[180:183], 0
    v_add_f32 v243, v243, v237
    v_add_f32 v244, v244, v238
    v_add_f32 v245, v245, v239
    v_add_f32 v240, -v240, -v241
    v_mov_b32 v254, s52
    v_mov_b32 v255, s38
    s_waitcnt vmcnt(4) lgkmcnt(0)
    v_mfma_f32_32x32x16_bf16 v[0:15], v[72:75], v[184:187], v[0:15]
    ds_read_b64_tr_b16 v[176:177], v246 offset:4096
    ds_read_b64_tr_b16 v[178:179], v246 offset:5120
    ds_read_b64_tr_b16 v[180:181], v247 offset:4096
    ds_read_b64_tr_b16 v[182:183], v247 offset:5120
    s_lshl_b32 s58, s38, 3
    s_add_u32 s58, s58, s20
    s_mov_b32 m0, s69
    v_mfma_f32_32x32x16_bf16 v[16:31], v[76:79], v[184:187], v[16:31]
    buffer_load_dwordx4 v226, s[4:7], s41 offen sc1 lds
    buffer_load_dwordx4 v227, s[72:75], s41 offen offset:1024 sc1 lds
    s_set_gpr_idx_on s32, gpr_idx(DST)
    s_nop 0
    v_cvt_pk_bf16_f32 v195, v242, v243
    v_cvt_pk_bf16_f32 v196, v244, v245
    v_cvt_pk_bf16_f32 v197, v240, v240
    s_set_gpr_idx_off
    s_mov_b64 exec, 1
    ds_write_b32 v254, v255
    s_mov_b64 exec, -1
    s_cmp_lt_u32 s58, s22
    s_cbranch_scc0 K2_dyn_34
K2_back_35:
    v_readlane_b32 s3, v253, s58
    s_lshl_b32 s44, s34, 7
    s_and_b32 s48, s3, 0x3ffff
    s_bfe_u32 s33, s3, 0x30013
    s_mul_i32 s35, s38, 6
    s_cmp_eq_u32 s34, 0
    s_cselect_b32 s35, s35, s48
    s_mov_b32 s45, s44
    s_xor_b32 s47, s44, 256
    s_add_u32 s49, s48, 128
    s_add_u32 s60, s48, 256
    s_cmp_eq_u32 s33, 3
    s_cselect_b32 s46, s44, s47
    s_cselect_b32 s50, s60, s48
    s_cselect_b32 s51, s48, s49
    s_sub_u32 s60, s33, 2
    s_cmp_lt_u32 s60, 2
    s_cbranch_scc0 K2_rare_40
K2_back_41:
    v_mfma_f32_32x32x16_bf16 v[32:47], v[72:75], v[188:191], v[32:47]
    v_add_u32 v233, s48, v230
    ds_read_b32 v232, v233
    ds_read_b32 v233, v233 offset:1024
    v_mfma_f32_32x32x16_bf16 v[48:63], v[76:79], v[188:191], v[48:63]
    s_waitcnt vmcnt(4) lgkmcnt(3)
    v_mfma_f32_32x32x16_bf16 v[0:15], v[80:83], v[176:179], v[0:15]
    ds_read_b64_tr_b16 v[184:185], v246 offset:6144
    ds_read_b64_tr_b16 v[186:187], v246 offset:7168
    ds_read_b64_tr_b16 v[188:189], v247 offset:6144
    ds_read_b64_tr_b16 v[190:191], v247 offset:7168
    s_mov_b32 m0, s70
    v_mfma_f32_32x32x16_bf16 v[16:31], v[84:87], v[176:179], v[16:31]
    buffer_load_dwordx4 v222, s[4:7], s42 offen sc1 lds
    buffer_load_dwordx4 v223, s[72:75], s42 offen offset:1024 sc1 lds
    v_mfma_f32_32x32x16_bf16 v[32:47], v[80:83], v[180:183], v[32:47]
    s_nop 2
    v_mul_f32 v234, v0, v96
    v_mul_f32 v236, v8, v128
    v_fmac_f32 v234, v1, v97
    v_fmac_f32 v236, v9, v129
    v_fmac_f32 v234, v2, v98
    v_fmac_f32 v236, v10, v130
    v_fmac_f32 v234, v3, v99
    v_mfma_f32_32x32x16_bf16 v[48:63], v[84:87], v[180:183], v[48:63]
    s_setprio 0
    s_waitcnt lgkmcnt(4)
    v_or_b32 v232, v232, v231
    v_or_b32 v233, v233, v231
    s_cmp_lg_u32 s34, 0
    s_cbranch_scc1 K2_dum_43
    s_cmp_eq_u32 s33, 4
    s_cbranch_scc1 K2_a4_44
K2_b4_46:
    s_add_u32 m0, s48, 512
    s_add_u32 s65, s48, 1536
    buffer_load_dwordx4 v232, s[16:19], 0 offen  lds
    s_mov_b32 m0, s65
    s_mov_b32 exec_hi, 0
    buffer_load_dwordx4 v233, s[16:19], 0 offen  lds
    s_mov_b32 exec_hi, -1
K2_back_45:
    v_fmac_f32 v236, v11, v131
    v_fmac_f32 v234, v4, v100
    v_fmac_f32 v236, v12, v132
    v_fmac_f32 v234, v5, v101
    v_fmac_f32 v236, v13, v133
    v_fmac_f32 v234, v6, v102
    v_fmac_f32 v236, v14, v134
    v_fmac_f32 v234, v7, v103
    v_fmac_f32 v236, v15, v135
    v_mul_f32 v238, v16, v128
    v_mul_f32 v240, v24, v128
    v_fmac_f32 v238, v17, v129
    v_fmac_f32 v240, v25, v129
    v_fmac_f32 v238, v18, v130
    v_fmac_f32 v240, v26, v130
    v_fmac_f32 v238, v19, v131
    v_fmac_f32 v240, v27, v131
    v_fmac_f32 v238, v20, v132
    v_fmac_f32 v240, v28, v132
    v_fmac_f32 v238, v21, v133
    v_fmac_f32 v240, v29, v133
    v_fmac_f32 v238, v22, v134
    v_fmac_f32 v240, v30, v134
    v_fmac_f32 v238, v23, v135
    v_fmac_f32 v240, v31, v135
    v_mul_f32 v235, v32, v104
    v_mul_f32 v237, v40, v136
    v_fmac_f32 v235, v33, v105
    v_fmac_f32 v237, v41, v137
    v_fmac_f32 v235, v34, v106
    v_fmac_f32 v237, v42, v138
    v_fmac_f32 v235, v35, v107
    v_fmac_f32 v237, v43, v139
    v_fmac_f32 v235, v36, v108
    v_fmac_f32 v237, v44, v140
    v_fmac_f32 v235, v37, v109
    v_fmac_f32 v237, v45, v141
    v_fmac_f32 v235, v38, v110
    v_fmac_f32 v237, v46, v142
    v_fmac_f32 v235, v39, v111
    v_fmac_f32 v237, v47, v143
    v_mul_f32 v239, v48, v136
    v_mul_f32 v241, v56, v136
    s_setprio 1
    s_waitcnt vmcnt(6) lgkmcnt(0)
    v_mfma_f32_32x32x16_bf16 v[0:15], v[64:67], v[184:187], 0
    ds_read_b64_tr_b16 v[176:177], v246 offset:0
    ds_read_b64_tr_b16 v[178:179], v246 offset:1024
    ds_read_b64_tr_b16 v[180:181], v247 offset:0
    ds_read_b64_tr_b16 v[182:183], v247 offset:1024
    v_fmac_f32 v239, v49, v137
    v_fmac_f32 v241, v57, v137
    s_mov_b32 m0, s71
    v_mfma_f32_32x32x16_bf16 v[16:31], v[68:71], v[184:187], 0
    buffer_load_dwordx4 v224, s[4:7], s42 offen sc1 lds
    buffer_load_dwordx4 v225, s[72:75], s42 offen offset:1024 sc1 lds
    v_fmac_f32 v239, v50, v138
    v_fmac_f32 v241, v58, v138
    v_fmac_f32 v239, v51, v139
    v_fmac_f32 v241, v59, v139
    v_fmac_f32 v239, v52, v140
    v_mfma_f32_32x32x16_bf16 v[32:47], v[64:67], v[188:191], 0
    v_fmac_f32 v241, v60, v140
    v_fmac_f32 v239, v53, v141
    v_fmac_f32 v241, v61, v141
    v_fmac_f32 v239, v54, v142
    v_fmac_f32 v241, v62, v142
    v_fmac_f32 v239, v55, v143
    v_fmac_f32 v241, v63, v143
    v_mfma_f32_32x32x16_bf16 v[48:63], v[68:71], v[188:191], 0
    v_permlane32_swap_b32 v234, v236
    v_permlane32_swap_b32 v235, v237
    v_permlane32_swap_b32 v240, v238
    s_waitcnt vmcnt(6) lgkmcnt(0)
    v_mfma_f32_32x32x16_bf16 v[0:15], v[72:75], v[176:179], v[0:15]
    ds_read_b64_tr_b16 v[184:185], v246 offset:2048
    ds_read_b64_tr_b16 v[186:187], v246 offset:3072
    ds_read_b64_tr_b16 v[188:189], v247 offset:2048
    ds_read_b64_tr_b16 v[190:191], v247 offset:3072
    v_permlane32_swap_b32 v241, v239
    s_mov_b32 m0, s68
    v_mfma_f32_32x32x16_bf16 v[16:31], v[76:79], v[176:179], v[16:31]
    buffer_load_dwordx4 v226, s[4:7], s42 offen sc1 lds
    buffer_load_dwordx4 v227, s[72:75], s42 offen offset:1024 sc1 lds
    v_add_f32 v234, v234, v236
    v_add_f32 v235, v235, v237
    v_add_f32 v240, v240, v238
    v_add_f32 v241, v241, v239
    v_mfma_f32_32x32x16_bf16 v[32:47], v[72:75], v[180:183], v[32:47]
    s_set_gpr_idx_on s31, gpr_idx(DST)
    s_nop 0
    v_cvt_pk_bf16_f32 v192, v234, v235
    v_cvt_pk_bf16_f32 v193, v240, v241
    s_set_gpr_idx_off
    v_mfma_f32_32x32x16_bf16 v[48:63], v[76:79], v[180:183], v[48:63]
    s_waitcnt vmcnt(6) lgkmcnt(0)
    v_mfma_f32_32x32x16_bf16 v[0:15], v[80:83], v[184:187], v[0:15]
    ds_read_b64_tr_b16 v[176:177], v246 offset:4096
    ds_read_b64_tr_b16 v[178:179], v246 offset:5120
    ds_read_b64_tr_b16 v[180:181], v247 offset:4096
    ds_read_b64_tr_b16 v[182:183], v247 offset:5120
    s_mov_b32 m0, s69
    v_mfma_f32_32x32x16_bf16 v[16:31], v[84:87], v[184:187], v[16:31]
    buffer_load_dwordx4 v222, s[4:7], s43 offen sc1 lds
    buffer_load_dwordx4 v223, s[72:75], s43 offen offset:1024 sc1 lds
    v_mfma_f32_32x32x16_bf16 v[32:47], v[80:83], v[188:191], v[32:47]
    s_nop 2
    v_mul_f32 v234, v0, v144
    v_mul_f32 v236, v8, v112
    v_fmac_f32 v234, v1, v145
    v_fmac_f32 v236, v9, v113
    v_fmac_f32 v234, v2, v146
    v_fmac_f32 v236, v10, v114
    v_fmac_f32 v234, v3, v147
    v_mfma_f32_32x32x16_bf16 v[48:63], v[84:87], v[188:191], v[48:63]
    s_setprio 0
    v_fmac_f32 v236, v11, v115
    v_fmac_f32 v234, v4, v148
    v_fmac_f32 v236, v12, v116
    v_fmac_f32 v234, v5, v149
    v_fmac_f32 v236, v13, v117
    v_fmac_f32 v234, v6, v150
    v_fmac_f32 v236, v14, v118
    v_fmac_f32 v234, v7, v151
    v_fmac_f32 v236, v15, v119
    v_mul_f32 v238, v16, v160
    v_mul_f32 v240, v24, v160
    v_fmac_f32 v238, v17, v161
    v_fmac_f32 v240, v25, v161
    v_fmac_f32 v238, v18, v162
    v_fmac_f32 v240, v26, v162
    v_fmac_f32 v238, v19, v163
    v_fmac_f32 v240, v27, v163
    v_fmac_f32 v238, v20, v164
    v_fmac_f32 v240, v28, v164
    v_fmac_f32 v238, v21, v165
    v_fmac_f32 v240, v29, v165
    v_fmac_f32 v238, v22, v166
    v_fmac_f32 v240, v30, v166
    v_fmac_f32 v238, v23, v167
    v_fmac_f32 v240, v31, v167
    v_mul_f32 v235, v32, v152
    v_mul_f32 v237, v40, v120
    v_fmac_f32 v235, v33, v153
    v_fmac_f32 v237, v41, v121
    v_fmac_f32 v235, v34, v154
    v_fmac_f32 v237, v42, v122
    v_fmac_f32 v235, v35, v155
    v_fmac_f32 v237, v43, v123
    v_fmac_f32 v235, v36, v156
    v_fmac_f32 v237, v44, v124
    v_fmac_f32 v235, v37, v157
    v_fmac_f32 v237, v45, v125
    v_fmac_f32 v235, v38, v158
    v_fmac_f32 v237, v46, v126
    v_fmac_f32 v235, v39, v159
    v_fmac_f32 v237, v47, v127
    v_mul_f32 v239, v48, v168
    v_mul_f32 v241, v56, v168
    v_fmac_f32 v239, v49, v169
    v_fmac_f32 v241, v57, v169
    s_setprio 1
    s_waitcnt vmcnt(4) lgkmcnt(0)
    v_mfma_f32_32x32x16_bf16 v[0:15], v[64:67], v[176:179], 0
    ds_read_b64_tr_b16 v[184:185], v246 offset:6144
    ds_read_b64_tr_b16 v[186:187], v246 offset:7168
    ds_read_b64_tr_b16 v[188:189], v247 offset:6144
    ds_read_b64_tr_b16 v[190:191], v247 offset:7168
    v_fmac_f32 v239, v50, v170
    v_fmac_f32 v241, v58, v170
    s_mov_b32 m0, s70
    v_mfma_f32_32x32x16_bf16 v[16:31], v[68:71], v[176:179], 0
    buffer_load_dwordx4 v224, s[4:7], s43 offen sc1 lds
    buffer_load_dwordx4 v225, s[72:75], s43 offen offset:1024 sc1 lds
    v_fmac_f32 v239, v51, v171
    v_fmac_f32 v241, v59, v171
    v_fmac_f32 v239, v52, v172
    v_fmac_f32 v241, v60, v172
    v_fmac_f32 v239, v53, v173
    v_mfma_f32_32x32x16_bf16 v[32:47], v[64:67], v[180:183], 0
    v_add_u32 v222, s48, v251
    ds_read2_b32 v[222:223], v222 offset0:1 offset1:3
    v_fmac_f32 v241, v61, v173
    v_fmac_f32 v239, v54, v174
    v_fmac_f32 v241, v62, v174
    v_fmac_f32 v239, v55, v175
    v_fmac_f32 v241, v63, v175
    v_mfma_f32_32x32x16_bf16 v[48:63], v[68:71], v[180:183], 0
    s_waitcnt vmcnt(4) lgkmcnt(1)
    v_mfma_f32_32x32x16_bf16 v[0:15], v[72:75], v[184:187], v[0:15]
    ds_read_b64_tr_b16 v[176:177], v246 offset:0
    ds_read_b64_tr_b16 v[178:179], v246 offset:1024
    ds_read_b64_tr_b16 v[180:181], v247 offset:0
    ds_read_b64_tr_b16 v[182:183], v247 offset:1024
    s_mov_b32 m0, s71
    v_mfma_f32_32x32x16_bf16 v[16:31], v[76:79], v[184:187], v[16:31]
    buffer_load_dwordx4 v226, s[4:7], s43 offen sc1 lds
    buffer_load_dwordx4 v227, s[72:75], s43 offen offset:1024 sc1 lds
    s_waitcnt lgkmcnt(4)
    v_mad_u32_u16 v222, v222, s39, v248 op_sel:[1,0,0,0]
    v_mad_u32_u16 v223, v223, s39, v248 op_sel:[1,0,0,0]
    v_mfma_f32_32x32x16_bf16 v[32:47], v[72:75], v[188:191], v[32:47]
    v_add_u32 v224, s49, v251
    ds_read2_b32 v[224:225], v224 offset0:1 offset1:3
    v_mfma_f32_32x32x16_bf16 v[48:63], v[76:79], v[188:191], v[48:63]
    s_waitcnt vmcnt(4) lgkmcnt(1)
    v_mfma_f32_32x32x16_bf16 v[0:15], v[80:83], v[176:179], v[0:15]
    ds_read_b64_tr_b16 v[184:185], v246 offset:2048
    ds_read_b64_tr_b16 v[186:187], v246 offset:3072
    ds_read_b64_tr_b16 v[188:189], v247 offset:2048
    ds_read_b64_tr_b16 v[190:191], v247 offset:3072
    s_mov_b32 m0, s68
    v_mfma_f32_32x32x16_bf16 v[16:31], v[84:87], v[176:179], v[16:31]
    buffer_load_dwordx4 v222, s[4:7], s44 offen sc1 lds
    buffer_load_dwordx4 v223, s[72:75], s44 offen offset:1024 sc1 lds
    s_waitcnt lgkmcnt(4)
    v_mad_u32_u16 v224, v224, s39, v248 op_sel:[1,0,0,0]
    v_mad_u32_u16 v225, v225, s39, v248 op_sel:[1,0,0,0]
    v_mfma_f32_32x32x16_bf16 v[32:47], v[80:83], v[180:183], v[32:47]
    v_add_u32 v226, s50, v251
    ds_read2_b32 v[226:227], v226 offset0:1 offset1:3
    v_mul_f32 v242, v0, v144
    v_fma_f32 v238, v8, v160, -v238
    v_fmac_f32 v242, v1, v145
    v_fmac_f32 v238, v9, v161
    v_fmac_f32 v242, v2, v146
    v_mfma_f32_32x32x16_bf16 v[48:63], v[84:87], v[180:183], v[48:63]
    s_setprio 0
    v_fmac_f32 v238, v10, v162
    v_fmac_f32 v242, v3, v147
    v_fmac_f32 v238, v11, v163
    v_fmac_f32 v242, v4, v148
    v_fmac_f32 v238, v12, v164
    v_fmac_f32 v242, v5, v149
    v_fmac_f32 v238, v13, v165
    v_fmac_f32 v242, v6, v150
    v_fmac_f32 v238, v14, v166
    v_fmac_f32 v242, v7, v151
    v_fmac_f32 v238, v15, v167
    v_fmac_f32 v236, v16, v112
    v_mul_f32 v244, v24, v160
    v_fmac_f32 v236, v17, v113
    v_fmac_f32 v244, v25, v161
    v_fmac_f32 v236, v18, v114
    v_fmac_f32 v244, v26, v162
    v_fmac_f32 v236, v19, v115
    v_fmac_f32 v244, v27, v163
    v_fmac_f32 v236, v20, v116
    v_fmac_f32 v244, v28, v164
    v_fmac_f32 v236, v21, v117
    v_fmac_f32 v244, v29, v165
    v_fmac_f32 v236, v22, v118
    v_fmac_f32 v244, v30, v166
    v_fmac_f32 v236, v23, v119
    v_fmac_f32 v244, v31, v167
    v_mul_f32 v243, v32, v152
    v_fma_f32 v239, v40, v168, -v239
    v_fmac_f32 v243, v33, v153
    v_fmac_f32 v239, v41, v169
    v_fmac_f32 v243, v34, v154
    v_fmac_f32 v239, v42, v170
    v_fmac_f32 v243, v35, v155
    v_fmac_f32 v239, v43, v171
    v_fmac_f32 v243, v36, v156
    v_fmac_f32 v239, v44, v172
    v_fmac_f32 v243, v37, v157
    v_fmac_f32 v239, v45, v173
    v_fmac_f32 v243, v38, v158
    v_fmac_f32 v239, v46, v174
    v_fmac_f32 v243, v39, v159
    v_fmac_f32 v239, v47, v175
    v_fmac_f32 v237, v48, v120
    v_mul_f32 v245, v56, v168
    v_fmac_f32 v237, v49, v121
    v_fmac_f32 v245, v57, v169
    v_fmac_f32 v237, v50, v122
    v_fmac_f32 v245, v58, v170
    v_fmac_f32 v237, v51, v123
    s_setprio 1
    s_waitcnt vmcnt(4) lgkmcnt(1)
    v_mfma_f32_32x32x16_bf16 v[0:15], v[64:67], v[184:187], 0
    ds_read_b64_tr_b16 v[176:177], v246 offset:4096
    ds_read_b64_tr_b16 v[178:179], v246 offset:5120
    ds_read_b64_tr_b16 v[180:181], v247 offset:4096
    ds_read_b64_tr_b16 v[182:183], v247 offset:5120
    v_fmac_f32 v245, v59, v171
    v_fmac_f32 v237, v52, v124
    s_mov_b32 m0, s69
    v_mfma_f32_32x32x16_bf16 v[16:31], v[68:71], v[184:187], 0
    buffer_load_dwordx4 v224, s[4:7], s45 offen sc1 lds
    buffer_load_dwordx4 v225, s[72:75], s45 offen offset:1024 sc1 lds
    s_waitcnt lgkmcnt(4)
    v_mad_u32_u16 v226, v226, s39, v248 op_sel:[1,0,0,0]
    v_mad_u32_u16 v227, v227, s39, v248 op_sel:[1,0,0,0]
    v_fmac_f32 v245, v60, v172
    v_fmac_f32 v237, v53, v125
    v_mfma_f32_32x32x16_bf16 v[32:47], v[64:67], v[188:191], 0
    v_add_u32 v228, s51, v251
    ds_read2_b32 v[228:229], v228 offset0:1 offset1:3
    v_fmac_f32 v245, v61, v173
    v_fmac_f32 v237, v54, v126
    v_fmac_f32 v245, v62, v174
    v_fmac_f32 v237, v55, v127
    v_fmac_f32 v245, v63, v175
    v_mfma_f32_32x32x16_bf16 v[48:63], v[68:71], v[188:191], 0
    v_permlane32_swap_b32 v242, v234
    v_permlane32_swap_b32 v243, v235
    v_add_f32 v242, v242, v234
    v_add_f32 v243, v243, v235
    s_waitcnt vmcnt(4) lgkmcnt(1)
    v_mfma_f32_32x32x16_bf16 v[0:15], v[72:75], v[176:179], v[0:15]
    ds_read_b64_tr_b16 v[184:185], v246 offset:6144
    ds_read_b64_tr_b16 v[186:187], v246 offset:7168
    ds_read_b64_tr_b16 v[188:189], v247 offset:6144
    ds_read_b64_tr_b16 v[190:191], v247 offset:7168
    s_mov_b32 m0, s70
    v_mfma_f32_32x32x16_bf16 v[16:31], v[76:79], v[176:179], v[16:31]
    buffer_load_dwordx4 v226, s[4:7], s46 offen sc1 lds
    buffer_load_dwordx4 v227, s[72:75], s46 offen offset:1024 sc1 lds
    s_waitcnt lgkmcnt(4)
    v_mad_u32_u16 v228, v228, s39, v248 op_sel:[1,0,0,0]
    v_mad_u32_u16 v229, v229, s39, v248 op_sel:[1,0,0,0]
    s_sub_u32 s26, s48, s29
    s_mov_b32 s29, s48
    v_mfma_f32_32x32x16_bf16 v[32:47], v[72:75], v[180:183], v[32:47]
    s_set_gpr_idx_on s31, gpr_idx(DST)
    s_nop 0
    v_cvt_pk_bf16_f32 v194, v242, v243
    s_set_gpr_idx_off
    s_mov_b32 s30, s3
    s_bfe_u32 s56, s3, 0x40012
    s_cmp_eq_u32 s34, 0
    s_cselect_b32 s56, s56, 0
    v_mfma_f32_32x32x16_bf16 v[48:63], v[76:79], v[180:183], v[48:63]
    s_mov_b32 s32, s31
    s_mov_b32 s31, s35
    s_waitcnt vmcnt(4) lgkmcnt(0)
    v_mfma_f32_32x32x16_bf16 v[0:15], v[80:83], v[184:187], v[0:15]
    ds_read_b64_tr_b16 v[176:177], v246 offset:0
    ds_read_b64_tr_b16 v[178:179], v246 offset:1024
    ds_read_b64_tr_b16 v[180:181], v247 offset:0
    ds_read_b64_tr_b16 v[182:183], v247 offset:1024
    s_mov_b32 m0, s71
    v_mfma_f32_32x32x16_bf16 v[16:31], v[84:87], v[184:187], v[16:31]
    buffer_load_dwordx4 v228, s[4:7], s47 offen sc1 lds
    buffer_load_dwordx4 v229, s[72:75], s47 offen offset:1024 sc1 lds
    v_mfma_f32_32x32x16_bf16 v[32:47], v[80:83], v[188:191], v[32:47]
    s_nop 2
    v_mul_f32 v242, v0, v144
    v_fma_f32 v240, v8, v160, -v240
    v_fmac_f32 v242, v1, v145
    v_fmac_f32 v240, v9, v161
    v_fmac_f32 v242, v2, v146
    v_fmac_f32 v240, v10, v162
    v_fmac_f32 v242, v3, v147
    v_mfma_f32_32x32x16_bf16 v[48:63], v[84:87], v[188:191], v[48:63]
    s_setprio 0
    v_fmac_f32 v240, v11, v163
    v_fmac_f32 v242, v4, v148
    v_fmac_f32 v240, v12, v164
    v_fmac_f32 v242, v5, v149
    v_fmac_f32 v240, v13, v165
    v_fmac_f32 v242, v6, v150
    v_fmac_f32 v240, v14, v166
    v_fmac_f32 v242, v7, v151
    v_fmac_f32 v240, v15, v167
    v_add_u32 v249, s26, v249
    v_add_u32 v250, s26, v250
    v_fma_f32 v244, v16, v160, -v244
    v_fmac_f32 v236, v24, v112
    v_fmac_f32 v244, v17, v161
    v_fmac_f32 v236, v25, v113
    v_fmac_f32 v244, v18, v162
    v_fmac_f32 v236, v26, v114
    v_fmac_f32 v244, v19, v163
    v_fmac_f32 v236, v27, v115
    v_fmac_f32 v244, v20, v164
    v_fmac_f32 v236, v28, v116
    v_fmac_f32 v244, v21, v165
    v_fmac_f32 v236, v29, v117
    v_fmac_f32 v244, v22, v166
    v_fmac_f32 v236, v30, v118
    v_fmac_f32 v244, v23, v167
    v_fmac_f32 v236, v31, v119
    ds_read_b64_tr_b16 v[0:1], v249 offset:0
    ds_read_b64_tr_b16 v[2:3], v249 offset:32
    ds_read_u16_d16_hi v16, v250 offset:0
    v_mul_f32 v243, v32, v152
    v_fma_f32 v241, v40, v168, -v241
    v_fmac_f32 v243, v33, v153
    v_fmac_f32 v241, v41, v169
    v_fmac_f32 v243, v34, v154
    v_fmac_f32 v241, v42, v170
    v_fmac_f32 v243, v35, v155
    v_fmac_f32 v241, v43, v171
    v_fmac_f32 v243, v36, v156
    v_fmac_f32 v241, v44, v172
    v_fmac_f32 v243, v37, v157
    v_fmac_f32 v241, v45, v173
    v_fmac_f32 v243, v38, v158
    v_fmac_f32 v241, v46, v174
    v_fmac_f32 v243, v39, v159
    v_fmac_f32 v241, v47, v175
    ds_read_b64_tr_b16 v[4:5], v249 offset:512
    ds_read_b64_tr_b16 v[6:7], v249 offset:544
    ds_read_u16_d16_hi v17, v250 offset:128
    v_fma_f32 v245, v48, v168, -v245
    v_fmac_f32 v237, v56, v120
    v_fmac_f32 v245, v49, v169
    v_fmac_f32 v237, v57, v121
    v_fmac_f32 v245, v50, v170
    v_fmac_f32 v237, v58, v122
    v_fmac_f32 v245, v51, v171
    v_fmac_f32 v237, v59, v123
    v_fmac_f32 v245, v52, v172
    v_fmac_f32 v237, v60, v124
    v_fmac_f32 v245, v53, v173
    v_fmac_f32 v237, v61, v125
    v_fmac_f32 v245, v54, v174
    v_fmac_f32 v237, v62, v126
    v_fmac_f32 v245, v55, v175
    v_fmac_f32 v237, v63, v127
    s_cmp_eq_u32 s56, 5
    s_cbranch_scc1 K2_U20
    s_cmp_eq_u32 s56, 6
    s_cbranch_scc1 K2_U3h0
    s_branch K2_DSP0
K2_PAD_U21:
    s_branch K2_HOP
K2_U21:
    s_setprio 1
    s_waitcnt lgkmcnt(0)
    v_lshlrev_b32 v20, 16, v0
    v_and_b32 v21, 0xffff0000, v0
    v_lshlrev_b32 v22, 16, v1
    v_and_b32 v23, 0xffff0000, v1
    v_lshlrev_b32 v24, 16, v2
    v_and_b32 v25, 0xffff0000, v2
    v_lshlrev_b32 v26, 16, v3
    v_and_b32 v27, 0xffff0000, v3
    v_mul_f32_dpp v36, v16, v20 row_newbcast:8 row_mask:0xf bank_mask:0xf
    v_mul_f32_dpp v37, v16, v21 row_newbcast:9 row_mask:0xf bank_mask:0xf
    v_mul_f32_dpp v38, v16, v22 row_newbcast:10 row_mask:0xf bank_mask:0xf
    v_mul_f32_dpp v39, v16, v23 row_newbcast:11 row_mask:0xf bank_mask:0xf
    v_mul_f32_dpp v40, v16, v24 row_newbcast:12 row_mask:0xf bank_mask:0xf
    v_mul_f32_dpp v41, v16, v25 row_newbcast:13 row_mask:0xf bank_mask:0xf
    v_mul_f32_dpp v42, v16, v26 row_newbcast:14 row_mask:0xf bank_mask:0xf
    v_mul_f32_dpp v43, v16, v27 row_newbcast:15 row_mask:0xf bank_mask:0xf
    v_cvt_pk_bf16_f32 v68, v36, v37
    v_cvt_pk_bf16_f32 v69, v38, v39
    v_cvt_pk_bf16_f32 v70, v40, v41
    v_cvt_pk_bf16_f32 v71, v42, v43
    v_mul_f32_dpp v20, v16, v20 row_newbcast:0 row_mask:0xa bank_mask:0xf
    v_mul_f32_dpp v21, v16, v21 row_newbcast:1 row_mask:0xa bank_mask:0xf
    v_mul_f32_dpp v22, v16, v22 row_newbcast:2 row_mask:0xa bank_mask:0xf
    v_mul_f32_dpp v23, v16, v23 row_newbcast:3 row_mask:0xa bank_mask:0xf
    v_mul_f32_dpp v24, v16, v24 row_newbcast:4 row_mask:0xa bank_mask:0xf
    v_mul_f32_dpp v25, v16, v25 row_newbcast:5 row_mask:0xa bank_mask:0xf
    v_mul_f32_dpp v26, v16, v26 row_newbcast:6 row_mask:0xa bank_mask:0xf
    v_mul_f32_dpp v27, v16, v27 row_newbcast:7 row_mask:0xa bank_mask:0xf
    v_cvt_pk_bf16_f32 v64, v20, v21
    v_cvt_pk_bf16_f32 v65, v22, v23
    v_cvt_pk_bf16_f32 v66, v24, v25
    v_cvt_pk_bf16_f32 v67, v26, v27
    v_lshlrev_b32 v28, 16, v4
    v_and_b32 v29, 0xffff0000, v4
    v_lshlrev_b32 v30, 16, v5
    v_and_b32 v31, 0xffff0000, v5
    v_lshlrev_b32 v32, 16, v6
    v_and_b32 v33, 0xffff0000, v6
    v_lshlrev_b32 v34, 16, v7
    v_and_b32 v35, 0xffff0000, v7
    v_mul_f32_dpp v36, v17, v28 row_newbcast:8 row_mask:0xf bank_mask:0xf
    v_mul_f32_dpp v37, v17, v29 row_newbcast:9 row_mask:0xf bank_mask:0xf
    v_mul_f32_dpp v38, v17, v30 row_newbcast:10 row_mask:0xf bank_mask:0xf
    v_mul_f32_dpp v39, v17, v31 row_newbcast:11 row_mask:0xf bank_mask:0xf
    v_mul_f32_dpp v40, v17, v32 row_newbcast:12 row_mask:0xf bank_mask:0xf
    v_mul_f32_dpp v41, v17, v33 row_newbcast:13 row_mask:0xf bank_mask:0xf
    v_mul_f32_dpp v42, v17, v34 row_newbcast:14 row_mask:0xf bank_mask:0xf
    v_mul_f32_dpp v43, v17, v35 row_newbcast:15 row_mask:0xf bank_mask:0xf
    v_cvt_pk_bf16_f32 v76, v36, v37
    v_cvt_pk_bf16_f32 v77, v38, v39
    v_cvt_pk_bf16_f32 v78, v40, v41
    v_cvt_pk_bf16_f32 v79, v42, v43
    v_mul_f32_dpp v28, v17, v28 row_newbcast:0 row_mask:0xa bank_mask:0xf
    v_mul_f32_dpp v29, v17, v29 row_newbcast:1 row_mask:0xa bank_mask:0xf
    v_mul_f32_dpp v30, v17, v30 row_newbcast:2 row_mask:0xa bank_mask:0xf
    v_mul_f32_dpp v31, v17, v31 row_newbcast:3 row_mask:0xa bank_mask:0xf
    v_mul_f32_dpp v32, v17, v32 row_newbcast:4 row_mask:0xa bank_mask:0xf
    v_mul_f32_dpp v33, v17, v33 row_newbcast:5 row_mask:0xa bank_mask:0xf
    v_mul_f32_dpp v34, v17, v34 row_newbcast:6 row_mask:0xa bank_mask:0xf
    v_mul_f32_dpp v35, v17, v35 row_newbcast:7 row_mask:0xa bank_mask:0xf
    v_cvt_pk_bf16_f32 v72, v28, v29
    v_cvt_pk_bf16_f32 v73, v30, v31
    v_cvt_pk_bf16_f32 v74, v32, v33
    v_cvt_pk_bf16_f32 v75, v34, v35
    s_waitcnt vmcnt(4)
    v_mfma_f32_32x32x16_bf16 v[0:15], v[64:67], v[176:179], 0
    ds_read_b64_tr_b16 v[184:185], v246 offset:2048
    ds_read_b64_tr_b16 v[186:187], v246 offset:3072
    ds_read_b64_tr_b16 v[188:189], v247 offset:2048
    ds_read_b64_tr_b16 v[190:191], v247 offset:3072
    s_mov_b32 m0, s68
    v_mfma_f32_32x32x16_bf16 v[16:31], v[68:71], v[176:179], 0
    buffer_load_dwordx4 v222, s[4:7], s42 offen sc1 lds
    buffer_load_dwordx4 v223, s[72:75], s42 offen offset:1024 sc1 lds
    v_permlane32_swap_b32 v242, v236
    v_permlane32_swap_b32 v243, v237
    v_mov_b32 v254, 163296
    v_mfma_f32_32x32x16_bf16 v[32:47], v[64:67], v[180:183], 0
    v_permlane32_swap_b32 v244, v238
    v_permlane32_swap_b32 v245, v239
    v_permlane32_swap_b32 v240, v241
    v_add_f32 v242, v242, v236
    v_mfma_f32_32x32x16_bf16 v[48:63], v[68:71], v[180:183], 0
    v_add_f32 v243, v243, v237
    v_add_f32 v244, v244, v238
    v_add_f32 v245, v245, v239
    v_add_f32 v240, -v240, -v241
    v_sub_u32 v241, v230, v231
    v_cvt_pk_bf16_f32 v242, v242, v243
    v_mov_b32 v255, 1
    v_lshl_add_u32 v233, v252, 1, s53
    s_mov_b64 exec, 1
    ds_add_rtn_u32 v232, v254, v255
    s_mov_b64 exec, -1
    ds_read_b32 v233, v233
    s_waitcnt vmcnt(4) lgkmcnt(2)
    v_mfma_f32_32x32x16_bf16 v[0:15], v[72:75], v[184:187], v[0:15]
    ds_read_b64_tr_b16 v[176:177], v246 offset:4096
    ds_read_b64_tr_b16 v[178:179], v246 offset:5120
    ds_read_b64_tr_b16 v[180:181], v247 offset:4096
    ds_read_b64_tr_b16 v[182:183], v247 offset:5120
    v_cvt_pk_bf16_f32 v244, v244, v245
    v_cvt_pk_bf16_f32 v240, v240, v240
    s_mov_b32 m0, s69
    v_mfma_f32_32x32x16_bf16 v[16:31], v[76:79], v[184:187], v[16:31]
    buffer_load_dwordx4 v224, s[4:7], s42 offen sc1 lds
    buffer_load_dwordx4 v225, s[72:75], s42 offen offset:1024 sc1 lds
    ds_write_b32 v230, v242 offset:768
    ds_write_b32 v230, v244 offset:1024
    ds_write_b16 v241, v240 offset:1280
    s_waitcnt lgkmcnt(7)
    v_readfirstlane_b32 s58, v232
    v_mfma_f32_32x32x16_bf16 v[32:47], v[72:75], v[188:191], v[32:47]
    s_cmp_lt_u32 s58, s22
    s_cbranch_scc0 K2_nul_47
    s_and_b32 s59, s58, 7
    s_lshr_b32 s60, s58, 3
K2_chk_49:
    v_readlane_b32 s61, v233, s59
    s_nop 0
    s_cmp_gt_u32 s61, s60
    s_cbranch_scc0 K2_spin_48
K2_back_50:
    v_mfma_f32_32x32x16_bf16 v[48:63], v[76:79], v[188:191], v[48:63]
    s_setprio 0
    v_readlane_b32 s3, v253, s58
    s_lshl_b32 s44, s34, 7
    s_and_b32 s48, s3, 0x3ffff
    s_bfe_u32 s33, s3, 0x30013
    s_mov_b32 s35, s48
    s_mov_b32 s45, s44
    v_mul_f32 v234, v0, v96
    v_mul_f32 v236, v8, v128
    v_fmac_f32 v234, v1, v97
    v_fmac_f32 v236, v9, v129
    v_fmac_f32 v234, v2, v98
    v_fmac_f32 v236, v10, v130
    v_fmac_f32 v234, v3, v99
    v_fmac_f32 v236, v11, v131
    v_fmac_f32 v234, v4, v100
    v_fmac_f32 v236, v12, v132
    v_fmac_f32 v234, v5, v101
    v_fmac_f32 v236, v13, v133
    v_fmac_f32 v234, v6, v102
    v_fmac_f32 v236, v14, v134
    v_fmac_f32 v234, v7, v103
    v_fmac_f32 v236, v15, v135
    v_mul_f32 v238, v16, v128
    v_mul_f32 v240, v24, v128
    v_fmac_f32 v238, v17, v129
    v_fmac_f32 v240, v25, v129
    v_fmac_f32 v238, v18, v130
    v_fmac_f32 v240, v26, v130
    v_fmac_f32 v238, v19, v131
    v_fmac_f32 v240, v27, v131
    v_fmac_f32 v238, v20, v132
    v_fmac_f32 v240, v28, v132
    v_fmac_f32 v238, v21, v133
    v_fmac_f32 v240, v29, v133
    v_fmac_f32 v238, v22, v134
    v_fmac_f32 v240, v30, v134
    v_fmac_f32 v238, v23, v135
    v_fmac_f32 v240, v31, v135
    v_mul_f32 v235, v32, v104
    v_mul_f32 v237, v40, v136
    v_fmac_f32 v235, v33, v105
    v_fmac_f32 v237, v41, v137
    v_fmac_f32 v235, v34, v106
    v_fmac_f32 v237, v42, v138
    v_fmac_f32 v235, v35, v107
    v_fmac_f32 v237, v43, v139
    v_fmac_f32 v235, v36, v108
    v_fmac_f32 v237, v44, v140
    v_fmac_f32 v235, v37, v109
    v_fmac_f32 v237, v45, v141
    v_fmac_f32 v235, v38, v110
    v_fmac_f32 v237, v46, v142
    v_fmac_f32 v235, v39, v111
    v_fmac_f32 v237, v47, v143
    v_mul_f32 v239, v48, v136
    v_mul_f32 v241, v56, v136
    v_fmac_f32 v239, v49, v137
    v_fmac_f32 v241, v57, v137
    s_setprio 1
    s_waitcnt vmcnt(4) lgkmcnt(3)
    v_mfma_f32_32x32x16_bf16 v[0:15], v[64:67], v[176:179], 0
    ds_read_b64_tr_b16 v[184:185], v246 offset:6144
    ds_read_b64_tr_b16 v[186:187], v246 offset:7168
    ds_read_b64_tr_b16 v[188:189], v247 offset:6144
    ds_read_b64_tr_b16 v[190:191], v247 offset:7168
    v_fmac_f32 v239, v50, v138
    v_fmac_f32 v241, v58, v138
    s_mov_b32 m0, s70
    v_mfma_f32_32x32x16_bf16 v[16:31], v[68:71], v[176:179], 0
    buffer_load_dwordx4 v222, s[4:7], s43 offen sc1 lds
    buffer_load_dwordx4 v223, s[72:75], s43 offen offset:1024 sc1 lds
    v_fmac_f32 v239, v51, v139
    v_fmac_f32 v241, v59, v139
    v_fmac_f32 v239, v52, v140
    v_fmac_f32 v241, v60, v140
    v_fmac_f32 v239, v53, v141
    v_mfma_f32_32x32x16_bf16 v[32:47], v[64:67], v[180:183], 0
    s_xor_b32 s47, s44, 256
    s_add_u32 s49, s48, 128
    s_add_u32 s60, s48, 256
    s_cmp_eq_u32 s33, 3
    s_cselect_b32 s46, s44, s47
    s_cselect_b32 s50, s60, s48
    s_cselect_b32 s51, s48, s49
    s_sub_u32 s60, s33, 2
    s_cmp_lt_u32 s60, 2
    s_cbranch_scc0 K2_rare_51
K2_back_52:
    v_add_u32 v222, s48, v251
    ds_read2_b32 v[222:223], v222 offset0:1 offset1:3
    v_fmac_f32 v241, v61, v141
    v_fmac_f32 v239, v54, v142
    v_fmac_f32 v241, v62, v142
    v_fmac_f32 v239, v55, v143
    v_fmac_f32 v241, v63, v143
    v_mfma_f32_32x32x16_bf16 v[48:63], v[68:71], v[180:183], 0
    v_permlane32_swap_b32 v234, v236
    v_permlane32_swap_b32 v235, v237
    v_permlane32_swap_b32 v240, v238
    s_waitcnt vmcnt(4) lgkmcnt(1)
    v_mfma_f32_32x32x16_bf16 v[0:15], v[72:75], v[184:187], v[0:15]
    ds_read_b64_tr_b16 v[176:177], v246 offset:0
    ds_read_b64_tr_b16 v[178:179], v246 offset:1024
    ds_read_b64_tr_b16 v[180:181], v247 offset:0
    ds_read_b64_tr_b16 v[182:183], v247 offset:1024
    v_permlane32_swap_b32 v241, v239
    s_mov_b32 m0, s71
    v_mfma_f32_32x32x16_bf16 v[16:31], v[76:79], v[184:187], v[16:31]
    buffer_load_dwordx4 v224, s[4:7], s43 offen sc1 lds
    buffer_load_dwordx4 v225, s[72:75], s43 offen offset:1024 sc1 lds
    s_waitcnt lgkmcnt(4)
    v_mad_u32_u16 v222, v222, s39, v248 op_sel:[1,0,0,0]
    v_mad_u32_u16 v223, v223, s39, v248 op_sel:[1,0,0,0]
    v_lshl_add_u32 v230, v252, 1, s31
    v_add_f32 v234, v234, v236
    v_add_f32 v235, v235, v237
    v_add_f32 v240, v240, v238
    v_add_f32 v241, v241, v239
    v_cvt_pk_bf16_f32 v234, v234, v235
    v_cvt_pk_bf16_f32 v240, v240, v241
    ds_write_b32 v230, v234 offset:0
    ds_write_b32 v230, v240 offset:256
    v_mfma_f32_32x32x16_bf16 v[32:47], v[72:75], v[188:191], v[32:47]
    v_add_u32 v224, s49, v251
    ds_read2_b32 v[224:225], v224 offset0:1 offset1:3
    v_mul_f32 v234, v0, v144
    v_mul_f32 v236, v8, v112
    v_fmac_f32 v234, v1, v145
    v_fmac_f32 v236, v9, v113
    v_fmac_f32 v234, v2, v146
    v_mfma_f32_32x32x16_bf16 v[48:63], v[76:79], v[188:191], v[48:63]
    s_setprio 0
    v_fmac_f32 v236, v10, v114
    v_fmac_f32 v234, v3, v147
    v_fmac_f32 v236, v11, v115
    v_fmac_f32 v234, v4, v148
    v_fmac_f32 v236, v12, v116
    v_fmac_f32 v234, v5, v149
    v_fmac_f32 v236, v13, v117
    v_fmac_f32 v234, v6, v150
    v_fmac_f32 v236, v14, v118
    v_fmac_f32 v234, v7, v151
    v_fmac_f32 v236, v15, v119
    v_mul_f32 v238, v16, v160
    v_mul_f32 v240, v24, v160
    v_fmac_f32 v238, v17, v161
    v_fmac_f32 v240, v25, v161
    v_fmac_f32 v238, v18, v162
    v_fmac_f32 v240, v26, v162
    v_fmac_f32 v238, v19, v163
    v_fmac_f32 v240, v27, v163
    v_fmac_f32 v238, v20, v164
    v_fmac_f32 v240, v28, v164
    v_fmac_f32 v238, v21, v165
    v_fmac_f32 v240, v29, v165
    v_fmac_f32 v238, v22, v166
    v_fmac_f32 v240, v30, v166
    v_fmac_f32 v238, v23, v167
    v_fmac_f32 v240, v31, v167
    v_mul_f32 v235, v32, v152
    v_mul_f32 v237, v40, v120
    v_fmac_f32 v235, v33, v153
    v_fmac_f32 v237, v41, v121
    v_fmac_f32 v235, v34, v154
    v_fmac_f32 v237, v42, v122
    v_fmac_f32 v235, v35, v155
    v_fmac_f32 v237, v43, v123
    v_fmac_f32 v235, v36, v156
    v_fmac_f32 v237, v44, v124
    v_fmac_f32 v235, v37, v157
    v_fmac_f32 v237, v45, v125
    v_fmac_f32 v235, v38, v158
    v_fmac_f32 v237, v46, v126
    v_fmac_f32 v235, v39, v159
    v_fmac_f32 v237, v47, v127
    v_mul_f32 v239, v48, v168
    v_mul_f32 v241, v56, v168
    v_fmac_f32 v239, v49, v169
    v_fmac_f32 v241, v57, v169
    v_fmac_f32 v239, v50, v170
    v_fmac_f32 v241, v58, v170
    v_fmac_f32 v239, v51, v171
    s_setprio 1
    s_waitcnt vmcnt(4) lgkmcnt(3)
    v_mfma_f32_32x32x16_bf16 v[0:15], v[64:67], v[176:179], 0
    ds_read_b64_tr_b16 v[184:185], v246 offset:2048
    ds_read_b64_tr_b16 v[186:187], v246 offset:3072
    ds_read_b64_tr_b16 v[188:189], v247 offset:2048
    ds_read_b64_tr_b16 v[190:191], v247 offset:3072
    v_fmac_f32 v241, v59, v171
    v_fmac_f32 v239, v52, v172
    s_mov_b32 m0, s68
    v_mfma_f32_32x32x16_bf16 v[16:31], v[68:71], v[176:179], 0
    buffer_load_dwordx4 v222, s[4:7], s44 offen sc1 lds
    buffer_load_dwordx4 v223, s[72:75], s44 offen offset:1024 sc1 lds
    s_waitcnt lgkmcnt(4)
    v_mad_u32_u16 v224, v224, s39, v248 op_sel:[1,0,0,0]
    v_mad_u32_u16 v225, v225, s39, v248 op_sel:[1,0,0,0]
    v_fmac_f32 v241, v60, v172
    v_fmac_f32 v239, v53, v173
    v_mfma_f32_32x32x16_bf16 v[32:47], v[64:67], v[180:183], 0
    v_add_u32 v226, s50, v251
    ds_read2_b32 v[226:227], v226 offset0:1 offset1:3
    v_fmac_f32 v241, v61, v173
    v_fmac_f32 v239, v54, v174
    v_fmac_f32 v241, v62, v174
    v_fmac_f32 v239, v55, v175
    v_fmac_f32 v241, v63, v175
    v_mfma_f32_32x32x16_bf16 v[48:63], v[68:71], v[180:183], 0
    s_waitcnt vmcnt(4) lgkmcnt(1)
    v_mfma_f32_32x32x16_bf16 v[0:15], v[72:75], v[184:187], v[0:15]
    ds_read_b64_tr_b16 v[176:177], v246 offset:4096
    ds_read_b64_tr_b16 v[178:179], v246 offset:5120
    ds_read_b64_tr_b16 v[180:181], v247 offset:4096
    ds_read_b64_tr_b16 v[182:183], v247 offset:5120
    s_mov_b32 m0, s69
    v_mfma_f32_32x32x16_bf16 v[16:31], v[76:79], v[184:187], v[16:31]
    buffer_load_dwordx4 v224, s[4:7], s45 offen sc1 lds
    buffer_load_dwordx4 v225, s[72:75], s45 offen offset:1024 sc1 lds
    s_waitcnt lgkmcnt(4)
    v_mad_u32_u16 v226, v226, s39, v248 op_sel:[1,0,0,0]
    v_mad_u32_u16 v227, v227, s39, v248 op_sel:[1,0,0,0]
    v_mfma_f32_32x32x16_bf16 v[32:47], v[72:75], v[188:191], v[32:47]
    v_add_u32 v228, s51, v251
    ds_read2_b32 v[228:229], v228 offset0:1 offset1:3
    v_mul_f32 v242, v0, v144
    v_fma_f32 v238, v8, v160, -v238
    v_fmac_f32 v242, v1, v145
    v_fmac_f32 v238, v9, v161
    v_fmac_f32 v242, v2, v146
    v_mfma_f32_32x32x16_bf16 v[48:63], v[76:79], v[188:191], v[48:63]
    s_setprio 0
    v_fmac_f32 v238, v10, v162
    v_fmac_f32 v242, v3, v147
    v_fmac_f32 v238, v11, v163
    v_fmac_f32 v242, v4, v148
    v_fmac_f32 v238, v12, v164
    v_fmac_f32 v242, v5, v149
    v_fmac_f32 v238, v13, v165
    v_fmac_f32 v242, v6, v150
    v_fmac_f32 v238, v14, v166
    v_fmac_f32 v242, v7, v151
    v_fmac_f32 v238, v15, v167
    v_fmac_f32 v236, v16, v112
    v_mul_f32 v244, v24, v160
    v_fmac_f32 v236, v17, v113
    v_fmac_f32 v244, v25, v161
    v_fmac_f32 v236, v18, v114
    v_fmac_f32 v244, v26, v162
    v_fmac_f32 v236, v19, v115
    v_fmac_f32 v244, v27, v163
    v_fmac_f32 v236, v20, v116
    v_fmac_f32 v244, v28, v164
    v_fmac_f32 v236, v21, v117
    v_fmac_f32 v244, v29, v165
    v_fmac_f32 v236, v22, v118
    v_fmac_f32 v244, v30, v166
    v_fmac_f32 v236, v23, v119
    v_fmac_f32 v244, v31, v167
    v_mul_f32 v243, v32, v152
    v_fma_f32 v239, v40, v168, -v239
    v_fmac_f32 v243, v33, v153
    v_fmac_f32 v239, v41, v169
    v_fmac_f32 v243, v34, v154
    v_fmac_f32 v239, v42, v170
    v_fmac_f32 v243, v35, v155
    v_fmac_f32 v239, v43, v171
    v_fmac_f32 v243, v36, v156
    v_fmac_f32 v239, v44, v172
    v_fmac_f32 v243, v37, v157
    v_fmac_f32 v239, v45, v173
    v_fmac_f32 v243, v38, v158
    v_fmac_f32 v239, v46, v174
    v_fmac_f32 v243, v39, v159
    v_fmac_f32 v239, v47, v175
    v_fmac_f32 v237, v48, v120
    v_mul_f32 v245, v56, v168
    v_fmac_f32 v237, v49, v121
    v_fmac_f32 v245, v57, v169
    v_fmac_f32 v237, v50, v122
    s_setprio 1
    s_waitcnt vmcnt(4) lgkmcnt(1)
    v_mfma_f32_32x32x16_bf16 v[0:15], v[64:67], v[176:179], 0
    ds_read_b64_tr_b16 v[184:185], v246 offset:6144
    ds_read_b64_tr_b16 v[186:187], v246 offset:7168
    ds_read_b64_tr_b16 v[188:189], v247 offset:6144
    ds_read_b64_tr_b16 v[190:191], v247 offset:7168
    v_fmac_f32 v245, v58, v170
    v_fmac_f32 v237, v51, v123
    s_mov_b32 m0, s70
    v_mfma_f32_32x32x16_bf16 v[16:31], v[68:71], v[176:179], 0
    buffer_load_dwordx4 v226, s[4:7], s46 offen sc1 lds
    buffer_load_dwordx4 v227, s[72:75], s46 offen offset:1024 sc1 lds
    s_waitcnt lgkmcnt(4)
    v_mad_u32_u16 v228, v228, s39, v248 op_sel:[1,0,0,0]
    v_mad_u32_u16 v229, v229, s39, v248 op_sel:[1,0,0,0]
    v_fmac_f32 v245, v59, v171
    v_fmac_f32 v237, v52, v124
    v_mfma_f32_32x32x16_bf16 v[32:47], v[64:67], v[180:183], 0
    v_fmac_f32 v245, v60, v172
    v_fmac_f32 v237, v53, v125
    v_fmac_f32 v245, v61, v173
    v_fmac_f32 v237, v54, v126
    v_fmac_f32 v245, v62, v174
    v_fmac_f32 v237, v55, v127
    v_fmac_f32 v245, v63, v175
    v_mfma_f32_32x32x16_bf16 v[48:63], v[68:71], v[180:183], 0
    v_permlane32_swap_b32 v242, v234
    v_permlane32_swap_b32 v243, v235
    v_add_f32 v242, v242, v234
    v_add_f32 v243, v243, v235
    s_waitcnt vmcnt(4) lgkmcnt(0)
    v_mfma_f32_32x32x16_bf16 v[0:15], v[72:75], v[184:187], v[0:15]
    ds_read_b64_tr_b16 v[176:177], v246 offset:0
    ds_read_b64_tr_b16 v[178:179], v246 offset:1024
    ds_read_b64_tr_b16 v[180:181], v247 offset:0
    ds_read_b64_tr_b16 v[182:183], v247 offset:1024
    v_cvt_pk_bf16_f32 v242, v242, v243
    ds_write_b32 v230, v242 offset:512
    s_mov_b32 m0, s71
    v_mfma_f32_32x32x16_bf16 v[16:31], v[76:79], v[184:187], v[16:31]
    buffer_load_dwordx4 v228, s[4:7], s47 offen sc1 lds
    buffer_load_dwordx4 v229, s[72:75], s47 offen offset:1024 sc1 lds
    s_sub_u32 s26, s48, s29
    s_mov_b32 s29, s48
    s_mov_b32 s30, s3
    s_bfe_u32 s56, s3, 0x40012
    s_cmp_lg_u32 s36, 0
    s_cselect_b32 s56, s56, 0
    v_mfma_f32_32x32x16_bf16 v[32:47], v[72:75], v[188:191], v[32:47]
    s_mov_b32 s32, s31
    s_mov_b32 s31, s35
    v_mul_f32 v242, v0, v144
    v_fma_f32 v240, v8, v160, -v240
    v_fmac_f32 v242, v1, v145
    v_fmac_f32 v240, v9, v161
    v_fmac_f32 v242, v2, v146
    v_mfma_f32_32x32x16_bf16 v[48:63], v[76:79], v[188:191], v[48:63]
    s_setprio 0
    v_fmac_f32 v240, v10, v162
    v_fmac_f32 v242, v3, v147
    v_fmac_f32 v240, v11, v163
    v_fmac_f32 v242, v4, v148
    v_fmac_f32 v240, v12, v164
    v_fmac_f32 v242, v5, v149
    v_fmac_f32 v240, v13, v165
    v_fmac_f32 v242, v6, v150
    v_fmac_f32 v240, v14, v166
    v_fmac_f32 v242, v7, v151
    v_fmac_f32 v240, v15, v167
    v_add_u32 v249, s26, v249
    v_add_u32 v250, s26, v250
    v_fma_f32 v244, v16, v160, -v244
    v_fmac_f32 v236, v24, v112
    v_fmac_f32 v244, v17, v161
    v_fmac_f32 v236, v25, v113
    v_fmac_f32 v244, v18, v162
    v_fmac_f32 v236, v26, v114
    v_fmac_f32 v244, v19, v163
    v_fmac_f32 v236, v27, v115
    v_fmac_f32 v244, v20, v164
    v_fmac_f32 v236, v28, v116
    v_fmac_f32 v244, v21, v165
    v_fmac_f32 v236, v29, v117
    v_fmac_f32 v244, v22, v166
    v_fmac_f32 v236, v30, v118
    v_fmac_f32 v244, v23, v167
    v_fmac_f32 v236, v31, v119
    ds_read_b64_tr_b16 v[0:1], v249 offset:0
    ds_read_b64_tr_b16 v[2:3], v249 offset:32
    ds_read_u16_d16_hi v16, v250 offset:0
    v_mul_f32 v243, v32, v152
    v_fma_f32 v241, v40, v168, -v241
    v_fmac_f32 v243, v33, v153
    v_fmac_f32 v241, v41, v169
    v_fmac_f32 v243, v34, v154
    v_fmac_f32 v241, v42, v170
    v_fmac_f32 v243, v35, v155
    v_fmac_f32 v241, v43, v171
    v_fmac_f32 v243, v36, v156
    v_fmac_f32 v241, v44, v172
    v_fmac_f32 v243, v37, v157
    v_fmac_f32 v241, v45, v173
    v_fmac_f32 v243, v38, v158
    v_fmac_f32 v241, v46, v174
    v_fmac_f32 v243, v39, v159
    v_fmac_f32 v241, v47, v175
    ds_read_b64_tr_b16 v[4:5], v249 offset:512
    ds_read_b64_tr_b16 v[6:7], v249 offset:544
    ds_read_u16_d16_hi v17, v250 offset:128
    v_fma_f32 v245, v48, v168, -v245
    v_fmac_f32 v237, v56, v120
    v_fmac_f32 v245, v49, v169
    v_fmac_f32 v237, v57, v121
    v_fmac_f32 v245, v50, v170
    v_fmac_f32 v237, v58, v122
    v_fmac_f32 v245, v51, v171
    v_fmac_f32 v237, v59, v123
    v_fmac_f32 v245, v52, v172
    v_fmac_f32 v237, v60, v124
    v_fmac_f32 v245, v53, v173
    v_fmac_f32 v237, v61, v125
    v_fmac_f32 v245, v54, v174
    v_fmac_f32 v237, v62, v126
    v_fmac_f32 v245, v55, v175
    v_fmac_f32 v237, v63, v127
    s_cmp_eq_u32 s56, 5
    s_cbranch_scc1 K2_U21
    s_cmp_eq_u32 s56, 6
    s_cbranch_scc1 K2_U3h1
    s_branch K2_DSP1
K2_PAD_U31:
    s_branch K2_HOP
K2_U3h1:
    s_setprio 1
    ds_read_b64_tr_b16 v[8:9], v249 offset:1024
    ds_read_u16_d16_hi v18, v250 offset:256
    s_waitcnt lgkmcnt(2)
    v_lshlrev_b32 v20, 16, v0
    v_and_b32 v21, 0xffff0000, v0
    v_lshlrev_b32 v22, 16, v1
    v_and_b32 v23, 0xffff0000, v1
    v_lshlrev_b32 v24, 16, v2
    v_and_b32 v25, 0xffff0000, v2
    v_lshlrev_b32 v26, 16, v3
    v_and_b32 v27, 0xffff0000, v3
    v_mul_f32_dpp v36, v16, v20 row_newbcast:8 row_mask:0xf bank_mask:0xf
    v_mul_f32_dpp v37, v16, v21 row_newbcast:9 row_mask:0xf bank_mask:0xf
    v_mul_f32_dpp v38, v16, v22 row_newbcast:10 row_mask:0xf bank_mask:0xf
    v_mul_f32_dpp v39, v16, v23 row_newbcast:11 row_mask:0xf bank_mask:0xf
    v_mul_f32_dpp v40, v16, v24 row_newbcast:12 row_mask:0xf bank_mask:0xf
    v_mul_f32_dpp v41, v16, v25 row_newbcast:13 row_mask:0xf bank_mask:0xf
    v_mul_f32_dpp v42, v16, v26 row_newbcast:14 row_mask:0xf bank_mask:0xf
    v_mul_f32_dpp v43, v16, v27 row_newbcast:15 row_mask:0xf bank_mask:0xf
    v_cvt_pk_bf16_f32 v68, v36, v37
    v_cvt_pk_bf16_f32 v69, v38, v39
    v_cvt_pk_bf16_f32 v70, v40, v41
    v_cvt_pk_bf16_f32 v71, v42, v43
    v_mul_f32_dpp v20, v16, v20 row_newbcast:0 row_mask:0xa bank_mask:0xf
    v_mul_f32_dpp v21, v16, v21 row_newbcast:1 row_mask:0xa bank_mask:0xf
    v_mul_f32_dpp v22, v16, v22 row_newbcast:2 row_mask:0xa bank_mask:0xf
    v_mul_f32_dpp v23, v16, v23 row_newbcast:3 row_mask:0xa bank_mask:0xf
    v_mul_f32_dpp v24, v16, v24 row_newbcast:4 row_mask:0xa bank_mask:0xf
    v_mul_f32_dpp v25, v16, v25 row_newbcast:5 row_mask:0xa bank_mask:0xf
    v_mul_f32_dpp v26, v16, v26 row_newbcast:6 row_mask:0xa bank_mask:0xf
    v_mul_f32_dpp v27, v16, v27 row_newbcast:7 row_mask:0xa bank_mask:0xf
    v_cvt_pk_bf16_f32 v64, v20, v21
    v_cvt_pk_bf16_f32 v65, v22, v23
    v_cvt_pk_bf16_f32 v66, v24, v25
    v_cvt_pk_bf16_f32 v67, v26, v27
    v_lshlrev_b32 v28, 16, v4
    v_and_b32 v29, 0xffff0000, v4
    v_lshlrev_b32 v30, 16, v5
    v_and_b32 v31, 0xffff0000, v5
    v_lshlrev_b32 v32, 16, v6
    v_and_b32 v33, 0xffff0000, v6
    v_lshlrev_b32 v34, 16, v7
    v_and_b32 v35, 0xffff0000, v7
    v_mul_f32_dpp v36, v17, v28 row_newbcast:8 row_mask:0xf bank_mask:0xf
    v_mul_f32_dpp v37, v17, v29 row_newbcast:9 row_mask:0xf bank_mask:0xf
    v_mul_f32_dpp v38, v17, v30 row_newbcast:10 row_mask:0xf bank_mask:0xf
    v_mul_f32_dpp v39, v17, v31 row_newbcast:11 row_mask:0xf bank_mask:0xf
    v_mul_f32_dpp v40, v17, v32 row_newbcast:12 row_mask:0xf bank_mask:0xf
    v_mul_f32_dpp v41, v17, v33 row_newbcast:13 row_mask:0xf bank_mask:0xf
    v_mul_f32_dpp v42, v17, v34 row_newbcast:14 row_mask:0xf bank_mask:0xf
    v_mul_f32_dpp v43, v17, v35 row_newbcast:15 row_mask:0xf bank_mask:0xf
    v_cvt_pk_bf16_f32 v76, v36, v37
    v_cvt_pk_bf16_f32 v77, v38, v39
    v_cvt_pk_bf16_f32 v78, v40, v41
    v_cvt_pk_bf16_f32 v79, v42, v43
    v_mul_f32_dpp v28, v17, v28 row_newbcast:0 row_mask:0xa bank_mask:0xf
    v_mul_f32_dpp v29, v17, v29 row_newbcast:1 row_mask:0xa bank_mask:0xf
    v_mul_f32_dpp v30, v17, v30 row_newbcast:2 row_mask:0xa bank_mask:0xf
    v_mul_f32_dpp v31, v17, v31 row_newbcast:3 row_mask:0xa bank_mask:0xf
    v_mul_f32_dpp v32, v17, v32 row_newbcast:4 row_mask:0xa bank_mask:0xf
    v_mul_f32_dpp v33, v17, v33 row_newbcast:5 row_mask:0xa bank_mask:0xf
    v_mul_f32_dpp v34, v17, v34 row_newbcast:6 row_mask:0xa bank_mask:0xf
    v_mul_f32_dpp v35, v17, v35 row_newbcast:7 row_mask:0xa bank_mask:0xf
    v_cvt_pk_bf16_f32 v72, v28, v29
    v_cvt_pk_bf16_f32 v73, v30, v31
    v_cvt_pk_bf16_f32 v74, v32, v33
    v_cvt_pk_bf16_f32 v75, v34, v35
    s_waitcnt lgkmcnt(0)
    v_lshlrev_b32 v20, 16, v8
    v_and_b32 v21, 0xffff0000, v8
    v_lshlrev_b32 v22, 16, v9
    v_and_b32 v23, 0xffff0000, v9
    v_mul_f32_dpp v36, v18, v20 row_newbcast:8 row_mask:0xf bank_mask:0xf
    v_mul_f32_dpp v37, v18, v21 row_newbcast:9 row_mask:0xf bank_mask:0xf
    v_mul_f32_dpp v38, v18, v22 row_newbcast:10 row_mask:0xf bank_mask:0xf
    v_mul_f32_dpp v39, v18, v23 row_newbcast:11 row_mask:0xf bank_mask:0xf
    v_cvt_pk_bf16_f32 v84, v36, v37
    v_cvt_pk_bf16_f32 v85, v38, v39
    v_mul_f32_dpp v20, v18, v20 row_newbcast:0 row_mask:0xa bank_mask:0xf
    v_mul_f32_dpp v21, v18, v21 row_newbcast:1 row_mask:0xa bank_mask:0xf
    v_mul_f32_dpp v22, v18, v22 row_newbcast:2 row_mask:0xa bank_mask:0xf
    v_mul_f32_dpp v23, v18, v23 row_newbcast:3 row_mask:0xa bank_mask:0xf
    v_cvt_pk_bf16_f32 v80, v20, v21
    v_cvt_pk_bf16_f32 v81, v22, v23
    s_waitcnt vmcnt(4)
    v_mfma_f32_32x32x16_bf16 v[0:15], v[64:67], v[176:179], 0
    ds_read_b64_tr_b16 v[184:185], v246 offset:2048
    ds_read_b64_tr_b16 v[186:187], v246 offset:3072
    ds_read_b64_tr_b16 v[188:189], v247 offset:2048
    ds_read_b64_tr_b16 v[190:191], v247 offset:3072
    s_mov_b32 m0, s68
    v_mfma_f32_32x32x16_bf16 v[16:31], v[68:71], v[176:179], 0
    buffer_load_dwordx4 v224, s[4:7], s41 offen sc1 lds
    buffer_load_dwordx4 v225, s[72:75], s41 offen offset:1024 sc1 lds
    v_permlane32_swap_b32 v242, v236
    v_permlane32_swap_b32 v243, v237
    v_mov_b32 v254, 163296
    v_mfma_f32_32x32x16_bf16 v[32:47], v[64:67], v[180:183], 0
    v_permlane32_swap_b32 v244, v238
    v_permlane32_swap_b32 v245, v239
    v_permlane32_swap_b32 v240, v241
    v_add_f32 v242, v242, v236
    v_mfma_f32_32x32x16_bf16 v[48:63], v[68:71], v[180:183], 0
    v_add_f32 v243, v243, v237
    v_add_f32 v244, v244, v238
    v_add_f32 v245, v245, v239
    v_add_f32 v240, -v240, -v241
    v_sub_u32 v241, v230, v231
    v_cvt_pk_bf16_f32 v242, v242, v243
    v_mov_b32 v255, 1
    v_lshl_add_u32 v233, v252, 1, s53
    s_mov_b64 exec, 1
    ds_add_rtn_u32 v232, v254, v255
    s_mov_b64 exec, -1
    ds_read_b32 v233, v233
    s_waitcnt vmcnt(4) lgkmcnt(2)
    v_mfma_f32_32x32x16_bf16 v[0:15], v[72:75], v[184:187], v[0:15]
    ds_read_b64_tr_b16 v[176:177], v246 offset:4096
    ds_read_b64_tr_b16 v[180:181], v247 offset:4096
    v_cvt_pk_bf16_f32 v244, v244, v245
    v_cvt_pk_bf16_f32 v240, v240, v240
    ds_write_b32 v230, v242 offset:768
    ds_write_b32 v230, v244 offset:1024
    s_mov_b32 m0, s69
    v_mfma_f32_32x32x16_bf16 v[16:31], v[76:79], v[184:187], v[16:31]
    buffer_load_dwordx4 v226, s[4:7], s41 offen sc1 lds
    ds_write_b16 v241, v240 offset:1280
    s_waitcnt lgkmcnt(5)
    v_readfirstlane_b32 s58, v232
    v_mfma_f32_32x32x16_bf16 v[32:47], v[72:75], v[188:191], v[32:47]
    s_cmp_lt_u32 s58, s22
    s_cbranch_scc0 K2_nul_54
    s_and_b32 s59, s58, 7
    s_lshr_b32 s60, s58, 3
K2_chk_56:
    v_readlane_b32 s61, v233, s59
    s_nop 0
    s_cmp_gt_u32 s61, s60
    s_cbranch_scc0 K2_spin_55
K2_back_57:
    v_mfma_f32_32x32x16_bf16 v[48:63], v[76:79], v[188:191], v[48:63]
    v_readlane_b32 s3, v253, s58
    s_lshl_b32 s44, s34, 7
    s_and_b32 s48, s3, 0x3ffff
    s_bfe_u32 s33, s3, 0x30013
    s_mov_b32 s35, s48
    s_mov_b32 s45, s44
    s_waitcnt vmcnt(3) lgkmcnt(3)
    v_mfma_f32_32x32x8_bf16 v[0:15], v[80:81], v[176:177], v[0:15]
    ds_read_b64_tr_b16 v[184:185], v246 offset:6144
    ds_read_b64_tr_b16 v[186:187], v246 offset:7168
    ds_read_b64_tr_b16 v[188:189], v247 offset:6144
    ds_read_b64_tr_b16 v[190:191], v247 offset:7168
    s_xor_b32 s47, s44, 256
    s_add_u32 s49, s48, 128
    s_mov_b32 m0, s70
    v_mfma_f32_32x32x8_bf16 v[16:31], v[84:85], v[176:177], v[16:31]
    buffer_load_dwordx4 v222, s[4:7], s42 offen sc1 lds
    buffer_load_dwordx4 v223, s[72:75], s42 offen offset:1024 sc1 lds
    s_add_u32 s60, s48, 256
    s_cmp_eq_u32 s33, 3
    s_cselect_b32 s46, s44, s47
    s_cselect_b32 s50, s60, s48
    s_cselect_b32 s51, s48, s49
    v_mfma_f32_32x32x8_bf16 v[32:47], v[80:81], v[180:181], v[32:47]
    s_sub_u32 s60, s33, 2
    s_cmp_lt_u32 s60, 2
    s_cbranch_scc0 K2_rare_58
K2_back_59:
    v_mul_f32 v234, v0, v96
    v_mul_f32 v236, v8, v128
    v_fmac_f32 v234, v1, v97
    v_fmac_f32 v236, v9, v129
    v_mfma_f32_32x32x8_bf16 v[48:63], v[84:85], v[180:181], v[48:63]
    s_setprio 0
    v_fmac_f32 v234, v2, v98
    v_fmac_f32 v236, v10, v130
    v_fmac_f32 v234, v3, v99
    v_fmac_f32 v236, v11, v131
    v_fmac_f32 v234, v4, v100
    v_fmac_f32 v236, v12, v132
    v_fmac_f32 v234, v5, v101
    v_fmac_f32 v236, v13, v133
    v_fmac_f32 v234, v6, v102
    v_fmac_f32 v236, v14, v134
    v_fmac_f32 v234, v7, v103
    v_fmac_f32 v236, v15, v135
    v_mul_f32 v238, v16, v128
    v_mul_f32 v240, v24, v128
    v_fmac_f32 v238, v17, v129
    v_fmac_f32 v240, v25, v129
    v_fmac_f32 v238, v18, v130
    v_fmac_f32 v240, v26, v130
    v_fmac_f32 v238, v19, v131
    v_fmac_f32 v240, v27, v131
    v_fmac_f32 v238, v20, v132
    v_fmac_f32 v240, v28, v132
    v_fmac_f32 v238, v21, v133
    v_fmac_f32 v240, v29, v133
    v_fmac_f32 v238, v22, v134
    v_fmac_f32 v240, v30, v134
    v_fmac_f32 v238, v23, v135
    v_fmac_f32 v240, v31, v135
    v_mul_f32 v235, v32, v104
    v_mul_f32 v237, v40, v136
    v_fmac_f32 v235, v33, v105
    v_fmac_f32 v237, v41, v137
    v_fmac_f32 v235, v34, v106
    v_fmac_f32 v237, v42, v138
    v_fmac_f32 v235, v35, v107
    v_fmac_f32 v237, v43, v139
    v_fmac_f32 v235, v36, v108
    v_fmac_f32 v237, v44, v140
    v_fmac_f32 v235, v37, v109
    v_fmac_f32 v237, v45, v141
    v_fmac_f32 v235, v38, v110
    v_fmac_f32 v237, v46, v142
    v_fmac_f32 v235, v39, v111
    v_fmac_f32 v237, v47, v143
    v_mul_f32 v239, v48, v136
    v_mul_f32 v241, v56, v136
    s_setprio 1
    s_waitcnt vmcnt(3) lgkmcnt(0)
    v_mfma_f32_32x32x16_bf16 v[0:15], v[64:67], v[184:187], 0
    ds_read_b64_tr_b16 v[176:177], v246 offset:0
    ds_read_b64_tr_b16 v[178:179], v246 offset:1024
    ds_read_b64_tr_b16 v[180:181], v247 offset:0
    ds_read_b64_tr_b16 v[182:183], v247 offset:1024
    v_fmac_f32 v239, v49, v137
    v_fmac_f32 v241, v57, v137
    s_mov_b32 m0, s71
    v_mfma_f32_32x32x16_bf16 v[16:31], v[68:71], v[184:187], 0
    buffer_load_dwordx4 v224, s[4:7], s42 offen sc1 lds
    buffer_load_dwordx4 v225, s[72:75], s42 offen offset:1024 sc1 lds
    v_fmac_f32 v239, v50, v138
    v_fmac_f32 v241, v58, v138
    v_fmac_f32 v239, v51, v139
    v_fmac_f32 v241, v59, v139
    v_fmac_f32 v239, v52, v140
    v_mfma_f32_32x32x16_bf16 v[32:47], v[64:67], v[188:191], 0
    v_fmac_f32 v241, v60, v140
    v_fmac_f32 v239, v53, v141
    v_fmac_f32 v241, v61, v141
    v_fmac_f32 v239, v54, v142
    v_fmac_f32 v241, v62, v142
    v_fmac_f32 v239, v55, v143
    v_fmac_f32 v241, v63, v143
    v_mfma_f32_32x32x16_bf16 v[48:63], v[68:71], v[188:191], 0
    v_permlane32_swap_b32 v234, v236
    v_permlane32_swap_b32 v235, v237
    v_permlane32_swap_b32 v240, v238
    s_waitcnt vmcnt(4) lgkmcnt(0)
    v_mfma_f32_32x32x16_bf16 v[0:15], v[72:75], v[176:179], v[0:15]
    ds_read_b64_tr_b16 v[184:185], v246 offset:2048
    ds_read_b64_tr_b16 v[188:189], v247 offset:2048
    v_permlane32_swap_b32 v241, v239
    v_lshl_add_u32 v230, v252, 1, s31
    v_add_f32 v234, v234, v236
    s_mov_b32 m0, s68
    v_mfma_f32_32x32x16_bf16 v[16:31], v[76:79], v[176:179], v[16:31]
    buffer_load_dwordx4 v226, s[4:7], s42 offen sc1 lds
    v_add_f32 v235, v235, v237
    v_add_f32 v240, v240, v238
    v_add_f32 v241, v241, v239
    v_cvt_pk_bf16_f32 v234, v234, v235
    v_cvt_pk_bf16_f32 v240, v240, v241
    ds_write_b32 v230, v234 offset:0
    v_mfma_f32_32x32x16_bf16 v[32:47], v[72:75], v[180:183], v[32:47]
    ds_write_b32 v230, v240 offset:256
    v_mfma_f32_32x32x16_bf16 v[48:63], v[76:79], v[180:183], v[48:63]
    s_waitcnt vmcnt(3) lgkmcnt(2)
    v_mfma_f32_32x32x8_bf16 v[0:15], v[80:81], v[184:185], v[0:15]
    ds_read_b64_tr_b16 v[176:177], v246 offset:4096
    ds_read_b64_tr_b16 v[178:179], v246 offset:5120
    ds_read_b64_tr_b16 v[180:181], v247 offset:4096
    ds_read_b64_tr_b16 v[182:183], v247 offset:5120
    s_mov_b32 m0, s69
    v_mfma_f32_32x32x8_bf16 v[16:31], v[84:85], v[184:185], v[16:31]
    buffer_load_dwordx4 v222, s[4:7], s43 offen sc1 lds
    buffer_load_dwordx4 v223, s[72:75], s43 offen offset:1024 sc1 lds
    v_mfma_f32_32x32x8_bf16 v[32:47], v[80:81], v[188:189], v[32:47]
    s_nop 2
    v_mul_f32 v234, v0, v144
    v_mul_f32 v236, v8, v112
    v_fmac_f32 v234, v1, v145
    v_fmac_f32 v236, v9, v113
    v_fmac_f32 v234, v2, v146
    v_fmac_f32 v236, v10, v114
    v_fmac_f32 v234, v3, v147
    v_mfma_f32_32x32x8_bf16 v[48:63], v[84:85], v[188:189], v[48:63]
    s_setprio 0
    v_fmac_f32 v236, v11, v115
    v_fmac_f32 v234, v4, v148
    v_fmac_f32 v236, v12, v116
    v_fmac_f32 v234, v5, v149
    v_fmac_f32 v236, v13, v117
    v_fmac_f32 v234, v6, v150
    v_fmac_f32 v236, v14, v118
    v_fmac_f32 v234, v7, v151
    v_fmac_f32 v236, v15, v119
    v_mul_f32 v238, v16, v160
    v_mul_f32 v240, v24, v160
    v_fmac_f32 v238, v17, v161
    v_fmac_f32 v240, v25, v161
    v_fmac_f32 v238, v18, v162
    v_fmac_f32 v240, v26, v162
    v_fmac_f32 v238, v19, v163
    v_fmac_f32 v240, v27, v163
    v_fmac_f32 v238, v20, v164
    v_fmac_f32 v240, v28, v164
    v_fmac_f32 v238, v21, v165
    v_fmac_f32 v240, v29, v165
    v_fmac_f32 v238, v22, v166
    v_fmac_f32 v240, v30, v166
    v_fmac_f32 v238, v23, v167
    v_fmac_f32 v240, v31, v167
    v_mul_f32 v235, v32, v152
    v_mul_f32 v237, v40, v120
    v_fmac_f32 v235, v33, v153
    v_fmac_f32 v237, v41, v121
    v_fmac_f32 v235, v34, v154
    v_fmac_f32 v237, v42, v122
    v_fmac_f32 v235, v35, v155
    v_fmac_f32 v237, v43, v123
    v_fmac_f32 v235, v36, v156
    v_fmac_f32 v237, v44, v124
    v_fmac_f32 v235, v37, v157
    v_fmac_f32 v237, v45, v125
    v_fmac_f32 v235, v38, v158
    v_fmac_f32 v237, v46, v126
    v_fmac_f32 v235, v39, v159
    v_fmac_f32 v237, v47, v127
    v_mul_f32 v239, v48, v168
    v_mul_f32 v241, v56, v168
    v_fmac_f32 v239, v49, v169
    v_fmac_f32 v241, v57, v169
    s_setprio 1
    s_waitcnt vmcnt(3) lgkmcnt(0)
    v_mfma_f32_32x32x16_bf16 v[0:15], v[64:67], v[176:179], 0
    ds_read_b64_tr_b16 v[184:185], v246 offset:6144
    ds_read_b64_tr_b16 v[186:187], v246 offset:7168
    ds_read_b64_tr_b16 v[188:189], v247 offset:6144
    ds_read_b64_tr_b16 v[190:191], v247 offset:7168
    v_fmac_f32 v239, v50, v170
    v_fmac_f32 v241, v58, v170
    s_mov_b32 m0, s70
    v_mfma_f32_32x32x16_bf16 v[16:31], v[68:71], v[176:179], 0
    buffer_load_dwordx4 v224, s[4:7], s43 offen sc1 lds
    buffer_load_dwordx4 v225, s[72:75], s43 offen offset:1024 sc1 lds
    v_fmac_f32 v239, v51, v171
    v_fmac_f32 v241, v59, v171
    v_fmac_f32 v239, v52, v172
    v_fmac_f32 v241, v60, v172
    v_fmac_f32 v239, v53, v173
    v_mfma_f32_32x32x16_bf16 v[32:47], v[64:67], v[180:183], 0
    v_add_u32 v222, s48, v251
    ds_read2_b32 v[222:223], v222 offset0:1 offset1:3
    v_fmac_f32 v241, v61, v173
    v_fmac_f32 v239, v54, v174
    v_fmac_f32 v241, v62, v174
    v_fmac_f32 v239, v55, v175
    v_fmac_f32 v241, v63, v175
    v_mfma_f32_32x32x16_bf16 v[48:63], v[68:71], v[180:183], 0
    s_waitcnt vmcnt(4) lgkmcnt(1)
    v_mfma_f32_32x32x16_bf16 v[0:15], v[72:75], v[184:187], v[0:15]
    ds_read_b64_tr_b16 v[176:177], v246 offset:0
    ds_read_b64_tr_b16 v[180:181], v247 offset:0
    s_mov_b32 m0, s71
    v_mfma_f32_32x32x16_bf16 v[16:31], v[76:79], v[184:187], v[16:31]
    buffer_load_dwordx4 v226, s[4:7], s43 offen sc1 lds
    s_waitcnt lgkmcnt(2)
    v_mad_u32_u16 v222, v222, s39, v248 op_sel:[1,0,0,0]
    v_mad_u32_u16 v223, v223, s39, v248 op_sel:[1,0,0,0]
    v_mfma_f32_32x32x16_bf16 v[32:47], v[72:75], v[188:191], v[32:47]
    v_add_u32 v224, s49, v251
    ds_read2_b32 v[224:225], v224 offset0:1 offset1:3
    v_mfma_f32_32x32x16_bf16 v[48:63], v[76:79], v[188:191], v[48:63]
    s_waitcnt vmcnt(3) lgkmcnt(1)
    v_mfma_f32_32x32x8_bf16 v[0:15], v[80:81], v[176:177], v[0:15]
    ds_read_b64_tr_b16 v[184:185], v246 offset:2048
    ds_read_b64_tr_b16 v[186:187], v246 offset:3072
    ds_read_b64_tr_b16 v[188:189], v247 offset:2048
    ds_read_b64_tr_b16 v[190:191], v247 offset:3072
    s_mov_b32 m0, s68
    v_mfma_f32_32x32x8_bf16 v[16:31], v[84:85], v[176:177], v[16:31]
    buffer_load_dwordx4 v222, s[4:7], s44 offen sc1 lds
    buffer_load_dwordx4 v223, s[72:75], s44 offen offset:1024 sc1 lds
    s_waitcnt lgkmcnt(4)
    v_mad_u32_u16 v224, v224, s39, v248 op_sel:[1,0,0,0]
    v_mad_u32_u16 v225, v225, s39, v248 op_sel:[1,0,0,0]
    v_mfma_f32_32x32x8_bf16 v[32:47], v[80:81], v[180:181], v[32:47]
    v_add_u32 v226, s50, v251
    ds_read2_b32 v[226:227], v226 offset0:1 offset1:3
    v_mul_f32 v242, v0, v144
    v_fma_f32 v238, v8, v160, -v238
    v_fmac_f32 v242, v1, v145
    v_fmac_f32 v238, v9, v161
    v_fmac_f32 v242, v2, v146
    v_mfma_f32_32x32x8_bf16 v[48:63], v[84:85], v[180:181], v[48:63]
    s_setprio 0
    v_fmac_f32 v238, v10, v162
    v_fmac_f32 v242, v3, v147
    v_fmac_f32 v238, v11, v163
    v_fmac_f32 v242, v4, v148
    v_fmac_f32 v238, v12, v164
    v_fmac_f32 v242, v5, v149
    v_fmac_f32 v238, v13, v165
    v_fmac_f32 v242, v6, v150
    v_fmac_f32 v238, v14, v166
    v_fmac_f32 v242, v7, v151
    v_fmac_f32 v238, v15, v167
    v_fmac_f32 v236, v16, v112
    v_mul_f32 v244, v24, v160
    v_fmac_f32 v236, v17, v113
    v_fmac_f32 v244, v25, v161
    v_fmac_f32 v236, v18, v114
    v_fmac_f32 v244, v26, v162
    v_fmac_f32 v236, v19, v115
    v_fmac_f32 v244, v27, v163
    v_fmac_f32 v236, v20, v116
    v_fmac_f32 v244, v28, v164
    v_fmac_f32 v236, v21, v117
    v_fmac_f32 v244, v29, v165
    v_fmac_f32 v236, v22, v118
    v_fmac_f32 v244, v30, v166
    v_fmac_f32 v236, v23, v119
    v_fmac_f32 v244, v31, v167
    v_mul_f32 v243, v32, v152
    v_fma_f32 v239, v40, v168, -v239
    v_fmac_f32 v243, v33, v153
    v_fmac_f32 v239, v41, v169
    v_fmac_f32 v243, v34, v154
    v_fmac_f32 v239, v42, v170
    v_fmac_f32 v243, v35, v155
    v_fmac_f32 v239, v43, v171
    v_fmac_f32 v243, v36, v156
    v_fmac_f32 v239, v44, v172
    v_fmac_f32 v243, v37, v157
    v_fmac_f32 v239, v45, v173
    v_fmac_f32 v243, v38, v158
    v_fmac_f32 v239, v46, v174
    v_fmac_f32 v243, v39, v159
    v_fmac_f32 v239, v47, v175
    v_fmac_f32 v237, v48, v120
    v_mul_f32 v245, v56, v168
    v_fmac_f32 v237, v49, v121
    v_fmac_f32 v245, v57, v169
    v_fmac_f32 v237, v50, v122
    v_fmac_f32 v245, v58, v170
    v_fmac_f32 v237, v51, v123
    s_setprio 1
    s_waitcnt vmcnt(3) lgkmcnt(1)
    v_mfma_f32_32x32x16_bf16 v[0:15], v[64:67], v[184:187], 0
    ds_read_b64_tr_b16 v[176:177], v246 offset:4096
    ds_read_b64_tr_b16 v[178:179], v246 offset:5120
    ds_read_b64_tr_b16 v[180:181], v247 offset:4096
    ds_read_b64_tr_b16 v[182:183], v247 offset:5120
    v_fmac_f32 v245, v59, v171
    v_fmac_f32 v237, v52, v124
    s_mov_b32 m0, s69
    v_mfma_f32_32x32x16_bf16 v[16:31], v[68:71], v[184:187], 0
    buffer_load_dwordx4 v224, s[4:7], s45 offen sc1 lds
    buffer_load_dwordx4 v225, s[72:75], s45 offen offset:1024 sc1 lds
    s_waitcnt lgkmcnt(4)
    v_mad_u32_u16 v226, v226, s39, v248 op_sel:[1,0,0,0]
    v_mad_u32_u16 v227, v227, s39, v248 op_sel:[1,0,0,0]
    v_fmac_f32 v245, v60, v172
    v_fmac_f32 v237, v53, v125
    v_mfma_f32_32x32x16_bf16 v[32:47], v[64:67], v[188:191], 0
    v_add_u32 v228, s51, v251
    ds_read2_b32 v[228:229], v228 offset0:1 offset1:3
    v_fmac_f32 v245, v61, v173
    v_fmac_f32 v237, v54, v126
    v_fmac_f32 v245, v62, v174
    v_fmac_f32 v237, v55, v127
    v_fmac_f32 v245, v63, v175
    v_mfma_f32_32x32x16_bf16 v[48:63], v[68:71], v[188:191], 0
    v_permlane32_swap_b32 v242, v234
    v_permlane32_swap_b32 v243, v235
    v_add_f32 v242, v242, v234
    v_add_f32 v243, v243, v235
    s_waitcnt vmcnt(4) lgkmcnt(1)
    v_mfma_f32_32x32x16_bf16 v[0:15], v[72:75], v[176:179], v[0:15]
    ds_read_b64_tr_b16 v[184:185], v246 offset:6144
    ds_read_b64_tr_b16 v[188:189], v247 offset:6144
    v_cvt_pk_bf16_f32 v242, v242, v243
    ds_write_b32 v230, v242 offset:512
    s_mov_b32 s32, s31
    s_mov_b32 s31, s35
    s_mov_b32 m0, s70
    v_mfma_f32_32x32x16_bf16 v[16:31], v[76:79], v[176:179], v[16:31]
    buffer_load_dwordx4 v226, s[4:7], s46 offen sc1 lds
    buffer_load_dwordx4 v227, s[72:75], s46 offen offset:1024 sc1 lds
    s_waitcnt lgkmcnt(3)
    v_mad_u32_u16 v228, v228, s39, v248 op_sel:[1,0,0,0]
    v_mad_u32_u16 v229, v229, s39, v248 op_sel:[1,0,0,0]
    s_sub_u32 s26, s48, s29
    s_mov_b32 s29, s48
    v_mfma_f32_32x32x16_bf16 v[32:47], v[72:75], v[180:183], v[32:47]
    s_mov_b32 s30, s3
    s_bfe_u32 s56, s3, 0x40012
    s_cmp_lg_u32 s36, 0
    s_cselect_b32 s56, s56, 0
    v_mfma_f32_32x32x16_bf16 v[48:63], v[76:79], v[180:183], v[48:63]
    s_waitcnt vmcnt(4) lgkmcnt(1)
    v_mfma_f32_32x32x8_bf16 v[0:15], v[80:81], v[184:185], v[0:15]
    ds_read_b64_tr_b16 v[176:177], v246 offset:0
    ds_read_b64_tr_b16 v[178:179], v246 offset:1024
    ds_read_b64_tr_b16 v[180:181], v247 offset:0
    ds_read_b64_tr_b16 v[182:183], v247 offset:1024
    s_mov_b32 m0, s71
    v_mfma_f32_32x32x8_bf16 v[16:31], v[84:85], v[184:185], v[16:31]
    buffer_load_dwordx4 v228, s[4:7], s47 offen sc1 lds
    buffer_load_dwordx4 v229, s[72:75], s47 offen offset:1024 sc1 lds
    v_mfma_f32_32x32x8_bf16 v[32:47], v[80:81], v[188:189], v[32:47]
    s_nop 2
    v_mul_f32 v242, v0, v144
    v_fma_f32 v240, v8, v160, -v240
    v_fmac_f32 v242, v1, v145
    v_fmac_f32 v240, v9, v161
    v_fmac_f32 v242, v2, v146
    v_fmac_f32 v240, v10, v162
    v_fmac_f32 v242, v3, v147
    v_mfma_f32_32x32x8_bf16 v[48:63], v[84:85], v[188:189], v[48:63]
    s_setprio 0
    v_fmac_f32 v240, v11, v163
    v_fmac_f32 v242, v4, v148
    v_fmac_f32 v240, v12, v164
    v_fmac_f32 v242, v5, v149
    v_fmac_f32 v240, v13, v165
    v_fmac_f32 v242, v6, v150
    v_fmac_f32 v240, v14, v166
    v_fmac_f32 v242, v7, v151
    v_fmac_f32 v240, v15, v167
    v_add_u32 v249, s26, v249
    v_add_u32 v250, s26, v250
    v_fma_f32 v244, v16, v160, -v244
    v_fmac_f32 v236, v24, v112
    v_fmac_f32 v244, v17, v161
    v_fmac_f32 v236, v25, v113
    v_fmac_f32 v244, v18, v162
    v_fmac_f32 v236, v26, v114
    v_fmac_f32 v244, v19, v163
    v_fmac_f32 v236, v27, v115
    v_fmac_f32 v244, v20, v164
    v_fmac_f32 v236, v28, v116
    v_fmac_f32 v244, v21, v165
    v_fmac_f32 v236, v29, v117
    v_fmac_f32 v244, v22, v166
    v_fmac_f32 v236, v30, v118
    v_fmac_f32 v244, v23, v167
    v_fmac_f32 v236, v31, v119
    ds_read_b64_tr_b16 v[0:1], v249 offset:0
    ds_read_b64_tr_b16 v[2:3], v249 offset:32
    ds_read_u16_d16_hi v16, v250 offset:0
    v_mul_f32 v243, v32, v152
    v_fma_f32 v241, v40, v168, -v241
    v_fmac_f32 v243, v33, v153
    v_fmac_f32 v241, v41, v169
    v_fmac_f32 v243, v34, v154
    v_fmac_f32 v241, v42, v170
    v_fmac_f32 v243, v35, v155
    v_fmac_f32 v241, v43, v171
    v_fmac_f32 v243, v36, v156
    v_fmac_f32 v241, v44, v172
    v_fmac_f32 v243, v37, v157
    v_fmac_f32 v241, v45, v173
    v_fmac_f32 v243, v38, v158
    v_fmac_f32 v241, v46, v174
    v_fmac_f32 v243, v39, v159
    v_fmac_f32 v241, v47, v175
    ds_read_b64_tr_b16 v[4:5], v249 offset:512
    ds_read_b64_tr_b16 v[6:7], v249 offset:544
    ds_read_u16_d16_hi v17, v250 offset:128
    v_fma_f32 v245, v48, v168, -v245
    v_fmac_f32 v237, v56, v120
    v_fmac_f32 v245, v49, v169
    v_fmac_f32 v237, v57, v121
    v_fmac_f32 v245, v50, v170
    v_fmac_f32 v237, v58, v122
    v_fmac_f32 v245, v51, v171
    v_fmac_f32 v237, v59, v123
    v_fmac_f32 v245, v52, v172
    v_fmac_f32 v237, v60, v124
    v_fmac_f32 v245, v53, v173
    v_fmac_f32 v237, v61, v125
    v_fmac_f32 v245, v54, v174
    v_fmac_f32 v237, v62, v126
    v_fmac_f32 v245, v55, v175
    v_fmac_f32 v237, v63, v127
    s_cmp_eq_u32 s56, 5
    s_cbranch_scc1 K2_U21
    s_cmp_eq_u32 s56, 6
    s_cbranch_scc1 K2_U3h1
    s_branch K2_DSP1
K2_U31:
    s_setprio 1
    ds_read_b64_tr_b16 v[8:9], v249 offset:1024
    ds_read_b64_tr_b16 v[10:11], v249 offset:1056
    ds_read_u16_d16_hi v18, v250 offset:256
    s_waitcnt lgkmcnt(3)
    v_lshlrev_b32 v20, 16, v0
    v_and_b32 v21, 0xffff0000, v0
    v_lshlrev_b32 v22, 16, v1
    v_and_b32 v23, 0xffff0000, v1
    v_lshlrev_b32 v24, 16, v2
    v_and_b32 v25, 0xffff0000, v2
    v_lshlrev_b32 v26, 16, v3
    v_and_b32 v27, 0xffff0000, v3
    v_mul_f32_dpp v36, v16, v20 row_newbcast:8 row_mask:0xf bank_mask:0xf
    v_mul_f32_dpp v37, v16, v21 row_newbcast:9 row_mask:0xf bank_mask:0xf
    v_mul_f32_dpp v38, v16, v22 row_newbcast:10 row_mask:0xf bank_mask:0xf
    v_mul_f32_dpp v39, v16, v23 row_newbcast:11 row_mask:0xf bank_mask:0xf
    v_mul_f32_dpp v40, v16, v24 row_newbcast:12 row_mask:0xf bank_mask:0xf
    v_mul_f32_dpp v41, v16, v25 row_newbcast:13 row_mask:0xf bank_mask:0xf
    v_mul_f32_dpp v42, v16, v26 row_newbcast:14 row_mask:0xf bank_mask:0xf
    v_mul_f32_dpp v43, v16, v27 row_newbcast:15 row_mask:0xf bank_mask:0xf
    v_cvt_pk_bf16_f32 v68, v36, v37
    v_cvt_pk_bf16_f32 v69, v38, v39
    v_cvt_pk_bf16_f32 v70, v40, v41
    v_cvt_pk_bf16_f32 v71, v42, v43
    v_mul_f32_dpp v20, v16, v20 row_newbcast:0 row_mask:0xa bank_mask:0xf
    v_mul_f32_dpp v21, v16, v21 row_newbcast:1 row_mask:0xa bank_mask:0xf
    v_mul_f32_dpp v22, v16, v22 row_newbcast:2 row_mask:0xa bank_mask:0xf
    v_mul_f32_dpp v23, v16, v23 row_newbcast:3 row_mask:0xa bank_mask:0xf
    v_mul_f32_dpp v24, v16, v24 row_newbcast:4 row_mask:0xa bank_mask:0xf
    v_mul_f32_dpp v25, v16, v25 row_newbcast:5 row_mask:0xa bank_mask:0xf
    v_mul_f32_dpp v26, v16, v26 row_newbcast:6 row_mask:0xa bank_mask:0xf
    v_mul_f32_dpp v27, v16, v27 row_newbcast:7 row_mask:0xa bank_mask:0xf
    v_cvt_pk_bf16_f32 v64, v20, v21
    v_cvt_pk_bf16_f32 v65, v22, v23
    v_cvt_pk_bf16_f32 v66, v24, v25
    v_cvt_pk_bf16_f32 v67, v26, v27
    v_lshlrev_b32 v28, 16, v4
    v_and_b32 v29, 0xffff0000, v4
    v_lshlrev_b32 v30, 16, v5
    v_and_b32 v31, 0xffff0000, v5
    v_lshlrev_b32 v32, 16, v6
    v_and_b32 v33, 0xffff0000, v6
    v_lshlrev_b32 v34, 16, v7
    v_and_b32 v35, 0xffff0000, v7
    v_mul_f32_dpp v36, v17, v28 row_newbcast:8 row_mask:0xf bank_mask:0xf
    v_mul_f32_dpp v37, v17, v29 row_newbcast:9 row_mask:0xf bank_mask:0xf
    v_mul_f32_dpp v38, v17, v30 row_newbcast:10 row_mask:0xf bank_mask:0xf
    v_mul_f32_dpp v39, v17, v31 row_newbcast:11 row_mask:0xf bank_mask:0xf
    v_mul_f32_dpp v40, v17, v32 row_newbcast:12 row_mask:0xf bank_mask:0xf
    v_mul_f32_dpp v41, v17, v33 row_newbcast:13 row_mask:0xf bank_mask:0xf
    v_mul_f32_dpp v42, v17, v34 row_newbcast:14 row_mask:0xf bank_mask:0xf
    v_mul_f32_dpp v43, v17, v35 row_newbcast:15 row_mask:0xf bank_mask:0xf
    v_cvt_pk_bf16_f32 v76, v36, v37
    v_cvt_pk_bf16_f32 v77, v38, v39
    v_cvt_pk_bf16_f32 v78, v40, v41
    v_cvt_pk_bf16_f32 v79, v42, v43
    v_mul_f32_dpp v28, v17, v28 row_newbcast:0 row_mask:0xa bank_mask:0xf
    v_mul_f32_dpp v29, v17, v29 row_newbcast:1 row_mask:0xa bank_mask:0xf
    v_mul_f32_dpp v30, v17, v30 row_newbcast:2 row_mask:0xa bank_mask:0xf
    v_mul_f32_dpp v31, v17, v31 row_newbcast:3 row_mask:0xa bank_mask:0xf
    v_mul_f32_dpp v32, v17, v32 row_newbcast:4 row_mask:0xa bank_mask:0xf
    v_mul_f32_dpp v33, v17, v33 row_newbcast:5 row_mask:0xa bank_mask:0xf
    v_mul_f32_dpp v34, v17, v34 row_newbcast:6 row_mask:0xa bank_mask:0xf
    v_mul_f32_dpp v35, v17, v35 row_newbcast:7 row_mask:0xa bank_mask:0xf
    v_cvt_pk_bf16_f32 v72, v28, v29
    v_cvt_pk_bf16_f32 v73, v30, v31
    v_cvt_pk_bf16_f32 v74, v32, v33
    v_cvt_pk_bf16_f32 v75, v34, v35
    s_waitcnt lgkmcnt(0)
    v_lshlrev_b32 v20, 16, v8
    v_and_b32 v21, 0xffff0000, v8
    v_lshlrev_b32 v22, 16, v9
    v_and_b32 v23, 0xffff0000, v9
    v_lshlrev_b32 v24, 16, v10
    v_and_b32 v25, 0xffff0000, v10
    v_lshlrev_b32 v26, 16, v11
    v_and_b32 v27, 0xffff0000, v11
    v_mul_f32_dpp v36, v18, v20 row_newbcast:8 row_mask:0xf bank_mask:0xf
    v_mul_f32_dpp v37, v18, v21 row_newbcast:9 row_mask:0xf bank_mask:0xf
    v_mul_f32_dpp v38, v18, v22 row_newbcast:10 row_mask:0xf bank_mask:0xf
    v_mul_f32_dpp v39, v18, v23 row_newbcast:11 row_mask:0xf bank_mask:0xf
    v_mul_f32_dpp v40, v18, v24 row_newbcast:12 row_mask:0xf bank_mask:0xf
    v_mul_f32_dpp v41, v18, v25 row_newbcast:13 row_mask:0xf bank_mask:0xf
    v_mul_f32_dpp v42, v18, v26 row_newbcast:14 row_mask:0xf bank_mask:0xf
    v_mul_f32_dpp v43, v18, v27 row_newbcast:15 row_mask:0xf bank_mask:0xf
    v_cvt_pk_bf16_f32 v84, v36, v37
    v_cvt_pk_bf16_f32 v85, v38, v39
    v_cvt_pk_bf16_f32 v86, v40, v41
    v_cvt_pk_bf16_f32 v87, v42, v43
    v_mul_f32_dpp v20, v18, v20 row_newbcast:0 row_mask:0xa bank_mask:0xf
    v_mul_f32_dpp v21, v18, v21 row_newbcast:1 row_mask:0xa bank_mask:0xf
    v_mul_f32_dpp v22, v18, v22 row_newbcast:2 row_mask:0xa bank_mask:0xf
    v_mul_f32_dpp v23, v18, v23 row_newbcast:3 row_mask:0xa bank_mask:0xf
    v_mul_f32_dpp v24, v18, v24 row_newbcast:4 row_mask:0xa bank_mask:0xf
    v_mul_f32_dpp v25, v18, v25 row_newbcast:5 row_mask:0xa bank_mask:0xf
    v_mul_f32_dpp v26, v18, v26 row_newbcast:6 row_mask:0xa bank_mask:0xf
    v_mul_f32_dpp v27, v18, v27 row_newbcast:7 row_mask:0xa bank_mask:0xf
    v_cvt_pk_bf16_f32 v80, v20, v21
    v_cvt_pk_bf16_f32 v81, v22, v23
    v_cvt_pk_bf16_f32 v82, v24, v25
    v_cvt_pk_bf16_f32 v83, v26, v27
    s_waitcnt vmcnt(4)
    v_mfma_f32_32x32x16_bf16 v[0:15], v[64:67], v[176:179], 0
    ds_read_b64_tr_b16 v[184:185], v246 offset:2048
    ds_read_b64_tr_b16 v[186:187], v246 offset:3072
    ds_read_b64_tr_b16 v[188:189], v247 offset:2048
    ds_read_b64_tr_b16 v[190:191], v247 offset:3072
    s_mov_b32 m0, s68
    v_mfma_f32_32x32x16_bf16 v[16:31], v[68:71], v[176:179], 0
    buffer_load_dwordx4 v224, s[4:7], s41 offen sc1 lds
    buffer_load_dwordx4 v225, s[72:75], s41 offen offset:1024 sc1 lds
    v_permlane32_swap_b32 v242, v236
    v_permlane32_swap_b32 v243, v237
    v_mov_b32 v254, 163296
    v_mfma_f32_32x32x16_bf16 v[32:47], v[64:67], v[180:183], 0
    v_permlane32_swap_b32 v244, v238
    v_permlane32_swap_b32 v245, v239
    v_permlane32_swap_b32 v240, v241
    v_add_f32 v242, v242, v236
    v_mfma_f32_32x32x16_bf16 v[48:63], v[68:71], v[180:183], 0
    v_add_f32 v243, v243, v237
    v_add_f32 v244, v244, v238
    v_add_f32 v245, v245, v239
    v_add_f32 v240, -v240, -v241
    v_sub_u32 v241, v230, v231
    v_cvt_pk_bf16_f32 v242, v242, v243
    v_mov_b32 v255, 1
    v_lshl_add_u32 v233, v252, 1, s53
    s_mov_b64 exec, 1
    ds_add_rtn_u32 v232, v254, v255
    s_mov_b64 exec, -1
    ds_read_b32 v233, v233
    s_waitcnt vmcnt(4) lgkmcnt(2)
    v_mfma_f32_32x32x16_bf16 v[0:15], v[72:75], v[184:187], v[0:15]
    ds_read_b64_tr_b16 v[176:177], v246 offset:4096
    ds_read_b64_tr_b16 v[178:179], v246 offset:5120
    ds_read_b64_tr_b16 v[180:181], v247 offset:4096
    ds_read_b64_tr_b16 v[182:183], v247 offset:5120
    v_cvt_pk_bf16_f32 v244, v244, v245
    v_cvt_pk_bf16_f32 v240, v240, v240
    s_mov_b32 m0, s69
    v_mfma_f32_32x32x16_bf16 v[16:31], v[76:79], v[184:187], v[16:31]
    buffer_load_dwordx4 v226, s[4:7], s41 offen sc1 lds
    buffer_load_dwordx4 v227, s[72:75], s41 offen offset:1024 sc1 lds
    ds_write_b32 v230, v242 offset:768
    ds_write_b32 v230, v244 offset:1024
    ds_write_b16 v241, v240 offset:1280
    s_waitcnt lgkmcnt(7)
    v_readfirstlane_b32 s58, v232
    v_mfma_f32_32x32x16_bf16 v[32:47], v[72:75], v[188:191], v[32:47]
    s_cmp_lt_u32 s58, s22
    s_cbranch_scc0 K2_nul_61
    s_and_b32 s59, s58, 7
    s_lshr_b32 s60, s58, 3
K2_chk_63:
    v_readlane_b32 s61, v233, s59
    s_nop 0
    s_cmp_gt_u32 s61, s60
    s_cbranch_scc0 K2_spin_62
K2_back_64:
    v_mfma_f32_32x32x16_bf16 v[48:63], v[76:79], v[188:191], v[48:63]
    v_readlane_b32 s3, v253, s58
    s_lshl_b32 s44, s34, 7
    s_and_b32 s48, s3, 0x3ffff
    s_bfe_u32 s33, s3, 0x30013
    s_mov_b32 s35, s48
    s_mov_b32 s45, s44
    s_waitcnt vmcnt(4) lgkmcnt(3)
    v_mfma_f32_32x32x16_bf16 v[0:15], v[80:83], v[176:179], v[0:15]
    ds_read_b64_tr_b16 v[184:185], v246 offset:6144
    ds_read_b64_tr_b16 v[186:187], v246 offset:7168
    ds_read_b64_tr_b16 v[188:189], v247 offset:6144
    ds_read_b64_tr_b16 v[190:191], v247 offset:7168
    s_xor_b32 s47, s44, 256
    s_add_u32 s49, s48, 128
    s_mov_b32 m0, s70
    v_mfma_f32_32x32x16_bf16 v[16:31], v[84:87], v[176:179], v[16:31]
    buffer_load_dwordx4 v222, s[4:7], s42 offen sc1 lds
    buffer_load_dwordx4 v223, s[72:75], s42 offen offset:1024 sc1 lds
    s_add_u32 s60, s48, 256
    s_cmp_eq_u32 s33, 3
    s_cselect_b32 s46, s44, s47
    s_cselect_b32 s50, s60, s48
    s_cselect_b32 s51, s48, s49
    v_mfma_f32_32x32x16_bf16 v[32:47], v[80:83], v[180:183], v[32:47]
    s_sub_u32 s60, s33, 2
    s_cmp_lt_u32 s60, 2
    s_cbranch_scc0 K2_rare_65
K2_back_66:
    v_mul_f32 v234, v0, v96
    v_mul_f32 v236, v8, v128
    v_fmac_f32 v234, v1, v97
    v_fmac_f32 v236, v9, v129
    v_mfma_f32_32x32x16_bf16 v[48:63], v[84:87], v[180:183], v[48:63]
    s_setprio 0
    v_fmac_f32 v234, v2, v98
    v_fmac_f32 v236, v10, v130
    v_fmac_f32 v234, v3, v99
    v_fmac_f32 v236, v11, v131
    v_fmac_f32 v234, v4, v100
    v_fmac_f32 v236, v12, v132
    v_fmac_f32 v234, v5, v101
    v_fmac_f32 v236, v13, v133
    v_fmac_f32 v234, v6, v102
    v_fmac_f32 v236, v14, v134
    v_fmac_f32 v234, v7, v103
    v_fmac_f32 v236, v15, v135
    v_mul_f32 v238, v16, v128
    v_mul_f32 v240, v24, v128
    v_fmac_f32 v238, v17, v129
    v_fmac_f32 v240, v25, v129
    v_fmac_f32 v238, v18, v130
    v_fmac_f32 v240, v26, v130
    v_fmac_f32 v238, v19, v131
    v_fmac_f32 v240, v27, v131
    v_fmac_f32 v238, v20, v132
    v_fmac_f32 v240, v28, v132
    v_fmac_f32 v238, v21, v133
    v_fmac_f32 v240, v29, v133
    v_fmac_f32 v238, v22, v134
    v_fmac_f32 v240, v30, v134
    v_fmac_f32 v238, v23, v135
    v_fmac_f32 v240, v31, v135
    v_mul_f32 v235, v32, v104
    v_mul_f32 v237, v40, v136
    v_fmac_f32 v235, v33, v105
    v_fmac_f32 v237, v41, v137
    v_fmac_f32 v235, v34, v106
    v_fmac_f32 v237, v42, v138
    v_fmac_f32 v235, v35, v107
    v_fmac_f32 v237, v43, v139
    v_fmac_f32 v235, v36, v108
    v_fmac_f32 v237, v44, v140
    v_fmac_f32 v235, v37, v109
    v_fmac_f32 v237, v45, v141
    v_fmac_f32 v235, v38, v110
    v_fmac_f32 v237, v46, v142
    v_fmac_f32 v235, v39, v111
    v_fmac_f32 v237, v47, v143
    v_mul_f32 v239, v48, v136
    v_mul_f32 v241, v56, v136
    s_setprio 1
    s_waitcnt vmcnt(4) lgkmcnt(0)
    v_mfma_f32_32x32x16_bf16 v[0:15], v[64:67], v[184:187], 0
    ds_read_b64_tr_b16 v[176:177], v246 offset:0
    ds_read_b64_tr_b16 v[178:179], v246 offset:1024
    ds_read_b64_tr_b16 v[180:181], v247 offset:0
    ds_read_b64_tr_b16 v[182:183], v247 offset:1024
    v_fmac_f32 v239, v49, v137
    v_fmac_f32 v241, v57, v137
    s_mov_b32 m0, s71
    v_mfma_f32_32x32x16_bf16 v[16:31], v[68:71], v[184:187], 0
    buffer_load_dwordx4 v224, s[4:7], s42 offen sc1 lds
    buffer_load_dwordx4 v225, s[72:75], s42 offen offset:1024 sc1 lds
    v_fmac_f32 v239, v50, v138
    v_fmac_f32 v241, v58, v138
    v_fmac_f32 v239, v51, v139
    v_fmac_f32 v241, v59, v139
    v_fmac_f32 v239, v52, v140
    v_mfma_f32_32x32x16_bf16 v[32:47], v[64:67], v[188:191], 0
    v_fmac_f32 v241, v60, v140
    v_fmac_f32 v239, v53, v141
    v_fmac_f32 v241, v61, v141
    v_fmac_f32 v239, v54, v142
    v_fmac_f32 v241, v62, v142
    v_fmac_f32 v239, v55, v143
    v_fmac_f32 v241, v63, v143
    v_mfma_f32_32x32x16_bf16 v[48:63], v[68:71], v[188:191], 0
    v_permlane32_swap_b32 v234, v236
    v_permlane32_swap_b32 v235, v237
    v_permlane32_swap_b32 v240, v238
    s_waitcnt vmcnt(4) lgkmcnt(0)
    v_mfma_f32_32x32x16_bf16 v[0:15], v[72:75], v[176:179], v[0:15]
    ds_read_b64_tr_b16 v[184:185], v246 offset:2048
    ds_read_b64_tr_b16 v[186:187], v246 offset:3072
    ds_read_b64_tr_b16 v[188:189], v247 offset:2048
    ds_read_b64_tr_b16 v[190:191], v247 offset:3072
    v_permlane32_swap_b32 v241, v239
    s_mov_b32 m0, s68
    v_mfma_f32_32x32x16_bf16 v[16:31], v[76:79], v[176:179], v[16:31]
    buffer_load_dwordx4 v226, s[4:7], s42 offen sc1 lds
    buffer_load_dwordx4 v227, s[72:75], s42 offen offset:1024 sc1 lds
    v_lshl_add_u32 v230, v252, 1, s31
    v_add_f32 v234, v234, v236
    v_add_f32 v235, v235, v237
    v_add_f32 v240, v240, v238
    v_add_f32 v241, v241, v239
    v_mfma_f32_32x32x16_bf16 v[32:47], v[72:75], v[180:183], v[32:47]
    v_cvt_pk_bf16_f32 v234, v234, v235
    v_cvt_pk_bf16_f32 v240, v240, v241
    ds_write_b32 v230, v234 offset:0
    ds_write_b32 v230, v240 offset:256
    v_mfma_f32_32x32x16_bf16 v[48:63], v[76:79], v[180:183], v[48:63]
    s_waitcnt vmcnt(4) lgkmcnt(2)
    v_mfma_f32_32x32x16_bf16 v[0:15], v[80:83], v[184:187], v[0:15]
    ds_read_b64_tr_b16 v[176:177], v246 offset:4096
    ds_read_b64_tr_b16 v[178:179], v246 offset:5120
    ds_read_b64_tr_b16 v[180:181], v247 offset:4096
    ds_read_b64_tr_b16 v[182:183], v247 offset:5120
    s_mov_b32 m0, s69
    v_mfma_f32_32x32x16_bf16 v[16:31], v[84:87], v[184:187], v[16:31]
    buffer_load_dwordx4 v222, s[4:7], s43 offen sc1 lds
    buffer_load_dwordx4 v223, s[72:75], s43 offen offset:1024 sc1 lds
    v_mfma_f32_32x32x16_bf16 v[32:47], v[80:83], v[188:191], v[32:47]
    s_nop 2
    v_mul_f32 v234, v0, v144
    v_mul_f32 v236, v8, v112
    v_fmac_f32 v234, v1, v145
    v_fmac_f32 v236, v9, v113
    v_fmac_f32 v234, v2, v146
    v_fmac_f32 v236, v10, v114
    v_fmac_f32 v234, v3, v147
    v_mfma_f32_32x32x16_bf16 v[48:63], v[84:87], v[188:191], v[48:63]
    s_setprio 0
    v_fmac_f32 v236, v11, v115
    v_fmac_f32 v234, v4, v148
    v_fmac_f32 v236, v12, v116
    v_fmac_f32 v234, v5, v149
    v_fmac_f32 v236, v13, v117
    v_fmac_f32 v234, v6, v150
    v_fmac_f32 v236, v14, v118
    v_fmac_f32 v234, v7, v151
    v_fmac_f32 v236, v15, v119
    v_mul_f32 v238, v16, v160
    v_mul_f32 v240, v24, v160
    v_fmac_f32 v238, v17, v161
    v_fmac_f32 v240, v25, v161
    v_fmac_f32 v238, v18, v162
    v_fmac_f32 v240, v26, v162
    v_fmac_f32 v238, v19, v163
    v_fmac_f32 v240, v27, v163
    v_fmac_f32 v238, v20, v164
    v_fmac_f32 v240, v28, v164
    v_fmac_f32 v238, v21, v165
    v_fmac_f32 v240, v29, v165
    v_fmac_f32 v238, v22, v166
    v_fmac_f32 v240, v30, v166
    v_fmac_f32 v238, v23, v167
    v_fmac_f32 v240, v31, v167
    v_mul_f32 v235, v32, v152
    v_mul_f32 v237, v40, v120
    v_fmac_f32 v235, v33, v153
    v_fmac_f32 v237, v41, v121
    v_fmac_f32 v235, v34, v154
    v_fmac_f32 v237, v42, v122
    v_fmac_f32 v235, v35, v155
    v_fmac_f32 v237, v43, v123
    v_fmac_f32 v235, v36, v156
    v_fmac_f32 v237, v44, v124
    v_fmac_f32 v235, v37, v157
    v_fmac_f32 v237, v45, v125
    v_fmac_f32 v235, v38, v158
    v_fmac_f32 v237, v46, v126
    v_fmac_f32 v235, v39, v159
    v_fmac_f32 v237, v47, v127
    v_mul_f32 v239, v48, v168
    v_mul_f32 v241, v56, v168
    v_fmac_f32 v239, v49, v169
    v_fmac_f32 v241, v57, v169
    s_setprio 1
    s_waitcnt vmcnt(4) lgkmcnt(0)
    v_mfma_f32_32x32x16_bf16 v[0:15], v[64:67], v[176:179], 0
    ds_read_b64_tr_b16 v[184:185], v246 offset:6144
    ds_read_b64_tr_b16 v[186:187], v246 offset:7168
    ds_read_b64_tr_b16 v[188:189], v247 offset:6144
    ds_read_b64_tr_b16 v[190:191], v247 offset:7168
    v_fmac_f32 v239, v50, v170
    v_fmac_f32 v241, v58, v170
    s_mov_b32 m0, s70
    v_mfma_f32_32x32x16_bf16 v[16:31], v[68:71], v[176:179], 0
    buffer_load_dwordx4 v224, s[4:7], s43 offen sc1 lds
    buffer_load_dwordx4 v225, s[72:75], s43 offen offset:1024 sc1 lds
    v_fmac_f32 v239, v51, v171
    v_fmac_f32 v241, v59, v171
    v_fmac_f32 v239, v52, v172
    v_fmac_f32 v241, v60, v172
    v_fmac_f32 v239, v53, v173
    v_mfma_f32_32x32x16_bf16 v[32:47], v[64:67], v[180:183], 0
    v_add_u32 v222, s48, v251
    ds_read2_b32 v[222:223], v222 offset0:1 offset1:3
    v_fmac_f32 v241, v61, v173
    v_fmac_f32 v239, v54, v174
    v_fmac_f32 v241, v62, v174
    v_fmac_f32 v239, v55, v175
    v_fmac_f32 v241, v63, v175
    v_mfma_f32_32x32x16_bf16 v[48:63], v[68:71], v[180:183], 0
    s_waitcnt vmcnt(4) lgkmcnt(1)
    v_mfma_f32_32x32x16_bf16 v[0:15], v[72:75], v[184:187], v[0:15]
    ds_read_b64_tr_b16 v[176:177], v246 offset:0
    ds_read_b64_tr_b16 v[178:179], v246 offset:1024
    ds_read_b64_tr_b16 v[180:181], v247 offset:0
    ds_read_b64_tr_b16 v[182:183], v247 offset:1024
    s_mov_b32 m0, s71
    v_mfma_f32_32x32x16_bf16 v[16:31], v[76:79], v[184:187], v[16:31]
    buffer_load_dwordx4 v226, s[4:7], s43 offen sc1 lds
    buffer_load_dwordx4 v227, s[72:75], s43 offen offset:1024 sc1 lds
    s_waitcnt lgkmcnt(4)
    v_mad_u32_u16 v222, v222, s39, v248 op_sel:[1,0,0,0]
    v_mad_u32_u16 v223, v223, s39, v248 op_sel:[1,0,0,0]
    v_mfma_f32_32x32x16_bf16 v[32:47], v[72:75], v[188:191], v[32:47]
    v_add_u32 v224, s49, v251
    ds_read2_b32 v[224:225], v224 offset0:1 offset1:3
    v_mfma_f32_32x32x16_bf16 v[48:63], v[76:79], v[188:191], v[48:63]
    s_waitcnt vmcnt(4) lgkmcnt(1)
    v_mfma_f32_32x32x16_bf16 v[0:15], v[80:83], v[176:179], v[0:15]
    ds_read_b64_tr_b16 v[184:185], v246 offset:2048
    ds_read_b64_tr_b16 v[186:187], v246 offset:3072
    ds_read_b64_tr_b16 v[188:189], v247 offset:2048
    ds_read_b64_tr_b16 v[190:191], v247 offset:3072
    s_mov_b32 m0, s68
    v_mfma_f32_32x32x16_bf16 v[16:31], v[84:87], v[176:179], v[16:31]
    buffer_load_dwordx4 v222, s[4:7], s44 offen sc1 lds
    buffer_load_dwordx4 v223, s[72:75], s44 offen offset:1024 sc1 lds
    s_waitcnt lgkmcnt(4)
    v_mad_u32_u16 v224, v224, s39, v248 op_sel:[1,0,0,0]
    v_mad_u32_u16 v225, v225, s39, v248 op_sel:[1,0,0,0]
    v_mfma_f32_32x32x16_bf16 v[32:47], v[80:83], v[180:183], v[32:47]
    v_add_u32 v226, s50, v251
    ds_read2_b32 v[226:227], v226 offset0:1 offset1:3
    v_mul_f32 v242, v0, v144
    v_fma_f32 v238, v8, v160, -v238
    v_fmac_f32 v242, v1, v145
    v_fmac_f32 v238, v9, v161
    v_fmac_f32 v242, v2, v146
    v_mfma_f32_32x32x16_bf16 v[48:63], v[84:87], v[180:183], v[48:63]
    s_setprio 0
    v_fmac_f32 v238, v10, v162
    v_fmac_f32 v242, v3, v147
    v_fmac_f32 v238, v11, v163
    v_fmac_f32 v242, v4, v148
    v_fmac_f32 v238, v12, v164
    v_fmac_f32 v242, v5, v149
    v_fmac_f32 v238, v13, v165
    v_fmac_f32 v242, v6, v150
    v_fmac_f32 v238, v14, v166
    v_fmac_f32 v242, v7, v151
    v_fmac_f32 v238, v15, v167
    v_fmac_f32 v236, v16, v112
    v_mul_f32 v244, v24, v160
    v_fmac_f32 v236, v17, v113
    v_fmac_f32 v244, v25, v161
    v_fmac_f32 v236, v18, v114
    v_fmac_f32 v244, v26, v162
    v_fmac_f32 v236, v19, v115
    v_fmac_f32 v244, v27, v163
    v_fmac_f32 v236, v20, v116
    v_fmac_f32 v244, v28, v164
    v_fmac_f32 v236, v21, v117
    v_fmac_f32 v244, v29, v165
    v_fmac_f32 v236, v22, v118
    v_fmac_f32 v244, v30, v166
    v_fmac_f32 v236, v23, v119
    v_fmac_f32 v244, v31, v167
    v_mul_f32 v243, v32, v152
    v_fma_f32 v239, v40, v168, -v239
    v_fmac_f32 v243, v33, v153
    v_fmac_f32 v239, v41, v169
    v_fmac_f32 v243, v34, v154
    v_fmac_f32 v239, v42, v170
    v_fmac_f32 v243, v35, v155
    v_fmac_f32 v239, v43, v171
    v_fmac_f32 v243, v36, v156
    v_fmac_f32 v239, v44, v172
    v_fmac_f32 v243, v37, v157
    v_fmac_f32 v239, v45, v173
    v_fmac_f32 v243, v38, v158
    v_fmac_f32 v239, v46, v174
    v_fmac_f32 v243, v39, v159
    v_fmac_f32 v239, v47, v175
    v_fmac_f32 v237, v48, v120
    v_mul_f32 v245, v56, v168
    v_fmac_f32 v237, v49, v121
    v_fmac_f32 v245, v57, v169
    v_fmac_f32 v237, v50, v122
    v_fmac_f32 v245, v58, v170
    v_fmac_f32 v237, v51, v123
    s_setprio 1
    s_waitcnt vmcnt(4) lgkmcnt(1)
    v_mfma_f32_32x32x16_bf16 v[0:15], v[64:67], v[184:187], 0
    ds_read_b64_tr_b16 v[176:177], v246 offset:4096
    ds_read_b64_tr_b16 v[178:179], v246 offset:5120
    ds_read_b64_tr_b16 v[180:181], v247 offset:4096
    ds_read_b64_tr_b16 v[182:183], v247 offset:5120
    v_fmac_f32 v245, v59, v171
    v_fmac_f32 v237, v52, v124
    s_mov_b32 m0, s69
    v_mfma_f32_32x32x16_bf16 v[16:31], v[68:71], v[184:187], 0
    buffer_load_dwordx4 v224, s[4:7], s45 offen sc1 lds
    buffer_load_dwordx4 v225, s[72:75], s45 offen offset:1024 sc1 lds
    s_waitcnt lgkmcnt(4)
    v_mad_u32_u16 v226, v226, s39, v248 op_sel:[1,0,0,0]
    v_mad_u32_u16 v227, v227, s39, v248 op_sel:[1,0,0,0]
    v_fmac_f32 v245, v60, v172
    v_fmac_f32 v237, v53, v125
    v_mfma_f32_32x32x16_bf16 v[32:47], v[64:67], v[188:191], 0
    v_add_u32 v228, s51, v251
    ds_read2_b32 v[228:229], v228 offset0:1 offset1:3
    v_fmac_f32 v245, v61, v173
    v_fmac_f32 v237, v54, v126
    v_fmac_f32 v245, v62, v174
    v_fmac_f32 v237, v55, v127
    v_fmac_f32 v245, v63, v175
    v_mfma_f32_32x32x16_bf16 v[48:63], v[68:71], v[188:191], 0
    v_permlane32_swap_b32 v242, v234
    v_permlane32_swap_b32 v243, v235
    v_add_f32 v242, v242, v234
    v_add_f32 v243, v243, v235
    s_waitcnt vmcnt(4) lgkmcnt(1)
    v_mfma_f32_32x32x16_bf16 v[0:15], v[72:75], v[176:179], v[0:15]
    ds_read_b64_tr_b16 v[184:185], v246 offset:6144
    ds_read_b64_tr_b16 v[186:187], v246 offset:7168
    ds_read_b64_tr_b16 v[188:189], v247 offset:6144
    ds_read_b64_tr_b16 v[190:191], v247 offset:7168
    v_cvt_pk_bf16_f32 v242, v242, v243
    ds_write_b32 v230, v242 offset:512
    s_mov_b32 m0, s70
    v_mfma_f32_32x32x16_bf16 v[16:31], v[76:79], v[176:179], v[16:31]
    buffer_load_dwordx4 v226, s[4:7], s46 offen sc1 lds
    buffer_load_dwordx4 v227, s[72:75], s46 offen offset:1024 sc1 lds
    s_waitcnt lgkmcnt(5)
    v_mad_u32_u16 v228, v228, s39, v248 op_sel:[1,0,0,0]
    v_mad_u32_u16 v229, v229, s39, v248 op_sel:[1,0,0,0]
    s_sub_u32 s26, s48, s29
    s_mov_b32 s29, s48
    v_mfma_f32_32x32x16_bf16 v[32:47], v[72:75], v[180:183], v[32:47]
    s_mov_b32 s30, s3
    s_bfe_u32 s56, s3, 0x40012
    s_cmp_lg_u32 s36, 0
    s_cselect_b32 s56, s56, 0
    s_mov_b32 s32, s31
    s_mov_b32 s31, s35
    v_mfma_f32_32x32x16_bf16 v[48:63], v[76:79], v[180:183], v[48:63]
    s_waitcnt vmcnt(4) lgkmcnt(1)
    v_mfma_f32_32x32x16_bf16 v[0:15], v[80:83], v[184:187], v[0:15]
    ds_read_b64_tr_b16 v[176:177], v246 offset:0
    ds_read_b64_tr_b16 v[178:179], v246 offset:1024
    ds_read_b64_tr_b16 v[180:181], v247 offset:0
    ds_read_b64_tr_b16 v[182:183], v247 offset:1024
    s_mov_b32 m0, s71
    v_mfma_f32_32x32x16_bf16 v[16:31], v[84:87], v[184:187], v[16:31]
    buffer_load_dwordx4 v228, s[4:7], s47 offen sc1 lds
    buffer_load_dwordx4 v229, s[72:75], s47 offen offset:1024 sc1 lds
    v_mfma_f32_32x32x16_bf16 v[32:47], v[80:83], v[188:191], v[32:47]
    s_nop 2
    v_mul_f32 v242, v0, v144
    v_fma_f32 v240, v8, v160, -v240
    v_fmac_f32 v242, v1, v145
    v_fmac_f32 v240, v9, v161
    v_fmac_f32 v242, v2, v146
    v_fmac_f32 v240, v10, v162
    v_fmac_f32 v242, v3, v147
    v_mfma_f32_32x32x16_bf16 v[48:63], v[84:87], v[188:191], v[48:63]
    s_setprio 0
    v_fmac_f32 v240, v11, v163
    v_fmac_f32 v242, v4, v148
    v_fmac_f32 v240, v12, v164
    v_fmac_f32 v242, v5, v149
    v_fmac_f32 v240, v13, v165
    v_fmac_f32 v242, v6, v150
    v_fmac_f32 v240, v14, v166
    v_fmac_f32 v242, v7, v151
    v_fmac_f32 v240, v15, v167
    v_add_u32 v249, s26, v249
    v_add_u32 v250, s26, v250
    v_fma_f32 v244, v16, v160, -v244
    v_fmac_f32 v236, v24, v112
    v_fmac_f32 v244, v17, v161
    v_fmac_f32 v236, v25, v113
    v_fmac_f32 v244, v18, v162
    v_fmac_f32 v236, v26, v114
    v_fmac_f32 v244, v19, v163
    v_fmac_f32 v236, v27, v115
    v_fmac_f32 v244, v20, v164
    v_fmac_f32 v236, v28, v116
    v_fmac_f32 v244, v21, v165
    v_fmac_f32 v236, v29, v117
    v_fmac_f32 v244, v22, v166
    v_fmac_f32 v236, v30, v118
    v_fmac_f32 v244, v23, v167
    v_fmac_f32 v236, v31, v119
    ds_read_b64_tr_b16 v[0:1], v249 offset:0
    ds_read_b64_tr_b16 v[2:3], v249 offset:32
    ds_read_u16_d16_hi v16, v250 offset:0
    v_mul_f32 v243, v32, v152
    v_fma_f32 v241, v40, v168, -v241
    v_fmac_f32 v243, v33, v153
    v_fmac_f32 v241, v41, v169
    v_fmac_f32 v243, v34, v154
    v_fmac_f32 v241, v42, v170
    v_fmac_f32 v243, v35, v155
    v_fmac_f32 v241, v43, v171
    v_fmac_f32 v243, v36, v156
    v_fmac_f32 v241, v44, v172
    v_fmac_f32 v243, v37, v157
    v_fmac_f32 v241, v45, v173
    v_fmac_f32 v243, v38, v158
    v_fmac_f32 v241, v46, v174
    v_fmac_f32 v243, v39, v159
    v_fmac_f32 v241, v47, v175
    ds_read_b64_tr_b16 v[4:5], v249 offset:512
    ds_read_b64_tr_b16 v[6:7], v249 offset:544
    ds_read_u16_d16_hi v17, v250 offset:128
    v_fma_f32 v245, v48, v168, -v245
    v_fmac_f32 v237, v56, v120
    v_fmac_f32 v245, v49, v169
    v_fmac_f32 v237, v57, v121
    v_fmac_f32 v245, v50, v170
    v_fmac_f32 v237, v58, v122
    v_fmac_f32 v245, v51, v171
    v_fmac_f32 v237, v59, v123
    v_fmac_f32 v245, v52, v172
    v_fmac_f32 v237, v60, v124
    v_fmac_f32 v245, v53, v173
    v_fmac_f32 v237, v61, v125
    v_fmac_f32 v245, v54, v174
    v_fmac_f32 v237, v62, v126
    v_fmac_f32 v245, v55, v175
    v_fmac_f32 v237, v63, v127
    s_cmp_eq_u32 s56, 5
    s_cbranch_scc1 K2_U21
    s_cmp_eq_u32 s56, 6
    s_cbranch_scc1 K2_U3h1
    s_branch K2_DSP1
K2_PAD_SW:
    s_branch K2_HOP
K2_DSP0:
    s_cmp_eq_u32 s56, 4
    s_cbranch_scc1 K2_U20
    s_cmp_eq_u32 s56, 7
    s_cbranch_scc1 K2_U30
    s_cmp_gt_u32 s56, 7
    s_cbranch_scc1 K2_U40
    s_cmp_lg_u32 s56, 0
    s_cbranch_scc1 K2_U10
    s_branch K2_SWITCH
K2_DSP1:
    s_cmp_eq_u32 s56, 4
    s_cbranch_scc1 K2_U21
    s_cmp_eq_u32 s56, 7
    s_cbranch_scc1 K2_U31
    s_cmp_gt_u32 s56, 7
    s_cbranch_scc1 K2_U41
    s_cmp_lg_u32 s56, 0
    s_cbranch_scc1 K2_U11
    s_branch K2_TAIL
K2_SWITCH:
    v_lshlrev_b32 v60, 3, v252
    s_mov_b32 s64, 7176192
    buffer_load_dwordx4 v[56:59], v60, s[8:11], s64 offen sc1
    v_permlane32_swap_b32 v242, v236
    v_permlane32_swap_b32 v243, v237
    v_permlane32_swap_b32 v244, v238
    v_permlane32_swap_b32 v245, v239
    v_permlane32_swap_b32 v240, v241
    v_add_f32 v242, v242, v236
    v_add_f32 v243, v243, v237
    v_add_f32 v244, v244, v238
    v_add_f32 v245, v245, v239
    v_add_f32 v240, -v240, -v241
    s_set_gpr_idx_on s32, gpr_idx(DST)
    s_nop 0
    v_cvt_pk_bf16_f32 v195, v242, v243
    v_cvt_pk_bf16_f32 v196, v244, v245
    v_cvt_pk_bf16_f32 v197, v240, v240
    s_set_gpr_idx_off
    v_lshl_add_u32 v230, v252, 1, s35
    v_lshrrev_b32 v231, 6, v252
    v_mul_u32_u24 v231, 126, v231
    v_lshrrev_b32 v254, 6, v252
    v_bfe_u32 v255, v252, 3, 2
    v_lshl_add_u32 v254, v254, 2, v255
    v_mul_u32_u24 v254, 640, v254
    v_bfe_u32 v255, v252, 5, 1
    v_lshl_add_u32 v254, v255, 5, v254
    v_and_b32 v255, 6, v252
    v_lshl_add_u32 v254, v255, 2, v254
    v_add_u32 v254, 152832, v254
    ds_read_b64_tr_b16 v[104:105], v254 offset:0
    ds_read_b64_tr_b16 v[106:107], v254 offset:5120
    ds_read_b64_tr_b16 v[108:109], v254 offset:64
    ds_read_b64_tr_b16 v[110:111], v254 offset:5184
    ds_read_b64_tr_b16 v[120:121], v254 offset:128
    ds_read_b64_tr_b16 v[122:123], v254 offset:5248
    ds_read_b64_tr_b16 v[124:125], v254 offset:192
    ds_read_b64_tr_b16 v[126:127], v254 offset:5312
    ds_read_b64_tr_b16 v[136:137], v254 offset:256
    ds_read_b64_tr_b16 v[138:139], v254 offset:5376
    ds_read_b64_tr_b16 v[140:141], v254 offset:320
    ds_read_b64_tr_b16 v[142:143], v254 offset:5440
    ds_read_b64_tr_b16 v[152:153], v254 offset:384
    ds_read_b64_tr_b16 v[154:155], v254 offset:5504
    ds_read_b64_tr_b16 v[156:157], v254 offset:448
    ds_read_b64_tr_b16 v[158:159], v254 offset:5568
    ds_read_b64_tr_b16 v[168:169], v254 offset:512
    ds_read_b64_tr_b16 v[170:171], v254 offset:5632
    ds_read_b64_tr_b16 v[172:173], v254 offset:576
    ds_read_b64_tr_b16 v[174:175], v254 offset:5696
    s_movk_i32 s40, 128
    s_movk_i32 s41, 384
    s_movk_i32 s42, 640
    s_movk_i32 s43, 896
    s_waitcnt lgkmcnt(15)
    v_lshlrev_b32 v96, 16, v104
    v_and_b32 v97, 0xffff0000, v104
    v_lshlrev_b32 v98, 16, v105
    v_and_b32 v99, 0xffff0000, v105
    v_lshlrev_b32 v100, 16, v106
    v_and_b32 v101, 0xffff0000, v106
    v_lshlrev_b32 v102, 16, v107
    v_and_b32 v103, 0xffff0000, v107
    v_lshlrev_b32 v104, 16, v108
    v_and_b32 v105, 0xffff0000, v108
    v_lshlrev_b32 v106, 16, v109
    v_and_b32 v107, 0xffff0000, v109
    v_lshlrev_b32 v108, 16, v110
    v_and_b32 v109, 0xffff0000, v110
    v_lshlrev_b32 v110, 16, v111
    v_and_b32 v111, 0xffff0000, v111
    s_waitcnt lgkmcnt(12)
    v_lshlrev_b32 v112, 16, v120
    v_and_b32 v113, 0xffff0000, v120
    v_lshlrev_b32 v114, 16, v121
    v_and_b32 v115, 0xffff0000, v121
    v_lshlrev_b32 v116, 16, v122
    v_and_b32 v117, 0xffff0000, v122
    v_lshlrev_b32 v118, 16, v123
    v_and_b32 v119, 0xffff0000, v123
    v_lshlrev_b32 v120, 16, v124
    v_and_b32 v121, 0xffff0000, v124
    v_lshlrev_b32 v122, 16, v125
    v_and_b32 v123, 0xffff0000, v125
    v_lshlrev_b32 v124, 16, v126
    v_and_b32 v125, 0xffff0000, v126
    v_lshlrev_b32 v126, 16, v127
    v_and_b32 v127, 0xffff0000, v127
    s_waitcnt lgkmcnt(8)
    v_lshlrev_b32 v128, 16, v136
    v_and_b32 v129, 0xffff0000, v136
    v_lshlrev_b32 v130, 16, v137
    v_and_b32 v131, 0xffff0000, v137
    v_lshlrev_b32 v132, 16, v138
    v_and_b32 v133, 0xffff0000, v138
    v_lshlrev_b32 v134, 16, v139
    v_and_b32 v135, 0xffff0000, v139
    v_lshlrev_b32 v136, 16, v140
    v_and_b32 v137, 0xffff0000, v140
    v_lshlrev_b32 v138, 16, v141
    v_and_b32 v139, 0xffff0000, v141
    v_lshlrev_b32 v140, 16, v142
    v_and_b32 v141, 0xffff0000, v142
    v_lshlrev_b32 v142, 16, v143
    v_and_b32 v143, 0xffff0000, v143
    s_waitcnt lgkmcnt(4)
    v_lshlrev_b32 v144, 16, v152
    v_and_b32 v145, 0xffff0000, v152
    v_lshlrev_b32 v146, 16, v153
    v_and_b32 v147, 0xffff0000, v153
    v_lshlrev_b32 v148, 16, v154
    v_and_b32 v149, 0xffff0000, v154
    v_lshlrev_b32 v150, 16, v155
    v_and_b32 v151, 0xffff0000, v155
    v_lshlrev_b32 v152, 16, v156
    v_and_b32 v153, 0xffff0000, v156
    v_lshlrev_b32 v154, 16, v157
    v_and_b32 v155, 0xffff0000, v157
    v_lshlrev_b32 v156, 16, v158
    v_and_b32 v157, 0xffff0000, v158
    v_lshlrev_b32 v158, 16, v159
    v_and_b32 v159, 0xffff0000, v159
    s_waitcnt lgkmcnt(0)
    v_lshlrev_b32 v160, 16, v168
    v_and_b32 v161, 0xffff0000, v168
    v_lshlrev_b32 v162, 16, v169
    v_and_b32 v163, 0xffff0000, v169
    v_lshlrev_b32 v164, 16, v170
    v_and_b32 v165, 0xffff0000, v170
    v_lshlrev_b32 v166, 16, v171
    v_and_b32 v167, 0xffff0000, v171
    v_lshlrev_b32 v168, 16, v172
    v_and_b32 v169, 0xffff0000, v172
    v_lshlrev_b32 v170, 16, v173
    v_and_b32 v171, 0xffff0000, v173
    v_lshlrev_b32 v172, 16, v174
    v_and_b32 v173, 0xffff0000, v174
    v_lshlrev_b32 v174, 16, v175
    v_and_b32 v175, 0xffff0000, v175
K2_FLGW:
    s_or_b32 s58, s54, s20
    s_waitcnt vmcnt(0)
    v_xor_b32 v56, s2, v56
    v_xor_b32 v57, s2, v57
    v_xor_b32 v58, s2, v58
    v_xor_b32 v59, s2, v59
    v_or3_b32 v56, v56, v57, v58
    v_or_b32 v56, v56, v59
    v_cmp_ne_u32 vcc, 0, v56
    s_nop 0
    s_cbranch_vccnz K2_FLGR
    s_cmp_eq_u32 s58, 0
    s_cbranch_scc1 K2_FLGY
K2_FLGOK:
    s_cmp_eq_u32 s36, 0
    s_cbranch_scc1 K2_TAIL2
    s_mov_b32 s29, s48
    s_mov_b32 s32, s31
    s_mov_b32 s30, s3
    s_mov_b32 s31, s35
    s_bfe_u32 s56, s3, 0x40012
    s_cmp_eq_u32 s56, 5
    s_cbranch_scc1 K2_U21
    s_cmp_eq_u32 s56, 6
    s_cbranch_scc1 K2_U3h1
    s_branch K2_DSP1
K2_dum_4:
    v_mov_b32 v232, -1
    s_mov_b32 m0, 163312
    s_mov_b64 exec, 1
    buffer_load_dwordx4 v232, s[16:19], 0 offen lds
    buffer_load_dwordx4 v232, s[16:19], 0 offen lds
    s_mov_b64 exec, -1
    s_branch K2_back_6
K2_nul_10:
    s_mov_b32 s58, 63
    s_mov_b32 s36, 0
    s_branch K2_back_13
K2_spin_11:
    s_sub_u32 s27, s27, 1
    s_cbranch_scc1 K2_END
    v_lshl_add_u32 v233, v252, 1, s53
    ds_read_b32 v233, v233
    s_waitcnt lgkmcnt(0)
    s_branch K2_chk_12
K2_dyn_8:
    v_mov_b32 v254, 163296
    v_mov_b32 v255, 1
    v_lshl_add_u32 v233, v252, 1, s53
    s_mov_b64 exec, 1
    ds_add_rtn_u32 v232, v254, v255
    s_mov_b64 exec, -1
    ds_read_b32 v233, v233
    s_waitcnt lgkmcnt(0)
    v_readfirstlane_b32 s58, v232
    s_nop 0
    s_cmp_lt_u32 s58, s22
    s_cbranch_scc0 K2_nul_10
    s_and_b32 s59, s58, 7
    s_lshr_b32 s60, s58, 3
K2_chk_12:
    v_readlane_b32 s61, v233, s59
    s_nop 0
    s_cmp_gt_u32 s61, s60
    s_cbranch_scc0 K2_spin_11
K2_back_13:
    s_mov_b32 s34, 1
    s_branch K2_back_9
K2_dum_17:
    v_mov_b32 v232, -1
    s_mov_b32 m0, 163312
    s_mov_b64 exec, 1
    buffer_load_dwordx4 v232, s[16:19], 0 offen lds
    buffer_load_dwordx4 v232, s[16:19], 0 offen lds
    s_mov_b64 exec, -1
    s_branch K2_back_19
K2_nul_23:
    s_mov_b32 s58, 63
    s_mov_b32 s36, 0
    s_branch K2_back_26
K2_spin_24:
    s_sub_u32 s27, s27, 1
    s_cbranch_scc1 K2_END
    v_lshl_add_u32 v233, v252, 1, s53
    ds_read_b32 v233, v233
    s_waitcnt lgkmcnt(0)
    s_branch K2_chk_25
K2_dyn_21:
    v_mov_b32 v254, 163296
    v_mov_b32 v255, 1
    v_lshl_add_u32 v233, v252, 1, s53
    s_mov_b64 exec, 1
    ds_add_rtn_u32 v232, v254, v255
    s_mov_b64 exec, -1
    ds_read_b32 v233, v233
    s_waitcnt lgkmcnt(0)
    v_readfirstlane_b32 s58, v232
    s_nop 0
    s_cmp_lt_u32 s58, s22
    s_cbranch_scc0 K2_nul_23
    s_and_b32 s59, s58, 7
    s_lshr_b32 s60, s58, 3
K2_chk_25:
    v_readlane_b32 s61, v233, s59
    s_nop 0
    s_cmp_gt_u32 s61, s60
    s_cbranch_scc0 K2_spin_24
K2_back_26:
    s_mov_b32 s34, 1
    s_branch K2_back_22
K2_dum_30:
    v_mov_b32 v232, -1
    s_mov_b32 m0, 163312
    s_mov_b64 exec, 1
    buffer_load_dwordx4 v232, s[16:19], 0 offen lds
    buffer_load_dwordx4 v232, s[16:19], 0 offen lds
    s_mov_b64 exec, -1
    s_branch K2_back_32
K2_nul_36:
    s_mov_b32 s58, 63
    s_mov_b32 s36, 0
    s_branch K2_back_39
K2_spin_37:
    s_sub_u32 s27, s27, 1
    s_cbranch_scc1 K2_END
    v_lshl_add_u32 v233, v252, 1, s53
    ds_read_b32 v233, v233
    s_waitcnt lgkmcnt(0)
    s_branch K2_chk_38
K2_dyn_34:
    v_mov_b32 v254, 163296
    v_mov_b32 v255, 1
    v_lshl_add_u32 v233, v252, 1, s53
    s_mov_b64 exec, 1
    ds_add_rtn_u32 v232, v254, v255
    s_mov_b64 exec, -1
    ds_read_b32 v233, v233
    s_waitcnt lgkmcnt(0)
    v_readfirstlane_b32 s58, v232
    s_nop 0
    s_cmp_lt_u32 s58, s22
    s_cbranch_scc0 K2_nul_36
    s_and_b32 s59, s58, 7
    s_lshr_b32 s60, s58, 3
K2_chk_38:
    v_readlane_b32 s61, v233, s59
    s_nop 0
    s_cmp_gt_u32 s61, s60
    s_cbranch_scc0 K2_spin_37
K2_back_39:
    s_mov_b32 s34, 1
    s_branch K2_back_35
K2_dum_43:
    v_mov_b32 v232, -1
    s_mov_b32 m0, 163312
    s_mov_b64 exec, 1
    buffer_load_dwordx4 v232, s[16:19], 0 offen lds
    buffer_load_dwordx4 v232, s[16:19], 0 offen lds
    s_mov_b64 exec, -1
    s_branch K2_back_45
K2_nul_47:
    s_mov_b32 s58, 63
    s_mov_b32 s36, 0
    s_branch K2_back_50
K2_spin_48:
    s_sub_u32 s27, s27, 1
    s_cbranch_scc1 K2_END
    v_lshl_add_u32 v233, v252, 1, s53
    ds_read_b32 v233, v233
    s_waitcnt lgkmcnt(0)
    s_branch K2_chk_49
K2_nul_54:
    s_mov_b32 s58, 63
    s_mov_b32 s36, 0
    s_branch K2_back_57
K2_spin_55:
    s_sub_u32 s27, s27, 1
    s_cbranch_scc1 K2_END
    v_lshl_add_u32 v233, v252, 1, s53
    ds_read_b32 v233, v233
    s_waitcnt lgkmcnt(0)
    s_branch K2_chk_56
K2_nul_61:
    s_mov_b32 s58, 63
    s_mov_b32 s36, 0
    s_branch K2_back_64
K2_spin_62:
    s_sub_u32 s27, s27, 1
    s_cbranch_scc1 K2_END
    v_lshl_add_u32 v233, v252, 1, s53
    ds_read_b32 v233, v233
    s_waitcnt lgkmcnt(0)
    s_branch K2_chk_63
K2_PAD_TL:
    s_branch K2_HOP
K2_TAIL2:
    v_lshlrev_b32 v229, 3, v252
    s_mul_i32 s58, s20, 20480
    s_add_u32 s58, s58, 6946816
    s_mul_i32 s59, s20, 8224
    buffer_load_dwordx4 v[96:99], v229, s[8:11], s58 offen offset:0 sc1
    buffer_load_dwordx4 v[100:103], v229, s[8:11], s58 offen offset:1024 sc1
    buffer_load_dwordx4 v[104:107], v229, s[8:11], s58 offen offset:2048 sc1
    buffer_load_dwordx4 v[108:111], v229, s[8:11], s58 offen offset:3072 sc1
    s_add_u32 s58, s58, 4096
    buffer_load_dwordx4 v[128:131], v229, s[8:11], s58 offen offset:0 sc1
    buffer_load_dwordx4 v[132:135], v229, s[8:11], s58 offen offset:1024 sc1
    buffer_load_dwordx4 v[136:139], v229, s[8:11], s58 offen offset:2048 sc1
    buffer_load_dwordx4 v[140:143], v229, s[8:11], s58 offen offset:3072 sc1
    v_lshl_add_u32 v228, v252, 1, s59
    v_lshrrev_b32 v226, 6, v252
    v_mul_u32_u24 v226, 126, v226
    v_sub_u32 v226, v228, v226
    s_branch K2_TAIL3
K2_TAIL:
    v_lshlrev_b32 v229, 3, v252
    s_mul_i32 s58, s20, 20480
    s_add_u32 s58, s58, 6946816
    s_mul_i32 s59, s20, 8224
    buffer_load_dwordx4 v[96:99], v229, s[8:11], s58 offen offset:0 sc1
    v_permlane32_swap_b32 v242, v236
    v_permlane32_swap_b32 v243, v237
    v_permlane32_swap_b32 v244, v238
    buffer_load_dwordx4 v[100:103], v229, s[8:11], s58 offen offset:1024 sc1
    v_permlane32_swap_b32 v245, v239
    v_permlane32_swap_b32 v240, v241
    v_add_f32 v242, v242, v236
    buffer_load_dwordx4 v[104:107], v229, s[8:11], s58 offen offset:2048 sc1
    v_add_f32 v243, v243, v237
    v_add_f32 v244, v244, v238
    v_add_f32 v245, v245, v239
    buffer_load_dwordx4 v[108:111], v229, s[8:11], s58 offen offset:3072 sc1
    v_add_f32 v240, -v240, -v241
    v_sub_u32 v241, v230, v231
    v_cvt_pk_bf16_f32 v242, v242, v243
    s_add_u32 s58, s58, 4096
    buffer_load_dwordx4 v[128:131], v229, s[8:11], s58 offen offset:0 sc1
    v_cvt_pk_bf16_f32 v244, v244, v245
    v_cvt_pk_bf16_f32 v240, v240, v240
    ds_write_b32 v230, v242 offset:768
    buffer_load_dwordx4 v[132:135], v229, s[8:11], s58 offen offset:1024 sc1
    ds_write_b32 v230, v244 offset:1024
    ds_write_b16 v241, v240 offset:1280
    v_lshl_add_u32 v228, v252, 1, s59
    buffer_load_dwordx4 v[136:139], v229, s[8:11], s58 offen offset:2048 sc1
    v_lshrrev_b32 v226, 6, v252
    v_mul_u32_u24 v226, 126, v226
    v_sub_u32 v226, v228, v226
    buffer_load_dwordx4 v[140:143], v229, s[8:11], s58 offen offset:3072 sc1
K2_TAIL3:
    s_waitcnt vmcnt(8)
    ds_write2st64_b32 v228, v192, v193 offset0:0 offset1:1
    ds_write2st64_b32 v228, v194, v195 offset0:2 offset1:3
    s_add_u32 s58, s58, 4096
    buffer_load_dwordx4 v[112:115], v229, s[8:11], s58 offen offset:0 sc1
    v_bfe_u32 v48, v252, 1, 4
    v_lshrrev_b32 v49, 5, v252
    ds_write_b16 v226, v197 offset:1280
    ds_write2st64_b32 v228, v196, v198 offset0:4 offset1:6
    buffer_load_dwordx4 v[116:119], v229, s[8:11], s58 offen offset:1024 sc1
    v_lshrrev_b32 v55, 3, v48
    v_lshlrev_b32 v52, 4, v49
    ds_write2st64_b32 v228, v199, v200 offset0:7 offset1:8
    ds_write2st64_b32 v228, v201, v202 offset0:9 offset1:10
    buffer_load_dwordx4 v[120:123], v229, s[8:11], s58 offen offset:2048 sc1
    v_lshl_add_u32 v54, v55, 2, v48
    v_and_b32 v54, 7, v54
    ds_write_b16 v226, v203 offset:2816
    ds_write2st64_b32 v228, v204, v205 offset0:12 offset1:13
    buffer_load_dwordx4 v[124:127], v229, s[8:11], s58 offen offset:3072 sc1
    v_and_b32 v50, 7, v48
    v_mul_u32_u24 v50, 8224, v50
    ds_write2st64_b32 v228, v206, v207 offset0:14 offset1:15
    ds_write2st64_b32 v228, v208, v210 offset0:16 offset1:18
    s_add_u32 s58, s58, 4096
    buffer_load_dwordx4 v[144:147], v229, s[8:11], s58 offen offset:0 sc1
    v_mul_u32_u24 v51, 1536, v55
    v_add_u32 v50, v50, v51
    ds_write_b16 v226, v209 offset:4352
    ds_write2st64_b32 v228, v211, v212 offset0:19 offset1:20
    buffer_load_dwordx4 v[148:151], v229, s[8:11], s58 offen offset:1024 sc1
    v_add_u32 v222, v50, v52
    v_mul_u32_u24 v51, 8224, v54
    ds_write2st64_b32 v228, v213, v214 offset0:21 offset1:22
    ds_write2st64_b32 v228, v216, v217 offset0:24 offset1:25
    buffer_load_dwordx4 v[152:155], v229, s[8:11], s58 offen offset:2048 sc1
    v_add_u32 v232, v51, v52
    v_lshl_add_u32 v247, v55, 7, v232
    ds_write_b16 v226, v215 offset:5888
    ds_write2st64_b32 v228, v218, v219 offset0:26 offset1:27
    buffer_load_dwordx4 v[156:159], v229, s[8:11], s58 offen offset:3072 sc1
    v_mul_u32_u24 v51, 2080, v48
    s_mov_b32 s60, 65536
    ds_write_b32 v228, v220 offset:7168
    ds_write_b16 v226, v221 offset:7424
    s_add_u32 s58, s58, 4096
    buffer_load_dwordx4 v[160:163], v229, s[8:11], s58 offen offset:0 sc1
    v_add3_u32 v223, v51, v52, s60
    v_mul_u32_u24 v51, 2080, v54
    buffer_load_dwordx4 v[164:167], v229, s[8:11], s58 offen offset:1024 sc1
    s_mov_b32 s60, 132096
    v_add3_u32 v225, v51, v52, s60
    buffer_load_dwordx4 v[168:171], v229, s[8:11], s58 offen offset:2048 sc1
    v_lshl_add_u32 v248, v55, 7, v225
    s_lshl_b32 s60, s20, 5
    buffer_load_dwordx4 v[172:175], v229, s[8:11], s58 offen offset:3072 sc1
    v_lshl_add_u32 v49, v49, 3, s60
    s_mov_b32 s60, 65536
    v_add3_u32 v255, v51, v49, s60
    v_lshl_add_u32 v246, v55, 9, v255
    v_bfe_u32 v53, v48, 2, 1
    v_lshl_add_u32 v49, v53, 4, v49
    v_add_u32 v254, v50, v49
    s_and_b32 s64, s55, s28
    s_waitcnt lgkmcnt(0)
    s_barrier
    s_cmp_eq_u32 s64, 0
    s_cbranch_scc1 K2_MULTI
    s_setprio 3
    ds_read_b128 v[48:51], v222 offset:0
    ds_read_b128 v[52:55], v222 offset:64
    ds_read_b128 v[56:59], v222 offset:896
    ds_read_b128 v[60:63], v222 offset:960
    ds_read_b128 v[64:67], v223 offset:0
    ds_read_b128 v[68:71], v223 offset:64
    ds_read_b128 v[72:75], v223 offset:896
    ds_read_b128 v[76:79], v223 offset:960
    ds_read_b128 v[80:83], v222 offset:3072
    ds_read_b128 v[84:87], v222 offset:3136
    ds_read_b128 v[88:91], v222 offset:3968
    s_waitcnt vmcnt(19) lgkmcnt(9)
    v_mfma_f32_16x16x32_bf16 v[0:3], v[96:99], v[48:51], 0
    ds_read_b128 v[92:95], v222 offset:4032
    s_waitcnt vmcnt(18)
    v_mfma_f32_16x16x32_bf16 v[0:3], v[100:103], v[52:55], v[0:3]
    ds_read_b128 v[48:51], v223 offset:33280
    s_waitcnt vmcnt(17) lgkmcnt(9)
    v_mfma_f32_16x16x32_bf16 v[0:3], v[104:107], v[56:59], v[0:3]
    s_bfe_u32 s60, s20, 0x10002
    s_lshl_b32 s60, s60, 4
    ds_read_b128 v[52:55], v223 offset:33344
    s_waitcnt vmcnt(16)
    v_mfma_f32_16x16x32_bf16 v[0:3], v[108:111], v[60:63], v[0:3]
    s_add_u32 s59, s59, s60
    v_add_u32 v228, s59, v229
    ds_read_b128 v[56:59], v223 offset:34176
    s_waitcnt vmcnt(15) lgkmcnt(9)
    v_mfma_f32_16x16x32_bf16 v[0:3], v[128:131], v[64:67], v[0:3]
    s_mul_i32 s60, s20, 2080
    s_add_u32 s60, s60, 65536
    ds_read_b128 v[60:63], v223 offset:34240
    s_waitcnt vmcnt(14)
    v_mfma_f32_16x16x32_bf16 v[0:3], v[132:135], v[68:71], v[0:3]
    v_add_u32 v249, s60, v229
    s_mov_b32 s63, 0xbfb8aa3b
    ds_read_b128 v[64:67], v232 offset:6144
    s_waitcnt vmcnt(13) lgkmcnt(9)
    v_mfma_f32_16x16x32_bf16 v[0:3], v[136:139], v[72:75], v[0:3]
    s_add_u32 s40, s20, s21
    s_lshl_b32 s40, s40, 10
    ds_read_b128 v[68:71], v232 offset:6208
    s_waitcnt vmcnt(12)
    v_mfma_f32_16x16x32_bf16 v[0:3], v[140:143], v[76:79], v[0:3]
    s_add_u32 s41, s40, 8192
    s_add_u32 s42, s40, 16384
    ds_read_b128 v[72:75], v232 offset:7040
    s_waitcnt lgkmcnt(9)
    v_mfma_f32_16x16x32_bf16 v[16:19], v[96:99], v[80:83], 0
    s_add_u32 s43, s40, 24576
    s_add_u32 s44, s40, 32768
    ds_read_b128 v[76:79], v232 offset:7104
    v_mfma_f32_16x16x32_bf16 v[16:19], v[100:103], v[84:87], v[16:19]
    ds_read_b128 v[80:83], v225 offset:0
    s_waitcnt lgkmcnt(9)
    v_mfma_f32_16x16x32_bf16 v[16:19], v[104:107], v[88:91], v[16:19]
    ds_read_b128 v[84:87], v225 offset:64
    v_mfma_f32_16x16x32_bf16 v[16:19], v[108:111], v[92:95], v[16:19]
    v_mul_f32 v204, s63, v0
    v_mul_f32 v205, s63, v1
    ds_read_b128 v[88:91], v225 offset:896
    s_waitcnt lgkmcnt(9)
    v_mfma_f32_16x16x32_bf16 v[16:19], v[128:131], v[48:51], v[16:19]
    v_mul_f32 v206, s63, v2
    ds_read_b128 v[92:95], v225 offset:960
    v_mfma_f32_16x16x32_bf16 v[16:19], v[132:135], v[52:55], v[16:19]
    v_mul_f32 v207, s63, v3
    ds_read_b128 v[48:51], v222 offset:128
    s_waitcnt lgkmcnt(9)
    v_mfma_f32_16x16x32_bf16 v[16:19], v[136:139], v[56:59], v[16:19]
    v_exp_f32 v204, v204
    ds_read_b128 v[52:55], v222 offset:384
    v_mfma_f32_16x16x32_bf16 v[16:19], v[140:143], v[60:63], v[16:19]
    v_exp_f32 v205, v205
    ds_read_b128 v[56:59], v222 offset:256
    s_waitcnt lgkmcnt(9)
    v_mfma_f32_16x16x32_bf16 v[32:35], v[96:99], v[64:67], 0
    v_exp_f32 v206, v206
    ds_read_b128 v[60:63], v222 offset:192
    v_mfma_f32_16x16x32_bf16 v[32:35], v[100:103], v[68:71], v[32:35]
    v_exp_f32 v207, v207
    s_setprio 2
    ds_read_b128 v[64:67], v222 offset:448
    s_waitcnt lgkmcnt(9)
    v_mfma_f32_16x16x32_bf16 v[32:35], v[104:107], v[72:75], v[32:35]
    v_add_f32 v204, 1.0, v204
    ds_read_b128 v[68:71], v222 offset:320
    v_mfma_f32_16x16x32_bf16 v[32:35], v[108:111], v[76:79], v[32:35]
    v_add_f32 v205, 1.0, v205
    v_add_f32 v206, 1.0, v206
    ds_read_b128 v[72:75], v222 offset:640
    s_waitcnt lgkmcnt(9)
    v_mfma_f32_16x16x32_bf16 v[32:35], v[128:131], v[80:83], v[32:35]
    v_add_f32 v207, 1.0, v207
    ds_read_b128 v[76:79], v222 offset:512
    v_mfma_f32_16x16x32_bf16 v[32:35], v[132:135], v[84:87], v[32:35]
    v_rcp_f32 v204, v204
    ds_read_b128 v[80:83], v222 offset:768
    s_waitcnt lgkmcnt(9)
    v_mfma_f32_16x16x32_bf16 v[32:35], v[136:139], v[88:91], v[32:35]
    v_rcp_f32 v205, v205
    ds_read_b128 v[84:87], v222 offset:704
    v_mfma_f32_16x16x32_bf16 v[32:35], v[140:143], v[92:95], v[32:35]
    v_rcp_f32 v206, v206
    ds_read_b128 v[88:91], v222 offset:576
    s_waitcnt vmcnt(11) lgkmcnt(9)
    v_mfma_f32_16x16x32_bf16 v[4:7], v[112:115], v[48:51], 0
    v_rcp_f32 v207, v207
    ds_read_b128 v[92:95], v222 offset:832
    v_mfma_f32_16x16x32_bf16 v[8:11], v[112:115], v[52:55], 0
    v_cvt_pk_bf16_f32 v176, v0, v1
    ds_read_b128 v[48:51], v222 offset:1024
    s_waitcnt lgkmcnt(9)
    v_mfma_f32_16x16x32_bf16 v[12:15], v[112:115], v[56:59], 0
    v_cvt_pk_bf16_f32 v177, v2, v3
    ds_read_b128 v[52:55], v222 offset:1280
    s_waitcnt vmcnt(10)
    v_mfma_f32_16x16x32_bf16 v[4:7], v[116:119], v[60:63], v[4:7]
    v_mul_f32 v208, s63, v16
    v_mul_f32 v209, s63, v17
    ds_read_b128 v[56:59], v222 offset:1152
    s_waitcnt lgkmcnt(9)
    v_mfma_f32_16x16x32_bf16 v[8:11], v[116:119], v[64:67], v[8:11]
    v_mul_f32 v210, s63, v18
    ds_read_b128 v[60:63], v222 offset:1088
    v_mfma_f32_16x16x32_bf16 v[12:15], v[116:119], v[68:71], v[12:15]
    v_mul_f32 v211, s63, v19
    ds_read_b128 v[64:67], v222 offset:1344
    s_waitcnt vmcnt(9) lgkmcnt(9)
    v_mfma_f32_16x16x32_bf16 v[4:7], v[120:123], v[72:75], v[4:7]
    v_exp_f32 v208, v208
    ds_read_b128 v[68:71], v222 offset:1216
    v_mfma_f32_16x16x32_bf16 v[8:11], v[120:123], v[76:79], v[8:11]
    v_exp_f32 v209, v209
    ds_read_b128 v[72:75], v223 offset:128
    s_waitcnt lgkmcnt(9)
    v_mfma_f32_16x16x32_bf16 v[12:15], v[120:123], v[80:83], v[12:15]
    v_exp_f32 v210, v210
    ds_read_b128 v[76:79], v223 offset:384
    s_waitcnt vmcnt(8)
    v_mfma_f32_16x16x32_bf16 v[4:7], v[124:127], v[84:87], v[4:7]
    v_exp_f32 v211, v211
    ds_read_b128 v[80:83], v223 offset:256
    s_waitcnt lgkmcnt(9)
    v_mfma_f32_16x16x32_bf16 v[8:11], v[124:127], v[88:91], v[8:11]
    v_add_f32 v208, 1.0, v208
    ds_read_b128 v[84:87], v223 offset:192
    v_mfma_f32_16x16x32_bf16 v[12:15], v[124:127], v[92:95], v[12:15]
    v_add_f32 v209, 1.0, v209
    v_add_f32 v210, 1.0, v210
    ds_read_b128 v[88:91], v223 offset:448
    s_waitcnt vmcnt(7) lgkmcnt(9)
    v_mfma_f32_16x16x32_bf16 v[4:7], v[144:147], v[48:51], v[4:7]
    v_add_f32 v211, 1.0, v211
    s_setprio 1
    ds_read_b128 v[92:95], v223 offset:320
    v_mfma_f32_16x16x32_bf16 v[8:11], v[144:147], v[52:55], v[8:11]
    v_rcp_f32 v208, v208
    ds_read_b128 v[48:51], v223 offset:640
    s_waitcnt lgkmcnt(9)
    v_mfma_f32_16x16x32_bf16 v[12:15], v[144:147], v[56:59], v[12:15]
    v_rcp_f32 v209, v209
    ds_read_b128 v[52:55], v223 offset:512
    s_waitcnt vmcnt(6)
    v_mfma_f32_16x16x32_bf16 v[4:7], v[148:151], v[60:63], v[4:7]
    v_rcp_f32 v210, v210
    ds_read_b128 v[56:59], v223 offset:768
    s_waitcnt lgkmcnt(9)
    v_mfma_f32_16x16x32_bf16 v[8:11], v[148:151], v[64:67], v[8:11]
    v_rcp_f32 v211, v211
    ds_read_b128 v[60:63], v223 offset:704
    v_mfma_f32_16x16x32_bf16 v[12:15], v[148:151], v[68:71], v[12:15]
K2_PAD_T2:
    s_cbranch_execz K2_HOP
    v_cvt_pk_bf16_f32 v184, v16, v17
    ds_read_b128 v[64:67], v223 offset:576
    s_waitcnt vmcnt(5) lgkmcnt(9)
    v_mfma_f32_16x16x32_bf16 v[4:7], v[152:155], v[72:75], v[4:7]
    v_cvt_pk_bf16_f32 v185, v18, v19
    ds_read_b128 v[68:71], v223 offset:832
    v_mfma_f32_16x16x32_bf16 v[8:11], v[152:155], v[76:79], v[8:11]
    v_mul_f32 v212, s63, v32
    v_mul_f32 v213, s63, v33
    ds_read_b128 v[72:75], v223 offset:1024
    s_waitcnt lgkmcnt(9)
    v_mfma_f32_16x16x32_bf16 v[12:15], v[152:155], v[80:83], v[12:15]
    v_mul_f32 v214, s63, v34
    ds_read_b128 v[76:79], v223 offset:1280
    s_waitcnt vmcnt(4)
    v_mfma_f32_16x16x32_bf16 v[4:7], v[156:159], v[84:87], v[4:7]
    v_mul_f32 v215, s63, v35
    ds_read_b128 v[80:83], v223 offset:1152
    s_waitcnt lgkmcnt(9)
    v_mfma_f32_16x16x32_bf16 v[8:11], v[156:159], v[88:91], v[8:11]
    v_exp_f32 v212, v212
    ds_read_b128 v[84:87], v223 offset:1088
    v_mfma_f32_16x16x32_bf16 v[12:15], v[156:159], v[92:95], v[12:15]
    v_exp_f32 v213, v213
    ds_read_b128 v[88:91], v223 offset:1344
    s_waitcnt vmcnt(3) lgkmcnt(9)
    v_mfma_f32_16x16x32_bf16 v[4:7], v[160:163], v[48:51], v[4:7]
    v_exp_f32 v214, v214
    ds_read_b128 v[92:95], v223 offset:1216
    v_mfma_f32_16x16x32_bf16 v[8:11], v[160:163], v[52:55], v[8:11]
    v_exp_f32 v215, v215
    ds_read_b128 v[48:51], v222 offset:3200
    s_waitcnt lgkmcnt(9)
    v_mfma_f32_16x16x32_bf16 v[12:15], v[160:163], v[56:59], v[12:15]
    v_add_f32 v212, 1.0, v212
    ds_read_b128 v[52:55], v222 offset:3456
    s_waitcnt vmcnt(2)
    v_mfma_f32_16x16x32_bf16 v[4:7], v[164:167], v[60:63], v[4:7]
    v_add_f32 v213, 1.0, v213
    v_add_f32 v214, 1.0, v214
    ds_read_b128 v[56:59], v222 offset:3328
    s_waitcnt lgkmcnt(9)
    v_mfma_f32_16x16x32_bf16 v[8:11], v[164:167], v[64:67], v[8:11]
    v_add_f32 v215, 1.0, v215
    ds_read_b128 v[60:63], v222 offset:3264
    v_mfma_f32_16x16x32_bf16 v[12:15], v[164:167], v[68:71], v[12:15]
    v_rcp_f32 v212, v212
    s_setprio 0
    ds_read_b128 v[64:67], v222 offset:3520
    s_waitcnt vmcnt(1) lgkmcnt(9)
    v_mfma_f32_16x16x32_bf16 v[4:7], v[168:171], v[72:75], v[4:7]
    v_rcp_f32 v213, v213
    ds_read_b128 v[68:71], v222 offset:3392
    v_mfma_f32_16x16x32_bf16 v[8:11], v[168:171], v[76:79], v[8:11]
    v_rcp_f32 v214, v214
    ds_read_b128 v[72:75], v222 offset:3712
    s_waitcnt lgkmcnt(9)
    v_mfma_f32_16x16x32_bf16 v[12:15], v[168:171], v[80:83], v[12:15]
    v_rcp_f32 v215, v215
    ds_read_b128 v[76:79], v222 offset:3584
    s_waitcnt vmcnt(0)
    v_mfma_f32_16x16x32_bf16 v[4:7], v[172:175], v[84:87], v[4:7]
    v_cvt_pk_bf16_f32 v220, v32, v33
    ds_read_b128 v[80:83], v222 offset:3840
    s_waitcnt lgkmcnt(9)
    v_mfma_f32_16x16x32_bf16 v[8:11], v[172:175], v[88:91], v[8:11]
    v_cvt_pk_bf16_f32 v221, v34, v35
    ds_read_b128 v[84:87], v222 offset:3776
    v_mfma_f32_16x16x32_bf16 v[12:15], v[172:175], v[92:95], v[12:15]
    ds_read_b128 v[88:91], v222 offset:3648
    s_waitcnt lgkmcnt(9)
    v_mfma_f32_16x16x32_bf16 v[20:23], v[112:115], v[48:51], 0
    ds_read_b128 v[92:95], v222 offset:3904
    v_mfma_f32_16x16x32_bf16 v[24:27], v[112:115], v[52:55], 0
    ds_read_b128 v[48:51], v222 offset:4096
    s_waitcnt lgkmcnt(9)
    v_mfma_f32_16x16x32_bf16 v[28:31], v[112:115], v[56:59], 0
    s_barrier
    s_setprio 3
    ds_read_b128 v[52:55], v222 offset:4352
    v_mfma_f32_16x16x32_bf16 v[20:23], v[116:119], v[60:63], v[20:23]
    v_mul_f32 v4, v4, v204
    ds_read_b128 v[56:59], v222 offset:4224
    s_waitcnt lgkmcnt(9)
    v_mfma_f32_16x16x32_bf16 v[24:27], v[116:119], v[64:67], v[24:27]
    v_mul_f32 v5, v5, v205
    ds_read_b128 v[60:63], v222 offset:4160
    v_mfma_f32_16x16x32_bf16 v[28:31], v[116:119], v[68:71], v[28:31]
    v_mul_f32 v6, v6, v206
    ds_read_b128 v[64:67], v222 offset:4416
    s_waitcnt lgkmcnt(9)
    v_mfma_f32_16x16x32_bf16 v[20:23], v[120:123], v[72:75], v[20:23]
    v_mul_f32 v7, v7, v207
    ds_read_b128 v[68:71], v222 offset:4288
    v_mfma_f32_16x16x32_bf16 v[24:27], v[120:123], v[76:79], v[24:27]
    v_cvt_pk_bf16_f32 v178, v4, v5
    ds_read_b128 v[72:75], v223 offset:33408
    s_waitcnt lgkmcnt(9)
    v_mfma_f32_16x16x32_bf16 v[28:31], v[120:123], v[80:83], v[28:31]
    v_cvt_pk_bf16_f32 v179, v6, v7
    ds_read_b128 v[76:79], v223 offset:33664
    v_mfma_f32_16x16x32_bf16 v[20:23], v[124:127], v[84:87], v[20:23]
    v_mul_f32 v8, v8, v204
    ds_read_b128 v[80:83], v223 offset:33536
    s_waitcnt lgkmcnt(9)
    v_mfma_f32_16x16x32_bf16 v[24:27], v[124:127], v[88:91], v[24:27]
    v_mul_f32 v9, v9, v205
    ds_read_b128 v[84:87], v223 offset:33472
    v_mfma_f32_16x16x32_bf16 v[28:31], v[124:127], v[92:95], v[28:31]
    v_mul_f32 v10, v10, v206
    ds_read_b128 v[88:91], v223 offset:33728
    s_waitcnt lgkmcnt(9)
    v_mfma_f32_16x16x32_bf16 v[20:23], v[144:147], v[48:51], v[20:23]
    v_mul_f32 v11, v11, v207
    s_setprio 2
    ds_read_b128 v[92:95], v223 offset:33600
    v_mfma_f32_16x16x32_bf16 v[24:27], v[144:147], v[52:55], v[24:27]
    v_cvt_pk_bf16_f32 v180, v8, v9
    ds_read_b128 v[48:51], v223 offset:33920
    s_waitcnt lgkmcnt(9)
    v_mfma_f32_16x16x32_bf16 v[28:31], v[144:147], v[56:59], v[28:31]
    v_cvt_pk_bf16_f32 v181, v10, v11
    ds_read_b128 v[52:55], v223 offset:33792
    v_mfma_f32_16x16x32_bf16 v[20:23], v[148:151], v[60:63], v[20:23]
    v_mul_f32 v12, v12, v204
    ds_read_b128 v[56:59], v223 offset:34048
    s_waitcnt lgkmcnt(9)
    v_mfma_f32_16x16x32_bf16 v[24:27], v[148:151], v[64:67], v[24:27]
    v_mul_f32 v13, v13, v205
    ds_read_b128 v[60:63], v223 offset:33984
    v_mfma_f32_16x16x32_bf16 v[28:31], v[148:151], v[68:71], v[28:31]
    v_mul_f32 v14, v14, v206
    ds_read_b128 v[64:67], v223 offset:33856
    s_waitcnt lgkmcnt(9)
    v_mfma_f32_16x16x32_bf16 v[20:23], v[152:155], v[72:75], v[20:23]
    v_mul_f32 v15, v15, v207
    ds_read_b128 v[68:71], v223 offset:34112
    v_mfma_f32_16x16x32_bf16 v[24:27], v[152:155], v[76:79], v[24:27]
    v_cvt_pk_bf16_f32 v182, v12, v13
    ds_read_b128 v[72:75], v223 offset:34304
    s_waitcnt lgkmcnt(9)
    v_mfma_f32_16x16x32_bf16 v[28:31], v[152:155], v[80:83], v[28:31]
    v_cvt_pk_bf16_f32 v183, v14, v15
    ds_read_b128 v[76:79], v223 offset:34560
    v_mfma_f32_16x16x32_bf16 v[20:23], v[156:159], v[84:87], v[20:23]
    ds_write_b64 v254, v[176:177] offset:0
    ds_write_b64 v254, v[178:179] offset:256
    ds_write_b64 v254, v[180:181] offset:512
    ds_write_b64 v254, v[182:183] offset:768
    ds_write_b64 v255, v[220:221] offset:0
    ds_read_b128 v[80:83], v223 offset:34432
    s_waitcnt lgkmcnt(14)
    v_mfma_f32_16x16x32_bf16 v[24:27], v[156:159], v[88:91], v[24:27]
    ds_read_b128 v[84:87], v223 offset:34368
    v_mfma_f32_16x16x32_bf16 v[28:31], v[156:159], v[92:95], v[28:31]
    s_setprio 1
    ds_read_b128 v[88:91], v223 offset:34624
    s_waitcnt lgkmcnt(14)
    v_mfma_f32_16x16x32_bf16 v[20:23], v[160:163], v[48:51], v[20:23]
    ds_read_b128 v[92:95], v223 offset:34496
    v_mfma_f32_16x16x32_bf16 v[24:27], v[160:163], v[52:55], v[24:27]
    ds_read_b128 v[48:51], v247 offset:6272
    s_waitcnt lgkmcnt(14)
    v_mfma_f32_16x16x32_bf16 v[28:31], v[160:163], v[56:59], v[28:31]
    ds_read_b128 v[52:55], v232 offset:6528
    v_mfma_f32_16x16x32_bf16 v[20:23], v[164:167], v[60:63], v[20:23]
    ds_read_b128 v[56:59], v247 offset:6336
    s_waitcnt lgkmcnt(14)
    v_mfma_f32_16x16x32_bf16 v[24:27], v[164:167], v[64:67], v[24:27]
    ds_read_b128 v[60:63], v232 offset:6592
    v_mfma_f32_16x16x32_bf16 v[28:31], v[164:167], v[68:71], v[28:31]
    ds_read_b128 v[64:67], v247 offset:6784
    s_waitcnt lgkmcnt(14)
    v_mfma_f32_16x16x32_bf16 v[20:23], v[168:171], v[72:75], v[20:23]
    ds_read_b128 v[68:71], v232 offset:6656
    v_mfma_f32_16x16x32_bf16 v[24:27], v[168:171], v[76:79], v[24:27]
    ds_read_b128 v[72:75], v247 offset:6848
    s_waitcnt lgkmcnt(9)
    v_mfma_f32_16x16x32_bf16 v[28:31], v[168:171], v[80:83], v[28:31]
    ds_read_b128 v[76:79], v232 offset:6720
    v_mfma_f32_16x16x32_bf16 v[20:23], v[172:175], v[84:87], v[20:23]
    s_setprio 0
    ds_read_b128 v[80:83], v247 offset:7168
    s_waitcnt lgkmcnt(9)
    v_mfma_f32_16x16x32_bf16 v[24:27], v[172:175], v[88:91], v[24:27]
    ds_read_b128 v[84:87], v232 offset:7424
    v_mfma_f32_16x16x32_bf16 v[28:31], v[172:175], v[92:95], v[28:31]
    ds_read_b128 v[88:91], v247 offset:7232
    s_waitcnt lgkmcnt(9)
    v_mfma_f32_16x16x32_bf16 v[36:39], v[112:115], v[48:51], 0
    ds_read_b128 v[92:95], v232 offset:7488
    v_mfma_f32_16x16x32_bf16 v[40:43], v[112:115], v[52:55], 0
    ds_read_b128 v[48:51], v248 offset:128
    s_waitcnt lgkmcnt(9)
    v_mfma_f32_16x16x32_bf16 v[36:39], v[116:119], v[56:59], v[36:39]
    s_barrier
    ds_read_b128 v[192:195], v228 offset:0
    ds_read_b128 v[196:199], v228 offset:1536
    s_setprio 3
    ds_read_b128 v[52:55], v225 offset:384
    v_mfma_f32_16x16x32_bf16 v[40:43], v[116:119], v[60:63], v[40:43]
    v_mul_f32 v20, v20, v208
    v_mul_f32 v21, v21, v209
    ds_read_b128 v[56:59], v248 offset:192
    s_waitcnt lgkmcnt(11)
    v_mfma_f32_16x16x32_bf16 v[36:39], v[120:123], v[64:67], v[36:39]
    v_mul_f32 v22, v22, v210
    ds_read_b128 v[60:63], v225 offset:448
    v_mfma_f32_16x16x32_bf16 v[40:43], v[120:123], v[68:71], v[40:43]
    v_mul_f32 v23, v23, v211
    ds_read_b128 v[64:67], v248 offset:640
    s_waitcnt lgkmcnt(11)
    v_mfma_f32_16x16x32_bf16 v[36:39], v[124:127], v[72:75], v[36:39]
    v_cvt_pk_bf16_f32 v186, v20, v21
    ds_read_b128 v[68:71], v225 offset:512
    v_mfma_f32_16x16x32_bf16 v[40:43], v[124:127], v[76:79], v[40:43]
    v_cvt_pk_bf16_f32 v187, v22, v23
    ds_read_b128 v[72:75], v248 offset:704
    s_waitcnt lgkmcnt(11)
    v_mfma_f32_16x16x32_bf16 v[36:39], v[144:147], v[80:83], v[36:39]
    v_mul_f32 v24, v24, v208
    v_mul_f32 v25, v25, v209
    s_waitcnt lgkmcnt(6)
    buffer_store_dwordx4 v[192:195], v229, s[12:15], s40 offen sc1
    buffer_store_dwordx4 v[196:199], v229, s[12:15], s41 offen sc1
    s_setprio 2
    ds_read_b128 v[76:79], v225 offset:576
    v_mfma_f32_16x16x32_bf16 v[40:43], v[144:147], v[84:87], v[40:43]
    v_mul_f32 v26, v26, v210
    ds_read_b128 v[80:83], v248 offset:1024
    v_mfma_f32_16x16x32_bf16 v[36:39], v[148:151], v[88:91], v[36:39]
    v_mul_f32 v27, v27, v211
    ds_read_b128 v[84:87], v225 offset:1280
    v_mfma_f32_16x16x32_bf16 v[40:43], v[148:151], v[92:95], v[40:43]
    v_cvt_pk_bf16_f32 v188, v24, v25
    ds_read_b128 v[88:91], v248 offset:1088
    s_waitcnt lgkmcnt(9)
    v_mfma_f32_16x16x32_bf16 v[36:39], v[152:155], v[48:51], v[36:39]
    v_cvt_pk_bf16_f32 v189, v26, v27
    ds_read_b128 v[92:95], v225 offset:1344
    v_mfma_f32_16x16x32_bf16 v[40:43], v[152:155], v[52:55], v[40:43]
    v_mul_f32 v28, v28, v208
    v_mul_f32 v29, v29, v209
    s_waitcnt lgkmcnt(8)
    v_mfma_f32_16x16x32_bf16 v[36:39], v[156:159], v[56:59], v[36:39]
    v_mul_f32 v30, v30, v210
    v_mfma_f32_16x16x32_bf16 v[40:43], v[156:159], v[60:63], v[40:43]
    v_mul_f32 v31, v31, v211
    s_setprio 1
    s_waitcnt lgkmcnt(6)
    v_mfma_f32_16x16x32_bf16 v[36:39], v[160:163], v[64:67], v[36:39]
    v_cvt_pk_bf16_f32 v190, v28, v29
    v_mfma_f32_16x16x32_bf16 v[40:43], v[160:163], v[68:71], v[40:43]
    v_cvt_pk_bf16_f32 v191, v30, v31
    s_waitcnt lgkmcnt(4)
    v_mfma_f32_16x16x32_bf16 v[36:39], v[164:167], v[72:75], v[36:39]
    ds_write_b64 v254, v[184:185] offset:3072
    ds_write_b64 v254, v[186:187] offset:3328
    ds_write_b64 v254, v[188:189] offset:3584
    ds_write_b64 v254, v[190:191] offset:3840
    v_mfma_f32_16x16x32_bf16 v[40:43], v[164:167], v[76:79], v[40:43]
    s_waitcnt lgkmcnt(6)
    v_mfma_f32_16x16x32_bf16 v[36:39], v[168:171], v[80:83], v[36:39]
    v_mfma_f32_16x16x32_bf16 v[40:43], v[168:171], v[84:87], v[40:43]
    s_setprio 0
    s_waitcnt lgkmcnt(4)
    v_mfma_f32_16x16x32_bf16 v[36:39], v[172:175], v[88:91], v[36:39]
    v_mfma_f32_16x16x32_bf16 v[40:43], v[172:175], v[92:95], v[40:43]
    s_nop 6
    v_mul_f32 v36, v36, v212
    v_mul_f32 v37, v37, v213
    v_mul_f32 v38, v38, v214
    v_mul_f32 v39, v39, v215
    v_cvt_pk_bf16_f32 v178, v36, v37
    v_cvt_pk_bf16_f32 v179, v38, v39
    v_mul_f32 v40, v40, v212
    v_mul_f32 v41, v41, v213
    v_mul_f32 v42, v42, v214
    v_mul_f32 v43, v43, v215
    v_cvt_pk_bf16_f32 v180, v40, v41
    v_cvt_pk_bf16_f32 v181, v42, v43
    ds_write_b64 v246, v[178:179] offset:256
    ds_write_b64 v255, v[180:181] offset:512
    s_waitcnt lgkmcnt(0)
    s_barrier
    ds_read_b128 v[192:195], v228 offset:3072
    ds_read_b128 v[196:199], v228 offset:4608
    ds_read_b128 v[200:203], v249
    s_waitcnt lgkmcnt(1)
    buffer_store_dwordx4 v[192:195], v229, s[12:15], s42 offen sc1
    buffer_store_dwordx4 v[196:199], v229, s[12:15], s43 offen sc1
K2_LASTROW:
    s_add_u32 s59, s20, 32
    s_cmp_ge_u32 s59, s22
    s_cbranch_scc1 K2_FIN
    s_waitcnt lgkmcnt(0)
    buffer_store_dwordx4 v[200:203], v229, s[12:15], s44 offen sc1
K2_FIN:
    s_endpgm
K2_MULTI:
    ds_read_b128 v[48:51], v222 offset:0
    ds_read_b128 v[52:55], v222 offset:64
    ds_read_b128 v[56:59], v222 offset:896
    ds_read_b128 v[60:63], v222 offset:960
    ds_read_b128 v[64:67], v223 offset:0
    ds_read_b128 v[68:71], v223 offset:64
    ds_read_b128 v[72:75], v223 offset:896
    ds_read_b128 v[76:79], v223 offset:960
    ds_read_b128 v[80:83], v222 offset:3072
    ds_read_b128 v[84:87], v222 offset:3136
    ds_read_b128 v[88:91], v222 offset:3968
    s_waitcnt vmcnt(19) lgkmcnt(9)
    v_mfma_f32_16x16x32_bf16 v[0:3], v[96:99], v[48:51], 0
    ds_read_b128 v[92:95], v222 offset:4032
    s_waitcnt vmcnt(18)
    v_mfma_f32_16x16x32_bf16 v[0:3], v[100:103], v[52:55], v[0:3]
    ds_read_b128 v[48:51], v223 offset:33280
    s_waitcnt vmcnt(17) lgkmcnt(9)
    v_mfma_f32_16x16x32_bf16 v[0:3], v[104:107], v[56:59], v[0:3]
    ds_read_b128 v[52:55], v223 offset:33344
    s_waitcnt vmcnt(16)
    v_mfma_f32_16x16x32_bf16 v[0:3], v[108:111], v[60:63], v[0:3]
    ds_read_b128 v[56:59], v223 offset:34176
    s_waitcnt vmcnt(15) lgkmcnt(9)
    v_mfma_f32_16x16x32_bf16 v[0:3], v[128:131], v[64:67], v[0:3]
    ds_read_b128 v[60:63], v223 offset:34240
    s_waitcnt vmcnt(14)
    v_mfma_f32_16x16x32_bf16 v[0:3], v[132:135], v[68:71], v[0:3]
    ds_read_b128 v[64:67], v232 offset:6144
    s_waitcnt vmcnt(13) lgkmcnt(9)
    v_mfma_f32_16x16x32_bf16 v[0:3], v[136:139], v[72:75], v[0:3]
    ds_read_b128 v[68:71], v232 offset:6208
    s_waitcnt vmcnt(12)
    v_mfma_f32_16x16x32_bf16 v[0:3], v[140:143], v[76:79], v[0:3]
    ds_read_b128 v[72:75], v232 offset:7040
    s_waitcnt lgkmcnt(9)
    v_mfma_f32_16x16x32_bf16 v[16:19], v[96:99], v[80:83], 0
    ds_read_b128 v[76:79], v232 offset:7104
    v_mfma_f32_16x16x32_bf16 v[16:19], v[100:103], v[84:87], v[16:19]
    ds_read_b128 v[80:83], v225 offset:0
    s_waitcnt lgkmcnt(9)
    v_mfma_f32_16x16x32_bf16 v[16:19], v[104:107], v[88:91], v[16:19]
    ds_read_b128 v[84:87], v225 offset:64
    v_mfma_f32_16x16x32_bf16 v[16:19], v[108:111], v[92:95], v[16:19]
    ds_read_b128 v[88:91], v225 offset:896
    s_waitcnt lgkmcnt(9)
    v_mfma_f32_16x16x32_bf16 v[16:19], v[128:131], v[48:51], v[16:19]
    ds_read_b128 v[92:95], v225 offset:960
    v_mfma_f32_16x16x32_bf16 v[16:19], v[132:135], v[52:55], v[16:19]
    ds_read_b128 v[48:51], v222 offset:128
    s_waitcnt lgkmcnt(9)
    v_mfma_f32_16x16x32_bf16 v[16:19], v[136:139], v[56:59], v[16:19]
    ds_read_b128 v[52:55], v222 offset:384
    v_mfma_f32_16x16x32_bf16 v[16:19], v[140:143], v[60:63], v[16:19]
    ds_read_b128 v[56:59], v222 offset:256
    s_waitcnt lgkmcnt(9)
    v_mfma_f32_16x16x32_bf16 v[32:35], v[96:99], v[64:67], 0
    ds_read_b128 v[60:63], v222 offset:192
    v_mfma_f32_16x16x32_bf16 v[32:35], v[100:103], v[68:71], v[32:35]
    ds_read_b128 v[64:67], v222 offset:448
    s_waitcnt lgkmcnt(9)
    v_mfma_f32_16x16x32_bf16 v[32:35], v[104:107], v[72:75], v[32:35]
    ds_read_b128 v[68:71], v222 offset:320
    v_mfma_f32_16x16x32_bf16 v[32:35], v[108:111], v[76:79], v[32:35]
    ds_read_b128 v[72:75], v222 offset:640
    s_waitcnt lgkmcnt(9)
    v_mfma_f32_16x16x32_bf16 v[32:35], v[128:131], v[80:83], v[32:35]
    ds_read_b128 v[76:79], v222 offset:512
    v_mfma_f32_16x16x32_bf16 v[32:35], v[132:135], v[84:87], v[32:35]
    ds_read_b128 v[80:83], v222 offset:768
    s_waitcnt lgkmcnt(9)
    v_mfma_f32_16x16x32_bf16 v[32:35], v[136:139], v[88:91], v[32:35]
    ds_read_b128 v[84:87], v222 offset:704
    v_mfma_f32_16x16x32_bf16 v[32:35], v[140:143], v[92:95], v[32:35]
    ds_read_b128 v[88:91], v222 offset:576
    s_waitcnt vmcnt(11) lgkmcnt(9)
    v_mfma_f32_16x16x32_bf16 v[4:7], v[112:115], v[48:51], 0
    ds_read_b128 v[92:95], v222 offset:832
    v_mfma_f32_16x16x32_bf16 v[8:11], v[112:115], v[52:55], 0
    ds_read_b128 v[48:51], v222 offset:1024
    s_waitcnt lgkmcnt(9)
    v_mfma_f32_16x16x32_bf16 v[12:15], v[112:115], v[56:59], 0
    ds_read_b128 v[52:55], v222 offset:1280
    s_waitcnt vmcnt(10)
    v_mfma_f32_16x16x32_bf16 v[4:7], v[116:119], v[60:63], v[4:7]
    ds_read_b128 v[56:59], v222 offset:1152
    s_waitcnt lgkmcnt(9)
    v_mfma_f32_16x16x32_bf16 v[8:11], v[116:119], v[64:67], v[8:11]
    ds_read_b128 v[60:63], v222 offset:1088
    v_mfma_f32_16x16x32_bf16 v[12:15], v[116:119], v[68:71], v[12:15]
    ds_read_b128 v[64:67], v222 offset:1344
    s_waitcnt vmcnt(9) lgkmcnt(9)
    v_mfma_f32_16x16x32_bf16 v[4:7], v[120:123], v[72:75], v[4:7]
    ds_read_b128 v[68:71], v222 offset:1216
    v_mfma_f32_16x16x32_bf16 v[8:11], v[120:123], v[76:79], v[8:11]
    ds_read_b128 v[72:75], v223 offset:128
    s_waitcnt lgkmcnt(9)
    v_mfma_f32_16x16x32_bf16 v[12:15], v[120:123], v[80:83], v[12:15]
    ds_read_b128 v[76:79], v223 offset:384
    s_waitcnt vmcnt(8)
    v_mfma_f32_16x16x32_bf16 v[4:7], v[124:127], v[84:87], v[4:7]
    ds_read_b128 v[80:83], v223 offset:256
    s_waitcnt lgkmcnt(9)
    v_mfma_f32_16x16x32_bf16 v[8:11], v[124:127], v[88:91], v[8:11]
    ds_read_b128 v[84:87], v223 offset:192
    v_mfma_f32_16x16x32_bf16 v[12:15], v[124:127], v[92:95], v[12:15]
    ds_read_b128 v[88:91], v223 offset:448
    s_waitcnt vmcnt(7) lgkmcnt(9)
    v_mfma_f32_16x16x32_bf16 v[4:7], v[144:147], v[48:51], v[4:7]
    ds_read_b128 v[92:95], v223 offset:320
    v_mfma_f32_16x16x32_bf16 v[8:11], v[144:147], v[52:55], v[8:11]
    ds_read_b128 v[48:51], v223 offset:640
    s_waitcnt lgkmcnt(9)
    v_mfma_f32_16x16x32_bf16 v[12:15], v[144:147], v[56:59], v[12:15]
    ds_read_b128 v[52:55], v223 offset:512
    s_waitcnt vmcnt(6)
    v_mfma_f32_16x16x32_bf16 v[4:7], v[148:151], v[60:63], v[4:7]
    ds_read_b128 v[56:59], v223 offset:768
    s_waitcnt lgkmcnt(9)
    v_mfma_f32_16x16x32_bf16 v[8:11], v[148:151], v[64:67], v[8:11]
    ds_read_b128 v[60:63], v223 offset:704
    v_mfma_f32_16x16x32_bf16 v[12:15], v[148:151], v[68:71], v[12:15]
    ds_read_b128 v[64:67], v223 offset:576
    s_waitcnt vmcnt(5) lgkmcnt(9)
    v_mfma_f32_16x16x32_bf16 v[4:7], v[152:155], v[72:75], v[4:7]
    ds_read_b128 v[68:71], v223 offset:832
    v_mfma_f32_16x16x32_bf16 v[8:11], v[152:155], v[76:79], v[8:11]
    ds_read_b128 v[72:75], v223 offset:1024
    s_waitcnt lgkmcnt(9)
    v_mfma_f32_16x16x32_bf16 v[12:15], v[152:155], v[80:83], v[12:15]
    ds_read_b128 v[76:79], v223 offset:1280
    s_waitcnt vmcnt(4)
    v_mfma_f32_16x16x32_bf16 v[4:7], v[156:159], v[84:87], v[4:7]
    ds_read_b128 v[80:83], v223 offset:1152
    s_waitcnt lgkmcnt(9)
    v_mfma_f32_16x16x32_bf16 v[8:11], v[156:159], v[88:91], v[8:11]
    ds_read_b128 v[84:87], v223 offset:1088
    v_mfma_f32_16x16x32_bf16 v[12:15], v[156:159], v[92:95], v[12:15]
    ds_read_b128 v[88:91], v223 offset:1344
    s_waitcnt vmcnt(3) lgkmcnt(9)
    v_mfma_f32_16x16x32_bf16 v[4:7], v[160:163], v[48:51], v[4:7]
    ds_read_b128 v[92:95], v223 offset:1216
    v_mfma_f32_16x16x32_bf16 v[8:11], v[160:163], v[52:55], v[8:11]
    ds_read_b128 v[48:51], v222 offset:3200
    s_waitcnt lgkmcnt(9)
    v_mfma_f32_16x16x32_bf16 v[12:15], v[160:163], v[56:59], v[12:15]
    ds_read_b128 v[52:55], v222 offset:3456
    s_waitcnt vmcnt(2)
    v_mfma_f32_16x16x32_bf16 v[4:7], v[164:167], v[60:63], v[4:7]
    ds_read_b128 v[56:59], v222 offset:3328
    s_waitcnt lgkmcnt(9)
    v_mfma_f32_16x16x32_bf16 v[8:11], v[164:167], v[64:67], v[8:11]
    ds_read_b128 v[60:63], v222 offset:3264
    v_mfma_f32_16x16x32_bf16 v[12:15], v[164:167], v[68:71], v[12:15]
    ds_read_b128 v[64:67], v222 offset:3520
    s_waitcnt vmcnt(1) lgkmcnt(9)
    v_mfma_f32_16x16x32_bf16 v[4:7], v[168:171], v[72:75], v[4:7]
    ds_read_b128 v[68:71], v222 offset:3392
    v_mfma_f32_16x16x32_bf16 v[8:11], v[168:171], v[76:79], v[8:11]
    ds_read_b128 v[72:75], v222 offset:3712
    s_waitcnt lgkmcnt(9)
    v_mfma_f32_16x16x32_bf16 v[12:15], v[168:171], v[80:83], v[12:15]
    ds_read_b128 v[76:79], v222 offset:3584
    s_waitcnt vmcnt(0)
    v_mfma_f32_16x16x32_bf16 v[4:7], v[172:175], v[84:87], v[4:7]
    ds_read_b128 v[80:83], v222 offset:3840
    s_waitcnt lgkmcnt(9)
    v_mfma_f32_16x16x32_bf16 v[8:11], v[172:175], v[88:91], v[8:11]
    ds_read_b128 v[84:87], v222 offset:3776
    v_mfma_f32_16x16x32_bf16 v[12:15], v[172:175], v[92:95], v[12:15]
    ds_read_b128 v[88:91], v222 offset:3648
    s_waitcnt lgkmcnt(9)
    v_mfma_f32_16x16x32_bf16 v[20:23], v[112:115], v[48:51], 0
    ds_read_b128 v[92:95], v222 offset:3904
    v_mfma_f32_16x16x32_bf16 v[24:27], v[112:115], v[52:55], 0
    ds_read_b128 v[48:51], v222 offset:4096
    s_waitcnt lgkmcnt(9)
    v_mfma_f32_16x16x32_bf16 v[28:31], v[112:115], v[56:59], 0
    ds_read_b128 v[52:55], v222 offset:4352
    v_mfma_f32_16x16x32_bf16 v[20:23], v[116:119], v[60:63], v[20:23]
    ds_read_b128 v[56:59], v222 offset:4224
    s_waitcnt lgkmcnt(9)
    v_mfma_f32_16x16x32_bf16 v[24:27], v[116:119], v[64:67], v[24:27]
    ds_read_b128 v[60:63], v222 offset:4160
    v_mfma_f32_16x16x32_bf16 v[28:31], v[116:119], v[68:71], v[28:31]
    ds_read_b128 v[64:67], v222 offset:4416
    s_waitcnt lgkmcnt(9)
    v_mfma_f32_16x16x32_bf16 v[20:23], v[120:123], v[72:75], v[20:23]
    ds_read_b128 v[68:71], v222 offset:4288
    v_mfma_f32_16x16x32_bf16 v[24:27], v[120:123], v[76:79], v[24:27]
    ds_read_b128 v[72:75], v223 offset:33408
    s_waitcnt lgkmcnt(9)
    v_mfma_f32_16x16x32_bf16 v[28:31], v[120:123], v[80:83], v[28:31]
    ds_read_b128 v[76:79], v223 offset:33664
    v_mfma_f32_16x16x32_bf16 v[20:23], v[124:127], v[84:87], v[20:23]
    ds_read_b128 v[80:83], v223 offset:33536
    s_waitcnt lgkmcnt(9)
    v_mfma_f32_16x16x32_bf16 v[24:27], v[124:127], v[88:91], v[24:27]
    ds_read_b128 v[84:87], v223 offset:33472
    v_mfma_f32_16x16x32_bf16 v[28:31], v[124:127], v[92:95], v[28:31]
    ds_read_b128 v[88:91], v223 offset:33728
    s_waitcnt lgkmcnt(9)
    v_mfma_f32_16x16x32_bf16 v[20:23], v[144:147], v[48:51], v[20:23]
    ds_read_b128 v[92:95], v223 offset:33600
    v_mfma_f32_16x16x32_bf16 v[24:27], v[144:147], v[52:55], v[24:27]
    ds_read_b128 v[48:51], v223 offset:33920
    s_waitcnt lgkmcnt(9)
    v_mfma_f32_16x16x32_bf16 v[28:31], v[144:147], v[56:59], v[28:31]
    ds_read_b128 v[52:55], v223 offset:33792
    v_mfma_f32_16x16x32_bf16 v[20:23], v[148:151], v[60:63], v[20:23]
    ds_read_b128 v[56:59], v223 offset:34048
    s_waitcnt lgkmcnt(9)
    v_mfma_f32_16x16x32_bf16 v[24:27], v[148:151], v[64:67], v[24:27]
    ds_read_b128 v[60:63], v223 offset:33984
    v_mfma_f32_16x16x32_bf16 v[28:31], v[148:151], v[68:71], v[28:31]
    ds_read_b128 v[64:67], v223 offset:33856
    s_waitcnt lgkmcnt(9)
    v_mfma_f32_16x16x32_bf16 v[20:23], v[152:155], v[72:75], v[20:23]
    ds_read_b128 v[68:71], v223 offset:34112
    v_mfma_f32_16x16x32_bf16 v[24:27], v[152:155], v[76:79], v[24:27]
    ds_read_b128 v[72:75], v223 offset:34304
    s_waitcnt lgkmcnt(9)
    v_mfma_f32_16x16x32_bf16 v[28:31], v[152:155], v[80:83], v[28:31]
    ds_read_b128 v[76:79], v223 offset:34560
    v_mfma_f32_16x16x32_bf16 v[20:23], v[156:159], v[84:87], v[20:23]
    ds_read_b128 v[80:83], v223 offset:34432
    s_waitcnt lgkmcnt(9)
    v_mfma_f32_16x16x32_bf16 v[24:27], v[156:159], v[88:91], v[24:27]
    ds_read_b128 v[84:87], v223 offset:34368
    v_mfma_f32_16x16x32_bf16 v[28:31], v[156:159], v[92:95], v[28:31]
    ds_read_b128 v[88:91], v223 offset:34624
    s_waitcnt lgkmcnt(9)
    v_mfma_f32_16x16x32_bf16 v[20:23], v[160:163], v[48:51], v[20:23]
    ds_read_b128 v[92:95], v223 offset:34496
    v_mfma_f32_16x16x32_bf16 v[24:27], v[160:163], v[52:55], v[24:27]
    ds_read_b128 v[48:51], v247 offset:6272
    s_waitcnt lgkmcnt(9)
    v_mfma_f32_16x16x32_bf16 v[28:31], v[160:163], v[56:59], v[28:31]
    ds_read_b128 v[52:55], v232 offset:6528
    v_mfma_f32_16x16x32_bf16 v[20:23], v[164:167], v[60:63], v[20:23]
    ds_read_b128 v[56:59], v247 offset:6336
    s_waitcnt lgkmcnt(9)
    v_mfma_f32_16x16x32_bf16 v[24:27], v[164:167], v[64:67], v[24:27]
    ds_read_b128 v[60:63], v232 offset:6592
    v_mfma_f32_16x16x32_bf16 v[28:31], v[164:167], v[68:71], v[28:31]
    ds_read_b128 v[64:67], v247 offset:6784
    s_waitcnt lgkmcnt(9)
    v_mfma_f32_16x16x32_bf16 v[20:23], v[168:171], v[72:75], v[20:23]
    ds_read_b128 v[68:71], v232 offset:6656
    v_mfma_f32_16x16x32_bf16 v[24:27], v[168:171], v[76:79], v[24:27]
    ds_read_b128 v[72:75], v247 offset:6848
    s_waitcnt lgkmcnt(9)
    v_mfma_f32_16x16x32_bf16 v[28:31], v[168:171], v[80:83], v[28:31]
    ds_read_b128 v[76:79], v232 offset:6720
    v_mfma_f32_16x16x32_bf16 v[20:23], v[172:175], v[84:87], v[20:23]
    ds_read_b128 v[80:83], v247 offset:7168
    s_waitcnt lgkmcnt(9)
    v_mfma_f32_16x16x32_bf16 v[24:27], v[172:175], v[88:91], v[24:27]
    ds_read_b128 v[84:87], v232 offset:7424
    v_mfma_f32_16x16x32_bf16 v[28:31], v[172:175], v[92:95], v[28:31]
    ds_read_b128 v[88:91], v247 offset:7232
    s_waitcnt lgkmcnt(9)
    v_mfma_f32_16x16x32_bf16 v[36:39], v[112:115], v[48:51], 0
    ds_read_b128 v[92:95], v232 offset:7488
    v_mfma_f32_16x16x32_bf16 v[40:43], v[112:115], v[52:55], 0
    ds_read_b128 v[48:51], v248 offset:128
    s_waitcnt lgkmcnt(9)
    v_mfma_f32_16x16x32_bf16 v[36:39], v[116:119], v[56:59], v[36:39]
    ds_read_b128 v[52:55], v225 offset:384
    v_mfma_f32_16x16x32_bf16 v[40:43], v[116:119], v[60:63], v[40:43]
    ds_read_b128 v[56:59], v248 offset:192
    s_waitcnt lgkmcnt(9)
    v_mfma_f32_16x16x32_bf16 v[36:39], v[120:123], v[64:67], v[36:39]
    ds_read_b128 v[60:63], v225 offset:448
    v_mfma_f32_16x16x32_bf16 v[40:43], v[120:123], v[68:71], v[40:43]
    ds_read_b128 v[64:67], v248 offset:640
    s_waitcnt lgkmcnt(9)
    v_mfma_f32_16x16x32_bf16 v[36:39], v[124:127], v[72:75], v[36:39]
    ds_read_b128 v[68:71], v225 offset:512
    v_mfma_f32_16x16x32_bf16 v[40:43], v[124:127], v[76:79], v[40:43]
    ds_read_b128 v[72:75], v248 offset:704
    s_waitcnt lgkmcnt(9)
    v_mfma_f32_16x16x32_bf16 v[36:39], v[144:147], v[80:83], v[36:39]
    ds_read_b128 v[76:79], v225 offset:576
    v_mfma_f32_16x16x32_bf16 v[40:43], v[144:147], v[84:87], v[40:43]
    ds_read_b128 v[80:83], v248 offset:1024
    s_waitcnt lgkmcnt(9)
    v_mfma_f32_16x16x32_bf16 v[36:39], v[148:151], v[88:91], v[36:39]
    ds_read_b128 v[84:87], v225 offset:1280
    v_mfma_f32_16x16x32_bf16 v[40:43], v[148:151], v[92:95], v[40:43]
    ds_read_b128 v[88:91], v248 offset:1088
    s_waitcnt lgkmcnt(9)
    v_mfma_f32_16x16x32_bf16 v[36:39], v[152:155], v[48:51], v[36:39]
    ds_read_b128 v[92:95], v225 offset:1344
    v_mfma_f32_16x16x32_bf16 v[40:43], v[152:155], v[52:55], v[40:43]
    s_waitcnt lgkmcnt(8)
    v_mfma_f32_16x16x32_bf16 v[36:39], v[156:159], v[56:59], v[36:39]
    v_mfma_f32_16x16x32_bf16 v[40:43], v[156:159], v[60:63], v[40:43]
    s_waitcnt lgkmcnt(6)
    v_mfma_f32_16x16x32_bf16 v[36:39], v[160:163], v[64:67], v[36:39]
    v_mfma_f32_16x16x32_bf16 v[40:43], v[160:163], v[68:71], v[40:43]
    s_waitcnt lgkmcnt(4)
    v_mfma_f32_16x16x32_bf16 v[36:39], v[164:167], v[72:75], v[36:39]
    v_mfma_f32_16x16x32_bf16 v[40:43], v[164:167], v[76:79], v[40:43]
    s_waitcnt lgkmcnt(2)
    v_mfma_f32_16x16x32_bf16 v[36:39], v[168:171], v[80:83], v[36:39]
    v_mfma_f32_16x16x32_bf16 v[40:43], v[168:171], v[84:87], v[40:43]
    s_waitcnt lgkmcnt(0)
    v_mfma_f32_16x16x32_bf16 v[36:39], v[172:175], v[88:91], v[36:39]
    v_mfma_f32_16x16x32_bf16 v[40:43], v[172:175], v[92:95], v[40:43]
    s_lshl_b32 s60, s54, 9
    s_lshl_b32 s61, s20, 6
    s_add_u32 s60, s60, s61
    s_mul_i32 s60, s60, 192
    s_add_u32 s60, s60, 10485760
    v_mul_u32_u24 v227, 96, v252
    s_cmp_lg_u32 s28, 0
    s_cbranch_scc1 K2_NOACC
    buffer_load_dwordx4 v[48:51], v227, s[8:11], s60 offen offset:0
    buffer_load_dwordx4 v[52:55], v227, s[8:11], s60 offen offset:16
    buffer_load_dwordx4 v[56:59], v227, s[8:11], s60 offen offset:32
    buffer_load_dwordx4 v[60:63], v227, s[8:11], s60 offen offset:48
    buffer_load_dwordx4 v[64:67], v227, s[8:11], s60 offen offset:64
    buffer_load_dwordx4 v[68:71], v227, s[8:11], s60 offen offset:80
    buffer_load_dwordx4 v[72:75], v227, s[8:11], s60 offen offset:96
    buffer_load_dwordx4 v[76:79], v227, s[8:11], s60 offen offset:112
    buffer_load_dwordx4 v[80:83], v227, s[8:11], s60 offen offset:128
    buffer_load_dwordx4 v[84:87], v227, s[8:11], s60 offen offset:144
    buffer_load_dwordx4 v[88:91], v227, s[8:11], s60 offen offset:160
    s_waitcnt vmcnt(0)
    v_add_f32 v0, v0, v48
    v_add_f32 v1, v1, v49
    v_add_f32 v2, v2, v50
    v_add_f32 v3, v3, v51
    v_add_f32 v4, v4, v52
    v_add_f32 v5, v5, v53
    v_add_f32 v6, v6, v54
    v_add_f32 v7, v7, v55
    v_add_f32 v8, v8, v56
    v_add_f32 v9, v9, v57
    v_add_f32 v10, v10, v58
    v_add_f32 v11, v11, v59
    v_add_f32 v12, v12, v60
    v_add_f32 v13, v13, v61
    v_add_f32 v14, v14, v62
    v_add_f32 v15, v15, v63
    v_add_f32 v16, v16, v64
    v_add_f32 v17, v17, v65
    v_add_f32 v18, v18, v66
    v_add_f32 v19, v19, v67
    v_add_f32 v20, v20, v68
    v_add_f32 v21, v21, v69
    v_add_f32 v22, v22, v70
    v_add_f32 v23, v23, v71
    v_add_f32 v24, v24, v72
    v_add_f32 v25, v25, v73
    v_add_f32 v26, v26, v74
    v_add_f32 v27, v27, v75
    v_add_f32 v28, v28, v76
    v_add_f32 v29, v29, v77
    v_add_f32 v30, v30, v78
    v_add_f32 v31, v31, v79
    v_add_f32 v32, v32, v80
    v_add_f32 v33, v33, v81
    v_add_f32 v34, v34, v82
    v_add_f32 v35, v35, v83
    v_add_f32 v36, v36, v84
    v_add_f32 v37, v37, v85
    v_add_f32 v38, v38, v86
    v_add_f32 v39, v39, v87
    v_add_f32 v40, v40, v88
    v_add_f32 v41, v41, v89
    v_add_f32 v42, v42, v90
    v_add_f32 v43, v43, v91
K2_NOACC:
    s_barrier
    s_cmp_eq_u32 s55, 0
    s_cbranch_scc1 K2_SPILL
    s_bfe_u32 s60, s20, 0x10002
    s_lshl_b32 s60, s60, 4
    s_add_u32 s59, s59, s60
    v_add_u32 v228, s59, v229
    s_mul_i32 s60, s20, 2080
    s_add_u32 s60, s60, 65536
    v_add_u32 v249, s60, v229
    s_mov_b32 s63, 0xbfb8aa3b
    s_add_u32 s40, s20, s21
    s_lshl_b32 s40, s40, 10
    s_add_u32 s41, s40, 8192
    s_add_u32 s42, s40, 16384
    s_add_u32 s43, s40, 24576
    s_add_u32 s44, s40, 32768
    v_mul_f32 v204, s63, v0
    v_mul_f32 v205, s63, v1
    v_mul_f32 v206, s63, v2
    v_mul_f32 v207, s63, v3
    v_exp_f32 v204, v204
    v_exp_f32 v205, v205
    v_exp_f32 v206, v206
    v_exp_f32 v207, v207
    v_add_f32 v204, 1.0, v204
    v_add_f32 v205, 1.0, v205
    v_add_f32 v206, 1.0, v206
    v_add_f32 v207, 1.0, v207
    v_rcp_f32 v204, v204
    v_rcp_f32 v205, v205
    v_rcp_f32 v206, v206
    v_rcp_f32 v207, v207
    v_cvt_pk_bf16_f32 v176, v0, v1
    v_cvt_pk_bf16_f32 v177, v2, v3
    v_mul_f32 v4, v4, v204
    v_mul_f32 v5, v5, v205
    v_mul_f32 v6, v6, v206
    v_mul_f32 v7, v7, v207
    v_cvt_pk_bf16_f32 v178, v4, v5
    v_cvt_pk_bf16_f32 v179, v6, v7
    v_mul_f32 v8, v8, v204
    v_mul_f32 v9, v9, v205
    v_mul_f32 v10, v10, v206
    v_mul_f32 v11, v11, v207
    v_cvt_pk_bf16_f32 v180, v8, v9
    v_cvt_pk_bf16_f32 v181, v10, v11
    v_mul_f32 v12, v12, v204
    v_mul_f32 v13, v13, v205
    v_mul_f32 v14, v14, v206
    v_mul_f32 v15, v15, v207
    v_cvt_pk_bf16_f32 v182, v12, v13
    v_cvt_pk_bf16_f32 v183, v14, v15
    ds_write_b64 v254, v[176:177] offset:0
    ds_write_b64 v254, v[178:179] offset:256
    ds_write_b64 v254, v[180:181] offset:512
    ds_write_b64 v254, v[182:183] offset:768
    s_waitcnt lgkmcnt(0)
    s_barrier
    ds_read_b128 v[192:195], v228 offset:0
    ds_read_b128 v[196:199], v228 offset:1536
    s_waitcnt lgkmcnt(0)
    buffer_store_dwordx4 v[192:195], v229, s[12:15], s40 offen sc1
    buffer_store_dwordx4 v[196:199], v229, s[12:15], s41 offen sc1
    v_mul_f32 v208, s63, v16
    v_mul_f32 v209, s63, v17
    v_mul_f32 v210, s63, v18
    v_mul_f32 v211, s63, v19
    v_exp_f32 v208, v208
    v_exp_f32 v209, v209
    v_exp_f32 v210, v210
    v_exp_f32 v211, v211
    v_add_f32 v208, 1.0, v208
    v_add_f32 v209, 1.0, v209
    v_add_f32 v210, 1.0, v210
    v_add_f32 v211, 1.0, v211
    v_rcp_f32 v208, v208
    v_rcp_f32 v209, v209
    v_rcp_f32 v210, v210
    v_rcp_f32 v211, v211
    v_cvt_pk_bf16_f32 v184, v16, v17
    v_cvt_pk_bf16_f32 v185, v18, v19
    v_mul_f32 v20, v20, v208
    v_mul_f32 v21, v21, v209
    v_mul_f32 v22, v22, v210
    v_mul_f32 v23, v23, v211
    v_cvt_pk_bf16_f32 v186, v20, v21
    v_cvt_pk_bf16_f32 v187, v22, v23
    v_mul_f32 v24, v24, v208
    v_mul_f32 v25, v25, v209
    v_mul_f32 v26, v26, v210
    v_mul_f32 v27, v27, v211
    v_cvt_pk_bf16_f32 v188, v24, v25
    v_cvt_pk_bf16_f32 v189, v26, v27
    v_mul_f32 v28, v28, v208
    v_mul_f32 v29, v29, v209
    v_mul_f32 v30, v30, v210
    v_mul_f32 v31, v31, v211
    v_cvt_pk_bf16_f32 v190, v28, v29
    v_cvt_pk_bf16_f32 v191, v30, v31
    ds_write_b64 v254, v[184:185] offset:3072
    ds_write_b64 v254, v[186:187] offset:3328
    ds_write_b64 v254, v[188:189] offset:3584
    ds_write_b64 v254, v[190:191] offset:3840
    s_waitcnt lgkmcnt(0)
    s_barrier
    ds_read_b128 v[192:195], v228 offset:3072
    ds_read_b128 v[196:199], v228 offset:4608
    s_waitcnt lgkmcnt(0)
    buffer_store_dwordx4 v[192:195], v229, s[12:15], s42 offen sc1
    buffer_store_dwordx4 v[196:199], v229, s[12:15], s43 offen sc1
    v_mul_f32 v212, s63, v32
    v_mul_f32 v213, s63, v33
    v_mul_f32 v214, s63, v34
    v_mul_f32 v215, s63, v35
    v_exp_f32 v212, v212
    v_exp_f32 v213, v213
    v_exp_f32 v214, v214
    v_exp_f32 v215, v215
    v_add_f32 v212, 1.0, v212
    v_add_f32 v213, 1.0, v213
    v_add_f32 v214, 1.0, v214
    v_add_f32 v215, 1.0, v215
    v_rcp_f32 v212, v212
    v_rcp_f32 v213, v213
    v_rcp_f32 v214, v214
    v_rcp_f32 v215, v215
    v_cvt_pk_bf16_f32 v220, v32, v33
    v_cvt_pk_bf16_f32 v221, v34, v35
    v_mul_f32 v36, v36, v212
    v_mul_f32 v37, v37, v213
    v_mul_f32 v38, v38, v214
    v_mul_f32 v39, v39, v215
    v_cvt_pk_bf16_f32 v178, v36, v37
    v_cvt_pk_bf16_f32 v179, v38, v39
    v_mul_f32 v40, v40, v212
    v_mul_f32 v41, v41, v213
    v_mul_f32 v42, v42, v214
    v_mul_f32 v43, v43, v215
    v_cvt_pk_bf16_f32 v180, v40, v41
    v_cvt_pk_bf16_f32 v181, v42, v43
    ds_write_b64 v255, v[220:221] offset:0
    ds_write_b64 v246, v[178:179] offset:256
    ds_write_b64 v255, v[180:181] offset:512
    s_waitcnt lgkmcnt(0)
    s_barrier
    ds_read_b128 v[200:203], v249
    s_branch K2_LASTROW
K2_SPILL:
    buffer_store_dwordx4 v[0:3], v227, s[8:11], s60 offen offset:0
    buffer_store_dwordx4 v[4:7], v227, s[8:11], s60 offen offset:16
    buffer_store_dwordx4 v[8:11], v227, s[8:11], s60 offen offset:32
    buffer_store_dwordx4 v[12:15], v227, s[8:11], s60 offen offset:48
    buffer_store_dwordx4 v[16:19], v227, s[8:11], s60 offen offset:64
    buffer_store_dwordx4 v[20:23], v227, s[8:11], s60 offen offset:80
    buffer_store_dwordx4 v[24:27], v227, s[8:11], s60 offen offset:96
    buffer_store_dwordx4 v[28:31], v227, s[8:11], s60 offen offset:112
    buffer_store_dwordx4 v[32:35], v227, s[8:11], s60 offen offset:128
    buffer_store_dwordx4 v[36:39], v227, s[8:11], s60 offen offset:144
    buffer_store_dwordx4 v[40:43], v227, s[8:11], s60 offen offset:160
    s_mov_b32 s28, 0
    s_waitcnt vmcnt(0)
    s_cmp_lt_u32 s24, s25
    s_cbranch_scc1 K2_LOAD
    s_add_u32 s23, s23, 20
    s_branch K2_WINDOW
K2_WINDOW:
    s_mov_b32 s24, 0
    s_mov_b32 s25, 1
K2_LOAD:
    v_mbcnt_lo_u32_b32 v176, -1, 0
    v_mbcnt_hi_u32_b32 v176, -1, v176
    s_lshl_b32 s58, s20, 6
    v_add_u32 v177, s58, v176
    v_lshlrev_b32 v70, 4, v176
    s_mov_b32 s58, 7110656
    buffer_load_dwordx4 v[136:139], v70, s[8:11], s58 offen offset:0 sc1
    buffer_load_dwordx4 v[140:143], v70, s[8:11], s58 offen offset:1024 sc1
    s_mov_b32 s58, 7112704
    buffer_load_dwordx4 v[144:147], v70, s[8:11], s58 offen offset:0 sc1
    buffer_load_dwordx4 v[148:151], v70, s[8:11], s58 offen offset:1024 sc1
    s_mov_b32 s58, 7114752
    buffer_load_dwordx4 v[152:155], v70, s[8:11], s58 offen offset:0 sc1
    buffer_load_dwordx4 v[156:159], v70, s[8:11], s58 offen offset:1024 sc1
    s_mov_b32 s58, 7116800
    buffer_load_dwordx4 v[160:163], v70, s[8:11], s58 offen offset:0 sc1
    buffer_load_dwordx4 v[164:167], v70, s[8:11], s58 offen offset:1024 sc1
    s_mov_b32 s58, 7118848
    buffer_load_dwordx4 v[168:171], v70, s[8:11], s58 offen offset:0 sc1
    buffer_load_dwordx4 v[172:175], v70, s[8:11], s58 offen offset:1024 sc1
    s_mul_i32 s58, s20, 10400
    s_add_u32 s58, s58, 65536
    s_add_u32 s59, s58, 512
    v_and_b32 v76, 31, v176
    v_lshrrev_b32 v77, 5, v176
    v_mov_b32 v80, 0
    v_mul_u32_u24 v77, 2080, v77
    v_mov_b32 v81, 0xffff0000
    v_lshl_add_u32 v78, v76, 4, v77
    v_mov_b32 v82, 0
    v_add_u32 v78, s58, v78
    v_mov_b32 v83, v81
    v_add_u32 v85, 16, v176
    v_lshlrev_b32 v84, 5, v176
    v_lshrrev_b32 v85, 6, v85
    v_mul_u32_u24 v85, 1532, v85
    v_sub_u32 v84, v84, v85
    v_mov_b32 v85, -1
    v_add_u32 v84, s59, v84
    ds_write_b32 v84, v85 offset:0
    ds_write_b32 v84, v85 offset:2080
    ds_write_b32 v84, v85 offset:4160
    ds_write_b32 v84, v85 offset:6240
    ds_write_b32 v84, v85 offset:8320
    s_mov_b32 exec_hi, 0
    ds_write_b128 v78, v[80:83] offset:0
    ds_write_b128 v78, v[80:83] offset:2080
    ds_write_b128 v78, v[80:83] offset:4160
    ds_write_b128 v78, v[80:83] offset:6240
    ds_write_b128 v78, v[80:83] offset:8320
    s_mov_b32 exec_hi, -1
    s_cmp_lg_u32 s20, 7
    s_cbranch_scc1 K2_NOH
    v_mov_b32 v76, 0
    v_mov_b32 v77, -1
    v_lshlrev_b32 v78, 2, v176
    v_add_u32 v78, 163072, v78
    s_mov_b64 exec, 0x1ff
    ds_write_b32 v78, v76 offset:192
    s_mov_b32 exec_lo, -1
    ds_write_b32 v78, v77 offset:256
    s_mov_b64 exec, -1
    s_cmp_lg_u32 s24, 0
    s_cbranch_scc1 K2_NOH
    s_mov_b32 exec_hi, 0xffff
    ds_write_b32 v78, v76
    s_mov_b64 exec, 1
    ds_write_b32 v78, v76 offset:228
    s_mov_b64 exec, -1
K2_NOH:
    s_waitcnt lgkmcnt(0)
    s_barrier
    s_branch K2_CELLS
K2_LD_GEN:
    s_mov_b64 exec, s[42:43]
    s_cbranch_execz K2_LD_DONE
    buffer_load_dwordx4 v[4:7], v182, s[8:11], 0 offen sc1
    s_mov_b64 exec, s[44:45]
    s_cbranch_execz K2_LD_DONE
    buffer_load_dwordx4 v[8:11], v183, s[8:11], 0 offen sc1
    s_mov_b64 exec, s[46:47]
    s_cbranch_execz K2_LD_DONE
    buffer_load_dwordx4 v[12:15], v184, s[8:11], 0 offen sc1
    s_mov_b64 exec, s[48:49]
    s_cbranch_execz K2_LD_DONE
    buffer_load_dwordx4 v[16:19], v181, s[8:11], 0 offen offset:128 sc1
    s_mov_b64 exec, s[50:51]
    s_cbranch_execz K2_LD_DONE
    buffer_load_dwordx4 v[20:23], v181, s[8:11], 0 offen offset:160 sc1
    s_mov_b64 exec, s[90:91]
    s_cbranch_execz K2_LD_DONE
    buffer_load_dwordx4 v[24:27], v181, s[8:11], 0 offen offset:192 sc1
    s_mov_b64 exec, s[92:93]
    s_cbranch_execz K2_LD_DONE
    buffer_load_dwordx4 v[28:31], v181, s[8:11], 0 offen offset:224 sc1
    s_mov_b64 exec, s[94:95]
    s_cbranch_execz K2_LD_DONE
    buffer_load_dwordx4 v[32:35], v181, s[8:11], 0 offen offset:256 sc1
    s_mov_b64 exec, s[96:97]
    s_cbranch_execz K2_LD_DONE
    buffer_load_dwordx4 v[36:39], v181, s[8:11], 0 offen offset:288 sc1
    s_branch K2_LD_DONE
K2_WLATE:
    s_waitcnt vmcnt(0)
    s_branch K2_WUNP
K2_RT0:
    s_sub_u32 s60, s60, 1
    s_cbranch_scc1 K2_END
    buffer_load_dwordx4 v[0:3], v181, s[8:11], 0 offen offset:0 sc1
    s_waitcnt vmcnt(0)
    s_branch K2_CK0
K2_RT1:
    s_sub_u32 s60, s60, 1
    s_cbranch_scc1 K2_END
    buffer_load_dwordx4 v[4:7], v182, s[8:11], 0 offen sc1
    s_waitcnt vmcnt(0)
    s_branch K2_CK1
K2_RT2:
    s_sub_u32 s60, s60, 1
    s_cbranch_scc1 K2_END
    buffer_load_dwordx4 v[8:11], v183, s[8:11], 0 offen sc1
    s_waitcnt vmcnt(0)
    s_branch K2_CK2
K2_RT3:
    s_sub_u32 s60, s60, 1
    s_cbranch_scc1 K2_END
    buffer_load_dwordx4 v[12:15], v184, s[8:11], 0 offen sc1
    s_waitcnt vmcnt(0)
    s_branch K2_CK3
K2_RT4:
    s_sub_u32 s60, s60, 1
    s_cbranch_scc1 K2_END
    buffer_load_dwordx4 v[16:19], v181, s[8:11], 0 offen offset:128 sc1
    s_waitcnt vmcnt(0)
    s_branch K2_CK4
K2_RT5:
    s_sub_u32 s60, s60, 1
    s_cbranch_scc1 K2_END
    buffer_load_dwordx4 v[20:23], v181, s[8:11], 0 offen offset:160 sc1
    s_waitcnt vmcnt(0)
    s_branch K2_CK5
K2_RT6:
    s_sub_u32 s60, s60, 1
    s_cbranch_scc1 K2_END
    buffer_load_dwordx4 v[24:27], v181, s[8:11], 0 offen offset:192 sc1
    s_waitcnt vmcnt(0)
    s_branch K2_CK6
K2_RT7:
    s_sub_u32 s60, s60, 1
    s_cbranch_scc1 K2_END
    buffer_load_dwordx4 v[28:31], v181, s[8:11], 0 offen offset:224 sc1
    s_waitcnt vmcnt(0)
    s_branch K2_CK7
K2_RT8:
    s_sub_u32 s60, s60, 1
    s_cbranch_scc1 K2_END
    buffer_load_dwordx4 v[32:35], v181, s[8:11], 0 offen offset:256 sc1
    s_waitcnt vmcnt(0)
    s_branch K2_CK8
K2_RT9:
    s_sub_u32 s60, s60, 1
    s_cbranch_scc1 K2_END
    buffer_load_dwordx4 v[36:39], v181, s[8:11], 0 offen offset:288 sc1
    s_waitcnt vmcnt(0)
    s_branch K2_CK9
K2_RK_LOAD:
    s_waitcnt vmcnt(0)
    s_mov_b64 exec, s[40:41]
    s_cbranch_execz K2_RK_B
    v_lshrrev_b32 v50, 24, v3
    buffer_load_dword v40, v179, s[8:11], s66 offen offset:0
    v_mad_u32_u24 v50, v50, s58, v202
    v_and_b32 v3, 0xffffff, v3
    s_mov_b64 exec, s[42:43]
    s_cbranch_execz K2_RK_B
    v_lshrrev_b32 v51, 24, v7
    buffer_load_dword v41, v185, s[8:11], s66 offen
    v_mad_u32_u24 v51, v51, s58, v202
    v_and_b32 v7, 0xffffff, v7
    s_mov_b64 exec, s[44:45]
    s_cbranch_execz K2_RK_B
    v_lshrrev_b32 v52, 24, v11
    buffer_load_dword v42, v186, s[8:11], s66 offen
    v_mad_u32_u24 v52, v52, s58, v202
    v_and_b32 v11, 0xffffff, v11
    s_mov_b64 exec, s[46:47]
    s_cbranch_execz K2_RK_B
    v_lshrrev_b32 v53, 24, v15
    buffer_load_dword v43, v187, s[8:11], s66 offen
    v_mad_u32_u24 v53, v53, s58, v202
    v_and_b32 v15, 0xffffff, v15
    s_mov_b64 exec, s[48:49]
    s_cbranch_execz K2_RK_B
    v_lshrrev_b32 v54, 24, v19
    buffer_load_dword v44, v179, s[8:11], s66 offen offset:32
    v_mad_u32_u24 v54, v54, s58, v202
    v_and_b32 v19, 0xffffff, v19
    s_mov_b64 exec, s[50:51]
    s_cbranch_execz K2_RK_B
    v_lshrrev_b32 v55, 24, v23
    buffer_load_dword v45, v179, s[8:11], s66 offen offset:40
    v_mad_u32_u24 v55, v55, s58, v202
    v_and_b32 v23, 0xffffff, v23
    s_mov_b64 exec, s[90:91]
    s_cbranch_execz K2_RK_B
    v_lshrrev_b32 v56, 24, v27
    buffer_load_dword v46, v179, s[8:11], s66 offen offset:48
    v_mad_u32_u24 v56, v56, s58, v202
    v_and_b32 v27, 0xffffff, v27
    s_mov_b64 exec, s[92:93]
    s_cbranch_execz K2_RK_B
    v_lshrrev_b32 v57, 24, v31
    buffer_load_dword v47, v179, s[8:11], s66 offen offset:56
    v_mad_u32_u24 v57, v57, s58, v202
    v_and_b32 v31, 0xffffff, v31
    s_mov_b64 exec, s[94:95]
    s_cbranch_execz K2_RK_B
    v_lshrrev_b32 v58, 24, v35
    buffer_load_dword v48, v179, s[8:11], s66 offen offset:64
    v_mad_u32_u24 v58, v58, s58, v202
    v_and_b32 v35, 0xffffff, v35
    s_mov_b64 exec, s[96:97]
    s_cbranch_execz K2_RK_B
    v_lshrrev_b32 v59, 24, v39
    buffer_load_dword v49, v179, s[8:11], s66 offen offset:72
    v_mad_u32_u24 v59, v59, s58, v202
    v_and_b32 v39, 0xffffff, v39
K2_RK_B:
    s_mov_b64 exec, -1
    s_mul_i32 s62, s24, 48
    s_waitcnt vmcnt(0)
    v_subrev_u32 v40, s62, v40
    v_subrev_u32 v41, s62, v41
    v_subrev_u32 v42, s62, v42
    v_subrev_u32 v43, s62, v43
    v_subrev_u32 v44, s62, v44
    v_subrev_u32 v45, s62, v45
    v_subrev_u32 v46, s62, v46
    v_subrev_u32 v47, s62, v47
    v_subrev_u32 v48, s62, v48
    v_subrev_u32 v49, s62, v49
    s_branch K2_RK_DONE
K2_BIG:
    s_cmp_lg_u32 s24, 0
    s_cbranch_scc1 K2_TOK
    s_movk_i32 s26, 48
    v_mov_b32 v197, v193
    s_nop 1
    v_max_u32_dpp v197, v197, v197 row_shr:1 row_mask:0xf bank_mask:0xf bound_ctrl:0
    s_nop 1
    v_max_u32_dpp v197, v197, v197 row_shr:2 row_mask:0xf bank_mask:0xf bound_ctrl:0
    s_nop 1
    v_max_u32_dpp v197, v197, v197 row_shr:4 row_mask:0xf bank_mask:0xf bound_ctrl:0
    s_nop 1
    v_max_u32_dpp v197, v197, v197 row_shr:8 row_mask:0xf bank_mask:0xf bound_ctrl:0
    s_nop 1
    v_max_u32_dpp v197, v197, v197 row_bcast:15 row_mask:0xa bank_mask:0xf
    s_nop 1
    v_max_u32_dpp v197, v197, v197 row_bcast:31 row_mask:0xc bank_mask:0xf
    s_nop 0
    v_readlane_b32 s25, v197, 63
    s_nop 0
    s_add_u32 s25, s25, 47
    s_mul_i32 s25, s25, 43691
    s_lshr_b32 s25, s25, 21
    s_mov_b64 exec, s[40:41]
    s_cbranch_execz K2_SV_DONE
    buffer_store_dword v40, v179, s[8:11], s66 offen offset:0
    s_mov_b64 exec, s[42:43]
    s_cbranch_execz K2_SV_DONE
    buffer_store_dword v41, v185, s[8:11], s66 offen
    s_mov_b64 exec, s[44:45]
    s_cbranch_execz K2_SV_DONE
    buffer_store_dword v42, v186, s[8:11], s66 offen
    s_mov_b64 exec, s[46:47]
    s_cbranch_execz K2_SV_DONE
    buffer_store_dword v43, v187, s[8:11], s66 offen
    s_mov_b64 exec, s[48:49]
    s_cbranch_execz K2_SV_DONE
    buffer_store_dword v44, v179, s[8:11], s66 offen offset:32
    s_mov_b64 exec, s[50:51]
    s_cbranch_execz K2_SV_DONE
    buffer_store_dword v45, v179, s[8:11], s66 offen offset:40
    s_mov_b64 exec, s[90:91]
    s_cbranch_execz K2_SV_DONE
    buffer_store_dword v46, v179, s[8:11], s66 offen offset:48
    s_mov_b64 exec, s[92:93]
    s_cbranch_execz K2_SV_DONE
    buffer_store_dword v47, v179, s[8:11], s66 offen offset:56
    s_mov_b64 exec, s[94:95]
    s_cbranch_execz K2_SV_DONE
    buffer_store_dword v48, v179, s[8:11], s66 offen offset:64
    s_mov_b64 exec, s[96:97]
    s_cbranch_execz K2_SV_DONE
    buffer_store_dword v49, v179, s[8:11], s66 offen offset:72
K2_SV_DONE:
    s_mov_b64 exec, -1
    s_branch K2_TOK
K2_rare_1:
    s_cmp_eq_u32 s33, 4
    s_cbranch_scc1 K2_four_3
    s_mov_b32 s49, s48
    s_mov_b32 s51, s48
    s_xor_b32 s45, s44, 256
    s_xor_b32 s46, s44, 512
    s_xor_b32 s47, s44, 768
    s_branch K2_back_2
K2_four_3:
    s_add_u32 s50, s48, 256
    s_add_u32 s51, s48, 384
    s_mov_b32 s46, s44
    s_mov_b32 s47, s44
    s_branch K2_back_2
K2_a4_5:
    v_add_u32 v254, s48, v230
    ds_read_b32 v254, v254 offset:4
    s_lshr_b32 s65, s3, 27
    s_mul_i32 s66, s22, 2080
    s_lshl_b32 s65, s65, 9
    s_add_u32 s65, s65, s66
    s_add_u32 s65, s65, 65536
    s_mov_b32 m0, s65
    s_mov_b32 exec_hi, 0
    s_waitcnt lgkmcnt(0)
    v_or_b32 v254, v254, v231
    buffer_load_dwordx4 v254, s[16:19], 0 offen  lds
    s_mov_b32 exec_hi, -1
    s_branch K2_b4_7
K2_rare_14:
    s_cmp_eq_u32 s33, 4
    s_cbranch_scc1 K2_four_16
    s_mov_b32 s49, s48
    s_mov_b32 s51, s48
    s_xor_b32 s45, s44, 256
    s_xor_b32 s46, s44, 512
    s_xor_b32 s47, s44, 768
    s_branch K2_back_15
K2_four_16:
    s_add_u32 s50, s48, 256
    s_add_u32 s51, s48, 384
    s_mov_b32 s46, s44
    s_mov_b32 s47, s44
    s_branch K2_back_15
K2_a4_18:
    v_add_u32 v254, s48, v230
    ds_read_b32 v254, v254 offset:4
    s_lshr_b32 s65, s3, 27
    s_mul_i32 s66, s22, 2080
    s_lshl_b32 s65, s65, 9
    s_add_u32 s65, s65, s66
    s_add_u32 s65, s65, 65536
    s_mov_b32 m0, s65
    s_mov_b32 exec_hi, 0
    s_waitcnt lgkmcnt(0)
    v_or_b32 v254, v254, v231
    buffer_load_dwordx4 v254, s[16:19], 0 offen  lds
    s_mov_b32 exec_hi, -1
    s_branch K2_b4_20
K2_rare_27:
    s_cmp_eq_u32 s33, 4
    s_cbranch_scc1 K2_four_29
    s_mov_b32 s49, s48
    s_mov_b32 s51, s48
    s_xor_b32 s45, s44, 256
    s_xor_b32 s46, s44, 512
    s_xor_b32 s47, s44, 768
    s_branch K2_back_28
K2_four_29:
    s_add_u32 s50, s48, 256
    s_add_u32 s51, s48, 384
    s_mov_b32 s46, s44
    s_mov_b32 s47, s44
    s_branch K2_back_28
K2_a4_31:
    v_add_u32 v254, s48, v230
    ds_read_b32 v254, v254 offset:4
    s_lshr_b32 s65, s3, 27
    s_mul_i32 s66, s22, 2080
    s_lshl_b32 s65, s65, 9
    s_add_u32 s65, s65, s66
    s_add_u32 s65, s65, 65536
    s_mov_b32 m0, s65
    s_mov_b32 exec_hi, 0
    s_waitcnt lgkmcnt(0)
    v_or_b32 v254, v254, v231
    buffer_load_dwordx4 v254, s[16:19], 0 offen  lds
    s_mov_b32 exec_hi, -1
    s_branch K2_b4_33
K2_rare_40:
    s_cmp_eq_u32 s33, 4
    s_cbranch_scc1 K2_four_42
    s_mov_b32 s49, s48
    s_mov_b32 s51, s48
    s_xor_b32 s45, s44, 256
    s_xor_b32 s46, s44, 512
    s_xor_b32 s47, s44, 768
    s_branch K2_back_41
K2_four_42:
    s_add_u32 s50, s48, 256
    s_add_u32 s51, s48, 384
    s_mov_b32 s46, s44
    s_mov_b32 s47, s44
    s_branch K2_back_41
K2_a4_44:
    v_add_u32 v254, s48, v230
    ds_read_b32 v254, v254 offset:4
    s_lshr_b32 s65, s3, 27
    s_mul_i32 s66, s22, 2080
    s_lshl_b32 s65, s65, 9
    s_add_u32 s65, s65, s66
    s_add_u32 s65, s65, 65536
    s_mov_b32 m0, s65
    s_mov_b32 exec_hi, 0
    s_waitcnt lgkmcnt(0)
    v_or_b32 v254, v254, v231
    buffer_load_dwordx4 v254, s[16:19], 0 offen  lds
    s_mov_b32 exec_hi, -1
    s_branch K2_b4_46
K2_rare_51:
    s_cmp_eq_u32 s33, 4
    s_cbranch_scc1 K2_four_53
    s_mov_b32 s49, s48
    s_mov_b32 s51, s48
    s_xor_b32 s45, s44, 256
    s_xor_b32 s46, s44, 512
    s_xor_b32 s47, s44, 768
    s_branch K2_back_52
K2_four_53:
    s_add_u32 s50, s48, 256
    s_add_u32 s51, s48, 384
    s_mov_b32 s46, s44
    s_mov_b32 s47, s44
    s_branch K2_back_52
K2_rare_58:
    s_cmp_eq_u32 s33, 4
    s_cbranch_scc1 K2_four_60
    s_mov_b32 s49, s48
    s_mov_b32 s51, s48
    s_xor_b32 s45, s44, 256
    s_xor_b32 s46, s44, 512
    s_xor_b32 s47, s44, 768
    s_branch K2_back_59
K2_four_60:
    s_add_u32 s50, s48, 256
    s_add_u32 s51, s48, 384
    s_mov_b32 s46, s44
    s_mov_b32 s47, s44
    s_branch K2_back_59
K2_rare_65:
    s_cmp_eq_u32 s33, 4
    s_cbranch_scc1 K2_four_67
    s_mov_b32 s49, s48
    s_mov_b32 s51, s48
    s_xor_b32 s45, s44, 256
    s_xor_b32 s46, s44, 512
    s_xor_b32 s47, s44, 768
    s_branch K2_back_66
K2_four_67:
    s_add_u32 s50, s48, 256
    s_add_u32 s51, s48, 384
    s_mov_b32 s46, s44
    s_mov_b32 s47, s44
    s_branch K2_back_66
K2_U10:
    s_setprio 1
    s_add_u32 s38, s38, 1
    v_mov_b32 v254, s52
    v_mov_b32 v255, s38
    s_lshl_b32 s58, s38, 3
    s_add_u32 s58, s58, s20
    s_mov_b64 exec, 1
    ds_write_b32 v254, v255
    s_mov_b64 exec, -1
    s_cmp_lt_u32 s58, s22
    s_cbranch_scc0 K2_dyn_68
K2_back_69:
    s_waitcnt lgkmcnt(4)
    v_lshlrev_b32 v20, 16, v0
    v_and_b32 v21, 0xffff0000, v0
    v_lshlrev_b32 v22, 16, v1
    v_and_b32 v23, 0xffff0000, v1
    v_lshlrev_b32 v24, 16, v2
    v_and_b32 v25, 0xffff0000, v2
    v_lshlrev_b32 v26, 16, v3
    v_and_b32 v27, 0xffff0000, v3
    v_mul_f32_dpp v36, v16, v20 row_newbcast:8 row_mask:0xf bank_mask:0xf
    v_mul_f32_dpp v37, v16, v21 row_newbcast:9 row_mask:0xf bank_mask:0xf
    v_mul_f32_dpp v38, v16, v22 row_newbcast:10 row_mask:0xf bank_mask:0xf
    v_mul_f32_dpp v39, v16, v23 row_newbcast:11 row_mask:0xf bank_mask:0xf
    v_mul_f32_dpp v40, v16, v24 row_newbcast:12 row_mask:0xf bank_mask:0xf
    v_mul_f32_dpp v41, v16, v25 row_newbcast:13 row_mask:0xf bank_mask:0xf
    v_mul_f32_dpp v42, v16, v26 row_newbcast:14 row_mask:0xf bank_mask:0xf
    v_mul_f32_dpp v43, v16, v27 row_newbcast:15 row_mask:0xf bank_mask:0xf
    v_cvt_pk_bf16_f32 v68, v36, v37
    v_cvt_pk_bf16_f32 v69, v38, v39
    v_cvt_pk_bf16_f32 v70, v40, v41
    v_cvt_pk_bf16_f32 v71, v42, v43
    v_mul_f32_dpp v20, v16, v20 row_newbcast:0 row_mask:0xa bank_mask:0xf
    v_mul_f32_dpp v21, v16, v21 row_newbcast:1 row_mask:0xa bank_mask:0xf
    v_mul_f32_dpp v22, v16, v22 row_newbcast:2 row_mask:0xa bank_mask:0xf
    v_mul_f32_dpp v23, v16, v23 row_newbcast:3 row_mask:0xa bank_mask:0xf
    v_mul_f32_dpp v24, v16, v24 row_newbcast:4 row_mask:0xa bank_mask:0xf
    v_mul_f32_dpp v25, v16, v25 row_newbcast:5 row_mask:0xa bank_mask:0xf
    v_mul_f32_dpp v26, v16, v26 row_newbcast:6 row_mask:0xa bank_mask:0xf
    v_mul_f32_dpp v27, v16, v27 row_newbcast:7 row_mask:0xa bank_mask:0xf
    v_cvt_pk_bf16_f32 v64, v20, v21
    v_cvt_pk_bf16_f32 v65, v22, v23
    v_cvt_pk_bf16_f32 v66, v24, v25
    v_cvt_pk_bf16_f32 v67, v26, v27
    v_readlane_b32 s3, v253, s58
    s_lshl_b32 s44, s34, 7
    s_and_b32 s48, s3, 0x3ffff
    s_bfe_u32 s33, s3, 0x30013
    s_mul_i32 s35, s38, 6
    s_cmp_eq_u32 s34, 0
    s_cselect_b32 s35, s35, s48
    s_mov_b32 s45, s44
    s_xor_b32 s47, s44, 256
    s_add_u32 s49, s48, 128
    s_add_u32 s60, s48, 256
    s_cmp_eq_u32 s33, 3
    s_cselect_b32 s46, s44, s47
    s_cselect_b32 s50, s60, s48
    s_cselect_b32 s51, s48, s49
    s_sub_u32 s60, s33, 2
    s_cmp_lt_u32 s60, 2
    s_cbranch_scc0 K2_rare_74
K2_back_75:
    v_add_u32 v233, s48, v230
    ds_read_b32 v232, v233
    ds_read_b32 v233, v233 offset:1024
    v_add_u32 v222, s48, v251
    ds_read2_b32 v[222:223], v222 offset0:1 offset1:3
    v_add_u32 v224, s49, v251
    ds_read2_b32 v[224:225], v224 offset0:1 offset1:3
    v_add_u32 v226, s50, v251
    ds_read2_b32 v[226:227], v226 offset0:1 offset1:3
    v_add_u32 v228, s51, v251
    ds_read2_b32 v[228:229], v228 offset0:1 offset1:3
    s_waitcnt lgkmcnt(4)
    v_or_b32 v232, v232, v231
    v_or_b32 v233, v233, v231
    s_cmp_lg_u32 s34, 0
    s_cbranch_scc1 K2_dum_77
    s_cmp_eq_u32 s33, 4
    s_cbranch_scc1 K2_a4_78
K2_b4_80:
    s_add_u32 m0, s48, 512
    s_add_u32 s65, s48, 1536
    buffer_load_dwordx4 v232, s[16:19], 0 offen  lds
    s_mov_b32 m0, s65
    s_mov_b32 exec_hi, 0
    buffer_load_dwordx4 v233, s[16:19], 0 offen  lds
    s_mov_b32 exec_hi, -1
K2_back_79:
    s_waitcnt lgkmcnt(3)
    v_mad_u32_u16 v222, v222, s39, v248 op_sel:[1,0,0,0]
    v_mad_u32_u16 v223, v223, s39, v248 op_sel:[1,0,0,0]
    s_waitcnt lgkmcnt(2)
    v_mad_u32_u16 v224, v224, s39, v248 op_sel:[1,0,0,0]
    v_mad_u32_u16 v225, v225, s39, v248 op_sel:[1,0,0,0]
    s_waitcnt lgkmcnt(1)
    v_mad_u32_u16 v226, v226, s39, v248 op_sel:[1,0,0,0]
    v_mad_u32_u16 v227, v227, s39, v248 op_sel:[1,0,0,0]
    s_waitcnt lgkmcnt(0)
    v_mad_u32_u16 v228, v228, s39, v248 op_sel:[1,0,0,0]
    v_mad_u32_u16 v229, v229, s39, v248 op_sel:[1,0,0,0]
    s_waitcnt vmcnt(6)
    v_mfma_f32_32x32x16_bf16 v[0:15], v[64:67], v[176:179], 0
    ds_read_b64_tr_b16 v[184:185], v246 offset:2048
    ds_read_b64_tr_b16 v[186:187], v246 offset:3072
    ds_read_b64_tr_b16 v[188:189], v247 offset:2048
    ds_read_b64_tr_b16 v[190:191], v247 offset:3072
    s_mov_b32 m0, s68
    v_mfma_f32_32x32x16_bf16 v[16:31], v[68:71], v[176:179], 0
    buffer_load_dwordx4 v222, s[4:7], s44 offen sc1 lds
    buffer_load_dwordx4 v223, s[72:75], s44 offen offset:1024 sc1 lds
    v_permlane32_swap_b32 v242, v236
    v_permlane32_swap_b32 v243, v237
    v_mfma_f32_32x32x16_bf16 v[32:47], v[64:67], v[180:183], 0
    v_permlane32_swap_b32 v244, v238
    v_permlane32_swap_b32 v245, v239
    v_permlane32_swap_b32 v240, v241
    v_add_f32 v242, v242, v236
    v_mfma_f32_32x32x16_bf16 v[48:63], v[68:71], v[180:183], 0
    s_setprio 0
    v_add_f32 v243, v243, v237
    v_add_f32 v244, v244, v238
    v_add_f32 v245, v245, v239
    v_add_f32 v240, -v240, -v241
    s_set_gpr_idx_on s32, gpr_idx(DST)
    s_nop 0
    v_cvt_pk_bf16_f32 v195, v242, v243
    v_cvt_pk_bf16_f32 v196, v244, v245
    v_cvt_pk_bf16_f32 v197, v240, v240
    s_set_gpr_idx_off
    v_mul_f32 v234, v0, v96
    v_mul_f32 v236, v8, v128
    v_fmac_f32 v234, v1, v97
    v_fmac_f32 v236, v9, v129
    v_fmac_f32 v234, v2, v98
    v_fmac_f32 v236, v10, v130
    v_fmac_f32 v234, v3, v99
    v_fmac_f32 v236, v11, v131
    v_fmac_f32 v234, v4, v100
    v_fmac_f32 v236, v12, v132
    v_fmac_f32 v234, v5, v101
    v_fmac_f32 v236, v13, v133
    v_fmac_f32 v234, v6, v102
    v_fmac_f32 v236, v14, v134
    v_fmac_f32 v234, v7, v103
    v_fmac_f32 v236, v15, v135
    v_mul_f32 v238, v16, v128
    v_mul_f32 v240, v24, v128
    v_fmac_f32 v238, v17, v129
    v_fmac_f32 v240, v25, v129
    v_fmac_f32 v238, v18, v130
    v_fmac_f32 v240, v26, v130
    v_fmac_f32 v238, v19, v131
    v_fmac_f32 v240, v27, v131
    v_fmac_f32 v238, v20, v132
    v_fmac_f32 v240, v28, v132
    v_fmac_f32 v238, v21, v133
    v_fmac_f32 v240, v29, v133
    v_fmac_f32 v238, v22, v134
    v_fmac_f32 v240, v30, v134
    v_fmac_f32 v238, v23, v135
    v_fmac_f32 v240, v31, v135
    v_mul_f32 v235, v32, v104
    v_mul_f32 v237, v40, v136
    v_fmac_f32 v235, v33, v105
    v_fmac_f32 v237, v41, v137
    v_fmac_f32 v235, v34, v106
    v_fmac_f32 v237, v42, v138
    v_fmac_f32 v235, v35, v107
    v_fmac_f32 v237, v43, v139
    v_fmac_f32 v235, v36, v108
    v_fmac_f32 v237, v44, v140
    v_fmac_f32 v235, v37, v109
    v_fmac_f32 v237, v45, v141
    v_fmac_f32 v235, v38, v110
    v_fmac_f32 v237, v46, v142
    v_fmac_f32 v235, v39, v111
    v_fmac_f32 v237, v47, v143
    v_mul_f32 v239, v48, v136
    v_mul_f32 v241, v56, v136
    v_fmac_f32 v239, v49, v137
    v_fmac_f32 v241, v57, v137
    v_fmac_f32 v239, v50, v138
    v_fmac_f32 v241, v58, v138
    v_fmac_f32 v239, v51, v139
    v_fmac_f32 v241, v59, v139
    v_fmac_f32 v239, v52, v140
    v_fmac_f32 v241, v60, v140
    v_fmac_f32 v239, v53, v141
    v_fmac_f32 v241, v61, v141
    v_fmac_f32 v239, v54, v142
    v_fmac_f32 v241, v62, v142
    v_fmac_f32 v239, v55, v143
    v_fmac_f32 v241, v63, v143
    s_setprio 1
    s_waitcnt vmcnt(6) lgkmcnt(0)
    v_mfma_f32_32x32x16_bf16 v[0:15], v[64:67], v[184:187], 0
    ds_read_b64_tr_b16 v[176:177], v246 offset:4096
    ds_read_b64_tr_b16 v[178:179], v246 offset:5120
    ds_read_b64_tr_b16 v[180:181], v247 offset:4096
    ds_read_b64_tr_b16 v[182:183], v247 offset:5120
    s_mov_b32 m0, s69
    v_mfma_f32_32x32x16_bf16 v[16:31], v[68:71], v[184:187], 0
    buffer_load_dwordx4 v224, s[4:7], s45 offen sc1 lds
    buffer_load_dwordx4 v225, s[72:75], s45 offen offset:1024 sc1 lds
    v_permlane32_swap_b32 v234, v236
    v_permlane32_swap_b32 v235, v237
    v_mfma_f32_32x32x16_bf16 v[32:47], v[64:67], v[188:191], 0
    v_permlane32_swap_b32 v240, v238
    v_permlane32_swap_b32 v241, v239
    v_add_f32 v234, v234, v236
    v_add_f32 v235, v235, v237
    v_add_f32 v240, v240, v238
    v_mfma_f32_32x32x16_bf16 v[48:63], v[68:71], v[188:191], 0
    s_setprio 0
    v_add_f32 v241, v241, v239
    s_set_gpr_idx_on s31, gpr_idx(DST)
    s_nop 0
    v_cvt_pk_bf16_f32 v192, v234, v235
    v_cvt_pk_bf16_f32 v193, v240, v241
    s_set_gpr_idx_off
    v_mul_f32 v234, v0, v144
    v_mul_f32 v236, v8, v112
    v_fmac_f32 v234, v1, v145
    v_fmac_f32 v236, v9, v113
    v_fmac_f32 v234, v2, v146
    v_fmac_f32 v236, v10, v114
    v_fmac_f32 v234, v3, v147
    v_fmac_f32 v236, v11, v115
    v_fmac_f32 v234, v4, v148
    v_fmac_f32 v236, v12, v116
    v_fmac_f32 v234, v5, v149
    v_fmac_f32 v236, v13, v117
    v_fmac_f32 v234, v6, v150
    v_fmac_f32 v236, v14, v118
    v_fmac_f32 v234, v7, v151
    v_fmac_f32 v236, v15, v119
    v_mul_f32 v238, v16, v160
    v_mul_f32 v240, v24, v160
    v_fmac_f32 v238, v17, v161
    v_fmac_f32 v240, v25, v161
    v_fmac_f32 v238, v18, v162
    v_fmac_f32 v240, v26, v162
    v_fmac_f32 v238, v19, v163
    v_fmac_f32 v240, v27, v163
    v_fmac_f32 v238, v20, v164
    v_fmac_f32 v240, v28, v164
    v_fmac_f32 v238, v21, v165
    v_fmac_f32 v240, v29, v165
    v_fmac_f32 v238, v22, v166
    v_fmac_f32 v240, v30, v166
    v_fmac_f32 v238, v23, v167
    v_fmac_f32 v240, v31, v167
    v_mul_f32 v235, v32, v152
    v_mul_f32 v237, v40, v120
    v_fmac_f32 v235, v33, v153
    v_fmac_f32 v237, v41, v121
    v_fmac_f32 v235, v34, v154
    v_fmac_f32 v237, v42, v122
    v_fmac_f32 v235, v35, v155
    v_fmac_f32 v237, v43, v123
    v_fmac_f32 v235, v36, v156
    v_fmac_f32 v237, v44, v124
    v_fmac_f32 v235, v37, v157
    v_fmac_f32 v237, v45, v125
    v_fmac_f32 v235, v38, v158
    v_fmac_f32 v237, v46, v126
    v_fmac_f32 v235, v39, v159
    v_fmac_f32 v237, v47, v127
    v_mul_f32 v239, v48, v168
    v_mul_f32 v241, v56, v168
    v_fmac_f32 v239, v49, v169
    v_fmac_f32 v241, v57, v169
    v_fmac_f32 v239, v50, v170
    v_fmac_f32 v241, v58, v170
    v_fmac_f32 v239, v51, v171
    v_fmac_f32 v241, v59, v171
    v_fmac_f32 v239, v52, v172
    v_fmac_f32 v241, v60, v172
    v_fmac_f32 v239, v53, v173
    v_fmac_f32 v241, v61, v173
    v_fmac_f32 v239, v54, v174
    v_fmac_f32 v241, v62, v174
    v_fmac_f32 v239, v55, v175
    v_fmac_f32 v241, v63, v175
    s_setprio 1
    s_waitcnt vmcnt(6) lgkmcnt(0)
    v_mfma_f32_32x32x16_bf16 v[0:15], v[64:67], v[176:179], 0
    ds_read_b64_tr_b16 v[184:185], v246 offset:6144
    ds_read_b64_tr_b16 v[186:187], v246 offset:7168
    ds_read_b64_tr_b16 v[188:189], v247 offset:6144
    ds_read_b64_tr_b16 v[190:191], v247 offset:7168
    s_mov_b32 m0, s70
    v_mfma_f32_32x32x16_bf16 v[16:31], v[68:71], v[176:179], 0
    buffer_load_dwordx4 v226, s[4:7], s46 offen sc1 lds
    buffer_load_dwordx4 v227, s[72:75], s46 offen offset:1024 sc1 lds
    s_sub_u32 s26, s48, s29
    s_mov_b32 s29, s48
    s_mov_b32 s30, s3
    s_bfe_u32 s56, s3, 0x40012
    v_mfma_f32_32x32x16_bf16 v[32:47], v[64:67], v[180:183], 0
    s_cmp_eq_u32 s34, 0
    s_cselect_b32 s56, s56, 0
    v_mfma_f32_32x32x16_bf16 v[48:63], v[68:71], v[180:183], 0
    s_setprio 0
    v_mul_f32 v242, v0, v144
    v_fma_f32 v238, v8, v160, -v238
    v_fmac_f32 v242, v1, v145
    v_fmac_f32 v238, v9, v161
    v_fmac_f32 v242, v2, v146
    v_fmac_f32 v238, v10, v162
    v_fmac_f32 v242, v3, v147
    v_fmac_f32 v238, v11, v163
    v_fmac_f32 v242, v4, v148
    v_fmac_f32 v238, v12, v164
    v_fmac_f32 v242, v5, v149
    v_fmac_f32 v238, v13, v165
    v_fmac_f32 v242, v6, v150
    v_fmac_f32 v238, v14, v166
    v_fmac_f32 v242, v7, v151
    v_fmac_f32 v238, v15, v167
    v_fmac_f32 v236, v16, v112
    v_mul_f32 v244, v24, v160
    v_fmac_f32 v236, v17, v113
    v_fmac_f32 v244, v25, v161
    v_fmac_f32 v236, v18, v114
    v_fmac_f32 v244, v26, v162
    v_fmac_f32 v236, v19, v115
    v_fmac_f32 v244, v27, v163
    v_fmac_f32 v236, v20, v116
    v_fmac_f32 v244, v28, v164
    v_fmac_f32 v236, v21, v117
    v_fmac_f32 v244, v29, v165
    v_fmac_f32 v236, v22, v118
    v_fmac_f32 v244, v30, v166
    v_fmac_f32 v236, v23, v119
    v_fmac_f32 v244, v31, v167
    v_mul_f32 v243, v32, v152
    v_fma_f32 v239, v40, v168, -v239
    v_fmac_f32 v243, v33, v153
    v_fmac_f32 v239, v41, v169
    v_fmac_f32 v243, v34, v154
    v_fmac_f32 v239, v42, v170
    v_fmac_f32 v243, v35, v155
    v_fmac_f32 v239, v43, v171
    v_fmac_f32 v243, v36, v156
    v_fmac_f32 v239, v44, v172
    v_fmac_f32 v243, v37, v157
    v_fmac_f32 v239, v45, v173
    v_fmac_f32 v243, v38, v158
    v_fmac_f32 v239, v46, v174
    v_fmac_f32 v243, v39, v159
    v_fmac_f32 v239, v47, v175
    v_fmac_f32 v237, v48, v120
    v_mul_f32 v245, v56, v168
    v_fmac_f32 v237, v49, v121
    v_fmac_f32 v245, v57, v169
    v_fmac_f32 v237, v50, v122
    v_fmac_f32 v245, v58, v170
    v_fmac_f32 v237, v51, v123
    v_fmac_f32 v245, v59, v171
    v_fmac_f32 v237, v52, v124
    v_fmac_f32 v245, v60, v172
    v_fmac_f32 v237, v53, v125
    v_fmac_f32 v245, v61, v173
    v_fmac_f32 v237, v54, v126
    v_fmac_f32 v245, v62, v174
    v_fmac_f32 v237, v55, v127
    v_fmac_f32 v245, v63, v175
    s_setprio 1
    s_waitcnt vmcnt(4) lgkmcnt(0)
    v_mfma_f32_32x32x16_bf16 v[0:15], v[64:67], v[184:187], 0
    ds_read_b64_tr_b16 v[176:177], v246 offset:0
    ds_read_b64_tr_b16 v[178:179], v246 offset:1024
    ds_read_b64_tr_b16 v[180:181], v247 offset:0
    ds_read_b64_tr_b16 v[182:183], v247 offset:1024
    s_mov_b32 m0, s71
    v_mfma_f32_32x32x16_bf16 v[16:31], v[68:71], v[184:187], 0
    buffer_load_dwordx4 v228, s[4:7], s47 offen sc1 lds
    buffer_load_dwordx4 v229, s[72:75], s47 offen offset:1024 sc1 lds
    v_permlane32_swap_b32 v242, v234
    v_permlane32_swap_b32 v243, v235
    v_add_f32 v242, v242, v234
    v_mfma_f32_32x32x16_bf16 v[32:47], v[64:67], v[188:191], 0
    v_add_f32 v243, v243, v235
    s_set_gpr_idx_on s31, gpr_idx(DST)
    s_nop 0
    v_cvt_pk_bf16_f32 v194, v242, v243
    s_set_gpr_idx_off
    s_mov_b32 s32, s31
    s_mov_b32 s31, s35
    v_mfma_f32_32x32x16_bf16 v[48:63], v[68:71], v[188:191], 0
    s_setprio 0
    v_mul_f32 v242, v0, v144
    v_fma_f32 v240, v8, v160, -v240
    v_fmac_f32 v242, v1, v145
    v_fmac_f32 v240, v9, v161
    v_fmac_f32 v242, v2, v146
    v_fmac_f32 v240, v10, v162
    v_fmac_f32 v242, v3, v147
    v_fmac_f32 v240, v11, v163
    v_fmac_f32 v242, v4, v148
    v_fmac_f32 v240, v12, v164
    v_fmac_f32 v242, v5, v149
    v_fmac_f32 v240, v13, v165
    v_fmac_f32 v242, v6, v150
    v_fmac_f32 v240, v14, v166
    v_fmac_f32 v242, v7, v151
    v_fmac_f32 v240, v15, v167
    v_add_u32 v249, s26, v249
    v_add_u32 v250, s26, v250
    v_fma_f32 v244, v16, v160, -v244
    v_fmac_f32 v236, v24, v112
    v_fmac_f32 v244, v17, v161
    v_fmac_f32 v236, v25, v113
    v_fmac_f32 v244, v18, v162
    v_fmac_f32 v236, v26, v114
    v_fmac_f32 v244, v19, v163
    v_fmac_f32 v236, v27, v115
    v_fmac_f32 v244, v20, v164
    v_fmac_f32 v236, v28, v116
    v_fmac_f32 v244, v21, v165
    v_fmac_f32 v236, v29, v117
    v_fmac_f32 v244, v22, v166
    v_fmac_f32 v236, v30, v118
    v_fmac_f32 v244, v23, v167
    v_fmac_f32 v236, v31, v119
    ds_read_b64_tr_b16 v[0:1], v249 offset:0
    ds_read_b64_tr_b16 v[2:3], v249 offset:32
    ds_read_u16_d16_hi v16, v250 offset:0
    v_mul_f32 v243, v32, v152
    v_fma_f32 v241, v40, v168, -v241
    v_fmac_f32 v243, v33, v153
    v_fmac_f32 v241, v41, v169
    v_fmac_f32 v243, v34, v154
    v_fmac_f32 v241, v42, v170
    v_fmac_f32 v243, v35, v155
    v_fmac_f32 v241, v43, v171
    v_fmac_f32 v243, v36, v156
    v_fmac_f32 v241, v44, v172
    v_fmac_f32 v243, v37, v157
    v_fmac_f32 v241, v45, v173
    v_fmac_f32 v243, v38, v158
    v_fmac_f32 v241, v46, v174
    v_fmac_f32 v243, v39, v159
    v_fmac_f32 v241, v47, v175
    ds_read_b64_tr_b16 v[4:5], v249 offset:512
    ds_read_b64_tr_b16 v[6:7], v249 offset:544
    ds_read_u16_d16_hi v17, v250 offset:128
    v_fma_f32 v245, v48, v168, -v245
    v_fmac_f32 v237, v56, v120
    v_fmac_f32 v245, v49, v169
    v_fmac_f32 v237, v57, v121
    v_fmac_f32 v245, v50, v170
    v_fmac_f32 v237, v58, v122
    v_fmac_f32 v245, v51, v171
    v_fmac_f32 v237, v59, v123
    v_fmac_f32 v245, v52, v172
    v_fmac_f32 v237, v60, v124
    v_fmac_f32 v245, v53, v173
    v_fmac_f32 v237, v61, v125
    v_fmac_f32 v245, v54, v174
    v_fmac_f32 v237, v62, v126
    v_fmac_f32 v245, v55, v175
    v_fmac_f32 v237, v63, v127
    s_cmp_eq_u32 s56, 5
    s_cbranch_scc1 K2_U20
    s_cmp_eq_u32 s56, 6
    s_cbranch_scc1 K2_U3h0
    s_branch K2_DSP0
K2_U40:
    s_setprio 1
    ds_read_b64_tr_b16 v[8:9], v249 offset:1024
    ds_read_b64_tr_b16 v[10:11], v249 offset:1056
    ds_read_u16_d16_hi v18, v250 offset:256
    s_lshr_b32 s65, s30, 27
    s_mul_i32 s66, s22, 2080
    s_lshl_b32 s65, s65, 9
    s_add_u32 s65, s65, s66
    s_add_u32 s65, s65, 65536
    s_sub_u32 s65, s65, s29
    s_sub_u32 s65, s65, 512
    v_add_u32 v56, s65, v249
    ds_read_b64_tr_b16 v[12:13], v56 offset:0
    ds_read_b64_tr_b16 v[14:15], v56 offset:32
    ds_read_u16_d16_hi v19, v250 offset:384
    s_waitcnt lgkmcnt(6)
    v_lshlrev_b32 v20, 16, v0
    v_and_b32 v21, 0xffff0000, v0
    v_lshlrev_b32 v22, 16, v1
    v_and_b32 v23, 0xffff0000, v1
    v_lshlrev_b32 v24, 16, v2
    v_and_b32 v25, 0xffff0000, v2
    v_lshlrev_b32 v26, 16, v3
    v_and_b32 v27, 0xffff0000, v3
    v_mul_f32_dpp v36, v16, v20 row_newbcast:8 row_mask:0xf bank_mask:0xf
    v_mul_f32_dpp v37, v16, v21 row_newbcast:9 row_mask:0xf bank_mask:0xf
    v_mul_f32_dpp v38, v16, v22 row_newbcast:10 row_mask:0xf bank_mask:0xf
    v_mul_f32_dpp v39, v16, v23 row_newbcast:11 row_mask:0xf bank_mask:0xf
    v_mul_f32_dpp v40, v16, v24 row_newbcast:12 row_mask:0xf bank_mask:0xf
    v_mul_f32_dpp v41, v16, v25 row_newbcast:13 row_mask:0xf bank_mask:0xf
    v_mul_f32_dpp v42, v16, v26 row_newbcast:14 row_mask:0xf bank_mask:0xf
    v_mul_f32_dpp v43, v16, v27 row_newbcast:15 row_mask:0xf bank_mask:0xf
    v_cvt_pk_bf16_f32 v68, v36, v37
    v_cvt_pk_bf16_f32 v69, v38, v39
    v_cvt_pk_bf16_f32 v70, v40, v41
    v_cvt_pk_bf16_f32 v71, v42, v43
    v_mul_f32_dpp v20, v16, v20 row_newbcast:0 row_mask:0xa bank_mask:0xf
    v_mul_f32_dpp v21, v16, v21 row_newbcast:1 row_mask:0xa bank_mask:0xf
    v_mul_f32_dpp v22, v16, v22 row_newbcast:2 row_mask:0xa bank_mask:0xf
    v_mul_f32_dpp v23, v16, v23 row_newbcast:3 row_mask:0xa bank_mask:0xf
    v_mul_f32_dpp v24, v16, v24 row_newbcast:4 row_mask:0xa bank_mask:0xf
    v_mul_f32_dpp v25, v16, v25 row_newbcast:5 row_mask:0xa bank_mask:0xf
    v_mul_f32_dpp v26, v16, v26 row_newbcast:6 row_mask:0xa bank_mask:0xf
    v_mul_f32_dpp v27, v16, v27 row_newbcast:7 row_mask:0xa bank_mask:0xf
    v_cvt_pk_bf16_f32 v64, v20, v21
    v_cvt_pk_bf16_f32 v65, v22, v23
    v_cvt_pk_bf16_f32 v66, v24, v25
    v_cvt_pk_bf16_f32 v67, v26, v27
    v_lshlrev_b32 v28, 16, v4
    v_and_b32 v29, 0xffff0000, v4
    v_lshlrev_b32 v30, 16, v5
    v_and_b32 v31, 0xffff0000, v5
    v_lshlrev_b32 v32, 16, v6
    v_and_b32 v33, 0xffff0000, v6
    v_lshlrev_b32 v34, 16, v7
    v_and_b32 v35, 0xffff0000, v7
    v_mul_f32_dpp v36, v17, v28 row_newbcast:8 row_mask:0xf bank_mask:0xf
    v_mul_f32_dpp v37, v17, v29 row_newbcast:9 row_mask:0xf bank_mask:0xf
    v_mul_f32_dpp v38, v17, v30 row_newbcast:10 row_mask:0xf bank_mask:0xf
    v_mul_f32_dpp v39, v17, v31 row_newbcast:11 row_mask:0xf bank_mask:0xf
    v_mul_f32_dpp v40, v17, v32 row_newbcast:12 row_mask:0xf bank_mask:0xf
    v_mul_f32_dpp v41, v17, v33 row_newbcast:13 row_mask:0xf bank_mask:0xf
    v_mul_f32_dpp v42, v17, v34 row_newbcast:14 row_mask:0xf bank_mask:0xf
    v_mul_f32_dpp v43, v17, v35 row_newbcast:15 row_mask:0xf bank_mask:0xf
    v_cvt_pk_bf16_f32 v76, v36, v37
    v_cvt_pk_bf16_f32 v77, v38, v39
    v_cvt_pk_bf16_f32 v78, v40, v41
    v_cvt_pk_bf16_f32 v79, v42, v43
    v_mul_f32_dpp v28, v17, v28 row_newbcast:0 row_mask:0xa bank_mask:0xf
    v_mul_f32_dpp v29, v17, v29 row_newbcast:1 row_mask:0xa bank_mask:0xf
    v_mul_f32_dpp v30, v17, v30 row_newbcast:2 row_mask:0xa bank_mask:0xf
    v_mul_f32_dpp v31, v17, v31 row_newbcast:3 row_mask:0xa bank_mask:0xf
    v_mul_f32_dpp v32, v17, v32 row_newbcast:4 row_mask:0xa bank_mask:0xf
    v_mul_f32_dpp v33, v17, v33 row_newbcast:5 row_mask:0xa bank_mask:0xf
    v_mul_f32_dpp v34, v17, v34 row_newbcast:6 row_mask:0xa bank_mask:0xf
    v_mul_f32_dpp v35, v17, v35 row_newbcast:7 row_mask:0xa bank_mask:0xf
    v_cvt_pk_bf16_f32 v72, v28, v29
    v_cvt_pk_bf16_f32 v73, v30, v31
    v_cvt_pk_bf16_f32 v74, v32, v33
    v_cvt_pk_bf16_f32 v75, v34, v35
    s_waitcnt lgkmcnt(3)
    v_lshlrev_b32 v20, 16, v8
    v_and_b32 v21, 0xffff0000, v8
    v_lshlrev_b32 v22, 16, v9
    v_and_b32 v23, 0xffff0000, v9
    v_lshlrev_b32 v24, 16, v10
    v_and_b32 v25, 0xffff0000, v10
    v_lshlrev_b32 v26, 16, v11
    v_and_b32 v27, 0xffff0000, v11
    v_mul_f32_dpp v36, v18, v20 row_newbcast:8 row_mask:0xf bank_mask:0xf
    v_mul_f32_dpp v37, v18, v21 row_newbcast:9 row_mask:0xf bank_mask:0xf
    v_mul_f32_dpp v38, v18, v22 row_newbcast:10 row_mask:0xf bank_mask:0xf
    v_mul_f32_dpp v39, v18, v23 row_newbcast:11 row_mask:0xf bank_mask:0xf
    v_mul_f32_dpp v40, v18, v24 row_newbcast:12 row_mask:0xf bank_mask:0xf
    v_mul_f32_dpp v41, v18, v25 row_newbcast:13 row_mask:0xf bank_mask:0xf
    v_mul_f32_dpp v42, v18, v26 row_newbcast:14 row_mask:0xf bank_mask:0xf
    v_mul_f32_dpp v43, v18, v27 row_newbcast:15 row_mask:0xf bank_mask:0xf
    v_cvt_pk_bf16_f32 v84, v36, v37
    v_cvt_pk_bf16_f32 v85, v38, v39
    v_cvt_pk_bf16_f32 v86, v40, v41
    v_cvt_pk_bf16_f32 v87, v42, v43
    v_mul_f32_dpp v20, v18, v20 row_newbcast:0 row_mask:0xa bank_mask:0xf
    v_mul_f32_dpp v21, v18, v21 row_newbcast:1 row_mask:0xa bank_mask:0xf
    v_mul_f32_dpp v22, v18, v22 row_newbcast:2 row_mask:0xa bank_mask:0xf
    v_mul_f32_dpp v23, v18, v23 row_newbcast:3 row_mask:0xa bank_mask:0xf
    v_mul_f32_dpp v24, v18, v24 row_newbcast:4 row_mask:0xa bank_mask:0xf
    v_mul_f32_dpp v25, v18, v25 row_newbcast:5 row_mask:0xa bank_mask:0xf
    v_mul_f32_dpp v26, v18, v26 row_newbcast:6 row_mask:0xa bank_mask:0xf
    v_mul_f32_dpp v27, v18, v27 row_newbcast:7 row_mask:0xa bank_mask:0xf
    v_cvt_pk_bf16_f32 v80, v20, v21
    v_cvt_pk_bf16_f32 v81, v22, v23
    v_cvt_pk_bf16_f32 v82, v24, v25
    v_cvt_pk_bf16_f32 v83, v26, v27
    s_waitcnt lgkmcnt(0)
    v_lshlrev_b32 v28, 16, v12
    v_and_b32 v29, 0xffff0000, v12
    v_lshlrev_b32 v30, 16, v13
    v_and_b32 v31, 0xffff0000, v13
    v_lshlrev_b32 v32, 16, v14
    v_and_b32 v33, 0xffff0000, v14
    v_lshlrev_b32 v34, 16, v15
    v_and_b32 v35, 0xffff0000, v15
    v_mul_f32_dpp v36, v19, v28 row_newbcast:8 row_mask:0xf bank_mask:0xf
    v_mul_f32_dpp v37, v19, v29 row_newbcast:9 row_mask:0xf bank_mask:0xf
    v_mul_f32_dpp v38, v19, v30 row_newbcast:10 row_mask:0xf bank_mask:0xf
    v_mul_f32_dpp v39, v19, v31 row_newbcast:11 row_mask:0xf bank_mask:0xf
    v_mul_f32_dpp v40, v19, v32 row_newbcast:12 row_mask:0xf bank_mask:0xf
    v_mul_f32_dpp v41, v19, v33 row_newbcast:13 row_mask:0xf bank_mask:0xf
    v_mul_f32_dpp v42, v19, v34 row_newbcast:14 row_mask:0xf bank_mask:0xf
    v_mul_f32_dpp v43, v19, v35 row_newbcast:15 row_mask:0xf bank_mask:0xf
    v_cvt_pk_bf16_f32 v92, v36, v37
    v_cvt_pk_bf16_f32 v93, v38, v39
    v_cvt_pk_bf16_f32 v94, v40, v41
    v_cvt_pk_bf16_f32 v95, v42, v43
    v_mul_f32_dpp v28, v19, v28 row_newbcast:0 row_mask:0xa bank_mask:0xf
    v_mul_f32_dpp v29, v19, v29 row_newbcast:1 row_mask:0xa bank_mask:0xf
    v_mul_f32_dpp v30, v19, v30 row_newbcast:2 row_mask:0xa bank_mask:0xf
    v_mul_f32_dpp v31, v19, v31 row_newbcast:3 row_mask:0xa bank_mask:0xf
    v_mul_f32_dpp v32, v19, v32 row_newbcast:4 row_mask:0xa bank_mask:0xf
    v_mul_f32_dpp v33, v19, v33 row_newbcast:5 row_mask:0xa bank_mask:0xf
    v_mul_f32_dpp v34, v19, v34 row_newbcast:6 row_mask:0xa bank_mask:0xf
    v_mul_f32_dpp v35, v19, v35 row_newbcast:7 row_mask:0xa bank_mask:0xf
    v_cvt_pk_bf16_f32 v88, v28, v29
    v_cvt_pk_bf16_f32 v89, v30, v31
    v_cvt_pk_bf16_f32 v90, v32, v33
    v_cvt_pk_bf16_f32 v91, v34, v35
    s_waitcnt vmcnt(4)
    v_mfma_f32_32x32x16_bf16 v[0:15], v[64:67], v[176:179], 0
    ds_read_b64_tr_b16 v[184:185], v246 offset:2048
    ds_read_b64_tr_b16 v[186:187], v246 offset:3072
    ds_read_b64_tr_b16 v[188:189], v247 offset:2048
    ds_read_b64_tr_b16 v[190:191], v247 offset:3072
    s_mov_b32 m0, s68
    v_mfma_f32_32x32x16_bf16 v[16:31], v[68:71], v[176:179], 0
    buffer_load_dwordx4 v222, s[4:7], s41 offen sc1 lds
    buffer_load_dwordx4 v223, s[72:75], s41 offen offset:1024 sc1 lds
    v_permlane32_swap_b32 v242, v236
    v_permlane32_swap_b32 v243, v237
    s_add_u32 s38, s38, 1
    v_mfma_f32_32x32x16_bf16 v[32:47], v[64:67], v[180:183], 0
    v_permlane32_swap_b32 v244, v238
    v_permlane32_swap_b32 v245, v239
    v_permlane32_swap_b32 v240, v241
    v_add_f32 v242, v242, v236
    v_mfma_f32_32x32x16_bf16 v[48:63], v[68:71], v[180:183], 0
    v_add_f32 v243, v243, v237
    v_add_f32 v244, v244, v238
    v_add_f32 v245, v245, v239
    v_add_f32 v240, -v240, -v241
    v_mov_b32 v254, s52
    v_mov_b32 v255, s38
    s_waitcnt vmcnt(4) lgkmcnt(0)
    v_mfma_f32_32x32x16_bf16 v[0:15], v[72:75], v[184:187], v[0:15]
    ds_read_b64_tr_b16 v[176:177], v246 offset:4096
    ds_read_b64_tr_b16 v[178:179], v246 offset:5120
    ds_read_b64_tr_b16 v[180:181], v247 offset:4096
    ds_read_b64_tr_b16 v[182:183], v247 offset:5120
    s_lshl_b32 s58, s38, 3
    s_add_u32 s58, s58, s20
    s_mov_b32 m0, s69
    v_mfma_f32_32x32x16_bf16 v[16:31], v[76:79], v[184:187], v[16:31]
    buffer_load_dwordx4 v224, s[4:7], s41 offen sc1 lds
    buffer_load_dwordx4 v225, s[72:75], s41 offen offset:1024 sc1 lds
    s_set_gpr_idx_on s32, gpr_idx(DST)
    s_nop 0
    v_cvt_pk_bf16_f32 v195, v242, v243
    v_cvt_pk_bf16_f32 v196, v244, v245
    v_cvt_pk_bf16_f32 v197, v240, v240
    s_set_gpr_idx_off
    s_mov_b64 exec, 1
    ds_write_b32 v254, v255
    s_mov_b64 exec, -1
    s_cmp_lt_u32 s58, s22
    s_cbranch_scc0 K2_dyn_81
K2_back_82:
    v_readlane_b32 s3, v253, s58
    s_lshl_b32 s44, s34, 7
    s_and_b32 s48, s3, 0x3ffff
    s_bfe_u32 s33, s3, 0x30013
    s_mul_i32 s35, s38, 6
    s_cmp_eq_u32 s34, 0
    s_cselect_b32 s35, s35, s48
    s_mov_b32 s45, s44
    s_xor_b32 s47, s44, 256
    s_add_u32 s49, s48, 128
    s_add_u32 s60, s48, 256
    s_cmp_eq_u32 s33, 3
    s_cselect_b32 s46, s44, s47
    s_cselect_b32 s50, s60, s48
    s_cselect_b32 s51, s48, s49
    s_sub_u32 s60, s33, 2
    s_cmp_lt_u32 s60, 2
    s_cbranch_scc0 K2_rare_87
K2_back_88:
    v_mfma_f32_32x32x16_bf16 v[32:47], v[72:75], v[188:191], v[32:47]
    v_add_u32 v233, s48, v230
    ds_read_b32 v232, v233
    ds_read_b32 v233, v233 offset:1024
    v_mfma_f32_32x32x16_bf16 v[48:63], v[76:79], v[188:191], v[48:63]
    s_waitcnt vmcnt(4) lgkmcnt(3)
    v_mfma_f32_32x32x16_bf16 v[0:15], v[80:83], v[176:179], v[0:15]
    ds_read_b64_tr_b16 v[184:185], v246 offset:6144
    ds_read_b64_tr_b16 v[186:187], v246 offset:7168
    ds_read_b64_tr_b16 v[188:189], v247 offset:6144
    ds_read_b64_tr_b16 v[190:191], v247 offset:7168
    s_mov_b32 m0, s70
    v_mfma_f32_32x32x16_bf16 v[16:31], v[84:87], v[176:179], v[16:31]
    buffer_load_dwordx4 v226, s[4:7], s41 offen sc1 lds
    buffer_load_dwordx4 v227, s[72:75], s41 offen offset:1024 sc1 lds
    v_mfma_f32_32x32x16_bf16 v[32:47], v[80:83], v[180:183], v[32:47]
    v_mfma_f32_32x32x16_bf16 v[48:63], v[84:87], v[180:183], v[48:63]
    s_waitcnt lgkmcnt(4)
    v_or_b32 v232, v232, v231
    v_or_b32 v233, v233, v231
    s_cmp_lg_u32 s34, 0
    s_cbranch_scc1 K2_dum_90
    s_cmp_eq_u32 s33, 4
    s_cbranch_scc1 K2_a4_91
K2_b4_93:
    s_add_u32 m0, s48, 512
    s_add_u32 s65, s48, 1536
    buffer_load_dwordx4 v232, s[16:19], 0 offen  lds
    s_mov_b32 m0, s65
    s_mov_b32 exec_hi, 0
    buffer_load_dwordx4 v233, s[16:19], 0 offen  lds
    s_mov_b32 exec_hi, -1
K2_back_92:
    s_waitcnt vmcnt(6) lgkmcnt(0)
    v_mfma_f32_32x32x16_bf16 v[0:15], v[88:91], v[184:187], v[0:15]
    ds_read_b64_tr_b16 v[176:177], v246 offset:0
    ds_read_b64_tr_b16 v[178:179], v246 offset:1024
    ds_read_b64_tr_b16 v[180:181], v247 offset:0
    ds_read_b64_tr_b16 v[182:183], v247 offset:1024
    s_mov_b32 m0, s71
    v_mfma_f32_32x32x16_bf16 v[16:31], v[92:95], v[184:187], v[16:31]
    buffer_load_dwordx4 v228, s[4:7], s41 offen sc1 lds
    buffer_load_dwordx4 v229, s[72:75], s41 offen offset:1024 sc1 lds
    v_mfma_f32_32x32x16_bf16 v[32:47], v[88:91], v[188:191], v[32:47]
    s_nop 2
    v_mul_f32 v234, v0, v96
    v_mul_f32 v236, v8, v128
    v_fmac_f32 v234, v1, v97
    v_fmac_f32 v236, v9, v129
    v_fmac_f32 v234, v2, v98
    v_fmac_f32 v236, v10, v130
    v_fmac_f32 v234, v3, v99
    v_mfma_f32_32x32x16_bf16 v[48:63], v[92:95], v[188:191], v[48:63]
    s_setprio 0
    v_fmac_f32 v236, v11, v131
    v_fmac_f32 v234, v4, v100
    v_fmac_f32 v236, v12, v132
    v_fmac_f32 v234, v5, v101
    v_fmac_f32 v236, v13, v133
    v_fmac_f32 v234, v6, v102
    v_fmac_f32 v236, v14, v134
    v_fmac_f32 v234, v7, v103
    v_fmac_f32 v236, v15, v135
    v_mul_f32 v238, v16, v128
    v_mul_f32 v240, v24, v128
    v_fmac_f32 v238, v17, v129
    v_fmac_f32 v240, v25, v129
    v_fmac_f32 v238, v18, v130
    v_fmac_f32 v240, v26, v130
    v_fmac_f32 v238, v19, v131
    v_fmac_f32 v240, v27, v131
    v_fmac_f32 v238, v20, v132
    v_fmac_f32 v240, v28, v132
    v_fmac_f32 v238, v21, v133
    v_fmac_f32 v240, v29, v133
    v_fmac_f32 v238, v22, v134
    v_fmac_f32 v240, v30, v134
    v_fmac_f32 v238, v23, v135
    v_fmac_f32 v240, v31, v135
    v_mul_f32 v235, v32, v104
    v_mul_f32 v237, v40, v136
    v_fmac_f32 v235, v33, v105
    v_fmac_f32 v237, v41, v137
    v_fmac_f32 v235, v34, v106
    v_fmac_f32 v237, v42, v138
    v_fmac_f32 v235, v35, v107
    v_fmac_f32 v237, v43, v139
    v_fmac_f32 v235, v36, v108
    v_fmac_f32 v237, v44, v140
    v_fmac_f32 v235, v37, v109
    v_fmac_f32 v237, v45, v141
    v_fmac_f32 v235, v38, v110
    v_fmac_f32 v237, v46, v142
    v_fmac_f32 v235, v39, v111
    v_fmac_f32 v237, v47, v143
    v_mul_f32 v239, v48, v136
    v_mul_f32 v241, v56, v136
    s_setprio 1
    s_waitcnt vmcnt(6) lgkmcnt(0)
    v_mfma_f32_32x32x16_bf16 v[0:15], v[64:67], v[176:179], 0
    ds_read_b64_tr_b16 v[184:185], v246 offset:2048
    ds_read_b64_tr_b16 v[186:187], v246 offset:3072
    ds_read_b64_tr_b16 v[188:189], v247 offset:2048
    ds_read_b64_tr_b16 v[190:191], v247 offset:3072
    v_fmac_f32 v239, v49, v137
    v_fmac_f32 v241, v57, v137
    s_mov_b32 m0, s68
    v_mfma_f32_32x32x16_bf16 v[16:31], v[68:71], v[176:179], 0
    buffer_load_dwordx4 v222, s[4:7], s42 offen sc1 lds
    buffer_load_dwordx4 v223, s[72:75], s42 offen offset:1024 sc1 lds
    v_fmac_f32 v239, v50, v138
    v_fmac_f32 v241, v58, v138
    v_fmac_f32 v239, v51, v139
    v_fmac_f32 v241, v59, v139
    v_fmac_f32 v239, v52, v140
    v_mfma_f32_32x32x16_bf16 v[32:47], v[64:67], v[180:183], 0
    v_fmac_f32 v241, v60, v140
    v_fmac_f32 v239, v53, v141
    v_fmac_f32 v241, v61, v141
    v_fmac_f32 v239, v54, v142
    v_fmac_f32 v241, v62, v142
    v_fmac_f32 v239, v55, v143
    v_fmac_f32 v241, v63, v143
    v_mfma_f32_32x32x16_bf16 v[48:63], v[68:71], v[180:183], 0
    v_permlane32_swap_b32 v234, v236
    v_permlane32_swap_b32 v235, v237
    v_permlane32_swap_b32 v240, v238
    s_waitcnt vmcnt(6) lgkmcnt(0)
    v_mfma_f32_32x32x16_bf16 v[0:15], v[72:75], v[184:187], v[0:15]
    ds_read_b64_tr_b16 v[176:177], v246 offset:4096
    ds_read_b64_tr_b16 v[178:179], v246 offset:5120
    ds_read_b64_tr_b16 v[180:181], v247 offset:4096
    ds_read_b64_tr_b16 v[182:183], v247 offset:5120
    v_permlane32_swap_b32 v241, v239
    s_mov_b32 m0, s69
    v_mfma_f32_32x32x16_bf16 v[16:31], v[76:79], v[184:187], v[16:31]
    buffer_load_dwordx4 v224, s[4:7], s42 offen sc1 lds
    buffer_load_dwordx4 v225, s[72:75], s42 offen offset:1024 sc1 lds
    v_add_f32 v234, v234, v236
    v_add_f32 v235, v235, v237
    v_add_f32 v240, v240, v238
    v_add_f32 v241, v241, v239
    v_mfma_f32_32x32x16_bf16 v[32:47], v[72:75], v[188:191], v[32:47]
    s_set_gpr_idx_on s31, gpr_idx(DST)
    s_nop 0
    v_cvt_pk_bf16_f32 v192, v234, v235
    v_cvt_pk_bf16_f32 v193, v240, v241
    s_set_gpr_idx_off
    v_mfma_f32_32x32x16_bf16 v[48:63], v[76:79], v[188:191], v[48:63]
    s_waitcnt vmcnt(4) lgkmcnt(0)
    v_mfma_f32_32x32x16_bf16 v[0:15], v[80:83], v[176:179], v[0:15]
    ds_read_b64_tr_b16 v[184:185], v246 offset:6144
    ds_read_b64_tr_b16 v[186:187], v246 offset:7168
    ds_read_b64_tr_b16 v[188:189], v247 offset:6144
    ds_read_b64_tr_b16 v[190:191], v247 offset:7168
    s_mov_b32 m0, s70
    v_mfma_f32_32x32x16_bf16 v[16:31], v[84:87], v[176:179], v[16:31]
    buffer_load_dwordx4 v226, s[4:7], s42 offen sc1 lds
    buffer_load_dwordx4 v227, s[72:75], s42 offen offset:1024 sc1 lds
    v_mfma_f32_32x32x16_bf16 v[32:47], v[80:83], v[180:183], v[32:47]
    v_mfma_f32_32x32x16_bf16 v[48:63], v[84:87], v[180:183], v[48:63]
    s_waitcnt vmcnt(4) lgkmcnt(0)
    v_mfma_f32_32x32x16_bf16 v[0:15], v[88:91], v[184:187], v[0:15]
    ds_read_b64_tr_b16 v[176:177], v246 offset:0
    ds_read_b64_tr_b16 v[178:179], v246 offset:1024
    ds_read_b64_tr_b16 v[180:181], v247 offset:0
    ds_read_b64_tr_b16 v[182:183], v247 offset:1024
    s_mov_b32 m0, s71
    v_mfma_f32_32x32x16_bf16 v[16:31], v[92:95], v[184:187], v[16:31]
    buffer_load_dwordx4 v228, s[4:7], s42 offen sc1 lds
    buffer_load_dwordx4 v229, s[72:75], s42 offen offset:1024 sc1 lds
    v_mfma_f32_32x32x16_bf16 v[32:47], v[88:91], v[188:191], v[32:47]
    s_nop 2
    v_mul_f32 v234, v0, v144
    v_mul_f32 v236, v8, v112
    v_fmac_f32 v234, v1, v145
    v_fmac_f32 v236, v9, v113
    v_fmac_f32 v234, v2, v146
    v_fmac_f32 v236, v10, v114
    v_fmac_f32 v234, v3, v147
    v_mfma_f32_32x32x16_bf16 v[48:63], v[92:95], v[188:191], v[48:63]
    s_setprio 0
    v_fmac_f32 v236, v11, v115
    v_fmac_f32 v234, v4, v148
    v_fmac_f32 v236, v12, v116
    v_fmac_f32 v234, v5, v149
    v_fmac_f32 v236, v13, v117
    v_fmac_f32 v234, v6, v150
    v_fmac_f32 v236, v14, v118
    v_fmac_f32 v234, v7, v151
    v_fmac_f32 v236, v15, v119
    v_mul_f32 v238, v16, v160
    v_mul_f32 v240, v24, v160
    v_fmac_f32 v238, v17, v161
    v_fmac_f32 v240, v25, v161
    v_fmac_f32 v238, v18, v162
    v_fmac_f32 v240, v26, v162
    v_fmac_f32 v238, v19, v163
    v_fmac_f32 v240, v27, v163
    v_fmac_f32 v238, v20, v164
    v_fmac_f32 v240, v28, v164
    v_fmac_f32 v238, v21, v165
    v_fmac_f32 v240, v29, v165
    v_fmac_f32 v238, v22, v166
    v_fmac_f32 v240, v30, v166
    v_fmac_f32 v238, v23, v167
    v_fmac_f32 v240, v31, v167
    v_mul_f32 v235, v32, v152
    v_mul_f32 v237, v40, v120
    v_fmac_f32 v235, v33, v153
    v_fmac_f32 v237, v41, v121
    v_fmac_f32 v235, v34, v154
    v_fmac_f32 v237, v42, v122
    v_fmac_f32 v235, v35, v155
    v_fmac_f32 v237, v43, v123
    v_fmac_f32 v235, v36, v156
    v_fmac_f32 v237, v44, v124
    v_fmac_f32 v235, v37, v157
    v_fmac_f32 v237, v45, v125
    v_fmac_f32 v235, v38, v158
    v_fmac_f32 v237, v46, v126
    v_fmac_f32 v235, v39, v159
    v_fmac_f32 v237, v47, v127
    v_mul_f32 v239, v48, v168
    v_mul_f32 v241, v56, v168
    s_setprio 1
    s_waitcnt vmcnt(4) lgkmcnt(0)
    v_mfma_f32_32x32x16_bf16 v[0:15], v[64:67], v[176:179], 0
    ds_read_b64_tr_b16 v[184:185], v246 offset:2048
    ds_read_b64_tr_b16 v[186:187], v246 offset:3072
    ds_read_b64_tr_b16 v[188:189], v247 offset:2048
    ds_read_b64_tr_b16 v[190:191], v247 offset:3072
    v_fmac_f32 v239, v49, v169
    v_fmac_f32 v241, v57, v169
    s_mov_b32 m0, s68
    v_mfma_f32_32x32x16_bf16 v[16:31], v[68:71], v[176:179], 0
    buffer_load_dwordx4 v222, s[4:7], s43 offen sc1 lds
    buffer_load_dwordx4 v223, s[72:75], s43 offen offset:1024 sc1 lds
    v_fmac_f32 v239, v50, v170
    v_fmac_f32 v241, v58, v170
    v_fmac_f32 v239, v51, v171
    v_fmac_f32 v241, v59, v171
    v_fmac_f32 v239, v52, v172
    v_mfma_f32_32x32x16_bf16 v[32:47], v[64:67], v[180:183], 0
    v_fmac_f32 v241, v60, v172
    v_fmac_f32 v239, v53, v173
    v_fmac_f32 v241, v61, v173
    v_fmac_f32 v239, v54, v174
    v_fmac_f32 v241, v62, v174
    v_fmac_f32 v239, v55, v175
    v_fmac_f32 v241, v63, v175
    v_mfma_f32_32x32x16_bf16 v[48:63], v[68:71], v[180:183], 0
    s_waitcnt vmcnt(4) lgkmcnt(0)
    v_mfma_f32_32x32x16_bf16 v[0:15], v[72:75], v[184:187], v[0:15]
    ds_read_b64_tr_b16 v[176:177], v246 offset:4096
    ds_read_b64_tr_b16 v[178:179], v246 offset:5120
    ds_read_b64_tr_b16 v[180:181], v247 offset:4096
    ds_read_b64_tr_b16 v[182:183], v247 offset:5120
    s_mov_b32 m0, s69
    v_mfma_f32_32x32x16_bf16 v[16:31], v[76:79], v[184:187], v[16:31]
    buffer_load_dwordx4 v224, s[4:7], s43 offen sc1 lds
    buffer_load_dwordx4 v225, s[72:75], s43 offen offset:1024 sc1 lds
    v_mfma_f32_32x32x16_bf16 v[32:47], v[72:75], v[188:191], v[32:47]
    v_mfma_f32_32x32x16_bf16 v[48:63], v[76:79], v[188:191], v[48:63]
    s_waitcnt vmcnt(4) lgkmcnt(0)
    v_mfma_f32_32x32x16_bf16 v[0:15], v[80:83], v[176:179], v[0:15]
    ds_read_b64_tr_b16 v[184:185], v246 offset:6144
    ds_read_b64_tr_b16 v[186:187], v246 offset:7168
    ds_read_b64_tr_b16 v[188:189], v247 offset:6144
    ds_read_b64_tr_b16 v[190:191], v247 offset:7168
    s_mov_b32 m0, s70
    v_mfma_f32_32x32x16_bf16 v[16:31], v[84:87], v[176:179], v[16:31]
    buffer_load_dwordx4 v226, s[4:7], s43 offen sc1 lds
    buffer_load_dwordx4 v227, s[72:75], s43 offen offset:1024 sc1 lds
    v_mfma_f32_32x32x16_bf16 v[32:47], v[80:83], v[180:183], v[32:47]
    v_add_u32 v222, s48, v251
    ds_read2_b32 v[222:223], v222 offset0:1 offset1:3
    v_mfma_f32_32x32x16_bf16 v[48:63], v[84:87], v[180:183], v[48:63]
    s_waitcnt vmcnt(4) lgkmcnt(1)
    v_mfma_f32_32x32x16_bf16 v[0:15], v[88:91], v[184:187], v[0:15]
    ds_read_b64_tr_b16 v[176:177], v246 offset:0
    ds_read_b64_tr_b16 v[178:179], v246 offset:1024
    ds_read_b64_tr_b16 v[180:181], v247 offset:0
    ds_read_b64_tr_b16 v[182:183], v247 offset:1024
    s_mov_b32 m0, s71
    v_mfma_f32_32x32x16_bf16 v[16:31], v[92:95], v[184:187], v[16:31]
    buffer_load_dwordx4 v228, s[4:7], s43 offen sc1 lds
    buffer_load_dwordx4 v229, s[72:75], s43 offen offset:1024 sc1 lds
    s_waitcnt lgkmcnt(4)
    v_mad_u32_u16 v222, v222, s39, v248 op_sel:[1,0,0,0]
    v_mad_u32_u16 v223, v223, s39, v248 op_sel:[1,0,0,0]
    v_mfma_f32_32x32x16_bf16 v[32:47], v[88:91], v[188:191], v[32:47]
    v_add_u32 v224, s49, v251
    ds_read2_b32 v[224:225], v224 offset0:1 offset1:3
    v_mul_f32 v242, v0, v144
    v_fma_f32 v238, v8, v160, -v238
    v_fmac_f32 v242, v1, v145
    v_fmac_f32 v238, v9, v161
    v_fmac_f32 v242, v2, v146
    v_mfma_f32_32x32x16_bf16 v[48:63], v[92:95], v[188:191], v[48:63]
    s_setprio 0
    v_fmac_f32 v238, v10, v162
    v_fmac_f32 v242, v3, v147
    v_fmac_f32 v238, v11, v163
    v_fmac_f32 v242, v4, v148
    v_fmac_f32 v238, v12, v164
    v_fmac_f32 v242, v5, v149
    v_fmac_f32 v238, v13, v165
    v_fmac_f32 v242, v6, v150
    v_fmac_f32 v238, v14, v166
    v_fmac_f32 v242, v7, v151
    v_fmac_f32 v238, v15, v167
    v_fmac_f32 v236, v16, v112
    v_mul_f32 v244, v24, v160
    v_fmac_f32 v236, v17, v113
    v_fmac_f32 v244, v25, v161
    v_fmac_f32 v236, v18, v114
    v_fmac_f32 v244, v26, v162
    v_fmac_f32 v236, v19, v115
    v_fmac_f32 v244, v27, v163
    v_fmac_f32 v236, v20, v116
    v_fmac_f32 v244, v28, v164
    v_fmac_f32 v236, v21, v117
    v_fmac_f32 v244, v29, v165
    v_fmac_f32 v236, v22, v118
    v_fmac_f32 v244, v30, v166
    v_fmac_f32 v236, v23, v119
    v_fmac_f32 v244, v31, v167
    v_mul_f32 v243, v32, v152
    v_fma_f32 v239, v40, v168, -v239
    v_fmac_f32 v243, v33, v153
    v_fmac_f32 v239, v41, v169
    v_fmac_f32 v243, v34, v154
    v_fmac_f32 v239, v42, v170
    v_fmac_f32 v243, v35, v155
    v_fmac_f32 v239, v43, v171
    v_fmac_f32 v243, v36, v156
    v_fmac_f32 v239, v44, v172
    v_fmac_f32 v243, v37, v157
    v_fmac_f32 v239, v45, v173
    v_fmac_f32 v243, v38, v158
    v_fmac_f32 v239, v46, v174
    v_fmac_f32 v243, v39, v159
    v_fmac_f32 v239, v47, v175
    v_fmac_f32 v237, v48, v120
    v_mul_f32 v245, v56, v168
    v_fmac_f32 v237, v49, v121
    v_fmac_f32 v245, v57, v169
    v_fmac_f32 v237, v50, v122
    v_fmac_f32 v245, v58, v170
    v_fmac_f32 v237, v51, v123
    s_setprio 1
    s_waitcnt vmcnt(4) lgkmcnt(1)
    v_mfma_f32_32x32x16_bf16 v[0:15], v[64:67], v[176:179], 0
    ds_read_b64_tr_b16 v[184:185], v246 offset:2048
    ds_read_b64_tr_b16 v[186:187], v246 offset:3072
    ds_read_b64_tr_b16 v[188:189], v247 offset:2048
    ds_read_b64_tr_b16 v[190:191], v247 offset:3072
    v_fmac_f32 v245, v59, v171
    v_fmac_f32 v237, v52, v124
    s_mov_b32 m0, s68
    v_mfma_f32_32x32x16_bf16 v[16:31], v[68:71], v[176:179], 0
    buffer_load_dwordx4 v222, s[4:7], s44 offen sc1 lds
    buffer_load_dwordx4 v223, s[72:75], s44 offen offset:1024 sc1 lds
    s_waitcnt lgkmcnt(4)
    v_mad_u32_u16 v224, v224, s39, v248 op_sel:[1,0,0,0]
    v_mad_u32_u16 v225, v225, s39, v248 op_sel:[1,0,0,0]
    v_fmac_f32 v245, v60, v172
    v_fmac_f32 v237, v53, v125
    v_mfma_f32_32x32x16_bf16 v[32:47], v[64:67], v[180:183], 0
    v_add_u32 v226, s50, v251
    ds_read2_b32 v[226:227], v226 offset0:1 offset1:3
    v_fmac_f32 v245, v61, v173
    v_fmac_f32 v237, v54, v126
    v_fmac_f32 v245, v62, v174
    v_fmac_f32 v237, v55, v127
    v_fmac_f32 v245, v63, v175
    v_mfma_f32_32x32x16_bf16 v[48:63], v[68:71], v[180:183], 0
    v_permlane32_swap_b32 v242, v234
    v_permlane32_swap_b32 v243, v235
    v_add_f32 v242, v242, v234
    v_add_f32 v243, v243, v235
    s_waitcnt vmcnt(4) lgkmcnt(1)
    v_mfma_f32_32x32x16_bf16 v[0:15], v[72:75], v[184:187], v[0:15]
    ds_read_b64_tr_b16 v[176:177], v246 offset:4096
    ds_read_b64_tr_b16 v[178:179], v246 offset:5120
    ds_read_b64_tr_b16 v[180:181], v247 offset:4096
    ds_read_b64_tr_b16 v[182:183], v247 offset:5120
    s_mov_b32 m0, s69
    v_mfma_f32_32x32x16_bf16 v[16:31], v[76:79], v[184:187], v[16:31]
    buffer_load_dwordx4 v224, s[4:7], s45 offen sc1 lds
    buffer_load_dwordx4 v225, s[72:75], s45 offen offset:1024 sc1 lds
    s_waitcnt lgkmcnt(4)
    v_mad_u32_u16 v226, v226, s39, v248 op_sel:[1,0,0,0]
    v_mad_u32_u16 v227, v227, s39, v248 op_sel:[1,0,0,0]
    v_mfma_f32_32x32x16_bf16 v[32:47], v[72:75], v[188:191], v[32:47]
    v_add_u32 v228, s51, v251
    ds_read2_b32 v[228:229], v228 offset0:1 offset1:3
    s_set_gpr_idx_on s31, gpr_idx(DST)
    s_nop 0
    v_cvt_pk_bf16_f32 v194, v242, v243
    s_set_gpr_idx_off
    v_mfma_f32_32x32x16_bf16 v[48:63], v[76:79], v[188:191], v[48:63]
    s_waitcnt vmcnt(4) lgkmcnt(1)
    v_mfma_f32_32x32x16_bf16 v[0:15], v[80:83], v[176:179], v[0:15]
    ds_read_b64_tr_b16 v[184:185], v246 offset:6144
    ds_read_b64_tr_b16 v[186:187], v246 offset:7168
    ds_read_b64_tr_b16 v[188:189], v247 offset:6144
    ds_read_b64_tr_b16 v[190:191], v247 offset:7168
    s_mov_b32 s32, s31
    s_mov_b32 s31, s35
    s_mov_b32 m0, s70
    v_mfma_f32_32x32x16_bf16 v[16:31], v[84:87], v[176:179], v[16:31]
    buffer_load_dwordx4 v226, s[4:7], s46 offen sc1 lds
    buffer_load_dwordx4 v227, s[72:75], s46 offen offset:1024 sc1 lds
    s_waitcnt lgkmcnt(4)
    v_mad_u32_u16 v228, v228, s39, v248 op_sel:[1,0,0,0]
    v_mad_u32_u16 v229, v229, s39, v248 op_sel:[1,0,0,0]
    s_sub_u32 s26, s48, s29
    s_mov_b32 s29, s48
    v_mfma_f32_32x32x16_bf16 v[32:47], v[80:83], v[180:183], v[32:47]
    s_mov_b32 s30, s3
    s_bfe_u32 s56, s3, 0x40012
    s_cmp_eq_u32 s34, 0
    s_cselect_b32 s56, s56, 0
    v_mfma_f32_32x32x16_bf16 v[48:63], v[84:87], v[180:183], v[48:63]
    s_waitcnt vmcnt(4) lgkmcnt(0)
    v_mfma_f32_32x32x16_bf16 v[0:15], v[88:91], v[184:187], v[0:15]
    ds_read_b64_tr_b16 v[176:177], v246 offset:0
    ds_read_b64_tr_b16 v[178:179], v246 offset:1024
    ds_read_b64_tr_b16 v[180:181], v247 offset:0
    ds_read_b64_tr_b16 v[182:183], v247 offset:1024
    s_mov_b32 m0, s71
    v_mfma_f32_32x32x16_bf16 v[16:31], v[92:95], v[184:187], v[16:31]
    buffer_load_dwordx4 v228, s[4:7], s47 offen sc1 lds
    buffer_load_dwordx4 v229, s[72:75], s47 offen offset:1024 sc1 lds
    v_mfma_f32_32x32x16_bf16 v[32:47], v[88:91], v[188:191], v[32:47]
    s_nop 2
    v_mul_f32 v242, v0, v144
    v_fma_f32 v240, v8, v160, -v240
    v_fmac_f32 v242, v1, v145
    v_fmac_f32 v240, v9, v161
    v_fmac_f32 v242, v2, v146
    v_fmac_f32 v240, v10, v162
    v_fmac_f32 v242, v3, v147
    v_mfma_f32_32x32x16_bf16 v[48:63], v[92:95], v[188:191], v[48:63]
    s_setprio 0
    v_fmac_f32 v240, v11, v163
    v_fmac_f32 v242, v4, v148
    v_fmac_f32 v240, v12, v164
    v_fmac_f32 v242, v5, v149
    v_fmac_f32 v240, v13, v165
    v_fmac_f32 v242, v6, v150
    v_fmac_f32 v240, v14, v166
    v_fmac_f32 v242, v7, v151
    v_fmac_f32 v240, v15, v167
    v_add_u32 v249, s26, v249
    v_add_u32 v250, s26, v250
    v_fma_f32 v244, v16, v160, -v244
    v_fmac_f32 v236, v24, v112
    v_fmac_f32 v244, v17, v161
    v_fmac_f32 v236, v25, v113
    v_fmac_f32 v244, v18, v162
    v_fmac_f32 v236, v26, v114
    v_fmac_f32 v244, v19, v163
    v_fmac_f32 v236, v27, v115
    v_fmac_f32 v244, v20, v164
    v_fmac_f32 v236, v28, v116
    v_fmac_f32 v244, v21, v165
    v_fmac_f32 v236, v29, v117
    v_fmac_f32 v244, v22, v166
    v_fmac_f32 v236, v30, v118
    v_fmac_f32 v244, v23, v167
    v_fmac_f32 v236, v31, v119
    ds_read_b64_tr_b16 v[0:1], v249 offset:0
    ds_read_b64_tr_b16 v[2:3], v249 offset:32
    ds_read_u16_d16_hi v16, v250 offset:0
    v_mul_f32 v243, v32, v152
    v_fma_f32 v241, v40, v168, -v241
    v_fmac_f32 v243, v33, v153
    v_fmac_f32 v241, v41, v169
    v_fmac_f32 v243, v34, v154
    v_fmac_f32 v241, v42, v170
    v_fmac_f32 v243, v35, v155
    v_fmac_f32 v241, v43, v171
    v_fmac_f32 v243, v36, v156
    v_fmac_f32 v241, v44, v172
    v_fmac_f32 v243, v37, v157
    v_fmac_f32 v241, v45, v173
    v_fmac_f32 v243, v38, v158
    v_fmac_f32 v241, v46, v174
    v_fmac_f32 v243, v39, v159
    v_fmac_f32 v241, v47, v175
    ds_read_b64_tr_b16 v[4:5], v249 offset:512
    ds_read_b64_tr_b16 v[6:7], v249 offset:544
    ds_read_u16_d16_hi v17, v250 offset:128
    v_fma_f32 v245, v48, v168, -v245
    v_fmac_f32 v237, v56, v120
    v_fmac_f32 v245, v49, v169
    v_fmac_f32 v237, v57, v121
    v_fmac_f32 v245, v50, v170
    v_fmac_f32 v237, v58, v122
    v_fmac_f32 v245, v51, v171
    v_fmac_f32 v237, v59, v123
    v_fmac_f32 v245, v52, v172
    v_fmac_f32 v237, v60, v124
    v_fmac_f32 v245, v53, v173
    v_fmac_f32 v237, v61, v125
    v_fmac_f32 v245, v54, v174
    v_fmac_f32 v237, v62, v126
    v_fmac_f32 v245, v55, v175
    v_fmac_f32 v237, v63, v127
    s_cmp_eq_u32 s56, 5
    s_cbranch_scc1 K2_U20
    s_cmp_eq_u32 s56, 6
    s_cbranch_scc1 K2_U3h0
    s_branch K2_DSP0
K2_U11:
    s_setprio 1
    v_mov_b32 v254, 163296
    v_mov_b32 v255, 1
    v_lshl_add_u32 v233, v252, 1, s53
    s_mov_b64 exec, 1
    ds_add_rtn_u32 v232, v254, v255
    s_mov_b64 exec, -1
    ds_read_b32 v233, v233
    s_waitcnt lgkmcnt(5)
    v_lshlrev_b32 v20, 16, v0
    v_and_b32 v21, 0xffff0000, v0
    v_lshlrev_b32 v22, 16, v1
    v_and_b32 v23, 0xffff0000, v1
    v_lshlrev_b32 v24, 16, v2
    v_and_b32 v25, 0xffff0000, v2
    v_lshlrev_b32 v26, 16, v3
    v_and_b32 v27, 0xffff0000, v3
    v_mul_f32_dpp v36, v16, v20 row_newbcast:8 row_mask:0xf bank_mask:0xf
    v_mul_f32_dpp v37, v16, v21 row_newbcast:9 row_mask:0xf bank_mask:0xf
    v_mul_f32_dpp v38, v16, v22 row_newbcast:10 row_mask:0xf bank_mask:0xf
    v_mul_f32_dpp v39, v16, v23 row_newbcast:11 row_mask:0xf bank_mask:0xf
    v_mul_f32_dpp v40, v16, v24 row_newbcast:12 row_mask:0xf bank_mask:0xf
    v_mul_f32_dpp v41, v16, v25 row_newbcast:13 row_mask:0xf bank_mask:0xf
    v_mul_f32_dpp v42, v16, v26 row_newbcast:14 row_mask:0xf bank_mask:0xf
    v_mul_f32_dpp v43, v16, v27 row_newbcast:15 row_mask:0xf bank_mask:0xf
    v_cvt_pk_bf16_f32 v68, v36, v37
    v_cvt_pk_bf16_f32 v69, v38, v39
    v_cvt_pk_bf16_f32 v70, v40, v41
    v_cvt_pk_bf16_f32 v71, v42, v43
    v_mul_f32_dpp v20, v16, v20 row_newbcast:0 row_mask:0xa bank_mask:0xf
    v_mul_f32_dpp v21, v16, v21 row_newbcast:1 row_mask:0xa bank_mask:0xf
    v_mul_f32_dpp v22, v16, v22 row_newbcast:2 row_mask:0xa bank_mask:0xf
    v_mul_f32_dpp v23, v16, v23 row_newbcast:3 row_mask:0xa bank_mask:0xf
    v_mul_f32_dpp v24, v16, v24 row_newbcast:4 row_mask:0xa bank_mask:0xf
    v_mul_f32_dpp v25, v16, v25 row_newbcast:5 row_mask:0xa bank_mask:0xf
    v_mul_f32_dpp v26, v16, v26 row_newbcast:6 row_mask:0xa bank_mask:0xf
    v_mul_f32_dpp v27, v16, v27 row_newbcast:7 row_mask:0xa bank_mask:0xf
    v_cvt_pk_bf16_f32 v64, v20, v21
    v_cvt_pk_bf16_f32 v65, v22, v23
    v_cvt_pk_bf16_f32 v66, v24, v25
    v_cvt_pk_bf16_f32 v67, v26, v27
    s_waitcnt lgkmcnt(0)
    v_readfirstlane_b32 s58, v232
    s_nop 0
    s_cmp_lt_u32 s58, s22
    s_cbranch_scc0 K2_nul_94
    s_and_b32 s59, s58, 7
    s_lshr_b32 s60, s58, 3
K2_chk_96:
    v_readlane_b32 s61, v233, s59
    s_nop 0
    s_cmp_gt_u32 s61, s60
    s_cbranch_scc0 K2_spin_95
K2_back_97:
    v_readlane_b32 s3, v253, s58
    s_lshl_b32 s44, s34, 7
    s_and_b32 s48, s3, 0x3ffff
    s_bfe_u32 s33, s3, 0x30013
    s_mov_b32 s35, s48
    s_mov_b32 s45, s44
    s_xor_b32 s47, s44, 256
    s_add_u32 s49, s48, 128
    s_add_u32 s60, s48, 256
    s_cmp_eq_u32 s33, 3
    s_cselect_b32 s46, s44, s47
    s_cselect_b32 s50, s60, s48
    s_cselect_b32 s51, s48, s49
    s_sub_u32 s60, s33, 2
    s_cmp_lt_u32 s60, 2
    s_cbranch_scc0 K2_rare_98
K2_back_99:
    v_add_u32 v222, s48, v251
    ds_read2_b32 v[222:223], v222 offset0:1 offset1:3
    v_add_u32 v224, s49, v251
    ds_read2_b32 v[224:225], v224 offset0:1 offset1:3
    v_add_u32 v226, s50, v251
    ds_read2_b32 v[226:227], v226 offset0:1 offset1:3
    v_add_u32 v228, s51, v251
    ds_read2_b32 v[228:229], v228 offset0:1 offset1:3
    s_waitcnt lgkmcnt(3)
    v_mad_u32_u16 v222, v222, s39, v248 op_sel:[1,0,0,0]
    v_mad_u32_u16 v223, v223, s39, v248 op_sel:[1,0,0,0]
    s_waitcnt lgkmcnt(2)
    v_mad_u32_u16 v224, v224, s39, v248 op_sel:[1,0,0,0]
    v_mad_u32_u16 v225, v225, s39, v248 op_sel:[1,0,0,0]
    s_waitcnt lgkmcnt(1)
    v_mad_u32_u16 v226, v226, s39, v248 op_sel:[1,0,0,0]
    v_mad_u32_u16 v227, v227, s39, v248 op_sel:[1,0,0,0]
    s_waitcnt lgkmcnt(0)
    v_mad_u32_u16 v228, v228, s39, v248 op_sel:[1,0,0,0]
    v_mad_u32_u16 v229, v229, s39, v248 op_sel:[1,0,0,0]
    s_waitcnt vmcnt(4)
    v_mfma_f32_32x32x16_bf16 v[0:15], v[64:67], v[176:179], 0
    ds_read_b64_tr_b16 v[184:185], v246 offset:2048
    ds_read_b64_tr_b16 v[186:187], v246 offset:3072
    ds_read_b64_tr_b16 v[188:189], v247 offset:2048
    ds_read_b64_tr_b16 v[190:191], v247 offset:3072
    s_mov_b32 m0, s68
    v_mfma_f32_32x32x16_bf16 v[16:31], v[68:71], v[176:179], 0
    buffer_load_dwordx4 v222, s[4:7], s44 offen sc1 lds
    buffer_load_dwordx4 v223, s[72:75], s44 offen offset:1024 sc1 lds
    v_permlane32_swap_b32 v242, v236
    v_permlane32_swap_b32 v243, v237
    v_mfma_f32_32x32x16_bf16 v[32:47], v[64:67], v[180:183], 0
    v_permlane32_swap_b32 v244, v238
    v_permlane32_swap_b32 v245, v239
    v_permlane32_swap_b32 v240, v241
    v_add_f32 v242, v242, v236
    v_mfma_f32_32x32x16_bf16 v[48:63], v[68:71], v[180:183], 0
    s_setprio 0
    v_add_f32 v243, v243, v237
    v_add_f32 v244, v244, v238
    v_add_f32 v245, v245, v239
    v_add_f32 v240, -v240, -v241
    v_sub_u32 v241, v230, v231
    v_cvt_pk_bf16_f32 v242, v242, v243
    v_cvt_pk_bf16_f32 v244, v244, v245
    v_cvt_pk_bf16_f32 v240, v240, v240
    ds_write_b32 v230, v242 offset:768
    ds_write_b32 v230, v244 offset:1024
    ds_write_b16 v241, v240 offset:1280
    v_mul_f32 v234, v0, v96
    v_mul_f32 v236, v8, v128
    v_fmac_f32 v234, v1, v97
    v_fmac_f32 v236, v9, v129
    v_fmac_f32 v234, v2, v98
    v_fmac_f32 v236, v10, v130
    v_fmac_f32 v234, v3, v99
    v_fmac_f32 v236, v11, v131
    v_fmac_f32 v234, v4, v100
    v_fmac_f32 v236, v12, v132
    v_fmac_f32 v234, v5, v101
    v_fmac_f32 v236, v13, v133
    v_fmac_f32 v234, v6, v102
    v_fmac_f32 v236, v14, v134
    v_fmac_f32 v234, v7, v103
    v_fmac_f32 v236, v15, v135
    v_mul_f32 v238, v16, v128
    v_mul_f32 v240, v24, v128
    v_fmac_f32 v238, v17, v129
    v_fmac_f32 v240, v25, v129
    v_fmac_f32 v238, v18, v130
    v_fmac_f32 v240, v26, v130
    v_fmac_f32 v238, v19, v131
    v_fmac_f32 v240, v27, v131
    v_fmac_f32 v238, v20, v132
    v_fmac_f32 v240, v28, v132
    v_fmac_f32 v238, v21, v133
    v_fmac_f32 v240, v29, v133
    v_fmac_f32 v238, v22, v134
    v_fmac_f32 v240, v30, v134
    v_fmac_f32 v238, v23, v135
    v_fmac_f32 v240, v31, v135
    v_mul_f32 v235, v32, v104
    v_mul_f32 v237, v40, v136
    v_fmac_f32 v235, v33, v105
    v_fmac_f32 v237, v41, v137
    v_fmac_f32 v235, v34, v106
    v_fmac_f32 v237, v42, v138
    v_fmac_f32 v235, v35, v107
    v_fmac_f32 v237, v43, v139
    v_fmac_f32 v235, v36, v108
    v_fmac_f32 v237, v44, v140
    v_fmac_f32 v235, v37, v109
    v_fmac_f32 v237, v45, v141
    v_fmac_f32 v235, v38, v110
    v_fmac_f32 v237, v46, v142
    v_fmac_f32 v235, v39, v111
    v_fmac_f32 v237, v47, v143
    v_mul_f32 v239, v48, v136
    v_mul_f32 v241, v56, v136
    v_fmac_f32 v239, v49, v137
    v_fmac_f32 v241, v57, v137
    v_fmac_f32 v239, v50, v138
    v_fmac_f32 v241, v58, v138
    v_fmac_f32 v239, v51, v139
    v_fmac_f32 v241, v59, v139
    v_fmac_f32 v239, v52, v140
    v_fmac_f32 v241, v60, v140
    v_fmac_f32 v239, v53, v141
    v_fmac_f32 v241, v61, v141
    v_fmac_f32 v239, v54, v142
    v_fmac_f32 v241, v62, v142
    v_fmac_f32 v239, v55, v143
    v_fmac_f32 v241, v63, v143
    s_setprio 1
    s_waitcnt vmcnt(4) lgkmcnt(3)
    v_mfma_f32_32x32x16_bf16 v[0:15], v[64:67], v[184:187], 0
    ds_read_b64_tr_b16 v[176:177], v246 offset:4096
    ds_read_b64_tr_b16 v[178:179], v246 offset:5120
    ds_read_b64_tr_b16 v[180:181], v247 offset:4096
    ds_read_b64_tr_b16 v[182:183], v247 offset:5120
    s_mov_b32 m0, s69
    v_mfma_f32_32x32x16_bf16 v[16:31], v[68:71], v[184:187], 0
    buffer_load_dwordx4 v224, s[4:7], s45 offen sc1 lds
    buffer_load_dwordx4 v225, s[72:75], s45 offen offset:1024 sc1 lds
    v_permlane32_swap_b32 v234, v236
    v_permlane32_swap_b32 v235, v237
    v_mfma_f32_32x32x16_bf16 v[32:47], v[64:67], v[188:191], 0
    v_permlane32_swap_b32 v240, v238
    v_permlane32_swap_b32 v241, v239
    v_lshl_add_u32 v230, v252, 1, s31
    v_add_f32 v234, v234, v236
    v_add_f32 v235, v235, v237
    v_mfma_f32_32x32x16_bf16 v[48:63], v[68:71], v[188:191], 0
    s_setprio 0
    v_add_f32 v240, v240, v238
    v_add_f32 v241, v241, v239
    v_cvt_pk_bf16_f32 v234, v234, v235
    v_cvt_pk_bf16_f32 v240, v240, v241
    ds_write_b32 v230, v234 offset:0
    ds_write_b32 v230, v240 offset:256
    v_mul_f32 v234, v0, v144
    v_mul_f32 v236, v8, v112
    v_fmac_f32 v234, v1, v145
    v_fmac_f32 v236, v9, v113
    v_fmac_f32 v234, v2, v146
    v_fmac_f32 v236, v10, v114
    v_fmac_f32 v234, v3, v147
    v_fmac_f32 v236, v11, v115
    v_fmac_f32 v234, v4, v148
    v_fmac_f32 v236, v12, v116
    v_fmac_f32 v234, v5, v149
    v_fmac_f32 v236, v13, v117
    v_fmac_f32 v234, v6, v150
    v_fmac_f32 v236, v14, v118
    v_fmac_f32 v234, v7, v151
    v_fmac_f32 v236, v15, v119
    v_mul_f32 v238, v16, v160
    v_mul_f32 v240, v24, v160
    v_fmac_f32 v238, v17, v161
    v_fmac_f32 v240, v25, v161
    v_fmac_f32 v238, v18, v162
    v_fmac_f32 v240, v26, v162
    v_fmac_f32 v238, v19, v163
    v_fmac_f32 v240, v27, v163
    v_fmac_f32 v238, v20, v164
    v_fmac_f32 v240, v28, v164
    v_fmac_f32 v238, v21, v165
    v_fmac_f32 v240, v29, v165
    v_fmac_f32 v238, v22, v166
    v_fmac_f32 v240, v30, v166
    v_fmac_f32 v238, v23, v167
    v_fmac_f32 v240, v31, v167
    v_mul_f32 v235, v32, v152
    v_mul_f32 v237, v40, v120
    v_fmac_f32 v235, v33, v153
    v_fmac_f32 v237, v41, v121
    v_fmac_f32 v235, v34, v154
    v_fmac_f32 v237, v42, v122
    v_fmac_f32 v235, v35, v155
    v_fmac_f32 v237, v43, v123
    v_fmac_f32 v235, v36, v156
    v_fmac_f32 v237, v44, v124
    v_fmac_f32 v235, v37, v157
    v_fmac_f32 v237, v45, v125
    v_fmac_f32 v235, v38, v158
    v_fmac_f32 v237, v46, v126
    v_fmac_f32 v235, v39, v159
    v_fmac_f32 v237, v47, v127
    v_mul_f32 v239, v48, v168
    v_mul_f32 v241, v56, v168
    v_fmac_f32 v239, v49, v169
    v_fmac_f32 v241, v57, v169
    v_fmac_f32 v239, v50, v170
    v_fmac_f32 v241, v58, v170
    v_fmac_f32 v239, v51, v171
    v_fmac_f32 v241, v59, v171
    v_fmac_f32 v239, v52, v172
    v_fmac_f32 v241, v60, v172
    v_fmac_f32 v239, v53, v173
    v_fmac_f32 v241, v61, v173
    v_fmac_f32 v239, v54, v174
    v_fmac_f32 v241, v62, v174
    v_fmac_f32 v239, v55, v175
    v_fmac_f32 v241, v63, v175
    s_setprio 1
    s_waitcnt vmcnt(4) lgkmcnt(2)
    v_mfma_f32_32x32x16_bf16 v[0:15], v[64:67], v[176:179], 0
    ds_read_b64_tr_b16 v[184:185], v246 offset:6144
    ds_read_b64_tr_b16 v[186:187], v246 offset:7168
    ds_read_b64_tr_b16 v[188:189], v247 offset:6144
    ds_read_b64_tr_b16 v[190:191], v247 offset:7168
    s_mov_b32 s32, s31
    s_mov_b32 s31, s35
    s_mov_b32 m0, s70
    v_mfma_f32_32x32x16_bf16 v[16:31], v[68:71], v[176:179], 0
    buffer_load_dwordx4 v226, s[4:7], s46 offen sc1 lds
    buffer_load_dwordx4 v227, s[72:75], s46 offen offset:1024 sc1 lds
    s_sub_u32 s26, s48, s29
    s_mov_b32 s29, s48
    s_mov_b32 s30, s3
    s_bfe_u32 s56, s3, 0x40012
    v_mfma_f32_32x32x16_bf16 v[32:47], v[64:67], v[180:183], 0
    s_cmp_lg_u32 s36, 0
    s_cselect_b32 s56, s56, 0
    v_mfma_f32_32x32x16_bf16 v[48:63], v[68:71], v[180:183], 0
    s_setprio 0
    v_mul_f32 v242, v0, v144
    v_fma_f32 v238, v8, v160, -v238
    v_fmac_f32 v242, v1, v145
    v_fmac_f32 v238, v9, v161
    v_fmac_f32 v242, v2, v146
    v_fmac_f32 v238, v10, v162
    v_fmac_f32 v242, v3, v147
    v_fmac_f32 v238, v11, v163
    v_fmac_f32 v242, v4, v148
    v_fmac_f32 v238, v12, v164
    v_fmac_f32 v242, v5, v149
    v_fmac_f32 v238, v13, v165
    v_fmac_f32 v242, v6, v150
    v_fmac_f32 v238, v14, v166
    v_fmac_f32 v242, v7, v151
    v_fmac_f32 v238, v15, v167
    v_fmac_f32 v236, v16, v112
    v_mul_f32 v244, v24, v160
    v_fmac_f32 v236, v17, v113
    v_fmac_f32 v244, v25, v161
    v_fmac_f32 v236, v18, v114
    v_fmac_f32 v244, v26, v162
    v_fmac_f32 v236, v19, v115
    v_fmac_f32 v244, v27, v163
    v_fmac_f32 v236, v20, v116
    v_fmac_f32 v244, v28, v164
    v_fmac_f32 v236, v21, v117
    v_fmac_f32 v244, v29, v165
    v_fmac_f32 v236, v22, v118
    v_fmac_f32 v244, v30, v166
    v_fmac_f32 v236, v23, v119
    v_fmac_f32 v244, v31, v167
    v_mul_f32 v243, v32, v152
    v_fma_f32 v239, v40, v168, -v239
    v_fmac_f32 v243, v33, v153
    v_fmac_f32 v239, v41, v169
    v_fmac_f32 v243, v34, v154
    v_fmac_f32 v239, v42, v170
    v_fmac_f32 v243, v35, v155
    v_fmac_f32 v239, v43, v171
    v_fmac_f32 v243, v36, v156
    v_fmac_f32 v239, v44, v172
    v_fmac_f32 v243, v37, v157
    v_fmac_f32 v239, v45, v173
    v_fmac_f32 v243, v38, v158
    v_fmac_f32 v239, v46, v174
    v_fmac_f32 v243, v39, v159
    v_fmac_f32 v239, v47, v175
    v_fmac_f32 v237, v48, v120
    v_mul_f32 v245, v56, v168
    v_fmac_f32 v237, v49, v121
    v_fmac_f32 v245, v57, v169
    v_fmac_f32 v237, v50, v122
    v_fmac_f32 v245, v58, v170
    v_fmac_f32 v237, v51, v123
    v_fmac_f32 v245, v59, v171
    v_fmac_f32 v237, v52, v124
    v_fmac_f32 v245, v60, v172
    v_fmac_f32 v237, v53, v125
    v_fmac_f32 v245, v61, v173
    v_fmac_f32 v237, v54, v126
    v_fmac_f32 v245, v62, v174
    v_fmac_f32 v237, v55, v127
    v_fmac_f32 v245, v63, v175
    s_setprio 1
    s_waitcnt vmcnt(4) lgkmcnt(0)
    v_mfma_f32_32x32x16_bf16 v[0:15], v[64:67], v[184:187], 0
    ds_read_b64_tr_b16 v[176:177], v246 offset:0
    ds_read_b64_tr_b16 v[178:179], v246 offset:1024
    ds_read_b64_tr_b16 v[180:181], v247 offset:0
    ds_read_b64_tr_b16 v[182:183], v247 offset:1024
    s_mov_b32 m0, s71
    v_mfma_f32_32x32x16_bf16 v[16:31], v[68:71], v[184:187], 0
    buffer_load_dwordx4 v228, s[4:7], s47 offen sc1 lds
    buffer_load_dwordx4 v229, s[72:75], s47 offen offset:1024 sc1 lds
    v_permlane32_swap_b32 v242, v234
    v_permlane32_swap_b32 v243, v235
    v_add_f32 v242, v242, v234
    v_mfma_f32_32x32x16_bf16 v[32:47], v[64:67], v[188:191], 0
    v_add_f32 v243, v243, v235
    v_cvt_pk_bf16_f32 v242, v242, v243
    ds_write_b32 v230, v242 offset:512
    v_mfma_f32_32x32x16_bf16 v[48:63], v[68:71], v[188:191], 0
    s_setprio 0
    v_mul_f32 v242, v0, v144
    v_fma_f32 v240, v8, v160, -v240
    v_fmac_f32 v242, v1, v145
    v_fmac_f32 v240, v9, v161
    v_fmac_f32 v242, v2, v146
    v_fmac_f32 v240, v10, v162
    v_fmac_f32 v242, v3, v147
    v_fmac_f32 v240, v11, v163
    v_fmac_f32 v242, v4, v148
    v_fmac_f32 v240, v12, v164
    v_fmac_f32 v242, v5, v149
    v_fmac_f32 v240, v13, v165
    v_fmac_f32 v242, v6, v150
    v_fmac_f32 v240, v14, v166
    v_fmac_f32 v242, v7, v151
    v_fmac_f32 v240, v15, v167
    v_add_u32 v249, s26, v249
    v_add_u32 v250, s26, v250
    v_fma_f32 v244, v16, v160, -v244
    v_fmac_f32 v236, v24, v112
    v_fmac_f32 v244, v17, v161
    v_fmac_f32 v236, v25, v113
    v_fmac_f32 v244, v18, v162
    v_fmac_f32 v236, v26, v114
    v_fmac_f32 v244, v19, v163
    v_fmac_f32 v236, v27, v115
    v_fmac_f32 v244, v20, v164
    v_fmac_f32 v236, v28, v116
    v_fmac_f32 v244, v21, v165
    v_fmac_f32 v236, v29, v117
    v_fmac_f32 v244, v22, v166
    v_fmac_f32 v236, v30, v118
    v_fmac_f32 v244, v23, v167
    v_fmac_f32 v236, v31, v119
    ds_read_b64_tr_b16 v[0:1], v249 offset:0
    ds_read_b64_tr_b16 v[2:3], v249 offset:32
    ds_read_u16_d16_hi v16, v250 offset:0
    v_mul_f32 v243, v32, v152
    v_fma_f32 v241, v40, v168, -v241
    v_fmac_f32 v243, v33, v153
    v_fmac_f32 v241, v41, v169
    v_fmac_f32 v243, v34, v154
    v_fmac_f32 v241, v42, v170
    v_fmac_f32 v243, v35, v155
    v_fmac_f32 v241, v43, v171
    v_fmac_f32 v243, v36, v156
    v_fmac_f32 v241, v44, v172
    v_fmac_f32 v243, v37, v157
    v_fmac_f32 v241, v45, v173
    v_fmac_f32 v243, v38, v158
    v_fmac_f32 v241, v46, v174
    v_fmac_f32 v243, v39, v159
    v_fmac_f32 v241, v47, v175
    ds_read_b64_tr_b16 v[4:5], v249 offset:512
    ds_read_b64_tr_b16 v[6:7], v249 offset:544
    ds_read_u16_d16_hi v17, v250 offset:128
    v_fma_f32 v245, v48, v168, -v245
    v_fmac_f32 v237, v56, v120
    v_fmac_f32 v245, v49, v169
    v_fmac_f32 v237, v57, v121
    v_fmac_f32 v245, v50, v170
    v_fmac_f32 v237, v58, v122
    v_fmac_f32 v245, v51, v171
    v_fmac_f32 v237, v59, v123
    v_fmac_f32 v245, v52, v172
    v_fmac_f32 v237, v60, v124
    v_fmac_f32 v245, v53, v173
    v_fmac_f32 v237, v61, v125
    v_fmac_f32 v245, v54, v174
    v_fmac_f32 v237, v62, v126
    v_fmac_f32 v245, v55, v175
    v_fmac_f32 v237, v63, v127
    s_cmp_eq_u32 s56, 5
    s_cbranch_scc1 K2_U21
    s_cmp_eq_u32 s56, 6
    s_cbranch_scc1 K2_U3h1
    s_branch K2_DSP1
K2_U41:
    s_setprio 1
    ds_read_b64_tr_b16 v[8:9], v249 offset:1024
    ds_read_b64_tr_b16 v[10:11], v249 offset:1056
    ds_read_u16_d16_hi v18, v250 offset:256
    s_lshr_b32 s65, s30, 27
    s_mul_i32 s66, s22, 2080
    s_lshl_b32 s65, s65, 9
    s_add_u32 s65, s65, s66
    s_add_u32 s65, s65, 65536
    s_sub_u32 s65, s65, s29
    s_sub_u32 s65, s65, 512
    v_add_u32 v56, s65, v249
    ds_read_b64_tr_b16 v[12:13], v56 offset:0
    ds_read_b64_tr_b16 v[14:15], v56 offset:32
    ds_read_u16_d16_hi v19, v250 offset:384
    s_waitcnt lgkmcnt(6)
    v_lshlrev_b32 v20, 16, v0
    v_and_b32 v21, 0xffff0000, v0
    v_lshlrev_b32 v22, 16, v1
    v_and_b32 v23, 0xffff0000, v1
    v_lshlrev_b32 v24, 16, v2
    v_and_b32 v25, 0xffff0000, v2
    v_lshlrev_b32 v26, 16, v3
    v_and_b32 v27, 0xffff0000, v3
    v_mul_f32_dpp v36, v16, v20 row_newbcast:8 row_mask:0xf bank_mask:0xf
    v_mul_f32_dpp v37, v16, v21 row_newbcast:9 row_mask:0xf bank_mask:0xf
    v_mul_f32_dpp v38, v16, v22 row_newbcast:10 row_mask:0xf bank_mask:0xf
    v_mul_f32_dpp v39, v16, v23 row_newbcast:11 row_mask:0xf bank_mask:0xf
    v_mul_f32_dpp v40, v16, v24 row_newbcast:12 row_mask:0xf bank_mask:0xf
    v_mul_f32_dpp v41, v16, v25 row_newbcast:13 row_mask:0xf bank_mask:0xf
    v_mul_f32_dpp v42, v16, v26 row_newbcast:14 row_mask:0xf bank_mask:0xf
    v_mul_f32_dpp v43, v16, v27 row_newbcast:15 row_mask:0xf bank_mask:0xf
    v_cvt_pk_bf16_f32 v68, v36, v37
    v_cvt_pk_bf16_f32 v69, v38, v39
    v_cvt_pk_bf16_f32 v70, v40, v41
    v_cvt_pk_bf16_f32 v71, v42, v43
    v_mul_f32_dpp v20, v16, v20 row_newbcast:0 row_mask:0xa bank_mask:0xf
    v_mul_f32_dpp v21, v16, v21 row_newbcast:1 row_mask:0xa bank_mask:0xf
    v_mul_f32_dpp v22, v16, v22 row_newbcast:2 row_mask:0xa bank_mask:0xf
    v_mul_f32_dpp v23, v16, v23 row_newbcast:3 row_mask:0xa bank_mask:0xf
    v_mul_f32_dpp v24, v16, v24 row_newbcast:4 row_mask:0xa bank_mask:0xf
    v_mul_f32_dpp v25, v16, v25 row_newbcast:5 row_mask:0xa bank_mask:0xf
    v_mul_f32_dpp v26, v16, v26 row_newbcast:6 row_mask:0xa bank_mask:0xf
    v_mul_f32_dpp v27, v16, v27 row_newbcast:7 row_mask:0xa bank_mask:0xf
    v_cvt_pk_bf16_f32 v64, v20, v21
    v_cvt_pk_bf16_f32 v65, v22, v23
    v_cvt_pk_bf16_f32 v66, v24, v25
    v_cvt_pk_bf16_f32 v67, v26, v27
    v_lshlrev_b32 v28, 16, v4
    v_and_b32 v29, 0xffff0000, v4
    v_lshlrev_b32 v30, 16, v5
    v_and_b32 v31, 0xffff0000, v5
    v_lshlrev_b32 v32, 16, v6
    v_and_b32 v33, 0xffff0000, v6
    v_lshlrev_b32 v34, 16, v7
    v_and_b32 v35, 0xffff0000, v7
    v_mul_f32_dpp v36, v17, v28 row_newbcast:8 row_mask:0xf bank_mask:0xf
    v_mul_f32_dpp v37, v17, v29 row_newbcast:9 row_mask:0xf bank_mask:0xf
    v_mul_f32_dpp v38, v17, v30 row_newbcast:10 row_mask:0xf bank_mask:0xf
    v_mul_f32_dpp v39, v17, v31 row_newbcast:11 row_mask:0xf bank_mask:0xf
    v_mul_f32_dpp v40, v17, v32 row_newbcast:12 row_mask:0xf bank_mask:0xf
    v_mul_f32_dpp v41, v17, v33 row_newbcast:13 row_mask:0xf bank_mask:0xf
    v_mul_f32_dpp v42, v17, v34 row_newbcast:14 row_mask:0xf bank_mask:0xf
    v_mul_f32_dpp v43, v17, v35 row_newbcast:15 row_mask:0xf bank_mask:0xf
    v_cvt_pk_bf16_f32 v76, v36, v37
    v_cvt_pk_bf16_f32 v77, v38, v39
    v_cvt_pk_bf16_f32 v78, v40, v41
    v_cvt_pk_bf16_f32 v79, v42, v43
    v_mul_f32_dpp v28, v17, v28 row_newbcast:0 row_mask:0xa bank_mask:0xf
    v_mul_f32_dpp v29, v17, v29 row_newbcast:1 row_mask:0xa bank_mask:0xf
    v_mul_f32_dpp v30, v17, v30 row_newbcast:2 row_mask:0xa bank_mask:0xf
    v_mul_f32_dpp v31, v17, v31 row_newbcast:3 row_mask:0xa bank_mask:0xf
    v_mul_f32_dpp v32, v17, v32 row_newbcast:4 row_mask:0xa bank_mask:0xf
    v_mul_f32_dpp v33, v17, v33 row_newbcast:5 row_mask:0xa bank_mask:0xf
    v_mul_f32_dpp v34, v17, v34 row_newbcast:6 row_mask:0xa bank_mask:0xf
    v_mul_f32_dpp v35, v17, v35 row_newbcast:7 row_mask:0xa bank_mask:0xf
    v_cvt_pk_bf16_f32 v72, v28, v29
    v_cvt_pk_bf16_f32 v73, v30, v31
    v_cvt_pk_bf16_f32 v74, v32, v33
    v_cvt_pk_bf16_f32 v75, v34, v35
    s_waitcnt lgkmcnt(3)
    v_lshlrev_b32 v20, 16, v8
    v_and_b32 v21, 0xffff0000, v8
    v_lshlrev_b32 v22, 16, v9
    v_and_b32 v23, 0xffff0000, v9
    v_lshlrev_b32 v24, 16, v10
    v_and_b32 v25, 0xffff0000, v10
    v_lshlrev_b32 v26, 16, v11
    v_and_b32 v27, 0xffff0000, v11
    v_mul_f32_dpp v36, v18, v20 row_newbcast:8 row_mask:0xf bank_mask:0xf
    v_mul_f32_dpp v37, v18, v21 row_newbcast:9 row_mask:0xf bank_mask:0xf
    v_mul_f32_dpp v38, v18, v22 row_newbcast:10 row_mask:0xf bank_mask:0xf
    v_mul_f32_dpp v39, v18, v23 row_newbcast:11 row_mask:0xf bank_mask:0xf
    v_mul_f32_dpp v40, v18, v24 row_newbcast:12 row_mask:0xf bank_mask:0xf
    v_mul_f32_dpp v41, v18, v25 row_newbcast:13 row_mask:0xf bank_mask:0xf
    v_mul_f32_dpp v42, v18, v26 row_newbcast:14 row_mask:0xf bank_mask:0xf
    v_mul_f32_dpp v43, v18, v27 row_newbcast:15 row_mask:0xf bank_mask:0xf
    v_cvt_pk_bf16_f32 v84, v36, v37
    v_cvt_pk_bf16_f32 v85, v38, v39
    v_cvt_pk_bf16_f32 v86, v40, v41
    v_cvt_pk_bf16_f32 v87, v42, v43
    v_mul_f32_dpp v20, v18, v20 row_newbcast:0 row_mask:0xa bank_mask:0xf
    v_mul_f32_dpp v21, v18, v21 row_newbcast:1 row_mask:0xa bank_mask:0xf
    v_mul_f32_dpp v22, v18, v22 row_newbcast:2 row_mask:0xa bank_mask:0xf
    v_mul_f32_dpp v23, v18, v23 row_newbcast:3 row_mask:0xa bank_mask:0xf
    v_mul_f32_dpp v24, v18, v24 row_newbcast:4 row_mask:0xa bank_mask:0xf
    v_mul_f32_dpp v25, v18, v25 row_newbcast:5 row_mask:0xa bank_mask:0xf
    v_mul_f32_dpp v26, v18, v26 row_newbcast:6 row_mask:0xa bank_mask:0xf
    v_mul_f32_dpp v27, v18, v27 row_newbcast:7 row_mask:0xa bank_mask:0xf
    v_cvt_pk_bf16_f32 v80, v20, v21
    v_cvt_pk_bf16_f32 v81, v22, v23
    v_cvt_pk_bf16_f32 v82, v24, v25
    v_cvt_pk_bf16_f32 v83, v26, v27
    s_waitcnt lgkmcnt(0)
    v_lshlrev_b32 v28, 16, v12
    v_and_b32 v29, 0xffff0000, v12
    v_lshlrev_b32 v30, 16, v13
    v_and_b32 v31, 0xffff0000, v13
    v_lshlrev_b32 v32, 16, v14
    v_and_b32 v33, 0xffff0000, v14
    v_lshlrev_b32 v34, 16, v15
    v_and_b32 v35, 0xffff0000, v15
    v_mul_f32_dpp v36, v19, v28 row_newbcast:8 row_mask:0xf bank_mask:0xf
    v_mul_f32_dpp v37, v19, v29 row_newbcast:9 row_mask:0xf bank_mask:0xf
    v_mul_f32_dpp v38, v19, v30 row_newbcast:10 row_mask:0xf bank_mask:0xf
    v_mul_f32_dpp v39, v19, v31 row_newbcast:11 row_mask:0xf bank_mask:0xf
    v_mul_f32_dpp v40, v19, v32 row_newbcast:12 row_mask:0xf bank_mask:0xf
    v_mul_f32_dpp v41, v19, v33 row_newbcast:13 row_mask:0xf bank_mask:0xf
    v_mul_f32_dpp v42, v19, v34 row_newbcast:14 row_mask:0xf bank_mask:0xf
    v_mul_f32_dpp v43, v19, v35 row_newbcast:15 row_mask:0xf bank_mask:0xf
    v_cvt_pk_bf16_f32 v92, v36, v37
    v_cvt_pk_bf16_f32 v93, v38, v39
    v_cvt_pk_bf16_f32 v94, v40, v41
    v_cvt_pk_bf16_f32 v95, v42, v43
    v_mul_f32_dpp v28, v19, v28 row_newbcast:0 row_mask:0xa bank_mask:0xf
    v_mul_f32_dpp v29, v19, v29 row_newbcast:1 row_mask:0xa bank_mask:0xf
    v_mul_f32_dpp v30, v19, v30 row_newbcast:2 row_mask:0xa bank_mask:0xf
    v_mul_f32_dpp v31, v19, v31 row_newbcast:3 row_mask:0xa bank_mask:0xf
    v_mul_f32_dpp v32, v19, v32 row_newbcast:4 row_mask:0xa bank_mask:0xf
    v_mul_f32_dpp v33, v19, v33 row_newbcast:5 row_mask:0xa bank_mask:0xf
    v_mul_f32_dpp v34, v19, v34 row_newbcast:6 row_mask:0xa bank_mask:0xf
    v_mul_f32_dpp v35, v19, v35 row_newbcast:7 row_mask:0xa bank_mask:0xf
    v_cvt_pk_bf16_f32 v88, v28, v29
    v_cvt_pk_bf16_f32 v89, v30, v31
    v_cvt_pk_bf16_f32 v90, v32, v33
    v_cvt_pk_bf16_f32 v91, v34, v35
    s_waitcnt vmcnt(4)
    v_mfma_f32_32x32x16_bf16 v[0:15], v[64:67], v[176:179], 0
    ds_read_b64_tr_b16 v[184:185], v246 offset:2048
    ds_read_b64_tr_b16 v[186:187], v246 offset:3072
    ds_read_b64_tr_b16 v[188:189], v247 offset:2048
    ds_read_b64_tr_b16 v[190:191], v247 offset:3072
    s_mov_b32 m0, s68
    v_mfma_f32_32x32x16_bf16 v[16:31], v[68:71], v[176:179], 0
    buffer_load_dwordx4 v222, s[4:7], s41 offen sc1 lds
    buffer_load_dwordx4 v223, s[72:75], s41 offen offset:1024 sc1 lds
    v_permlane32_swap_b32 v242, v236
    v_permlane32_swap_b32 v243, v237
    v_mov_b32 v254, 163296
    v_mfma_f32_32x32x16_bf16 v[32:47], v[64:67], v[180:183], 0
    v_permlane32_swap_b32 v244, v238
    v_permlane32_swap_b32 v245, v239
    v_permlane32_swap_b32 v240, v241
    v_add_f32 v242, v242, v236
    v_mfma_f32_32x32x16_bf16 v[48:63], v[68:71], v[180:183], 0
    v_add_f32 v243, v243, v237
    v_add_f32 v244, v244, v238
    v_add_f32 v245, v245, v239
    v_add_f32 v240, -v240, -v241
    v_sub_u32 v241, v230, v231
    v_cvt_pk_bf16_f32 v242, v242, v243
    v_mov_b32 v255, 1
    v_lshl_add_u32 v233, v252, 1, s53
    s_mov_b64 exec, 1
    ds_add_rtn_u32 v232, v254, v255
    s_mov_b64 exec, -1
    ds_read_b32 v233, v233
    s_waitcnt vmcnt(4) lgkmcnt(2)
    v_mfma_f32_32x32x16_bf16 v[0:15], v[72:75], v[184:187], v[0:15]
    ds_read_b64_tr_b16 v[176:177], v246 offset:4096
    ds_read_b64_tr_b16 v[178:179], v246 offset:5120
    ds_read_b64_tr_b16 v[180:181], v247 offset:4096
    ds_read_b64_tr_b16 v[182:183], v247 offset:5120
    v_cvt_pk_bf16_f32 v244, v244, v245
    v_cvt_pk_bf16_f32 v240, v240, v240
    s_mov_b32 m0, s69
    v_mfma_f32_32x32x16_bf16 v[16:31], v[76:79], v[184:187], v[16:31]
    buffer_load_dwordx4 v224, s[4:7], s41 offen sc1 lds
    buffer_load_dwordx4 v225, s[72:75], s41 offen offset:1024 sc1 lds
    ds_write_b32 v230, v242 offset:768
    ds_write_b32 v230, v244 offset:1024
    ds_write_b16 v241, v240 offset:1280
    s_waitcnt lgkmcnt(7)
    v_readfirstlane_b32 s58, v232
    v_mfma_f32_32x32x16_bf16 v[32:47], v[72:75], v[188:191], v[32:47]
    s_cmp_lt_u32 s58, s22
    s_cbranch_scc0 K2_nul_101
    s_and_b32 s59, s58, 7
    s_lshr_b32 s60, s58, 3
K2_chk_103:
    v_readlane_b32 s61, v233, s59
    s_nop 0
    s_cmp_gt_u32 s61, s60
    s_cbranch_scc0 K2_spin_102
K2_back_104:
    v_mfma_f32_32x32x16_bf16 v[48:63], v[76:79], v[188:191], v[48:63]
    v_readlane_b32 s3, v253, s58
    s_lshl_b32 s44, s34, 7
    s_and_b32 s48, s3, 0x3ffff
    s_bfe_u32 s33, s3, 0x30013
    s_mov_b32 s35, s48
    s_mov_b32 s45, s44
    s_waitcnt vmcnt(4) lgkmcnt(3)
    v_mfma_f32_32x32x16_bf16 v[0:15], v[80:83], v[176:179], v[0:15]
    ds_read_b64_tr_b16 v[184:185], v246 offset:6144
    ds_read_b64_tr_b16 v[186:187], v246 offset:7168
    ds_read_b64_tr_b16 v[188:189], v247 offset:6144
    ds_read_b64_tr_b16 v[190:191], v247 offset:7168
    s_xor_b32 s47, s44, 256
    s_add_u32 s49, s48, 128
    s_mov_b32 m0, s70
    v_mfma_f32_32x32x16_bf16 v[16:31], v[84:87], v[176:179], v[16:31]
    buffer_load_dwordx4 v226, s[4:7], s41 offen sc1 lds
    buffer_load_dwordx4 v227, s[72:75], s41 offen offset:1024 sc1 lds
    s_add_u32 s60, s48, 256
    s_cmp_eq_u32 s33, 3
    s_cselect_b32 s46, s44, s47
    s_cselect_b32 s50, s60, s48
    s_cselect_b32 s51, s48, s49
    v_mfma_f32_32x32x16_bf16 v[32:47], v[80:83], v[180:183], v[32:47]
    s_sub_u32 s60, s33, 2
    s_cmp_lt_u32 s60, 2
    s_cbranch_scc0 K2_rare_105
K2_back_106:
    v_mfma_f32_32x32x16_bf16 v[48:63], v[84:87], v[180:183], v[48:63]
    s_waitcnt vmcnt(4) lgkmcnt(0)
    v_mfma_f32_32x32x16_bf16 v[0:15], v[88:91], v[184:187], v[0:15]
    ds_read_b64_tr_b16 v[176:177], v246 offset:0
    ds_read_b64_tr_b16 v[178:179], v246 offset:1024
    ds_read_b64_tr_b16 v[180:181], v247 offset:0
    ds_read_b64_tr_b16 v[182:183], v247 offset:1024
    s_mov_b32 m0, s71
    v_mfma_f32_32x32x16_bf16 v[16:31], v[92:95], v[184:187], v[16:31]
    buffer_load_dwordx4 v228, s[4:7], s41 offen sc1 lds
    buffer_load_dwordx4 v229, s[72:75], s41 offen offset:1024 sc1 lds
    v_mfma_f32_32x32x16_bf16 v[32:47], v[88:91], v[188:191], v[32:47]
    s_nop 2
    v_mul_f32 v234, v0, v96
    v_mul_f32 v236, v8, v128
    v_fmac_f32 v234, v1, v97
    v_fmac_f32 v236, v9, v129
    v_fmac_f32 v234, v2, v98
    v_fmac_f32 v236, v10, v130
    v_fmac_f32 v234, v3, v99
    v_mfma_f32_32x32x16_bf16 v[48:63], v[92:95], v[188:191], v[48:63]
    s_setprio 0
    v_fmac_f32 v236, v11, v131
    v_fmac_f32 v234, v4, v100
    v_fmac_f32 v236, v12, v132
    v_fmac_f32 v234, v5, v101
    v_fmac_f32 v236, v13, v133
    v_fmac_f32 v234, v6, v102
    v_fmac_f32 v236, v14, v134
    v_fmac_f32 v234, v7, v103
    v_fmac_f32 v236, v15, v135
    v_mul_f32 v238, v16, v128
    v_mul_f32 v240, v24, v128
    v_fmac_f32 v238, v17, v129
    v_fmac_f32 v240, v25, v129
    v_fmac_f32 v238, v18, v130
    v_fmac_f32 v240, v26, v130
    v_fmac_f32 v238, v19, v131
    v_fmac_f32 v240, v27, v131
    v_fmac_f32 v238, v20, v132
    v_fmac_f32 v240, v28, v132
    v_fmac_f32 v238, v21, v133
    v_fmac_f32 v240, v29, v133
    v_fmac_f32 v238, v22, v134
    v_fmac_f32 v240, v30, v134
    v_fmac_f32 v238, v23, v135
    v_fmac_f32 v240, v31, v135
    v_mul_f32 v235, v32, v104
    v_mul_f32 v237, v40, v136
    v_fmac_f32 v235, v33, v105
    v_fmac_f32 v237, v41, v137
    v_fmac_f32 v235, v34, v106
    v_fmac_f32 v237, v42, v138
    v_fmac_f32 v235, v35, v107
    v_fmac_f32 v237, v43, v139
    v_fmac_f32 v235, v36, v108
    v_fmac_f32 v237, v44, v140
    v_fmac_f32 v235, v37, v109
    v_fmac_f32 v237, v45, v141
    v_fmac_f32 v235, v38, v110
    v_fmac_f32 v237, v46, v142
    v_fmac_f32 v235, v39, v111
    v_fmac_f32 v237, v47, v143
    v_mul_f32 v239, v48, v136
    v_mul_f32 v241, v56, v136
    s_setprio 1
    s_waitcnt vmcnt(4) lgkmcnt(0)
    v_mfma_f32_32x32x16_bf16 v[0:15], v[64:67], v[176:179], 0
    ds_read_b64_tr_b16 v[184:185], v246 offset:2048
    ds_read_b64_tr_b16 v[186:187], v246 offset:3072
    ds_read_b64_tr_b16 v[188:189], v247 offset:2048
    ds_read_b64_tr_b16 v[190:191], v247 offset:3072
    v_fmac_f32 v239, v49, v137
    v_fmac_f32 v241, v57, v137
    s_mov_b32 m0, s68
    v_mfma_f32_32x32x16_bf16 v[16:31], v[68:71], v[176:179], 0
    buffer_load_dwordx4 v222, s[4:7], s42 offen sc1 lds
    buffer_load_dwordx4 v223, s[72:75], s42 offen offset:1024 sc1 lds
    v_fmac_f32 v239, v50, v138
    v_fmac_f32 v241, v58, v138
    v_fmac_f32 v239, v51, v139
    v_fmac_f32 v241, v59, v139
    v_fmac_f32 v239, v52, v140
    v_mfma_f32_32x32x16_bf16 v[32:47], v[64:67], v[180:183], 0
    v_fmac_f32 v241, v60, v140
    v_fmac_f32 v239, v53, v141
    v_fmac_f32 v241, v61, v141
    v_fmac_f32 v239, v54, v142
    v_fmac_f32 v241, v62, v142
    v_fmac_f32 v239, v55, v143
    v_fmac_f32 v241, v63, v143
    v_mfma_f32_32x32x16_bf16 v[48:63], v[68:71], v[180:183], 0
    v_permlane32_swap_b32 v234, v236
    v_permlane32_swap_b32 v235, v237
    v_permlane32_swap_b32 v240, v238
    s_waitcnt vmcnt(4) lgkmcnt(0)
    v_mfma_f32_32x32x16_bf16 v[0:15], v[72:75], v[184:187], v[0:15]
    ds_read_b64_tr_b16 v[176:177], v246 offset:4096
    ds_read_b64_tr_b16 v[178:179], v246 offset:5120
    ds_read_b64_tr_b16 v[180:181], v247 offset:4096
    ds_read_b64_tr_b16 v[182:183], v247 offset:5120
    v_permlane32_swap_b32 v241, v239
    s_mov_b32 m0, s69
    v_mfma_f32_32x32x16_bf16 v[16:31], v[76:79], v[184:187], v[16:31]
    buffer_load_dwordx4 v224, s[4:7], s42 offen sc1 lds
    buffer_load_dwordx4 v225, s[72:75], s42 offen offset:1024 sc1 lds
    v_lshl_add_u32 v230, v252, 1, s31
    v_add_f32 v234, v234, v236
    v_add_f32 v235, v235, v237
    v_add_f32 v240, v240, v238
    v_add_f32 v241, v241, v239
    v_mfma_f32_32x32x16_bf16 v[32:47], v[72:75], v[188:191], v[32:47]
    v_cvt_pk_bf16_f32 v234, v234, v235
    v_cvt_pk_bf16_f32 v240, v240, v241
    ds_write_b32 v230, v234 offset:0
    ds_write_b32 v230, v240 offset:256
    v_mfma_f32_32x32x16_bf16 v[48:63], v[76:79], v[188:191], v[48:63]
    s_waitcnt vmcnt(4) lgkmcnt(2)
    v_mfma_f32_32x32x16_bf16 v[0:15], v[80:83], v[176:179], v[0:15]
    ds_read_b64_tr_b16 v[184:185], v246 offset:6144
    ds_read_b64_tr_b16 v[186:187], v246 offset:7168
    ds_read_b64_tr_b16 v[188:189], v247 offset:6144
    ds_read_b64_tr_b16 v[190:191], v247 offset:7168
    s_mov_b32 m0, s70
    v_mfma_f32_32x32x16_bf16 v[16:31], v[84:87], v[176:179], v[16:31]
    buffer_load_dwordx4 v226, s[4:7], s42 offen sc1 lds
    buffer_load_dwordx4 v227, s[72:75], s42 offen offset:1024 sc1 lds
    v_mfma_f32_32x32x16_bf16 v[32:47], v[80:83], v[180:183], v[32:47]
    v_mfma_f32_32x32x16_bf16 v[48:63], v[84:87], v[180:183], v[48:63]
    s_waitcnt vmcnt(4) lgkmcnt(0)
    v_mfma_f32_32x32x16_bf16 v[0:15], v[88:91], v[184:187], v[0:15]
    ds_read_b64_tr_b16 v[176:177], v246 offset:0
    ds_read_b64_tr_b16 v[178:179], v246 offset:1024
    ds_read_b64_tr_b16 v[180:181], v247 offset:0
    ds_read_b64_tr_b16 v[182:183], v247 offset:1024
    s_mov_b32 m0, s71
    v_mfma_f32_32x32x16_bf16 v[16:31], v[92:95], v[184:187], v[16:31]
    buffer_load_dwordx4 v228, s[4:7], s42 offen sc1 lds
    buffer_load_dwordx4 v229, s[72:75], s42 offen offset:1024 sc1 lds
    v_mfma_f32_32x32x16_bf16 v[32:47], v[88:91], v[188:191], v[32:47]
    s_nop 2
    v_mul_f32 v234, v0, v144
    v_mul_f32 v236, v8, v112
    v_fmac_f32 v234, v1, v145
    v_fmac_f32 v236, v9, v113
    v_fmac_f32 v234, v2, v146
    v_fmac_f32 v236, v10, v114
    v_fmac_f32 v234, v3, v147
    v_mfma_f32_32x32x16_bf16 v[48:63], v[92:95], v[188:191], v[48:63]
    s_setprio 0
    v_fmac_f32 v236, v11, v115
    v_fmac_f32 v234, v4, v148
    v_fmac_f32 v236, v12, v116
    v_fmac_f32 v234, v5, v149
    v_fmac_f32 v236, v13, v117
    v_fmac_f32 v234, v6, v150
    v_fmac_f32 v236, v14, v118
    v_fmac_f32 v234, v7, v151
    v_fmac_f32 v236, v15, v119
    v_mul_f32 v238, v16, v160
    v_mul_f32 v240, v24, v160
    v_fmac_f32 v238, v17, v161
    v_fmac_f32 v240, v25, v161
    v_fmac_f32 v238, v18, v162
    v_fmac_f32 v240, v26, v162
    v_fmac_f32 v238, v19, v163
    v_fmac_f32 v240, v27, v163
    v_fmac_f32 v238, v20, v164
    v_fmac_f32 v240, v28, v164
    v_fmac_f32 v238, v21, v165
    v_fmac_f32 v240, v29, v165
    v_fmac_f32 v238, v22, v166
    v_fmac_f32 v240, v30, v166
    v_fmac_f32 v238, v23, v167
    v_fmac_f32 v240, v31, v167
    v_mul_f32 v235, v32, v152
    v_mul_f32 v237, v40, v120
    v_fmac_f32 v235, v33, v153
    v_fmac_f32 v237, v41, v121
    v_fmac_f32 v235, v34, v154
    v_fmac_f32 v237, v42, v122
    v_fmac_f32 v235, v35, v155
    v_fmac_f32 v237, v43, v123
    v_fmac_f32 v235, v36, v156
    v_fmac_f32 v237, v44, v124
    v_fmac_f32 v235, v37, v157
    v_fmac_f32 v237, v45, v125
    v_fmac_f32 v235, v38, v158
    v_fmac_f32 v237, v46, v126
    v_fmac_f32 v235, v39, v159
    v_fmac_f32 v237, v47, v127
    v_mul_f32 v239, v48, v168
    v_mul_f32 v241, v56, v168
    s_setprio 1
    s_waitcnt vmcnt(4) lgkmcnt(0)
    v_mfma_f32_32x32x16_bf16 v[0:15], v[64:67], v[176:179], 0
    ds_read_b64_tr_b16 v[184:185], v246 offset:2048
    ds_read_b64_tr_b16 v[186:187], v246 offset:3072
    ds_read_b64_tr_b16 v[188:189], v247 offset:2048
    ds_read_b64_tr_b16 v[190:191], v247 offset:3072
    v_fmac_f32 v239, v49, v169
    v_fmac_f32 v241, v57, v169
    s_mov_b32 m0, s68
    v_mfma_f32_32x32x16_bf16 v[16:31], v[68:71], v[176:179], 0
    buffer_load_dwordx4 v222, s[4:7], s43 offen sc1 lds
    buffer_load_dwordx4 v223, s[72:75], s43 offen offset:1024 sc1 lds
    v_fmac_f32 v239, v50, v170
    v_fmac_f32 v241, v58, v170
    v_fmac_f32 v239, v51, v171
    v_fmac_f32 v241, v59, v171
    v_fmac_f32 v239, v52, v172
    v_mfma_f32_32x32x16_bf16 v[32:47], v[64:67], v[180:183], 0
    v_fmac_f32 v241, v60, v172
    v_fmac_f32 v239, v53, v173
    v_fmac_f32 v241, v61, v173
    v_fmac_f32 v239, v54, v174
    v_fmac_f32 v241, v62, v174
    v_fmac_f32 v239, v55, v175
    v_fmac_f32 v241, v63, v175
    v_mfma_f32_32x32x16_bf16 v[48:63], v[68:71], v[180:183], 0
    s_waitcnt vmcnt(4) lgkmcnt(0)
    v_mfma_f32_32x32x16_bf16 v[0:15], v[72:75], v[184:187], v[0:15]
    ds_read_b64_tr_b16 v[176:177], v246 offset:4096
    ds_read_b64_tr_b16 v[178:179], v246 offset:5120
    ds_read_b64_tr_b16 v[180:181], v247 offset:4096
    ds_read_b64_tr_b16 v[182:183], v247 offset:5120
    s_mov_b32 m0, s69
    v_mfma_f32_32x32x16_bf16 v[16:31], v[76:79], v[184:187], v[16:31]
    buffer_load_dwordx4 v224, s[4:7], s43 offen sc1 lds
    buffer_load_dwordx4 v225, s[72:75], s43 offen offset:1024 sc1 lds
    v_mfma_f32_32x32x16_bf16 v[32:47], v[72:75], v[188:191], v[32:47]
    v_mfma_f32_32x32x16_bf16 v[48:63], v[76:79], v[188:191], v[48:63]
    s_waitcnt vmcnt(4) lgkmcnt(0)
    v_mfma_f32_32x32x16_bf16 v[0:15], v[80:83], v[176:179], v[0:15]
    ds_read_b64_tr_b16 v[184:185], v246 offset:6144
    ds_read_b64_tr_b16 v[186:187], v246 offset:7168
    ds_read_b64_tr_b16 v[188:189], v247 offset:6144
    ds_read_b64_tr_b16 v[190:191], v247 offset:7168
    s_mov_b32 m0, s70
    v_mfma_f32_32x32x16_bf16 v[16:31], v[84:87], v[176:179], v[16:31]
    buffer_load_dwordx4 v226, s[4:7], s43 offen sc1 lds
    buffer_load_dwordx4 v227, s[72:75], s43 offen offset:1024 sc1 lds
    v_mfma_f32_32x32x16_bf16 v[32:47], v[80:83], v[180:183], v[32:47]
    v_add_u32 v222, s48, v251
    ds_read2_b32 v[222:223], v222 offset0:1 offset1:3
    v_mfma_f32_32x32x16_bf16 v[48:63], v[84:87], v[180:183], v[48:63]
    s_waitcnt vmcnt(4) lgkmcnt(1)
    v_mfma_f32_32x32x16_bf16 v[0:15], v[88:91], v[184:187], v[0:15]
    ds_read_b64_tr_b16 v[176:177], v246 offset:0
    ds_read_b64_tr_b16 v[178:179], v246 offset:1024
    ds_read_b64_tr_b16 v[180:181], v247 offset:0
    ds_read_b64_tr_b16 v[182:183], v247 offset:1024
    s_mov_b32 m0, s71
    v_mfma_f32_32x32x16_bf16 v[16:31], v[92:95], v[184:187], v[16:31]
    buffer_load_dwordx4 v228, s[4:7], s43 offen sc1 lds
    buffer_load_dwordx4 v229, s[72:75], s43 offen offset:1024 sc1 lds
    s_waitcnt lgkmcnt(4)
    v_mad_u32_u16 v222, v222, s39, v248 op_sel:[1,0,0,0]
    v_mad_u32_u16 v223, v223, s39, v248 op_sel:[1,0,0,0]
    v_mfma_f32_32x32x16_bf16 v[32:47], v[88:91], v[188:191], v[32:47]
    v_add_u32 v224, s49, v251
    ds_read2_b32 v[224:225], v224 offset0:1 offset1:3
    v_mul_f32 v242, v0, v144
    v_fma_f32 v238, v8, v160, -v238
    v_fmac_f32 v242, v1, v145
    v_fmac_f32 v238, v9, v161
    v_fmac_f32 v242, v2, v146
    v_mfma_f32_32x32x16_bf16 v[48:63], v[92:95], v[188:191], v[48:63]
    s_setprio 0
    v_fmac_f32 v238, v10, v162
    v_fmac_f32 v242, v3, v147
    v_fmac_f32 v238, v11, v163
    v_fmac_f32 v242, v4, v148
    v_fmac_f32 v238, v12, v164
    v_fmac_f32 v242, v5, v149
    v_fmac_f32 v238, v13, v165
    v_fmac_f32 v242, v6, v150
    v_fmac_f32 v238, v14, v166
    v_fmac_f32 v242, v7, v151
    v_fmac_f32 v238, v15, v167
    v_fmac_f32 v236, v16, v112
    v_mul_f32 v244, v24, v160
    v_fmac_f32 v236, v17, v113
    v_fmac_f32 v244, v25, v161
    v_fmac_f32 v236, v18, v114
    v_fmac_f32 v244, v26, v162
    v_fmac_f32 v236, v19, v115
    v_fmac_f32 v244, v27, v163
    v_fmac_f32 v236, v20, v116
    v_fmac_f32 v244, v28, v164
    v_fmac_f32 v236, v21, v117
    v_fmac_f32 v244, v29, v165
    v_fmac_f32 v236, v22, v118
    v_fmac_f32 v244, v30, v166
    v_fmac_f32 v236, v23, v119
    v_fmac_f32 v244, v31, v167
    v_mul_f32 v243, v32, v152
    v_fma_f32 v239, v40, v168, -v239
    v_fmac_f32 v243, v33, v153
    v_fmac_f32 v239, v41, v169
    v_fmac_f32 v243, v34, v154
    v_fmac_f32 v239, v42, v170
    v_fmac_f32 v243, v35, v155
    v_fmac_f32 v239, v43, v171
    v_fmac_f32 v243, v36, v156
    v_fmac_f32 v239, v44, v172
    v_fmac_f32 v243, v37, v157
    v_fmac_f32 v239, v45, v173
    v_fmac_f32 v243, v38, v158
    v_fmac_f32 v239, v46, v174
    v_fmac_f32 v243, v39, v159
    v_fmac_f32 v239, v47, v175
    v_fmac_f32 v237, v48, v120
    v_mul_f32 v245, v56, v168
    v_fmac_f32 v237, v49, v121
    v_fmac_f32 v245, v57, v169
    v_fmac_f32 v237, v50, v122
    v_fmac_f32 v245, v58, v170
    v_fmac_f32 v237, v51, v123
    s_setprio 1
    s_waitcnt vmcnt(4) lgkmcnt(1)
    v_mfma_f32_32x32x16_bf16 v[0:15], v[64:67], v[176:179], 0
    ds_read_b64_tr_b16 v[184:185], v246 offset:2048
    ds_read_b64_tr_b16 v[186:187], v246 offset:3072
    ds_read_b64_tr_b16 v[188:189], v247 offset:2048
    ds_read_b64_tr_b16 v[190:191], v247 offset:3072
    v_fmac_f32 v245, v59, v171
    v_fmac_f32 v237, v52, v124
    s_mov_b32 m0, s68
    v_mfma_f32_32x32x16_bf16 v[16:31], v[68:71], v[176:179], 0
    buffer_load_dwordx4 v222, s[4:7], s44 offen sc1 lds
    buffer_load_dwordx4 v223, s[72:75], s44 offen offset:1024 sc1 lds
    s_waitcnt lgkmcnt(4)
    v_mad_u32_u16 v224, v224, s39, v248 op_sel:[1,0,0,0]
    v_mad_u32_u16 v225, v225, s39, v248 op_sel:[1,0,0,0]
    v_fmac_f32 v245, v60, v172
    v_fmac_f32 v237, v53, v125
    v_mfma_f32_32x32x16_bf16 v[32:47], v[64:67], v[180:183], 0
    v_add_u32 v226, s50, v251
    ds_read2_b32 v[226:227], v226 offset0:1 offset1:3
    v_fmac_f32 v245, v61, v173
    v_fmac_f32 v237, v54, v126
    v_fmac_f32 v245, v62, v174
    v_fmac_f32 v237, v55, v127
    v_fmac_f32 v245, v63, v175
    v_mfma_f32_32x32x16_bf16 v[48:63], v[68:71], v[180:183], 0
    v_permlane32_swap_b32 v242, v234
    v_permlane32_swap_b32 v243, v235
    v_add_f32 v242, v242, v234
    v_add_f32 v243, v243, v235
    s_waitcnt vmcnt(4) lgkmcnt(1)
    v_mfma_f32_32x32x16_bf16 v[0:15], v[72:75], v[184:187], v[0:15]
    ds_read_b64_tr_b16 v[176:177], v246 offset:4096
    ds_read_b64_tr_b16 v[178:179], v246 offset:5120
    ds_read_b64_tr_b16 v[180:181], v247 offset:4096
    ds_read_b64_tr_b16 v[182:183], v247 offset:5120
    v_cvt_pk_bf16_f32 v242, v242, v243
    ds_write_b32 v230, v242 offset:512
    s_mov_b32 m0, s69
    v_mfma_f32_32x32x16_bf16 v[16:31], v[76:79], v[184:187], v[16:31]
    buffer_load_dwordx4 v224, s[4:7], s45 offen sc1 lds
    buffer_load_dwordx4 v225, s[72:75], s45 offen offset:1024 sc1 lds
    s_waitcnt lgkmcnt(5)
    v_mad_u32_u16 v226, v226, s39, v248 op_sel:[1,0,0,0]
    v_mad_u32_u16 v227, v227, s39, v248 op_sel:[1,0,0,0]
    v_mfma_f32_32x32x16_bf16 v[32:47], v[72:75], v[188:191], v[32:47]
    v_add_u32 v228, s51, v251
    ds_read2_b32 v[228:229], v228 offset0:1 offset1:3
    v_mfma_f32_32x32x16_bf16 v[48:63], v[76:79], v[188:191], v[48:63]
    s_waitcnt vmcnt(4) lgkmcnt(2)
    v_mfma_f32_32x32x16_bf16 v[0:15], v[80:83], v[176:179], v[0:15]
    ds_read_b64_tr_b16 v[184:185], v246 offset:6144
    ds_read_b64_tr_b16 v[186:187], v246 offset:7168
    ds_read_b64_tr_b16 v[188:189], v247 offset:6144
    ds_read_b64_tr_b16 v[190:191], v247 offset:7168
    s_mov_b32 s32, s31
    s_mov_b32 s31, s35
    s_mov_b32 m0, s70
    v_mfma_f32_32x32x16_bf16 v[16:31], v[84:87], v[176:179], v[16:31]
    buffer_load_dwordx4 v226, s[4:7], s46 offen sc1 lds
    buffer_load_dwordx4 v227, s[72:75], s46 offen offset:1024 sc1 lds
    s_waitcnt lgkmcnt(4)
    v_mad_u32_u16 v228, v228, s39, v248 op_sel:[1,0,0,0]
    v_mad_u32_u16 v229, v229, s39, v248 op_sel:[1,0,0,0]
    s_sub_u32 s26, s48, s29
    s_mov_b32 s29, s48
    v_mfma_f32_32x32x16_bf16 v[32:47], v[80:83], v[180:183], v[32:47]
    s_mov_b32 s30, s3
    s_bfe_u32 s56, s3, 0x40012
    s_cmp_lg_u32 s36, 0
    s_cselect_b32 s56, s56, 0
    v_mfma_f32_32x32x16_bf16 v[48:63], v[84:87], v[180:183], v[48:63]
    s_waitcnt vmcnt(4) lgkmcnt(0)
    v_mfma_f32_32x32x16_bf16 v[0:15], v[88:91], v[184:187], v[0:15]
    ds_read_b64_tr_b16 v[176:177], v246 offset:0
    ds_read_b64_tr_b16 v[178:179], v246 offset:1024
    ds_read_b64_tr_b16 v[180:181], v247 offset:0
    ds_read_b64_tr_b16 v[182:183], v247 offset:1024
    s_mov_b32 m0, s71
    v_mfma_f32_32x32x16_bf16 v[16:31], v[92:95], v[184:187], v[16:31]
    buffer_load_dwordx4 v228, s[4:7], s47 offen sc1 lds
    buffer_load_dwordx4 v229, s[72:75], s47 offen offset:1024 sc1 lds
    v_mfma_f32_32x32x16_bf16 v[32:47], v[88:91], v[188:191], v[32:47]
    s_nop 2
    v_mul_f32 v242, v0, v144
    v_fma_f32 v240, v8, v160, -v240
    v_fmac_f32 v242, v1, v145
    v_fmac_f32 v240, v9, v161
    v_fmac_f32 v242, v2, v146
    v_fmac_f32 v240, v10, v162
    v_fmac_f32 v242, v3, v147
    v_mfma_f32_32x32x16_bf16 v[48:63], v[92:95], v[188:191], v[48:63]
    s_setprio 0
    v_fmac_f32 v240, v11, v163
    v_fmac_f32 v242, v4, v148
    v_fmac_f32 v240, v12, v164
    v_fmac_f32 v242, v5, v149
    v_fmac_f32 v240, v13, v165
    v_fmac_f32 v242, v6, v150
    v_fmac_f32 v240, v14, v166
    v_fmac_f32 v242, v7, v151
    v_fmac_f32 v240, v15, v167
    v_add_u32 v249, s26, v249
    v_add_u32 v250, s26, v250
    v_fma_f32 v244, v16, v160, -v244
    v_fmac_f32 v236, v24, v112
    v_fmac_f32 v244, v17, v161
    v_fmac_f32 v236, v25, v113
    v_fmac_f32 v244, v18, v162
    v_fmac_f32 v236, v26, v114
    v_fmac_f32 v244, v19, v163
    v_fmac_f32 v236, v27, v115
    v_fmac_f32 v244, v20, v164
    v_fmac_f32 v236, v28, v116
    v_fmac_f32 v244, v21, v165
    v_fmac_f32 v236, v29, v117
    v_fmac_f32 v244, v22, v166
    v_fmac_f32 v236, v30, v118
    v_fmac_f32 v244, v23, v167
    v_fmac_f32 v236, v31, v119
    ds_read_b64_tr_b16 v[0:1], v249 offset:0
    ds_read_b64_tr_b16 v[2:3], v249 offset:32
    ds_read_u16_d16_hi v16, v250 offset:0
    v_mul_f32 v243, v32, v152
    v_fma_f32 v241, v40, v168, -v241
    v_fmac_f32 v243, v33, v153
    v_fmac_f32 v241, v41, v169
    v_fmac_f32 v243, v34, v154
    v_fmac_f32 v241, v42, v170
    v_fmac_f32 v243, v35, v155
    v_fmac_f32 v241, v43, v171
    v_fmac_f32 v243, v36, v156
    v_fmac_f32 v241, v44, v172
    v_fmac_f32 v243, v37, v157
    v_fmac_f32 v241, v45, v173
    v_fmac_f32 v243, v38, v158
    v_fmac_f32 v241, v46, v174
    v_fmac_f32 v243, v39, v159
    v_fmac_f32 v241, v47, v175
    ds_read_b64_tr_b16 v[4:5], v249 offset:512
    ds_read_b64_tr_b16 v[6:7], v249 offset:544
    ds_read_u16_d16_hi v17, v250 offset:128
    v_fma_f32 v245, v48, v168, -v245
    v_fmac_f32 v237, v56, v120
    v_fmac_f32 v245, v49, v169
    v_fmac_f32 v237, v57, v121
    v_fmac_f32 v245, v50, v170
    v_fmac_f32 v237, v58, v122
    v_fmac_f32 v245, v51, v171
    v_fmac_f32 v237, v59, v123
    v_fmac_f32 v245, v52, v172
    v_fmac_f32 v237, v60, v124
    v_fmac_f32 v245, v53, v173
    v_fmac_f32 v237, v61, v125
    v_fmac_f32 v245, v54, v174
    v_fmac_f32 v237, v62, v126
    v_fmac_f32 v245, v55, v175
    v_fmac_f32 v237, v63, v127
    s_cmp_eq_u32 s56, 5
    s_cbranch_scc1 K2_U21
    s_cmp_eq_u32 s56, 6
    s_cbranch_scc1 K2_U3h1
    s_branch K2_DSP1
K2_FLGR:
    s_sub_u32 s27, s27, 16
    s_cbranch_scc1 K2_END
    buffer_load_dwordx4 v[56:59], v60, s[8:11], s64 offen sc1
    s_branch K2_FLGW
K2_FLGY:
    v_mov_b32 v56, s2
    v_mov_b32 v57, 7178240
    s_mov_b64 exec, 1
    buffer_store_dword v56, v57, s[8:11], 0 offen sc1
    s_mov_b64 exec, -1
    s_branch K2_FLGOK
K2_nul_70:
    s_mov_b32 s58, 63
    s_mov_b32 s36, 0
    s_branch K2_back_73
K2_spin_71:
    s_sub_u32 s27, s27, 1
    s_cbranch_scc1 K2_END
    v_lshl_add_u32 v233, v252, 1, s53
    ds_read_b32 v233, v233
    s_waitcnt lgkmcnt(0)
    s_branch K2_chk_72
K2_dyn_68:
    v_mov_b32 v254, 163296
    v_mov_b32 v255, 1
    v_lshl_add_u32 v233, v252, 1, s53
    s_mov_b64 exec, 1
    ds_add_rtn_u32 v232, v254, v255
    s_mov_b64 exec, -1
    ds_read_b32 v233, v233
    s_waitcnt lgkmcnt(0)
    v_readfirstlane_b32 s58, v232
    s_nop 0
    s_cmp_lt_u32 s58, s22
    s_cbranch_scc0 K2_nul_70
    s_and_b32 s59, s58, 7
    s_lshr_b32 s60, s58, 3
K2_chk_72:
    v_readlane_b32 s61, v233, s59
    s_nop 0
    s_cmp_gt_u32 s61, s60
    s_cbranch_scc0 K2_spin_71
K2_back_73:
    s_mov_b32 s34, 1
    s_branch K2_back_69
K2_rare_74:
    s_cmp_eq_u32 s33, 4
    s_cbranch_scc1 K2_four_76
    s_mov_b32 s49, s48
    s_mov_b32 s51, s48
    s_xor_b32 s45, s44, 256
    s_xor_b32 s46, s44, 512
    s_xor_b32 s47, s44, 768
    s_branch K2_back_75
K2_four_76:
    s_add_u32 s50, s48, 256
    s_add_u32 s51, s48, 384
    s_mov_b32 s46, s44
    s_mov_b32 s47, s44
    s_branch K2_back_75
K2_dum_77:
    v_mov_b32 v232, -1
    s_mov_b32 m0, 163312
    s_mov_b64 exec, 1
    buffer_load_dwordx4 v232, s[16:19], 0 offen lds
    buffer_load_dwordx4 v232, s[16:19], 0 offen lds
    s_mov_b64 exec, -1
    s_branch K2_back_79
K2_a4_78:
    v_add_u32 v254, s48, v230
    ds_read_b32 v254, v254 offset:4
    s_lshr_b32 s65, s3, 27
    s_mul_i32 s66, s22, 2080
    s_lshl_b32 s65, s65, 9
    s_add_u32 s65, s65, s66
    s_add_u32 s65, s65, 65536
    s_mov_b32 m0, s65
    s_mov_b32 exec_hi, 0
    s_waitcnt lgkmcnt(0)
    v_or_b32 v254, v254, v231
    buffer_load_dwordx4 v254, s[16:19], 0 offen  lds
    s_mov_b32 exec_hi, -1
    s_branch K2_b4_80
K2_nul_83:
    s_mov_b32 s58, 63
    s_mov_b32 s36, 0
    s_branch K2_back_86
K2_spin_84:
    s_sub_u32 s27, s27, 1
    s_cbranch_scc1 K2_END
    v_lshl_add_u32 v233, v252, 1, s53
    ds_read_b32 v233, v233
    s_waitcnt lgkmcnt(0)
    s_branch K2_chk_85
K2_dyn_81:
    v_mov_b32 v254, 163296
    v_mov_b32 v255, 1
    v_lshl_add_u32 v233, v252, 1, s53
    s_mov_b64 exec, 1
    ds_add_rtn_u32 v232, v254, v255
    s_mov_b64 exec, -1
    ds_read_b32 v233, v233
    s_waitcnt lgkmcnt(0)
    v_readfirstlane_b32 s58, v232
    s_nop 0
    s_cmp_lt_u32 s58, s22
    s_cbranch_scc0 K2_nul_83
    s_and_b32 s59, s58, 7
    s_lshr_b32 s60, s58, 3
K2_chk_85:
    v_readlane_b32 s61, v233, s59
    s_nop 0
    s_cmp_gt_u32 s61, s60
    s_cbranch_scc0 K2_spin_84
K2_back_86:
    s_mov_b32 s34, 1
    s_branch K2_back_82
K2_rare_87:
    s_cmp_eq_u32 s33, 4
    s_cbranch_scc1 K2_four_89
    s_mov_b32 s49, s48
    s_mov_b32 s51, s48
    s_xor_b32 s45, s44, 256
    s_xor_b32 s46, s44, 512
    s_xor_b32 s47, s44, 768
    s_branch K2_back_88
K2_four_89:
    s_add_u32 s50, s48, 256
    s_add_u32 s51, s48, 384
    s_mov_b32 s46, s44
    s_mov_b32 s47, s44
    s_branch K2_back_88
K2_dum_90:
    v_mov_b32 v232, -1
    s_mov_b32 m0, 163312
    s_mov_b64 exec, 1
    buffer_load_dwordx4 v232, s[16:19], 0 offen lds
    buffer_load_dwordx4 v232, s[16:19], 0 offen lds
    s_mov_b64 exec, -1
    s_branch K2_back_92
K2_a4_91:
    v_add_u32 v254, s48, v230
    ds_read_b32 v254, v254 offset:4
    s_lshr_b32 s65, s3, 27
    s_mul_i32 s66, s22, 2080
    s_lshl_b32 s65, s65, 9
    s_add_u32 s65, s65, s66
    s_add_u32 s65, s65, 65536
    s_mov_b32 m0, s65
    s_mov_b32 exec_hi, 0
    s_waitcnt lgkmcnt(0)
    v_or_b32 v254, v254, v231
    buffer_load_dwordx4 v254, s[16:19], 0 offen  lds
    s_mov_b32 exec_hi, -1
    s_branch K2_b4_93
K2_nul_94:
    s_mov_b32 s58, 63
    s_mov_b32 s36, 0
    s_branch K2_back_97
K2_spin_95:
    s_sub_u32 s27, s27, 1
    s_cbranch_scc1 K2_END
    v_lshl_add_u32 v233, v252, 1, s53
    ds_read_b32 v233, v233
    s_waitcnt lgkmcnt(0)
    s_branch K2_chk_96
K2_rare_98:
    s_cmp_eq_u32 s33, 4
    s_cbranch_scc1 K2_four_100
    s_mov_b32 s49, s48
    s_mov_b32 s51, s48
    s_xor_b32 s45, s44, 256
    s_xor_b32 s46, s44, 512
    s_xor_b32 s47, s44, 768
    s_branch K2_back_99
K2_four_100:
    s_add_u32 s50, s48, 256
    s_add_u32 s51, s48, 384
    s_mov_b32 s46, s44
    s_mov_b32 s47, s44
    s_branch K2_back_99
K2_nul_101:
    s_mov_b32 s58, 63
    s_mov_b32 s36, 0
    s_branch K2_back_104
K2_spin_102:
    s_sub_u32 s27, s27, 1
    s_cbranch_scc1 K2_END
    v_lshl_add_u32 v233, v252, 1, s53
    ds_read_b32 v233, v233
    s_waitcnt lgkmcnt(0)
    s_branch K2_chk_103
K2_rare_105:
    s_cmp_eq_u32 s33, 4
    s_cbranch_scc1 K2_four_107
    s_mov_b32 s49, s48
    s_mov_b32 s51, s48
    s_xor_b32 s45, s44, 256
    s_xor_b32 s46, s44, 512
    s_xor_b32 s47, s44, 768
    s_branch K2_back_106
K2_four_107:
    s_add_u32 s50, s48, 256
    s_add_u32 s51, s48, 384
    s_mov_b32 s46, s44
    s_mov_b32 s47, s44
    s_branch K2_back_106
K2_END:
    s_endpgm
.section .rodata,"a"
.p2align 6
.amdhsa_kernel standalone__tensor_product_equiv_equiformer__graph_kernel
  .amdhsa_next_free_vgpr 256
  .amdhsa_next_free_sgpr 102
  .amdhsa_accum_offset 256
  .amdhsa_group_segment_fixed_size 0
  .amdhsa_kernarg_size 96
  .amdhsa_user_sgpr_count 2
  .amdhsa_user_sgpr_kernarg_segment_ptr 1
  .amdhsa_system_sgpr_workgroup_id_x 1
  .amdhsa_float_denorm_mode_32 3
.end_amdhsa_kernel
```

```asm
; @launch grid=(256,1,1) block=(512,1,1) lds=163840
.amdgcn_target "amdgcn-amd-amdhsa--gfx950"
.text
.globl standalone__tensor_product_equiv_equiformer__graph_kernel
.p2align 8
.type standalone__tensor_product_equiv_equiformer__graph_kernel,@function
standalone__tensor_product_equiv_equiformer__graph_kernel:
    s_cmp_ge_u32 s2, 256
    s_cbranch_scc1 K2_END
    s_load_dwordx16 s[80:95], s[0:1], 0
    s_load_dwordx4 s[96:99], s[0:1], 72
    s_load_dwordx2 s[100:101], s[0:1], 88
    v_lshrrev_b32 v1, 6, v0
    s_mov_b32 s54, s2
    v_readfirstlane_b32 s20, v1
    s_mov_b64 exec, 0
    s_cmp_eq_u32 s20, 0
    s_cbranch_scc1 K2_PAD_S1
    s_cmp_eq_u32 s20, 1
    s_cbranch_scc1 K2_PAD_S2
    s_cmp_eq_u32 s20, 5
    s_cbranch_scc1 K2_PAD_H1
    s_cmp_eq_u32 s20, 6
    s_cbranch_scc1 K2_PAD_H2
    s_cmp_eq_u32 s20, 2
    s_cbranch_scc1 K2_PAD_H3
KS_HOP0:
    s_mov_b64 exec, -1
    v_and_b32 v8, 63, v0
    v_lshlrev_b32 v9, 4, v8
    v_mov_b32 v6, 0
    v_lshlrev_b32 v5, 4, v0
    v_mul_u32_u24 v4, 24, v0
    s_mul_i32 s64, s2, 5120
    s_mul_i32 s65, s2, 7680
    v_mov_b32 v176, v8
    v_mov_b32 v177, v0
    s_lshr_b32 s21, s2, 1
    s_mul_i32 s21, s21, 625
    s_add_u32 s22, s21, 632
    s_add_u32 s21, s21, 7
    s_lshr_b32 s21, s21, 3
    s_lshr_b32 s22, s22, 3
    s_add_u32 s24, s21, 40
    s_sub_u32 s22, s22, s24
    s_bitcmp1_b32 s2, 0
    s_cselect_b32 s21, s24, s21
    s_cselect_b32 s22, s22, 40
    s_movk_i32 s39, 1024
    s_lshl_b32 s37, s20, 13
    s_mov_b32 s53, 163264
    s_lshl_b32 s52, s20, 2
    s_add_u32 s52, s52, s53
    s_add_u32 s68, s37, 0
    s_add_u32 s69, s37, 2048
    s_add_u32 s70, s37, 4096
    s_add_u32 s71, s37, 6144
    s_waitcnt lgkmcnt(0)
    s_mov_b32 s8, s100
    s_and_b32 s9, s101, 0xffff
    s_mov_b32 s10, 37748736
    s_mov_b32 s11, 0x20000
    s_cmp_lg_u32 s20, 7
    s_cbranch_scc1 KS_NOTAG
    s_mov_b32 s24, 7178240
    s_mov_b64 exec, 1
    buffer_load_dword v14, v6, s[8:11], s24 offen sc1
    s_mov_b64 exec, -1
    s_barrier
    v_mov_b32 v76, 0
    v_mov_b32 v77, -1
    v_lshlrev_b32 v78, 2, v8
    v_add_u32 v78, 163072, v78
    s_mov_b64 exec, 0x1ff
    ds_write_b32 v78, v76 offset:192
    s_mov_b32 exec_lo, -1
    ds_write_b32 v78, v77 offset:256
    s_mov_b64 exec, -1
    s_mov_b32 exec_hi, 0xffff
    ds_write_b32 v78, v76
    s_mov_b64 exec, 1
    ds_write_b32 v78, v76 offset:228
    s_mov_b64 exec, -1
    s_mov_b64 exec, 1
    v_mov_b32 v12, 163456
    s_mov_b32 s24, 1664525
    s_waitcnt vmcnt(0)
    v_mul_lo_u32 v14, v14, s24
    v_add_u32 v14, 1013904223, v14
    ds_write_b32 v12, v14
KS_TAGOK2:
    s_mov_b64 exec, -1
    s_waitcnt lgkmcnt(0)
    s_barrier
    s_branch KS_B3
KS_H0:
    s_barrier
    s_branch KS_HELP
K2_PAD_S1:
    s_branch KS_HOP0
KS_NOTAG:
    s_cmp_ge_u32 s20, 5
    s_cbranch_scc1 KS_HELP
    s_cmp_ge_u32 s2, 250
    s_cbranch_scc1 KS_IDLE
    s_mov_b32 s40, s88
    s_and_b32 s41, s89, 0xffff
    s_mov_b32 s42, 1280000
    s_mov_b32 s43, 0x20000
    buffer_load_dwordx4 v[12:15], v5, s[40:43], s64 offen
    s_mov_b32 s44, s86
    s_and_b32 s45, s87, 0xffff
    s_mov_b32 s46, 1280000
    s_mov_b32 s47, 0x20000
    s_mov_b32 s48, s82
    s_and_b32 s49, s83, 0xffff
    s_mov_b32 s50, 1920000
    s_mov_b32 s51, 0x20000
    buffer_load_dwordx4 v[16:19], v5, s[44:47], s64 offen
    buffer_load_dwordx4 v[20:23], v4, s[48:51], s65 offen
    buffer_load_dwordx2 v[24:25], v4, s[48:51], s65 offen offset:16
    v_lshlrev_b32 v2, 2, v0
    s_lshl_b32 s64, s64, 3
    v_lshl_add_u32 v3, v0, 7, s64
    v_mov_b32 v7, 1
    s_cmp_eq_u32 s20, 4
    s_cbranch_scc1 KS_NOCLR
    ds_write_b32 v2, v6
KS_NOCLR:
    s_waitcnt lgkmcnt(0)
    s_barrier
    s_mov_b64 exec, 0
    s_cmp_eq_u32 s20, 0
    s_cbranch_scc1 K2_PAD_B3
    s_cmp_eq_u32 s20, 1
    s_cbranch_scc1 K2_PAD_LD
    s_cmp_eq_u32 s20, 2
    s_cbranch_scc1 K2_PAD_NW
    s_cmp_eq_u32 s20, 3
    s_cbranch_scc1 K2_PAD_SC
    s_cmp_eq_u32 s20, 4
    s_cbranch_scc1 K2_PAD_SD
KS_HOP:
    s_mov_b64 exec, -1
    s_mov_b32 s58, 214749
    s_movk_i32 s59, 625
    s_waitcnt vmcnt(3)
    v_mul_u32_u24 v28, s58, v12
    v_and_b32 v40, 0xffffff, v28
    v_lshrrev_b32 v32, 26, v28
    v_add_u32 v40, 8187281, v40
    v_bfe_u32 v36, v28, 24, 2
    v_lshlrev_b32 v32, 2, v32
    v_lshrrev_b32 v40, 24, v40
    v_lshl_or_b32 v32, v36, 8, v32
    v_lshl_or_b32 v32, v40, 7, v32
    ds_add_rtn_u32 v36, v32, v7
    v_mul_u32_u24 v29, s58, v13
    v_and_b32 v41, 0xffffff, v29
    v_lshrrev_b32 v33, 26, v29
    v_add_u32 v41, 8187281, v41
    v_bfe_u32 v37, v29, 24, 2
    v_lshlrev_b32 v33, 2, v33
    v_lshrrev_b32 v41, 24, v41
    v_lshl_or_b32 v33, v37, 8, v33
    v_lshl_or_b32 v33, v41, 7, v33
    ds_add_rtn_u32 v37, v33, v7
    v_mul_u32_u24 v30, s58, v14
    v_and_b32 v42, 0xffffff, v30
    v_lshrrev_b32 v34, 26, v30
    v_add_u32 v42, 8187281, v42
    v_bfe_u32 v38, v30, 24, 2
    v_lshlrev_b32 v34, 2, v34
    v_lshrrev_b32 v42, 24, v42
    v_lshl_or_b32 v34, v38, 8, v34
    v_lshl_or_b32 v34, v42, 7, v34
    ds_add_rtn_u32 v38, v34, v7
    v_mul_u32_u24 v31, s58, v15
    v_and_b32 v43, 0xffffff, v31
    v_lshrrev_b32 v35, 26, v31
    v_add_u32 v43, 8187281, v43
    v_bfe_u32 v39, v31, 24, 2
    v_lshlrev_b32 v35, 2, v35
    v_lshrrev_b32 v43, 24, v43
    v_lshl_or_b32 v35, v39, 8, v35
    v_lshl_or_b32 v35, v43, 7, v35
    ds_add_rtn_u32 v39, v35, v7
    v_lshrrev_b32 v28, 24, v28
    v_mad_u32_u24 v28, v28, s59, 7
    v_lshrrev_b32 v28, 3, v28
    v_mad_u32_u24 v28, v40, 40, v28
    v_sub_u32 v28, v12, v28
    v_add_u32 v12, 0, v3
    v_lshl_or_b32 v28, v28, 26, v12
    v_lshrrev_b32 v29, 24, v29
    v_mad_u32_u24 v29, v29, s59, 7
    v_lshrrev_b32 v29, 3, v29
    v_mad_u32_u24 v29, v41, 40, v29
    v_sub_u32 v29, v13, v29
    v_add_u32 v13, 32, v3
    v_lshl_or_b32 v29, v29, 26, v13
    v_lshrrev_b32 v30, 24, v30
    v_mad_u32_u24 v30, v30, s59, 7
    v_lshrrev_b32 v30, 3, v30
    v_mad_u32_u24 v30, v42, 40, v30
    v_sub_u32 v30, v14, v30
    v_add_u32 v14, 64, v3
    v_lshl_or_b32 v30, v30, 26, v14
    v_lshrrev_b32 v31, 24, v31
    v_mad_u32_u24 v31, v31, s59, 7
    v_lshrrev_b32 v31, 3, v31
    v_mad_u32_u24 v31, v43, 40, v31
    v_sub_u32 v31, v15, v31
    v_add_u32 v15, 96, v3
    v_lshl_or_b32 v31, v31, 26, v15
K2_PAD_S2:
    s_cbranch_execz KS_HOP0
    v_mov_b32 v59, 163456
    s_mul_i32 s65, s2, 1152
    s_add_u32 s65, s65, 6291456
    s_mul_i32 s64, s2, 20608
    s_waitcnt lgkmcnt(0)
    s_barrier
    ds_read_b128 v[40:43], v9
    ds_read_b32 v59, v59
    s_waitcnt lgkmcnt(1)
    v_add_u32 v45, v40, v41
    v_add_u32 v46, v45, v42
    v_add_u32 v47, v46, v43
    v_mov_b32 v58, v47
    s_nop 1
    v_add_u32_dpp v58, v58, v58 row_shr:1 row_mask:0xf bank_mask:0xf bound_ctrl:0
    s_nop 1
    v_add_u32_dpp v58, v58, v58 row_shr:2 row_mask:0xf bank_mask:0xf bound_ctrl:0
    s_nop 1
    v_add_u32_dpp v58, v58, v58 row_shr:4 row_mask:0xf bank_mask:0xf bound_ctrl:0
    s_nop 1
    v_add_u32_dpp v58, v58, v58 row_shr:8 row_mask:0xf bank_mask:0xf bound_ctrl:0
    s_nop 1
    v_add_u32_dpp v58, v58, v58 row_bcast:15 row_mask:0xa bank_mask:0xf
    s_nop 1
    v_add_u32_dpp v58, v58, v58 row_bcast:31 row_mask:0xc bank_mask:0xf
    v_sub_u32 v48, v58, v47
    v_add_u32 v49, v48, v40
    v_add_u32 v50, v48, v45
    v_add_u32 v51, v48, v46
    ds_write_b128 v9, v[48:51] offset:1024
    s_waitcnt vmcnt(0) lgkmcnt(1)
    s_cmp_lg_u32 s20, 4
    s_cbranch_scc1 KS_NOPUB
    v_lshl_or_b32 v56, v49, 11, v48
    v_lshl_or_b32 v57, v51, 11, v50
    v_lshl_or_b32 v56, v59, 22, v56
    v_lshl_or_b32 v57, v59, 22, v57
    buffer_store_dwordx4 v[56:59], v9, s[8:11], s65 offen sc1
KS_NOPUB:
    s_waitcnt lgkmcnt(0)
    ds_read_b32 v32, v32 offset:1024
    ds_read_b32 v33, v33 offset:1024
    ds_read_b32 v34, v34 offset:1024
    ds_read_b32 v35, v35 offset:1024
    v_and_b32 v60, 0xffff, v59
    v_and_b32 v61, 0xffff0000, v59
    s_mov_b32 s58, 0xffff0000
    v_mov_b32 v40, v20
    v_lshl_or_b32 v41, v21, 16, v60
    v_or_b32 v42, v61, v16
    v_mov_b32 v43, v28
    v_alignbit_b32 v44, v22, v21, 16
    v_and_or_b32 v45, v22, s58, v60
    v_or_b32 v46, v61, v17
    v_mov_b32 v47, v29
    v_mov_b32 v48, v23
    v_lshl_or_b32 v49, v24, 16, v60
    v_or_b32 v50, v61, v18
    v_mov_b32 v51, v30
    v_alignbit_b32 v52, v25, v24, 16
    v_and_or_b32 v53, v25, s58, v60
    v_or_b32 v54, v61, v19
    v_mov_b32 v55, v31
    s_waitcnt lgkmcnt(0)
    v_add_lshl_u32 v32, v32, v36, 4
    ds_write_b128 v32, v[40:43] offset:2048
    v_add_lshl_u32 v33, v33, v37, 4
    ds_write_b128 v33, v[44:47] offset:2048
    v_add_lshl_u32 v34, v34, v38, 4
    ds_write_b128 v34, v[48:51] offset:2048
    v_add_lshl_u32 v35, v35, v39, 4
    ds_write_b128 v35, v[52:55] offset:2048
    s_waitcnt lgkmcnt(0)
    s_barrier
    ds_read_b128 v[12:15], v5 offset:2048
    ds_read_b128 v[16:19], v5 offset:7168
    ds_read_b128 v[20:23], v5 offset:12288
    ds_read_b128 v[24:27], v5 offset:17408
    s_waitcnt lgkmcnt(3)
    buffer_store_dwordx4 v[12:15], v5, s[8:11], s64 offen sc1
    s_add_u32 s64, s64, 5120
    s_waitcnt lgkmcnt(2)
    buffer_store_dwordx4 v[16:19], v5, s[8:11], s64 offen sc1
    s_add_u32 s64, s64, 5120
    s_waitcnt lgkmcnt(1)
    buffer_store_dwordx4 v[20:23], v5, s[8:11], s64 offen sc1
    s_add_u32 s64, s64, 5120
    s_waitcnt lgkmcnt(0)
    buffer_store_dwordx4 v[24:27], v5, s[8:11], s64 offen sc1
    s_branch KS_JOIN
K2_PAD_B3:
    s_branch KS_HOP
KS_B3:
    v_mov_b32 v59, 163456
    ds_read_b32 v59, v59
    s_waitcnt lgkmcnt(0)
    s_barrier
KS_JOIN:
    v_readfirstlane_b32 s2, v59
    s_mov_b32 s23, 0
    s_mov_b32 s28, 1
    s_mov_b32 s24, 0
    s_mov_b32 s25, 1
K2_CELLS:
    v_lshrrev_b32 v178, 1, v177
    v_min_u32 v178, 249, v178
    v_mul_u32_u24 v72, 1152, v178
    s_and_b32 s58, s54, 7
    s_lshl_b32 s58, s58, 7
    s_lshr_b32 s59, s54, 5
    s_lshl_b32 s59, s59, 4
    s_add_u32 s67, s58, s59
    s_add_u32 s67, s67, 6291456
    buffer_load_dwordx4 v[76:79], v72, s[8:11], s67 offen sc1
    s_cmp_eq_u32 s28, 0
    s_cbranch_scc1 K2_NOSRD
    s_mov_b32 s4, s80
    s_and_b32 s5, s81, 0xffff
    s_mov_b32 s6, 10240000
    s_mov_b32 s7, 0x20000
    s_mov_b32 s12, s96
    s_and_b32 s13, s97, 0xffff
    s_mov_b32 s14, 10240000
    s_mov_b32 s15, 0x20000
    s_mov_b32 s16, s84
    s_and_b32 s17, s85, 0xffff
    s_mov_b32 s18, 10240000
    s_mov_b32 s19, 0x20000
    s_sub_u32 s80, s80, 1024
    s_subb_u32 s81, s81, 0
    s_mov_b32 s72, s80
    s_and_b32 s73, s81, 0xffff
    s_mov_b32 s74, 10241024
    s_mov_b32 s75, 0x20000
    s_mov_b64 exec, 0
    s_cmp_eq_u32 s20, 0
    s_cbranch_scc1 K2_PAD_U20
    s_cmp_eq_u32 s20, 1
    s_cbranch_scc1 K2_PAD_U30
    s_cmp_eq_u32 s20, 2
    s_cbranch_scc1 K2_PAD_U21
    s_cmp_eq_u32 s20, 3
    s_cbranch_scc1 K2_PAD_U31
    s_cmp_eq_u32 s20, 4
    s_cbranch_scc1 K2_PAD_SW
    s_cmp_eq_u32 s20, 5
    s_cbranch_scc1 K2_PAD_TL
    s_cmp_eq_u32 s20, 6
    s_cbranch_scc1 K2_PAD_T2
K2_HOP:
    s_mov_b64 exec, -1
K2_NOSRD:
    v_and_b32 v84, 15, v176
    v_lshrrev_b32 v85, 5, v176
    v_bfe_u32 v86, v176, 4, 1
    v_lshrrev_b32 v87, 2, v84
    v_and_b32 v88, 3, v84
    v_lshl_add_u32 v89, v85, 2, v87
    v_lshlrev_b32 v249, 6, v89
    v_lshl_add_u32 v249, v88, 3, v249
    v_add_u32 v249, 512, v249
    v_lshrrev_b32 v90, 3, v84
    v_lshl_add_u32 v90, v90, 1, v86
    v_sub_u32 v90, v90, 1 clamp
    v_lshlrev_b32 v250, 1, v90
    v_lshl_add_u32 v91, v85, 2, v88
    v_lshl_add_u32 v250, v91, 4, v250
    v_and_b32 v91, 1, v87
    v_lshl_add_u32 v250, v91, 3, v250
    v_lshrrev_b32 v90, 1, v88
    v_lshl_add_u32 v90, v86, 1, v90
    v_bfe_u32 v91, v87, 1, 1
    v_lshlrev_b32 v91, 2, v91
    v_xor_b32 v90, v90, v91
    v_lshlrev_b32 v90, 4, v90
    v_lshl_add_u32 v90, v89, 7, v90
    v_and_b32 v91, 1, v88
    v_lshl_add_u32 v90, v91, 3, v90
    v_add_u32 v246, s37, v90
    v_xor_b32 v247, 64, v246
    v_lshrrev_b32 v90, 3, v176
    v_lshlrev_b32 v251, 4, v90
    v_bfe_u32 v90, v90, 1, 1
    v_lshlrev_b32 v90, 2, v90
    v_and_b32 v91, 7, v176
    v_xor_b32 v90, v90, v91
    v_lshlrev_b32 v248, 4, v90
    v_lshlrev_b32 v252, 1, v176
    v_and_b32 v231, 1, v176
    v_lshlrev_b32 v231, 4, v231
    v_lshrrev_b32 v90, 1, v176
    v_lshlrev_b32 v90, 5, v90
    v_add_u32 v230, 512, v90
    s_lshl_b32 s59, s2, 22
    s_mov_b32 s60, 0x40000
    s_bfe_u32 s61, s54, 0x10004
    s_bfe_u32 s62, s54, 0x10003
    s_add_u32 s63, s61, s62
    s_mul_i32 s62, s62, 11
    s_sub_u32 s64, 11, s62
    v_cmp_gt_u32 vcc, 500, v177
    s_nop 0
    s_mov_b64 s[56:57], vcc
K2_POLL:
    s_waitcnt vmcnt(0)
    v_xor_b32 v73, s59, v76
    v_xor_b32 v74, s59, v77
    v_or_b32 v73, v73, v74
    v_xor_b32 v74, s2, v79
    v_lshrrev_b32 v73, 22, v73
    v_or_b32 v73, v73, v74
    v_cmp_ne_u32 vcc, 0, v73
    s_nop 0
    s_cbranch_vccz K2_POLLED
    s_sub_u32 s60, s60, 1
    s_cbranch_scc1 K2_END
    s_mov_b64 exec, vcc
    buffer_load_dwordx4 v[76:79], v72, s[8:11], s67 offen sc1
    s_mov_b64 exec, -1
    s_branch K2_POLL
K2_PAD_LD:
    s_branch KS_HOP
K2_POLLED:
    s_set_gpr_idx_on s61, gpr_idx(SRC0)
    s_nop 0
    v_bfe_u32 v179, v76, s62, 11
    s_set_gpr_idx_idx s63
    s_nop 0
    v_bfe_u32 v73, v76, s64, 11
    s_set_gpr_idx_off
    v_sub_u32 v73, v73, v179
    v_cndmask_b32 v73, 0, v73, s[56:57]
    v_and_b32 v1, 1, v177
    v_add_u32 v1, s23, v1
    v_sub_u32 v180, v73, v1
    v_add_u32 v179, v179, v1
    v_mul_u32_u24 v181, 20608, v178
    v_lshl_add_u32 v181, v179, 4, v181
    v_cmp_lt_i32 s[40:41], 0, v180
    v_add_u32 v182, 32, v181
    s_mov_b32 s65, 0
    s_mov_b64 exec, s[40:41]
    buffer_load_dwordx4 v[0:3], v181, s[8:11], 0 offen offset:0 sc1
    s_mov_b64 exec, -1
    v_cmp_lt_i32 s[42:43], 2, v180
    v_cmp_lt_i32 s[44:45], 4, v180
    v_cmp_lt_i32 s[46:47], 6, v180
    v_cmp_lt_i32 s[48:49], 8, v180
    v_cmp_lt_i32 s[50:51], 10, v180
    v_cmp_lt_i32 s[90:91], 12, v180
    v_cmp_lt_i32 s[92:93], 14, v180
    v_cmp_lt_i32 s[94:95], 16, v180
    v_cmp_lt_i32 s[96:97], 18, v180
    v_add_u32 v183, 64, v181
    v_add_u32 v184, 96, v181
    v_subrev_u32 v62, 1, v180
    v_ashrrev_i32 v62, 1, v62
    v_med3_i32 v62, v62, 0, 9
    s_cmp_eq_u64 s[42:43], 0
    s_cbranch_scc1 K2_LD_DONE
    v_mov_b32 v63, v62
    s_nop 1
    v_add_u32_dpp v63, v63, v63 row_shr:1 row_mask:0xf bank_mask:0xf bound_ctrl:0
    s_nop 1
    v_add_u32_dpp v63, v63, v63 row_shr:2 row_mask:0xf bank_mask:0xf bound_ctrl:0
    s_nop 1
    v_add_u32_dpp v63, v63, v63 row_shr:4 row_mask:0xf bank_mask:0xf bound_ctrl:0
    s_nop 1
    v_add_u32_dpp v63, v63, v63 row_shr:8 row_mask:0xf bank_mask:0xf bound_ctrl:0
    s_nop 1
    v_add_u32_dpp v63, v63, v63 row_bcast:15 row_mask:0xa bank_mask:0xf
    s_nop 1
    v_add_u32_dpp v63, v63, v63 row_bcast:31 row_mask:0xc bank_mask:0xf
    s_lshl_b32 s58, s20, 10
    s_add_u32 s58, s58, 45056
    v_readlane_b32 s59, v63, 63
    v_sub_u32 v63, v63, v62
    v_lshl_add_u32 v64, v63, 2, s58
    v_lshlrev_b32 v63, 5, v63
    v_sub_u32 v63, v182, v63
    s_cmp_gt_u32 s59, 189
    s_cbranch_scc1 K2_LD_GEN
    s_mov_b64 exec, s[42:43]
    s_cbranch_execz K2_LD_L
    ds_write_b32 v64, v63 offset:0
    s_mov_b64 exec, s[44:45]
    s_cbranch_execz K2_LD_L
    ds_write_b32 v64, v63 offset:4
    s_mov_b64 exec, s[46:47]
    s_cbranch_execz K2_LD_L
    ds_write_b32 v64, v63 offset:8
    s_mov_b64 exec, s[48:49]
    s_cbranch_execz K2_LD_L
    ds_write_b32 v64, v63 offset:12
    s_mov_b64 exec, s[50:51]
    s_cbranch_execz K2_LD_L
    ds_write_b32 v64, v63 offset:16
    s_mov_b64 exec, s[90:91]
    s_cbranch_execz K2_LD_L
    ds_write_b32 v64, v63 offset:20
    s_mov_b64 exec, s[92:93]
    s_cbranch_execz K2_LD_L
    ds_write_b32 v64, v63 offset:24
    s_mov_b64 exec, s[94:95]
    s_cbranch_execz K2_LD_L
    ds_write_b32 v64, v63 offset:28
    s_mov_b64 exec, s[96:97]
    s_cbranch_execz K2_LD_L
    ds_write_b32 v64, v63 offset:32
K2_LD_L:
    s_mov_b64 exec, -1
    v_lshl_add_u32 v63, v176, 2, s58
    v_lshlrev_b32 v62, 5, v176
    s_waitcnt lgkmcnt(0)
    ds_read_b32 v64, v63 offset:0
    ds_read_b32 v65, v63 offset:252
    ds_read_b32 v66, v63 offset:504
    s_min_u32 s60, s59, 63
    s_sub_u32 s59, s59, s60
    s_bfm_b64 s[42:43], s60, 0
    s_min_u32 s60, s59, 63
    s_sub_u32 s59, s59, s60
    s_bfm_b64 s[44:45], s60, 0
    s_min_u32 s60, s59, 63
    s_sub_u32 s59, s59, s60
    s_bfm_b64 s[46:47], s60, 0
    s_mov_b64 s[48:49], 0
    s_mov_b32 s65, 1
    s_mov_b32 s60, 0
    s_waitcnt lgkmcnt(2)
    v_add3_u32 v182, v62, v64, s60
    s_mov_b64 exec, s[42:43]
    buffer_load_dwordx4 v[4:7], v182, s[8:11], 0 offen sc1
    s_mov_b32 s60, 2016
    s_waitcnt lgkmcnt(1)
    v_add3_u32 v183, v62, v65, s60
    s_mov_b64 exec, s[44:45]
    buffer_load_dwordx4 v[8:11], v183, s[8:11], 0 offen sc1
    s_mov_b32 s60, 4032
    s_waitcnt lgkmcnt(0)
    v_add3_u32 v184, v62, v66, s60
    s_mov_b64 exec, s[46:47]
    buffer_load_dwordx4 v[12:15], v184, s[8:11], 0 offen sc1
K2_LD_DONE:
    s_mov_b64 exec, -1
    s_cmp_eq_u32 s28, 0
    s_cbranch_scc1 K2_WLATE
    v_lshrrev_b32 v60, 6, v252
    v_bfe_u32 v61, v252, 3, 2
    v_lshl_add_u32 v60, v60, 2, v61
    v_mul_u32_u24 v60, 640, v60
    v_bfe_u32 v61, v252, 5, 1
    v_lshl_add_u32 v60, v61, 5, v60
    v_and_b32 v61, 6, v252
    v_lshl_add_u32 v60, v61, 2, v60
    v_add_u32 v60, 24576, v60
    ds_read_b64_tr_b16 v[136:137], v60 offset:0
    ds_read_b64_tr_b16 v[138:139], v60 offset:5120
    ds_read_b64_tr_b16 v[140:141], v60 offset:64
    ds_read_b64_tr_b16 v[142:143], v60 offset:5184
    ds_read_b64_tr_b16 v[144:145], v60 offset:128
    ds_read_b64_tr_b16 v[146:147], v60 offset:5248
    ds_read_b64_tr_b16 v[148:149], v60 offset:192
    ds_read_b64_tr_b16 v[150:151], v60 offset:5312
    ds_read_b64_tr_b16 v[152:153], v60 offset:256
    ds_read_b64_tr_b16 v[154:155], v60 offset:5376
    ds_read_b64_tr_b16 v[156:157], v60 offset:320
    ds_read_b64_tr_b16 v[158:159], v60 offset:5440
    ds_read_b64_tr_b16 v[160:161], v60 offset:384
    ds_read_b64_tr_b16 v[162:163], v60 offset:5504
    ds_read_b64_tr_b16 v[164:165], v60 offset:448
    ds_read_b64_tr_b16 v[166:167], v60 offset:5568
    ds_read_b64_tr_b16 v[168:169], v60 offset:512
    ds_read_b64_tr_b16 v[170:171], v60 offset:5632
    ds_read_b64_tr_b16 v[172:173], v60 offset:576
    ds_read_b64_tr_b16 v[174:175], v60 offset:5696
    s_waitcnt lgkmcnt(0)
K2_WUNP:
    v_lshlrev_b32 v96, 16, v136
    v_and_b32 v97, 0xffff0000, v136
    v_lshlrev_b32 v98, 16, v137
    v_and_b32 v99, 0xffff0000, v137
    v_lshlrev_b32 v100, 16, v138
    v_and_b32 v101, 0xffff0000, v138
    v_lshlrev_b32 v102, 16, v139
    v_and_b32 v103, 0xffff0000, v139
    v_lshlrev_b32 v104, 16, v140
    v_and_b32 v105, 0xffff0000, v140
    v_lshlrev_b32 v106, 16, v141
    v_and_b32 v107, 0xffff0000, v141
    v_lshlrev_b32 v108, 16, v142
    v_and_b32 v109, 0xffff0000, v142
    v_lshlrev_b32 v110, 16, v143
    v_and_b32 v111, 0xffff0000, v143
    v_lshlrev_b32 v112, 16, v144
    v_and_b32 v113, 0xffff0000, v144
    v_lshlrev_b32 v114, 16, v145
    v_and_b32 v115, 0xffff0000, v145
    v_lshlrev_b32 v116, 16, v146
    v_and_b32 v117, 0xffff0000, v146
    v_lshlrev_b32 v118, 16, v147
    v_and_b32 v119, 0xffff0000, v147
    v_lshlrev_b32 v120, 16, v148
    v_and_b32 v121, 0xffff0000, v148
    v_lshlrev_b32 v122, 16, v149
    v_and_b32 v123, 0xffff0000, v149
    v_lshlrev_b32 v124, 16, v150
    v_and_b32 v125, 0xffff0000, v150
    v_lshlrev_b32 v126, 16, v151
    v_and_b32 v127, 0xffff0000, v151
    v_lshlrev_b32 v128, 16, v152
    v_and_b32 v129, 0xffff0000, v152
    v_lshlrev_b32 v130, 16, v153
    v_and_b32 v131, 0xffff0000, v153
    v_lshlrev_b32 v132, 16, v154
    v_and_b32 v133, 0xffff0000, v154
    v_lshlrev_b32 v134, 16, v155
    v_and_b32 v135, 0xffff0000, v155
    v_lshlrev_b32 v136, 16, v156
    v_and_b32 v137, 0xffff0000, v156
    v_lshlrev_b32 v138, 16, v157
    v_and_b32 v139, 0xffff0000, v157
    v_lshlrev_b32 v140, 16, v158
    v_and_b32 v141, 0xffff0000, v158
    v_lshlrev_b32 v142, 16, v159
    v_and_b32 v143, 0xffff0000, v159
    v_lshlrev_b32 v144, 16, v160
    v_and_b32 v145, 0xffff0000, v160
    v_lshlrev_b32 v146, 16, v161
    v_and_b32 v147, 0xffff0000, v161
    v_lshlrev_b32 v148, 16, v162
    v_and_b32 v149, 0xffff0000, v162
    v_lshlrev_b32 v150, 16, v163
    v_and_b32 v151, 0xffff0000, v163
    v_lshlrev_b32 v152, 16, v164
    v_and_b32 v153, 0xffff0000, v164
    v_lshlrev_b32 v154, 16, v165
    v_and_b32 v155, 0xffff0000, v165
    v_lshlrev_b32 v156, 16, v166
    v_and_b32 v157, 0xffff0000, v166
    v_lshlrev_b32 v158, 16, v167
    v_and_b32 v159, 0xffff0000, v167
    v_lshlrev_b32 v160, 16, v168
    v_and_b32 v161, 0xffff0000, v168
    v_lshlrev_b32 v162, 16, v169
    v_and_b32 v163, 0xffff0000, v169
    v_lshlrev_b32 v164, 16, v170
    v_and_b32 v165, 0xffff0000, v170
    v_lshlrev_b32 v166, 16, v171
    v_and_b32 v167, 0xffff0000, v171
    v_lshlrev_b32 v168, 16, v172
    v_and_b32 v169, 0xffff0000, v172
    v_lshlrev_b32 v170, 16, v173
    v_and_b32 v171, 0xffff0000, v173
    v_lshlrev_b32 v172, 16, v174
    v_and_b32 v173, 0xffff0000, v174
    v_lshlrev_b32 v174, 16, v175
    v_and_b32 v175, 0xffff0000, v175
K2_NOWRAW:
K2_PAD_NW:
    s_cbranch_execz KS_HOP
    v_lshrrev_b32 v179, 2, v181
    v_lshrrev_b32 v185, 2, v182
    v_lshrrev_b32 v186, 2, v183
    v_lshrrev_b32 v187, 2, v184
    s_mov_b32 s66, 7340032
    v_mov_b32 v201, 1
    s_movk_i32 s58, 520
    s_movk_i32 s59, 2080
    s_mov_b32 s60, 0x40000
    s_mov_b32 s61, 0xffff
    v_mov_b32 v202, 65536
    s_cmp_lg_u32 s24, 0
    s_cbranch_scc1 K2_RK_LOAD
    v_cmp_lt_i32 vcc, 20, v180
    s_nop 0
    s_cbranch_vccz K2_NOMORE
    v_mov_b32 v61, 163300
    ds_write_b32 v61, v201
K2_NOMORE:
    s_mov_b32 s62, 82176
    s_cmp_eq_u32 s65, 0
    s_waitcnt vmcnt(3)
    s_cbranch_scc0 K2_ARR
    s_waitcnt vmcnt(0)
K2_ARR:
    s_mov_b64 exec, s[40:41]
    s_cbranch_execz K2_RK_A
K2_CK0:
    v_bfi_b32 v192, s61, v1, v2
    v_lshrrev_b32 v50, 24, v3
    v_cmp_ne_u32 vcc, s2, v192
    v_add_u32 v40, 163072, v50
    s_cbranch_vccnz K2_RT0
    ds_add_rtn_u32 v40, v40, v201
    v_mad_u32_u24 v50, v50, s58, v202
    s_mov_b64 exec, s[42:43]
    s_cbranch_execz K2_RK_A
    s_waitcnt vmcnt(2)
K2_CK1:
    v_bfi_b32 v192, s61, v5, v6
    v_lshrrev_b32 v51, 24, v7
    v_cmp_ne_u32 vcc, s2, v192
    v_add_u32 v41, 163072, v51
    s_cbranch_vccnz K2_RT1
    ds_add_rtn_u32 v41, v41, v201
    v_mad_u32_u24 v51, v51, s58, v202
    s_mov_b64 exec, s[44:45]
    s_cbranch_execz K2_RK_A
    s_waitcnt vmcnt(1)
K2_CK2:
    v_bfi_b32 v192, s61, v9, v10
    v_lshrrev_b32 v52, 24, v11
    v_cmp_ne_u32 vcc, s2, v192
    v_add_u32 v42, 163072, v52
    s_cbranch_vccnz K2_RT2
    ds_add_rtn_u32 v42, v42, v201
    v_mad_u32_u24 v52, v52, s58, v202
    s_mov_b64 exec, s[46:47]
    s_cbranch_execz K2_RK_A
    s_waitcnt vmcnt(0)
K2_CK3:
    v_bfi_b32 v192, s61, v13, v14
    v_lshrrev_b32 v53, 24, v15
    v_cmp_ne_u32 vcc, s2, v192
    v_add_u32 v43, 163072, v53
    s_cbranch_vccnz K2_RT3
    ds_add_rtn_u32 v43, v43, v201
    v_mad_u32_u24 v53, v53, s58, v202
    s_mov_b64 exec, s[48:49]
    s_cbranch_execz K2_RK_A
K2_CK4:
    v_bfi_b32 v192, s61, v17, v18
    v_lshrrev_b32 v54, 24, v19
    v_cmp_ne_u32 vcc, s2, v192
    v_add_u32 v44, 163072, v54
    s_cbranch_vccnz K2_RT4
    ds_add_rtn_u32 v44, v44, v201
    v_mad_u32_u24 v54, v54, s58, v202
    s_mov_b64 exec, s[50:51]
    s_cbranch_execz K2_RK_A
K2_CK5:
    v_bfi_b32 v192, s61, v21, v22
    v_lshrrev_b32 v55, 24, v23
    v_cmp_ne_u32 vcc, s2, v192
    v_add_u32 v45, 163072, v55
    s_cbranch_vccnz K2_RT5
    ds_add_rtn_u32 v45, v45, v201
    v_mad_u32_u24 v55, v55, s58, v202
    s_mov_b64 exec, s[90:91]
    s_cbranch_execz K2_RK_A
K2_CK6:
    v_bfi_b32 v192, s61, v25, v26
    v_lshrrev_b32 v56, 24, v27
    v_cmp_ne_u32 vcc, s2, v192
    v_add_u32 v46, 163072, v56
    s_cbranch_vccnz K2_RT6
    ds_add_rtn_u32 v46, v46, v201
    v_mad_u32_u24 v56, v56, s58, v202
    s_mov_b64 exec, s[92:93]
    s_cbranch_execz K2_RK_A
K2_CK7:
    v_bfi_b32 v192, s61, v29, v30
    v_lshrrev_b32 v57, 24, v31
    v_cmp_ne_u32 vcc, s2, v192
    v_add_u32 v47, 163072, v57
    s_cbranch_vccnz K2_RT7
    ds_add_rtn_u32 v47, v47, v201
    v_mad_u32_u24 v57, v57, s58, v202
    s_mov_b64 exec, s[94:95]
    s_cbranch_execz K2_RK_A
K2_CK8:
    v_bfi_b32 v192, s61, v33, v34
    v_lshrrev_b32 v58, 24, v35
    v_cmp_ne_u32 vcc, s2, v192
    v_add_u32 v48, 163072, v58
    s_cbranch_vccnz K2_RT8
    ds_add_rtn_u32 v48, v48, v201
    v_mad_u32_u24 v58, v58, s58, v202
    s_mov_b64 exec, s[96:97]
    s_cbranch_execz K2_RK_A
K2_CK9:
    v_bfi_b32 v192, s61, v37, v38
    v_lshrrev_b32 v59, 24, v39
    v_cmp_ne_u32 vcc, s2, v192
    v_add_u32 v49, 163072, v59
    s_cbranch_vccnz K2_RT9
    ds_add_rtn_u32 v49, v49, v201
    v_mad_u32_u24 v59, v59, s58, v202
K2_RK_A:
    s_mov_b64 exec, -1
    s_mov_b64 exec, s[40:41]
    s_cbranch_execz K2_TP
    v_cmp_gt_u32 vcc, s62, v50
    v_and_b32 v3, 0xffffff, v3
    s_mov_b64 exec, vcc
    buffer_load_dword v245, v3, s[16:19], 0 offen
    s_mov_b64 exec, s[42:43]
    s_cbranch_execz K2_TP
    v_cmp_gt_u32 vcc, s62, v51
    v_and_b32 v7, 0xffffff, v7
    s_mov_b64 exec, vcc
    buffer_load_dword v245, v7, s[16:19], 0 offen
    s_mov_b64 exec, s[44:45]
    s_cbranch_execz K2_TP
    v_cmp_gt_u32 vcc, s62, v52
    v_and_b32 v11, 0xffffff, v11
    s_mov_b64 exec, vcc
    buffer_load_dword v245, v11, s[16:19], 0 offen
    s_mov_b64 exec, s[46:47]
    s_cbranch_execz K2_TP
    v_cmp_gt_u32 vcc, s62, v53
    v_and_b32 v15, 0xffffff, v15
    s_mov_b64 exec, vcc
    buffer_load_dword v245, v15, s[16:19], 0 offen
    s_mov_b64 exec, s[48:49]
    s_cbranch_execz K2_TP
    v_cmp_gt_u32 vcc, s62, v54
    v_and_b32 v19, 0xffffff, v19
    s_mov_b64 exec, vcc
    buffer_load_dword v245, v19, s[16:19], 0 offen
    s_mov_b64 exec, s[50:51]
    s_cbranch_execz K2_TP
    v_cmp_gt_u32 vcc, s62, v55
    v_and_b32 v23, 0xffffff, v23
    s_mov_b64 exec, vcc
    buffer_load_dword v245, v23, s[16:19], 0 offen
    s_mov_b64 exec, s[90:91]
    s_cbranch_execz K2_TP
    v_cmp_gt_u32 vcc, s62, v56
    v_and_b32 v27, 0xffffff, v27
    s_mov_b64 exec, vcc
    buffer_load_dword v245, v27, s[16:19], 0 offen
    s_mov_b64 exec, s[92:93]
    s_cbranch_execz K2_TP
    v_cmp_gt_u32 vcc, s62, v57
    v_and_b32 v31, 0xffffff, v31
    s_mov_b64 exec, vcc
    buffer_load_dword v245, v31, s[16:19], 0 offen
    s_mov_b64 exec, s[94:95]
    s_cbranch_execz K2_TP
    v_cmp_gt_u32 vcc, s62, v58
    v_and_b32 v35, 0xffffff, v35
    s_mov_b64 exec, vcc
    buffer_load_dword v245, v35, s[16:19], 0 offen
    s_mov_b64 exec, s[96:97]
    s_cbranch_execz K2_TP
    v_cmp_gt_u32 vcc, s62, v59
    v_and_b32 v39, 0xffffff, v39
    s_mov_b64 exec, vcc
    buffer_load_dword v245, v39, s[16:19], 0 offen
K2_TP:
    s_mov_b64 exec, -1
K2_RK_DONE:
K2_PAD_SC:
    s_cbranch_execz KS_HOP
    s_mul_i32 s67, s24, 48
    s_movk_i32 s58, -1532
    s_waitcnt lgkmcnt(0)
    s_mov_b64 exec, s[40:41]
    s_cbranch_execz K2_SC_DONE
    v_cmpx_gt_u32 vcc, 64, v40
    v_bfe_u32 v194, v40, 3, 1
    v_add_u32 v193, 16, v40
    v_lshl_or_b32 v194, v40, 1, v194
    v_bfi_b32 v194, 15, v194, v40
    v_lshrrev_b32 v193, 6, v193
    v_alignbit_b32 v1, v2, v1, 16
    v_lshl_add_u32 v195, v194, 3, v50
    v_lshl_add_u32 v194, v194, 5, v50
    ds_write_b64 v195, v[0:1]
    v_mad_i32_i24 v194, v193, s58, v194
    ds_write_b32 v194, v3 offset:512
    s_mov_b64 exec, s[42:43]
    s_cbranch_execz K2_SC_DONE
    v_cmpx_gt_u32 vcc, 64, v41
    v_bfe_u32 v194, v41, 3, 1
    v_add_u32 v193, 16, v41
    v_lshl_or_b32 v194, v41, 1, v194
    v_bfi_b32 v194, 15, v194, v41
    v_lshrrev_b32 v193, 6, v193
    v_alignbit_b32 v5, v6, v5, 16
    v_lshl_add_u32 v195, v194, 3, v51
    v_lshl_add_u32 v194, v194, 5, v51
    ds_write_b64 v195, v[4:5]
    v_mad_i32_i24 v194, v193, s58, v194
    ds_write_b32 v194, v7 offset:512
    s_mov_b64 exec, s[44:45]
    s_cbranch_execz K2_SC_DONE
    v_cmpx_gt_u32 vcc, 64, v42
    v_bfe_u32 v194, v42, 3, 1
    v_add_u32 v193, 16, v42
    v_lshl_or_b32 v194, v42, 1, v194
    v_bfi_b32 v194, 15, v194, v42
    v_lshrrev_b32 v193, 6, v193
    v_alignbit_b32 v9, v10, v9, 16
    v_lshl_add_u32 v195, v194, 3, v52
    v_lshl_add_u32 v194, v194, 5, v52
    ds_write_b64 v195, v[8:9]
    v_mad_i32_i24 v194, v193, s58, v194
    ds_write_b32 v194, v11 offset:512
    s_mov_b64 exec, s[46:47]
    s_cbranch_execz K2_SC_DONE
    v_cmpx_gt_u32 vcc, 64, v43
    v_bfe_u32 v194, v43, 3, 1
    v_add_u32 v193, 16, v43
    v_lshl_or_b32 v194, v43, 1, v194
    v_bfi_b32 v194, 15, v194, v43
    v_lshrrev_b32 v193, 6, v193
    v_alignbit_b32 v13, v14, v13, 16
    v_lshl_add_u32 v195, v194, 3, v53
    v_lshl_add_u32 v194, v194, 5, v53
    ds_write_b64 v195, v[12:13]
    v_mad_i32_i24 v194, v193, s58, v194
    ds_write_b32 v194, v15 offset:512
    s_mov_b64 exec, s[48:49]
    s_cbranch_execz K2_SC_DONE
    v_cmpx_gt_u32 vcc, 64, v44
    v_bfe_u32 v194, v44, 3, 1
    v_add_u32 v193, 16, v44
    v_lshl_or_b32 v194, v44, 1, v194
    v_bfi_b32 v194, 15, v194, v44
    v_lshrrev_b32 v193, 6, v193
    v_alignbit_b32 v17, v18, v17, 16
    v_lshl_add_u32 v195, v194, 3, v54
    v_lshl_add_u32 v194, v194, 5, v54
    ds_write_b64 v195, v[16:17]
    v_mad_i32_i24 v194, v193, s58, v194
    ds_write_b32 v194, v19 offset:512
    s_mov_b64 exec, s[50:51]
    s_cbranch_execz K2_SC_DONE
    v_cmpx_gt_u32 vcc, 64, v45
    v_bfe_u32 v194, v45, 3, 1
    v_add_u32 v193, 16, v45
    v_lshl_or_b32 v194, v45, 1, v194
    v_bfi_b32 v194, 15, v194, v45
    v_lshrrev_b32 v193, 6, v193
    v_alignbit_b32 v21, v22, v21, 16
    v_lshl_add_u32 v195, v194, 3, v55
    v_lshl_add_u32 v194, v194, 5, v55
    ds_write_b64 v195, v[20:21]
    v_mad_i32_i24 v194, v193, s58, v194
    ds_write_b32 v194, v23 offset:512
    s_mov_b64 exec, s[90:91]
    s_cbranch_execz K2_SC_DONE
    v_cmpx_gt_u32 vcc, 64, v46
    v_bfe_u32 v194, v46, 3, 1
    v_add_u32 v193, 16, v46
    v_lshl_or_b32 v194, v46, 1, v194
    v_bfi_b32 v194, 15, v194, v46
    v_lshrrev_b32 v193, 6, v193
    v_alignbit_b32 v25, v26, v25, 16
    v_lshl_add_u32 v195, v194, 3, v56
    v_lshl_add_u32 v194, v194, 5, v56
    ds_write_b64 v195, v[24:25]
    v_mad_i32_i24 v194, v193, s58, v194
    ds_write_b32 v194, v27 offset:512
    s_mov_b64 exec, s[92:93]
    s_cbranch_execz K2_SC_DONE
    v_cmpx_gt_u32 vcc, 64, v47
    v_bfe_u32 v194, v47, 3, 1
    v_add_u32 v193, 16, v47
    v_lshl_or_b32 v194, v47, 1, v194
    v_bfi_b32 v194, 15, v194, v47
    v_lshrrev_b32 v193, 6, v193
    v_alignbit_b32 v29, v30, v29, 16
    v_lshl_add_u32 v195, v194, 3, v57
    v_lshl_add_u32 v194, v194, 5, v57
    ds_write_b64 v195, v[28:29]
    v_mad_i32_i24 v194, v193, s58, v194
    ds_write_b32 v194, v31 offset:512
    s_mov_b64 exec, s[94:95]
    s_cbranch_execz K2_SC_DONE
    v_cmpx_gt_u32 vcc, 64, v48
    v_bfe_u32 v194, v48, 3, 1
    v_add_u32 v193, 16, v48
    v_lshl_or_b32 v194, v48, 1, v194
    v_bfi_b32 v194, 15, v194, v48
    v_lshrrev_b32 v193, 6, v193
    v_alignbit_b32 v33, v34, v33, 16
    v_lshl_add_u32 v195, v194, 3, v58
    v_lshl_add_u32 v194, v194, 5, v58
    ds_write_b64 v195, v[32:33]
    v_mad_i32_i24 v194, v193, s58, v194
    ds_write_b32 v194, v35 offset:512
    s_mov_b64 exec, s[96:97]
    s_cbranch_execz K2_SC_DONE
    v_cmpx_gt_u32 vcc, 64, v49
    v_bfe_u32 v194, v49, 3, 1
    v_add_u32 v193, 16, v49
    v_lshl_or_b32 v194, v49, 1, v194
    v_bfi_b32 v194, 15, v194, v49
    v_lshrrev_b32 v193, 6, v193
    v_alignbit_b32 v37, v38, v37, 16
    v_lshl_add_u32 v195, v194, 3, v59
    v_lshl_add_u32 v194, v194, 5, v59
    ds_write_b64 v195, v[36:37]
    v_mad_i32_i24 v194, v193, s58, v194
    ds_write_b32 v194, v39 offset:512
K2_SC_DONE:
    s_mov_b64 exec, -1
K2_PAD_SD:
    s_cbranch_execz KS_HOP
    v_lshlrev_b32 v192, 2, v176
    v_add_u32 v192, 163072, v192
    v_mov_b32 v200, 163300
    s_cmp_eq_u32 s24, 0
    s_cselect_b32 s26, 64, 48
    s_waitcnt lgkmcnt(0)
    s_barrier
    ds_read_b32 v193, v192
    ds_read_b32 v200, v200
    v_cmp_gt_u32 s[56:57], s22, v176
    v_mad_u32_u24 v195, v176, s59, v202
    s_waitcnt lgkmcnt(0)
    v_cndmask_b32 v193, 0, v193, s[56:57]
    v_readfirstlane_b32 s27, v200
    v_cmp_lt_u32 s[62:63], 48, v193
    v_cmp_lt_u32 vcc, 64, v193
    s_bcnt1_i32_b64 s60, s[62:63]
    v_mbcnt_lo_u32_b32 v198, s62, 0
    v_mbcnt_hi_u32_b32 v198, s63, v198
    s_cbranch_vccnz K2_BIG
    s_cmp_gt_u32 s60, 8
    s_cbranch_scc1 K2_BIG
K2_TOK:
    v_subrev_u32 v194, s67, v193
    v_max_i32 v194, 1, v194
    v_min_i32 v194, s26, v194
    v_add_u32 v194, 15, v194
    v_lshrrev_b32 v194, 3, v194
    v_lshl_or_b32 v195, v194, 18, v195
    v_lshl_or_b32 v195, v198, 27, v195
    v_mov_b32 v197, 949760
    v_cndmask_b32 v253, v197, v195, s[56:57]
    s_movk_i32 s40, 0
    s_movk_i32 s41, 256
    s_movk_i32 s42, 512
    s_movk_i32 s43, 768
    s_add_u32 s24, s24, 1
    s_cmp_ge_u32 s24, s25
    s_cselect_b32 s55, 1, 0
    s_cmp_eq_u32 s27, 0
    s_cselect_b32 s55, s55, 0
    s_mov_b32 s27, 0x400000
    s_mov_b32 s38, 0
    s_mov_b32 s34, 0
    s_mov_b32 s35, 0
    s_mov_b32 s36, 1
    s_mov_b32 s31, 0
    s_mov_b32 s58, s20
    v_readlane_b32 s3, v253, s58
    s_lshl_b32 s44, s34, 7
    s_and_b32 s48, s3, 0x3ffff
    s_bfe_u32 s33, s3, 0x30013
    s_mul_i32 s35, s38, 6
    s_cmp_eq_u32 s34, 0
    s_cselect_b32 s35, s35, s48
    s_mov_b32 s45, s44
    s_xor_b32 s47, s44, 256
    s_add_u32 s49, s48, 128
    s_add_u32 s60, s48, 256
    s_cmp_eq_u32 s33, 3
    s_cselect_b32 s46, s44, s47
    s_cselect_b32 s50, s60, s48
    s_cselect_b32 s51, s48, s49
    s_sub_u32 s60, s33, 2
    s_cmp_lt_u32 s60, 2
    s_cbranch_scc0 K2_rare_1
K2_back_2:
    v_add_u32 v233, s48, v230
    ds_read_b32 v232, v233
    ds_read_b32 v233, v233 offset:1024
    v_add_u32 v222, s48, v251
    ds_read2_b32 v[222:223], v222 offset0:1 offset1:3
    v_add_u32 v224, s49, v251
    ds_read2_b32 v[224:225], v224 offset0:1 offset1:3
    v_add_u32 v226, s50, v251
    ds_read2_b32 v[226:227], v226 offset0:1 offset1:3
    v_add_u32 v228, s51, v251
    ds_read2_b32 v[228:229], v228 offset0:1 offset1:3
    s_waitcnt lgkmcnt(4)
    v_or_b32 v232, v232, v231
    v_or_b32 v233, v233, v231
    s_cmp_lg_u32 s34, 0
    s_cbranch_scc1 K2_dum_4
    s_cmp_eq_u32 s33, 4
    s_cbranch_scc1 K2_a4_5
K2_b4_7:
    s_add_u32 m0, s48, 512
    s_add_u32 s65, s48, 1536
    buffer_load_dwordx4 v232, s[16:19], 0 offen  lds
    s_mov_b32 m0, s65
    s_mov_b32 exec_hi, 0
    buffer_load_dwordx4 v233, s[16:19], 0 offen  lds
    s_mov_b32 exec_hi, -1
K2_back_6:
    s_waitcnt lgkmcnt(3)
    v_mad_u32_u16 v222, v222, s39, v248 op_sel:[1,0,0,0]
    v_mad_u32_u16 v223, v223, s39, v248 op_sel:[1,0,0,0]
    s_waitcnt lgkmcnt(2)
    v_mad_u32_u16 v224, v224, s39, v248 op_sel:[1,0,0,0]
    v_mad_u32_u16 v225, v225, s39, v248 op_sel:[1,0,0,0]
    s_waitcnt lgkmcnt(1)
    v_mad_u32_u16 v226, v226, s39, v248 op_sel:[1,0,0,0]
    v_mad_u32_u16 v227, v227, s39, v248 op_sel:[1,0,0,0]
    s_waitcnt lgkmcnt(0)
    v_mad_u32_u16 v228, v228, s39, v248 op_sel:[1,0,0,0]
    v_mad_u32_u16 v229, v229, s39, v248 op_sel:[1,0,0,0]
    s_mov_b32 m0, s68
    s_nop 0
    buffer_load_dwordx4 v222, s[4:7], s44 offen sc1 lds
    buffer_load_dwordx4 v223, s[72:75], s44 offen offset:1024 sc1 lds
    s_mov_b32 m0, s69
    s_nop 0
    buffer_load_dwordx4 v224, s[4:7], s45 offen sc1 lds
    buffer_load_dwordx4 v225, s[72:75], s45 offen offset:1024 sc1 lds
    s_mov_b32 m0, s70
    s_nop 0
    buffer_load_dwordx4 v226, s[4:7], s46 offen sc1 lds
    buffer_load_dwordx4 v227, s[72:75], s46 offen offset:1024 sc1 lds
    s_mov_b32 m0, s71
    s_nop 0
    buffer_load_dwordx4 v228, s[4:7], s47 offen sc1 lds
    buffer_load_dwordx4 v229, s[72:75], s47 offen offset:1024 sc1 lds
    v_add_u32 v249, s48, v249
    v_add_u32 v250, s48, v250
    s_waitcnt vmcnt(6)
    ds_read_b64_tr_b16 v[176:177], v246 offset:0
    ds_read_b64_tr_b16 v[178:179], v246 offset:1024
    ds_read_b64_tr_b16 v[180:181], v247 offset:0
    ds_read_b64_tr_b16 v[182:183], v247 offset:1024
    ds_read_b64_tr_b16 v[0:1], v249 offset:0
    ds_read_b64_tr_b16 v[2:3], v249 offset:32
    ds_read_u16_d16_hi v16, v250 offset:0
    ds_read_b64_tr_b16 v[4:5], v249 offset:512
    ds_read_b64_tr_b16 v[6:7], v249 offset:544
    ds_read_u16_d16_hi v17, v250 offset:128
    s_mov_b32 s29, s48
    s_mov_b32 s32, s31
    s_mov_b32 s30, s3
    s_mov_b32 s31, s35
    s_bfe_u32 s56, s3, 0x40012
    s_cmp_eq_u32 s56, 5
    s_cbranch_scc1 K2_U20
    s_cmp_eq_u32 s56, 6
    s_cbranch_scc1 K2_U3h0
    s_branch K2_DSP0
K2_PAD_H1:
    s_branch KS_HOP0
KS_HELP:
    s_mov_b32 s30, 0
    s_cmp_eq_u32 s20, 6
    s_cbranch_scc1 KS_RAW
    s_mov_b32 s30, 2
    s_cmp_ge_u32 s2, 170
    s_cbranch_scc1 KS_NOW
    s_mov_b32 s30, 1
    v_and_b32 v1, 15, v8
    v_lshrrev_b32 v3, 4, v8
    s_cmp_ge_u32 s2, 160
    s_cbranch_scc1 K1_WT
    s_cmp_ge_u32 s2, 64
    s_cbranch_scc1 K1_S1
    s_lshr_b32 s24, s2, 3
    s_and_b32 s25, s2, 7
    s_lshr_b32 s26, s25, 2
    s_bfe_u32 s27, s25, 0x10001
    s_and_b32 s28, s25, 1
    s_mov_b32 s60, s92
    s_and_b32 s61, s93, 0xffff
    s_mov_b32 s62, 65536
    s_mov_b32 s63, 0x20000
    s_branch K1_SC
K1_S1:
    s_sub_u32 s29, s2, 64
    s_mul_i32 s24, s29, 43
    s_lshr_b32 s24, s24, 9
    s_mul_i32 s25, s24, 12
    s_sub_u32 s25, s29, s25
    s_cmp_ge_u32 s25, 6
    s_cselect_b32 s26, 1, 0
    s_mul_i32 s27, s26, 6
    s_sub_u32 s27, s25, s27
    s_lshr_b32 s27, s27, 1
    s_and_b32 s28, s25, 1
    s_add_u32 s25, s25, 8
    s_mov_b32 s60, s94
    s_and_b32 s61, s95, 0xffff
    s_mov_b32 s62, 98304
    s_mov_b32 s63, 0x20000
K1_SC:
    s_lshl_b32 s27, s27, 7
    s_lshl_b32 s26, s26, 6
    s_lshl_b32 s28, s28, 4
    s_add_u32 s27, s27, s26
    s_add_u32 s27, s27, s28
    s_lshl_b32 s27, s27, 8
    s_lshl_b32 s26, s24, 5
    s_add_u32 s27, s27, s26
    s_add_u32 s29, s27, 8192
    v_lshlrev_b32 v3, 10, v3
    v_lshl_add_u32 v3, v1, 1, v3
    buffer_load_ushort v64, v3, s[60:63], s27 offen offset:0
    buffer_load_ushort v65, v3, s[60:63], s29 offen offset:0
    buffer_load_ushort v66, v3, s[60:63], s27 offen offset:256
    buffer_load_ushort v67, v3, s[60:63], s29 offen offset:256
    buffer_load_ushort v68, v3, s[60:63], s27 offen offset:512
    buffer_load_ushort v69, v3, s[60:63], s29 offen offset:512
    buffer_load_ushort v70, v3, s[60:63], s27 offen offset:768
    buffer_load_ushort v71, v3, s[60:63], s29 offen offset:768
    s_mul_i32 s24, s24, 20
    s_add_u32 s24, s24, s25
    s_lshl_b32 s24, s24, 10
    s_add_u32 s24, s24, 6946816
    s_branch K1_GO
K1_WT:
    s_sub_u32 s24, s2, 160
    s_lshr_b32 s27, s24, 1
    s_and_b32 s28, s24, 1
    s_lshl_b32 s27, s27, 8
    s_lshl_b32 s28, s28, 6
    s_add_u32 s27, s27, s28
    s_add_u32 s29, s27, 10240
    s_mov_b32 s60, s90
    s_and_b32 s61, s91, 0xffff
    s_mov_b32 s62, 20480
    s_mov_b32 s63, 0x20000
    v_and_b32 v1, 31, v8
    v_lshrrev_b32 v3, 5, v8
    v_mul_u32_u24 v3, 5120, v3
    v_lshl_add_u32 v3, v1, 1, v3
    buffer_load_ushort v64, v3, s[60:63], s27 offen offset:0
    buffer_load_ushort v65, v3, s[60:63], s27 offen offset:1280
    buffer_load_ushort v66, v3, s[60:63], s27 offen offset:2560
    buffer_load_ushort v67, v3, s[60:63], s27 offen offset:3840
    buffer_load_ushort v68, v3, s[60:63], s29 offen offset:0
    buffer_load_ushort v69, v3, s[60:63], s29 offen offset:1280
    buffer_load_ushort v70, v3, s[60:63], s29 offen offset:2560
    buffer_load_ushort v71, v3, s[60:63], s29 offen offset:3840
    s_lshl_b32 s24, s24, 10
    s_add_u32 s24, s24, 7110656
K1_GO:
KS_NOW:
    s_barrier
K2_PAD_H2:
    s_cbranch_execz KS_HOP0
    v_and_b32 v76, 31, v8
    v_lshrrev_b32 v77, 5, v8
    v_mov_b32 v80, 0
    v_mul_u32_u24 v77, 2080, v77
    v_mov_b32 v81, 0xffff0000
    v_lshl_add_u32 v78, v76, 4, v77
    v_mov_b32 v82, 0
    v_add_u32 v78, 65536, v78
    v_mov_b32 v83, v81
    v_add_u32 v79, 41600, v78
    ds_write_b128 v78, v[80:83] offset:0
    ds_write_b128 v78, v[80:83] offset:4160
    ds_write_b128 v78, v[80:83] offset:8320
    ds_write_b128 v78, v[80:83] offset:12480
    ds_write_b128 v78, v[80:83] offset:16640
    ds_write_b128 v78, v[80:83] offset:20800
    ds_write_b128 v78, v[80:83] offset:24960
    ds_write_b128 v78, v[80:83] offset:29120
    ds_write_b128 v78, v[80:83] offset:33280
    ds_write_b128 v78, v[80:83] offset:37440
    ds_write_b128 v79, v[80:83] offset:0
    ds_write_b128 v79, v[80:83] offset:4160
    ds_write_b128 v79, v[80:83] offset:8320
    ds_write_b128 v79, v[80:83] offset:12480
    ds_write_b128 v79, v[80:83] offset:16640
    ds_write_b128 v79, v[80:83] offset:20800
    ds_write_b128 v79, v[80:83] offset:24960
    ds_write_b128 v79, v[80:83] offset:29120
    ds_write_b128 v79, v[80:83] offset:33280
    ds_write_b128 v79, v[80:83] offset:37440
KS_FILL:
    v_mov_b32 v59, 163456
    s_barrier
    ds_read_b32 v59, v59
    s_waitcnt vmcnt(0) lgkmcnt(0)
    s_cmp_eq_u32 s30, 0
    s_cbranch_scc1 KS_B3
    s_cmp_eq_u32 s30, 2
    s_cbranch_scc1 KS_NOST
    v_lshl_or_b32 v40, v65, 16, v64
    v_lshl_or_b32 v41, v67, 16, v66
    v_lshl_or_b32 v42, v69, 16, v68
    v_lshl_or_b32 v43, v71, 16, v70
    buffer_store_dwordx4 v[40:43], v9, s[8:11], s24 offen sc1
KS_NOST:
    s_waitcnt lgkmcnt(0)
    s_barrier
    s_lshl_b32 s24, s2, 2
    s_add_u32 s24, s24, 7176192
    s_mov_b64 exec, 1
    s_waitcnt vmcnt(0)
    buffer_store_dword v59, v6, s[8:11], s24 offen sc1
    s_mov_b64 exec, -1
    s_branch KS_JOIN
K2_PAD_H3:
    s_branch KS_HOP0
KS_RAW:
    s_barrier
    s_mov_b32 s60, s90
    s_and_b32 s61, s91, 0xffff
    s_mov_b32 s62, 20480
    s_mov_b32 s63, 0x20000
    v_lshrrev_b32 v10, 3, v8
    v_and_b32 v11, 7, v8
    v_lshlrev_b32 v10, 8, v10
    v_lshl_add_u32 v10, v11, 4, v10
    s_mov_b32 m0, 24576
    s_movk_i32 s24, 0
    buffer_load_dwordx4 v10, s[60:63], s24 offen lds
    s_mov_b32 m0, 25600
    s_movk_i32 s24, 2048
    buffer_load_dwordx4 v10, s[60:63], s24 offen lds
    s_mov_b32 m0, 26624
    s_movk_i32 s24, 4096
    buffer_load_dwordx4 v10, s[60:63], s24 offen lds
    s_mov_b32 m0, 27648
    s_movk_i32 s24, 6144
    buffer_load_dwordx4 v10, s[60:63], s24 offen lds
    s_mov_b32 m0, 28672
    s_movk_i32 s24, 8192
    buffer_load_dwordx4 v10, s[60:63], s24 offen lds
    s_mov_b32 m0, 29696
    s_movk_i32 s24, 10240
    buffer_load_dwordx4 v10, s[60:63], s24 offen lds
    s_mov_b32 m0, 30720
    s_movk_i32 s24, 12288
    buffer_load_dwordx4 v10, s[60:63], s24 offen lds
    s_mov_b32 m0, 31744
    s_movk_i32 s24, 14336
    buffer_load_dwordx4 v10, s[60:63], s24 offen lds
    s_mov_b32 m0, 32768
    s_movk_i32 s24, 16384
    buffer_load_dwordx4 v10, s[60:63], s24 offen lds
    s_mov_b32 m0, 33792
    s_movk_i32 s24, 18432
    buffer_load_dwordx4 v10, s[60:63], s24 offen lds
    s_mov_b32 m0, 152832
    s_movk_i32 s24, 128
    buffer_load_dwordx4 v10, s[60:63], s24 offen lds
    s_mov_b32 m0, 153856
    s_movk_i32 s24, 2176
    buffer_load_dwordx4 v10, s[60:63], s24 offen lds
    s_mov_b32 m0, 154880
    s_movk_i32 s24, 4224
    buffer_load_dwordx4 v10, s[60:63], s24 offen lds
    s_mov_b32 m0, 155904
    s_movk_i32 s24, 6272
    buffer_load_dwordx4 v10, s[60:63], s24 offen lds
    s_mov_b32 m0, 156928
    s_movk_i32 s24, 8320
    buffer_load_dwordx4 v10, s[60:63], s24 offen lds
    s_mov_b32 m0, 157952
    s_movk_i32 s24, 10368
    buffer_load_dwordx4 v10, s[60:63], s24 offen lds
    s_mov_b32 m0, 158976
    s_movk_i32 s24, 12416
    buffer_load_dwordx4 v10, s[60:63], s24 offen lds
    s_mov_b32 m0, 160000
    s_movk_i32 s24, 14464
    buffer_load_dwordx4 v10, s[60:63], s24 offen lds
    s_mov_b32 m0, 161024
    s_movk_i32 s24, 16512
    buffer_load_dwordx4 v10, s[60:63], s24 offen lds
    s_mov_b32 m0, 162048
    s_movk_i32 s24, 18560
    buffer_load_dwordx4 v10, s[60:63], s24 offen lds
    v_add_u32 v85, 16, v8
    v_lshlrev_b32 v84, 5, v8
    v_lshrrev_b32 v85, 6, v85
    v_mul_u32_u24 v85, 1532, v85
    v_sub_u32 v84, v84, v85
    v_mov_b32 v85, -1
    v_add_u32 v84, 66048, v84
    v_add_u32 v86, 41600, v84
    ds_write_b32 v84, v85 offset:0
    ds_write_b32 v84, v85 offset:2080
    ds_write_b32 v84, v85 offset:4160
    ds_write_b32 v84, v85 offset:6240
    ds_write_b32 v84, v85 offset:8320
    ds_write_b32 v84, v85 offset:10400
    ds_write_b32 v84, v85 offset:12480
    ds_write_b32 v84, v85 offset:14560
    ds_write_b32 v84, v85 offset:16640
    ds_write_b32 v84, v85 offset:18720
    ds_write_b32 v84, v85 offset:20800
    ds_write_b32 v84, v85 offset:22880
    ds_write_b32 v84, v85 offset:24960
    ds_write_b32 v84, v85 offset:27040
    ds_write_b32 v84, v85 offset:29120
    ds_write_b32 v84, v85 offset:31200
    ds_write_b32 v84, v85 offset:33280
    ds_write_b32 v84, v85 offset:35360
    ds_write_b32 v84, v85 offset:37440
    ds_write_b32 v84, v85 offset:39520
    ds_write_b32 v86, v85 offset:0
    ds_write_b32 v86, v85 offset:2080
    ds_write_b32 v86, v85 offset:4160
    ds_write_b32 v86, v85 offset:6240
    ds_write_b32 v86, v85 offset:8320
    ds_write_b32 v86, v85 offset:10400
    ds_write_b32 v86, v85 offset:12480
    ds_write_b32 v86, v85 offset:14560
    ds_write_b32 v86, v85 offset:16640
    ds_write_b32 v86, v85 offset:18720
    ds_write_b32 v86, v85 offset:20800
    ds_write_b32 v86, v85 offset:22880
    ds_write_b32 v86, v85 offset:24960
    ds_write_b32 v86, v85 offset:27040
    ds_write_b32 v86, v85 offset:29120
    ds_write_b32 v86, v85 offset:31200
    ds_write_b32 v86, v85 offset:33280
    ds_write_b32 v86, v85 offset:35360
    ds_write_b32 v86, v85 offset:37440
    ds_write_b32 v86, v85 offset:39520
    s_branch KS_FILL
KS_IDLE:
    s_barrier
    s_barrier
    s_branch KS_B3
K2_PAD_U20:
    s_branch K2_HOP
K2_U20:
    s_setprio 1
    s_waitcnt lgkmcnt(0)
    v_lshlrev_b32 v20, 16, v0
    v_and_b32 v21, 0xffff0000, v0
    v_lshlrev_b32 v22, 16, v1
    v_and_b32 v23, 0xffff0000, v1
    v_lshlrev_b32 v24, 16, v2
    v_and_b32 v25, 0xffff0000, v2
    v_lshlrev_b32 v26, 16, v3
    v_and_b32 v27, 0xffff0000, v3
    v_mul_f32_dpp v36, v16, v20 row_newbcast:8 row_mask:0xf bank_mask:0xf
    v_mul_f32_dpp v37, v16, v21 row_newbcast:9 row_mask:0xf bank_mask:0xf
    v_mul_f32_dpp v38, v16, v22 row_newbcast:10 row_mask:0xf bank_mask:0xf
    v_mul_f32_dpp v39, v16, v23 row_newbcast:11 row_mask:0xf bank_mask:0xf
    v_mul_f32_dpp v40, v16, v24 row_newbcast:12 row_mask:0xf bank_mask:0xf
    v_mul_f32_dpp v41, v16, v25 row_newbcast:13 row_mask:0xf bank_mask:0xf
    v_mul_f32_dpp v42, v16, v26 row_newbcast:14 row_mask:0xf bank_mask:0xf
    v_mul_f32_dpp v43, v16, v27 row_newbcast:15 row_mask:0xf bank_mask:0xf
    v_cvt_pk_bf16_f32 v68, v36, v37
    v_cvt_pk_bf16_f32 v69, v38, v39
    v_cvt_pk_bf16_f32 v70, v40, v41
    v_cvt_pk_bf16_f32 v71, v42, v43
    v_mul_f32_dpp v20, v16, v20 row_newbcast:0 row_mask:0xa bank_mask:0xf
    v_mul_f32_dpp v21, v16, v21 row_newbcast:1 row_mask:0xa bank_mask:0xf
    v_mul_f32_dpp v22, v16, v22 row_newbcast:2 row_mask:0xa bank_mask:0xf
    v_mul_f32_dpp v23, v16, v23 row_newbcast:3 row_mask:0xa bank_mask:0xf
    v_mul_f32_dpp v24, v16, v24 row_newbcast:4 row_mask:0xa bank_mask:0xf
    v_mul_f32_dpp v25, v16, v25 row_newbcast:5 row_mask:0xa bank_mask:0xf
    v_mul_f32_dpp v26, v16, v26 row_newbcast:6 row_mask:0xa bank_mask:0xf
    v_mul_f32_dpp v27, v16, v27 row_newbcast:7 row_mask:0xa bank_mask:0xf
    v_cvt_pk_bf16_f32 v64, v20, v21
    v_cvt_pk_bf16_f32 v65, v22, v23
    v_cvt_pk_bf16_f32 v66, v24, v25
    v_cvt_pk_bf16_f32 v67, v26, v27
    v_lshlrev_b32 v28, 16, v4
    v_and_b32 v29, 0xffff0000, v4
    v_lshlrev_b32 v30, 16, v5
    v_and_b32 v31, 0xffff0000, v5
    v_lshlrev_b32 v32, 16, v6
    v_and_b32 v33, 0xffff0000, v6
    v_lshlrev_b32 v34, 16, v7
    v_and_b32 v35, 0xffff0000, v7
    v_mul_f32_dpp v36, v17, v28 row_newbcast:8 row_mask:0xf bank_mask:0xf
    v_mul_f32_dpp v37, v17, v29 row_newbcast:9 row_mask:0xf bank_mask:0xf
    v_mul_f32_dpp v38, v17, v30 row_newbcast:10 row_mask:0xf bank_mask:0xf
    v_mul_f32_dpp v39, v17, v31 row_newbcast:11 row_mask:0xf bank_mask:0xf
    v_mul_f32_dpp v40, v17, v32 row_newbcast:12 row_mask:0xf bank_mask:0xf
    v_mul_f32_dpp v41, v17, v33 row_newbcast:13 row_mask:0xf bank_mask:0xf
    v_mul_f32_dpp v42, v17, v34 row_newbcast:14 row_mask:0xf bank_mask:0xf
    v_mul_f32_dpp v43, v17, v35 row_newbcast:15 row_mask:0xf bank_mask:0xf
    v_cvt_pk_bf16_f32 v76, v36, v37
    v_cvt_pk_bf16_f32 v77, v38, v39
    v_cvt_pk_bf16_f32 v78, v40, v41
    v_cvt_pk_bf16_f32 v79, v42, v43
    v_mul_f32_dpp v28, v17, v28 row_newbcast:0 row_mask:0xa bank_mask:0xf
    v_mul_f32_dpp v29, v17, v29 row_newbcast:1 row_mask:0xa bank_mask:0xf
    v_mul_f32_dpp v30, v17, v30 row_newbcast:2 row_mask:0xa bank_mask:0xf
    v_mul_f32_dpp v31, v17, v31 row_newbcast:3 row_mask:0xa bank_mask:0xf
    v_mul_f32_dpp v32, v17, v32 row_newbcast:4 row_mask:0xa bank_mask:0xf
    v_mul_f32_dpp v33, v17, v33 row_newbcast:5 row_mask:0xa bank_mask:0xf
    v_mul_f32_dpp v34, v17, v34 row_newbcast:6 row_mask:0xa bank_mask:0xf
    v_mul_f32_dpp v35, v17, v35 row_newbcast:7 row_mask:0xa bank_mask:0xf
    v_cvt_pk_bf16_f32 v72, v28, v29
    v_cvt_pk_bf16_f32 v73, v30, v31
    v_cvt_pk_bf16_f32 v74, v32, v33
    v_cvt_pk_bf16_f32 v75, v34, v35
    s_waitcnt vmcnt(4)
    v_mfma_f32_32x32x16_bf16 v[0:15], v[64:67], v[176:179], 0
    ds_read_b64_tr_b16 v[184:185], v246 offset:2048
    ds_read_b64_tr_b16 v[186:187], v246 offset:3072
    ds_read_b64_tr_b16 v[188:189], v247 offset:2048
    ds_read_b64_tr_b16 v[190:191], v247 offset:3072
    s_mov_b32 m0, s68
    v_mfma_f32_32x32x16_bf16 v[16:31], v[68:71], v[176:179], 0
    buffer_load_dwordx4 v222, s[4:7], s42 offen sc1 lds
    buffer_load_dwordx4 v223, s[72:75], s42 offen offset:1024 sc1 lds
    v_permlane32_swap_b32 v242, v236
    v_permlane32_swap_b32 v243, v237
    s_add_u32 s38, s38, 1
    v_mfma_f32_32x32x16_bf16 v[32:47], v[64:67], v[180:183], 0
    v_permlane32_swap_b32 v244, v238
    v_permlane32_swap_b32 v245, v239
    v_permlane32_swap_b32 v240, v241
    v_add_f32 v242, v242, v236
    v_mfma_f32_32x32x16_bf16 v[48:63], v[68:71], v[180:183], 0
    v_add_f32 v243, v243, v237
    v_add_f32 v244, v244, v238
    v_add_f32 v245, v245, v239
    v_add_f32 v240, -v240, -v241
    v_mov_b32 v254, s52
    v_mov_b32 v255, s38
    s_waitcnt vmcnt(4) lgkmcnt(0)
    v_mfma_f32_32x32x16_bf16 v[0:15], v[72:75], v[184:187], v[0:15]
    ds_read_b64_tr_b16 v[176:177], v246 offset:4096
    ds_read_b64_tr_b16 v[178:179], v246 offset:5120
    ds_read_b64_tr_b16 v[180:181], v247 offset:4096
    ds_read_b64_tr_b16 v[182:183], v247 offset:5120
    s_lshl_b32 s58, s38, 3
    s_add_u32 s58, s58, s20
    s_mov_b32 m0, s69
    v_mfma_f32_32x32x16_bf16 v[16:31], v[76:79], v[184:187], v[16:31]
    buffer_load_dwordx4 v224, s[4:7], s42 offen sc1 lds
    buffer_load_dwordx4 v225, s[72:75], s42 offen offset:1024 sc1 lds
    s_set_gpr_idx_on s32, gpr_idx(DST)
    s_nop 0
    v_cvt_pk_bf16_f32 v195, v242, v243
    v_cvt_pk_bf16_f32 v196, v244, v245
    v_cvt_pk_bf16_f32 v197, v240, v240
    s_set_gpr_idx_off
    s_mov_b64 exec, 1
    ds_write_b32 v254, v255
    s_mov_b64 exec, -1
    s_cmp_lt_u32 s58, s22
    s_cbranch_scc0 K2_dyn_8
K2_back_9:
    v_readlane_b32 s3, v253, s58
    s_lshl_b32 s44, s34, 7
    s_and_b32 s48, s3, 0x3ffff
    s_bfe_u32 s33, s3, 0x30013
    s_mul_i32 s35, s38, 6
    s_cmp_eq_u32 s34, 0
    s_cselect_b32 s35, s35, s48
    s_mov_b32 s45, s44
    s_xor_b32 s47, s44, 256
    s_add_u32 s49, s48, 128
    s_add_u32 s60, s48, 256
    s_cmp_eq_u32 s33, 3
    s_cselect_b32 s46, s44, s47
    s_cselect_b32 s50, s60, s48
    s_cselect_b32 s51, s48, s49
    s_sub_u32 s60, s33, 2
    s_cmp_lt_u32 s60, 2
    s_cbranch_scc0 K2_rare_14
K2_back_15:
    v_mfma_f32_32x32x16_bf16 v[32:47], v[72:75], v[188:191], v[32:47]
    v_add_u32 v233, s48, v230
    ds_read_b32 v232, v233
    ds_read_b32 v233, v233 offset:1024
    v_mul_f32 v234, v0, v96
    v_mul_f32 v236, v8, v128
    v_fmac_f32 v234, v1, v97
    v_fmac_f32 v236, v9, v129
    v_mfma_f32_32x32x16_bf16 v[48:63], v[76:79], v[188:191], v[48:63]
    s_setprio 0
    v_fmac_f32 v234, v2, v98
    v_fmac_f32 v236, v10, v130
    v_fmac_f32 v234, v3, v99
    v_fmac_f32 v236, v11, v131
    v_fmac_f32 v234, v4, v100
    v_fmac_f32 v236, v12, v132
    v_fmac_f32 v234, v5, v101
    v_fmac_f32 v236, v13, v133
    v_fmac_f32 v234, v6, v102
    v_fmac_f32 v236, v14, v134
    v_fmac_f32 v234, v7, v103
    v_fmac_f32 v236, v15, v135
    v_mul_f32 v238, v16, v128
    v_mul_f32 v240, v24, v128
    v_fmac_f32 v238, v17, v129
    v_fmac_f32 v240, v25, v129
    v_fmac_f32 v238, v18, v130
    v_fmac_f32 v240, v26, v130
    v_fmac_f32 v238, v19, v131
    v_fmac_f32 v240, v27, v131
    v_fmac_f32 v238, v20, v132
    v_fmac_f32 v240, v28, v132
    v_fmac_f32 v238, v21, v133
    v_fmac_f32 v240, v29, v133
    v_fmac_f32 v238, v22, v134
    v_fmac_f32 v240, v30, v134
    v_fmac_f32 v238, v23, v135
    v_fmac_f32 v240, v31, v135
    v_mul_f32 v235, v32, v104
    v_mul_f32 v237, v40, v136
    v_fmac_f32 v235, v33, v105
    v_fmac_f32 v237, v41, v137
    v_fmac_f32 v235, v34, v106
    v_fmac_f32 v237, v42, v138
    v_fmac_f32 v235, v35, v107
    v_fmac_f32 v237, v43, v139
    v_fmac_f32 v235, v36, v108
    v_fmac_f32 v237, v44, v140
    v_fmac_f32 v235, v37, v109
    v_fmac_f32 v237, v45, v141
    v_fmac_f32 v235, v38, v110
    v_fmac_f32 v237, v46, v142
    v_fmac_f32 v235, v39, v111
    v_fmac_f32 v237, v47, v143
    v_mul_f32 v239, v48, v136
    v_mul_f32 v241, v56, v136
    v_fmac_f32 v239, v49, v137
    v_fmac_f32 v241, v57, v137
    s_setprio 1
    s_waitcnt vmcnt(4) lgkmcnt(3)
    v_mfma_f32_32x32x16_bf16 v[0:15], v[64:67], v[176:179], 0
    ds_read_b64_tr_b16 v[184:185], v246 offset:6144
    ds_read_b64_tr_b16 v[186:187], v246 offset:7168
    ds_read_b64_tr_b16 v[188:189], v247 offset:6144
    ds_read_b64_tr_b16 v[190:191], v247 offset:7168
    v_fmac_f32 v239, v50, v138
    v_fmac_f32 v241, v58, v138
    s_mov_b32 m0, s70
    v_mfma_f32_32x32x16_bf16 v[16:31], v[68:71], v[176:179], 0
    buffer_load_dwordx4 v222, s[4:7], s43 offen sc1 lds
    buffer_load_dwordx4 v223, s[72:75], s43 offen offset:1024 sc1 lds
    v_fmac_f32 v239, v51, v139
    v_fmac_f32 v241, v59, v139
    v_fmac_f32 v239, v52, v140
    v_fmac_f32 v241, v60, v140
    v_fmac_f32 v239, v53, v141
    v_mfma_f32_32x32x16_bf16 v[32:47], v[64:67], v[180:183], 0
    v_add_u32 v222, s48, v251
    ds_read2_b32 v[222:223], v222 offset0:1 offset1:3
    v_fmac_f32 v241, v61, v141
    v_fmac_f32 v239, v54, v142
    v_fmac_f32 v241, v62, v142
    v_fmac_f32 v239, v55, v143
    v_fmac_f32 v241, v63, v143
    v_mfma_f32_32x32x16_bf16 v[48:63], v[68:71], v[180:183], 0
    v_permlane32_swap_b32 v234, v236
    v_permlane32_swap_b32 v235, v237
    v_permlane32_swap_b32 v240, v238
    s_waitcnt lgkmcnt(5)
    v_or_b32 v232, v232, v231
    v_or_b32 v233, v233, v231
    s_cmp_lg_u32 s34, 0
    s_cbranch_scc1 K2_dum_17
    s_cmp_eq_u32 s33, 4
    s_cbranch_scc1 K2_a4_18
K2_b4_20:
    s_add_u32 m0, s48, 512
    s_add_u32 s65, s48, 1536
    buffer_load_dwordx4 v232, s[16:19], 0 offen  lds
    s_mov_b32 m0, s65
    s_mov_b32 exec_hi, 0
    buffer_load_dwordx4 v233, s[16:19], 0 offen  lds
    s_mov_b32 exec_hi, -1
K2_back_19:
    s_waitcnt vmcnt(6) lgkmcnt(1)
    v_mfma_f32_32x32x16_bf16 v[0:15], v[72:75], v[184:187], v[0:15]
    ds_read_b64_tr_b16 v[176:177], v246 offset:0
    ds_read_b64_tr_b16 v[178:179], v246 offset:1024
    ds_read_b64_tr_b16 v[180:181], v247 offset:0
    ds_read_b64_tr_b16 v[182:183], v247 offset:1024
    v_permlane32_swap_b32 v241, v239
    s_mov_b32 m0, s71
    v_mfma_f32_32x32x16_bf16 v[16:31], v[76:79], v[184:187], v[16:31]
    buffer_load_dwordx4 v224, s[4:7], s43 offen sc1 lds
    buffer_load_dwordx4 v225, s[72:75], s43 offen offset:1024 sc1 lds
    s_waitcnt lgkmcnt(4)
    v_mad_u32_u16 v222, v222, s39, v248 op_sel:[1,0,0,0]
    v_mad_u32_u16 v223, v223, s39, v248 op_sel:[1,0,0,0]
    v_add_f32 v234, v234, v236
    v_add_f32 v235, v235, v237
    v_add_f32 v240, v240, v238
    v_add_f32 v241, v241, v239
    s_set_gpr_idx_on s31, gpr_idx(DST)
    s_nop 0
    v_cvt_pk_bf16_f32 v192, v234, v235
    v_cvt_pk_bf16_f32 v193, v240, v241
    s_set_gpr_idx_off
    v_mfma_f32_32x32x16_bf16 v[32:47], v[72:75], v[188:191], v[32:47]
    v_add_u32 v224, s49, v251
    ds_read2_b32 v[224:225], v224 offset0:1 offset1:3
    v_mul_f32 v234, v0, v144
    v_mul_f32 v236, v8, v112
    v_fmac_f32 v234, v1, v145
    v_fmac_f32 v236, v9, v113
    v_fmac_f32 v234, v2, v146
    v_mfma_f32_32x32x16_bf16 v[48:63], v[76:79], v[188:191], v[48:63]
    s_setprio 0
    v_fmac_f32 v236, v10, v114
    v_fmac_f32 v234, v3, v147
    v_fmac_f32 v236, v11, v115
    v_fmac_f32 v234, v4, v148
    v_fmac_f32 v236, v12, v116
    v_fmac_f32 v234, v5, v149
    v_fmac_f32 v236, v13, v117
    v_fmac_f32 v234, v6, v150
    v_fmac_f32 v236, v14, v118
    v_fmac_f32 v234, v7, v151
    v_fmac_f32 v236, v15, v119
    v_mul_f32 v238, v16, v160
    v_mul_f32 v240, v24, v160
    v_fmac_f32 v238, v17, v161
    v_fmac_f32 v240, v25, v161
    v_fmac_f32 v238, v18, v162
    v_fmac_f32 v240, v26, v162
    v_fmac_f32 v238, v19, v163
    v_fmac_f32 v240, v27, v163
    v_fmac_f32 v238, v20, v164
    v_fmac_f32 v240, v28, v164
    v_fmac_f32 v238, v21, v165
    v_fmac_f32 v240, v29, v165
    v_fmac_f32 v238, v22, v166
    v_fmac_f32 v240, v30, v166
    v_fmac_f32 v238, v23, v167
    v_fmac_f32 v240, v31, v167
    v_mul_f32 v235, v32, v152
    v_mul_f32 v237, v40, v120
    v_fmac_f32 v235, v33, v153
    v_fmac_f32 v237, v41, v121
    v_fmac_f32 v235, v34, v154
    v_fmac_f32 v237, v42, v122
    v_fmac_f32 v235, v35, v155
    v_fmac_f32 v237, v43, v123
    v_fmac_f32 v235, v36, v156
    v_fmac_f32 v237, v44, v124
    v_fmac_f32 v235, v37, v157
    v_fmac_f32 v237, v45, v125
    v_fmac_f32 v235, v38, v158
    v_fmac_f32 v237, v46, v126
    v_fmac_f32 v235, v39, v159
    v_fmac_f32 v237, v47, v127
    v_mul_f32 v239, v48, v168
    v_mul_f32 v241, v56, v168
    v_fmac_f32 v239, v49, v169
    v_fmac_f32 v241, v57, v169
    v_fmac_f32 v239, v50, v170
    v_fmac_f32 v241, v58, v170
    v_fmac_f32 v239, v51, v171
    s_setprio 1
    s_waitcnt vmcnt(6) lgkmcnt(1)
    v_mfma_f32_32x32x16_bf16 v[0:15], v[64:67], v[176:179], 0
    ds_read_b64_tr_b16 v[184:185], v246 offset:2048
    ds_read_b64_tr_b16 v[186:187], v246 offset:3072
    ds_read_b64_tr_b16 v[188:189], v247 offset:2048
    ds_read_b64_tr_b16 v[190:191], v247 offset:3072
    v_fmac_f32 v241, v59, v171
    v_fmac_f32 v239, v52, v172
    s_mov_b32 m0, s68
    v_mfma_f32_32x32x16_bf16 v[16:31], v[68:71], v[176:179], 0
    buffer_load_dwordx4 v222, s[4:7], s44 offen sc1 lds
    buffer_load_dwordx4 v223, s[72:75], s44 offen offset:1024 sc1 lds
    s_waitcnt lgkmcnt(4)
    v_mad_u32_u16 v224, v224, s39, v248 op_sel:[1,0,0,0]
    v_mad_u32_u16 v225, v225, s39, v248 op_sel:[1,0,0,0]
    v_fmac_f32 v241, v60, v172
    v_fmac_f32 v239, v53, v173
    v_mfma_f32_32x32x16_bf16 v[32:47], v[64:67], v[180:183], 0
    v_add_u32 v226, s50, v251
    ds_read2_b32 v[226:227], v226 offset0:1 offset1:3
    v_fmac_f32 v241, v61, v173
    v_fmac_f32 v239, v54, v174
    v_fmac_f32 v241, v62, v174
    v_fmac_f32 v239, v55, v175
    v_fmac_f32 v241, v63, v175
    v_mfma_f32_32x32x16_bf16 v[48:63], v[68:71], v[180:183], 0
    s_waitcnt vmcnt(6) lgkmcnt(1)
    v_mfma_f32_32x32x16_bf16 v[0:15], v[72:75], v[184:187], v[0:15]
    ds_read_b64_tr_b16 v[176:177], v246 offset:4096
    ds_read_b64_tr_b16 v[178:179], v246 offset:5120
    ds_read_b64_tr_b16 v[180:181], v247 offset:4096
    ds_read_b64_tr_b16 v[182:183], v247 offset:5120
    s_mov_b32 m0, s69
    v_mfma_f32_32x32x16_bf16 v[16:31], v[76:79], v[184:187], v[16:31]
    buffer_load_dwordx4 v224, s[4:7], s45 offen sc1 lds
    buffer_load_dwordx4 v225, s[72:75], s45 offen offset:1024 sc1 lds
    s_waitcnt lgkmcnt(4)
    v_mad_u32_u16 v226, v226, s39, v248 op_sel:[1,0,0,0]
    v_mad_u32_u16 v227, v227, s39, v248 op_sel:[1,0,0,0]
    v_mfma_f32_32x32x16_bf16 v[32:47], v[72:75], v[188:191], v[32:47]
    v_add_u32 v228, s51, v251
    ds_read2_b32 v[228:229], v228 offset0:1 offset1:3
    v_mul_f32 v242, v0, v144
    v_fma_f32 v238, v8, v160, -v238
    v_fmac_f32 v242, v1, v145
    v_fmac_f32 v238, v9, v161
    v_fmac_f32 v242, v2, v146
    v_mfma_f32_32x32x16_bf16 v[48:63], v[76:79], v[188:191], v[48:63]
    s_setprio 0
    v_fmac_f32 v238, v10, v162
    v_fmac_f32 v242, v3, v147
    v_fmac_f32 v238, v11, v163
    v_fmac_f32 v242, v4, v148
    v_fmac_f32 v238, v12, v164
    v_fmac_f32 v242, v5, v149
    v_fmac_f32 v238, v13, v165
    v_fmac_f32 v242, v6, v150
    v_fmac_f32 v238, v14, v166
    v_fmac_f32 v242, v7, v151
    v_fmac_f32 v238, v15, v167
    v_fmac_f32 v236, v16, v112
    v_mul_f32 v244, v24, v160
    v_fmac_f32 v236, v17, v113
    v_fmac_f32 v244, v25, v161
    v_fmac_f32 v236, v18, v114
    v_fmac_f32 v244, v26, v162
    v_fmac_f32 v236, v19, v115
    v_fmac_f32 v244, v27, v163
    v_fmac_f32 v236, v20, v116
    v_fmac_f32 v244, v28, v164
    v_fmac_f32 v236, v21, v117
    v_fmac_f32 v244, v29, v165
    v_fmac_f32 v236, v22, v118
    v_fmac_f32 v244, v30, v166
    v_fmac_f32 v236, v23, v119
    v_fmac_f32 v244, v31, v167
    v_mul_f32 v243, v32, v152
    v_fma_f32 v239, v40, v168, -v239
    v_fmac_f32 v243, v33, v153
    v_fmac_f32 v239, v41, v169
    v_fmac_f32 v243, v34, v154
    v_fmac_f32 v239, v42, v170
    v_fmac_f32 v243, v35, v155
    v_fmac_f32 v239, v43, v171
    v_fmac_f32 v243, v36, v156
    v_fmac_f32 v239, v44, v172
    v_fmac_f32 v243, v37, v157
    v_fmac_f32 v239, v45, v173
    v_fmac_f32 v243, v38, v158
    v_fmac_f32 v239, v46, v174
    v_fmac_f32 v243, v39, v159
    v_fmac_f32 v239, v47, v175
    v_fmac_f32 v237, v48, v120
    v_mul_f32 v245, v56, v168
    v_fmac_f32 v237, v49, v121
    v_fmac_f32 v245, v57, v169
    v_fmac_f32 v237, v50, v122
    s_setprio 1
    s_waitcnt vmcnt(4) lgkmcnt(1)
    v_mfma_f32_32x32x16_bf16 v[0:15], v[64:67], v[176:179], 0
    ds_read_b64_tr_b16 v[184:185], v246 offset:6144
    ds_read_b64_tr_b16 v[186:187], v246 offset:7168
    ds_read_b64_tr_b16 v[188:189], v247 offset:6144
    ds_read_b64_tr_b16 v[190:191], v247 offset:7168
    v_fmac_f32 v245, v58, v170
    v_fmac_f32 v237, v51, v123
    s_mov_b32 m0, s70
    v_mfma_f32_32x32x16_bf16 v[16:31], v[68:71], v[176:179], 0
    buffer_load_dwordx4 v226, s[4:7], s46 offen sc1 lds
    buffer_load_dwordx4 v227, s[72:75], s46 offen offset:1024 sc1 lds
    s_waitcnt lgkmcnt(4)
    v_mad_u32_u16 v228, v228, s39, v248 op_sel:[1,0,0,0]
    v_mad_u32_u16 v229, v229, s39, v248 op_sel:[1,0,0,0]
    v_fmac_f32 v245, v59, v171
    v_fmac_f32 v237, v52, v124
    v_mfma_f32_32x32x16_bf16 v[32:47], v[64:67], v[180:183], 0
    v_fmac_f32 v245, v60, v172
    v_fmac_f32 v237, v53, v125
    v_fmac_f32 v245, v61, v173
    v_fmac_f32 v237, v54, v126
    v_fmac_f32 v245, v62, v174
    v_fmac_f32 v237, v55, v127
    v_fmac_f32 v245, v63, v175
    v_mfma_f32_32x32x16_bf16 v[48:63], v[68:71], v[180:183], 0
    v_permlane32_swap_b32 v242, v234
    v_permlane32_swap_b32 v243, v235
    v_add_f32 v242, v242, v234
    v_add_f32 v243, v243, v235
    s_waitcnt vmcnt(4) lgkmcnt(0)
    v_mfma_f32_32x32x16_bf16 v[0:15], v[72:75], v[184:187], v[0:15]
    ds_read_b64_tr_b16 v[176:177], v246 offset:0
    ds_read_b64_tr_b16 v[178:179], v246 offset:1024
    ds_read_b64_tr_b16 v[180:181], v247 offset:0
    ds_read_b64_tr_b16 v[182:183], v247 offset:1024
    s_sub_u32 s26, s48, s29
    s_mov_b32 s29, s48
    s_mov_b32 m0, s71
    v_mfma_f32_32x32x16_bf16 v[16:31], v[76:79], v[184:187], v[16:31]
    buffer_load_dwordx4 v228, s[4:7], s47 offen sc1 lds
    buffer_load_dwordx4 v229, s[72:75], s47 offen offset:1024 sc1 lds
    s_set_gpr_idx_on s31, gpr_idx(DST)
    s_nop 0
    v_cvt_pk_bf16_f32 v194, v242, v243
    s_set_gpr_idx_off
    s_mov_b32 s30, s3
    s_bfe_u32 s56, s3, 0x40012
    s_cmp_eq_u32 s34, 0
    s_cselect_b32 s56, s56, 0
    v_mfma_f32_32x32x16_bf16 v[32:47], v[72:75], v[188:191], v[32:47]
    s_mov_b32 s32, s31
    s_mov_b32 s31, s35
    v_mul_f32 v242, v0, v144
    v_fma_f32 v240, v8, v160, -v240
    v_fmac_f32 v242, v1, v145
    v_fmac_f32 v240, v9, v161
    v_fmac_f32 v242, v2, v146
    v_mfma_f32_32x32x16_bf16 v[48:63], v[76:79], v[188:191], v[48:63]
    s_setprio 0
    v_fmac_f32 v240, v10, v162
    v_fmac_f32 v242, v3, v147
    v_fmac_f32 v240, v11, v163
    v_fmac_f32 v242, v4, v148
    v_fmac_f32 v240, v12, v164
    v_fmac_f32 v242, v5, v149
    v_fmac_f32 v240, v13, v165
    v_fmac_f32 v242, v6, v150
    v_fmac_f32 v240, v14, v166
    v_fmac_f32 v242, v7, v151
    v_fmac_f32 v240, v15, v167
    v_add_u32 v249, s26, v249
    v_add_u32 v250, s26, v250
    v_fma_f32 v244, v16, v160, -v244
    v_fmac_f32 v236, v24, v112
    v_fmac_f32 v244, v17, v161
    v_fmac_f32 v236, v25, v113
    v_fmac_f32 v244, v18, v162
    v_fmac_f32 v236, v26, v114
    v_fmac_f32 v244, v19, v163
    v_fmac_f32 v236, v27, v115
    v_fmac_f32 v244, v20, v164
    v_fmac_f32 v236, v28, v116
    v_fmac_f32 v244, v21, v165
    v_fmac_f32 v236, v29, v117
    v_fmac_f32 v244, v22, v166
    v_fmac_f32 v236, v30, v118
    v_fmac_f32 v244, v23, v167
    v_fmac_f32 v236, v31, v119
    ds_read_b64_tr_b16 v[0:1], v249 offset:0
    ds_read_b64_tr_b16 v[2:3], v249 offset:32
    ds_read_u16_d16_hi v16, v250 offset:0
    v_mul_f32 v243, v32, v152
    v_fma_f32 v241, v40, v168, -v241
    v_fmac_f32 v243, v33, v153
    v_fmac_f32 v241, v41, v169
    v_fmac_f32 v243, v34, v154
    v_fmac_f32 v241, v42, v170
    v_fmac_f32 v243, v35, v155
    v_fmac_f32 v241, v43, v171
    v_fmac_f32 v243, v36, v156
    v_fmac_f32 v241, v44, v172
    v_fmac_f32 v243, v37, v157
    v_fmac_f32 v241, v45, v173
    v_fmac_f32 v243, v38, v158
    v_fmac_f32 v241, v46, v174
    v_fmac_f32 v243, v39, v159
    v_fmac_f32 v241, v47, v175
    ds_read_b64_tr_b16 v[4:5], v249 offset:512
    ds_read_b64_tr_b16 v[6:7], v249 offset:544
    ds_read_u16_d16_hi v17, v250 offset:128
    v_fma_f32 v245, v48, v168, -v245
    v_fmac_f32 v237, v56, v120
    v_fmac_f32 v245, v49, v169
    v_fmac_f32 v237, v57, v121
    v_fmac_f32 v245, v50, v170
    v_fmac_f32 v237, v58, v122
    v_fmac_f32 v245, v51, v171
    v_fmac_f32 v237, v59, v123
    v_fmac_f32 v245, v52, v172
    v_fmac_f32 v237, v60, v124
    v_fmac_f32 v245, v53, v173
    v_fmac_f32 v237, v61, v125
    v_fmac_f32 v245, v54, v174
    v_fmac_f32 v237, v62, v126
    v_fmac_f32 v245, v55, v175
    v_fmac_f32 v237, v63, v127
    s_cmp_eq_u32 s56, 5
    s_cbranch_scc1 K2_U20
    s_cmp_eq_u32 s56, 6
    s_cbranch_scc1 K2_U3h0
    s_branch K2_DSP0
K2_PAD_U30:
    s_branch K2_HOP
K2_U3h0:
    s_setprio 1
    ds_read_b64_tr_b16 v[8:9], v249 offset:1024
    ds_read_u16_d16_hi v18, v250 offset:256
    s_waitcnt lgkmcnt(2)
    v_lshlrev_b32 v20, 16, v0
    v_and_b32 v21, 0xffff0000, v0
    v_lshlrev_b32 v22, 16, v1
    v_and_b32 v23, 0xffff0000, v1
    v_lshlrev_b32 v24, 16, v2
    v_and_b32 v25, 0xffff0000, v2
    v_lshlrev_b32 v26, 16, v3
    v_and_b32 v27, 0xffff0000, v3
    v_mul_f32_dpp v36, v16, v20 row_newbcast:8 row_mask:0xf bank_mask:0xf
    v_mul_f32_dpp v37, v16, v21 row_newbcast:9 row_mask:0xf bank_mask:0xf
    v_mul_f32_dpp v38, v16, v22 row_newbcast:10 row_mask:0xf bank_mask:0xf
    v_mul_f32_dpp v39, v16, v23 row_newbcast:11 row_mask:0xf bank_mask:0xf
    v_mul_f32_dpp v40, v16, v24 row_newbcast:12 row_mask:0xf bank_mask:0xf
    v_mul_f32_dpp v41, v16, v25 row_newbcast:13 row_mask:0xf bank_mask:0xf
    v_mul_f32_dpp v42, v16, v26 row_newbcast:14 row_mask:0xf bank_mask:0xf
    v_mul_f32_dpp v43, v16, v27 row_newbcast:15 row_mask:0xf bank_mask:0xf
    v_cvt_pk_bf16_f32 v68, v36, v37
    v_cvt_pk_bf16_f32 v69, v38, v39
    v_cvt_pk_bf16_f32 v70, v40, v41
    v_cvt_pk_bf16_f32 v71, v42, v43
    v_mul_f32_dpp v20, v16, v20 row_newbcast:0 row_mask:0xa bank_mask:0xf
    v_mul_f32_dpp v21, v16, v21 row_newbcast:1 row_mask:0xa bank_mask:0xf
    v_mul_f32_dpp v22, v16, v22 row_newbcast:2 row_mask:0xa bank_mask:0xf
    v_mul_f32_dpp v23, v16, v23 row_newbcast:3 row_mask:0xa bank_mask:0xf
    v_mul_f32_dpp v24, v16, v24 row_newbcast:4 row_mask:0xa bank_mask:0xf
    v_mul_f32_dpp v25, v16, v25 row_newbcast:5 row_mask:0xa bank_mask:0xf
    v_mul_f32_dpp v26, v16, v26 row_newbcast:6 row_mask:0xa bank_mask:0xf
    v_mul_f32_dpp v27, v16, v27 row_newbcast:7 row_mask:0xa bank_mask:0xf
    v_cvt_pk_bf16_f32 v64, v20, v21
    v_cvt_pk_bf16_f32 v65, v22, v23
    v_cvt_pk_bf16_f32 v66, v24, v25
    v_cvt_pk_bf16_f32 v67, v26, v27
    v_lshlrev_b32 v28, 16, v4
    v_and_b32 v29, 0xffff0000, v4
    v_lshlrev_b32 v30, 16, v5
    v_and_b32 v31, 0xffff0000, v5
    v_lshlrev_b32 v32, 16, v6
    v_and_b32 v33, 0xffff0000, v6
    v_lshlrev_b32 v34, 16, v7
    v_and_b32 v35, 0xffff0000, v7
    v_mul_f32_dpp v36, v17, v28 row_newbcast:8 row_mask:0xf bank_mask:0xf
    v_mul_f32_dpp v37, v17, v29 row_newbcast:9 row_mask:0xf bank_mask:0xf
    v_mul_f32_dpp v38, v17, v30 row_newbcast:10 row_mask:0xf bank_mask:0xf
    v_mul_f32_dpp v39, v17, v31 row_newbcast:11 row_mask:0xf bank_mask:0xf
    v_mul_f32_dpp v40, v17, v32 row_newbcast:12 row_mask:0xf bank_mask:0xf
    v_mul_f32_dpp v41, v17, v33 row_newbcast:13 row_mask:0xf bank_mask:0xf
    v_mul_f32_dpp v42, v17, v34 row_newbcast:14 row_mask:0xf bank_mask:0xf
    v_mul_f32_dpp v43, v17, v35 row_newbcast:15 row_mask:0xf bank_mask:0xf
    v_cvt_pk_bf16_f32 v76, v36, v37
    v_cvt_pk_bf16_f32 v77, v38, v39
    v_cvt_pk_bf16_f32 v78, v40, v41
    v_cvt_pk_bf16_f32 v79, v42, v43
    v_mul_f32_dpp v28, v17, v28 row_newbcast:0 row_mask:0xa bank_mask:0xf
    v_mul_f32_dpp v29, v17, v29 row_newbcast:1 row_mask:0xa bank_mask:0xf
    v_mul_f32_dpp v30, v17, v30 row_newbcast:2 row_mask:0xa bank_mask:0xf
    v_mul_f32_dpp v31, v17, v31 row_newbcast:3 row_mask:0xa bank_mask:0xf
    v_mul_f32_dpp v32, v17, v32 row_newbcast:4 row_mask:0xa bank_mask:0xf
    v_mul_f32_dpp v33, v17, v33 row_newbcast:5 row_mask:0xa bank_mask:0xf
    v_mul_f32_dpp v34, v17, v34 row_newbcast:6 row_mask:0xa bank_mask:0xf
    v_mul_f32_dpp v35, v17, v35 row_newbcast:7 row_mask:0xa bank_mask:0xf
    v_cvt_pk_bf16_f32 v72, v28, v29
    v_cvt_pk_bf16_f32 v73, v30, v31
    v_cvt_pk_bf16_f32 v74, v32, v33
    v_cvt_pk_bf16_f32 v75, v34, v35
    s_waitcnt lgkmcnt(0)
    v_lshlrev_b32 v20, 16, v8
    v_and_b32 v21, 0xffff0000, v8
    v_lshlrev_b32 v22, 16, v9
    v_and_b32 v23, 0xffff0000, v9
    v_mul_f32_dpp v36, v18, v20 row_newbcast:8 row_mask:0xf bank_mask:0xf
    v_mul_f32_dpp v37, v18, v21 row_newbcast:9 row_mask:0xf bank_mask:0xf
    v_mul_f32_dpp v38, v18, v22 row_newbcast:10 row_mask:0xf bank_mask:0xf
    v_mul_f32_dpp v39, v18, v23 row_newbcast:11 row_mask:0xf bank_mask:0xf
    v_cvt_pk_bf16_f32 v84, v36, v37
    v_cvt_pk_bf16_f32 v85, v38, v39
    v_mul_f32_dpp v20, v18, v20 row_newbcast:0 row_mask:0xa bank_mask:0xf
    v_mul_f32_dpp v21, v18, v21 row_newbcast:1 row_mask:0xa bank_mask:0xf
    v_mul_f32_dpp v22, v18, v22 row_newbcast:2 row_mask:0xa bank_mask:0xf
    v_mul_f32_dpp v23, v18, v23 row_newbcast:3 row_mask:0xa bank_mask:0xf
    v_cvt_pk_bf16_f32 v80, v20, v21
    v_cvt_pk_bf16_f32 v81, v22, v23
    s_waitcnt vmcnt(4)
    v_mfma_f32_32x32x16_bf16 v[0:15], v[64:67], v[176:179], 0
    ds_read_b64_tr_b16 v[184:185], v246 offset:2048
    ds_read_b64_tr_b16 v[186:187], v246 offset:3072
    ds_read_b64_tr_b16 v[188:189], v247 offset:2048
    ds_read_b64_tr_b16 v[190:191], v247 offset:3072
    s_mov_b32 m0, s68
    v_mfma_f32_32x32x16_bf16 v[16:31], v[68:71], v[176:179], 0
    buffer_load_dwordx4 v224, s[4:7], s41 offen sc1 lds
    buffer_load_dwordx4 v225, s[72:75], s41 offen offset:1024 sc1 lds
    v_permlane32_swap_b32 v242, v236
    v_permlane32_swap_b32 v243, v237
    s_add_u32 s38, s38, 1
    v_mfma_f32_32x32x16_bf16 v[32:47], v[64:67], v[180:183], 0
    v_permlane32_swap_b32 v244, v238
    v_permlane32_swap_b32 v245, v239
    v_permlane32_swap_b32 v240, v241
    v_add_f32 v242, v242, v236
    v_mfma_f32_32x32x16_bf16 v[48:63], v[68:71], v[180:183], 0
    v_add_f32 v243, v243, v237
    v_add_f32 v244, v244, v238
    v_add_f32 v245, v245, v239
    v_add_f32 v240, -v240, -v241
    v_mov_b32 v254, s52
    v_mov_b32 v255, s38
    s_waitcnt vmcnt(4) lgkmcnt(0)
    v_mfma_f32_32x32x16_bf16 v[0:15], v[72:75], v[184:187], v[0:15]
    ds_read_b64_tr_b16 v[176:177], v246 offset:4096
    ds_read_b64_tr_b16 v[180:181], v247 offset:4096
    s_lshl_b32 s58, s38, 3
    s_add_u32 s58, s58, s20
    s_mov_b32 m0, s69
    v_mfma_f32_32x32x16_bf16 v[16:31], v[76:79], v[184:187], v[16:31]
    buffer_load_dwordx4 v226, s[4:7], s41 offen sc1 lds
    s_set_gpr_idx_on s32, gpr_idx(DST)
    s_nop 0
    v_cvt_pk_bf16_f32 v195, v242, v243
    v_cvt_pk_bf16_f32 v196, v244, v245
    v_cvt_pk_bf16_f32 v197, v240, v240
    s_set_gpr_idx_off
    s_mov_b64 exec, 1
    ds_write_b32 v254, v255
    s_mov_b64 exec, -1
    s_cmp_lt_u32 s58, s22
    s_cbranch_scc0 K2_dyn_21
K2_back_22:
    v_readlane_b32 s3, v253, s58
    s_lshl_b32 s44, s34, 7
    s_and_b32 s48, s3, 0x3ffff
    s_bfe_u32 s33, s3, 0x30013
    s_mul_i32 s35, s38, 6
    s_cmp_eq_u32 s34, 0
    s_cselect_b32 s35, s35, s48
    s_mov_b32 s45, s44
    s_xor_b32 s47, s44, 256
    s_add_u32 s49, s48, 128
    s_add_u32 s60, s48, 256
    s_cmp_eq_u32 s33, 3
    s_cselect_b32 s46, s44, s47
    s_cselect_b32 s50, s60, s48
    s_cselect_b32 s51, s48, s49
    s_sub_u32 s60, s33, 2
    s_cmp_lt_u32 s60, 2
    s_cbranch_scc0 K2_rare_27
K2_back_28:
    v_mfma_f32_32x32x16_bf16 v[32:47], v[72:75], v[188:191], v[32:47]
    v_add_u32 v233, s48, v230
    ds_read_b32 v232, v233
    ds_read_b32 v233, v233 offset:1024
    v_mfma_f32_32x32x16_bf16 v[48:63], v[76:79], v[188:191], v[48:63]
    s_waitcnt vmcnt(3) lgkmcnt(3)
    v_mfma_f32_32x32x8_bf16 v[0:15], v[80:81], v[176:177], v[0:15]
    ds_read_b64_tr_b16 v[184:185], v246 offset:6144
    ds_read_b64_tr_b16 v[186:187], v246 offset:7168
    ds_read_b64_tr_b16 v[188:189], v247 offset:6144
    ds_read_b64_tr_b16 v[190:191], v247 offset:7168
    s_mov_b32 m0, s70
    v_mfma_f32_32x32x8_bf16 v[16:31], v[84:85], v[176:177], v[16:31]
    buffer_load_dwordx4 v222, s[4:7], s42 offen sc1 lds
    buffer_load_dwordx4 v223, s[72:75], s42 offen offset:1024 sc1 lds
    v_mfma_f32_32x32x8_bf16 v[32:47], v[80:81], v[180:181], v[32:47]
    s_nop 2
    v_mul_f32 v234, v0, v96
    v_mul_f32 v236, v8, v128
    v_fmac_f32 v234, v1, v97
    v_fmac_f32 v236, v9, v129
    v_fmac_f32 v234, v2, v98
    v_fmac_f32 v236, v10, v130
    v_fmac_f32 v234, v3, v99
    v_mfma_f32_32x32x8_bf16 v[48:63], v[84:85], v[180:181], v[48:63]
    s_setprio 0
    s_waitcnt lgkmcnt(4)
    v_or_b32 v232, v232, v231
    v_or_b32 v233, v233, v231
    s_cmp_lg_u32 s34, 0
    s_cbranch_scc1 K2_dum_30
    s_cmp_eq_u32 s33, 4
    s_cbranch_scc1 K2_a4_31
K2_b4_33:
    s_add_u32 m0, s48, 512
    s_add_u32 s65, s48, 1536
    buffer_load_dwordx4 v232, s[16:19], 0 offen  lds
    s_mov_b32 m0, s65
    s_mov_b32 exec_hi, 0
    buffer_load_dwordx4 v233, s[16:19], 0 offen  lds
    s_mov_b32 exec_hi, -1
K2_back_32:
    v_fmac_f32 v236, v11, v131
    v_fmac_f32 v234, v4, v100
    v_fmac_f32 v236, v12, v132
    v_fmac_f32 v234, v5, v101
    v_fmac_f32 v236, v13, v133
    v_fmac_f32 v234, v6, v102
    v_fmac_f32 v236, v14, v134
    v_fmac_f32 v234, v7, v103
    v_fmac_f32 v236, v15, v135
    v_mul_f32 v238, v16, v128
    v_mul_f32 v240, v24, v128
    v_fmac_f32 v238, v17, v129
    v_fmac_f32 v240, v25, v129
    v_fmac_f32 v238, v18, v130
    v_fmac_f32 v240, v26, v130
    v_fmac_f32 v238, v19, v131
    v_fmac_f32 v240, v27, v131
    v_fmac_f32 v238, v20, v132
    v_fmac_f32 v240, v28, v132
    v_fmac_f32 v238, v21, v133
    v_fmac_f32 v240, v29, v133
    v_fmac_f32 v238, v22, v134
    v_fmac_f32 v240, v30, v134
    v_fmac_f32 v238, v23, v135
    v_fmac_f32 v240, v31, v135
    v_mul_f32 v235, v32, v104
    v_mul_f32 v237, v40, v136
    v_fmac_f32 v235, v33, v105
    v_fmac_f32 v237, v41, v137
    v_fmac_f32 v235, v34, v106
    v_fmac_f32 v237, v42, v138
    v_fmac_f32 v235, v35, v107
    v_fmac_f32 v237, v43, v139
    v_fmac_f32 v235, v36, v108
    v_fmac_f32 v237, v44, v140
    v_fmac_f32 v235, v37, v109
    v_fmac_f32 v237, v45, v141
    v_fmac_f32 v235, v38, v110
    v_fmac_f32 v237, v46, v142
    v_fmac_f32 v235, v39, v111
    v_fmac_f32 v237, v47, v143
    v_mul_f32 v239, v48, v136
    v_mul_f32 v241, v56, v136
    s_setprio 1
    s_waitcnt vmcnt(5) lgkmcnt(0)
    v_mfma_f32_32x32x16_bf16 v[0:15], v[64:67], v[184:187], 0
    ds_read_b64_tr_b16 v[176:177], v246 offset:0
    ds_read_b64_tr_b16 v[178:179], v246 offset:1024
    ds_read_b64_tr_b16 v[180:181], v247 offset:0
    ds_read_b64_tr_b16 v[182:183], v247 offset:1024
    v_fmac_f32 v239, v49, v137
    v_fmac_f32 v241, v57, v137
    s_mov_b32 m0, s71
    v_mfma_f32_32x32x16_bf16 v[16:31], v[68:71], v[184:187], 0
    buffer_load_dwordx4 v224, s[4:7], s42 offen sc1 lds
    buffer_load_dwordx4 v225, s[72:75], s42 offen offset:1024 sc1 lds
    v_fmac_f32 v239, v50, v138
    v_fmac_f32 v241, v58, v138
    v_fmac_f32 v239, v51, v139
    v_fmac_f32 v241, v59, v139
    v_fmac_f32 v239, v52, v140
    v_mfma_f32_32x32x16_bf16 v[32:47], v[64:67], v[188:191], 0
    v_fmac_f32 v241, v60, v140
    v_fmac_f32 v239, v53, v141
    v_fmac_f32 v241, v61, v141
    v_fmac_f32 v239, v54, v142
    v_fmac_f32 v241, v62, v142
    v_fmac_f32 v239, v55, v143
    v_fmac_f32 v241, v63, v143
    v_mfma_f32_32x32x16_bf16 v[48:63], v[68:71], v[188:191], 0
    v_permlane32_swap_b32 v234, v236
    v_permlane32_swap_b32 v235, v237
    v_permlane32_swap_b32 v240, v238
    s_waitcnt vmcnt(6) lgkmcnt(0)
    v_mfma_f32_32x32x16_bf16 v[0:15], v[72:75], v[176:179], v[0:15]
    ds_read_b64_tr_b16 v[184:185], v246 offset:2048
    ds_read_b64_tr_b16 v[188:189], v247 offset:2048
    v_permlane32_swap_b32 v241, v239
    v_add_f32 v234, v234, v236
    v_add_f32 v235, v235, v237
    s_mov_b32 m0, s68
    v_mfma_f32_32x32x16_bf16 v[16:31], v[76:79], v[176:179], v[16:31]
    buffer_load_dwordx4 v226, s[4:7], s42 offen sc1 lds
    v_add_f32 v240, v240, v238
    v_add_f32 v241, v241, v239
    s_set_gpr_idx_on s31, gpr_idx(DST)
    s_nop 0
    v_cvt_pk_bf16_f32 v192, v234, v235
    v_cvt_pk_bf16_f32 v193, v240, v241
    s_set_gpr_idx_off
    v_mfma_f32_32x32x16_bf16 v[32:47], v[72:75], v[180:183], v[32:47]
    v_mfma_f32_32x32x16_bf16 v[48:63], v[76:79], v[180:183], v[48:63]
    s_waitcnt vmcnt(5) lgkmcnt(0)
    v_mfma_f32_32x32x8_bf16 v[0:15], v[80:81], v[184:185], v[0:15]
    ds_read_b64_tr_b16 v[176:177], v246 offset:4096
    ds_read_b64_tr_b16 v[178:179], v246 offset:5120
    ds_read_b64_tr_b16 v[180:181], v247 offset:4096
    ds_read_b64_tr_b16 v[182:183], v247 offset:5120
    s_mov_b32 m0, s69
    v_mfma_f32_32x32x8_bf16 v[16:31], v[84:85], v[184:185], v[16:31]
    buffer_load_dwordx4 v222, s[4:7], s43 offen sc1 lds
    buffer_load_dwordx4 v223, s[72:75], s43 offen offset:1024 sc1 lds
    v_mfma_f32_32x32x8_bf16 v[32:47], v[80:81], v[188:189], v[32:47]
    s_nop 2
    v_mul_f32 v234, v0, v144
    v_mul_f32 v236, v8, v112
    v_fmac_f32 v234, v1, v145
    v_fmac_f32 v236, v9, v113
    v_fmac_f32 v234, v2, v146
    v_fmac_f32 v236, v10, v114
    v_fmac_f32 v234, v3, v147
    v_mfma_f32_32x32x8_bf16 v[48:63], v[84:85], v[188:189], v[48:63]
    s_setprio 0
    v_fmac_f32 v236, v11, v115
    v_fmac_f32 v234, v4, v148
    v_fmac_f32 v236, v12, v116
    v_fmac_f32 v234, v5, v149
    v_fmac_f32 v236, v13, v117
    v_fmac_f32 v234, v6, v150
    v_fmac_f32 v236, v14, v118
    v_fmac_f32 v234, v7, v151
    v_fmac_f32 v236, v15, v119
    v_mul_f32 v238, v16, v160
    v_mul_f32 v240, v24, v160
    v_fmac_f32 v238, v17, v161
    v_fmac_f32 v240, v25, v161
    v_fmac_f32 v238, v18, v162
    v_fmac_f32 v240, v26, v162
    v_fmac_f32 v238, v19, v163
    v_fmac_f32 v240, v27, v163
    v_fmac_f32 v238, v20, v164
    v_fmac_f32 v240, v28, v164
    v_fmac_f32 v238, v21, v165
    v_fmac_f32 v240, v29, v165
    v_fmac_f32 v238, v22, v166
    v_fmac_f32 v240, v30, v166
    v_fmac_f32 v238, v23, v167
    v_fmac_f32 v240, v31, v167
    v_mul_f32 v235, v32, v152
    v_mul_f32 v237, v40, v120
    v_fmac_f32 v235, v33, v153
    v_fmac_f32 v237, v41, v121
    v_fmac_f32 v235, v34, v154
    v_fmac_f32 v237, v42, v122
    v_fmac_f32 v235, v35, v155
    v_fmac_f32 v237, v43, v123
    v_fmac_f32 v235, v36, v156
    v_fmac_f32 v237, v44, v124
    v_fmac_f32 v235, v37, v157
    v_fmac_f32 v237, v45, v125
    v_fmac_f32 v235, v38, v158
    v_fmac_f32 v237, v46, v126
    v_fmac_f32 v235, v39, v159
    v_fmac_f32 v237, v47, v127
    v_mul_f32 v239, v48, v168
    v_mul_f32 v241, v56, v168
    v_fmac_f32 v239, v49, v169
    v_fmac_f32 v241, v57, v169
    s_setprio 1
    s_waitcnt vmcnt(3) lgkmcnt(0)
    v_mfma_f32_32x32x16_bf16 v[0:15], v[64:67], v[176:179], 0
    ds_read_b64_tr_b16 v[184:185], v246 offset:6144
    ds_read_b64_tr_b16 v[186:187], v246 offset:7168
    ds_read_b64_tr_b16 v[188:189], v247 offset:6144
    ds_read_b64_tr_b16 v[190:191], v247 offset:7168
    v_fmac_f32 v239, v50, v170
    v_fmac_f32 v241, v58, v170
    s_mov_b32 m0, s70
    v_mfma_f32_32x32x16_bf16 v[16:31], v[68:71], v[176:179], 0
    buffer_load_dwordx4 v224, s[4:7], s43 offen sc1 lds
    buffer_load_dwordx4 v225, s[72:75], s43 offen offset:1024 sc1 lds
    v_fmac_f32 v239, v51, v171
    v_fmac_f32 v241, v59, v171
    v_fmac_f32 v239, v52, v172
    v_fmac_f32 v241, v60, v172
    v_fmac_f32 v239, v53, v173
    v_mfma_f32_32x32x16_bf16 v[32:47], v[64:67], v[180:183], 0
    v_add_u32 v222, s48, v251
    ds_read2_b32 v[222:223], v222 offset0:1 offset1:3
    v_fmac_f32 v241, v61, v173
    v_fmac_f32 v239, v54, v174
    v_fmac_f32 v241, v62, v174
    v_fmac_f32 v239, v55, v175
    v_fmac_f32 v241, v63, v175
    v_mfma_f32_32x32x16_bf16 v[48:63], v[68:71], v[180:183], 0
    s_waitcnt vmcnt(4) lgkmcnt(1)
    v_mfma_f32_32x32x16_bf16 v[0:15], v[72:75], v[184:187], v[0:15]
    ds_read_b64_tr_b16 v[176:177], v246 offset:0
    ds_read_b64_tr_b16 v[180:181], v247 offset:0
    s_mov_b32 m0, s71
    v_mfma_f32_32x32x16_bf16 v[16:31], v[76:79], v[184:187], v[16:31]
    buffer_load_dwordx4 v226, s[4:7], s43 offen sc1 lds
    s_waitcnt lgkmcnt(2)
    v_mad_u32_u16 v222, v222, s39, v248 op_sel:[1,0,0,0]
    v_mad_u32_u16 v223, v223, s39, v248 op_sel:[1,0,0,0]
    v_mfma_f32_32x32x16_bf16 v[32:47], v[72:75], v[188:191], v[32:47]
    v_add_u32 v224, s49, v251
    ds_read2_b32 v[224:225], v224 offset0:1 offset1:3
    v_mfma_f32_32x32x16_bf16 v[48:63], v[76:79], v[188:191], v[48:63]
    s_waitcnt vmcnt(3) lgkmcnt(1)
    v_mfma_f32_32x32x8_bf16 v[0:15], v[80:81], v[176:177], v[0:15]
    ds_read_b64_tr_b16 v[184:185], v246 offset:2048
    ds_read_b64_tr_b16 v[186:187], v246 offset:3072
    ds_read_b64_tr_b16 v[188:189], v247 offset:2048
    ds_read_b64_tr_b16 v[190:191], v247 offset:3072
    s_mov_b32 m0, s68
    v_mfma_f32_32x32x8_bf16 v[16:31], v[84:85], v[176:177], v[16:31]
    buffer_load_dwordx4 v222, s[4:7], s44 offen sc1 lds
    buffer_load_dwordx4 v223, s[72:75], s44 offen offset:1024 sc1 lds
    s_waitcnt lgkmcnt(4)
    v_mad_u32_u16 v224, v224, s39, v248 op_sel:[1,0,0,0]
    v_mad_u32_u16 v225, v225, s39, v248 op_sel:[1,0,0,0]
    v_mfma_f32_32x32x8_bf16 v[32:47], v[80:81], v[180:181], v[32:47]
    v_add_u32 v226, s50, v251
    ds_read2_b32 v[226:227], v226 offset0:1 offset1:3
    v_mul_f32 v242, v0, v144
    v_fma_f32 v238, v8, v160, -v238
    v_fmac_f32 v242, v1, v145
    v_fmac_f32 v238, v9, v161
    v_fmac_f32 v242, v2, v146
    v_mfma_f32_32x32x8_bf16 v[48:63], v[84:85], v[180:181], v[48:63]
    s_setprio 0
    v_fmac_f32 v238, v10, v162
    v_fmac_f32 v242, v3, v147
    v_fmac_f32 v238, v11, v163
    v_fmac_f32 v242, v4, v148
    v_fmac_f32 v238, v12, v164
    v_fmac_f32 v242, v5, v149
    v_fmac_f32 v238, v13, v165
    v_fmac_f32 v242, v6, v150
    v_fmac_f32 v238, v14, v166
    v_fmac_f32 v242, v7, v151
    v_fmac_f32 v238, v15, v167
    v_fmac_f32 v236, v16, v112
    v_mul_f32 v244, v24, v160
    v_fmac_f32 v236, v17, v113
    v_fmac_f32 v244, v25, v161
    v_fmac_f32 v236, v18, v114
    v_fmac_f32 v244, v26, v162
    v_fmac_f32 v236, v19, v115
    v_fmac_f32 v244, v27, v163
    v_fmac_f32 v236, v20, v116
    v_fmac_f32 v244, v28, v164
    v_fmac_f32 v236, v21, v117
    v_fmac_f32 v244, v29, v165
    v_fmac_f32 v236, v22, v118
    v_fmac_f32 v244, v30, v166
    v_fmac_f32 v236, v23, v119
    v_fmac_f32 v244, v31, v167
    v_mul_f32 v243, v32, v152
    v_fma_f32 v239, v40, v168, -v239
    v_fmac_f32 v243, v33, v153
    v_fmac_f32 v239, v41, v169
    v_fmac_f32 v243, v34, v154
    v_fmac_f32 v239, v42, v170
    v_fmac_f32 v243, v35, v155
    v_fmac_f32 v239, v43, v171
    v_fmac_f32 v243, v36, v156
    v_fmac_f32 v239, v44, v172
    v_fmac_f32 v243, v37, v157
    v_fmac_f32 v239, v45, v173
    v_fmac_f32 v243, v38, v158
    v_fmac_f32 v239, v46, v174
    v_fmac_f32 v243, v39, v159
    v_fmac_f32 v239, v47, v175
    v_fmac_f32 v237, v48, v120
    v_mul_f32 v245, v56, v168
    v_fmac_f32 v237, v49, v121
    v_fmac_f32 v245, v57, v169
    v_fmac_f32 v237, v50, v122
    v_fmac_f32 v245, v58, v170
    v_fmac_f32 v237, v51, v123
    s_setprio 1
    s_waitcnt vmcnt(3) lgkmcnt(1)
    v_mfma_f32_32x32x16_bf16 v[0:15], v[64:67], v[184:187], 0
    ds_read_b64_tr_b16 v[176:177], v246 offset:4096
    ds_read_b64_tr_b16 v[178:179], v246 offset:5120
    ds_read_b64_tr_b16 v[180:181], v247 offset:4096
    ds_read_b64_tr_b16 v[182:183], v247 offset:5120
    v_fmac_f32 v245, v59, v171
    v_fmac_f32 v237, v52, v124
    s_mov_b32 m0, s69
    v_mfma_f32_32x32x16_bf16 v[16:31], v[68:71], v[184:187], 0
    buffer_load_dwordx4 v224, s[4:7], s45 offen sc1 lds
    buffer_load_dwordx4 v225, s[72:75], s45 offen offset:1024 sc1 lds
    s_waitcnt lgkmcnt(4)
    v_mad_u32_u16 v226, v226, s39, v248 op_sel:[1,0,0,0]
    v_mad_u32_u16 v227, v227, s39, v248 op_sel:[1,0,0,0]
    v_fmac_f32 v245, v60, v172
    v_fmac_f32 v237, v53, v125
    v_mfma_f32_32x32x16_bf16 v[32:47], v[64:67], v[188:191], 0
    v_add_u32 v228, s51, v251
    ds_read2_b32 v[228:229], v228 offset0:1 offset1:3
    v_fmac_f32 v245, v61, v173
    v_fmac_f32 v237, v54, v126
    v_fmac_f32 v245, v62, v174
    v_fmac_f32 v237, v55, v127
    v_fmac_f32 v245, v63, v175
    v_mfma_f32_32x32x16_bf16 v[48:63], v[68:71], v[188:191], 0
    v_permlane32_swap_b32 v242, v234
    v_permlane32_swap_b32 v243, v235
    v_add_f32 v242, v242, v234
    v_add_f32 v243, v243, v235
    s_waitcnt vmcnt(4) lgkmcnt(1)
    v_mfma_f32_32x32x16_bf16 v[0:15], v[72:75], v[176:179], v[0:15]
    ds_read_b64_tr_b16 v[184:185], v246 offset:6144
    ds_read_b64_tr_b16 v[188:189], v247 offset:6144
    s_set_gpr_idx_on s31, gpr_idx(DST)
    s_nop 0
    v_cvt_pk_bf16_f32 v194, v242, v243
    s_set_gpr_idx_off
    s_mov_b32 s32, s31
    s_mov_b32 m0, s70
    v_mfma_f32_32x32x16_bf16 v[16:31], v[76:79], v[176:179], v[16:31]
    buffer_load_dwordx4 v226, s[4:7], s46 offen sc1 lds
    buffer_load_dwordx4 v227, s[72:75], s46 offen offset:1024 sc1 lds
    s_waitcnt lgkmcnt(2)
    v_mad_u32_u16 v228, v228, s39, v248 op_sel:[1,0,0,0]
    v_mad_u32_u16 v229, v229, s39, v248 op_sel:[1,0,0,0]
    s_sub_u32 s26, s48, s29
    s_mov_b32 s29, s48
    v_mfma_f32_32x32x16_bf16 v[32:47], v[72:75], v[180:183], v[32:47]
    s_mov_b32 s30, s3
    s_bfe_u32 s56, s3, 0x40012
    s_cmp_eq_u32 s34, 0
    s_cselect_b32 s56, s56, 0
    s_mov_b32 s31, s35
    v_mfma_f32_32x32x16_bf16 v[48:63], v[76:79], v[180:183], v[48:63]
    s_waitcnt vmcnt(4) lgkmcnt(0)
    v_mfma_f32_32x32x8_bf16 v[0:15], v[80:81], v[184:185], v[0:15]
    ds_read_b64_tr_b16 v[176:177], v246 offset:0
    ds_read_b64_tr_b16 v[178:179], v246 offset:1024
    ds_read_b64_tr_b16 v[180:181], v247 offset:0
    ds_read_b64_tr_b16 v[182:183], v247 offset:1024
    s_mov_b32 m0, s71
    v_mfma_f32_32x32x8_bf16 v[16:31], v[84:85], v[184:185], v[16:31]
    buffer_load_dwordx4 v228, s[4:7], s47 offen sc1 lds
    buffer_load_dwordx4 v229, s[72:75], s47 offen offset:1024 sc1 lds
    v_mfma_f32_32x32x8_bf16 v[32:47], v[80:81], v[188:189], v[32:47]
    s_nop 2
    v_mul_f32 v242, v0, v144
    v_fma_f32 v240, v8, v160, -v240
    v_fmac_f32 v242, v1, v145
    v_fmac_f32 v240, v9, v161
    v_fmac_f32 v242, v2, v146
    v_fmac_f32 v240, v10, v162
    v_fmac_f32 v242, v3, v147
    v_mfma_f32_32x32x8_bf16 v[48:63], v[84:85], v[188:189], v[48:63]
    s_setprio 0
    v_fmac_f32 v240, v11, v163
    v_fmac_f32 v242, v4, v148
    v_fmac_f32 v240, v12, v164
    v_fmac_f32 v242, v5, v149
    v_fmac_f32 v240, v13, v165
    v_fmac_f32 v242, v6, v150
    v_fmac_f32 v240, v14, v166
    v_fmac_f32 v242, v7, v151
    v_fmac_f32 v240, v15, v167
    v_add_u32 v249, s26, v249
    v_add_u32 v250, s26, v250
    v_fma_f32 v244, v16, v160, -v244
    v_fmac_f32 v236, v24, v112
    v_fmac_f32 v244, v17, v161
    v_fmac_f32 v236, v25, v113
    v_fmac_f32 v244, v18, v162
    v_fmac_f32 v236, v26, v114
    v_fmac_f32 v244, v19, v163
    v_fmac_f32 v236, v27, v115
    v_fmac_f32 v244, v20, v164
    v_fmac_f32 v236, v28, v116
    v_fmac_f32 v244, v21, v165
    v_fmac_f32 v236, v29, v117
    v_fmac_f32 v244, v22, v166
    v_fmac_f32 v236, v30, v118
    v_fmac_f32 v244, v23, v167
    v_fmac_f32 v236, v31, v119
    ds_read_b64_tr_b16 v[0:1], v249 offset:0
    ds_read_b64_tr_b16 v[2:3], v249 offset:32
    ds_read_u16_d16_hi v16, v250 offset:0
    v_mul_f32 v243, v32, v152
    v_fma_f32 v241, v40, v168, -v241
    v_fmac_f32 v243, v33, v153
    v_fmac_f32 v241, v41, v169
    v_fmac_f32 v243, v34, v154
    v_fmac_f32 v241, v42, v170
    v_fmac_f32 v243, v35, v155
    v_fmac_f32 v241, v43, v171
    v_fmac_f32 v243, v36, v156
    v_fmac_f32 v241, v44, v172
    v_fmac_f32 v243, v37, v157
    v_fmac_f32 v241, v45, v173
    v_fmac_f32 v243, v38, v158
    v_fmac_f32 v241, v46, v174
    v_fmac_f32 v243, v39, v159
    v_fmac_f32 v241, v47, v175
    ds_read_b64_tr_b16 v[4:5], v249 offset:512
    ds_read_b64_tr_b16 v[6:7], v249 offset:544
    ds_read_u16_d16_hi v17, v250 offset:128
    v_fma_f32 v245, v48, v168, -v245
    v_fmac_f32 v237, v56, v120
    v_fmac_f32 v245, v49, v169
    v_fmac_f32 v237, v57, v121
    v_fmac_f32 v245, v50, v170
    v_fmac_f32 v237, v58, v122
    v_fmac_f32 v245, v51, v171
    v_fmac_f32 v237, v59, v123
    v_fmac_f32 v245, v52, v172
    v_fmac_f32 v237, v60, v124
    v_fmac_f32 v245, v53, v173
    v_fmac_f32 v237, v61, v125
    v_fmac_f32 v245, v54, v174
    v_fmac_f32 v237, v62, v126
    v_fmac_f32 v245, v55, v175
    v_fmac_f32 v237, v63, v127
    s_cmp_eq_u32 s56, 5
    s_cbranch_scc1 K2_U20
    s_cmp_eq_u32 s56, 6
    s_cbranch_scc1 K2_U3h0
    s_branch K2_DSP0
K2_U30:
    s_setprio 1
    ds_read_b64_tr_b16 v[8:9], v249 offset:1024
    ds_read_b64_tr_b16 v[10:11], v249 offset:1056
    ds_read_u16_d16_hi v18, v250 offset:256
    s_waitcnt lgkmcnt(3)
    v_lshlrev_b32 v20, 16, v0
    v_and_b32 v21, 0xffff0000, v0
    v_lshlrev_b32 v22, 16, v1
    v_and_b32 v23, 0xffff0000, v1
    v_lshlrev_b32 v24, 16, v2
    v_and_b32 v25, 0xffff0000, v2
    v_lshlrev_b32 v26, 16, v3
    v_and_b32 v27, 0xffff0000, v3
    v_mul_f32_dpp v36, v16, v20 row_newbcast:8 row_mask:0xf bank_mask:0xf
    v_mul_f32_dpp v37, v16, v21 row_newbcast:9 row_mask:0xf bank_mask:0xf
    v_mul_f32_dpp v38, v16, v22 row_newbcast:10 row_mask:0xf bank_mask:0xf
    v_mul_f32_dpp v39, v16, v23 row_newbcast:11 row_mask:0xf bank_mask:0xf
    v_mul_f32_dpp v40, v16, v24 row_newbcast:12 row_mask:0xf bank_mask:0xf
    v_mul_f32_dpp v41, v16, v25 row_newbcast:13 row_mask:0xf bank_mask:0xf
    v_mul_f32_dpp v42, v16, v26 row_newbcast:14 row_mask:0xf bank_mask:0xf
    v_mul_f32_dpp v43, v16, v27 row_newbcast:15 row_mask:0xf bank_mask:0xf
    v_cvt_pk_bf16_f32 v68, v36, v37
    v_cvt_pk_bf16_f32 v69, v38, v39
    v_cvt_pk_bf16_f32 v70, v40, v41
    v_cvt_pk_bf16_f32 v71, v42, v43
    v_mul_f32_dpp v20, v16, v20 row_newbcast:0 row_mask:0xa bank_mask:0xf
    v_mul_f32_dpp v21, v16, v21 row_newbcast:1 row_mask:0xa bank_mask:0xf
    v_mul_f32_dpp v22, v16, v22 row_newbcast:2 row_mask:0xa bank_mask:0xf
    v_mul_f32_dpp v23, v16, v23 row_newbcast:3 row_mask:0xa bank_mask:0xf
    v_mul_f32_dpp v24, v16, v24 row_newbcast:4 row_mask:0xa bank_mask:0xf
    v_mul_f32_dpp v25, v16, v25 row_newbcast:5 row_mask:0xa bank_mask:0xf
    v_mul_f32_dpp v26, v16, v26 row_newbcast:6 row_mask:0xa bank_mask:0xf
    v_mul_f32_dpp v27, v16, v27 row_newbcast:7 row_mask:0xa bank_mask:0xf
    v_cvt_pk_bf16_f32 v64, v20, v21
    v_cvt_pk_bf16_f32 v65, v22, v23
    v_cvt_pk_bf16_f32 v66, v24, v25
    v_cvt_pk_bf16_f32 v67, v26, v27
    v_lshlrev_b32 v28, 16, v4
    v_and_b32 v29, 0xffff0000, v4
    v_lshlrev_b32 v30, 16, v5
    v_and_b32 v31, 0xffff0000, v5
    v_lshlrev_b32 v32, 16, v6
    v_and_b32 v33, 0xffff0000, v6
    v_lshlrev_b32 v34, 16, v7
    v_and_b32 v35, 0xffff0000, v7
    v_mul_f32_dpp v36, v17, v28 row_newbcast:8 row_mask:0xf bank_mask:0xf
    v_mul_f32_dpp v37, v17, v29 row_newbcast:9 row_mask:0xf bank_mask:0xf
    v_mul_f32_dpp v38, v17, v30 row_newbcast:10 row_mask:0xf bank_mask:0xf
    v_mul_f32_dpp v39, v17, v31 row_newbcast:11 row_mask:0xf bank_mask:0xf
    v_mul_f32_dpp v40, v17, v32 row_newbcast:12 row_mask:0xf bank_mask:0xf
    v_mul_f32_dpp v41, v17, v33 row_newbcast:13 row_mask:0xf bank_mask:0xf
    v_mul_f32_dpp v42, v17, v34 row_newbcast:14 row_mask:0xf bank_mask:0xf
    v_mul_f32_dpp v43, v17, v35 row_newbcast:15 row_mask:0xf bank_mask:0xf
    v_cvt_pk_bf16_f32 v76, v36, v37
    v_cvt_pk_bf16_f32 v77, v38, v39
    v_cvt_pk_bf16_f32 v78, v40, v41
    v_cvt_pk_bf16_f32 v79, v42, v43
    v_mul_f32_dpp v28, v17, v28 row_newbcast:0 row_mask:0xa bank_mask:0xf
    v_mul_f32_dpp v29, v17, v29 row_newbcast:1 row_mask:0xa bank_mask:0xf
    v_mul_f32_dpp v30, v17, v30 row_newbcast:2 row_mask:0xa bank_mask:0xf
    v_mul_f32_dpp v31, v17, v31 row_newbcast:3 row_mask:0xa bank_mask:0xf
    v_mul_f32_dpp v32, v17, v32 row_newbcast:4 row_mask:0xa bank_mask:0xf
    v_mul_f32_dpp v33, v17, v33 row_newbcast:5 row_mask:0xa bank_mask:0xf
    v_mul_f32_dpp v34, v17, v34 row_newbcast:6 row_mask:0xa bank_mask:0xf
    v_mul_f32_dpp v35, v17, v35 row_newbcast:7 row_mask:0xa bank_mask:0xf
    v_cvt_pk_bf16_f32 v72, v28, v29
    v_cvt_pk_bf16_f32 v73, v30, v31
    v_cvt_pk_bf16_f32 v74, v32, v33
    v_cvt_pk_bf16_f32 v75, v34, v35
    s_waitcnt lgkmcnt(0)
    v_lshlrev_b32 v20, 16, v8
    v_and_b32 v21, 0xffff0000, v8
    v_lshlrev_b32 v22, 16, v9
    v_and_b32 v23, 0xffff0000, v9
    v_lshlrev_b32 v24, 16, v10
    v_and_b32 v25, 0xffff0000, v10
    v_lshlrev_b32 v26, 16, v11
    v_and_b32 v27, 0xffff0000, v11
    v_mul_f32_dpp v36, v18, v20 row_newbcast:8 row_mask:0xf bank_mask:0xf
    v_mul_f32_dpp v37, v18, v21 row_newbcast:9 row_mask:0xf bank_mask:0xf
    v_mul_f32_dpp v38, v18, v22 row_newbcast:10 row_mask:0xf bank_mask:0xf
    v_mul_f32_dpp v39, v18, v23 row_newbcast:11 row_mask:0xf bank_mask:0xf
    v_mul_f32_dpp v40, v18, v24 row_newbcast:12 row_mask:0xf bank_mask:0xf
    v_mul_f32_dpp v41, v18, v25 row_newbcast:13 row_mask:0xf bank_mask:0xf
    v_mul_f32_dpp v42, v18, v26 row_newbcast:14 row_mask:0xf bank_mask:0xf
    v_mul_f32_dpp v43, v18, v27 row_newbcast:15 row_mask:0xf bank_mask:0xf
    v_cvt_pk_bf16_f32 v84, v36, v37
    v_cvt_pk_bf16_f32 v85, v38, v39
    v_cvt_pk_bf16_f32 v86, v40, v41
    v_cvt_pk_bf16_f32 v87, v42, v43
    v_mul_f32_dpp v20, v18, v20 row_newbcast:0 row_mask:0xa bank_mask:0xf
    v_mul_f32_dpp v21, v18, v21 row_newbcast:1 row_mask:0xa bank_mask:0xf
    v_mul_f32_dpp v22, v18, v22 row_newbcast:2 row_mask:0xa bank_mask:0xf
    v_mul_f32_dpp v23, v18, v23 row_newbcast:3 row_mask:0xa bank_mask:0xf
    v_mul_f32_dpp v24, v18, v24 row_newbcast:4 row_mask:0xa bank_mask:0xf
    v_mul_f32_dpp v25, v18, v25 row_newbcast:5 row_mask:0xa bank_mask:0xf
    v_mul_f32_dpp v26, v18, v26 row_newbcast:6 row_mask:0xa bank_mask:0xf
    v_mul_f32_dpp v27, v18, v27 row_newbcast:7 row_mask:0xa bank_mask:0xf
    v_cvt_pk_bf16_f32 v80, v20, v21
    v_cvt_pk_bf16_f32 v81, v22, v23
    v_cvt_pk_bf16_f32 v82, v24, v25
    v_cvt_pk_bf16_f32 v83, v26, v27
    s_waitcnt vmcnt(4)
    v_mfma_f32_32x32x16_bf16 v[0:15], v[64:67], v[176:179], 0
    ds_read_b64_tr_b16 v[184:185], v246 offset:2048
    ds_read_b64_tr_b16 v[186:187], v246 offset:3072
    ds_read_b64_tr_b16 v[188:189], v247 offset:2048
    ds_read_b64_tr_b16 v[190:191], v247 offset:3072
    s_mov_b32 m0, s68
    v_mfma_f32_32x32x16_bf16 v[16:31], v[68:71], v[176:179], 0
    buffer_load_dwordx4 v224, s[4:7], s41 offen sc1 lds
    buffer_load_dwordx4 v225, s[72:75], s41 offen offset:1024 sc1 lds
    v_permlane32_swap_b32 v242, v236
    v_permlane32_swap_b32 v243, v237
    s_add_u32 s38, s38, 1
    v_mfma_f32_32x32x16_bf16 v[32:47], v[64:67], v[180:183], 0
    v_permlane32_swap_b32 v244, v238
    v_permlane32_swap_b32 v245, v239
    v_permlane32_swap_b32 v240, v241
    v_add_f32 v242, v242, v236
    v_mfma_f32_32x32x16_bf16 v[48:63], v[68:71], v[180:183], 0
    v_add_f32 v243, v243, v237
    v_add_f32 v244, v244, v238
    v_add_f32 v245, v245, v239
    v_add_f32 v240, -v240, -v241
    v_mov_b32 v254, s52
    v_mov_b32 v255, s38
    s_waitcnt vmcnt(4) lgkmcnt(0)
    v_mfma_f32_32x32x16_bf16 v[0:15], v[72:75], v[184:187], v[0:15]
    ds_read_b64_tr_b16 v[176:177], v246 offset:4096
    ds_read_b64_tr_b16 v[178:179], v246 offset:5120
    ds_read_b64_tr_b16 v[180:181], v247 offset:4096
    ds_read_b64_tr_b16 v[182:183], v247 offset:5120
    s_lshl_b32 s58, s38, 3
    s_add_u32 s58, s58, s20
    s_mov_b32 m0, s69
    v_mfma_f32_32x32x16_bf16 v[16:31], v[76:79], v[184:187], v[16:31]
    buffer_load_dwordx4 v226, s[4:7], s41 offen sc1 lds
    buffer_load_dwordx4 v227, s[72:75], s41 offen offset:1024 sc1 lds
    s_set_gpr_idx_on s32, gpr_idx(DST)
    s_nop 0
    v_cvt_pk_bf16_f32 v195, v242, v243
    v_cvt_pk_bf16_f32 v196, v244, v245
    v_cvt_pk_bf16_f32 v197, v240, v240
    s_set_gpr_idx_off
    s_mov_b64 exec, 1
    ds_write_b32 v254, v255
    s_mov_b64 exec, -1
    s_cmp_lt_u32 s58, s22
    s_cbranch_scc0 K2_dyn_34
K2_back_35:
    v_readlane_b32 s3, v253, s58
    s_lshl_b32 s44, s34, 7
    s_and_b32 s48, s3, 0x3ffff
    s_bfe_u32 s33, s3, 0x30013
    s_mul_i32 s35, s38, 6
    s_cmp_eq_u32 s34, 0
    s_cselect_b32 s35, s35, s48
    s_mov_b32 s45, s44
    s_xor_b32 s47, s44, 256
    s_add_u32 s49, s48, 128
    s_add_u32 s60, s48, 256
    s_cmp_eq_u32 s33, 3
    s_cselect_b32 s46, s44, s47
    s_cselect_b32 s50, s60, s48
    s_cselect_b32 s51, s48, s49
    s_sub_u32 s60, s33, 2
    s_cmp_lt_u32 s60, 2
    s_cbranch_scc0 K2_rare_40
K2_back_41:
    v_mfma_f32_32x32x16_bf16 v[32:47], v[72:75], v[188:191], v[32:47]
    v_add_u32 v233, s48, v230
    ds_read_b32 v232, v233
    ds_read_b32 v233, v233 offset:1024
    v_mfma_f32_32x32x16_bf16 v[48:63], v[76:79], v[188:191], v[48:63]
    s_waitcnt vmcnt(4) lgkmcnt(3)
    v_mfma_f32_32x32x16_bf16 v[0:15], v[80:83], v[176:179], v[0:15]
    ds_read_b64_tr_b16 v[184:185], v246 offset:6144
    ds_read_b64_tr_b16 v[186:187], v246 offset:7168
    ds_read_b64_tr_b16 v[188:189], v247 offset:6144
    ds_read_b64_tr_b16 v[190:191], v247 offset:7168
    s_mov_b32 m0, s70
    v_mfma_f32_32x32x16_bf16 v[16:31], v[84:87], v[176:179], v[16:31]
    buffer_load_dwordx4 v222, s[4:7], s42 offen sc1 lds
    buffer_load_dwordx4 v223, s[72:75], s42 offen offset:1024 sc1 lds
    v_mfma_f32_32x32x16_bf16 v[32:47], v[80:83], v[180:183], v[32:47]
    s_nop 2
    v_mul_f32 v234, v0, v96
    v_mul_f32 v236, v8, v128
    v_fmac_f32 v234, v1, v97
    v_fmac_f32 v236, v9, v129
    v_fmac_f32 v234, v2, v98
    v_fmac_f32 v236, v10, v130
    v_fmac_f32 v234, v3, v99
    v_mfma_f32_32x32x16_bf16 v[48:63], v[84:87], v[180:183], v[48:63]
    s_setprio 0
    s_waitcnt lgkmcnt(4)
    v_or_b32 v232, v232, v231
    v_or_b32 v233, v233, v231
    s_cmp_lg_u32 s34, 0
    s_cbranch_scc1 K2_dum_43
    s_cmp_eq_u32 s33, 4
    s_cbranch_scc1 K2_a4_44
K2_b4_46:
    s_add_u32 m0, s48, 512
    s_add_u32 s65, s48, 1536
    buffer_load_dwordx4 v232, s[16:19], 0 offen  lds
    s_mov_b32 m0, s65
    s_mov_b32 exec_hi, 0
    buffer_load_dwordx4 v233, s[16:19], 0 offen  lds
    s_mov_b32 exec_hi, -1
K2_back_45:
    v_fmac_f32 v236, v11, v131
    v_fmac_f32 v234, v4, v100
    v_fmac_f32 v236, v12, v132
    v_fmac_f32 v234, v5, v101
    v_fmac_f32 v236, v13, v133
    v_fmac_f32 v234, v6, v102
    v_fmac_f32 v236, v14, v134
    v_fmac_f32 v234, v7, v103
    v_fmac_f32 v236, v15, v135
    v_mul_f32 v238, v16, v128
    v_mul_f32 v240, v24, v128
    v_fmac_f32 v238, v17, v129
    v_fmac_f32 v240, v25, v129
    v_fmac_f32 v238, v18, v130
    v_fmac_f32 v240, v26, v130
    v_fmac_f32 v238, v19, v131
    v_fmac_f32 v240, v27, v131
    v_fmac_f32 v238, v20, v132
    v_fmac_f32 v240, v28, v132
    v_fmac_f32 v238, v21, v133
    v_fmac_f32 v240, v29, v133
    v_fmac_f32 v238, v22, v134
    v_fmac_f32 v240, v30, v134
    v_fmac_f32 v238, v23, v135
    v_fmac_f32 v240, v31, v135
    v_mul_f32 v235, v32, v104
    v_mul_f32 v237, v40, v136
    v_fmac_f32 v235, v33, v105
    v_fmac_f32 v237, v41, v137
    v_fmac_f32 v235, v34, v106
    v_fmac_f32 v237, v42, v138
    v_fmac_f32 v235, v35, v107
    v_fmac_f32 v237, v43, v139
    v_fmac_f32 v235, v36, v108
    v_fmac_f32 v237, v44, v140
    v_fmac_f32 v235, v37, v109
    v_fmac_f32 v237, v45, v141
    v_fmac_f32 v235, v38, v110
    v_fmac_f32 v237, v46, v142
    v_fmac_f32 v235, v39, v111
    v_fmac_f32 v237, v47, v143
    v_mul_f32 v239, v48, v136
    v_mul_f32 v241, v56, v136
    s_setprio 1
    s_waitcnt vmcnt(6) lgkmcnt(0)
    v_mfma_f32_32x32x16_bf16 v[0:15], v[64:67], v[184:187], 0
    ds_read_b64_tr_b16 v[176:177], v246 offset:0
    ds_read_b64_tr_b16 v[178:179], v246 offset:1024
    ds_read_b64_tr_b16 v[180:181], v247 offset:0
    ds_read_b64_tr_b16 v[182:183], v247 offset:1024
    v_fmac_f32 v239, v49, v137
    v_fmac_f32 v241, v57, v137
    s_mov_b32 m0, s71
    v_mfma_f32_32x32x16_bf16 v[16:31], v[68:71], v[184:187], 0
    buffer_load_dwordx4 v224, s[4:7], s42 offen sc1 lds
    buffer_load_dwordx4 v225, s[72:75], s42 offen offset:1024 sc1 lds
    v_fmac_f32 v239, v50, v138
    v_fmac_f32 v241, v58, v138
    v_fmac_f32 v239, v51, v139
    v_fmac_f32 v241, v59, v139
    v_fmac_f32 v239, v52, v140
    v_mfma_f32_32x32x16_bf16 v[32:47], v[64:67], v[188:191], 0
    v_fmac_f32 v241, v60, v140
    v_fmac_f32 v239, v53, v141
    v_fmac_f32 v241, v61, v141
    v_fmac_f32 v239, v54, v142
    v_fmac_f32 v241, v62, v142
    v_fmac_f32 v239, v55, v143
    v_fmac_f32 v241, v63, v143
    v_mfma_f32_32x32x16_bf16 v[48:63], v[68:71], v[188:191], 0
    v_permlane32_swap_b32 v234, v236
    v_permlane32_swap_b32 v235, v237
    v_permlane32_swap_b32 v240, v238
    s_waitcnt vmcnt(6) lgkmcnt(0)
    v_mfma_f32_32x32x16_bf16 v[0:15], v[72:75], v[176:179], v[0:15]
    ds_read_b64_tr_b16 v[184:185], v246 offset:2048
    ds_read_b64_tr_b16 v[186:187], v246 offset:3072
    ds_read_b64_tr_b16 v[188:189], v247 offset:2048
    ds_read_b64_tr_b16 v[190:191], v247 offset:3072
    v_permlane32_swap_b32 v241, v239
    s_mov_b32 m0, s68
    v_mfma_f32_32x32x16_bf16 v[16:31], v[76:79], v[176:179], v[16:31]
    buffer_load_dwordx4 v226, s[4:7], s42 offen sc1 lds
    buffer_load_dwordx4 v227, s[72:75], s42 offen offset:1024 sc1 lds
    v_add_f32 v234, v234, v236
    v_add_f32 v235, v235, v237
    v_add_f32 v240, v240, v238
    v_add_f32 v241, v241, v239
    v_mfma_f32_32x32x16_bf16 v[32:47], v[72:75], v[180:183], v[32:47]
    s_set_gpr_idx_on s31, gpr_idx(DST)
    s_nop 0
    v_cvt_pk_bf16_f32 v192, v234, v235
    v_cvt_pk_bf16_f32 v193, v240, v241
    s_set_gpr_idx_off
    v_mfma_f32_32x32x16_bf16 v[48:63], v[76:79], v[180:183], v[48:63]
    s_waitcnt vmcnt(6) lgkmcnt(0)
    v_mfma_f32_32x32x16_bf16 v[0:15], v[80:83], v[184:187], v[0:15]
    ds_read_b64_tr_b16 v[176:177], v246 offset:4096
    ds_read_b64_tr_b16 v[178:179], v246 offset:5120
    ds_read_b64_tr_b16 v[180:181], v247 offset:4096
    ds_read_b64_tr_b16 v[182:183], v247 offset:5120
    s_mov_b32 m0, s69
    v_mfma_f32_32x32x16_bf16 v[16:31], v[84:87], v[184:187], v[16:31]
    buffer_load_dwordx4 v222, s[4:7], s43 offen sc1 lds
    buffer_load_dwordx4 v223, s[72:75], s43 offen offset:1024 sc1 lds
    v_mfma_f32_32x32x16_bf16 v[32:47], v[80:83], v[188:191], v[32:47]
    s_nop 2
    v_mul_f32 v234, v0, v144
    v_mul_f32 v236, v8, v112
    v_fmac_f32 v234, v1, v145
    v_fmac_f32 v236, v9, v113
    v_fmac_f32 v234, v2, v146
    v_fmac_f32 v236, v10, v114
    v_fmac_f32 v234, v3, v147
    v_mfma_f32_32x32x16_bf16 v[48:63], v[84:87], v[188:191], v[48:63]
    s_setprio 0
    v_fmac_f32 v236, v11, v115
    v_fmac_f32 v234, v4, v148
    v_fmac_f32 v236, v12, v116
    v_fmac_f32 v234, v5, v149
    v_fmac_f32 v236, v13, v117
    v_fmac_f32 v234, v6, v150
    v_fmac_f32 v236, v14, v118
    v_fmac_f32 v234, v7, v151
    v_fmac_f32 v236, v15, v119
    v_mul_f32 v238, v16, v160
    v_mul_f32 v240, v24, v160
    v_fmac_f32 v238, v17, v161
    v_fmac_f32 v240, v25, v161
    v_fmac_f32 v238, v18, v162
    v_fmac_f32 v240, v26, v162
    v_fmac_f32 v238, v19, v163
    v_fmac_f32 v240, v27, v163
    v_fmac_f32 v238, v20, v164
    v_fmac_f32 v240, v28, v164
    v_fmac_f32 v238, v21, v165
    v_fmac_f32 v240, v29, v165
    v_fmac_f32 v238, v22, v166
    v_fmac_f32 v240, v30, v166
    v_fmac_f32 v238, v23, v167
    v_fmac_f32 v240, v31, v167
    v_mul_f32 v235, v32, v152
    v_mul_f32 v237, v40, v120
    v_fmac_f32 v235, v33, v153
    v_fmac_f32 v237, v41, v121
    v_fmac_f32 v235, v34, v154
    v_fmac_f32 v237, v42, v122
    v_fmac_f32 v235, v35, v155
    v_fmac_f32 v237, v43, v123
    v_fmac_f32 v235, v36, v156
    v_fmac_f32 v237, v44, v124
    v_fmac_f32 v235, v37, v157
    v_fmac_f32 v237, v45, v125
    v_fmac_f32 v235, v38, v158
    v_fmac_f32 v237, v46, v126
    v_fmac_f32 v235, v39, v159
    v_fmac_f32 v237, v47, v127
    v_mul_f32 v239, v48, v168
    v_mul_f32 v241, v56, v168
    v_fmac_f32 v239, v49, v169
    v_fmac_f32 v241, v57, v169
    s_setprio 1
    s_waitcnt vmcnt(4) lgkmcnt(0)
    v_mfma_f32_32x32x16_bf16 v[0:15], v[64:67], v[176:179], 0
    ds_read_b64_tr_b16 v[184:185], v246 offset:6144
    ds_read_b64_tr_b16 v[186:187], v246 offset:7168
    ds_read_b64_tr_b16 v[188:189], v247 offset:6144
    ds_read_b64_tr_b16 v[190:191], v247 offset:7168
    v_fmac_f32 v239, v50, v170
    v_fmac_f32 v241, v58, v170
    s_mov_b32 m0, s70
    v_mfma_f32_32x32x16_bf16 v[16:31], v[68:71], v[176:179], 0
    buffer_load_dwordx4 v224, s[4:7], s43 offen sc1 lds
    buffer_load_dwordx4 v225, s[72:75], s43 offen offset:1024 sc1 lds
    v_fmac_f32 v239, v51, v171
    v_fmac_f32 v241, v59, v171
    v_fmac_f32 v239, v52, v172
    v_fmac_f32 v241, v60, v172
    v_fmac_f32 v239, v53, v173
    v_mfma_f32_32x32x16_bf16 v[32:47], v[64:67], v[180:183], 0
    v_add_u32 v222, s48, v251
    ds_read2_b32 v[222:223], v222 offset0:1 offset1:3
    v_fmac_f32 v241, v61, v173
    v_fmac_f32 v239, v54, v174
    v_fmac_f32 v241, v62, v174
    v_fmac_f32 v239, v55, v175
    v_fmac_f32 v241, v63, v175
    v_mfma_f32_32x32x16_bf16 v[48:63], v[68:71], v[180:183], 0
    s_waitcnt vmcnt(4) lgkmcnt(1)
    v_mfma_f32_32x32x16_bf16 v[0:15], v[72:75], v[184:187], v[0:15]
    ds_read_b64_tr_b16 v[176:177], v246 offset:0
    ds_read_b64_tr_b16 v[178:179], v246 offset:1024
    ds_read_b64_tr_b16 v[180:181], v247 offset:0
    ds_read_b64_tr_b16 v[182:183], v247 offset:1024
    s_mov_b32 m0, s71
    v_mfma_f32_32x32x16_bf16 v[16:31], v[76:79], v[184:187], v[16:31]
    buffer_load_dwordx4 v226, s[4:7], s43 offen sc1 lds
    buffer_load_dwordx4 v227, s[72:75], s43 offen offset:1024 sc1 lds
    s_waitcnt lgkmcnt(4)
    v_mad_u32_u16 v222, v222, s39, v248 op_sel:[1,0,0,0]
    v_mad_u32_u16 v223, v223, s39, v248 op_sel:[1,0,0,0]
    v_mfma_f32_32x32x16_bf16 v[32:47], v[72:75], v[188:191], v[32:47]
    v_add_u32 v224, s49, v251
    ds_read2_b32 v[224:225], v224 offset0:1 offset1:3
    v_mfma_f32_32x32x16_bf16 v[48:63], v[76:79], v[188:191], v[48:63]
    s_waitcnt vmcnt(4) lgkmcnt(1)
    v_mfma_f32_32x32x16_bf16 v[0:15], v[80:83], v[176:179], v[0:15]
    ds_read_b64_tr_b16 v[184:185], v246 offset:2048
    ds_read_b64_tr_b16 v[186:187], v246 offset:3072
    ds_read_b64_tr_b16 v[188:189], v247 offset:2048
    ds_read_b64_tr_b16 v[190:191], v247 offset:3072
    s_mov_b32 m0, s68
    v_mfma_f32_32x32x16_bf16 v[16:31], v[84:87], v[176:179], v[16:31]
    buffer_load_dwordx4 v222, s[4:7], s44 offen sc1 lds
    buffer_load_dwordx4 v223, s[72:75], s44 offen offset:1024 sc1 lds
    s_waitcnt lgkmcnt(4)
    v_mad_u32_u16 v224, v224, s39, v248 op_sel:[1,0,0,0]
    v_mad_u32_u16 v225, v225, s39, v248 op_sel:[1,0,0,0]
    v_mfma_f32_32x32x16_bf16 v[32:47], v[80:83], v[180:183], v[32:47]
    v_add_u32 v226, s50, v251
    ds_read2_b32 v[226:227], v226 offset0:1 offset1:3
    v_mul_f32 v242, v0, v144
    v_fma_f32 v238, v8, v160, -v238
    v_fmac_f32 v242, v1, v145
    v_fmac_f32 v238, v9, v161
    v_fmac_f32 v242, v2, v146
    v_mfma_f32_32x32x16_bf16 v[48:63], v[84:87], v[180:183], v[48:63]
    s_setprio 0
    v_fmac_f32 v238, v10, v162
    v_fmac_f32 v242, v3, v147
    v_fmac_f32 v238, v11, v163
    v_fmac_f32 v242, v4, v148
    v_fmac_f32 v238, v12, v164
    v_fmac_f32 v242, v5, v149
    v_fmac_f32 v238, v13, v165
    v_fmac_f32 v242, v6, v150
    v_fmac_f32 v238, v14, v166
    v_fmac_f32 v242, v7, v151
    v_fmac_f32 v238, v15, v167
    v_fmac_f32 v236, v16, v112
    v_mul_f32 v244, v24, v160
    v_fmac_f32 v236, v17, v113
    v_fmac_f32 v244, v25, v161
    v_fmac_f32 v236, v18, v114
    v_fmac_f32 v244, v26, v162
    v_fmac_f32 v236, v19, v115
    v_fmac_f32 v244, v27, v163
    v_fmac_f32 v236, v20, v116
    v_fmac_f32 v244, v28, v164
    v_fmac_f32 v236, v21, v117
    v_fmac_f32 v244, v29, v165
    v_fmac_f32 v236, v22, v118
    v_fmac_f32 v244, v30, v166
    v_fmac_f32 v236, v23, v119
    v_fmac_f32 v244, v31, v167
    v_mul_f32 v243, v32, v152
    v_fma_f32 v239, v40, v168, -v239
    v_fmac_f32 v243, v33, v153
    v_fmac_f32 v239, v41, v169
    v_fmac_f32 v243, v34, v154
    v_fmac_f32 v239, v42, v170
    v_fmac_f32 v243, v35, v155
    v_fmac_f32 v239, v43, v171
    v_fmac_f32 v243, v36, v156
    v_fmac_f32 v239, v44, v172
    v_fmac_f32 v243, v37, v157
    v_fmac_f32 v239, v45, v173
    v_fmac_f32 v243, v38, v158
    v_fmac_f32 v239, v46, v174
    v_fmac_f32 v243, v39, v159
    v_fmac_f32 v239, v47, v175
    v_fmac_f32 v237, v48, v120
    v_mul_f32 v245, v56, v168
    v_fmac_f32 v237, v49, v121
    v_fmac_f32 v245, v57, v169
    v_fmac_f32 v237, v50, v122
    v_fmac_f32 v245, v58, v170
    v_fmac_f32 v237, v51, v123
    s_setprio 1
    s_waitcnt vmcnt(4) lgkmcnt(1)
    v_mfma_f32_32x32x16_bf16 v[0:15], v[64:67], v[184:187], 0
    ds_read_b64_tr_b16 v[176:177], v246 offset:4096
    ds_read_b64_tr_b16 v[178:179], v246 offset:5120
    ds_read_b64_tr_b16 v[180:181], v247 offset:4096
    ds_read_b64_tr_b16 v[182:183], v247 offset:5120
    v_fmac_f32 v245, v59, v171
    v_fmac_f32 v237, v52, v124
    s_mov_b32 m0, s69
    v_mfma_f32_32x32x16_bf16 v[16:31], v[68:71], v[184:187], 0
    buffer_load_dwordx4 v224, s[4:7], s45 offen sc1 lds
    buffer_load_dwordx4 v225, s[72:75], s45 offen offset:1024 sc1 lds
    s_waitcnt lgkmcnt(4)
    v_mad_u32_u16 v226, v226, s39, v248 op_sel:[1,0,0,0]
    v_mad_u32_u16 v227, v227, s39, v248 op_sel:[1,0,0,0]
    v_fmac_f32 v245, v60, v172
    v_fmac_f32 v237, v53, v125
    v_mfma_f32_32x32x16_bf16 v[32:47], v[64:67], v[188:191], 0
    v_add_u32 v228, s51, v251
    ds_read2_b32 v[228:229], v228 offset0:1 offset1:3
    v_fmac_f32 v245, v61, v173
    v_fmac_f32 v237, v54, v126
    v_fmac_f32 v245, v62, v174
    v_fmac_f32 v237, v55, v127
    v_fmac_f32 v245, v63, v175
    v_mfma_f32_32x32x16_bf16 v[48:63], v[68:71], v[188:191], 0
    v_permlane32_swap_b32 v242, v234
    v_permlane32_swap_b32 v243, v235
    v_add_f32 v242, v242, v234
    v_add_f32 v243, v243, v235
    s_waitcnt vmcnt(4) lgkmcnt(1)
    v_mfma_f32_32x32x16_bf16 v[0:15], v[72:75], v[176:179], v[0:15]
    ds_read_b64_tr_b16 v[184:185], v246 offset:6144
    ds_read_b64_tr_b16 v[186:187], v246 offset:7168
    ds_read_b64_tr_b16 v[188:189], v247 offset:6144
    ds_read_b64_tr_b16 v[190:191], v247 offset:7168
    s_mov_b32 m0, s70
    v_mfma_f32_32x32x16_bf16 v[16:31], v[76:79], v[176:179], v[16:31]
    buffer_load_dwordx4 v226, s[4:7], s46 offen sc1 lds
    buffer_load_dwordx4 v227, s[72:75], s46 offen offset:1024 sc1 lds
    s_waitcnt lgkmcnt(4)
    v_mad_u32_u16 v228, v228, s39, v248 op_sel:[1,0,0,0]
    v_mad_u32_u16 v229, v229, s39, v248 op_sel:[1,0,0,0]
    s_sub_u32 s26, s48, s29
    s_mov_b32 s29, s48
    v_mfma_f32_32x32x16_bf16 v[32:47], v[72:75], v[180:183], v[32:47]
    s_set_gpr_idx_on s31, gpr_idx(DST)
    s_nop 0
    v_cvt_pk_bf16_f32 v194, v242, v243
    s_set_gpr_idx_off
    s_mov_b32 s30, s3
    s_bfe_u32 s56, s3, 0x40012
    s_cmp_eq_u32 s34, 0
    s_cselect_b32 s56, s56, 0
    v_mfma_f32_32x32x16_bf16 v[48:63], v[76:79], v[180:183], v[48:63]
    s_mov_b32 s32, s31
    s_mov_b32 s31, s35
    s_waitcnt vmcnt(4) lgkmcnt(0)
    v_mfma_f32_32x32x16_bf16 v[0:15], v[80:83], v[184:187], v[0:15]
    ds_read_b64_tr_b16 v[176:177], v246 offset:0
    ds_read_b64_tr_b16 v[178:179], v246 offset:1024
    ds_read_b64_tr_b16 v[180:181], v247 offset:0
    ds_read_b64_tr_b16 v[182:183], v247 offset:1024
    s_mov_b32 m0, s71
    v_mfma_f32_32x32x16_bf16 v[16:31], v[84:87], v[184:187], v[16:31]
    buffer_load_dwordx4 v228, s[4:7], s47 offen sc1 lds
    buffer_load_dwordx4 v229, s[72:75], s47 offen offset:1024 sc1 lds
    v_mfma_f32_32x32x16_bf16 v[32:47], v[80:83], v[188:191], v[32:47]
    s_nop 2
    v_mul_f32 v242, v0, v144
    v_fma_f32 v240, v8, v160, -v240
    v_fmac_f32 v242, v1, v145
    v_fmac_f32 v240, v9, v161
    v_fmac_f32 v242, v2, v146
    v_fmac_f32 v240, v10, v162
    v_fmac_f32 v242, v3, v147
    v_mfma_f32_32x32x16_bf16 v[48:63], v[84:87], v[188:191], v[48:63]
    s_setprio 0
    v_fmac_f32 v240, v11, v163
    v_fmac_f32 v242, v4, v148
    v_fmac_f32 v240, v12, v164
    v_fmac_f32 v242, v5, v149
    v_fmac_f32 v240, v13, v165
    v_fmac_f32 v242, v6, v150
    v_fmac_f32 v240, v14, v166
    v_fmac_f32 v242, v7, v151
    v_fmac_f32 v240, v15, v167
    v_add_u32 v249, s26, v249
    v_add_u32 v250, s26, v250
    v_fma_f32 v244, v16, v160, -v244
    v_fmac_f32 v236, v24, v112
    v_fmac_f32 v244, v17, v161
    v_fmac_f32 v236, v25, v113
    v_fmac_f32 v244, v18, v162
    v_fmac_f32 v236, v26, v114
    v_fmac_f32 v244, v19, v163
    v_fmac_f32 v236, v27, v115
    v_fmac_f32 v244, v20, v164
    v_fmac_f32 v236, v28, v116
    v_fmac_f32 v244, v21, v165
    v_fmac_f32 v236, v29, v117
    v_fmac_f32 v244, v22, v166
    v_fmac_f32 v236, v30, v118
    v_fmac_f32 v244, v23, v167
    v_fmac_f32 v236, v31, v119
    ds_read_b64_tr_b16 v[0:1], v249 offset:0
    ds_read_b64_tr_b16 v[2:3], v249 offset:32
    ds_read_u16_d16_hi v16, v250 offset:0
    v_mul_f32 v243, v32, v152
    v_fma_f32 v241, v40, v168, -v241
    v_fmac_f32 v243, v33, v153
    v_fmac_f32 v241, v41, v169
    v_fmac_f32 v243, v34, v154
    v_fmac_f32 v241, v42, v170
    v_fmac_f32 v243, v35, v155
    v_fmac_f32 v241, v43, v171
    v_fmac_f32 v243, v36, v156
    v_fmac_f32 v241, v44, v172
    v_fmac_f32 v243, v37, v157
    v_fmac_f32 v241, v45, v173
    v_fmac_f32 v243, v38, v158
    v_fmac_f32 v241, v46, v174
    v_fmac_f32 v243, v39, v159
    v_fmac_f32 v241, v47, v175
    ds_read_b64_tr_b16 v[4:5], v249 offset:512
    ds_read_b64_tr_b16 v[6:7], v249 offset:544
    ds_read_u16_d16_hi v17, v250 offset:128
    v_fma_f32 v245, v48, v168, -v245
    v_fmac_f32 v237, v56, v120
    v_fmac_f32 v245, v49, v169
    v_fmac_f32 v237, v57, v121
    v_fmac_f32 v245, v50, v170
    v_fmac_f32 v237, v58, v122
    v_fmac_f32 v245, v51, v171
    v_fmac_f32 v237, v59, v123
    v_fmac_f32 v245, v52, v172
    v_fmac_f32 v237, v60, v124
    v_fmac_f32 v245, v53, v173
    v_fmac_f32 v237, v61, v125
    v_fmac_f32 v245, v54, v174
    v_fmac_f32 v237, v62, v126
    v_fmac_f32 v245, v55, v175
    v_fmac_f32 v237, v63, v127
    s_cmp_eq_u32 s56, 5
    s_cbranch_scc1 K2_U20
    s_cmp_eq_u32 s56, 6
    s_cbranch_scc1 K2_U3h0
    s_branch K2_DSP0
K2_PAD_U21:
    s_branch K2_HOP
K2_U21:
    s_setprio 1
    s_waitcnt lgkmcnt(0)
    v_lshlrev_b32 v20, 16, v0
    v_and_b32 v21, 0xffff0000, v0
    v_lshlrev_b32 v22, 16, v1
    v_and_b32 v23, 0xffff0000, v1
    v_lshlrev_b32 v24, 16, v2
    v_and_b32 v25, 0xffff0000, v2
    v_lshlrev_b32 v26, 16, v3
    v_and_b32 v27, 0xffff0000, v3
    v_mul_f32_dpp v36, v16, v20 row_newbcast:8 row_mask:0xf bank_mask:0xf
    v_mul_f32_dpp v37, v16, v21 row_newbcast:9 row_mask:0xf bank_mask:0xf
    v_mul_f32_dpp v38, v16, v22 row_newbcast:10 row_mask:0xf bank_mask:0xf
    v_mul_f32_dpp v39, v16, v23 row_newbcast:11 row_mask:0xf bank_mask:0xf
    v_mul_f32_dpp v40, v16, v24 row_newbcast:12 row_mask:0xf bank_mask:0xf
    v_mul_f32_dpp v41, v16, v25 row_newbcast:13 row_mask:0xf bank_mask:0xf
    v_mul_f32_dpp v42, v16, v26 row_newbcast:14 row_mask:0xf bank_mask:0xf
    v_mul_f32_dpp v43, v16, v27 row_newbcast:15 row_mask:0xf bank_mask:0xf
    v_cvt_pk_bf16_f32 v68, v36, v37
    v_cvt_pk_bf16_f32 v69, v38, v39
    v_cvt_pk_bf16_f32 v70, v40, v41
    v_cvt_pk_bf16_f32 v71, v42, v43
    v_mul_f32_dpp v20, v16, v20 row_newbcast:0 row_mask:0xa bank_mask:0xf
    v_mul_f32_dpp v21, v16, v21 row_newbcast:1 row_mask:0xa bank_mask:0xf
    v_mul_f32_dpp v22, v16, v22 row_newbcast:2 row_mask:0xa bank_mask:0xf
    v_mul_f32_dpp v23, v16, v23 row_newbcast:3 row_mask:0xa bank_mask:0xf
    v_mul_f32_dpp v24, v16, v24 row_newbcast:4 row_mask:0xa bank_mask:0xf
    v_mul_f32_dpp v25, v16, v25 row_newbcast:5 row_mask:0xa bank_mask:0xf
    v_mul_f32_dpp v26, v16, v26 row_newbcast:6 row_mask:0xa bank_mask:0xf
    v_mul_f32_dpp v27, v16, v27 row_newbcast:7 row_mask:0xa bank_mask:0xf
    v_cvt_pk_bf16_f32 v64, v20, v21
    v_cvt_pk_bf16_f32 v65, v22, v23
    v_cvt_pk_bf16_f32 v66, v24, v25
    v_cvt_pk_bf16_f32 v67, v26, v27
    v_lshlrev_b32 v28, 16, v4
    v_and_b32 v29, 0xffff0000, v4
    v_lshlrev_b32 v30, 16, v5
    v_and_b32 v31, 0xffff0000, v5
    v_lshlrev_b32 v32, 16, v6
    v_and_b32 v33, 0xffff0000, v6
    v_lshlrev_b32 v34, 16, v7
    v_and_b32 v35, 0xffff0000, v7
    v_mul_f32_dpp v36, v17, v28 row_newbcast:8 row_mask:0xf bank_mask:0xf
    v_mul_f32_dpp v37, v17, v29 row_newbcast:9 row_mask:0xf bank_mask:0xf
    v_mul_f32_dpp v38, v17, v30 row_newbcast:10 row_mask:0xf bank_mask:0xf
    v_mul_f32_dpp v39, v17, v31 row_newbcast:11 row_mask:0xf bank_mask:0xf
    v_mul_f32_dpp v40, v17, v32 row_newbcast:12 row_mask:0xf bank_mask:0xf
    v_mul_f32_dpp v41, v17, v33 row_newbcast:13 row_mask:0xf bank_mask:0xf
    v_mul_f32_dpp v42, v17, v34 row_newbcast:14 row_mask:0xf bank_mask:0xf
    v_mul_f32_dpp v43, v17, v35 row_newbcast:15 row_mask:0xf bank_mask:0xf
    v_cvt_pk_bf16_f32 v76, v36, v37
    v_cvt_pk_bf16_f32 v77, v38, v39
    v_cvt_pk_bf16_f32 v78, v40, v41
    v_cvt_pk_bf16_f32 v79, v42, v43
    v_mul_f32_dpp v28, v17, v28 row_newbcast:0 row_mask:0xa bank_mask:0xf
    v_mul_f32_dpp v29, v17, v29 row_newbcast:1 row_mask:0xa bank_mask:0xf
    v_mul_f32_dpp v30, v17, v30 row_newbcast:2 row_mask:0xa bank_mask:0xf
    v_mul_f32_dpp v31, v17, v31 row_newbcast:3 row_mask:0xa bank_mask:0xf
    v_mul_f32_dpp v32, v17, v32 row_newbcast:4 row_mask:0xa bank_mask:0xf
    v_mul_f32_dpp v33, v17, v33 row_newbcast:5 row_mask:0xa bank_mask:0xf
    v_mul_f32_dpp v34, v17, v34 row_newbcast:6 row_mask:0xa bank_mask:0xf
    v_mul_f32_dpp v35, v17, v35 row_newbcast:7 row_mask:0xa bank_mask:0xf
    v_cvt_pk_bf16_f32 v72, v28, v29
    v_cvt_pk_bf16_f32 v73, v30, v31
    v_cvt_pk_bf16_f32 v74, v32, v33
    v_cvt_pk_bf16_f32 v75, v34, v35
    s_waitcnt vmcnt(4)
    v_mfma_f32_32x32x16_bf16 v[0:15], v[64:67], v[176:179], 0
    ds_read_b64_tr_b16 v[184:185], v246 offset:2048
    ds_read_b64_tr_b16 v[186:187], v246 offset:3072
    ds_read_b64_tr_b16 v[188:189], v247 offset:2048
    ds_read_b64_tr_b16 v[190:191], v247 offset:3072
    s_mov_b32 m0, s68
    v_mfma_f32_32x32x16_bf16 v[16:31], v[68:71], v[176:179], 0
    buffer_load_dwordx4 v222, s[4:7], s42 offen sc1 lds
    buffer_load_dwordx4 v223, s[72:75], s42 offen offset:1024 sc1 lds
    v_permlane32_swap_b32 v242, v236
    v_permlane32_swap_b32 v243, v237
    v_mov_b32 v254, 163296
    v_mfma_f32_32x32x16_bf16 v[32:47], v[64:67], v[180:183], 0
    v_permlane32_swap_b32 v244, v238
    v_permlane32_swap_b32 v245, v239
    v_permlane32_swap_b32 v240, v241
    v_add_f32 v242, v242, v236
    v_mfma_f32_32x32x16_bf16 v[48:63], v[68:71], v[180:183], 0
    v_add_f32 v243, v243, v237
    v_add_f32 v244, v244, v238
    v_add_f32 v245, v245, v239
    v_add_f32 v240, -v240, -v241
    v_sub_u32 v241, v230, v231
    v_cvt_pk_bf16_f32 v242, v242, v243
    v_mov_b32 v255, 1
    v_lshl_add_u32 v233, v252, 1, s53
    s_mov_b64 exec, 1
    ds_add_rtn_u32 v232, v254, v255
    s_mov_b64 exec, -1
    ds_read_b32 v233, v233
    s_waitcnt vmcnt(4) lgkmcnt(2)
    v_mfma_f32_32x32x16_bf16 v[0:15], v[72:75], v[184:187], v[0:15]
    ds_read_b64_tr_b16 v[176:177], v246 offset:4096
    ds_read_b64_tr_b16 v[178:179], v246 offset:5120
    ds_read_b64_tr_b16 v[180:181], v247 offset:4096
    ds_read_b64_tr_b16 v[182:183], v247 offset:5120
    v_cvt_pk_bf16_f32 v244, v244, v245
    v_cvt_pk_bf16_f32 v240, v240, v240
    s_mov_b32 m0, s69
    v_mfma_f32_32x32x16_bf16 v[16:31], v[76:79], v[184:187], v[16:31]
    buffer_load_dwordx4 v224, s[4:7], s42 offen sc1 lds
    buffer_load_dwordx4 v225, s[72:75], s42 offen offset:1024 sc1 lds
    ds_write_b32 v230, v242 offset:768
    ds_write_b32 v230, v244 offset:1024
    ds_write_b16 v241, v240 offset:1280
    s_waitcnt lgkmcnt(7)
    v_readfirstlane_b32 s58, v232
    v_mfma_f32_32x32x16_bf16 v[32:47], v[72:75], v[188:191], v[32:47]
    s_cmp_lt_u32 s58, s22
    s_cbranch_scc0 K2_nul_47
    s_and_b32 s59, s58, 7
    s_lshr_b32 s60, s58, 3
K2_chk_49:
    v_readlane_b32 s61, v233, s59
    s_nop 0
    s_cmp_gt_u32 s61, s60
    s_cbranch_scc0 K2_spin_48
K2_back_50:
    v_mfma_f32_32x32x16_bf16 v[48:63], v[76:79], v[188:191], v[48:63]
    s_setprio 0
    v_readlane_b32 s3, v253, s58
    s_lshl_b32 s44, s34, 7
    s_and_b32 s48, s3, 0x3ffff
    s_bfe_u32 s33, s3, 0x30013
    s_mov_b32 s35, s48
    s_mov_b32 s45, s44
    v_mul_f32 v234, v0, v96
    v_mul_f32 v236, v8, v128
    v_fmac_f32 v234, v1, v97
    v_fmac_f32 v236, v9, v129
    v_fmac_f32 v234, v2, v98
    v_fmac_f32 v236, v10, v130
    v_fmac_f32 v234, v3, v99
    v_fmac_f32 v236, v11, v131
    v_fmac_f32 v234, v4, v100
    v_fmac_f32 v236, v12, v132
    v_fmac_f32 v234, v5, v101
    v_fmac_f32 v236, v13, v133
    v_fmac_f32 v234, v6, v102
    v_fmac_f32 v236, v14, v134
    v_fmac_f32 v234, v7, v103
    v_fmac_f32 v236, v15, v135
    v_mul_f32 v238, v16, v128
    v_mul_f32 v240, v24, v128
    v_fmac_f32 v238, v17, v129
    v_fmac_f32 v240, v25, v129
    v_fmac_f32 v238, v18, v130
    v_fmac_f32 v240, v26, v130
    v_fmac_f32 v238, v19, v131
    v_fmac_f32 v240, v27, v131
    v_fmac_f32 v238, v20, v132
    v_fmac_f32 v240, v28, v132
    v_fmac_f32 v238, v21, v133
    v_fmac_f32 v240, v29, v133
    v_fmac_f32 v238, v22, v134
    v_fmac_f32 v240, v30, v134
    v_fmac_f32 v238, v23, v135
    v_fmac_f32 v240, v31, v135
    v_mul_f32 v235, v32, v104
    v_mul_f32 v237, v40, v136
    v_fmac_f32 v235, v33, v105
    v_fmac_f32 v237, v41, v137
    v_fmac_f32 v235, v34, v106
    v_fmac_f32 v237, v42, v138
    v_fmac_f32 v235, v35, v107
    v_fmac_f32 v237, v43, v139
    v_fmac_f32 v235, v36, v108
    v_fmac_f32 v237, v44, v140
    v_fmac_f32 v235, v37, v109
    v_fmac_f32 v237, v45, v141
    v_fmac_f32 v235, v38, v110
    v_fmac_f32 v237, v46, v142
    v_fmac_f32 v235, v39, v111
    v_fmac_f32 v237, v47, v143
    v_mul_f32 v239, v48, v136
    v_mul_f32 v241, v56, v136
    v_fmac_f32 v239, v49, v137
    v_fmac_f32 v241, v57, v137
    s_setprio 1
    s_waitcnt vmcnt(4) lgkmcnt(3)
    v_mfma_f32_32x32x16_bf16 v[0:15], v[64:67], v[176:179], 0
    ds_read_b64_tr_b16 v[184:185], v246 offset:6144
    ds_read_b64_tr_b16 v[186:187], v246 offset:7168
    ds_read_b64_tr_b16 v[188:189], v247 offset:6144
    ds_read_b64_tr_b16 v[190:191], v247 offset:7168
    v_fmac_f32 v239, v50, v138
    v_fmac_f32 v241, v58, v138
    s_mov_b32 m0, s70
    v_mfma_f32_32x32x16_bf16 v[16:31], v[68:71], v[176:179], 0
    buffer_load_dwordx4 v222, s[4:7], s43 offen sc1 lds
    buffer_load_dwordx4 v223, s[72:75], s43 offen offset:1024 sc1 lds
    v_fmac_f32 v239, v51, v139
    v_fmac_f32 v241, v59, v139
    v_fmac_f32 v239, v52, v140
    v_fmac_f32 v241, v60, v140
    v_fmac_f32 v239, v53, v141
    v_mfma_f32_32x32x16_bf16 v[32:47], v[64:67], v[180:183], 0
    s_xor_b32 s47, s44, 256
    s_add_u32 s49, s48, 128
    s_add_u32 s60, s48, 256
    s_cmp_eq_u32 s33, 3
    s_cselect_b32 s46, s44, s47
    s_cselect_b32 s50, s60, s48
    s_cselect_b32 s51, s48, s49
    s_sub_u32 s60, s33, 2
    s_cmp_lt_u32 s60, 2
    s_cbranch_scc0 K2_rare_51
K2_back_52:
    v_add_u32 v222, s48, v251
    ds_read2_b32 v[222:223], v222 offset0:1 offset1:3
    v_fmac_f32 v241, v61, v141
    v_fmac_f32 v239, v54, v142
    v_fmac_f32 v241, v62, v142
    v_fmac_f32 v239, v55, v143
    v_fmac_f32 v241, v63, v143
    v_mfma_f32_32x32x16_bf16 v[48:63], v[68:71], v[180:183], 0
    v_permlane32_swap_b32 v234, v236
    v_permlane32_swap_b32 v235, v237
    v_permlane32_swap_b32 v240, v238
    s_waitcnt vmcnt(4) lgkmcnt(1)
    v_mfma_f32_32x32x16_bf16 v[0:15], v[72:75], v[184:187], v[0:15]
    ds_read_b64_tr_b16 v[176:177], v246 offset:0
    ds_read_b64_tr_b16 v[178:179], v246 offset:1024
    ds_read_b64_tr_b16 v[180:181], v247 offset:0
    ds_read_b64_tr_b16 v[182:183], v247 offset:1024
    v_permlane32_swap_b32 v241, v239
    s_mov_b32 m0, s71
    v_mfma_f32_32x32x16_bf16 v[16:31], v[76:79], v[184:187], v[16:31]
    buffer_load_dwordx4 v224, s[4:7], s43 offen sc1 lds
    buffer_load_dwordx4 v225, s[72:75], s43 offen offset:1024 sc1 lds
    s_waitcnt lgkmcnt(4)
    v_mad_u32_u16 v222, v222, s39, v248 op_sel:[1,0,0,0]
    v_mad_u32_u16 v223, v223, s39, v248 op_sel:[1,0,0,0]
    v_lshl_add_u32 v230, v252, 1, s31
    v_add_f32 v234, v234, v236
    v_add_f32 v235, v235, v237
    v_add_f32 v240, v240, v238
    v_add_f32 v241, v241, v239
    v_cvt_pk_bf16_f32 v234, v234, v235
    v_cvt_pk_bf16_f32 v240, v240, v241
    ds_write_b32 v230, v234 offset:0
    ds_write_b32 v230, v240 offset:256
    v_mfma_f32_32x32x16_bf16 v[32:47], v[72:75], v[188:191], v[32:47]
    v_add_u32 v224, s49, v251
    ds_read2_b32 v[224:225], v224 offset0:1 offset1:3
    v_mul_f32 v234, v0, v144
    v_mul_f32 v236, v8, v112
    v_fmac_f32 v234, v1, v145
    v_fmac_f32 v236, v9, v113
    v_fmac_f32 v234, v2, v146
    v_mfma_f32_32x32x16_bf16 v[48:63], v[76:79], v[188:191], v[48:63]
    s_setprio 0
    v_fmac_f32 v236, v10, v114
    v_fmac_f32 v234, v3, v147
    v_fmac_f32 v236, v11, v115
    v_fmac_f32 v234, v4, v148
    v_fmac_f32 v236, v12, v116
    v_fmac_f32 v234, v5, v149
    v_fmac_f32 v236, v13, v117
    v_fmac_f32 v234, v6, v150
    v_fmac_f32 v236, v14, v118
    v_fmac_f32 v234, v7, v151
    v_fmac_f32 v236, v15, v119
    v_mul_f32 v238, v16, v160
    v_mul_f32 v240, v24, v160
    v_fmac_f32 v238, v17, v161
    v_fmac_f32 v240, v25, v161
    v_fmac_f32 v238, v18, v162
    v_fmac_f32 v240, v26, v162
    v_fmac_f32 v238, v19, v163
    v_fmac_f32 v240, v27, v163
    v_fmac_f32 v238, v20, v164
    v_fmac_f32 v240, v28, v164
    v_fmac_f32 v238, v21, v165
    v_fmac_f32 v240, v29, v165
    v_fmac_f32 v238, v22, v166
    v_fmac_f32 v240, v30, v166
    v_fmac_f32 v238, v23, v167
    v_fmac_f32 v240, v31, v167
    v_mul_f32 v235, v32, v152
    v_mul_f32 v237, v40, v120
    v_fmac_f32 v235, v33, v153
    v_fmac_f32 v237, v41, v121
    v_fmac_f32 v235, v34, v154
    v_fmac_f32 v237, v42, v122
    v_fmac_f32 v235, v35, v155
    v_fmac_f32 v237, v43, v123
    v_fmac_f32 v235, v36, v156
    v_fmac_f32 v237, v44, v124
    v_fmac_f32 v235, v37, v157
    v_fmac_f32 v237, v45, v125
    v_fmac_f32 v235, v38, v158
    v_fmac_f32 v237, v46, v126
    v_fmac_f32 v235, v39, v159
    v_fmac_f32 v237, v47, v127
    v_mul_f32 v239, v48, v168
    v_mul_f32 v241, v56, v168
    v_fmac_f32 v239, v49, v169
    v_fmac_f32 v241, v57, v169
    v_fmac_f32 v239, v50, v170
    v_fmac_f32 v241, v58, v170
    v_fmac_f32 v239, v51, v171
    s_setprio 1
    s_waitcnt vmcnt(4) lgkmcnt(3)
    v_mfma_f32_32x32x16_bf16 v[0:15], v[64:67], v[176:179], 0
    ds_read_b64_tr_b16 v[184:185], v246 offset:2048
    ds_read_b64_tr_b16 v[186:187], v246 offset:3072
    ds_read_b64_tr_b16 v[188:189], v247 offset:2048
    ds_read_b64_tr_b16 v[190:191], v247 offset:3072
    v_fmac_f32 v241, v59, v171
    v_fmac_f32 v239, v52, v172
    s_mov_b32 m0, s68
    v_mfma_f32_32x32x16_bf16 v[16:31], v[68:71], v[176:179], 0
    buffer_load_dwordx4 v222, s[4:7], s44 offen sc1 lds
    buffer_load_dwordx4 v223, s[72:75], s44 offen offset:1024 sc1 lds
    s_waitcnt lgkmcnt(4)
    v_mad_u32_u16 v224, v224, s39, v248 op_sel:[1,0,0,0]
    v_mad_u32_u16 v225, v225, s39, v248 op_sel:[1,0,0,0]
    v_fmac_f32 v241, v60, v172
    v_fmac_f32 v239, v53, v173
    v_mfma_f32_32x32x16_bf16 v[32:47], v[64:67], v[180:183], 0
    v_add_u32 v226, s50, v251
    ds_read2_b32 v[226:227], v226 offset0:1 offset1:3
    v_fmac_f32 v241, v61, v173
    v_fmac_f32 v239, v54, v174
    v_fmac_f32 v241, v62, v174
    v_fmac_f32 v239, v55, v175
    v_fmac_f32 v241, v63, v175
    v_mfma_f32_32x32x16_bf16 v[48:63], v[68:71], v[180:183], 0
    s_waitcnt vmcnt(4) lgkmcnt(1)
    v_mfma_f32_32x32x16_bf16 v[0:15], v[72:75], v[184:187], v[0:15]
    ds_read_b64_tr_b16 v[176:177], v246 offset:4096
    ds_read_b64_tr_b16 v[178:179], v246 offset:5120
    ds_read_b64_tr_b16 v[180:181], v247 offset:4096
    ds_read_b64_tr_b16 v[182:183], v247 offset:5120
    s_mov_b32 m0, s69
    v_mfma_f32_32x32x16_bf16 v[16:31], v[76:79], v[184:187], v[16:31]
    buffer_load_dwordx4 v224, s[4:7], s45 offen sc1 lds
    buffer_load_dwordx4 v225, s[72:75], s45 offen offset:1024 sc1 lds
    s_waitcnt lgkmcnt(4)
    v_mad_u32_u16 v226, v226, s39, v248 op_sel:[1,0,0,0]
    v_mad_u32_u16 v227, v227, s39, v248 op_sel:[1,0,0,0]
    v_mfma_f32_32x32x16_bf16 v[32:47], v[72:75], v[188:191], v[32:47]
    v_add_u32 v228, s51, v251
    ds_read2_b32 v[228:229], v228 offset0:1 offset1:3
    v_mul_f32 v242, v0, v144
    v_fma_f32 v238, v8, v160, -v238
    v_fmac_f32 v242, v1, v145
    v_fmac_f32 v238, v9, v161
    v_fmac_f32 v242, v2, v146
    v_mfma_f32_32x32x16_bf16 v[48:63], v[76:79], v[188:191], v[48:63]
    s_setprio 0
    v_fmac_f32 v238, v10, v162
    v_fmac_f32 v242, v3, v147
    v_fmac_f32 v238, v11, v163
    v_fmac_f32 v242, v4, v148
    v_fmac_f32 v238, v12, v164
    v_fmac_f32 v242, v5, v149
    v_fmac_f32 v238, v13, v165
    v_fmac_f32 v242, v6, v150
    v_fmac_f32 v238, v14, v166
    v_fmac_f32 v242, v7, v151
    v_fmac_f32 v238, v15, v167
    v_fmac_f32 v236, v16, v112
    v_mul_f32 v244, v24, v160
    v_fmac_f32 v236, v17, v113
    v_fmac_f32 v244, v25, v161
    v_fmac_f32 v236, v18, v114
    v_fmac_f32 v244, v26, v162
    v_fmac_f32 v236, v19, v115
    v_fmac_f32 v244, v27, v163
    v_fmac_f32 v236, v20, v116
    v_fmac_f32 v244, v28, v164
    v_fmac_f32 v236, v21, v117
    v_fmac_f32 v244, v29, v165
    v_fmac_f32 v236, v22, v118
    v_fmac_f32 v244, v30, v166
    v_fmac_f32 v236, v23, v119
    v_fmac_f32 v244, v31, v167
    v_mul_f32 v243, v32, v152
    v_fma_f32 v239, v40, v168, -v239
    v_fmac_f32 v243, v33, v153
    v_fmac_f32 v239, v41, v169
    v_fmac_f32 v243, v34, v154
    v_fmac_f32 v239, v42, v170
    v_fmac_f32 v243, v35, v155
    v_fmac_f32 v239, v43, v171
    v_fmac_f32 v243, v36, v156
    v_fmac_f32 v239, v44, v172
    v_fmac_f32 v243, v37, v157
    v_fmac_f32 v239, v45, v173
    v_fmac_f32 v243, v38, v158
    v_fmac_f32 v239, v46, v174
    v_fmac_f32 v243, v39, v159
    v_fmac_f32 v239, v47, v175
    v_fmac_f32 v237, v48, v120
    v_mul_f32 v245, v56, v168
    v_fmac_f32 v237, v49, v121
    v_fmac_f32 v245, v57, v169
    v_fmac_f32 v237, v50, v122
    s_setprio 1
    s_waitcnt vmcnt(4) lgkmcnt(1)
    v_mfma_f32_32x32x16_bf16 v[0:15], v[64:67], v[176:179], 0
    ds_read_b64_tr_b16 v[184:185], v246 offset:6144
    ds_read_b64_tr_b16 v[186:187], v246 offset:7168
    ds_read_b64_tr_b16 v[188:189], v247 offset:6144
    ds_read_b64_tr_b16 v[190:191], v247 offset:7168
    v_fmac_f32 v245, v58, v170
    v_fmac_f32 v237, v51, v123
    s_mov_b32 m0, s70
    v_mfma_f32_32x32x16_bf16 v[16:31], v[68:71], v[176:179], 0
    buffer_load_dwordx4 v226, s[4:7], s46 offen sc1 lds
    buffer_load_dwordx4 v227, s[72:75], s46 offen offset:1024 sc1 lds
    s_waitcnt lgkmcnt(4)
    v_mad_u32_u16 v228, v228, s39, v248 op_sel:[1,0,0,0]
    v_mad_u32_u16 v229, v229, s39, v248 op_sel:[1,0,0,0]
    v_fmac_f32 v245, v59, v171
    v_fmac_f32 v237, v52, v124
    v_mfma_f32_32x32x16_bf16 v[32:47], v[64:67], v[180:183], 0
    v_fmac_f32 v245, v60, v172
    v_fmac_f32 v237, v53, v125
    v_fmac_f32 v245, v61, v173
    v_fmac_f32 v237, v54, v126
    v_fmac_f32 v245, v62, v174
    v_fmac_f32 v237, v55, v127
    v_fmac_f32 v245, v63, v175
    v_mfma_f32_32x32x16_bf16 v[48:63], v[68:71], v[180:183], 0
    v_permlane32_swap_b32 v242, v234
    v_permlane32_swap_b32 v243, v235
    v_add_f32 v242, v242, v234
    v_add_f32 v243, v243, v235
    s_waitcnt vmcnt(4) lgkmcnt(0)
    v_mfma_f32_32x32x16_bf16 v[0:15], v[72:75], v[184:187], v[0:15]
    ds_read_b64_tr_b16 v[176:177], v246 offset:0
    ds_read_b64_tr_b16 v[178:179], v246 offset:1024
    ds_read_b64_tr_b16 v[180:181], v247 offset:0
    ds_read_b64_tr_b16 v[182:183], v247 offset:1024
    v_cvt_pk_bf16_f32 v242, v242, v243
    ds_write_b32 v230, v242 offset:512
    s_mov_b32 m0, s71
    v_mfma_f32_32x32x16_bf16 v[16:31], v[76:79], v[184:187], v[16:31]
    buffer_load_dwordx4 v228, s[4:7], s47 offen sc1 lds
    buffer_load_dwordx4 v229, s[72:75], s47 offen offset:1024 sc1 lds
    s_sub_u32 s26, s48, s29
    s_mov_b32 s29, s48
    s_mov_b32 s30, s3
    s_bfe_u32 s56, s3, 0x40012
    s_cmp_lg_u32 s36, 0
    s_cselect_b32 s56, s56, 0
    v_mfma_f32_32x32x16_bf16 v[32:47], v[72:75], v[188:191], v[32:47]
    s_mov_b32 s32, s31
    s_mov_b32 s31, s35
    v_mul_f32 v242, v0, v144
    v_fma_f32 v240, v8, v160, -v240
    v_fmac_f32 v242, v1, v145
    v_fmac_f32 v240, v9, v161
    v_fmac_f32 v242, v2, v146
    v_mfma_f32_32x32x16_bf16 v[48:63], v[76:79], v[188:191], v[48:63]
    s_setprio 0
    v_fmac_f32 v240, v10, v162
    v_fmac_f32 v242, v3, v147
    v_fmac_f32 v240, v11, v163
    v_fmac_f32 v242, v4, v148
    v_fmac_f32 v240, v12, v164
    v_fmac_f32 v242, v5, v149
    v_fmac_f32 v240, v13, v165
    v_fmac_f32 v242, v6, v150
    v_fmac_f32 v240, v14, v166
    v_fmac_f32 v242, v7, v151
    v_fmac_f32 v240, v15, v167
    v_add_u32 v249, s26, v249
    v_add_u32 v250, s26, v250
    v_fma_f32 v244, v16, v160, -v244
    v_fmac_f32 v236, v24, v112
    v_fmac_f32 v244, v17, v161
    v_fmac_f32 v236, v25, v113
    v_fmac_f32 v244, v18, v162
    v_fmac_f32 v236, v26, v114
    v_fmac_f32 v244, v19, v163
    v_fmac_f32 v236, v27, v115
    v_fmac_f32 v244, v20, v164
    v_fmac_f32 v236, v28, v116
    v_fmac_f32 v244, v21, v165
    v_fmac_f32 v236, v29, v117
    v_fmac_f32 v244, v22, v166
    v_fmac_f32 v236, v30, v118
    v_fmac_f32 v244, v23, v167
    v_fmac_f32 v236, v31, v119
    ds_read_b64_tr_b16 v[0:1], v249 offset:0
    ds_read_b64_tr_b16 v[2:3], v249 offset:32
    ds_read_u16_d16_hi v16, v250 offset:0
    v_mul_f32 v243, v32, v152
    v_fma_f32 v241, v40, v168, -v241
    v_fmac_f32 v243, v33, v153
    v_fmac_f32 v241, v41, v169
    v_fmac_f32 v243, v34, v154
    v_fmac_f32 v241, v42, v170
    v_fmac_f32 v243, v35, v155
    v_fmac_f32 v241, v43, v171
    v_fmac_f32 v243, v36, v156
    v_fmac_f32 v241, v44, v172
    v_fmac_f32 v243, v37, v157
    v_fmac_f32 v241, v45, v173
    v_fmac_f32 v243, v38, v158
    v_fmac_f32 v241, v46, v174
    v_fmac_f32 v243, v39, v159
    v_fmac_f32 v241, v47, v175
    ds_read_b64_tr_b16 v[4:5], v249 offset:512
    ds_read_b64_tr_b16 v[6:7], v249 offset:544
    ds_read_u16_d16_hi v17, v250 offset:128
    v_fma_f32 v245, v48, v168, -v245
    v_fmac_f32 v237, v56, v120
    v_fmac_f32 v245, v49, v169
    v_fmac_f32 v237, v57, v121
    v_fmac_f32 v245, v50, v170
    v_fmac_f32 v237, v58, v122
    v_fmac_f32 v245, v51, v171
    v_fmac_f32 v237, v59, v123
    v_fmac_f32 v245, v52, v172
    v_fmac_f32 v237, v60, v124
    v_fmac_f32 v245, v53, v173
    v_fmac_f32 v237, v61, v125
    v_fmac_f32 v245, v54, v174
    v_fmac_f32 v237, v62, v126
    v_fmac_f32 v245, v55, v175
    v_fmac_f32 v237, v63, v127
    s_cmp_eq_u32 s56, 5
    s_cbranch_scc1 K2_U21
    s_cmp_eq_u32 s56, 6
    s_cbranch_scc1 K2_U3h1
    s_branch K2_DSP1
K2_PAD_U31:
    s_branch K2_HOP
K2_U3h1:
    s_setprio 1
    ds_read_b64_tr_b16 v[8:9], v249 offset:1024
    ds_read_u16_d16_hi v18, v250 offset:256
    s_waitcnt lgkmcnt(2)
    v_lshlrev_b32 v20, 16, v0
    v_and_b32 v21, 0xffff0000, v0
    v_lshlrev_b32 v22, 16, v1
    v_and_b32 v23, 0xffff0000, v1
    v_lshlrev_b32 v24, 16, v2
    v_and_b32 v25, 0xffff0000, v2
    v_lshlrev_b32 v26, 16, v3
    v_and_b32 v27, 0xffff0000, v3
    v_mul_f32_dpp v36, v16, v20 row_newbcast:8 row_mask:0xf bank_mask:0xf
    v_mul_f32_dpp v37, v16, v21 row_newbcast:9 row_mask:0xf bank_mask:0xf
    v_mul_f32_dpp v38, v16, v22 row_newbcast:10 row_mask:0xf bank_mask:0xf
    v_mul_f32_dpp v39, v16, v23 row_newbcast:11 row_mask:0xf bank_mask:0xf
    v_mul_f32_dpp v40, v16, v24 row_newbcast:12 row_mask:0xf bank_mask:0xf
    v_mul_f32_dpp v41, v16, v25 row_newbcast:13 row_mask:0xf bank_mask:0xf
    v_mul_f32_dpp v42, v16, v26 row_newbcast:14 row_mask:0xf bank_mask:0xf
    v_mul_f32_dpp v43, v16, v27 row_newbcast:15 row_mask:0xf bank_mask:0xf
    v_cvt_pk_bf16_f32 v68, v36, v37
    v_cvt_pk_bf16_f32 v69, v38, v39
    v_cvt_pk_bf16_f32 v70, v40, v41
    v_cvt_pk_bf16_f32 v71, v42, v43
    v_mul_f32_dpp v20, v16, v20 row_newbcast:0 row_mask:0xa bank_mask:0xf
    v_mul_f32_dpp v21, v16, v21 row_newbcast:1 row_mask:0xa bank_mask:0xf
    v_mul_f32_dpp v22, v16, v22 row_newbcast:2 row_mask:0xa bank_mask:0xf
    v_mul_f32_dpp v23, v16, v23 row_newbcast:3 row_mask:0xa bank_mask:0xf
    v_mul_f32_dpp v24, v16, v24 row_newbcast:4 row_mask:0xa bank_mask:0xf
    v_mul_f32_dpp v25, v16, v25 row_newbcast:5 row_mask:0xa bank_mask:0xf
    v_mul_f32_dpp v26, v16, v26 row_newbcast:6 row_mask:0xa bank_mask:0xf
    v_mul_f32_dpp v27, v16, v27 row_newbcast:7 row_mask:0xa bank_mask:0xf
    v_cvt_pk_bf16_f32 v64, v20, v21
    v_cvt_pk_bf16_f32 v65, v22, v23
    v_cvt_pk_bf16_f32 v66, v24, v25
    v_cvt_pk_bf16_f32 v67, v26, v27
    v_lshlrev_b32 v28, 16, v4
    v_and_b32 v29, 0xffff0000, v4
    v_lshlrev_b32 v30, 16, v5
    v_and_b32 v31, 0xffff0000, v5
    v_lshlrev_b32 v32, 16, v6
    v_and_b32 v33, 0xffff0000, v6
    v_lshlrev_b32 v34, 16, v7
    v_and_b32 v35, 0xffff0000, v7
    v_mul_f32_dpp v36, v17, v28 row_newbcast:8 row_mask:0xf bank_mask:0xf
    v_mul_f32_dpp v37, v17, v29 row_newbcast:9 row_mask:0xf bank_mask:0xf
    v_mul_f32_dpp v38, v17, v30 row_newbcast:10 row_mask:0xf bank_mask:0xf
    v_mul_f32_dpp v39, v17, v31 row_newbcast:11 row_mask:0xf bank_mask:0xf
    v_mul_f32_dpp v40, v17, v32 row_newbcast:12 row_mask:0xf bank_mask:0xf
    v_mul_f32_dpp v41, v17, v33 row_newbcast:13 row_mask:0xf bank_mask:0xf
    v_mul_f32_dpp v42, v17, v34 row_newbcast:14 row_mask:0xf bank_mask:0xf
    v_mul_f32_dpp v43, v17, v35 row_newbcast:15 row_mask:0xf bank_mask:0xf
    v_cvt_pk_bf16_f32 v76, v36, v37
    v_cvt_pk_bf16_f32 v77, v38, v39
    v_cvt_pk_bf16_f32 v78, v40, v41
    v_cvt_pk_bf16_f32 v79, v42, v43
    v_mul_f32_dpp v28, v17, v28 row_newbcast:0 row_mask:0xa bank_mask:0xf
    v_mul_f32_dpp v29, v17, v29 row_newbcast:1 row_mask:0xa bank_mask:0xf
    v_mul_f32_dpp v30, v17, v30 row_newbcast:2 row_mask:0xa bank_mask:0xf
    v_mul_f32_dpp v31, v17, v31 row_newbcast:3 row_mask:0xa bank_mask:0xf
    v_mul_f32_dpp v32, v17, v32 row_newbcast:4 row_mask:0xa bank_mask:0xf
    v_mul_f32_dpp v33, v17, v33 row_newbcast:5 row_mask:0xa bank_mask:0xf
    v_mul_f32_dpp v34, v17, v34 row_newbcast:6 row_mask:0xa bank_mask:0xf
    v_mul_f32_dpp v35, v17, v35 row_newbcast:7 row_mask:0xa bank_mask:0xf
    v_cvt_pk_bf16_f32 v72, v28, v29
    v_cvt_pk_bf16_f32 v73, v30, v31
    v_cvt_pk_bf16_f32 v74, v32, v33
    v_cvt_pk_bf16_f32 v75, v34, v35
    s_waitcnt lgkmcnt(0)
    v_lshlrev_b32 v20, 16, v8
    v_and_b32 v21, 0xffff0000, v8
    v_lshlrev_b32 v22, 16, v9
    v_and_b32 v23, 0xffff0000, v9
    v_mul_f32_dpp v36, v18, v20 row_newbcast:8 row_mask:0xf bank_mask:0xf
    v_mul_f32_dpp v37, v18, v21 row_newbcast:9 row_mask:0xf bank_mask:0xf
    v_mul_f32_dpp v38, v18, v22 row_newbcast:10 row_mask:0xf bank_mask:0xf
    v_mul_f32_dpp v39, v18, v23 row_newbcast:11 row_mask:0xf bank_mask:0xf
    v_cvt_pk_bf16_f32 v84, v36, v37
    v_cvt_pk_bf16_f32 v85, v38, v39
    v_mul_f32_dpp v20, v18, v20 row_newbcast:0 row_mask:0xa bank_mask:0xf
    v_mul_f32_dpp v21, v18, v21 row_newbcast:1 row_mask:0xa bank_mask:0xf
    v_mul_f32_dpp v22, v18, v22 row_newbcast:2 row_mask:0xa bank_mask:0xf
    v_mul_f32_dpp v23, v18, v23 row_newbcast:3 row_mask:0xa bank_mask:0xf
    v_cvt_pk_bf16_f32 v80, v20, v21
    v_cvt_pk_bf16_f32 v81, v22, v23
    s_waitcnt vmcnt(4)
    v_mfma_f32_32x32x16_bf16 v[0:15], v[64:67], v[176:179], 0
    ds_read_b64_tr_b16 v[184:185], v246 offset:2048
    ds_read_b64_tr_b16 v[186:187], v246 offset:3072
    ds_read_b64_tr_b16 v[188:189], v247 offset:2048
    ds_read_b64_tr_b16 v[190:191], v247 offset:3072
    s_mov_b32 m0, s68
    v_mfma_f32_32x32x16_bf16 v[16:31], v[68:71], v[176:179], 0
    buffer_load_dwordx4 v224, s[4:7], s41 offen sc1 lds
    buffer_load_dwordx4 v225, s[72:75], s41 offen offset:1024 sc1 lds
    v_permlane32_swap_b32 v242, v236
    v_permlane32_swap_b32 v243, v237
    v_mov_b32 v254, 163296
    v_mfma_f32_32x32x16_bf16 v[32:47], v[64:67], v[180:183], 0
    v_permlane32_swap_b32 v244, v238
    v_permlane32_swap_b32 v245, v239
    v_permlane32_swap_b32 v240, v241
    v_add_f32 v242, v242, v236
    v_mfma_f32_32x32x16_bf16 v[48:63], v[68:71], v[180:183], 0
    v_add_f32 v243, v243, v237
    v_add_f32 v244, v244, v238
    v_add_f32 v245, v245, v239
    v_add_f32 v240, -v240, -v241
    v_sub_u32 v241, v230, v231
    v_cvt_pk_bf16_f32 v242, v242, v243
    v_mov_b32 v255, 1
    v_lshl_add_u32 v233, v252, 1, s53
    s_mov_b64 exec, 1
    ds_add_rtn_u32 v232, v254, v255
    s_mov_b64 exec, -1
    ds_read_b32 v233, v233
    s_waitcnt vmcnt(4) lgkmcnt(2)
    v_mfma_f32_32x32x16_bf16 v[0:15], v[72:75], v[184:187], v[0:15]
    ds_read_b64_tr_b16 v[176:177], v246 offset:4096
    ds_read_b64_tr_b16 v[180:181], v247 offset:4096
    v_cvt_pk_bf16_f32 v244, v244, v245
    v_cvt_pk_bf16_f32 v240, v240, v240
    ds_write_b32 v230, v242 offset:768
    ds_write_b32 v230, v244 offset:1024
    s_mov_b32 m0, s69
    v_mfma_f32_32x32x16_bf16 v[16:31], v[76:79], v[184:187], v[16:31]
    buffer_load_dwordx4 v226, s[4:7], s41 offen sc1 lds
    ds_write_b16 v241, v240 offset:1280
    s_waitcnt lgkmcnt(5)
    v_readfirstlane_b32 s58, v232
    v_mfma_f32_32x32x16_bf16 v[32:47], v[72:75], v[188:191], v[32:47]
    s_cmp_lt_u32 s58, s22
    s_cbranch_scc0 K2_nul_54
    s_and_b32 s59, s58, 7
    s_lshr_b32 s60, s58, 3
K2_chk_56:
    v_readlane_b32 s61, v233, s59
    s_nop 0
    s_cmp_gt_u32 s61, s60
    s_cbranch_scc0 K2_spin_55
K2_back_57:
    v_mfma_f32_32x32x16_bf16 v[48:63], v[76:79], v[188:191], v[48:63]
    v_readlane_b32 s3, v253, s58
    s_lshl_b32 s44, s34, 7
    s_and_b32 s48, s3, 0x3ffff
    s_bfe_u32 s33, s3, 0x30013
    s_mov_b32 s35, s48
    s_mov_b32 s45, s44
    s_waitcnt vmcnt(3) lgkmcnt(3)
    v_mfma_f32_32x32x8_bf16 v[0:15], v[80:81], v[176:177], v[0:15]
    ds_read_b64_tr_b16 v[184:185], v246 offset:6144
    ds_read_b64_tr_b16 v[186:187], v246 offset:7168
    ds_read_b64_tr_b16 v[188:189], v247 offset:6144
    ds_read_b64_tr_b16 v[190:191], v247 offset:7168
    s_xor_b32 s47, s44, 256
    s_add_u32 s49, s48, 128
    s_mov_b32 m0, s70
    v_mfma_f32_32x32x8_bf16 v[16:31], v[84:85], v[176:177], v[16:31]
    buffer_load_dwordx4 v222, s[4:7], s42 offen sc1 lds
    buffer_load_dwordx4 v223, s[72:75], s42 offen offset:1024 sc1 lds
    s_add_u32 s60, s48, 256
    s_cmp_eq_u32 s33, 3
    s_cselect_b32 s46, s44, s47
    s_cselect_b32 s50, s60, s48
    s_cselect_b32 s51, s48, s49
    v_mfma_f32_32x32x8_bf16 v[32:47], v[80:81], v[180:181], v[32:47]
    s_sub_u32 s60, s33, 2
    s_cmp_lt_u32 s60, 2
    s_cbranch_scc0 K2_rare_58
K2_back_59:
    v_mul_f32 v234, v0, v96
    v_mul_f32 v236, v8, v128
    v_fmac_f32 v234, v1, v97
    v_fmac_f32 v236, v9, v129
    v_mfma_f32_32x32x8_bf16 v[48:63], v[84:85], v[180:181], v[48:63]
    s_setprio 0
    v_fmac_f32 v234, v2, v98
    v_fmac_f32 v236, v10, v130
    v_fmac_f32 v234, v3, v99
    v_fmac_f32 v236, v11, v131
    v_fmac_f32 v234, v4, v100
    v_fmac_f32 v236, v12, v132
    v_fmac_f32 v234, v5, v101
    v_fmac_f32 v236, v13, v133
    v_fmac_f32 v234, v6, v102
    v_fmac_f32 v236, v14, v134
    v_fmac_f32 v234, v7, v103
    v_fmac_f32 v236, v15, v135
    v_mul_f32 v238, v16, v128
    v_mul_f32 v240, v24, v128
    v_fmac_f32 v238, v17, v129
    v_fmac_f32 v240, v25, v129
    v_fmac_f32 v238, v18, v130
    v_fmac_f32 v240, v26, v130
    v_fmac_f32 v238, v19, v131
    v_fmac_f32 v240, v27, v131
    v_fmac_f32 v238, v20, v132
    v_fmac_f32 v240, v28, v132
    v_fmac_f32 v238, v21, v133
    v_fmac_f32 v240, v29, v133
    v_fmac_f32 v238, v22, v134
    v_fmac_f32 v240, v30, v134
    v_fmac_f32 v238, v23, v135
    v_fmac_f32 v240, v31, v135
    v_mul_f32 v235, v32, v104
    v_mul_f32 v237, v40, v136
    v_fmac_f32 v235, v33, v105
    v_fmac_f32 v237, v41, v137
    v_fmac_f32 v235, v34, v106
    v_fmac_f32 v237, v42, v138
    v_fmac_f32 v235, v35, v107
    v_fmac_f32 v237, v43, v139
    v_fmac_f32 v235, v36, v108
    v_fmac_f32 v237, v44, v140
    v_fmac_f32 v235, v37, v109
    v_fmac_f32 v237, v45, v141
    v_fmac_f32 v235, v38, v110
    v_fmac_f32 v237, v46, v142
    v_fmac_f32 v235, v39, v111
    v_fmac_f32 v237, v47, v143
    v_mul_f32 v239, v48, v136
    v_mul_f32 v241, v56, v136
    s_setprio 1
    s_waitcnt vmcnt(3) lgkmcnt(0)
    v_mfma_f32_32x32x16_bf16 v[0:15], v[64:67], v[184:187], 0
    ds_read_b64_tr_b16 v[176:177], v246 offset:0
    ds_read_b64_tr_b16 v[178:179], v246 offset:1024
    ds_read_b64_tr_b16 v[180:181], v247 offset:0
    ds_read_b64_tr_b16 v[182:183], v247 offset:1024
    v_fmac_f32 v239, v49, v137
    v_fmac_f32 v241, v57, v137
    s_mov_b32 m0, s71
    v_mfma_f32_32x32x16_bf16 v[16:31], v[68:71], v[184:187], 0
    buffer_load_dwordx4 v224, s[4:7], s42 offen sc1 lds
    buffer_load_dwordx4 v225, s[72:75], s42 offen offset:1024 sc1 lds
    v_fmac_f32 v239, v50, v138
    v_fmac_f32 v241, v58, v138
    v_fmac_f32 v239, v51, v139
    v_fmac_f32 v241, v59, v139
    v_fmac_f32 v239, v52, v140
    v_mfma_f32_32x32x16_bf16 v[32:47], v[64:67], v[188:191], 0
    v_fmac_f32 v241, v60, v140
    v_fmac_f32 v239, v53, v141
    v_fmac_f32 v241, v61, v141
    v_fmac_f32 v239, v54, v142
    v_fmac_f32 v241, v62, v142
    v_fmac_f32 v239, v55, v143
    v_fmac_f32 v241, v63, v143
    v_mfma_f32_32x32x16_bf16 v[48:63], v[68:71], v[188:191], 0
    v_permlane32_swap_b32 v234, v236
    v_permlane32_swap_b32 v235, v237
    v_permlane32_swap_b32 v240, v238
    s_waitcnt vmcnt(4) lgkmcnt(0)
    v_mfma_f32_32x32x16_bf16 v[0:15], v[72:75], v[176:179], v[0:15]
    ds_read_b64_tr_b16 v[184:185], v246 offset:2048
    ds_read_b64_tr_b16 v[188:189], v247 offset:2048
    v_permlane32_swap_b32 v241, v239
    v_lshl_add_u32 v230, v252, 1, s31
    v_add_f32 v234, v234, v236
    s_mov_b32 m0, s68
    v_mfma_f32_32x32x16_bf16 v[16:31], v[76:79], v[176:179], v[16:31]
    buffer_load_dwordx4 v226, s[4:7], s42 offen sc1 lds
    v_add_f32 v235, v235, v237
    v_add_f32 v240, v240, v238
    v_add_f32 v241, v241, v239
    v_cvt_pk_bf16_f32 v234, v234, v235
    v_cvt_pk_bf16_f32 v240, v240, v241
    ds_write_b32 v230, v234 offset:0
    v_mfma_f32_32x32x16_bf16 v[32:47], v[72:75], v[180:183], v[32:47]
    ds_write_b32 v230, v240 offset:256
    v_mfma_f32_32x32x16_bf16 v[48:63], v[76:79], v[180:183], v[48:63]
    s_waitcnt vmcnt(3) lgkmcnt(2)
    v_mfma_f32_32x32x8_bf16 v[0:15], v[80:81], v[184:185], v[0:15]
    ds_read_b64_tr_b16 v[176:177], v246 offset:4096
    ds_read_b64_tr_b16 v[178:179], v246 offset:5120
    ds_read_b64_tr_b16 v[180:181], v247 offset:4096
    ds_read_b64_tr_b16 v[182:183], v247 offset:5120
    s_mov_b32 m0, s69
    v_mfma_f32_32x32x8_bf16 v[16:31], v[84:85], v[184:185], v[16:31]
    buffer_load_dwordx4 v222, s[4:7], s43 offen sc1 lds
    buffer_load_dwordx4 v223, s[72:75], s43 offen offset:1024 sc1 lds
    v_mfma_f32_32x32x8_bf16 v[32:47], v[80:81], v[188:189], v[32:47]
    s_nop 2
    v_mul_f32 v234, v0, v144
    v_mul_f32 v236, v8, v112
    v_fmac_f32 v234, v1, v145
    v_fmac_f32 v236, v9, v113
    v_fmac_f32 v234, v2, v146
    v_fmac_f32 v236, v10, v114
    v_fmac_f32 v234, v3, v147
    v_mfma_f32_32x32x8_bf16 v[48:63], v[84:85], v[188:189], v[48:63]
    s_setprio 0
    v_fmac_f32 v236, v11, v115
    v_fmac_f32 v234, v4, v148
    v_fmac_f32 v236, v12, v116
    v_fmac_f32 v234, v5, v149
    v_fmac_f32 v236, v13, v117
    v_fmac_f32 v234, v6, v150
    v_fmac_f32 v236, v14, v118
    v_fmac_f32 v234, v7, v151
    v_fmac_f32 v236, v15, v119
    v_mul_f32 v238, v16, v160
    v_mul_f32 v240, v24, v160
    v_fmac_f32 v238, v17, v161
    v_fmac_f32 v240, v25, v161
    v_fmac_f32 v238, v18, v162
    v_fmac_f32 v240, v26, v162
    v_fmac_f32 v238, v19, v163
    v_fmac_f32 v240, v27, v163
    v_fmac_f32 v238, v20, v164
    v_fmac_f32 v240, v28, v164
    v_fmac_f32 v238, v21, v165
    v_fmac_f32 v240, v29, v165
    v_fmac_f32 v238, v22, v166
    v_fmac_f32 v240, v30, v166
    v_fmac_f32 v238, v23, v167
    v_fmac_f32 v240, v31, v167
    v_mul_f32 v235, v32, v152
    v_mul_f32 v237, v40, v120
    v_fmac_f32 v235, v33, v153
    v_fmac_f32 v237, v41, v121
    v_fmac_f32 v235, v34, v154
    v_fmac_f32 v237, v42, v122
    v_fmac_f32 v235, v35, v155
    v_fmac_f32 v237, v43, v123
    v_fmac_f32 v235, v36, v156
    v_fmac_f32 v237, v44, v124
    v_fmac_f32 v235, v37, v157
    v_fmac_f32 v237, v45, v125
    v_fmac_f32 v235, v38, v158
    v_fmac_f32 v237, v46, v126
    v_fmac_f32 v235, v39, v159
    v_fmac_f32 v237, v47, v127
    v_mul_f32 v239, v48, v168
    v_mul_f32 v241, v56, v168
    v_fmac_f32 v239, v49, v169
    v_fmac_f32 v241, v57, v169
    s_setprio 1
    s_waitcnt vmcnt(3) lgkmcnt(0)
    v_mfma_f32_32x32x16_bf16 v[0:15], v[64:67], v[176:179], 0
    ds_read_b64_tr_b16 v[184:185], v246 offset:6144
    ds_read_b64_tr_b16 v[186:187], v246 offset:7168
    ds_read_b64_tr_b16 v[188:189], v247 offset:6144
    ds_read_b64_tr_b16 v[190:191], v247 offset:7168
    v_fmac_f32 v239, v50, v170
    v_fmac_f32 v241, v58, v170
    s_mov_b32 m0, s70
    v_mfma_f32_32x32x16_bf16 v[16:31], v[68:71], v[176:179], 0
    buffer_load_dwordx4 v224, s[4:7], s43 offen sc1 lds
    buffer_load_dwordx4 v225, s[72:75], s43 offen offset:1024 sc1 lds
    v_fmac_f32 v239, v51, v171
    v_fmac_f32 v241, v59, v171
    v_fmac_f32 v239, v52, v172
    v_fmac_f32 v241, v60, v172
    v_fmac_f32 v239, v53, v173
    v_mfma_f32_32x32x16_bf16 v[32:47], v[64:67], v[180:183], 0
    v_add_u32 v222, s48, v251
    ds_read2_b32 v[222:223], v222 offset0:1 offset1:3
    v_fmac_f32 v241, v61, v173
    v_fmac_f32 v239, v54, v174
    v_fmac_f32 v241, v62, v174
    v_fmac_f32 v239, v55, v175
    v_fmac_f32 v241, v63, v175
    v_mfma_f32_32x32x16_bf16 v[48:63], v[68:71], v[180:183], 0
    s_waitcnt vmcnt(4) lgkmcnt(1)
    v_mfma_f32_32x32x16_bf16 v[0:15], v[72:75], v[184:187], v[0:15]
    ds_read_b64_tr_b16 v[176:177], v246 offset:0
    ds_read_b64_tr_b16 v[180:181], v247 offset:0
    s_mov_b32 m0, s71
    v_mfma_f32_32x32x16_bf16 v[16:31], v[76:79], v[184:187], v[16:31]
    buffer_load_dwordx4 v226, s[4:7], s43 offen sc1 lds
    s_waitcnt lgkmcnt(2)
    v_mad_u32_u16 v222, v222, s39, v248 op_sel:[1,0,0,0]
    v_mad_u32_u16 v223, v223, s39, v248 op_sel:[1,0,0,0]
    v_mfma_f32_32x32x16_bf16 v[32:47], v[72:75], v[188:191], v[32:47]
    v_add_u32 v224, s49, v251
    ds_read2_b32 v[224:225], v224 offset0:1 offset1:3
    v_mfma_f32_32x32x16_bf16 v[48:63], v[76:79], v[188:191], v[48:63]
    s_waitcnt vmcnt(3) lgkmcnt(1)
    v_mfma_f32_32x32x8_bf16 v[0:15], v[80:81], v[176:177], v[0:15]
    ds_read_b64_tr_b16 v[184:185], v246 offset:2048
    ds_read_b64_tr_b16 v[186:187], v246 offset:3072
    ds_read_b64_tr_b16 v[188:189], v247 offset:2048
    ds_read_b64_tr_b16 v[190:191], v247 offset:3072
    s_mov_b32 m0, s68
    v_mfma_f32_32x32x8_bf16 v[16:31], v[84:85], v[176:177], v[16:31]
    buffer_load_dwordx4 v222, s[4:7], s44 offen sc1 lds
    buffer_load_dwordx4 v223, s[72:75], s44 offen offset:1024 sc1 lds
    s_waitcnt lgkmcnt(4)
    v_mad_u32_u16 v224, v224, s39, v248 op_sel:[1,0,0,0]
    v_mad_u32_u16 v225, v225, s39, v248 op_sel:[1,0,0,0]
    v_mfma_f32_32x32x8_bf16 v[32:47], v[80:81], v[180:181], v[32:47]
    v_add_u32 v226, s50, v251
    ds_read2_b32 v[226:227], v226 offset0:1 offset1:3
    v_mul_f32 v242, v0, v144
    v_fma_f32 v238, v8, v160, -v238
    v_fmac_f32 v242, v1, v145
    v_fmac_f32 v238, v9, v161
    v_fmac_f32 v242, v2, v146
    v_mfma_f32_32x32x8_bf16 v[48:63], v[84:85], v[180:181], v[48:63]
    s_setprio 0
    v_fmac_f32 v238, v10, v162
    v_fmac_f32 v242, v3, v147
    v_fmac_f32 v238, v11, v163
    v_fmac_f32 v242, v4, v148
    v_fmac_f32 v238, v12, v164
    v_fmac_f32 v242, v5, v149
    v_fmac_f32 v238, v13, v165
    v_fmac_f32 v242, v6, v150
    v_fmac_f32 v238, v14, v166
    v_fmac_f32 v242, v7, v151
    v_fmac_f32 v238, v15, v167
    v_fmac_f32 v236, v16, v112
    v_mul_f32 v244, v24, v160
    v_fmac_f32 v236, v17, v113
    v_fmac_f32 v244, v25, v161
    v_fmac_f32 v236, v18, v114
    v_fmac_f32 v244, v26, v162
    v_fmac_f32 v236, v19, v115
    v_fmac_f32 v244, v27, v163
    v_fmac_f32 v236, v20, v116
    v_fmac_f32 v244, v28, v164
    v_fmac_f32 v236, v21, v117
    v_fmac_f32 v244, v29, v165
    v_fmac_f32 v236, v22, v118
    v_fmac_f32 v244, v30, v166
    v_fmac_f32 v236, v23, v119
    v_fmac_f32 v244, v31, v167
    v_mul_f32 v243, v32, v152
    v_fma_f32 v239, v40, v168, -v239
    v_fmac_f32 v243, v33, v153
    v_fmac_f32 v239, v41, v169
    v_fmac_f32 v243, v34, v154
    v_fmac_f32 v239, v42, v170
    v_fmac_f32 v243, v35, v155
    v_fmac_f32 v239, v43, v171
    v_fmac_f32 v243, v36, v156
    v_fmac_f32 v239, v44, v172
    v_fmac_f32 v243, v37, v157
    v_fmac_f32 v239, v45, v173
    v_fmac_f32 v243, v38, v158
    v_fmac_f32 v239, v46, v174
    v_fmac_f32 v243, v39, v159
    v_fmac_f32 v239, v47, v175
    v_fmac_f32 v237, v48, v120
    v_mul_f32 v245, v56, v168
    v_fmac_f32 v237, v49, v121
    v_fmac_f32 v245, v57, v169
    v_fmac_f32 v237, v50, v122
    v_fmac_f32 v245, v58, v170
    v_fmac_f32 v237, v51, v123
    s_setprio 1
    s_waitcnt vmcnt(3) lgkmcnt(1)
    v_mfma_f32_32x32x16_bf16 v[0:15], v[64:67], v[184:187], 0
    ds_read_b64_tr_b16 v[176:177], v246 offset:4096
    ds_read_b64_tr_b16 v[178:179], v246 offset:5120
    ds_read_b64_tr_b16 v[180:181], v247 offset:4096
    ds_read_b64_tr_b16 v[182:183], v247 offset:5120
    v_fmac_f32 v245, v59, v171
    v_fmac_f32 v237, v52, v124
    s_mov_b32 m0, s69
    v_mfma_f32_32x32x16_bf16 v[16:31], v[68:71], v[184:187], 0
    buffer_load_dwordx4 v224, s[4:7], s45 offen sc1 lds
    buffer_load_dwordx4 v225, s[72:75], s45 offen offset:1024 sc1 lds
    s_waitcnt lgkmcnt(4)
    v_mad_u32_u16 v226, v226, s39, v248 op_sel:[1,0,0,0]
    v_mad_u32_u16 v227, v227, s39, v248 op_sel:[1,0,0,0]
    v_fmac_f32 v245, v60, v172
    v_fmac_f32 v237, v53, v125
    v_mfma_f32_32x32x16_bf16 v[32:47], v[64:67], v[188:191], 0
    v_add_u32 v228, s51, v251
    ds_read2_b32 v[228:229], v228 offset0:1 offset1:3
    v_fmac_f32 v245, v61, v173
    v_fmac_f32 v237, v54, v126
    v_fmac_f32 v245, v62, v174
    v_fmac_f32 v237, v55, v127
    v_fmac_f32 v245, v63, v175
    v_mfma_f32_32x32x16_bf16 v[48:63], v[68:71], v[188:191], 0
    v_permlane32_swap_b32 v242, v234
    v_permlane32_swap_b32 v243, v235
    v_add_f32 v242, v242, v234
    v_add_f32 v243, v243, v235
    s_waitcnt vmcnt(4) lgkmcnt(1)
    v_mfma_f32_32x32x16_bf16 v[0:15], v[72:75], v[176:179], v[0:15]
    ds_read_b64_tr_b16 v[184:185], v246 offset:6144
    ds_read_b64_tr_b16 v[188:189], v247 offset:6144
    v_cvt_pk_bf16_f32 v242, v242, v243
    ds_write_b32 v230, v242 offset:512
    s_mov_b32 s32, s31
    s_mov_b32 s31, s35
    s_mov_b32 m0, s70
    v_mfma_f32_32x32x16_bf16 v[16:31], v[76:79], v[176:179], v[16:31]
    buffer_load_dwordx4 v226, s[4:7], s46 offen sc1 lds
    buffer_load_dwordx4 v227, s[72:75], s46 offen offset:1024 sc1 lds
    s_waitcnt lgkmcnt(3)
    v_mad_u32_u16 v228, v228, s39, v248 op_sel:[1,0,0,0]
    v_mad_u32_u16 v229, v229, s39, v248 op_sel:[1,0,0,0]
    s_sub_u32 s26, s48, s29
    s_mov_b32 s29, s48
    v_mfma_f32_32x32x16_bf16 v[32:47], v[72:75], v[180:183], v[32:47]
    s_mov_b32 s30, s3
    s_bfe_u32 s56, s3, 0x40012
    s_cmp_lg_u32 s36, 0
    s_cselect_b32 s56, s56, 0
    v_mfma_f32_32x32x16_bf16 v[48:63], v[76:79], v[180:183], v[48:63]
    s_waitcnt vmcnt(4) lgkmcnt(1)
    v_mfma_f32_32x32x8_bf16 v[0:15], v[80:81], v[184:185], v[0:15]
    ds_read_b64_tr_b16 v[176:177], v246 offset:0
    ds_read_b64_tr_b16 v[178:179], v246 offset:1024
    ds_read_b64_tr_b16 v[180:181], v247 offset:0
    ds_read_b64_tr_b16 v[182:183], v247 offset:1024
    s_mov_b32 m0, s71
    v_mfma_f32_32x32x8_bf16 v[16:31], v[84:85], v[184:185], v[16:31]
    buffer_load_dwordx4 v228, s[4:7], s47 offen sc1 lds
    buffer_load_dwordx4 v229, s[72:75], s47 offen offset:1024 sc1 lds
    v_mfma_f32_32x32x8_bf16 v[32:47], v[80:81], v[188:189], v[32:47]
    s_nop 2
    v_mul_f32 v242, v0, v144
    v_fma_f32 v240, v8, v160, -v240
    v_fmac_f32 v242, v1, v145
    v_fmac_f32 v240, v9, v161
    v_fmac_f32 v242, v2, v146
    v_fmac_f32 v240, v10, v162
    v_fmac_f32 v242, v3, v147
    v_mfma_f32_32x32x8_bf16 v[48:63], v[84:85], v[188:189], v[48:63]
    s_setprio 0
    v_fmac_f32 v240, v11, v163
    v_fmac_f32 v242, v4, v148
    v_fmac_f32 v240, v12, v164
    v_fmac_f32 v242, v5, v149
    v_fmac_f32 v240, v13, v165
    v_fmac_f32 v242, v6, v150
    v_fmac_f32 v240, v14, v166
    v_fmac_f32 v242, v7, v151
    v_fmac_f32 v240, v15, v167
    v_add_u32 v249, s26, v249
    v_add_u32 v250, s26, v250
    v_fma_f32 v244, v16, v160, -v244
    v_fmac_f32 v236, v24, v112
    v_fmac_f32 v244, v17, v161
    v_fmac_f32 v236, v25, v113
    v_fmac_f32 v244, v18, v162
    v_fmac_f32 v236, v26, v114
    v_fmac_f32 v244, v19, v163
    v_fmac_f32 v236, v27, v115
    v_fmac_f32 v244, v20, v164
    v_fmac_f32 v236, v28, v116
    v_fmac_f32 v244, v21, v165
    v_fmac_f32 v236, v29, v117
    v_fmac_f32 v244, v22, v166
    v_fmac_f32 v236, v30, v118
    v_fmac_f32 v244, v23, v167
    v_fmac_f32 v236, v31, v119
    ds_read_b64_tr_b16 v[0:1], v249 offset:0
    ds_read_b64_tr_b16 v[2:3], v249 offset:32
    ds_read_u16_d16_hi v16, v250 offset:0
    v_mul_f32 v243, v32, v152
    v_fma_f32 v241, v40, v168, -v241
    v_fmac_f32 v243, v33, v153
    v_fmac_f32 v241, v41, v169
    v_fmac_f32 v243, v34, v154
    v_fmac_f32 v241, v42, v170
    v_fmac_f32 v243, v35, v155
    v_fmac_f32 v241, v43, v171
    v_fmac_f32 v243, v36, v156
    v_fmac_f32 v241, v44, v172
    v_fmac_f32 v243, v37, v157
    v_fmac_f32 v241, v45, v173
    v_fmac_f32 v243, v38, v158
    v_fmac_f32 v241, v46, v174
    v_fmac_f32 v243, v39, v159
    v_fmac_f32 v241, v47, v175
    ds_read_b64_tr_b16 v[4:5], v249 offset:512
    ds_read_b64_tr_b16 v[6:7], v249 offset:544
    ds_read_u16_d16_hi v17, v250 offset:128
    v_fma_f32 v245, v48, v168, -v245
    v_fmac_f32 v237, v56, v120
    v_fmac_f32 v245, v49, v169
    v_fmac_f32 v237, v57, v121
    v_fmac_f32 v245, v50, v170
    v_fmac_f32 v237, v58, v122
    v_fmac_f32 v245, v51, v171
    v_fmac_f32 v237, v59, v123
    v_fmac_f32 v245, v52, v172
    v_fmac_f32 v237, v60, v124
    v_fmac_f32 v245, v53, v173
    v_fmac_f32 v237, v61, v125
    v_fmac_f32 v245, v54, v174
    v_fmac_f32 v237, v62, v126
    v_fmac_f32 v245, v55, v175
    v_fmac_f32 v237, v63, v127
    s_cmp_eq_u32 s56, 5
    s_cbranch_scc1 K2_U21
    s_cmp_eq_u32 s56, 6
    s_cbranch_scc1 K2_U3h1
    s_branch K2_DSP1
K2_U31:
    s_setprio 1
    ds_read_b64_tr_b16 v[8:9], v249 offset:1024
    ds_read_b64_tr_b16 v[10:11], v249 offset:1056
    ds_read_u16_d16_hi v18, v250 offset:256
    s_waitcnt lgkmcnt(3)
    v_lshlrev_b32 v20, 16, v0
    v_and_b32 v21, 0xffff0000, v0
    v_lshlrev_b32 v22, 16, v1
    v_and_b32 v23, 0xffff0000, v1
    v_lshlrev_b32 v24, 16, v2
    v_and_b32 v25, 0xffff0000, v2
    v_lshlrev_b32 v26, 16, v3
    v_and_b32 v27, 0xffff0000, v3
    v_mul_f32_dpp v36, v16, v20 row_newbcast:8 row_mask:0xf bank_mask:0xf
    v_mul_f32_dpp v37, v16, v21 row_newbcast:9 row_mask:0xf bank_mask:0xf
    v_mul_f32_dpp v38, v16, v22 row_newbcast:10 row_mask:0xf bank_mask:0xf
    v_mul_f32_dpp v39, v16, v23 row_newbcast:11 row_mask:0xf bank_mask:0xf
    v_mul_f32_dpp v40, v16, v24 row_newbcast:12 row_mask:0xf bank_mask:0xf
    v_mul_f32_dpp v41, v16, v25 row_newbcast:13 row_mask:0xf bank_mask:0xf
    v_mul_f32_dpp v42, v16, v26 row_newbcast:14 row_mask:0xf bank_mask:0xf
    v_mul_f32_dpp v43, v16, v27 row_newbcast:15 row_mask:0xf bank_mask:0xf
    v_cvt_pk_bf16_f32 v68, v36, v37
    v_cvt_pk_bf16_f32 v69, v38, v39
    v_cvt_pk_bf16_f32 v70, v40, v41
    v_cvt_pk_bf16_f32 v71, v42, v43
    v_mul_f32_dpp v20, v16, v20 row_newbcast:0 row_mask:0xa bank_mask:0xf
    v_mul_f32_dpp v21, v16, v21 row_newbcast:1 row_mask:0xa bank_mask:0xf
    v_mul_f32_dpp v22, v16, v22 row_newbcast:2 row_mask:0xa bank_mask:0xf
    v_mul_f32_dpp v23, v16, v23 row_newbcast:3 row_mask:0xa bank_mask:0xf
    v_mul_f32_dpp v24, v16, v24 row_newbcast:4 row_mask:0xa bank_mask:0xf
    v_mul_f32_dpp v25, v16, v25 row_newbcast:5 row_mask:0xa bank_mask:0xf
    v_mul_f32_dpp v26, v16, v26 row_newbcast:6 row_mask:0xa bank_mask:0xf
    v_mul_f32_dpp v27, v16, v27 row_newbcast:7 row_mask:0xa bank_mask:0xf
    v_cvt_pk_bf16_f32 v64, v20, v21
    v_cvt_pk_bf16_f32 v65, v22, v23
    v_cvt_pk_bf16_f32 v66, v24, v25
    v_cvt_pk_bf16_f32 v67, v26, v27
    v_lshlrev_b32 v28, 16, v4
    v_and_b32 v29, 0xffff0000, v4
    v_lshlrev_b32 v30, 16, v5
    v_and_b32 v31, 0xffff0000, v5
    v_lshlrev_b32 v32, 16, v6
    v_and_b32 v33, 0xffff0000, v6
    v_lshlrev_b32 v34, 16, v7
    v_and_b32 v35, 0xffff0000, v7
    v_mul_f32_dpp v36, v17, v28 row_newbcast:8 row_mask:0xf bank_mask:0xf
    v_mul_f32_dpp v37, v17, v29 row_newbcast:9 row_mask:0xf bank_mask:0xf
    v_mul_f32_dpp v38, v17, v30 row_newbcast:10 row_mask:0xf bank_mask:0xf
    v_mul_f32_dpp v39, v17, v31 row_newbcast:11 row_mask:0xf bank_mask:0xf
    v_mul_f32_dpp v40, v17, v32 row_newbcast:12 row_mask:0xf bank_mask:0xf
    v_mul_f32_dpp v41, v17, v33 row_newbcast:13 row_mask:0xf bank_mask:0xf
    v_mul_f32_dpp v42, v17, v34 row_newbcast:14 row_mask:0xf bank_mask:0xf
    v_mul_f32_dpp v43, v17, v35 row_newbcast:15 row_mask:0xf bank_mask:0xf
    v_cvt_pk_bf16_f32 v76, v36, v37
    v_cvt_pk_bf16_f32 v77, v38, v39
    v_cvt_pk_bf16_f32 v78, v40, v41
    v_cvt_pk_bf16_f32 v79, v42, v43
    v_mul_f32_dpp v28, v17, v28 row_newbcast:0 row_mask:0xa bank_mask:0xf
    v_mul_f32_dpp v29, v17, v29 row_newbcast:1 row_mask:0xa bank_mask:0xf
    v_mul_f32_dpp v30, v17, v30 row_newbcast:2 row_mask:0xa bank_mask:0xf
    v_mul_f32_dpp v31, v17, v31 row_newbcast:3 row_mask:0xa bank_mask:0xf
    v_mul_f32_dpp v32, v17, v32 row_newbcast:4 row_mask:0xa bank_mask:0xf
    v_mul_f32_dpp v33, v17, v33 row_newbcast:5 row_mask:0xa bank_mask:0xf
    v_mul_f32_dpp v34, v17, v34 row_newbcast:6 row_mask:0xa bank_mask:0xf
    v_mul_f32_dpp v35, v17, v35 row_newbcast:7 row_mask:0xa bank_mask:0xf
    v_cvt_pk_bf16_f32 v72, v28, v29
    v_cvt_pk_bf16_f32 v73, v30, v31
    v_cvt_pk_bf16_f32 v74, v32, v33
    v_cvt_pk_bf16_f32 v75, v34, v35
    s_waitcnt lgkmcnt(0)
    v_lshlrev_b32 v20, 16, v8
    v_and_b32 v21, 0xffff0000, v8
    v_lshlrev_b32 v22, 16, v9
    v_and_b32 v23, 0xffff0000, v9
    v_lshlrev_b32 v24, 16, v10
    v_and_b32 v25, 0xffff0000, v10
    v_lshlrev_b32 v26, 16, v11
    v_and_b32 v27, 0xffff0000, v11
    v_mul_f32_dpp v36, v18, v20 row_newbcast:8 row_mask:0xf bank_mask:0xf
    v_mul_f32_dpp v37, v18, v21 row_newbcast:9 row_mask:0xf bank_mask:0xf
    v_mul_f32_dpp v38, v18, v22 row_newbcast:10 row_mask:0xf bank_mask:0xf
    v_mul_f32_dpp v39, v18, v23 row_newbcast:11 row_mask:0xf bank_mask:0xf
    v_mul_f32_dpp v40, v18, v24 row_newbcast:12 row_mask:0xf bank_mask:0xf
    v_mul_f32_dpp v41, v18, v25 row_newbcast:13 row_mask:0xf bank_mask:0xf
    v_mul_f32_dpp v42, v18, v26 row_newbcast:14 row_mask:0xf bank_mask:0xf
    v_mul_f32_dpp v43, v18, v27 row_newbcast:15 row_mask:0xf bank_mask:0xf
    v_cvt_pk_bf16_f32 v84, v36, v37
    v_cvt_pk_bf16_f32 v85, v38, v39
    v_cvt_pk_bf16_f32 v86, v40, v41
    v_cvt_pk_bf16_f32 v87, v42, v43
    v_mul_f32_dpp v20, v18, v20 row_newbcast:0 row_mask:0xa bank_mask:0xf
    v_mul_f32_dpp v21, v18, v21 row_newbcast:1 row_mask:0xa bank_mask:0xf
    v_mul_f32_dpp v22, v18, v22 row_newbcast:2 row_mask:0xa bank_mask:0xf
    v_mul_f32_dpp v23, v18, v23 row_newbcast:3 row_mask:0xa bank_mask:0xf
    v_mul_f32_dpp v24, v18, v24 row_newbcast:4 row_mask:0xa bank_mask:0xf
    v_mul_f32_dpp v25, v18, v25 row_newbcast:5 row_mask:0xa bank_mask:0xf
    v_mul_f32_dpp v26, v18, v26 row_newbcast:6 row_mask:0xa bank_mask:0xf
    v_mul_f32_dpp v27, v18, v27 row_newbcast:7 row_mask:0xa bank_mask:0xf
    v_cvt_pk_bf16_f32 v80, v20, v21
    v_cvt_pk_bf16_f32 v81, v22, v23
    v_cvt_pk_bf16_f32 v82, v24, v25
    v_cvt_pk_bf16_f32 v83, v26, v27
    s_waitcnt vmcnt(4)
    v_mfma_f32_32x32x16_bf16 v[0:15], v[64:67], v[176:179], 0
    ds_read_b64_tr_b16 v[184:185], v246 offset:2048
    ds_read_b64_tr_b16 v[186:187], v246 offset:3072
    ds_read_b64_tr_b16 v[188:189], v247 offset:2048
    ds_read_b64_tr_b16 v[190:191], v247 offset:3072
    s_mov_b32 m0, s68
    v_mfma_f32_32x32x16_bf16 v[16:31], v[68:71], v[176:179], 0
    buffer_load_dwordx4 v224, s[4:7], s41 offen sc1 lds
    buffer_load_dwordx4 v225, s[72:75], s41 offen offset:1024 sc1 lds
    v_permlane32_swap_b32 v242, v236
    v_permlane32_swap_b32 v243, v237
    v_mov_b32 v254, 163296
    v_mfma_f32_32x32x16_bf16 v[32:47], v[64:67], v[180:183], 0
    v_permlane32_swap_b32 v244, v238
    v_permlane32_swap_b32 v245, v239
    v_permlane32_swap_b32 v240, v241
    v_add_f32 v242, v242, v236
    v_mfma_f32_32x32x16_bf16 v[48:63], v[68:71], v[180:183], 0
    v_add_f32 v243, v243, v237
    v_add_f32 v244, v244, v238
    v_add_f32 v245, v245, v239
    v_add_f32 v240, -v240, -v241
    v_sub_u32 v241, v230, v231
    v_cvt_pk_bf16_f32 v242, v242, v243
    v_mov_b32 v255, 1
    v_lshl_add_u32 v233, v252, 1, s53
    s_mov_b64 exec, 1
    ds_add_rtn_u32 v232, v254, v255
    s_mov_b64 exec, -1
    ds_read_b32 v233, v233
    s_waitcnt vmcnt(4) lgkmcnt(2)
    v_mfma_f32_32x32x16_bf16 v[0:15], v[72:75], v[184:187], v[0:15]
    ds_read_b64_tr_b16 v[176:177], v246 offset:4096
    ds_read_b64_tr_b16 v[178:179], v246 offset:5120
    ds_read_b64_tr_b16 v[180:181], v247 offset:4096
    ds_read_b64_tr_b16 v[182:183], v247 offset:5120
    v_cvt_pk_bf16_f32 v244, v244, v245
    v_cvt_pk_bf16_f32 v240, v240, v240
    s_mov_b32 m0, s69
    v_mfma_f32_32x32x16_bf16 v[16:31], v[76:79], v[184:187], v[16:31]
    buffer_load_dwordx4 v226, s[4:7], s41 offen sc1 lds
    buffer_load_dwordx4 v227, s[72:75], s41 offen offset:1024 sc1 lds
    ds_write_b32 v230, v242 offset:768
    ds_write_b32 v230, v244 offset:1024
    ds_write_b16 v241, v240 offset:1280
    s_waitcnt lgkmcnt(7)
    v_readfirstlane_b32 s58, v232
    v_mfma_f32_32x32x16_bf16 v[32:47], v[72:75], v[188:191], v[32:47]
    s_cmp_lt_u32 s58, s22
    s_cbranch_scc0 K2_nul_61
    s_and_b32 s59, s58, 7
    s_lshr_b32 s60, s58, 3
K2_chk_63:
    v_readlane_b32 s61, v233, s59
    s_nop 0
    s_cmp_gt_u32 s61, s60
    s_cbranch_scc0 K2_spin_62
K2_back_64:
    v_mfma_f32_32x32x16_bf16 v[48:63], v[76:79], v[188:191], v[48:63]
    v_readlane_b32 s3, v253, s58
    s_lshl_b32 s44, s34, 7
    s_and_b32 s48, s3, 0x3ffff
    s_bfe_u32 s33, s3, 0x30013
    s_mov_b32 s35, s48
    s_mov_b32 s45, s44
    s_waitcnt vmcnt(4) lgkmcnt(3)
    v_mfma_f32_32x32x16_bf16 v[0:15], v[80:83], v[176:179], v[0:15]
    ds_read_b64_tr_b16 v[184:185], v246 offset:6144
    ds_read_b64_tr_b16 v[186:187], v246 offset:7168
    ds_read_b64_tr_b16 v[188:189], v247 offset:6144
    ds_read_b64_tr_b16 v[190:191], v247 offset:7168
    s_xor_b32 s47, s44, 256
    s_add_u32 s49, s48, 128
    s_mov_b32 m0, s70
    v_mfma_f32_32x32x16_bf16 v[16:31], v[84:87], v[176:179], v[16:31]
    buffer_load_dwordx4 v222, s[4:7], s42 offen sc1 lds
    buffer_load_dwordx4 v223, s[72:75], s42 offen offset:1024 sc1 lds
    s_add_u32 s60, s48, 256
    s_cmp_eq_u32 s33, 3
    s_cselect_b32 s46, s44, s47
    s_cselect_b32 s50, s60, s48
    s_cselect_b32 s51, s48, s49
    v_mfma_f32_32x32x16_bf16 v[32:47], v[80:83], v[180:183], v[32:47]
    s_sub_u32 s60, s33, 2
    s_cmp_lt_u32 s60, 2
    s_cbranch_scc0 K2_rare_65
K2_back_66:
    v_mul_f32 v234, v0, v96
    v_mul_f32 v236, v8, v128
    v_fmac_f32 v234, v1, v97
    v_fmac_f32 v236, v9, v129
    v_mfma_f32_32x32x16_bf16 v[48:63], v[84:87], v[180:183], v[48:63]
    s_setprio 0
    v_fmac_f32 v234, v2, v98
    v_fmac_f32 v236, v10, v130
    v_fmac_f32 v234, v3, v99
    v_fmac_f32 v236, v11, v131
    v_fmac_f32 v234, v4, v100
    v_fmac_f32 v236, v12, v132
    v_fmac_f32 v234, v5, v101
    v_fmac_f32 v236, v13, v133
    v_fmac_f32 v234, v6, v102
    v_fmac_f32 v236, v14, v134
    v_fmac_f32 v234, v7, v103
    v_fmac_f32 v236, v15, v135
    v_mul_f32 v238, v16, v128
    v_mul_f32 v240, v24, v128
    v_fmac_f32 v238, v17, v129
    v_fmac_f32 v240, v25, v129
    v_fmac_f32 v238, v18, v130
    v_fmac_f32 v240, v26, v130
    v_fmac_f32 v238, v19, v131
    v_fmac_f32 v240, v27, v131
    v_fmac_f32 v238, v20, v132
    v_fmac_f32 v240, v28, v132
    v_fmac_f32 v238, v21, v133
    v_fmac_f32 v240, v29, v133
    v_fmac_f32 v238, v22, v134
    v_fmac_f32 v240, v30, v134
    v_fmac_f32 v238, v23, v135
    v_fmac_f32 v240, v31, v135
    v_mul_f32 v235, v32, v104
    v_mul_f32 v237, v40, v136
    v_fmac_f32 v235, v33, v105
    v_fmac_f32 v237, v41, v137
    v_fmac_f32 v235, v34, v106
    v_fmac_f32 v237, v42, v138
    v_fmac_f32 v235, v35, v107
    v_fmac_f32 v237, v43, v139
    v_fmac_f32 v235, v36, v108
    v_fmac_f32 v237, v44, v140
    v_fmac_f32 v235, v37, v109
    v_fmac_f32 v237, v45, v141
    v_fmac_f32 v235, v38, v110
    v_fmac_f32 v237, v46, v142
    v_fmac_f32 v235, v39, v111
    v_fmac_f32 v237, v47, v143
    v_mul_f32 v239, v48, v136
    v_mul_f32 v241, v56, v136
    s_setprio 1
    s_waitcnt vmcnt(4) lgkmcnt(0)
    v_mfma_f32_32x32x16_bf16 v[0:15], v[64:67], v[184:187], 0
    ds_read_b64_tr_b16 v[176:177], v246 offset:0
    ds_read_b64_tr_b16 v[178:179], v246 offset:1024
    ds_read_b64_tr_b16 v[180:181], v247 offset:0
    ds_read_b64_tr_b16 v[182:183], v247 offset:1024
    v_fmac_f32 v239, v49, v137
    v_fmac_f32 v241, v57, v137
    s_mov_b32 m0, s71
    v_mfma_f32_32x32x16_bf16 v[16:31], v[68:71], v[184:187], 0
    buffer_load_dwordx4 v224, s[4:7], s42 offen sc1 lds
    buffer_load_dwordx4 v225, s[72:75], s42 offen offset:1024 sc1 lds
    v_fmac_f32 v239, v50, v138
    v_fmac_f32 v241, v58, v138
    v_fmac_f32 v239, v51, v139
    v_fmac_f32 v241, v59, v139
    v_fmac_f32 v239, v52, v140
    v_mfma_f32_32x32x16_bf16 v[32:47], v[64:67], v[188:191], 0
    v_fmac_f32 v241, v60, v140
    v_fmac_f32 v239, v53, v141
    v_fmac_f32 v241, v61, v141
    v_fmac_f32 v239, v54, v142
    v_fmac_f32 v241, v62, v142
    v_fmac_f32 v239, v55, v143
    v_fmac_f32 v241, v63, v143
    v_mfma_f32_32x32x16_bf16 v[48:63], v[68:71], v[188:191], 0
    v_permlane32_swap_b32 v234, v236
    v_permlane32_swap_b32 v235, v237
    v_permlane32_swap_b32 v240, v238
    s_waitcnt vmcnt(4) lgkmcnt(0)
    v_mfma_f32_32x32x16_bf16 v[0:15], v[72:75], v[176:179], v[0:15]
    ds_read_b64_tr_b16 v[184:185], v246 offset:2048
    ds_read_b64_tr_b16 v[186:187], v246 offset:3072
    ds_read_b64_tr_b16 v[188:189], v247 offset:2048
    ds_read_b64_tr_b16 v[190:191], v247 offset:3072
    v_permlane32_swap_b32 v241, v239
    s_mov_b32 m0, s68
    v_mfma_f32_32x32x16_bf16 v[16:31], v[76:79], v[176:179], v[16:31]
    buffer_load_dwordx4 v226, s[4:7], s42 offen sc1 lds
    buffer_load_dwordx4 v227, s[72:75], s42 offen offset:1024 sc1 lds
    v_lshl_add_u32 v230, v252, 1, s31
    v_add_f32 v234, v234, v236
    v_add_f32 v235, v235, v237
    v_add_f32 v240, v240, v238
    v_add_f32 v241, v241, v239
    v_mfma_f32_32x32x16_bf16 v[32:47], v[72:75], v[180:183], v[32:47]
    v_cvt_pk_bf16_f32 v234, v234, v235
    v_cvt_pk_bf16_f32 v240, v240, v241
    ds_write_b32 v230, v234 offset:0
    ds_write_b32 v230, v240 offset:256
    v_mfma_f32_32x32x16_bf16 v[48:63], v[76:79], v[180:183], v[48:63]
    s_waitcnt vmcnt(4) lgkmcnt(2)
    v_mfma_f32_32x32x16_bf16 v[0:15], v[80:83], v[184:187], v[0:15]
    ds_read_b64_tr_b16 v[176:177], v246 offset:4096
    ds_read_b64_tr_b16 v[178:179], v246 offset:5120
    ds_read_b64_tr_b16 v[180:181], v247 offset:4096
    ds_read_b64_tr_b16 v[182:183], v247 offset:5120
    s_mov_b32 m0, s69
    v_mfma_f32_32x32x16_bf16 v[16:31], v[84:87], v[184:187], v[16:31]
    buffer_load_dwordx4 v222, s[4:7], s43 offen sc1 lds
    buffer_load_dwordx4 v223, s[72:75], s43 offen offset:1024 sc1 lds
    v_mfma_f32_32x32x16_bf16 v[32:47], v[80:83], v[188:191], v[32:47]
    s_nop 2
    v_mul_f32 v234, v0, v144
    v_mul_f32 v236, v8, v112
    v_fmac_f32 v234, v1, v145
    v_fmac_f32 v236, v9, v113
    v_fmac_f32 v234, v2, v146
    v_fmac_f32 v236, v10, v114
    v_fmac_f32 v234, v3, v147
    v_mfma_f32_32x32x16_bf16 v[48:63], v[84:87], v[188:191], v[48:63]
    s_setprio 0
    v_fmac_f32 v236, v11, v115
    v_fmac_f32 v234, v4, v148
    v_fmac_f32 v236, v12, v116
    v_fmac_f32 v234, v5, v149
    v_fmac_f32 v236, v13, v117
    v_fmac_f32 v234, v6, v150
    v_fmac_f32 v236, v14, v118
    v_fmac_f32 v234, v7, v151
    v_fmac_f32 v236, v15, v119
    v_mul_f32 v238, v16, v160
    v_mul_f32 v240, v24, v160
    v_fmac_f32 v238, v17, v161
    v_fmac_f32 v240, v25, v161
    v_fmac_f32 v238, v18, v162
    v_fmac_f32 v240, v26, v162
    v_fmac_f32 v238, v19, v163
    v_fmac_f32 v240, v27, v163
    v_fmac_f32 v238, v20, v164
    v_fmac_f32 v240, v28, v164
    v_fmac_f32 v238, v21, v165
    v_fmac_f32 v240, v29, v165
    v_fmac_f32 v238, v22, v166
    v_fmac_f32 v240, v30, v166
    v_fmac_f32 v238, v23, v167
    v_fmac_f32 v240, v31, v167
    v_mul_f32 v235, v32, v152
    v_mul_f32 v237, v40, v120
    v_fmac_f32 v235, v33, v153
    v_fmac_f32 v237, v41, v121
    v_fmac_f32 v235, v34, v154
    v_fmac_f32 v237, v42, v122
    v_fmac_f32 v235, v35, v155
    v_fmac_f32 v237, v43, v123
    v_fmac_f32 v235, v36, v156
    v_fmac_f32 v237, v44, v124
    v_fmac_f32 v235, v37, v157
    v_fmac_f32 v237, v45, v125
    v_fmac_f32 v235, v38, v158
    v_fmac_f32 v237, v46, v126
    v_fmac_f32 v235, v39, v159
    v_fmac_f32 v237, v47, v127
    v_mul_f32 v239, v48, v168
    v_mul_f32 v241, v56, v168
    v_fmac_f32 v239, v49, v169
    v_fmac_f32 v241, v57, v169
    s_setprio 1
    s_waitcnt vmcnt(4) lgkmcnt(0)
    v_mfma_f32_32x32x16_bf16 v[0:15], v[64:67], v[176:179], 0
    ds_read_b64_tr_b16 v[184:185], v246 offset:6144
    ds_read_b64_tr_b16 v[186:187], v246 offset:7168
    ds_read_b64_tr_b16 v[188:189], v247 offset:6144
    ds_read_b64_tr_b16 v[190:191], v247 offset:7168
    v_fmac_f32 v239, v50, v170
    v_fmac_f32 v241, v58, v170
    s_mov_b32 m0, s70
    v_mfma_f32_32x32x16_bf16 v[16:31], v[68:71], v[176:179], 0
    buffer_load_dwordx4 v224, s[4:7], s43 offen sc1 lds
    buffer_load_dwordx4 v225, s[72:75], s43 offen offset:1024 sc1 lds
    v_fmac_f32 v239, v51, v171
    v_fmac_f32 v241, v59, v171
    v_fmac_f32 v239, v52, v172
    v_fmac_f32 v241, v60, v172
    v_fmac_f32 v239, v53, v173
    v_mfma_f32_32x32x16_bf16 v[32:47], v[64:67], v[180:183], 0
    v_add_u32 v222, s48, v251
    ds_read2_b32 v[222:223], v222 offset0:1 offset1:3
    v_fmac_f32 v241, v61, v173
    v_fmac_f32 v239, v54, v174
    v_fmac_f32 v241, v62, v174
    v_fmac_f32 v239, v55, v175
    v_fmac_f32 v241, v63, v175
    v_mfma_f32_32x32x16_bf16 v[48:63], v[68:71], v[180:183], 0
    s_waitcnt vmcnt(4) lgkmcnt(1)
    v_mfma_f32_32x32x16_bf16 v[0:15], v[72:75], v[184:187], v[0:15]
    ds_read_b64_tr_b16 v[176:177], v246 offset:0
    ds_read_b64_tr_b16 v[178:179], v246 offset:1024
    ds_read_b64_tr_b16 v[180:181], v247 offset:0
    ds_read_b64_tr_b16 v[182:183], v247 offset:1024
    s_mov_b32 m0, s71
    v_mfma_f32_32x32x16_bf16 v[16:31], v[76:79], v[184:187], v[16:31]
    buffer_load_dwordx4 v226, s[4:7], s43 offen sc1 lds
    buffer_load_dwordx4 v227, s[72:75], s43 offen offset:1024 sc1 lds
    s_waitcnt lgkmcnt(4)
    v_mad_u32_u16 v222, v222, s39, v248 op_sel:[1,0,0,0]
    v_mad_u32_u16 v223, v223, s39, v248 op_sel:[1,0,0,0]
    v_mfma_f32_32x32x16_bf16 v[32:47], v[72:75], v[188:191], v[32:47]
    v_add_u32 v224, s49, v251
    ds_read2_b32 v[224:225], v224 offset0:1 offset1:3
    v_mfma_f32_32x32x16_bf16 v[48:63], v[76:79], v[188:191], v[48:63]
    s_waitcnt vmcnt(4) lgkmcnt(1)
    v_mfma_f32_32x32x16_bf16 v[0:15], v[80:83], v[176:179], v[0:15]
    ds_read_b64_tr_b16 v[184:185], v246 offset:2048
    ds_read_b64_tr_b16 v[186:187], v246 offset:3072
    ds_read_b64_tr_b16 v[188:189], v247 offset:2048
    ds_read_b64_tr_b16 v[190:191], v247 offset:3072
    s_mov_b32 m0, s68
    v_mfma_f32_32x32x16_bf16 v[16:31], v[84:87], v[176:179], v[16:31]
    buffer_load_dwordx4 v222, s[4:7], s44 offen sc1 lds
    buffer_load_dwordx4 v223, s[72:75], s44 offen offset:1024 sc1 lds
    s_waitcnt lgkmcnt(4)
    v_mad_u32_u16 v224, v224, s39, v248 op_sel:[1,0,0,0]
    v_mad_u32_u16 v225, v225, s39, v248 op_sel:[1,0,0,0]
    v_mfma_f32_32x32x16_bf16 v[32:47], v[80:83], v[180:183], v[32:47]
    v_add_u32 v226, s50, v251
    ds_read2_b32 v[226:227], v226 offset0:1 offset1:3
    v_mul_f32 v242, v0, v144
    v_fma_f32 v238, v8, v160, -v238
    v_fmac_f32 v242, v1, v145
    v_fmac_f32 v238, v9, v161
    v_fmac_f32 v242, v2, v146
    v_mfma_f32_32x32x16_bf16 v[48:63], v[84:87], v[180:183], v[48:63]
    s_setprio 0
    v_fmac_f32 v238, v10, v162
    v_fmac_f32 v242, v3, v147
    v_fmac_f32 v238, v11, v163
    v_fmac_f32 v242, v4, v148
    v_fmac_f32 v238, v12, v164
    v_fmac_f32 v242, v5, v149
    v_fmac_f32 v238, v13, v165
    v_fmac_f32 v242, v6, v150
    v_fmac_f32 v238, v14, v166
    v_fmac_f32 v242, v7, v151
    v_fmac_f32 v238, v15, v167
    v_fmac_f32 v236, v16, v112
    v_mul_f32 v244, v24, v160
    v_fmac_f32 v236, v17, v113
    v_fmac_f32 v244, v25, v161
    v_fmac_f32 v236, v18, v114
    v_fmac_f32 v244, v26, v162
    v_fmac_f32 v236, v19, v115
    v_fmac_f32 v244, v27, v163
    v_fmac_f32 v236, v20, v116
    v_fmac_f32 v244, v28, v164
    v_fmac_f32 v236, v21, v117
    v_fmac_f32 v244, v29, v165
    v_fmac_f32 v236, v22, v118
    v_fmac_f32 v244, v30, v166
    v_fmac_f32 v236, v23, v119
    v_fmac_f32 v244, v31, v167
    v_mul_f32 v243, v32, v152
    v_fma_f32 v239, v40, v168, -v239
    v_fmac_f32 v243, v33, v153
    v_fmac_f32 v239, v41, v169
    v_fmac_f32 v243, v34, v154
    v_fmac_f32 v239, v42, v170
    v_fmac_f32 v243, v35, v155
    v_fmac_f32 v239, v43, v171
    v_fmac_f32 v243, v36, v156
    v_fmac_f32 v239, v44, v172
    v_fmac_f32 v243, v37, v157
    v_fmac_f32 v239, v45, v173
    v_fmac_f32 v243, v38, v158
    v_fmac_f32 v239, v46, v174
    v_fmac_f32 v243, v39, v159
    v_fmac_f32 v239, v47, v175
    v_fmac_f32 v237, v48, v120
    v_mul_f32 v245, v56, v168
    v_fmac_f32 v237, v49, v121
    v_fmac_f32 v245, v57, v169
    v_fmac_f32 v237, v50, v122
    v_fmac_f32 v245, v58, v170
    v_fmac_f32 v237, v51, v123
    s_setprio 1
    s_waitcnt vmcnt(4) lgkmcnt(1)
    v_mfma_f32_32x32x16_bf16 v[0:15], v[64:67], v[184:187], 0
    ds_read_b64_tr_b16 v[176:177], v246 offset:4096
    ds_read_b64_tr_b16 v[178:179], v246 offset:5120
    ds_read_b64_tr_b16 v[180:181], v247 offset:4096
    ds_read_b64_tr_b16 v[182:183], v247 offset:5120
    v_fmac_f32 v245, v59, v171
    v_fmac_f32 v237, v52, v124
    s_mov_b32 m0, s69
    v_mfma_f32_32x32x16_bf16 v[16:31], v[68:71], v[184:187], 0
    buffer_load_dwordx4 v224, s[4:7], s45 offen sc1 lds
    buffer_load_dwordx4 v225, s[72:75], s45 offen offset:1024 sc1 lds
    s_waitcnt lgkmcnt(4)
    v_mad_u32_u16 v226, v226, s39, v248 op_sel:[1,0,0,0]
    v_mad_u32_u16 v227, v227, s39, v248 op_sel:[1,0,0,0]
    v_fmac_f32 v245, v60, v172
    v_fmac_f32 v237, v53, v125
    v_mfma_f32_32x32x16_bf16 v[32:47], v[64:67], v[188:191], 0
    v_add_u32 v228, s51, v251
    ds_read2_b32 v[228:229], v228 offset0:1 offset1:3
    v_fmac_f32 v245, v61, v173
    v_fmac_f32 v237, v54, v126
    v_fmac_f32 v245, v62, v174
    v_fmac_f32 v237, v55, v127
    v_fmac_f32 v245, v63, v175
    v_mfma_f32_32x32x16_bf16 v[48:63], v[68:71], v[188:191], 0
    v_permlane32_swap_b32 v242, v234
    v_permlane32_swap_b32 v243, v235
    v_add_f32 v242, v242, v234
    v_add_f32 v243, v243, v235
    s_waitcnt vmcnt(4) lgkmcnt(1)
    v_mfma_f32_32x32x16_bf16 v[0:15], v[72:75], v[176:179], v[0:15]
    ds_read_b64_tr_b16 v[184:185], v246 offset:6144
    ds_read_b64_tr_b16 v[186:187], v246 offset:7168
    ds_read_b64_tr_b16 v[188:189], v247 offset:6144
    ds_read_b64_tr_b16 v[190:191], v247 offset:7168
    v_cvt_pk_bf16_f32 v242, v242, v243
    ds_write_b32 v230, v242 offset:512
    s_mov_b32 m0, s70
    v_mfma_f32_32x32x16_bf16 v[16:31], v[76:79], v[176:179], v[16:31]
    buffer_load_dwordx4 v226, s[4:7], s46 offen sc1 lds
    buffer_load_dwordx4 v227, s[72:75], s46 offen offset:1024 sc1 lds
    s_waitcnt lgkmcnt(5)
    v_mad_u32_u16 v228, v228, s39, v248 op_sel:[1,0,0,0]
    v_mad_u32_u16 v229, v229, s39, v248 op_sel:[1,0,0,0]
    s_sub_u32 s26, s48, s29
    s_mov_b32 s29, s48
    v_mfma_f32_32x32x16_bf16 v[32:47], v[72:75], v[180:183], v[32:47]
    s_mov_b32 s30, s3
    s_bfe_u32 s56, s3, 0x40012
    s_cmp_lg_u32 s36, 0
    s_cselect_b32 s56, s56, 0
    s_mov_b32 s32, s31
    s_mov_b32 s31, s35
    v_mfma_f32_32x32x16_bf16 v[48:63], v[76:79], v[180:183], v[48:63]
    s_waitcnt vmcnt(4) lgkmcnt(1)
    v_mfma_f32_32x32x16_bf16 v[0:15], v[80:83], v[184:187], v[0:15]
    ds_read_b64_tr_b16 v[176:177], v246 offset:0
    ds_read_b64_tr_b16 v[178:179], v246 offset:1024
    ds_read_b64_tr_b16 v[180:181], v247 offset:0
    ds_read_b64_tr_b16 v[182:183], v247 offset:1024
    s_mov_b32 m0, s71
    v_mfma_f32_32x32x16_bf16 v[16:31], v[84:87], v[184:187], v[16:31]
    buffer_load_dwordx4 v228, s[4:7], s47 offen sc1 lds
    buffer_load_dwordx4 v229, s[72:75], s47 offen offset:1024 sc1 lds
    v_mfma_f32_32x32x16_bf16 v[32:47], v[80:83], v[188:191], v[32:47]
    s_nop 2
    v_mul_f32 v242, v0, v144
    v_fma_f32 v240, v8, v160, -v240
    v_fmac_f32 v242, v1, v145
    v_fmac_f32 v240, v9, v161
    v_fmac_f32 v242, v2, v146
    v_fmac_f32 v240, v10, v162
    v_fmac_f32 v242, v3, v147
    v_mfma_f32_32x32x16_bf16 v[48:63], v[84:87], v[188:191], v[48:63]
    s_setprio 0
    v_fmac_f32 v240, v11, v163
    v_fmac_f32 v242, v4, v148
    v_fmac_f32 v240, v12, v164
    v_fmac_f32 v242, v5, v149
    v_fmac_f32 v240, v13, v165
    v_fmac_f32 v242, v6, v150
    v_fmac_f32 v240, v14, v166
    v_fmac_f32 v242, v7, v151
    v_fmac_f32 v240, v15, v167
    v_add_u32 v249, s26, v249
    v_add_u32 v250, s26, v250
    v_fma_f32 v244, v16, v160, -v244
    v_fmac_f32 v236, v24, v112
    v_fmac_f32 v244, v17, v161
    v_fmac_f32 v236, v25, v113
    v_fmac_f32 v244, v18, v162
    v_fmac_f32 v236, v26, v114
    v_fmac_f32 v244, v19, v163
    v_fmac_f32 v236, v27, v115
    v_fmac_f32 v244, v20, v164
    v_fmac_f32 v236, v28, v116
    v_fmac_f32 v244, v21, v165
    v_fmac_f32 v236, v29, v117
    v_fmac_f32 v244, v22, v166
    v_fmac_f32 v236, v30, v118
    v_fmac_f32 v244, v23, v167
    v_fmac_f32 v236, v31, v119
    ds_read_b64_tr_b16 v[0:1], v249 offset:0
    ds_read_b64_tr_b16 v[2:3], v249 offset:32
    ds_read_u16_d16_hi v16, v250 offset:0
    v_mul_f32 v243, v32, v152
    v_fma_f32 v241, v40, v168, -v241
    v_fmac_f32 v243, v33, v153
    v_fmac_f32 v241, v41, v169
    v_fmac_f32 v243, v34, v154
    v_fmac_f32 v241, v42, v170
    v_fmac_f32 v243, v35, v155
    v_fmac_f32 v241, v43, v171
    v_fmac_f32 v243, v36, v156
    v_fmac_f32 v241, v44, v172
    v_fmac_f32 v243, v37, v157
    v_fmac_f32 v241, v45, v173
    v_fmac_f32 v243, v38, v158
    v_fmac_f32 v241, v46, v174
    v_fmac_f32 v243, v39, v159
    v_fmac_f32 v241, v47, v175
    ds_read_b64_tr_b16 v[4:5], v249 offset:512
    ds_read_b64_tr_b16 v[6:7], v249 offset:544
    ds_read_u16_d16_hi v17, v250 offset:128
    v_fma_f32 v245, v48, v168, -v245
    v_fmac_f32 v237, v56, v120
    v_fmac_f32 v245, v49, v169
    v_fmac_f32 v237, v57, v121
    v_fmac_f32 v245, v50, v170
    v_fmac_f32 v237, v58, v122
    v_fmac_f32 v245, v51, v171
    v_fmac_f32 v237, v59, v123
    v_fmac_f32 v245, v52, v172
    v_fmac_f32 v237, v60, v124
    v_fmac_f32 v245, v53, v173
    v_fmac_f32 v237, v61, v125
    v_fmac_f32 v245, v54, v174
    v_fmac_f32 v237, v62, v126
    v_fmac_f32 v245, v55, v175
    v_fmac_f32 v237, v63, v127
    s_cmp_eq_u32 s56, 5
    s_cbranch_scc1 K2_U21
    s_cmp_eq_u32 s56, 6
    s_cbranch_scc1 K2_U3h1
    s_branch K2_DSP1
K2_PAD_SW:
    s_branch K2_HOP
K2_DSP0:
    s_cmp_eq_u32 s56, 4
    s_cbranch_scc1 K2_U20
    s_cmp_eq_u32 s56, 7
    s_cbranch_scc1 K2_U30
    s_cmp_gt_u32 s56, 7
    s_cbranch_scc1 K2_U40
    s_cmp_lg_u32 s56, 0
    s_cbranch_scc1 K2_U10
    s_branch K2_SWITCH
K2_DSP1:
    s_cmp_eq_u32 s56, 4
    s_cbranch_scc1 K2_U21
    s_cmp_eq_u32 s56, 7
    s_cbranch_scc1 K2_U31
    s_cmp_gt_u32 s56, 7
    s_cbranch_scc1 K2_U41
    s_cmp_lg_u32 s56, 0
    s_cbranch_scc1 K2_U11
    s_branch K2_TAIL
K2_SWITCH:
    v_lshlrev_b32 v60, 3, v252
    s_mov_b32 s64, 7176192
    buffer_load_dwordx4 v[56:59], v60, s[8:11], s64 offen sc1
    v_permlane32_swap_b32 v242, v236
    v_permlane32_swap_b32 v243, v237
    v_permlane32_swap_b32 v244, v238
    v_permlane32_swap_b32 v245, v239
    v_permlane32_swap_b32 v240, v241
    v_add_f32 v242, v242, v236
    v_add_f32 v243, v243, v237
    v_add_f32 v244, v244, v238
    v_add_f32 v245, v245, v239
    v_add_f32 v240, -v240, -v241
    s_set_gpr_idx_on s32, gpr_idx(DST)
    s_nop 0
    v_cvt_pk_bf16_f32 v195, v242, v243
    v_cvt_pk_bf16_f32 v196, v244, v245
    v_cvt_pk_bf16_f32 v197, v240, v240
    s_set_gpr_idx_off
    v_lshl_add_u32 v230, v252, 1, s35
    v_lshrrev_b32 v231, 6, v252
    v_mul_u32_u24 v231, 126, v231
    v_lshrrev_b32 v254, 6, v252
    v_bfe_u32 v255, v252, 3, 2
    v_lshl_add_u32 v254, v254, 2, v255
    v_mul_u32_u24 v254, 640, v254
    v_bfe_u32 v255, v252, 5, 1
    v_lshl_add_u32 v254, v255, 5, v254
    v_and_b32 v255, 6, v252
    v_lshl_add_u32 v254, v255, 2, v254
    v_add_u32 v254, 152832, v254
    ds_read_b64_tr_b16 v[104:105], v254 offset:0
    ds_read_b64_tr_b16 v[106:107], v254 offset:5120
    ds_read_b64_tr_b16 v[108:109], v254 offset:64
    ds_read_b64_tr_b16 v[110:111], v254 offset:5184
    ds_read_b64_tr_b16 v[120:121], v254 offset:128
    ds_read_b64_tr_b16 v[122:123], v254 offset:5248
    ds_read_b64_tr_b16 v[124:125], v254 offset:192
    ds_read_b64_tr_b16 v[126:127], v254 offset:5312
    ds_read_b64_tr_b16 v[136:137], v254 offset:256
    ds_read_b64_tr_b16 v[138:139], v254 offset:5376
    ds_read_b64_tr_b16 v[140:141], v254 offset:320
    ds_read_b64_tr_b16 v[142:143], v254 offset:5440
    ds_read_b64_tr_b16 v[152:153], v254 offset:384
    ds_read_b64_tr_b16 v[154:155], v254 offset:5504
    ds_read_b64_tr_b16 v[156:157], v254 offset:448
    ds_read_b64_tr_b16 v[158:159], v254 offset:5568
    ds_read_b64_tr_b16 v[168:169], v254 offset:512
    ds_read_b64_tr_b16 v[170:171], v254 offset:5632
    ds_read_b64_tr_b16 v[172:173], v254 offset:576
    ds_read_b64_tr_b16 v[174:175], v254 offset:5696
    s_movk_i32 s40, 128
    s_movk_i32 s41, 384
    s_movk_i32 s42, 640
    s_movk_i32 s43, 896
    s_waitcnt lgkmcnt(15)
    v_lshlrev_b32 v96, 16, v104
    v_and_b32 v97, 0xffff0000, v104
    v_lshlrev_b32 v98, 16, v105
    v_and_b32 v99, 0xffff0000, v105
    v_lshlrev_b32 v100, 16, v106
    v_and_b32 v101, 0xffff0000, v106
    v_lshlrev_b32 v102, 16, v107
    v_and_b32 v103, 0xffff0000, v107
    v_lshlrev_b32 v104, 16, v108
    v_and_b32 v105, 0xffff0000, v108
    v_lshlrev_b32 v106, 16, v109
    v_and_b32 v107, 0xffff0000, v109
    v_lshlrev_b32 v108, 16, v110
    v_and_b32 v109, 0xffff0000, v110
    v_lshlrev_b32 v110, 16, v111
    v_and_b32 v111, 0xffff0000, v111
    s_waitcnt lgkmcnt(12)
    v_lshlrev_b32 v112, 16, v120
    v_and_b32 v113, 0xffff0000, v120
    v_lshlrev_b32 v114, 16, v121
    v_and_b32 v115, 0xffff0000, v121
    v_lshlrev_b32 v116, 16, v122
    v_and_b32 v117, 0xffff0000, v122
    v_lshlrev_b32 v118, 16, v123
    v_and_b32 v119, 0xffff0000, v123
    v_lshlrev_b32 v120, 16, v124
    v_and_b32 v121, 0xffff0000, v124
    v_lshlrev_b32 v122, 16, v125
    v_and_b32 v123, 0xffff0000, v125
    v_lshlrev_b32 v124, 16, v126
    v_and_b32 v125, 0xffff0000, v126
    v_lshlrev_b32 v126, 16, v127
    v_and_b32 v127, 0xffff0000, v127
    s_waitcnt lgkmcnt(8)
    v_lshlrev_b32 v128, 16, v136
    v_and_b32 v129, 0xffff0000, v136
    v_lshlrev_b32 v130, 16, v137
    v_and_b32 v131, 0xffff0000, v137
    v_lshlrev_b32 v132, 16, v138
    v_and_b32 v133, 0xffff0000, v138
    v_lshlrev_b32 v134, 16, v139
    v_and_b32 v135, 0xffff0000, v139
    v_lshlrev_b32 v136, 16, v140
    v_and_b32 v137, 0xffff0000, v140
    v_lshlrev_b32 v138, 16, v141
    v_and_b32 v139, 0xffff0000, v141
    v_lshlrev_b32 v140, 16, v142
    v_and_b32 v141, 0xffff0000, v142
    v_lshlrev_b32 v142, 16, v143
    v_and_b32 v143, 0xffff0000, v143
    s_waitcnt lgkmcnt(4)
    v_lshlrev_b32 v144, 16, v152
    v_and_b32 v145, 0xffff0000, v152
    v_lshlrev_b32 v146, 16, v153
    v_and_b32 v147, 0xffff0000, v153
    v_lshlrev_b32 v148, 16, v154
    v_and_b32 v149, 0xffff0000, v154
    v_lshlrev_b32 v150, 16, v155
    v_and_b32 v151, 0xffff0000, v155
    v_lshlrev_b32 v152, 16, v156
    v_and_b32 v153, 0xffff0000, v156
    v_lshlrev_b32 v154, 16, v157
    v_and_b32 v155, 0xffff0000, v157
    v_lshlrev_b32 v156, 16, v158
    v_and_b32 v157, 0xffff0000, v158
    v_lshlrev_b32 v158, 16, v159
    v_and_b32 v159, 0xffff0000, v159
    s_waitcnt lgkmcnt(0)
    v_lshlrev_b32 v160, 16, v168
    v_and_b32 v161, 0xffff0000, v168
    v_lshlrev_b32 v162, 16, v169
    v_and_b32 v163, 0xffff0000, v169
    v_lshlrev_b32 v164, 16, v170
    v_and_b32 v165, 0xffff0000, v170
    v_lshlrev_b32 v166, 16, v171
    v_and_b32 v167, 0xffff0000, v171
    v_lshlrev_b32 v168, 16, v172
    v_and_b32 v169, 0xffff0000, v172
    v_lshlrev_b32 v170, 16, v173
    v_and_b32 v171, 0xffff0000, v173
    v_lshlrev_b32 v172, 16, v174
    v_and_b32 v173, 0xffff0000, v174
    v_lshlrev_b32 v174, 16, v175
    v_and_b32 v175, 0xffff0000, v175
K2_FLGW:
    s_or_b32 s58, s54, s20
    s_waitcnt vmcnt(0)
    v_xor_b32 v56, s2, v56
    v_xor_b32 v57, s2, v57
    v_xor_b32 v58, s2, v58
    v_xor_b32 v59, s2, v59
    v_or3_b32 v56, v56, v57, v58
    v_or_b32 v56, v56, v59
    v_cmp_ne_u32 vcc, 0, v56
    s_nop 0
    s_cbranch_vccnz K2_FLGR
    s_cmp_eq_u32 s58, 0
    s_cbranch_scc1 K2_FLGY
K2_FLGOK:
    s_cmp_eq_u32 s36, 0
    s_cbranch_scc1 K2_TAIL2
    s_mov_b32 s29, s48
    s_mov_b32 s32, s31
    s_mov_b32 s30, s3
    s_mov_b32 s31, s35
    s_bfe_u32 s56, s3, 0x40012
    s_cmp_eq_u32 s56, 5
    s_cbranch_scc1 K2_U21
    s_cmp_eq_u32 s56, 6
    s_cbranch_scc1 K2_U3h1
    s_branch K2_DSP1
K2_dum_4:
    v_mov_b32 v232, -1
    s_mov_b32 m0, 163312
    s_mov_b64 exec, 1
    buffer_load_dwordx4 v232, s[16:19], 0 offen lds
    buffer_load_dwordx4 v232, s[16:19], 0 offen lds
    s_mov_b64 exec, -1
    s_branch K2_back_6
K2_nul_10:
    s_mov_b32 s58, 63
    s_mov_b32 s36, 0
    s_branch K2_back_13
K2_spin_11:
    s_sub_u32 s27, s27, 1
    s_cbranch_scc1 K2_END
    v_lshl_add_u32 v233, v252, 1, s53
    ds_read_b32 v233, v233
    s_waitcnt lgkmcnt(0)
    s_branch K2_chk_12
K2_dyn_8:
    v_mov_b32 v254, 163296
    v_mov_b32 v255, 1
    v_lshl_add_u32 v233, v252, 1, s53
    s_mov_b64 exec, 1
    ds_add_rtn_u32 v232, v254, v255
    s_mov_b64 exec, -1
    ds_read_b32 v233, v233
    s_waitcnt lgkmcnt(0)
    v_readfirstlane_b32 s58, v232
    s_nop 0
    s_cmp_lt_u32 s58, s22
    s_cbranch_scc0 K2_nul_10
    s_and_b32 s59, s58, 7
    s_lshr_b32 s60, s58, 3
K2_chk_12:
    v_readlane_b32 s61, v233, s59
    s_nop 0
    s_cmp_gt_u32 s61, s60
    s_cbranch_scc0 K2_spin_11
K2_back_13:
    s_mov_b32 s34, 1
    s_branch K2_back_9
K2_dum_17:
    v_mov_b32 v232, -1
    s_mov_b32 m0, 163312
    s_mov_b64 exec, 1
    buffer_load_dwordx4 v232, s[16:19], 0 offen lds
    buffer_load_dwordx4 v232, s[16:19], 0 offen lds
    s_mov_b64 exec, -1
    s_branch K2_back_19
K2_nul_23:
    s_mov_b32 s58, 63
    s_mov_b32 s36, 0
    s_branch K2_back_26
K2_spin_24:
    s_sub_u32 s27, s27, 1
    s_cbranch_scc1 K2_END
    v_lshl_add_u32 v233, v252, 1, s53
    ds_read_b32 v233, v233
    s_waitcnt lgkmcnt(0)
    s_branch K2_chk_25
K2_dyn_21:
    v_mov_b32 v254, 163296
    v_mov_b32 v255, 1
    v_lshl_add_u32 v233, v252, 1, s53
    s_mov_b64 exec, 1
    ds_add_rtn_u32 v232, v254, v255
    s_mov_b64 exec, -1
    ds_read_b32 v233, v233
    s_waitcnt lgkmcnt(0)
    v_readfirstlane_b32 s58, v232
    s_nop 0
    s_cmp_lt_u32 s58, s22
    s_cbranch_scc0 K2_nul_23
    s_and_b32 s59, s58, 7
    s_lshr_b32 s60, s58, 3
K2_chk_25:
    v_readlane_b32 s61, v233, s59
    s_nop 0
    s_cmp_gt_u32 s61, s60
    s_cbranch_scc0 K2_spin_24
K2_back_26:
    s_mov_b32 s34, 1
    s_branch K2_back_22
K2_dum_30:
    v_mov_b32 v232, -1
    s_mov_b32 m0, 163312
    s_mov_b64 exec, 1
    buffer_load_dwordx4 v232, s[16:19], 0 offen lds
    buffer_load_dwordx4 v232, s[16:19], 0 offen lds
    s_mov_b64 exec, -1
    s_branch K2_back_32
K2_nul_36:
    s_mov_b32 s58, 63
    s_mov_b32 s36, 0
    s_branch K2_back_39
K2_spin_37:
    s_sub_u32 s27, s27, 1
    s_cbranch_scc1 K2_END
    v_lshl_add_u32 v233, v252, 1, s53
    ds_read_b32 v233, v233
    s_waitcnt lgkmcnt(0)
    s_branch K2_chk_38
K2_dyn_34:
    v_mov_b32 v254, 163296
    v_mov_b32 v255, 1
    v_lshl_add_u32 v233, v252, 1, s53
    s_mov_b64 exec, 1
    ds_add_rtn_u32 v232, v254, v255
    s_mov_b64 exec, -1
    ds_read_b32 v233, v233
    s_waitcnt lgkmcnt(0)
    v_readfirstlane_b32 s58, v232
    s_nop 0
    s_cmp_lt_u32 s58, s22
    s_cbranch_scc0 K2_nul_36
    s_and_b32 s59, s58, 7
    s_lshr_b32 s60, s58, 3
K2_chk_38:
    v_readlane_b32 s61, v233, s59
    s_nop 0
    s_cmp_gt_u32 s61, s60
    s_cbranch_scc0 K2_spin_37
K2_back_39:
    s_mov_b32 s34, 1
    s_branch K2_back_35
K2_dum_43:
    v_mov_b32 v232, -1
    s_mov_b32 m0, 163312
    s_mov_b64 exec, 1
    buffer_load_dwordx4 v232, s[16:19], 0 offen lds
    buffer_load_dwordx4 v232, s[16:19], 0 offen lds
    s_mov_b64 exec, -1
    s_branch K2_back_45
K2_nul_47:
    s_mov_b32 s58, 63
    s_mov_b32 s36, 0
    s_branch K2_back_50
K2_spin_48:
    s_sub_u32 s27, s27, 1
    s_cbranch_scc1 K2_END
    v_lshl_add_u32 v233, v252, 1, s53
    ds_read_b32 v233, v233
    s_waitcnt lgkmcnt(0)
    s_branch K2_chk_49
K2_nul_54:
    s_mov_b32 s58, 63
    s_mov_b32 s36, 0
    s_branch K2_back_57
K2_spin_55:
    s_sub_u32 s27, s27, 1
    s_cbranch_scc1 K2_END
    v_lshl_add_u32 v233, v252, 1, s53
    ds_read_b32 v233, v233
    s_waitcnt lgkmcnt(0)
    s_branch K2_chk_56
K2_nul_61:
    s_mov_b32 s58, 63
    s_mov_b32 s36, 0
    s_branch K2_back_64
K2_spin_62:
    s_sub_u32 s27, s27, 1
    s_cbranch_scc1 K2_END
    v_lshl_add_u32 v233, v252, 1, s53
    ds_read_b32 v233, v233
    s_waitcnt lgkmcnt(0)
    s_branch K2_chk_63
K2_PAD_TL:
    s_branch K2_HOP
K2_TAIL2:
    v_lshlrev_b32 v229, 3, v252
    s_mul_i32 s58, s20, 20480
    s_add_u32 s58, s58, 6946816
    s_mul_i32 s59, s20, 8224
    buffer_load_dwordx4 v[96:99], v229, s[8:11], s58 offen offset:0 sc1
    buffer_load_dwordx4 v[100:103], v229, s[8:11], s58 offen offset:1024 sc1
    buffer_load_dwordx4 v[104:107], v229, s[8:11], s58 offen offset:2048 sc1
    buffer_load_dwordx4 v[108:111], v229, s[8:11], s58 offen offset:3072 sc1
    s_add_u32 s58, s58, 4096
    buffer_load_dwordx4 v[128:131], v229, s[8:11], s58 offen offset:0 sc1
    buffer_load_dwordx4 v[132:135], v229, s[8:11], s58 offen offset:1024 sc1
    buffer_load_dwordx4 v[136:139], v229, s[8:11], s58 offen offset:2048 sc1
    buffer_load_dwordx4 v[140:143], v229, s[8:11], s58 offen offset:3072 sc1
    v_lshl_add_u32 v228, v252, 1, s59
    v_lshrrev_b32 v226, 6, v252
    v_mul_u32_u24 v226, 126, v226
    v_sub_u32 v226, v228, v226
    s_branch K2_TAIL3
K2_TAIL:
    v_lshlrev_b32 v229, 3, v252
    s_mul_i32 s58, s20, 20480
    s_add_u32 s58, s58, 6946816
    s_mul_i32 s59, s20, 8224
    buffer_load_dwordx4 v[96:99], v229, s[8:11], s58 offen offset:0 sc1
    v_permlane32_swap_b32 v242, v236
    v_permlane32_swap_b32 v243, v237
    v_permlane32_swap_b32 v244, v238
    buffer_load_dwordx4 v[100:103], v229, s[8:11], s58 offen offset:1024 sc1
    v_permlane32_swap_b32 v245, v239
    v_permlane32_swap_b32 v240, v241
    v_add_f32 v242, v242, v236
    buffer_load_dwordx4 v[104:107], v229, s[8:11], s58 offen offset:2048 sc1
    v_add_f32 v243, v243, v237
    v_add_f32 v244, v244, v238
    v_add_f32 v245, v245, v239
    buffer_load_dwordx4 v[108:111], v229, s[8:11], s58 offen offset:3072 sc1
    v_add_f32 v240, -v240, -v241
    v_sub_u32 v241, v230, v231
    v_cvt_pk_bf16_f32 v242, v242, v243
    s_add_u32 s58, s58, 4096
    buffer_load_dwordx4 v[128:131], v229, s[8:11], s58 offen offset:0 sc1
    v_cvt_pk_bf16_f32 v244, v244, v245
    v_cvt_pk_bf16_f32 v240, v240, v240
    ds_write_b32 v230, v242 offset:768
    buffer_load_dwordx4 v[132:135], v229, s[8:11], s58 offen offset:1024 sc1
    ds_write_b32 v230, v244 offset:1024
    ds_write_b16 v241, v240 offset:1280
    v_lshl_add_u32 v228, v252, 1, s59
    buffer_load_dwordx4 v[136:139], v229, s[8:11], s58 offen offset:2048 sc1
    v_lshrrev_b32 v226, 6, v252
    v_mul_u32_u24 v226, 126, v226
    v_sub_u32 v226, v228, v226
    buffer_load_dwordx4 v[140:143], v229, s[8:11], s58 offen offset:3072 sc1
K2_TAIL3:
    s_waitcnt vmcnt(8)
    ds_write2st64_b32 v228, v192, v193 offset0:0 offset1:1
    ds_write2st64_b32 v228, v194, v195 offset0:2 offset1:3
    s_add_u32 s58, s58, 4096
    buffer_load_dwordx4 v[112:115], v229, s[8:11], s58 offen offset:0 sc1
    v_bfe_u32 v48, v252, 1, 4
    v_lshrrev_b32 v49, 5, v252
    ds_write_b16 v226, v197 offset:1280
    ds_write2st64_b32 v228, v196, v198 offset0:4 offset1:6
    buffer_load_dwordx4 v[116:119], v229, s[8:11], s58 offen offset:1024 sc1
    v_lshrrev_b32 v55, 3, v48
    v_lshlrev_b32 v52, 4, v49
    ds_write2st64_b32 v228, v199, v200 offset0:7 offset1:8
    ds_write2st64_b32 v228, v201, v202 offset0:9 offset1:10
    buffer_load_dwordx4 v[120:123], v229, s[8:11], s58 offen offset:2048 sc1
    v_lshl_add_u32 v54, v55, 2, v48
    v_and_b32 v54, 7, v54
    ds_write_b16 v226, v203 offset:2816
    ds_write2st64_b32 v228, v204, v205 offset0:12 offset1:13
    buffer_load_dwordx4 v[124:127], v229, s[8:11], s58 offen offset:3072 sc1
    v_and_b32 v50, 7, v48
    v_mul_u32_u24 v50, 8224, v50
    ds_write2st64_b32 v228, v206, v207 offset0:14 offset1:15
    ds_write2st64_b32 v228, v208, v210 offset0:16 offset1:18
    s_add_u32 s58, s58, 4096
    buffer_load_dwordx4 v[144:147], v229, s[8:11], s58 offen offset:0 sc1
    v_mul_u32_u24 v51, 1536, v55
    v_add_u32 v50, v50, v51
    ds_write_b16 v226, v209 offset:4352
    ds_write2st64_b32 v228, v211, v212 offset0:19 offset1:20
    buffer_load_dwordx4 v[148:151], v229, s[8:11], s58 offen offset:1024 sc1
    v_add_u32 v222, v50, v52
    v_mul_u32_u24 v51, 8224, v54
    ds_write2st64_b32 v228, v213, v214 offset0:21 offset1:22
    ds_write2st64_b32 v228, v216, v217 offset0:24 offset1:25
    buffer_load_dwordx4 v[152:155], v229, s[8:11], s58 offen offset:2048 sc1
    v_add_u32 v232, v51, v52
    v_lshl_add_u32 v247, v55, 7, v232
    ds_write_b16 v226, v215 offset:5888
    ds_write2st64_b32 v228, v218, v219 offset0:26 offset1:27
    buffer_load_dwordx4 v[156:159], v229, s[8:11], s58 offen offset:3072 sc1
    v_mul_u32_u24 v51, 2080, v48
    s_mov_b32 s60, 65536
    ds_write_b32 v228, v220 offset:7168
    ds_write_b16 v226, v221 offset:7424
    s_add_u32 s58, s58, 4096
    buffer_load_dwordx4 v[160:163], v229, s[8:11], s58 offen offset:0 sc1
    v_add3_u32 v223, v51, v52, s60
    v_mul_u32_u24 v51, 2080, v54
    buffer_load_dwordx4 v[164:167], v229, s[8:11], s58 offen offset:1024 sc1
    s_mov_b32 s60, 132096
    v_add3_u32 v225, v51, v52, s60
    buffer_load_dwordx4 v[168:171], v229, s[8:11], s58 offen offset:2048 sc1
    v_lshl_add_u32 v248, v55, 7, v225
    s_lshl_b32 s60, s20, 5
    buffer_load_dwordx4 v[172:175], v229, s[8:11], s58 offen offset:3072 sc1
    v_lshl_add_u32 v49, v49, 3, s60
    s_mov_b32 s60, 65536
    v_add3_u32 v255, v51, v49, s60
    v_lshl_add_u32 v246, v55, 9, v255
    v_bfe_u32 v53, v48, 2, 1
    v_lshl_add_u32 v49, v53, 4, v49
    v_add_u32 v254, v50, v49
    s_and_b32 s64, s55, s28
    s_waitcnt lgkmcnt(0)
    s_barrier
    s_cmp_eq_u32 s64, 0
    s_cbranch_scc1 K2_MULTI
    s_setprio 3
    ds_read_b128 v[48:51], v222 offset:0
    ds_read_b128 v[52:55], v222 offset:64
    ds_read_b128 v[56:59], v222 offset:896
    ds_read_b128 v[60:63], v222 offset:960
    ds_read_b128 v[64:67], v223 offset:0
    ds_read_b128 v[68:71], v223 offset:64
    ds_read_b128 v[72:75], v223 offset:896
    ds_read_b128 v[76:79], v223 offset:960
    ds_read_b128 v[80:83], v222 offset:3072
    ds_read_b128 v[84:87], v222 offset:3136
    ds_read_b128 v[88:91], v222 offset:3968
    s_waitcnt vmcnt(19) lgkmcnt(9)
    v_mfma_f32_16x16x32_bf16 v[0:3], v[96:99], v[48:51], 0
    ds_read_b128 v[92:95], v222 offset:4032
    s_waitcnt vmcnt(18)
    v_mfma_f32_16x16x32_bf16 v[0:3], v[100:103], v[52:55], v[0:3]
    ds_read_b128 v[48:51], v223 offset:33280
    s_waitcnt vmcnt(17) lgkmcnt(9)
    v_mfma_f32_16x16x32_bf16 v[0:3], v[104:107], v[56:59], v[0:3]
    s_bfe_u32 s60, s20, 0x10002
    s_lshl_b32 s60, s60, 4
    ds_read_b128 v[52:55], v223 offset:33344
    s_waitcnt vmcnt(16)
    v_mfma_f32_16x16x32_bf16 v[0:3], v[108:111], v[60:63], v[0:3]
    s_add_u32 s59, s59, s60
    v_add_u32 v228, s59, v229
    ds_read_b128 v[56:59], v223 offset:34176
    s_waitcnt vmcnt(15) lgkmcnt(9)
    v_mfma_f32_16x16x32_bf16 v[0:3], v[128:131], v[64:67], v[0:3]
    s_mul_i32 s60, s20, 2080
    s_add_u32 s60, s60, 65536
    ds_read_b128 v[60:63], v223 offset:34240
    s_waitcnt vmcnt(14)
    v_mfma_f32_16x16x32_bf16 v[0:3], v[132:135], v[68:71], v[0:3]
    v_add_u32 v249, s60, v229
    s_mov_b32 s63, 0xbfb8aa3b
    ds_read_b128 v[64:67], v232 offset:6144
    s_waitcnt vmcnt(13) lgkmcnt(9)
    v_mfma_f32_16x16x32_bf16 v[0:3], v[136:139], v[72:75], v[0:3]
    s_add_u32 s40, s20, s21
    s_lshl_b32 s40, s40, 10
    ds_read_b128 v[68:71], v232 offset:6208
    s_waitcnt vmcnt(12)
    v_mfma_f32_16x16x32_bf16 v[0:3], v[140:143], v[76:79], v[0:3]
    s_add_u32 s41, s40, 8192
    s_add_u32 s42, s40, 16384
    ds_read_b128 v[72:75], v232 offset:7040
    s_waitcnt lgkmcnt(9)
    v_mfma_f32_16x16x32_bf16 v[16:19], v[96:99], v[80:83], 0
    s_add_u32 s43, s40, 24576
    s_add_u32 s44, s40, 32768
    ds_read_b128 v[76:79], v232 offset:7104
    v_mfma_f32_16x16x32_bf16 v[16:19], v[100:103], v[84:87], v[16:19]
    ds_read_b128 v[80:83], v225 offset:0
    s_waitcnt lgkmcnt(9)
    v_mfma_f32_16x16x32_bf16 v[16:19], v[104:107], v[88:91], v[16:19]
    ds_read_b128 v[84:87], v225 offset:64
    v_mfma_f32_16x16x32_bf16 v[16:19], v[108:111], v[92:95], v[16:19]
    v_mul_f32 v204, s63, v0
    v_mul_f32 v205, s63, v1
    ds_read_b128 v[88:91], v225 offset:896
    s_waitcnt lgkmcnt(9)
    v_mfma_f32_16x16x32_bf16 v[16:19], v[128:131], v[48:51], v[16:19]
    v_mul_f32 v206, s63, v2
    ds_read_b128 v[92:95], v225 offset:960
    v_mfma_f32_16x16x32_bf16 v[16:19], v[132:135], v[52:55], v[16:19]
    v_mul_f32 v207, s63, v3
    ds_read_b128 v[48:51], v222 offset:128
    s_waitcnt lgkmcnt(9)
    v_mfma_f32_16x16x32_bf16 v[16:19], v[136:139], v[56:59], v[16:19]
    v_exp_f32 v204, v204
    ds_read_b128 v[52:55], v222 offset:384
    v_mfma_f32_16x16x32_bf16 v[16:19], v[140:143], v[60:63], v[16:19]
    v_exp_f32 v205, v205
    ds_read_b128 v[56:59], v222 offset:256
    s_waitcnt lgkmcnt(9)
    v_mfma_f32_16x16x32_bf16 v[32:35], v[96:99], v[64:67], 0
    v_exp_f32 v206, v206
    ds_read_b128 v[60:63], v222 offset:192
    v_mfma_f32_16x16x32_bf16 v[32:35], v[100:103], v[68:71], v[32:35]
    v_exp_f32 v207, v207
    s_setprio 2
    ds_read_b128 v[64:67], v222 offset:448
    s_waitcnt lgkmcnt(9)
    v_mfma_f32_16x16x32_bf16 v[32:35], v[104:107], v[72:75], v[32:35]
    v_add_f32 v204, 1.0, v204
    ds_read_b128 v[68:71], v222 offset:320
    v_mfma_f32_16x16x32_bf16 v[32:35], v[108:111], v[76:79], v[32:35]
    v_add_f32 v205, 1.0, v205
    v_add_f32 v206, 1.0, v206
    ds_read_b128 v[72:75], v222 offset:640
    s_waitcnt lgkmcnt(9)
    v_mfma_f32_16x16x32_bf16 v[32:35], v[128:131], v[80:83], v[32:35]
    v_add_f32 v207, 1.0, v207
    ds_read_b128 v[76:79], v222 offset:512
    v_mfma_f32_16x16x32_bf16 v[32:35], v[132:135], v[84:87], v[32:35]
    v_rcp_f32 v204, v204
    ds_read_b128 v[80:83], v222 offset:768
    s_waitcnt lgkmcnt(9)
    v_mfma_f32_16x16x32_bf16 v[32:35], v[136:139], v[88:91], v[32:35]
    v_rcp_f32 v205, v205
    ds_read_b128 v[84:87], v222 offset:704
    v_mfma_f32_16x16x32_bf16 v[32:35], v[140:143], v[92:95], v[32:35]
    v_rcp_f32 v206, v206
    ds_read_b128 v[88:91], v222 offset:576
    s_waitcnt vmcnt(11) lgkmcnt(9)
    v_mfma_f32_16x16x32_bf16 v[4:7], v[112:115], v[48:51], 0
    v_rcp_f32 v207, v207
    ds_read_b128 v[92:95], v222 offset:832
    v_mfma_f32_16x16x32_bf16 v[8:11], v[112:115], v[52:55], 0
    v_cvt_pk_bf16_f32 v176, v0, v1
    ds_read_b128 v[48:51], v222 offset:1024
    s_waitcnt lgkmcnt(9)
    v_mfma_f32_16x16x32_bf16 v[12:15], v[112:115], v[56:59], 0
    v_cvt_pk_bf16_f32 v177, v2, v3
    ds_read_b128 v[52:55], v222 offset:1280
    s_waitcnt vmcnt(10)
    v_mfma_f32_16x16x32_bf16 v[4:7], v[116:119], v[60:63], v[4:7]
    v_mul_f32 v208, s63, v16
    v_mul_f32 v209, s63, v17
    ds_read_b128 v[56:59], v222 offset:1152
    s_waitcnt lgkmcnt(9)
    v_mfma_f32_16x16x32_bf16 v[8:11], v[116:119], v[64:67], v[8:11]
    v_mul_f32 v210, s63, v18
    ds_read_b128 v[60:63], v222 offset:1088
    v_mfma_f32_16x16x32_bf16 v[12:15], v[116:119], v[68:71], v[12:15]
    v_mul_f32 v211, s63, v19
    ds_read_b128 v[64:67], v222 offset:1344
    s_waitcnt vmcnt(9) lgkmcnt(9)
    v_mfma_f32_16x16x32_bf16 v[4:7], v[120:123], v[72:75], v[4:7]
    v_exp_f32 v208, v208
    ds_read_b128 v[68:71], v222 offset:1216
    v_mfma_f32_16x16x32_bf16 v[8:11], v[120:123], v[76:79], v[8:11]
    v_exp_f32 v209, v209
    ds_read_b128 v[72:75], v223 offset:128
    s_waitcnt lgkmcnt(9)
    v_mfma_f32_16x16x32_bf16 v[12:15], v[120:123], v[80:83], v[12:15]
    v_exp_f32 v210, v210
    ds_read_b128 v[76:79], v223 offset:384
    s_waitcnt vmcnt(8)
    v_mfma_f32_16x16x32_bf16 v[4:7], v[124:127], v[84:87], v[4:7]
    v_exp_f32 v211, v211
    ds_read_b128 v[80:83], v223 offset:256
    s_waitcnt lgkmcnt(9)
    v_mfma_f32_16x16x32_bf16 v[8:11], v[124:127], v[88:91], v[8:11]
    v_add_f32 v208, 1.0, v208
    ds_read_b128 v[84:87], v223 offset:192
    v_mfma_f32_16x16x32_bf16 v[12:15], v[124:127], v[92:95], v[12:15]
    v_add_f32 v209, 1.0, v209
    v_add_f32 v210, 1.0, v210
    ds_read_b128 v[88:91], v223 offset:448
    s_waitcnt vmcnt(7) lgkmcnt(9)
    v_mfma_f32_16x16x32_bf16 v[4:7], v[144:147], v[48:51], v[4:7]
    v_add_f32 v211, 1.0, v211
    s_setprio 1
    ds_read_b128 v[92:95], v223 offset:320
    v_mfma_f32_16x16x32_bf16 v[8:11], v[144:147], v[52:55], v[8:11]
    v_rcp_f32 v208, v208
    ds_read_b128 v[48:51], v223 offset:640
    s_waitcnt lgkmcnt(9)
    v_mfma_f32_16x16x32_bf16 v[12:15], v[144:147], v[56:59], v[12:15]
    v_rcp_f32 v209, v209
    ds_read_b128 v[52:55], v223 offset:512
    s_waitcnt vmcnt(6)
    v_mfma_f32_16x16x32_bf16 v[4:7], v[148:151], v[60:63], v[4:7]
    v_rcp_f32 v210, v210
    ds_read_b128 v[56:59], v223 offset:768
    s_waitcnt lgkmcnt(9)
    v_mfma_f32_16x16x32_bf16 v[8:11], v[148:151], v[64:67], v[8:11]
    v_rcp_f32 v211, v211
    ds_read_b128 v[60:63], v223 offset:704
    v_mfma_f32_16x16x32_bf16 v[12:15], v[148:151], v[68:71], v[12:15]
K2_PAD_T2:
    s_cbranch_execz K2_HOP
    v_cvt_pk_bf16_f32 v184, v16, v17
    ds_read_b128 v[64:67], v223 offset:576
    s_waitcnt vmcnt(5) lgkmcnt(9)
    v_mfma_f32_16x16x32_bf16 v[4:7], v[152:155], v[72:75], v[4:7]
    v_cvt_pk_bf16_f32 v185, v18, v19
    ds_read_b128 v[68:71], v223 offset:832
    v_mfma_f32_16x16x32_bf16 v[8:11], v[152:155], v[76:79], v[8:11]
    v_mul_f32 v212, s63, v32
    v_mul_f32 v213, s63, v33
    ds_read_b128 v[72:75], v223 offset:1024
    s_waitcnt lgkmcnt(9)
    v_mfma_f32_16x16x32_bf16 v[12:15], v[152:155], v[80:83], v[12:15]
    v_mul_f32 v214, s63, v34
    ds_read_b128 v[76:79], v223 offset:1280
    s_waitcnt vmcnt(4)
    v_mfma_f32_16x16x32_bf16 v[4:7], v[156:159], v[84:87], v[4:7]
    v_mul_f32 v215, s63, v35
    ds_read_b128 v[80:83], v223 offset:1152
    s_waitcnt lgkmcnt(9)
    v_mfma_f32_16x16x32_bf16 v[8:11], v[156:159], v[88:91], v[8:11]
    v_exp_f32 v212, v212
    ds_read_b128 v[84:87], v223 offset:1088
    v_mfma_f32_16x16x32_bf16 v[12:15], v[156:159], v[92:95], v[12:15]
    v_exp_f32 v213, v213
    ds_read_b128 v[88:91], v223 offset:1344
    s_waitcnt vmcnt(3) lgkmcnt(9)
    v_mfma_f32_16x16x32_bf16 v[4:7], v[160:163], v[48:51], v[4:7]
    v_exp_f32 v214, v214
    ds_read_b128 v[92:95], v223 offset:1216
    v_mfma_f32_16x16x32_bf16 v[8:11], v[160:163], v[52:55], v[8:11]
    v_exp_f32 v215, v215
    ds_read_b128 v[48:51], v222 offset:3200
    s_waitcnt lgkmcnt(9)
    v_mfma_f32_16x16x32_bf16 v[12:15], v[160:163], v[56:59], v[12:15]
    v_add_f32 v212, 1.0, v212
    ds_read_b128 v[52:55], v222 offset:3456
    s_waitcnt vmcnt(2)
    v_mfma_f32_16x16x32_bf16 v[4:7], v[164:167], v[60:63], v[4:7]
    v_add_f32 v213, 1.0, v213
    v_add_f32 v214, 1.0, v214
    ds_read_b128 v[56:59], v222 offset:3328
    s_waitcnt lgkmcnt(9)
    v_mfma_f32_16x16x32_bf16 v[8:11], v[164:167], v[64:67], v[8:11]
    v_add_f32 v215, 1.0, v215
    ds_read_b128 v[60:63], v222 offset:3264
    v_mfma_f32_16x16x32_bf16 v[12:15], v[164:167], v[68:71], v[12:15]
    v_rcp_f32 v212, v212
    s_setprio 0
    ds_read_b128 v[64:67], v222 offset:3520
    s_waitcnt vmcnt(1) lgkmcnt(9)
    v_mfma_f32_16x16x32_bf16 v[4:7], v[168:171], v[72:75], v[4:7]
    v_rcp_f32 v213, v213
    ds_read_b128 v[68:71], v222 offset:3392
    v_mfma_f32_16x16x32_bf16 v[8:11], v[168:171], v[76:79], v[8:11]
    v_rcp_f32 v214, v214
    ds_read_b128 v[72:75], v222 offset:3712
    s_waitcnt lgkmcnt(9)
    v_mfma_f32_16x16x32_bf16 v[12:15], v[168:171], v[80:83], v[12:15]
    v_rcp_f32 v215, v215
    ds_read_b128 v[76:79], v222 offset:3584
    s_waitcnt vmcnt(0)
    v_mfma_f32_16x16x32_bf16 v[4:7], v[172:175], v[84:87], v[4:7]
    v_cvt_pk_bf16_f32 v220, v32, v33
    ds_read_b128 v[80:83], v222 offset:3840
    s_waitcnt lgkmcnt(9)
    v_mfma_f32_16x16x32_bf16 v[8:11], v[172:175], v[88:91], v[8:11]
    v_cvt_pk_bf16_f32 v221, v34, v35
    ds_read_b128 v[84:87], v222 offset:3776
    v_mfma_f32_16x16x32_bf16 v[12:15], v[172:175], v[92:95], v[12:15]
    ds_read_b128 v[88:91], v222 offset:3648
    s_waitcnt lgkmcnt(9)
    v_mfma_f32_16x16x32_bf16 v[20:23], v[112:115], v[48:51], 0
    ds_read_b128 v[92:95], v222 offset:3904
    v_mfma_f32_16x16x32_bf16 v[24:27], v[112:115], v[52:55], 0
    ds_read_b128 v[48:51], v222 offset:4096
    s_waitcnt lgkmcnt(9)
    v_mfma_f32_16x16x32_bf16 v[28:31], v[112:115], v[56:59], 0
    s_barrier
    s_setprio 3
    ds_read_b128 v[52:55], v222 offset:4352
    v_mfma_f32_16x16x32_bf16 v[20:23], v[116:119], v[60:63], v[20:23]
    v_mul_f32 v4, v4, v204
    ds_read_b128 v[56:59], v222 offset:4224
    s_waitcnt lgkmcnt(9)
    v_mfma_f32_16x16x32_bf16 v[24:27], v[116:119], v[64:67], v[24:27]
    v_mul_f32 v5, v5, v205
    ds_read_b128 v[60:63], v222 offset:4160
    v_mfma_f32_16x16x32_bf16 v[28:31], v[116:119], v[68:71], v[28:31]
    v_mul_f32 v6, v6, v206
    ds_read_b128 v[64:67], v222 offset:4416
    s_waitcnt lgkmcnt(9)
    v_mfma_f32_16x16x32_bf16 v[20:23], v[120:123], v[72:75], v[20:23]
    v_mul_f32 v7, v7, v207
    ds_read_b128 v[68:71], v222 offset:4288
    v_mfma_f32_16x16x32_bf16 v[24:27], v[120:123], v[76:79], v[24:27]
    v_cvt_pk_bf16_f32 v178, v4, v5
    ds_read_b128 v[72:75], v223 offset:33408
    s_waitcnt lgkmcnt(9)
    v_mfma_f32_16x16x32_bf16 v[28:31], v[120:123], v[80:83], v[28:31]
    v_cvt_pk_bf16_f32 v179, v6, v7
    ds_read_b128 v[76:79], v223 offset:33664
    v_mfma_f32_16x16x32_bf16 v[20:23], v[124:127], v[84:87], v[20:23]
    v_mul_f32 v8, v8, v204
    ds_read_b128 v[80:83], v223 offset:33536
    s_waitcnt lgkmcnt(9)
    v_mfma_f32_16x16x32_bf16 v[24:27], v[124:127], v[88:91], v[24:27]
    v_mul_f32 v9, v9, v205
    ds_read_b128 v[84:87], v223 offset:33472
    v_mfma_f32_16x16x32_bf16 v[28:31], v[124:127], v[92:95], v[28:31]
    v_mul_f32 v10, v10, v206
    ds_read_b128 v[88:91], v223 offset:33728
    s_waitcnt lgkmcnt(9)
    v_mfma_f32_16x16x32_bf16 v[20:23], v[144:147], v[48:51], v[20:23]
    v_mul_f32 v11, v11, v207
    s_setprio 2
    ds_read_b128 v[92:95], v223 offset:33600
    v_mfma_f32_16x16x32_bf16 v[24:27], v[144:147], v[52:55], v[24:27]
    v_cvt_pk_bf16_f32 v180, v8, v9
    ds_read_b128 v[48:51], v223 offset:33920
    s_waitcnt lgkmcnt(9)
    v_mfma_f32_16x16x32_bf16 v[28:31], v[144:147], v[56:59], v[28:31]
    v_cvt_pk_bf16_f32 v181, v10, v11
    ds_read_b128 v[52:55], v223 offset:33792
    v_mfma_f32_16x16x32_bf16 v[20:23], v[148:151], v[60:63], v[20:23]
    v_mul_f32 v12, v12, v204
    ds_read_b128 v[56:59], v223 offset:34048
    s_waitcnt lgkmcnt(9)
    v_mfma_f32_16x16x32_bf16 v[24:27], v[148:151], v[64:67], v[24:27]
    v_mul_f32 v13, v13, v205
    ds_read_b128 v[60:63], v223 offset:33984
    v_mfma_f32_16x16x32_bf16 v[28:31], v[148:151], v[68:71], v[28:31]
    v_mul_f32 v14, v14, v206
    ds_read_b128 v[64:67], v223 offset:33856
    s_waitcnt lgkmcnt(9)
    v_mfma_f32_16x16x32_bf16 v[20:23], v[152:155], v[72:75], v[20:23]
    v_mul_f32 v15, v15, v207
    ds_read_b128 v[68:71], v223 offset:34112
    v_mfma_f32_16x16x32_bf16 v[24:27], v[152:155], v[76:79], v[24:27]
    v_cvt_pk_bf16_f32 v182, v12, v13
    ds_read_b128 v[72:75], v223 offset:34304
    s_waitcnt lgkmcnt(9)
    v_mfma_f32_16x16x32_bf16 v[28:31], v[152:155], v[80:83], v[28:31]
    v_cvt_pk_bf16_f32 v183, v14, v15
    ds_read_b128 v[76:79], v223 offset:34560
    v_mfma_f32_16x16x32_bf16 v[20:23], v[156:159], v[84:87], v[20:23]
    ds_write_b64 v254, v[176:177] offset:0
    ds_write_b64 v254, v[178:179] offset:256
    ds_write_b64 v254, v[180:181] offset:512
    ds_write_b64 v254, v[182:183] offset:768
    ds_write_b64 v255, v[220:221] offset:0
    ds_read_b128 v[80:83], v223 offset:34432
    s_waitcnt lgkmcnt(14)
    v_mfma_f32_16x16x32_bf16 v[24:27], v[156:159], v[88:91], v[24:27]
    ds_read_b128 v[84:87], v223 offset:34368
    v_mfma_f32_16x16x32_bf16 v[28:31], v[156:159], v[92:95], v[28:31]
    s_setprio 1
    ds_read_b128 v[88:91], v223 offset:34624
    s_waitcnt lgkmcnt(14)
    v_mfma_f32_16x16x32_bf16 v[20:23], v[160:163], v[48:51], v[20:23]
    ds_read_b128 v[92:95], v223 offset:34496
    v_mfma_f32_16x16x32_bf16 v[24:27], v[160:163], v[52:55], v[24:27]
    ds_read_b128 v[48:51], v247 offset:6272
    s_waitcnt lgkmcnt(14)
    v_mfma_f32_16x16x32_bf16 v[28:31], v[160:163], v[56:59], v[28:31]
    ds_read_b128 v[52:55], v232 offset:6528
    v_mfma_f32_16x16x32_bf16 v[20:23], v[164:167], v[60:63], v[20:23]
    ds_read_b128 v[56:59], v247 offset:6336
    s_waitcnt lgkmcnt(14)
    v_mfma_f32_16x16x32_bf16 v[24:27], v[164:167], v[64:67], v[24:27]
    ds_read_b128 v[60:63], v232 offset:6592
    v_mfma_f32_16x16x32_bf16 v[28:31], v[164:167], v[68:71], v[28:31]
    ds_read_b128 v[64:67], v247 offset:6784
    s_waitcnt lgkmcnt(14)
    v_mfma_f32_16x16x32_bf16 v[20:23], v[168:171], v[72:75], v[20:23]
    ds_read_b128 v[68:71], v232 offset:6656
    v_mfma_f32_16x16x32_bf16 v[24:27], v[168:171], v[76:79], v[24:27]
    ds_read_b128 v[72:75], v247 offset:6848
    s_waitcnt lgkmcnt(9)
    v_mfma_f32_16x16x32_bf16 v[28:31], v[168:171], v[80:83], v[28:31]
    ds_read_b128 v[76:79], v232 offset:6720
    v_mfma_f32_16x16x32_bf16 v[20:23], v[172:175], v[84:87], v[20:23]
    s_setprio 0
    ds_read_b128 v[80:83], v247 offset:7168
    s_waitcnt lgkmcnt(9)
    v_mfma_f32_16x16x32_bf16 v[24:27], v[172:175], v[88:91], v[24:27]
    ds_read_b128 v[84:87], v232 offset:7424
    v_mfma_f32_16x16x32_bf16 v[28:31], v[172:175], v[92:95], v[28:31]
    ds_read_b128 v[88:91], v247 offset:7232
    s_waitcnt lgkmcnt(9)
    v_mfma_f32_16x16x32_bf16 v[36:39], v[112:115], v[48:51], 0
    ds_read_b128 v[92:95], v232 offset:7488
    v_mfma_f32_16x16x32_bf16 v[40:43], v[112:115], v[52:55], 0
    ds_read_b128 v[48:51], v248 offset:128
    s_waitcnt lgkmcnt(9)
    v_mfma_f32_16x16x32_bf16 v[36:39], v[116:119], v[56:59], v[36:39]
    s_barrier
    ds_read_b128 v[192:195], v228 offset:0
    ds_read_b128 v[196:199], v228 offset:1536
    s_setprio 3
    ds_read_b128 v[52:55], v225 offset:384
    v_mfma_f32_16x16x32_bf16 v[40:43], v[116:119], v[60:63], v[40:43]
    v_mul_f32 v20, v20, v208
    v_mul_f32 v21, v21, v209
    ds_read_b128 v[56:59], v248 offset:192
    s_waitcnt lgkmcnt(11)
    v_mfma_f32_16x16x32_bf16 v[36:39], v[120:123], v[64:67], v[36:39]
    v_mul_f32 v22, v22, v210
    ds_read_b128 v[60:63], v225 offset:448
    v_mfma_f32_16x16x32_bf16 v[40:43], v[120:123], v[68:71], v[40:43]
    v_mul_f32 v23, v23, v211
    ds_read_b128 v[64:67], v248 offset:640
    s_waitcnt lgkmcnt(11)
    v_mfma_f32_16x16x32_bf16 v[36:39], v[124:127], v[72:75], v[36:39]
    v_cvt_pk_bf16_f32 v186, v20, v21
    ds_read_b128 v[68:71], v225 offset:512
    v_mfma_f32_16x16x32_bf16 v[40:43], v[124:127], v[76:79], v[40:43]
    v_cvt_pk_bf16_f32 v187, v22, v23
    ds_read_b128 v[72:75], v248 offset:704
    s_waitcnt lgkmcnt(11)
    v_mfma_f32_16x16x32_bf16 v[36:39], v[144:147], v[80:83], v[36:39]
    v_mul_f32 v24, v24, v208
    v_mul_f32 v25, v25, v209
    s_waitcnt lgkmcnt(6)
    buffer_store_dwordx4 v[192:195], v229, s[12:15], s40 offen sc1
    buffer_store_dwordx4 v[196:199], v229, s[12:15], s41 offen sc1
    s_setprio 2
    ds_read_b128 v[76:79], v225 offset:576
    v_mfma_f32_16x16x32_bf16 v[40:43], v[144:147], v[84:87], v[40:43]
    v_mul_f32 v26, v26, v210
    ds_read_b128 v[80:83], v248 offset:1024
    v_mfma_f32_16x16x32_bf16 v[36:39], v[148:151], v[88:91], v[36:39]
    v_mul_f32 v27, v27, v211
    ds_read_b128 v[84:87], v225 offset:1280
    v_mfma_f32_16x16x32_bf16 v[40:43], v[148:151], v[92:95], v[40:43]
    v_cvt_pk_bf16_f32 v188, v24, v25
    ds_read_b128 v[88:91], v248 offset:1088
    s_waitcnt lgkmcnt(9)
    v_mfma_f32_16x16x32_bf16 v[36:39], v[152:155], v[48:51], v[36:39]
    v_cvt_pk_bf16_f32 v189, v26, v27
    ds_read_b128 v[92:95], v225 offset:1344
    v_mfma_f32_16x16x32_bf16 v[40:43], v[152:155], v[52:55], v[40:43]
    v_mul_f32 v28, v28, v208
    v_mul_f32 v29, v29, v209
    s_waitcnt lgkmcnt(8)
    v_mfma_f32_16x16x32_bf16 v[36:39], v[156:159], v[56:59], v[36:39]
    v_mul_f32 v30, v30, v210
    v_mfma_f32_16x16x32_bf16 v[40:43], v[156:159], v[60:63], v[40:43]
    v_mul_f32 v31, v31, v211
    s_setprio 1
    s_waitcnt lgkmcnt(6)
    v_mfma_f32_16x16x32_bf16 v[36:39], v[160:163], v[64:67], v[36:39]
    v_cvt_pk_bf16_f32 v190, v28, v29
    v_mfma_f32_16x16x32_bf16 v[40:43], v[160:163], v[68:71], v[40:43]
    v_cvt_pk_bf16_f32 v191, v30, v31
    s_waitcnt lgkmcnt(4)
    v_mfma_f32_16x16x32_bf16 v[36:39], v[164:167], v[72:75], v[36:39]
    ds_write_b64 v254, v[184:185] offset:3072
    ds_write_b64 v254, v[186:187] offset:3328
    ds_write_b64 v254, v[188:189] offset:3584
    ds_write_b64 v254, v[190:191] offset:3840
    v_mfma_f32_16x16x32_bf16 v[40:43], v[164:167], v[76:79], v[40:43]
    s_waitcnt lgkmcnt(6)
    v_mfma_f32_16x16x32_bf16 v[36:39], v[168:171], v[80:83], v[36:39]
    v_mfma_f32_16x16x32_bf16 v[40:43], v[168:171], v[84:87], v[40:43]
    s_setprio 0
    s_waitcnt lgkmcnt(4)
    v_mfma_f32_16x16x32_bf16 v[36:39], v[172:175], v[88:91], v[36:39]
    v_mfma_f32_16x16x32_bf16 v[40:43], v[172:175], v[92:95], v[40:43]
    s_nop 6
    v_mul_f32 v36, v36, v212
    v_mul_f32 v37, v37, v213
    v_mul_f32 v38, v38, v214
    v_mul_f32 v39, v39, v215
    v_cvt_pk_bf16_f32 v178, v36, v37
    v_cvt_pk_bf16_f32 v179, v38, v39
    v_mul_f32 v40, v40, v212
    v_mul_f32 v41, v41, v213
    v_mul_f32 v42, v42, v214
    v_mul_f32 v43, v43, v215
    v_cvt_pk_bf16_f32 v180, v40, v41
    v_cvt_pk_bf16_f32 v181, v42, v43
    ds_write_b64 v246, v[178:179] offset:256
    ds_write_b64 v255, v[180:181] offset:512
    s_waitcnt lgkmcnt(0)
    s_barrier
    ds_read_b128 v[192:195], v228 offset:3072
    ds_read_b128 v[196:199], v228 offset:4608
    ds_read_b128 v[200:203], v249
    s_waitcnt lgkmcnt(1)
    buffer_store_dwordx4 v[192:195], v229, s[12:15], s42 offen sc1
    buffer_store_dwordx4 v[196:199], v229, s[12:15], s43 offen sc1
K2_LASTROW:
    s_add_u32 s59, s20, 32
    s_cmp_ge_u32 s59, s22
    s_cbranch_scc1 K2_FIN
    s_waitcnt lgkmcnt(0)
    buffer_store_dwordx4 v[200:203], v229, s[12:15], s44 offen sc1
K2_FIN:
    s_endpgm
K2_MULTI:
    ds_read_b128 v[48:51], v222 offset:0
    ds_read_b128 v[52:55], v222 offset:64
    ds_read_b128 v[56:59], v222 offset:896
    ds_read_b128 v[60:63], v222 offset:960
    ds_read_b128 v[64:67], v223 offset:0
    ds_read_b128 v[68:71], v223 offset:64
    ds_read_b128 v[72:75], v223 offset:896
    ds_read_b128 v[76:79], v223 offset:960
    ds_read_b128 v[80:83], v222 offset:3072
    ds_read_b128 v[84:87], v222 offset:3136
    ds_read_b128 v[88:91], v222 offset:3968
    s_waitcnt vmcnt(19) lgkmcnt(9)
    v_mfma_f32_16x16x32_bf16 v[0:3], v[96:99], v[48:51], 0
    ds_read_b128 v[92:95], v222 offset:4032
    s_waitcnt vmcnt(18)
    v_mfma_f32_16x16x32_bf16 v[0:3], v[100:103], v[52:55], v[0:3]
    ds_read_b128 v[48:51], v223 offset:33280
    s_waitcnt vmcnt(17) lgkmcnt(9)
    v_mfma_f32_16x16x32_bf16 v[0:3], v[104:107], v[56:59], v[0:3]
    ds_read_b128 v[52:55], v223 offset:33344
    s_waitcnt vmcnt(16)
    v_mfma_f32_16x16x32_bf16 v[0:3], v[108:111], v[60:63], v[0:3]
    ds_read_b128 v[56:59], v223 offset:34176
    s_waitcnt vmcnt(15) lgkmcnt(9)
    v_mfma_f32_16x16x32_bf16 v[0:3], v[128:131], v[64:67], v[0:3]
    ds_read_b128 v[60:63], v223 offset:34240
    s_waitcnt vmcnt(14)
    v_mfma_f32_16x16x32_bf16 v[0:3], v[132:135], v[68:71], v[0:3]
    ds_read_b128 v[64:67], v232 offset:6144
    s_waitcnt vmcnt(13) lgkmcnt(9)
    v_mfma_f32_16x16x32_bf16 v[0:3], v[136:139], v[72:75], v[0:3]
    ds_read_b128 v[68:71], v232 offset:6208
    s_waitcnt vmcnt(12)
    v_mfma_f32_16x16x32_bf16 v[0:3], v[140:143], v[76:79], v[0:3]
    ds_read_b128 v[72:75], v232 offset:7040
    s_waitcnt lgkmcnt(9)
    v_mfma_f32_16x16x32_bf16 v[16:19], v[96:99], v[80:83], 0
    ds_read_b128 v[76:79], v232 offset:7104
    v_mfma_f32_16x16x32_bf16 v[16:19], v[100:103], v[84:87], v[16:19]
    ds_read_b128 v[80:83], v225 offset:0
    s_waitcnt lgkmcnt(9)
    v_mfma_f32_16x16x32_bf16 v[16:19], v[104:107], v[88:91], v[16:19]
    ds_read_b128 v[84:87], v225 offset:64
    v_mfma_f32_16x16x32_bf16 v[16:19], v[108:111], v[92:95], v[16:19]
    ds_read_b128 v[88:91], v225 offset:896
    s_waitcnt lgkmcnt(9)
    v_mfma_f32_16x16x32_bf16 v[16:19], v[128:131], v[48:51], v[16:19]
    ds_read_b128 v[92:95], v225 offset:960
    v_mfma_f32_16x16x32_bf16 v[16:19], v[132:135], v[52:55], v[16:19]
    ds_read_b128 v[48:51], v222 offset:128
    s_waitcnt lgkmcnt(9)
    v_mfma_f32_16x16x32_bf16 v[16:19], v[136:139], v[56:59], v[16:19]
    ds_read_b128 v[52:55], v222 offset:384
    v_mfma_f32_16x16x32_bf16 v[16:19], v[140:143], v[60:63], v[16:19]
    ds_read_b128 v[56:59], v222 offset:256
    s_waitcnt lgkmcnt(9)
    v_mfma_f32_16x16x32_bf16 v[32:35], v[96:99], v[64:67], 0
    ds_read_b128 v[60:63], v222 offset:192
    v_mfma_f32_16x16x32_bf16 v[32:35], v[100:103], v[68:71], v[32:35]
    ds_read_b128 v[64:67], v222 offset:448
    s_waitcnt lgkmcnt(9)
    v_mfma_f32_16x16x32_bf16 v[32:35], v[104:107], v[72:75], v[32:35]
    ds_read_b128 v[68:71], v222 offset:320
    v_mfma_f32_16x16x32_bf16 v[32:35], v[108:111], v[76:79], v[32:35]
    ds_read_b128 v[72:75], v222 offset:640
    s_waitcnt lgkmcnt(9)
    v_mfma_f32_16x16x32_bf16 v[32:35], v[128:131], v[80:83], v[32:35]
    ds_read_b128 v[76:79], v222 offset:512
    v_mfma_f32_16x16x32_bf16 v[32:35], v[132:135], v[84:87], v[32:35]
    ds_read_b128 v[80:83], v222 offset:768
    s_waitcnt lgkmcnt(9)
    v_mfma_f32_16x16x32_bf16 v[32:35], v[136:139], v[88:91], v[32:35]
    ds_read_b128 v[84:87], v222 offset:704
    v_mfma_f32_16x16x32_bf16 v[32:35], v[140:143], v[92:95], v[32:35]
    ds_read_b128 v[88:91], v222 offset:576
    s_waitcnt vmcnt(11) lgkmcnt(9)
    v_mfma_f32_16x16x32_bf16 v[4:7], v[112:115], v[48:51], 0
    ds_read_b128 v[92:95], v222 offset:832
    v_mfma_f32_16x16x32_bf16 v[8:11], v[112:115], v[52:55], 0
    ds_read_b128 v[48:51], v222 offset:1024
    s_waitcnt lgkmcnt(9)
    v_mfma_f32_16x16x32_bf16 v[12:15], v[112:115], v[56:59], 0
    ds_read_b128 v[52:55], v222 offset:1280
    s_waitcnt vmcnt(10)
    v_mfma_f32_16x16x32_bf16 v[4:7], v[116:119], v[60:63], v[4:7]
    ds_read_b128 v[56:59], v222 offset:1152
    s_waitcnt lgkmcnt(9)
    v_mfma_f32_16x16x32_bf16 v[8:11], v[116:119], v[64:67], v[8:11]
    ds_read_b128 v[60:63], v222 offset:1088
    v_mfma_f32_16x16x32_bf16 v[12:15], v[116:119], v[68:71], v[12:15]
    ds_read_b128 v[64:67], v222 offset:1344
    s_waitcnt vmcnt(9) lgkmcnt(9)
    v_mfma_f32_16x16x32_bf16 v[4:7], v[120:123], v[72:75], v[4:7]
    ds_read_b128 v[68:71], v222 offset:1216
    v_mfma_f32_16x16x32_bf16 v[8:11], v[120:123], v[76:79], v[8:11]
    ds_read_b128 v[72:75], v223 offset:128
    s_waitcnt lgkmcnt(9)
    v_mfma_f32_16x16x32_bf16 v[12:15], v[120:123], v[80:83], v[12:15]
    ds_read_b128 v[76:79], v223 offset:384
    s_waitcnt vmcnt(8)
    v_mfma_f32_16x16x32_bf16 v[4:7], v[124:127], v[84:87], v[4:7]
    ds_read_b128 v[80:83], v223 offset:256
    s_waitcnt lgkmcnt(9)
    v_mfma_f32_16x16x32_bf16 v[8:11], v[124:127], v[88:91], v[8:11]
    ds_read_b128 v[84:87], v223 offset:192
    v_mfma_f32_16x16x32_bf16 v[12:15], v[124:127], v[92:95], v[12:15]
    ds_read_b128 v[88:91], v223 offset:448
    s_waitcnt vmcnt(7) lgkmcnt(9)
    v_mfma_f32_16x16x32_bf16 v[4:7], v[144:147], v[48:51], v[4:7]
    ds_read_b128 v[92:95], v223 offset:320
    v_mfma_f32_16x16x32_bf16 v[8:11], v[144:147], v[52:55], v[8:11]
    ds_read_b128 v[48:51], v223 offset:640
    s_waitcnt lgkmcnt(9)
    v_mfma_f32_16x16x32_bf16 v[12:15], v[144:147], v[56:59], v[12:15]
    ds_read_b128 v[52:55], v223 offset:512
    s_waitcnt vmcnt(6)
    v_mfma_f32_16x16x32_bf16 v[4:7], v[148:151], v[60:63], v[4:7]
    ds_read_b128 v[56:59], v223 offset:768
    s_waitcnt lgkmcnt(9)
    v_mfma_f32_16x16x32_bf16 v[8:11], v[148:151], v[64:67], v[8:11]
    ds_read_b128 v[60:63], v223 offset:704
    v_mfma_f32_16x16x32_bf16 v[12:15], v[148:151], v[68:71], v[12:15]
    ds_read_b128 v[64:67], v223 offset:576
    s_waitcnt vmcnt(5) lgkmcnt(9)
    v_mfma_f32_16x16x32_bf16 v[4:7], v[152:155], v[72:75], v[4:7]
    ds_read_b128 v[68:71], v223 offset:832
    v_mfma_f32_16x16x32_bf16 v[8:11], v[152:155], v[76:79], v[8:11]
    ds_read_b128 v[72:75], v223 offset:1024
    s_waitcnt lgkmcnt(9)
    v_mfma_f32_16x16x32_bf16 v[12:15], v[152:155], v[80:83], v[12:15]
    ds_read_b128 v[76:79], v223 offset:1280
    s_waitcnt vmcnt(4)
    v_mfma_f32_16x16x32_bf16 v[4:7], v[156:159], v[84:87], v[4:7]
    ds_read_b128 v[80:83], v223 offset:1152
    s_waitcnt lgkmcnt(9)
    v_mfma_f32_16x16x32_bf16 v[8:11], v[156:159], v[88:91], v[8:11]
    ds_read_b128 v[84:87], v223 offset:1088
    v_mfma_f32_16x16x32_bf16 v[12:15], v[156:159], v[92:95], v[12:15]
    ds_read_b128 v[88:91], v223 offset:1344
    s_waitcnt vmcnt(3) lgkmcnt(9)
    v_mfma_f32_16x16x32_bf16 v[4:7], v[160:163], v[48:51], v[4:7]
    ds_read_b128 v[92:95], v223 offset:1216
    v_mfma_f32_16x16x32_bf16 v[8:11], v[160:163], v[52:55], v[8:11]
    ds_read_b128 v[48:51], v222 offset:3200
    s_waitcnt lgkmcnt(9)
    v_mfma_f32_16x16x32_bf16 v[12:15], v[160:163], v[56:59], v[12:15]
    ds_read_b128 v[52:55], v222 offset:3456
    s_waitcnt vmcnt(2)
    v_mfma_f32_16x16x32_bf16 v[4:7], v[164:167], v[60:63], v[4:7]
    ds_read_b128 v[56:59], v222 offset:3328
    s_waitcnt lgkmcnt(9)
    v_mfma_f32_16x16x32_bf16 v[8:11], v[164:167], v[64:67], v[8:11]
    ds_read_b128 v[60:63], v222 offset:3264
    v_mfma_f32_16x16x32_bf16 v[12:15], v[164:167], v[68:71], v[12:15]
    ds_read_b128 v[64:67], v222 offset:3520
    s_waitcnt vmcnt(1) lgkmcnt(9)
    v_mfma_f32_16x16x32_bf16 v[4:7], v[168:171], v[72:75], v[4:7]
    ds_read_b128 v[68:71], v222 offset:3392
    v_mfma_f32_16x16x32_bf16 v[8:11], v[168:171], v[76:79], v[8:11]
    ds_read_b128 v[72:75], v222 offset:3712
    s_waitcnt lgkmcnt(9)
    v_mfma_f32_16x16x32_bf16 v[12:15], v[168:171], v[80:83], v[12:15]
    ds_read_b128 v[76:79], v222 offset:3584
    s_waitcnt vmcnt(0)
    v_mfma_f32_16x16x32_bf16 v[4:7], v[172:175], v[84:87], v[4:7]
    ds_read_b128 v[80:83], v222 offset:3840
    s_waitcnt lgkmcnt(9)
    v_mfma_f32_16x16x32_bf16 v[8:11], v[172:175], v[88:91], v[8:11]
    ds_read_b128 v[84:87], v222 offset:3776
    v_mfma_f32_16x16x32_bf16 v[12:15], v[172:175], v[92:95], v[12:15]
    ds_read_b128 v[88:91], v222 offset:3648
    s_waitcnt lgkmcnt(9)
    v_mfma_f32_16x16x32_bf16 v[20:23], v[112:115], v[48:51], 0
    ds_read_b128 v[92:95], v222 offset:3904
    v_mfma_f32_16x16x32_bf16 v[24:27], v[112:115], v[52:55], 0
    ds_read_b128 v[48:51], v222 offset:4096
    s_waitcnt lgkmcnt(9)
    v_mfma_f32_16x16x32_bf16 v[28:31], v[112:115], v[56:59], 0
    ds_read_b128 v[52:55], v222 offset:4352
    v_mfma_f32_16x16x32_bf16 v[20:23], v[116:119], v[60:63], v[20:23]
    ds_read_b128 v[56:59], v222 offset:4224
    s_waitcnt lgkmcnt(9)
    v_mfma_f32_16x16x32_bf16 v[24:27], v[116:119], v[64:67], v[24:27]
    ds_read_b128 v[60:63], v222 offset:4160
    v_mfma_f32_16x16x32_bf16 v[28:31], v[116:119], v[68:71], v[28:31]
    ds_read_b128 v[64:67], v222 offset:4416
    s_waitcnt lgkmcnt(9)
    v_mfma_f32_16x16x32_bf16 v[20:23], v[120:123], v[72:75], v[20:23]
    ds_read_b128 v[68:71], v222 offset:4288
    v_mfma_f32_16x16x32_bf16 v[24:27], v[120:123], v[76:79], v[24:27]
    ds_read_b128 v[72:75], v223 offset:33408
    s_waitcnt lgkmcnt(9)
    v_mfma_f32_16x16x32_bf16 v[28:31], v[120:123], v[80:83], v[28:31]
    ds_read_b128 v[76:79], v223 offset:33664
    v_mfma_f32_16x16x32_bf16 v[20:23], v[124:127], v[84:87], v[20:23]
    ds_read_b128 v[80:83], v223 offset:33536
    s_waitcnt lgkmcnt(9)
    v_mfma_f32_16x16x32_bf16 v[24:27], v[124:127], v[88:91], v[24:27]
    ds_read_b128 v[84:87], v223 offset:33472
    v_mfma_f32_16x16x32_bf16 v[28:31], v[124:127], v[92:95], v[28:31]
    ds_read_b128 v[88:91], v223 offset:33728
    s_waitcnt lgkmcnt(9)
    v_mfma_f32_16x16x32_bf16 v[20:23], v[144:147], v[48:51], v[20:23]
    ds_read_b128 v[92:95], v223 offset:33600
    v_mfma_f32_16x16x32_bf16 v[24:27], v[144:147], v[52:55], v[24:27]
    ds_read_b128 v[48:51], v223 offset:33920
    s_waitcnt lgkmcnt(9)
    v_mfma_f32_16x16x32_bf16 v[28:31], v[144:147], v[56:59], v[28:31]
    ds_read_b128 v[52:55], v223 offset:33792
    v_mfma_f32_16x16x32_bf16 v[20:23], v[148:151], v[60:63], v[20:23]
    ds_read_b128 v[56:59], v223 offset:34048
    s_waitcnt lgkmcnt(9)
    v_mfma_f32_16x16x32_bf16 v[24:27], v[148:151], v[64:67], v[24:27]
    ds_read_b128 v[60:63], v223 offset:33984
    v_mfma_f32_16x16x32_bf16 v[28:31], v[148:151], v[68:71], v[28:31]
    ds_read_b128 v[64:67], v223 offset:33856
    s_waitcnt lgkmcnt(9)
    v_mfma_f32_16x16x32_bf16 v[20:23], v[152:155], v[72:75], v[20:23]
    ds_read_b128 v[68:71], v223 offset:34112
    v_mfma_f32_16x16x32_bf16 v[24:27], v[152:155], v[76:79], v[24:27]
    ds_read_b128 v[72:75], v223 offset:34304
    s_waitcnt lgkmcnt(9)
    v_mfma_f32_16x16x32_bf16 v[28:31], v[152:155], v[80:83], v[28:31]
    ds_read_b128 v[76:79], v223 offset:34560
    v_mfma_f32_16x16x32_bf16 v[20:23], v[156:159], v[84:87], v[20:23]
    ds_read_b128 v[80:83], v223 offset:34432
    s_waitcnt lgkmcnt(9)
    v_mfma_f32_16x16x32_bf16 v[24:27], v[156:159], v[88:91], v[24:27]
    ds_read_b128 v[84:87], v223 offset:34368
    v_mfma_f32_16x16x32_bf16 v[28:31], v[156:159], v[92:95], v[28:31]
    ds_read_b128 v[88:91], v223 offset:34624
    s_waitcnt lgkmcnt(9)
    v_mfma_f32_16x16x32_bf16 v[20:23], v[160:163], v[48:51], v[20:23]
    ds_read_b128 v[92:95], v223 offset:34496
    v_mfma_f32_16x16x32_bf16 v[24:27], v[160:163], v[52:55], v[24:27]
    ds_read_b128 v[48:51], v247 offset:6272
    s_waitcnt lgkmcnt(9)
    v_mfma_f32_16x16x32_bf16 v[28:31], v[160:163], v[56:59], v[28:31]
    ds_read_b128 v[52:55], v232 offset:6528
    v_mfma_f32_16x16x32_bf16 v[20:23], v[164:167], v[60:63], v[20:23]
    ds_read_b128 v[56:59], v247 offset:6336
    s_waitcnt lgkmcnt(9)
    v_mfma_f32_16x16x32_bf16 v[24:27], v[164:167], v[64:67], v[24:27]
    ds_read_b128 v[60:63], v232 offset:6592
    v_mfma_f32_16x16x32_bf16 v[28:31], v[164:167], v[68:71], v[28:31]
    ds_read_b128 v[64:67], v247 offset:6784
    s_waitcnt lgkmcnt(9)
    v_mfma_f32_16x16x32_bf16 v[20:23], v[168:171], v[72:75], v[20:23]
    ds_read_b128 v[68:71], v232 offset:6656
    v_mfma_f32_16x16x32_bf16 v[24:27], v[168:171], v[76:79], v[24:27]
    ds_read_b128 v[72:75], v247 offset:6848
    s_waitcnt lgkmcnt(9)
    v_mfma_f32_16x16x32_bf16 v[28:31], v[168:171], v[80:83], v[28:31]
    ds_read_b128 v[76:79], v232 offset:6720
    v_mfma_f32_16x16x32_bf16 v[20:23], v[172:175], v[84:87], v[20:23]
    ds_read_b128 v[80:83], v247 offset:7168
    s_waitcnt lgkmcnt(9)
    v_mfma_f32_16x16x32_bf16 v[24:27], v[172:175], v[88:91], v[24:27]
    ds_read_b128 v[84:87], v232 offset:7424
    v_mfma_f32_16x16x32_bf16 v[28:31], v[172:175], v[92:95], v[28:31]
    ds_read_b128 v[88:91], v247 offset:7232
    s_waitcnt lgkmcnt(9)
    v_mfma_f32_16x16x32_bf16 v[36:39], v[112:115], v[48:51], 0
    ds_read_b128 v[92:95], v232 offset:7488
    v_mfma_f32_16x16x32_bf16 v[40:43], v[112:115], v[52:55], 0
    ds_read_b128 v[48:51], v248 offset:128
    s_waitcnt lgkmcnt(9)
    v_mfma_f32_16x16x32_bf16 v[36:39], v[116:119], v[56:59], v[36:39]
    ds_read_b128 v[52:55], v225 offset:384
    v_mfma_f32_16x16x32_bf16 v[40:43], v[116:119], v[60:63], v[40:43]
    ds_read_b128 v[56:59], v248 offset:192
    s_waitcnt lgkmcnt(9)
    v_mfma_f32_16x16x32_bf16 v[36:39], v[120:123], v[64:67], v[36:39]
    ds_read_b128 v[60:63], v225 offset:448
    v_mfma_f32_16x16x32_bf16 v[40:43], v[120:123], v[68:71], v[40:43]
    ds_read_b128 v[64:67], v248 offset:640
    s_waitcnt lgkmcnt(9)
    v_mfma_f32_16x16x32_bf16 v[36:39], v[124:127], v[72:75], v[36:39]
    ds_read_b128 v[68:71], v225 offset:512
    v_mfma_f32_16x16x32_bf16 v[40:43], v[124:127], v[76:79], v[40:43]
    ds_read_b128 v[72:75], v248 offset:704
    s_waitcnt lgkmcnt(9)
    v_mfma_f32_16x16x32_bf16 v[36:39], v[144:147], v[80:83], v[36:39]
    ds_read_b128 v[76:79], v225 offset:576
    v_mfma_f32_16x16x32_bf16 v[40:43], v[144:147], v[84:87], v[40:43]
    ds_read_b128 v[80:83], v248 offset:1024
    s_waitcnt lgkmcnt(9)
    v_mfma_f32_16x16x32_bf16 v[36:39], v[148:151], v[88:91], v[36:39]
    ds_read_b128 v[84:87], v225 offset:1280
    v_mfma_f32_16x16x32_bf16 v[40:43], v[148:151], v[92:95], v[40:43]
    ds_read_b128 v[88:91], v248 offset:1088
    s_waitcnt lgkmcnt(9)
    v_mfma_f32_16x16x32_bf16 v[36:39], v[152:155], v[48:51], v[36:39]
    ds_read_b128 v[92:95], v225 offset:1344
    v_mfma_f32_16x16x32_bf16 v[40:43], v[152:155], v[52:55], v[40:43]
    s_waitcnt lgkmcnt(8)
    v_mfma_f32_16x16x32_bf16 v[36:39], v[156:159], v[56:59], v[36:39]
    v_mfma_f32_16x16x32_bf16 v[40:43], v[156:159], v[60:63], v[40:43]
    s_waitcnt lgkmcnt(6)
    v_mfma_f32_16x16x32_bf16 v[36:39], v[160:163], v[64:67], v[36:39]
    v_mfma_f32_16x16x32_bf16 v[40:43], v[160:163], v[68:71], v[40:43]
    s_waitcnt lgkmcnt(4)
    v_mfma_f32_16x16x32_bf16 v[36:39], v[164:167], v[72:75], v[36:39]
    v_mfma_f32_16x16x32_bf16 v[40:43], v[164:167], v[76:79], v[40:43]
    s_waitcnt lgkmcnt(2)
    v_mfma_f32_16x16x32_bf16 v[36:39], v[168:171], v[80:83], v[36:39]
    v_mfma_f32_16x16x32_bf16 v[40:43], v[168:171], v[84:87], v[40:43]
    s_waitcnt lgkmcnt(0)
    v_mfma_f32_16x16x32_bf16 v[36:39], v[172:175], v[88:91], v[36:39]
    v_mfma_f32_16x16x32_bf16 v[40:43], v[172:175], v[92:95], v[40:43]
    s_lshl_b32 s60, s54, 9
    s_lshl_b32 s61, s20, 6
    s_add_u32 s60, s60, s61
    s_mul_i32 s60, s60, 192
    s_add_u32 s60, s60, 10485760
    v_mul_u32_u24 v227, 96, v252
    s_cmp_lg_u32 s28, 0
    s_cbranch_scc1 K2_NOACC
    buffer_load_dwordx4 v[48:51], v227, s[8:11], s60 offen offset:0
    buffer_load_dwordx4 v[52:55], v227, s[8:11], s60 offen offset:16
    buffer_load_dwordx4 v[56:59], v227, s[8:11], s60 offen offset:32
    buffer_load_dwordx4 v[60:63], v227, s[8:11], s60 offen offset:48
    buffer_load_dwordx4 v[64:67], v227, s[8:11], s60 offen offset:64
    buffer_load_dwordx4 v[68:71], v227, s[8:11], s60 offen offset:80
    buffer_load_dwordx4 v[72:75], v227, s[8:11], s60 offen offset:96
    buffer_load_dwordx4 v[76:79], v227, s[8:11], s60 offen offset:112
    buffer_load_dwordx4 v[80:83], v227, s[8:11], s60 offen offset:128
    buffer_load_dwordx4 v[84:87], v227, s[8:11], s60 offen offset:144
    buffer_load_dwordx4 v[88:91], v227, s[8:11], s60 offen offset:160
    s_waitcnt vmcnt(0)
    v_add_f32 v0, v0, v48
    v_add_f32 v1, v1, v49
    v_add_f32 v2, v2, v50
    v_add_f32 v3, v3, v51
    v_add_f32 v4, v4, v52
    v_add_f32 v5, v5, v53
    v_add_f32 v6, v6, v54
    v_add_f32 v7, v7, v55
    v_add_f32 v8, v8, v56
    v_add_f32 v9, v9, v57
    v_add_f32 v10, v10, v58
    v_add_f32 v11, v11, v59
    v_add_f32 v12, v12, v60
    v_add_f32 v13, v13, v61
    v_add_f32 v14, v14, v62
    v_add_f32 v15, v15, v63
    v_add_f32 v16, v16, v64
    v_add_f32 v17, v17, v65
    v_add_f32 v18, v18, v66
    v_add_f32 v19, v19, v67
    v_add_f32 v20, v20, v68
    v_add_f32 v21, v21, v69
    v_add_f32 v22, v22, v70
    v_add_f32 v23, v23, v71
    v_add_f32 v24, v24, v72
    v_add_f32 v25, v25, v73
    v_add_f32 v26, v26, v74
    v_add_f32 v27, v27, v75
    v_add_f32 v28, v28, v76
    v_add_f32 v29, v29, v77
    v_add_f32 v30, v30, v78
    v_add_f32 v31, v31, v79
    v_add_f32 v32, v32, v80
    v_add_f32 v33, v33, v81
    v_add_f32 v34, v34, v82
    v_add_f32 v35, v35, v83
    v_add_f32 v36, v36, v84
    v_add_f32 v37, v37, v85
    v_add_f32 v38, v38, v86
    v_add_f32 v39, v39, v87
    v_add_f32 v40, v40, v88
    v_add_f32 v41, v41, v89
    v_add_f32 v42, v42, v90
    v_add_f32 v43, v43, v91
K2_NOACC:
    s_barrier
    s_cmp_eq_u32 s55, 0
    s_cbranch_scc1 K2_SPILL
    s_bfe_u32 s60, s20, 0x10002
    s_lshl_b32 s60, s60, 4
    s_add_u32 s59, s59, s60
    v_add_u32 v228, s59, v229
    s_mul_i32 s60, s20, 2080
    s_add_u32 s60, s60, 65536
    v_add_u32 v249, s60, v229
    s_mov_b32 s63, 0xbfb8aa3b
    s_add_u32 s40, s20, s21
    s_lshl_b32 s40, s40, 10
    s_add_u32 s41, s40, 8192
    s_add_u32 s42, s40, 16384
    s_add_u32 s43, s40, 24576
    s_add_u32 s44, s40, 32768
    v_mul_f32 v204, s63, v0
    v_mul_f32 v205, s63, v1
    v_mul_f32 v206, s63, v2
    v_mul_f32 v207, s63, v3
    v_exp_f32 v204, v204
    v_exp_f32 v205, v205
    v_exp_f32 v206, v206
    v_exp_f32 v207, v207
    v_add_f32 v204, 1.0, v204
    v_add_f32 v205, 1.0, v205
    v_add_f32 v206, 1.0, v206
    v_add_f32 v207, 1.0, v207
    v_rcp_f32 v204, v204
    v_rcp_f32 v205, v205
    v_rcp_f32 v206, v206
    v_rcp_f32 v207, v207
    v_cvt_pk_bf16_f32 v176, v0, v1
    v_cvt_pk_bf16_f32 v177, v2, v3
    v_mul_f32 v4, v4, v204
    v_mul_f32 v5, v5, v205
    v_mul_f32 v6, v6, v206
    v_mul_f32 v7, v7, v207
    v_cvt_pk_bf16_f32 v178, v4, v5
    v_cvt_pk_bf16_f32 v179, v6, v7
    v_mul_f32 v8, v8, v204
    v_mul_f32 v9, v9, v205
    v_mul_f32 v10, v10, v206
    v_mul_f32 v11, v11, v207
    v_cvt_pk_bf16_f32 v180, v8, v9
    v_cvt_pk_bf16_f32 v181, v10, v11
    v_mul_f32 v12, v12, v204
    v_mul_f32 v13, v13, v205
    v_mul_f32 v14, v14, v206
    v_mul_f32 v15, v15, v207
    v_cvt_pk_bf16_f32 v182, v12, v13
    v_cvt_pk_bf16_f32 v183, v14, v15
    ds_write_b64 v254, v[176:177] offset:0
    ds_write_b64 v254, v[178:179] offset:256
    ds_write_b64 v254, v[180:181] offset:512
    ds_write_b64 v254, v[182:183] offset:768
    s_waitcnt lgkmcnt(0)
    s_barrier
    ds_read_b128 v[192:195], v228 offset:0
    ds_read_b128 v[196:199], v228 offset:1536
    s_waitcnt lgkmcnt(0)
    buffer_store_dwordx4 v[192:195], v229, s[12:15], s40 offen sc1
    buffer_store_dwordx4 v[196:199], v229, s[12:15], s41 offen sc1
    v_mul_f32 v208, s63, v16
    v_mul_f32 v209, s63, v17
    v_mul_f32 v210, s63, v18
    v_mul_f32 v211, s63, v19
    v_exp_f32 v208, v208
    v_exp_f32 v209, v209
    v_exp_f32 v210, v210
    v_exp_f32 v211, v211
    v_add_f32 v208, 1.0, v208
    v_add_f32 v209, 1.0, v209
    v_add_f32 v210, 1.0, v210
    v_add_f32 v211, 1.0, v211
    v_rcp_f32 v208, v208
    v_rcp_f32 v209, v209
    v_rcp_f32 v210, v210
    v_rcp_f32 v211, v211
    v_cvt_pk_bf16_f32 v184, v16, v17
    v_cvt_pk_bf16_f32 v185, v18, v19
    v_mul_f32 v20, v20, v208
    v_mul_f32 v21, v21, v209
    v_mul_f32 v22, v22, v210
    v_mul_f32 v23, v23, v211
    v_cvt_pk_bf16_f32 v186, v20, v21
    v_cvt_pk_bf16_f32 v187, v22, v23
    v_mul_f32 v24, v24, v208
    v_mul_f32 v25, v25, v209
    v_mul_f32 v26, v26, v210
    v_mul_f32 v27, v27, v211
    v_cvt_pk_bf16_f32 v188, v24, v25
    v_cvt_pk_bf16_f32 v189, v26, v27
    v_mul_f32 v28, v28, v208
    v_mul_f32 v29, v29, v209
    v_mul_f32 v30, v30, v210
    v_mul_f32 v31, v31, v211
    v_cvt_pk_bf16_f32 v190, v28, v29
    v_cvt_pk_bf16_f32 v191, v30, v31
    ds_write_b64 v254, v[184:185] offset:3072
    ds_write_b64 v254, v[186:187] offset:3328
    ds_write_b64 v254, v[188:189] offset:3584
    ds_write_b64 v254, v[190:191] offset:3840
    s_waitcnt lgkmcnt(0)
    s_barrier
    ds_read_b128 v[192:195], v228 offset:3072
    ds_read_b128 v[196:199], v228 offset:4608
    s_waitcnt lgkmcnt(0)
    buffer_store_dwordx4 v[192:195], v229, s[12:15], s42 offen sc1
    buffer_store_dwordx4 v[196:199], v229, s[12:15], s43 offen sc1
    v_mul_f32 v212, s63, v32
    v_mul_f32 v213, s63, v33
    v_mul_f32 v214, s63, v34
    v_mul_f32 v215, s63, v35
    v_exp_f32 v212, v212
    v_exp_f32 v213, v213
    v_exp_f32 v214, v214
    v_exp_f32 v215, v215
    v_add_f32 v212, 1.0, v212
    v_add_f32 v213, 1.0, v213
    v_add_f32 v214, 1.0, v214
    v_add_f32 v215, 1.0, v215
    v_rcp_f32 v212, v212
    v_rcp_f32 v213, v213
    v_rcp_f32 v214, v214
    v_rcp_f32 v215, v215
    v_cvt_pk_bf16_f32 v220, v32, v33
    v_cvt_pk_bf16_f32 v221, v34, v35
    v_mul_f32 v36, v36, v212
    v_mul_f32 v37, v37, v213
    v_mul_f32 v38, v38, v214
    v_mul_f32 v39, v39, v215
    v_cvt_pk_bf16_f32 v178, v36, v37
    v_cvt_pk_bf16_f32 v179, v38, v39
    v_mul_f32 v40, v40, v212
    v_mul_f32 v41, v41, v213
    v_mul_f32 v42, v42, v214
    v_mul_f32 v43, v43, v215
    v_cvt_pk_bf16_f32 v180, v40, v41
    v_cvt_pk_bf16_f32 v181, v42, v43
    ds_write_b64 v255, v[220:221] offset:0
    ds_write_b64 v246, v[178:179] offset:256
    ds_write_b64 v255, v[180:181] offset:512
    s_waitcnt lgkmcnt(0)
    s_barrier
    ds_read_b128 v[200:203], v249
    s_branch K2_LASTROW
K2_SPILL:
    buffer_store_dwordx4 v[0:3], v227, s[8:11], s60 offen offset:0
    buffer_store_dwordx4 v[4:7], v227, s[8:11], s60 offen offset:16
    buffer_store_dwordx4 v[8:11], v227, s[8:11], s60 offen offset:32
    buffer_store_dwordx4 v[12:15], v227, s[8:11], s60 offen offset:48
    buffer_store_dwordx4 v[16:19], v227, s[8:11], s60 offen offset:64
    buffer_store_dwordx4 v[20:23], v227, s[8:11], s60 offen offset:80
    buffer_store_dwordx4 v[24:27], v227, s[8:11], s60 offen offset:96
    buffer_store_dwordx4 v[28:31], v227, s[8:11], s60 offen offset:112
    buffer_store_dwordx4 v[32:35], v227, s[8:11], s60 offen offset:128
    buffer_store_dwordx4 v[36:39], v227, s[8:11], s60 offen offset:144
    buffer_store_dwordx4 v[40:43], v227, s[8:11], s60 offen offset:160
    s_mov_b32 s28, 0
    s_waitcnt vmcnt(0)
    s_cmp_lt_u32 s24, s25
    s_cbranch_scc1 K2_LOAD
    s_add_u32 s23, s23, 20
    s_branch K2_WINDOW
K2_WINDOW:
    s_mov_b32 s24, 0
    s_mov_b32 s25, 1
K2_LOAD:
    v_mbcnt_lo_u32_b32 v176, -1, 0
    v_mbcnt_hi_u32_b32 v176, -1, v176
    s_lshl_b32 s58, s20, 6
    v_add_u32 v177, s58, v176
    v_lshlrev_b32 v70, 4, v176
    s_mov_b32 s58, 7110656
    buffer_load_dwordx4 v[136:139], v70, s[8:11], s58 offen offset:0 sc1
    buffer_load_dwordx4 v[140:143], v70, s[8:11], s58 offen offset:1024 sc1
    s_mov_b32 s58, 7112704
    buffer_load_dwordx4 v[144:147], v70, s[8:11], s58 offen offset:0 sc1
    buffer_load_dwordx4 v[148:151], v70, s[8:11], s58 offen offset:1024 sc1
    s_mov_b32 s58, 7114752
    buffer_load_dwordx4 v[152:155], v70, s[8:11], s58 offen offset:0 sc1
    buffer_load_dwordx4 v[156:159], v70, s[8:11], s58 offen offset:1024 sc1
    s_mov_b32 s58, 7116800
    buffer_load_dwordx4 v[160:163], v70, s[8:11], s58 offen offset:0 sc1
    buffer_load_dwordx4 v[164:167], v70, s[8:11], s58 offen offset:1024 sc1
    s_mov_b32 s58, 7118848
    buffer_load_dwordx4 v[168:171], v70, s[8:11], s58 offen offset:0 sc1
    buffer_load_dwordx4 v[172:175], v70, s[8:11], s58 offen offset:1024 sc1
    s_mul_i32 s58, s20, 10400
    s_add_u32 s58, s58, 65536
    s_add_u32 s59, s58, 512
    v_and_b32 v76, 31, v176
    v_lshrrev_b32 v77, 5, v176
    v_mov_b32 v80, 0
    v_mul_u32_u24 v77, 2080, v77
    v_mov_b32 v81, 0xffff0000
    v_lshl_add_u32 v78, v76, 4, v77
    v_mov_b32 v82, 0
    v_add_u32 v78, s58, v78
    v_mov_b32 v83, v81
    v_add_u32 v85, 16, v176
    v_lshlrev_b32 v84, 5, v176
    v_lshrrev_b32 v85, 6, v85
    v_mul_u32_u24 v85, 1532, v85
    v_sub_u32 v84, v84, v85
    v_mov_b32 v85, -1
    v_add_u32 v84, s59, v84
    ds_write_b32 v84, v85 offset:0
    ds_write_b32 v84, v85 offset:2080
    ds_write_b32 v84, v85 offset:4160
    ds_write_b32 v84, v85 offset:6240
    ds_write_b32 v84, v85 offset:8320
    s_mov_b32 exec_hi, 0
    ds_write_b128 v78, v[80:83] offset:0
    ds_write_b128 v78, v[80:83] offset:2080
    ds_write_b128 v78, v[80:83] offset:4160
    ds_write_b128 v78, v[80:83] offset:6240
    ds_write_b128 v78, v[80:83] offset:8320
    s_mov_b32 exec_hi, -1
    s_cmp_lg_u32 s20, 7
    s_cbranch_scc1 K2_NOH
    v_mov_b32 v76, 0
    v_mov_b32 v77, -1
    v_lshlrev_b32 v78, 2, v176
    v_add_u32 v78, 163072, v78
    s_mov_b64 exec, 0x1ff
    ds_write_b32 v78, v76 offset:192
    s_mov_b32 exec_lo, -1
    ds_write_b32 v78, v77 offset:256
    s_mov_b64 exec, -1
    s_cmp_lg_u32 s24, 0
    s_cbranch_scc1 K2_NOH
    s_mov_b32 exec_hi, 0xffff
    ds_write_b32 v78, v76
    s_mov_b64 exec, 1
    ds_write_b32 v78, v76 offset:228
    s_mov_b64 exec, -1
K2_NOH:
    s_waitcnt lgkmcnt(0)
    s_barrier
    s_branch K2_CELLS
K2_LD_GEN:
    s_mov_b64 exec, s[42:43]
    s_cbranch_execz K2_LD_DONE
    buffer_load_dwordx4 v[4:7], v182, s[8:11], 0 offen sc1
    s_mov_b64 exec, s[44:45]
    s_cbranch_execz K2_LD_DONE
    buffer_load_dwordx4 v[8:11], v183, s[8:11], 0 offen sc1
    s_mov_b64 exec, s[46:47]
    s_cbranch_execz K2_LD_DONE
    buffer_load_dwordx4 v[12:15], v184, s[8:11], 0 offen sc1
    s_mov_b64 exec, s[48:49]
    s_cbranch_execz K2_LD_DONE
    buffer_load_dwordx4 v[16:19], v181, s[8:11], 0 offen offset:128 sc1
    s_mov_b64 exec, s[50:51]
    s_cbranch_execz K2_LD_DONE
    buffer_load_dwordx4 v[20:23], v181, s[8:11], 0 offen offset:160 sc1
    s_mov_b64 exec, s[90:91]
    s_cbranch_execz K2_LD_DONE
    buffer_load_dwordx4 v[24:27], v181, s[8:11], 0 offen offset:192 sc1
    s_mov_b64 exec, s[92:93]
    s_cbranch_execz K2_LD_DONE
    buffer_load_dwordx4 v[28:31], v181, s[8:11], 0 offen offset:224 sc1
    s_mov_b64 exec, s[94:95]
    s_cbranch_execz K2_LD_DONE
    buffer_load_dwordx4 v[32:35], v181, s[8:11], 0 offen offset:256 sc1
    s_mov_b64 exec, s[96:97]
    s_cbranch_execz K2_LD_DONE
    buffer_load_dwordx4 v[36:39], v181, s[8:11], 0 offen offset:288 sc1
    s_branch K2_LD_DONE
K2_WLATE:
    s_waitcnt vmcnt(0)
    s_branch K2_WUNP
K2_RT0:
    s_sub_u32 s60, s60, 1
    s_cbranch_scc1 K2_END
    buffer_load_dwordx4 v[0:3], v181, s[8:11], 0 offen offset:0 sc1
    s_waitcnt vmcnt(0)
    s_branch K2_CK0
K2_RT1:
    s_sub_u32 s60, s60, 1
    s_cbranch_scc1 K2_END
    buffer_load_dwordx4 v[4:7], v182, s[8:11], 0 offen sc1
    s_waitcnt vmcnt(0)
    s_branch K2_CK1
K2_RT2:
    s_sub_u32 s60, s60, 1
    s_cbranch_scc1 K2_END
    buffer_load_dwordx4 v[8:11], v183, s[8:11], 0 offen sc1
    s_waitcnt vmcnt(0)
    s_branch K2_CK2
K2_RT3:
    s_sub_u32 s60, s60, 1
    s_cbranch_scc1 K2_END
    buffer_load_dwordx4 v[12:15], v184, s[8:11], 0 offen sc1
    s_waitcnt vmcnt(0)
    s_branch K2_CK3
K2_RT4:
    s_sub_u32 s60, s60, 1
    s_cbranch_scc1 K2_END
    buffer_load_dwordx4 v[16:19], v181, s[8:11], 0 offen offset:128 sc1
    s_waitcnt vmcnt(0)
    s_branch K2_CK4
K2_RT5:
    s_sub_u32 s60, s60, 1
    s_cbranch_scc1 K2_END
    buffer_load_dwordx4 v[20:23], v181, s[8:11], 0 offen offset:160 sc1
    s_waitcnt vmcnt(0)
    s_branch K2_CK5
K2_RT6:
    s_sub_u32 s60, s60, 1
    s_cbranch_scc1 K2_END
    buffer_load_dwordx4 v[24:27], v181, s[8:11], 0 offen offset:192 sc1
    s_waitcnt vmcnt(0)
    s_branch K2_CK6
K2_RT7:
    s_sub_u32 s60, s60, 1
    s_cbranch_scc1 K2_END
    buffer_load_dwordx4 v[28:31], v181, s[8:11], 0 offen offset:224 sc1
    s_waitcnt vmcnt(0)
    s_branch K2_CK7
K2_RT8:
    s_sub_u32 s60, s60, 1
    s_cbranch_scc1 K2_END
    buffer_load_dwordx4 v[32:35], v181, s[8:11], 0 offen offset:256 sc1
    s_waitcnt vmcnt(0)
    s_branch K2_CK8
K2_RT9:
    s_sub_u32 s60, s60, 1
    s_cbranch_scc1 K2_END
    buffer_load_dwordx4 v[36:39], v181, s[8:11], 0 offen offset:288 sc1
    s_waitcnt vmcnt(0)
    s_branch K2_CK9
K2_RK_LOAD:
    s_waitcnt vmcnt(0)
    s_mov_b64 exec, s[40:41]
    s_cbranch_execz K2_RK_B
    v_lshrrev_b32 v50, 24, v3
    buffer_load_dword v40, v179, s[8:11], s66 offen offset:0
    v_mad_u32_u24 v50, v50, s58, v202
    v_and_b32 v3, 0xffffff, v3
    s_mov_b64 exec, s[42:43]
    s_cbranch_execz K2_RK_B
    v_lshrrev_b32 v51, 24, v7
    buffer_load_dword v41, v185, s[8:11], s66 offen
    v_mad_u32_u24 v51, v51, s58, v202
    v_and_b32 v7, 0xffffff, v7
    s_mov_b64 exec, s[44:45]
    s_cbranch_execz K2_RK_B
    v_lshrrev_b32 v52, 24, v11
    buffer_load_dword v42, v186, s[8:11], s66 offen
    v_mad_u32_u24 v52, v52, s58, v202
    v_and_b32 v11, 0xffffff, v11
    s_mov_b64 exec, s[46:47]
    s_cbranch_execz K2_RK_B
    v_lshrrev_b32 v53, 24, v15
    buffer_load_dword v43, v187, s[8:11], s66 offen
    v_mad_u32_u24 v53, v53, s58, v202
    v_and_b32 v15, 0xffffff, v15
    s_mov_b64 exec, s[48:49]
    s_cbranch_execz K2_RK_B
    v_lshrrev_b32 v54, 24, v19
    buffer_load_dword v44, v179, s[8:11], s66 offen offset:32
    v_mad_u32_u24 v54, v54, s58, v202
    v_and_b32 v19, 0xffffff, v19
    s_mov_b64 exec, s[50:51]
    s_cbranch_execz K2_RK_B
    v_lshrrev_b32 v55, 24, v23
    buffer_load_dword v45, v179, s[8:11], s66 offen offset:40
    v_mad_u32_u24 v55, v55, s58, v202
    v_and_b32 v23, 0xffffff, v23
    s_mov_b64 exec, s[90:91]
    s_cbranch_execz K2_RK_B
    v_lshrrev_b32 v56, 24, v27
    buffer_load_dword v46, v179, s[8:11], s66 offen offset:48
    v_mad_u32_u24 v56, v56, s58, v202
    v_and_b32 v27, 0xffffff, v27
    s_mov_b64 exec, s[92:93]
    s_cbranch_execz K2_RK_B
    v_lshrrev_b32 v57, 24, v31
    buffer_load_dword v47, v179, s[8:11], s66 offen offset:56
    v_mad_u32_u24 v57, v57, s58, v202
    v_and_b32 v31, 0xffffff, v31
    s_mov_b64 exec, s[94:95]
    s_cbranch_execz K2_RK_B
    v_lshrrev_b32 v58, 24, v35
    buffer_load_dword v48, v179, s[8:11], s66 offen offset:64
    v_mad_u32_u24 v58, v58, s58, v202
    v_and_b32 v35, 0xffffff, v35
    s_mov_b64 exec, s[96:97]
    s_cbranch_execz K2_RK_B
    v_lshrrev_b32 v59, 24, v39
    buffer_load_dword v49, v179, s[8:11], s66 offen offset:72
    v_mad_u32_u24 v59, v59, s58, v202
    v_and_b32 v39, 0xffffff, v39
K2_RK_B:
    s_mov_b64 exec, -1
    s_mul_i32 s62, s24, 48
    s_waitcnt vmcnt(0)
    v_subrev_u32 v40, s62, v40
    v_subrev_u32 v41, s62, v41
    v_subrev_u32 v42, s62, v42
    v_subrev_u32 v43, s62, v43
    v_subrev_u32 v44, s62, v44
    v_subrev_u32 v45, s62, v45
    v_subrev_u32 v46, s62, v46
    v_subrev_u32 v47, s62, v47
    v_subrev_u32 v48, s62, v48
    v_subrev_u32 v49, s62, v49
    s_branch K2_RK_DONE
K2_BIG:
    s_cmp_lg_u32 s24, 0
    s_cbranch_scc1 K2_TOK
    s_movk_i32 s26, 48
    v_mov_b32 v197, v193
    s_nop 1
    v_max_u32_dpp v197, v197, v197 row_shr:1 row_mask:0xf bank_mask:0xf bound_ctrl:0
    s_nop 1
    v_max_u32_dpp v197, v197, v197 row_shr:2 row_mask:0xf bank_mask:0xf bound_ctrl:0
    s_nop 1
    v_max_u32_dpp v197, v197, v197 row_shr:4 row_mask:0xf bank_mask:0xf bound_ctrl:0
    s_nop 1
    v_max_u32_dpp v197, v197, v197 row_shr:8 row_mask:0xf bank_mask:0xf bound_ctrl:0
    s_nop 1
    v_max_u32_dpp v197, v197, v197 row_bcast:15 row_mask:0xa bank_mask:0xf
    s_nop 1
    v_max_u32_dpp v197, v197, v197 row_bcast:31 row_mask:0xc bank_mask:0xf
    s_nop 0
    v_readlane_b32 s25, v197, 63
    s_nop 0
    s_add_u32 s25, s25, 47
    s_mul_i32 s25, s25, 43691
    s_lshr_b32 s25, s25, 21
    s_mov_b64 exec, s[40:41]
    s_cbranch_execz K2_SV_DONE
    buffer_store_dword v40, v179, s[8:11], s66 offen offset:0
    s_mov_b64 exec, s[42:43]
    s_cbranch_execz K2_SV_DONE
    buffer_store_dword v41, v185, s[8:11], s66 offen
    s_mov_b64 exec, s[44:45]
    s_cbranch_execz K2_SV_DONE
    buffer_store_dword v42, v186, s[8:11], s66 offen
    s_mov_b64 exec, s[46:47]
    s_cbranch_execz K2_SV_DONE
    buffer_store_dword v43, v187, s[8:11], s66 offen
    s_mov_b64 exec, s[48:49]
    s_cbranch_execz K2_SV_DONE
    buffer_store_dword v44, v179, s[8:11], s66 offen offset:32
    s_mov_b64 exec, s[50:51]
    s_cbranch_execz K2_SV_DONE
    buffer_store_dword v45, v179, s[8:11], s66 offen offset:40
    s_mov_b64 exec, s[90:91]
    s_cbranch_execz K2_SV_DONE
    buffer_store_dword v46, v179, s[8:11], s66 offen offset:48
    s_mov_b64 exec, s[92:93]
    s_cbranch_execz K2_SV_DONE
    buffer_store_dword v47, v179, s[8:11], s66 offen offset:56
    s_mov_b64 exec, s[94:95]
    s_cbranch_execz K2_SV_DONE
    buffer_store_dword v48, v179, s[8:11], s66 offen offset:64
    s_mov_b64 exec, s[96:97]
    s_cbranch_execz K2_SV_DONE
    buffer_store_dword v49, v179, s[8:11], s66 offen offset:72
K2_SV_DONE:
    s_mov_b64 exec, -1
    s_branch K2_TOK
K2_rare_1:
    s_cmp_eq_u32 s33, 4
    s_cbranch_scc1 K2_four_3
    s_mov_b32 s49, s48
    s_mov_b32 s51, s48
    s_xor_b32 s45, s44, 256
    s_xor_b32 s46, s44, 512
    s_xor_b32 s47, s44, 768
    s_branch K2_back_2
K2_four_3:
    s_add_u32 s50, s48, 256
    s_add_u32 s51, s48, 384
    s_mov_b32 s46, s44
    s_mov_b32 s47, s44
    s_branch K2_back_2
K2_a4_5:
    v_add_u32 v254, s48, v230
    ds_read_b32 v254, v254 offset:4
    s_lshr_b32 s65, s3, 27
    s_mul_i32 s66, s22, 2080
    s_lshl_b32 s65, s65, 9
    s_add_u32 s65, s65, s66
    s_add_u32 s65, s65, 65536
    s_mov_b32 m0, s65
    s_mov_b32 exec_hi, 0
    s_waitcnt lgkmcnt(0)
    v_or_b32 v254, v254, v231
    buffer_load_dwordx4 v254, s[16:19], 0 offen  lds
    s_mov_b32 exec_hi, -1
    s_branch K2_b4_7
K2_rare_14:
    s_cmp_eq_u32 s33, 4
    s_cbranch_scc1 K2_four_16
    s_mov_b32 s49, s48
    s_mov_b32 s51, s48
    s_xor_b32 s45, s44, 256
    s_xor_b32 s46, s44, 512
    s_xor_b32 s47, s44, 768
    s_branch K2_back_15
K2_four_16:
    s_add_u32 s50, s48, 256
    s_add_u32 s51, s48, 384
    s_mov_b32 s46, s44
    s_mov_b32 s47, s44
    s_branch K2_back_15
K2_a4_18:
    v_add_u32 v254, s48, v230
    ds_read_b32 v254, v254 offset:4
    s_lshr_b32 s65, s3, 27
    s_mul_i32 s66, s22, 2080
    s_lshl_b32 s65, s65, 9
    s_add_u32 s65, s65, s66
    s_add_u32 s65, s65, 65536
    s_mov_b32 m0, s65
    s_mov_b32 exec_hi, 0
    s_waitcnt lgkmcnt(0)
    v_or_b32 v254, v254, v231
    buffer_load_dwordx4 v254, s[16:19], 0 offen  lds
    s_mov_b32 exec_hi, -1
    s_branch K2_b4_20
K2_rare_27:
    s_cmp_eq_u32 s33, 4
    s_cbranch_scc1 K2_four_29
    s_mov_b32 s49, s48
    s_mov_b32 s51, s48
    s_xor_b32 s45, s44, 256
    s_xor_b32 s46, s44, 512
    s_xor_b32 s47, s44, 768
    s_branch K2_back_28
K2_four_29:
    s_add_u32 s50, s48, 256
    s_add_u32 s51, s48, 384
    s_mov_b32 s46, s44
    s_mov_b32 s47, s44
    s_branch K2_back_28
K2_a4_31:
    v_add_u32 v254, s48, v230
    ds_read_b32 v254, v254 offset:4
    s_lshr_b32 s65, s3, 27
    s_mul_i32 s66, s22, 2080
    s_lshl_b32 s65, s65, 9
    s_add_u32 s65, s65, s66
    s_add_u32 s65, s65, 65536
    s_mov_b32 m0, s65
    s_mov_b32 exec_hi, 0
    s_waitcnt lgkmcnt(0)
    v_or_b32 v254, v254, v231
    buffer_load_dwordx4 v254, s[16:19], 0 offen  lds
    s_mov_b32 exec_hi, -1
    s_branch K2_b4_33
K2_rare_40:
    s_cmp_eq_u32 s33, 4
    s_cbranch_scc1 K2_four_42
    s_mov_b32 s49, s48
    s_mov_b32 s51, s48
    s_xor_b32 s45, s44, 256
    s_xor_b32 s46, s44, 512
    s_xor_b32 s47, s44, 768
    s_branch K2_back_41
K2_four_42:
    s_add_u32 s50, s48, 256
    s_add_u32 s51, s48, 384
    s_mov_b32 s46, s44
    s_mov_b32 s47, s44
    s_branch K2_back_41
K2_a4_44:
    v_add_u32 v254, s48, v230
    ds_read_b32 v254, v254 offset:4
    s_lshr_b32 s65, s3, 27
    s_mul_i32 s66, s22, 2080
    s_lshl_b32 s65, s65, 9
    s_add_u32 s65, s65, s66
    s_add_u32 s65, s65, 65536
    s_mov_b32 m0, s65
    s_mov_b32 exec_hi, 0
    s_waitcnt lgkmcnt(0)
    v_or_b32 v254, v254, v231
    buffer_load_dwordx4 v254, s[16:19], 0 offen  lds
    s_mov_b32 exec_hi, -1
    s_branch K2_b4_46
K2_rare_51:
    s_cmp_eq_u32 s33, 4
    s_cbranch_scc1 K2_four_53
    s_mov_b32 s49, s48
    s_mov_b32 s51, s48
    s_xor_b32 s45, s44, 256
    s_xor_b32 s46, s44, 512
    s_xor_b32 s47, s44, 768
    s_branch K2_back_52
K2_four_53:
    s_add_u32 s50, s48, 256
    s_add_u32 s51, s48, 384
    s_mov_b32 s46, s44
    s_mov_b32 s47, s44
    s_branch K2_back_52
K2_rare_58:
    s_cmp_eq_u32 s33, 4
    s_cbranch_scc1 K2_four_60
    s_mov_b32 s49, s48
    s_mov_b32 s51, s48
    s_xor_b32 s45, s44, 256
    s_xor_b32 s46, s44, 512
    s_xor_b32 s47, s44, 768
    s_branch K2_back_59
K2_four_60:
    s_add_u32 s50, s48, 256
    s_add_u32 s51, s48, 384
    s_mov_b32 s46, s44
    s_mov_b32 s47, s44
    s_branch K2_back_59
K2_rare_65:
    s_cmp_eq_u32 s33, 4
    s_cbranch_scc1 K2_four_67
    s_mov_b32 s49, s48
    s_mov_b32 s51, s48
    s_xor_b32 s45, s44, 256
    s_xor_b32 s46, s44, 512
    s_xor_b32 s47, s44, 768
    s_branch K2_back_66
K2_four_67:
    s_add_u32 s50, s48, 256
    s_add_u32 s51, s48, 384
    s_mov_b32 s46, s44
    s_mov_b32 s47, s44
    s_branch K2_back_66
K2_U10:
    s_setprio 1
    s_add_u32 s38, s38, 1
    v_mov_b32 v254, s52
    v_mov_b32 v255, s38
    s_lshl_b32 s58, s38, 3
    s_add_u32 s58, s58, s20
    s_mov_b64 exec, 1
    ds_write_b32 v254, v255
    s_mov_b64 exec, -1
    s_cmp_lt_u32 s58, s22
    s_cbranch_scc0 K2_dyn_68
K2_back_69:
    s_waitcnt lgkmcnt(4)
    v_lshlrev_b32 v20, 16, v0
    v_and_b32 v21, 0xffff0000, v0
    v_lshlrev_b32 v22, 16, v1
    v_and_b32 v23, 0xffff0000, v1
    v_lshlrev_b32 v24, 16, v2
    v_and_b32 v25, 0xffff0000, v2
    v_lshlrev_b32 v26, 16, v3
    v_and_b32 v27, 0xffff0000, v3
    v_mul_f32_dpp v36, v16, v20 row_newbcast:8 row_mask:0xf bank_mask:0xf
    v_mul_f32_dpp v37, v16, v21 row_newbcast:9 row_mask:0xf bank_mask:0xf
    v_mul_f32_dpp v38, v16, v22 row_newbcast:10 row_mask:0xf bank_mask:0xf
    v_mul_f32_dpp v39, v16, v23 row_newbcast:11 row_mask:0xf bank_mask:0xf
    v_mul_f32_dpp v40, v16, v24 row_newbcast:12 row_mask:0xf bank_mask:0xf
    v_mul_f32_dpp v41, v16, v25 row_newbcast:13 row_mask:0xf bank_mask:0xf
    v_mul_f32_dpp v42, v16, v26 row_newbcast:14 row_mask:0xf bank_mask:0xf
    v_mul_f32_dpp v43, v16, v27 row_newbcast:15 row_mask:0xf bank_mask:0xf
    v_cvt_pk_bf16_f32 v68, v36, v37
    v_cvt_pk_bf16_f32 v69, v38, v39
    v_cvt_pk_bf16_f32 v70, v40, v41
    v_cvt_pk_bf16_f32 v71, v42, v43
    v_mul_f32_dpp v20, v16, v20 row_newbcast:0 row_mask:0xa bank_mask:0xf
    v_mul_f32_dpp v21, v16, v21 row_newbcast:1 row_mask:0xa bank_mask:0xf
    v_mul_f32_dpp v22, v16, v22 row_newbcast:2 row_mask:0xa bank_mask:0xf
    v_mul_f32_dpp v23, v16, v23 row_newbcast:3 row_mask:0xa bank_mask:0xf
    v_mul_f32_dpp v24, v16, v24 row_newbcast:4 row_mask:0xa bank_mask:0xf
    v_mul_f32_dpp v25, v16, v25 row_newbcast:5 row_mask:0xa bank_mask:0xf
    v_mul_f32_dpp v26, v16, v26 row_newbcast:6 row_mask:0xa bank_mask:0xf
    v_mul_f32_dpp v27, v16, v27 row_newbcast:7 row_mask:0xa bank_mask:0xf
    v_cvt_pk_bf16_f32 v64, v20, v21
    v_cvt_pk_bf16_f32 v65, v22, v23
    v_cvt_pk_bf16_f32 v66, v24, v25
    v_cvt_pk_bf16_f32 v67, v26, v27
    v_readlane_b32 s3, v253, s58
    s_lshl_b32 s44, s34, 7
    s_and_b32 s48, s3, 0x3ffff
    s_bfe_u32 s33, s3, 0x30013
    s_mul_i32 s35, s38, 6
    s_cmp_eq_u32 s34, 0
    s_cselect_b32 s35, s35, s48
    s_mov_b32 s45, s44
    s_xor_b32 s47, s44, 256
    s_add_u32 s49, s48, 128
    s_add_u32 s60, s48, 256
    s_cmp_eq_u32 s33, 3
    s_cselect_b32 s46, s44, s47
    s_cselect_b32 s50, s60, s48
    s_cselect_b32 s51, s48, s49
    s_sub_u32 s60, s33, 2
    s_cmp_lt_u32 s60, 2
    s_cbranch_scc0 K2_rare_74
K2_back_75:
    v_add_u32 v233, s48, v230
    ds_read_b32 v232, v233
    ds_read_b32 v233, v233 offset:1024
    v_add_u32 v222, s48, v251
    ds_read2_b32 v[222:223], v222 offset0:1 offset1:3
    v_add_u32 v224, s49, v251
    ds_read2_b32 v[224:225], v224 offset0:1 offset1:3
    v_add_u32 v226, s50, v251
    ds_read2_b32 v[226:227], v226 offset0:1 offset1:3
    v_add_u32 v228, s51, v251
    ds_read2_b32 v[228:229], v228 offset0:1 offset1:3
    s_waitcnt lgkmcnt(4)
    v_or_b32 v232, v232, v231
    v_or_b32 v233, v233, v231
    s_cmp_lg_u32 s34, 0
    s_cbranch_scc1 K2_dum_77
    s_cmp_eq_u32 s33, 4
    s_cbranch_scc1 K2_a4_78
K2_b4_80:
    s_add_u32 m0, s48, 512
    s_add_u32 s65, s48, 1536
    buffer_load_dwordx4 v232, s[16:19], 0 offen  lds
    s_mov_b32 m0, s65
    s_mov_b32 exec_hi, 0
    buffer_load_dwordx4 v233, s[16:19], 0 offen  lds
    s_mov_b32 exec_hi, -1
K2_back_79:
    s_waitcnt lgkmcnt(3)
    v_mad_u32_u16 v222, v222, s39, v248 op_sel:[1,0,0,0]
    v_mad_u32_u16 v223, v223, s39, v248 op_sel:[1,0,0,0]
    s_waitcnt lgkmcnt(2)
    v_mad_u32_u16 v224, v224, s39, v248 op_sel:[1,0,0,0]
    v_mad_u32_u16 v225, v225, s39, v248 op_sel:[1,0,0,0]
    s_waitcnt lgkmcnt(1)
    v_mad_u32_u16 v226, v226, s39, v248 op_sel:[1,0,0,0]
    v_mad_u32_u16 v227, v227, s39, v248 op_sel:[1,0,0,0]
    s_waitcnt lgkmcnt(0)
    v_mad_u32_u16 v228, v228, s39, v248 op_sel:[1,0,0,0]
    v_mad_u32_u16 v229, v229, s39, v248 op_sel:[1,0,0,0]
    s_waitcnt vmcnt(6)
    v_mfma_f32_32x32x16_bf16 v[0:15], v[64:67], v[176:179], 0
    ds_read_b64_tr_b16 v[184:185], v246 offset:2048
    ds_read_b64_tr_b16 v[186:187], v246 offset:3072
    ds_read_b64_tr_b16 v[188:189], v247 offset:2048
    ds_read_b64_tr_b16 v[190:191], v247 offset:3072
    s_mov_b32 m0, s68
    v_mfma_f32_32x32x16_bf16 v[16:31], v[68:71], v[176:179], 0
    buffer_load_dwordx4 v222, s[4:7], s44 offen sc1 lds
    buffer_load_dwordx4 v223, s[72:75], s44 offen offset:1024 sc1 lds
    v_permlane32_swap_b32 v242, v236
    v_permlane32_swap_b32 v243, v237
    v_mfma_f32_32x32x16_bf16 v[32:47], v[64:67], v[180:183], 0
    v_permlane32_swap_b32 v244, v238
    v_permlane32_swap_b32 v245, v239
    v_permlane32_swap_b32 v240, v241
    v_add_f32 v242, v242, v236
    v_mfma_f32_32x32x16_bf16 v[48:63], v[68:71], v[180:183], 0
    s_setprio 0
    v_add_f32 v243, v243, v237
    v_add_f32 v244, v244, v238
    v_add_f32 v245, v245, v239
    v_add_f32 v240, -v240, -v241
    s_set_gpr_idx_on s32, gpr_idx(DST)
    s_nop 0
    v_cvt_pk_bf16_f32 v195, v242, v243
    v_cvt_pk_bf16_f32 v196, v244, v245
    v_cvt_pk_bf16_f32 v197, v240, v240
    s_set_gpr_idx_off
    v_mul_f32 v234, v0, v96
    v_mul_f32 v236, v8, v128
    v_fmac_f32 v234, v1, v97
    v_fmac_f32 v236, v9, v129
    v_fmac_f32 v234, v2, v98
    v_fmac_f32 v236, v10, v130
    v_fmac_f32 v234, v3, v99
    v_fmac_f32 v236, v11, v131
    v_fmac_f32 v234, v4, v100
    v_fmac_f32 v236, v12, v132
    v_fmac_f32 v234, v5, v101
    v_fmac_f32 v236, v13, v133
    v_fmac_f32 v234, v6, v102
    v_fmac_f32 v236, v14, v134
    v_fmac_f32 v234, v7, v103
    v_fmac_f32 v236, v15, v135
    v_mul_f32 v238, v16, v128
    v_mul_f32 v240, v24, v128
    v_fmac_f32 v238, v17, v129
    v_fmac_f32 v240, v25, v129
    v_fmac_f32 v238, v18, v130
    v_fmac_f32 v240, v26, v130
    v_fmac_f32 v238, v19, v131
    v_fmac_f32 v240, v27, v131
    v_fmac_f32 v238, v20, v132
    v_fmac_f32 v240, v28, v132
    v_fmac_f32 v238, v21, v133
    v_fmac_f32 v240, v29, v133
    v_fmac_f32 v238, v22, v134
    v_fmac_f32 v240, v30, v134
    v_fmac_f32 v238, v23, v135
    v_fmac_f32 v240, v31, v135
    v_mul_f32 v235, v32, v104
    v_mul_f32 v237, v40, v136
    v_fmac_f32 v235, v33, v105
    v_fmac_f32 v237, v41, v137
    v_fmac_f32 v235, v34, v106
    v_fmac_f32 v237, v42, v138
    v_fmac_f32 v235, v35, v107
    v_fmac_f32 v237, v43, v139
    v_fmac_f32 v235, v36, v108
    v_fmac_f32 v237, v44, v140
    v_fmac_f32 v235, v37, v109
    v_fmac_f32 v237, v45, v141
    v_fmac_f32 v235, v38, v110
    v_fmac_f32 v237, v46, v142
    v_fmac_f32 v235, v39, v111
    v_fmac_f32 v237, v47, v143
    v_mul_f32 v239, v48, v136
    v_mul_f32 v241, v56, v136
    v_fmac_f32 v239, v49, v137
    v_fmac_f32 v241, v57, v137
    v_fmac_f32 v239, v50, v138
    v_fmac_f32 v241, v58, v138
    v_fmac_f32 v239, v51, v139
    v_fmac_f32 v241, v59, v139
    v_fmac_f32 v239, v52, v140
    v_fmac_f32 v241, v60, v140
    v_fmac_f32 v239, v53, v141
    v_fmac_f32 v241, v61, v141
    v_fmac_f32 v239, v54, v142
    v_fmac_f32 v241, v62, v142
    v_fmac_f32 v239, v55, v143
    v_fmac_f32 v241, v63, v143
    s_setprio 1
    s_waitcnt vmcnt(6) lgkmcnt(0)
    v_mfma_f32_32x32x16_bf16 v[0:15], v[64:67], v[184:187], 0
    ds_read_b64_tr_b16 v[176:177], v246 offset:4096
    ds_read_b64_tr_b16 v[178:179], v246 offset:5120
    ds_read_b64_tr_b16 v[180:181], v247 offset:4096
    ds_read_b64_tr_b16 v[182:183], v247 offset:5120
    s_mov_b32 m0, s69
    v_mfma_f32_32x32x16_bf16 v[16:31], v[68:71], v[184:187], 0
    buffer_load_dwordx4 v224, s[4:7], s45 offen sc1 lds
    buffer_load_dwordx4 v225, s[72:75], s45 offen offset:1024 sc1 lds
    v_permlane32_swap_b32 v234, v236
    v_permlane32_swap_b32 v235, v237
    v_mfma_f32_32x32x16_bf16 v[32:47], v[64:67], v[188:191], 0
    v_permlane32_swap_b32 v240, v238
    v_permlane32_swap_b32 v241, v239
    v_add_f32 v234, v234, v236
    v_add_f32 v235, v235, v237
    v_add_f32 v240, v240, v238
    v_mfma_f32_32x32x16_bf16 v[48:63], v[68:71], v[188:191], 0
    s_setprio 0
    v_add_f32 v241, v241, v239
    s_set_gpr_idx_on s31, gpr_idx(DST)
    s_nop 0
    v_cvt_pk_bf16_f32 v192, v234, v235
    v_cvt_pk_bf16_f32 v193, v240, v241
    s_set_gpr_idx_off
    v_mul_f32 v234, v0, v144
    v_mul_f32 v236, v8, v112
    v_fmac_f32 v234, v1, v145
    v_fmac_f32 v236, v9, v113
    v_fmac_f32 v234, v2, v146
    v_fmac_f32 v236, v10, v114
    v_fmac_f32 v234, v3, v147
    v_fmac_f32 v236, v11, v115
    v_fmac_f32 v234, v4, v148
    v_fmac_f32 v236, v12, v116
    v_fmac_f32 v234, v5, v149
    v_fmac_f32 v236, v13, v117
    v_fmac_f32 v234, v6, v150
    v_fmac_f32 v236, v14, v118
    v_fmac_f32 v234, v7, v151
    v_fmac_f32 v236, v15, v119
    v_mul_f32 v238, v16, v160
    v_mul_f32 v240, v24, v160
    v_fmac_f32 v238, v17, v161
    v_fmac_f32 v240, v25, v161
    v_fmac_f32 v238, v18, v162
    v_fmac_f32 v240, v26, v162
    v_fmac_f32 v238, v19, v163
    v_fmac_f32 v240, v27, v163
    v_fmac_f32 v238, v20, v164
    v_fmac_f32 v240, v28, v164
    v_fmac_f32 v238, v21, v165
    v_fmac_f32 v240, v29, v165
    v_fmac_f32 v238, v22, v166
    v_fmac_f32 v240, v30, v166
    v_fmac_f32 v238, v23, v167
    v_fmac_f32 v240, v31, v167
    v_mul_f32 v235, v32, v152
    v_mul_f32 v237, v40, v120
    v_fmac_f32 v235, v33, v153
    v_fmac_f32 v237, v41, v121
    v_fmac_f32 v235, v34, v154
    v_fmac_f32 v237, v42, v122
    v_fmac_f32 v235, v35, v155
    v_fmac_f32 v237, v43, v123
    v_fmac_f32 v235, v36, v156
    v_fmac_f32 v237, v44, v124
    v_fmac_f32 v235, v37, v157
    v_fmac_f32 v237, v45, v125
    v_fmac_f32 v235, v38, v158
    v_fmac_f32 v237, v46, v126
    v_fmac_f32 v235, v39, v159
    v_fmac_f32 v237, v47, v127
    v_mul_f32 v239, v48, v168
    v_mul_f32 v241, v56, v168
    v_fmac_f32 v239, v49, v169
    v_fmac_f32 v241, v57, v169
    v_fmac_f32 v239, v50, v170
    v_fmac_f32 v241, v58, v170
    v_fmac_f32 v239, v51, v171
    v_fmac_f32 v241, v59, v171
    v_fmac_f32 v239, v52, v172
    v_fmac_f32 v241, v60, v172
    v_fmac_f32 v239, v53, v173
    v_fmac_f32 v241, v61, v173
    v_fmac_f32 v239, v54, v174
    v_fmac_f32 v241, v62, v174
    v_fmac_f32 v239, v55, v175
    v_fmac_f32 v241, v63, v175
    s_setprio 1
    s_waitcnt vmcnt(6) lgkmcnt(0)
    v_mfma_f32_32x32x16_bf16 v[0:15], v[64:67], v[176:179], 0
    ds_read_b64_tr_b16 v[184:185], v246 offset:6144
    ds_read_b64_tr_b16 v[186:187], v246 offset:7168
    ds_read_b64_tr_b16 v[188:189], v247 offset:6144
    ds_read_b64_tr_b16 v[190:191], v247 offset:7168
    s_mov_b32 m0, s70
    v_mfma_f32_32x32x16_bf16 v[16:31], v[68:71], v[176:179], 0
    buffer_load_dwordx4 v226, s[4:7], s46 offen sc1 lds
    buffer_load_dwordx4 v227, s[72:75], s46 offen offset:1024 sc1 lds
    s_sub_u32 s26, s48, s29
    s_mov_b32 s29, s48
    s_mov_b32 s30, s3
    s_bfe_u32 s56, s3, 0x40012
    v_mfma_f32_32x32x16_bf16 v[32:47], v[64:67], v[180:183], 0
    s_cmp_eq_u32 s34, 0
    s_cselect_b32 s56, s56, 0
    v_mfma_f32_32x32x16_bf16 v[48:63], v[68:71], v[180:183], 0
    s_setprio 0
    v_mul_f32 v242, v0, v144
    v_fma_f32 v238, v8, v160, -v238
    v_fmac_f32 v242, v1, v145
    v_fmac_f32 v238, v9, v161
    v_fmac_f32 v242, v2, v146
    v_fmac_f32 v238, v10, v162
    v_fmac_f32 v242, v3, v147
    v_fmac_f32 v238, v11, v163
    v_fmac_f32 v242, v4, v148
    v_fmac_f32 v238, v12, v164
    v_fmac_f32 v242, v5, v149
    v_fmac_f32 v238, v13, v165
    v_fmac_f32 v242, v6, v150
    v_fmac_f32 v238, v14, v166
    v_fmac_f32 v242, v7, v151
    v_fmac_f32 v238, v15, v167
    v_fmac_f32 v236, v16, v112
    v_mul_f32 v244, v24, v160
    v_fmac_f32 v236, v17, v113
    v_fmac_f32 v244, v25, v161
    v_fmac_f32 v236, v18, v114
    v_fmac_f32 v244, v26, v162
    v_fmac_f32 v236, v19, v115
    v_fmac_f32 v244, v27, v163
    v_fmac_f32 v236, v20, v116
    v_fmac_f32 v244, v28, v164
    v_fmac_f32 v236, v21, v117
    v_fmac_f32 v244, v29, v165
    v_fmac_f32 v236, v22, v118
    v_fmac_f32 v244, v30, v166
    v_fmac_f32 v236, v23, v119
    v_fmac_f32 v244, v31, v167
    v_mul_f32 v243, v32, v152
    v_fma_f32 v239, v40, v168, -v239
    v_fmac_f32 v243, v33, v153
    v_fmac_f32 v239, v41, v169
    v_fmac_f32 v243, v34, v154
    v_fmac_f32 v239, v42, v170
    v_fmac_f32 v243, v35, v155
    v_fmac_f32 v239, v43, v171
    v_fmac_f32 v243, v36, v156
    v_fmac_f32 v239, v44, v172
    v_fmac_f32 v243, v37, v157
    v_fmac_f32 v239, v45, v173
    v_fmac_f32 v243, v38, v158
    v_fmac_f32 v239, v46, v174
    v_fmac_f32 v243, v39, v159
    v_fmac_f32 v239, v47, v175
    v_fmac_f32 v237, v48, v120
    v_mul_f32 v245, v56, v168
    v_fmac_f32 v237, v49, v121
    v_fmac_f32 v245, v57, v169
    v_fmac_f32 v237, v50, v122
    v_fmac_f32 v245, v58, v170
    v_fmac_f32 v237, v51, v123
    v_fmac_f32 v245, v59, v171
    v_fmac_f32 v237, v52, v124
    v_fmac_f32 v245, v60, v172
    v_fmac_f32 v237, v53, v125
    v_fmac_f32 v245, v61, v173
    v_fmac_f32 v237, v54, v126
    v_fmac_f32 v245, v62, v174
    v_fmac_f32 v237, v55, v127
    v_fmac_f32 v245, v63, v175
    s_setprio 1
    s_waitcnt vmcnt(4) lgkmcnt(0)
    v_mfma_f32_32x32x16_bf16 v[0:15], v[64:67], v[184:187], 0
    ds_read_b64_tr_b16 v[176:177], v246 offset:0
    ds_read_b64_tr_b16 v[178:179], v246 offset:1024
    ds_read_b64_tr_b16 v[180:181], v247 offset:0
    ds_read_b64_tr_b16 v[182:183], v247 offset:1024
    s_mov_b32 m0, s71
    v_mfma_f32_32x32x16_bf16 v[16:31], v[68:71], v[184:187], 0
    buffer_load_dwordx4 v228, s[4:7], s47 offen sc1 lds
    buffer_load_dwordx4 v229, s[72:75], s47 offen offset:1024 sc1 lds
    v_permlane32_swap_b32 v242, v234
    v_permlane32_swap_b32 v243, v235
    v_add_f32 v242, v242, v234
    v_mfma_f32_32x32x16_bf16 v[32:47], v[64:67], v[188:191], 0
    v_add_f32 v243, v243, v235
    s_set_gpr_idx_on s31, gpr_idx(DST)
    s_nop 0
    v_cvt_pk_bf16_f32 v194, v242, v243
    s_set_gpr_idx_off
    s_mov_b32 s32, s31
    s_mov_b32 s31, s35
    v_mfma_f32_32x32x16_bf16 v[48:63], v[68:71], v[188:191], 0
    s_setprio 0
    v_mul_f32 v242, v0, v144
    v_fma_f32 v240, v8, v160, -v240
    v_fmac_f32 v242, v1, v145
    v_fmac_f32 v240, v9, v161
    v_fmac_f32 v242, v2, v146
    v_fmac_f32 v240, v10, v162
    v_fmac_f32 v242, v3, v147
    v_fmac_f32 v240, v11, v163
    v_fmac_f32 v242, v4, v148
    v_fmac_f32 v240, v12, v164
    v_fmac_f32 v242, v5, v149
    v_fmac_f32 v240, v13, v165
    v_fmac_f32 v242, v6, v150
    v_fmac_f32 v240, v14, v166
    v_fmac_f32 v242, v7, v151
    v_fmac_f32 v240, v15, v167
    v_add_u32 v249, s26, v249
    v_add_u32 v250, s26, v250
    v_fma_f32 v244, v16, v160, -v244
    v_fmac_f32 v236, v24, v112
    v_fmac_f32 v244, v17, v161
    v_fmac_f32 v236, v25, v113
    v_fmac_f32 v244, v18, v162
    v_fmac_f32 v236, v26, v114
    v_fmac_f32 v244, v19, v163
    v_fmac_f32 v236, v27, v115
    v_fmac_f32 v244, v20, v164
    v_fmac_f32 v236, v28, v116
    v_fmac_f32 v244, v21, v165
    v_fmac_f32 v236, v29, v117
    v_fmac_f32 v244, v22, v166
    v_fmac_f32 v236, v30, v118
    v_fmac_f32 v244, v23, v167
    v_fmac_f32 v236, v31, v119
    ds_read_b64_tr_b16 v[0:1], v249 offset:0
    ds_read_b64_tr_b16 v[2:3], v249 offset:32
    ds_read_u16_d16_hi v16, v250 offset:0
    v_mul_f32 v243, v32, v152
    v_fma_f32 v241, v40, v168, -v241
    v_fmac_f32 v243, v33, v153
    v_fmac_f32 v241, v41, v169
    v_fmac_f32 v243, v34, v154
    v_fmac_f32 v241, v42, v170
    v_fmac_f32 v243, v35, v155
    v_fmac_f32 v241, v43, v171
    v_fmac_f32 v243, v36, v156
    v_fmac_f32 v241, v44, v172
    v_fmac_f32 v243, v37, v157
    v_fmac_f32 v241, v45, v173
    v_fmac_f32 v243, v38, v158
    v_fmac_f32 v241, v46, v174
    v_fmac_f32 v243, v39, v159
    v_fmac_f32 v241, v47, v175
    ds_read_b64_tr_b16 v[4:5], v249 offset:512
    ds_read_b64_tr_b16 v[6:7], v249 offset:544
    ds_read_u16_d16_hi v17, v250 offset:128
    v_fma_f32 v245, v48, v168, -v245
    v_fmac_f32 v237, v56, v120
    v_fmac_f32 v245, v49, v169
    v_fmac_f32 v237, v57, v121
    v_fmac_f32 v245, v50, v170
    v_fmac_f32 v237, v58, v122
    v_fmac_f32 v245, v51, v171
    v_fmac_f32 v237, v59, v123
    v_fmac_f32 v245, v52, v172
    v_fmac_f32 v237, v60, v124
    v_fmac_f32 v245, v53, v173
    v_fmac_f32 v237, v61, v125
    v_fmac_f32 v245, v54, v174
    v_fmac_f32 v237, v62, v126
    v_fmac_f32 v245, v55, v175
    v_fmac_f32 v237, v63, v127
    s_cmp_eq_u32 s56, 5
    s_cbranch_scc1 K2_U20
    s_cmp_eq_u32 s56, 6
    s_cbranch_scc1 K2_U3h0
    s_branch K2_DSP0
K2_U40:
    s_setprio 1
    ds_read_b64_tr_b16 v[8:9], v249 offset:1024
    ds_read_b64_tr_b16 v[10:11], v249 offset:1056
    ds_read_u16_d16_hi v18, v250 offset:256
    s_lshr_b32 s65, s30, 27
    s_mul_i32 s66, s22, 2080
    s_lshl_b32 s65, s65, 9
    s_add_u32 s65, s65, s66
    s_add_u32 s65, s65, 65536
    s_sub_u32 s65, s65, s29
    s_sub_u32 s65, s65, 512
    v_add_u32 v56, s65, v249
    ds_read_b64_tr_b16 v[12:13], v56 offset:0
    ds_read_b64_tr_b16 v[14:15], v56 offset:32
    ds_read_u16_d16_hi v19, v250 offset:384
    s_waitcnt lgkmcnt(6)
    v_lshlrev_b32 v20, 16, v0
    v_and_b32 v21, 0xffff0000, v0
    v_lshlrev_b32 v22, 16, v1
    v_and_b32 v23, 0xffff0000, v1
    v_lshlrev_b32 v24, 16, v2
    v_and_b32 v25, 0xffff0000, v2
    v_lshlrev_b32 v26, 16, v3
    v_and_b32 v27, 0xffff0000, v3
    v_mul_f32_dpp v36, v16, v20 row_newbcast:8 row_mask:0xf bank_mask:0xf
    v_mul_f32_dpp v37, v16, v21 row_newbcast:9 row_mask:0xf bank_mask:0xf
    v_mul_f32_dpp v38, v16, v22 row_newbcast:10 row_mask:0xf bank_mask:0xf
    v_mul_f32_dpp v39, v16, v23 row_newbcast:11 row_mask:0xf bank_mask:0xf
    v_mul_f32_dpp v40, v16, v24 row_newbcast:12 row_mask:0xf bank_mask:0xf
    v_mul_f32_dpp v41, v16, v25 row_newbcast:13 row_mask:0xf bank_mask:0xf
    v_mul_f32_dpp v42, v16, v26 row_newbcast:14 row_mask:0xf bank_mask:0xf
    v_mul_f32_dpp v43, v16, v27 row_newbcast:15 row_mask:0xf bank_mask:0xf
    v_cvt_pk_bf16_f32 v68, v36, v37
    v_cvt_pk_bf16_f32 v69, v38, v39
    v_cvt_pk_bf16_f32 v70, v40, v41
    v_cvt_pk_bf16_f32 v71, v42, v43
    v_mul_f32_dpp v20, v16, v20 row_newbcast:0 row_mask:0xa bank_mask:0xf
    v_mul_f32_dpp v21, v16, v21 row_newbcast:1 row_mask:0xa bank_mask:0xf
    v_mul_f32_dpp v22, v16, v22 row_newbcast:2 row_mask:0xa bank_mask:0xf
    v_mul_f32_dpp v23, v16, v23 row_newbcast:3 row_mask:0xa bank_mask:0xf
    v_mul_f32_dpp v24, v16, v24 row_newbcast:4 row_mask:0xa bank_mask:0xf
    v_mul_f32_dpp v25, v16, v25 row_newbcast:5 row_mask:0xa bank_mask:0xf
    v_mul_f32_dpp v26, v16, v26 row_newbcast:6 row_mask:0xa bank_mask:0xf
    v_mul_f32_dpp v27, v16, v27 row_newbcast:7 row_mask:0xa bank_mask:0xf
    v_cvt_pk_bf16_f32 v64, v20, v21
    v_cvt_pk_bf16_f32 v65, v22, v23
    v_cvt_pk_bf16_f32 v66, v24, v25
    v_cvt_pk_bf16_f32 v67, v26, v27
    v_lshlrev_b32 v28, 16, v4
    v_and_b32 v29, 0xffff0000, v4
    v_lshlrev_b32 v30, 16, v5
    v_and_b32 v31, 0xffff0000, v5
    v_lshlrev_b32 v32, 16, v6
    v_and_b32 v33, 0xffff0000, v6
    v_lshlrev_b32 v34, 16, v7
    v_and_b32 v35, 0xffff0000, v7
    v_mul_f32_dpp v36, v17, v28 row_newbcast:8 row_mask:0xf bank_mask:0xf
    v_mul_f32_dpp v37, v17, v29 row_newbcast:9 row_mask:0xf bank_mask:0xf
    v_mul_f32_dpp v38, v17, v30 row_newbcast:10 row_mask:0xf bank_mask:0xf
    v_mul_f32_dpp v39, v17, v31 row_newbcast:11 row_mask:0xf bank_mask:0xf
    v_mul_f32_dpp v40, v17, v32 row_newbcast:12 row_mask:0xf bank_mask:0xf
    v_mul_f32_dpp v41, v17, v33 row_newbcast:13 row_mask:0xf bank_mask:0xf
    v_mul_f32_dpp v42, v17, v34 row_newbcast:14 row_mask:0xf bank_mask:0xf
    v_mul_f32_dpp v43, v17, v35 row_newbcast:15 row_mask:0xf bank_mask:0xf
    v_cvt_pk_bf16_f32 v76, v36, v37
    v_cvt_pk_bf16_f32 v77, v38, v39
    v_cvt_pk_bf16_f32 v78, v40, v41
    v_cvt_pk_bf16_f32 v79, v42, v43
    v_mul_f32_dpp v28, v17, v28 row_newbcast:0 row_mask:0xa bank_mask:0xf
    v_mul_f32_dpp v29, v17, v29 row_newbcast:1 row_mask:0xa bank_mask:0xf
    v_mul_f32_dpp v30, v17, v30 row_newbcast:2 row_mask:0xa bank_mask:0xf
    v_mul_f32_dpp v31, v17, v31 row_newbcast:3 row_mask:0xa bank_mask:0xf
    v_mul_f32_dpp v32, v17, v32 row_newbcast:4 row_mask:0xa bank_mask:0xf
    v_mul_f32_dpp v33, v17, v33 row_newbcast:5 row_mask:0xa bank_mask:0xf
    v_mul_f32_dpp v34, v17, v34 row_newbcast:6 row_mask:0xa bank_mask:0xf
    v_mul_f32_dpp v35, v17, v35 row_newbcast:7 row_mask:0xa bank_mask:0xf
    v_cvt_pk_bf16_f32 v72, v28, v29
    v_cvt_pk_bf16_f32 v73, v30, v31
    v_cvt_pk_bf16_f32 v74, v32, v33
    v_cvt_pk_bf16_f32 v75, v34, v35
    s_waitcnt lgkmcnt(3)
    v_lshlrev_b32 v20, 16, v8
    v_and_b32 v21, 0xffff0000, v8
    v_lshlrev_b32 v22, 16, v9
    v_and_b32 v23, 0xffff0000, v9
    v_lshlrev_b32 v24, 16, v10
    v_and_b32 v25, 0xffff0000, v10
    v_lshlrev_b32 v26, 16, v11
    v_and_b32 v27, 0xffff0000, v11
    v_mul_f32_dpp v36, v18, v20 row_newbcast:8 row_mask:0xf bank_mask:0xf
    v_mul_f32_dpp v37, v18, v21 row_newbcast:9 row_mask:0xf bank_mask:0xf
    v_mul_f32_dpp v38, v18, v22 row_newbcast:10 row_mask:0xf bank_mask:0xf
    v_mul_f32_dpp v39, v18, v23 row_newbcast:11 row_mask:0xf bank_mask:0xf
    v_mul_f32_dpp v40, v18, v24 row_newbcast:12 row_mask:0xf bank_mask:0xf
    v_mul_f32_dpp v41, v18, v25 row_newbcast:13 row_mask:0xf bank_mask:0xf
    v_mul_f32_dpp v42, v18, v26 row_newbcast:14 row_mask:0xf bank_mask:0xf
    v_mul_f32_dpp v43, v18, v27 row_newbcast:15 row_mask:0xf bank_mask:0xf
    v_cvt_pk_bf16_f32 v84, v36, v37
    v_cvt_pk_bf16_f32 v85, v38, v39
    v_cvt_pk_bf16_f32 v86, v40, v41
    v_cvt_pk_bf16_f32 v87, v42, v43
    v_mul_f32_dpp v20, v18, v20 row_newbcast:0 row_mask:0xa bank_mask:0xf
    v_mul_f32_dpp v21, v18, v21 row_newbcast:1 row_mask:0xa bank_mask:0xf
    v_mul_f32_dpp v22, v18, v22 row_newbcast:2 row_mask:0xa bank_mask:0xf
    v_mul_f32_dpp v23, v18, v23 row_newbcast:3 row_mask:0xa bank_mask:0xf
    v_mul_f32_dpp v24, v18, v24 row_newbcast:4 row_mask:0xa bank_mask:0xf
    v_mul_f32_dpp v25, v18, v25 row_newbcast:5 row_mask:0xa bank_mask:0xf
    v_mul_f32_dpp v26, v18, v26 row_newbcast:6 row_mask:0xa bank_mask:0xf
    v_mul_f32_dpp v27, v18, v27 row_newbcast:7 row_mask:0xa bank_mask:0xf
    v_cvt_pk_bf16_f32 v80, v20, v21
    v_cvt_pk_bf16_f32 v81, v22, v23
    v_cvt_pk_bf16_f32 v82, v24, v25
    v_cvt_pk_bf16_f32 v83, v26, v27
    s_waitcnt lgkmcnt(0)
    v_lshlrev_b32 v28, 16, v12
    v_and_b32 v29, 0xffff0000, v12
    v_lshlrev_b32 v30, 16, v13
    v_and_b32 v31, 0xffff0000, v13
    v_lshlrev_b32 v32, 16, v14
    v_and_b32 v33, 0xffff0000, v14
    v_lshlrev_b32 v34, 16, v15
    v_and_b32 v35, 0xffff0000, v15
    v_mul_f32_dpp v36, v19, v28 row_newbcast:8 row_mask:0xf bank_mask:0xf
    v_mul_f32_dpp v37, v19, v29 row_newbcast:9 row_mask:0xf bank_mask:0xf
    v_mul_f32_dpp v38, v19, v30 row_newbcast:10 row_mask:0xf bank_mask:0xf
    v_mul_f32_dpp v39, v19, v31 row_newbcast:11 row_mask:0xf bank_mask:0xf
    v_mul_f32_dpp v40, v19, v32 row_newbcast:12 row_mask:0xf bank_mask:0xf
    v_mul_f32_dpp v41, v19, v33 row_newbcast:13 row_mask:0xf bank_mask:0xf
    v_mul_f32_dpp v42, v19, v34 row_newbcast:14 row_mask:0xf bank_mask:0xf
    v_mul_f32_dpp v43, v19, v35 row_newbcast:15 row_mask:0xf bank_mask:0xf
    v_cvt_pk_bf16_f32 v92, v36, v37
    v_cvt_pk_bf16_f32 v93, v38, v39
    v_cvt_pk_bf16_f32 v94, v40, v41
    v_cvt_pk_bf16_f32 v95, v42, v43
    v_mul_f32_dpp v28, v19, v28 row_newbcast:0 row_mask:0xa bank_mask:0xf
    v_mul_f32_dpp v29, v19, v29 row_newbcast:1 row_mask:0xa bank_mask:0xf
    v_mul_f32_dpp v30, v19, v30 row_newbcast:2 row_mask:0xa bank_mask:0xf
    v_mul_f32_dpp v31, v19, v31 row_newbcast:3 row_mask:0xa bank_mask:0xf
    v_mul_f32_dpp v32, v19, v32 row_newbcast:4 row_mask:0xa bank_mask:0xf
    v_mul_f32_dpp v33, v19, v33 row_newbcast:5 row_mask:0xa bank_mask:0xf
    v_mul_f32_dpp v34, v19, v34 row_newbcast:6 row_mask:0xa bank_mask:0xf
    v_mul_f32_dpp v35, v19, v35 row_newbcast:7 row_mask:0xa bank_mask:0xf
    v_cvt_pk_bf16_f32 v88, v28, v29
    v_cvt_pk_bf16_f32 v89, v30, v31
    v_cvt_pk_bf16_f32 v90, v32, v33
    v_cvt_pk_bf16_f32 v91, v34, v35
    s_waitcnt vmcnt(4)
    v_mfma_f32_32x32x16_bf16 v[0:15], v[64:67], v[176:179], 0
    ds_read_b64_tr_b16 v[184:185], v246 offset:2048
    ds_read_b64_tr_b16 v[186:187], v246 offset:3072
    ds_read_b64_tr_b16 v[188:189], v247 offset:2048
    ds_read_b64_tr_b16 v[190:191], v247 offset:3072
    s_mov_b32 m0, s68
    v_mfma_f32_32x32x16_bf16 v[16:31], v[68:71], v[176:179], 0
    buffer_load_dwordx4 v222, s[4:7], s41 offen sc1 lds
    buffer_load_dwordx4 v223, s[72:75], s41 offen offset:1024 sc1 lds
    v_permlane32_swap_b32 v242, v236
    v_permlane32_swap_b32 v243, v237
    s_add_u32 s38, s38, 1
    v_mfma_f32_32x32x16_bf16 v[32:47], v[64:67], v[180:183], 0
    v_permlane32_swap_b32 v244, v238
    v_permlane32_swap_b32 v245, v239
    v_permlane32_swap_b32 v240, v241
    v_add_f32 v242, v242, v236
    v_mfma_f32_32x32x16_bf16 v[48:63], v[68:71], v[180:183], 0
    v_add_f32 v243, v243, v237
    v_add_f32 v244, v244, v238
    v_add_f32 v245, v245, v239
    v_add_f32 v240, -v240, -v241
    v_mov_b32 v254, s52
    v_mov_b32 v255, s38
    s_waitcnt vmcnt(4) lgkmcnt(0)
    v_mfma_f32_32x32x16_bf16 v[0:15], v[72:75], v[184:187], v[0:15]
    ds_read_b64_tr_b16 v[176:177], v246 offset:4096
    ds_read_b64_tr_b16 v[178:179], v246 offset:5120
    ds_read_b64_tr_b16 v[180:181], v247 offset:4096
    ds_read_b64_tr_b16 v[182:183], v247 offset:5120
    s_lshl_b32 s58, s38, 3
    s_add_u32 s58, s58, s20
    s_mov_b32 m0, s69
    v_mfma_f32_32x32x16_bf16 v[16:31], v[76:79], v[184:187], v[16:31]
    buffer_load_dwordx4 v224, s[4:7], s41 offen sc1 lds
    buffer_load_dwordx4 v225, s[72:75], s41 offen offset:1024 sc1 lds
    s_set_gpr_idx_on s32, gpr_idx(DST)
    s_nop 0
    v_cvt_pk_bf16_f32 v195, v242, v243
    v_cvt_pk_bf16_f32 v196, v244, v245
    v_cvt_pk_bf16_f32 v197, v240, v240
    s_set_gpr_idx_off
    s_mov_b64 exec, 1
    ds_write_b32 v254, v255
    s_mov_b64 exec, -1
    s_cmp_lt_u32 s58, s22
    s_cbranch_scc0 K2_dyn_81
K2_back_82:
    v_readlane_b32 s3, v253, s58
    s_lshl_b32 s44, s34, 7
    s_and_b32 s48, s3, 0x3ffff
    s_bfe_u32 s33, s3, 0x30013
    s_mul_i32 s35, s38, 6
    s_cmp_eq_u32 s34, 0
    s_cselect_b32 s35, s35, s48
    s_mov_b32 s45, s44
    s_xor_b32 s47, s44, 256
    s_add_u32 s49, s48, 128
    s_add_u32 s60, s48, 256
    s_cmp_eq_u32 s33, 3
    s_cselect_b32 s46, s44, s47
    s_cselect_b32 s50, s60, s48
    s_cselect_b32 s51, s48, s49
    s_sub_u32 s60, s33, 2
    s_cmp_lt_u32 s60, 2
    s_cbranch_scc0 K2_rare_87
K2_back_88:
    v_mfma_f32_32x32x16_bf16 v[32:47], v[72:75], v[188:191], v[32:47]
    v_add_u32 v233, s48, v230
    ds_read_b32 v232, v233
    ds_read_b32 v233, v233 offset:1024
    v_mfma_f32_32x32x16_bf16 v[48:63], v[76:79], v[188:191], v[48:63]
    s_waitcnt vmcnt(4) lgkmcnt(3)
    v_mfma_f32_32x32x16_bf16 v[0:15], v[80:83], v[176:179], v[0:15]
    ds_read_b64_tr_b16 v[184:185], v246 offset:6144
    ds_read_b64_tr_b16 v[186:187], v246 offset:7168
    ds_read_b64_tr_b16 v[188:189], v247 offset:6144
    ds_read_b64_tr_b16 v[190:191], v247 offset:7168
    s_mov_b32 m0, s70
    v_mfma_f32_32x32x16_bf16 v[16:31], v[84:87], v[176:179], v[16:31]
    buffer_load_dwordx4 v226, s[4:7], s41 offen sc1 lds
    buffer_load_dwordx4 v227, s[72:75], s41 offen offset:1024 sc1 lds
    v_mfma_f32_32x32x16_bf16 v[32:47], v[80:83], v[180:183], v[32:47]
    v_mfma_f32_32x32x16_bf16 v[48:63], v[84:87], v[180:183], v[48:63]
    s_waitcnt lgkmcnt(4)
    v_or_b32 v232, v232, v231
    v_or_b32 v233, v233, v231
    s_cmp_lg_u32 s34, 0
    s_cbranch_scc1 K2_dum_90
    s_cmp_eq_u32 s33, 4
    s_cbranch_scc1 K2_a4_91
K2_b4_93:
    s_add_u32 m0, s48, 512
    s_add_u32 s65, s48, 1536
    buffer_load_dwordx4 v232, s[16:19], 0 offen  lds
    s_mov_b32 m0, s65
    s_mov_b32 exec_hi, 0
    buffer_load_dwordx4 v233, s[16:19], 0 offen  lds
    s_mov_b32 exec_hi, -1
K2_back_92:
    s_waitcnt vmcnt(6) lgkmcnt(0)
    v_mfma_f32_32x32x16_bf16 v[0:15], v[88:91], v[184:187], v[0:15]
    ds_read_b64_tr_b16 v[176:177], v246 offset:0
    ds_read_b64_tr_b16 v[178:179], v246 offset:1024
    ds_read_b64_tr_b16 v[180:181], v247 offset:0
    ds_read_b64_tr_b16 v[182:183], v247 offset:1024
    s_mov_b32 m0, s71
    v_mfma_f32_32x32x16_bf16 v[16:31], v[92:95], v[184:187], v[16:31]
    buffer_load_dwordx4 v228, s[4:7], s41 offen sc1 lds
    buffer_load_dwordx4 v229, s[72:75], s41 offen offset:1024 sc1 lds
    v_mfma_f32_32x32x16_bf16 v[32:47], v[88:91], v[188:191], v[32:47]
    s_nop 2
    v_mul_f32 v234, v0, v96
    v_mul_f32 v236, v8, v128
    v_fmac_f32 v234, v1, v97
    v_fmac_f32 v236, v9, v129
    v_fmac_f32 v234, v2, v98
    v_fmac_f32 v236, v10, v130
    v_fmac_f32 v234, v3, v99
    v_mfma_f32_32x32x16_bf16 v[48:63], v[92:95], v[188:191], v[48:63]
    s_setprio 0
    v_fmac_f32 v236, v11, v131
    v_fmac_f32 v234, v4, v100
    v_fmac_f32 v236, v12, v132
    v_fmac_f32 v234, v5, v101
    v_fmac_f32 v236, v13, v133
    v_fmac_f32 v234, v6, v102
    v_fmac_f32 v236, v14, v134
    v_fmac_f32 v234, v7, v103
    v_fmac_f32 v236, v15, v135
    v_mul_f32 v238, v16, v128
    v_mul_f32 v240, v24, v128
    v_fmac_f32 v238, v17, v129
    v_fmac_f32 v240, v25, v129
    v_fmac_f32 v238, v18, v130
    v_fmac_f32 v240, v26, v130
    v_fmac_f32 v238, v19, v131
    v_fmac_f32 v240, v27, v131
    v_fmac_f32 v238, v20, v132
    v_fmac_f32 v240, v28, v132
    v_fmac_f32 v238, v21, v133
    v_fmac_f32 v240, v29, v133
    v_fmac_f32 v238, v22, v134
    v_fmac_f32 v240, v30, v134
    v_fmac_f32 v238, v23, v135
    v_fmac_f32 v240, v31, v135
    v_mul_f32 v235, v32, v104
    v_mul_f32 v237, v40, v136
    v_fmac_f32 v235, v33, v105
    v_fmac_f32 v237, v41, v137
    v_fmac_f32 v235, v34, v106
    v_fmac_f32 v237, v42, v138
    v_fmac_f32 v235, v35, v107
    v_fmac_f32 v237, v43, v139
    v_fmac_f32 v235, v36, v108
    v_fmac_f32 v237, v44, v140
    v_fmac_f32 v235, v37, v109
    v_fmac_f32 v237, v45, v141
    v_fmac_f32 v235, v38, v110
    v_fmac_f32 v237, v46, v142
    v_fmac_f32 v235, v39, v111
    v_fmac_f32 v237, v47, v143
    v_mul_f32 v239, v48, v136
    v_mul_f32 v241, v56, v136
    s_setprio 1
    s_waitcnt vmcnt(6) lgkmcnt(0)
    v_mfma_f32_32x32x16_bf16 v[0:15], v[64:67], v[176:179], 0
    ds_read_b64_tr_b16 v[184:185], v246 offset:2048
    ds_read_b64_tr_b16 v[186:187], v246 offset:3072
    ds_read_b64_tr_b16 v[188:189], v247 offset:2048
    ds_read_b64_tr_b16 v[190:191], v247 offset:3072
    v_fmac_f32 v239, v49, v137
    v_fmac_f32 v241, v57, v137
    s_mov_b32 m0, s68
    v_mfma_f32_32x32x16_bf16 v[16:31], v[68:71], v[176:179], 0
    buffer_load_dwordx4 v222, s[4:7], s42 offen sc1 lds
    buffer_load_dwordx4 v223, s[72:75], s42 offen offset:1024 sc1 lds
    v_fmac_f32 v239, v50, v138
    v_fmac_f32 v241, v58, v138
    v_fmac_f32 v239, v51, v139
    v_fmac_f32 v241, v59, v139
    v_fmac_f32 v239, v52, v140
    v_mfma_f32_32x32x16_bf16 v[32:47], v[64:67], v[180:183], 0
    v_fmac_f32 v241, v60, v140
    v_fmac_f32 v239, v53, v141
    v_fmac_f32 v241, v61, v141
    v_fmac_f32 v239, v54, v142
    v_fmac_f32 v241, v62, v142
    v_fmac_f32 v239, v55, v143
    v_fmac_f32 v241, v63, v143
    v_mfma_f32_32x32x16_bf16 v[48:63], v[68:71], v[180:183], 0
    v_permlane32_swap_b32 v234, v236
    v_permlane32_swap_b32 v235, v237
    v_permlane32_swap_b32 v240, v238
    s_waitcnt vmcnt(6) lgkmcnt(0)
    v_mfma_f32_32x32x16_bf16 v[0:15], v[72:75], v[184:187], v[0:15]
    ds_read_b64_tr_b16 v[176:177], v246 offset:4096
    ds_read_b64_tr_b16 v[178:179], v246 offset:5120
    ds_read_b64_tr_b16 v[180:181], v247 offset:4096
    ds_read_b64_tr_b16 v[182:183], v247 offset:5120
    v_permlane32_swap_b32 v241, v239
    s_mov_b32 m0, s69
    v_mfma_f32_32x32x16_bf16 v[16:31], v[76:79], v[184:187], v[16:31]
    buffer_load_dwordx4 v224, s[4:7], s42 offen sc1 lds
    buffer_load_dwordx4 v225, s[72:75], s42 offen offset:1024 sc1 lds
    v_add_f32 v234, v234, v236
    v_add_f32 v235, v235, v237
    v_add_f32 v240, v240, v238
    v_add_f32 v241, v241, v239
    v_mfma_f32_32x32x16_bf16 v[32:47], v[72:75], v[188:191], v[32:47]
    s_set_gpr_idx_on s31, gpr_idx(DST)
    s_nop 0
    v_cvt_pk_bf16_f32 v192, v234, v235
    v_cvt_pk_bf16_f32 v193, v240, v241
    s_set_gpr_idx_off
    v_mfma_f32_32x32x16_bf16 v[48:63], v[76:79], v[188:191], v[48:63]
    s_waitcnt vmcnt(4) lgkmcnt(0)
    v_mfma_f32_32x32x16_bf16 v[0:15], v[80:83], v[176:179], v[0:15]
    ds_read_b64_tr_b16 v[184:185], v246 offset:6144
    ds_read_b64_tr_b16 v[186:187], v246 offset:7168
    ds_read_b64_tr_b16 v[188:189], v247 offset:6144
    ds_read_b64_tr_b16 v[190:191], v247 offset:7168
    s_mov_b32 m0, s70
    v_mfma_f32_32x32x16_bf16 v[16:31], v[84:87], v[176:179], v[16:31]
    buffer_load_dwordx4 v226, s[4:7], s42 offen sc1 lds
    buffer_load_dwordx4 v227, s[72:75], s42 offen offset:1024 sc1 lds
    v_mfma_f32_32x32x16_bf16 v[32:47], v[80:83], v[180:183], v[32:47]
    v_mfma_f32_32x32x16_bf16 v[48:63], v[84:87], v[180:183], v[48:63]
    s_waitcnt vmcnt(4) lgkmcnt(0)
    v_mfma_f32_32x32x16_bf16 v[0:15], v[88:91], v[184:187], v[0:15]
    ds_read_b64_tr_b16 v[176:177], v246 offset:0
    ds_read_b64_tr_b16 v[178:179], v246 offset:1024
    ds_read_b64_tr_b16 v[180:181], v247 offset:0
    ds_read_b64_tr_b16 v[182:183], v247 offset:1024
    s_mov_b32 m0, s71
    v_mfma_f32_32x32x16_bf16 v[16:31], v[92:95], v[184:187], v[16:31]
    buffer_load_dwordx4 v228, s[4:7], s42 offen sc1 lds
    buffer_load_dwordx4 v229, s[72:75], s42 offen offset:1024 sc1 lds
    v_mfma_f32_32x32x16_bf16 v[32:47], v[88:91], v[188:191], v[32:47]
    s_nop 2
    v_mul_f32 v234, v0, v144
    v_mul_f32 v236, v8, v112
    v_fmac_f32 v234, v1, v145
    v_fmac_f32 v236, v9, v113
    v_fmac_f32 v234, v2, v146
    v_fmac_f32 v236, v10, v114
    v_fmac_f32 v234, v3, v147
    v_mfma_f32_32x32x16_bf16 v[48:63], v[92:95], v[188:191], v[48:63]
    s_setprio 0
    v_fmac_f32 v236, v11, v115
    v_fmac_f32 v234, v4, v148
    v_fmac_f32 v236, v12, v116
    v_fmac_f32 v234, v5, v149
    v_fmac_f32 v236, v13, v117
    v_fmac_f32 v234, v6, v150
    v_fmac_f32 v236, v14, v118
    v_fmac_f32 v234, v7, v151
    v_fmac_f32 v236, v15, v119
    v_mul_f32 v238, v16, v160
    v_mul_f32 v240, v24, v160
    v_fmac_f32 v238, v17, v161
    v_fmac_f32 v240, v25, v161
    v_fmac_f32 v238, v18, v162
    v_fmac_f32 v240, v26, v162
    v_fmac_f32 v238, v19, v163
    v_fmac_f32 v240, v27, v163
    v_fmac_f32 v238, v20, v164
    v_fmac_f32 v240, v28, v164
    v_fmac_f32 v238, v21, v165
    v_fmac_f32 v240, v29, v165
    v_fmac_f32 v238, v22, v166
    v_fmac_f32 v240, v30, v166
    v_fmac_f32 v238, v23, v167
    v_fmac_f32 v240, v31, v167
    v_mul_f32 v235, v32, v152
    v_mul_f32 v237, v40, v120
    v_fmac_f32 v235, v33, v153
    v_fmac_f32 v237, v41, v121
    v_fmac_f32 v235, v34, v154
    v_fmac_f32 v237, v42, v122
    v_fmac_f32 v235, v35, v155
    v_fmac_f32 v237, v43, v123
    v_fmac_f32 v235, v36, v156
    v_fmac_f32 v237, v44, v124
    v_fmac_f32 v235, v37, v157
    v_fmac_f32 v237, v45, v125
    v_fmac_f32 v235, v38, v158
    v_fmac_f32 v237, v46, v126
    v_fmac_f32 v235, v39, v159
    v_fmac_f32 v237, v47, v127
    v_mul_f32 v239, v48, v168
    v_mul_f32 v241, v56, v168
    s_setprio 1
    s_waitcnt vmcnt(4) lgkmcnt(0)
    v_mfma_f32_32x32x16_bf16 v[0:15], v[64:67], v[176:179], 0
    ds_read_b64_tr_b16 v[184:185], v246 offset:2048
    ds_read_b64_tr_b16 v[186:187], v246 offset:3072
    ds_read_b64_tr_b16 v[188:189], v247 offset:2048
    ds_read_b64_tr_b16 v[190:191], v247 offset:3072
    v_fmac_f32 v239, v49, v169
    v_fmac_f32 v241, v57, v169
    s_mov_b32 m0, s68
    v_mfma_f32_32x32x16_bf16 v[16:31], v[68:71], v[176:179], 0
    buffer_load_dwordx4 v222, s[4:7], s43 offen sc1 lds
    buffer_load_dwordx4 v223, s[72:75], s43 offen offset:1024 sc1 lds
    v_fmac_f32 v239, v50, v170
    v_fmac_f32 v241, v58, v170
    v_fmac_f32 v239, v51, v171
    v_fmac_f32 v241, v59, v171
    v_fmac_f32 v239, v52, v172
    v_mfma_f32_32x32x16_bf16 v[32:47], v[64:67], v[180:183], 0
    v_fmac_f32 v241, v60, v172
    v_fmac_f32 v239, v53, v173
    v_fmac_f32 v241, v61, v173
    v_fmac_f32 v239, v54, v174
    v_fmac_f32 v241, v62, v174
    v_fmac_f32 v239, v55, v175
    v_fmac_f32 v241, v63, v175
    v_mfma_f32_32x32x16_bf16 v[48:63], v[68:71], v[180:183], 0
    s_waitcnt vmcnt(4) lgkmcnt(0)
    v_mfma_f32_32x32x16_bf16 v[0:15], v[72:75], v[184:187], v[0:15]
    ds_read_b64_tr_b16 v[176:177], v246 offset:4096
    ds_read_b64_tr_b16 v[178:179], v246 offset:5120
    ds_read_b64_tr_b16 v[180:181], v247 offset:4096
    ds_read_b64_tr_b16 v[182:183], v247 offset:5120
    s_mov_b32 m0, s69
    v_mfma_f32_32x32x16_bf16 v[16:31], v[76:79], v[184:187], v[16:31]
    buffer_load_dwordx4 v224, s[4:7], s43 offen sc1 lds
    buffer_load_dwordx4 v225, s[72:75], s43 offen offset:1024 sc1 lds
    v_mfma_f32_32x32x16_bf16 v[32:47], v[72:75], v[188:191], v[32:47]
    v_mfma_f32_32x32x16_bf16 v[48:63], v[76:79], v[188:191], v[48:63]
    s_waitcnt vmcnt(4) lgkmcnt(0)
    v_mfma_f32_32x32x16_bf16 v[0:15], v[80:83], v[176:179], v[0:15]
    ds_read_b64_tr_b16 v[184:185], v246 offset:6144
    ds_read_b64_tr_b16 v[186:187], v246 offset:7168
    ds_read_b64_tr_b16 v[188:189], v247 offset:6144
    ds_read_b64_tr_b16 v[190:191], v247 offset:7168
    s_mov_b32 m0, s70
    v_mfma_f32_32x32x16_bf16 v[16:31], v[84:87], v[176:179], v[16:31]
    buffer_load_dwordx4 v226, s[4:7], s43 offen sc1 lds
    buffer_load_dwordx4 v227, s[72:75], s43 offen offset:1024 sc1 lds
    v_mfma_f32_32x32x16_bf16 v[32:47], v[80:83], v[180:183], v[32:47]
    v_add_u32 v222, s48, v251
    ds_read2_b32 v[222:223], v222 offset0:1 offset1:3
    v_mfma_f32_32x32x16_bf16 v[48:63], v[84:87], v[180:183], v[48:63]
    s_waitcnt vmcnt(4) lgkmcnt(1)
    v_mfma_f32_32x32x16_bf16 v[0:15], v[88:91], v[184:187], v[0:15]
    ds_read_b64_tr_b16 v[176:177], v246 offset:0
    ds_read_b64_tr_b16 v[178:179], v246 offset:1024
    ds_read_b64_tr_b16 v[180:181], v247 offset:0
    ds_read_b64_tr_b16 v[182:183], v247 offset:1024
    s_mov_b32 m0, s71
    v_mfma_f32_32x32x16_bf16 v[16:31], v[92:95], v[184:187], v[16:31]
    buffer_load_dwordx4 v228, s[4:7], s43 offen sc1 lds
    buffer_load_dwordx4 v229, s[72:75], s43 offen offset:1024 sc1 lds
    s_waitcnt lgkmcnt(4)
    v_mad_u32_u16 v222, v222, s39, v248 op_sel:[1,0,0,0]
    v_mad_u32_u16 v223, v223, s39, v248 op_sel:[1,0,0,0]
    v_mfma_f32_32x32x16_bf16 v[32:47], v[88:91], v[188:191], v[32:47]
    v_add_u32 v224, s49, v251
    ds_read2_b32 v[224:225], v224 offset0:1 offset1:3
    v_mul_f32 v242, v0, v144
    v_fma_f32 v238, v8, v160, -v238
    v_fmac_f32 v242, v1, v145
    v_fmac_f32 v238, v9, v161
    v_fmac_f32 v242, v2, v146
    v_mfma_f32_32x32x16_bf16 v[48:63], v[92:95], v[188:191], v[48:63]
    s_setprio 0
    v_fmac_f32 v238, v10, v162
    v_fmac_f32 v242, v3, v147
    v_fmac_f32 v238, v11, v163
    v_fmac_f32 v242, v4, v148
    v_fmac_f32 v238, v12, v164
    v_fmac_f32 v242, v5, v149
    v_fmac_f32 v238, v13, v165
    v_fmac_f32 v242, v6, v150
    v_fmac_f32 v238, v14, v166
    v_fmac_f32 v242, v7, v151
    v_fmac_f32 v238, v15, v167
    v_fmac_f32 v236, v16, v112
    v_mul_f32 v244, v24, v160
    v_fmac_f32 v236, v17, v113
    v_fmac_f32 v244, v25, v161
    v_fmac_f32 v236, v18, v114
    v_fmac_f32 v244, v26, v162
    v_fmac_f32 v236, v19, v115
    v_fmac_f32 v244, v27, v163
    v_fmac_f32 v236, v20, v116
    v_fmac_f32 v244, v28, v164
    v_fmac_f32 v236, v21, v117
    v_fmac_f32 v244, v29, v165
    v_fmac_f32 v236, v22, v118
    v_fmac_f32 v244, v30, v166
    v_fmac_f32 v236, v23, v119
    v_fmac_f32 v244, v31, v167
    v_mul_f32 v243, v32, v152
    v_fma_f32 v239, v40, v168, -v239
    v_fmac_f32 v243, v33, v153
    v_fmac_f32 v239, v41, v169
    v_fmac_f32 v243, v34, v154
    v_fmac_f32 v239, v42, v170
    v_fmac_f32 v243, v35, v155
    v_fmac_f32 v239, v43, v171
    v_fmac_f32 v243, v36, v156
    v_fmac_f32 v239, v44, v172
    v_fmac_f32 v243, v37, v157
    v_fmac_f32 v239, v45, v173
    v_fmac_f32 v243, v38, v158
    v_fmac_f32 v239, v46, v174
    v_fmac_f32 v243, v39, v159
    v_fmac_f32 v239, v47, v175
    v_fmac_f32 v237, v48, v120
    v_mul_f32 v245, v56, v168
    v_fmac_f32 v237, v49, v121
    v_fmac_f32 v245, v57, v169
    v_fmac_f32 v237, v50, v122
    v_fmac_f32 v245, v58, v170
    v_fmac_f32 v237, v51, v123
    s_setprio 1
    s_waitcnt vmcnt(4) lgkmcnt(1)
    v_mfma_f32_32x32x16_bf16 v[0:15], v[64:67], v[176:179], 0
    ds_read_b64_tr_b16 v[184:185], v246 offset:2048
    ds_read_b64_tr_b16 v[186:187], v246 offset:3072
    ds_read_b64_tr_b16 v[188:189], v247 offset:2048
    ds_read_b64_tr_b16 v[190:191], v247 offset:3072
    v_fmac_f32 v245, v59, v171
    v_fmac_f32 v237, v52, v124
    s_mov_b32 m0, s68
    v_mfma_f32_32x32x16_bf16 v[16:31], v[68:71], v[176:179], 0
    buffer_load_dwordx4 v222, s[4:7], s44 offen sc1 lds
    buffer_load_dwordx4 v223, s[72:75], s44 offen offset:1024 sc1 lds
    s_waitcnt lgkmcnt(4)
    v_mad_u32_u16 v224, v224, s39, v248 op_sel:[1,0,0,0]
    v_mad_u32_u16 v225, v225, s39, v248 op_sel:[1,0,0,0]
    v_fmac_f32 v245, v60, v172
    v_fmac_f32 v237, v53, v125
    v_mfma_f32_32x32x16_bf16 v[32:47], v[64:67], v[180:183], 0
    v_add_u32 v226, s50, v251
    ds_read2_b32 v[226:227], v226 offset0:1 offset1:3
    v_fmac_f32 v245, v61, v173
    v_fmac_f32 v237, v54, v126
    v_fmac_f32 v245, v62, v174
    v_fmac_f32 v237, v55, v127
    v_fmac_f32 v245, v63, v175
    v_mfma_f32_32x32x16_bf16 v[48:63], v[68:71], v[180:183], 0
    v_permlane32_swap_b32 v242, v234
    v_permlane32_swap_b32 v243, v235
    v_add_f32 v242, v242, v234
    v_add_f32 v243, v243, v235
    s_waitcnt vmcnt(4) lgkmcnt(1)
    v_mfma_f32_32x32x16_bf16 v[0:15], v[72:75], v[184:187], v[0:15]
    ds_read_b64_tr_b16 v[176:177], v246 offset:4096
    ds_read_b64_tr_b16 v[178:179], v246 offset:5120
    ds_read_b64_tr_b16 v[180:181], v247 offset:4096
    ds_read_b64_tr_b16 v[182:183], v247 offset:5120
    s_mov_b32 m0, s69
    v_mfma_f32_32x32x16_bf16 v[16:31], v[76:79], v[184:187], v[16:31]
    buffer_load_dwordx4 v224, s[4:7], s45 offen sc1 lds
    buffer_load_dwordx4 v225, s[72:75], s45 offen offset:1024 sc1 lds
    s_waitcnt lgkmcnt(4)
    v_mad_u32_u16 v226, v226, s39, v248 op_sel:[1,0,0,0]
    v_mad_u32_u16 v227, v227, s39, v248 op_sel:[1,0,0,0]
    v_mfma_f32_32x32x16_bf16 v[32:47], v[72:75], v[188:191], v[32:47]
    v_add_u32 v228, s51, v251
    ds_read2_b32 v[228:229], v228 offset0:1 offset1:3
    s_set_gpr_idx_on s31, gpr_idx(DST)
    s_nop 0
    v_cvt_pk_bf16_f32 v194, v242, v243
    s_set_gpr_idx_off
    v_mfma_f32_32x32x16_bf16 v[48:63], v[76:79], v[188:191], v[48:63]
    s_waitcnt vmcnt(4) lgkmcnt(1)
    v_mfma_f32_32x32x16_bf16 v[0:15], v[80:83], v[176:179], v[0:15]
    ds_read_b64_tr_b16 v[184:185], v246 offset:6144
    ds_read_b64_tr_b16 v[186:187], v246 offset:7168
    ds_read_b64_tr_b16 v[188:189], v247 offset:6144
    ds_read_b64_tr_b16 v[190:191], v247 offset:7168
    s_mov_b32 s32, s31
    s_mov_b32 s31, s35
    s_mov_b32 m0, s70
    v_mfma_f32_32x32x16_bf16 v[16:31], v[84:87], v[176:179], v[16:31]
    buffer_load_dwordx4 v226, s[4:7], s46 offen sc1 lds
    buffer_load_dwordx4 v227, s[72:75], s46 offen offset:1024 sc1 lds
    s_waitcnt lgkmcnt(4)
    v_mad_u32_u16 v228, v228, s39, v248 op_sel:[1,0,0,0]
    v_mad_u32_u16 v229, v229, s39, v248 op_sel:[1,0,0,0]
    s_sub_u32 s26, s48, s29
    s_mov_b32 s29, s48
    v_mfma_f32_32x32x16_bf16 v[32:47], v[80:83], v[180:183], v[32:47]
    s_mov_b32 s30, s3
    s_bfe_u32 s56, s3, 0x40012
    s_cmp_eq_u32 s34, 0
    s_cselect_b32 s56, s56, 0
    v_mfma_f32_32x32x16_bf16 v[48:63], v[84:87], v[180:183], v[48:63]
    s_waitcnt vmcnt(4) lgkmcnt(0)
    v_mfma_f32_32x32x16_bf16 v[0:15], v[88:91], v[184:187], v[0:15]
    ds_read_b64_tr_b16 v[176:177], v246 offset:0
    ds_read_b64_tr_b16 v[178:179], v246 offset:1024
    ds_read_b64_tr_b16 v[180:181], v247 offset:0
    ds_read_b64_tr_b16 v[182:183], v247 offset:1024
    s_mov_b32 m0, s71
    v_mfma_f32_32x32x16_bf16 v[16:31], v[92:95], v[184:187], v[16:31]
    buffer_load_dwordx4 v228, s[4:7], s47 offen sc1 lds
    buffer_load_dwordx4 v229, s[72:75], s47 offen offset:1024 sc1 lds
    v_mfma_f32_32x32x16_bf16 v[32:47], v[88:91], v[188:191], v[32:47]
    s_nop 2
    v_mul_f32 v242, v0, v144
    v_fma_f32 v240, v8, v160, -v240
    v_fmac_f32 v242, v1, v145
    v_fmac_f32 v240, v9, v161
    v_fmac_f32 v242, v2, v146
    v_fmac_f32 v240, v10, v162
    v_fmac_f32 v242, v3, v147
    v_mfma_f32_32x32x16_bf16 v[48:63], v[92:95], v[188:191], v[48:63]
    s_setprio 0
    v_fmac_f32 v240, v11, v163
    v_fmac_f32 v242, v4, v148
    v_fmac_f32 v240, v12, v164
    v_fmac_f32 v242, v5, v149
    v_fmac_f32 v240, v13, v165
    v_fmac_f32 v242, v6, v150
    v_fmac_f32 v240, v14, v166
    v_fmac_f32 v242, v7, v151
    v_fmac_f32 v240, v15, v167
    v_add_u32 v249, s26, v249
    v_add_u32 v250, s26, v250
    v_fma_f32 v244, v16, v160, -v244
    v_fmac_f32 v236, v24, v112
    v_fmac_f32 v244, v17, v161
    v_fmac_f32 v236, v25, v113
    v_fmac_f32 v244, v18, v162
    v_fmac_f32 v236, v26, v114
    v_fmac_f32 v244, v19, v163
    v_fmac_f32 v236, v27, v115
    v_fmac_f32 v244, v20, v164
    v_fmac_f32 v236, v28, v116
    v_fmac_f32 v244, v21, v165
    v_fmac_f32 v236, v29, v117
    v_fmac_f32 v244, v22, v166
    v_fmac_f32 v236, v30, v118
    v_fmac_f32 v244, v23, v167
    v_fmac_f32 v236, v31, v119
    ds_read_b64_tr_b16 v[0:1], v249 offset:0
    ds_read_b64_tr_b16 v[2:3], v249 offset:32
    ds_read_u16_d16_hi v16, v250 offset:0
    v_mul_f32 v243, v32, v152
    v_fma_f32 v241, v40, v168, -v241
    v_fmac_f32 v243, v33, v153
    v_fmac_f32 v241, v41, v169
    v_fmac_f32 v243, v34, v154
    v_fmac_f32 v241, v42, v170
    v_fmac_f32 v243, v35, v155
    v_fmac_f32 v241, v43, v171
    v_fmac_f32 v243, v36, v156
    v_fmac_f32 v241, v44, v172
    v_fmac_f32 v243, v37, v157
    v_fmac_f32 v241, v45, v173
    v_fmac_f32 v243, v38, v158
    v_fmac_f32 v241, v46, v174
    v_fmac_f32 v243, v39, v159
    v_fmac_f32 v241, v47, v175
    ds_read_b64_tr_b16 v[4:5], v249 offset:512
    ds_read_b64_tr_b16 v[6:7], v249 offset:544
    ds_read_u16_d16_hi v17, v250 offset:128
    v_fma_f32 v245, v48, v168, -v245
    v_fmac_f32 v237, v56, v120
    v_fmac_f32 v245, v49, v169
    v_fmac_f32 v237, v57, v121
    v_fmac_f32 v245, v50, v170
    v_fmac_f32 v237, v58, v122
    v_fmac_f32 v245, v51, v171
    v_fmac_f32 v237, v59, v123
    v_fmac_f32 v245, v52, v172
    v_fmac_f32 v237, v60, v124
    v_fmac_f32 v245, v53, v173
    v_fmac_f32 v237, v61, v125
    v_fmac_f32 v245, v54, v174
    v_fmac_f32 v237, v62, v126
    v_fmac_f32 v245, v55, v175
    v_fmac_f32 v237, v63, v127
    s_cmp_eq_u32 s56, 5
    s_cbranch_scc1 K2_U20
    s_cmp_eq_u32 s56, 6
    s_cbranch_scc1 K2_U3h0
    s_branch K2_DSP0
K2_U11:
    s_setprio 1
    v_mov_b32 v254, 163296
    v_mov_b32 v255, 1
    v_lshl_add_u32 v233, v252, 1, s53
    s_mov_b64 exec, 1
    ds_add_rtn_u32 v232, v254, v255
    s_mov_b64 exec, -1
    ds_read_b32 v233, v233
    s_waitcnt lgkmcnt(5)
    v_lshlrev_b32 v20, 16, v0
    v_and_b32 v21, 0xffff0000, v0
    v_lshlrev_b32 v22, 16, v1
    v_and_b32 v23, 0xffff0000, v1
    v_lshlrev_b32 v24, 16, v2
    v_and_b32 v25, 0xffff0000, v2
    v_lshlrev_b32 v26, 16, v3
    v_and_b32 v27, 0xffff0000, v3
    v_mul_f32_dpp v36, v16, v20 row_newbcast:8 row_mask:0xf bank_mask:0xf
    v_mul_f32_dpp v37, v16, v21 row_newbcast:9 row_mask:0xf bank_mask:0xf
    v_mul_f32_dpp v38, v16, v22 row_newbcast:10 row_mask:0xf bank_mask:0xf
    v_mul_f32_dpp v39, v16, v23 row_newbcast:11 row_mask:0xf bank_mask:0xf
    v_mul_f32_dpp v40, v16, v24 row_newbcast:12 row_mask:0xf bank_mask:0xf
    v_mul_f32_dpp v41, v16, v25 row_newbcast:13 row_mask:0xf bank_mask:0xf
    v_mul_f32_dpp v42, v16, v26 row_newbcast:14 row_mask:0xf bank_mask:0xf
    v_mul_f32_dpp v43, v16, v27 row_newbcast:15 row_mask:0xf bank_mask:0xf
    v_cvt_pk_bf16_f32 v68, v36, v37
    v_cvt_pk_bf16_f32 v69, v38, v39
    v_cvt_pk_bf16_f32 v70, v40, v41
    v_cvt_pk_bf16_f32 v71, v42, v43
    v_mul_f32_dpp v20, v16, v20 row_newbcast:0 row_mask:0xa bank_mask:0xf
    v_mul_f32_dpp v21, v16, v21 row_newbcast:1 row_mask:0xa bank_mask:0xf
    v_mul_f32_dpp v22, v16, v22 row_newbcast:2 row_mask:0xa bank_mask:0xf
    v_mul_f32_dpp v23, v16, v23 row_newbcast:3 row_mask:0xa bank_mask:0xf
    v_mul_f32_dpp v24, v16, v24 row_newbcast:4 row_mask:0xa bank_mask:0xf
    v_mul_f32_dpp v25, v16, v25 row_newbcast:5 row_mask:0xa bank_mask:0xf
    v_mul_f32_dpp v26, v16, v26 row_newbcast:6 row_mask:0xa bank_mask:0xf
    v_mul_f32_dpp v27, v16, v27 row_newbcast:7 row_mask:0xa bank_mask:0xf
    v_cvt_pk_bf16_f32 v64, v20, v21
    v_cvt_pk_bf16_f32 v65, v22, v23
    v_cvt_pk_bf16_f32 v66, v24, v25
    v_cvt_pk_bf16_f32 v67, v26, v27
    s_waitcnt lgkmcnt(0)
    v_readfirstlane_b32 s58, v232
    s_nop 0
    s_cmp_lt_u32 s58, s22
    s_cbranch_scc0 K2_nul_94
    s_and_b32 s59, s58, 7
    s_lshr_b32 s60, s58, 3
K2_chk_96:
    v_readlane_b32 s61, v233, s59
    s_nop 0
    s_cmp_gt_u32 s61, s60
    s_cbranch_scc0 K2_spin_95
K2_back_97:
    v_readlane_b32 s3, v253, s58
    s_lshl_b32 s44, s34, 7
    s_and_b32 s48, s3, 0x3ffff
    s_bfe_u32 s33, s3, 0x30013
    s_mov_b32 s35, s48
    s_mov_b32 s45, s44
    s_xor_b32 s47, s44, 256
    s_add_u32 s49, s48, 128
    s_add_u32 s60, s48, 256
    s_cmp_eq_u32 s33, 3
    s_cselect_b32 s46, s44, s47
    s_cselect_b32 s50, s60, s48
    s_cselect_b32 s51, s48, s49
    s_sub_u32 s60, s33, 2
    s_cmp_lt_u32 s60, 2
    s_cbranch_scc0 K2_rare_98
K2_back_99:
    v_add_u32 v222, s48, v251
    ds_read2_b32 v[222:223], v222 offset0:1 offset1:3
    v_add_u32 v224, s49, v251
    ds_read2_b32 v[224:225], v224 offset0:1 offset1:3
    v_add_u32 v226, s50, v251
    ds_read2_b32 v[226:227], v226 offset0:1 offset1:3
    v_add_u32 v228, s51, v251
    ds_read2_b32 v[228:229], v228 offset0:1 offset1:3
    s_waitcnt lgkmcnt(3)
    v_mad_u32_u16 v222, v222, s39, v248 op_sel:[1,0,0,0]
    v_mad_u32_u16 v223, v223, s39, v248 op_sel:[1,0,0,0]
    s_waitcnt lgkmcnt(2)
    v_mad_u32_u16 v224, v224, s39, v248 op_sel:[1,0,0,0]
    v_mad_u32_u16 v225, v225, s39, v248 op_sel:[1,0,0,0]
    s_waitcnt lgkmcnt(1)
    v_mad_u32_u16 v226, v226, s39, v248 op_sel:[1,0,0,0]
    v_mad_u32_u16 v227, v227, s39, v248 op_sel:[1,0,0,0]
    s_waitcnt lgkmcnt(0)
    v_mad_u32_u16 v228, v228, s39, v248 op_sel:[1,0,0,0]
    v_mad_u32_u16 v229, v229, s39, v248 op_sel:[1,0,0,0]
    s_waitcnt vmcnt(4)
    v_mfma_f32_32x32x16_bf16 v[0:15], v[64:67], v[176:179], 0
    ds_read_b64_tr_b16 v[184:185], v246 offset:2048
    ds_read_b64_tr_b16 v[186:187], v246 offset:3072
    ds_read_b64_tr_b16 v[188:189], v247 offset:2048
    ds_read_b64_tr_b16 v[190:191], v247 offset:3072
    s_mov_b32 m0, s68
    v_mfma_f32_32x32x16_bf16 v[16:31], v[68:71], v[176:179], 0
    buffer_load_dwordx4 v222, s[4:7], s44 offen sc1 lds
    buffer_load_dwordx4 v223, s[72:75], s44 offen offset:1024 sc1 lds
    v_permlane32_swap_b32 v242, v236
    v_permlane32_swap_b32 v243, v237
    v_mfma_f32_32x32x16_bf16 v[32:47], v[64:67], v[180:183], 0
    v_permlane32_swap_b32 v244, v238
    v_permlane32_swap_b32 v245, v239
    v_permlane32_swap_b32 v240, v241
    v_add_f32 v242, v242, v236
    v_mfma_f32_32x32x16_bf16 v[48:63], v[68:71], v[180:183], 0
    s_setprio 0
    v_add_f32 v243, v243, v237
    v_add_f32 v244, v244, v238
    v_add_f32 v245, v245, v239
    v_add_f32 v240, -v240, -v241
    v_sub_u32 v241, v230, v231
    v_cvt_pk_bf16_f32 v242, v242, v243
    v_cvt_pk_bf16_f32 v244, v244, v245
    v_cvt_pk_bf16_f32 v240, v240, v240
    ds_write_b32 v230, v242 offset:768
    ds_write_b32 v230, v244 offset:1024
    ds_write_b16 v241, v240 offset:1280
    v_mul_f32 v234, v0, v96
    v_mul_f32 v236, v8, v128
    v_fmac_f32 v234, v1, v97
    v_fmac_f32 v236, v9, v129
    v_fmac_f32 v234, v2, v98
    v_fmac_f32 v236, v10, v130
    v_fmac_f32 v234, v3, v99
    v_fmac_f32 v236, v11, v131
    v_fmac_f32 v234, v4, v100
    v_fmac_f32 v236, v12, v132
    v_fmac_f32 v234, v5, v101
    v_fmac_f32 v236, v13, v133
    v_fmac_f32 v234, v6, v102
    v_fmac_f32 v236, v14, v134
    v_fmac_f32 v234, v7, v103
    v_fmac_f32 v236, v15, v135
    v_mul_f32 v238, v16, v128
    v_mul_f32 v240, v24, v128
    v_fmac_f32 v238, v17, v129
    v_fmac_f32 v240, v25, v129
    v_fmac_f32 v238, v18, v130
    v_fmac_f32 v240, v26, v130
    v_fmac_f32 v238, v19, v131
    v_fmac_f32 v240, v27, v131
    v_fmac_f32 v238, v20, v132
    v_fmac_f32 v240, v28, v132
    v_fmac_f32 v238, v21, v133
    v_fmac_f32 v240, v29, v133
    v_fmac_f32 v238, v22, v134
    v_fmac_f32 v240, v30, v134
    v_fmac_f32 v238, v23, v135
    v_fmac_f32 v240, v31, v135
    v_mul_f32 v235, v32, v104
    v_mul_f32 v237, v40, v136
    v_fmac_f32 v235, v33, v105
    v_fmac_f32 v237, v41, v137
    v_fmac_f32 v235, v34, v106
    v_fmac_f32 v237, v42, v138
    v_fmac_f32 v235, v35, v107
    v_fmac_f32 v237, v43, v139
    v_fmac_f32 v235, v36, v108
    v_fmac_f32 v237, v44, v140
    v_fmac_f32 v235, v37, v109
    v_fmac_f32 v237, v45, v141
    v_fmac_f32 v235, v38, v110
    v_fmac_f32 v237, v46, v142
    v_fmac_f32 v235, v39, v111
    v_fmac_f32 v237, v47, v143
    v_mul_f32 v239, v48, v136
    v_mul_f32 v241, v56, v136
    v_fmac_f32 v239, v49, v137
    v_fmac_f32 v241, v57, v137
    v_fmac_f32 v239, v50, v138
    v_fmac_f32 v241, v58, v138
    v_fmac_f32 v239, v51, v139
    v_fmac_f32 v241, v59, v139
    v_fmac_f32 v239, v52, v140
    v_fmac_f32 v241, v60, v140
    v_fmac_f32 v239, v53, v141
    v_fmac_f32 v241, v61, v141
    v_fmac_f32 v239, v54, v142
    v_fmac_f32 v241, v62, v142
    v_fmac_f32 v239, v55, v143
    v_fmac_f32 v241, v63, v143
    s_setprio 1
    s_waitcnt vmcnt(4) lgkmcnt(3)
    v_mfma_f32_32x32x16_bf16 v[0:15], v[64:67], v[184:187], 0
    ds_read_b64_tr_b16 v[176:177], v246 offset:4096
    ds_read_b64_tr_b16 v[178:179], v246 offset:5120
    ds_read_b64_tr_b16 v[180:181], v247 offset:4096
    ds_read_b64_tr_b16 v[182:183], v247 offset:5120
    s_mov_b32 m0, s69
    v_mfma_f32_32x32x16_bf16 v[16:31], v[68:71], v[184:187], 0
    buffer_load_dwordx4 v224, s[4:7], s45 offen sc1 lds
    buffer_load_dwordx4 v225, s[72:75], s45 offen offset:1024 sc1 lds
    v_permlane32_swap_b32 v234, v236
    v_permlane32_swap_b32 v235, v237
    v_mfma_f32_32x32x16_bf16 v[32:47], v[64:67], v[188:191], 0
    v_permlane32_swap_b32 v240, v238
    v_permlane32_swap_b32 v241, v239
    v_lshl_add_u32 v230, v252, 1, s31
    v_add_f32 v234, v234, v236
    v_add_f32 v235, v235, v237
    v_mfma_f32_32x32x16_bf16 v[48:63], v[68:71], v[188:191], 0
    s_setprio 0
    v_add_f32 v240, v240, v238
    v_add_f32 v241, v241, v239
    v_cvt_pk_bf16_f32 v234, v234, v235
    v_cvt_pk_bf16_f32 v240, v240, v241
    ds_write_b32 v230, v234 offset:0
    ds_write_b32 v230, v240 offset:256
    v_mul_f32 v234, v0, v144
    v_mul_f32 v236, v8, v112
    v_fmac_f32 v234, v1, v145
    v_fmac_f32 v236, v9, v113
    v_fmac_f32 v234, v2, v146
    v_fmac_f32 v236, v10, v114
    v_fmac_f32 v234, v3, v147
    v_fmac_f32 v236, v11, v115
    v_fmac_f32 v234, v4, v148
    v_fmac_f32 v236, v12, v116
    v_fmac_f32 v234, v5, v149
    v_fmac_f32 v236, v13, v117
    v_fmac_f32 v234, v6, v150
    v_fmac_f32 v236, v14, v118
    v_fmac_f32 v234, v7, v151
    v_fmac_f32 v236, v15, v119
    v_mul_f32 v238, v16, v160
    v_mul_f32 v240, v24, v160
    v_fmac_f32 v238, v17, v161
    v_fmac_f32 v240, v25, v161
    v_fmac_f32 v238, v18, v162
    v_fmac_f32 v240, v26, v162
    v_fmac_f32 v238, v19, v163
    v_fmac_f32 v240, v27, v163
    v_fmac_f32 v238, v20, v164
    v_fmac_f32 v240, v28, v164
    v_fmac_f32 v238, v21, v165
    v_fmac_f32 v240, v29, v165
    v_fmac_f32 v238, v22, v166
    v_fmac_f32 v240, v30, v166
    v_fmac_f32 v238, v23, v167
    v_fmac_f32 v240, v31, v167
    v_mul_f32 v235, v32, v152
    v_mul_f32 v237, v40, v120
    v_fmac_f32 v235, v33, v153
    v_fmac_f32 v237, v41, v121
    v_fmac_f32 v235, v34, v154
    v_fmac_f32 v237, v42, v122
    v_fmac_f32 v235, v35, v155
    v_fmac_f32 v237, v43, v123
    v_fmac_f32 v235, v36, v156
    v_fmac_f32 v237, v44, v124
    v_fmac_f32 v235, v37, v157
    v_fmac_f32 v237, v45, v125
    v_fmac_f32 v235, v38, v158
    v_fmac_f32 v237, v46, v126
    v_fmac_f32 v235, v39, v159
    v_fmac_f32 v237, v47, v127
    v_mul_f32 v239, v48, v168
    v_mul_f32 v241, v56, v168
    v_fmac_f32 v239, v49, v169
    v_fmac_f32 v241, v57, v169
    v_fmac_f32 v239, v50, v170
    v_fmac_f32 v241, v58, v170
    v_fmac_f32 v239, v51, v171
    v_fmac_f32 v241, v59, v171
    v_fmac_f32 v239, v52, v172
    v_fmac_f32 v241, v60, v172
    v_fmac_f32 v239, v53, v173
    v_fmac_f32 v241, v61, v173
    v_fmac_f32 v239, v54, v174
    v_fmac_f32 v241, v62, v174
    v_fmac_f32 v239, v55, v175
    v_fmac_f32 v241, v63, v175
    s_setprio 1
    s_waitcnt vmcnt(4) lgkmcnt(2)
    v_mfma_f32_32x32x16_bf16 v[0:15], v[64:67], v[176:179], 0
    ds_read_b64_tr_b16 v[184:185], v246 offset:6144
    ds_read_b64_tr_b16 v[186:187], v246 offset:7168
    ds_read_b64_tr_b16 v[188:189], v247 offset:6144
    ds_read_b64_tr_b16 v[190:191], v247 offset:7168
    s_mov_b32 s32, s31
    s_mov_b32 s31, s35
    s_mov_b32 m0, s70
    v_mfma_f32_32x32x16_bf16 v[16:31], v[68:71], v[176:179], 0
    buffer_load_dwordx4 v226, s[4:7], s46 offen sc1 lds
    buffer_load_dwordx4 v227, s[72:75], s46 offen offset:1024 sc1 lds
    s_sub_u32 s26, s48, s29
    s_mov_b32 s29, s48
    s_mov_b32 s30, s3
    s_bfe_u32 s56, s3, 0x40012
    v_mfma_f32_32x32x16_bf16 v[32:47], v[64:67], v[180:183], 0
    s_cmp_lg_u32 s36, 0
    s_cselect_b32 s56, s56, 0
    v_mfma_f32_32x32x16_bf16 v[48:63], v[68:71], v[180:183], 0
    s_setprio 0
    v_mul_f32 v242, v0, v144
    v_fma_f32 v238, v8, v160, -v238
    v_fmac_f32 v242, v1, v145
    v_fmac_f32 v238, v9, v161
    v_fmac_f32 v242, v2, v146
    v_fmac_f32 v238, v10, v162
    v_fmac_f32 v242, v3, v147
    v_fmac_f32 v238, v11, v163
    v_fmac_f32 v242, v4, v148
    v_fmac_f32 v238, v12, v164
    v_fmac_f32 v242, v5, v149
    v_fmac_f32 v238, v13, v165
    v_fmac_f32 v242, v6, v150
    v_fmac_f32 v238, v14, v166
    v_fmac_f32 v242, v7, v151
    v_fmac_f32 v238, v15, v167
    v_fmac_f32 v236, v16, v112
    v_mul_f32 v244, v24, v160
    v_fmac_f32 v236, v17, v113
    v_fmac_f32 v244, v25, v161
    v_fmac_f32 v236, v18, v114
    v_fmac_f32 v244, v26, v162
    v_fmac_f32 v236, v19, v115
    v_fmac_f32 v244, v27, v163
    v_fmac_f32 v236, v20, v116
    v_fmac_f32 v244, v28, v164
    v_fmac_f32 v236, v21, v117
    v_fmac_f32 v244, v29, v165
    v_fmac_f32 v236, v22, v118
    v_fmac_f32 v244, v30, v166
    v_fmac_f32 v236, v23, v119
    v_fmac_f32 v244, v31, v167
    v_mul_f32 v243, v32, v152
    v_fma_f32 v239, v40, v168, -v239
    v_fmac_f32 v243, v33, v153
    v_fmac_f32 v239, v41, v169
    v_fmac_f32 v243, v34, v154
    v_fmac_f32 v239, v42, v170
    v_fmac_f32 v243, v35, v155
    v_fmac_f32 v239, v43, v171
    v_fmac_f32 v243, v36, v156
    v_fmac_f32 v239, v44, v172
    v_fmac_f32 v243, v37, v157
    v_fmac_f32 v239, v45, v173
    v_fmac_f32 v243, v38, v158
    v_fmac_f32 v239, v46, v174
    v_fmac_f32 v243, v39, v159
    v_fmac_f32 v239, v47, v175
    v_fmac_f32 v237, v48, v120
    v_mul_f32 v245, v56, v168
    v_fmac_f32 v237, v49, v121
    v_fmac_f32 v245, v57, v169
    v_fmac_f32 v237, v50, v122
    v_fmac_f32 v245, v58, v170
    v_fmac_f32 v237, v51, v123
    v_fmac_f32 v245, v59, v171
    v_fmac_f32 v237, v52, v124
    v_fmac_f32 v245, v60, v172
    v_fmac_f32 v237, v53, v125
    v_fmac_f32 v245, v61, v173
    v_fmac_f32 v237, v54, v126
    v_fmac_f32 v245, v62, v174
    v_fmac_f32 v237, v55, v127
    v_fmac_f32 v245, v63, v175
    s_setprio 1
    s_waitcnt vmcnt(4) lgkmcnt(0)
    v_mfma_f32_32x32x16_bf16 v[0:15], v[64:67], v[184:187], 0
    ds_read_b64_tr_b16 v[176:177], v246 offset:0
    ds_read_b64_tr_b16 v[178:179], v246 offset:1024
    ds_read_b64_tr_b16 v[180:181], v247 offset:0
    ds_read_b64_tr_b16 v[182:183], v247 offset:1024
    s_mov_b32 m0, s71
    v_mfma_f32_32x32x16_bf16 v[16:31], v[68:71], v[184:187], 0
    buffer_load_dwordx4 v228, s[4:7], s47 offen sc1 lds
    buffer_load_dwordx4 v229, s[72:75], s47 offen offset:1024 sc1 lds
    v_permlane32_swap_b32 v242, v234
    v_permlane32_swap_b32 v243, v235
    v_add_f32 v242, v242, v234
    v_mfma_f32_32x32x16_bf16 v[32:47], v[64:67], v[188:191], 0
    v_add_f32 v243, v243, v235
    v_cvt_pk_bf16_f32 v242, v242, v243
    ds_write_b32 v230, v242 offset:512
    v_mfma_f32_32x32x16_bf16 v[48:63], v[68:71], v[188:191], 0
    s_setprio 0
    v_mul_f32 v242, v0, v144
    v_fma_f32 v240, v8, v160, -v240
    v_fmac_f32 v242, v1, v145
    v_fmac_f32 v240, v9, v161
    v_fmac_f32 v242, v2, v146
    v_fmac_f32 v240, v10, v162
    v_fmac_f32 v242, v3, v147
    v_fmac_f32 v240, v11, v163
    v_fmac_f32 v242, v4, v148
    v_fmac_f32 v240, v12, v164
    v_fmac_f32 v242, v5, v149
    v_fmac_f32 v240, v13, v165
    v_fmac_f32 v242, v6, v150
    v_fmac_f32 v240, v14, v166
    v_fmac_f32 v242, v7, v151
    v_fmac_f32 v240, v15, v167
    v_add_u32 v249, s26, v249
    v_add_u32 v250, s26, v250
    v_fma_f32 v244, v16, v160, -v244
    v_fmac_f32 v236, v24, v112
    v_fmac_f32 v244, v17, v161
    v_fmac_f32 v236, v25, v113
    v_fmac_f32 v244, v18, v162
    v_fmac_f32 v236, v26, v114
    v_fmac_f32 v244, v19, v163
    v_fmac_f32 v236, v27, v115
    v_fmac_f32 v244, v20, v164
    v_fmac_f32 v236, v28, v116
    v_fmac_f32 v244, v21, v165
    v_fmac_f32 v236, v29, v117
    v_fmac_f32 v244, v22, v166
    v_fmac_f32 v236, v30, v118
    v_fmac_f32 v244, v23, v167
    v_fmac_f32 v236, v31, v119
    ds_read_b64_tr_b16 v[0:1], v249 offset:0
    ds_read_b64_tr_b16 v[2:3], v249 offset:32
    ds_read_u16_d16_hi v16, v250 offset:0
    v_mul_f32 v243, v32, v152
    v_fma_f32 v241, v40, v168, -v241
    v_fmac_f32 v243, v33, v153
    v_fmac_f32 v241, v41, v169
    v_fmac_f32 v243, v34, v154
    v_fmac_f32 v241, v42, v170
    v_fmac_f32 v243, v35, v155
    v_fmac_f32 v241, v43, v171
    v_fmac_f32 v243, v36, v156
    v_fmac_f32 v241, v44, v172
    v_fmac_f32 v243, v37, v157
    v_fmac_f32 v241, v45, v173
    v_fmac_f32 v243, v38, v158
    v_fmac_f32 v241, v46, v174
    v_fmac_f32 v243, v39, v159
    v_fmac_f32 v241, v47, v175
    ds_read_b64_tr_b16 v[4:5], v249 offset:512
    ds_read_b64_tr_b16 v[6:7], v249 offset:544
    ds_read_u16_d16_hi v17, v250 offset:128
    v_fma_f32 v245, v48, v168, -v245
    v_fmac_f32 v237, v56, v120
    v_fmac_f32 v245, v49, v169
    v_fmac_f32 v237, v57, v121
    v_fmac_f32 v245, v50, v170
    v_fmac_f32 v237, v58, v122
    v_fmac_f32 v245, v51, v171
    v_fmac_f32 v237, v59, v123
    v_fmac_f32 v245, v52, v172
    v_fmac_f32 v237, v60, v124
    v_fmac_f32 v245, v53, v173
    v_fmac_f32 v237, v61, v125
    v_fmac_f32 v245, v54, v174
    v_fmac_f32 v237, v62, v126
    v_fmac_f32 v245, v55, v175
    v_fmac_f32 v237, v63, v127
    s_cmp_eq_u32 s56, 5
    s_cbranch_scc1 K2_U21
    s_cmp_eq_u32 s56, 6
    s_cbranch_scc1 K2_U3h1
    s_branch K2_DSP1
K2_U41:
    s_setprio 1
    ds_read_b64_tr_b16 v[8:9], v249 offset:1024
    ds_read_b64_tr_b16 v[10:11], v249 offset:1056
    ds_read_u16_d16_hi v18, v250 offset:256
    s_lshr_b32 s65, s30, 27
    s_mul_i32 s66, s22, 2080
    s_lshl_b32 s65, s65, 9
    s_add_u32 s65, s65, s66
    s_add_u32 s65, s65, 65536
    s_sub_u32 s65, s65, s29
    s_sub_u32 s65, s65, 512
    v_add_u32 v56, s65, v249
    ds_read_b64_tr_b16 v[12:13], v56 offset:0
    ds_read_b64_tr_b16 v[14:15], v56 offset:32
    ds_read_u16_d16_hi v19, v250 offset:384
    s_waitcnt lgkmcnt(6)
    v_lshlrev_b32 v20, 16, v0
    v_and_b32 v21, 0xffff0000, v0
    v_lshlrev_b32 v22, 16, v1
    v_and_b32 v23, 0xffff0000, v1
    v_lshlrev_b32 v24, 16, v2
    v_and_b32 v25, 0xffff0000, v2
    v_lshlrev_b32 v26, 16, v3
    v_and_b32 v27, 0xffff0000, v3
    v_mul_f32_dpp v36, v16, v20 row_newbcast:8 row_mask:0xf bank_mask:0xf
    v_mul_f32_dpp v37, v16, v21 row_newbcast:9 row_mask:0xf bank_mask:0xf
    v_mul_f32_dpp v38, v16, v22 row_newbcast:10 row_mask:0xf bank_mask:0xf
    v_mul_f32_dpp v39, v16, v23 row_newbcast:11 row_mask:0xf bank_mask:0xf
    v_mul_f32_dpp v40, v16, v24 row_newbcast:12 row_mask:0xf bank_mask:0xf
    v_mul_f32_dpp v41, v16, v25 row_newbcast:13 row_mask:0xf bank_mask:0xf
    v_mul_f32_dpp v42, v16, v26 row_newbcast:14 row_mask:0xf bank_mask:0xf
    v_mul_f32_dpp v43, v16, v27 row_newbcast:15 row_mask:0xf bank_mask:0xf
    v_cvt_pk_bf16_f32 v68, v36, v37
    v_cvt_pk_bf16_f32 v69, v38, v39
    v_cvt_pk_bf16_f32 v70, v40, v41
    v_cvt_pk_bf16_f32 v71, v42, v43
    v_mul_f32_dpp v20, v16, v20 row_newbcast:0 row_mask:0xa bank_mask:0xf
    v_mul_f32_dpp v21, v16, v21 row_newbcast:1 row_mask:0xa bank_mask:0xf
    v_mul_f32_dpp v22, v16, v22 row_newbcast:2 row_mask:0xa bank_mask:0xf
    v_mul_f32_dpp v23, v16, v23 row_newbcast:3 row_mask:0xa bank_mask:0xf
    v_mul_f32_dpp v24, v16, v24 row_newbcast:4 row_mask:0xa bank_mask:0xf
    v_mul_f32_dpp v25, v16, v25 row_newbcast:5 row_mask:0xa bank_mask:0xf
    v_mul_f32_dpp v26, v16, v26 row_newbcast:6 row_mask:0xa bank_mask:0xf
    v_mul_f32_dpp v27, v16, v27 row_newbcast:7 row_mask:0xa bank_mask:0xf
    v_cvt_pk_bf16_f32 v64, v20, v21
    v_cvt_pk_bf16_f32 v65, v22, v23
    v_cvt_pk_bf16_f32 v66, v24, v25
    v_cvt_pk_bf16_f32 v67, v26, v27
    v_lshlrev_b32 v28, 16, v4
    v_and_b32 v29, 0xffff0000, v4
    v_lshlrev_b32 v30, 16, v5
    v_and_b32 v31, 0xffff0000, v5
    v_lshlrev_b32 v32, 16, v6
    v_and_b32 v33, 0xffff0000, v6
    v_lshlrev_b32 v34, 16, v7
    v_and_b32 v35, 0xffff0000, v7
    v_mul_f32_dpp v36, v17, v28 row_newbcast:8 row_mask:0xf bank_mask:0xf
    v_mul_f32_dpp v37, v17, v29 row_newbcast:9 row_mask:0xf bank_mask:0xf
    v_mul_f32_dpp v38, v17, v30 row_newbcast:10 row_mask:0xf bank_mask:0xf
    v_mul_f32_dpp v39, v17, v31 row_newbcast:11 row_mask:0xf bank_mask:0xf
    v_mul_f32_dpp v40, v17, v32 row_newbcast:12 row_mask:0xf bank_mask:0xf
    v_mul_f32_dpp v41, v17, v33 row_newbcast:13 row_mask:0xf bank_mask:0xf
    v_mul_f32_dpp v42, v17, v34 row_newbcast:14 row_mask:0xf bank_mask:0xf
    v_mul_f32_dpp v43, v17, v35 row_newbcast:15 row_mask:0xf bank_mask:0xf
    v_cvt_pk_bf16_f32 v76, v36, v37
    v_cvt_pk_bf16_f32 v77, v38, v39
    v_cvt_pk_bf16_f32 v78, v40, v41
    v_cvt_pk_bf16_f32 v79, v42, v43
    v_mul_f32_dpp v28, v17, v28 row_newbcast:0 row_mask:0xa bank_mask:0xf
    v_mul_f32_dpp v29, v17, v29 row_newbcast:1 row_mask:0xa bank_mask:0xf
    v_mul_f32_dpp v30, v17, v30 row_newbcast:2 row_mask:0xa bank_mask:0xf
    v_mul_f32_dpp v31, v17, v31 row_newbcast:3 row_mask:0xa bank_mask:0xf
    v_mul_f32_dpp v32, v17, v32 row_newbcast:4 row_mask:0xa bank_mask:0xf
    v_mul_f32_dpp v33, v17, v33 row_newbcast:5 row_mask:0xa bank_mask:0xf
    v_mul_f32_dpp v34, v17, v34 row_newbcast:6 row_mask:0xa bank_mask:0xf
    v_mul_f32_dpp v35, v17, v35 row_newbcast:7 row_mask:0xa bank_mask:0xf
    v_cvt_pk_bf16_f32 v72, v28, v29
    v_cvt_pk_bf16_f32 v73, v30, v31
    v_cvt_pk_bf16_f32 v74, v32, v33
    v_cvt_pk_bf16_f32 v75, v34, v35
    s_waitcnt lgkmcnt(3)
    v_lshlrev_b32 v20, 16, v8
    v_and_b32 v21, 0xffff0000, v8
    v_lshlrev_b32 v22, 16, v9
    v_and_b32 v23, 0xffff0000, v9
    v_lshlrev_b32 v24, 16, v10
    v_and_b32 v25, 0xffff0000, v10
    v_lshlrev_b32 v26, 16, v11
    v_and_b32 v27, 0xffff0000, v11
    v_mul_f32_dpp v36, v18, v20 row_newbcast:8 row_mask:0xf bank_mask:0xf
    v_mul_f32_dpp v37, v18, v21 row_newbcast:9 row_mask:0xf bank_mask:0xf
    v_mul_f32_dpp v38, v18, v22 row_newbcast:10 row_mask:0xf bank_mask:0xf
    v_mul_f32_dpp v39, v18, v23 row_newbcast:11 row_mask:0xf bank_mask:0xf
    v_mul_f32_dpp v40, v18, v24 row_newbcast:12 row_mask:0xf bank_mask:0xf
    v_mul_f32_dpp v41, v18, v25 row_newbcast:13 row_mask:0xf bank_mask:0xf
    v_mul_f32_dpp v42, v18, v26 row_newbcast:14 row_mask:0xf bank_mask:0xf
    v_mul_f32_dpp v43, v18, v27 row_newbcast:15 row_mask:0xf bank_mask:0xf
    v_cvt_pk_bf16_f32 v84, v36, v37
    v_cvt_pk_bf16_f32 v85, v38, v39
    v_cvt_pk_bf16_f32 v86, v40, v41
    v_cvt_pk_bf16_f32 v87, v42, v43
    v_mul_f32_dpp v20, v18, v20 row_newbcast:0 row_mask:0xa bank_mask:0xf
    v_mul_f32_dpp v21, v18, v21 row_newbcast:1 row_mask:0xa bank_mask:0xf
    v_mul_f32_dpp v22, v18, v22 row_newbcast:2 row_mask:0xa bank_mask:0xf
    v_mul_f32_dpp v23, v18, v23 row_newbcast:3 row_mask:0xa bank_mask:0xf
    v_mul_f32_dpp v24, v18, v24 row_newbcast:4 row_mask:0xa bank_mask:0xf
    v_mul_f32_dpp v25, v18, v25 row_newbcast:5 row_mask:0xa bank_mask:0xf
    v_mul_f32_dpp v26, v18, v26 row_newbcast:6 row_mask:0xa bank_mask:0xf
    v_mul_f32_dpp v27, v18, v27 row_newbcast:7 row_mask:0xa bank_mask:0xf
    v_cvt_pk_bf16_f32 v80, v20, v21
    v_cvt_pk_bf16_f32 v81, v22, v23
    v_cvt_pk_bf16_f32 v82, v24, v25
    v_cvt_pk_bf16_f32 v83, v26, v27
    s_waitcnt lgkmcnt(0)
    v_lshlrev_b32 v28, 16, v12
    v_and_b32 v29, 0xffff0000, v12
    v_lshlrev_b32 v30, 16, v13
    v_and_b32 v31, 0xffff0000, v13
    v_lshlrev_b32 v32, 16, v14
    v_and_b32 v33, 0xffff0000, v14
    v_lshlrev_b32 v34, 16, v15
    v_and_b32 v35, 0xffff0000, v15
    v_mul_f32_dpp v36, v19, v28 row_newbcast:8 row_mask:0xf bank_mask:0xf
    v_mul_f32_dpp v37, v19, v29 row_newbcast:9 row_mask:0xf bank_mask:0xf
    v_mul_f32_dpp v38, v19, v30 row_newbcast:10 row_mask:0xf bank_mask:0xf
    v_mul_f32_dpp v39, v19, v31 row_newbcast:11 row_mask:0xf bank_mask:0xf
    v_mul_f32_dpp v40, v19, v32 row_newbcast:12 row_mask:0xf bank_mask:0xf
    v_mul_f32_dpp v41, v19, v33 row_newbcast:13 row_mask:0xf bank_mask:0xf
    v_mul_f32_dpp v42, v19, v34 row_newbcast:14 row_mask:0xf bank_mask:0xf
    v_mul_f32_dpp v43, v19, v35 row_newbcast:15 row_mask:0xf bank_mask:0xf
    v_cvt_pk_bf16_f32 v92, v36, v37
    v_cvt_pk_bf16_f32 v93, v38, v39
    v_cvt_pk_bf16_f32 v94, v40, v41
    v_cvt_pk_bf16_f32 v95, v42, v43
    v_mul_f32_dpp v28, v19, v28 row_newbcast:0 row_mask:0xa bank_mask:0xf
    v_mul_f32_dpp v29, v19, v29 row_newbcast:1 row_mask:0xa bank_mask:0xf
    v_mul_f32_dpp v30, v19, v30 row_newbcast:2 row_mask:0xa bank_mask:0xf
    v_mul_f32_dpp v31, v19, v31 row_newbcast:3 row_mask:0xa bank_mask:0xf
    v_mul_f32_dpp v32, v19, v32 row_newbcast:4 row_mask:0xa bank_mask:0xf
    v_mul_f32_dpp v33, v19, v33 row_newbcast:5 row_mask:0xa bank_mask:0xf
    v_mul_f32_dpp v34, v19, v34 row_newbcast:6 row_mask:0xa bank_mask:0xf
    v_mul_f32_dpp v35, v19, v35 row_newbcast:7 row_mask:0xa bank_mask:0xf
    v_cvt_pk_bf16_f32 v88, v28, v29
    v_cvt_pk_bf16_f32 v89, v30, v31
    v_cvt_pk_bf16_f32 v90, v32, v33
    v_cvt_pk_bf16_f32 v91, v34, v35
    s_waitcnt vmcnt(4)
    v_mfma_f32_32x32x16_bf16 v[0:15], v[64:67], v[176:179], 0
    ds_read_b64_tr_b16 v[184:185], v246 offset:2048
    ds_read_b64_tr_b16 v[186:187], v246 offset:3072
    ds_read_b64_tr_b16 v[188:189], v247 offset:2048
    ds_read_b64_tr_b16 v[190:191], v247 offset:3072
    s_mov_b32 m0, s68
    v_mfma_f32_32x32x16_bf16 v[16:31], v[68:71], v[176:179], 0
    buffer_load_dwordx4 v222, s[4:7], s41 offen sc1 lds
    buffer_load_dwordx4 v223, s[72:75], s41 offen offset:1024 sc1 lds
    v_permlane32_swap_b32 v242, v236
    v_permlane32_swap_b32 v243, v237
    v_mov_b32 v254, 163296
    v_mfma_f32_32x32x16_bf16 v[32:47], v[64:67], v[180:183], 0
    v_permlane32_swap_b32 v244, v238
    v_permlane32_swap_b32 v245, v239
    v_permlane32_swap_b32 v240, v241
    v_add_f32 v242, v242, v236
    v_mfma_f32_32x32x16_bf16 v[48:63], v[68:71], v[180:183], 0
    v_add_f32 v243, v243, v237
    v_add_f32 v244, v244, v238
    v_add_f32 v245, v245, v239
    v_add_f32 v240, -v240, -v241
    v_sub_u32 v241, v230, v231
    v_cvt_pk_bf16_f32 v242, v242, v243
    v_mov_b32 v255, 1
    v_lshl_add_u32 v233, v252, 1, s53
    s_mov_b64 exec, 1
    ds_add_rtn_u32 v232, v254, v255
    s_mov_b64 exec, -1
    ds_read_b32 v233, v233
    s_waitcnt vmcnt(4) lgkmcnt(2)
    v_mfma_f32_32x32x16_bf16 v[0:15], v[72:75], v[184:187], v[0:15]
    ds_read_b64_tr_b16 v[176:177], v246 offset:4096
    ds_read_b64_tr_b16 v[178:179], v246 offset:5120
    ds_read_b64_tr_b16 v[180:181], v247 offset:4096
    ds_read_b64_tr_b16 v[182:183], v247 offset:5120
    v_cvt_pk_bf16_f32 v244, v244, v245
    v_cvt_pk_bf16_f32 v240, v240, v240
    s_mov_b32 m0, s69
    v_mfma_f32_32x32x16_bf16 v[16:31], v[76:79], v[184:187], v[16:31]
    buffer_load_dwordx4 v224, s[4:7], s41 offen sc1 lds
    buffer_load_dwordx4 v225, s[72:75], s41 offen offset:1024 sc1 lds
    ds_write_b32 v230, v242 offset:768
    ds_write_b32 v230, v244 offset:1024
    ds_write_b16 v241, v240 offset:1280
    s_waitcnt lgkmcnt(7)
    v_readfirstlane_b32 s58, v232
    v_mfma_f32_32x32x16_bf16 v[32:47], v[72:75], v[188:191], v[32:47]
    s_cmp_lt_u32 s58, s22
    s_cbranch_scc0 K2_nul_101
    s_and_b32 s59, s58, 7
    s_lshr_b32 s60, s58, 3
K2_chk_103:
    v_readlane_b32 s61, v233, s59
    s_nop 0
    s_cmp_gt_u32 s61, s60
    s_cbranch_scc0 K2_spin_102
K2_back_104:
    v_mfma_f32_32x32x16_bf16 v[48:63], v[76:79], v[188:191], v[48:63]
    v_readlane_b32 s3, v253, s58
    s_lshl_b32 s44, s34, 7
    s_and_b32 s48, s3, 0x3ffff
    s_bfe_u32 s33, s3, 0x30013
    s_mov_b32 s35, s48
    s_mov_b32 s45, s44
    s_waitcnt vmcnt(4) lgkmcnt(3)
    v_mfma_f32_32x32x16_bf16 v[0:15], v[80:83], v[176:179], v[0:15]
    ds_read_b64_tr_b16 v[184:185], v246 offset:6144
    ds_read_b64_tr_b16 v[186:187], v246 offset:7168
    ds_read_b64_tr_b16 v[188:189], v247 offset:6144
    ds_read_b64_tr_b16 v[190:191], v247 offset:7168
    s_xor_b32 s47, s44, 256
    s_add_u32 s49, s48, 128
    s_mov_b32 m0, s70
    v_mfma_f32_32x32x16_bf16 v[16:31], v[84:87], v[176:179], v[16:31]
    buffer_load_dwordx4 v226, s[4:7], s41 offen sc1 lds
    buffer_load_dwordx4 v227, s[72:75], s41 offen offset:1024 sc1 lds
    s_add_u32 s60, s48, 256
    s_cmp_eq_u32 s33, 3
    s_cselect_b32 s46, s44, s47
    s_cselect_b32 s50, s60, s48
    s_cselect_b32 s51, s48, s49
    v_mfma_f32_32x32x16_bf16 v[32:47], v[80:83], v[180:183], v[32:47]
    s_sub_u32 s60, s33, 2
    s_cmp_lt_u32 s60, 2
    s_cbranch_scc0 K2_rare_105
K2_back_106:
    v_mfma_f32_32x32x16_bf16 v[48:63], v[84:87], v[180:183], v[48:63]
    s_waitcnt vmcnt(4) lgkmcnt(0)
    v_mfma_f32_32x32x16_bf16 v[0:15], v[88:91], v[184:187], v[0:15]
    ds_read_b64_tr_b16 v[176:177], v246 offset:0
    ds_read_b64_tr_b16 v[178:179], v246 offset:1024
    ds_read_b64_tr_b16 v[180:181], v247 offset:0
    ds_read_b64_tr_b16 v[182:183], v247 offset:1024
    s_mov_b32 m0, s71
    v_mfma_f32_32x32x16_bf16 v[16:31], v[92:95], v[184:187], v[16:31]
    buffer_load_dwordx4 v228, s[4:7], s41 offen sc1 lds
    buffer_load_dwordx4 v229, s[72:75], s41 offen offset:1024 sc1 lds
    v_mfma_f32_32x32x16_bf16 v[32:47], v[88:91], v[188:191], v[32:47]
    s_nop 2
    v_mul_f32 v234, v0, v96
    v_mul_f32 v236, v8, v128
    v_fmac_f32 v234, v1, v97
    v_fmac_f32 v236, v9, v129
    v_fmac_f32 v234, v2, v98
    v_fmac_f32 v236, v10, v130
    v_fmac_f32 v234, v3, v99
    v_mfma_f32_32x32x16_bf16 v[48:63], v[92:95], v[188:191], v[48:63]
    s_setprio 0
    v_fmac_f32 v236, v11, v131
    v_fmac_f32 v234, v4, v100
    v_fmac_f32 v236, v12, v132
    v_fmac_f32 v234, v5, v101
    v_fmac_f32 v236, v13, v133
    v_fmac_f32 v234, v6, v102
    v_fmac_f32 v236, v14, v134
    v_fmac_f32 v234, v7, v103
    v_fmac_f32 v236, v15, v135
    v_mul_f32 v238, v16, v128
    v_mul_f32 v240, v24, v128
    v_fmac_f32 v238, v17, v129
    v_fmac_f32 v240, v25, v129
    v_fmac_f32 v238, v18, v130
    v_fmac_f32 v240, v26, v130
    v_fmac_f32 v238, v19, v131
    v_fmac_f32 v240, v27, v131
    v_fmac_f32 v238, v20, v132
    v_fmac_f32 v240, v28, v132
    v_fmac_f32 v238, v21, v133
    v_fmac_f32 v240, v29, v133
    v_fmac_f32 v238, v22, v134
    v_fmac_f32 v240, v30, v134
    v_fmac_f32 v238, v23, v135
    v_fmac_f32 v240, v31, v135
    v_mul_f32 v235, v32, v104
    v_mul_f32 v237, v40, v136
    v_fmac_f32 v235, v33, v105
    v_fmac_f32 v237, v41, v137
    v_fmac_f32 v235, v34, v106
    v_fmac_f32 v237, v42, v138
    v_fmac_f32 v235, v35, v107
    v_fmac_f32 v237, v43, v139
    v_fmac_f32 v235, v36, v108
    v_fmac_f32 v237, v44, v140
    v_fmac_f32 v235, v37, v109
    v_fmac_f32 v237, v45, v141
    v_fmac_f32 v235, v38, v110
    v_fmac_f32 v237, v46, v142
    v_fmac_f32 v235, v39, v111
    v_fmac_f32 v237, v47, v143
    v_mul_f32 v239, v48, v136
    v_mul_f32 v241, v56, v136
    s_setprio 1
    s_waitcnt vmcnt(4) lgkmcnt(0)
    v_mfma_f32_32x32x16_bf16 v[0:15], v[64:67], v[176:179], 0
    ds_read_b64_tr_b16 v[184:185], v246 offset:2048
    ds_read_b64_tr_b16 v[186:187], v246 offset:3072
    ds_read_b64_tr_b16 v[188:189], v247 offset:2048
    ds_read_b64_tr_b16 v[190:191], v247 offset:3072
    v_fmac_f32 v239, v49, v137
    v_fmac_f32 v241, v57, v137
    s_mov_b32 m0, s68
    v_mfma_f32_32x32x16_bf16 v[16:31], v[68:71], v[176:179], 0
    buffer_load_dwordx4 v222, s[4:7], s42 offen sc1 lds
    buffer_load_dwordx4 v223, s[72:75], s42 offen offset:1024 sc1 lds
    v_fmac_f32 v239, v50, v138
    v_fmac_f32 v241, v58, v138
    v_fmac_f32 v239, v51, v139
    v_fmac_f32 v241, v59, v139
    v_fmac_f32 v239, v52, v140
    v_mfma_f32_32x32x16_bf16 v[32:47], v[64:67], v[180:183], 0
    v_fmac_f32 v241, v60, v140
    v_fmac_f32 v239, v53, v141
    v_fmac_f32 v241, v61, v141
    v_fmac_f32 v239, v54, v142
    v_fmac_f32 v241, v62, v142
    v_fmac_f32 v239, v55, v143
    v_fmac_f32 v241, v63, v143
    v_mfma_f32_32x32x16_bf16 v[48:63], v[68:71], v[180:183], 0
    v_permlane32_swap_b32 v234, v236
    v_permlane32_swap_b32 v235, v237
    v_permlane32_swap_b32 v240, v238
    s_waitcnt vmcnt(4) lgkmcnt(0)
    v_mfma_f32_32x32x16_bf16 v[0:15], v[72:75], v[184:187], v[0:15]
    ds_read_b64_tr_b16 v[176:177], v246 offset:4096
    ds_read_b64_tr_b16 v[178:179], v246 offset:5120
    ds_read_b64_tr_b16 v[180:181], v247 offset:4096
    ds_read_b64_tr_b16 v[182:183], v247 offset:5120
    v_permlane32_swap_b32 v241, v239
    s_mov_b32 m0, s69
    v_mfma_f32_32x32x16_bf16 v[16:31], v[76:79], v[184:187], v[16:31]
    buffer_load_dwordx4 v224, s[4:7], s42 offen sc1 lds
    buffer_load_dwordx4 v225, s[72:75], s42 offen offset:1024 sc1 lds
    v_lshl_add_u32 v230, v252, 1, s31
    v_add_f32 v234, v234, v236
    v_add_f32 v235, v235, v237
    v_add_f32 v240, v240, v238
    v_add_f32 v241, v241, v239
    v_mfma_f32_32x32x16_bf16 v[32:47], v[72:75], v[188:191], v[32:47]
    v_cvt_pk_bf16_f32 v234, v234, v235
    v_cvt_pk_bf16_f32 v240, v240, v241
    ds_write_b32 v230, v234 offset:0
    ds_write_b32 v230, v240 offset:256
    v_mfma_f32_32x32x16_bf16 v[48:63], v[76:79], v[188:191], v[48:63]
    s_waitcnt vmcnt(4) lgkmcnt(2)
    v_mfma_f32_32x32x16_bf16 v[0:15], v[80:83], v[176:179], v[0:15]
    ds_read_b64_tr_b16 v[184:185], v246 offset:6144
    ds_read_b64_tr_b16 v[186:187], v246 offset:7168
    ds_read_b64_tr_b16 v[188:189], v247 offset:6144
    ds_read_b64_tr_b16 v[190:191], v247 offset:7168
    s_mov_b32 m0, s70
    v_mfma_f32_32x32x16_bf16 v[16:31], v[84:87], v[176:179], v[16:31]
    buffer_load_dwordx4 v226, s[4:7], s42 offen sc1 lds
    buffer_load_dwordx4 v227, s[72:75], s42 offen offset:1024 sc1 lds
    v_mfma_f32_32x32x16_bf16 v[32:47], v[80:83], v[180:183], v[32:47]
    v_mfma_f32_32x32x16_bf16 v[48:63], v[84:87], v[180:183], v[48:63]
    s_waitcnt vmcnt(4) lgkmcnt(0)
    v_mfma_f32_32x32x16_bf16 v[0:15], v[88:91], v[184:187], v[0:15]
    ds_read_b64_tr_b16 v[176:177], v246 offset:0
    ds_read_b64_tr_b16 v[178:179], v246 offset:1024
    ds_read_b64_tr_b16 v[180:181], v247 offset:0
    ds_read_b64_tr_b16 v[182:183], v247 offset:1024
    s_mov_b32 m0, s71
    v_mfma_f32_32x32x16_bf16 v[16:31], v[92:95], v[184:187], v[16:31]
    buffer_load_dwordx4 v228, s[4:7], s42 offen sc1 lds
    buffer_load_dwordx4 v229, s[72:75], s42 offen offset:1024 sc1 lds
    v_mfma_f32_32x32x16_bf16 v[32:47], v[88:91], v[188:191], v[32:47]
    s_nop 2
    v_mul_f32 v234, v0, v144
    v_mul_f32 v236, v8, v112
    v_fmac_f32 v234, v1, v145
    v_fmac_f32 v236, v9, v113
    v_fmac_f32 v234, v2, v146
    v_fmac_f32 v236, v10, v114
    v_fmac_f32 v234, v3, v147
    v_mfma_f32_32x32x16_bf16 v[48:63], v[92:95], v[188:191], v[48:63]
    s_setprio 0
    v_fmac_f32 v236, v11, v115
    v_fmac_f32 v234, v4, v148
    v_fmac_f32 v236, v12, v116
    v_fmac_f32 v234, v5, v149
    v_fmac_f32 v236, v13, v117
    v_fmac_f32 v234, v6, v150
    v_fmac_f32 v236, v14, v118
    v_fmac_f32 v234, v7, v151
    v_fmac_f32 v236, v15, v119
    v_mul_f32 v238, v16, v160
    v_mul_f32 v240, v24, v160
    v_fmac_f32 v238, v17, v161
    v_fmac_f32 v240, v25, v161
    v_fmac_f32 v238, v18, v162
    v_fmac_f32 v240, v26, v162
    v_fmac_f32 v238, v19, v163
    v_fmac_f32 v240, v27, v163
    v_fmac_f32 v238, v20, v164
    v_fmac_f32 v240, v28, v164
    v_fmac_f32 v238, v21, v165
    v_fmac_f32 v240, v29, v165
    v_fmac_f32 v238, v22, v166
    v_fmac_f32 v240, v30, v166
    v_fmac_f32 v238, v23, v167
    v_fmac_f32 v240, v31, v167
    v_mul_f32 v235, v32, v152
    v_mul_f32 v237, v40, v120
    v_fmac_f32 v235, v33, v153
    v_fmac_f32 v237, v41, v121
    v_fmac_f32 v235, v34, v154
    v_fmac_f32 v237, v42, v122
    v_fmac_f32 v235, v35, v155
    v_fmac_f32 v237, v43, v123
    v_fmac_f32 v235, v36, v156
    v_fmac_f32 v237, v44, v124
    v_fmac_f32 v235, v37, v157
    v_fmac_f32 v237, v45, v125
    v_fmac_f32 v235, v38, v158
    v_fmac_f32 v237, v46, v126
    v_fmac_f32 v235, v39, v159
    v_fmac_f32 v237, v47, v127
    v_mul_f32 v239, v48, v168
    v_mul_f32 v241, v56, v168
    s_setprio 1
    s_waitcnt vmcnt(4) lgkmcnt(0)
    v_mfma_f32_32x32x16_bf16 v[0:15], v[64:67], v[176:179], 0
    ds_read_b64_tr_b16 v[184:185], v246 offset:2048
    ds_read_b64_tr_b16 v[186:187], v246 offset:3072
    ds_read_b64_tr_b16 v[188:189], v247 offset:2048
    ds_read_b64_tr_b16 v[190:191], v247 offset:3072
    v_fmac_f32 v239, v49, v169
    v_fmac_f32 v241, v57, v169
    s_mov_b32 m0, s68
    v_mfma_f32_32x32x16_bf16 v[16:31], v[68:71], v[176:179], 0
    buffer_load_dwordx4 v222, s[4:7], s43 offen sc1 lds
    buffer_load_dwordx4 v223, s[72:75], s43 offen offset:1024 sc1 lds
    v_fmac_f32 v239, v50, v170
    v_fmac_f32 v241, v58, v170
    v_fmac_f32 v239, v51, v171
    v_fmac_f32 v241, v59, v171
    v_fmac_f32 v239, v52, v172
    v_mfma_f32_32x32x16_bf16 v[32:47], v[64:67], v[180:183], 0
    v_fmac_f32 v241, v60, v172
    v_fmac_f32 v239, v53, v173
    v_fmac_f32 v241, v61, v173
    v_fmac_f32 v239, v54, v174
    v_fmac_f32 v241, v62, v174
    v_fmac_f32 v239, v55, v175
    v_fmac_f32 v241, v63, v175
    v_mfma_f32_32x32x16_bf16 v[48:63], v[68:71], v[180:183], 0
    s_waitcnt vmcnt(4) lgkmcnt(0)
    v_mfma_f32_32x32x16_bf16 v[0:15], v[72:75], v[184:187], v[0:15]
    ds_read_b64_tr_b16 v[176:177], v246 offset:4096
    ds_read_b64_tr_b16 v[178:179], v246 offset:5120
    ds_read_b64_tr_b16 v[180:181], v247 offset:4096
    ds_read_b64_tr_b16 v[182:183], v247 offset:5120
    s_mov_b32 m0, s69
    v_mfma_f32_32x32x16_bf16 v[16:31], v[76:79], v[184:187], v[16:31]
    buffer_load_dwordx4 v224, s[4:7], s43 offen sc1 lds
    buffer_load_dwordx4 v225, s[72:75], s43 offen offset:1024 sc1 lds
    v_mfma_f32_32x32x16_bf16 v[32:47], v[72:75], v[188:191], v[32:47]
    v_mfma_f32_32x32x16_bf16 v[48:63], v[76:79], v[188:191], v[48:63]
    s_waitcnt vmcnt(4) lgkmcnt(0)
    v_mfma_f32_32x32x16_bf16 v[0:15], v[80:83], v[176:179], v[0:15]
    ds_read_b64_tr_b16 v[184:185], v246 offset:6144
    ds_read_b64_tr_b16 v[186:187], v246 offset:7168
    ds_read_b64_tr_b16 v[188:189], v247 offset:6144
    ds_read_b64_tr_b16 v[190:191], v247 offset:7168
    s_mov_b32 m0, s70
    v_mfma_f32_32x32x16_bf16 v[16:31], v[84:87], v[176:179], v[16:31]
    buffer_load_dwordx4 v226, s[4:7], s43 offen sc1 lds
    buffer_load_dwordx4 v227, s[72:75], s43 offen offset:1024 sc1 lds
    v_mfma_f32_32x32x16_bf16 v[32:47], v[80:83], v[180:183], v[32:47]
    v_add_u32 v222, s48, v251
    ds_read2_b32 v[222:223], v222 offset0:1 offset1:3
    v_mfma_f32_32x32x16_bf16 v[48:63], v[84:87], v[180:183], v[48:63]
    s_waitcnt vmcnt(4) lgkmcnt(1)
    v_mfma_f32_32x32x16_bf16 v[0:15], v[88:91], v[184:187], v[0:15]
    ds_read_b64_tr_b16 v[176:177], v246 offset:0
    ds_read_b64_tr_b16 v[178:179], v246 offset:1024
    ds_read_b64_tr_b16 v[180:181], v247 offset:0
    ds_read_b64_tr_b16 v[182:183], v247 offset:1024
    s_mov_b32 m0, s71
    v_mfma_f32_32x32x16_bf16 v[16:31], v[92:95], v[184:187], v[16:31]
    buffer_load_dwordx4 v228, s[4:7], s43 offen sc1 lds
    buffer_load_dwordx4 v229, s[72:75], s43 offen offset:1024 sc1 lds
    s_waitcnt lgkmcnt(4)
    v_mad_u32_u16 v222, v222, s39, v248 op_sel:[1,0,0,0]
    v_mad_u32_u16 v223, v223, s39, v248 op_sel:[1,0,0,0]
    v_mfma_f32_32x32x16_bf16 v[32:47], v[88:91], v[188:191], v[32:47]
    v_add_u32 v224, s49, v251
    ds_read2_b32 v[224:225], v224 offset0:1 offset1:3
    v_mul_f32 v242, v0, v144
    v_fma_f32 v238, v8, v160, -v238
    v_fmac_f32 v242, v1, v145
    v_fmac_f32 v238, v9, v161
    v_fmac_f32 v242, v2, v146
    v_mfma_f32_32x32x16_bf16 v[48:63], v[92:95], v[188:191], v[48:63]
    s_setprio 0
    v_fmac_f32 v238, v10, v162
    v_fmac_f32 v242, v3, v147
    v_fmac_f32 v238, v11, v163
    v_fmac_f32 v242, v4, v148
    v_fmac_f32 v238, v12, v164
    v_fmac_f32 v242, v5, v149
    v_fmac_f32 v238, v13, v165
    v_fmac_f32 v242, v6, v150
    v_fmac_f32 v238, v14, v166
    v_fmac_f32 v242, v7, v151
    v_fmac_f32 v238, v15, v167
    v_fmac_f32 v236, v16, v112
    v_mul_f32 v244, v24, v160
    v_fmac_f32 v236, v17, v113
    v_fmac_f32 v244, v25, v161
    v_fmac_f32 v236, v18, v114
    v_fmac_f32 v244, v26, v162
    v_fmac_f32 v236, v19, v115
    v_fmac_f32 v244, v27, v163
    v_fmac_f32 v236, v20, v116
    v_fmac_f32 v244, v28, v164
    v_fmac_f32 v236, v21, v117
    v_fmac_f32 v244, v29, v165
    v_fmac_f32 v236, v22, v118
    v_fmac_f32 v244, v30, v166
    v_fmac_f32 v236, v23, v119
    v_fmac_f32 v244, v31, v167
    v_mul_f32 v243, v32, v152
    v_fma_f32 v239, v40, v168, -v239
    v_fmac_f32 v243, v33, v153
    v_fmac_f32 v239, v41, v169
    v_fmac_f32 v243, v34, v154
    v_fmac_f32 v239, v42, v170
    v_fmac_f32 v243, v35, v155
    v_fmac_f32 v239, v43, v171
    v_fmac_f32 v243, v36, v156
    v_fmac_f32 v239, v44, v172
    v_fmac_f32 v243, v37, v157
    v_fmac_f32 v239, v45, v173
    v_fmac_f32 v243, v38, v158
    v_fmac_f32 v239, v46, v174
    v_fmac_f32 v243, v39, v159
    v_fmac_f32 v239, v47, v175
    v_fmac_f32 v237, v48, v120
    v_mul_f32 v245, v56, v168
    v_fmac_f32 v237, v49, v121
    v_fmac_f32 v245, v57, v169
    v_fmac_f32 v237, v50, v122
    v_fmac_f32 v245, v58, v170
    v_fmac_f32 v237, v51, v123
    s_setprio 1
    s_waitcnt vmcnt(4) lgkmcnt(1)
    v_mfma_f32_32x32x16_bf16 v[0:15], v[64:67], v[176:179], 0
    ds_read_b64_tr_b16 v[184:185], v246 offset:2048
    ds_read_b64_tr_b16 v[186:187], v246 offset:3072
    ds_read_b64_tr_b16 v[188:189], v247 offset:2048
    ds_read_b64_tr_b16 v[190:191], v247 offset:3072
    v_fmac_f32 v245, v59, v171
    v_fmac_f32 v237, v52, v124
    s_mov_b32 m0, s68
    v_mfma_f32_32x32x16_bf16 v[16:31], v[68:71], v[176:179], 0
    buffer_load_dwordx4 v222, s[4:7], s44 offen sc1 lds
    buffer_load_dwordx4 v223, s[72:75], s44 offen offset:1024 sc1 lds
    s_waitcnt lgkmcnt(4)
    v_mad_u32_u16 v224, v224, s39, v248 op_sel:[1,0,0,0]
    v_mad_u32_u16 v225, v225, s39, v248 op_sel:[1,0,0,0]
    v_fmac_f32 v245, v60, v172
    v_fmac_f32 v237, v53, v125
    v_mfma_f32_32x32x16_bf16 v[32:47], v[64:67], v[180:183], 0
    v_add_u32 v226, s50, v251
    ds_read2_b32 v[226:227], v226 offset0:1 offset1:3
    v_fmac_f32 v245, v61, v173
    v_fmac_f32 v237, v54, v126
    v_fmac_f32 v245, v62, v174
    v_fmac_f32 v237, v55, v127
    v_fmac_f32 v245, v63, v175
    v_mfma_f32_32x32x16_bf16 v[48:63], v[68:71], v[180:183], 0
    v_permlane32_swap_b32 v242, v234
    v_permlane32_swap_b32 v243, v235
    v_add_f32 v242, v242, v234
    v_add_f32 v243, v243, v235
    s_waitcnt vmcnt(4) lgkmcnt(1)
    v_mfma_f32_32x32x16_bf16 v[0:15], v[72:75], v[184:187], v[0:15]
    ds_read_b64_tr_b16 v[176:177], v246 offset:4096
    ds_read_b64_tr_b16 v[178:179], v246 offset:5120
    ds_read_b64_tr_b16 v[180:181], v247 offset:4096
    ds_read_b64_tr_b16 v[182:183], v247 offset:5120
    v_cvt_pk_bf16_f32 v242, v242, v243
    ds_write_b32 v230, v242 offset:512
    s_mov_b32 m0, s69
    v_mfma_f32_32x32x16_bf16 v[16:31], v[76:79], v[184:187], v[16:31]
    buffer_load_dwordx4 v224, s[4:7], s45 offen sc1 lds
    buffer_load_dwordx4 v225, s[72:75], s45 offen offset:1024 sc1 lds
    s_waitcnt lgkmcnt(5)
    v_mad_u32_u16 v226, v226, s39, v248 op_sel:[1,0,0,0]
    v_mad_u32_u16 v227, v227, s39, v248 op_sel:[1,0,0,0]
    v_mfma_f32_32x32x16_bf16 v[32:47], v[72:75], v[188:191], v[32:47]
    v_add_u32 v228, s51, v251
    ds_read2_b32 v[228:229], v228 offset0:1 offset1:3
    v_mfma_f32_32x32x16_bf16 v[48:63], v[76:79], v[188:191], v[48:63]
    s_waitcnt vmcnt(4) lgkmcnt(2)
    v_mfma_f32_32x32x16_bf16 v[0:15], v[80:83], v[176:179], v[0:15]
    ds_read_b64_tr_b16 v[184:185], v246 offset:6144
    ds_read_b64_tr_b16 v[186:187], v246 offset:7168
    ds_read_b64_tr_b16 v[188:189], v247 offset:6144
    ds_read_b64_tr_b16 v[190:191], v247 offset:7168
    s_mov_b32 s32, s31
    s_mov_b32 s31, s35
    s_mov_b32 m0, s70
    v_mfma_f32_32x32x16_bf16 v[16:31], v[84:87], v[176:179], v[16:31]
    buffer_load_dwordx4 v226, s[4:7], s46 offen sc1 lds
    buffer_load_dwordx4 v227, s[72:75], s46 offen offset:1024 sc1 lds
    s_waitcnt lgkmcnt(4)
    v_mad_u32_u16 v228, v228, s39, v248 op_sel:[1,0,0,0]
    v_mad_u32_u16 v229, v229, s39, v248 op_sel:[1,0,0,0]
    s_sub_u32 s26, s48, s29
    s_mov_b32 s29, s48
    v_mfma_f32_32x32x16_bf16 v[32:47], v[80:83], v[180:183], v[32:47]
    s_mov_b32 s30, s3
    s_bfe_u32 s56, s3, 0x40012
    s_cmp_lg_u32 s36, 0
    s_cselect_b32 s56, s56, 0
    v_mfma_f32_32x32x16_bf16 v[48:63], v[84:87], v[180:183], v[48:63]
    s_waitcnt vmcnt(4) lgkmcnt(0)
    v_mfma_f32_32x32x16_bf16 v[0:15], v[88:91], v[184:187], v[0:15]
    ds_read_b64_tr_b16 v[176:177], v246 offset:0
    ds_read_b64_tr_b16 v[178:179], v246 offset:1024
    ds_read_b64_tr_b16 v[180:181], v247 offset:0
    ds_read_b64_tr_b16 v[182:183], v247 offset:1024
    s_mov_b32 m0, s71
    v_mfma_f32_32x32x16_bf16 v[16:31], v[92:95], v[184:187], v[16:31]
    buffer_load_dwordx4 v228, s[4:7], s47 offen sc1 lds
    buffer_load_dwordx4 v229, s[72:75], s47 offen offset:1024 sc1 lds
    v_mfma_f32_32x32x16_bf16 v[32:47], v[88:91], v[188:191], v[32:47]
    s_nop 2
    v_mul_f32 v242, v0, v144
    v_fma_f32 v240, v8, v160, -v240
    v_fmac_f32 v242, v1, v145
    v_fmac_f32 v240, v9, v161
    v_fmac_f32 v242, v2, v146
    v_fmac_f32 v240, v10, v162
    v_fmac_f32 v242, v3, v147
    v_mfma_f32_32x32x16_bf16 v[48:63], v[92:95], v[188:191], v[48:63]
    s_setprio 0
    v_fmac_f32 v240, v11, v163
    v_fmac_f32 v242, v4, v148
    v_fmac_f32 v240, v12, v164
    v_fmac_f32 v242, v5, v149
    v_fmac_f32 v240, v13, v165
    v_fmac_f32 v242, v6, v150
    v_fmac_f32 v240, v14, v166
    v_fmac_f32 v242, v7, v151
    v_fmac_f32 v240, v15, v167
    v_add_u32 v249, s26, v249
    v_add_u32 v250, s26, v250
    v_fma_f32 v244, v16, v160, -v244
    v_fmac_f32 v236, v24, v112
    v_fmac_f32 v244, v17, v161
    v_fmac_f32 v236, v25, v113
    v_fmac_f32 v244, v18, v162
    v_fmac_f32 v236, v26, v114
    v_fmac_f32 v244, v19, v163
    v_fmac_f32 v236, v27, v115
    v_fmac_f32 v244, v20, v164
    v_fmac_f32 v236, v28, v116
    v_fmac_f32 v244, v21, v165
    v_fmac_f32 v236, v29, v117
    v_fmac_f32 v244, v22, v166
    v_fmac_f32 v236, v30, v118
    v_fmac_f32 v244, v23, v167
    v_fmac_f32 v236, v31, v119
    ds_read_b64_tr_b16 v[0:1], v249 offset:0
    ds_read_b64_tr_b16 v[2:3], v249 offset:32
    ds_read_u16_d16_hi v16, v250 offset:0
    v_mul_f32 v243, v32, v152
    v_fma_f32 v241, v40, v168, -v241
    v_fmac_f32 v243, v33, v153
    v_fmac_f32 v241, v41, v169
    v_fmac_f32 v243, v34, v154
    v_fmac_f32 v241, v42, v170
    v_fmac_f32 v243, v35, v155
    v_fmac_f32 v241, v43, v171
    v_fmac_f32 v243, v36, v156
    v_fmac_f32 v241, v44, v172
    v_fmac_f32 v243, v37, v157
    v_fmac_f32 v241, v45, v173
    v_fmac_f32 v243, v38, v158
    v_fmac_f32 v241, v46, v174
    v_fmac_f32 v243, v39, v159
    v_fmac_f32 v241, v47, v175
    ds_read_b64_tr_b16 v[4:5], v249 offset:512
    ds_read_b64_tr_b16 v[6:7], v249 offset:544
    ds_read_u16_d16_hi v17, v250 offset:128
    v_fma_f32 v245, v48, v168, -v245
    v_fmac_f32 v237, v56, v120
    v_fmac_f32 v245, v49, v169
    v_fmac_f32 v237, v57, v121
    v_fmac_f32 v245, v50, v170
    v_fmac_f32 v237, v58, v122
    v_fmac_f32 v245, v51, v171
    v_fmac_f32 v237, v59, v123
    v_fmac_f32 v245, v52, v172
    v_fmac_f32 v237, v60, v124
    v_fmac_f32 v245, v53, v173
    v_fmac_f32 v237, v61, v125
    v_fmac_f32 v245, v54, v174
    v_fmac_f32 v237, v62, v126
    v_fmac_f32 v245, v55, v175
    v_fmac_f32 v237, v63, v127
    s_cmp_eq_u32 s56, 5
    s_cbranch_scc1 K2_U21
    s_cmp_eq_u32 s56, 6
    s_cbranch_scc1 K2_U3h1
    s_branch K2_DSP1
K2_FLGR:
    s_sub_u32 s27, s27, 16
    s_cbranch_scc1 K2_END
    buffer_load_dwordx4 v[56:59], v60, s[8:11], s64 offen sc1
    s_branch K2_FLGW
K2_FLGY:
    v_mov_b32 v56, s2
    v_mov_b32 v57, 7178240
    s_mov_b64 exec, 1
    buffer_store_dword v56, v57, s[8:11], 0 offen sc1
    s_mov_b64 exec, -1
    s_branch K2_FLGOK
K2_nul_70:
    s_mov_b32 s58, 63
    s_mov_b32 s36, 0
    s_branch K2_back_73
K2_spin_71:
    s_sub_u32 s27, s27, 1
    s_cbranch_scc1 K2_END
    v_lshl_add_u32 v233, v252, 1, s53
    ds_read_b32 v233, v233
    s_waitcnt lgkmcnt(0)
    s_branch K2_chk_72
K2_dyn_68:
    v_mov_b32 v254, 163296
    v_mov_b32 v255, 1
    v_lshl_add_u32 v233, v252, 1, s53
    s_mov_b64 exec, 1
    ds_add_rtn_u32 v232, v254, v255
    s_mov_b64 exec, -1
    ds_read_b32 v233, v233
    s_waitcnt lgkmcnt(0)
    v_readfirstlane_b32 s58, v232
    s_nop 0
    s_cmp_lt_u32 s58, s22
    s_cbranch_scc0 K2_nul_70
    s_and_b32 s59, s58, 7
    s_lshr_b32 s60, s58, 3
K2_chk_72:
    v_readlane_b32 s61, v233, s59
    s_nop 0
    s_cmp_gt_u32 s61, s60
    s_cbranch_scc0 K2_spin_71
K2_back_73:
    s_mov_b32 s34, 1
    s_branch K2_back_69
K2_rare_74:
    s_cmp_eq_u32 s33, 4
    s_cbranch_scc1 K2_four_76
    s_mov_b32 s49, s48
    s_mov_b32 s51, s48
    s_xor_b32 s45, s44, 256
    s_xor_b32 s46, s44, 512
    s_xor_b32 s47, s44, 768
    s_branch K2_back_75
K2_four_76:
    s_add_u32 s50, s48, 256
    s_add_u32 s51, s48, 384
    s_mov_b32 s46, s44
    s_mov_b32 s47, s44
    s_branch K2_back_75
K2_dum_77:
    v_mov_b32 v232, -1
    s_mov_b32 m0, 163312
    s_mov_b64 exec, 1
    buffer_load_dwordx4 v232, s[16:19], 0 offen lds
    buffer_load_dwordx4 v232, s[16:19], 0 offen lds
    s_mov_b64 exec, -1
    s_branch K2_back_79
K2_a4_78:
    v_add_u32 v254, s48, v230
    ds_read_b32 v254, v254 offset:4
    s_lshr_b32 s65, s3, 27
    s_mul_i32 s66, s22, 2080
    s_lshl_b32 s65, s65, 9
    s_add_u32 s65, s65, s66
    s_add_u32 s65, s65, 65536
    s_mov_b32 m0, s65
    s_mov_b32 exec_hi, 0
    s_waitcnt lgkmcnt(0)
    v_or_b32 v254, v254, v231
    buffer_load_dwordx4 v254, s[16:19], 0 offen  lds
    s_mov_b32 exec_hi, -1
    s_branch K2_b4_80
K2_nul_83:
    s_mov_b32 s58, 63
    s_mov_b32 s36, 0
    s_branch K2_back_86
K2_spin_84:
    s_sub_u32 s27, s27, 1
    s_cbranch_scc1 K2_END
    v_lshl_add_u32 v233, v252, 1, s53
    ds_read_b32 v233, v233
    s_waitcnt lgkmcnt(0)
    s_branch K2_chk_85
K2_dyn_81:
    v_mov_b32 v254, 163296
    v_mov_b32 v255, 1
    v_lshl_add_u32 v233, v252, 1, s53
    s_mov_b64 exec, 1
    ds_add_rtn_u32 v232, v254, v255
    s_mov_b64 exec, -1
    ds_read_b32 v233, v233
    s_waitcnt lgkmcnt(0)
    v_readfirstlane_b32 s58, v232
    s_nop 0
    s_cmp_lt_u32 s58, s22
    s_cbranch_scc0 K2_nul_83
    s_and_b32 s59, s58, 7
    s_lshr_b32 s60, s58, 3
K2_chk_85:
    v_readlane_b32 s61, v233, s59
    s_nop 0
    s_cmp_gt_u32 s61, s60
    s_cbranch_scc0 K2_spin_84
K2_back_86:
    s_mov_b32 s34, 1
    s_branch K2_back_82
K2_rare_87:
    s_cmp_eq_u32 s33, 4
    s_cbranch_scc1 K2_four_89
    s_mov_b32 s49, s48
    s_mov_b32 s51, s48
    s_xor_b32 s45, s44, 256
    s_xor_b32 s46, s44, 512
    s_xor_b32 s47, s44, 768
    s_branch K2_back_88
K2_four_89:
    s_add_u32 s50, s48, 256
    s_add_u32 s51, s48, 384
    s_mov_b32 s46, s44
    s_mov_b32 s47, s44
    s_branch K2_back_88
K2_dum_90:
    v_mov_b32 v232, -1
    s_mov_b32 m0, 163312
    s_mov_b64 exec, 1
    buffer_load_dwordx4 v232, s[16:19], 0 offen lds
    buffer_load_dwordx4 v232, s[16:19], 0 offen lds
    s_mov_b64 exec, -1
    s_branch K2_back_92
K2_a4_91:
    v_add_u32 v254, s48, v230
    ds_read_b32 v254, v254 offset:4
    s_lshr_b32 s65, s3, 27
    s_mul_i32 s66, s22, 2080
    s_lshl_b32 s65, s65, 9
    s_add_u32 s65, s65, s66
    s_add_u32 s65, s65, 65536
    s_mov_b32 m0, s65
    s_mov_b32 exec_hi, 0
    s_waitcnt lgkmcnt(0)
    v_or_b32 v254, v254, v231
    buffer_load_dwordx4 v254, s[16:19], 0 offen  lds
    s_mov_b32 exec_hi, -1
    s_branch K2_b4_93
K2_nul_94:
    s_mov_b32 s58, 63
    s_mov_b32 s36, 0
    s_branch K2_back_97
K2_spin_95:
    s_sub_u32 s27, s27, 1
    s_cbranch_scc1 K2_END
    v_lshl_add_u32 v233, v252, 1, s53
    ds_read_b32 v233, v233
    s_waitcnt lgkmcnt(0)
    s_branch K2_chk_96
K2_rare_98:
    s_cmp_eq_u32 s33, 4
    s_cbranch_scc1 K2_four_100
    s_mov_b32 s49, s48
    s_mov_b32 s51, s48
    s_xor_b32 s45, s44, 256
    s_xor_b32 s46, s44, 512
    s_xor_b32 s47, s44, 768
    s_branch K2_back_99
K2_four_100:
    s_add_u32 s50, s48, 256
    s_add_u32 s51, s48, 384
    s_mov_b32 s46, s44
    s_mov_b32 s47, s44
    s_branch K2_back_99
K2_nul_101:
    s_mov_b32 s58, 63
    s_mov_b32 s36, 0
    s_branch K2_back_104
K2_spin_102:
    s_sub_u32 s27, s27, 1
    s_cbranch_scc1 K2_END
    v_lshl_add_u32 v233, v252, 1, s53
    ds_read_b32 v233, v233
    s_waitcnt lgkmcnt(0)
    s_branch K2_chk_103
K2_rare_105:
    s_cmp_eq_u32 s33, 4
    s_cbranch_scc1 K2_four_107
    s_mov_b32 s49, s48
    s_mov_b32 s51, s48
    s_xor_b32 s45, s44, 256
    s_xor_b32 s46, s44, 512
    s_xor_b32 s47, s44, 768
    s_branch K2_back_106
K2_four_107:
    s_add_u32 s50, s48, 256
    s_add_u32 s51, s48, 384
    s_mov_b32 s46, s44
    s_mov_b32 s47, s44
    s_branch K2_back_106
K2_END:
    s_endpgm
.section .rodata,"a"
.p2align 6
.amdhsa_kernel standalone__tensor_product_equiv_equiformer__graph_kernel
  .amdhsa_next_free_vgpr 256
  .amdhsa_next_free_sgpr 102
  .amdhsa_accum_offset 256
  .amdhsa_group_segment_fixed_size 0
  .amdhsa_kernarg_size 96
  .amdhsa_user_sgpr_count 2
  .amdhsa_user_sgpr_kernarg_segment_ptr 1
  .amdhsa_system_sgpr_workgroup_id_x 1
  .amdhsa_float_denorm_mode_32 3
.end_amdhsa_kernel
```

```asm
; @launch grid=(256,1,1) block=(512,1,1) lds=163840
.amdgcn_target "amdgcn-amd-amdhsa--gfx950"
.text
.globl standalone__tensor_product_equiv_equiformer__graph_kernel
.p2align 8
.type standalone__tensor_product_equiv_equiformer__graph_kernel,@function
standalone__tensor_product_equiv_equiformer__graph_kernel:
    s_cmp_ge_u32 s2, 256
    s_cbranch_scc1 K2_END
    s_load_dwordx16 s[80:95], s[0:1], 0
    s_load_dwordx4 s[96:99], s[0:1], 72
    s_load_dwordx2 s[100:101], s[0:1], 88
    v_lshrrev_b32 v1, 6, v0
    s_mov_b32 s54, s2
    v_readfirstlane_b32 s20, v1
    s_mov_b64 exec, 0
    s_cmp_eq_u32 s20, 0
    s_cbranch_scc1 K2_PAD_S1
    s_cmp_eq_u32 s20, 1
    s_cbranch_scc1 K2_PAD_S2
    s_cmp_eq_u32 s20, 5
    s_cbranch_scc1 K2_PAD_H1
    s_cmp_eq_u32 s20, 6
    s_cbranch_scc1 K2_PAD_H2
    s_cmp_eq_u32 s20, 2
    s_cbranch_scc1 K2_PAD_H3
KS_HOP0:
    s_mov_b64 exec, -1
    v_and_b32 v8, 63, v0
    v_lshlrev_b32 v9, 4, v8
    v_mov_b32 v6, 0
    v_lshlrev_b32 v5, 4, v0
    v_mul_u32_u24 v4, 24, v0
    s_mul_i32 s64, s2, 5120
    s_mul_i32 s65, s2, 7680
    v_mov_b32 v176, v8
    v_mov_b32 v177, v0
    s_movk_i32 s39, 1024
    s_lshl_b32 s37, s20, 13
    s_mov_b32 s53, 163264
    s_lshl_b32 s52, s20, 2
    s_add_u32 s52, s52, s53
    s_add_u32 s68, s37, 0
    s_add_u32 s69, s37, 2048
    s_add_u32 s70, s37, 4096
    s_add_u32 s71, s37, 6144
    s_waitcnt lgkmcnt(0)
    s_mov_b32 s8, s100
    s_and_b32 s9, s101, 0xffff
    s_mov_b32 s10, 37748736
    s_mov_b32 s11, 0x20000
    s_cmp_lg_u32 s20, 7
    s_cbranch_scc1 KS_NOTAG
    s_mov_b32 s24, 7178240
    s_mov_b64 exec, 1
    buffer_load_dword v14, v6, s[8:11], s24 offen sc1
    s_mov_b64 exec, -1
    s_mov_b32 s60, s98
    s_and_b32 s61, s99, 0xffff
    s_mov_b32 s62, 256
    s_mov_b32 s63, 0x20000
    s_barrier
    v_mov_b32 v76, 0
    v_mov_b32 v77, -1
    v_lshlrev_b32 v78, 2, v8
    v_add_u32 v78, 163072, v78
    s_mov_b64 exec, 0x1ff
    ds_write_b32 v78, v76 offset:192
    s_mov_b32 exec_lo, -1
    ds_write_b32 v78, v77 offset:256
    s_mov_b64 exec, -1
    s_mov_b32 exec_hi, 0xffff
    ds_write_b32 v78, v76
    s_mov_b64 exec, 1
    ds_write_b32 v78, v76 offset:228
    s_mov_b64 exec, -1
    s_mov_b64 exec, 1
    buffer_load_dword v15, v6, s[60:63], 0 offen sc1
    v_mov_b32 v12, 163456
    s_mov_b32 s24, 1664525
    s_waitcnt vmcnt(1)
    v_mul_lo_u32 v59, v14, s24
    v_add_u32 v59, 1013904223, v59
    ds_write2_b32 v12, v59, v6 offset0:0 offset1:1
    s_waitcnt lgkmcnt(0)
    s_barrier
    s_waitcnt vmcnt(0)
    v_mov_b32 v62, v15
    ds_write_b32 v12, v15 offset:4
    v_cmp_ne_u32 vcc, 0, v15
    s_mov_b32 s24, 0x40000
    s_waitcnt lgkmcnt(0)
    s_barrier
    s_cbranch_vccnz KS_FLOK
KS_FLW:
    s_sub_u32 s24, s24, 1
    s_cbranch_scc1 K2_END
    buffer_load_dword v62, v6, s[60:63], 0 offen sc1
    s_waitcnt vmcnt(0)
    v_cmp_ne_u32 vcc, 0, v62
    s_nop 0
    s_cbranch_vccz KS_FLW
    ds_write_b32 v12, v62 offset:4
KS_FLOK:
    s_mov_b64 exec, -1
    s_branch KS_JOIN
KS_H0:
    s_barrier
    s_branch KS_HELP
K2_PAD_S1:
    s_branch KS_HOP0
KS_NOTAG:
    s_cmp_ge_u32 s20, 5
    s_cbranch_scc1 KS_HELP
    s_cmp_ge_u32 s2, 250
    s_cbranch_scc1 KS_IDLE
    s_mov_b32 s40, s88
    s_and_b32 s41, s89, 0xffff
    s_mov_b32 s42, 1280000
    s_mov_b32 s43, 0x20000
    buffer_load_dwordx4 v[12:15], v5, s[40:43], s64 offen
    s_mov_b32 s44, s86
    s_and_b32 s45, s87, 0xffff
    s_mov_b32 s46, 1280000
    s_mov_b32 s47, 0x20000
    s_mov_b32 s48, s82
    s_and_b32 s49, s83, 0xffff
    s_mov_b32 s50, 1920000
    s_mov_b32 s51, 0x20000
    buffer_load_dwordx4 v[16:19], v5, s[44:47], s64 offen
    buffer_load_dwordx4 v[20:23], v4, s[48:51], s65 offen
    buffer_load_dwordx2 v[24:25], v4, s[48:51], s65 offen offset:16
    v_lshlrev_b32 v2, 2, v0
    s_lshl_b32 s64, s64, 3
    v_lshl_add_u32 v3, v0, 7, s64
    v_mov_b32 v7, 1
    s_cmp_eq_u32 s20, 4
    s_cbranch_scc1 KS_NOCLR
    ds_write_b32 v2, v6
KS_NOCLR:
    s_waitcnt lgkmcnt(0)
    s_barrier
    s_mov_b64 exec, 0
    s_cmp_eq_u32 s20, 0
    s_cbranch_scc1 K2_PAD_B3
    s_cmp_eq_u32 s20, 1
    s_cbranch_scc1 K2_PAD_LD
    s_cmp_eq_u32 s20, 2
    s_cbranch_scc1 K2_PAD_NW
    s_cmp_eq_u32 s20, 3
    s_cbranch_scc1 K2_PAD_SC
    s_cmp_eq_u32 s20, 4
    s_cbranch_scc1 K2_PAD_SD
KS_HOP:
    s_mov_b64 exec, -1
    s_mov_b32 s58, 214749
    s_movk_i32 s59, 625
    s_waitcnt vmcnt(3)
    v_mul_u32_u24 v28, s58, v12
    v_and_b32 v40, 0xffffff, v28
    v_lshrrev_b32 v32, 26, v28
    v_add_u32 v40, 8187281, v40
    v_bfe_u32 v36, v28, 24, 2
    v_lshlrev_b32 v32, 2, v32
    v_lshrrev_b32 v40, 24, v40
    v_lshl_or_b32 v32, v36, 8, v32
    v_lshl_or_b32 v32, v40, 7, v32
    ds_add_rtn_u32 v36, v32, v7
    v_mul_u32_u24 v29, s58, v13
    v_and_b32 v41, 0xffffff, v29
    v_lshrrev_b32 v33, 26, v29
    v_add_u32 v41, 8187281, v41
    v_bfe_u32 v37, v29, 24, 2
    v_lshlrev_b32 v33, 2, v33
    v_lshrrev_b32 v41, 24, v41
    v_lshl_or_b32 v33, v37, 8, v33
    v_lshl_or_b32 v33, v41, 7, v33
    ds_add_rtn_u32 v37, v33, v7
    v_mul_u32_u24 v30, s58, v14
    v_and_b32 v42, 0xffffff, v30
    v_lshrrev_b32 v34, 26, v30
    v_add_u32 v42, 8187281, v42
    v_bfe_u32 v38, v30, 24, 2
    v_lshlrev_b32 v34, 2, v34
    v_lshrrev_b32 v42, 24, v42
    v_lshl_or_b32 v34, v38, 8, v34
    v_lshl_or_b32 v34, v42, 7, v34
    ds_add_rtn_u32 v38, v34, v7
    v_mul_u32_u24 v31, s58, v15
    v_and_b32 v43, 0xffffff, v31
    v_lshrrev_b32 v35, 26, v31
    v_add_u32 v43, 8187281, v43
    v_bfe_u32 v39, v31, 24, 2
    v_lshlrev_b32 v35, 2, v35
    v_lshrrev_b32 v43, 24, v43
    v_lshl_or_b32 v35, v39, 8, v35
    v_lshl_or_b32 v35, v43, 7, v35
    ds_add_rtn_u32 v39, v35, v7
    v_lshrrev_b32 v28, 24, v28
    v_mad_u32_u24 v28, v28, s59, 7
    v_lshrrev_b32 v28, 3, v28
    v_mad_u32_u24 v28, v40, 40, v28
    v_sub_u32 v28, v12, v28
    v_add_u32 v12, 0, v3
    v_lshl_or_b32 v28, v28, 26, v12
    v_lshrrev_b32 v29, 24, v29
    v_mad_u32_u24 v29, v29, s59, 7
    v_lshrrev_b32 v29, 3, v29
    v_mad_u32_u24 v29, v41, 40, v29
    v_sub_u32 v29, v13, v29
    v_add_u32 v13, 32, v3
    v_lshl_or_b32 v29, v29, 26, v13
    v_lshrrev_b32 v30, 24, v30
    v_mad_u32_u24 v30, v30, s59, 7
    v_lshrrev_b32 v30, 3, v30
    v_mad_u32_u24 v30, v42, 40, v30
    v_sub_u32 v30, v14, v30
    v_add_u32 v14, 64, v3
    v_lshl_or_b32 v30, v30, 26, v14
    v_lshrrev_b32 v31, 24, v31
    v_mad_u32_u24 v31, v31, s59, 7
    v_lshrrev_b32 v31, 3, v31
    v_mad_u32_u24 v31, v43, 40, v31
    v_sub_u32 v31, v15, v31
    v_add_u32 v15, 96, v3
    v_lshl_or_b32 v31, v31, 26, v15
K2_PAD_S2:
    s_cbranch_execz KS_HOP0
    v_mov_b32 v59, 163456
    s_mul_i32 s65, s2, 1152
    s_add_u32 s65, s65, 6291456
    s_mul_i32 s64, s2, 20608
    s_waitcnt lgkmcnt(0)
    s_barrier
    ds_read_b128 v[40:43], v9
    ds_read_b32 v59, v59
    s_waitcnt lgkmcnt(1)
    v_add_u32 v45, v40, v41
    v_add_u32 v46, v45, v42
    v_add_u32 v47, v46, v43
    v_mov_b32 v58, v47
    s_nop 1
    v_add_u32_dpp v58, v58, v58 row_shr:1 row_mask:0xf bank_mask:0xf bound_ctrl:0
    s_nop 1
    v_add_u32_dpp v58, v58, v58 row_shr:2 row_mask:0xf bank_mask:0xf bound_ctrl:0
    s_nop 1
    v_add_u32_dpp v58, v58, v58 row_shr:4 row_mask:0xf bank_mask:0xf bound_ctrl:0
    s_nop 1
    v_add_u32_dpp v58, v58, v58 row_shr:8 row_mask:0xf bank_mask:0xf bound_ctrl:0
    s_nop 1
    v_add_u32_dpp v58, v58, v58 row_bcast:15 row_mask:0xa bank_mask:0xf
    s_nop 1
    v_add_u32_dpp v58, v58, v58 row_bcast:31 row_mask:0xc bank_mask:0xf
    v_sub_u32 v48, v58, v47
    v_add_u32 v49, v48, v40
    v_add_u32 v50, v48, v45
    v_add_u32 v51, v48, v46
    ds_write_b128 v9, v[48:51] offset:1024
    s_waitcnt vmcnt(0) lgkmcnt(1)
    s_cmp_lg_u32 s20, 4
    s_cbranch_scc1 KS_NOPUB
    v_lshl_or_b32 v56, v49, 11, v48
    v_lshl_or_b32 v57, v51, 11, v50
    v_lshl_or_b32 v56, v59, 22, v56
    v_lshl_or_b32 v57, v59, 22, v57
    buffer_store_dwordx4 v[56:59], v9, s[8:11], s65 offen sc1
KS_NOPUB:
    s_waitcnt lgkmcnt(0)
    ds_read_b32 v32, v32 offset:1024
    ds_read_b32 v33, v33 offset:1024
    ds_read_b32 v34, v34 offset:1024
    ds_read_b32 v35, v35 offset:1024
    v_and_b32 v60, 0xffff, v59
    v_and_b32 v61, 0xffff0000, v59
    s_mov_b32 s58, 0xffff0000
    v_mov_b32 v40, v20
    v_lshl_or_b32 v41, v21, 16, v60
    v_or_b32 v42, v61, v16
    v_mov_b32 v43, v28
    v_alignbit_b32 v44, v22, v21, 16
    v_and_or_b32 v45, v22, s58, v60
    v_or_b32 v46, v61, v17
    v_mov_b32 v47, v29
    v_mov_b32 v48, v23
    v_lshl_or_b32 v49, v24, 16, v60
    v_or_b32 v50, v61, v18
    v_mov_b32 v51, v30
    v_alignbit_b32 v52, v25, v24, 16
    v_and_or_b32 v53, v25, s58, v60
    v_or_b32 v54, v61, v19
    v_mov_b32 v55, v31
    s_waitcnt lgkmcnt(0)
    v_add_lshl_u32 v32, v32, v36, 4
    ds_write_b128 v32, v[40:43] offset:2048
    v_add_lshl_u32 v33, v33, v37, 4
    ds_write_b128 v33, v[44:47] offset:2048
    v_add_lshl_u32 v34, v34, v38, 4
    ds_write_b128 v34, v[48:51] offset:2048
    v_add_lshl_u32 v35, v35, v39, 4
    ds_write_b128 v35, v[52:55] offset:2048
    v_mov_b32 v62, 163460
    s_waitcnt lgkmcnt(0)
    s_barrier
    ds_read_b32 v62, v62
    ds_read_b128 v[12:15], v5 offset:2048
    ds_read_b128 v[16:19], v5 offset:7168
    ds_read_b128 v[20:23], v5 offset:12288
    ds_read_b128 v[24:27], v5 offset:17408
    s_waitcnt lgkmcnt(3)
    buffer_store_dwordx4 v[12:15], v5, s[8:11], s64 offen sc1
    s_add_u32 s64, s64, 5120
    s_waitcnt lgkmcnt(2)
    buffer_store_dwordx4 v[16:19], v5, s[8:11], s64 offen sc1
    s_add_u32 s64, s64, 5120
    s_waitcnt lgkmcnt(1)
    buffer_store_dwordx4 v[20:23], v5, s[8:11], s64 offen sc1
    s_add_u32 s64, s64, 5120
    s_waitcnt lgkmcnt(0)
    buffer_store_dwordx4 v[24:27], v5, s[8:11], s64 offen sc1
    s_branch KS_JOIN
K2_PAD_B3:
    s_branch KS_HOP
KS_B3:
    v_mov_b32 v59, 163456
    ds_read_b32 v59, v59
    v_mov_b32 v62, 163460
    s_waitcnt lgkmcnt(0)
    s_barrier
    ds_read_b32 v62, v62
KS_JOIN:
    v_readfirstlane_b32 s2, v59
    s_mov_b32 s25, 0x400000
KS_JOIN2:
    s_waitcnt lgkmcnt(0)
    v_readfirstlane_b32 s24, v62
    s_nop 0
    s_cmp_eq_u32 s24, 0
    s_cbranch_scc1 KS_FLS
    s_bfe_u32 s24, s24, 0x10001
    s_xor_b32 s54, s54, s24
    s_lshr_b32 s21, s54, 1
    s_mul_i32 s21, s21, 625
    s_add_u32 s22, s21, 632
    s_add_u32 s21, s21, 7
    s_lshr_b32 s21, s21, 3
    s_lshr_b32 s22, s22, 3
    s_add_u32 s24, s21, 40
    s_sub_u32 s22, s22, s24
    s_bitcmp1_b32 s54, 0
    s_cselect_b32 s21, s24, s21
    s_cselect_b32 s22, s22, 40
    s_mov_b32 s23, 0
    s_mov_b32 s28, 1
    s_mov_b32 s24, 0
    s_mov_b32 s25, 1
K2_CELLS:
    v_lshrrev_b32 v178, 1, v177
    v_min_u32 v178, 249, v178
    v_mul_u32_u24 v72, 1152, v178
    s_and_b32 s58, s54, 7
    s_lshl_b32 s58, s58, 7
    s_lshr_b32 s59, s54, 5
    s_lshl_b32 s59, s59, 4
    s_add_u32 s67, s58, s59
    s_add_u32 s67, s67, 6291456
    s_cmp_eq_u32 s28, 0
    s_cbranch_scc1 K2_NOSRD
    s_mov_b32 s4, s80
    s_and_b32 s5, s81, 0xffff
    s_mov_b32 s6, 10240000
    s_mov_b32 s7, 0x20000
    s_mov_b32 s12, s96
    s_and_b32 s13, s97, 0xffff
    s_mov_b32 s14, 10240000
    s_mov_b32 s15, 0x20000
    s_mov_b32 s16, s84
    s_and_b32 s17, s85, 0xffff
    s_mov_b32 s18, 10240000
    s_mov_b32 s19, 0x20000
    s_sub_u32 s80, s80, 1024
    s_subb_u32 s81, s81, 0
    s_mov_b32 s72, s80
    s_and_b32 s73, s81, 0xffff
    s_mov_b32 s74, 10241024
    s_mov_b32 s75, 0x20000
    s_mov_b64 exec, 0
    s_cmp_eq_u32 s20, 0
    s_cbranch_scc1 K2_PAD_U20
    s_cmp_eq_u32 s20, 1
    s_cbranch_scc1 K2_PAD_U30
    s_cmp_eq_u32 s20, 2
    s_cbranch_scc1 K2_PAD_U21
    s_cmp_eq_u32 s20, 3
    s_cbranch_scc1 K2_PAD_U31
    s_cmp_eq_u32 s20, 4
    s_cbranch_scc1 K2_PAD_SW
    s_cmp_eq_u32 s20, 5
    s_cbranch_scc1 K2_PAD_TL
    s_cmp_eq_u32 s20, 6
    s_cbranch_scc1 K2_PAD_T2
K2_HOP:
    s_mov_b64 exec, -1
K2_NOSRD:
    v_and_b32 v84, 15, v176
    v_lshrrev_b32 v85, 5, v176
    v_bfe_u32 v86, v176, 4, 1
    v_lshrrev_b32 v87, 2, v84
    v_and_b32 v88, 3, v84
    v_lshl_add_u32 v89, v85, 2, v87
    v_lshlrev_b32 v249, 6, v89
    v_lshl_add_u32 v249, v88, 3, v249
    v_add_u32 v249, 512, v249
    v_lshrrev_b32 v90, 3, v84
    v_lshl_add_u32 v90, v90, 1, v86
    v_sub_u32 v90, v90, 1 clamp
    v_lshlrev_b32 v250, 1, v90
    v_lshl_add_u32 v91, v85, 2, v88
    v_lshl_add_u32 v250, v91, 4, v250
    v_and_b32 v91, 1, v87
    v_lshl_add_u32 v250, v91, 3, v250
    v_lshrrev_b32 v90, 1, v88
    v_lshl_add_u32 v90, v86, 1, v90
    v_bfe_u32 v91, v87, 1, 1
    v_lshlrev_b32 v91, 2, v91
    v_xor_b32 v90, v90, v91
    v_lshlrev_b32 v90, 4, v90
    v_lshl_add_u32 v90, v89, 7, v90
    v_and_b32 v91, 1, v88
    v_lshl_add_u32 v90, v91, 3, v90
    v_add_u32 v246, s37, v90
    v_xor_b32 v247, 64, v246
    v_lshrrev_b32 v90, 3, v176
    v_lshlrev_b32 v251, 4, v90
    v_bfe_u32 v90, v90, 1, 1
    v_lshlrev_b32 v90, 2, v90
    v_and_b32 v91, 7, v176
    v_xor_b32 v90, v90, v91
    v_lshlrev_b32 v248, 4, v90
    v_lshlrev_b32 v252, 1, v176
    v_and_b32 v231, 1, v176
    v_lshlrev_b32 v231, 4, v231
    v_lshrrev_b32 v90, 1, v176
    v_lshlrev_b32 v90, 5, v90
    v_add_u32 v230, 512, v90
    s_cmp_eq_u32 s28, 0
    s_cbranch_scc1 K2_NOW0
    v_lshrrev_b32 v60, 6, v252
    v_bfe_u32 v61, v252, 3, 2
    v_lshl_add_u32 v60, v60, 2, v61
    v_mul_u32_u24 v60, 640, v60
    v_bfe_u32 v61, v252, 5, 1
    v_lshl_add_u32 v60, v61, 5, v60
    v_and_b32 v61, 6, v252
    v_lshl_add_u32 v60, v61, 2, v60
    v_add_u32 v60, 24576, v60
    ds_read_b64_tr_b16 v[136:137], v60 offset:0
    ds_read_b64_tr_b16 v[138:139], v60 offset:5120
    ds_read_b64_tr_b16 v[140:141], v60 offset:64
    ds_read_b64_tr_b16 v[142:143], v60 offset:5184
    ds_read_b64_tr_b16 v[144:145], v60 offset:128
    ds_read_b64_tr_b16 v[146:147], v60 offset:5248
    ds_read_b64_tr_b16 v[148:149], v60 offset:192
    ds_read_b64_tr_b16 v[150:151], v60 offset:5312
    ds_read_b64_tr_b16 v[152:153], v60 offset:256
    ds_read_b64_tr_b16 v[154:155], v60 offset:5376
    ds_read_b64_tr_b16 v[156:157], v60 offset:320
    ds_read_b64_tr_b16 v[158:159], v60 offset:5440
    ds_read_b64_tr_b16 v[160:161], v60 offset:384
    ds_read_b64_tr_b16 v[162:163], v60 offset:5504
    ds_read_b64_tr_b16 v[164:165], v60 offset:448
    ds_read_b64_tr_b16 v[166:167], v60 offset:5568
    ds_read_b64_tr_b16 v[168:169], v60 offset:512
    ds_read_b64_tr_b16 v[170:171], v60 offset:5632
    ds_read_b64_tr_b16 v[172:173], v60 offset:576
    ds_read_b64_tr_b16 v[174:175], v60 offset:5696
    s_waitcnt lgkmcnt(0)
    v_lshlrev_b32 v96, 16, v136
    v_and_b32 v97, 0xffff0000, v136
    v_lshlrev_b32 v98, 16, v137
    v_and_b32 v99, 0xffff0000, v137
    v_lshlrev_b32 v100, 16, v138
    v_and_b32 v101, 0xffff0000, v138
    v_lshlrev_b32 v102, 16, v139
    v_and_b32 v103, 0xffff0000, v139
    v_lshlrev_b32 v104, 16, v140
    v_and_b32 v105, 0xffff0000, v140
    v_lshlrev_b32 v106, 16, v141
    v_and_b32 v107, 0xffff0000, v141
    v_lshlrev_b32 v108, 16, v142
    v_and_b32 v109, 0xffff0000, v142
    v_lshlrev_b32 v110, 16, v143
    v_and_b32 v111, 0xffff0000, v143
    v_lshlrev_b32 v112, 16, v144
    v_and_b32 v113, 0xffff0000, v144
    v_lshlrev_b32 v114, 16, v145
    v_and_b32 v115, 0xffff0000, v145
    v_lshlrev_b32 v116, 16, v146
    v_and_b32 v117, 0xffff0000, v146
    v_lshlrev_b32 v118, 16, v147
    v_and_b32 v119, 0xffff0000, v147
    v_lshlrev_b32 v120, 16, v148
    v_and_b32 v121, 0xffff0000, v148
    v_lshlrev_b32 v122, 16, v149
    v_and_b32 v123, 0xffff0000, v149
    v_lshlrev_b32 v124, 16, v150
    v_and_b32 v125, 0xffff0000, v150
    v_lshlrev_b32 v126, 16, v151
    v_and_b32 v127, 0xffff0000, v151
    buffer_load_dwordx4 v[76:79], v72, s[8:11], s67 offen sc1
    v_lshlrev_b32 v128, 16, v152
    v_and_b32 v129, 0xffff0000, v152
    v_lshlrev_b32 v130, 16, v153
    v_and_b32 v131, 0xffff0000, v153
    v_lshlrev_b32 v132, 16, v154
    v_and_b32 v133, 0xffff0000, v154
    v_lshlrev_b32 v134, 16, v155
    v_and_b32 v135, 0xffff0000, v155
    v_lshlrev_b32 v136, 16, v156
    v_and_b32 v137, 0xffff0000, v156
    v_lshlrev_b32 v138, 16, v157
    v_and_b32 v139, 0xffff0000, v157
    v_lshlrev_b32 v140, 16, v158
    v_and_b32 v141, 0xffff0000, v158
    v_lshlrev_b32 v142, 16, v159
    v_and_b32 v143, 0xffff0000, v159
    v_lshlrev_b32 v144, 16, v160
    v_and_b32 v145, 0xffff0000, v160
    v_lshlrev_b32 v146, 16, v161
    v_and_b32 v147, 0xffff0000, v161
    v_lshlrev_b32 v148, 16, v162
    v_and_b32 v149, 0xffff0000, v162
    v_lshlrev_b32 v150, 16, v163
    v_and_b32 v151, 0xffff0000, v163
    v_lshlrev_b32 v152, 16, v164
    v_and_b32 v153, 0xffff0000, v164
    v_lshlrev_b32 v154, 16, v165
    v_and_b32 v155, 0xffff0000, v165
    v_lshlrev_b32 v156, 16, v166
    v_and_b32 v157, 0xffff0000, v166
    v_lshlrev_b32 v158, 16, v167
    v_and_b32 v159, 0xffff0000, v167
    v_lshlrev_b32 v160, 16, v168
    v_and_b32 v161, 0xffff0000, v168
    v_lshlrev_b32 v162, 16, v169
    v_and_b32 v163, 0xffff0000, v169
    v_lshlrev_b32 v164, 16, v170
    v_and_b32 v165, 0xffff0000, v170
    v_lshlrev_b32 v166, 16, v171
    v_and_b32 v167, 0xffff0000, v171
    v_lshlrev_b32 v168, 16, v172
    v_and_b32 v169, 0xffff0000, v172
    v_lshlrev_b32 v170, 16, v173
    v_and_b32 v171, 0xffff0000, v173
    v_lshlrev_b32 v172, 16, v174
    v_and_b32 v173, 0xffff0000, v174
    v_lshlrev_b32 v174, 16, v175
    v_and_b32 v175, 0xffff0000, v175
K2_W0:
    s_lshl_b32 s59, s2, 22
    s_mov_b32 s60, 0x40000
    s_bfe_u32 s61, s54, 0x10004
    s_bfe_u32 s62, s54, 0x10003
    s_add_u32 s63, s61, s62
    s_mul_i32 s62, s62, 11
    s_sub_u32 s64, 11, s62
    v_cmp_gt_u32 vcc, 500, v177
    s_nop 0
    s_mov_b64 s[56:57], vcc
K2_POLL:
    s_waitcnt vmcnt(0)
    v_xor_b32 v73, s59, v76
    v_xor_b32 v74, s59, v77
    v_or_b32 v73, v73, v74
    v_xor_b32 v74, s2, v79
    v_lshrrev_b32 v73, 22, v73
    v_or_b32 v73, v73, v74
    v_cmp_ne_u32 vcc, 0, v73
    s_nop 0
    s_cbranch_vccz K2_POLLED
    s_sub_u32 s60, s60, 1
    s_cbranch_scc1 K2_END
    s_mov_b64 exec, vcc
    buffer_load_dwordx4 v[76:79], v72, s[8:11], s67 offen sc1
    s_mov_b64 exec, -1
    s_branch K2_POLL
K2_PAD_LD:
    s_branch KS_HOP
K2_POLLED:
    s_set_gpr_idx_on s61, gpr_idx(SRC0)
    s_nop 0
    v_bfe_u32 v179, v76, s62, 11
    s_set_gpr_idx_idx s63
    s_nop 0
    v_bfe_u32 v73, v76, s64, 11
    s_set_gpr_idx_off
    v_sub_u32 v73, v73, v179
    v_cndmask_b32 v73, 0, v73, s[56:57]
    v_and_b32 v1, 1, v177
    v_add_u32 v1, s23, v1
    v_sub_u32 v180, v73, v1
    v_add_u32 v179, v179, v1
    v_mul_u32_u24 v181, 20608, v178
    v_lshl_add_u32 v181, v179, 4, v181
    v_cmp_lt_i32 s[40:41], 0, v180
    v_add_u32 v182, 32, v181
    s_mov_b32 s65, 0
    s_mov_b64 exec, s[40:41]
    buffer_load_dwordx4 v[0:3], v181, s[8:11], 0 offen offset:0 sc1
    s_mov_b64 exec, -1
    v_cmp_lt_i32 s[42:43], 2, v180
    v_cmp_lt_i32 s[44:45], 4, v180
    v_cmp_lt_i32 s[46:47], 6, v180
    v_cmp_lt_i32 s[48:49], 8, v180
    v_cmp_lt_i32 s[50:51], 10, v180
    v_cmp_lt_i32 s[90:91], 12, v180
    v_cmp_lt_i32 s[92:93], 14, v180
    v_cmp_lt_i32 s[94:95], 16, v180
    v_cmp_lt_i32 s[96:97], 18, v180
    v_add_u32 v183, 64, v181
    v_add_u32 v184, 96, v181
    v_subrev_u32 v62, 1, v180
    v_ashrrev_i32 v62, 1, v62
    v_med3_i32 v62, v62, 0, 9
    s_cmp_eq_u64 s[42:43], 0
    s_cbranch_scc1 K2_LD_DONE
    v_mov_b32 v63, v62
    s_nop 1
    v_add_u32_dpp v63, v63, v63 row_shr:1 row_mask:0xf bank_mask:0xf bound_ctrl:0
    s_nop 1
    v_add_u32_dpp v63, v63, v63 row_shr:2 row_mask:0xf bank_mask:0xf bound_ctrl:0
    s_nop 1
    v_add_u32_dpp v63, v63, v63 row_shr:4 row_mask:0xf bank_mask:0xf bound_ctrl:0
    s_nop 1
    v_add_u32_dpp v63, v63, v63 row_shr:8 row_mask:0xf bank_mask:0xf bound_ctrl:0
    s_nop 1
    v_add_u32_dpp v63, v63, v63 row_bcast:15 row_mask:0xa bank_mask:0xf
    s_nop 1
    v_add_u32_dpp v63, v63, v63 row_bcast:31 row_mask:0xc bank_mask:0xf
    s_lshl_b32 s58, s20, 10
    s_add_u32 s58, s58, 45056
    v_readlane_b32 s59, v63, 63
    v_sub_u32 v63, v63, v62
    v_lshl_add_u32 v64, v63, 2, s58
    v_lshlrev_b32 v63, 5, v63
    v_sub_u32 v63, v182, v63
    s_cmp_gt_u32 s59, 189
    s_cbranch_scc1 K2_LD_GEN
    s_mov_b64 exec, s[42:43]
    s_cbranch_execz K2_LD_L
    ds_write_b32 v64, v63 offset:0
    s_mov_b64 exec, s[44:45]
    s_cbranch_execz K2_LD_L
    ds_write_b32 v64, v63 offset:4
    s_mov_b64 exec, s[46:47]
    s_cbranch_execz K2_LD_L
    ds_write_b32 v64, v63 offset:8
    s_mov_b64 exec, s[48:49]
    s_cbranch_execz K2_LD_L
    ds_write_b32 v64, v63 offset:12
    s_mov_b64 exec, s[50:51]
    s_cbranch_execz K2_LD_L
    ds_write_b32 v64, v63 offset:16
    s_mov_b64 exec, s[90:91]
    s_cbranch_execz K2_LD_L
    ds_write_b32 v64, v63 offset:20
    s_mov_b64 exec, s[92:93]
    s_cbranch_execz K2_LD_L
    ds_write_b32 v64, v63 offset:24
    s_mov_b64 exec, s[94:95]
    s_cbranch_execz K2_LD_L
    ds_write_b32 v64, v63 offset:28
    s_mov_b64 exec, s[96:97]
    s_cbranch_execz K2_LD_L
    ds_write_b32 v64, v63 offset:32
K2_LD_L:
    s_mov_b64 exec, -1
    v_lshl_add_u32 v63, v176, 2, s58
    v_lshlrev_b32 v62, 5, v176
    s_waitcnt lgkmcnt(0)
    ds_read_b32 v64, v63 offset:0
    ds_read_b32 v65, v63 offset:252
    ds_read_b32 v66, v63 offset:504
    s_min_u32 s60, s59, 63
    s_sub_u32 s59, s59, s60
    s_bfm_b64 s[42:43], s60, 0
    s_min_u32 s60, s59, 63
    s_sub_u32 s59, s59, s60
    s_bfm_b64 s[44:45], s60, 0
    s_min_u32 s60, s59, 63
    s_sub_u32 s59, s59, s60
    s_bfm_b64 s[46:47], s60, 0
    s_mov_b64 s[48:49], 0
    s_mov_b32 s65, 1
    s_mov_b32 s60, 0
    s_waitcnt lgkmcnt(2)
    v_add3_u32 v182, v62, v64, s60
    s_mov_b64 exec, s[42:43]
    buffer_load_dwordx4 v[4:7], v182, s[8:11], 0 offen sc1
    s_mov_b32 s60, 2016
    s_waitcnt lgkmcnt(1)
    v_add3_u32 v183, v62, v65, s60
    s_mov_b64 exec, s[44:45]
    buffer_load_dwordx4 v[8:11], v183, s[8:11], 0 offen sc1
    s_mov_b32 s60, 4032
    s_waitcnt lgkmcnt(0)
    v_add3_u32 v184, v62, v66, s60
    s_mov_b64 exec, s[46:47]
    buffer_load_dwordx4 v[12:15], v184, s[8:11], 0 offen sc1
K2_LD_DONE:
    s_mov_b64 exec, -1
    s_cmp_eq_u32 s28, 0
    s_cbranch_scc1 K2_WLATE
K2_NOWRAW:
K2_PAD_NW:
    s_cbranch_execz KS_HOP
    v_lshrrev_b32 v179, 2, v181
    v_lshrrev_b32 v185, 2, v182
    v_lshrrev_b32 v186, 2, v183
    v_lshrrev_b32 v187, 2, v184
    s_mov_b32 s66, 7340032
    v_mov_b32 v201, 1
    s_movk_i32 s58, 520
    s_movk_i32 s59, 2080
    s_mov_b32 s60, 0x40000
    s_mov_b32 s61, 0xffff
    v_mov_b32 v202, 65536
    s_cmp_lg_u32 s24, 0
    s_cbranch_scc1 K2_RK_LOAD
    v_cmp_lt_i32 vcc, 20, v180
    s_nop 0
    s_cbranch_vccz K2_NOMORE
    v_mov_b32 v61, 163300
    ds_write_b32 v61, v201
K2_NOMORE:
    s_mov_b32 s62, 82176
    s_cmp_eq_u32 s65, 0
    s_waitcnt vmcnt(3)
    s_cbranch_scc0 K2_ARR
    s_waitcnt vmcnt(0)
K2_ARR:
    s_mov_b64 exec, s[40:41]
    s_cbranch_execz K2_RK_A
K2_CK0:
    v_bfi_b32 v192, s61, v1, v2
    v_lshrrev_b32 v50, 24, v3
    v_cmp_ne_u32 vcc, s2, v192
    v_add_u32 v40, 163072, v50
    s_cbranch_vccnz K2_RT0
    ds_add_rtn_u32 v40, v40, v201
    v_mad_u32_u24 v50, v50, s58, v202
    s_mov_b64 exec, s[42:43]
    s_cbranch_execz K2_RK_A
    s_waitcnt vmcnt(2)
K2_CK1:
    v_bfi_b32 v192, s61, v5, v6
    v_lshrrev_b32 v51, 24, v7
    v_cmp_ne_u32 vcc, s2, v192
    v_add_u32 v41, 163072, v51
    s_cbranch_vccnz K2_RT1
    ds_add_rtn_u32 v41, v41, v201
    v_mad_u32_u24 v51, v51, s58, v202
    s_mov_b64 exec, s[44:45]
    s_cbranch_execz K2_RK_A
    s_waitcnt vmcnt(1)
K2_CK2:
    v_bfi_b32 v192, s61, v9, v10
    v_lshrrev_b32 v52, 24, v11
    v_cmp_ne_u32 vcc, s2, v192
    v_add_u32 v42, 163072, v52
    s_cbranch_vccnz K2_RT2
    ds_add_rtn_u32 v42, v42, v201
    v_mad_u32_u24 v52, v52, s58, v202
    s_mov_b64 exec, s[46:47]
    s_cbranch_execz K2_RK_A
    s_waitcnt vmcnt(0)
K2_CK3:
    v_bfi_b32 v192, s61, v13, v14
    v_lshrrev_b32 v53, 24, v15
    v_cmp_ne_u32 vcc, s2, v192
    v_add_u32 v43, 163072, v53
    s_cbranch_vccnz K2_RT3
    ds_add_rtn_u32 v43, v43, v201
    v_mad_u32_u24 v53, v53, s58, v202
    s_mov_b64 exec, s[48:49]
    s_cbranch_execz K2_RK_A
K2_CK4:
    v_bfi_b32 v192, s61, v17, v18
    v_lshrrev_b32 v54, 24, v19
    v_cmp_ne_u32 vcc, s2, v192
    v_add_u32 v44, 163072, v54
    s_cbranch_vccnz K2_RT4
    ds_add_rtn_u32 v44, v44, v201
    v_mad_u32_u24 v54, v54, s58, v202
    s_mov_b64 exec, s[50:51]
    s_cbranch_execz K2_RK_A
K2_CK5:
    v_bfi_b32 v192, s61, v21, v22
    v_lshrrev_b32 v55, 24, v23
    v_cmp_ne_u32 vcc, s2, v192
    v_add_u32 v45, 163072, v55
    s_cbranch_vccnz K2_RT5
    ds_add_rtn_u32 v45, v45, v201
    v_mad_u32_u24 v55, v55, s58, v202
    s_mov_b64 exec, s[90:91]
    s_cbranch_execz K2_RK_A
K2_CK6:
    v_bfi_b32 v192, s61, v25, v26
    v_lshrrev_b32 v56, 24, v27
    v_cmp_ne_u32 vcc, s2, v192
    v_add_u32 v46, 163072, v56
    s_cbranch_vccnz K2_RT6
    ds_add_rtn_u32 v46, v46, v201
    v_mad_u32_u24 v56, v56, s58, v202
    s_mov_b64 exec, s[92:93]
    s_cbranch_execz K2_RK_A
K2_CK7:
    v_bfi_b32 v192, s61, v29, v30
    v_lshrrev_b32 v57, 24, v31
    v_cmp_ne_u32 vcc, s2, v192
    v_add_u32 v47, 163072, v57
    s_cbranch_vccnz K2_RT7
    ds_add_rtn_u32 v47, v47, v201
    v_mad_u32_u24 v57, v57, s58, v202
    s_mov_b64 exec, s[94:95]
    s_cbranch_execz K2_RK_A
K2_CK8:
    v_bfi_b32 v192, s61, v33, v34
    v_lshrrev_b32 v58, 24, v35
    v_cmp_ne_u32 vcc, s2, v192
    v_add_u32 v48, 163072, v58
    s_cbranch_vccnz K2_RT8
    ds_add_rtn_u32 v48, v48, v201
    v_mad_u32_u24 v58, v58, s58, v202
    s_mov_b64 exec, s[96:97]
    s_cbranch_execz K2_RK_A
K2_CK9:
    v_bfi_b32 v192, s61, v37, v38
    v_lshrrev_b32 v59, 24, v39
    v_cmp_ne_u32 vcc, s2, v192
    v_add_u32 v49, 163072, v59
    s_cbranch_vccnz K2_RT9
    ds_add_rtn_u32 v49, v49, v201
    v_mad_u32_u24 v59, v59, s58, v202
K2_RK_A:
    s_mov_b64 exec, -1
    s_mov_b64 exec, s[40:41]
    s_cbranch_execz K2_TP
    v_cmp_gt_u32 vcc, s62, v50
    v_and_b32 v3, 0xffffff, v3
    s_mov_b64 exec, vcc
    buffer_load_dword v245, v3, s[16:19], 0 offen
    s_mov_b64 exec, s[42:43]
    s_cbranch_execz K2_TP
    v_cmp_gt_u32 vcc, s62, v51
    v_and_b32 v7, 0xffffff, v7
    s_mov_b64 exec, vcc
    buffer_load_dword v245, v7, s[16:19], 0 offen
    s_mov_b64 exec, s[44:45]
    s_cbranch_execz K2_TP
    v_cmp_gt_u32 vcc, s62, v52
    v_and_b32 v11, 0xffffff, v11
    s_mov_b64 exec, vcc
    buffer_load_dword v245, v11, s[16:19], 0 offen
    s_mov_b64 exec, s[46:47]
    s_cbranch_execz K2_TP
    v_cmp_gt_u32 vcc, s62, v53
    v_and_b32 v15, 0xffffff, v15
    s_mov_b64 exec, vcc
    buffer_load_dword v245, v15, s[16:19], 0 offen
    s_mov_b64 exec, s[48:49]
    s_cbranch_execz K2_TP
    v_cmp_gt_u32 vcc, s62, v54
    v_and_b32 v19, 0xffffff, v19
    s_mov_b64 exec, vcc
    buffer_load_dword v245, v19, s[16:19], 0 offen
    s_mov_b64 exec, s[50:51]
    s_cbranch_execz K2_TP
    v_cmp_gt_u32 vcc, s62, v55
    v_and_b32 v23, 0xffffff, v23
    s_mov_b64 exec, vcc
    buffer_load_dword v245, v23, s[16:19], 0 offen
    s_mov_b64 exec, s[90:91]
    s_cbranch_execz K2_TP
    v_cmp_gt_u32 vcc, s62, v56
    v_and_b32 v27, 0xffffff, v27
    s_mov_b64 exec, vcc
    buffer_load_dword v245, v27, s[16:19], 0 offen
    s_mov_b64 exec, s[92:93]
    s_cbranch_execz K2_TP
    v_cmp_gt_u32 vcc, s62, v57
    v_and_b32 v31, 0xffffff, v31
    s_mov_b64 exec, vcc
    buffer_load_dword v245, v31, s[16:19], 0 offen
    s_mov_b64 exec, s[94:95]
    s_cbranch_execz K2_TP
    v_cmp_gt_u32 vcc, s62, v58
    v_and_b32 v35, 0xffffff, v35
    s_mov_b64 exec, vcc
    buffer_load_dword v245, v35, s[16:19], 0 offen
    s_mov_b64 exec, s[96:97]
    s_cbranch_execz K2_TP
    v_cmp_gt_u32 vcc, s62, v59
    v_and_b32 v39, 0xffffff, v39
    s_mov_b64 exec, vcc
    buffer_load_dword v245, v39, s[16:19], 0 offen
K2_TP:
    s_mov_b64 exec, -1
K2_RK_DONE:
K2_PAD_SC:
    s_cbranch_execz KS_HOP
    s_mul_i32 s67, s24, 48
    s_movk_i32 s58, -1532
    s_waitcnt lgkmcnt(0)
    s_mov_b64 exec, s[40:41]
    s_cbranch_execz K2_SC_DONE
    v_cmpx_gt_u32 vcc, 64, v40
    v_bfe_u32 v194, v40, 3, 1
    v_add_u32 v193, 16, v40
    v_lshl_or_b32 v194, v40, 1, v194
    v_bfi_b32 v194, 15, v194, v40
    v_lshrrev_b32 v193, 6, v193
    v_alignbit_b32 v1, v2, v1, 16
    v_lshl_add_u32 v195, v194, 3, v50
    v_lshl_add_u32 v194, v194, 5, v50
    ds_write_b64 v195, v[0:1]
    v_mad_i32_i24 v194, v193, s58, v194
    ds_write_b32 v194, v3 offset:512
    s_mov_b64 exec, s[42:43]
    s_cbranch_execz K2_SC_DONE
    v_cmpx_gt_u32 vcc, 64, v41
    v_bfe_u32 v194, v41, 3, 1
    v_add_u32 v193, 16, v41
    v_lshl_or_b32 v194, v41, 1, v194
    v_bfi_b32 v194, 15, v194, v41
    v_lshrrev_b32 v193, 6, v193
    v_alignbit_b32 v5, v6, v5, 16
    v_lshl_add_u32 v195, v194, 3, v51
    v_lshl_add_u32 v194, v194, 5, v51
    ds_write_b64 v195, v[4:5]
    v_mad_i32_i24 v194, v193, s58, v194
    ds_write_b32 v194, v7 offset:512
    s_mov_b64 exec, s[44:45]
    s_cbranch_execz K2_SC_DONE
    v_cmpx_gt_u32 vcc, 64, v42
    v_bfe_u32 v194, v42, 3, 1
    v_add_u32 v193, 16, v42
    v_lshl_or_b32 v194, v42, 1, v194
    v_bfi_b32 v194, 15, v194, v42
    v_lshrrev_b32 v193, 6, v193
    v_alignbit_b32 v9, v10, v9, 16
    v_lshl_add_u32 v195, v194, 3, v52
    v_lshl_add_u32 v194, v194, 5, v52
    ds_write_b64 v195, v[8:9]
    v_mad_i32_i24 v194, v193, s58, v194
    ds_write_b32 v194, v11 offset:512
    s_mov_b64 exec, s[46:47]
    s_cbranch_execz K2_SC_DONE
    v_cmpx_gt_u32 vcc, 64, v43
    v_bfe_u32 v194, v43, 3, 1
    v_add_u32 v193, 16, v43
    v_lshl_or_b32 v194, v43, 1, v194
    v_bfi_b32 v194, 15, v194, v43
    v_lshrrev_b32 v193, 6, v193
    v_alignbit_b32 v13, v14, v13, 16
    v_lshl_add_u32 v195, v194, 3, v53
    v_lshl_add_u32 v194, v194, 5, v53
    ds_write_b64 v195, v[12:13]
    v_mad_i32_i24 v194, v193, s58, v194
    ds_write_b32 v194, v15 offset:512
    s_mov_b64 exec, s[48:49]
    s_cbranch_execz K2_SC_DONE
    v_cmpx_gt_u32 vcc, 64, v44
    v_bfe_u32 v194, v44, 3, 1
    v_add_u32 v193, 16, v44
    v_lshl_or_b32 v194, v44, 1, v194
    v_bfi_b32 v194, 15, v194, v44
    v_lshrrev_b32 v193, 6, v193
    v_alignbit_b32 v17, v18, v17, 16
    v_lshl_add_u32 v195, v194, 3, v54
    v_lshl_add_u32 v194, v194, 5, v54
    ds_write_b64 v195, v[16:17]
    v_mad_i32_i24 v194, v193, s58, v194
    ds_write_b32 v194, v19 offset:512
    s_mov_b64 exec, s[50:51]
    s_cbranch_execz K2_SC_DONE
    v_cmpx_gt_u32 vcc, 64, v45
    v_bfe_u32 v194, v45, 3, 1
    v_add_u32 v193, 16, v45
    v_lshl_or_b32 v194, v45, 1, v194
    v_bfi_b32 v194, 15, v194, v45
    v_lshrrev_b32 v193, 6, v193
    v_alignbit_b32 v21, v22, v21, 16
    v_lshl_add_u32 v195, v194, 3, v55
    v_lshl_add_u32 v194, v194, 5, v55
    ds_write_b64 v195, v[20:21]
    v_mad_i32_i24 v194, v193, s58, v194
    ds_write_b32 v194, v23 offset:512
    s_mov_b64 exec, s[90:91]
    s_cbranch_execz K2_SC_DONE
    v_cmpx_gt_u32 vcc, 64, v46
    v_bfe_u32 v194, v46, 3, 1
    v_add_u32 v193, 16, v46
    v_lshl_or_b32 v194, v46, 1, v194
    v_bfi_b32 v194, 15, v194, v46
    v_lshrrev_b32 v193, 6, v193
    v_alignbit_b32 v25, v26, v25, 16
    v_lshl_add_u32 v195, v194, 3, v56
    v_lshl_add_u32 v194, v194, 5, v56
    ds_write_b64 v195, v[24:25]
    v_mad_i32_i24 v194, v193, s58, v194
    ds_write_b32 v194, v27 offset:512
    s_mov_b64 exec, s[92:93]
    s_cbranch_execz K2_SC_DONE
    v_cmpx_gt_u32 vcc, 64, v47
    v_bfe_u32 v194, v47, 3, 1
    v_add_u32 v193, 16, v47
    v_lshl_or_b32 v194, v47, 1, v194
    v_bfi_b32 v194, 15, v194, v47
    v_lshrrev_b32 v193, 6, v193
    v_alignbit_b32 v29, v30, v29, 16
    v_lshl_add_u32 v195, v194, 3, v57
    v_lshl_add_u32 v194, v194, 5, v57
    ds_write_b64 v195, v[28:29]
    v_mad_i32_i24 v194, v193, s58, v194
    ds_write_b32 v194, v31 offset:512
    s_mov_b64 exec, s[94:95]
    s_cbranch_execz K2_SC_DONE
    v_cmpx_gt_u32 vcc, 64, v48
    v_bfe_u32 v194, v48, 3, 1
    v_add_u32 v193, 16, v48
    v_lshl_or_b32 v194, v48, 1, v194
    v_bfi_b32 v194, 15, v194, v48
    v_lshrrev_b32 v193, 6, v193
    v_alignbit_b32 v33, v34, v33, 16
    v_lshl_add_u32 v195, v194, 3, v58
    v_lshl_add_u32 v194, v194, 5, v58
    ds_write_b64 v195, v[32:33]
    v_mad_i32_i24 v194, v193, s58, v194
    ds_write_b32 v194, v35 offset:512
    s_mov_b64 exec, s[96:97]
    s_cbranch_execz K2_SC_DONE
    v_cmpx_gt_u32 vcc, 64, v49
    v_bfe_u32 v194, v49, 3, 1
    v_add_u32 v193, 16, v49
    v_lshl_or_b32 v194, v49, 1, v194
    v_bfi_b32 v194, 15, v194, v49
    v_lshrrev_b32 v193, 6, v193
    v_alignbit_b32 v37, v38, v37, 16
    v_lshl_add_u32 v195, v194, 3, v59
    v_lshl_add_u32 v194, v194, 5, v59
    ds_write_b64 v195, v[36:37]
    v_mad_i32_i24 v194, v193, s58, v194
    ds_write_b32 v194, v39 offset:512
K2_SC_DONE:
    s_mov_b64 exec, -1
K2_PAD_SD:
    s_cbranch_execz KS_HOP
    v_lshlrev_b32 v192, 2, v176
    v_add_u32 v192, 163072, v192
    v_mov_b32 v200, 163300
    s_cmp_eq_u32 s24, 0
    s_cselect_b32 s26, 64, 48
    s_waitcnt lgkmcnt(0)
    s_barrier
    ds_read_b32 v193, v192
    ds_read_b32 v200, v200
    v_cmp_gt_u32 s[56:57], s22, v176
    v_mad_u32_u24 v195, v176, s59, v202
    s_waitcnt lgkmcnt(0)
    v_cndmask_b32 v193, 0, v193, s[56:57]
    v_readfirstlane_b32 s27, v200
    v_cmp_lt_u32 s[62:63], 48, v193
    v_cmp_lt_u32 vcc, 64, v193
    s_bcnt1_i32_b64 s60, s[62:63]
    v_mbcnt_lo_u32_b32 v198, s62, 0
    v_mbcnt_hi_u32_b32 v198, s63, v198
    s_cbranch_vccnz K2_BIG
    s_cmp_gt_u32 s60, 8
    s_cbranch_scc1 K2_BIG
K2_TOK:
    v_subrev_u32 v194, s67, v193
    v_max_i32 v194, 1, v194
    v_min_i32 v194, s26, v194
    v_add_u32 v194, 15, v194
    v_lshrrev_b32 v194, 3, v194
    v_lshl_or_b32 v195, v194, 18, v195
    v_lshl_or_b32 v195, v198, 27, v195
    v_mov_b32 v197, 949760
    v_cndmask_b32 v253, v197, v195, s[56:57]
    s_movk_i32 s40, 0
    s_movk_i32 s41, 256
    s_movk_i32 s42, 512
    s_movk_i32 s43, 768
    s_add_u32 s24, s24, 1
    s_cmp_ge_u32 s24, s25
    s_cselect_b32 s55, 1, 0
    s_cmp_eq_u32 s27, 0
    s_cselect_b32 s55, s55, 0
    s_mov_b32 s27, 0x400000
    s_mov_b32 s38, 0
    s_mov_b32 s34, 0
    s_mov_b32 s35, 0
    s_mov_b32 s36, 1
    s_mov_b32 s31, 0
    s_mov_b32 s58, s20
    v_readlane_b32 s3, v253, s58
    s_lshl_b32 s44, s34, 7
    s_and_b32 s48, s3, 0x3ffff
    s_bfe_u32 s33, s3, 0x30013
    s_mul_i32 s35, s38, 6
    s_cmp_eq_u32 s34, 0
    s_cselect_b32 s35, s35, s48
    s_mov_b32 s45, s44
    s_xor_b32 s47, s44, 256
    s_add_u32 s49, s48, 128
    s_add_u32 s60, s48, 256
    s_cmp_eq_u32 s33, 3
    s_cselect_b32 s46, s44, s47
    s_cselect_b32 s50, s60, s48
    s_cselect_b32 s51, s48, s49
    s_sub_u32 s60, s33, 2
    s_cmp_lt_u32 s60, 2
    s_cbranch_scc0 K2_rare_1
K2_back_2:
    v_add_u32 v233, s48, v230
    ds_read_b32 v232, v233
    ds_read_b32 v233, v233 offset:1024
    v_add_u32 v222, s48, v251
    ds_read2_b32 v[222:223], v222 offset0:1 offset1:3
    v_add_u32 v224, s49, v251
    ds_read2_b32 v[224:225], v224 offset0:1 offset1:3
    v_add_u32 v226, s50, v251
    ds_read2_b32 v[226:227], v226 offset0:1 offset1:3
    v_add_u32 v228, s51, v251
    ds_read2_b32 v[228:229], v228 offset0:1 offset1:3
    s_waitcnt lgkmcnt(4)
    v_or_b32 v232, v232, v231
    v_or_b32 v233, v233, v231
    s_cmp_lg_u32 s34, 0
    s_cbranch_scc1 K2_dum_4
    s_cmp_eq_u32 s33, 4
    s_cbranch_scc1 K2_a4_5
K2_b4_7:
    s_add_u32 m0, s48, 512
    s_add_u32 s65, s48, 1536
    buffer_load_dwordx4 v232, s[16:19], 0 offen  lds
    s_mov_b32 m0, s65
    s_mov_b32 exec_hi, 0
    buffer_load_dwordx4 v233, s[16:19], 0 offen  lds
    s_mov_b32 exec_hi, -1
K2_back_6:
    s_waitcnt lgkmcnt(3)
    v_mad_u32_u16 v222, v222, s39, v248 op_sel:[1,0,0,0]
    v_mad_u32_u16 v223, v223, s39, v248 op_sel:[1,0,0,0]
    s_waitcnt lgkmcnt(2)
    v_mad_u32_u16 v224, v224, s39, v248 op_sel:[1,0,0,0]
    v_mad_u32_u16 v225, v225, s39, v248 op_sel:[1,0,0,0]
    s_waitcnt lgkmcnt(1)
    v_mad_u32_u16 v226, v226, s39, v248 op_sel:[1,0,0,0]
    v_mad_u32_u16 v227, v227, s39, v248 op_sel:[1,0,0,0]
    s_waitcnt lgkmcnt(0)
    v_mad_u32_u16 v228, v228, s39, v248 op_sel:[1,0,0,0]
    v_mad_u32_u16 v229, v229, s39, v248 op_sel:[1,0,0,0]
    s_mov_b32 m0, s68
    s_nop 0
    buffer_load_dwordx4 v222, s[4:7], s44 offen sc1 lds
    buffer_load_dwordx4 v223, s[72:75], s44 offen offset:1024 sc1 lds
    s_mov_b32 m0, s69
    s_nop 0
    buffer_load_dwordx4 v224, s[4:7], s45 offen sc1 lds
    buffer_load_dwordx4 v225, s[72:75], s45 offen offset:1024 sc1 lds
    s_mov_b32 m0, s70
    s_nop 0
    buffer_load_dwordx4 v226, s[4:7], s46 offen sc1 lds
    buffer_load_dwordx4 v227, s[72:75], s46 offen offset:1024 sc1 lds
    s_mov_b32 m0, s71
    s_nop 0
    buffer_load_dwordx4 v228, s[4:7], s47 offen sc1 lds
    buffer_load_dwordx4 v229, s[72:75], s47 offen offset:1024 sc1 lds
    v_add_u32 v249, s48, v249
    v_add_u32 v250, s48, v250
    s_waitcnt vmcnt(6)
    ds_read_b64_tr_b16 v[176:177], v246 offset:0
    ds_read_b64_tr_b16 v[178:179], v246 offset:1024
    ds_read_b64_tr_b16 v[180:181], v247 offset:0
    ds_read_b64_tr_b16 v[182:183], v247 offset:1024
    ds_read_b64_tr_b16 v[0:1], v249 offset:0
    ds_read_b64_tr_b16 v[2:3], v249 offset:32
    ds_read_u16_d16_hi v16, v250 offset:0
    ds_read_b64_tr_b16 v[4:5], v249 offset:512
    ds_read_b64_tr_b16 v[6:7], v249 offset:544
    ds_read_u16_d16_hi v17, v250 offset:128
    s_mov_b32 s29, s48
    s_mov_b32 s32, s31
    s_mov_b32 s30, s3
    s_mov_b32 s31, s35
    s_bfe_u32 s56, s3, 0x40012
    s_cmp_eq_u32 s56, 5
    s_cbranch_scc1 K2_U20
    s_cmp_eq_u32 s56, 6
    s_cbranch_scc1 K2_U3h0
    s_branch K2_DSP0
K2_PAD_H1:
    s_branch KS_HOP0
KS_HELP:
    s_mov_b32 s30, 0
    s_cmp_eq_u32 s20, 6
    s_cbranch_scc1 KS_RAW
    s_mov_b32 s30, 2
    s_cmp_ge_u32 s2, 170
    s_cbranch_scc1 KS_NOW
    s_mov_b32 s30, 1
    v_and_b32 v1, 15, v8
    v_lshrrev_b32 v3, 4, v8
    s_cmp_ge_u32 s2, 160
    s_cbranch_scc1 K1_WT
    s_cmp_ge_u32 s2, 64
    s_cbranch_scc1 K1_S1
    s_lshr_b32 s24, s2, 3
    s_and_b32 s25, s2, 7
    s_lshr_b32 s26, s25, 2
    s_bfe_u32 s27, s25, 0x10001
    s_and_b32 s28, s25, 1
    s_mov_b32 s60, s92
    s_and_b32 s61, s93, 0xffff
    s_mov_b32 s62, 65536
    s_mov_b32 s63, 0x20000
    s_branch K1_SC
K1_S1:
    s_sub_u32 s29, s2, 64
    s_mul_i32 s24, s29, 43
    s_lshr_b32 s24, s24, 9
    s_mul_i32 s25, s24, 12
    s_sub_u32 s25, s29, s25
    s_cmp_ge_u32 s25, 6
    s_cselect_b32 s26, 1, 0
    s_mul_i32 s27, s26, 6
    s_sub_u32 s27, s25, s27
    s_lshr_b32 s27, s27, 1
    s_and_b32 s28, s25, 1
    s_add_u32 s25, s25, 8
    s_mov_b32 s60, s94
    s_and_b32 s61, s95, 0xffff
    s_mov_b32 s62, 98304
    s_mov_b32 s63, 0x20000
K1_SC:
    s_lshl_b32 s27, s27, 7
    s_lshl_b32 s26, s26, 6
    s_lshl_b32 s28, s28, 4
    s_add_u32 s27, s27, s26
    s_add_u32 s27, s27, s28
    s_lshl_b32 s27, s27, 8
    s_lshl_b32 s26, s24, 5
    s_add_u32 s27, s27, s26
    s_add_u32 s29, s27, 8192
    v_lshlrev_b32 v3, 10, v3
    v_lshl_add_u32 v3, v1, 1, v3
    buffer_load_ushort v64, v3, s[60:63], s27 offen offset:0
    buffer_load_ushort v65, v3, s[60:63], s29 offen offset:0
    buffer_load_ushort v66, v3, s[60:63], s27 offen offset:256
    buffer_load_ushort v67, v3, s[60:63], s29 offen offset:256
    buffer_load_ushort v68, v3, s[60:63], s27 offen offset:512
    buffer_load_ushort v69, v3, s[60:63], s29 offen offset:512
    buffer_load_ushort v70, v3, s[60:63], s27 offen offset:768
    buffer_load_ushort v71, v3, s[60:63], s29 offen offset:768
    s_mul_i32 s24, s24, 20
    s_add_u32 s24, s24, s25
    s_lshl_b32 s24, s24, 10
    s_add_u32 s24, s24, 6946816
    s_branch K1_GO
K1_WT:
    s_sub_u32 s24, s2, 160
    s_lshr_b32 s27, s24, 1
    s_and_b32 s28, s24, 1
    s_lshl_b32 s27, s27, 8
    s_lshl_b32 s28, s28, 6
    s_add_u32 s27, s27, s28
    s_add_u32 s29, s27, 10240
    s_mov_b32 s60, s90
    s_and_b32 s61, s91, 0xffff
    s_mov_b32 s62, 20480
    s_mov_b32 s63, 0x20000
    v_and_b32 v1, 31, v8
    v_lshrrev_b32 v3, 5, v8
    v_mul_u32_u24 v3, 5120, v3
    v_lshl_add_u32 v3, v1, 1, v3
    buffer_load_ushort v64, v3, s[60:63], s27 offen offset:0
    buffer_load_ushort v65, v3, s[60:63], s27 offen offset:1280
    buffer_load_ushort v66, v3, s[60:63], s27 offen offset:2560
    buffer_load_ushort v67, v3, s[60:63], s27 offen offset:3840
    buffer_load_ushort v68, v3, s[60:63], s29 offen offset:0
    buffer_load_ushort v69, v3, s[60:63], s29 offen offset:1280
    buffer_load_ushort v70, v3, s[60:63], s29 offen offset:2560
    buffer_load_ushort v71, v3, s[60:63], s29 offen offset:3840
    s_lshl_b32 s24, s24, 10
    s_add_u32 s24, s24, 7110656
K1_GO:
KS_NOW:
    s_barrier
K2_PAD_H2:
    s_cbranch_execz KS_HOP0
    v_and_b32 v76, 31, v8
    v_lshrrev_b32 v77, 5, v8
    v_mov_b32 v80, 0
    v_mul_u32_u24 v77, 2080, v77
    v_mov_b32 v81, 0xffff0000
    v_lshl_add_u32 v78, v76, 4, v77
    v_mov_b32 v82, 0
    v_add_u32 v78, 65536, v78
    v_mov_b32 v83, v81
    v_add_u32 v79, 41600, v78
    ds_write_b128 v78, v[80:83] offset:0
    ds_write_b128 v78, v[80:83] offset:4160
    ds_write_b128 v78, v[80:83] offset:8320
    ds_write_b128 v78, v[80:83] offset:12480
    ds_write_b128 v78, v[80:83] offset:16640
    ds_write_b128 v78, v[80:83] offset:20800
    ds_write_b128 v78, v[80:83] offset:24960
    ds_write_b128 v78, v[80:83] offset:29120
    ds_write_b128 v78, v[80:83] offset:33280
    ds_write_b128 v78, v[80:83] offset:37440
    ds_write_b128 v79, v[80:83] offset:0
    ds_write_b128 v79, v[80:83] offset:4160
    ds_write_b128 v79, v[80:83] offset:8320
    ds_write_b128 v79, v[80:83] offset:12480
    ds_write_b128 v79, v[80:83] offset:16640
    ds_write_b128 v79, v[80:83] offset:20800
    ds_write_b128 v79, v[80:83] offset:24960
    ds_write_b128 v79, v[80:83] offset:29120
    ds_write_b128 v79, v[80:83] offset:33280
    ds_write_b128 v79, v[80:83] offset:37440
KS_FILL:
    v_mov_b32 v59, 163456
    s_barrier
    ds_read_b32 v59, v59
    s_waitcnt vmcnt(0) lgkmcnt(0)
    s_cmp_eq_u32 s30, 0
    s_cbranch_scc1 KS_B3
    s_cmp_eq_u32 s30, 2
    s_cbranch_scc1 KS_NOST
    v_lshl_or_b32 v40, v65, 16, v64
    v_lshl_or_b32 v41, v67, 16, v66
    v_lshl_or_b32 v42, v69, 16, v68
    v_lshl_or_b32 v43, v71, 16, v70
    buffer_store_dwordx4 v[40:43], v9, s[8:11], s24 offen sc1
KS_NOST:
    v_mov_b32 v62, 163460
    s_waitcnt lgkmcnt(0)
    s_barrier
    ds_read_b32 v62, v62
    s_lshl_b32 s24, s2, 2
    s_add_u32 s24, s24, 7176192
    s_mov_b64 exec, 1
    s_waitcnt vmcnt(0)
    buffer_store_dword v59, v6, s[8:11], s24 offen sc1
    s_mov_b64 exec, -1
    s_branch KS_JOIN
K2_PAD_H3:
    s_branch KS_HOP0
KS_RAW:
    s_cmp_lg_u32 s2, 0
    s_cbranch_scc1 KS_NOX
    s_mov_b32 s60, s98
    s_and_b32 s61, s99, 0xffff
    s_mov_b32 s62, 256
    s_mov_b32 s63, 0x20000
    s_getreg_b32 s24, hwreg(HW_REG_XCC_ID, 0, 1)
    s_add_u32 s24, s24, 1
    v_mov_b32 v10, s24
    v_mov_b32 v11, 0
    s_mov_b64 exec, 1
    buffer_atomic_cmpswap v[10:11], v6, s[60:63], 0 offen sc1
    s_mov_b64 exec, -1
KS_NOX:
    s_barrier
    s_mov_b32 s60, s90
    s_and_b32 s61, s91, 0xffff
    s_mov_b32 s62, 20480
    s_mov_b32 s63, 0x20000
    v_lshrrev_b32 v10, 3, v8
    v_and_b32 v11, 7, v8
    v_lshlrev_b32 v10, 8, v10
    v_lshl_add_u32 v10, v11, 4, v10
    s_mov_b32 m0, 24576
    s_movk_i32 s24, 0
    buffer_load_dwordx4 v10, s[60:63], s24 offen lds
    s_mov_b32 m0, 25600
    s_movk_i32 s24, 2048
    buffer_load_dwordx4 v10, s[60:63], s24 offen lds
    s_mov_b32 m0, 26624
    s_movk_i32 s24, 4096
    buffer_load_dwordx4 v10, s[60:63], s24 offen lds
    s_mov_b32 m0, 27648
    s_movk_i32 s24, 6144
    buffer_load_dwordx4 v10, s[60:63], s24 offen lds
    s_mov_b32 m0, 28672
    s_movk_i32 s24, 8192
    buffer_load_dwordx4 v10, s[60:63], s24 offen lds
    s_mov_b32 m0, 29696
    s_movk_i32 s24, 10240
    buffer_load_dwordx4 v10, s[60:63], s24 offen lds
    s_mov_b32 m0, 30720
    s_movk_i32 s24, 12288
    buffer_load_dwordx4 v10, s[60:63], s24 offen lds
    s_mov_b32 m0, 31744
    s_movk_i32 s24, 14336
    buffer_load_dwordx4 v10, s[60:63], s24 offen lds
    s_mov_b32 m0, 32768
    s_movk_i32 s24, 16384
    buffer_load_dwordx4 v10, s[60:63], s24 offen lds
    s_mov_b32 m0, 33792
    s_movk_i32 s24, 18432
    buffer_load_dwordx4 v10, s[60:63], s24 offen lds
    s_mov_b32 m0, 152832
    s_movk_i32 s24, 128
    buffer_load_dwordx4 v10, s[60:63], s24 offen lds
    s_mov_b32 m0, 153856
    s_movk_i32 s24, 2176
    buffer_load_dwordx4 v10, s[60:63], s24 offen lds
    s_mov_b32 m0, 154880
    s_movk_i32 s24, 4224
    buffer_load_dwordx4 v10, s[60:63], s24 offen lds
    s_mov_b32 m0, 155904
    s_movk_i32 s24, 6272
    buffer_load_dwordx4 v10, s[60:63], s24 offen lds
    s_mov_b32 m0, 156928
    s_movk_i32 s24, 8320
    buffer_load_dwordx4 v10, s[60:63], s24 offen lds
    s_mov_b32 m0, 157952
    s_movk_i32 s24, 10368
    buffer_load_dwordx4 v10, s[60:63], s24 offen lds
    s_mov_b32 m0, 158976
    s_movk_i32 s24, 12416
    buffer_load_dwordx4 v10, s[60:63], s24 offen lds
    s_mov_b32 m0, 160000
    s_movk_i32 s24, 14464
    buffer_load_dwordx4 v10, s[60:63], s24 offen lds
    s_mov_b32 m0, 161024
    s_movk_i32 s24, 16512
    buffer_load_dwordx4 v10, s[60:63], s24 offen lds
    s_mov_b32 m0, 162048
    s_movk_i32 s24, 18560
    buffer_load_dwordx4 v10, s[60:63], s24 offen lds
    v_add_u32 v85, 16, v8
    v_lshlrev_b32 v84, 5, v8
    v_lshrrev_b32 v85, 6, v85
    v_mul_u32_u24 v85, 1532, v85
    v_sub_u32 v84, v84, v85
    v_mov_b32 v85, -1
    v_add_u32 v84, 66048, v84
    v_add_u32 v86, 41600, v84
    ds_write_b32 v84, v85 offset:0
    ds_write_b32 v84, v85 offset:2080
    ds_write_b32 v84, v85 offset:4160
    ds_write_b32 v84, v85 offset:6240
    ds_write_b32 v84, v85 offset:8320
    ds_write_b32 v84, v85 offset:10400
    ds_write_b32 v84, v85 offset:12480
    ds_write_b32 v84, v85 offset:14560
    ds_write_b32 v84, v85 offset:16640
    ds_write_b32 v84, v85 offset:18720
    ds_write_b32 v84, v85 offset:20800
    ds_write_b32 v84, v85 offset:22880
    ds_write_b32 v84, v85 offset:24960
    ds_write_b32 v84, v85 offset:27040
    ds_write_b32 v84, v85 offset:29120
    ds_write_b32 v84, v85 offset:31200
    ds_write_b32 v84, v85 offset:33280
    ds_write_b32 v84, v85 offset:35360
    ds_write_b32 v84, v85 offset:37440
    ds_write_b32 v84, v85 offset:39520
    ds_write_b32 v86, v85 offset:0
    ds_write_b32 v86, v85 offset:2080
    ds_write_b32 v86, v85 offset:4160
    ds_write_b32 v86, v85 offset:6240
    ds_write_b32 v86, v85 offset:8320
    ds_write_b32 v86, v85 offset:10400
    ds_write_b32 v86, v85 offset:12480
    ds_write_b32 v86, v85 offset:14560
    ds_write_b32 v86, v85 offset:16640
    ds_write_b32 v86, v85 offset:18720
    ds_write_b32 v86, v85 offset:20800
    ds_write_b32 v86, v85 offset:22880
    ds_write_b32 v86, v85 offset:24960
    ds_write_b32 v86, v85 offset:27040
    ds_write_b32 v86, v85 offset:29120
    ds_write_b32 v86, v85 offset:31200
    ds_write_b32 v86, v85 offset:33280
    ds_write_b32 v86, v85 offset:35360
    ds_write_b32 v86, v85 offset:37440
    ds_write_b32 v86, v85 offset:39520
    s_branch KS_FILL
KS_IDLE:
    s_barrier
    s_barrier
    s_branch KS_B3
K2_PAD_U20:
    s_branch K2_HOP
K2_U20:
    s_setprio 1
    s_waitcnt lgkmcnt(0)
    v_lshlrev_b32 v20, 16, v0
    v_and_b32 v21, 0xffff0000, v0
    v_lshlrev_b32 v22, 16, v1
    v_and_b32 v23, 0xffff0000, v1
    v_lshlrev_b32 v24, 16, v2
    v_and_b32 v25, 0xffff0000, v2
    v_lshlrev_b32 v26, 16, v3
    v_and_b32 v27, 0xffff0000, v3
    v_mul_f32_dpp v36, v16, v20 row_newbcast:8 row_mask:0xf bank_mask:0xf
    v_mul_f32_dpp v37, v16, v21 row_newbcast:9 row_mask:0xf bank_mask:0xf
    v_mul_f32_dpp v38, v16, v22 row_newbcast:10 row_mask:0xf bank_mask:0xf
    v_mul_f32_dpp v39, v16, v23 row_newbcast:11 row_mask:0xf bank_mask:0xf
    v_mul_f32_dpp v40, v16, v24 row_newbcast:12 row_mask:0xf bank_mask:0xf
    v_mul_f32_dpp v41, v16, v25 row_newbcast:13 row_mask:0xf bank_mask:0xf
    v_mul_f32_dpp v42, v16, v26 row_newbcast:14 row_mask:0xf bank_mask:0xf
    v_mul_f32_dpp v43, v16, v27 row_newbcast:15 row_mask:0xf bank_mask:0xf
    v_cvt_pk_bf16_f32 v68, v36, v37
    v_cvt_pk_bf16_f32 v69, v38, v39
    v_cvt_pk_bf16_f32 v70, v40, v41
    v_cvt_pk_bf16_f32 v71, v42, v43
    v_mul_f32_dpp v20, v16, v20 row_newbcast:0 row_mask:0xa bank_mask:0xf
    v_mul_f32_dpp v21, v16, v21 row_newbcast:1 row_mask:0xa bank_mask:0xf
    v_mul_f32_dpp v22, v16, v22 row_newbcast:2 row_mask:0xa bank_mask:0xf
    v_mul_f32_dpp v23, v16, v23 row_newbcast:3 row_mask:0xa bank_mask:0xf
    v_mul_f32_dpp v24, v16, v24 row_newbcast:4 row_mask:0xa bank_mask:0xf
    v_mul_f32_dpp v25, v16, v25 row_newbcast:5 row_mask:0xa bank_mask:0xf
    v_mul_f32_dpp v26, v16, v26 row_newbcast:6 row_mask:0xa bank_mask:0xf
    v_mul_f32_dpp v27, v16, v27 row_newbcast:7 row_mask:0xa bank_mask:0xf
    v_cvt_pk_bf16_f32 v64, v20, v21
    v_cvt_pk_bf16_f32 v65, v22, v23
    v_cvt_pk_bf16_f32 v66, v24, v25
    v_cvt_pk_bf16_f32 v67, v26, v27
    v_lshlrev_b32 v28, 16, v4
    v_and_b32 v29, 0xffff0000, v4
    v_lshlrev_b32 v30, 16, v5
    v_and_b32 v31, 0xffff0000, v5
    v_lshlrev_b32 v32, 16, v6
    v_and_b32 v33, 0xffff0000, v6
    v_lshlrev_b32 v34, 16, v7
    v_and_b32 v35, 0xffff0000, v7
    v_mul_f32_dpp v36, v17, v28 row_newbcast:8 row_mask:0xf bank_mask:0xf
    v_mul_f32_dpp v37, v17, v29 row_newbcast:9 row_mask:0xf bank_mask:0xf
    v_mul_f32_dpp v38, v17, v30 row_newbcast:10 row_mask:0xf bank_mask:0xf
    v_mul_f32_dpp v39, v17, v31 row_newbcast:11 row_mask:0xf bank_mask:0xf
    v_mul_f32_dpp v40, v17, v32 row_newbcast:12 row_mask:0xf bank_mask:0xf
    v_mul_f32_dpp v41, v17, v33 row_newbcast:13 row_mask:0xf bank_mask:0xf
    v_mul_f32_dpp v42, v17, v34 row_newbcast:14 row_mask:0xf bank_mask:0xf
    v_mul_f32_dpp v43, v17, v35 row_newbcast:15 row_mask:0xf bank_mask:0xf
    v_cvt_pk_bf16_f32 v76, v36, v37
    v_cvt_pk_bf16_f32 v77, v38, v39
    v_cvt_pk_bf16_f32 v78, v40, v41
    v_cvt_pk_bf16_f32 v79, v42, v43
    v_mul_f32_dpp v28, v17, v28 row_newbcast:0 row_mask:0xa bank_mask:0xf
    v_mul_f32_dpp v29, v17, v29 row_newbcast:1 row_mask:0xa bank_mask:0xf
    v_mul_f32_dpp v30, v17, v30 row_newbcast:2 row_mask:0xa bank_mask:0xf
    v_mul_f32_dpp v31, v17, v31 row_newbcast:3 row_mask:0xa bank_mask:0xf
    v_mul_f32_dpp v32, v17, v32 row_newbcast:4 row_mask:0xa bank_mask:0xf
    v_mul_f32_dpp v33, v17, v33 row_newbcast:5 row_mask:0xa bank_mask:0xf
    v_mul_f32_dpp v34, v17, v34 row_newbcast:6 row_mask:0xa bank_mask:0xf
    v_mul_f32_dpp v35, v17, v35 row_newbcast:7 row_mask:0xa bank_mask:0xf
    v_cvt_pk_bf16_f32 v72, v28, v29
    v_cvt_pk_bf16_f32 v73, v30, v31
    v_cvt_pk_bf16_f32 v74, v32, v33
    v_cvt_pk_bf16_f32 v75, v34, v35
    s_waitcnt vmcnt(4)
    v_mfma_f32_32x32x16_bf16 v[0:15], v[64:67], v[176:179], 0
    ds_read_b64_tr_b16 v[184:185], v246 offset:2048
    ds_read_b64_tr_b16 v[186:187], v246 offset:3072
    ds_read_b64_tr_b16 v[188:189], v247 offset:2048
    ds_read_b64_tr_b16 v[190:191], v247 offset:3072
    s_mov_b32 m0, s68
    v_mfma_f32_32x32x16_bf16 v[16:31], v[68:71], v[176:179], 0
    buffer_load_dwordx4 v222, s[4:7], s42 offen sc1 lds
    buffer_load_dwordx4 v223, s[72:75], s42 offen offset:1024 sc1 lds
    v_permlane32_swap_b32 v242, v236
    v_permlane32_swap_b32 v243, v237
    s_add_u32 s38, s38, 1
    v_mfma_f32_32x32x16_bf16 v[32:47], v[64:67], v[180:183], 0
    v_permlane32_swap_b32 v244, v238
    v_permlane32_swap_b32 v245, v239
    v_permlane32_swap_b32 v240, v241
    v_add_f32 v242, v242, v236
    v_mfma_f32_32x32x16_bf16 v[48:63], v[68:71], v[180:183], 0
    v_add_f32 v243, v243, v237
    v_add_f32 v244, v244, v238
    v_add_f32 v245, v245, v239
    v_add_f32 v240, -v240, -v241
    v_mov_b32 v254, s52
    v_mov_b32 v255, s38
    s_waitcnt vmcnt(4) lgkmcnt(0)
    v_mfma_f32_32x32x16_bf16 v[0:15], v[72:75], v[184:187], v[0:15]
    ds_read_b64_tr_b16 v[176:177], v246 offset:4096
    ds_read_b64_tr_b16 v[178:179], v246 offset:5120
    ds_read_b64_tr_b16 v[180:181], v247 offset:4096
    ds_read_b64_tr_b16 v[182:183], v247 offset:5120
    s_lshl_b32 s58, s38, 3
    s_add_u32 s58, s58, s20
    s_mov_b32 m0, s69
    v_mfma_f32_32x32x16_bf16 v[16:31], v[76:79], v[184:187], v[16:31]
    buffer_load_dwordx4 v224, s[4:7], s42 offen sc1 lds
    buffer_load_dwordx4 v225, s[72:75], s42 offen offset:1024 sc1 lds
    s_set_gpr_idx_on s32, gpr_idx(DST)
    s_nop 0
    v_cvt_pk_bf16_f32 v195, v242, v243
    v_cvt_pk_bf16_f32 v196, v244, v245
    v_cvt_pk_bf16_f32 v197, v240, v240
    s_set_gpr_idx_off
    s_mov_b64 exec, 1
    ds_write_b32 v254, v255
    s_mov_b64 exec, -1
    s_cmp_lt_u32 s58, s22
    s_cbranch_scc0 K2_dyn_8
K2_back_9:
    v_readlane_b32 s3, v253, s58
    s_lshl_b32 s44, s34, 7
    s_and_b32 s48, s3, 0x3ffff
    s_bfe_u32 s33, s3, 0x30013
    s_mul_i32 s35, s38, 6
    s_cmp_eq_u32 s34, 0
    s_cselect_b32 s35, s35, s48
    s_mov_b32 s45, s44
    s_xor_b32 s47, s44, 256
    s_add_u32 s49, s48, 128
    s_add_u32 s60, s48, 256
    s_cmp_eq_u32 s33, 3
    s_cselect_b32 s46, s44, s47
    s_cselect_b32 s50, s60, s48
    s_cselect_b32 s51, s48, s49
    s_sub_u32 s60, s33, 2
    s_cmp_lt_u32 s60, 2
    s_cbranch_scc0 K2_rare_14
K2_back_15:
    v_mfma_f32_32x32x16_bf16 v[32:47], v[72:75], v[188:191], v[32:47]
    v_add_u32 v233, s48, v230
    ds_read_b32 v232, v233
    ds_read_b32 v233, v233 offset:1024
    v_mul_f32 v234, v0, v96
    v_mul_f32 v236, v8, v128
    v_fmac_f32 v234, v1, v97
    v_fmac_f32 v236, v9, v129
    v_mfma_f32_32x32x16_bf16 v[48:63], v[76:79], v[188:191], v[48:63]
    s_setprio 0
    v_fmac_f32 v234, v2, v98
    v_fmac_f32 v236, v10, v130
    v_fmac_f32 v234, v3, v99
    v_fmac_f32 v236, v11, v131
    v_fmac_f32 v234, v4, v100
    v_fmac_f32 v236, v12, v132
    v_fmac_f32 v234, v5, v101
    v_fmac_f32 v236, v13, v133
    v_fmac_f32 v234, v6, v102
    v_fmac_f32 v236, v14, v134
    v_fmac_f32 v234, v7, v103
    v_fmac_f32 v236, v15, v135
    v_mul_f32 v238, v16, v128
    v_mul_f32 v240, v24, v128
    v_fmac_f32 v238, v17, v129
    v_fmac_f32 v240, v25, v129
    v_fmac_f32 v238, v18, v130
    v_fmac_f32 v240, v26, v130
    v_fmac_f32 v238, v19, v131
    v_fmac_f32 v240, v27, v131
    v_fmac_f32 v238, v20, v132
    v_fmac_f32 v240, v28, v132
    v_fmac_f32 v238, v21, v133
    v_fmac_f32 v240, v29, v133
    v_fmac_f32 v238, v22, v134
    v_fmac_f32 v240, v30, v134
    v_fmac_f32 v238, v23, v135
    v_fmac_f32 v240, v31, v135
    v_mul_f32 v235, v32, v104
    v_mul_f32 v237, v40, v136
    v_fmac_f32 v235, v33, v105
    v_fmac_f32 v237, v41, v137
    v_fmac_f32 v235, v34, v106
    v_fmac_f32 v237, v42, v138
    v_fmac_f32 v235, v35, v107
    v_fmac_f32 v237, v43, v139
    v_fmac_f32 v235, v36, v108
    v_fmac_f32 v237, v44, v140
    v_fmac_f32 v235, v37, v109
    v_fmac_f32 v237, v45, v141
    v_fmac_f32 v235, v38, v110
    v_fmac_f32 v237, v46, v142
    v_fmac_f32 v235, v39, v111
    v_fmac_f32 v237, v47, v143
    v_mul_f32 v239, v48, v136
    v_mul_f32 v241, v56, v136
    v_fmac_f32 v239, v49, v137
    v_fmac_f32 v241, v57, v137
    s_setprio 1
    s_waitcnt vmcnt(4) lgkmcnt(3)
    v_mfma_f32_32x32x16_bf16 v[0:15], v[64:67], v[176:179], 0
    ds_read_b64_tr_b16 v[184:185], v246 offset:6144
    ds_read_b64_tr_b16 v[186:187], v246 offset:7168
    ds_read_b64_tr_b16 v[188:189], v247 offset:6144
    ds_read_b64_tr_b16 v[190:191], v247 offset:7168
    v_fmac_f32 v239, v50, v138
    v_fmac_f32 v241, v58, v138
    s_mov_b32 m0, s70
    v_mfma_f32_32x32x16_bf16 v[16:31], v[68:71], v[176:179], 0
    buffer_load_dwordx4 v222, s[4:7], s43 offen sc1 lds
    buffer_load_dwordx4 v223, s[72:75], s43 offen offset:1024 sc1 lds
    v_fmac_f32 v239, v51, v139
    v_fmac_f32 v241, v59, v139
    v_fmac_f32 v239, v52, v140
    v_fmac_f32 v241, v60, v140
    v_fmac_f32 v239, v53, v141
    v_mfma_f32_32x32x16_bf16 v[32:47], v[64:67], v[180:183], 0
    v_add_u32 v222, s48, v251
    ds_read2_b32 v[222:223], v222 offset0:1 offset1:3
    v_fmac_f32 v241, v61, v141
    v_fmac_f32 v239, v54, v142
    v_fmac_f32 v241, v62, v142
    v_fmac_f32 v239, v55, v143
    v_fmac_f32 v241, v63, v143
    v_mfma_f32_32x32x16_bf16 v[48:63], v[68:71], v[180:183], 0
    v_permlane32_swap_b32 v234, v236
    v_permlane32_swap_b32 v235, v237
    v_permlane32_swap_b32 v240, v238
    s_waitcnt lgkmcnt(5)
    v_or_b32 v232, v232, v231
    v_or_b32 v233, v233, v231
    s_cmp_lg_u32 s34, 0
    s_cbranch_scc1 K2_dum_17
    s_cmp_eq_u32 s33, 4
    s_cbranch_scc1 K2_a4_18
K2_b4_20:
    s_add_u32 m0, s48, 512
    s_add_u32 s65, s48, 1536
    buffer_load_dwordx4 v232, s[16:19], 0 offen  lds
    s_mov_b32 m0, s65
    s_mov_b32 exec_hi, 0
    buffer_load_dwordx4 v233, s[16:19], 0 offen  lds
    s_mov_b32 exec_hi, -1
K2_back_19:
    s_waitcnt vmcnt(6) lgkmcnt(1)
    v_mfma_f32_32x32x16_bf16 v[0:15], v[72:75], v[184:187], v[0:15]
    ds_read_b64_tr_b16 v[176:177], v246 offset:0
    ds_read_b64_tr_b16 v[178:179], v246 offset:1024
    ds_read_b64_tr_b16 v[180:181], v247 offset:0
    ds_read_b64_tr_b16 v[182:183], v247 offset:1024
    v_permlane32_swap_b32 v241, v239
    s_mov_b32 m0, s71
    v_mfma_f32_32x32x16_bf16 v[16:31], v[76:79], v[184:187], v[16:31]
    buffer_load_dwordx4 v224, s[4:7], s43 offen sc1 lds
    buffer_load_dwordx4 v225, s[72:75], s43 offen offset:1024 sc1 lds
    s_waitcnt lgkmcnt(4)
    v_mad_u32_u16 v222, v222, s39, v248 op_sel:[1,0,0,0]
    v_mad_u32_u16 v223, v223, s39, v248 op_sel:[1,0,0,0]
    v_add_f32 v234, v234, v236
    v_add_f32 v235, v235, v237
    v_add_f32 v240, v240, v238
    v_add_f32 v241, v241, v239
    s_set_gpr_idx_on s31, gpr_idx(DST)
    s_nop 0
    v_cvt_pk_bf16_f32 v192, v234, v235
    v_cvt_pk_bf16_f32 v193, v240, v241
    s_set_gpr_idx_off
    v_mfma_f32_32x32x16_bf16 v[32:47], v[72:75], v[188:191], v[32:47]
    v_add_u32 v224, s49, v251
    ds_read2_b32 v[224:225], v224 offset0:1 offset1:3
    v_mul_f32 v234, v0, v144
    v_mul_f32 v236, v8, v112
    v_fmac_f32 v234, v1, v145
    v_fmac_f32 v236, v9, v113
    v_fmac_f32 v234, v2, v146
    v_mfma_f32_32x32x16_bf16 v[48:63], v[76:79], v[188:191], v[48:63]
    s_setprio 0
    v_fmac_f32 v236, v10, v114
    v_fmac_f32 v234, v3, v147
    v_fmac_f32 v236, v11, v115
    v_fmac_f32 v234, v4, v148
    v_fmac_f32 v236, v12, v116
    v_fmac_f32 v234, v5, v149
    v_fmac_f32 v236, v13, v117
    v_fmac_f32 v234, v6, v150
    v_fmac_f32 v236, v14, v118
    v_fmac_f32 v234, v7, v151
    v_fmac_f32 v236, v15, v119
    v_mul_f32 v238, v16, v160
    v_mul_f32 v240, v24, v160
    v_fmac_f32 v238, v17, v161
    v_fmac_f32 v240, v25, v161
    v_fmac_f32 v238, v18, v162
    v_fmac_f32 v240, v26, v162
    v_fmac_f32 v238, v19, v163
    v_fmac_f32 v240, v27, v163
    v_fmac_f32 v238, v20, v164
    v_fmac_f32 v240, v28, v164
    v_fmac_f32 v238, v21, v165
    v_fmac_f32 v240, v29, v165
    v_fmac_f32 v238, v22, v166
    v_fmac_f32 v240, v30, v166
    v_fmac_f32 v238, v23, v167
    v_fmac_f32 v240, v31, v167
    v_mul_f32 v235, v32, v152
    v_mul_f32 v237, v40, v120
    v_fmac_f32 v235, v33, v153
    v_fmac_f32 v237, v41, v121
    v_fmac_f32 v235, v34, v154
    v_fmac_f32 v237, v42, v122
    v_fmac_f32 v235, v35, v155
    v_fmac_f32 v237, v43, v123
    v_fmac_f32 v235, v36, v156
    v_fmac_f32 v237, v44, v124
    v_fmac_f32 v235, v37, v157
    v_fmac_f32 v237, v45, v125
    v_fmac_f32 v235, v38, v158
    v_fmac_f32 v237, v46, v126
    v_fmac_f32 v235, v39, v159
    v_fmac_f32 v237, v47, v127
    v_mul_f32 v239, v48, v168
    v_mul_f32 v241, v56, v168
    v_fmac_f32 v239, v49, v169
    v_fmac_f32 v241, v57, v169
    v_fmac_f32 v239, v50, v170
    v_fmac_f32 v241, v58, v170
    v_fmac_f32 v239, v51, v171
    s_setprio 1
    s_waitcnt vmcnt(6) lgkmcnt(1)
    v_mfma_f32_32x32x16_bf16 v[0:15], v[64:67], v[176:179], 0
    ds_read_b64_tr_b16 v[184:185], v246 offset:2048
    ds_read_b64_tr_b16 v[186:187], v246 offset:3072
    ds_read_b64_tr_b16 v[188:189], v247 offset:2048
    ds_read_b64_tr_b16 v[190:191], v247 offset:3072
    v_fmac_f32 v241, v59, v171
    v_fmac_f32 v239, v52, v172
    s_mov_b32 m0, s68
    v_mfma_f32_32x32x16_bf16 v[16:31], v[68:71], v[176:179], 0
    buffer_load_dwordx4 v222, s[4:7], s44 offen sc1 lds
    buffer_load_dwordx4 v223, s[72:75], s44 offen offset:1024 sc1 lds
    s_waitcnt lgkmcnt(4)
    v_mad_u32_u16 v224, v224, s39, v248 op_sel:[1,0,0,0]
    v_mad_u32_u16 v225, v225, s39, v248 op_sel:[1,0,0,0]
    v_fmac_f32 v241, v60, v172
    v_fmac_f32 v239, v53, v173
    v_mfma_f32_32x32x16_bf16 v[32:47], v[64:67], v[180:183], 0
    v_add_u32 v226, s50, v251
    ds_read2_b32 v[226:227], v226 offset0:1 offset1:3
    v_fmac_f32 v241, v61, v173
    v_fmac_f32 v239, v54, v174
    v_fmac_f32 v241, v62, v174
    v_fmac_f32 v239, v55, v175
    v_fmac_f32 v241, v63, v175
    v_mfma_f32_32x32x16_bf16 v[48:63], v[68:71], v[180:183], 0
    s_waitcnt vmcnt(6) lgkmcnt(1)
    v_mfma_f32_32x32x16_bf16 v[0:15], v[72:75], v[184:187], v[0:15]
    ds_read_b64_tr_b16 v[176:177], v246 offset:4096
    ds_read_b64_tr_b16 v[178:179], v246 offset:5120
    ds_read_b64_tr_b16 v[180:181], v247 offset:4096
    ds_read_b64_tr_b16 v[182:183], v247 offset:5120
    s_mov_b32 m0, s69
    v_mfma_f32_32x32x16_bf16 v[16:31], v[76:79], v[184:187], v[16:31]
    buffer_load_dwordx4 v224, s[4:7], s45 offen sc1 lds
    buffer_load_dwordx4 v225, s[72:75], s45 offen offset:1024 sc1 lds
    s_waitcnt lgkmcnt(4)
    v_mad_u32_u16 v226, v226, s39, v248 op_sel:[1,0,0,0]
    v_mad_u32_u16 v227, v227, s39, v248 op_sel:[1,0,0,0]
    v_mfma_f32_32x32x16_bf16 v[32:47], v[72:75], v[188:191], v[32:47]
    v_add_u32 v228, s51, v251
    ds_read2_b32 v[228:229], v228 offset0:1 offset1:3
    v_mul_f32 v242, v0, v144
    v_fma_f32 v238, v8, v160, -v238
    v_fmac_f32 v242, v1, v145
    v_fmac_f32 v238, v9, v161
    v_fmac_f32 v242, v2, v146
    v_mfma_f32_32x32x16_bf16 v[48:63], v[76:79], v[188:191], v[48:63]
    s_setprio 0
    v_fmac_f32 v238, v10, v162
    v_fmac_f32 v242, v3, v147
    v_fmac_f32 v238, v11, v163
    v_fmac_f32 v242, v4, v148
    v_fmac_f32 v238, v12, v164
    v_fmac_f32 v242, v5, v149
    v_fmac_f32 v238, v13, v165
    v_fmac_f32 v242, v6, v150
    v_fmac_f32 v238, v14, v166
    v_fmac_f32 v242, v7, v151
    v_fmac_f32 v238, v15, v167
    v_fmac_f32 v236, v16, v112
    v_mul_f32 v244, v24, v160
    v_fmac_f32 v236, v17, v113
    v_fmac_f32 v244, v25, v161
    v_fmac_f32 v236, v18, v114
    v_fmac_f32 v244, v26, v162
    v_fmac_f32 v236, v19, v115
    v_fmac_f32 v244, v27, v163
    v_fmac_f32 v236, v20, v116
    v_fmac_f32 v244, v28, v164
    v_fmac_f32 v236, v21, v117
    v_fmac_f32 v244, v29, v165
    v_fmac_f32 v236, v22, v118
    v_fmac_f32 v244, v30, v166
    v_fmac_f32 v236, v23, v119
    v_fmac_f32 v244, v31, v167
    v_mul_f32 v243, v32, v152
    v_fma_f32 v239, v40, v168, -v239
    v_fmac_f32 v243, v33, v153
    v_fmac_f32 v239, v41, v169
    v_fmac_f32 v243, v34, v154
    v_fmac_f32 v239, v42, v170
    v_fmac_f32 v243, v35, v155
    v_fmac_f32 v239, v43, v171
    v_fmac_f32 v243, v36, v156
    v_fmac_f32 v239, v44, v172
    v_fmac_f32 v243, v37, v157
    v_fmac_f32 v239, v45, v173
    v_fmac_f32 v243, v38, v158
    v_fmac_f32 v239, v46, v174
    v_fmac_f32 v243, v39, v159
    v_fmac_f32 v239, v47, v175
    v_fmac_f32 v237, v48, v120
    v_mul_f32 v245, v56, v168
    v_fmac_f32 v237, v49, v121
    v_fmac_f32 v245, v57, v169
    v_fmac_f32 v237, v50, v122
    s_setprio 1
    s_waitcnt vmcnt(4) lgkmcnt(1)
    v_mfma_f32_32x32x16_bf16 v[0:15], v[64:67], v[176:179], 0
    ds_read_b64_tr_b16 v[184:185], v246 offset:6144
    ds_read_b64_tr_b16 v[186:187], v246 offset:7168
    ds_read_b64_tr_b16 v[188:189], v247 offset:6144
    ds_read_b64_tr_b16 v[190:191], v247 offset:7168
    v_fmac_f32 v245, v58, v170
    v_fmac_f32 v237, v51, v123
    s_mov_b32 m0, s70
    v_mfma_f32_32x32x16_bf16 v[16:31], v[68:71], v[176:179], 0
    buffer_load_dwordx4 v226, s[4:7], s46 offen sc1 lds
    buffer_load_dwordx4 v227, s[72:75], s46 offen offset:1024 sc1 lds
    s_waitcnt lgkmcnt(4)
    v_mad_u32_u16 v228, v228, s39, v248 op_sel:[1,0,0,0]
    v_mad_u32_u16 v229, v229, s39, v248 op_sel:[1,0,0,0]
    v_fmac_f32 v245, v59, v171
    v_fmac_f32 v237, v52, v124
    v_mfma_f32_32x32x16_bf16 v[32:47], v[64:67], v[180:183], 0
    v_fmac_f32 v245, v60, v172
    v_fmac_f32 v237, v53, v125
    v_fmac_f32 v245, v61, v173
    v_fmac_f32 v237, v54, v126
    v_fmac_f32 v245, v62, v174
    v_fmac_f32 v237, v55, v127
    v_fmac_f32 v245, v63, v175
    v_mfma_f32_32x32x16_bf16 v[48:63], v[68:71], v[180:183], 0
    v_permlane32_swap_b32 v242, v234
    v_permlane32_swap_b32 v243, v235
    v_add_f32 v242, v242, v234
    v_add_f32 v243, v243, v235
    s_waitcnt vmcnt(4) lgkmcnt(0)
    v_mfma_f32_32x32x16_bf16 v[0:15], v[72:75], v[184:187], v[0:15]
    ds_read_b64_tr_b16 v[176:177], v246 offset:0
    ds_read_b64_tr_b16 v[178:179], v246 offset:1024
    ds_read_b64_tr_b16 v[180:181], v247 offset:0
    ds_read_b64_tr_b16 v[182:183], v247 offset:1024
    s_sub_u32 s26, s48, s29
    s_mov_b32 s29, s48
    s_mov_b32 m0, s71
    v_mfma_f32_32x32x16_bf16 v[16:31], v[76:79], v[184:187], v[16:31]
    buffer_load_dwordx4 v228, s[4:7], s47 offen sc1 lds
    buffer_load_dwordx4 v229, s[72:75], s47 offen offset:1024 sc1 lds
    s_set_gpr_idx_on s31, gpr_idx(DST)
    s_nop 0
    v_cvt_pk_bf16_f32 v194, v242, v243
    s_set_gpr_idx_off
    s_mov_b32 s30, s3
    s_bfe_u32 s56, s3, 0x40012
    s_cmp_eq_u32 s34, 0
    s_cselect_b32 s56, s56, 0
    v_mfma_f32_32x32x16_bf16 v[32:47], v[72:75], v[188:191], v[32:47]
    s_mov_b32 s32, s31
    s_mov_b32 s31, s35
    v_mul_f32 v242, v0, v144
    v_fma_f32 v240, v8, v160, -v240
    v_fmac_f32 v242, v1, v145
    v_fmac_f32 v240, v9, v161
    v_fmac_f32 v242, v2, v146
    v_mfma_f32_32x32x16_bf16 v[48:63], v[76:79], v[188:191], v[48:63]
    s_setprio 0
    v_fmac_f32 v240, v10, v162
    v_fmac_f32 v242, v3, v147
    v_fmac_f32 v240, v11, v163
    v_fmac_f32 v242, v4, v148
    v_fmac_f32 v240, v12, v164
    v_fmac_f32 v242, v5, v149
    v_fmac_f32 v240, v13, v165
    v_fmac_f32 v242, v6, v150
    v_fmac_f32 v240, v14, v166
    v_fmac_f32 v242, v7, v151
    v_fmac_f32 v240, v15, v167
    v_add_u32 v249, s26, v249
    v_add_u32 v250, s26, v250
    v_fma_f32 v244, v16, v160, -v244
    v_fmac_f32 v236, v24, v112
    v_fmac_f32 v244, v17, v161
    v_fmac_f32 v236, v25, v113
    v_fmac_f32 v244, v18, v162
    v_fmac_f32 v236, v26, v114
    v_fmac_f32 v244, v19, v163
    v_fmac_f32 v236, v27, v115
    v_fmac_f32 v244, v20, v164
    v_fmac_f32 v236, v28, v116
    v_fmac_f32 v244, v21, v165
    v_fmac_f32 v236, v29, v117
    v_fmac_f32 v244, v22, v166
    v_fmac_f32 v236, v30, v118
    v_fmac_f32 v244, v23, v167
    v_fmac_f32 v236, v31, v119
    ds_read_b64_tr_b16 v[0:1], v249 offset:0
    ds_read_b64_tr_b16 v[2:3], v249 offset:32
    ds_read_u16_d16_hi v16, v250 offset:0
    v_mul_f32 v243, v32, v152
    v_fma_f32 v241, v40, v168, -v241
    v_fmac_f32 v243, v33, v153
    v_fmac_f32 v241, v41, v169
    v_fmac_f32 v243, v34, v154
    v_fmac_f32 v241, v42, v170
    v_fmac_f32 v243, v35, v155
    v_fmac_f32 v241, v43, v171
    v_fmac_f32 v243, v36, v156
    v_fmac_f32 v241, v44, v172
    v_fmac_f32 v243, v37, v157
    v_fmac_f32 v241, v45, v173
    v_fmac_f32 v243, v38, v158
    v_fmac_f32 v241, v46, v174
    v_fmac_f32 v243, v39, v159
    v_fmac_f32 v241, v47, v175
    ds_read_b64_tr_b16 v[4:5], v249 offset:512
    ds_read_b64_tr_b16 v[6:7], v249 offset:544
    ds_read_u16_d16_hi v17, v250 offset:128
    v_fma_f32 v245, v48, v168, -v245
    v_fmac_f32 v237, v56, v120
    v_fmac_f32 v245, v49, v169
    v_fmac_f32 v237, v57, v121
    v_fmac_f32 v245, v50, v170
    v_fmac_f32 v237, v58, v122
    v_fmac_f32 v245, v51, v171
    v_fmac_f32 v237, v59, v123
    v_fmac_f32 v245, v52, v172
    v_fmac_f32 v237, v60, v124
    v_fmac_f32 v245, v53, v173
    v_fmac_f32 v237, v61, v125
    v_fmac_f32 v245, v54, v174
    v_fmac_f32 v237, v62, v126
    v_fmac_f32 v245, v55, v175
    v_fmac_f32 v237, v63, v127
    s_cmp_eq_u32 s56, 5
    s_cbranch_scc1 K2_U20
    s_cmp_eq_u32 s56, 6
    s_cbranch_scc1 K2_U3h0
    s_branch K2_DSP0
K2_PAD_U30:
    s_branch K2_HOP
K2_U3h0:
    s_setprio 1
    ds_read_b64_tr_b16 v[8:9], v249 offset:1024
    ds_read_u16_d16_hi v18, v250 offset:256
    s_waitcnt lgkmcnt(2)
    v_lshlrev_b32 v20, 16, v0
    v_and_b32 v21, 0xffff0000, v0
    v_lshlrev_b32 v22, 16, v1
    v_and_b32 v23, 0xffff0000, v1
    v_lshlrev_b32 v24, 16, v2
    v_and_b32 v25, 0xffff0000, v2
    v_lshlrev_b32 v26, 16, v3
    v_and_b32 v27, 0xffff0000, v3
    v_mul_f32_dpp v36, v16, v20 row_newbcast:8 row_mask:0xf bank_mask:0xf
    v_mul_f32_dpp v37, v16, v21 row_newbcast:9 row_mask:0xf bank_mask:0xf
    v_mul_f32_dpp v38, v16, v22 row_newbcast:10 row_mask:0xf bank_mask:0xf
    v_mul_f32_dpp v39, v16, v23 row_newbcast:11 row_mask:0xf bank_mask:0xf
    v_mul_f32_dpp v40, v16, v24 row_newbcast:12 row_mask:0xf bank_mask:0xf
    v_mul_f32_dpp v41, v16, v25 row_newbcast:13 row_mask:0xf bank_mask:0xf
    v_mul_f32_dpp v42, v16, v26 row_newbcast:14 row_mask:0xf bank_mask:0xf
    v_mul_f32_dpp v43, v16, v27 row_newbcast:15 row_mask:0xf bank_mask:0xf
    v_cvt_pk_bf16_f32 v68, v36, v37
    v_cvt_pk_bf16_f32 v69, v38, v39
    v_cvt_pk_bf16_f32 v70, v40, v41
    v_cvt_pk_bf16_f32 v71, v42, v43
    v_mul_f32_dpp v20, v16, v20 row_newbcast:0 row_mask:0xa bank_mask:0xf
    v_mul_f32_dpp v21, v16, v21 row_newbcast:1 row_mask:0xa bank_mask:0xf
    v_mul_f32_dpp v22, v16, v22 row_newbcast:2 row_mask:0xa bank_mask:0xf
    v_mul_f32_dpp v23, v16, v23 row_newbcast:3 row_mask:0xa bank_mask:0xf
    v_mul_f32_dpp v24, v16, v24 row_newbcast:4 row_mask:0xa bank_mask:0xf
    v_mul_f32_dpp v25, v16, v25 row_newbcast:5 row_mask:0xa bank_mask:0xf
    v_mul_f32_dpp v26, v16, v26 row_newbcast:6 row_mask:0xa bank_mask:0xf
    v_mul_f32_dpp v27, v16, v27 row_newbcast:7 row_mask:0xa bank_mask:0xf
    v_cvt_pk_bf16_f32 v64, v20, v21
    v_cvt_pk_bf16_f32 v65, v22, v23
    v_cvt_pk_bf16_f32 v66, v24, v25
    v_cvt_pk_bf16_f32 v67, v26, v27
    v_lshlrev_b32 v28, 16, v4
    v_and_b32 v29, 0xffff0000, v4
    v_lshlrev_b32 v30, 16, v5
    v_and_b32 v31, 0xffff0000, v5
    v_lshlrev_b32 v32, 16, v6
    v_and_b32 v33, 0xffff0000, v6
    v_lshlrev_b32 v34, 16, v7
    v_and_b32 v35, 0xffff0000, v7
    v_mul_f32_dpp v36, v17, v28 row_newbcast:8 row_mask:0xf bank_mask:0xf
    v_mul_f32_dpp v37, v17, v29 row_newbcast:9 row_mask:0xf bank_mask:0xf
    v_mul_f32_dpp v38, v17, v30 row_newbcast:10 row_mask:0xf bank_mask:0xf
    v_mul_f32_dpp v39, v17, v31 row_newbcast:11 row_mask:0xf bank_mask:0xf
    v_mul_f32_dpp v40, v17, v32 row_newbcast:12 row_mask:0xf bank_mask:0xf
    v_mul_f32_dpp v41, v17, v33 row_newbcast:13 row_mask:0xf bank_mask:0xf
    v_mul_f32_dpp v42, v17, v34 row_newbcast:14 row_mask:0xf bank_mask:0xf
    v_mul_f32_dpp v43, v17, v35 row_newbcast:15 row_mask:0xf bank_mask:0xf
    v_cvt_pk_bf16_f32 v76, v36, v37
    v_cvt_pk_bf16_f32 v77, v38, v39
    v_cvt_pk_bf16_f32 v78, v40, v41
    v_cvt_pk_bf16_f32 v79, v42, v43
    v_mul_f32_dpp v28, v17, v28 row_newbcast:0 row_mask:0xa bank_mask:0xf
    v_mul_f32_dpp v29, v17, v29 row_newbcast:1 row_mask:0xa bank_mask:0xf
    v_mul_f32_dpp v30, v17, v30 row_newbcast:2 row_mask:0xa bank_mask:0xf
    v_mul_f32_dpp v31, v17, v31 row_newbcast:3 row_mask:0xa bank_mask:0xf
    v_mul_f32_dpp v32, v17, v32 row_newbcast:4 row_mask:0xa bank_mask:0xf
    v_mul_f32_dpp v33, v17, v33 row_newbcast:5 row_mask:0xa bank_mask:0xf
    v_mul_f32_dpp v34, v17, v34 row_newbcast:6 row_mask:0xa bank_mask:0xf
    v_mul_f32_dpp v35, v17, v35 row_newbcast:7 row_mask:0xa bank_mask:0xf
    v_cvt_pk_bf16_f32 v72, v28, v29
    v_cvt_pk_bf16_f32 v73, v30, v31
    v_cvt_pk_bf16_f32 v74, v32, v33
    v_cvt_pk_bf16_f32 v75, v34, v35
    s_waitcnt lgkmcnt(0)
    v_lshlrev_b32 v20, 16, v8
    v_and_b32 v21, 0xffff0000, v8
    v_lshlrev_b32 v22, 16, v9
    v_and_b32 v23, 0xffff0000, v9
    v_mul_f32_dpp v36, v18, v20 row_newbcast:8 row_mask:0xf bank_mask:0xf
    v_mul_f32_dpp v37, v18, v21 row_newbcast:9 row_mask:0xf bank_mask:0xf
    v_mul_f32_dpp v38, v18, v22 row_newbcast:10 row_mask:0xf bank_mask:0xf
    v_mul_f32_dpp v39, v18, v23 row_newbcast:11 row_mask:0xf bank_mask:0xf
    v_cvt_pk_bf16_f32 v84, v36, v37
    v_cvt_pk_bf16_f32 v85, v38, v39
    v_mul_f32_dpp v20, v18, v20 row_newbcast:0 row_mask:0xa bank_mask:0xf
    v_mul_f32_dpp v21, v18, v21 row_newbcast:1 row_mask:0xa bank_mask:0xf
    v_mul_f32_dpp v22, v18, v22 row_newbcast:2 row_mask:0xa bank_mask:0xf
    v_mul_f32_dpp v23, v18, v23 row_newbcast:3 row_mask:0xa bank_mask:0xf
    v_cvt_pk_bf16_f32 v80, v20, v21
    v_cvt_pk_bf16_f32 v81, v22, v23
    s_waitcnt vmcnt(4)
    v_mfma_f32_32x32x16_bf16 v[0:15], v[64:67], v[176:179], 0
    ds_read_b64_tr_b16 v[184:185], v246 offset:2048
    ds_read_b64_tr_b16 v[186:187], v246 offset:3072
    ds_read_b64_tr_b16 v[188:189], v247 offset:2048
    ds_read_b64_tr_b16 v[190:191], v247 offset:3072
    s_mov_b32 m0, s68
    v_mfma_f32_32x32x16_bf16 v[16:31], v[68:71], v[176:179], 0
    buffer_load_dwordx4 v224, s[4:7], s41 offen sc1 lds
    buffer_load_dwordx4 v225, s[72:75], s41 offen offset:1024 sc1 lds
    v_permlane32_swap_b32 v242, v236
    v_permlane32_swap_b32 v243, v237
    s_add_u32 s38, s38, 1
    v_mfma_f32_32x32x16_bf16 v[32:47], v[64:67], v[180:183], 0
    v_permlane32_swap_b32 v244, v238
    v_permlane32_swap_b32 v245, v239
    v_permlane32_swap_b32 v240, v241
    v_add_f32 v242, v242, v236
    v_mfma_f32_32x32x16_bf16 v[48:63], v[68:71], v[180:183], 0
    v_add_f32 v243, v243, v237
    v_add_f32 v244, v244, v238
    v_add_f32 v245, v245, v239
    v_add_f32 v240, -v240, -v241
    v_mov_b32 v254, s52
    v_mov_b32 v255, s38
    s_waitcnt vmcnt(4) lgkmcnt(0)
    v_mfma_f32_32x32x16_bf16 v[0:15], v[72:75], v[184:187], v[0:15]
    ds_read_b64_tr_b16 v[176:177], v246 offset:4096
    ds_read_b64_tr_b16 v[180:181], v247 offset:4096
    s_lshl_b32 s58, s38, 3
    s_add_u32 s58, s58, s20
    s_mov_b32 m0, s69
    v_mfma_f32_32x32x16_bf16 v[16:31], v[76:79], v[184:187], v[16:31]
    buffer_load_dwordx4 v226, s[4:7], s41 offen sc1 lds
    s_set_gpr_idx_on s32, gpr_idx(DST)
    s_nop 0
    v_cvt_pk_bf16_f32 v195, v242, v243
    v_cvt_pk_bf16_f32 v196, v244, v245
    v_cvt_pk_bf16_f32 v197, v240, v240
    s_set_gpr_idx_off
    s_mov_b64 exec, 1
    ds_write_b32 v254, v255
    s_mov_b64 exec, -1
    s_cmp_lt_u32 s58, s22
    s_cbranch_scc0 K2_dyn_21
K2_back_22:
    v_readlane_b32 s3, v253, s58
    s_lshl_b32 s44, s34, 7
    s_and_b32 s48, s3, 0x3ffff
    s_bfe_u32 s33, s3, 0x30013
    s_mul_i32 s35, s38, 6
    s_cmp_eq_u32 s34, 0
    s_cselect_b32 s35, s35, s48
    s_mov_b32 s45, s44
    s_xor_b32 s47, s44, 256
    s_add_u32 s49, s48, 128
    s_add_u32 s60, s48, 256
    s_cmp_eq_u32 s33, 3
    s_cselect_b32 s46, s44, s47
    s_cselect_b32 s50, s60, s48
    s_cselect_b32 s51, s48, s49
    s_sub_u32 s60, s33, 2
    s_cmp_lt_u32 s60, 2
    s_cbranch_scc0 K2_rare_27
K2_back_28:
    v_mfma_f32_32x32x16_bf16 v[32:47], v[72:75], v[188:191], v[32:47]
    v_add_u32 v233, s48, v230
    ds_read_b32 v232, v233
    ds_read_b32 v233, v233 offset:1024
    v_mfma_f32_32x32x16_bf16 v[48:63], v[76:79], v[188:191], v[48:63]
    s_waitcnt vmcnt(3) lgkmcnt(3)
    v_mfma_f32_32x32x8_bf16 v[0:15], v[80:81], v[176:177], v[0:15]
    ds_read_b64_tr_b16 v[184:185], v246 offset:6144
    ds_read_b64_tr_b16 v[186:187], v246 offset:7168
    ds_read_b64_tr_b16 v[188:189], v247 offset:6144
    ds_read_b64_tr_b16 v[190:191], v247 offset:7168
    s_mov_b32 m0, s70
    v_mfma_f32_32x32x8_bf16 v[16:31], v[84:85], v[176:177], v[16:31]
    buffer_load_dwordx4 v222, s[4:7], s42 offen sc1 lds
    buffer_load_dwordx4 v223, s[72:75], s42 offen offset:1024 sc1 lds
    v_mfma_f32_32x32x8_bf16 v[32:47], v[80:81], v[180:181], v[32:47]
    s_nop 2
    v_mul_f32 v234, v0, v96
    v_mul_f32 v236, v8, v128
    v_fmac_f32 v234, v1, v97
    v_fmac_f32 v236, v9, v129
    v_fmac_f32 v234, v2, v98
    v_fmac_f32 v236, v10, v130
    v_fmac_f32 v234, v3, v99
    v_mfma_f32_32x32x8_bf16 v[48:63], v[84:85], v[180:181], v[48:63]
    s_setprio 0
    s_waitcnt lgkmcnt(4)
    v_or_b32 v232, v232, v231
    v_or_b32 v233, v233, v231
    s_cmp_lg_u32 s34, 0
    s_cbranch_scc1 K2_dum_30
    s_cmp_eq_u32 s33, 4
    s_cbranch_scc1 K2_a4_31
K2_b4_33:
    s_add_u32 m0, s48, 512
    s_add_u32 s65, s48, 1536
    buffer_load_dwordx4 v232, s[16:19], 0 offen  lds
    s_mov_b32 m0, s65
    s_mov_b32 exec_hi, 0
    buffer_load_dwordx4 v233, s[16:19], 0 offen  lds
    s_mov_b32 exec_hi, -1
K2_back_32:
    v_fmac_f32 v236, v11, v131
    v_fmac_f32 v234, v4, v100
    v_fmac_f32 v236, v12, v132
    v_fmac_f32 v234, v5, v101
    v_fmac_f32 v236, v13, v133
    v_fmac_f32 v234, v6, v102
    v_fmac_f32 v236, v14, v134
    v_fmac_f32 v234, v7, v103
    v_fmac_f32 v236, v15, v135
    v_mul_f32 v238, v16, v128
    v_mul_f32 v240, v24, v128
    v_fmac_f32 v238, v17, v129
    v_fmac_f32 v240, v25, v129
    v_fmac_f32 v238, v18, v130
    v_fmac_f32 v240, v26, v130
    v_fmac_f32 v238, v19, v131
    v_fmac_f32 v240, v27, v131
    v_fmac_f32 v238, v20, v132
    v_fmac_f32 v240, v28, v132
    v_fmac_f32 v238, v21, v133
    v_fmac_f32 v240, v29, v133
    v_fmac_f32 v238, v22, v134
    v_fmac_f32 v240, v30, v134
    v_fmac_f32 v238, v23, v135
    v_fmac_f32 v240, v31, v135
    v_mul_f32 v235, v32, v104
    v_mul_f32 v237, v40, v136
    v_fmac_f32 v235, v33, v105
    v_fmac_f32 v237, v41, v137
    v_fmac_f32 v235, v34, v106
    v_fmac_f32 v237, v42, v138
    v_fmac_f32 v235, v35, v107
    v_fmac_f32 v237, v43, v139
    v_fmac_f32 v235, v36, v108
    v_fmac_f32 v237, v44, v140
    v_fmac_f32 v235, v37, v109
    v_fmac_f32 v237, v45, v141
    v_fmac_f32 v235, v38, v110
    v_fmac_f32 v237, v46, v142
    v_fmac_f32 v235, v39, v111
    v_fmac_f32 v237, v47, v143
    v_mul_f32 v239, v48, v136
    v_mul_f32 v241, v56, v136
    s_setprio 1
    s_waitcnt vmcnt(5) lgkmcnt(0)
    v_mfma_f32_32x32x16_bf16 v[0:15], v[64:67], v[184:187], 0
    ds_read_b64_tr_b16 v[176:177], v246 offset:0
    ds_read_b64_tr_b16 v[178:179], v246 offset:1024
    ds_read_b64_tr_b16 v[180:181], v247 offset:0
    ds_read_b64_tr_b16 v[182:183], v247 offset:1024
    v_fmac_f32 v239, v49, v137
    v_fmac_f32 v241, v57, v137
    s_mov_b32 m0, s71
    v_mfma_f32_32x32x16_bf16 v[16:31], v[68:71], v[184:187], 0
    buffer_load_dwordx4 v224, s[4:7], s42 offen sc1 lds
    buffer_load_dwordx4 v225, s[72:75], s42 offen offset:1024 sc1 lds
    v_fmac_f32 v239, v50, v138
    v_fmac_f32 v241, v58, v138
    v_fmac_f32 v239, v51, v139
    v_fmac_f32 v241, v59, v139
    v_fmac_f32 v239, v52, v140
    v_mfma_f32_32x32x16_bf16 v[32:47], v[64:67], v[188:191], 0
    v_fmac_f32 v241, v60, v140
    v_fmac_f32 v239, v53, v141
    v_fmac_f32 v241, v61, v141
    v_fmac_f32 v239, v54, v142
    v_fmac_f32 v241, v62, v142
    v_fmac_f32 v239, v55, v143
    v_fmac_f32 v241, v63, v143
    v_mfma_f32_32x32x16_bf16 v[48:63], v[68:71], v[188:191], 0
    v_permlane32_swap_b32 v234, v236
    v_permlane32_swap_b32 v235, v237
    v_permlane32_swap_b32 v240, v238
    s_waitcnt vmcnt(6) lgkmcnt(0)
    v_mfma_f32_32x32x16_bf16 v[0:15], v[72:75], v[176:179], v[0:15]
    ds_read_b64_tr_b16 v[184:185], v246 offset:2048
    ds_read_b64_tr_b16 v[188:189], v247 offset:2048
    v_permlane32_swap_b32 v241, v239
    v_add_f32 v234, v234, v236
    v_add_f32 v235, v235, v237
    s_mov_b32 m0, s68
    v_mfma_f32_32x32x16_bf16 v[16:31], v[76:79], v[176:179], v[16:31]
    buffer_load_dwordx4 v226, s[4:7], s42 offen sc1 lds
    v_add_f32 v240, v240, v238
    v_add_f32 v241, v241, v239
    s_set_gpr_idx_on s31, gpr_idx(DST)
    s_nop 0
    v_cvt_pk_bf16_f32 v192, v234, v235
    v_cvt_pk_bf16_f32 v193, v240, v241
    s_set_gpr_idx_off
    v_mfma_f32_32x32x16_bf16 v[32:47], v[72:75], v[180:183], v[32:47]
    v_mfma_f32_32x32x16_bf16 v[48:63], v[76:79], v[180:183], v[48:63]
    s_waitcnt vmcnt(5) lgkmcnt(0)
    v_mfma_f32_32x32x8_bf16 v[0:15], v[80:81], v[184:185], v[0:15]
    ds_read_b64_tr_b16 v[176:177], v246 offset:4096
    ds_read_b64_tr_b16 v[178:179], v246 offset:5120
    ds_read_b64_tr_b16 v[180:181], v247 offset:4096
    ds_read_b64_tr_b16 v[182:183], v247 offset:5120
    s_mov_b32 m0, s69
    v_mfma_f32_32x32x8_bf16 v[16:31], v[84:85], v[184:185], v[16:31]
    buffer_load_dwordx4 v222, s[4:7], s43 offen sc1 lds
    buffer_load_dwordx4 v223, s[72:75], s43 offen offset:1024 sc1 lds
    v_mfma_f32_32x32x8_bf16 v[32:47], v[80:81], v[188:189], v[32:47]
    s_nop 2
    v_mul_f32 v234, v0, v144
    v_mul_f32 v236, v8, v112
    v_fmac_f32 v234, v1, v145
    v_fmac_f32 v236, v9, v113
    v_fmac_f32 v234, v2, v146
    v_fmac_f32 v236, v10, v114
    v_fmac_f32 v234, v3, v147
    v_mfma_f32_32x32x8_bf16 v[48:63], v[84:85], v[188:189], v[48:63]
    s_setprio 0
    v_fmac_f32 v236, v11, v115
    v_fmac_f32 v234, v4, v148
    v_fmac_f32 v236, v12, v116
    v_fmac_f32 v234, v5, v149
    v_fmac_f32 v236, v13, v117
    v_fmac_f32 v234, v6, v150
    v_fmac_f32 v236, v14, v118
    v_fmac_f32 v234, v7, v151
    v_fmac_f32 v236, v15, v119
    v_mul_f32 v238, v16, v160
    v_mul_f32 v240, v24, v160
    v_fmac_f32 v238, v17, v161
    v_fmac_f32 v240, v25, v161
    v_fmac_f32 v238, v18, v162
    v_fmac_f32 v240, v26, v162
    v_fmac_f32 v238, v19, v163
    v_fmac_f32 v240, v27, v163
    v_fmac_f32 v238, v20, v164
    v_fmac_f32 v240, v28, v164
    v_fmac_f32 v238, v21, v165
    v_fmac_f32 v240, v29, v165
    v_fmac_f32 v238, v22, v166
    v_fmac_f32 v240, v30, v166
    v_fmac_f32 v238, v23, v167
    v_fmac_f32 v240, v31, v167
    v_mul_f32 v235, v32, v152
    v_mul_f32 v237, v40, v120
    v_fmac_f32 v235, v33, v153
    v_fmac_f32 v237, v41, v121
    v_fmac_f32 v235, v34, v154
    v_fmac_f32 v237, v42, v122
    v_fmac_f32 v235, v35, v155
    v_fmac_f32 v237, v43, v123
    v_fmac_f32 v235, v36, v156
    v_fmac_f32 v237, v44, v124
    v_fmac_f32 v235, v37, v157
    v_fmac_f32 v237, v45, v125
    v_fmac_f32 v235, v38, v158
    v_fmac_f32 v237, v46, v126
    v_fmac_f32 v235, v39, v159
    v_fmac_f32 v237, v47, v127
    v_mul_f32 v239, v48, v168
    v_mul_f32 v241, v56, v168
    v_fmac_f32 v239, v49, v169
    v_fmac_f32 v241, v57, v169
    s_setprio 1
    s_waitcnt vmcnt(3) lgkmcnt(0)
    v_mfma_f32_32x32x16_bf16 v[0:15], v[64:67], v[176:179], 0
    ds_read_b64_tr_b16 v[184:185], v246 offset:6144
    ds_read_b64_tr_b16 v[186:187], v246 offset:7168
    ds_read_b64_tr_b16 v[188:189], v247 offset:6144
    ds_read_b64_tr_b16 v[190:191], v247 offset:7168
    v_fmac_f32 v239, v50, v170
    v_fmac_f32 v241, v58, v170
    s_mov_b32 m0, s70
    v_mfma_f32_32x32x16_bf16 v[16:31], v[68:71], v[176:179], 0
    buffer_load_dwordx4 v224, s[4:7], s43 offen sc1 lds
    buffer_load_dwordx4 v225, s[72:75], s43 offen offset:1024 sc1 lds
    v_fmac_f32 v239, v51, v171
    v_fmac_f32 v241, v59, v171
    v_fmac_f32 v239, v52, v172
    v_fmac_f32 v241, v60, v172
    v_fmac_f32 v239, v53, v173
    v_mfma_f32_32x32x16_bf16 v[32:47], v[64:67], v[180:183], 0
    v_add_u32 v222, s48, v251
    ds_read2_b32 v[222:223], v222 offset0:1 offset1:3
    v_fmac_f32 v241, v61, v173
    v_fmac_f32 v239, v54, v174
    v_fmac_f32 v241, v62, v174
    v_fmac_f32 v239, v55, v175
    v_fmac_f32 v241, v63, v175
    v_mfma_f32_32x32x16_bf16 v[48:63], v[68:71], v[180:183], 0
    s_waitcnt vmcnt(4) lgkmcnt(1)
    v_mfma_f32_32x32x16_bf16 v[0:15], v[72:75], v[184:187], v[0:15]
    ds_read_b64_tr_b16 v[176:177], v246 offset:0
    ds_read_b64_tr_b16 v[180:181], v247 offset:0
    s_mov_b32 m0, s71
    v_mfma_f32_32x32x16_bf16 v[16:31], v[76:79], v[184:187], v[16:31]
    buffer_load_dwordx4 v226, s[4:7], s43 offen sc1 lds
    s_waitcnt lgkmcnt(2)
    v_mad_u32_u16 v222, v222, s39, v248 op_sel:[1,0,0,0]
    v_mad_u32_u16 v223, v223, s39, v248 op_sel:[1,0,0,0]
    v_mfma_f32_32x32x16_bf16 v[32:47], v[72:75], v[188:191], v[32:47]
    v_add_u32 v224, s49, v251
    ds_read2_b32 v[224:225], v224 offset0:1 offset1:3
    v_mfma_f32_32x32x16_bf16 v[48:63], v[76:79], v[188:191], v[48:63]
    s_waitcnt vmcnt(3) lgkmcnt(1)
    v_mfma_f32_32x32x8_bf16 v[0:15], v[80:81], v[176:177], v[0:15]
    ds_read_b64_tr_b16 v[184:185], v246 offset:2048
    ds_read_b64_tr_b16 v[186:187], v246 offset:3072
    ds_read_b64_tr_b16 v[188:189], v247 offset:2048
    ds_read_b64_tr_b16 v[190:191], v247 offset:3072
    s_mov_b32 m0, s68
    v_mfma_f32_32x32x8_bf16 v[16:31], v[84:85], v[176:177], v[16:31]
    buffer_load_dwordx4 v222, s[4:7], s44 offen sc1 lds
    buffer_load_dwordx4 v223, s[72:75], s44 offen offset:1024 sc1 lds
    s_waitcnt lgkmcnt(4)
    v_mad_u32_u16 v224, v224, s39, v248 op_sel:[1,0,0,0]
    v_mad_u32_u16 v225, v225, s39, v248 op_sel:[1,0,0,0]
    v_mfma_f32_32x32x8_bf16 v[32:47], v[80:81], v[180:181], v[32:47]
    v_add_u32 v226, s50, v251
    ds_read2_b32 v[226:227], v226 offset0:1 offset1:3
    v_mul_f32 v242, v0, v144
    v_fma_f32 v238, v8, v160, -v238
    v_fmac_f32 v242, v1, v145
    v_fmac_f32 v238, v9, v161
    v_fmac_f32 v242, v2, v146
    v_mfma_f32_32x32x8_bf16 v[48:63], v[84:85], v[180:181], v[48:63]
    s_setprio 0
    v_fmac_f32 v238, v10, v162
    v_fmac_f32 v242, v3, v147
    v_fmac_f32 v238, v11, v163
    v_fmac_f32 v242, v4, v148
    v_fmac_f32 v238, v12, v164
    v_fmac_f32 v242, v5, v149
    v_fmac_f32 v238, v13, v165
    v_fmac_f32 v242, v6, v150
    v_fmac_f32 v238, v14, v166
    v_fmac_f32 v242, v7, v151
    v_fmac_f32 v238, v15, v167
    v_fmac_f32 v236, v16, v112
    v_mul_f32 v244, v24, v160
    v_fmac_f32 v236, v17, v113
    v_fmac_f32 v244, v25, v161
    v_fmac_f32 v236, v18, v114
    v_fmac_f32 v244, v26, v162
    v_fmac_f32 v236, v19, v115
    v_fmac_f32 v244, v27, v163
    v_fmac_f32 v236, v20, v116
    v_fmac_f32 v244, v28, v164
    v_fmac_f32 v236, v21, v117
    v_fmac_f32 v244, v29, v165
    v_fmac_f32 v236, v22, v118
    v_fmac_f32 v244, v30, v166
    v_fmac_f32 v236, v23, v119
    v_fmac_f32 v244, v31, v167
    v_mul_f32 v243, v32, v152
    v_fma_f32 v239, v40, v168, -v239
    v_fmac_f32 v243, v33, v153
    v_fmac_f32 v239, v41, v169
    v_fmac_f32 v243, v34, v154
    v_fmac_f32 v239, v42, v170
    v_fmac_f32 v243, v35, v155
    v_fmac_f32 v239, v43, v171
    v_fmac_f32 v243, v36, v156
    v_fmac_f32 v239, v44, v172
    v_fmac_f32 v243, v37, v157
    v_fmac_f32 v239, v45, v173
    v_fmac_f32 v243, v38, v158
    v_fmac_f32 v239, v46, v174
    v_fmac_f32 v243, v39, v159
    v_fmac_f32 v239, v47, v175
    v_fmac_f32 v237, v48, v120
    v_mul_f32 v245, v56, v168
    v_fmac_f32 v237, v49, v121
    v_fmac_f32 v245, v57, v169
    v_fmac_f32 v237, v50, v122
    v_fmac_f32 v245, v58, v170
    v_fmac_f32 v237, v51, v123
    s_setprio 1
    s_waitcnt vmcnt(3) lgkmcnt(1)
    v_mfma_f32_32x32x16_bf16 v[0:15], v[64:67], v[184:187], 0
    ds_read_b64_tr_b16 v[176:177], v246 offset:4096
    ds_read_b64_tr_b16 v[178:179], v246 offset:5120
    ds_read_b64_tr_b16 v[180:181], v247 offset:4096
    ds_read_b64_tr_b16 v[182:183], v247 offset:5120
    v_fmac_f32 v245, v59, v171
    v_fmac_f32 v237, v52, v124
    s_mov_b32 m0, s69
    v_mfma_f32_32x32x16_bf16 v[16:31], v[68:71], v[184:187], 0
    buffer_load_dwordx4 v224, s[4:7], s45 offen sc1 lds
    buffer_load_dwordx4 v225, s[72:75], s45 offen offset:1024 sc1 lds
    s_waitcnt lgkmcnt(4)
    v_mad_u32_u16 v226, v226, s39, v248 op_sel:[1,0,0,0]
    v_mad_u32_u16 v227, v227, s39, v248 op_sel:[1,0,0,0]
    v_fmac_f32 v245, v60, v172
    v_fmac_f32 v237, v53, v125
    v_mfma_f32_32x32x16_bf16 v[32:47], v[64:67], v[188:191], 0
    v_add_u32 v228, s51, v251
    ds_read2_b32 v[228:229], v228 offset0:1 offset1:3
    v_fmac_f32 v245, v61, v173
    v_fmac_f32 v237, v54, v126
    v_fmac_f32 v245, v62, v174
    v_fmac_f32 v237, v55, v127
    v_fmac_f32 v245, v63, v175
    v_mfma_f32_32x32x16_bf16 v[48:63], v[68:71], v[188:191], 0
    v_permlane32_swap_b32 v242, v234
    v_permlane32_swap_b32 v243, v235
    v_add_f32 v242, v242, v234
    v_add_f32 v243, v243, v235
    s_waitcnt vmcnt(4) lgkmcnt(1)
    v_mfma_f32_32x32x16_bf16 v[0:15], v[72:75], v[176:179], v[0:15]
    ds_read_b64_tr_b16 v[184:185], v246 offset:6144
    ds_read_b64_tr_b16 v[188:189], v247 offset:6144
    s_set_gpr_idx_on s31, gpr_idx(DST)
    s_nop 0
    v_cvt_pk_bf16_f32 v194, v242, v243
    s_set_gpr_idx_off
    s_mov_b32 s32, s31
    s_mov_b32 m0, s70
    v_mfma_f32_32x32x16_bf16 v[16:31], v[76:79], v[176:179], v[16:31]
    buffer_load_dwordx4 v226, s[4:7], s46 offen sc1 lds
    buffer_load_dwordx4 v227, s[72:75], s46 offen offset:1024 sc1 lds
    s_waitcnt lgkmcnt(2)
    v_mad_u32_u16 v228, v228, s39, v248 op_sel:[1,0,0,0]
    v_mad_u32_u16 v229, v229, s39, v248 op_sel:[1,0,0,0]
    s_sub_u32 s26, s48, s29
    s_mov_b32 s29, s48
    v_mfma_f32_32x32x16_bf16 v[32:47], v[72:75], v[180:183], v[32:47]
    s_mov_b32 s30, s3
    s_bfe_u32 s56, s3, 0x40012
    s_cmp_eq_u32 s34, 0
    s_cselect_b32 s56, s56, 0
    s_mov_b32 s31, s35
    v_mfma_f32_32x32x16_bf16 v[48:63], v[76:79], v[180:183], v[48:63]
    s_waitcnt vmcnt(4) lgkmcnt(0)
    v_mfma_f32_32x32x8_bf16 v[0:15], v[80:81], v[184:185], v[0:15]
    ds_read_b64_tr_b16 v[176:177], v246 offset:0
    ds_read_b64_tr_b16 v[178:179], v246 offset:1024
    ds_read_b64_tr_b16 v[180:181], v247 offset:0
    ds_read_b64_tr_b16 v[182:183], v247 offset:1024
    s_mov_b32 m0, s71
    v_mfma_f32_32x32x8_bf16 v[16:31], v[84:85], v[184:185], v[16:31]
    buffer_load_dwordx4 v228, s[4:7], s47 offen sc1 lds
    buffer_load_dwordx4 v229, s[72:75], s47 offen offset:1024 sc1 lds
    v_mfma_f32_32x32x8_bf16 v[32:47], v[80:81], v[188:189], v[32:47]
    s_nop 2
    v_mul_f32 v242, v0, v144
    v_fma_f32 v240, v8, v160, -v240
    v_fmac_f32 v242, v1, v145
    v_fmac_f32 v240, v9, v161
    v_fmac_f32 v242, v2, v146
    v_fmac_f32 v240, v10, v162
    v_fmac_f32 v242, v3, v147
    v_mfma_f32_32x32x8_bf16 v[48:63], v[84:85], v[188:189], v[48:63]
    s_setprio 0
    v_fmac_f32 v240, v11, v163
    v_fmac_f32 v242, v4, v148
    v_fmac_f32 v240, v12, v164
    v_fmac_f32 v242, v5, v149
    v_fmac_f32 v240, v13, v165
    v_fmac_f32 v242, v6, v150
    v_fmac_f32 v240, v14, v166
    v_fmac_f32 v242, v7, v151
    v_fmac_f32 v240, v15, v167
    v_add_u32 v249, s26, v249
    v_add_u32 v250, s26, v250
    v_fma_f32 v244, v16, v160, -v244
    v_fmac_f32 v236, v24, v112
    v_fmac_f32 v244, v17, v161
    v_fmac_f32 v236, v25, v113
    v_fmac_f32 v244, v18, v162
    v_fmac_f32 v236, v26, v114
    v_fmac_f32 v244, v19, v163
    v_fmac_f32 v236, v27, v115
    v_fmac_f32 v244, v20, v164
    v_fmac_f32 v236, v28, v116
    v_fmac_f32 v244, v21, v165
    v_fmac_f32 v236, v29, v117
    v_fmac_f32 v244, v22, v166
    v_fmac_f32 v236, v30, v118
    v_fmac_f32 v244, v23, v167
    v_fmac_f32 v236, v31, v119
    ds_read_b64_tr_b16 v[0:1], v249 offset:0
    ds_read_b64_tr_b16 v[2:3], v249 offset:32
    ds_read_u16_d16_hi v16, v250 offset:0
    v_mul_f32 v243, v32, v152
    v_fma_f32 v241, v40, v168, -v241
    v_fmac_f32 v243, v33, v153
    v_fmac_f32 v241, v41, v169
    v_fmac_f32 v243, v34, v154
    v_fmac_f32 v241, v42, v170
    v_fmac_f32 v243, v35, v155
    v_fmac_f32 v241, v43, v171
    v_fmac_f32 v243, v36, v156
    v_fmac_f32 v241, v44, v172
    v_fmac_f32 v243, v37, v157
    v_fmac_f32 v241, v45, v173
    v_fmac_f32 v243, v38, v158
    v_fmac_f32 v241, v46, v174
    v_fmac_f32 v243, v39, v159
    v_fmac_f32 v241, v47, v175
    ds_read_b64_tr_b16 v[4:5], v249 offset:512
    ds_read_b64_tr_b16 v[6:7], v249 offset:544
    ds_read_u16_d16_hi v17, v250 offset:128
    v_fma_f32 v245, v48, v168, -v245
    v_fmac_f32 v237, v56, v120
    v_fmac_f32 v245, v49, v169
    v_fmac_f32 v237, v57, v121
    v_fmac_f32 v245, v50, v170
    v_fmac_f32 v237, v58, v122
    v_fmac_f32 v245, v51, v171
    v_fmac_f32 v237, v59, v123
    v_fmac_f32 v245, v52, v172
    v_fmac_f32 v237, v60, v124
    v_fmac_f32 v245, v53, v173
    v_fmac_f32 v237, v61, v125
    v_fmac_f32 v245, v54, v174
    v_fmac_f32 v237, v62, v126
    v_fmac_f32 v245, v55, v175
    v_fmac_f32 v237, v63, v127
    s_cmp_eq_u32 s56, 5
    s_cbranch_scc1 K2_U20
    s_cmp_eq_u32 s56, 6
    s_cbranch_scc1 K2_U3h0
    s_branch K2_DSP0
K2_U30:
    s_setprio 1
    ds_read_b64_tr_b16 v[8:9], v249 offset:1024
    ds_read_b64_tr_b16 v[10:11], v249 offset:1056
    ds_read_u16_d16_hi v18, v250 offset:256
    s_waitcnt lgkmcnt(3)
    v_lshlrev_b32 v20, 16, v0
    v_and_b32 v21, 0xffff0000, v0
    v_lshlrev_b32 v22, 16, v1
    v_and_b32 v23, 0xffff0000, v1
    v_lshlrev_b32 v24, 16, v2
    v_and_b32 v25, 0xffff0000, v2
    v_lshlrev_b32 v26, 16, v3
    v_and_b32 v27, 0xffff0000, v3
    v_mul_f32_dpp v36, v16, v20 row_newbcast:8 row_mask:0xf bank_mask:0xf
    v_mul_f32_dpp v37, v16, v21 row_newbcast:9 row_mask:0xf bank_mask:0xf
    v_mul_f32_dpp v38, v16, v22 row_newbcast:10 row_mask:0xf bank_mask:0xf
    v_mul_f32_dpp v39, v16, v23 row_newbcast:11 row_mask:0xf bank_mask:0xf
    v_mul_f32_dpp v40, v16, v24 row_newbcast:12 row_mask:0xf bank_mask:0xf
    v_mul_f32_dpp v41, v16, v25 row_newbcast:13 row_mask:0xf bank_mask:0xf
    v_mul_f32_dpp v42, v16, v26 row_newbcast:14 row_mask:0xf bank_mask:0xf
    v_mul_f32_dpp v43, v16, v27 row_newbcast:15 row_mask:0xf bank_mask:0xf
    v_cvt_pk_bf16_f32 v68, v36, v37
    v_cvt_pk_bf16_f32 v69, v38, v39
    v_cvt_pk_bf16_f32 v70, v40, v41
    v_cvt_pk_bf16_f32 v71, v42, v43
    v_mul_f32_dpp v20, v16, v20 row_newbcast:0 row_mask:0xa bank_mask:0xf
    v_mul_f32_dpp v21, v16, v21 row_newbcast:1 row_mask:0xa bank_mask:0xf
    v_mul_f32_dpp v22, v16, v22 row_newbcast:2 row_mask:0xa bank_mask:0xf
    v_mul_f32_dpp v23, v16, v23 row_newbcast:3 row_mask:0xa bank_mask:0xf
    v_mul_f32_dpp v24, v16, v24 row_newbcast:4 row_mask:0xa bank_mask:0xf
    v_mul_f32_dpp v25, v16, v25 row_newbcast:5 row_mask:0xa bank_mask:0xf
    v_mul_f32_dpp v26, v16, v26 row_newbcast:6 row_mask:0xa bank_mask:0xf
    v_mul_f32_dpp v27, v16, v27 row_newbcast:7 row_mask:0xa bank_mask:0xf
    v_cvt_pk_bf16_f32 v64, v20, v21
    v_cvt_pk_bf16_f32 v65, v22, v23
    v_cvt_pk_bf16_f32 v66, v24, v25
    v_cvt_pk_bf16_f32 v67, v26, v27
    v_lshlrev_b32 v28, 16, v4
    v_and_b32 v29, 0xffff0000, v4
    v_lshlrev_b32 v30, 16, v5
    v_and_b32 v31, 0xffff0000, v5
    v_lshlrev_b32 v32, 16, v6
    v_and_b32 v33, 0xffff0000, v6
    v_lshlrev_b32 v34, 16, v7
    v_and_b32 v35, 0xffff0000, v7
    v_mul_f32_dpp v36, v17, v28 row_newbcast:8 row_mask:0xf bank_mask:0xf
    v_mul_f32_dpp v37, v17, v29 row_newbcast:9 row_mask:0xf bank_mask:0xf
    v_mul_f32_dpp v38, v17, v30 row_newbcast:10 row_mask:0xf bank_mask:0xf
    v_mul_f32_dpp v39, v17, v31 row_newbcast:11 row_mask:0xf bank_mask:0xf
    v_mul_f32_dpp v40, v17, v32 row_newbcast:12 row_mask:0xf bank_mask:0xf
    v_mul_f32_dpp v41, v17, v33 row_newbcast:13 row_mask:0xf bank_mask:0xf
    v_mul_f32_dpp v42, v17, v34 row_newbcast:14 row_mask:0xf bank_mask:0xf
    v_mul_f32_dpp v43, v17, v35 row_newbcast:15 row_mask:0xf bank_mask:0xf
    v_cvt_pk_bf16_f32 v76, v36, v37
    v_cvt_pk_bf16_f32 v77, v38, v39
    v_cvt_pk_bf16_f32 v78, v40, v41
    v_cvt_pk_bf16_f32 v79, v42, v43
    v_mul_f32_dpp v28, v17, v28 row_newbcast:0 row_mask:0xa bank_mask:0xf
    v_mul_f32_dpp v29, v17, v29 row_newbcast:1 row_mask:0xa bank_mask:0xf
    v_mul_f32_dpp v30, v17, v30 row_newbcast:2 row_mask:0xa bank_mask:0xf
    v_mul_f32_dpp v31, v17, v31 row_newbcast:3 row_mask:0xa bank_mask:0xf
    v_mul_f32_dpp v32, v17, v32 row_newbcast:4 row_mask:0xa bank_mask:0xf
    v_mul_f32_dpp v33, v17, v33 row_newbcast:5 row_mask:0xa bank_mask:0xf
    v_mul_f32_dpp v34, v17, v34 row_newbcast:6 row_mask:0xa bank_mask:0xf
    v_mul_f32_dpp v35, v17, v35 row_newbcast:7 row_mask:0xa bank_mask:0xf
    v_cvt_pk_bf16_f32 v72, v28, v29
    v_cvt_pk_bf16_f32 v73, v30, v31
    v_cvt_pk_bf16_f32 v74, v32, v33
    v_cvt_pk_bf16_f32 v75, v34, v35
    s_waitcnt lgkmcnt(0)
    v_lshlrev_b32 v20, 16, v8
    v_and_b32 v21, 0xffff0000, v8
    v_lshlrev_b32 v22, 16, v9
    v_and_b32 v23, 0xffff0000, v9
    v_lshlrev_b32 v24, 16, v10
    v_and_b32 v25, 0xffff0000, v10
    v_lshlrev_b32 v26, 16, v11
    v_and_b32 v27, 0xffff0000, v11
    v_mul_f32_dpp v36, v18, v20 row_newbcast:8 row_mask:0xf bank_mask:0xf
    v_mul_f32_dpp v37, v18, v21 row_newbcast:9 row_mask:0xf bank_mask:0xf
    v_mul_f32_dpp v38, v18, v22 row_newbcast:10 row_mask:0xf bank_mask:0xf
    v_mul_f32_dpp v39, v18, v23 row_newbcast:11 row_mask:0xf bank_mask:0xf
    v_mul_f32_dpp v40, v18, v24 row_newbcast:12 row_mask:0xf bank_mask:0xf
    v_mul_f32_dpp v41, v18, v25 row_newbcast:13 row_mask:0xf bank_mask:0xf
    v_mul_f32_dpp v42, v18, v26 row_newbcast:14 row_mask:0xf bank_mask:0xf
    v_mul_f32_dpp v43, v18, v27 row_newbcast:15 row_mask:0xf bank_mask:0xf
    v_cvt_pk_bf16_f32 v84, v36, v37
    v_cvt_pk_bf16_f32 v85, v38, v39
    v_cvt_pk_bf16_f32 v86, v40, v41
    v_cvt_pk_bf16_f32 v87, v42, v43
    v_mul_f32_dpp v20, v18, v20 row_newbcast:0 row_mask:0xa bank_mask:0xf
    v_mul_f32_dpp v21, v18, v21 row_newbcast:1 row_mask:0xa bank_mask:0xf
    v_mul_f32_dpp v22, v18, v22 row_newbcast:2 row_mask:0xa bank_mask:0xf
    v_mul_f32_dpp v23, v18, v23 row_newbcast:3 row_mask:0xa bank_mask:0xf
    v_mul_f32_dpp v24, v18, v24 row_newbcast:4 row_mask:0xa bank_mask:0xf
    v_mul_f32_dpp v25, v18, v25 row_newbcast:5 row_mask:0xa bank_mask:0xf
    v_mul_f32_dpp v26, v18, v26 row_newbcast:6 row_mask:0xa bank_mask:0xf
    v_mul_f32_dpp v27, v18, v27 row_newbcast:7 row_mask:0xa bank_mask:0xf
    v_cvt_pk_bf16_f32 v80, v20, v21
    v_cvt_pk_bf16_f32 v81, v22, v23
    v_cvt_pk_bf16_f32 v82, v24, v25
    v_cvt_pk_bf16_f32 v83, v26, v27
    s_waitcnt vmcnt(4)
    v_mfma_f32_32x32x16_bf16 v[0:15], v[64:67], v[176:179], 0
    ds_read_b64_tr_b16 v[184:185], v246 offset:2048
    ds_read_b64_tr_b16 v[186:187], v246 offset:3072
    ds_read_b64_tr_b16 v[188:189], v247 offset:2048
    ds_read_b64_tr_b16 v[190:191], v247 offset:3072
    s_mov_b32 m0, s68
    v_mfma_f32_32x32x16_bf16 v[16:31], v[68:71], v[176:179], 0
    buffer_load_dwordx4 v224, s[4:7], s41 offen sc1 lds
    buffer_load_dwordx4 v225, s[72:75], s41 offen offset:1024 sc1 lds
    v_permlane32_swap_b32 v242, v236
    v_permlane32_swap_b32 v243, v237
    s_add_u32 s38, s38, 1
    v_mfma_f32_32x32x16_bf16 v[32:47], v[64:67], v[180:183], 0
    v_permlane32_swap_b32 v244, v238
    v_permlane32_swap_b32 v245, v239
    v_permlane32_swap_b32 v240, v241
    v_add_f32 v242, v242, v236
    v_mfma_f32_32x32x16_bf16 v[48:63], v[68:71], v[180:183], 0
    v_add_f32 v243, v243, v237
    v_add_f32 v244, v244, v238
    v_add_f32 v245, v245, v239
    v_add_f32 v240, -v240, -v241
    v_mov_b32 v254, s52
    v_mov_b32 v255, s38
    s_waitcnt vmcnt(4) lgkmcnt(0)
    v_mfma_f32_32x32x16_bf16 v[0:15], v[72:75], v[184:187], v[0:15]
    ds_read_b64_tr_b16 v[176:177], v246 offset:4096
    ds_read_b64_tr_b16 v[178:179], v246 offset:5120
    ds_read_b64_tr_b16 v[180:181], v247 offset:4096
    ds_read_b64_tr_b16 v[182:183], v247 offset:5120
    s_lshl_b32 s58, s38, 3
    s_add_u32 s58, s58, s20
    s_mov_b32 m0, s69
    v_mfma_f32_32x32x16_bf16 v[16:31], v[76:79], v[184:187], v[16:31]
    buffer_load_dwordx4 v226, s[4:7], s41 offen sc1 lds
    buffer_load_dwordx4 v227, s[72:75], s41 offen offset:1024 sc1 lds
    s_set_gpr_idx_on s32, gpr_idx(DST)
    s_nop 0
    v_cvt_pk_bf16_f32 v195, v242, v243
    v_cvt_pk_bf16_f32 v196, v244, v245
    v_cvt_pk_bf16_f32 v197, v240, v240
    s_set_gpr_idx_off
    s_mov_b64 exec, 1
    ds_write_b32 v254, v255
    s_mov_b64 exec, -1
    s_cmp_lt_u32 s58, s22
    s_cbranch_scc0 K2_dyn_34
K2_back_35:
    v_readlane_b32 s3, v253, s58
    s_lshl_b32 s44, s34, 7
    s_and_b32 s48, s3, 0x3ffff
    s_bfe_u32 s33, s3, 0x30013
    s_mul_i32 s35, s38, 6
    s_cmp_eq_u32 s34, 0
    s_cselect_b32 s35, s35, s48
    s_mov_b32 s45, s44
    s_xor_b32 s47, s44, 256
    s_add_u32 s49, s48, 128
    s_add_u32 s60, s48, 256
    s_cmp_eq_u32 s33, 3
    s_cselect_b32 s46, s44, s47
    s_cselect_b32 s50, s60, s48
    s_cselect_b32 s51, s48, s49
    s_sub_u32 s60, s33, 2
    s_cmp_lt_u32 s60, 2
    s_cbranch_scc0 K2_rare_40
K2_back_41:
    v_mfma_f32_32x32x16_bf16 v[32:47], v[72:75], v[188:191], v[32:47]
    v_add_u32 v233, s48, v230
    ds_read_b32 v232, v233
    ds_read_b32 v233, v233 offset:1024
    v_mfma_f32_32x32x16_bf16 v[48:63], v[76:79], v[188:191], v[48:63]
    s_waitcnt vmcnt(4) lgkmcnt(3)
    v_mfma_f32_32x32x16_bf16 v[0:15], v[80:83], v[176:179], v[0:15]
    ds_read_b64_tr_b16 v[184:185], v246 offset:6144
    ds_read_b64_tr_b16 v[186:187], v246 offset:7168
    ds_read_b64_tr_b16 v[188:189], v247 offset:6144
    ds_read_b64_tr_b16 v[190:191], v247 offset:7168
    s_mov_b32 m0, s70
    v_mfma_f32_32x32x16_bf16 v[16:31], v[84:87], v[176:179], v[16:31]
    buffer_load_dwordx4 v222, s[4:7], s42 offen sc1 lds
    buffer_load_dwordx4 v223, s[72:75], s42 offen offset:1024 sc1 lds
    v_mfma_f32_32x32x16_bf16 v[32:47], v[80:83], v[180:183], v[32:47]
    s_nop 2
    v_mul_f32 v234, v0, v96
    v_mul_f32 v236, v8, v128
    v_fmac_f32 v234, v1, v97
    v_fmac_f32 v236, v9, v129
    v_fmac_f32 v234, v2, v98
    v_fmac_f32 v236, v10, v130
    v_fmac_f32 v234, v3, v99
    v_mfma_f32_32x32x16_bf16 v[48:63], v[84:87], v[180:183], v[48:63]
    s_setprio 0
    s_waitcnt lgkmcnt(4)
    v_or_b32 v232, v232, v231
    v_or_b32 v233, v233, v231
    s_cmp_lg_u32 s34, 0
    s_cbranch_scc1 K2_dum_43
    s_cmp_eq_u32 s33, 4
    s_cbranch_scc1 K2_a4_44
K2_b4_46:
    s_add_u32 m0, s48, 512
    s_add_u32 s65, s48, 1536
    buffer_load_dwordx4 v232, s[16:19], 0 offen  lds
    s_mov_b32 m0, s65
    s_mov_b32 exec_hi, 0
    buffer_load_dwordx4 v233, s[16:19], 0 offen  lds
    s_mov_b32 exec_hi, -1
K2_back_45:
    v_fmac_f32 v236, v11, v131
    v_fmac_f32 v234, v4, v100
    v_fmac_f32 v236, v12, v132
    v_fmac_f32 v234, v5, v101
    v_fmac_f32 v236, v13, v133
    v_fmac_f32 v234, v6, v102
    v_fmac_f32 v236, v14, v134
    v_fmac_f32 v234, v7, v103
    v_fmac_f32 v236, v15, v135
    v_mul_f32 v238, v16, v128
    v_mul_f32 v240, v24, v128
    v_fmac_f32 v238, v17, v129
    v_fmac_f32 v240, v25, v129
    v_fmac_f32 v238, v18, v130
    v_fmac_f32 v240, v26, v130
    v_fmac_f32 v238, v19, v131
    v_fmac_f32 v240, v27, v131
    v_fmac_f32 v238, v20, v132
    v_fmac_f32 v240, v28, v132
    v_fmac_f32 v238, v21, v133
    v_fmac_f32 v240, v29, v133
    v_fmac_f32 v238, v22, v134
    v_fmac_f32 v240, v30, v134
    v_fmac_f32 v238, v23, v135
    v_fmac_f32 v240, v31, v135
    v_mul_f32 v235, v32, v104
    v_mul_f32 v237, v40, v136
    v_fmac_f32 v235, v33, v105
    v_fmac_f32 v237, v41, v137
    v_fmac_f32 v235, v34, v106
    v_fmac_f32 v237, v42, v138
    v_fmac_f32 v235, v35, v107
    v_fmac_f32 v237, v43, v139
    v_fmac_f32 v235, v36, v108
    v_fmac_f32 v237, v44, v140
    v_fmac_f32 v235, v37, v109
    v_fmac_f32 v237, v45, v141
    v_fmac_f32 v235, v38, v110
    v_fmac_f32 v237, v46, v142
    v_fmac_f32 v235, v39, v111
    v_fmac_f32 v237, v47, v143
    v_mul_f32 v239, v48, v136
    v_mul_f32 v241, v56, v136
    s_setprio 1
    s_waitcnt vmcnt(6) lgkmcnt(0)
    v_mfma_f32_32x32x16_bf16 v[0:15], v[64:67], v[184:187], 0
    ds_read_b64_tr_b16 v[176:177], v246 offset:0
    ds_read_b64_tr_b16 v[178:179], v246 offset:1024
    ds_read_b64_tr_b16 v[180:181], v247 offset:0
    ds_read_b64_tr_b16 v[182:183], v247 offset:1024
    v_fmac_f32 v239, v49, v137
    v_fmac_f32 v241, v57, v137
    s_mov_b32 m0, s71
    v_mfma_f32_32x32x16_bf16 v[16:31], v[68:71], v[184:187], 0
    buffer_load_dwordx4 v224, s[4:7], s42 offen sc1 lds
    buffer_load_dwordx4 v225, s[72:75], s42 offen offset:1024 sc1 lds
    v_fmac_f32 v239, v50, v138
    v_fmac_f32 v241, v58, v138
    v_fmac_f32 v239, v51, v139
    v_fmac_f32 v241, v59, v139
    v_fmac_f32 v239, v52, v140
    v_mfma_f32_32x32x16_bf16 v[32:47], v[64:67], v[188:191], 0
    v_fmac_f32 v241, v60, v140
    v_fmac_f32 v239, v53, v141
    v_fmac_f32 v241, v61, v141
    v_fmac_f32 v239, v54, v142
    v_fmac_f32 v241, v62, v142
    v_fmac_f32 v239, v55, v143
    v_fmac_f32 v241, v63, v143
    v_mfma_f32_32x32x16_bf16 v[48:63], v[68:71], v[188:191], 0
    v_permlane32_swap_b32 v234, v236
    v_permlane32_swap_b32 v235, v237
    v_permlane32_swap_b32 v240, v238
    s_waitcnt vmcnt(6) lgkmcnt(0)
    v_mfma_f32_32x32x16_bf16 v[0:15], v[72:75], v[176:179], v[0:15]
    ds_read_b64_tr_b16 v[184:185], v246 offset:2048
    ds_read_b64_tr_b16 v[186:187], v246 offset:3072
    ds_read_b64_tr_b16 v[188:189], v247 offset:2048
    ds_read_b64_tr_b16 v[190:191], v247 offset:3072
    v_permlane32_swap_b32 v241, v239
    s_mov_b32 m0, s68
    v_mfma_f32_32x32x16_bf16 v[16:31], v[76:79], v[176:179], v[16:31]
    buffer_load_dwordx4 v226, s[4:7], s42 offen sc1 lds
    buffer_load_dwordx4 v227, s[72:75], s42 offen offset:1024 sc1 lds
    v_add_f32 v234, v234, v236
    v_add_f32 v235, v235, v237
    v_add_f32 v240, v240, v238
    v_add_f32 v241, v241, v239
    v_mfma_f32_32x32x16_bf16 v[32:47], v[72:75], v[180:183], v[32:47]
    s_set_gpr_idx_on s31, gpr_idx(DST)
    s_nop 0
    v_cvt_pk_bf16_f32 v192, v234, v235
    v_cvt_pk_bf16_f32 v193, v240, v241
    s_set_gpr_idx_off
    v_mfma_f32_32x32x16_bf16 v[48:63], v[76:79], v[180:183], v[48:63]
    s_waitcnt vmcnt(6) lgkmcnt(0)
    v_mfma_f32_32x32x16_bf16 v[0:15], v[80:83], v[184:187], v[0:15]
    ds_read_b64_tr_b16 v[176:177], v246 offset:4096
    ds_read_b64_tr_b16 v[178:179], v246 offset:5120
    ds_read_b64_tr_b16 v[180:181], v247 offset:4096
    ds_read_b64_tr_b16 v[182:183], v247 offset:5120
    s_mov_b32 m0, s69
    v_mfma_f32_32x32x16_bf16 v[16:31], v[84:87], v[184:187], v[16:31]
    buffer_load_dwordx4 v222, s[4:7], s43 offen sc1 lds
    buffer_load_dwordx4 v223, s[72:75], s43 offen offset:1024 sc1 lds
    v_mfma_f32_32x32x16_bf16 v[32:47], v[80:83], v[188:191], v[32:47]
    s_nop 2
    v_mul_f32 v234, v0, v144
    v_mul_f32 v236, v8, v112
    v_fmac_f32 v234, v1, v145
    v_fmac_f32 v236, v9, v113
    v_fmac_f32 v234, v2, v146
    v_fmac_f32 v236, v10, v114
    v_fmac_f32 v234, v3, v147
    v_mfma_f32_32x32x16_bf16 v[48:63], v[84:87], v[188:191], v[48:63]
    s_setprio 0
    v_fmac_f32 v236, v11, v115
    v_fmac_f32 v234, v4, v148
    v_fmac_f32 v236, v12, v116
    v_fmac_f32 v234, v5, v149
    v_fmac_f32 v236, v13, v117
    v_fmac_f32 v234, v6, v150
    v_fmac_f32 v236, v14, v118
    v_fmac_f32 v234, v7, v151
    v_fmac_f32 v236, v15, v119
    v_mul_f32 v238, v16, v160
    v_mul_f32 v240, v24, v160
    v_fmac_f32 v238, v17, v161
    v_fmac_f32 v240, v25, v161
    v_fmac_f32 v238, v18, v162
    v_fmac_f32 v240, v26, v162
    v_fmac_f32 v238, v19, v163
    v_fmac_f32 v240, v27, v163
    v_fmac_f32 v238, v20, v164
    v_fmac_f32 v240, v28, v164
    v_fmac_f32 v238, v21, v165
    v_fmac_f32 v240, v29, v165
    v_fmac_f32 v238, v22, v166
    v_fmac_f32 v240, v30, v166
    v_fmac_f32 v238, v23, v167
    v_fmac_f32 v240, v31, v167
    v_mul_f32 v235, v32, v152
    v_mul_f32 v237, v40, v120
    v_fmac_f32 v235, v33, v153
    v_fmac_f32 v237, v41, v121
    v_fmac_f32 v235, v34, v154
    v_fmac_f32 v237, v42, v122
    v_fmac_f32 v235, v35, v155
    v_fmac_f32 v237, v43, v123
    v_fmac_f32 v235, v36, v156
    v_fmac_f32 v237, v44, v124
    v_fmac_f32 v235, v37, v157
    v_fmac_f32 v237, v45, v125
    v_fmac_f32 v235, v38, v158
    v_fmac_f32 v237, v46, v126
    v_fmac_f32 v235, v39, v159
    v_fmac_f32 v237, v47, v127
    v_mul_f32 v239, v48, v168
    v_mul_f32 v241, v56, v168
    v_fmac_f32 v239, v49, v169
    v_fmac_f32 v241, v57, v169
    s_setprio 1
    s_waitcnt vmcnt(4) lgkmcnt(0)
    v_mfma_f32_32x32x16_bf16 v[0:15], v[64:67], v[176:179], 0
    ds_read_b64_tr_b16 v[184:185], v246 offset:6144
    ds_read_b64_tr_b16 v[186:187], v246 offset:7168
    ds_read_b64_tr_b16 v[188:189], v247 offset:6144
    ds_read_b64_tr_b16 v[190:191], v247 offset:7168
    v_fmac_f32 v239, v50, v170
    v_fmac_f32 v241, v58, v170
    s_mov_b32 m0, s70
    v_mfma_f32_32x32x16_bf16 v[16:31], v[68:71], v[176:179], 0
    buffer_load_dwordx4 v224, s[4:7], s43 offen sc1 lds
    buffer_load_dwordx4 v225, s[72:75], s43 offen offset:1024 sc1 lds
    v_fmac_f32 v239, v51, v171
    v_fmac_f32 v241, v59, v171
    v_fmac_f32 v239, v52, v172
    v_fmac_f32 v241, v60, v172
    v_fmac_f32 v239, v53, v173
    v_mfma_f32_32x32x16_bf16 v[32:47], v[64:67], v[180:183], 0
    v_add_u32 v222, s48, v251
    ds_read2_b32 v[222:223], v222 offset0:1 offset1:3
    v_fmac_f32 v241, v61, v173
    v_fmac_f32 v239, v54, v174
    v_fmac_f32 v241, v62, v174
    v_fmac_f32 v239, v55, v175
    v_fmac_f32 v241, v63, v175
    v_mfma_f32_32x32x16_bf16 v[48:63], v[68:71], v[180:183], 0
    s_waitcnt vmcnt(4) lgkmcnt(1)
    v_mfma_f32_32x32x16_bf16 v[0:15], v[72:75], v[184:187], v[0:15]
    ds_read_b64_tr_b16 v[176:177], v246 offset:0
    ds_read_b64_tr_b16 v[178:179], v246 offset:1024
    ds_read_b64_tr_b16 v[180:181], v247 offset:0
    ds_read_b64_tr_b16 v[182:183], v247 offset:1024
    s_mov_b32 m0, s71
    v_mfma_f32_32x32x16_bf16 v[16:31], v[76:79], v[184:187], v[16:31]
    buffer_load_dwordx4 v226, s[4:7], s43 offen sc1 lds
    buffer_load_dwordx4 v227, s[72:75], s43 offen offset:1024 sc1 lds
    s_waitcnt lgkmcnt(4)
    v_mad_u32_u16 v222, v222, s39, v248 op_sel:[1,0,0,0]
    v_mad_u32_u16 v223, v223, s39, v248 op_sel:[1,0,0,0]
    v_mfma_f32_32x32x16_bf16 v[32:47], v[72:75], v[188:191], v[32:47]
    v_add_u32 v224, s49, v251
    ds_read2_b32 v[224:225], v224 offset0:1 offset1:3
    v_mfma_f32_32x32x16_bf16 v[48:63], v[76:79], v[188:191], v[48:63]
    s_waitcnt vmcnt(4) lgkmcnt(1)
    v_mfma_f32_32x32x16_bf16 v[0:15], v[80:83], v[176:179], v[0:15]
    ds_read_b64_tr_b16 v[184:185], v246 offset:2048
    ds_read_b64_tr_b16 v[186:187], v246 offset:3072
    ds_read_b64_tr_b16 v[188:189], v247 offset:2048
    ds_read_b64_tr_b16 v[190:191], v247 offset:3072
    s_mov_b32 m0, s68
    v_mfma_f32_32x32x16_bf16 v[16:31], v[84:87], v[176:179], v[16:31]
    buffer_load_dwordx4 v222, s[4:7], s44 offen sc1 lds
    buffer_load_dwordx4 v223, s[72:75], s44 offen offset:1024 sc1 lds
    s_waitcnt lgkmcnt(4)
    v_mad_u32_u16 v224, v224, s39, v248 op_sel:[1,0,0,0]
    v_mad_u32_u16 v225, v225, s39, v248 op_sel:[1,0,0,0]
    v_mfma_f32_32x32x16_bf16 v[32:47], v[80:83], v[180:183], v[32:47]
    v_add_u32 v226, s50, v251
    ds_read2_b32 v[226:227], v226 offset0:1 offset1:3
    v_mul_f32 v242, v0, v144
    v_fma_f32 v238, v8, v160, -v238
    v_fmac_f32 v242, v1, v145
    v_fmac_f32 v238, v9, v161
    v_fmac_f32 v242, v2, v146
    v_mfma_f32_32x32x16_bf16 v[48:63], v[84:87], v[180:183], v[48:63]
    s_setprio 0
    v_fmac_f32 v238, v10, v162
    v_fmac_f32 v242, v3, v147
    v_fmac_f32 v238, v11, v163
    v_fmac_f32 v242, v4, v148
    v_fmac_f32 v238, v12, v164
    v_fmac_f32 v242, v5, v149
    v_fmac_f32 v238, v13, v165
    v_fmac_f32 v242, v6, v150
    v_fmac_f32 v238, v14, v166
    v_fmac_f32 v242, v7, v151
    v_fmac_f32 v238, v15, v167
    v_fmac_f32 v236, v16, v112
    v_mul_f32 v244, v24, v160
    v_fmac_f32 v236, v17, v113
    v_fmac_f32 v244, v25, v161
    v_fmac_f32 v236, v18, v114
    v_fmac_f32 v244, v26, v162
    v_fmac_f32 v236, v19, v115
    v_fmac_f32 v244, v27, v163
    v_fmac_f32 v236, v20, v116
    v_fmac_f32 v244, v28, v164
    v_fmac_f32 v236, v21, v117
    v_fmac_f32 v244, v29, v165
    v_fmac_f32 v236, v22, v118
    v_fmac_f32 v244, v30, v166
    v_fmac_f32 v236, v23, v119
    v_fmac_f32 v244, v31, v167
    v_mul_f32 v243, v32, v152
    v_fma_f32 v239, v40, v168, -v239
    v_fmac_f32 v243, v33, v153
    v_fmac_f32 v239, v41, v169
    v_fmac_f32 v243, v34, v154
    v_fmac_f32 v239, v42, v170
    v_fmac_f32 v243, v35, v155
    v_fmac_f32 v239, v43, v171
    v_fmac_f32 v243, v36, v156
    v_fmac_f32 v239, v44, v172
    v_fmac_f32 v243, v37, v157
    v_fmac_f32 v239, v45, v173
    v_fmac_f32 v243, v38, v158
    v_fmac_f32 v239, v46, v174
    v_fmac_f32 v243, v39, v159
    v_fmac_f32 v239, v47, v175
    v_fmac_f32 v237, v48, v120
    v_mul_f32 v245, v56, v168
    v_fmac_f32 v237, v49, v121
    v_fmac_f32 v245, v57, v169
    v_fmac_f32 v237, v50, v122
    v_fmac_f32 v245, v58, v170
    v_fmac_f32 v237, v51, v123
    s_setprio 1
    s_waitcnt vmcnt(4) lgkmcnt(1)
    v_mfma_f32_32x32x16_bf16 v[0:15], v[64:67], v[184:187], 0
    ds_read_b64_tr_b16 v[176:177], v246 offset:4096
    ds_read_b64_tr_b16 v[178:179], v246 offset:5120
    ds_read_b64_tr_b16 v[180:181], v247 offset:4096
    ds_read_b64_tr_b16 v[182:183], v247 offset:5120
    v_fmac_f32 v245, v59, v171
    v_fmac_f32 v237, v52, v124
    s_mov_b32 m0, s69
    v_mfma_f32_32x32x16_bf16 v[16:31], v[68:71], v[184:187], 0
    buffer_load_dwordx4 v224, s[4:7], s45 offen sc1 lds
    buffer_load_dwordx4 v225, s[72:75], s45 offen offset:1024 sc1 lds
    s_waitcnt lgkmcnt(4)
    v_mad_u32_u16 v226, v226, s39, v248 op_sel:[1,0,0,0]
    v_mad_u32_u16 v227, v227, s39, v248 op_sel:[1,0,0,0]
    v_fmac_f32 v245, v60, v172
    v_fmac_f32 v237, v53, v125
    v_mfma_f32_32x32x16_bf16 v[32:47], v[64:67], v[188:191], 0
    v_add_u32 v228, s51, v251
    ds_read2_b32 v[228:229], v228 offset0:1 offset1:3
    v_fmac_f32 v245, v61, v173
    v_fmac_f32 v237, v54, v126
    v_fmac_f32 v245, v62, v174
    v_fmac_f32 v237, v55, v127
    v_fmac_f32 v245, v63, v175
    v_mfma_f32_32x32x16_bf16 v[48:63], v[68:71], v[188:191], 0
    v_permlane32_swap_b32 v242, v234
    v_permlane32_swap_b32 v243, v235
    v_add_f32 v242, v242, v234
    v_add_f32 v243, v243, v235
    s_waitcnt vmcnt(4) lgkmcnt(1)
    v_mfma_f32_32x32x16_bf16 v[0:15], v[72:75], v[176:179], v[0:15]
    ds_read_b64_tr_b16 v[184:185], v246 offset:6144
    ds_read_b64_tr_b16 v[186:187], v246 offset:7168
    ds_read_b64_tr_b16 v[188:189], v247 offset:6144
    ds_read_b64_tr_b16 v[190:191], v247 offset:7168
    s_mov_b32 m0, s70
    v_mfma_f32_32x32x16_bf16 v[16:31], v[76:79], v[176:179], v[16:31]
    buffer_load_dwordx4 v226, s[4:7], s46 offen sc1 lds
    buffer_load_dwordx4 v227, s[72:75], s46 offen offset:1024 sc1 lds
    s_waitcnt lgkmcnt(4)
    v_mad_u32_u16 v228, v228, s39, v248 op_sel:[1,0,0,0]
    v_mad_u32_u16 v229, v229, s39, v248 op_sel:[1,0,0,0]
    s_sub_u32 s26, s48, s29
    s_mov_b32 s29, s48
    v_mfma_f32_32x32x16_bf16 v[32:47], v[72:75], v[180:183], v[32:47]
    s_set_gpr_idx_on s31, gpr_idx(DST)
    s_nop 0
    v_cvt_pk_bf16_f32 v194, v242, v243
    s_set_gpr_idx_off
    s_mov_b32 s30, s3
    s_bfe_u32 s56, s3, 0x40012
    s_cmp_eq_u32 s34, 0
    s_cselect_b32 s56, s56, 0
    v_mfma_f32_32x32x16_bf16 v[48:63], v[76:79], v[180:183], v[48:63]
    s_mov_b32 s32, s31
    s_mov_b32 s31, s35
    s_waitcnt vmcnt(4) lgkmcnt(0)
    v_mfma_f32_32x32x16_bf16 v[0:15], v[80:83], v[184:187], v[0:15]
    ds_read_b64_tr_b16 v[176:177], v246 offset:0
    ds_read_b64_tr_b16 v[178:179], v246 offset:1024
    ds_read_b64_tr_b16 v[180:181], v247 offset:0
    ds_read_b64_tr_b16 v[182:183], v247 offset:1024
    s_mov_b32 m0, s71
    v_mfma_f32_32x32x16_bf16 v[16:31], v[84:87], v[184:187], v[16:31]
    buffer_load_dwordx4 v228, s[4:7], s47 offen sc1 lds
    buffer_load_dwordx4 v229, s[72:75], s47 offen offset:1024 sc1 lds
    v_mfma_f32_32x32x16_bf16 v[32:47], v[80:83], v[188:191], v[32:47]
    s_nop 2
    v_mul_f32 v242, v0, v144
    v_fma_f32 v240, v8, v160, -v240
    v_fmac_f32 v242, v1, v145
    v_fmac_f32 v240, v9, v161
    v_fmac_f32 v242, v2, v146
    v_fmac_f32 v240, v10, v162
    v_fmac_f32 v242, v3, v147
    v_mfma_f32_32x32x16_bf16 v[48:63], v[84:87], v[188:191], v[48:63]
    s_setprio 0
    v_fmac_f32 v240, v11, v163
    v_fmac_f32 v242, v4, v148
    v_fmac_f32 v240, v12, v164
    v_fmac_f32 v242, v5, v149
    v_fmac_f32 v240, v13, v165
    v_fmac_f32 v242, v6, v150
    v_fmac_f32 v240, v14, v166
    v_fmac_f32 v242, v7, v151
    v_fmac_f32 v240, v15, v167
    v_add_u32 v249, s26, v249
    v_add_u32 v250, s26, v250
    v_fma_f32 v244, v16, v160, -v244
    v_fmac_f32 v236, v24, v112
    v_fmac_f32 v244, v17, v161
    v_fmac_f32 v236, v25, v113
    v_fmac_f32 v244, v18, v162
    v_fmac_f32 v236, v26, v114
    v_fmac_f32 v244, v19, v163
    v_fmac_f32 v236, v27, v115
    v_fmac_f32 v244, v20, v164
    v_fmac_f32 v236, v28, v116
    v_fmac_f32 v244, v21, v165
    v_fmac_f32 v236, v29, v117
    v_fmac_f32 v244, v22, v166
    v_fmac_f32 v236, v30, v118
    v_fmac_f32 v244, v23, v167
    v_fmac_f32 v236, v31, v119
    ds_read_b64_tr_b16 v[0:1], v249 offset:0
    ds_read_b64_tr_b16 v[2:3], v249 offset:32
    ds_read_u16_d16_hi v16, v250 offset:0
    v_mul_f32 v243, v32, v152
    v_fma_f32 v241, v40, v168, -v241
    v_fmac_f32 v243, v33, v153
    v_fmac_f32 v241, v41, v169
    v_fmac_f32 v243, v34, v154
    v_fmac_f32 v241, v42, v170
    v_fmac_f32 v243, v35, v155
    v_fmac_f32 v241, v43, v171
    v_fmac_f32 v243, v36, v156
    v_fmac_f32 v241, v44, v172
    v_fmac_f32 v243, v37, v157
    v_fmac_f32 v241, v45, v173
    v_fmac_f32 v243, v38, v158
    v_fmac_f32 v241, v46, v174
    v_fmac_f32 v243, v39, v159
    v_fmac_f32 v241, v47, v175
    ds_read_b64_tr_b16 v[4:5], v249 offset:512
    ds_read_b64_tr_b16 v[6:7], v249 offset:544
    ds_read_u16_d16_hi v17, v250 offset:128
    v_fma_f32 v245, v48, v168, -v245
    v_fmac_f32 v237, v56, v120
    v_fmac_f32 v245, v49, v169
    v_fmac_f32 v237, v57, v121
    v_fmac_f32 v245, v50, v170
    v_fmac_f32 v237, v58, v122
    v_fmac_f32 v245, v51, v171
    v_fmac_f32 v237, v59, v123
    v_fmac_f32 v245, v52, v172
    v_fmac_f32 v237, v60, v124
    v_fmac_f32 v245, v53, v173
    v_fmac_f32 v237, v61, v125
    v_fmac_f32 v245, v54, v174
    v_fmac_f32 v237, v62, v126
    v_fmac_f32 v245, v55, v175
    v_fmac_f32 v237, v63, v127
    s_cmp_eq_u32 s56, 5
    s_cbranch_scc1 K2_U20
    s_cmp_eq_u32 s56, 6
    s_cbranch_scc1 K2_U3h0
    s_branch K2_DSP0
K2_PAD_U21:
    s_branch K2_HOP
K2_U21:
    s_setprio 1
    s_waitcnt lgkmcnt(0)
    v_lshlrev_b32 v20, 16, v0
    v_and_b32 v21, 0xffff0000, v0
    v_lshlrev_b32 v22, 16, v1
    v_and_b32 v23, 0xffff0000, v1
    v_lshlrev_b32 v24, 16, v2
    v_and_b32 v25, 0xffff0000, v2
    v_lshlrev_b32 v26, 16, v3
    v_and_b32 v27, 0xffff0000, v3
    v_mul_f32_dpp v36, v16, v20 row_newbcast:8 row_mask:0xf bank_mask:0xf
    v_mul_f32_dpp v37, v16, v21 row_newbcast:9 row_mask:0xf bank_mask:0xf
    v_mul_f32_dpp v38, v16, v22 row_newbcast:10 row_mask:0xf bank_mask:0xf
    v_mul_f32_dpp v39, v16, v23 row_newbcast:11 row_mask:0xf bank_mask:0xf
    v_mul_f32_dpp v40, v16, v24 row_newbcast:12 row_mask:0xf bank_mask:0xf
    v_mul_f32_dpp v41, v16, v25 row_newbcast:13 row_mask:0xf bank_mask:0xf
    v_mul_f32_dpp v42, v16, v26 row_newbcast:14 row_mask:0xf bank_mask:0xf
    v_mul_f32_dpp v43, v16, v27 row_newbcast:15 row_mask:0xf bank_mask:0xf
    v_cvt_pk_bf16_f32 v68, v36, v37
    v_cvt_pk_bf16_f32 v69, v38, v39
    v_cvt_pk_bf16_f32 v70, v40, v41
    v_cvt_pk_bf16_f32 v71, v42, v43
    v_mul_f32_dpp v20, v16, v20 row_newbcast:0 row_mask:0xa bank_mask:0xf
    v_mul_f32_dpp v21, v16, v21 row_newbcast:1 row_mask:0xa bank_mask:0xf
    v_mul_f32_dpp v22, v16, v22 row_newbcast:2 row_mask:0xa bank_mask:0xf
    v_mul_f32_dpp v23, v16, v23 row_newbcast:3 row_mask:0xa bank_mask:0xf
    v_mul_f32_dpp v24, v16, v24 row_newbcast:4 row_mask:0xa bank_mask:0xf
    v_mul_f32_dpp v25, v16, v25 row_newbcast:5 row_mask:0xa bank_mask:0xf
    v_mul_f32_dpp v26, v16, v26 row_newbcast:6 row_mask:0xa bank_mask:0xf
    v_mul_f32_dpp v27, v16, v27 row_newbcast:7 row_mask:0xa bank_mask:0xf
    v_cvt_pk_bf16_f32 v64, v20, v21
    v_cvt_pk_bf16_f32 v65, v22, v23
    v_cvt_pk_bf16_f32 v66, v24, v25
    v_cvt_pk_bf16_f32 v67, v26, v27
    v_lshlrev_b32 v28, 16, v4
    v_and_b32 v29, 0xffff0000, v4
    v_lshlrev_b32 v30, 16, v5
    v_and_b32 v31, 0xffff0000, v5
    v_lshlrev_b32 v32, 16, v6
    v_and_b32 v33, 0xffff0000, v6
    v_lshlrev_b32 v34, 16, v7
    v_and_b32 v35, 0xffff0000, v7
    v_mul_f32_dpp v36, v17, v28 row_newbcast:8 row_mask:0xf bank_mask:0xf
    v_mul_f32_dpp v37, v17, v29 row_newbcast:9 row_mask:0xf bank_mask:0xf
    v_mul_f32_dpp v38, v17, v30 row_newbcast:10 row_mask:0xf bank_mask:0xf
    v_mul_f32_dpp v39, v17, v31 row_newbcast:11 row_mask:0xf bank_mask:0xf
    v_mul_f32_dpp v40, v17, v32 row_newbcast:12 row_mask:0xf bank_mask:0xf
    v_mul_f32_dpp v41, v17, v33 row_newbcast:13 row_mask:0xf bank_mask:0xf
    v_mul_f32_dpp v42, v17, v34 row_newbcast:14 row_mask:0xf bank_mask:0xf
    v_mul_f32_dpp v43, v17, v35 row_newbcast:15 row_mask:0xf bank_mask:0xf
    v_cvt_pk_bf16_f32 v76, v36, v37
    v_cvt_pk_bf16_f32 v77, v38, v39
    v_cvt_pk_bf16_f32 v78, v40, v41
    v_cvt_pk_bf16_f32 v79, v42, v43
    v_mul_f32_dpp v28, v17, v28 row_newbcast:0 row_mask:0xa bank_mask:0xf
    v_mul_f32_dpp v29, v17, v29 row_newbcast:1 row_mask:0xa bank_mask:0xf
    v_mul_f32_dpp v30, v17, v30 row_newbcast:2 row_mask:0xa bank_mask:0xf
    v_mul_f32_dpp v31, v17, v31 row_newbcast:3 row_mask:0xa bank_mask:0xf
    v_mul_f32_dpp v32, v17, v32 row_newbcast:4 row_mask:0xa bank_mask:0xf
    v_mul_f32_dpp v33, v17, v33 row_newbcast:5 row_mask:0xa bank_mask:0xf
    v_mul_f32_dpp v34, v17, v34 row_newbcast:6 row_mask:0xa bank_mask:0xf
    v_mul_f32_dpp v35, v17, v35 row_newbcast:7 row_mask:0xa bank_mask:0xf
    v_cvt_pk_bf16_f32 v72, v28, v29
    v_cvt_pk_bf16_f32 v73, v30, v31
    v_cvt_pk_bf16_f32 v74, v32, v33
    v_cvt_pk_bf16_f32 v75, v34, v35
    s_waitcnt vmcnt(4)
    v_mfma_f32_32x32x16_bf16 v[0:15], v[64:67], v[176:179], 0
    ds_read_b64_tr_b16 v[184:185], v246 offset:2048
    ds_read_b64_tr_b16 v[186:187], v246 offset:3072
    ds_read_b64_tr_b16 v[188:189], v247 offset:2048
    ds_read_b64_tr_b16 v[190:191], v247 offset:3072
    s_mov_b32 m0, s68
    v_mfma_f32_32x32x16_bf16 v[16:31], v[68:71], v[176:179], 0
    buffer_load_dwordx4 v222, s[4:7], s42 offen sc1 lds
    buffer_load_dwordx4 v223, s[72:75], s42 offen offset:1024 sc1 lds
    v_permlane32_swap_b32 v242, v236
    v_permlane32_swap_b32 v243, v237
    v_mov_b32 v254, 163296
    v_mfma_f32_32x32x16_bf16 v[32:47], v[64:67], v[180:183], 0
    v_permlane32_swap_b32 v244, v238
    v_permlane32_swap_b32 v245, v239
    v_permlane32_swap_b32 v240, v241
    v_add_f32 v242, v242, v236
    v_mfma_f32_32x32x16_bf16 v[48:63], v[68:71], v[180:183], 0
    v_add_f32 v243, v243, v237
    v_add_f32 v244, v244, v238
    v_add_f32 v245, v245, v239
    v_add_f32 v240, -v240, -v241
    v_sub_u32 v241, v230, v231
    v_cvt_pk_bf16_f32 v242, v242, v243
    v_mov_b32 v255, 1
    v_lshl_add_u32 v233, v252, 1, s53
    s_mov_b64 exec, 1
    ds_add_rtn_u32 v232, v254, v255
    s_mov_b64 exec, -1
    ds_read_b32 v233, v233
    s_waitcnt vmcnt(4) lgkmcnt(2)
    v_mfma_f32_32x32x16_bf16 v[0:15], v[72:75], v[184:187], v[0:15]
    ds_read_b64_tr_b16 v[176:177], v246 offset:4096
    ds_read_b64_tr_b16 v[178:179], v246 offset:5120
    ds_read_b64_tr_b16 v[180:181], v247 offset:4096
    ds_read_b64_tr_b16 v[182:183], v247 offset:5120
    v_cvt_pk_bf16_f32 v244, v244, v245
    v_cvt_pk_bf16_f32 v240, v240, v240
    s_mov_b32 m0, s69
    v_mfma_f32_32x32x16_bf16 v[16:31], v[76:79], v[184:187], v[16:31]
    buffer_load_dwordx4 v224, s[4:7], s42 offen sc1 lds
    buffer_load_dwordx4 v225, s[72:75], s42 offen offset:1024 sc1 lds
    ds_write_b32 v230, v242 offset:768
    ds_write_b32 v230, v244 offset:1024
    ds_write_b16 v241, v240 offset:1280
    s_waitcnt lgkmcnt(7)
    v_readfirstlane_b32 s58, v232
    v_mfma_f32_32x32x16_bf16 v[32:47], v[72:75], v[188:191], v[32:47]
    s_cmp_lt_u32 s58, s22
    s_cbranch_scc0 K2_nul_47
    s_and_b32 s59, s58, 7
    s_lshr_b32 s60, s58, 3
K2_chk_49:
    v_readlane_b32 s61, v233, s59
    s_nop 0
    s_cmp_gt_u32 s61, s60
    s_cbranch_scc0 K2_spin_48
K2_back_50:
    v_mfma_f32_32x32x16_bf16 v[48:63], v[76:79], v[188:191], v[48:63]
    s_setprio 0
    v_readlane_b32 s3, v253, s58
    s_lshl_b32 s44, s34, 7
    s_and_b32 s48, s3, 0x3ffff
    s_bfe_u32 s33, s3, 0x30013
    s_mov_b32 s35, s48
    s_mov_b32 s45, s44
    v_mul_f32 v234, v0, v96
    v_mul_f32 v236, v8, v128
    v_fmac_f32 v234, v1, v97
    v_fmac_f32 v236, v9, v129
    v_fmac_f32 v234, v2, v98
    v_fmac_f32 v236, v10, v130
    v_fmac_f32 v234, v3, v99
    v_fmac_f32 v236, v11, v131
    v_fmac_f32 v234, v4, v100
    v_fmac_f32 v236, v12, v132
    v_fmac_f32 v234, v5, v101
    v_fmac_f32 v236, v13, v133
    v_fmac_f32 v234, v6, v102
    v_fmac_f32 v236, v14, v134
    v_fmac_f32 v234, v7, v103
    v_fmac_f32 v236, v15, v135
    v_mul_f32 v238, v16, v128
    v_mul_f32 v240, v24, v128
    v_fmac_f32 v238, v17, v129
    v_fmac_f32 v240, v25, v129
    v_fmac_f32 v238, v18, v130
    v_fmac_f32 v240, v26, v130
    v_fmac_f32 v238, v19, v131
    v_fmac_f32 v240, v27, v131
    v_fmac_f32 v238, v20, v132
    v_fmac_f32 v240, v28, v132
    v_fmac_f32 v238, v21, v133
    v_fmac_f32 v240, v29, v133
    v_fmac_f32 v238, v22, v134
    v_fmac_f32 v240, v30, v134
    v_fmac_f32 v238, v23, v135
    v_fmac_f32 v240, v31, v135
    v_mul_f32 v235, v32, v104
    v_mul_f32 v237, v40, v136
    v_fmac_f32 v235, v33, v105
    v_fmac_f32 v237, v41, v137
    v_fmac_f32 v235, v34, v106
    v_fmac_f32 v237, v42, v138
    v_fmac_f32 v235, v35, v107
    v_fmac_f32 v237, v43, v139
    v_fmac_f32 v235, v36, v108
    v_fmac_f32 v237, v44, v140
    v_fmac_f32 v235, v37, v109
    v_fmac_f32 v237, v45, v141
    v_fmac_f32 v235, v38, v110
    v_fmac_f32 v237, v46, v142
    v_fmac_f32 v235, v39, v111
    v_fmac_f32 v237, v47, v143
    v_mul_f32 v239, v48, v136
    v_mul_f32 v241, v56, v136
    v_fmac_f32 v239, v49, v137
    v_fmac_f32 v241, v57, v137
    s_setprio 1
    s_waitcnt vmcnt(4) lgkmcnt(3)
    v_mfma_f32_32x32x16_bf16 v[0:15], v[64:67], v[176:179], 0
    ds_read_b64_tr_b16 v[184:185], v246 offset:6144
    ds_read_b64_tr_b16 v[186:187], v246 offset:7168
    ds_read_b64_tr_b16 v[188:189], v247 offset:6144
    ds_read_b64_tr_b16 v[190:191], v247 offset:7168
    v_fmac_f32 v239, v50, v138
    v_fmac_f32 v241, v58, v138
    s_mov_b32 m0, s70
    v_mfma_f32_32x32x16_bf16 v[16:31], v[68:71], v[176:179], 0
    buffer_load_dwordx4 v222, s[4:7], s43 offen sc1 lds
    buffer_load_dwordx4 v223, s[72:75], s43 offen offset:1024 sc1 lds
    v_fmac_f32 v239, v51, v139
    v_fmac_f32 v241, v59, v139
    v_fmac_f32 v239, v52, v140
    v_fmac_f32 v241, v60, v140
    v_fmac_f32 v239, v53, v141
    v_mfma_f32_32x32x16_bf16 v[32:47], v[64:67], v[180:183], 0
    s_xor_b32 s47, s44, 256
    s_add_u32 s49, s48, 128
    s_add_u32 s60, s48, 256
    s_cmp_eq_u32 s33, 3
    s_cselect_b32 s46, s44, s47
    s_cselect_b32 s50, s60, s48
    s_cselect_b32 s51, s48, s49
    s_sub_u32 s60, s33, 2
    s_cmp_lt_u32 s60, 2
    s_cbranch_scc0 K2_rare_51
K2_back_52:
    v_add_u32 v222, s48, v251
    ds_read2_b32 v[222:223], v222 offset0:1 offset1:3
    v_fmac_f32 v241, v61, v141
    v_fmac_f32 v239, v54, v142
    v_fmac_f32 v241, v62, v142
    v_fmac_f32 v239, v55, v143
    v_fmac_f32 v241, v63, v143
    v_mfma_f32_32x32x16_bf16 v[48:63], v[68:71], v[180:183], 0
    v_permlane32_swap_b32 v234, v236
    v_permlane32_swap_b32 v235, v237
    v_permlane32_swap_b32 v240, v238
    s_waitcnt vmcnt(4) lgkmcnt(1)
    v_mfma_f32_32x32x16_bf16 v[0:15], v[72:75], v[184:187], v[0:15]
    ds_read_b64_tr_b16 v[176:177], v246 offset:0
    ds_read_b64_tr_b16 v[178:179], v246 offset:1024
    ds_read_b64_tr_b16 v[180:181], v247 offset:0
    ds_read_b64_tr_b16 v[182:183], v247 offset:1024
    v_permlane32_swap_b32 v241, v239
    s_mov_b32 m0, s71
    v_mfma_f32_32x32x16_bf16 v[16:31], v[76:79], v[184:187], v[16:31]
    buffer_load_dwordx4 v224, s[4:7], s43 offen sc1 lds
    buffer_load_dwordx4 v225, s[72:75], s43 offen offset:1024 sc1 lds
    s_waitcnt lgkmcnt(4)
    v_mad_u32_u16 v222, v222, s39, v248 op_sel:[1,0,0,0]
    v_mad_u32_u16 v223, v223, s39, v248 op_sel:[1,0,0,0]
    v_lshl_add_u32 v230, v252, 1, s31
    v_add_f32 v234, v234, v236
    v_add_f32 v235, v235, v237
    v_add_f32 v240, v240, v238
    v_add_f32 v241, v241, v239
    v_cvt_pk_bf16_f32 v234, v234, v235
    v_cvt_pk_bf16_f32 v240, v240, v241
    ds_write_b32 v230, v234 offset:0
    ds_write_b32 v230, v240 offset:256
    v_mfma_f32_32x32x16_bf16 v[32:47], v[72:75], v[188:191], v[32:47]
    v_add_u32 v224, s49, v251
    ds_read2_b32 v[224:225], v224 offset0:1 offset1:3
    v_mul_f32 v234, v0, v144
    v_mul_f32 v236, v8, v112
    v_fmac_f32 v234, v1, v145
    v_fmac_f32 v236, v9, v113
    v_fmac_f32 v234, v2, v146
    v_mfma_f32_32x32x16_bf16 v[48:63], v[76:79], v[188:191], v[48:63]
    s_setprio 0
    v_fmac_f32 v236, v10, v114
    v_fmac_f32 v234, v3, v147
    v_fmac_f32 v236, v11, v115
    v_fmac_f32 v234, v4, v148
    v_fmac_f32 v236, v12, v116
    v_fmac_f32 v234, v5, v149
    v_fmac_f32 v236, v13, v117
    v_fmac_f32 v234, v6, v150
    v_fmac_f32 v236, v14, v118
    v_fmac_f32 v234, v7, v151
    v_fmac_f32 v236, v15, v119
    v_mul_f32 v238, v16, v160
    v_mul_f32 v240, v24, v160
    v_fmac_f32 v238, v17, v161
    v_fmac_f32 v240, v25, v161
    v_fmac_f32 v238, v18, v162
    v_fmac_f32 v240, v26, v162
    v_fmac_f32 v238, v19, v163
    v_fmac_f32 v240, v27, v163
    v_fmac_f32 v238, v20, v164
    v_fmac_f32 v240, v28, v164
    v_fmac_f32 v238, v21, v165
    v_fmac_f32 v240, v29, v165
    v_fmac_f32 v238, v22, v166
    v_fmac_f32 v240, v30, v166
    v_fmac_f32 v238, v23, v167
    v_fmac_f32 v240, v31, v167
    v_mul_f32 v235, v32, v152
    v_mul_f32 v237, v40, v120
    v_fmac_f32 v235, v33, v153
    v_fmac_f32 v237, v41, v121
    v_fmac_f32 v235, v34, v154
    v_fmac_f32 v237, v42, v122
    v_fmac_f32 v235, v35, v155
    v_fmac_f32 v237, v43, v123
    v_fmac_f32 v235, v36, v156
    v_fmac_f32 v237, v44, v124
    v_fmac_f32 v235, v37, v157
    v_fmac_f32 v237, v45, v125
    v_fmac_f32 v235, v38, v158
    v_fmac_f32 v237, v46, v126
    v_fmac_f32 v235, v39, v159
    v_fmac_f32 v237, v47, v127
    v_mul_f32 v239, v48, v168
    v_mul_f32 v241, v56, v168
    v_fmac_f32 v239, v49, v169
    v_fmac_f32 v241, v57, v169
    v_fmac_f32 v239, v50, v170
    v_fmac_f32 v241, v58, v170
    v_fmac_f32 v239, v51, v171
    s_setprio 1
    s_waitcnt vmcnt(4) lgkmcnt(3)
    v_mfma_f32_32x32x16_bf16 v[0:15], v[64:67], v[176:179], 0
    ds_read_b64_tr_b16 v[184:185], v246 offset:2048
    ds_read_b64_tr_b16 v[186:187], v246 offset:3072
    ds_read_b64_tr_b16 v[188:189], v247 offset:2048
    ds_read_b64_tr_b16 v[190:191], v247 offset:3072
    v_fmac_f32 v241, v59, v171
    v_fmac_f32 v239, v52, v172
    s_mov_b32 m0, s68
    v_mfma_f32_32x32x16_bf16 v[16:31], v[68:71], v[176:179], 0
    buffer_load_dwordx4 v222, s[4:7], s44 offen sc1 lds
    buffer_load_dwordx4 v223, s[72:75], s44 offen offset:1024 sc1 lds
    s_waitcnt lgkmcnt(4)
    v_mad_u32_u16 v224, v224, s39, v248 op_sel:[1,0,0,0]
    v_mad_u32_u16 v225, v225, s39, v248 op_sel:[1,0,0,0]
    v_fmac_f32 v241, v60, v172
    v_fmac_f32 v239, v53, v173
    v_mfma_f32_32x32x16_bf16 v[32:47], v[64:67], v[180:183], 0
    v_add_u32 v226, s50, v251
    ds_read2_b32 v[226:227], v226 offset0:1 offset1:3
    v_fmac_f32 v241, v61, v173
    v_fmac_f32 v239, v54, v174
    v_fmac_f32 v241, v62, v174
    v_fmac_f32 v239, v55, v175
    v_fmac_f32 v241, v63, v175
    v_mfma_f32_32x32x16_bf16 v[48:63], v[68:71], v[180:183], 0
    s_waitcnt vmcnt(4) lgkmcnt(1)
    v_mfma_f32_32x32x16_bf16 v[0:15], v[72:75], v[184:187], v[0:15]
    ds_read_b64_tr_b16 v[176:177], v246 offset:4096
    ds_read_b64_tr_b16 v[178:179], v246 offset:5120
    ds_read_b64_tr_b16 v[180:181], v247 offset:4096
    ds_read_b64_tr_b16 v[182:183], v247 offset:5120
    s_mov_b32 m0, s69
    v_mfma_f32_32x32x16_bf16 v[16:31], v[76:79], v[184:187], v[16:31]
    buffer_load_dwordx4 v224, s[4:7], s45 offen sc1 lds
    buffer_load_dwordx4 v225, s[72:75], s45 offen offset:1024 sc1 lds
    s_waitcnt lgkmcnt(4)
    v_mad_u32_u16 v226, v226, s39, v248 op_sel:[1,0,0,0]
    v_mad_u32_u16 v227, v227, s39, v248 op_sel:[1,0,0,0]
    v_mfma_f32_32x32x16_bf16 v[32:47], v[72:75], v[188:191], v[32:47]
    v_add_u32 v228, s51, v251
    ds_read2_b32 v[228:229], v228 offset0:1 offset1:3
    v_mul_f32 v242, v0, v144
    v_fma_f32 v238, v8, v160, -v238
    v_fmac_f32 v242, v1, v145
    v_fmac_f32 v238, v9, v161
    v_fmac_f32 v242, v2, v146
    v_mfma_f32_32x32x16_bf16 v[48:63], v[76:79], v[188:191], v[48:63]
    s_setprio 0
    v_fmac_f32 v238, v10, v162
    v_fmac_f32 v242, v3, v147
    v_fmac_f32 v238, v11, v163
    v_fmac_f32 v242, v4, v148
    v_fmac_f32 v238, v12, v164
    v_fmac_f32 v242, v5, v149
    v_fmac_f32 v238, v13, v165
    v_fmac_f32 v242, v6, v150
    v_fmac_f32 v238, v14, v166
    v_fmac_f32 v242, v7, v151
    v_fmac_f32 v238, v15, v167
    v_fmac_f32 v236, v16, v112
    v_mul_f32 v244, v24, v160
    v_fmac_f32 v236, v17, v113
    v_fmac_f32 v244, v25, v161
    v_fmac_f32 v236, v18, v114
    v_fmac_f32 v244, v26, v162
    v_fmac_f32 v236, v19, v115
    v_fmac_f32 v244, v27, v163
    v_fmac_f32 v236, v20, v116
    v_fmac_f32 v244, v28, v164
    v_fmac_f32 v236, v21, v117
    v_fmac_f32 v244, v29, v165
    v_fmac_f32 v236, v22, v118
    v_fmac_f32 v244, v30, v166
    v_fmac_f32 v236, v23, v119
    v_fmac_f32 v244, v31, v167
    v_mul_f32 v243, v32, v152
    v_fma_f32 v239, v40, v168, -v239
    v_fmac_f32 v243, v33, v153
    v_fmac_f32 v239, v41, v169
    v_fmac_f32 v243, v34, v154
    v_fmac_f32 v239, v42, v170
    v_fmac_f32 v243, v35, v155
    v_fmac_f32 v239, v43, v171
    v_fmac_f32 v243, v36, v156
    v_fmac_f32 v239, v44, v172
    v_fmac_f32 v243, v37, v157
    v_fmac_f32 v239, v45, v173
    v_fmac_f32 v243, v38, v158
    v_fmac_f32 v239, v46, v174
    v_fmac_f32 v243, v39, v159
    v_fmac_f32 v239, v47, v175
    v_fmac_f32 v237, v48, v120
    v_mul_f32 v245, v56, v168
    v_fmac_f32 v237, v49, v121
    v_fmac_f32 v245, v57, v169
    v_fmac_f32 v237, v50, v122
    s_setprio 1
    s_waitcnt vmcnt(4) lgkmcnt(1)
    v_mfma_f32_32x32x16_bf16 v[0:15], v[64:67], v[176:179], 0
    ds_read_b64_tr_b16 v[184:185], v246 offset:6144
    ds_read_b64_tr_b16 v[186:187], v246 offset:7168
    ds_read_b64_tr_b16 v[188:189], v247 offset:6144
    ds_read_b64_tr_b16 v[190:191], v247 offset:7168
    v_fmac_f32 v245, v58, v170
    v_fmac_f32 v237, v51, v123
    s_mov_b32 m0, s70
    v_mfma_f32_32x32x16_bf16 v[16:31], v[68:71], v[176:179], 0
    buffer_load_dwordx4 v226, s[4:7], s46 offen sc1 lds
    buffer_load_dwordx4 v227, s[72:75], s46 offen offset:1024 sc1 lds
    s_waitcnt lgkmcnt(4)
    v_mad_u32_u16 v228, v228, s39, v248 op_sel:[1,0,0,0]
    v_mad_u32_u16 v229, v229, s39, v248 op_sel:[1,0,0,0]
    v_fmac_f32 v245, v59, v171
    v_fmac_f32 v237, v52, v124
    v_mfma_f32_32x32x16_bf16 v[32:47], v[64:67], v[180:183], 0
    v_fmac_f32 v245, v60, v172
    v_fmac_f32 v237, v53, v125
    v_fmac_f32 v245, v61, v173
    v_fmac_f32 v237, v54, v126
    v_fmac_f32 v245, v62, v174
    v_fmac_f32 v237, v55, v127
    v_fmac_f32 v245, v63, v175
    v_mfma_f32_32x32x16_bf16 v[48:63], v[68:71], v[180:183], 0
    v_permlane32_swap_b32 v242, v234
    v_permlane32_swap_b32 v243, v235
    v_add_f32 v242, v242, v234
    v_add_f32 v243, v243, v235
    s_waitcnt vmcnt(4) lgkmcnt(0)
    v_mfma_f32_32x32x16_bf16 v[0:15], v[72:75], v[184:187], v[0:15]
    ds_read_b64_tr_b16 v[176:177], v246 offset:0
    ds_read_b64_tr_b16 v[178:179], v246 offset:1024
    ds_read_b64_tr_b16 v[180:181], v247 offset:0
    ds_read_b64_tr_b16 v[182:183], v247 offset:1024
    v_cvt_pk_bf16_f32 v242, v242, v243
    ds_write_b32 v230, v242 offset:512
    s_mov_b32 m0, s71
    v_mfma_f32_32x32x16_bf16 v[16:31], v[76:79], v[184:187], v[16:31]
    buffer_load_dwordx4 v228, s[4:7], s47 offen sc1 lds
    buffer_load_dwordx4 v229, s[72:75], s47 offen offset:1024 sc1 lds
    s_sub_u32 s26, s48, s29
    s_mov_b32 s29, s48
    s_mov_b32 s30, s3
    s_bfe_u32 s56, s3, 0x40012
    s_cmp_lg_u32 s36, 0
    s_cselect_b32 s56, s56, 0
    v_mfma_f32_32x32x16_bf16 v[32:47], v[72:75], v[188:191], v[32:47]
    s_mov_b32 s32, s31
    s_mov_b32 s31, s35
    v_mul_f32 v242, v0, v144
    v_fma_f32 v240, v8, v160, -v240
    v_fmac_f32 v242, v1, v145
    v_fmac_f32 v240, v9, v161
    v_fmac_f32 v242, v2, v146
    v_mfma_f32_32x32x16_bf16 v[48:63], v[76:79], v[188:191], v[48:63]
    s_setprio 0
    v_fmac_f32 v240, v10, v162
    v_fmac_f32 v242, v3, v147
    v_fmac_f32 v240, v11, v163
    v_fmac_f32 v242, v4, v148
    v_fmac_f32 v240, v12, v164
    v_fmac_f32 v242, v5, v149
    v_fmac_f32 v240, v13, v165
    v_fmac_f32 v242, v6, v150
    v_fmac_f32 v240, v14, v166
    v_fmac_f32 v242, v7, v151
    v_fmac_f32 v240, v15, v167
    v_add_u32 v249, s26, v249
    v_add_u32 v250, s26, v250
    v_fma_f32 v244, v16, v160, -v244
    v_fmac_f32 v236, v24, v112
    v_fmac_f32 v244, v17, v161
    v_fmac_f32 v236, v25, v113
    v_fmac_f32 v244, v18, v162
    v_fmac_f32 v236, v26, v114
    v_fmac_f32 v244, v19, v163
    v_fmac_f32 v236, v27, v115
    v_fmac_f32 v244, v20, v164
    v_fmac_f32 v236, v28, v116
    v_fmac_f32 v244, v21, v165
    v_fmac_f32 v236, v29, v117
    v_fmac_f32 v244, v22, v166
    v_fmac_f32 v236, v30, v118
    v_fmac_f32 v244, v23, v167
    v_fmac_f32 v236, v31, v119
    ds_read_b64_tr_b16 v[0:1], v249 offset:0
    ds_read_b64_tr_b16 v[2:3], v249 offset:32
    ds_read_u16_d16_hi v16, v250 offset:0
    v_mul_f32 v243, v32, v152
    v_fma_f32 v241, v40, v168, -v241
    v_fmac_f32 v243, v33, v153
    v_fmac_f32 v241, v41, v169
    v_fmac_f32 v243, v34, v154
    v_fmac_f32 v241, v42, v170
    v_fmac_f32 v243, v35, v155
    v_fmac_f32 v241, v43, v171
    v_fmac_f32 v243, v36, v156
    v_fmac_f32 v241, v44, v172
    v_fmac_f32 v243, v37, v157
    v_fmac_f32 v241, v45, v173
    v_fmac_f32 v243, v38, v158
    v_fmac_f32 v241, v46, v174
    v_fmac_f32 v243, v39, v159
    v_fmac_f32 v241, v47, v175
    ds_read_b64_tr_b16 v[4:5], v249 offset:512
    ds_read_b64_tr_b16 v[6:7], v249 offset:544
    ds_read_u16_d16_hi v17, v250 offset:128
    v_fma_f32 v245, v48, v168, -v245
    v_fmac_f32 v237, v56, v120
    v_fmac_f32 v245, v49, v169
    v_fmac_f32 v237, v57, v121
    v_fmac_f32 v245, v50, v170
    v_fmac_f32 v237, v58, v122
    v_fmac_f32 v245, v51, v171
    v_fmac_f32 v237, v59, v123
    v_fmac_f32 v245, v52, v172
    v_fmac_f32 v237, v60, v124
    v_fmac_f32 v245, v53, v173
    v_fmac_f32 v237, v61, v125
    v_fmac_f32 v245, v54, v174
    v_fmac_f32 v237, v62, v126
    v_fmac_f32 v245, v55, v175
    v_fmac_f32 v237, v63, v127
    s_cmp_eq_u32 s56, 5
    s_cbranch_scc1 K2_U21
    s_cmp_eq_u32 s56, 6
    s_cbranch_scc1 K2_U3h1
    s_branch K2_DSP1
K2_PAD_U31:
    s_branch K2_HOP
K2_U3h1:
    s_setprio 1
    ds_read_b64_tr_b16 v[8:9], v249 offset:1024
    ds_read_u16_d16_hi v18, v250 offset:256
    s_waitcnt lgkmcnt(2)
    v_lshlrev_b32 v20, 16, v0
    v_and_b32 v21, 0xffff0000, v0
    v_lshlrev_b32 v22, 16, v1
    v_and_b32 v23, 0xffff0000, v1
    v_lshlrev_b32 v24, 16, v2
    v_and_b32 v25, 0xffff0000, v2
    v_lshlrev_b32 v26, 16, v3
    v_and_b32 v27, 0xffff0000, v3
    v_mul_f32_dpp v36, v16, v20 row_newbcast:8 row_mask:0xf bank_mask:0xf
    v_mul_f32_dpp v37, v16, v21 row_newbcast:9 row_mask:0xf bank_mask:0xf
    v_mul_f32_dpp v38, v16, v22 row_newbcast:10 row_mask:0xf bank_mask:0xf
    v_mul_f32_dpp v39, v16, v23 row_newbcast:11 row_mask:0xf bank_mask:0xf
    v_mul_f32_dpp v40, v16, v24 row_newbcast:12 row_mask:0xf bank_mask:0xf
    v_mul_f32_dpp v41, v16, v25 row_newbcast:13 row_mask:0xf bank_mask:0xf
    v_mul_f32_dpp v42, v16, v26 row_newbcast:14 row_mask:0xf bank_mask:0xf
    v_mul_f32_dpp v43, v16, v27 row_newbcast:15 row_mask:0xf bank_mask:0xf
    v_cvt_pk_bf16_f32 v68, v36, v37
    v_cvt_pk_bf16_f32 v69, v38, v39
    v_cvt_pk_bf16_f32 v70, v40, v41
    v_cvt_pk_bf16_f32 v71, v42, v43
    v_mul_f32_dpp v20, v16, v20 row_newbcast:0 row_mask:0xa bank_mask:0xf
    v_mul_f32_dpp v21, v16, v21 row_newbcast:1 row_mask:0xa bank_mask:0xf
    v_mul_f32_dpp v22, v16, v22 row_newbcast:2 row_mask:0xa bank_mask:0xf
    v_mul_f32_dpp v23, v16, v23 row_newbcast:3 row_mask:0xa bank_mask:0xf
    v_mul_f32_dpp v24, v16, v24 row_newbcast:4 row_mask:0xa bank_mask:0xf
    v_mul_f32_dpp v25, v16, v25 row_newbcast:5 row_mask:0xa bank_mask:0xf
    v_mul_f32_dpp v26, v16, v26 row_newbcast:6 row_mask:0xa bank_mask:0xf
    v_mul_f32_dpp v27, v16, v27 row_newbcast:7 row_mask:0xa bank_mask:0xf
    v_cvt_pk_bf16_f32 v64, v20, v21
    v_cvt_pk_bf16_f32 v65, v22, v23
    v_cvt_pk_bf16_f32 v66, v24, v25
    v_cvt_pk_bf16_f32 v67, v26, v27
    v_lshlrev_b32 v28, 16, v4
    v_and_b32 v29, 0xffff0000, v4
    v_lshlrev_b32 v30, 16, v5
    v_and_b32 v31, 0xffff0000, v5
    v_lshlrev_b32 v32, 16, v6
    v_and_b32 v33, 0xffff0000, v6
    v_lshlrev_b32 v34, 16, v7
    v_and_b32 v35, 0xffff0000, v7
    v_mul_f32_dpp v36, v17, v28 row_newbcast:8 row_mask:0xf bank_mask:0xf
    v_mul_f32_dpp v37, v17, v29 row_newbcast:9 row_mask:0xf bank_mask:0xf
    v_mul_f32_dpp v38, v17, v30 row_newbcast:10 row_mask:0xf bank_mask:0xf
    v_mul_f32_dpp v39, v17, v31 row_newbcast:11 row_mask:0xf bank_mask:0xf
    v_mul_f32_dpp v40, v17, v32 row_newbcast:12 row_mask:0xf bank_mask:0xf
    v_mul_f32_dpp v41, v17, v33 row_newbcast:13 row_mask:0xf bank_mask:0xf
    v_mul_f32_dpp v42, v17, v34 row_newbcast:14 row_mask:0xf bank_mask:0xf
    v_mul_f32_dpp v43, v17, v35 row_newbcast:15 row_mask:0xf bank_mask:0xf
    v_cvt_pk_bf16_f32 v76, v36, v37
    v_cvt_pk_bf16_f32 v77, v38, v39
    v_cvt_pk_bf16_f32 v78, v40, v41
    v_cvt_pk_bf16_f32 v79, v42, v43
    v_mul_f32_dpp v28, v17, v28 row_newbcast:0 row_mask:0xa bank_mask:0xf
    v_mul_f32_dpp v29, v17, v29 row_newbcast:1 row_mask:0xa bank_mask:0xf
    v_mul_f32_dpp v30, v17, v30 row_newbcast:2 row_mask:0xa bank_mask:0xf
    v_mul_f32_dpp v31, v17, v31 row_newbcast:3 row_mask:0xa bank_mask:0xf
    v_mul_f32_dpp v32, v17, v32 row_newbcast:4 row_mask:0xa bank_mask:0xf
    v_mul_f32_dpp v33, v17, v33 row_newbcast:5 row_mask:0xa bank_mask:0xf
    v_mul_f32_dpp v34, v17, v34 row_newbcast:6 row_mask:0xa bank_mask:0xf
    v_mul_f32_dpp v35, v17, v35 row_newbcast:7 row_mask:0xa bank_mask:0xf
    v_cvt_pk_bf16_f32 v72, v28, v29
    v_cvt_pk_bf16_f32 v73, v30, v31
    v_cvt_pk_bf16_f32 v74, v32, v33
    v_cvt_pk_bf16_f32 v75, v34, v35
    s_waitcnt lgkmcnt(0)
    v_lshlrev_b32 v20, 16, v8
    v_and_b32 v21, 0xffff0000, v8
    v_lshlrev_b32 v22, 16, v9
    v_and_b32 v23, 0xffff0000, v9
    v_mul_f32_dpp v36, v18, v20 row_newbcast:8 row_mask:0xf bank_mask:0xf
    v_mul_f32_dpp v37, v18, v21 row_newbcast:9 row_mask:0xf bank_mask:0xf
    v_mul_f32_dpp v38, v18, v22 row_newbcast:10 row_mask:0xf bank_mask:0xf
    v_mul_f32_dpp v39, v18, v23 row_newbcast:11 row_mask:0xf bank_mask:0xf
    v_cvt_pk_bf16_f32 v84, v36, v37
    v_cvt_pk_bf16_f32 v85, v38, v39
    v_mul_f32_dpp v20, v18, v20 row_newbcast:0 row_mask:0xa bank_mask:0xf
    v_mul_f32_dpp v21, v18, v21 row_newbcast:1 row_mask:0xa bank_mask:0xf
    v_mul_f32_dpp v22, v18, v22 row_newbcast:2 row_mask:0xa bank_mask:0xf
    v_mul_f32_dpp v23, v18, v23 row_newbcast:3 row_mask:0xa bank_mask:0xf
    v_cvt_pk_bf16_f32 v80, v20, v21
    v_cvt_pk_bf16_f32 v81, v22, v23
    s_waitcnt vmcnt(4)
    v_mfma_f32_32x32x16_bf16 v[0:15], v[64:67], v[176:179], 0
    ds_read_b64_tr_b16 v[184:185], v246 offset:2048
    ds_read_b64_tr_b16 v[186:187], v246 offset:3072
    ds_read_b64_tr_b16 v[188:189], v247 offset:2048
    ds_read_b64_tr_b16 v[190:191], v247 offset:3072
    s_mov_b32 m0, s68
    v_mfma_f32_32x32x16_bf16 v[16:31], v[68:71], v[176:179], 0
    buffer_load_dwordx4 v224, s[4:7], s41 offen sc1 lds
    buffer_load_dwordx4 v225, s[72:75], s41 offen offset:1024 sc1 lds
    v_permlane32_swap_b32 v242, v236
    v_permlane32_swap_b32 v243, v237
    v_mov_b32 v254, 163296
    v_mfma_f32_32x32x16_bf16 v[32:47], v[64:67], v[180:183], 0
    v_permlane32_swap_b32 v244, v238
    v_permlane32_swap_b32 v245, v239
    v_permlane32_swap_b32 v240, v241
    v_add_f32 v242, v242, v236
    v_mfma_f32_32x32x16_bf16 v[48:63], v[68:71], v[180:183], 0
    v_add_f32 v243, v243, v237
    v_add_f32 v244, v244, v238
    v_add_f32 v245, v245, v239
    v_add_f32 v240, -v240, -v241
    v_sub_u32 v241, v230, v231
    v_cvt_pk_bf16_f32 v242, v242, v243
    v_mov_b32 v255, 1
    v_lshl_add_u32 v233, v252, 1, s53
    s_mov_b64 exec, 1
    ds_add_rtn_u32 v232, v254, v255
    s_mov_b64 exec, -1
    ds_read_b32 v233, v233
    s_waitcnt vmcnt(4) lgkmcnt(2)
    v_mfma_f32_32x32x16_bf16 v[0:15], v[72:75], v[184:187], v[0:15]
    ds_read_b64_tr_b16 v[176:177], v246 offset:4096
    ds_read_b64_tr_b16 v[180:181], v247 offset:4096
    v_cvt_pk_bf16_f32 v244, v244, v245
    v_cvt_pk_bf16_f32 v240, v240, v240
    ds_write_b32 v230, v242 offset:768
    ds_write_b32 v230, v244 offset:1024
    s_mov_b32 m0, s69
    v_mfma_f32_32x32x16_bf16 v[16:31], v[76:79], v[184:187], v[16:31]
    buffer_load_dwordx4 v226, s[4:7], s41 offen sc1 lds
    ds_write_b16 v241, v240 offset:1280
    s_waitcnt lgkmcnt(5)
    v_readfirstlane_b32 s58, v232
    v_mfma_f32_32x32x16_bf16 v[32:47], v[72:75], v[188:191], v[32:47]
    s_cmp_lt_u32 s58, s22
    s_cbranch_scc0 K2_nul_54
    s_and_b32 s59, s58, 7
    s_lshr_b32 s60, s58, 3
K2_chk_56:
    v_readlane_b32 s61, v233, s59
    s_nop 0
    s_cmp_gt_u32 s61, s60
    s_cbranch_scc0 K2_spin_55
K2_back_57:
    v_mfma_f32_32x32x16_bf16 v[48:63], v[76:79], v[188:191], v[48:63]
    v_readlane_b32 s3, v253, s58
    s_lshl_b32 s44, s34, 7
    s_and_b32 s48, s3, 0x3ffff
    s_bfe_u32 s33, s3, 0x30013
    s_mov_b32 s35, s48
    s_mov_b32 s45, s44
    s_waitcnt vmcnt(3) lgkmcnt(3)
    v_mfma_f32_32x32x8_bf16 v[0:15], v[80:81], v[176:177], v[0:15]
    ds_read_b64_tr_b16 v[184:185], v246 offset:6144
    ds_read_b64_tr_b16 v[186:187], v246 offset:7168
    ds_read_b64_tr_b16 v[188:189], v247 offset:6144
    ds_read_b64_tr_b16 v[190:191], v247 offset:7168
    s_xor_b32 s47, s44, 256
    s_add_u32 s49, s48, 128
    s_mov_b32 m0, s70
    v_mfma_f32_32x32x8_bf16 v[16:31], v[84:85], v[176:177], v[16:31]
    buffer_load_dwordx4 v222, s[4:7], s42 offen sc1 lds
    buffer_load_dwordx4 v223, s[72:75], s42 offen offset:1024 sc1 lds
    s_add_u32 s60, s48, 256
    s_cmp_eq_u32 s33, 3
    s_cselect_b32 s46, s44, s47
    s_cselect_b32 s50, s60, s48
    s_cselect_b32 s51, s48, s49
    v_mfma_f32_32x32x8_bf16 v[32:47], v[80:81], v[180:181], v[32:47]
    s_sub_u32 s60, s33, 2
    s_cmp_lt_u32 s60, 2
    s_cbranch_scc0 K2_rare_58
K2_back_59:
    v_mul_f32 v234, v0, v96
    v_mul_f32 v236, v8, v128
    v_fmac_f32 v234, v1, v97
    v_fmac_f32 v236, v9, v129
    v_mfma_f32_32x32x8_bf16 v[48:63], v[84:85], v[180:181], v[48:63]
    s_setprio 0
    v_fmac_f32 v234, v2, v98
    v_fmac_f32 v236, v10, v130
    v_fmac_f32 v234, v3, v99
    v_fmac_f32 v236, v11, v131
    v_fmac_f32 v234, v4, v100
    v_fmac_f32 v236, v12, v132
    v_fmac_f32 v234, v5, v101
    v_fmac_f32 v236, v13, v133
    v_fmac_f32 v234, v6, v102
    v_fmac_f32 v236, v14, v134
    v_fmac_f32 v234, v7, v103
    v_fmac_f32 v236, v15, v135
    v_mul_f32 v238, v16, v128
    v_mul_f32 v240, v24, v128
    v_fmac_f32 v238, v17, v129
    v_fmac_f32 v240, v25, v129
    v_fmac_f32 v238, v18, v130
    v_fmac_f32 v240, v26, v130
    v_fmac_f32 v238, v19, v131
    v_fmac_f32 v240, v27, v131
    v_fmac_f32 v238, v20, v132
    v_fmac_f32 v240, v28, v132
    v_fmac_f32 v238, v21, v133
    v_fmac_f32 v240, v29, v133
    v_fmac_f32 v238, v22, v134
    v_fmac_f32 v240, v30, v134
    v_fmac_f32 v238, v23, v135
    v_fmac_f32 v240, v31, v135
    v_mul_f32 v235, v32, v104
    v_mul_f32 v237, v40, v136
    v_fmac_f32 v235, v33, v105
    v_fmac_f32 v237, v41, v137
    v_fmac_f32 v235, v34, v106
    v_fmac_f32 v237, v42, v138
    v_fmac_f32 v235, v35, v107
    v_fmac_f32 v237, v43, v139
    v_fmac_f32 v235, v36, v108
    v_fmac_f32 v237, v44, v140
    v_fmac_f32 v235, v37, v109
    v_fmac_f32 v237, v45, v141
    v_fmac_f32 v235, v38, v110
    v_fmac_f32 v237, v46, v142
    v_fmac_f32 v235, v39, v111
    v_fmac_f32 v237, v47, v143
    v_mul_f32 v239, v48, v136
    v_mul_f32 v241, v56, v136
    s_setprio 1
    s_waitcnt vmcnt(3) lgkmcnt(0)
    v_mfma_f32_32x32x16_bf16 v[0:15], v[64:67], v[184:187], 0
    ds_read_b64_tr_b16 v[176:177], v246 offset:0
    ds_read_b64_tr_b16 v[178:179], v246 offset:1024
    ds_read_b64_tr_b16 v[180:181], v247 offset:0
    ds_read_b64_tr_b16 v[182:183], v247 offset:1024
    v_fmac_f32 v239, v49, v137
    v_fmac_f32 v241, v57, v137
    s_mov_b32 m0, s71
    v_mfma_f32_32x32x16_bf16 v[16:31], v[68:71], v[184:187], 0
    buffer_load_dwordx4 v224, s[4:7], s42 offen sc1 lds
    buffer_load_dwordx4 v225, s[72:75], s42 offen offset:1024 sc1 lds
    v_fmac_f32 v239, v50, v138
    v_fmac_f32 v241, v58, v138
    v_fmac_f32 v239, v51, v139
    v_fmac_f32 v241, v59, v139
    v_fmac_f32 v239, v52, v140
    v_mfma_f32_32x32x16_bf16 v[32:47], v[64:67], v[188:191], 0
    v_fmac_f32 v241, v60, v140
    v_fmac_f32 v239, v53, v141
    v_fmac_f32 v241, v61, v141
    v_fmac_f32 v239, v54, v142
    v_fmac_f32 v241, v62, v142
    v_fmac_f32 v239, v55, v143
    v_fmac_f32 v241, v63, v143
    v_mfma_f32_32x32x16_bf16 v[48:63], v[68:71], v[188:191], 0
    v_permlane32_swap_b32 v234, v236
    v_permlane32_swap_b32 v235, v237
    v_permlane32_swap_b32 v240, v238
    s_waitcnt vmcnt(4) lgkmcnt(0)
    v_mfma_f32_32x32x16_bf16 v[0:15], v[72:75], v[176:179], v[0:15]
    ds_read_b64_tr_b16 v[184:185], v246 offset:2048
    ds_read_b64_tr_b16 v[188:189], v247 offset:2048
    v_permlane32_swap_b32 v241, v239
    v_lshl_add_u32 v230, v252, 1, s31
    v_add_f32 v234, v234, v236
    s_mov_b32 m0, s68
    v_mfma_f32_32x32x16_bf16 v[16:31], v[76:79], v[176:179], v[16:31]
    buffer_load_dwordx4 v226, s[4:7], s42 offen sc1 lds
    v_add_f32 v235, v235, v237
    v_add_f32 v240, v240, v238
    v_add_f32 v241, v241, v239
    v_cvt_pk_bf16_f32 v234, v234, v235
    v_cvt_pk_bf16_f32 v240, v240, v241
    ds_write_b32 v230, v234 offset:0
    v_mfma_f32_32x32x16_bf16 v[32:47], v[72:75], v[180:183], v[32:47]
    ds_write_b32 v230, v240 offset:256
    v_mfma_f32_32x32x16_bf16 v[48:63], v[76:79], v[180:183], v[48:63]
    s_waitcnt vmcnt(3) lgkmcnt(2)
    v_mfma_f32_32x32x8_bf16 v[0:15], v[80:81], v[184:185], v[0:15]
    ds_read_b64_tr_b16 v[176:177], v246 offset:4096
    ds_read_b64_tr_b16 v[178:179], v246 offset:5120
    ds_read_b64_tr_b16 v[180:181], v247 offset:4096
    ds_read_b64_tr_b16 v[182:183], v247 offset:5120
    s_mov_b32 m0, s69
    v_mfma_f32_32x32x8_bf16 v[16:31], v[84:85], v[184:185], v[16:31]
    buffer_load_dwordx4 v222, s[4:7], s43 offen sc1 lds
    buffer_load_dwordx4 v223, s[72:75], s43 offen offset:1024 sc1 lds
    v_mfma_f32_32x32x8_bf16 v[32:47], v[80:81], v[188:189], v[32:47]
    s_nop 2
    v_mul_f32 v234, v0, v144
    v_mul_f32 v236, v8, v112
    v_fmac_f32 v234, v1, v145
    v_fmac_f32 v236, v9, v113
    v_fmac_f32 v234, v2, v146
    v_fmac_f32 v236, v10, v114
    v_fmac_f32 v234, v3, v147
    v_mfma_f32_32x32x8_bf16 v[48:63], v[84:85], v[188:189], v[48:63]
    s_setprio 0
    v_fmac_f32 v236, v11, v115
    v_fmac_f32 v234, v4, v148
    v_fmac_f32 v236, v12, v116
    v_fmac_f32 v234, v5, v149
    v_fmac_f32 v236, v13, v117
    v_fmac_f32 v234, v6, v150
    v_fmac_f32 v236, v14, v118
    v_fmac_f32 v234, v7, v151
    v_fmac_f32 v236, v15, v119
    v_mul_f32 v238, v16, v160
    v_mul_f32 v240, v24, v160
    v_fmac_f32 v238, v17, v161
    v_fmac_f32 v240, v25, v161
    v_fmac_f32 v238, v18, v162
    v_fmac_f32 v240, v26, v162
    v_fmac_f32 v238, v19, v163
    v_fmac_f32 v240, v27, v163
    v_fmac_f32 v238, v20, v164
    v_fmac_f32 v240, v28, v164
    v_fmac_f32 v238, v21, v165
    v_fmac_f32 v240, v29, v165
    v_fmac_f32 v238, v22, v166
    v_fmac_f32 v240, v30, v166
    v_fmac_f32 v238, v23, v167
    v_fmac_f32 v240, v31, v167
    v_mul_f32 v235, v32, v152
    v_mul_f32 v237, v40, v120
    v_fmac_f32 v235, v33, v153
    v_fmac_f32 v237, v41, v121
    v_fmac_f32 v235, v34, v154
    v_fmac_f32 v237, v42, v122
    v_fmac_f32 v235, v35, v155
    v_fmac_f32 v237, v43, v123
    v_fmac_f32 v235, v36, v156
    v_fmac_f32 v237, v44, v124
    v_fmac_f32 v235, v37, v157
    v_fmac_f32 v237, v45, v125
    v_fmac_f32 v235, v38, v158
    v_fmac_f32 v237, v46, v126
    v_fmac_f32 v235, v39, v159
    v_fmac_f32 v237, v47, v127
    v_mul_f32 v239, v48, v168
    v_mul_f32 v241, v56, v168
    v_fmac_f32 v239, v49, v169
    v_fmac_f32 v241, v57, v169
    s_setprio 1
    s_waitcnt vmcnt(3) lgkmcnt(0)
    v_mfma_f32_32x32x16_bf16 v[0:15], v[64:67], v[176:179], 0
    ds_read_b64_tr_b16 v[184:185], v246 offset:6144
    ds_read_b64_tr_b16 v[186:187], v246 offset:7168
    ds_read_b64_tr_b16 v[188:189], v247 offset:6144
    ds_read_b64_tr_b16 v[190:191], v247 offset:7168
    v_fmac_f32 v239, v50, v170
    v_fmac_f32 v241, v58, v170
    s_mov_b32 m0, s70
    v_mfma_f32_32x32x16_bf16 v[16:31], v[68:71], v[176:179], 0
    buffer_load_dwordx4 v224, s[4:7], s43 offen sc1 lds
    buffer_load_dwordx4 v225, s[72:75], s43 offen offset:1024 sc1 lds
    v_fmac_f32 v239, v51, v171
    v_fmac_f32 v241, v59, v171
    v_fmac_f32 v239, v52, v172
    v_fmac_f32 v241, v60, v172
    v_fmac_f32 v239, v53, v173
    v_mfma_f32_32x32x16_bf16 v[32:47], v[64:67], v[180:183], 0
    v_add_u32 v222, s48, v251
    ds_read2_b32 v[222:223], v222 offset0:1 offset1:3
    v_fmac_f32 v241, v61, v173
    v_fmac_f32 v239, v54, v174
    v_fmac_f32 v241, v62, v174
    v_fmac_f32 v239, v55, v175
    v_fmac_f32 v241, v63, v175
    v_mfma_f32_32x32x16_bf16 v[48:63], v[68:71], v[180:183], 0
    s_waitcnt vmcnt(4) lgkmcnt(1)
    v_mfma_f32_32x32x16_bf16 v[0:15], v[72:75], v[184:187], v[0:15]
    ds_read_b64_tr_b16 v[176:177], v246 offset:0
    ds_read_b64_tr_b16 v[180:181], v247 offset:0
    s_mov_b32 m0, s71
    v_mfma_f32_32x32x16_bf16 v[16:31], v[76:79], v[184:187], v[16:31]
    buffer_load_dwordx4 v226, s[4:7], s43 offen sc1 lds
    s_waitcnt lgkmcnt(2)
    v_mad_u32_u16 v222, v222, s39, v248 op_sel:[1,0,0,0]
    v_mad_u32_u16 v223, v223, s39, v248 op_sel:[1,0,0,0]
    v_mfma_f32_32x32x16_bf16 v[32:47], v[72:75], v[188:191], v[32:47]
    v_add_u32 v224, s49, v251
    ds_read2_b32 v[224:225], v224 offset0:1 offset1:3
    v_mfma_f32_32x32x16_bf16 v[48:63], v[76:79], v[188:191], v[48:63]
    s_waitcnt vmcnt(3) lgkmcnt(1)
    v_mfma_f32_32x32x8_bf16 v[0:15], v[80:81], v[176:177], v[0:15]
    ds_read_b64_tr_b16 v[184:185], v246 offset:2048
    ds_read_b64_tr_b16 v[186:187], v246 offset:3072
    ds_read_b64_tr_b16 v[188:189], v247 offset:2048
    ds_read_b64_tr_b16 v[190:191], v247 offset:3072
    s_mov_b32 m0, s68
    v_mfma_f32_32x32x8_bf16 v[16:31], v[84:85], v[176:177], v[16:31]
    buffer_load_dwordx4 v222, s[4:7], s44 offen sc1 lds
    buffer_load_dwordx4 v223, s[72:75], s44 offen offset:1024 sc1 lds
    s_waitcnt lgkmcnt(4)
    v_mad_u32_u16 v224, v224, s39, v248 op_sel:[1,0,0,0]
    v_mad_u32_u16 v225, v225, s39, v248 op_sel:[1,0,0,0]
    v_mfma_f32_32x32x8_bf16 v[32:47], v[80:81], v[180:181], v[32:47]
    v_add_u32 v226, s50, v251
    ds_read2_b32 v[226:227], v226 offset0:1 offset1:3
    v_mul_f32 v242, v0, v144
    v_fma_f32 v238, v8, v160, -v238
    v_fmac_f32 v242, v1, v145
    v_fmac_f32 v238, v9, v161
    v_fmac_f32 v242, v2, v146
    v_mfma_f32_32x32x8_bf16 v[48:63], v[84:85], v[180:181], v[48:63]
    s_setprio 0
    v_fmac_f32 v238, v10, v162
    v_fmac_f32 v242, v3, v147
    v_fmac_f32 v238, v11, v163
    v_fmac_f32 v242, v4, v148
    v_fmac_f32 v238, v12, v164
    v_fmac_f32 v242, v5, v149
    v_fmac_f32 v238, v13, v165
    v_fmac_f32 v242, v6, v150
    v_fmac_f32 v238, v14, v166
    v_fmac_f32 v242, v7, v151
    v_fmac_f32 v238, v15, v167
    v_fmac_f32 v236, v16, v112
    v_mul_f32 v244, v24, v160
    v_fmac_f32 v236, v17, v113
    v_fmac_f32 v244, v25, v161
    v_fmac_f32 v236, v18, v114
    v_fmac_f32 v244, v26, v162
    v_fmac_f32 v236, v19, v115
    v_fmac_f32 v244, v27, v163
    v_fmac_f32 v236, v20, v116
    v_fmac_f32 v244, v28, v164
    v_fmac_f32 v236, v21, v117
    v_fmac_f32 v244, v29, v165
    v_fmac_f32 v236, v22, v118
    v_fmac_f32 v244, v30, v166
    v_fmac_f32 v236, v23, v119
    v_fmac_f32 v244, v31, v167
    v_mul_f32 v243, v32, v152
    v_fma_f32 v239, v40, v168, -v239
    v_fmac_f32 v243, v33, v153
    v_fmac_f32 v239, v41, v169
    v_fmac_f32 v243, v34, v154
    v_fmac_f32 v239, v42, v170
    v_fmac_f32 v243, v35, v155
    v_fmac_f32 v239, v43, v171
    v_fmac_f32 v243, v36, v156
    v_fmac_f32 v239, v44, v172
    v_fmac_f32 v243, v37, v157
    v_fmac_f32 v239, v45, v173
    v_fmac_f32 v243, v38, v158
    v_fmac_f32 v239, v46, v174
    v_fmac_f32 v243, v39, v159
    v_fmac_f32 v239, v47, v175
    v_fmac_f32 v237, v48, v120
    v_mul_f32 v245, v56, v168
    v_fmac_f32 v237, v49, v121
    v_fmac_f32 v245, v57, v169
    v_fmac_f32 v237, v50, v122
    v_fmac_f32 v245, v58, v170
    v_fmac_f32 v237, v51, v123
    s_setprio 1
    s_waitcnt vmcnt(3) lgkmcnt(1)
    v_mfma_f32_32x32x16_bf16 v[0:15], v[64:67], v[184:187], 0
    ds_read_b64_tr_b16 v[176:177], v246 offset:4096
    ds_read_b64_tr_b16 v[178:179], v246 offset:5120
    ds_read_b64_tr_b16 v[180:181], v247 offset:4096
    ds_read_b64_tr_b16 v[182:183], v247 offset:5120
    v_fmac_f32 v245, v59, v171
    v_fmac_f32 v237, v52, v124
    s_mov_b32 m0, s69
    v_mfma_f32_32x32x16_bf16 v[16:31], v[68:71], v[184:187], 0
    buffer_load_dwordx4 v224, s[4:7], s45 offen sc1 lds
    buffer_load_dwordx4 v225, s[72:75], s45 offen offset:1024 sc1 lds
    s_waitcnt lgkmcnt(4)
    v_mad_u32_u16 v226, v226, s39, v248 op_sel:[1,0,0,0]
    v_mad_u32_u16 v227, v227, s39, v248 op_sel:[1,0,0,0]
    v_fmac_f32 v245, v60, v172
    v_fmac_f32 v237, v53, v125
    v_mfma_f32_32x32x16_bf16 v[32:47], v[64:67], v[188:191], 0
    v_add_u32 v228, s51, v251
    ds_read2_b32 v[228:229], v228 offset0:1 offset1:3
    v_fmac_f32 v245, v61, v173
    v_fmac_f32 v237, v54, v126
    v_fmac_f32 v245, v62, v174
    v_fmac_f32 v237, v55, v127
    v_fmac_f32 v245, v63, v175
    v_mfma_f32_32x32x16_bf16 v[48:63], v[68:71], v[188:191], 0
    v_permlane32_swap_b32 v242, v234
    v_permlane32_swap_b32 v243, v235
    v_add_f32 v242, v242, v234
    v_add_f32 v243, v243, v235
    s_waitcnt vmcnt(4) lgkmcnt(1)
    v_mfma_f32_32x32x16_bf16 v[0:15], v[72:75], v[176:179], v[0:15]
    ds_read_b64_tr_b16 v[184:185], v246 offset:6144
    ds_read_b64_tr_b16 v[188:189], v247 offset:6144
    v_cvt_pk_bf16_f32 v242, v242, v243
    ds_write_b32 v230, v242 offset:512
    s_mov_b32 s32, s31
    s_mov_b32 s31, s35
    s_mov_b32 m0, s70
    v_mfma_f32_32x32x16_bf16 v[16:31], v[76:79], v[176:179], v[16:31]
    buffer_load_dwordx4 v226, s[4:7], s46 offen sc1 lds
    buffer_load_dwordx4 v227, s[72:75], s46 offen offset:1024 sc1 lds
    s_waitcnt lgkmcnt(3)
    v_mad_u32_u16 v228, v228, s39, v248 op_sel:[1,0,0,0]
    v_mad_u32_u16 v229, v229, s39, v248 op_sel:[1,0,0,0]
    s_sub_u32 s26, s48, s29
    s_mov_b32 s29, s48
    v_mfma_f32_32x32x16_bf16 v[32:47], v[72:75], v[180:183], v[32:47]
    s_mov_b32 s30, s3
    s_bfe_u32 s56, s3, 0x40012
    s_cmp_lg_u32 s36, 0
    s_cselect_b32 s56, s56, 0
    v_mfma_f32_32x32x16_bf16 v[48:63], v[76:79], v[180:183], v[48:63]
    s_waitcnt vmcnt(4) lgkmcnt(1)
    v_mfma_f32_32x32x8_bf16 v[0:15], v[80:81], v[184:185], v[0:15]
    ds_read_b64_tr_b16 v[176:177], v246 offset:0
    ds_read_b64_tr_b16 v[178:179], v246 offset:1024
    ds_read_b64_tr_b16 v[180:181], v247 offset:0
    ds_read_b64_tr_b16 v[182:183], v247 offset:1024
    s_mov_b32 m0, s71
    v_mfma_f32_32x32x8_bf16 v[16:31], v[84:85], v[184:185], v[16:31]
    buffer_load_dwordx4 v228, s[4:7], s47 offen sc1 lds
    buffer_load_dwordx4 v229, s[72:75], s47 offen offset:1024 sc1 lds
    v_mfma_f32_32x32x8_bf16 v[32:47], v[80:81], v[188:189], v[32:47]
    s_nop 2
    v_mul_f32 v242, v0, v144
    v_fma_f32 v240, v8, v160, -v240
    v_fmac_f32 v242, v1, v145
    v_fmac_f32 v240, v9, v161
    v_fmac_f32 v242, v2, v146
    v_fmac_f32 v240, v10, v162
    v_fmac_f32 v242, v3, v147
    v_mfma_f32_32x32x8_bf16 v[48:63], v[84:85], v[188:189], v[48:63]
    s_setprio 0
    v_fmac_f32 v240, v11, v163
    v_fmac_f32 v242, v4, v148
    v_fmac_f32 v240, v12, v164
    v_fmac_f32 v242, v5, v149
    v_fmac_f32 v240, v13, v165
    v_fmac_f32 v242, v6, v150
    v_fmac_f32 v240, v14, v166
    v_fmac_f32 v242, v7, v151
    v_fmac_f32 v240, v15, v167
    v_add_u32 v249, s26, v249
    v_add_u32 v250, s26, v250
    v_fma_f32 v244, v16, v160, -v244
    v_fmac_f32 v236, v24, v112
    v_fmac_f32 v244, v17, v161
    v_fmac_f32 v236, v25, v113
    v_fmac_f32 v244, v18, v162
    v_fmac_f32 v236, v26, v114
    v_fmac_f32 v244, v19, v163
    v_fmac_f32 v236, v27, v115
    v_fmac_f32 v244, v20, v164
    v_fmac_f32 v236, v28, v116
    v_fmac_f32 v244, v21, v165
    v_fmac_f32 v236, v29, v117
    v_fmac_f32 v244, v22, v166
    v_fmac_f32 v236, v30, v118
    v_fmac_f32 v244, v23, v167
    v_fmac_f32 v236, v31, v119
    ds_read_b64_tr_b16 v[0:1], v249 offset:0
    ds_read_b64_tr_b16 v[2:3], v249 offset:32
    ds_read_u16_d16_hi v16, v250 offset:0
    v_mul_f32 v243, v32, v152
    v_fma_f32 v241, v40, v168, -v241
    v_fmac_f32 v243, v33, v153
    v_fmac_f32 v241, v41, v169
    v_fmac_f32 v243, v34, v154
    v_fmac_f32 v241, v42, v170
    v_fmac_f32 v243, v35, v155
    v_fmac_f32 v241, v43, v171
    v_fmac_f32 v243, v36, v156
    v_fmac_f32 v241, v44, v172
    v_fmac_f32 v243, v37, v157
    v_fmac_f32 v241, v45, v173
    v_fmac_f32 v243, v38, v158
    v_fmac_f32 v241, v46, v174
    v_fmac_f32 v243, v39, v159
    v_fmac_f32 v241, v47, v175
    ds_read_b64_tr_b16 v[4:5], v249 offset:512
    ds_read_b64_tr_b16 v[6:7], v249 offset:544
    ds_read_u16_d16_hi v17, v250 offset:128
    v_fma_f32 v245, v48, v168, -v245
    v_fmac_f32 v237, v56, v120
    v_fmac_f32 v245, v49, v169
    v_fmac_f32 v237, v57, v121
    v_fmac_f32 v245, v50, v170
    v_fmac_f32 v237, v58, v122
    v_fmac_f32 v245, v51, v171
    v_fmac_f32 v237, v59, v123
    v_fmac_f32 v245, v52, v172
    v_fmac_f32 v237, v60, v124
    v_fmac_f32 v245, v53, v173
    v_fmac_f32 v237, v61, v125
    v_fmac_f32 v245, v54, v174
    v_fmac_f32 v237, v62, v126
    v_fmac_f32 v245, v55, v175
    v_fmac_f32 v237, v63, v127
    s_cmp_eq_u32 s56, 5
    s_cbranch_scc1 K2_U21
    s_cmp_eq_u32 s56, 6
    s_cbranch_scc1 K2_U3h1
    s_branch K2_DSP1
K2_U31:
    s_setprio 1
    ds_read_b64_tr_b16 v[8:9], v249 offset:1024
    ds_read_b64_tr_b16 v[10:11], v249 offset:1056
    ds_read_u16_d16_hi v18, v250 offset:256
    s_waitcnt lgkmcnt(3)
    v_lshlrev_b32 v20, 16, v0
    v_and_b32 v21, 0xffff0000, v0
    v_lshlrev_b32 v22, 16, v1
    v_and_b32 v23, 0xffff0000, v1
    v_lshlrev_b32 v24, 16, v2
    v_and_b32 v25, 0xffff0000, v2
    v_lshlrev_b32 v26, 16, v3
    v_and_b32 v27, 0xffff0000, v3
    v_mul_f32_dpp v36, v16, v20 row_newbcast:8 row_mask:0xf bank_mask:0xf
    v_mul_f32_dpp v37, v16, v21 row_newbcast:9 row_mask:0xf bank_mask:0xf
    v_mul_f32_dpp v38, v16, v22 row_newbcast:10 row_mask:0xf bank_mask:0xf
    v_mul_f32_dpp v39, v16, v23 row_newbcast:11 row_mask:0xf bank_mask:0xf
    v_mul_f32_dpp v40, v16, v24 row_newbcast:12 row_mask:0xf bank_mask:0xf
    v_mul_f32_dpp v41, v16, v25 row_newbcast:13 row_mask:0xf bank_mask:0xf
    v_mul_f32_dpp v42, v16, v26 row_newbcast:14 row_mask:0xf bank_mask:0xf
    v_mul_f32_dpp v43, v16, v27 row_newbcast:15 row_mask:0xf bank_mask:0xf
    v_cvt_pk_bf16_f32 v68, v36, v37
    v_cvt_pk_bf16_f32 v69, v38, v39
    v_cvt_pk_bf16_f32 v70, v40, v41
    v_cvt_pk_bf16_f32 v71, v42, v43
    v_mul_f32_dpp v20, v16, v20 row_newbcast:0 row_mask:0xa bank_mask:0xf
    v_mul_f32_dpp v21, v16, v21 row_newbcast:1 row_mask:0xa bank_mask:0xf
    v_mul_f32_dpp v22, v16, v22 row_newbcast:2 row_mask:0xa bank_mask:0xf
    v_mul_f32_dpp v23, v16, v23 row_newbcast:3 row_mask:0xa bank_mask:0xf
    v_mul_f32_dpp v24, v16, v24 row_newbcast:4 row_mask:0xa bank_mask:0xf
    v_mul_f32_dpp v25, v16, v25 row_newbcast:5 row_mask:0xa bank_mask:0xf
    v_mul_f32_dpp v26, v16, v26 row_newbcast:6 row_mask:0xa bank_mask:0xf
    v_mul_f32_dpp v27, v16, v27 row_newbcast:7 row_mask:0xa bank_mask:0xf
    v_cvt_pk_bf16_f32 v64, v20, v21
    v_cvt_pk_bf16_f32 v65, v22, v23
    v_cvt_pk_bf16_f32 v66, v24, v25
    v_cvt_pk_bf16_f32 v67, v26, v27
    v_lshlrev_b32 v28, 16, v4
    v_and_b32 v29, 0xffff0000, v4
    v_lshlrev_b32 v30, 16, v5
    v_and_b32 v31, 0xffff0000, v5
    v_lshlrev_b32 v32, 16, v6
    v_and_b32 v33, 0xffff0000, v6
    v_lshlrev_b32 v34, 16, v7
    v_and_b32 v35, 0xffff0000, v7
    v_mul_f32_dpp v36, v17, v28 row_newbcast:8 row_mask:0xf bank_mask:0xf
    v_mul_f32_dpp v37, v17, v29 row_newbcast:9 row_mask:0xf bank_mask:0xf
    v_mul_f32_dpp v38, v17, v30 row_newbcast:10 row_mask:0xf bank_mask:0xf
    v_mul_f32_dpp v39, v17, v31 row_newbcast:11 row_mask:0xf bank_mask:0xf
    v_mul_f32_dpp v40, v17, v32 row_newbcast:12 row_mask:0xf bank_mask:0xf
    v_mul_f32_dpp v41, v17, v33 row_newbcast:13 row_mask:0xf bank_mask:0xf
    v_mul_f32_dpp v42, v17, v34 row_newbcast:14 row_mask:0xf bank_mask:0xf
    v_mul_f32_dpp v43, v17, v35 row_newbcast:15 row_mask:0xf bank_mask:0xf
    v_cvt_pk_bf16_f32 v76, v36, v37
    v_cvt_pk_bf16_f32 v77, v38, v39
    v_cvt_pk_bf16_f32 v78, v40, v41
    v_cvt_pk_bf16_f32 v79, v42, v43
    v_mul_f32_dpp v28, v17, v28 row_newbcast:0 row_mask:0xa bank_mask:0xf
    v_mul_f32_dpp v29, v17, v29 row_newbcast:1 row_mask:0xa bank_mask:0xf
    v_mul_f32_dpp v30, v17, v30 row_newbcast:2 row_mask:0xa bank_mask:0xf
    v_mul_f32_dpp v31, v17, v31 row_newbcast:3 row_mask:0xa bank_mask:0xf
    v_mul_f32_dpp v32, v17, v32 row_newbcast:4 row_mask:0xa bank_mask:0xf
    v_mul_f32_dpp v33, v17, v33 row_newbcast:5 row_mask:0xa bank_mask:0xf
    v_mul_f32_dpp v34, v17, v34 row_newbcast:6 row_mask:0xa bank_mask:0xf
    v_mul_f32_dpp v35, v17, v35 row_newbcast:7 row_mask:0xa bank_mask:0xf
    v_cvt_pk_bf16_f32 v72, v28, v29
    v_cvt_pk_bf16_f32 v73, v30, v31
    v_cvt_pk_bf16_f32 v74, v32, v33
    v_cvt_pk_bf16_f32 v75, v34, v35
    s_waitcnt lgkmcnt(0)
    v_lshlrev_b32 v20, 16, v8
    v_and_b32 v21, 0xffff0000, v8
    v_lshlrev_b32 v22, 16, v9
    v_and_b32 v23, 0xffff0000, v9
    v_lshlrev_b32 v24, 16, v10
    v_and_b32 v25, 0xffff0000, v10
    v_lshlrev_b32 v26, 16, v11
    v_and_b32 v27, 0xffff0000, v11
    v_mul_f32_dpp v36, v18, v20 row_newbcast:8 row_mask:0xf bank_mask:0xf
    v_mul_f32_dpp v37, v18, v21 row_newbcast:9 row_mask:0xf bank_mask:0xf
    v_mul_f32_dpp v38, v18, v22 row_newbcast:10 row_mask:0xf bank_mask:0xf
    v_mul_f32_dpp v39, v18, v23 row_newbcast:11 row_mask:0xf bank_mask:0xf
    v_mul_f32_dpp v40, v18, v24 row_newbcast:12 row_mask:0xf bank_mask:0xf
    v_mul_f32_dpp v41, v18, v25 row_newbcast:13 row_mask:0xf bank_mask:0xf
    v_mul_f32_dpp v42, v18, v26 row_newbcast:14 row_mask:0xf bank_mask:0xf
    v_mul_f32_dpp v43, v18, v27 row_newbcast:15 row_mask:0xf bank_mask:0xf
    v_cvt_pk_bf16_f32 v84, v36, v37
    v_cvt_pk_bf16_f32 v85, v38, v39
    v_cvt_pk_bf16_f32 v86, v40, v41
    v_cvt_pk_bf16_f32 v87, v42, v43
    v_mul_f32_dpp v20, v18, v20 row_newbcast:0 row_mask:0xa bank_mask:0xf
    v_mul_f32_dpp v21, v18, v21 row_newbcast:1 row_mask:0xa bank_mask:0xf
    v_mul_f32_dpp v22, v18, v22 row_newbcast:2 row_mask:0xa bank_mask:0xf
    v_mul_f32_dpp v23, v18, v23 row_newbcast:3 row_mask:0xa bank_mask:0xf
    v_mul_f32_dpp v24, v18, v24 row_newbcast:4 row_mask:0xa bank_mask:0xf
    v_mul_f32_dpp v25, v18, v25 row_newbcast:5 row_mask:0xa bank_mask:0xf
    v_mul_f32_dpp v26, v18, v26 row_newbcast:6 row_mask:0xa bank_mask:0xf
    v_mul_f32_dpp v27, v18, v27 row_newbcast:7 row_mask:0xa bank_mask:0xf
    v_cvt_pk_bf16_f32 v80, v20, v21
    v_cvt_pk_bf16_f32 v81, v22, v23
    v_cvt_pk_bf16_f32 v82, v24, v25
    v_cvt_pk_bf16_f32 v83, v26, v27
    s_waitcnt vmcnt(4)
    v_mfma_f32_32x32x16_bf16 v[0:15], v[64:67], v[176:179], 0
    ds_read_b64_tr_b16 v[184:185], v246 offset:2048
    ds_read_b64_tr_b16 v[186:187], v246 offset:3072
    ds_read_b64_tr_b16 v[188:189], v247 offset:2048
    ds_read_b64_tr_b16 v[190:191], v247 offset:3072
    s_mov_b32 m0, s68
    v_mfma_f32_32x32x16_bf16 v[16:31], v[68:71], v[176:179], 0
    buffer_load_dwordx4 v224, s[4:7], s41 offen sc1 lds
    buffer_load_dwordx4 v225, s[72:75], s41 offen offset:1024 sc1 lds
    v_permlane32_swap_b32 v242, v236
    v_permlane32_swap_b32 v243, v237
    v_mov_b32 v254, 163296
    v_mfma_f32_32x32x16_bf16 v[32:47], v[64:67], v[180:183], 0
    v_permlane32_swap_b32 v244, v238
    v_permlane32_swap_b32 v245, v239
    v_permlane32_swap_b32 v240, v241
    v_add_f32 v242, v242, v236
    v_mfma_f32_32x32x16_bf16 v[48:63], v[68:71], v[180:183], 0
    v_add_f32 v243, v243, v237
    v_add_f32 v244, v244, v238
    v_add_f32 v245, v245, v239
    v_add_f32 v240, -v240, -v241
    v_sub_u32 v241, v230, v231
    v_cvt_pk_bf16_f32 v242, v242, v243
    v_mov_b32 v255, 1
    v_lshl_add_u32 v233, v252, 1, s53
    s_mov_b64 exec, 1
    ds_add_rtn_u32 v232, v254, v255
    s_mov_b64 exec, -1
    ds_read_b32 v233, v233
    s_waitcnt vmcnt(4) lgkmcnt(2)
    v_mfma_f32_32x32x16_bf16 v[0:15], v[72:75], v[184:187], v[0:15]
    ds_read_b64_tr_b16 v[176:177], v246 offset:4096
    ds_read_b64_tr_b16 v[178:179], v246 offset:5120
    ds_read_b64_tr_b16 v[180:181], v247 offset:4096
    ds_read_b64_tr_b16 v[182:183], v247 offset:5120
    v_cvt_pk_bf16_f32 v244, v244, v245
    v_cvt_pk_bf16_f32 v240, v240, v240
    s_mov_b32 m0, s69
    v_mfma_f32_32x32x16_bf16 v[16:31], v[76:79], v[184:187], v[16:31]
    buffer_load_dwordx4 v226, s[4:7], s41 offen sc1 lds
    buffer_load_dwordx4 v227, s[72:75], s41 offen offset:1024 sc1 lds
    ds_write_b32 v230, v242 offset:768
    ds_write_b32 v230, v244 offset:1024
    ds_write_b16 v241, v240 offset:1280
    s_waitcnt lgkmcnt(7)
    v_readfirstlane_b32 s58, v232
    v_mfma_f32_32x32x16_bf16 v[32:47], v[72:75], v[188:191], v[32:47]
    s_cmp_lt_u32 s58, s22
    s_cbranch_scc0 K2_nul_61
    s_and_b32 s59, s58, 7
    s_lshr_b32 s60, s58, 3
K2_chk_63:
    v_readlane_b32 s61, v233, s59
    s_nop 0
    s_cmp_gt_u32 s61, s60
    s_cbranch_scc0 K2_spin_62
K2_back_64:
    v_mfma_f32_32x32x16_bf16 v[48:63], v[76:79], v[188:191], v[48:63]
    v_readlane_b32 s3, v253, s58
    s_lshl_b32 s44, s34, 7
    s_and_b32 s48, s3, 0x3ffff
    s_bfe_u32 s33, s3, 0x30013
    s_mov_b32 s35, s48
    s_mov_b32 s45, s44
    s_waitcnt vmcnt(4) lgkmcnt(3)
    v_mfma_f32_32x32x16_bf16 v[0:15], v[80:83], v[176:179], v[0:15]
    ds_read_b64_tr_b16 v[184:185], v246 offset:6144
    ds_read_b64_tr_b16 v[186:187], v246 offset:7168
    ds_read_b64_tr_b16 v[188:189], v247 offset:6144
    ds_read_b64_tr_b16 v[190:191], v247 offset:7168
    s_xor_b32 s47, s44, 256
    s_add_u32 s49, s48, 128
    s_mov_b32 m0, s70
    v_mfma_f32_32x32x16_bf16 v[16:31], v[84:87], v[176:179], v[16:31]
    buffer_load_dwordx4 v222, s[4:7], s42 offen sc1 lds
    buffer_load_dwordx4 v223, s[72:75], s42 offen offset:1024 sc1 lds
    s_add_u32 s60, s48, 256
    s_cmp_eq_u32 s33, 3
    s_cselect_b32 s46, s44, s47
    s_cselect_b32 s50, s60, s48
    s_cselect_b32 s51, s48, s49
    v_mfma_f32_32x32x16_bf16 v[32:47], v[80:83], v[180:183], v[32:47]
    s_sub_u32 s60, s33, 2
    s_cmp_lt_u32 s60, 2
    s_cbranch_scc0 K2_rare_65
K2_back_66:
    v_mul_f32 v234, v0, v96
    v_mul_f32 v236, v8, v128
    v_fmac_f32 v234, v1, v97
    v_fmac_f32 v236, v9, v129
    v_mfma_f32_32x32x16_bf16 v[48:63], v[84:87], v[180:183], v[48:63]
    s_setprio 0
    v_fmac_f32 v234, v2, v98
    v_fmac_f32 v236, v10, v130
    v_fmac_f32 v234, v3, v99
    v_fmac_f32 v236, v11, v131
    v_fmac_f32 v234, v4, v100
    v_fmac_f32 v236, v12, v132
    v_fmac_f32 v234, v5, v101
    v_fmac_f32 v236, v13, v133
    v_fmac_f32 v234, v6, v102
    v_fmac_f32 v236, v14, v134
    v_fmac_f32 v234, v7, v103
    v_fmac_f32 v236, v15, v135
    v_mul_f32 v238, v16, v128
    v_mul_f32 v240, v24, v128
    v_fmac_f32 v238, v17, v129
    v_fmac_f32 v240, v25, v129
    v_fmac_f32 v238, v18, v130
    v_fmac_f32 v240, v26, v130
    v_fmac_f32 v238, v19, v131
    v_fmac_f32 v240, v27, v131
    v_fmac_f32 v238, v20, v132
    v_fmac_f32 v240, v28, v132
    v_fmac_f32 v238, v21, v133
    v_fmac_f32 v240, v29, v133
    v_fmac_f32 v238, v22, v134
    v_fmac_f32 v240, v30, v134
    v_fmac_f32 v238, v23, v135
    v_fmac_f32 v240, v31, v135
    v_mul_f32 v235, v32, v104
    v_mul_f32 v237, v40, v136
    v_fmac_f32 v235, v33, v105
    v_fmac_f32 v237, v41, v137
    v_fmac_f32 v235, v34, v106
    v_fmac_f32 v237, v42, v138
    v_fmac_f32 v235, v35, v107
    v_fmac_f32 v237, v43, v139
    v_fmac_f32 v235, v36, v108
    v_fmac_f32 v237, v44, v140
    v_fmac_f32 v235, v37, v109
    v_fmac_f32 v237, v45, v141
    v_fmac_f32 v235, v38, v110
    v_fmac_f32 v237, v46, v142
    v_fmac_f32 v235, v39, v111
    v_fmac_f32 v237, v47, v143
    v_mul_f32 v239, v48, v136
    v_mul_f32 v241, v56, v136
    s_setprio 1
    s_waitcnt vmcnt(4) lgkmcnt(0)
    v_mfma_f32_32x32x16_bf16 v[0:15], v[64:67], v[184:187], 0
    ds_read_b64_tr_b16 v[176:177], v246 offset:0
    ds_read_b64_tr_b16 v[178:179], v246 offset:1024
    ds_read_b64_tr_b16 v[180:181], v247 offset:0
    ds_read_b64_tr_b16 v[182:183], v247 offset:1024
    v_fmac_f32 v239, v49, v137
    v_fmac_f32 v241, v57, v137
    s_mov_b32 m0, s71
    v_mfma_f32_32x32x16_bf16 v[16:31], v[68:71], v[184:187], 0
    buffer_load_dwordx4 v224, s[4:7], s42 offen sc1 lds
    buffer_load_dwordx4 v225, s[72:75], s42 offen offset:1024 sc1 lds
    v_fmac_f32 v239, v50, v138
    v_fmac_f32 v241, v58, v138
    v_fmac_f32 v239, v51, v139
    v_fmac_f32 v241, v59, v139
    v_fmac_f32 v239, v52, v140
    v_mfma_f32_32x32x16_bf16 v[32:47], v[64:67], v[188:191], 0
    v_fmac_f32 v241, v60, v140
    v_fmac_f32 v239, v53, v141
    v_fmac_f32 v241, v61, v141
    v_fmac_f32 v239, v54, v142
    v_fmac_f32 v241, v62, v142
    v_fmac_f32 v239, v55, v143
    v_fmac_f32 v241, v63, v143
    v_mfma_f32_32x32x16_bf16 v[48:63], v[68:71], v[188:191], 0
    v_permlane32_swap_b32 v234, v236
    v_permlane32_swap_b32 v235, v237
    v_permlane32_swap_b32 v240, v238
    s_waitcnt vmcnt(4) lgkmcnt(0)
    v_mfma_f32_32x32x16_bf16 v[0:15], v[72:75], v[176:179], v[0:15]
    ds_read_b64_tr_b16 v[184:185], v246 offset:2048
    ds_read_b64_tr_b16 v[186:187], v246 offset:3072
    ds_read_b64_tr_b16 v[188:189], v247 offset:2048
    ds_read_b64_tr_b16 v[190:191], v247 offset:3072
    v_permlane32_swap_b32 v241, v239
    s_mov_b32 m0, s68
    v_mfma_f32_32x32x16_bf16 v[16:31], v[76:79], v[176:179], v[16:31]
    buffer_load_dwordx4 v226, s[4:7], s42 offen sc1 lds
    buffer_load_dwordx4 v227, s[72:75], s42 offen offset:1024 sc1 lds
    v_lshl_add_u32 v230, v252, 1, s31
    v_add_f32 v234, v234, v236
    v_add_f32 v235, v235, v237
    v_add_f32 v240, v240, v238
    v_add_f32 v241, v241, v239
    v_mfma_f32_32x32x16_bf16 v[32:47], v[72:75], v[180:183], v[32:47]
    v_cvt_pk_bf16_f32 v234, v234, v235
    v_cvt_pk_bf16_f32 v240, v240, v241
    ds_write_b32 v230, v234 offset:0
    ds_write_b32 v230, v240 offset:256
    v_mfma_f32_32x32x16_bf16 v[48:63], v[76:79], v[180:183], v[48:63]
    s_waitcnt vmcnt(4) lgkmcnt(2)
    v_mfma_f32_32x32x16_bf16 v[0:15], v[80:83], v[184:187], v[0:15]
    ds_read_b64_tr_b16 v[176:177], v246 offset:4096
    ds_read_b64_tr_b16 v[178:179], v246 offset:5120
    ds_read_b64_tr_b16 v[180:181], v247 offset:4096
    ds_read_b64_tr_b16 v[182:183], v247 offset:5120
    s_mov_b32 m0, s69
    v_mfma_f32_32x32x16_bf16 v[16:31], v[84:87], v[184:187], v[16:31]
    buffer_load_dwordx4 v222, s[4:7], s43 offen sc1 lds
    buffer_load_dwordx4 v223, s[72:75], s43 offen offset:1024 sc1 lds
    v_mfma_f32_32x32x16_bf16 v[32:47], v[80:83], v[188:191], v[32:47]
    s_nop 2
    v_mul_f32 v234, v0, v144
    v_mul_f32 v236, v8, v112
    v_fmac_f32 v234, v1, v145
    v_fmac_f32 v236, v9, v113
    v_fmac_f32 v234, v2, v146
    v_fmac_f32 v236, v10, v114
    v_fmac_f32 v234, v3, v147
    v_mfma_f32_32x32x16_bf16 v[48:63], v[84:87], v[188:191], v[48:63]
    s_setprio 0
    v_fmac_f32 v236, v11, v115
    v_fmac_f32 v234, v4, v148
    v_fmac_f32 v236, v12, v116
    v_fmac_f32 v234, v5, v149
    v_fmac_f32 v236, v13, v117
    v_fmac_f32 v234, v6, v150
    v_fmac_f32 v236, v14, v118
    v_fmac_f32 v234, v7, v151
    v_fmac_f32 v236, v15, v119
    v_mul_f32 v238, v16, v160
    v_mul_f32 v240, v24, v160
    v_fmac_f32 v238, v17, v161
    v_fmac_f32 v240, v25, v161
    v_fmac_f32 v238, v18, v162
    v_fmac_f32 v240, v26, v162
    v_fmac_f32 v238, v19, v163
    v_fmac_f32 v240, v27, v163
    v_fmac_f32 v238, v20, v164
    v_fmac_f32 v240, v28, v164
    v_fmac_f32 v238, v21, v165
    v_fmac_f32 v240, v29, v165
    v_fmac_f32 v238, v22, v166
    v_fmac_f32 v240, v30, v166
    v_fmac_f32 v238, v23, v167
    v_fmac_f32 v240, v31, v167
    v_mul_f32 v235, v32, v152
    v_mul_f32 v237, v40, v120
    v_fmac_f32 v235, v33, v153
    v_fmac_f32 v237, v41, v121
    v_fmac_f32 v235, v34, v154
    v_fmac_f32 v237, v42, v122
    v_fmac_f32 v235, v35, v155
    v_fmac_f32 v237, v43, v123
    v_fmac_f32 v235, v36, v156
    v_fmac_f32 v237, v44, v124
    v_fmac_f32 v235, v37, v157
    v_fmac_f32 v237, v45, v125
    v_fmac_f32 v235, v38, v158
    v_fmac_f32 v237, v46, v126
    v_fmac_f32 v235, v39, v159
    v_fmac_f32 v237, v47, v127
    v_mul_f32 v239, v48, v168
    v_mul_f32 v241, v56, v168
    v_fmac_f32 v239, v49, v169
    v_fmac_f32 v241, v57, v169
    s_setprio 1
    s_waitcnt vmcnt(4) lgkmcnt(0)
    v_mfma_f32_32x32x16_bf16 v[0:15], v[64:67], v[176:179], 0
    ds_read_b64_tr_b16 v[184:185], v246 offset:6144
    ds_read_b64_tr_b16 v[186:187], v246 offset:7168
    ds_read_b64_tr_b16 v[188:189], v247 offset:6144
    ds_read_b64_tr_b16 v[190:191], v247 offset:7168
    v_fmac_f32 v239, v50, v170
    v_fmac_f32 v241, v58, v170
    s_mov_b32 m0, s70
    v_mfma_f32_32x32x16_bf16 v[16:31], v[68:71], v[176:179], 0
    buffer_load_dwordx4 v224, s[4:7], s43 offen sc1 lds
    buffer_load_dwordx4 v225, s[72:75], s43 offen offset:1024 sc1 lds
    v_fmac_f32 v239, v51, v171
    v_fmac_f32 v241, v59, v171
    v_fmac_f32 v239, v52, v172
    v_fmac_f32 v241, v60, v172
    v_fmac_f32 v239, v53, v173
    v_mfma_f32_32x32x16_bf16 v[32:47], v[64:67], v[180:183], 0
    v_add_u32 v222, s48, v251
    ds_read2_b32 v[222:223], v222 offset0:1 offset1:3
    v_fmac_f32 v241, v61, v173
    v_fmac_f32 v239, v54, v174
    v_fmac_f32 v241, v62, v174
    v_fmac_f32 v239, v55, v175
    v_fmac_f32 v241, v63, v175
    v_mfma_f32_32x32x16_bf16 v[48:63], v[68:71], v[180:183], 0
    s_waitcnt vmcnt(4) lgkmcnt(1)
    v_mfma_f32_32x32x16_bf16 v[0:15], v[72:75], v[184:187], v[0:15]
    ds_read_b64_tr_b16 v[176:177], v246 offset:0
    ds_read_b64_tr_b16 v[178:179], v246 offset:1024
    ds_read_b64_tr_b16 v[180:181], v247 offset:0
    ds_read_b64_tr_b16 v[182:183], v247 offset:1024
    s_mov_b32 m0, s71
    v_mfma_f32_32x32x16_bf16 v[16:31], v[76:79], v[184:187], v[16:31]
    buffer_load_dwordx4 v226, s[4:7], s43 offen sc1 lds
    buffer_load_dwordx4 v227, s[72:75], s43 offen offset:1024 sc1 lds
    s_waitcnt lgkmcnt(4)
    v_mad_u32_u16 v222, v222, s39, v248 op_sel:[1,0,0,0]
    v_mad_u32_u16 v223, v223, s39, v248 op_sel:[1,0,0,0]
    v_mfma_f32_32x32x16_bf16 v[32:47], v[72:75], v[188:191], v[32:47]
    v_add_u32 v224, s49, v251
    ds_read2_b32 v[224:225], v224 offset0:1 offset1:3
    v_mfma_f32_32x32x16_bf16 v[48:63], v[76:79], v[188:191], v[48:63]
    s_waitcnt vmcnt(4) lgkmcnt(1)
    v_mfma_f32_32x32x16_bf16 v[0:15], v[80:83], v[176:179], v[0:15]
    ds_read_b64_tr_b16 v[184:185], v246 offset:2048
    ds_read_b64_tr_b16 v[186:187], v246 offset:3072
    ds_read_b64_tr_b16 v[188:189], v247 offset:2048
    ds_read_b64_tr_b16 v[190:191], v247 offset:3072
    s_mov_b32 m0, s68
    v_mfma_f32_32x32x16_bf16 v[16:31], v[84:87], v[176:179], v[16:31]
    buffer_load_dwordx4 v222, s[4:7], s44 offen sc1 lds
    buffer_load_dwordx4 v223, s[72:75], s44 offen offset:1024 sc1 lds
    s_waitcnt lgkmcnt(4)
    v_mad_u32_u16 v224, v224, s39, v248 op_sel:[1,0,0,0]
    v_mad_u32_u16 v225, v225, s39, v248 op_sel:[1,0,0,0]
    v_mfma_f32_32x32x16_bf16 v[32:47], v[80:83], v[180:183], v[32:47]
    v_add_u32 v226, s50, v251
    ds_read2_b32 v[226:227], v226 offset0:1 offset1:3
    v_mul_f32 v242, v0, v144
    v_fma_f32 v238, v8, v160, -v238
    v_fmac_f32 v242, v1, v145
    v_fmac_f32 v238, v9, v161
    v_fmac_f32 v242, v2, v146
    v_mfma_f32_32x32x16_bf16 v[48:63], v[84:87], v[180:183], v[48:63]
    s_setprio 0
    v_fmac_f32 v238, v10, v162
    v_fmac_f32 v242, v3, v147
    v_fmac_f32 v238, v11, v163
    v_fmac_f32 v242, v4, v148
    v_fmac_f32 v238, v12, v164
    v_fmac_f32 v242, v5, v149
    v_fmac_f32 v238, v13, v165
    v_fmac_f32 v242, v6, v150
    v_fmac_f32 v238, v14, v166
    v_fmac_f32 v242, v7, v151
    v_fmac_f32 v238, v15, v167
    v_fmac_f32 v236, v16, v112
    v_mul_f32 v244, v24, v160
    v_fmac_f32 v236, v17, v113
    v_fmac_f32 v244, v25, v161
    v_fmac_f32 v236, v18, v114
    v_fmac_f32 v244, v26, v162
    v_fmac_f32 v236, v19, v115
    v_fmac_f32 v244, v27, v163
    v_fmac_f32 v236, v20, v116
    v_fmac_f32 v244, v28, v164
    v_fmac_f32 v236, v21, v117
    v_fmac_f32 v244, v29, v165
    v_fmac_f32 v236, v22, v118
    v_fmac_f32 v244, v30, v166
    v_fmac_f32 v236, v23, v119
    v_fmac_f32 v244, v31, v167
    v_mul_f32 v243, v32, v152
    v_fma_f32 v239, v40, v168, -v239
    v_fmac_f32 v243, v33, v153
    v_fmac_f32 v239, v41, v169
    v_fmac_f32 v243, v34, v154
    v_fmac_f32 v239, v42, v170
    v_fmac_f32 v243, v35, v155
    v_fmac_f32 v239, v43, v171
    v_fmac_f32 v243, v36, v156
    v_fmac_f32 v239, v44, v172
    v_fmac_f32 v243, v37, v157
    v_fmac_f32 v239, v45, v173
    v_fmac_f32 v243, v38, v158
    v_fmac_f32 v239, v46, v174
    v_fmac_f32 v243, v39, v159
    v_fmac_f32 v239, v47, v175
    v_fmac_f32 v237, v48, v120
    v_mul_f32 v245, v56, v168
    v_fmac_f32 v237, v49, v121
    v_fmac_f32 v245, v57, v169
    v_fmac_f32 v237, v50, v122
    v_fmac_f32 v245, v58, v170
    v_fmac_f32 v237, v51, v123
    s_setprio 1
    s_waitcnt vmcnt(4) lgkmcnt(1)
    v_mfma_f32_32x32x16_bf16 v[0:15], v[64:67], v[184:187], 0
    ds_read_b64_tr_b16 v[176:177], v246 offset:4096
    ds_read_b64_tr_b16 v[178:179], v246 offset:5120
    ds_read_b64_tr_b16 v[180:181], v247 offset:4096
    ds_read_b64_tr_b16 v[182:183], v247 offset:5120
    v_fmac_f32 v245, v59, v171
    v_fmac_f32 v237, v52, v124
    s_mov_b32 m0, s69
    v_mfma_f32_32x32x16_bf16 v[16:31], v[68:71], v[184:187], 0
    buffer_load_dwordx4 v224, s[4:7], s45 offen sc1 lds
    buffer_load_dwordx4 v225, s[72:75], s45 offen offset:1024 sc1 lds
    s_waitcnt lgkmcnt(4)
    v_mad_u32_u16 v226, v226, s39, v248 op_sel:[1,0,0,0]
    v_mad_u32_u16 v227, v227, s39, v248 op_sel:[1,0,0,0]
    v_fmac_f32 v245, v60, v172
    v_fmac_f32 v237, v53, v125
    v_mfma_f32_32x32x16_bf16 v[32:47], v[64:67], v[188:191], 0
    v_add_u32 v228, s51, v251
    ds_read2_b32 v[228:229], v228 offset0:1 offset1:3
    v_fmac_f32 v245, v61, v173
    v_fmac_f32 v237, v54, v126
    v_fmac_f32 v245, v62, v174
    v_fmac_f32 v237, v55, v127
    v_fmac_f32 v245, v63, v175
    v_mfma_f32_32x32x16_bf16 v[48:63], v[68:71], v[188:191], 0
    v_permlane32_swap_b32 v242, v234
    v_permlane32_swap_b32 v243, v235
    v_add_f32 v242, v242, v234
    v_add_f32 v243, v243, v235
    s_waitcnt vmcnt(4) lgkmcnt(1)
    v_mfma_f32_32x32x16_bf16 v[0:15], v[72:75], v[176:179], v[0:15]
    ds_read_b64_tr_b16 v[184:185], v246 offset:6144
    ds_read_b64_tr_b16 v[186:187], v246 offset:7168
    ds_read_b64_tr_b16 v[188:189], v247 offset:6144
    ds_read_b64_tr_b16 v[190:191], v247 offset:7168
    v_cvt_pk_bf16_f32 v242, v242, v243
    ds_write_b32 v230, v242 offset:512
    s_mov_b32 m0, s70
    v_mfma_f32_32x32x16_bf16 v[16:31], v[76:79], v[176:179], v[16:31]
    buffer_load_dwordx4 v226, s[4:7], s46 offen sc1 lds
    buffer_load_dwordx4 v227, s[72:75], s46 offen offset:1024 sc1 lds
    s_waitcnt lgkmcnt(5)
    v_mad_u32_u16 v228, v228, s39, v248 op_sel:[1,0,0,0]
    v_mad_u32_u16 v229, v229, s39, v248 op_sel:[1,0,0,0]
    s_sub_u32 s26, s48, s29
    s_mov_b32 s29, s48
    v_mfma_f32_32x32x16_bf16 v[32:47], v[72:75], v[180:183], v[32:47]
    s_mov_b32 s30, s3
    s_bfe_u32 s56, s3, 0x40012
    s_cmp_lg_u32 s36, 0
    s_cselect_b32 s56, s56, 0
    s_mov_b32 s32, s31
    s_mov_b32 s31, s35
    v_mfma_f32_32x32x16_bf16 v[48:63], v[76:79], v[180:183], v[48:63]
    s_waitcnt vmcnt(4) lgkmcnt(1)
    v_mfma_f32_32x32x16_bf16 v[0:15], v[80:83], v[184:187], v[0:15]
    ds_read_b64_tr_b16 v[176:177], v246 offset:0
    ds_read_b64_tr_b16 v[178:179], v246 offset:1024
    ds_read_b64_tr_b16 v[180:181], v247 offset:0
    ds_read_b64_tr_b16 v[182:183], v247 offset:1024
    s_mov_b32 m0, s71
    v_mfma_f32_32x32x16_bf16 v[16:31], v[84:87], v[184:187], v[16:31]
    buffer_load_dwordx4 v228, s[4:7], s47 offen sc1 lds
    buffer_load_dwordx4 v229, s[72:75], s47 offen offset:1024 sc1 lds
    v_mfma_f32_32x32x16_bf16 v[32:47], v[80:83], v[188:191], v[32:47]
    s_nop 2
    v_mul_f32 v242, v0, v144
    v_fma_f32 v240, v8, v160, -v240
    v_fmac_f32 v242, v1, v145
    v_fmac_f32 v240, v9, v161
    v_fmac_f32 v242, v2, v146
    v_fmac_f32 v240, v10, v162
    v_fmac_f32 v242, v3, v147
    v_mfma_f32_32x32x16_bf16 v[48:63], v[84:87], v[188:191], v[48:63]
    s_setprio 0
    v_fmac_f32 v240, v11, v163
    v_fmac_f32 v242, v4, v148
    v_fmac_f32 v240, v12, v164
    v_fmac_f32 v242, v5, v149
    v_fmac_f32 v240, v13, v165
    v_fmac_f32 v242, v6, v150
    v_fmac_f32 v240, v14, v166
    v_fmac_f32 v242, v7, v151
    v_fmac_f32 v240, v15, v167
    v_add_u32 v249, s26, v249
    v_add_u32 v250, s26, v250
    v_fma_f32 v244, v16, v160, -v244
    v_fmac_f32 v236, v24, v112
    v_fmac_f32 v244, v17, v161
    v_fmac_f32 v236, v25, v113
    v_fmac_f32 v244, v18, v162
    v_fmac_f32 v236, v26, v114
    v_fmac_f32 v244, v19, v163
    v_fmac_f32 v236, v27, v115
    v_fmac_f32 v244, v20, v164
    v_fmac_f32 v236, v28, v116
    v_fmac_f32 v244, v21, v165
    v_fmac_f32 v236, v29, v117
    v_fmac_f32 v244, v22, v166
    v_fmac_f32 v236, v30, v118
    v_fmac_f32 v244, v23, v167
    v_fmac_f32 v236, v31, v119
    ds_read_b64_tr_b16 v[0:1], v249 offset:0
    ds_read_b64_tr_b16 v[2:3], v249 offset:32
    ds_read_u16_d16_hi v16, v250 offset:0
    v_mul_f32 v243, v32, v152
    v_fma_f32 v241, v40, v168, -v241
    v_fmac_f32 v243, v33, v153
    v_fmac_f32 v241, v41, v169
    v_fmac_f32 v243, v34, v154
    v_fmac_f32 v241, v42, v170
    v_fmac_f32 v243, v35, v155
    v_fmac_f32 v241, v43, v171
    v_fmac_f32 v243, v36, v156
    v_fmac_f32 v241, v44, v172
    v_fmac_f32 v243, v37, v157
    v_fmac_f32 v241, v45, v173
    v_fmac_f32 v243, v38, v158
    v_fmac_f32 v241, v46, v174
    v_fmac_f32 v243, v39, v159
    v_fmac_f32 v241, v47, v175
    ds_read_b64_tr_b16 v[4:5], v249 offset:512
    ds_read_b64_tr_b16 v[6:7], v249 offset:544
    ds_read_u16_d16_hi v17, v250 offset:128
    v_fma_f32 v245, v48, v168, -v245
    v_fmac_f32 v237, v56, v120
    v_fmac_f32 v245, v49, v169
    v_fmac_f32 v237, v57, v121
    v_fmac_f32 v245, v50, v170
    v_fmac_f32 v237, v58, v122
    v_fmac_f32 v245, v51, v171
    v_fmac_f32 v237, v59, v123
    v_fmac_f32 v245, v52, v172
    v_fmac_f32 v237, v60, v124
    v_fmac_f32 v245, v53, v173
    v_fmac_f32 v237, v61, v125
    v_fmac_f32 v245, v54, v174
    v_fmac_f32 v237, v62, v126
    v_fmac_f32 v245, v55, v175
    v_fmac_f32 v237, v63, v127
    s_cmp_eq_u32 s56, 5
    s_cbranch_scc1 K2_U21
    s_cmp_eq_u32 s56, 6
    s_cbranch_scc1 K2_U3h1
    s_branch K2_DSP1
K2_PAD_SW:
    s_branch K2_HOP
K2_DSP0:
    s_cmp_eq_u32 s56, 4
    s_cbranch_scc1 K2_U20
    s_cmp_eq_u32 s56, 7
    s_cbranch_scc1 K2_U30
    s_cmp_gt_u32 s56, 7
    s_cbranch_scc1 K2_U40
    s_cmp_lg_u32 s56, 0
    s_cbranch_scc1 K2_U10
    s_branch K2_SWITCH
K2_DSP1:
    s_cmp_eq_u32 s56, 4
    s_cbranch_scc1 K2_U21
    s_cmp_eq_u32 s56, 7
    s_cbranch_scc1 K2_U31
    s_cmp_gt_u32 s56, 7
    s_cbranch_scc1 K2_U41
    s_cmp_lg_u32 s56, 0
    s_cbranch_scc1 K2_U11
    s_branch K2_TAIL
K2_SWITCH:
    v_lshlrev_b32 v60, 3, v252
    s_mov_b32 s64, 7176192
    buffer_load_dwordx4 v[56:59], v60, s[8:11], s64 offen sc1
    v_permlane32_swap_b32 v242, v236
    v_permlane32_swap_b32 v243, v237
    v_permlane32_swap_b32 v244, v238
    v_permlane32_swap_b32 v245, v239
    v_permlane32_swap_b32 v240, v241
    v_add_f32 v242, v242, v236
    v_add_f32 v243, v243, v237
    v_add_f32 v244, v244, v238
    v_add_f32 v245, v245, v239
    v_add_f32 v240, -v240, -v241
    s_set_gpr_idx_on s32, gpr_idx(DST)
    s_nop 0
    v_cvt_pk_bf16_f32 v195, v242, v243
    v_cvt_pk_bf16_f32 v196, v244, v245
    v_cvt_pk_bf16_f32 v197, v240, v240
    s_set_gpr_idx_off
    v_lshl_add_u32 v230, v252, 1, s35
    v_lshrrev_b32 v231, 6, v252
    v_mul_u32_u24 v231, 126, v231
    v_lshrrev_b32 v254, 6, v252
    v_bfe_u32 v255, v252, 3, 2
    v_lshl_add_u32 v254, v254, 2, v255
    v_mul_u32_u24 v254, 640, v254
    v_bfe_u32 v255, v252, 5, 1
    v_lshl_add_u32 v254, v255, 5, v254
    v_and_b32 v255, 6, v252
    v_lshl_add_u32 v254, v255, 2, v254
    v_add_u32 v254, 152832, v254
    ds_read_b64_tr_b16 v[104:105], v254 offset:0
    ds_read_b64_tr_b16 v[106:107], v254 offset:5120
    ds_read_b64_tr_b16 v[108:109], v254 offset:64
    ds_read_b64_tr_b16 v[110:111], v254 offset:5184
    ds_read_b64_tr_b16 v[120:121], v254 offset:128
    ds_read_b64_tr_b16 v[122:123], v254 offset:5248
    ds_read_b64_tr_b16 v[124:125], v254 offset:192
    ds_read_b64_tr_b16 v[126:127], v254 offset:5312
    ds_read_b64_tr_b16 v[136:137], v254 offset:256
    ds_read_b64_tr_b16 v[138:139], v254 offset:5376
    ds_read_b64_tr_b16 v[140:141], v254 offset:320
    ds_read_b64_tr_b16 v[142:143], v254 offset:5440
    ds_read_b64_tr_b16 v[152:153], v254 offset:384
    ds_read_b64_tr_b16 v[154:155], v254 offset:5504
    ds_read_b64_tr_b16 v[156:157], v254 offset:448
    ds_read_b64_tr_b16 v[158:159], v254 offset:5568
    ds_read_b64_tr_b16 v[168:169], v254 offset:512
    ds_read_b64_tr_b16 v[170:171], v254 offset:5632
    ds_read_b64_tr_b16 v[172:173], v254 offset:576
    ds_read_b64_tr_b16 v[174:175], v254 offset:5696
    s_movk_i32 s40, 128
    s_movk_i32 s41, 384
    s_movk_i32 s42, 640
    s_movk_i32 s43, 896
    s_waitcnt lgkmcnt(15)
    v_lshlrev_b32 v96, 16, v104
    v_and_b32 v97, 0xffff0000, v104
    v_lshlrev_b32 v98, 16, v105
    v_and_b32 v99, 0xffff0000, v105
    v_lshlrev_b32 v100, 16, v106
    v_and_b32 v101, 0xffff0000, v106
    v_lshlrev_b32 v102, 16, v107
    v_and_b32 v103, 0xffff0000, v107
    v_lshlrev_b32 v104, 16, v108
    v_and_b32 v105, 0xffff0000, v108
    v_lshlrev_b32 v106, 16, v109
    v_and_b32 v107, 0xffff0000, v109
    v_lshlrev_b32 v108, 16, v110
    v_and_b32 v109, 0xffff0000, v110
    v_lshlrev_b32 v110, 16, v111
    v_and_b32 v111, 0xffff0000, v111
    s_waitcnt lgkmcnt(12)
    v_lshlrev_b32 v112, 16, v120
    v_and_b32 v113, 0xffff0000, v120
    v_lshlrev_b32 v114, 16, v121
    v_and_b32 v115, 0xffff0000, v121
    v_lshlrev_b32 v116, 16, v122
    v_and_b32 v117, 0xffff0000, v122
    v_lshlrev_b32 v118, 16, v123
    v_and_b32 v119, 0xffff0000, v123
    v_lshlrev_b32 v120, 16, v124
    v_and_b32 v121, 0xffff0000, v124
    v_lshlrev_b32 v122, 16, v125
    v_and_b32 v123, 0xffff0000, v125
    v_lshlrev_b32 v124, 16, v126
    v_and_b32 v125, 0xffff0000, v126
    v_lshlrev_b32 v126, 16, v127
    v_and_b32 v127, 0xffff0000, v127
    s_waitcnt lgkmcnt(8)
    v_lshlrev_b32 v128, 16, v136
    v_and_b32 v129, 0xffff0000, v136
    v_lshlrev_b32 v130, 16, v137
    v_and_b32 v131, 0xffff0000, v137
    v_lshlrev_b32 v132, 16, v138
    v_and_b32 v133, 0xffff0000, v138
    v_lshlrev_b32 v134, 16, v139
    v_and_b32 v135, 0xffff0000, v139
    v_lshlrev_b32 v136, 16, v140
    v_and_b32 v137, 0xffff0000, v140
    v_lshlrev_b32 v138, 16, v141
    v_and_b32 v139, 0xffff0000, v141
    v_lshlrev_b32 v140, 16, v142
    v_and_b32 v141, 0xffff0000, v142
    v_lshlrev_b32 v142, 16, v143
    v_and_b32 v143, 0xffff0000, v143
    s_waitcnt lgkmcnt(4)
    v_lshlrev_b32 v144, 16, v152
    v_and_b32 v145, 0xffff0000, v152
    v_lshlrev_b32 v146, 16, v153
    v_and_b32 v147, 0xffff0000, v153
    v_lshlrev_b32 v148, 16, v154
    v_and_b32 v149, 0xffff0000, v154
    v_lshlrev_b32 v150, 16, v155
    v_and_b32 v151, 0xffff0000, v155
    v_lshlrev_b32 v152, 16, v156
    v_and_b32 v153, 0xffff0000, v156
    v_lshlrev_b32 v154, 16, v157
    v_and_b32 v155, 0xffff0000, v157
    v_lshlrev_b32 v156, 16, v158
    v_and_b32 v157, 0xffff0000, v158
    v_lshlrev_b32 v158, 16, v159
    v_and_b32 v159, 0xffff0000, v159
    s_waitcnt lgkmcnt(0)
    v_lshlrev_b32 v160, 16, v168
    v_and_b32 v161, 0xffff0000, v168
    v_lshlrev_b32 v162, 16, v169
    v_and_b32 v163, 0xffff0000, v169
    v_lshlrev_b32 v164, 16, v170
    v_and_b32 v165, 0xffff0000, v170
    v_lshlrev_b32 v166, 16, v171
    v_and_b32 v167, 0xffff0000, v171
    v_lshlrev_b32 v168, 16, v172
    v_and_b32 v169, 0xffff0000, v172
    v_lshlrev_b32 v170, 16, v173
    v_and_b32 v171, 0xffff0000, v173
    v_lshlrev_b32 v172, 16, v174
    v_and_b32 v173, 0xffff0000, v174
    v_lshlrev_b32 v174, 16, v175
    v_and_b32 v175, 0xffff0000, v175
K2_FLGW:
    s_or_b32 s58, s54, s20
    s_waitcnt vmcnt(0)
    v_xor_b32 v56, s2, v56
    v_xor_b32 v57, s2, v57
    v_xor_b32 v58, s2, v58
    v_xor_b32 v59, s2, v59
    v_or3_b32 v56, v56, v57, v58
    v_or_b32 v56, v56, v59
    v_cmp_ne_u32 vcc, 0, v56
    s_nop 0
    s_cbranch_vccnz K2_FLGR
    s_cmp_eq_u32 s58, 0
    s_cbranch_scc1 K2_FLGY
K2_FLGOK:
    s_cmp_eq_u32 s36, 0
    s_cbranch_scc1 K2_TAIL2
    s_mov_b32 s29, s48
    s_mov_b32 s32, s31
    s_mov_b32 s30, s3
    s_mov_b32 s31, s35
    s_bfe_u32 s56, s3, 0x40012
    s_cmp_eq_u32 s56, 5
    s_cbranch_scc1 K2_U21
    s_cmp_eq_u32 s56, 6
    s_cbranch_scc1 K2_U3h1
    s_branch K2_DSP1
K2_dum_4:
    v_mov_b32 v232, -1
    s_mov_b32 m0, 163312
    s_mov_b64 exec, 1
    buffer_load_dwordx4 v232, s[16:19], 0 offen lds
    buffer_load_dwordx4 v232, s[16:19], 0 offen lds
    s_mov_b64 exec, -1
    s_branch K2_back_6
K2_nul_10:
    s_mov_b32 s58, 63
    s_mov_b32 s36, 0
    s_branch K2_back_13
K2_spin_11:
    s_sub_u32 s27, s27, 1
    s_cbranch_scc1 K2_END
    v_lshl_add_u32 v233, v252, 1, s53
    ds_read_b32 v233, v233
    s_waitcnt lgkmcnt(0)
    s_branch K2_chk_12
K2_dyn_8:
    v_mov_b32 v254, 163296
    v_mov_b32 v255, 1
    v_lshl_add_u32 v233, v252, 1, s53
    s_mov_b64 exec, 1
    ds_add_rtn_u32 v232, v254, v255
    s_mov_b64 exec, -1
    ds_read_b32 v233, v233
    s_waitcnt lgkmcnt(0)
    v_readfirstlane_b32 s58, v232
    s_nop 0
    s_cmp_lt_u32 s58, s22
    s_cbranch_scc0 K2_nul_10
    s_and_b32 s59, s58, 7
    s_lshr_b32 s60, s58, 3
K2_chk_12:
    v_readlane_b32 s61, v233, s59
    s_nop 0
    s_cmp_gt_u32 s61, s60
    s_cbranch_scc0 K2_spin_11
K2_back_13:
    s_mov_b32 s34, 1
    s_branch K2_back_9
K2_dum_17:
    v_mov_b32 v232, -1
    s_mov_b32 m0, 163312
    s_mov_b64 exec, 1
    buffer_load_dwordx4 v232, s[16:19], 0 offen lds
    buffer_load_dwordx4 v232, s[16:19], 0 offen lds
    s_mov_b64 exec, -1
    s_branch K2_back_19
K2_nul_23:
    s_mov_b32 s58, 63
    s_mov_b32 s36, 0
    s_branch K2_back_26
K2_spin_24:
    s_sub_u32 s27, s27, 1
    s_cbranch_scc1 K2_END
    v_lshl_add_u32 v233, v252, 1, s53
    ds_read_b32 v233, v233
    s_waitcnt lgkmcnt(0)
    s_branch K2_chk_25
K2_dyn_21:
    v_mov_b32 v254, 163296
    v_mov_b32 v255, 1
    v_lshl_add_u32 v233, v252, 1, s53
    s_mov_b64 exec, 1
    ds_add_rtn_u32 v232, v254, v255
    s_mov_b64 exec, -1
    ds_read_b32 v233, v233
    s_waitcnt lgkmcnt(0)
    v_readfirstlane_b32 s58, v232
    s_nop 0
    s_cmp_lt_u32 s58, s22
    s_cbranch_scc0 K2_nul_23
    s_and_b32 s59, s58, 7
    s_lshr_b32 s60, s58, 3
K2_chk_25:
    v_readlane_b32 s61, v233, s59
    s_nop 0
    s_cmp_gt_u32 s61, s60
    s_cbranch_scc0 K2_spin_24
K2_back_26:
    s_mov_b32 s34, 1
    s_branch K2_back_22
K2_dum_30:
    v_mov_b32 v232, -1
    s_mov_b32 m0, 163312
    s_mov_b64 exec, 1
    buffer_load_dwordx4 v232, s[16:19], 0 offen lds
    buffer_load_dwordx4 v232, s[16:19], 0 offen lds
    s_mov_b64 exec, -1
    s_branch K2_back_32
K2_nul_36:
    s_mov_b32 s58, 63
    s_mov_b32 s36, 0
    s_branch K2_back_39
K2_spin_37:
    s_sub_u32 s27, s27, 1
    s_cbranch_scc1 K2_END
    v_lshl_add_u32 v233, v252, 1, s53
    ds_read_b32 v233, v233
    s_waitcnt lgkmcnt(0)
    s_branch K2_chk_38
K2_dyn_34:
    v_mov_b32 v254, 163296
    v_mov_b32 v255, 1
    v_lshl_add_u32 v233, v252, 1, s53
    s_mov_b64 exec, 1
    ds_add_rtn_u32 v232, v254, v255
    s_mov_b64 exec, -1
    ds_read_b32 v233, v233
    s_waitcnt lgkmcnt(0)
    v_readfirstlane_b32 s58, v232
    s_nop 0
    s_cmp_lt_u32 s58, s22
    s_cbranch_scc0 K2_nul_36
    s_and_b32 s59, s58, 7
    s_lshr_b32 s60, s58, 3
K2_chk_38:
    v_readlane_b32 s61, v233, s59
    s_nop 0
    s_cmp_gt_u32 s61, s60
    s_cbranch_scc0 K2_spin_37
K2_back_39:
    s_mov_b32 s34, 1
    s_branch K2_back_35
K2_dum_43:
    v_mov_b32 v232, -1
    s_mov_b32 m0, 163312
    s_mov_b64 exec, 1
    buffer_load_dwordx4 v232, s[16:19], 0 offen lds
    buffer_load_dwordx4 v232, s[16:19], 0 offen lds
    s_mov_b64 exec, -1
    s_branch K2_back_45
K2_nul_47:
    s_mov_b32 s58, 63
    s_mov_b32 s36, 0
    s_branch K2_back_50
K2_spin_48:
    s_sub_u32 s27, s27, 1
    s_cbranch_scc1 K2_END
    v_lshl_add_u32 v233, v252, 1, s53
    ds_read_b32 v233, v233
    s_waitcnt lgkmcnt(0)
    s_branch K2_chk_49
K2_nul_54:
    s_mov_b32 s58, 63
    s_mov_b32 s36, 0
    s_branch K2_back_57
K2_spin_55:
    s_sub_u32 s27, s27, 1
    s_cbranch_scc1 K2_END
    v_lshl_add_u32 v233, v252, 1, s53
    ds_read_b32 v233, v233
    s_waitcnt lgkmcnt(0)
    s_branch K2_chk_56
K2_nul_61:
    s_mov_b32 s58, 63
    s_mov_b32 s36, 0
    s_branch K2_back_64
K2_spin_62:
    s_sub_u32 s27, s27, 1
    s_cbranch_scc1 K2_END
    v_lshl_add_u32 v233, v252, 1, s53
    ds_read_b32 v233, v233
    s_waitcnt lgkmcnt(0)
    s_branch K2_chk_63
K2_PAD_TL:
    s_branch K2_HOP
K2_TAIL2:
    v_lshlrev_b32 v229, 3, v252
    s_mul_i32 s58, s20, 20480
    s_add_u32 s58, s58, 6946816
    s_mul_i32 s59, s20, 8224
    buffer_load_dwordx4 v[96:99], v229, s[8:11], s58 offen offset:0 sc1
    buffer_load_dwordx4 v[100:103], v229, s[8:11], s58 offen offset:1024 sc1
    buffer_load_dwordx4 v[104:107], v229, s[8:11], s58 offen offset:2048 sc1
    buffer_load_dwordx4 v[108:111], v229, s[8:11], s58 offen offset:3072 sc1
    s_add_u32 s58, s58, 4096
    buffer_load_dwordx4 v[128:131], v229, s[8:11], s58 offen offset:0 sc1
    buffer_load_dwordx4 v[132:135], v229, s[8:11], s58 offen offset:1024 sc1
    buffer_load_dwordx4 v[136:139], v229, s[8:11], s58 offen offset:2048 sc1
    buffer_load_dwordx4 v[140:143], v229, s[8:11], s58 offen offset:3072 sc1
    v_lshl_add_u32 v228, v252, 1, s59
    v_lshrrev_b32 v226, 6, v252
    v_mul_u32_u24 v226, 126, v226
    v_sub_u32 v226, v228, v226
    s_branch K2_TAIL3
K2_TAIL:
    v_lshlrev_b32 v229, 3, v252
    s_mul_i32 s58, s20, 20480
    s_add_u32 s58, s58, 6946816
    s_mul_i32 s59, s20, 8224
    buffer_load_dwordx4 v[96:99], v229, s[8:11], s58 offen offset:0 sc1
    v_permlane32_swap_b32 v242, v236
    v_permlane32_swap_b32 v243, v237
    v_permlane32_swap_b32 v244, v238
    buffer_load_dwordx4 v[100:103], v229, s[8:11], s58 offen offset:1024 sc1
    v_permlane32_swap_b32 v245, v239
    v_permlane32_swap_b32 v240, v241
    v_add_f32 v242, v242, v236
    buffer_load_dwordx4 v[104:107], v229, s[8:11], s58 offen offset:2048 sc1
    v_add_f32 v243, v243, v237
    v_add_f32 v244, v244, v238
    v_add_f32 v245, v245, v239
    buffer_load_dwordx4 v[108:111], v229, s[8:11], s58 offen offset:3072 sc1
    v_add_f32 v240, -v240, -v241
    v_sub_u32 v241, v230, v231
    v_cvt_pk_bf16_f32 v242, v242, v243
    s_add_u32 s58, s58, 4096
    buffer_load_dwordx4 v[128:131], v229, s[8:11], s58 offen offset:0 sc1
    v_cvt_pk_bf16_f32 v244, v244, v245
    v_cvt_pk_bf16_f32 v240, v240, v240
    ds_write_b32 v230, v242 offset:768
    buffer_load_dwordx4 v[132:135], v229, s[8:11], s58 offen offset:1024 sc1
    ds_write_b32 v230, v244 offset:1024
    ds_write_b16 v241, v240 offset:1280
    v_lshl_add_u32 v228, v252, 1, s59
    buffer_load_dwordx4 v[136:139], v229, s[8:11], s58 offen offset:2048 sc1
    v_lshrrev_b32 v226, 6, v252
    v_mul_u32_u24 v226, 126, v226
    v_sub_u32 v226, v228, v226
    buffer_load_dwordx4 v[140:143], v229, s[8:11], s58 offen offset:3072 sc1
K2_TAIL3:
    s_waitcnt vmcnt(8)
    ds_write2st64_b32 v228, v192, v193 offset0:0 offset1:1
    ds_write2st64_b32 v228, v194, v195 offset0:2 offset1:3
    s_add_u32 s58, s58, 4096
    buffer_load_dwordx4 v[112:115], v229, s[8:11], s58 offen offset:0 sc1
    v_bfe_u32 v48, v252, 1, 4
    v_lshrrev_b32 v49, 5, v252
    ds_write_b16 v226, v197 offset:1280
    ds_write2st64_b32 v228, v196, v198 offset0:4 offset1:6
    buffer_load_dwordx4 v[116:119], v229, s[8:11], s58 offen offset:1024 sc1
    v_lshrrev_b32 v55, 3, v48
    v_lshlrev_b32 v52, 4, v49
    ds_write2st64_b32 v228, v199, v200 offset0:7 offset1:8
    ds_write2st64_b32 v228, v201, v202 offset0:9 offset1:10
    buffer_load_dwordx4 v[120:123], v229, s[8:11], s58 offen offset:2048 sc1
    v_lshl_add_u32 v54, v55, 2, v48
    v_and_b32 v54, 7, v54
    ds_write_b16 v226, v203 offset:2816
    ds_write2st64_b32 v228, v204, v205 offset0:12 offset1:13
    buffer_load_dwordx4 v[124:127], v229, s[8:11], s58 offen offset:3072 sc1
    v_and_b32 v50, 7, v48
    v_mul_u32_u24 v50, 8224, v50
    ds_write2st64_b32 v228, v206, v207 offset0:14 offset1:15
    ds_write2st64_b32 v228, v208, v210 offset0:16 offset1:18
    s_add_u32 s58, s58, 4096
    buffer_load_dwordx4 v[144:147], v229, s[8:11], s58 offen offset:0 sc1
    v_mul_u32_u24 v51, 1536, v55
    v_add_u32 v50, v50, v51
    ds_write_b16 v226, v209 offset:4352
    ds_write2st64_b32 v228, v211, v212 offset0:19 offset1:20
    buffer_load_dwordx4 v[148:151], v229, s[8:11], s58 offen offset:1024 sc1
    v_add_u32 v222, v50, v52
    v_mul_u32_u24 v51, 8224, v54
    ds_write2st64_b32 v228, v213, v214 offset0:21 offset1:22
    ds_write2st64_b32 v228, v216, v217 offset0:24 offset1:25
    buffer_load_dwordx4 v[152:155], v229, s[8:11], s58 offen offset:2048 sc1
    v_add_u32 v232, v51, v52
    v_lshl_add_u32 v247, v55, 7, v232
    ds_write_b16 v226, v215 offset:5888
    ds_write2st64_b32 v228, v218, v219 offset0:26 offset1:27
    buffer_load_dwordx4 v[156:159], v229, s[8:11], s58 offen offset:3072 sc1
    v_mul_u32_u24 v51, 2080, v48
    s_mov_b32 s60, 65536
    ds_write_b32 v228, v220 offset:7168
    ds_write_b16 v226, v221 offset:7424
    s_add_u32 s58, s58, 4096
    buffer_load_dwordx4 v[160:163], v229, s[8:11], s58 offen offset:0 sc1
    v_add3_u32 v223, v51, v52, s60
    v_mul_u32_u24 v51, 2080, v54
    buffer_load_dwordx4 v[164:167], v229, s[8:11], s58 offen offset:1024 sc1
    s_mov_b32 s60, 132096
    v_add3_u32 v225, v51, v52, s60
    buffer_load_dwordx4 v[168:171], v229, s[8:11], s58 offen offset:2048 sc1
    v_lshl_add_u32 v248, v55, 7, v225
    s_lshl_b32 s60, s20, 5
    buffer_load_dwordx4 v[172:175], v229, s[8:11], s58 offen offset:3072 sc1
    v_lshl_add_u32 v49, v49, 3, s60
    s_mov_b32 s60, 65536
    v_add3_u32 v255, v51, v49, s60
    v_lshl_add_u32 v246, v55, 9, v255
    v_bfe_u32 v53, v48, 2, 1
    v_lshl_add_u32 v49, v53, 4, v49
    v_add_u32 v254, v50, v49
    s_and_b32 s64, s55, s28
    s_waitcnt lgkmcnt(0)
    s_barrier
    s_cmp_eq_u32 s64, 0
    s_cbranch_scc1 K2_MULTI
    s_setprio 3
    ds_read_b128 v[48:51], v222 offset:0
    ds_read_b128 v[52:55], v222 offset:64
    ds_read_b128 v[56:59], v222 offset:896
    ds_read_b128 v[60:63], v222 offset:960
    ds_read_b128 v[64:67], v223 offset:0
    ds_read_b128 v[68:71], v223 offset:64
    ds_read_b128 v[72:75], v223 offset:896
    ds_read_b128 v[76:79], v223 offset:960
    ds_read_b128 v[80:83], v222 offset:3072
    ds_read_b128 v[84:87], v222 offset:3136
    ds_read_b128 v[88:91], v222 offset:3968
    s_waitcnt vmcnt(19) lgkmcnt(9)
    v_mfma_f32_16x16x32_bf16 v[0:3], v[96:99], v[48:51], 0
    ds_read_b128 v[92:95], v222 offset:4032
    s_waitcnt vmcnt(18)
    v_mfma_f32_16x16x32_bf16 v[0:3], v[100:103], v[52:55], v[0:3]
    ds_read_b128 v[48:51], v223 offset:33280
    s_waitcnt vmcnt(17) lgkmcnt(9)
    v_mfma_f32_16x16x32_bf16 v[0:3], v[104:107], v[56:59], v[0:3]
    s_bfe_u32 s60, s20, 0x10002
    s_lshl_b32 s60, s60, 4
    ds_read_b128 v[52:55], v223 offset:33344
    s_waitcnt vmcnt(16)
    v_mfma_f32_16x16x32_bf16 v[0:3], v[108:111], v[60:63], v[0:3]
    s_add_u32 s59, s59, s60
    v_add_u32 v228, s59, v229
    ds_read_b128 v[56:59], v223 offset:34176
    s_waitcnt vmcnt(15) lgkmcnt(9)
    v_mfma_f32_16x16x32_bf16 v[0:3], v[128:131], v[64:67], v[0:3]
    s_mul_i32 s60, s20, 2080
    s_add_u32 s60, s60, 65536
    ds_read_b128 v[60:63], v223 offset:34240
    s_waitcnt vmcnt(14)
    v_mfma_f32_16x16x32_bf16 v[0:3], v[132:135], v[68:71], v[0:3]
    v_add_u32 v249, s60, v229
    s_mov_b32 s63, 0xbfb8aa3b
    ds_read_b128 v[64:67], v232 offset:6144
    s_waitcnt vmcnt(13) lgkmcnt(9)
    v_mfma_f32_16x16x32_bf16 v[0:3], v[136:139], v[72:75], v[0:3]
    s_add_u32 s40, s20, s21
    s_lshl_b32 s40, s40, 10
    ds_read_b128 v[68:71], v232 offset:6208
    s_waitcnt vmcnt(12)
    v_mfma_f32_16x16x32_bf16 v[0:3], v[140:143], v[76:79], v[0:3]
    s_add_u32 s41, s40, 8192
    s_add_u32 s42, s40, 16384
    ds_read_b128 v[72:75], v232 offset:7040
    s_waitcnt lgkmcnt(9)
    v_mfma_f32_16x16x32_bf16 v[16:19], v[96:99], v[80:83], 0
    s_add_u32 s43, s40, 24576
    s_add_u32 s44, s40, 32768
    ds_read_b128 v[76:79], v232 offset:7104
    v_mfma_f32_16x16x32_bf16 v[16:19], v[100:103], v[84:87], v[16:19]
    ds_read_b128 v[80:83], v225 offset:0
    s_waitcnt lgkmcnt(9)
    v_mfma_f32_16x16x32_bf16 v[16:19], v[104:107], v[88:91], v[16:19]
    ds_read_b128 v[84:87], v225 offset:64
    v_mfma_f32_16x16x32_bf16 v[16:19], v[108:111], v[92:95], v[16:19]
    v_mul_f32 v204, s63, v0
    v_mul_f32 v205, s63, v1
    ds_read_b128 v[88:91], v225 offset:896
    s_waitcnt lgkmcnt(9)
    v_mfma_f32_16x16x32_bf16 v[16:19], v[128:131], v[48:51], v[16:19]
    v_mul_f32 v206, s63, v2
    ds_read_b128 v[92:95], v225 offset:960
    v_mfma_f32_16x16x32_bf16 v[16:19], v[132:135], v[52:55], v[16:19]
    v_mul_f32 v207, s63, v3
    ds_read_b128 v[48:51], v222 offset:128
    s_waitcnt lgkmcnt(9)
    v_mfma_f32_16x16x32_bf16 v[16:19], v[136:139], v[56:59], v[16:19]
    v_exp_f32 v204, v204
    ds_read_b128 v[52:55], v222 offset:384
    v_mfma_f32_16x16x32_bf16 v[16:19], v[140:143], v[60:63], v[16:19]
    v_exp_f32 v205, v205
    ds_read_b128 v[56:59], v222 offset:256
    s_waitcnt lgkmcnt(9)
    v_mfma_f32_16x16x32_bf16 v[32:35], v[96:99], v[64:67], 0
    v_exp_f32 v206, v206
    ds_read_b128 v[60:63], v222 offset:192
    v_mfma_f32_16x16x32_bf16 v[32:35], v[100:103], v[68:71], v[32:35]
    v_exp_f32 v207, v207
    s_setprio 2
    ds_read_b128 v[64:67], v222 offset:448
    s_waitcnt lgkmcnt(9)
    v_mfma_f32_16x16x32_bf16 v[32:35], v[104:107], v[72:75], v[32:35]
    v_add_f32 v204, 1.0, v204
    ds_read_b128 v[68:71], v222 offset:320
    v_mfma_f32_16x16x32_bf16 v[32:35], v[108:111], v[76:79], v[32:35]
    v_add_f32 v205, 1.0, v205
    v_add_f32 v206, 1.0, v206
    ds_read_b128 v[72:75], v222 offset:640
    s_waitcnt lgkmcnt(9)
    v_mfma_f32_16x16x32_bf16 v[32:35], v[128:131], v[80:83], v[32:35]
    v_add_f32 v207, 1.0, v207
    ds_read_b128 v[76:79], v222 offset:512
    v_mfma_f32_16x16x32_bf16 v[32:35], v[132:135], v[84:87], v[32:35]
    v_rcp_f32 v204, v204
    ds_read_b128 v[80:83], v222 offset:768
    s_waitcnt lgkmcnt(9)
    v_mfma_f32_16x16x32_bf16 v[32:35], v[136:139], v[88:91], v[32:35]
    v_rcp_f32 v205, v205
    ds_read_b128 v[84:87], v222 offset:704
    v_mfma_f32_16x16x32_bf16 v[32:35], v[140:143], v[92:95], v[32:35]
    v_rcp_f32 v206, v206
    ds_read_b128 v[88:91], v222 offset:576
    s_waitcnt vmcnt(11) lgkmcnt(9)
    v_mfma_f32_16x16x32_bf16 v[4:7], v[112:115], v[48:51], 0
    v_rcp_f32 v207, v207
    ds_read_b128 v[92:95], v222 offset:832
    v_mfma_f32_16x16x32_bf16 v[8:11], v[112:115], v[52:55], 0
    v_cvt_pk_bf16_f32 v176, v0, v1
    ds_read_b128 v[48:51], v222 offset:1024
    s_waitcnt lgkmcnt(9)
    v_mfma_f32_16x16x32_bf16 v[12:15], v[112:115], v[56:59], 0
    v_cvt_pk_bf16_f32 v177, v2, v3
    ds_read_b128 v[52:55], v222 offset:1280
    s_waitcnt vmcnt(10)
    v_mfma_f32_16x16x32_bf16 v[4:7], v[116:119], v[60:63], v[4:7]
    v_mul_f32 v208, s63, v16
    v_mul_f32 v209, s63, v17
    ds_read_b128 v[56:59], v222 offset:1152
    s_waitcnt lgkmcnt(9)
    v_mfma_f32_16x16x32_bf16 v[8:11], v[116:119], v[64:67], v[8:11]
    v_mul_f32 v210, s63, v18
    ds_read_b128 v[60:63], v222 offset:1088
    v_mfma_f32_16x16x32_bf16 v[12:15], v[116:119], v[68:71], v[12:15]
    v_mul_f32 v211, s63, v19
    ds_read_b128 v[64:67], v222 offset:1344
    s_waitcnt vmcnt(9) lgkmcnt(9)
    v_mfma_f32_16x16x32_bf16 v[4:7], v[120:123], v[72:75], v[4:7]
    v_exp_f32 v208, v208
    ds_read_b128 v[68:71], v222 offset:1216
    v_mfma_f32_16x16x32_bf16 v[8:11], v[120:123], v[76:79], v[8:11]
    v_exp_f32 v209, v209
    ds_read_b128 v[72:75], v223 offset:128
    s_waitcnt lgkmcnt(9)
    v_mfma_f32_16x16x32_bf16 v[12:15], v[120:123], v[80:83], v[12:15]
    v_exp_f32 v210, v210
    ds_read_b128 v[76:79], v223 offset:384
    s_waitcnt vmcnt(8)
    v_mfma_f32_16x16x32_bf16 v[4:7], v[124:127], v[84:87], v[4:7]
    v_exp_f32 v211, v211
    ds_read_b128 v[80:83], v223 offset:256
    s_waitcnt lgkmcnt(9)
    v_mfma_f32_16x16x32_bf16 v[8:11], v[124:127], v[88:91], v[8:11]
    v_add_f32 v208, 1.0, v208
    ds_read_b128 v[84:87], v223 offset:192
    v_mfma_f32_16x16x32_bf16 v[12:15], v[124:127], v[92:95], v[12:15]
    v_add_f32 v209, 1.0, v209
    v_add_f32 v210, 1.0, v210
    ds_read_b128 v[88:91], v223 offset:448
    s_waitcnt vmcnt(7) lgkmcnt(9)
    v_mfma_f32_16x16x32_bf16 v[4:7], v[144:147], v[48:51], v[4:7]
    v_add_f32 v211, 1.0, v211
    s_setprio 1
    ds_read_b128 v[92:95], v223 offset:320
    v_mfma_f32_16x16x32_bf16 v[8:11], v[144:147], v[52:55], v[8:11]
    v_rcp_f32 v208, v208
    ds_read_b128 v[48:51], v223 offset:640
    s_waitcnt lgkmcnt(9)
    v_mfma_f32_16x16x32_bf16 v[12:15], v[144:147], v[56:59], v[12:15]
    v_rcp_f32 v209, v209
    ds_read_b128 v[52:55], v223 offset:512
    s_waitcnt vmcnt(6)
    v_mfma_f32_16x16x32_bf16 v[4:7], v[148:151], v[60:63], v[4:7]
    v_rcp_f32 v210, v210
    ds_read_b128 v[56:59], v223 offset:768
    s_waitcnt lgkmcnt(9)
    v_mfma_f32_16x16x32_bf16 v[8:11], v[148:151], v[64:67], v[8:11]
    v_rcp_f32 v211, v211
    ds_read_b128 v[60:63], v223 offset:704
    v_mfma_f32_16x16x32_bf16 v[12:15], v[148:151], v[68:71], v[12:15]
K2_PAD_T2:
    s_cbranch_execz K2_HOP
    v_cvt_pk_bf16_f32 v184, v16, v17
    ds_read_b128 v[64:67], v223 offset:576
    s_waitcnt vmcnt(5) lgkmcnt(9)
    v_mfma_f32_16x16x32_bf16 v[4:7], v[152:155], v[72:75], v[4:7]
    v_cvt_pk_bf16_f32 v185, v18, v19
    ds_read_b128 v[68:71], v223 offset:832
    v_mfma_f32_16x16x32_bf16 v[8:11], v[152:155], v[76:79], v[8:11]
    v_mul_f32 v212, s63, v32
    v_mul_f32 v213, s63, v33
    ds_read_b128 v[72:75], v223 offset:1024
    s_waitcnt lgkmcnt(9)
    v_mfma_f32_16x16x32_bf16 v[12:15], v[152:155], v[80:83], v[12:15]
    v_mul_f32 v214, s63, v34
    ds_read_b128 v[76:79], v223 offset:1280
    s_waitcnt vmcnt(4)
    v_mfma_f32_16x16x32_bf16 v[4:7], v[156:159], v[84:87], v[4:7]
    v_mul_f32 v215, s63, v35
    ds_read_b128 v[80:83], v223 offset:1152
    s_waitcnt lgkmcnt(9)
    v_mfma_f32_16x16x32_bf16 v[8:11], v[156:159], v[88:91], v[8:11]
    v_exp_f32 v212, v212
    ds_read_b128 v[84:87], v223 offset:1088
    v_mfma_f32_16x16x32_bf16 v[12:15], v[156:159], v[92:95], v[12:15]
    v_exp_f32 v213, v213
    ds_read_b128 v[88:91], v223 offset:1344
    s_waitcnt vmcnt(3) lgkmcnt(9)
    v_mfma_f32_16x16x32_bf16 v[4:7], v[160:163], v[48:51], v[4:7]
    v_exp_f32 v214, v214
    ds_read_b128 v[92:95], v223 offset:1216
    v_mfma_f32_16x16x32_bf16 v[8:11], v[160:163], v[52:55], v[8:11]
    v_exp_f32 v215, v215
    ds_read_b128 v[48:51], v222 offset:3200
    s_waitcnt lgkmcnt(9)
    v_mfma_f32_16x16x32_bf16 v[12:15], v[160:163], v[56:59], v[12:15]
    v_add_f32 v212, 1.0, v212
    ds_read_b128 v[52:55], v222 offset:3456
    s_waitcnt vmcnt(2)
    v_mfma_f32_16x16x32_bf16 v[4:7], v[164:167], v[60:63], v[4:7]
    v_add_f32 v213, 1.0, v213
    v_add_f32 v214, 1.0, v214
    ds_read_b128 v[56:59], v222 offset:3328
    s_waitcnt lgkmcnt(9)
    v_mfma_f32_16x16x32_bf16 v[8:11], v[164:167], v[64:67], v[8:11]
    v_add_f32 v215, 1.0, v215
    ds_read_b128 v[60:63], v222 offset:3264
    v_mfma_f32_16x16x32_bf16 v[12:15], v[164:167], v[68:71], v[12:15]
    v_rcp_f32 v212, v212
    s_setprio 0
    ds_read_b128 v[64:67], v222 offset:3520
    s_waitcnt vmcnt(1) lgkmcnt(9)
    v_mfma_f32_16x16x32_bf16 v[4:7], v[168:171], v[72:75], v[4:7]
    v_rcp_f32 v213, v213
    ds_read_b128 v[68:71], v222 offset:3392
    v_mfma_f32_16x16x32_bf16 v[8:11], v[168:171], v[76:79], v[8:11]
    v_rcp_f32 v214, v214
    ds_read_b128 v[72:75], v222 offset:3712
    s_waitcnt lgkmcnt(9)
    v_mfma_f32_16x16x32_bf16 v[12:15], v[168:171], v[80:83], v[12:15]
    v_rcp_f32 v215, v215
    ds_read_b128 v[76:79], v222 offset:3584
    s_waitcnt vmcnt(0)
    v_mfma_f32_16x16x32_bf16 v[4:7], v[172:175], v[84:87], v[4:7]
    v_cvt_pk_bf16_f32 v220, v32, v33
    ds_read_b128 v[80:83], v222 offset:3840
    s_waitcnt lgkmcnt(9)
    v_mfma_f32_16x16x32_bf16 v[8:11], v[172:175], v[88:91], v[8:11]
    v_cvt_pk_bf16_f32 v221, v34, v35
    ds_read_b128 v[84:87], v222 offset:3776
    v_mfma_f32_16x16x32_bf16 v[12:15], v[172:175], v[92:95], v[12:15]
    ds_read_b128 v[88:91], v222 offset:3648
    s_waitcnt lgkmcnt(9)
    v_mfma_f32_16x16x32_bf16 v[20:23], v[112:115], v[48:51], 0
    ds_read_b128 v[92:95], v222 offset:3904
    v_mfma_f32_16x16x32_bf16 v[24:27], v[112:115], v[52:55], 0
    ds_read_b128 v[48:51], v222 offset:4096
    s_waitcnt lgkmcnt(9)
    v_mfma_f32_16x16x32_bf16 v[28:31], v[112:115], v[56:59], 0
    s_barrier
    s_setprio 3
    ds_read_b128 v[52:55], v222 offset:4352
    v_mfma_f32_16x16x32_bf16 v[20:23], v[116:119], v[60:63], v[20:23]
    v_mul_f32 v4, v4, v204
    ds_read_b128 v[56:59], v222 offset:4224
    s_waitcnt lgkmcnt(9)
    v_mfma_f32_16x16x32_bf16 v[24:27], v[116:119], v[64:67], v[24:27]
    v_mul_f32 v5, v5, v205
    ds_read_b128 v[60:63], v222 offset:4160
    v_mfma_f32_16x16x32_bf16 v[28:31], v[116:119], v[68:71], v[28:31]
    v_mul_f32 v6, v6, v206
    ds_read_b128 v[64:67], v222 offset:4416
    s_waitcnt lgkmcnt(9)
    v_mfma_f32_16x16x32_bf16 v[20:23], v[120:123], v[72:75], v[20:23]
    v_mul_f32 v7, v7, v207
    ds_read_b128 v[68:71], v222 offset:4288
    v_mfma_f32_16x16x32_bf16 v[24:27], v[120:123], v[76:79], v[24:27]
    v_cvt_pk_bf16_f32 v178, v4, v5
    ds_read_b128 v[72:75], v223 offset:33408
    s_waitcnt lgkmcnt(9)
    v_mfma_f32_16x16x32_bf16 v[28:31], v[120:123], v[80:83], v[28:31]
    v_cvt_pk_bf16_f32 v179, v6, v7
    ds_read_b128 v[76:79], v223 offset:33664
    v_mfma_f32_16x16x32_bf16 v[20:23], v[124:127], v[84:87], v[20:23]
    v_mul_f32 v8, v8, v204
    ds_read_b128 v[80:83], v223 offset:33536
    s_waitcnt lgkmcnt(9)
    v_mfma_f32_16x16x32_bf16 v[24:27], v[124:127], v[88:91], v[24:27]
    v_mul_f32 v9, v9, v205
    ds_read_b128 v[84:87], v223 offset:33472
    v_mfma_f32_16x16x32_bf16 v[28:31], v[124:127], v[92:95], v[28:31]
    v_mul_f32 v10, v10, v206
    ds_read_b128 v[88:91], v223 offset:33728
    s_waitcnt lgkmcnt(9)
    v_mfma_f32_16x16x32_bf16 v[20:23], v[144:147], v[48:51], v[20:23]
    v_mul_f32 v11, v11, v207
    s_setprio 2
    ds_read_b128 v[92:95], v223 offset:33600
    v_mfma_f32_16x16x32_bf16 v[24:27], v[144:147], v[52:55], v[24:27]
    v_cvt_pk_bf16_f32 v180, v8, v9
    ds_read_b128 v[48:51], v223 offset:33920
    s_waitcnt lgkmcnt(9)
    v_mfma_f32_16x16x32_bf16 v[28:31], v[144:147], v[56:59], v[28:31]
    v_cvt_pk_bf16_f32 v181, v10, v11
    ds_read_b128 v[52:55], v223 offset:33792
    v_mfma_f32_16x16x32_bf16 v[20:23], v[148:151], v[60:63], v[20:23]
    v_mul_f32 v12, v12, v204
    ds_read_b128 v[56:59], v223 offset:34048
    s_waitcnt lgkmcnt(9)
    v_mfma_f32_16x16x32_bf16 v[24:27], v[148:151], v[64:67], v[24:27]
    v_mul_f32 v13, v13, v205
    ds_read_b128 v[60:63], v223 offset:33984
    v_mfma_f32_16x16x32_bf16 v[28:31], v[148:151], v[68:71], v[28:31]
    v_mul_f32 v14, v14, v206
    ds_read_b128 v[64:67], v223 offset:33856
    s_waitcnt lgkmcnt(9)
    v_mfma_f32_16x16x32_bf16 v[20:23], v[152:155], v[72:75], v[20:23]
    v_mul_f32 v15, v15, v207
    ds_read_b128 v[68:71], v223 offset:34112
    v_mfma_f32_16x16x32_bf16 v[24:27], v[152:155], v[76:79], v[24:27]
    v_cvt_pk_bf16_f32 v182, v12, v13
    ds_read_b128 v[72:75], v223 offset:34304
    s_waitcnt lgkmcnt(9)
    v_mfma_f32_16x16x32_bf16 v[28:31], v[152:155], v[80:83], v[28:31]
    v_cvt_pk_bf16_f32 v183, v14, v15
    ds_read_b128 v[76:79], v223 offset:34560
    v_mfma_f32_16x16x32_bf16 v[20:23], v[156:159], v[84:87], v[20:23]
    ds_write_b64 v254, v[176:177] offset:0
    ds_write_b64 v254, v[178:179] offset:256
    ds_write_b64 v254, v[180:181] offset:512
    ds_write_b64 v254, v[182:183] offset:768
    ds_write_b64 v255, v[220:221] offset:0
    ds_read_b128 v[80:83], v223 offset:34432
    s_waitcnt lgkmcnt(14)
    v_mfma_f32_16x16x32_bf16 v[24:27], v[156:159], v[88:91], v[24:27]
    ds_read_b128 v[84:87], v223 offset:34368
    v_mfma_f32_16x16x32_bf16 v[28:31], v[156:159], v[92:95], v[28:31]
    s_setprio 1
    ds_read_b128 v[88:91], v223 offset:34624
    s_waitcnt lgkmcnt(14)
    v_mfma_f32_16x16x32_bf16 v[20:23], v[160:163], v[48:51], v[20:23]
    ds_read_b128 v[92:95], v223 offset:34496
    v_mfma_f32_16x16x32_bf16 v[24:27], v[160:163], v[52:55], v[24:27]
    ds_read_b128 v[48:51], v247 offset:6272
    s_waitcnt lgkmcnt(14)
    v_mfma_f32_16x16x32_bf16 v[28:31], v[160:163], v[56:59], v[28:31]
    ds_read_b128 v[52:55], v232 offset:6528
    v_mfma_f32_16x16x32_bf16 v[20:23], v[164:167], v[60:63], v[20:23]
    ds_read_b128 v[56:59], v247 offset:6336
    s_waitcnt lgkmcnt(14)
    v_mfma_f32_16x16x32_bf16 v[24:27], v[164:167], v[64:67], v[24:27]
    ds_read_b128 v[60:63], v232 offset:6592
    v_mfma_f32_16x16x32_bf16 v[28:31], v[164:167], v[68:71], v[28:31]
    ds_read_b128 v[64:67], v247 offset:6784
    s_waitcnt lgkmcnt(14)
    v_mfma_f32_16x16x32_bf16 v[20:23], v[168:171], v[72:75], v[20:23]
    ds_read_b128 v[68:71], v232 offset:6656
    v_mfma_f32_16x16x32_bf16 v[24:27], v[168:171], v[76:79], v[24:27]
    ds_read_b128 v[72:75], v247 offset:6848
    s_waitcnt lgkmcnt(9)
    v_mfma_f32_16x16x32_bf16 v[28:31], v[168:171], v[80:83], v[28:31]
    ds_read_b128 v[76:79], v232 offset:6720
    v_mfma_f32_16x16x32_bf16 v[20:23], v[172:175], v[84:87], v[20:23]
    s_setprio 0
    ds_read_b128 v[80:83], v247 offset:7168
    s_waitcnt lgkmcnt(9)
    v_mfma_f32_16x16x32_bf16 v[24:27], v[172:175], v[88:91], v[24:27]
    ds_read_b128 v[84:87], v232 offset:7424
    v_mfma_f32_16x16x32_bf16 v[28:31], v[172:175], v[92:95], v[28:31]
    ds_read_b128 v[88:91], v247 offset:7232
    s_waitcnt lgkmcnt(9)
    v_mfma_f32_16x16x32_bf16 v[36:39], v[112:115], v[48:51], 0
    ds_read_b128 v[92:95], v232 offset:7488
    v_mfma_f32_16x16x32_bf16 v[40:43], v[112:115], v[52:55], 0
    ds_read_b128 v[48:51], v248 offset:128
    s_waitcnt lgkmcnt(9)
    v_mfma_f32_16x16x32_bf16 v[36:39], v[116:119], v[56:59], v[36:39]
    s_barrier
    ds_read_b128 v[192:195], v228 offset:0
    ds_read_b128 v[196:199], v228 offset:1536
    s_setprio 3
    ds_read_b128 v[52:55], v225 offset:384
    v_mfma_f32_16x16x32_bf16 v[40:43], v[116:119], v[60:63], v[40:43]
    v_mul_f32 v20, v20, v208
    v_mul_f32 v21, v21, v209
    ds_read_b128 v[56:59], v248 offset:192
    s_waitcnt lgkmcnt(11)
    v_mfma_f32_16x16x32_bf16 v[36:39], v[120:123], v[64:67], v[36:39]
    v_mul_f32 v22, v22, v210
    ds_read_b128 v[60:63], v225 offset:448
    v_mfma_f32_16x16x32_bf16 v[40:43], v[120:123], v[68:71], v[40:43]
    v_mul_f32 v23, v23, v211
    ds_read_b128 v[64:67], v248 offset:640
    s_waitcnt lgkmcnt(11)
    v_mfma_f32_16x16x32_bf16 v[36:39], v[124:127], v[72:75], v[36:39]
    v_cvt_pk_bf16_f32 v186, v20, v21
    ds_read_b128 v[68:71], v225 offset:512
    v_mfma_f32_16x16x32_bf16 v[40:43], v[124:127], v[76:79], v[40:43]
    v_cvt_pk_bf16_f32 v187, v22, v23
    ds_read_b128 v[72:75], v248 offset:704
    s_waitcnt lgkmcnt(11)
    v_mfma_f32_16x16x32_bf16 v[36:39], v[144:147], v[80:83], v[36:39]
    v_mul_f32 v24, v24, v208
    v_mul_f32 v25, v25, v209
    s_waitcnt lgkmcnt(6)
    buffer_store_dwordx4 v[192:195], v229, s[12:15], s40 offen sc1
    buffer_store_dwordx4 v[196:199], v229, s[12:15], s41 offen sc1
    s_setprio 2
    ds_read_b128 v[76:79], v225 offset:576
    v_mfma_f32_16x16x32_bf16 v[40:43], v[144:147], v[84:87], v[40:43]
    v_mul_f32 v26, v26, v210
    ds_read_b128 v[80:83], v248 offset:1024
    v_mfma_f32_16x16x32_bf16 v[36:39], v[148:151], v[88:91], v[36:39]
    v_mul_f32 v27, v27, v211
    ds_read_b128 v[84:87], v225 offset:1280
    v_mfma_f32_16x16x32_bf16 v[40:43], v[148:151], v[92:95], v[40:43]
    v_cvt_pk_bf16_f32 v188, v24, v25
    ds_read_b128 v[88:91], v248 offset:1088
    s_waitcnt lgkmcnt(9)
    v_mfma_f32_16x16x32_bf16 v[36:39], v[152:155], v[48:51], v[36:39]
    v_cvt_pk_bf16_f32 v189, v26, v27
    ds_read_b128 v[92:95], v225 offset:1344
    v_mfma_f32_16x16x32_bf16 v[40:43], v[152:155], v[52:55], v[40:43]
    v_mul_f32 v28, v28, v208
    v_mul_f32 v29, v29, v209
    s_waitcnt lgkmcnt(8)
    v_mfma_f32_16x16x32_bf16 v[36:39], v[156:159], v[56:59], v[36:39]
    v_mul_f32 v30, v30, v210
    v_mfma_f32_16x16x32_bf16 v[40:43], v[156:159], v[60:63], v[40:43]
    v_mul_f32 v31, v31, v211
    s_setprio 1
    s_waitcnt lgkmcnt(6)
    v_mfma_f32_16x16x32_bf16 v[36:39], v[160:163], v[64:67], v[36:39]
    v_cvt_pk_bf16_f32 v190, v28, v29
    v_mfma_f32_16x16x32_bf16 v[40:43], v[160:163], v[68:71], v[40:43]
    v_cvt_pk_bf16_f32 v191, v30, v31
    s_waitcnt lgkmcnt(4)
    v_mfma_f32_16x16x32_bf16 v[36:39], v[164:167], v[72:75], v[36:39]
    ds_write_b64 v254, v[184:185] offset:3072
    ds_write_b64 v254, v[186:187] offset:3328
    ds_write_b64 v254, v[188:189] offset:3584
    ds_write_b64 v254, v[190:191] offset:3840
    v_mfma_f32_16x16x32_bf16 v[40:43], v[164:167], v[76:79], v[40:43]
    s_waitcnt lgkmcnt(6)
    v_mfma_f32_16x16x32_bf16 v[36:39], v[168:171], v[80:83], v[36:39]
    v_mfma_f32_16x16x32_bf16 v[40:43], v[168:171], v[84:87], v[40:43]
    s_setprio 0
    s_waitcnt lgkmcnt(4)
    v_mfma_f32_16x16x32_bf16 v[36:39], v[172:175], v[88:91], v[36:39]
    v_mfma_f32_16x16x32_bf16 v[40:43], v[172:175], v[92:95], v[40:43]
    s_nop 6
    v_mul_f32 v36, v36, v212
    v_mul_f32 v37, v37, v213
    v_mul_f32 v38, v38, v214
    v_mul_f32 v39, v39, v215
    v_cvt_pk_bf16_f32 v178, v36, v37
    v_cvt_pk_bf16_f32 v179, v38, v39
    v_mul_f32 v40, v40, v212
    v_mul_f32 v41, v41, v213
    v_mul_f32 v42, v42, v214
    v_mul_f32 v43, v43, v215
    v_cvt_pk_bf16_f32 v180, v40, v41
    v_cvt_pk_bf16_f32 v181, v42, v43
    ds_write_b64 v246, v[178:179] offset:256
    ds_write_b64 v255, v[180:181] offset:512
    s_waitcnt lgkmcnt(0)
    s_barrier
    ds_read_b128 v[192:195], v228 offset:3072
    ds_read_b128 v[196:199], v228 offset:4608
    ds_read_b128 v[200:203], v249
    s_waitcnt lgkmcnt(1)
    buffer_store_dwordx4 v[192:195], v229, s[12:15], s42 offen sc1
    buffer_store_dwordx4 v[196:199], v229, s[12:15], s43 offen sc1
K2_LASTROW:
    s_add_u32 s59, s20, 32
    s_cmp_ge_u32 s59, s22
    s_cbranch_scc1 K2_FIN
    s_waitcnt lgkmcnt(0)
    buffer_store_dwordx4 v[200:203], v229, s[12:15], s44 offen sc1
K2_FIN:
    s_endpgm
K2_MULTI:
    ds_read_b128 v[48:51], v222 offset:0
    ds_read_b128 v[52:55], v222 offset:64
    ds_read_b128 v[56:59], v222 offset:896
    ds_read_b128 v[60:63], v222 offset:960
    ds_read_b128 v[64:67], v223 offset:0
    ds_read_b128 v[68:71], v223 offset:64
    ds_read_b128 v[72:75], v223 offset:896
    ds_read_b128 v[76:79], v223 offset:960
    ds_read_b128 v[80:83], v222 offset:3072
    ds_read_b128 v[84:87], v222 offset:3136
    ds_read_b128 v[88:91], v222 offset:3968
    s_waitcnt vmcnt(19) lgkmcnt(9)
    v_mfma_f32_16x16x32_bf16 v[0:3], v[96:99], v[48:51], 0
    ds_read_b128 v[92:95], v222 offset:4032
    s_waitcnt vmcnt(18)
    v_mfma_f32_16x16x32_bf16 v[0:3], v[100:103], v[52:55], v[0:3]
    ds_read_b128 v[48:51], v223 offset:33280
    s_waitcnt vmcnt(17) lgkmcnt(9)
    v_mfma_f32_16x16x32_bf16 v[0:3], v[104:107], v[56:59], v[0:3]
    ds_read_b128 v[52:55], v223 offset:33344
    s_waitcnt vmcnt(16)
    v_mfma_f32_16x16x32_bf16 v[0:3], v[108:111], v[60:63], v[0:3]
    ds_read_b128 v[56:59], v223 offset:34176
    s_waitcnt vmcnt(15) lgkmcnt(9)
    v_mfma_f32_16x16x32_bf16 v[0:3], v[128:131], v[64:67], v[0:3]
    ds_read_b128 v[60:63], v223 offset:34240
    s_waitcnt vmcnt(14)
    v_mfma_f32_16x16x32_bf16 v[0:3], v[132:135], v[68:71], v[0:3]
    ds_read_b128 v[64:67], v232 offset:6144
    s_waitcnt vmcnt(13) lgkmcnt(9)
    v_mfma_f32_16x16x32_bf16 v[0:3], v[136:139], v[72:75], v[0:3]
    ds_read_b128 v[68:71], v232 offset:6208
    s_waitcnt vmcnt(12)
    v_mfma_f32_16x16x32_bf16 v[0:3], v[140:143], v[76:79], v[0:3]
    ds_read_b128 v[72:75], v232 offset:7040
    s_waitcnt lgkmcnt(9)
    v_mfma_f32_16x16x32_bf16 v[16:19], v[96:99], v[80:83], 0
    ds_read_b128 v[76:79], v232 offset:7104
    v_mfma_f32_16x16x32_bf16 v[16:19], v[100:103], v[84:87], v[16:19]
    ds_read_b128 v[80:83], v225 offset:0
    s_waitcnt lgkmcnt(9)
    v_mfma_f32_16x16x32_bf16 v[16:19], v[104:107], v[88:91], v[16:19]
    ds_read_b128 v[84:87], v225 offset:64
    v_mfma_f32_16x16x32_bf16 v[16:19], v[108:111], v[92:95], v[16:19]
    ds_read_b128 v[88:91], v225 offset:896
    s_waitcnt lgkmcnt(9)
    v_mfma_f32_16x16x32_bf16 v[16:19], v[128:131], v[48:51], v[16:19]
    ds_read_b128 v[92:95], v225 offset:960
    v_mfma_f32_16x16x32_bf16 v[16:19], v[132:135], v[52:55], v[16:19]
    ds_read_b128 v[48:51], v222 offset:128
    s_waitcnt lgkmcnt(9)
    v_mfma_f32_16x16x32_bf16 v[16:19], v[136:139], v[56:59], v[16:19]
    ds_read_b128 v[52:55], v222 offset:384
    v_mfma_f32_16x16x32_bf16 v[16:19], v[140:143], v[60:63], v[16:19]
    ds_read_b128 v[56:59], v222 offset:256
    s_waitcnt lgkmcnt(9)
    v_mfma_f32_16x16x32_bf16 v[32:35], v[96:99], v[64:67], 0
    ds_read_b128 v[60:63], v222 offset:192
    v_mfma_f32_16x16x32_bf16 v[32:35], v[100:103], v[68:71], v[32:35]
    ds_read_b128 v[64:67], v222 offset:448
    s_waitcnt lgkmcnt(9)
    v_mfma_f32_16x16x32_bf16 v[32:35], v[104:107], v[72:75], v[32:35]
    ds_read_b128 v[68:71], v222 offset:320
    v_mfma_f32_16x16x32_bf16 v[32:35], v[108:111], v[76:79], v[32:35]
    ds_read_b128 v[72:75], v222 offset:640
    s_waitcnt lgkmcnt(9)
    v_mfma_f32_16x16x32_bf16 v[32:35], v[128:131], v[80:83], v[32:35]
    ds_read_b128 v[76:79], v222 offset:512
    v_mfma_f32_16x16x32_bf16 v[32:35], v[132:135], v[84:87], v[32:35]
    ds_read_b128 v[80:83], v222 offset:768
    s_waitcnt lgkmcnt(9)
    v_mfma_f32_16x16x32_bf16 v[32:35], v[136:139], v[88:91], v[32:35]
    ds_read_b128 v[84:87], v222 offset:704
    v_mfma_f32_16x16x32_bf16 v[32:35], v[140:143], v[92:95], v[32:35]
    ds_read_b128 v[88:91], v222 offset:576
    s_waitcnt vmcnt(11) lgkmcnt(9)
    v_mfma_f32_16x16x32_bf16 v[4:7], v[112:115], v[48:51], 0
    ds_read_b128 v[92:95], v222 offset:832
    v_mfma_f32_16x16x32_bf16 v[8:11], v[112:115], v[52:55], 0
    ds_read_b128 v[48:51], v222 offset:1024
    s_waitcnt lgkmcnt(9)
    v_mfma_f32_16x16x32_bf16 v[12:15], v[112:115], v[56:59], 0
    ds_read_b128 v[52:55], v222 offset:1280
    s_waitcnt vmcnt(10)
    v_mfma_f32_16x16x32_bf16 v[4:7], v[116:119], v[60:63], v[4:7]
    ds_read_b128 v[56:59], v222 offset:1152
    s_waitcnt lgkmcnt(9)
    v_mfma_f32_16x16x32_bf16 v[8:11], v[116:119], v[64:67], v[8:11]
    ds_read_b128 v[60:63], v222 offset:1088
    v_mfma_f32_16x16x32_bf16 v[12:15], v[116:119], v[68:71], v[12:15]
    ds_read_b128 v[64:67], v222 offset:1344
    s_waitcnt vmcnt(9) lgkmcnt(9)
    v_mfma_f32_16x16x32_bf16 v[4:7], v[120:123], v[72:75], v[4:7]
    ds_read_b128 v[68:71], v222 offset:1216
    v_mfma_f32_16x16x32_bf16 v[8:11], v[120:123], v[76:79], v[8:11]
    ds_read_b128 v[72:75], v223 offset:128
    s_waitcnt lgkmcnt(9)
    v_mfma_f32_16x16x32_bf16 v[12:15], v[120:123], v[80:83], v[12:15]
    ds_read_b128 v[76:79], v223 offset:384
    s_waitcnt vmcnt(8)
    v_mfma_f32_16x16x32_bf16 v[4:7], v[124:127], v[84:87], v[4:7]
    ds_read_b128 v[80:83], v223 offset:256
    s_waitcnt lgkmcnt(9)
    v_mfma_f32_16x16x32_bf16 v[8:11], v[124:127], v[88:91], v[8:11]
    ds_read_b128 v[84:87], v223 offset:192
    v_mfma_f32_16x16x32_bf16 v[12:15], v[124:127], v[92:95], v[12:15]
    ds_read_b128 v[88:91], v223 offset:448
    s_waitcnt vmcnt(7) lgkmcnt(9)
    v_mfma_f32_16x16x32_bf16 v[4:7], v[144:147], v[48:51], v[4:7]
    ds_read_b128 v[92:95], v223 offset:320
    v_mfma_f32_16x16x32_bf16 v[8:11], v[144:147], v[52:55], v[8:11]
    ds_read_b128 v[48:51], v223 offset:640
    s_waitcnt lgkmcnt(9)
    v_mfma_f32_16x16x32_bf16 v[12:15], v[144:147], v[56:59], v[12:15]
    ds_read_b128 v[52:55], v223 offset:512
    s_waitcnt vmcnt(6)
    v_mfma_f32_16x16x32_bf16 v[4:7], v[148:151], v[60:63], v[4:7]
    ds_read_b128 v[56:59], v223 offset:768
    s_waitcnt lgkmcnt(9)
    v_mfma_f32_16x16x32_bf16 v[8:11], v[148:151], v[64:67], v[8:11]
    ds_read_b128 v[60:63], v223 offset:704
    v_mfma_f32_16x16x32_bf16 v[12:15], v[148:151], v[68:71], v[12:15]
    ds_read_b128 v[64:67], v223 offset:576
    s_waitcnt vmcnt(5) lgkmcnt(9)
    v_mfma_f32_16x16x32_bf16 v[4:7], v[152:155], v[72:75], v[4:7]
    ds_read_b128 v[68:71], v223 offset:832
    v_mfma_f32_16x16x32_bf16 v[8:11], v[152:155], v[76:79], v[8:11]
    ds_read_b128 v[72:75], v223 offset:1024
    s_waitcnt lgkmcnt(9)
    v_mfma_f32_16x16x32_bf16 v[12:15], v[152:155], v[80:83], v[12:15]
    ds_read_b128 v[76:79], v223 offset:1280
    s_waitcnt vmcnt(4)
    v_mfma_f32_16x16x32_bf16 v[4:7], v[156:159], v[84:87], v[4:7]
    ds_read_b128 v[80:83], v223 offset:1152
    s_waitcnt lgkmcnt(9)
    v_mfma_f32_16x16x32_bf16 v[8:11], v[156:159], v[88:91], v[8:11]
    ds_read_b128 v[84:87], v223 offset:1088
    v_mfma_f32_16x16x32_bf16 v[12:15], v[156:159], v[92:95], v[12:15]
    ds_read_b128 v[88:91], v223 offset:1344
    s_waitcnt vmcnt(3) lgkmcnt(9)
    v_mfma_f32_16x16x32_bf16 v[4:7], v[160:163], v[48:51], v[4:7]
    ds_read_b128 v[92:95], v223 offset:1216
    v_mfma_f32_16x16x32_bf16 v[8:11], v[160:163], v[52:55], v[8:11]
    ds_read_b128 v[48:51], v222 offset:3200
    s_waitcnt lgkmcnt(9)
    v_mfma_f32_16x16x32_bf16 v[12:15], v[160:163], v[56:59], v[12:15]
    ds_read_b128 v[52:55], v222 offset:3456
    s_waitcnt vmcnt(2)
    v_mfma_f32_16x16x32_bf16 v[4:7], v[164:167], v[60:63], v[4:7]
    ds_read_b128 v[56:59], v222 offset:3328
    s_waitcnt lgkmcnt(9)
    v_mfma_f32_16x16x32_bf16 v[8:11], v[164:167], v[64:67], v[8:11]
    ds_read_b128 v[60:63], v222 offset:3264
    v_mfma_f32_16x16x32_bf16 v[12:15], v[164:167], v[68:71], v[12:15]
    ds_read_b128 v[64:67], v222 offset:3520
    s_waitcnt vmcnt(1) lgkmcnt(9)
    v_mfma_f32_16x16x32_bf16 v[4:7], v[168:171], v[72:75], v[4:7]
    ds_read_b128 v[68:71], v222 offset:3392
    v_mfma_f32_16x16x32_bf16 v[8:11], v[168:171], v[76:79], v[8:11]
    ds_read_b128 v[72:75], v222 offset:3712
    s_waitcnt lgkmcnt(9)
    v_mfma_f32_16x16x32_bf16 v[12:15], v[168:171], v[80:83], v[12:15]
    ds_read_b128 v[76:79], v222 offset:3584
    s_waitcnt vmcnt(0)
    v_mfma_f32_16x16x32_bf16 v[4:7], v[172:175], v[84:87], v[4:7]
    ds_read_b128 v[80:83], v222 offset:3840
    s_waitcnt lgkmcnt(9)
    v_mfma_f32_16x16x32_bf16 v[8:11], v[172:175], v[88:91], v[8:11]
    ds_read_b128 v[84:87], v222 offset:3776
    v_mfma_f32_16x16x32_bf16 v[12:15], v[172:175], v[92:95], v[12:15]
    ds_read_b128 v[88:91], v222 offset:3648
    s_waitcnt lgkmcnt(9)
    v_mfma_f32_16x16x32_bf16 v[20:23], v[112:115], v[48:51], 0
    ds_read_b128 v[92:95], v222 offset:3904
    v_mfma_f32_16x16x32_bf16 v[24:27], v[112:115], v[52:55], 0
    ds_read_b128 v[48:51], v222 offset:4096
    s_waitcnt lgkmcnt(9)
    v_mfma_f32_16x16x32_bf16 v[28:31], v[112:115], v[56:59], 0
    ds_read_b128 v[52:55], v222 offset:4352
    v_mfma_f32_16x16x32_bf16 v[20:23], v[116:119], v[60:63], v[20:23]
    ds_read_b128 v[56:59], v222 offset:4224
    s_waitcnt lgkmcnt(9)
    v_mfma_f32_16x16x32_bf16 v[24:27], v[116:119], v[64:67], v[24:27]
    ds_read_b128 v[60:63], v222 offset:4160
    v_mfma_f32_16x16x32_bf16 v[28:31], v[116:119], v[68:71], v[28:31]
    ds_read_b128 v[64:67], v222 offset:4416
    s_waitcnt lgkmcnt(9)
    v_mfma_f32_16x16x32_bf16 v[20:23], v[120:123], v[72:75], v[20:23]
    ds_read_b128 v[68:71], v222 offset:4288
    v_mfma_f32_16x16x32_bf16 v[24:27], v[120:123], v[76:79], v[24:27]
    ds_read_b128 v[72:75], v223 offset:33408
    s_waitcnt lgkmcnt(9)
    v_mfma_f32_16x16x32_bf16 v[28:31], v[120:123], v[80:83], v[28:31]
    ds_read_b128 v[76:79], v223 offset:33664
    v_mfma_f32_16x16x32_bf16 v[20:23], v[124:127], v[84:87], v[20:23]
    ds_read_b128 v[80:83], v223 offset:33536
    s_waitcnt lgkmcnt(9)
    v_mfma_f32_16x16x32_bf16 v[24:27], v[124:127], v[88:91], v[24:27]
    ds_read_b128 v[84:87], v223 offset:33472
    v_mfma_f32_16x16x32_bf16 v[28:31], v[124:127], v[92:95], v[28:31]
    ds_read_b128 v[88:91], v223 offset:33728
    s_waitcnt lgkmcnt(9)
    v_mfma_f32_16x16x32_bf16 v[20:23], v[144:147], v[48:51], v[20:23]
    ds_read_b128 v[92:95], v223 offset:33600
    v_mfma_f32_16x16x32_bf16 v[24:27], v[144:147], v[52:55], v[24:27]
    ds_read_b128 v[48:51], v223 offset:33920
    s_waitcnt lgkmcnt(9)
    v_mfma_f32_16x16x32_bf16 v[28:31], v[144:147], v[56:59], v[28:31]
    ds_read_b128 v[52:55], v223 offset:33792
    v_mfma_f32_16x16x32_bf16 v[20:23], v[148:151], v[60:63], v[20:23]
    ds_read_b128 v[56:59], v223 offset:34048
    s_waitcnt lgkmcnt(9)
    v_mfma_f32_16x16x32_bf16 v[24:27], v[148:151], v[64:67], v[24:27]
    ds_read_b128 v[60:63], v223 offset:33984
    v_mfma_f32_16x16x32_bf16 v[28:31], v[148:151], v[68:71], v[28:31]
    ds_read_b128 v[64:67], v223 offset:33856
    s_waitcnt lgkmcnt(9)
    v_mfma_f32_16x16x32_bf16 v[20:23], v[152:155], v[72:75], v[20:23]
    ds_read_b128 v[68:71], v223 offset:34112
    v_mfma_f32_16x16x32_bf16 v[24:27], v[152:155], v[76:79], v[24:27]
    ds_read_b128 v[72:75], v223 offset:34304
    s_waitcnt lgkmcnt(9)
    v_mfma_f32_16x16x32_bf16 v[28:31], v[152:155], v[80:83], v[28:31]
    ds_read_b128 v[76:79], v223 offset:34560
    v_mfma_f32_16x16x32_bf16 v[20:23], v[156:159], v[84:87], v[20:23]
    ds_read_b128 v[80:83], v223 offset:34432
    s_waitcnt lgkmcnt(9)
    v_mfma_f32_16x16x32_bf16 v[24:27], v[156:159], v[88:91], v[24:27]
    ds_read_b128 v[84:87], v223 offset:34368
    v_mfma_f32_16x16x32_bf16 v[28:31], v[156:159], v[92:95], v[28:31]
    ds_read_b128 v[88:91], v223 offset:34624
    s_waitcnt lgkmcnt(9)
    v_mfma_f32_16x16x32_bf16 v[20:23], v[160:163], v[48:51], v[20:23]
    ds_read_b128 v[92:95], v223 offset:34496
    v_mfma_f32_16x16x32_bf16 v[24:27], v[160:163], v[52:55], v[24:27]
    ds_read_b128 v[48:51], v247 offset:6272
    s_waitcnt lgkmcnt(9)
    v_mfma_f32_16x16x32_bf16 v[28:31], v[160:163], v[56:59], v[28:31]
    ds_read_b128 v[52:55], v232 offset:6528
    v_mfma_f32_16x16x32_bf16 v[20:23], v[164:167], v[60:63], v[20:23]
    ds_read_b128 v[56:59], v247 offset:6336
    s_waitcnt lgkmcnt(9)
    v_mfma_f32_16x16x32_bf16 v[24:27], v[164:167], v[64:67], v[24:27]
    ds_read_b128 v[60:63], v232 offset:6592
    v_mfma_f32_16x16x32_bf16 v[28:31], v[164:167], v[68:71], v[28:31]
    ds_read_b128 v[64:67], v247 offset:6784
    s_waitcnt lgkmcnt(9)
    v_mfma_f32_16x16x32_bf16 v[20:23], v[168:171], v[72:75], v[20:23]
    ds_read_b128 v[68:71], v232 offset:6656
    v_mfma_f32_16x16x32_bf16 v[24:27], v[168:171], v[76:79], v[24:27]
    ds_read_b128 v[72:75], v247 offset:6848
    s_waitcnt lgkmcnt(9)
    v_mfma_f32_16x16x32_bf16 v[28:31], v[168:171], v[80:83], v[28:31]
    ds_read_b128 v[76:79], v232 offset:6720
    v_mfma_f32_16x16x32_bf16 v[20:23], v[172:175], v[84:87], v[20:23]
    ds_read_b128 v[80:83], v247 offset:7168
    s_waitcnt lgkmcnt(9)
    v_mfma_f32_16x16x32_bf16 v[24:27], v[172:175], v[88:91], v[24:27]
    ds_read_b128 v[84:87], v232 offset:7424
    v_mfma_f32_16x16x32_bf16 v[28:31], v[172:175], v[92:95], v[28:31]
    ds_read_b128 v[88:91], v247 offset:7232
    s_waitcnt lgkmcnt(9)
    v_mfma_f32_16x16x32_bf16 v[36:39], v[112:115], v[48:51], 0
    ds_read_b128 v[92:95], v232 offset:7488
    v_mfma_f32_16x16x32_bf16 v[40:43], v[112:115], v[52:55], 0
    ds_read_b128 v[48:51], v248 offset:128
    s_waitcnt lgkmcnt(9)
    v_mfma_f32_16x16x32_bf16 v[36:39], v[116:119], v[56:59], v[36:39]
    ds_read_b128 v[52:55], v225 offset:384
    v_mfma_f32_16x16x32_bf16 v[40:43], v[116:119], v[60:63], v[40:43]
    ds_read_b128 v[56:59], v248 offset:192
    s_waitcnt lgkmcnt(9)
    v_mfma_f32_16x16x32_bf16 v[36:39], v[120:123], v[64:67], v[36:39]
    ds_read_b128 v[60:63], v225 offset:448
    v_mfma_f32_16x16x32_bf16 v[40:43], v[120:123], v[68:71], v[40:43]
    ds_read_b128 v[64:67], v248 offset:640
    s_waitcnt lgkmcnt(9)
    v_mfma_f32_16x16x32_bf16 v[36:39], v[124:127], v[72:75], v[36:39]
    ds_read_b128 v[68:71], v225 offset:512
    v_mfma_f32_16x16x32_bf16 v[40:43], v[124:127], v[76:79], v[40:43]
    ds_read_b128 v[72:75], v248 offset:704
    s_waitcnt lgkmcnt(9)
    v_mfma_f32_16x16x32_bf16 v[36:39], v[144:147], v[80:83], v[36:39]
    ds_read_b128 v[76:79], v225 offset:576
    v_mfma_f32_16x16x32_bf16 v[40:43], v[144:147], v[84:87], v[40:43]
    ds_read_b128 v[80:83], v248 offset:1024
    s_waitcnt lgkmcnt(9)
    v_mfma_f32_16x16x32_bf16 v[36:39], v[148:151], v[88:91], v[36:39]
    ds_read_b128 v[84:87], v225 offset:1280
    v_mfma_f32_16x16x32_bf16 v[40:43], v[148:151], v[92:95], v[40:43]
    ds_read_b128 v[88:91], v248 offset:1088
    s_waitcnt lgkmcnt(9)
    v_mfma_f32_16x16x32_bf16 v[36:39], v[152:155], v[48:51], v[36:39]
    ds_read_b128 v[92:95], v225 offset:1344
    v_mfma_f32_16x16x32_bf16 v[40:43], v[152:155], v[52:55], v[40:43]
    s_waitcnt lgkmcnt(8)
    v_mfma_f32_16x16x32_bf16 v[36:39], v[156:159], v[56:59], v[36:39]
    v_mfma_f32_16x16x32_bf16 v[40:43], v[156:159], v[60:63], v[40:43]
    s_waitcnt lgkmcnt(6)
    v_mfma_f32_16x16x32_bf16 v[36:39], v[160:163], v[64:67], v[36:39]
    v_mfma_f32_16x16x32_bf16 v[40:43], v[160:163], v[68:71], v[40:43]
    s_waitcnt lgkmcnt(4)
    v_mfma_f32_16x16x32_bf16 v[36:39], v[164:167], v[72:75], v[36:39]
    v_mfma_f32_16x16x32_bf16 v[40:43], v[164:167], v[76:79], v[40:43]
    s_waitcnt lgkmcnt(2)
    v_mfma_f32_16x16x32_bf16 v[36:39], v[168:171], v[80:83], v[36:39]
    v_mfma_f32_16x16x32_bf16 v[40:43], v[168:171], v[84:87], v[40:43]
    s_waitcnt lgkmcnt(0)
    v_mfma_f32_16x16x32_bf16 v[36:39], v[172:175], v[88:91], v[36:39]
    v_mfma_f32_16x16x32_bf16 v[40:43], v[172:175], v[92:95], v[40:43]
    s_lshl_b32 s60, s54, 9
    s_lshl_b32 s61, s20, 6
    s_add_u32 s60, s60, s61
    s_mul_i32 s60, s60, 192
    s_add_u32 s60, s60, 10485760
    v_mul_u32_u24 v227, 96, v252
    s_cmp_lg_u32 s28, 0
    s_cbranch_scc1 K2_NOACC
    buffer_load_dwordx4 v[48:51], v227, s[8:11], s60 offen offset:0
    buffer_load_dwordx4 v[52:55], v227, s[8:11], s60 offen offset:16
    buffer_load_dwordx4 v[56:59], v227, s[8:11], s60 offen offset:32
    buffer_load_dwordx4 v[60:63], v227, s[8:11], s60 offen offset:48
    buffer_load_dwordx4 v[64:67], v227, s[8:11], s60 offen offset:64
    buffer_load_dwordx4 v[68:71], v227, s[8:11], s60 offen offset:80
    buffer_load_dwordx4 v[72:75], v227, s[8:11], s60 offen offset:96
    buffer_load_dwordx4 v[76:79], v227, s[8:11], s60 offen offset:112
    buffer_load_dwordx4 v[80:83], v227, s[8:11], s60 offen offset:128
    buffer_load_dwordx4 v[84:87], v227, s[8:11], s60 offen offset:144
    buffer_load_dwordx4 v[88:91], v227, s[8:11], s60 offen offset:160
    s_waitcnt vmcnt(0)
    v_add_f32 v0, v0, v48
    v_add_f32 v1, v1, v49
    v_add_f32 v2, v2, v50
    v_add_f32 v3, v3, v51
    v_add_f32 v4, v4, v52
    v_add_f32 v5, v5, v53
    v_add_f32 v6, v6, v54
    v_add_f32 v7, v7, v55
    v_add_f32 v8, v8, v56
    v_add_f32 v9, v9, v57
    v_add_f32 v10, v10, v58
    v_add_f32 v11, v11, v59
    v_add_f32 v12, v12, v60
    v_add_f32 v13, v13, v61
    v_add_f32 v14, v14, v62
    v_add_f32 v15, v15, v63
    v_add_f32 v16, v16, v64
    v_add_f32 v17, v17, v65
    v_add_f32 v18, v18, v66
    v_add_f32 v19, v19, v67
    v_add_f32 v20, v20, v68
    v_add_f32 v21, v21, v69
    v_add_f32 v22, v22, v70
    v_add_f32 v23, v23, v71
    v_add_f32 v24, v24, v72
    v_add_f32 v25, v25, v73
    v_add_f32 v26, v26, v74
    v_add_f32 v27, v27, v75
    v_add_f32 v28, v28, v76
    v_add_f32 v29, v29, v77
    v_add_f32 v30, v30, v78
    v_add_f32 v31, v31, v79
    v_add_f32 v32, v32, v80
    v_add_f32 v33, v33, v81
    v_add_f32 v34, v34, v82
    v_add_f32 v35, v35, v83
    v_add_f32 v36, v36, v84
    v_add_f32 v37, v37, v85
    v_add_f32 v38, v38, v86
    v_add_f32 v39, v39, v87
    v_add_f32 v40, v40, v88
    v_add_f32 v41, v41, v89
    v_add_f32 v42, v42, v90
    v_add_f32 v43, v43, v91
K2_NOACC:
    s_barrier
    s_cmp_eq_u32 s55, 0
    s_cbranch_scc1 K2_SPILL
    s_bfe_u32 s60, s20, 0x10002
    s_lshl_b32 s60, s60, 4
    s_add_u32 s59, s59, s60
    v_add_u32 v228, s59, v229
    s_mul_i32 s60, s20, 2080
    s_add_u32 s60, s60, 65536
    v_add_u32 v249, s60, v229
    s_mov_b32 s63, 0xbfb8aa3b
    s_add_u32 s40, s20, s21
    s_lshl_b32 s40, s40, 10
    s_add_u32 s41, s40, 8192
    s_add_u32 s42, s40, 16384
    s_add_u32 s43, s40, 24576
    s_add_u32 s44, s40, 32768
    v_mul_f32 v204, s63, v0
    v_mul_f32 v205, s63, v1
    v_mul_f32 v206, s63, v2
    v_mul_f32 v207, s63, v3
    v_exp_f32 v204, v204
    v_exp_f32 v205, v205
    v_exp_f32 v206, v206
    v_exp_f32 v207, v207
    v_add_f32 v204, 1.0, v204
    v_add_f32 v205, 1.0, v205
    v_add_f32 v206, 1.0, v206
    v_add_f32 v207, 1.0, v207
    v_rcp_f32 v204, v204
    v_rcp_f32 v205, v205
    v_rcp_f32 v206, v206
    v_rcp_f32 v207, v207
    v_cvt_pk_bf16_f32 v176, v0, v1
    v_cvt_pk_bf16_f32 v177, v2, v3
    v_mul_f32 v4, v4, v204
    v_mul_f32 v5, v5, v205
    v_mul_f32 v6, v6, v206
    v_mul_f32 v7, v7, v207
    v_cvt_pk_bf16_f32 v178, v4, v5
    v_cvt_pk_bf16_f32 v179, v6, v7
    v_mul_f32 v8, v8, v204
    v_mul_f32 v9, v9, v205
    v_mul_f32 v10, v10, v206
    v_mul_f32 v11, v11, v207
    v_cvt_pk_bf16_f32 v180, v8, v9
    v_cvt_pk_bf16_f32 v181, v10, v11
    v_mul_f32 v12, v12, v204
    v_mul_f32 v13, v13, v205
    v_mul_f32 v14, v14, v206
    v_mul_f32 v15, v15, v207
    v_cvt_pk_bf16_f32 v182, v12, v13
    v_cvt_pk_bf16_f32 v183, v14, v15
    ds_write_b64 v254, v[176:177] offset:0
    ds_write_b64 v254, v[178:179] offset:256
    ds_write_b64 v254, v[180:181] offset:512
    ds_write_b64 v254, v[182:183] offset:768
    s_waitcnt lgkmcnt(0)
    s_barrier
    ds_read_b128 v[192:195], v228 offset:0
    ds_read_b128 v[196:199], v228 offset:1536
    s_waitcnt lgkmcnt(0)
    buffer_store_dwordx4 v[192:195], v229, s[12:15], s40 offen sc1
    buffer_store_dwordx4 v[196:199], v229, s[12:15], s41 offen sc1
    v_mul_f32 v208, s63, v16
    v_mul_f32 v209, s63, v17
    v_mul_f32 v210, s63, v18
    v_mul_f32 v211, s63, v19
    v_exp_f32 v208, v208
    v_exp_f32 v209, v209
    v_exp_f32 v210, v210
    v_exp_f32 v211, v211
    v_add_f32 v208, 1.0, v208
    v_add_f32 v209, 1.0, v209
    v_add_f32 v210, 1.0, v210
    v_add_f32 v211, 1.0, v211
    v_rcp_f32 v208, v208
    v_rcp_f32 v209, v209
    v_rcp_f32 v210, v210
    v_rcp_f32 v211, v211
    v_cvt_pk_bf16_f32 v184, v16, v17
    v_cvt_pk_bf16_f32 v185, v18, v19
    v_mul_f32 v20, v20, v208
    v_mul_f32 v21, v21, v209
    v_mul_f32 v22, v22, v210
    v_mul_f32 v23, v23, v211
    v_cvt_pk_bf16_f32 v186, v20, v21
    v_cvt_pk_bf16_f32 v187, v22, v23
    v_mul_f32 v24, v24, v208
    v_mul_f32 v25, v25, v209
    v_mul_f32 v26, v26, v210
    v_mul_f32 v27, v27, v211
    v_cvt_pk_bf16_f32 v188, v24, v25
    v_cvt_pk_bf16_f32 v189, v26, v27
    v_mul_f32 v28, v28, v208
    v_mul_f32 v29, v29, v209
    v_mul_f32 v30, v30, v210
    v_mul_f32 v31, v31, v211
    v_cvt_pk_bf16_f32 v190, v28, v29
    v_cvt_pk_bf16_f32 v191, v30, v31
    ds_write_b64 v254, v[184:185] offset:3072
    ds_write_b64 v254, v[186:187] offset:3328
    ds_write_b64 v254, v[188:189] offset:3584
    ds_write_b64 v254, v[190:191] offset:3840
    s_waitcnt lgkmcnt(0)
    s_barrier
    ds_read_b128 v[192:195], v228 offset:3072
    ds_read_b128 v[196:199], v228 offset:4608
    s_waitcnt lgkmcnt(0)
    buffer_store_dwordx4 v[192:195], v229, s[12:15], s42 offen sc1
    buffer_store_dwordx4 v[196:199], v229, s[12:15], s43 offen sc1
    v_mul_f32 v212, s63, v32
    v_mul_f32 v213, s63, v33
    v_mul_f32 v214, s63, v34
    v_mul_f32 v215, s63, v35
    v_exp_f32 v212, v212
    v_exp_f32 v213, v213
    v_exp_f32 v214, v214
    v_exp_f32 v215, v215
    v_add_f32 v212, 1.0, v212
    v_add_f32 v213, 1.0, v213
    v_add_f32 v214, 1.0, v214
    v_add_f32 v215, 1.0, v215
    v_rcp_f32 v212, v212
    v_rcp_f32 v213, v213
    v_rcp_f32 v214, v214
    v_rcp_f32 v215, v215
    v_cvt_pk_bf16_f32 v220, v32, v33
    v_cvt_pk_bf16_f32 v221, v34, v35
    v_mul_f32 v36, v36, v212
    v_mul_f32 v37, v37, v213
    v_mul_f32 v38, v38, v214
    v_mul_f32 v39, v39, v215
    v_cvt_pk_bf16_f32 v178, v36, v37
    v_cvt_pk_bf16_f32 v179, v38, v39
    v_mul_f32 v40, v40, v212
    v_mul_f32 v41, v41, v213
    v_mul_f32 v42, v42, v214
    v_mul_f32 v43, v43, v215
    v_cvt_pk_bf16_f32 v180, v40, v41
    v_cvt_pk_bf16_f32 v181, v42, v43
    ds_write_b64 v255, v[220:221] offset:0
    ds_write_b64 v246, v[178:179] offset:256
    ds_write_b64 v255, v[180:181] offset:512
    s_waitcnt lgkmcnt(0)
    s_barrier
    ds_read_b128 v[200:203], v249
    s_branch K2_LASTROW
K2_SPILL:
    buffer_store_dwordx4 v[0:3], v227, s[8:11], s60 offen offset:0
    buffer_store_dwordx4 v[4:7], v227, s[8:11], s60 offen offset:16
    buffer_store_dwordx4 v[8:11], v227, s[8:11], s60 offen offset:32
    buffer_store_dwordx4 v[12:15], v227, s[8:11], s60 offen offset:48
    buffer_store_dwordx4 v[16:19], v227, s[8:11], s60 offen offset:64
    buffer_store_dwordx4 v[20:23], v227, s[8:11], s60 offen offset:80
    buffer_store_dwordx4 v[24:27], v227, s[8:11], s60 offen offset:96
    buffer_store_dwordx4 v[28:31], v227, s[8:11], s60 offen offset:112
    buffer_store_dwordx4 v[32:35], v227, s[8:11], s60 offen offset:128
    buffer_store_dwordx4 v[36:39], v227, s[8:11], s60 offen offset:144
    buffer_store_dwordx4 v[40:43], v227, s[8:11], s60 offen offset:160
    s_mov_b32 s28, 0
    s_waitcnt vmcnt(0)
    s_cmp_lt_u32 s24, s25
    s_cbranch_scc1 K2_LOAD
    s_add_u32 s23, s23, 20
    s_branch K2_WINDOW
KS_FLS:
    s_sub_u32 s25, s25, 1
    s_cbranch_scc1 K2_END
    v_mov_b32 v62, 163460
    ds_read_b32 v62, v62
    s_branch KS_JOIN2
K2_NOW0:
    buffer_load_dwordx4 v[76:79], v72, s[8:11], s67 offen sc1
    s_branch K2_W0
K2_WINDOW:
    s_mov_b32 s24, 0
    s_mov_b32 s25, 1
K2_LOAD:
    v_mbcnt_lo_u32_b32 v176, -1, 0
    v_mbcnt_hi_u32_b32 v176, -1, v176
    s_lshl_b32 s58, s20, 6
    v_add_u32 v177, s58, v176
    v_lshlrev_b32 v70, 4, v176
    s_mov_b32 s58, 7110656
    buffer_load_dwordx4 v[136:139], v70, s[8:11], s58 offen offset:0 sc1
    buffer_load_dwordx4 v[140:143], v70, s[8:11], s58 offen offset:1024 sc1
    s_mov_b32 s58, 7112704
    buffer_load_dwordx4 v[144:147], v70, s[8:11], s58 offen offset:0 sc1
    buffer_load_dwordx4 v[148:151], v70, s[8:11], s58 offen offset:1024 sc1
    s_mov_b32 s58, 7114752
    buffer_load_dwordx4 v[152:155], v70, s[8:11], s58 offen offset:0 sc1
    buffer_load_dwordx4 v[156:159], v70, s[8:11], s58 offen offset:1024 sc1
    s_mov_b32 s58, 7116800
    buffer_load_dwordx4 v[160:163], v70, s[8:11], s58 offen offset:0 sc1
    buffer_load_dwordx4 v[164:167], v70, s[8:11], s58 offen offset:1024 sc1
    s_mov_b32 s58, 7118848
    buffer_load_dwordx4 v[168:171], v70, s[8:11], s58 offen offset:0 sc1
    buffer_load_dwordx4 v[172:175], v70, s[8:11], s58 offen offset:1024 sc1
    s_mul_i32 s58, s20, 10400
    s_add_u32 s58, s58, 65536
    s_add_u32 s59, s58, 512
    v_and_b32 v76, 31, v176
    v_lshrrev_b32 v77, 5, v176
    v_mov_b32 v80, 0
    v_mul_u32_u24 v77, 2080, v77
    v_mov_b32 v81, 0xffff0000
    v_lshl_add_u32 v78, v76, 4, v77
    v_mov_b32 v82, 0
    v_add_u32 v78, s58, v78
    v_mov_b32 v83, v81
    v_add_u32 v85, 16, v176
    v_lshlrev_b32 v84, 5, v176
    v_lshrrev_b32 v85, 6, v85
    v_mul_u32_u24 v85, 1532, v85
    v_sub_u32 v84, v84, v85
    v_mov_b32 v85, -1
    v_add_u32 v84, s59, v84
    ds_write_b32 v84, v85 offset:0
    ds_write_b32 v84, v85 offset:2080
    ds_write_b32 v84, v85 offset:4160
    ds_write_b32 v84, v85 offset:6240
    ds_write_b32 v84, v85 offset:8320
    s_mov_b32 exec_hi, 0
    ds_write_b128 v78, v[80:83] offset:0
    ds_write_b128 v78, v[80:83] offset:2080
    ds_write_b128 v78, v[80:83] offset:4160
    ds_write_b128 v78, v[80:83] offset:6240
    ds_write_b128 v78, v[80:83] offset:8320
    s_mov_b32 exec_hi, -1
    s_cmp_lg_u32 s20, 7
    s_cbranch_scc1 K2_NOH
    v_mov_b32 v76, 0
    v_mov_b32 v77, -1
    v_lshlrev_b32 v78, 2, v176
    v_add_u32 v78, 163072, v78
    s_mov_b64 exec, 0x1ff
    ds_write_b32 v78, v76 offset:192
    s_mov_b32 exec_lo, -1
    ds_write_b32 v78, v77 offset:256
    s_mov_b64 exec, -1
    s_cmp_lg_u32 s24, 0
    s_cbranch_scc1 K2_NOH
    s_mov_b32 exec_hi, 0xffff
    ds_write_b32 v78, v76
    s_mov_b64 exec, 1
    ds_write_b32 v78, v76 offset:228
    s_mov_b64 exec, -1
K2_NOH:
    s_waitcnt lgkmcnt(0)
    s_barrier
    s_branch K2_CELLS
K2_LD_GEN:
    s_mov_b64 exec, s[42:43]
    s_cbranch_execz K2_LD_DONE
    buffer_load_dwordx4 v[4:7], v182, s[8:11], 0 offen sc1
    s_mov_b64 exec, s[44:45]
    s_cbranch_execz K2_LD_DONE
    buffer_load_dwordx4 v[8:11], v183, s[8:11], 0 offen sc1
    s_mov_b64 exec, s[46:47]
    s_cbranch_execz K2_LD_DONE
    buffer_load_dwordx4 v[12:15], v184, s[8:11], 0 offen sc1
    s_mov_b64 exec, s[48:49]
    s_cbranch_execz K2_LD_DONE
    buffer_load_dwordx4 v[16:19], v181, s[8:11], 0 offen offset:128 sc1
    s_mov_b64 exec, s[50:51]
    s_cbranch_execz K2_LD_DONE
    buffer_load_dwordx4 v[20:23], v181, s[8:11], 0 offen offset:160 sc1
    s_mov_b64 exec, s[90:91]
    s_cbranch_execz K2_LD_DONE
    buffer_load_dwordx4 v[24:27], v181, s[8:11], 0 offen offset:192 sc1
    s_mov_b64 exec, s[92:93]
    s_cbranch_execz K2_LD_DONE
    buffer_load_dwordx4 v[28:31], v181, s[8:11], 0 offen offset:224 sc1
    s_mov_b64 exec, s[94:95]
    s_cbranch_execz K2_LD_DONE
    buffer_load_dwordx4 v[32:35], v181, s[8:11], 0 offen offset:256 sc1
    s_mov_b64 exec, s[96:97]
    s_cbranch_execz K2_LD_DONE
    buffer_load_dwordx4 v[36:39], v181, s[8:11], 0 offen offset:288 sc1
    s_branch K2_LD_DONE
K2_WLATE:
    s_waitcnt vmcnt(0)
    v_lshlrev_b32 v96, 16, v136
    v_and_b32 v97, 0xffff0000, v136
    v_lshlrev_b32 v98, 16, v137
    v_and_b32 v99, 0xffff0000, v137
    v_lshlrev_b32 v100, 16, v138
    v_and_b32 v101, 0xffff0000, v138
    v_lshlrev_b32 v102, 16, v139
    v_and_b32 v103, 0xffff0000, v139
    v_lshlrev_b32 v104, 16, v140
    v_and_b32 v105, 0xffff0000, v140
    v_lshlrev_b32 v106, 16, v141
    v_and_b32 v107, 0xffff0000, v141
    v_lshlrev_b32 v108, 16, v142
    v_and_b32 v109, 0xffff0000, v142
    v_lshlrev_b32 v110, 16, v143
    v_and_b32 v111, 0xffff0000, v143
    v_lshlrev_b32 v112, 16, v144
    v_and_b32 v113, 0xffff0000, v144
    v_lshlrev_b32 v114, 16, v145
    v_and_b32 v115, 0xffff0000, v145
    v_lshlrev_b32 v116, 16, v146
    v_and_b32 v117, 0xffff0000, v146
    v_lshlrev_b32 v118, 16, v147
    v_and_b32 v119, 0xffff0000, v147
    v_lshlrev_b32 v120, 16, v148
    v_and_b32 v121, 0xffff0000, v148
    v_lshlrev_b32 v122, 16, v149
    v_and_b32 v123, 0xffff0000, v149
    v_lshlrev_b32 v124, 16, v150
    v_and_b32 v125, 0xffff0000, v150
    v_lshlrev_b32 v126, 16, v151
    v_and_b32 v127, 0xffff0000, v151
    v_lshlrev_b32 v128, 16, v152
    v_and_b32 v129, 0xffff0000, v152
    v_lshlrev_b32 v130, 16, v153
    v_and_b32 v131, 0xffff0000, v153
    v_lshlrev_b32 v132, 16, v154
    v_and_b32 v133, 0xffff0000, v154
    v_lshlrev_b32 v134, 16, v155
    v_and_b32 v135, 0xffff0000, v155
    v_lshlrev_b32 v136, 16, v156
    v_and_b32 v137, 0xffff0000, v156
    v_lshlrev_b32 v138, 16, v157
    v_and_b32 v139, 0xffff0000, v157
    v_lshlrev_b32 v140, 16, v158
    v_and_b32 v141, 0xffff0000, v158
    v_lshlrev_b32 v142, 16, v159
    v_and_b32 v143, 0xffff0000, v159
    v_lshlrev_b32 v144, 16, v160
    v_and_b32 v145, 0xffff0000, v160
    v_lshlrev_b32 v146, 16, v161
    v_and_b32 v147, 0xffff0000, v161
    v_lshlrev_b32 v148, 16, v162
    v_and_b32 v149, 0xffff0000, v162
    v_lshlrev_b32 v150, 16, v163
    v_and_b32 v151, 0xffff0000, v163
    v_lshlrev_b32 v152, 16, v164
    v_and_b32 v153, 0xffff0000, v164
    v_lshlrev_b32 v154, 16, v165
    v_and_b32 v155, 0xffff0000, v165
    v_lshlrev_b32 v156, 16, v166
    v_and_b32 v157, 0xffff0000, v166
    v_lshlrev_b32 v158, 16, v167
    v_and_b32 v159, 0xffff0000, v167
    v_lshlrev_b32 v160, 16, v168
    v_and_b32 v161, 0xffff0000, v168
    v_lshlrev_b32 v162, 16, v169
    v_and_b32 v163, 0xffff0000, v169
    v_lshlrev_b32 v164, 16, v170
    v_and_b32 v165, 0xffff0000, v170
    v_lshlrev_b32 v166, 16, v171
    v_and_b32 v167, 0xffff0000, v171
    v_lshlrev_b32 v168, 16, v172
    v_and_b32 v169, 0xffff0000, v172
    v_lshlrev_b32 v170, 16, v173
    v_and_b32 v171, 0xffff0000, v173
    v_lshlrev_b32 v172, 16, v174
    v_and_b32 v173, 0xffff0000, v174
    v_lshlrev_b32 v174, 16, v175
    v_and_b32 v175, 0xffff0000, v175
    s_branch K2_NOWRAW
K2_RT0:
    s_sub_u32 s60, s60, 1
    s_cbranch_scc1 K2_END
    buffer_load_dwordx4 v[0:3], v181, s[8:11], 0 offen offset:0 sc1
    s_waitcnt vmcnt(0)
    s_branch K2_CK0
K2_RT1:
    s_sub_u32 s60, s60, 1
    s_cbranch_scc1 K2_END
    buffer_load_dwordx4 v[4:7], v182, s[8:11], 0 offen sc1
    s_waitcnt vmcnt(0)
    s_branch K2_CK1
K2_RT2:
    s_sub_u32 s60, s60, 1
    s_cbranch_scc1 K2_END
    buffer_load_dwordx4 v[8:11], v183, s[8:11], 0 offen sc1
    s_waitcnt vmcnt(0)
    s_branch K2_CK2
K2_RT3:
    s_sub_u32 s60, s60, 1
    s_cbranch_scc1 K2_END
    buffer_load_dwordx4 v[12:15], v184, s[8:11], 0 offen sc1
    s_waitcnt vmcnt(0)
    s_branch K2_CK3
K2_RT4:
    s_sub_u32 s60, s60, 1
    s_cbranch_scc1 K2_END
    buffer_load_dwordx4 v[16:19], v181, s[8:11], 0 offen offset:128 sc1
    s_waitcnt vmcnt(0)
    s_branch K2_CK4
K2_RT5:
    s_sub_u32 s60, s60, 1
    s_cbranch_scc1 K2_END
    buffer_load_dwordx4 v[20:23], v181, s[8:11], 0 offen offset:160 sc1
    s_waitcnt vmcnt(0)
    s_branch K2_CK5
K2_RT6:
    s_sub_u32 s60, s60, 1
    s_cbranch_scc1 K2_END
    buffer_load_dwordx4 v[24:27], v181, s[8:11], 0 offen offset:192 sc1
    s_waitcnt vmcnt(0)
    s_branch K2_CK6
K2_RT7:
    s_sub_u32 s60, s60, 1
    s_cbranch_scc1 K2_END
    buffer_load_dwordx4 v[28:31], v181, s[8:11], 0 offen offset:224 sc1
    s_waitcnt vmcnt(0)
    s_branch K2_CK7
K2_RT8:
    s_sub_u32 s60, s60, 1
    s_cbranch_scc1 K2_END
    buffer_load_dwordx4 v[32:35], v181, s[8:11], 0 offen offset:256 sc1
    s_waitcnt vmcnt(0)
    s_branch K2_CK8
K2_RT9:
    s_sub_u32 s60, s60, 1
    s_cbranch_scc1 K2_END
    buffer_load_dwordx4 v[36:39], v181, s[8:11], 0 offen offset:288 sc1
    s_waitcnt vmcnt(0)
    s_branch K2_CK9
K2_RK_LOAD:
    s_waitcnt vmcnt(0)
    s_mov_b64 exec, s[40:41]
    s_cbranch_execz K2_RK_B
    v_lshrrev_b32 v50, 24, v3
    buffer_load_dword v40, v179, s[8:11], s66 offen offset:0
    v_mad_u32_u24 v50, v50, s58, v202
    v_and_b32 v3, 0xffffff, v3
    s_mov_b64 exec, s[42:43]
    s_cbranch_execz K2_RK_B
    v_lshrrev_b32 v51, 24, v7
    buffer_load_dword v41, v185, s[8:11], s66 offen
    v_mad_u32_u24 v51, v51, s58, v202
    v_and_b32 v7, 0xffffff, v7
    s_mov_b64 exec, s[44:45]
    s_cbranch_execz K2_RK_B
    v_lshrrev_b32 v52, 24, v11
    buffer_load_dword v42, v186, s[8:11], s66 offen
    v_mad_u32_u24 v52, v52, s58, v202
    v_and_b32 v11, 0xffffff, v11
    s_mov_b64 exec, s[46:47]
    s_cbranch_execz K2_RK_B
    v_lshrrev_b32 v53, 24, v15
    buffer_load_dword v43, v187, s[8:11], s66 offen
    v_mad_u32_u24 v53, v53, s58, v202
    v_and_b32 v15, 0xffffff, v15
    s_mov_b64 exec, s[48:49]
    s_cbranch_execz K2_RK_B
    v_lshrrev_b32 v54, 24, v19
    buffer_load_dword v44, v179, s[8:11], s66 offen offset:32
    v_mad_u32_u24 v54, v54, s58, v202
    v_and_b32 v19, 0xffffff, v19
    s_mov_b64 exec, s[50:51]
    s_cbranch_execz K2_RK_B
    v_lshrrev_b32 v55, 24, v23
    buffer_load_dword v45, v179, s[8:11], s66 offen offset:40
    v_mad_u32_u24 v55, v55, s58, v202
    v_and_b32 v23, 0xffffff, v23
    s_mov_b64 exec, s[90:91]
    s_cbranch_execz K2_RK_B
    v_lshrrev_b32 v56, 24, v27
    buffer_load_dword v46, v179, s[8:11], s66 offen offset:48
    v_mad_u32_u24 v56, v56, s58, v202
    v_and_b32 v27, 0xffffff, v27
    s_mov_b64 exec, s[92:93]
    s_cbranch_execz K2_RK_B
    v_lshrrev_b32 v57, 24, v31
    buffer_load_dword v47, v179, s[8:11], s66 offen offset:56
    v_mad_u32_u24 v57, v57, s58, v202
    v_and_b32 v31, 0xffffff, v31
    s_mov_b64 exec, s[94:95]
    s_cbranch_execz K2_RK_B
    v_lshrrev_b32 v58, 24, v35
    buffer_load_dword v48, v179, s[8:11], s66 offen offset:64
    v_mad_u32_u24 v58, v58, s58, v202
    v_and_b32 v35, 0xffffff, v35
    s_mov_b64 exec, s[96:97]
    s_cbranch_execz K2_RK_B
    v_lshrrev_b32 v59, 24, v39
    buffer_load_dword v49, v179, s[8:11], s66 offen offset:72
    v_mad_u32_u24 v59, v59, s58, v202
    v_and_b32 v39, 0xffffff, v39
K2_RK_B:
    s_mov_b64 exec, -1
    s_mul_i32 s62, s24, 48
    s_waitcnt vmcnt(0)
    v_subrev_u32 v40, s62, v40
    v_subrev_u32 v41, s62, v41
    v_subrev_u32 v42, s62, v42
    v_subrev_u32 v43, s62, v43
    v_subrev_u32 v44, s62, v44
    v_subrev_u32 v45, s62, v45
    v_subrev_u32 v46, s62, v46
    v_subrev_u32 v47, s62, v47
    v_subrev_u32 v48, s62, v48
    v_subrev_u32 v49, s62, v49
    s_branch K2_RK_DONE
K2_BIG:
    s_cmp_lg_u32 s24, 0
    s_cbranch_scc1 K2_TOK
    s_movk_i32 s26, 48
    v_mov_b32 v197, v193
    s_nop 1
    v_max_u32_dpp v197, v197, v197 row_shr:1 row_mask:0xf bank_mask:0xf bound_ctrl:0
    s_nop 1
    v_max_u32_dpp v197, v197, v197 row_shr:2 row_mask:0xf bank_mask:0xf bound_ctrl:0
    s_nop 1
    v_max_u32_dpp v197, v197, v197 row_shr:4 row_mask:0xf bank_mask:0xf bound_ctrl:0
    s_nop 1
    v_max_u32_dpp v197, v197, v197 row_shr:8 row_mask:0xf bank_mask:0xf bound_ctrl:0
    s_nop 1
    v_max_u32_dpp v197, v197, v197 row_bcast:15 row_mask:0xa bank_mask:0xf
    s_nop 1
    v_max_u32_dpp v197, v197, v197 row_bcast:31 row_mask:0xc bank_mask:0xf
    s_nop 0
    v_readlane_b32 s25, v197, 63
    s_nop 0
    s_add_u32 s25, s25, 47
    s_mul_i32 s25, s25, 43691
    s_lshr_b32 s25, s25, 21
    s_mov_b64 exec, s[40:41]
    s_cbranch_execz K2_SV_DONE
    buffer_store_dword v40, v179, s[8:11], s66 offen offset:0
    s_mov_b64 exec, s[42:43]
    s_cbranch_execz K2_SV_DONE
    buffer_store_dword v41, v185, s[8:11], s66 offen
    s_mov_b64 exec, s[44:45]
    s_cbranch_execz K2_SV_DONE
    buffer_store_dword v42, v186, s[8:11], s66 offen
    s_mov_b64 exec, s[46:47]
    s_cbranch_execz K2_SV_DONE
    buffer_store_dword v43, v187, s[8:11], s66 offen
    s_mov_b64 exec, s[48:49]
    s_cbranch_execz K2_SV_DONE
    buffer_store_dword v44, v179, s[8:11], s66 offen offset:32
    s_mov_b64 exec, s[50:51]
    s_cbranch_execz K2_SV_DONE
    buffer_store_dword v45, v179, s[8:11], s66 offen offset:40
    s_mov_b64 exec, s[90:91]
    s_cbranch_execz K2_SV_DONE
    buffer_store_dword v46, v179, s[8:11], s66 offen offset:48
    s_mov_b64 exec, s[92:93]
    s_cbranch_execz K2_SV_DONE
    buffer_store_dword v47, v179, s[8:11], s66 offen offset:56
    s_mov_b64 exec, s[94:95]
    s_cbranch_execz K2_SV_DONE
    buffer_store_dword v48, v179, s[8:11], s66 offen offset:64
    s_mov_b64 exec, s[96:97]
    s_cbranch_execz K2_SV_DONE
    buffer_store_dword v49, v179, s[8:11], s66 offen offset:72
K2_SV_DONE:
    s_mov_b64 exec, -1
    s_branch K2_TOK
K2_rare_1:
    s_cmp_eq_u32 s33, 4
    s_cbranch_scc1 K2_four_3
    s_mov_b32 s49, s48
    s_mov_b32 s51, s48
    s_xor_b32 s45, s44, 256
    s_xor_b32 s46, s44, 512
    s_xor_b32 s47, s44, 768
    s_branch K2_back_2
K2_four_3:
    s_add_u32 s50, s48, 256
    s_add_u32 s51, s48, 384
    s_mov_b32 s46, s44
    s_mov_b32 s47, s44
    s_branch K2_back_2
K2_a4_5:
    v_add_u32 v254, s48, v230
    ds_read_b32 v254, v254 offset:4
    s_lshr_b32 s65, s3, 27
    s_mul_i32 s66, s22, 2080
    s_lshl_b32 s65, s65, 9
    s_add_u32 s65, s65, s66
    s_add_u32 s65, s65, 65536
    s_mov_b32 m0, s65
    s_mov_b32 exec_hi, 0
    s_waitcnt lgkmcnt(0)
    v_or_b32 v254, v254, v231
    buffer_load_dwordx4 v254, s[16:19], 0 offen  lds
    s_mov_b32 exec_hi, -1
    s_branch K2_b4_7
K2_rare_14:
    s_cmp_eq_u32 s33, 4
    s_cbranch_scc1 K2_four_16
    s_mov_b32 s49, s48
    s_mov_b32 s51, s48
    s_xor_b32 s45, s44, 256
    s_xor_b32 s46, s44, 512
    s_xor_b32 s47, s44, 768
    s_branch K2_back_15
K2_four_16:
    s_add_u32 s50, s48, 256
    s_add_u32 s51, s48, 384
    s_mov_b32 s46, s44
    s_mov_b32 s47, s44
    s_branch K2_back_15
K2_a4_18:
    v_add_u32 v254, s48, v230
    ds_read_b32 v254, v254 offset:4
    s_lshr_b32 s65, s3, 27
    s_mul_i32 s66, s22, 2080
    s_lshl_b32 s65, s65, 9
    s_add_u32 s65, s65, s66
    s_add_u32 s65, s65, 65536
    s_mov_b32 m0, s65
    s_mov_b32 exec_hi, 0
    s_waitcnt lgkmcnt(0)
    v_or_b32 v254, v254, v231
    buffer_load_dwordx4 v254, s[16:19], 0 offen  lds
    s_mov_b32 exec_hi, -1
    s_branch K2_b4_20
K2_rare_27:
    s_cmp_eq_u32 s33, 4
    s_cbranch_scc1 K2_four_29
    s_mov_b32 s49, s48
    s_mov_b32 s51, s48
    s_xor_b32 s45, s44, 256
    s_xor_b32 s46, s44, 512
    s_xor_b32 s47, s44, 768
    s_branch K2_back_28
K2_four_29:
    s_add_u32 s50, s48, 256
    s_add_u32 s51, s48, 384
    s_mov_b32 s46, s44
    s_mov_b32 s47, s44
    s_branch K2_back_28
K2_a4_31:
    v_add_u32 v254, s48, v230
    ds_read_b32 v254, v254 offset:4
    s_lshr_b32 s65, s3, 27
    s_mul_i32 s66, s22, 2080
    s_lshl_b32 s65, s65, 9
    s_add_u32 s65, s65, s66
    s_add_u32 s65, s65, 65536
    s_mov_b32 m0, s65
    s_mov_b32 exec_hi, 0
    s_waitcnt lgkmcnt(0)
    v_or_b32 v254, v254, v231
    buffer_load_dwordx4 v254, s[16:19], 0 offen  lds
    s_mov_b32 exec_hi, -1
    s_branch K2_b4_33
K2_rare_40:
    s_cmp_eq_u32 s33, 4
    s_cbranch_scc1 K2_four_42
    s_mov_b32 s49, s48
    s_mov_b32 s51, s48
    s_xor_b32 s45, s44, 256
    s_xor_b32 s46, s44, 512
    s_xor_b32 s47, s44, 768
    s_branch K2_back_41
K2_four_42:
    s_add_u32 s50, s48, 256
    s_add_u32 s51, s48, 384
    s_mov_b32 s46, s44
    s_mov_b32 s47, s44
    s_branch K2_back_41
K2_a4_44:
    v_add_u32 v254, s48, v230
    ds_read_b32 v254, v254 offset:4
    s_lshr_b32 s65, s3, 27
    s_mul_i32 s66, s22, 2080
    s_lshl_b32 s65, s65, 9
    s_add_u32 s65, s65, s66
    s_add_u32 s65, s65, 65536
    s_mov_b32 m0, s65
    s_mov_b32 exec_hi, 0
    s_waitcnt lgkmcnt(0)
    v_or_b32 v254, v254, v231
    buffer_load_dwordx4 v254, s[16:19], 0 offen  lds
    s_mov_b32 exec_hi, -1
    s_branch K2_b4_46
K2_rare_51:
    s_cmp_eq_u32 s33, 4
    s_cbranch_scc1 K2_four_53
    s_mov_b32 s49, s48
    s_mov_b32 s51, s48
    s_xor_b32 s45, s44, 256
    s_xor_b32 s46, s44, 512
    s_xor_b32 s47, s44, 768
    s_branch K2_back_52
K2_four_53:
    s_add_u32 s50, s48, 256
    s_add_u32 s51, s48, 384
    s_mov_b32 s46, s44
    s_mov_b32 s47, s44
    s_branch K2_back_52
K2_rare_58:
    s_cmp_eq_u32 s33, 4
    s_cbranch_scc1 K2_four_60
    s_mov_b32 s49, s48
    s_mov_b32 s51, s48
    s_xor_b32 s45, s44, 256
    s_xor_b32 s46, s44, 512
    s_xor_b32 s47, s44, 768
    s_branch K2_back_59
K2_four_60:
    s_add_u32 s50, s48, 256
    s_add_u32 s51, s48, 384
    s_mov_b32 s46, s44
    s_mov_b32 s47, s44
    s_branch K2_back_59
K2_rare_65:
    s_cmp_eq_u32 s33, 4
    s_cbranch_scc1 K2_four_67
    s_mov_b32 s49, s48
    s_mov_b32 s51, s48
    s_xor_b32 s45, s44, 256
    s_xor_b32 s46, s44, 512
    s_xor_b32 s47, s44, 768
    s_branch K2_back_66
K2_four_67:
    s_add_u32 s50, s48, 256
    s_add_u32 s51, s48, 384
    s_mov_b32 s46, s44
    s_mov_b32 s47, s44
    s_branch K2_back_66
K2_U10:
    s_setprio 1
    s_add_u32 s38, s38, 1
    v_mov_b32 v254, s52
    v_mov_b32 v255, s38
    s_lshl_b32 s58, s38, 3
    s_add_u32 s58, s58, s20
    s_mov_b64 exec, 1
    ds_write_b32 v254, v255
    s_mov_b64 exec, -1
    s_cmp_lt_u32 s58, s22
    s_cbranch_scc0 K2_dyn_68
K2_back_69:
    s_waitcnt lgkmcnt(4)
    v_lshlrev_b32 v20, 16, v0
    v_and_b32 v21, 0xffff0000, v0
    v_lshlrev_b32 v22, 16, v1
    v_and_b32 v23, 0xffff0000, v1
    v_lshlrev_b32 v24, 16, v2
    v_and_b32 v25, 0xffff0000, v2
    v_lshlrev_b32 v26, 16, v3
    v_and_b32 v27, 0xffff0000, v3
    v_mul_f32_dpp v36, v16, v20 row_newbcast:8 row_mask:0xf bank_mask:0xf
    v_mul_f32_dpp v37, v16, v21 row_newbcast:9 row_mask:0xf bank_mask:0xf
    v_mul_f32_dpp v38, v16, v22 row_newbcast:10 row_mask:0xf bank_mask:0xf
    v_mul_f32_dpp v39, v16, v23 row_newbcast:11 row_mask:0xf bank_mask:0xf
    v_mul_f32_dpp v40, v16, v24 row_newbcast:12 row_mask:0xf bank_mask:0xf
    v_mul_f32_dpp v41, v16, v25 row_newbcast:13 row_mask:0xf bank_mask:0xf
    v_mul_f32_dpp v42, v16, v26 row_newbcast:14 row_mask:0xf bank_mask:0xf
    v_mul_f32_dpp v43, v16, v27 row_newbcast:15 row_mask:0xf bank_mask:0xf
    v_cvt_pk_bf16_f32 v68, v36, v37
    v_cvt_pk_bf16_f32 v69, v38, v39
    v_cvt_pk_bf16_f32 v70, v40, v41
    v_cvt_pk_bf16_f32 v71, v42, v43
    v_mul_f32_dpp v20, v16, v20 row_newbcast:0 row_mask:0xa bank_mask:0xf
    v_mul_f32_dpp v21, v16, v21 row_newbcast:1 row_mask:0xa bank_mask:0xf
    v_mul_f32_dpp v22, v16, v22 row_newbcast:2 row_mask:0xa bank_mask:0xf
    v_mul_f32_dpp v23, v16, v23 row_newbcast:3 row_mask:0xa bank_mask:0xf
    v_mul_f32_dpp v24, v16, v24 row_newbcast:4 row_mask:0xa bank_mask:0xf
    v_mul_f32_dpp v25, v16, v25 row_newbcast:5 row_mask:0xa bank_mask:0xf
    v_mul_f32_dpp v26, v16, v26 row_newbcast:6 row_mask:0xa bank_mask:0xf
    v_mul_f32_dpp v27, v16, v27 row_newbcast:7 row_mask:0xa bank_mask:0xf
    v_cvt_pk_bf16_f32 v64, v20, v21
    v_cvt_pk_bf16_f32 v65, v22, v23
    v_cvt_pk_bf16_f32 v66, v24, v25
    v_cvt_pk_bf16_f32 v67, v26, v27
    v_readlane_b32 s3, v253, s58
    s_lshl_b32 s44, s34, 7
    s_and_b32 s48, s3, 0x3ffff
    s_bfe_u32 s33, s3, 0x30013
    s_mul_i32 s35, s38, 6
    s_cmp_eq_u32 s34, 0
    s_cselect_b32 s35, s35, s48
    s_mov_b32 s45, s44
    s_xor_b32 s47, s44, 256
    s_add_u32 s49, s48, 128
    s_add_u32 s60, s48, 256
    s_cmp_eq_u32 s33, 3
    s_cselect_b32 s46, s44, s47
    s_cselect_b32 s50, s60, s48
    s_cselect_b32 s51, s48, s49
    s_sub_u32 s60, s33, 2
    s_cmp_lt_u32 s60, 2
    s_cbranch_scc0 K2_rare_74
K2_back_75:
    v_add_u32 v233, s48, v230
    ds_read_b32 v232, v233
    ds_read_b32 v233, v233 offset:1024
    v_add_u32 v222, s48, v251
    ds_read2_b32 v[222:223], v222 offset0:1 offset1:3
    v_add_u32 v224, s49, v251
    ds_read2_b32 v[224:225], v224 offset0:1 offset1:3
    v_add_u32 v226, s50, v251
    ds_read2_b32 v[226:227], v226 offset0:1 offset1:3
    v_add_u32 v228, s51, v251
    ds_read2_b32 v[228:229], v228 offset0:1 offset1:3
    s_waitcnt lgkmcnt(4)
    v_or_b32 v232, v232, v231
    v_or_b32 v233, v233, v231
    s_cmp_lg_u32 s34, 0
    s_cbranch_scc1 K2_dum_77
    s_cmp_eq_u32 s33, 4
    s_cbranch_scc1 K2_a4_78
K2_b4_80:
    s_add_u32 m0, s48, 512
    s_add_u32 s65, s48, 1536
    buffer_load_dwordx4 v232, s[16:19], 0 offen  lds
    s_mov_b32 m0, s65
    s_mov_b32 exec_hi, 0
    buffer_load_dwordx4 v233, s[16:19], 0 offen  lds
    s_mov_b32 exec_hi, -1
K2_back_79:
    s_waitcnt lgkmcnt(3)
    v_mad_u32_u16 v222, v222, s39, v248 op_sel:[1,0,0,0]
    v_mad_u32_u16 v223, v223, s39, v248 op_sel:[1,0,0,0]
    s_waitcnt lgkmcnt(2)
    v_mad_u32_u16 v224, v224, s39, v248 op_sel:[1,0,0,0]
    v_mad_u32_u16 v225, v225, s39, v248 op_sel:[1,0,0,0]
    s_waitcnt lgkmcnt(1)
    v_mad_u32_u16 v226, v226, s39, v248 op_sel:[1,0,0,0]
    v_mad_u32_u16 v227, v227, s39, v248 op_sel:[1,0,0,0]
    s_waitcnt lgkmcnt(0)
    v_mad_u32_u16 v228, v228, s39, v248 op_sel:[1,0,0,0]
    v_mad_u32_u16 v229, v229, s39, v248 op_sel:[1,0,0,0]
    s_waitcnt vmcnt(6)
    v_mfma_f32_32x32x16_bf16 v[0:15], v[64:67], v[176:179], 0
    ds_read_b64_tr_b16 v[184:185], v246 offset:2048
    ds_read_b64_tr_b16 v[186:187], v246 offset:3072
    ds_read_b64_tr_b16 v[188:189], v247 offset:2048
    ds_read_b64_tr_b16 v[190:191], v247 offset:3072
    s_mov_b32 m0, s68
    v_mfma_f32_32x32x16_bf16 v[16:31], v[68:71], v[176:179], 0
    buffer_load_dwordx4 v222, s[4:7], s44 offen sc1 lds
    buffer_load_dwordx4 v223, s[72:75], s44 offen offset:1024 sc1 lds
    v_permlane32_swap_b32 v242, v236
    v_permlane32_swap_b32 v243, v237
    v_mfma_f32_32x32x16_bf16 v[32:47], v[64:67], v[180:183], 0
    v_permlane32_swap_b32 v244, v238
    v_permlane32_swap_b32 v245, v239
    v_permlane32_swap_b32 v240, v241
    v_add_f32 v242, v242, v236
    v_mfma_f32_32x32x16_bf16 v[48:63], v[68:71], v[180:183], 0
    s_setprio 0
    v_add_f32 v243, v243, v237
    v_add_f32 v244, v244, v238
    v_add_f32 v245, v245, v239
    v_add_f32 v240, -v240, -v241
    s_set_gpr_idx_on s32, gpr_idx(DST)
    s_nop 0
    v_cvt_pk_bf16_f32 v195, v242, v243
    v_cvt_pk_bf16_f32 v196, v244, v245
    v_cvt_pk_bf16_f32 v197, v240, v240
    s_set_gpr_idx_off
    v_mul_f32 v234, v0, v96
    v_mul_f32 v236, v8, v128
    v_fmac_f32 v234, v1, v97
    v_fmac_f32 v236, v9, v129
    v_fmac_f32 v234, v2, v98
    v_fmac_f32 v236, v10, v130
    v_fmac_f32 v234, v3, v99
    v_fmac_f32 v236, v11, v131
    v_fmac_f32 v234, v4, v100
    v_fmac_f32 v236, v12, v132
    v_fmac_f32 v234, v5, v101
    v_fmac_f32 v236, v13, v133
    v_fmac_f32 v234, v6, v102
    v_fmac_f32 v236, v14, v134
    v_fmac_f32 v234, v7, v103
    v_fmac_f32 v236, v15, v135
    v_mul_f32 v238, v16, v128
    v_mul_f32 v240, v24, v128
    v_fmac_f32 v238, v17, v129
    v_fmac_f32 v240, v25, v129
    v_fmac_f32 v238, v18, v130
    v_fmac_f32 v240, v26, v130
    v_fmac_f32 v238, v19, v131
    v_fmac_f32 v240, v27, v131
    v_fmac_f32 v238, v20, v132
    v_fmac_f32 v240, v28, v132
    v_fmac_f32 v238, v21, v133
    v_fmac_f32 v240, v29, v133
    v_fmac_f32 v238, v22, v134
    v_fmac_f32 v240, v30, v134
    v_fmac_f32 v238, v23, v135
    v_fmac_f32 v240, v31, v135
    v_mul_f32 v235, v32, v104
    v_mul_f32 v237, v40, v136
    v_fmac_f32 v235, v33, v105
    v_fmac_f32 v237, v41, v137
    v_fmac_f32 v235, v34, v106
    v_fmac_f32 v237, v42, v138
    v_fmac_f32 v235, v35, v107
    v_fmac_f32 v237, v43, v139
    v_fmac_f32 v235, v36, v108
    v_fmac_f32 v237, v44, v140
    v_fmac_f32 v235, v37, v109
    v_fmac_f32 v237, v45, v141
    v_fmac_f32 v235, v38, v110
    v_fmac_f32 v237, v46, v142
    v_fmac_f32 v235, v39, v111
    v_fmac_f32 v237, v47, v143
    v_mul_f32 v239, v48, v136
    v_mul_f32 v241, v56, v136
    v_fmac_f32 v239, v49, v137
    v_fmac_f32 v241, v57, v137
    v_fmac_f32 v239, v50, v138
    v_fmac_f32 v241, v58, v138
    v_fmac_f32 v239, v51, v139
    v_fmac_f32 v241, v59, v139
    v_fmac_f32 v239, v52, v140
    v_fmac_f32 v241, v60, v140
    v_fmac_f32 v239, v53, v141
    v_fmac_f32 v241, v61, v141
    v_fmac_f32 v239, v54, v142
    v_fmac_f32 v241, v62, v142
    v_fmac_f32 v239, v55, v143
    v_fmac_f32 v241, v63, v143
    s_setprio 1
    s_waitcnt vmcnt(6) lgkmcnt(0)
    v_mfma_f32_32x32x16_bf16 v[0:15], v[64:67], v[184:187], 0
    ds_read_b64_tr_b16 v[176:177], v246 offset:4096
    ds_read_b64_tr_b16 v[178:179], v246 offset:5120
    ds_read_b64_tr_b16 v[180:181], v247 offset:4096
    ds_read_b64_tr_b16 v[182:183], v247 offset:5120
    s_mov_b32 m0, s69
    v_mfma_f32_32x32x16_bf16 v[16:31], v[68:71], v[184:187], 0
    buffer_load_dwordx4 v224, s[4:7], s45 offen sc1 lds
    buffer_load_dwordx4 v225, s[72:75], s45 offen offset:1024 sc1 lds
    v_permlane32_swap_b32 v234, v236
    v_permlane32_swap_b32 v235, v237
    v_mfma_f32_32x32x16_bf16 v[32:47], v[64:67], v[188:191], 0
    v_permlane32_swap_b32 v240, v238
    v_permlane32_swap_b32 v241, v239
    v_add_f32 v234, v234, v236
    v_add_f32 v235, v235, v237
    v_add_f32 v240, v240, v238
    v_mfma_f32_32x32x16_bf16 v[48:63], v[68:71], v[188:191], 0
    s_setprio 0
    v_add_f32 v241, v241, v239
    s_set_gpr_idx_on s31, gpr_idx(DST)
    s_nop 0
    v_cvt_pk_bf16_f32 v192, v234, v235
    v_cvt_pk_bf16_f32 v193, v240, v241
    s_set_gpr_idx_off
    v_mul_f32 v234, v0, v144
    v_mul_f32 v236, v8, v112
    v_fmac_f32 v234, v1, v145
    v_fmac_f32 v236, v9, v113
    v_fmac_f32 v234, v2, v146
    v_fmac_f32 v236, v10, v114
    v_fmac_f32 v234, v3, v147
    v_fmac_f32 v236, v11, v115
    v_fmac_f32 v234, v4, v148
    v_fmac_f32 v236, v12, v116
    v_fmac_f32 v234, v5, v149
    v_fmac_f32 v236, v13, v117
    v_fmac_f32 v234, v6, v150
    v_fmac_f32 v236, v14, v118
    v_fmac_f32 v234, v7, v151
    v_fmac_f32 v236, v15, v119
    v_mul_f32 v238, v16, v160
    v_mul_f32 v240, v24, v160
    v_fmac_f32 v238, v17, v161
    v_fmac_f32 v240, v25, v161
    v_fmac_f32 v238, v18, v162
    v_fmac_f32 v240, v26, v162
    v_fmac_f32 v238, v19, v163
    v_fmac_f32 v240, v27, v163
    v_fmac_f32 v238, v20, v164
    v_fmac_f32 v240, v28, v164
    v_fmac_f32 v238, v21, v165
    v_fmac_f32 v240, v29, v165
    v_fmac_f32 v238, v22, v166
    v_fmac_f32 v240, v30, v166
    v_fmac_f32 v238, v23, v167
    v_fmac_f32 v240, v31, v167
    v_mul_f32 v235, v32, v152
    v_mul_f32 v237, v40, v120
    v_fmac_f32 v235, v33, v153
    v_fmac_f32 v237, v41, v121
    v_fmac_f32 v235, v34, v154
    v_fmac_f32 v237, v42, v122
    v_fmac_f32 v235, v35, v155
    v_fmac_f32 v237, v43, v123
    v_fmac_f32 v235, v36, v156
    v_fmac_f32 v237, v44, v124
    v_fmac_f32 v235, v37, v157
    v_fmac_f32 v237, v45, v125
    v_fmac_f32 v235, v38, v158
    v_fmac_f32 v237, v46, v126
    v_fmac_f32 v235, v39, v159
    v_fmac_f32 v237, v47, v127
    v_mul_f32 v239, v48, v168
    v_mul_f32 v241, v56, v168
    v_fmac_f32 v239, v49, v169
    v_fmac_f32 v241, v57, v169
    v_fmac_f32 v239, v50, v170
    v_fmac_f32 v241, v58, v170
    v_fmac_f32 v239, v51, v171
    v_fmac_f32 v241, v59, v171
    v_fmac_f32 v239, v52, v172
    v_fmac_f32 v241, v60, v172
    v_fmac_f32 v239, v53, v173
    v_fmac_f32 v241, v61, v173
    v_fmac_f32 v239, v54, v174
    v_fmac_f32 v241, v62, v174
    v_fmac_f32 v239, v55, v175
    v_fmac_f32 v241, v63, v175
    s_setprio 1
    s_waitcnt vmcnt(6) lgkmcnt(0)
    v_mfma_f32_32x32x16_bf16 v[0:15], v[64:67], v[176:179], 0
    ds_read_b64_tr_b16 v[184:185], v246 offset:6144
    ds_read_b64_tr_b16 v[186:187], v246 offset:7168
    ds_read_b64_tr_b16 v[188:189], v247 offset:6144
    ds_read_b64_tr_b16 v[190:191], v247 offset:7168
    s_mov_b32 m0, s70
    v_mfma_f32_32x32x16_bf16 v[16:31], v[68:71], v[176:179], 0
    buffer_load_dwordx4 v226, s[4:7], s46 offen sc1 lds
    buffer_load_dwordx4 v227, s[72:75], s46 offen offset:1024 sc1 lds
    s_sub_u32 s26, s48, s29
    s_mov_b32 s29, s48
    s_mov_b32 s30, s3
    s_bfe_u32 s56, s3, 0x40012
    v_mfma_f32_32x32x16_bf16 v[32:47], v[64:67], v[180:183], 0
    s_cmp_eq_u32 s34, 0
    s_cselect_b32 s56, s56, 0
    v_mfma_f32_32x32x16_bf16 v[48:63], v[68:71], v[180:183], 0
    s_setprio 0
    v_mul_f32 v242, v0, v144
    v_fma_f32 v238, v8, v160, -v238
    v_fmac_f32 v242, v1, v145
    v_fmac_f32 v238, v9, v161
    v_fmac_f32 v242, v2, v146
    v_fmac_f32 v238, v10, v162
    v_fmac_f32 v242, v3, v147
    v_fmac_f32 v238, v11, v163
    v_fmac_f32 v242, v4, v148
    v_fmac_f32 v238, v12, v164
    v_fmac_f32 v242, v5, v149
    v_fmac_f32 v238, v13, v165
    v_fmac_f32 v242, v6, v150
    v_fmac_f32 v238, v14, v166
    v_fmac_f32 v242, v7, v151
    v_fmac_f32 v238, v15, v167
    v_fmac_f32 v236, v16, v112
    v_mul_f32 v244, v24, v160
    v_fmac_f32 v236, v17, v113
    v_fmac_f32 v244, v25, v161
    v_fmac_f32 v236, v18, v114
    v_fmac_f32 v244, v26, v162
    v_fmac_f32 v236, v19, v115
    v_fmac_f32 v244, v27, v163
    v_fmac_f32 v236, v20, v116
    v_fmac_f32 v244, v28, v164
    v_fmac_f32 v236, v21, v117
    v_fmac_f32 v244, v29, v165
    v_fmac_f32 v236, v22, v118
    v_fmac_f32 v244, v30, v166
    v_fmac_f32 v236, v23, v119
    v_fmac_f32 v244, v31, v167
    v_mul_f32 v243, v32, v152
    v_fma_f32 v239, v40, v168, -v239
    v_fmac_f32 v243, v33, v153
    v_fmac_f32 v239, v41, v169
    v_fmac_f32 v243, v34, v154
    v_fmac_f32 v239, v42, v170
    v_fmac_f32 v243, v35, v155
    v_fmac_f32 v239, v43, v171
    v_fmac_f32 v243, v36, v156
    v_fmac_f32 v239, v44, v172
    v_fmac_f32 v243, v37, v157
    v_fmac_f32 v239, v45, v173
    v_fmac_f32 v243, v38, v158
    v_fmac_f32 v239, v46, v174
    v_fmac_f32 v243, v39, v159
    v_fmac_f32 v239, v47, v175
    v_fmac_f32 v237, v48, v120
    v_mul_f32 v245, v56, v168
    v_fmac_f32 v237, v49, v121
    v_fmac_f32 v245, v57, v169
    v_fmac_f32 v237, v50, v122
    v_fmac_f32 v245, v58, v170
    v_fmac_f32 v237, v51, v123
    v_fmac_f32 v245, v59, v171
    v_fmac_f32 v237, v52, v124
    v_fmac_f32 v245, v60, v172
    v_fmac_f32 v237, v53, v125
    v_fmac_f32 v245, v61, v173
    v_fmac_f32 v237, v54, v126
    v_fmac_f32 v245, v62, v174
    v_fmac_f32 v237, v55, v127
    v_fmac_f32 v245, v63, v175
    s_setprio 1
    s_waitcnt vmcnt(4) lgkmcnt(0)
    v_mfma_f32_32x32x16_bf16 v[0:15], v[64:67], v[184:187], 0
    ds_read_b64_tr_b16 v[176:177], v246 offset:0
    ds_read_b64_tr_b16 v[178:179], v246 offset:1024
    ds_read_b64_tr_b16 v[180:181], v247 offset:0
    ds_read_b64_tr_b16 v[182:183], v247 offset:1024
    s_mov_b32 m0, s71
    v_mfma_f32_32x32x16_bf16 v[16:31], v[68:71], v[184:187], 0
    buffer_load_dwordx4 v228, s[4:7], s47 offen sc1 lds
    buffer_load_dwordx4 v229, s[72:75], s47 offen offset:1024 sc1 lds
    v_permlane32_swap_b32 v242, v234
    v_permlane32_swap_b32 v243, v235
    v_add_f32 v242, v242, v234
    v_mfma_f32_32x32x16_bf16 v[32:47], v[64:67], v[188:191], 0
    v_add_f32 v243, v243, v235
    s_set_gpr_idx_on s31, gpr_idx(DST)
    s_nop 0
    v_cvt_pk_bf16_f32 v194, v242, v243
    s_set_gpr_idx_off
    s_mov_b32 s32, s31
    s_mov_b32 s31, s35
    v_mfma_f32_32x32x16_bf16 v[48:63], v[68:71], v[188:191], 0
    s_setprio 0
    v_mul_f32 v242, v0, v144
    v_fma_f32 v240, v8, v160, -v240
    v_fmac_f32 v242, v1, v145
    v_fmac_f32 v240, v9, v161
    v_fmac_f32 v242, v2, v146
    v_fmac_f32 v240, v10, v162
    v_fmac_f32 v242, v3, v147
    v_fmac_f32 v240, v11, v163
    v_fmac_f32 v242, v4, v148
    v_fmac_f32 v240, v12, v164
    v_fmac_f32 v242, v5, v149
    v_fmac_f32 v240, v13, v165
    v_fmac_f32 v242, v6, v150
    v_fmac_f32 v240, v14, v166
    v_fmac_f32 v242, v7, v151
    v_fmac_f32 v240, v15, v167
    v_add_u32 v249, s26, v249
    v_add_u32 v250, s26, v250
    v_fma_f32 v244, v16, v160, -v244
    v_fmac_f32 v236, v24, v112
    v_fmac_f32 v244, v17, v161
    v_fmac_f32 v236, v25, v113
    v_fmac_f32 v244, v18, v162
    v_fmac_f32 v236, v26, v114
    v_fmac_f32 v244, v19, v163
    v_fmac_f32 v236, v27, v115
    v_fmac_f32 v244, v20, v164
    v_fmac_f32 v236, v28, v116
    v_fmac_f32 v244, v21, v165
    v_fmac_f32 v236, v29, v117
    v_fmac_f32 v244, v22, v166
    v_fmac_f32 v236, v30, v118
    v_fmac_f32 v244, v23, v167
    v_fmac_f32 v236, v31, v119
    ds_read_b64_tr_b16 v[0:1], v249 offset:0
    ds_read_b64_tr_b16 v[2:3], v249 offset:32
    ds_read_u16_d16_hi v16, v250 offset:0
    v_mul_f32 v243, v32, v152
    v_fma_f32 v241, v40, v168, -v241
    v_fmac_f32 v243, v33, v153
    v_fmac_f32 v241, v41, v169
    v_fmac_f32 v243, v34, v154
    v_fmac_f32 v241, v42, v170
    v_fmac_f32 v243, v35, v155
    v_fmac_f32 v241, v43, v171
    v_fmac_f32 v243, v36, v156
    v_fmac_f32 v241, v44, v172
    v_fmac_f32 v243, v37, v157
    v_fmac_f32 v241, v45, v173
    v_fmac_f32 v243, v38, v158
    v_fmac_f32 v241, v46, v174
    v_fmac_f32 v243, v39, v159
    v_fmac_f32 v241, v47, v175
    ds_read_b64_tr_b16 v[4:5], v249 offset:512
    ds_read_b64_tr_b16 v[6:7], v249 offset:544
    ds_read_u16_d16_hi v17, v250 offset:128
    v_fma_f32 v245, v48, v168, -v245
    v_fmac_f32 v237, v56, v120
    v_fmac_f32 v245, v49, v169
    v_fmac_f32 v237, v57, v121
    v_fmac_f32 v245, v50, v170
    v_fmac_f32 v237, v58, v122
    v_fmac_f32 v245, v51, v171
    v_fmac_f32 v237, v59, v123
    v_fmac_f32 v245, v52, v172
    v_fmac_f32 v237, v60, v124
    v_fmac_f32 v245, v53, v173
    v_fmac_f32 v237, v61, v125
    v_fmac_f32 v245, v54, v174
    v_fmac_f32 v237, v62, v126
    v_fmac_f32 v245, v55, v175
    v_fmac_f32 v237, v63, v127
    s_cmp_eq_u32 s56, 5
    s_cbranch_scc1 K2_U20
    s_cmp_eq_u32 s56, 6
    s_cbranch_scc1 K2_U3h0
    s_branch K2_DSP0
K2_U40:
    s_setprio 1
    ds_read_b64_tr_b16 v[8:9], v249 offset:1024
    ds_read_b64_tr_b16 v[10:11], v249 offset:1056
    ds_read_u16_d16_hi v18, v250 offset:256
    s_lshr_b32 s65, s30, 27
    s_mul_i32 s66, s22, 2080
    s_lshl_b32 s65, s65, 9
    s_add_u32 s65, s65, s66
    s_add_u32 s65, s65, 65536
    s_sub_u32 s65, s65, s29
    s_sub_u32 s65, s65, 512
    v_add_u32 v56, s65, v249
    ds_read_b64_tr_b16 v[12:13], v56 offset:0
    ds_read_b64_tr_b16 v[14:15], v56 offset:32
    ds_read_u16_d16_hi v19, v250 offset:384
    s_waitcnt lgkmcnt(6)
    v_lshlrev_b32 v20, 16, v0
    v_and_b32 v21, 0xffff0000, v0
    v_lshlrev_b32 v22, 16, v1
    v_and_b32 v23, 0xffff0000, v1
    v_lshlrev_b32 v24, 16, v2
    v_and_b32 v25, 0xffff0000, v2
    v_lshlrev_b32 v26, 16, v3
    v_and_b32 v27, 0xffff0000, v3
    v_mul_f32_dpp v36, v16, v20 row_newbcast:8 row_mask:0xf bank_mask:0xf
    v_mul_f32_dpp v37, v16, v21 row_newbcast:9 row_mask:0xf bank_mask:0xf
    v_mul_f32_dpp v38, v16, v22 row_newbcast:10 row_mask:0xf bank_mask:0xf
    v_mul_f32_dpp v39, v16, v23 row_newbcast:11 row_mask:0xf bank_mask:0xf
    v_mul_f32_dpp v40, v16, v24 row_newbcast:12 row_mask:0xf bank_mask:0xf
    v_mul_f32_dpp v41, v16, v25 row_newbcast:13 row_mask:0xf bank_mask:0xf
    v_mul_f32_dpp v42, v16, v26 row_newbcast:14 row_mask:0xf bank_mask:0xf
    v_mul_f32_dpp v43, v16, v27 row_newbcast:15 row_mask:0xf bank_mask:0xf
    v_cvt_pk_bf16_f32 v68, v36, v37
    v_cvt_pk_bf16_f32 v69, v38, v39
    v_cvt_pk_bf16_f32 v70, v40, v41
    v_cvt_pk_bf16_f32 v71, v42, v43
    v_mul_f32_dpp v20, v16, v20 row_newbcast:0 row_mask:0xa bank_mask:0xf
    v_mul_f32_dpp v21, v16, v21 row_newbcast:1 row_mask:0xa bank_mask:0xf
    v_mul_f32_dpp v22, v16, v22 row_newbcast:2 row_mask:0xa bank_mask:0xf
    v_mul_f32_dpp v23, v16, v23 row_newbcast:3 row_mask:0xa bank_mask:0xf
    v_mul_f32_dpp v24, v16, v24 row_newbcast:4 row_mask:0xa bank_mask:0xf
    v_mul_f32_dpp v25, v16, v25 row_newbcast:5 row_mask:0xa bank_mask:0xf
    v_mul_f32_dpp v26, v16, v26 row_newbcast:6 row_mask:0xa bank_mask:0xf
    v_mul_f32_dpp v27, v16, v27 row_newbcast:7 row_mask:0xa bank_mask:0xf
    v_cvt_pk_bf16_f32 v64, v20, v21
    v_cvt_pk_bf16_f32 v65, v22, v23
    v_cvt_pk_bf16_f32 v66, v24, v25
    v_cvt_pk_bf16_f32 v67, v26, v27
    v_lshlrev_b32 v28, 16, v4
    v_and_b32 v29, 0xffff0000, v4
    v_lshlrev_b32 v30, 16, v5
    v_and_b32 v31, 0xffff0000, v5
    v_lshlrev_b32 v32, 16, v6
    v_and_b32 v33, 0xffff0000, v6
    v_lshlrev_b32 v34, 16, v7
    v_and_b32 v35, 0xffff0000, v7
    v_mul_f32_dpp v36, v17, v28 row_newbcast:8 row_mask:0xf bank_mask:0xf
    v_mul_f32_dpp v37, v17, v29 row_newbcast:9 row_mask:0xf bank_mask:0xf
    v_mul_f32_dpp v38, v17, v30 row_newbcast:10 row_mask:0xf bank_mask:0xf
    v_mul_f32_dpp v39, v17, v31 row_newbcast:11 row_mask:0xf bank_mask:0xf
    v_mul_f32_dpp v40, v17, v32 row_newbcast:12 row_mask:0xf bank_mask:0xf
    v_mul_f32_dpp v41, v17, v33 row_newbcast:13 row_mask:0xf bank_mask:0xf
    v_mul_f32_dpp v42, v17, v34 row_newbcast:14 row_mask:0xf bank_mask:0xf
    v_mul_f32_dpp v43, v17, v35 row_newbcast:15 row_mask:0xf bank_mask:0xf
    v_cvt_pk_bf16_f32 v76, v36, v37
    v_cvt_pk_bf16_f32 v77, v38, v39
    v_cvt_pk_bf16_f32 v78, v40, v41
    v_cvt_pk_bf16_f32 v79, v42, v43
    v_mul_f32_dpp v28, v17, v28 row_newbcast:0 row_mask:0xa bank_mask:0xf
    v_mul_f32_dpp v29, v17, v29 row_newbcast:1 row_mask:0xa bank_mask:0xf
    v_mul_f32_dpp v30, v17, v30 row_newbcast:2 row_mask:0xa bank_mask:0xf
    v_mul_f32_dpp v31, v17, v31 row_newbcast:3 row_mask:0xa bank_mask:0xf
    v_mul_f32_dpp v32, v17, v32 row_newbcast:4 row_mask:0xa bank_mask:0xf
    v_mul_f32_dpp v33, v17, v33 row_newbcast:5 row_mask:0xa bank_mask:0xf
    v_mul_f32_dpp v34, v17, v34 row_newbcast:6 row_mask:0xa bank_mask:0xf
    v_mul_f32_dpp v35, v17, v35 row_newbcast:7 row_mask:0xa bank_mask:0xf
    v_cvt_pk_bf16_f32 v72, v28, v29
    v_cvt_pk_bf16_f32 v73, v30, v31
    v_cvt_pk_bf16_f32 v74, v32, v33
    v_cvt_pk_bf16_f32 v75, v34, v35
    s_waitcnt lgkmcnt(3)
    v_lshlrev_b32 v20, 16, v8
    v_and_b32 v21, 0xffff0000, v8
    v_lshlrev_b32 v22, 16, v9
    v_and_b32 v23, 0xffff0000, v9
    v_lshlrev_b32 v24, 16, v10
    v_and_b32 v25, 0xffff0000, v10
    v_lshlrev_b32 v26, 16, v11
    v_and_b32 v27, 0xffff0000, v11
    v_mul_f32_dpp v36, v18, v20 row_newbcast:8 row_mask:0xf bank_mask:0xf
    v_mul_f32_dpp v37, v18, v21 row_newbcast:9 row_mask:0xf bank_mask:0xf
    v_mul_f32_dpp v38, v18, v22 row_newbcast:10 row_mask:0xf bank_mask:0xf
    v_mul_f32_dpp v39, v18, v23 row_newbcast:11 row_mask:0xf bank_mask:0xf
    v_mul_f32_dpp v40, v18, v24 row_newbcast:12 row_mask:0xf bank_mask:0xf
    v_mul_f32_dpp v41, v18, v25 row_newbcast:13 row_mask:0xf bank_mask:0xf
    v_mul_f32_dpp v42, v18, v26 row_newbcast:14 row_mask:0xf bank_mask:0xf
    v_mul_f32_dpp v43, v18, v27 row_newbcast:15 row_mask:0xf bank_mask:0xf
    v_cvt_pk_bf16_f32 v84, v36, v37
    v_cvt_pk_bf16_f32 v85, v38, v39
    v_cvt_pk_bf16_f32 v86, v40, v41
    v_cvt_pk_bf16_f32 v87, v42, v43
    v_mul_f32_dpp v20, v18, v20 row_newbcast:0 row_mask:0xa bank_mask:0xf
    v_mul_f32_dpp v21, v18, v21 row_newbcast:1 row_mask:0xa bank_mask:0xf
    v_mul_f32_dpp v22, v18, v22 row_newbcast:2 row_mask:0xa bank_mask:0xf
    v_mul_f32_dpp v23, v18, v23 row_newbcast:3 row_mask:0xa bank_mask:0xf
    v_mul_f32_dpp v24, v18, v24 row_newbcast:4 row_mask:0xa bank_mask:0xf
    v_mul_f32_dpp v25, v18, v25 row_newbcast:5 row_mask:0xa bank_mask:0xf
    v_mul_f32_dpp v26, v18, v26 row_newbcast:6 row_mask:0xa bank_mask:0xf
    v_mul_f32_dpp v27, v18, v27 row_newbcast:7 row_mask:0xa bank_mask:0xf
    v_cvt_pk_bf16_f32 v80, v20, v21
    v_cvt_pk_bf16_f32 v81, v22, v23
    v_cvt_pk_bf16_f32 v82, v24, v25
    v_cvt_pk_bf16_f32 v83, v26, v27
    s_waitcnt lgkmcnt(0)
    v_lshlrev_b32 v28, 16, v12
    v_and_b32 v29, 0xffff0000, v12
    v_lshlrev_b32 v30, 16, v13
    v_and_b32 v31, 0xffff0000, v13
    v_lshlrev_b32 v32, 16, v14
    v_and_b32 v33, 0xffff0000, v14
    v_lshlrev_b32 v34, 16, v15
    v_and_b32 v35, 0xffff0000, v15
    v_mul_f32_dpp v36, v19, v28 row_newbcast:8 row_mask:0xf bank_mask:0xf
    v_mul_f32_dpp v37, v19, v29 row_newbcast:9 row_mask:0xf bank_mask:0xf
    v_mul_f32_dpp v38, v19, v30 row_newbcast:10 row_mask:0xf bank_mask:0xf
    v_mul_f32_dpp v39, v19, v31 row_newbcast:11 row_mask:0xf bank_mask:0xf
    v_mul_f32_dpp v40, v19, v32 row_newbcast:12 row_mask:0xf bank_mask:0xf
    v_mul_f32_dpp v41, v19, v33 row_newbcast:13 row_mask:0xf bank_mask:0xf
    v_mul_f32_dpp v42, v19, v34 row_newbcast:14 row_mask:0xf bank_mask:0xf
    v_mul_f32_dpp v43, v19, v35 row_newbcast:15 row_mask:0xf bank_mask:0xf
    v_cvt_pk_bf16_f32 v92, v36, v37
    v_cvt_pk_bf16_f32 v93, v38, v39
    v_cvt_pk_bf16_f32 v94, v40, v41
    v_cvt_pk_bf16_f32 v95, v42, v43
    v_mul_f32_dpp v28, v19, v28 row_newbcast:0 row_mask:0xa bank_mask:0xf
    v_mul_f32_dpp v29, v19, v29 row_newbcast:1 row_mask:0xa bank_mask:0xf
    v_mul_f32_dpp v30, v19, v30 row_newbcast:2 row_mask:0xa bank_mask:0xf
    v_mul_f32_dpp v31, v19, v31 row_newbcast:3 row_mask:0xa bank_mask:0xf
    v_mul_f32_dpp v32, v19, v32 row_newbcast:4 row_mask:0xa bank_mask:0xf
    v_mul_f32_dpp v33, v19, v33 row_newbcast:5 row_mask:0xa bank_mask:0xf
    v_mul_f32_dpp v34, v19, v34 row_newbcast:6 row_mask:0xa bank_mask:0xf
    v_mul_f32_dpp v35, v19, v35 row_newbcast:7 row_mask:0xa bank_mask:0xf
    v_cvt_pk_bf16_f32 v88, v28, v29
    v_cvt_pk_bf16_f32 v89, v30, v31
    v_cvt_pk_bf16_f32 v90, v32, v33
    v_cvt_pk_bf16_f32 v91, v34, v35
    s_waitcnt vmcnt(4)
    v_mfma_f32_32x32x16_bf16 v[0:15], v[64:67], v[176:179], 0
    ds_read_b64_tr_b16 v[184:185], v246 offset:2048
    ds_read_b64_tr_b16 v[186:187], v246 offset:3072
    ds_read_b64_tr_b16 v[188:189], v247 offset:2048
    ds_read_b64_tr_b16 v[190:191], v247 offset:3072
    s_mov_b32 m0, s68
    v_mfma_f32_32x32x16_bf16 v[16:31], v[68:71], v[176:179], 0
    buffer_load_dwordx4 v222, s[4:7], s41 offen sc1 lds
    buffer_load_dwordx4 v223, s[72:75], s41 offen offset:1024 sc1 lds
    v_permlane32_swap_b32 v242, v236
    v_permlane32_swap_b32 v243, v237
    s_add_u32 s38, s38, 1
    v_mfma_f32_32x32x16_bf16 v[32:47], v[64:67], v[180:183], 0
    v_permlane32_swap_b32 v244, v238
    v_permlane32_swap_b32 v245, v239
    v_permlane32_swap_b32 v240, v241
    v_add_f32 v242, v242, v236
    v_mfma_f32_32x32x16_bf16 v[48:63], v[68:71], v[180:183], 0
    v_add_f32 v243, v243, v237
    v_add_f32 v244, v244, v238
    v_add_f32 v245, v245, v239
    v_add_f32 v240, -v240, -v241
    v_mov_b32 v254, s52
    v_mov_b32 v255, s38
    s_waitcnt vmcnt(4) lgkmcnt(0)
    v_mfma_f32_32x32x16_bf16 v[0:15], v[72:75], v[184:187], v[0:15]
    ds_read_b64_tr_b16 v[176:177], v246 offset:4096
    ds_read_b64_tr_b16 v[178:179], v246 offset:5120
    ds_read_b64_tr_b16 v[180:181], v247 offset:4096
    ds_read_b64_tr_b16 v[182:183], v247 offset:5120
    s_lshl_b32 s58, s38, 3
    s_add_u32 s58, s58, s20
    s_mov_b32 m0, s69
    v_mfma_f32_32x32x16_bf16 v[16:31], v[76:79], v[184:187], v[16:31]
    buffer_load_dwordx4 v224, s[4:7], s41 offen sc1 lds
    buffer_load_dwordx4 v225, s[72:75], s41 offen offset:1024 sc1 lds
    s_set_gpr_idx_on s32, gpr_idx(DST)
    s_nop 0
    v_cvt_pk_bf16_f32 v195, v242, v243
    v_cvt_pk_bf16_f32 v196, v244, v245
    v_cvt_pk_bf16_f32 v197, v240, v240
    s_set_gpr_idx_off
    s_mov_b64 exec, 1
    ds_write_b32 v254, v255
    s_mov_b64 exec, -1
    s_cmp_lt_u32 s58, s22
    s_cbranch_scc0 K2_dyn_81
K2_back_82:
    v_readlane_b32 s3, v253, s58
    s_lshl_b32 s44, s34, 7
    s_and_b32 s48, s3, 0x3ffff
    s_bfe_u32 s33, s3, 0x30013
    s_mul_i32 s35, s38, 6
    s_cmp_eq_u32 s34, 0
    s_cselect_b32 s35, s35, s48
    s_mov_b32 s45, s44
    s_xor_b32 s47, s44, 256
    s_add_u32 s49, s48, 128
    s_add_u32 s60, s48, 256
    s_cmp_eq_u32 s33, 3
    s_cselect_b32 s46, s44, s47
    s_cselect_b32 s50, s60, s48
    s_cselect_b32 s51, s48, s49
    s_sub_u32 s60, s33, 2
    s_cmp_lt_u32 s60, 2
    s_cbranch_scc0 K2_rare_87
K2_back_88:
    v_mfma_f32_32x32x16_bf16 v[32:47], v[72:75], v[188:191], v[32:47]
    v_add_u32 v233, s48, v230
    ds_read_b32 v232, v233
    ds_read_b32 v233, v233 offset:1024
    v_mfma_f32_32x32x16_bf16 v[48:63], v[76:79], v[188:191], v[48:63]
    s_waitcnt vmcnt(4) lgkmcnt(3)
    v_mfma_f32_32x32x16_bf16 v[0:15], v[80:83], v[176:179], v[0:15]
    ds_read_b64_tr_b16 v[184:185], v246 offset:6144
    ds_read_b64_tr_b16 v[186:187], v246 offset:7168
    ds_read_b64_tr_b16 v[188:189], v247 offset:6144
    ds_read_b64_tr_b16 v[190:191], v247 offset:7168
    s_mov_b32 m0, s70
    v_mfma_f32_32x32x16_bf16 v[16:31], v[84:87], v[176:179], v[16:31]
    buffer_load_dwordx4 v226, s[4:7], s41 offen sc1 lds
    buffer_load_dwordx4 v227, s[72:75], s41 offen offset:1024 sc1 lds
    v_mfma_f32_32x32x16_bf16 v[32:47], v[80:83], v[180:183], v[32:47]
    v_mfma_f32_32x32x16_bf16 v[48:63], v[84:87], v[180:183], v[48:63]
    s_waitcnt lgkmcnt(4)
    v_or_b32 v232, v232, v231
    v_or_b32 v233, v233, v231
    s_cmp_lg_u32 s34, 0
    s_cbranch_scc1 K2_dum_90
    s_cmp_eq_u32 s33, 4
    s_cbranch_scc1 K2_a4_91
K2_b4_93:
    s_add_u32 m0, s48, 512
    s_add_u32 s65, s48, 1536
    buffer_load_dwordx4 v232, s[16:19], 0 offen  lds
    s_mov_b32 m0, s65
    s_mov_b32 exec_hi, 0
    buffer_load_dwordx4 v233, s[16:19], 0 offen  lds
    s_mov_b32 exec_hi, -1
K2_back_92:
    s_waitcnt vmcnt(6) lgkmcnt(0)
    v_mfma_f32_32x32x16_bf16 v[0:15], v[88:91], v[184:187], v[0:15]
    ds_read_b64_tr_b16 v[176:177], v246 offset:0
    ds_read_b64_tr_b16 v[178:179], v246 offset:1024
    ds_read_b64_tr_b16 v[180:181], v247 offset:0
    ds_read_b64_tr_b16 v[182:183], v247 offset:1024
    s_mov_b32 m0, s71
    v_mfma_f32_32x32x16_bf16 v[16:31], v[92:95], v[184:187], v[16:31]
    buffer_load_dwordx4 v228, s[4:7], s41 offen sc1 lds
    buffer_load_dwordx4 v229, s[72:75], s41 offen offset:1024 sc1 lds
    v_mfma_f32_32x32x16_bf16 v[32:47], v[88:91], v[188:191], v[32:47]
    s_nop 2
    v_mul_f32 v234, v0, v96
    v_mul_f32 v236, v8, v128
    v_fmac_f32 v234, v1, v97
    v_fmac_f32 v236, v9, v129
    v_fmac_f32 v234, v2, v98
    v_fmac_f32 v236, v10, v130
    v_fmac_f32 v234, v3, v99
    v_mfma_f32_32x32x16_bf16 v[48:63], v[92:95], v[188:191], v[48:63]
    s_setprio 0
    v_fmac_f32 v236, v11, v131
    v_fmac_f32 v234, v4, v100
    v_fmac_f32 v236, v12, v132
    v_fmac_f32 v234, v5, v101
    v_fmac_f32 v236, v13, v133
    v_fmac_f32 v234, v6, v102
    v_fmac_f32 v236, v14, v134
    v_fmac_f32 v234, v7, v103
    v_fmac_f32 v236, v15, v135
    v_mul_f32 v238, v16, v128
    v_mul_f32 v240, v24, v128
    v_fmac_f32 v238, v17, v129
    v_fmac_f32 v240, v25, v129
    v_fmac_f32 v238, v18, v130
    v_fmac_f32 v240, v26, v130
    v_fmac_f32 v238, v19, v131
    v_fmac_f32 v240, v27, v131
    v_fmac_f32 v238, v20, v132
    v_fmac_f32 v240, v28, v132
    v_fmac_f32 v238, v21, v133
    v_fmac_f32 v240, v29, v133
    v_fmac_f32 v238, v22, v134
    v_fmac_f32 v240, v30, v134
    v_fmac_f32 v238, v23, v135
    v_fmac_f32 v240, v31, v135
    v_mul_f32 v235, v32, v104
    v_mul_f32 v237, v40, v136
    v_fmac_f32 v235, v33, v105
    v_fmac_f32 v237, v41, v137
    v_fmac_f32 v235, v34, v106
    v_fmac_f32 v237, v42, v138
    v_fmac_f32 v235, v35, v107
    v_fmac_f32 v237, v43, v139
    v_fmac_f32 v235, v36, v108
    v_fmac_f32 v237, v44, v140
    v_fmac_f32 v235, v37, v109
    v_fmac_f32 v237, v45, v141
    v_fmac_f32 v235, v38, v110
    v_fmac_f32 v237, v46, v142
    v_fmac_f32 v235, v39, v111
    v_fmac_f32 v237, v47, v143
    v_mul_f32 v239, v48, v136
    v_mul_f32 v241, v56, v136
    s_setprio 1
    s_waitcnt vmcnt(6) lgkmcnt(0)
    v_mfma_f32_32x32x16_bf16 v[0:15], v[64:67], v[176:179], 0
    ds_read_b64_tr_b16 v[184:185], v246 offset:2048
    ds_read_b64_tr_b16 v[186:187], v246 offset:3072
    ds_read_b64_tr_b16 v[188:189], v247 offset:2048
    ds_read_b64_tr_b16 v[190:191], v247 offset:3072
    v_fmac_f32 v239, v49, v137
    v_fmac_f32 v241, v57, v137
    s_mov_b32 m0, s68
    v_mfma_f32_32x32x16_bf16 v[16:31], v[68:71], v[176:179], 0
    buffer_load_dwordx4 v222, s[4:7], s42 offen sc1 lds
    buffer_load_dwordx4 v223, s[72:75], s42 offen offset:1024 sc1 lds
    v_fmac_f32 v239, v50, v138
    v_fmac_f32 v241, v58, v138
    v_fmac_f32 v239, v51, v139
    v_fmac_f32 v241, v59, v139
    v_fmac_f32 v239, v52, v140
    v_mfma_f32_32x32x16_bf16 v[32:47], v[64:67], v[180:183], 0
    v_fmac_f32 v241, v60, v140
    v_fmac_f32 v239, v53, v141
    v_fmac_f32 v241, v61, v141
    v_fmac_f32 v239, v54, v142
    v_fmac_f32 v241, v62, v142
    v_fmac_f32 v239, v55, v143
    v_fmac_f32 v241, v63, v143
    v_mfma_f32_32x32x16_bf16 v[48:63], v[68:71], v[180:183], 0
    v_permlane32_swap_b32 v234, v236
    v_permlane32_swap_b32 v235, v237
    v_permlane32_swap_b32 v240, v238
    s_waitcnt vmcnt(6) lgkmcnt(0)
    v_mfma_f32_32x32x16_bf16 v[0:15], v[72:75], v[184:187], v[0:15]
    ds_read_b64_tr_b16 v[176:177], v246 offset:4096
    ds_read_b64_tr_b16 v[178:179], v246 offset:5120
    ds_read_b64_tr_b16 v[180:181], v247 offset:4096
    ds_read_b64_tr_b16 v[182:183], v247 offset:5120
    v_permlane32_swap_b32 v241, v239
    s_mov_b32 m0, s69
    v_mfma_f32_32x32x16_bf16 v[16:31], v[76:79], v[184:187], v[16:31]
    buffer_load_dwordx4 v224, s[4:7], s42 offen sc1 lds
    buffer_load_dwordx4 v225, s[72:75], s42 offen offset:1024 sc1 lds
    v_add_f32 v234, v234, v236
    v_add_f32 v235, v235, v237
    v_add_f32 v240, v240, v238
    v_add_f32 v241, v241, v239
    v_mfma_f32_32x32x16_bf16 v[32:47], v[72:75], v[188:191], v[32:47]
    s_set_gpr_idx_on s31, gpr_idx(DST)
    s_nop 0
    v_cvt_pk_bf16_f32 v192, v234, v235
    v_cvt_pk_bf16_f32 v193, v240, v241
    s_set_gpr_idx_off
    v_mfma_f32_32x32x16_bf16 v[48:63], v[76:79], v[188:191], v[48:63]
    s_waitcnt vmcnt(4) lgkmcnt(0)
    v_mfma_f32_32x32x16_bf16 v[0:15], v[80:83], v[176:179], v[0:15]
    ds_read_b64_tr_b16 v[184:185], v246 offset:6144
    ds_read_b64_tr_b16 v[186:187], v246 offset:7168
    ds_read_b64_tr_b16 v[188:189], v247 offset:6144
    ds_read_b64_tr_b16 v[190:191], v247 offset:7168
    s_mov_b32 m0, s70
    v_mfma_f32_32x32x16_bf16 v[16:31], v[84:87], v[176:179], v[16:31]
    buffer_load_dwordx4 v226, s[4:7], s42 offen sc1 lds
    buffer_load_dwordx4 v227, s[72:75], s42 offen offset:1024 sc1 lds
    v_mfma_f32_32x32x16_bf16 v[32:47], v[80:83], v[180:183], v[32:47]
    v_mfma_f32_32x32x16_bf16 v[48:63], v[84:87], v[180:183], v[48:63]
    s_waitcnt vmcnt(4) lgkmcnt(0)
    v_mfma_f32_32x32x16_bf16 v[0:15], v[88:91], v[184:187], v[0:15]
    ds_read_b64_tr_b16 v[176:177], v246 offset:0
    ds_read_b64_tr_b16 v[178:179], v246 offset:1024
    ds_read_b64_tr_b16 v[180:181], v247 offset:0
    ds_read_b64_tr_b16 v[182:183], v247 offset:1024
    s_mov_b32 m0, s71
    v_mfma_f32_32x32x16_bf16 v[16:31], v[92:95], v[184:187], v[16:31]
    buffer_load_dwordx4 v228, s[4:7], s42 offen sc1 lds
    buffer_load_dwordx4 v229, s[72:75], s42 offen offset:1024 sc1 lds
    v_mfma_f32_32x32x16_bf16 v[32:47], v[88:91], v[188:191], v[32:47]
    s_nop 2
    v_mul_f32 v234, v0, v144
    v_mul_f32 v236, v8, v112
    v_fmac_f32 v234, v1, v145
    v_fmac_f32 v236, v9, v113
    v_fmac_f32 v234, v2, v146
    v_fmac_f32 v236, v10, v114
    v_fmac_f32 v234, v3, v147
    v_mfma_f32_32x32x16_bf16 v[48:63], v[92:95], v[188:191], v[48:63]
    s_setprio 0
    v_fmac_f32 v236, v11, v115
    v_fmac_f32 v234, v4, v148
    v_fmac_f32 v236, v12, v116
    v_fmac_f32 v234, v5, v149
    v_fmac_f32 v236, v13, v117
    v_fmac_f32 v234, v6, v150
    v_fmac_f32 v236, v14, v118
    v_fmac_f32 v234, v7, v151
    v_fmac_f32 v236, v15, v119
    v_mul_f32 v238, v16, v160
    v_mul_f32 v240, v24, v160
    v_fmac_f32 v238, v17, v161
    v_fmac_f32 v240, v25, v161
    v_fmac_f32 v238, v18, v162
    v_fmac_f32 v240, v26, v162
    v_fmac_f32 v238, v19, v163
    v_fmac_f32 v240, v27, v163
    v_fmac_f32 v238, v20, v164
    v_fmac_f32 v240, v28, v164
    v_fmac_f32 v238, v21, v165
    v_fmac_f32 v240, v29, v165
    v_fmac_f32 v238, v22, v166
    v_fmac_f32 v240, v30, v166
    v_fmac_f32 v238, v23, v167
    v_fmac_f32 v240, v31, v167
    v_mul_f32 v235, v32, v152
    v_mul_f32 v237, v40, v120
    v_fmac_f32 v235, v33, v153
    v_fmac_f32 v237, v41, v121
    v_fmac_f32 v235, v34, v154
    v_fmac_f32 v237, v42, v122
    v_fmac_f32 v235, v35, v155
    v_fmac_f32 v237, v43, v123
    v_fmac_f32 v235, v36, v156
    v_fmac_f32 v237, v44, v124
    v_fmac_f32 v235, v37, v157
    v_fmac_f32 v237, v45, v125
    v_fmac_f32 v235, v38, v158
    v_fmac_f32 v237, v46, v126
    v_fmac_f32 v235, v39, v159
    v_fmac_f32 v237, v47, v127
    v_mul_f32 v239, v48, v168
    v_mul_f32 v241, v56, v168
    s_setprio 1
    s_waitcnt vmcnt(4) lgkmcnt(0)
    v_mfma_f32_32x32x16_bf16 v[0:15], v[64:67], v[176:179], 0
    ds_read_b64_tr_b16 v[184:185], v246 offset:2048
    ds_read_b64_tr_b16 v[186:187], v246 offset:3072
    ds_read_b64_tr_b16 v[188:189], v247 offset:2048
    ds_read_b64_tr_b16 v[190:191], v247 offset:3072
    v_fmac_f32 v239, v49, v169
    v_fmac_f32 v241, v57, v169
    s_mov_b32 m0, s68
    v_mfma_f32_32x32x16_bf16 v[16:31], v[68:71], v[176:179], 0
    buffer_load_dwordx4 v222, s[4:7], s43 offen sc1 lds
    buffer_load_dwordx4 v223, s[72:75], s43 offen offset:1024 sc1 lds
    v_fmac_f32 v239, v50, v170
    v_fmac_f32 v241, v58, v170
    v_fmac_f32 v239, v51, v171
    v_fmac_f32 v241, v59, v171
    v_fmac_f32 v239, v52, v172
    v_mfma_f32_32x32x16_bf16 v[32:47], v[64:67], v[180:183], 0
    v_fmac_f32 v241, v60, v172
    v_fmac_f32 v239, v53, v173
    v_fmac_f32 v241, v61, v173
    v_fmac_f32 v239, v54, v174
    v_fmac_f32 v241, v62, v174
    v_fmac_f32 v239, v55, v175
    v_fmac_f32 v241, v63, v175
    v_mfma_f32_32x32x16_bf16 v[48:63], v[68:71], v[180:183], 0
    s_waitcnt vmcnt(4) lgkmcnt(0)
    v_mfma_f32_32x32x16_bf16 v[0:15], v[72:75], v[184:187], v[0:15]
    ds_read_b64_tr_b16 v[176:177], v246 offset:4096
    ds_read_b64_tr_b16 v[178:179], v246 offset:5120
    ds_read_b64_tr_b16 v[180:181], v247 offset:4096
    ds_read_b64_tr_b16 v[182:183], v247 offset:5120
    s_mov_b32 m0, s69
    v_mfma_f32_32x32x16_bf16 v[16:31], v[76:79], v[184:187], v[16:31]
    buffer_load_dwordx4 v224, s[4:7], s43 offen sc1 lds
    buffer_load_dwordx4 v225, s[72:75], s43 offen offset:1024 sc1 lds
    v_mfma_f32_32x32x16_bf16 v[32:47], v[72:75], v[188:191], v[32:47]
    v_mfma_f32_32x32x16_bf16 v[48:63], v[76:79], v[188:191], v[48:63]
    s_waitcnt vmcnt(4) lgkmcnt(0)
    v_mfma_f32_32x32x16_bf16 v[0:15], v[80:83], v[176:179], v[0:15]
    ds_read_b64_tr_b16 v[184:185], v246 offset:6144
    ds_read_b64_tr_b16 v[186:187], v246 offset:7168
    ds_read_b64_tr_b16 v[188:189], v247 offset:6144
    ds_read_b64_tr_b16 v[190:191], v247 offset:7168
    s_mov_b32 m0, s70
    v_mfma_f32_32x32x16_bf16 v[16:31], v[84:87], v[176:179], v[16:31]
    buffer_load_dwordx4 v226, s[4:7], s43 offen sc1 lds
    buffer_load_dwordx4 v227, s[72:75], s43 offen offset:1024 sc1 lds
    v_mfma_f32_32x32x16_bf16 v[32:47], v[80:83], v[180:183], v[32:47]
    v_add_u32 v222, s48, v251
    ds_read2_b32 v[222:223], v222 offset0:1 offset1:3
    v_mfma_f32_32x32x16_bf16 v[48:63], v[84:87], v[180:183], v[48:63]
    s_waitcnt vmcnt(4) lgkmcnt(1)
    v_mfma_f32_32x32x16_bf16 v[0:15], v[88:91], v[184:187], v[0:15]
    ds_read_b64_tr_b16 v[176:177], v246 offset:0
    ds_read_b64_tr_b16 v[178:179], v246 offset:1024
    ds_read_b64_tr_b16 v[180:181], v247 offset:0
    ds_read_b64_tr_b16 v[182:183], v247 offset:1024
    s_mov_b32 m0, s71
    v_mfma_f32_32x32x16_bf16 v[16:31], v[92:95], v[184:187], v[16:31]
    buffer_load_dwordx4 v228, s[4:7], s43 offen sc1 lds
    buffer_load_dwordx4 v229, s[72:75], s43 offen offset:1024 sc1 lds
    s_waitcnt lgkmcnt(4)
    v_mad_u32_u16 v222, v222, s39, v248 op_sel:[1,0,0,0]
    v_mad_u32_u16 v223, v223, s39, v248 op_sel:[1,0,0,0]
    v_mfma_f32_32x32x16_bf16 v[32:47], v[88:91], v[188:191], v[32:47]
    v_add_u32 v224, s49, v251
    ds_read2_b32 v[224:225], v224 offset0:1 offset1:3
    v_mul_f32 v242, v0, v144
    v_fma_f32 v238, v8, v160, -v238
    v_fmac_f32 v242, v1, v145
    v_fmac_f32 v238, v9, v161
    v_fmac_f32 v242, v2, v146
    v_mfma_f32_32x32x16_bf16 v[48:63], v[92:95], v[188:191], v[48:63]
    s_setprio 0
    v_fmac_f32 v238, v10, v162
    v_fmac_f32 v242, v3, v147
    v_fmac_f32 v238, v11, v163
    v_fmac_f32 v242, v4, v148
    v_fmac_f32 v238, v12, v164
    v_fmac_f32 v242, v5, v149
    v_fmac_f32 v238, v13, v165
    v_fmac_f32 v242, v6, v150
    v_fmac_f32 v238, v14, v166
    v_fmac_f32 v242, v7, v151
    v_fmac_f32 v238, v15, v167
    v_fmac_f32 v236, v16, v112
    v_mul_f32 v244, v24, v160
    v_fmac_f32 v236, v17, v113
    v_fmac_f32 v244, v25, v161
    v_fmac_f32 v236, v18, v114
    v_fmac_f32 v244, v26, v162
    v_fmac_f32 v236, v19, v115
    v_fmac_f32 v244, v27, v163
    v_fmac_f32 v236, v20, v116
    v_fmac_f32 v244, v28, v164
    v_fmac_f32 v236, v21, v117
    v_fmac_f32 v244, v29, v165
    v_fmac_f32 v236, v22, v118
    v_fmac_f32 v244, v30, v166
    v_fmac_f32 v236, v23, v119
    v_fmac_f32 v244, v31, v167
    v_mul_f32 v243, v32, v152
    v_fma_f32 v239, v40, v168, -v239
    v_fmac_f32 v243, v33, v153
    v_fmac_f32 v239, v41, v169
    v_fmac_f32 v243, v34, v154
    v_fmac_f32 v239, v42, v170
    v_fmac_f32 v243, v35, v155
    v_fmac_f32 v239, v43, v171
    v_fmac_f32 v243, v36, v156
    v_fmac_f32 v239, v44, v172
    v_fmac_f32 v243, v37, v157
    v_fmac_f32 v239, v45, v173
    v_fmac_f32 v243, v38, v158
    v_fmac_f32 v239, v46, v174
    v_fmac_f32 v243, v39, v159
    v_fmac_f32 v239, v47, v175
    v_fmac_f32 v237, v48, v120
    v_mul_f32 v245, v56, v168
    v_fmac_f32 v237, v49, v121
    v_fmac_f32 v245, v57, v169
    v_fmac_f32 v237, v50, v122
    v_fmac_f32 v245, v58, v170
    v_fmac_f32 v237, v51, v123
    s_setprio 1
    s_waitcnt vmcnt(4) lgkmcnt(1)
    v_mfma_f32_32x32x16_bf16 v[0:15], v[64:67], v[176:179], 0
    ds_read_b64_tr_b16 v[184:185], v246 offset:2048
    ds_read_b64_tr_b16 v[186:187], v246 offset:3072
    ds_read_b64_tr_b16 v[188:189], v247 offset:2048
    ds_read_b64_tr_b16 v[190:191], v247 offset:3072
    v_fmac_f32 v245, v59, v171
    v_fmac_f32 v237, v52, v124
    s_mov_b32 m0, s68
    v_mfma_f32_32x32x16_bf16 v[16:31], v[68:71], v[176:179], 0
    buffer_load_dwordx4 v222, s[4:7], s44 offen sc1 lds
    buffer_load_dwordx4 v223, s[72:75], s44 offen offset:1024 sc1 lds
    s_waitcnt lgkmcnt(4)
    v_mad_u32_u16 v224, v224, s39, v248 op_sel:[1,0,0,0]
    v_mad_u32_u16 v225, v225, s39, v248 op_sel:[1,0,0,0]
    v_fmac_f32 v245, v60, v172
    v_fmac_f32 v237, v53, v125
    v_mfma_f32_32x32x16_bf16 v[32:47], v[64:67], v[180:183], 0
    v_add_u32 v226, s50, v251
    ds_read2_b32 v[226:227], v226 offset0:1 offset1:3
    v_fmac_f32 v245, v61, v173
    v_fmac_f32 v237, v54, v126
    v_fmac_f32 v245, v62, v174
    v_fmac_f32 v237, v55, v127
    v_fmac_f32 v245, v63, v175
    v_mfma_f32_32x32x16_bf16 v[48:63], v[68:71], v[180:183], 0
    v_permlane32_swap_b32 v242, v234
    v_permlane32_swap_b32 v243, v235
    v_add_f32 v242, v242, v234
    v_add_f32 v243, v243, v235
    s_waitcnt vmcnt(4) lgkmcnt(1)
    v_mfma_f32_32x32x16_bf16 v[0:15], v[72:75], v[184:187], v[0:15]
    ds_read_b64_tr_b16 v[176:177], v246 offset:4096
    ds_read_b64_tr_b16 v[178:179], v246 offset:5120
    ds_read_b64_tr_b16 v[180:181], v247 offset:4096
    ds_read_b64_tr_b16 v[182:183], v247 offset:5120
    s_mov_b32 m0, s69
    v_mfma_f32_32x32x16_bf16 v[16:31], v[76:79], v[184:187], v[16:31]
    buffer_load_dwordx4 v224, s[4:7], s45 offen sc1 lds
    buffer_load_dwordx4 v225, s[72:75], s45 offen offset:1024 sc1 lds
    s_waitcnt lgkmcnt(4)
    v_mad_u32_u16 v226, v226, s39, v248 op_sel:[1,0,0,0]
    v_mad_u32_u16 v227, v227, s39, v248 op_sel:[1,0,0,0]
    v_mfma_f32_32x32x16_bf16 v[32:47], v[72:75], v[188:191], v[32:47]
    v_add_u32 v228, s51, v251
    ds_read2_b32 v[228:229], v228 offset0:1 offset1:3
    s_set_gpr_idx_on s31, gpr_idx(DST)
    s_nop 0
    v_cvt_pk_bf16_f32 v194, v242, v243
    s_set_gpr_idx_off
    v_mfma_f32_32x32x16_bf16 v[48:63], v[76:79], v[188:191], v[48:63]
    s_waitcnt vmcnt(4) lgkmcnt(1)
    v_mfma_f32_32x32x16_bf16 v[0:15], v[80:83], v[176:179], v[0:15]
    ds_read_b64_tr_b16 v[184:185], v246 offset:6144
    ds_read_b64_tr_b16 v[186:187], v246 offset:7168
    ds_read_b64_tr_b16 v[188:189], v247 offset:6144
    ds_read_b64_tr_b16 v[190:191], v247 offset:7168
    s_mov_b32 s32, s31
    s_mov_b32 s31, s35
    s_mov_b32 m0, s70
    v_mfma_f32_32x32x16_bf16 v[16:31], v[84:87], v[176:179], v[16:31]
    buffer_load_dwordx4 v226, s[4:7], s46 offen sc1 lds
    buffer_load_dwordx4 v227, s[72:75], s46 offen offset:1024 sc1 lds
    s_waitcnt lgkmcnt(4)
    v_mad_u32_u16 v228, v228, s39, v248 op_sel:[1,0,0,0]
    v_mad_u32_u16 v229, v229, s39, v248 op_sel:[1,0,0,0]
    s_sub_u32 s26, s48, s29
    s_mov_b32 s29, s48
    v_mfma_f32_32x32x16_bf16 v[32:47], v[80:83], v[180:183], v[32:47]
    s_mov_b32 s30, s3
    s_bfe_u32 s56, s3, 0x40012
    s_cmp_eq_u32 s34, 0
    s_cselect_b32 s56, s56, 0
    v_mfma_f32_32x32x16_bf16 v[48:63], v[84:87], v[180:183], v[48:63]
    s_waitcnt vmcnt(4) lgkmcnt(0)
    v_mfma_f32_32x32x16_bf16 v[0:15], v[88:91], v[184:187], v[0:15]
    ds_read_b64_tr_b16 v[176:177], v246 offset:0
    ds_read_b64_tr_b16 v[178:179], v246 offset:1024
    ds_read_b64_tr_b16 v[180:181], v247 offset:0
    ds_read_b64_tr_b16 v[182:183], v247 offset:1024
    s_mov_b32 m0, s71
    v_mfma_f32_32x32x16_bf16 v[16:31], v[92:95], v[184:187], v[16:31]
    buffer_load_dwordx4 v228, s[4:7], s47 offen sc1 lds
    buffer_load_dwordx4 v229, s[72:75], s47 offen offset:1024 sc1 lds
    v_mfma_f32_32x32x16_bf16 v[32:47], v[88:91], v[188:191], v[32:47]
    s_nop 2
    v_mul_f32 v242, v0, v144
    v_fma_f32 v240, v8, v160, -v240
    v_fmac_f32 v242, v1, v145
    v_fmac_f32 v240, v9, v161
    v_fmac_f32 v242, v2, v146
    v_fmac_f32 v240, v10, v162
    v_fmac_f32 v242, v3, v147
    v_mfma_f32_32x32x16_bf16 v[48:63], v[92:95], v[188:191], v[48:63]
    s_setprio 0
    v_fmac_f32 v240, v11, v163
    v_fmac_f32 v242, v4, v148
    v_fmac_f32 v240, v12, v164
    v_fmac_f32 v242, v5, v149
    v_fmac_f32 v240, v13, v165
    v_fmac_f32 v242, v6, v150
    v_fmac_f32 v240, v14, v166
    v_fmac_f32 v242, v7, v151
    v_fmac_f32 v240, v15, v167
    v_add_u32 v249, s26, v249
    v_add_u32 v250, s26, v250
    v_fma_f32 v244, v16, v160, -v244
    v_fmac_f32 v236, v24, v112
    v_fmac_f32 v244, v17, v161
    v_fmac_f32 v236, v25, v113
    v_fmac_f32 v244, v18, v162
    v_fmac_f32 v236, v26, v114
    v_fmac_f32 v244, v19, v163
    v_fmac_f32 v236, v27, v115
    v_fmac_f32 v244, v20, v164
    v_fmac_f32 v236, v28, v116
    v_fmac_f32 v244, v21, v165
    v_fmac_f32 v236, v29, v117
    v_fmac_f32 v244, v22, v166
    v_fmac_f32 v236, v30, v118
    v_fmac_f32 v244, v23, v167
    v_fmac_f32 v236, v31, v119
    ds_read_b64_tr_b16 v[0:1], v249 offset:0
    ds_read_b64_tr_b16 v[2:3], v249 offset:32
    ds_read_u16_d16_hi v16, v250 offset:0
    v_mul_f32 v243, v32, v152
    v_fma_f32 v241, v40, v168, -v241
    v_fmac_f32 v243, v33, v153
    v_fmac_f32 v241, v41, v169
    v_fmac_f32 v243, v34, v154
    v_fmac_f32 v241, v42, v170
    v_fmac_f32 v243, v35, v155
    v_fmac_f32 v241, v43, v171
    v_fmac_f32 v243, v36, v156
    v_fmac_f32 v241, v44, v172
    v_fmac_f32 v243, v37, v157
    v_fmac_f32 v241, v45, v173
    v_fmac_f32 v243, v38, v158
    v_fmac_f32 v241, v46, v174
    v_fmac_f32 v243, v39, v159
    v_fmac_f32 v241, v47, v175
    ds_read_b64_tr_b16 v[4:5], v249 offset:512
    ds_read_b64_tr_b16 v[6:7], v249 offset:544
    ds_read_u16_d16_hi v17, v250 offset:128
    v_fma_f32 v245, v48, v168, -v245
    v_fmac_f32 v237, v56, v120
    v_fmac_f32 v245, v49, v169
    v_fmac_f32 v237, v57, v121
    v_fmac_f32 v245, v50, v170
    v_fmac_f32 v237, v58, v122
    v_fmac_f32 v245, v51, v171
    v_fmac_f32 v237, v59, v123
    v_fmac_f32 v245, v52, v172
    v_fmac_f32 v237, v60, v124
    v_fmac_f32 v245, v53, v173
    v_fmac_f32 v237, v61, v125
    v_fmac_f32 v245, v54, v174
    v_fmac_f32 v237, v62, v126
    v_fmac_f32 v245, v55, v175
    v_fmac_f32 v237, v63, v127
    s_cmp_eq_u32 s56, 5
    s_cbranch_scc1 K2_U20
    s_cmp_eq_u32 s56, 6
    s_cbranch_scc1 K2_U3h0
    s_branch K2_DSP0
K2_U11:
    s_setprio 1
    v_mov_b32 v254, 163296
    v_mov_b32 v255, 1
    v_lshl_add_u32 v233, v252, 1, s53
    s_mov_b64 exec, 1
    ds_add_rtn_u32 v232, v254, v255
    s_mov_b64 exec, -1
    ds_read_b32 v233, v233
    s_waitcnt lgkmcnt(5)
    v_lshlrev_b32 v20, 16, v0
    v_and_b32 v21, 0xffff0000, v0
    v_lshlrev_b32 v22, 16, v1
    v_and_b32 v23, 0xffff0000, v1
    v_lshlrev_b32 v24, 16, v2
    v_and_b32 v25, 0xffff0000, v2
    v_lshlrev_b32 v26, 16, v3
    v_and_b32 v27, 0xffff0000, v3
    v_mul_f32_dpp v36, v16, v20 row_newbcast:8 row_mask:0xf bank_mask:0xf
    v_mul_f32_dpp v37, v16, v21 row_newbcast:9 row_mask:0xf bank_mask:0xf
    v_mul_f32_dpp v38, v16, v22 row_newbcast:10 row_mask:0xf bank_mask:0xf
    v_mul_f32_dpp v39, v16, v23 row_newbcast:11 row_mask:0xf bank_mask:0xf
    v_mul_f32_dpp v40, v16, v24 row_newbcast:12 row_mask:0xf bank_mask:0xf
    v_mul_f32_dpp v41, v16, v25 row_newbcast:13 row_mask:0xf bank_mask:0xf
    v_mul_f32_dpp v42, v16, v26 row_newbcast:14 row_mask:0xf bank_mask:0xf
    v_mul_f32_dpp v43, v16, v27 row_newbcast:15 row_mask:0xf bank_mask:0xf
    v_cvt_pk_bf16_f32 v68, v36, v37
    v_cvt_pk_bf16_f32 v69, v38, v39
    v_cvt_pk_bf16_f32 v70, v40, v41
    v_cvt_pk_bf16_f32 v71, v42, v43
    v_mul_f32_dpp v20, v16, v20 row_newbcast:0 row_mask:0xa bank_mask:0xf
    v_mul_f32_dpp v21, v16, v21 row_newbcast:1 row_mask:0xa bank_mask:0xf
    v_mul_f32_dpp v22, v16, v22 row_newbcast:2 row_mask:0xa bank_mask:0xf
    v_mul_f32_dpp v23, v16, v23 row_newbcast:3 row_mask:0xa bank_mask:0xf
    v_mul_f32_dpp v24, v16, v24 row_newbcast:4 row_mask:0xa bank_mask:0xf
    v_mul_f32_dpp v25, v16, v25 row_newbcast:5 row_mask:0xa bank_mask:0xf
    v_mul_f32_dpp v26, v16, v26 row_newbcast:6 row_mask:0xa bank_mask:0xf
    v_mul_f32_dpp v27, v16, v27 row_newbcast:7 row_mask:0xa bank_mask:0xf
    v_cvt_pk_bf16_f32 v64, v20, v21
    v_cvt_pk_bf16_f32 v65, v22, v23
    v_cvt_pk_bf16_f32 v66, v24, v25
    v_cvt_pk_bf16_f32 v67, v26, v27
    s_waitcnt lgkmcnt(0)
    v_readfirstlane_b32 s58, v232
    s_nop 0
    s_cmp_lt_u32 s58, s22
    s_cbranch_scc0 K2_nul_94
    s_and_b32 s59, s58, 7
    s_lshr_b32 s60, s58, 3
K2_chk_96:
    v_readlane_b32 s61, v233, s59
    s_nop 0
    s_cmp_gt_u32 s61, s60
    s_cbranch_scc0 K2_spin_95
K2_back_97:
    v_readlane_b32 s3, v253, s58
    s_lshl_b32 s44, s34, 7
    s_and_b32 s48, s3, 0x3ffff
    s_bfe_u32 s33, s3, 0x30013
    s_mov_b32 s35, s48
    s_mov_b32 s45, s44
    s_xor_b32 s47, s44, 256
    s_add_u32 s49, s48, 128
    s_add_u32 s60, s48, 256
    s_cmp_eq_u32 s33, 3
    s_cselect_b32 s46, s44, s47
    s_cselect_b32 s50, s60, s48
    s_cselect_b32 s51, s48, s49
    s_sub_u32 s60, s33, 2
    s_cmp_lt_u32 s60, 2
    s_cbranch_scc0 K2_rare_98
K2_back_99:
    v_add_u32 v222, s48, v251
    ds_read2_b32 v[222:223], v222 offset0:1 offset1:3
    v_add_u32 v224, s49, v251
    ds_read2_b32 v[224:225], v224 offset0:1 offset1:3
    v_add_u32 v226, s50, v251
    ds_read2_b32 v[226:227], v226 offset0:1 offset1:3
    v_add_u32 v228, s51, v251
    ds_read2_b32 v[228:229], v228 offset0:1 offset1:3
    s_waitcnt lgkmcnt(3)
    v_mad_u32_u16 v222, v222, s39, v248 op_sel:[1,0,0,0]
    v_mad_u32_u16 v223, v223, s39, v248 op_sel:[1,0,0,0]
    s_waitcnt lgkmcnt(2)
    v_mad_u32_u16 v224, v224, s39, v248 op_sel:[1,0,0,0]
    v_mad_u32_u16 v225, v225, s39, v248 op_sel:[1,0,0,0]
    s_waitcnt lgkmcnt(1)
    v_mad_u32_u16 v226, v226, s39, v248 op_sel:[1,0,0,0]
    v_mad_u32_u16 v227, v227, s39, v248 op_sel:[1,0,0,0]
    s_waitcnt lgkmcnt(0)
    v_mad_u32_u16 v228, v228, s39, v248 op_sel:[1,0,0,0]
    v_mad_u32_u16 v229, v229, s39, v248 op_sel:[1,0,0,0]
    s_waitcnt vmcnt(4)
    v_mfma_f32_32x32x16_bf16 v[0:15], v[64:67], v[176:179], 0
    ds_read_b64_tr_b16 v[184:185], v246 offset:2048
    ds_read_b64_tr_b16 v[186:187], v246 offset:3072
    ds_read_b64_tr_b16 v[188:189], v247 offset:2048
    ds_read_b64_tr_b16 v[190:191], v247 offset:3072
    s_mov_b32 m0, s68
    v_mfma_f32_32x32x16_bf16 v[16:31], v[68:71], v[176:179], 0
    buffer_load_dwordx4 v222, s[4:7], s44 offen sc1 lds
    buffer_load_dwordx4 v223, s[72:75], s44 offen offset:1024 sc1 lds
    v_permlane32_swap_b32 v242, v236
    v_permlane32_swap_b32 v243, v237
    v_mfma_f32_32x32x16_bf16 v[32:47], v[64:67], v[180:183], 0
    v_permlane32_swap_b32 v244, v238
    v_permlane32_swap_b32 v245, v239
    v_permlane32_swap_b32 v240, v241
    v_add_f32 v242, v242, v236
    v_mfma_f32_32x32x16_bf16 v[48:63], v[68:71], v[180:183], 0
    s_setprio 0
    v_add_f32 v243, v243, v237
    v_add_f32 v244, v244, v238
    v_add_f32 v245, v245, v239
    v_add_f32 v240, -v240, -v241
    v_sub_u32 v241, v230, v231
    v_cvt_pk_bf16_f32 v242, v242, v243
    v_cvt_pk_bf16_f32 v244, v244, v245
    v_cvt_pk_bf16_f32 v240, v240, v240
    ds_write_b32 v230, v242 offset:768
    ds_write_b32 v230, v244 offset:1024
    ds_write_b16 v241, v240 offset:1280
    v_mul_f32 v234, v0, v96
    v_mul_f32 v236, v8, v128
    v_fmac_f32 v234, v1, v97
    v_fmac_f32 v236, v9, v129
    v_fmac_f32 v234, v2, v98
    v_fmac_f32 v236, v10, v130
    v_fmac_f32 v234, v3, v99
    v_fmac_f32 v236, v11, v131
    v_fmac_f32 v234, v4, v100
    v_fmac_f32 v236, v12, v132
    v_fmac_f32 v234, v5, v101
    v_fmac_f32 v236, v13, v133
    v_fmac_f32 v234, v6, v102
    v_fmac_f32 v236, v14, v134
    v_fmac_f32 v234, v7, v103
    v_fmac_f32 v236, v15, v135
    v_mul_f32 v238, v16, v128
    v_mul_f32 v240, v24, v128
    v_fmac_f32 v238, v17, v129
    v_fmac_f32 v240, v25, v129
    v_fmac_f32 v238, v18, v130
    v_fmac_f32 v240, v26, v130
    v_fmac_f32 v238, v19, v131
    v_fmac_f32 v240, v27, v131
    v_fmac_f32 v238, v20, v132
    v_fmac_f32 v240, v28, v132
    v_fmac_f32 v238, v21, v133
    v_fmac_f32 v240, v29, v133
    v_fmac_f32 v238, v22, v134
    v_fmac_f32 v240, v30, v134
    v_fmac_f32 v238, v23, v135
    v_fmac_f32 v240, v31, v135
    v_mul_f32 v235, v32, v104
    v_mul_f32 v237, v40, v136
    v_fmac_f32 v235, v33, v105
    v_fmac_f32 v237, v41, v137
    v_fmac_f32 v235, v34, v106
    v_fmac_f32 v237, v42, v138
    v_fmac_f32 v235, v35, v107
    v_fmac_f32 v237, v43, v139
    v_fmac_f32 v235, v36, v108
    v_fmac_f32 v237, v44, v140
    v_fmac_f32 v235, v37, v109
    v_fmac_f32 v237, v45, v141
    v_fmac_f32 v235, v38, v110
    v_fmac_f32 v237, v46, v142
    v_fmac_f32 v235, v39, v111
    v_fmac_f32 v237, v47, v143
    v_mul_f32 v239, v48, v136
    v_mul_f32 v241, v56, v136
    v_fmac_f32 v239, v49, v137
    v_fmac_f32 v241, v57, v137
    v_fmac_f32 v239, v50, v138
    v_fmac_f32 v241, v58, v138
    v_fmac_f32 v239, v51, v139
    v_fmac_f32 v241, v59, v139
    v_fmac_f32 v239, v52, v140
    v_fmac_f32 v241, v60, v140
    v_fmac_f32 v239, v53, v141
    v_fmac_f32 v241, v61, v141
    v_fmac_f32 v239, v54, v142
    v_fmac_f32 v241, v62, v142
    v_fmac_f32 v239, v55, v143
    v_fmac_f32 v241, v63, v143
    s_setprio 1
    s_waitcnt vmcnt(4) lgkmcnt(3)
    v_mfma_f32_32x32x16_bf16 v[0:15], v[64:67], v[184:187], 0
    ds_read_b64_tr_b16 v[176:177], v246 offset:4096
    ds_read_b64_tr_b16 v[178:179], v246 offset:5120
    ds_read_b64_tr_b16 v[180:181], v247 offset:4096
    ds_read_b64_tr_b16 v[182:183], v247 offset:5120
    s_mov_b32 m0, s69
    v_mfma_f32_32x32x16_bf16 v[16:31], v[68:71], v[184:187], 0
    buffer_load_dwordx4 v224, s[4:7], s45 offen sc1 lds
    buffer_load_dwordx4 v225, s[72:75], s45 offen offset:1024 sc1 lds
    v_permlane32_swap_b32 v234, v236
    v_permlane32_swap_b32 v235, v237
    v_mfma_f32_32x32x16_bf16 v[32:47], v[64:67], v[188:191], 0
    v_permlane32_swap_b32 v240, v238
    v_permlane32_swap_b32 v241, v239
    v_lshl_add_u32 v230, v252, 1, s31
    v_add_f32 v234, v234, v236
    v_add_f32 v235, v235, v237
    v_mfma_f32_32x32x16_bf16 v[48:63], v[68:71], v[188:191], 0
    s_setprio 0
    v_add_f32 v240, v240, v238
    v_add_f32 v241, v241, v239
    v_cvt_pk_bf16_f32 v234, v234, v235
    v_cvt_pk_bf16_f32 v240, v240, v241
    ds_write_b32 v230, v234 offset:0
    ds_write_b32 v230, v240 offset:256
    v_mul_f32 v234, v0, v144
    v_mul_f32 v236, v8, v112
    v_fmac_f32 v234, v1, v145
    v_fmac_f32 v236, v9, v113
    v_fmac_f32 v234, v2, v146
    v_fmac_f32 v236, v10, v114
    v_fmac_f32 v234, v3, v147
    v_fmac_f32 v236, v11, v115
    v_fmac_f32 v234, v4, v148
    v_fmac_f32 v236, v12, v116
    v_fmac_f32 v234, v5, v149
    v_fmac_f32 v236, v13, v117
    v_fmac_f32 v234, v6, v150
    v_fmac_f32 v236, v14, v118
    v_fmac_f32 v234, v7, v151
    v_fmac_f32 v236, v15, v119
    v_mul_f32 v238, v16, v160
    v_mul_f32 v240, v24, v160
    v_fmac_f32 v238, v17, v161
    v_fmac_f32 v240, v25, v161
    v_fmac_f32 v238, v18, v162
    v_fmac_f32 v240, v26, v162
    v_fmac_f32 v238, v19, v163
    v_fmac_f32 v240, v27, v163
    v_fmac_f32 v238, v20, v164
    v_fmac_f32 v240, v28, v164
    v_fmac_f32 v238, v21, v165
    v_fmac_f32 v240, v29, v165
    v_fmac_f32 v238, v22, v166
    v_fmac_f32 v240, v30, v166
    v_fmac_f32 v238, v23, v167
    v_fmac_f32 v240, v31, v167
    v_mul_f32 v235, v32, v152
    v_mul_f32 v237, v40, v120
    v_fmac_f32 v235, v33, v153
    v_fmac_f32 v237, v41, v121
    v_fmac_f32 v235, v34, v154
    v_fmac_f32 v237, v42, v122
    v_fmac_f32 v235, v35, v155
    v_fmac_f32 v237, v43, v123
    v_fmac_f32 v235, v36, v156
    v_fmac_f32 v237, v44, v124
    v_fmac_f32 v235, v37, v157
    v_fmac_f32 v237, v45, v125
    v_fmac_f32 v235, v38, v158
    v_fmac_f32 v237, v46, v126
    v_fmac_f32 v235, v39, v159
    v_fmac_f32 v237, v47, v127
    v_mul_f32 v239, v48, v168
    v_mul_f32 v241, v56, v168
    v_fmac_f32 v239, v49, v169
    v_fmac_f32 v241, v57, v169
    v_fmac_f32 v239, v50, v170
    v_fmac_f32 v241, v58, v170
    v_fmac_f32 v239, v51, v171
    v_fmac_f32 v241, v59, v171
    v_fmac_f32 v239, v52, v172
    v_fmac_f32 v241, v60, v172
    v_fmac_f32 v239, v53, v173
    v_fmac_f32 v241, v61, v173
    v_fmac_f32 v239, v54, v174
    v_fmac_f32 v241, v62, v174
    v_fmac_f32 v239, v55, v175
    v_fmac_f32 v241, v63, v175
    s_setprio 1
    s_waitcnt vmcnt(4) lgkmcnt(2)
    v_mfma_f32_32x32x16_bf16 v[0:15], v[64:67], v[176:179], 0
    ds_read_b64_tr_b16 v[184:185], v246 offset:6144
    ds_read_b64_tr_b16 v[186:187], v246 offset:7168
    ds_read_b64_tr_b16 v[188:189], v247 offset:6144
    ds_read_b64_tr_b16 v[190:191], v247 offset:7168
    s_mov_b32 s32, s31
    s_mov_b32 s31, s35
    s_mov_b32 m0, s70
    v_mfma_f32_32x32x16_bf16 v[16:31], v[68:71], v[176:179], 0
    buffer_load_dwordx4 v226, s[4:7], s46 offen sc1 lds
    buffer_load_dwordx4 v227, s[72:75], s46 offen offset:1024 sc1 lds
    s_sub_u32 s26, s48, s29
    s_mov_b32 s29, s48
    s_mov_b32 s30, s3
    s_bfe_u32 s56, s3, 0x40012
    v_mfma_f32_32x32x16_bf16 v[32:47], v[64:67], v[180:183], 0
    s_cmp_lg_u32 s36, 0
    s_cselect_b32 s56, s56, 0
    v_mfma_f32_32x32x16_bf16 v[48:63], v[68:71], v[180:183], 0
    s_setprio 0
    v_mul_f32 v242, v0, v144
    v_fma_f32 v238, v8, v160, -v238
    v_fmac_f32 v242, v1, v145
    v_fmac_f32 v238, v9, v161
    v_fmac_f32 v242, v2, v146
    v_fmac_f32 v238, v10, v162
    v_fmac_f32 v242, v3, v147
    v_fmac_f32 v238, v11, v163
    v_fmac_f32 v242, v4, v148
    v_fmac_f32 v238, v12, v164
    v_fmac_f32 v242, v5, v149
    v_fmac_f32 v238, v13, v165
    v_fmac_f32 v242, v6, v150
    v_fmac_f32 v238, v14, v166
    v_fmac_f32 v242, v7, v151
    v_fmac_f32 v238, v15, v167
    v_fmac_f32 v236, v16, v112
    v_mul_f32 v244, v24, v160
    v_fmac_f32 v236, v17, v113
    v_fmac_f32 v244, v25, v161
    v_fmac_f32 v236, v18, v114
    v_fmac_f32 v244, v26, v162
    v_fmac_f32 v236, v19, v115
    v_fmac_f32 v244, v27, v163
    v_fmac_f32 v236, v20, v116
    v_fmac_f32 v244, v28, v164
    v_fmac_f32 v236, v21, v117
    v_fmac_f32 v244, v29, v165
    v_fmac_f32 v236, v22, v118
    v_fmac_f32 v244, v30, v166
    v_fmac_f32 v236, v23, v119
    v_fmac_f32 v244, v31, v167
    v_mul_f32 v243, v32, v152
    v_fma_f32 v239, v40, v168, -v239
    v_fmac_f32 v243, v33, v153
    v_fmac_f32 v239, v41, v169
    v_fmac_f32 v243, v34, v154
    v_fmac_f32 v239, v42, v170
    v_fmac_f32 v243, v35, v155
    v_fmac_f32 v239, v43, v171
    v_fmac_f32 v243, v36, v156
    v_fmac_f32 v239, v44, v172
    v_fmac_f32 v243, v37, v157
    v_fmac_f32 v239, v45, v173
    v_fmac_f32 v243, v38, v158
    v_fmac_f32 v239, v46, v174
    v_fmac_f32 v243, v39, v159
    v_fmac_f32 v239, v47, v175
    v_fmac_f32 v237, v48, v120
    v_mul_f32 v245, v56, v168
    v_fmac_f32 v237, v49, v121
    v_fmac_f32 v245, v57, v169
    v_fmac_f32 v237, v50, v122
    v_fmac_f32 v245, v58, v170
    v_fmac_f32 v237, v51, v123
    v_fmac_f32 v245, v59, v171
    v_fmac_f32 v237, v52, v124
    v_fmac_f32 v245, v60, v172
    v_fmac_f32 v237, v53, v125
    v_fmac_f32 v245, v61, v173
    v_fmac_f32 v237, v54, v126
    v_fmac_f32 v245, v62, v174
    v_fmac_f32 v237, v55, v127
    v_fmac_f32 v245, v63, v175
    s_setprio 1
    s_waitcnt vmcnt(4) lgkmcnt(0)
    v_mfma_f32_32x32x16_bf16 v[0:15], v[64:67], v[184:187], 0
    ds_read_b64_tr_b16 v[176:177], v246 offset:0
    ds_read_b64_tr_b16 v[178:179], v246 offset:1024
    ds_read_b64_tr_b16 v[180:181], v247 offset:0
    ds_read_b64_tr_b16 v[182:183], v247 offset:1024
    s_mov_b32 m0, s71
    v_mfma_f32_32x32x16_bf16 v[16:31], v[68:71], v[184:187], 0
    buffer_load_dwordx4 v228, s[4:7], s47 offen sc1 lds
    buffer_load_dwordx4 v229, s[72:75], s47 offen offset:1024 sc1 lds
    v_permlane32_swap_b32 v242, v234
    v_permlane32_swap_b32 v243, v235
    v_add_f32 v242, v242, v234
    v_mfma_f32_32x32x16_bf16 v[32:47], v[64:67], v[188:191], 0
    v_add_f32 v243, v243, v235
    v_cvt_pk_bf16_f32 v242, v242, v243
    ds_write_b32 v230, v242 offset:512
    v_mfma_f32_32x32x16_bf16 v[48:63], v[68:71], v[188:191], 0
    s_setprio 0
    v_mul_f32 v242, v0, v144
    v_fma_f32 v240, v8, v160, -v240
    v_fmac_f32 v242, v1, v145
    v_fmac_f32 v240, v9, v161
    v_fmac_f32 v242, v2, v146
    v_fmac_f32 v240, v10, v162
    v_fmac_f32 v242, v3, v147
    v_fmac_f32 v240, v11, v163
    v_fmac_f32 v242, v4, v148
    v_fmac_f32 v240, v12, v164
    v_fmac_f32 v242, v5, v149
    v_fmac_f32 v240, v13, v165
    v_fmac_f32 v242, v6, v150
    v_fmac_f32 v240, v14, v166
    v_fmac_f32 v242, v7, v151
    v_fmac_f32 v240, v15, v167
    v_add_u32 v249, s26, v249
    v_add_u32 v250, s26, v250
    v_fma_f32 v244, v16, v160, -v244
    v_fmac_f32 v236, v24, v112
    v_fmac_f32 v244, v17, v161
    v_fmac_f32 v236, v25, v113
    v_fmac_f32 v244, v18, v162
    v_fmac_f32 v236, v26, v114
    v_fmac_f32 v244, v19, v163
    v_fmac_f32 v236, v27, v115
    v_fmac_f32 v244, v20, v164
    v_fmac_f32 v236, v28, v116
    v_fmac_f32 v244, v21, v165
    v_fmac_f32 v236, v29, v117
    v_fmac_f32 v244, v22, v166
    v_fmac_f32 v236, v30, v118
    v_fmac_f32 v244, v23, v167
    v_fmac_f32 v236, v31, v119
    ds_read_b64_tr_b16 v[0:1], v249 offset:0
    ds_read_b64_tr_b16 v[2:3], v249 offset:32
    ds_read_u16_d16_hi v16, v250 offset:0
    v_mul_f32 v243, v32, v152
    v_fma_f32 v241, v40, v168, -v241
    v_fmac_f32 v243, v33, v153
    v_fmac_f32 v241, v41, v169
    v_fmac_f32 v243, v34, v154
    v_fmac_f32 v241, v42, v170
    v_fmac_f32 v243, v35, v155
    v_fmac_f32 v241, v43, v171
    v_fmac_f32 v243, v36, v156
    v_fmac_f32 v241, v44, v172
    v_fmac_f32 v243, v37, v157
    v_fmac_f32 v241, v45, v173
    v_fmac_f32 v243, v38, v158
    v_fmac_f32 v241, v46, v174
    v_fmac_f32 v243, v39, v159
    v_fmac_f32 v241, v47, v175
    ds_read_b64_tr_b16 v[4:5], v249 offset:512
    ds_read_b64_tr_b16 v[6:7], v249 offset:544
    ds_read_u16_d16_hi v17, v250 offset:128
    v_fma_f32 v245, v48, v168, -v245
    v_fmac_f32 v237, v56, v120
    v_fmac_f32 v245, v49, v169
    v_fmac_f32 v237, v57, v121
    v_fmac_f32 v245, v50, v170
    v_fmac_f32 v237, v58, v122
    v_fmac_f32 v245, v51, v171
    v_fmac_f32 v237, v59, v123
    v_fmac_f32 v245, v52, v172
    v_fmac_f32 v237, v60, v124
    v_fmac_f32 v245, v53, v173
    v_fmac_f32 v237, v61, v125
    v_fmac_f32 v245, v54, v174
    v_fmac_f32 v237, v62, v126
    v_fmac_f32 v245, v55, v175
    v_fmac_f32 v237, v63, v127
    s_cmp_eq_u32 s56, 5
    s_cbranch_scc1 K2_U21
    s_cmp_eq_u32 s56, 6
    s_cbranch_scc1 K2_U3h1
    s_branch K2_DSP1
K2_U41:
    s_setprio 1
    ds_read_b64_tr_b16 v[8:9], v249 offset:1024
    ds_read_b64_tr_b16 v[10:11], v249 offset:1056
    ds_read_u16_d16_hi v18, v250 offset:256
    s_lshr_b32 s65, s30, 27
    s_mul_i32 s66, s22, 2080
    s_lshl_b32 s65, s65, 9
    s_add_u32 s65, s65, s66
    s_add_u32 s65, s65, 65536
    s_sub_u32 s65, s65, s29
    s_sub_u32 s65, s65, 512
    v_add_u32 v56, s65, v249
    ds_read_b64_tr_b16 v[12:13], v56 offset:0
    ds_read_b64_tr_b16 v[14:15], v56 offset:32
    ds_read_u16_d16_hi v19, v250 offset:384
    s_waitcnt lgkmcnt(6)
    v_lshlrev_b32 v20, 16, v0
    v_and_b32 v21, 0xffff0000, v0
    v_lshlrev_b32 v22, 16, v1
    v_and_b32 v23, 0xffff0000, v1
    v_lshlrev_b32 v24, 16, v2
    v_and_b32 v25, 0xffff0000, v2
    v_lshlrev_b32 v26, 16, v3
    v_and_b32 v27, 0xffff0000, v3
    v_mul_f32_dpp v36, v16, v20 row_newbcast:8 row_mask:0xf bank_mask:0xf
    v_mul_f32_dpp v37, v16, v21 row_newbcast:9 row_mask:0xf bank_mask:0xf
    v_mul_f32_dpp v38, v16, v22 row_newbcast:10 row_mask:0xf bank_mask:0xf
    v_mul_f32_dpp v39, v16, v23 row_newbcast:11 row_mask:0xf bank_mask:0xf
    v_mul_f32_dpp v40, v16, v24 row_newbcast:12 row_mask:0xf bank_mask:0xf
    v_mul_f32_dpp v41, v16, v25 row_newbcast:13 row_mask:0xf bank_mask:0xf
    v_mul_f32_dpp v42, v16, v26 row_newbcast:14 row_mask:0xf bank_mask:0xf
    v_mul_f32_dpp v43, v16, v27 row_newbcast:15 row_mask:0xf bank_mask:0xf
    v_cvt_pk_bf16_f32 v68, v36, v37
    v_cvt_pk_bf16_f32 v69, v38, v39
    v_cvt_pk_bf16_f32 v70, v40, v41
    v_cvt_pk_bf16_f32 v71, v42, v43
    v_mul_f32_dpp v20, v16, v20 row_newbcast:0 row_mask:0xa bank_mask:0xf
    v_mul_f32_dpp v21, v16, v21 row_newbcast:1 row_mask:0xa bank_mask:0xf
    v_mul_f32_dpp v22, v16, v22 row_newbcast:2 row_mask:0xa bank_mask:0xf
    v_mul_f32_dpp v23, v16, v23 row_newbcast:3 row_mask:0xa bank_mask:0xf
    v_mul_f32_dpp v24, v16, v24 row_newbcast:4 row_mask:0xa bank_mask:0xf
    v_mul_f32_dpp v25, v16, v25 row_newbcast:5 row_mask:0xa bank_mask:0xf
    v_mul_f32_dpp v26, v16, v26 row_newbcast:6 row_mask:0xa bank_mask:0xf
    v_mul_f32_dpp v27, v16, v27 row_newbcast:7 row_mask:0xa bank_mask:0xf
    v_cvt_pk_bf16_f32 v64, v20, v21
    v_cvt_pk_bf16_f32 v65, v22, v23
    v_cvt_pk_bf16_f32 v66, v24, v25
    v_cvt_pk_bf16_f32 v67, v26, v27
    v_lshlrev_b32 v28, 16, v4
    v_and_b32 v29, 0xffff0000, v4
    v_lshlrev_b32 v30, 16, v5
    v_and_b32 v31, 0xffff0000, v5
    v_lshlrev_b32 v32, 16, v6
    v_and_b32 v33, 0xffff0000, v6
    v_lshlrev_b32 v34, 16, v7
    v_and_b32 v35, 0xffff0000, v7
    v_mul_f32_dpp v36, v17, v28 row_newbcast:8 row_mask:0xf bank_mask:0xf
    v_mul_f32_dpp v37, v17, v29 row_newbcast:9 row_mask:0xf bank_mask:0xf
    v_mul_f32_dpp v38, v17, v30 row_newbcast:10 row_mask:0xf bank_mask:0xf
    v_mul_f32_dpp v39, v17, v31 row_newbcast:11 row_mask:0xf bank_mask:0xf
    v_mul_f32_dpp v40, v17, v32 row_newbcast:12 row_mask:0xf bank_mask:0xf
    v_mul_f32_dpp v41, v17, v33 row_newbcast:13 row_mask:0xf bank_mask:0xf
    v_mul_f32_dpp v42, v17, v34 row_newbcast:14 row_mask:0xf bank_mask:0xf
    v_mul_f32_dpp v43, v17, v35 row_newbcast:15 row_mask:0xf bank_mask:0xf
    v_cvt_pk_bf16_f32 v76, v36, v37
    v_cvt_pk_bf16_f32 v77, v38, v39
    v_cvt_pk_bf16_f32 v78, v40, v41
    v_cvt_pk_bf16_f32 v79, v42, v43
    v_mul_f32_dpp v28, v17, v28 row_newbcast:0 row_mask:0xa bank_mask:0xf
    v_mul_f32_dpp v29, v17, v29 row_newbcast:1 row_mask:0xa bank_mask:0xf
    v_mul_f32_dpp v30, v17, v30 row_newbcast:2 row_mask:0xa bank_mask:0xf
    v_mul_f32_dpp v31, v17, v31 row_newbcast:3 row_mask:0xa bank_mask:0xf
    v_mul_f32_dpp v32, v17, v32 row_newbcast:4 row_mask:0xa bank_mask:0xf
    v_mul_f32_dpp v33, v17, v33 row_newbcast:5 row_mask:0xa bank_mask:0xf
    v_mul_f32_dpp v34, v17, v34 row_newbcast:6 row_mask:0xa bank_mask:0xf
    v_mul_f32_dpp v35, v17, v35 row_newbcast:7 row_mask:0xa bank_mask:0xf
    v_cvt_pk_bf16_f32 v72, v28, v29
    v_cvt_pk_bf16_f32 v73, v30, v31
    v_cvt_pk_bf16_f32 v74, v32, v33
    v_cvt_pk_bf16_f32 v75, v34, v35
    s_waitcnt lgkmcnt(3)
    v_lshlrev_b32 v20, 16, v8
    v_and_b32 v21, 0xffff0000, v8
    v_lshlrev_b32 v22, 16, v9
    v_and_b32 v23, 0xffff0000, v9
    v_lshlrev_b32 v24, 16, v10
    v_and_b32 v25, 0xffff0000, v10
    v_lshlrev_b32 v26, 16, v11
    v_and_b32 v27, 0xffff0000, v11
    v_mul_f32_dpp v36, v18, v20 row_newbcast:8 row_mask:0xf bank_mask:0xf
    v_mul_f32_dpp v37, v18, v21 row_newbcast:9 row_mask:0xf bank_mask:0xf
    v_mul_f32_dpp v38, v18, v22 row_newbcast:10 row_mask:0xf bank_mask:0xf
    v_mul_f32_dpp v39, v18, v23 row_newbcast:11 row_mask:0xf bank_mask:0xf
    v_mul_f32_dpp v40, v18, v24 row_newbcast:12 row_mask:0xf bank_mask:0xf
    v_mul_f32_dpp v41, v18, v25 row_newbcast:13 row_mask:0xf bank_mask:0xf
    v_mul_f32_dpp v42, v18, v26 row_newbcast:14 row_mask:0xf bank_mask:0xf
    v_mul_f32_dpp v43, v18, v27 row_newbcast:15 row_mask:0xf bank_mask:0xf
    v_cvt_pk_bf16_f32 v84, v36, v37
    v_cvt_pk_bf16_f32 v85, v38, v39
    v_cvt_pk_bf16_f32 v86, v40, v41
    v_cvt_pk_bf16_f32 v87, v42, v43
    v_mul_f32_dpp v20, v18, v20 row_newbcast:0 row_mask:0xa bank_mask:0xf
    v_mul_f32_dpp v21, v18, v21 row_newbcast:1 row_mask:0xa bank_mask:0xf
    v_mul_f32_dpp v22, v18, v22 row_newbcast:2 row_mask:0xa bank_mask:0xf
    v_mul_f32_dpp v23, v18, v23 row_newbcast:3 row_mask:0xa bank_mask:0xf
    v_mul_f32_dpp v24, v18, v24 row_newbcast:4 row_mask:0xa bank_mask:0xf
    v_mul_f32_dpp v25, v18, v25 row_newbcast:5 row_mask:0xa bank_mask:0xf
    v_mul_f32_dpp v26, v18, v26 row_newbcast:6 row_mask:0xa bank_mask:0xf
    v_mul_f32_dpp v27, v18, v27 row_newbcast:7 row_mask:0xa bank_mask:0xf
    v_cvt_pk_bf16_f32 v80, v20, v21
    v_cvt_pk_bf16_f32 v81, v22, v23
    v_cvt_pk_bf16_f32 v82, v24, v25
    v_cvt_pk_bf16_f32 v83, v26, v27
    s_waitcnt lgkmcnt(0)
    v_lshlrev_b32 v28, 16, v12
    v_and_b32 v29, 0xffff0000, v12
    v_lshlrev_b32 v30, 16, v13
    v_and_b32 v31, 0xffff0000, v13
    v_lshlrev_b32 v32, 16, v14
    v_and_b32 v33, 0xffff0000, v14
    v_lshlrev_b32 v34, 16, v15
    v_and_b32 v35, 0xffff0000, v15
    v_mul_f32_dpp v36, v19, v28 row_newbcast:8 row_mask:0xf bank_mask:0xf
    v_mul_f32_dpp v37, v19, v29 row_newbcast:9 row_mask:0xf bank_mask:0xf
    v_mul_f32_dpp v38, v19, v30 row_newbcast:10 row_mask:0xf bank_mask:0xf
    v_mul_f32_dpp v39, v19, v31 row_newbcast:11 row_mask:0xf bank_mask:0xf
    v_mul_f32_dpp v40, v19, v32 row_newbcast:12 row_mask:0xf bank_mask:0xf
    v_mul_f32_dpp v41, v19, v33 row_newbcast:13 row_mask:0xf bank_mask:0xf
    v_mul_f32_dpp v42, v19, v34 row_newbcast:14 row_mask:0xf bank_mask:0xf
    v_mul_f32_dpp v43, v19, v35 row_newbcast:15 row_mask:0xf bank_mask:0xf
    v_cvt_pk_bf16_f32 v92, v36, v37
    v_cvt_pk_bf16_f32 v93, v38, v39
    v_cvt_pk_bf16_f32 v94, v40, v41
    v_cvt_pk_bf16_f32 v95, v42, v43
    v_mul_f32_dpp v28, v19, v28 row_newbcast:0 row_mask:0xa bank_mask:0xf
    v_mul_f32_dpp v29, v19, v29 row_newbcast:1 row_mask:0xa bank_mask:0xf
    v_mul_f32_dpp v30, v19, v30 row_newbcast:2 row_mask:0xa bank_mask:0xf
    v_mul_f32_dpp v31, v19, v31 row_newbcast:3 row_mask:0xa bank_mask:0xf
    v_mul_f32_dpp v32, v19, v32 row_newbcast:4 row_mask:0xa bank_mask:0xf
    v_mul_f32_dpp v33, v19, v33 row_newbcast:5 row_mask:0xa bank_mask:0xf
    v_mul_f32_dpp v34, v19, v34 row_newbcast:6 row_mask:0xa bank_mask:0xf
    v_mul_f32_dpp v35, v19, v35 row_newbcast:7 row_mask:0xa bank_mask:0xf
    v_cvt_pk_bf16_f32 v88, v28, v29
    v_cvt_pk_bf16_f32 v89, v30, v31
    v_cvt_pk_bf16_f32 v90, v32, v33
    v_cvt_pk_bf16_f32 v91, v34, v35
    s_waitcnt vmcnt(4)
    v_mfma_f32_32x32x16_bf16 v[0:15], v[64:67], v[176:179], 0
    ds_read_b64_tr_b16 v[184:185], v246 offset:2048
    ds_read_b64_tr_b16 v[186:187], v246 offset:3072
    ds_read_b64_tr_b16 v[188:189], v247 offset:2048
    ds_read_b64_tr_b16 v[190:191], v247 offset:3072
    s_mov_b32 m0, s68
    v_mfma_f32_32x32x16_bf16 v[16:31], v[68:71], v[176:179], 0
    buffer_load_dwordx4 v222, s[4:7], s41 offen sc1 lds
    buffer_load_dwordx4 v223, s[72:75], s41 offen offset:1024 sc1 lds
    v_permlane32_swap_b32 v242, v236
    v_permlane32_swap_b32 v243, v237
    v_mov_b32 v254, 163296
    v_mfma_f32_32x32x16_bf16 v[32:47], v[64:67], v[180:183], 0
    v_permlane32_swap_b32 v244, v238
    v_permlane32_swap_b32 v245, v239
    v_permlane32_swap_b32 v240, v241
    v_add_f32 v242, v242, v236
    v_mfma_f32_32x32x16_bf16 v[48:63], v[68:71], v[180:183], 0
    v_add_f32 v243, v243, v237
    v_add_f32 v244, v244, v238
    v_add_f32 v245, v245, v239
    v_add_f32 v240, -v240, -v241
    v_sub_u32 v241, v230, v231
    v_cvt_pk_bf16_f32 v242, v242, v243
    v_mov_b32 v255, 1
    v_lshl_add_u32 v233, v252, 1, s53
    s_mov_b64 exec, 1
    ds_add_rtn_u32 v232, v254, v255
    s_mov_b64 exec, -1
    ds_read_b32 v233, v233
    s_waitcnt vmcnt(4) lgkmcnt(2)
    v_mfma_f32_32x32x16_bf16 v[0:15], v[72:75], v[184:187], v[0:15]
    ds_read_b64_tr_b16 v[176:177], v246 offset:4096
    ds_read_b64_tr_b16 v[178:179], v246 offset:5120
    ds_read_b64_tr_b16 v[180:181], v247 offset:4096
    ds_read_b64_tr_b16 v[182:183], v247 offset:5120
    v_cvt_pk_bf16_f32 v244, v244, v245
    v_cvt_pk_bf16_f32 v240, v240, v240
    s_mov_b32 m0, s69
    v_mfma_f32_32x32x16_bf16 v[16:31], v[76:79], v[184:187], v[16:31]
    buffer_load_dwordx4 v224, s[4:7], s41 offen sc1 lds
    buffer_load_dwordx4 v225, s[72:75], s41 offen offset:1024 sc1 lds
    ds_write_b32 v230, v242 offset:768
    ds_write_b32 v230, v244 offset:1024
    ds_write_b16 v241, v240 offset:1280
    s_waitcnt lgkmcnt(7)
    v_readfirstlane_b32 s58, v232
    v_mfma_f32_32x32x16_bf16 v[32:47], v[72:75], v[188:191], v[32:47]
    s_cmp_lt_u32 s58, s22
    s_cbranch_scc0 K2_nul_101
    s_and_b32 s59, s58, 7
    s_lshr_b32 s60, s58, 3
K2_chk_103:
    v_readlane_b32 s61, v233, s59
    s_nop 0
    s_cmp_gt_u32 s61, s60
    s_cbranch_scc0 K2_spin_102
K2_back_104:
    v_mfma_f32_32x32x16_bf16 v[48:63], v[76:79], v[188:191], v[48:63]
    v_readlane_b32 s3, v253, s58
    s_lshl_b32 s44, s34, 7
    s_and_b32 s48, s3, 0x3ffff
    s_bfe_u32 s33, s3, 0x30013
    s_mov_b32 s35, s48
    s_mov_b32 s45, s44
    s_waitcnt vmcnt(4) lgkmcnt(3)
    v_mfma_f32_32x32x16_bf16 v[0:15], v[80:83], v[176:179], v[0:15]
    ds_read_b64_tr_b16 v[184:185], v246 offset:6144
    ds_read_b64_tr_b16 v[186:187], v246 offset:7168
    ds_read_b64_tr_b16 v[188:189], v247 offset:6144
    ds_read_b64_tr_b16 v[190:191], v247 offset:7168
    s_xor_b32 s47, s44, 256
    s_add_u32 s49, s48, 128
    s_mov_b32 m0, s70
    v_mfma_f32_32x32x16_bf16 v[16:31], v[84:87], v[176:179], v[16:31]
    buffer_load_dwordx4 v226, s[4:7], s41 offen sc1 lds
    buffer_load_dwordx4 v227, s[72:75], s41 offen offset:1024 sc1 lds
    s_add_u32 s60, s48, 256
    s_cmp_eq_u32 s33, 3
    s_cselect_b32 s46, s44, s47
    s_cselect_b32 s50, s60, s48
    s_cselect_b32 s51, s48, s49
    v_mfma_f32_32x32x16_bf16 v[32:47], v[80:83], v[180:183], v[32:47]
    s_sub_u32 s60, s33, 2
    s_cmp_lt_u32 s60, 2
    s_cbranch_scc0 K2_rare_105
K2_back_106:
    v_mfma_f32_32x32x16_bf16 v[48:63], v[84:87], v[180:183], v[48:63]
    s_waitcnt vmcnt(4) lgkmcnt(0)
    v_mfma_f32_32x32x16_bf16 v[0:15], v[88:91], v[184:187], v[0:15]
    ds_read_b64_tr_b16 v[176:177], v246 offset:0
    ds_read_b64_tr_b16 v[178:179], v246 offset:1024
    ds_read_b64_tr_b16 v[180:181], v247 offset:0
    ds_read_b64_tr_b16 v[182:183], v247 offset:1024
    s_mov_b32 m0, s71
    v_mfma_f32_32x32x16_bf16 v[16:31], v[92:95], v[184:187], v[16:31]
    buffer_load_dwordx4 v228, s[4:7], s41 offen sc1 lds
    buffer_load_dwordx4 v229, s[72:75], s41 offen offset:1024 sc1 lds
    v_mfma_f32_32x32x16_bf16 v[32:47], v[88:91], v[188:191], v[32:47]
    s_nop 2
    v_mul_f32 v234, v0, v96
    v_mul_f32 v236, v8, v128
    v_fmac_f32 v234, v1, v97
    v_fmac_f32 v236, v9, v129
    v_fmac_f32 v234, v2, v98
    v_fmac_f32 v236, v10, v130
    v_fmac_f32 v234, v3, v99
    v_mfma_f32_32x32x16_bf16 v[48:63], v[92:95], v[188:191], v[48:63]
    s_setprio 0
    v_fmac_f32 v236, v11, v131
    v_fmac_f32 v234, v4, v100
    v_fmac_f32 v236, v12, v132
    v_fmac_f32 v234, v5, v101
    v_fmac_f32 v236, v13, v133
    v_fmac_f32 v234, v6, v102
    v_fmac_f32 v236, v14, v134
    v_fmac_f32 v234, v7, v103
    v_fmac_f32 v236, v15, v135
    v_mul_f32 v238, v16, v128
    v_mul_f32 v240, v24, v128
    v_fmac_f32 v238, v17, v129
    v_fmac_f32 v240, v25, v129
    v_fmac_f32 v238, v18, v130
    v_fmac_f32 v240, v26, v130
    v_fmac_f32 v238, v19, v131
    v_fmac_f32 v240, v27, v131
    v_fmac_f32 v238, v20, v132
    v_fmac_f32 v240, v28, v132
    v_fmac_f32 v238, v21, v133
    v_fmac_f32 v240, v29, v133
    v_fmac_f32 v238, v22, v134
    v_fmac_f32 v240, v30, v134
    v_fmac_f32 v238, v23, v135
    v_fmac_f32 v240, v31, v135
    v_mul_f32 v235, v32, v104
    v_mul_f32 v237, v40, v136
    v_fmac_f32 v235, v33, v105
    v_fmac_f32 v237, v41, v137
    v_fmac_f32 v235, v34, v106
    v_fmac_f32 v237, v42, v138
    v_fmac_f32 v235, v35, v107
    v_fmac_f32 v237, v43, v139
    v_fmac_f32 v235, v36, v108
    v_fmac_f32 v237, v44, v140
    v_fmac_f32 v235, v37, v109
    v_fmac_f32 v237, v45, v141
    v_fmac_f32 v235, v38, v110
    v_fmac_f32 v237, v46, v142
    v_fmac_f32 v235, v39, v111
    v_fmac_f32 v237, v47, v143
    v_mul_f32 v239, v48, v136
    v_mul_f32 v241, v56, v136
    s_setprio 1
    s_waitcnt vmcnt(4) lgkmcnt(0)
    v_mfma_f32_32x32x16_bf16 v[0:15], v[64:67], v[176:179], 0
    ds_read_b64_tr_b16 v[184:185], v246 offset:2048
    ds_read_b64_tr_b16 v[186:187], v246 offset:3072
    ds_read_b64_tr_b16 v[188:189], v247 offset:2048
    ds_read_b64_tr_b16 v[190:191], v247 offset:3072
    v_fmac_f32 v239, v49, v137
    v_fmac_f32 v241, v57, v137
    s_mov_b32 m0, s68
    v_mfma_f32_32x32x16_bf16 v[16:31], v[68:71], v[176:179], 0
    buffer_load_dwordx4 v222, s[4:7], s42 offen sc1 lds
    buffer_load_dwordx4 v223, s[72:75], s42 offen offset:1024 sc1 lds
    v_fmac_f32 v239, v50, v138
    v_fmac_f32 v241, v58, v138
    v_fmac_f32 v239, v51, v139
    v_fmac_f32 v241, v59, v139
    v_fmac_f32 v239, v52, v140
    v_mfma_f32_32x32x16_bf16 v[32:47], v[64:67], v[180:183], 0
    v_fmac_f32 v241, v60, v140
    v_fmac_f32 v239, v53, v141
    v_fmac_f32 v241, v61, v141
    v_fmac_f32 v239, v54, v142
    v_fmac_f32 v241, v62, v142
    v_fmac_f32 v239, v55, v143
    v_fmac_f32 v241, v63, v143
    v_mfma_f32_32x32x16_bf16 v[48:63], v[68:71], v[180:183], 0
    v_permlane32_swap_b32 v234, v236
    v_permlane32_swap_b32 v235, v237
    v_permlane32_swap_b32 v240, v238
    s_waitcnt vmcnt(4) lgkmcnt(0)
    v_mfma_f32_32x32x16_bf16 v[0:15], v[72:75], v[184:187], v[0:15]
    ds_read_b64_tr_b16 v[176:177], v246 offset:4096
    ds_read_b64_tr_b16 v[178:179], v246 offset:5120
    ds_read_b64_tr_b16 v[180:181], v247 offset:4096
    ds_read_b64_tr_b16 v[182:183], v247 offset:5120
    v_permlane32_swap_b32 v241, v239
    s_mov_b32 m0, s69
    v_mfma_f32_32x32x16_bf16 v[16:31], v[76:79], v[184:187], v[16:31]
    buffer_load_dwordx4 v224, s[4:7], s42 offen sc1 lds
    buffer_load_dwordx4 v225, s[72:75], s42 offen offset:1024 sc1 lds
    v_lshl_add_u32 v230, v252, 1, s31
    v_add_f32 v234, v234, v236
    v_add_f32 v235, v235, v237
    v_add_f32 v240, v240, v238
    v_add_f32 v241, v241, v239
    v_mfma_f32_32x32x16_bf16 v[32:47], v[72:75], v[188:191], v[32:47]
    v_cvt_pk_bf16_f32 v234, v234, v235
    v_cvt_pk_bf16_f32 v240, v240, v241
    ds_write_b32 v230, v234 offset:0
    ds_write_b32 v230, v240 offset:256
    v_mfma_f32_32x32x16_bf16 v[48:63], v[76:79], v[188:191], v[48:63]
    s_waitcnt vmcnt(4) lgkmcnt(2)
    v_mfma_f32_32x32x16_bf16 v[0:15], v[80:83], v[176:179], v[0:15]
    ds_read_b64_tr_b16 v[184:185], v246 offset:6144
    ds_read_b64_tr_b16 v[186:187], v246 offset:7168
    ds_read_b64_tr_b16 v[188:189], v247 offset:6144
    ds_read_b64_tr_b16 v[190:191], v247 offset:7168
    s_mov_b32 m0, s70
    v_mfma_f32_32x32x16_bf16 v[16:31], v[84:87], v[176:179], v[16:31]
    buffer_load_dwordx4 v226, s[4:7], s42 offen sc1 lds
    buffer_load_dwordx4 v227, s[72:75], s42 offen offset:1024 sc1 lds
    v_mfma_f32_32x32x16_bf16 v[32:47], v[80:83], v[180:183], v[32:47]
    v_mfma_f32_32x32x16_bf16 v[48:63], v[84:87], v[180:183], v[48:63]
    s_waitcnt vmcnt(4) lgkmcnt(0)
    v_mfma_f32_32x32x16_bf16 v[0:15], v[88:91], v[184:187], v[0:15]
    ds_read_b64_tr_b16 v[176:177], v246 offset:0
    ds_read_b64_tr_b16 v[178:179], v246 offset:1024
    ds_read_b64_tr_b16 v[180:181], v247 offset:0
    ds_read_b64_tr_b16 v[182:183], v247 offset:1024
    s_mov_b32 m0, s71
    v_mfma_f32_32x32x16_bf16 v[16:31], v[92:95], v[184:187], v[16:31]
    buffer_load_dwordx4 v228, s[4:7], s42 offen sc1 lds
    buffer_load_dwordx4 v229, s[72:75], s42 offen offset:1024 sc1 lds
    v_mfma_f32_32x32x16_bf16 v[32:47], v[88:91], v[188:191], v[32:47]
    s_nop 2
    v_mul_f32 v234, v0, v144
    v_mul_f32 v236, v8, v112
    v_fmac_f32 v234, v1, v145
    v_fmac_f32 v236, v9, v113
    v_fmac_f32 v234, v2, v146
    v_fmac_f32 v236, v10, v114
    v_fmac_f32 v234, v3, v147
    v_mfma_f32_32x32x16_bf16 v[48:63], v[92:95], v[188:191], v[48:63]
    s_setprio 0
    v_fmac_f32 v236, v11, v115
    v_fmac_f32 v234, v4, v148
    v_fmac_f32 v236, v12, v116
    v_fmac_f32 v234, v5, v149
    v_fmac_f32 v236, v13, v117
    v_fmac_f32 v234, v6, v150
    v_fmac_f32 v236, v14, v118
    v_fmac_f32 v234, v7, v151
    v_fmac_f32 v236, v15, v119
    v_mul_f32 v238, v16, v160
    v_mul_f32 v240, v24, v160
    v_fmac_f32 v238, v17, v161
    v_fmac_f32 v240, v25, v161
    v_fmac_f32 v238, v18, v162
    v_fmac_f32 v240, v26, v162
    v_fmac_f32 v238, v19, v163
    v_fmac_f32 v240, v27, v163
    v_fmac_f32 v238, v20, v164
    v_fmac_f32 v240, v28, v164
    v_fmac_f32 v238, v21, v165
    v_fmac_f32 v240, v29, v165
    v_fmac_f32 v238, v22, v166
    v_fmac_f32 v240, v30, v166
    v_fmac_f32 v238, v23, v167
    v_fmac_f32 v240, v31, v167
    v_mul_f32 v235, v32, v152
    v_mul_f32 v237, v40, v120
    v_fmac_f32 v235, v33, v153
    v_fmac_f32 v237, v41, v121
    v_fmac_f32 v235, v34, v154
    v_fmac_f32 v237, v42, v122
    v_fmac_f32 v235, v35, v155
    v_fmac_f32 v237, v43, v123
    v_fmac_f32 v235, v36, v156
    v_fmac_f32 v237, v44, v124
    v_fmac_f32 v235, v37, v157
    v_fmac_f32 v237, v45, v125
    v_fmac_f32 v235, v38, v158
    v_fmac_f32 v237, v46, v126
    v_fmac_f32 v235, v39, v159
    v_fmac_f32 v237, v47, v127
    v_mul_f32 v239, v48, v168
    v_mul_f32 v241, v56, v168
    s_setprio 1
    s_waitcnt vmcnt(4) lgkmcnt(0)
    v_mfma_f32_32x32x16_bf16 v[0:15], v[64:67], v[176:179], 0
    ds_read_b64_tr_b16 v[184:185], v246 offset:2048
    ds_read_b64_tr_b16 v[186:187], v246 offset:3072
    ds_read_b64_tr_b16 v[188:189], v247 offset:2048
    ds_read_b64_tr_b16 v[190:191], v247 offset:3072
    v_fmac_f32 v239, v49, v169
    v_fmac_f32 v241, v57, v169
    s_mov_b32 m0, s68
    v_mfma_f32_32x32x16_bf16 v[16:31], v[68:71], v[176:179], 0
    buffer_load_dwordx4 v222, s[4:7], s43 offen sc1 lds
    buffer_load_dwordx4 v223, s[72:75], s43 offen offset:1024 sc1 lds
    v_fmac_f32 v239, v50, v170
    v_fmac_f32 v241, v58, v170
    v_fmac_f32 v239, v51, v171
    v_fmac_f32 v241, v59, v171
    v_fmac_f32 v239, v52, v172
    v_mfma_f32_32x32x16_bf16 v[32:47], v[64:67], v[180:183], 0
    v_fmac_f32 v241, v60, v172
    v_fmac_f32 v239, v53, v173
    v_fmac_f32 v241, v61, v173
    v_fmac_f32 v239, v54, v174
    v_fmac_f32 v241, v62, v174
    v_fmac_f32 v239, v55, v175
    v_fmac_f32 v241, v63, v175
    v_mfma_f32_32x32x16_bf16 v[48:63], v[68:71], v[180:183], 0
    s_waitcnt vmcnt(4) lgkmcnt(0)
    v_mfma_f32_32x32x16_bf16 v[0:15], v[72:75], v[184:187], v[0:15]
    ds_read_b64_tr_b16 v[176:177], v246 offset:4096
    ds_read_b64_tr_b16 v[178:179], v246 offset:5120
    ds_read_b64_tr_b16 v[180:181], v247 offset:4096
    ds_read_b64_tr_b16 v[182:183], v247 offset:5120
    s_mov_b32 m0, s69
    v_mfma_f32_32x32x16_bf16 v[16:31], v[76:79], v[184:187], v[16:31]
    buffer_load_dwordx4 v224, s[4:7], s43 offen sc1 lds
    buffer_load_dwordx4 v225, s[72:75], s43 offen offset:1024 sc1 lds
    v_mfma_f32_32x32x16_bf16 v[32:47], v[72:75], v[188:191], v[32:47]
    v_mfma_f32_32x32x16_bf16 v[48:63], v[76:79], v[188:191], v[48:63]
    s_waitcnt vmcnt(4) lgkmcnt(0)
    v_mfma_f32_32x32x16_bf16 v[0:15], v[80:83], v[176:179], v[0:15]
    ds_read_b64_tr_b16 v[184:185], v246 offset:6144
    ds_read_b64_tr_b16 v[186:187], v246 offset:7168
    ds_read_b64_tr_b16 v[188:189], v247 offset:6144
    ds_read_b64_tr_b16 v[190:191], v247 offset:7168
    s_mov_b32 m0, s70
    v_mfma_f32_32x32x16_bf16 v[16:31], v[84:87], v[176:179], v[16:31]
    buffer_load_dwordx4 v226, s[4:7], s43 offen sc1 lds
    buffer_load_dwordx4 v227, s[72:75], s43 offen offset:1024 sc1 lds
    v_mfma_f32_32x32x16_bf16 v[32:47], v[80:83], v[180:183], v[32:47]
    v_add_u32 v222, s48, v251
    ds_read2_b32 v[222:223], v222 offset0:1 offset1:3
    v_mfma_f32_32x32x16_bf16 v[48:63], v[84:87], v[180:183], v[48:63]
    s_waitcnt vmcnt(4) lgkmcnt(1)
    v_mfma_f32_32x32x16_bf16 v[0:15], v[88:91], v[184:187], v[0:15]
    ds_read_b64_tr_b16 v[176:177], v246 offset:0
    ds_read_b64_tr_b16 v[178:179], v246 offset:1024
    ds_read_b64_tr_b16 v[180:181], v247 offset:0
    ds_read_b64_tr_b16 v[182:183], v247 offset:1024
    s_mov_b32 m0, s71
    v_mfma_f32_32x32x16_bf16 v[16:31], v[92:95], v[184:187], v[16:31]
    buffer_load_dwordx4 v228, s[4:7], s43 offen sc1 lds
    buffer_load_dwordx4 v229, s[72:75], s43 offen offset:1024 sc1 lds
    s_waitcnt lgkmcnt(4)
    v_mad_u32_u16 v222, v222, s39, v248 op_sel:[1,0,0,0]
    v_mad_u32_u16 v223, v223, s39, v248 op_sel:[1,0,0,0]
    v_mfma_f32_32x32x16_bf16 v[32:47], v[88:91], v[188:191], v[32:47]
    v_add_u32 v224, s49, v251
    ds_read2_b32 v[224:225], v224 offset0:1 offset1:3
    v_mul_f32 v242, v0, v144
    v_fma_f32 v238, v8, v160, -v238
    v_fmac_f32 v242, v1, v145
    v_fmac_f32 v238, v9, v161
    v_fmac_f32 v242, v2, v146
    v_mfma_f32_32x32x16_bf16 v[48:63], v[92:95], v[188:191], v[48:63]
    s_setprio 0
    v_fmac_f32 v238, v10, v162
    v_fmac_f32 v242, v3, v147
    v_fmac_f32 v238, v11, v163
    v_fmac_f32 v242, v4, v148
    v_fmac_f32 v238, v12, v164
    v_fmac_f32 v242, v5, v149
    v_fmac_f32 v238, v13, v165
    v_fmac_f32 v242, v6, v150
    v_fmac_f32 v238, v14, v166
    v_fmac_f32 v242, v7, v151
    v_fmac_f32 v238, v15, v167
    v_fmac_f32 v236, v16, v112
    v_mul_f32 v244, v24, v160
    v_fmac_f32 v236, v17, v113
    v_fmac_f32 v244, v25, v161
    v_fmac_f32 v236, v18, v114
    v_fmac_f32 v244, v26, v162
    v_fmac_f32 v236, v19, v115
    v_fmac_f32 v244, v27, v163
    v_fmac_f32 v236, v20, v116
    v_fmac_f32 v244, v28, v164
    v_fmac_f32 v236, v21, v117
    v_fmac_f32 v244, v29, v165
    v_fmac_f32 v236, v22, v118
    v_fmac_f32 v244, v30, v166
    v_fmac_f32 v236, v23, v119
    v_fmac_f32 v244, v31, v167
    v_mul_f32 v243, v32, v152
    v_fma_f32 v239, v40, v168, -v239
    v_fmac_f32 v243, v33, v153
    v_fmac_f32 v239, v41, v169
    v_fmac_f32 v243, v34, v154
    v_fmac_f32 v239, v42, v170
    v_fmac_f32 v243, v35, v155
    v_fmac_f32 v239, v43, v171
    v_fmac_f32 v243, v36, v156
    v_fmac_f32 v239, v44, v172
    v_fmac_f32 v243, v37, v157
    v_fmac_f32 v239, v45, v173
    v_fmac_f32 v243, v38, v158
    v_fmac_f32 v239, v46, v174
    v_fmac_f32 v243, v39, v159
    v_fmac_f32 v239, v47, v175
    v_fmac_f32 v237, v48, v120
    v_mul_f32 v245, v56, v168
    v_fmac_f32 v237, v49, v121
    v_fmac_f32 v245, v57, v169
    v_fmac_f32 v237, v50, v122
    v_fmac_f32 v245, v58, v170
    v_fmac_f32 v237, v51, v123
    s_setprio 1
    s_waitcnt vmcnt(4) lgkmcnt(1)
    v_mfma_f32_32x32x16_bf16 v[0:15], v[64:67], v[176:179], 0
    ds_read_b64_tr_b16 v[184:185], v246 offset:2048
    ds_read_b64_tr_b16 v[186:187], v246 offset:3072
    ds_read_b64_tr_b16 v[188:189], v247 offset:2048
    ds_read_b64_tr_b16 v[190:191], v247 offset:3072
    v_fmac_f32 v245, v59, v171
    v_fmac_f32 v237, v52, v124
    s_mov_b32 m0, s68
    v_mfma_f32_32x32x16_bf16 v[16:31], v[68:71], v[176:179], 0
    buffer_load_dwordx4 v222, s[4:7], s44 offen sc1 lds
    buffer_load_dwordx4 v223, s[72:75], s44 offen offset:1024 sc1 lds
    s_waitcnt lgkmcnt(4)
    v_mad_u32_u16 v224, v224, s39, v248 op_sel:[1,0,0,0]
    v_mad_u32_u16 v225, v225, s39, v248 op_sel:[1,0,0,0]
    v_fmac_f32 v245, v60, v172
    v_fmac_f32 v237, v53, v125
    v_mfma_f32_32x32x16_bf16 v[32:47], v[64:67], v[180:183], 0
    v_add_u32 v226, s50, v251
    ds_read2_b32 v[226:227], v226 offset0:1 offset1:3
    v_fmac_f32 v245, v61, v173
    v_fmac_f32 v237, v54, v126
    v_fmac_f32 v245, v62, v174
    v_fmac_f32 v237, v55, v127
    v_fmac_f32 v245, v63, v175
    v_mfma_f32_32x32x16_bf16 v[48:63], v[68:71], v[180:183], 0
    v_permlane32_swap_b32 v242, v234
    v_permlane32_swap_b32 v243, v235
    v_add_f32 v242, v242, v234
    v_add_f32 v243, v243, v235
    s_waitcnt vmcnt(4) lgkmcnt(1)
    v_mfma_f32_32x32x16_bf16 v[0:15], v[72:75], v[184:187], v[0:15]
    ds_read_b64_tr_b16 v[176:177], v246 offset:4096
    ds_read_b64_tr_b16 v[178:179], v246 offset:5120
    ds_read_b64_tr_b16 v[180:181], v247 offset:4096
    ds_read_b64_tr_b16 v[182:183], v247 offset:5120
    v_cvt_pk_bf16_f32 v242, v242, v243
    ds_write_b32 v230, v242 offset:512
    s_mov_b32 m0, s69
    v_mfma_f32_32x32x16_bf16 v[16:31], v[76:79], v[184:187], v[16:31]
    buffer_load_dwordx4 v224, s[4:7], s45 offen sc1 lds
    buffer_load_dwordx4 v225, s[72:75], s45 offen offset:1024 sc1 lds
    s_waitcnt lgkmcnt(5)
    v_mad_u32_u16 v226, v226, s39, v248 op_sel:[1,0,0,0]
    v_mad_u32_u16 v227, v227, s39, v248 op_sel:[1,0,0,0]
    v_mfma_f32_32x32x16_bf16 v[32:47], v[72:75], v[188:191], v[32:47]
    v_add_u32 v228, s51, v251
    ds_read2_b32 v[228:229], v228 offset0:1 offset1:3
    v_mfma_f32_32x32x16_bf16 v[48:63], v[76:79], v[188:191], v[48:63]
    s_waitcnt vmcnt(4) lgkmcnt(2)
    v_mfma_f32_32x32x16_bf16 v[0:15], v[80:83], v[176:179], v[0:15]
    ds_read_b64_tr_b16 v[184:185], v246 offset:6144
    ds_read_b64_tr_b16 v[186:187], v246 offset:7168
    ds_read_b64_tr_b16 v[188:189], v247 offset:6144
    ds_read_b64_tr_b16 v[190:191], v247 offset:7168
    s_mov_b32 s32, s31
    s_mov_b32 s31, s35
    s_mov_b32 m0, s70
    v_mfma_f32_32x32x16_bf16 v[16:31], v[84:87], v[176:179], v[16:31]
    buffer_load_dwordx4 v226, s[4:7], s46 offen sc1 lds
    buffer_load_dwordx4 v227, s[72:75], s46 offen offset:1024 sc1 lds
    s_waitcnt lgkmcnt(4)
    v_mad_u32_u16 v228, v228, s39, v248 op_sel:[1,0,0,0]
    v_mad_u32_u16 v229, v229, s39, v248 op_sel:[1,0,0,0]
    s_sub_u32 s26, s48, s29
    s_mov_b32 s29, s48
    v_mfma_f32_32x32x16_bf16 v[32:47], v[80:83], v[180:183], v[32:47]
    s_mov_b32 s30, s3
    s_bfe_u32 s56, s3, 0x40012
    s_cmp_lg_u32 s36, 0
    s_cselect_b32 s56, s56, 0
    v_mfma_f32_32x32x16_bf16 v[48:63], v[84:87], v[180:183], v[48:63]
    s_waitcnt vmcnt(4) lgkmcnt(0)
    v_mfma_f32_32x32x16_bf16 v[0:15], v[88:91], v[184:187], v[0:15]
    ds_read_b64_tr_b16 v[176:177], v246 offset:0
    ds_read_b64_tr_b16 v[178:179], v246 offset:1024
    ds_read_b64_tr_b16 v[180:181], v247 offset:0
    ds_read_b64_tr_b16 v[182:183], v247 offset:1024
    s_mov_b32 m0, s71
    v_mfma_f32_32x32x16_bf16 v[16:31], v[92:95], v[184:187], v[16:31]
    buffer_load_dwordx4 v228, s[4:7], s47 offen sc1 lds
    buffer_load_dwordx4 v229, s[72:75], s47 offen offset:1024 sc1 lds
    v_mfma_f32_32x32x16_bf16 v[32:47], v[88:91], v[188:191], v[32:47]
    s_nop 2
    v_mul_f32 v242, v0, v144
    v_fma_f32 v240, v8, v160, -v240
    v_fmac_f32 v242, v1, v145
    v_fmac_f32 v240, v9, v161
    v_fmac_f32 v242, v2, v146
    v_fmac_f32 v240, v10, v162
    v_fmac_f32 v242, v3, v147
    v_mfma_f32_32x32x16_bf16 v[48:63], v[92:95], v[188:191], v[48:63]
    s_setprio 0
    v_fmac_f32 v240, v11, v163
    v_fmac_f32 v242, v4, v148
    v_fmac_f32 v240, v12, v164
    v_fmac_f32 v242, v5, v149
    v_fmac_f32 v240, v13, v165
    v_fmac_f32 v242, v6, v150
    v_fmac_f32 v240, v14, v166
    v_fmac_f32 v242, v7, v151
    v_fmac_f32 v240, v15, v167
    v_add_u32 v249, s26, v249
    v_add_u32 v250, s26, v250
    v_fma_f32 v244, v16, v160, -v244
    v_fmac_f32 v236, v24, v112
    v_fmac_f32 v244, v17, v161
    v_fmac_f32 v236, v25, v113
    v_fmac_f32 v244, v18, v162
    v_fmac_f32 v236, v26, v114
    v_fmac_f32 v244, v19, v163
    v_fmac_f32 v236, v27, v115
    v_fmac_f32 v244, v20, v164
    v_fmac_f32 v236, v28, v116
    v_fmac_f32 v244, v21, v165
    v_fmac_f32 v236, v29, v117
    v_fmac_f32 v244, v22, v166
    v_fmac_f32 v236, v30, v118
    v_fmac_f32 v244, v23, v167
    v_fmac_f32 v236, v31, v119
    ds_read_b64_tr_b16 v[0:1], v249 offset:0
    ds_read_b64_tr_b16 v[2:3], v249 offset:32
    ds_read_u16_d16_hi v16, v250 offset:0
    v_mul_f32 v243, v32, v152
    v_fma_f32 v241, v40, v168, -v241
    v_fmac_f32 v243, v33, v153
    v_fmac_f32 v241, v41, v169
    v_fmac_f32 v243, v34, v154
    v_fmac_f32 v241, v42, v170
    v_fmac_f32 v243, v35, v155
    v_fmac_f32 v241, v43, v171
    v_fmac_f32 v243, v36, v156
    v_fmac_f32 v241, v44, v172
    v_fmac_f32 v243, v37, v157
    v_fmac_f32 v241, v45, v173
    v_fmac_f32 v243, v38, v158
    v_fmac_f32 v241, v46, v174
    v_fmac_f32 v243, v39, v159
    v_fmac_f32 v241, v47, v175
    ds_read_b64_tr_b16 v[4:5], v249 offset:512
    ds_read_b64_tr_b16 v[6:7], v249 offset:544
    ds_read_u16_d16_hi v17, v250 offset:128
    v_fma_f32 v245, v48, v168, -v245
    v_fmac_f32 v237, v56, v120
    v_fmac_f32 v245, v49, v169
    v_fmac_f32 v237, v57, v121
    v_fmac_f32 v245, v50, v170
    v_fmac_f32 v237, v58, v122
    v_fmac_f32 v245, v51, v171
    v_fmac_f32 v237, v59, v123
    v_fmac_f32 v245, v52, v172
    v_fmac_f32 v237, v60, v124
    v_fmac_f32 v245, v53, v173
    v_fmac_f32 v237, v61, v125
    v_fmac_f32 v245, v54, v174
    v_fmac_f32 v237, v62, v126
    v_fmac_f32 v245, v55, v175
    v_fmac_f32 v237, v63, v127
    s_cmp_eq_u32 s56, 5
    s_cbranch_scc1 K2_U21
    s_cmp_eq_u32 s56, 6
    s_cbranch_scc1 K2_U3h1
    s_branch K2_DSP1
K2_FLGR:
    s_sub_u32 s27, s27, 16
    s_cbranch_scc1 K2_END
    buffer_load_dwordx4 v[56:59], v60, s[8:11], s64 offen sc1
    s_branch K2_FLGW
K2_FLGY:
    v_mov_b32 v56, s2
    v_mov_b32 v57, 7178240
    s_mov_b64 exec, 1
    buffer_store_dword v56, v57, s[8:11], 0 offen sc1
    s_mov_b64 exec, -1
    s_branch K2_FLGOK
K2_nul_70:
    s_mov_b32 s58, 63
    s_mov_b32 s36, 0
    s_branch K2_back_73
K2_spin_71:
    s_sub_u32 s27, s27, 1
    s_cbranch_scc1 K2_END
    v_lshl_add_u32 v233, v252, 1, s53
    ds_read_b32 v233, v233
    s_waitcnt lgkmcnt(0)
    s_branch K2_chk_72
K2_dyn_68:
    v_mov_b32 v254, 163296
    v_mov_b32 v255, 1
    v_lshl_add_u32 v233, v252, 1, s53
    s_mov_b64 exec, 1
    ds_add_rtn_u32 v232, v254, v255
    s_mov_b64 exec, -1
    ds_read_b32 v233, v233
    s_waitcnt lgkmcnt(0)
    v_readfirstlane_b32 s58, v232
    s_nop 0
    s_cmp_lt_u32 s58, s22
    s_cbranch_scc0 K2_nul_70
    s_and_b32 s59, s58, 7
    s_lshr_b32 s60, s58, 3
K2_chk_72:
    v_readlane_b32 s61, v233, s59
    s_nop 0
    s_cmp_gt_u32 s61, s60
    s_cbranch_scc0 K2_spin_71
K2_back_73:
    s_mov_b32 s34, 1
    s_branch K2_back_69
K2_rare_74:
    s_cmp_eq_u32 s33, 4
    s_cbranch_scc1 K2_four_76
    s_mov_b32 s49, s48
    s_mov_b32 s51, s48
    s_xor_b32 s45, s44, 256
    s_xor_b32 s46, s44, 512
    s_xor_b32 s47, s44, 768
    s_branch K2_back_75
K2_four_76:
    s_add_u32 s50, s48, 256
    s_add_u32 s51, s48, 384
    s_mov_b32 s46, s44
    s_mov_b32 s47, s44
    s_branch K2_back_75
K2_dum_77:
    v_mov_b32 v232, -1
    s_mov_b32 m0, 163312
    s_mov_b64 exec, 1
    buffer_load_dwordx4 v232, s[16:19], 0 offen lds
    buffer_load_dwordx4 v232, s[16:19], 0 offen lds
    s_mov_b64 exec, -1
    s_branch K2_back_79
K2_a4_78:
    v_add_u32 v254, s48, v230
    ds_read_b32 v254, v254 offset:4
    s_lshr_b32 s65, s3, 27
    s_mul_i32 s66, s22, 2080
    s_lshl_b32 s65, s65, 9
    s_add_u32 s65, s65, s66
    s_add_u32 s65, s65, 65536
    s_mov_b32 m0, s65
    s_mov_b32 exec_hi, 0
    s_waitcnt lgkmcnt(0)
    v_or_b32 v254, v254, v231
    buffer_load_dwordx4 v254, s[16:19], 0 offen  lds
    s_mov_b32 exec_hi, -1
    s_branch K2_b4_80
K2_nul_83:
    s_mov_b32 s58, 63
    s_mov_b32 s36, 0
    s_branch K2_back_86
K2_spin_84:
    s_sub_u32 s27, s27, 1
    s_cbranch_scc1 K2_END
    v_lshl_add_u32 v233, v252, 1, s53
    ds_read_b32 v233, v233
    s_waitcnt lgkmcnt(0)
    s_branch K2_chk_85
K2_dyn_81:
    v_mov_b32 v254, 163296
    v_mov_b32 v255, 1
    v_lshl_add_u32 v233, v252, 1, s53
    s_mov_b64 exec, 1
    ds_add_rtn_u32 v232, v254, v255
    s_mov_b64 exec, -1
    ds_read_b32 v233, v233
    s_waitcnt lgkmcnt(0)
    v_readfirstlane_b32 s58, v232
    s_nop 0
    s_cmp_lt_u32 s58, s22
    s_cbranch_scc0 K2_nul_83
    s_and_b32 s59, s58, 7
    s_lshr_b32 s60, s58, 3
K2_chk_85:
    v_readlane_b32 s61, v233, s59
    s_nop 0
    s_cmp_gt_u32 s61, s60
    s_cbranch_scc0 K2_spin_84
K2_back_86:
    s_mov_b32 s34, 1
    s_branch K2_back_82
K2_rare_87:
    s_cmp_eq_u32 s33, 4
    s_cbranch_scc1 K2_four_89
    s_mov_b32 s49, s48
    s_mov_b32 s51, s48
    s_xor_b32 s45, s44, 256
    s_xor_b32 s46, s44, 512
    s_xor_b32 s47, s44, 768
    s_branch K2_back_88
K2_four_89:
    s_add_u32 s50, s48, 256
    s_add_u32 s51, s48, 384
    s_mov_b32 s46, s44
    s_mov_b32 s47, s44
    s_branch K2_back_88
K2_dum_90:
    v_mov_b32 v232, -1
    s_mov_b32 m0, 163312
    s_mov_b64 exec, 1
    buffer_load_dwordx4 v232, s[16:19], 0 offen lds
    buffer_load_dwordx4 v232, s[16:19], 0 offen lds
    s_mov_b64 exec, -1
    s_branch K2_back_92
K2_a4_91:
    v_add_u32 v254, s48, v230
    ds_read_b32 v254, v254 offset:4
    s_lshr_b32 s65, s3, 27
    s_mul_i32 s66, s22, 2080
    s_lshl_b32 s65, s65, 9
    s_add_u32 s65, s65, s66
    s_add_u32 s65, s65, 65536
    s_mov_b32 m0, s65
    s_mov_b32 exec_hi, 0
    s_waitcnt lgkmcnt(0)
    v_or_b32 v254, v254, v231
    buffer_load_dwordx4 v254, s[16:19], 0 offen  lds
    s_mov_b32 exec_hi, -1
    s_branch K2_b4_93
K2_nul_94:
    s_mov_b32 s58, 63
    s_mov_b32 s36, 0
    s_branch K2_back_97
K2_spin_95:
    s_sub_u32 s27, s27, 1
    s_cbranch_scc1 K2_END
    v_lshl_add_u32 v233, v252, 1, s53
    ds_read_b32 v233, v233
    s_waitcnt lgkmcnt(0)
    s_branch K2_chk_96
K2_rare_98:
    s_cmp_eq_u32 s33, 4
    s_cbranch_scc1 K2_four_100
    s_mov_b32 s49, s48
    s_mov_b32 s51, s48
    s_xor_b32 s45, s44, 256
    s_xor_b32 s46, s44, 512
    s_xor_b32 s47, s44, 768
    s_branch K2_back_99
K2_four_100:
    s_add_u32 s50, s48, 256
    s_add_u32 s51, s48, 384
    s_mov_b32 s46, s44
    s_mov_b32 s47, s44
    s_branch K2_back_99
K2_nul_101:
    s_mov_b32 s58, 63
    s_mov_b32 s36, 0
    s_branch K2_back_104
K2_spin_102:
    s_sub_u32 s27, s27, 1
    s_cbranch_scc1 K2_END
    v_lshl_add_u32 v233, v252, 1, s53
    ds_read_b32 v233, v233
    s_waitcnt lgkmcnt(0)
    s_branch K2_chk_103
K2_rare_105:
    s_cmp_eq_u32 s33, 4
    s_cbranch_scc1 K2_four_107
    s_mov_b32 s49, s48
    s_mov_b32 s51, s48
    s_xor_b32 s45, s44, 256
    s_xor_b32 s46, s44, 512
    s_xor_b32 s47, s44, 768
    s_branch K2_back_106
K2_four_107:
    s_add_u32 s50, s48, 256
    s_add_u32 s51, s48, 384
    s_mov_b32 s46, s44
    s_mov_b32 s47, s44
    s_branch K2_back_106
K2_END:
    s_endpgm
.section .rodata,"a"
.p2align 6
.amdhsa_kernel standalone__tensor_product_equiv_equiformer__graph_kernel
  .amdhsa_next_free_vgpr 256
  .amdhsa_next_free_sgpr 102
  .amdhsa_accum_offset 256
  .amdhsa_group_segment_fixed_size 0
  .amdhsa_kernarg_size 96
  .amdhsa_user_sgpr_count 2
  .amdhsa_user_sgpr_kernarg_segment_ptr 1
  .amdhsa_system_sgpr_workgroup_id_x 1
  .amdhsa_float_denorm_mode_32 3
.end_amdhsa_kernel
```

```asm
; @launch grid=(256,1,1) block=(512,1,1) lds=163840
.amdgcn_target "amdgcn-amd-amdhsa--gfx950"
.text
.globl standalone__tensor_product_equiv_equiformer__graph_kernel
.p2align 8
.type standalone__tensor_product_equiv_equiformer__graph_kernel,@function
standalone__tensor_product_equiv_equiformer__graph_kernel:
    s_cmp_ge_u32 s2, 256
    s_cbranch_scc1 K2_END
    s_load_dwordx16 s[80:95], s[0:1], 0
    s_load_dwordx4 s[96:99], s[0:1], 72
    s_load_dwordx2 s[100:101], s[0:1], 88
    v_lshrrev_b32 v1, 6, v0
    s_mov_b32 s54, s2
    v_readfirstlane_b32 s20, v1
    s_mov_b64 exec, 0
    s_cmp_eq_u32 s20, 0
    s_cbranch_scc1 K2_PAD_S1
    s_cmp_eq_u32 s20, 1
    s_cbranch_scc1 K2_PAD_S2
    s_cmp_eq_u32 s20, 5
    s_cbranch_scc1 K2_PAD_H1
    s_cmp_eq_u32 s20, 6
    s_cbranch_scc1 K2_PAD_H2
    s_cmp_eq_u32 s20, 2
    s_cbranch_scc1 K2_PAD_H3
KS_HOP0:
    s_mov_b64 exec, -1
    v_and_b32 v8, 63, v0
    v_lshlrev_b32 v9, 4, v8
    v_mov_b32 v6, 0
    v_lshlrev_b32 v5, 4, v0
    v_mul_u32_u24 v4, 24, v0
    s_mul_i32 s64, s2, 5120
    s_mul_i32 s65, s2, 7680
    v_mov_b32 v176, v8
    v_mov_b32 v177, v0
    s_movk_i32 s39, 1024
    s_lshl_b32 s37, s20, 13
    s_mov_b32 s53, 163264
    s_lshl_b32 s52, s20, 2
    s_add_u32 s52, s52, s53
    s_add_u32 s68, s37, 0
    s_add_u32 s69, s37, 2048
    s_add_u32 s70, s37, 4096
    s_add_u32 s71, s37, 6144
    s_waitcnt lgkmcnt(0)
    s_mov_b32 s8, s100
    s_and_b32 s9, s101, 0xffff
    s_mov_b32 s10, 37748736
    s_mov_b32 s11, 0x20000
    s_cmp_lg_u32 s20, 7
    s_cbranch_scc1 KS_NOTAG
    s_mov_b32 s24, 7178240
    s_mov_b64 exec, 1
    buffer_load_dword v14, v6, s[8:11], s24 offen sc1
    s_mov_b64 exec, -1
    s_mov_b32 s60, s98
    s_and_b32 s61, s99, 0xffff
    s_mov_b32 s62, 256
    s_mov_b32 s63, 0x20000
    s_barrier
    v_mov_b32 v76, 0
    v_mov_b32 v77, -1
    v_lshlrev_b32 v78, 2, v8
    v_add_u32 v78, 163072, v78
    s_mov_b64 exec, 0x1ff
    ds_write_b32 v78, v76 offset:192
    s_mov_b32 exec_lo, -1
    ds_write_b32 v78, v77 offset:256
    s_mov_b64 exec, -1
    s_mov_b32 exec_hi, 0xffff
    ds_write_b32 v78, v76
    s_mov_b64 exec, 1
    ds_write_b32 v78, v76 offset:228
    s_mov_b64 exec, -1
    s_mov_b64 exec, 1
    buffer_load_dword v15, v6, s[60:63], 0 offen sc1
    v_mov_b32 v12, 163456
    s_mov_b32 s24, 1664525
    s_waitcnt vmcnt(1)
    v_mul_lo_u32 v59, v14, s24
    v_add_u32 v59, 1013904223, v59
    ds_write2_b32 v12, v59, v6 offset0:0 offset1:1
    s_waitcnt lgkmcnt(0)
    s_barrier
    s_waitcnt vmcnt(0)
    v_mov_b32 v62, v15
    ds_write_b32 v12, v15 offset:4
    v_cmp_ne_u32 vcc, 0, v15
    s_mov_b32 s24, 0x40000
    s_waitcnt lgkmcnt(0)
    s_barrier
    s_cbranch_vccnz KS_FLOK
KS_FLW:
    s_sub_u32 s24, s24, 1
    s_cbranch_scc1 K2_END
    buffer_load_dword v62, v6, s[60:63], 0 offen sc1
    s_waitcnt vmcnt(0)
    v_cmp_ne_u32 vcc, 0, v62
    s_nop 0
    s_cbranch_vccz KS_FLW
    ds_write_b32 v12, v62 offset:4
KS_FLOK:
    s_mov_b64 exec, -1
    s_branch KS_JOIN
KS_H0:
    s_barrier
    s_branch KS_HELP
K2_PAD_S1:
    s_branch KS_HOP0
KS_NOTAG:
    s_cmp_ge_u32 s20, 5
    s_cbranch_scc1 KS_HELP
    s_cmp_ge_u32 s2, 250
    s_cbranch_scc1 KS_IDLE
    s_mov_b32 s40, s88
    s_and_b32 s41, s89, 0xffff
    s_mov_b32 s42, 1280000
    s_mov_b32 s43, 0x20000
    buffer_load_dwordx4 v[12:15], v5, s[40:43], s64 offen
    s_mov_b32 s44, s86
    s_and_b32 s45, s87, 0xffff
    s_mov_b32 s46, 1280000
    s_mov_b32 s47, 0x20000
    s_mov_b32 s48, s82
    s_and_b32 s49, s83, 0xffff
    s_mov_b32 s50, 1920000
    s_mov_b32 s51, 0x20000
    buffer_load_dwordx4 v[16:19], v5, s[44:47], s64 offen
    buffer_load_dwordx4 v[20:23], v4, s[48:51], s65 offen
    buffer_load_dwordx2 v[24:25], v4, s[48:51], s65 offen offset:16
    v_lshlrev_b32 v2, 2, v0
    s_lshl_b32 s64, s64, 3
    v_lshl_add_u32 v3, v0, 7, s64
    v_mov_b32 v7, 1
    s_cmp_eq_u32 s20, 4
    s_cbranch_scc1 KS_NOCLR
    ds_write_b32 v2, v6
KS_NOCLR:
    s_waitcnt lgkmcnt(0)
    s_barrier
    s_mov_b64 exec, 0
    s_cmp_eq_u32 s20, 0
    s_cbranch_scc1 K2_PAD_B3
    s_cmp_eq_u32 s20, 1
    s_cbranch_scc1 K2_PAD_LD
    s_cmp_eq_u32 s20, 2
    s_cbranch_scc1 K2_PAD_NW
    s_cmp_eq_u32 s20, 3
    s_cbranch_scc1 K2_PAD_SC
    s_cmp_eq_u32 s20, 4
    s_cbranch_scc1 K2_PAD_SD
KS_HOP:
    s_mov_b64 exec, -1
    s_mov_b32 s58, 214749
    s_movk_i32 s59, 625
    s_waitcnt vmcnt(3)
    v_mul_u32_u24 v28, s58, v12
    v_and_b32 v40, 0xffffff, v28
    v_lshrrev_b32 v32, 26, v28
    v_add_u32 v40, 8187281, v40
    v_bfe_u32 v36, v28, 24, 2
    v_lshlrev_b32 v32, 2, v32
    v_lshrrev_b32 v40, 24, v40
    v_lshl_or_b32 v32, v36, 8, v32
    v_lshl_or_b32 v32, v40, 7, v32
    ds_add_rtn_u32 v36, v32, v7
    v_mul_u32_u24 v29, s58, v13
    v_and_b32 v41, 0xffffff, v29
    v_lshrrev_b32 v33, 26, v29
    v_add_u32 v41, 8187281, v41
    v_bfe_u32 v37, v29, 24, 2
    v_lshlrev_b32 v33, 2, v33
    v_lshrrev_b32 v41, 24, v41
    v_lshl_or_b32 v33, v37, 8, v33
    v_lshl_or_b32 v33, v41, 7, v33
    ds_add_rtn_u32 v37, v33, v7
    v_mul_u32_u24 v30, s58, v14
    v_and_b32 v42, 0xffffff, v30
    v_lshrrev_b32 v34, 26, v30
    v_add_u32 v42, 8187281, v42
    v_bfe_u32 v38, v30, 24, 2
    v_lshlrev_b32 v34, 2, v34
    v_lshrrev_b32 v42, 24, v42
    v_lshl_or_b32 v34, v38, 8, v34
    v_lshl_or_b32 v34, v42, 7, v34
    ds_add_rtn_u32 v38, v34, v7
    v_mul_u32_u24 v31, s58, v15
    v_and_b32 v43, 0xffffff, v31
    v_lshrrev_b32 v35, 26, v31
    v_add_u32 v43, 8187281, v43
    v_bfe_u32 v39, v31, 24, 2
    v_lshlrev_b32 v35, 2, v35
    v_lshrrev_b32 v43, 24, v43
    v_lshl_or_b32 v35, v39, 8, v35
    v_lshl_or_b32 v35, v43, 7, v35
    ds_add_rtn_u32 v39, v35, v7
    v_lshrrev_b32 v28, 24, v28
    v_mad_u32_u24 v28, v28, s59, 7
    v_lshrrev_b32 v28, 3, v28
    v_mad_u32_u24 v28, v40, 40, v28
    v_sub_u32 v28, v12, v28
    v_add_u32 v12, 0, v3
    v_lshl_or_b32 v28, v28, 26, v12
    v_lshrrev_b32 v29, 24, v29
    v_mad_u32_u24 v29, v29, s59, 7
    v_lshrrev_b32 v29, 3, v29
    v_mad_u32_u24 v29, v41, 40, v29
    v_sub_u32 v29, v13, v29
    v_add_u32 v13, 32, v3
    v_lshl_or_b32 v29, v29, 26, v13
    v_lshrrev_b32 v30, 24, v30
    v_mad_u32_u24 v30, v30, s59, 7
    v_lshrrev_b32 v30, 3, v30
    v_mad_u32_u24 v30, v42, 40, v30
    v_sub_u32 v30, v14, v30
    v_add_u32 v14, 64, v3
    v_lshl_or_b32 v30, v30, 26, v14
    v_lshrrev_b32 v31, 24, v31
    v_mad_u32_u24 v31, v31, s59, 7
    v_lshrrev_b32 v31, 3, v31
    v_mad_u32_u24 v31, v43, 40, v31
    v_sub_u32 v31, v15, v31
    v_add_u32 v15, 96, v3
    v_lshl_or_b32 v31, v31, 26, v15
K2_PAD_S2:
    s_cbranch_execz KS_HOP0
    v_mov_b32 v59, 163456
    s_mul_i32 s65, s2, 1152
    s_add_u32 s65, s65, 6291456
    s_mul_i32 s64, s2, 20608
    s_waitcnt lgkmcnt(0)
    s_barrier
    ds_read_b128 v[40:43], v9
    ds_read_b32 v59, v59
    s_waitcnt lgkmcnt(1)
    v_add_u32 v45, v40, v41
    v_add_u32 v46, v45, v42
    v_add_u32 v47, v46, v43
    v_mov_b32 v58, v47
    s_nop 1
    v_add_u32_dpp v58, v58, v58 row_shr:1 row_mask:0xf bank_mask:0xf bound_ctrl:0
    s_nop 1
    v_add_u32_dpp v58, v58, v58 row_shr:2 row_mask:0xf bank_mask:0xf bound_ctrl:0
    s_nop 1
    v_add_u32_dpp v58, v58, v58 row_shr:4 row_mask:0xf bank_mask:0xf bound_ctrl:0
    s_nop 1
    v_add_u32_dpp v58, v58, v58 row_shr:8 row_mask:0xf bank_mask:0xf bound_ctrl:0
    s_nop 1
    v_add_u32_dpp v58, v58, v58 row_bcast:15 row_mask:0xa bank_mask:0xf
    s_nop 1
    v_add_u32_dpp v58, v58, v58 row_bcast:31 row_mask:0xc bank_mask:0xf
    v_sub_u32 v48, v58, v47
    v_add_u32 v49, v48, v40
    v_add_u32 v50, v48, v45
    v_add_u32 v51, v48, v46
    ds_write_b128 v9, v[48:51] offset:1024
    s_waitcnt lgkmcnt(1)
    s_cmp_lg_u32 s20, 4
    s_cbranch_scc1 KS_NOPUB
    v_lshl_or_b32 v56, v49, 11, v48
    v_lshl_or_b32 v57, v51, 11, v50
    v_lshl_or_b32 v56, v59, 22, v56
    v_lshl_or_b32 v57, v59, 22, v57
    buffer_store_dwordx4 v[56:59], v9, s[8:11], s65 offen sc1
KS_NOPUB:
    s_waitcnt lgkmcnt(0)
    ds_read_b32 v32, v32 offset:1024
    ds_read_b32 v33, v33 offset:1024
    ds_read_b32 v34, v34 offset:1024
    ds_read_b32 v35, v35 offset:1024
    s_cbranch_scc1 KS_PUB0
    s_waitcnt vmcnt(1)
    s_branch KS_PUB1
KS_PUB0:
    s_waitcnt vmcnt(0)
KS_PUB1:
    v_and_b32 v60, 0xffff, v59
    v_and_b32 v61, 0xffff0000, v59
    s_mov_b32 s58, 0xffff0000
    v_mov_b32 v40, v20
    v_lshl_or_b32 v41, v21, 16, v60
    v_or_b32 v42, v61, v16
    v_mov_b32 v43, v28
    v_alignbit_b32 v44, v22, v21, 16
    v_and_or_b32 v45, v22, s58, v60
    v_or_b32 v46, v61, v17
    v_mov_b32 v47, v29
    v_mov_b32 v48, v23
    v_lshl_or_b32 v49, v24, 16, v60
    v_or_b32 v50, v61, v18
    v_mov_b32 v51, v30
    v_alignbit_b32 v52, v25, v24, 16
    v_and_or_b32 v53, v25, s58, v60
    v_or_b32 v54, v61, v19
    v_mov_b32 v55, v31
    s_waitcnt lgkmcnt(0)
    v_add_lshl_u32 v32, v32, v36, 4
    ds_write_b128 v32, v[40:43] offset:2048
    v_add_lshl_u32 v33, v33, v37, 4
    ds_write_b128 v33, v[44:47] offset:2048
    v_add_lshl_u32 v34, v34, v38, 4
    ds_write_b128 v34, v[48:51] offset:2048
    v_add_lshl_u32 v35, v35, v39, 4
    ds_write_b128 v35, v[52:55] offset:2048
    v_mov_b32 v62, 163460
    s_waitcnt lgkmcnt(0)
    s_barrier
    ds_read_b32 v62, v62
    ds_read_b128 v[12:15], v5 offset:2048
    ds_read_b128 v[16:19], v5 offset:7168
    ds_read_b128 v[20:23], v5 offset:12288
    ds_read_b128 v[24:27], v5 offset:17408
    s_waitcnt lgkmcnt(3)
    buffer_store_dwordx4 v[12:15], v5, s[8:11], s64 offen sc1
    s_add_u32 s64, s64, 5120
    s_waitcnt lgkmcnt(2)
    buffer_store_dwordx4 v[16:19], v5, s[8:11], s64 offen sc1
    s_add_u32 s64, s64, 5120
    s_waitcnt lgkmcnt(1)
    buffer_store_dwordx4 v[20:23], v5, s[8:11], s64 offen sc1
    s_add_u32 s64, s64, 5120
    s_waitcnt lgkmcnt(0)
    buffer_store_dwordx4 v[24:27], v5, s[8:11], s64 offen sc1
    s_branch KS_JOIN
K2_PAD_B3:
    s_branch KS_HOP
KS_B3:
    v_mov_b32 v59, 163456
    ds_read_b32 v59, v59
    v_mov_b32 v62, 163460
    s_waitcnt lgkmcnt(0)
    s_barrier
    ds_read_b32 v62, v62
KS_JOIN:
    v_readfirstlane_b32 s2, v59
    s_mov_b32 s25, 0x400000
KS_JOIN2:
    s_waitcnt lgkmcnt(0)
    v_readfirstlane_b32 s24, v62
    s_nop 0
    s_cmp_eq_u32 s24, 0
    s_cbranch_scc1 KS_FLS
    s_bfe_u32 s24, s24, 0x10001
    s_xor_b32 s54, s54, s24
    s_lshr_b32 s21, s54, 1
    s_mul_i32 s21, s21, 625
    s_add_u32 s22, s21, 632
    s_add_u32 s21, s21, 7
    s_lshr_b32 s21, s21, 3
    s_lshr_b32 s22, s22, 3
    s_add_u32 s24, s21, 40
    s_sub_u32 s22, s22, s24
    s_bitcmp1_b32 s54, 0
    s_cselect_b32 s21, s24, s21
    s_cselect_b32 s22, s22, 40
    s_mov_b32 s23, 0
    s_mov_b32 s28, 1
    s_mov_b32 s24, 0
    s_mov_b32 s25, 1
K2_CELLS:
    v_lshrrev_b32 v178, 1, v177
    v_min_u32 v178, 249, v178
    v_mul_u32_u24 v72, 1152, v178
    s_and_b32 s58, s54, 7
    s_lshl_b32 s58, s58, 7
    s_lshr_b32 s59, s54, 5
    s_lshl_b32 s59, s59, 4
    s_add_u32 s67, s58, s59
    s_add_u32 s67, s67, 6291456
    s_cmp_eq_u32 s28, 0
    s_cbranch_scc1 K2_NOSRD
    s_mov_b32 s4, s80
    s_and_b32 s5, s81, 0xffff
    s_mov_b32 s6, 10240000
    s_mov_b32 s7, 0x20000
    s_mov_b32 s12, s96
    s_and_b32 s13, s97, 0xffff
    s_mov_b32 s14, 10240000
    s_mov_b32 s15, 0x20000
    s_mov_b32 s16, s84
    s_and_b32 s17, s85, 0xffff
    s_mov_b32 s18, 10240000
    s_mov_b32 s19, 0x20000
    s_sub_u32 s80, s80, 1024
    s_subb_u32 s81, s81, 0
    s_mov_b32 s72, s80
    s_and_b32 s73, s81, 0xffff
    s_mov_b32 s74, 10241024
    s_mov_b32 s75, 0x20000
    s_mov_b64 exec, 0
    s_cmp_eq_u32 s20, 0
    s_cbranch_scc1 K2_PAD_U20
    s_cmp_eq_u32 s20, 1
    s_cbranch_scc1 K2_PAD_U30
    s_cmp_eq_u32 s20, 2
    s_cbranch_scc1 K2_PAD_U21
    s_cmp_eq_u32 s20, 3
    s_cbranch_scc1 K2_PAD_U31
    s_cmp_eq_u32 s20, 4
    s_cbranch_scc1 K2_PAD_SW
    s_cmp_eq_u32 s20, 5
    s_cbranch_scc1 K2_PAD_TL
    s_cmp_eq_u32 s20, 6
    s_cbranch_scc1 K2_PAD_T2
K2_HOP:
    s_mov_b64 exec, -1
K2_NOSRD:
    v_and_b32 v84, 15, v176
    v_lshrrev_b32 v85, 5, v176
    v_bfe_u32 v86, v176, 4, 1
    v_lshrrev_b32 v87, 2, v84
    v_and_b32 v88, 3, v84
    v_lshl_add_u32 v89, v85, 2, v87
    v_lshlrev_b32 v249, 6, v89
    v_lshl_add_u32 v249, v88, 3, v249
    v_add_u32 v249, 512, v249
    v_lshrrev_b32 v90, 3, v84
    v_lshl_add_u32 v90, v90, 1, v86
    v_sub_u32 v90, v90, 1 clamp
    v_lshlrev_b32 v250, 1, v90
    v_lshl_add_u32 v91, v85, 2, v88
    v_lshl_add_u32 v250, v91, 4, v250
    v_and_b32 v91, 1, v87
    v_lshl_add_u32 v250, v91, 3, v250
    v_lshrrev_b32 v90, 1, v88
    v_lshl_add_u32 v90, v86, 1, v90
    v_bfe_u32 v91, v87, 1, 1
    v_lshlrev_b32 v91, 2, v91
    v_xor_b32 v90, v90, v91
    v_lshlrev_b32 v90, 4, v90
    v_lshl_add_u32 v90, v89, 7, v90
    v_and_b32 v91, 1, v88
    v_lshl_add_u32 v90, v91, 3, v90
    v_add_u32 v246, s37, v90
    v_xor_b32 v247, 64, v246
    v_lshrrev_b32 v90, 3, v176
    v_lshlrev_b32 v251, 4, v90
    v_bfe_u32 v90, v90, 1, 1
    v_lshlrev_b32 v90, 2, v90
    v_and_b32 v91, 7, v176
    v_xor_b32 v90, v90, v91
    v_lshlrev_b32 v248, 4, v90
    v_lshlrev_b32 v252, 1, v176
    v_and_b32 v231, 1, v176
    v_lshlrev_b32 v231, 4, v231
    v_lshrrev_b32 v90, 1, v176
    v_lshlrev_b32 v90, 5, v90
    v_add_u32 v230, 512, v90
    s_cmp_eq_u32 s28, 0
    s_cbranch_scc1 K2_NOW0
    v_lshrrev_b32 v60, 6, v252
    v_bfe_u32 v61, v252, 3, 2
    v_lshl_add_u32 v60, v60, 2, v61
    v_mul_u32_u24 v60, 640, v60
    v_bfe_u32 v61, v252, 5, 1
    v_lshl_add_u32 v60, v61, 5, v60
    v_and_b32 v61, 6, v252
    v_lshl_add_u32 v60, v61, 2, v60
    v_add_u32 v60, 24576, v60
    ds_read_b64_tr_b16 v[136:137], v60 offset:0
    ds_read_b64_tr_b16 v[138:139], v60 offset:5120
    ds_read_b64_tr_b16 v[140:141], v60 offset:64
    ds_read_b64_tr_b16 v[142:143], v60 offset:5184
    ds_read_b64_tr_b16 v[144:145], v60 offset:128
    ds_read_b64_tr_b16 v[146:147], v60 offset:5248
    ds_read_b64_tr_b16 v[148:149], v60 offset:192
    ds_read_b64_tr_b16 v[150:151], v60 offset:5312
    ds_read_b64_tr_b16 v[152:153], v60 offset:256
    ds_read_b64_tr_b16 v[154:155], v60 offset:5376
    ds_read_b64_tr_b16 v[156:157], v60 offset:320
    ds_read_b64_tr_b16 v[158:159], v60 offset:5440
    ds_read_b64_tr_b16 v[160:161], v60 offset:384
    ds_read_b64_tr_b16 v[162:163], v60 offset:5504
    ds_read_b64_tr_b16 v[164:165], v60 offset:448
    ds_read_b64_tr_b16 v[166:167], v60 offset:5568
    ds_read_b64_tr_b16 v[168:169], v60 offset:512
    ds_read_b64_tr_b16 v[170:171], v60 offset:5632
    ds_read_b64_tr_b16 v[172:173], v60 offset:576
    ds_read_b64_tr_b16 v[174:175], v60 offset:5696
    s_waitcnt lgkmcnt(0)
    v_lshlrev_b32 v96, 16, v136
    v_and_b32 v97, 0xffff0000, v136
    v_lshlrev_b32 v98, 16, v137
    v_and_b32 v99, 0xffff0000, v137
    v_lshlrev_b32 v100, 16, v138
    v_and_b32 v101, 0xffff0000, v138
    v_lshlrev_b32 v102, 16, v139
    v_and_b32 v103, 0xffff0000, v139
    v_lshlrev_b32 v104, 16, v140
    v_and_b32 v105, 0xffff0000, v140
    v_lshlrev_b32 v106, 16, v141
    v_and_b32 v107, 0xffff0000, v141
    v_lshlrev_b32 v108, 16, v142
    v_and_b32 v109, 0xffff0000, v142
    v_lshlrev_b32 v110, 16, v143
    v_and_b32 v111, 0xffff0000, v143
    v_lshlrev_b32 v112, 16, v144
    v_and_b32 v113, 0xffff0000, v144
    v_lshlrev_b32 v114, 16, v145
    v_and_b32 v115, 0xffff0000, v145
    v_lshlrev_b32 v116, 16, v146
    v_and_b32 v117, 0xffff0000, v146
    v_lshlrev_b32 v118, 16, v147
    v_and_b32 v119, 0xffff0000, v147
    v_lshlrev_b32 v120, 16, v148
    v_and_b32 v121, 0xffff0000, v148
    v_lshlrev_b32 v122, 16, v149
    v_and_b32 v123, 0xffff0000, v149
    v_lshlrev_b32 v124, 16, v150
    v_and_b32 v125, 0xffff0000, v150
    v_lshlrev_b32 v126, 16, v151
    v_and_b32 v127, 0xffff0000, v151
    buffer_load_dwordx4 v[76:79], v72, s[8:11], s67 offen sc1
    v_lshlrev_b32 v128, 16, v152
    v_and_b32 v129, 0xffff0000, v152
    v_lshlrev_b32 v130, 16, v153
    v_and_b32 v131, 0xffff0000, v153
    v_lshlrev_b32 v132, 16, v154
    v_and_b32 v133, 0xffff0000, v154
    v_lshlrev_b32 v134, 16, v155
    v_and_b32 v135, 0xffff0000, v155
    v_lshlrev_b32 v136, 16, v156
    v_and_b32 v137, 0xffff0000, v156
    v_lshlrev_b32 v138, 16, v157
    v_and_b32 v139, 0xffff0000, v157
    v_lshlrev_b32 v140, 16, v158
    v_and_b32 v141, 0xffff0000, v158
    v_lshlrev_b32 v142, 16, v159
    v_and_b32 v143, 0xffff0000, v159
    v_lshlrev_b32 v144, 16, v160
    v_and_b32 v145, 0xffff0000, v160
    v_lshlrev_b32 v146, 16, v161
    v_and_b32 v147, 0xffff0000, v161
    v_lshlrev_b32 v148, 16, v162
    v_and_b32 v149, 0xffff0000, v162
    v_lshlrev_b32 v150, 16, v163
    v_and_b32 v151, 0xffff0000, v163
    v_lshlrev_b32 v152, 16, v164
    v_and_b32 v153, 0xffff0000, v164
    v_lshlrev_b32 v154, 16, v165
    v_and_b32 v155, 0xffff0000, v165
    v_lshlrev_b32 v156, 16, v166
    v_and_b32 v157, 0xffff0000, v166
    v_lshlrev_b32 v158, 16, v167
    v_and_b32 v159, 0xffff0000, v167
    v_lshlrev_b32 v160, 16, v168
    v_and_b32 v161, 0xffff0000, v168
    v_lshlrev_b32 v162, 16, v169
    v_and_b32 v163, 0xffff0000, v169
    v_lshlrev_b32 v164, 16, v170
    v_and_b32 v165, 0xffff0000, v170
    v_lshlrev_b32 v166, 16, v171
    v_and_b32 v167, 0xffff0000, v171
    v_lshlrev_b32 v168, 16, v172
    v_and_b32 v169, 0xffff0000, v172
    v_lshlrev_b32 v170, 16, v173
    v_and_b32 v171, 0xffff0000, v173
    v_lshlrev_b32 v172, 16, v174
    v_and_b32 v173, 0xffff0000, v174
    v_lshlrev_b32 v174, 16, v175
    v_and_b32 v175, 0xffff0000, v175
K2_W0:
    s_lshl_b32 s59, s2, 22
    s_mov_b32 s60, 0x40000
    s_bfe_u32 s61, s54, 0x10004
    s_bfe_u32 s62, s54, 0x10003
    s_add_u32 s63, s61, s62
    s_mul_i32 s62, s62, 11
    s_sub_u32 s64, 11, s62
    v_cmp_gt_u32 vcc, 500, v177
    s_nop 0
    s_mov_b64 s[56:57], vcc
K2_POLL:
    s_waitcnt vmcnt(0)
    v_xor_b32 v73, s59, v76
    v_xor_b32 v74, s59, v77
    v_or_b32 v73, v73, v74
    v_xor_b32 v74, s2, v79
    v_lshrrev_b32 v73, 22, v73
    v_or_b32 v73, v73, v74
    v_cmp_ne_u32 vcc, 0, v73
    s_nop 0
    s_cbranch_vccz K2_POLLED
    s_sub_u32 s60, s60, 1
    s_cbranch_scc1 K2_END
    s_mov_b64 exec, vcc
    buffer_load_dwordx4 v[76:79], v72, s[8:11], s67 offen sc1
    s_mov_b64 exec, -1
    s_branch K2_POLL
K2_PAD_LD:
    s_branch KS_HOP
K2_POLLED:
    s_set_gpr_idx_on s61, gpr_idx(SRC0)
    s_nop 0
    v_bfe_u32 v179, v76, s62, 11
    s_set_gpr_idx_idx s63
    s_nop 0
    v_bfe_u32 v73, v76, s64, 11
    s_set_gpr_idx_off
    v_sub_u32 v73, v73, v179
    v_cndmask_b32 v73, 0, v73, s[56:57]
    v_and_b32 v1, 1, v177
    v_add_u32 v1, s23, v1
    v_sub_u32 v180, v73, v1
    v_add_u32 v179, v179, v1
    v_mul_u32_u24 v181, 20608, v178
    v_lshl_add_u32 v181, v179, 4, v181
    v_cmp_lt_i32 s[40:41], 0, v180
    v_add_u32 v182, 32, v181
    s_mov_b32 s65, 0
    s_mov_b64 exec, s[40:41]
    buffer_load_dwordx4 v[0:3], v181, s[8:11], 0 offen offset:0 sc1
    s_mov_b64 exec, -1
    v_cmp_lt_i32 s[42:43], 2, v180
    v_cmp_lt_i32 s[44:45], 4, v180
    v_cmp_lt_i32 s[46:47], 6, v180
    v_cmp_lt_i32 s[48:49], 8, v180
    v_cmp_lt_i32 s[50:51], 10, v180
    v_cmp_lt_i32 s[90:91], 12, v180
    v_cmp_lt_i32 s[92:93], 14, v180
    v_cmp_lt_i32 s[94:95], 16, v180
    v_cmp_lt_i32 s[96:97], 18, v180
    v_add_u32 v183, 64, v181
    v_add_u32 v184, 96, v181
    v_subrev_u32 v62, 1, v180
    v_ashrrev_i32 v62, 1, v62
    v_med3_i32 v62, v62, 0, 9
    s_cmp_eq_u64 s[42:43], 0
    s_cbranch_scc1 K2_LD_DONE
    v_mov_b32 v63, v62
    s_nop 1
    v_add_u32_dpp v63, v63, v63 row_shr:1 row_mask:0xf bank_mask:0xf bound_ctrl:0
    s_nop 1
    v_add_u32_dpp v63, v63, v63 row_shr:2 row_mask:0xf bank_mask:0xf bound_ctrl:0
    s_nop 1
    v_add_u32_dpp v63, v63, v63 row_shr:4 row_mask:0xf bank_mask:0xf bound_ctrl:0
    s_nop 1
    v_add_u32_dpp v63, v63, v63 row_shr:8 row_mask:0xf bank_mask:0xf bound_ctrl:0
    s_nop 1
    v_add_u32_dpp v63, v63, v63 row_bcast:15 row_mask:0xa bank_mask:0xf
    s_nop 1
    v_add_u32_dpp v63, v63, v63 row_bcast:31 row_mask:0xc bank_mask:0xf
    s_lshl_b32 s58, s20, 10
    s_add_u32 s58, s58, 45056
    v_readlane_b32 s59, v63, 63
    v_sub_u32 v63, v63, v62
    v_lshl_add_u32 v64, v63, 2, s58
    v_lshlrev_b32 v63, 5, v63
    v_sub_u32 v63, v182, v63
    s_cmp_gt_u32 s59, 189
    s_cbranch_scc1 K2_LD_GEN
    s_mov_b64 exec, s[42:43]
    s_cbranch_execz K2_LD_L
    ds_write_b32 v64, v63 offset:0
    s_mov_b64 exec, s[44:45]
    s_cbranch_execz K2_LD_L
    ds_write_b32 v64, v63 offset:4
    s_mov_b64 exec, s[46:47]
    s_cbranch_execz K2_LD_L
    ds_write_b32 v64, v63 offset:8
    s_mov_b64 exec, s[48:49]
    s_cbranch_execz K2_LD_L
    ds_write_b32 v64, v63 offset:12
    s_mov_b64 exec, s[50:51]
    s_cbranch_execz K2_LD_L
    ds_write_b32 v64, v63 offset:16
    s_mov_b64 exec, s[90:91]
    s_cbranch_execz K2_LD_L
    ds_write_b32 v64, v63 offset:20
    s_mov_b64 exec, s[92:93]
    s_cbranch_execz K2_LD_L
    ds_write_b32 v64, v63 offset:24
    s_mov_b64 exec, s[94:95]
    s_cbranch_execz K2_LD_L
    ds_write_b32 v64, v63 offset:28
    s_mov_b64 exec, s[96:97]
    s_cbranch_execz K2_LD_L
    ds_write_b32 v64, v63 offset:32
K2_LD_L:
    s_mov_b64 exec, -1
    v_lshl_add_u32 v63, v176, 2, s58
    v_lshlrev_b32 v62, 5, v176
    s_waitcnt lgkmcnt(0)
    ds_read_b32 v64, v63 offset:0
    ds_read_b32 v65, v63 offset:252
    ds_read_b32 v66, v63 offset:504
    s_min_u32 s60, s59, 63
    s_sub_u32 s59, s59, s60
    s_bfm_b64 s[42:43], s60, 0
    s_min_u32 s60, s59, 63
    s_sub_u32 s59, s59, s60
    s_bfm_b64 s[44:45], s60, 0
    s_min_u32 s60, s59, 63
    s_sub_u32 s59, s59, s60
    s_bfm_b64 s[46:47], s60, 0
    s_mov_b64 s[48:49], 0
    s_mov_b32 s65, 1
    s_mov_b32 s60, 0
    s_waitcnt lgkmcnt(2)
    v_add3_u32 v182, v62, v64, s60
    s_mov_b64 exec, s[42:43]
    buffer_load_dwordx4 v[4:7], v182, s[8:11], 0 offen sc1
    s_mov_b32 s60, 2016
    s_waitcnt lgkmcnt(1)
    v_add3_u32 v183, v62, v65, s60
    s_mov_b64 exec, s[44:45]
    buffer_load_dwordx4 v[8:11], v183, s[8:11], 0 offen sc1
    s_mov_b32 s60, 4032
    s_waitcnt lgkmcnt(0)
    v_add3_u32 v184, v62, v66, s60
    s_mov_b64 exec, s[46:47]
    buffer_load_dwordx4 v[12:15], v184, s[8:11], 0 offen sc1
K2_LD_DONE:
    s_mov_b64 exec, -1
    s_cmp_eq_u32 s28, 0
    s_cbranch_scc1 K2_WLATE
K2_NOWRAW:
K2_PAD_NW:
    s_cbranch_execz KS_HOP
    v_lshrrev_b32 v179, 2, v181
    v_lshrrev_b32 v185, 2, v182
    v_lshrrev_b32 v186, 2, v183
    v_lshrrev_b32 v187, 2, v184
    s_mov_b32 s66, 7340032
    v_mov_b32 v201, 1
    s_movk_i32 s58, 520
    s_movk_i32 s59, 2080
    s_mov_b32 s60, 0x40000
    s_mov_b32 s61, 0xffff
    v_mov_b32 v202, 65536
    s_cmp_lg_u32 s24, 0
    s_cbranch_scc1 K2_RK_LOAD
    v_cmp_lt_i32 vcc, 20, v180
    s_nop 0
    s_cbranch_vccz K2_NOMORE
    v_mov_b32 v61, 163300
    ds_write_b32 v61, v201
K2_NOMORE:
    s_mov_b32 s62, 82176
    s_cmp_eq_u32 s65, 0
    s_waitcnt vmcnt(3)
    s_cbranch_scc0 K2_ARR
    s_waitcnt vmcnt(0)
K2_ARR:
    s_mov_b64 exec, s[40:41]
    s_cbranch_execz K2_RK_A
K2_CK0:
    v_bfi_b32 v192, s61, v1, v2
    v_lshrrev_b32 v50, 24, v3
    v_cmp_ne_u32 vcc, s2, v192
    v_add_u32 v40, 163072, v50
    s_cbranch_vccnz K2_RT0
    ds_add_rtn_u32 v40, v40, v201
    v_mad_u32_u24 v50, v50, s58, v202
    s_mov_b64 exec, s[42:43]
    s_cbranch_execz K2_RK_A
    s_waitcnt vmcnt(2)
K2_CK1:
    v_bfi_b32 v192, s61, v5, v6
    v_lshrrev_b32 v51, 24, v7
    v_cmp_ne_u32 vcc, s2, v192
    v_add_u32 v41, 163072, v51
    s_cbranch_vccnz K2_RT1
    ds_add_rtn_u32 v41, v41, v201
    v_mad_u32_u24 v51, v51, s58, v202
    s_mov_b64 exec, s[44:45]
    s_cbranch_execz K2_RK_A
    s_waitcnt vmcnt(1)
K2_CK2:
    v_bfi_b32 v192, s61, v9, v10
    v_lshrrev_b32 v52, 24, v11
    v_cmp_ne_u32 vcc, s2, v192
    v_add_u32 v42, 163072, v52
    s_cbranch_vccnz K2_RT2
    ds_add_rtn_u32 v42, v42, v201
    v_mad_u32_u24 v52, v52, s58, v202
    s_mov_b64 exec, s[46:47]
    s_cbranch_execz K2_RK_A
    s_waitcnt vmcnt(0)
K2_CK3:
    v_bfi_b32 v192, s61, v13, v14
    v_lshrrev_b32 v53, 24, v15
    v_cmp_ne_u32 vcc, s2, v192
    v_add_u32 v43, 163072, v53
    s_cbranch_vccnz K2_RT3
    ds_add_rtn_u32 v43, v43, v201
    v_mad_u32_u24 v53, v53, s58, v202
    s_mov_b64 exec, s[48:49]
    s_cbranch_execz K2_RK_A
K2_CK4:
    v_bfi_b32 v192, s61, v17, v18
    v_lshrrev_b32 v54, 24, v19
    v_cmp_ne_u32 vcc, s2, v192
    v_add_u32 v44, 163072, v54
    s_cbranch_vccnz K2_RT4
    ds_add_rtn_u32 v44, v44, v201
    v_mad_u32_u24 v54, v54, s58, v202
    s_mov_b64 exec, s[50:51]
    s_cbranch_execz K2_RK_A
K2_CK5:
    v_bfi_b32 v192, s61, v21, v22
    v_lshrrev_b32 v55, 24, v23
    v_cmp_ne_u32 vcc, s2, v192
    v_add_u32 v45, 163072, v55
    s_cbranch_vccnz K2_RT5
    ds_add_rtn_u32 v45, v45, v201
    v_mad_u32_u24 v55, v55, s58, v202
    s_mov_b64 exec, s[90:91]
    s_cbranch_execz K2_RK_A
K2_CK6:
    v_bfi_b32 v192, s61, v25, v26
    v_lshrrev_b32 v56, 24, v27
    v_cmp_ne_u32 vcc, s2, v192
    v_add_u32 v46, 163072, v56
    s_cbranch_vccnz K2_RT6
    ds_add_rtn_u32 v46, v46, v201
    v_mad_u32_u24 v56, v56, s58, v202
    s_mov_b64 exec, s[92:93]
    s_cbranch_execz K2_RK_A
K2_CK7:
    v_bfi_b32 v192, s61, v29, v30
    v_lshrrev_b32 v57, 24, v31
    v_cmp_ne_u32 vcc, s2, v192
    v_add_u32 v47, 163072, v57
    s_cbranch_vccnz K2_RT7
    ds_add_rtn_u32 v47, v47, v201
    v_mad_u32_u24 v57, v57, s58, v202
    s_mov_b64 exec, s[94:95]
    s_cbranch_execz K2_RK_A
K2_CK8:
    v_bfi_b32 v192, s61, v33, v34
    v_lshrrev_b32 v58, 24, v35
    v_cmp_ne_u32 vcc, s2, v192
    v_add_u32 v48, 163072, v58
    s_cbranch_vccnz K2_RT8
    ds_add_rtn_u32 v48, v48, v201
    v_mad_u32_u24 v58, v58, s58, v202
    s_mov_b64 exec, s[96:97]
    s_cbranch_execz K2_RK_A
K2_CK9:
    v_bfi_b32 v192, s61, v37, v38
    v_lshrrev_b32 v59, 24, v39
    v_cmp_ne_u32 vcc, s2, v192
    v_add_u32 v49, 163072, v59
    s_cbranch_vccnz K2_RT9
    ds_add_rtn_u32 v49, v49, v201
    v_mad_u32_u24 v59, v59, s58, v202
K2_RK_A:
    s_mov_b64 exec, -1
    s_mov_b64 exec, s[40:41]
    s_cbranch_execz K2_TP
    v_cmp_gt_u32 vcc, s62, v50
    v_and_b32 v3, 0xffffff, v3
    s_mov_b64 exec, vcc
    buffer_load_dword v245, v3, s[16:19], 0 offen
    s_mov_b64 exec, s[42:43]
    s_cbranch_execz K2_TP
    v_cmp_gt_u32 vcc, s62, v51
    v_and_b32 v7, 0xffffff, v7
    s_mov_b64 exec, vcc
    buffer_load_dword v245, v7, s[16:19], 0 offen
    s_mov_b64 exec, s[44:45]
    s_cbranch_execz K2_TP
    v_cmp_gt_u32 vcc, s62, v52
    v_and_b32 v11, 0xffffff, v11
    s_mov_b64 exec, vcc
    buffer_load_dword v245, v11, s[16:19], 0 offen
    s_mov_b64 exec, s[46:47]
    s_cbranch_execz K2_TP
    v_cmp_gt_u32 vcc, s62, v53
    v_and_b32 v15, 0xffffff, v15
    s_mov_b64 exec, vcc
    buffer_load_dword v245, v15, s[16:19], 0 offen
    s_mov_b64 exec, s[48:49]
    s_cbranch_execz K2_TP
    v_cmp_gt_u32 vcc, s62, v54
    v_and_b32 v19, 0xffffff, v19
    s_mov_b64 exec, vcc
    buffer_load_dword v245, v19, s[16:19], 0 offen
    s_mov_b64 exec, s[50:51]
    s_cbranch_execz K2_TP
    v_cmp_gt_u32 vcc, s62, v55
    v_and_b32 v23, 0xffffff, v23
    s_mov_b64 exec, vcc
    buffer_load_dword v245, v23, s[16:19], 0 offen
    s_mov_b64 exec, s[90:91]
    s_cbranch_execz K2_TP
    v_cmp_gt_u32 vcc, s62, v56
    v_and_b32 v27, 0xffffff, v27
    s_mov_b64 exec, vcc
    buffer_load_dword v245, v27, s[16:19], 0 offen
    s_mov_b64 exec, s[92:93]
    s_cbranch_execz K2_TP
    v_cmp_gt_u32 vcc, s62, v57
    v_and_b32 v31, 0xffffff, v31
    s_mov_b64 exec, vcc
    buffer_load_dword v245, v31, s[16:19], 0 offen
    s_mov_b64 exec, s[94:95]
    s_cbranch_execz K2_TP
    v_cmp_gt_u32 vcc, s62, v58
    v_and_b32 v35, 0xffffff, v35
    s_mov_b64 exec, vcc
    buffer_load_dword v245, v35, s[16:19], 0 offen
    s_mov_b64 exec, s[96:97]
    s_cbranch_execz K2_TP
    v_cmp_gt_u32 vcc, s62, v59
    v_and_b32 v39, 0xffffff, v39
    s_mov_b64 exec, vcc
    buffer_load_dword v245, v39, s[16:19], 0 offen
K2_TP:
    s_mov_b64 exec, -1
K2_RK_DONE:
K2_PAD_SC:
    s_cbranch_execz KS_HOP
    s_mul_i32 s67, s24, 48
    s_movk_i32 s58, -1532
    s_waitcnt lgkmcnt(0)
    s_mov_b64 exec, s[40:41]
    s_cbranch_execz K2_SC_DONE
    v_cmpx_gt_u32 vcc, 64, v40
    v_bfe_u32 v194, v40, 3, 1
    v_add_u32 v193, 16, v40
    v_lshl_or_b32 v194, v40, 1, v194
    v_bfi_b32 v194, 15, v194, v40
    v_lshrrev_b32 v193, 6, v193
    v_alignbit_b32 v1, v2, v1, 16
    v_lshl_add_u32 v195, v194, 3, v50
    v_lshl_add_u32 v194, v194, 5, v50
    ds_write_b64 v195, v[0:1]
    v_mad_i32_i24 v194, v193, s58, v194
    ds_write_b32 v194, v3 offset:512
    s_mov_b64 exec, s[42:43]
    s_cbranch_execz K2_SC_DONE
    v_cmpx_gt_u32 vcc, 64, v41
    v_bfe_u32 v194, v41, 3, 1
    v_add_u32 v193, 16, v41
    v_lshl_or_b32 v194, v41, 1, v194
    v_bfi_b32 v194, 15, v194, v41
    v_lshrrev_b32 v193, 6, v193
    v_alignbit_b32 v5, v6, v5, 16
    v_lshl_add_u32 v195, v194, 3, v51
    v_lshl_add_u32 v194, v194, 5, v51
    ds_write_b64 v195, v[4:5]
    v_mad_i32_i24 v194, v193, s58, v194
    ds_write_b32 v194, v7 offset:512
    s_mov_b64 exec, s[44:45]
    s_cbranch_execz K2_SC_DONE
    v_cmpx_gt_u32 vcc, 64, v42
    v_bfe_u32 v194, v42, 3, 1
    v_add_u32 v193, 16, v42
    v_lshl_or_b32 v194, v42, 1, v194
    v_bfi_b32 v194, 15, v194, v42
    v_lshrrev_b32 v193, 6, v193
    v_alignbit_b32 v9, v10, v9, 16
    v_lshl_add_u32 v195, v194, 3, v52
    v_lshl_add_u32 v194, v194, 5, v52
    ds_write_b64 v195, v[8:9]
    v_mad_i32_i24 v194, v193, s58, v194
    ds_write_b32 v194, v11 offset:512
    s_mov_b64 exec, s[46:47]
    s_cbranch_execz K2_SC_DONE
    v_cmpx_gt_u32 vcc, 64, v43
    v_bfe_u32 v194, v43, 3, 1
    v_add_u32 v193, 16, v43
    v_lshl_or_b32 v194, v43, 1, v194
    v_bfi_b32 v194, 15, v194, v43
    v_lshrrev_b32 v193, 6, v193
    v_alignbit_b32 v13, v14, v13, 16
    v_lshl_add_u32 v195, v194, 3, v53
    v_lshl_add_u32 v194, v194, 5, v53
    ds_write_b64 v195, v[12:13]
    v_mad_i32_i24 v194, v193, s58, v194
    ds_write_b32 v194, v15 offset:512
    s_mov_b64 exec, s[48:49]
    s_cbranch_execz K2_SC_DONE
    v_cmpx_gt_u32 vcc, 64, v44
    v_bfe_u32 v194, v44, 3, 1
    v_add_u32 v193, 16, v44
    v_lshl_or_b32 v194, v44, 1, v194
    v_bfi_b32 v194, 15, v194, v44
    v_lshrrev_b32 v193, 6, v193
    v_alignbit_b32 v17, v18, v17, 16
    v_lshl_add_u32 v195, v194, 3, v54
    v_lshl_add_u32 v194, v194, 5, v54
    ds_write_b64 v195, v[16:17]
    v_mad_i32_i24 v194, v193, s58, v194
    ds_write_b32 v194, v19 offset:512
    s_mov_b64 exec, s[50:51]
    s_cbranch_execz K2_SC_DONE
    v_cmpx_gt_u32 vcc, 64, v45
    v_bfe_u32 v194, v45, 3, 1
    v_add_u32 v193, 16, v45
    v_lshl_or_b32 v194, v45, 1, v194
    v_bfi_b32 v194, 15, v194, v45
    v_lshrrev_b32 v193, 6, v193
    v_alignbit_b32 v21, v22, v21, 16
    v_lshl_add_u32 v195, v194, 3, v55
    v_lshl_add_u32 v194, v194, 5, v55
    ds_write_b64 v195, v[20:21]
    v_mad_i32_i24 v194, v193, s58, v194
    ds_write_b32 v194, v23 offset:512
    s_mov_b64 exec, s[90:91]
    s_cbranch_execz K2_SC_DONE
    v_cmpx_gt_u32 vcc, 64, v46
    v_bfe_u32 v194, v46, 3, 1
    v_add_u32 v193, 16, v46
    v_lshl_or_b32 v194, v46, 1, v194
    v_bfi_b32 v194, 15, v194, v46
    v_lshrrev_b32 v193, 6, v193
    v_alignbit_b32 v25, v26, v25, 16
    v_lshl_add_u32 v195, v194, 3, v56
    v_lshl_add_u32 v194, v194, 5, v56
    ds_write_b64 v195, v[24:25]
    v_mad_i32_i24 v194, v193, s58, v194
    ds_write_b32 v194, v27 offset:512
    s_mov_b64 exec, s[92:93]
    s_cbranch_execz K2_SC_DONE
    v_cmpx_gt_u32 vcc, 64, v47
    v_bfe_u32 v194, v47, 3, 1
    v_add_u32 v193, 16, v47
    v_lshl_or_b32 v194, v47, 1, v194
    v_bfi_b32 v194, 15, v194, v47
    v_lshrrev_b32 v193, 6, v193
    v_alignbit_b32 v29, v30, v29, 16
    v_lshl_add_u32 v195, v194, 3, v57
    v_lshl_add_u32 v194, v194, 5, v57
    ds_write_b64 v195, v[28:29]
    v_mad_i32_i24 v194, v193, s58, v194
    ds_write_b32 v194, v31 offset:512
    s_mov_b64 exec, s[94:95]
    s_cbranch_execz K2_SC_DONE
    v_cmpx_gt_u32 vcc, 64, v48
    v_bfe_u32 v194, v48, 3, 1
    v_add_u32 v193, 16, v48
    v_lshl_or_b32 v194, v48, 1, v194
    v_bfi_b32 v194, 15, v194, v48
    v_lshrrev_b32 v193, 6, v193
    v_alignbit_b32 v33, v34, v33, 16
    v_lshl_add_u32 v195, v194, 3, v58
    v_lshl_add_u32 v194, v194, 5, v58
    ds_write_b64 v195, v[32:33]
    v_mad_i32_i24 v194, v193, s58, v194
    ds_write_b32 v194, v35 offset:512
    s_mov_b64 exec, s[96:97]
    s_cbranch_execz K2_SC_DONE
    v_cmpx_gt_u32 vcc, 64, v49
    v_bfe_u32 v194, v49, 3, 1
    v_add_u32 v193, 16, v49
    v_lshl_or_b32 v194, v49, 1, v194
    v_bfi_b32 v194, 15, v194, v49
    v_lshrrev_b32 v193, 6, v193
    v_alignbit_b32 v37, v38, v37, 16
    v_lshl_add_u32 v195, v194, 3, v59
    v_lshl_add_u32 v194, v194, 5, v59
    ds_write_b64 v195, v[36:37]
    v_mad_i32_i24 v194, v193, s58, v194
    ds_write_b32 v194, v39 offset:512
K2_SC_DONE:
    s_mov_b64 exec, -1
K2_PAD_SD:
    s_cbranch_execz KS_HOP
    v_lshlrev_b32 v192, 2, v176
    v_add_u32 v192, 163072, v192
    v_mov_b32 v200, 163300
    s_cmp_eq_u32 s24, 0
    s_cselect_b32 s26, 64, 48
    s_waitcnt lgkmcnt(0)
    s_barrier
    ds_read_b32 v193, v192
    ds_read_b32 v200, v200
    v_cmp_gt_u32 s[56:57], s22, v176
    v_mad_u32_u24 v195, v176, s59, v202
    s_waitcnt lgkmcnt(0)
    v_cndmask_b32 v193, 0, v193, s[56:57]
    v_readfirstlane_b32 s27, v200
    v_cmp_lt_u32 s[62:63], 48, v193
    v_cmp_lt_u32 vcc, 64, v193
    s_bcnt1_i32_b64 s60, s[62:63]
    v_mbcnt_lo_u32_b32 v198, s62, 0
    v_mbcnt_hi_u32_b32 v198, s63, v198
    s_cbranch_vccnz K2_BIG
    s_cmp_gt_u32 s60, 8
    s_cbranch_scc1 K2_BIG
K2_TOK:
    v_subrev_u32 v194, s67, v193
    v_max_i32 v194, 1, v194
    v_min_i32 v194, s26, v194
    v_add_u32 v194, 15, v194
    v_lshrrev_b32 v194, 3, v194
    v_lshl_or_b32 v195, v194, 18, v195
    v_lshl_or_b32 v195, v198, 27, v195
    v_mov_b32 v197, 949760
    v_cndmask_b32 v253, v197, v195, s[56:57]
    s_movk_i32 s40, 0
    s_movk_i32 s41, 256
    s_movk_i32 s42, 512
    s_movk_i32 s43, 768
    s_add_u32 s24, s24, 1
    s_cmp_ge_u32 s24, s25
    s_cselect_b32 s55, 1, 0
    s_cmp_eq_u32 s27, 0
    s_cselect_b32 s55, s55, 0
    s_mov_b32 s27, 0x400000
    s_mov_b32 s38, 0
    s_mov_b32 s34, 0
    s_mov_b32 s35, 0
    s_mov_b32 s36, 1
    s_mov_b32 s31, 0
    s_mov_b32 s58, s20
    v_readlane_b32 s3, v253, s58
    s_lshl_b32 s44, s34, 7
    s_and_b32 s48, s3, 0x3ffff
    s_bfe_u32 s33, s3, 0x30013
    s_mul_i32 s35, s38, 6
    s_cmp_eq_u32 s34, 0
    s_cselect_b32 s35, s35, s48
    s_mov_b32 s45, s44
    s_xor_b32 s47, s44, 256
    s_add_u32 s49, s48, 128
    s_add_u32 s60, s48, 256
    s_cmp_eq_u32 s33, 3
    s_cselect_b32 s46, s44, s47
    s_cselect_b32 s50, s60, s48
    s_cselect_b32 s51, s48, s49
    s_sub_u32 s60, s33, 2
    s_cmp_lt_u32 s60, 2
    s_cbranch_scc0 K2_rare_1
K2_back_2:
    v_add_u32 v233, s48, v230
    ds_read_b32 v232, v233
    ds_read_b32 v233, v233 offset:1024
    v_add_u32 v222, s48, v251
    ds_read2_b32 v[222:223], v222 offset0:1 offset1:3
    v_add_u32 v224, s49, v251
    ds_read2_b32 v[224:225], v224 offset0:1 offset1:3
    v_add_u32 v226, s50, v251
    ds_read2_b32 v[226:227], v226 offset0:1 offset1:3
    v_add_u32 v228, s51, v251
    ds_read2_b32 v[228:229], v228 offset0:1 offset1:3
    s_waitcnt lgkmcnt(4)
    v_or_b32 v232, v232, v231
    v_or_b32 v233, v233, v231
    s_cmp_lg_u32 s34, 0
    s_cbranch_scc1 K2_dum_4
    s_cmp_eq_u32 s33, 4
    s_cbranch_scc1 K2_a4_5
K2_b4_7:
    s_add_u32 m0, s48, 512
    s_add_u32 s65, s48, 1536
    buffer_load_dwordx4 v232, s[16:19], 0 offen  lds
    s_mov_b32 m0, s65
    s_mov_b32 exec_hi, 0
    buffer_load_dwordx4 v233, s[16:19], 0 offen  lds
    s_mov_b32 exec_hi, -1
K2_back_6:
    s_waitcnt lgkmcnt(3)
    v_mad_u32_u16 v222, v222, s39, v248 op_sel:[1,0,0,0]
    v_mad_u32_u16 v223, v223, s39, v248 op_sel:[1,0,0,0]
    s_waitcnt lgkmcnt(2)
    v_mad_u32_u16 v224, v224, s39, v248 op_sel:[1,0,0,0]
    v_mad_u32_u16 v225, v225, s39, v248 op_sel:[1,0,0,0]
    s_waitcnt lgkmcnt(1)
    v_mad_u32_u16 v226, v226, s39, v248 op_sel:[1,0,0,0]
    v_mad_u32_u16 v227, v227, s39, v248 op_sel:[1,0,0,0]
    s_waitcnt lgkmcnt(0)
    v_mad_u32_u16 v228, v228, s39, v248 op_sel:[1,0,0,0]
    v_mad_u32_u16 v229, v229, s39, v248 op_sel:[1,0,0,0]
    s_mov_b32 m0, s68
    s_nop 0
    buffer_load_dwordx4 v222, s[4:7], s44 offen sc1 lds
    buffer_load_dwordx4 v223, s[72:75], s44 offen offset:1024 sc1 lds
    s_mov_b32 m0, s69
    s_nop 0
    buffer_load_dwordx4 v224, s[4:7], s45 offen sc1 lds
    buffer_load_dwordx4 v225, s[72:75], s45 offen offset:1024 sc1 lds
    s_mov_b32 m0, s70
    s_nop 0
    buffer_load_dwordx4 v226, s[4:7], s46 offen sc1 lds
    buffer_load_dwordx4 v227, s[72:75], s46 offen offset:1024 sc1 lds
    s_mov_b32 m0, s71
    s_nop 0
    buffer_load_dwordx4 v228, s[4:7], s47 offen sc1 lds
    buffer_load_dwordx4 v229, s[72:75], s47 offen offset:1024 sc1 lds
    v_add_u32 v249, s48, v249
    v_add_u32 v250, s48, v250
    s_waitcnt vmcnt(6)
    ds_read_b64_tr_b16 v[176:177], v246 offset:0
    ds_read_b64_tr_b16 v[178:179], v246 offset:1024
    ds_read_b64_tr_b16 v[180:181], v247 offset:0
    ds_read_b64_tr_b16 v[182:183], v247 offset:1024
    ds_read_b64_tr_b16 v[0:1], v249 offset:0
    ds_read_b64_tr_b16 v[2:3], v249 offset:32
    ds_read_u16_d16_hi v16, v250 offset:0
    ds_read_b64_tr_b16 v[4:5], v249 offset:512
    ds_read_b64_tr_b16 v[6:7], v249 offset:544
    ds_read_u16_d16_hi v17, v250 offset:128
    s_mov_b32 s29, s48
    s_mov_b32 s32, s31
    s_mov_b32 s30, s3
    s_mov_b32 s31, s35
    s_bfe_u32 s56, s3, 0x40012
    s_cmp_eq_u32 s56, 5
    s_cbranch_scc1 K2_U20
    s_cmp_eq_u32 s56, 6
    s_cbranch_scc1 K2_U3h0
    s_branch K2_DSP0
K2_PAD_H1:
    s_branch KS_HOP0
KS_HELP:
    s_mov_b32 s30, 0
    s_cmp_eq_u32 s20, 6
    s_cbranch_scc1 KS_RAW
    s_mov_b32 s30, 2
    s_cmp_ge_u32 s2, 170
    s_cbranch_scc1 KS_NOW
    s_mov_b32 s30, 1
    v_and_b32 v1, 15, v8
    v_lshrrev_b32 v3, 4, v8
    s_cmp_ge_u32 s2, 160
    s_cbranch_scc1 K1_WT
    s_cmp_ge_u32 s2, 64
    s_cbranch_scc1 K1_S1
    s_lshr_b32 s24, s2, 3
    s_and_b32 s25, s2, 7
    s_lshr_b32 s26, s25, 2
    s_bfe_u32 s27, s25, 0x10001
    s_and_b32 s28, s25, 1
    s_mov_b32 s60, s92
    s_and_b32 s61, s93, 0xffff
    s_mov_b32 s62, 65536
    s_mov_b32 s63, 0x20000
    s_branch K1_SC
K1_S1:
    s_sub_u32 s29, s2, 64
    s_mul_i32 s24, s29, 43
    s_lshr_b32 s24, s24, 9
    s_mul_i32 s25, s24, 12
    s_sub_u32 s25, s29, s25
    s_cmp_ge_u32 s25, 6
    s_cselect_b32 s26, 1, 0
    s_mul_i32 s27, s26, 6
    s_sub_u32 s27, s25, s27
    s_lshr_b32 s27, s27, 1
    s_and_b32 s28, s25, 1
    s_add_u32 s25, s25, 8
    s_mov_b32 s60, s94
    s_and_b32 s61, s95, 0xffff
    s_mov_b32 s62, 98304
    s_mov_b32 s63, 0x20000
K1_SC:
    s_lshl_b32 s27, s27, 7
    s_lshl_b32 s26, s26, 6
    s_lshl_b32 s28, s28, 4
    s_add_u32 s27, s27, s26
    s_add_u32 s27, s27, s28
    s_lshl_b32 s27, s27, 8
    s_lshl_b32 s26, s24, 5
    s_add_u32 s27, s27, s26
    s_add_u32 s29, s27, 8192
    v_lshlrev_b32 v3, 10, v3
    v_lshl_add_u32 v3, v1, 1, v3
    buffer_load_ushort v64, v3, s[60:63], s27 offen offset:0
    buffer_load_ushort v65, v3, s[60:63], s29 offen offset:0
    buffer_load_ushort v66, v3, s[60:63], s27 offen offset:256
    buffer_load_ushort v67, v3, s[60:63], s29 offen offset:256
    buffer_load_ushort v68, v3, s[60:63], s27 offen offset:512
    buffer_load_ushort v69, v3, s[60:63], s29 offen offset:512
    buffer_load_ushort v70, v3, s[60:63], s27 offen offset:768
    buffer_load_ushort v71, v3, s[60:63], s29 offen offset:768
    s_mul_i32 s24, s24, 20
    s_add_u32 s24, s24, s25
    s_lshl_b32 s24, s24, 10
    s_add_u32 s24, s24, 6946816
    s_branch K1_GO
K1_WT:
    s_sub_u32 s24, s2, 160
    s_lshr_b32 s27, s24, 1
    s_and_b32 s28, s24, 1
    s_lshl_b32 s27, s27, 8
    s_lshl_b32 s28, s28, 6
    s_add_u32 s27, s27, s28
    s_add_u32 s29, s27, 10240
    s_mov_b32 s60, s90
    s_and_b32 s61, s91, 0xffff
    s_mov_b32 s62, 20480
    s_mov_b32 s63, 0x20000
    v_and_b32 v1, 31, v8
    v_lshrrev_b32 v3, 5, v8
    v_mul_u32_u24 v3, 5120, v3
    v_lshl_add_u32 v3, v1, 1, v3
    buffer_load_ushort v64, v3, s[60:63], s27 offen offset:0
    buffer_load_ushort v65, v3, s[60:63], s27 offen offset:1280
    buffer_load_ushort v66, v3, s[60:63], s27 offen offset:2560
    buffer_load_ushort v67, v3, s[60:63], s27 offen offset:3840
    buffer_load_ushort v68, v3, s[60:63], s29 offen offset:0
    buffer_load_ushort v69, v3, s[60:63], s29 offen offset:1280
    buffer_load_ushort v70, v3, s[60:63], s29 offen offset:2560
    buffer_load_ushort v71, v3, s[60:63], s29 offen offset:3840
    s_lshl_b32 s24, s24, 10
    s_add_u32 s24, s24, 7110656
K1_GO:
KS_NOW:
    s_barrier
K2_PAD_H2:
    s_cbranch_execz KS_HOP0
    v_and_b32 v76, 31, v8
    v_lshrrev_b32 v77, 5, v8
    v_mov_b32 v80, 0
    v_mul_u32_u24 v77, 2080, v77
    v_mov_b32 v81, 0xffff0000
    v_lshl_add_u32 v78, v76, 4, v77
    v_mov_b32 v82, 0
    v_add_u32 v78, 65536, v78
    v_mov_b32 v83, v81
    v_add_u32 v79, 41600, v78
    ds_write_b128 v78, v[80:83] offset:0
    ds_write_b128 v78, v[80:83] offset:4160
    ds_write_b128 v78, v[80:83] offset:8320
    ds_write_b128 v78, v[80:83] offset:12480
    ds_write_b128 v78, v[80:83] offset:16640
    ds_write_b128 v78, v[80:83] offset:20800
    ds_write_b128 v78, v[80:83] offset:24960
    ds_write_b128 v78, v[80:83] offset:29120
    ds_write_b128 v78, v[80:83] offset:33280
    ds_write_b128 v78, v[80:83] offset:37440
    ds_write_b128 v79, v[80:83] offset:0
    ds_write_b128 v79, v[80:83] offset:4160
    ds_write_b128 v79, v[80:83] offset:8320
    ds_write_b128 v79, v[80:83] offset:12480
    ds_write_b128 v79, v[80:83] offset:16640
    ds_write_b128 v79, v[80:83] offset:20800
    ds_write_b128 v79, v[80:83] offset:24960
    ds_write_b128 v79, v[80:83] offset:29120
    ds_write_b128 v79, v[80:83] offset:33280
    ds_write_b128 v79, v[80:83] offset:37440
KS_FILL:
    v_mov_b32 v59, 163456
    s_barrier
    ds_read_b32 v59, v59
    s_waitcnt vmcnt(0) lgkmcnt(0)
    s_cmp_eq_u32 s30, 0
    s_cbranch_scc1 KS_B3
    s_cmp_eq_u32 s30, 2
    s_cbranch_scc1 KS_NOST
    v_lshl_or_b32 v40, v65, 16, v64
    v_lshl_or_b32 v41, v67, 16, v66
    v_lshl_or_b32 v42, v69, 16, v68
    v_lshl_or_b32 v43, v71, 16, v70
    buffer_store_dwordx4 v[40:43], v9, s[8:11], s24 offen sc1
KS_NOST:
    v_mov_b32 v62, 163460
    s_waitcnt lgkmcnt(0)
    s_barrier
    ds_read_b32 v62, v62
    s_lshl_b32 s24, s2, 2
    s_add_u32 s24, s24, 7176192
    s_mov_b64 exec, 1
    s_waitcnt vmcnt(0)
    buffer_store_dword v59, v6, s[8:11], s24 offen sc1
    s_mov_b64 exec, -1
    s_branch KS_JOIN
K2_PAD_H3:
    s_branch KS_HOP0
KS_RAW:
    s_cmp_lg_u32 s2, 0
    s_cbranch_scc1 KS_NOX
    s_mov_b32 s60, s98
    s_and_b32 s61, s99, 0xffff
    s_mov_b32 s62, 256
    s_mov_b32 s63, 0x20000
    s_getreg_b32 s24, hwreg(HW_REG_XCC_ID, 0, 1)
    s_add_u32 s24, s24, 1
    v_mov_b32 v10, s24
    v_mov_b32 v11, 0
    s_mov_b64 exec, 1
    buffer_atomic_cmpswap v[10:11], v6, s[60:63], 0 offen sc1
    s_mov_b64 exec, -1
KS_NOX:
    s_barrier
    s_mov_b32 s60, s90
    s_and_b32 s61, s91, 0xffff
    s_mov_b32 s62, 20480
    s_mov_b32 s63, 0x20000
    v_lshrrev_b32 v10, 3, v8
    v_and_b32 v11, 7, v8
    v_lshlrev_b32 v10, 8, v10
    v_lshl_add_u32 v10, v11, 4, v10
    s_mov_b32 m0, 24576
    s_movk_i32 s24, 0
    buffer_load_dwordx4 v10, s[60:63], s24 offen lds
    s_mov_b32 m0, 25600
    s_movk_i32 s24, 2048
    buffer_load_dwordx4 v10, s[60:63], s24 offen lds
    s_mov_b32 m0, 26624
    s_movk_i32 s24, 4096
    buffer_load_dwordx4 v10, s[60:63], s24 offen lds
    s_mov_b32 m0, 27648
    s_movk_i32 s24, 6144
    buffer_load_dwordx4 v10, s[60:63], s24 offen lds
    s_mov_b32 m0, 28672
    s_movk_i32 s24, 8192
    buffer_load_dwordx4 v10, s[60:63], s24 offen lds
    s_mov_b32 m0, 29696
    s_movk_i32 s24, 10240
    buffer_load_dwordx4 v10, s[60:63], s24 offen lds
    s_mov_b32 m0, 30720
    s_movk_i32 s24, 12288
    buffer_load_dwordx4 v10, s[60:63], s24 offen lds
    s_mov_b32 m0, 31744
    s_movk_i32 s24, 14336
    buffer_load_dwordx4 v10, s[60:63], s24 offen lds
    s_mov_b32 m0, 32768
    s_movk_i32 s24, 16384
    buffer_load_dwordx4 v10, s[60:63], s24 offen lds
    s_mov_b32 m0, 33792
    s_movk_i32 s24, 18432
    buffer_load_dwordx4 v10, s[60:63], s24 offen lds
    s_mov_b32 m0, 152832
    s_movk_i32 s24, 128
    buffer_load_dwordx4 v10, s[60:63], s24 offen lds
    s_mov_b32 m0, 153856
    s_movk_i32 s24, 2176
    buffer_load_dwordx4 v10, s[60:63], s24 offen lds
    s_mov_b32 m0, 154880
    s_movk_i32 s24, 4224
    buffer_load_dwordx4 v10, s[60:63], s24 offen lds
    s_mov_b32 m0, 155904
    s_movk_i32 s24, 6272
    buffer_load_dwordx4 v10, s[60:63], s24 offen lds
    s_mov_b32 m0, 156928
    s_movk_i32 s24, 8320
    buffer_load_dwordx4 v10, s[60:63], s24 offen lds
    s_mov_b32 m0, 157952
    s_movk_i32 s24, 10368
    buffer_load_dwordx4 v10, s[60:63], s24 offen lds
    s_mov_b32 m0, 158976
    s_movk_i32 s24, 12416
    buffer_load_dwordx4 v10, s[60:63], s24 offen lds
    s_mov_b32 m0, 160000
    s_movk_i32 s24, 14464
    buffer_load_dwordx4 v10, s[60:63], s24 offen lds
    s_mov_b32 m0, 161024
    s_movk_i32 s24, 16512
    buffer_load_dwordx4 v10, s[60:63], s24 offen lds
    s_mov_b32 m0, 162048
    s_movk_i32 s24, 18560
    buffer_load_dwordx4 v10, s[60:63], s24 offen lds
    v_add_u32 v85, 16, v8
    v_lshlrev_b32 v84, 5, v8
    v_lshrrev_b32 v85, 6, v85
    v_mul_u32_u24 v85, 1532, v85
    v_sub_u32 v84, v84, v85
    v_mov_b32 v85, -1
    v_add_u32 v84, 66048, v84
    v_add_u32 v86, 41600, v84
    ds_write_b32 v84, v85 offset:0
    ds_write_b32 v84, v85 offset:2080
    ds_write_b32 v84, v85 offset:4160
    ds_write_b32 v84, v85 offset:6240
    ds_write_b32 v84, v85 offset:8320
    ds_write_b32 v84, v85 offset:10400
    ds_write_b32 v84, v85 offset:12480
    ds_write_b32 v84, v85 offset:14560
    ds_write_b32 v84, v85 offset:16640
    ds_write_b32 v84, v85 offset:18720
    ds_write_b32 v84, v85 offset:20800
    ds_write_b32 v84, v85 offset:22880
    ds_write_b32 v84, v85 offset:24960
    ds_write_b32 v84, v85 offset:27040
    ds_write_b32 v84, v85 offset:29120
    ds_write_b32 v84, v85 offset:31200
    ds_write_b32 v84, v85 offset:33280
    ds_write_b32 v84, v85 offset:35360
    ds_write_b32 v84, v85 offset:37440
    ds_write_b32 v84, v85 offset:39520
    ds_write_b32 v86, v85 offset:0
    ds_write_b32 v86, v85 offset:2080
    ds_write_b32 v86, v85 offset:4160
    ds_write_b32 v86, v85 offset:6240
    ds_write_b32 v86, v85 offset:8320
    ds_write_b32 v86, v85 offset:10400
    ds_write_b32 v86, v85 offset:12480
    ds_write_b32 v86, v85 offset:14560
    ds_write_b32 v86, v85 offset:16640
    ds_write_b32 v86, v85 offset:18720
    ds_write_b32 v86, v85 offset:20800
    ds_write_b32 v86, v85 offset:22880
    ds_write_b32 v86, v85 offset:24960
    ds_write_b32 v86, v85 offset:27040
    ds_write_b32 v86, v85 offset:29120
    ds_write_b32 v86, v85 offset:31200
    ds_write_b32 v86, v85 offset:33280
    ds_write_b32 v86, v85 offset:35360
    ds_write_b32 v86, v85 offset:37440
    ds_write_b32 v86, v85 offset:39520
    s_branch KS_FILL
KS_IDLE:
    s_barrier
    s_barrier
    s_branch KS_B3
K2_PAD_U20:
    s_branch K2_HOP
K2_U20:
    s_setprio 1
    s_waitcnt lgkmcnt(0)
    v_lshlrev_b32 v20, 16, v0
    v_and_b32 v21, 0xffff0000, v0
    v_lshlrev_b32 v22, 16, v1
    v_and_b32 v23, 0xffff0000, v1
    v_lshlrev_b32 v24, 16, v2
    v_and_b32 v25, 0xffff0000, v2
    v_lshlrev_b32 v26, 16, v3
    v_and_b32 v27, 0xffff0000, v3
    v_mul_f32_dpp v36, v16, v20 row_newbcast:8 row_mask:0xf bank_mask:0xf
    v_mul_f32_dpp v37, v16, v21 row_newbcast:9 row_mask:0xf bank_mask:0xf
    v_mul_f32_dpp v38, v16, v22 row_newbcast:10 row_mask:0xf bank_mask:0xf
    v_mul_f32_dpp v39, v16, v23 row_newbcast:11 row_mask:0xf bank_mask:0xf
    v_mul_f32_dpp v40, v16, v24 row_newbcast:12 row_mask:0xf bank_mask:0xf
    v_mul_f32_dpp v41, v16, v25 row_newbcast:13 row_mask:0xf bank_mask:0xf
    v_mul_f32_dpp v42, v16, v26 row_newbcast:14 row_mask:0xf bank_mask:0xf
    v_mul_f32_dpp v43, v16, v27 row_newbcast:15 row_mask:0xf bank_mask:0xf
    v_cvt_pk_bf16_f32 v68, v36, v37
    v_cvt_pk_bf16_f32 v69, v38, v39
    v_cvt_pk_bf16_f32 v70, v40, v41
    v_cvt_pk_bf16_f32 v71, v42, v43
    v_mul_f32_dpp v20, v16, v20 row_newbcast:0 row_mask:0xa bank_mask:0xf
    v_mul_f32_dpp v21, v16, v21 row_newbcast:1 row_mask:0xa bank_mask:0xf
    v_mul_f32_dpp v22, v16, v22 row_newbcast:2 row_mask:0xa bank_mask:0xf
    v_mul_f32_dpp v23, v16, v23 row_newbcast:3 row_mask:0xa bank_mask:0xf
    v_mul_f32_dpp v24, v16, v24 row_newbcast:4 row_mask:0xa bank_mask:0xf
    v_mul_f32_dpp v25, v16, v25 row_newbcast:5 row_mask:0xa bank_mask:0xf
    v_mul_f32_dpp v26, v16, v26 row_newbcast:6 row_mask:0xa bank_mask:0xf
    v_mul_f32_dpp v27, v16, v27 row_newbcast:7 row_mask:0xa bank_mask:0xf
    v_cvt_pk_bf16_f32 v64, v20, v21
    v_cvt_pk_bf16_f32 v65, v22, v23
    v_cvt_pk_bf16_f32 v66, v24, v25
    v_cvt_pk_bf16_f32 v67, v26, v27
    v_lshlrev_b32 v28, 16, v4
    v_and_b32 v29, 0xffff0000, v4
    v_lshlrev_b32 v30, 16, v5
    v_and_b32 v31, 0xffff0000, v5
    v_lshlrev_b32 v32, 16, v6
    v_and_b32 v33, 0xffff0000, v6
    v_lshlrev_b32 v34, 16, v7
    v_and_b32 v35, 0xffff0000, v7
    v_mul_f32_dpp v36, v17, v28 row_newbcast:8 row_mask:0xf bank_mask:0xf
    v_mul_f32_dpp v37, v17, v29 row_newbcast:9 row_mask:0xf bank_mask:0xf
    v_mul_f32_dpp v38, v17, v30 row_newbcast:10 row_mask:0xf bank_mask:0xf
    v_mul_f32_dpp v39, v17, v31 row_newbcast:11 row_mask:0xf bank_mask:0xf
    v_mul_f32_dpp v40, v17, v32 row_newbcast:12 row_mask:0xf bank_mask:0xf
    v_mul_f32_dpp v41, v17, v33 row_newbcast:13 row_mask:0xf bank_mask:0xf
    v_mul_f32_dpp v42, v17, v34 row_newbcast:14 row_mask:0xf bank_mask:0xf
    v_mul_f32_dpp v43, v17, v35 row_newbcast:15 row_mask:0xf bank_mask:0xf
    v_cvt_pk_bf16_f32 v76, v36, v37
    v_cvt_pk_bf16_f32 v77, v38, v39
    v_cvt_pk_bf16_f32 v78, v40, v41
    v_cvt_pk_bf16_f32 v79, v42, v43
    v_mul_f32_dpp v28, v17, v28 row_newbcast:0 row_mask:0xa bank_mask:0xf
    v_mul_f32_dpp v29, v17, v29 row_newbcast:1 row_mask:0xa bank_mask:0xf
    v_mul_f32_dpp v30, v17, v30 row_newbcast:2 row_mask:0xa bank_mask:0xf
    v_mul_f32_dpp v31, v17, v31 row_newbcast:3 row_mask:0xa bank_mask:0xf
    v_mul_f32_dpp v32, v17, v32 row_newbcast:4 row_mask:0xa bank_mask:0xf
    v_mul_f32_dpp v33, v17, v33 row_newbcast:5 row_mask:0xa bank_mask:0xf
    v_mul_f32_dpp v34, v17, v34 row_newbcast:6 row_mask:0xa bank_mask:0xf
    v_mul_f32_dpp v35, v17, v35 row_newbcast:7 row_mask:0xa bank_mask:0xf
    v_cvt_pk_bf16_f32 v72, v28, v29
    v_cvt_pk_bf16_f32 v73, v30, v31
    v_cvt_pk_bf16_f32 v74, v32, v33
    v_cvt_pk_bf16_f32 v75, v34, v35
    s_waitcnt vmcnt(4)
    v_mfma_f32_32x32x16_bf16 v[0:15], v[64:67], v[176:179], 0
    ds_read_b64_tr_b16 v[184:185], v246 offset:2048
    ds_read_b64_tr_b16 v[186:187], v246 offset:3072
    ds_read_b64_tr_b16 v[188:189], v247 offset:2048
    ds_read_b64_tr_b16 v[190:191], v247 offset:3072
    s_mov_b32 m0, s68
    v_mfma_f32_32x32x16_bf16 v[16:31], v[68:71], v[176:179], 0
    buffer_load_dwordx4 v222, s[4:7], s42 offen sc1 lds
    buffer_load_dwordx4 v223, s[72:75], s42 offen offset:1024 sc1 lds
    v_permlane32_swap_b32 v242, v236
    v_permlane32_swap_b32 v243, v237
    s_add_u32 s38, s38, 1
    v_mfma_f32_32x32x16_bf16 v[32:47], v[64:67], v[180:183], 0
    v_permlane32_swap_b32 v244, v238
    v_permlane32_swap_b32 v245, v239
    v_permlane32_swap_b32 v240, v241
    v_add_f32 v242, v242, v236
    v_mfma_f32_32x32x16_bf16 v[48:63], v[68:71], v[180:183], 0
    v_add_f32 v243, v243, v237
    v_add_f32 v244, v244, v238
    v_add_f32 v245, v245, v239
    v_add_f32 v240, -v240, -v241
    v_mov_b32 v254, s52
    v_mov_b32 v255, s38
    s_waitcnt vmcnt(4) lgkmcnt(0)
    v_mfma_f32_32x32x16_bf16 v[0:15], v[72:75], v[184:187], v[0:15]
    ds_read_b64_tr_b16 v[176:177], v246 offset:4096
    ds_read_b64_tr_b16 v[178:179], v246 offset:5120
    ds_read_b64_tr_b16 v[180:181], v247 offset:4096
    ds_read_b64_tr_b16 v[182:183], v247 offset:5120
    s_lshl_b32 s58, s38, 3
    s_add_u32 s58, s58, s20
    s_mov_b32 m0, s69
    v_mfma_f32_32x32x16_bf16 v[16:31], v[76:79], v[184:187], v[16:31]
    buffer_load_dwordx4 v224, s[4:7], s42 offen sc1 lds
    buffer_load_dwordx4 v225, s[72:75], s42 offen offset:1024 sc1 lds
    s_set_gpr_idx_on s32, gpr_idx(DST)
    s_nop 0
    v_cvt_pk_bf16_f32 v195, v242, v243
    v_cvt_pk_bf16_f32 v196, v244, v245
    v_cvt_pk_bf16_f32 v197, v240, v240
    s_set_gpr_idx_off
    s_mov_b64 exec, 1
    ds_write_b32 v254, v255
    s_mov_b64 exec, -1
    s_cmp_lt_u32 s58, s22
    s_cbranch_scc0 K2_dyn_8
K2_back_9:
    v_readlane_b32 s3, v253, s58
    s_lshl_b32 s44, s34, 7
    s_and_b32 s48, s3, 0x3ffff
    s_bfe_u32 s33, s3, 0x30013
    s_mul_i32 s35, s38, 6
    s_cmp_eq_u32 s34, 0
    s_cselect_b32 s35, s35, s48
    s_mov_b32 s45, s44
    s_xor_b32 s47, s44, 256
    s_add_u32 s49, s48, 128
    s_add_u32 s60, s48, 256
    s_cmp_eq_u32 s33, 3
    s_cselect_b32 s46, s44, s47
    s_cselect_b32 s50, s60, s48
    s_cselect_b32 s51, s48, s49
    s_sub_u32 s60, s33, 2
    s_cmp_lt_u32 s60, 2
    s_cbranch_scc0 K2_rare_14
K2_back_15:
    v_mfma_f32_32x32x16_bf16 v[32:47], v[72:75], v[188:191], v[32:47]
    v_add_u32 v233, s48, v230
    ds_read_b32 v232, v233
    ds_read_b32 v233, v233 offset:1024
    v_mul_f32 v234, v0, v96
    v_mul_f32 v236, v8, v128
    v_fmac_f32 v234, v1, v97
    v_fmac_f32 v236, v9, v129
    v_mfma_f32_32x32x16_bf16 v[48:63], v[76:79], v[188:191], v[48:63]
    s_setprio 0
    v_fmac_f32 v234, v2, v98
    v_fmac_f32 v236, v10, v130
    v_fmac_f32 v234, v3, v99
    v_fmac_f32 v236, v11, v131
    v_fmac_f32 v234, v4, v100
    v_fmac_f32 v236, v12, v132
    v_fmac_f32 v234, v5, v101
    v_fmac_f32 v236, v13, v133
    v_fmac_f32 v234, v6, v102
    v_fmac_f32 v236, v14, v134
    v_fmac_f32 v234, v7, v103
    v_fmac_f32 v236, v15, v135
    v_mul_f32 v238, v16, v128
    v_mul_f32 v240, v24, v128
    v_fmac_f32 v238, v17, v129
    v_fmac_f32 v240, v25, v129
    v_fmac_f32 v238, v18, v130
    v_fmac_f32 v240, v26, v130
    v_fmac_f32 v238, v19, v131
    v_fmac_f32 v240, v27, v131
    v_fmac_f32 v238, v20, v132
    v_fmac_f32 v240, v28, v132
    v_fmac_f32 v238, v21, v133
    v_fmac_f32 v240, v29, v133
    v_fmac_f32 v238, v22, v134
    v_fmac_f32 v240, v30, v134
    v_fmac_f32 v238, v23, v135
    v_fmac_f32 v240, v31, v135
    v_mul_f32 v235, v32, v104
    v_mul_f32 v237, v40, v136
    v_fmac_f32 v235, v33, v105
    v_fmac_f32 v237, v41, v137
    v_fmac_f32 v235, v34, v106
    v_fmac_f32 v237, v42, v138
    v_fmac_f32 v235, v35, v107
    v_fmac_f32 v237, v43, v139
    v_fmac_f32 v235, v36, v108
    v_fmac_f32 v237, v44, v140
    v_fmac_f32 v235, v37, v109
    v_fmac_f32 v237, v45, v141
    v_fmac_f32 v235, v38, v110
    v_fmac_f32 v237, v46, v142
    v_fmac_f32 v235, v39, v111
    v_fmac_f32 v237, v47, v143
    v_mul_f32 v239, v48, v136
    v_mul_f32 v241, v56, v136
    v_fmac_f32 v239, v49, v137
    v_fmac_f32 v241, v57, v137
    s_setprio 1
    s_waitcnt vmcnt(4) lgkmcnt(3)
    v_mfma_f32_32x32x16_bf16 v[0:15], v[64:67], v[176:179], 0
    ds_read_b64_tr_b16 v[184:185], v246 offset:6144
    ds_read_b64_tr_b16 v[186:187], v246 offset:7168
    ds_read_b64_tr_b16 v[188:189], v247 offset:6144
    ds_read_b64_tr_b16 v[190:191], v247 offset:7168
    v_fmac_f32 v239, v50, v138
    v_fmac_f32 v241, v58, v138
    s_mov_b32 m0, s70
    v_mfma_f32_32x32x16_bf16 v[16:31], v[68:71], v[176:179], 0
    buffer_load_dwordx4 v222, s[4:7], s43 offen sc1 lds
    buffer_load_dwordx4 v223, s[72:75], s43 offen offset:1024 sc1 lds
    v_fmac_f32 v239, v51, v139
    v_fmac_f32 v241, v59, v139
    v_fmac_f32 v239, v52, v140
    v_fmac_f32 v241, v60, v140
    v_fmac_f32 v239, v53, v141
    v_mfma_f32_32x32x16_bf16 v[32:47], v[64:67], v[180:183], 0
    v_add_u32 v222, s48, v251
    ds_read2_b32 v[222:223], v222 offset0:1 offset1:3
    v_fmac_f32 v241, v61, v141
    v_fmac_f32 v239, v54, v142
    v_fmac_f32 v241, v62, v142
    v_fmac_f32 v239, v55, v143
    v_fmac_f32 v241, v63, v143
    v_mfma_f32_32x32x16_bf16 v[48:63], v[68:71], v[180:183], 0
    v_permlane32_swap_b32 v234, v236
    v_permlane32_swap_b32 v235, v237
    v_permlane32_swap_b32 v240, v238
    s_waitcnt lgkmcnt(5)
    v_or_b32 v232, v232, v231
    v_or_b32 v233, v233, v231
    s_cmp_lg_u32 s34, 0
    s_cbranch_scc1 K2_dum_17
    s_cmp_eq_u32 s33, 4
    s_cbranch_scc1 K2_a4_18
K2_b4_20:
    s_add_u32 m0, s48, 512
    s_add_u32 s65, s48, 1536
    buffer_load_dwordx4 v232, s[16:19], 0 offen  lds
    s_mov_b32 m0, s65
    s_mov_b32 exec_hi, 0
    buffer_load_dwordx4 v233, s[16:19], 0 offen  lds
    s_mov_b32 exec_hi, -1
K2_back_19:
    s_waitcnt vmcnt(6) lgkmcnt(1)
    v_mfma_f32_32x32x16_bf16 v[0:15], v[72:75], v[184:187], v[0:15]
    ds_read_b64_tr_b16 v[176:177], v246 offset:0
    ds_read_b64_tr_b16 v[178:179], v246 offset:1024
    ds_read_b64_tr_b16 v[180:181], v247 offset:0
    ds_read_b64_tr_b16 v[182:183], v247 offset:1024
    v_permlane32_swap_b32 v241, v239
    s_mov_b32 m0, s71
    v_mfma_f32_32x32x16_bf16 v[16:31], v[76:79], v[184:187], v[16:31]
    buffer_load_dwordx4 v224, s[4:7], s43 offen sc1 lds
    buffer_load_dwordx4 v225, s[72:75], s43 offen offset:1024 sc1 lds
    s_waitcnt lgkmcnt(4)
    v_mad_u32_u16 v222, v222, s39, v248 op_sel:[1,0,0,0]
    v_mad_u32_u16 v223, v223, s39, v248 op_sel:[1,0,0,0]
    v_add_f32 v234, v234, v236
    v_add_f32 v235, v235, v237
    v_add_f32 v240, v240, v238
    v_add_f32 v241, v241, v239
    s_set_gpr_idx_on s31, gpr_idx(DST)
    s_nop 0
    v_cvt_pk_bf16_f32 v192, v234, v235
    v_cvt_pk_bf16_f32 v193, v240, v241
    s_set_gpr_idx_off
    v_mfma_f32_32x32x16_bf16 v[32:47], v[72:75], v[188:191], v[32:47]
    v_add_u32 v224, s49, v251
    ds_read2_b32 v[224:225], v224 offset0:1 offset1:3
    v_mul_f32 v234, v0, v144
    v_mul_f32 v236, v8, v112
    v_fmac_f32 v234, v1, v145
    v_fmac_f32 v236, v9, v113
    v_fmac_f32 v234, v2, v146
    v_mfma_f32_32x32x16_bf16 v[48:63], v[76:79], v[188:191], v[48:63]
    s_setprio 0
    v_fmac_f32 v236, v10, v114
    v_fmac_f32 v234, v3, v147
    v_fmac_f32 v236, v11, v115
    v_fmac_f32 v234, v4, v148
    v_fmac_f32 v236, v12, v116
    v_fmac_f32 v234, v5, v149
    v_fmac_f32 v236, v13, v117
    v_fmac_f32 v234, v6, v150
    v_fmac_f32 v236, v14, v118
    v_fmac_f32 v234, v7, v151
    v_fmac_f32 v236, v15, v119
    v_mul_f32 v238, v16, v160
    v_mul_f32 v240, v24, v160
    v_fmac_f32 v238, v17, v161
    v_fmac_f32 v240, v25, v161
    v_fmac_f32 v238, v18, v162
    v_fmac_f32 v240, v26, v162
    v_fmac_f32 v238, v19, v163
    v_fmac_f32 v240, v27, v163
    v_fmac_f32 v238, v20, v164
    v_fmac_f32 v240, v28, v164
    v_fmac_f32 v238, v21, v165
    v_fmac_f32 v240, v29, v165
    v_fmac_f32 v238, v22, v166
    v_fmac_f32 v240, v30, v166
    v_fmac_f32 v238, v23, v167
    v_fmac_f32 v240, v31, v167
    v_mul_f32 v235, v32, v152
    v_mul_f32 v237, v40, v120
    v_fmac_f32 v235, v33, v153
    v_fmac_f32 v237, v41, v121
    v_fmac_f32 v235, v34, v154
    v_fmac_f32 v237, v42, v122
    v_fmac_f32 v235, v35, v155
    v_fmac_f32 v237, v43, v123
    v_fmac_f32 v235, v36, v156
    v_fmac_f32 v237, v44, v124
    v_fmac_f32 v235, v37, v157
    v_fmac_f32 v237, v45, v125
    v_fmac_f32 v235, v38, v158
    v_fmac_f32 v237, v46, v126
    v_fmac_f32 v235, v39, v159
    v_fmac_f32 v237, v47, v127
    v_mul_f32 v239, v48, v168
    v_mul_f32 v241, v56, v168
    v_fmac_f32 v239, v49, v169
    v_fmac_f32 v241, v57, v169
    v_fmac_f32 v239, v50, v170
    v_fmac_f32 v241, v58, v170
    v_fmac_f32 v239, v51, v171
    s_setprio 1
    s_waitcnt vmcnt(6) lgkmcnt(1)
    v_mfma_f32_32x32x16_bf16 v[0:15], v[64:67], v[176:179], 0
    ds_read_b64_tr_b16 v[184:185], v246 offset:2048
    ds_read_b64_tr_b16 v[186:187], v246 offset:3072
    ds_read_b64_tr_b16 v[188:189], v247 offset:2048
    ds_read_b64_tr_b16 v[190:191], v247 offset:3072
    v_fmac_f32 v241, v59, v171
    v_fmac_f32 v239, v52, v172
    s_mov_b32 m0, s68
    v_mfma_f32_32x32x16_bf16 v[16:31], v[68:71], v[176:179], 0
    buffer_load_dwordx4 v222, s[4:7], s44 offen sc1 lds
    buffer_load_dwordx4 v223, s[72:75], s44 offen offset:1024 sc1 lds
    s_waitcnt lgkmcnt(4)
    v_mad_u32_u16 v224, v224, s39, v248 op_sel:[1,0,0,0]
    v_mad_u32_u16 v225, v225, s39, v248 op_sel:[1,0,0,0]
    v_fmac_f32 v241, v60, v172
    v_fmac_f32 v239, v53, v173
    v_mfma_f32_32x32x16_bf16 v[32:47], v[64:67], v[180:183], 0
    v_add_u32 v226, s50, v251
    ds_read2_b32 v[226:227], v226 offset0:1 offset1:3
    v_fmac_f32 v241, v61, v173
    v_fmac_f32 v239, v54, v174
    v_fmac_f32 v241, v62, v174
    v_fmac_f32 v239, v55, v175
    v_fmac_f32 v241, v63, v175
    v_mfma_f32_32x32x16_bf16 v[48:63], v[68:71], v[180:183], 0
    s_waitcnt vmcnt(6) lgkmcnt(1)
    v_mfma_f32_32x32x16_bf16 v[0:15], v[72:75], v[184:187], v[0:15]
    ds_read_b64_tr_b16 v[176:177], v246 offset:4096
    ds_read_b64_tr_b16 v[178:179], v246 offset:5120
    ds_read_b64_tr_b16 v[180:181], v247 offset:4096
    ds_read_b64_tr_b16 v[182:183], v247 offset:5120
    s_mov_b32 m0, s69
    v_mfma_f32_32x32x16_bf16 v[16:31], v[76:79], v[184:187], v[16:31]
    buffer_load_dwordx4 v224, s[4:7], s45 offen sc1 lds
    buffer_load_dwordx4 v225, s[72:75], s45 offen offset:1024 sc1 lds
    s_waitcnt lgkmcnt(4)
    v_mad_u32_u16 v226, v226, s39, v248 op_sel:[1,0,0,0]
    v_mad_u32_u16 v227, v227, s39, v248 op_sel:[1,0,0,0]
    v_mfma_f32_32x32x16_bf16 v[32:47], v[72:75], v[188:191], v[32:47]
    v_add_u32 v228, s51, v251
    ds_read2_b32 v[228:229], v228 offset0:1 offset1:3
    v_mul_f32 v242, v0, v144
    v_fma_f32 v238, v8, v160, -v238
    v_fmac_f32 v242, v1, v145
    v_fmac_f32 v238, v9, v161
    v_fmac_f32 v242, v2, v146
    v_mfma_f32_32x32x16_bf16 v[48:63], v[76:79], v[188:191], v[48:63]
    s_setprio 0
    v_fmac_f32 v238, v10, v162
    v_fmac_f32 v242, v3, v147
    v_fmac_f32 v238, v11, v163
    v_fmac_f32 v242, v4, v148
    v_fmac_f32 v238, v12, v164
    v_fmac_f32 v242, v5, v149
    v_fmac_f32 v238, v13, v165
    v_fmac_f32 v242, v6, v150
    v_fmac_f32 v238, v14, v166
    v_fmac_f32 v242, v7, v151
    v_fmac_f32 v238, v15, v167
    v_fmac_f32 v236, v16, v112
    v_mul_f32 v244, v24, v160
    v_fmac_f32 v236, v17, v113
    v_fmac_f32 v244, v25, v161
    v_fmac_f32 v236, v18, v114
    v_fmac_f32 v244, v26, v162
    v_fmac_f32 v236, v19, v115
    v_fmac_f32 v244, v27, v163
    v_fmac_f32 v236, v20, v116
    v_fmac_f32 v244, v28, v164
    v_fmac_f32 v236, v21, v117
    v_fmac_f32 v244, v29, v165
    v_fmac_f32 v236, v22, v118
    v_fmac_f32 v244, v30, v166
    v_fmac_f32 v236, v23, v119
    v_fmac_f32 v244, v31, v167
    v_mul_f32 v243, v32, v152
    v_fma_f32 v239, v40, v168, -v239
    v_fmac_f32 v243, v33, v153
    v_fmac_f32 v239, v41, v169
    v_fmac_f32 v243, v34, v154
    v_fmac_f32 v239, v42, v170
    v_fmac_f32 v243, v35, v155
    v_fmac_f32 v239, v43, v171
    v_fmac_f32 v243, v36, v156
    v_fmac_f32 v239, v44, v172
    v_fmac_f32 v243, v37, v157
    v_fmac_f32 v239, v45, v173
    v_fmac_f32 v243, v38, v158
    v_fmac_f32 v239, v46, v174
    v_fmac_f32 v243, v39, v159
    v_fmac_f32 v239, v47, v175
    v_fmac_f32 v237, v48, v120
    v_mul_f32 v245, v56, v168
    v_fmac_f32 v237, v49, v121
    v_fmac_f32 v245, v57, v169
    v_fmac_f32 v237, v50, v122
    s_setprio 1
    s_waitcnt vmcnt(4) lgkmcnt(1)
    v_mfma_f32_32x32x16_bf16 v[0:15], v[64:67], v[176:179], 0
    ds_read_b64_tr_b16 v[184:185], v246 offset:6144
    ds_read_b64_tr_b16 v[186:187], v246 offset:7168
    ds_read_b64_tr_b16 v[188:189], v247 offset:6144
    ds_read_b64_tr_b16 v[190:191], v247 offset:7168
    v_fmac_f32 v245, v58, v170
    v_fmac_f32 v237, v51, v123
    s_mov_b32 m0, s70
    v_mfma_f32_32x32x16_bf16 v[16:31], v[68:71], v[176:179], 0
    buffer_load_dwordx4 v226, s[4:7], s46 offen sc1 lds
    buffer_load_dwordx4 v227, s[72:75], s46 offen offset:1024 sc1 lds
    s_waitcnt lgkmcnt(4)
    v_mad_u32_u16 v228, v228, s39, v248 op_sel:[1,0,0,0]
    v_mad_u32_u16 v229, v229, s39, v248 op_sel:[1,0,0,0]
    v_fmac_f32 v245, v59, v171
    v_fmac_f32 v237, v52, v124
    v_mfma_f32_32x32x16_bf16 v[32:47], v[64:67], v[180:183], 0
    v_fmac_f32 v245, v60, v172
    v_fmac_f32 v237, v53, v125
    v_fmac_f32 v245, v61, v173
    v_fmac_f32 v237, v54, v126
    v_fmac_f32 v245, v62, v174
    v_fmac_f32 v237, v55, v127
    v_fmac_f32 v245, v63, v175
    v_mfma_f32_32x32x16_bf16 v[48:63], v[68:71], v[180:183], 0
    v_permlane32_swap_b32 v242, v234
    v_permlane32_swap_b32 v243, v235
    v_add_f32 v242, v242, v234
    v_add_f32 v243, v243, v235
    s_waitcnt vmcnt(4) lgkmcnt(0)
    v_mfma_f32_32x32x16_bf16 v[0:15], v[72:75], v[184:187], v[0:15]
    ds_read_b64_tr_b16 v[176:177], v246 offset:0
    ds_read_b64_tr_b16 v[178:179], v246 offset:1024
    ds_read_b64_tr_b16 v[180:181], v247 offset:0
    ds_read_b64_tr_b16 v[182:183], v247 offset:1024
    s_sub_u32 s26, s48, s29
    s_mov_b32 s29, s48
    s_mov_b32 m0, s71
    v_mfma_f32_32x32x16_bf16 v[16:31], v[76:79], v[184:187], v[16:31]
    buffer_load_dwordx4 v228, s[4:7], s47 offen sc1 lds
    buffer_load_dwordx4 v229, s[72:75], s47 offen offset:1024 sc1 lds
    s_set_gpr_idx_on s31, gpr_idx(DST)
    s_nop 0
    v_cvt_pk_bf16_f32 v194, v242, v243
    s_set_gpr_idx_off
    s_mov_b32 s30, s3
    s_bfe_u32 s56, s3, 0x40012
    s_cmp_eq_u32 s34, 0
    s_cselect_b32 s56, s56, 0
    v_mfma_f32_32x32x16_bf16 v[32:47], v[72:75], v[188:191], v[32:47]
    s_mov_b32 s32, s31
    s_mov_b32 s31, s35
    v_mul_f32 v242, v0, v144
    v_fma_f32 v240, v8, v160, -v240
    v_fmac_f32 v242, v1, v145
    v_fmac_f32 v240, v9, v161
    v_fmac_f32 v242, v2, v146
    v_mfma_f32_32x32x16_bf16 v[48:63], v[76:79], v[188:191], v[48:63]
    s_setprio 0
    v_fmac_f32 v240, v10, v162
    v_fmac_f32 v242, v3, v147
    v_fmac_f32 v240, v11, v163
    v_fmac_f32 v242, v4, v148
    v_fmac_f32 v240, v12, v164
    v_fmac_f32 v242, v5, v149
    v_fmac_f32 v240, v13, v165
    v_fmac_f32 v242, v6, v150
    v_fmac_f32 v240, v14, v166
    v_fmac_f32 v242, v7, v151
    v_fmac_f32 v240, v15, v167
    v_add_u32 v249, s26, v249
    v_add_u32 v250, s26, v250
    v_fma_f32 v244, v16, v160, -v244
    v_fmac_f32 v236, v24, v112
    v_fmac_f32 v244, v17, v161
    v_fmac_f32 v236, v25, v113
    v_fmac_f32 v244, v18, v162
    v_fmac_f32 v236, v26, v114
    v_fmac_f32 v244, v19, v163
    v_fmac_f32 v236, v27, v115
    v_fmac_f32 v244, v20, v164
    v_fmac_f32 v236, v28, v116
    v_fmac_f32 v244, v21, v165
    v_fmac_f32 v236, v29, v117
    v_fmac_f32 v244, v22, v166
    v_fmac_f32 v236, v30, v118
    v_fmac_f32 v244, v23, v167
    v_fmac_f32 v236, v31, v119
    ds_read_b64_tr_b16 v[0:1], v249 offset:0
    ds_read_b64_tr_b16 v[2:3], v249 offset:32
    ds_read_u16_d16_hi v16, v250 offset:0
    v_mul_f32 v243, v32, v152
    v_fma_f32 v241, v40, v168, -v241
    v_fmac_f32 v243, v33, v153
    v_fmac_f32 v241, v41, v169
    v_fmac_f32 v243, v34, v154
    v_fmac_f32 v241, v42, v170
    v_fmac_f32 v243, v35, v155
    v_fmac_f32 v241, v43, v171
    v_fmac_f32 v243, v36, v156
    v_fmac_f32 v241, v44, v172
    v_fmac_f32 v243, v37, v157
    v_fmac_f32 v241, v45, v173
    v_fmac_f32 v243, v38, v158
    v_fmac_f32 v241, v46, v174
    v_fmac_f32 v243, v39, v159
    v_fmac_f32 v241, v47, v175
    ds_read_b64_tr_b16 v[4:5], v249 offset:512
    ds_read_b64_tr_b16 v[6:7], v249 offset:544
    ds_read_u16_d16_hi v17, v250 offset:128
    v_fma_f32 v245, v48, v168, -v245
    v_fmac_f32 v237, v56, v120
    v_fmac_f32 v245, v49, v169
    v_fmac_f32 v237, v57, v121
    v_fmac_f32 v245, v50, v170
    v_fmac_f32 v237, v58, v122
    v_fmac_f32 v245, v51, v171
    v_fmac_f32 v237, v59, v123
    v_fmac_f32 v245, v52, v172
    v_fmac_f32 v237, v60, v124
    v_fmac_f32 v245, v53, v173
    v_fmac_f32 v237, v61, v125
    v_fmac_f32 v245, v54, v174
    v_fmac_f32 v237, v62, v126
    v_fmac_f32 v245, v55, v175
    v_fmac_f32 v237, v63, v127
    s_cmp_eq_u32 s56, 5
    s_cbranch_scc1 K2_U20
    s_cmp_eq_u32 s56, 6
    s_cbranch_scc1 K2_U3h0
    s_branch K2_DSP0
K2_PAD_U30:
    s_branch K2_HOP
K2_U3h0:
    s_setprio 1
    ds_read_b64_tr_b16 v[8:9], v249 offset:1024
    ds_read_u16_d16_hi v18, v250 offset:256
    s_waitcnt lgkmcnt(2)
    v_lshlrev_b32 v20, 16, v0
    v_and_b32 v21, 0xffff0000, v0
    v_lshlrev_b32 v22, 16, v1
    v_and_b32 v23, 0xffff0000, v1
    v_lshlrev_b32 v24, 16, v2
    v_and_b32 v25, 0xffff0000, v2
    v_lshlrev_b32 v26, 16, v3
    v_and_b32 v27, 0xffff0000, v3
    v_mul_f32_dpp v36, v16, v20 row_newbcast:8 row_mask:0xf bank_mask:0xf
    v_mul_f32_dpp v37, v16, v21 row_newbcast:9 row_mask:0xf bank_mask:0xf
    v_mul_f32_dpp v38, v16, v22 row_newbcast:10 row_mask:0xf bank_mask:0xf
    v_mul_f32_dpp v39, v16, v23 row_newbcast:11 row_mask:0xf bank_mask:0xf
    v_mul_f32_dpp v40, v16, v24 row_newbcast:12 row_mask:0xf bank_mask:0xf
    v_mul_f32_dpp v41, v16, v25 row_newbcast:13 row_mask:0xf bank_mask:0xf
    v_mul_f32_dpp v42, v16, v26 row_newbcast:14 row_mask:0xf bank_mask:0xf
    v_mul_f32_dpp v43, v16, v27 row_newbcast:15 row_mask:0xf bank_mask:0xf
    v_cvt_pk_bf16_f32 v68, v36, v37
    v_cvt_pk_bf16_f32 v69, v38, v39
    v_cvt_pk_bf16_f32 v70, v40, v41
    v_cvt_pk_bf16_f32 v71, v42, v43
    v_mul_f32_dpp v20, v16, v20 row_newbcast:0 row_mask:0xa bank_mask:0xf
    v_mul_f32_dpp v21, v16, v21 row_newbcast:1 row_mask:0xa bank_mask:0xf
    v_mul_f32_dpp v22, v16, v22 row_newbcast:2 row_mask:0xa bank_mask:0xf
    v_mul_f32_dpp v23, v16, v23 row_newbcast:3 row_mask:0xa bank_mask:0xf
    v_mul_f32_dpp v24, v16, v24 row_newbcast:4 row_mask:0xa bank_mask:0xf
    v_mul_f32_dpp v25, v16, v25 row_newbcast:5 row_mask:0xa bank_mask:0xf
    v_mul_f32_dpp v26, v16, v26 row_newbcast:6 row_mask:0xa bank_mask:0xf
    v_mul_f32_dpp v27, v16, v27 row_newbcast:7 row_mask:0xa bank_mask:0xf
    v_cvt_pk_bf16_f32 v64, v20, v21
    v_cvt_pk_bf16_f32 v65, v22, v23
    v_cvt_pk_bf16_f32 v66, v24, v25
    v_cvt_pk_bf16_f32 v67, v26, v27
    v_lshlrev_b32 v28, 16, v4
    v_and_b32 v29, 0xffff0000, v4
    v_lshlrev_b32 v30, 16, v5
    v_and_b32 v31, 0xffff0000, v5
    v_lshlrev_b32 v32, 16, v6
    v_and_b32 v33, 0xffff0000, v6
    v_lshlrev_b32 v34, 16, v7
    v_and_b32 v35, 0xffff0000, v7
    v_mul_f32_dpp v36, v17, v28 row_newbcast:8 row_mask:0xf bank_mask:0xf
    v_mul_f32_dpp v37, v17, v29 row_newbcast:9 row_mask:0xf bank_mask:0xf
    v_mul_f32_dpp v38, v17, v30 row_newbcast:10 row_mask:0xf bank_mask:0xf
    v_mul_f32_dpp v39, v17, v31 row_newbcast:11 row_mask:0xf bank_mask:0xf
    v_mul_f32_dpp v40, v17, v32 row_newbcast:12 row_mask:0xf bank_mask:0xf
    v_mul_f32_dpp v41, v17, v33 row_newbcast:13 row_mask:0xf bank_mask:0xf
    v_mul_f32_dpp v42, v17, v34 row_newbcast:14 row_mask:0xf bank_mask:0xf
    v_mul_f32_dpp v43, v17, v35 row_newbcast:15 row_mask:0xf bank_mask:0xf
    v_cvt_pk_bf16_f32 v76, v36, v37
    v_cvt_pk_bf16_f32 v77, v38, v39
    v_cvt_pk_bf16_f32 v78, v40, v41
    v_cvt_pk_bf16_f32 v79, v42, v43
    v_mul_f32_dpp v28, v17, v28 row_newbcast:0 row_mask:0xa bank_mask:0xf
    v_mul_f32_dpp v29, v17, v29 row_newbcast:1 row_mask:0xa bank_mask:0xf
    v_mul_f32_dpp v30, v17, v30 row_newbcast:2 row_mask:0xa bank_mask:0xf
    v_mul_f32_dpp v31, v17, v31 row_newbcast:3 row_mask:0xa bank_mask:0xf
    v_mul_f32_dpp v32, v17, v32 row_newbcast:4 row_mask:0xa bank_mask:0xf
    v_mul_f32_dpp v33, v17, v33 row_newbcast:5 row_mask:0xa bank_mask:0xf
    v_mul_f32_dpp v34, v17, v34 row_newbcast:6 row_mask:0xa bank_mask:0xf
    v_mul_f32_dpp v35, v17, v35 row_newbcast:7 row_mask:0xa bank_mask:0xf
    v_cvt_pk_bf16_f32 v72, v28, v29
    v_cvt_pk_bf16_f32 v73, v30, v31
    v_cvt_pk_bf16_f32 v74, v32, v33
    v_cvt_pk_bf16_f32 v75, v34, v35
    s_waitcnt lgkmcnt(0)
    v_lshlrev_b32 v20, 16, v8
    v_and_b32 v21, 0xffff0000, v8
    v_lshlrev_b32 v22, 16, v9
    v_and_b32 v23, 0xffff0000, v9
    v_mul_f32_dpp v36, v18, v20 row_newbcast:8 row_mask:0xf bank_mask:0xf
    v_mul_f32_dpp v37, v18, v21 row_newbcast:9 row_mask:0xf bank_mask:0xf
    v_mul_f32_dpp v38, v18, v22 row_newbcast:10 row_mask:0xf bank_mask:0xf
    v_mul_f32_dpp v39, v18, v23 row_newbcast:11 row_mask:0xf bank_mask:0xf
    v_cvt_pk_bf16_f32 v84, v36, v37
    v_cvt_pk_bf16_f32 v85, v38, v39
    v_mul_f32_dpp v20, v18, v20 row_newbcast:0 row_mask:0xa bank_mask:0xf
    v_mul_f32_dpp v21, v18, v21 row_newbcast:1 row_mask:0xa bank_mask:0xf
    v_mul_f32_dpp v22, v18, v22 row_newbcast:2 row_mask:0xa bank_mask:0xf
    v_mul_f32_dpp v23, v18, v23 row_newbcast:3 row_mask:0xa bank_mask:0xf
    v_cvt_pk_bf16_f32 v80, v20, v21
    v_cvt_pk_bf16_f32 v81, v22, v23
    s_waitcnt vmcnt(4)
    v_mfma_f32_32x32x16_bf16 v[0:15], v[64:67], v[176:179], 0
    ds_read_b64_tr_b16 v[184:185], v246 offset:2048
    ds_read_b64_tr_b16 v[186:187], v246 offset:3072
    ds_read_b64_tr_b16 v[188:189], v247 offset:2048
    ds_read_b64_tr_b16 v[190:191], v247 offset:3072
    s_mov_b32 m0, s68
    v_mfma_f32_32x32x16_bf16 v[16:31], v[68:71], v[176:179], 0
    buffer_load_dwordx4 v224, s[4:7], s41 offen sc1 lds
    buffer_load_dwordx4 v225, s[72:75], s41 offen offset:1024 sc1 lds
    v_permlane32_swap_b32 v242, v236
    v_permlane32_swap_b32 v243, v237
    s_add_u32 s38, s38, 1
    v_mfma_f32_32x32x16_bf16 v[32:47], v[64:67], v[180:183], 0
    v_permlane32_swap_b32 v244, v238
    v_permlane32_swap_b32 v245, v239
    v_permlane32_swap_b32 v240, v241
    v_add_f32 v242, v242, v236
    v_mfma_f32_32x32x16_bf16 v[48:63], v[68:71], v[180:183], 0
    v_add_f32 v243, v243, v237
    v_add_f32 v244, v244, v238
    v_add_f32 v245, v245, v239
    v_add_f32 v240, -v240, -v241
    v_mov_b32 v254, s52
    v_mov_b32 v255, s38
    s_waitcnt vmcnt(4) lgkmcnt(0)
    v_mfma_f32_32x32x16_bf16 v[0:15], v[72:75], v[184:187], v[0:15]
    ds_read_b64_tr_b16 v[176:177], v246 offset:4096
    ds_read_b64_tr_b16 v[180:181], v247 offset:4096
    s_lshl_b32 s58, s38, 3
    s_add_u32 s58, s58, s20
    s_mov_b32 m0, s69
    v_mfma_f32_32x32x16_bf16 v[16:31], v[76:79], v[184:187], v[16:31]
    buffer_load_dwordx4 v226, s[4:7], s41 offen sc1 lds
    s_set_gpr_idx_on s32, gpr_idx(DST)
    s_nop 0
    v_cvt_pk_bf16_f32 v195, v242, v243
    v_cvt_pk_bf16_f32 v196, v244, v245
    v_cvt_pk_bf16_f32 v197, v240, v240
    s_set_gpr_idx_off
    s_mov_b64 exec, 1
    ds_write_b32 v254, v255
    s_mov_b64 exec, -1
    s_cmp_lt_u32 s58, s22
    s_cbranch_scc0 K2_dyn_21
K2_back_22:
    v_readlane_b32 s3, v253, s58
    s_lshl_b32 s44, s34, 7
    s_and_b32 s48, s3, 0x3ffff
    s_bfe_u32 s33, s3, 0x30013
    s_mul_i32 s35, s38, 6
    s_cmp_eq_u32 s34, 0
    s_cselect_b32 s35, s35, s48
    s_mov_b32 s45, s44
    s_xor_b32 s47, s44, 256
    s_add_u32 s49, s48, 128
    s_add_u32 s60, s48, 256
    s_cmp_eq_u32 s33, 3
    s_cselect_b32 s46, s44, s47
    s_cselect_b32 s50, s60, s48
    s_cselect_b32 s51, s48, s49
    s_sub_u32 s60, s33, 2
    s_cmp_lt_u32 s60, 2
    s_cbranch_scc0 K2_rare_27
K2_back_28:
    v_mfma_f32_32x32x16_bf16 v[32:47], v[72:75], v[188:191], v[32:47]
    v_add_u32 v233, s48, v230
    ds_read_b32 v232, v233
    ds_read_b32 v233, v233 offset:1024
    v_mfma_f32_32x32x16_bf16 v[48:63], v[76:79], v[188:191], v[48:63]
    s_waitcnt vmcnt(3) lgkmcnt(3)
    v_mfma_f32_32x32x8_bf16 v[0:15], v[80:81], v[176:177], v[0:15]
    ds_read_b64_tr_b16 v[184:185], v246 offset:6144
    ds_read_b64_tr_b16 v[186:187], v246 offset:7168
    ds_read_b64_tr_b16 v[188:189], v247 offset:6144
    ds_read_b64_tr_b16 v[190:191], v247 offset:7168
    s_mov_b32 m0, s70
    v_mfma_f32_32x32x8_bf16 v[16:31], v[84:85], v[176:177], v[16:31]
    buffer_load_dwordx4 v222, s[4:7], s42 offen sc1 lds
    buffer_load_dwordx4 v223, s[72:75], s42 offen offset:1024 sc1 lds
    v_mfma_f32_32x32x8_bf16 v[32:47], v[80:81], v[180:181], v[32:47]
    s_nop 2
    v_mul_f32 v234, v0, v96
    v_mul_f32 v236, v8, v128
    v_fmac_f32 v234, v1, v97
    v_fmac_f32 v236, v9, v129
    v_fmac_f32 v234, v2, v98
    v_fmac_f32 v236, v10, v130
    v_fmac_f32 v234, v3, v99
    v_mfma_f32_32x32x8_bf16 v[48:63], v[84:85], v[180:181], v[48:63]
    s_setprio 0
    s_waitcnt lgkmcnt(4)
    v_or_b32 v232, v232, v231
    v_or_b32 v233, v233, v231
    s_cmp_lg_u32 s34, 0
    s_cbranch_scc1 K2_dum_30
    s_cmp_eq_u32 s33, 4
    s_cbranch_scc1 K2_a4_31
K2_b4_33:
    s_add_u32 m0, s48, 512
    s_add_u32 s65, s48, 1536
    buffer_load_dwordx4 v232, s[16:19], 0 offen  lds
    s_mov_b32 m0, s65
    s_mov_b32 exec_hi, 0
    buffer_load_dwordx4 v233, s[16:19], 0 offen  lds
    s_mov_b32 exec_hi, -1
K2_back_32:
    v_fmac_f32 v236, v11, v131
    v_fmac_f32 v234, v4, v100
    v_fmac_f32 v236, v12, v132
    v_fmac_f32 v234, v5, v101
    v_fmac_f32 v236, v13, v133
    v_fmac_f32 v234, v6, v102
    v_fmac_f32 v236, v14, v134
    v_fmac_f32 v234, v7, v103
    v_fmac_f32 v236, v15, v135
    v_mul_f32 v238, v16, v128
    v_mul_f32 v240, v24, v128
    v_fmac_f32 v238, v17, v129
    v_fmac_f32 v240, v25, v129
    v_fmac_f32 v238, v18, v130
    v_fmac_f32 v240, v26, v130
    v_fmac_f32 v238, v19, v131
    v_fmac_f32 v240, v27, v131
    v_fmac_f32 v238, v20, v132
    v_fmac_f32 v240, v28, v132
    v_fmac_f32 v238, v21, v133
    v_fmac_f32 v240, v29, v133
    v_fmac_f32 v238, v22, v134
    v_fmac_f32 v240, v30, v134
    v_fmac_f32 v238, v23, v135
    v_fmac_f32 v240, v31, v135
    v_mul_f32 v235, v32, v104
    v_mul_f32 v237, v40, v136
    v_fmac_f32 v235, v33, v105
    v_fmac_f32 v237, v41, v137
    v_fmac_f32 v235, v34, v106
    v_fmac_f32 v237, v42, v138
    v_fmac_f32 v235, v35, v107
    v_fmac_f32 v237, v43, v139
    v_fmac_f32 v235, v36, v108
    v_fmac_f32 v237, v44, v140
    v_fmac_f32 v235, v37, v109
    v_fmac_f32 v237, v45, v141
    v_fmac_f32 v235, v38, v110
    v_fmac_f32 v237, v46, v142
    v_fmac_f32 v235, v39, v111
    v_fmac_f32 v237, v47, v143
    v_mul_f32 v239, v48, v136
    v_mul_f32 v241, v56, v136
    s_setprio 1
    s_waitcnt vmcnt(5) lgkmcnt(0)
    v_mfma_f32_32x32x16_bf16 v[0:15], v[64:67], v[184:187], 0
    ds_read_b64_tr_b16 v[176:177], v246 offset:0
    ds_read_b64_tr_b16 v[178:179], v246 offset:1024
    ds_read_b64_tr_b16 v[180:181], v247 offset:0
    ds_read_b64_tr_b16 v[182:183], v247 offset:1024
    v_fmac_f32 v239, v49, v137
    v_fmac_f32 v241, v57, v137
    s_mov_b32 m0, s71
    v_mfma_f32_32x32x16_bf16 v[16:31], v[68:71], v[184:187], 0
    buffer_load_dwordx4 v224, s[4:7], s42 offen sc1 lds
    buffer_load_dwordx4 v225, s[72:75], s42 offen offset:1024 sc1 lds
    v_fmac_f32 v239, v50, v138
    v_fmac_f32 v241, v58, v138
    v_fmac_f32 v239, v51, v139
    v_fmac_f32 v241, v59, v139
    v_fmac_f32 v239, v52, v140
    v_mfma_f32_32x32x16_bf16 v[32:47], v[64:67], v[188:191], 0
    v_fmac_f32 v241, v60, v140
    v_fmac_f32 v239, v53, v141
    v_fmac_f32 v241, v61, v141
    v_fmac_f32 v239, v54, v142
    v_fmac_f32 v241, v62, v142
    v_fmac_f32 v239, v55, v143
    v_fmac_f32 v241, v63, v143
    v_mfma_f32_32x32x16_bf16 v[48:63], v[68:71], v[188:191], 0
    v_permlane32_swap_b32 v234, v236
    v_permlane32_swap_b32 v235, v237
    v_permlane32_swap_b32 v240, v238
    s_waitcnt vmcnt(6) lgkmcnt(0)
    v_mfma_f32_32x32x16_bf16 v[0:15], v[72:75], v[176:179], v[0:15]
    ds_read_b64_tr_b16 v[184:185], v246 offset:2048
    ds_read_b64_tr_b16 v[188:189], v247 offset:2048
    v_permlane32_swap_b32 v241, v239
    v_add_f32 v234, v234, v236
    v_add_f32 v235, v235, v237
    s_mov_b32 m0, s68
    v_mfma_f32_32x32x16_bf16 v[16:31], v[76:79], v[176:179], v[16:31]
    buffer_load_dwordx4 v226, s[4:7], s42 offen sc1 lds
    v_add_f32 v240, v240, v238
    v_add_f32 v241, v241, v239
    s_set_gpr_idx_on s31, gpr_idx(DST)
    s_nop 0
    v_cvt_pk_bf16_f32 v192, v234, v235
    v_cvt_pk_bf16_f32 v193, v240, v241
    s_set_gpr_idx_off
    v_mfma_f32_32x32x16_bf16 v[32:47], v[72:75], v[180:183], v[32:47]
    v_mfma_f32_32x32x16_bf16 v[48:63], v[76:79], v[180:183], v[48:63]
    s_waitcnt vmcnt(5) lgkmcnt(0)
    v_mfma_f32_32x32x8_bf16 v[0:15], v[80:81], v[184:185], v[0:15]
    ds_read_b64_tr_b16 v[176:177], v246 offset:4096
    ds_read_b64_tr_b16 v[178:179], v246 offset:5120
    ds_read_b64_tr_b16 v[180:181], v247 offset:4096
    ds_read_b64_tr_b16 v[182:183], v247 offset:5120
    s_mov_b32 m0, s69
    v_mfma_f32_32x32x8_bf16 v[16:31], v[84:85], v[184:185], v[16:31]
    buffer_load_dwordx4 v222, s[4:7], s43 offen sc1 lds
    buffer_load_dwordx4 v223, s[72:75], s43 offen offset:1024 sc1 lds
    v_mfma_f32_32x32x8_bf16 v[32:47], v[80:81], v[188:189], v[32:47]
    s_nop 2
    v_mul_f32 v234, v0, v144
    v_mul_f32 v236, v8, v112
    v_fmac_f32 v234, v1, v145
    v_fmac_f32 v236, v9, v113
    v_fmac_f32 v234, v2, v146
    v_fmac_f32 v236, v10, v114
    v_fmac_f32 v234, v3, v147
    v_mfma_f32_32x32x8_bf16 v[48:63], v[84:85], v[188:189], v[48:63]
    s_setprio 0
    v_fmac_f32 v236, v11, v115
    v_fmac_f32 v234, v4, v148
    v_fmac_f32 v236, v12, v116
    v_fmac_f32 v234, v5, v149
    v_fmac_f32 v236, v13, v117
    v_fmac_f32 v234, v6, v150
    v_fmac_f32 v236, v14, v118
    v_fmac_f32 v234, v7, v151
    v_fmac_f32 v236, v15, v119
    v_mul_f32 v238, v16, v160
    v_mul_f32 v240, v24, v160
    v_fmac_f32 v238, v17, v161
    v_fmac_f32 v240, v25, v161
    v_fmac_f32 v238, v18, v162
    v_fmac_f32 v240, v26, v162
    v_fmac_f32 v238, v19, v163
    v_fmac_f32 v240, v27, v163
    v_fmac_f32 v238, v20, v164
    v_fmac_f32 v240, v28, v164
    v_fmac_f32 v238, v21, v165
    v_fmac_f32 v240, v29, v165
    v_fmac_f32 v238, v22, v166
    v_fmac_f32 v240, v30, v166
    v_fmac_f32 v238, v23, v167
    v_fmac_f32 v240, v31, v167
    v_mul_f32 v235, v32, v152
    v_mul_f32 v237, v40, v120
    v_fmac_f32 v235, v33, v153
    v_fmac_f32 v237, v41, v121
    v_fmac_f32 v235, v34, v154
    v_fmac_f32 v237, v42, v122
    v_fmac_f32 v235, v35, v155
    v_fmac_f32 v237, v43, v123
    v_fmac_f32 v235, v36, v156
    v_fmac_f32 v237, v44, v124
    v_fmac_f32 v235, v37, v157
    v_fmac_f32 v237, v45, v125
    v_fmac_f32 v235, v38, v158
    v_fmac_f32 v237, v46, v126
    v_fmac_f32 v235, v39, v159
    v_fmac_f32 v237, v47, v127
    v_mul_f32 v239, v48, v168
    v_mul_f32 v241, v56, v168
    v_fmac_f32 v239, v49, v169
    v_fmac_f32 v241, v57, v169
    s_setprio 1
    s_waitcnt vmcnt(3) lgkmcnt(0)
    v_mfma_f32_32x32x16_bf16 v[0:15], v[64:67], v[176:179], 0
    ds_read_b64_tr_b16 v[184:185], v246 offset:6144
    ds_read_b64_tr_b16 v[186:187], v246 offset:7168
    ds_read_b64_tr_b16 v[188:189], v247 offset:6144
    ds_read_b64_tr_b16 v[190:191], v247 offset:7168
    v_fmac_f32 v239, v50, v170
    v_fmac_f32 v241, v58, v170
    s_mov_b32 m0, s70
    v_mfma_f32_32x32x16_bf16 v[16:31], v[68:71], v[176:179], 0
    buffer_load_dwordx4 v224, s[4:7], s43 offen sc1 lds
    buffer_load_dwordx4 v225, s[72:75], s43 offen offset:1024 sc1 lds
    v_fmac_f32 v239, v51, v171
    v_fmac_f32 v241, v59, v171
    v_fmac_f32 v239, v52, v172
    v_fmac_f32 v241, v60, v172
    v_fmac_f32 v239, v53, v173
    v_mfma_f32_32x32x16_bf16 v[32:47], v[64:67], v[180:183], 0
    v_add_u32 v222, s48, v251
    ds_read2_b32 v[222:223], v222 offset0:1 offset1:3
    v_fmac_f32 v241, v61, v173
    v_fmac_f32 v239, v54, v174
    v_fmac_f32 v241, v62, v174
    v_fmac_f32 v239, v55, v175
    v_fmac_f32 v241, v63, v175
    v_mfma_f32_32x32x16_bf16 v[48:63], v[68:71], v[180:183], 0
    s_waitcnt vmcnt(4) lgkmcnt(1)
    v_mfma_f32_32x32x16_bf16 v[0:15], v[72:75], v[184:187], v[0:15]
    ds_read_b64_tr_b16 v[176:177], v246 offset:0
    ds_read_b64_tr_b16 v[180:181], v247 offset:0
    s_mov_b32 m0, s71
    v_mfma_f32_32x32x16_bf16 v[16:31], v[76:79], v[184:187], v[16:31]
    buffer_load_dwordx4 v226, s[4:7], s43 offen sc1 lds
    s_waitcnt lgkmcnt(2)
    v_mad_u32_u16 v222, v222, s39, v248 op_sel:[1,0,0,0]
    v_mad_u32_u16 v223, v223, s39, v248 op_sel:[1,0,0,0]
    v_mfma_f32_32x32x16_bf16 v[32:47], v[72:75], v[188:191], v[32:47]
    v_add_u32 v224, s49, v251
    ds_read2_b32 v[224:225], v224 offset0:1 offset1:3
    v_mfma_f32_32x32x16_bf16 v[48:63], v[76:79], v[188:191], v[48:63]
    s_waitcnt vmcnt(3) lgkmcnt(1)
    v_mfma_f32_32x32x8_bf16 v[0:15], v[80:81], v[176:177], v[0:15]
    ds_read_b64_tr_b16 v[184:185], v246 offset:2048
    ds_read_b64_tr_b16 v[186:187], v246 offset:3072
    ds_read_b64_tr_b16 v[188:189], v247 offset:2048
    ds_read_b64_tr_b16 v[190:191], v247 offset:3072
    s_mov_b32 m0, s68
    v_mfma_f32_32x32x8_bf16 v[16:31], v[84:85], v[176:177], v[16:31]
    buffer_load_dwordx4 v222, s[4:7], s44 offen sc1 lds
    buffer_load_dwordx4 v223, s[72:75], s44 offen offset:1024 sc1 lds
    s_waitcnt lgkmcnt(4)
    v_mad_u32_u16 v224, v224, s39, v248 op_sel:[1,0,0,0]
    v_mad_u32_u16 v225, v225, s39, v248 op_sel:[1,0,0,0]
    v_mfma_f32_32x32x8_bf16 v[32:47], v[80:81], v[180:181], v[32:47]
    v_add_u32 v226, s50, v251
    ds_read2_b32 v[226:227], v226 offset0:1 offset1:3
    v_mul_f32 v242, v0, v144
    v_fma_f32 v238, v8, v160, -v238
    v_fmac_f32 v242, v1, v145
    v_fmac_f32 v238, v9, v161
    v_fmac_f32 v242, v2, v146
    v_mfma_f32_32x32x8_bf16 v[48:63], v[84:85], v[180:181], v[48:63]
    s_setprio 0
    v_fmac_f32 v238, v10, v162
    v_fmac_f32 v242, v3, v147
    v_fmac_f32 v238, v11, v163
    v_fmac_f32 v242, v4, v148
    v_fmac_f32 v238, v12, v164
    v_fmac_f32 v242, v5, v149
    v_fmac_f32 v238, v13, v165
    v_fmac_f32 v242, v6, v150
    v_fmac_f32 v238, v14, v166
    v_fmac_f32 v242, v7, v151
    v_fmac_f32 v238, v15, v167
    v_fmac_f32 v236, v16, v112
    v_mul_f32 v244, v24, v160
    v_fmac_f32 v236, v17, v113
    v_fmac_f32 v244, v25, v161
    v_fmac_f32 v236, v18, v114
    v_fmac_f32 v244, v26, v162
    v_fmac_f32 v236, v19, v115
    v_fmac_f32 v244, v27, v163
    v_fmac_f32 v236, v20, v116
    v_fmac_f32 v244, v28, v164
    v_fmac_f32 v236, v21, v117
    v_fmac_f32 v244, v29, v165
    v_fmac_f32 v236, v22, v118
    v_fmac_f32 v244, v30, v166
    v_fmac_f32 v236, v23, v119
    v_fmac_f32 v244, v31, v167
    v_mul_f32 v243, v32, v152
    v_fma_f32 v239, v40, v168, -v239
    v_fmac_f32 v243, v33, v153
    v_fmac_f32 v239, v41, v169
    v_fmac_f32 v243, v34, v154
    v_fmac_f32 v239, v42, v170
    v_fmac_f32 v243, v35, v155
    v_fmac_f32 v239, v43, v171
    v_fmac_f32 v243, v36, v156
    v_fmac_f32 v239, v44, v172
    v_fmac_f32 v243, v37, v157
    v_fmac_f32 v239, v45, v173
    v_fmac_f32 v243, v38, v158
    v_fmac_f32 v239, v46, v174
    v_fmac_f32 v243, v39, v159
    v_fmac_f32 v239, v47, v175
    v_fmac_f32 v237, v48, v120
    v_mul_f32 v245, v56, v168
    v_fmac_f32 v237, v49, v121
    v_fmac_f32 v245, v57, v169
    v_fmac_f32 v237, v50, v122
    v_fmac_f32 v245, v58, v170
    v_fmac_f32 v237, v51, v123
    s_setprio 1
    s_waitcnt vmcnt(3) lgkmcnt(1)
    v_mfma_f32_32x32x16_bf16 v[0:15], v[64:67], v[184:187], 0
    ds_read_b64_tr_b16 v[176:177], v246 offset:4096
    ds_read_b64_tr_b16 v[178:179], v246 offset:5120
    ds_read_b64_tr_b16 v[180:181], v247 offset:4096
    ds_read_b64_tr_b16 v[182:183], v247 offset:5120
    v_fmac_f32 v245, v59, v171
    v_fmac_f32 v237, v52, v124
    s_mov_b32 m0, s69
    v_mfma_f32_32x32x16_bf16 v[16:31], v[68:71], v[184:187], 0
    buffer_load_dwordx4 v224, s[4:7], s45 offen sc1 lds
    buffer_load_dwordx4 v225, s[72:75], s45 offen offset:1024 sc1 lds
    s_waitcnt lgkmcnt(4)
    v_mad_u32_u16 v226, v226, s39, v248 op_sel:[1,0,0,0]
    v_mad_u32_u16 v227, v227, s39, v248 op_sel:[1,0,0,0]
    v_fmac_f32 v245, v60, v172
    v_fmac_f32 v237, v53, v125
    v_mfma_f32_32x32x16_bf16 v[32:47], v[64:67], v[188:191], 0
    v_add_u32 v228, s51, v251
    ds_read2_b32 v[228:229], v228 offset0:1 offset1:3
    v_fmac_f32 v245, v61, v173
    v_fmac_f32 v237, v54, v126
    v_fmac_f32 v245, v62, v174
    v_fmac_f32 v237, v55, v127
    v_fmac_f32 v245, v63, v175
    v_mfma_f32_32x32x16_bf16 v[48:63], v[68:71], v[188:191], 0
    v_permlane32_swap_b32 v242, v234
    v_permlane32_swap_b32 v243, v235
    v_add_f32 v242, v242, v234
    v_add_f32 v243, v243, v235
    s_waitcnt vmcnt(4) lgkmcnt(1)
    v_mfma_f32_32x32x16_bf16 v[0:15], v[72:75], v[176:179], v[0:15]
    ds_read_b64_tr_b16 v[184:185], v246 offset:6144
    ds_read_b64_tr_b16 v[188:189], v247 offset:6144
    s_set_gpr_idx_on s31, gpr_idx(DST)
    s_nop 0
    v_cvt_pk_bf16_f32 v194, v242, v243
    s_set_gpr_idx_off
    s_mov_b32 s32, s31
    s_mov_b32 m0, s70
    v_mfma_f32_32x32x16_bf16 v[16:31], v[76:79], v[176:179], v[16:31]
    buffer_load_dwordx4 v226, s[4:7], s46 offen sc1 lds
    buffer_load_dwordx4 v227, s[72:75], s46 offen offset:1024 sc1 lds
    s_waitcnt lgkmcnt(2)
    v_mad_u32_u16 v228, v228, s39, v248 op_sel:[1,0,0,0]
    v_mad_u32_u16 v229, v229, s39, v248 op_sel:[1,0,0,0]
    s_sub_u32 s26, s48, s29
    s_mov_b32 s29, s48
    v_mfma_f32_32x32x16_bf16 v[32:47], v[72:75], v[180:183], v[32:47]
    s_mov_b32 s30, s3
    s_bfe_u32 s56, s3, 0x40012
    s_cmp_eq_u32 s34, 0
    s_cselect_b32 s56, s56, 0
    s_mov_b32 s31, s35
    v_mfma_f32_32x32x16_bf16 v[48:63], v[76:79], v[180:183], v[48:63]
    s_waitcnt vmcnt(4) lgkmcnt(0)
    v_mfma_f32_32x32x8_bf16 v[0:15], v[80:81], v[184:185], v[0:15]
    ds_read_b64_tr_b16 v[176:177], v246 offset:0
    ds_read_b64_tr_b16 v[178:179], v246 offset:1024
    ds_read_b64_tr_b16 v[180:181], v247 offset:0
    ds_read_b64_tr_b16 v[182:183], v247 offset:1024
    s_mov_b32 m0, s71
    v_mfma_f32_32x32x8_bf16 v[16:31], v[84:85], v[184:185], v[16:31]
    buffer_load_dwordx4 v228, s[4:7], s47 offen sc1 lds
    buffer_load_dwordx4 v229, s[72:75], s47 offen offset:1024 sc1 lds
    v_mfma_f32_32x32x8_bf16 v[32:47], v[80:81], v[188:189], v[32:47]
    s_nop 2
    v_mul_f32 v242, v0, v144
    v_fma_f32 v240, v8, v160, -v240
    v_fmac_f32 v242, v1, v145
    v_fmac_f32 v240, v9, v161
    v_fmac_f32 v242, v2, v146
    v_fmac_f32 v240, v10, v162
    v_fmac_f32 v242, v3, v147
    v_mfma_f32_32x32x8_bf16 v[48:63], v[84:85], v[188:189], v[48:63]
    s_setprio 0
    v_fmac_f32 v240, v11, v163
    v_fmac_f32 v242, v4, v148
    v_fmac_f32 v240, v12, v164
    v_fmac_f32 v242, v5, v149
    v_fmac_f32 v240, v13, v165
    v_fmac_f32 v242, v6, v150
    v_fmac_f32 v240, v14, v166
    v_fmac_f32 v242, v7, v151
    v_fmac_f32 v240, v15, v167
    v_add_u32 v249, s26, v249
    v_add_u32 v250, s26, v250
    v_fma_f32 v244, v16, v160, -v244
    v_fmac_f32 v236, v24, v112
    v_fmac_f32 v244, v17, v161
    v_fmac_f32 v236, v25, v113
    v_fmac_f32 v244, v18, v162
    v_fmac_f32 v236, v26, v114
    v_fmac_f32 v244, v19, v163
    v_fmac_f32 v236, v27, v115
    v_fmac_f32 v244, v20, v164
    v_fmac_f32 v236, v28, v116
    v_fmac_f32 v244, v21, v165
    v_fmac_f32 v236, v29, v117
    v_fmac_f32 v244, v22, v166
    v_fmac_f32 v236, v30, v118
    v_fmac_f32 v244, v23, v167
    v_fmac_f32 v236, v31, v119
    ds_read_b64_tr_b16 v[0:1], v249 offset:0
    ds_read_b64_tr_b16 v[2:3], v249 offset:32
    ds_read_u16_d16_hi v16, v250 offset:0
    v_mul_f32 v243, v32, v152
    v_fma_f32 v241, v40, v168, -v241
    v_fmac_f32 v243, v33, v153
    v_fmac_f32 v241, v41, v169
    v_fmac_f32 v243, v34, v154
    v_fmac_f32 v241, v42, v170
    v_fmac_f32 v243, v35, v155
    v_fmac_f32 v241, v43, v171
    v_fmac_f32 v243, v36, v156
    v_fmac_f32 v241, v44, v172
    v_fmac_f32 v243, v37, v157
    v_fmac_f32 v241, v45, v173
    v_fmac_f32 v243, v38, v158
    v_fmac_f32 v241, v46, v174
    v_fmac_f32 v243, v39, v159
    v_fmac_f32 v241, v47, v175
    ds_read_b64_tr_b16 v[4:5], v249 offset:512
    ds_read_b64_tr_b16 v[6:7], v249 offset:544
    ds_read_u16_d16_hi v17, v250 offset:128
    v_fma_f32 v245, v48, v168, -v245
    v_fmac_f32 v237, v56, v120
    v_fmac_f32 v245, v49, v169
    v_fmac_f32 v237, v57, v121
    v_fmac_f32 v245, v50, v170
    v_fmac_f32 v237, v58, v122
    v_fmac_f32 v245, v51, v171
    v_fmac_f32 v237, v59, v123
    v_fmac_f32 v245, v52, v172
    v_fmac_f32 v237, v60, v124
    v_fmac_f32 v245, v53, v173
    v_fmac_f32 v237, v61, v125
    v_fmac_f32 v245, v54, v174
    v_fmac_f32 v237, v62, v126
    v_fmac_f32 v245, v55, v175
    v_fmac_f32 v237, v63, v127
    s_cmp_eq_u32 s56, 5
    s_cbranch_scc1 K2_U20
    s_cmp_eq_u32 s56, 6
    s_cbranch_scc1 K2_U3h0
    s_branch K2_DSP0
K2_U30:
    s_setprio 1
    ds_read_b64_tr_b16 v[8:9], v249 offset:1024
    ds_read_b64_tr_b16 v[10:11], v249 offset:1056
    ds_read_u16_d16_hi v18, v250 offset:256
    s_waitcnt lgkmcnt(3)
    v_lshlrev_b32 v20, 16, v0
    v_and_b32 v21, 0xffff0000, v0
    v_lshlrev_b32 v22, 16, v1
    v_and_b32 v23, 0xffff0000, v1
    v_lshlrev_b32 v24, 16, v2
    v_and_b32 v25, 0xffff0000, v2
    v_lshlrev_b32 v26, 16, v3
    v_and_b32 v27, 0xffff0000, v3
    v_mul_f32_dpp v36, v16, v20 row_newbcast:8 row_mask:0xf bank_mask:0xf
    v_mul_f32_dpp v37, v16, v21 row_newbcast:9 row_mask:0xf bank_mask:0xf
    v_mul_f32_dpp v38, v16, v22 row_newbcast:10 row_mask:0xf bank_mask:0xf
    v_mul_f32_dpp v39, v16, v23 row_newbcast:11 row_mask:0xf bank_mask:0xf
    v_mul_f32_dpp v40, v16, v24 row_newbcast:12 row_mask:0xf bank_mask:0xf
    v_mul_f32_dpp v41, v16, v25 row_newbcast:13 row_mask:0xf bank_mask:0xf
    v_mul_f32_dpp v42, v16, v26 row_newbcast:14 row_mask:0xf bank_mask:0xf
    v_mul_f32_dpp v43, v16, v27 row_newbcast:15 row_mask:0xf bank_mask:0xf
    v_cvt_pk_bf16_f32 v68, v36, v37
    v_cvt_pk_bf16_f32 v69, v38, v39
    v_cvt_pk_bf16_f32 v70, v40, v41
    v_cvt_pk_bf16_f32 v71, v42, v43
    v_mul_f32_dpp v20, v16, v20 row_newbcast:0 row_mask:0xa bank_mask:0xf
    v_mul_f32_dpp v21, v16, v21 row_newbcast:1 row_mask:0xa bank_mask:0xf
    v_mul_f32_dpp v22, v16, v22 row_newbcast:2 row_mask:0xa bank_mask:0xf
    v_mul_f32_dpp v23, v16, v23 row_newbcast:3 row_mask:0xa bank_mask:0xf
    v_mul_f32_dpp v24, v16, v24 row_newbcast:4 row_mask:0xa bank_mask:0xf
    v_mul_f32_dpp v25, v16, v25 row_newbcast:5 row_mask:0xa bank_mask:0xf
    v_mul_f32_dpp v26, v16, v26 row_newbcast:6 row_mask:0xa bank_mask:0xf
    v_mul_f32_dpp v27, v16, v27 row_newbcast:7 row_mask:0xa bank_mask:0xf
    v_cvt_pk_bf16_f32 v64, v20, v21
    v_cvt_pk_bf16_f32 v65, v22, v23
    v_cvt_pk_bf16_f32 v66, v24, v25
    v_cvt_pk_bf16_f32 v67, v26, v27
    v_lshlrev_b32 v28, 16, v4
    v_and_b32 v29, 0xffff0000, v4
    v_lshlrev_b32 v30, 16, v5
    v_and_b32 v31, 0xffff0000, v5
    v_lshlrev_b32 v32, 16, v6
    v_and_b32 v33, 0xffff0000, v6
    v_lshlrev_b32 v34, 16, v7
    v_and_b32 v35, 0xffff0000, v7
    v_mul_f32_dpp v36, v17, v28 row_newbcast:8 row_mask:0xf bank_mask:0xf
    v_mul_f32_dpp v37, v17, v29 row_newbcast:9 row_mask:0xf bank_mask:0xf
    v_mul_f32_dpp v38, v17, v30 row_newbcast:10 row_mask:0xf bank_mask:0xf
    v_mul_f32_dpp v39, v17, v31 row_newbcast:11 row_mask:0xf bank_mask:0xf
    v_mul_f32_dpp v40, v17, v32 row_newbcast:12 row_mask:0xf bank_mask:0xf
    v_mul_f32_dpp v41, v17, v33 row_newbcast:13 row_mask:0xf bank_mask:0xf
    v_mul_f32_dpp v42, v17, v34 row_newbcast:14 row_mask:0xf bank_mask:0xf
    v_mul_f32_dpp v43, v17, v35 row_newbcast:15 row_mask:0xf bank_mask:0xf
    v_cvt_pk_bf16_f32 v76, v36, v37
    v_cvt_pk_bf16_f32 v77, v38, v39
    v_cvt_pk_bf16_f32 v78, v40, v41
    v_cvt_pk_bf16_f32 v79, v42, v43
    v_mul_f32_dpp v28, v17, v28 row_newbcast:0 row_mask:0xa bank_mask:0xf
    v_mul_f32_dpp v29, v17, v29 row_newbcast:1 row_mask:0xa bank_mask:0xf
    v_mul_f32_dpp v30, v17, v30 row_newbcast:2 row_mask:0xa bank_mask:0xf
    v_mul_f32_dpp v31, v17, v31 row_newbcast:3 row_mask:0xa bank_mask:0xf
    v_mul_f32_dpp v32, v17, v32 row_newbcast:4 row_mask:0xa bank_mask:0xf
    v_mul_f32_dpp v33, v17, v33 row_newbcast:5 row_mask:0xa bank_mask:0xf
    v_mul_f32_dpp v34, v17, v34 row_newbcast:6 row_mask:0xa bank_mask:0xf
    v_mul_f32_dpp v35, v17, v35 row_newbcast:7 row_mask:0xa bank_mask:0xf
    v_cvt_pk_bf16_f32 v72, v28, v29
    v_cvt_pk_bf16_f32 v73, v30, v31
    v_cvt_pk_bf16_f32 v74, v32, v33
    v_cvt_pk_bf16_f32 v75, v34, v35
    s_waitcnt lgkmcnt(0)
    v_lshlrev_b32 v20, 16, v8
    v_and_b32 v21, 0xffff0000, v8
    v_lshlrev_b32 v22, 16, v9
    v_and_b32 v23, 0xffff0000, v9
    v_lshlrev_b32 v24, 16, v10
    v_and_b32 v25, 0xffff0000, v10
    v_lshlrev_b32 v26, 16, v11
    v_and_b32 v27, 0xffff0000, v11
    v_mul_f32_dpp v36, v18, v20 row_newbcast:8 row_mask:0xf bank_mask:0xf
    v_mul_f32_dpp v37, v18, v21 row_newbcast:9 row_mask:0xf bank_mask:0xf
    v_mul_f32_dpp v38, v18, v22 row_newbcast:10 row_mask:0xf bank_mask:0xf
    v_mul_f32_dpp v39, v18, v23 row_newbcast:11 row_mask:0xf bank_mask:0xf
    v_mul_f32_dpp v40, v18, v24 row_newbcast:12 row_mask:0xf bank_mask:0xf
    v_mul_f32_dpp v41, v18, v25 row_newbcast:13 row_mask:0xf bank_mask:0xf
    v_mul_f32_dpp v42, v18, v26 row_newbcast:14 row_mask:0xf bank_mask:0xf
    v_mul_f32_dpp v43, v18, v27 row_newbcast:15 row_mask:0xf bank_mask:0xf
    v_cvt_pk_bf16_f32 v84, v36, v37
    v_cvt_pk_bf16_f32 v85, v38, v39
    v_cvt_pk_bf16_f32 v86, v40, v41
    v_cvt_pk_bf16_f32 v87, v42, v43
    v_mul_f32_dpp v20, v18, v20 row_newbcast:0 row_mask:0xa bank_mask:0xf
    v_mul_f32_dpp v21, v18, v21 row_newbcast:1 row_mask:0xa bank_mask:0xf
    v_mul_f32_dpp v22, v18, v22 row_newbcast:2 row_mask:0xa bank_mask:0xf
    v_mul_f32_dpp v23, v18, v23 row_newbcast:3 row_mask:0xa bank_mask:0xf
    v_mul_f32_dpp v24, v18, v24 row_newbcast:4 row_mask:0xa bank_mask:0xf
    v_mul_f32_dpp v25, v18, v25 row_newbcast:5 row_mask:0xa bank_mask:0xf
    v_mul_f32_dpp v26, v18, v26 row_newbcast:6 row_mask:0xa bank_mask:0xf
    v_mul_f32_dpp v27, v18, v27 row_newbcast:7 row_mask:0xa bank_mask:0xf
    v_cvt_pk_bf16_f32 v80, v20, v21
    v_cvt_pk_bf16_f32 v81, v22, v23
    v_cvt_pk_bf16_f32 v82, v24, v25
    v_cvt_pk_bf16_f32 v83, v26, v27
    s_waitcnt vmcnt(4)
    v_mfma_f32_32x32x16_bf16 v[0:15], v[64:67], v[176:179], 0
    ds_read_b64_tr_b16 v[184:185], v246 offset:2048
    ds_read_b64_tr_b16 v[186:187], v246 offset:3072
    ds_read_b64_tr_b16 v[188:189], v247 offset:2048
    ds_read_b64_tr_b16 v[190:191], v247 offset:3072
    s_mov_b32 m0, s68
    v_mfma_f32_32x32x16_bf16 v[16:31], v[68:71], v[176:179], 0
    buffer_load_dwordx4 v224, s[4:7], s41 offen sc1 lds
    buffer_load_dwordx4 v225, s[72:75], s41 offen offset:1024 sc1 lds
    v_permlane32_swap_b32 v242, v236
    v_permlane32_swap_b32 v243, v237
    s_add_u32 s38, s38, 1
    v_mfma_f32_32x32x16_bf16 v[32:47], v[64:67], v[180:183], 0
    v_permlane32_swap_b32 v244, v238
    v_permlane32_swap_b32 v245, v239
    v_permlane32_swap_b32 v240, v241
    v_add_f32 v242, v242, v236
    v_mfma_f32_32x32x16_bf16 v[48:63], v[68:71], v[180:183], 0
    v_add_f32 v243, v243, v237
    v_add_f32 v244, v244, v238
    v_add_f32 v245, v245, v239
    v_add_f32 v240, -v240, -v241
    v_mov_b32 v254, s52
    v_mov_b32 v255, s38
    s_waitcnt vmcnt(4) lgkmcnt(0)
    v_mfma_f32_32x32x16_bf16 v[0:15], v[72:75], v[184:187], v[0:15]
    ds_read_b64_tr_b16 v[176:177], v246 offset:4096
    ds_read_b64_tr_b16 v[178:179], v246 offset:5120
    ds_read_b64_tr_b16 v[180:181], v247 offset:4096
    ds_read_b64_tr_b16 v[182:183], v247 offset:5120
    s_lshl_b32 s58, s38, 3
    s_add_u32 s58, s58, s20
    s_mov_b32 m0, s69
    v_mfma_f32_32x32x16_bf16 v[16:31], v[76:79], v[184:187], v[16:31]
    buffer_load_dwordx4 v226, s[4:7], s41 offen sc1 lds
    buffer_load_dwordx4 v227, s[72:75], s41 offen offset:1024 sc1 lds
    s_set_gpr_idx_on s32, gpr_idx(DST)
    s_nop 0
    v_cvt_pk_bf16_f32 v195, v242, v243
    v_cvt_pk_bf16_f32 v196, v244, v245
    v_cvt_pk_bf16_f32 v197, v240, v240
    s_set_gpr_idx_off
    s_mov_b64 exec, 1
    ds_write_b32 v254, v255
    s_mov_b64 exec, -1
    s_cmp_lt_u32 s58, s22
    s_cbranch_scc0 K2_dyn_34
K2_back_35:
    v_readlane_b32 s3, v253, s58
    s_lshl_b32 s44, s34, 7
    s_and_b32 s48, s3, 0x3ffff
    s_bfe_u32 s33, s3, 0x30013
    s_mul_i32 s35, s38, 6
    s_cmp_eq_u32 s34, 0
    s_cselect_b32 s35, s35, s48
    s_mov_b32 s45, s44
    s_xor_b32 s47, s44, 256
    s_add_u32 s49, s48, 128
    s_add_u32 s60, s48, 256
    s_cmp_eq_u32 s33, 3
    s_cselect_b32 s46, s44, s47
    s_cselect_b32 s50, s60, s48
    s_cselect_b32 s51, s48, s49
    s_sub_u32 s60, s33, 2
    s_cmp_lt_u32 s60, 2
    s_cbranch_scc0 K2_rare_40
K2_back_41:
    v_mfma_f32_32x32x16_bf16 v[32:47], v[72:75], v[188:191], v[32:47]
    v_add_u32 v233, s48, v230
    ds_read_b32 v232, v233
    ds_read_b32 v233, v233 offset:1024
    v_mfma_f32_32x32x16_bf16 v[48:63], v[76:79], v[188:191], v[48:63]
    s_waitcnt vmcnt(4) lgkmcnt(3)
    v_mfma_f32_32x32x16_bf16 v[0:15], v[80:83], v[176:179], v[0:15]
    ds_read_b64_tr_b16 v[184:185], v246 offset:6144
    ds_read_b64_tr_b16 v[186:187], v246 offset:7168
    ds_read_b64_tr_b16 v[188:189], v247 offset:6144
    ds_read_b64_tr_b16 v[190:191], v247 offset:7168
    s_mov_b32 m0, s70
    v_mfma_f32_32x32x16_bf16 v[16:31], v[84:87], v[176:179], v[16:31]
    buffer_load_dwordx4 v222, s[4:7], s42 offen sc1 lds
    buffer_load_dwordx4 v223, s[72:75], s42 offen offset:1024 sc1 lds
    v_mfma_f32_32x32x16_bf16 v[32:47], v[80:83], v[180:183], v[32:47]
    s_nop 2
    v_mul_f32 v234, v0, v96
    v_mul_f32 v236, v8, v128
    v_fmac_f32 v234, v1, v97
    v_fmac_f32 v236, v9, v129
    v_fmac_f32 v234, v2, v98
    v_fmac_f32 v236, v10, v130
    v_fmac_f32 v234, v3, v99
    v_mfma_f32_32x32x16_bf16 v[48:63], v[84:87], v[180:183], v[48:63]
    s_setprio 0
    s_waitcnt lgkmcnt(4)
    v_or_b32 v232, v232, v231
    v_or_b32 v233, v233, v231
    s_cmp_lg_u32 s34, 0
    s_cbranch_scc1 K2_dum_43
    s_cmp_eq_u32 s33, 4
    s_cbranch_scc1 K2_a4_44
K2_b4_46:
    s_add_u32 m0, s48, 512
    s_add_u32 s65, s48, 1536
    buffer_load_dwordx4 v232, s[16:19], 0 offen  lds
    s_mov_b32 m0, s65
    s_mov_b32 exec_hi, 0
    buffer_load_dwordx4 v233, s[16:19], 0 offen  lds
    s_mov_b32 exec_hi, -1
K2_back_45:
    v_fmac_f32 v236, v11, v131
    v_fmac_f32 v234, v4, v100
    v_fmac_f32 v236, v12, v132
    v_fmac_f32 v234, v5, v101
    v_fmac_f32 v236, v13, v133
    v_fmac_f32 v234, v6, v102
    v_fmac_f32 v236, v14, v134
    v_fmac_f32 v234, v7, v103
    v_fmac_f32 v236, v15, v135
    v_mul_f32 v238, v16, v128
    v_mul_f32 v240, v24, v128
    v_fmac_f32 v238, v17, v129
    v_fmac_f32 v240, v25, v129
    v_fmac_f32 v238, v18, v130
    v_fmac_f32 v240, v26, v130
    v_fmac_f32 v238, v19, v131
    v_fmac_f32 v240, v27, v131
    v_fmac_f32 v238, v20, v132
    v_fmac_f32 v240, v28, v132
    v_fmac_f32 v238, v21, v133
    v_fmac_f32 v240, v29, v133
    v_fmac_f32 v238, v22, v134
    v_fmac_f32 v240, v30, v134
    v_fmac_f32 v238, v23, v135
    v_fmac_f32 v240, v31, v135
    v_mul_f32 v235, v32, v104
    v_mul_f32 v237, v40, v136
    v_fmac_f32 v235, v33, v105
    v_fmac_f32 v237, v41, v137
    v_fmac_f32 v235, v34, v106
    v_fmac_f32 v237, v42, v138
    v_fmac_f32 v235, v35, v107
    v_fmac_f32 v237, v43, v139
    v_fmac_f32 v235, v36, v108
    v_fmac_f32 v237, v44, v140
    v_fmac_f32 v235, v37, v109
    v_fmac_f32 v237, v45, v141
    v_fmac_f32 v235, v38, v110
    v_fmac_f32 v237, v46, v142
    v_fmac_f32 v235, v39, v111
    v_fmac_f32 v237, v47, v143
    v_mul_f32 v239, v48, v136
    v_mul_f32 v241, v56, v136
    s_setprio 1
    s_waitcnt vmcnt(6) lgkmcnt(0)
    v_mfma_f32_32x32x16_bf16 v[0:15], v[64:67], v[184:187], 0
    ds_read_b64_tr_b16 v[176:177], v246 offset:0
    ds_read_b64_tr_b16 v[178:179], v246 offset:1024
    ds_read_b64_tr_b16 v[180:181], v247 offset:0
    ds_read_b64_tr_b16 v[182:183], v247 offset:1024
    v_fmac_f32 v239, v49, v137
    v_fmac_f32 v241, v57, v137
    s_mov_b32 m0, s71
    v_mfma_f32_32x32x16_bf16 v[16:31], v[68:71], v[184:187], 0
    buffer_load_dwordx4 v224, s[4:7], s42 offen sc1 lds
    buffer_load_dwordx4 v225, s[72:75], s42 offen offset:1024 sc1 lds
    v_fmac_f32 v239, v50, v138
    v_fmac_f32 v241, v58, v138
    v_fmac_f32 v239, v51, v139
    v_fmac_f32 v241, v59, v139
    v_fmac_f32 v239, v52, v140
    v_mfma_f32_32x32x16_bf16 v[32:47], v[64:67], v[188:191], 0
    v_fmac_f32 v241, v60, v140
    v_fmac_f32 v239, v53, v141
    v_fmac_f32 v241, v61, v141
    v_fmac_f32 v239, v54, v142
    v_fmac_f32 v241, v62, v142
    v_fmac_f32 v239, v55, v143
    v_fmac_f32 v241, v63, v143
    v_mfma_f32_32x32x16_bf16 v[48:63], v[68:71], v[188:191], 0
    v_permlane32_swap_b32 v234, v236
    v_permlane32_swap_b32 v235, v237
    v_permlane32_swap_b32 v240, v238
    s_waitcnt vmcnt(6) lgkmcnt(0)
    v_mfma_f32_32x32x16_bf16 v[0:15], v[72:75], v[176:179], v[0:15]
    ds_read_b64_tr_b16 v[184:185], v246 offset:2048
    ds_read_b64_tr_b16 v[186:187], v246 offset:3072
    ds_read_b64_tr_b16 v[188:189], v247 offset:2048
    ds_read_b64_tr_b16 v[190:191], v247 offset:3072
    v_permlane32_swap_b32 v241, v239
    s_mov_b32 m0, s68
    v_mfma_f32_32x32x16_bf16 v[16:31], v[76:79], v[176:179], v[16:31]
    buffer_load_dwordx4 v226, s[4:7], s42 offen sc1 lds
    buffer_load_dwordx4 v227, s[72:75], s42 offen offset:1024 sc1 lds
    v_add_f32 v234, v234, v236
    v_add_f32 v235, v235, v237
    v_add_f32 v240, v240, v238
    v_add_f32 v241, v241, v239
    v_mfma_f32_32x32x16_bf16 v[32:47], v[72:75], v[180:183], v[32:47]
    s_set_gpr_idx_on s31, gpr_idx(DST)
    s_nop 0
    v_cvt_pk_bf16_f32 v192, v234, v235
    v_cvt_pk_bf16_f32 v193, v240, v241
    s_set_gpr_idx_off
    v_mfma_f32_32x32x16_bf16 v[48:63], v[76:79], v[180:183], v[48:63]
    s_waitcnt vmcnt(6) lgkmcnt(0)
    v_mfma_f32_32x32x16_bf16 v[0:15], v[80:83], v[184:187], v[0:15]
    ds_read_b64_tr_b16 v[176:177], v246 offset:4096
    ds_read_b64_tr_b16 v[178:179], v246 offset:5120
    ds_read_b64_tr_b16 v[180:181], v247 offset:4096
    ds_read_b64_tr_b16 v[182:183], v247 offset:5120
    s_mov_b32 m0, s69
    v_mfma_f32_32x32x16_bf16 v[16:31], v[84:87], v[184:187], v[16:31]
    buffer_load_dwordx4 v222, s[4:7], s43 offen sc1 lds
    buffer_load_dwordx4 v223, s[72:75], s43 offen offset:1024 sc1 lds
    v_mfma_f32_32x32x16_bf16 v[32:47], v[80:83], v[188:191], v[32:47]
    s_nop 2
    v_mul_f32 v234, v0, v144
    v_mul_f32 v236, v8, v112
    v_fmac_f32 v234, v1, v145
    v_fmac_f32 v236, v9, v113
    v_fmac_f32 v234, v2, v146
    v_fmac_f32 v236, v10, v114
    v_fmac_f32 v234, v3, v147
    v_mfma_f32_32x32x16_bf16 v[48:63], v[84:87], v[188:191], v[48:63]
    s_setprio 0
    v_fmac_f32 v236, v11, v115
    v_fmac_f32 v234, v4, v148
    v_fmac_f32 v236, v12, v116
    v_fmac_f32 v234, v5, v149
    v_fmac_f32 v236, v13, v117
    v_fmac_f32 v234, v6, v150
    v_fmac_f32 v236, v14, v118
    v_fmac_f32 v234, v7, v151
    v_fmac_f32 v236, v15, v119
    v_mul_f32 v238, v16, v160
    v_mul_f32 v240, v24, v160
    v_fmac_f32 v238, v17, v161
    v_fmac_f32 v240, v25, v161
    v_fmac_f32 v238, v18, v162
    v_fmac_f32 v240, v26, v162
    v_fmac_f32 v238, v19, v163
    v_fmac_f32 v240, v27, v163
    v_fmac_f32 v238, v20, v164
    v_fmac_f32 v240, v28, v164
    v_fmac_f32 v238, v21, v165
    v_fmac_f32 v240, v29, v165
    v_fmac_f32 v238, v22, v166
    v_fmac_f32 v240, v30, v166
    v_fmac_f32 v238, v23, v167
    v_fmac_f32 v240, v31, v167
    v_mul_f32 v235, v32, v152
    v_mul_f32 v237, v40, v120
    v_fmac_f32 v235, v33, v153
    v_fmac_f32 v237, v41, v121
    v_fmac_f32 v235, v34, v154
    v_fmac_f32 v237, v42, v122
    v_fmac_f32 v235, v35, v155
    v_fmac_f32 v237, v43, v123
    v_fmac_f32 v235, v36, v156
    v_fmac_f32 v237, v44, v124
    v_fmac_f32 v235, v37, v157
    v_fmac_f32 v237, v45, v125
    v_fmac_f32 v235, v38, v158
    v_fmac_f32 v237, v46, v126
    v_fmac_f32 v235, v39, v159
    v_fmac_f32 v237, v47, v127
    v_mul_f32 v239, v48, v168
    v_mul_f32 v241, v56, v168
    v_fmac_f32 v239, v49, v169
    v_fmac_f32 v241, v57, v169
    s_setprio 1
    s_waitcnt vmcnt(4) lgkmcnt(0)
    v_mfma_f32_32x32x16_bf16 v[0:15], v[64:67], v[176:179], 0
    ds_read_b64_tr_b16 v[184:185], v246 offset:6144
    ds_read_b64_tr_b16 v[186:187], v246 offset:7168
    ds_read_b64_tr_b16 v[188:189], v247 offset:6144
    ds_read_b64_tr_b16 v[190:191], v247 offset:7168
    v_fmac_f32 v239, v50, v170
    v_fmac_f32 v241, v58, v170
    s_mov_b32 m0, s70
    v_mfma_f32_32x32x16_bf16 v[16:31], v[68:71], v[176:179], 0
    buffer_load_dwordx4 v224, s[4:7], s43 offen sc1 lds
    buffer_load_dwordx4 v225, s[72:75], s43 offen offset:1024 sc1 lds
    v_fmac_f32 v239, v51, v171
    v_fmac_f32 v241, v59, v171
    v_fmac_f32 v239, v52, v172
    v_fmac_f32 v241, v60, v172
    v_fmac_f32 v239, v53, v173
    v_mfma_f32_32x32x16_bf16 v[32:47], v[64:67], v[180:183], 0
    v_add_u32 v222, s48, v251
    ds_read2_b32 v[222:223], v222 offset0:1 offset1:3
    v_fmac_f32 v241, v61, v173
    v_fmac_f32 v239, v54, v174
    v_fmac_f32 v241, v62, v174
    v_fmac_f32 v239, v55, v175
    v_fmac_f32 v241, v63, v175
    v_mfma_f32_32x32x16_bf16 v[48:63], v[68:71], v[180:183], 0
    s_waitcnt vmcnt(4) lgkmcnt(1)
    v_mfma_f32_32x32x16_bf16 v[0:15], v[72:75], v[184:187], v[0:15]
    ds_read_b64_tr_b16 v[176:177], v246 offset:0
    ds_read_b64_tr_b16 v[178:179], v246 offset:1024
    ds_read_b64_tr_b16 v[180:181], v247 offset:0
    ds_read_b64_tr_b16 v[182:183], v247 offset:1024
    s_mov_b32 m0, s71
    v_mfma_f32_32x32x16_bf16 v[16:31], v[76:79], v[184:187], v[16:31]
    buffer_load_dwordx4 v226, s[4:7], s43 offen sc1 lds
    buffer_load_dwordx4 v227, s[72:75], s43 offen offset:1024 sc1 lds
    s_waitcnt lgkmcnt(4)
    v_mad_u32_u16 v222, v222, s39, v248 op_sel:[1,0,0,0]
    v_mad_u32_u16 v223, v223, s39, v248 op_sel:[1,0,0,0]
    v_mfma_f32_32x32x16_bf16 v[32:47], v[72:75], v[188:191], v[32:47]
    v_add_u32 v224, s49, v251
    ds_read2_b32 v[224:225], v224 offset0:1 offset1:3
    v_mfma_f32_32x32x16_bf16 v[48:63], v[76:79], v[188:191], v[48:63]
    s_waitcnt vmcnt(4) lgkmcnt(1)
    v_mfma_f32_32x32x16_bf16 v[0:15], v[80:83], v[176:179], v[0:15]
    ds_read_b64_tr_b16 v[184:185], v246 offset:2048
    ds_read_b64_tr_b16 v[186:187], v246 offset:3072
    ds_read_b64_tr_b16 v[188:189], v247 offset:2048
    ds_read_b64_tr_b16 v[190:191], v247 offset:3072
    s_mov_b32 m0, s68
    v_mfma_f32_32x32x16_bf16 v[16:31], v[84:87], v[176:179], v[16:31]
    buffer_load_dwordx4 v222, s[4:7], s44 offen sc1 lds
    buffer_load_dwordx4 v223, s[72:75], s44 offen offset:1024 sc1 lds
    s_waitcnt lgkmcnt(4)
    v_mad_u32_u16 v224, v224, s39, v248 op_sel:[1,0,0,0]
    v_mad_u32_u16 v225, v225, s39, v248 op_sel:[1,0,0,0]
    v_mfma_f32_32x32x16_bf16 v[32:47], v[80:83], v[180:183], v[32:47]
    v_add_u32 v226, s50, v251
    ds_read2_b32 v[226:227], v226 offset0:1 offset1:3
    v_mul_f32 v242, v0, v144
    v_fma_f32 v238, v8, v160, -v238
    v_fmac_f32 v242, v1, v145
    v_fmac_f32 v238, v9, v161
    v_fmac_f32 v242, v2, v146
    v_mfma_f32_32x32x16_bf16 v[48:63], v[84:87], v[180:183], v[48:63]
    s_setprio 0
    v_fmac_f32 v238, v10, v162
    v_fmac_f32 v242, v3, v147
    v_fmac_f32 v238, v11, v163
    v_fmac_f32 v242, v4, v148
    v_fmac_f32 v238, v12, v164
    v_fmac_f32 v242, v5, v149
    v_fmac_f32 v238, v13, v165
    v_fmac_f32 v242, v6, v150
    v_fmac_f32 v238, v14, v166
    v_fmac_f32 v242, v7, v151
    v_fmac_f32 v238, v15, v167
    v_fmac_f32 v236, v16, v112
    v_mul_f32 v244, v24, v160
    v_fmac_f32 v236, v17, v113
    v_fmac_f32 v244, v25, v161
    v_fmac_f32 v236, v18, v114
    v_fmac_f32 v244, v26, v162
    v_fmac_f32 v236, v19, v115
    v_fmac_f32 v244, v27, v163
    v_fmac_f32 v236, v20, v116
    v_fmac_f32 v244, v28, v164
    v_fmac_f32 v236, v21, v117
    v_fmac_f32 v244, v29, v165
    v_fmac_f32 v236, v22, v118
    v_fmac_f32 v244, v30, v166
    v_fmac_f32 v236, v23, v119
    v_fmac_f32 v244, v31, v167
    v_mul_f32 v243, v32, v152
    v_fma_f32 v239, v40, v168, -v239
    v_fmac_f32 v243, v33, v153
    v_fmac_f32 v239, v41, v169
    v_fmac_f32 v243, v34, v154
    v_fmac_f32 v239, v42, v170
    v_fmac_f32 v243, v35, v155
    v_fmac_f32 v239, v43, v171
    v_fmac_f32 v243, v36, v156
    v_fmac_f32 v239, v44, v172
    v_fmac_f32 v243, v37, v157
    v_fmac_f32 v239, v45, v173
    v_fmac_f32 v243, v38, v158
    v_fmac_f32 v239, v46, v174
    v_fmac_f32 v243, v39, v159
    v_fmac_f32 v239, v47, v175
    v_fmac_f32 v237, v48, v120
    v_mul_f32 v245, v56, v168
    v_fmac_f32 v237, v49, v121
    v_fmac_f32 v245, v57, v169
    v_fmac_f32 v237, v50, v122
    v_fmac_f32 v245, v58, v170
    v_fmac_f32 v237, v51, v123
    s_setprio 1
    s_waitcnt vmcnt(4) lgkmcnt(1)
    v_mfma_f32_32x32x16_bf16 v[0:15], v[64:67], v[184:187], 0
    ds_read_b64_tr_b16 v[176:177], v246 offset:4096
    ds_read_b64_tr_b16 v[178:179], v246 offset:5120
    ds_read_b64_tr_b16 v[180:181], v247 offset:4096
    ds_read_b64_tr_b16 v[182:183], v247 offset:5120
    v_fmac_f32 v245, v59, v171
    v_fmac_f32 v237, v52, v124
    s_mov_b32 m0, s69
    v_mfma_f32_32x32x16_bf16 v[16:31], v[68:71], v[184:187], 0
    buffer_load_dwordx4 v224, s[4:7], s45 offen sc1 lds
    buffer_load_dwordx4 v225, s[72:75], s45 offen offset:1024 sc1 lds
    s_waitcnt lgkmcnt(4)
    v_mad_u32_u16 v226, v226, s39, v248 op_sel:[1,0,0,0]
    v_mad_u32_u16 v227, v227, s39, v248 op_sel:[1,0,0,0]
    v_fmac_f32 v245, v60, v172
    v_fmac_f32 v237, v53, v125
    v_mfma_f32_32x32x16_bf16 v[32:47], v[64:67], v[188:191], 0
    v_add_u32 v228, s51, v251
    ds_read2_b32 v[228:229], v228 offset0:1 offset1:3
    v_fmac_f32 v245, v61, v173
    v_fmac_f32 v237, v54, v126
    v_fmac_f32 v245, v62, v174
    v_fmac_f32 v237, v55, v127
    v_fmac_f32 v245, v63, v175
    v_mfma_f32_32x32x16_bf16 v[48:63], v[68:71], v[188:191], 0
    v_permlane32_swap_b32 v242, v234
    v_permlane32_swap_b32 v243, v235
    v_add_f32 v242, v242, v234
    v_add_f32 v243, v243, v235
    s_waitcnt vmcnt(4) lgkmcnt(1)
    v_mfma_f32_32x32x16_bf16 v[0:15], v[72:75], v[176:179], v[0:15]
    ds_read_b64_tr_b16 v[184:185], v246 offset:6144
    ds_read_b64_tr_b16 v[186:187], v246 offset:7168
    ds_read_b64_tr_b16 v[188:189], v247 offset:6144
    ds_read_b64_tr_b16 v[190:191], v247 offset:7168
    s_mov_b32 m0, s70
    v_mfma_f32_32x32x16_bf16 v[16:31], v[76:79], v[176:179], v[16:31]
    buffer_load_dwordx4 v226, s[4:7], s46 offen sc1 lds
    buffer_load_dwordx4 v227, s[72:75], s46 offen offset:1024 sc1 lds
    s_waitcnt lgkmcnt(4)
    v_mad_u32_u16 v228, v228, s39, v248 op_sel:[1,0,0,0]
    v_mad_u32_u16 v229, v229, s39, v248 op_sel:[1,0,0,0]
    s_sub_u32 s26, s48, s29
    s_mov_b32 s29, s48
    v_mfma_f32_32x32x16_bf16 v[32:47], v[72:75], v[180:183], v[32:47]
    s_set_gpr_idx_on s31, gpr_idx(DST)
    s_nop 0
    v_cvt_pk_bf16_f32 v194, v242, v243
    s_set_gpr_idx_off
    s_mov_b32 s30, s3
    s_bfe_u32 s56, s3, 0x40012
    s_cmp_eq_u32 s34, 0
    s_cselect_b32 s56, s56, 0
    v_mfma_f32_32x32x16_bf16 v[48:63], v[76:79], v[180:183], v[48:63]
    s_mov_b32 s32, s31
    s_mov_b32 s31, s35
    s_waitcnt vmcnt(4) lgkmcnt(0)
    v_mfma_f32_32x32x16_bf16 v[0:15], v[80:83], v[184:187], v[0:15]
    ds_read_b64_tr_b16 v[176:177], v246 offset:0
    ds_read_b64_tr_b16 v[178:179], v246 offset:1024
    ds_read_b64_tr_b16 v[180:181], v247 offset:0
    ds_read_b64_tr_b16 v[182:183], v247 offset:1024
    s_mov_b32 m0, s71
    v_mfma_f32_32x32x16_bf16 v[16:31], v[84:87], v[184:187], v[16:31]
    buffer_load_dwordx4 v228, s[4:7], s47 offen sc1 lds
    buffer_load_dwordx4 v229, s[72:75], s47 offen offset:1024 sc1 lds
    v_mfma_f32_32x32x16_bf16 v[32:47], v[80:83], v[188:191], v[32:47]
    s_nop 2
    v_mul_f32 v242, v0, v144
    v_fma_f32 v240, v8, v160, -v240
    v_fmac_f32 v242, v1, v145
    v_fmac_f32 v240, v9, v161
    v_fmac_f32 v242, v2, v146
    v_fmac_f32 v240, v10, v162
    v_fmac_f32 v242, v3, v147
    v_mfma_f32_32x32x16_bf16 v[48:63], v[84:87], v[188:191], v[48:63]
    s_setprio 0
    v_fmac_f32 v240, v11, v163
    v_fmac_f32 v242, v4, v148
    v_fmac_f32 v240, v12, v164
    v_fmac_f32 v242, v5, v149
    v_fmac_f32 v240, v13, v165
    v_fmac_f32 v242, v6, v150
    v_fmac_f32 v240, v14, v166
    v_fmac_f32 v242, v7, v151
    v_fmac_f32 v240, v15, v167
    v_add_u32 v249, s26, v249
    v_add_u32 v250, s26, v250
    v_fma_f32 v244, v16, v160, -v244
    v_fmac_f32 v236, v24, v112
    v_fmac_f32 v244, v17, v161
    v_fmac_f32 v236, v25, v113
    v_fmac_f32 v244, v18, v162
    v_fmac_f32 v236, v26, v114
    v_fmac_f32 v244, v19, v163
    v_fmac_f32 v236, v27, v115
    v_fmac_f32 v244, v20, v164
    v_fmac_f32 v236, v28, v116
    v_fmac_f32 v244, v21, v165
    v_fmac_f32 v236, v29, v117
    v_fmac_f32 v244, v22, v166
    v_fmac_f32 v236, v30, v118
    v_fmac_f32 v244, v23, v167
    v_fmac_f32 v236, v31, v119
    ds_read_b64_tr_b16 v[0:1], v249 offset:0
    ds_read_b64_tr_b16 v[2:3], v249 offset:32
    ds_read_u16_d16_hi v16, v250 offset:0
    v_mul_f32 v243, v32, v152
    v_fma_f32 v241, v40, v168, -v241
    v_fmac_f32 v243, v33, v153
    v_fmac_f32 v241, v41, v169
    v_fmac_f32 v243, v34, v154
    v_fmac_f32 v241, v42, v170
    v_fmac_f32 v243, v35, v155
    v_fmac_f32 v241, v43, v171
    v_fmac_f32 v243, v36, v156
    v_fmac_f32 v241, v44, v172
    v_fmac_f32 v243, v37, v157
    v_fmac_f32 v241, v45, v173
    v_fmac_f32 v243, v38, v158
    v_fmac_f32 v241, v46, v174
    v_fmac_f32 v243, v39, v159
    v_fmac_f32 v241, v47, v175
    ds_read_b64_tr_b16 v[4:5], v249 offset:512
    ds_read_b64_tr_b16 v[6:7], v249 offset:544
    ds_read_u16_d16_hi v17, v250 offset:128
    v_fma_f32 v245, v48, v168, -v245
    v_fmac_f32 v237, v56, v120
    v_fmac_f32 v245, v49, v169
    v_fmac_f32 v237, v57, v121
    v_fmac_f32 v245, v50, v170
    v_fmac_f32 v237, v58, v122
    v_fmac_f32 v245, v51, v171
    v_fmac_f32 v237, v59, v123
    v_fmac_f32 v245, v52, v172
    v_fmac_f32 v237, v60, v124
    v_fmac_f32 v245, v53, v173
    v_fmac_f32 v237, v61, v125
    v_fmac_f32 v245, v54, v174
    v_fmac_f32 v237, v62, v126
    v_fmac_f32 v245, v55, v175
    v_fmac_f32 v237, v63, v127
    s_cmp_eq_u32 s56, 5
    s_cbranch_scc1 K2_U20
    s_cmp_eq_u32 s56, 6
    s_cbranch_scc1 K2_U3h0
    s_branch K2_DSP0
K2_PAD_U21:
    s_branch K2_HOP
K2_U21:
    s_setprio 1
    s_waitcnt lgkmcnt(0)
    v_lshlrev_b32 v20, 16, v0
    v_and_b32 v21, 0xffff0000, v0
    v_lshlrev_b32 v22, 16, v1
    v_and_b32 v23, 0xffff0000, v1
    v_lshlrev_b32 v24, 16, v2
    v_and_b32 v25, 0xffff0000, v2
    v_lshlrev_b32 v26, 16, v3
    v_and_b32 v27, 0xffff0000, v3
    v_mul_f32_dpp v36, v16, v20 row_newbcast:8 row_mask:0xf bank_mask:0xf
    v_mul_f32_dpp v37, v16, v21 row_newbcast:9 row_mask:0xf bank_mask:0xf
    v_mul_f32_dpp v38, v16, v22 row_newbcast:10 row_mask:0xf bank_mask:0xf
    v_mul_f32_dpp v39, v16, v23 row_newbcast:11 row_mask:0xf bank_mask:0xf
    v_mul_f32_dpp v40, v16, v24 row_newbcast:12 row_mask:0xf bank_mask:0xf
    v_mul_f32_dpp v41, v16, v25 row_newbcast:13 row_mask:0xf bank_mask:0xf
    v_mul_f32_dpp v42, v16, v26 row_newbcast:14 row_mask:0xf bank_mask:0xf
    v_mul_f32_dpp v43, v16, v27 row_newbcast:15 row_mask:0xf bank_mask:0xf
    v_cvt_pk_bf16_f32 v68, v36, v37
    v_cvt_pk_bf16_f32 v69, v38, v39
    v_cvt_pk_bf16_f32 v70, v40, v41
    v_cvt_pk_bf16_f32 v71, v42, v43
    v_mul_f32_dpp v20, v16, v20 row_newbcast:0 row_mask:0xa bank_mask:0xf
    v_mul_f32_dpp v21, v16, v21 row_newbcast:1 row_mask:0xa bank_mask:0xf
    v_mul_f32_dpp v22, v16, v22 row_newbcast:2 row_mask:0xa bank_mask:0xf
    v_mul_f32_dpp v23, v16, v23 row_newbcast:3 row_mask:0xa bank_mask:0xf
    v_mul_f32_dpp v24, v16, v24 row_newbcast:4 row_mask:0xa bank_mask:0xf
    v_mul_f32_dpp v25, v16, v25 row_newbcast:5 row_mask:0xa bank_mask:0xf
    v_mul_f32_dpp v26, v16, v26 row_newbcast:6 row_mask:0xa bank_mask:0xf
    v_mul_f32_dpp v27, v16, v27 row_newbcast:7 row_mask:0xa bank_mask:0xf
    v_cvt_pk_bf16_f32 v64, v20, v21
    v_cvt_pk_bf16_f32 v65, v22, v23
    v_cvt_pk_bf16_f32 v66, v24, v25
    v_cvt_pk_bf16_f32 v67, v26, v27
    v_lshlrev_b32 v28, 16, v4
    v_and_b32 v29, 0xffff0000, v4
    v_lshlrev_b32 v30, 16, v5
    v_and_b32 v31, 0xffff0000, v5
    v_lshlrev_b32 v32, 16, v6
    v_and_b32 v33, 0xffff0000, v6
    v_lshlrev_b32 v34, 16, v7
    v_and_b32 v35, 0xffff0000, v7
    v_mul_f32_dpp v36, v17, v28 row_newbcast:8 row_mask:0xf bank_mask:0xf
    v_mul_f32_dpp v37, v17, v29 row_newbcast:9 row_mask:0xf bank_mask:0xf
    v_mul_f32_dpp v38, v17, v30 row_newbcast:10 row_mask:0xf bank_mask:0xf
    v_mul_f32_dpp v39, v17, v31 row_newbcast:11 row_mask:0xf bank_mask:0xf
    v_mul_f32_dpp v40, v17, v32 row_newbcast:12 row_mask:0xf bank_mask:0xf
    v_mul_f32_dpp v41, v17, v33 row_newbcast:13 row_mask:0xf bank_mask:0xf
    v_mul_f32_dpp v42, v17, v34 row_newbcast:14 row_mask:0xf bank_mask:0xf
    v_mul_f32_dpp v43, v17, v35 row_newbcast:15 row_mask:0xf bank_mask:0xf
    v_cvt_pk_bf16_f32 v76, v36, v37
    v_cvt_pk_bf16_f32 v77, v38, v39
    v_cvt_pk_bf16_f32 v78, v40, v41
    v_cvt_pk_bf16_f32 v79, v42, v43
    v_mul_f32_dpp v28, v17, v28 row_newbcast:0 row_mask:0xa bank_mask:0xf
    v_mul_f32_dpp v29, v17, v29 row_newbcast:1 row_mask:0xa bank_mask:0xf
    v_mul_f32_dpp v30, v17, v30 row_newbcast:2 row_mask:0xa bank_mask:0xf
    v_mul_f32_dpp v31, v17, v31 row_newbcast:3 row_mask:0xa bank_mask:0xf
    v_mul_f32_dpp v32, v17, v32 row_newbcast:4 row_mask:0xa bank_mask:0xf
    v_mul_f32_dpp v33, v17, v33 row_newbcast:5 row_mask:0xa bank_mask:0xf
    v_mul_f32_dpp v34, v17, v34 row_newbcast:6 row_mask:0xa bank_mask:0xf
    v_mul_f32_dpp v35, v17, v35 row_newbcast:7 row_mask:0xa bank_mask:0xf
    v_cvt_pk_bf16_f32 v72, v28, v29
    v_cvt_pk_bf16_f32 v73, v30, v31
    v_cvt_pk_bf16_f32 v74, v32, v33
    v_cvt_pk_bf16_f32 v75, v34, v35
    s_waitcnt vmcnt(4)
    v_mfma_f32_32x32x16_bf16 v[0:15], v[64:67], v[176:179], 0
    ds_read_b64_tr_b16 v[184:185], v246 offset:2048
    ds_read_b64_tr_b16 v[186:187], v246 offset:3072
    ds_read_b64_tr_b16 v[188:189], v247 offset:2048
    ds_read_b64_tr_b16 v[190:191], v247 offset:3072
    s_mov_b32 m0, s68
    v_mfma_f32_32x32x16_bf16 v[16:31], v[68:71], v[176:179], 0
    buffer_load_dwordx4 v222, s[4:7], s42 offen sc1 lds
    buffer_load_dwordx4 v223, s[72:75], s42 offen offset:1024 sc1 lds
    v_permlane32_swap_b32 v242, v236
    v_permlane32_swap_b32 v243, v237
    v_mov_b32 v254, 163296
    v_mfma_f32_32x32x16_bf16 v[32:47], v[64:67], v[180:183], 0
    v_permlane32_swap_b32 v244, v238
    v_permlane32_swap_b32 v245, v239
    v_permlane32_swap_b32 v240, v241
    v_add_f32 v242, v242, v236
    v_mfma_f32_32x32x16_bf16 v[48:63], v[68:71], v[180:183], 0
    v_add_f32 v243, v243, v237
    v_add_f32 v244, v244, v238
    v_add_f32 v245, v245, v239
    v_add_f32 v240, -v240, -v241
    v_sub_u32 v241, v230, v231
    v_cvt_pk_bf16_f32 v242, v242, v243
    v_mov_b32 v255, 1
    v_lshl_add_u32 v233, v252, 1, s53
    s_mov_b64 exec, 1
    ds_add_rtn_u32 v232, v254, v255
    s_mov_b64 exec, -1
    ds_read_b32 v233, v233
    s_waitcnt vmcnt(4) lgkmcnt(2)
    v_mfma_f32_32x32x16_bf16 v[0:15], v[72:75], v[184:187], v[0:15]
    ds_read_b64_tr_b16 v[176:177], v246 offset:4096
    ds_read_b64_tr_b16 v[178:179], v246 offset:5120
    ds_read_b64_tr_b16 v[180:181], v247 offset:4096
    ds_read_b64_tr_b16 v[182:183], v247 offset:5120
    v_cvt_pk_bf16_f32 v244, v244, v245
    v_cvt_pk_bf16_f32 v240, v240, v240
    s_mov_b32 m0, s69
    v_mfma_f32_32x32x16_bf16 v[16:31], v[76:79], v[184:187], v[16:31]
    buffer_load_dwordx4 v224, s[4:7], s42 offen sc1 lds
    buffer_load_dwordx4 v225, s[72:75], s42 offen offset:1024 sc1 lds
    ds_write_b32 v230, v242 offset:768
    ds_write_b32 v230, v244 offset:1024
    ds_write_b16 v241, v240 offset:1280
    s_waitcnt lgkmcnt(7)
    v_readfirstlane_b32 s58, v232
    v_mfma_f32_32x32x16_bf16 v[32:47], v[72:75], v[188:191], v[32:47]
    s_cmp_lt_u32 s58, s22
    s_cbranch_scc0 K2_nul_47
    s_and_b32 s59, s58, 7
    s_lshr_b32 s60, s58, 3
K2_chk_49:
    v_readlane_b32 s61, v233, s59
    s_nop 0
    s_cmp_gt_u32 s61, s60
    s_cbranch_scc0 K2_spin_48
K2_back_50:
    v_mfma_f32_32x32x16_bf16 v[48:63], v[76:79], v[188:191], v[48:63]
    s_setprio 0
    v_readlane_b32 s3, v253, s58
    s_lshl_b32 s44, s34, 7
    s_and_b32 s48, s3, 0x3ffff
    s_bfe_u32 s33, s3, 0x30013
    s_mov_b32 s35, s48
    s_mov_b32 s45, s44
    v_mul_f32 v234, v0, v96
    v_mul_f32 v236, v8, v128
    v_fmac_f32 v234, v1, v97
    v_fmac_f32 v236, v9, v129
    v_fmac_f32 v234, v2, v98
    v_fmac_f32 v236, v10, v130
    v_fmac_f32 v234, v3, v99
    v_fmac_f32 v236, v11, v131
    v_fmac_f32 v234, v4, v100
    v_fmac_f32 v236, v12, v132
    v_fmac_f32 v234, v5, v101
    v_fmac_f32 v236, v13, v133
    v_fmac_f32 v234, v6, v102
    v_fmac_f32 v236, v14, v134
    v_fmac_f32 v234, v7, v103
    v_fmac_f32 v236, v15, v135
    v_mul_f32 v238, v16, v128
    v_mul_f32 v240, v24, v128
    v_fmac_f32 v238, v17, v129
    v_fmac_f32 v240, v25, v129
    v_fmac_f32 v238, v18, v130
    v_fmac_f32 v240, v26, v130
    v_fmac_f32 v238, v19, v131
    v_fmac_f32 v240, v27, v131
    v_fmac_f32 v238, v20, v132
    v_fmac_f32 v240, v28, v132
    v_fmac_f32 v238, v21, v133
    v_fmac_f32 v240, v29, v133
    v_fmac_f32 v238, v22, v134
    v_fmac_f32 v240, v30, v134
    v_fmac_f32 v238, v23, v135
    v_fmac_f32 v240, v31, v135
    v_mul_f32 v235, v32, v104
    v_mul_f32 v237, v40, v136
    v_fmac_f32 v235, v33, v105
    v_fmac_f32 v237, v41, v137
    v_fmac_f32 v235, v34, v106
    v_fmac_f32 v237, v42, v138
    v_fmac_f32 v235, v35, v107
    v_fmac_f32 v237, v43, v139
    v_fmac_f32 v235, v36, v108
    v_fmac_f32 v237, v44, v140
    v_fmac_f32 v235, v37, v109
    v_fmac_f32 v237, v45, v141
    v_fmac_f32 v235, v38, v110
    v_fmac_f32 v237, v46, v142
    v_fmac_f32 v235, v39, v111
    v_fmac_f32 v237, v47, v143
    v_mul_f32 v239, v48, v136
    v_mul_f32 v241, v56, v136
    v_fmac_f32 v239, v49, v137
    v_fmac_f32 v241, v57, v137
    s_setprio 1
    s_waitcnt vmcnt(4) lgkmcnt(3)
    v_mfma_f32_32x32x16_bf16 v[0:15], v[64:67], v[176:179], 0
    ds_read_b64_tr_b16 v[184:185], v246 offset:6144
    ds_read_b64_tr_b16 v[186:187], v246 offset:7168
    ds_read_b64_tr_b16 v[188:189], v247 offset:6144
    ds_read_b64_tr_b16 v[190:191], v247 offset:7168
    v_fmac_f32 v239, v50, v138
    v_fmac_f32 v241, v58, v138
    s_mov_b32 m0, s70
    v_mfma_f32_32x32x16_bf16 v[16:31], v[68:71], v[176:179], 0
    buffer_load_dwordx4 v222, s[4:7], s43 offen sc1 lds
    buffer_load_dwordx4 v223, s[72:75], s43 offen offset:1024 sc1 lds
    v_fmac_f32 v239, v51, v139
    v_fmac_f32 v241, v59, v139
    v_fmac_f32 v239, v52, v140
    v_fmac_f32 v241, v60, v140
    v_fmac_f32 v239, v53, v141
    v_mfma_f32_32x32x16_bf16 v[32:47], v[64:67], v[180:183], 0
    s_xor_b32 s47, s44, 256
    s_add_u32 s49, s48, 128
    s_add_u32 s60, s48, 256
    s_cmp_eq_u32 s33, 3
    s_cselect_b32 s46, s44, s47
    s_cselect_b32 s50, s60, s48
    s_cselect_b32 s51, s48, s49
    s_sub_u32 s60, s33, 2
    s_cmp_lt_u32 s60, 2
    s_cbranch_scc0 K2_rare_51
K2_back_52:
    v_add_u32 v222, s48, v251
    ds_read2_b32 v[222:223], v222 offset0:1 offset1:3
    v_fmac_f32 v241, v61, v141
    v_fmac_f32 v239, v54, v142
    v_fmac_f32 v241, v62, v142
    v_fmac_f32 v239, v55, v143
    v_fmac_f32 v241, v63, v143
    v_mfma_f32_32x32x16_bf16 v[48:63], v[68:71], v[180:183], 0
    v_permlane32_swap_b32 v234, v236
    v_permlane32_swap_b32 v235, v237
    v_permlane32_swap_b32 v240, v238
    s_waitcnt vmcnt(4) lgkmcnt(1)
    v_mfma_f32_32x32x16_bf16 v[0:15], v[72:75], v[184:187], v[0:15]
    ds_read_b64_tr_b16 v[176:177], v246 offset:0
    ds_read_b64_tr_b16 v[178:179], v246 offset:1024
    ds_read_b64_tr_b16 v[180:181], v247 offset:0
    ds_read_b64_tr_b16 v[182:183], v247 offset:1024
    v_permlane32_swap_b32 v241, v239
    s_mov_b32 m0, s71
    v_mfma_f32_32x32x16_bf16 v[16:31], v[76:79], v[184:187], v[16:31]
    buffer_load_dwordx4 v224, s[4:7], s43 offen sc1 lds
    buffer_load_dwordx4 v225, s[72:75], s43 offen offset:1024 sc1 lds
    s_waitcnt lgkmcnt(4)
    v_mad_u32_u16 v222, v222, s39, v248 op_sel:[1,0,0,0]
    v_mad_u32_u16 v223, v223, s39, v248 op_sel:[1,0,0,0]
    v_lshl_add_u32 v230, v252, 1, s31
    v_add_f32 v234, v234, v236
    v_add_f32 v235, v235, v237
    v_add_f32 v240, v240, v238
    v_add_f32 v241, v241, v239
    v_cvt_pk_bf16_f32 v234, v234, v235
    v_cvt_pk_bf16_f32 v240, v240, v241
    ds_write_b32 v230, v234 offset:0
    ds_write_b32 v230, v240 offset:256
    v_mfma_f32_32x32x16_bf16 v[32:47], v[72:75], v[188:191], v[32:47]
    v_add_u32 v224, s49, v251
    ds_read2_b32 v[224:225], v224 offset0:1 offset1:3
    v_mul_f32 v234, v0, v144
    v_mul_f32 v236, v8, v112
    v_fmac_f32 v234, v1, v145
    v_fmac_f32 v236, v9, v113
    v_fmac_f32 v234, v2, v146
    v_mfma_f32_32x32x16_bf16 v[48:63], v[76:79], v[188:191], v[48:63]
    s_setprio 0
    v_fmac_f32 v236, v10, v114
    v_fmac_f32 v234, v3, v147
    v_fmac_f32 v236, v11, v115
    v_fmac_f32 v234, v4, v148
    v_fmac_f32 v236, v12, v116
    v_fmac_f32 v234, v5, v149
    v_fmac_f32 v236, v13, v117
    v_fmac_f32 v234, v6, v150
    v_fmac_f32 v236, v14, v118
    v_fmac_f32 v234, v7, v151
    v_fmac_f32 v236, v15, v119
    v_mul_f32 v238, v16, v160
    v_mul_f32 v240, v24, v160
    v_fmac_f32 v238, v17, v161
    v_fmac_f32 v240, v25, v161
    v_fmac_f32 v238, v18, v162
    v_fmac_f32 v240, v26, v162
    v_fmac_f32 v238, v19, v163
    v_fmac_f32 v240, v27, v163
    v_fmac_f32 v238, v20, v164
    v_fmac_f32 v240, v28, v164
    v_fmac_f32 v238, v21, v165
    v_fmac_f32 v240, v29, v165
    v_fmac_f32 v238, v22, v166
    v_fmac_f32 v240, v30, v166
    v_fmac_f32 v238, v23, v167
    v_fmac_f32 v240, v31, v167
    v_mul_f32 v235, v32, v152
    v_mul_f32 v237, v40, v120
    v_fmac_f32 v235, v33, v153
    v_fmac_f32 v237, v41, v121
    v_fmac_f32 v235, v34, v154
    v_fmac_f32 v237, v42, v122
    v_fmac_f32 v235, v35, v155
    v_fmac_f32 v237, v43, v123
    v_fmac_f32 v235, v36, v156
    v_fmac_f32 v237, v44, v124
    v_fmac_f32 v235, v37, v157
    v_fmac_f32 v237, v45, v125
    v_fmac_f32 v235, v38, v158
    v_fmac_f32 v237, v46, v126
    v_fmac_f32 v235, v39, v159
    v_fmac_f32 v237, v47, v127
    v_mul_f32 v239, v48, v168
    v_mul_f32 v241, v56, v168
    v_fmac_f32 v239, v49, v169
    v_fmac_f32 v241, v57, v169
    v_fmac_f32 v239, v50, v170
    v_fmac_f32 v241, v58, v170
    v_fmac_f32 v239, v51, v171
    s_setprio 1
    s_waitcnt vmcnt(4) lgkmcnt(3)
    v_mfma_f32_32x32x16_bf16 v[0:15], v[64:67], v[176:179], 0
    ds_read_b64_tr_b16 v[184:185], v246 offset:2048
    ds_read_b64_tr_b16 v[186:187], v246 offset:3072
    ds_read_b64_tr_b16 v[188:189], v247 offset:2048
    ds_read_b64_tr_b16 v[190:191], v247 offset:3072
    v_fmac_f32 v241, v59, v171
    v_fmac_f32 v239, v52, v172
    s_mov_b32 m0, s68
    v_mfma_f32_32x32x16_bf16 v[16:31], v[68:71], v[176:179], 0
    buffer_load_dwordx4 v222, s[4:7], s44 offen sc1 lds
    buffer_load_dwordx4 v223, s[72:75], s44 offen offset:1024 sc1 lds
    s_waitcnt lgkmcnt(4)
    v_mad_u32_u16 v224, v224, s39, v248 op_sel:[1,0,0,0]
    v_mad_u32_u16 v225, v225, s39, v248 op_sel:[1,0,0,0]
    v_fmac_f32 v241, v60, v172
    v_fmac_f32 v239, v53, v173
    v_mfma_f32_32x32x16_bf16 v[32:47], v[64:67], v[180:183], 0
    v_add_u32 v226, s50, v251
    ds_read2_b32 v[226:227], v226 offset0:1 offset1:3
    v_fmac_f32 v241, v61, v173
    v_fmac_f32 v239, v54, v174
    v_fmac_f32 v241, v62, v174
    v_fmac_f32 v239, v55, v175
    v_fmac_f32 v241, v63, v175
    v_mfma_f32_32x32x16_bf16 v[48:63], v[68:71], v[180:183], 0
    s_waitcnt vmcnt(4) lgkmcnt(1)
    v_mfma_f32_32x32x16_bf16 v[0:15], v[72:75], v[184:187], v[0:15]
    ds_read_b64_tr_b16 v[176:177], v246 offset:4096
    ds_read_b64_tr_b16 v[178:179], v246 offset:5120
    ds_read_b64_tr_b16 v[180:181], v247 offset:4096
    ds_read_b64_tr_b16 v[182:183], v247 offset:5120
    s_mov_b32 m0, s69
    v_mfma_f32_32x32x16_bf16 v[16:31], v[76:79], v[184:187], v[16:31]
    buffer_load_dwordx4 v224, s[4:7], s45 offen sc1 lds
    buffer_load_dwordx4 v225, s[72:75], s45 offen offset:1024 sc1 lds
    s_waitcnt lgkmcnt(4)
    v_mad_u32_u16 v226, v226, s39, v248 op_sel:[1,0,0,0]
    v_mad_u32_u16 v227, v227, s39, v248 op_sel:[1,0,0,0]
    v_mfma_f32_32x32x16_bf16 v[32:47], v[72:75], v[188:191], v[32:47]
    v_add_u32 v228, s51, v251
    ds_read2_b32 v[228:229], v228 offset0:1 offset1:3
    v_mul_f32 v242, v0, v144
    v_fma_f32 v238, v8, v160, -v238
    v_fmac_f32 v242, v1, v145
    v_fmac_f32 v238, v9, v161
    v_fmac_f32 v242, v2, v146
    v_mfma_f32_32x32x16_bf16 v[48:63], v[76:79], v[188:191], v[48:63]
    s_setprio 0
    v_fmac_f32 v238, v10, v162
    v_fmac_f32 v242, v3, v147
    v_fmac_f32 v238, v11, v163
    v_fmac_f32 v242, v4, v148
    v_fmac_f32 v238, v12, v164
    v_fmac_f32 v242, v5, v149
    v_fmac_f32 v238, v13, v165
    v_fmac_f32 v242, v6, v150
    v_fmac_f32 v238, v14, v166
    v_fmac_f32 v242, v7, v151
    v_fmac_f32 v238, v15, v167
    v_fmac_f32 v236, v16, v112
    v_mul_f32 v244, v24, v160
    v_fmac_f32 v236, v17, v113
    v_fmac_f32 v244, v25, v161
    v_fmac_f32 v236, v18, v114
    v_fmac_f32 v244, v26, v162
    v_fmac_f32 v236, v19, v115
    v_fmac_f32 v244, v27, v163
    v_fmac_f32 v236, v20, v116
    v_fmac_f32 v244, v28, v164
    v_fmac_f32 v236, v21, v117
    v_fmac_f32 v244, v29, v165
    v_fmac_f32 v236, v22, v118
    v_fmac_f32 v244, v30, v166
    v_fmac_f32 v236, v23, v119
    v_fmac_f32 v244, v31, v167
    v_mul_f32 v243, v32, v152
    v_fma_f32 v239, v40, v168, -v239
    v_fmac_f32 v243, v33, v153
    v_fmac_f32 v239, v41, v169
    v_fmac_f32 v243, v34, v154
    v_fmac_f32 v239, v42, v170
    v_fmac_f32 v243, v35, v155
    v_fmac_f32 v239, v43, v171
    v_fmac_f32 v243, v36, v156
    v_fmac_f32 v239, v44, v172
    v_fmac_f32 v243, v37, v157
    v_fmac_f32 v239, v45, v173
    v_fmac_f32 v243, v38, v158
    v_fmac_f32 v239, v46, v174
    v_fmac_f32 v243, v39, v159
    v_fmac_f32 v239, v47, v175
    v_fmac_f32 v237, v48, v120
    v_mul_f32 v245, v56, v168
    v_fmac_f32 v237, v49, v121
    v_fmac_f32 v245, v57, v169
    v_fmac_f32 v237, v50, v122
    s_setprio 1
    s_waitcnt vmcnt(4) lgkmcnt(1)
    v_mfma_f32_32x32x16_bf16 v[0:15], v[64:67], v[176:179], 0
    ds_read_b64_tr_b16 v[184:185], v246 offset:6144
    ds_read_b64_tr_b16 v[186:187], v246 offset:7168
    ds_read_b64_tr_b16 v[188:189], v247 offset:6144
    ds_read_b64_tr_b16 v[190:191], v247 offset:7168
    v_fmac_f32 v245, v58, v170
    v_fmac_f32 v237, v51, v123
    s_mov_b32 m0, s70
    v_mfma_f32_32x32x16_bf16 v[16:31], v[68:71], v[176:179], 0
    buffer_load_dwordx4 v226, s[4:7], s46 offen sc1 lds
    buffer_load_dwordx4 v227, s[72:75], s46 offen offset:1024 sc1 lds
    s_waitcnt lgkmcnt(4)
    v_mad_u32_u16 v228, v228, s39, v248 op_sel:[1,0,0,0]
    v_mad_u32_u16 v229, v229, s39, v248 op_sel:[1,0,0,0]
    v_fmac_f32 v245, v59, v171
    v_fmac_f32 v237, v52, v124
    v_mfma_f32_32x32x16_bf16 v[32:47], v[64:67], v[180:183], 0
    v_fmac_f32 v245, v60, v172
    v_fmac_f32 v237, v53, v125
    v_fmac_f32 v245, v61, v173
    v_fmac_f32 v237, v54, v126
    v_fmac_f32 v245, v62, v174
    v_fmac_f32 v237, v55, v127
    v_fmac_f32 v245, v63, v175
    v_mfma_f32_32x32x16_bf16 v[48:63], v[68:71], v[180:183], 0
    v_permlane32_swap_b32 v242, v234
    v_permlane32_swap_b32 v243, v235
    v_add_f32 v242, v242, v234
    v_add_f32 v243, v243, v235
    s_waitcnt vmcnt(4) lgkmcnt(0)
    v_mfma_f32_32x32x16_bf16 v[0:15], v[72:75], v[184:187], v[0:15]
    ds_read_b64_tr_b16 v[176:177], v246 offset:0
    ds_read_b64_tr_b16 v[178:179], v246 offset:1024
    ds_read_b64_tr_b16 v[180:181], v247 offset:0
    ds_read_b64_tr_b16 v[182:183], v247 offset:1024
    v_cvt_pk_bf16_f32 v242, v242, v243
    ds_write_b32 v230, v242 offset:512
    s_mov_b32 m0, s71
    v_mfma_f32_32x32x16_bf16 v[16:31], v[76:79], v[184:187], v[16:31]
    buffer_load_dwordx4 v228, s[4:7], s47 offen sc1 lds
    buffer_load_dwordx4 v229, s[72:75], s47 offen offset:1024 sc1 lds
    s_sub_u32 s26, s48, s29
    s_mov_b32 s29, s48
    s_mov_b32 s30, s3
    s_bfe_u32 s56, s3, 0x40012
    s_cmp_lg_u32 s36, 0
    s_cselect_b32 s56, s56, 0
    v_mfma_f32_32x32x16_bf16 v[32:47], v[72:75], v[188:191], v[32:47]
    s_mov_b32 s32, s31
    s_mov_b32 s31, s35
    v_mul_f32 v242, v0, v144
    v_fma_f32 v240, v8, v160, -v240
    v_fmac_f32 v242, v1, v145
    v_fmac_f32 v240, v9, v161
    v_fmac_f32 v242, v2, v146
    v_mfma_f32_32x32x16_bf16 v[48:63], v[76:79], v[188:191], v[48:63]
    s_setprio 0
    v_fmac_f32 v240, v10, v162
    v_fmac_f32 v242, v3, v147
    v_fmac_f32 v240, v11, v163
    v_fmac_f32 v242, v4, v148
    v_fmac_f32 v240, v12, v164
    v_fmac_f32 v242, v5, v149
    v_fmac_f32 v240, v13, v165
    v_fmac_f32 v242, v6, v150
    v_fmac_f32 v240, v14, v166
    v_fmac_f32 v242, v7, v151
    v_fmac_f32 v240, v15, v167
    v_add_u32 v249, s26, v249
    v_add_u32 v250, s26, v250
    v_fma_f32 v244, v16, v160, -v244
    v_fmac_f32 v236, v24, v112
    v_fmac_f32 v244, v17, v161
    v_fmac_f32 v236, v25, v113
    v_fmac_f32 v244, v18, v162
    v_fmac_f32 v236, v26, v114
    v_fmac_f32 v244, v19, v163
    v_fmac_f32 v236, v27, v115
    v_fmac_f32 v244, v20, v164
    v_fmac_f32 v236, v28, v116
    v_fmac_f32 v244, v21, v165
    v_fmac_f32 v236, v29, v117
    v_fmac_f32 v244, v22, v166
    v_fmac_f32 v236, v30, v118
    v_fmac_f32 v244, v23, v167
    v_fmac_f32 v236, v31, v119
    ds_read_b64_tr_b16 v[0:1], v249 offset:0
    ds_read_b64_tr_b16 v[2:3], v249 offset:32
    ds_read_u16_d16_hi v16, v250 offset:0
    v_mul_f32 v243, v32, v152
    v_fma_f32 v241, v40, v168, -v241
    v_fmac_f32 v243, v33, v153
    v_fmac_f32 v241, v41, v169
    v_fmac_f32 v243, v34, v154
    v_fmac_f32 v241, v42, v170
    v_fmac_f32 v243, v35, v155
    v_fmac_f32 v241, v43, v171
    v_fmac_f32 v243, v36, v156
    v_fmac_f32 v241, v44, v172
    v_fmac_f32 v243, v37, v157
    v_fmac_f32 v241, v45, v173
    v_fmac_f32 v243, v38, v158
    v_fmac_f32 v241, v46, v174
    v_fmac_f32 v243, v39, v159
    v_fmac_f32 v241, v47, v175
    ds_read_b64_tr_b16 v[4:5], v249 offset:512
    ds_read_b64_tr_b16 v[6:7], v249 offset:544
    ds_read_u16_d16_hi v17, v250 offset:128
    v_fma_f32 v245, v48, v168, -v245
    v_fmac_f32 v237, v56, v120
    v_fmac_f32 v245, v49, v169
    v_fmac_f32 v237, v57, v121
    v_fmac_f32 v245, v50, v170
    v_fmac_f32 v237, v58, v122
    v_fmac_f32 v245, v51, v171
    v_fmac_f32 v237, v59, v123
    v_fmac_f32 v245, v52, v172
    v_fmac_f32 v237, v60, v124
    v_fmac_f32 v245, v53, v173
    v_fmac_f32 v237, v61, v125
    v_fmac_f32 v245, v54, v174
    v_fmac_f32 v237, v62, v126
    v_fmac_f32 v245, v55, v175
    v_fmac_f32 v237, v63, v127
    s_cmp_eq_u32 s56, 5
    s_cbranch_scc1 K2_U21
    s_cmp_eq_u32 s56, 6
    s_cbranch_scc1 K2_U3h1
    s_branch K2_DSP1
K2_PAD_U31:
    s_branch K2_HOP
K2_U3h1:
    s_setprio 1
    ds_read_b64_tr_b16 v[8:9], v249 offset:1024
    ds_read_u16_d16_hi v18, v250 offset:256
    s_waitcnt lgkmcnt(2)
    v_lshlrev_b32 v20, 16, v0
    v_and_b32 v21, 0xffff0000, v0
    v_lshlrev_b32 v22, 16, v1
    v_and_b32 v23, 0xffff0000, v1
    v_lshlrev_b32 v24, 16, v2
    v_and_b32 v25, 0xffff0000, v2
    v_lshlrev_b32 v26, 16, v3
    v_and_b32 v27, 0xffff0000, v3
    v_mul_f32_dpp v36, v16, v20 row_newbcast:8 row_mask:0xf bank_mask:0xf
    v_mul_f32_dpp v37, v16, v21 row_newbcast:9 row_mask:0xf bank_mask:0xf
    v_mul_f32_dpp v38, v16, v22 row_newbcast:10 row_mask:0xf bank_mask:0xf
    v_mul_f32_dpp v39, v16, v23 row_newbcast:11 row_mask:0xf bank_mask:0xf
    v_mul_f32_dpp v40, v16, v24 row_newbcast:12 row_mask:0xf bank_mask:0xf
    v_mul_f32_dpp v41, v16, v25 row_newbcast:13 row_mask:0xf bank_mask:0xf
    v_mul_f32_dpp v42, v16, v26 row_newbcast:14 row_mask:0xf bank_mask:0xf
    v_mul_f32_dpp v43, v16, v27 row_newbcast:15 row_mask:0xf bank_mask:0xf
    v_cvt_pk_bf16_f32 v68, v36, v37
    v_cvt_pk_bf16_f32 v69, v38, v39
    v_cvt_pk_bf16_f32 v70, v40, v41
    v_cvt_pk_bf16_f32 v71, v42, v43
    v_mul_f32_dpp v20, v16, v20 row_newbcast:0 row_mask:0xa bank_mask:0xf
    v_mul_f32_dpp v21, v16, v21 row_newbcast:1 row_mask:0xa bank_mask:0xf
    v_mul_f32_dpp v22, v16, v22 row_newbcast:2 row_mask:0xa bank_mask:0xf
    v_mul_f32_dpp v23, v16, v23 row_newbcast:3 row_mask:0xa bank_mask:0xf
    v_mul_f32_dpp v24, v16, v24 row_newbcast:4 row_mask:0xa bank_mask:0xf
    v_mul_f32_dpp v25, v16, v25 row_newbcast:5 row_mask:0xa bank_mask:0xf
    v_mul_f32_dpp v26, v16, v26 row_newbcast:6 row_mask:0xa bank_mask:0xf
    v_mul_f32_dpp v27, v16, v27 row_newbcast:7 row_mask:0xa bank_mask:0xf
    v_cvt_pk_bf16_f32 v64, v20, v21
    v_cvt_pk_bf16_f32 v65, v22, v23
    v_cvt_pk_bf16_f32 v66, v24, v25
    v_cvt_pk_bf16_f32 v67, v26, v27
    v_lshlrev_b32 v28, 16, v4
    v_and_b32 v29, 0xffff0000, v4
    v_lshlrev_b32 v30, 16, v5
    v_and_b32 v31, 0xffff0000, v5
    v_lshlrev_b32 v32, 16, v6
    v_and_b32 v33, 0xffff0000, v6
    v_lshlrev_b32 v34, 16, v7
    v_and_b32 v35, 0xffff0000, v7
    v_mul_f32_dpp v36, v17, v28 row_newbcast:8 row_mask:0xf bank_mask:0xf
    v_mul_f32_dpp v37, v17, v29 row_newbcast:9 row_mask:0xf bank_mask:0xf
    v_mul_f32_dpp v38, v17, v30 row_newbcast:10 row_mask:0xf bank_mask:0xf
    v_mul_f32_dpp v39, v17, v31 row_newbcast:11 row_mask:0xf bank_mask:0xf
    v_mul_f32_dpp v40, v17, v32 row_newbcast:12 row_mask:0xf bank_mask:0xf
    v_mul_f32_dpp v41, v17, v33 row_newbcast:13 row_mask:0xf bank_mask:0xf
    v_mul_f32_dpp v42, v17, v34 row_newbcast:14 row_mask:0xf bank_mask:0xf
    v_mul_f32_dpp v43, v17, v35 row_newbcast:15 row_mask:0xf bank_mask:0xf
    v_cvt_pk_bf16_f32 v76, v36, v37
    v_cvt_pk_bf16_f32 v77, v38, v39
    v_cvt_pk_bf16_f32 v78, v40, v41
    v_cvt_pk_bf16_f32 v79, v42, v43
    v_mul_f32_dpp v28, v17, v28 row_newbcast:0 row_mask:0xa bank_mask:0xf
    v_mul_f32_dpp v29, v17, v29 row_newbcast:1 row_mask:0xa bank_mask:0xf
    v_mul_f32_dpp v30, v17, v30 row_newbcast:2 row_mask:0xa bank_mask:0xf
    v_mul_f32_dpp v31, v17, v31 row_newbcast:3 row_mask:0xa bank_mask:0xf
    v_mul_f32_dpp v32, v17, v32 row_newbcast:4 row_mask:0xa bank_mask:0xf
    v_mul_f32_dpp v33, v17, v33 row_newbcast:5 row_mask:0xa bank_mask:0xf
    v_mul_f32_dpp v34, v17, v34 row_newbcast:6 row_mask:0xa bank_mask:0xf
    v_mul_f32_dpp v35, v17, v35 row_newbcast:7 row_mask:0xa bank_mask:0xf
    v_cvt_pk_bf16_f32 v72, v28, v29
    v_cvt_pk_bf16_f32 v73, v30, v31
    v_cvt_pk_bf16_f32 v74, v32, v33
    v_cvt_pk_bf16_f32 v75, v34, v35
    s_waitcnt lgkmcnt(0)
    v_lshlrev_b32 v20, 16, v8
    v_and_b32 v21, 0xffff0000, v8
    v_lshlrev_b32 v22, 16, v9
    v_and_b32 v23, 0xffff0000, v9
    v_mul_f32_dpp v36, v18, v20 row_newbcast:8 row_mask:0xf bank_mask:0xf
    v_mul_f32_dpp v37, v18, v21 row_newbcast:9 row_mask:0xf bank_mask:0xf
    v_mul_f32_dpp v38, v18, v22 row_newbcast:10 row_mask:0xf bank_mask:0xf
    v_mul_f32_dpp v39, v18, v23 row_newbcast:11 row_mask:0xf bank_mask:0xf
    v_cvt_pk_bf16_f32 v84, v36, v37
    v_cvt_pk_bf16_f32 v85, v38, v39
    v_mul_f32_dpp v20, v18, v20 row_newbcast:0 row_mask:0xa bank_mask:0xf
    v_mul_f32_dpp v21, v18, v21 row_newbcast:1 row_mask:0xa bank_mask:0xf
    v_mul_f32_dpp v22, v18, v22 row_newbcast:2 row_mask:0xa bank_mask:0xf
    v_mul_f32_dpp v23, v18, v23 row_newbcast:3 row_mask:0xa bank_mask:0xf
    v_cvt_pk_bf16_f32 v80, v20, v21
    v_cvt_pk_bf16_f32 v81, v22, v23
    s_waitcnt vmcnt(4)
    v_mfma_f32_32x32x16_bf16 v[0:15], v[64:67], v[176:179], 0
    ds_read_b64_tr_b16 v[184:185], v246 offset:2048
    ds_read_b64_tr_b16 v[186:187], v246 offset:3072
    ds_read_b64_tr_b16 v[188:189], v247 offset:2048
    ds_read_b64_tr_b16 v[190:191], v247 offset:3072
    s_mov_b32 m0, s68
    v_mfma_f32_32x32x16_bf16 v[16:31], v[68:71], v[176:179], 0
    buffer_load_dwordx4 v224, s[4:7], s41 offen sc1 lds
    buffer_load_dwordx4 v225, s[72:75], s41 offen offset:1024 sc1 lds
    v_permlane32_swap_b32 v242, v236
    v_permlane32_swap_b32 v243, v237
    v_mov_b32 v254, 163296
    v_mfma_f32_32x32x16_bf16 v[32:47], v[64:67], v[180:183], 0
    v_permlane32_swap_b32 v244, v238
    v_permlane32_swap_b32 v245, v239
    v_permlane32_swap_b32 v240, v241
    v_add_f32 v242, v242, v236
    v_mfma_f32_32x32x16_bf16 v[48:63], v[68:71], v[180:183], 0
    v_add_f32 v243, v243, v237
    v_add_f32 v244, v244, v238
    v_add_f32 v245, v245, v239
    v_add_f32 v240, -v240, -v241
    v_sub_u32 v241, v230, v231
    v_cvt_pk_bf16_f32 v242, v242, v243
    v_mov_b32 v255, 1
    v_lshl_add_u32 v233, v252, 1, s53
    s_mov_b64 exec, 1
    ds_add_rtn_u32 v232, v254, v255
    s_mov_b64 exec, -1
    ds_read_b32 v233, v233
    s_waitcnt vmcnt(4) lgkmcnt(2)
    v_mfma_f32_32x32x16_bf16 v[0:15], v[72:75], v[184:187], v[0:15]
    ds_read_b64_tr_b16 v[176:177], v246 offset:4096
    ds_read_b64_tr_b16 v[180:181], v247 offset:4096
    v_cvt_pk_bf16_f32 v244, v244, v245
    v_cvt_pk_bf16_f32 v240, v240, v240
    ds_write_b32 v230, v242 offset:768
    ds_write_b32 v230, v244 offset:1024
    s_mov_b32 m0, s69
    v_mfma_f32_32x32x16_bf16 v[16:31], v[76:79], v[184:187], v[16:31]
    buffer_load_dwordx4 v226, s[4:7], s41 offen sc1 lds
    ds_write_b16 v241, v240 offset:1280
    s_waitcnt lgkmcnt(5)
    v_readfirstlane_b32 s58, v232
    v_mfma_f32_32x32x16_bf16 v[32:47], v[72:75], v[188:191], v[32:47]
    s_cmp_lt_u32 s58, s22
    s_cbranch_scc0 K2_nul_54
    s_and_b32 s59, s58, 7
    s_lshr_b32 s60, s58, 3
K2_chk_56:
    v_readlane_b32 s61, v233, s59
    s_nop 0
    s_cmp_gt_u32 s61, s60
    s_cbranch_scc0 K2_spin_55
K2_back_57:
    v_mfma_f32_32x32x16_bf16 v[48:63], v[76:79], v[188:191], v[48:63]
    v_readlane_b32 s3, v253, s58
    s_lshl_b32 s44, s34, 7
    s_and_b32 s48, s3, 0x3ffff
    s_bfe_u32 s33, s3, 0x30013
    s_mov_b32 s35, s48
    s_mov_b32 s45, s44
    s_waitcnt vmcnt(3) lgkmcnt(3)
    v_mfma_f32_32x32x8_bf16 v[0:15], v[80:81], v[176:177], v[0:15]
    ds_read_b64_tr_b16 v[184:185], v246 offset:6144
    ds_read_b64_tr_b16 v[186:187], v246 offset:7168
    ds_read_b64_tr_b16 v[188:189], v247 offset:6144
    ds_read_b64_tr_b16 v[190:191], v247 offset:7168
    s_xor_b32 s47, s44, 256
    s_add_u32 s49, s48, 128
    s_mov_b32 m0, s70
    v_mfma_f32_32x32x8_bf16 v[16:31], v[84:85], v[176:177], v[16:31]
    buffer_load_dwordx4 v222, s[4:7], s42 offen sc1 lds
    buffer_load_dwordx4 v223, s[72:75], s42 offen offset:1024 sc1 lds
    s_add_u32 s60, s48, 256
    s_cmp_eq_u32 s33, 3
    s_cselect_b32 s46, s44, s47
    s_cselect_b32 s50, s60, s48
    s_cselect_b32 s51, s48, s49
    v_mfma_f32_32x32x8_bf16 v[32:47], v[80:81], v[180:181], v[32:47]
    s_sub_u32 s60, s33, 2
    s_cmp_lt_u32 s60, 2
    s_cbranch_scc0 K2_rare_58
K2_back_59:
    v_mul_f32 v234, v0, v96
    v_mul_f32 v236, v8, v128
    v_fmac_f32 v234, v1, v97
    v_fmac_f32 v236, v9, v129
    v_mfma_f32_32x32x8_bf16 v[48:63], v[84:85], v[180:181], v[48:63]
    s_setprio 0
    v_fmac_f32 v234, v2, v98
    v_fmac_f32 v236, v10, v130
    v_fmac_f32 v234, v3, v99
    v_fmac_f32 v236, v11, v131
    v_fmac_f32 v234, v4, v100
    v_fmac_f32 v236, v12, v132
    v_fmac_f32 v234, v5, v101
    v_fmac_f32 v236, v13, v133
    v_fmac_f32 v234, v6, v102
    v_fmac_f32 v236, v14, v134
    v_fmac_f32 v234, v7, v103
    v_fmac_f32 v236, v15, v135
    v_mul_f32 v238, v16, v128
    v_mul_f32 v240, v24, v128
    v_fmac_f32 v238, v17, v129
    v_fmac_f32 v240, v25, v129
    v_fmac_f32 v238, v18, v130
    v_fmac_f32 v240, v26, v130
    v_fmac_f32 v238, v19, v131
    v_fmac_f32 v240, v27, v131
    v_fmac_f32 v238, v20, v132
    v_fmac_f32 v240, v28, v132
    v_fmac_f32 v238, v21, v133
    v_fmac_f32 v240, v29, v133
    v_fmac_f32 v238, v22, v134
    v_fmac_f32 v240, v30, v134
    v_fmac_f32 v238, v23, v135
    v_fmac_f32 v240, v31, v135
    v_mul_f32 v235, v32, v104
    v_mul_f32 v237, v40, v136
    v_fmac_f32 v235, v33, v105
    v_fmac_f32 v237, v41, v137
    v_fmac_f32 v235, v34, v106
    v_fmac_f32 v237, v42, v138
    v_fmac_f32 v235, v35, v107
    v_fmac_f32 v237, v43, v139
    v_fmac_f32 v235, v36, v108
    v_fmac_f32 v237, v44, v140
    v_fmac_f32 v235, v37, v109
    v_fmac_f32 v237, v45, v141
    v_fmac_f32 v235, v38, v110
    v_fmac_f32 v237, v46, v142
    v_fmac_f32 v235, v39, v111
    v_fmac_f32 v237, v47, v143
    v_mul_f32 v239, v48, v136
    v_mul_f32 v241, v56, v136
    s_setprio 1
    s_waitcnt vmcnt(3) lgkmcnt(0)
    v_mfma_f32_32x32x16_bf16 v[0:15], v[64:67], v[184:187], 0
    ds_read_b64_tr_b16 v[176:177], v246 offset:0
    ds_read_b64_tr_b16 v[178:179], v246 offset:1024
    ds_read_b64_tr_b16 v[180:181], v247 offset:0
    ds_read_b64_tr_b16 v[182:183], v247 offset:1024
    v_fmac_f32 v239, v49, v137
    v_fmac_f32 v241, v57, v137
    s_mov_b32 m0, s71
    v_mfma_f32_32x32x16_bf16 v[16:31], v[68:71], v[184:187], 0
    buffer_load_dwordx4 v224, s[4:7], s42 offen sc1 lds
    buffer_load_dwordx4 v225, s[72:75], s42 offen offset:1024 sc1 lds
    v_fmac_f32 v239, v50, v138
    v_fmac_f32 v241, v58, v138
    v_fmac_f32 v239, v51, v139
    v_fmac_f32 v241, v59, v139
    v_fmac_f32 v239, v52, v140
    v_mfma_f32_32x32x16_bf16 v[32:47], v[64:67], v[188:191], 0
    v_fmac_f32 v241, v60, v140
    v_fmac_f32 v239, v53, v141
    v_fmac_f32 v241, v61, v141
    v_fmac_f32 v239, v54, v142
    v_fmac_f32 v241, v62, v142
    v_fmac_f32 v239, v55, v143
    v_fmac_f32 v241, v63, v143
    v_mfma_f32_32x32x16_bf16 v[48:63], v[68:71], v[188:191], 0
    v_permlane32_swap_b32 v234, v236
    v_permlane32_swap_b32 v235, v237
    v_permlane32_swap_b32 v240, v238
    s_waitcnt vmcnt(4) lgkmcnt(0)
    v_mfma_f32_32x32x16_bf16 v[0:15], v[72:75], v[176:179], v[0:15]
    ds_read_b64_tr_b16 v[184:185], v246 offset:2048
    ds_read_b64_tr_b16 v[188:189], v247 offset:2048
    v_permlane32_swap_b32 v241, v239
    v_lshl_add_u32 v230, v252, 1, s31
    v_add_f32 v234, v234, v236
    s_mov_b32 m0, s68
    v_mfma_f32_32x32x16_bf16 v[16:31], v[76:79], v[176:179], v[16:31]
    buffer_load_dwordx4 v226, s[4:7], s42 offen sc1 lds
    v_add_f32 v235, v235, v237
    v_add_f32 v240, v240, v238
    v_add_f32 v241, v241, v239
    v_cvt_pk_bf16_f32 v234, v234, v235
    v_cvt_pk_bf16_f32 v240, v240, v241
    ds_write_b32 v230, v234 offset:0
    v_mfma_f32_32x32x16_bf16 v[32:47], v[72:75], v[180:183], v[32:47]
    ds_write_b32 v230, v240 offset:256
    v_mfma_f32_32x32x16_bf16 v[48:63], v[76:79], v[180:183], v[48:63]
    s_waitcnt vmcnt(3) lgkmcnt(2)
    v_mfma_f32_32x32x8_bf16 v[0:15], v[80:81], v[184:185], v[0:15]
    ds_read_b64_tr_b16 v[176:177], v246 offset:4096
    ds_read_b64_tr_b16 v[178:179], v246 offset:5120
    ds_read_b64_tr_b16 v[180:181], v247 offset:4096
    ds_read_b64_tr_b16 v[182:183], v247 offset:5120
    s_mov_b32 m0, s69
    v_mfma_f32_32x32x8_bf16 v[16:31], v[84:85], v[184:185], v[16:31]
    buffer_load_dwordx4 v222, s[4:7], s43 offen sc1 lds
    buffer_load_dwordx4 v223, s[72:75], s43 offen offset:1024 sc1 lds
    v_mfma_f32_32x32x8_bf16 v[32:47], v[80:81], v[188:189], v[32:47]
    s_nop 2
    v_mul_f32 v234, v0, v144
    v_mul_f32 v236, v8, v112
    v_fmac_f32 v234, v1, v145
    v_fmac_f32 v236, v9, v113
    v_fmac_f32 v234, v2, v146
    v_fmac_f32 v236, v10, v114
    v_fmac_f32 v234, v3, v147
    v_mfma_f32_32x32x8_bf16 v[48:63], v[84:85], v[188:189], v[48:63]
    s_setprio 0
    v_fmac_f32 v236, v11, v115
    v_fmac_f32 v234, v4, v148
    v_fmac_f32 v236, v12, v116
    v_fmac_f32 v234, v5, v149
    v_fmac_f32 v236, v13, v117
    v_fmac_f32 v234, v6, v150
    v_fmac_f32 v236, v14, v118
    v_fmac_f32 v234, v7, v151
    v_fmac_f32 v236, v15, v119
    v_mul_f32 v238, v16, v160
    v_mul_f32 v240, v24, v160
    v_fmac_f32 v238, v17, v161
    v_fmac_f32 v240, v25, v161
    v_fmac_f32 v238, v18, v162
    v_fmac_f32 v240, v26, v162
    v_fmac_f32 v238, v19, v163
    v_fmac_f32 v240, v27, v163
    v_fmac_f32 v238, v20, v164
    v_fmac_f32 v240, v28, v164
    v_fmac_f32 v238, v21, v165
    v_fmac_f32 v240, v29, v165
    v_fmac_f32 v238, v22, v166
    v_fmac_f32 v240, v30, v166
    v_fmac_f32 v238, v23, v167
    v_fmac_f32 v240, v31, v167
    v_mul_f32 v235, v32, v152
    v_mul_f32 v237, v40, v120
    v_fmac_f32 v235, v33, v153
    v_fmac_f32 v237, v41, v121
    v_fmac_f32 v235, v34, v154
    v_fmac_f32 v237, v42, v122
    v_fmac_f32 v235, v35, v155
    v_fmac_f32 v237, v43, v123
    v_fmac_f32 v235, v36, v156
    v_fmac_f32 v237, v44, v124
    v_fmac_f32 v235, v37, v157
    v_fmac_f32 v237, v45, v125
    v_fmac_f32 v235, v38, v158
    v_fmac_f32 v237, v46, v126
    v_fmac_f32 v235, v39, v159
    v_fmac_f32 v237, v47, v127
    v_mul_f32 v239, v48, v168
    v_mul_f32 v241, v56, v168
    v_fmac_f32 v239, v49, v169
    v_fmac_f32 v241, v57, v169
    s_setprio 1
    s_waitcnt vmcnt(3) lgkmcnt(0)
    v_mfma_f32_32x32x16_bf16 v[0:15], v[64:67], v[176:179], 0
    ds_read_b64_tr_b16 v[184:185], v246 offset:6144
    ds_read_b64_tr_b16 v[186:187], v246 offset:7168
    ds_read_b64_tr_b16 v[188:189], v247 offset:6144
    ds_read_b64_tr_b16 v[190:191], v247 offset:7168
    v_fmac_f32 v239, v50, v170
    v_fmac_f32 v241, v58, v170
    s_mov_b32 m0, s70
    v_mfma_f32_32x32x16_bf16 v[16:31], v[68:71], v[176:179], 0
    buffer_load_dwordx4 v224, s[4:7], s43 offen sc1 lds
    buffer_load_dwordx4 v225, s[72:75], s43 offen offset:1024 sc1 lds
    v_fmac_f32 v239, v51, v171
    v_fmac_f32 v241, v59, v171
    v_fmac_f32 v239, v52, v172
    v_fmac_f32 v241, v60, v172
    v_fmac_f32 v239, v53, v173
    v_mfma_f32_32x32x16_bf16 v[32:47], v[64:67], v[180:183], 0
    v_add_u32 v222, s48, v251
    ds_read2_b32 v[222:223], v222 offset0:1 offset1:3
    v_fmac_f32 v241, v61, v173
    v_fmac_f32 v239, v54, v174
    v_fmac_f32 v241, v62, v174
    v_fmac_f32 v239, v55, v175
    v_fmac_f32 v241, v63, v175
    v_mfma_f32_32x32x16_bf16 v[48:63], v[68:71], v[180:183], 0
    s_waitcnt vmcnt(4) lgkmcnt(1)
    v_mfma_f32_32x32x16_bf16 v[0:15], v[72:75], v[184:187], v[0:15]
    ds_read_b64_tr_b16 v[176:177], v246 offset:0
    ds_read_b64_tr_b16 v[180:181], v247 offset:0
    s_mov_b32 m0, s71
    v_mfma_f32_32x32x16_bf16 v[16:31], v[76:79], v[184:187], v[16:31]
    buffer_load_dwordx4 v226, s[4:7], s43 offen sc1 lds
    s_waitcnt lgkmcnt(2)
    v_mad_u32_u16 v222, v222, s39, v248 op_sel:[1,0,0,0]
    v_mad_u32_u16 v223, v223, s39, v248 op_sel:[1,0,0,0]
    v_mfma_f32_32x32x16_bf16 v[32:47], v[72:75], v[188:191], v[32:47]
    v_add_u32 v224, s49, v251
    ds_read2_b32 v[224:225], v224 offset0:1 offset1:3
    v_mfma_f32_32x32x16_bf16 v[48:63], v[76:79], v[188:191], v[48:63]
    s_waitcnt vmcnt(3) lgkmcnt(1)
    v_mfma_f32_32x32x8_bf16 v[0:15], v[80:81], v[176:177], v[0:15]
    ds_read_b64_tr_b16 v[184:185], v246 offset:2048
    ds_read_b64_tr_b16 v[186:187], v246 offset:3072
    ds_read_b64_tr_b16 v[188:189], v247 offset:2048
    ds_read_b64_tr_b16 v[190:191], v247 offset:3072
    s_mov_b32 m0, s68
    v_mfma_f32_32x32x8_bf16 v[16:31], v[84:85], v[176:177], v[16:31]
    buffer_load_dwordx4 v222, s[4:7], s44 offen sc1 lds
    buffer_load_dwordx4 v223, s[72:75], s44 offen offset:1024 sc1 lds
    s_waitcnt lgkmcnt(4)
    v_mad_u32_u16 v224, v224, s39, v248 op_sel:[1,0,0,0]
    v_mad_u32_u16 v225, v225, s39, v248 op_sel:[1,0,0,0]
    v_mfma_f32_32x32x8_bf16 v[32:47], v[80:81], v[180:181], v[32:47]
    v_add_u32 v226, s50, v251
    ds_read2_b32 v[226:227], v226 offset0:1 offset1:3
    v_mul_f32 v242, v0, v144
    v_fma_f32 v238, v8, v160, -v238
    v_fmac_f32 v242, v1, v145
    v_fmac_f32 v238, v9, v161
    v_fmac_f32 v242, v2, v146
    v_mfma_f32_32x32x8_bf16 v[48:63], v[84:85], v[180:181], v[48:63]
    s_setprio 0
    v_fmac_f32 v238, v10, v162
    v_fmac_f32 v242, v3, v147
    v_fmac_f32 v238, v11, v163
    v_fmac_f32 v242, v4, v148
    v_fmac_f32 v238, v12, v164
    v_fmac_f32 v242, v5, v149
    v_fmac_f32 v238, v13, v165
    v_fmac_f32 v242, v6, v150
    v_fmac_f32 v238, v14, v166
    v_fmac_f32 v242, v7, v151
    v_fmac_f32 v238, v15, v167
    v_fmac_f32 v236, v16, v112
    v_mul_f32 v244, v24, v160
    v_fmac_f32 v236, v17, v113
    v_fmac_f32 v244, v25, v161
    v_fmac_f32 v236, v18, v114
    v_fmac_f32 v244, v26, v162
    v_fmac_f32 v236, v19, v115
    v_fmac_f32 v244, v27, v163
    v_fmac_f32 v236, v20, v116
    v_fmac_f32 v244, v28, v164
    v_fmac_f32 v236, v21, v117
    v_fmac_f32 v244, v29, v165
    v_fmac_f32 v236, v22, v118
    v_fmac_f32 v244, v30, v166
    v_fmac_f32 v236, v23, v119
    v_fmac_f32 v244, v31, v167
    v_mul_f32 v243, v32, v152
    v_fma_f32 v239, v40, v168, -v239
    v_fmac_f32 v243, v33, v153
    v_fmac_f32 v239, v41, v169
    v_fmac_f32 v243, v34, v154
    v_fmac_f32 v239, v42, v170
    v_fmac_f32 v243, v35, v155
    v_fmac_f32 v239, v43, v171
    v_fmac_f32 v243, v36, v156
    v_fmac_f32 v239, v44, v172
    v_fmac_f32 v243, v37, v157
    v_fmac_f32 v239, v45, v173
    v_fmac_f32 v243, v38, v158
    v_fmac_f32 v239, v46, v174
    v_fmac_f32 v243, v39, v159
    v_fmac_f32 v239, v47, v175
    v_fmac_f32 v237, v48, v120
    v_mul_f32 v245, v56, v168
    v_fmac_f32 v237, v49, v121
    v_fmac_f32 v245, v57, v169
    v_fmac_f32 v237, v50, v122
    v_fmac_f32 v245, v58, v170
    v_fmac_f32 v237, v51, v123
    s_setprio 1
    s_waitcnt vmcnt(3) lgkmcnt(1)
    v_mfma_f32_32x32x16_bf16 v[0:15], v[64:67], v[184:187], 0
    ds_read_b64_tr_b16 v[176:177], v246 offset:4096
    ds_read_b64_tr_b16 v[178:179], v246 offset:5120
    ds_read_b64_tr_b16 v[180:181], v247 offset:4096
    ds_read_b64_tr_b16 v[182:183], v247 offset:5120
    v_fmac_f32 v245, v59, v171
    v_fmac_f32 v237, v52, v124
    s_mov_b32 m0, s69
    v_mfma_f32_32x32x16_bf16 v[16:31], v[68:71], v[184:187], 0
    buffer_load_dwordx4 v224, s[4:7], s45 offen sc1 lds
    buffer_load_dwordx4 v225, s[72:75], s45 offen offset:1024 sc1 lds
    s_waitcnt lgkmcnt(4)
    v_mad_u32_u16 v226, v226, s39, v248 op_sel:[1,0,0,0]
    v_mad_u32_u16 v227, v227, s39, v248 op_sel:[1,0,0,0]
    v_fmac_f32 v245, v60, v172
    v_fmac_f32 v237, v53, v125
    v_mfma_f32_32x32x16_bf16 v[32:47], v[64:67], v[188:191], 0
    v_add_u32 v228, s51, v251
    ds_read2_b32 v[228:229], v228 offset0:1 offset1:3
    v_fmac_f32 v245, v61, v173
    v_fmac_f32 v237, v54, v126
    v_fmac_f32 v245, v62, v174
    v_fmac_f32 v237, v55, v127
    v_fmac_f32 v245, v63, v175
    v_mfma_f32_32x32x16_bf16 v[48:63], v[68:71], v[188:191], 0
    v_permlane32_swap_b32 v242, v234
    v_permlane32_swap_b32 v243, v235
    v_add_f32 v242, v242, v234
    v_add_f32 v243, v243, v235
    s_waitcnt vmcnt(4) lgkmcnt(1)
    v_mfma_f32_32x32x16_bf16 v[0:15], v[72:75], v[176:179], v[0:15]
    ds_read_b64_tr_b16 v[184:185], v246 offset:6144
    ds_read_b64_tr_b16 v[188:189], v247 offset:6144
    v_cvt_pk_bf16_f32 v242, v242, v243
    ds_write_b32 v230, v242 offset:512
    s_mov_b32 s32, s31
    s_mov_b32 s31, s35
    s_mov_b32 m0, s70
    v_mfma_f32_32x32x16_bf16 v[16:31], v[76:79], v[176:179], v[16:31]
    buffer_load_dwordx4 v226, s[4:7], s46 offen sc1 lds
    buffer_load_dwordx4 v227, s[72:75], s46 offen offset:1024 sc1 lds
    s_waitcnt lgkmcnt(3)
    v_mad_u32_u16 v228, v228, s39, v248 op_sel:[1,0,0,0]
    v_mad_u32_u16 v229, v229, s39, v248 op_sel:[1,0,0,0]
    s_sub_u32 s26, s48, s29
    s_mov_b32 s29, s48
    v_mfma_f32_32x32x16_bf16 v[32:47], v[72:75], v[180:183], v[32:47]
    s_mov_b32 s30, s3
    s_bfe_u32 s56, s3, 0x40012
    s_cmp_lg_u32 s36, 0
    s_cselect_b32 s56, s56, 0
    v_mfma_f32_32x32x16_bf16 v[48:63], v[76:79], v[180:183], v[48:63]
    s_waitcnt vmcnt(4) lgkmcnt(1)
    v_mfma_f32_32x32x8_bf16 v[0:15], v[80:81], v[184:185], v[0:15]
    ds_read_b64_tr_b16 v[176:177], v246 offset:0
    ds_read_b64_tr_b16 v[178:179], v246 offset:1024
    ds_read_b64_tr_b16 v[180:181], v247 offset:0
    ds_read_b64_tr_b16 v[182:183], v247 offset:1024
    s_mov_b32 m0, s71
    v_mfma_f32_32x32x8_bf16 v[16:31], v[84:85], v[184:185], v[16:31]
    buffer_load_dwordx4 v228, s[4:7], s47 offen sc1 lds
    buffer_load_dwordx4 v229, s[72:75], s47 offen offset:1024 sc1 lds
    v_mfma_f32_32x32x8_bf16 v[32:47], v[80:81], v[188:189], v[32:47]
    s_nop 2
    v_mul_f32 v242, v0, v144
    v_fma_f32 v240, v8, v160, -v240
    v_fmac_f32 v242, v1, v145
    v_fmac_f32 v240, v9, v161
    v_fmac_f32 v242, v2, v146
    v_fmac_f32 v240, v10, v162
    v_fmac_f32 v242, v3, v147
    v_mfma_f32_32x32x8_bf16 v[48:63], v[84:85], v[188:189], v[48:63]
    s_setprio 0
    v_fmac_f32 v240, v11, v163
    v_fmac_f32 v242, v4, v148
    v_fmac_f32 v240, v12, v164
    v_fmac_f32 v242, v5, v149
    v_fmac_f32 v240, v13, v165
    v_fmac_f32 v242, v6, v150
    v_fmac_f32 v240, v14, v166
    v_fmac_f32 v242, v7, v151
    v_fmac_f32 v240, v15, v167
    v_add_u32 v249, s26, v249
    v_add_u32 v250, s26, v250
    v_fma_f32 v244, v16, v160, -v244
    v_fmac_f32 v236, v24, v112
    v_fmac_f32 v244, v17, v161
    v_fmac_f32 v236, v25, v113
    v_fmac_f32 v244, v18, v162
    v_fmac_f32 v236, v26, v114
    v_fmac_f32 v244, v19, v163
    v_fmac_f32 v236, v27, v115
    v_fmac_f32 v244, v20, v164
    v_fmac_f32 v236, v28, v116
    v_fmac_f32 v244, v21, v165
    v_fmac_f32 v236, v29, v117
    v_fmac_f32 v244, v22, v166
    v_fmac_f32 v236, v30, v118
    v_fmac_f32 v244, v23, v167
    v_fmac_f32 v236, v31, v119
    ds_read_b64_tr_b16 v[0:1], v249 offset:0
    ds_read_b64_tr_b16 v[2:3], v249 offset:32
    ds_read_u16_d16_hi v16, v250 offset:0
    v_mul_f32 v243, v32, v152
    v_fma_f32 v241, v40, v168, -v241
    v_fmac_f32 v243, v33, v153
    v_fmac_f32 v241, v41, v169
    v_fmac_f32 v243, v34, v154
    v_fmac_f32 v241, v42, v170
    v_fmac_f32 v243, v35, v155
    v_fmac_f32 v241, v43, v171
    v_fmac_f32 v243, v36, v156
    v_fmac_f32 v241, v44, v172
    v_fmac_f32 v243, v37, v157
    v_fmac_f32 v241, v45, v173
    v_fmac_f32 v243, v38, v158
    v_fmac_f32 v241, v46, v174
    v_fmac_f32 v243, v39, v159
    v_fmac_f32 v241, v47, v175
    ds_read_b64_tr_b16 v[4:5], v249 offset:512
    ds_read_b64_tr_b16 v[6:7], v249 offset:544
    ds_read_u16_d16_hi v17, v250 offset:128
    v_fma_f32 v245, v48, v168, -v245
    v_fmac_f32 v237, v56, v120
    v_fmac_f32 v245, v49, v169
    v_fmac_f32 v237, v57, v121
    v_fmac_f32 v245, v50, v170
    v_fmac_f32 v237, v58, v122
    v_fmac_f32 v245, v51, v171
    v_fmac_f32 v237, v59, v123
    v_fmac_f32 v245, v52, v172
    v_fmac_f32 v237, v60, v124
    v_fmac_f32 v245, v53, v173
    v_fmac_f32 v237, v61, v125
    v_fmac_f32 v245, v54, v174
    v_fmac_f32 v237, v62, v126
    v_fmac_f32 v245, v55, v175
    v_fmac_f32 v237, v63, v127
    s_cmp_eq_u32 s56, 5
    s_cbranch_scc1 K2_U21
    s_cmp_eq_u32 s56, 6
    s_cbranch_scc1 K2_U3h1
    s_branch K2_DSP1
K2_U31:
    s_setprio 1
    ds_read_b64_tr_b16 v[8:9], v249 offset:1024
    ds_read_b64_tr_b16 v[10:11], v249 offset:1056
    ds_read_u16_d16_hi v18, v250 offset:256
    s_waitcnt lgkmcnt(3)
    v_lshlrev_b32 v20, 16, v0
    v_and_b32 v21, 0xffff0000, v0
    v_lshlrev_b32 v22, 16, v1
    v_and_b32 v23, 0xffff0000, v1
    v_lshlrev_b32 v24, 16, v2
    v_and_b32 v25, 0xffff0000, v2
    v_lshlrev_b32 v26, 16, v3
    v_and_b32 v27, 0xffff0000, v3
    v_mul_f32_dpp v36, v16, v20 row_newbcast:8 row_mask:0xf bank_mask:0xf
    v_mul_f32_dpp v37, v16, v21 row_newbcast:9 row_mask:0xf bank_mask:0xf
    v_mul_f32_dpp v38, v16, v22 row_newbcast:10 row_mask:0xf bank_mask:0xf
    v_mul_f32_dpp v39, v16, v23 row_newbcast:11 row_mask:0xf bank_mask:0xf
    v_mul_f32_dpp v40, v16, v24 row_newbcast:12 row_mask:0xf bank_mask:0xf
    v_mul_f32_dpp v41, v16, v25 row_newbcast:13 row_mask:0xf bank_mask:0xf
    v_mul_f32_dpp v42, v16, v26 row_newbcast:14 row_mask:0xf bank_mask:0xf
    v_mul_f32_dpp v43, v16, v27 row_newbcast:15 row_mask:0xf bank_mask:0xf
    v_cvt_pk_bf16_f32 v68, v36, v37
    v_cvt_pk_bf16_f32 v69, v38, v39
    v_cvt_pk_bf16_f32 v70, v40, v41
    v_cvt_pk_bf16_f32 v71, v42, v43
    v_mul_f32_dpp v20, v16, v20 row_newbcast:0 row_mask:0xa bank_mask:0xf
    v_mul_f32_dpp v21, v16, v21 row_newbcast:1 row_mask:0xa bank_mask:0xf
    v_mul_f32_dpp v22, v16, v22 row_newbcast:2 row_mask:0xa bank_mask:0xf
    v_mul_f32_dpp v23, v16, v23 row_newbcast:3 row_mask:0xa bank_mask:0xf
    v_mul_f32_dpp v24, v16, v24 row_newbcast:4 row_mask:0xa bank_mask:0xf
    v_mul_f32_dpp v25, v16, v25 row_newbcast:5 row_mask:0xa bank_mask:0xf
    v_mul_f32_dpp v26, v16, v26 row_newbcast:6 row_mask:0xa bank_mask:0xf
    v_mul_f32_dpp v27, v16, v27 row_newbcast:7 row_mask:0xa bank_mask:0xf
    v_cvt_pk_bf16_f32 v64, v20, v21
    v_cvt_pk_bf16_f32 v65, v22, v23
    v_cvt_pk_bf16_f32 v66, v24, v25
    v_cvt_pk_bf16_f32 v67, v26, v27
    v_lshlrev_b32 v28, 16, v4
    v_and_b32 v29, 0xffff0000, v4
    v_lshlrev_b32 v30, 16, v5
    v_and_b32 v31, 0xffff0000, v5
    v_lshlrev_b32 v32, 16, v6
    v_and_b32 v33, 0xffff0000, v6
    v_lshlrev_b32 v34, 16, v7
    v_and_b32 v35, 0xffff0000, v7
    v_mul_f32_dpp v36, v17, v28 row_newbcast:8 row_mask:0xf bank_mask:0xf
    v_mul_f32_dpp v37, v17, v29 row_newbcast:9 row_mask:0xf bank_mask:0xf
    v_mul_f32_dpp v38, v17, v30 row_newbcast:10 row_mask:0xf bank_mask:0xf
    v_mul_f32_dpp v39, v17, v31 row_newbcast:11 row_mask:0xf bank_mask:0xf
    v_mul_f32_dpp v40, v17, v32 row_newbcast:12 row_mask:0xf bank_mask:0xf
    v_mul_f32_dpp v41, v17, v33 row_newbcast:13 row_mask:0xf bank_mask:0xf
    v_mul_f32_dpp v42, v17, v34 row_newbcast:14 row_mask:0xf bank_mask:0xf
    v_mul_f32_dpp v43, v17, v35 row_newbcast:15 row_mask:0xf bank_mask:0xf
    v_cvt_pk_bf16_f32 v76, v36, v37
    v_cvt_pk_bf16_f32 v77, v38, v39
    v_cvt_pk_bf16_f32 v78, v40, v41
    v_cvt_pk_bf16_f32 v79, v42, v43
    v_mul_f32_dpp v28, v17, v28 row_newbcast:0 row_mask:0xa bank_mask:0xf
    v_mul_f32_dpp v29, v17, v29 row_newbcast:1 row_mask:0xa bank_mask:0xf
    v_mul_f32_dpp v30, v17, v30 row_newbcast:2 row_mask:0xa bank_mask:0xf
    v_mul_f32_dpp v31, v17, v31 row_newbcast:3 row_mask:0xa bank_mask:0xf
    v_mul_f32_dpp v32, v17, v32 row_newbcast:4 row_mask:0xa bank_mask:0xf
    v_mul_f32_dpp v33, v17, v33 row_newbcast:5 row_mask:0xa bank_mask:0xf
    v_mul_f32_dpp v34, v17, v34 row_newbcast:6 row_mask:0xa bank_mask:0xf
    v_mul_f32_dpp v35, v17, v35 row_newbcast:7 row_mask:0xa bank_mask:0xf
    v_cvt_pk_bf16_f32 v72, v28, v29
    v_cvt_pk_bf16_f32 v73, v30, v31
    v_cvt_pk_bf16_f32 v74, v32, v33
    v_cvt_pk_bf16_f32 v75, v34, v35
    s_waitcnt lgkmcnt(0)
    v_lshlrev_b32 v20, 16, v8
    v_and_b32 v21, 0xffff0000, v8
    v_lshlrev_b32 v22, 16, v9
    v_and_b32 v23, 0xffff0000, v9
    v_lshlrev_b32 v24, 16, v10
    v_and_b32 v25, 0xffff0000, v10
    v_lshlrev_b32 v26, 16, v11
    v_and_b32 v27, 0xffff0000, v11
    v_mul_f32_dpp v36, v18, v20 row_newbcast:8 row_mask:0xf bank_mask:0xf
    v_mul_f32_dpp v37, v18, v21 row_newbcast:9 row_mask:0xf bank_mask:0xf
    v_mul_f32_dpp v38, v18, v22 row_newbcast:10 row_mask:0xf bank_mask:0xf
    v_mul_f32_dpp v39, v18, v23 row_newbcast:11 row_mask:0xf bank_mask:0xf
    v_mul_f32_dpp v40, v18, v24 row_newbcast:12 row_mask:0xf bank_mask:0xf
    v_mul_f32_dpp v41, v18, v25 row_newbcast:13 row_mask:0xf bank_mask:0xf
    v_mul_f32_dpp v42, v18, v26 row_newbcast:14 row_mask:0xf bank_mask:0xf
    v_mul_f32_dpp v43, v18, v27 row_newbcast:15 row_mask:0xf bank_mask:0xf
    v_cvt_pk_bf16_f32 v84, v36, v37
    v_cvt_pk_bf16_f32 v85, v38, v39
    v_cvt_pk_bf16_f32 v86, v40, v41
    v_cvt_pk_bf16_f32 v87, v42, v43
    v_mul_f32_dpp v20, v18, v20 row_newbcast:0 row_mask:0xa bank_mask:0xf
    v_mul_f32_dpp v21, v18, v21 row_newbcast:1 row_mask:0xa bank_mask:0xf
    v_mul_f32_dpp v22, v18, v22 row_newbcast:2 row_mask:0xa bank_mask:0xf
    v_mul_f32_dpp v23, v18, v23 row_newbcast:3 row_mask:0xa bank_mask:0xf
    v_mul_f32_dpp v24, v18, v24 row_newbcast:4 row_mask:0xa bank_mask:0xf
    v_mul_f32_dpp v25, v18, v25 row_newbcast:5 row_mask:0xa bank_mask:0xf
    v_mul_f32_dpp v26, v18, v26 row_newbcast:6 row_mask:0xa bank_mask:0xf
    v_mul_f32_dpp v27, v18, v27 row_newbcast:7 row_mask:0xa bank_mask:0xf
    v_cvt_pk_bf16_f32 v80, v20, v21
    v_cvt_pk_bf16_f32 v81, v22, v23
    v_cvt_pk_bf16_f32 v82, v24, v25
    v_cvt_pk_bf16_f32 v83, v26, v27
    s_waitcnt vmcnt(4)
    v_mfma_f32_32x32x16_bf16 v[0:15], v[64:67], v[176:179], 0
    ds_read_b64_tr_b16 v[184:185], v246 offset:2048
    ds_read_b64_tr_b16 v[186:187], v246 offset:3072
    ds_read_b64_tr_b16 v[188:189], v247 offset:2048
    ds_read_b64_tr_b16 v[190:191], v247 offset:3072
    s_mov_b32 m0, s68
    v_mfma_f32_32x32x16_bf16 v[16:31], v[68:71], v[176:179], 0
    buffer_load_dwordx4 v224, s[4:7], s41 offen sc1 lds
    buffer_load_dwordx4 v225, s[72:75], s41 offen offset:1024 sc1 lds
    v_permlane32_swap_b32 v242, v236
    v_permlane32_swap_b32 v243, v237
    v_mov_b32 v254, 163296
    v_mfma_f32_32x32x16_bf16 v[32:47], v[64:67], v[180:183], 0
    v_permlane32_swap_b32 v244, v238
    v_permlane32_swap_b32 v245, v239
    v_permlane32_swap_b32 v240, v241
    v_add_f32 v242, v242, v236
    v_mfma_f32_32x32x16_bf16 v[48:63], v[68:71], v[180:183], 0
    v_add_f32 v243, v243, v237
    v_add_f32 v244, v244, v238
    v_add_f32 v245, v245, v239
    v_add_f32 v240, -v240, -v241
    v_sub_u32 v241, v230, v231
    v_cvt_pk_bf16_f32 v242, v242, v243
    v_mov_b32 v255, 1
    v_lshl_add_u32 v233, v252, 1, s53
    s_mov_b64 exec, 1
    ds_add_rtn_u32 v232, v254, v255
    s_mov_b64 exec, -1
    ds_read_b32 v233, v233
    s_waitcnt vmcnt(4) lgkmcnt(2)
    v_mfma_f32_32x32x16_bf16 v[0:15], v[72:75], v[184:187], v[0:15]
    ds_read_b64_tr_b16 v[176:177], v246 offset:4096
    ds_read_b64_tr_b16 v[178:179], v246 offset:5120
    ds_read_b64_tr_b16 v[180:181], v247 offset:4096
    ds_read_b64_tr_b16 v[182:183], v247 offset:5120
    v_cvt_pk_bf16_f32 v244, v244, v245
    v_cvt_pk_bf16_f32 v240, v240, v240
    s_mov_b32 m0, s69
    v_mfma_f32_32x32x16_bf16 v[16:31], v[76:79], v[184:187], v[16:31]
    buffer_load_dwordx4 v226, s[4:7], s41 offen sc1 lds
    buffer_load_dwordx4 v227, s[72:75], s41 offen offset:1024 sc1 lds
    ds_write_b32 v230, v242 offset:768
    ds_write_b32 v230, v244 offset:1024
    ds_write_b16 v241, v240 offset:1280
    s_waitcnt lgkmcnt(7)
    v_readfirstlane_b32 s58, v232
    v_mfma_f32_32x32x16_bf16 v[32:47], v[72:75], v[188:191], v[32:47]
    s_cmp_lt_u32 s58, s22
    s_cbranch_scc0 K2_nul_61
    s_and_b32 s59, s58, 7
    s_lshr_b32 s60, s58, 3
K2_chk_63:
    v_readlane_b32 s61, v233, s59
    s_nop 0
    s_cmp_gt_u32 s61, s60
    s_cbranch_scc0 K2_spin_62
K2_back_64:
    v_mfma_f32_32x32x16_bf16 v[48:63], v[76:79], v[188:191], v[48:63]
    v_readlane_b32 s3, v253, s58
    s_lshl_b32 s44, s34, 7
    s_and_b32 s48, s3, 0x3ffff
    s_bfe_u32 s33, s3, 0x30013
    s_mov_b32 s35, s48
    s_mov_b32 s45, s44
    s_waitcnt vmcnt(4) lgkmcnt(3)
    v_mfma_f32_32x32x16_bf16 v[0:15], v[80:83], v[176:179], v[0:15]
    ds_read_b64_tr_b16 v[184:185], v246 offset:6144
    ds_read_b64_tr_b16 v[186:187], v246 offset:7168
    ds_read_b64_tr_b16 v[188:189], v247 offset:6144
    ds_read_b64_tr_b16 v[190:191], v247 offset:7168
    s_xor_b32 s47, s44, 256
    s_add_u32 s49, s48, 128
    s_mov_b32 m0, s70
    v_mfma_f32_32x32x16_bf16 v[16:31], v[84:87], v[176:179], v[16:31]
    buffer_load_dwordx4 v222, s[4:7], s42 offen sc1 lds
    buffer_load_dwordx4 v223, s[72:75], s42 offen offset:1024 sc1 lds
    s_add_u32 s60, s48, 256
    s_cmp_eq_u32 s33, 3
    s_cselect_b32 s46, s44, s47
    s_cselect_b32 s50, s60, s48
    s_cselect_b32 s51, s48, s49
    v_mfma_f32_32x32x16_bf16 v[32:47], v[80:83], v[180:183], v[32:47]
    s_sub_u32 s60, s33, 2
    s_cmp_lt_u32 s60, 2
    s_cbranch_scc0 K2_rare_65
K2_back_66:
    v_mul_f32 v234, v0, v96
    v_mul_f32 v236, v8, v128
    v_fmac_f32 v234, v1, v97
    v_fmac_f32 v236, v9, v129
    v_mfma_f32_32x32x16_bf16 v[48:63], v[84:87], v[180:183], v[48:63]
    s_setprio 0
    v_fmac_f32 v234, v2, v98
    v_fmac_f32 v236, v10, v130
    v_fmac_f32 v234, v3, v99
    v_fmac_f32 v236, v11, v131
    v_fmac_f32 v234, v4, v100
    v_fmac_f32 v236, v12, v132
    v_fmac_f32 v234, v5, v101
    v_fmac_f32 v236, v13, v133
    v_fmac_f32 v234, v6, v102
    v_fmac_f32 v236, v14, v134
    v_fmac_f32 v234, v7, v103
    v_fmac_f32 v236, v15, v135
    v_mul_f32 v238, v16, v128
    v_mul_f32 v240, v24, v128
    v_fmac_f32 v238, v17, v129
    v_fmac_f32 v240, v25, v129
    v_fmac_f32 v238, v18, v130
    v_fmac_f32 v240, v26, v130
    v_fmac_f32 v238, v19, v131
    v_fmac_f32 v240, v27, v131
    v_fmac_f32 v238, v20, v132
    v_fmac_f32 v240, v28, v132
    v_fmac_f32 v238, v21, v133
    v_fmac_f32 v240, v29, v133
    v_fmac_f32 v238, v22, v134
    v_fmac_f32 v240, v30, v134
    v_fmac_f32 v238, v23, v135
    v_fmac_f32 v240, v31, v135
    v_mul_f32 v235, v32, v104
    v_mul_f32 v237, v40, v136
    v_fmac_f32 v235, v33, v105
    v_fmac_f32 v237, v41, v137
    v_fmac_f32 v235, v34, v106
    v_fmac_f32 v237, v42, v138
    v_fmac_f32 v235, v35, v107
    v_fmac_f32 v237, v43, v139
    v_fmac_f32 v235, v36, v108
    v_fmac_f32 v237, v44, v140
    v_fmac_f32 v235, v37, v109
    v_fmac_f32 v237, v45, v141
    v_fmac_f32 v235, v38, v110
    v_fmac_f32 v237, v46, v142
    v_fmac_f32 v235, v39, v111
    v_fmac_f32 v237, v47, v143
    v_mul_f32 v239, v48, v136
    v_mul_f32 v241, v56, v136
    s_setprio 1
    s_waitcnt vmcnt(4) lgkmcnt(0)
    v_mfma_f32_32x32x16_bf16 v[0:15], v[64:67], v[184:187], 0
    ds_read_b64_tr_b16 v[176:177], v246 offset:0
    ds_read_b64_tr_b16 v[178:179], v246 offset:1024
    ds_read_b64_tr_b16 v[180:181], v247 offset:0
    ds_read_b64_tr_b16 v[182:183], v247 offset:1024
    v_fmac_f32 v239, v49, v137
    v_fmac_f32 v241, v57, v137
    s_mov_b32 m0, s71
    v_mfma_f32_32x32x16_bf16 v[16:31], v[68:71], v[184:187], 0
    buffer_load_dwordx4 v224, s[4:7], s42 offen sc1 lds
    buffer_load_dwordx4 v225, s[72:75], s42 offen offset:1024 sc1 lds
    v_fmac_f32 v239, v50, v138
    v_fmac_f32 v241, v58, v138
    v_fmac_f32 v239, v51, v139
    v_fmac_f32 v241, v59, v139
    v_fmac_f32 v239, v52, v140
    v_mfma_f32_32x32x16_bf16 v[32:47], v[64:67], v[188:191], 0
    v_fmac_f32 v241, v60, v140
    v_fmac_f32 v239, v53, v141
    v_fmac_f32 v241, v61, v141
    v_fmac_f32 v239, v54, v142
    v_fmac_f32 v241, v62, v142
    v_fmac_f32 v239, v55, v143
    v_fmac_f32 v241, v63, v143
    v_mfma_f32_32x32x16_bf16 v[48:63], v[68:71], v[188:191], 0
    v_permlane32_swap_b32 v234, v236
    v_permlane32_swap_b32 v235, v237
    v_permlane32_swap_b32 v240, v238
    s_waitcnt vmcnt(4) lgkmcnt(0)
    v_mfma_f32_32x32x16_bf16 v[0:15], v[72:75], v[176:179], v[0:15]
    ds_read_b64_tr_b16 v[184:185], v246 offset:2048
    ds_read_b64_tr_b16 v[186:187], v246 offset:3072
    ds_read_b64_tr_b16 v[188:189], v247 offset:2048
    ds_read_b64_tr_b16 v[190:191], v247 offset:3072
    v_permlane32_swap_b32 v241, v239
    s_mov_b32 m0, s68
    v_mfma_f32_32x32x16_bf16 v[16:31], v[76:79], v[176:179], v[16:31]
    buffer_load_dwordx4 v226, s[4:7], s42 offen sc1 lds
    buffer_load_dwordx4 v227, s[72:75], s42 offen offset:1024 sc1 lds
    v_lshl_add_u32 v230, v252, 1, s31
    v_add_f32 v234, v234, v236
    v_add_f32 v235, v235, v237
    v_add_f32 v240, v240, v238
    v_add_f32 v241, v241, v239
    v_mfma_f32_32x32x16_bf16 v[32:47], v[72:75], v[180:183], v[32:47]
    v_cvt_pk_bf16_f32 v234, v234, v235
    v_cvt_pk_bf16_f32 v240, v240, v241
    ds_write_b32 v230, v234 offset:0
    ds_write_b32 v230, v240 offset:256
    v_mfma_f32_32x32x16_bf16 v[48:63], v[76:79], v[180:183], v[48:63]
    s_waitcnt vmcnt(4) lgkmcnt(2)
    v_mfma_f32_32x32x16_bf16 v[0:15], v[80:83], v[184:187], v[0:15]
    ds_read_b64_tr_b16 v[176:177], v246 offset:4096
    ds_read_b64_tr_b16 v[178:179], v246 offset:5120
    ds_read_b64_tr_b16 v[180:181], v247 offset:4096
    ds_read_b64_tr_b16 v[182:183], v247 offset:5120
    s_mov_b32 m0, s69
    v_mfma_f32_32x32x16_bf16 v[16:31], v[84:87], v[184:187], v[16:31]
    buffer_load_dwordx4 v222, s[4:7], s43 offen sc1 lds
    buffer_load_dwordx4 v223, s[72:75], s43 offen offset:1024 sc1 lds
    v_mfma_f32_32x32x16_bf16 v[32:47], v[80:83], v[188:191], v[32:47]
    s_nop 2
    v_mul_f32 v234, v0, v144
    v_mul_f32 v236, v8, v112
    v_fmac_f32 v234, v1, v145
    v_fmac_f32 v236, v9, v113
    v_fmac_f32 v234, v2, v146
    v_fmac_f32 v236, v10, v114
    v_fmac_f32 v234, v3, v147
    v_mfma_f32_32x32x16_bf16 v[48:63], v[84:87], v[188:191], v[48:63]
    s_setprio 0
    v_fmac_f32 v236, v11, v115
    v_fmac_f32 v234, v4, v148
    v_fmac_f32 v236, v12, v116
    v_fmac_f32 v234, v5, v149
    v_fmac_f32 v236, v13, v117
    v_fmac_f32 v234, v6, v150
    v_fmac_f32 v236, v14, v118
    v_fmac_f32 v234, v7, v151
    v_fmac_f32 v236, v15, v119
    v_mul_f32 v238, v16, v160
    v_mul_f32 v240, v24, v160
    v_fmac_f32 v238, v17, v161
    v_fmac_f32 v240, v25, v161
    v_fmac_f32 v238, v18, v162
    v_fmac_f32 v240, v26, v162
    v_fmac_f32 v238, v19, v163
    v_fmac_f32 v240, v27, v163
    v_fmac_f32 v238, v20, v164
    v_fmac_f32 v240, v28, v164
    v_fmac_f32 v238, v21, v165
    v_fmac_f32 v240, v29, v165
    v_fmac_f32 v238, v22, v166
    v_fmac_f32 v240, v30, v166
    v_fmac_f32 v238, v23, v167
    v_fmac_f32 v240, v31, v167
    v_mul_f32 v235, v32, v152
    v_mul_f32 v237, v40, v120
    v_fmac_f32 v235, v33, v153
    v_fmac_f32 v237, v41, v121
    v_fmac_f32 v235, v34, v154
    v_fmac_f32 v237, v42, v122
    v_fmac_f32 v235, v35, v155
    v_fmac_f32 v237, v43, v123
    v_fmac_f32 v235, v36, v156
    v_fmac_f32 v237, v44, v124
    v_fmac_f32 v235, v37, v157
    v_fmac_f32 v237, v45, v125
    v_fmac_f32 v235, v38, v158
    v_fmac_f32 v237, v46, v126
    v_fmac_f32 v235, v39, v159
    v_fmac_f32 v237, v47, v127
    v_mul_f32 v239, v48, v168
    v_mul_f32 v241, v56, v168
    v_fmac_f32 v239, v49, v169
    v_fmac_f32 v241, v57, v169
    s_setprio 1
    s_waitcnt vmcnt(4) lgkmcnt(0)
    v_mfma_f32_32x32x16_bf16 v[0:15], v[64:67], v[176:179], 0
    ds_read_b64_tr_b16 v[184:185], v246 offset:6144
    ds_read_b64_tr_b16 v[186:187], v246 offset:7168
    ds_read_b64_tr_b16 v[188:189], v247 offset:6144
    ds_read_b64_tr_b16 v[190:191], v247 offset:7168
    v_fmac_f32 v239, v50, v170
    v_fmac_f32 v241, v58, v170
    s_mov_b32 m0, s70
    v_mfma_f32_32x32x16_bf16 v[16:31], v[68:71], v[176:179], 0
    buffer_load_dwordx4 v224, s[4:7], s43 offen sc1 lds
    buffer_load_dwordx4 v225, s[72:75], s43 offen offset:1024 sc1 lds
    v_fmac_f32 v239, v51, v171
    v_fmac_f32 v241, v59, v171
    v_fmac_f32 v239, v52, v172
    v_fmac_f32 v241, v60, v172
    v_fmac_f32 v239, v53, v173
    v_mfma_f32_32x32x16_bf16 v[32:47], v[64:67], v[180:183], 0
    v_add_u32 v222, s48, v251
    ds_read2_b32 v[222:223], v222 offset0:1 offset1:3
    v_fmac_f32 v241, v61, v173
    v_fmac_f32 v239, v54, v174
    v_fmac_f32 v241, v62, v174
    v_fmac_f32 v239, v55, v175
    v_fmac_f32 v241, v63, v175
    v_mfma_f32_32x32x16_bf16 v[48:63], v[68:71], v[180:183], 0
    s_waitcnt vmcnt(4) lgkmcnt(1)
    v_mfma_f32_32x32x16_bf16 v[0:15], v[72:75], v[184:187], v[0:15]
    ds_read_b64_tr_b16 v[176:177], v246 offset:0
    ds_read_b64_tr_b16 v[178:179], v246 offset:1024
    ds_read_b64_tr_b16 v[180:181], v247 offset:0
    ds_read_b64_tr_b16 v[182:183], v247 offset:1024
    s_mov_b32 m0, s71
    v_mfma_f32_32x32x16_bf16 v[16:31], v[76:79], v[184:187], v[16:31]
    buffer_load_dwordx4 v226, s[4:7], s43 offen sc1 lds
    buffer_load_dwordx4 v227, s[72:75], s43 offen offset:1024 sc1 lds
    s_waitcnt lgkmcnt(4)
    v_mad_u32_u16 v222, v222, s39, v248 op_sel:[1,0,0,0]
    v_mad_u32_u16 v223, v223, s39, v248 op_sel:[1,0,0,0]
    v_mfma_f32_32x32x16_bf16 v[32:47], v[72:75], v[188:191], v[32:47]
    v_add_u32 v224, s49, v251
    ds_read2_b32 v[224:225], v224 offset0:1 offset1:3
    v_mfma_f32_32x32x16_bf16 v[48:63], v[76:79], v[188:191], v[48:63]
    s_waitcnt vmcnt(4) lgkmcnt(1)
    v_mfma_f32_32x32x16_bf16 v[0:15], v[80:83], v[176:179], v[0:15]
    ds_read_b64_tr_b16 v[184:185], v246 offset:2048
    ds_read_b64_tr_b16 v[186:187], v246 offset:3072
    ds_read_b64_tr_b16 v[188:189], v247 offset:2048
    ds_read_b64_tr_b16 v[190:191], v247 offset:3072
    s_mov_b32 m0, s68
    v_mfma_f32_32x32x16_bf16 v[16:31], v[84:87], v[176:179], v[16:31]
    buffer_load_dwordx4 v222, s[4:7], s44 offen sc1 lds
    buffer_load_dwordx4 v223, s[72:75], s44 offen offset:1024 sc1 lds
    s_waitcnt lgkmcnt(4)
    v_mad_u32_u16 v224, v224, s39, v248 op_sel:[1,0,0,0]
    v_mad_u32_u16 v225, v225, s39, v248 op_sel:[1,0,0,0]
    v_mfma_f32_32x32x16_bf16 v[32:47], v[80:83], v[180:183], v[32:47]
    v_add_u32 v226, s50, v251
    ds_read2_b32 v[226:227], v226 offset0:1 offset1:3
    v_mul_f32 v242, v0, v144
    v_fma_f32 v238, v8, v160, -v238
    v_fmac_f32 v242, v1, v145
    v_fmac_f32 v238, v9, v161
    v_fmac_f32 v242, v2, v146
    v_mfma_f32_32x32x16_bf16 v[48:63], v[84:87], v[180:183], v[48:63]
    s_setprio 0
    v_fmac_f32 v238, v10, v162
    v_fmac_f32 v242, v3, v147
    v_fmac_f32 v238, v11, v163
    v_fmac_f32 v242, v4, v148
    v_fmac_f32 v238, v12, v164
    v_fmac_f32 v242, v5, v149
    v_fmac_f32 v238, v13, v165
    v_fmac_f32 v242, v6, v150
    v_fmac_f32 v238, v14, v166
    v_fmac_f32 v242, v7, v151
    v_fmac_f32 v238, v15, v167
    v_fmac_f32 v236, v16, v112
    v_mul_f32 v244, v24, v160
    v_fmac_f32 v236, v17, v113
    v_fmac_f32 v244, v25, v161
    v_fmac_f32 v236, v18, v114
    v_fmac_f32 v244, v26, v162
    v_fmac_f32 v236, v19, v115
    v_fmac_f32 v244, v27, v163
    v_fmac_f32 v236, v20, v116
    v_fmac_f32 v244, v28, v164
    v_fmac_f32 v236, v21, v117
    v_fmac_f32 v244, v29, v165
    v_fmac_f32 v236, v22, v118
    v_fmac_f32 v244, v30, v166
    v_fmac_f32 v236, v23, v119
    v_fmac_f32 v244, v31, v167
    v_mul_f32 v243, v32, v152
    v_fma_f32 v239, v40, v168, -v239
    v_fmac_f32 v243, v33, v153
    v_fmac_f32 v239, v41, v169
    v_fmac_f32 v243, v34, v154
    v_fmac_f32 v239, v42, v170
    v_fmac_f32 v243, v35, v155
    v_fmac_f32 v239, v43, v171
    v_fmac_f32 v243, v36, v156
    v_fmac_f32 v239, v44, v172
    v_fmac_f32 v243, v37, v157
    v_fmac_f32 v239, v45, v173
    v_fmac_f32 v243, v38, v158
    v_fmac_f32 v239, v46, v174
    v_fmac_f32 v243, v39, v159
    v_fmac_f32 v239, v47, v175
    v_fmac_f32 v237, v48, v120
    v_mul_f32 v245, v56, v168
    v_fmac_f32 v237, v49, v121
    v_fmac_f32 v245, v57, v169
    v_fmac_f32 v237, v50, v122
    v_fmac_f32 v245, v58, v170
    v_fmac_f32 v237, v51, v123
    s_setprio 1
    s_waitcnt vmcnt(4) lgkmcnt(1)
    v_mfma_f32_32x32x16_bf16 v[0:15], v[64:67], v[184:187], 0
    ds_read_b64_tr_b16 v[176:177], v246 offset:4096
    ds_read_b64_tr_b16 v[178:179], v246 offset:5120
    ds_read_b64_tr_b16 v[180:181], v247 offset:4096
    ds_read_b64_tr_b16 v[182:183], v247 offset:5120
    v_fmac_f32 v245, v59, v171
    v_fmac_f32 v237, v52, v124
    s_mov_b32 m0, s69
    v_mfma_f32_32x32x16_bf16 v[16:31], v[68:71], v[184:187], 0
    buffer_load_dwordx4 v224, s[4:7], s45 offen sc1 lds
    buffer_load_dwordx4 v225, s[72:75], s45 offen offset:1024 sc1 lds
    s_waitcnt lgkmcnt(4)
    v_mad_u32_u16 v226, v226, s39, v248 op_sel:[1,0,0,0]
    v_mad_u32_u16 v227, v227, s39, v248 op_sel:[1,0,0,0]
    v_fmac_f32 v245, v60, v172
    v_fmac_f32 v237, v53, v125
    v_mfma_f32_32x32x16_bf16 v[32:47], v[64:67], v[188:191], 0
    v_add_u32 v228, s51, v251
    ds_read2_b32 v[228:229], v228 offset0:1 offset1:3
    v_fmac_f32 v245, v61, v173
    v_fmac_f32 v237, v54, v126
    v_fmac_f32 v245, v62, v174
    v_fmac_f32 v237, v55, v127
    v_fmac_f32 v245, v63, v175
    v_mfma_f32_32x32x16_bf16 v[48:63], v[68:71], v[188:191], 0
    v_permlane32_swap_b32 v242, v234
    v_permlane32_swap_b32 v243, v235
    v_add_f32 v242, v242, v234
    v_add_f32 v243, v243, v235
    s_waitcnt vmcnt(4) lgkmcnt(1)
    v_mfma_f32_32x32x16_bf16 v[0:15], v[72:75], v[176:179], v[0:15]
    ds_read_b64_tr_b16 v[184:185], v246 offset:6144
    ds_read_b64_tr_b16 v[186:187], v246 offset:7168
    ds_read_b64_tr_b16 v[188:189], v247 offset:6144
    ds_read_b64_tr_b16 v[190:191], v247 offset:7168
    v_cvt_pk_bf16_f32 v242, v242, v243
    ds_write_b32 v230, v242 offset:512
    s_mov_b32 m0, s70
    v_mfma_f32_32x32x16_bf16 v[16:31], v[76:79], v[176:179], v[16:31]
    buffer_load_dwordx4 v226, s[4:7], s46 offen sc1 lds
    buffer_load_dwordx4 v227, s[72:75], s46 offen offset:1024 sc1 lds
    s_waitcnt lgkmcnt(5)
    v_mad_u32_u16 v228, v228, s39, v248 op_sel:[1,0,0,0]
    v_mad_u32_u16 v229, v229, s39, v248 op_sel:[1,0,0,0]
    s_sub_u32 s26, s48, s29
    s_mov_b32 s29, s48
    v_mfma_f32_32x32x16_bf16 v[32:47], v[72:75], v[180:183], v[32:47]
    s_mov_b32 s30, s3
    s_bfe_u32 s56, s3, 0x40012
    s_cmp_lg_u32 s36, 0
    s_cselect_b32 s56, s56, 0
    s_mov_b32 s32, s31
    s_mov_b32 s31, s35
    v_mfma_f32_32x32x16_bf16 v[48:63], v[76:79], v[180:183], v[48:63]
    s_waitcnt vmcnt(4) lgkmcnt(1)
    v_mfma_f32_32x32x16_bf16 v[0:15], v[80:83], v[184:187], v[0:15]
    ds_read_b64_tr_b16 v[176:177], v246 offset:0
    ds_read_b64_tr_b16 v[178:179], v246 offset:1024
    ds_read_b64_tr_b16 v[180:181], v247 offset:0
    ds_read_b64_tr_b16 v[182:183], v247 offset:1024
    s_mov_b32 m0, s71
    v_mfma_f32_32x32x16_bf16 v[16:31], v[84:87], v[184:187], v[16:31]
    buffer_load_dwordx4 v228, s[4:7], s47 offen sc1 lds
    buffer_load_dwordx4 v229, s[72:75], s47 offen offset:1024 sc1 lds
    v_mfma_f32_32x32x16_bf16 v[32:47], v[80:83], v[188:191], v[32:47]
    s_nop 2
    v_mul_f32 v242, v0, v144
    v_fma_f32 v240, v8, v160, -v240
    v_fmac_f32 v242, v1, v145
    v_fmac_f32 v240, v9, v161
    v_fmac_f32 v242, v2, v146
    v_fmac_f32 v240, v10, v162
    v_fmac_f32 v242, v3, v147
    v_mfma_f32_32x32x16_bf16 v[48:63], v[84:87], v[188:191], v[48:63]
    s_setprio 0
    v_fmac_f32 v240, v11, v163
    v_fmac_f32 v242, v4, v148
    v_fmac_f32 v240, v12, v164
    v_fmac_f32 v242, v5, v149
    v_fmac_f32 v240, v13, v165
    v_fmac_f32 v242, v6, v150
    v_fmac_f32 v240, v14, v166
    v_fmac_f32 v242, v7, v151
    v_fmac_f32 v240, v15, v167
    v_add_u32 v249, s26, v249
    v_add_u32 v250, s26, v250
    v_fma_f32 v244, v16, v160, -v244
    v_fmac_f32 v236, v24, v112
    v_fmac_f32 v244, v17, v161
    v_fmac_f32 v236, v25, v113
    v_fmac_f32 v244, v18, v162
    v_fmac_f32 v236, v26, v114
    v_fmac_f32 v244, v19, v163
    v_fmac_f32 v236, v27, v115
    v_fmac_f32 v244, v20, v164
    v_fmac_f32 v236, v28, v116
    v_fmac_f32 v244, v21, v165
    v_fmac_f32 v236, v29, v117
    v_fmac_f32 v244, v22, v166
    v_fmac_f32 v236, v30, v118
    v_fmac_f32 v244, v23, v167
    v_fmac_f32 v236, v31, v119
    ds_read_b64_tr_b16 v[0:1], v249 offset:0
    ds_read_b64_tr_b16 v[2:3], v249 offset:32
    ds_read_u16_d16_hi v16, v250 offset:0
    v_mul_f32 v243, v32, v152
    v_fma_f32 v241, v40, v168, -v241
    v_fmac_f32 v243, v33, v153
    v_fmac_f32 v241, v41, v169
    v_fmac_f32 v243, v34, v154
    v_fmac_f32 v241, v42, v170
    v_fmac_f32 v243, v35, v155
    v_fmac_f32 v241, v43, v171
    v_fmac_f32 v243, v36, v156
    v_fmac_f32 v241, v44, v172
    v_fmac_f32 v243, v37, v157
    v_fmac_f32 v241, v45, v173
    v_fmac_f32 v243, v38, v158
    v_fmac_f32 v241, v46, v174
    v_fmac_f32 v243, v39, v159
    v_fmac_f32 v241, v47, v175
    ds_read_b64_tr_b16 v[4:5], v249 offset:512
    ds_read_b64_tr_b16 v[6:7], v249 offset:544
    ds_read_u16_d16_hi v17, v250 offset:128
    v_fma_f32 v245, v48, v168, -v245
    v_fmac_f32 v237, v56, v120
    v_fmac_f32 v245, v49, v169
    v_fmac_f32 v237, v57, v121
    v_fmac_f32 v245, v50, v170
    v_fmac_f32 v237, v58, v122
    v_fmac_f32 v245, v51, v171
    v_fmac_f32 v237, v59, v123
    v_fmac_f32 v245, v52, v172
    v_fmac_f32 v237, v60, v124
    v_fmac_f32 v245, v53, v173
    v_fmac_f32 v237, v61, v125
    v_fmac_f32 v245, v54, v174
    v_fmac_f32 v237, v62, v126
    v_fmac_f32 v245, v55, v175
    v_fmac_f32 v237, v63, v127
    s_cmp_eq_u32 s56, 5
    s_cbranch_scc1 K2_U21
    s_cmp_eq_u32 s56, 6
    s_cbranch_scc1 K2_U3h1
    s_branch K2_DSP1
K2_PAD_SW:
    s_branch K2_HOP
K2_DSP0:
    s_cmp_eq_u32 s56, 4
    s_cbranch_scc1 K2_U20
    s_cmp_eq_u32 s56, 7
    s_cbranch_scc1 K2_U30
    s_cmp_gt_u32 s56, 7
    s_cbranch_scc1 K2_U40
    s_cmp_lg_u32 s56, 0
    s_cbranch_scc1 K2_U10
    s_branch K2_SWITCH
K2_DSP1:
    s_cmp_eq_u32 s56, 4
    s_cbranch_scc1 K2_U21
    s_cmp_eq_u32 s56, 7
    s_cbranch_scc1 K2_U31
    s_cmp_gt_u32 s56, 7
    s_cbranch_scc1 K2_U41
    s_cmp_lg_u32 s56, 0
    s_cbranch_scc1 K2_U11
    s_branch K2_TAIL
K2_SWITCH:
    v_lshlrev_b32 v60, 3, v252
    s_mov_b32 s64, 7176192
    buffer_load_dwordx4 v[56:59], v60, s[8:11], s64 offen sc1
    v_permlane32_swap_b32 v242, v236
    v_permlane32_swap_b32 v243, v237
    v_permlane32_swap_b32 v244, v238
    v_permlane32_swap_b32 v245, v239
    v_permlane32_swap_b32 v240, v241
    v_add_f32 v242, v242, v236
    v_add_f32 v243, v243, v237
    v_add_f32 v244, v244, v238
    v_add_f32 v245, v245, v239
    v_add_f32 v240, -v240, -v241
    s_set_gpr_idx_on s32, gpr_idx(DST)
    s_nop 0
    v_cvt_pk_bf16_f32 v195, v242, v243
    v_cvt_pk_bf16_f32 v196, v244, v245
    v_cvt_pk_bf16_f32 v197, v240, v240
    s_set_gpr_idx_off
    v_lshl_add_u32 v230, v252, 1, s35
    v_lshrrev_b32 v231, 6, v252
    v_mul_u32_u24 v231, 126, v231
    v_lshrrev_b32 v254, 6, v252
    v_bfe_u32 v255, v252, 3, 2
    v_lshl_add_u32 v254, v254, 2, v255
    v_mul_u32_u24 v254, 640, v254
    v_bfe_u32 v255, v252, 5, 1
    v_lshl_add_u32 v254, v255, 5, v254
    v_and_b32 v255, 6, v252
    v_lshl_add_u32 v254, v255, 2, v254
    v_add_u32 v254, 152832, v254
    ds_read_b64_tr_b16 v[104:105], v254 offset:0
    ds_read_b64_tr_b16 v[106:107], v254 offset:5120
    ds_read_b64_tr_b16 v[108:109], v254 offset:64
    ds_read_b64_tr_b16 v[110:111], v254 offset:5184
    ds_read_b64_tr_b16 v[120:121], v254 offset:128
    ds_read_b64_tr_b16 v[122:123], v254 offset:5248
    ds_read_b64_tr_b16 v[124:125], v254 offset:192
    ds_read_b64_tr_b16 v[126:127], v254 offset:5312
    ds_read_b64_tr_b16 v[136:137], v254 offset:256
    ds_read_b64_tr_b16 v[138:139], v254 offset:5376
    ds_read_b64_tr_b16 v[140:141], v254 offset:320
    ds_read_b64_tr_b16 v[142:143], v254 offset:5440
    ds_read_b64_tr_b16 v[152:153], v254 offset:384
    ds_read_b64_tr_b16 v[154:155], v254 offset:5504
    ds_read_b64_tr_b16 v[156:157], v254 offset:448
    ds_read_b64_tr_b16 v[158:159], v254 offset:5568
    ds_read_b64_tr_b16 v[168:169], v254 offset:512
    ds_read_b64_tr_b16 v[170:171], v254 offset:5632
    ds_read_b64_tr_b16 v[172:173], v254 offset:576
    ds_read_b64_tr_b16 v[174:175], v254 offset:5696
    s_movk_i32 s40, 128
    s_movk_i32 s41, 384
    s_movk_i32 s42, 640
    s_movk_i32 s43, 896
    s_waitcnt lgkmcnt(15)
    v_lshlrev_b32 v96, 16, v104
    v_and_b32 v97, 0xffff0000, v104
    v_lshlrev_b32 v98, 16, v105
    v_and_b32 v99, 0xffff0000, v105
    v_lshlrev_b32 v100, 16, v106
    v_and_b32 v101, 0xffff0000, v106
    v_lshlrev_b32 v102, 16, v107
    v_and_b32 v103, 0xffff0000, v107
    v_lshlrev_b32 v104, 16, v108
    v_and_b32 v105, 0xffff0000, v108
    v_lshlrev_b32 v106, 16, v109
    v_and_b32 v107, 0xffff0000, v109
    v_lshlrev_b32 v108, 16, v110
    v_and_b32 v109, 0xffff0000, v110
    v_lshlrev_b32 v110, 16, v111
    v_and_b32 v111, 0xffff0000, v111
    s_waitcnt lgkmcnt(12)
    v_lshlrev_b32 v112, 16, v120
    v_and_b32 v113, 0xffff0000, v120
    v_lshlrev_b32 v114, 16, v121
    v_and_b32 v115, 0xffff0000, v121
    v_lshlrev_b32 v116, 16, v122
    v_and_b32 v117, 0xffff0000, v122
    v_lshlrev_b32 v118, 16, v123
    v_and_b32 v119, 0xffff0000, v123
    v_lshlrev_b32 v120, 16, v124
    v_and_b32 v121, 0xffff0000, v124
    v_lshlrev_b32 v122, 16, v125
    v_and_b32 v123, 0xffff0000, v125
    v_lshlrev_b32 v124, 16, v126
    v_and_b32 v125, 0xffff0000, v126
    v_lshlrev_b32 v126, 16, v127
    v_and_b32 v127, 0xffff0000, v127
    s_waitcnt lgkmcnt(8)
    v_lshlrev_b32 v128, 16, v136
    v_and_b32 v129, 0xffff0000, v136
    v_lshlrev_b32 v130, 16, v137
    v_and_b32 v131, 0xffff0000, v137
    v_lshlrev_b32 v132, 16, v138
    v_and_b32 v133, 0xffff0000, v138
    v_lshlrev_b32 v134, 16, v139
    v_and_b32 v135, 0xffff0000, v139
    v_lshlrev_b32 v136, 16, v140
    v_and_b32 v137, 0xffff0000, v140
    v_lshlrev_b32 v138, 16, v141
    v_and_b32 v139, 0xffff0000, v141
    v_lshlrev_b32 v140, 16, v142
    v_and_b32 v141, 0xffff0000, v142
    v_lshlrev_b32 v142, 16, v143
    v_and_b32 v143, 0xffff0000, v143
    s_waitcnt lgkmcnt(4)
    v_lshlrev_b32 v144, 16, v152
    v_and_b32 v145, 0xffff0000, v152
    v_lshlrev_b32 v146, 16, v153
    v_and_b32 v147, 0xffff0000, v153
    v_lshlrev_b32 v148, 16, v154
    v_and_b32 v149, 0xffff0000, v154
    v_lshlrev_b32 v150, 16, v155
    v_and_b32 v151, 0xffff0000, v155
    v_lshlrev_b32 v152, 16, v156
    v_and_b32 v153, 0xffff0000, v156
    v_lshlrev_b32 v154, 16, v157
    v_and_b32 v155, 0xffff0000, v157
    v_lshlrev_b32 v156, 16, v158
    v_and_b32 v157, 0xffff0000, v158
    v_lshlrev_b32 v158, 16, v159
    v_and_b32 v159, 0xffff0000, v159
    s_waitcnt lgkmcnt(0)
    v_lshlrev_b32 v160, 16, v168
    v_and_b32 v161, 0xffff0000, v168
    v_lshlrev_b32 v162, 16, v169
    v_and_b32 v163, 0xffff0000, v169
    v_lshlrev_b32 v164, 16, v170
    v_and_b32 v165, 0xffff0000, v170
    v_lshlrev_b32 v166, 16, v171
    v_and_b32 v167, 0xffff0000, v171
    v_lshlrev_b32 v168, 16, v172
    v_and_b32 v169, 0xffff0000, v172
    v_lshlrev_b32 v170, 16, v173
    v_and_b32 v171, 0xffff0000, v173
    v_lshlrev_b32 v172, 16, v174
    v_and_b32 v173, 0xffff0000, v174
    v_lshlrev_b32 v174, 16, v175
    v_and_b32 v175, 0xffff0000, v175
K2_FLGW:
    s_or_b32 s58, s54, s20
    s_waitcnt vmcnt(0)
    v_xor_b32 v56, s2, v56
    v_xor_b32 v57, s2, v57
    v_xor_b32 v58, s2, v58
    v_xor_b32 v59, s2, v59
    v_or3_b32 v56, v56, v57, v58
    v_or_b32 v56, v56, v59
    v_cmp_ne_u32 vcc, 0, v56
    s_nop 0
    s_cbranch_vccnz K2_FLGR
    s_cmp_eq_u32 s58, 0
    s_cbranch_scc1 K2_FLGY
K2_FLGOK:
    s_cmp_eq_u32 s36, 0
    s_cbranch_scc1 K2_TAIL2
    s_mov_b32 s29, s48
    s_mov_b32 s32, s31
    s_mov_b32 s30, s3
    s_mov_b32 s31, s35
    s_bfe_u32 s56, s3, 0x40012
    s_cmp_eq_u32 s56, 5
    s_cbranch_scc1 K2_U21
    s_cmp_eq_u32 s56, 6
    s_cbranch_scc1 K2_U3h1
    s_branch K2_DSP1
K2_dum_4:
    v_mov_b32 v232, -1
    s_mov_b32 m0, 163312
    s_mov_b64 exec, 1
    buffer_load_dwordx4 v232, s[16:19], 0 offen lds
    buffer_load_dwordx4 v232, s[16:19], 0 offen lds
    s_mov_b64 exec, -1
    s_branch K2_back_6
K2_nul_10:
    s_mov_b32 s58, 63
    s_mov_b32 s36, 0
    s_branch K2_back_13
K2_spin_11:
    s_sub_u32 s27, s27, 1
    s_cbranch_scc1 K2_END
    v_lshl_add_u32 v233, v252, 1, s53
    ds_read_b32 v233, v233
    s_waitcnt lgkmcnt(0)
    s_branch K2_chk_12
K2_dyn_8:
    v_mov_b32 v254, 163296
    v_mov_b32 v255, 1
    v_lshl_add_u32 v233, v252, 1, s53
    s_mov_b64 exec, 1
    ds_add_rtn_u32 v232, v254, v255
    s_mov_b64 exec, -1
    ds_read_b32 v233, v233
    s_waitcnt lgkmcnt(0)
    v_readfirstlane_b32 s58, v232
    s_nop 0
    s_cmp_lt_u32 s58, s22
    s_cbranch_scc0 K2_nul_10
    s_and_b32 s59, s58, 7
    s_lshr_b32 s60, s58, 3
K2_chk_12:
    v_readlane_b32 s61, v233, s59
    s_nop 0
    s_cmp_gt_u32 s61, s60
    s_cbranch_scc0 K2_spin_11
K2_back_13:
    s_mov_b32 s34, 1
    s_branch K2_back_9
K2_dum_17:
    v_mov_b32 v232, -1
    s_mov_b32 m0, 163312
    s_mov_b64 exec, 1
    buffer_load_dwordx4 v232, s[16:19], 0 offen lds
    buffer_load_dwordx4 v232, s[16:19], 0 offen lds
    s_mov_b64 exec, -1
    s_branch K2_back_19
K2_nul_23:
    s_mov_b32 s58, 63
    s_mov_b32 s36, 0
    s_branch K2_back_26
K2_spin_24:
    s_sub_u32 s27, s27, 1
    s_cbranch_scc1 K2_END
    v_lshl_add_u32 v233, v252, 1, s53
    ds_read_b32 v233, v233
    s_waitcnt lgkmcnt(0)
    s_branch K2_chk_25
K2_dyn_21:
    v_mov_b32 v254, 163296
    v_mov_b32 v255, 1
    v_lshl_add_u32 v233, v252, 1, s53
    s_mov_b64 exec, 1
    ds_add_rtn_u32 v232, v254, v255
    s_mov_b64 exec, -1
    ds_read_b32 v233, v233
    s_waitcnt lgkmcnt(0)
    v_readfirstlane_b32 s58, v232
    s_nop 0
    s_cmp_lt_u32 s58, s22
    s_cbranch_scc0 K2_nul_23
    s_and_b32 s59, s58, 7
    s_lshr_b32 s60, s58, 3
K2_chk_25:
    v_readlane_b32 s61, v233, s59
    s_nop 0
    s_cmp_gt_u32 s61, s60
    s_cbranch_scc0 K2_spin_24
K2_back_26:
    s_mov_b32 s34, 1
    s_branch K2_back_22
K2_dum_30:
    v_mov_b32 v232, -1
    s_mov_b32 m0, 163312
    s_mov_b64 exec, 1
    buffer_load_dwordx4 v232, s[16:19], 0 offen lds
    buffer_load_dwordx4 v232, s[16:19], 0 offen lds
    s_mov_b64 exec, -1
    s_branch K2_back_32
K2_nul_36:
    s_mov_b32 s58, 63
    s_mov_b32 s36, 0
    s_branch K2_back_39
K2_spin_37:
    s_sub_u32 s27, s27, 1
    s_cbranch_scc1 K2_END
    v_lshl_add_u32 v233, v252, 1, s53
    ds_read_b32 v233, v233
    s_waitcnt lgkmcnt(0)
    s_branch K2_chk_38
K2_dyn_34:
    v_mov_b32 v254, 163296
    v_mov_b32 v255, 1
    v_lshl_add_u32 v233, v252, 1, s53
    s_mov_b64 exec, 1
    ds_add_rtn_u32 v232, v254, v255
    s_mov_b64 exec, -1
    ds_read_b32 v233, v233
    s_waitcnt lgkmcnt(0)
    v_readfirstlane_b32 s58, v232
    s_nop 0
    s_cmp_lt_u32 s58, s22
    s_cbranch_scc0 K2_nul_36
    s_and_b32 s59, s58, 7
    s_lshr_b32 s60, s58, 3
K2_chk_38:
    v_readlane_b32 s61, v233, s59
    s_nop 0
    s_cmp_gt_u32 s61, s60
    s_cbranch_scc0 K2_spin_37
K2_back_39:
    s_mov_b32 s34, 1
    s_branch K2_back_35
K2_dum_43:
    v_mov_b32 v232, -1
    s_mov_b32 m0, 163312
    s_mov_b64 exec, 1
    buffer_load_dwordx4 v232, s[16:19], 0 offen lds
    buffer_load_dwordx4 v232, s[16:19], 0 offen lds
    s_mov_b64 exec, -1
    s_branch K2_back_45
K2_nul_47:
    s_mov_b32 s58, 63
    s_mov_b32 s36, 0
    s_branch K2_back_50
K2_spin_48:
    s_sub_u32 s27, s27, 1
    s_cbranch_scc1 K2_END
    v_lshl_add_u32 v233, v252, 1, s53
    ds_read_b32 v233, v233
    s_waitcnt lgkmcnt(0)
    s_branch K2_chk_49
K2_nul_54:
    s_mov_b32 s58, 63
    s_mov_b32 s36, 0
    s_branch K2_back_57
K2_spin_55:
    s_sub_u32 s27, s27, 1
    s_cbranch_scc1 K2_END
    v_lshl_add_u32 v233, v252, 1, s53
    ds_read_b32 v233, v233
    s_waitcnt lgkmcnt(0)
    s_branch K2_chk_56
K2_nul_61:
    s_mov_b32 s58, 63
    s_mov_b32 s36, 0
    s_branch K2_back_64
K2_spin_62:
    s_sub_u32 s27, s27, 1
    s_cbranch_scc1 K2_END
    v_lshl_add_u32 v233, v252, 1, s53
    ds_read_b32 v233, v233
    s_waitcnt lgkmcnt(0)
    s_branch K2_chk_63
K2_PAD_TL:
    s_branch K2_HOP
K2_TAIL2:
    v_lshlrev_b32 v229, 3, v252
    s_mul_i32 s58, s20, 20480
    s_add_u32 s58, s58, 6946816
    s_mul_i32 s59, s20, 8224
    buffer_load_dwordx4 v[96:99], v229, s[8:11], s58 offen offset:0 sc1
    buffer_load_dwordx4 v[100:103], v229, s[8:11], s58 offen offset:1024 sc1
    buffer_load_dwordx4 v[104:107], v229, s[8:11], s58 offen offset:2048 sc1
    buffer_load_dwordx4 v[108:111], v229, s[8:11], s58 offen offset:3072 sc1
    s_add_u32 s58, s58, 4096
    buffer_load_dwordx4 v[128:131], v229, s[8:11], s58 offen offset:0 sc1
    buffer_load_dwordx4 v[132:135], v229, s[8:11], s58 offen offset:1024 sc1
    buffer_load_dwordx4 v[136:139], v229, s[8:11], s58 offen offset:2048 sc1
    buffer_load_dwordx4 v[140:143], v229, s[8:11], s58 offen offset:3072 sc1
    v_lshl_add_u32 v228, v252, 1, s59
    v_lshrrev_b32 v226, 6, v252
    v_mul_u32_u24 v226, 126, v226
    v_sub_u32 v226, v228, v226
    s_branch K2_TAIL3
K2_TAIL:
    v_lshlrev_b32 v229, 3, v252
    s_mul_i32 s58, s20, 20480
    s_add_u32 s58, s58, 6946816
    s_mul_i32 s59, s20, 8224
    buffer_load_dwordx4 v[96:99], v229, s[8:11], s58 offen offset:0 sc1
    v_permlane32_swap_b32 v242, v236
    v_permlane32_swap_b32 v243, v237
    v_permlane32_swap_b32 v244, v238
    buffer_load_dwordx4 v[100:103], v229, s[8:11], s58 offen offset:1024 sc1
    v_permlane32_swap_b32 v245, v239
    v_permlane32_swap_b32 v240, v241
    v_add_f32 v242, v242, v236
    buffer_load_dwordx4 v[104:107], v229, s[8:11], s58 offen offset:2048 sc1
    v_add_f32 v243, v243, v237
    v_add_f32 v244, v244, v238
    v_add_f32 v245, v245, v239
    buffer_load_dwordx4 v[108:111], v229, s[8:11], s58 offen offset:3072 sc1
    v_add_f32 v240, -v240, -v241
    v_sub_u32 v241, v230, v231
    v_cvt_pk_bf16_f32 v242, v242, v243
    s_add_u32 s58, s58, 4096
    buffer_load_dwordx4 v[128:131], v229, s[8:11], s58 offen offset:0 sc1
    v_cvt_pk_bf16_f32 v244, v244, v245
    v_cvt_pk_bf16_f32 v240, v240, v240
    ds_write_b32 v230, v242 offset:768
    buffer_load_dwordx4 v[132:135], v229, s[8:11], s58 offen offset:1024 sc1
    ds_write_b32 v230, v244 offset:1024
    ds_write_b16 v241, v240 offset:1280
    v_lshl_add_u32 v228, v252, 1, s59
    buffer_load_dwordx4 v[136:139], v229, s[8:11], s58 offen offset:2048 sc1
    v_lshrrev_b32 v226, 6, v252
    v_mul_u32_u24 v226, 126, v226
    v_sub_u32 v226, v228, v226
    buffer_load_dwordx4 v[140:143], v229, s[8:11], s58 offen offset:3072 sc1
K2_TAIL3:
    s_waitcnt vmcnt(8)
    ds_write2st64_b32 v228, v192, v193 offset0:0 offset1:1
    ds_write2st64_b32 v228, v194, v195 offset0:2 offset1:3
    s_add_u32 s58, s58, 4096
    buffer_load_dwordx4 v[112:115], v229, s[8:11], s58 offen offset:0 sc1
    v_bfe_u32 v48, v252, 1, 4
    v_lshrrev_b32 v49, 5, v252
    ds_write_b16 v226, v197 offset:1280
    ds_write2st64_b32 v228, v196, v198 offset0:4 offset1:6
    buffer_load_dwordx4 v[116:119], v229, s[8:11], s58 offen offset:1024 sc1
    v_lshrrev_b32 v55, 3, v48
    v_lshlrev_b32 v52, 4, v49
    ds_write2st64_b32 v228, v199, v200 offset0:7 offset1:8
    ds_write2st64_b32 v228, v201, v202 offset0:9 offset1:10
    buffer_load_dwordx4 v[120:123], v229, s[8:11], s58 offen offset:2048 sc1
    v_lshl_add_u32 v54, v55, 2, v48
    v_and_b32 v54, 7, v54
    ds_write_b16 v226, v203 offset:2816
    ds_write2st64_b32 v228, v204, v205 offset0:12 offset1:13
    buffer_load_dwordx4 v[124:127], v229, s[8:11], s58 offen offset:3072 sc1
    v_and_b32 v50, 7, v48
    v_mul_u32_u24 v50, 8224, v50
    ds_write2st64_b32 v228, v206, v207 offset0:14 offset1:15
    ds_write2st64_b32 v228, v208, v210 offset0:16 offset1:18
    s_add_u32 s58, s58, 4096
    buffer_load_dwordx4 v[144:147], v229, s[8:11], s58 offen offset:0 sc1
    v_mul_u32_u24 v51, 1536, v55
    v_add_u32 v50, v50, v51
    ds_write_b16 v226, v209 offset:4352
    ds_write2st64_b32 v228, v211, v212 offset0:19 offset1:20
    buffer_load_dwordx4 v[148:151], v229, s[8:11], s58 offen offset:1024 sc1
    v_add_u32 v222, v50, v52
    v_mul_u32_u24 v51, 8224, v54
    ds_write2st64_b32 v228, v213, v214 offset0:21 offset1:22
    ds_write2st64_b32 v228, v216, v217 offset0:24 offset1:25
    buffer_load_dwordx4 v[152:155], v229, s[8:11], s58 offen offset:2048 sc1
    v_add_u32 v232, v51, v52
    v_lshl_add_u32 v247, v55, 7, v232
    ds_write_b16 v226, v215 offset:5888
    ds_write2st64_b32 v228, v218, v219 offset0:26 offset1:27
    buffer_load_dwordx4 v[156:159], v229, s[8:11], s58 offen offset:3072 sc1
    v_mul_u32_u24 v51, 2080, v48
    s_mov_b32 s60, 65536
    ds_write_b32 v228, v220 offset:7168
    ds_write_b16 v226, v221 offset:7424
    s_add_u32 s58, s58, 4096
    buffer_load_dwordx4 v[160:163], v229, s[8:11], s58 offen offset:0 sc1
    v_add3_u32 v223, v51, v52, s60
    v_mul_u32_u24 v51, 2080, v54
    buffer_load_dwordx4 v[164:167], v229, s[8:11], s58 offen offset:1024 sc1
    s_mov_b32 s60, 132096
    v_add3_u32 v225, v51, v52, s60
    buffer_load_dwordx4 v[168:171], v229, s[8:11], s58 offen offset:2048 sc1
    v_lshl_add_u32 v248, v55, 7, v225
    s_lshl_b32 s60, s20, 5
    buffer_load_dwordx4 v[172:175], v229, s[8:11], s58 offen offset:3072 sc1
    v_lshl_add_u32 v49, v49, 3, s60
    s_mov_b32 s60, 65536
    v_add3_u32 v255, v51, v49, s60
    v_lshl_add_u32 v246, v55, 9, v255
    v_bfe_u32 v53, v48, 2, 1
    v_lshl_add_u32 v49, v53, 4, v49
    v_add_u32 v254, v50, v49
    s_and_b32 s64, s55, s28
    s_waitcnt lgkmcnt(0)
    s_barrier
    s_cmp_eq_u32 s64, 0
    s_cbranch_scc1 K2_MULTI
    s_setprio 3
    ds_read_b128 v[48:51], v222 offset:0
    ds_read_b128 v[52:55], v222 offset:64
    ds_read_b128 v[56:59], v222 offset:896
    ds_read_b128 v[60:63], v222 offset:960
    ds_read_b128 v[64:67], v223 offset:0
    ds_read_b128 v[68:71], v223 offset:64
    ds_read_b128 v[72:75], v223 offset:896
    ds_read_b128 v[76:79], v223 offset:960
    ds_read_b128 v[80:83], v222 offset:3072
    ds_read_b128 v[84:87], v222 offset:3136
    ds_read_b128 v[88:91], v222 offset:3968
    s_waitcnt vmcnt(19) lgkmcnt(9)
    v_mfma_f32_16x16x32_bf16 v[0:3], v[96:99], v[48:51], 0
    ds_read_b128 v[92:95], v222 offset:4032
    s_waitcnt vmcnt(18)
    v_mfma_f32_16x16x32_bf16 v[0:3], v[100:103], v[52:55], v[0:3]
    ds_read_b128 v[48:51], v223 offset:33280
    s_waitcnt vmcnt(17) lgkmcnt(9)
    v_mfma_f32_16x16x32_bf16 v[0:3], v[104:107], v[56:59], v[0:3]
    s_bfe_u32 s60, s20, 0x10002
    s_lshl_b32 s60, s60, 4
    ds_read_b128 v[52:55], v223 offset:33344
    s_waitcnt vmcnt(16)
    v_mfma_f32_16x16x32_bf16 v[0:3], v[108:111], v[60:63], v[0:3]
    s_add_u32 s59, s59, s60
    v_add_u32 v228, s59, v229
    ds_read_b128 v[56:59], v223 offset:34176
    s_waitcnt vmcnt(15) lgkmcnt(9)
    v_mfma_f32_16x16x32_bf16 v[0:3], v[128:131], v[64:67], v[0:3]
    s_mul_i32 s60, s20, 2080
    s_add_u32 s60, s60, 65536
    ds_read_b128 v[60:63], v223 offset:34240
    s_waitcnt vmcnt(14)
    v_mfma_f32_16x16x32_bf16 v[0:3], v[132:135], v[68:71], v[0:3]
    v_add_u32 v249, s60, v229
    s_mov_b32 s63, 0xbfb8aa3b
    ds_read_b128 v[64:67], v232 offset:6144
    s_waitcnt vmcnt(13) lgkmcnt(9)
    v_mfma_f32_16x16x32_bf16 v[0:3], v[136:139], v[72:75], v[0:3]
    s_add_u32 s40, s20, s21
    s_lshl_b32 s40, s40, 10
    ds_read_b128 v[68:71], v232 offset:6208
    s_waitcnt vmcnt(12)
    v_mfma_f32_16x16x32_bf16 v[0:3], v[140:143], v[76:79], v[0:3]
    s_add_u32 s41, s40, 8192
    s_add_u32 s42, s40, 16384
    ds_read_b128 v[72:75], v232 offset:7040
    s_waitcnt lgkmcnt(9)
    v_mfma_f32_16x16x32_bf16 v[16:19], v[96:99], v[80:83], 0
    s_add_u32 s43, s40, 24576
    s_add_u32 s44, s40, 32768
    ds_read_b128 v[76:79], v232 offset:7104
    v_mfma_f32_16x16x32_bf16 v[16:19], v[100:103], v[84:87], v[16:19]
    ds_read_b128 v[80:83], v225 offset:0
    s_waitcnt lgkmcnt(9)
    v_mfma_f32_16x16x32_bf16 v[16:19], v[104:107], v[88:91], v[16:19]
    ds_read_b128 v[84:87], v225 offset:64
    v_mfma_f32_16x16x32_bf16 v[16:19], v[108:111], v[92:95], v[16:19]
    v_mul_f32 v204, s63, v0
    v_mul_f32 v205, s63, v1
    ds_read_b128 v[88:91], v225 offset:896
    s_waitcnt lgkmcnt(9)
    v_mfma_f32_16x16x32_bf16 v[16:19], v[128:131], v[48:51], v[16:19]
    v_mul_f32 v206, s63, v2
    ds_read_b128 v[92:95], v225 offset:960
    v_mfma_f32_16x16x32_bf16 v[16:19], v[132:135], v[52:55], v[16:19]
    v_mul_f32 v207, s63, v3
    ds_read_b128 v[48:51], v222 offset:128
    s_waitcnt lgkmcnt(9)
    v_mfma_f32_16x16x32_bf16 v[16:19], v[136:139], v[56:59], v[16:19]
    v_exp_f32 v204, v204
    ds_read_b128 v[52:55], v222 offset:384
    v_mfma_f32_16x16x32_bf16 v[16:19], v[140:143], v[60:63], v[16:19]
    v_exp_f32 v205, v205
    ds_read_b128 v[56:59], v222 offset:256
    s_waitcnt lgkmcnt(9)
    v_mfma_f32_16x16x32_bf16 v[32:35], v[96:99], v[64:67], 0
    v_exp_f32 v206, v206
    ds_read_b128 v[60:63], v222 offset:192
    v_mfma_f32_16x16x32_bf16 v[32:35], v[100:103], v[68:71], v[32:35]
    v_exp_f32 v207, v207
    s_setprio 2
    ds_read_b128 v[64:67], v222 offset:448
    s_waitcnt lgkmcnt(9)
    v_mfma_f32_16x16x32_bf16 v[32:35], v[104:107], v[72:75], v[32:35]
    v_add_f32 v204, 1.0, v204
    ds_read_b128 v[68:71], v222 offset:320
    v_mfma_f32_16x16x32_bf16 v[32:35], v[108:111], v[76:79], v[32:35]
    v_add_f32 v205, 1.0, v205
    v_add_f32 v206, 1.0, v206
    ds_read_b128 v[72:75], v222 offset:640
    s_waitcnt lgkmcnt(9)
    v_mfma_f32_16x16x32_bf16 v[32:35], v[128:131], v[80:83], v[32:35]
    v_add_f32 v207, 1.0, v207
    ds_read_b128 v[76:79], v222 offset:512
    v_mfma_f32_16x16x32_bf16 v[32:35], v[132:135], v[84:87], v[32:35]
    v_rcp_f32 v204, v204
    ds_read_b128 v[80:83], v222 offset:768
    s_waitcnt lgkmcnt(9)
    v_mfma_f32_16x16x32_bf16 v[32:35], v[136:139], v[88:91], v[32:35]
    v_rcp_f32 v205, v205
    ds_read_b128 v[84:87], v222 offset:704
    v_mfma_f32_16x16x32_bf16 v[32:35], v[140:143], v[92:95], v[32:35]
    v_rcp_f32 v206, v206
    ds_read_b128 v[88:91], v222 offset:576
    s_waitcnt vmcnt(11) lgkmcnt(9)
    v_mfma_f32_16x16x32_bf16 v[4:7], v[112:115], v[48:51], 0
    v_rcp_f32 v207, v207
    ds_read_b128 v[92:95], v222 offset:832
    v_mfma_f32_16x16x32_bf16 v[8:11], v[112:115], v[52:55], 0
    v_cvt_pk_bf16_f32 v176, v0, v1
    ds_read_b128 v[48:51], v222 offset:1024
    s_waitcnt lgkmcnt(9)
    v_mfma_f32_16x16x32_bf16 v[12:15], v[112:115], v[56:59], 0
    v_cvt_pk_bf16_f32 v177, v2, v3
    ds_read_b128 v[52:55], v222 offset:1280
    s_waitcnt vmcnt(10)
    v_mfma_f32_16x16x32_bf16 v[4:7], v[116:119], v[60:63], v[4:7]
    v_mul_f32 v208, s63, v16
    v_mul_f32 v209, s63, v17
    ds_read_b128 v[56:59], v222 offset:1152
    s_waitcnt lgkmcnt(9)
    v_mfma_f32_16x16x32_bf16 v[8:11], v[116:119], v[64:67], v[8:11]
    v_mul_f32 v210, s63, v18
    ds_read_b128 v[60:63], v222 offset:1088
    v_mfma_f32_16x16x32_bf16 v[12:15], v[116:119], v[68:71], v[12:15]
    v_mul_f32 v211, s63, v19
    ds_read_b128 v[64:67], v222 offset:1344
    s_waitcnt vmcnt(9) lgkmcnt(9)
    v_mfma_f32_16x16x32_bf16 v[4:7], v[120:123], v[72:75], v[4:7]
    v_exp_f32 v208, v208
    ds_read_b128 v[68:71], v222 offset:1216
    v_mfma_f32_16x16x32_bf16 v[8:11], v[120:123], v[76:79], v[8:11]
    v_exp_f32 v209, v209
    ds_read_b128 v[72:75], v223 offset:128
    s_waitcnt lgkmcnt(9)
    v_mfma_f32_16x16x32_bf16 v[12:15], v[120:123], v[80:83], v[12:15]
    v_exp_f32 v210, v210
    ds_read_b128 v[76:79], v223 offset:384
    s_waitcnt vmcnt(8)
    v_mfma_f32_16x16x32_bf16 v[4:7], v[124:127], v[84:87], v[4:7]
    v_exp_f32 v211, v211
    ds_read_b128 v[80:83], v223 offset:256
    s_waitcnt lgkmcnt(9)
    v_mfma_f32_16x16x32_bf16 v[8:11], v[124:127], v[88:91], v[8:11]
    v_add_f32 v208, 1.0, v208
    ds_read_b128 v[84:87], v223 offset:192
    v_mfma_f32_16x16x32_bf16 v[12:15], v[124:127], v[92:95], v[12:15]
    v_add_f32 v209, 1.0, v209
    v_add_f32 v210, 1.0, v210
    ds_read_b128 v[88:91], v223 offset:448
    s_waitcnt vmcnt(7) lgkmcnt(9)
    v_mfma_f32_16x16x32_bf16 v[4:7], v[144:147], v[48:51], v[4:7]
    v_add_f32 v211, 1.0, v211
    s_setprio 1
    ds_read_b128 v[92:95], v223 offset:320
    v_mfma_f32_16x16x32_bf16 v[8:11], v[144:147], v[52:55], v[8:11]
    v_rcp_f32 v208, v208
    ds_read_b128 v[48:51], v223 offset:640
    s_waitcnt lgkmcnt(9)
    v_mfma_f32_16x16x32_bf16 v[12:15], v[144:147], v[56:59], v[12:15]
    v_rcp_f32 v209, v209
    ds_read_b128 v[52:55], v223 offset:512
    s_waitcnt vmcnt(6)
    v_mfma_f32_16x16x32_bf16 v[4:7], v[148:151], v[60:63], v[4:7]
    v_rcp_f32 v210, v210
    ds_read_b128 v[56:59], v223 offset:768
    s_waitcnt lgkmcnt(9)
    v_mfma_f32_16x16x32_bf16 v[8:11], v[148:151], v[64:67], v[8:11]
    v_rcp_f32 v211, v211
    ds_read_b128 v[60:63], v223 offset:704
    v_mfma_f32_16x16x32_bf16 v[12:15], v[148:151], v[68:71], v[12:15]
K2_PAD_T2:
    s_cbranch_execz K2_HOP
    v_cvt_pk_bf16_f32 v184, v16, v17
    ds_read_b128 v[64:67], v223 offset:576
    s_waitcnt vmcnt(5) lgkmcnt(9)
    v_mfma_f32_16x16x32_bf16 v[4:7], v[152:155], v[72:75], v[4:7]
    v_cvt_pk_bf16_f32 v185, v18, v19
    ds_read_b128 v[68:71], v223 offset:832
    v_mfma_f32_16x16x32_bf16 v[8:11], v[152:155], v[76:79], v[8:11]
    v_mul_f32 v212, s63, v32
    v_mul_f32 v213, s63, v33
    ds_read_b128 v[72:75], v223 offset:1024
    s_waitcnt lgkmcnt(9)
    v_mfma_f32_16x16x32_bf16 v[12:15], v[152:155], v[80:83], v[12:15]
    v_mul_f32 v214, s63, v34
    ds_read_b128 v[76:79], v223 offset:1280
    s_waitcnt vmcnt(4)
    v_mfma_f32_16x16x32_bf16 v[4:7], v[156:159], v[84:87], v[4:7]
    v_mul_f32 v215, s63, v35
    ds_read_b128 v[80:83], v223 offset:1152
    s_waitcnt lgkmcnt(9)
    v_mfma_f32_16x16x32_bf16 v[8:11], v[156:159], v[88:91], v[8:11]
    v_exp_f32 v212, v212
    ds_read_b128 v[84:87], v223 offset:1088
    v_mfma_f32_16x16x32_bf16 v[12:15], v[156:159], v[92:95], v[12:15]
    v_exp_f32 v213, v213
    ds_read_b128 v[88:91], v223 offset:1344
    s_waitcnt vmcnt(3) lgkmcnt(9)
    v_mfma_f32_16x16x32_bf16 v[4:7], v[160:163], v[48:51], v[4:7]
    v_exp_f32 v214, v214
    ds_read_b128 v[92:95], v223 offset:1216
    v_mfma_f32_16x16x32_bf16 v[8:11], v[160:163], v[52:55], v[8:11]
    v_exp_f32 v215, v215
    ds_read_b128 v[48:51], v222 offset:3200
    s_waitcnt lgkmcnt(9)
    v_mfma_f32_16x16x32_bf16 v[12:15], v[160:163], v[56:59], v[12:15]
    v_add_f32 v212, 1.0, v212
    ds_read_b128 v[52:55], v222 offset:3456
    s_waitcnt vmcnt(2)
    v_mfma_f32_16x16x32_bf16 v[4:7], v[164:167], v[60:63], v[4:7]
    v_add_f32 v213, 1.0, v213
    v_add_f32 v214, 1.0, v214
    ds_read_b128 v[56:59], v222 offset:3328
    s_waitcnt lgkmcnt(9)
    v_mfma_f32_16x16x32_bf16 v[8:11], v[164:167], v[64:67], v[8:11]
    v_add_f32 v215, 1.0, v215
    ds_read_b128 v[60:63], v222 offset:3264
    v_mfma_f32_16x16x32_bf16 v[12:15], v[164:167], v[68:71], v[12:15]
    v_rcp_f32 v212, v212
    s_setprio 0
    ds_read_b128 v[64:67], v222 offset:3520
    s_waitcnt vmcnt(1) lgkmcnt(9)
    v_mfma_f32_16x16x32_bf16 v[4:7], v[168:171], v[72:75], v[4:7]
    v_rcp_f32 v213, v213
    ds_read_b128 v[68:71], v222 offset:3392
    v_mfma_f32_16x16x32_bf16 v[8:11], v[168:171], v[76:79], v[8:11]
    v_rcp_f32 v214, v214
    ds_read_b128 v[72:75], v222 offset:3712
    s_waitcnt lgkmcnt(9)
    v_mfma_f32_16x16x32_bf16 v[12:15], v[168:171], v[80:83], v[12:15]
    v_rcp_f32 v215, v215
    ds_read_b128 v[76:79], v222 offset:3584
    s_waitcnt vmcnt(0)
    v_mfma_f32_16x16x32_bf16 v[4:7], v[172:175], v[84:87], v[4:7]
    v_cvt_pk_bf16_f32 v220, v32, v33
    ds_read_b128 v[80:83], v222 offset:3840
    s_waitcnt lgkmcnt(9)
    v_mfma_f32_16x16x32_bf16 v[8:11], v[172:175], v[88:91], v[8:11]
    v_cvt_pk_bf16_f32 v221, v34, v35
    ds_read_b128 v[84:87], v222 offset:3776
    v_mfma_f32_16x16x32_bf16 v[12:15], v[172:175], v[92:95], v[12:15]
    ds_read_b128 v[88:91], v222 offset:3648
    s_waitcnt lgkmcnt(9)
    v_mfma_f32_16x16x32_bf16 v[20:23], v[112:115], v[48:51], 0
    ds_read_b128 v[92:95], v222 offset:3904
    v_mfma_f32_16x16x32_bf16 v[24:27], v[112:115], v[52:55], 0
    ds_read_b128 v[48:51], v222 offset:4096
    s_waitcnt lgkmcnt(9)
    v_mfma_f32_16x16x32_bf16 v[28:31], v[112:115], v[56:59], 0
    s_barrier
    s_setprio 3
    ds_read_b128 v[52:55], v222 offset:4352
    v_mfma_f32_16x16x32_bf16 v[20:23], v[116:119], v[60:63], v[20:23]
    v_mul_f32 v4, v4, v204
    ds_read_b128 v[56:59], v222 offset:4224
    s_waitcnt lgkmcnt(9)
    v_mfma_f32_16x16x32_bf16 v[24:27], v[116:119], v[64:67], v[24:27]
    v_mul_f32 v5, v5, v205
    ds_read_b128 v[60:63], v222 offset:4160
    v_mfma_f32_16x16x32_bf16 v[28:31], v[116:119], v[68:71], v[28:31]
    v_mul_f32 v6, v6, v206
    ds_read_b128 v[64:67], v222 offset:4416
    s_waitcnt lgkmcnt(9)
    v_mfma_f32_16x16x32_bf16 v[20:23], v[120:123], v[72:75], v[20:23]
    v_mul_f32 v7, v7, v207
    ds_read_b128 v[68:71], v222 offset:4288
    v_mfma_f32_16x16x32_bf16 v[24:27], v[120:123], v[76:79], v[24:27]
    v_cvt_pk_bf16_f32 v178, v4, v5
    ds_read_b128 v[72:75], v223 offset:33408
    s_waitcnt lgkmcnt(9)
    v_mfma_f32_16x16x32_bf16 v[28:31], v[120:123], v[80:83], v[28:31]
    v_cvt_pk_bf16_f32 v179, v6, v7
    ds_read_b128 v[76:79], v223 offset:33664
    v_mfma_f32_16x16x32_bf16 v[20:23], v[124:127], v[84:87], v[20:23]
    v_mul_f32 v8, v8, v204
    ds_read_b128 v[80:83], v223 offset:33536
    s_waitcnt lgkmcnt(9)
    v_mfma_f32_16x16x32_bf16 v[24:27], v[124:127], v[88:91], v[24:27]
    v_mul_f32 v9, v9, v205
    ds_read_b128 v[84:87], v223 offset:33472
    v_mfma_f32_16x16x32_bf16 v[28:31], v[124:127], v[92:95], v[28:31]
    v_mul_f32 v10, v10, v206
    ds_read_b128 v[88:91], v223 offset:33728
    s_waitcnt lgkmcnt(9)
    v_mfma_f32_16x16x32_bf16 v[20:23], v[144:147], v[48:51], v[20:23]
    v_mul_f32 v11, v11, v207
    s_setprio 2
    ds_read_b128 v[92:95], v223 offset:33600
    v_mfma_f32_16x16x32_bf16 v[24:27], v[144:147], v[52:55], v[24:27]
    v_cvt_pk_bf16_f32 v180, v8, v9
    ds_read_b128 v[48:51], v223 offset:33920
    s_waitcnt lgkmcnt(9)
    v_mfma_f32_16x16x32_bf16 v[28:31], v[144:147], v[56:59], v[28:31]
    v_cvt_pk_bf16_f32 v181, v10, v11
    ds_read_b128 v[52:55], v223 offset:33792
    v_mfma_f32_16x16x32_bf16 v[20:23], v[148:151], v[60:63], v[20:23]
    v_mul_f32 v12, v12, v204
    ds_read_b128 v[56:59], v223 offset:34048
    s_waitcnt lgkmcnt(9)
    v_mfma_f32_16x16x32_bf16 v[24:27], v[148:151], v[64:67], v[24:27]
    v_mul_f32 v13, v13, v205
    ds_read_b128 v[60:63], v223 offset:33984
    v_mfma_f32_16x16x32_bf16 v[28:31], v[148:151], v[68:71], v[28:31]
    v_mul_f32 v14, v14, v206
    ds_read_b128 v[64:67], v223 offset:33856
    s_waitcnt lgkmcnt(9)
    v_mfma_f32_16x16x32_bf16 v[20:23], v[152:155], v[72:75], v[20:23]
    v_mul_f32 v15, v15, v207
    ds_read_b128 v[68:71], v223 offset:34112
    v_mfma_f32_16x16x32_bf16 v[24:27], v[152:155], v[76:79], v[24:27]
    v_cvt_pk_bf16_f32 v182, v12, v13
    ds_read_b128 v[72:75], v223 offset:34304
    s_waitcnt lgkmcnt(9)
    v_mfma_f32_16x16x32_bf16 v[28:31], v[152:155], v[80:83], v[28:31]
    v_cvt_pk_bf16_f32 v183, v14, v15
    ds_read_b128 v[76:79], v223 offset:34560
    v_mfma_f32_16x16x32_bf16 v[20:23], v[156:159], v[84:87], v[20:23]
    ds_write_b64 v254, v[176:177] offset:0
    ds_write_b64 v254, v[178:179] offset:256
    ds_write_b64 v254, v[180:181] offset:512
    ds_write_b64 v254, v[182:183] offset:768
    ds_write_b64 v255, v[220:221] offset:0
    ds_read_b128 v[80:83], v223 offset:34432
    s_waitcnt lgkmcnt(14)
    v_mfma_f32_16x16x32_bf16 v[24:27], v[156:159], v[88:91], v[24:27]
    ds_read_b128 v[84:87], v223 offset:34368
    v_mfma_f32_16x16x32_bf16 v[28:31], v[156:159], v[92:95], v[28:31]
    s_setprio 1
    ds_read_b128 v[88:91], v223 offset:34624
    s_waitcnt lgkmcnt(14)
    v_mfma_f32_16x16x32_bf16 v[20:23], v[160:163], v[48:51], v[20:23]
    ds_read_b128 v[92:95], v223 offset:34496
    v_mfma_f32_16x16x32_bf16 v[24:27], v[160:163], v[52:55], v[24:27]
    ds_read_b128 v[48:51], v247 offset:6272
    s_waitcnt lgkmcnt(14)
    v_mfma_f32_16x16x32_bf16 v[28:31], v[160:163], v[56:59], v[28:31]
    ds_read_b128 v[52:55], v232 offset:6528
    v_mfma_f32_16x16x32_bf16 v[20:23], v[164:167], v[60:63], v[20:23]
    ds_read_b128 v[56:59], v247 offset:6336
    s_waitcnt lgkmcnt(14)
    v_mfma_f32_16x16x32_bf16 v[24:27], v[164:167], v[64:67], v[24:27]
    ds_read_b128 v[60:63], v232 offset:6592
    v_mfma_f32_16x16x32_bf16 v[28:31], v[164:167], v[68:71], v[28:31]
    ds_read_b128 v[64:67], v247 offset:6784
    s_waitcnt lgkmcnt(14)
    v_mfma_f32_16x16x32_bf16 v[20:23], v[168:171], v[72:75], v[20:23]
    ds_read_b128 v[68:71], v232 offset:6656
    v_mfma_f32_16x16x32_bf16 v[24:27], v[168:171], v[76:79], v[24:27]
    ds_read_b128 v[72:75], v247 offset:6848
    s_waitcnt lgkmcnt(9)
    v_mfma_f32_16x16x32_bf16 v[28:31], v[168:171], v[80:83], v[28:31]
    ds_read_b128 v[76:79], v232 offset:6720
    v_mfma_f32_16x16x32_bf16 v[20:23], v[172:175], v[84:87], v[20:23]
    s_setprio 0
    ds_read_b128 v[80:83], v247 offset:7168
    s_waitcnt lgkmcnt(9)
    v_mfma_f32_16x16x32_bf16 v[24:27], v[172:175], v[88:91], v[24:27]
    ds_read_b128 v[84:87], v232 offset:7424
    v_mfma_f32_16x16x32_bf16 v[28:31], v[172:175], v[92:95], v[28:31]
    ds_read_b128 v[88:91], v247 offset:7232
    s_waitcnt lgkmcnt(9)
    v_mfma_f32_16x16x32_bf16 v[36:39], v[112:115], v[48:51], 0
    ds_read_b128 v[92:95], v232 offset:7488
    v_mfma_f32_16x16x32_bf16 v[40:43], v[112:115], v[52:55], 0
    ds_read_b128 v[48:51], v248 offset:128
    s_waitcnt lgkmcnt(9)
    v_mfma_f32_16x16x32_bf16 v[36:39], v[116:119], v[56:59], v[36:39]
    s_barrier
    ds_read_b128 v[192:195], v228 offset:0
    ds_read_b128 v[196:199], v228 offset:1536
    s_setprio 3
    ds_read_b128 v[52:55], v225 offset:384
    v_mfma_f32_16x16x32_bf16 v[40:43], v[116:119], v[60:63], v[40:43]
    v_mul_f32 v20, v20, v208
    v_mul_f32 v21, v21, v209
    ds_read_b128 v[56:59], v248 offset:192
    s_waitcnt lgkmcnt(11)
    v_mfma_f32_16x16x32_bf16 v[36:39], v[120:123], v[64:67], v[36:39]
    v_mul_f32 v22, v22, v210
    ds_read_b128 v[60:63], v225 offset:448
    v_mfma_f32_16x16x32_bf16 v[40:43], v[120:123], v[68:71], v[40:43]
    v_mul_f32 v23, v23, v211
    ds_read_b128 v[64:67], v248 offset:640
    s_waitcnt lgkmcnt(11)
    v_mfma_f32_16x16x32_bf16 v[36:39], v[124:127], v[72:75], v[36:39]
    v_cvt_pk_bf16_f32 v186, v20, v21
    ds_read_b128 v[68:71], v225 offset:512
    v_mfma_f32_16x16x32_bf16 v[40:43], v[124:127], v[76:79], v[40:43]
    v_cvt_pk_bf16_f32 v187, v22, v23
    ds_read_b128 v[72:75], v248 offset:704
    s_waitcnt lgkmcnt(11)
    v_mfma_f32_16x16x32_bf16 v[36:39], v[144:147], v[80:83], v[36:39]
    v_mul_f32 v24, v24, v208
    v_mul_f32 v25, v25, v209
    s_waitcnt lgkmcnt(6)
    buffer_store_dwordx4 v[192:195], v229, s[12:15], s40 offen sc1
    buffer_store_dwordx4 v[196:199], v229, s[12:15], s41 offen sc1
    s_setprio 2
    ds_read_b128 v[76:79], v225 offset:576
    v_mfma_f32_16x16x32_bf16 v[40:43], v[144:147], v[84:87], v[40:43]
    v_mul_f32 v26, v26, v210
    ds_read_b128 v[80:83], v248 offset:1024
    v_mfma_f32_16x16x32_bf16 v[36:39], v[148:151], v[88:91], v[36:39]
    v_mul_f32 v27, v27, v211
    ds_read_b128 v[84:87], v225 offset:1280
    v_mfma_f32_16x16x32_bf16 v[40:43], v[148:151], v[92:95], v[40:43]
    v_cvt_pk_bf16_f32 v188, v24, v25
    ds_read_b128 v[88:91], v248 offset:1088
    s_waitcnt lgkmcnt(9)
    v_mfma_f32_16x16x32_bf16 v[36:39], v[152:155], v[48:51], v[36:39]
    v_cvt_pk_bf16_f32 v189, v26, v27
    ds_read_b128 v[92:95], v225 offset:1344
    v_mfma_f32_16x16x32_bf16 v[40:43], v[152:155], v[52:55], v[40:43]
    v_mul_f32 v28, v28, v208
    v_mul_f32 v29, v29, v209
    s_waitcnt lgkmcnt(8)
    v_mfma_f32_16x16x32_bf16 v[36:39], v[156:159], v[56:59], v[36:39]
    v_mul_f32 v30, v30, v210
    v_mfma_f32_16x16x32_bf16 v[40:43], v[156:159], v[60:63], v[40:43]
    v_mul_f32 v31, v31, v211
    s_setprio 1
    s_waitcnt lgkmcnt(6)
    v_mfma_f32_16x16x32_bf16 v[36:39], v[160:163], v[64:67], v[36:39]
    v_cvt_pk_bf16_f32 v190, v28, v29
    v_mfma_f32_16x16x32_bf16 v[40:43], v[160:163], v[68:71], v[40:43]
    v_cvt_pk_bf16_f32 v191, v30, v31
    s_waitcnt lgkmcnt(4)
    v_mfma_f32_16x16x32_bf16 v[36:39], v[164:167], v[72:75], v[36:39]
    ds_write_b64 v254, v[184:185] offset:3072
    ds_write_b64 v254, v[186:187] offset:3328
    ds_write_b64 v254, v[188:189] offset:3584
    ds_write_b64 v254, v[190:191] offset:3840
    v_mfma_f32_16x16x32_bf16 v[40:43], v[164:167], v[76:79], v[40:43]
    s_waitcnt lgkmcnt(6)
    v_mfma_f32_16x16x32_bf16 v[36:39], v[168:171], v[80:83], v[36:39]
    v_mfma_f32_16x16x32_bf16 v[40:43], v[168:171], v[84:87], v[40:43]
    s_setprio 0
    s_waitcnt lgkmcnt(4)
    v_mfma_f32_16x16x32_bf16 v[36:39], v[172:175], v[88:91], v[36:39]
    v_mfma_f32_16x16x32_bf16 v[40:43], v[172:175], v[92:95], v[40:43]
    s_nop 6
    v_mul_f32 v36, v36, v212
    v_mul_f32 v37, v37, v213
    v_mul_f32 v38, v38, v214
    v_mul_f32 v39, v39, v215
    v_cvt_pk_bf16_f32 v178, v36, v37
    v_cvt_pk_bf16_f32 v179, v38, v39
    v_mul_f32 v40, v40, v212
    v_mul_f32 v41, v41, v213
    v_mul_f32 v42, v42, v214
    v_mul_f32 v43, v43, v215
    v_cvt_pk_bf16_f32 v180, v40, v41
    v_cvt_pk_bf16_f32 v181, v42, v43
    ds_write_b64 v246, v[178:179] offset:256
    ds_write_b64 v255, v[180:181] offset:512
    s_waitcnt lgkmcnt(0)
    s_barrier
    ds_read_b128 v[192:195], v228 offset:3072
    ds_read_b128 v[196:199], v228 offset:4608
    ds_read_b128 v[200:203], v249
    s_waitcnt lgkmcnt(1)
    buffer_store_dwordx4 v[192:195], v229, s[12:15], s42 offen sc1
    buffer_store_dwordx4 v[196:199], v229, s[12:15], s43 offen sc1
K2_LASTROW:
    s_add_u32 s59, s20, 32
    s_cmp_ge_u32 s59, s22
    s_cbranch_scc1 K2_FIN
    s_waitcnt lgkmcnt(0)
    buffer_store_dwordx4 v[200:203], v229, s[12:15], s44 offen sc1
K2_FIN:
    s_endpgm
K2_MULTI:
    ds_read_b128 v[48:51], v222 offset:0
    ds_read_b128 v[52:55], v222 offset:64
    ds_read_b128 v[56:59], v222 offset:896
    ds_read_b128 v[60:63], v222 offset:960
    ds_read_b128 v[64:67], v223 offset:0
    ds_read_b128 v[68:71], v223 offset:64
    ds_read_b128 v[72:75], v223 offset:896
    ds_read_b128 v[76:79], v223 offset:960
    ds_read_b128 v[80:83], v222 offset:3072
    ds_read_b128 v[84:87], v222 offset:3136
    ds_read_b128 v[88:91], v222 offset:3968
    s_waitcnt vmcnt(19) lgkmcnt(9)
    v_mfma_f32_16x16x32_bf16 v[0:3], v[96:99], v[48:51], 0
    ds_read_b128 v[92:95], v222 offset:4032
    s_waitcnt vmcnt(18)
    v_mfma_f32_16x16x32_bf16 v[0:3], v[100:103], v[52:55], v[0:3]
    ds_read_b128 v[48:51], v223 offset:33280
    s_waitcnt vmcnt(17) lgkmcnt(9)
    v_mfma_f32_16x16x32_bf16 v[0:3], v[104:107], v[56:59], v[0:3]
    ds_read_b128 v[52:55], v223 offset:33344
    s_waitcnt vmcnt(16)
    v_mfma_f32_16x16x32_bf16 v[0:3], v[108:111], v[60:63], v[0:3]
    ds_read_b128 v[56:59], v223 offset:34176
    s_waitcnt vmcnt(15) lgkmcnt(9)
    v_mfma_f32_16x16x32_bf16 v[0:3], v[128:131], v[64:67], v[0:3]
    ds_read_b128 v[60:63], v223 offset:34240
    s_waitcnt vmcnt(14)
    v_mfma_f32_16x16x32_bf16 v[0:3], v[132:135], v[68:71], v[0:3]
    ds_read_b128 v[64:67], v232 offset:6144
    s_waitcnt vmcnt(13) lgkmcnt(9)
    v_mfma_f32_16x16x32_bf16 v[0:3], v[136:139], v[72:75], v[0:3]
    ds_read_b128 v[68:71], v232 offset:6208
    s_waitcnt vmcnt(12)
    v_mfma_f32_16x16x32_bf16 v[0:3], v[140:143], v[76:79], v[0:3]
    ds_read_b128 v[72:75], v232 offset:7040
    s_waitcnt lgkmcnt(9)
    v_mfma_f32_16x16x32_bf16 v[16:19], v[96:99], v[80:83], 0
    ds_read_b128 v[76:79], v232 offset:7104
    v_mfma_f32_16x16x32_bf16 v[16:19], v[100:103], v[84:87], v[16:19]
    ds_read_b128 v[80:83], v225 offset:0
    s_waitcnt lgkmcnt(9)
    v_mfma_f32_16x16x32_bf16 v[16:19], v[104:107], v[88:91], v[16:19]
    ds_read_b128 v[84:87], v225 offset:64
    v_mfma_f32_16x16x32_bf16 v[16:19], v[108:111], v[92:95], v[16:19]
    ds_read_b128 v[88:91], v225 offset:896
    s_waitcnt lgkmcnt(9)
    v_mfma_f32_16x16x32_bf16 v[16:19], v[128:131], v[48:51], v[16:19]
    ds_read_b128 v[92:95], v225 offset:960
    v_mfma_f32_16x16x32_bf16 v[16:19], v[132:135], v[52:55], v[16:19]
    ds_read_b128 v[48:51], v222 offset:128
    s_waitcnt lgkmcnt(9)
    v_mfma_f32_16x16x32_bf16 v[16:19], v[136:139], v[56:59], v[16:19]
    ds_read_b128 v[52:55], v222 offset:384
    v_mfma_f32_16x16x32_bf16 v[16:19], v[140:143], v[60:63], v[16:19]
    ds_read_b128 v[56:59], v222 offset:256
    s_waitcnt lgkmcnt(9)
    v_mfma_f32_16x16x32_bf16 v[32:35], v[96:99], v[64:67], 0
    ds_read_b128 v[60:63], v222 offset:192
    v_mfma_f32_16x16x32_bf16 v[32:35], v[100:103], v[68:71], v[32:35]
    ds_read_b128 v[64:67], v222 offset:448
    s_waitcnt lgkmcnt(9)
    v_mfma_f32_16x16x32_bf16 v[32:35], v[104:107], v[72:75], v[32:35]
    ds_read_b128 v[68:71], v222 offset:320
    v_mfma_f32_16x16x32_bf16 v[32:35], v[108:111], v[76:79], v[32:35]
    ds_read_b128 v[72:75], v222 offset:640
    s_waitcnt lgkmcnt(9)
    v_mfma_f32_16x16x32_bf16 v[32:35], v[128:131], v[80:83], v[32:35]
    ds_read_b128 v[76:79], v222 offset:512
    v_mfma_f32_16x16x32_bf16 v[32:35], v[132:135], v[84:87], v[32:35]
    ds_read_b128 v[80:83], v222 offset:768
    s_waitcnt lgkmcnt(9)
    v_mfma_f32_16x16x32_bf16 v[32:35], v[136:139], v[88:91], v[32:35]
    ds_read_b128 v[84:87], v222 offset:704
    v_mfma_f32_16x16x32_bf16 v[32:35], v[140:143], v[92:95], v[32:35]
    ds_read_b128 v[88:91], v222 offset:576
    s_waitcnt vmcnt(11) lgkmcnt(9)
    v_mfma_f32_16x16x32_bf16 v[4:7], v[112:115], v[48:51], 0
    ds_read_b128 v[92:95], v222 offset:832
    v_mfma_f32_16x16x32_bf16 v[8:11], v[112:115], v[52:55], 0
    ds_read_b128 v[48:51], v222 offset:1024
    s_waitcnt lgkmcnt(9)
    v_mfma_f32_16x16x32_bf16 v[12:15], v[112:115], v[56:59], 0
    ds_read_b128 v[52:55], v222 offset:1280
    s_waitcnt vmcnt(10)
    v_mfma_f32_16x16x32_bf16 v[4:7], v[116:119], v[60:63], v[4:7]
    ds_read_b128 v[56:59], v222 offset:1152
    s_waitcnt lgkmcnt(9)
    v_mfma_f32_16x16x32_bf16 v[8:11], v[116:119], v[64:67], v[8:11]
    ds_read_b128 v[60:63], v222 offset:1088
    v_mfma_f32_16x16x32_bf16 v[12:15], v[116:119], v[68:71], v[12:15]
    ds_read_b128 v[64:67], v222 offset:1344
    s_waitcnt vmcnt(9) lgkmcnt(9)
    v_mfma_f32_16x16x32_bf16 v[4:7], v[120:123], v[72:75], v[4:7]
    ds_read_b128 v[68:71], v222 offset:1216
    v_mfma_f32_16x16x32_bf16 v[8:11], v[120:123], v[76:79], v[8:11]
    ds_read_b128 v[72:75], v223 offset:128
    s_waitcnt lgkmcnt(9)
    v_mfma_f32_16x16x32_bf16 v[12:15], v[120:123], v[80:83], v[12:15]
    ds_read_b128 v[76:79], v223 offset:384
    s_waitcnt vmcnt(8)
    v_mfma_f32_16x16x32_bf16 v[4:7], v[124:127], v[84:87], v[4:7]
    ds_read_b128 v[80:83], v223 offset:256
    s_waitcnt lgkmcnt(9)
    v_mfma_f32_16x16x32_bf16 v[8:11], v[124:127], v[88:91], v[8:11]
    ds_read_b128 v[84:87], v223 offset:192
    v_mfma_f32_16x16x32_bf16 v[12:15], v[124:127], v[92:95], v[12:15]
    ds_read_b128 v[88:91], v223 offset:448
    s_waitcnt vmcnt(7) lgkmcnt(9)
    v_mfma_f32_16x16x32_bf16 v[4:7], v[144:147], v[48:51], v[4:7]
    ds_read_b128 v[92:95], v223 offset:320
    v_mfma_f32_16x16x32_bf16 v[8:11], v[144:147], v[52:55], v[8:11]
    ds_read_b128 v[48:51], v223 offset:640
    s_waitcnt lgkmcnt(9)
    v_mfma_f32_16x16x32_bf16 v[12:15], v[144:147], v[56:59], v[12:15]
    ds_read_b128 v[52:55], v223 offset:512
    s_waitcnt vmcnt(6)
    v_mfma_f32_16x16x32_bf16 v[4:7], v[148:151], v[60:63], v[4:7]
    ds_read_b128 v[56:59], v223 offset:768
    s_waitcnt lgkmcnt(9)
    v_mfma_f32_16x16x32_bf16 v[8:11], v[148:151], v[64:67], v[8:11]
    ds_read_b128 v[60:63], v223 offset:704
    v_mfma_f32_16x16x32_bf16 v[12:15], v[148:151], v[68:71], v[12:15]
    ds_read_b128 v[64:67], v223 offset:576
    s_waitcnt vmcnt(5) lgkmcnt(9)
    v_mfma_f32_16x16x32_bf16 v[4:7], v[152:155], v[72:75], v[4:7]
    ds_read_b128 v[68:71], v223 offset:832
    v_mfma_f32_16x16x32_bf16 v[8:11], v[152:155], v[76:79], v[8:11]
    ds_read_b128 v[72:75], v223 offset:1024
    s_waitcnt lgkmcnt(9)
    v_mfma_f32_16x16x32_bf16 v[12:15], v[152:155], v[80:83], v[12:15]
    ds_read_b128 v[76:79], v223 offset:1280
    s_waitcnt vmcnt(4)
    v_mfma_f32_16x16x32_bf16 v[4:7], v[156:159], v[84:87], v[4:7]
    ds_read_b128 v[80:83], v223 offset:1152
    s_waitcnt lgkmcnt(9)
    v_mfma_f32_16x16x32_bf16 v[8:11], v[156:159], v[88:91], v[8:11]
    ds_read_b128 v[84:87], v223 offset:1088
    v_mfma_f32_16x16x32_bf16 v[12:15], v[156:159], v[92:95], v[12:15]
    ds_read_b128 v[88:91], v223 offset:1344
    s_waitcnt vmcnt(3) lgkmcnt(9)
    v_mfma_f32_16x16x32_bf16 v[4:7], v[160:163], v[48:51], v[4:7]
    ds_read_b128 v[92:95], v223 offset:1216
    v_mfma_f32_16x16x32_bf16 v[8:11], v[160:163], v[52:55], v[8:11]
    ds_read_b128 v[48:51], v222 offset:3200
    s_waitcnt lgkmcnt(9)
    v_mfma_f32_16x16x32_bf16 v[12:15], v[160:163], v[56:59], v[12:15]
    ds_read_b128 v[52:55], v222 offset:3456
    s_waitcnt vmcnt(2)
    v_mfma_f32_16x16x32_bf16 v[4:7], v[164:167], v[60:63], v[4:7]
    ds_read_b128 v[56:59], v222 offset:3328
    s_waitcnt lgkmcnt(9)
    v_mfma_f32_16x16x32_bf16 v[8:11], v[164:167], v[64:67], v[8:11]
    ds_read_b128 v[60:63], v222 offset:3264
    v_mfma_f32_16x16x32_bf16 v[12:15], v[164:167], v[68:71], v[12:15]
    ds_read_b128 v[64:67], v222 offset:3520
    s_waitcnt vmcnt(1) lgkmcnt(9)
    v_mfma_f32_16x16x32_bf16 v[4:7], v[168:171], v[72:75], v[4:7]
    ds_read_b128 v[68:71], v222 offset:3392
    v_mfma_f32_16x16x32_bf16 v[8:11], v[168:171], v[76:79], v[8:11]
    ds_read_b128 v[72:75], v222 offset:3712
    s_waitcnt lgkmcnt(9)
    v_mfma_f32_16x16x32_bf16 v[12:15], v[168:171], v[80:83], v[12:15]
    ds_read_b128 v[76:79], v222 offset:3584
    s_waitcnt vmcnt(0)
    v_mfma_f32_16x16x32_bf16 v[4:7], v[172:175], v[84:87], v[4:7]
    ds_read_b128 v[80:83], v222 offset:3840
    s_waitcnt lgkmcnt(9)
    v_mfma_f32_16x16x32_bf16 v[8:11], v[172:175], v[88:91], v[8:11]
    ds_read_b128 v[84:87], v222 offset:3776
    v_mfma_f32_16x16x32_bf16 v[12:15], v[172:175], v[92:95], v[12:15]
    ds_read_b128 v[88:91], v222 offset:3648
    s_waitcnt lgkmcnt(9)
    v_mfma_f32_16x16x32_bf16 v[20:23], v[112:115], v[48:51], 0
    ds_read_b128 v[92:95], v222 offset:3904
    v_mfma_f32_16x16x32_bf16 v[24:27], v[112:115], v[52:55], 0
    ds_read_b128 v[48:51], v222 offset:4096
    s_waitcnt lgkmcnt(9)
    v_mfma_f32_16x16x32_bf16 v[28:31], v[112:115], v[56:59], 0
    ds_read_b128 v[52:55], v222 offset:4352
    v_mfma_f32_16x16x32_bf16 v[20:23], v[116:119], v[60:63], v[20:23]
    ds_read_b128 v[56:59], v222 offset:4224
    s_waitcnt lgkmcnt(9)
    v_mfma_f32_16x16x32_bf16 v[24:27], v[116:119], v[64:67], v[24:27]
    ds_read_b128 v[60:63], v222 offset:4160
    v_mfma_f32_16x16x32_bf16 v[28:31], v[116:119], v[68:71], v[28:31]
    ds_read_b128 v[64:67], v222 offset:4416
    s_waitcnt lgkmcnt(9)
    v_mfma_f32_16x16x32_bf16 v[20:23], v[120:123], v[72:75], v[20:23]
    ds_read_b128 v[68:71], v222 offset:4288
    v_mfma_f32_16x16x32_bf16 v[24:27], v[120:123], v[76:79], v[24:27]
    ds_read_b128 v[72:75], v223 offset:33408
    s_waitcnt lgkmcnt(9)
    v_mfma_f32_16x16x32_bf16 v[28:31], v[120:123], v[80:83], v[28:31]
    ds_read_b128 v[76:79], v223 offset:33664
    v_mfma_f32_16x16x32_bf16 v[20:23], v[124:127], v[84:87], v[20:23]
    ds_read_b128 v[80:83], v223 offset:33536
    s_waitcnt lgkmcnt(9)
    v_mfma_f32_16x16x32_bf16 v[24:27], v[124:127], v[88:91], v[24:27]
    ds_read_b128 v[84:87], v223 offset:33472
    v_mfma_f32_16x16x32_bf16 v[28:31], v[124:127], v[92:95], v[28:31]
    ds_read_b128 v[88:91], v223 offset:33728
    s_waitcnt lgkmcnt(9)
    v_mfma_f32_16x16x32_bf16 v[20:23], v[144:147], v[48:51], v[20:23]
    ds_read_b128 v[92:95], v223 offset:33600
    v_mfma_f32_16x16x32_bf16 v[24:27], v[144:147], v[52:55], v[24:27]
    ds_read_b128 v[48:51], v223 offset:33920
    s_waitcnt lgkmcnt(9)
    v_mfma_f32_16x16x32_bf16 v[28:31], v[144:147], v[56:59], v[28:31]
    ds_read_b128 v[52:55], v223 offset:33792
    v_mfma_f32_16x16x32_bf16 v[20:23], v[148:151], v[60:63], v[20:23]
    ds_read_b128 v[56:59], v223 offset:34048
    s_waitcnt lgkmcnt(9)
    v_mfma_f32_16x16x32_bf16 v[24:27], v[148:151], v[64:67], v[24:27]
    ds_read_b128 v[60:63], v223 offset:33984
    v_mfma_f32_16x16x32_bf16 v[28:31], v[148:151], v[68:71], v[28:31]
    ds_read_b128 v[64:67], v223 offset:33856
    s_waitcnt lgkmcnt(9)
    v_mfma_f32_16x16x32_bf16 v[20:23], v[152:155], v[72:75], v[20:23]
    ds_read_b128 v[68:71], v223 offset:34112
    v_mfma_f32_16x16x32_bf16 v[24:27], v[152:155], v[76:79], v[24:27]
    ds_read_b128 v[72:75], v223 offset:34304
    s_waitcnt lgkmcnt(9)
    v_mfma_f32_16x16x32_bf16 v[28:31], v[152:155], v[80:83], v[28:31]
    ds_read_b128 v[76:79], v223 offset:34560
    v_mfma_f32_16x16x32_bf16 v[20:23], v[156:159], v[84:87], v[20:23]
    ds_read_b128 v[80:83], v223 offset:34432
    s_waitcnt lgkmcnt(9)
    v_mfma_f32_16x16x32_bf16 v[24:27], v[156:159], v[88:91], v[24:27]
    ds_read_b128 v[84:87], v223 offset:34368
    v_mfma_f32_16x16x32_bf16 v[28:31], v[156:159], v[92:95], v[28:31]
    ds_read_b128 v[88:91], v223 offset:34624
    s_waitcnt lgkmcnt(9)
    v_mfma_f32_16x16x32_bf16 v[20:23], v[160:163], v[48:51], v[20:23]
    ds_read_b128 v[92:95], v223 offset:34496
    v_mfma_f32_16x16x32_bf16 v[24:27], v[160:163], v[52:55], v[24:27]
    ds_read_b128 v[48:51], v247 offset:6272
    s_waitcnt lgkmcnt(9)
    v_mfma_f32_16x16x32_bf16 v[28:31], v[160:163], v[56:59], v[28:31]
    ds_read_b128 v[52:55], v232 offset:6528
    v_mfma_f32_16x16x32_bf16 v[20:23], v[164:167], v[60:63], v[20:23]
    ds_read_b128 v[56:59], v247 offset:6336
    s_waitcnt lgkmcnt(9)
    v_mfma_f32_16x16x32_bf16 v[24:27], v[164:167], v[64:67], v[24:27]
    ds_read_b128 v[60:63], v232 offset:6592
    v_mfma_f32_16x16x32_bf16 v[28:31], v[164:167], v[68:71], v[28:31]
    ds_read_b128 v[64:67], v247 offset:6784
    s_waitcnt lgkmcnt(9)
    v_mfma_f32_16x16x32_bf16 v[20:23], v[168:171], v[72:75], v[20:23]
    ds_read_b128 v[68:71], v232 offset:6656
    v_mfma_f32_16x16x32_bf16 v[24:27], v[168:171], v[76:79], v[24:27]
    ds_read_b128 v[72:75], v247 offset:6848
    s_waitcnt lgkmcnt(9)
    v_mfma_f32_16x16x32_bf16 v[28:31], v[168:171], v[80:83], v[28:31]
    ds_read_b128 v[76:79], v232 offset:6720
    v_mfma_f32_16x16x32_bf16 v[20:23], v[172:175], v[84:87], v[20:23]
    ds_read_b128 v[80:83], v247 offset:7168
    s_waitcnt lgkmcnt(9)
    v_mfma_f32_16x16x32_bf16 v[24:27], v[172:175], v[88:91], v[24:27]
    ds_read_b128 v[84:87], v232 offset:7424
    v_mfma_f32_16x16x32_bf16 v[28:31], v[172:175], v[92:95], v[28:31]
    ds_read_b128 v[88:91], v247 offset:7232
    s_waitcnt lgkmcnt(9)
    v_mfma_f32_16x16x32_bf16 v[36:39], v[112:115], v[48:51], 0
    ds_read_b128 v[92:95], v232 offset:7488
    v_mfma_f32_16x16x32_bf16 v[40:43], v[112:115], v[52:55], 0
    ds_read_b128 v[48:51], v248 offset:128
    s_waitcnt lgkmcnt(9)
    v_mfma_f32_16x16x32_bf16 v[36:39], v[116:119], v[56:59], v[36:39]
    ds_read_b128 v[52:55], v225 offset:384
    v_mfma_f32_16x16x32_bf16 v[40:43], v[116:119], v[60:63], v[40:43]
    ds_read_b128 v[56:59], v248 offset:192
    s_waitcnt lgkmcnt(9)
    v_mfma_f32_16x16x32_bf16 v[36:39], v[120:123], v[64:67], v[36:39]
    ds_read_b128 v[60:63], v225 offset:448
    v_mfma_f32_16x16x32_bf16 v[40:43], v[120:123], v[68:71], v[40:43]
    ds_read_b128 v[64:67], v248 offset:640
    s_waitcnt lgkmcnt(9)
    v_mfma_f32_16x16x32_bf16 v[36:39], v[124:127], v[72:75], v[36:39]
    ds_read_b128 v[68:71], v225 offset:512
    v_mfma_f32_16x16x32_bf16 v[40:43], v[124:127], v[76:79], v[40:43]
    ds_read_b128 v[72:75], v248 offset:704
    s_waitcnt lgkmcnt(9)
    v_mfma_f32_16x16x32_bf16 v[36:39], v[144:147], v[80:83], v[36:39]
    ds_read_b128 v[76:79], v225 offset:576
    v_mfma_f32_16x16x32_bf16 v[40:43], v[144:147], v[84:87], v[40:43]
    ds_read_b128 v[80:83], v248 offset:1024
    s_waitcnt lgkmcnt(9)
    v_mfma_f32_16x16x32_bf16 v[36:39], v[148:151], v[88:91], v[36:39]
    ds_read_b128 v[84:87], v225 offset:1280
    v_mfma_f32_16x16x32_bf16 v[40:43], v[148:151], v[92:95], v[40:43]
    ds_read_b128 v[88:91], v248 offset:1088
    s_waitcnt lgkmcnt(9)
    v_mfma_f32_16x16x32_bf16 v[36:39], v[152:155], v[48:51], v[36:39]
    ds_read_b128 v[92:95], v225 offset:1344
    v_mfma_f32_16x16x32_bf16 v[40:43], v[152:155], v[52:55], v[40:43]
    s_waitcnt lgkmcnt(8)
    v_mfma_f32_16x16x32_bf16 v[36:39], v[156:159], v[56:59], v[36:39]
    v_mfma_f32_16x16x32_bf16 v[40:43], v[156:159], v[60:63], v[40:43]
    s_waitcnt lgkmcnt(6)
    v_mfma_f32_16x16x32_bf16 v[36:39], v[160:163], v[64:67], v[36:39]
    v_mfma_f32_16x16x32_bf16 v[40:43], v[160:163], v[68:71], v[40:43]
    s_waitcnt lgkmcnt(4)
    v_mfma_f32_16x16x32_bf16 v[36:39], v[164:167], v[72:75], v[36:39]
    v_mfma_f32_16x16x32_bf16 v[40:43], v[164:167], v[76:79], v[40:43]
    s_waitcnt lgkmcnt(2)
    v_mfma_f32_16x16x32_bf16 v[36:39], v[168:171], v[80:83], v[36:39]
    v_mfma_f32_16x16x32_bf16 v[40:43], v[168:171], v[84:87], v[40:43]
    s_waitcnt lgkmcnt(0)
    v_mfma_f32_16x16x32_bf16 v[36:39], v[172:175], v[88:91], v[36:39]
    v_mfma_f32_16x16x32_bf16 v[40:43], v[172:175], v[92:95], v[40:43]
    s_lshl_b32 s60, s54, 9
    s_lshl_b32 s61, s20, 6
    s_add_u32 s60, s60, s61
    s_mul_i32 s60, s60, 192
    s_add_u32 s60, s60, 10485760
    v_mul_u32_u24 v227, 96, v252
    s_cmp_lg_u32 s28, 0
    s_cbranch_scc1 K2_NOACC
    buffer_load_dwordx4 v[48:51], v227, s[8:11], s60 offen offset:0
    buffer_load_dwordx4 v[52:55], v227, s[8:11], s60 offen offset:16
    buffer_load_dwordx4 v[56:59], v227, s[8:11], s60 offen offset:32
    buffer_load_dwordx4 v[60:63], v227, s[8:11], s60 offen offset:48
    buffer_load_dwordx4 v[64:67], v227, s[8:11], s60 offen offset:64
    buffer_load_dwordx4 v[68:71], v227, s[8:11], s60 offen offset:80
    buffer_load_dwordx4 v[72:75], v227, s[8:11], s60 offen offset:96
    buffer_load_dwordx4 v[76:79], v227, s[8:11], s60 offen offset:112
    buffer_load_dwordx4 v[80:83], v227, s[8:11], s60 offen offset:128
    buffer_load_dwordx4 v[84:87], v227, s[8:11], s60 offen offset:144
    buffer_load_dwordx4 v[88:91], v227, s[8:11], s60 offen offset:160
    s_waitcnt vmcnt(0)
    v_add_f32 v0, v0, v48
    v_add_f32 v1, v1, v49
    v_add_f32 v2, v2, v50
    v_add_f32 v3, v3, v51
    v_add_f32 v4, v4, v52
    v_add_f32 v5, v5, v53
    v_add_f32 v6, v6, v54
    v_add_f32 v7, v7, v55
    v_add_f32 v8, v8, v56
    v_add_f32 v9, v9, v57
    v_add_f32 v10, v10, v58
    v_add_f32 v11, v11, v59
    v_add_f32 v12, v12, v60
    v_add_f32 v13, v13, v61
    v_add_f32 v14, v14, v62
    v_add_f32 v15, v15, v63
    v_add_f32 v16, v16, v64
    v_add_f32 v17, v17, v65
    v_add_f32 v18, v18, v66
    v_add_f32 v19, v19, v67
    v_add_f32 v20, v20, v68
    v_add_f32 v21, v21, v69
    v_add_f32 v22, v22, v70
    v_add_f32 v23, v23, v71
    v_add_f32 v24, v24, v72
    v_add_f32 v25, v25, v73
    v_add_f32 v26, v26, v74
    v_add_f32 v27, v27, v75
    v_add_f32 v28, v28, v76
    v_add_f32 v29, v29, v77
    v_add_f32 v30, v30, v78
    v_add_f32 v31, v31, v79
    v_add_f32 v32, v32, v80
    v_add_f32 v33, v33, v81
    v_add_f32 v34, v34, v82
    v_add_f32 v35, v35, v83
    v_add_f32 v36, v36, v84
    v_add_f32 v37, v37, v85
    v_add_f32 v38, v38, v86
    v_add_f32 v39, v39, v87
    v_add_f32 v40, v40, v88
    v_add_f32 v41, v41, v89
    v_add_f32 v42, v42, v90
    v_add_f32 v43, v43, v91
K2_NOACC:
    s_barrier
    s_cmp_eq_u32 s55, 0
    s_cbranch_scc1 K2_SPILL
    s_bfe_u32 s60, s20, 0x10002
    s_lshl_b32 s60, s60, 4
    s_add_u32 s59, s59, s60
    v_add_u32 v228, s59, v229
    s_mul_i32 s60, s20, 2080
    s_add_u32 s60, s60, 65536
    v_add_u32 v249, s60, v229
    s_mov_b32 s63, 0xbfb8aa3b
    s_add_u32 s40, s20, s21
    s_lshl_b32 s40, s40, 10
    s_add_u32 s41, s40, 8192
    s_add_u32 s42, s40, 16384
    s_add_u32 s43, s40, 24576
    s_add_u32 s44, s40, 32768
    v_mul_f32 v204, s63, v0
    v_mul_f32 v205, s63, v1
    v_mul_f32 v206, s63, v2
    v_mul_f32 v207, s63, v3
    v_exp_f32 v204, v204
    v_exp_f32 v205, v205
    v_exp_f32 v206, v206
    v_exp_f32 v207, v207
    v_add_f32 v204, 1.0, v204
    v_add_f32 v205, 1.0, v205
    v_add_f32 v206, 1.0, v206
    v_add_f32 v207, 1.0, v207
    v_rcp_f32 v204, v204
    v_rcp_f32 v205, v205
    v_rcp_f32 v206, v206
    v_rcp_f32 v207, v207
    v_cvt_pk_bf16_f32 v176, v0, v1
    v_cvt_pk_bf16_f32 v177, v2, v3
    v_mul_f32 v4, v4, v204
    v_mul_f32 v5, v5, v205
    v_mul_f32 v6, v6, v206
    v_mul_f32 v7, v7, v207
    v_cvt_pk_bf16_f32 v178, v4, v5
    v_cvt_pk_bf16_f32 v179, v6, v7
    v_mul_f32 v8, v8, v204
    v_mul_f32 v9, v9, v205
    v_mul_f32 v10, v10, v206
    v_mul_f32 v11, v11, v207
    v_cvt_pk_bf16_f32 v180, v8, v9
    v_cvt_pk_bf16_f32 v181, v10, v11
    v_mul_f32 v12, v12, v204
    v_mul_f32 v13, v13, v205
    v_mul_f32 v14, v14, v206
    v_mul_f32 v15, v15, v207
    v_cvt_pk_bf16_f32 v182, v12, v13
    v_cvt_pk_bf16_f32 v183, v14, v15
    ds_write_b64 v254, v[176:177] offset:0
    ds_write_b64 v254, v[178:179] offset:256
    ds_write_b64 v254, v[180:181] offset:512
    ds_write_b64 v254, v[182:183] offset:768
    s_waitcnt lgkmcnt(0)
    s_barrier
    ds_read_b128 v[192:195], v228 offset:0
    ds_read_b128 v[196:199], v228 offset:1536
    s_waitcnt lgkmcnt(0)
    buffer_store_dwordx4 v[192:195], v229, s[12:15], s40 offen sc1
    buffer_store_dwordx4 v[196:199], v229, s[12:15], s41 offen sc1
    v_mul_f32 v208, s63, v16
    v_mul_f32 v209, s63, v17
    v_mul_f32 v210, s63, v18
    v_mul_f32 v211, s63, v19
    v_exp_f32 v208, v208
    v_exp_f32 v209, v209
    v_exp_f32 v210, v210
    v_exp_f32 v211, v211
    v_add_f32 v208, 1.0, v208
    v_add_f32 v209, 1.0, v209
    v_add_f32 v210, 1.0, v210
    v_add_f32 v211, 1.0, v211
    v_rcp_f32 v208, v208
    v_rcp_f32 v209, v209
    v_rcp_f32 v210, v210
    v_rcp_f32 v211, v211
    v_cvt_pk_bf16_f32 v184, v16, v17
    v_cvt_pk_bf16_f32 v185, v18, v19
    v_mul_f32 v20, v20, v208
    v_mul_f32 v21, v21, v209
    v_mul_f32 v22, v22, v210
    v_mul_f32 v23, v23, v211
    v_cvt_pk_bf16_f32 v186, v20, v21
    v_cvt_pk_bf16_f32 v187, v22, v23
    v_mul_f32 v24, v24, v208
    v_mul_f32 v25, v25, v209
    v_mul_f32 v26, v26, v210
    v_mul_f32 v27, v27, v211
    v_cvt_pk_bf16_f32 v188, v24, v25
    v_cvt_pk_bf16_f32 v189, v26, v27
    v_mul_f32 v28, v28, v208
    v_mul_f32 v29, v29, v209
    v_mul_f32 v30, v30, v210
    v_mul_f32 v31, v31, v211
    v_cvt_pk_bf16_f32 v190, v28, v29
    v_cvt_pk_bf16_f32 v191, v30, v31
    ds_write_b64 v254, v[184:185] offset:3072
    ds_write_b64 v254, v[186:187] offset:3328
    ds_write_b64 v254, v[188:189] offset:3584
    ds_write_b64 v254, v[190:191] offset:3840
    s_waitcnt lgkmcnt(0)
    s_barrier
    ds_read_b128 v[192:195], v228 offset:3072
    ds_read_b128 v[196:199], v228 offset:4608
    s_waitcnt lgkmcnt(0)
    buffer_store_dwordx4 v[192:195], v229, s[12:15], s42 offen sc1
    buffer_store_dwordx4 v[196:199], v229, s[12:15], s43 offen sc1
    v_mul_f32 v212, s63, v32
    v_mul_f32 v213, s63, v33
    v_mul_f32 v214, s63, v34
    v_mul_f32 v215, s63, v35
    v_exp_f32 v212, v212
    v_exp_f32 v213, v213
    v_exp_f32 v214, v214
    v_exp_f32 v215, v215
    v_add_f32 v212, 1.0, v212
    v_add_f32 v213, 1.0, v213
    v_add_f32 v214, 1.0, v214
    v_add_f32 v215, 1.0, v215
    v_rcp_f32 v212, v212
    v_rcp_f32 v213, v213
    v_rcp_f32 v214, v214
    v_rcp_f32 v215, v215
    v_cvt_pk_bf16_f32 v220, v32, v33
    v_cvt_pk_bf16_f32 v221, v34, v35
    v_mul_f32 v36, v36, v212
    v_mul_f32 v37, v37, v213
    v_mul_f32 v38, v38, v214
    v_mul_f32 v39, v39, v215
    v_cvt_pk_bf16_f32 v178, v36, v37
    v_cvt_pk_bf16_f32 v179, v38, v39
    v_mul_f32 v40, v40, v212
    v_mul_f32 v41, v41, v213
    v_mul_f32 v42, v42, v214
    v_mul_f32 v43, v43, v215
    v_cvt_pk_bf16_f32 v180, v40, v41
    v_cvt_pk_bf16_f32 v181, v42, v43
    ds_write_b64 v255, v[220:221] offset:0
    ds_write_b64 v246, v[178:179] offset:256
    ds_write_b64 v255, v[180:181] offset:512
    s_waitcnt lgkmcnt(0)
    s_barrier
    ds_read_b128 v[200:203], v249
    s_branch K2_LASTROW
K2_SPILL:
    buffer_store_dwordx4 v[0:3], v227, s[8:11], s60 offen offset:0
    buffer_store_dwordx4 v[4:7], v227, s[8:11], s60 offen offset:16
    buffer_store_dwordx4 v[8:11], v227, s[8:11], s60 offen offset:32
    buffer_store_dwordx4 v[12:15], v227, s[8:11], s60 offen offset:48
    buffer_store_dwordx4 v[16:19], v227, s[8:11], s60 offen offset:64
    buffer_store_dwordx4 v[20:23], v227, s[8:11], s60 offen offset:80
    buffer_store_dwordx4 v[24:27], v227, s[8:11], s60 offen offset:96
    buffer_store_dwordx4 v[28:31], v227, s[8:11], s60 offen offset:112
    buffer_store_dwordx4 v[32:35], v227, s[8:11], s60 offen offset:128
    buffer_store_dwordx4 v[36:39], v227, s[8:11], s60 offen offset:144
    buffer_store_dwordx4 v[40:43], v227, s[8:11], s60 offen offset:160
    s_mov_b32 s28, 0
    s_waitcnt vmcnt(0)
    s_cmp_lt_u32 s24, s25
    s_cbranch_scc1 K2_LOAD
    s_add_u32 s23, s23, 20
    s_branch K2_WINDOW
KS_FLS:
    s_sub_u32 s25, s25, 1
    s_cbranch_scc1 K2_END
    v_mov_b32 v62, 163460
    ds_read_b32 v62, v62
    s_branch KS_JOIN2
K2_NOW0:
    buffer_load_dwordx4 v[76:79], v72, s[8:11], s67 offen sc1
    s_branch K2_W0
K2_WINDOW:
    s_mov_b32 s24, 0
    s_mov_b32 s25, 1
K2_LOAD:
    v_mbcnt_lo_u32_b32 v176, -1, 0
    v_mbcnt_hi_u32_b32 v176, -1, v176
    s_lshl_b32 s58, s20, 6
    v_add_u32 v177, s58, v176
    v_lshlrev_b32 v70, 4, v176
    s_mov_b32 s58, 7110656
    buffer_load_dwordx4 v[136:139], v70, s[8:11], s58 offen offset:0 sc1
    buffer_load_dwordx4 v[140:143], v70, s[8:11], s58 offen offset:1024 sc1
    s_mov_b32 s58, 7112704
    buffer_load_dwordx4 v[144:147], v70, s[8:11], s58 offen offset:0 sc1
    buffer_load_dwordx4 v[148:151], v70, s[8:11], s58 offen offset:1024 sc1
    s_mov_b32 s58, 7114752
    buffer_load_dwordx4 v[152:155], v70, s[8:11], s58 offen offset:0 sc1
    buffer_load_dwordx4 v[156:159], v70, s[8:11], s58 offen offset:1024 sc1
    s_mov_b32 s58, 7116800
    buffer_load_dwordx4 v[160:163], v70, s[8:11], s58 offen offset:0 sc1
    buffer_load_dwordx4 v[164:167], v70, s[8:11], s58 offen offset:1024 sc1
    s_mov_b32 s58, 7118848
    buffer_load_dwordx4 v[168:171], v70, s[8:11], s58 offen offset:0 sc1
    buffer_load_dwordx4 v[172:175], v70, s[8:11], s58 offen offset:1024 sc1
    s_mul_i32 s58, s20, 10400
    s_add_u32 s58, s58, 65536
    s_add_u32 s59, s58, 512
    v_and_b32 v76, 31, v176
    v_lshrrev_b32 v77, 5, v176
    v_mov_b32 v80, 0
    v_mul_u32_u24 v77, 2080, v77
    v_mov_b32 v81, 0xffff0000
    v_lshl_add_u32 v78, v76, 4, v77
    v_mov_b32 v82, 0
    v_add_u32 v78, s58, v78
    v_mov_b32 v83, v81
    v_add_u32 v85, 16, v176
    v_lshlrev_b32 v84, 5, v176
    v_lshrrev_b32 v85, 6, v85
    v_mul_u32_u24 v85, 1532, v85
    v_sub_u32 v84, v84, v85
    v_mov_b32 v85, -1
    v_add_u32 v84, s59, v84
    ds_write_b32 v84, v85 offset:0
    ds_write_b32 v84, v85 offset:2080
    ds_write_b32 v84, v85 offset:4160
    ds_write_b32 v84, v85 offset:6240
    ds_write_b32 v84, v85 offset:8320
    s_mov_b32 exec_hi, 0
    ds_write_b128 v78, v[80:83] offset:0
    ds_write_b128 v78, v[80:83] offset:2080
    ds_write_b128 v78, v[80:83] offset:4160
    ds_write_b128 v78, v[80:83] offset:6240
    ds_write_b128 v78, v[80:83] offset:8320
    s_mov_b32 exec_hi, -1
    s_cmp_lg_u32 s20, 7
    s_cbranch_scc1 K2_NOH
    v_mov_b32 v76, 0
    v_mov_b32 v77, -1
    v_lshlrev_b32 v78, 2, v176
    v_add_u32 v78, 163072, v78
    s_mov_b64 exec, 0x1ff
    ds_write_b32 v78, v76 offset:192
    s_mov_b32 exec_lo, -1
    ds_write_b32 v78, v77 offset:256
    s_mov_b64 exec, -1
    s_cmp_lg_u32 s24, 0
    s_cbranch_scc1 K2_NOH
    s_mov_b32 exec_hi, 0xffff
    ds_write_b32 v78, v76
    s_mov_b64 exec, 1
    ds_write_b32 v78, v76 offset:228
    s_mov_b64 exec, -1
K2_NOH:
    s_waitcnt lgkmcnt(0)
    s_barrier
    s_branch K2_CELLS
K2_LD_GEN:
    s_mov_b64 exec, s[42:43]
    s_cbranch_execz K2_LD_DONE
    buffer_load_dwordx4 v[4:7], v182, s[8:11], 0 offen sc1
    s_mov_b64 exec, s[44:45]
    s_cbranch_execz K2_LD_DONE
    buffer_load_dwordx4 v[8:11], v183, s[8:11], 0 offen sc1
    s_mov_b64 exec, s[46:47]
    s_cbranch_execz K2_LD_DONE
    buffer_load_dwordx4 v[12:15], v184, s[8:11], 0 offen sc1
    s_mov_b64 exec, s[48:49]
    s_cbranch_execz K2_LD_DONE
    buffer_load_dwordx4 v[16:19], v181, s[8:11], 0 offen offset:128 sc1
    s_mov_b64 exec, s[50:51]
    s_cbranch_execz K2_LD_DONE
    buffer_load_dwordx4 v[20:23], v181, s[8:11], 0 offen offset:160 sc1
    s_mov_b64 exec, s[90:91]
    s_cbranch_execz K2_LD_DONE
    buffer_load_dwordx4 v[24:27], v181, s[8:11], 0 offen offset:192 sc1
    s_mov_b64 exec, s[92:93]
    s_cbranch_execz K2_LD_DONE
    buffer_load_dwordx4 v[28:31], v181, s[8:11], 0 offen offset:224 sc1
    s_mov_b64 exec, s[94:95]
    s_cbranch_execz K2_LD_DONE
    buffer_load_dwordx4 v[32:35], v181, s[8:11], 0 offen offset:256 sc1
    s_mov_b64 exec, s[96:97]
    s_cbranch_execz K2_LD_DONE
    buffer_load_dwordx4 v[36:39], v181, s[8:11], 0 offen offset:288 sc1
    s_branch K2_LD_DONE
K2_WLATE:
    s_waitcnt vmcnt(0)
    v_lshlrev_b32 v96, 16, v136
    v_and_b32 v97, 0xffff0000, v136
    v_lshlrev_b32 v98, 16, v137
    v_and_b32 v99, 0xffff0000, v137
    v_lshlrev_b32 v100, 16, v138
    v_and_b32 v101, 0xffff0000, v138
    v_lshlrev_b32 v102, 16, v139
    v_and_b32 v103, 0xffff0000, v139
    v_lshlrev_b32 v104, 16, v140
    v_and_b32 v105, 0xffff0000, v140
    v_lshlrev_b32 v106, 16, v141
    v_and_b32 v107, 0xffff0000, v141
    v_lshlrev_b32 v108, 16, v142
    v_and_b32 v109, 0xffff0000, v142
    v_lshlrev_b32 v110, 16, v143
    v_and_b32 v111, 0xffff0000, v143
    v_lshlrev_b32 v112, 16, v144
    v_and_b32 v113, 0xffff0000, v144
    v_lshlrev_b32 v114, 16, v145
    v_and_b32 v115, 0xffff0000, v145
    v_lshlrev_b32 v116, 16, v146
    v_and_b32 v117, 0xffff0000, v146
    v_lshlrev_b32 v118, 16, v147
    v_and_b32 v119, 0xffff0000, v147
    v_lshlrev_b32 v120, 16, v148
    v_and_b32 v121, 0xffff0000, v148
    v_lshlrev_b32 v122, 16, v149
    v_and_b32 v123, 0xffff0000, v149
    v_lshlrev_b32 v124, 16, v150
    v_and_b32 v125, 0xffff0000, v150
    v_lshlrev_b32 v126, 16, v151
    v_and_b32 v127, 0xffff0000, v151
    v_lshlrev_b32 v128, 16, v152
    v_and_b32 v129, 0xffff0000, v152
    v_lshlrev_b32 v130, 16, v153
    v_and_b32 v131, 0xffff0000, v153
    v_lshlrev_b32 v132, 16, v154
    v_and_b32 v133, 0xffff0000, v154
    v_lshlrev_b32 v134, 16, v155
    v_and_b32 v135, 0xffff0000, v155
    v_lshlrev_b32 v136, 16, v156
    v_and_b32 v137, 0xffff0000, v156
    v_lshlrev_b32 v138, 16, v157
    v_and_b32 v139, 0xffff0000, v157
    v_lshlrev_b32 v140, 16, v158
    v_and_b32 v141, 0xffff0000, v158
    v_lshlrev_b32 v142, 16, v159
    v_and_b32 v143, 0xffff0000, v159
    v_lshlrev_b32 v144, 16, v160
    v_and_b32 v145, 0xffff0000, v160
    v_lshlrev_b32 v146, 16, v161
    v_and_b32 v147, 0xffff0000, v161
    v_lshlrev_b32 v148, 16, v162
    v_and_b32 v149, 0xffff0000, v162
    v_lshlrev_b32 v150, 16, v163
    v_and_b32 v151, 0xffff0000, v163
    v_lshlrev_b32 v152, 16, v164
    v_and_b32 v153, 0xffff0000, v164
    v_lshlrev_b32 v154, 16, v165
    v_and_b32 v155, 0xffff0000, v165
    v_lshlrev_b32 v156, 16, v166
    v_and_b32 v157, 0xffff0000, v166
    v_lshlrev_b32 v158, 16, v167
    v_and_b32 v159, 0xffff0000, v167
    v_lshlrev_b32 v160, 16, v168
    v_and_b32 v161, 0xffff0000, v168
    v_lshlrev_b32 v162, 16, v169
    v_and_b32 v163, 0xffff0000, v169
    v_lshlrev_b32 v164, 16, v170
    v_and_b32 v165, 0xffff0000, v170
    v_lshlrev_b32 v166, 16, v171
    v_and_b32 v167, 0xffff0000, v171
    v_lshlrev_b32 v168, 16, v172
    v_and_b32 v169, 0xffff0000, v172
    v_lshlrev_b32 v170, 16, v173
    v_and_b32 v171, 0xffff0000, v173
    v_lshlrev_b32 v172, 16, v174
    v_and_b32 v173, 0xffff0000, v174
    v_lshlrev_b32 v174, 16, v175
    v_and_b32 v175, 0xffff0000, v175
    s_branch K2_NOWRAW
K2_RT0:
    s_sub_u32 s60, s60, 1
    s_cbranch_scc1 K2_END
    buffer_load_dwordx4 v[0:3], v181, s[8:11], 0 offen offset:0 sc1
    s_waitcnt vmcnt(0)
    s_branch K2_CK0
K2_RT1:
    s_sub_u32 s60, s60, 1
    s_cbranch_scc1 K2_END
    buffer_load_dwordx4 v[4:7], v182, s[8:11], 0 offen sc1
    s_waitcnt vmcnt(0)
    s_branch K2_CK1
K2_RT2:
    s_sub_u32 s60, s60, 1
    s_cbranch_scc1 K2_END
    buffer_load_dwordx4 v[8:11], v183, s[8:11], 0 offen sc1
    s_waitcnt vmcnt(0)
    s_branch K2_CK2
K2_RT3:
    s_sub_u32 s60, s60, 1
    s_cbranch_scc1 K2_END
    buffer_load_dwordx4 v[12:15], v184, s[8:11], 0 offen sc1
    s_waitcnt vmcnt(0)
    s_branch K2_CK3
K2_RT4:
    s_sub_u32 s60, s60, 1
    s_cbranch_scc1 K2_END
    buffer_load_dwordx4 v[16:19], v181, s[8:11], 0 offen offset:128 sc1
    s_waitcnt vmcnt(0)
    s_branch K2_CK4
K2_RT5:
    s_sub_u32 s60, s60, 1
    s_cbranch_scc1 K2_END
    buffer_load_dwordx4 v[20:23], v181, s[8:11], 0 offen offset:160 sc1
    s_waitcnt vmcnt(0)
    s_branch K2_CK5
K2_RT6:
    s_sub_u32 s60, s60, 1
    s_cbranch_scc1 K2_END
    buffer_load_dwordx4 v[24:27], v181, s[8:11], 0 offen offset:192 sc1
    s_waitcnt vmcnt(0)
    s_branch K2_CK6
K2_RT7:
    s_sub_u32 s60, s60, 1
    s_cbranch_scc1 K2_END
    buffer_load_dwordx4 v[28:31], v181, s[8:11], 0 offen offset:224 sc1
    s_waitcnt vmcnt(0)
    s_branch K2_CK7
K2_RT8:
    s_sub_u32 s60, s60, 1
    s_cbranch_scc1 K2_END
    buffer_load_dwordx4 v[32:35], v181, s[8:11], 0 offen offset:256 sc1
    s_waitcnt vmcnt(0)
    s_branch K2_CK8
K2_RT9:
    s_sub_u32 s60, s60, 1
    s_cbranch_scc1 K2_END
    buffer_load_dwordx4 v[36:39], v181, s[8:11], 0 offen offset:288 sc1
    s_waitcnt vmcnt(0)
    s_branch K2_CK9
K2_RK_LOAD:
    s_waitcnt vmcnt(0)
    s_mov_b64 exec, s[40:41]
    s_cbranch_execz K2_RK_B
    v_lshrrev_b32 v50, 24, v3
    buffer_load_dword v40, v179, s[8:11], s66 offen offset:0
    v_mad_u32_u24 v50, v50, s58, v202
    v_and_b32 v3, 0xffffff, v3
    s_mov_b64 exec, s[42:43]
    s_cbranch_execz K2_RK_B
    v_lshrrev_b32 v51, 24, v7
    buffer_load_dword v41, v185, s[8:11], s66 offen
    v_mad_u32_u24 v51, v51, s58, v202
    v_and_b32 v7, 0xffffff, v7
    s_mov_b64 exec, s[44:45]
    s_cbranch_execz K2_RK_B
    v_lshrrev_b32 v52, 24, v11
    buffer_load_dword v42, v186, s[8:11], s66 offen
    v_mad_u32_u24 v52, v52, s58, v202
    v_and_b32 v11, 0xffffff, v11
    s_mov_b64 exec, s[46:47]
    s_cbranch_execz K2_RK_B
    v_lshrrev_b32 v53, 24, v15
    buffer_load_dword v43, v187, s[8:11], s66 offen
    v_mad_u32_u24 v53, v53, s58, v202
    v_and_b32 v15, 0xffffff, v15
    s_mov_b64 exec, s[48:49]
    s_cbranch_execz K2_RK_B
    v_lshrrev_b32 v54, 24, v19
    buffer_load_dword v44, v179, s[8:11], s66 offen offset:32
    v_mad_u32_u24 v54, v54, s58, v202
    v_and_b32 v19, 0xffffff, v19
    s_mov_b64 exec, s[50:51]
    s_cbranch_execz K2_RK_B
    v_lshrrev_b32 v55, 24, v23
    buffer_load_dword v45, v179, s[8:11], s66 offen offset:40
    v_mad_u32_u24 v55, v55, s58, v202
    v_and_b32 v23, 0xffffff, v23
    s_mov_b64 exec, s[90:91]
    s_cbranch_execz K2_RK_B
    v_lshrrev_b32 v56, 24, v27
    buffer_load_dword v46, v179, s[8:11], s66 offen offset:48
    v_mad_u32_u24 v56, v56, s58, v202
    v_and_b32 v27, 0xffffff, v27
    s_mov_b64 exec, s[92:93]
    s_cbranch_execz K2_RK_B
    v_lshrrev_b32 v57, 24, v31
    buffer_load_dword v47, v179, s[8:11], s66 offen offset:56
    v_mad_u32_u24 v57, v57, s58, v202
    v_and_b32 v31, 0xffffff, v31
    s_mov_b64 exec, s[94:95]
    s_cbranch_execz K2_RK_B
    v_lshrrev_b32 v58, 24, v35
    buffer_load_dword v48, v179, s[8:11], s66 offen offset:64
    v_mad_u32_u24 v58, v58, s58, v202
    v_and_b32 v35, 0xffffff, v35
    s_mov_b64 exec, s[96:97]
    s_cbranch_execz K2_RK_B
    v_lshrrev_b32 v59, 24, v39
    buffer_load_dword v49, v179, s[8:11], s66 offen offset:72
    v_mad_u32_u24 v59, v59, s58, v202
    v_and_b32 v39, 0xffffff, v39
K2_RK_B:
    s_mov_b64 exec, -1
    s_mul_i32 s62, s24, 48
    s_waitcnt vmcnt(0)
    v_subrev_u32 v40, s62, v40
    v_subrev_u32 v41, s62, v41
    v_subrev_u32 v42, s62, v42
    v_subrev_u32 v43, s62, v43
    v_subrev_u32 v44, s62, v44
    v_subrev_u32 v45, s62, v45
    v_subrev_u32 v46, s62, v46
    v_subrev_u32 v47, s62, v47
    v_subrev_u32 v48, s62, v48
    v_subrev_u32 v49, s62, v49
    s_branch K2_RK_DONE
K2_BIG:
    s_cmp_lg_u32 s24, 0
    s_cbranch_scc1 K2_TOK
    s_movk_i32 s26, 48
    v_mov_b32 v197, v193
    s_nop 1
    v_max_u32_dpp v197, v197, v197 row_shr:1 row_mask:0xf bank_mask:0xf bound_ctrl:0
    s_nop 1
    v_max_u32_dpp v197, v197, v197 row_shr:2 row_mask:0xf bank_mask:0xf bound_ctrl:0
    s_nop 1
    v_max_u32_dpp v197, v197, v197 row_shr:4 row_mask:0xf bank_mask:0xf bound_ctrl:0
    s_nop 1
    v_max_u32_dpp v197, v197, v197 row_shr:8 row_mask:0xf bank_mask:0xf bound_ctrl:0
    s_nop 1
    v_max_u32_dpp v197, v197, v197 row_bcast:15 row_mask:0xa bank_mask:0xf
    s_nop 1
    v_max_u32_dpp v197, v197, v197 row_bcast:31 row_mask:0xc bank_mask:0xf
    s_nop 0
    v_readlane_b32 s25, v197, 63
    s_nop 0
    s_add_u32 s25, s25, 47
    s_mul_i32 s25, s25, 43691
    s_lshr_b32 s25, s25, 21
    s_mov_b64 exec, s[40:41]
    s_cbranch_execz K2_SV_DONE
    buffer_store_dword v40, v179, s[8:11], s66 offen offset:0
    s_mov_b64 exec, s[42:43]
    s_cbranch_execz K2_SV_DONE
    buffer_store_dword v41, v185, s[8:11], s66 offen
    s_mov_b64 exec, s[44:45]
    s_cbranch_execz K2_SV_DONE
    buffer_store_dword v42, v186, s[8:11], s66 offen
    s_mov_b64 exec, s[46:47]
    s_cbranch_execz K2_SV_DONE
    buffer_store_dword v43, v187, s[8:11], s66 offen
    s_mov_b64 exec, s[48:49]
    s_cbranch_execz K2_SV_DONE
    buffer_store_dword v44, v179, s[8:11], s66 offen offset:32
    s_mov_b64 exec, s[50:51]
    s_cbranch_execz K2_SV_DONE
    buffer_store_dword v45, v179, s[8:11], s66 offen offset:40
    s_mov_b64 exec, s[90:91]
    s_cbranch_execz K2_SV_DONE
    buffer_store_dword v46, v179, s[8:11], s66 offen offset:48
    s_mov_b64 exec, s[92:93]
    s_cbranch_execz K2_SV_DONE
    buffer_store_dword v47, v179, s[8:11], s66 offen offset:56
    s_mov_b64 exec, s[94:95]
    s_cbranch_execz K2_SV_DONE
    buffer_store_dword v48, v179, s[8:11], s66 offen offset:64
    s_mov_b64 exec, s[96:97]
    s_cbranch_execz K2_SV_DONE
    buffer_store_dword v49, v179, s[8:11], s66 offen offset:72
K2_SV_DONE:
    s_mov_b64 exec, -1
    s_branch K2_TOK
K2_rare_1:
    s_cmp_eq_u32 s33, 4
    s_cbranch_scc1 K2_four_3
    s_mov_b32 s49, s48
    s_mov_b32 s51, s48
    s_xor_b32 s45, s44, 256
    s_xor_b32 s46, s44, 512
    s_xor_b32 s47, s44, 768
    s_branch K2_back_2
K2_four_3:
    s_add_u32 s50, s48, 256
    s_add_u32 s51, s48, 384
    s_mov_b32 s46, s44
    s_mov_b32 s47, s44
    s_branch K2_back_2
K2_a4_5:
    v_add_u32 v254, s48, v230
    ds_read_b32 v254, v254 offset:4
    s_lshr_b32 s65, s3, 27
    s_mul_i32 s66, s22, 2080
    s_lshl_b32 s65, s65, 9
    s_add_u32 s65, s65, s66
    s_add_u32 s65, s65, 65536
    s_mov_b32 m0, s65
    s_mov_b32 exec_hi, 0
    s_waitcnt lgkmcnt(0)
    v_or_b32 v254, v254, v231
    buffer_load_dwordx4 v254, s[16:19], 0 offen  lds
    s_mov_b32 exec_hi, -1
    s_branch K2_b4_7
K2_rare_14:
    s_cmp_eq_u32 s33, 4
    s_cbranch_scc1 K2_four_16
    s_mov_b32 s49, s48
    s_mov_b32 s51, s48
    s_xor_b32 s45, s44, 256
    s_xor_b32 s46, s44, 512
    s_xor_b32 s47, s44, 768
    s_branch K2_back_15
K2_four_16:
    s_add_u32 s50, s48, 256
    s_add_u32 s51, s48, 384
    s_mov_b32 s46, s44
    s_mov_b32 s47, s44
    s_branch K2_back_15
K2_a4_18:
    v_add_u32 v254, s48, v230
    ds_read_b32 v254, v254 offset:4
    s_lshr_b32 s65, s3, 27
    s_mul_i32 s66, s22, 2080
    s_lshl_b32 s65, s65, 9
    s_add_u32 s65, s65, s66
    s_add_u32 s65, s65, 65536
    s_mov_b32 m0, s65
    s_mov_b32 exec_hi, 0
    s_waitcnt lgkmcnt(0)
    v_or_b32 v254, v254, v231
    buffer_load_dwordx4 v254, s[16:19], 0 offen  lds
    s_mov_b32 exec_hi, -1
    s_branch K2_b4_20
K2_rare_27:
    s_cmp_eq_u32 s33, 4
    s_cbranch_scc1 K2_four_29
    s_mov_b32 s49, s48
    s_mov_b32 s51, s48
    s_xor_b32 s45, s44, 256
    s_xor_b32 s46, s44, 512
    s_xor_b32 s47, s44, 768
    s_branch K2_back_28
K2_four_29:
    s_add_u32 s50, s48, 256
    s_add_u32 s51, s48, 384
    s_mov_b32 s46, s44
    s_mov_b32 s47, s44
    s_branch K2_back_28
K2_a4_31:
    v_add_u32 v254, s48, v230
    ds_read_b32 v254, v254 offset:4
    s_lshr_b32 s65, s3, 27
    s_mul_i32 s66, s22, 2080
    s_lshl_b32 s65, s65, 9
    s_add_u32 s65, s65, s66
    s_add_u32 s65, s65, 65536
    s_mov_b32 m0, s65
    s_mov_b32 exec_hi, 0
    s_waitcnt lgkmcnt(0)
    v_or_b32 v254, v254, v231
    buffer_load_dwordx4 v254, s[16:19], 0 offen  lds
    s_mov_b32 exec_hi, -1
    s_branch K2_b4_33
K2_rare_40:
    s_cmp_eq_u32 s33, 4
    s_cbranch_scc1 K2_four_42
    s_mov_b32 s49, s48
    s_mov_b32 s51, s48
    s_xor_b32 s45, s44, 256
    s_xor_b32 s46, s44, 512
    s_xor_b32 s47, s44, 768
    s_branch K2_back_41
K2_four_42:
    s_add_u32 s50, s48, 256
    s_add_u32 s51, s48, 384
    s_mov_b32 s46, s44
    s_mov_b32 s47, s44
    s_branch K2_back_41
K2_a4_44:
    v_add_u32 v254, s48, v230
    ds_read_b32 v254, v254 offset:4
    s_lshr_b32 s65, s3, 27
    s_mul_i32 s66, s22, 2080
    s_lshl_b32 s65, s65, 9
    s_add_u32 s65, s65, s66
    s_add_u32 s65, s65, 65536
    s_mov_b32 m0, s65
    s_mov_b32 exec_hi, 0
    s_waitcnt lgkmcnt(0)
    v_or_b32 v254, v254, v231
    buffer_load_dwordx4 v254, s[16:19], 0 offen  lds
    s_mov_b32 exec_hi, -1
    s_branch K2_b4_46
K2_rare_51:
    s_cmp_eq_u32 s33, 4
    s_cbranch_scc1 K2_four_53
    s_mov_b32 s49, s48
    s_mov_b32 s51, s48
    s_xor_b32 s45, s44, 256
    s_xor_b32 s46, s44, 512
    s_xor_b32 s47, s44, 768
    s_branch K2_back_52
K2_four_53:
    s_add_u32 s50, s48, 256
    s_add_u32 s51, s48, 384
    s_mov_b32 s46, s44
    s_mov_b32 s47, s44
    s_branch K2_back_52
K2_rare_58:
    s_cmp_eq_u32 s33, 4
    s_cbranch_scc1 K2_four_60
    s_mov_b32 s49, s48
    s_mov_b32 s51, s48
    s_xor_b32 s45, s44, 256
    s_xor_b32 s46, s44, 512
    s_xor_b32 s47, s44, 768
    s_branch K2_back_59
K2_four_60:
    s_add_u32 s50, s48, 256
    s_add_u32 s51, s48, 384
    s_mov_b32 s46, s44
    s_mov_b32 s47, s44
    s_branch K2_back_59
K2_rare_65:
    s_cmp_eq_u32 s33, 4
    s_cbranch_scc1 K2_four_67
    s_mov_b32 s49, s48
    s_mov_b32 s51, s48
    s_xor_b32 s45, s44, 256
    s_xor_b32 s46, s44, 512
    s_xor_b32 s47, s44, 768
    s_branch K2_back_66
K2_four_67:
    s_add_u32 s50, s48, 256
    s_add_u32 s51, s48, 384
    s_mov_b32 s46, s44
    s_mov_b32 s47, s44
    s_branch K2_back_66
K2_U10:
    s_setprio 1
    s_add_u32 s38, s38, 1
    v_mov_b32 v254, s52
    v_mov_b32 v255, s38
    s_lshl_b32 s58, s38, 3
    s_add_u32 s58, s58, s20
    s_mov_b64 exec, 1
    ds_write_b32 v254, v255
    s_mov_b64 exec, -1
    s_cmp_lt_u32 s58, s22
    s_cbranch_scc0 K2_dyn_68
K2_back_69:
    s_waitcnt lgkmcnt(4)
    v_lshlrev_b32 v20, 16, v0
    v_and_b32 v21, 0xffff0000, v0
    v_lshlrev_b32 v22, 16, v1
    v_and_b32 v23, 0xffff0000, v1
    v_lshlrev_b32 v24, 16, v2
    v_and_b32 v25, 0xffff0000, v2
    v_lshlrev_b32 v26, 16, v3
    v_and_b32 v27, 0xffff0000, v3
    v_mul_f32_dpp v36, v16, v20 row_newbcast:8 row_mask:0xf bank_mask:0xf
    v_mul_f32_dpp v37, v16, v21 row_newbcast:9 row_mask:0xf bank_mask:0xf
    v_mul_f32_dpp v38, v16, v22 row_newbcast:10 row_mask:0xf bank_mask:0xf
    v_mul_f32_dpp v39, v16, v23 row_newbcast:11 row_mask:0xf bank_mask:0xf
    v_mul_f32_dpp v40, v16, v24 row_newbcast:12 row_mask:0xf bank_mask:0xf
    v_mul_f32_dpp v41, v16, v25 row_newbcast:13 row_mask:0xf bank_mask:0xf
    v_mul_f32_dpp v42, v16, v26 row_newbcast:14 row_mask:0xf bank_mask:0xf
    v_mul_f32_dpp v43, v16, v27 row_newbcast:15 row_mask:0xf bank_mask:0xf
    v_cvt_pk_bf16_f32 v68, v36, v37
    v_cvt_pk_bf16_f32 v69, v38, v39
    v_cvt_pk_bf16_f32 v70, v40, v41
    v_cvt_pk_bf16_f32 v71, v42, v43
    v_mul_f32_dpp v20, v16, v20 row_newbcast:0 row_mask:0xa bank_mask:0xf
    v_mul_f32_dpp v21, v16, v21 row_newbcast:1 row_mask:0xa bank_mask:0xf
    v_mul_f32_dpp v22, v16, v22 row_newbcast:2 row_mask:0xa bank_mask:0xf
    v_mul_f32_dpp v23, v16, v23 row_newbcast:3 row_mask:0xa bank_mask:0xf
    v_mul_f32_dpp v24, v16, v24 row_newbcast:4 row_mask:0xa bank_mask:0xf
    v_mul_f32_dpp v25, v16, v25 row_newbcast:5 row_mask:0xa bank_mask:0xf
    v_mul_f32_dpp v26, v16, v26 row_newbcast:6 row_mask:0xa bank_mask:0xf
    v_mul_f32_dpp v27, v16, v27 row_newbcast:7 row_mask:0xa bank_mask:0xf
    v_cvt_pk_bf16_f32 v64, v20, v21
    v_cvt_pk_bf16_f32 v65, v22, v23
    v_cvt_pk_bf16_f32 v66, v24, v25
    v_cvt_pk_bf16_f32 v67, v26, v27
    v_readlane_b32 s3, v253, s58
    s_lshl_b32 s44, s34, 7
    s_and_b32 s48, s3, 0x3ffff
    s_bfe_u32 s33, s3, 0x30013
    s_mul_i32 s35, s38, 6
    s_cmp_eq_u32 s34, 0
    s_cselect_b32 s35, s35, s48
    s_mov_b32 s45, s44
    s_xor_b32 s47, s44, 256
    s_add_u32 s49, s48, 128
    s_add_u32 s60, s48, 256
    s_cmp_eq_u32 s33, 3
    s_cselect_b32 s46, s44, s47
    s_cselect_b32 s50, s60, s48
    s_cselect_b32 s51, s48, s49
    s_sub_u32 s60, s33, 2
    s_cmp_lt_u32 s60, 2
    s_cbranch_scc0 K2_rare_74
K2_back_75:
    v_add_u32 v233, s48, v230
    ds_read_b32 v232, v233
    ds_read_b32 v233, v233 offset:1024
    v_add_u32 v222, s48, v251
    ds_read2_b32 v[222:223], v222 offset0:1 offset1:3
    v_add_u32 v224, s49, v251
    ds_read2_b32 v[224:225], v224 offset0:1 offset1:3
    v_add_u32 v226, s50, v251
    ds_read2_b32 v[226:227], v226 offset0:1 offset1:3
    v_add_u32 v228, s51, v251
    ds_read2_b32 v[228:229], v228 offset0:1 offset1:3
    s_waitcnt lgkmcnt(4)
    v_or_b32 v232, v232, v231
    v_or_b32 v233, v233, v231
    s_cmp_lg_u32 s34, 0
    s_cbranch_scc1 K2_dum_77
    s_cmp_eq_u32 s33, 4
    s_cbranch_scc1 K2_a4_78
K2_b4_80:
    s_add_u32 m0, s48, 512
    s_add_u32 s65, s48, 1536
    buffer_load_dwordx4 v232, s[16:19], 0 offen  lds
    s_mov_b32 m0, s65
    s_mov_b32 exec_hi, 0
    buffer_load_dwordx4 v233, s[16:19], 0 offen  lds
    s_mov_b32 exec_hi, -1
K2_back_79:
    s_waitcnt lgkmcnt(3)
    v_mad_u32_u16 v222, v222, s39, v248 op_sel:[1,0,0,0]
    v_mad_u32_u16 v223, v223, s39, v248 op_sel:[1,0,0,0]
    s_waitcnt lgkmcnt(2)
    v_mad_u32_u16 v224, v224, s39, v248 op_sel:[1,0,0,0]
    v_mad_u32_u16 v225, v225, s39, v248 op_sel:[1,0,0,0]
    s_waitcnt lgkmcnt(1)
    v_mad_u32_u16 v226, v226, s39, v248 op_sel:[1,0,0,0]
    v_mad_u32_u16 v227, v227, s39, v248 op_sel:[1,0,0,0]
    s_waitcnt lgkmcnt(0)
    v_mad_u32_u16 v228, v228, s39, v248 op_sel:[1,0,0,0]
    v_mad_u32_u16 v229, v229, s39, v248 op_sel:[1,0,0,0]
    s_waitcnt vmcnt(6)
    v_mfma_f32_32x32x16_bf16 v[0:15], v[64:67], v[176:179], 0
    ds_read_b64_tr_b16 v[184:185], v246 offset:2048
    ds_read_b64_tr_b16 v[186:187], v246 offset:3072
    ds_read_b64_tr_b16 v[188:189], v247 offset:2048
    ds_read_b64_tr_b16 v[190:191], v247 offset:3072
    s_mov_b32 m0, s68
    v_mfma_f32_32x32x16_bf16 v[16:31], v[68:71], v[176:179], 0
    buffer_load_dwordx4 v222, s[4:7], s44 offen sc1 lds
    buffer_load_dwordx4 v223, s[72:75], s44 offen offset:1024 sc1 lds
    v_permlane32_swap_b32 v242, v236
    v_permlane32_swap_b32 v243, v237
    v_mfma_f32_32x32x16_bf16 v[32:47], v[64:67], v[180:183], 0
    v_permlane32_swap_b32 v244, v238
    v_permlane32_swap_b32 v245, v239
    v_permlane32_swap_b32 v240, v241
    v_add_f32 v242, v242, v236
    v_mfma_f32_32x32x16_bf16 v[48:63], v[68:71], v[180:183], 0
    s_setprio 0
    v_add_f32 v243, v243, v237
    v_add_f32 v244, v244, v238
    v_add_f32 v245, v245, v239
    v_add_f32 v240, -v240, -v241
    s_set_gpr_idx_on s32, gpr_idx(DST)
    s_nop 0
    v_cvt_pk_bf16_f32 v195, v242, v243
    v_cvt_pk_bf16_f32 v196, v244, v245
    v_cvt_pk_bf16_f32 v197, v240, v240
    s_set_gpr_idx_off
    v_mul_f32 v234, v0, v96
    v_mul_f32 v236, v8, v128
    v_fmac_f32 v234, v1, v97
    v_fmac_f32 v236, v9, v129
    v_fmac_f32 v234, v2, v98
    v_fmac_f32 v236, v10, v130
    v_fmac_f32 v234, v3, v99
    v_fmac_f32 v236, v11, v131
    v_fmac_f32 v234, v4, v100
    v_fmac_f32 v236, v12, v132
    v_fmac_f32 v234, v5, v101
    v_fmac_f32 v236, v13, v133
    v_fmac_f32 v234, v6, v102
    v_fmac_f32 v236, v14, v134
    v_fmac_f32 v234, v7, v103
    v_fmac_f32 v236, v15, v135
    v_mul_f32 v238, v16, v128
    v_mul_f32 v240, v24, v128
    v_fmac_f32 v238, v17, v129
    v_fmac_f32 v240, v25, v129
    v_fmac_f32 v238, v18, v130
    v_fmac_f32 v240, v26, v130
    v_fmac_f32 v238, v19, v131
    v_fmac_f32 v240, v27, v131
    v_fmac_f32 v238, v20, v132
    v_fmac_f32 v240, v28, v132
    v_fmac_f32 v238, v21, v133
    v_fmac_f32 v240, v29, v133
    v_fmac_f32 v238, v22, v134
    v_fmac_f32 v240, v30, v134
    v_fmac_f32 v238, v23, v135
    v_fmac_f32 v240, v31, v135
    v_mul_f32 v235, v32, v104
    v_mul_f32 v237, v40, v136
    v_fmac_f32 v235, v33, v105
    v_fmac_f32 v237, v41, v137
    v_fmac_f32 v235, v34, v106
    v_fmac_f32 v237, v42, v138
    v_fmac_f32 v235, v35, v107
    v_fmac_f32 v237, v43, v139
    v_fmac_f32 v235, v36, v108
    v_fmac_f32 v237, v44, v140
    v_fmac_f32 v235, v37, v109
    v_fmac_f32 v237, v45, v141
    v_fmac_f32 v235, v38, v110
    v_fmac_f32 v237, v46, v142
    v_fmac_f32 v235, v39, v111
    v_fmac_f32 v237, v47, v143
    v_mul_f32 v239, v48, v136
    v_mul_f32 v241, v56, v136
    v_fmac_f32 v239, v49, v137
    v_fmac_f32 v241, v57, v137
    v_fmac_f32 v239, v50, v138
    v_fmac_f32 v241, v58, v138
    v_fmac_f32 v239, v51, v139
    v_fmac_f32 v241, v59, v139
    v_fmac_f32 v239, v52, v140
    v_fmac_f32 v241, v60, v140
    v_fmac_f32 v239, v53, v141
    v_fmac_f32 v241, v61, v141
    v_fmac_f32 v239, v54, v142
    v_fmac_f32 v241, v62, v142
    v_fmac_f32 v239, v55, v143
    v_fmac_f32 v241, v63, v143
    s_setprio 1
    s_waitcnt vmcnt(6) lgkmcnt(0)
    v_mfma_f32_32x32x16_bf16 v[0:15], v[64:67], v[184:187], 0
    ds_read_b64_tr_b16 v[176:177], v246 offset:4096
    ds_read_b64_tr_b16 v[178:179], v246 offset:5120
    ds_read_b64_tr_b16 v[180:181], v247 offset:4096
    ds_read_b64_tr_b16 v[182:183], v247 offset:5120
    s_mov_b32 m0, s69
    v_mfma_f32_32x32x16_bf16 v[16:31], v[68:71], v[184:187], 0
    buffer_load_dwordx4 v224, s[4:7], s45 offen sc1 lds
    buffer_load_dwordx4 v225, s[72:75], s45 offen offset:1024 sc1 lds
    v_permlane32_swap_b32 v234, v236
    v_permlane32_swap_b32 v235, v237
    v_mfma_f32_32x32x16_bf16 v[32:47], v[64:67], v[188:191], 0
    v_permlane32_swap_b32 v240, v238
    v_permlane32_swap_b32 v241, v239
    v_add_f32 v234, v234, v236
    v_add_f32 v235, v235, v237
    v_add_f32 v240, v240, v238
    v_mfma_f32_32x32x16_bf16 v[48:63], v[68:71], v[188:191], 0
    s_setprio 0
    v_add_f32 v241, v241, v239
    s_set_gpr_idx_on s31, gpr_idx(DST)
    s_nop 0
    v_cvt_pk_bf16_f32 v192, v234, v235
    v_cvt_pk_bf16_f32 v193, v240, v241
    s_set_gpr_idx_off
    v_mul_f32 v234, v0, v144
    v_mul_f32 v236, v8, v112
    v_fmac_f32 v234, v1, v145
    v_fmac_f32 v236, v9, v113
    v_fmac_f32 v234, v2, v146
    v_fmac_f32 v236, v10, v114
    v_fmac_f32 v234, v3, v147
    v_fmac_f32 v236, v11, v115
    v_fmac_f32 v234, v4, v148
    v_fmac_f32 v236, v12, v116
    v_fmac_f32 v234, v5, v149
    v_fmac_f32 v236, v13, v117
    v_fmac_f32 v234, v6, v150
    v_fmac_f32 v236, v14, v118
    v_fmac_f32 v234, v7, v151
    v_fmac_f32 v236, v15, v119
    v_mul_f32 v238, v16, v160
    v_mul_f32 v240, v24, v160
    v_fmac_f32 v238, v17, v161
    v_fmac_f32 v240, v25, v161
    v_fmac_f32 v238, v18, v162
    v_fmac_f32 v240, v26, v162
    v_fmac_f32 v238, v19, v163
    v_fmac_f32 v240, v27, v163
    v_fmac_f32 v238, v20, v164
    v_fmac_f32 v240, v28, v164
    v_fmac_f32 v238, v21, v165
    v_fmac_f32 v240, v29, v165
    v_fmac_f32 v238, v22, v166
    v_fmac_f32 v240, v30, v166
    v_fmac_f32 v238, v23, v167
    v_fmac_f32 v240, v31, v167
    v_mul_f32 v235, v32, v152
    v_mul_f32 v237, v40, v120
    v_fmac_f32 v235, v33, v153
    v_fmac_f32 v237, v41, v121
    v_fmac_f32 v235, v34, v154
    v_fmac_f32 v237, v42, v122
    v_fmac_f32 v235, v35, v155
    v_fmac_f32 v237, v43, v123
    v_fmac_f32 v235, v36, v156
    v_fmac_f32 v237, v44, v124
    v_fmac_f32 v235, v37, v157
    v_fmac_f32 v237, v45, v125
    v_fmac_f32 v235, v38, v158
    v_fmac_f32 v237, v46, v126
    v_fmac_f32 v235, v39, v159
    v_fmac_f32 v237, v47, v127
    v_mul_f32 v239, v48, v168
    v_mul_f32 v241, v56, v168
    v_fmac_f32 v239, v49, v169
    v_fmac_f32 v241, v57, v169
    v_fmac_f32 v239, v50, v170
    v_fmac_f32 v241, v58, v170
    v_fmac_f32 v239, v51, v171
    v_fmac_f32 v241, v59, v171
    v_fmac_f32 v239, v52, v172
    v_fmac_f32 v241, v60, v172
    v_fmac_f32 v239, v53, v173
    v_fmac_f32 v241, v61, v173
    v_fmac_f32 v239, v54, v174
    v_fmac_f32 v241, v62, v174
    v_fmac_f32 v239, v55, v175
    v_fmac_f32 v241, v63, v175
    s_setprio 1
    s_waitcnt vmcnt(6) lgkmcnt(0)
    v_mfma_f32_32x32x16_bf16 v[0:15], v[64:67], v[176:179], 0
    ds_read_b64_tr_b16 v[184:185], v246 offset:6144
    ds_read_b64_tr_b16 v[186:187], v246 offset:7168
    ds_read_b64_tr_b16 v[188:189], v247 offset:6144
    ds_read_b64_tr_b16 v[190:191], v247 offset:7168
    s_mov_b32 m0, s70
    v_mfma_f32_32x32x16_bf16 v[16:31], v[68:71], v[176:179], 0
    buffer_load_dwordx4 v226, s[4:7], s46 offen sc1 lds
    buffer_load_dwordx4 v227, s[72:75], s46 offen offset:1024 sc1 lds
    s_sub_u32 s26, s48, s29
    s_mov_b32 s29, s48
    s_mov_b32 s30, s3
    s_bfe_u32 s56, s3, 0x40012
    v_mfma_f32_32x32x16_bf16 v[32:47], v[64:67], v[180:183], 0
    s_cmp_eq_u32 s34, 0
    s_cselect_b32 s56, s56, 0
    v_mfma_f32_32x32x16_bf16 v[48:63], v[68:71], v[180:183], 0
    s_setprio 0
    v_mul_f32 v242, v0, v144
    v_fma_f32 v238, v8, v160, -v238
    v_fmac_f32 v242, v1, v145
    v_fmac_f32 v238, v9, v161
    v_fmac_f32 v242, v2, v146
    v_fmac_f32 v238, v10, v162
    v_fmac_f32 v242, v3, v147
    v_fmac_f32 v238, v11, v163
    v_fmac_f32 v242, v4, v148
    v_fmac_f32 v238, v12, v164
    v_fmac_f32 v242, v5, v149
    v_fmac_f32 v238, v13, v165
    v_fmac_f32 v242, v6, v150
    v_fmac_f32 v238, v14, v166
    v_fmac_f32 v242, v7, v151
    v_fmac_f32 v238, v15, v167
    v_fmac_f32 v236, v16, v112
    v_mul_f32 v244, v24, v160
    v_fmac_f32 v236, v17, v113
    v_fmac_f32 v244, v25, v161
    v_fmac_f32 v236, v18, v114
    v_fmac_f32 v244, v26, v162
    v_fmac_f32 v236, v19, v115
    v_fmac_f32 v244, v27, v163
    v_fmac_f32 v236, v20, v116
    v_fmac_f32 v244, v28, v164
    v_fmac_f32 v236, v21, v117
    v_fmac_f32 v244, v29, v165
    v_fmac_f32 v236, v22, v118
    v_fmac_f32 v244, v30, v166
    v_fmac_f32 v236, v23, v119
    v_fmac_f32 v244, v31, v167
    v_mul_f32 v243, v32, v152
    v_fma_f32 v239, v40, v168, -v239
    v_fmac_f32 v243, v33, v153
    v_fmac_f32 v239, v41, v169
    v_fmac_f32 v243, v34, v154
    v_fmac_f32 v239, v42, v170
    v_fmac_f32 v243, v35, v155
    v_fmac_f32 v239, v43, v171
    v_fmac_f32 v243, v36, v156
    v_fmac_f32 v239, v44, v172
    v_fmac_f32 v243, v37, v157
    v_fmac_f32 v239, v45, v173
    v_fmac_f32 v243, v38, v158
    v_fmac_f32 v239, v46, v174
    v_fmac_f32 v243, v39, v159
    v_fmac_f32 v239, v47, v175
    v_fmac_f32 v237, v48, v120
    v_mul_f32 v245, v56, v168
    v_fmac_f32 v237, v49, v121
    v_fmac_f32 v245, v57, v169
    v_fmac_f32 v237, v50, v122
    v_fmac_f32 v245, v58, v170
    v_fmac_f32 v237, v51, v123
    v_fmac_f32 v245, v59, v171
    v_fmac_f32 v237, v52, v124
    v_fmac_f32 v245, v60, v172
    v_fmac_f32 v237, v53, v125
    v_fmac_f32 v245, v61, v173
    v_fmac_f32 v237, v54, v126
    v_fmac_f32 v245, v62, v174
    v_fmac_f32 v237, v55, v127
    v_fmac_f32 v245, v63, v175
    s_setprio 1
    s_waitcnt vmcnt(4) lgkmcnt(0)
    v_mfma_f32_32x32x16_bf16 v[0:15], v[64:67], v[184:187], 0
    ds_read_b64_tr_b16 v[176:177], v246 offset:0
    ds_read_b64_tr_b16 v[178:179], v246 offset:1024
    ds_read_b64_tr_b16 v[180:181], v247 offset:0
    ds_read_b64_tr_b16 v[182:183], v247 offset:1024
    s_mov_b32 m0, s71
    v_mfma_f32_32x32x16_bf16 v[16:31], v[68:71], v[184:187], 0
    buffer_load_dwordx4 v228, s[4:7], s47 offen sc1 lds
    buffer_load_dwordx4 v229, s[72:75], s47 offen offset:1024 sc1 lds
    v_permlane32_swap_b32 v242, v234
    v_permlane32_swap_b32 v243, v235
    v_add_f32 v242, v242, v234
    v_mfma_f32_32x32x16_bf16 v[32:47], v[64:67], v[188:191], 0
    v_add_f32 v243, v243, v235
    s_set_gpr_idx_on s31, gpr_idx(DST)
    s_nop 0
    v_cvt_pk_bf16_f32 v194, v242, v243
    s_set_gpr_idx_off
    s_mov_b32 s32, s31
    s_mov_b32 s31, s35
    v_mfma_f32_32x32x16_bf16 v[48:63], v[68:71], v[188:191], 0
    s_setprio 0
    v_mul_f32 v242, v0, v144
    v_fma_f32 v240, v8, v160, -v240
    v_fmac_f32 v242, v1, v145
    v_fmac_f32 v240, v9, v161
    v_fmac_f32 v242, v2, v146
    v_fmac_f32 v240, v10, v162
    v_fmac_f32 v242, v3, v147
    v_fmac_f32 v240, v11, v163
    v_fmac_f32 v242, v4, v148
    v_fmac_f32 v240, v12, v164
    v_fmac_f32 v242, v5, v149
    v_fmac_f32 v240, v13, v165
    v_fmac_f32 v242, v6, v150
    v_fmac_f32 v240, v14, v166
    v_fmac_f32 v242, v7, v151
    v_fmac_f32 v240, v15, v167
    v_add_u32 v249, s26, v249
    v_add_u32 v250, s26, v250
    v_fma_f32 v244, v16, v160, -v244
    v_fmac_f32 v236, v24, v112
    v_fmac_f32 v244, v17, v161
    v_fmac_f32 v236, v25, v113
    v_fmac_f32 v244, v18, v162
    v_fmac_f32 v236, v26, v114
    v_fmac_f32 v244, v19, v163
    v_fmac_f32 v236, v27, v115
    v_fmac_f32 v244, v20, v164
    v_fmac_f32 v236, v28, v116
    v_fmac_f32 v244, v21, v165
    v_fmac_f32 v236, v29, v117
    v_fmac_f32 v244, v22, v166
    v_fmac_f32 v236, v30, v118
    v_fmac_f32 v244, v23, v167
    v_fmac_f32 v236, v31, v119
    ds_read_b64_tr_b16 v[0:1], v249 offset:0
    ds_read_b64_tr_b16 v[2:3], v249 offset:32
    ds_read_u16_d16_hi v16, v250 offset:0
    v_mul_f32 v243, v32, v152
    v_fma_f32 v241, v40, v168, -v241
    v_fmac_f32 v243, v33, v153
    v_fmac_f32 v241, v41, v169
    v_fmac_f32 v243, v34, v154
    v_fmac_f32 v241, v42, v170
    v_fmac_f32 v243, v35, v155
    v_fmac_f32 v241, v43, v171
    v_fmac_f32 v243, v36, v156
    v_fmac_f32 v241, v44, v172
    v_fmac_f32 v243, v37, v157
    v_fmac_f32 v241, v45, v173
    v_fmac_f32 v243, v38, v158
    v_fmac_f32 v241, v46, v174
    v_fmac_f32 v243, v39, v159
    v_fmac_f32 v241, v47, v175
    ds_read_b64_tr_b16 v[4:5], v249 offset:512
    ds_read_b64_tr_b16 v[6:7], v249 offset:544
    ds_read_u16_d16_hi v17, v250 offset:128
    v_fma_f32 v245, v48, v168, -v245
    v_fmac_f32 v237, v56, v120
    v_fmac_f32 v245, v49, v169
    v_fmac_f32 v237, v57, v121
    v_fmac_f32 v245, v50, v170
    v_fmac_f32 v237, v58, v122
    v_fmac_f32 v245, v51, v171
    v_fmac_f32 v237, v59, v123
    v_fmac_f32 v245, v52, v172
    v_fmac_f32 v237, v60, v124
    v_fmac_f32 v245, v53, v173
    v_fmac_f32 v237, v61, v125
    v_fmac_f32 v245, v54, v174
    v_fmac_f32 v237, v62, v126
    v_fmac_f32 v245, v55, v175
    v_fmac_f32 v237, v63, v127
    s_cmp_eq_u32 s56, 5
    s_cbranch_scc1 K2_U20
    s_cmp_eq_u32 s56, 6
    s_cbranch_scc1 K2_U3h0
    s_branch K2_DSP0
K2_U40:
    s_setprio 1
    ds_read_b64_tr_b16 v[8:9], v249 offset:1024
    ds_read_b64_tr_b16 v[10:11], v249 offset:1056
    ds_read_u16_d16_hi v18, v250 offset:256
    s_lshr_b32 s65, s30, 27
    s_mul_i32 s66, s22, 2080
    s_lshl_b32 s65, s65, 9
    s_add_u32 s65, s65, s66
    s_add_u32 s65, s65, 65536
    s_sub_u32 s65, s65, s29
    s_sub_u32 s65, s65, 512
    v_add_u32 v56, s65, v249
    ds_read_b64_tr_b16 v[12:13], v56 offset:0
    ds_read_b64_tr_b16 v[14:15], v56 offset:32
    ds_read_u16_d16_hi v19, v250 offset:384
    s_waitcnt lgkmcnt(6)
    v_lshlrev_b32 v20, 16, v0
    v_and_b32 v21, 0xffff0000, v0
    v_lshlrev_b32 v22, 16, v1
    v_and_b32 v23, 0xffff0000, v1
    v_lshlrev_b32 v24, 16, v2
    v_and_b32 v25, 0xffff0000, v2
    v_lshlrev_b32 v26, 16, v3
    v_and_b32 v27, 0xffff0000, v3
    v_mul_f32_dpp v36, v16, v20 row_newbcast:8 row_mask:0xf bank_mask:0xf
    v_mul_f32_dpp v37, v16, v21 row_newbcast:9 row_mask:0xf bank_mask:0xf
    v_mul_f32_dpp v38, v16, v22 row_newbcast:10 row_mask:0xf bank_mask:0xf
    v_mul_f32_dpp v39, v16, v23 row_newbcast:11 row_mask:0xf bank_mask:0xf
    v_mul_f32_dpp v40, v16, v24 row_newbcast:12 row_mask:0xf bank_mask:0xf
    v_mul_f32_dpp v41, v16, v25 row_newbcast:13 row_mask:0xf bank_mask:0xf
    v_mul_f32_dpp v42, v16, v26 row_newbcast:14 row_mask:0xf bank_mask:0xf
    v_mul_f32_dpp v43, v16, v27 row_newbcast:15 row_mask:0xf bank_mask:0xf
    v_cvt_pk_bf16_f32 v68, v36, v37
    v_cvt_pk_bf16_f32 v69, v38, v39
    v_cvt_pk_bf16_f32 v70, v40, v41
    v_cvt_pk_bf16_f32 v71, v42, v43
    v_mul_f32_dpp v20, v16, v20 row_newbcast:0 row_mask:0xa bank_mask:0xf
    v_mul_f32_dpp v21, v16, v21 row_newbcast:1 row_mask:0xa bank_mask:0xf
    v_mul_f32_dpp v22, v16, v22 row_newbcast:2 row_mask:0xa bank_mask:0xf
    v_mul_f32_dpp v23, v16, v23 row_newbcast:3 row_mask:0xa bank_mask:0xf
    v_mul_f32_dpp v24, v16, v24 row_newbcast:4 row_mask:0xa bank_mask:0xf
    v_mul_f32_dpp v25, v16, v25 row_newbcast:5 row_mask:0xa bank_mask:0xf
    v_mul_f32_dpp v26, v16, v26 row_newbcast:6 row_mask:0xa bank_mask:0xf
    v_mul_f32_dpp v27, v16, v27 row_newbcast:7 row_mask:0xa bank_mask:0xf
    v_cvt_pk_bf16_f32 v64, v20, v21
    v_cvt_pk_bf16_f32 v65, v22, v23
    v_cvt_pk_bf16_f32 v66, v24, v25
    v_cvt_pk_bf16_f32 v67, v26, v27
    v_lshlrev_b32 v28, 16, v4
    v_and_b32 v29, 0xffff0000, v4
    v_lshlrev_b32 v30, 16, v5
    v_and_b32 v31, 0xffff0000, v5
    v_lshlrev_b32 v32, 16, v6
    v_and_b32 v33, 0xffff0000, v6
    v_lshlrev_b32 v34, 16, v7
    v_and_b32 v35, 0xffff0000, v7
    v_mul_f32_dpp v36, v17, v28 row_newbcast:8 row_mask:0xf bank_mask:0xf
    v_mul_f32_dpp v37, v17, v29 row_newbcast:9 row_mask:0xf bank_mask:0xf
    v_mul_f32_dpp v38, v17, v30 row_newbcast:10 row_mask:0xf bank_mask:0xf
    v_mul_f32_dpp v39, v17, v31 row_newbcast:11 row_mask:0xf bank_mask:0xf
    v_mul_f32_dpp v40, v17, v32 row_newbcast:12 row_mask:0xf bank_mask:0xf
    v_mul_f32_dpp v41, v17, v33 row_newbcast:13 row_mask:0xf bank_mask:0xf
    v_mul_f32_dpp v42, v17, v34 row_newbcast:14 row_mask:0xf bank_mask:0xf
    v_mul_f32_dpp v43, v17, v35 row_newbcast:15 row_mask:0xf bank_mask:0xf
    v_cvt_pk_bf16_f32 v76, v36, v37
    v_cvt_pk_bf16_f32 v77, v38, v39
    v_cvt_pk_bf16_f32 v78, v40, v41
    v_cvt_pk_bf16_f32 v79, v42, v43
    v_mul_f32_dpp v28, v17, v28 row_newbcast:0 row_mask:0xa bank_mask:0xf
    v_mul_f32_dpp v29, v17, v29 row_newbcast:1 row_mask:0xa bank_mask:0xf
    v_mul_f32_dpp v30, v17, v30 row_newbcast:2 row_mask:0xa bank_mask:0xf
    v_mul_f32_dpp v31, v17, v31 row_newbcast:3 row_mask:0xa bank_mask:0xf
    v_mul_f32_dpp v32, v17, v32 row_newbcast:4 row_mask:0xa bank_mask:0xf
    v_mul_f32_dpp v33, v17, v33 row_newbcast:5 row_mask:0xa bank_mask:0xf
    v_mul_f32_dpp v34, v17, v34 row_newbcast:6 row_mask:0xa bank_mask:0xf
    v_mul_f32_dpp v35, v17, v35 row_newbcast:7 row_mask:0xa bank_mask:0xf
    v_cvt_pk_bf16_f32 v72, v28, v29
    v_cvt_pk_bf16_f32 v73, v30, v31
    v_cvt_pk_bf16_f32 v74, v32, v33
    v_cvt_pk_bf16_f32 v75, v34, v35
    s_waitcnt lgkmcnt(3)
    v_lshlrev_b32 v20, 16, v8
    v_and_b32 v21, 0xffff0000, v8
    v_lshlrev_b32 v22, 16, v9
    v_and_b32 v23, 0xffff0000, v9
    v_lshlrev_b32 v24, 16, v10
    v_and_b32 v25, 0xffff0000, v10
    v_lshlrev_b32 v26, 16, v11
    v_and_b32 v27, 0xffff0000, v11
    v_mul_f32_dpp v36, v18, v20 row_newbcast:8 row_mask:0xf bank_mask:0xf
    v_mul_f32_dpp v37, v18, v21 row_newbcast:9 row_mask:0xf bank_mask:0xf
    v_mul_f32_dpp v38, v18, v22 row_newbcast:10 row_mask:0xf bank_mask:0xf
    v_mul_f32_dpp v39, v18, v23 row_newbcast:11 row_mask:0xf bank_mask:0xf
    v_mul_f32_dpp v40, v18, v24 row_newbcast:12 row_mask:0xf bank_mask:0xf
    v_mul_f32_dpp v41, v18, v25 row_newbcast:13 row_mask:0xf bank_mask:0xf
    v_mul_f32_dpp v42, v18, v26 row_newbcast:14 row_mask:0xf bank_mask:0xf
    v_mul_f32_dpp v43, v18, v27 row_newbcast:15 row_mask:0xf bank_mask:0xf
    v_cvt_pk_bf16_f32 v84, v36, v37
    v_cvt_pk_bf16_f32 v85, v38, v39
    v_cvt_pk_bf16_f32 v86, v40, v41
    v_cvt_pk_bf16_f32 v87, v42, v43
    v_mul_f32_dpp v20, v18, v20 row_newbcast:0 row_mask:0xa bank_mask:0xf
    v_mul_f32_dpp v21, v18, v21 row_newbcast:1 row_mask:0xa bank_mask:0xf
    v_mul_f32_dpp v22, v18, v22 row_newbcast:2 row_mask:0xa bank_mask:0xf
    v_mul_f32_dpp v23, v18, v23 row_newbcast:3 row_mask:0xa bank_mask:0xf
    v_mul_f32_dpp v24, v18, v24 row_newbcast:4 row_mask:0xa bank_mask:0xf
    v_mul_f32_dpp v25, v18, v25 row_newbcast:5 row_mask:0xa bank_mask:0xf
    v_mul_f32_dpp v26, v18, v26 row_newbcast:6 row_mask:0xa bank_mask:0xf
    v_mul_f32_dpp v27, v18, v27 row_newbcast:7 row_mask:0xa bank_mask:0xf
    v_cvt_pk_bf16_f32 v80, v20, v21
    v_cvt_pk_bf16_f32 v81, v22, v23
    v_cvt_pk_bf16_f32 v82, v24, v25
    v_cvt_pk_bf16_f32 v83, v26, v27
    s_waitcnt lgkmcnt(0)
    v_lshlrev_b32 v28, 16, v12
    v_and_b32 v29, 0xffff0000, v12
    v_lshlrev_b32 v30, 16, v13
    v_and_b32 v31, 0xffff0000, v13
    v_lshlrev_b32 v32, 16, v14
    v_and_b32 v33, 0xffff0000, v14
    v_lshlrev_b32 v34, 16, v15
    v_and_b32 v35, 0xffff0000, v15
    v_mul_f32_dpp v36, v19, v28 row_newbcast:8 row_mask:0xf bank_mask:0xf
    v_mul_f32_dpp v37, v19, v29 row_newbcast:9 row_mask:0xf bank_mask:0xf
    v_mul_f32_dpp v38, v19, v30 row_newbcast:10 row_mask:0xf bank_mask:0xf
    v_mul_f32_dpp v39, v19, v31 row_newbcast:11 row_mask:0xf bank_mask:0xf
    v_mul_f32_dpp v40, v19, v32 row_newbcast:12 row_mask:0xf bank_mask:0xf
    v_mul_f32_dpp v41, v19, v33 row_newbcast:13 row_mask:0xf bank_mask:0xf
    v_mul_f32_dpp v42, v19, v34 row_newbcast:14 row_mask:0xf bank_mask:0xf
    v_mul_f32_dpp v43, v19, v35 row_newbcast:15 row_mask:0xf bank_mask:0xf
    v_cvt_pk_bf16_f32 v92, v36, v37
    v_cvt_pk_bf16_f32 v93, v38, v39
    v_cvt_pk_bf16_f32 v94, v40, v41
    v_cvt_pk_bf16_f32 v95, v42, v43
    v_mul_f32_dpp v28, v19, v28 row_newbcast:0 row_mask:0xa bank_mask:0xf
    v_mul_f32_dpp v29, v19, v29 row_newbcast:1 row_mask:0xa bank_mask:0xf
    v_mul_f32_dpp v30, v19, v30 row_newbcast:2 row_mask:0xa bank_mask:0xf
    v_mul_f32_dpp v31, v19, v31 row_newbcast:3 row_mask:0xa bank_mask:0xf
    v_mul_f32_dpp v32, v19, v32 row_newbcast:4 row_mask:0xa bank_mask:0xf
    v_mul_f32_dpp v33, v19, v33 row_newbcast:5 row_mask:0xa bank_mask:0xf
    v_mul_f32_dpp v34, v19, v34 row_newbcast:6 row_mask:0xa bank_mask:0xf
    v_mul_f32_dpp v35, v19, v35 row_newbcast:7 row_mask:0xa bank_mask:0xf
    v_cvt_pk_bf16_f32 v88, v28, v29
    v_cvt_pk_bf16_f32 v89, v30, v31
    v_cvt_pk_bf16_f32 v90, v32, v33
    v_cvt_pk_bf16_f32 v91, v34, v35
    s_waitcnt vmcnt(4)
    v_mfma_f32_32x32x16_bf16 v[0:15], v[64:67], v[176:179], 0
    ds_read_b64_tr_b16 v[184:185], v246 offset:2048
    ds_read_b64_tr_b16 v[186:187], v246 offset:3072
    ds_read_b64_tr_b16 v[188:189], v247 offset:2048
    ds_read_b64_tr_b16 v[190:191], v247 offset:3072
    s_mov_b32 m0, s68
    v_mfma_f32_32x32x16_bf16 v[16:31], v[68:71], v[176:179], 0
    buffer_load_dwordx4 v222, s[4:7], s41 offen sc1 lds
    buffer_load_dwordx4 v223, s[72:75], s41 offen offset:1024 sc1 lds
    v_permlane32_swap_b32 v242, v236
    v_permlane32_swap_b32 v243, v237
    s_add_u32 s38, s38, 1
    v_mfma_f32_32x32x16_bf16 v[32:47], v[64:67], v[180:183], 0
    v_permlane32_swap_b32 v244, v238
    v_permlane32_swap_b32 v245, v239
    v_permlane32_swap_b32 v240, v241
    v_add_f32 v242, v242, v236
    v_mfma_f32_32x32x16_bf16 v[48:63], v[68:71], v[180:183], 0
    v_add_f32 v243, v243, v237
    v_add_f32 v244, v244, v238
    v_add_f32 v245, v245, v239
    v_add_f32 v240, -v240, -v241
    v_mov_b32 v254, s52
    v_mov_b32 v255, s38
    s_waitcnt vmcnt(4) lgkmcnt(0)
    v_mfma_f32_32x32x16_bf16 v[0:15], v[72:75], v[184:187], v[0:15]
    ds_read_b64_tr_b16 v[176:177], v246 offset:4096
    ds_read_b64_tr_b16 v[178:179], v246 offset:5120
    ds_read_b64_tr_b16 v[180:181], v247 offset:4096
    ds_read_b64_tr_b16 v[182:183], v247 offset:5120
    s_lshl_b32 s58, s38, 3
    s_add_u32 s58, s58, s20
    s_mov_b32 m0, s69
    v_mfma_f32_32x32x16_bf16 v[16:31], v[76:79], v[184:187], v[16:31]
    buffer_load_dwordx4 v224, s[4:7], s41 offen sc1 lds
    buffer_load_dwordx4 v225, s[72:75], s41 offen offset:1024 sc1 lds
    s_set_gpr_idx_on s32, gpr_idx(DST)
    s_nop 0
    v_cvt_pk_bf16_f32 v195, v242, v243
    v_cvt_pk_bf16_f32 v196, v244, v245
    v_cvt_pk_bf16_f32 v197, v240, v240
    s_set_gpr_idx_off
    s_mov_b64 exec, 1
    ds_write_b32 v254, v255
    s_mov_b64 exec, -1
    s_cmp_lt_u32 s58, s22
    s_cbranch_scc0 K2_dyn_81
K2_back_82:
    v_readlane_b32 s3, v253, s58
    s_lshl_b32 s44, s34, 7
    s_and_b32 s48, s3, 0x3ffff
    s_bfe_u32 s33, s3, 0x30013
    s_mul_i32 s35, s38, 6
    s_cmp_eq_u32 s34, 0
    s_cselect_b32 s35, s35, s48
    s_mov_b32 s45, s44
    s_xor_b32 s47, s44, 256
    s_add_u32 s49, s48, 128
    s_add_u32 s60, s48, 256
    s_cmp_eq_u32 s33, 3
    s_cselect_b32 s46, s44, s47
    s_cselect_b32 s50, s60, s48
    s_cselect_b32 s51, s48, s49
    s_sub_u32 s60, s33, 2
    s_cmp_lt_u32 s60, 2
    s_cbranch_scc0 K2_rare_87
K2_back_88:
    v_mfma_f32_32x32x16_bf16 v[32:47], v[72:75], v[188:191], v[32:47]
    v_add_u32 v233, s48, v230
    ds_read_b32 v232, v233
    ds_read_b32 v233, v233 offset:1024
    v_mfma_f32_32x32x16_bf16 v[48:63], v[76:79], v[188:191], v[48:63]
    s_waitcnt vmcnt(4) lgkmcnt(3)
    v_mfma_f32_32x32x16_bf16 v[0:15], v[80:83], v[176:179], v[0:15]
    ds_read_b64_tr_b16 v[184:185], v246 offset:6144
    ds_read_b64_tr_b16 v[186:187], v246 offset:7168
    ds_read_b64_tr_b16 v[188:189], v247 offset:6144
    ds_read_b64_tr_b16 v[190:191], v247 offset:7168
    s_mov_b32 m0, s70
    v_mfma_f32_32x32x16_bf16 v[16:31], v[84:87], v[176:179], v[16:31]
    buffer_load_dwordx4 v226, s[4:7], s41 offen sc1 lds
    buffer_load_dwordx4 v227, s[72:75], s41 offen offset:1024 sc1 lds
    v_mfma_f32_32x32x16_bf16 v[32:47], v[80:83], v[180:183], v[32:47]
    v_mfma_f32_32x32x16_bf16 v[48:63], v[84:87], v[180:183], v[48:63]
    s_waitcnt lgkmcnt(4)
    v_or_b32 v232, v232, v231
    v_or_b32 v233, v233, v231
    s_cmp_lg_u32 s34, 0
    s_cbranch_scc1 K2_dum_90
    s_cmp_eq_u32 s33, 4
    s_cbranch_scc1 K2_a4_91
K2_b4_93:
    s_add_u32 m0, s48, 512
    s_add_u32 s65, s48, 1536
    buffer_load_dwordx4 v232, s[16:19], 0 offen  lds
    s_mov_b32 m0, s65
    s_mov_b32 exec_hi, 0
    buffer_load_dwordx4 v233, s[16:19], 0 offen  lds
    s_mov_b32 exec_hi, -1
K2_back_92:
    s_waitcnt vmcnt(6) lgkmcnt(0)
    v_mfma_f32_32x32x16_bf16 v[0:15], v[88:91], v[184:187], v[0:15]
    ds_read_b64_tr_b16 v[176:177], v246 offset:0
    ds_read_b64_tr_b16 v[178:179], v246 offset:1024
    ds_read_b64_tr_b16 v[180:181], v247 offset:0
    ds_read_b64_tr_b16 v[182:183], v247 offset:1024
    s_mov_b32 m0, s71
    v_mfma_f32_32x32x16_bf16 v[16:31], v[92:95], v[184:187], v[16:31]
    buffer_load_dwordx4 v228, s[4:7], s41 offen sc1 lds
    buffer_load_dwordx4 v229, s[72:75], s41 offen offset:1024 sc1 lds
    v_mfma_f32_32x32x16_bf16 v[32:47], v[88:91], v[188:191], v[32:47]
    s_nop 2
    v_mul_f32 v234, v0, v96
    v_mul_f32 v236, v8, v128
    v_fmac_f32 v234, v1, v97
    v_fmac_f32 v236, v9, v129
    v_fmac_f32 v234, v2, v98
    v_fmac_f32 v236, v10, v130
    v_fmac_f32 v234, v3, v99
    v_mfma_f32_32x32x16_bf16 v[48:63], v[92:95], v[188:191], v[48:63]
    s_setprio 0
    v_fmac_f32 v236, v11, v131
    v_fmac_f32 v234, v4, v100
    v_fmac_f32 v236, v12, v132
    v_fmac_f32 v234, v5, v101
    v_fmac_f32 v236, v13, v133
    v_fmac_f32 v234, v6, v102
    v_fmac_f32 v236, v14, v134
    v_fmac_f32 v234, v7, v103
    v_fmac_f32 v236, v15, v135
    v_mul_f32 v238, v16, v128
    v_mul_f32 v240, v24, v128
    v_fmac_f32 v238, v17, v129
    v_fmac_f32 v240, v25, v129
    v_fmac_f32 v238, v18, v130
    v_fmac_f32 v240, v26, v130
    v_fmac_f32 v238, v19, v131
    v_fmac_f32 v240, v27, v131
    v_fmac_f32 v238, v20, v132
    v_fmac_f32 v240, v28, v132
    v_fmac_f32 v238, v21, v133
    v_fmac_f32 v240, v29, v133
    v_fmac_f32 v238, v22, v134
    v_fmac_f32 v240, v30, v134
    v_fmac_f32 v238, v23, v135
    v_fmac_f32 v240, v31, v135
    v_mul_f32 v235, v32, v104
    v_mul_f32 v237, v40, v136
    v_fmac_f32 v235, v33, v105
    v_fmac_f32 v237, v41, v137
    v_fmac_f32 v235, v34, v106
    v_fmac_f32 v237, v42, v138
    v_fmac_f32 v235, v35, v107
    v_fmac_f32 v237, v43, v139
    v_fmac_f32 v235, v36, v108
    v_fmac_f32 v237, v44, v140
    v_fmac_f32 v235, v37, v109
    v_fmac_f32 v237, v45, v141
    v_fmac_f32 v235, v38, v110
    v_fmac_f32 v237, v46, v142
    v_fmac_f32 v235, v39, v111
    v_fmac_f32 v237, v47, v143
    v_mul_f32 v239, v48, v136
    v_mul_f32 v241, v56, v136
    s_setprio 1
    s_waitcnt vmcnt(6) lgkmcnt(0)
    v_mfma_f32_32x32x16_bf16 v[0:15], v[64:67], v[176:179], 0
    ds_read_b64_tr_b16 v[184:185], v246 offset:2048
    ds_read_b64_tr_b16 v[186:187], v246 offset:3072
    ds_read_b64_tr_b16 v[188:189], v247 offset:2048
    ds_read_b64_tr_b16 v[190:191], v247 offset:3072
    v_fmac_f32 v239, v49, v137
    v_fmac_f32 v241, v57, v137
    s_mov_b32 m0, s68
    v_mfma_f32_32x32x16_bf16 v[16:31], v[68:71], v[176:179], 0
    buffer_load_dwordx4 v222, s[4:7], s42 offen sc1 lds
    buffer_load_dwordx4 v223, s[72:75], s42 offen offset:1024 sc1 lds
    v_fmac_f32 v239, v50, v138
    v_fmac_f32 v241, v58, v138
    v_fmac_f32 v239, v51, v139
    v_fmac_f32 v241, v59, v139
    v_fmac_f32 v239, v52, v140
    v_mfma_f32_32x32x16_bf16 v[32:47], v[64:67], v[180:183], 0
    v_fmac_f32 v241, v60, v140
    v_fmac_f32 v239, v53, v141
    v_fmac_f32 v241, v61, v141
    v_fmac_f32 v239, v54, v142
    v_fmac_f32 v241, v62, v142
    v_fmac_f32 v239, v55, v143
    v_fmac_f32 v241, v63, v143
    v_mfma_f32_32x32x16_bf16 v[48:63], v[68:71], v[180:183], 0
    v_permlane32_swap_b32 v234, v236
    v_permlane32_swap_b32 v235, v237
    v_permlane32_swap_b32 v240, v238
    s_waitcnt vmcnt(6) lgkmcnt(0)
    v_mfma_f32_32x32x16_bf16 v[0:15], v[72:75], v[184:187], v[0:15]
    ds_read_b64_tr_b16 v[176:177], v246 offset:4096
    ds_read_b64_tr_b16 v[178:179], v246 offset:5120
    ds_read_b64_tr_b16 v[180:181], v247 offset:4096
    ds_read_b64_tr_b16 v[182:183], v247 offset:5120
    v_permlane32_swap_b32 v241, v239
    s_mov_b32 m0, s69
    v_mfma_f32_32x32x16_bf16 v[16:31], v[76:79], v[184:187], v[16:31]
    buffer_load_dwordx4 v224, s[4:7], s42 offen sc1 lds
    buffer_load_dwordx4 v225, s[72:75], s42 offen offset:1024 sc1 lds
    v_add_f32 v234, v234, v236
    v_add_f32 v235, v235, v237
    v_add_f32 v240, v240, v238
    v_add_f32 v241, v241, v239
    v_mfma_f32_32x32x16_bf16 v[32:47], v[72:75], v[188:191], v[32:47]
    s_set_gpr_idx_on s31, gpr_idx(DST)
    s_nop 0
    v_cvt_pk_bf16_f32 v192, v234, v235
    v_cvt_pk_bf16_f32 v193, v240, v241
    s_set_gpr_idx_off
    v_mfma_f32_32x32x16_bf16 v[48:63], v[76:79], v[188:191], v[48:63]
    s_waitcnt vmcnt(4) lgkmcnt(0)
    v_mfma_f32_32x32x16_bf16 v[0:15], v[80:83], v[176:179], v[0:15]
    ds_read_b64_tr_b16 v[184:185], v246 offset:6144
    ds_read_b64_tr_b16 v[186:187], v246 offset:7168
    ds_read_b64_tr_b16 v[188:189], v247 offset:6144
    ds_read_b64_tr_b16 v[190:191], v247 offset:7168
    s_mov_b32 m0, s70
    v_mfma_f32_32x32x16_bf16 v[16:31], v[84:87], v[176:179], v[16:31]
    buffer_load_dwordx4 v226, s[4:7], s42 offen sc1 lds
    buffer_load_dwordx4 v227, s[72:75], s42 offen offset:1024 sc1 lds
    v_mfma_f32_32x32x16_bf16 v[32:47], v[80:83], v[180:183], v[32:47]
    v_mfma_f32_32x32x16_bf16 v[48:63], v[84:87], v[180:183], v[48:63]
    s_waitcnt vmcnt(4) lgkmcnt(0)
    v_mfma_f32_32x32x16_bf16 v[0:15], v[88:91], v[184:187], v[0:15]
    ds_read_b64_tr_b16 v[176:177], v246 offset:0
    ds_read_b64_tr_b16 v[178:179], v246 offset:1024
    ds_read_b64_tr_b16 v[180:181], v247 offset:0
    ds_read_b64_tr_b16 v[182:183], v247 offset:1024
    s_mov_b32 m0, s71
    v_mfma_f32_32x32x16_bf16 v[16:31], v[92:95], v[184:187], v[16:31]
    buffer_load_dwordx4 v228, s[4:7], s42 offen sc1 lds
    buffer_load_dwordx4 v229, s[72:75], s42 offen offset:1024 sc1 lds
    v_mfma_f32_32x32x16_bf16 v[32:47], v[88:91], v[188:191], v[32:47]
    s_nop 2
    v_mul_f32 v234, v0, v144
    v_mul_f32 v236, v8, v112
    v_fmac_f32 v234, v1, v145
    v_fmac_f32 v236, v9, v113
    v_fmac_f32 v234, v2, v146
    v_fmac_f32 v236, v10, v114
    v_fmac_f32 v234, v3, v147
    v_mfma_f32_32x32x16_bf16 v[48:63], v[92:95], v[188:191], v[48:63]
    s_setprio 0
    v_fmac_f32 v236, v11, v115
    v_fmac_f32 v234, v4, v148
    v_fmac_f32 v236, v12, v116
    v_fmac_f32 v234, v5, v149
    v_fmac_f32 v236, v13, v117
    v_fmac_f32 v234, v6, v150
    v_fmac_f32 v236, v14, v118
    v_fmac_f32 v234, v7, v151
    v_fmac_f32 v236, v15, v119
    v_mul_f32 v238, v16, v160
    v_mul_f32 v240, v24, v160
    v_fmac_f32 v238, v17, v161
    v_fmac_f32 v240, v25, v161
    v_fmac_f32 v238, v18, v162
    v_fmac_f32 v240, v26, v162
    v_fmac_f32 v238, v19, v163
    v_fmac_f32 v240, v27, v163
    v_fmac_f32 v238, v20, v164
    v_fmac_f32 v240, v28, v164
    v_fmac_f32 v238, v21, v165
    v_fmac_f32 v240, v29, v165
    v_fmac_f32 v238, v22, v166
    v_fmac_f32 v240, v30, v166
    v_fmac_f32 v238, v23, v167
    v_fmac_f32 v240, v31, v167
    v_mul_f32 v235, v32, v152
    v_mul_f32 v237, v40, v120
    v_fmac_f32 v235, v33, v153
    v_fmac_f32 v237, v41, v121
    v_fmac_f32 v235, v34, v154
    v_fmac_f32 v237, v42, v122
    v_fmac_f32 v235, v35, v155
    v_fmac_f32 v237, v43, v123
    v_fmac_f32 v235, v36, v156
    v_fmac_f32 v237, v44, v124
    v_fmac_f32 v235, v37, v157
    v_fmac_f32 v237, v45, v125
    v_fmac_f32 v235, v38, v158
    v_fmac_f32 v237, v46, v126
    v_fmac_f32 v235, v39, v159
    v_fmac_f32 v237, v47, v127
    v_mul_f32 v239, v48, v168
    v_mul_f32 v241, v56, v168
    s_setprio 1
    s_waitcnt vmcnt(4) lgkmcnt(0)
    v_mfma_f32_32x32x16_bf16 v[0:15], v[64:67], v[176:179], 0
    ds_read_b64_tr_b16 v[184:185], v246 offset:2048
    ds_read_b64_tr_b16 v[186:187], v246 offset:3072
    ds_read_b64_tr_b16 v[188:189], v247 offset:2048
    ds_read_b64_tr_b16 v[190:191], v247 offset:3072
    v_fmac_f32 v239, v49, v169
    v_fmac_f32 v241, v57, v169
    s_mov_b32 m0, s68
    v_mfma_f32_32x32x16_bf16 v[16:31], v[68:71], v[176:179], 0
    buffer_load_dwordx4 v222, s[4:7], s43 offen sc1 lds
    buffer_load_dwordx4 v223, s[72:75], s43 offen offset:1024 sc1 lds
    v_fmac_f32 v239, v50, v170
    v_fmac_f32 v241, v58, v170
    v_fmac_f32 v239, v51, v171
    v_fmac_f32 v241, v59, v171
    v_fmac_f32 v239, v52, v172
    v_mfma_f32_32x32x16_bf16 v[32:47], v[64:67], v[180:183], 0
    v_fmac_f32 v241, v60, v172
    v_fmac_f32 v239, v53, v173
    v_fmac_f32 v241, v61, v173
    v_fmac_f32 v239, v54, v174
    v_fmac_f32 v241, v62, v174
    v_fmac_f32 v239, v55, v175
    v_fmac_f32 v241, v63, v175
    v_mfma_f32_32x32x16_bf16 v[48:63], v[68:71], v[180:183], 0
    s_waitcnt vmcnt(4) lgkmcnt(0)
    v_mfma_f32_32x32x16_bf16 v[0:15], v[72:75], v[184:187], v[0:15]
    ds_read_b64_tr_b16 v[176:177], v246 offset:4096
    ds_read_b64_tr_b16 v[178:179], v246 offset:5120
    ds_read_b64_tr_b16 v[180:181], v247 offset:4096
    ds_read_b64_tr_b16 v[182:183], v247 offset:5120
    s_mov_b32 m0, s69
    v_mfma_f32_32x32x16_bf16 v[16:31], v[76:79], v[184:187], v[16:31]
    buffer_load_dwordx4 v224, s[4:7], s43 offen sc1 lds
    buffer_load_dwordx4 v225, s[72:75], s43 offen offset:1024 sc1 lds
    v_mfma_f32_32x32x16_bf16 v[32:47], v[72:75], v[188:191], v[32:47]
    v_mfma_f32_32x32x16_bf16 v[48:63], v[76:79], v[188:191], v[48:63]
    s_waitcnt vmcnt(4) lgkmcnt(0)
    v_mfma_f32_32x32x16_bf16 v[0:15], v[80:83], v[176:179], v[0:15]
    ds_read_b64_tr_b16 v[184:185], v246 offset:6144
    ds_read_b64_tr_b16 v[186:187], v246 offset:7168
    ds_read_b64_tr_b16 v[188:189], v247 offset:6144
    ds_read_b64_tr_b16 v[190:191], v247 offset:7168
    s_mov_b32 m0, s70
    v_mfma_f32_32x32x16_bf16 v[16:31], v[84:87], v[176:179], v[16:31]
    buffer_load_dwordx4 v226, s[4:7], s43 offen sc1 lds
    buffer_load_dwordx4 v227, s[72:75], s43 offen offset:1024 sc1 lds
    v_mfma_f32_32x32x16_bf16 v[32:47], v[80:83], v[180:183], v[32:47]
    v_add_u32 v222, s48, v251
    ds_read2_b32 v[222:223], v222 offset0:1 offset1:3
    v_mfma_f32_32x32x16_bf16 v[48:63], v[84:87], v[180:183], v[48:63]
    s_waitcnt vmcnt(4) lgkmcnt(1)
    v_mfma_f32_32x32x16_bf16 v[0:15], v[88:91], v[184:187], v[0:15]
    ds_read_b64_tr_b16 v[176:177], v246 offset:0
    ds_read_b64_tr_b16 v[178:179], v246 offset:1024
    ds_read_b64_tr_b16 v[180:181], v247 offset:0
    ds_read_b64_tr_b16 v[182:183], v247 offset:1024
    s_mov_b32 m0, s71
    v_mfma_f32_32x32x16_bf16 v[16:31], v[92:95], v[184:187], v[16:31]
    buffer_load_dwordx4 v228, s[4:7], s43 offen sc1 lds
    buffer_load_dwordx4 v229, s[72:75], s43 offen offset:1024 sc1 lds
    s_waitcnt lgkmcnt(4)
    v_mad_u32_u16 v222, v222, s39, v248 op_sel:[1,0,0,0]
    v_mad_u32_u16 v223, v223, s39, v248 op_sel:[1,0,0,0]
    v_mfma_f32_32x32x16_bf16 v[32:47], v[88:91], v[188:191], v[32:47]
    v_add_u32 v224, s49, v251
    ds_read2_b32 v[224:225], v224 offset0:1 offset1:3
    v_mul_f32 v242, v0, v144
    v_fma_f32 v238, v8, v160, -v238
    v_fmac_f32 v242, v1, v145
    v_fmac_f32 v238, v9, v161
    v_fmac_f32 v242, v2, v146
    v_mfma_f32_32x32x16_bf16 v[48:63], v[92:95], v[188:191], v[48:63]
    s_setprio 0
    v_fmac_f32 v238, v10, v162
    v_fmac_f32 v242, v3, v147
    v_fmac_f32 v238, v11, v163
    v_fmac_f32 v242, v4, v148
    v_fmac_f32 v238, v12, v164
    v_fmac_f32 v242, v5, v149
    v_fmac_f32 v238, v13, v165
    v_fmac_f32 v242, v6, v150
    v_fmac_f32 v238, v14, v166
    v_fmac_f32 v242, v7, v151
    v_fmac_f32 v238, v15, v167
    v_fmac_f32 v236, v16, v112
    v_mul_f32 v244, v24, v160
    v_fmac_f32 v236, v17, v113
    v_fmac_f32 v244, v25, v161
    v_fmac_f32 v236, v18, v114
    v_fmac_f32 v244, v26, v162
    v_fmac_f32 v236, v19, v115
    v_fmac_f32 v244, v27, v163
    v_fmac_f32 v236, v20, v116
    v_fmac_f32 v244, v28, v164
    v_fmac_f32 v236, v21, v117
    v_fmac_f32 v244, v29, v165
    v_fmac_f32 v236, v22, v118
    v_fmac_f32 v244, v30, v166
    v_fmac_f32 v236, v23, v119
    v_fmac_f32 v244, v31, v167
    v_mul_f32 v243, v32, v152
    v_fma_f32 v239, v40, v168, -v239
    v_fmac_f32 v243, v33, v153
    v_fmac_f32 v239, v41, v169
    v_fmac_f32 v243, v34, v154
    v_fmac_f32 v239, v42, v170
    v_fmac_f32 v243, v35, v155
    v_fmac_f32 v239, v43, v171
    v_fmac_f32 v243, v36, v156
    v_fmac_f32 v239, v44, v172
    v_fmac_f32 v243, v37, v157
    v_fmac_f32 v239, v45, v173
    v_fmac_f32 v243, v38, v158
    v_fmac_f32 v239, v46, v174
    v_fmac_f32 v243, v39, v159
    v_fmac_f32 v239, v47, v175
    v_fmac_f32 v237, v48, v120
    v_mul_f32 v245, v56, v168
    v_fmac_f32 v237, v49, v121
    v_fmac_f32 v245, v57, v169
    v_fmac_f32 v237, v50, v122
    v_fmac_f32 v245, v58, v170
    v_fmac_f32 v237, v51, v123
    s_setprio 1
    s_waitcnt vmcnt(4) lgkmcnt(1)
    v_mfma_f32_32x32x16_bf16 v[0:15], v[64:67], v[176:179], 0
    ds_read_b64_tr_b16 v[184:185], v246 offset:2048
    ds_read_b64_tr_b16 v[186:187], v246 offset:3072
    ds_read_b64_tr_b16 v[188:189], v247 offset:2048
    ds_read_b64_tr_b16 v[190:191], v247 offset:3072
    v_fmac_f32 v245, v59, v171
    v_fmac_f32 v237, v52, v124
    s_mov_b32 m0, s68
    v_mfma_f32_32x32x16_bf16 v[16:31], v[68:71], v[176:179], 0
    buffer_load_dwordx4 v222, s[4:7], s44 offen sc1 lds
    buffer_load_dwordx4 v223, s[72:75], s44 offen offset:1024 sc1 lds
    s_waitcnt lgkmcnt(4)
    v_mad_u32_u16 v224, v224, s39, v248 op_sel:[1,0,0,0]
    v_mad_u32_u16 v225, v225, s39, v248 op_sel:[1,0,0,0]
    v_fmac_f32 v245, v60, v172
    v_fmac_f32 v237, v53, v125
    v_mfma_f32_32x32x16_bf16 v[32:47], v[64:67], v[180:183], 0
    v_add_u32 v226, s50, v251
    ds_read2_b32 v[226:227], v226 offset0:1 offset1:3
    v_fmac_f32 v245, v61, v173
    v_fmac_f32 v237, v54, v126
    v_fmac_f32 v245, v62, v174
    v_fmac_f32 v237, v55, v127
    v_fmac_f32 v245, v63, v175
    v_mfma_f32_32x32x16_bf16 v[48:63], v[68:71], v[180:183], 0
    v_permlane32_swap_b32 v242, v234
    v_permlane32_swap_b32 v243, v235
    v_add_f32 v242, v242, v234
    v_add_f32 v243, v243, v235
    s_waitcnt vmcnt(4) lgkmcnt(1)
    v_mfma_f32_32x32x16_bf16 v[0:15], v[72:75], v[184:187], v[0:15]
    ds_read_b64_tr_b16 v[176:177], v246 offset:4096
    ds_read_b64_tr_b16 v[178:179], v246 offset:5120
    ds_read_b64_tr_b16 v[180:181], v247 offset:4096
    ds_read_b64_tr_b16 v[182:183], v247 offset:5120
    s_mov_b32 m0, s69
    v_mfma_f32_32x32x16_bf16 v[16:31], v[76:79], v[184:187], v[16:31]
    buffer_load_dwordx4 v224, s[4:7], s45 offen sc1 lds
    buffer_load_dwordx4 v225, s[72:75], s45 offen offset:1024 sc1 lds
    s_waitcnt lgkmcnt(4)
    v_mad_u32_u16 v226, v226, s39, v248 op_sel:[1,0,0,0]
    v_mad_u32_u16 v227, v227, s39, v248 op_sel:[1,0,0,0]
    v_mfma_f32_32x32x16_bf16 v[32:47], v[72:75], v[188:191], v[32:47]
    v_add_u32 v228, s51, v251
    ds_read2_b32 v[228:229], v228 offset0:1 offset1:3
    s_set_gpr_idx_on s31, gpr_idx(DST)
    s_nop 0
    v_cvt_pk_bf16_f32 v194, v242, v243
    s_set_gpr_idx_off
    v_mfma_f32_32x32x16_bf16 v[48:63], v[76:79], v[188:191], v[48:63]
    s_waitcnt vmcnt(4) lgkmcnt(1)
    v_mfma_f32_32x32x16_bf16 v[0:15], v[80:83], v[176:179], v[0:15]
    ds_read_b64_tr_b16 v[184:185], v246 offset:6144
    ds_read_b64_tr_b16 v[186:187], v246 offset:7168
    ds_read_b64_tr_b16 v[188:189], v247 offset:6144
    ds_read_b64_tr_b16 v[190:191], v247 offset:7168
    s_mov_b32 s32, s31
    s_mov_b32 s31, s35
    s_mov_b32 m0, s70
    v_mfma_f32_32x32x16_bf16 v[16:31], v[84:87], v[176:179], v[16:31]
    buffer_load_dwordx4 v226, s[4:7], s46 offen sc1 lds
    buffer_load_dwordx4 v227, s[72:75], s46 offen offset:1024 sc1 lds
    s_waitcnt lgkmcnt(4)
    v_mad_u32_u16 v228, v228, s39, v248 op_sel:[1,0,0,0]
    v_mad_u32_u16 v229, v229, s39, v248 op_sel:[1,0,0,0]
    s_sub_u32 s26, s48, s29
    s_mov_b32 s29, s48
    v_mfma_f32_32x32x16_bf16 v[32:47], v[80:83], v[180:183], v[32:47]
    s_mov_b32 s30, s3
    s_bfe_u32 s56, s3, 0x40012
    s_cmp_eq_u32 s34, 0
    s_cselect_b32 s56, s56, 0
    v_mfma_f32_32x32x16_bf16 v[48:63], v[84:87], v[180:183], v[48:63]
    s_waitcnt vmcnt(4) lgkmcnt(0)
    v_mfma_f32_32x32x16_bf16 v[0:15], v[88:91], v[184:187], v[0:15]
    ds_read_b64_tr_b16 v[176:177], v246 offset:0
    ds_read_b64_tr_b16 v[178:179], v246 offset:1024
    ds_read_b64_tr_b16 v[180:181], v247 offset:0
    ds_read_b64_tr_b16 v[182:183], v247 offset:1024
    s_mov_b32 m0, s71
    v_mfma_f32_32x32x16_bf16 v[16:31], v[92:95], v[184:187], v[16:31]
    buffer_load_dwordx4 v228, s[4:7], s47 offen sc1 lds
    buffer_load_dwordx4 v229, s[72:75], s47 offen offset:1024 sc1 lds
    v_mfma_f32_32x32x16_bf16 v[32:47], v[88:91], v[188:191], v[32:47]
    s_nop 2
    v_mul_f32 v242, v0, v144
    v_fma_f32 v240, v8, v160, -v240
    v_fmac_f32 v242, v1, v145
    v_fmac_f32 v240, v9, v161
    v_fmac_f32 v242, v2, v146
    v_fmac_f32 v240, v10, v162
    v_fmac_f32 v242, v3, v147
    v_mfma_f32_32x32x16_bf16 v[48:63], v[92:95], v[188:191], v[48:63]
    s_setprio 0
    v_fmac_f32 v240, v11, v163
    v_fmac_f32 v242, v4, v148
    v_fmac_f32 v240, v12, v164
    v_fmac_f32 v242, v5, v149
    v_fmac_f32 v240, v13, v165
    v_fmac_f32 v242, v6, v150
    v_fmac_f32 v240, v14, v166
    v_fmac_f32 v242, v7, v151
    v_fmac_f32 v240, v15, v167
    v_add_u32 v249, s26, v249
    v_add_u32 v250, s26, v250
    v_fma_f32 v244, v16, v160, -v244
    v_fmac_f32 v236, v24, v112
    v_fmac_f32 v244, v17, v161
    v_fmac_f32 v236, v25, v113
    v_fmac_f32 v244, v18, v162
    v_fmac_f32 v236, v26, v114
    v_fmac_f32 v244, v19, v163
    v_fmac_f32 v236, v27, v115
    v_fmac_f32 v244, v20, v164
    v_fmac_f32 v236, v28, v116
    v_fmac_f32 v244, v21, v165
    v_fmac_f32 v236, v29, v117
    v_fmac_f32 v244, v22, v166
    v_fmac_f32 v236, v30, v118
    v_fmac_f32 v244, v23, v167
    v_fmac_f32 v236, v31, v119
    ds_read_b64_tr_b16 v[0:1], v249 offset:0
    ds_read_b64_tr_b16 v[2:3], v249 offset:32
    ds_read_u16_d16_hi v16, v250 offset:0
    v_mul_f32 v243, v32, v152
    v_fma_f32 v241, v40, v168, -v241
    v_fmac_f32 v243, v33, v153
    v_fmac_f32 v241, v41, v169
    v_fmac_f32 v243, v34, v154
    v_fmac_f32 v241, v42, v170
    v_fmac_f32 v243, v35, v155
    v_fmac_f32 v241, v43, v171
    v_fmac_f32 v243, v36, v156
    v_fmac_f32 v241, v44, v172
    v_fmac_f32 v243, v37, v157
    v_fmac_f32 v241, v45, v173
    v_fmac_f32 v243, v38, v158
    v_fmac_f32 v241, v46, v174
    v_fmac_f32 v243, v39, v159
    v_fmac_f32 v241, v47, v175
    ds_read_b64_tr_b16 v[4:5], v249 offset:512
    ds_read_b64_tr_b16 v[6:7], v249 offset:544
    ds_read_u16_d16_hi v17, v250 offset:128
    v_fma_f32 v245, v48, v168, -v245
    v_fmac_f32 v237, v56, v120
    v_fmac_f32 v245, v49, v169
    v_fmac_f32 v237, v57, v121
    v_fmac_f32 v245, v50, v170
    v_fmac_f32 v237, v58, v122
    v_fmac_f32 v245, v51, v171
    v_fmac_f32 v237, v59, v123
    v_fmac_f32 v245, v52, v172
    v_fmac_f32 v237, v60, v124
    v_fmac_f32 v245, v53, v173
    v_fmac_f32 v237, v61, v125
    v_fmac_f32 v245, v54, v174
    v_fmac_f32 v237, v62, v126
    v_fmac_f32 v245, v55, v175
    v_fmac_f32 v237, v63, v127
    s_cmp_eq_u32 s56, 5
    s_cbranch_scc1 K2_U20
    s_cmp_eq_u32 s56, 6
    s_cbranch_scc1 K2_U3h0
    s_branch K2_DSP0
K2_U11:
    s_setprio 1
    v_mov_b32 v254, 163296
    v_mov_b32 v255, 1
    v_lshl_add_u32 v233, v252, 1, s53
    s_mov_b64 exec, 1
    ds_add_rtn_u32 v232, v254, v255
    s_mov_b64 exec, -1
    ds_read_b32 v233, v233
    s_waitcnt lgkmcnt(5)
    v_lshlrev_b32 v20, 16, v0
    v_and_b32 v21, 0xffff0000, v0
    v_lshlrev_b32 v22, 16, v1
    v_and_b32 v23, 0xffff0000, v1
    v_lshlrev_b32 v24, 16, v2
    v_and_b32 v25, 0xffff0000, v2
    v_lshlrev_b32 v26, 16, v3
    v_and_b32 v27, 0xffff0000, v3
    v_mul_f32_dpp v36, v16, v20 row_newbcast:8 row_mask:0xf bank_mask:0xf
    v_mul_f32_dpp v37, v16, v21 row_newbcast:9 row_mask:0xf bank_mask:0xf
    v_mul_f32_dpp v38, v16, v22 row_newbcast:10 row_mask:0xf bank_mask:0xf
    v_mul_f32_dpp v39, v16, v23 row_newbcast:11 row_mask:0xf bank_mask:0xf
    v_mul_f32_dpp v40, v16, v24 row_newbcast:12 row_mask:0xf bank_mask:0xf
    v_mul_f32_dpp v41, v16, v25 row_newbcast:13 row_mask:0xf bank_mask:0xf
    v_mul_f32_dpp v42, v16, v26 row_newbcast:14 row_mask:0xf bank_mask:0xf
    v_mul_f32_dpp v43, v16, v27 row_newbcast:15 row_mask:0xf bank_mask:0xf
    v_cvt_pk_bf16_f32 v68, v36, v37
    v_cvt_pk_bf16_f32 v69, v38, v39
    v_cvt_pk_bf16_f32 v70, v40, v41
    v_cvt_pk_bf16_f32 v71, v42, v43
    v_mul_f32_dpp v20, v16, v20 row_newbcast:0 row_mask:0xa bank_mask:0xf
    v_mul_f32_dpp v21, v16, v21 row_newbcast:1 row_mask:0xa bank_mask:0xf
    v_mul_f32_dpp v22, v16, v22 row_newbcast:2 row_mask:0xa bank_mask:0xf
    v_mul_f32_dpp v23, v16, v23 row_newbcast:3 row_mask:0xa bank_mask:0xf
    v_mul_f32_dpp v24, v16, v24 row_newbcast:4 row_mask:0xa bank_mask:0xf
    v_mul_f32_dpp v25, v16, v25 row_newbcast:5 row_mask:0xa bank_mask:0xf
    v_mul_f32_dpp v26, v16, v26 row_newbcast:6 row_mask:0xa bank_mask:0xf
    v_mul_f32_dpp v27, v16, v27 row_newbcast:7 row_mask:0xa bank_mask:0xf
    v_cvt_pk_bf16_f32 v64, v20, v21
    v_cvt_pk_bf16_f32 v65, v22, v23
    v_cvt_pk_bf16_f32 v66, v24, v25
    v_cvt_pk_bf16_f32 v67, v26, v27
    s_waitcnt lgkmcnt(0)
    v_readfirstlane_b32 s58, v232
    s_nop 0
    s_cmp_lt_u32 s58, s22
    s_cbranch_scc0 K2_nul_94
    s_and_b32 s59, s58, 7
    s_lshr_b32 s60, s58, 3
K2_chk_96:
    v_readlane_b32 s61, v233, s59
    s_nop 0
    s_cmp_gt_u32 s61, s60
    s_cbranch_scc0 K2_spin_95
K2_back_97:
    v_readlane_b32 s3, v253, s58
    s_lshl_b32 s44, s34, 7
    s_and_b32 s48, s3, 0x3ffff
    s_bfe_u32 s33, s3, 0x30013
    s_mov_b32 s35, s48
    s_mov_b32 s45, s44
    s_xor_b32 s47, s44, 256
    s_add_u32 s49, s48, 128
    s_add_u32 s60, s48, 256
    s_cmp_eq_u32 s33, 3
    s_cselect_b32 s46, s44, s47
    s_cselect_b32 s50, s60, s48
    s_cselect_b32 s51, s48, s49
    s_sub_u32 s60, s33, 2
    s_cmp_lt_u32 s60, 2
    s_cbranch_scc0 K2_rare_98
K2_back_99:
    v_add_u32 v222, s48, v251
    ds_read2_b32 v[222:223], v222 offset0:1 offset1:3
    v_add_u32 v224, s49, v251
    ds_read2_b32 v[224:225], v224 offset0:1 offset1:3
    v_add_u32 v226, s50, v251
    ds_read2_b32 v[226:227], v226 offset0:1 offset1:3
    v_add_u32 v228, s51, v251
    ds_read2_b32 v[228:229], v228 offset0:1 offset1:3
    s_waitcnt lgkmcnt(3)
    v_mad_u32_u16 v222, v222, s39, v248 op_sel:[1,0,0,0]
    v_mad_u32_u16 v223, v223, s39, v248 op_sel:[1,0,0,0]
    s_waitcnt lgkmcnt(2)
    v_mad_u32_u16 v224, v224, s39, v248 op_sel:[1,0,0,0]
    v_mad_u32_u16 v225, v225, s39, v248 op_sel:[1,0,0,0]
    s_waitcnt lgkmcnt(1)
    v_mad_u32_u16 v226, v226, s39, v248 op_sel:[1,0,0,0]
    v_mad_u32_u16 v227, v227, s39, v248 op_sel:[1,0,0,0]
    s_waitcnt lgkmcnt(0)
    v_mad_u32_u16 v228, v228, s39, v248 op_sel:[1,0,0,0]
    v_mad_u32_u16 v229, v229, s39, v248 op_sel:[1,0,0,0]
    s_waitcnt vmcnt(4)
    v_mfma_f32_32x32x16_bf16 v[0:15], v[64:67], v[176:179], 0
    ds_read_b64_tr_b16 v[184:185], v246 offset:2048
    ds_read_b64_tr_b16 v[186:187], v246 offset:3072
    ds_read_b64_tr_b16 v[188:189], v247 offset:2048
    ds_read_b64_tr_b16 v[190:191], v247 offset:3072
    s_mov_b32 m0, s68
    v_mfma_f32_32x32x16_bf16 v[16:31], v[68:71], v[176:179], 0
    buffer_load_dwordx4 v222, s[4:7], s44 offen sc1 lds
    buffer_load_dwordx4 v223, s[72:75], s44 offen offset:1024 sc1 lds
    v_permlane32_swap_b32 v242, v236
    v_permlane32_swap_b32 v243, v237
    v_mfma_f32_32x32x16_bf16 v[32:47], v[64:67], v[180:183], 0
    v_permlane32_swap_b32 v244, v238
    v_permlane32_swap_b32 v245, v239
    v_permlane32_swap_b32 v240, v241
    v_add_f32 v242, v242, v236
    v_mfma_f32_32x32x16_bf16 v[48:63], v[68:71], v[180:183], 0
    s_setprio 0
    v_add_f32 v243, v243, v237
    v_add_f32 v244, v244, v238
    v_add_f32 v245, v245, v239
    v_add_f32 v240, -v240, -v241
    v_sub_u32 v241, v230, v231
    v_cvt_pk_bf16_f32 v242, v242, v243
    v_cvt_pk_bf16_f32 v244, v244, v245
    v_cvt_pk_bf16_f32 v240, v240, v240
    ds_write_b32 v230, v242 offset:768
    ds_write_b32 v230, v244 offset:1024
    ds_write_b16 v241, v240 offset:1280
    v_mul_f32 v234, v0, v96
    v_mul_f32 v236, v8, v128
    v_fmac_f32 v234, v1, v97
    v_fmac_f32 v236, v9, v129
    v_fmac_f32 v234, v2, v98
    v_fmac_f32 v236, v10, v130
    v_fmac_f32 v234, v3, v99
    v_fmac_f32 v236, v11, v131
    v_fmac_f32 v234, v4, v100
    v_fmac_f32 v236, v12, v132
    v_fmac_f32 v234, v5, v101
    v_fmac_f32 v236, v13, v133
    v_fmac_f32 v234, v6, v102
    v_fmac_f32 v236, v14, v134
    v_fmac_f32 v234, v7, v103
    v_fmac_f32 v236, v15, v135
    v_mul_f32 v238, v16, v128
    v_mul_f32 v240, v24, v128
    v_fmac_f32 v238, v17, v129
    v_fmac_f32 v240, v25, v129
    v_fmac_f32 v238, v18, v130
    v_fmac_f32 v240, v26, v130
    v_fmac_f32 v238, v19, v131
    v_fmac_f32 v240, v27, v131
    v_fmac_f32 v238, v20, v132
    v_fmac_f32 v240, v28, v132
    v_fmac_f32 v238, v21, v133
    v_fmac_f32 v240, v29, v133
    v_fmac_f32 v238, v22, v134
    v_fmac_f32 v240, v30, v134
    v_fmac_f32 v238, v23, v135
    v_fmac_f32 v240, v31, v135
    v_mul_f32 v235, v32, v104
    v_mul_f32 v237, v40, v136
    v_fmac_f32 v235, v33, v105
    v_fmac_f32 v237, v41, v137
    v_fmac_f32 v235, v34, v106
    v_fmac_f32 v237, v42, v138
    v_fmac_f32 v235, v35, v107
    v_fmac_f32 v237, v43, v139
    v_fmac_f32 v235, v36, v108
    v_fmac_f32 v237, v44, v140
    v_fmac_f32 v235, v37, v109
    v_fmac_f32 v237, v45, v141
    v_fmac_f32 v235, v38, v110
    v_fmac_f32 v237, v46, v142
    v_fmac_f32 v235, v39, v111
    v_fmac_f32 v237, v47, v143
    v_mul_f32 v239, v48, v136
    v_mul_f32 v241, v56, v136
    v_fmac_f32 v239, v49, v137
    v_fmac_f32 v241, v57, v137
    v_fmac_f32 v239, v50, v138
    v_fmac_f32 v241, v58, v138
    v_fmac_f32 v239, v51, v139
    v_fmac_f32 v241, v59, v139
    v_fmac_f32 v239, v52, v140
    v_fmac_f32 v241, v60, v140
    v_fmac_f32 v239, v53, v141
    v_fmac_f32 v241, v61, v141
    v_fmac_f32 v239, v54, v142
    v_fmac_f32 v241, v62, v142
    v_fmac_f32 v239, v55, v143
    v_fmac_f32 v241, v63, v143
    s_setprio 1
    s_waitcnt vmcnt(4) lgkmcnt(3)
    v_mfma_f32_32x32x16_bf16 v[0:15], v[64:67], v[184:187], 0
    ds_read_b64_tr_b16 v[176:177], v246 offset:4096
    ds_read_b64_tr_b16 v[178:179], v246 offset:5120
    ds_read_b64_tr_b16 v[180:181], v247 offset:4096
    ds_read_b64_tr_b16 v[182:183], v247 offset:5120
    s_mov_b32 m0, s69
    v_mfma_f32_32x32x16_bf16 v[16:31], v[68:71], v[184:187], 0
    buffer_load_dwordx4 v224, s[4:7], s45 offen sc1 lds
    buffer_load_dwordx4 v225, s[72:75], s45 offen offset:1024 sc1 lds
    v_permlane32_swap_b32 v234, v236
    v_permlane32_swap_b32 v235, v237
    v_mfma_f32_32x32x16_bf16 v[32:47], v[64:67], v[188:191], 0
    v_permlane32_swap_b32 v240, v238
    v_permlane32_swap_b32 v241, v239
    v_lshl_add_u32 v230, v252, 1, s31
    v_add_f32 v234, v234, v236
    v_add_f32 v235, v235, v237
    v_mfma_f32_32x32x16_bf16 v[48:63], v[68:71], v[188:191], 0
    s_setprio 0
    v_add_f32 v240, v240, v238
    v_add_f32 v241, v241, v239
    v_cvt_pk_bf16_f32 v234, v234, v235
    v_cvt_pk_bf16_f32 v240, v240, v241
    ds_write_b32 v230, v234 offset:0
    ds_write_b32 v230, v240 offset:256
    v_mul_f32 v234, v0, v144
    v_mul_f32 v236, v8, v112
    v_fmac_f32 v234, v1, v145
    v_fmac_f32 v236, v9, v113
    v_fmac_f32 v234, v2, v146
    v_fmac_f32 v236, v10, v114
    v_fmac_f32 v234, v3, v147
    v_fmac_f32 v236, v11, v115
    v_fmac_f32 v234, v4, v148
    v_fmac_f32 v236, v12, v116
    v_fmac_f32 v234, v5, v149
    v_fmac_f32 v236, v13, v117
    v_fmac_f32 v234, v6, v150
    v_fmac_f32 v236, v14, v118
    v_fmac_f32 v234, v7, v151
    v_fmac_f32 v236, v15, v119
    v_mul_f32 v238, v16, v160
    v_mul_f32 v240, v24, v160
    v_fmac_f32 v238, v17, v161
    v_fmac_f32 v240, v25, v161
    v_fmac_f32 v238, v18, v162
    v_fmac_f32 v240, v26, v162
    v_fmac_f32 v238, v19, v163
    v_fmac_f32 v240, v27, v163
    v_fmac_f32 v238, v20, v164
    v_fmac_f32 v240, v28, v164
    v_fmac_f32 v238, v21, v165
    v_fmac_f32 v240, v29, v165
    v_fmac_f32 v238, v22, v166
    v_fmac_f32 v240, v30, v166
    v_fmac_f32 v238, v23, v167
    v_fmac_f32 v240, v31, v167
    v_mul_f32 v235, v32, v152
    v_mul_f32 v237, v40, v120
    v_fmac_f32 v235, v33, v153
    v_fmac_f32 v237, v41, v121
    v_fmac_f32 v235, v34, v154
    v_fmac_f32 v237, v42, v122
    v_fmac_f32 v235, v35, v155
    v_fmac_f32 v237, v43, v123
    v_fmac_f32 v235, v36, v156
    v_fmac_f32 v237, v44, v124
    v_fmac_f32 v235, v37, v157
    v_fmac_f32 v237, v45, v125
    v_fmac_f32 v235, v38, v158
    v_fmac_f32 v237, v46, v126
    v_fmac_f32 v235, v39, v159
    v_fmac_f32 v237, v47, v127
    v_mul_f32 v239, v48, v168
    v_mul_f32 v241, v56, v168
    v_fmac_f32 v239, v49, v169
    v_fmac_f32 v241, v57, v169
    v_fmac_f32 v239, v50, v170
    v_fmac_f32 v241, v58, v170
    v_fmac_f32 v239, v51, v171
    v_fmac_f32 v241, v59, v171
    v_fmac_f32 v239, v52, v172
    v_fmac_f32 v241, v60, v172
    v_fmac_f32 v239, v53, v173
    v_fmac_f32 v241, v61, v173
    v_fmac_f32 v239, v54, v174
    v_fmac_f32 v241, v62, v174
    v_fmac_f32 v239, v55, v175
    v_fmac_f32 v241, v63, v175
    s_setprio 1
    s_waitcnt vmcnt(4) lgkmcnt(2)
    v_mfma_f32_32x32x16_bf16 v[0:15], v[64:67], v[176:179], 0
    ds_read_b64_tr_b16 v[184:185], v246 offset:6144
    ds_read_b64_tr_b16 v[186:187], v246 offset:7168
    ds_read_b64_tr_b16 v[188:189], v247 offset:6144
    ds_read_b64_tr_b16 v[190:191], v247 offset:7168
    s_mov_b32 s32, s31
    s_mov_b32 s31, s35
    s_mov_b32 m0, s70
    v_mfma_f32_32x32x16_bf16 v[16:31], v[68:71], v[176:179], 0
    buffer_load_dwordx4 v226, s[4:7], s46 offen sc1 lds
    buffer_load_dwordx4 v227, s[72:75], s46 offen offset:1024 sc1 lds
    s_sub_u32 s26, s48, s29
    s_mov_b32 s29, s48
    s_mov_b32 s30, s3
    s_bfe_u32 s56, s3, 0x40012
    v_mfma_f32_32x32x16_bf16 v[32:47], v[64:67], v[180:183], 0
    s_cmp_lg_u32 s36, 0
    s_cselect_b32 s56, s56, 0
    v_mfma_f32_32x32x16_bf16 v[48:63], v[68:71], v[180:183], 0
    s_setprio 0
    v_mul_f32 v242, v0, v144
    v_fma_f32 v238, v8, v160, -v238
    v_fmac_f32 v242, v1, v145
    v_fmac_f32 v238, v9, v161
    v_fmac_f32 v242, v2, v146
    v_fmac_f32 v238, v10, v162
    v_fmac_f32 v242, v3, v147
    v_fmac_f32 v238, v11, v163
    v_fmac_f32 v242, v4, v148
    v_fmac_f32 v238, v12, v164
    v_fmac_f32 v242, v5, v149
    v_fmac_f32 v238, v13, v165
    v_fmac_f32 v242, v6, v150
    v_fmac_f32 v238, v14, v166
    v_fmac_f32 v242, v7, v151
    v_fmac_f32 v238, v15, v167
    v_fmac_f32 v236, v16, v112
    v_mul_f32 v244, v24, v160
    v_fmac_f32 v236, v17, v113
    v_fmac_f32 v244, v25, v161
    v_fmac_f32 v236, v18, v114
    v_fmac_f32 v244, v26, v162
    v_fmac_f32 v236, v19, v115
    v_fmac_f32 v244, v27, v163
    v_fmac_f32 v236, v20, v116
    v_fmac_f32 v244, v28, v164
    v_fmac_f32 v236, v21, v117
    v_fmac_f32 v244, v29, v165
    v_fmac_f32 v236, v22, v118
    v_fmac_f32 v244, v30, v166
    v_fmac_f32 v236, v23, v119
    v_fmac_f32 v244, v31, v167
    v_mul_f32 v243, v32, v152
    v_fma_f32 v239, v40, v168, -v239
    v_fmac_f32 v243, v33, v153
    v_fmac_f32 v239, v41, v169
    v_fmac_f32 v243, v34, v154
    v_fmac_f32 v239, v42, v170
    v_fmac_f32 v243, v35, v155
    v_fmac_f32 v239, v43, v171
    v_fmac_f32 v243, v36, v156
    v_fmac_f32 v239, v44, v172
    v_fmac_f32 v243, v37, v157
    v_fmac_f32 v239, v45, v173
    v_fmac_f32 v243, v38, v158
    v_fmac_f32 v239, v46, v174
    v_fmac_f32 v243, v39, v159
    v_fmac_f32 v239, v47, v175
    v_fmac_f32 v237, v48, v120
    v_mul_f32 v245, v56, v168
    v_fmac_f32 v237, v49, v121
    v_fmac_f32 v245, v57, v169
    v_fmac_f32 v237, v50, v122
    v_fmac_f32 v245, v58, v170
    v_fmac_f32 v237, v51, v123
    v_fmac_f32 v245, v59, v171
    v_fmac_f32 v237, v52, v124
    v_fmac_f32 v245, v60, v172
    v_fmac_f32 v237, v53, v125
    v_fmac_f32 v245, v61, v173
    v_fmac_f32 v237, v54, v126
    v_fmac_f32 v245, v62, v174
    v_fmac_f32 v237, v55, v127
    v_fmac_f32 v245, v63, v175
    s_setprio 1
    s_waitcnt vmcnt(4) lgkmcnt(0)
    v_mfma_f32_32x32x16_bf16 v[0:15], v[64:67], v[184:187], 0
    ds_read_b64_tr_b16 v[176:177], v246 offset:0
    ds_read_b64_tr_b16 v[178:179], v246 offset:1024
    ds_read_b64_tr_b16 v[180:181], v247 offset:0
    ds_read_b64_tr_b16 v[182:183], v247 offset:1024
    s_mov_b32 m0, s71
    v_mfma_f32_32x32x16_bf16 v[16:31], v[68:71], v[184:187], 0
    buffer_load_dwordx4 v228, s[4:7], s47 offen sc1 lds
    buffer_load_dwordx4 v229, s[72:75], s47 offen offset:1024 sc1 lds
    v_permlane32_swap_b32 v242, v234
    v_permlane32_swap_b32 v243, v235
    v_add_f32 v242, v242, v234
    v_mfma_f32_32x32x16_bf16 v[32:47], v[64:67], v[188:191], 0
    v_add_f32 v243, v243, v235
    v_cvt_pk_bf16_f32 v242, v242, v243
    ds_write_b32 v230, v242 offset:512
    v_mfma_f32_32x32x16_bf16 v[48:63], v[68:71], v[188:191], 0
    s_setprio 0
    v_mul_f32 v242, v0, v144
    v_fma_f32 v240, v8, v160, -v240
    v_fmac_f32 v242, v1, v145
    v_fmac_f32 v240, v9, v161
    v_fmac_f32 v242, v2, v146
    v_fmac_f32 v240, v10, v162
    v_fmac_f32 v242, v3, v147
    v_fmac_f32 v240, v11, v163
    v_fmac_f32 v242, v4, v148
    v_fmac_f32 v240, v12, v164
    v_fmac_f32 v242, v5, v149
    v_fmac_f32 v240, v13, v165
    v_fmac_f32 v242, v6, v150
    v_fmac_f32 v240, v14, v166
    v_fmac_f32 v242, v7, v151
    v_fmac_f32 v240, v15, v167
    v_add_u32 v249, s26, v249
    v_add_u32 v250, s26, v250
    v_fma_f32 v244, v16, v160, -v244
    v_fmac_f32 v236, v24, v112
    v_fmac_f32 v244, v17, v161
    v_fmac_f32 v236, v25, v113
    v_fmac_f32 v244, v18, v162
    v_fmac_f32 v236, v26, v114
    v_fmac_f32 v244, v19, v163
    v_fmac_f32 v236, v27, v115
    v_fmac_f32 v244, v20, v164
    v_fmac_f32 v236, v28, v116
    v_fmac_f32 v244, v21, v165
    v_fmac_f32 v236, v29, v117
    v_fmac_f32 v244, v22, v166
    v_fmac_f32 v236, v30, v118
    v_fmac_f32 v244, v23, v167
    v_fmac_f32 v236, v31, v119
    ds_read_b64_tr_b16 v[0:1], v249 offset:0
    ds_read_b64_tr_b16 v[2:3], v249 offset:32
    ds_read_u16_d16_hi v16, v250 offset:0
    v_mul_f32 v243, v32, v152
    v_fma_f32 v241, v40, v168, -v241
    v_fmac_f32 v243, v33, v153
    v_fmac_f32 v241, v41, v169
    v_fmac_f32 v243, v34, v154
    v_fmac_f32 v241, v42, v170
    v_fmac_f32 v243, v35, v155
    v_fmac_f32 v241, v43, v171
    v_fmac_f32 v243, v36, v156
    v_fmac_f32 v241, v44, v172
    v_fmac_f32 v243, v37, v157
    v_fmac_f32 v241, v45, v173
    v_fmac_f32 v243, v38, v158
    v_fmac_f32 v241, v46, v174
    v_fmac_f32 v243, v39, v159
    v_fmac_f32 v241, v47, v175
    ds_read_b64_tr_b16 v[4:5], v249 offset:512
    ds_read_b64_tr_b16 v[6:7], v249 offset:544
    ds_read_u16_d16_hi v17, v250 offset:128
    v_fma_f32 v245, v48, v168, -v245
    v_fmac_f32 v237, v56, v120
    v_fmac_f32 v245, v49, v169
    v_fmac_f32 v237, v57, v121
    v_fmac_f32 v245, v50, v170
    v_fmac_f32 v237, v58, v122
    v_fmac_f32 v245, v51, v171
    v_fmac_f32 v237, v59, v123
    v_fmac_f32 v245, v52, v172
    v_fmac_f32 v237, v60, v124
    v_fmac_f32 v245, v53, v173
    v_fmac_f32 v237, v61, v125
    v_fmac_f32 v245, v54, v174
    v_fmac_f32 v237, v62, v126
    v_fmac_f32 v245, v55, v175
    v_fmac_f32 v237, v63, v127
    s_cmp_eq_u32 s56, 5
    s_cbranch_scc1 K2_U21
    s_cmp_eq_u32 s56, 6
    s_cbranch_scc1 K2_U3h1
    s_branch K2_DSP1
K2_U41:
    s_setprio 1
    ds_read_b64_tr_b16 v[8:9], v249 offset:1024
    ds_read_b64_tr_b16 v[10:11], v249 offset:1056
    ds_read_u16_d16_hi v18, v250 offset:256
    s_lshr_b32 s65, s30, 27
    s_mul_i32 s66, s22, 2080
    s_lshl_b32 s65, s65, 9
    s_add_u32 s65, s65, s66
    s_add_u32 s65, s65, 65536
    s_sub_u32 s65, s65, s29
    s_sub_u32 s65, s65, 512
    v_add_u32 v56, s65, v249
    ds_read_b64_tr_b16 v[12:13], v56 offset:0
    ds_read_b64_tr_b16 v[14:15], v56 offset:32
    ds_read_u16_d16_hi v19, v250 offset:384
    s_waitcnt lgkmcnt(6)
    v_lshlrev_b32 v20, 16, v0
    v_and_b32 v21, 0xffff0000, v0
    v_lshlrev_b32 v22, 16, v1
    v_and_b32 v23, 0xffff0000, v1
    v_lshlrev_b32 v24, 16, v2
    v_and_b32 v25, 0xffff0000, v2
    v_lshlrev_b32 v26, 16, v3
    v_and_b32 v27, 0xffff0000, v3
    v_mul_f32_dpp v36, v16, v20 row_newbcast:8 row_mask:0xf bank_mask:0xf
    v_mul_f32_dpp v37, v16, v21 row_newbcast:9 row_mask:0xf bank_mask:0xf
    v_mul_f32_dpp v38, v16, v22 row_newbcast:10 row_mask:0xf bank_mask:0xf
    v_mul_f32_dpp v39, v16, v23 row_newbcast:11 row_mask:0xf bank_mask:0xf
    v_mul_f32_dpp v40, v16, v24 row_newbcast:12 row_mask:0xf bank_mask:0xf
    v_mul_f32_dpp v41, v16, v25 row_newbcast:13 row_mask:0xf bank_mask:0xf
    v_mul_f32_dpp v42, v16, v26 row_newbcast:14 row_mask:0xf bank_mask:0xf
    v_mul_f32_dpp v43, v16, v27 row_newbcast:15 row_mask:0xf bank_mask:0xf
    v_cvt_pk_bf16_f32 v68, v36, v37
    v_cvt_pk_bf16_f32 v69, v38, v39
    v_cvt_pk_bf16_f32 v70, v40, v41
    v_cvt_pk_bf16_f32 v71, v42, v43
    v_mul_f32_dpp v20, v16, v20 row_newbcast:0 row_mask:0xa bank_mask:0xf
    v_mul_f32_dpp v21, v16, v21 row_newbcast:1 row_mask:0xa bank_mask:0xf
    v_mul_f32_dpp v22, v16, v22 row_newbcast:2 row_mask:0xa bank_mask:0xf
    v_mul_f32_dpp v23, v16, v23 row_newbcast:3 row_mask:0xa bank_mask:0xf
    v_mul_f32_dpp v24, v16, v24 row_newbcast:4 row_mask:0xa bank_mask:0xf
    v_mul_f32_dpp v25, v16, v25 row_newbcast:5 row_mask:0xa bank_mask:0xf
    v_mul_f32_dpp v26, v16, v26 row_newbcast:6 row_mask:0xa bank_mask:0xf
    v_mul_f32_dpp v27, v16, v27 row_newbcast:7 row_mask:0xa bank_mask:0xf
    v_cvt_pk_bf16_f32 v64, v20, v21
    v_cvt_pk_bf16_f32 v65, v22, v23
    v_cvt_pk_bf16_f32 v66, v24, v25
    v_cvt_pk_bf16_f32 v67, v26, v27
    v_lshlrev_b32 v28, 16, v4
    v_and_b32 v29, 0xffff0000, v4
    v_lshlrev_b32 v30, 16, v5
    v_and_b32 v31, 0xffff0000, v5
    v_lshlrev_b32 v32, 16, v6
    v_and_b32 v33, 0xffff0000, v6
    v_lshlrev_b32 v34, 16, v7
    v_and_b32 v35, 0xffff0000, v7
    v_mul_f32_dpp v36, v17, v28 row_newbcast:8 row_mask:0xf bank_mask:0xf
    v_mul_f32_dpp v37, v17, v29 row_newbcast:9 row_mask:0xf bank_mask:0xf
    v_mul_f32_dpp v38, v17, v30 row_newbcast:10 row_mask:0xf bank_mask:0xf
    v_mul_f32_dpp v39, v17, v31 row_newbcast:11 row_mask:0xf bank_mask:0xf
    v_mul_f32_dpp v40, v17, v32 row_newbcast:12 row_mask:0xf bank_mask:0xf
    v_mul_f32_dpp v41, v17, v33 row_newbcast:13 row_mask:0xf bank_mask:0xf
    v_mul_f32_dpp v42, v17, v34 row_newbcast:14 row_mask:0xf bank_mask:0xf
    v_mul_f32_dpp v43, v17, v35 row_newbcast:15 row_mask:0xf bank_mask:0xf
    v_cvt_pk_bf16_f32 v76, v36, v37
    v_cvt_pk_bf16_f32 v77, v38, v39
    v_cvt_pk_bf16_f32 v78, v40, v41
    v_cvt_pk_bf16_f32 v79, v42, v43
    v_mul_f32_dpp v28, v17, v28 row_newbcast:0 row_mask:0xa bank_mask:0xf
    v_mul_f32_dpp v29, v17, v29 row_newbcast:1 row_mask:0xa bank_mask:0xf
    v_mul_f32_dpp v30, v17, v30 row_newbcast:2 row_mask:0xa bank_mask:0xf
    v_mul_f32_dpp v31, v17, v31 row_newbcast:3 row_mask:0xa bank_mask:0xf
    v_mul_f32_dpp v32, v17, v32 row_newbcast:4 row_mask:0xa bank_mask:0xf
    v_mul_f32_dpp v33, v17, v33 row_newbcast:5 row_mask:0xa bank_mask:0xf
    v_mul_f32_dpp v34, v17, v34 row_newbcast:6 row_mask:0xa bank_mask:0xf
    v_mul_f32_dpp v35, v17, v35 row_newbcast:7 row_mask:0xa bank_mask:0xf
    v_cvt_pk_bf16_f32 v72, v28, v29
    v_cvt_pk_bf16_f32 v73, v30, v31
    v_cvt_pk_bf16_f32 v74, v32, v33
    v_cvt_pk_bf16_f32 v75, v34, v35
    s_waitcnt lgkmcnt(3)
    v_lshlrev_b32 v20, 16, v8
    v_and_b32 v21, 0xffff0000, v8
    v_lshlrev_b32 v22, 16, v9
    v_and_b32 v23, 0xffff0000, v9
    v_lshlrev_b32 v24, 16, v10
    v_and_b32 v25, 0xffff0000, v10
    v_lshlrev_b32 v26, 16, v11
    v_and_b32 v27, 0xffff0000, v11
    v_mul_f32_dpp v36, v18, v20 row_newbcast:8 row_mask:0xf bank_mask:0xf
    v_mul_f32_dpp v37, v18, v21 row_newbcast:9 row_mask:0xf bank_mask:0xf
    v_mul_f32_dpp v38, v18, v22 row_newbcast:10 row_mask:0xf bank_mask:0xf
    v_mul_f32_dpp v39, v18, v23 row_newbcast:11 row_mask:0xf bank_mask:0xf
    v_mul_f32_dpp v40, v18, v24 row_newbcast:12 row_mask:0xf bank_mask:0xf
    v_mul_f32_dpp v41, v18, v25 row_newbcast:13 row_mask:0xf bank_mask:0xf
    v_mul_f32_dpp v42, v18, v26 row_newbcast:14 row_mask:0xf bank_mask:0xf
    v_mul_f32_dpp v43, v18, v27 row_newbcast:15 row_mask:0xf bank_mask:0xf
    v_cvt_pk_bf16_f32 v84, v36, v37
    v_cvt_pk_bf16_f32 v85, v38, v39
    v_cvt_pk_bf16_f32 v86, v40, v41
    v_cvt_pk_bf16_f32 v87, v42, v43
    v_mul_f32_dpp v20, v18, v20 row_newbcast:0 row_mask:0xa bank_mask:0xf
    v_mul_f32_dpp v21, v18, v21 row_newbcast:1 row_mask:0xa bank_mask:0xf
    v_mul_f32_dpp v22, v18, v22 row_newbcast:2 row_mask:0xa bank_mask:0xf
    v_mul_f32_dpp v23, v18, v23 row_newbcast:3 row_mask:0xa bank_mask:0xf
    v_mul_f32_dpp v24, v18, v24 row_newbcast:4 row_mask:0xa bank_mask:0xf
    v_mul_f32_dpp v25, v18, v25 row_newbcast:5 row_mask:0xa bank_mask:0xf
    v_mul_f32_dpp v26, v18, v26 row_newbcast:6 row_mask:0xa bank_mask:0xf
    v_mul_f32_dpp v27, v18, v27 row_newbcast:7 row_mask:0xa bank_mask:0xf
    v_cvt_pk_bf16_f32 v80, v20, v21
    v_cvt_pk_bf16_f32 v81, v22, v23
    v_cvt_pk_bf16_f32 v82, v24, v25
    v_cvt_pk_bf16_f32 v83, v26, v27
    s_waitcnt lgkmcnt(0)
    v_lshlrev_b32 v28, 16, v12
    v_and_b32 v29, 0xffff0000, v12
    v_lshlrev_b32 v30, 16, v13
    v_and_b32 v31, 0xffff0000, v13
    v_lshlrev_b32 v32, 16, v14
    v_and_b32 v33, 0xffff0000, v14
    v_lshlrev_b32 v34, 16, v15
    v_and_b32 v35, 0xffff0000, v15
    v_mul_f32_dpp v36, v19, v28 row_newbcast:8 row_mask:0xf bank_mask:0xf
    v_mul_f32_dpp v37, v19, v29 row_newbcast:9 row_mask:0xf bank_mask:0xf
    v_mul_f32_dpp v38, v19, v30 row_newbcast:10 row_mask:0xf bank_mask:0xf
    v_mul_f32_dpp v39, v19, v31 row_newbcast:11 row_mask:0xf bank_mask:0xf
    v_mul_f32_dpp v40, v19, v32 row_newbcast:12 row_mask:0xf bank_mask:0xf
    v_mul_f32_dpp v41, v19, v33 row_newbcast:13 row_mask:0xf bank_mask:0xf
    v_mul_f32_dpp v42, v19, v34 row_newbcast:14 row_mask:0xf bank_mask:0xf
    v_mul_f32_dpp v43, v19, v35 row_newbcast:15 row_mask:0xf bank_mask:0xf
    v_cvt_pk_bf16_f32 v92, v36, v37
    v_cvt_pk_bf16_f32 v93, v38, v39
    v_cvt_pk_bf16_f32 v94, v40, v41
    v_cvt_pk_bf16_f32 v95, v42, v43
    v_mul_f32_dpp v28, v19, v28 row_newbcast:0 row_mask:0xa bank_mask:0xf
    v_mul_f32_dpp v29, v19, v29 row_newbcast:1 row_mask:0xa bank_mask:0xf
    v_mul_f32_dpp v30, v19, v30 row_newbcast:2 row_mask:0xa bank_mask:0xf
    v_mul_f32_dpp v31, v19, v31 row_newbcast:3 row_mask:0xa bank_mask:0xf
    v_mul_f32_dpp v32, v19, v32 row_newbcast:4 row_mask:0xa bank_mask:0xf
    v_mul_f32_dpp v33, v19, v33 row_newbcast:5 row_mask:0xa bank_mask:0xf
    v_mul_f32_dpp v34, v19, v34 row_newbcast:6 row_mask:0xa bank_mask:0xf
    v_mul_f32_dpp v35, v19, v35 row_newbcast:7 row_mask:0xa bank_mask:0xf
    v_cvt_pk_bf16_f32 v88, v28, v29
    v_cvt_pk_bf16_f32 v89, v30, v31
    v_cvt_pk_bf16_f32 v90, v32, v33
    v_cvt_pk_bf16_f32 v91, v34, v35
    s_waitcnt vmcnt(4)
    v_mfma_f32_32x32x16_bf16 v[0:15], v[64:67], v[176:179], 0
    ds_read_b64_tr_b16 v[184:185], v246 offset:2048
    ds_read_b64_tr_b16 v[186:187], v246 offset:3072
    ds_read_b64_tr_b16 v[188:189], v247 offset:2048
    ds_read_b64_tr_b16 v[190:191], v247 offset:3072
    s_mov_b32 m0, s68
    v_mfma_f32_32x32x16_bf16 v[16:31], v[68:71], v[176:179], 0
    buffer_load_dwordx4 v222, s[4:7], s41 offen sc1 lds
    buffer_load_dwordx4 v223, s[72:75], s41 offen offset:1024 sc1 lds
    v_permlane32_swap_b32 v242, v236
    v_permlane32_swap_b32 v243, v237
    v_mov_b32 v254, 163296
    v_mfma_f32_32x32x16_bf16 v[32:47], v[64:67], v[180:183], 0
    v_permlane32_swap_b32 v244, v238
    v_permlane32_swap_b32 v245, v239
    v_permlane32_swap_b32 v240, v241
    v_add_f32 v242, v242, v236
    v_mfma_f32_32x32x16_bf16 v[48:63], v[68:71], v[180:183], 0
    v_add_f32 v243, v243, v237
    v_add_f32 v244, v244, v238
    v_add_f32 v245, v245, v239
    v_add_f32 v240, -v240, -v241
    v_sub_u32 v241, v230, v231
    v_cvt_pk_bf16_f32 v242, v242, v243
    v_mov_b32 v255, 1
    v_lshl_add_u32 v233, v252, 1, s53
    s_mov_b64 exec, 1
    ds_add_rtn_u32 v232, v254, v255
    s_mov_b64 exec, -1
    ds_read_b32 v233, v233
    s_waitcnt vmcnt(4) lgkmcnt(2)
    v_mfma_f32_32x32x16_bf16 v[0:15], v[72:75], v[184:187], v[0:15]
    ds_read_b64_tr_b16 v[176:177], v246 offset:4096
    ds_read_b64_tr_b16 v[178:179], v246 offset:5120
    ds_read_b64_tr_b16 v[180:181], v247 offset:4096
    ds_read_b64_tr_b16 v[182:183], v247 offset:5120
    v_cvt_pk_bf16_f32 v244, v244, v245
    v_cvt_pk_bf16_f32 v240, v240, v240
    s_mov_b32 m0, s69
    v_mfma_f32_32x32x16_bf16 v[16:31], v[76:79], v[184:187], v[16:31]
    buffer_load_dwordx4 v224, s[4:7], s41 offen sc1 lds
    buffer_load_dwordx4 v225, s[72:75], s41 offen offset:1024 sc1 lds
    ds_write_b32 v230, v242 offset:768
    ds_write_b32 v230, v244 offset:1024
    ds_write_b16 v241, v240 offset:1280
    s_waitcnt lgkmcnt(7)
    v_readfirstlane_b32 s58, v232
    v_mfma_f32_32x32x16_bf16 v[32:47], v[72:75], v[188:191], v[32:47]
    s_cmp_lt_u32 s58, s22
    s_cbranch_scc0 K2_nul_101
    s_and_b32 s59, s58, 7
    s_lshr_b32 s60, s58, 3
K2_chk_103:
    v_readlane_b32 s61, v233, s59
    s_nop 0
    s_cmp_gt_u32 s61, s60
    s_cbranch_scc0 K2_spin_102
K2_back_104:
    v_mfma_f32_32x32x16_bf16 v[48:63], v[76:79], v[188:191], v[48:63]
    v_readlane_b32 s3, v253, s58
    s_lshl_b32 s44, s34, 7
    s_and_b32 s48, s3, 0x3ffff
    s_bfe_u32 s33, s3, 0x30013
    s_mov_b32 s35, s48
    s_mov_b32 s45, s44
    s_waitcnt vmcnt(4) lgkmcnt(3)
    v_mfma_f32_32x32x16_bf16 v[0:15], v[80:83], v[176:179], v[0:15]
    ds_read_b64_tr_b16 v[184:185], v246 offset:6144
    ds_read_b64_tr_b16 v[186:187], v246 offset:7168
    ds_read_b64_tr_b16 v[188:189], v247 offset:6144
    ds_read_b64_tr_b16 v[190:191], v247 offset:7168
    s_xor_b32 s47, s44, 256
    s_add_u32 s49, s48, 128
    s_mov_b32 m0, s70
    v_mfma_f32_32x32x16_bf16 v[16:31], v[84:87], v[176:179], v[16:31]
    buffer_load_dwordx4 v226, s[4:7], s41 offen sc1 lds
    buffer_load_dwordx4 v227, s[72:75], s41 offen offset:1024 sc1 lds
    s_add_u32 s60, s48, 256
    s_cmp_eq_u32 s33, 3
    s_cselect_b32 s46, s44, s47
    s_cselect_b32 s50, s60, s48
    s_cselect_b32 s51, s48, s49
    v_mfma_f32_32x32x16_bf16 v[32:47], v[80:83], v[180:183], v[32:47]
    s_sub_u32 s60, s33, 2
    s_cmp_lt_u32 s60, 2
    s_cbranch_scc0 K2_rare_105
K2_back_106:
    v_mfma_f32_32x32x16_bf16 v[48:63], v[84:87], v[180:183], v[48:63]
    s_waitcnt vmcnt(4) lgkmcnt(0)
    v_mfma_f32_32x32x16_bf16 v[0:15], v[88:91], v[184:187], v[0:15]
    ds_read_b64_tr_b16 v[176:177], v246 offset:0
    ds_read_b64_tr_b16 v[178:179], v246 offset:1024
    ds_read_b64_tr_b16 v[180:181], v247 offset:0
    ds_read_b64_tr_b16 v[182:183], v247 offset:1024
    s_mov_b32 m0, s71
    v_mfma_f32_32x32x16_bf16 v[16:31], v[92:95], v[184:187], v[16:31]
    buffer_load_dwordx4 v228, s[4:7], s41 offen sc1 lds
    buffer_load_dwordx4 v229, s[72:75], s41 offen offset:1024 sc1 lds
    v_mfma_f32_32x32x16_bf16 v[32:47], v[88:91], v[188:191], v[32:47]
    s_nop 2
    v_mul_f32 v234, v0, v96
    v_mul_f32 v236, v8, v128
    v_fmac_f32 v234, v1, v97
    v_fmac_f32 v236, v9, v129
    v_fmac_f32 v234, v2, v98
    v_fmac_f32 v236, v10, v130
    v_fmac_f32 v234, v3, v99
    v_mfma_f32_32x32x16_bf16 v[48:63], v[92:95], v[188:191], v[48:63]
    s_setprio 0
    v_fmac_f32 v236, v11, v131
    v_fmac_f32 v234, v4, v100
    v_fmac_f32 v236, v12, v132
    v_fmac_f32 v234, v5, v101
    v_fmac_f32 v236, v13, v133
    v_fmac_f32 v234, v6, v102
    v_fmac_f32 v236, v14, v134
    v_fmac_f32 v234, v7, v103
    v_fmac_f32 v236, v15, v135
    v_mul_f32 v238, v16, v128
    v_mul_f32 v240, v24, v128
    v_fmac_f32 v238, v17, v129
    v_fmac_f32 v240, v25, v129
    v_fmac_f32 v238, v18, v130
    v_fmac_f32 v240, v26, v130
    v_fmac_f32 v238, v19, v131
    v_fmac_f32 v240, v27, v131
    v_fmac_f32 v238, v20, v132
    v_fmac_f32 v240, v28, v132
    v_fmac_f32 v238, v21, v133
    v_fmac_f32 v240, v29, v133
    v_fmac_f32 v238, v22, v134
    v_fmac_f32 v240, v30, v134
    v_fmac_f32 v238, v23, v135
    v_fmac_f32 v240, v31, v135
    v_mul_f32 v235, v32, v104
    v_mul_f32 v237, v40, v136
    v_fmac_f32 v235, v33, v105
    v_fmac_f32 v237, v41, v137
    v_fmac_f32 v235, v34, v106
    v_fmac_f32 v237, v42, v138
    v_fmac_f32 v235, v35, v107
    v_fmac_f32 v237, v43, v139
    v_fmac_f32 v235, v36, v108
    v_fmac_f32 v237, v44, v140
    v_fmac_f32 v235, v37, v109
    v_fmac_f32 v237, v45, v141
    v_fmac_f32 v235, v38, v110
    v_fmac_f32 v237, v46, v142
    v_fmac_f32 v235, v39, v111
    v_fmac_f32 v237, v47, v143
    v_mul_f32 v239, v48, v136
    v_mul_f32 v241, v56, v136
    s_setprio 1
    s_waitcnt vmcnt(4) lgkmcnt(0)
    v_mfma_f32_32x32x16_bf16 v[0:15], v[64:67], v[176:179], 0
    ds_read_b64_tr_b16 v[184:185], v246 offset:2048
    ds_read_b64_tr_b16 v[186:187], v246 offset:3072
    ds_read_b64_tr_b16 v[188:189], v247 offset:2048
    ds_read_b64_tr_b16 v[190:191], v247 offset:3072
    v_fmac_f32 v239, v49, v137
    v_fmac_f32 v241, v57, v137
    s_mov_b32 m0, s68
    v_mfma_f32_32x32x16_bf16 v[16:31], v[68:71], v[176:179], 0
    buffer_load_dwordx4 v222, s[4:7], s42 offen sc1 lds
    buffer_load_dwordx4 v223, s[72:75], s42 offen offset:1024 sc1 lds
    v_fmac_f32 v239, v50, v138
    v_fmac_f32 v241, v58, v138
    v_fmac_f32 v239, v51, v139
    v_fmac_f32 v241, v59, v139
    v_fmac_f32 v239, v52, v140
    v_mfma_f32_32x32x16_bf16 v[32:47], v[64:67], v[180:183], 0
    v_fmac_f32 v241, v60, v140
    v_fmac_f32 v239, v53, v141
    v_fmac_f32 v241, v61, v141
    v_fmac_f32 v239, v54, v142
    v_fmac_f32 v241, v62, v142
    v_fmac_f32 v239, v55, v143
    v_fmac_f32 v241, v63, v143
    v_mfma_f32_32x32x16_bf16 v[48:63], v[68:71], v[180:183], 0
    v_permlane32_swap_b32 v234, v236
    v_permlane32_swap_b32 v235, v237
    v_permlane32_swap_b32 v240, v238
    s_waitcnt vmcnt(4) lgkmcnt(0)
    v_mfma_f32_32x32x16_bf16 v[0:15], v[72:75], v[184:187], v[0:15]
    ds_read_b64_tr_b16 v[176:177], v246 offset:4096
    ds_read_b64_tr_b16 v[178:179], v246 offset:5120
    ds_read_b64_tr_b16 v[180:181], v247 offset:4096
    ds_read_b64_tr_b16 v[182:183], v247 offset:5120
    v_permlane32_swap_b32 v241, v239
    s_mov_b32 m0, s69
    v_mfma_f32_32x32x16_bf16 v[16:31], v[76:79], v[184:187], v[16:31]
    buffer_load_dwordx4 v224, s[4:7], s42 offen sc1 lds
    buffer_load_dwordx4 v225, s[72:75], s42 offen offset:1024 sc1 lds
    v_lshl_add_u32 v230, v252, 1, s31
    v_add_f32 v234, v234, v236
    v_add_f32 v235, v235, v237
    v_add_f32 v240, v240, v238
    v_add_f32 v241, v241, v239
    v_mfma_f32_32x32x16_bf16 v[32:47], v[72:75], v[188:191], v[32:47]
    v_cvt_pk_bf16_f32 v234, v234, v235
    v_cvt_pk_bf16_f32 v240, v240, v241
    ds_write_b32 v230, v234 offset:0
    ds_write_b32 v230, v240 offset:256
    v_mfma_f32_32x32x16_bf16 v[48:63], v[76:79], v[188:191], v[48:63]
    s_waitcnt vmcnt(4) lgkmcnt(2)
    v_mfma_f32_32x32x16_bf16 v[0:15], v[80:83], v[176:179], v[0:15]
    ds_read_b64_tr_b16 v[184:185], v246 offset:6144
    ds_read_b64_tr_b16 v[186:187], v246 offset:7168
    ds_read_b64_tr_b16 v[188:189], v247 offset:6144
    ds_read_b64_tr_b16 v[190:191], v247 offset:7168
    s_mov_b32 m0, s70
    v_mfma_f32_32x32x16_bf16 v[16:31], v[84:87], v[176:179], v[16:31]
    buffer_load_dwordx4 v226, s[4:7], s42 offen sc1 lds
    buffer_load_dwordx4 v227, s[72:75], s42 offen offset:1024 sc1 lds
    v_mfma_f32_32x32x16_bf16 v[32:47], v[80:83], v[180:183], v[32:47]
    v_mfma_f32_32x32x16_bf16 v[48:63], v[84:87], v[180:183], v[48:63]
    s_waitcnt vmcnt(4) lgkmcnt(0)
    v_mfma_f32_32x32x16_bf16 v[0:15], v[88:91], v[184:187], v[0:15]
    ds_read_b64_tr_b16 v[176:177], v246 offset:0
    ds_read_b64_tr_b16 v[178:179], v246 offset:1024
    ds_read_b64_tr_b16 v[180:181], v247 offset:0
    ds_read_b64_tr_b16 v[182:183], v247 offset:1024
    s_mov_b32 m0, s71
    v_mfma_f32_32x32x16_bf16 v[16:31], v[92:95], v[184:187], v[16:31]
    buffer_load_dwordx4 v228, s[4:7], s42 offen sc1 lds
    buffer_load_dwordx4 v229, s[72:75], s42 offen offset:1024 sc1 lds
    v_mfma_f32_32x32x16_bf16 v[32:47], v[88:91], v[188:191], v[32:47]
    s_nop 2
    v_mul_f32 v234, v0, v144
    v_mul_f32 v236, v8, v112
    v_fmac_f32 v234, v1, v145
    v_fmac_f32 v236, v9, v113
    v_fmac_f32 v234, v2, v146
    v_fmac_f32 v236, v10, v114
    v_fmac_f32 v234, v3, v147
    v_mfma_f32_32x32x16_bf16 v[48:63], v[92:95], v[188:191], v[48:63]
    s_setprio 0
    v_fmac_f32 v236, v11, v115
    v_fmac_f32 v234, v4, v148
    v_fmac_f32 v236, v12, v116
    v_fmac_f32 v234, v5, v149
    v_fmac_f32 v236, v13, v117
    v_fmac_f32 v234, v6, v150
    v_fmac_f32 v236, v14, v118
    v_fmac_f32 v234, v7, v151
    v_fmac_f32 v236, v15, v119
    v_mul_f32 v238, v16, v160
    v_mul_f32 v240, v24, v160
    v_fmac_f32 v238, v17, v161
    v_fmac_f32 v240, v25, v161
    v_fmac_f32 v238, v18, v162
    v_fmac_f32 v240, v26, v162
    v_fmac_f32 v238, v19, v163
    v_fmac_f32 v240, v27, v163
    v_fmac_f32 v238, v20, v164
    v_fmac_f32 v240, v28, v164
    v_fmac_f32 v238, v21, v165
    v_fmac_f32 v240, v29, v165
    v_fmac_f32 v238, v22, v166
    v_fmac_f32 v240, v30, v166
    v_fmac_f32 v238, v23, v167
    v_fmac_f32 v240, v31, v167
    v_mul_f32 v235, v32, v152
    v_mul_f32 v237, v40, v120
    v_fmac_f32 v235, v33, v153
    v_fmac_f32 v237, v41, v121
    v_fmac_f32 v235, v34, v154
    v_fmac_f32 v237, v42, v122
    v_fmac_f32 v235, v35, v155
    v_fmac_f32 v237, v43, v123
    v_fmac_f32 v235, v36, v156
    v_fmac_f32 v237, v44, v124
    v_fmac_f32 v235, v37, v157
    v_fmac_f32 v237, v45, v125
    v_fmac_f32 v235, v38, v158
    v_fmac_f32 v237, v46, v126
    v_fmac_f32 v235, v39, v159
    v_fmac_f32 v237, v47, v127
    v_mul_f32 v239, v48, v168
    v_mul_f32 v241, v56, v168
    s_setprio 1
    s_waitcnt vmcnt(4) lgkmcnt(0)
    v_mfma_f32_32x32x16_bf16 v[0:15], v[64:67], v[176:179], 0
    ds_read_b64_tr_b16 v[184:185], v246 offset:2048
    ds_read_b64_tr_b16 v[186:187], v246 offset:3072
    ds_read_b64_tr_b16 v[188:189], v247 offset:2048
    ds_read_b64_tr_b16 v[190:191], v247 offset:3072
    v_fmac_f32 v239, v49, v169
    v_fmac_f32 v241, v57, v169
    s_mov_b32 m0, s68
    v_mfma_f32_32x32x16_bf16 v[16:31], v[68:71], v[176:179], 0
    buffer_load_dwordx4 v222, s[4:7], s43 offen sc1 lds
    buffer_load_dwordx4 v223, s[72:75], s43 offen offset:1024 sc1 lds
    v_fmac_f32 v239, v50, v170
    v_fmac_f32 v241, v58, v170
    v_fmac_f32 v239, v51, v171
    v_fmac_f32 v241, v59, v171
    v_fmac_f32 v239, v52, v172
    v_mfma_f32_32x32x16_bf16 v[32:47], v[64:67], v[180:183], 0
    v_fmac_f32 v241, v60, v172
    v_fmac_f32 v239, v53, v173
    v_fmac_f32 v241, v61, v173
    v_fmac_f32 v239, v54, v174
    v_fmac_f32 v241, v62, v174
    v_fmac_f32 v239, v55, v175
    v_fmac_f32 v241, v63, v175
    v_mfma_f32_32x32x16_bf16 v[48:63], v[68:71], v[180:183], 0
    s_waitcnt vmcnt(4) lgkmcnt(0)
    v_mfma_f32_32x32x16_bf16 v[0:15], v[72:75], v[184:187], v[0:15]
    ds_read_b64_tr_b16 v[176:177], v246 offset:4096
    ds_read_b64_tr_b16 v[178:179], v246 offset:5120
    ds_read_b64_tr_b16 v[180:181], v247 offset:4096
    ds_read_b64_tr_b16 v[182:183], v247 offset:5120
    s_mov_b32 m0, s69
    v_mfma_f32_32x32x16_bf16 v[16:31], v[76:79], v[184:187], v[16:31]
    buffer_load_dwordx4 v224, s[4:7], s43 offen sc1 lds
    buffer_load_dwordx4 v225, s[72:75], s43 offen offset:1024 sc1 lds
    v_mfma_f32_32x32x16_bf16 v[32:47], v[72:75], v[188:191], v[32:47]
    v_mfma_f32_32x32x16_bf16 v[48:63], v[76:79], v[188:191], v[48:63]
    s_waitcnt vmcnt(4) lgkmcnt(0)
    v_mfma_f32_32x32x16_bf16 v[0:15], v[80:83], v[176:179], v[0:15]
    ds_read_b64_tr_b16 v[184:185], v246 offset:6144
    ds_read_b64_tr_b16 v[186:187], v246 offset:7168
    ds_read_b64_tr_b16 v[188:189], v247 offset:6144
    ds_read_b64_tr_b16 v[190:191], v247 offset:7168
    s_mov_b32 m0, s70
    v_mfma_f32_32x32x16_bf16 v[16:31], v[84:87], v[176:179], v[16:31]
    buffer_load_dwordx4 v226, s[4:7], s43 offen sc1 lds
    buffer_load_dwordx4 v227, s[72:75], s43 offen offset:1024 sc1 lds
    v_mfma_f32_32x32x16_bf16 v[32:47], v[80:83], v[180:183], v[32:47]
    v_add_u32 v222, s48, v251
    ds_read2_b32 v[222:223], v222 offset0:1 offset1:3
    v_mfma_f32_32x32x16_bf16 v[48:63], v[84:87], v[180:183], v[48:63]
    s_waitcnt vmcnt(4) lgkmcnt(1)
    v_mfma_f32_32x32x16_bf16 v[0:15], v[88:91], v[184:187], v[0:15]
    ds_read_b64_tr_b16 v[176:177], v246 offset:0
    ds_read_b64_tr_b16 v[178:179], v246 offset:1024
    ds_read_b64_tr_b16 v[180:181], v247 offset:0
    ds_read_b64_tr_b16 v[182:183], v247 offset:1024
    s_mov_b32 m0, s71
    v_mfma_f32_32x32x16_bf16 v[16:31], v[92:95], v[184:187], v[16:31]
    buffer_load_dwordx4 v228, s[4:7], s43 offen sc1 lds
    buffer_load_dwordx4 v229, s[72:75], s43 offen offset:1024 sc1 lds
    s_waitcnt lgkmcnt(4)
    v_mad_u32_u16 v222, v222, s39, v248 op_sel:[1,0,0,0]
    v_mad_u32_u16 v223, v223, s39, v248 op_sel:[1,0,0,0]
    v_mfma_f32_32x32x16_bf16 v[32:47], v[88:91], v[188:191], v[32:47]
    v_add_u32 v224, s49, v251
    ds_read2_b32 v[224:225], v224 offset0:1 offset1:3
    v_mul_f32 v242, v0, v144
    v_fma_f32 v238, v8, v160, -v238
    v_fmac_f32 v242, v1, v145
    v_fmac_f32 v238, v9, v161
    v_fmac_f32 v242, v2, v146
    v_mfma_f32_32x32x16_bf16 v[48:63], v[92:95], v[188:191], v[48:63]
    s_setprio 0
    v_fmac_f32 v238, v10, v162
    v_fmac_f32 v242, v3, v147
    v_fmac_f32 v238, v11, v163
    v_fmac_f32 v242, v4, v148
    v_fmac_f32 v238, v12, v164
    v_fmac_f32 v242, v5, v149
    v_fmac_f32 v238, v13, v165
    v_fmac_f32 v242, v6, v150
    v_fmac_f32 v238, v14, v166
    v_fmac_f32 v242, v7, v151
    v_fmac_f32 v238, v15, v167
    v_fmac_f32 v236, v16, v112
    v_mul_f32 v244, v24, v160
    v_fmac_f32 v236, v17, v113
    v_fmac_f32 v244, v25, v161
    v_fmac_f32 v236, v18, v114
    v_fmac_f32 v244, v26, v162
    v_fmac_f32 v236, v19, v115
    v_fmac_f32 v244, v27, v163
    v_fmac_f32 v236, v20, v116
    v_fmac_f32 v244, v28, v164
    v_fmac_f32 v236, v21, v117
    v_fmac_f32 v244, v29, v165
    v_fmac_f32 v236, v22, v118
    v_fmac_f32 v244, v30, v166
    v_fmac_f32 v236, v23, v119
    v_fmac_f32 v244, v31, v167
    v_mul_f32 v243, v32, v152
    v_fma_f32 v239, v40, v168, -v239
    v_fmac_f32 v243, v33, v153
    v_fmac_f32 v239, v41, v169
    v_fmac_f32 v243, v34, v154
    v_fmac_f32 v239, v42, v170
    v_fmac_f32 v243, v35, v155
    v_fmac_f32 v239, v43, v171
    v_fmac_f32 v243, v36, v156
    v_fmac_f32 v239, v44, v172
    v_fmac_f32 v243, v37, v157
    v_fmac_f32 v239, v45, v173
    v_fmac_f32 v243, v38, v158
    v_fmac_f32 v239, v46, v174
    v_fmac_f32 v243, v39, v159
    v_fmac_f32 v239, v47, v175
    v_fmac_f32 v237, v48, v120
    v_mul_f32 v245, v56, v168
    v_fmac_f32 v237, v49, v121
    v_fmac_f32 v245, v57, v169
    v_fmac_f32 v237, v50, v122
    v_fmac_f32 v245, v58, v170
    v_fmac_f32 v237, v51, v123
    s_setprio 1
    s_waitcnt vmcnt(4) lgkmcnt(1)
    v_mfma_f32_32x32x16_bf16 v[0:15], v[64:67], v[176:179], 0
    ds_read_b64_tr_b16 v[184:185], v246 offset:2048
    ds_read_b64_tr_b16 v[186:187], v246 offset:3072
    ds_read_b64_tr_b16 v[188:189], v247 offset:2048
    ds_read_b64_tr_b16 v[190:191], v247 offset:3072
    v_fmac_f32 v245, v59, v171
    v_fmac_f32 v237, v52, v124
    s_mov_b32 m0, s68
    v_mfma_f32_32x32x16_bf16 v[16:31], v[68:71], v[176:179], 0
    buffer_load_dwordx4 v222, s[4:7], s44 offen sc1 lds
    buffer_load_dwordx4 v223, s[72:75], s44 offen offset:1024 sc1 lds
    s_waitcnt lgkmcnt(4)
    v_mad_u32_u16 v224, v224, s39, v248 op_sel:[1,0,0,0]
    v_mad_u32_u16 v225, v225, s39, v248 op_sel:[1,0,0,0]
    v_fmac_f32 v245, v60, v172
    v_fmac_f32 v237, v53, v125
    v_mfma_f32_32x32x16_bf16 v[32:47], v[64:67], v[180:183], 0
    v_add_u32 v226, s50, v251
    ds_read2_b32 v[226:227], v226 offset0:1 offset1:3
    v_fmac_f32 v245, v61, v173
    v_fmac_f32 v237, v54, v126
    v_fmac_f32 v245, v62, v174
    v_fmac_f32 v237, v55, v127
    v_fmac_f32 v245, v63, v175
    v_mfma_f32_32x32x16_bf16 v[48:63], v[68:71], v[180:183], 0
    v_permlane32_swap_b32 v242, v234
    v_permlane32_swap_b32 v243, v235
    v_add_f32 v242, v242, v234
    v_add_f32 v243, v243, v235
    s_waitcnt vmcnt(4) lgkmcnt(1)
    v_mfma_f32_32x32x16_bf16 v[0:15], v[72:75], v[184:187], v[0:15]
    ds_read_b64_tr_b16 v[176:177], v246 offset:4096
    ds_read_b64_tr_b16 v[178:179], v246 offset:5120
    ds_read_b64_tr_b16 v[180:181], v247 offset:4096
    ds_read_b64_tr_b16 v[182:183], v247 offset:5120
    v_cvt_pk_bf16_f32 v242, v242, v243
    ds_write_b32 v230, v242 offset:512
    s_mov_b32 m0, s69
    v_mfma_f32_32x32x16_bf16 v[16:31], v[76:79], v[184:187], v[16:31]
    buffer_load_dwordx4 v224, s[4:7], s45 offen sc1 lds
    buffer_load_dwordx4 v225, s[72:75], s45 offen offset:1024 sc1 lds
    s_waitcnt lgkmcnt(5)
    v_mad_u32_u16 v226, v226, s39, v248 op_sel:[1,0,0,0]
    v_mad_u32_u16 v227, v227, s39, v248 op_sel:[1,0,0,0]
    v_mfma_f32_32x32x16_bf16 v[32:47], v[72:75], v[188:191], v[32:47]
    v_add_u32 v228, s51, v251
    ds_read2_b32 v[228:229], v228 offset0:1 offset1:3
    v_mfma_f32_32x32x16_bf16 v[48:63], v[76:79], v[188:191], v[48:63]
    s_waitcnt vmcnt(4) lgkmcnt(2)
    v_mfma_f32_32x32x16_bf16 v[0:15], v[80:83], v[176:179], v[0:15]
    ds_read_b64_tr_b16 v[184:185], v246 offset:6144
    ds_read_b64_tr_b16 v[186:187], v246 offset:7168
    ds_read_b64_tr_b16 v[188:189], v247 offset:6144
    ds_read_b64_tr_b16 v[190:191], v247 offset:7168
    s_mov_b32 s32, s31
    s_mov_b32 s31, s35
    s_mov_b32 m0, s70
    v_mfma_f32_32x32x16_bf16 v[16:31], v[84:87], v[176:179], v[16:31]
    buffer_load_dwordx4 v226, s[4:7], s46 offen sc1 lds
    buffer_load_dwordx4 v227, s[72:75], s46 offen offset:1024 sc1 lds
    s_waitcnt lgkmcnt(4)
    v_mad_u32_u16 v228, v228, s39, v248 op_sel:[1,0,0,0]
    v_mad_u32_u16 v229, v229, s39, v248 op_sel:[1,0,0,0]
    s_sub_u32 s26, s48, s29
    s_mov_b32 s29, s48
    v_mfma_f32_32x32x16_bf16 v[32:47], v[80:83], v[180:183], v[32:47]
    s_mov_b32 s30, s3
    s_bfe_u32 s56, s3, 0x40012
    s_cmp_lg_u32 s36, 0
    s_cselect_b32 s56, s56, 0
    v_mfma_f32_32x32x16_bf16 v[48:63], v[84:87], v[180:183], v[48:63]
    s_waitcnt vmcnt(4) lgkmcnt(0)
    v_mfma_f32_32x32x16_bf16 v[0:15], v[88:91], v[184:187], v[0:15]
    ds_read_b64_tr_b16 v[176:177], v246 offset:0
    ds_read_b64_tr_b16 v[178:179], v246 offset:1024
    ds_read_b64_tr_b16 v[180:181], v247 offset:0
    ds_read_b64_tr_b16 v[182:183], v247 offset:1024
    s_mov_b32 m0, s71
    v_mfma_f32_32x32x16_bf16 v[16:31], v[92:95], v[184:187], v[16:31]
    buffer_load_dwordx4 v228, s[4:7], s47 offen sc1 lds
    buffer_load_dwordx4 v229, s[72:75], s47 offen offset:1024 sc1 lds
    v_mfma_f32_32x32x16_bf16 v[32:47], v[88:91], v[188:191], v[32:47]
    s_nop 2
    v_mul_f32 v242, v0, v144
    v_fma_f32 v240, v8, v160, -v240
    v_fmac_f32 v242, v1, v145
    v_fmac_f32 v240, v9, v161
    v_fmac_f32 v242, v2, v146
    v_fmac_f32 v240, v10, v162
    v_fmac_f32 v242, v3, v147
    v_mfma_f32_32x32x16_bf16 v[48:63], v[92:95], v[188:191], v[48:63]
    s_setprio 0
    v_fmac_f32 v240, v11, v163
    v_fmac_f32 v242, v4, v148
    v_fmac_f32 v240, v12, v164
    v_fmac_f32 v242, v5, v149
    v_fmac_f32 v240, v13, v165
    v_fmac_f32 v242, v6, v150
    v_fmac_f32 v240, v14, v166
    v_fmac_f32 v242, v7, v151
    v_fmac_f32 v240, v15, v167
    v_add_u32 v249, s26, v249
    v_add_u32 v250, s26, v250
    v_fma_f32 v244, v16, v160, -v244
    v_fmac_f32 v236, v24, v112
    v_fmac_f32 v244, v17, v161
    v_fmac_f32 v236, v25, v113
    v_fmac_f32 v244, v18, v162
    v_fmac_f32 v236, v26, v114
    v_fmac_f32 v244, v19, v163
    v_fmac_f32 v236, v27, v115
    v_fmac_f32 v244, v20, v164
    v_fmac_f32 v236, v28, v116
    v_fmac_f32 v244, v21, v165
    v_fmac_f32 v236, v29, v117
    v_fmac_f32 v244, v22, v166
    v_fmac_f32 v236, v30, v118
    v_fmac_f32 v244, v23, v167
    v_fmac_f32 v236, v31, v119
    ds_read_b64_tr_b16 v[0:1], v249 offset:0
    ds_read_b64_tr_b16 v[2:3], v249 offset:32
    ds_read_u16_d16_hi v16, v250 offset:0
    v_mul_f32 v243, v32, v152
    v_fma_f32 v241, v40, v168, -v241
    v_fmac_f32 v243, v33, v153
    v_fmac_f32 v241, v41, v169
    v_fmac_f32 v243, v34, v154
    v_fmac_f32 v241, v42, v170
    v_fmac_f32 v243, v35, v155
    v_fmac_f32 v241, v43, v171
    v_fmac_f32 v243, v36, v156
    v_fmac_f32 v241, v44, v172
    v_fmac_f32 v243, v37, v157
    v_fmac_f32 v241, v45, v173
    v_fmac_f32 v243, v38, v158
    v_fmac_f32 v241, v46, v174
    v_fmac_f32 v243, v39, v159
    v_fmac_f32 v241, v47, v175
    ds_read_b64_tr_b16 v[4:5], v249 offset:512
    ds_read_b64_tr_b16 v[6:7], v249 offset:544
    ds_read_u16_d16_hi v17, v250 offset:128
    v_fma_f32 v245, v48, v168, -v245
    v_fmac_f32 v237, v56, v120
    v_fmac_f32 v245, v49, v169
    v_fmac_f32 v237, v57, v121
    v_fmac_f32 v245, v50, v170
    v_fmac_f32 v237, v58, v122
    v_fmac_f32 v245, v51, v171
    v_fmac_f32 v237, v59, v123
    v_fmac_f32 v245, v52, v172
    v_fmac_f32 v237, v60, v124
    v_fmac_f32 v245, v53, v173
    v_fmac_f32 v237, v61, v125
    v_fmac_f32 v245, v54, v174
    v_fmac_f32 v237, v62, v126
    v_fmac_f32 v245, v55, v175
    v_fmac_f32 v237, v63, v127
    s_cmp_eq_u32 s56, 5
    s_cbranch_scc1 K2_U21
    s_cmp_eq_u32 s56, 6
    s_cbranch_scc1 K2_U3h1
    s_branch K2_DSP1
K2_FLGR:
    s_sub_u32 s27, s27, 16
    s_cbranch_scc1 K2_END
    buffer_load_dwordx4 v[56:59], v60, s[8:11], s64 offen sc1
    s_branch K2_FLGW
K2_FLGY:
    v_mov_b32 v56, s2
    v_mov_b32 v57, 7178240
    s_mov_b64 exec, 1
    buffer_store_dword v56, v57, s[8:11], 0 offen sc1
    s_mov_b64 exec, -1
    s_branch K2_FLGOK
K2_nul_70:
    s_mov_b32 s58, 63
    s_mov_b32 s36, 0
    s_branch K2_back_73
K2_spin_71:
    s_sub_u32 s27, s27, 1
    s_cbranch_scc1 K2_END
    v_lshl_add_u32 v233, v252, 1, s53
    ds_read_b32 v233, v233
    s_waitcnt lgkmcnt(0)
    s_branch K2_chk_72
K2_dyn_68:
    v_mov_b32 v254, 163296
    v_mov_b32 v255, 1
    v_lshl_add_u32 v233, v252, 1, s53
    s_mov_b64 exec, 1
    ds_add_rtn_u32 v232, v254, v255
    s_mov_b64 exec, -1
    ds_read_b32 v233, v233
    s_waitcnt lgkmcnt(0)
    v_readfirstlane_b32 s58, v232
    s_nop 0
    s_cmp_lt_u32 s58, s22
    s_cbranch_scc0 K2_nul_70
    s_and_b32 s59, s58, 7
    s_lshr_b32 s60, s58, 3
K2_chk_72:
    v_readlane_b32 s61, v233, s59
    s_nop 0
    s_cmp_gt_u32 s61, s60
    s_cbranch_scc0 K2_spin_71
K2_back_73:
    s_mov_b32 s34, 1
    s_branch K2_back_69
K2_rare_74:
    s_cmp_eq_u32 s33, 4
    s_cbranch_scc1 K2_four_76
    s_mov_b32 s49, s48
    s_mov_b32 s51, s48
    s_xor_b32 s45, s44, 256
    s_xor_b32 s46, s44, 512
    s_xor_b32 s47, s44, 768
    s_branch K2_back_75
K2_four_76:
    s_add_u32 s50, s48, 256
    s_add_u32 s51, s48, 384
    s_mov_b32 s46, s44
    s_mov_b32 s47, s44
    s_branch K2_back_75
K2_dum_77:
    v_mov_b32 v232, -1
    s_mov_b32 m0, 163312
    s_mov_b64 exec, 1
    buffer_load_dwordx4 v232, s[16:19], 0 offen lds
    buffer_load_dwordx4 v232, s[16:19], 0 offen lds
    s_mov_b64 exec, -1
    s_branch K2_back_79
K2_a4_78:
    v_add_u32 v254, s48, v230
    ds_read_b32 v254, v254 offset:4
    s_lshr_b32 s65, s3, 27
    s_mul_i32 s66, s22, 2080
    s_lshl_b32 s65, s65, 9
    s_add_u32 s65, s65, s66
    s_add_u32 s65, s65, 65536
    s_mov_b32 m0, s65
    s_mov_b32 exec_hi, 0
    s_waitcnt lgkmcnt(0)
    v_or_b32 v254, v254, v231
    buffer_load_dwordx4 v254, s[16:19], 0 offen  lds
    s_mov_b32 exec_hi, -1
    s_branch K2_b4_80
K2_nul_83:
    s_mov_b32 s58, 63
    s_mov_b32 s36, 0
    s_branch K2_back_86
K2_spin_84:
    s_sub_u32 s27, s27, 1
    s_cbranch_scc1 K2_END
    v_lshl_add_u32 v233, v252, 1, s53
    ds_read_b32 v233, v233
    s_waitcnt lgkmcnt(0)
    s_branch K2_chk_85
K2_dyn_81:
    v_mov_b32 v254, 163296
    v_mov_b32 v255, 1
    v_lshl_add_u32 v233, v252, 1, s53
    s_mov_b64 exec, 1
    ds_add_rtn_u32 v232, v254, v255
    s_mov_b64 exec, -1
    ds_read_b32 v233, v233
    s_waitcnt lgkmcnt(0)
    v_readfirstlane_b32 s58, v232
    s_nop 0
    s_cmp_lt_u32 s58, s22
    s_cbranch_scc0 K2_nul_83
    s_and_b32 s59, s58, 7
    s_lshr_b32 s60, s58, 3
K2_chk_85:
    v_readlane_b32 s61, v233, s59
    s_nop 0
    s_cmp_gt_u32 s61, s60
    s_cbranch_scc0 K2_spin_84
K2_back_86:
    s_mov_b32 s34, 1
    s_branch K2_back_82
K2_rare_87:
    s_cmp_eq_u32 s33, 4
    s_cbranch_scc1 K2_four_89
    s_mov_b32 s49, s48
    s_mov_b32 s51, s48
    s_xor_b32 s45, s44, 256
    s_xor_b32 s46, s44, 512
    s_xor_b32 s47, s44, 768
    s_branch K2_back_88
K2_four_89:
    s_add_u32 s50, s48, 256
    s_add_u32 s51, s48, 384
    s_mov_b32 s46, s44
    s_mov_b32 s47, s44
    s_branch K2_back_88
K2_dum_90:
    v_mov_b32 v232, -1
    s_mov_b32 m0, 163312
    s_mov_b64 exec, 1
    buffer_load_dwordx4 v232, s[16:19], 0 offen lds
    buffer_load_dwordx4 v232, s[16:19], 0 offen lds
    s_mov_b64 exec, -1
    s_branch K2_back_92
K2_a4_91:
    v_add_u32 v254, s48, v230
    ds_read_b32 v254, v254 offset:4
    s_lshr_b32 s65, s3, 27
    s_mul_i32 s66, s22, 2080
    s_lshl_b32 s65, s65, 9
    s_add_u32 s65, s65, s66
    s_add_u32 s65, s65, 65536
    s_mov_b32 m0, s65
    s_mov_b32 exec_hi, 0
    s_waitcnt lgkmcnt(0)
    v_or_b32 v254, v254, v231
    buffer_load_dwordx4 v254, s[16:19], 0 offen  lds
    s_mov_b32 exec_hi, -1
    s_branch K2_b4_93
K2_nul_94:
    s_mov_b32 s58, 63
    s_mov_b32 s36, 0
    s_branch K2_back_97
K2_spin_95:
    s_sub_u32 s27, s27, 1
    s_cbranch_scc1 K2_END
    v_lshl_add_u32 v233, v252, 1, s53
    ds_read_b32 v233, v233
    s_waitcnt lgkmcnt(0)
    s_branch K2_chk_96
K2_rare_98:
    s_cmp_eq_u32 s33, 4
    s_cbranch_scc1 K2_four_100
    s_mov_b32 s49, s48
    s_mov_b32 s51, s48
    s_xor_b32 s45, s44, 256
    s_xor_b32 s46, s44, 512
    s_xor_b32 s47, s44, 768
    s_branch K2_back_99
K2_four_100:
    s_add_u32 s50, s48, 256
    s_add_u32 s51, s48, 384
    s_mov_b32 s46, s44
    s_mov_b32 s47, s44
    s_branch K2_back_99
K2_nul_101:
    s_mov_b32 s58, 63
    s_mov_b32 s36, 0
    s_branch K2_back_104
K2_spin_102:
    s_sub_u32 s27, s27, 1
    s_cbranch_scc1 K2_END
    v_lshl_add_u32 v233, v252, 1, s53
    ds_read_b32 v233, v233
    s_waitcnt lgkmcnt(0)
    s_branch K2_chk_103
K2_rare_105:
    s_cmp_eq_u32 s33, 4
    s_cbranch_scc1 K2_four_107
    s_mov_b32 s49, s48
    s_mov_b32 s51, s48
    s_xor_b32 s45, s44, 256
    s_xor_b32 s46, s44, 512
    s_xor_b32 s47, s44, 768
    s_branch K2_back_106
K2_four_107:
    s_add_u32 s50, s48, 256
    s_add_u32 s51, s48, 384
    s_mov_b32 s46, s44
    s_mov_b32 s47, s44
    s_branch K2_back_106
K2_END:
    s_endpgm
.section .rodata,"a"
.p2align 6
.amdhsa_kernel standalone__tensor_product_equiv_equiformer__graph_kernel
  .amdhsa_next_free_vgpr 256
  .amdhsa_next_free_sgpr 102
  .amdhsa_accum_offset 256
  .amdhsa_group_segment_fixed_size 0
  .amdhsa_kernarg_size 96
  .amdhsa_user_sgpr_count 2
  .amdhsa_user_sgpr_kernarg_segment_ptr 1
  .amdhsa_system_sgpr_workgroup_id_x 1
  .amdhsa_float_denorm_mode_32 3
.end_amdhsa_kernel
```

```asm
; @launch grid=(256,1,1) block=(512,1,1) lds=163840
.amdgcn_target "amdgcn-amd-amdhsa--gfx950"
.text
.globl standalone__tensor_product_equiv_equiformer__graph_kernel
.p2align 8
.type standalone__tensor_product_equiv_equiformer__graph_kernel,@function
standalone__tensor_product_equiv_equiformer__graph_kernel:
    s_cmp_ge_u32 s2, 256
    s_cbranch_scc1 K2_END
    s_load_dwordx16 s[80:95], s[0:1], 0
    s_load_dwordx4 s[96:99], s[0:1], 72
    s_load_dwordx2 s[100:101], s[0:1], 88
    v_lshrrev_b32 v1, 6, v0
    s_mov_b32 s54, s2
    v_readfirstlane_b32 s20, v1
    s_mov_b64 exec, 0
    s_cmp_eq_u32 s20, 0
    s_cbranch_scc1 K2_PAD_S1
    s_cmp_eq_u32 s20, 1
    s_cbranch_scc1 K2_PAD_S2
    s_cmp_eq_u32 s20, 5
    s_cbranch_scc1 K2_PAD_H1
    s_cmp_eq_u32 s20, 6
    s_cbranch_scc1 K2_PAD_H2
    s_cmp_eq_u32 s20, 2
    s_cbranch_scc1 K2_PAD_H3
KS_HOP0:
    s_mov_b64 exec, -1
    v_and_b32 v8, 63, v0
    v_lshlrev_b32 v9, 4, v8
    v_mov_b32 v6, 0
    v_lshlrev_b32 v5, 4, v0
    v_mul_u32_u24 v4, 24, v0
    s_mul_i32 s64, s2, 5120
    s_mul_i32 s65, s2, 7680
    v_mov_b32 v176, v8
    v_mov_b32 v177, v0
    s_movk_i32 s39, 1024
    s_lshl_b32 s37, s20, 13
    s_mov_b32 s53, 163264
    s_lshl_b32 s52, s20, 2
    s_add_u32 s52, s52, s53
    s_add_u32 s68, s37, 0
    s_add_u32 s69, s37, 2048
    s_add_u32 s70, s37, 4096
    s_add_u32 s71, s37, 6144
    s_waitcnt lgkmcnt(0)
    s_mov_b32 s8, s100
    s_and_b32 s9, s101, 0xffff
    s_mov_b32 s10, 37748736
    s_mov_b32 s11, 0x20000
    s_cmp_lg_u32 s20, 7
    s_cbranch_scc1 KS_NOTAG
    s_mov_b32 s24, 7178240
    s_mov_b64 exec, 1
    buffer_load_dword v14, v6, s[8:11], s24 offen sc1
    s_mov_b64 exec, -1
    s_mov_b32 s60, s98
    s_and_b32 s61, s99, 0xffff
    s_mov_b32 s62, 256
    s_mov_b32 s63, 0x20000
    s_barrier
    v_mov_b32 v76, 0
    v_mov_b32 v77, -1
    v_lshlrev_b32 v78, 2, v8
    v_add_u32 v78, 163072, v78
    s_mov_b64 exec, 0x1ff
    ds_write_b32 v78, v76 offset:192
    s_mov_b32 exec_lo, 1
    ds_write_b32 v78, v76 offset:232
    s_mov_b32 exec_lo, -1
    ds_write_b32 v78, v77 offset:256
    s_mov_b64 exec, -1
    s_mov_b32 exec_hi, 0xffff
    ds_write_b32 v78, v76
    s_mov_b64 exec, 1
    ds_write_b32 v78, v76 offset:228
    s_mov_b64 exec, -1
    s_mov_b64 exec, 1
    buffer_load_dword v15, v6, s[60:63], 0 offen sc1
    v_mov_b32 v12, 163456
    s_mov_b32 s24, 1664525
    s_waitcnt vmcnt(1)
    v_mul_lo_u32 v59, v14, s24
    v_add_u32 v59, 1013904223, v59
    ds_write2_b32 v12, v59, v6 offset0:0 offset1:1
    s_waitcnt lgkmcnt(0)
    s_barrier
    s_waitcnt vmcnt(0)
    v_mov_b32 v62, v15
    ds_write_b32 v12, v15 offset:4
    v_cmp_ne_u32 vcc, 0, v15
    s_mov_b32 s24, 0x40000
    s_waitcnt lgkmcnt(0)
    s_barrier
    s_cbranch_vccnz KS_FLOK
KS_FLW:
    s_sub_u32 s24, s24, 1
    s_cbranch_scc1 K2_END
    buffer_load_dword v62, v6, s[60:63], 0 offen sc1
    s_waitcnt vmcnt(0)
    v_cmp_ne_u32 vcc, 0, v62
    s_nop 0
    s_cbranch_vccz KS_FLW
    ds_write_b32 v12, v62 offset:4
KS_FLOK:
    s_mov_b64 exec, -1
    s_branch KS_JOIN
KS_H0:
    s_barrier
    s_branch KS_HELP
K2_PAD_S1:
    s_branch KS_HOP0
KS_NOTAG:
    s_cmp_ge_u32 s20, 5
    s_cbranch_scc1 KS_HELP
    s_cmp_ge_u32 s2, 250
    s_cbranch_scc1 KS_IDLE
    s_mov_b32 s40, s88
    s_and_b32 s41, s89, 0xffff
    s_mov_b32 s42, 1280000
    s_mov_b32 s43, 0x20000
    buffer_load_dwordx4 v[12:15], v5, s[40:43], s64 offen
    s_mov_b32 s44, s86
    s_and_b32 s45, s87, 0xffff
    s_mov_b32 s46, 1280000
    s_mov_b32 s47, 0x20000
    s_mov_b32 s48, s82
    s_and_b32 s49, s83, 0xffff
    s_mov_b32 s50, 1920000
    s_mov_b32 s51, 0x20000
    buffer_load_dwordx4 v[16:19], v5, s[44:47], s64 offen
    buffer_load_dwordx4 v[20:23], v4, s[48:51], s65 offen
    buffer_load_dwordx2 v[24:25], v4, s[48:51], s65 offen offset:16
    v_lshlrev_b32 v2, 2, v0
    s_lshl_b32 s64, s64, 3
    v_lshl_add_u32 v3, v0, 7, s64
    v_mov_b32 v7, 1
    s_cmp_eq_u32 s20, 4
    s_cbranch_scc1 KS_NOCLR
    ds_write_b32 v2, v6
KS_NOCLR:
    s_waitcnt lgkmcnt(0)
    s_barrier
    s_mov_b64 exec, 0
    s_cmp_eq_u32 s20, 0
    s_cbranch_scc1 K2_PAD_B3
    s_cmp_eq_u32 s20, 1
    s_cbranch_scc1 K2_PAD_LD
    s_cmp_eq_u32 s20, 2
    s_cbranch_scc1 K2_PAD_NW
    s_cmp_eq_u32 s20, 3
    s_cbranch_scc1 K2_PAD_SC
    s_cmp_eq_u32 s20, 4
    s_cbranch_scc1 K2_PAD_SD
KS_HOP:
    s_mov_b64 exec, -1
    s_mov_b32 s58, 214749
    s_movk_i32 s59, 625
    s_waitcnt vmcnt(3)
    v_mul_u32_u24 v28, s58, v12
    v_and_b32 v40, 0xffffff, v28
    v_lshrrev_b32 v32, 26, v28
    v_add_u32 v40, 8187281, v40
    v_bfe_u32 v36, v28, 24, 2
    v_lshlrev_b32 v32, 2, v32
    v_lshrrev_b32 v40, 24, v40
    v_lshl_or_b32 v32, v36, 8, v32
    v_lshl_or_b32 v32, v40, 7, v32
    ds_add_rtn_u32 v36, v32, v7
    v_mul_u32_u24 v29, s58, v13
    v_and_b32 v41, 0xffffff, v29
    v_lshrrev_b32 v33, 26, v29
    v_add_u32 v41, 8187281, v41
    v_bfe_u32 v37, v29, 24, 2
    v_lshlrev_b32 v33, 2, v33
    v_lshrrev_b32 v41, 24, v41
    v_lshl_or_b32 v33, v37, 8, v33
    v_lshl_or_b32 v33, v41, 7, v33
    ds_add_rtn_u32 v37, v33, v7
    v_mul_u32_u24 v30, s58, v14
    v_and_b32 v42, 0xffffff, v30
    v_lshrrev_b32 v34, 26, v30
    v_add_u32 v42, 8187281, v42
    v_bfe_u32 v38, v30, 24, 2
    v_lshlrev_b32 v34, 2, v34
    v_lshrrev_b32 v42, 24, v42
    v_lshl_or_b32 v34, v38, 8, v34
    v_lshl_or_b32 v34, v42, 7, v34
    ds_add_rtn_u32 v38, v34, v7
    v_mul_u32_u24 v31, s58, v15
    v_and_b32 v43, 0xffffff, v31
    v_lshrrev_b32 v35, 26, v31
    v_add_u32 v43, 8187281, v43
    v_bfe_u32 v39, v31, 24, 2
    v_lshlrev_b32 v35, 2, v35
    v_lshrrev_b32 v43, 24, v43
    v_lshl_or_b32 v35, v39, 8, v35
    v_lshl_or_b32 v35, v43, 7, v35
    ds_add_rtn_u32 v39, v35, v7
    v_lshrrev_b32 v28, 24, v28
    v_mad_u32_u24 v28, v28, s59, 7
    v_lshrrev_b32 v28, 3, v28
    v_mad_u32_u24 v28, v40, 40, v28
    v_sub_u32 v28, v12, v28
    v_add_u32 v12, 0, v3
    v_lshl_or_b32 v28, v28, 26, v12
    v_lshrrev_b32 v29, 24, v29
    v_mad_u32_u24 v29, v29, s59, 7
    v_lshrrev_b32 v29, 3, v29
    v_mad_u32_u24 v29, v41, 40, v29
    v_sub_u32 v29, v13, v29
    v_add_u32 v13, 32, v3
    v_lshl_or_b32 v29, v29, 26, v13
    v_lshrrev_b32 v30, 24, v30
    v_mad_u32_u24 v30, v30, s59, 7
    v_lshrrev_b32 v30, 3, v30
    v_mad_u32_u24 v30, v42, 40, v30
    v_sub_u32 v30, v14, v30
    v_add_u32 v14, 64, v3
    v_lshl_or_b32 v30, v30, 26, v14
    v_lshrrev_b32 v31, 24, v31
    v_mad_u32_u24 v31, v31, s59, 7
    v_lshrrev_b32 v31, 3, v31
    v_mad_u32_u24 v31, v43, 40, v31
    v_sub_u32 v31, v15, v31
    v_add_u32 v15, 96, v3
    v_lshl_or_b32 v31, v31, 26, v15
K2_PAD_S2:
    s_cbranch_execz KS_HOP0
    v_mov_b32 v59, 163456
    s_mul_i32 s65, s2, 1152
    s_add_u32 s65, s65, 6291456
    s_mul_i32 s64, s2, 20608
    s_waitcnt lgkmcnt(0)
    s_barrier
    ds_read_b128 v[40:43], v9
    ds_read_b32 v59, v59
    s_waitcnt lgkmcnt(1)
    v_add_u32 v45, v40, v41
    v_add_u32 v46, v45, v42
    v_add_u32 v47, v46, v43
    v_mov_b32 v58, v47
    s_nop 1
    v_add_u32_dpp v58, v58, v58 row_shr:1 row_mask:0xf bank_mask:0xf bound_ctrl:0
    s_nop 1
    v_add_u32_dpp v58, v58, v58 row_shr:2 row_mask:0xf bank_mask:0xf bound_ctrl:0
    s_nop 1
    v_add_u32_dpp v58, v58, v58 row_shr:4 row_mask:0xf bank_mask:0xf bound_ctrl:0
    s_nop 1
    v_add_u32_dpp v58, v58, v58 row_shr:8 row_mask:0xf bank_mask:0xf bound_ctrl:0
    s_nop 1
    v_add_u32_dpp v58, v58, v58 row_bcast:15 row_mask:0xa bank_mask:0xf
    s_nop 1
    v_add_u32_dpp v58, v58, v58 row_bcast:31 row_mask:0xc bank_mask:0xf
    v_sub_u32 v48, v58, v47
    v_add_u32 v49, v48, v40
    v_add_u32 v50, v48, v45
    v_add_u32 v51, v48, v46
    ds_write_b128 v9, v[48:51] offset:1024
    s_waitcnt lgkmcnt(1)
    s_cmp_lg_u32 s20, 4
    s_cbranch_scc1 KS_NOPUB
    v_lshl_or_b32 v56, v49, 11, v48
    v_lshl_or_b32 v57, v51, 11, v50
    v_lshl_or_b32 v56, v59, 22, v56
    v_lshl_or_b32 v57, v59, 22, v57
    buffer_store_dwordx4 v[56:59], v9, s[8:11], s65 offen sc1
KS_NOPUB:
    s_waitcnt lgkmcnt(0)
    ds_read_b32 v32, v32 offset:1024
    ds_read_b32 v33, v33 offset:1024
    ds_read_b32 v34, v34 offset:1024
    ds_read_b32 v35, v35 offset:1024
    s_cbranch_scc1 KS_PUB0
    s_waitcnt vmcnt(1)
    s_branch KS_PUB1
KS_PUB0:
    s_waitcnt vmcnt(0)
KS_PUB1:
    v_and_b32 v60, 0xffff, v59
    v_and_b32 v61, 0xffff0000, v59
    s_mov_b32 s58, 0xffff0000
    v_mov_b32 v40, v20
    v_lshl_or_b32 v41, v21, 16, v60
    v_or_b32 v42, v61, v16
    v_mov_b32 v43, v28
    v_alignbit_b32 v44, v22, v21, 16
    v_and_or_b32 v45, v22, s58, v60
    v_or_b32 v46, v61, v17
    v_mov_b32 v47, v29
    v_mov_b32 v48, v23
    v_lshl_or_b32 v49, v24, 16, v60
    v_or_b32 v50, v61, v18
    v_mov_b32 v51, v30
    v_alignbit_b32 v52, v25, v24, 16
    v_and_or_b32 v53, v25, s58, v60
    v_or_b32 v54, v61, v19
    v_mov_b32 v55, v31
    s_waitcnt lgkmcnt(0)
    v_add_lshl_u32 v32, v32, v36, 4
    ds_write_b128 v32, v[40:43] offset:2048
    v_add_lshl_u32 v33, v33, v37, 4
    ds_write_b128 v33, v[44:47] offset:2048
    v_add_lshl_u32 v34, v34, v38, 4
    ds_write_b128 v34, v[48:51] offset:2048
    v_add_lshl_u32 v35, v35, v39, 4
    ds_write_b128 v35, v[52:55] offset:2048
    v_mov_b32 v62, 163460
    s_waitcnt lgkmcnt(0)
    s_barrier
    ds_read_b32 v62, v62
    ds_read_b128 v[12:15], v5 offset:2048
    ds_read_b128 v[16:19], v5 offset:7168
    ds_read_b128 v[20:23], v5 offset:12288
    ds_read_b128 v[24:27], v5 offset:17408
    s_waitcnt lgkmcnt(3)
    buffer_store_dwordx4 v[12:15], v5, s[8:11], s64 offen sc1
    s_add_u32 s64, s64, 5120
    s_waitcnt lgkmcnt(2)
    buffer_store_dwordx4 v[16:19], v5, s[8:11], s64 offen sc1
    s_add_u32 s64, s64, 5120
    s_waitcnt lgkmcnt(1)
    buffer_store_dwordx4 v[20:23], v5, s[8:11], s64 offen sc1
    s_add_u32 s64, s64, 5120
    s_waitcnt lgkmcnt(0)
    buffer_store_dwordx4 v[24:27], v5, s[8:11], s64 offen sc1
    s_branch KS_JOIN
K2_PAD_B3:
    s_branch KS_HOP
KS_B3:
    v_mov_b32 v59, 163456
    ds_read_b32 v59, v59
    v_mov_b32 v62, 163460
    s_waitcnt lgkmcnt(0)
    s_barrier
    ds_read_b32 v62, v62
KS_JOIN:
    v_readfirstlane_b32 s2, v59
    s_mov_b32 s25, 0x400000
KS_JOIN2:
    s_waitcnt lgkmcnt(0)
    v_readfirstlane_b32 s24, v62
    s_nop 0
    s_cmp_eq_u32 s24, 0
    s_cbranch_scc1 KS_FLS
    s_bfe_u32 s24, s24, 0x10001
    s_xor_b32 s54, s54, s24
    s_lshr_b32 s21, s54, 1
    s_mul_i32 s21, s21, 625
    s_add_u32 s22, s21, 632
    s_add_u32 s21, s21, 7
    s_lshr_b32 s21, s21, 3
    s_lshr_b32 s22, s22, 3
    s_add_u32 s24, s21, 40
    s_sub_u32 s22, s22, s24
    s_bitcmp1_b32 s54, 0
    s_cselect_b32 s21, s24, s21
    s_cselect_b32 s22, s22, 40
    s_mov_b32 s23, 0
    s_mov_b32 s28, 1
    s_mov_b32 s24, 0
    s_mov_b32 s25, 1
K2_CELLS:
    v_lshrrev_b32 v178, 1, v177
    v_min_u32 v178, 249, v178
    v_mul_u32_u24 v72, 1152, v178
    s_and_b32 s58, s54, 7
    s_lshl_b32 s58, s58, 7
    s_lshr_b32 s59, s54, 5
    s_lshl_b32 s59, s59, 4
    s_add_u32 s67, s58, s59
    s_add_u32 s67, s67, 6291456
    s_cmp_eq_u32 s28, 0
    s_cbranch_scc1 K2_NOSRD
    s_mov_b32 s4, s80
    s_and_b32 s5, s81, 0xffff
    s_mov_b32 s6, 10240000
    s_mov_b32 s7, 0x20000
    s_mov_b32 s12, s96
    s_and_b32 s13, s97, 0xffff
    s_mov_b32 s14, 10240000
    s_mov_b32 s15, 0x20000
    s_mov_b32 s16, s84
    s_and_b32 s17, s85, 0xffff
    s_mov_b32 s18, 10240000
    s_mov_b32 s19, 0x20000
    s_sub_u32 s80, s80, 1024
    s_subb_u32 s81, s81, 0
    s_mov_b32 s72, s80
    s_and_b32 s73, s81, 0xffff
    s_mov_b32 s74, 10241024
    s_mov_b32 s75, 0x20000
    s_mov_b64 exec, 0
    s_cmp_eq_u32 s20, 0
    s_cbranch_scc1 K2_PAD_U20
    s_cmp_eq_u32 s20, 1
    s_cbranch_scc1 K2_PAD_U30
    s_cmp_eq_u32 s20, 2
    s_cbranch_scc1 K2_PAD_U21
    s_cmp_eq_u32 s20, 3
    s_cbranch_scc1 K2_PAD_U31
    s_cmp_eq_u32 s20, 4
    s_cbranch_scc1 K2_PAD_SW
    s_cmp_eq_u32 s20, 5
    s_cbranch_scc1 K2_PAD_TL
    s_cmp_eq_u32 s20, 6
    s_cbranch_scc1 K2_PAD_T2
K2_HOP:
    s_mov_b64 exec, -1
K2_NOSRD:
    v_and_b32 v84, 15, v176
    v_lshrrev_b32 v85, 5, v176
    v_bfe_u32 v86, v176, 4, 1
    v_lshrrev_b32 v87, 2, v84
    v_and_b32 v88, 3, v84
    v_lshl_add_u32 v89, v85, 2, v87
    v_lshlrev_b32 v249, 6, v89
    v_lshl_add_u32 v249, v88, 3, v249
    v_add_u32 v249, 512, v249
    v_lshrrev_b32 v90, 3, v84
    v_lshl_add_u32 v90, v90, 1, v86
    v_sub_u32 v90, v90, 1 clamp
    v_lshlrev_b32 v250, 1, v90
    v_lshl_add_u32 v91, v85, 2, v88
    v_lshl_add_u32 v250, v91, 4, v250
    v_and_b32 v91, 1, v87
    v_lshl_add_u32 v250, v91, 3, v250
    v_lshrrev_b32 v90, 1, v88
    v_lshl_add_u32 v90, v86, 1, v90
    v_bfe_u32 v91, v87, 1, 1
    v_lshlrev_b32 v91, 2, v91
    v_xor_b32 v90, v90, v91
    v_lshlrev_b32 v90, 4, v90
    v_lshl_add_u32 v90, v89, 7, v90
    v_and_b32 v91, 1, v88
    v_lshl_add_u32 v90, v91, 3, v90
    v_add_u32 v246, s37, v90
    v_xor_b32 v247, 64, v246
    v_lshrrev_b32 v90, 3, v176
    v_lshlrev_b32 v251, 4, v90
    v_bfe_u32 v90, v90, 1, 1
    v_lshlrev_b32 v90, 2, v90
    v_and_b32 v91, 7, v176
    v_xor_b32 v90, v90, v91
    v_lshlrev_b32 v248, 4, v90
    v_lshlrev_b32 v252, 1, v176
    v_and_b32 v231, 1, v176
    v_lshlrev_b32 v231, 4, v231
    v_lshrrev_b32 v90, 1, v176
    v_lshlrev_b32 v90, 5, v90
    v_add_u32 v230, 512, v90
    s_cmp_eq_u32 s28, 0
    s_cbranch_scc1 K2_NOW0
    v_lshrrev_b32 v60, 6, v252
    v_bfe_u32 v61, v252, 3, 2
    v_lshl_add_u32 v60, v60, 2, v61
    v_mul_u32_u24 v60, 640, v60
    v_bfe_u32 v61, v252, 5, 1
    v_lshl_add_u32 v60, v61, 5, v60
    v_and_b32 v61, 6, v252
    v_lshl_add_u32 v60, v61, 2, v60
    v_add_u32 v60, 24576, v60
    ds_read_b64_tr_b16 v[136:137], v60 offset:0
    ds_read_b64_tr_b16 v[138:139], v60 offset:5120
    ds_read_b64_tr_b16 v[140:141], v60 offset:64
    ds_read_b64_tr_b16 v[142:143], v60 offset:5184
    ds_read_b64_tr_b16 v[144:145], v60 offset:128
    ds_read_b64_tr_b16 v[146:147], v60 offset:5248
    ds_read_b64_tr_b16 v[148:149], v60 offset:192
    ds_read_b64_tr_b16 v[150:151], v60 offset:5312
    ds_read_b64_tr_b16 v[152:153], v60 offset:256
    ds_read_b64_tr_b16 v[154:155], v60 offset:5376
    ds_read_b64_tr_b16 v[156:157], v60 offset:320
    ds_read_b64_tr_b16 v[158:159], v60 offset:5440
    ds_read_b64_tr_b16 v[160:161], v60 offset:384
    ds_read_b64_tr_b16 v[162:163], v60 offset:5504
    ds_read_b64_tr_b16 v[164:165], v60 offset:448
    ds_read_b64_tr_b16 v[166:167], v60 offset:5568
    ds_read_b64_tr_b16 v[168:169], v60 offset:512
    ds_read_b64_tr_b16 v[170:171], v60 offset:5632
    ds_read_b64_tr_b16 v[172:173], v60 offset:576
    ds_read_b64_tr_b16 v[174:175], v60 offset:5696
    s_waitcnt lgkmcnt(0)
    v_lshlrev_b32 v96, 16, v136
    v_and_b32 v97, 0xffff0000, v136
    v_lshlrev_b32 v98, 16, v137
    v_and_b32 v99, 0xffff0000, v137
    v_lshlrev_b32 v100, 16, v138
    v_and_b32 v101, 0xffff0000, v138
    v_lshlrev_b32 v102, 16, v139
    v_and_b32 v103, 0xffff0000, v139
    v_lshlrev_b32 v104, 16, v140
    v_and_b32 v105, 0xffff0000, v140
    v_lshlrev_b32 v106, 16, v141
    v_and_b32 v107, 0xffff0000, v141
    v_lshlrev_b32 v108, 16, v142
    v_and_b32 v109, 0xffff0000, v142
    v_lshlrev_b32 v110, 16, v143
    v_and_b32 v111, 0xffff0000, v143
    v_lshlrev_b32 v112, 16, v144
    v_and_b32 v113, 0xffff0000, v144
    v_lshlrev_b32 v114, 16, v145
    v_and_b32 v115, 0xffff0000, v145
    v_lshlrev_b32 v116, 16, v146
    v_and_b32 v117, 0xffff0000, v146
    v_lshlrev_b32 v118, 16, v147
    v_and_b32 v119, 0xffff0000, v147
    v_lshlrev_b32 v120, 16, v148
    v_and_b32 v121, 0xffff0000, v148
    v_lshlrev_b32 v122, 16, v149
    v_and_b32 v123, 0xffff0000, v149
    v_lshlrev_b32 v124, 16, v150
    v_and_b32 v125, 0xffff0000, v150
    v_lshlrev_b32 v126, 16, v151
    v_and_b32 v127, 0xffff0000, v151
    buffer_load_dwordx4 v[76:79], v72, s[8:11], s67 offen sc1
    v_lshlrev_b32 v128, 16, v152
    v_and_b32 v129, 0xffff0000, v152
    v_lshlrev_b32 v130, 16, v153
    v_and_b32 v131, 0xffff0000, v153
    v_lshlrev_b32 v132, 16, v154
    v_and_b32 v133, 0xffff0000, v154
    v_lshlrev_b32 v134, 16, v155
    v_and_b32 v135, 0xffff0000, v155
    v_lshlrev_b32 v136, 16, v156
    v_and_b32 v137, 0xffff0000, v156
    v_lshlrev_b32 v138, 16, v157
    v_and_b32 v139, 0xffff0000, v157
    v_lshlrev_b32 v140, 16, v158
    v_and_b32 v141, 0xffff0000, v158
    v_lshlrev_b32 v142, 16, v159
    v_and_b32 v143, 0xffff0000, v159
    v_lshlrev_b32 v144, 16, v160
    v_and_b32 v145, 0xffff0000, v160
    v_lshlrev_b32 v146, 16, v161
    v_and_b32 v147, 0xffff0000, v161
    v_lshlrev_b32 v148, 16, v162
    v_and_b32 v149, 0xffff0000, v162
    v_lshlrev_b32 v150, 16, v163
    v_and_b32 v151, 0xffff0000, v163
    v_lshlrev_b32 v152, 16, v164
    v_and_b32 v153, 0xffff0000, v164
    v_lshlrev_b32 v154, 16, v165
    v_and_b32 v155, 0xffff0000, v165
    v_lshlrev_b32 v156, 16, v166
    v_and_b32 v157, 0xffff0000, v166
    v_lshlrev_b32 v158, 16, v167
    v_and_b32 v159, 0xffff0000, v167
    v_lshlrev_b32 v160, 16, v168
    v_and_b32 v161, 0xffff0000, v168
    v_lshlrev_b32 v162, 16, v169
    v_and_b32 v163, 0xffff0000, v169
    v_lshlrev_b32 v164, 16, v170
    v_and_b32 v165, 0xffff0000, v170
    v_lshlrev_b32 v166, 16, v171
    v_and_b32 v167, 0xffff0000, v171
    v_lshlrev_b32 v168, 16, v172
    v_and_b32 v169, 0xffff0000, v172
    v_lshlrev_b32 v170, 16, v173
    v_and_b32 v171, 0xffff0000, v173
    v_lshlrev_b32 v172, 16, v174
    v_and_b32 v173, 0xffff0000, v174
    v_lshlrev_b32 v174, 16, v175
    v_and_b32 v175, 0xffff0000, v175
K2_W0:
    s_lshl_b32 s59, s2, 22
    s_mov_b32 s60, 0x40000
    s_bfe_u32 s61, s54, 0x10004
    s_bfe_u32 s62, s54, 0x10003
    s_add_u32 s63, s61, s62
    s_mul_i32 s62, s62, 11
    s_sub_u32 s64, 11, s62
    v_cmp_gt_u32 vcc, 500, v177
    s_nop 0
    s_mov_b64 s[56:57], vcc
K2_POLL:
    s_waitcnt vmcnt(0)
    v_xor_b32 v73, s59, v76
    v_xor_b32 v74, s59, v77
    v_or_b32 v73, v73, v74
    v_xor_b32 v74, s2, v79
    v_lshrrev_b32 v73, 22, v73
    v_or_b32 v73, v73, v74
    v_cmp_ne_u32 vcc, 0, v73
    s_nop 0
    s_cbranch_vccz K2_POLLED
    s_sub_u32 s60, s60, 1
    s_cbranch_scc1 K2_END
    s_mov_b64 exec, vcc
    buffer_load_dwordx4 v[76:79], v72, s[8:11], s67 offen sc1
    s_mov_b64 exec, -1
    s_branch K2_POLL
K2_PAD_LD:
    s_branch KS_HOP
K2_POLLED:
    s_set_gpr_idx_on s61, gpr_idx(SRC0)
    s_nop 0
    v_bfe_u32 v179, v76, s62, 11
    s_set_gpr_idx_idx s63
    s_nop 0
    v_bfe_u32 v73, v76, s64, 11
    s_set_gpr_idx_off
    v_sub_u32 v73, v73, v179
    v_cndmask_b32 v73, 0, v73, s[56:57]
    v_and_b32 v1, 1, v177
    v_add_u32 v1, s23, v1
    v_sub_u32 v180, v73, v1
    v_add_u32 v179, v179, v1
    v_mul_u32_u24 v181, 20608, v178
    v_lshl_add_u32 v181, v179, 4, v181
    v_cmp_lt_i32 s[40:41], 0, v180
    v_add_u32 v182, 32, v181
    s_mov_b32 s65, 0
    s_mov_b64 exec, s[40:41]
    buffer_load_dwordx4 v[0:3], v181, s[8:11], 0 offen offset:0 sc1
    s_mov_b64 exec, -1
    v_cmp_lt_i32 s[42:43], 2, v180
    v_cmp_lt_i32 s[44:45], 4, v180
    v_cmp_lt_i32 s[46:47], 6, v180
    v_cmp_lt_i32 s[48:49], 8, v180
    v_cmp_lt_i32 s[50:51], 10, v180
    v_cmp_lt_i32 s[90:91], 12, v180
    v_cmp_lt_i32 s[92:93], 14, v180
    v_cmp_lt_i32 s[94:95], 16, v180
    v_cmp_lt_i32 s[96:97], 18, v180
    v_add_u32 v183, 64, v181
    v_add_u32 v184, 96, v181
    v_subrev_u32 v62, 1, v180
    v_ashrrev_i32 v62, 1, v62
    v_med3_i32 v62, v62, 0, 9
    s_cmp_eq_u64 s[42:43], 0
    s_cbranch_scc1 K2_LD_DONE
    v_mov_b32 v63, v62
    s_nop 1
    v_add_u32_dpp v63, v63, v63 row_shr:1 row_mask:0xf bank_mask:0xf bound_ctrl:0
    s_nop 1
    v_add_u32_dpp v63, v63, v63 row_shr:2 row_mask:0xf bank_mask:0xf bound_ctrl:0
    s_nop 1
    v_add_u32_dpp v63, v63, v63 row_shr:4 row_mask:0xf bank_mask:0xf bound_ctrl:0
    s_nop 1
    v_add_u32_dpp v63, v63, v63 row_shr:8 row_mask:0xf bank_mask:0xf bound_ctrl:0
    s_nop 1
    v_add_u32_dpp v63, v63, v63 row_bcast:15 row_mask:0xa bank_mask:0xf
    s_nop 1
    v_add_u32_dpp v63, v63, v63 row_bcast:31 row_mask:0xc bank_mask:0xf
    s_lshl_b32 s58, s20, 10
    s_add_u32 s58, s58, 45056
    v_readlane_b32 s59, v63, 63
    v_sub_u32 v63, v63, v62
    v_lshl_add_u32 v64, v63, 2, s58
    v_lshlrev_b32 v63, 5, v63
    v_sub_u32 v63, v182, v63
    s_cmp_gt_u32 s59, 189
    s_cbranch_scc1 K2_LD_GEN
    s_mov_b64 exec, s[42:43]
    s_cbranch_execz K2_LD_L
    ds_write_b32 v64, v63 offset:0
    s_mov_b64 exec, s[44:45]
    s_cbranch_execz K2_LD_L
    ds_write_b32 v64, v63 offset:4
    s_mov_b64 exec, s[46:47]
    s_cbranch_execz K2_LD_L
    ds_write_b32 v64, v63 offset:8
    s_mov_b64 exec, s[48:49]
    s_cbranch_execz K2_LD_L
    ds_write_b32 v64, v63 offset:12
    s_mov_b64 exec, s[50:51]
    s_cbranch_execz K2_LD_L
    ds_write_b32 v64, v63 offset:16
    s_mov_b64 exec, s[90:91]
    s_cbranch_execz K2_LD_L
    ds_write_b32 v64, v63 offset:20
    s_mov_b64 exec, s[92:93]
    s_cbranch_execz K2_LD_L
    ds_write_b32 v64, v63 offset:24
    s_mov_b64 exec, s[94:95]
    s_cbranch_execz K2_LD_L
    ds_write_b32 v64, v63 offset:28
    s_mov_b64 exec, s[96:97]
    s_cbranch_execz K2_LD_L
    ds_write_b32 v64, v63 offset:32
K2_LD_L:
    s_mov_b64 exec, -1
    v_lshl_add_u32 v63, v176, 2, s58
    v_lshlrev_b32 v62, 5, v176
    s_waitcnt lgkmcnt(0)
    ds_read_b32 v64, v63 offset:0
    ds_read_b32 v65, v63 offset:252
    ds_read_b32 v66, v63 offset:504
    s_min_u32 s60, s59, 63
    s_sub_u32 s59, s59, s60
    s_bfm_b64 s[42:43], s60, 0
    s_min_u32 s60, s59, 63
    s_sub_u32 s59, s59, s60
    s_bfm_b64 s[44:45], s60, 0
    s_min_u32 s60, s59, 63
    s_sub_u32 s59, s59, s60
    s_bfm_b64 s[46:47], s60, 0
    s_mov_b64 s[48:49], 0
    s_mov_b32 s65, 1
    s_mov_b32 s60, 0
    s_waitcnt lgkmcnt(2)
    v_add3_u32 v182, v62, v64, s60
    s_mov_b64 exec, s[42:43]
    buffer_load_dwordx4 v[4:7], v182, s[8:11], 0 offen sc1
    s_mov_b32 s60, 2016
    s_waitcnt lgkmcnt(1)
    v_add3_u32 v183, v62, v65, s60
    s_mov_b64 exec, s[44:45]
    buffer_load_dwordx4 v[8:11], v183, s[8:11], 0 offen sc1
    s_mov_b32 s60, 4032
    s_waitcnt lgkmcnt(0)
    v_add3_u32 v184, v62, v66, s60
    s_mov_b64 exec, s[46:47]
    buffer_load_dwordx4 v[12:15], v184, s[8:11], 0 offen sc1
K2_LD_DONE:
    s_mov_b64 exec, -1
    s_cmp_eq_u32 s28, 0
    s_cbranch_scc1 K2_WLATE
K2_NOWRAW:
K2_PAD_NW:
    s_cbranch_execz KS_HOP
    v_lshrrev_b32 v179, 2, v181
    v_lshrrev_b32 v185, 2, v182
    v_lshrrev_b32 v186, 2, v183
    v_lshrrev_b32 v187, 2, v184
    s_mov_b32 s66, 7340032
    v_mov_b32 v201, 1
    s_movk_i32 s58, 520
    s_movk_i32 s59, 2080
    s_mov_b32 s60, 0x40000
    s_mov_b32 s61, 0xffff
    v_mov_b32 v202, 65536
    s_cmp_lg_u32 s24, 0
    s_cbranch_scc1 K2_RK_LOAD
    v_cmp_lt_i32 vcc, 20, v180
    s_nop 0
    s_cbranch_vccz K2_NOMORE
    v_mov_b32 v61, 163300
    ds_write_b32 v61, v201
K2_NOMORE:
    s_mov_b32 s62, 82176
    s_cmp_eq_u32 s65, 0
    s_waitcnt vmcnt(3)
    s_cbranch_scc0 K2_ARR
    s_waitcnt vmcnt(0)
K2_ARR:
    s_mov_b64 exec, s[40:41]
    s_cbranch_execz K2_RK_A
K2_CK0:
    v_bfi_b32 v192, s61, v1, v2
    v_lshrrev_b32 v50, 24, v3
    v_cmp_ne_u32 vcc, s2, v192
    v_add_u32 v40, 163072, v50
    s_cbranch_vccnz K2_RT0
    ds_add_rtn_u32 v40, v40, v201
    v_mad_u32_u24 v50, v50, s58, v202
    s_mov_b64 exec, s[42:43]
    s_cbranch_execz K2_RK_A
    s_waitcnt vmcnt(2)
K2_CK1:
    v_bfi_b32 v192, s61, v5, v6
    v_lshrrev_b32 v51, 24, v7
    v_cmp_ne_u32 vcc, s2, v192
    v_add_u32 v41, 163072, v51
    s_cbranch_vccnz K2_RT1
    ds_add_rtn_u32 v41, v41, v201
    v_mad_u32_u24 v51, v51, s58, v202
    s_mov_b64 exec, s[44:45]
    s_cbranch_execz K2_RK_A
    s_waitcnt vmcnt(1)
K2_CK2:
    v_bfi_b32 v192, s61, v9, v10
    v_lshrrev_b32 v52, 24, v11
    v_cmp_ne_u32 vcc, s2, v192
    v_add_u32 v42, 163072, v52
    s_cbranch_vccnz K2_RT2
    ds_add_rtn_u32 v42, v42, v201
    v_mad_u32_u24 v52, v52, s58, v202
    s_mov_b64 exec, s[46:47]
    s_cbranch_execz K2_RK_A
    s_waitcnt vmcnt(0)
K2_CK3:
    v_bfi_b32 v192, s61, v13, v14
    v_lshrrev_b32 v53, 24, v15
    v_cmp_ne_u32 vcc, s2, v192
    v_add_u32 v43, 163072, v53
    s_cbranch_vccnz K2_RT3
    ds_add_rtn_u32 v43, v43, v201
    v_mad_u32_u24 v53, v53, s58, v202
    s_mov_b64 exec, s[48:49]
    s_cbranch_execz K2_RK_A
K2_CK4:
    v_bfi_b32 v192, s61, v17, v18
    v_lshrrev_b32 v54, 24, v19
    v_cmp_ne_u32 vcc, s2, v192
    v_add_u32 v44, 163072, v54
    s_cbranch_vccnz K2_RT4
    ds_add_rtn_u32 v44, v44, v201
    v_mad_u32_u24 v54, v54, s58, v202
    s_mov_b64 exec, s[50:51]
    s_cbranch_execz K2_RK_A
K2_CK5:
    v_bfi_b32 v192, s61, v21, v22
    v_lshrrev_b32 v55, 24, v23
    v_cmp_ne_u32 vcc, s2, v192
    v_add_u32 v45, 163072, v55
    s_cbranch_vccnz K2_RT5
    ds_add_rtn_u32 v45, v45, v201
    v_mad_u32_u24 v55, v55, s58, v202
    s_mov_b64 exec, s[90:91]
    s_cbranch_execz K2_RK_A
K2_CK6:
    v_bfi_b32 v192, s61, v25, v26
    v_lshrrev_b32 v56, 24, v27
    v_cmp_ne_u32 vcc, s2, v192
    v_add_u32 v46, 163072, v56
    s_cbranch_vccnz K2_RT6
    ds_add_rtn_u32 v46, v46, v201
    v_mad_u32_u24 v56, v56, s58, v202
    s_mov_b64 exec, s[92:93]
    s_cbranch_execz K2_RK_A
K2_CK7:
    v_bfi_b32 v192, s61, v29, v30
    v_lshrrev_b32 v57, 24, v31
    v_cmp_ne_u32 vcc, s2, v192
    v_add_u32 v47, 163072, v57
    s_cbranch_vccnz K2_RT7
    ds_add_rtn_u32 v47, v47, v201
    v_mad_u32_u24 v57, v57, s58, v202
    s_mov_b64 exec, s[94:95]
    s_cbranch_execz K2_RK_A
K2_CK8:
    v_bfi_b32 v192, s61, v33, v34
    v_lshrrev_b32 v58, 24, v35
    v_cmp_ne_u32 vcc, s2, v192
    v_add_u32 v48, 163072, v58
    s_cbranch_vccnz K2_RT8
    ds_add_rtn_u32 v48, v48, v201
    v_mad_u32_u24 v58, v58, s58, v202
    s_mov_b64 exec, s[96:97]
    s_cbranch_execz K2_RK_A
K2_CK9:
    v_bfi_b32 v192, s61, v37, v38
    v_lshrrev_b32 v59, 24, v39
    v_cmp_ne_u32 vcc, s2, v192
    v_add_u32 v49, 163072, v59
    s_cbranch_vccnz K2_RT9
    ds_add_rtn_u32 v49, v49, v201
    v_mad_u32_u24 v59, v59, s58, v202
K2_RK_A:
    s_mov_b64 exec, -1
    s_mov_b64 exec, s[40:41]
    s_cbranch_execz K2_TP
    v_cmp_gt_u32 vcc, s62, v50
    v_and_b32 v3, 0xffffff, v3
    s_mov_b64 exec, vcc
    buffer_load_dword v245, v3, s[16:19], 0 offen
    s_mov_b64 exec, s[42:43]
    s_cbranch_execz K2_TP
    v_cmp_gt_u32 vcc, s62, v51
    v_and_b32 v7, 0xffffff, v7
    s_mov_b64 exec, vcc
    buffer_load_dword v245, v7, s[16:19], 0 offen
    s_mov_b64 exec, s[44:45]
    s_cbranch_execz K2_TP
    v_cmp_gt_u32 vcc, s62, v52
    v_and_b32 v11, 0xffffff, v11
    s_mov_b64 exec, vcc
    buffer_load_dword v245, v11, s[16:19], 0 offen
    s_mov_b64 exec, s[46:47]
    s_cbranch_execz K2_TP
    v_cmp_gt_u32 vcc, s62, v53
    v_and_b32 v15, 0xffffff, v15
    s_mov_b64 exec, vcc
    buffer_load_dword v245, v15, s[16:19], 0 offen
    s_mov_b64 exec, s[48:49]
    s_cbranch_execz K2_TP
    v_cmp_gt_u32 vcc, s62, v54
    v_and_b32 v19, 0xffffff, v19
    s_mov_b64 exec, vcc
    buffer_load_dword v245, v19, s[16:19], 0 offen
    s_mov_b64 exec, s[50:51]
    s_cbranch_execz K2_TP
    v_cmp_gt_u32 vcc, s62, v55
    v_and_b32 v23, 0xffffff, v23
    s_mov_b64 exec, vcc
    buffer_load_dword v245, v23, s[16:19], 0 offen
    s_mov_b64 exec, s[90:91]
    s_cbranch_execz K2_TP
    v_cmp_gt_u32 vcc, s62, v56
    v_and_b32 v27, 0xffffff, v27
    s_mov_b64 exec, vcc
    buffer_load_dword v245, v27, s[16:19], 0 offen
    s_mov_b64 exec, s[92:93]
    s_cbranch_execz K2_TP
    v_cmp_gt_u32 vcc, s62, v57
    v_and_b32 v31, 0xffffff, v31
    s_mov_b64 exec, vcc
    buffer_load_dword v245, v31, s[16:19], 0 offen
    s_mov_b64 exec, s[94:95]
    s_cbranch_execz K2_TP
    v_cmp_gt_u32 vcc, s62, v58
    v_and_b32 v35, 0xffffff, v35
    s_mov_b64 exec, vcc
    buffer_load_dword v245, v35, s[16:19], 0 offen
    s_mov_b64 exec, s[96:97]
    s_cbranch_execz K2_TP
    v_cmp_gt_u32 vcc, s62, v59
    v_and_b32 v39, 0xffffff, v39
    s_mov_b64 exec, vcc
    buffer_load_dword v245, v39, s[16:19], 0 offen
K2_TP:
    s_mov_b64 exec, -1
K2_RK_DONE:
K2_PAD_SC:
    s_cbranch_execz KS_HOP
    s_mul_i32 s67, s24, 48
    s_movk_i32 s58, -1532
    s_waitcnt lgkmcnt(0)
    s_mov_b64 exec, s[40:41]
    s_cbranch_execz K2_SC_DONE
    v_cmpx_gt_u32 vcc, 64, v40
    v_bfe_u32 v194, v40, 3, 1
    v_add_u32 v193, 16, v40
    v_lshl_or_b32 v194, v40, 1, v194
    v_bfi_b32 v194, 15, v194, v40
    v_lshrrev_b32 v193, 6, v193
    v_alignbit_b32 v1, v2, v1, 16
    v_lshl_add_u32 v195, v194, 3, v50
    v_lshl_add_u32 v194, v194, 5, v50
    ds_write_b64 v195, v[0:1]
    v_mad_i32_i24 v194, v193, s58, v194
    ds_write_b32 v194, v3 offset:512
    s_mov_b64 exec, s[42:43]
    s_cbranch_execz K2_SC_DONE
    v_cmpx_gt_u32 vcc, 64, v41
    v_bfe_u32 v194, v41, 3, 1
    v_add_u32 v193, 16, v41
    v_lshl_or_b32 v194, v41, 1, v194
    v_bfi_b32 v194, 15, v194, v41
    v_lshrrev_b32 v193, 6, v193
    v_alignbit_b32 v5, v6, v5, 16
    v_lshl_add_u32 v195, v194, 3, v51
    v_lshl_add_u32 v194, v194, 5, v51
    ds_write_b64 v195, v[4:5]
    v_mad_i32_i24 v194, v193, s58, v194
    ds_write_b32 v194, v7 offset:512
    s_mov_b64 exec, s[44:45]
    s_cbranch_execz K2_SC_DONE
    v_cmpx_gt_u32 vcc, 64, v42
    v_bfe_u32 v194, v42, 3, 1
    v_add_u32 v193, 16, v42
    v_lshl_or_b32 v194, v42, 1, v194
    v_bfi_b32 v194, 15, v194, v42
    v_lshrrev_b32 v193, 6, v193
    v_alignbit_b32 v9, v10, v9, 16
    v_lshl_add_u32 v195, v194, 3, v52
    v_lshl_add_u32 v194, v194, 5, v52
    ds_write_b64 v195, v[8:9]
    v_mad_i32_i24 v194, v193, s58, v194
    ds_write_b32 v194, v11 offset:512
    s_mov_b64 exec, s[46:47]
    s_cbranch_execz K2_SC_DONE
    v_cmpx_gt_u32 vcc, 64, v43
    v_bfe_u32 v194, v43, 3, 1
    v_add_u32 v193, 16, v43
    v_lshl_or_b32 v194, v43, 1, v194
    v_bfi_b32 v194, 15, v194, v43
    v_lshrrev_b32 v193, 6, v193
    v_alignbit_b32 v13, v14, v13, 16
    v_lshl_add_u32 v195, v194, 3, v53
    v_lshl_add_u32 v194, v194, 5, v53
    ds_write_b64 v195, v[12:13]
    v_mad_i32_i24 v194, v193, s58, v194
    ds_write_b32 v194, v15 offset:512
    s_mov_b64 exec, s[48:49]
    s_cbranch_execz K2_SC_DONE
    v_cmpx_gt_u32 vcc, 64, v44
    v_bfe_u32 v194, v44, 3, 1
    v_add_u32 v193, 16, v44
    v_lshl_or_b32 v194, v44, 1, v194
    v_bfi_b32 v194, 15, v194, v44
    v_lshrrev_b32 v193, 6, v193
    v_alignbit_b32 v17, v18, v17, 16
    v_lshl_add_u32 v195, v194, 3, v54
    v_lshl_add_u32 v194, v194, 5, v54
    ds_write_b64 v195, v[16:17]
    v_mad_i32_i24 v194, v193, s58, v194
    ds_write_b32 v194, v19 offset:512
    s_mov_b64 exec, s[50:51]
    s_cbranch_execz K2_SC_DONE
    v_cmpx_gt_u32 vcc, 64, v45
    v_bfe_u32 v194, v45, 3, 1
    v_add_u32 v193, 16, v45
    v_lshl_or_b32 v194, v45, 1, v194
    v_bfi_b32 v194, 15, v194, v45
    v_lshrrev_b32 v193, 6, v193
    v_alignbit_b32 v21, v22, v21, 16
    v_lshl_add_u32 v195, v194, 3, v55
    v_lshl_add_u32 v194, v194, 5, v55
    ds_write_b64 v195, v[20:21]
    v_mad_i32_i24 v194, v193, s58, v194
    ds_write_b32 v194, v23 offset:512
    s_mov_b64 exec, s[90:91]
    s_cbranch_execz K2_SC_DONE
    v_cmpx_gt_u32 vcc, 64, v46
    v_bfe_u32 v194, v46, 3, 1
    v_add_u32 v193, 16, v46
    v_lshl_or_b32 v194, v46, 1, v194
    v_bfi_b32 v194, 15, v194, v46
    v_lshrrev_b32 v193, 6, v193
    v_alignbit_b32 v25, v26, v25, 16
    v_lshl_add_u32 v195, v194, 3, v56
    v_lshl_add_u32 v194, v194, 5, v56
    ds_write_b64 v195, v[24:25]
    v_mad_i32_i24 v194, v193, s58, v194
    ds_write_b32 v194, v27 offset:512
    s_mov_b64 exec, s[92:93]
    s_cbranch_execz K2_SC_DONE
    v_cmpx_gt_u32 vcc, 64, v47
    v_bfe_u32 v194, v47, 3, 1
    v_add_u32 v193, 16, v47
    v_lshl_or_b32 v194, v47, 1, v194
    v_bfi_b32 v194, 15, v194, v47
    v_lshrrev_b32 v193, 6, v193
    v_alignbit_b32 v29, v30, v29, 16
    v_lshl_add_u32 v195, v194, 3, v57
    v_lshl_add_u32 v194, v194, 5, v57
    ds_write_b64 v195, v[28:29]
    v_mad_i32_i24 v194, v193, s58, v194
    ds_write_b32 v194, v31 offset:512
    s_mov_b64 exec, s[94:95]
    s_cbranch_execz K2_SC_DONE
    v_cmpx_gt_u32 vcc, 64, v48
    v_bfe_u32 v194, v48, 3, 1
    v_add_u32 v193, 16, v48
    v_lshl_or_b32 v194, v48, 1, v194
    v_bfi_b32 v194, 15, v194, v48
    v_lshrrev_b32 v193, 6, v193
    v_alignbit_b32 v33, v34, v33, 16
    v_lshl_add_u32 v195, v194, 3, v58
    v_lshl_add_u32 v194, v194, 5, v58
    ds_write_b64 v195, v[32:33]
    v_mad_i32_i24 v194, v193, s58, v194
    ds_write_b32 v194, v35 offset:512
    s_mov_b64 exec, s[96:97]
    s_cbranch_execz K2_SC_DONE
    v_cmpx_gt_u32 vcc, 64, v49
    v_bfe_u32 v194, v49, 3, 1
    v_add_u32 v193, 16, v49
    v_lshl_or_b32 v194, v49, 1, v194
    v_bfi_b32 v194, 15, v194, v49
    v_lshrrev_b32 v193, 6, v193
    v_alignbit_b32 v37, v38, v37, 16
    v_lshl_add_u32 v195, v194, 3, v59
    v_lshl_add_u32 v194, v194, 5, v59
    ds_write_b64 v195, v[36:37]
    v_mad_i32_i24 v194, v193, s58, v194
    ds_write_b32 v194, v39 offset:512
K2_SC_DONE:
    s_mov_b64 exec, -1
K2_PAD_SD:
    s_cbranch_execz KS_HOP
    v_lshlrev_b32 v192, 2, v176
    v_add_u32 v192, 163072, v192
    v_mov_b32 v200, 163300
    s_cmp_eq_u32 s24, 0
    s_cselect_b32 s26, 64, 48
    s_waitcnt lgkmcnt(0)
    s_barrier
    ds_read_b32 v193, v192
    ds_read_b32 v200, v200
    v_cmp_gt_u32 s[56:57], s22, v176
    v_mad_u32_u24 v195, v176, s59, v202
    s_waitcnt lgkmcnt(0)
    v_cndmask_b32 v193, 0, v193, s[56:57]
    v_readfirstlane_b32 s27, v200
    v_cmp_lt_u32 s[62:63], 48, v193
    v_cmp_lt_u32 vcc, 64, v193
    s_bcnt1_i32_b64 s60, s[62:63]
    v_mbcnt_lo_u32_b32 v198, s62, 0
    v_mbcnt_hi_u32_b32 v198, s63, v198
    s_cbranch_vccnz K2_BIG
    s_cmp_gt_u32 s60, 8
    s_cbranch_scc1 K2_BIG
K2_TOK:
    v_subrev_u32 v194, s67, v193
    v_max_i32 v194, 1, v194
    v_min_i32 v194, s26, v194
    v_add_u32 v194, 15, v194
    v_lshrrev_b32 v194, 3, v194
    v_lshl_or_b32 v195, v194, 18, v195
    v_lshl_or_b32 v195, v198, 28, v195
    v_mov_b32 v197, 949760
    v_cndmask_b32 v253, v197, v195, s[56:57]
    s_movk_i32 s40, 0
    s_movk_i32 s41, 256
    s_movk_i32 s42, 512
    s_movk_i32 s43, 768
    s_add_u32 s24, s24, 1
    s_cmp_ge_u32 s24, s25
    s_cselect_b32 s55, 1, 0
    s_cmp_eq_u32 s27, 0
    s_cselect_b32 s55, s55, 0
    s_mov_b32 s27, 0x400000
    s_mov_b32 s38, 0
    s_mov_b32 s34, 0
    s_mov_b32 s35, 0
    s_mov_b32 s36, 1
    s_mov_b32 s31, 0
    s_mov_b32 s58, s20
    v_readlane_b32 s3, v253, s58
    s_lshl_b32 s44, s34, 7
    s_and_b32 s48, s3, 0x3ffff
    s_bfe_u32 s33, s3, 0x30013
    s_mul_i32 s35, s38, 6
    s_cmp_eq_u32 s34, 0
    s_cselect_b32 s35, s35, s48
    s_mov_b32 s45, s44
    s_xor_b32 s47, s44, 256
    s_add_u32 s49, s48, 128
    s_add_u32 s60, s48, 256
    s_cmp_eq_u32 s33, 3
    s_cselect_b32 s46, s44, s47
    s_cselect_b32 s50, s60, s48
    s_cselect_b32 s51, s48, s49
    s_sub_u32 s60, s33, 2
    s_cmp_lt_u32 s60, 2
    s_cbranch_scc0 K2_rare_1
K2_back_2:
    v_add_u32 v233, s48, v230
    ds_read_b32 v232, v233
    ds_read_b32 v233, v233 offset:1024
    v_add_u32 v222, s48, v251
    ds_read2_b32 v[222:223], v222 offset0:1 offset1:3
    v_add_u32 v224, s49, v251
    ds_read2_b32 v[224:225], v224 offset0:1 offset1:3
    v_add_u32 v226, s50, v251
    ds_read2_b32 v[226:227], v226 offset0:1 offset1:3
    v_add_u32 v228, s51, v251
    ds_read2_b32 v[228:229], v228 offset0:1 offset1:3
    s_waitcnt lgkmcnt(4)
    v_or_b32 v232, v232, v231
    v_or_b32 v233, v233, v231
    s_cmp_lg_u32 s34, 0
    s_cbranch_scc1 K2_dum_4
    s_cmp_eq_u32 s33, 4
    s_cbranch_scc1 K2_a4_5
K2_b4_7:
    s_add_u32 m0, s48, 512
    s_add_u32 s65, s48, 1536
    buffer_load_dwordx4 v232, s[16:19], 0 offen  lds
    s_mov_b32 m0, s65
    s_mov_b32 exec_hi, 0
    buffer_load_dwordx4 v233, s[16:19], 0 offen  lds
    s_mov_b32 exec_hi, -1
K2_back_6:
    s_waitcnt lgkmcnt(3)
    v_mad_u32_u16 v222, v222, s39, v248 op_sel:[1,0,0,0]
    v_mad_u32_u16 v223, v223, s39, v248 op_sel:[1,0,0,0]
    s_waitcnt lgkmcnt(2)
    v_mad_u32_u16 v224, v224, s39, v248 op_sel:[1,0,0,0]
    v_mad_u32_u16 v225, v225, s39, v248 op_sel:[1,0,0,0]
    s_waitcnt lgkmcnt(1)
    v_mad_u32_u16 v226, v226, s39, v248 op_sel:[1,0,0,0]
    v_mad_u32_u16 v227, v227, s39, v248 op_sel:[1,0,0,0]
    s_waitcnt lgkmcnt(0)
    v_mad_u32_u16 v228, v228, s39, v248 op_sel:[1,0,0,0]
    v_mad_u32_u16 v229, v229, s39, v248 op_sel:[1,0,0,0]
    s_mov_b32 m0, s68
    s_nop 0
    buffer_load_dwordx4 v222, s[4:7], s44 offen sc1 lds
    buffer_load_dwordx4 v223, s[72:75], s44 offen offset:1024 sc1 lds
    s_mov_b32 m0, s69
    s_nop 0
    buffer_load_dwordx4 v224, s[4:7], s45 offen sc1 lds
    buffer_load_dwordx4 v225, s[72:75], s45 offen offset:1024 sc1 lds
    s_mov_b32 m0, s70
    s_nop 0
    buffer_load_dwordx4 v226, s[4:7], s46 offen sc1 lds
    buffer_load_dwordx4 v227, s[72:75], s46 offen offset:1024 sc1 lds
    s_mov_b32 m0, s71
    s_nop 0
    buffer_load_dwordx4 v228, s[4:7], s47 offen sc1 lds
    buffer_load_dwordx4 v229, s[72:75], s47 offen offset:1024 sc1 lds
    v_add_u32 v249, s48, v249
    v_add_u32 v250, s48, v250
    v_bfe_u32 v192, v253, 18, 4
    s_sub_u32 s58, s22, 16
    v_cmp_le_u32 vcc, 6, v192
    v_cmp_gt_u32 s[60:61], s58, v176
    s_nop 0
    s_or_b64 vcc, vcc, s[60:61]
    v_mbcnt_lo_u32_b32 v192, vcc_lo, 0
    v_mbcnt_hi_u32_b32 v192, vcc_hi, v192
    s_bcnt1_i32_b64 s58, vcc
    v_sub_u32 v193, v176, v192
    v_add_u32 v193, s58, v193
    v_cndmask_b32 v192, v193, v192, vcc
    v_lshlrev_b32 v192, 2, v192
    ds_permute_b32 v193, v192, v176
    s_waitcnt lgkmcnt(0)
    v_lshl_or_b32 v253, v193, 22, v253
    s_waitcnt vmcnt(6)
    ds_read_b64_tr_b16 v[176:177], v246 offset:0
    ds_read_b64_tr_b16 v[178:179], v246 offset:1024
    ds_read_b64_tr_b16 v[180:181], v247 offset:0
    ds_read_b64_tr_b16 v[182:183], v247 offset:1024
    ds_read_b64_tr_b16 v[0:1], v249 offset:0
    ds_read_b64_tr_b16 v[2:3], v249 offset:32
    ds_read_u16_d16_hi v16, v250 offset:0
    ds_read_b64_tr_b16 v[4:5], v249 offset:512
    ds_read_b64_tr_b16 v[6:7], v249 offset:544
    ds_read_u16_d16_hi v17, v250 offset:128
    s_mov_b32 s29, s48
    s_mov_b32 s32, s31
    s_mov_b32 s30, s3
    s_mov_b32 s31, s35
    s_bfe_u32 s56, s3, 0x40012
    s_cmp_eq_u32 s56, 5
    s_cbranch_scc1 K2_U20
    s_cmp_eq_u32 s56, 6
    s_cbranch_scc1 K2_U3h0
    s_branch K2_DSP0
K2_PAD_H1:
    s_branch KS_HOP0
KS_HELP:
    s_mov_b32 s30, 0
    s_cmp_eq_u32 s20, 6
    s_cbranch_scc1 KS_RAW
    s_mov_b32 s30, 2
    s_cmp_ge_u32 s2, 170
    s_cbranch_scc1 KS_NOW
    s_mov_b32 s30, 1
    v_and_b32 v1, 15, v8
    v_lshrrev_b32 v3, 4, v8
    s_cmp_ge_u32 s2, 160
    s_cbranch_scc1 K1_WT
    s_cmp_ge_u32 s2, 64
    s_cbranch_scc1 K1_S1
    s_lshr_b32 s24, s2, 3
    s_and_b32 s25, s2, 7
    s_lshr_b32 s26, s25, 2
    s_bfe_u32 s27, s25, 0x10001
    s_and_b32 s28, s25, 1
    s_mov_b32 s60, s92
    s_and_b32 s61, s93, 0xffff
    s_mov_b32 s62, 65536
    s_mov_b32 s63, 0x20000
    s_branch K1_SC
K1_S1:
    s_sub_u32 s29, s2, 64
    s_mul_i32 s24, s29, 43
    s_lshr_b32 s24, s24, 9
    s_mul_i32 s25, s24, 12
    s_sub_u32 s25, s29, s25
    s_cmp_ge_u32 s25, 6
    s_cselect_b32 s26, 1, 0
    s_mul_i32 s27, s26, 6
    s_sub_u32 s27, s25, s27
    s_lshr_b32 s27, s27, 1
    s_and_b32 s28, s25, 1
    s_add_u32 s25, s25, 8
    s_mov_b32 s60, s94
    s_and_b32 s61, s95, 0xffff
    s_mov_b32 s62, 98304
    s_mov_b32 s63, 0x20000
K1_SC:
    s_lshl_b32 s27, s27, 7
    s_lshl_b32 s26, s26, 6
    s_lshl_b32 s28, s28, 4
    s_add_u32 s27, s27, s26
    s_add_u32 s27, s27, s28
    s_lshl_b32 s27, s27, 8
    s_lshl_b32 s26, s24, 5
    s_add_u32 s27, s27, s26
    s_add_u32 s29, s27, 8192
    v_lshlrev_b32 v3, 10, v3
    v_lshl_add_u32 v3, v1, 1, v3
    buffer_load_ushort v64, v3, s[60:63], s27 offen offset:0
    buffer_load_ushort v65, v3, s[60:63], s29 offen offset:0
    buffer_load_ushort v66, v3, s[60:63], s27 offen offset:256
    buffer_load_ushort v67, v3, s[60:63], s29 offen offset:256
    buffer_load_ushort v68, v3, s[60:63], s27 offen offset:512
    buffer_load_ushort v69, v3, s[60:63], s29 offen offset:512
    buffer_load_ushort v70, v3, s[60:63], s27 offen offset:768
    buffer_load_ushort v71, v3, s[60:63], s29 offen offset:768
    s_mul_i32 s24, s24, 20
    s_add_u32 s24, s24, s25
    s_lshl_b32 s24, s24, 10
    s_add_u32 s24, s24, 6946816
    s_branch K1_GO
K1_WT:
    s_sub_u32 s24, s2, 160
    s_lshr_b32 s27, s24, 1
    s_and_b32 s28, s24, 1
    s_lshl_b32 s27, s27, 8
    s_lshl_b32 s28, s28, 6
    s_add_u32 s27, s27, s28
    s_add_u32 s29, s27, 10240
    s_mov_b32 s60, s90
    s_and_b32 s61, s91, 0xffff
    s_mov_b32 s62, 20480
    s_mov_b32 s63, 0x20000
    v_and_b32 v1, 31, v8
    v_lshrrev_b32 v3, 5, v8
    v_mul_u32_u24 v3, 5120, v3
    v_lshl_add_u32 v3, v1, 1, v3
    buffer_load_ushort v64, v3, s[60:63], s27 offen offset:0
    buffer_load_ushort v65, v3, s[60:63], s27 offen offset:1280
    buffer_load_ushort v66, v3, s[60:63], s27 offen offset:2560
    buffer_load_ushort v67, v3, s[60:63], s27 offen offset:3840
    buffer_load_ushort v68, v3, s[60:63], s29 offen offset:0
    buffer_load_ushort v69, v3, s[60:63], s29 offen offset:1280
    buffer_load_ushort v70, v3, s[60:63], s29 offen offset:2560
    buffer_load_ushort v71, v3, s[60:63], s29 offen offset:3840
    s_lshl_b32 s24, s24, 10
    s_add_u32 s24, s24, 7110656
K1_GO:
KS_NOW:
    s_barrier
K2_PAD_H2:
    s_cbranch_execz KS_HOP0
    v_and_b32 v76, 31, v8
    v_lshrrev_b32 v77, 5, v8
    v_mov_b32 v80, 0
    v_mul_u32_u24 v77, 2080, v77
    v_mov_b32 v81, 0xffff0000
    v_lshl_add_u32 v78, v76, 4, v77
    v_mov_b32 v82, 0
    v_add_u32 v78, 65536, v78
    v_mov_b32 v83, v81
    v_add_u32 v79, 41600, v78
    ds_write_b128 v78, v[80:83] offset:0
    ds_write_b128 v78, v[80:83] offset:4160
    ds_write_b128 v78, v[80:83] offset:8320
    ds_write_b128 v78, v[80:83] offset:12480
    ds_write_b128 v78, v[80:83] offset:16640
    ds_write_b128 v78, v[80:83] offset:20800
    ds_write_b128 v78, v[80:83] offset:24960
    ds_write_b128 v78, v[80:83] offset:29120
    ds_write_b128 v78, v[80:83] offset:33280
    ds_write_b128 v78, v[80:83] offset:37440
    ds_write_b128 v79, v[80:83] offset:0
    ds_write_b128 v79, v[80:83] offset:4160
    ds_write_b128 v79, v[80:83] offset:8320
    ds_write_b128 v79, v[80:83] offset:12480
    ds_write_b128 v79, v[80:83] offset:16640
    ds_write_b128 v79, v[80:83] offset:20800
    ds_write_b128 v79, v[80:83] offset:24960
    ds_write_b128 v79, v[80:83] offset:29120
    ds_write_b128 v79, v[80:83] offset:33280
    ds_write_b128 v79, v[80:83] offset:37440
KS_FILL:
    v_mov_b32 v59, 163456
    s_barrier
    ds_read_b32 v59, v59
    s_waitcnt vmcnt(0) lgkmcnt(0)
    s_cmp_eq_u32 s30, 0
    s_cbranch_scc1 KS_B3
    s_cmp_eq_u32 s30, 2
    s_cbranch_scc1 KS_NOST
    v_lshl_or_b32 v40, v65, 16, v64
    v_lshl_or_b32 v41, v67, 16, v66
    v_lshl_or_b32 v42, v69, 16, v68
    v_lshl_or_b32 v43, v71, 16, v70
    buffer_store_dwordx4 v[40:43], v9, s[8:11], s24 offen sc1
KS_NOST:
    v_mov_b32 v62, 163460
    s_waitcnt lgkmcnt(0)
    s_barrier
    ds_read_b32 v62, v62
    s_lshl_b32 s24, s2, 2
    s_add_u32 s24, s24, 7176192
    s_mov_b64 exec, 1
    s_waitcnt vmcnt(0)
    buffer_store_dword v59, v6, s[8:11], s24 offen sc1
    s_mov_b64 exec, -1
    s_branch KS_JOIN
K2_PAD_H3:
    s_branch KS_HOP0
KS_RAW:
    s_cmp_lg_u32 s2, 0
    s_cbranch_scc1 KS_NOX
    s_mov_b32 s60, s98
    s_and_b32 s61, s99, 0xffff
    s_mov_b32 s62, 256
    s_mov_b32 s63, 0x20000
    s_getreg_b32 s24, hwreg(HW_REG_XCC_ID, 0, 1)
    s_add_u32 s24, s24, 1
    v_mov_b32 v10, s24
    v_mov_b32 v11, 0
    s_mov_b64 exec, 1
    buffer_atomic_cmpswap v[10:11], v6, s[60:63], 0 offen sc1
    s_mov_b64 exec, -1
KS_NOX:
    s_barrier
    s_mov_b32 s60, s90
    s_and_b32 s61, s91, 0xffff
    s_mov_b32 s62, 20480
    s_mov_b32 s63, 0x20000
    v_lshrrev_b32 v10, 3, v8
    v_and_b32 v11, 7, v8
    v_lshlrev_b32 v10, 8, v10
    v_lshl_add_u32 v10, v11, 4, v10
    s_mov_b32 m0, 24576
    s_movk_i32 s24, 0
    buffer_load_dwordx4 v10, s[60:63], s24 offen lds
    s_mov_b32 m0, 25600
    s_movk_i32 s24, 2048
    buffer_load_dwordx4 v10, s[60:63], s24 offen lds
    s_mov_b32 m0, 26624
    s_movk_i32 s24, 4096
    buffer_load_dwordx4 v10, s[60:63], s24 offen lds
    s_mov_b32 m0, 27648
    s_movk_i32 s24, 6144
    buffer_load_dwordx4 v10, s[60:63], s24 offen lds
    s_mov_b32 m0, 28672
    s_movk_i32 s24, 8192
    buffer_load_dwordx4 v10, s[60:63], s24 offen lds
    s_mov_b32 m0, 29696
    s_movk_i32 s24, 10240
    buffer_load_dwordx4 v10, s[60:63], s24 offen lds
    s_mov_b32 m0, 30720
    s_movk_i32 s24, 12288
    buffer_load_dwordx4 v10, s[60:63], s24 offen lds
    s_mov_b32 m0, 31744
    s_movk_i32 s24, 14336
    buffer_load_dwordx4 v10, s[60:63], s24 offen lds
    s_mov_b32 m0, 32768
    s_movk_i32 s24, 16384
    buffer_load_dwordx4 v10, s[60:63], s24 offen lds
    s_mov_b32 m0, 33792
    s_movk_i32 s24, 18432
    buffer_load_dwordx4 v10, s[60:63], s24 offen lds
    s_mov_b32 m0, 152832
    s_movk_i32 s24, 128
    buffer_load_dwordx4 v10, s[60:63], s24 offen lds
    s_mov_b32 m0, 153856
    s_movk_i32 s24, 2176
    buffer_load_dwordx4 v10, s[60:63], s24 offen lds
    s_mov_b32 m0, 154880
    s_movk_i32 s24, 4224
    buffer_load_dwordx4 v10, s[60:63], s24 offen lds
    s_mov_b32 m0, 155904
    s_movk_i32 s24, 6272
    buffer_load_dwordx4 v10, s[60:63], s24 offen lds
    s_mov_b32 m0, 156928
    s_movk_i32 s24, 8320
    buffer_load_dwordx4 v10, s[60:63], s24 offen lds
    s_mov_b32 m0, 157952
    s_movk_i32 s24, 10368
    buffer_load_dwordx4 v10, s[60:63], s24 offen lds
    s_mov_b32 m0, 158976
    s_movk_i32 s24, 12416
    buffer_load_dwordx4 v10, s[60:63], s24 offen lds
    s_mov_b32 m0, 160000
    s_movk_i32 s24, 14464
    buffer_load_dwordx4 v10, s[60:63], s24 offen lds
    s_mov_b32 m0, 161024
    s_movk_i32 s24, 16512
    buffer_load_dwordx4 v10, s[60:63], s24 offen lds
    s_mov_b32 m0, 162048
    s_movk_i32 s24, 18560
    buffer_load_dwordx4 v10, s[60:63], s24 offen lds
    v_add_u32 v85, 16, v8
    v_lshlrev_b32 v84, 5, v8
    v_lshrrev_b32 v85, 6, v85
    v_mul_u32_u24 v85, 1532, v85
    v_sub_u32 v84, v84, v85
    v_mov_b32 v85, -1
    v_add_u32 v84, 66048, v84
    v_add_u32 v86, 41600, v84
    ds_write_b32 v84, v85 offset:0
    ds_write_b32 v84, v85 offset:2080
    ds_write_b32 v84, v85 offset:4160
    ds_write_b32 v84, v85 offset:6240
    ds_write_b32 v84, v85 offset:8320
    ds_write_b32 v84, v85 offset:10400
    ds_write_b32 v84, v85 offset:12480
    ds_write_b32 v84, v85 offset:14560
    ds_write_b32 v84, v85 offset:16640
    ds_write_b32 v84, v85 offset:18720
    ds_write_b32 v84, v85 offset:20800
    ds_write_b32 v84, v85 offset:22880
    ds_write_b32 v84, v85 offset:24960
    ds_write_b32 v84, v85 offset:27040
    ds_write_b32 v84, v85 offset:29120
    ds_write_b32 v84, v85 offset:31200
    ds_write_b32 v84, v85 offset:33280
    ds_write_b32 v84, v85 offset:35360
    ds_write_b32 v84, v85 offset:37440
    ds_write_b32 v84, v85 offset:39520
    ds_write_b32 v86, v85 offset:0
    ds_write_b32 v86, v85 offset:2080
    ds_write_b32 v86, v85 offset:4160
    ds_write_b32 v86, v85 offset:6240
    ds_write_b32 v86, v85 offset:8320
    ds_write_b32 v86, v85 offset:10400
    ds_write_b32 v86, v85 offset:12480
    ds_write_b32 v86, v85 offset:14560
    ds_write_b32 v86, v85 offset:16640
    ds_write_b32 v86, v85 offset:18720
    ds_write_b32 v86, v85 offset:20800
    ds_write_b32 v86, v85 offset:22880
    ds_write_b32 v86, v85 offset:24960
    ds_write_b32 v86, v85 offset:27040
    ds_write_b32 v86, v85 offset:29120
    ds_write_b32 v86, v85 offset:31200
    ds_write_b32 v86, v85 offset:33280
    ds_write_b32 v86, v85 offset:35360
    ds_write_b32 v86, v85 offset:37440
    ds_write_b32 v86, v85 offset:39520
    s_branch KS_FILL
KS_IDLE:
    s_barrier
    s_barrier
    s_branch KS_B3
K2_PAD_U20:
    s_branch K2_HOP
K2_U20:
    s_setprio 1
    s_waitcnt lgkmcnt(0)
    v_lshlrev_b32 v20, 16, v0
    v_and_b32 v21, 0xffff0000, v0
    v_lshlrev_b32 v22, 16, v1
    v_and_b32 v23, 0xffff0000, v1
    v_lshlrev_b32 v24, 16, v2
    v_and_b32 v25, 0xffff0000, v2
    v_lshlrev_b32 v26, 16, v3
    v_and_b32 v27, 0xffff0000, v3
    v_mul_f32_dpp v36, v16, v20 row_newbcast:8 row_mask:0xf bank_mask:0xf
    v_mul_f32_dpp v37, v16, v21 row_newbcast:9 row_mask:0xf bank_mask:0xf
    v_mul_f32_dpp v38, v16, v22 row_newbcast:10 row_mask:0xf bank_mask:0xf
    v_mul_f32_dpp v39, v16, v23 row_newbcast:11 row_mask:0xf bank_mask:0xf
    v_mul_f32_dpp v40, v16, v24 row_newbcast:12 row_mask:0xf bank_mask:0xf
    v_mul_f32_dpp v41, v16, v25 row_newbcast:13 row_mask:0xf bank_mask:0xf
    v_mul_f32_dpp v42, v16, v26 row_newbcast:14 row_mask:0xf bank_mask:0xf
    v_mul_f32_dpp v43, v16, v27 row_newbcast:15 row_mask:0xf bank_mask:0xf
    v_cvt_pk_bf16_f32 v68, v36, v37
    v_cvt_pk_bf16_f32 v69, v38, v39
    v_cvt_pk_bf16_f32 v70, v40, v41
    v_cvt_pk_bf16_f32 v71, v42, v43
    v_mul_f32_dpp v20, v16, v20 row_newbcast:0 row_mask:0xa bank_mask:0xf
    v_mul_f32_dpp v21, v16, v21 row_newbcast:1 row_mask:0xa bank_mask:0xf
    v_mul_f32_dpp v22, v16, v22 row_newbcast:2 row_mask:0xa bank_mask:0xf
    v_mul_f32_dpp v23, v16, v23 row_newbcast:3 row_mask:0xa bank_mask:0xf
    v_mul_f32_dpp v24, v16, v24 row_newbcast:4 row_mask:0xa bank_mask:0xf
    v_mul_f32_dpp v25, v16, v25 row_newbcast:5 row_mask:0xa bank_mask:0xf
    v_mul_f32_dpp v26, v16, v26 row_newbcast:6 row_mask:0xa bank_mask:0xf
    v_mul_f32_dpp v27, v16, v27 row_newbcast:7 row_mask:0xa bank_mask:0xf
    v_cvt_pk_bf16_f32 v64, v20, v21
    v_cvt_pk_bf16_f32 v65, v22, v23
    v_cvt_pk_bf16_f32 v66, v24, v25
    v_cvt_pk_bf16_f32 v67, v26, v27
    v_lshlrev_b32 v28, 16, v4
    v_and_b32 v29, 0xffff0000, v4
    v_lshlrev_b32 v30, 16, v5
    v_and_b32 v31, 0xffff0000, v5
    v_lshlrev_b32 v32, 16, v6
    v_and_b32 v33, 0xffff0000, v6
    v_lshlrev_b32 v34, 16, v7
    v_and_b32 v35, 0xffff0000, v7
    v_mul_f32_dpp v36, v17, v28 row_newbcast:8 row_mask:0xf bank_mask:0xf
    v_mul_f32_dpp v37, v17, v29 row_newbcast:9 row_mask:0xf bank_mask:0xf
    v_mul_f32_dpp v38, v17, v30 row_newbcast:10 row_mask:0xf bank_mask:0xf
    v_mul_f32_dpp v39, v17, v31 row_newbcast:11 row_mask:0xf bank_mask:0xf
    v_mul_f32_dpp v40, v17, v32 row_newbcast:12 row_mask:0xf bank_mask:0xf
    v_mul_f32_dpp v41, v17, v33 row_newbcast:13 row_mask:0xf bank_mask:0xf
    v_mul_f32_dpp v42, v17, v34 row_newbcast:14 row_mask:0xf bank_mask:0xf
    v_mul_f32_dpp v43, v17, v35 row_newbcast:15 row_mask:0xf bank_mask:0xf
    v_cvt_pk_bf16_f32 v76, v36, v37
    v_cvt_pk_bf16_f32 v77, v38, v39
    v_cvt_pk_bf16_f32 v78, v40, v41
    v_cvt_pk_bf16_f32 v79, v42, v43
    v_mul_f32_dpp v28, v17, v28 row_newbcast:0 row_mask:0xa bank_mask:0xf
    v_mul_f32_dpp v29, v17, v29 row_newbcast:1 row_mask:0xa bank_mask:0xf
    v_mul_f32_dpp v30, v17, v30 row_newbcast:2 row_mask:0xa bank_mask:0xf
    v_mul_f32_dpp v31, v17, v31 row_newbcast:3 row_mask:0xa bank_mask:0xf
    v_mul_f32_dpp v32, v17, v32 row_newbcast:4 row_mask:0xa bank_mask:0xf
    v_mul_f32_dpp v33, v17, v33 row_newbcast:5 row_mask:0xa bank_mask:0xf
    v_mul_f32_dpp v34, v17, v34 row_newbcast:6 row_mask:0xa bank_mask:0xf
    v_mul_f32_dpp v35, v17, v35 row_newbcast:7 row_mask:0xa bank_mask:0xf
    v_cvt_pk_bf16_f32 v72, v28, v29
    v_cvt_pk_bf16_f32 v73, v30, v31
    v_cvt_pk_bf16_f32 v74, v32, v33
    v_cvt_pk_bf16_f32 v75, v34, v35
    s_waitcnt vmcnt(4)
    v_mfma_f32_32x32x16_bf16 v[0:15], v[64:67], v[176:179], 0
    ds_read_b64_tr_b16 v[184:185], v246 offset:2048
    ds_read_b64_tr_b16 v[186:187], v246 offset:3072
    ds_read_b64_tr_b16 v[188:189], v247 offset:2048
    ds_read_b64_tr_b16 v[190:191], v247 offset:3072
    s_mov_b32 m0, s68
    v_mfma_f32_32x32x16_bf16 v[16:31], v[68:71], v[176:179], 0
    buffer_load_dwordx4 v222, s[4:7], s42 offen sc1 lds
    buffer_load_dwordx4 v223, s[72:75], s42 offen offset:1024 sc1 lds
    v_permlane32_swap_b32 v242, v236
    v_permlane32_swap_b32 v243, v237
    s_add_u32 s38, s38, 1
    v_mfma_f32_32x32x16_bf16 v[32:47], v[64:67], v[180:183], 0
    v_permlane32_swap_b32 v244, v238
    v_permlane32_swap_b32 v245, v239
    v_permlane32_swap_b32 v240, v241
    v_add_f32 v242, v242, v236
    v_mfma_f32_32x32x16_bf16 v[48:63], v[68:71], v[180:183], 0
    v_add_f32 v243, v243, v237
    v_add_f32 v244, v244, v238
    v_add_f32 v245, v245, v239
    v_add_f32 v240, -v240, -v241
    v_mov_b32 v254, s52
    v_mov_b32 v255, s38
    s_waitcnt vmcnt(4) lgkmcnt(0)
    v_mfma_f32_32x32x16_bf16 v[0:15], v[72:75], v[184:187], v[0:15]
    ds_read_b64_tr_b16 v[176:177], v246 offset:4096
    ds_read_b64_tr_b16 v[178:179], v246 offset:5120
    ds_read_b64_tr_b16 v[180:181], v247 offset:4096
    ds_read_b64_tr_b16 v[182:183], v247 offset:5120
    s_lshl_b32 s58, s38, 3
    s_add_u32 s58, s58, s20
    s_mov_b32 m0, s69
    v_mfma_f32_32x32x16_bf16 v[16:31], v[76:79], v[184:187], v[16:31]
    buffer_load_dwordx4 v224, s[4:7], s42 offen sc1 lds
    buffer_load_dwordx4 v225, s[72:75], s42 offen offset:1024 sc1 lds
    s_set_gpr_idx_on s32, gpr_idx(DST)
    s_nop 0
    v_cvt_pk_bf16_f32 v195, v242, v243
    v_cvt_pk_bf16_f32 v196, v244, v245
    v_cvt_pk_bf16_f32 v197, v240, v240
    s_set_gpr_idx_off
    s_mov_b64 exec, 1
    ds_write_b32 v254, v255
    s_mov_b64 exec, -1
    s_cmp_lt_u32 s58, s22
    s_cbranch_scc0 K2_dyn_8
K2_back_9:
    v_readlane_b32 s3, v253, s58
    s_lshl_b32 s44, s34, 7
    s_and_b32 s48, s3, 0x3ffff
    s_bfe_u32 s33, s3, 0x30013
    s_mul_i32 s35, s38, 6
    s_cmp_eq_u32 s34, 0
    s_cselect_b32 s35, s35, s48
    s_mov_b32 s45, s44
    s_xor_b32 s47, s44, 256
    s_add_u32 s49, s48, 128
    s_add_u32 s60, s48, 256
    s_cmp_eq_u32 s33, 3
    s_cselect_b32 s46, s44, s47
    s_cselect_b32 s50, s60, s48
    s_cselect_b32 s51, s48, s49
    s_sub_u32 s60, s33, 2
    s_cmp_lt_u32 s60, 2
    s_cbranch_scc0 K2_rare_14
K2_back_15:
    v_mfma_f32_32x32x16_bf16 v[32:47], v[72:75], v[188:191], v[32:47]
    v_add_u32 v233, s48, v230
    ds_read_b32 v232, v233
    ds_read_b32 v233, v233 offset:1024
    v_mul_f32 v234, v0, v96
    v_mul_f32 v236, v8, v128
    v_fmac_f32 v234, v1, v97
    v_fmac_f32 v236, v9, v129
    v_mfma_f32_32x32x16_bf16 v[48:63], v[76:79], v[188:191], v[48:63]
    s_setprio 0
    v_fmac_f32 v234, v2, v98
    v_fmac_f32 v236, v10, v130
    v_fmac_f32 v234, v3, v99
    v_fmac_f32 v236, v11, v131
    v_fmac_f32 v234, v4, v100
    v_fmac_f32 v236, v12, v132
    v_fmac_f32 v234, v5, v101
    v_fmac_f32 v236, v13, v133
    v_fmac_f32 v234, v6, v102
    v_fmac_f32 v236, v14, v134
    v_fmac_f32 v234, v7, v103
    v_fmac_f32 v236, v15, v135
    v_mul_f32 v238, v16, v128
    v_mul_f32 v240, v24, v128
    v_fmac_f32 v238, v17, v129
    v_fmac_f32 v240, v25, v129
    v_fmac_f32 v238, v18, v130
    v_fmac_f32 v240, v26, v130
    v_fmac_f32 v238, v19, v131
    v_fmac_f32 v240, v27, v131
    v_fmac_f32 v238, v20, v132
    v_fmac_f32 v240, v28, v132
    v_fmac_f32 v238, v21, v133
    v_fmac_f32 v240, v29, v133
    v_fmac_f32 v238, v22, v134
    v_fmac_f32 v240, v30, v134
    v_fmac_f32 v238, v23, v135
    v_fmac_f32 v240, v31, v135
    v_mul_f32 v235, v32, v104
    v_mul_f32 v237, v40, v136
    v_fmac_f32 v235, v33, v105
    v_fmac_f32 v237, v41, v137
    v_fmac_f32 v235, v34, v106
    v_fmac_f32 v237, v42, v138
    v_fmac_f32 v235, v35, v107
    v_fmac_f32 v237, v43, v139
    v_fmac_f32 v235, v36, v108
    v_fmac_f32 v237, v44, v140
    v_fmac_f32 v235, v37, v109
    v_fmac_f32 v237, v45, v141
    v_fmac_f32 v235, v38, v110
    v_fmac_f32 v237, v46, v142
    v_fmac_f32 v235, v39, v111
    v_fmac_f32 v237, v47, v143
    v_mul_f32 v239, v48, v136
    v_mul_f32 v241, v56, v136
    v_fmac_f32 v239, v49, v137
    v_fmac_f32 v241, v57, v137
    s_setprio 1
    s_waitcnt vmcnt(4) lgkmcnt(3)
    v_mfma_f32_32x32x16_bf16 v[0:15], v[64:67], v[176:179], 0
    ds_read_b64_tr_b16 v[184:185], v246 offset:6144
    ds_read_b64_tr_b16 v[186:187], v246 offset:7168
    ds_read_b64_tr_b16 v[188:189], v247 offset:6144
    ds_read_b64_tr_b16 v[190:191], v247 offset:7168
    v_fmac_f32 v239, v50, v138
    v_fmac_f32 v241, v58, v138
    s_mov_b32 m0, s70
    v_mfma_f32_32x32x16_bf16 v[16:31], v[68:71], v[176:179], 0
    buffer_load_dwordx4 v222, s[4:7], s43 offen sc1 lds
    buffer_load_dwordx4 v223, s[72:75], s43 offen offset:1024 sc1 lds
    v_fmac_f32 v239, v51, v139
    v_fmac_f32 v241, v59, v139
    v_fmac_f32 v239, v52, v140
    v_fmac_f32 v241, v60, v140
    v_fmac_f32 v239, v53, v141
    v_mfma_f32_32x32x16_bf16 v[32:47], v[64:67], v[180:183], 0
    v_add_u32 v222, s48, v251
    ds_read2_b32 v[222:223], v222 offset0:1 offset1:3
    v_fmac_f32 v241, v61, v141
    v_fmac_f32 v239, v54, v142
    v_fmac_f32 v241, v62, v142
    v_fmac_f32 v239, v55, v143
    v_fmac_f32 v241, v63, v143
    v_mfma_f32_32x32x16_bf16 v[48:63], v[68:71], v[180:183], 0
    v_permlane32_swap_b32 v234, v236
    v_permlane32_swap_b32 v235, v237
    v_permlane32_swap_b32 v240, v238
    s_waitcnt lgkmcnt(5)
    v_or_b32 v232, v232, v231
    v_or_b32 v233, v233, v231
    s_cmp_lg_u32 s34, 0
    s_cbranch_scc1 K2_dum_17
    s_cmp_eq_u32 s33, 4
    s_cbranch_scc1 K2_a4_18
K2_b4_20:
    s_add_u32 m0, s48, 512
    s_add_u32 s65, s48, 1536
    buffer_load_dwordx4 v232, s[16:19], 0 offen  lds
    s_mov_b32 m0, s65
    s_mov_b32 exec_hi, 0
    buffer_load_dwordx4 v233, s[16:19], 0 offen  lds
    s_mov_b32 exec_hi, -1
K2_back_19:
    s_waitcnt vmcnt(6) lgkmcnt(1)
    v_mfma_f32_32x32x16_bf16 v[0:15], v[72:75], v[184:187], v[0:15]
    ds_read_b64_tr_b16 v[176:177], v246 offset:0
    ds_read_b64_tr_b16 v[178:179], v246 offset:1024
    ds_read_b64_tr_b16 v[180:181], v247 offset:0
    ds_read_b64_tr_b16 v[182:183], v247 offset:1024
    v_permlane32_swap_b32 v241, v239
    s_mov_b32 m0, s71
    v_mfma_f32_32x32x16_bf16 v[16:31], v[76:79], v[184:187], v[16:31]
    buffer_load_dwordx4 v224, s[4:7], s43 offen sc1 lds
    buffer_load_dwordx4 v225, s[72:75], s43 offen offset:1024 sc1 lds
    s_waitcnt lgkmcnt(4)
    v_mad_u32_u16 v222, v222, s39, v248 op_sel:[1,0,0,0]
    v_mad_u32_u16 v223, v223, s39, v248 op_sel:[1,0,0,0]
    v_add_f32 v234, v234, v236
    v_add_f32 v235, v235, v237
    v_add_f32 v240, v240, v238
    v_add_f32 v241, v241, v239
    s_set_gpr_idx_on s31, gpr_idx(DST)
    s_nop 0
    v_cvt_pk_bf16_f32 v192, v234, v235
    v_cvt_pk_bf16_f32 v193, v240, v241
    s_set_gpr_idx_off
    v_mfma_f32_32x32x16_bf16 v[32:47], v[72:75], v[188:191], v[32:47]
    v_add_u32 v224, s49, v251
    ds_read2_b32 v[224:225], v224 offset0:1 offset1:3
    v_mul_f32 v234, v0, v144
    v_mul_f32 v236, v8, v112
    v_fmac_f32 v234, v1, v145
    v_fmac_f32 v236, v9, v113
    v_fmac_f32 v234, v2, v146
    v_mfma_f32_32x32x16_bf16 v[48:63], v[76:79], v[188:191], v[48:63]
    s_setprio 0
    v_fmac_f32 v236, v10, v114
    v_fmac_f32 v234, v3, v147
    v_fmac_f32 v236, v11, v115
    v_fmac_f32 v234, v4, v148
    v_fmac_f32 v236, v12, v116
    v_fmac_f32 v234, v5, v149
    v_fmac_f32 v236, v13, v117
    v_fmac_f32 v234, v6, v150
    v_fmac_f32 v236, v14, v118
    v_fmac_f32 v234, v7, v151
    v_fmac_f32 v236, v15, v119
    v_mul_f32 v238, v16, v160
    v_mul_f32 v240, v24, v160
    v_fmac_f32 v238, v17, v161
    v_fmac_f32 v240, v25, v161
    v_fmac_f32 v238, v18, v162
    v_fmac_f32 v240, v26, v162
    v_fmac_f32 v238, v19, v163
    v_fmac_f32 v240, v27, v163
    v_fmac_f32 v238, v20, v164
    v_fmac_f32 v240, v28, v164
    v_fmac_f32 v238, v21, v165
    v_fmac_f32 v240, v29, v165
    v_fmac_f32 v238, v22, v166
    v_fmac_f32 v240, v30, v166
    v_fmac_f32 v238, v23, v167
    v_fmac_f32 v240, v31, v167
    v_mul_f32 v235, v32, v152
    v_mul_f32 v237, v40, v120
    v_fmac_f32 v235, v33, v153
    v_fmac_f32 v237, v41, v121
    v_fmac_f32 v235, v34, v154
    v_fmac_f32 v237, v42, v122
    v_fmac_f32 v235, v35, v155
    v_fmac_f32 v237, v43, v123
    v_fmac_f32 v235, v36, v156
    v_fmac_f32 v237, v44, v124
    v_fmac_f32 v235, v37, v157
    v_fmac_f32 v237, v45, v125
    v_fmac_f32 v235, v38, v158
    v_fmac_f32 v237, v46, v126
    v_fmac_f32 v235, v39, v159
    v_fmac_f32 v237, v47, v127
    v_mul_f32 v239, v48, v168
    v_mul_f32 v241, v56, v168
    v_fmac_f32 v239, v49, v169
    v_fmac_f32 v241, v57, v169
    v_fmac_f32 v239, v50, v170
    v_fmac_f32 v241, v58, v170
    v_fmac_f32 v239, v51, v171
    s_setprio 1
    s_waitcnt vmcnt(6) lgkmcnt(1)
    v_mfma_f32_32x32x16_bf16 v[0:15], v[64:67], v[176:179], 0
    ds_read_b64_tr_b16 v[184:185], v246 offset:2048
    ds_read_b64_tr_b16 v[186:187], v246 offset:3072
    ds_read_b64_tr_b16 v[188:189], v247 offset:2048
    ds_read_b64_tr_b16 v[190:191], v247 offset:3072
    v_fmac_f32 v241, v59, v171
    v_fmac_f32 v239, v52, v172
    s_mov_b32 m0, s68
    v_mfma_f32_32x32x16_bf16 v[16:31], v[68:71], v[176:179], 0
    buffer_load_dwordx4 v222, s[4:7], s44 offen sc1 lds
    buffer_load_dwordx4 v223, s[72:75], s44 offen offset:1024 sc1 lds
    s_waitcnt lgkmcnt(4)
    v_mad_u32_u16 v224, v224, s39, v248 op_sel:[1,0,0,0]
    v_mad_u32_u16 v225, v225, s39, v248 op_sel:[1,0,0,0]
    v_fmac_f32 v241, v60, v172
    v_fmac_f32 v239, v53, v173
    v_mfma_f32_32x32x16_bf16 v[32:47], v[64:67], v[180:183], 0
    v_add_u32 v226, s50, v251
    ds_read2_b32 v[226:227], v226 offset0:1 offset1:3
    v_fmac_f32 v241, v61, v173
    v_fmac_f32 v239, v54, v174
    v_fmac_f32 v241, v62, v174
    v_fmac_f32 v239, v55, v175
    v_fmac_f32 v241, v63, v175
    v_mfma_f32_32x32x16_bf16 v[48:63], v[68:71], v[180:183], 0
    s_waitcnt vmcnt(6) lgkmcnt(1)
    v_mfma_f32_32x32x16_bf16 v[0:15], v[72:75], v[184:187], v[0:15]
    ds_read_b64_tr_b16 v[176:177], v246 offset:4096
    ds_read_b64_tr_b16 v[178:179], v246 offset:5120
    ds_read_b64_tr_b16 v[180:181], v247 offset:4096
    ds_read_b64_tr_b16 v[182:183], v247 offset:5120
    s_mov_b32 m0, s69
    v_mfma_f32_32x32x16_bf16 v[16:31], v[76:79], v[184:187], v[16:31]
    buffer_load_dwordx4 v224, s[4:7], s45 offen sc1 lds
    buffer_load_dwordx4 v225, s[72:75], s45 offen offset:1024 sc1 lds
    s_waitcnt lgkmcnt(4)
    v_mad_u32_u16 v226, v226, s39, v248 op_sel:[1,0,0,0]
    v_mad_u32_u16 v227, v227, s39, v248 op_sel:[1,0,0,0]
    v_mfma_f32_32x32x16_bf16 v[32:47], v[72:75], v[188:191], v[32:47]
    v_add_u32 v228, s51, v251
    ds_read2_b32 v[228:229], v228 offset0:1 offset1:3
    v_mul_f32 v242, v0, v144
    v_fma_f32 v238, v8, v160, -v238
    v_fmac_f32 v242, v1, v145
    v_fmac_f32 v238, v9, v161
    v_fmac_f32 v242, v2, v146
    v_mfma_f32_32x32x16_bf16 v[48:63], v[76:79], v[188:191], v[48:63]
    s_setprio 0
    v_fmac_f32 v238, v10, v162
    v_fmac_f32 v242, v3, v147
    v_fmac_f32 v238, v11, v163
    v_fmac_f32 v242, v4, v148
    v_fmac_f32 v238, v12, v164
    v_fmac_f32 v242, v5, v149
    v_fmac_f32 v238, v13, v165
    v_fmac_f32 v242, v6, v150
    v_fmac_f32 v238, v14, v166
    v_fmac_f32 v242, v7, v151
    v_fmac_f32 v238, v15, v167
    v_fmac_f32 v236, v16, v112
    v_mul_f32 v244, v24, v160
    v_fmac_f32 v236, v17, v113
    v_fmac_f32 v244, v25, v161
    v_fmac_f32 v236, v18, v114
    v_fmac_f32 v244, v26, v162
    v_fmac_f32 v236, v19, v115
    v_fmac_f32 v244, v27, v163
    v_fmac_f32 v236, v20, v116
    v_fmac_f32 v244, v28, v164
    v_fmac_f32 v236, v21, v117
    v_fmac_f32 v244, v29, v165
    v_fmac_f32 v236, v22, v118
    v_fmac_f32 v244, v30, v166
    v_fmac_f32 v236, v23, v119
    v_fmac_f32 v244, v31, v167
    v_mul_f32 v243, v32, v152
    v_fma_f32 v239, v40, v168, -v239
    v_fmac_f32 v243, v33, v153
    v_fmac_f32 v239, v41, v169
    v_fmac_f32 v243, v34, v154
    v_fmac_f32 v239, v42, v170
    v_fmac_f32 v243, v35, v155
    v_fmac_f32 v239, v43, v171
    v_fmac_f32 v243, v36, v156
    v_fmac_f32 v239, v44, v172
    v_fmac_f32 v243, v37, v157
    v_fmac_f32 v239, v45, v173
    v_fmac_f32 v243, v38, v158
    v_fmac_f32 v239, v46, v174
    v_fmac_f32 v243, v39, v159
    v_fmac_f32 v239, v47, v175
    v_fmac_f32 v237, v48, v120
    v_mul_f32 v245, v56, v168
    v_fmac_f32 v237, v49, v121
    v_fmac_f32 v245, v57, v169
    v_fmac_f32 v237, v50, v122
    s_setprio 1
    s_waitcnt vmcnt(4) lgkmcnt(1)
    v_mfma_f32_32x32x16_bf16 v[0:15], v[64:67], v[176:179], 0
    ds_read_b64_tr_b16 v[184:185], v246 offset:6144
    ds_read_b64_tr_b16 v[186:187], v246 offset:7168
    ds_read_b64_tr_b16 v[188:189], v247 offset:6144
    ds_read_b64_tr_b16 v[190:191], v247 offset:7168
    v_fmac_f32 v245, v58, v170
    v_fmac_f32 v237, v51, v123
    s_mov_b32 m0, s70
    v_mfma_f32_32x32x16_bf16 v[16:31], v[68:71], v[176:179], 0
    buffer_load_dwordx4 v226, s[4:7], s46 offen sc1 lds
    buffer_load_dwordx4 v227, s[72:75], s46 offen offset:1024 sc1 lds
    s_waitcnt lgkmcnt(4)
    v_mad_u32_u16 v228, v228, s39, v248 op_sel:[1,0,0,0]
    v_mad_u32_u16 v229, v229, s39, v248 op_sel:[1,0,0,0]
    v_fmac_f32 v245, v59, v171
    v_fmac_f32 v237, v52, v124
    v_mfma_f32_32x32x16_bf16 v[32:47], v[64:67], v[180:183], 0
    v_fmac_f32 v245, v60, v172
    v_fmac_f32 v237, v53, v125
    v_fmac_f32 v245, v61, v173
    v_fmac_f32 v237, v54, v126
    v_fmac_f32 v245, v62, v174
    v_fmac_f32 v237, v55, v127
    v_fmac_f32 v245, v63, v175
    v_mfma_f32_32x32x16_bf16 v[48:63], v[68:71], v[180:183], 0
    v_permlane32_swap_b32 v242, v234
    v_permlane32_swap_b32 v243, v235
    v_add_f32 v242, v242, v234
    v_add_f32 v243, v243, v235
    s_waitcnt vmcnt(4) lgkmcnt(0)
    v_mfma_f32_32x32x16_bf16 v[0:15], v[72:75], v[184:187], v[0:15]
    ds_read_b64_tr_b16 v[176:177], v246 offset:0
    ds_read_b64_tr_b16 v[178:179], v246 offset:1024
    ds_read_b64_tr_b16 v[180:181], v247 offset:0
    ds_read_b64_tr_b16 v[182:183], v247 offset:1024
    s_sub_u32 s26, s48, s29
    s_mov_b32 s29, s48
    s_mov_b32 m0, s71
    v_mfma_f32_32x32x16_bf16 v[16:31], v[76:79], v[184:187], v[16:31]
    buffer_load_dwordx4 v228, s[4:7], s47 offen sc1 lds
    buffer_load_dwordx4 v229, s[72:75], s47 offen offset:1024 sc1 lds
    s_set_gpr_idx_on s31, gpr_idx(DST)
    s_nop 0
    v_cvt_pk_bf16_f32 v194, v242, v243
    s_set_gpr_idx_off
    s_mov_b32 s30, s3
    s_bfe_u32 s56, s3, 0x40012
    s_cmp_eq_u32 s34, 0
    s_cselect_b32 s56, s56, 0
    v_mfma_f32_32x32x16_bf16 v[32:47], v[72:75], v[188:191], v[32:47]
    s_mov_b32 s32, s31
    s_mov_b32 s31, s35
    v_mul_f32 v242, v0, v144
    v_fma_f32 v240, v8, v160, -v240
    v_fmac_f32 v242, v1, v145
    v_fmac_f32 v240, v9, v161
    v_fmac_f32 v242, v2, v146
    v_mfma_f32_32x32x16_bf16 v[48:63], v[76:79], v[188:191], v[48:63]
    s_setprio 0
    v_fmac_f32 v240, v10, v162
    v_fmac_f32 v242, v3, v147
    v_fmac_f32 v240, v11, v163
    v_fmac_f32 v242, v4, v148
    v_fmac_f32 v240, v12, v164
    v_fmac_f32 v242, v5, v149
    v_fmac_f32 v240, v13, v165
    v_fmac_f32 v242, v6, v150
    v_fmac_f32 v240, v14, v166
    v_fmac_f32 v242, v7, v151
    v_fmac_f32 v240, v15, v167
    v_add_u32 v249, s26, v249
    v_add_u32 v250, s26, v250
    v_fma_f32 v244, v16, v160, -v244
    v_fmac_f32 v236, v24, v112
    v_fmac_f32 v244, v17, v161
    v_fmac_f32 v236, v25, v113
    v_fmac_f32 v244, v18, v162
    v_fmac_f32 v236, v26, v114
    v_fmac_f32 v244, v19, v163
    v_fmac_f32 v236, v27, v115
    v_fmac_f32 v244, v20, v164
    v_fmac_f32 v236, v28, v116
    v_fmac_f32 v244, v21, v165
    v_fmac_f32 v236, v29, v117
    v_fmac_f32 v244, v22, v166
    v_fmac_f32 v236, v30, v118
    v_fmac_f32 v244, v23, v167
    v_fmac_f32 v236, v31, v119
    ds_read_b64_tr_b16 v[0:1], v249 offset:0
    ds_read_b64_tr_b16 v[2:3], v249 offset:32
    ds_read_u16_d16_hi v16, v250 offset:0
    v_mul_f32 v243, v32, v152
    v_fma_f32 v241, v40, v168, -v241
    v_fmac_f32 v243, v33, v153
    v_fmac_f32 v241, v41, v169
    v_fmac_f32 v243, v34, v154
    v_fmac_f32 v241, v42, v170
    v_fmac_f32 v243, v35, v155
    v_fmac_f32 v241, v43, v171
    v_fmac_f32 v243, v36, v156
    v_fmac_f32 v241, v44, v172
    v_fmac_f32 v243, v37, v157
    v_fmac_f32 v241, v45, v173
    v_fmac_f32 v243, v38, v158
    v_fmac_f32 v241, v46, v174
    v_fmac_f32 v243, v39, v159
    v_fmac_f32 v241, v47, v175
    ds_read_b64_tr_b16 v[4:5], v249 offset:512
    ds_read_b64_tr_b16 v[6:7], v249 offset:544
    ds_read_u16_d16_hi v17, v250 offset:128
    v_fma_f32 v245, v48, v168, -v245
    v_fmac_f32 v237, v56, v120
    v_fmac_f32 v245, v49, v169
    v_fmac_f32 v237, v57, v121
    v_fmac_f32 v245, v50, v170
    v_fmac_f32 v237, v58, v122
    v_fmac_f32 v245, v51, v171
    v_fmac_f32 v237, v59, v123
    v_fmac_f32 v245, v52, v172
    v_fmac_f32 v237, v60, v124
    v_fmac_f32 v245, v53, v173
    v_fmac_f32 v237, v61, v125
    v_fmac_f32 v245, v54, v174
    v_fmac_f32 v237, v62, v126
    v_fmac_f32 v245, v55, v175
    v_fmac_f32 v237, v63, v127
    s_cmp_eq_u32 s56, 5
    s_cbranch_scc1 K2_U20
    s_cmp_eq_u32 s56, 6
    s_cbranch_scc1 K2_U3h0
    s_branch K2_DSP0
K2_PAD_U30:
    s_branch K2_HOP
K2_U3h0:
    s_setprio 1
    ds_read_b64_tr_b16 v[8:9], v249 offset:1024
    ds_read_u16_d16_hi v18, v250 offset:256
    s_waitcnt lgkmcnt(2)
    v_lshlrev_b32 v20, 16, v0
    v_and_b32 v21, 0xffff0000, v0
    v_lshlrev_b32 v22, 16, v1
    v_and_b32 v23, 0xffff0000, v1
    v_lshlrev_b32 v24, 16, v2
    v_and_b32 v25, 0xffff0000, v2
    v_lshlrev_b32 v26, 16, v3
    v_and_b32 v27, 0xffff0000, v3
    v_mul_f32_dpp v36, v16, v20 row_newbcast:8 row_mask:0xf bank_mask:0xf
    v_mul_f32_dpp v37, v16, v21 row_newbcast:9 row_mask:0xf bank_mask:0xf
    v_mul_f32_dpp v38, v16, v22 row_newbcast:10 row_mask:0xf bank_mask:0xf
    v_mul_f32_dpp v39, v16, v23 row_newbcast:11 row_mask:0xf bank_mask:0xf
    v_mul_f32_dpp v40, v16, v24 row_newbcast:12 row_mask:0xf bank_mask:0xf
    v_mul_f32_dpp v41, v16, v25 row_newbcast:13 row_mask:0xf bank_mask:0xf
    v_mul_f32_dpp v42, v16, v26 row_newbcast:14 row_mask:0xf bank_mask:0xf
    v_mul_f32_dpp v43, v16, v27 row_newbcast:15 row_mask:0xf bank_mask:0xf
    v_cvt_pk_bf16_f32 v68, v36, v37
    v_cvt_pk_bf16_f32 v69, v38, v39
    v_cvt_pk_bf16_f32 v70, v40, v41
    v_cvt_pk_bf16_f32 v71, v42, v43
    v_mul_f32_dpp v20, v16, v20 row_newbcast:0 row_mask:0xa bank_mask:0xf
    v_mul_f32_dpp v21, v16, v21 row_newbcast:1 row_mask:0xa bank_mask:0xf
    v_mul_f32_dpp v22, v16, v22 row_newbcast:2 row_mask:0xa bank_mask:0xf
    v_mul_f32_dpp v23, v16, v23 row_newbcast:3 row_mask:0xa bank_mask:0xf
    v_mul_f32_dpp v24, v16, v24 row_newbcast:4 row_mask:0xa bank_mask:0xf
    v_mul_f32_dpp v25, v16, v25 row_newbcast:5 row_mask:0xa bank_mask:0xf
    v_mul_f32_dpp v26, v16, v26 row_newbcast:6 row_mask:0xa bank_mask:0xf
    v_mul_f32_dpp v27, v16, v27 row_newbcast:7 row_mask:0xa bank_mask:0xf
    v_cvt_pk_bf16_f32 v64, v20, v21
    v_cvt_pk_bf16_f32 v65, v22, v23
    v_cvt_pk_bf16_f32 v66, v24, v25
    v_cvt_pk_bf16_f32 v67, v26, v27
    v_lshlrev_b32 v28, 16, v4
    v_and_b32 v29, 0xffff0000, v4
    v_lshlrev_b32 v30, 16, v5
    v_and_b32 v31, 0xffff0000, v5
    v_lshlrev_b32 v32, 16, v6
    v_and_b32 v33, 0xffff0000, v6
    v_lshlrev_b32 v34, 16, v7
    v_and_b32 v35, 0xffff0000, v7
    v_mul_f32_dpp v36, v17, v28 row_newbcast:8 row_mask:0xf bank_mask:0xf
    v_mul_f32_dpp v37, v17, v29 row_newbcast:9 row_mask:0xf bank_mask:0xf
    v_mul_f32_dpp v38, v17, v30 row_newbcast:10 row_mask:0xf bank_mask:0xf
    v_mul_f32_dpp v39, v17, v31 row_newbcast:11 row_mask:0xf bank_mask:0xf
    v_mul_f32_dpp v40, v17, v32 row_newbcast:12 row_mask:0xf bank_mask:0xf
    v_mul_f32_dpp v41, v17, v33 row_newbcast:13 row_mask:0xf bank_mask:0xf
    v_mul_f32_dpp v42, v17, v34 row_newbcast:14 row_mask:0xf bank_mask:0xf
    v_mul_f32_dpp v43, v17, v35 row_newbcast:15 row_mask:0xf bank_mask:0xf
    v_cvt_pk_bf16_f32 v76, v36, v37
    v_cvt_pk_bf16_f32 v77, v38, v39
    v_cvt_pk_bf16_f32 v78, v40, v41
    v_cvt_pk_bf16_f32 v79, v42, v43
    v_mul_f32_dpp v28, v17, v28 row_newbcast:0 row_mask:0xa bank_mask:0xf
    v_mul_f32_dpp v29, v17, v29 row_newbcast:1 row_mask:0xa bank_mask:0xf
    v_mul_f32_dpp v30, v17, v30 row_newbcast:2 row_mask:0xa bank_mask:0xf
    v_mul_f32_dpp v31, v17, v31 row_newbcast:3 row_mask:0xa bank_mask:0xf
    v_mul_f32_dpp v32, v17, v32 row_newbcast:4 row_mask:0xa bank_mask:0xf
    v_mul_f32_dpp v33, v17, v33 row_newbcast:5 row_mask:0xa bank_mask:0xf
    v_mul_f32_dpp v34, v17, v34 row_newbcast:6 row_mask:0xa bank_mask:0xf
    v_mul_f32_dpp v35, v17, v35 row_newbcast:7 row_mask:0xa bank_mask:0xf
    v_cvt_pk_bf16_f32 v72, v28, v29
    v_cvt_pk_bf16_f32 v73, v30, v31
    v_cvt_pk_bf16_f32 v74, v32, v33
    v_cvt_pk_bf16_f32 v75, v34, v35
    s_waitcnt lgkmcnt(0)
    v_lshlrev_b32 v20, 16, v8
    v_and_b32 v21, 0xffff0000, v8
    v_lshlrev_b32 v22, 16, v9
    v_and_b32 v23, 0xffff0000, v9
    v_mul_f32_dpp v36, v18, v20 row_newbcast:8 row_mask:0xf bank_mask:0xf
    v_mul_f32_dpp v37, v18, v21 row_newbcast:9 row_mask:0xf bank_mask:0xf
    v_mul_f32_dpp v38, v18, v22 row_newbcast:10 row_mask:0xf bank_mask:0xf
    v_mul_f32_dpp v39, v18, v23 row_newbcast:11 row_mask:0xf bank_mask:0xf
    v_cvt_pk_bf16_f32 v84, v36, v37
    v_cvt_pk_bf16_f32 v85, v38, v39
    v_mul_f32_dpp v20, v18, v20 row_newbcast:0 row_mask:0xa bank_mask:0xf
    v_mul_f32_dpp v21, v18, v21 row_newbcast:1 row_mask:0xa bank_mask:0xf
    v_mul_f32_dpp v22, v18, v22 row_newbcast:2 row_mask:0xa bank_mask:0xf
    v_mul_f32_dpp v23, v18, v23 row_newbcast:3 row_mask:0xa bank_mask:0xf
    v_cvt_pk_bf16_f32 v80, v20, v21
    v_cvt_pk_bf16_f32 v81, v22, v23
    s_waitcnt vmcnt(4)
    v_mfma_f32_32x32x16_bf16 v[0:15], v[64:67], v[176:179], 0
    ds_read_b64_tr_b16 v[184:185], v246 offset:2048
    ds_read_b64_tr_b16 v[186:187], v246 offset:3072
    ds_read_b64_tr_b16 v[188:189], v247 offset:2048
    ds_read_b64_tr_b16 v[190:191], v247 offset:3072
    s_mov_b32 m0, s68
    v_mfma_f32_32x32x16_bf16 v[16:31], v[68:71], v[176:179], 0
    buffer_load_dwordx4 v224, s[4:7], s41 offen sc1 lds
    buffer_load_dwordx4 v225, s[72:75], s41 offen offset:1024 sc1 lds
    v_permlane32_swap_b32 v242, v236
    v_permlane32_swap_b32 v243, v237
    s_add_u32 s38, s38, 1
    v_mfma_f32_32x32x16_bf16 v[32:47], v[64:67], v[180:183], 0
    v_permlane32_swap_b32 v244, v238
    v_permlane32_swap_b32 v245, v239
    v_permlane32_swap_b32 v240, v241
    v_add_f32 v242, v242, v236
    v_mfma_f32_32x32x16_bf16 v[48:63], v[68:71], v[180:183], 0
    v_add_f32 v243, v243, v237
    v_add_f32 v244, v244, v238
    v_add_f32 v245, v245, v239
    v_add_f32 v240, -v240, -v241
    v_mov_b32 v254, s52
    v_mov_b32 v255, s38
    s_waitcnt vmcnt(4) lgkmcnt(0)
    v_mfma_f32_32x32x16_bf16 v[0:15], v[72:75], v[184:187], v[0:15]
    ds_read_b64_tr_b16 v[176:177], v246 offset:4096
    ds_read_b64_tr_b16 v[180:181], v247 offset:4096
    s_lshl_b32 s58, s38, 3
    s_add_u32 s58, s58, s20
    s_mov_b32 m0, s69
    v_mfma_f32_32x32x16_bf16 v[16:31], v[76:79], v[184:187], v[16:31]
    buffer_load_dwordx4 v226, s[4:7], s41 offen sc1 lds
    s_set_gpr_idx_on s32, gpr_idx(DST)
    s_nop 0
    v_cvt_pk_bf16_f32 v195, v242, v243
    v_cvt_pk_bf16_f32 v196, v244, v245
    v_cvt_pk_bf16_f32 v197, v240, v240
    s_set_gpr_idx_off
    s_mov_b64 exec, 1
    ds_write_b32 v254, v255
    s_mov_b64 exec, -1
    s_cmp_lt_u32 s58, s22
    s_cbranch_scc0 K2_dyn_21
K2_back_22:
    v_readlane_b32 s3, v253, s58
    s_lshl_b32 s44, s34, 7
    s_and_b32 s48, s3, 0x3ffff
    s_bfe_u32 s33, s3, 0x30013
    s_mul_i32 s35, s38, 6
    s_cmp_eq_u32 s34, 0
    s_cselect_b32 s35, s35, s48
    s_mov_b32 s45, s44
    s_xor_b32 s47, s44, 256
    s_add_u32 s49, s48, 128
    s_add_u32 s60, s48, 256
    s_cmp_eq_u32 s33, 3
    s_cselect_b32 s46, s44, s47
    s_cselect_b32 s50, s60, s48
    s_cselect_b32 s51, s48, s49
    s_sub_u32 s60, s33, 2
    s_cmp_lt_u32 s60, 2
    s_cbranch_scc0 K2_rare_27
K2_back_28:
    v_mfma_f32_32x32x16_bf16 v[32:47], v[72:75], v[188:191], v[32:47]
    v_add_u32 v233, s48, v230
    ds_read_b32 v232, v233
    ds_read_b32 v233, v233 offset:1024
    v_mfma_f32_32x32x16_bf16 v[48:63], v[76:79], v[188:191], v[48:63]
    s_waitcnt vmcnt(3) lgkmcnt(3)
    v_mfma_f32_32x32x8_bf16 v[0:15], v[80:81], v[176:177], v[0:15]
    ds_read_b64_tr_b16 v[184:185], v246 offset:6144
    ds_read_b64_tr_b16 v[186:187], v246 offset:7168
    ds_read_b64_tr_b16 v[188:189], v247 offset:6144
    ds_read_b64_tr_b16 v[190:191], v247 offset:7168
    s_mov_b32 m0, s70
    v_mfma_f32_32x32x8_bf16 v[16:31], v[84:85], v[176:177], v[16:31]
    buffer_load_dwordx4 v222, s[4:7], s42 offen sc1 lds
    buffer_load_dwordx4 v223, s[72:75], s42 offen offset:1024 sc1 lds
    v_mfma_f32_32x32x8_bf16 v[32:47], v[80:81], v[180:181], v[32:47]
    s_nop 2
    v_mul_f32 v234, v0, v96
    v_mul_f32 v236, v8, v128
    v_fmac_f32 v234, v1, v97
    v_fmac_f32 v236, v9, v129
    v_fmac_f32 v234, v2, v98
    v_fmac_f32 v236, v10, v130
    v_fmac_f32 v234, v3, v99
    v_mfma_f32_32x32x8_bf16 v[48:63], v[84:85], v[180:181], v[48:63]
    s_setprio 0
    s_waitcnt lgkmcnt(4)
    v_or_b32 v232, v232, v231
    v_or_b32 v233, v233, v231
    s_cmp_lg_u32 s34, 0
    s_cbranch_scc1 K2_dum_30
    s_cmp_eq_u32 s33, 4
    s_cbranch_scc1 K2_a4_31
K2_b4_33:
    s_add_u32 m0, s48, 512
    s_add_u32 s65, s48, 1536
    buffer_load_dwordx4 v232, s[16:19], 0 offen  lds
    s_mov_b32 m0, s65
    s_mov_b32 exec_hi, 0
    buffer_load_dwordx4 v233, s[16:19], 0 offen  lds
    s_mov_b32 exec_hi, -1
K2_back_32:
    v_fmac_f32 v236, v11, v131
    v_fmac_f32 v234, v4, v100
    v_fmac_f32 v236, v12, v132
    v_fmac_f32 v234, v5, v101
    v_fmac_f32 v236, v13, v133
    v_fmac_f32 v234, v6, v102
    v_fmac_f32 v236, v14, v134
    v_fmac_f32 v234, v7, v103
    v_fmac_f32 v236, v15, v135
    v_mul_f32 v238, v16, v128
    v_mul_f32 v240, v24, v128
    v_fmac_f32 v238, v17, v129
    v_fmac_f32 v240, v25, v129
    v_fmac_f32 v238, v18, v130
    v_fmac_f32 v240, v26, v130
    v_fmac_f32 v238, v19, v131
    v_fmac_f32 v240, v27, v131
    v_fmac_f32 v238, v20, v132
    v_fmac_f32 v240, v28, v132
    v_fmac_f32 v238, v21, v133
    v_fmac_f32 v240, v29, v133
    v_fmac_f32 v238, v22, v134
    v_fmac_f32 v240, v30, v134
    v_fmac_f32 v238, v23, v135
    v_fmac_f32 v240, v31, v135
    v_mul_f32 v235, v32, v104
    v_mul_f32 v237, v40, v136
    v_fmac_f32 v235, v33, v105
    v_fmac_f32 v237, v41, v137
    v_fmac_f32 v235, v34, v106
    v_fmac_f32 v237, v42, v138
    v_fmac_f32 v235, v35, v107
    v_fmac_f32 v237, v43, v139
    v_fmac_f32 v235, v36, v108
    v_fmac_f32 v237, v44, v140
    v_fmac_f32 v235, v37, v109
    v_fmac_f32 v237, v45, v141
    v_fmac_f32 v235, v38, v110
    v_fmac_f32 v237, v46, v142
    v_fmac_f32 v235, v39, v111
    v_fmac_f32 v237, v47, v143
    v_mul_f32 v239, v48, v136
    v_mul_f32 v241, v56, v136
    s_setprio 1
    s_waitcnt vmcnt(5) lgkmcnt(0)
    v_mfma_f32_32x32x16_bf16 v[0:15], v[64:67], v[184:187], 0
    ds_read_b64_tr_b16 v[176:177], v246 offset:0
    ds_read_b64_tr_b16 v[178:179], v246 offset:1024
    ds_read_b64_tr_b16 v[180:181], v247 offset:0
    ds_read_b64_tr_b16 v[182:183], v247 offset:1024
    v_fmac_f32 v239, v49, v137
    v_fmac_f32 v241, v57, v137
    s_mov_b32 m0, s71
    v_mfma_f32_32x32x16_bf16 v[16:31], v[68:71], v[184:187], 0
    buffer_load_dwordx4 v224, s[4:7], s42 offen sc1 lds
    buffer_load_dwordx4 v225, s[72:75], s42 offen offset:1024 sc1 lds
    v_fmac_f32 v239, v50, v138
    v_fmac_f32 v241, v58, v138
    v_fmac_f32 v239, v51, v139
    v_fmac_f32 v241, v59, v139
    v_fmac_f32 v239, v52, v140
    v_mfma_f32_32x32x16_bf16 v[32:47], v[64:67], v[188:191], 0
    v_fmac_f32 v241, v60, v140
    v_fmac_f32 v239, v53, v141
    v_fmac_f32 v241, v61, v141
    v_fmac_f32 v239, v54, v142
    v_fmac_f32 v241, v62, v142
    v_fmac_f32 v239, v55, v143
    v_fmac_f32 v241, v63, v143
    v_mfma_f32_32x32x16_bf16 v[48:63], v[68:71], v[188:191], 0
    v_permlane32_swap_b32 v234, v236
    v_permlane32_swap_b32 v235, v237
    v_permlane32_swap_b32 v240, v238
    s_waitcnt vmcnt(6) lgkmcnt(0)
    v_mfma_f32_32x32x16_bf16 v[0:15], v[72:75], v[176:179], v[0:15]
    ds_read_b64_tr_b16 v[184:185], v246 offset:2048
    ds_read_b64_tr_b16 v[188:189], v247 offset:2048
    v_permlane32_swap_b32 v241, v239
    v_add_f32 v234, v234, v236
    v_add_f32 v235, v235, v237
    s_mov_b32 m0, s68
    v_mfma_f32_32x32x16_bf16 v[16:31], v[76:79], v[176:179], v[16:31]
    buffer_load_dwordx4 v226, s[4:7], s42 offen sc1 lds
    v_add_f32 v240, v240, v238
    v_add_f32 v241, v241, v239
    s_set_gpr_idx_on s31, gpr_idx(DST)
    s_nop 0
    v_cvt_pk_bf16_f32 v192, v234, v235
    v_cvt_pk_bf16_f32 v193, v240, v241
    s_set_gpr_idx_off
    v_mfma_f32_32x32x16_bf16 v[32:47], v[72:75], v[180:183], v[32:47]
    v_mfma_f32_32x32x16_bf16 v[48:63], v[76:79], v[180:183], v[48:63]
    s_waitcnt vmcnt(5) lgkmcnt(0)
    v_mfma_f32_32x32x8_bf16 v[0:15], v[80:81], v[184:185], v[0:15]
    ds_read_b64_tr_b16 v[176:177], v246 offset:4096
    ds_read_b64_tr_b16 v[178:179], v246 offset:5120
    ds_read_b64_tr_b16 v[180:181], v247 offset:4096
    ds_read_b64_tr_b16 v[182:183], v247 offset:5120
    s_mov_b32 m0, s69
    v_mfma_f32_32x32x8_bf16 v[16:31], v[84:85], v[184:185], v[16:31]
    buffer_load_dwordx4 v222, s[4:7], s43 offen sc1 lds
    buffer_load_dwordx4 v223, s[72:75], s43 offen offset:1024 sc1 lds
    v_mfma_f32_32x32x8_bf16 v[32:47], v[80:81], v[188:189], v[32:47]
    s_nop 2
    v_mul_f32 v234, v0, v144
    v_mul_f32 v236, v8, v112
    v_fmac_f32 v234, v1, v145
    v_fmac_f32 v236, v9, v113
    v_fmac_f32 v234, v2, v146
    v_fmac_f32 v236, v10, v114
    v_fmac_f32 v234, v3, v147
    v_mfma_f32_32x32x8_bf16 v[48:63], v[84:85], v[188:189], v[48:63]
    s_setprio 0
    v_fmac_f32 v236, v11, v115
    v_fmac_f32 v234, v4, v148
    v_fmac_f32 v236, v12, v116
    v_fmac_f32 v234, v5, v149
    v_fmac_f32 v236, v13, v117
    v_fmac_f32 v234, v6, v150
    v_fmac_f32 v236, v14, v118
    v_fmac_f32 v234, v7, v151
    v_fmac_f32 v236, v15, v119
    v_mul_f32 v238, v16, v160
    v_mul_f32 v240, v24, v160
    v_fmac_f32 v238, v17, v161
    v_fmac_f32 v240, v25, v161
    v_fmac_f32 v238, v18, v162
    v_fmac_f32 v240, v26, v162
    v_fmac_f32 v238, v19, v163
    v_fmac_f32 v240, v27, v163
    v_fmac_f32 v238, v20, v164
    v_fmac_f32 v240, v28, v164
    v_fmac_f32 v238, v21, v165
    v_fmac_f32 v240, v29, v165
    v_fmac_f32 v238, v22, v166
    v_fmac_f32 v240, v30, v166
    v_fmac_f32 v238, v23, v167
    v_fmac_f32 v240, v31, v167
    v_mul_f32 v235, v32, v152
    v_mul_f32 v237, v40, v120
    v_fmac_f32 v235, v33, v153
    v_fmac_f32 v237, v41, v121
    v_fmac_f32 v235, v34, v154
    v_fmac_f32 v237, v42, v122
    v_fmac_f32 v235, v35, v155
    v_fmac_f32 v237, v43, v123
    v_fmac_f32 v235, v36, v156
    v_fmac_f32 v237, v44, v124
    v_fmac_f32 v235, v37, v157
    v_fmac_f32 v237, v45, v125
    v_fmac_f32 v235, v38, v158
    v_fmac_f32 v237, v46, v126
    v_fmac_f32 v235, v39, v159
    v_fmac_f32 v237, v47, v127
    v_mul_f32 v239, v48, v168
    v_mul_f32 v241, v56, v168
    v_fmac_f32 v239, v49, v169
    v_fmac_f32 v241, v57, v169
    s_setprio 1
    s_waitcnt vmcnt(3) lgkmcnt(0)
    v_mfma_f32_32x32x16_bf16 v[0:15], v[64:67], v[176:179], 0
    ds_read_b64_tr_b16 v[184:185], v246 offset:6144
    ds_read_b64_tr_b16 v[186:187], v246 offset:7168
    ds_read_b64_tr_b16 v[188:189], v247 offset:6144
    ds_read_b64_tr_b16 v[190:191], v247 offset:7168
    v_fmac_f32 v239, v50, v170
    v_fmac_f32 v241, v58, v170
    s_mov_b32 m0, s70
    v_mfma_f32_32x32x16_bf16 v[16:31], v[68:71], v[176:179], 0
    buffer_load_dwordx4 v224, s[4:7], s43 offen sc1 lds
    buffer_load_dwordx4 v225, s[72:75], s43 offen offset:1024 sc1 lds
    v_fmac_f32 v239, v51, v171
    v_fmac_f32 v241, v59, v171
    v_fmac_f32 v239, v52, v172
    v_fmac_f32 v241, v60, v172
    v_fmac_f32 v239, v53, v173
    v_mfma_f32_32x32x16_bf16 v[32:47], v[64:67], v[180:183], 0
    v_add_u32 v222, s48, v251
    ds_read2_b32 v[222:223], v222 offset0:1 offset1:3
    v_fmac_f32 v241, v61, v173
    v_fmac_f32 v239, v54, v174
    v_fmac_f32 v241, v62, v174
    v_fmac_f32 v239, v55, v175
    v_fmac_f32 v241, v63, v175
    v_mfma_f32_32x32x16_bf16 v[48:63], v[68:71], v[180:183], 0
    s_waitcnt vmcnt(4) lgkmcnt(1)
    v_mfma_f32_32x32x16_bf16 v[0:15], v[72:75], v[184:187], v[0:15]
    ds_read_b64_tr_b16 v[176:177], v246 offset:0
    ds_read_b64_tr_b16 v[180:181], v247 offset:0
    s_mov_b32 m0, s71
    v_mfma_f32_32x32x16_bf16 v[16:31], v[76:79], v[184:187], v[16:31]
    buffer_load_dwordx4 v226, s[4:7], s43 offen sc1 lds
    s_waitcnt lgkmcnt(2)
    v_mad_u32_u16 v222, v222, s39, v248 op_sel:[1,0,0,0]
    v_mad_u32_u16 v223, v223, s39, v248 op_sel:[1,0,0,0]
    v_mfma_f32_32x32x16_bf16 v[32:47], v[72:75], v[188:191], v[32:47]
    v_add_u32 v224, s49, v251
    ds_read2_b32 v[224:225], v224 offset0:1 offset1:3
    v_mfma_f32_32x32x16_bf16 v[48:63], v[76:79], v[188:191], v[48:63]
    s_waitcnt vmcnt(3) lgkmcnt(1)
    v_mfma_f32_32x32x8_bf16 v[0:15], v[80:81], v[176:177], v[0:15]
    ds_read_b64_tr_b16 v[184:185], v246 offset:2048
    ds_read_b64_tr_b16 v[186:187], v246 offset:3072
    ds_read_b64_tr_b16 v[188:189], v247 offset:2048
    ds_read_b64_tr_b16 v[190:191], v247 offset:3072
    s_mov_b32 m0, s68
    v_mfma_f32_32x32x8_bf16 v[16:31], v[84:85], v[176:177], v[16:31]
    buffer_load_dwordx4 v222, s[4:7], s44 offen sc1 lds
    buffer_load_dwordx4 v223, s[72:75], s44 offen offset:1024 sc1 lds
    s_waitcnt lgkmcnt(4)
    v_mad_u32_u16 v224, v224, s39, v248 op_sel:[1,0,0,0]
    v_mad_u32_u16 v225, v225, s39, v248 op_sel:[1,0,0,0]
    v_mfma_f32_32x32x8_bf16 v[32:47], v[80:81], v[180:181], v[32:47]
    v_add_u32 v226, s50, v251
    ds_read2_b32 v[226:227], v226 offset0:1 offset1:3
    v_mul_f32 v242, v0, v144
    v_fma_f32 v238, v8, v160, -v238
    v_fmac_f32 v242, v1, v145
    v_fmac_f32 v238, v9, v161
    v_fmac_f32 v242, v2, v146
    v_mfma_f32_32x32x8_bf16 v[48:63], v[84:85], v[180:181], v[48:63]
    s_setprio 0
    v_fmac_f32 v238, v10, v162
    v_fmac_f32 v242, v3, v147
    v_fmac_f32 v238, v11, v163
    v_fmac_f32 v242, v4, v148
    v_fmac_f32 v238, v12, v164
    v_fmac_f32 v242, v5, v149
    v_fmac_f32 v238, v13, v165
    v_fmac_f32 v242, v6, v150
    v_fmac_f32 v238, v14, v166
    v_fmac_f32 v242, v7, v151
    v_fmac_f32 v238, v15, v167
    v_fmac_f32 v236, v16, v112
    v_mul_f32 v244, v24, v160
    v_fmac_f32 v236, v17, v113
    v_fmac_f32 v244, v25, v161
    v_fmac_f32 v236, v18, v114
    v_fmac_f32 v244, v26, v162
    v_fmac_f32 v236, v19, v115
    v_fmac_f32 v244, v27, v163
    v_fmac_f32 v236, v20, v116
    v_fmac_f32 v244, v28, v164
    v_fmac_f32 v236, v21, v117
    v_fmac_f32 v244, v29, v165
    v_fmac_f32 v236, v22, v118
    v_fmac_f32 v244, v30, v166
    v_fmac_f32 v236, v23, v119
    v_fmac_f32 v244, v31, v167
    v_mul_f32 v243, v32, v152
    v_fma_f32 v239, v40, v168, -v239
    v_fmac_f32 v243, v33, v153
    v_fmac_f32 v239, v41, v169
    v_fmac_f32 v243, v34, v154
    v_fmac_f32 v239, v42, v170
    v_fmac_f32 v243, v35, v155
    v_fmac_f32 v239, v43, v171
    v_fmac_f32 v243, v36, v156
    v_fmac_f32 v239, v44, v172
    v_fmac_f32 v243, v37, v157
    v_fmac_f32 v239, v45, v173
    v_fmac_f32 v243, v38, v158
    v_fmac_f32 v239, v46, v174
    v_fmac_f32 v243, v39, v159
    v_fmac_f32 v239, v47, v175
    v_fmac_f32 v237, v48, v120
    v_mul_f32 v245, v56, v168
    v_fmac_f32 v237, v49, v121
    v_fmac_f32 v245, v57, v169
    v_fmac_f32 v237, v50, v122
    v_fmac_f32 v245, v58, v170
    v_fmac_f32 v237, v51, v123
    s_setprio 1
    s_waitcnt vmcnt(3) lgkmcnt(1)
    v_mfma_f32_32x32x16_bf16 v[0:15], v[64:67], v[184:187], 0
    ds_read_b64_tr_b16 v[176:177], v246 offset:4096
    ds_read_b64_tr_b16 v[178:179], v246 offset:5120
    ds_read_b64_tr_b16 v[180:181], v247 offset:4096
    ds_read_b64_tr_b16 v[182:183], v247 offset:5120
    v_fmac_f32 v245, v59, v171
    v_fmac_f32 v237, v52, v124
    s_mov_b32 m0, s69
    v_mfma_f32_32x32x16_bf16 v[16:31], v[68:71], v[184:187], 0
    buffer_load_dwordx4 v224, s[4:7], s45 offen sc1 lds
    buffer_load_dwordx4 v225, s[72:75], s45 offen offset:1024 sc1 lds
    s_waitcnt lgkmcnt(4)
    v_mad_u32_u16 v226, v226, s39, v248 op_sel:[1,0,0,0]
    v_mad_u32_u16 v227, v227, s39, v248 op_sel:[1,0,0,0]
    v_fmac_f32 v245, v60, v172
    v_fmac_f32 v237, v53, v125
    v_mfma_f32_32x32x16_bf16 v[32:47], v[64:67], v[188:191], 0
    v_add_u32 v228, s51, v251
    ds_read2_b32 v[228:229], v228 offset0:1 offset1:3
    v_fmac_f32 v245, v61, v173
    v_fmac_f32 v237, v54, v126
    v_fmac_f32 v245, v62, v174
    v_fmac_f32 v237, v55, v127
    v_fmac_f32 v245, v63, v175
    v_mfma_f32_32x32x16_bf16 v[48:63], v[68:71], v[188:191], 0
    v_permlane32_swap_b32 v242, v234
    v_permlane32_swap_b32 v243, v235
    v_add_f32 v242, v242, v234
    v_add_f32 v243, v243, v235
    s_waitcnt vmcnt(4) lgkmcnt(1)
    v_mfma_f32_32x32x16_bf16 v[0:15], v[72:75], v[176:179], v[0:15]
    ds_read_b64_tr_b16 v[184:185], v246 offset:6144
    ds_read_b64_tr_b16 v[188:189], v247 offset:6144
    s_set_gpr_idx_on s31, gpr_idx(DST)
    s_nop 0
    v_cvt_pk_bf16_f32 v194, v242, v243
    s_set_gpr_idx_off
    s_mov_b32 s32, s31
    s_mov_b32 m0, s70
    v_mfma_f32_32x32x16_bf16 v[16:31], v[76:79], v[176:179], v[16:31]
    buffer_load_dwordx4 v226, s[4:7], s46 offen sc1 lds
    buffer_load_dwordx4 v227, s[72:75], s46 offen offset:1024 sc1 lds
    s_waitcnt lgkmcnt(2)
    v_mad_u32_u16 v228, v228, s39, v248 op_sel:[1,0,0,0]
    v_mad_u32_u16 v229, v229, s39, v248 op_sel:[1,0,0,0]
    s_sub_u32 s26, s48, s29
    s_mov_b32 s29, s48
    v_mfma_f32_32x32x16_bf16 v[32:47], v[72:75], v[180:183], v[32:47]
    s_mov_b32 s30, s3
    s_bfe_u32 s56, s3, 0x40012
    s_cmp_eq_u32 s34, 0
    s_cselect_b32 s56, s56, 0
    s_mov_b32 s31, s35
    v_mfma_f32_32x32x16_bf16 v[48:63], v[76:79], v[180:183], v[48:63]
    s_waitcnt vmcnt(4) lgkmcnt(0)
    v_mfma_f32_32x32x8_bf16 v[0:15], v[80:81], v[184:185], v[0:15]
    ds_read_b64_tr_b16 v[176:177], v246 offset:0
    ds_read_b64_tr_b16 v[178:179], v246 offset:1024
    ds_read_b64_tr_b16 v[180:181], v247 offset:0
    ds_read_b64_tr_b16 v[182:183], v247 offset:1024
    s_mov_b32 m0, s71
    v_mfma_f32_32x32x8_bf16 v[16:31], v[84:85], v[184:185], v[16:31]
    buffer_load_dwordx4 v228, s[4:7], s47 offen sc1 lds
    buffer_load_dwordx4 v229, s[72:75], s47 offen offset:1024 sc1 lds
    v_mfma_f32_32x32x8_bf16 v[32:47], v[80:81], v[188:189], v[32:47]
    s_nop 2
    v_mul_f32 v242, v0, v144
    v_fma_f32 v240, v8, v160, -v240
    v_fmac_f32 v242, v1, v145
    v_fmac_f32 v240, v9, v161
    v_fmac_f32 v242, v2, v146
    v_fmac_f32 v240, v10, v162
    v_fmac_f32 v242, v3, v147
    v_mfma_f32_32x32x8_bf16 v[48:63], v[84:85], v[188:189], v[48:63]
    s_setprio 0
    v_fmac_f32 v240, v11, v163
    v_fmac_f32 v242, v4, v148
    v_fmac_f32 v240, v12, v164
    v_fmac_f32 v242, v5, v149
    v_fmac_f32 v240, v13, v165
    v_fmac_f32 v242, v6, v150
    v_fmac_f32 v240, v14, v166
    v_fmac_f32 v242, v7, v151
    v_fmac_f32 v240, v15, v167
    v_add_u32 v249, s26, v249
    v_add_u32 v250, s26, v250
    v_fma_f32 v244, v16, v160, -v244
    v_fmac_f32 v236, v24, v112
    v_fmac_f32 v244, v17, v161
    v_fmac_f32 v236, v25, v113
    v_fmac_f32 v244, v18, v162
    v_fmac_f32 v236, v26, v114
    v_fmac_f32 v244, v19, v163
    v_fmac_f32 v236, v27, v115
    v_fmac_f32 v244, v20, v164
    v_fmac_f32 v236, v28, v116
    v_fmac_f32 v244, v21, v165
    v_fmac_f32 v236, v29, v117
    v_fmac_f32 v244, v22, v166
    v_fmac_f32 v236, v30, v118
    v_fmac_f32 v244, v23, v167
    v_fmac_f32 v236, v31, v119
    ds_read_b64_tr_b16 v[0:1], v249 offset:0
    ds_read_b64_tr_b16 v[2:3], v249 offset:32
    ds_read_u16_d16_hi v16, v250 offset:0
    v_mul_f32 v243, v32, v152
    v_fma_f32 v241, v40, v168, -v241
    v_fmac_f32 v243, v33, v153
    v_fmac_f32 v241, v41, v169
    v_fmac_f32 v243, v34, v154
    v_fmac_f32 v241, v42, v170
    v_fmac_f32 v243, v35, v155
    v_fmac_f32 v241, v43, v171
    v_fmac_f32 v243, v36, v156
    v_fmac_f32 v241, v44, v172
    v_fmac_f32 v243, v37, v157
    v_fmac_f32 v241, v45, v173
    v_fmac_f32 v243, v38, v158
    v_fmac_f32 v241, v46, v174
    v_fmac_f32 v243, v39, v159
    v_fmac_f32 v241, v47, v175
    ds_read_b64_tr_b16 v[4:5], v249 offset:512
    ds_read_b64_tr_b16 v[6:7], v249 offset:544
    ds_read_u16_d16_hi v17, v250 offset:128
    v_fma_f32 v245, v48, v168, -v245
    v_fmac_f32 v237, v56, v120
    v_fmac_f32 v245, v49, v169
    v_fmac_f32 v237, v57, v121
    v_fmac_f32 v245, v50, v170
    v_fmac_f32 v237, v58, v122
    v_fmac_f32 v245, v51, v171
    v_fmac_f32 v237, v59, v123
    v_fmac_f32 v245, v52, v172
    v_fmac_f32 v237, v60, v124
    v_fmac_f32 v245, v53, v173
    v_fmac_f32 v237, v61, v125
    v_fmac_f32 v245, v54, v174
    v_fmac_f32 v237, v62, v126
    v_fmac_f32 v245, v55, v175
    v_fmac_f32 v237, v63, v127
    s_cmp_eq_u32 s56, 5
    s_cbranch_scc1 K2_U20
    s_cmp_eq_u32 s56, 6
    s_cbranch_scc1 K2_U3h0
    s_branch K2_DSP0
K2_U30:
    s_setprio 1
    ds_read_b64_tr_b16 v[8:9], v249 offset:1024
    ds_read_b64_tr_b16 v[10:11], v249 offset:1056
    ds_read_u16_d16_hi v18, v250 offset:256
    s_waitcnt lgkmcnt(3)
    v_lshlrev_b32 v20, 16, v0
    v_and_b32 v21, 0xffff0000, v0
    v_lshlrev_b32 v22, 16, v1
    v_and_b32 v23, 0xffff0000, v1
    v_lshlrev_b32 v24, 16, v2
    v_and_b32 v25, 0xffff0000, v2
    v_lshlrev_b32 v26, 16, v3
    v_and_b32 v27, 0xffff0000, v3
    v_mul_f32_dpp v36, v16, v20 row_newbcast:8 row_mask:0xf bank_mask:0xf
    v_mul_f32_dpp v37, v16, v21 row_newbcast:9 row_mask:0xf bank_mask:0xf
    v_mul_f32_dpp v38, v16, v22 row_newbcast:10 row_mask:0xf bank_mask:0xf
    v_mul_f32_dpp v39, v16, v23 row_newbcast:11 row_mask:0xf bank_mask:0xf
    v_mul_f32_dpp v40, v16, v24 row_newbcast:12 row_mask:0xf bank_mask:0xf
    v_mul_f32_dpp v41, v16, v25 row_newbcast:13 row_mask:0xf bank_mask:0xf
    v_mul_f32_dpp v42, v16, v26 row_newbcast:14 row_mask:0xf bank_mask:0xf
    v_mul_f32_dpp v43, v16, v27 row_newbcast:15 row_mask:0xf bank_mask:0xf
    v_cvt_pk_bf16_f32 v68, v36, v37
    v_cvt_pk_bf16_f32 v69, v38, v39
    v_cvt_pk_bf16_f32 v70, v40, v41
    v_cvt_pk_bf16_f32 v71, v42, v43
    v_mul_f32_dpp v20, v16, v20 row_newbcast:0 row_mask:0xa bank_mask:0xf
    v_mul_f32_dpp v21, v16, v21 row_newbcast:1 row_mask:0xa bank_mask:0xf
    v_mul_f32_dpp v22, v16, v22 row_newbcast:2 row_mask:0xa bank_mask:0xf
    v_mul_f32_dpp v23, v16, v23 row_newbcast:3 row_mask:0xa bank_mask:0xf
    v_mul_f32_dpp v24, v16, v24 row_newbcast:4 row_mask:0xa bank_mask:0xf
    v_mul_f32_dpp v25, v16, v25 row_newbcast:5 row_mask:0xa bank_mask:0xf
    v_mul_f32_dpp v26, v16, v26 row_newbcast:6 row_mask:0xa bank_mask:0xf
    v_mul_f32_dpp v27, v16, v27 row_newbcast:7 row_mask:0xa bank_mask:0xf
    v_cvt_pk_bf16_f32 v64, v20, v21
    v_cvt_pk_bf16_f32 v65, v22, v23
    v_cvt_pk_bf16_f32 v66, v24, v25
    v_cvt_pk_bf16_f32 v67, v26, v27
    v_lshlrev_b32 v28, 16, v4
    v_and_b32 v29, 0xffff0000, v4
    v_lshlrev_b32 v30, 16, v5
    v_and_b32 v31, 0xffff0000, v5
    v_lshlrev_b32 v32, 16, v6
    v_and_b32 v33, 0xffff0000, v6
    v_lshlrev_b32 v34, 16, v7
    v_and_b32 v35, 0xffff0000, v7
    v_mul_f32_dpp v36, v17, v28 row_newbcast:8 row_mask:0xf bank_mask:0xf
    v_mul_f32_dpp v37, v17, v29 row_newbcast:9 row_mask:0xf bank_mask:0xf
    v_mul_f32_dpp v38, v17, v30 row_newbcast:10 row_mask:0xf bank_mask:0xf
    v_mul_f32_dpp v39, v17, v31 row_newbcast:11 row_mask:0xf bank_mask:0xf
    v_mul_f32_dpp v40, v17, v32 row_newbcast:12 row_mask:0xf bank_mask:0xf
    v_mul_f32_dpp v41, v17, v33 row_newbcast:13 row_mask:0xf bank_mask:0xf
    v_mul_f32_dpp v42, v17, v34 row_newbcast:14 row_mask:0xf bank_mask:0xf
    v_mul_f32_dpp v43, v17, v35 row_newbcast:15 row_mask:0xf bank_mask:0xf
    v_cvt_pk_bf16_f32 v76, v36, v37
    v_cvt_pk_bf16_f32 v77, v38, v39
    v_cvt_pk_bf16_f32 v78, v40, v41
    v_cvt_pk_bf16_f32 v79, v42, v43
    v_mul_f32_dpp v28, v17, v28 row_newbcast:0 row_mask:0xa bank_mask:0xf
    v_mul_f32_dpp v29, v17, v29 row_newbcast:1 row_mask:0xa bank_mask:0xf
    v_mul_f32_dpp v30, v17, v30 row_newbcast:2 row_mask:0xa bank_mask:0xf
    v_mul_f32_dpp v31, v17, v31 row_newbcast:3 row_mask:0xa bank_mask:0xf
    v_mul_f32_dpp v32, v17, v32 row_newbcast:4 row_mask:0xa bank_mask:0xf
    v_mul_f32_dpp v33, v17, v33 row_newbcast:5 row_mask:0xa bank_mask:0xf
    v_mul_f32_dpp v34, v17, v34 row_newbcast:6 row_mask:0xa bank_mask:0xf
    v_mul_f32_dpp v35, v17, v35 row_newbcast:7 row_mask:0xa bank_mask:0xf
    v_cvt_pk_bf16_f32 v72, v28, v29
    v_cvt_pk_bf16_f32 v73, v30, v31
    v_cvt_pk_bf16_f32 v74, v32, v33
    v_cvt_pk_bf16_f32 v75, v34, v35
    s_waitcnt lgkmcnt(0)
    v_lshlrev_b32 v20, 16, v8
    v_and_b32 v21, 0xffff0000, v8
    v_lshlrev_b32 v22, 16, v9
    v_and_b32 v23, 0xffff0000, v9
    v_lshlrev_b32 v24, 16, v10
    v_and_b32 v25, 0xffff0000, v10
    v_lshlrev_b32 v26, 16, v11
    v_and_b32 v27, 0xffff0000, v11
    v_mul_f32_dpp v36, v18, v20 row_newbcast:8 row_mask:0xf bank_mask:0xf
    v_mul_f32_dpp v37, v18, v21 row_newbcast:9 row_mask:0xf bank_mask:0xf
    v_mul_f32_dpp v38, v18, v22 row_newbcast:10 row_mask:0xf bank_mask:0xf
    v_mul_f32_dpp v39, v18, v23 row_newbcast:11 row_mask:0xf bank_mask:0xf
    v_mul_f32_dpp v40, v18, v24 row_newbcast:12 row_mask:0xf bank_mask:0xf
    v_mul_f32_dpp v41, v18, v25 row_newbcast:13 row_mask:0xf bank_mask:0xf
    v_mul_f32_dpp v42, v18, v26 row_newbcast:14 row_mask:0xf bank_mask:0xf
    v_mul_f32_dpp v43, v18, v27 row_newbcast:15 row_mask:0xf bank_mask:0xf
    v_cvt_pk_bf16_f32 v84, v36, v37
    v_cvt_pk_bf16_f32 v85, v38, v39
    v_cvt_pk_bf16_f32 v86, v40, v41
    v_cvt_pk_bf16_f32 v87, v42, v43
    v_mul_f32_dpp v20, v18, v20 row_newbcast:0 row_mask:0xa bank_mask:0xf
    v_mul_f32_dpp v21, v18, v21 row_newbcast:1 row_mask:0xa bank_mask:0xf
    v_mul_f32_dpp v22, v18, v22 row_newbcast:2 row_mask:0xa bank_mask:0xf
    v_mul_f32_dpp v23, v18, v23 row_newbcast:3 row_mask:0xa bank_mask:0xf
    v_mul_f32_dpp v24, v18, v24 row_newbcast:4 row_mask:0xa bank_mask:0xf
    v_mul_f32_dpp v25, v18, v25 row_newbcast:5 row_mask:0xa bank_mask:0xf
    v_mul_f32_dpp v26, v18, v26 row_newbcast:6 row_mask:0xa bank_mask:0xf
    v_mul_f32_dpp v27, v18, v27 row_newbcast:7 row_mask:0xa bank_mask:0xf
    v_cvt_pk_bf16_f32 v80, v20, v21
    v_cvt_pk_bf16_f32 v81, v22, v23
    v_cvt_pk_bf16_f32 v82, v24, v25
    v_cvt_pk_bf16_f32 v83, v26, v27
    s_waitcnt vmcnt(4)
    v_mfma_f32_32x32x16_bf16 v[0:15], v[64:67], v[176:179], 0
    ds_read_b64_tr_b16 v[184:185], v246 offset:2048
    ds_read_b64_tr_b16 v[186:187], v246 offset:3072
    ds_read_b64_tr_b16 v[188:189], v247 offset:2048
    ds_read_b64_tr_b16 v[190:191], v247 offset:3072
    s_mov_b32 m0, s68
    v_mfma_f32_32x32x16_bf16 v[16:31], v[68:71], v[176:179], 0
    buffer_load_dwordx4 v224, s[4:7], s41 offen sc1 lds
    buffer_load_dwordx4 v225, s[72:75], s41 offen offset:1024 sc1 lds
    v_permlane32_swap_b32 v242, v236
    v_permlane32_swap_b32 v243, v237
    s_add_u32 s38, s38, 1
    v_mfma_f32_32x32x16_bf16 v[32:47], v[64:67], v[180:183], 0
    v_permlane32_swap_b32 v244, v238
    v_permlane32_swap_b32 v245, v239
    v_permlane32_swap_b32 v240, v241
    v_add_f32 v242, v242, v236
    v_mfma_f32_32x32x16_bf16 v[48:63], v[68:71], v[180:183], 0
    v_add_f32 v243, v243, v237
    v_add_f32 v244, v244, v238
    v_add_f32 v245, v245, v239
    v_add_f32 v240, -v240, -v241
    v_mov_b32 v254, s52
    v_mov_b32 v255, s38
    s_waitcnt vmcnt(4) lgkmcnt(0)
    v_mfma_f32_32x32x16_bf16 v[0:15], v[72:75], v[184:187], v[0:15]
    ds_read_b64_tr_b16 v[176:177], v246 offset:4096
    ds_read_b64_tr_b16 v[178:179], v246 offset:5120
    ds_read_b64_tr_b16 v[180:181], v247 offset:4096
    ds_read_b64_tr_b16 v[182:183], v247 offset:5120
    s_lshl_b32 s58, s38, 3
    s_add_u32 s58, s58, s20
    s_mov_b32 m0, s69
    v_mfma_f32_32x32x16_bf16 v[16:31], v[76:79], v[184:187], v[16:31]
    buffer_load_dwordx4 v226, s[4:7], s41 offen sc1 lds
    buffer_load_dwordx4 v227, s[72:75], s41 offen offset:1024 sc1 lds
    s_set_gpr_idx_on s32, gpr_idx(DST)
    s_nop 0
    v_cvt_pk_bf16_f32 v195, v242, v243
    v_cvt_pk_bf16_f32 v196, v244, v245
    v_cvt_pk_bf16_f32 v197, v240, v240
    s_set_gpr_idx_off
    s_mov_b64 exec, 1
    ds_write_b32 v254, v255
    s_mov_b64 exec, -1
    s_cmp_lt_u32 s58, s22
    s_cbranch_scc0 K2_dyn_34
K2_back_35:
    v_readlane_b32 s3, v253, s58
    s_lshl_b32 s44, s34, 7
    s_and_b32 s48, s3, 0x3ffff
    s_bfe_u32 s33, s3, 0x30013
    s_mul_i32 s35, s38, 6
    s_cmp_eq_u32 s34, 0
    s_cselect_b32 s35, s35, s48
    s_mov_b32 s45, s44
    s_xor_b32 s47, s44, 256
    s_add_u32 s49, s48, 128
    s_add_u32 s60, s48, 256
    s_cmp_eq_u32 s33, 3
    s_cselect_b32 s46, s44, s47
    s_cselect_b32 s50, s60, s48
    s_cselect_b32 s51, s48, s49
    s_sub_u32 s60, s33, 2
    s_cmp_lt_u32 s60, 2
    s_cbranch_scc0 K2_rare_40
K2_back_41:
    v_mfma_f32_32x32x16_bf16 v[32:47], v[72:75], v[188:191], v[32:47]
    v_add_u32 v233, s48, v230
    ds_read_b32 v232, v233
    ds_read_b32 v233, v233 offset:1024
    v_mfma_f32_32x32x16_bf16 v[48:63], v[76:79], v[188:191], v[48:63]
    s_waitcnt vmcnt(4) lgkmcnt(3)
    v_mfma_f32_32x32x16_bf16 v[0:15], v[80:83], v[176:179], v[0:15]
    ds_read_b64_tr_b16 v[184:185], v246 offset:6144
    ds_read_b64_tr_b16 v[186:187], v246 offset:7168
    ds_read_b64_tr_b16 v[188:189], v247 offset:6144
    ds_read_b64_tr_b16 v[190:191], v247 offset:7168
    s_mov_b32 m0, s70
    v_mfma_f32_32x32x16_bf16 v[16:31], v[84:87], v[176:179], v[16:31]
    buffer_load_dwordx4 v222, s[4:7], s42 offen sc1 lds
    buffer_load_dwordx4 v223, s[72:75], s42 offen offset:1024 sc1 lds
    v_mfma_f32_32x32x16_bf16 v[32:47], v[80:83], v[180:183], v[32:47]
    s_nop 2
    v_mul_f32 v234, v0, v96
    v_mul_f32 v236, v8, v128
    v_fmac_f32 v234, v1, v97
    v_fmac_f32 v236, v9, v129
    v_fmac_f32 v234, v2, v98
    v_fmac_f32 v236, v10, v130
    v_fmac_f32 v234, v3, v99
    v_mfma_f32_32x32x16_bf16 v[48:63], v[84:87], v[180:183], v[48:63]
    s_setprio 0
    s_waitcnt lgkmcnt(4)
    v_or_b32 v232, v232, v231
    v_or_b32 v233, v233, v231
    s_cmp_lg_u32 s34, 0
    s_cbranch_scc1 K2_dum_43
    s_cmp_eq_u32 s33, 4
    s_cbranch_scc1 K2_a4_44
K2_b4_46:
    s_add_u32 m0, s48, 512
    s_add_u32 s65, s48, 1536
    buffer_load_dwordx4 v232, s[16:19], 0 offen  lds
    s_mov_b32 m0, s65
    s_mov_b32 exec_hi, 0
    buffer_load_dwordx4 v233, s[16:19], 0 offen  lds
    s_mov_b32 exec_hi, -1
K2_back_45:
    v_fmac_f32 v236, v11, v131
    v_fmac_f32 v234, v4, v100
    v_fmac_f32 v236, v12, v132
    v_fmac_f32 v234, v5, v101
    v_fmac_f32 v236, v13, v133
    v_fmac_f32 v234, v6, v102
    v_fmac_f32 v236, v14, v134
    v_fmac_f32 v234, v7, v103
    v_fmac_f32 v236, v15, v135
    v_mul_f32 v238, v16, v128
    v_mul_f32 v240, v24, v128
    v_fmac_f32 v238, v17, v129
    v_fmac_f32 v240, v25, v129
    v_fmac_f32 v238, v18, v130
    v_fmac_f32 v240, v26, v130
    v_fmac_f32 v238, v19, v131
    v_fmac_f32 v240, v27, v131
    v_fmac_f32 v238, v20, v132
    v_fmac_f32 v240, v28, v132
    v_fmac_f32 v238, v21, v133
    v_fmac_f32 v240, v29, v133
    v_fmac_f32 v238, v22, v134
    v_fmac_f32 v240, v30, v134
    v_fmac_f32 v238, v23, v135
    v_fmac_f32 v240, v31, v135
    v_mul_f32 v235, v32, v104
    v_mul_f32 v237, v40, v136
    v_fmac_f32 v235, v33, v105
    v_fmac_f32 v237, v41, v137
    v_fmac_f32 v235, v34, v106
    v_fmac_f32 v237, v42, v138
    v_fmac_f32 v235, v35, v107
    v_fmac_f32 v237, v43, v139
    v_fmac_f32 v235, v36, v108
    v_fmac_f32 v237, v44, v140
    v_fmac_f32 v235, v37, v109
    v_fmac_f32 v237, v45, v141
    v_fmac_f32 v235, v38, v110
    v_fmac_f32 v237, v46, v142
    v_fmac_f32 v235, v39, v111
    v_fmac_f32 v237, v47, v143
    v_mul_f32 v239, v48, v136
    v_mul_f32 v241, v56, v136
    s_setprio 1
    s_waitcnt vmcnt(6) lgkmcnt(0)
    v_mfma_f32_32x32x16_bf16 v[0:15], v[64:67], v[184:187], 0
    ds_read_b64_tr_b16 v[176:177], v246 offset:0
    ds_read_b64_tr_b16 v[178:179], v246 offset:1024
    ds_read_b64_tr_b16 v[180:181], v247 offset:0
    ds_read_b64_tr_b16 v[182:183], v247 offset:1024
    v_fmac_f32 v239, v49, v137
    v_fmac_f32 v241, v57, v137
    s_mov_b32 m0, s71
    v_mfma_f32_32x32x16_bf16 v[16:31], v[68:71], v[184:187], 0
    buffer_load_dwordx4 v224, s[4:7], s42 offen sc1 lds
    buffer_load_dwordx4 v225, s[72:75], s42 offen offset:1024 sc1 lds
    v_fmac_f32 v239, v50, v138
    v_fmac_f32 v241, v58, v138
    v_fmac_f32 v239, v51, v139
    v_fmac_f32 v241, v59, v139
    v_fmac_f32 v239, v52, v140
    v_mfma_f32_32x32x16_bf16 v[32:47], v[64:67], v[188:191], 0
    v_fmac_f32 v241, v60, v140
    v_fmac_f32 v239, v53, v141
    v_fmac_f32 v241, v61, v141
    v_fmac_f32 v239, v54, v142
    v_fmac_f32 v241, v62, v142
    v_fmac_f32 v239, v55, v143
    v_fmac_f32 v241, v63, v143
    v_mfma_f32_32x32x16_bf16 v[48:63], v[68:71], v[188:191], 0
    v_permlane32_swap_b32 v234, v236
    v_permlane32_swap_b32 v235, v237
    v_permlane32_swap_b32 v240, v238
    s_waitcnt vmcnt(6) lgkmcnt(0)
    v_mfma_f32_32x32x16_bf16 v[0:15], v[72:75], v[176:179], v[0:15]
    ds_read_b64_tr_b16 v[184:185], v246 offset:2048
    ds_read_b64_tr_b16 v[186:187], v246 offset:3072
    ds_read_b64_tr_b16 v[188:189], v247 offset:2048
    ds_read_b64_tr_b16 v[190:191], v247 offset:3072
    v_permlane32_swap_b32 v241, v239
    s_mov_b32 m0, s68
    v_mfma_f32_32x32x16_bf16 v[16:31], v[76:79], v[176:179], v[16:31]
    buffer_load_dwordx4 v226, s[4:7], s42 offen sc1 lds
    buffer_load_dwordx4 v227, s[72:75], s42 offen offset:1024 sc1 lds
    v_add_f32 v234, v234, v236
    v_add_f32 v235, v235, v237
    v_add_f32 v240, v240, v238
    v_add_f32 v241, v241, v239
    v_mfma_f32_32x32x16_bf16 v[32:47], v[72:75], v[180:183], v[32:47]
    s_set_gpr_idx_on s31, gpr_idx(DST)
    s_nop 0
    v_cvt_pk_bf16_f32 v192, v234, v235
    v_cvt_pk_bf16_f32 v193, v240, v241
    s_set_gpr_idx_off
    v_mfma_f32_32x32x16_bf16 v[48:63], v[76:79], v[180:183], v[48:63]
    s_waitcnt vmcnt(6) lgkmcnt(0)
    v_mfma_f32_32x32x16_bf16 v[0:15], v[80:83], v[184:187], v[0:15]
    ds_read_b64_tr_b16 v[176:177], v246 offset:4096
    ds_read_b64_tr_b16 v[178:179], v246 offset:5120
    ds_read_b64_tr_b16 v[180:181], v247 offset:4096
    ds_read_b64_tr_b16 v[182:183], v247 offset:5120
    s_mov_b32 m0, s69
    v_mfma_f32_32x32x16_bf16 v[16:31], v[84:87], v[184:187], v[16:31]
    buffer_load_dwordx4 v222, s[4:7], s43 offen sc1 lds
    buffer_load_dwordx4 v223, s[72:75], s43 offen offset:1024 sc1 lds
    v_mfma_f32_32x32x16_bf16 v[32:47], v[80:83], v[188:191], v[32:47]
    s_nop 2
    v_mul_f32 v234, v0, v144
    v_mul_f32 v236, v8, v112
    v_fmac_f32 v234, v1, v145
    v_fmac_f32 v236, v9, v113
    v_fmac_f32 v234, v2, v146
    v_fmac_f32 v236, v10, v114
    v_fmac_f32 v234, v3, v147
    v_mfma_f32_32x32x16_bf16 v[48:63], v[84:87], v[188:191], v[48:63]
    s_setprio 0
    v_fmac_f32 v236, v11, v115
    v_fmac_f32 v234, v4, v148
    v_fmac_f32 v236, v12, v116
    v_fmac_f32 v234, v5, v149
    v_fmac_f32 v236, v13, v117
    v_fmac_f32 v234, v6, v150
    v_fmac_f32 v236, v14, v118
    v_fmac_f32 v234, v7, v151
    v_fmac_f32 v236, v15, v119
    v_mul_f32 v238, v16, v160
    v_mul_f32 v240, v24, v160
    v_fmac_f32 v238, v17, v161
    v_fmac_f32 v240, v25, v161
    v_fmac_f32 v238, v18, v162
    v_fmac_f32 v240, v26, v162
    v_fmac_f32 v238, v19, v163
    v_fmac_f32 v240, v27, v163
    v_fmac_f32 v238, v20, v164
    v_fmac_f32 v240, v28, v164
    v_fmac_f32 v238, v21, v165
    v_fmac_f32 v240, v29, v165
    v_fmac_f32 v238, v22, v166
    v_fmac_f32 v240, v30, v166
    v_fmac_f32 v238, v23, v167
    v_fmac_f32 v240, v31, v167
    v_mul_f32 v235, v32, v152
    v_mul_f32 v237, v40, v120
    v_fmac_f32 v235, v33, v153
    v_fmac_f32 v237, v41, v121
    v_fmac_f32 v235, v34, v154
    v_fmac_f32 v237, v42, v122
    v_fmac_f32 v235, v35, v155
    v_fmac_f32 v237, v43, v123
    v_fmac_f32 v235, v36, v156
    v_fmac_f32 v237, v44, v124
    v_fmac_f32 v235, v37, v157
    v_fmac_f32 v237, v45, v125
    v_fmac_f32 v235, v38, v158
    v_fmac_f32 v237, v46, v126
    v_fmac_f32 v235, v39, v159
    v_fmac_f32 v237, v47, v127
    v_mul_f32 v239, v48, v168
    v_mul_f32 v241, v56, v168
    v_fmac_f32 v239, v49, v169
    v_fmac_f32 v241, v57, v169
    s_setprio 1
    s_waitcnt vmcnt(4) lgkmcnt(0)
    v_mfma_f32_32x32x16_bf16 v[0:15], v[64:67], v[176:179], 0
    ds_read_b64_tr_b16 v[184:185], v246 offset:6144
    ds_read_b64_tr_b16 v[186:187], v246 offset:7168
    ds_read_b64_tr_b16 v[188:189], v247 offset:6144
    ds_read_b64_tr_b16 v[190:191], v247 offset:7168
    v_fmac_f32 v239, v50, v170
    v_fmac_f32 v241, v58, v170
    s_mov_b32 m0, s70
    v_mfma_f32_32x32x16_bf16 v[16:31], v[68:71], v[176:179], 0
    buffer_load_dwordx4 v224, s[4:7], s43 offen sc1 lds
    buffer_load_dwordx4 v225, s[72:75], s43 offen offset:1024 sc1 lds
    v_fmac_f32 v239, v51, v171
    v_fmac_f32 v241, v59, v171
    v_fmac_f32 v239, v52, v172
    v_fmac_f32 v241, v60, v172
    v_fmac_f32 v239, v53, v173
    v_mfma_f32_32x32x16_bf16 v[32:47], v[64:67], v[180:183], 0
    v_add_u32 v222, s48, v251
    ds_read2_b32 v[222:223], v222 offset0:1 offset1:3
    v_fmac_f32 v241, v61, v173
    v_fmac_f32 v239, v54, v174
    v_fmac_f32 v241, v62, v174
    v_fmac_f32 v239, v55, v175
    v_fmac_f32 v241, v63, v175
    v_mfma_f32_32x32x16_bf16 v[48:63], v[68:71], v[180:183], 0
    s_waitcnt vmcnt(4) lgkmcnt(1)
    v_mfma_f32_32x32x16_bf16 v[0:15], v[72:75], v[184:187], v[0:15]
    ds_read_b64_tr_b16 v[176:177], v246 offset:0
    ds_read_b64_tr_b16 v[178:179], v246 offset:1024
    ds_read_b64_tr_b16 v[180:181], v247 offset:0
    ds_read_b64_tr_b16 v[182:183], v247 offset:1024
    s_mov_b32 m0, s71
    v_mfma_f32_32x32x16_bf16 v[16:31], v[76:79], v[184:187], v[16:31]
    buffer_load_dwordx4 v226, s[4:7], s43 offen sc1 lds
    buffer_load_dwordx4 v227, s[72:75], s43 offen offset:1024 sc1 lds
    s_waitcnt lgkmcnt(4)
    v_mad_u32_u16 v222, v222, s39, v248 op_sel:[1,0,0,0]
    v_mad_u32_u16 v223, v223, s39, v248 op_sel:[1,0,0,0]
    v_mfma_f32_32x32x16_bf16 v[32:47], v[72:75], v[188:191], v[32:47]
    v_add_u32 v224, s49, v251
    ds_read2_b32 v[224:225], v224 offset0:1 offset1:3
    v_mfma_f32_32x32x16_bf16 v[48:63], v[76:79], v[188:191], v[48:63]
    s_waitcnt vmcnt(4) lgkmcnt(1)
    v_mfma_f32_32x32x16_bf16 v[0:15], v[80:83], v[176:179], v[0:15]
    ds_read_b64_tr_b16 v[184:185], v246 offset:2048
    ds_read_b64_tr_b16 v[186:187], v246 offset:3072
    ds_read_b64_tr_b16 v[188:189], v247 offset:2048
    ds_read_b64_tr_b16 v[190:191], v247 offset:3072
    s_mov_b32 m0, s68
    v_mfma_f32_32x32x16_bf16 v[16:31], v[84:87], v[176:179], v[16:31]
    buffer_load_dwordx4 v222, s[4:7], s44 offen sc1 lds
    buffer_load_dwordx4 v223, s[72:75], s44 offen offset:1024 sc1 lds
    s_waitcnt lgkmcnt(4)
    v_mad_u32_u16 v224, v224, s39, v248 op_sel:[1,0,0,0]
    v_mad_u32_u16 v225, v225, s39, v248 op_sel:[1,0,0,0]
    v_mfma_f32_32x32x16_bf16 v[32:47], v[80:83], v[180:183], v[32:47]
    v_add_u32 v226, s50, v251
    ds_read2_b32 v[226:227], v226 offset0:1 offset1:3
    v_mul_f32 v242, v0, v144
    v_fma_f32 v238, v8, v160, -v238
    v_fmac_f32 v242, v1, v145
    v_fmac_f32 v238, v9, v161
    v_fmac_f32 v242, v2, v146
    v_mfma_f32_32x32x16_bf16 v[48:63], v[84:87], v[180:183], v[48:63]
    s_setprio 0
    v_fmac_f32 v238, v10, v162
    v_fmac_f32 v242, v3, v147
    v_fmac_f32 v238, v11, v163
    v_fmac_f32 v242, v4, v148
    v_fmac_f32 v238, v12, v164
    v_fmac_f32 v242, v5, v149
    v_fmac_f32 v238, v13, v165
    v_fmac_f32 v242, v6, v150
    v_fmac_f32 v238, v14, v166
    v_fmac_f32 v242, v7, v151
    v_fmac_f32 v238, v15, v167
    v_fmac_f32 v236, v16, v112
    v_mul_f32 v244, v24, v160
    v_fmac_f32 v236, v17, v113
    v_fmac_f32 v244, v25, v161
    v_fmac_f32 v236, v18, v114
    v_fmac_f32 v244, v26, v162
    v_fmac_f32 v236, v19, v115
    v_fmac_f32 v244, v27, v163
    v_fmac_f32 v236, v20, v116
    v_fmac_f32 v244, v28, v164
    v_fmac_f32 v236, v21, v117
    v_fmac_f32 v244, v29, v165
    v_fmac_f32 v236, v22, v118
    v_fmac_f32 v244, v30, v166
    v_fmac_f32 v236, v23, v119
    v_fmac_f32 v244, v31, v167
    v_mul_f32 v243, v32, v152
    v_fma_f32 v239, v40, v168, -v239
    v_fmac_f32 v243, v33, v153
    v_fmac_f32 v239, v41, v169
    v_fmac_f32 v243, v34, v154
    v_fmac_f32 v239, v42, v170
    v_fmac_f32 v243, v35, v155
    v_fmac_f32 v239, v43, v171
    v_fmac_f32 v243, v36, v156
    v_fmac_f32 v239, v44, v172
    v_fmac_f32 v243, v37, v157
    v_fmac_f32 v239, v45, v173
    v_fmac_f32 v243, v38, v158
    v_fmac_f32 v239, v46, v174
    v_fmac_f32 v243, v39, v159
    v_fmac_f32 v239, v47, v175
    v_fmac_f32 v237, v48, v120
    v_mul_f32 v245, v56, v168
    v_fmac_f32 v237, v49, v121
    v_fmac_f32 v245, v57, v169
    v_fmac_f32 v237, v50, v122
    v_fmac_f32 v245, v58, v170
    v_fmac_f32 v237, v51, v123
    s_setprio 1
    s_waitcnt vmcnt(4) lgkmcnt(1)
    v_mfma_f32_32x32x16_bf16 v[0:15], v[64:67], v[184:187], 0
    ds_read_b64_tr_b16 v[176:177], v246 offset:4096
    ds_read_b64_tr_b16 v[178:179], v246 offset:5120
    ds_read_b64_tr_b16 v[180:181], v247 offset:4096
    ds_read_b64_tr_b16 v[182:183], v247 offset:5120
    v_fmac_f32 v245, v59, v171
    v_fmac_f32 v237, v52, v124
    s_mov_b32 m0, s69
    v_mfma_f32_32x32x16_bf16 v[16:31], v[68:71], v[184:187], 0
    buffer_load_dwordx4 v224, s[4:7], s45 offen sc1 lds
    buffer_load_dwordx4 v225, s[72:75], s45 offen offset:1024 sc1 lds
    s_waitcnt lgkmcnt(4)
    v_mad_u32_u16 v226, v226, s39, v248 op_sel:[1,0,0,0]
    v_mad_u32_u16 v227, v227, s39, v248 op_sel:[1,0,0,0]
    v_fmac_f32 v245, v60, v172
    v_fmac_f32 v237, v53, v125
    v_mfma_f32_32x32x16_bf16 v[32:47], v[64:67], v[188:191], 0
    v_add_u32 v228, s51, v251
    ds_read2_b32 v[228:229], v228 offset0:1 offset1:3
    v_fmac_f32 v245, v61, v173
    v_fmac_f32 v237, v54, v126
    v_fmac_f32 v245, v62, v174
    v_fmac_f32 v237, v55, v127
    v_fmac_f32 v245, v63, v175
    v_mfma_f32_32x32x16_bf16 v[48:63], v[68:71], v[188:191], 0
    v_permlane32_swap_b32 v242, v234
    v_permlane32_swap_b32 v243, v235
    v_add_f32 v242, v242, v234
    v_add_f32 v243, v243, v235
    s_waitcnt vmcnt(4) lgkmcnt(1)
    v_mfma_f32_32x32x16_bf16 v[0:15], v[72:75], v[176:179], v[0:15]
    ds_read_b64_tr_b16 v[184:185], v246 offset:6144
    ds_read_b64_tr_b16 v[186:187], v246 offset:7168
    ds_read_b64_tr_b16 v[188:189], v247 offset:6144
    ds_read_b64_tr_b16 v[190:191], v247 offset:7168
    s_mov_b32 m0, s70
    v_mfma_f32_32x32x16_bf16 v[16:31], v[76:79], v[176:179], v[16:31]
    buffer_load_dwordx4 v226, s[4:7], s46 offen sc1 lds
    buffer_load_dwordx4 v227, s[72:75], s46 offen offset:1024 sc1 lds
    s_waitcnt lgkmcnt(4)
    v_mad_u32_u16 v228, v228, s39, v248 op_sel:[1,0,0,0]
    v_mad_u32_u16 v229, v229, s39, v248 op_sel:[1,0,0,0]
    s_sub_u32 s26, s48, s29
    s_mov_b32 s29, s48
    v_mfma_f32_32x32x16_bf16 v[32:47], v[72:75], v[180:183], v[32:47]
    s_set_gpr_idx_on s31, gpr_idx(DST)
    s_nop 0
    v_cvt_pk_bf16_f32 v194, v242, v243
    s_set_gpr_idx_off
    s_mov_b32 s30, s3
    s_bfe_u32 s56, s3, 0x40012
    s_cmp_eq_u32 s34, 0
    s_cselect_b32 s56, s56, 0
    v_mfma_f32_32x32x16_bf16 v[48:63], v[76:79], v[180:183], v[48:63]
    s_mov_b32 s32, s31
    s_mov_b32 s31, s35
    s_waitcnt vmcnt(4) lgkmcnt(0)
    v_mfma_f32_32x32x16_bf16 v[0:15], v[80:83], v[184:187], v[0:15]
    ds_read_b64_tr_b16 v[176:177], v246 offset:0
    ds_read_b64_tr_b16 v[178:179], v246 offset:1024
    ds_read_b64_tr_b16 v[180:181], v247 offset:0
    ds_read_b64_tr_b16 v[182:183], v247 offset:1024
    s_mov_b32 m0, s71
    v_mfma_f32_32x32x16_bf16 v[16:31], v[84:87], v[184:187], v[16:31]
    buffer_load_dwordx4 v228, s[4:7], s47 offen sc1 lds
    buffer_load_dwordx4 v229, s[72:75], s47 offen offset:1024 sc1 lds
    v_mfma_f32_32x32x16_bf16 v[32:47], v[80:83], v[188:191], v[32:47]
    s_nop 2
    v_mul_f32 v242, v0, v144
    v_fma_f32 v240, v8, v160, -v240
    v_fmac_f32 v242, v1, v145
    v_fmac_f32 v240, v9, v161
    v_fmac_f32 v242, v2, v146
    v_fmac_f32 v240, v10, v162
    v_fmac_f32 v242, v3, v147
    v_mfma_f32_32x32x16_bf16 v[48:63], v[84:87], v[188:191], v[48:63]
    s_setprio 0
    v_fmac_f32 v240, v11, v163
    v_fmac_f32 v242, v4, v148
    v_fmac_f32 v240, v12, v164
    v_fmac_f32 v242, v5, v149
    v_fmac_f32 v240, v13, v165
    v_fmac_f32 v242, v6, v150
    v_fmac_f32 v240, v14, v166
    v_fmac_f32 v242, v7, v151
    v_fmac_f32 v240, v15, v167
    v_add_u32 v249, s26, v249
    v_add_u32 v250, s26, v250
    v_fma_f32 v244, v16, v160, -v244
    v_fmac_f32 v236, v24, v112
    v_fmac_f32 v244, v17, v161
    v_fmac_f32 v236, v25, v113
    v_fmac_f32 v244, v18, v162
    v_fmac_f32 v236, v26, v114
    v_fmac_f32 v244, v19, v163
    v_fmac_f32 v236, v27, v115
    v_fmac_f32 v244, v20, v164
    v_fmac_f32 v236, v28, v116
    v_fmac_f32 v244, v21, v165
    v_fmac_f32 v236, v29, v117
    v_fmac_f32 v244, v22, v166
    v_fmac_f32 v236, v30, v118
    v_fmac_f32 v244, v23, v167
    v_fmac_f32 v236, v31, v119
    ds_read_b64_tr_b16 v[0:1], v249 offset:0
    ds_read_b64_tr_b16 v[2:3], v249 offset:32
    ds_read_u16_d16_hi v16, v250 offset:0
    v_mul_f32 v243, v32, v152
    v_fma_f32 v241, v40, v168, -v241
    v_fmac_f32 v243, v33, v153
    v_fmac_f32 v241, v41, v169
    v_fmac_f32 v243, v34, v154
    v_fmac_f32 v241, v42, v170
    v_fmac_f32 v243, v35, v155
    v_fmac_f32 v241, v43, v171
    v_fmac_f32 v243, v36, v156
    v_fmac_f32 v241, v44, v172
    v_fmac_f32 v243, v37, v157
    v_fmac_f32 v241, v45, v173
    v_fmac_f32 v243, v38, v158
    v_fmac_f32 v241, v46, v174
    v_fmac_f32 v243, v39, v159
    v_fmac_f32 v241, v47, v175
    ds_read_b64_tr_b16 v[4:5], v249 offset:512
    ds_read_b64_tr_b16 v[6:7], v249 offset:544
    ds_read_u16_d16_hi v17, v250 offset:128
    v_fma_f32 v245, v48, v168, -v245
    v_fmac_f32 v237, v56, v120
    v_fmac_f32 v245, v49, v169
    v_fmac_f32 v237, v57, v121
    v_fmac_f32 v245, v50, v170
    v_fmac_f32 v237, v58, v122
    v_fmac_f32 v245, v51, v171
    v_fmac_f32 v237, v59, v123
    v_fmac_f32 v245, v52, v172
    v_fmac_f32 v237, v60, v124
    v_fmac_f32 v245, v53, v173
    v_fmac_f32 v237, v61, v125
    v_fmac_f32 v245, v54, v174
    v_fmac_f32 v237, v62, v126
    v_fmac_f32 v245, v55, v175
    v_fmac_f32 v237, v63, v127
    s_cmp_eq_u32 s56, 5
    s_cbranch_scc1 K2_U20
    s_cmp_eq_u32 s56, 6
    s_cbranch_scc1 K2_U3h0
    s_branch K2_DSP0
K2_PAD_U21:
    s_branch K2_HOP
K2_U21:
    s_setprio 1
    s_waitcnt lgkmcnt(0)
    v_lshlrev_b32 v20, 16, v0
    v_and_b32 v21, 0xffff0000, v0
    v_lshlrev_b32 v22, 16, v1
    v_and_b32 v23, 0xffff0000, v1
    v_lshlrev_b32 v24, 16, v2
    v_and_b32 v25, 0xffff0000, v2
    v_lshlrev_b32 v26, 16, v3
    v_and_b32 v27, 0xffff0000, v3
    v_mul_f32_dpp v36, v16, v20 row_newbcast:8 row_mask:0xf bank_mask:0xf
    v_mul_f32_dpp v37, v16, v21 row_newbcast:9 row_mask:0xf bank_mask:0xf
    v_mul_f32_dpp v38, v16, v22 row_newbcast:10 row_mask:0xf bank_mask:0xf
    v_mul_f32_dpp v39, v16, v23 row_newbcast:11 row_mask:0xf bank_mask:0xf
    v_mul_f32_dpp v40, v16, v24 row_newbcast:12 row_mask:0xf bank_mask:0xf
    v_mul_f32_dpp v41, v16, v25 row_newbcast:13 row_mask:0xf bank_mask:0xf
    v_mul_f32_dpp v42, v16, v26 row_newbcast:14 row_mask:0xf bank_mask:0xf
    v_mul_f32_dpp v43, v16, v27 row_newbcast:15 row_mask:0xf bank_mask:0xf
    v_cvt_pk_bf16_f32 v68, v36, v37
    v_cvt_pk_bf16_f32 v69, v38, v39
    v_cvt_pk_bf16_f32 v70, v40, v41
    v_cvt_pk_bf16_f32 v71, v42, v43
    v_mul_f32_dpp v20, v16, v20 row_newbcast:0 row_mask:0xa bank_mask:0xf
    v_mul_f32_dpp v21, v16, v21 row_newbcast:1 row_mask:0xa bank_mask:0xf
    v_mul_f32_dpp v22, v16, v22 row_newbcast:2 row_mask:0xa bank_mask:0xf
    v_mul_f32_dpp v23, v16, v23 row_newbcast:3 row_mask:0xa bank_mask:0xf
    v_mul_f32_dpp v24, v16, v24 row_newbcast:4 row_mask:0xa bank_mask:0xf
    v_mul_f32_dpp v25, v16, v25 row_newbcast:5 row_mask:0xa bank_mask:0xf
    v_mul_f32_dpp v26, v16, v26 row_newbcast:6 row_mask:0xa bank_mask:0xf
    v_mul_f32_dpp v27, v16, v27 row_newbcast:7 row_mask:0xa bank_mask:0xf
    v_cvt_pk_bf16_f32 v64, v20, v21
    v_cvt_pk_bf16_f32 v65, v22, v23
    v_cvt_pk_bf16_f32 v66, v24, v25
    v_cvt_pk_bf16_f32 v67, v26, v27
    v_lshlrev_b32 v28, 16, v4
    v_and_b32 v29, 0xffff0000, v4
    v_lshlrev_b32 v30, 16, v5
    v_and_b32 v31, 0xffff0000, v5
    v_lshlrev_b32 v32, 16, v6
    v_and_b32 v33, 0xffff0000, v6
    v_lshlrev_b32 v34, 16, v7
    v_and_b32 v35, 0xffff0000, v7
    v_mul_f32_dpp v36, v17, v28 row_newbcast:8 row_mask:0xf bank_mask:0xf
    v_mul_f32_dpp v37, v17, v29 row_newbcast:9 row_mask:0xf bank_mask:0xf
    v_mul_f32_dpp v38, v17, v30 row_newbcast:10 row_mask:0xf bank_mask:0xf
    v_mul_f32_dpp v39, v17, v31 row_newbcast:11 row_mask:0xf bank_mask:0xf
    v_mul_f32_dpp v40, v17, v32 row_newbcast:12 row_mask:0xf bank_mask:0xf
    v_mul_f32_dpp v41, v17, v33 row_newbcast:13 row_mask:0xf bank_mask:0xf
    v_mul_f32_dpp v42, v17, v34 row_newbcast:14 row_mask:0xf bank_mask:0xf
    v_mul_f32_dpp v43, v17, v35 row_newbcast:15 row_mask:0xf bank_mask:0xf
    v_cvt_pk_bf16_f32 v76, v36, v37
    v_cvt_pk_bf16_f32 v77, v38, v39
    v_cvt_pk_bf16_f32 v78, v40, v41
    v_cvt_pk_bf16_f32 v79, v42, v43
    v_mul_f32_dpp v28, v17, v28 row_newbcast:0 row_mask:0xa bank_mask:0xf
    v_mul_f32_dpp v29, v17, v29 row_newbcast:1 row_mask:0xa bank_mask:0xf
    v_mul_f32_dpp v30, v17, v30 row_newbcast:2 row_mask:0xa bank_mask:0xf
    v_mul_f32_dpp v31, v17, v31 row_newbcast:3 row_mask:0xa bank_mask:0xf
    v_mul_f32_dpp v32, v17, v32 row_newbcast:4 row_mask:0xa bank_mask:0xf
    v_mul_f32_dpp v33, v17, v33 row_newbcast:5 row_mask:0xa bank_mask:0xf
    v_mul_f32_dpp v34, v17, v34 row_newbcast:6 row_mask:0xa bank_mask:0xf
    v_mul_f32_dpp v35, v17, v35 row_newbcast:7 row_mask:0xa bank_mask:0xf
    v_cvt_pk_bf16_f32 v72, v28, v29
    v_cvt_pk_bf16_f32 v73, v30, v31
    v_cvt_pk_bf16_f32 v74, v32, v33
    v_cvt_pk_bf16_f32 v75, v34, v35
    s_waitcnt vmcnt(4)
    v_mfma_f32_32x32x16_bf16 v[0:15], v[64:67], v[176:179], 0
    ds_read_b64_tr_b16 v[184:185], v246 offset:2048
    ds_read_b64_tr_b16 v[186:187], v246 offset:3072
    ds_read_b64_tr_b16 v[188:189], v247 offset:2048
    ds_read_b64_tr_b16 v[190:191], v247 offset:3072
    s_mov_b32 m0, s68
    v_mfma_f32_32x32x16_bf16 v[16:31], v[68:71], v[176:179], 0
    buffer_load_dwordx4 v222, s[4:7], s42 offen sc1 lds
    buffer_load_dwordx4 v223, s[72:75], s42 offen offset:1024 sc1 lds
    v_permlane32_swap_b32 v242, v236
    v_permlane32_swap_b32 v243, v237
    v_mov_b32 v254, 163296
    v_mfma_f32_32x32x16_bf16 v[32:47], v[64:67], v[180:183], 0
    v_permlane32_swap_b32 v244, v238
    v_permlane32_swap_b32 v245, v239
    v_permlane32_swap_b32 v240, v241
    v_add_f32 v242, v242, v236
    v_mfma_f32_32x32x16_bf16 v[48:63], v[68:71], v[180:183], 0
    v_add_f32 v243, v243, v237
    v_add_f32 v244, v244, v238
    v_add_f32 v245, v245, v239
    v_add_f32 v240, -v240, -v241
    v_sub_u32 v241, v230, v231
    v_cvt_pk_bf16_f32 v242, v242, v243
    v_mov_b32 v255, 1
    v_lshl_add_u32 v233, v252, 1, s53
    s_mov_b64 exec, 1
    ds_add_rtn_u32 v232, v254, v255
    s_mov_b64 exec, -1
    ds_read_b32 v233, v233
    s_waitcnt vmcnt(4) lgkmcnt(2)
    v_mfma_f32_32x32x16_bf16 v[0:15], v[72:75], v[184:187], v[0:15]
    ds_read_b64_tr_b16 v[176:177], v246 offset:4096
    ds_read_b64_tr_b16 v[178:179], v246 offset:5120
    ds_read_b64_tr_b16 v[180:181], v247 offset:4096
    ds_read_b64_tr_b16 v[182:183], v247 offset:5120
    v_cvt_pk_bf16_f32 v244, v244, v245
    v_cvt_pk_bf16_f32 v240, v240, v240
    s_mov_b32 m0, s69
    v_mfma_f32_32x32x16_bf16 v[16:31], v[76:79], v[184:187], v[16:31]
    buffer_load_dwordx4 v224, s[4:7], s42 offen sc1 lds
    buffer_load_dwordx4 v225, s[72:75], s42 offen offset:1024 sc1 lds
    ds_write_b32 v230, v242 offset:768
    ds_write_b32 v230, v244 offset:1024
    ds_write_b16 v241, v240 offset:1280
    s_waitcnt lgkmcnt(7)
    v_readfirstlane_b32 s58, v232
    v_mfma_f32_32x32x16_bf16 v[32:47], v[72:75], v[188:191], v[32:47]
    s_cmp_lt_u32 s58, s22
    s_cbranch_scc0 K2_nul_47
    s_nop 0
    v_readlane_b32 s58, v253, s58
    s_nop 0
    s_bfe_u32 s58, s58, 0x60016
    s_and_b32 s59, s58, 7
    s_lshr_b32 s60, s58, 3
K2_chk_49:
    v_readlane_b32 s61, v233, s59
    s_nop 0
    s_cmp_gt_u32 s61, s60
    s_cbranch_scc0 K2_spin_48
K2_back_50:
    v_mfma_f32_32x32x16_bf16 v[48:63], v[76:79], v[188:191], v[48:63]
    s_setprio 0
    v_readlane_b32 s3, v253, s58
    s_lshl_b32 s44, s34, 7
    s_and_b32 s48, s3, 0x3ffff
    s_bfe_u32 s33, s3, 0x30013
    s_mov_b32 s35, s48
    s_mov_b32 s45, s44
    v_mul_f32 v234, v0, v96
    v_mul_f32 v236, v8, v128
    v_fmac_f32 v234, v1, v97
    v_fmac_f32 v236, v9, v129
    v_fmac_f32 v234, v2, v98
    v_fmac_f32 v236, v10, v130
    v_fmac_f32 v234, v3, v99
    v_fmac_f32 v236, v11, v131
    v_fmac_f32 v234, v4, v100
    v_fmac_f32 v236, v12, v132
    v_fmac_f32 v234, v5, v101
    v_fmac_f32 v236, v13, v133
    v_fmac_f32 v234, v6, v102
    v_fmac_f32 v236, v14, v134
    v_fmac_f32 v234, v7, v103
    v_fmac_f32 v236, v15, v135
    v_mul_f32 v238, v16, v128
    v_mul_f32 v240, v24, v128
    v_fmac_f32 v238, v17, v129
    v_fmac_f32 v240, v25, v129
    v_fmac_f32 v238, v18, v130
    v_fmac_f32 v240, v26, v130
    v_fmac_f32 v238, v19, v131
    v_fmac_f32 v240, v27, v131
    v_fmac_f32 v238, v20, v132
    v_fmac_f32 v240, v28, v132
    v_fmac_f32 v238, v21, v133
    v_fmac_f32 v240, v29, v133
    v_fmac_f32 v238, v22, v134
    v_fmac_f32 v240, v30, v134
    v_fmac_f32 v238, v23, v135
    v_fmac_f32 v240, v31, v135
    v_mul_f32 v235, v32, v104
    v_mul_f32 v237, v40, v136
    v_fmac_f32 v235, v33, v105
    v_fmac_f32 v237, v41, v137
    v_fmac_f32 v235, v34, v106
    v_fmac_f32 v237, v42, v138
    v_fmac_f32 v235, v35, v107
    v_fmac_f32 v237, v43, v139
    v_fmac_f32 v235, v36, v108
    v_fmac_f32 v237, v44, v140
    v_fmac_f32 v235, v37, v109
    v_fmac_f32 v237, v45, v141
    v_fmac_f32 v235, v38, v110
    v_fmac_f32 v237, v46, v142
    v_fmac_f32 v235, v39, v111
    v_fmac_f32 v237, v47, v143
    v_mul_f32 v239, v48, v136
    v_mul_f32 v241, v56, v136
    v_fmac_f32 v239, v49, v137
    v_fmac_f32 v241, v57, v137
    s_setprio 1
    s_waitcnt vmcnt(4) lgkmcnt(3)
    v_mfma_f32_32x32x16_bf16 v[0:15], v[64:67], v[176:179], 0
    ds_read_b64_tr_b16 v[184:185], v246 offset:6144
    ds_read_b64_tr_b16 v[186:187], v246 offset:7168
    ds_read_b64_tr_b16 v[188:189], v247 offset:6144
    ds_read_b64_tr_b16 v[190:191], v247 offset:7168
    v_fmac_f32 v239, v50, v138
    v_fmac_f32 v241, v58, v138
    s_mov_b32 m0, s70
    v_mfma_f32_32x32x16_bf16 v[16:31], v[68:71], v[176:179], 0
    buffer_load_dwordx4 v222, s[4:7], s43 offen sc1 lds
    buffer_load_dwordx4 v223, s[72:75], s43 offen offset:1024 sc1 lds
    v_fmac_f32 v239, v51, v139
    v_fmac_f32 v241, v59, v139
    v_fmac_f32 v239, v52, v140
    v_fmac_f32 v241, v60, v140
    v_fmac_f32 v239, v53, v141
    v_mfma_f32_32x32x16_bf16 v[32:47], v[64:67], v[180:183], 0
    s_xor_b32 s47, s44, 256
    s_add_u32 s49, s48, 128
    s_add_u32 s60, s48, 256
    s_cmp_eq_u32 s33, 3
    s_cselect_b32 s46, s44, s47
    s_cselect_b32 s50, s60, s48
    s_cselect_b32 s51, s48, s49
    s_sub_u32 s60, s33, 2
    s_cmp_lt_u32 s60, 2
    s_cbranch_scc0 K2_rare_51
K2_back_52:
    v_add_u32 v222, s48, v251
    ds_read2_b32 v[222:223], v222 offset0:1 offset1:3
    v_fmac_f32 v241, v61, v141
    v_fmac_f32 v239, v54, v142
    v_fmac_f32 v241, v62, v142
    v_fmac_f32 v239, v55, v143
    v_fmac_f32 v241, v63, v143
    v_mfma_f32_32x32x16_bf16 v[48:63], v[68:71], v[180:183], 0
    v_permlane32_swap_b32 v234, v236
    v_permlane32_swap_b32 v235, v237
    v_permlane32_swap_b32 v240, v238
    s_waitcnt vmcnt(4) lgkmcnt(1)
    v_mfma_f32_32x32x16_bf16 v[0:15], v[72:75], v[184:187], v[0:15]
    ds_read_b64_tr_b16 v[176:177], v246 offset:0
    ds_read_b64_tr_b16 v[178:179], v246 offset:1024
    ds_read_b64_tr_b16 v[180:181], v247 offset:0
    ds_read_b64_tr_b16 v[182:183], v247 offset:1024
    v_permlane32_swap_b32 v241, v239
    s_mov_b32 m0, s71
    v_mfma_f32_32x32x16_bf16 v[16:31], v[76:79], v[184:187], v[16:31]
    buffer_load_dwordx4 v224, s[4:7], s43 offen sc1 lds
    buffer_load_dwordx4 v225, s[72:75], s43 offen offset:1024 sc1 lds
    s_waitcnt lgkmcnt(4)
    v_mad_u32_u16 v222, v222, s39, v248 op_sel:[1,0,0,0]
    v_mad_u32_u16 v223, v223, s39, v248 op_sel:[1,0,0,0]
    v_lshl_add_u32 v230, v252, 1, s31
    v_add_f32 v234, v234, v236
    v_add_f32 v235, v235, v237
    v_add_f32 v240, v240, v238
    v_add_f32 v241, v241, v239
    v_cvt_pk_bf16_f32 v234, v234, v235
    v_cvt_pk_bf16_f32 v240, v240, v241
    ds_write_b32 v230, v234 offset:0
    ds_write_b32 v230, v240 offset:256
    v_mfma_f32_32x32x16_bf16 v[32:47], v[72:75], v[188:191], v[32:47]
    v_add_u32 v224, s49, v251
    ds_read2_b32 v[224:225], v224 offset0:1 offset1:3
    v_mul_f32 v234, v0, v144
    v_mul_f32 v236, v8, v112
    v_fmac_f32 v234, v1, v145
    v_fmac_f32 v236, v9, v113
    v_fmac_f32 v234, v2, v146
    v_mfma_f32_32x32x16_bf16 v[48:63], v[76:79], v[188:191], v[48:63]
    s_setprio 0
    v_fmac_f32 v236, v10, v114
    v_fmac_f32 v234, v3, v147
    v_fmac_f32 v236, v11, v115
    v_fmac_f32 v234, v4, v148
    v_fmac_f32 v236, v12, v116
    v_fmac_f32 v234, v5, v149
    v_fmac_f32 v236, v13, v117
    v_fmac_f32 v234, v6, v150
    v_fmac_f32 v236, v14, v118
    v_fmac_f32 v234, v7, v151
    v_fmac_f32 v236, v15, v119
    v_mul_f32 v238, v16, v160
    v_mul_f32 v240, v24, v160
    v_fmac_f32 v238, v17, v161
    v_fmac_f32 v240, v25, v161
    v_fmac_f32 v238, v18, v162
    v_fmac_f32 v240, v26, v162
    v_fmac_f32 v238, v19, v163
    v_fmac_f32 v240, v27, v163
    v_fmac_f32 v238, v20, v164
    v_fmac_f32 v240, v28, v164
    v_fmac_f32 v238, v21, v165
    v_fmac_f32 v240, v29, v165
    v_fmac_f32 v238, v22, v166
    v_fmac_f32 v240, v30, v166
    v_fmac_f32 v238, v23, v167
    v_fmac_f32 v240, v31, v167
    v_mul_f32 v235, v32, v152
    v_mul_f32 v237, v40, v120
    v_fmac_f32 v235, v33, v153
    v_fmac_f32 v237, v41, v121
    v_fmac_f32 v235, v34, v154
    v_fmac_f32 v237, v42, v122
    v_fmac_f32 v235, v35, v155
    v_fmac_f32 v237, v43, v123
    v_fmac_f32 v235, v36, v156
    v_fmac_f32 v237, v44, v124
    v_fmac_f32 v235, v37, v157
    v_fmac_f32 v237, v45, v125
    v_fmac_f32 v235, v38, v158
    v_fmac_f32 v237, v46, v126
    v_fmac_f32 v235, v39, v159
    v_fmac_f32 v237, v47, v127
    v_mul_f32 v239, v48, v168
    v_mul_f32 v241, v56, v168
    v_fmac_f32 v239, v49, v169
    v_fmac_f32 v241, v57, v169
    v_fmac_f32 v239, v50, v170
    v_fmac_f32 v241, v58, v170
    v_fmac_f32 v239, v51, v171
    s_setprio 1
    s_waitcnt vmcnt(4) lgkmcnt(3)
    v_mfma_f32_32x32x16_bf16 v[0:15], v[64:67], v[176:179], 0
    ds_read_b64_tr_b16 v[184:185], v246 offset:2048
    ds_read_b64_tr_b16 v[186:187], v246 offset:3072
    ds_read_b64_tr_b16 v[188:189], v247 offset:2048
    ds_read_b64_tr_b16 v[190:191], v247 offset:3072
    v_fmac_f32 v241, v59, v171
    v_fmac_f32 v239, v52, v172
    s_mov_b32 m0, s68
    v_mfma_f32_32x32x16_bf16 v[16:31], v[68:71], v[176:179], 0
    buffer_load_dwordx4 v222, s[4:7], s44 offen sc1 lds
    buffer_load_dwordx4 v223, s[72:75], s44 offen offset:1024 sc1 lds
    s_waitcnt lgkmcnt(4)
    v_mad_u32_u16 v224, v224, s39, v248 op_sel:[1,0,0,0]
    v_mad_u32_u16 v225, v225, s39, v248 op_sel:[1,0,0,0]
    v_fmac_f32 v241, v60, v172
    v_fmac_f32 v239, v53, v173
    v_mfma_f32_32x32x16_bf16 v[32:47], v[64:67], v[180:183], 0
    v_add_u32 v226, s50, v251
    ds_read2_b32 v[226:227], v226 offset0:1 offset1:3
    v_fmac_f32 v241, v61, v173
    v_fmac_f32 v239, v54, v174
    v_fmac_f32 v241, v62, v174
    v_fmac_f32 v239, v55, v175
    v_fmac_f32 v241, v63, v175
    v_mfma_f32_32x32x16_bf16 v[48:63], v[68:71], v[180:183], 0
    s_waitcnt vmcnt(4) lgkmcnt(1)
    v_mfma_f32_32x32x16_bf16 v[0:15], v[72:75], v[184:187], v[0:15]
    ds_read_b64_tr_b16 v[176:177], v246 offset:4096
    ds_read_b64_tr_b16 v[178:179], v246 offset:5120
    ds_read_b64_tr_b16 v[180:181], v247 offset:4096
    ds_read_b64_tr_b16 v[182:183], v247 offset:5120
    s_mov_b32 m0, s69
    v_mfma_f32_32x32x16_bf16 v[16:31], v[76:79], v[184:187], v[16:31]
    buffer_load_dwordx4 v224, s[4:7], s45 offen sc1 lds
    buffer_load_dwordx4 v225, s[72:75], s45 offen offset:1024 sc1 lds
    s_waitcnt lgkmcnt(4)
    v_mad_u32_u16 v226, v226, s39, v248 op_sel:[1,0,0,0]
    v_mad_u32_u16 v227, v227, s39, v248 op_sel:[1,0,0,0]
    v_mfma_f32_32x32x16_bf16 v[32:47], v[72:75], v[188:191], v[32:47]
    v_add_u32 v228, s51, v251
    ds_read2_b32 v[228:229], v228 offset0:1 offset1:3
    v_mul_f32 v242, v0, v144
    v_fma_f32 v238, v8, v160, -v238
    v_fmac_f32 v242, v1, v145
    v_fmac_f32 v238, v9, v161
    v_fmac_f32 v242, v2, v146
    v_mfma_f32_32x32x16_bf16 v[48:63], v[76:79], v[188:191], v[48:63]
    s_setprio 0
    v_fmac_f32 v238, v10, v162
    v_fmac_f32 v242, v3, v147
    v_fmac_f32 v238, v11, v163
    v_fmac_f32 v242, v4, v148
    v_fmac_f32 v238, v12, v164
    v_fmac_f32 v242, v5, v149
    v_fmac_f32 v238, v13, v165
    v_fmac_f32 v242, v6, v150
    v_fmac_f32 v238, v14, v166
    v_fmac_f32 v242, v7, v151
    v_fmac_f32 v238, v15, v167
    v_fmac_f32 v236, v16, v112
    v_mul_f32 v244, v24, v160
    v_fmac_f32 v236, v17, v113
    v_fmac_f32 v244, v25, v161
    v_fmac_f32 v236, v18, v114
    v_fmac_f32 v244, v26, v162
    v_fmac_f32 v236, v19, v115
    v_fmac_f32 v244, v27, v163
    v_fmac_f32 v236, v20, v116
    v_fmac_f32 v244, v28, v164
    v_fmac_f32 v236, v21, v117
    v_fmac_f32 v244, v29, v165
    v_fmac_f32 v236, v22, v118
    v_fmac_f32 v244, v30, v166
    v_fmac_f32 v236, v23, v119
    v_fmac_f32 v244, v31, v167
    v_mul_f32 v243, v32, v152
    v_fma_f32 v239, v40, v168, -v239
    v_fmac_f32 v243, v33, v153
    v_fmac_f32 v239, v41, v169
    v_fmac_f32 v243, v34, v154
    v_fmac_f32 v239, v42, v170
    v_fmac_f32 v243, v35, v155
    v_fmac_f32 v239, v43, v171
    v_fmac_f32 v243, v36, v156
    v_fmac_f32 v239, v44, v172
    v_fmac_f32 v243, v37, v157
    v_fmac_f32 v239, v45, v173
    v_fmac_f32 v243, v38, v158
    v_fmac_f32 v239, v46, v174
    v_fmac_f32 v243, v39, v159
    v_fmac_f32 v239, v47, v175
    v_fmac_f32 v237, v48, v120
    v_mul_f32 v245, v56, v168
    v_fmac_f32 v237, v49, v121
    v_fmac_f32 v245, v57, v169
    v_fmac_f32 v237, v50, v122
    s_setprio 1
    s_waitcnt vmcnt(4) lgkmcnt(1)
    v_mfma_f32_32x32x16_bf16 v[0:15], v[64:67], v[176:179], 0
    ds_read_b64_tr_b16 v[184:185], v246 offset:6144
    ds_read_b64_tr_b16 v[186:187], v246 offset:7168
    ds_read_b64_tr_b16 v[188:189], v247 offset:6144
    ds_read_b64_tr_b16 v[190:191], v247 offset:7168
    v_fmac_f32 v245, v58, v170
    v_fmac_f32 v237, v51, v123
    s_mov_b32 m0, s70
    v_mfma_f32_32x32x16_bf16 v[16:31], v[68:71], v[176:179], 0
    buffer_load_dwordx4 v226, s[4:7], s46 offen sc1 lds
    buffer_load_dwordx4 v227, s[72:75], s46 offen offset:1024 sc1 lds
    s_waitcnt lgkmcnt(4)
    v_mad_u32_u16 v228, v228, s39, v248 op_sel:[1,0,0,0]
    v_mad_u32_u16 v229, v229, s39, v248 op_sel:[1,0,0,0]
    v_fmac_f32 v245, v59, v171
    v_fmac_f32 v237, v52, v124
    v_mfma_f32_32x32x16_bf16 v[32:47], v[64:67], v[180:183], 0
    v_fmac_f32 v245, v60, v172
    v_fmac_f32 v237, v53, v125
    v_fmac_f32 v245, v61, v173
    v_fmac_f32 v237, v54, v126
    v_fmac_f32 v245, v62, v174
    v_fmac_f32 v237, v55, v127
    v_fmac_f32 v245, v63, v175
    v_mfma_f32_32x32x16_bf16 v[48:63], v[68:71], v[180:183], 0
    v_permlane32_swap_b32 v242, v234
    v_permlane32_swap_b32 v243, v235
    v_add_f32 v242, v242, v234
    v_add_f32 v243, v243, v235
    s_waitcnt vmcnt(4) lgkmcnt(0)
    v_mfma_f32_32x32x16_bf16 v[0:15], v[72:75], v[184:187], v[0:15]
    ds_read_b64_tr_b16 v[176:177], v246 offset:0
    ds_read_b64_tr_b16 v[178:179], v246 offset:1024
    ds_read_b64_tr_b16 v[180:181], v247 offset:0
    ds_read_b64_tr_b16 v[182:183], v247 offset:1024
    v_cvt_pk_bf16_f32 v242, v242, v243
    ds_write_b32 v230, v242 offset:512
    s_mov_b32 m0, s71
    v_mfma_f32_32x32x16_bf16 v[16:31], v[76:79], v[184:187], v[16:31]
    buffer_load_dwordx4 v228, s[4:7], s47 offen sc1 lds
    buffer_load_dwordx4 v229, s[72:75], s47 offen offset:1024 sc1 lds
    s_sub_u32 s26, s48, s29
    s_mov_b32 s29, s48
    s_mov_b32 s30, s3
    s_bfe_u32 s56, s3, 0x40012
    s_cmp_lg_u32 s36, 0
    s_cselect_b32 s56, s56, 0
    v_mfma_f32_32x32x16_bf16 v[32:47], v[72:75], v[188:191], v[32:47]
    s_mov_b32 s32, s31
    s_mov_b32 s31, s35
    v_mul_f32 v242, v0, v144
    v_fma_f32 v240, v8, v160, -v240
    v_fmac_f32 v242, v1, v145
    v_fmac_f32 v240, v9, v161
    v_fmac_f32 v242, v2, v146
    v_mfma_f32_32x32x16_bf16 v[48:63], v[76:79], v[188:191], v[48:63]
    s_setprio 0
    v_fmac_f32 v240, v10, v162
    v_fmac_f32 v242, v3, v147
    v_fmac_f32 v240, v11, v163
    v_fmac_f32 v242, v4, v148
    v_fmac_f32 v240, v12, v164
    v_fmac_f32 v242, v5, v149
    v_fmac_f32 v240, v13, v165
    v_fmac_f32 v242, v6, v150
    v_fmac_f32 v240, v14, v166
    v_fmac_f32 v242, v7, v151
    v_fmac_f32 v240, v15, v167
    v_add_u32 v249, s26, v249
    v_add_u32 v250, s26, v250
    v_fma_f32 v244, v16, v160, -v244
    v_fmac_f32 v236, v24, v112
    v_fmac_f32 v244, v17, v161
    v_fmac_f32 v236, v25, v113
    v_fmac_f32 v244, v18, v162
    v_fmac_f32 v236, v26, v114
    v_fmac_f32 v244, v19, v163
    v_fmac_f32 v236, v27, v115
    v_fmac_f32 v244, v20, v164
    v_fmac_f32 v236, v28, v116
    v_fmac_f32 v244, v21, v165
    v_fmac_f32 v236, v29, v117
    v_fmac_f32 v244, v22, v166
    v_fmac_f32 v236, v30, v118
    v_fmac_f32 v244, v23, v167
    v_fmac_f32 v236, v31, v119
    ds_read_b64_tr_b16 v[0:1], v249 offset:0
    ds_read_b64_tr_b16 v[2:3], v249 offset:32
    ds_read_u16_d16_hi v16, v250 offset:0
    v_mul_f32 v243, v32, v152
    v_fma_f32 v241, v40, v168, -v241
    v_fmac_f32 v243, v33, v153
    v_fmac_f32 v241, v41, v169
    v_fmac_f32 v243, v34, v154
    v_fmac_f32 v241, v42, v170
    v_fmac_f32 v243, v35, v155
    v_fmac_f32 v241, v43, v171
    v_fmac_f32 v243, v36, v156
    v_fmac_f32 v241, v44, v172
    v_fmac_f32 v243, v37, v157
    v_fmac_f32 v241, v45, v173
    v_fmac_f32 v243, v38, v158
    v_fmac_f32 v241, v46, v174
    v_fmac_f32 v243, v39, v159
    v_fmac_f32 v241, v47, v175
    ds_read_b64_tr_b16 v[4:5], v249 offset:512
    ds_read_b64_tr_b16 v[6:7], v249 offset:544
    ds_read_u16_d16_hi v17, v250 offset:128
    v_fma_f32 v245, v48, v168, -v245
    v_fmac_f32 v237, v56, v120
    v_fmac_f32 v245, v49, v169
    v_fmac_f32 v237, v57, v121
    v_fmac_f32 v245, v50, v170
    v_fmac_f32 v237, v58, v122
    v_fmac_f32 v245, v51, v171
    v_fmac_f32 v237, v59, v123
    v_fmac_f32 v245, v52, v172
    v_fmac_f32 v237, v60, v124
    v_fmac_f32 v245, v53, v173
    v_fmac_f32 v237, v61, v125
    v_fmac_f32 v245, v54, v174
    v_fmac_f32 v237, v62, v126
    v_fmac_f32 v245, v55, v175
    v_fmac_f32 v237, v63, v127
    s_cmp_eq_u32 s56, 5
    s_cbranch_scc1 K2_U21
    s_cmp_eq_u32 s56, 6
    s_cbranch_scc1 K2_U3h1
    s_branch K2_DSP1
K2_PAD_U31:
    s_branch K2_HOP
K2_U3h1:
    s_setprio 1
    ds_read_b64_tr_b16 v[8:9], v249 offset:1024
    ds_read_u16_d16_hi v18, v250 offset:256
    s_waitcnt lgkmcnt(2)
    v_lshlrev_b32 v20, 16, v0
    v_and_b32 v21, 0xffff0000, v0
    v_lshlrev_b32 v22, 16, v1
    v_and_b32 v23, 0xffff0000, v1
    v_lshlrev_b32 v24, 16, v2
    v_and_b32 v25, 0xffff0000, v2
    v_lshlrev_b32 v26, 16, v3
    v_and_b32 v27, 0xffff0000, v3
    v_mul_f32_dpp v36, v16, v20 row_newbcast:8 row_mask:0xf bank_mask:0xf
    v_mul_f32_dpp v37, v16, v21 row_newbcast:9 row_mask:0xf bank_mask:0xf
    v_mul_f32_dpp v38, v16, v22 row_newbcast:10 row_mask:0xf bank_mask:0xf
    v_mul_f32_dpp v39, v16, v23 row_newbcast:11 row_mask:0xf bank_mask:0xf
    v_mul_f32_dpp v40, v16, v24 row_newbcast:12 row_mask:0xf bank_mask:0xf
    v_mul_f32_dpp v41, v16, v25 row_newbcast:13 row_mask:0xf bank_mask:0xf
    v_mul_f32_dpp v42, v16, v26 row_newbcast:14 row_mask:0xf bank_mask:0xf
    v_mul_f32_dpp v43, v16, v27 row_newbcast:15 row_mask:0xf bank_mask:0xf
    v_cvt_pk_bf16_f32 v68, v36, v37
    v_cvt_pk_bf16_f32 v69, v38, v39
    v_cvt_pk_bf16_f32 v70, v40, v41
    v_cvt_pk_bf16_f32 v71, v42, v43
    v_mul_f32_dpp v20, v16, v20 row_newbcast:0 row_mask:0xa bank_mask:0xf
    v_mul_f32_dpp v21, v16, v21 row_newbcast:1 row_mask:0xa bank_mask:0xf
    v_mul_f32_dpp v22, v16, v22 row_newbcast:2 row_mask:0xa bank_mask:0xf
    v_mul_f32_dpp v23, v16, v23 row_newbcast:3 row_mask:0xa bank_mask:0xf
    v_mul_f32_dpp v24, v16, v24 row_newbcast:4 row_mask:0xa bank_mask:0xf
    v_mul_f32_dpp v25, v16, v25 row_newbcast:5 row_mask:0xa bank_mask:0xf
    v_mul_f32_dpp v26, v16, v26 row_newbcast:6 row_mask:0xa bank_mask:0xf
    v_mul_f32_dpp v27, v16, v27 row_newbcast:7 row_mask:0xa bank_mask:0xf
    v_cvt_pk_bf16_f32 v64, v20, v21
    v_cvt_pk_bf16_f32 v65, v22, v23
    v_cvt_pk_bf16_f32 v66, v24, v25
    v_cvt_pk_bf16_f32 v67, v26, v27
    v_lshlrev_b32 v28, 16, v4
    v_and_b32 v29, 0xffff0000, v4
    v_lshlrev_b32 v30, 16, v5
    v_and_b32 v31, 0xffff0000, v5
    v_lshlrev_b32 v32, 16, v6
    v_and_b32 v33, 0xffff0000, v6
    v_lshlrev_b32 v34, 16, v7
    v_and_b32 v35, 0xffff0000, v7
    v_mul_f32_dpp v36, v17, v28 row_newbcast:8 row_mask:0xf bank_mask:0xf
    v_mul_f32_dpp v37, v17, v29 row_newbcast:9 row_mask:0xf bank_mask:0xf
    v_mul_f32_dpp v38, v17, v30 row_newbcast:10 row_mask:0xf bank_mask:0xf
    v_mul_f32_dpp v39, v17, v31 row_newbcast:11 row_mask:0xf bank_mask:0xf
    v_mul_f32_dpp v40, v17, v32 row_newbcast:12 row_mask:0xf bank_mask:0xf
    v_mul_f32_dpp v41, v17, v33 row_newbcast:13 row_mask:0xf bank_mask:0xf
    v_mul_f32_dpp v42, v17, v34 row_newbcast:14 row_mask:0xf bank_mask:0xf
    v_mul_f32_dpp v43, v17, v35 row_newbcast:15 row_mask:0xf bank_mask:0xf
    v_cvt_pk_bf16_f32 v76, v36, v37
    v_cvt_pk_bf16_f32 v77, v38, v39
    v_cvt_pk_bf16_f32 v78, v40, v41
    v_cvt_pk_bf16_f32 v79, v42, v43
    v_mul_f32_dpp v28, v17, v28 row_newbcast:0 row_mask:0xa bank_mask:0xf
    v_mul_f32_dpp v29, v17, v29 row_newbcast:1 row_mask:0xa bank_mask:0xf
    v_mul_f32_dpp v30, v17, v30 row_newbcast:2 row_mask:0xa bank_mask:0xf
    v_mul_f32_dpp v31, v17, v31 row_newbcast:3 row_mask:0xa bank_mask:0xf
    v_mul_f32_dpp v32, v17, v32 row_newbcast:4 row_mask:0xa bank_mask:0xf
    v_mul_f32_dpp v33, v17, v33 row_newbcast:5 row_mask:0xa bank_mask:0xf
    v_mul_f32_dpp v34, v17, v34 row_newbcast:6 row_mask:0xa bank_mask:0xf
    v_mul_f32_dpp v35, v17, v35 row_newbcast:7 row_mask:0xa bank_mask:0xf
    v_cvt_pk_bf16_f32 v72, v28, v29
    v_cvt_pk_bf16_f32 v73, v30, v31
    v_cvt_pk_bf16_f32 v74, v32, v33
    v_cvt_pk_bf16_f32 v75, v34, v35
    s_waitcnt lgkmcnt(0)
    v_lshlrev_b32 v20, 16, v8
    v_and_b32 v21, 0xffff0000, v8
    v_lshlrev_b32 v22, 16, v9
    v_and_b32 v23, 0xffff0000, v9
    v_mul_f32_dpp v36, v18, v20 row_newbcast:8 row_mask:0xf bank_mask:0xf
    v_mul_f32_dpp v37, v18, v21 row_newbcast:9 row_mask:0xf bank_mask:0xf
    v_mul_f32_dpp v38, v18, v22 row_newbcast:10 row_mask:0xf bank_mask:0xf
    v_mul_f32_dpp v39, v18, v23 row_newbcast:11 row_mask:0xf bank_mask:0xf
    v_cvt_pk_bf16_f32 v84, v36, v37
    v_cvt_pk_bf16_f32 v85, v38, v39
    v_mul_f32_dpp v20, v18, v20 row_newbcast:0 row_mask:0xa bank_mask:0xf
    v_mul_f32_dpp v21, v18, v21 row_newbcast:1 row_mask:0xa bank_mask:0xf
    v_mul_f32_dpp v22, v18, v22 row_newbcast:2 row_mask:0xa bank_mask:0xf
    v_mul_f32_dpp v23, v18, v23 row_newbcast:3 row_mask:0xa bank_mask:0xf
    v_cvt_pk_bf16_f32 v80, v20, v21
    v_cvt_pk_bf16_f32 v81, v22, v23
    s_waitcnt vmcnt(4)
    v_mfma_f32_32x32x16_bf16 v[0:15], v[64:67], v[176:179], 0
    ds_read_b64_tr_b16 v[184:185], v246 offset:2048
    ds_read_b64_tr_b16 v[186:187], v246 offset:3072
    ds_read_b64_tr_b16 v[188:189], v247 offset:2048
    ds_read_b64_tr_b16 v[190:191], v247 offset:3072
    s_mov_b32 m0, s68
    v_mfma_f32_32x32x16_bf16 v[16:31], v[68:71], v[176:179], 0
    buffer_load_dwordx4 v224, s[4:7], s41 offen sc1 lds
    buffer_load_dwordx4 v225, s[72:75], s41 offen offset:1024 sc1 lds
    v_permlane32_swap_b32 v242, v236
    v_permlane32_swap_b32 v243, v237
    v_mov_b32 v254, 163296
    v_mfma_f32_32x32x16_bf16 v[32:47], v[64:67], v[180:183], 0
    v_permlane32_swap_b32 v244, v238
    v_permlane32_swap_b32 v245, v239
    v_permlane32_swap_b32 v240, v241
    v_add_f32 v242, v242, v236
    v_mfma_f32_32x32x16_bf16 v[48:63], v[68:71], v[180:183], 0
    v_add_f32 v243, v243, v237
    v_add_f32 v244, v244, v238
    v_add_f32 v245, v245, v239
    v_add_f32 v240, -v240, -v241
    v_sub_u32 v241, v230, v231
    v_cvt_pk_bf16_f32 v242, v242, v243
    v_mov_b32 v255, 1
    v_lshl_add_u32 v233, v252, 1, s53
    s_mov_b64 exec, 1
    ds_add_rtn_u32 v232, v254, v255
    s_mov_b64 exec, -1
    ds_read_b32 v233, v233
    s_waitcnt vmcnt(4) lgkmcnt(2)
    v_mfma_f32_32x32x16_bf16 v[0:15], v[72:75], v[184:187], v[0:15]
    ds_read_b64_tr_b16 v[176:177], v246 offset:4096
    ds_read_b64_tr_b16 v[180:181], v247 offset:4096
    v_cvt_pk_bf16_f32 v244, v244, v245
    v_cvt_pk_bf16_f32 v240, v240, v240
    ds_write_b32 v230, v242 offset:768
    ds_write_b32 v230, v244 offset:1024
    s_mov_b32 m0, s69
    v_mfma_f32_32x32x16_bf16 v[16:31], v[76:79], v[184:187], v[16:31]
    buffer_load_dwordx4 v226, s[4:7], s41 offen sc1 lds
    ds_write_b16 v241, v240 offset:1280
    s_waitcnt lgkmcnt(5)
    v_readfirstlane_b32 s58, v232
    v_mfma_f32_32x32x16_bf16 v[32:47], v[72:75], v[188:191], v[32:47]
    s_cmp_lt_u32 s58, s22
    s_cbranch_scc0 K2_nul_54
    s_nop 0
    v_readlane_b32 s58, v253, s58
    s_nop 0
    s_bfe_u32 s58, s58, 0x60016
    s_and_b32 s59, s58, 7
    s_lshr_b32 s60, s58, 3
K2_chk_56:
    v_readlane_b32 s61, v233, s59
    s_nop 0
    s_cmp_gt_u32 s61, s60
    s_cbranch_scc0 K2_spin_55
K2_back_57:
    v_mfma_f32_32x32x16_bf16 v[48:63], v[76:79], v[188:191], v[48:63]
    v_readlane_b32 s3, v253, s58
    s_lshl_b32 s44, s34, 7
    s_and_b32 s48, s3, 0x3ffff
    s_bfe_u32 s33, s3, 0x30013
    s_mov_b32 s35, s48
    s_mov_b32 s45, s44
    s_waitcnt vmcnt(3) lgkmcnt(3)
    v_mfma_f32_32x32x8_bf16 v[0:15], v[80:81], v[176:177], v[0:15]
    ds_read_b64_tr_b16 v[184:185], v246 offset:6144
    ds_read_b64_tr_b16 v[186:187], v246 offset:7168
    ds_read_b64_tr_b16 v[188:189], v247 offset:6144
    ds_read_b64_tr_b16 v[190:191], v247 offset:7168
    s_xor_b32 s47, s44, 256
    s_add_u32 s49, s48, 128
    s_mov_b32 m0, s70
    v_mfma_f32_32x32x8_bf16 v[16:31], v[84:85], v[176:177], v[16:31]
    buffer_load_dwordx4 v222, s[4:7], s42 offen sc1 lds
    buffer_load_dwordx4 v223, s[72:75], s42 offen offset:1024 sc1 lds
    s_add_u32 s60, s48, 256
    s_cmp_eq_u32 s33, 3
    s_cselect_b32 s46, s44, s47
    s_cselect_b32 s50, s60, s48
    s_cselect_b32 s51, s48, s49
    v_mfma_f32_32x32x8_bf16 v[32:47], v[80:81], v[180:181], v[32:47]
    s_sub_u32 s60, s33, 2
    s_cmp_lt_u32 s60, 2
    s_cbranch_scc0 K2_rare_58
K2_back_59:
    v_mul_f32 v234, v0, v96
    v_mul_f32 v236, v8, v128
    v_fmac_f32 v234, v1, v97
    v_fmac_f32 v236, v9, v129
    v_mfma_f32_32x32x8_bf16 v[48:63], v[84:85], v[180:181], v[48:63]
    s_setprio 0
    v_fmac_f32 v234, v2, v98
    v_fmac_f32 v236, v10, v130
    v_fmac_f32 v234, v3, v99
    v_fmac_f32 v236, v11, v131
    v_fmac_f32 v234, v4, v100
    v_fmac_f32 v236, v12, v132
    v_fmac_f32 v234, v5, v101
    v_fmac_f32 v236, v13, v133
    v_fmac_f32 v234, v6, v102
    v_fmac_f32 v236, v14, v134
    v_fmac_f32 v234, v7, v103
    v_fmac_f32 v236, v15, v135
    v_mul_f32 v238, v16, v128
    v_mul_f32 v240, v24, v128
    v_fmac_f32 v238, v17, v129
    v_fmac_f32 v240, v25, v129
    v_fmac_f32 v238, v18, v130
    v_fmac_f32 v240, v26, v130
    v_fmac_f32 v238, v19, v131
    v_fmac_f32 v240, v27, v131
    v_fmac_f32 v238, v20, v132
    v_fmac_f32 v240, v28, v132
    v_fmac_f32 v238, v21, v133
    v_fmac_f32 v240, v29, v133
    v_fmac_f32 v238, v22, v134
    v_fmac_f32 v240, v30, v134
    v_fmac_f32 v238, v23, v135
    v_fmac_f32 v240, v31, v135
    v_mul_f32 v235, v32, v104
    v_mul_f32 v237, v40, v136
    v_fmac_f32 v235, v33, v105
    v_fmac_f32 v237, v41, v137
    v_fmac_f32 v235, v34, v106
    v_fmac_f32 v237, v42, v138
    v_fmac_f32 v235, v35, v107
    v_fmac_f32 v237, v43, v139
    v_fmac_f32 v235, v36, v108
    v_fmac_f32 v237, v44, v140
    v_fmac_f32 v235, v37, v109
    v_fmac_f32 v237, v45, v141
    v_fmac_f32 v235, v38, v110
    v_fmac_f32 v237, v46, v142
    v_fmac_f32 v235, v39, v111
    v_fmac_f32 v237, v47, v143
    v_mul_f32 v239, v48, v136
    v_mul_f32 v241, v56, v136
    s_setprio 1
    s_waitcnt vmcnt(3) lgkmcnt(0)
    v_mfma_f32_32x32x16_bf16 v[0:15], v[64:67], v[184:187], 0
    ds_read_b64_tr_b16 v[176:177], v246 offset:0
    ds_read_b64_tr_b16 v[178:179], v246 offset:1024
    ds_read_b64_tr_b16 v[180:181], v247 offset:0
    ds_read_b64_tr_b16 v[182:183], v247 offset:1024
    v_fmac_f32 v239, v49, v137
    v_fmac_f32 v241, v57, v137
    s_mov_b32 m0, s71
    v_mfma_f32_32x32x16_bf16 v[16:31], v[68:71], v[184:187], 0
    buffer_load_dwordx4 v224, s[4:7], s42 offen sc1 lds
    buffer_load_dwordx4 v225, s[72:75], s42 offen offset:1024 sc1 lds
    v_fmac_f32 v239, v50, v138
    v_fmac_f32 v241, v58, v138
    v_fmac_f32 v239, v51, v139
    v_fmac_f32 v241, v59, v139
    v_fmac_f32 v239, v52, v140
    v_mfma_f32_32x32x16_bf16 v[32:47], v[64:67], v[188:191], 0
    v_fmac_f32 v241, v60, v140
    v_fmac_f32 v239, v53, v141
    v_fmac_f32 v241, v61, v141
    v_fmac_f32 v239, v54, v142
    v_fmac_f32 v241, v62, v142
    v_fmac_f32 v239, v55, v143
    v_fmac_f32 v241, v63, v143
    v_mfma_f32_32x32x16_bf16 v[48:63], v[68:71], v[188:191], 0
    v_permlane32_swap_b32 v234, v236
    v_permlane32_swap_b32 v235, v237
    v_permlane32_swap_b32 v240, v238
    s_waitcnt vmcnt(4) lgkmcnt(0)
    v_mfma_f32_32x32x16_bf16 v[0:15], v[72:75], v[176:179], v[0:15]
    ds_read_b64_tr_b16 v[184:185], v246 offset:2048
    ds_read_b64_tr_b16 v[188:189], v247 offset:2048
    v_permlane32_swap_b32 v241, v239
    v_lshl_add_u32 v230, v252, 1, s31
    v_add_f32 v234, v234, v236
    s_mov_b32 m0, s68
    v_mfma_f32_32x32x16_bf16 v[16:31], v[76:79], v[176:179], v[16:31]
    buffer_load_dwordx4 v226, s[4:7], s42 offen sc1 lds
    v_add_f32 v235, v235, v237
    v_add_f32 v240, v240, v238
    v_add_f32 v241, v241, v239
    v_cvt_pk_bf16_f32 v234, v234, v235
    v_cvt_pk_bf16_f32 v240, v240, v241
    ds_write_b32 v230, v234 offset:0
    v_mfma_f32_32x32x16_bf16 v[32:47], v[72:75], v[180:183], v[32:47]
    ds_write_b32 v230, v240 offset:256
    v_mfma_f32_32x32x16_bf16 v[48:63], v[76:79], v[180:183], v[48:63]
    s_waitcnt vmcnt(3) lgkmcnt(2)
    v_mfma_f32_32x32x8_bf16 v[0:15], v[80:81], v[184:185], v[0:15]
    ds_read_b64_tr_b16 v[176:177], v246 offset:4096
    ds_read_b64_tr_b16 v[178:179], v246 offset:5120
    ds_read_b64_tr_b16 v[180:181], v247 offset:4096
    ds_read_b64_tr_b16 v[182:183], v247 offset:5120
    s_mov_b32 m0, s69
    v_mfma_f32_32x32x8_bf16 v[16:31], v[84:85], v[184:185], v[16:31]
    buffer_load_dwordx4 v222, s[4:7], s43 offen sc1 lds
    buffer_load_dwordx4 v223, s[72:75], s43 offen offset:1024 sc1 lds
    v_mfma_f32_32x32x8_bf16 v[32:47], v[80:81], v[188:189], v[32:47]
    s_nop 2
    v_mul_f32 v234, v0, v144
    v_mul_f32 v236, v8, v112
    v_fmac_f32 v234, v1, v145
    v_fmac_f32 v236, v9, v113
    v_fmac_f32 v234, v2, v146
    v_fmac_f32 v236, v10, v114
    v_fmac_f32 v234, v3, v147
    v_mfma_f32_32x32x8_bf16 v[48:63], v[84:85], v[188:189], v[48:63]
    s_setprio 0
    v_fmac_f32 v236, v11, v115
    v_fmac_f32 v234, v4, v148
    v_fmac_f32 v236, v12, v116
    v_fmac_f32 v234, v5, v149
    v_fmac_f32 v236, v13, v117
    v_fmac_f32 v234, v6, v150
    v_fmac_f32 v236, v14, v118
    v_fmac_f32 v234, v7, v151
    v_fmac_f32 v236, v15, v119
    v_mul_f32 v238, v16, v160
    v_mul_f32 v240, v24, v160
    v_fmac_f32 v238, v17, v161
    v_fmac_f32 v240, v25, v161
    v_fmac_f32 v238, v18, v162
    v_fmac_f32 v240, v26, v162
    v_fmac_f32 v238, v19, v163
    v_fmac_f32 v240, v27, v163
    v_fmac_f32 v238, v20, v164
    v_fmac_f32 v240, v28, v164
    v_fmac_f32 v238, v21, v165
    v_fmac_f32 v240, v29, v165
    v_fmac_f32 v238, v22, v166
    v_fmac_f32 v240, v30, v166
    v_fmac_f32 v238, v23, v167
    v_fmac_f32 v240, v31, v167
    v_mul_f32 v235, v32, v152
    v_mul_f32 v237, v40, v120
    v_fmac_f32 v235, v33, v153
    v_fmac_f32 v237, v41, v121
    v_fmac_f32 v235, v34, v154
    v_fmac_f32 v237, v42, v122
    v_fmac_f32 v235, v35, v155
    v_fmac_f32 v237, v43, v123
    v_fmac_f32 v235, v36, v156
    v_fmac_f32 v237, v44, v124
    v_fmac_f32 v235, v37, v157
    v_fmac_f32 v237, v45, v125
    v_fmac_f32 v235, v38, v158
    v_fmac_f32 v237, v46, v126
    v_fmac_f32 v235, v39, v159
    v_fmac_f32 v237, v47, v127
    v_mul_f32 v239, v48, v168
    v_mul_f32 v241, v56, v168
    v_fmac_f32 v239, v49, v169
    v_fmac_f32 v241, v57, v169
    s_setprio 1
    s_waitcnt vmcnt(3) lgkmcnt(0)
    v_mfma_f32_32x32x16_bf16 v[0:15], v[64:67], v[176:179], 0
    ds_read_b64_tr_b16 v[184:185], v246 offset:6144
    ds_read_b64_tr_b16 v[186:187], v246 offset:7168
    ds_read_b64_tr_b16 v[188:189], v247 offset:6144
    ds_read_b64_tr_b16 v[190:191], v247 offset:7168
    v_fmac_f32 v239, v50, v170
    v_fmac_f32 v241, v58, v170
    s_mov_b32 m0, s70
    v_mfma_f32_32x32x16_bf16 v[16:31], v[68:71], v[176:179], 0
    buffer_load_dwordx4 v224, s[4:7], s43 offen sc1 lds
    buffer_load_dwordx4 v225, s[72:75], s43 offen offset:1024 sc1 lds
    v_fmac_f32 v239, v51, v171
    v_fmac_f32 v241, v59, v171
    v_fmac_f32 v239, v52, v172
    v_fmac_f32 v241, v60, v172
    v_fmac_f32 v239, v53, v173
    v_mfma_f32_32x32x16_bf16 v[32:47], v[64:67], v[180:183], 0
    v_add_u32 v222, s48, v251
    ds_read2_b32 v[222:223], v222 offset0:1 offset1:3
    v_fmac_f32 v241, v61, v173
    v_fmac_f32 v239, v54, v174
    v_fmac_f32 v241, v62, v174
    v_fmac_f32 v239, v55, v175
    v_fmac_f32 v241, v63, v175
    v_mfma_f32_32x32x16_bf16 v[48:63], v[68:71], v[180:183], 0
    s_waitcnt vmcnt(4) lgkmcnt(1)
    v_mfma_f32_32x32x16_bf16 v[0:15], v[72:75], v[184:187], v[0:15]
    ds_read_b64_tr_b16 v[176:177], v246 offset:0
    ds_read_b64_tr_b16 v[180:181], v247 offset:0
    s_mov_b32 m0, s71
    v_mfma_f32_32x32x16_bf16 v[16:31], v[76:79], v[184:187], v[16:31]
    buffer_load_dwordx4 v226, s[4:7], s43 offen sc1 lds
    s_waitcnt lgkmcnt(2)
    v_mad_u32_u16 v222, v222, s39, v248 op_sel:[1,0,0,0]
    v_mad_u32_u16 v223, v223, s39, v248 op_sel:[1,0,0,0]
    v_mfma_f32_32x32x16_bf16 v[32:47], v[72:75], v[188:191], v[32:47]
    v_add_u32 v224, s49, v251
    ds_read2_b32 v[224:225], v224 offset0:1 offset1:3
    v_mfma_f32_32x32x16_bf16 v[48:63], v[76:79], v[188:191], v[48:63]
    s_waitcnt vmcnt(3) lgkmcnt(1)
    v_mfma_f32_32x32x8_bf16 v[0:15], v[80:81], v[176:177], v[0:15]
    ds_read_b64_tr_b16 v[184:185], v246 offset:2048
    ds_read_b64_tr_b16 v[186:187], v246 offset:3072
    ds_read_b64_tr_b16 v[188:189], v247 offset:2048
    ds_read_b64_tr_b16 v[190:191], v247 offset:3072
    s_mov_b32 m0, s68
    v_mfma_f32_32x32x8_bf16 v[16:31], v[84:85], v[176:177], v[16:31]
    buffer_load_dwordx4 v222, s[4:7], s44 offen sc1 lds
    buffer_load_dwordx4 v223, s[72:75], s44 offen offset:1024 sc1 lds
    s_waitcnt lgkmcnt(4)
    v_mad_u32_u16 v224, v224, s39, v248 op_sel:[1,0,0,0]
    v_mad_u32_u16 v225, v225, s39, v248 op_sel:[1,0,0,0]
    v_mfma_f32_32x32x8_bf16 v[32:47], v[80:81], v[180:181], v[32:47]
    v_add_u32 v226, s50, v251
    ds_read2_b32 v[226:227], v226 offset0:1 offset1:3
    v_mul_f32 v242, v0, v144
    v_fma_f32 v238, v8, v160, -v238
    v_fmac_f32 v242, v1, v145
    v_fmac_f32 v238, v9, v161
    v_fmac_f32 v242, v2, v146
    v_mfma_f32_32x32x8_bf16 v[48:63], v[84:85], v[180:181], v[48:63]
    s_setprio 0
    v_fmac_f32 v238, v10, v162
    v_fmac_f32 v242, v3, v147
    v_fmac_f32 v238, v11, v163
    v_fmac_f32 v242, v4, v148
    v_fmac_f32 v238, v12, v164
    v_fmac_f32 v242, v5, v149
    v_fmac_f32 v238, v13, v165
    v_fmac_f32 v242, v6, v150
    v_fmac_f32 v238, v14, v166
    v_fmac_f32 v242, v7, v151
    v_fmac_f32 v238, v15, v167
    v_fmac_f32 v236, v16, v112
    v_mul_f32 v244, v24, v160
    v_fmac_f32 v236, v17, v113
    v_fmac_f32 v244, v25, v161
    v_fmac_f32 v236, v18, v114
    v_fmac_f32 v244, v26, v162
    v_fmac_f32 v236, v19, v115
    v_fmac_f32 v244, v27, v163
    v_fmac_f32 v236, v20, v116
    v_fmac_f32 v244, v28, v164
    v_fmac_f32 v236, v21, v117
    v_fmac_f32 v244, v29, v165
    v_fmac_f32 v236, v22, v118
    v_fmac_f32 v244, v30, v166
    v_fmac_f32 v236, v23, v119
    v_fmac_f32 v244, v31, v167
    v_mul_f32 v243, v32, v152
    v_fma_f32 v239, v40, v168, -v239
    v_fmac_f32 v243, v33, v153
    v_fmac_f32 v239, v41, v169
    v_fmac_f32 v243, v34, v154
    v_fmac_f32 v239, v42, v170
    v_fmac_f32 v243, v35, v155
    v_fmac_f32 v239, v43, v171
    v_fmac_f32 v243, v36, v156
    v_fmac_f32 v239, v44, v172
    v_fmac_f32 v243, v37, v157
    v_fmac_f32 v239, v45, v173
    v_fmac_f32 v243, v38, v158
    v_fmac_f32 v239, v46, v174
    v_fmac_f32 v243, v39, v159
    v_fmac_f32 v239, v47, v175
    v_fmac_f32 v237, v48, v120
    v_mul_f32 v245, v56, v168
    v_fmac_f32 v237, v49, v121
    v_fmac_f32 v245, v57, v169
    v_fmac_f32 v237, v50, v122
    v_fmac_f32 v245, v58, v170
    v_fmac_f32 v237, v51, v123
    s_setprio 1
    s_waitcnt vmcnt(3) lgkmcnt(1)
    v_mfma_f32_32x32x16_bf16 v[0:15], v[64:67], v[184:187], 0
    ds_read_b64_tr_b16 v[176:177], v246 offset:4096
    ds_read_b64_tr_b16 v[178:179], v246 offset:5120
    ds_read_b64_tr_b16 v[180:181], v247 offset:4096
    ds_read_b64_tr_b16 v[182:183], v247 offset:5120
    v_fmac_f32 v245, v59, v171
    v_fmac_f32 v237, v52, v124
    s_mov_b32 m0, s69
    v_mfma_f32_32x32x16_bf16 v[16:31], v[68:71], v[184:187], 0
    buffer_load_dwordx4 v224, s[4:7], s45 offen sc1 lds
    buffer_load_dwordx4 v225, s[72:75], s45 offen offset:1024 sc1 lds
    s_waitcnt lgkmcnt(4)
    v_mad_u32_u16 v226, v226, s39, v248 op_sel:[1,0,0,0]
    v_mad_u32_u16 v227, v227, s39, v248 op_sel:[1,0,0,0]
    v_fmac_f32 v245, v60, v172
    v_fmac_f32 v237, v53, v125
    v_mfma_f32_32x32x16_bf16 v[32:47], v[64:67], v[188:191], 0
    v_add_u32 v228, s51, v251
    ds_read2_b32 v[228:229], v228 offset0:1 offset1:3
    v_fmac_f32 v245, v61, v173
    v_fmac_f32 v237, v54, v126
    v_fmac_f32 v245, v62, v174
    v_fmac_f32 v237, v55, v127
    v_fmac_f32 v245, v63, v175
    v_mfma_f32_32x32x16_bf16 v[48:63], v[68:71], v[188:191], 0
    v_permlane32_swap_b32 v242, v234
    v_permlane32_swap_b32 v243, v235
    v_add_f32 v242, v242, v234
    v_add_f32 v243, v243, v235
    s_waitcnt vmcnt(4) lgkmcnt(1)
    v_mfma_f32_32x32x16_bf16 v[0:15], v[72:75], v[176:179], v[0:15]
    ds_read_b64_tr_b16 v[184:185], v246 offset:6144
    ds_read_b64_tr_b16 v[188:189], v247 offset:6144
    v_cvt_pk_bf16_f32 v242, v242, v243
    ds_write_b32 v230, v242 offset:512
    s_mov_b32 s32, s31
    s_mov_b32 s31, s35
    s_mov_b32 m0, s70
    v_mfma_f32_32x32x16_bf16 v[16:31], v[76:79], v[176:179], v[16:31]
    buffer_load_dwordx4 v226, s[4:7], s46 offen sc1 lds
    buffer_load_dwordx4 v227, s[72:75], s46 offen offset:1024 sc1 lds
    s_waitcnt lgkmcnt(3)
    v_mad_u32_u16 v228, v228, s39, v248 op_sel:[1,0,0,0]
    v_mad_u32_u16 v229, v229, s39, v248 op_sel:[1,0,0,0]
    s_sub_u32 s26, s48, s29
    s_mov_b32 s29, s48
    v_mfma_f32_32x32x16_bf16 v[32:47], v[72:75], v[180:183], v[32:47]
    s_mov_b32 s30, s3
    s_bfe_u32 s56, s3, 0x40012
    s_cmp_lg_u32 s36, 0
    s_cselect_b32 s56, s56, 0
    v_mfma_f32_32x32x16_bf16 v[48:63], v[76:79], v[180:183], v[48:63]
    s_waitcnt vmcnt(4) lgkmcnt(1)
    v_mfma_f32_32x32x8_bf16 v[0:15], v[80:81], v[184:185], v[0:15]
    ds_read_b64_tr_b16 v[176:177], v246 offset:0
    ds_read_b64_tr_b16 v[178:179], v246 offset:1024
    ds_read_b64_tr_b16 v[180:181], v247 offset:0
    ds_read_b64_tr_b16 v[182:183], v247 offset:1024
    s_mov_b32 m0, s71
    v_mfma_f32_32x32x8_bf16 v[16:31], v[84:85], v[184:185], v[16:31]
    buffer_load_dwordx4 v228, s[4:7], s47 offen sc1 lds
    buffer_load_dwordx4 v229, s[72:75], s47 offen offset:1024 sc1 lds
    v_mfma_f32_32x32x8_bf16 v[32:47], v[80:81], v[188:189], v[32:47]
    s_nop 2
    v_mul_f32 v242, v0, v144
    v_fma_f32 v240, v8, v160, -v240
    v_fmac_f32 v242, v1, v145
    v_fmac_f32 v240, v9, v161
    v_fmac_f32 v242, v2, v146
    v_fmac_f32 v240, v10, v162
    v_fmac_f32 v242, v3, v147
    v_mfma_f32_32x32x8_bf16 v[48:63], v[84:85], v[188:189], v[48:63]
    s_setprio 0
    v_fmac_f32 v240, v11, v163
    v_fmac_f32 v242, v4, v148
    v_fmac_f32 v240, v12, v164
    v_fmac_f32 v242, v5, v149
    v_fmac_f32 v240, v13, v165
    v_fmac_f32 v242, v6, v150
    v_fmac_f32 v240, v14, v166
    v_fmac_f32 v242, v7, v151
    v_fmac_f32 v240, v15, v167
    v_add_u32 v249, s26, v249
    v_add_u32 v250, s26, v250
    v_fma_f32 v244, v16, v160, -v244
    v_fmac_f32 v236, v24, v112
    v_fmac_f32 v244, v17, v161
    v_fmac_f32 v236, v25, v113
    v_fmac_f32 v244, v18, v162
    v_fmac_f32 v236, v26, v114
    v_fmac_f32 v244, v19, v163
    v_fmac_f32 v236, v27, v115
    v_fmac_f32 v244, v20, v164
    v_fmac_f32 v236, v28, v116
    v_fmac_f32 v244, v21, v165
    v_fmac_f32 v236, v29, v117
    v_fmac_f32 v244, v22, v166
    v_fmac_f32 v236, v30, v118
    v_fmac_f32 v244, v23, v167
    v_fmac_f32 v236, v31, v119
    ds_read_b64_tr_b16 v[0:1], v249 offset:0
    ds_read_b64_tr_b16 v[2:3], v249 offset:32
    ds_read_u16_d16_hi v16, v250 offset:0
    v_mul_f32 v243, v32, v152
    v_fma_f32 v241, v40, v168, -v241
    v_fmac_f32 v243, v33, v153
    v_fmac_f32 v241, v41, v169
    v_fmac_f32 v243, v34, v154
    v_fmac_f32 v241, v42, v170
    v_fmac_f32 v243, v35, v155
    v_fmac_f32 v241, v43, v171
    v_fmac_f32 v243, v36, v156
    v_fmac_f32 v241, v44, v172
    v_fmac_f32 v243, v37, v157
    v_fmac_f32 v241, v45, v173
    v_fmac_f32 v243, v38, v158
    v_fmac_f32 v241, v46, v174
    v_fmac_f32 v243, v39, v159
    v_fmac_f32 v241, v47, v175
    ds_read_b64_tr_b16 v[4:5], v249 offset:512
    ds_read_b64_tr_b16 v[6:7], v249 offset:544
    ds_read_u16_d16_hi v17, v250 offset:128
    v_fma_f32 v245, v48, v168, -v245
    v_fmac_f32 v237, v56, v120
    v_fmac_f32 v245, v49, v169
    v_fmac_f32 v237, v57, v121
    v_fmac_f32 v245, v50, v170
    v_fmac_f32 v237, v58, v122
    v_fmac_f32 v245, v51, v171
    v_fmac_f32 v237, v59, v123
    v_fmac_f32 v245, v52, v172
    v_fmac_f32 v237, v60, v124
    v_fmac_f32 v245, v53, v173
    v_fmac_f32 v237, v61, v125
    v_fmac_f32 v245, v54, v174
    v_fmac_f32 v237, v62, v126
    v_fmac_f32 v245, v55, v175
    v_fmac_f32 v237, v63, v127
    s_cmp_eq_u32 s56, 5
    s_cbranch_scc1 K2_U21
    s_cmp_eq_u32 s56, 6
    s_cbranch_scc1 K2_U3h1
    s_branch K2_DSP1
K2_U31:
    s_setprio 1
    ds_read_b64_tr_b16 v[8:9], v249 offset:1024
    ds_read_b64_tr_b16 v[10:11], v249 offset:1056
    ds_read_u16_d16_hi v18, v250 offset:256
    s_waitcnt lgkmcnt(3)
    v_lshlrev_b32 v20, 16, v0
    v_and_b32 v21, 0xffff0000, v0
    v_lshlrev_b32 v22, 16, v1
    v_and_b32 v23, 0xffff0000, v1
    v_lshlrev_b32 v24, 16, v2
    v_and_b32 v25, 0xffff0000, v2
    v_lshlrev_b32 v26, 16, v3
    v_and_b32 v27, 0xffff0000, v3
    v_mul_f32_dpp v36, v16, v20 row_newbcast:8 row_mask:0xf bank_mask:0xf
    v_mul_f32_dpp v37, v16, v21 row_newbcast:9 row_mask:0xf bank_mask:0xf
    v_mul_f32_dpp v38, v16, v22 row_newbcast:10 row_mask:0xf bank_mask:0xf
    v_mul_f32_dpp v39, v16, v23 row_newbcast:11 row_mask:0xf bank_mask:0xf
    v_mul_f32_dpp v40, v16, v24 row_newbcast:12 row_mask:0xf bank_mask:0xf
    v_mul_f32_dpp v41, v16, v25 row_newbcast:13 row_mask:0xf bank_mask:0xf
    v_mul_f32_dpp v42, v16, v26 row_newbcast:14 row_mask:0xf bank_mask:0xf
    v_mul_f32_dpp v43, v16, v27 row_newbcast:15 row_mask:0xf bank_mask:0xf
    v_cvt_pk_bf16_f32 v68, v36, v37
    v_cvt_pk_bf16_f32 v69, v38, v39
    v_cvt_pk_bf16_f32 v70, v40, v41
    v_cvt_pk_bf16_f32 v71, v42, v43
    v_mul_f32_dpp v20, v16, v20 row_newbcast:0 row_mask:0xa bank_mask:0xf
    v_mul_f32_dpp v21, v16, v21 row_newbcast:1 row_mask:0xa bank_mask:0xf
    v_mul_f32_dpp v22, v16, v22 row_newbcast:2 row_mask:0xa bank_mask:0xf
    v_mul_f32_dpp v23, v16, v23 row_newbcast:3 row_mask:0xa bank_mask:0xf
    v_mul_f32_dpp v24, v16, v24 row_newbcast:4 row_mask:0xa bank_mask:0xf
    v_mul_f32_dpp v25, v16, v25 row_newbcast:5 row_mask:0xa bank_mask:0xf
    v_mul_f32_dpp v26, v16, v26 row_newbcast:6 row_mask:0xa bank_mask:0xf
    v_mul_f32_dpp v27, v16, v27 row_newbcast:7 row_mask:0xa bank_mask:0xf
    v_cvt_pk_bf16_f32 v64, v20, v21
    v_cvt_pk_bf16_f32 v65, v22, v23
    v_cvt_pk_bf16_f32 v66, v24, v25
    v_cvt_pk_bf16_f32 v67, v26, v27
    v_lshlrev_b32 v28, 16, v4
    v_and_b32 v29, 0xffff0000, v4
    v_lshlrev_b32 v30, 16, v5
    v_and_b32 v31, 0xffff0000, v5
    v_lshlrev_b32 v32, 16, v6
    v_and_b32 v33, 0xffff0000, v6
    v_lshlrev_b32 v34, 16, v7
    v_and_b32 v35, 0xffff0000, v7
    v_mul_f32_dpp v36, v17, v28 row_newbcast:8 row_mask:0xf bank_mask:0xf
    v_mul_f32_dpp v37, v17, v29 row_newbcast:9 row_mask:0xf bank_mask:0xf
    v_mul_f32_dpp v38, v17, v30 row_newbcast:10 row_mask:0xf bank_mask:0xf
    v_mul_f32_dpp v39, v17, v31 row_newbcast:11 row_mask:0xf bank_mask:0xf
    v_mul_f32_dpp v40, v17, v32 row_newbcast:12 row_mask:0xf bank_mask:0xf
    v_mul_f32_dpp v41, v17, v33 row_newbcast:13 row_mask:0xf bank_mask:0xf
    v_mul_f32_dpp v42, v17, v34 row_newbcast:14 row_mask:0xf bank_mask:0xf
    v_mul_f32_dpp v43, v17, v35 row_newbcast:15 row_mask:0xf bank_mask:0xf
    v_cvt_pk_bf16_f32 v76, v36, v37
    v_cvt_pk_bf16_f32 v77, v38, v39
    v_cvt_pk_bf16_f32 v78, v40, v41
    v_cvt_pk_bf16_f32 v79, v42, v43
    v_mul_f32_dpp v28, v17, v28 row_newbcast:0 row_mask:0xa bank_mask:0xf
    v_mul_f32_dpp v29, v17, v29 row_newbcast:1 row_mask:0xa bank_mask:0xf
    v_mul_f32_dpp v30, v17, v30 row_newbcast:2 row_mask:0xa bank_mask:0xf
    v_mul_f32_dpp v31, v17, v31 row_newbcast:3 row_mask:0xa bank_mask:0xf
    v_mul_f32_dpp v32, v17, v32 row_newbcast:4 row_mask:0xa bank_mask:0xf
    v_mul_f32_dpp v33, v17, v33 row_newbcast:5 row_mask:0xa bank_mask:0xf
    v_mul_f32_dpp v34, v17, v34 row_newbcast:6 row_mask:0xa bank_mask:0xf
    v_mul_f32_dpp v35, v17, v35 row_newbcast:7 row_mask:0xa bank_mask:0xf
    v_cvt_pk_bf16_f32 v72, v28, v29
    v_cvt_pk_bf16_f32 v73, v30, v31
    v_cvt_pk_bf16_f32 v74, v32, v33
    v_cvt_pk_bf16_f32 v75, v34, v35
    s_waitcnt lgkmcnt(0)
    v_lshlrev_b32 v20, 16, v8
    v_and_b32 v21, 0xffff0000, v8
    v_lshlrev_b32 v22, 16, v9
    v_and_b32 v23, 0xffff0000, v9
    v_lshlrev_b32 v24, 16, v10
    v_and_b32 v25, 0xffff0000, v10
    v_lshlrev_b32 v26, 16, v11
    v_and_b32 v27, 0xffff0000, v11
    v_mul_f32_dpp v36, v18, v20 row_newbcast:8 row_mask:0xf bank_mask:0xf
    v_mul_f32_dpp v37, v18, v21 row_newbcast:9 row_mask:0xf bank_mask:0xf
    v_mul_f32_dpp v38, v18, v22 row_newbcast:10 row_mask:0xf bank_mask:0xf
    v_mul_f32_dpp v39, v18, v23 row_newbcast:11 row_mask:0xf bank_mask:0xf
    v_mul_f32_dpp v40, v18, v24 row_newbcast:12 row_mask:0xf bank_mask:0xf
    v_mul_f32_dpp v41, v18, v25 row_newbcast:13 row_mask:0xf bank_mask:0xf
    v_mul_f32_dpp v42, v18, v26 row_newbcast:14 row_mask:0xf bank_mask:0xf
    v_mul_f32_dpp v43, v18, v27 row_newbcast:15 row_mask:0xf bank_mask:0xf
    v_cvt_pk_bf16_f32 v84, v36, v37
    v_cvt_pk_bf16_f32 v85, v38, v39
    v_cvt_pk_bf16_f32 v86, v40, v41
    v_cvt_pk_bf16_f32 v87, v42, v43
    v_mul_f32_dpp v20, v18, v20 row_newbcast:0 row_mask:0xa bank_mask:0xf
    v_mul_f32_dpp v21, v18, v21 row_newbcast:1 row_mask:0xa bank_mask:0xf
    v_mul_f32_dpp v22, v18, v22 row_newbcast:2 row_mask:0xa bank_mask:0xf
    v_mul_f32_dpp v23, v18, v23 row_newbcast:3 row_mask:0xa bank_mask:0xf
    v_mul_f32_dpp v24, v18, v24 row_newbcast:4 row_mask:0xa bank_mask:0xf
    v_mul_f32_dpp v25, v18, v25 row_newbcast:5 row_mask:0xa bank_mask:0xf
    v_mul_f32_dpp v26, v18, v26 row_newbcast:6 row_mask:0xa bank_mask:0xf
    v_mul_f32_dpp v27, v18, v27 row_newbcast:7 row_mask:0xa bank_mask:0xf
    v_cvt_pk_bf16_f32 v80, v20, v21
    v_cvt_pk_bf16_f32 v81, v22, v23
    v_cvt_pk_bf16_f32 v82, v24, v25
    v_cvt_pk_bf16_f32 v83, v26, v27
    s_waitcnt vmcnt(4)
    v_mfma_f32_32x32x16_bf16 v[0:15], v[64:67], v[176:179], 0
    ds_read_b64_tr_b16 v[184:185], v246 offset:2048
    ds_read_b64_tr_b16 v[186:187], v246 offset:3072
    ds_read_b64_tr_b16 v[188:189], v247 offset:2048
    ds_read_b64_tr_b16 v[190:191], v247 offset:3072
    s_mov_b32 m0, s68
    v_mfma_f32_32x32x16_bf16 v[16:31], v[68:71], v[176:179], 0
    buffer_load_dwordx4 v224, s[4:7], s41 offen sc1 lds
    buffer_load_dwordx4 v225, s[72:75], s41 offen offset:1024 sc1 lds
    v_permlane32_swap_b32 v242, v236
    v_permlane32_swap_b32 v243, v237
    v_mov_b32 v254, 163296
    v_mfma_f32_32x32x16_bf16 v[32:47], v[64:67], v[180:183], 0
    v_permlane32_swap_b32 v244, v238
    v_permlane32_swap_b32 v245, v239
    v_permlane32_swap_b32 v240, v241
    v_add_f32 v242, v242, v236
    v_mfma_f32_32x32x16_bf16 v[48:63], v[68:71], v[180:183], 0
    v_add_f32 v243, v243, v237
    v_add_f32 v244, v244, v238
    v_add_f32 v245, v245, v239
    v_add_f32 v240, -v240, -v241
    v_sub_u32 v241, v230, v231
    v_cvt_pk_bf16_f32 v242, v242, v243
    v_mov_b32 v255, 1
    v_lshl_add_u32 v233, v252, 1, s53
    s_mov_b64 exec, 1
    ds_add_rtn_u32 v232, v254, v255
    s_mov_b64 exec, -1
    ds_read_b32 v233, v233
    s_waitcnt vmcnt(4) lgkmcnt(2)
    v_mfma_f32_32x32x16_bf16 v[0:15], v[72:75], v[184:187], v[0:15]
    ds_read_b64_tr_b16 v[176:177], v246 offset:4096
    ds_read_b64_tr_b16 v[178:179], v246 offset:5120
    ds_read_b64_tr_b16 v[180:181], v247 offset:4096
    ds_read_b64_tr_b16 v[182:183], v247 offset:5120
    v_cvt_pk_bf16_f32 v244, v244, v245
    v_cvt_pk_bf16_f32 v240, v240, v240
    s_mov_b32 m0, s69
    v_mfma_f32_32x32x16_bf16 v[16:31], v[76:79], v[184:187], v[16:31]
    buffer_load_dwordx4 v226, s[4:7], s41 offen sc1 lds
    buffer_load_dwordx4 v227, s[72:75], s41 offen offset:1024 sc1 lds
    ds_write_b32 v230, v242 offset:768
    ds_write_b32 v230, v244 offset:1024
    ds_write_b16 v241, v240 offset:1280
    s_waitcnt lgkmcnt(7)
    v_readfirstlane_b32 s58, v232
    v_mfma_f32_32x32x16_bf16 v[32:47], v[72:75], v[188:191], v[32:47]
    s_cmp_lt_u32 s58, s22
    s_cbranch_scc0 K2_nul_61
    s_nop 0
    v_readlane_b32 s58, v253, s58
    s_nop 0
    s_bfe_u32 s58, s58, 0x60016
    s_and_b32 s59, s58, 7
    s_lshr_b32 s60, s58, 3
K2_chk_63:
    v_readlane_b32 s61, v233, s59
    s_nop 0
    s_cmp_gt_u32 s61, s60
    s_cbranch_scc0 K2_spin_62
K2_back_64:
    v_mfma_f32_32x32x16_bf16 v[48:63], v[76:79], v[188:191], v[48:63]
    v_readlane_b32 s3, v253, s58
    s_lshl_b32 s44, s34, 7
    s_and_b32 s48, s3, 0x3ffff
    s_bfe_u32 s33, s3, 0x30013
    s_mov_b32 s35, s48
    s_mov_b32 s45, s44
    s_waitcnt vmcnt(4) lgkmcnt(3)
    v_mfma_f32_32x32x16_bf16 v[0:15], v[80:83], v[176:179], v[0:15]
    ds_read_b64_tr_b16 v[184:185], v246 offset:6144
    ds_read_b64_tr_b16 v[186:187], v246 offset:7168
    ds_read_b64_tr_b16 v[188:189], v247 offset:6144
    ds_read_b64_tr_b16 v[190:191], v247 offset:7168
    s_xor_b32 s47, s44, 256
    s_add_u32 s49, s48, 128
    s_mov_b32 m0, s70
    v_mfma_f32_32x32x16_bf16 v[16:31], v[84:87], v[176:179], v[16:31]
    buffer_load_dwordx4 v222, s[4:7], s42 offen sc1 lds
    buffer_load_dwordx4 v223, s[72:75], s42 offen offset:1024 sc1 lds
    s_add_u32 s60, s48, 256
    s_cmp_eq_u32 s33, 3
    s_cselect_b32 s46, s44, s47
    s_cselect_b32 s50, s60, s48
    s_cselect_b32 s51, s48, s49
    v_mfma_f32_32x32x16_bf16 v[32:47], v[80:83], v[180:183], v[32:47]
    s_sub_u32 s60, s33, 2
    s_cmp_lt_u32 s60, 2
    s_cbranch_scc0 K2_rare_65
K2_back_66:
    v_mul_f32 v234, v0, v96
    v_mul_f32 v236, v8, v128
    v_fmac_f32 v234, v1, v97
    v_fmac_f32 v236, v9, v129
    v_mfma_f32_32x32x16_bf16 v[48:63], v[84:87], v[180:183], v[48:63]
    s_setprio 0
    v_fmac_f32 v234, v2, v98
    v_fmac_f32 v236, v10, v130
    v_fmac_f32 v234, v3, v99
    v_fmac_f32 v236, v11, v131
    v_fmac_f32 v234, v4, v100
    v_fmac_f32 v236, v12, v132
    v_fmac_f32 v234, v5, v101
    v_fmac_f32 v236, v13, v133
    v_fmac_f32 v234, v6, v102
    v_fmac_f32 v236, v14, v134
    v_fmac_f32 v234, v7, v103
    v_fmac_f32 v236, v15, v135
    v_mul_f32 v238, v16, v128
    v_mul_f32 v240, v24, v128
    v_fmac_f32 v238, v17, v129
    v_fmac_f32 v240, v25, v129
    v_fmac_f32 v238, v18, v130
    v_fmac_f32 v240, v26, v130
    v_fmac_f32 v238, v19, v131
    v_fmac_f32 v240, v27, v131
    v_fmac_f32 v238, v20, v132
    v_fmac_f32 v240, v28, v132
    v_fmac_f32 v238, v21, v133
    v_fmac_f32 v240, v29, v133
    v_fmac_f32 v238, v22, v134
    v_fmac_f32 v240, v30, v134
    v_fmac_f32 v238, v23, v135
    v_fmac_f32 v240, v31, v135
    v_mul_f32 v235, v32, v104
    v_mul_f32 v237, v40, v136
    v_fmac_f32 v235, v33, v105
    v_fmac_f32 v237, v41, v137
    v_fmac_f32 v235, v34, v106
    v_fmac_f32 v237, v42, v138
    v_fmac_f32 v235, v35, v107
    v_fmac_f32 v237, v43, v139
    v_fmac_f32 v235, v36, v108
    v_fmac_f32 v237, v44, v140
    v_fmac_f32 v235, v37, v109
    v_fmac_f32 v237, v45, v141
    v_fmac_f32 v235, v38, v110
    v_fmac_f32 v237, v46, v142
    v_fmac_f32 v235, v39, v111
    v_fmac_f32 v237, v47, v143
    v_mul_f32 v239, v48, v136
    v_mul_f32 v241, v56, v136
    s_setprio 1
    s_waitcnt vmcnt(4) lgkmcnt(0)
    v_mfma_f32_32x32x16_bf16 v[0:15], v[64:67], v[184:187], 0
    ds_read_b64_tr_b16 v[176:177], v246 offset:0
    ds_read_b64_tr_b16 v[178:179], v246 offset:1024
    ds_read_b64_tr_b16 v[180:181], v247 offset:0
    ds_read_b64_tr_b16 v[182:183], v247 offset:1024
    v_fmac_f32 v239, v49, v137
    v_fmac_f32 v241, v57, v137
    s_mov_b32 m0, s71
    v_mfma_f32_32x32x16_bf16 v[16:31], v[68:71], v[184:187], 0
    buffer_load_dwordx4 v224, s[4:7], s42 offen sc1 lds
    buffer_load_dwordx4 v225, s[72:75], s42 offen offset:1024 sc1 lds
    v_fmac_f32 v239, v50, v138
    v_fmac_f32 v241, v58, v138
    v_fmac_f32 v239, v51, v139
    v_fmac_f32 v241, v59, v139
    v_fmac_f32 v239, v52, v140
    v_mfma_f32_32x32x16_bf16 v[32:47], v[64:67], v[188:191], 0
    v_fmac_f32 v241, v60, v140
    v_fmac_f32 v239, v53, v141
    v_fmac_f32 v241, v61, v141
    v_fmac_f32 v239, v54, v142
    v_fmac_f32 v241, v62, v142
    v_fmac_f32 v239, v55, v143
    v_fmac_f32 v241, v63, v143
    v_mfma_f32_32x32x16_bf16 v[48:63], v[68:71], v[188:191], 0
    v_permlane32_swap_b32 v234, v236
    v_permlane32_swap_b32 v235, v237
    v_permlane32_swap_b32 v240, v238
    s_waitcnt vmcnt(4) lgkmcnt(0)
    v_mfma_f32_32x32x16_bf16 v[0:15], v[72:75], v[176:179], v[0:15]
    ds_read_b64_tr_b16 v[184:185], v246 offset:2048
    ds_read_b64_tr_b16 v[186:187], v246 offset:3072
    ds_read_b64_tr_b16 v[188:189], v247 offset:2048
    ds_read_b64_tr_b16 v[190:191], v247 offset:3072
    v_permlane32_swap_b32 v241, v239
    s_mov_b32 m0, s68
    v_mfma_f32_32x32x16_bf16 v[16:31], v[76:79], v[176:179], v[16:31]
    buffer_load_dwordx4 v226, s[4:7], s42 offen sc1 lds
    buffer_load_dwordx4 v227, s[72:75], s42 offen offset:1024 sc1 lds
    v_lshl_add_u32 v230, v252, 1, s31
    v_add_f32 v234, v234, v236
    v_add_f32 v235, v235, v237
    v_add_f32 v240, v240, v238
    v_add_f32 v241, v241, v239
    v_mfma_f32_32x32x16_bf16 v[32:47], v[72:75], v[180:183], v[32:47]
    v_cvt_pk_bf16_f32 v234, v234, v235
    v_cvt_pk_bf16_f32 v240, v240, v241
    ds_write_b32 v230, v234 offset:0
    ds_write_b32 v230, v240 offset:256
    v_mfma_f32_32x32x16_bf16 v[48:63], v[76:79], v[180:183], v[48:63]
    s_waitcnt vmcnt(4) lgkmcnt(2)
    v_mfma_f32_32x32x16_bf16 v[0:15], v[80:83], v[184:187], v[0:15]
    ds_read_b64_tr_b16 v[176:177], v246 offset:4096
    ds_read_b64_tr_b16 v[178:179], v246 offset:5120
    ds_read_b64_tr_b16 v[180:181], v247 offset:4096
    ds_read_b64_tr_b16 v[182:183], v247 offset:5120
    s_mov_b32 m0, s69
    v_mfma_f32_32x32x16_bf16 v[16:31], v[84:87], v[184:187], v[16:31]
    buffer_load_dwordx4 v222, s[4:7], s43 offen sc1 lds
    buffer_load_dwordx4 v223, s[72:75], s43 offen offset:1024 sc1 lds
    v_mfma_f32_32x32x16_bf16 v[32:47], v[80:83], v[188:191], v[32:47]
    s_nop 2
    v_mul_f32 v234, v0, v144
    v_mul_f32 v236, v8, v112
    v_fmac_f32 v234, v1, v145
    v_fmac_f32 v236, v9, v113
    v_fmac_f32 v234, v2, v146
    v_fmac_f32 v236, v10, v114
    v_fmac_f32 v234, v3, v147
    v_mfma_f32_32x32x16_bf16 v[48:63], v[84:87], v[188:191], v[48:63]
    s_setprio 0
    v_fmac_f32 v236, v11, v115
    v_fmac_f32 v234, v4, v148
    v_fmac_f32 v236, v12, v116
    v_fmac_f32 v234, v5, v149
    v_fmac_f32 v236, v13, v117
    v_fmac_f32 v234, v6, v150
    v_fmac_f32 v236, v14, v118
    v_fmac_f32 v234, v7, v151
    v_fmac_f32 v236, v15, v119
    v_mul_f32 v238, v16, v160
    v_mul_f32 v240, v24, v160
    v_fmac_f32 v238, v17, v161
    v_fmac_f32 v240, v25, v161
    v_fmac_f32 v238, v18, v162
    v_fmac_f32 v240, v26, v162
    v_fmac_f32 v238, v19, v163
    v_fmac_f32 v240, v27, v163
    v_fmac_f32 v238, v20, v164
    v_fmac_f32 v240, v28, v164
    v_fmac_f32 v238, v21, v165
    v_fmac_f32 v240, v29, v165
    v_fmac_f32 v238, v22, v166
    v_fmac_f32 v240, v30, v166
    v_fmac_f32 v238, v23, v167
    v_fmac_f32 v240, v31, v167
    v_mul_f32 v235, v32, v152
    v_mul_f32 v237, v40, v120
    v_fmac_f32 v235, v33, v153
    v_fmac_f32 v237, v41, v121
    v_fmac_f32 v235, v34, v154
    v_fmac_f32 v237, v42, v122
    v_fmac_f32 v235, v35, v155
    v_fmac_f32 v237, v43, v123
    v_fmac_f32 v235, v36, v156
    v_fmac_f32 v237, v44, v124
    v_fmac_f32 v235, v37, v157
    v_fmac_f32 v237, v45, v125
    v_fmac_f32 v235, v38, v158
    v_fmac_f32 v237, v46, v126
    v_fmac_f32 v235, v39, v159
    v_fmac_f32 v237, v47, v127
    v_mul_f32 v239, v48, v168
    v_mul_f32 v241, v56, v168
    v_fmac_f32 v239, v49, v169
    v_fmac_f32 v241, v57, v169
    s_setprio 1
    s_waitcnt vmcnt(4) lgkmcnt(0)
    v_mfma_f32_32x32x16_bf16 v[0:15], v[64:67], v[176:179], 0
    ds_read_b64_tr_b16 v[184:185], v246 offset:6144
    ds_read_b64_tr_b16 v[186:187], v246 offset:7168
    ds_read_b64_tr_b16 v[188:189], v247 offset:6144
    ds_read_b64_tr_b16 v[190:191], v247 offset:7168
    v_fmac_f32 v239, v50, v170
    v_fmac_f32 v241, v58, v170
    s_mov_b32 m0, s70
    v_mfma_f32_32x32x16_bf16 v[16:31], v[68:71], v[176:179], 0
    buffer_load_dwordx4 v224, s[4:7], s43 offen sc1 lds
    buffer_load_dwordx4 v225, s[72:75], s43 offen offset:1024 sc1 lds
    v_fmac_f32 v239, v51, v171
    v_fmac_f32 v241, v59, v171
    v_fmac_f32 v239, v52, v172
    v_fmac_f32 v241, v60, v172
    v_fmac_f32 v239, v53, v173
    v_mfma_f32_32x32x16_bf16 v[32:47], v[64:67], v[180:183], 0
    v_add_u32 v222, s48, v251
    ds_read2_b32 v[222:223], v222 offset0:1 offset1:3
    v_fmac_f32 v241, v61, v173
    v_fmac_f32 v239, v54, v174
    v_fmac_f32 v241, v62, v174
    v_fmac_f32 v239, v55, v175
    v_fmac_f32 v241, v63, v175
    v_mfma_f32_32x32x16_bf16 v[48:63], v[68:71], v[180:183], 0
    s_waitcnt vmcnt(4) lgkmcnt(1)
    v_mfma_f32_32x32x16_bf16 v[0:15], v[72:75], v[184:187], v[0:15]
    ds_read_b64_tr_b16 v[176:177], v246 offset:0
    ds_read_b64_tr_b16 v[178:179], v246 offset:1024
    ds_read_b64_tr_b16 v[180:181], v247 offset:0
    ds_read_b64_tr_b16 v[182:183], v247 offset:1024
    s_mov_b32 m0, s71
    v_mfma_f32_32x32x16_bf16 v[16:31], v[76:79], v[184:187], v[16:31]
    buffer_load_dwordx4 v226, s[4:7], s43 offen sc1 lds
    buffer_load_dwordx4 v227, s[72:75], s43 offen offset:1024 sc1 lds
    s_waitcnt lgkmcnt(4)
    v_mad_u32_u16 v222, v222, s39, v248 op_sel:[1,0,0,0]
    v_mad_u32_u16 v223, v223, s39, v248 op_sel:[1,0,0,0]
    v_mfma_f32_32x32x16_bf16 v[32:47], v[72:75], v[188:191], v[32:47]
    v_add_u32 v224, s49, v251
    ds_read2_b32 v[224:225], v224 offset0:1 offset1:3
    v_mfma_f32_32x32x16_bf16 v[48:63], v[76:79], v[188:191], v[48:63]
    s_waitcnt vmcnt(4) lgkmcnt(1)
    v_mfma_f32_32x32x16_bf16 v[0:15], v[80:83], v[176:179], v[0:15]
    ds_read_b64_tr_b16 v[184:185], v246 offset:2048
    ds_read_b64_tr_b16 v[186:187], v246 offset:3072
    ds_read_b64_tr_b16 v[188:189], v247 offset:2048
    ds_read_b64_tr_b16 v[190:191], v247 offset:3072
    s_mov_b32 m0, s68
    v_mfma_f32_32x32x16_bf16 v[16:31], v[84:87], v[176:179], v[16:31]
    buffer_load_dwordx4 v222, s[4:7], s44 offen sc1 lds
    buffer_load_dwordx4 v223, s[72:75], s44 offen offset:1024 sc1 lds
    s_waitcnt lgkmcnt(4)
    v_mad_u32_u16 v224, v224, s39, v248 op_sel:[1,0,0,0]
    v_mad_u32_u16 v225, v225, s39, v248 op_sel:[1,0,0,0]
    v_mfma_f32_32x32x16_bf16 v[32:47], v[80:83], v[180:183], v[32:47]
    v_add_u32 v226, s50, v251
    ds_read2_b32 v[226:227], v226 offset0:1 offset1:3
    v_mul_f32 v242, v0, v144
    v_fma_f32 v238, v8, v160, -v238
    v_fmac_f32 v242, v1, v145
    v_fmac_f32 v238, v9, v161
    v_fmac_f32 v242, v2, v146
    v_mfma_f32_32x32x16_bf16 v[48:63], v[84:87], v[180:183], v[48:63]
    s_setprio 0
    v_fmac_f32 v238, v10, v162
    v_fmac_f32 v242, v3, v147
    v_fmac_f32 v238, v11, v163
    v_fmac_f32 v242, v4, v148
    v_fmac_f32 v238, v12, v164
    v_fmac_f32 v242, v5, v149
    v_fmac_f32 v238, v13, v165
    v_fmac_f32 v242, v6, v150
    v_fmac_f32 v238, v14, v166
    v_fmac_f32 v242, v7, v151
    v_fmac_f32 v238, v15, v167
    v_fmac_f32 v236, v16, v112
    v_mul_f32 v244, v24, v160
    v_fmac_f32 v236, v17, v113
    v_fmac_f32 v244, v25, v161
    v_fmac_f32 v236, v18, v114
    v_fmac_f32 v244, v26, v162
    v_fmac_f32 v236, v19, v115
    v_fmac_f32 v244, v27, v163
    v_fmac_f32 v236, v20, v116
    v_fmac_f32 v244, v28, v164
    v_fmac_f32 v236, v21, v117
    v_fmac_f32 v244, v29, v165
    v_fmac_f32 v236, v22, v118
    v_fmac_f32 v244, v30, v166
    v_fmac_f32 v236, v23, v119
    v_fmac_f32 v244, v31, v167
    v_mul_f32 v243, v32, v152
    v_fma_f32 v239, v40, v168, -v239
    v_fmac_f32 v243, v33, v153
    v_fmac_f32 v239, v41, v169
    v_fmac_f32 v243, v34, v154
    v_fmac_f32 v239, v42, v170
    v_fmac_f32 v243, v35, v155
    v_fmac_f32 v239, v43, v171
    v_fmac_f32 v243, v36, v156
    v_fmac_f32 v239, v44, v172
    v_fmac_f32 v243, v37, v157
    v_fmac_f32 v239, v45, v173
    v_fmac_f32 v243, v38, v158
    v_fmac_f32 v239, v46, v174
    v_fmac_f32 v243, v39, v159
    v_fmac_f32 v239, v47, v175
    v_fmac_f32 v237, v48, v120
    v_mul_f32 v245, v56, v168
    v_fmac_f32 v237, v49, v121
    v_fmac_f32 v245, v57, v169
    v_fmac_f32 v237, v50, v122
    v_fmac_f32 v245, v58, v170
    v_fmac_f32 v237, v51, v123
    s_setprio 1
    s_waitcnt vmcnt(4) lgkmcnt(1)
    v_mfma_f32_32x32x16_bf16 v[0:15], v[64:67], v[184:187], 0
    ds_read_b64_tr_b16 v[176:177], v246 offset:4096
    ds_read_b64_tr_b16 v[178:179], v246 offset:5120
    ds_read_b64_tr_b16 v[180:181], v247 offset:4096
    ds_read_b64_tr_b16 v[182:183], v247 offset:5120
    v_fmac_f32 v245, v59, v171
    v_fmac_f32 v237, v52, v124
    s_mov_b32 m0, s69
    v_mfma_f32_32x32x16_bf16 v[16:31], v[68:71], v[184:187], 0
    buffer_load_dwordx4 v224, s[4:7], s45 offen sc1 lds
    buffer_load_dwordx4 v225, s[72:75], s45 offen offset:1024 sc1 lds
    s_waitcnt lgkmcnt(4)
    v_mad_u32_u16 v226, v226, s39, v248 op_sel:[1,0,0,0]
    v_mad_u32_u16 v227, v227, s39, v248 op_sel:[1,0,0,0]
    v_fmac_f32 v245, v60, v172
    v_fmac_f32 v237, v53, v125
    v_mfma_f32_32x32x16_bf16 v[32:47], v[64:67], v[188:191], 0
    v_add_u32 v228, s51, v251
    ds_read2_b32 v[228:229], v228 offset0:1 offset1:3
    v_fmac_f32 v245, v61, v173
    v_fmac_f32 v237, v54, v126
    v_fmac_f32 v245, v62, v174
    v_fmac_f32 v237, v55, v127
    v_fmac_f32 v245, v63, v175
    v_mfma_f32_32x32x16_bf16 v[48:63], v[68:71], v[188:191], 0
    v_permlane32_swap_b32 v242, v234
    v_permlane32_swap_b32 v243, v235
    v_add_f32 v242, v242, v234
    v_add_f32 v243, v243, v235
    s_waitcnt vmcnt(4) lgkmcnt(1)
    v_mfma_f32_32x32x16_bf16 v[0:15], v[72:75], v[176:179], v[0:15]
    ds_read_b64_tr_b16 v[184:185], v246 offset:6144
    ds_read_b64_tr_b16 v[186:187], v246 offset:7168
    ds_read_b64_tr_b16 v[188:189], v247 offset:6144
    ds_read_b64_tr_b16 v[190:191], v247 offset:7168
    v_cvt_pk_bf16_f32 v242, v242, v243
    ds_write_b32 v230, v242 offset:512
    s_mov_b32 m0, s70
    v_mfma_f32_32x32x16_bf16 v[16:31], v[76:79], v[176:179], v[16:31]
    buffer_load_dwordx4 v226, s[4:7], s46 offen sc1 lds
    buffer_load_dwordx4 v227, s[72:75], s46 offen offset:1024 sc1 lds
    s_waitcnt lgkmcnt(5)
    v_mad_u32_u16 v228, v228, s39, v248 op_sel:[1,0,0,0]
    v_mad_u32_u16 v229, v229, s39, v248 op_sel:[1,0,0,0]
    s_sub_u32 s26, s48, s29
    s_mov_b32 s29, s48
    v_mfma_f32_32x32x16_bf16 v[32:47], v[72:75], v[180:183], v[32:47]
    s_mov_b32 s30, s3
    s_bfe_u32 s56, s3, 0x40012
    s_cmp_lg_u32 s36, 0
    s_cselect_b32 s56, s56, 0
    s_mov_b32 s32, s31
    s_mov_b32 s31, s35
    v_mfma_f32_32x32x16_bf16 v[48:63], v[76:79], v[180:183], v[48:63]
    s_waitcnt vmcnt(4) lgkmcnt(1)
    v_mfma_f32_32x32x16_bf16 v[0:15], v[80:83], v[184:187], v[0:15]
    ds_read_b64_tr_b16 v[176:177], v246 offset:0
    ds_read_b64_tr_b16 v[178:179], v246 offset:1024
    ds_read_b64_tr_b16 v[180:181], v247 offset:0
    ds_read_b64_tr_b16 v[182:183], v247 offset:1024
    s_mov_b32 m0, s71
    v_mfma_f32_32x32x16_bf16 v[16:31], v[84:87], v[184:187], v[16:31]
    buffer_load_dwordx4 v228, s[4:7], s47 offen sc1 lds
    buffer_load_dwordx4 v229, s[72:75], s47 offen offset:1024 sc1 lds
    v_mfma_f32_32x32x16_bf16 v[32:47], v[80:83], v[188:191], v[32:47]
    s_nop 2
    v_mul_f32 v242, v0, v144
    v_fma_f32 v240, v8, v160, -v240
    v_fmac_f32 v242, v1, v145
    v_fmac_f32 v240, v9, v161
    v_fmac_f32 v242, v2, v146
    v_fmac_f32 v240, v10, v162
    v_fmac_f32 v242, v3, v147
    v_mfma_f32_32x32x16_bf16 v[48:63], v[84:87], v[188:191], v[48:63]
    s_setprio 0
    v_fmac_f32 v240, v11, v163
    v_fmac_f32 v242, v4, v148
    v_fmac_f32 v240, v12, v164
    v_fmac_f32 v242, v5, v149
    v_fmac_f32 v240, v13, v165
    v_fmac_f32 v242, v6, v150
    v_fmac_f32 v240, v14, v166
    v_fmac_f32 v242, v7, v151
    v_fmac_f32 v240, v15, v167
    v_add_u32 v249, s26, v249
    v_add_u32 v250, s26, v250
    v_fma_f32 v244, v16, v160, -v244
    v_fmac_f32 v236, v24, v112
    v_fmac_f32 v244, v17, v161
    v_fmac_f32 v236, v25, v113
    v_fmac_f32 v244, v18, v162
    v_fmac_f32 v236, v26, v114
    v_fmac_f32 v244, v19, v163
    v_fmac_f32 v236, v27, v115
    v_fmac_f32 v244, v20, v164
    v_fmac_f32 v236, v28, v116
    v_fmac_f32 v244, v21, v165
    v_fmac_f32 v236, v29, v117
    v_fmac_f32 v244, v22, v166
    v_fmac_f32 v236, v30, v118
    v_fmac_f32 v244, v23, v167
    v_fmac_f32 v236, v31, v119
    ds_read_b64_tr_b16 v[0:1], v249 offset:0
    ds_read_b64_tr_b16 v[2:3], v249 offset:32
    ds_read_u16_d16_hi v16, v250 offset:0
    v_mul_f32 v243, v32, v152
    v_fma_f32 v241, v40, v168, -v241
    v_fmac_f32 v243, v33, v153
    v_fmac_f32 v241, v41, v169
    v_fmac_f32 v243, v34, v154
    v_fmac_f32 v241, v42, v170
    v_fmac_f32 v243, v35, v155
    v_fmac_f32 v241, v43, v171
    v_fmac_f32 v243, v36, v156
    v_fmac_f32 v241, v44, v172
    v_fmac_f32 v243, v37, v157
    v_fmac_f32 v241, v45, v173
    v_fmac_f32 v243, v38, v158
    v_fmac_f32 v241, v46, v174
    v_fmac_f32 v243, v39, v159
    v_fmac_f32 v241, v47, v175
    ds_read_b64_tr_b16 v[4:5], v249 offset:512
    ds_read_b64_tr_b16 v[6:7], v249 offset:544
    ds_read_u16_d16_hi v17, v250 offset:128
    v_fma_f32 v245, v48, v168, -v245
    v_fmac_f32 v237, v56, v120
    v_fmac_f32 v245, v49, v169
    v_fmac_f32 v237, v57, v121
    v_fmac_f32 v245, v50, v170
    v_fmac_f32 v237, v58, v122
    v_fmac_f32 v245, v51, v171
    v_fmac_f32 v237, v59, v123
    v_fmac_f32 v245, v52, v172
    v_fmac_f32 v237, v60, v124
    v_fmac_f32 v245, v53, v173
    v_fmac_f32 v237, v61, v125
    v_fmac_f32 v245, v54, v174
    v_fmac_f32 v237, v62, v126
    v_fmac_f32 v245, v55, v175
    v_fmac_f32 v237, v63, v127
    s_cmp_eq_u32 s56, 5
    s_cbranch_scc1 K2_U21
    s_cmp_eq_u32 s56, 6
    s_cbranch_scc1 K2_U3h1
    s_branch K2_DSP1
K2_PAD_SW:
    s_branch K2_HOP
K2_DSP0:
    s_cmp_eq_u32 s56, 4
    s_cbranch_scc1 K2_U20
    s_cmp_eq_u32 s56, 7
    s_cbranch_scc1 K2_U30
    s_cmp_gt_u32 s56, 7
    s_cbranch_scc1 K2_U40
    s_cmp_lg_u32 s56, 0
    s_cbranch_scc1 K2_U10
    s_branch K2_SWITCH
K2_DSP1:
    s_cmp_eq_u32 s56, 4
    s_cbranch_scc1 K2_U21
    s_cmp_eq_u32 s56, 7
    s_cbranch_scc1 K2_U31
    s_cmp_gt_u32 s56, 7
    s_cbranch_scc1 K2_U41
    s_cmp_lg_u32 s56, 0
    s_cbranch_scc1 K2_U11
    s_branch K2_TAIL
K2_SWITCH:
    v_lshlrev_b32 v60, 3, v252
    s_mov_b32 s64, 7176192
    buffer_load_dwordx4 v[56:59], v60, s[8:11], s64 offen sc1
    v_permlane32_swap_b32 v242, v236
    v_permlane32_swap_b32 v243, v237
    v_permlane32_swap_b32 v244, v238
    v_permlane32_swap_b32 v245, v239
    v_permlane32_swap_b32 v240, v241
    v_add_f32 v242, v242, v236
    v_add_f32 v243, v243, v237
    v_add_f32 v244, v244, v238
    v_add_f32 v245, v245, v239
    v_add_f32 v240, -v240, -v241
    s_set_gpr_idx_on s32, gpr_idx(DST)
    s_nop 0
    v_cvt_pk_bf16_f32 v195, v242, v243
    v_cvt_pk_bf16_f32 v196, v244, v245
    v_cvt_pk_bf16_f32 v197, v240, v240
    s_set_gpr_idx_off
    v_lshl_add_u32 v230, v252, 1, s35
    v_lshrrev_b32 v231, 6, v252
    v_mul_u32_u24 v231, 126, v231
    v_lshrrev_b32 v254, 6, v252
    v_bfe_u32 v255, v252, 3, 2
    v_lshl_add_u32 v254, v254, 2, v255
    v_mul_u32_u24 v254, 640, v254
    v_bfe_u32 v255, v252, 5, 1
    v_lshl_add_u32 v254, v255, 5, v254
    v_and_b32 v255, 6, v252
    v_lshl_add_u32 v254, v255, 2, v254
    v_add_u32 v254, 152832, v254
    ds_read_b64_tr_b16 v[104:105], v254 offset:0
    ds_read_b64_tr_b16 v[106:107], v254 offset:5120
    ds_read_b64_tr_b16 v[108:109], v254 offset:64
    ds_read_b64_tr_b16 v[110:111], v254 offset:5184
    ds_read_b64_tr_b16 v[120:121], v254 offset:128
    ds_read_b64_tr_b16 v[122:123], v254 offset:5248
    ds_read_b64_tr_b16 v[124:125], v254 offset:192
    ds_read_b64_tr_b16 v[126:127], v254 offset:5312
    ds_read_b64_tr_b16 v[136:137], v254 offset:256
    ds_read_b64_tr_b16 v[138:139], v254 offset:5376
    ds_read_b64_tr_b16 v[140:141], v254 offset:320
    ds_read_b64_tr_b16 v[142:143], v254 offset:5440
    ds_read_b64_tr_b16 v[152:153], v254 offset:384
    ds_read_b64_tr_b16 v[154:155], v254 offset:5504
    ds_read_b64_tr_b16 v[156:157], v254 offset:448
    ds_read_b64_tr_b16 v[158:159], v254 offset:5568
    ds_read_b64_tr_b16 v[168:169], v254 offset:512
    ds_read_b64_tr_b16 v[170:171], v254 offset:5632
    ds_read_b64_tr_b16 v[172:173], v254 offset:576
    ds_read_b64_tr_b16 v[174:175], v254 offset:5696
    s_movk_i32 s40, 128
    s_movk_i32 s41, 384
    s_movk_i32 s42, 640
    s_movk_i32 s43, 896
    s_waitcnt lgkmcnt(15)
    v_lshlrev_b32 v96, 16, v104
    v_and_b32 v97, 0xffff0000, v104
    v_lshlrev_b32 v98, 16, v105
    v_and_b32 v99, 0xffff0000, v105
    v_lshlrev_b32 v100, 16, v106
    v_and_b32 v101, 0xffff0000, v106
    v_lshlrev_b32 v102, 16, v107
    v_and_b32 v103, 0xffff0000, v107
    v_lshlrev_b32 v104, 16, v108
    v_and_b32 v105, 0xffff0000, v108
    v_lshlrev_b32 v106, 16, v109
    v_and_b32 v107, 0xffff0000, v109
    v_lshlrev_b32 v108, 16, v110
    v_and_b32 v109, 0xffff0000, v110
    v_lshlrev_b32 v110, 16, v111
    v_and_b32 v111, 0xffff0000, v111
    s_waitcnt lgkmcnt(12)
    v_lshlrev_b32 v112, 16, v120
    v_and_b32 v113, 0xffff0000, v120
    v_lshlrev_b32 v114, 16, v121
    v_and_b32 v115, 0xffff0000, v121
    v_lshlrev_b32 v116, 16, v122
    v_and_b32 v117, 0xffff0000, v122
    v_lshlrev_b32 v118, 16, v123
    v_and_b32 v119, 0xffff0000, v123
    v_lshlrev_b32 v120, 16, v124
    v_and_b32 v121, 0xffff0000, v124
    v_lshlrev_b32 v122, 16, v125
    v_and_b32 v123, 0xffff0000, v125
    v_lshlrev_b32 v124, 16, v126
    v_and_b32 v125, 0xffff0000, v126
    v_lshlrev_b32 v126, 16, v127
    v_and_b32 v127, 0xffff0000, v127
    s_waitcnt lgkmcnt(8)
    v_lshlrev_b32 v128, 16, v136
    v_and_b32 v129, 0xffff0000, v136
    v_lshlrev_b32 v130, 16, v137
    v_and_b32 v131, 0xffff0000, v137
    v_lshlrev_b32 v132, 16, v138
    v_and_b32 v133, 0xffff0000, v138
    v_lshlrev_b32 v134, 16, v139
    v_and_b32 v135, 0xffff0000, v139
    v_lshlrev_b32 v136, 16, v140
    v_and_b32 v137, 0xffff0000, v140
    v_lshlrev_b32 v138, 16, v141
    v_and_b32 v139, 0xffff0000, v141
    v_lshlrev_b32 v140, 16, v142
    v_and_b32 v141, 0xffff0000, v142
    v_lshlrev_b32 v142, 16, v143
    v_and_b32 v143, 0xffff0000, v143
    s_waitcnt lgkmcnt(4)
    v_lshlrev_b32 v144, 16, v152
    v_and_b32 v145, 0xffff0000, v152
    v_lshlrev_b32 v146, 16, v153
    v_and_b32 v147, 0xffff0000, v153
    v_lshlrev_b32 v148, 16, v154
    v_and_b32 v149, 0xffff0000, v154
    v_lshlrev_b32 v150, 16, v155
    v_and_b32 v151, 0xffff0000, v155
    v_lshlrev_b32 v152, 16, v156
    v_and_b32 v153, 0xffff0000, v156
    v_lshlrev_b32 v154, 16, v157
    v_and_b32 v155, 0xffff0000, v157
    v_lshlrev_b32 v156, 16, v158
    v_and_b32 v157, 0xffff0000, v158
    v_lshlrev_b32 v158, 16, v159
    v_and_b32 v159, 0xffff0000, v159
    s_waitcnt lgkmcnt(0)
    v_lshlrev_b32 v160, 16, v168
    v_and_b32 v161, 0xffff0000, v168
    v_lshlrev_b32 v162, 16, v169
    v_and_b32 v163, 0xffff0000, v169
    v_lshlrev_b32 v164, 16, v170
    v_and_b32 v165, 0xffff0000, v170
    v_lshlrev_b32 v166, 16, v171
    v_and_b32 v167, 0xffff0000, v171
    v_lshlrev_b32 v168, 16, v172
    v_and_b32 v169, 0xffff0000, v172
    v_lshlrev_b32 v170, 16, v173
    v_and_b32 v171, 0xffff0000, v173
    v_lshlrev_b32 v172, 16, v174
    v_and_b32 v173, 0xffff0000, v174
    v_lshlrev_b32 v174, 16, v175
    v_and_b32 v175, 0xffff0000, v175
K2_FLGW:
    s_or_b32 s58, s54, s20
    s_waitcnt vmcnt(0)
    v_xor_b32 v56, s2, v56
    v_xor_b32 v57, s2, v57
    v_xor_b32 v58, s2, v58
    v_xor_b32 v59, s2, v59
    v_or3_b32 v56, v56, v57, v58
    v_or_b32 v56, v56, v59
    v_cmp_ne_u32 vcc, 0, v56
    s_nop 0
    s_cbranch_vccnz K2_FLGR
    s_cmp_eq_u32 s58, 0
    s_cbranch_scc1 K2_FLGY
K2_FLGOK:
    s_cmp_eq_u32 s36, 0
    s_cbranch_scc1 K2_TAIL2
    s_mov_b32 s29, s48
    s_mov_b32 s32, s31
    s_mov_b32 s30, s3
    s_mov_b32 s31, s35
    s_bfe_u32 s56, s3, 0x40012
    s_cmp_eq_u32 s56, 5
    s_cbranch_scc1 K2_U21
    s_cmp_eq_u32 s56, 6
    s_cbranch_scc1 K2_U3h1
    s_branch K2_DSP1
K2_dum_4:
    v_mov_b32 v232, -1
    s_mov_b32 m0, 163312
    s_mov_b64 exec, 1
    buffer_load_dwordx4 v232, s[16:19], 0 offen lds
    buffer_load_dwordx4 v232, s[16:19], 0 offen lds
    s_mov_b64 exec, -1
    s_branch K2_back_6
K2_nul_10:
    s_mov_b32 s58, 63
    s_mov_b32 s36, 0
    s_branch K2_back_13
K2_spin_11:
    s_sub_u32 s27, s27, 1
    s_cbranch_scc1 K2_END
    v_lshl_add_u32 v233, v252, 1, s53
    ds_read_b32 v233, v233
    s_waitcnt lgkmcnt(0)
    s_branch K2_chk_12
K2_dyn_8:
    v_mov_b32 v254, 163296
    v_mov_b32 v255, 1
    v_lshl_add_u32 v233, v252, 1, s53
    s_mov_b64 exec, 1
    ds_add_rtn_u32 v232, v254, v255
    s_mov_b64 exec, -1
    ds_read_b32 v233, v233
    s_waitcnt lgkmcnt(0)
    v_readfirstlane_b32 s58, v232
    s_nop 0
    s_cmp_lt_u32 s58, s22
    s_cbranch_scc0 K2_nul_10
    s_nop 0
    v_readlane_b32 s58, v253, s58
    s_nop 0
    s_bfe_u32 s58, s58, 0x60016
    s_and_b32 s59, s58, 7
    s_lshr_b32 s60, s58, 3
K2_chk_12:
    v_readlane_b32 s61, v233, s59
    s_nop 0
    s_cmp_gt_u32 s61, s60
    s_cbranch_scc0 K2_spin_11
K2_back_13:
    s_mov_b32 s34, 1
    s_branch K2_back_9
K2_dum_17:
    v_mov_b32 v232, -1
    s_mov_b32 m0, 163312
    s_mov_b64 exec, 1
    buffer_load_dwordx4 v232, s[16:19], 0 offen lds
    buffer_load_dwordx4 v232, s[16:19], 0 offen lds
    s_mov_b64 exec, -1
    s_branch K2_back_19
K2_nul_23:
    s_mov_b32 s58, 63
    s_mov_b32 s36, 0
    s_branch K2_back_26
K2_spin_24:
    s_sub_u32 s27, s27, 1
    s_cbranch_scc1 K2_END
    v_lshl_add_u32 v233, v252, 1, s53
    ds_read_b32 v233, v233
    s_waitcnt lgkmcnt(0)
    s_branch K2_chk_25
K2_dyn_21:
    v_mov_b32 v254, 163296
    v_mov_b32 v255, 1
    v_lshl_add_u32 v233, v252, 1, s53
    s_mov_b64 exec, 1
    ds_add_rtn_u32 v232, v254, v255
    s_mov_b64 exec, -1
    ds_read_b32 v233, v233
    s_waitcnt lgkmcnt(0)
    v_readfirstlane_b32 s58, v232
    s_nop 0
    s_cmp_lt_u32 s58, s22
    s_cbranch_scc0 K2_nul_23
    s_nop 0
    v_readlane_b32 s58, v253, s58
    s_nop 0
    s_bfe_u32 s58, s58, 0x60016
    s_and_b32 s59, s58, 7
    s_lshr_b32 s60, s58, 3
K2_chk_25:
    v_readlane_b32 s61, v233, s59
    s_nop 0
    s_cmp_gt_u32 s61, s60
    s_cbranch_scc0 K2_spin_24
K2_back_26:
    s_mov_b32 s34, 1
    s_branch K2_back_22
K2_dum_30:
    v_mov_b32 v232, -1
    s_mov_b32 m0, 163312
    s_mov_b64 exec, 1
    buffer_load_dwordx4 v232, s[16:19], 0 offen lds
    buffer_load_dwordx4 v232, s[16:19], 0 offen lds
    s_mov_b64 exec, -1
    s_branch K2_back_32
K2_nul_36:
    s_mov_b32 s58, 63
    s_mov_b32 s36, 0
    s_branch K2_back_39
K2_spin_37:
    s_sub_u32 s27, s27, 1
    s_cbranch_scc1 K2_END
    v_lshl_add_u32 v233, v252, 1, s53
    ds_read_b32 v233, v233
    s_waitcnt lgkmcnt(0)
    s_branch K2_chk_38
K2_dyn_34:
    v_mov_b32 v254, 163296
    v_mov_b32 v255, 1
    v_lshl_add_u32 v233, v252, 1, s53
    s_mov_b64 exec, 1
    ds_add_rtn_u32 v232, v254, v255
    s_mov_b64 exec, -1
    ds_read_b32 v233, v233
    s_waitcnt lgkmcnt(0)
    v_readfirstlane_b32 s58, v232
    s_nop 0
    s_cmp_lt_u32 s58, s22
    s_cbranch_scc0 K2_nul_36
    s_nop 0
    v_readlane_b32 s58, v253, s58
    s_nop 0
    s_bfe_u32 s58, s58, 0x60016
    s_and_b32 s59, s58, 7
    s_lshr_b32 s60, s58, 3
K2_chk_38:
    v_readlane_b32 s61, v233, s59
    s_nop 0
    s_cmp_gt_u32 s61, s60
    s_cbranch_scc0 K2_spin_37
K2_back_39:
    s_mov_b32 s34, 1
    s_branch K2_back_35
K2_dum_43:
    v_mov_b32 v232, -1
    s_mov_b32 m0, 163312
    s_mov_b64 exec, 1
    buffer_load_dwordx4 v232, s[16:19], 0 offen lds
    buffer_load_dwordx4 v232, s[16:19], 0 offen lds
    s_mov_b64 exec, -1
    s_branch K2_back_45
K2_nul_47:
    s_mov_b32 s58, 63
    s_mov_b32 s36, 0
    s_branch K2_back_50
K2_spin_48:
    s_sub_u32 s27, s27, 1
    s_cbranch_scc1 K2_END
    v_lshl_add_u32 v233, v252, 1, s53
    ds_read_b32 v233, v233
    s_waitcnt lgkmcnt(0)
    s_branch K2_chk_49
K2_nul_54:
    s_mov_b32 s58, 63
    s_mov_b32 s36, 0
    s_branch K2_back_57
K2_spin_55:
    s_sub_u32 s27, s27, 1
    s_cbranch_scc1 K2_END
    v_lshl_add_u32 v233, v252, 1, s53
    ds_read_b32 v233, v233
    s_waitcnt lgkmcnt(0)
    s_branch K2_chk_56
K2_nul_61:
    s_mov_b32 s58, 63
    s_mov_b32 s36, 0
    s_branch K2_back_64
K2_spin_62:
    s_sub_u32 s27, s27, 1
    s_cbranch_scc1 K2_END
    v_lshl_add_u32 v233, v252, 1, s53
    ds_read_b32 v233, v233
    s_waitcnt lgkmcnt(0)
    s_branch K2_chk_63
K2_PAD_TL:
    s_branch K2_HOP
K2_TAIL2:
    v_lshlrev_b32 v229, 3, v252
    s_mul_i32 s58, s20, 20480
    s_add_u32 s58, s58, 6946816
    s_mul_i32 s59, s20, 8224
    buffer_load_dwordx4 v[96:99], v229, s[8:11], s58 offen offset:0 sc1
    buffer_load_dwordx4 v[100:103], v229, s[8:11], s58 offen offset:1024 sc1
    buffer_load_dwordx4 v[104:107], v229, s[8:11], s58 offen offset:2048 sc1
    buffer_load_dwordx4 v[108:111], v229, s[8:11], s58 offen offset:3072 sc1
    s_add_u32 s58, s58, 4096
    buffer_load_dwordx4 v[128:131], v229, s[8:11], s58 offen offset:0 sc1
    buffer_load_dwordx4 v[132:135], v229, s[8:11], s58 offen offset:1024 sc1
    buffer_load_dwordx4 v[136:139], v229, s[8:11], s58 offen offset:2048 sc1
    buffer_load_dwordx4 v[140:143], v229, s[8:11], s58 offen offset:3072 sc1
    v_lshl_add_u32 v228, v252, 1, s59
    v_lshrrev_b32 v226, 6, v252
    v_mul_u32_u24 v226, 126, v226
    v_sub_u32 v226, v228, v226
    s_branch K2_TAIL3
K2_TAIL:
    v_lshlrev_b32 v229, 3, v252
    s_mul_i32 s58, s20, 20480
    s_add_u32 s58, s58, 6946816
    s_mul_i32 s59, s20, 8224
    buffer_load_dwordx4 v[96:99], v229, s[8:11], s58 offen offset:0 sc1
    v_permlane32_swap_b32 v242, v236
    v_permlane32_swap_b32 v243, v237
    v_permlane32_swap_b32 v244, v238
    buffer_load_dwordx4 v[100:103], v229, s[8:11], s58 offen offset:1024 sc1
    v_permlane32_swap_b32 v245, v239
    v_permlane32_swap_b32 v240, v241
    v_add_f32 v242, v242, v236
    buffer_load_dwordx4 v[104:107], v229, s[8:11], s58 offen offset:2048 sc1
    v_add_f32 v243, v243, v237
    v_add_f32 v244, v244, v238
    v_add_f32 v245, v245, v239
    buffer_load_dwordx4 v[108:111], v229, s[8:11], s58 offen offset:3072 sc1
    v_add_f32 v240, -v240, -v241
    v_sub_u32 v241, v230, v231
    v_cvt_pk_bf16_f32 v242, v242, v243
    s_add_u32 s58, s58, 4096
    buffer_load_dwordx4 v[128:131], v229, s[8:11], s58 offen offset:0 sc1
    v_cvt_pk_bf16_f32 v244, v244, v245
    v_cvt_pk_bf16_f32 v240, v240, v240
    ds_write_b32 v230, v242 offset:768
    buffer_load_dwordx4 v[132:135], v229, s[8:11], s58 offen offset:1024 sc1
    ds_write_b32 v230, v244 offset:1024
    ds_write_b16 v241, v240 offset:1280
    v_lshl_add_u32 v228, v252, 1, s59
    buffer_load_dwordx4 v[136:139], v229, s[8:11], s58 offen offset:2048 sc1
    v_lshrrev_b32 v226, 6, v252
    v_mul_u32_u24 v226, 126, v226
    v_sub_u32 v226, v228, v226
    buffer_load_dwordx4 v[140:143], v229, s[8:11], s58 offen offset:3072 sc1
K2_TAIL3:
    s_waitcnt vmcnt(8)
    ds_write2st64_b32 v228, v192, v193 offset0:0 offset1:1
    ds_write2st64_b32 v228, v194, v195 offset0:2 offset1:3
    s_add_u32 s58, s58, 4096
    buffer_load_dwordx4 v[112:115], v229, s[8:11], s58 offen offset:0 sc1
    v_bfe_u32 v48, v252, 1, 4
    v_lshrrev_b32 v49, 5, v252
    ds_write_b16 v226, v197 offset:1280
    ds_write2st64_b32 v228, v196, v198 offset0:4 offset1:6
    buffer_load_dwordx4 v[116:119], v229, s[8:11], s58 offen offset:1024 sc1
    v_lshrrev_b32 v55, 3, v48
    v_lshlrev_b32 v52, 4, v49
    ds_write2st64_b32 v228, v199, v200 offset0:7 offset1:8
    ds_write2st64_b32 v228, v201, v202 offset0:9 offset1:10
    buffer_load_dwordx4 v[120:123], v229, s[8:11], s58 offen offset:2048 sc1
    v_lshl_add_u32 v54, v55, 2, v48
    v_and_b32 v54, 7, v54
    ds_write_b16 v226, v203 offset:2816
    ds_write2st64_b32 v228, v204, v205 offset0:12 offset1:13
    buffer_load_dwordx4 v[124:127], v229, s[8:11], s58 offen offset:3072 sc1
    v_and_b32 v50, 7, v48
    v_mul_u32_u24 v50, 8224, v50
    ds_write2st64_b32 v228, v206, v207 offset0:14 offset1:15
    ds_write2st64_b32 v228, v208, v210 offset0:16 offset1:18
    s_add_u32 s58, s58, 4096
    buffer_load_dwordx4 v[144:147], v229, s[8:11], s58 offen offset:0 sc1
    v_mul_u32_u24 v51, 1536, v55
    v_add_u32 v50, v50, v51
    ds_write_b16 v226, v209 offset:4352
    ds_write2st64_b32 v228, v211, v212 offset0:19 offset1:20
    buffer_load_dwordx4 v[148:151], v229, s[8:11], s58 offen offset:1024 sc1
    v_add_u32 v222, v50, v52
    v_mul_u32_u24 v51, 8224, v54
    ds_write2st64_b32 v228, v213, v214 offset0:21 offset1:22
    ds_write2st64_b32 v228, v216, v217 offset0:24 offset1:25
    buffer_load_dwordx4 v[152:155], v229, s[8:11], s58 offen offset:2048 sc1
    v_add_u32 v232, v51, v52
    v_lshl_add_u32 v247, v55, 7, v232
    ds_write_b16 v226, v215 offset:5888
    ds_write2st64_b32 v228, v218, v219 offset0:26 offset1:27
    buffer_load_dwordx4 v[156:159], v229, s[8:11], s58 offen offset:3072 sc1
    v_mul_u32_u24 v51, 2080, v48
    s_mov_b32 s60, 65536
    ds_write_b32 v228, v220 offset:7168
    ds_write_b16 v226, v221 offset:7424
    s_add_u32 s58, s58, 4096
    buffer_load_dwordx4 v[160:163], v229, s[8:11], s58 offen offset:0 sc1
    v_add3_u32 v223, v51, v52, s60
    v_mul_u32_u24 v51, 2080, v54
    buffer_load_dwordx4 v[164:167], v229, s[8:11], s58 offen offset:1024 sc1
    s_mov_b32 s60, 132096
    v_add3_u32 v225, v51, v52, s60
    buffer_load_dwordx4 v[168:171], v229, s[8:11], s58 offen offset:2048 sc1
    v_lshl_add_u32 v248, v55, 7, v225
    s_lshl_b32 s60, s20, 5
    buffer_load_dwordx4 v[172:175], v229, s[8:11], s58 offen offset:3072 sc1
    v_lshl_add_u32 v49, v49, 3, s60
    s_mov_b32 s60, 65536
    v_add3_u32 v255, v51, v49, s60
    v_lshl_add_u32 v246, v55, 9, v255
    v_bfe_u32 v53, v48, 2, 1
    v_lshl_add_u32 v49, v53, 4, v49
    v_add_u32 v254, v50, v49
    s_and_b32 s64, s55, s28
    s_waitcnt lgkmcnt(0)
    s_barrier
    s_cmp_eq_u32 s64, 0
    s_cbranch_scc1 K2_MULTI
    s_setprio 3
    ds_read_b128 v[48:51], v222 offset:0
    ds_read_b128 v[52:55], v222 offset:64
    ds_read_b128 v[56:59], v222 offset:896
    ds_read_b128 v[60:63], v222 offset:960
    ds_read_b128 v[64:67], v223 offset:0
    ds_read_b128 v[68:71], v223 offset:64
    ds_read_b128 v[72:75], v223 offset:896
    ds_read_b128 v[76:79], v223 offset:960
    ds_read_b128 v[80:83], v222 offset:3072
    ds_read_b128 v[84:87], v222 offset:3136
    ds_read_b128 v[88:91], v222 offset:3968
    s_waitcnt vmcnt(19) lgkmcnt(9)
    v_mfma_f32_16x16x32_bf16 v[0:3], v[96:99], v[48:51], 0
    ds_read_b128 v[92:95], v222 offset:4032
    s_waitcnt vmcnt(18)
    v_mfma_f32_16x16x32_bf16 v[0:3], v[100:103], v[52:55], v[0:3]
    ds_read_b128 v[48:51], v223 offset:33280
    s_waitcnt vmcnt(17) lgkmcnt(9)
    v_mfma_f32_16x16x32_bf16 v[0:3], v[104:107], v[56:59], v[0:3]
    s_bfe_u32 s60, s20, 0x10002
    s_lshl_b32 s60, s60, 4
    ds_read_b128 v[52:55], v223 offset:33344
    s_waitcnt vmcnt(16)
    v_mfma_f32_16x16x32_bf16 v[0:3], v[108:111], v[60:63], v[0:3]
    s_add_u32 s59, s59, s60
    v_add_u32 v228, s59, v229
    ds_read_b128 v[56:59], v223 offset:34176
    s_waitcnt vmcnt(15) lgkmcnt(9)
    v_mfma_f32_16x16x32_bf16 v[0:3], v[128:131], v[64:67], v[0:3]
    s_mul_i32 s60, s20, 2080
    s_add_u32 s60, s60, 65536
    ds_read_b128 v[60:63], v223 offset:34240
    s_waitcnt vmcnt(14)
    v_mfma_f32_16x16x32_bf16 v[0:3], v[132:135], v[68:71], v[0:3]
    v_add_u32 v249, s60, v229
    s_mov_b32 s63, 0xbfb8aa3b
    ds_read_b128 v[64:67], v232 offset:6144
    s_waitcnt vmcnt(13) lgkmcnt(9)
    v_mfma_f32_16x16x32_bf16 v[0:3], v[136:139], v[72:75], v[0:3]
    s_add_u32 s40, s20, s21
    s_lshl_b32 s40, s40, 10
    ds_read_b128 v[68:71], v232 offset:6208
    s_waitcnt vmcnt(12)
    v_mfma_f32_16x16x32_bf16 v[0:3], v[140:143], v[76:79], v[0:3]
    s_add_u32 s41, s40, 8192
    s_add_u32 s42, s40, 16384
    ds_read_b128 v[72:75], v232 offset:7040
    s_waitcnt lgkmcnt(9)
    v_mfma_f32_16x16x32_bf16 v[16:19], v[96:99], v[80:83], 0
    s_add_u32 s43, s40, 24576
    s_add_u32 s44, s40, 32768
    ds_read_b128 v[76:79], v232 offset:7104
    v_mfma_f32_16x16x32_bf16 v[16:19], v[100:103], v[84:87], v[16:19]
    ds_read_b128 v[80:83], v225 offset:0
    s_waitcnt lgkmcnt(9)
    v_mfma_f32_16x16x32_bf16 v[16:19], v[104:107], v[88:91], v[16:19]
    ds_read_b128 v[84:87], v225 offset:64
    v_mfma_f32_16x16x32_bf16 v[16:19], v[108:111], v[92:95], v[16:19]
    v_mul_f32 v204, s63, v0
    v_mul_f32 v205, s63, v1
    ds_read_b128 v[88:91], v225 offset:896
    s_waitcnt lgkmcnt(9)
    v_mfma_f32_16x16x32_bf16 v[16:19], v[128:131], v[48:51], v[16:19]
    v_mul_f32 v206, s63, v2
    ds_read_b128 v[92:95], v225 offset:960
    v_mfma_f32_16x16x32_bf16 v[16:19], v[132:135], v[52:55], v[16:19]
    v_mul_f32 v207, s63, v3
    ds_read_b128 v[48:51], v222 offset:128
    s_waitcnt lgkmcnt(9)
    v_mfma_f32_16x16x32_bf16 v[16:19], v[136:139], v[56:59], v[16:19]
    v_exp_f32 v204, v204
    ds_read_b128 v[52:55], v222 offset:384
    v_mfma_f32_16x16x32_bf16 v[16:19], v[140:143], v[60:63], v[16:19]
    v_exp_f32 v205, v205
    ds_read_b128 v[56:59], v222 offset:256
    s_waitcnt lgkmcnt(9)
    v_mfma_f32_16x16x32_bf16 v[32:35], v[96:99], v[64:67], 0
    v_exp_f32 v206, v206
    ds_read_b128 v[60:63], v222 offset:192
    v_mfma_f32_16x16x32_bf16 v[32:35], v[100:103], v[68:71], v[32:35]
    v_exp_f32 v207, v207
    s_setprio 2
    ds_read_b128 v[64:67], v222 offset:448
    s_waitcnt lgkmcnt(9)
    v_mfma_f32_16x16x32_bf16 v[32:35], v[104:107], v[72:75], v[32:35]
    v_add_f32 v204, 1.0, v204
    ds_read_b128 v[68:71], v222 offset:320
    v_mfma_f32_16x16x32_bf16 v[32:35], v[108:111], v[76:79], v[32:35]
    v_add_f32 v205, 1.0, v205
    v_add_f32 v206, 1.0, v206
    ds_read_b128 v[72:75], v222 offset:640
    s_waitcnt lgkmcnt(9)
    v_mfma_f32_16x16x32_bf16 v[32:35], v[128:131], v[80:83], v[32:35]
    v_add_f32 v207, 1.0, v207
    ds_read_b128 v[76:79], v222 offset:512
    v_mfma_f32_16x16x32_bf16 v[32:35], v[132:135], v[84:87], v[32:35]
    v_rcp_f32 v204, v204
    ds_read_b128 v[80:83], v222 offset:768
    s_waitcnt lgkmcnt(9)
    v_mfma_f32_16x16x32_bf16 v[32:35], v[136:139], v[88:91], v[32:35]
    v_rcp_f32 v205, v205
    ds_read_b128 v[84:87], v222 offset:704
    v_mfma_f32_16x16x32_bf16 v[32:35], v[140:143], v[92:95], v[32:35]
    v_rcp_f32 v206, v206
    ds_read_b128 v[88:91], v222 offset:576
    s_waitcnt vmcnt(11) lgkmcnt(9)
    v_mfma_f32_16x16x32_bf16 v[4:7], v[112:115], v[48:51], 0
    v_rcp_f32 v207, v207
    ds_read_b128 v[92:95], v222 offset:832
    v_mfma_f32_16x16x32_bf16 v[8:11], v[112:115], v[52:55], 0
    v_cvt_pk_bf16_f32 v176, v0, v1
    ds_read_b128 v[48:51], v222 offset:1024
    s_waitcnt lgkmcnt(9)
    v_mfma_f32_16x16x32_bf16 v[12:15], v[112:115], v[56:59], 0
    v_cvt_pk_bf16_f32 v177, v2, v3
    ds_read_b128 v[52:55], v222 offset:1280
    s_waitcnt vmcnt(10)
    v_mfma_f32_16x16x32_bf16 v[4:7], v[116:119], v[60:63], v[4:7]
    v_mul_f32 v208, s63, v16
    v_mul_f32 v209, s63, v17
    ds_read_b128 v[56:59], v222 offset:1152
    s_waitcnt lgkmcnt(9)
    v_mfma_f32_16x16x32_bf16 v[8:11], v[116:119], v[64:67], v[8:11]
    v_mul_f32 v210, s63, v18
    ds_read_b128 v[60:63], v222 offset:1088
    v_mfma_f32_16x16x32_bf16 v[12:15], v[116:119], v[68:71], v[12:15]
    v_mul_f32 v211, s63, v19
    ds_read_b128 v[64:67], v222 offset:1344
    s_waitcnt vmcnt(9) lgkmcnt(9)
    v_mfma_f32_16x16x32_bf16 v[4:7], v[120:123], v[72:75], v[4:7]
    v_exp_f32 v208, v208
    ds_read_b128 v[68:71], v222 offset:1216
    v_mfma_f32_16x16x32_bf16 v[8:11], v[120:123], v[76:79], v[8:11]
    v_exp_f32 v209, v209
    ds_read_b128 v[72:75], v223 offset:128
    s_waitcnt lgkmcnt(9)
    v_mfma_f32_16x16x32_bf16 v[12:15], v[120:123], v[80:83], v[12:15]
    v_exp_f32 v210, v210
    ds_read_b128 v[76:79], v223 offset:384
    s_waitcnt vmcnt(8)
    v_mfma_f32_16x16x32_bf16 v[4:7], v[124:127], v[84:87], v[4:7]
    v_exp_f32 v211, v211
    ds_read_b128 v[80:83], v223 offset:256
    s_waitcnt lgkmcnt(9)
    v_mfma_f32_16x16x32_bf16 v[8:11], v[124:127], v[88:91], v[8:11]
    v_add_f32 v208, 1.0, v208
    ds_read_b128 v[84:87], v223 offset:192
    v_mfma_f32_16x16x32_bf16 v[12:15], v[124:127], v[92:95], v[12:15]
    v_add_f32 v209, 1.0, v209
    v_add_f32 v210, 1.0, v210
    ds_read_b128 v[88:91], v223 offset:448
    s_waitcnt vmcnt(7) lgkmcnt(9)
    v_mfma_f32_16x16x32_bf16 v[4:7], v[144:147], v[48:51], v[4:7]
    v_add_f32 v211, 1.0, v211
    s_setprio 1
    ds_read_b128 v[92:95], v223 offset:320
    v_mfma_f32_16x16x32_bf16 v[8:11], v[144:147], v[52:55], v[8:11]
    v_rcp_f32 v208, v208
    ds_read_b128 v[48:51], v223 offset:640
    s_waitcnt lgkmcnt(9)
    v_mfma_f32_16x16x32_bf16 v[12:15], v[144:147], v[56:59], v[12:15]
    v_rcp_f32 v209, v209
    ds_read_b128 v[52:55], v223 offset:512
    s_waitcnt vmcnt(6)
    v_mfma_f32_16x16x32_bf16 v[4:7], v[148:151], v[60:63], v[4:7]
    v_rcp_f32 v210, v210
    ds_read_b128 v[56:59], v223 offset:768
    s_waitcnt lgkmcnt(9)
    v_mfma_f32_16x16x32_bf16 v[8:11], v[148:151], v[64:67], v[8:11]
    v_rcp_f32 v211, v211
    ds_read_b128 v[60:63], v223 offset:704
    v_mfma_f32_16x16x32_bf16 v[12:15], v[148:151], v[68:71], v[12:15]
K2_PAD_T2:
    s_cbranch_execz K2_HOP
    v_cvt_pk_bf16_f32 v184, v16, v17
    ds_read_b128 v[64:67], v223 offset:576
    s_waitcnt vmcnt(5) lgkmcnt(9)
    v_mfma_f32_16x16x32_bf16 v[4:7], v[152:155], v[72:75], v[4:7]
    v_cvt_pk_bf16_f32 v185, v18, v19
    ds_read_b128 v[68:71], v223 offset:832
    v_mfma_f32_16x16x32_bf16 v[8:11], v[152:155], v[76:79], v[8:11]
    v_mul_f32 v212, s63, v32
    v_mul_f32 v213, s63, v33
    ds_read_b128 v[72:75], v223 offset:1024
    s_waitcnt lgkmcnt(9)
    v_mfma_f32_16x16x32_bf16 v[12:15], v[152:155], v[80:83], v[12:15]
    v_mul_f32 v214, s63, v34
    ds_read_b128 v[76:79], v223 offset:1280
    s_waitcnt vmcnt(4)
    v_mfma_f32_16x16x32_bf16 v[4:7], v[156:159], v[84:87], v[4:7]
    v_mul_f32 v215, s63, v35
    ds_read_b128 v[80:83], v223 offset:1152
    s_waitcnt lgkmcnt(9)
    v_mfma_f32_16x16x32_bf16 v[8:11], v[156:159], v[88:91], v[8:11]
    v_exp_f32 v212, v212
    ds_read_b128 v[84:87], v223 offset:1088
    v_mfma_f32_16x16x32_bf16 v[12:15], v[156:159], v[92:95], v[12:15]
    v_exp_f32 v213, v213
    ds_read_b128 v[88:91], v223 offset:1344
    s_waitcnt vmcnt(3) lgkmcnt(9)
    v_mfma_f32_16x16x32_bf16 v[4:7], v[160:163], v[48:51], v[4:7]
    v_exp_f32 v214, v214
    ds_read_b128 v[92:95], v223 offset:1216
    v_mfma_f32_16x16x32_bf16 v[8:11], v[160:163], v[52:55], v[8:11]
    v_exp_f32 v215, v215
    ds_read_b128 v[48:51], v222 offset:3200
    s_waitcnt lgkmcnt(9)
    v_mfma_f32_16x16x32_bf16 v[12:15], v[160:163], v[56:59], v[12:15]
    v_add_f32 v212, 1.0, v212
    ds_read_b128 v[52:55], v222 offset:3456
    s_waitcnt vmcnt(2)
    v_mfma_f32_16x16x32_bf16 v[4:7], v[164:167], v[60:63], v[4:7]
    v_add_f32 v213, 1.0, v213
    v_add_f32 v214, 1.0, v214
    ds_read_b128 v[56:59], v222 offset:3328
    s_waitcnt lgkmcnt(9)
    v_mfma_f32_16x16x32_bf16 v[8:11], v[164:167], v[64:67], v[8:11]
    v_add_f32 v215, 1.0, v215
    ds_read_b128 v[60:63], v222 offset:3264
    v_mfma_f32_16x16x32_bf16 v[12:15], v[164:167], v[68:71], v[12:15]
    v_rcp_f32 v212, v212
    s_setprio 0
    ds_read_b128 v[64:67], v222 offset:3520
    s_waitcnt vmcnt(1) lgkmcnt(9)
    v_mfma_f32_16x16x32_bf16 v[4:7], v[168:171], v[72:75], v[4:7]
    v_rcp_f32 v213, v213
    ds_read_b128 v[68:71], v222 offset:3392
    v_mfma_f32_16x16x32_bf16 v[8:11], v[168:171], v[76:79], v[8:11]
    v_rcp_f32 v214, v214
    ds_read_b128 v[72:75], v222 offset:3712
    s_waitcnt lgkmcnt(9)
    v_mfma_f32_16x16x32_bf16 v[12:15], v[168:171], v[80:83], v[12:15]
    v_rcp_f32 v215, v215
    ds_read_b128 v[76:79], v222 offset:3584
    s_waitcnt vmcnt(0)
    v_mfma_f32_16x16x32_bf16 v[4:7], v[172:175], v[84:87], v[4:7]
    v_cvt_pk_bf16_f32 v220, v32, v33
    ds_read_b128 v[80:83], v222 offset:3840
    s_waitcnt lgkmcnt(9)
    v_mfma_f32_16x16x32_bf16 v[8:11], v[172:175], v[88:91], v[8:11]
    v_cvt_pk_bf16_f32 v221, v34, v35
    ds_read_b128 v[84:87], v222 offset:3776
    v_mfma_f32_16x16x32_bf16 v[12:15], v[172:175], v[92:95], v[12:15]
    ds_read_b128 v[88:91], v222 offset:3648
    s_waitcnt lgkmcnt(9)
    v_mfma_f32_16x16x32_bf16 v[20:23], v[112:115], v[48:51], 0
    ds_read_b128 v[92:95], v222 offset:3904
    v_mfma_f32_16x16x32_bf16 v[24:27], v[112:115], v[52:55], 0
    ds_read_b128 v[48:51], v222 offset:4096
    s_waitcnt lgkmcnt(9)
    v_mfma_f32_16x16x32_bf16 v[28:31], v[112:115], v[56:59], 0
    s_barrier
    s_setprio 3
    ds_read_b128 v[52:55], v222 offset:4352
    v_mfma_f32_16x16x32_bf16 v[20:23], v[116:119], v[60:63], v[20:23]
    v_mul_f32 v4, v4, v204
    ds_read_b128 v[56:59], v222 offset:4224
    s_waitcnt lgkmcnt(9)
    v_mfma_f32_16x16x32_bf16 v[24:27], v[116:119], v[64:67], v[24:27]
    v_mul_f32 v5, v5, v205
    ds_read_b128 v[60:63], v222 offset:4160
    v_mfma_f32_16x16x32_bf16 v[28:31], v[116:119], v[68:71], v[28:31]
    v_mul_f32 v6, v6, v206
    ds_read_b128 v[64:67], v222 offset:4416
    s_waitcnt lgkmcnt(9)
    v_mfma_f32_16x16x32_bf16 v[20:23], v[120:123], v[72:75], v[20:23]
    v_mul_f32 v7, v7, v207
    ds_read_b128 v[68:71], v222 offset:4288
    v_mfma_f32_16x16x32_bf16 v[24:27], v[120:123], v[76:79], v[24:27]
    v_cvt_pk_bf16_f32 v178, v4, v5
    ds_read_b128 v[72:75], v223 offset:33408
    s_waitcnt lgkmcnt(9)
    v_mfma_f32_16x16x32_bf16 v[28:31], v[120:123], v[80:83], v[28:31]
    v_cvt_pk_bf16_f32 v179, v6, v7
    ds_read_b128 v[76:79], v223 offset:33664
    v_mfma_f32_16x16x32_bf16 v[20:23], v[124:127], v[84:87], v[20:23]
    v_mul_f32 v8, v8, v204
    ds_read_b128 v[80:83], v223 offset:33536
    s_waitcnt lgkmcnt(9)
    v_mfma_f32_16x16x32_bf16 v[24:27], v[124:127], v[88:91], v[24:27]
    v_mul_f32 v9, v9, v205
    ds_read_b128 v[84:87], v223 offset:33472
    v_mfma_f32_16x16x32_bf16 v[28:31], v[124:127], v[92:95], v[28:31]
    v_mul_f32 v10, v10, v206
    ds_read_b128 v[88:91], v223 offset:33728
    s_waitcnt lgkmcnt(9)
    v_mfma_f32_16x16x32_bf16 v[20:23], v[144:147], v[48:51], v[20:23]
    v_mul_f32 v11, v11, v207
    s_setprio 2
    ds_read_b128 v[92:95], v223 offset:33600
    v_mfma_f32_16x16x32_bf16 v[24:27], v[144:147], v[52:55], v[24:27]
    v_cvt_pk_bf16_f32 v180, v8, v9
    ds_read_b128 v[48:51], v223 offset:33920
    s_waitcnt lgkmcnt(9)
    v_mfma_f32_16x16x32_bf16 v[28:31], v[144:147], v[56:59], v[28:31]
    v_cvt_pk_bf16_f32 v181, v10, v11
    ds_read_b128 v[52:55], v223 offset:33792
    v_mfma_f32_16x16x32_bf16 v[20:23], v[148:151], v[60:63], v[20:23]
    v_mul_f32 v12, v12, v204
    ds_read_b128 v[56:59], v223 offset:34048
    s_waitcnt lgkmcnt(9)
    v_mfma_f32_16x16x32_bf16 v[24:27], v[148:151], v[64:67], v[24:27]
    v_mul_f32 v13, v13, v205
    ds_read_b128 v[60:63], v223 offset:33984
    v_mfma_f32_16x16x32_bf16 v[28:31], v[148:151], v[68:71], v[28:31]
    v_mul_f32 v14, v14, v206
    ds_read_b128 v[64:67], v223 offset:33856
    s_waitcnt lgkmcnt(9)
    v_mfma_f32_16x16x32_bf16 v[20:23], v[152:155], v[72:75], v[20:23]
    v_mul_f32 v15, v15, v207
    ds_read_b128 v[68:71], v223 offset:34112
    v_mfma_f32_16x16x32_bf16 v[24:27], v[152:155], v[76:79], v[24:27]
    v_cvt_pk_bf16_f32 v182, v12, v13
    ds_read_b128 v[72:75], v223 offset:34304
    s_waitcnt lgkmcnt(9)
    v_mfma_f32_16x16x32_bf16 v[28:31], v[152:155], v[80:83], v[28:31]
    v_cvt_pk_bf16_f32 v183, v14, v15
    ds_read_b128 v[76:79], v223 offset:34560
    v_mfma_f32_16x16x32_bf16 v[20:23], v[156:159], v[84:87], v[20:23]
    ds_write_b64 v254, v[176:177] offset:0
    ds_write_b64 v254, v[178:179] offset:256
    ds_write_b64 v254, v[180:181] offset:512
    ds_write_b64 v254, v[182:183] offset:768
    ds_write_b64 v255, v[220:221] offset:0
    ds_read_b128 v[80:83], v223 offset:34432
    s_waitcnt lgkmcnt(14)
    v_mfma_f32_16x16x32_bf16 v[24:27], v[156:159], v[88:91], v[24:27]
    ds_read_b128 v[84:87], v223 offset:34368
    v_mfma_f32_16x16x32_bf16 v[28:31], v[156:159], v[92:95], v[28:31]
    s_setprio 1
    ds_read_b128 v[88:91], v223 offset:34624
    s_waitcnt lgkmcnt(14)
    v_mfma_f32_16x16x32_bf16 v[20:23], v[160:163], v[48:51], v[20:23]
    ds_read_b128 v[92:95], v223 offset:34496
    v_mfma_f32_16x16x32_bf16 v[24:27], v[160:163], v[52:55], v[24:27]
    ds_read_b128 v[48:51], v247 offset:6272
    s_waitcnt lgkmcnt(14)
    v_mfma_f32_16x16x32_bf16 v[28:31], v[160:163], v[56:59], v[28:31]
    ds_read_b128 v[52:55], v232 offset:6528
    v_mfma_f32_16x16x32_bf16 v[20:23], v[164:167], v[60:63], v[20:23]
    ds_read_b128 v[56:59], v247 offset:6336
    s_waitcnt lgkmcnt(14)
    v_mfma_f32_16x16x32_bf16 v[24:27], v[164:167], v[64:67], v[24:27]
    ds_read_b128 v[60:63], v232 offset:6592
    v_mfma_f32_16x16x32_bf16 v[28:31], v[164:167], v[68:71], v[28:31]
    ds_read_b128 v[64:67], v247 offset:6784
    s_waitcnt lgkmcnt(14)
    v_mfma_f32_16x16x32_bf16 v[20:23], v[168:171], v[72:75], v[20:23]
    ds_read_b128 v[68:71], v232 offset:6656
    v_mfma_f32_16x16x32_bf16 v[24:27], v[168:171], v[76:79], v[24:27]
    ds_read_b128 v[72:75], v247 offset:6848
    s_waitcnt lgkmcnt(9)
    v_mfma_f32_16x16x32_bf16 v[28:31], v[168:171], v[80:83], v[28:31]
    ds_read_b128 v[76:79], v232 offset:6720
    v_mfma_f32_16x16x32_bf16 v[20:23], v[172:175], v[84:87], v[20:23]
    s_setprio 0
    ds_read_b128 v[80:83], v247 offset:7168
    s_waitcnt lgkmcnt(9)
    v_mfma_f32_16x16x32_bf16 v[24:27], v[172:175], v[88:91], v[24:27]
    ds_read_b128 v[84:87], v232 offset:7424
    v_mfma_f32_16x16x32_bf16 v[28:31], v[172:175], v[92:95], v[28:31]
    ds_read_b128 v[88:91], v247 offset:7232
    s_waitcnt lgkmcnt(9)
    v_mfma_f32_16x16x32_bf16 v[36:39], v[112:115], v[48:51], 0
    ds_read_b128 v[92:95], v232 offset:7488
    v_mfma_f32_16x16x32_bf16 v[40:43], v[112:115], v[52:55], 0
    ds_read_b128 v[48:51], v248 offset:128
    s_waitcnt lgkmcnt(9)
    v_mfma_f32_16x16x32_bf16 v[36:39], v[116:119], v[56:59], v[36:39]
    s_barrier
    ds_read_b128 v[192:195], v228 offset:0
    ds_read_b128 v[196:199], v228 offset:1536
    s_setprio 3
    ds_read_b128 v[52:55], v225 offset:384
    v_mfma_f32_16x16x32_bf16 v[40:43], v[116:119], v[60:63], v[40:43]
    v_mul_f32 v20, v20, v208
    v_mul_f32 v21, v21, v209
    ds_read_b128 v[56:59], v248 offset:192
    s_waitcnt lgkmcnt(11)
    v_mfma_f32_16x16x32_bf16 v[36:39], v[120:123], v[64:67], v[36:39]
    v_mul_f32 v22, v22, v210
    ds_read_b128 v[60:63], v225 offset:448
    v_mfma_f32_16x16x32_bf16 v[40:43], v[120:123], v[68:71], v[40:43]
    v_mul_f32 v23, v23, v211
    ds_read_b128 v[64:67], v248 offset:640
    s_waitcnt lgkmcnt(11)
    v_mfma_f32_16x16x32_bf16 v[36:39], v[124:127], v[72:75], v[36:39]
    v_cvt_pk_bf16_f32 v186, v20, v21
    ds_read_b128 v[68:71], v225 offset:512
    v_mfma_f32_16x16x32_bf16 v[40:43], v[124:127], v[76:79], v[40:43]
    v_cvt_pk_bf16_f32 v187, v22, v23
    ds_read_b128 v[72:75], v248 offset:704
    s_waitcnt lgkmcnt(11)
    v_mfma_f32_16x16x32_bf16 v[36:39], v[144:147], v[80:83], v[36:39]
    v_mul_f32 v24, v24, v208
    v_mul_f32 v25, v25, v209
    s_waitcnt lgkmcnt(6)
    buffer_store_dwordx4 v[192:195], v229, s[12:15], s40 offen sc1
    buffer_store_dwordx4 v[196:199], v229, s[12:15], s41 offen sc1
    s_setprio 2
    ds_read_b128 v[76:79], v225 offset:576
    v_mfma_f32_16x16x32_bf16 v[40:43], v[144:147], v[84:87], v[40:43]
    v_mul_f32 v26, v26, v210
    ds_read_b128 v[80:83], v248 offset:1024
    v_mfma_f32_16x16x32_bf16 v[36:39], v[148:151], v[88:91], v[36:39]
    v_mul_f32 v27, v27, v211
    ds_read_b128 v[84:87], v225 offset:1280
    v_mfma_f32_16x16x32_bf16 v[40:43], v[148:151], v[92:95], v[40:43]
    v_cvt_pk_bf16_f32 v188, v24, v25
    ds_read_b128 v[88:91], v248 offset:1088
    s_waitcnt lgkmcnt(9)
    v_mfma_f32_16x16x32_bf16 v[36:39], v[152:155], v[48:51], v[36:39]
    v_cvt_pk_bf16_f32 v189, v26, v27
    ds_read_b128 v[92:95], v225 offset:1344
    v_mfma_f32_16x16x32_bf16 v[40:43], v[152:155], v[52:55], v[40:43]
    v_mul_f32 v28, v28, v208
    v_mul_f32 v29, v29, v209
    s_waitcnt lgkmcnt(8)
    v_mfma_f32_16x16x32_bf16 v[36:39], v[156:159], v[56:59], v[36:39]
    v_mul_f32 v30, v30, v210
    v_mfma_f32_16x16x32_bf16 v[40:43], v[156:159], v[60:63], v[40:43]
    v_mul_f32 v31, v31, v211
    s_setprio 1
    s_waitcnt lgkmcnt(6)
    v_mfma_f32_16x16x32_bf16 v[36:39], v[160:163], v[64:67], v[36:39]
    v_cvt_pk_bf16_f32 v190, v28, v29
    v_mfma_f32_16x16x32_bf16 v[40:43], v[160:163], v[68:71], v[40:43]
    v_cvt_pk_bf16_f32 v191, v30, v31
    s_waitcnt lgkmcnt(4)
    v_mfma_f32_16x16x32_bf16 v[36:39], v[164:167], v[72:75], v[36:39]
    ds_write_b64 v254, v[184:185] offset:3072
    ds_write_b64 v254, v[186:187] offset:3328
    ds_write_b64 v254, v[188:189] offset:3584
    ds_write_b64 v254, v[190:191] offset:3840
    v_mfma_f32_16x16x32_bf16 v[40:43], v[164:167], v[76:79], v[40:43]
    s_waitcnt lgkmcnt(6)
    v_mfma_f32_16x16x32_bf16 v[36:39], v[168:171], v[80:83], v[36:39]
    v_mfma_f32_16x16x32_bf16 v[40:43], v[168:171], v[84:87], v[40:43]
    s_setprio 0
    s_waitcnt lgkmcnt(4)
    v_mfma_f32_16x16x32_bf16 v[36:39], v[172:175], v[88:91], v[36:39]
    v_mfma_f32_16x16x32_bf16 v[40:43], v[172:175], v[92:95], v[40:43]
    s_nop 6
    v_mul_f32 v36, v36, v212
    v_mul_f32 v37, v37, v213
    v_mul_f32 v38, v38, v214
    v_mul_f32 v39, v39, v215
    v_cvt_pk_bf16_f32 v178, v36, v37
    v_cvt_pk_bf16_f32 v179, v38, v39
    v_mul_f32 v40, v40, v212
    v_mul_f32 v41, v41, v213
    v_mul_f32 v42, v42, v214
    v_mul_f32 v43, v43, v215
    v_cvt_pk_bf16_f32 v180, v40, v41
    v_cvt_pk_bf16_f32 v181, v42, v43
    ds_write_b64 v246, v[178:179] offset:256
    ds_write_b64 v255, v[180:181] offset:512
    s_waitcnt lgkmcnt(0)
    s_barrier
    ds_read_b128 v[192:195], v228 offset:3072
    ds_read_b128 v[196:199], v228 offset:4608
    ds_read_b128 v[200:203], v249
    s_waitcnt lgkmcnt(1)
    buffer_store_dwordx4 v[192:195], v229, s[12:15], s42 offen sc1
    buffer_store_dwordx4 v[196:199], v229, s[12:15], s43 offen sc1
K2_LASTROW:
    s_add_u32 s59, s20, 32
    s_cmp_ge_u32 s59, s22
    s_cbranch_scc1 K2_FIN
    s_waitcnt lgkmcnt(0)
    buffer_store_dwordx4 v[200:203], v229, s[12:15], s44 offen sc1
K2_FIN:
    s_endpgm
K2_MULTI:
    ds_read_b128 v[48:51], v222 offset:0
    ds_read_b128 v[52:55], v222 offset:64
    ds_read_b128 v[56:59], v222 offset:896
    ds_read_b128 v[60:63], v222 offset:960
    ds_read_b128 v[64:67], v223 offset:0
    ds_read_b128 v[68:71], v223 offset:64
    ds_read_b128 v[72:75], v223 offset:896
    ds_read_b128 v[76:79], v223 offset:960
    ds_read_b128 v[80:83], v222 offset:3072
    ds_read_b128 v[84:87], v222 offset:3136
    ds_read_b128 v[88:91], v222 offset:3968
    s_waitcnt vmcnt(19) lgkmcnt(9)
    v_mfma_f32_16x16x32_bf16 v[0:3], v[96:99], v[48:51], 0
    ds_read_b128 v[92:95], v222 offset:4032
    s_waitcnt vmcnt(18)
    v_mfma_f32_16x16x32_bf16 v[0:3], v[100:103], v[52:55], v[0:3]
    ds_read_b128 v[48:51], v223 offset:33280
    s_waitcnt vmcnt(17) lgkmcnt(9)
    v_mfma_f32_16x16x32_bf16 v[0:3], v[104:107], v[56:59], v[0:3]
    ds_read_b128 v[52:55], v223 offset:33344
    s_waitcnt vmcnt(16)
    v_mfma_f32_16x16x32_bf16 v[0:3], v[108:111], v[60:63], v[0:3]
    ds_read_b128 v[56:59], v223 offset:34176
    s_waitcnt vmcnt(15) lgkmcnt(9)
    v_mfma_f32_16x16x32_bf16 v[0:3], v[128:131], v[64:67], v[0:3]
    ds_read_b128 v[60:63], v223 offset:34240
    s_waitcnt vmcnt(14)
    v_mfma_f32_16x16x32_bf16 v[0:3], v[132:135], v[68:71], v[0:3]
    ds_read_b128 v[64:67], v232 offset:6144
    s_waitcnt vmcnt(13) lgkmcnt(9)
    v_mfma_f32_16x16x32_bf16 v[0:3], v[136:139], v[72:75], v[0:3]
    ds_read_b128 v[68:71], v232 offset:6208
    s_waitcnt vmcnt(12)
    v_mfma_f32_16x16x32_bf16 v[0:3], v[140:143], v[76:79], v[0:3]
    ds_read_b128 v[72:75], v232 offset:7040
    s_waitcnt lgkmcnt(9)
    v_mfma_f32_16x16x32_bf16 v[16:19], v[96:99], v[80:83], 0
    ds_read_b128 v[76:79], v232 offset:7104
    v_mfma_f32_16x16x32_bf16 v[16:19], v[100:103], v[84:87], v[16:19]
    ds_read_b128 v[80:83], v225 offset:0
    s_waitcnt lgkmcnt(9)
    v_mfma_f32_16x16x32_bf16 v[16:19], v[104:107], v[88:91], v[16:19]
    ds_read_b128 v[84:87], v225 offset:64
    v_mfma_f32_16x16x32_bf16 v[16:19], v[108:111], v[92:95], v[16:19]
    ds_read_b128 v[88:91], v225 offset:896
    s_waitcnt lgkmcnt(9)
    v_mfma_f32_16x16x32_bf16 v[16:19], v[128:131], v[48:51], v[16:19]
    ds_read_b128 v[92:95], v225 offset:960
    v_mfma_f32_16x16x32_bf16 v[16:19], v[132:135], v[52:55], v[16:19]
    ds_read_b128 v[48:51], v222 offset:128
    s_waitcnt lgkmcnt(9)
    v_mfma_f32_16x16x32_bf16 v[16:19], v[136:139], v[56:59], v[16:19]
    ds_read_b128 v[52:55], v222 offset:384
    v_mfma_f32_16x16x32_bf16 v[16:19], v[140:143], v[60:63], v[16:19]
    ds_read_b128 v[56:59], v222 offset:256
    s_waitcnt lgkmcnt(9)
    v_mfma_f32_16x16x32_bf16 v[32:35], v[96:99], v[64:67], 0
    ds_read_b128 v[60:63], v222 offset:192
    v_mfma_f32_16x16x32_bf16 v[32:35], v[100:103], v[68:71], v[32:35]
    ds_read_b128 v[64:67], v222 offset:448
    s_waitcnt lgkmcnt(9)
    v_mfma_f32_16x16x32_bf16 v[32:35], v[104:107], v[72:75], v[32:35]
    ds_read_b128 v[68:71], v222 offset:320
    v_mfma_f32_16x16x32_bf16 v[32:35], v[108:111], v[76:79], v[32:35]
    ds_read_b128 v[72:75], v222 offset:640
    s_waitcnt lgkmcnt(9)
    v_mfma_f32_16x16x32_bf16 v[32:35], v[128:131], v[80:83], v[32:35]
    ds_read_b128 v[76:79], v222 offset:512
    v_mfma_f32_16x16x32_bf16 v[32:35], v[132:135], v[84:87], v[32:35]
    ds_read_b128 v[80:83], v222 offset:768
    s_waitcnt lgkmcnt(9)
    v_mfma_f32_16x16x32_bf16 v[32:35], v[136:139], v[88:91], v[32:35]
    ds_read_b128 v[84:87], v222 offset:704
    v_mfma_f32_16x16x32_bf16 v[32:35], v[140:143], v[92:95], v[32:35]
    ds_read_b128 v[88:91], v222 offset:576
    s_waitcnt vmcnt(11) lgkmcnt(9)
    v_mfma_f32_16x16x32_bf16 v[4:7], v[112:115], v[48:51], 0
    ds_read_b128 v[92:95], v222 offset:832
    v_mfma_f32_16x16x32_bf16 v[8:11], v[112:115], v[52:55], 0
    ds_read_b128 v[48:51], v222 offset:1024
    s_waitcnt lgkmcnt(9)
    v_mfma_f32_16x16x32_bf16 v[12:15], v[112:115], v[56:59], 0
    ds_read_b128 v[52:55], v222 offset:1280
    s_waitcnt vmcnt(10)
    v_mfma_f32_16x16x32_bf16 v[4:7], v[116:119], v[60:63], v[4:7]
    ds_read_b128 v[56:59], v222 offset:1152
    s_waitcnt lgkmcnt(9)
    v_mfma_f32_16x16x32_bf16 v[8:11], v[116:119], v[64:67], v[8:11]
    ds_read_b128 v[60:63], v222 offset:1088
    v_mfma_f32_16x16x32_bf16 v[12:15], v[116:119], v[68:71], v[12:15]
    ds_read_b128 v[64:67], v222 offset:1344
    s_waitcnt vmcnt(9) lgkmcnt(9)
    v_mfma_f32_16x16x32_bf16 v[4:7], v[120:123], v[72:75], v[4:7]
    ds_read_b128 v[68:71], v222 offset:1216
    v_mfma_f32_16x16x32_bf16 v[8:11], v[120:123], v[76:79], v[8:11]
    ds_read_b128 v[72:75], v223 offset:128
    s_waitcnt lgkmcnt(9)
    v_mfma_f32_16x16x32_bf16 v[12:15], v[120:123], v[80:83], v[12:15]
    ds_read_b128 v[76:79], v223 offset:384
    s_waitcnt vmcnt(8)
    v_mfma_f32_16x16x32_bf16 v[4:7], v[124:127], v[84:87], v[4:7]
    ds_read_b128 v[80:83], v223 offset:256
    s_waitcnt lgkmcnt(9)
    v_mfma_f32_16x16x32_bf16 v[8:11], v[124:127], v[88:91], v[8:11]
    ds_read_b128 v[84:87], v223 offset:192
    v_mfma_f32_16x16x32_bf16 v[12:15], v[124:127], v[92:95], v[12:15]
    ds_read_b128 v[88:91], v223 offset:448
    s_waitcnt vmcnt(7) lgkmcnt(9)
    v_mfma_f32_16x16x32_bf16 v[4:7], v[144:147], v[48:51], v[4:7]
    ds_read_b128 v[92:95], v223 offset:320
    v_mfma_f32_16x16x32_bf16 v[8:11], v[144:147], v[52:55], v[8:11]
    ds_read_b128 v[48:51], v223 offset:640
    s_waitcnt lgkmcnt(9)
    v_mfma_f32_16x16x32_bf16 v[12:15], v[144:147], v[56:59], v[12:15]
    ds_read_b128 v[52:55], v223 offset:512
    s_waitcnt vmcnt(6)
    v_mfma_f32_16x16x32_bf16 v[4:7], v[148:151], v[60:63], v[4:7]
    ds_read_b128 v[56:59], v223 offset:768
    s_waitcnt lgkmcnt(9)
    v_mfma_f32_16x16x32_bf16 v[8:11], v[148:151], v[64:67], v[8:11]
    ds_read_b128 v[60:63], v223 offset:704
    v_mfma_f32_16x16x32_bf16 v[12:15], v[148:151], v[68:71], v[12:15]
    ds_read_b128 v[64:67], v223 offset:576
    s_waitcnt vmcnt(5) lgkmcnt(9)
    v_mfma_f32_16x16x32_bf16 v[4:7], v[152:155], v[72:75], v[4:7]
    ds_read_b128 v[68:71], v223 offset:832
    v_mfma_f32_16x16x32_bf16 v[8:11], v[152:155], v[76:79], v[8:11]
    ds_read_b128 v[72:75], v223 offset:1024
    s_waitcnt lgkmcnt(9)
    v_mfma_f32_16x16x32_bf16 v[12:15], v[152:155], v[80:83], v[12:15]
    ds_read_b128 v[76:79], v223 offset:1280
    s_waitcnt vmcnt(4)
    v_mfma_f32_16x16x32_bf16 v[4:7], v[156:159], v[84:87], v[4:7]
    ds_read_b128 v[80:83], v223 offset:1152
    s_waitcnt lgkmcnt(9)
    v_mfma_f32_16x16x32_bf16 v[8:11], v[156:159], v[88:91], v[8:11]
    ds_read_b128 v[84:87], v223 offset:1088
    v_mfma_f32_16x16x32_bf16 v[12:15], v[156:159], v[92:95], v[12:15]
    ds_read_b128 v[88:91], v223 offset:1344
    s_waitcnt vmcnt(3) lgkmcnt(9)
    v_mfma_f32_16x16x32_bf16 v[4:7], v[160:163], v[48:51], v[4:7]
    ds_read_b128 v[92:95], v223 offset:1216
    v_mfma_f32_16x16x32_bf16 v[8:11], v[160:163], v[52:55], v[8:11]
    ds_read_b128 v[48:51], v222 offset:3200
    s_waitcnt lgkmcnt(9)
    v_mfma_f32_16x16x32_bf16 v[12:15], v[160:163], v[56:59], v[12:15]
    ds_read_b128 v[52:55], v222 offset:3456
    s_waitcnt vmcnt(2)
    v_mfma_f32_16x16x32_bf16 v[4:7], v[164:167], v[60:63], v[4:7]
    ds_read_b128 v[56:59], v222 offset:3328
    s_waitcnt lgkmcnt(9)
    v_mfma_f32_16x16x32_bf16 v[8:11], v[164:167], v[64:67], v[8:11]
    ds_read_b128 v[60:63], v222 offset:3264
    v_mfma_f32_16x16x32_bf16 v[12:15], v[164:167], v[68:71], v[12:15]
    ds_read_b128 v[64:67], v222 offset:3520
    s_waitcnt vmcnt(1) lgkmcnt(9)
    v_mfma_f32_16x16x32_bf16 v[4:7], v[168:171], v[72:75], v[4:7]
    ds_read_b128 v[68:71], v222 offset:3392
    v_mfma_f32_16x16x32_bf16 v[8:11], v[168:171], v[76:79], v[8:11]
    ds_read_b128 v[72:75], v222 offset:3712
    s_waitcnt lgkmcnt(9)
    v_mfma_f32_16x16x32_bf16 v[12:15], v[168:171], v[80:83], v[12:15]
    ds_read_b128 v[76:79], v222 offset:3584
    s_waitcnt vmcnt(0)
    v_mfma_f32_16x16x32_bf16 v[4:7], v[172:175], v[84:87], v[4:7]
    ds_read_b128 v[80:83], v222 offset:3840
    s_waitcnt lgkmcnt(9)
    v_mfma_f32_16x16x32_bf16 v[8:11], v[172:175], v[88:91], v[8:11]
    ds_read_b128 v[84:87], v222 offset:3776
    v_mfma_f32_16x16x32_bf16 v[12:15], v[172:175], v[92:95], v[12:15]
    ds_read_b128 v[88:91], v222 offset:3648
    s_waitcnt lgkmcnt(9)
    v_mfma_f32_16x16x32_bf16 v[20:23], v[112:115], v[48:51], 0
    ds_read_b128 v[92:95], v222 offset:3904
    v_mfma_f32_16x16x32_bf16 v[24:27], v[112:115], v[52:55], 0
    ds_read_b128 v[48:51], v222 offset:4096
    s_waitcnt lgkmcnt(9)
    v_mfma_f32_16x16x32_bf16 v[28:31], v[112:115], v[56:59], 0
    ds_read_b128 v[52:55], v222 offset:4352
    v_mfma_f32_16x16x32_bf16 v[20:23], v[116:119], v[60:63], v[20:23]
    ds_read_b128 v[56:59], v222 offset:4224
    s_waitcnt lgkmcnt(9)
    v_mfma_f32_16x16x32_bf16 v[24:27], v[116:119], v[64:67], v[24:27]
    ds_read_b128 v[60:63], v222 offset:4160
    v_mfma_f32_16x16x32_bf16 v[28:31], v[116:119], v[68:71], v[28:31]
    ds_read_b128 v[64:67], v222 offset:4416
    s_waitcnt lgkmcnt(9)
    v_mfma_f32_16x16x32_bf16 v[20:23], v[120:123], v[72:75], v[20:23]
    ds_read_b128 v[68:71], v222 offset:4288
    v_mfma_f32_16x16x32_bf16 v[24:27], v[120:123], v[76:79], v[24:27]
    ds_read_b128 v[72:75], v223 offset:33408
    s_waitcnt lgkmcnt(9)
    v_mfma_f32_16x16x32_bf16 v[28:31], v[120:123], v[80:83], v[28:31]
    ds_read_b128 v[76:79], v223 offset:33664
    v_mfma_f32_16x16x32_bf16 v[20:23], v[124:127], v[84:87], v[20:23]
    ds_read_b128 v[80:83], v223 offset:33536
    s_waitcnt lgkmcnt(9)
    v_mfma_f32_16x16x32_bf16 v[24:27], v[124:127], v[88:91], v[24:27]
    ds_read_b128 v[84:87], v223 offset:33472
    v_mfma_f32_16x16x32_bf16 v[28:31], v[124:127], v[92:95], v[28:31]
    ds_read_b128 v[88:91], v223 offset:33728
    s_waitcnt lgkmcnt(9)
    v_mfma_f32_16x16x32_bf16 v[20:23], v[144:147], v[48:51], v[20:23]
    ds_read_b128 v[92:95], v223 offset:33600
    v_mfma_f32_16x16x32_bf16 v[24:27], v[144:147], v[52:55], v[24:27]
    ds_read_b128 v[48:51], v223 offset:33920
    s_waitcnt lgkmcnt(9)
    v_mfma_f32_16x16x32_bf16 v[28:31], v[144:147], v[56:59], v[28:31]
    ds_read_b128 v[52:55], v223 offset:33792
    v_mfma_f32_16x16x32_bf16 v[20:23], v[148:151], v[60:63], v[20:23]
    ds_read_b128 v[56:59], v223 offset:34048
    s_waitcnt lgkmcnt(9)
    v_mfma_f32_16x16x32_bf16 v[24:27], v[148:151], v[64:67], v[24:27]
    ds_read_b128 v[60:63], v223 offset:33984
    v_mfma_f32_16x16x32_bf16 v[28:31], v[148:151], v[68:71], v[28:31]
    ds_read_b128 v[64:67], v223 offset:33856
    s_waitcnt lgkmcnt(9)
    v_mfma_f32_16x16x32_bf16 v[20:23], v[152:155], v[72:75], v[20:23]
    ds_read_b128 v[68:71], v223 offset:34112
    v_mfma_f32_16x16x32_bf16 v[24:27], v[152:155], v[76:79], v[24:27]
    ds_read_b128 v[72:75], v223 offset:34304
    s_waitcnt lgkmcnt(9)
    v_mfma_f32_16x16x32_bf16 v[28:31], v[152:155], v[80:83], v[28:31]
    ds_read_b128 v[76:79], v223 offset:34560
    v_mfma_f32_16x16x32_bf16 v[20:23], v[156:159], v[84:87], v[20:23]
    ds_read_b128 v[80:83], v223 offset:34432
    s_waitcnt lgkmcnt(9)
    v_mfma_f32_16x16x32_bf16 v[24:27], v[156:159], v[88:91], v[24:27]
    ds_read_b128 v[84:87], v223 offset:34368
    v_mfma_f32_16x16x32_bf16 v[28:31], v[156:159], v[92:95], v[28:31]
    ds_read_b128 v[88:91], v223 offset:34624
    s_waitcnt lgkmcnt(9)
    v_mfma_f32_16x16x32_bf16 v[20:23], v[160:163], v[48:51], v[20:23]
    ds_read_b128 v[92:95], v223 offset:34496
    v_mfma_f32_16x16x32_bf16 v[24:27], v[160:163], v[52:55], v[24:27]
    ds_read_b128 v[48:51], v247 offset:6272
    s_waitcnt lgkmcnt(9)
    v_mfma_f32_16x16x32_bf16 v[28:31], v[160:163], v[56:59], v[28:31]
    ds_read_b128 v[52:55], v232 offset:6528
    v_mfma_f32_16x16x32_bf16 v[20:23], v[164:167], v[60:63], v[20:23]
    ds_read_b128 v[56:59], v247 offset:6336
    s_waitcnt lgkmcnt(9)
    v_mfma_f32_16x16x32_bf16 v[24:27], v[164:167], v[64:67], v[24:27]
    ds_read_b128 v[60:63], v232 offset:6592
    v_mfma_f32_16x16x32_bf16 v[28:31], v[164:167], v[68:71], v[28:31]
    ds_read_b128 v[64:67], v247 offset:6784
    s_waitcnt lgkmcnt(9)
    v_mfma_f32_16x16x32_bf16 v[20:23], v[168:171], v[72:75], v[20:23]
    ds_read_b128 v[68:71], v232 offset:6656
    v_mfma_f32_16x16x32_bf16 v[24:27], v[168:171], v[76:79], v[24:27]
    ds_read_b128 v[72:75], v247 offset:6848
    s_waitcnt lgkmcnt(9)
    v_mfma_f32_16x16x32_bf16 v[28:31], v[168:171], v[80:83], v[28:31]
    ds_read_b128 v[76:79], v232 offset:6720
    v_mfma_f32_16x16x32_bf16 v[20:23], v[172:175], v[84:87], v[20:23]
    ds_read_b128 v[80:83], v247 offset:7168
    s_waitcnt lgkmcnt(9)
    v_mfma_f32_16x16x32_bf16 v[24:27], v[172:175], v[88:91], v[24:27]
    ds_read_b128 v[84:87], v232 offset:7424
    v_mfma_f32_16x16x32_bf16 v[28:31], v[172:175], v[92:95], v[28:31]
    ds_read_b128 v[88:91], v247 offset:7232
    s_waitcnt lgkmcnt(9)
    v_mfma_f32_16x16x32_bf16 v[36:39], v[112:115], v[48:51], 0
    ds_read_b128 v[92:95], v232 offset:7488
    v_mfma_f32_16x16x32_bf16 v[40:43], v[112:115], v[52:55], 0
    ds_read_b128 v[48:51], v248 offset:128
    s_waitcnt lgkmcnt(9)
    v_mfma_f32_16x16x32_bf16 v[36:39], v[116:119], v[56:59], v[36:39]
    ds_read_b128 v[52:55], v225 offset:384
    v_mfma_f32_16x16x32_bf16 v[40:43], v[116:119], v[60:63], v[40:43]
    ds_read_b128 v[56:59], v248 offset:192
    s_waitcnt lgkmcnt(9)
    v_mfma_f32_16x16x32_bf16 v[36:39], v[120:123], v[64:67], v[36:39]
    ds_read_b128 v[60:63], v225 offset:448
    v_mfma_f32_16x16x32_bf16 v[40:43], v[120:123], v[68:71], v[40:43]
    ds_read_b128 v[64:67], v248 offset:640
    s_waitcnt lgkmcnt(9)
    v_mfma_f32_16x16x32_bf16 v[36:39], v[124:127], v[72:75], v[36:39]
    ds_read_b128 v[68:71], v225 offset:512
    v_mfma_f32_16x16x32_bf16 v[40:43], v[124:127], v[76:79], v[40:43]
    ds_read_b128 v[72:75], v248 offset:704
    s_waitcnt lgkmcnt(9)
    v_mfma_f32_16x16x32_bf16 v[36:39], v[144:147], v[80:83], v[36:39]
    ds_read_b128 v[76:79], v225 offset:576
    v_mfma_f32_16x16x32_bf16 v[40:43], v[144:147], v[84:87], v[40:43]
    ds_read_b128 v[80:83], v248 offset:1024
    s_waitcnt lgkmcnt(9)
    v_mfma_f32_16x16x32_bf16 v[36:39], v[148:151], v[88:91], v[36:39]
    ds_read_b128 v[84:87], v225 offset:1280
    v_mfma_f32_16x16x32_bf16 v[40:43], v[148:151], v[92:95], v[40:43]
    ds_read_b128 v[88:91], v248 offset:1088
    s_waitcnt lgkmcnt(9)
    v_mfma_f32_16x16x32_bf16 v[36:39], v[152:155], v[48:51], v[36:39]
    ds_read_b128 v[92:95], v225 offset:1344
    v_mfma_f32_16x16x32_bf16 v[40:43], v[152:155], v[52:55], v[40:43]
    s_waitcnt lgkmcnt(8)
    v_mfma_f32_16x16x32_bf16 v[36:39], v[156:159], v[56:59], v[36:39]
    v_mfma_f32_16x16x32_bf16 v[40:43], v[156:159], v[60:63], v[40:43]
    s_waitcnt lgkmcnt(6)
    v_mfma_f32_16x16x32_bf16 v[36:39], v[160:163], v[64:67], v[36:39]
    v_mfma_f32_16x16x32_bf16 v[40:43], v[160:163], v[68:71], v[40:43]
    s_waitcnt lgkmcnt(4)
    v_mfma_f32_16x16x32_bf16 v[36:39], v[164:167], v[72:75], v[36:39]
    v_mfma_f32_16x16x32_bf16 v[40:43], v[164:167], v[76:79], v[40:43]
    s_waitcnt lgkmcnt(2)
    v_mfma_f32_16x16x32_bf16 v[36:39], v[168:171], v[80:83], v[36:39]
    v_mfma_f32_16x16x32_bf16 v[40:43], v[168:171], v[84:87], v[40:43]
    s_waitcnt lgkmcnt(0)
    v_mfma_f32_16x16x32_bf16 v[36:39], v[172:175], v[88:91], v[36:39]
    v_mfma_f32_16x16x32_bf16 v[40:43], v[172:175], v[92:95], v[40:43]
    s_lshl_b32 s60, s54, 9
    s_lshl_b32 s61, s20, 6
    s_add_u32 s60, s60, s61
    s_mul_i32 s60, s60, 192
    s_add_u32 s60, s60, 10485760
    v_mul_u32_u24 v227, 96, v252
    s_cmp_lg_u32 s28, 0
    s_cbranch_scc1 K2_NOACC
    buffer_load_dwordx4 v[48:51], v227, s[8:11], s60 offen offset:0
    buffer_load_dwordx4 v[52:55], v227, s[8:11], s60 offen offset:16
    buffer_load_dwordx4 v[56:59], v227, s[8:11], s60 offen offset:32
    buffer_load_dwordx4 v[60:63], v227, s[8:11], s60 offen offset:48
    buffer_load_dwordx4 v[64:67], v227, s[8:11], s60 offen offset:64
    buffer_load_dwordx4 v[68:71], v227, s[8:11], s60 offen offset:80
    buffer_load_dwordx4 v[72:75], v227, s[8:11], s60 offen offset:96
    buffer_load_dwordx4 v[76:79], v227, s[8:11], s60 offen offset:112
    buffer_load_dwordx4 v[80:83], v227, s[8:11], s60 offen offset:128
    buffer_load_dwordx4 v[84:87], v227, s[8:11], s60 offen offset:144
    buffer_load_dwordx4 v[88:91], v227, s[8:11], s60 offen offset:160
    s_waitcnt vmcnt(0)
    v_add_f32 v0, v0, v48
    v_add_f32 v1, v1, v49
    v_add_f32 v2, v2, v50
    v_add_f32 v3, v3, v51
    v_add_f32 v4, v4, v52
    v_add_f32 v5, v5, v53
    v_add_f32 v6, v6, v54
    v_add_f32 v7, v7, v55
    v_add_f32 v8, v8, v56
    v_add_f32 v9, v9, v57
    v_add_f32 v10, v10, v58
    v_add_f32 v11, v11, v59
    v_add_f32 v12, v12, v60
    v_add_f32 v13, v13, v61
    v_add_f32 v14, v14, v62
    v_add_f32 v15, v15, v63
    v_add_f32 v16, v16, v64
    v_add_f32 v17, v17, v65
    v_add_f32 v18, v18, v66
    v_add_f32 v19, v19, v67
    v_add_f32 v20, v20, v68
    v_add_f32 v21, v21, v69
    v_add_f32 v22, v22, v70
    v_add_f32 v23, v23, v71
    v_add_f32 v24, v24, v72
    v_add_f32 v25, v25, v73
    v_add_f32 v26, v26, v74
    v_add_f32 v27, v27, v75
    v_add_f32 v28, v28, v76
    v_add_f32 v29, v29, v77
    v_add_f32 v30, v30, v78
    v_add_f32 v31, v31, v79
    v_add_f32 v32, v32, v80
    v_add_f32 v33, v33, v81
    v_add_f32 v34, v34, v82
    v_add_f32 v35, v35, v83
    v_add_f32 v36, v36, v84
    v_add_f32 v37, v37, v85
    v_add_f32 v38, v38, v86
    v_add_f32 v39, v39, v87
    v_add_f32 v40, v40, v88
    v_add_f32 v41, v41, v89
    v_add_f32 v42, v42, v90
    v_add_f32 v43, v43, v91
K2_NOACC:
    s_barrier
    s_cmp_eq_u32 s55, 0
    s_cbranch_scc1 K2_SPILL
    s_bfe_u32 s60, s20, 0x10002
    s_lshl_b32 s60, s60, 4
    s_add_u32 s59, s59, s60
    v_add_u32 v228, s59, v229
    s_mul_i32 s60, s20, 2080
    s_add_u32 s60, s60, 65536
    v_add_u32 v249, s60, v229
    s_mov_b32 s63, 0xbfb8aa3b
    s_add_u32 s40, s20, s21
    s_lshl_b32 s40, s40, 10
    s_add_u32 s41, s40, 8192
    s_add_u32 s42, s40, 16384
    s_add_u32 s43, s40, 24576
    s_add_u32 s44, s40, 32768
    v_mul_f32 v204, s63, v0
    v_mul_f32 v205, s63, v1
    v_mul_f32 v206, s63, v2
    v_mul_f32 v207, s63, v3
    v_exp_f32 v204, v204
    v_exp_f32 v205, v205
    v_exp_f32 v206, v206
    v_exp_f32 v207, v207
    v_add_f32 v204, 1.0, v204
    v_add_f32 v205, 1.0, v205
    v_add_f32 v206, 1.0, v206
    v_add_f32 v207, 1.0, v207
    v_rcp_f32 v204, v204
    v_rcp_f32 v205, v205
    v_rcp_f32 v206, v206
    v_rcp_f32 v207, v207
    v_cvt_pk_bf16_f32 v176, v0, v1
    v_cvt_pk_bf16_f32 v177, v2, v3
    v_mul_f32 v4, v4, v204
    v_mul_f32 v5, v5, v205
    v_mul_f32 v6, v6, v206
    v_mul_f32 v7, v7, v207
    v_cvt_pk_bf16_f32 v178, v4, v5
    v_cvt_pk_bf16_f32 v179, v6, v7
    v_mul_f32 v8, v8, v204
    v_mul_f32 v9, v9, v205
    v_mul_f32 v10, v10, v206
    v_mul_f32 v11, v11, v207
    v_cvt_pk_bf16_f32 v180, v8, v9
    v_cvt_pk_bf16_f32 v181, v10, v11
    v_mul_f32 v12, v12, v204
    v_mul_f32 v13, v13, v205
    v_mul_f32 v14, v14, v206
    v_mul_f32 v15, v15, v207
    v_cvt_pk_bf16_f32 v182, v12, v13
    v_cvt_pk_bf16_f32 v183, v14, v15
    ds_write_b64 v254, v[176:177] offset:0
    ds_write_b64 v254, v[178:179] offset:256
    ds_write_b64 v254, v[180:181] offset:512
    ds_write_b64 v254, v[182:183] offset:768
    s_waitcnt lgkmcnt(0)
    s_barrier
    ds_read_b128 v[192:195], v228 offset:0
    ds_read_b128 v[196:199], v228 offset:1536
    s_waitcnt lgkmcnt(0)
    buffer_store_dwordx4 v[192:195], v229, s[12:15], s40 offen sc1
    buffer_store_dwordx4 v[196:199], v229, s[12:15], s41 offen sc1
    v_mul_f32 v208, s63, v16
    v_mul_f32 v209, s63, v17
    v_mul_f32 v210, s63, v18
    v_mul_f32 v211, s63, v19
    v_exp_f32 v208, v208
    v_exp_f32 v209, v209
    v_exp_f32 v210, v210
    v_exp_f32 v211, v211
    v_add_f32 v208, 1.0, v208
    v_add_f32 v209, 1.0, v209
    v_add_f32 v210, 1.0, v210
    v_add_f32 v211, 1.0, v211
    v_rcp_f32 v208, v208
    v_rcp_f32 v209, v209
    v_rcp_f32 v210, v210
    v_rcp_f32 v211, v211
    v_cvt_pk_bf16_f32 v184, v16, v17
    v_cvt_pk_bf16_f32 v185, v18, v19
    v_mul_f32 v20, v20, v208
    v_mul_f32 v21, v21, v209
    v_mul_f32 v22, v22, v210
    v_mul_f32 v23, v23, v211
    v_cvt_pk_bf16_f32 v186, v20, v21
    v_cvt_pk_bf16_f32 v187, v22, v23
    v_mul_f32 v24, v24, v208
    v_mul_f32 v25, v25, v209
    v_mul_f32 v26, v26, v210
    v_mul_f32 v27, v27, v211
    v_cvt_pk_bf16_f32 v188, v24, v25
    v_cvt_pk_bf16_f32 v189, v26, v27
    v_mul_f32 v28, v28, v208
    v_mul_f32 v29, v29, v209
    v_mul_f32 v30, v30, v210
    v_mul_f32 v31, v31, v211
    v_cvt_pk_bf16_f32 v190, v28, v29
    v_cvt_pk_bf16_f32 v191, v30, v31
    ds_write_b64 v254, v[184:185] offset:3072
    ds_write_b64 v254, v[186:187] offset:3328
    ds_write_b64 v254, v[188:189] offset:3584
    ds_write_b64 v254, v[190:191] offset:3840
    s_waitcnt lgkmcnt(0)
    s_barrier
    ds_read_b128 v[192:195], v228 offset:3072
    ds_read_b128 v[196:199], v228 offset:4608
    s_waitcnt lgkmcnt(0)
    buffer_store_dwordx4 v[192:195], v229, s[12:15], s42 offen sc1
    buffer_store_dwordx4 v[196:199], v229, s[12:15], s43 offen sc1
    v_mul_f32 v212, s63, v32
    v_mul_f32 v213, s63, v33
    v_mul_f32 v214, s63, v34
    v_mul_f32 v215, s63, v35
    v_exp_f32 v212, v212
    v_exp_f32 v213, v213
    v_exp_f32 v214, v214
    v_exp_f32 v215, v215
    v_add_f32 v212, 1.0, v212
    v_add_f32 v213, 1.0, v213
    v_add_f32 v214, 1.0, v214
    v_add_f32 v215, 1.0, v215
    v_rcp_f32 v212, v212
    v_rcp_f32 v213, v213
    v_rcp_f32 v214, v214
    v_rcp_f32 v215, v215
    v_cvt_pk_bf16_f32 v220, v32, v33
    v_cvt_pk_bf16_f32 v221, v34, v35
    v_mul_f32 v36, v36, v212
    v_mul_f32 v37, v37, v213
    v_mul_f32 v38, v38, v214
    v_mul_f32 v39, v39, v215
    v_cvt_pk_bf16_f32 v178, v36, v37
    v_cvt_pk_bf16_f32 v179, v38, v39
    v_mul_f32 v40, v40, v212
    v_mul_f32 v41, v41, v213
    v_mul_f32 v42, v42, v214
    v_mul_f32 v43, v43, v215
    v_cvt_pk_bf16_f32 v180, v40, v41
    v_cvt_pk_bf16_f32 v181, v42, v43
    ds_write_b64 v255, v[220:221] offset:0
    ds_write_b64 v246, v[178:179] offset:256
    ds_write_b64 v255, v[180:181] offset:512
    s_waitcnt lgkmcnt(0)
    s_barrier
    ds_read_b128 v[200:203], v249
    s_branch K2_LASTROW
K2_SPILL:
    buffer_store_dwordx4 v[0:3], v227, s[8:11], s60 offen offset:0
    buffer_store_dwordx4 v[4:7], v227, s[8:11], s60 offen offset:16
    buffer_store_dwordx4 v[8:11], v227, s[8:11], s60 offen offset:32
    buffer_store_dwordx4 v[12:15], v227, s[8:11], s60 offen offset:48
    buffer_store_dwordx4 v[16:19], v227, s[8:11], s60 offen offset:64
    buffer_store_dwordx4 v[20:23], v227, s[8:11], s60 offen offset:80
    buffer_store_dwordx4 v[24:27], v227, s[8:11], s60 offen offset:96
    buffer_store_dwordx4 v[28:31], v227, s[8:11], s60 offen offset:112
    buffer_store_dwordx4 v[32:35], v227, s[8:11], s60 offen offset:128
    buffer_store_dwordx4 v[36:39], v227, s[8:11], s60 offen offset:144
    buffer_store_dwordx4 v[40:43], v227, s[8:11], s60 offen offset:160
    s_mov_b32 s28, 0
    s_waitcnt vmcnt(0)
    s_cmp_lt_u32 s24, s25
    s_cbranch_scc1 K2_LOAD
    s_add_u32 s23, s23, 20
    s_branch K2_WINDOW
KS_FLS:
    s_sub_u32 s25, s25, 1
    s_cbranch_scc1 K2_END
    v_mov_b32 v62, 163460
    ds_read_b32 v62, v62
    s_branch KS_JOIN2
K2_NOW0:
    buffer_load_dwordx4 v[76:79], v72, s[8:11], s67 offen sc1
    s_branch K2_W0
K2_WINDOW:
    s_mov_b32 s24, 0
    s_mov_b32 s25, 1
K2_LOAD:
    v_mbcnt_lo_u32_b32 v176, -1, 0
    v_mbcnt_hi_u32_b32 v176, -1, v176
    s_lshl_b32 s58, s20, 6
    v_add_u32 v177, s58, v176
    v_lshlrev_b32 v70, 4, v176
    s_mov_b32 s58, 7110656
    buffer_load_dwordx4 v[136:139], v70, s[8:11], s58 offen offset:0 sc1
    buffer_load_dwordx4 v[140:143], v70, s[8:11], s58 offen offset:1024 sc1
    s_mov_b32 s58, 7112704
    buffer_load_dwordx4 v[144:147], v70, s[8:11], s58 offen offset:0 sc1
    buffer_load_dwordx4 v[148:151], v70, s[8:11], s58 offen offset:1024 sc1
    s_mov_b32 s58, 7114752
    buffer_load_dwordx4 v[152:155], v70, s[8:11], s58 offen offset:0 sc1
    buffer_load_dwordx4 v[156:159], v70, s[8:11], s58 offen offset:1024 sc1
    s_mov_b32 s58, 7116800
    buffer_load_dwordx4 v[160:163], v70, s[8:11], s58 offen offset:0 sc1
    buffer_load_dwordx4 v[164:167], v70, s[8:11], s58 offen offset:1024 sc1
    s_mov_b32 s58, 7118848
    buffer_load_dwordx4 v[168:171], v70, s[8:11], s58 offen offset:0 sc1
    buffer_load_dwordx4 v[172:175], v70, s[8:11], s58 offen offset:1024 sc1
    s_mul_i32 s58, s20, 10400
    s_add_u32 s58, s58, 65536
    s_add_u32 s59, s58, 512
    v_and_b32 v76, 31, v176
    v_lshrrev_b32 v77, 5, v176
    v_mov_b32 v80, 0
    v_mul_u32_u24 v77, 2080, v77
    v_mov_b32 v81, 0xffff0000
    v_lshl_add_u32 v78, v76, 4, v77
    v_mov_b32 v82, 0
    v_add_u32 v78, s58, v78
    v_mov_b32 v83, v81
    v_add_u32 v85, 16, v176
    v_lshlrev_b32 v84, 5, v176
    v_lshrrev_b32 v85, 6, v85
    v_mul_u32_u24 v85, 1532, v85
    v_sub_u32 v84, v84, v85
    v_mov_b32 v85, -1
    v_add_u32 v84, s59, v84
    ds_write_b32 v84, v85 offset:0
    ds_write_b32 v84, v85 offset:2080
    ds_write_b32 v84, v85 offset:4160
    ds_write_b32 v84, v85 offset:6240
    ds_write_b32 v84, v85 offset:8320
    s_mov_b32 exec_hi, 0
    ds_write_b128 v78, v[80:83] offset:0
    ds_write_b128 v78, v[80:83] offset:2080
    ds_write_b128 v78, v[80:83] offset:4160
    ds_write_b128 v78, v[80:83] offset:6240
    ds_write_b128 v78, v[80:83] offset:8320
    s_mov_b32 exec_hi, -1
    s_cmp_lg_u32 s20, 7
    s_cbranch_scc1 K2_NOH
    v_mov_b32 v76, 0
    v_mov_b32 v77, -1
    v_lshlrev_b32 v78, 2, v176
    v_add_u32 v78, 163072, v78
    s_mov_b64 exec, 0x1ff
    ds_write_b32 v78, v76 offset:192
    s_mov_b32 exec_lo, 1
    ds_write_b32 v78, v76 offset:232
    s_mov_b32 exec_lo, -1
    ds_write_b32 v78, v77 offset:256
    s_mov_b64 exec, -1
    s_cmp_lg_u32 s24, 0
    s_cbranch_scc1 K2_NOH
    s_mov_b32 exec_hi, 0xffff
    ds_write_b32 v78, v76
    s_mov_b64 exec, 1
    ds_write_b32 v78, v76 offset:228
    s_mov_b64 exec, -1
K2_NOH:
    s_waitcnt lgkmcnt(0)
    s_barrier
    s_branch K2_CELLS
K2_LD_GEN:
    s_mov_b64 exec, s[42:43]
    s_cbranch_execz K2_LD_DONE
    buffer_load_dwordx4 v[4:7], v182, s[8:11], 0 offen sc1
    s_mov_b64 exec, s[44:45]
    s_cbranch_execz K2_LD_DONE
    buffer_load_dwordx4 v[8:11], v183, s[8:11], 0 offen sc1
    s_mov_b64 exec, s[46:47]
    s_cbranch_execz K2_LD_DONE
    buffer_load_dwordx4 v[12:15], v184, s[8:11], 0 offen sc1
    s_mov_b64 exec, s[48:49]
    s_cbranch_execz K2_LD_DONE
    buffer_load_dwordx4 v[16:19], v181, s[8:11], 0 offen offset:128 sc1
    s_mov_b64 exec, s[50:51]
    s_cbranch_execz K2_LD_DONE
    buffer_load_dwordx4 v[20:23], v181, s[8:11], 0 offen offset:160 sc1
    s_mov_b64 exec, s[90:91]
    s_cbranch_execz K2_LD_DONE
    buffer_load_dwordx4 v[24:27], v181, s[8:11], 0 offen offset:192 sc1
    s_mov_b64 exec, s[92:93]
    s_cbranch_execz K2_LD_DONE
    buffer_load_dwordx4 v[28:31], v181, s[8:11], 0 offen offset:224 sc1
    s_mov_b64 exec, s[94:95]
    s_cbranch_execz K2_LD_DONE
    buffer_load_dwordx4 v[32:35], v181, s[8:11], 0 offen offset:256 sc1
    s_mov_b64 exec, s[96:97]
    s_cbranch_execz K2_LD_DONE
    buffer_load_dwordx4 v[36:39], v181, s[8:11], 0 offen offset:288 sc1
    s_branch K2_LD_DONE
K2_WLATE:
    s_waitcnt vmcnt(0)
    v_lshlrev_b32 v96, 16, v136
    v_and_b32 v97, 0xffff0000, v136
    v_lshlrev_b32 v98, 16, v137
    v_and_b32 v99, 0xffff0000, v137
    v_lshlrev_b32 v100, 16, v138
    v_and_b32 v101, 0xffff0000, v138
    v_lshlrev_b32 v102, 16, v139
    v_and_b32 v103, 0xffff0000, v139
    v_lshlrev_b32 v104, 16, v140
    v_and_b32 v105, 0xffff0000, v140
    v_lshlrev_b32 v106, 16, v141
    v_and_b32 v107, 0xffff0000, v141
    v_lshlrev_b32 v108, 16, v142
    v_and_b32 v109, 0xffff0000, v142
    v_lshlrev_b32 v110, 16, v143
    v_and_b32 v111, 0xffff0000, v143
    v_lshlrev_b32 v112, 16, v144
    v_and_b32 v113, 0xffff0000, v144
    v_lshlrev_b32 v114, 16, v145
    v_and_b32 v115, 0xffff0000, v145
    v_lshlrev_b32 v116, 16, v146
    v_and_b32 v117, 0xffff0000, v146
    v_lshlrev_b32 v118, 16, v147
    v_and_b32 v119, 0xffff0000, v147
    v_lshlrev_b32 v120, 16, v148
    v_and_b32 v121, 0xffff0000, v148
    v_lshlrev_b32 v122, 16, v149
    v_and_b32 v123, 0xffff0000, v149
    v_lshlrev_b32 v124, 16, v150
    v_and_b32 v125, 0xffff0000, v150
    v_lshlrev_b32 v126, 16, v151
    v_and_b32 v127, 0xffff0000, v151
    v_lshlrev_b32 v128, 16, v152
    v_and_b32 v129, 0xffff0000, v152
    v_lshlrev_b32 v130, 16, v153
    v_and_b32 v131, 0xffff0000, v153
    v_lshlrev_b32 v132, 16, v154
    v_and_b32 v133, 0xffff0000, v154
    v_lshlrev_b32 v134, 16, v155
    v_and_b32 v135, 0xffff0000, v155
    v_lshlrev_b32 v136, 16, v156
    v_and_b32 v137, 0xffff0000, v156
    v_lshlrev_b32 v138, 16, v157
    v_and_b32 v139, 0xffff0000, v157
    v_lshlrev_b32 v140, 16, v158
    v_and_b32 v141, 0xffff0000, v158
    v_lshlrev_b32 v142, 16, v159
    v_and_b32 v143, 0xffff0000, v159
    v_lshlrev_b32 v144, 16, v160
    v_and_b32 v145, 0xffff0000, v160
    v_lshlrev_b32 v146, 16, v161
    v_and_b32 v147, 0xffff0000, v161
    v_lshlrev_b32 v148, 16, v162
    v_and_b32 v149, 0xffff0000, v162
    v_lshlrev_b32 v150, 16, v163
    v_and_b32 v151, 0xffff0000, v163
    v_lshlrev_b32 v152, 16, v164
    v_and_b32 v153, 0xffff0000, v164
    v_lshlrev_b32 v154, 16, v165
    v_and_b32 v155, 0xffff0000, v165
    v_lshlrev_b32 v156, 16, v166
    v_and_b32 v157, 0xffff0000, v166
    v_lshlrev_b32 v158, 16, v167
    v_and_b32 v159, 0xffff0000, v167
    v_lshlrev_b32 v160, 16, v168
    v_and_b32 v161, 0xffff0000, v168
    v_lshlrev_b32 v162, 16, v169
    v_and_b32 v163, 0xffff0000, v169
    v_lshlrev_b32 v164, 16, v170
    v_and_b32 v165, 0xffff0000, v170
    v_lshlrev_b32 v166, 16, v171
    v_and_b32 v167, 0xffff0000, v171
    v_lshlrev_b32 v168, 16, v172
    v_and_b32 v169, 0xffff0000, v172
    v_lshlrev_b32 v170, 16, v173
    v_and_b32 v171, 0xffff0000, v173
    v_lshlrev_b32 v172, 16, v174
    v_and_b32 v173, 0xffff0000, v174
    v_lshlrev_b32 v174, 16, v175
    v_and_b32 v175, 0xffff0000, v175
    s_branch K2_NOWRAW
K2_RT0:
    s_sub_u32 s60, s60, 1
    s_cbranch_scc1 K2_END
    buffer_load_dwordx4 v[0:3], v181, s[8:11], 0 offen offset:0 sc1
    s_waitcnt vmcnt(0)
    s_branch K2_CK0
K2_RT1:
    s_sub_u32 s60, s60, 1
    s_cbranch_scc1 K2_END
    buffer_load_dwordx4 v[4:7], v182, s[8:11], 0 offen sc1
    s_waitcnt vmcnt(0)
    s_branch K2_CK1
K2_RT2:
    s_sub_u32 s60, s60, 1
    s_cbranch_scc1 K2_END
    buffer_load_dwordx4 v[8:11], v183, s[8:11], 0 offen sc1
    s_waitcnt vmcnt(0)
    s_branch K2_CK2
K2_RT3:
    s_sub_u32 s60, s60, 1
    s_cbranch_scc1 K2_END
    buffer_load_dwordx4 v[12:15], v184, s[8:11], 0 offen sc1
    s_waitcnt vmcnt(0)
    s_branch K2_CK3
K2_RT4:
    s_sub_u32 s60, s60, 1
    s_cbranch_scc1 K2_END
    buffer_load_dwordx4 v[16:19], v181, s[8:11], 0 offen offset:128 sc1
    s_waitcnt vmcnt(0)
    s_branch K2_CK4
K2_RT5:
    s_sub_u32 s60, s60, 1
    s_cbranch_scc1 K2_END
    buffer_load_dwordx4 v[20:23], v181, s[8:11], 0 offen offset:160 sc1
    s_waitcnt vmcnt(0)
    s_branch K2_CK5
K2_RT6:
    s_sub_u32 s60, s60, 1
    s_cbranch_scc1 K2_END
    buffer_load_dwordx4 v[24:27], v181, s[8:11], 0 offen offset:192 sc1
    s_waitcnt vmcnt(0)
    s_branch K2_CK6
K2_RT7:
    s_sub_u32 s60, s60, 1
    s_cbranch_scc1 K2_END
    buffer_load_dwordx4 v[28:31], v181, s[8:11], 0 offen offset:224 sc1
    s_waitcnt vmcnt(0)
    s_branch K2_CK7
K2_RT8:
    s_sub_u32 s60, s60, 1
    s_cbranch_scc1 K2_END
    buffer_load_dwordx4 v[32:35], v181, s[8:11], 0 offen offset:256 sc1
    s_waitcnt vmcnt(0)
    s_branch K2_CK8
K2_RT9:
    s_sub_u32 s60, s60, 1
    s_cbranch_scc1 K2_END
    buffer_load_dwordx4 v[36:39], v181, s[8:11], 0 offen offset:288 sc1
    s_waitcnt vmcnt(0)
    s_branch K2_CK9
K2_RK_LOAD:
    s_waitcnt vmcnt(0)
    s_mov_b64 exec, s[40:41]
    s_cbranch_execz K2_RK_B
    v_lshrrev_b32 v50, 24, v3
    buffer_load_dword v40, v179, s[8:11], s66 offen offset:0
    v_mad_u32_u24 v50, v50, s58, v202
    v_and_b32 v3, 0xffffff, v3
    s_mov_b64 exec, s[42:43]
    s_cbranch_execz K2_RK_B
    v_lshrrev_b32 v51, 24, v7
    buffer_load_dword v41, v185, s[8:11], s66 offen
    v_mad_u32_u24 v51, v51, s58, v202
    v_and_b32 v7, 0xffffff, v7
    s_mov_b64 exec, s[44:45]
    s_cbranch_execz K2_RK_B
    v_lshrrev_b32 v52, 24, v11
    buffer_load_dword v42, v186, s[8:11], s66 offen
    v_mad_u32_u24 v52, v52, s58, v202
    v_and_b32 v11, 0xffffff, v11
    s_mov_b64 exec, s[46:47]
    s_cbranch_execz K2_RK_B
    v_lshrrev_b32 v53, 24, v15
    buffer_load_dword v43, v187, s[8:11], s66 offen
    v_mad_u32_u24 v53, v53, s58, v202
    v_and_b32 v15, 0xffffff, v15
    s_mov_b64 exec, s[48:49]
    s_cbranch_execz K2_RK_B
    v_lshrrev_b32 v54, 24, v19
    buffer_load_dword v44, v179, s[8:11], s66 offen offset:32
    v_mad_u32_u24 v54, v54, s58, v202
    v_and_b32 v19, 0xffffff, v19
    s_mov_b64 exec, s[50:51]
    s_cbranch_execz K2_RK_B
    v_lshrrev_b32 v55, 24, v23
    buffer_load_dword v45, v179, s[8:11], s66 offen offset:40
    v_mad_u32_u24 v55, v55, s58, v202
    v_and_b32 v23, 0xffffff, v23
    s_mov_b64 exec, s[90:91]
    s_cbranch_execz K2_RK_B
    v_lshrrev_b32 v56, 24, v27
    buffer_load_dword v46, v179, s[8:11], s66 offen offset:48
    v_mad_u32_u24 v56, v56, s58, v202
    v_and_b32 v27, 0xffffff, v27
    s_mov_b64 exec, s[92:93]
    s_cbranch_execz K2_RK_B
    v_lshrrev_b32 v57, 24, v31
    buffer_load_dword v47, v179, s[8:11], s66 offen offset:56
    v_mad_u32_u24 v57, v57, s58, v202
    v_and_b32 v31, 0xffffff, v31
    s_mov_b64 exec, s[94:95]
    s_cbranch_execz K2_RK_B
    v_lshrrev_b32 v58, 24, v35
    buffer_load_dword v48, v179, s[8:11], s66 offen offset:64
    v_mad_u32_u24 v58, v58, s58, v202
    v_and_b32 v35, 0xffffff, v35
    s_mov_b64 exec, s[96:97]
    s_cbranch_execz K2_RK_B
    v_lshrrev_b32 v59, 24, v39
    buffer_load_dword v49, v179, s[8:11], s66 offen offset:72
    v_mad_u32_u24 v59, v59, s58, v202
    v_and_b32 v39, 0xffffff, v39
K2_RK_B:
    s_mov_b64 exec, -1
    s_mul_i32 s62, s24, 48
    s_waitcnt vmcnt(0)
    v_subrev_u32 v40, s62, v40
    v_subrev_u32 v41, s62, v41
    v_subrev_u32 v42, s62, v42
    v_subrev_u32 v43, s62, v43
    v_subrev_u32 v44, s62, v44
    v_subrev_u32 v45, s62, v45
    v_subrev_u32 v46, s62, v46
    v_subrev_u32 v47, s62, v47
    v_subrev_u32 v48, s62, v48
    v_subrev_u32 v49, s62, v49
    s_branch K2_RK_DONE
K2_BIG:
    s_cmp_lg_u32 s24, 0
    s_cbranch_scc1 K2_TOK
    s_movk_i32 s26, 48
    v_mov_b32 v197, v193
    s_nop 1
    v_max_u32_dpp v197, v197, v197 row_shr:1 row_mask:0xf bank_mask:0xf bound_ctrl:0
    s_nop 1
    v_max_u32_dpp v197, v197, v197 row_shr:2 row_mask:0xf bank_mask:0xf bound_ctrl:0
    s_nop 1
    v_max_u32_dpp v197, v197, v197 row_shr:4 row_mask:0xf bank_mask:0xf bound_ctrl:0
    s_nop 1
    v_max_u32_dpp v197, v197, v197 row_shr:8 row_mask:0xf bank_mask:0xf bound_ctrl:0
    s_nop 1
    v_max_u32_dpp v197, v197, v197 row_bcast:15 row_mask:0xa bank_mask:0xf
    s_nop 1
    v_max_u32_dpp v197, v197, v197 row_bcast:31 row_mask:0xc bank_mask:0xf
    s_nop 0
    v_readlane_b32 s25, v197, 63
    s_nop 0
    s_add_u32 s25, s25, 47
    s_mul_i32 s25, s25, 43691
    s_lshr_b32 s25, s25, 21
    s_mov_b64 exec, s[40:41]
    s_cbranch_execz K2_SV_DONE
    buffer_store_dword v40, v179, s[8:11], s66 offen offset:0
    s_mov_b64 exec, s[42:43]
    s_cbranch_execz K2_SV_DONE
    buffer_store_dword v41, v185, s[8:11], s66 offen
    s_mov_b64 exec, s[44:45]
    s_cbranch_execz K2_SV_DONE
    buffer_store_dword v42, v186, s[8:11], s66 offen
    s_mov_b64 exec, s[46:47]
    s_cbranch_execz K2_SV_DONE
    buffer_store_dword v43, v187, s[8:11], s66 offen
    s_mov_b64 exec, s[48:49]
    s_cbranch_execz K2_SV_DONE
    buffer_store_dword v44, v179, s[8:11], s66 offen offset:32
    s_mov_b64 exec, s[50:51]
    s_cbranch_execz K2_SV_DONE
    buffer_store_dword v45, v179, s[8:11], s66 offen offset:40
    s_mov_b64 exec, s[90:91]
    s_cbranch_execz K2_SV_DONE
    buffer_store_dword v46, v179, s[8:11], s66 offen offset:48
    s_mov_b64 exec, s[92:93]
    s_cbranch_execz K2_SV_DONE
    buffer_store_dword v47, v179, s[8:11], s66 offen offset:56
    s_mov_b64 exec, s[94:95]
    s_cbranch_execz K2_SV_DONE
    buffer_store_dword v48, v179, s[8:11], s66 offen offset:64
    s_mov_b64 exec, s[96:97]
    s_cbranch_execz K2_SV_DONE
    buffer_store_dword v49, v179, s[8:11], s66 offen offset:72
K2_SV_DONE:
    s_mov_b64 exec, -1
    s_branch K2_TOK
K2_rare_1:
    s_cmp_eq_u32 s33, 4
    s_cbranch_scc1 K2_four_3
    s_mov_b32 s49, s48
    s_mov_b32 s51, s48
    s_xor_b32 s45, s44, 256
    s_xor_b32 s46, s44, 512
    s_xor_b32 s47, s44, 768
    s_branch K2_back_2
K2_four_3:
    s_add_u32 s50, s48, 256
    s_add_u32 s51, s48, 384
    s_mov_b32 s46, s44
    s_mov_b32 s47, s44
    s_branch K2_back_2
K2_a4_5:
    v_add_u32 v254, s48, v230
    ds_read_b32 v254, v254 offset:4
    s_lshr_b32 s65, s3, 28
    s_mul_i32 s66, s22, 2080
    s_lshl_b32 s65, s65, 9
    s_add_u32 s65, s65, s66
    s_add_u32 s65, s65, 65536
    s_mov_b32 m0, s65
    s_mov_b32 exec_hi, 0
    s_waitcnt lgkmcnt(0)
    v_or_b32 v254, v254, v231
    buffer_load_dwordx4 v254, s[16:19], 0 offen  lds
    s_mov_b32 exec_hi, -1
    s_branch K2_b4_7
K2_rare_14:
    s_cmp_eq_u32 s33, 4
    s_cbranch_scc1 K2_four_16
    s_mov_b32 s49, s48
    s_mov_b32 s51, s48
    s_xor_b32 s45, s44, 256
    s_xor_b32 s46, s44, 512
    s_xor_b32 s47, s44, 768
    s_branch K2_back_15
K2_four_16:
    s_add_u32 s50, s48, 256
    s_add_u32 s51, s48, 384
    s_mov_b32 s46, s44
    s_mov_b32 s47, s44
    s_branch K2_back_15
K2_a4_18:
    v_add_u32 v254, s48, v230
    ds_read_b32 v254, v254 offset:4
    s_lshr_b32 s65, s3, 28
    s_mul_i32 s66, s22, 2080
    s_lshl_b32 s65, s65, 9
    s_add_u32 s65, s65, s66
    s_add_u32 s65, s65, 65536
    s_mov_b32 m0, s65
    s_mov_b32 exec_hi, 0
    s_waitcnt lgkmcnt(0)
    v_or_b32 v254, v254, v231
    buffer_load_dwordx4 v254, s[16:19], 0 offen  lds
    s_mov_b32 exec_hi, -1
    s_branch K2_b4_20
K2_rare_27:
    s_cmp_eq_u32 s33, 4
    s_cbranch_scc1 K2_four_29
    s_mov_b32 s49, s48
    s_mov_b32 s51, s48
    s_xor_b32 s45, s44, 256
    s_xor_b32 s46, s44, 512
    s_xor_b32 s47, s44, 768
    s_branch K2_back_28
K2_four_29:
    s_add_u32 s50, s48, 256
    s_add_u32 s51, s48, 384
    s_mov_b32 s46, s44
    s_mov_b32 s47, s44
    s_branch K2_back_28
K2_a4_31:
    v_add_u32 v254, s48, v230
    ds_read_b32 v254, v254 offset:4
    s_lshr_b32 s65, s3, 28
    s_mul_i32 s66, s22, 2080
    s_lshl_b32 s65, s65, 9
    s_add_u32 s65, s65, s66
    s_add_u32 s65, s65, 65536
    s_mov_b32 m0, s65
    s_mov_b32 exec_hi, 0
    s_waitcnt lgkmcnt(0)
    v_or_b32 v254, v254, v231
    buffer_load_dwordx4 v254, s[16:19], 0 offen  lds
    s_mov_b32 exec_hi, -1
    s_branch K2_b4_33
K2_rare_40:
    s_cmp_eq_u32 s33, 4
    s_cbranch_scc1 K2_four_42
    s_mov_b32 s49, s48
    s_mov_b32 s51, s48
    s_xor_b32 s45, s44, 256
    s_xor_b32 s46, s44, 512
    s_xor_b32 s47, s44, 768
    s_branch K2_back_41
K2_four_42:
    s_add_u32 s50, s48, 256
    s_add_u32 s51, s48, 384
    s_mov_b32 s46, s44
    s_mov_b32 s47, s44
    s_branch K2_back_41
K2_a4_44:
    v_add_u32 v254, s48, v230
    ds_read_b32 v254, v254 offset:4
    s_lshr_b32 s65, s3, 28
    s_mul_i32 s66, s22, 2080
    s_lshl_b32 s65, s65, 9
    s_add_u32 s65, s65, s66
    s_add_u32 s65, s65, 65536
    s_mov_b32 m0, s65
    s_mov_b32 exec_hi, 0
    s_waitcnt lgkmcnt(0)
    v_or_b32 v254, v254, v231
    buffer_load_dwordx4 v254, s[16:19], 0 offen  lds
    s_mov_b32 exec_hi, -1
    s_branch K2_b4_46
K2_rare_51:
    s_cmp_eq_u32 s33, 4
    s_cbranch_scc1 K2_four_53
    s_mov_b32 s49, s48
    s_mov_b32 s51, s48
    s_xor_b32 s45, s44, 256
    s_xor_b32 s46, s44, 512
    s_xor_b32 s47, s44, 768
    s_branch K2_back_52
K2_four_53:
    s_add_u32 s50, s48, 256
    s_add_u32 s51, s48, 384
    s_mov_b32 s46, s44
    s_mov_b32 s47, s44
    s_branch K2_back_52
K2_rare_58:
    s_cmp_eq_u32 s33, 4
    s_cbranch_scc1 K2_four_60
    s_mov_b32 s49, s48
    s_mov_b32 s51, s48
    s_xor_b32 s45, s44, 256
    s_xor_b32 s46, s44, 512
    s_xor_b32 s47, s44, 768
    s_branch K2_back_59
K2_four_60:
    s_add_u32 s50, s48, 256
    s_add_u32 s51, s48, 384
    s_mov_b32 s46, s44
    s_mov_b32 s47, s44
    s_branch K2_back_59
K2_rare_65:
    s_cmp_eq_u32 s33, 4
    s_cbranch_scc1 K2_four_67
    s_mov_b32 s49, s48
    s_mov_b32 s51, s48
    s_xor_b32 s45, s44, 256
    s_xor_b32 s46, s44, 512
    s_xor_b32 s47, s44, 768
    s_branch K2_back_66
K2_four_67:
    s_add_u32 s50, s48, 256
    s_add_u32 s51, s48, 384
    s_mov_b32 s46, s44
    s_mov_b32 s47, s44
    s_branch K2_back_66
K2_U10:
    s_setprio 1
    s_add_u32 s38, s38, 1
    v_mov_b32 v254, s52
    v_mov_b32 v255, s38
    s_lshl_b32 s58, s38, 3
    s_add_u32 s58, s58, s20
    s_mov_b64 exec, 1
    ds_write_b32 v254, v255
    s_mov_b64 exec, -1
    s_cmp_lt_u32 s58, s22
    s_cbranch_scc0 K2_dyn_68
K2_back_69:
    s_waitcnt lgkmcnt(4)
    v_lshlrev_b32 v20, 16, v0
    v_and_b32 v21, 0xffff0000, v0
    v_lshlrev_b32 v22, 16, v1
    v_and_b32 v23, 0xffff0000, v1
    v_lshlrev_b32 v24, 16, v2
    v_and_b32 v25, 0xffff0000, v2
    v_lshlrev_b32 v26, 16, v3
    v_and_b32 v27, 0xffff0000, v3
    v_mul_f32_dpp v36, v16, v20 row_newbcast:8 row_mask:0xf bank_mask:0xf
    v_mul_f32_dpp v37, v16, v21 row_newbcast:9 row_mask:0xf bank_mask:0xf
    v_mul_f32_dpp v38, v16, v22 row_newbcast:10 row_mask:0xf bank_mask:0xf
    v_mul_f32_dpp v39, v16, v23 row_newbcast:11 row_mask:0xf bank_mask:0xf
    v_mul_f32_dpp v40, v16, v24 row_newbcast:12 row_mask:0xf bank_mask:0xf
    v_mul_f32_dpp v41, v16, v25 row_newbcast:13 row_mask:0xf bank_mask:0xf
    v_mul_f32_dpp v42, v16, v26 row_newbcast:14 row_mask:0xf bank_mask:0xf
    v_mul_f32_dpp v43, v16, v27 row_newbcast:15 row_mask:0xf bank_mask:0xf
    v_cvt_pk_bf16_f32 v68, v36, v37
    v_cvt_pk_bf16_f32 v69, v38, v39
    v_cvt_pk_bf16_f32 v70, v40, v41
    v_cvt_pk_bf16_f32 v71, v42, v43
    v_mul_f32_dpp v20, v16, v20 row_newbcast:0 row_mask:0xa bank_mask:0xf
    v_mul_f32_dpp v21, v16, v21 row_newbcast:1 row_mask:0xa bank_mask:0xf
    v_mul_f32_dpp v22, v16, v22 row_newbcast:2 row_mask:0xa bank_mask:0xf
    v_mul_f32_dpp v23, v16, v23 row_newbcast:3 row_mask:0xa bank_mask:0xf
    v_mul_f32_dpp v24, v16, v24 row_newbcast:4 row_mask:0xa bank_mask:0xf
    v_mul_f32_dpp v25, v16, v25 row_newbcast:5 row_mask:0xa bank_mask:0xf
    v_mul_f32_dpp v26, v16, v26 row_newbcast:6 row_mask:0xa bank_mask:0xf
    v_mul_f32_dpp v27, v16, v27 row_newbcast:7 row_mask:0xa bank_mask:0xf
    v_cvt_pk_bf16_f32 v64, v20, v21
    v_cvt_pk_bf16_f32 v65, v22, v23
    v_cvt_pk_bf16_f32 v66, v24, v25
    v_cvt_pk_bf16_f32 v67, v26, v27
    v_readlane_b32 s3, v253, s58
    s_lshl_b32 s44, s34, 7
    s_and_b32 s48, s3, 0x3ffff
    s_bfe_u32 s33, s3, 0x30013
    s_mul_i32 s35, s38, 6
    s_cmp_eq_u32 s34, 0
    s_cselect_b32 s35, s35, s48
    s_mov_b32 s45, s44
    s_xor_b32 s47, s44, 256
    s_add_u32 s49, s48, 128
    s_add_u32 s60, s48, 256
    s_cmp_eq_u32 s33, 3
    s_cselect_b32 s46, s44, s47
    s_cselect_b32 s50, s60, s48
    s_cselect_b32 s51, s48, s49
    s_sub_u32 s60, s33, 2
    s_cmp_lt_u32 s60, 2
    s_cbranch_scc0 K2_rare_74
K2_back_75:
    v_add_u32 v233, s48, v230
    ds_read_b32 v232, v233
    ds_read_b32 v233, v233 offset:1024
    v_add_u32 v222, s48, v251
    ds_read2_b32 v[222:223], v222 offset0:1 offset1:3
    v_add_u32 v224, s49, v251
    ds_read2_b32 v[224:225], v224 offset0:1 offset1:3
    v_add_u32 v226, s50, v251
    ds_read2_b32 v[226:227], v226 offset0:1 offset1:3
    v_add_u32 v228, s51, v251
    ds_read2_b32 v[228:229], v228 offset0:1 offset1:3
    s_waitcnt lgkmcnt(4)
    v_or_b32 v232, v232, v231
    v_or_b32 v233, v233, v231
    s_cmp_lg_u32 s34, 0
    s_cbranch_scc1 K2_dum_77
    s_cmp_eq_u32 s33, 4
    s_cbranch_scc1 K2_a4_78
K2_b4_80:
    s_add_u32 m0, s48, 512
    s_add_u32 s65, s48, 1536
    buffer_load_dwordx4 v232, s[16:19], 0 offen  lds
    s_mov_b32 m0, s65
    s_mov_b32 exec_hi, 0
    buffer_load_dwordx4 v233, s[16:19], 0 offen  lds
    s_mov_b32 exec_hi, -1
K2_back_79:
    s_waitcnt lgkmcnt(3)
    v_mad_u32_u16 v222, v222, s39, v248 op_sel:[1,0,0,0]
    v_mad_u32_u16 v223, v223, s39, v248 op_sel:[1,0,0,0]
    s_waitcnt lgkmcnt(2)
    v_mad_u32_u16 v224, v224, s39, v248 op_sel:[1,0,0,0]
    v_mad_u32_u16 v225, v225, s39, v248 op_sel:[1,0,0,0]
    s_waitcnt lgkmcnt(1)
    v_mad_u32_u16 v226, v226, s39, v248 op_sel:[1,0,0,0]
    v_mad_u32_u16 v227, v227, s39, v248 op_sel:[1,0,0,0]
    s_waitcnt lgkmcnt(0)
    v_mad_u32_u16 v228, v228, s39, v248 op_sel:[1,0,0,0]
    v_mad_u32_u16 v229, v229, s39, v248 op_sel:[1,0,0,0]
    s_waitcnt vmcnt(6)
    v_mfma_f32_32x32x16_bf16 v[0:15], v[64:67], v[176:179], 0
    ds_read_b64_tr_b16 v[184:185], v246 offset:2048
    ds_read_b64_tr_b16 v[186:187], v246 offset:3072
    ds_read_b64_tr_b16 v[188:189], v247 offset:2048
    ds_read_b64_tr_b16 v[190:191], v247 offset:3072
    s_mov_b32 m0, s68
    v_mfma_f32_32x32x16_bf16 v[16:31], v[68:71], v[176:179], 0
    buffer_load_dwordx4 v222, s[4:7], s44 offen sc1 lds
    buffer_load_dwordx4 v223, s[72:75], s44 offen offset:1024 sc1 lds
    v_permlane32_swap_b32 v242, v236
    v_permlane32_swap_b32 v243, v237
    v_mfma_f32_32x32x16_bf16 v[32:47], v[64:67], v[180:183], 0
    v_permlane32_swap_b32 v244, v238
    v_permlane32_swap_b32 v245, v239
    v_permlane32_swap_b32 v240, v241
    v_add_f32 v242, v242, v236
    v_mfma_f32_32x32x16_bf16 v[48:63], v[68:71], v[180:183], 0
    s_setprio 0
    v_add_f32 v243, v243, v237
    v_add_f32 v244, v244, v238
    v_add_f32 v245, v245, v239
    v_add_f32 v240, -v240, -v241
    s_set_gpr_idx_on s32, gpr_idx(DST)
    s_nop 0
    v_cvt_pk_bf16_f32 v195, v242, v243
    v_cvt_pk_bf16_f32 v196, v244, v245
    v_cvt_pk_bf16_f32 v197, v240, v240
    s_set_gpr_idx_off
    v_mul_f32 v234, v0, v96
    v_mul_f32 v236, v8, v128
    v_fmac_f32 v234, v1, v97
    v_fmac_f32 v236, v9, v129
    v_fmac_f32 v234, v2, v98
    v_fmac_f32 v236, v10, v130
    v_fmac_f32 v234, v3, v99
    v_fmac_f32 v236, v11, v131
    v_fmac_f32 v234, v4, v100
    v_fmac_f32 v236, v12, v132
    v_fmac_f32 v234, v5, v101
    v_fmac_f32 v236, v13, v133
    v_fmac_f32 v234, v6, v102
    v_fmac_f32 v236, v14, v134
    v_fmac_f32 v234, v7, v103
    v_fmac_f32 v236, v15, v135
    v_mul_f32 v238, v16, v128
    v_mul_f32 v240, v24, v128
    v_fmac_f32 v238, v17, v129
    v_fmac_f32 v240, v25, v129
    v_fmac_f32 v238, v18, v130
    v_fmac_f32 v240, v26, v130
    v_fmac_f32 v238, v19, v131
    v_fmac_f32 v240, v27, v131
    v_fmac_f32 v238, v20, v132
    v_fmac_f32 v240, v28, v132
    v_fmac_f32 v238, v21, v133
    v_fmac_f32 v240, v29, v133
    v_fmac_f32 v238, v22, v134
    v_fmac_f32 v240, v30, v134
    v_fmac_f32 v238, v23, v135
    v_fmac_f32 v240, v31, v135
    v_mul_f32 v235, v32, v104
    v_mul_f32 v237, v40, v136
    v_fmac_f32 v235, v33, v105
    v_fmac_f32 v237, v41, v137
    v_fmac_f32 v235, v34, v106
    v_fmac_f32 v237, v42, v138
    v_fmac_f32 v235, v35, v107
    v_fmac_f32 v237, v43, v139
    v_fmac_f32 v235, v36, v108
    v_fmac_f32 v237, v44, v140
    v_fmac_f32 v235, v37, v109
    v_fmac_f32 v237, v45, v141
    v_fmac_f32 v235, v38, v110
    v_fmac_f32 v237, v46, v142
    v_fmac_f32 v235, v39, v111
    v_fmac_f32 v237, v47, v143
    v_mul_f32 v239, v48, v136
    v_mul_f32 v241, v56, v136
    v_fmac_f32 v239, v49, v137
    v_fmac_f32 v241, v57, v137
    v_fmac_f32 v239, v50, v138
    v_fmac_f32 v241, v58, v138
    v_fmac_f32 v239, v51, v139
    v_fmac_f32 v241, v59, v139
    v_fmac_f32 v239, v52, v140
    v_fmac_f32 v241, v60, v140
    v_fmac_f32 v239, v53, v141
    v_fmac_f32 v241, v61, v141
    v_fmac_f32 v239, v54, v142
    v_fmac_f32 v241, v62, v142
    v_fmac_f32 v239, v55, v143
    v_fmac_f32 v241, v63, v143
    s_setprio 1
    s_waitcnt vmcnt(6) lgkmcnt(0)
    v_mfma_f32_32x32x16_bf16 v[0:15], v[64:67], v[184:187], 0
    ds_read_b64_tr_b16 v[176:177], v246 offset:4096
    ds_read_b64_tr_b16 v[178:179], v246 offset:5120
    ds_read_b64_tr_b16 v[180:181], v247 offset:4096
    ds_read_b64_tr_b16 v[182:183], v247 offset:5120
    s_mov_b32 m0, s69
    v_mfma_f32_32x32x16_bf16 v[16:31], v[68:71], v[184:187], 0
    buffer_load_dwordx4 v224, s[4:7], s45 offen sc1 lds
    buffer_load_dwordx4 v225, s[72:75], s45 offen offset:1024 sc1 lds
    v_permlane32_swap_b32 v234, v236
    v_permlane32_swap_b32 v235, v237
    v_mfma_f32_32x32x16_bf16 v[32:47], v[64:67], v[188:191], 0
    v_permlane32_swap_b32 v240, v238
    v_permlane32_swap_b32 v241, v239
    v_add_f32 v234, v234, v236
    v_add_f32 v235, v235, v237
    v_add_f32 v240, v240, v238
    v_mfma_f32_32x32x16_bf16 v[48:63], v[68:71], v[188:191], 0
    s_setprio 0
    v_add_f32 v241, v241, v239
    s_set_gpr_idx_on s31, gpr_idx(DST)
    s_nop 0
    v_cvt_pk_bf16_f32 v192, v234, v235
    v_cvt_pk_bf16_f32 v193, v240, v241
    s_set_gpr_idx_off
    v_mul_f32 v234, v0, v144
    v_mul_f32 v236, v8, v112
    v_fmac_f32 v234, v1, v145
    v_fmac_f32 v236, v9, v113
    v_fmac_f32 v234, v2, v146
    v_fmac_f32 v236, v10, v114
    v_fmac_f32 v234, v3, v147
    v_fmac_f32 v236, v11, v115
    v_fmac_f32 v234, v4, v148
    v_fmac_f32 v236, v12, v116
    v_fmac_f32 v234, v5, v149
    v_fmac_f32 v236, v13, v117
    v_fmac_f32 v234, v6, v150
    v_fmac_f32 v236, v14, v118
    v_fmac_f32 v234, v7, v151
    v_fmac_f32 v236, v15, v119
    v_mul_f32 v238, v16, v160
    v_mul_f32 v240, v24, v160
    v_fmac_f32 v238, v17, v161
    v_fmac_f32 v240, v25, v161
    v_fmac_f32 v238, v18, v162
    v_fmac_f32 v240, v26, v162
    v_fmac_f32 v238, v19, v163
    v_fmac_f32 v240, v27, v163
    v_fmac_f32 v238, v20, v164
    v_fmac_f32 v240, v28, v164
    v_fmac_f32 v238, v21, v165
    v_fmac_f32 v240, v29, v165
    v_fmac_f32 v238, v22, v166
    v_fmac_f32 v240, v30, v166
    v_fmac_f32 v238, v23, v167
    v_fmac_f32 v240, v31, v167
    v_mul_f32 v235, v32, v152
    v_mul_f32 v237, v40, v120
    v_fmac_f32 v235, v33, v153
    v_fmac_f32 v237, v41, v121
    v_fmac_f32 v235, v34, v154
    v_fmac_f32 v237, v42, v122
    v_fmac_f32 v235, v35, v155
    v_fmac_f32 v237, v43, v123
    v_fmac_f32 v235, v36, v156
    v_fmac_f32 v237, v44, v124
    v_fmac_f32 v235, v37, v157
    v_fmac_f32 v237, v45, v125
    v_fmac_f32 v235, v38, v158
    v_fmac_f32 v237, v46, v126
    v_fmac_f32 v235, v39, v159
    v_fmac_f32 v237, v47, v127
    v_mul_f32 v239, v48, v168
    v_mul_f32 v241, v56, v168
    v_fmac_f32 v239, v49, v169
    v_fmac_f32 v241, v57, v169
    v_fmac_f32 v239, v50, v170
    v_fmac_f32 v241, v58, v170
    v_fmac_f32 v239, v51, v171
    v_fmac_f32 v241, v59, v171
    v_fmac_f32 v239, v52, v172
    v_fmac_f32 v241, v60, v172
    v_fmac_f32 v239, v53, v173
    v_fmac_f32 v241, v61, v173
    v_fmac_f32 v239, v54, v174
    v_fmac_f32 v241, v62, v174
    v_fmac_f32 v239, v55, v175
    v_fmac_f32 v241, v63, v175
    s_setprio 1
    s_waitcnt vmcnt(6) lgkmcnt(0)
    v_mfma_f32_32x32x16_bf16 v[0:15], v[64:67], v[176:179], 0
    ds_read_b64_tr_b16 v[184:185], v246 offset:6144
    ds_read_b64_tr_b16 v[186:187], v246 offset:7168
    ds_read_b64_tr_b16 v[188:189], v247 offset:6144
    ds_read_b64_tr_b16 v[190:191], v247 offset:7168
    s_mov_b32 m0, s70
    v_mfma_f32_32x32x16_bf16 v[16:31], v[68:71], v[176:179], 0
    buffer_load_dwordx4 v226, s[4:7], s46 offen sc1 lds
    buffer_load_dwordx4 v227, s[72:75], s46 offen offset:1024 sc1 lds
    s_sub_u32 s26, s48, s29
    s_mov_b32 s29, s48
    s_mov_b32 s30, s3
    s_bfe_u32 s56, s3, 0x40012
    v_mfma_f32_32x32x16_bf16 v[32:47], v[64:67], v[180:183], 0
    s_cmp_eq_u32 s34, 0
    s_cselect_b32 s56, s56, 0
    v_mfma_f32_32x32x16_bf16 v[48:63], v[68:71], v[180:183], 0
    s_setprio 0
    v_mul_f32 v242, v0, v144
    v_fma_f32 v238, v8, v160, -v238
    v_fmac_f32 v242, v1, v145
    v_fmac_f32 v238, v9, v161
    v_fmac_f32 v242, v2, v146
    v_fmac_f32 v238, v10, v162
    v_fmac_f32 v242, v3, v147
    v_fmac_f32 v238, v11, v163
    v_fmac_f32 v242, v4, v148
    v_fmac_f32 v238, v12, v164
    v_fmac_f32 v242, v5, v149
    v_fmac_f32 v238, v13, v165
    v_fmac_f32 v242, v6, v150
    v_fmac_f32 v238, v14, v166
    v_fmac_f32 v242, v7, v151
    v_fmac_f32 v238, v15, v167
    v_fmac_f32 v236, v16, v112
    v_mul_f32 v244, v24, v160
    v_fmac_f32 v236, v17, v113
    v_fmac_f32 v244, v25, v161
    v_fmac_f32 v236, v18, v114
    v_fmac_f32 v244, v26, v162
    v_fmac_f32 v236, v19, v115
    v_fmac_f32 v244, v27, v163
    v_fmac_f32 v236, v20, v116
    v_fmac_f32 v244, v28, v164
    v_fmac_f32 v236, v21, v117
    v_fmac_f32 v244, v29, v165
    v_fmac_f32 v236, v22, v118
    v_fmac_f32 v244, v30, v166
    v_fmac_f32 v236, v23, v119
    v_fmac_f32 v244, v31, v167
    v_mul_f32 v243, v32, v152
    v_fma_f32 v239, v40, v168, -v239
    v_fmac_f32 v243, v33, v153
    v_fmac_f32 v239, v41, v169
    v_fmac_f32 v243, v34, v154
    v_fmac_f32 v239, v42, v170
    v_fmac_f32 v243, v35, v155
    v_fmac_f32 v239, v43, v171
    v_fmac_f32 v243, v36, v156
    v_fmac_f32 v239, v44, v172
    v_fmac_f32 v243, v37, v157
    v_fmac_f32 v239, v45, v173
    v_fmac_f32 v243, v38, v158
    v_fmac_f32 v239, v46, v174
    v_fmac_f32 v243, v39, v159
    v_fmac_f32 v239, v47, v175
    v_fmac_f32 v237, v48, v120
    v_mul_f32 v245, v56, v168
    v_fmac_f32 v237, v49, v121
    v_fmac_f32 v245, v57, v169
    v_fmac_f32 v237, v50, v122
    v_fmac_f32 v245, v58, v170
    v_fmac_f32 v237, v51, v123
    v_fmac_f32 v245, v59, v171
    v_fmac_f32 v237, v52, v124
    v_fmac_f32 v245, v60, v172
    v_fmac_f32 v237, v53, v125
    v_fmac_f32 v245, v61, v173
    v_fmac_f32 v237, v54, v126
    v_fmac_f32 v245, v62, v174
    v_fmac_f32 v237, v55, v127
    v_fmac_f32 v245, v63, v175
    s_setprio 1
    s_waitcnt vmcnt(4) lgkmcnt(0)
    v_mfma_f32_32x32x16_bf16 v[0:15], v[64:67], v[184:187], 0
    ds_read_b64_tr_b16 v[176:177], v246 offset:0
    ds_read_b64_tr_b16 v[178:179], v246 offset:1024
    ds_read_b64_tr_b16 v[180:181], v247 offset:0
    ds_read_b64_tr_b16 v[182:183], v247 offset:1024
    s_mov_b32 m0, s71
    v_mfma_f32_32x32x16_bf16 v[16:31], v[68:71], v[184:187], 0
    buffer_load_dwordx4 v228, s[4:7], s47 offen sc1 lds
    buffer_load_dwordx4 v229, s[72:75], s47 offen offset:1024 sc1 lds
    v_permlane32_swap_b32 v242, v234
    v_permlane32_swap_b32 v243, v235
    v_add_f32 v242, v242, v234
    v_mfma_f32_32x32x16_bf16 v[32:47], v[64:67], v[188:191], 0
    v_add_f32 v243, v243, v235
    s_set_gpr_idx_on s31, gpr_idx(DST)
    s_nop 0
    v_cvt_pk_bf16_f32 v194, v242, v243
    s_set_gpr_idx_off
    s_mov_b32 s32, s31
    s_mov_b32 s31, s35
    v_mfma_f32_32x32x16_bf16 v[48:63], v[68:71], v[188:191], 0
    s_setprio 0
    v_mul_f32 v242, v0, v144
    v_fma_f32 v240, v8, v160, -v240
    v_fmac_f32 v242, v1, v145
    v_fmac_f32 v240, v9, v161
    v_fmac_f32 v242, v2, v146
    v_fmac_f32 v240, v10, v162
    v_fmac_f32 v242, v3, v147
    v_fmac_f32 v240, v11, v163
    v_fmac_f32 v242, v4, v148
    v_fmac_f32 v240, v12, v164
    v_fmac_f32 v242, v5, v149
    v_fmac_f32 v240, v13, v165
    v_fmac_f32 v242, v6, v150
    v_fmac_f32 v240, v14, v166
    v_fmac_f32 v242, v7, v151
    v_fmac_f32 v240, v15, v167
    v_add_u32 v249, s26, v249
    v_add_u32 v250, s26, v250
    v_fma_f32 v244, v16, v160, -v244
    v_fmac_f32 v236, v24, v112
    v_fmac_f32 v244, v17, v161
    v_fmac_f32 v236, v25, v113
    v_fmac_f32 v244, v18, v162
    v_fmac_f32 v236, v26, v114
    v_fmac_f32 v244, v19, v163
    v_fmac_f32 v236, v27, v115
    v_fmac_f32 v244, v20, v164
    v_fmac_f32 v236, v28, v116
    v_fmac_f32 v244, v21, v165
    v_fmac_f32 v236, v29, v117
    v_fmac_f32 v244, v22, v166
    v_fmac_f32 v236, v30, v118
    v_fmac_f32 v244, v23, v167
    v_fmac_f32 v236, v31, v119
    ds_read_b64_tr_b16 v[0:1], v249 offset:0
    ds_read_b64_tr_b16 v[2:3], v249 offset:32
    ds_read_u16_d16_hi v16, v250 offset:0
    v_mul_f32 v243, v32, v152
    v_fma_f32 v241, v40, v168, -v241
    v_fmac_f32 v243, v33, v153
    v_fmac_f32 v241, v41, v169
    v_fmac_f32 v243, v34, v154
    v_fmac_f32 v241, v42, v170
    v_fmac_f32 v243, v35, v155
    v_fmac_f32 v241, v43, v171
    v_fmac_f32 v243, v36, v156
    v_fmac_f32 v241, v44, v172
    v_fmac_f32 v243, v37, v157
    v_fmac_f32 v241, v45, v173
    v_fmac_f32 v243, v38, v158
    v_fmac_f32 v241, v46, v174
    v_fmac_f32 v243, v39, v159
    v_fmac_f32 v241, v47, v175
    ds_read_b64_tr_b16 v[4:5], v249 offset:512
    ds_read_b64_tr_b16 v[6:7], v249 offset:544
    ds_read_u16_d16_hi v17, v250 offset:128
    v_fma_f32 v245, v48, v168, -v245
    v_fmac_f32 v237, v56, v120
    v_fmac_f32 v245, v49, v169
    v_fmac_f32 v237, v57, v121
    v_fmac_f32 v245, v50, v170
    v_fmac_f32 v237, v58, v122
    v_fmac_f32 v245, v51, v171
    v_fmac_f32 v237, v59, v123
    v_fmac_f32 v245, v52, v172
    v_fmac_f32 v237, v60, v124
    v_fmac_f32 v245, v53, v173
    v_fmac_f32 v237, v61, v125
    v_fmac_f32 v245, v54, v174
    v_fmac_f32 v237, v62, v126
    v_fmac_f32 v245, v55, v175
    v_fmac_f32 v237, v63, v127
    s_cmp_eq_u32 s56, 5
    s_cbranch_scc1 K2_U20
    s_cmp_eq_u32 s56, 6
    s_cbranch_scc1 K2_U3h0
    s_branch K2_DSP0
K2_U40:
    s_setprio 1
    ds_read_b64_tr_b16 v[8:9], v249 offset:1024
    ds_read_b64_tr_b16 v[10:11], v249 offset:1056
    ds_read_u16_d16_hi v18, v250 offset:256
    s_lshr_b32 s65, s30, 28
    s_mul_i32 s66, s22, 2080
    s_lshl_b32 s65, s65, 9
    s_add_u32 s65, s65, s66
    s_add_u32 s65, s65, 65536
    s_sub_u32 s65, s65, s29
    s_sub_u32 s65, s65, 512
    v_add_u32 v56, s65, v249
    ds_read_b64_tr_b16 v[12:13], v56 offset:0
    ds_read_b64_tr_b16 v[14:15], v56 offset:32
    ds_read_u16_d16_hi v19, v250 offset:384
    s_waitcnt lgkmcnt(6)
    v_lshlrev_b32 v20, 16, v0
    v_and_b32 v21, 0xffff0000, v0
    v_lshlrev_b32 v22, 16, v1
    v_and_b32 v23, 0xffff0000, v1
    v_lshlrev_b32 v24, 16, v2
    v_and_b32 v25, 0xffff0000, v2
    v_lshlrev_b32 v26, 16, v3
    v_and_b32 v27, 0xffff0000, v3
    v_mul_f32_dpp v36, v16, v20 row_newbcast:8 row_mask:0xf bank_mask:0xf
    v_mul_f32_dpp v37, v16, v21 row_newbcast:9 row_mask:0xf bank_mask:0xf
    v_mul_f32_dpp v38, v16, v22 row_newbcast:10 row_mask:0xf bank_mask:0xf
    v_mul_f32_dpp v39, v16, v23 row_newbcast:11 row_mask:0xf bank_mask:0xf
    v_mul_f32_dpp v40, v16, v24 row_newbcast:12 row_mask:0xf bank_mask:0xf
    v_mul_f32_dpp v41, v16, v25 row_newbcast:13 row_mask:0xf bank_mask:0xf
    v_mul_f32_dpp v42, v16, v26 row_newbcast:14 row_mask:0xf bank_mask:0xf
    v_mul_f32_dpp v43, v16, v27 row_newbcast:15 row_mask:0xf bank_mask:0xf
    v_cvt_pk_bf16_f32 v68, v36, v37
    v_cvt_pk_bf16_f32 v69, v38, v39
    v_cvt_pk_bf16_f32 v70, v40, v41
    v_cvt_pk_bf16_f32 v71, v42, v43
    v_mul_f32_dpp v20, v16, v20 row_newbcast:0 row_mask:0xa bank_mask:0xf
    v_mul_f32_dpp v21, v16, v21 row_newbcast:1 row_mask:0xa bank_mask:0xf
    v_mul_f32_dpp v22, v16, v22 row_newbcast:2 row_mask:0xa bank_mask:0xf
    v_mul_f32_dpp v23, v16, v23 row_newbcast:3 row_mask:0xa bank_mask:0xf
    v_mul_f32_dpp v24, v16, v24 row_newbcast:4 row_mask:0xa bank_mask:0xf
    v_mul_f32_dpp v25, v16, v25 row_newbcast:5 row_mask:0xa bank_mask:0xf
    v_mul_f32_dpp v26, v16, v26 row_newbcast:6 row_mask:0xa bank_mask:0xf
    v_mul_f32_dpp v27, v16, v27 row_newbcast:7 row_mask:0xa bank_mask:0xf
    v_cvt_pk_bf16_f32 v64, v20, v21
    v_cvt_pk_bf16_f32 v65, v22, v23
    v_cvt_pk_bf16_f32 v66, v24, v25
    v_cvt_pk_bf16_f32 v67, v26, v27
    v_lshlrev_b32 v28, 16, v4
    v_and_b32 v29, 0xffff0000, v4
    v_lshlrev_b32 v30, 16, v5
    v_and_b32 v31, 0xffff0000, v5
    v_lshlrev_b32 v32, 16, v6
    v_and_b32 v33, 0xffff0000, v6
    v_lshlrev_b32 v34, 16, v7
    v_and_b32 v35, 0xffff0000, v7
    v_mul_f32_dpp v36, v17, v28 row_newbcast:8 row_mask:0xf bank_mask:0xf
    v_mul_f32_dpp v37, v17, v29 row_newbcast:9 row_mask:0xf bank_mask:0xf
    v_mul_f32_dpp v38, v17, v30 row_newbcast:10 row_mask:0xf bank_mask:0xf
    v_mul_f32_dpp v39, v17, v31 row_newbcast:11 row_mask:0xf bank_mask:0xf
    v_mul_f32_dpp v40, v17, v32 row_newbcast:12 row_mask:0xf bank_mask:0xf
    v_mul_f32_dpp v41, v17, v33 row_newbcast:13 row_mask:0xf bank_mask:0xf
    v_mul_f32_dpp v42, v17, v34 row_newbcast:14 row_mask:0xf bank_mask:0xf
    v_mul_f32_dpp v43, v17, v35 row_newbcast:15 row_mask:0xf bank_mask:0xf
    v_cvt_pk_bf16_f32 v76, v36, v37
    v_cvt_pk_bf16_f32 v77, v38, v39
    v_cvt_pk_bf16_f32 v78, v40, v41
    v_cvt_pk_bf16_f32 v79, v42, v43
    v_mul_f32_dpp v28, v17, v28 row_newbcast:0 row_mask:0xa bank_mask:0xf
    v_mul_f32_dpp v29, v17, v29 row_newbcast:1 row_mask:0xa bank_mask:0xf
    v_mul_f32_dpp v30, v17, v30 row_newbcast:2 row_mask:0xa bank_mask:0xf
    v_mul_f32_dpp v31, v17, v31 row_newbcast:3 row_mask:0xa bank_mask:0xf
    v_mul_f32_dpp v32, v17, v32 row_newbcast:4 row_mask:0xa bank_mask:0xf
    v_mul_f32_dpp v33, v17, v33 row_newbcast:5 row_mask:0xa bank_mask:0xf
    v_mul_f32_dpp v34, v17, v34 row_newbcast:6 row_mask:0xa bank_mask:0xf
    v_mul_f32_dpp v35, v17, v35 row_newbcast:7 row_mask:0xa bank_mask:0xf
    v_cvt_pk_bf16_f32 v72, v28, v29
    v_cvt_pk_bf16_f32 v73, v30, v31
    v_cvt_pk_bf16_f32 v74, v32, v33
    v_cvt_pk_bf16_f32 v75, v34, v35
    s_waitcnt lgkmcnt(3)
    v_lshlrev_b32 v20, 16, v8
    v_and_b32 v21, 0xffff0000, v8
    v_lshlrev_b32 v22, 16, v9
    v_and_b32 v23, 0xffff0000, v9
    v_lshlrev_b32 v24, 16, v10
    v_and_b32 v25, 0xffff0000, v10
    v_lshlrev_b32 v26, 16, v11
    v_and_b32 v27, 0xffff0000, v11
    v_mul_f32_dpp v36, v18, v20 row_newbcast:8 row_mask:0xf bank_mask:0xf
    v_mul_f32_dpp v37, v18, v21 row_newbcast:9 row_mask:0xf bank_mask:0xf
    v_mul_f32_dpp v38, v18, v22 row_newbcast:10 row_mask:0xf bank_mask:0xf
    v_mul_f32_dpp v39, v18, v23 row_newbcast:11 row_mask:0xf bank_mask:0xf
    v_mul_f32_dpp v40, v18, v24 row_newbcast:12 row_mask:0xf bank_mask:0xf
    v_mul_f32_dpp v41, v18, v25 row_newbcast:13 row_mask:0xf bank_mask:0xf
    v_mul_f32_dpp v42, v18, v26 row_newbcast:14 row_mask:0xf bank_mask:0xf
    v_mul_f32_dpp v43, v18, v27 row_newbcast:15 row_mask:0xf bank_mask:0xf
    v_cvt_pk_bf16_f32 v84, v36, v37
    v_cvt_pk_bf16_f32 v85, v38, v39
    v_cvt_pk_bf16_f32 v86, v40, v41
    v_cvt_pk_bf16_f32 v87, v42, v43
    v_mul_f32_dpp v20, v18, v20 row_newbcast:0 row_mask:0xa bank_mask:0xf
    v_mul_f32_dpp v21, v18, v21 row_newbcast:1 row_mask:0xa bank_mask:0xf
    v_mul_f32_dpp v22, v18, v22 row_newbcast:2 row_mask:0xa bank_mask:0xf
    v_mul_f32_dpp v23, v18, v23 row_newbcast:3 row_mask:0xa bank_mask:0xf
    v_mul_f32_dpp v24, v18, v24 row_newbcast:4 row_mask:0xa bank_mask:0xf
    v_mul_f32_dpp v25, v18, v25 row_newbcast:5 row_mask:0xa bank_mask:0xf
    v_mul_f32_dpp v26, v18, v26 row_newbcast:6 row_mask:0xa bank_mask:0xf
    v_mul_f32_dpp v27, v18, v27 row_newbcast:7 row_mask:0xa bank_mask:0xf
    v_cvt_pk_bf16_f32 v80, v20, v21
    v_cvt_pk_bf16_f32 v81, v22, v23
    v_cvt_pk_bf16_f32 v82, v24, v25
    v_cvt_pk_bf16_f32 v83, v26, v27
    s_waitcnt lgkmcnt(0)
    v_lshlrev_b32 v28, 16, v12
    v_and_b32 v29, 0xffff0000, v12
    v_lshlrev_b32 v30, 16, v13
    v_and_b32 v31, 0xffff0000, v13
    v_lshlrev_b32 v32, 16, v14
    v_and_b32 v33, 0xffff0000, v14
    v_lshlrev_b32 v34, 16, v15
    v_and_b32 v35, 0xffff0000, v15
    v_mul_f32_dpp v36, v19, v28 row_newbcast:8 row_mask:0xf bank_mask:0xf
    v_mul_f32_dpp v37, v19, v29 row_newbcast:9 row_mask:0xf bank_mask:0xf
    v_mul_f32_dpp v38, v19, v30 row_newbcast:10 row_mask:0xf bank_mask:0xf
    v_mul_f32_dpp v39, v19, v31 row_newbcast:11 row_mask:0xf bank_mask:0xf
    v_mul_f32_dpp v40, v19, v32 row_newbcast:12 row_mask:0xf bank_mask:0xf
    v_mul_f32_dpp v41, v19, v33 row_newbcast:13 row_mask:0xf bank_mask:0xf
    v_mul_f32_dpp v42, v19, v34 row_newbcast:14 row_mask:0xf bank_mask:0xf
    v_mul_f32_dpp v43, v19, v35 row_newbcast:15 row_mask:0xf bank_mask:0xf
    v_cvt_pk_bf16_f32 v92, v36, v37
    v_cvt_pk_bf16_f32 v93, v38, v39
    v_cvt_pk_bf16_f32 v94, v40, v41
    v_cvt_pk_bf16_f32 v95, v42, v43
    v_mul_f32_dpp v28, v19, v28 row_newbcast:0 row_mask:0xa bank_mask:0xf
    v_mul_f32_dpp v29, v19, v29 row_newbcast:1 row_mask:0xa bank_mask:0xf
    v_mul_f32_dpp v30, v19, v30 row_newbcast:2 row_mask:0xa bank_mask:0xf
    v_mul_f32_dpp v31, v19, v31 row_newbcast:3 row_mask:0xa bank_mask:0xf
    v_mul_f32_dpp v32, v19, v32 row_newbcast:4 row_mask:0xa bank_mask:0xf
    v_mul_f32_dpp v33, v19, v33 row_newbcast:5 row_mask:0xa bank_mask:0xf
    v_mul_f32_dpp v34, v19, v34 row_newbcast:6 row_mask:0xa bank_mask:0xf
    v_mul_f32_dpp v35, v19, v35 row_newbcast:7 row_mask:0xa bank_mask:0xf
    v_cvt_pk_bf16_f32 v88, v28, v29
    v_cvt_pk_bf16_f32 v89, v30, v31
    v_cvt_pk_bf16_f32 v90, v32, v33
    v_cvt_pk_bf16_f32 v91, v34, v35
    s_waitcnt vmcnt(4)
    v_mfma_f32_32x32x16_bf16 v[0:15], v[64:67], v[176:179], 0
    ds_read_b64_tr_b16 v[184:185], v246 offset:2048
    ds_read_b64_tr_b16 v[186:187], v246 offset:3072
    ds_read_b64_tr_b16 v[188:189], v247 offset:2048
    ds_read_b64_tr_b16 v[190:191], v247 offset:3072
    s_mov_b32 m0, s68
    v_mfma_f32_32x32x16_bf16 v[16:31], v[68:71], v[176:179], 0
    buffer_load_dwordx4 v222, s[4:7], s41 offen sc1 lds
    buffer_load_dwordx4 v223, s[72:75], s41 offen offset:1024 sc1 lds
    v_permlane32_swap_b32 v242, v236
    v_permlane32_swap_b32 v243, v237
    s_add_u32 s38, s38, 1
    v_mfma_f32_32x32x16_bf16 v[32:47], v[64:67], v[180:183], 0
    v_permlane32_swap_b32 v244, v238
    v_permlane32_swap_b32 v245, v239
    v_permlane32_swap_b32 v240, v241
    v_add_f32 v242, v242, v236
    v_mfma_f32_32x32x16_bf16 v[48:63], v[68:71], v[180:183], 0
    v_add_f32 v243, v243, v237
    v_add_f32 v244, v244, v238
    v_add_f32 v245, v245, v239
    v_add_f32 v240, -v240, -v241
    v_mov_b32 v254, s52
    v_mov_b32 v255, s38
    s_waitcnt vmcnt(4) lgkmcnt(0)
    v_mfma_f32_32x32x16_bf16 v[0:15], v[72:75], v[184:187], v[0:15]
    ds_read_b64_tr_b16 v[176:177], v246 offset:4096
    ds_read_b64_tr_b16 v[178:179], v246 offset:5120
    ds_read_b64_tr_b16 v[180:181], v247 offset:4096
    ds_read_b64_tr_b16 v[182:183], v247 offset:5120
    s_lshl_b32 s58, s38, 3
    s_add_u32 s58, s58, s20
    s_mov_b32 m0, s69
    v_mfma_f32_32x32x16_bf16 v[16:31], v[76:79], v[184:187], v[16:31]
    buffer_load_dwordx4 v224, s[4:7], s41 offen sc1 lds
    buffer_load_dwordx4 v225, s[72:75], s41 offen offset:1024 sc1 lds
    s_set_gpr_idx_on s32, gpr_idx(DST)
    s_nop 0
    v_cvt_pk_bf16_f32 v195, v242, v243
    v_cvt_pk_bf16_f32 v196, v244, v245
    v_cvt_pk_bf16_f32 v197, v240, v240
    s_set_gpr_idx_off
    s_mov_b64 exec, 1
    ds_write_b32 v254, v255
    s_mov_b64 exec, -1
    s_cmp_lt_u32 s58, s22
    s_cbranch_scc0 K2_dyn_81
K2_back_82:
    v_readlane_b32 s3, v253, s58
    s_lshl_b32 s44, s34, 7
    s_and_b32 s48, s3, 0x3ffff
    s_bfe_u32 s33, s3, 0x30013
    s_mul_i32 s35, s38, 6
    s_cmp_eq_u32 s34, 0
    s_cselect_b32 s35, s35, s48
    s_mov_b32 s45, s44
    s_xor_b32 s47, s44, 256
    s_add_u32 s49, s48, 128
    s_add_u32 s60, s48, 256
    s_cmp_eq_u32 s33, 3
    s_cselect_b32 s46, s44, s47
    s_cselect_b32 s50, s60, s48
    s_cselect_b32 s51, s48, s49
    s_sub_u32 s60, s33, 2
    s_cmp_lt_u32 s60, 2
    s_cbranch_scc0 K2_rare_87
K2_back_88:
    v_mfma_f32_32x32x16_bf16 v[32:47], v[72:75], v[188:191], v[32:47]
    v_add_u32 v233, s48, v230
    ds_read_b32 v232, v233
    ds_read_b32 v233, v233 offset:1024
    v_mfma_f32_32x32x16_bf16 v[48:63], v[76:79], v[188:191], v[48:63]
    s_waitcnt vmcnt(4) lgkmcnt(3)
    v_mfma_f32_32x32x16_bf16 v[0:15], v[80:83], v[176:179], v[0:15]
    ds_read_b64_tr_b16 v[184:185], v246 offset:6144
    ds_read_b64_tr_b16 v[186:187], v246 offset:7168
    ds_read_b64_tr_b16 v[188:189], v247 offset:6144
    ds_read_b64_tr_b16 v[190:191], v247 offset:7168
    s_mov_b32 m0, s70
    v_mfma_f32_32x32x16_bf16 v[16:31], v[84:87], v[176:179], v[16:31]
    buffer_load_dwordx4 v226, s[4:7], s41 offen sc1 lds
    buffer_load_dwordx4 v227, s[72:75], s41 offen offset:1024 sc1 lds
    v_mfma_f32_32x32x16_bf16 v[32:47], v[80:83], v[180:183], v[32:47]
    v_mfma_f32_32x32x16_bf16 v[48:63], v[84:87], v[180:183], v[48:63]
    s_waitcnt lgkmcnt(4)
    v_or_b32 v232, v232, v231
    v_or_b32 v233, v233, v231
    s_cmp_lg_u32 s34, 0
    s_cbranch_scc1 K2_dum_90
    s_cmp_eq_u32 s33, 4
    s_cbranch_scc1 K2_a4_91
K2_b4_93:
    s_add_u32 m0, s48, 512
    s_add_u32 s65, s48, 1536
    buffer_load_dwordx4 v232, s[16:19], 0 offen  lds
    s_mov_b32 m0, s65
    s_mov_b32 exec_hi, 0
    buffer_load_dwordx4 v233, s[16:19], 0 offen  lds
    s_mov_b32 exec_hi, -1
K2_back_92:
    s_waitcnt vmcnt(6) lgkmcnt(0)
    v_mfma_f32_32x32x16_bf16 v[0:15], v[88:91], v[184:187], v[0:15]
    ds_read_b64_tr_b16 v[176:177], v246 offset:0
    ds_read_b64_tr_b16 v[178:179], v246 offset:1024
    ds_read_b64_tr_b16 v[180:181], v247 offset:0
    ds_read_b64_tr_b16 v[182:183], v247 offset:1024
    s_mov_b32 m0, s71
    v_mfma_f32_32x32x16_bf16 v[16:31], v[92:95], v[184:187], v[16:31]
    buffer_load_dwordx4 v228, s[4:7], s41 offen sc1 lds
    buffer_load_dwordx4 v229, s[72:75], s41 offen offset:1024 sc1 lds
    v_mfma_f32_32x32x16_bf16 v[32:47], v[88:91], v[188:191], v[32:47]
    s_nop 2
    v_mul_f32 v234, v0, v96
    v_mul_f32 v236, v8, v128
    v_fmac_f32 v234, v1, v97
    v_fmac_f32 v236, v9, v129
    v_fmac_f32 v234, v2, v98
    v_fmac_f32 v236, v10, v130
    v_fmac_f32 v234, v3, v99
    v_mfma_f32_32x32x16_bf16 v[48:63], v[92:95], v[188:191], v[48:63]
    s_setprio 0
    v_fmac_f32 v236, v11, v131
    v_fmac_f32 v234, v4, v100
    v_fmac_f32 v236, v12, v132
    v_fmac_f32 v234, v5, v101
    v_fmac_f32 v236, v13, v133
    v_fmac_f32 v234, v6, v102
    v_fmac_f32 v236, v14, v134
    v_fmac_f32 v234, v7, v103
    v_fmac_f32 v236, v15, v135
    v_mul_f32 v238, v16, v128
    v_mul_f32 v240, v24, v128
    v_fmac_f32 v238, v17, v129
    v_fmac_f32 v240, v25, v129
    v_fmac_f32 v238, v18, v130
    v_fmac_f32 v240, v26, v130
    v_fmac_f32 v238, v19, v131
    v_fmac_f32 v240, v27, v131
    v_fmac_f32 v238, v20, v132
    v_fmac_f32 v240, v28, v132
    v_fmac_f32 v238, v21, v133
    v_fmac_f32 v240, v29, v133
    v_fmac_f32 v238, v22, v134
    v_fmac_f32 v240, v30, v134
    v_fmac_f32 v238, v23, v135
    v_fmac_f32 v240, v31, v135
    v_mul_f32 v235, v32, v104
    v_mul_f32 v237, v40, v136
    v_fmac_f32 v235, v33, v105
    v_fmac_f32 v237, v41, v137
    v_fmac_f32 v235, v34, v106
    v_fmac_f32 v237, v42, v138
    v_fmac_f32 v235, v35, v107
    v_fmac_f32 v237, v43, v139
    v_fmac_f32 v235, v36, v108
    v_fmac_f32 v237, v44, v140
    v_fmac_f32 v235, v37, v109
    v_fmac_f32 v237, v45, v141
    v_fmac_f32 v235, v38, v110
    v_fmac_f32 v237, v46, v142
    v_fmac_f32 v235, v39, v111
    v_fmac_f32 v237, v47, v143
    v_mul_f32 v239, v48, v136
    v_mul_f32 v241, v56, v136
    s_setprio 1
    s_waitcnt vmcnt(6) lgkmcnt(0)
    v_mfma_f32_32x32x16_bf16 v[0:15], v[64:67], v[176:179], 0
    ds_read_b64_tr_b16 v[184:185], v246 offset:2048
    ds_read_b64_tr_b16 v[186:187], v246 offset:3072
    ds_read_b64_tr_b16 v[188:189], v247 offset:2048
    ds_read_b64_tr_b16 v[190:191], v247 offset:3072
    v_fmac_f32 v239, v49, v137
    v_fmac_f32 v241, v57, v137
    s_mov_b32 m0, s68
    v_mfma_f32_32x32x16_bf16 v[16:31], v[68:71], v[176:179], 0
    buffer_load_dwordx4 v222, s[4:7], s42 offen sc1 lds
    buffer_load_dwordx4 v223, s[72:75], s42 offen offset:1024 sc1 lds
    v_fmac_f32 v239, v50, v138
    v_fmac_f32 v241, v58, v138
    v_fmac_f32 v239, v51, v139
    v_fmac_f32 v241, v59, v139
    v_fmac_f32 v239, v52, v140
    v_mfma_f32_32x32x16_bf16 v[32:47], v[64:67], v[180:183], 0
    v_fmac_f32 v241, v60, v140
    v_fmac_f32 v239, v53, v141
    v_fmac_f32 v241, v61, v141
    v_fmac_f32 v239, v54, v142
    v_fmac_f32 v241, v62, v142
    v_fmac_f32 v239, v55, v143
    v_fmac_f32 v241, v63, v143
    v_mfma_f32_32x32x16_bf16 v[48:63], v[68:71], v[180:183], 0
    v_permlane32_swap_b32 v234, v236
    v_permlane32_swap_b32 v235, v237
    v_permlane32_swap_b32 v240, v238
    s_waitcnt vmcnt(6) lgkmcnt(0)
    v_mfma_f32_32x32x16_bf16 v[0:15], v[72:75], v[184:187], v[0:15]
    ds_read_b64_tr_b16 v[176:177], v246 offset:4096
    ds_read_b64_tr_b16 v[178:179], v246 offset:5120
    ds_read_b64_tr_b16 v[180:181], v247 offset:4096
    ds_read_b64_tr_b16 v[182:183], v247 offset:5120
    v_permlane32_swap_b32 v241, v239
    s_mov_b32 m0, s69
    v_mfma_f32_32x32x16_bf16 v[16:31], v[76:79], v[184:187], v[16:31]
    buffer_load_dwordx4 v224, s[4:7], s42 offen sc1 lds
    buffer_load_dwordx4 v225, s[72:75], s42 offen offset:1024 sc1 lds
    v_add_f32 v234, v234, v236
    v_add_f32 v235, v235, v237
    v_add_f32 v240, v240, v238
    v_add_f32 v241, v241, v239
    v_mfma_f32_32x32x16_bf16 v[32:47], v[72:75], v[188:191], v[32:47]
    s_set_gpr_idx_on s31, gpr_idx(DST)
    s_nop 0
    v_cvt_pk_bf16_f32 v192, v234, v235
    v_cvt_pk_bf16_f32 v193, v240, v241
    s_set_gpr_idx_off
    v_mfma_f32_32x32x16_bf16 v[48:63], v[76:79], v[188:191], v[48:63]
    s_waitcnt vmcnt(4) lgkmcnt(0)
    v_mfma_f32_32x32x16_bf16 v[0:15], v[80:83], v[176:179], v[0:15]
    ds_read_b64_tr_b16 v[184:185], v246 offset:6144
    ds_read_b64_tr_b16 v[186:187], v246 offset:7168
    ds_read_b64_tr_b16 v[188:189], v247 offset:6144
    ds_read_b64_tr_b16 v[190:191], v247 offset:7168
    s_mov_b32 m0, s70
    v_mfma_f32_32x32x16_bf16 v[16:31], v[84:87], v[176:179], v[16:31]
    buffer_load_dwordx4 v226, s[4:7], s42 offen sc1 lds
    buffer_load_dwordx4 v227, s[72:75], s42 offen offset:1024 sc1 lds
    v_mfma_f32_32x32x16_bf16 v[32:47], v[80:83], v[180:183], v[32:47]
    v_mfma_f32_32x32x16_bf16 v[48:63], v[84:87], v[180:183], v[48:63]
    s_waitcnt vmcnt(4) lgkmcnt(0)
    v_mfma_f32_32x32x16_bf16 v[0:15], v[88:91], v[184:187], v[0:15]
    ds_read_b64_tr_b16 v[176:177], v246 offset:0
    ds_read_b64_tr_b16 v[178:179], v246 offset:1024
    ds_read_b64_tr_b16 v[180:181], v247 offset:0
    ds_read_b64_tr_b16 v[182:183], v247 offset:1024
    s_mov_b32 m0, s71
    v_mfma_f32_32x32x16_bf16 v[16:31], v[92:95], v[184:187], v[16:31]
    buffer_load_dwordx4 v228, s[4:7], s42 offen sc1 lds
    buffer_load_dwordx4 v229, s[72:75], s42 offen offset:1024 sc1 lds
    v_mfma_f32_32x32x16_bf16 v[32:47], v[88:91], v[188:191], v[32:47]
    s_nop 2
    v_mul_f32 v234, v0, v144
    v_mul_f32 v236, v8, v112
    v_fmac_f32 v234, v1, v145
    v_fmac_f32 v236, v9, v113
    v_fmac_f32 v234, v2, v146
    v_fmac_f32 v236, v10, v114
    v_fmac_f32 v234, v3, v147
    v_mfma_f32_32x32x16_bf16 v[48:63], v[92:95], v[188:191], v[48:63]
    s_setprio 0
    v_fmac_f32 v236, v11, v115
    v_fmac_f32 v234, v4, v148
    v_fmac_f32 v236, v12, v116
    v_fmac_f32 v234, v5, v149
    v_fmac_f32 v236, v13, v117
    v_fmac_f32 v234, v6, v150
    v_fmac_f32 v236, v14, v118
    v_fmac_f32 v234, v7, v151
    v_fmac_f32 v236, v15, v119
    v_mul_f32 v238, v16, v160
    v_mul_f32 v240, v24, v160
    v_fmac_f32 v238, v17, v161
    v_fmac_f32 v240, v25, v161
    v_fmac_f32 v238, v18, v162
    v_fmac_f32 v240, v26, v162
    v_fmac_f32 v238, v19, v163
    v_fmac_f32 v240, v27, v163
    v_fmac_f32 v238, v20, v164
    v_fmac_f32 v240, v28, v164
    v_fmac_f32 v238, v21, v165
    v_fmac_f32 v240, v29, v165
    v_fmac_f32 v238, v22, v166
    v_fmac_f32 v240, v30, v166
    v_fmac_f32 v238, v23, v167
    v_fmac_f32 v240, v31, v167
    v_mul_f32 v235, v32, v152
    v_mul_f32 v237, v40, v120
    v_fmac_f32 v235, v33, v153
    v_fmac_f32 v237, v41, v121
    v_fmac_f32 v235, v34, v154
    v_fmac_f32 v237, v42, v122
    v_fmac_f32 v235, v35, v155
    v_fmac_f32 v237, v43, v123
    v_fmac_f32 v235, v36, v156
    v_fmac_f32 v237, v44, v124
    v_fmac_f32 v235, v37, v157
    v_fmac_f32 v237, v45, v125
    v_fmac_f32 v235, v38, v158
    v_fmac_f32 v237, v46, v126
    v_fmac_f32 v235, v39, v159
    v_fmac_f32 v237, v47, v127
    v_mul_f32 v239, v48, v168
    v_mul_f32 v241, v56, v168
    s_setprio 1
    s_waitcnt vmcnt(4) lgkmcnt(0)
    v_mfma_f32_32x32x16_bf16 v[0:15], v[64:67], v[176:179], 0
    ds_read_b64_tr_b16 v[184:185], v246 offset:2048
    ds_read_b64_tr_b16 v[186:187], v246 offset:3072
    ds_read_b64_tr_b16 v[188:189], v247 offset:2048
    ds_read_b64_tr_b16 v[190:191], v247 offset:3072
    v_fmac_f32 v239, v49, v169
    v_fmac_f32 v241, v57, v169
    s_mov_b32 m0, s68
    v_mfma_f32_32x32x16_bf16 v[16:31], v[68:71], v[176:179], 0
    buffer_load_dwordx4 v222, s[4:7], s43 offen sc1 lds
    buffer_load_dwordx4 v223, s[72:75], s43 offen offset:1024 sc1 lds
    v_fmac_f32 v239, v50, v170
    v_fmac_f32 v241, v58, v170
    v_fmac_f32 v239, v51, v171
    v_fmac_f32 v241, v59, v171
    v_fmac_f32 v239, v52, v172
    v_mfma_f32_32x32x16_bf16 v[32:47], v[64:67], v[180:183], 0
    v_fmac_f32 v241, v60, v172
    v_fmac_f32 v239, v53, v173
    v_fmac_f32 v241, v61, v173
    v_fmac_f32 v239, v54, v174
    v_fmac_f32 v241, v62, v174
    v_fmac_f32 v239, v55, v175
    v_fmac_f32 v241, v63, v175
    v_mfma_f32_32x32x16_bf16 v[48:63], v[68:71], v[180:183], 0
    s_waitcnt vmcnt(4) lgkmcnt(0)
    v_mfma_f32_32x32x16_bf16 v[0:15], v[72:75], v[184:187], v[0:15]
    ds_read_b64_tr_b16 v[176:177], v246 offset:4096
    ds_read_b64_tr_b16 v[178:179], v246 offset:5120
    ds_read_b64_tr_b16 v[180:181], v247 offset:4096
    ds_read_b64_tr_b16 v[182:183], v247 offset:5120
    s_mov_b32 m0, s69
    v_mfma_f32_32x32x16_bf16 v[16:31], v[76:79], v[184:187], v[16:31]
    buffer_load_dwordx4 v224, s[4:7], s43 offen sc1 lds
    buffer_load_dwordx4 v225, s[72:75], s43 offen offset:1024 sc1 lds
    v_mfma_f32_32x32x16_bf16 v[32:47], v[72:75], v[188:191], v[32:47]
    v_mfma_f32_32x32x16_bf16 v[48:63], v[76:79], v[188:191], v[48:63]
    s_waitcnt vmcnt(4) lgkmcnt(0)
    v_mfma_f32_32x32x16_bf16 v[0:15], v[80:83], v[176:179], v[0:15]
    ds_read_b64_tr_b16 v[184:185], v246 offset:6144
    ds_read_b64_tr_b16 v[186:187], v246 offset:7168
    ds_read_b64_tr_b16 v[188:189], v247 offset:6144
    ds_read_b64_tr_b16 v[190:191], v247 offset:7168
    s_mov_b32 m0, s70
    v_mfma_f32_32x32x16_bf16 v[16:31], v[84:87], v[176:179], v[16:31]
    buffer_load_dwordx4 v226, s[4:7], s43 offen sc1 lds
    buffer_load_dwordx4 v227, s[72:75], s43 offen offset:1024 sc1 lds
    v_mfma_f32_32x32x16_bf16 v[32:47], v[80:83], v[180:183], v[32:47]
    v_add_u32 v222, s48, v251
    ds_read2_b32 v[222:223], v222 offset0:1 offset1:3
    v_mfma_f32_32x32x16_bf16 v[48:63], v[84:87], v[180:183], v[48:63]
    s_waitcnt vmcnt(4) lgkmcnt(1)
    v_mfma_f32_32x32x16_bf16 v[0:15], v[88:91], v[184:187], v[0:15]
    ds_read_b64_tr_b16 v[176:177], v246 offset:0
    ds_read_b64_tr_b16 v[178:179], v246 offset:1024
    ds_read_b64_tr_b16 v[180:181], v247 offset:0
    ds_read_b64_tr_b16 v[182:183], v247 offset:1024
    s_mov_b32 m0, s71
    v_mfma_f32_32x32x16_bf16 v[16:31], v[92:95], v[184:187], v[16:31]
    buffer_load_dwordx4 v228, s[4:7], s43 offen sc1 lds
    buffer_load_dwordx4 v229, s[72:75], s43 offen offset:1024 sc1 lds
    s_waitcnt lgkmcnt(4)
    v_mad_u32_u16 v222, v222, s39, v248 op_sel:[1,0,0,0]
    v_mad_u32_u16 v223, v223, s39, v248 op_sel:[1,0,0,0]
    v_mfma_f32_32x32x16_bf16 v[32:47], v[88:91], v[188:191], v[32:47]
    v_add_u32 v224, s49, v251
    ds_read2_b32 v[224:225], v224 offset0:1 offset1:3
    v_mul_f32 v242, v0, v144
    v_fma_f32 v238, v8, v160, -v238
    v_fmac_f32 v242, v1, v145
    v_fmac_f32 v238, v9, v161
    v_fmac_f32 v242, v2, v146
    v_mfma_f32_32x32x16_bf16 v[48:63], v[92:95], v[188:191], v[48:63]
    s_setprio 0
    v_fmac_f32 v238, v10, v162
    v_fmac_f32 v242, v3, v147
    v_fmac_f32 v238, v11, v163
    v_fmac_f32 v242, v4, v148
    v_fmac_f32 v238, v12, v164
    v_fmac_f32 v242, v5, v149
    v_fmac_f32 v238, v13, v165
    v_fmac_f32 v242, v6, v150
    v_fmac_f32 v238, v14, v166
    v_fmac_f32 v242, v7, v151
    v_fmac_f32 v238, v15, v167
    v_fmac_f32 v236, v16, v112
    v_mul_f32 v244, v24, v160
    v_fmac_f32 v236, v17, v113
    v_fmac_f32 v244, v25, v161
    v_fmac_f32 v236, v18, v114
    v_fmac_f32 v244, v26, v162
    v_fmac_f32 v236, v19, v115
    v_fmac_f32 v244, v27, v163
    v_fmac_f32 v236, v20, v116
    v_fmac_f32 v244, v28, v164
    v_fmac_f32 v236, v21, v117
    v_fmac_f32 v244, v29, v165
    v_fmac_f32 v236, v22, v118
    v_fmac_f32 v244, v30, v166
    v_fmac_f32 v236, v23, v119
    v_fmac_f32 v244, v31, v167
    v_mul_f32 v243, v32, v152
    v_fma_f32 v239, v40, v168, -v239
    v_fmac_f32 v243, v33, v153
    v_fmac_f32 v239, v41, v169
    v_fmac_f32 v243, v34, v154
    v_fmac_f32 v239, v42, v170
    v_fmac_f32 v243, v35, v155
    v_fmac_f32 v239, v43, v171
    v_fmac_f32 v243, v36, v156
    v_fmac_f32 v239, v44, v172
    v_fmac_f32 v243, v37, v157
    v_fmac_f32 v239, v45, v173
    v_fmac_f32 v243, v38, v158
    v_fmac_f32 v239, v46, v174
    v_fmac_f32 v243, v39, v159
    v_fmac_f32 v239, v47, v175
    v_fmac_f32 v237, v48, v120
    v_mul_f32 v245, v56, v168
    v_fmac_f32 v237, v49, v121
    v_fmac_f32 v245, v57, v169
    v_fmac_f32 v237, v50, v122
    v_fmac_f32 v245, v58, v170
    v_fmac_f32 v237, v51, v123
    s_setprio 1
    s_waitcnt vmcnt(4) lgkmcnt(1)
    v_mfma_f32_32x32x16_bf16 v[0:15], v[64:67], v[176:179], 0
    ds_read_b64_tr_b16 v[184:185], v246 offset:2048
    ds_read_b64_tr_b16 v[186:187], v246 offset:3072
    ds_read_b64_tr_b16 v[188:189], v247 offset:2048
    ds_read_b64_tr_b16 v[190:191], v247 offset:3072
    v_fmac_f32 v245, v59, v171
    v_fmac_f32 v237, v52, v124
    s_mov_b32 m0, s68
    v_mfma_f32_32x32x16_bf16 v[16:31], v[68:71], v[176:179], 0
    buffer_load_dwordx4 v222, s[4:7], s44 offen sc1 lds
    buffer_load_dwordx4 v223, s[72:75], s44 offen offset:1024 sc1 lds
    s_waitcnt lgkmcnt(4)
    v_mad_u32_u16 v224, v224, s39, v248 op_sel:[1,0,0,0]
    v_mad_u32_u16 v225, v225, s39, v248 op_sel:[1,0,0,0]
    v_fmac_f32 v245, v60, v172
    v_fmac_f32 v237, v53, v125
    v_mfma_f32_32x32x16_bf16 v[32:47], v[64:67], v[180:183], 0
    v_add_u32 v226, s50, v251
    ds_read2_b32 v[226:227], v226 offset0:1 offset1:3
    v_fmac_f32 v245, v61, v173
    v_fmac_f32 v237, v54, v126
    v_fmac_f32 v245, v62, v174
    v_fmac_f32 v237, v55, v127
    v_fmac_f32 v245, v63, v175
    v_mfma_f32_32x32x16_bf16 v[48:63], v[68:71], v[180:183], 0
    v_permlane32_swap_b32 v242, v234
    v_permlane32_swap_b32 v243, v235
    v_add_f32 v242, v242, v234
    v_add_f32 v243, v243, v235
    s_waitcnt vmcnt(4) lgkmcnt(1)
    v_mfma_f32_32x32x16_bf16 v[0:15], v[72:75], v[184:187], v[0:15]
    ds_read_b64_tr_b16 v[176:177], v246 offset:4096
    ds_read_b64_tr_b16 v[178:179], v246 offset:5120
    ds_read_b64_tr_b16 v[180:181], v247 offset:4096
    ds_read_b64_tr_b16 v[182:183], v247 offset:5120
    s_mov_b32 m0, s69
    v_mfma_f32_32x32x16_bf16 v[16:31], v[76:79], v[184:187], v[16:31]
    buffer_load_dwordx4 v224, s[4:7], s45 offen sc1 lds
    buffer_load_dwordx4 v225, s[72:75], s45 offen offset:1024 sc1 lds
    s_waitcnt lgkmcnt(4)
    v_mad_u32_u16 v226, v226, s39, v248 op_sel:[1,0,0,0]
    v_mad_u32_u16 v227, v227, s39, v248 op_sel:[1,0,0,0]
    v_mfma_f32_32x32x16_bf16 v[32:47], v[72:75], v[188:191], v[32:47]
    v_add_u32 v228, s51, v251
    ds_read2_b32 v[228:229], v228 offset0:1 offset1:3
    s_set_gpr_idx_on s31, gpr_idx(DST)
    s_nop 0
    v_cvt_pk_bf16_f32 v194, v242, v243
    s_set_gpr_idx_off
    v_mfma_f32_32x32x16_bf16 v[48:63], v[76:79], v[188:191], v[48:63]
    s_waitcnt vmcnt(4) lgkmcnt(1)
    v_mfma_f32_32x32x16_bf16 v[0:15], v[80:83], v[176:179], v[0:15]
    ds_read_b64_tr_b16 v[184:185], v246 offset:6144
    ds_read_b64_tr_b16 v[186:187], v246 offset:7168
    ds_read_b64_tr_b16 v[188:189], v247 offset:6144
    ds_read_b64_tr_b16 v[190:191], v247 offset:7168
    s_mov_b32 s32, s31
    s_mov_b32 s31, s35
    s_mov_b32 m0, s70
    v_mfma_f32_32x32x16_bf16 v[16:31], v[84:87], v[176:179], v[16:31]
    buffer_load_dwordx4 v226, s[4:7], s46 offen sc1 lds
    buffer_load_dwordx4 v227, s[72:75], s46 offen offset:1024 sc1 lds
    s_waitcnt lgkmcnt(4)
    v_mad_u32_u16 v228, v228, s39, v248 op_sel:[1,0,0,0]
    v_mad_u32_u16 v229, v229, s39, v248 op_sel:[1,0,0,0]
    s_sub_u32 s26, s48, s29
    s_mov_b32 s29, s48
    v_mfma_f32_32x32x16_bf16 v[32:47], v[80:83], v[180:183], v[32:47]
    s_mov_b32 s30, s3
    s_bfe_u32 s56, s3, 0x40012
    s_cmp_eq_u32 s34, 0
    s_cselect_b32 s56, s56, 0
    v_mfma_f32_32x32x16_bf16 v[48:63], v[84:87], v[180:183], v[48:63]
    s_waitcnt vmcnt(4) lgkmcnt(0)
    v_mfma_f32_32x32x16_bf16 v[0:15], v[88:91], v[184:187], v[0:15]
    ds_read_b64_tr_b16 v[176:177], v246 offset:0
    ds_read_b64_tr_b16 v[178:179], v246 offset:1024
    ds_read_b64_tr_b16 v[180:181], v247 offset:0
    ds_read_b64_tr_b16 v[182:183], v247 offset:1024
    s_mov_b32 m0, s71
    v_mfma_f32_32x32x16_bf16 v[16:31], v[92:95], v[184:187], v[16:31]
    buffer_load_dwordx4 v228, s[4:7], s47 offen sc1 lds
    buffer_load_dwordx4 v229, s[72:75], s47 offen offset:1024 sc1 lds
    v_mfma_f32_32x32x16_bf16 v[32:47], v[88:91], v[188:191], v[32:47]
    s_nop 2
    v_mul_f32 v242, v0, v144
    v_fma_f32 v240, v8, v160, -v240
    v_fmac_f32 v242, v1, v145
    v_fmac_f32 v240, v9, v161
    v_fmac_f32 v242, v2, v146
    v_fmac_f32 v240, v10, v162
    v_fmac_f32 v242, v3, v147
    v_mfma_f32_32x32x16_bf16 v[48:63], v[92:95], v[188:191], v[48:63]
    s_setprio 0
    v_fmac_f32 v240, v11, v163
    v_fmac_f32 v242, v4, v148
    v_fmac_f32 v240, v12, v164
    v_fmac_f32 v242, v5, v149
    v_fmac_f32 v240, v13, v165
    v_fmac_f32 v242, v6, v150
    v_fmac_f32 v240, v14, v166
    v_fmac_f32 v242, v7, v151
    v_fmac_f32 v240, v15, v167
    v_add_u32 v249, s26, v249
    v_add_u32 v250, s26, v250
    v_fma_f32 v244, v16, v160, -v244
    v_fmac_f32 v236, v24, v112
    v_fmac_f32 v244, v17, v161
    v_fmac_f32 v236, v25, v113
    v_fmac_f32 v244, v18, v162
    v_fmac_f32 v236, v26, v114
    v_fmac_f32 v244, v19, v163
    v_fmac_f32 v236, v27, v115
    v_fmac_f32 v244, v20, v164
    v_fmac_f32 v236, v28, v116
    v_fmac_f32 v244, v21, v165
    v_fmac_f32 v236, v29, v117
    v_fmac_f32 v244, v22, v166
    v_fmac_f32 v236, v30, v118
    v_fmac_f32 v244, v23, v167
    v_fmac_f32 v236, v31, v119
    ds_read_b64_tr_b16 v[0:1], v249 offset:0
    ds_read_b64_tr_b16 v[2:3], v249 offset:32
    ds_read_u16_d16_hi v16, v250 offset:0
    v_mul_f32 v243, v32, v152
    v_fma_f32 v241, v40, v168, -v241
    v_fmac_f32 v243, v33, v153
    v_fmac_f32 v241, v41, v169
    v_fmac_f32 v243, v34, v154
    v_fmac_f32 v241, v42, v170
    v_fmac_f32 v243, v35, v155
    v_fmac_f32 v241, v43, v171
    v_fmac_f32 v243, v36, v156
    v_fmac_f32 v241, v44, v172
    v_fmac_f32 v243, v37, v157
    v_fmac_f32 v241, v45, v173
    v_fmac_f32 v243, v38, v158
    v_fmac_f32 v241, v46, v174
    v_fmac_f32 v243, v39, v159
    v_fmac_f32 v241, v47, v175
    ds_read_b64_tr_b16 v[4:5], v249 offset:512
    ds_read_b64_tr_b16 v[6:7], v249 offset:544
    ds_read_u16_d16_hi v17, v250 offset:128
    v_fma_f32 v245, v48, v168, -v245
    v_fmac_f32 v237, v56, v120
    v_fmac_f32 v245, v49, v169
    v_fmac_f32 v237, v57, v121
    v_fmac_f32 v245, v50, v170
    v_fmac_f32 v237, v58, v122
    v_fmac_f32 v245, v51, v171
    v_fmac_f32 v237, v59, v123
    v_fmac_f32 v245, v52, v172
    v_fmac_f32 v237, v60, v124
    v_fmac_f32 v245, v53, v173
    v_fmac_f32 v237, v61, v125
    v_fmac_f32 v245, v54, v174
    v_fmac_f32 v237, v62, v126
    v_fmac_f32 v245, v55, v175
    v_fmac_f32 v237, v63, v127
    s_cmp_eq_u32 s56, 5
    s_cbranch_scc1 K2_U20
    s_cmp_eq_u32 s56, 6
    s_cbranch_scc1 K2_U3h0
    s_branch K2_DSP0
K2_U11:
    s_setprio 1
    v_mov_b32 v254, 163296
    v_mov_b32 v255, 1
    v_lshl_add_u32 v233, v252, 1, s53
    s_mov_b64 exec, 1
    ds_add_rtn_u32 v232, v254, v255
    s_mov_b64 exec, -1
    ds_read_b32 v233, v233
    s_waitcnt lgkmcnt(5)
    v_lshlrev_b32 v20, 16, v0
    v_and_b32 v21, 0xffff0000, v0
    v_lshlrev_b32 v22, 16, v1
    v_and_b32 v23, 0xffff0000, v1
    v_lshlrev_b32 v24, 16, v2
    v_and_b32 v25, 0xffff0000, v2
    v_lshlrev_b32 v26, 16, v3
    v_and_b32 v27, 0xffff0000, v3
    v_mul_f32_dpp v36, v16, v20 row_newbcast:8 row_mask:0xf bank_mask:0xf
    v_mul_f32_dpp v37, v16, v21 row_newbcast:9 row_mask:0xf bank_mask:0xf
    v_mul_f32_dpp v38, v16, v22 row_newbcast:10 row_mask:0xf bank_mask:0xf
    v_mul_f32_dpp v39, v16, v23 row_newbcast:11 row_mask:0xf bank_mask:0xf
    v_mul_f32_dpp v40, v16, v24 row_newbcast:12 row_mask:0xf bank_mask:0xf
    v_mul_f32_dpp v41, v16, v25 row_newbcast:13 row_mask:0xf bank_mask:0xf
    v_mul_f32_dpp v42, v16, v26 row_newbcast:14 row_mask:0xf bank_mask:0xf
    v_mul_f32_dpp v43, v16, v27 row_newbcast:15 row_mask:0xf bank_mask:0xf
    v_cvt_pk_bf16_f32 v68, v36, v37
    v_cvt_pk_bf16_f32 v69, v38, v39
    v_cvt_pk_bf16_f32 v70, v40, v41
    v_cvt_pk_bf16_f32 v71, v42, v43
    v_mul_f32_dpp v20, v16, v20 row_newbcast:0 row_mask:0xa bank_mask:0xf
    v_mul_f32_dpp v21, v16, v21 row_newbcast:1 row_mask:0xa bank_mask:0xf
    v_mul_f32_dpp v22, v16, v22 row_newbcast:2 row_mask:0xa bank_mask:0xf
    v_mul_f32_dpp v23, v16, v23 row_newbcast:3 row_mask:0xa bank_mask:0xf
    v_mul_f32_dpp v24, v16, v24 row_newbcast:4 row_mask:0xa bank_mask:0xf
    v_mul_f32_dpp v25, v16, v25 row_newbcast:5 row_mask:0xa bank_mask:0xf
    v_mul_f32_dpp v26, v16, v26 row_newbcast:6 row_mask:0xa bank_mask:0xf
    v_mul_f32_dpp v27, v16, v27 row_newbcast:7 row_mask:0xa bank_mask:0xf
    v_cvt_pk_bf16_f32 v64, v20, v21
    v_cvt_pk_bf16_f32 v65, v22, v23
    v_cvt_pk_bf16_f32 v66, v24, v25
    v_cvt_pk_bf16_f32 v67, v26, v27
    s_waitcnt lgkmcnt(0)
    v_readfirstlane_b32 s58, v232
    s_nop 0
    s_cmp_lt_u32 s58, s22
    s_cbranch_scc0 K2_nul_94
    s_nop 0
    v_readlane_b32 s58, v253, s58
    s_nop 0
    s_bfe_u32 s58, s58, 0x60016
    s_and_b32 s59, s58, 7
    s_lshr_b32 s60, s58, 3
K2_chk_96:
    v_readlane_b32 s61, v233, s59
    s_nop 0
    s_cmp_gt_u32 s61, s60
    s_cbranch_scc0 K2_spin_95
K2_back_97:
    v_readlane_b32 s3, v253, s58
    s_lshl_b32 s44, s34, 7
    s_and_b32 s48, s3, 0x3ffff
    s_bfe_u32 s33, s3, 0x30013
    s_mov_b32 s35, s48
    s_mov_b32 s45, s44
    s_xor_b32 s47, s44, 256
    s_add_u32 s49, s48, 128
    s_add_u32 s60, s48, 256
    s_cmp_eq_u32 s33, 3
    s_cselect_b32 s46, s44, s47
    s_cselect_b32 s50, s60, s48
    s_cselect_b32 s51, s48, s49
    s_sub_u32 s60, s33, 2
    s_cmp_lt_u32 s60, 2
    s_cbranch_scc0 K2_rare_98
K2_back_99:
    v_add_u32 v222, s48, v251
    ds_read2_b32 v[222:223], v222 offset0:1 offset1:3
    v_add_u32 v224, s49, v251
    ds_read2_b32 v[224:225], v224 offset0:1 offset1:3
    v_add_u32 v226, s50, v251
    ds_read2_b32 v[226:227], v226 offset0:1 offset1:3
    v_add_u32 v228, s51, v251
    ds_read2_b32 v[228:229], v228 offset0:1 offset1:3
    s_waitcnt lgkmcnt(3)
    v_mad_u32_u16 v222, v222, s39, v248 op_sel:[1,0,0,0]
    v_mad_u32_u16 v223, v223, s39, v248 op_sel:[1,0,0,0]
    s_waitcnt lgkmcnt(2)
    v_mad_u32_u16 v224, v224, s39, v248 op_sel:[1,0,0,0]
    v_mad_u32_u16 v225, v225, s39, v248 op_sel:[1,0,0,0]
    s_waitcnt lgkmcnt(1)
    v_mad_u32_u16 v226, v226, s39, v248 op_sel:[1,0,0,0]
    v_mad_u32_u16 v227, v227, s39, v248 op_sel:[1,0,0,0]
    s_waitcnt lgkmcnt(0)
    v_mad_u32_u16 v228, v228, s39, v248 op_sel:[1,0,0,0]
    v_mad_u32_u16 v229, v229, s39, v248 op_sel:[1,0,0,0]
    s_waitcnt vmcnt(4)
    v_mfma_f32_32x32x16_bf16 v[0:15], v[64:67], v[176:179], 0
    ds_read_b64_tr_b16 v[184:185], v246 offset:2048
    ds_read_b64_tr_b16 v[186:187], v246 offset:3072
    ds_read_b64_tr_b16 v[188:189], v247 offset:2048
    ds_read_b64_tr_b16 v[190:191], v247 offset:3072
    s_mov_b32 m0, s68
    v_mfma_f32_32x32x16_bf16 v[16:31], v[68:71], v[176:179], 0
    buffer_load_dwordx4 v222, s[4:7], s44 offen sc1 lds
    buffer_load_dwordx4 v223, s[72:75], s44 offen offset:1024 sc1 lds
    v_permlane32_swap_b32 v242, v236
    v_permlane32_swap_b32 v243, v237
    v_mfma_f32_32x32x16_bf16 v[32:47], v[64:67], v[180:183], 0
    v_permlane32_swap_b32 v244, v238
    v_permlane32_swap_b32 v245, v239
    v_permlane32_swap_b32 v240, v241
    v_add_f32 v242, v242, v236
    v_mfma_f32_32x32x16_bf16 v[48:63], v[68:71], v[180:183], 0
    s_setprio 0
    v_add_f32 v243, v243, v237
    v_add_f32 v244, v244, v238
    v_add_f32 v245, v245, v239
    v_add_f32 v240, -v240, -v241
    v_sub_u32 v241, v230, v231
    v_cvt_pk_bf16_f32 v242, v242, v243
    v_cvt_pk_bf16_f32 v244, v244, v245
    v_cvt_pk_bf16_f32 v240, v240, v240
    ds_write_b32 v230, v242 offset:768
    ds_write_b32 v230, v244 offset:1024
    ds_write_b16 v241, v240 offset:1280
    v_mul_f32 v234, v0, v96
    v_mul_f32 v236, v8, v128
    v_fmac_f32 v234, v1, v97
    v_fmac_f32 v236, v9, v129
    v_fmac_f32 v234, v2, v98
    v_fmac_f32 v236, v10, v130
    v_fmac_f32 v234, v3, v99
    v_fmac_f32 v236, v11, v131
    v_fmac_f32 v234, v4, v100
    v_fmac_f32 v236, v12, v132
    v_fmac_f32 v234, v5, v101
    v_fmac_f32 v236, v13, v133
    v_fmac_f32 v234, v6, v102
    v_fmac_f32 v236, v14, v134
    v_fmac_f32 v234, v7, v103
    v_fmac_f32 v236, v15, v135
    v_mul_f32 v238, v16, v128
    v_mul_f32 v240, v24, v128
    v_fmac_f32 v238, v17, v129
    v_fmac_f32 v240, v25, v129
    v_fmac_f32 v238, v18, v130
    v_fmac_f32 v240, v26, v130
    v_fmac_f32 v238, v19, v131
    v_fmac_f32 v240, v27, v131
    v_fmac_f32 v238, v20, v132
    v_fmac_f32 v240, v28, v132
    v_fmac_f32 v238, v21, v133
    v_fmac_f32 v240, v29, v133
    v_fmac_f32 v238, v22, v134
    v_fmac_f32 v240, v30, v134
    v_fmac_f32 v238, v23, v135
    v_fmac_f32 v240, v31, v135
    v_mul_f32 v235, v32, v104
    v_mul_f32 v237, v40, v136
    v_fmac_f32 v235, v33, v105
    v_fmac_f32 v237, v41, v137
    v_fmac_f32 v235, v34, v106
    v_fmac_f32 v237, v42, v138
    v_fmac_f32 v235, v35, v107
    v_fmac_f32 v237, v43, v139
    v_fmac_f32 v235, v36, v108
    v_fmac_f32 v237, v44, v140
    v_fmac_f32 v235, v37, v109
    v_fmac_f32 v237, v45, v141
    v_fmac_f32 v235, v38, v110
    v_fmac_f32 v237, v46, v142
    v_fmac_f32 v235, v39, v111
    v_fmac_f32 v237, v47, v143
    v_mul_f32 v239, v48, v136
    v_mul_f32 v241, v56, v136
    v_fmac_f32 v239, v49, v137
    v_fmac_f32 v241, v57, v137
    v_fmac_f32 v239, v50, v138
    v_fmac_f32 v241, v58, v138
    v_fmac_f32 v239, v51, v139
    v_fmac_f32 v241, v59, v139
    v_fmac_f32 v239, v52, v140
    v_fmac_f32 v241, v60, v140
    v_fmac_f32 v239, v53, v141
    v_fmac_f32 v241, v61, v141
    v_fmac_f32 v239, v54, v142
    v_fmac_f32 v241, v62, v142
    v_fmac_f32 v239, v55, v143
    v_fmac_f32 v241, v63, v143
    s_setprio 1
    s_waitcnt vmcnt(4) lgkmcnt(3)
    v_mfma_f32_32x32x16_bf16 v[0:15], v[64:67], v[184:187], 0
    ds_read_b64_tr_b16 v[176:177], v246 offset:4096
    ds_read_b64_tr_b16 v[178:179], v246 offset:5120
    ds_read_b64_tr_b16 v[180:181], v247 offset:4096
    ds_read_b64_tr_b16 v[182:183], v247 offset:5120
    s_mov_b32 m0, s69
    v_mfma_f32_32x32x16_bf16 v[16:31], v[68:71], v[184:187], 0
    buffer_load_dwordx4 v224, s[4:7], s45 offen sc1 lds
    buffer_load_dwordx4 v225, s[72:75], s45 offen offset:1024 sc1 lds
    v_permlane32_swap_b32 v234, v236
    v_permlane32_swap_b32 v235, v237
    v_mfma_f32_32x32x16_bf16 v[32:47], v[64:67], v[188:191], 0
    v_permlane32_swap_b32 v240, v238
    v_permlane32_swap_b32 v241, v239
    v_lshl_add_u32 v230, v252, 1, s31
    v_add_f32 v234, v234, v236
    v_add_f32 v235, v235, v237
    v_mfma_f32_32x32x16_bf16 v[48:63], v[68:71], v[188:191], 0
    s_setprio 0
    v_add_f32 v240, v240, v238
    v_add_f32 v241, v241, v239
    v_cvt_pk_bf16_f32 v234, v234, v235
    v_cvt_pk_bf16_f32 v240, v240, v241
    ds_write_b32 v230, v234 offset:0
    ds_write_b32 v230, v240 offset:256
    v_mul_f32 v234, v0, v144
    v_mul_f32 v236, v8, v112
    v_fmac_f32 v234, v1, v145
    v_fmac_f32 v236, v9, v113
    v_fmac_f32 v234, v2, v146
    v_fmac_f32 v236, v10, v114
    v_fmac_f32 v234, v3, v147
    v_fmac_f32 v236, v11, v115
    v_fmac_f32 v234, v4, v148
    v_fmac_f32 v236, v12, v116
    v_fmac_f32 v234, v5, v149
    v_fmac_f32 v236, v13, v117
    v_fmac_f32 v234, v6, v150
    v_fmac_f32 v236, v14, v118
    v_fmac_f32 v234, v7, v151
    v_fmac_f32 v236, v15, v119
    v_mul_f32 v238, v16, v160
    v_mul_f32 v240, v24, v160
    v_fmac_f32 v238, v17, v161
    v_fmac_f32 v240, v25, v161
    v_fmac_f32 v238, v18, v162
    v_fmac_f32 v240, v26, v162
    v_fmac_f32 v238, v19, v163
    v_fmac_f32 v240, v27, v163
    v_fmac_f32 v238, v20, v164
    v_fmac_f32 v240, v28, v164
    v_fmac_f32 v238, v21, v165
    v_fmac_f32 v240, v29, v165
    v_fmac_f32 v238, v22, v166
    v_fmac_f32 v240, v30, v166
    v_fmac_f32 v238, v23, v167
    v_fmac_f32 v240, v31, v167
    v_mul_f32 v235, v32, v152
    v_mul_f32 v237, v40, v120
    v_fmac_f32 v235, v33, v153
    v_fmac_f32 v237, v41, v121
    v_fmac_f32 v235, v34, v154
    v_fmac_f32 v237, v42, v122
    v_fmac_f32 v235, v35, v155
    v_fmac_f32 v237, v43, v123
    v_fmac_f32 v235, v36, v156
    v_fmac_f32 v237, v44, v124
    v_fmac_f32 v235, v37, v157
    v_fmac_f32 v237, v45, v125
    v_fmac_f32 v235, v38, v158
    v_fmac_f32 v237, v46, v126
    v_fmac_f32 v235, v39, v159
    v_fmac_f32 v237, v47, v127
    v_mul_f32 v239, v48, v168
    v_mul_f32 v241, v56, v168
    v_fmac_f32 v239, v49, v169
    v_fmac_f32 v241, v57, v169
    v_fmac_f32 v239, v50, v170
    v_fmac_f32 v241, v58, v170
    v_fmac_f32 v239, v51, v171
    v_fmac_f32 v241, v59, v171
    v_fmac_f32 v239, v52, v172
    v_fmac_f32 v241, v60, v172
    v_fmac_f32 v239, v53, v173
    v_fmac_f32 v241, v61, v173
    v_fmac_f32 v239, v54, v174
    v_fmac_f32 v241, v62, v174
    v_fmac_f32 v239, v55, v175
    v_fmac_f32 v241, v63, v175
    s_setprio 1
    s_waitcnt vmcnt(4) lgkmcnt(2)
    v_mfma_f32_32x32x16_bf16 v[0:15], v[64:67], v[176:179], 0
    ds_read_b64_tr_b16 v[184:185], v246 offset:6144
    ds_read_b64_tr_b16 v[186:187], v246 offset:7168
    ds_read_b64_tr_b16 v[188:189], v247 offset:6144
    ds_read_b64_tr_b16 v[190:191], v247 offset:7168
    s_mov_b32 s32, s31
    s_mov_b32 s31, s35
    s_mov_b32 m0, s70
    v_mfma_f32_32x32x16_bf16 v[16:31], v[68:71], v[176:179], 0
    buffer_load_dwordx4 v226, s[4:7], s46 offen sc1 lds
    buffer_load_dwordx4 v227, s[72:75], s46 offen offset:1024 sc1 lds
    s_sub_u32 s26, s48, s29
    s_mov_b32 s29, s48
    s_mov_b32 s30, s3
    s_bfe_u32 s56, s3, 0x40012
    v_mfma_f32_32x32x16_bf16 v[32:47], v[64:67], v[180:183], 0
    s_cmp_lg_u32 s36, 0
    s_cselect_b32 s56, s56, 0
    v_mfma_f32_32x32x16_bf16 v[48:63], v[68:71], v[180:183], 0
    s_setprio 0
    v_mul_f32 v242, v0, v144
    v_fma_f32 v238, v8, v160, -v238
    v_fmac_f32 v242, v1, v145
    v_fmac_f32 v238, v9, v161
    v_fmac_f32 v242, v2, v146
    v_fmac_f32 v238, v10, v162
    v_fmac_f32 v242, v3, v147
    v_fmac_f32 v238, v11, v163
    v_fmac_f32 v242, v4, v148
    v_fmac_f32 v238, v12, v164
    v_fmac_f32 v242, v5, v149
    v_fmac_f32 v238, v13, v165
    v_fmac_f32 v242, v6, v150
    v_fmac_f32 v238, v14, v166
    v_fmac_f32 v242, v7, v151
    v_fmac_f32 v238, v15, v167
    v_fmac_f32 v236, v16, v112
    v_mul_f32 v244, v24, v160
    v_fmac_f32 v236, v17, v113
    v_fmac_f32 v244, v25, v161
    v_fmac_f32 v236, v18, v114
    v_fmac_f32 v244, v26, v162
    v_fmac_f32 v236, v19, v115
    v_fmac_f32 v244, v27, v163
    v_fmac_f32 v236, v20, v116
    v_fmac_f32 v244, v28, v164
    v_fmac_f32 v236, v21, v117
    v_fmac_f32 v244, v29, v165
    v_fmac_f32 v236, v22, v118
    v_fmac_f32 v244, v30, v166
    v_fmac_f32 v236, v23, v119
    v_fmac_f32 v244, v31, v167
    v_mul_f32 v243, v32, v152
    v_fma_f32 v239, v40, v168, -v239
    v_fmac_f32 v243, v33, v153
    v_fmac_f32 v239, v41, v169
    v_fmac_f32 v243, v34, v154
    v_fmac_f32 v239, v42, v170
    v_fmac_f32 v243, v35, v155
    v_fmac_f32 v239, v43, v171
    v_fmac_f32 v243, v36, v156
    v_fmac_f32 v239, v44, v172
    v_fmac_f32 v243, v37, v157
    v_fmac_f32 v239, v45, v173
    v_fmac_f32 v243, v38, v158
    v_fmac_f32 v239, v46, v174
    v_fmac_f32 v243, v39, v159
    v_fmac_f32 v239, v47, v175
    v_fmac_f32 v237, v48, v120
    v_mul_f32 v245, v56, v168
    v_fmac_f32 v237, v49, v121
    v_fmac_f32 v245, v57, v169
    v_fmac_f32 v237, v50, v122
    v_fmac_f32 v245, v58, v170
    v_fmac_f32 v237, v51, v123
    v_fmac_f32 v245, v59, v171
    v_fmac_f32 v237, v52, v124
    v_fmac_f32 v245, v60, v172
    v_fmac_f32 v237, v53, v125
    v_fmac_f32 v245, v61, v173
    v_fmac_f32 v237, v54, v126
    v_fmac_f32 v245, v62, v174
    v_fmac_f32 v237, v55, v127
    v_fmac_f32 v245, v63, v175
    s_setprio 1
    s_waitcnt vmcnt(4) lgkmcnt(0)
    v_mfma_f32_32x32x16_bf16 v[0:15], v[64:67], v[184:187], 0
    ds_read_b64_tr_b16 v[176:177], v246 offset:0
    ds_read_b64_tr_b16 v[178:179], v246 offset:1024
    ds_read_b64_tr_b16 v[180:181], v247 offset:0
    ds_read_b64_tr_b16 v[182:183], v247 offset:1024
    s_mov_b32 m0, s71
    v_mfma_f32_32x32x16_bf16 v[16:31], v[68:71], v[184:187], 0
    buffer_load_dwordx4 v228, s[4:7], s47 offen sc1 lds
    buffer_load_dwordx4 v229, s[72:75], s47 offen offset:1024 sc1 lds
    v_permlane32_swap_b32 v242, v234
    v_permlane32_swap_b32 v243, v235
    v_add_f32 v242, v242, v234
    v_mfma_f32_32x32x16_bf16 v[32:47], v[64:67], v[188:191], 0
    v_add_f32 v243, v243, v235
    v_cvt_pk_bf16_f32 v242, v242, v243
    ds_write_b32 v230, v242 offset:512
    v_mfma_f32_32x32x16_bf16 v[48:63], v[68:71], v[188:191], 0
    s_setprio 0
    v_mul_f32 v242, v0, v144
    v_fma_f32 v240, v8, v160, -v240
    v_fmac_f32 v242, v1, v145
    v_fmac_f32 v240, v9, v161
    v_fmac_f32 v242, v2, v146
    v_fmac_f32 v240, v10, v162
    v_fmac_f32 v242, v3, v147
    v_fmac_f32 v240, v11, v163
    v_fmac_f32 v242, v4, v148
    v_fmac_f32 v240, v12, v164
    v_fmac_f32 v242, v5, v149
    v_fmac_f32 v240, v13, v165
    v_fmac_f32 v242, v6, v150
    v_fmac_f32 v240, v14, v166
    v_fmac_f32 v242, v7, v151
    v_fmac_f32 v240, v15, v167
    v_add_u32 v249, s26, v249
    v_add_u32 v250, s26, v250
    v_fma_f32 v244, v16, v160, -v244
    v_fmac_f32 v236, v24, v112
    v_fmac_f32 v244, v17, v161
    v_fmac_f32 v236, v25, v113
    v_fmac_f32 v244, v18, v162
    v_fmac_f32 v236, v26, v114
    v_fmac_f32 v244, v19, v163
    v_fmac_f32 v236, v27, v115
    v_fmac_f32 v244, v20, v164
    v_fmac_f32 v236, v28, v116
    v_fmac_f32 v244, v21, v165
    v_fmac_f32 v236, v29, v117
    v_fmac_f32 v244, v22, v166
    v_fmac_f32 v236, v30, v118
    v_fmac_f32 v244, v23, v167
    v_fmac_f32 v236, v31, v119
    ds_read_b64_tr_b16 v[0:1], v249 offset:0
    ds_read_b64_tr_b16 v[2:3], v249 offset:32
    ds_read_u16_d16_hi v16, v250 offset:0
    v_mul_f32 v243, v32, v152
    v_fma_f32 v241, v40, v168, -v241
    v_fmac_f32 v243, v33, v153
    v_fmac_f32 v241, v41, v169
    v_fmac_f32 v243, v34, v154
    v_fmac_f32 v241, v42, v170
    v_fmac_f32 v243, v35, v155
    v_fmac_f32 v241, v43, v171
    v_fmac_f32 v243, v36, v156
    v_fmac_f32 v241, v44, v172
    v_fmac_f32 v243, v37, v157
    v_fmac_f32 v241, v45, v173
    v_fmac_f32 v243, v38, v158
    v_fmac_f32 v241, v46, v174
    v_fmac_f32 v243, v39, v159
    v_fmac_f32 v241, v47, v175
    ds_read_b64_tr_b16 v[4:5], v249 offset:512
    ds_read_b64_tr_b16 v[6:7], v249 offset:544
    ds_read_u16_d16_hi v17, v250 offset:128
    v_fma_f32 v245, v48, v168, -v245
    v_fmac_f32 v237, v56, v120
    v_fmac_f32 v245, v49, v169
    v_fmac_f32 v237, v57, v121
    v_fmac_f32 v245, v50, v170
    v_fmac_f32 v237, v58, v122
    v_fmac_f32 v245, v51, v171
    v_fmac_f32 v237, v59, v123
    v_fmac_f32 v245, v52, v172
    v_fmac_f32 v237, v60, v124
    v_fmac_f32 v245, v53, v173
    v_fmac_f32 v237, v61, v125
    v_fmac_f32 v245, v54, v174
    v_fmac_f32 v237, v62, v126
    v_fmac_f32 v245, v55, v175
    v_fmac_f32 v237, v63, v127
    s_cmp_eq_u32 s56, 5
    s_cbranch_scc1 K2_U21
    s_cmp_eq_u32 s56, 6
    s_cbranch_scc1 K2_U3h1
    s_branch K2_DSP1
K2_U41:
    s_setprio 1
    ds_read_b64_tr_b16 v[8:9], v249 offset:1024
    ds_read_b64_tr_b16 v[10:11], v249 offset:1056
    ds_read_u16_d16_hi v18, v250 offset:256
    s_lshr_b32 s65, s30, 28
    s_mul_i32 s66, s22, 2080
    s_lshl_b32 s65, s65, 9
    s_add_u32 s65, s65, s66
    s_add_u32 s65, s65, 65536
    s_sub_u32 s65, s65, s29
    s_sub_u32 s65, s65, 512
    v_add_u32 v56, s65, v249
    ds_read_b64_tr_b16 v[12:13], v56 offset:0
    ds_read_b64_tr_b16 v[14:15], v56 offset:32
    ds_read_u16_d16_hi v19, v250 offset:384
    s_waitcnt lgkmcnt(6)
    v_lshlrev_b32 v20, 16, v0
    v_and_b32 v21, 0xffff0000, v0
    v_lshlrev_b32 v22, 16, v1
    v_and_b32 v23, 0xffff0000, v1
    v_lshlrev_b32 v24, 16, v2
    v_and_b32 v25, 0xffff0000, v2
    v_lshlrev_b32 v26, 16, v3
    v_and_b32 v27, 0xffff0000, v3
    v_mul_f32_dpp v36, v16, v20 row_newbcast:8 row_mask:0xf bank_mask:0xf
    v_mul_f32_dpp v37, v16, v21 row_newbcast:9 row_mask:0xf bank_mask:0xf
    v_mul_f32_dpp v38, v16, v22 row_newbcast:10 row_mask:0xf bank_mask:0xf
    v_mul_f32_dpp v39, v16, v23 row_newbcast:11 row_mask:0xf bank_mask:0xf
    v_mul_f32_dpp v40, v16, v24 row_newbcast:12 row_mask:0xf bank_mask:0xf
    v_mul_f32_dpp v41, v16, v25 row_newbcast:13 row_mask:0xf bank_mask:0xf
    v_mul_f32_dpp v42, v16, v26 row_newbcast:14 row_mask:0xf bank_mask:0xf
    v_mul_f32_dpp v43, v16, v27 row_newbcast:15 row_mask:0xf bank_mask:0xf
    v_cvt_pk_bf16_f32 v68, v36, v37
    v_cvt_pk_bf16_f32 v69, v38, v39
    v_cvt_pk_bf16_f32 v70, v40, v41
    v_cvt_pk_bf16_f32 v71, v42, v43
    v_mul_f32_dpp v20, v16, v20 row_newbcast:0 row_mask:0xa bank_mask:0xf
    v_mul_f32_dpp v21, v16, v21 row_newbcast:1 row_mask:0xa bank_mask:0xf
    v_mul_f32_dpp v22, v16, v22 row_newbcast:2 row_mask:0xa bank_mask:0xf
    v_mul_f32_dpp v23, v16, v23 row_newbcast:3 row_mask:0xa bank_mask:0xf
    v_mul_f32_dpp v24, v16, v24 row_newbcast:4 row_mask:0xa bank_mask:0xf
    v_mul_f32_dpp v25, v16, v25 row_newbcast:5 row_mask:0xa bank_mask:0xf
    v_mul_f32_dpp v26, v16, v26 row_newbcast:6 row_mask:0xa bank_mask:0xf
    v_mul_f32_dpp v27, v16, v27 row_newbcast:7 row_mask:0xa bank_mask:0xf
    v_cvt_pk_bf16_f32 v64, v20, v21
    v_cvt_pk_bf16_f32 v65, v22, v23
    v_cvt_pk_bf16_f32 v66, v24, v25
    v_cvt_pk_bf16_f32 v67, v26, v27
    v_lshlrev_b32 v28, 16, v4
    v_and_b32 v29, 0xffff0000, v4
    v_lshlrev_b32 v30, 16, v5
    v_and_b32 v31, 0xffff0000, v5
    v_lshlrev_b32 v32, 16, v6
    v_and_b32 v33, 0xffff0000, v6
    v_lshlrev_b32 v34, 16, v7
    v_and_b32 v35, 0xffff0000, v7
    v_mul_f32_dpp v36, v17, v28 row_newbcast:8 row_mask:0xf bank_mask:0xf
    v_mul_f32_dpp v37, v17, v29 row_newbcast:9 row_mask:0xf bank_mask:0xf
    v_mul_f32_dpp v38, v17, v30 row_newbcast:10 row_mask:0xf bank_mask:0xf
    v_mul_f32_dpp v39, v17, v31 row_newbcast:11 row_mask:0xf bank_mask:0xf
    v_mul_f32_dpp v40, v17, v32 row_newbcast:12 row_mask:0xf bank_mask:0xf
    v_mul_f32_dpp v41, v17, v33 row_newbcast:13 row_mask:0xf bank_mask:0xf
    v_mul_f32_dpp v42, v17, v34 row_newbcast:14 row_mask:0xf bank_mask:0xf
    v_mul_f32_dpp v43, v17, v35 row_newbcast:15 row_mask:0xf bank_mask:0xf
    v_cvt_pk_bf16_f32 v76, v36, v37
    v_cvt_pk_bf16_f32 v77, v38, v39
    v_cvt_pk_bf16_f32 v78, v40, v41
    v_cvt_pk_bf16_f32 v79, v42, v43
    v_mul_f32_dpp v28, v17, v28 row_newbcast:0 row_mask:0xa bank_mask:0xf
    v_mul_f32_dpp v29, v17, v29 row_newbcast:1 row_mask:0xa bank_mask:0xf
    v_mul_f32_dpp v30, v17, v30 row_newbcast:2 row_mask:0xa bank_mask:0xf
    v_mul_f32_dpp v31, v17, v31 row_newbcast:3 row_mask:0xa bank_mask:0xf
    v_mul_f32_dpp v32, v17, v32 row_newbcast:4 row_mask:0xa bank_mask:0xf
    v_mul_f32_dpp v33, v17, v33 row_newbcast:5 row_mask:0xa bank_mask:0xf
    v_mul_f32_dpp v34, v17, v34 row_newbcast:6 row_mask:0xa bank_mask:0xf
    v_mul_f32_dpp v35, v17, v35 row_newbcast:7 row_mask:0xa bank_mask:0xf
    v_cvt_pk_bf16_f32 v72, v28, v29
    v_cvt_pk_bf16_f32 v73, v30, v31
    v_cvt_pk_bf16_f32 v74, v32, v33
    v_cvt_pk_bf16_f32 v75, v34, v35
    s_waitcnt lgkmcnt(3)
    v_lshlrev_b32 v20, 16, v8
    v_and_b32 v21, 0xffff0000, v8
    v_lshlrev_b32 v22, 16, v9
    v_and_b32 v23, 0xffff0000, v9
    v_lshlrev_b32 v24, 16, v10
    v_and_b32 v25, 0xffff0000, v10
    v_lshlrev_b32 v26, 16, v11
    v_and_b32 v27, 0xffff0000, v11
    v_mul_f32_dpp v36, v18, v20 row_newbcast:8 row_mask:0xf bank_mask:0xf
    v_mul_f32_dpp v37, v18, v21 row_newbcast:9 row_mask:0xf bank_mask:0xf
    v_mul_f32_dpp v38, v18, v22 row_newbcast:10 row_mask:0xf bank_mask:0xf
    v_mul_f32_dpp v39, v18, v23 row_newbcast:11 row_mask:0xf bank_mask:0xf
    v_mul_f32_dpp v40, v18, v24 row_newbcast:12 row_mask:0xf bank_mask:0xf
    v_mul_f32_dpp v41, v18, v25 row_newbcast:13 row_mask:0xf bank_mask:0xf
    v_mul_f32_dpp v42, v18, v26 row_newbcast:14 row_mask:0xf bank_mask:0xf
    v_mul_f32_dpp v43, v18, v27 row_newbcast:15 row_mask:0xf bank_mask:0xf
    v_cvt_pk_bf16_f32 v84, v36, v37
    v_cvt_pk_bf16_f32 v85, v38, v39
    v_cvt_pk_bf16_f32 v86, v40, v41
    v_cvt_pk_bf16_f32 v87, v42, v43
    v_mul_f32_dpp v20, v18, v20 row_newbcast:0 row_mask:0xa bank_mask:0xf
    v_mul_f32_dpp v21, v18, v21 row_newbcast:1 row_mask:0xa bank_mask:0xf
    v_mul_f32_dpp v22, v18, v22 row_newbcast:2 row_mask:0xa bank_mask:0xf
    v_mul_f32_dpp v23, v18, v23 row_newbcast:3 row_mask:0xa bank_mask:0xf
    v_mul_f32_dpp v24, v18, v24 row_newbcast:4 row_mask:0xa bank_mask:0xf
    v_mul_f32_dpp v25, v18, v25 row_newbcast:5 row_mask:0xa bank_mask:0xf
    v_mul_f32_dpp v26, v18, v26 row_newbcast:6 row_mask:0xa bank_mask:0xf
    v_mul_f32_dpp v27, v18, v27 row_newbcast:7 row_mask:0xa bank_mask:0xf
    v_cvt_pk_bf16_f32 v80, v20, v21
    v_cvt_pk_bf16_f32 v81, v22, v23
    v_cvt_pk_bf16_f32 v82, v24, v25
    v_cvt_pk_bf16_f32 v83, v26, v27
    s_waitcnt lgkmcnt(0)
    v_lshlrev_b32 v28, 16, v12
    v_and_b32 v29, 0xffff0000, v12
    v_lshlrev_b32 v30, 16, v13
    v_and_b32 v31, 0xffff0000, v13
    v_lshlrev_b32 v32, 16, v14
    v_and_b32 v33, 0xffff0000, v14
    v_lshlrev_b32 v34, 16, v15
    v_and_b32 v35, 0xffff0000, v15
    v_mul_f32_dpp v36, v19, v28 row_newbcast:8 row_mask:0xf bank_mask:0xf
    v_mul_f32_dpp v37, v19, v29 row_newbcast:9 row_mask:0xf bank_mask:0xf
    v_mul_f32_dpp v38, v19, v30 row_newbcast:10 row_mask:0xf bank_mask:0xf
    v_mul_f32_dpp v39, v19, v31 row_newbcast:11 row_mask:0xf bank_mask:0xf
    v_mul_f32_dpp v40, v19, v32 row_newbcast:12 row_mask:0xf bank_mask:0xf
    v_mul_f32_dpp v41, v19, v33 row_newbcast:13 row_mask:0xf bank_mask:0xf
    v_mul_f32_dpp v42, v19, v34 row_newbcast:14 row_mask:0xf bank_mask:0xf
    v_mul_f32_dpp v43, v19, v35 row_newbcast:15 row_mask:0xf bank_mask:0xf
    v_cvt_pk_bf16_f32 v92, v36, v37
    v_cvt_pk_bf16_f32 v93, v38, v39
    v_cvt_pk_bf16_f32 v94, v40, v41
    v_cvt_pk_bf16_f32 v95, v42, v43
    v_mul_f32_dpp v28, v19, v28 row_newbcast:0 row_mask:0xa bank_mask:0xf
    v_mul_f32_dpp v29, v19, v29 row_newbcast:1 row_mask:0xa bank_mask:0xf
    v_mul_f32_dpp v30, v19, v30 row_newbcast:2 row_mask:0xa bank_mask:0xf
    v_mul_f32_dpp v31, v19, v31 row_newbcast:3 row_mask:0xa bank_mask:0xf
    v_mul_f32_dpp v32, v19, v32 row_newbcast:4 row_mask:0xa bank_mask:0xf
    v_mul_f32_dpp v33, v19, v33 row_newbcast:5 row_mask:0xa bank_mask:0xf
    v_mul_f32_dpp v34, v19, v34 row_newbcast:6 row_mask:0xa bank_mask:0xf
    v_mul_f32_dpp v35, v19, v35 row_newbcast:7 row_mask:0xa bank_mask:0xf
    v_cvt_pk_bf16_f32 v88, v28, v29
    v_cvt_pk_bf16_f32 v89, v30, v31
    v_cvt_pk_bf16_f32 v90, v32, v33
    v_cvt_pk_bf16_f32 v91, v34, v35
    s_waitcnt vmcnt(4)
    v_mfma_f32_32x32x16_bf16 v[0:15], v[64:67], v[176:179], 0
    ds_read_b64_tr_b16 v[184:185], v246 offset:2048
    ds_read_b64_tr_b16 v[186:187], v246 offset:3072
    ds_read_b64_tr_b16 v[188:189], v247 offset:2048
    ds_read_b64_tr_b16 v[190:191], v247 offset:3072
    s_mov_b32 m0, s68
    v_mfma_f32_32x32x16_bf16 v[16:31], v[68:71], v[176:179], 0
    buffer_load_dwordx4 v222, s[4:7], s41 offen sc1 lds
    buffer_load_dwordx4 v223, s[72:75], s41 offen offset:1024 sc1 lds
    v_permlane32_swap_b32 v242, v236
    v_permlane32_swap_b32 v243, v237
    v_mov_b32 v254, 163296
    v_mfma_f32_32x32x16_bf16 v[32:47], v[64:67], v[180:183], 0
    v_permlane32_swap_b32 v244, v238
    v_permlane32_swap_b32 v245, v239
    v_permlane32_swap_b32 v240, v241
    v_add_f32 v242, v242, v236
    v_mfma_f32_32x32x16_bf16 v[48:63], v[68:71], v[180:183], 0
    v_add_f32 v243, v243, v237
    v_add_f32 v244, v244, v238
    v_add_f32 v245, v245, v239
    v_add_f32 v240, -v240, -v241
    v_sub_u32 v241, v230, v231
    v_cvt_pk_bf16_f32 v242, v242, v243
    v_mov_b32 v255, 1
    v_lshl_add_u32 v233, v252, 1, s53
    s_mov_b64 exec, 1
    ds_add_rtn_u32 v232, v254, v255
    s_mov_b64 exec, -1
    ds_read_b32 v233, v233
    s_waitcnt vmcnt(4) lgkmcnt(2)
    v_mfma_f32_32x32x16_bf16 v[0:15], v[72:75], v[184:187], v[0:15]
    ds_read_b64_tr_b16 v[176:177], v246 offset:4096
    ds_read_b64_tr_b16 v[178:179], v246 offset:5120
    ds_read_b64_tr_b16 v[180:181], v247 offset:4096
    ds_read_b64_tr_b16 v[182:183], v247 offset:5120
    v_cvt_pk_bf16_f32 v244, v244, v245
    v_cvt_pk_bf16_f32 v240, v240, v240
    s_mov_b32 m0, s69
    v_mfma_f32_32x32x16_bf16 v[16:31], v[76:79], v[184:187], v[16:31]
    buffer_load_dwordx4 v224, s[4:7], s41 offen sc1 lds
    buffer_load_dwordx4 v225, s[72:75], s41 offen offset:1024 sc1 lds
    ds_write_b32 v230, v242 offset:768
    ds_write_b32 v230, v244 offset:1024
    ds_write_b16 v241, v240 offset:1280
    s_waitcnt lgkmcnt(7)
    v_readfirstlane_b32 s58, v232
    v_mfma_f32_32x32x16_bf16 v[32:47], v[72:75], v[188:191], v[32:47]
    s_cmp_lt_u32 s58, s22
    s_cbranch_scc0 K2_nul_101
    s_nop 0
    v_readlane_b32 s58, v253, s58
    s_nop 0
    s_bfe_u32 s58, s58, 0x60016
    s_and_b32 s59, s58, 7
    s_lshr_b32 s60, s58, 3
K2_chk_103:
    v_readlane_b32 s61, v233, s59
    s_nop 0
    s_cmp_gt_u32 s61, s60
    s_cbranch_scc0 K2_spin_102
K2_back_104:
    v_mfma_f32_32x32x16_bf16 v[48:63], v[76:79], v[188:191], v[48:63]
    v_readlane_b32 s3, v253, s58
    s_lshl_b32 s44, s34, 7
    s_and_b32 s48, s3, 0x3ffff
    s_bfe_u32 s33, s3, 0x30013
    s_mov_b32 s35, s48
    s_mov_b32 s45, s44
    s_waitcnt vmcnt(4) lgkmcnt(3)
    v_mfma_f32_32x32x16_bf16 v[0:15], v[80:83], v[176:179], v[0:15]
    ds_read_b64_tr_b16 v[184:185], v246 offset:6144
    ds_read_b64_tr_b16 v[186:187], v246 offset:7168
    ds_read_b64_tr_b16 v[188:189], v247 offset:6144
    ds_read_b64_tr_b16 v[190:191], v247 offset:7168
    s_xor_b32 s47, s44, 256
    s_add_u32 s49, s48, 128
    s_mov_b32 m0, s70
    v_mfma_f32_32x32x16_bf16 v[16:31], v[84:87], v[176:179], v[16:31]
    buffer_load_dwordx4 v226, s[4:7], s41 offen sc1 lds
    buffer_load_dwordx4 v227, s[72:75], s41 offen offset:1024 sc1 lds
    s_add_u32 s60, s48, 256
    s_cmp_eq_u32 s33, 3
    s_cselect_b32 s46, s44, s47
    s_cselect_b32 s50, s60, s48
    s_cselect_b32 s51, s48, s49
    v_mfma_f32_32x32x16_bf16 v[32:47], v[80:83], v[180:183], v[32:47]
    s_sub_u32 s60, s33, 2
    s_cmp_lt_u32 s60, 2
    s_cbranch_scc0 K2_rare_105
K2_back_106:
    v_mfma_f32_32x32x16_bf16 v[48:63], v[84:87], v[180:183], v[48:63]
    s_waitcnt vmcnt(4) lgkmcnt(0)
    v_mfma_f32_32x32x16_bf16 v[0:15], v[88:91], v[184:187], v[0:15]
    ds_read_b64_tr_b16 v[176:177], v246 offset:0
    ds_read_b64_tr_b16 v[178:179], v246 offset:1024
    ds_read_b64_tr_b16 v[180:181], v247 offset:0
    ds_read_b64_tr_b16 v[182:183], v247 offset:1024
    s_mov_b32 m0, s71
    v_mfma_f32_32x32x16_bf16 v[16:31], v[92:95], v[184:187], v[16:31]
    buffer_load_dwordx4 v228, s[4:7], s41 offen sc1 lds
    buffer_load_dwordx4 v229, s[72:75], s41 offen offset:1024 sc1 lds
    v_mfma_f32_32x32x16_bf16 v[32:47], v[88:91], v[188:191], v[32:47]
    s_nop 2
    v_mul_f32 v234, v0, v96
    v_mul_f32 v236, v8, v128
    v_fmac_f32 v234, v1, v97
    v_fmac_f32 v236, v9, v129
    v_fmac_f32 v234, v2, v98
    v_fmac_f32 v236, v10, v130
    v_fmac_f32 v234, v3, v99
    v_mfma_f32_32x32x16_bf16 v[48:63], v[92:95], v[188:191], v[48:63]
    s_setprio 0
    v_fmac_f32 v236, v11, v131
    v_fmac_f32 v234, v4, v100
    v_fmac_f32 v236, v12, v132
    v_fmac_f32 v234, v5, v101
    v_fmac_f32 v236, v13, v133
    v_fmac_f32 v234, v6, v102
    v_fmac_f32 v236, v14, v134
    v_fmac_f32 v234, v7, v103
    v_fmac_f32 v236, v15, v135
    v_mul_f32 v238, v16, v128
    v_mul_f32 v240, v24, v128
    v_fmac_f32 v238, v17, v129
    v_fmac_f32 v240, v25, v129
    v_fmac_f32 v238, v18, v130
    v_fmac_f32 v240, v26, v130
    v_fmac_f32 v238, v19, v131
    v_fmac_f32 v240, v27, v131
    v_fmac_f32 v238, v20, v132
    v_fmac_f32 v240, v28, v132
    v_fmac_f32 v238, v21, v133
    v_fmac_f32 v240, v29, v133
    v_fmac_f32 v238, v22, v134
    v_fmac_f32 v240, v30, v134
    v_fmac_f32 v238, v23, v135
    v_fmac_f32 v240, v31, v135
    v_mul_f32 v235, v32, v104
    v_mul_f32 v237, v40, v136
    v_fmac_f32 v235, v33, v105
    v_fmac_f32 v237, v41, v137
    v_fmac_f32 v235, v34, v106
    v_fmac_f32 v237, v42, v138
    v_fmac_f32 v235, v35, v107
    v_fmac_f32 v237, v43, v139
    v_fmac_f32 v235, v36, v108
    v_fmac_f32 v237, v44, v140
    v_fmac_f32 v235, v37, v109
    v_fmac_f32 v237, v45, v141
    v_fmac_f32 v235, v38, v110
    v_fmac_f32 v237, v46, v142
    v_fmac_f32 v235, v39, v111
    v_fmac_f32 v237, v47, v143
    v_mul_f32 v239, v48, v136
    v_mul_f32 v241, v56, v136
    s_setprio 1
    s_waitcnt vmcnt(4) lgkmcnt(0)
    v_mfma_f32_32x32x16_bf16 v[0:15], v[64:67], v[176:179], 0
    ds_read_b64_tr_b16 v[184:185], v246 offset:2048
    ds_read_b64_tr_b16 v[186:187], v246 offset:3072
    ds_read_b64_tr_b16 v[188:189], v247 offset:2048
    ds_read_b64_tr_b16 v[190:191], v247 offset:3072
    v_fmac_f32 v239, v49, v137
    v_fmac_f32 v241, v57, v137
    s_mov_b32 m0, s68
    v_mfma_f32_32x32x16_bf16 v[16:31], v[68:71], v[176:179], 0
    buffer_load_dwordx4 v222, s[4:7], s42 offen sc1 lds
    buffer_load_dwordx4 v223, s[72:75], s42 offen offset:1024 sc1 lds
    v_fmac_f32 v239, v50, v138
    v_fmac_f32 v241, v58, v138
    v_fmac_f32 v239, v51, v139
    v_fmac_f32 v241, v59, v139
    v_fmac_f32 v239, v52, v140
    v_mfma_f32_32x32x16_bf16 v[32:47], v[64:67], v[180:183], 0
    v_fmac_f32 v241, v60, v140
    v_fmac_f32 v239, v53, v141
    v_fmac_f32 v241, v61, v141
    v_fmac_f32 v239, v54, v142
    v_fmac_f32 v241, v62, v142
    v_fmac_f32 v239, v55, v143
    v_fmac_f32 v241, v63, v143
    v_mfma_f32_32x32x16_bf16 v[48:63], v[68:71], v[180:183], 0
    v_permlane32_swap_b32 v234, v236
    v_permlane32_swap_b32 v235, v237
    v_permlane32_swap_b32 v240, v238
    s_waitcnt vmcnt(4) lgkmcnt(0)
    v_mfma_f32_32x32x16_bf16 v[0:15], v[72:75], v[184:187], v[0:15]
    ds_read_b64_tr_b16 v[176:177], v246 offset:4096
    ds_read_b64_tr_b16 v[178:179], v246 offset:5120
    ds_read_b64_tr_b16 v[180:181], v247 offset:4096
    ds_read_b64_tr_b16 v[182:183], v247 offset:5120
    v_permlane32_swap_b32 v241, v239
    s_mov_b32 m0, s69
    v_mfma_f32_32x32x16_bf16 v[16:31], v[76:79], v[184:187], v[16:31]
    buffer_load_dwordx4 v224, s[4:7], s42 offen sc1 lds
    buffer_load_dwordx4 v225, s[72:75], s42 offen offset:1024 sc1 lds
    v_lshl_add_u32 v230, v252, 1, s31
    v_add_f32 v234, v234, v236
    v_add_f32 v235, v235, v237
    v_add_f32 v240, v240, v238
    v_add_f32 v241, v241, v239
    v_mfma_f32_32x32x16_bf16 v[32:47], v[72:75], v[188:191], v[32:47]
    v_cvt_pk_bf16_f32 v234, v234, v235
    v_cvt_pk_bf16_f32 v240, v240, v241
    ds_write_b32 v230, v234 offset:0
    ds_write_b32 v230, v240 offset:256
    v_mfma_f32_32x32x16_bf16 v[48:63], v[76:79], v[188:191], v[48:63]
    s_waitcnt vmcnt(4) lgkmcnt(2)
    v_mfma_f32_32x32x16_bf16 v[0:15], v[80:83], v[176:179], v[0:15]
    ds_read_b64_tr_b16 v[184:185], v246 offset:6144
    ds_read_b64_tr_b16 v[186:187], v246 offset:7168
    ds_read_b64_tr_b16 v[188:189], v247 offset:6144
    ds_read_b64_tr_b16 v[190:191], v247 offset:7168
    s_mov_b32 m0, s70
    v_mfma_f32_32x32x16_bf16 v[16:31], v[84:87], v[176:179], v[16:31]
    buffer_load_dwordx4 v226, s[4:7], s42 offen sc1 lds
    buffer_load_dwordx4 v227, s[72:75], s42 offen offset:1024 sc1 lds
    v_mfma_f32_32x32x16_bf16 v[32:47], v[80:83], v[180:183], v[32:47]
    v_mfma_f32_32x32x16_bf16 v[48:63], v[84:87], v[180:183], v[48:63]
    s_waitcnt vmcnt(4) lgkmcnt(0)
    v_mfma_f32_32x32x16_bf16 v[0:15], v[88:91], v[184:187], v[0:15]
    ds_read_b64_tr_b16 v[176:177], v246 offset:0
    ds_read_b64_tr_b16 v[178:179], v246 offset:1024
    ds_read_b64_tr_b16 v[180:181], v247 offset:0
    ds_read_b64_tr_b16 v[182:183], v247 offset:1024
    s_mov_b32 m0, s71
    v_mfma_f32_32x32x16_bf16 v[16:31], v[92:95], v[184:187], v[16:31]
    buffer_load_dwordx4 v228, s[4:7], s42 offen sc1 lds
    buffer_load_dwordx4 v229, s[72:75], s42 offen offset:1024 sc1 lds
    v_mfma_f32_32x32x16_bf16 v[32:47], v[88:91], v[188:191], v[32:47]
    s_nop 2
    v_mul_f32 v234, v0, v144
    v_mul_f32 v236, v8, v112
    v_fmac_f32 v234, v1, v145
    v_fmac_f32 v236, v9, v113
    v_fmac_f32 v234, v2, v146
    v_fmac_f32 v236, v10, v114
    v_fmac_f32 v234, v3, v147
    v_mfma_f32_32x32x16_bf16 v[48:63], v[92:95], v[188:191], v[48:63]
    s_setprio 0
    v_fmac_f32 v236, v11, v115
    v_fmac_f32 v234, v4, v148
    v_fmac_f32 v236, v12, v116
    v_fmac_f32 v234, v5, v149
    v_fmac_f32 v236, v13, v117
    v_fmac_f32 v234, v6, v150
    v_fmac_f32 v236, v14, v118
    v_fmac_f32 v234, v7, v151
    v_fmac_f32 v236, v15, v119
    v_mul_f32 v238, v16, v160
    v_mul_f32 v240, v24, v160
    v_fmac_f32 v238, v17, v161
    v_fmac_f32 v240, v25, v161
    v_fmac_f32 v238, v18, v162
    v_fmac_f32 v240, v26, v162
    v_fmac_f32 v238, v19, v163
    v_fmac_f32 v240, v27, v163
    v_fmac_f32 v238, v20, v164
    v_fmac_f32 v240, v28, v164
    v_fmac_f32 v238, v21, v165
    v_fmac_f32 v240, v29, v165
    v_fmac_f32 v238, v22, v166
    v_fmac_f32 v240, v30, v166
    v_fmac_f32 v238, v23, v167
    v_fmac_f32 v240, v31, v167
    v_mul_f32 v235, v32, v152
    v_mul_f32 v237, v40, v120
    v_fmac_f32 v235, v33, v153
    v_fmac_f32 v237, v41, v121
    v_fmac_f32 v235, v34, v154
    v_fmac_f32 v237, v42, v122
    v_fmac_f32 v235, v35, v155
    v_fmac_f32 v237, v43, v123
    v_fmac_f32 v235, v36, v156
    v_fmac_f32 v237, v44, v124
    v_fmac_f32 v235, v37, v157
    v_fmac_f32 v237, v45, v125
    v_fmac_f32 v235, v38, v158
    v_fmac_f32 v237, v46, v126
    v_fmac_f32 v235, v39, v159
    v_fmac_f32 v237, v47, v127
    v_mul_f32 v239, v48, v168
    v_mul_f32 v241, v56, v168
    s_setprio 1
    s_waitcnt vmcnt(4) lgkmcnt(0)
    v_mfma_f32_32x32x16_bf16 v[0:15], v[64:67], v[176:179], 0
    ds_read_b64_tr_b16 v[184:185], v246 offset:2048
    ds_read_b64_tr_b16 v[186:187], v246 offset:3072
    ds_read_b64_tr_b16 v[188:189], v247 offset:2048
    ds_read_b64_tr_b16 v[190:191], v247 offset:3072
    v_fmac_f32 v239, v49, v169
    v_fmac_f32 v241, v57, v169
    s_mov_b32 m0, s68
    v_mfma_f32_32x32x16_bf16 v[16:31], v[68:71], v[176:179], 0
    buffer_load_dwordx4 v222, s[4:7], s43 offen sc1 lds
    buffer_load_dwordx4 v223, s[72:75], s43 offen offset:1024 sc1 lds
    v_fmac_f32 v239, v50, v170
    v_fmac_f32 v241, v58, v170
    v_fmac_f32 v239, v51, v171
    v_fmac_f32 v241, v59, v171
    v_fmac_f32 v239, v52, v172
    v_mfma_f32_32x32x16_bf16 v[32:47], v[64:67], v[180:183], 0
    v_fmac_f32 v241, v60, v172
    v_fmac_f32 v239, v53, v173
    v_fmac_f32 v241, v61, v173
    v_fmac_f32 v239, v54, v174
    v_fmac_f32 v241, v62, v174
    v_fmac_f32 v239, v55, v175
    v_fmac_f32 v241, v63, v175
    v_mfma_f32_32x32x16_bf16 v[48:63], v[68:71], v[180:183], 0
    s_waitcnt vmcnt(4) lgkmcnt(0)
    v_mfma_f32_32x32x16_bf16 v[0:15], v[72:75], v[184:187], v[0:15]
    ds_read_b64_tr_b16 v[176:177], v246 offset:4096
    ds_read_b64_tr_b16 v[178:179], v246 offset:5120
    ds_read_b64_tr_b16 v[180:181], v247 offset:4096
    ds_read_b64_tr_b16 v[182:183], v247 offset:5120
    s_mov_b32 m0, s69
    v_mfma_f32_32x32x16_bf16 v[16:31], v[76:79], v[184:187], v[16:31]
    buffer_load_dwordx4 v224, s[4:7], s43 offen sc1 lds
    buffer_load_dwordx4 v225, s[72:75], s43 offen offset:1024 sc1 lds
    v_mfma_f32_32x32x16_bf16 v[32:47], v[72:75], v[188:191], v[32:47]
    v_mfma_f32_32x32x16_bf16 v[48:63], v[76:79], v[188:191], v[48:63]
    s_waitcnt vmcnt(4) lgkmcnt(0)
    v_mfma_f32_32x32x16_bf16 v[0:15], v[80:83], v[176:179], v[0:15]
    ds_read_b64_tr_b16 v[184:185], v246 offset:6144
    ds_read_b64_tr_b16 v[186:187], v246 offset:7168
    ds_read_b64_tr_b16 v[188:189], v247 offset:6144
    ds_read_b64_tr_b16 v[190:191], v247 offset:7168
    s_mov_b32 m0, s70
    v_mfma_f32_32x32x16_bf16 v[16:31], v[84:87], v[176:179], v[16:31]
    buffer_load_dwordx4 v226, s[4:7], s43 offen sc1 lds
    buffer_load_dwordx4 v227, s[72:75], s43 offen offset:1024 sc1 lds
    v_mfma_f32_32x32x16_bf16 v[32:47], v[80:83], v[180:183], v[32:47]
    v_add_u32 v222, s48, v251
    ds_read2_b32 v[222:223], v222 offset0:1 offset1:3
    v_mfma_f32_32x32x16_bf16 v[48:63], v[84:87], v[180:183], v[48:63]
    s_waitcnt vmcnt(4) lgkmcnt(1)
    v_mfma_f32_32x32x16_bf16 v[0:15], v[88:91], v[184:187], v[0:15]
    ds_read_b64_tr_b16 v[176:177], v246 offset:0
    ds_read_b64_tr_b16 v[178:179], v246 offset:1024
    ds_read_b64_tr_b16 v[180:181], v247 offset:0
    ds_read_b64_tr_b16 v[182:183], v247 offset:1024
    s_mov_b32 m0, s71
    v_mfma_f32_32x32x16_bf16 v[16:31], v[92:95], v[184:187], v[16:31]
    buffer_load_dwordx4 v228, s[4:7], s43 offen sc1 lds
    buffer_load_dwordx4 v229, s[72:75], s43 offen offset:1024 sc1 lds
    s_waitcnt lgkmcnt(4)
    v_mad_u32_u16 v222, v222, s39, v248 op_sel:[1,0,0,0]
    v_mad_u32_u16 v223, v223, s39, v248 op_sel:[1,0,0,0]
    v_mfma_f32_32x32x16_bf16 v[32:47], v[88:91], v[188:191], v[32:47]
    v_add_u32 v224, s49, v251
    ds_read2_b32 v[224:225], v224 offset0:1 offset1:3
    v_mul_f32 v242, v0, v144
    v_fma_f32 v238, v8, v160, -v238
    v_fmac_f32 v242, v1, v145
    v_fmac_f32 v238, v9, v161
    v_fmac_f32 v242, v2, v146
    v_mfma_f32_32x32x16_bf16 v[48:63], v[92:95], v[188:191], v[48:63]
    s_setprio 0
    v_fmac_f32 v238, v10, v162
    v_fmac_f32 v242, v3, v147
    v_fmac_f32 v238, v11, v163
    v_fmac_f32 v242, v4, v148
    v_fmac_f32 v238, v12, v164
    v_fmac_f32 v242, v5, v149
    v_fmac_f32 v238, v13, v165
    v_fmac_f32 v242, v6, v150
    v_fmac_f32 v238, v14, v166
    v_fmac_f32 v242, v7, v151
    v_fmac_f32 v238, v15, v167
    v_fmac_f32 v236, v16, v112
    v_mul_f32 v244, v24, v160
    v_fmac_f32 v236, v17, v113
    v_fmac_f32 v244, v25, v161
    v_fmac_f32 v236, v18, v114
    v_fmac_f32 v244, v26, v162
    v_fmac_f32 v236, v19, v115
    v_fmac_f32 v244, v27, v163
    v_fmac_f32 v236, v20, v116
    v_fmac_f32 v244, v28, v164
    v_fmac_f32 v236, v21, v117
    v_fmac_f32 v244, v29, v165
    v_fmac_f32 v236, v22, v118
    v_fmac_f32 v244, v30, v166
    v_fmac_f32 v236, v23, v119
    v_fmac_f32 v244, v31, v167
    v_mul_f32 v243, v32, v152
    v_fma_f32 v239, v40, v168, -v239
    v_fmac_f32 v243, v33, v153
    v_fmac_f32 v239, v41, v169
    v_fmac_f32 v243, v34, v154
    v_fmac_f32 v239, v42, v170
    v_fmac_f32 v243, v35, v155
    v_fmac_f32 v239, v43, v171
    v_fmac_f32 v243, v36, v156
    v_fmac_f32 v239, v44, v172
    v_fmac_f32 v243, v37, v157
    v_fmac_f32 v239, v45, v173
    v_fmac_f32 v243, v38, v158
    v_fmac_f32 v239, v46, v174
    v_fmac_f32 v243, v39, v159
    v_fmac_f32 v239, v47, v175
    v_fmac_f32 v237, v48, v120
    v_mul_f32 v245, v56, v168
    v_fmac_f32 v237, v49, v121
    v_fmac_f32 v245, v57, v169
    v_fmac_f32 v237, v50, v122
    v_fmac_f32 v245, v58, v170
    v_fmac_f32 v237, v51, v123
    s_setprio 1
    s_waitcnt vmcnt(4) lgkmcnt(1)
    v_mfma_f32_32x32x16_bf16 v[0:15], v[64:67], v[176:179], 0
    ds_read_b64_tr_b16 v[184:185], v246 offset:2048
    ds_read_b64_tr_b16 v[186:187], v246 offset:3072
    ds_read_b64_tr_b16 v[188:189], v247 offset:2048
    ds_read_b64_tr_b16 v[190:191], v247 offset:3072
    v_fmac_f32 v245, v59, v171
    v_fmac_f32 v237, v52, v124
    s_mov_b32 m0, s68
    v_mfma_f32_32x32x16_bf16 v[16:31], v[68:71], v[176:179], 0
    buffer_load_dwordx4 v222, s[4:7], s44 offen sc1 lds
    buffer_load_dwordx4 v223, s[72:75], s44 offen offset:1024 sc1 lds
    s_waitcnt lgkmcnt(4)
    v_mad_u32_u16 v224, v224, s39, v248 op_sel:[1,0,0,0]
    v_mad_u32_u16 v225, v225, s39, v248 op_sel:[1,0,0,0]
    v_fmac_f32 v245, v60, v172
    v_fmac_f32 v237, v53, v125
    v_mfma_f32_32x32x16_bf16 v[32:47], v[64:67], v[180:183], 0
    v_add_u32 v226, s50, v251
    ds_read2_b32 v[226:227], v226 offset0:1 offset1:3
    v_fmac_f32 v245, v61, v173
    v_fmac_f32 v237, v54, v126
    v_fmac_f32 v245, v62, v174
    v_fmac_f32 v237, v55, v127
    v_fmac_f32 v245, v63, v175
    v_mfma_f32_32x32x16_bf16 v[48:63], v[68:71], v[180:183], 0
    v_permlane32_swap_b32 v242, v234
    v_permlane32_swap_b32 v243, v235
    v_add_f32 v242, v242, v234
    v_add_f32 v243, v243, v235
    s_waitcnt vmcnt(4) lgkmcnt(1)
    v_mfma_f32_32x32x16_bf16 v[0:15], v[72:75], v[184:187], v[0:15]
    ds_read_b64_tr_b16 v[176:177], v246 offset:4096
    ds_read_b64_tr_b16 v[178:179], v246 offset:5120
    ds_read_b64_tr_b16 v[180:181], v247 offset:4096
    ds_read_b64_tr_b16 v[182:183], v247 offset:5120
    v_cvt_pk_bf16_f32 v242, v242, v243
    ds_write_b32 v230, v242 offset:512
    s_mov_b32 m0, s69
    v_mfma_f32_32x32x16_bf16 v[16:31], v[76:79], v[184:187], v[16:31]
    buffer_load_dwordx4 v224, s[4:7], s45 offen sc1 lds
    buffer_load_dwordx4 v225, s[72:75], s45 offen offset:1024 sc1 lds
    s_waitcnt lgkmcnt(5)
    v_mad_u32_u16 v226, v226, s39, v248 op_sel:[1,0,0,0]
    v_mad_u32_u16 v227, v227, s39, v248 op_sel:[1,0,0,0]
    v_mfma_f32_32x32x16_bf16 v[32:47], v[72:75], v[188:191], v[32:47]
    v_add_u32 v228, s51, v251
    ds_read2_b32 v[228:229], v228 offset0:1 offset1:3
    v_mfma_f32_32x32x16_bf16 v[48:63], v[76:79], v[188:191], v[48:63]
    s_waitcnt vmcnt(4) lgkmcnt(2)
    v_mfma_f32_32x32x16_bf16 v[0:15], v[80:83], v[176:179], v[0:15]
    ds_read_b64_tr_b16 v[184:185], v246 offset:6144
    ds_read_b64_tr_b16 v[186:187], v246 offset:7168
    ds_read_b64_tr_b16 v[188:189], v247 offset:6144
    ds_read_b64_tr_b16 v[190:191], v247 offset:7168
    s_mov_b32 s32, s31
    s_mov_b32 s31, s35
    s_mov_b32 m0, s70
    v_mfma_f32_32x32x16_bf16 v[16:31], v[84:87], v[176:179], v[16:31]
    buffer_load_dwordx4 v226, s[4:7], s46 offen sc1 lds
    buffer_load_dwordx4 v227, s[72:75], s46 offen offset:1024 sc1 lds
    s_waitcnt lgkmcnt(4)
    v_mad_u32_u16 v228, v228, s39, v248 op_sel:[1,0,0,0]
    v_mad_u32_u16 v229, v229, s39, v248 op_sel:[1,0,0,0]
    s_sub_u32 s26, s48, s29
    s_mov_b32 s29, s48
    v_mfma_f32_32x32x16_bf16 v[32:47], v[80:83], v[180:183], v[32:47]
    s_mov_b32 s30, s3
    s_bfe_u32 s56, s3, 0x40012
    s_cmp_lg_u32 s36, 0
    s_cselect_b32 s56, s56, 0
    v_mfma_f32_32x32x16_bf16 v[48:63], v[84:87], v[180:183], v[48:63]
    s_waitcnt vmcnt(4) lgkmcnt(0)
    v_mfma_f32_32x32x16_bf16 v[0:15], v[88:91], v[184:187], v[0:15]
    ds_read_b64_tr_b16 v[176:177], v246 offset:0
    ds_read_b64_tr_b16 v[178:179], v246 offset:1024
    ds_read_b64_tr_b16 v[180:181], v247 offset:0
    ds_read_b64_tr_b16 v[182:183], v247 offset:1024
    s_mov_b32 m0, s71
    v_mfma_f32_32x32x16_bf16 v[16:31], v[92:95], v[184:187], v[16:31]
    buffer_load_dwordx4 v228, s[4:7], s47 offen sc1 lds
    buffer_load_dwordx4 v229, s[72:75], s47 offen offset:1024 sc1 lds
    v_mfma_f32_32x32x16_bf16 v[32:47], v[88:91], v[188:191], v[32:47]
    s_nop 2
    v_mul_f32 v242, v0, v144
    v_fma_f32 v240, v8, v160, -v240
    v_fmac_f32 v242, v1, v145
    v_fmac_f32 v240, v9, v161
    v_fmac_f32 v242, v2, v146
    v_fmac_f32 v240, v10, v162
    v_fmac_f32 v242, v3, v147
    v_mfma_f32_32x32x16_bf16 v[48:63], v[92:95], v[188:191], v[48:63]
    s_setprio 0
    v_fmac_f32 v240, v11, v163
    v_fmac_f32 v242, v4, v148
    v_fmac_f32 v240, v12, v164
    v_fmac_f32 v242, v5, v149
    v_fmac_f32 v240, v13, v165
    v_fmac_f32 v242, v6, v150
    v_fmac_f32 v240, v14, v166
    v_fmac_f32 v242, v7, v151
    v_fmac_f32 v240, v15, v167
    v_add_u32 v249, s26, v249
    v_add_u32 v250, s26, v250
    v_fma_f32 v244, v16, v160, -v244
    v_fmac_f32 v236, v24, v112
    v_fmac_f32 v244, v17, v161
    v_fmac_f32 v236, v25, v113
    v_fmac_f32 v244, v18, v162
    v_fmac_f32 v236, v26, v114
    v_fmac_f32 v244, v19, v163
    v_fmac_f32 v236, v27, v115
    v_fmac_f32 v244, v20, v164
    v_fmac_f32 v236, v28, v116
    v_fmac_f32 v244, v21, v165
    v_fmac_f32 v236, v29, v117
    v_fmac_f32 v244, v22, v166
    v_fmac_f32 v236, v30, v118
    v_fmac_f32 v244, v23, v167
    v_fmac_f32 v236, v31, v119
    ds_read_b64_tr_b16 v[0:1], v249 offset:0
    ds_read_b64_tr_b16 v[2:3], v249 offset:32
    ds_read_u16_d16_hi v16, v250 offset:0
    v_mul_f32 v243, v32, v152
    v_fma_f32 v241, v40, v168, -v241
    v_fmac_f32 v243, v33, v153
    v_fmac_f32 v241, v41, v169
    v_fmac_f32 v243, v34, v154
    v_fmac_f32 v241, v42, v170
    v_fmac_f32 v243, v35, v155
    v_fmac_f32 v241, v43, v171
    v_fmac_f32 v243, v36, v156
    v_fmac_f32 v241, v44, v172
    v_fmac_f32 v243, v37, v157
    v_fmac_f32 v241, v45, v173
    v_fmac_f32 v243, v38, v158
    v_fmac_f32 v241, v46, v174
    v_fmac_f32 v243, v39, v159
    v_fmac_f32 v241, v47, v175
    ds_read_b64_tr_b16 v[4:5], v249 offset:512
    ds_read_b64_tr_b16 v[6:7], v249 offset:544
    ds_read_u16_d16_hi v17, v250 offset:128
    v_fma_f32 v245, v48, v168, -v245
    v_fmac_f32 v237, v56, v120
    v_fmac_f32 v245, v49, v169
    v_fmac_f32 v237, v57, v121
    v_fmac_f32 v245, v50, v170
    v_fmac_f32 v237, v58, v122
    v_fmac_f32 v245, v51, v171
    v_fmac_f32 v237, v59, v123
    v_fmac_f32 v245, v52, v172
    v_fmac_f32 v237, v60, v124
    v_fmac_f32 v245, v53, v173
    v_fmac_f32 v237, v61, v125
    v_fmac_f32 v245, v54, v174
    v_fmac_f32 v237, v62, v126
    v_fmac_f32 v245, v55, v175
    v_fmac_f32 v237, v63, v127
    s_cmp_eq_u32 s56, 5
    s_cbranch_scc1 K2_U21
    s_cmp_eq_u32 s56, 6
    s_cbranch_scc1 K2_U3h1
    s_branch K2_DSP1
K2_FLGR:
    s_sub_u32 s27, s27, 16
    s_cbranch_scc1 K2_END
    buffer_load_dwordx4 v[56:59], v60, s[8:11], s64 offen sc1
    s_branch K2_FLGW
K2_FLGY:
    v_mov_b32 v56, s2
    v_mov_b32 v57, 7178240
    s_mov_b64 exec, 1
    buffer_store_dword v56, v57, s[8:11], 0 offen sc1
    s_mov_b64 exec, -1
    s_branch K2_FLGOK
K2_nul_70:
    s_mov_b32 s58, 63
    s_mov_b32 s36, 0
    s_branch K2_back_73
K2_spin_71:
    s_sub_u32 s27, s27, 1
    s_cbranch_scc1 K2_END
    v_lshl_add_u32 v233, v252, 1, s53
    ds_read_b32 v233, v233
    s_waitcnt lgkmcnt(0)
    s_branch K2_chk_72
K2_dyn_68:
    v_mov_b32 v254, 163296
    v_mov_b32 v255, 1
    v_lshl_add_u32 v233, v252, 1, s53
    s_mov_b64 exec, 1
    ds_add_rtn_u32 v232, v254, v255
    s_mov_b64 exec, -1
    ds_read_b32 v233, v233
    s_waitcnt lgkmcnt(0)
    v_readfirstlane_b32 s58, v232
    s_nop 0
    s_cmp_lt_u32 s58, s22
    s_cbranch_scc0 K2_nul_70
    s_nop 0
    v_readlane_b32 s58, v253, s58
    s_nop 0
    s_bfe_u32 s58, s58, 0x60016
    s_and_b32 s59, s58, 7
    s_lshr_b32 s60, s58, 3
K2_chk_72:
    v_readlane_b32 s61, v233, s59
    s_nop 0
    s_cmp_gt_u32 s61, s60
    s_cbranch_scc0 K2_spin_71
K2_back_73:
    s_mov_b32 s34, 1
    s_branch K2_back_69
K2_rare_74:
    s_cmp_eq_u32 s33, 4
    s_cbranch_scc1 K2_four_76
    s_mov_b32 s49, s48
    s_mov_b32 s51, s48
    s_xor_b32 s45, s44, 256
    s_xor_b32 s46, s44, 512
    s_xor_b32 s47, s44, 768
    s_branch K2_back_75
K2_four_76:
    s_add_u32 s50, s48, 256
    s_add_u32 s51, s48, 384
    s_mov_b32 s46, s44
    s_mov_b32 s47, s44
    s_branch K2_back_75
K2_dum_77:
    v_mov_b32 v232, -1
    s_mov_b32 m0, 163312
    s_mov_b64 exec, 1
    buffer_load_dwordx4 v232, s[16:19], 0 offen lds
    buffer_load_dwordx4 v232, s[16:19], 0 offen lds
    s_mov_b64 exec, -1
    s_branch K2_back_79
K2_a4_78:
    v_add_u32 v254, s48, v230
    ds_read_b32 v254, v254 offset:4
    s_lshr_b32 s65, s3, 28
    s_mul_i32 s66, s22, 2080
    s_lshl_b32 s65, s65, 9
    s_add_u32 s65, s65, s66
    s_add_u32 s65, s65, 65536
    s_mov_b32 m0, s65
    s_mov_b32 exec_hi, 0
    s_waitcnt lgkmcnt(0)
    v_or_b32 v254, v254, v231
    buffer_load_dwordx4 v254, s[16:19], 0 offen  lds
    s_mov_b32 exec_hi, -1
    s_branch K2_b4_80
K2_nul_83:
    s_mov_b32 s58, 63
    s_mov_b32 s36, 0
    s_branch K2_back_86
K2_spin_84:
    s_sub_u32 s27, s27, 1
    s_cbranch_scc1 K2_END
    v_lshl_add_u32 v233, v252, 1, s53
    ds_read_b32 v233, v233
    s_waitcnt lgkmcnt(0)
    s_branch K2_chk_85
K2_dyn_81:
    v_mov_b32 v254, 163296
    v_mov_b32 v255, 1
    v_lshl_add_u32 v233, v252, 1, s53
    s_mov_b64 exec, 1
    ds_add_rtn_u32 v232, v254, v255
    s_mov_b64 exec, -1
    ds_read_b32 v233, v233
    s_waitcnt lgkmcnt(0)
    v_readfirstlane_b32 s58, v232
    s_nop 0
    s_cmp_lt_u32 s58, s22
    s_cbranch_scc0 K2_nul_83
    s_nop 0
    v_readlane_b32 s58, v253, s58
    s_nop 0
    s_bfe_u32 s58, s58, 0x60016
    s_and_b32 s59, s58, 7
    s_lshr_b32 s60, s58, 3
K2_chk_85:
    v_readlane_b32 s61, v233, s59
    s_nop 0
    s_cmp_gt_u32 s61, s60
    s_cbranch_scc0 K2_spin_84
K2_back_86:
    s_mov_b32 s34, 1
    s_branch K2_back_82
K2_rare_87:
    s_cmp_eq_u32 s33, 4
    s_cbranch_scc1 K2_four_89
    s_mov_b32 s49, s48
    s_mov_b32 s51, s48
    s_xor_b32 s45, s44, 256
    s_xor_b32 s46, s44, 512
    s_xor_b32 s47, s44, 768
    s_branch K2_back_88
K2_four_89:
    s_add_u32 s50, s48, 256
    s_add_u32 s51, s48, 384
    s_mov_b32 s46, s44
    s_mov_b32 s47, s44
    s_branch K2_back_88
K2_dum_90:
    v_mov_b32 v232, -1
    s_mov_b32 m0, 163312
    s_mov_b64 exec, 1
    buffer_load_dwordx4 v232, s[16:19], 0 offen lds
    buffer_load_dwordx4 v232, s[16:19], 0 offen lds
    s_mov_b64 exec, -1
    s_branch K2_back_92
K2_a4_91:
    v_add_u32 v254, s48, v230
    ds_read_b32 v254, v254 offset:4
    s_lshr_b32 s65, s3, 28
    s_mul_i32 s66, s22, 2080
    s_lshl_b32 s65, s65, 9
    s_add_u32 s65, s65, s66
    s_add_u32 s65, s65, 65536
    s_mov_b32 m0, s65
    s_mov_b32 exec_hi, 0
    s_waitcnt lgkmcnt(0)
    v_or_b32 v254, v254, v231
    buffer_load_dwordx4 v254, s[16:19], 0 offen  lds
    s_mov_b32 exec_hi, -1
    s_branch K2_b4_93
K2_nul_94:
    s_mov_b32 s58, 63
    s_mov_b32 s36, 0
    s_branch K2_back_97
K2_spin_95:
    s_sub_u32 s27, s27, 1
    s_cbranch_scc1 K2_END
    v_lshl_add_u32 v233, v252, 1, s53
    ds_read_b32 v233, v233
    s_waitcnt lgkmcnt(0)
    s_branch K2_chk_96
K2_rare_98:
    s_cmp_eq_u32 s33, 4
    s_cbranch_scc1 K2_four_100
    s_mov_b32 s49, s48
    s_mov_b32 s51, s48
    s_xor_b32 s45, s44, 256
    s_xor_b32 s46, s44, 512
    s_xor_b32 s47, s44, 768
    s_branch K2_back_99
K2_four_100:
    s_add_u32 s50, s48, 256
    s_add_u32 s51, s48, 384
    s_mov_b32 s46, s44
    s_mov_b32 s47, s44
    s_branch K2_back_99
K2_nul_101:
    s_mov_b32 s58, 63
    s_mov_b32 s36, 0
    s_branch K2_back_104
K2_spin_102:
    s_sub_u32 s27, s27, 1
    s_cbranch_scc1 K2_END
    v_lshl_add_u32 v233, v252, 1, s53
    ds_read_b32 v233, v233
    s_waitcnt lgkmcnt(0)
    s_branch K2_chk_103
K2_rare_105:
    s_cmp_eq_u32 s33, 4
    s_cbranch_scc1 K2_four_107
    s_mov_b32 s49, s48
    s_mov_b32 s51, s48
    s_xor_b32 s45, s44, 256
    s_xor_b32 s46, s44, 512
    s_xor_b32 s47, s44, 768
    s_branch K2_back_106
K2_four_107:
    s_add_u32 s50, s48, 256
    s_add_u32 s51, s48, 384
    s_mov_b32 s46, s44
    s_mov_b32 s47, s44
    s_branch K2_back_106
K2_END:
    s_endpgm
.section .rodata,"a"
.p2align 6
.amdhsa_kernel standalone__tensor_product_equiv_equiformer__graph_kernel
  .amdhsa_next_free_vgpr 256
  .amdhsa_next_free_sgpr 102
  .amdhsa_accum_offset 256
  .amdhsa_group_segment_fixed_size 0
  .amdhsa_kernarg_size 96
  .amdhsa_user_sgpr_count 2
  .amdhsa_user_sgpr_kernarg_segment_ptr 1
  .amdhsa_system_sgpr_workgroup_id_x 1
  .amdhsa_float_denorm_mode_32 3
.end_amdhsa_kernel
```

```asm
; @launch grid=(256,1,1) block=(512,1,1) lds=163840
.amdgcn_target "amdgcn-amd-amdhsa--gfx950"
.text
.globl standalone__tensor_product_equiv_equiformer__graph_kernel
.p2align 8
.type standalone__tensor_product_equiv_equiformer__graph_kernel,@function
standalone__tensor_product_equiv_equiformer__graph_kernel:
    s_cmp_ge_u32 s2, 256
    s_cbranch_scc1 K2_END
    s_load_dwordx16 s[80:95], s[0:1], 0
    s_load_dwordx4 s[96:99], s[0:1], 72
    s_load_dwordx2 s[100:101], s[0:1], 88
    v_lshrrev_b32 v1, 6, v0
    s_mov_b32 s54, s2
    v_readfirstlane_b32 s20, v1
    s_mov_b64 exec, 0
    s_cmp_eq_u32 s20, 0
    s_cbranch_scc1 K2_PAD_S1
    s_cmp_eq_u32 s20, 1
    s_cbranch_scc1 K2_PAD_S2
    s_cmp_eq_u32 s20, 5
    s_cbranch_scc1 K2_PAD_H1
    s_cmp_eq_u32 s20, 6
    s_cbranch_scc1 K2_PAD_H2
    s_cmp_eq_u32 s20, 2
    s_cbranch_scc1 K2_PAD_H3
KS_HOP0:
    s_mov_b64 exec, -1
    v_and_b32 v8, 63, v0
    v_lshlrev_b32 v9, 4, v8
    v_mov_b32 v6, 0
    v_lshlrev_b32 v5, 4, v0
    v_mul_u32_u24 v4, 24, v0
    s_mul_i32 s64, s2, 5120
    s_mul_i32 s65, s2, 7680
    v_mov_b32 v176, v8
    v_mov_b32 v177, v0
    s_movk_i32 s39, 1024
    s_lshl_b32 s37, s20, 13
    s_mov_b32 s53, 163264
    s_lshl_b32 s52, s20, 2
    s_add_u32 s52, s52, s53
    s_add_u32 s68, s37, 0
    s_add_u32 s69, s37, 2048
    s_add_u32 s70, s37, 4096
    s_add_u32 s71, s37, 6144
    s_waitcnt lgkmcnt(0)
    s_mov_b32 s8, s100
    s_and_b32 s9, s101, 0xffff
    s_mov_b32 s10, 37748736
    s_mov_b32 s11, 0x20000
    s_cmp_lg_u32 s20, 7
    s_cbranch_scc1 KS_NOTAG
    s_mov_b32 s24, 7178240
    s_mov_b64 exec, 1
    buffer_load_dword v14, v6, s[8:11], s24 offen sc1
    s_mov_b64 exec, -1
    s_mov_b32 s60, s98
    s_and_b32 s61, s99, 0xffff
    s_mov_b32 s62, 256
    s_mov_b32 s63, 0x20000
    s_barrier
    v_mov_b32 v76, 0
    v_mov_b32 v77, -1
    v_lshlrev_b32 v78, 2, v8
    v_add_u32 v78, 163072, v78
    s_mov_b64 exec, 0x1ff
    ds_write_b32 v78, v76 offset:192
    s_mov_b32 exec_lo, 1
    ds_write_b32 v78, v76 offset:232
    s_mov_b32 exec_lo, -1
    ds_write_b32 v78, v77 offset:256
    s_mov_b64 exec, -1
    s_mov_b32 exec_hi, 0xffff
    ds_write_b32 v78, v76
    s_mov_b64 exec, 1
    ds_write_b32 v78, v76 offset:228
    s_mov_b64 exec, -1
    s_mov_b64 exec, 1
    buffer_load_dword v15, v6, s[60:63], 0 offen sc1
    v_mov_b32 v12, 163456
    s_mov_b32 s24, 1664525
    s_waitcnt vmcnt(1)
    v_mul_lo_u32 v59, v14, s24
    v_add_u32 v59, 1013904223, v59
    ds_write2_b32 v12, v59, v6 offset0:0 offset1:1
    s_waitcnt lgkmcnt(0)
    s_barrier
    s_waitcnt vmcnt(0)
    v_mov_b32 v62, v15
    ds_write_b32 v12, v15 offset:4
    v_cmp_ne_u32 vcc, 0, v15
    s_mov_b32 s24, 0x40000
    s_waitcnt lgkmcnt(0)
    s_barrier
    s_cbranch_vccnz KS_FLOK
KS_FLW:
    s_sub_u32 s24, s24, 1
    s_cbranch_scc1 K2_END
    buffer_load_dword v62, v6, s[60:63], 0 offen sc1
    s_waitcnt vmcnt(0)
    v_cmp_ne_u32 vcc, 0, v62
    s_nop 0
    s_cbranch_vccz KS_FLW
    ds_write_b32 v12, v62 offset:4
KS_FLOK:
    s_mov_b64 exec, -1
    s_branch KS_JOIN
KS_H0:
    s_barrier
    s_branch KS_HELP
K2_PAD_S1:
    s_branch KS_HOP0
KS_NOTAG:
    s_cmp_ge_u32 s20, 5
    s_cbranch_scc1 KS_HELP
    s_cmp_ge_u32 s2, 250
    s_cbranch_scc1 KS_IDLE
    s_mov_b32 s40, s88
    s_and_b32 s41, s89, 0xffff
    s_mov_b32 s42, 1280000
    s_mov_b32 s43, 0x20000
    buffer_load_dwordx4 v[12:15], v5, s[40:43], s64 offen
    s_mov_b32 s44, s86
    s_and_b32 s45, s87, 0xffff
    s_mov_b32 s46, 1280000
    s_mov_b32 s47, 0x20000
    s_mov_b32 s48, s82
    s_and_b32 s49, s83, 0xffff
    s_mov_b32 s50, 1920000
    s_mov_b32 s51, 0x20000
    buffer_load_dwordx4 v[16:19], v5, s[44:47], s64 offen
    buffer_load_dwordx4 v[20:23], v4, s[48:51], s65 offen
    buffer_load_dwordx2 v[24:25], v4, s[48:51], s65 offen offset:16
    v_lshlrev_b32 v2, 2, v0
    s_lshl_b32 s64, s64, 3
    v_lshl_add_u32 v3, v0, 7, s64
    v_mov_b32 v7, 1
    s_cmp_eq_u32 s20, 4
    s_cbranch_scc1 KS_NOCLR
    ds_write_b32 v2, v6
KS_NOCLR:
    s_waitcnt lgkmcnt(0)
    s_barrier
    s_mov_b64 exec, 0
    s_cmp_eq_u32 s20, 0
    s_cbranch_scc1 K2_PAD_B3
    s_cmp_eq_u32 s20, 1
    s_cbranch_scc1 K2_PAD_LD
    s_cmp_eq_u32 s20, 2
    s_cbranch_scc1 K2_PAD_NW
    s_cmp_eq_u32 s20, 3
    s_cbranch_scc1 K2_PAD_SC
    s_cmp_eq_u32 s20, 4
    s_cbranch_scc1 K2_PAD_SD
KS_HOP:
    s_mov_b64 exec, -1
    s_mov_b32 s58, 214749
    s_movk_i32 s59, 625
    s_waitcnt vmcnt(3)
    v_mul_u32_u24 v28, s58, v12
    v_and_b32 v40, 0xffffff, v28
    v_lshrrev_b32 v32, 26, v28
    v_add_u32 v40, 8187281, v40
    v_bfe_u32 v36, v28, 24, 2
    v_lshlrev_b32 v32, 2, v32
    v_lshrrev_b32 v40, 24, v40
    v_lshl_or_b32 v32, v36, 8, v32
    v_lshl_or_b32 v32, v40, 7, v32
    ds_add_rtn_u32 v36, v32, v7
    v_mul_u32_u24 v29, s58, v13
    v_and_b32 v41, 0xffffff, v29
    v_lshrrev_b32 v33, 26, v29
    v_add_u32 v41, 8187281, v41
    v_bfe_u32 v37, v29, 24, 2
    v_lshlrev_b32 v33, 2, v33
    v_lshrrev_b32 v41, 24, v41
    v_lshl_or_b32 v33, v37, 8, v33
    v_lshl_or_b32 v33, v41, 7, v33
    ds_add_rtn_u32 v37, v33, v7
    v_mul_u32_u24 v30, s58, v14
    v_and_b32 v42, 0xffffff, v30
    v_lshrrev_b32 v34, 26, v30
    v_add_u32 v42, 8187281, v42
    v_bfe_u32 v38, v30, 24, 2
    v_lshlrev_b32 v34, 2, v34
    v_lshrrev_b32 v42, 24, v42
    v_lshl_or_b32 v34, v38, 8, v34
    v_lshl_or_b32 v34, v42, 7, v34
    ds_add_rtn_u32 v38, v34, v7
    v_mul_u32_u24 v31, s58, v15
    v_and_b32 v43, 0xffffff, v31
    v_lshrrev_b32 v35, 26, v31
    v_add_u32 v43, 8187281, v43
    v_bfe_u32 v39, v31, 24, 2
    v_lshlrev_b32 v35, 2, v35
    v_lshrrev_b32 v43, 24, v43
    v_lshl_or_b32 v35, v39, 8, v35
    v_lshl_or_b32 v35, v43, 7, v35
    ds_add_rtn_u32 v39, v35, v7
    v_lshrrev_b32 v28, 24, v28
    v_mad_u32_u24 v28, v28, s59, 7
    v_lshrrev_b32 v28, 3, v28
    v_mad_u32_u24 v28, v40, 40, v28
    v_sub_u32 v28, v12, v28
    v_add_u32 v12, 0, v3
    v_lshl_or_b32 v28, v28, 26, v12
    v_lshrrev_b32 v29, 24, v29
    v_mad_u32_u24 v29, v29, s59, 7
    v_lshrrev_b32 v29, 3, v29
    v_mad_u32_u24 v29, v41, 40, v29
    v_sub_u32 v29, v13, v29
    v_add_u32 v13, 32, v3
    v_lshl_or_b32 v29, v29, 26, v13
    v_lshrrev_b32 v30, 24, v30
    v_mad_u32_u24 v30, v30, s59, 7
    v_lshrrev_b32 v30, 3, v30
    v_mad_u32_u24 v30, v42, 40, v30
    v_sub_u32 v30, v14, v30
    v_add_u32 v14, 64, v3
    v_lshl_or_b32 v30, v30, 26, v14
    v_lshrrev_b32 v31, 24, v31
    v_mad_u32_u24 v31, v31, s59, 7
    v_lshrrev_b32 v31, 3, v31
    v_mad_u32_u24 v31, v43, 40, v31
    v_sub_u32 v31, v15, v31
    v_add_u32 v15, 96, v3
    v_lshl_or_b32 v31, v31, 26, v15
K2_PAD_S2:
    s_cbranch_execz KS_HOP0
    v_mov_b32 v59, 163456
    s_mul_i32 s65, s2, 1152
    s_add_u32 s65, s65, 6291456
    s_mul_i32 s64, s2, 20608
    s_waitcnt lgkmcnt(0)
    s_barrier
    ds_read_b128 v[40:43], v9
    ds_read_b32 v59, v59
    s_waitcnt lgkmcnt(1)
    v_add_u32 v45, v40, v41
    v_add_u32 v46, v45, v42
    v_add_u32 v47, v46, v43
    v_mov_b32 v58, v47
    s_nop 1
    v_add_u32_dpp v58, v58, v58 row_shr:1 row_mask:0xf bank_mask:0xf bound_ctrl:0
    s_nop 1
    v_add_u32_dpp v58, v58, v58 row_shr:2 row_mask:0xf bank_mask:0xf bound_ctrl:0
    s_nop 1
    v_add_u32_dpp v58, v58, v58 row_shr:4 row_mask:0xf bank_mask:0xf bound_ctrl:0
    s_nop 1
    v_add_u32_dpp v58, v58, v58 row_shr:8 row_mask:0xf bank_mask:0xf bound_ctrl:0
    s_nop 1
    v_add_u32_dpp v58, v58, v58 row_bcast:15 row_mask:0xa bank_mask:0xf
    s_nop 1
    v_add_u32_dpp v58, v58, v58 row_bcast:31 row_mask:0xc bank_mask:0xf
    v_sub_u32 v48, v58, v47
    v_add_u32 v49, v48, v40
    v_add_u32 v50, v48, v45
    v_add_u32 v51, v48, v46
    ds_write_b128 v9, v[48:51] offset:1024
    s_waitcnt lgkmcnt(1)
    s_cmp_lg_u32 s20, 4
    s_cbranch_scc1 KS_NOPUB
    v_lshl_or_b32 v56, v49, 11, v48
    v_lshl_or_b32 v57, v51, 11, v50
    v_lshl_or_b32 v56, v59, 22, v56
    v_lshl_or_b32 v57, v59, 22, v57
    buffer_store_dwordx4 v[56:59], v9, s[8:11], s65 offen sc1
KS_NOPUB:
    s_waitcnt lgkmcnt(0)
    ds_read_b32 v32, v32 offset:1024
    ds_read_b32 v33, v33 offset:1024
    ds_read_b32 v34, v34 offset:1024
    ds_read_b32 v35, v35 offset:1024
    s_cbranch_scc1 KS_PUB0
    s_waitcnt vmcnt(1)
    s_branch KS_PUB1
KS_PUB0:
    s_waitcnt vmcnt(0)
KS_PUB1:
    v_and_b32 v60, 0xffff, v59
    v_and_b32 v61, 0xffff0000, v59
    s_mov_b32 s58, 0xffff0000
    v_mov_b32 v40, v20
    v_lshl_or_b32 v41, v21, 16, v60
    v_or_b32 v42, v61, v16
    v_mov_b32 v43, v28
    v_alignbit_b32 v44, v22, v21, 16
    v_and_or_b32 v45, v22, s58, v60
    v_or_b32 v46, v61, v17
    v_mov_b32 v47, v29
    v_mov_b32 v48, v23
    v_lshl_or_b32 v49, v24, 16, v60
    v_or_b32 v50, v61, v18
    v_mov_b32 v51, v30
    v_alignbit_b32 v52, v25, v24, 16
    v_and_or_b32 v53, v25, s58, v60
    v_or_b32 v54, v61, v19
    v_mov_b32 v55, v31
    s_waitcnt lgkmcnt(0)
    v_add_lshl_u32 v32, v32, v36, 4
    ds_write_b128 v32, v[40:43] offset:2048
    v_add_lshl_u32 v33, v33, v37, 4
    ds_write_b128 v33, v[44:47] offset:2048
    v_add_lshl_u32 v34, v34, v38, 4
    ds_write_b128 v34, v[48:51] offset:2048
    v_add_lshl_u32 v35, v35, v39, 4
    ds_write_b128 v35, v[52:55] offset:2048
    v_mov_b32 v62, 163460
    s_waitcnt lgkmcnt(0)
    s_barrier
    ds_read_b32 v62, v62
    ds_read_b128 v[12:15], v5 offset:2048
    ds_read_b128 v[16:19], v5 offset:7168
    ds_read_b128 v[20:23], v5 offset:12288
    ds_read_b128 v[24:27], v5 offset:17408
    s_waitcnt lgkmcnt(3)
    buffer_store_dwordx4 v[12:15], v5, s[8:11], s64 offen sc1
    s_add_u32 s64, s64, 5120
    s_waitcnt lgkmcnt(2)
    buffer_store_dwordx4 v[16:19], v5, s[8:11], s64 offen sc1
    s_add_u32 s64, s64, 5120
    s_waitcnt lgkmcnt(1)
    buffer_store_dwordx4 v[20:23], v5, s[8:11], s64 offen sc1
    s_add_u32 s64, s64, 5120
    s_waitcnt lgkmcnt(0)
    buffer_store_dwordx4 v[24:27], v5, s[8:11], s64 offen sc1
    s_branch KS_JOIN
K2_PAD_B3:
    s_branch KS_HOP
KS_B3:
    v_mov_b32 v59, 163456
    ds_read_b32 v59, v59
    v_mov_b32 v62, 163460
    s_waitcnt lgkmcnt(0)
    s_barrier
    ds_read_b32 v62, v62
KS_JOIN:
    v_readfirstlane_b32 s2, v59
    s_mov_b32 s25, 0x400000
KS_JOIN2:
    s_waitcnt lgkmcnt(0)
    v_readfirstlane_b32 s24, v62
    s_nop 0
    s_cmp_eq_u32 s24, 0
    s_cbranch_scc1 KS_FLS
    s_bfe_u32 s24, s24, 0x10001
    s_xor_b32 s54, s54, s24
    s_lshr_b32 s21, s54, 1
    s_mul_i32 s21, s21, 625
    s_add_u32 s22, s21, 632
    s_add_u32 s21, s21, 7
    s_lshr_b32 s21, s21, 3
    s_lshr_b32 s22, s22, 3
    s_add_u32 s24, s21, 40
    s_sub_u32 s22, s22, s24
    s_bitcmp1_b32 s54, 0
    s_cselect_b32 s21, s24, s21
    s_cselect_b32 s22, s22, 40
    s_mov_b32 s23, 0
    s_mov_b32 s28, 1
    s_mov_b32 s24, 0
    s_mov_b32 s25, 1
K2_CELLS:
    v_lshrrev_b32 v178, 1, v177
    v_min_u32 v178, 249, v178
    v_mul_u32_u24 v72, 1152, v178
    s_and_b32 s58, s54, 7
    s_lshl_b32 s58, s58, 7
    s_lshr_b32 s59, s54, 5
    s_lshl_b32 s59, s59, 4
    s_add_u32 s67, s58, s59
    s_add_u32 s67, s67, 6291456
    s_cmp_eq_u32 s28, 0
    s_cbranch_scc1 K2_NOSRD
    s_mov_b32 s4, s80
    s_and_b32 s5, s81, 0xffff
    s_mov_b32 s6, 10240000
    s_mov_b32 s7, 0x20000
    s_mov_b32 s12, s96
    s_and_b32 s13, s97, 0xffff
    s_mov_b32 s14, 10240000
    s_mov_b32 s15, 0x20000
    s_mov_b32 s16, s84
    s_and_b32 s17, s85, 0xffff
    s_mov_b32 s18, 10240000
    s_mov_b32 s19, 0x20000
    s_sub_u32 s80, s80, 1024
    s_subb_u32 s81, s81, 0
    s_mov_b32 s72, s80
    s_and_b32 s73, s81, 0xffff
    s_mov_b32 s74, 10241024
    s_mov_b32 s75, 0x20000
    s_mov_b64 exec, 0
    s_cmp_eq_u32 s20, 0
    s_cbranch_scc1 K2_PAD_U20
    s_cmp_eq_u32 s20, 1
    s_cbranch_scc1 K2_PAD_U30
    s_cmp_eq_u32 s20, 2
    s_cbranch_scc1 K2_PAD_U21
    s_cmp_eq_u32 s20, 3
    s_cbranch_scc1 K2_PAD_U31
    s_cmp_eq_u32 s20, 4
    s_cbranch_scc1 K2_PAD_SW
    s_cmp_eq_u32 s20, 5
    s_cbranch_scc1 K2_PAD_TL
    s_cmp_eq_u32 s20, 6
    s_cbranch_scc1 K2_PAD_T2
K2_HOP:
    s_mov_b64 exec, -1
K2_NOSRD:
    v_and_b32 v84, 15, v176
    v_lshrrev_b32 v85, 5, v176
    v_bfe_u32 v86, v176, 4, 1
    v_lshrrev_b32 v87, 2, v84
    v_and_b32 v88, 3, v84
    v_lshl_add_u32 v89, v85, 2, v87
    v_lshlrev_b32 v249, 6, v89
    v_lshl_add_u32 v249, v88, 3, v249
    v_add_u32 v249, 512, v249
    v_lshrrev_b32 v90, 3, v84
    v_lshl_add_u32 v90, v90, 1, v86
    v_sub_u32 v90, v90, 1 clamp
    v_lshlrev_b32 v250, 1, v90
    v_lshl_add_u32 v91, v85, 2, v88
    v_lshl_add_u32 v250, v91, 4, v250
    v_and_b32 v91, 1, v87
    v_lshl_add_u32 v250, v91, 3, v250
    v_lshrrev_b32 v90, 1, v88
    v_lshl_add_u32 v90, v86, 1, v90
    v_bfe_u32 v91, v87, 1, 1
    v_lshlrev_b32 v91, 2, v91
    v_xor_b32 v90, v90, v91
    v_lshlrev_b32 v90, 4, v90
    v_lshl_add_u32 v90, v89, 7, v90
    v_and_b32 v91, 1, v88
    v_lshl_add_u32 v90, v91, 3, v90
    v_add_u32 v246, s37, v90
    v_xor_b32 v247, 64, v246
    v_lshrrev_b32 v90, 3, v176
    v_lshlrev_b32 v251, 4, v90
    v_bfe_u32 v90, v90, 1, 1
    v_lshlrev_b32 v90, 2, v90
    v_and_b32 v91, 7, v176
    v_xor_b32 v90, v90, v91
    v_lshlrev_b32 v248, 4, v90
    v_lshlrev_b32 v252, 1, v176
    v_mov_b32 v228, -1
    v_mov_b32 v229, -1
    v_and_b32 v231, 1, v176
    v_lshlrev_b32 v231, 4, v231
    v_lshrrev_b32 v90, 1, v176
    v_lshlrev_b32 v90, 5, v90
    v_add_u32 v230, 512, v90
    s_cmp_eq_u32 s28, 0
    s_cbranch_scc1 K2_NOW0
    v_lshrrev_b32 v60, 6, v252
    v_bfe_u32 v61, v252, 3, 2
    v_lshl_add_u32 v60, v60, 2, v61
    v_mul_u32_u24 v60, 640, v60
    v_bfe_u32 v61, v252, 5, 1
    v_lshl_add_u32 v60, v61, 5, v60
    v_and_b32 v61, 6, v252
    v_lshl_add_u32 v60, v61, 2, v60
    v_add_u32 v60, 24576, v60
    ds_read_b64_tr_b16 v[136:137], v60 offset:0
    ds_read_b64_tr_b16 v[138:139], v60 offset:5120
    ds_read_b64_tr_b16 v[140:141], v60 offset:64
    ds_read_b64_tr_b16 v[142:143], v60 offset:5184
    ds_read_b64_tr_b16 v[144:145], v60 offset:128
    ds_read_b64_tr_b16 v[146:147], v60 offset:5248
    ds_read_b64_tr_b16 v[148:149], v60 offset:192
    ds_read_b64_tr_b16 v[150:151], v60 offset:5312
    ds_read_b64_tr_b16 v[152:153], v60 offset:256
    ds_read_b64_tr_b16 v[154:155], v60 offset:5376
    ds_read_b64_tr_b16 v[156:157], v60 offset:320
    ds_read_b64_tr_b16 v[158:159], v60 offset:5440
    ds_read_b64_tr_b16 v[160:161], v60 offset:384
    ds_read_b64_tr_b16 v[162:163], v60 offset:5504
    ds_read_b64_tr_b16 v[164:165], v60 offset:448
    ds_read_b64_tr_b16 v[166:167], v60 offset:5568
    ds_read_b64_tr_b16 v[168:169], v60 offset:512
    ds_read_b64_tr_b16 v[170:171], v60 offset:5632
    ds_read_b64_tr_b16 v[172:173], v60 offset:576
    ds_read_b64_tr_b16 v[174:175], v60 offset:5696
    s_waitcnt lgkmcnt(0)
    v_lshlrev_b32 v96, 16, v136
    v_and_b32 v97, 0xffff0000, v136
    v_lshlrev_b32 v98, 16, v137
    v_and_b32 v99, 0xffff0000, v137
    v_lshlrev_b32 v100, 16, v138
    v_and_b32 v101, 0xffff0000, v138
    v_lshlrev_b32 v102, 16, v139
    v_and_b32 v103, 0xffff0000, v139
    v_lshlrev_b32 v104, 16, v140
    v_and_b32 v105, 0xffff0000, v140
    v_lshlrev_b32 v106, 16, v141
    v_and_b32 v107, 0xffff0000, v141
    v_lshlrev_b32 v108, 16, v142
    v_and_b32 v109, 0xffff0000, v142
    v_lshlrev_b32 v110, 16, v143
    v_and_b32 v111, 0xffff0000, v143
    v_lshlrev_b32 v112, 16, v144
    v_and_b32 v113, 0xffff0000, v144
    v_lshlrev_b32 v114, 16, v145
    v_and_b32 v115, 0xffff0000, v145
    v_lshlrev_b32 v116, 16, v146
    v_and_b32 v117, 0xffff0000, v146
    v_lshlrev_b32 v118, 16, v147
    v_and_b32 v119, 0xffff0000, v147
    v_lshlrev_b32 v120, 16, v148
    v_and_b32 v121, 0xffff0000, v148
    v_lshlrev_b32 v122, 16, v149
    v_and_b32 v123, 0xffff0000, v149
    v_lshlrev_b32 v124, 16, v150
    v_and_b32 v125, 0xffff0000, v150
    v_lshlrev_b32 v126, 16, v151
    v_and_b32 v127, 0xffff0000, v151
    buffer_load_dwordx4 v[76:79], v72, s[8:11], s67 offen sc1
    v_lshlrev_b32 v128, 16, v152
    v_and_b32 v129, 0xffff0000, v152
    v_lshlrev_b32 v130, 16, v153
    v_and_b32 v131, 0xffff0000, v153
    v_lshlrev_b32 v132, 16, v154
    v_and_b32 v133, 0xffff0000, v154
    v_lshlrev_b32 v134, 16, v155
    v_and_b32 v135, 0xffff0000, v155
    v_lshlrev_b32 v136, 16, v156
    v_and_b32 v137, 0xffff0000, v156
    v_lshlrev_b32 v138, 16, v157
    v_and_b32 v139, 0xffff0000, v157
    v_lshlrev_b32 v140, 16, v158
    v_and_b32 v141, 0xffff0000, v158
    v_lshlrev_b32 v142, 16, v159
    v_and_b32 v143, 0xffff0000, v159
    v_lshlrev_b32 v144, 16, v160
    v_and_b32 v145, 0xffff0000, v160
    v_lshlrev_b32 v146, 16, v161
    v_and_b32 v147, 0xffff0000, v161
    v_lshlrev_b32 v148, 16, v162
    v_and_b32 v149, 0xffff0000, v162
    v_lshlrev_b32 v150, 16, v163
    v_and_b32 v151, 0xffff0000, v163
    v_lshlrev_b32 v152, 16, v164
    v_and_b32 v153, 0xffff0000, v164
    v_lshlrev_b32 v154, 16, v165
    v_and_b32 v155, 0xffff0000, v165
    v_lshlrev_b32 v156, 16, v166
    v_and_b32 v157, 0xffff0000, v166
    v_lshlrev_b32 v158, 16, v167
    v_and_b32 v159, 0xffff0000, v167
    v_lshlrev_b32 v160, 16, v168
    v_and_b32 v161, 0xffff0000, v168
    v_lshlrev_b32 v162, 16, v169
    v_and_b32 v163, 0xffff0000, v169
    v_lshlrev_b32 v164, 16, v170
    v_and_b32 v165, 0xffff0000, v170
    v_lshlrev_b32 v166, 16, v171
    v_and_b32 v167, 0xffff0000, v171
    v_lshlrev_b32 v168, 16, v172
    v_and_b32 v169, 0xffff0000, v172
    v_lshlrev_b32 v170, 16, v173
    v_and_b32 v171, 0xffff0000, v173
    v_lshlrev_b32 v172, 16, v174
    v_and_b32 v173, 0xffff0000, v174
    v_lshlrev_b32 v174, 16, v175
    v_and_b32 v175, 0xffff0000, v175
K2_W0:
    s_lshl_b32 s59, s2, 22
    s_mov_b32 s60, 0x40000
    s_bfe_u32 s61, s54, 0x10004
    s_bfe_u32 s62, s54, 0x10003
    s_add_u32 s63, s61, s62
    s_mul_i32 s62, s62, 11
    s_sub_u32 s64, 11, s62
    v_cmp_gt_u32 vcc, 500, v177
    s_nop 0
    s_mov_b64 s[56:57], vcc
K2_POLL:
    s_waitcnt vmcnt(0)
    v_xor_b32 v73, s59, v76
    v_xor_b32 v74, s59, v77
    v_or_b32 v73, v73, v74
    v_xor_b32 v74, s2, v79
    v_lshrrev_b32 v73, 22, v73
    v_or_b32 v73, v73, v74
    v_cmp_ne_u32 vcc, 0, v73
    s_nop 0
    s_cbranch_vccz K2_POLLED
    s_sub_u32 s60, s60, 1
    s_cbranch_scc1 K2_END
    s_mov_b64 exec, vcc
    buffer_load_dwordx4 v[76:79], v72, s[8:11], s67 offen sc1
    s_mov_b64 exec, -1
    s_branch K2_POLL
K2_PAD_LD:
    s_branch KS_HOP
K2_POLLED:
    s_set_gpr_idx_on s61, gpr_idx(SRC0)
    s_nop 0
    v_bfe_u32 v179, v76, s62, 11
    s_set_gpr_idx_idx s63
    s_nop 0
    v_bfe_u32 v73, v76, s64, 11
    s_set_gpr_idx_off
    v_sub_u32 v73, v73, v179
    v_cndmask_b32 v73, 0, v73, s[56:57]
    v_and_b32 v1, 1, v177
    v_add_u32 v1, s23, v1
    v_sub_u32 v180, v73, v1
    v_add_u32 v179, v179, v1
    v_mul_u32_u24 v181, 20608, v178
    v_lshl_add_u32 v181, v179, 4, v181
    v_cmp_lt_i32 s[40:41], 0, v180
    v_add_u32 v182, 32, v181
    s_mov_b32 s65, 0
    s_mov_b64 exec, s[40:41]
    buffer_load_dwordx4 v[0:3], v181, s[8:11], 0 offen offset:0 sc1
    s_mov_b64 exec, -1
    v_cmp_lt_i32 s[42:43], 2, v180
    v_cmp_lt_i32 s[44:45], 4, v180
    v_cmp_lt_i32 s[46:47], 6, v180
    v_cmp_lt_i32 s[48:49], 8, v180
    v_cmp_lt_i32 s[50:51], 10, v180
    v_cmp_lt_i32 s[90:91], 12, v180
    v_cmp_lt_i32 s[92:93], 14, v180
    v_cmp_lt_i32 s[94:95], 16, v180
    v_cmp_lt_i32 s[96:97], 18, v180
    v_add_u32 v183, 64, v181
    v_add_u32 v184, 96, v181
    v_subrev_u32 v62, 1, v180
    v_ashrrev_i32 v62, 1, v62
    v_med3_i32 v62, v62, 0, 9
    s_cmp_eq_u64 s[42:43], 0
    s_cbranch_scc1 K2_LD_DONE
    v_mov_b32 v63, v62
    s_nop 1
    v_add_u32_dpp v63, v63, v63 row_shr:1 row_mask:0xf bank_mask:0xf bound_ctrl:0
    s_nop 1
    v_add_u32_dpp v63, v63, v63 row_shr:2 row_mask:0xf bank_mask:0xf bound_ctrl:0
    s_nop 1
    v_add_u32_dpp v63, v63, v63 row_shr:4 row_mask:0xf bank_mask:0xf bound_ctrl:0
    s_nop 1
    v_add_u32_dpp v63, v63, v63 row_shr:8 row_mask:0xf bank_mask:0xf bound_ctrl:0
    s_nop 1
    v_add_u32_dpp v63, v63, v63 row_bcast:15 row_mask:0xa bank_mask:0xf
    s_nop 1
    v_add_u32_dpp v63, v63, v63 row_bcast:31 row_mask:0xc bank_mask:0xf
    s_lshl_b32 s58, s20, 10
    s_add_u32 s58, s58, 45056
    v_readlane_b32 s59, v63, 63
    v_sub_u32 v63, v63, v62
    v_lshl_add_u32 v64, v63, 2, s58
    v_lshlrev_b32 v63, 5, v63
    v_sub_u32 v63, v182, v63
    s_cmp_gt_u32 s59, 189
    s_cbranch_scc1 K2_LD_GEN
    s_mov_b64 exec, s[42:43]
    s_cbranch_execz K2_LD_L
    ds_write_b32 v64, v63 offset:0
    s_mov_b64 exec, s[44:45]
    s_cbranch_execz K2_LD_L
    ds_write_b32 v64, v63 offset:4
    s_mov_b64 exec, s[46:47]
    s_cbranch_execz K2_LD_L
    ds_write_b32 v64, v63 offset:8
    s_mov_b64 exec, s[48:49]
    s_cbranch_execz K2_LD_L
    ds_write_b32 v64, v63 offset:12
    s_mov_b64 exec, s[50:51]
    s_cbranch_execz K2_LD_L
    ds_write_b32 v64, v63 offset:16
    s_mov_b64 exec, s[90:91]
    s_cbranch_execz K2_LD_L
    ds_write_b32 v64, v63 offset:20
    s_mov_b64 exec, s[92:93]
    s_cbranch_execz K2_LD_L
    ds_write_b32 v64, v63 offset:24
    s_mov_b64 exec, s[94:95]
    s_cbranch_execz K2_LD_L
    ds_write_b32 v64, v63 offset:28
    s_mov_b64 exec, s[96:97]
    s_cbranch_execz K2_LD_L
    ds_write_b32 v64, v63 offset:32
K2_LD_L:
    s_mov_b64 exec, -1
    v_lshl_add_u32 v63, v176, 2, s58
    v_lshlrev_b32 v62, 5, v176
    s_waitcnt lgkmcnt(0)
    ds_read_b32 v64, v63 offset:0
    ds_read_b32 v65, v63 offset:252
    ds_read_b32 v66, v63 offset:504
    s_min_u32 s60, s59, 63
    s_sub_u32 s59, s59, s60
    s_bfm_b64 s[42:43], s60, 0
    s_min_u32 s60, s59, 63
    s_sub_u32 s59, s59, s60
    s_bfm_b64 s[44:45], s60, 0
    s_min_u32 s60, s59, 63
    s_sub_u32 s59, s59, s60
    s_bfm_b64 s[46:47], s60, 0
    s_mov_b64 s[48:49], 0
    s_mov_b32 s65, 1
    s_mov_b32 s60, 0
    s_waitcnt lgkmcnt(2)
    v_add3_u32 v182, v62, v64, s60
    s_mov_b64 exec, s[42:43]
    buffer_load_dwordx4 v[4:7], v182, s[8:11], 0 offen sc1
    s_mov_b32 s60, 2016
    s_waitcnt lgkmcnt(1)
    v_add3_u32 v183, v62, v65, s60
    s_mov_b64 exec, s[44:45]
    buffer_load_dwordx4 v[8:11], v183, s[8:11], 0 offen sc1
    s_mov_b32 s60, 4032
    s_waitcnt lgkmcnt(0)
    v_add3_u32 v184, v62, v66, s60
    s_mov_b64 exec, s[46:47]
    buffer_load_dwordx4 v[12:15], v184, s[8:11], 0 offen sc1
K2_LD_DONE:
    s_mov_b64 exec, -1
    s_cmp_eq_u32 s28, 0
    s_cbranch_scc1 K2_WLATE
K2_NOWRAW:
K2_PAD_NW:
    s_cbranch_execz KS_HOP
    v_lshrrev_b32 v179, 2, v181
    v_lshrrev_b32 v185, 2, v182
    v_lshrrev_b32 v186, 2, v183
    v_lshrrev_b32 v187, 2, v184
    s_mov_b32 s66, 7340032
    v_mov_b32 v201, 1
    s_movk_i32 s58, 520
    s_movk_i32 s59, 2080
    s_mov_b32 s60, 0x40000
    s_mov_b32 s61, 0xffff
    v_mov_b32 v202, 65536
    s_cmp_lg_u32 s24, 0
    s_cbranch_scc1 K2_RK_LOAD
    v_cmp_lt_i32 vcc, 20, v180
    s_nop 0
    s_cbranch_vccz K2_NOMORE
    v_mov_b32 v61, 163300
    ds_write_b32 v61, v201
K2_NOMORE:
    s_mov_b32 s62, 82176
    s_cmp_eq_u32 s65, 0
    s_waitcnt vmcnt(3)
    s_cbranch_scc0 K2_ARR
    s_waitcnt vmcnt(0)
K2_ARR:
    s_mov_b64 exec, s[40:41]
    s_cbranch_execz K2_RK_A
K2_CK0:
    v_bfi_b32 v192, s61, v1, v2
    v_lshrrev_b32 v50, 24, v3
    v_cmp_ne_u32 vcc, s2, v192
    v_add_u32 v40, 163072, v50
    s_cbranch_vccnz K2_RT0
    ds_add_rtn_u32 v40, v40, v201
    v_mad_u32_u24 v50, v50, s58, v202
    s_mov_b64 exec, s[42:43]
    s_cbranch_execz K2_RK_A
    s_waitcnt vmcnt(2)
K2_CK1:
    v_bfi_b32 v192, s61, v5, v6
    v_lshrrev_b32 v51, 24, v7
    v_cmp_ne_u32 vcc, s2, v192
    v_add_u32 v41, 163072, v51
    s_cbranch_vccnz K2_RT1
    ds_add_rtn_u32 v41, v41, v201
    v_mad_u32_u24 v51, v51, s58, v202
    s_mov_b64 exec, s[44:45]
    s_cbranch_execz K2_RK_A
    s_waitcnt vmcnt(1)
K2_CK2:
    v_bfi_b32 v192, s61, v9, v10
    v_lshrrev_b32 v52, 24, v11
    v_cmp_ne_u32 vcc, s2, v192
    v_add_u32 v42, 163072, v52
    s_cbranch_vccnz K2_RT2
    ds_add_rtn_u32 v42, v42, v201
    v_mad_u32_u24 v52, v52, s58, v202
    s_mov_b64 exec, s[46:47]
    s_cbranch_execz K2_RK_A
    s_waitcnt vmcnt(0)
K2_CK3:
    v_bfi_b32 v192, s61, v13, v14
    v_lshrrev_b32 v53, 24, v15
    v_cmp_ne_u32 vcc, s2, v192
    v_add_u32 v43, 163072, v53
    s_cbranch_vccnz K2_RT3
    ds_add_rtn_u32 v43, v43, v201
    v_mad_u32_u24 v53, v53, s58, v202
    s_mov_b64 exec, s[48:49]
    s_cbranch_execz K2_RK_A
K2_CK4:
    v_bfi_b32 v192, s61, v17, v18
    v_lshrrev_b32 v54, 24, v19
    v_cmp_ne_u32 vcc, s2, v192
    v_add_u32 v44, 163072, v54
    s_cbranch_vccnz K2_RT4
    ds_add_rtn_u32 v44, v44, v201
    v_mad_u32_u24 v54, v54, s58, v202
    s_mov_b64 exec, s[50:51]
    s_cbranch_execz K2_RK_A
K2_CK5:
    v_bfi_b32 v192, s61, v21, v22
    v_lshrrev_b32 v55, 24, v23
    v_cmp_ne_u32 vcc, s2, v192
    v_add_u32 v45, 163072, v55
    s_cbranch_vccnz K2_RT5
    ds_add_rtn_u32 v45, v45, v201
    v_mad_u32_u24 v55, v55, s58, v202
    s_mov_b64 exec, s[90:91]
    s_cbranch_execz K2_RK_A
K2_CK6:
    v_bfi_b32 v192, s61, v25, v26
    v_lshrrev_b32 v56, 24, v27
    v_cmp_ne_u32 vcc, s2, v192
    v_add_u32 v46, 163072, v56
    s_cbranch_vccnz K2_RT6
    ds_add_rtn_u32 v46, v46, v201
    v_mad_u32_u24 v56, v56, s58, v202
    s_mov_b64 exec, s[92:93]
    s_cbranch_execz K2_RK_A
K2_CK7:
    v_bfi_b32 v192, s61, v29, v30
    v_lshrrev_b32 v57, 24, v31
    v_cmp_ne_u32 vcc, s2, v192
    v_add_u32 v47, 163072, v57
    s_cbranch_vccnz K2_RT7
    ds_add_rtn_u32 v47, v47, v201
    v_mad_u32_u24 v57, v57, s58, v202
    s_mov_b64 exec, s[94:95]
    s_cbranch_execz K2_RK_A
K2_CK8:
    v_bfi_b32 v192, s61, v33, v34
    v_lshrrev_b32 v58, 24, v35
    v_cmp_ne_u32 vcc, s2, v192
    v_add_u32 v48, 163072, v58
    s_cbranch_vccnz K2_RT8
    ds_add_rtn_u32 v48, v48, v201
    v_mad_u32_u24 v58, v58, s58, v202
    s_mov_b64 exec, s[96:97]
    s_cbranch_execz K2_RK_A
K2_CK9:
    v_bfi_b32 v192, s61, v37, v38
    v_lshrrev_b32 v59, 24, v39
    v_cmp_ne_u32 vcc, s2, v192
    v_add_u32 v49, 163072, v59
    s_cbranch_vccnz K2_RT9
    ds_add_rtn_u32 v49, v49, v201
    v_mad_u32_u24 v59, v59, s58, v202
K2_RK_A:
    s_mov_b64 exec, -1
    s_mov_b64 exec, s[40:41]
    s_cbranch_execz K2_TP
    v_cmp_gt_u32 vcc, s62, v50
    v_and_b32 v3, 0xffffff, v3
    s_mov_b64 exec, vcc
    buffer_load_dword v245, v3, s[16:19], 0 offen
    s_mov_b64 exec, s[42:43]
    s_cbranch_execz K2_TP
    v_cmp_gt_u32 vcc, s62, v51
    v_and_b32 v7, 0xffffff, v7
    s_mov_b64 exec, vcc
    buffer_load_dword v245, v7, s[16:19], 0 offen
    s_mov_b64 exec, s[44:45]
    s_cbranch_execz K2_TP
    v_cmp_gt_u32 vcc, s62, v52
    v_and_b32 v11, 0xffffff, v11
    s_mov_b64 exec, vcc
    buffer_load_dword v245, v11, s[16:19], 0 offen
    s_mov_b64 exec, s[46:47]
    s_cbranch_execz K2_TP
    v_cmp_gt_u32 vcc, s62, v53
    v_and_b32 v15, 0xffffff, v15
    s_mov_b64 exec, vcc
    buffer_load_dword v245, v15, s[16:19], 0 offen
    s_mov_b64 exec, s[48:49]
    s_cbranch_execz K2_TP
    v_cmp_gt_u32 vcc, s62, v54
    v_and_b32 v19, 0xffffff, v19
    s_mov_b64 exec, vcc
    buffer_load_dword v245, v19, s[16:19], 0 offen
    s_mov_b64 exec, s[50:51]
    s_cbranch_execz K2_TP
    v_cmp_gt_u32 vcc, s62, v55
    v_and_b32 v23, 0xffffff, v23
    s_mov_b64 exec, vcc
    buffer_load_dword v245, v23, s[16:19], 0 offen
    s_mov_b64 exec, s[90:91]
    s_cbranch_execz K2_TP
    v_cmp_gt_u32 vcc, s62, v56
    v_and_b32 v27, 0xffffff, v27
    s_mov_b64 exec, vcc
    buffer_load_dword v245, v27, s[16:19], 0 offen
    s_mov_b64 exec, s[92:93]
    s_cbranch_execz K2_TP
    v_cmp_gt_u32 vcc, s62, v57
    v_and_b32 v31, 0xffffff, v31
    s_mov_b64 exec, vcc
    buffer_load_dword v245, v31, s[16:19], 0 offen
    s_mov_b64 exec, s[94:95]
    s_cbranch_execz K2_TP
    v_cmp_gt_u32 vcc, s62, v58
    v_and_b32 v35, 0xffffff, v35
    s_mov_b64 exec, vcc
    buffer_load_dword v245, v35, s[16:19], 0 offen
    s_mov_b64 exec, s[96:97]
    s_cbranch_execz K2_TP
    v_cmp_gt_u32 vcc, s62, v59
    v_and_b32 v39, 0xffffff, v39
    s_mov_b64 exec, vcc
    buffer_load_dword v245, v39, s[16:19], 0 offen
K2_TP:
    s_mov_b64 exec, -1
K2_RK_DONE:
K2_PAD_SC:
    s_cbranch_execz KS_HOP
    s_mul_i32 s67, s24, 48
    s_movk_i32 s58, -1532
    s_waitcnt lgkmcnt(0)
    s_mov_b64 exec, s[40:41]
    s_cbranch_execz K2_SC_DONE
    v_cmpx_gt_u32 vcc, 64, v40
    v_bfe_u32 v194, v40, 3, 1
    v_add_u32 v193, 16, v40
    v_lshl_or_b32 v194, v40, 1, v194
    v_bfi_b32 v194, 15, v194, v40
    v_lshrrev_b32 v193, 6, v193
    v_alignbit_b32 v1, v2, v1, 16
    v_lshl_add_u32 v195, v194, 3, v50
    v_lshl_add_u32 v194, v194, 5, v50
    ds_write_b64 v195, v[0:1]
    v_mad_i32_i24 v194, v193, s58, v194
    ds_write_b32 v194, v3 offset:512
    s_mov_b64 exec, s[42:43]
    s_cbranch_execz K2_SC_DONE
    v_cmpx_gt_u32 vcc, 64, v41
    v_bfe_u32 v194, v41, 3, 1
    v_add_u32 v193, 16, v41
    v_lshl_or_b32 v194, v41, 1, v194
    v_bfi_b32 v194, 15, v194, v41
    v_lshrrev_b32 v193, 6, v193
    v_alignbit_b32 v5, v6, v5, 16
    v_lshl_add_u32 v195, v194, 3, v51
    v_lshl_add_u32 v194, v194, 5, v51
    ds_write_b64 v195, v[4:5]
    v_mad_i32_i24 v194, v193, s58, v194
    ds_write_b32 v194, v7 offset:512
    s_mov_b64 exec, s[44:45]
    s_cbranch_execz K2_SC_DONE
    v_cmpx_gt_u32 vcc, 64, v42
    v_bfe_u32 v194, v42, 3, 1
    v_add_u32 v193, 16, v42
    v_lshl_or_b32 v194, v42, 1, v194
    v_bfi_b32 v194, 15, v194, v42
    v_lshrrev_b32 v193, 6, v193
    v_alignbit_b32 v9, v10, v9, 16
    v_lshl_add_u32 v195, v194, 3, v52
    v_lshl_add_u32 v194, v194, 5, v52
    ds_write_b64 v195, v[8:9]
    v_mad_i32_i24 v194, v193, s58, v194
    ds_write_b32 v194, v11 offset:512
    s_mov_b64 exec, s[46:47]
    s_cbranch_execz K2_SC_DONE
    v_cmpx_gt_u32 vcc, 64, v43
    v_bfe_u32 v194, v43, 3, 1
    v_add_u32 v193, 16, v43
    v_lshl_or_b32 v194, v43, 1, v194
    v_bfi_b32 v194, 15, v194, v43
    v_lshrrev_b32 v193, 6, v193
    v_alignbit_b32 v13, v14, v13, 16
    v_lshl_add_u32 v195, v194, 3, v53
    v_lshl_add_u32 v194, v194, 5, v53
    ds_write_b64 v195, v[12:13]
    v_mad_i32_i24 v194, v193, s58, v194
    ds_write_b32 v194, v15 offset:512
    s_mov_b64 exec, s[48:49]
    s_cbranch_execz K2_SC_DONE
    v_cmpx_gt_u32 vcc, 64, v44
    v_bfe_u32 v194, v44, 3, 1
    v_add_u32 v193, 16, v44
    v_lshl_or_b32 v194, v44, 1, v194
    v_bfi_b32 v194, 15, v194, v44
    v_lshrrev_b32 v193, 6, v193
    v_alignbit_b32 v17, v18, v17, 16
    v_lshl_add_u32 v195, v194, 3, v54
    v_lshl_add_u32 v194, v194, 5, v54
    ds_write_b64 v195, v[16:17]
    v_mad_i32_i24 v194, v193, s58, v194
    ds_write_b32 v194, v19 offset:512
    s_mov_b64 exec, s[50:51]
    s_cbranch_execz K2_SC_DONE
    v_cmpx_gt_u32 vcc, 64, v45
    v_bfe_u32 v194, v45, 3, 1
    v_add_u32 v193, 16, v45
    v_lshl_or_b32 v194, v45, 1, v194
    v_bfi_b32 v194, 15, v194, v45
    v_lshrrev_b32 v193, 6, v193
    v_alignbit_b32 v21, v22, v21, 16
    v_lshl_add_u32 v195, v194, 3, v55
    v_lshl_add_u32 v194, v194, 5, v55
    ds_write_b64 v195, v[20:21]
    v_mad_i32_i24 v194, v193, s58, v194
    ds_write_b32 v194, v23 offset:512
    s_mov_b64 exec, s[90:91]
    s_cbranch_execz K2_SC_DONE
    v_cmpx_gt_u32 vcc, 64, v46
    v_bfe_u32 v194, v46, 3, 1
    v_add_u32 v193, 16, v46
    v_lshl_or_b32 v194, v46, 1, v194
    v_bfi_b32 v194, 15, v194, v46
    v_lshrrev_b32 v193, 6, v193
    v_alignbit_b32 v25, v26, v25, 16
    v_lshl_add_u32 v195, v194, 3, v56
    v_lshl_add_u32 v194, v194, 5, v56
    ds_write_b64 v195, v[24:25]
    v_mad_i32_i24 v194, v193, s58, v194
    ds_write_b32 v194, v27 offset:512
    s_mov_b64 exec, s[92:93]
    s_cbranch_execz K2_SC_DONE
    v_cmpx_gt_u32 vcc, 64, v47
    v_bfe_u32 v194, v47, 3, 1
    v_add_u32 v193, 16, v47
    v_lshl_or_b32 v194, v47, 1, v194
    v_bfi_b32 v194, 15, v194, v47
    v_lshrrev_b32 v193, 6, v193
    v_alignbit_b32 v29, v30, v29, 16
    v_lshl_add_u32 v195, v194, 3, v57
    v_lshl_add_u32 v194, v194, 5, v57
    ds_write_b64 v195, v[28:29]
    v_mad_i32_i24 v194, v193, s58, v194
    ds_write_b32 v194, v31 offset:512
    s_mov_b64 exec, s[94:95]
    s_cbranch_execz K2_SC_DONE
    v_cmpx_gt_u32 vcc, 64, v48
    v_bfe_u32 v194, v48, 3, 1
    v_add_u32 v193, 16, v48
    v_lshl_or_b32 v194, v48, 1, v194
    v_bfi_b32 v194, 15, v194, v48
    v_lshrrev_b32 v193, 6, v193
    v_alignbit_b32 v33, v34, v33, 16
    v_lshl_add_u32 v195, v194, 3, v58
    v_lshl_add_u32 v194, v194, 5, v58
    ds_write_b64 v195, v[32:33]
    v_mad_i32_i24 v194, v193, s58, v194
    ds_write_b32 v194, v35 offset:512
    s_mov_b64 exec, s[96:97]
    s_cbranch_execz K2_SC_DONE
    v_cmpx_gt_u32 vcc, 64, v49
    v_bfe_u32 v194, v49, 3, 1
    v_add_u32 v193, 16, v49
    v_lshl_or_b32 v194, v49, 1, v194
    v_bfi_b32 v194, 15, v194, v49
    v_lshrrev_b32 v193, 6, v193
    v_alignbit_b32 v37, v38, v37, 16
    v_lshl_add_u32 v195, v194, 3, v59
    v_lshl_add_u32 v194, v194, 5, v59
    ds_write_b64 v195, v[36:37]
    v_mad_i32_i24 v194, v193, s58, v194
    ds_write_b32 v194, v39 offset:512
K2_SC_DONE:
    s_mov_b64 exec, -1
K2_PAD_SD:
    s_cbranch_execz KS_HOP
    v_lshlrev_b32 v192, 2, v176
    v_add_u32 v192, 163072, v192
    v_mov_b32 v200, 163300
    s_cmp_eq_u32 s24, 0
    s_cselect_b32 s26, 64, 48
    s_waitcnt lgkmcnt(0)
    s_barrier
    ds_read_b32 v193, v192
    ds_read_b32 v200, v200
    v_cmp_gt_u32 s[56:57], s22, v176
    v_mad_u32_u24 v195, v176, s59, v202
    s_waitcnt lgkmcnt(0)
    v_cndmask_b32 v193, 0, v193, s[56:57]
    v_readfirstlane_b32 s27, v200
    v_cmp_lt_u32 s[62:63], 48, v193
    v_cmp_lt_u32 vcc, 64, v193
    s_bcnt1_i32_b64 s60, s[62:63]
    v_mbcnt_lo_u32_b32 v198, s62, 0
    v_mbcnt_hi_u32_b32 v198, s63, v198
    s_cbranch_vccnz K2_BIG
    s_cmp_gt_u32 s60, 8
    s_cbranch_scc1 K2_BIG
K2_TOK:
    v_subrev_u32 v194, s67, v193
    v_max_i32 v194, 1, v194
    v_min_i32 v194, s26, v194
    v_add_u32 v194, 15, v194
    v_lshrrev_b32 v194, 3, v194
    v_lshl_or_b32 v195, v194, 18, v195
    v_lshl_or_b32 v195, v198, 28, v195
    v_mov_b32 v197, 949760
    v_cndmask_b32 v253, v197, v195, s[56:57]
    s_movk_i32 s40, 0
    s_movk_i32 s41, 256
    s_movk_i32 s42, 512
    s_movk_i32 s43, 768
    s_add_u32 s24, s24, 1
    s_cmp_ge_u32 s24, s25
    s_cselect_b32 s55, 1, 0
    s_cmp_eq_u32 s27, 0
    s_cselect_b32 s55, s55, 0
    s_mov_b32 s27, 0x400000
    s_mov_b32 s38, 0
    s_mov_b32 s34, 0
    s_mov_b32 s35, 0
    s_mov_b32 s36, 1
    s_mov_b32 s31, 0
    s_mov_b32 s58, s20
    v_readlane_b32 s3, v253, s58
    s_lshl_b32 s44, s34, 7
    s_and_b32 s48, s3, 0x3ffff
    s_bfe_u32 s33, s3, 0x30013
    s_mul_i32 s35, s38, 6
    s_cmp_eq_u32 s34, 0
    s_cselect_b32 s35, s35, s48
    s_mov_b32 s45, s44
    s_xor_b32 s47, s44, 256
    s_add_u32 s49, s48, 128
    s_add_u32 s60, s48, 256
    s_cmp_eq_u32 s33, 3
    s_cselect_b32 s46, s44, s47
    s_cselect_b32 s50, s60, s48
    s_sub_u32 s60, s33, 2
    s_cmp_lt_u32 s60, 2
    s_cbranch_scc0 K2_rare_1
K2_back_2:
    v_add_u32 v233, s48, v230
    ds_read_b32 v232, v233
    ds_read_b32 v233, v233 offset:1024
    v_add_u32 v222, s48, v251
    ds_read2_b32 v[222:223], v222 offset0:1 offset1:3
    v_add_u32 v224, s49, v251
    ds_read2_b32 v[224:225], v224 offset0:1 offset1:3
    v_add_u32 v226, s50, v251
    ds_read2_b32 v[226:227], v226 offset0:1 offset1:3
    s_waitcnt lgkmcnt(3)
    v_or_b32 v232, v232, v231
    v_or_b32 v233, v233, v231
    s_cmp_lg_u32 s34, 0
    s_cbranch_scc1 K2_dum_4
    s_cmp_eq_u32 s33, 4
    s_cbranch_scc1 K2_a4_5
K2_b4_7:
    s_add_u32 m0, s48, 512
    s_add_u32 s65, s48, 1536
    buffer_load_dwordx4 v232, s[16:19], 0 offen  lds
    s_mov_b32 m0, s65
    s_mov_b32 exec_hi, 0
    buffer_load_dwordx4 v233, s[16:19], 0 offen  lds
    s_mov_b32 exec_hi, -1
K2_back_6:
    s_waitcnt lgkmcnt(2)
    v_mad_u32_u16 v222, v222, s39, v248 op_sel:[1,0,0,0]
    v_mad_u32_u16 v223, v223, s39, v248 op_sel:[1,0,0,0]
    s_waitcnt lgkmcnt(1)
    v_mad_u32_u16 v224, v224, s39, v248 op_sel:[1,0,0,0]
    v_mad_u32_u16 v225, v225, s39, v248 op_sel:[1,0,0,0]
    s_waitcnt lgkmcnt(0)
    v_mad_u32_u16 v226, v226, s39, v248 op_sel:[1,0,0,0]
    v_mad_u32_u16 v227, v227, s39, v248 op_sel:[1,0,0,0]
    s_mov_b32 m0, s68
    s_nop 0
    buffer_load_dwordx4 v222, s[4:7], s44 offen sc1 lds
    buffer_load_dwordx4 v223, s[72:75], s44 offen offset:1024 sc1 lds
    s_mov_b32 m0, s69
    s_nop 0
    buffer_load_dwordx4 v224, s[4:7], s45 offen sc1 lds
    buffer_load_dwordx4 v225, s[72:75], s45 offen offset:1024 sc1 lds
    s_mov_b32 m0, s70
    s_nop 0
    buffer_load_dwordx4 v226, s[4:7], s46 offen sc1 lds
    buffer_load_dwordx4 v227, s[72:75], s46 offen offset:1024 sc1 lds
    s_mov_b32 m0, s71
    s_cmp_eq_u32 s33, 4
    s_cbranch_scc1 K2_g4_8
    buffer_load_dwordx4 v224, s[4:7], s47 offen sc1 lds
    buffer_load_dwordx4 v225, s[72:75], s47 offen offset:1024 sc1 lds
K2_back_9:
    v_add_u32 v249, s48, v249
    v_add_u32 v250, s48, v250
    v_bfe_u32 v192, v253, 18, 4
    s_sub_u32 s58, s22, 16
    v_cmp_le_u32 vcc, 6, v192
    v_cmp_gt_u32 s[60:61], s58, v176
    s_nop 0
    s_or_b64 vcc, vcc, s[60:61]
    v_mbcnt_lo_u32_b32 v192, vcc_lo, 0
    v_mbcnt_hi_u32_b32 v192, vcc_hi, v192
    s_bcnt1_i32_b64 s58, vcc
    v_sub_u32 v193, v176, v192
    v_add_u32 v193, s58, v193
    v_cndmask_b32 v192, v193, v192, vcc
    v_lshlrev_b32 v192, 2, v192
    ds_permute_b32 v193, v192, v176
    s_waitcnt lgkmcnt(0)
    v_lshl_or_b32 v253, v193, 22, v253
    s_waitcnt vmcnt(6)
    ds_read_b64_tr_b16 v[176:177], v246 offset:0
    ds_read_b64_tr_b16 v[178:179], v246 offset:1024
    ds_read_b64_tr_b16 v[180:181], v247 offset:0
    ds_read_b64_tr_b16 v[182:183], v247 offset:1024
    ds_read_b64_tr_b16 v[0:1], v249 offset:0
    ds_read_b64_tr_b16 v[2:3], v249 offset:32
    ds_read_u16_d16_hi v16, v250 offset:0
    ds_read_b64_tr_b16 v[4:5], v249 offset:512
    ds_read_b64_tr_b16 v[6:7], v249 offset:544
    ds_read_u16_d16_hi v17, v250 offset:128
    s_mov_b32 s29, s48
    s_mov_b32 s32, s31
    s_mov_b32 s30, s3
    s_mov_b32 s31, s35
    s_bfe_u32 s56, s3, 0x40012
    s_cmp_eq_u32 s56, 5
    s_cbranch_scc1 K2_U20
    s_cmp_eq_u32 s56, 6
    s_cbranch_scc1 K2_U3h0
    s_branch K2_DSP0
K2_PAD_H1:
    s_branch KS_HOP0
KS_HELP:
    s_mov_b32 s30, 0
    s_cmp_eq_u32 s20, 6
    s_cbranch_scc1 KS_RAW
    s_mov_b32 s30, 2
    s_cmp_ge_u32 s2, 170
    s_cbranch_scc1 KS_NOW
    s_mov_b32 s30, 1
    v_and_b32 v1, 15, v8
    v_lshrrev_b32 v3, 4, v8
    s_cmp_ge_u32 s2, 160
    s_cbranch_scc1 K1_WT
    s_cmp_ge_u32 s2, 64
    s_cbranch_scc1 K1_S1
    s_lshr_b32 s24, s2, 3
    s_and_b32 s25, s2, 7
    s_lshr_b32 s26, s25, 2
    s_bfe_u32 s27, s25, 0x10001
    s_and_b32 s28, s25, 1
    s_mov_b32 s60, s92
    s_and_b32 s61, s93, 0xffff
    s_mov_b32 s62, 65536
    s_mov_b32 s63, 0x20000
    s_branch K1_SC
K1_S1:
    s_sub_u32 s29, s2, 64
    s_mul_i32 s24, s29, 43
    s_lshr_b32 s24, s24, 9
    s_mul_i32 s25, s24, 12
    s_sub_u32 s25, s29, s25
    s_cmp_ge_u32 s25, 6
    s_cselect_b32 s26, 1, 0
    s_mul_i32 s27, s26, 6
    s_sub_u32 s27, s25, s27
    s_lshr_b32 s27, s27, 1
    s_and_b32 s28, s25, 1
    s_add_u32 s25, s25, 8
    s_mov_b32 s60, s94
    s_and_b32 s61, s95, 0xffff
    s_mov_b32 s62, 98304
    s_mov_b32 s63, 0x20000
K1_SC:
    s_lshl_b32 s27, s27, 7
    s_lshl_b32 s26, s26, 6
    s_lshl_b32 s28, s28, 4
    s_add_u32 s27, s27, s26
    s_add_u32 s27, s27, s28
    s_lshl_b32 s27, s27, 8
    s_lshl_b32 s26, s24, 5
    s_add_u32 s27, s27, s26
    s_add_u32 s29, s27, 8192
    v_lshlrev_b32 v3, 10, v3
    v_lshl_add_u32 v3, v1, 1, v3
    buffer_load_ushort v64, v3, s[60:63], s27 offen offset:0
    buffer_load_ushort v65, v3, s[60:63], s29 offen offset:0
    buffer_load_ushort v66, v3, s[60:63], s27 offen offset:256
    buffer_load_ushort v67, v3, s[60:63], s29 offen offset:256
    buffer_load_ushort v68, v3, s[60:63], s27 offen offset:512
    buffer_load_ushort v69, v3, s[60:63], s29 offen offset:512
    buffer_load_ushort v70, v3, s[60:63], s27 offen offset:768
    buffer_load_ushort v71, v3, s[60:63], s29 offen offset:768
    s_mul_i32 s24, s24, 20
    s_add_u32 s24, s24, s25
    s_lshl_b32 s24, s24, 10
    s_add_u32 s24, s24, 6946816
    s_branch K1_GO
K1_WT:
    s_sub_u32 s24, s2, 160
    s_lshr_b32 s27, s24, 1
    s_and_b32 s28, s24, 1
    s_lshl_b32 s27, s27, 8
    s_lshl_b32 s28, s28, 6
    s_add_u32 s27, s27, s28
    s_add_u32 s29, s27, 10240
    s_mov_b32 s60, s90
    s_and_b32 s61, s91, 0xffff
    s_mov_b32 s62, 20480
    s_mov_b32 s63, 0x20000
    v_and_b32 v1, 31, v8
    v_lshrrev_b32 v3, 5, v8
    v_mul_u32_u24 v3, 5120, v3
    v_lshl_add_u32 v3, v1, 1, v3
    buffer_load_ushort v64, v3, s[60:63], s27 offen offset:0
    buffer_load_ushort v65, v3, s[60:63], s27 offen offset:1280
    buffer_load_ushort v66, v3, s[60:63], s27 offen offset:2560
    buffer_load_ushort v67, v3, s[60:63], s27 offen offset:3840
    buffer_load_ushort v68, v3, s[60:63], s29 offen offset:0
    buffer_load_ushort v69, v3, s[60:63], s29 offen offset:1280
    buffer_load_ushort v70, v3, s[60:63], s29 offen offset:2560
    buffer_load_ushort v71, v3, s[60:63], s29 offen offset:3840
    s_lshl_b32 s24, s24, 10
    s_add_u32 s24, s24, 7110656
K1_GO:
KS_NOW:
    s_barrier
K2_PAD_H2:
    s_cbranch_execz KS_HOP0
    v_and_b32 v76, 31, v8
    v_lshrrev_b32 v77, 5, v8
    v_mov_b32 v80, 0
    v_mul_u32_u24 v77, 2080, v77
    v_mov_b32 v81, 0xffff0000
    v_lshl_add_u32 v78, v76, 4, v77
    v_mov_b32 v82, 0
    v_add_u32 v78, 65536, v78
    v_mov_b32 v83, v81
    v_add_u32 v79, 41600, v78
    ds_write_b128 v78, v[80:83] offset:0
    ds_write_b128 v78, v[80:83] offset:4160
    ds_write_b128 v78, v[80:83] offset:8320
    ds_write_b128 v78, v[80:83] offset:12480
    ds_write_b128 v78, v[80:83] offset:16640
    ds_write_b128 v78, v[80:83] offset:20800
    ds_write_b128 v78, v[80:83] offset:24960
    ds_write_b128 v78, v[80:83] offset:29120
    ds_write_b128 v78, v[80:83] offset:33280
    ds_write_b128 v78, v[80:83] offset:37440
    ds_write_b128 v79, v[80:83] offset:0
    ds_write_b128 v79, v[80:83] offset:4160
    ds_write_b128 v79, v[80:83] offset:8320
    ds_write_b128 v79, v[80:83] offset:12480
    ds_write_b128 v79, v[80:83] offset:16640
    ds_write_b128 v79, v[80:83] offset:20800
    ds_write_b128 v79, v[80:83] offset:24960
    ds_write_b128 v79, v[80:83] offset:29120
    ds_write_b128 v79, v[80:83] offset:33280
    ds_write_b128 v79, v[80:83] offset:37440
KS_FILL:
    v_mov_b32 v59, 163456
    s_barrier
    ds_read_b32 v59, v59
    s_waitcnt vmcnt(0) lgkmcnt(0)
    s_cmp_eq_u32 s30, 0
    s_cbranch_scc1 KS_B3
    s_cmp_eq_u32 s30, 2
    s_cbranch_scc1 KS_NOST
    v_lshl_or_b32 v40, v65, 16, v64
    v_lshl_or_b32 v41, v67, 16, v66
    v_lshl_or_b32 v42, v69, 16, v68
    v_lshl_or_b32 v43, v71, 16, v70
    buffer_store_dwordx4 v[40:43], v9, s[8:11], s24 offen sc1
KS_NOST:
    v_mov_b32 v62, 163460
    s_waitcnt lgkmcnt(0)
    s_barrier
    ds_read_b32 v62, v62
    s_lshl_b32 s24, s2, 2
    s_add_u32 s24, s24, 7176192
    s_mov_b64 exec, 1
    s_waitcnt vmcnt(0)
    buffer_store_dword v59, v6, s[8:11], s24 offen sc1
    s_mov_b64 exec, -1
    s_branch KS_JOIN
K2_PAD_H3:
    s_branch KS_HOP0
KS_RAW:
    s_cmp_lg_u32 s2, 0
    s_cbranch_scc1 KS_NOX
    s_mov_b32 s60, s98
    s_and_b32 s61, s99, 0xffff
    s_mov_b32 s62, 256
    s_mov_b32 s63, 0x20000
    s_getreg_b32 s24, hwreg(HW_REG_XCC_ID, 0, 1)
    s_add_u32 s24, s24, 1
    v_mov_b32 v10, s24
    v_mov_b32 v11, 0
    s_mov_b64 exec, 1
    buffer_atomic_cmpswap v[10:11], v6, s[60:63], 0 offen sc1
    s_mov_b64 exec, -1
KS_NOX:
    s_barrier
    s_mov_b32 s60, s90
    s_and_b32 s61, s91, 0xffff
    s_mov_b32 s62, 20480
    s_mov_b32 s63, 0x20000
    v_lshrrev_b32 v10, 3, v8
    v_and_b32 v11, 7, v8
    v_lshlrev_b32 v10, 8, v10
    v_lshl_add_u32 v10, v11, 4, v10
    s_mov_b32 m0, 24576
    s_movk_i32 s24, 0
    buffer_load_dwordx4 v10, s[60:63], s24 offen lds
    s_mov_b32 m0, 25600
    s_movk_i32 s24, 2048
    buffer_load_dwordx4 v10, s[60:63], s24 offen lds
    s_mov_b32 m0, 26624
    s_movk_i32 s24, 4096
    buffer_load_dwordx4 v10, s[60:63], s24 offen lds
    s_mov_b32 m0, 27648
    s_movk_i32 s24, 6144
    buffer_load_dwordx4 v10, s[60:63], s24 offen lds
    s_mov_b32 m0, 28672
    s_movk_i32 s24, 8192
    buffer_load_dwordx4 v10, s[60:63], s24 offen lds
    s_mov_b32 m0, 29696
    s_movk_i32 s24, 10240
    buffer_load_dwordx4 v10, s[60:63], s24 offen lds
    s_mov_b32 m0, 30720
    s_movk_i32 s24, 12288
    buffer_load_dwordx4 v10, s[60:63], s24 offen lds
    s_mov_b32 m0, 31744
    s_movk_i32 s24, 14336
    buffer_load_dwordx4 v10, s[60:63], s24 offen lds
    s_mov_b32 m0, 32768
    s_movk_i32 s24, 16384
    buffer_load_dwordx4 v10, s[60:63], s24 offen lds
    s_mov_b32 m0, 33792
    s_movk_i32 s24, 18432
    buffer_load_dwordx4 v10, s[60:63], s24 offen lds
    s_mov_b32 m0, 152832
    s_movk_i32 s24, 128
    buffer_load_dwordx4 v10, s[60:63], s24 offen lds
    s_mov_b32 m0, 153856
    s_movk_i32 s24, 2176
    buffer_load_dwordx4 v10, s[60:63], s24 offen lds
    s_mov_b32 m0, 154880
    s_movk_i32 s24, 4224
    buffer_load_dwordx4 v10, s[60:63], s24 offen lds
    s_mov_b32 m0, 155904
    s_movk_i32 s24, 6272
    buffer_load_dwordx4 v10, s[60:63], s24 offen lds
    s_mov_b32 m0, 156928
    s_movk_i32 s24, 8320
    buffer_load_dwordx4 v10, s[60:63], s24 offen lds
    s_mov_b32 m0, 157952
    s_movk_i32 s24, 10368
    buffer_load_dwordx4 v10, s[60:63], s24 offen lds
    s_mov_b32 m0, 158976
    s_movk_i32 s24, 12416
    buffer_load_dwordx4 v10, s[60:63], s24 offen lds
    s_mov_b32 m0, 160000
    s_movk_i32 s24, 14464
    buffer_load_dwordx4 v10, s[60:63], s24 offen lds
    s_mov_b32 m0, 161024
    s_movk_i32 s24, 16512
    buffer_load_dwordx4 v10, s[60:63], s24 offen lds
    s_mov_b32 m0, 162048
    s_movk_i32 s24, 18560
    buffer_load_dwordx4 v10, s[60:63], s24 offen lds
    v_add_u32 v85, 16, v8
    v_lshlrev_b32 v84, 5, v8
    v_lshrrev_b32 v85, 6, v85
    v_mul_u32_u24 v85, 1532, v85
    v_sub_u32 v84, v84, v85
    v_mov_b32 v85, -1
    v_add_u32 v84, 66048, v84
    v_add_u32 v86, 41600, v84
    ds_write_b32 v84, v85 offset:0
    ds_write_b32 v84, v85 offset:2080
    ds_write_b32 v84, v85 offset:4160
    ds_write_b32 v84, v85 offset:6240
    ds_write_b32 v84, v85 offset:8320
    ds_write_b32 v84, v85 offset:10400
    ds_write_b32 v84, v85 offset:12480
    ds_write_b32 v84, v85 offset:14560
    ds_write_b32 v84, v85 offset:16640
    ds_write_b32 v84, v85 offset:18720
    ds_write_b32 v84, v85 offset:20800
    ds_write_b32 v84, v85 offset:22880
    ds_write_b32 v84, v85 offset:24960
    ds_write_b32 v84, v85 offset:27040
    ds_write_b32 v84, v85 offset:29120
    ds_write_b32 v84, v85 offset:31200
    ds_write_b32 v84, v85 offset:33280
    ds_write_b32 v84, v85 offset:35360
    ds_write_b32 v84, v85 offset:37440
    ds_write_b32 v84, v85 offset:39520
    ds_write_b32 v86, v85 offset:0
    ds_write_b32 v86, v85 offset:2080
    ds_write_b32 v86, v85 offset:4160
    ds_write_b32 v86, v85 offset:6240
    ds_write_b32 v86, v85 offset:8320
    ds_write_b32 v86, v85 offset:10400
    ds_write_b32 v86, v85 offset:12480
    ds_write_b32 v86, v85 offset:14560
    ds_write_b32 v86, v85 offset:16640
    ds_write_b32 v86, v85 offset:18720
    ds_write_b32 v86, v85 offset:20800
    ds_write_b32 v86, v85 offset:22880
    ds_write_b32 v86, v85 offset:24960
    ds_write_b32 v86, v85 offset:27040
    ds_write_b32 v86, v85 offset:29120
    ds_write_b32 v86, v85 offset:31200
    ds_write_b32 v86, v85 offset:33280
    ds_write_b32 v86, v85 offset:35360
    ds_write_b32 v86, v85 offset:37440
    ds_write_b32 v86, v85 offset:39520
    s_branch KS_FILL
KS_IDLE:
    s_barrier
    s_barrier
    s_branch KS_B3
K2_PAD_U20:
    s_branch K2_HOP
K2_U20:
    s_setprio 1
    s_waitcnt lgkmcnt(0)
    v_lshlrev_b32 v20, 16, v0
    v_and_b32 v21, 0xffff0000, v0
    v_lshlrev_b32 v22, 16, v1
    v_and_b32 v23, 0xffff0000, v1
    v_lshlrev_b32 v24, 16, v2
    v_and_b32 v25, 0xffff0000, v2
    v_lshlrev_b32 v26, 16, v3
    v_and_b32 v27, 0xffff0000, v3
    v_mul_f32_dpp v36, v16, v20 row_newbcast:8 row_mask:0xf bank_mask:0xf
    v_mul_f32_dpp v37, v16, v21 row_newbcast:9 row_mask:0xf bank_mask:0xf
    v_mul_f32_dpp v38, v16, v22 row_newbcast:10 row_mask:0xf bank_mask:0xf
    v_mul_f32_dpp v39, v16, v23 row_newbcast:11 row_mask:0xf bank_mask:0xf
    v_mul_f32_dpp v40, v16, v24 row_newbcast:12 row_mask:0xf bank_mask:0xf
    v_mul_f32_dpp v41, v16, v25 row_newbcast:13 row_mask:0xf bank_mask:0xf
    v_mul_f32_dpp v42, v16, v26 row_newbcast:14 row_mask:0xf bank_mask:0xf
    v_mul_f32_dpp v43, v16, v27 row_newbcast:15 row_mask:0xf bank_mask:0xf
    v_cvt_pk_bf16_f32 v68, v36, v37
    v_cvt_pk_bf16_f32 v69, v38, v39
    v_cvt_pk_bf16_f32 v70, v40, v41
    v_cvt_pk_bf16_f32 v71, v42, v43
    v_mul_f32_dpp v20, v16, v20 row_newbcast:0 row_mask:0xa bank_mask:0xf
    v_mul_f32_dpp v21, v16, v21 row_newbcast:1 row_mask:0xa bank_mask:0xf
    v_mul_f32_dpp v22, v16, v22 row_newbcast:2 row_mask:0xa bank_mask:0xf
    v_mul_f32_dpp v23, v16, v23 row_newbcast:3 row_mask:0xa bank_mask:0xf
    v_mul_f32_dpp v24, v16, v24 row_newbcast:4 row_mask:0xa bank_mask:0xf
    v_mul_f32_dpp v25, v16, v25 row_newbcast:5 row_mask:0xa bank_mask:0xf
    v_mul_f32_dpp v26, v16, v26 row_newbcast:6 row_mask:0xa bank_mask:0xf
    v_mul_f32_dpp v27, v16, v27 row_newbcast:7 row_mask:0xa bank_mask:0xf
    v_cvt_pk_bf16_f32 v64, v20, v21
    v_cvt_pk_bf16_f32 v65, v22, v23
    v_cvt_pk_bf16_f32 v66, v24, v25
    v_cvt_pk_bf16_f32 v67, v26, v27
    v_lshlrev_b32 v28, 16, v4
    v_and_b32 v29, 0xffff0000, v4
    v_lshlrev_b32 v30, 16, v5
    v_and_b32 v31, 0xffff0000, v5
    v_lshlrev_b32 v32, 16, v6
    v_and_b32 v33, 0xffff0000, v6
    v_lshlrev_b32 v34, 16, v7
    v_and_b32 v35, 0xffff0000, v7
    v_mul_f32_dpp v36, v17, v28 row_newbcast:8 row_mask:0xf bank_mask:0xf
    v_mul_f32_dpp v37, v17, v29 row_newbcast:9 row_mask:0xf bank_mask:0xf
    v_mul_f32_dpp v38, v17, v30 row_newbcast:10 row_mask:0xf bank_mask:0xf
    v_mul_f32_dpp v39, v17, v31 row_newbcast:11 row_mask:0xf bank_mask:0xf
    v_mul_f32_dpp v40, v17, v32 row_newbcast:12 row_mask:0xf bank_mask:0xf
    v_mul_f32_dpp v41, v17, v33 row_newbcast:13 row_mask:0xf bank_mask:0xf
    v_mul_f32_dpp v42, v17, v34 row_newbcast:14 row_mask:0xf bank_mask:0xf
    v_mul_f32_dpp v43, v17, v35 row_newbcast:15 row_mask:0xf bank_mask:0xf
    v_cvt_pk_bf16_f32 v76, v36, v37
    v_cvt_pk_bf16_f32 v77, v38, v39
    v_cvt_pk_bf16_f32 v78, v40, v41
    v_cvt_pk_bf16_f32 v79, v42, v43
    v_mul_f32_dpp v28, v17, v28 row_newbcast:0 row_mask:0xa bank_mask:0xf
    v_mul_f32_dpp v29, v17, v29 row_newbcast:1 row_mask:0xa bank_mask:0xf
    v_mul_f32_dpp v30, v17, v30 row_newbcast:2 row_mask:0xa bank_mask:0xf
    v_mul_f32_dpp v31, v17, v31 row_newbcast:3 row_mask:0xa bank_mask:0xf
    v_mul_f32_dpp v32, v17, v32 row_newbcast:4 row_mask:0xa bank_mask:0xf
    v_mul_f32_dpp v33, v17, v33 row_newbcast:5 row_mask:0xa bank_mask:0xf
    v_mul_f32_dpp v34, v17, v34 row_newbcast:6 row_mask:0xa bank_mask:0xf
    v_mul_f32_dpp v35, v17, v35 row_newbcast:7 row_mask:0xa bank_mask:0xf
    v_cvt_pk_bf16_f32 v72, v28, v29
    v_cvt_pk_bf16_f32 v73, v30, v31
    v_cvt_pk_bf16_f32 v74, v32, v33
    v_cvt_pk_bf16_f32 v75, v34, v35
    s_waitcnt vmcnt(4)
    v_mfma_f32_32x32x16_bf16 v[0:15], v[64:67], v[176:179], 0
    ds_read_b64_tr_b16 v[184:185], v246 offset:2048
    ds_read_b64_tr_b16 v[186:187], v246 offset:3072
    ds_read_b64_tr_b16 v[188:189], v247 offset:2048
    ds_read_b64_tr_b16 v[190:191], v247 offset:3072
    s_mov_b32 m0, s68
    v_mfma_f32_32x32x16_bf16 v[16:31], v[68:71], v[176:179], 0
    buffer_load_dwordx4 v222, s[4:7], s42 offen sc1 lds
    buffer_load_dwordx4 v223, s[72:75], s42 offen offset:1024 sc1 lds
    v_permlane32_swap_b32 v242, v236
    v_permlane32_swap_b32 v243, v237
    s_add_u32 s38, s38, 1
    v_mfma_f32_32x32x16_bf16 v[32:47], v[64:67], v[180:183], 0
    v_permlane32_swap_b32 v244, v238
    v_permlane32_swap_b32 v245, v239
    v_permlane32_swap_b32 v240, v241
    v_add_f32 v242, v242, v236
    v_mfma_f32_32x32x16_bf16 v[48:63], v[68:71], v[180:183], 0
    v_add_f32 v243, v243, v237
    v_add_f32 v244, v244, v238
    v_add_f32 v245, v245, v239
    v_add_f32 v240, -v240, -v241
    v_mov_b32 v254, s52
    v_mov_b32 v255, s38
    s_waitcnt vmcnt(4) lgkmcnt(0)
    v_mfma_f32_32x32x16_bf16 v[0:15], v[72:75], v[184:187], v[0:15]
    ds_read_b64_tr_b16 v[176:177], v246 offset:4096
    ds_read_b64_tr_b16 v[178:179], v246 offset:5120
    ds_read_b64_tr_b16 v[180:181], v247 offset:4096
    ds_read_b64_tr_b16 v[182:183], v247 offset:5120
    s_lshl_b32 s58, s38, 3
    s_add_u32 s58, s58, s20
    s_mov_b32 m0, s69
    v_mfma_f32_32x32x16_bf16 v[16:31], v[76:79], v[184:187], v[16:31]
    buffer_load_dwordx4 v224, s[4:7], s42 offen sc1 lds
    buffer_load_dwordx4 v225, s[72:75], s42 offen offset:1024 sc1 lds
    s_set_gpr_idx_on s32, gpr_idx(DST)
    s_nop 0
    v_cvt_pk_bf16_f32 v195, v242, v243
    v_cvt_pk_bf16_f32 v196, v244, v245
    v_cvt_pk_bf16_f32 v197, v240, v240
    s_set_gpr_idx_off
    s_mov_b64 exec, 1
    ds_write_b32 v254, v255
    s_mov_b64 exec, -1
    s_cmp_lt_u32 s58, s22
    s_cbranch_scc0 K2_dyn_10
K2_back_11:
    v_readlane_b32 s3, v253, s58
    s_lshl_b32 s44, s34, 7
    s_and_b32 s48, s3, 0x3ffff
    s_bfe_u32 s33, s3, 0x30013
    s_mul_i32 s35, s38, 6
    s_cmp_eq_u32 s34, 0
    s_cselect_b32 s35, s35, s48
    s_mov_b32 s45, s44
    s_xor_b32 s47, s44, 256
    s_add_u32 s49, s48, 128
    s_add_u32 s60, s48, 256
    s_cmp_eq_u32 s33, 3
    s_cselect_b32 s46, s44, s47
    s_cselect_b32 s50, s60, s48
    s_sub_u32 s60, s33, 2
    s_cmp_lt_u32 s60, 2
    s_cbranch_scc0 K2_rare_16
K2_back_17:
    v_mfma_f32_32x32x16_bf16 v[32:47], v[72:75], v[188:191], v[32:47]
    v_add_u32 v233, s48, v230
    ds_read_b32 v232, v233
    ds_read_b32 v233, v233 offset:1024
    v_mul_f32 v234, v0, v96
    v_mul_f32 v236, v8, v128
    v_fmac_f32 v234, v1, v97
    v_fmac_f32 v236, v9, v129
    v_mfma_f32_32x32x16_bf16 v[48:63], v[76:79], v[188:191], v[48:63]
    s_setprio 0
    v_fmac_f32 v234, v2, v98
    v_fmac_f32 v236, v10, v130
    v_fmac_f32 v234, v3, v99
    v_fmac_f32 v236, v11, v131
    v_fmac_f32 v234, v4, v100
    v_fmac_f32 v236, v12, v132
    v_fmac_f32 v234, v5, v101
    v_fmac_f32 v236, v13, v133
    v_fmac_f32 v234, v6, v102
    v_fmac_f32 v236, v14, v134
    v_fmac_f32 v234, v7, v103
    v_fmac_f32 v236, v15, v135
    v_mul_f32 v238, v16, v128
    v_mul_f32 v240, v24, v128
    v_fmac_f32 v238, v17, v129
    v_fmac_f32 v240, v25, v129
    v_fmac_f32 v238, v18, v130
    v_fmac_f32 v240, v26, v130
    v_fmac_f32 v238, v19, v131
    v_fmac_f32 v240, v27, v131
    v_fmac_f32 v238, v20, v132
    v_fmac_f32 v240, v28, v132
    v_fmac_f32 v238, v21, v133
    v_fmac_f32 v240, v29, v133
    v_fmac_f32 v238, v22, v134
    v_fmac_f32 v240, v30, v134
    v_fmac_f32 v238, v23, v135
    v_fmac_f32 v240, v31, v135
    v_mul_f32 v235, v32, v104
    v_mul_f32 v237, v40, v136
    v_fmac_f32 v235, v33, v105
    v_fmac_f32 v237, v41, v137
    v_fmac_f32 v235, v34, v106
    v_fmac_f32 v237, v42, v138
    v_fmac_f32 v235, v35, v107
    v_fmac_f32 v237, v43, v139
    v_fmac_f32 v235, v36, v108
    v_fmac_f32 v237, v44, v140
    v_fmac_f32 v235, v37, v109
    v_fmac_f32 v237, v45, v141
    v_fmac_f32 v235, v38, v110
    v_fmac_f32 v237, v46, v142
    v_fmac_f32 v235, v39, v111
    v_fmac_f32 v237, v47, v143
    v_mul_f32 v239, v48, v136
    v_mul_f32 v241, v56, v136
    v_fmac_f32 v239, v49, v137
    v_fmac_f32 v241, v57, v137
    s_setprio 1
    s_waitcnt vmcnt(4) lgkmcnt(3)
    v_mfma_f32_32x32x16_bf16 v[0:15], v[64:67], v[176:179], 0
    ds_read_b64_tr_b16 v[184:185], v246 offset:6144
    ds_read_b64_tr_b16 v[186:187], v246 offset:7168
    ds_read_b64_tr_b16 v[188:189], v247 offset:6144
    ds_read_b64_tr_b16 v[190:191], v247 offset:7168
    v_fmac_f32 v239, v50, v138
    v_fmac_f32 v241, v58, v138
    s_mov_b32 m0, s70
    v_mfma_f32_32x32x16_bf16 v[16:31], v[68:71], v[176:179], 0
    buffer_load_dwordx4 v222, s[4:7], s43 offen sc1 lds
    buffer_load_dwordx4 v223, s[72:75], s43 offen offset:1024 sc1 lds
    v_fmac_f32 v239, v51, v139
    v_fmac_f32 v241, v59, v139
    v_fmac_f32 v239, v52, v140
    v_fmac_f32 v241, v60, v140
    v_fmac_f32 v239, v53, v141
    v_mfma_f32_32x32x16_bf16 v[32:47], v[64:67], v[180:183], 0
    v_add_u32 v222, s48, v251
    ds_read2_b32 v[222:223], v222 offset0:1 offset1:3
    v_fmac_f32 v241, v61, v141
    v_fmac_f32 v239, v54, v142
    v_fmac_f32 v241, v62, v142
    v_fmac_f32 v239, v55, v143
    v_fmac_f32 v241, v63, v143
    v_mfma_f32_32x32x16_bf16 v[48:63], v[68:71], v[180:183], 0
    v_permlane32_swap_b32 v234, v236
    v_permlane32_swap_b32 v235, v237
    v_permlane32_swap_b32 v240, v238
    s_waitcnt lgkmcnt(5)
    v_or_b32 v232, v232, v231
    v_or_b32 v233, v233, v231
    s_cmp_lg_u32 s34, 0
    s_cbranch_scc1 K2_dum_21
    s_cmp_eq_u32 s33, 4
    s_cbranch_scc1 K2_a4_22
K2_b4_24:
    s_add_u32 m0, s48, 512
    s_add_u32 s65, s48, 1536
    buffer_load_dwordx4 v232, s[16:19], 0 offen  lds
    s_mov_b32 m0, s65
    s_mov_b32 exec_hi, 0
    buffer_load_dwordx4 v233, s[16:19], 0 offen  lds
    s_mov_b32 exec_hi, -1
K2_back_23:
    s_waitcnt vmcnt(6) lgkmcnt(1)
    v_mfma_f32_32x32x16_bf16 v[0:15], v[72:75], v[184:187], v[0:15]
    ds_read_b64_tr_b16 v[176:177], v246 offset:0
    ds_read_b64_tr_b16 v[178:179], v246 offset:1024
    ds_read_b64_tr_b16 v[180:181], v247 offset:0
    ds_read_b64_tr_b16 v[182:183], v247 offset:1024
    v_permlane32_swap_b32 v241, v239
    s_mov_b32 m0, s71
    v_mfma_f32_32x32x16_bf16 v[16:31], v[76:79], v[184:187], v[16:31]
    buffer_load_dwordx4 v224, s[4:7], s43 offen sc1 lds
    buffer_load_dwordx4 v225, s[72:75], s43 offen offset:1024 sc1 lds
    s_waitcnt lgkmcnt(4)
    v_mad_u32_u16 v222, v222, s39, v248 op_sel:[1,0,0,0]
    v_mad_u32_u16 v223, v223, s39, v248 op_sel:[1,0,0,0]
    v_add_f32 v234, v234, v236
    v_add_f32 v235, v235, v237
    v_add_f32 v240, v240, v238
    v_add_f32 v241, v241, v239
    s_set_gpr_idx_on s31, gpr_idx(DST)
    s_nop 0
    v_cvt_pk_bf16_f32 v192, v234, v235
    v_cvt_pk_bf16_f32 v193, v240, v241
    s_set_gpr_idx_off
    v_mfma_f32_32x32x16_bf16 v[32:47], v[72:75], v[188:191], v[32:47]
    v_add_u32 v224, s49, v251
    ds_read2_b32 v[224:225], v224 offset0:1 offset1:3
    v_mul_f32 v234, v0, v144
    v_mul_f32 v236, v8, v112
    v_fmac_f32 v234, v1, v145
    v_fmac_f32 v236, v9, v113
    v_fmac_f32 v234, v2, v146
    v_mfma_f32_32x32x16_bf16 v[48:63], v[76:79], v[188:191], v[48:63]
    s_setprio 0
    v_fmac_f32 v236, v10, v114
    v_fmac_f32 v234, v3, v147
    v_fmac_f32 v236, v11, v115
    v_fmac_f32 v234, v4, v148
    v_fmac_f32 v236, v12, v116
    v_fmac_f32 v234, v5, v149
    v_fmac_f32 v236, v13, v117
    v_fmac_f32 v234, v6, v150
    v_fmac_f32 v236, v14, v118
    v_fmac_f32 v234, v7, v151
    v_fmac_f32 v236, v15, v119
    v_mul_f32 v238, v16, v160
    v_mul_f32 v240, v24, v160
    v_fmac_f32 v238, v17, v161
    v_fmac_f32 v240, v25, v161
    v_fmac_f32 v238, v18, v162
    v_fmac_f32 v240, v26, v162
    v_fmac_f32 v238, v19, v163
    v_fmac_f32 v240, v27, v163
    v_fmac_f32 v238, v20, v164
    v_fmac_f32 v240, v28, v164
    v_fmac_f32 v238, v21, v165
    v_fmac_f32 v240, v29, v165
    v_fmac_f32 v238, v22, v166
    v_fmac_f32 v240, v30, v166
    v_fmac_f32 v238, v23, v167
    v_fmac_f32 v240, v31, v167
    v_mul_f32 v235, v32, v152
    v_mul_f32 v237, v40, v120
    v_fmac_f32 v235, v33, v153
    v_fmac_f32 v237, v41, v121
    v_fmac_f32 v235, v34, v154
    v_fmac_f32 v237, v42, v122
    v_fmac_f32 v235, v35, v155
    v_fmac_f32 v237, v43, v123
    v_fmac_f32 v235, v36, v156
    v_fmac_f32 v237, v44, v124
    v_fmac_f32 v235, v37, v157
    v_fmac_f32 v237, v45, v125
    v_fmac_f32 v235, v38, v158
    v_fmac_f32 v237, v46, v126
    v_fmac_f32 v235, v39, v159
    v_fmac_f32 v237, v47, v127
    v_mul_f32 v239, v48, v168
    v_mul_f32 v241, v56, v168
    v_fmac_f32 v239, v49, v169
    v_fmac_f32 v241, v57, v169
    v_fmac_f32 v239, v50, v170
    v_fmac_f32 v241, v58, v170
    v_fmac_f32 v239, v51, v171
    s_setprio 1
    s_waitcnt vmcnt(6) lgkmcnt(1)
    v_mfma_f32_32x32x16_bf16 v[0:15], v[64:67], v[176:179], 0
    ds_read_b64_tr_b16 v[184:185], v246 offset:2048
    ds_read_b64_tr_b16 v[186:187], v246 offset:3072
    ds_read_b64_tr_b16 v[188:189], v247 offset:2048
    ds_read_b64_tr_b16 v[190:191], v247 offset:3072
    v_fmac_f32 v241, v59, v171
    v_fmac_f32 v239, v52, v172
    s_mov_b32 m0, s68
    v_mfma_f32_32x32x16_bf16 v[16:31], v[68:71], v[176:179], 0
    buffer_load_dwordx4 v222, s[4:7], s44 offen sc1 lds
    buffer_load_dwordx4 v223, s[72:75], s44 offen offset:1024 sc1 lds
    s_waitcnt lgkmcnt(4)
    v_mad_u32_u16 v224, v224, s39, v248 op_sel:[1,0,0,0]
    v_mad_u32_u16 v225, v225, s39, v248 op_sel:[1,0,0,0]
    v_fmac_f32 v241, v60, v172
    v_fmac_f32 v239, v53, v173
    v_mfma_f32_32x32x16_bf16 v[32:47], v[64:67], v[180:183], 0
    v_add_u32 v226, s50, v251
    ds_read2_b32 v[226:227], v226 offset0:1 offset1:3
    v_fmac_f32 v241, v61, v173
    v_fmac_f32 v239, v54, v174
    v_fmac_f32 v241, v62, v174
    v_fmac_f32 v239, v55, v175
    v_fmac_f32 v241, v63, v175
    v_mfma_f32_32x32x16_bf16 v[48:63], v[68:71], v[180:183], 0
    s_waitcnt vmcnt(6) lgkmcnt(1)
    v_mfma_f32_32x32x16_bf16 v[0:15], v[72:75], v[184:187], v[0:15]
    ds_read_b64_tr_b16 v[176:177], v246 offset:4096
    ds_read_b64_tr_b16 v[178:179], v246 offset:5120
    ds_read_b64_tr_b16 v[180:181], v247 offset:4096
    ds_read_b64_tr_b16 v[182:183], v247 offset:5120
    s_mov_b32 m0, s69
    v_mfma_f32_32x32x16_bf16 v[16:31], v[76:79], v[184:187], v[16:31]
    buffer_load_dwordx4 v224, s[4:7], s45 offen sc1 lds
    buffer_load_dwordx4 v225, s[72:75], s45 offen offset:1024 sc1 lds
    s_waitcnt lgkmcnt(4)
    v_mad_u32_u16 v226, v226, s39, v248 op_sel:[1,0,0,0]
    v_mad_u32_u16 v227, v227, s39, v248 op_sel:[1,0,0,0]
    v_mfma_f32_32x32x16_bf16 v[32:47], v[72:75], v[188:191], v[32:47]
    v_mul_f32 v242, v0, v144
    v_fma_f32 v238, v8, v160, -v238
    v_fmac_f32 v242, v1, v145
    v_fmac_f32 v238, v9, v161
    v_fmac_f32 v242, v2, v146
    v_fmac_f32 v238, v10, v162
    v_fmac_f32 v242, v3, v147
    v_mfma_f32_32x32x16_bf16 v[48:63], v[76:79], v[188:191], v[48:63]
    s_setprio 0
    v_fmac_f32 v238, v11, v163
    v_fmac_f32 v242, v4, v148
    v_fmac_f32 v238, v12, v164
    v_fmac_f32 v242, v5, v149
    v_fmac_f32 v238, v13, v165
    v_fmac_f32 v242, v6, v150
    v_fmac_f32 v238, v14, v166
    v_fmac_f32 v242, v7, v151
    v_fmac_f32 v238, v15, v167
    v_fmac_f32 v236, v16, v112
    v_mul_f32 v244, v24, v160
    v_fmac_f32 v236, v17, v113
    v_fmac_f32 v244, v25, v161
    v_fmac_f32 v236, v18, v114
    v_fmac_f32 v244, v26, v162
    v_fmac_f32 v236, v19, v115
    v_fmac_f32 v244, v27, v163
    v_fmac_f32 v236, v20, v116
    v_fmac_f32 v244, v28, v164
    v_fmac_f32 v236, v21, v117
    v_fmac_f32 v244, v29, v165
    v_fmac_f32 v236, v22, v118
    v_fmac_f32 v244, v30, v166
    v_fmac_f32 v236, v23, v119
    v_fmac_f32 v244, v31, v167
    v_mul_f32 v243, v32, v152
    v_fma_f32 v239, v40, v168, -v239
    v_fmac_f32 v243, v33, v153
    v_fmac_f32 v239, v41, v169
    v_fmac_f32 v243, v34, v154
    v_fmac_f32 v239, v42, v170
    v_fmac_f32 v243, v35, v155
    v_fmac_f32 v239, v43, v171
    v_fmac_f32 v243, v36, v156
    v_fmac_f32 v239, v44, v172
    v_fmac_f32 v243, v37, v157
    v_fmac_f32 v239, v45, v173
    v_fmac_f32 v243, v38, v158
    v_fmac_f32 v239, v46, v174
    v_fmac_f32 v243, v39, v159
    v_fmac_f32 v239, v47, v175
    v_fmac_f32 v237, v48, v120
    v_mul_f32 v245, v56, v168
    s_setprio 1
    s_waitcnt vmcnt(4) lgkmcnt(0)
    v_mfma_f32_32x32x16_bf16 v[0:15], v[64:67], v[176:179], 0
    ds_read_b64_tr_b16 v[184:185], v246 offset:6144
    ds_read_b64_tr_b16 v[186:187], v246 offset:7168
    ds_read_b64_tr_b16 v[188:189], v247 offset:6144
    ds_read_b64_tr_b16 v[190:191], v247 offset:7168
    v_fmac_f32 v237, v49, v121
    v_fmac_f32 v245, v57, v169
    s_mov_b32 m0, s70
    v_mfma_f32_32x32x16_bf16 v[16:31], v[68:71], v[176:179], 0
    buffer_load_dwordx4 v226, s[4:7], s46 offen sc1 lds
    buffer_load_dwordx4 v227, s[72:75], s46 offen offset:1024 sc1 lds
    v_fmac_f32 v237, v50, v122
    v_fmac_f32 v245, v58, v170
    v_fmac_f32 v237, v51, v123
    v_fmac_f32 v245, v59, v171
    v_fmac_f32 v237, v52, v124
    v_mfma_f32_32x32x16_bf16 v[32:47], v[64:67], v[180:183], 0
    v_fmac_f32 v245, v60, v172
    v_fmac_f32 v237, v53, v125
    v_fmac_f32 v245, v61, v173
    v_fmac_f32 v237, v54, v126
    v_fmac_f32 v245, v62, v174
    v_fmac_f32 v237, v55, v127
    v_fmac_f32 v245, v63, v175
    v_mfma_f32_32x32x16_bf16 v[48:63], v[68:71], v[180:183], 0
    v_permlane32_swap_b32 v242, v234
    v_permlane32_swap_b32 v243, v235
    v_add_f32 v242, v242, v234
    v_add_f32 v243, v243, v235
    s_waitcnt vmcnt(4) lgkmcnt(0)
    v_mfma_f32_32x32x16_bf16 v[0:15], v[72:75], v[184:187], v[0:15]
    ds_read_b64_tr_b16 v[176:177], v246 offset:0
    ds_read_b64_tr_b16 v[178:179], v246 offset:1024
    ds_read_b64_tr_b16 v[180:181], v247 offset:0
    ds_read_b64_tr_b16 v[182:183], v247 offset:1024
    s_sub_u32 s26, s48, s29
    s_mov_b32 s29, s48
    s_mov_b32 m0, s71
    v_mfma_f32_32x32x16_bf16 v[16:31], v[76:79], v[184:187], v[16:31]
    s_cmp_eq_u32 s33, 4
    s_cbranch_scc1 K2_g4_19
    buffer_load_dwordx4 v224, s[4:7], s47 offen sc1 lds
    buffer_load_dwordx4 v225, s[72:75], s47 offen offset:1024 sc1 lds
K2_back_20:
    s_set_gpr_idx_on s31, gpr_idx(DST)
    s_nop 0
    v_cvt_pk_bf16_f32 v194, v242, v243
    s_set_gpr_idx_off
    s_mov_b32 s30, s3
    s_bfe_u32 s56, s3, 0x40012
    s_cmp_eq_u32 s34, 0
    s_cselect_b32 s56, s56, 0
    v_mfma_f32_32x32x16_bf16 v[32:47], v[72:75], v[188:191], v[32:47]
    s_mov_b32 s32, s31
    s_mov_b32 s31, s35
    v_mul_f32 v242, v0, v144
    v_fma_f32 v240, v8, v160, -v240
    v_fmac_f32 v242, v1, v145
    v_fmac_f32 v240, v9, v161
    v_fmac_f32 v242, v2, v146
    v_mfma_f32_32x32x16_bf16 v[48:63], v[76:79], v[188:191], v[48:63]
    s_setprio 0
    v_fmac_f32 v240, v10, v162
    v_fmac_f32 v242, v3, v147
    v_fmac_f32 v240, v11, v163
    v_fmac_f32 v242, v4, v148
    v_fmac_f32 v240, v12, v164
    v_fmac_f32 v242, v5, v149
    v_fmac_f32 v240, v13, v165
    v_fmac_f32 v242, v6, v150
    v_fmac_f32 v240, v14, v166
    v_fmac_f32 v242, v7, v151
    v_fmac_f32 v240, v15, v167
    v_add_u32 v249, s26, v249
    v_add_u32 v250, s26, v250
    v_fma_f32 v244, v16, v160, -v244
    v_fmac_f32 v236, v24, v112
    v_fmac_f32 v244, v17, v161
    v_fmac_f32 v236, v25, v113
    v_fmac_f32 v244, v18, v162
    v_fmac_f32 v236, v26, v114
    v_fmac_f32 v244, v19, v163
    v_fmac_f32 v236, v27, v115
    v_fmac_f32 v244, v20, v164
    v_fmac_f32 v236, v28, v116
    v_fmac_f32 v244, v21, v165
    v_fmac_f32 v236, v29, v117
    v_fmac_f32 v244, v22, v166
    v_fmac_f32 v236, v30, v118
    v_fmac_f32 v244, v23, v167
    v_fmac_f32 v236, v31, v119
    ds_read_b64_tr_b16 v[0:1], v249 offset:0
    ds_read_b64_tr_b16 v[2:3], v249 offset:32
    ds_read_u16_d16_hi v16, v250 offset:0
    v_mul_f32 v243, v32, v152
    v_fma_f32 v241, v40, v168, -v241
    v_fmac_f32 v243, v33, v153
    v_fmac_f32 v241, v41, v169
    v_fmac_f32 v243, v34, v154
    v_fmac_f32 v241, v42, v170
    v_fmac_f32 v243, v35, v155
    v_fmac_f32 v241, v43, v171
    v_fmac_f32 v243, v36, v156
    v_fmac_f32 v241, v44, v172
    v_fmac_f32 v243, v37, v157
    v_fmac_f32 v241, v45, v173
    v_fmac_f32 v243, v38, v158
    v_fmac_f32 v241, v46, v174
    v_fmac_f32 v243, v39, v159
    v_fmac_f32 v241, v47, v175
    ds_read_b64_tr_b16 v[4:5], v249 offset:512
    ds_read_b64_tr_b16 v[6:7], v249 offset:544
    ds_read_u16_d16_hi v17, v250 offset:128
    v_fma_f32 v245, v48, v168, -v245
    v_fmac_f32 v237, v56, v120
    v_fmac_f32 v245, v49, v169
    v_fmac_f32 v237, v57, v121
    v_fmac_f32 v245, v50, v170
    v_fmac_f32 v237, v58, v122
    v_fmac_f32 v245, v51, v171
    v_fmac_f32 v237, v59, v123
    v_fmac_f32 v245, v52, v172
    v_fmac_f32 v237, v60, v124
    v_fmac_f32 v245, v53, v173
    v_fmac_f32 v237, v61, v125
    v_fmac_f32 v245, v54, v174
    v_fmac_f32 v237, v62, v126
    v_fmac_f32 v245, v55, v175
    v_fmac_f32 v237, v63, v127
    s_cmp_eq_u32 s56, 5
    s_cbranch_scc1 K2_U20
    s_cmp_eq_u32 s56, 6
    s_cbranch_scc1 K2_U3h0
    s_branch K2_DSP0
K2_PAD_U30:
    s_branch K2_HOP
K2_U3h0:
    s_setprio 1
    ds_read_b64_tr_b16 v[8:9], v249 offset:1024
    ds_read_u16_d16_hi v18, v250 offset:256
    s_waitcnt lgkmcnt(2)
    v_lshlrev_b32 v20, 16, v0
    v_and_b32 v21, 0xffff0000, v0
    v_lshlrev_b32 v22, 16, v1
    v_and_b32 v23, 0xffff0000, v1
    v_lshlrev_b32 v24, 16, v2
    v_and_b32 v25, 0xffff0000, v2
    v_lshlrev_b32 v26, 16, v3
    v_and_b32 v27, 0xffff0000, v3
    v_mul_f32_dpp v36, v16, v20 row_newbcast:8 row_mask:0xf bank_mask:0xf
    v_mul_f32_dpp v37, v16, v21 row_newbcast:9 row_mask:0xf bank_mask:0xf
    v_mul_f32_dpp v38, v16, v22 row_newbcast:10 row_mask:0xf bank_mask:0xf
    v_mul_f32_dpp v39, v16, v23 row_newbcast:11 row_mask:0xf bank_mask:0xf
    v_mul_f32_dpp v40, v16, v24 row_newbcast:12 row_mask:0xf bank_mask:0xf
    v_mul_f32_dpp v41, v16, v25 row_newbcast:13 row_mask:0xf bank_mask:0xf
    v_mul_f32_dpp v42, v16, v26 row_newbcast:14 row_mask:0xf bank_mask:0xf
    v_mul_f32_dpp v43, v16, v27 row_newbcast:15 row_mask:0xf bank_mask:0xf
    v_cvt_pk_bf16_f32 v68, v36, v37
    v_cvt_pk_bf16_f32 v69, v38, v39
    v_cvt_pk_bf16_f32 v70, v40, v41
    v_cvt_pk_bf16_f32 v71, v42, v43
    v_mul_f32_dpp v20, v16, v20 row_newbcast:0 row_mask:0xa bank_mask:0xf
    v_mul_f32_dpp v21, v16, v21 row_newbcast:1 row_mask:0xa bank_mask:0xf
    v_mul_f32_dpp v22, v16, v22 row_newbcast:2 row_mask:0xa bank_mask:0xf
    v_mul_f32_dpp v23, v16, v23 row_newbcast:3 row_mask:0xa bank_mask:0xf
    v_mul_f32_dpp v24, v16, v24 row_newbcast:4 row_mask:0xa bank_mask:0xf
    v_mul_f32_dpp v25, v16, v25 row_newbcast:5 row_mask:0xa bank_mask:0xf
    v_mul_f32_dpp v26, v16, v26 row_newbcast:6 row_mask:0xa bank_mask:0xf
    v_mul_f32_dpp v27, v16, v27 row_newbcast:7 row_mask:0xa bank_mask:0xf
    v_cvt_pk_bf16_f32 v64, v20, v21
    v_cvt_pk_bf16_f32 v65, v22, v23
    v_cvt_pk_bf16_f32 v66, v24, v25
    v_cvt_pk_bf16_f32 v67, v26, v27
    v_lshlrev_b32 v28, 16, v4
    v_and_b32 v29, 0xffff0000, v4
    v_lshlrev_b32 v30, 16, v5
    v_and_b32 v31, 0xffff0000, v5
    v_lshlrev_b32 v32, 16, v6
    v_and_b32 v33, 0xffff0000, v6
    v_lshlrev_b32 v34, 16, v7
    v_and_b32 v35, 0xffff0000, v7
    v_mul_f32_dpp v36, v17, v28 row_newbcast:8 row_mask:0xf bank_mask:0xf
    v_mul_f32_dpp v37, v17, v29 row_newbcast:9 row_mask:0xf bank_mask:0xf
    v_mul_f32_dpp v38, v17, v30 row_newbcast:10 row_mask:0xf bank_mask:0xf
    v_mul_f32_dpp v39, v17, v31 row_newbcast:11 row_mask:0xf bank_mask:0xf
    v_mul_f32_dpp v40, v17, v32 row_newbcast:12 row_mask:0xf bank_mask:0xf
    v_mul_f32_dpp v41, v17, v33 row_newbcast:13 row_mask:0xf bank_mask:0xf
    v_mul_f32_dpp v42, v17, v34 row_newbcast:14 row_mask:0xf bank_mask:0xf
    v_mul_f32_dpp v43, v17, v35 row_newbcast:15 row_mask:0xf bank_mask:0xf
    v_cvt_pk_bf16_f32 v76, v36, v37
    v_cvt_pk_bf16_f32 v77, v38, v39
    v_cvt_pk_bf16_f32 v78, v40, v41
    v_cvt_pk_bf16_f32 v79, v42, v43
    v_mul_f32_dpp v28, v17, v28 row_newbcast:0 row_mask:0xa bank_mask:0xf
    v_mul_f32_dpp v29, v17, v29 row_newbcast:1 row_mask:0xa bank_mask:0xf
    v_mul_f32_dpp v30, v17, v30 row_newbcast:2 row_mask:0xa bank_mask:0xf
    v_mul_f32_dpp v31, v17, v31 row_newbcast:3 row_mask:0xa bank_mask:0xf
    v_mul_f32_dpp v32, v17, v32 row_newbcast:4 row_mask:0xa bank_mask:0xf
    v_mul_f32_dpp v33, v17, v33 row_newbcast:5 row_mask:0xa bank_mask:0xf
    v_mul_f32_dpp v34, v17, v34 row_newbcast:6 row_mask:0xa bank_mask:0xf
    v_mul_f32_dpp v35, v17, v35 row_newbcast:7 row_mask:0xa bank_mask:0xf
    v_cvt_pk_bf16_f32 v72, v28, v29
    v_cvt_pk_bf16_f32 v73, v30, v31
    v_cvt_pk_bf16_f32 v74, v32, v33
    v_cvt_pk_bf16_f32 v75, v34, v35
    s_waitcnt lgkmcnt(0)
    v_lshlrev_b32 v20, 16, v8
    v_and_b32 v21, 0xffff0000, v8
    v_lshlrev_b32 v22, 16, v9
    v_and_b32 v23, 0xffff0000, v9
    v_mul_f32_dpp v36, v18, v20 row_newbcast:8 row_mask:0xf bank_mask:0xf
    v_mul_f32_dpp v37, v18, v21 row_newbcast:9 row_mask:0xf bank_mask:0xf
    v_mul_f32_dpp v38, v18, v22 row_newbcast:10 row_mask:0xf bank_mask:0xf
    v_mul_f32_dpp v39, v18, v23 row_newbcast:11 row_mask:0xf bank_mask:0xf
    v_cvt_pk_bf16_f32 v84, v36, v37
    v_cvt_pk_bf16_f32 v85, v38, v39
    v_mul_f32_dpp v20, v18, v20 row_newbcast:0 row_mask:0xa bank_mask:0xf
    v_mul_f32_dpp v21, v18, v21 row_newbcast:1 row_mask:0xa bank_mask:0xf
    v_mul_f32_dpp v22, v18, v22 row_newbcast:2 row_mask:0xa bank_mask:0xf
    v_mul_f32_dpp v23, v18, v23 row_newbcast:3 row_mask:0xa bank_mask:0xf
    v_cvt_pk_bf16_f32 v80, v20, v21
    v_cvt_pk_bf16_f32 v81, v22, v23
    s_waitcnt vmcnt(4)
    v_mfma_f32_32x32x16_bf16 v[0:15], v[64:67], v[176:179], 0
    ds_read_b64_tr_b16 v[184:185], v246 offset:2048
    ds_read_b64_tr_b16 v[186:187], v246 offset:3072
    ds_read_b64_tr_b16 v[188:189], v247 offset:2048
    ds_read_b64_tr_b16 v[190:191], v247 offset:3072
    s_mov_b32 m0, s68
    v_mfma_f32_32x32x16_bf16 v[16:31], v[68:71], v[176:179], 0
    buffer_load_dwordx4 v222, s[4:7], s41 offen sc1 lds
    buffer_load_dwordx4 v223, s[72:75], s41 offen offset:1024 sc1 lds
    v_permlane32_swap_b32 v242, v236
    v_permlane32_swap_b32 v243, v237
    s_add_u32 s38, s38, 1
    v_mfma_f32_32x32x16_bf16 v[32:47], v[64:67], v[180:183], 0
    v_permlane32_swap_b32 v244, v238
    v_permlane32_swap_b32 v245, v239
    v_permlane32_swap_b32 v240, v241
    v_add_f32 v242, v242, v236
    v_mfma_f32_32x32x16_bf16 v[48:63], v[68:71], v[180:183], 0
    v_add_f32 v243, v243, v237
    v_add_f32 v244, v244, v238
    v_add_f32 v245, v245, v239
    v_add_f32 v240, -v240, -v241
    v_mov_b32 v254, s52
    v_mov_b32 v255, s38
    s_waitcnt vmcnt(4) lgkmcnt(0)
    v_mfma_f32_32x32x16_bf16 v[0:15], v[72:75], v[184:187], v[0:15]
    ds_read_b64_tr_b16 v[176:177], v246 offset:4096
    ds_read_b64_tr_b16 v[180:181], v247 offset:4096
    s_lshl_b32 s58, s38, 3
    s_add_u32 s58, s58, s20
    s_mov_b32 m0, s69
    v_mfma_f32_32x32x16_bf16 v[16:31], v[76:79], v[184:187], v[16:31]
    buffer_load_dwordx4 v226, s[4:7], s41 offen sc1 lds
    s_set_gpr_idx_on s32, gpr_idx(DST)
    s_nop 0
    v_cvt_pk_bf16_f32 v195, v242, v243
    v_cvt_pk_bf16_f32 v196, v244, v245
    v_cvt_pk_bf16_f32 v197, v240, v240
    s_set_gpr_idx_off
    s_mov_b64 exec, 1
    ds_write_b32 v254, v255
    s_mov_b64 exec, -1
    s_cmp_lt_u32 s58, s22
    s_cbranch_scc0 K2_dyn_25
K2_back_26:
    v_readlane_b32 s3, v253, s58
    s_lshl_b32 s44, s34, 7
    s_and_b32 s48, s3, 0x3ffff
    s_bfe_u32 s33, s3, 0x30013
    s_mul_i32 s35, s38, 6
    s_cmp_eq_u32 s34, 0
    s_cselect_b32 s35, s35, s48
    s_mov_b32 s45, s44
    s_xor_b32 s47, s44, 256
    s_add_u32 s49, s48, 128
    s_add_u32 s60, s48, 256
    s_cmp_eq_u32 s33, 3
    s_cselect_b32 s46, s44, s47
    s_cselect_b32 s50, s60, s48
    s_sub_u32 s60, s33, 2
    s_cmp_lt_u32 s60, 2
    s_cbranch_scc0 K2_rare_31
K2_back_32:
    v_mfma_f32_32x32x16_bf16 v[32:47], v[72:75], v[188:191], v[32:47]
    v_add_u32 v233, s48, v230
    ds_read_b32 v232, v233
    ds_read_b32 v233, v233 offset:1024
    v_mfma_f32_32x32x16_bf16 v[48:63], v[76:79], v[188:191], v[48:63]
    s_waitcnt vmcnt(3) lgkmcnt(3)
    v_mfma_f32_32x32x8_bf16 v[0:15], v[80:81], v[176:177], v[0:15]
    ds_read_b64_tr_b16 v[184:185], v246 offset:6144
    ds_read_b64_tr_b16 v[186:187], v246 offset:7168
    ds_read_b64_tr_b16 v[188:189], v247 offset:6144
    ds_read_b64_tr_b16 v[190:191], v247 offset:7168
    s_mov_b32 m0, s70
    v_mfma_f32_32x32x8_bf16 v[16:31], v[84:85], v[176:177], v[16:31]
    buffer_load_dwordx4 v222, s[4:7], s42 offen sc1 lds
    buffer_load_dwordx4 v223, s[72:75], s42 offen offset:1024 sc1 lds
    v_mfma_f32_32x32x8_bf16 v[32:47], v[80:81], v[180:181], v[32:47]
    s_nop 2
    v_mul_f32 v234, v0, v96
    v_mul_f32 v236, v8, v128
    v_fmac_f32 v234, v1, v97
    v_fmac_f32 v236, v9, v129
    v_fmac_f32 v234, v2, v98
    v_fmac_f32 v236, v10, v130
    v_fmac_f32 v234, v3, v99
    v_mfma_f32_32x32x8_bf16 v[48:63], v[84:85], v[180:181], v[48:63]
    s_setprio 0
    s_waitcnt lgkmcnt(4)
    v_or_b32 v232, v232, v231
    v_or_b32 v233, v233, v231
    s_cmp_lg_u32 s34, 0
    s_cbranch_scc1 K2_dum_36
    s_cmp_eq_u32 s33, 4
    s_cbranch_scc1 K2_a4_37
K2_b4_39:
    s_add_u32 m0, s48, 512
    s_add_u32 s65, s48, 1536
    buffer_load_dwordx4 v232, s[16:19], 0 offen  lds
    s_mov_b32 m0, s65
    s_mov_b32 exec_hi, 0
    buffer_load_dwordx4 v233, s[16:19], 0 offen  lds
    s_mov_b32 exec_hi, -1
K2_back_38:
    v_fmac_f32 v236, v11, v131
    v_fmac_f32 v234, v4, v100
    v_fmac_f32 v236, v12, v132
    v_fmac_f32 v234, v5, v101
    v_fmac_f32 v236, v13, v133
    v_fmac_f32 v234, v6, v102
    v_fmac_f32 v236, v14, v134
    v_fmac_f32 v234, v7, v103
    v_fmac_f32 v236, v15, v135
    v_mul_f32 v238, v16, v128
    v_mul_f32 v240, v24, v128
    v_fmac_f32 v238, v17, v129
    v_fmac_f32 v240, v25, v129
    v_fmac_f32 v238, v18, v130
    v_fmac_f32 v240, v26, v130
    v_fmac_f32 v238, v19, v131
    v_fmac_f32 v240, v27, v131
    v_fmac_f32 v238, v20, v132
    v_fmac_f32 v240, v28, v132
    v_fmac_f32 v238, v21, v133
    v_fmac_f32 v240, v29, v133
    v_fmac_f32 v238, v22, v134
    v_fmac_f32 v240, v30, v134
    v_fmac_f32 v238, v23, v135
    v_fmac_f32 v240, v31, v135
    v_mul_f32 v235, v32, v104
    v_mul_f32 v237, v40, v136
    v_fmac_f32 v235, v33, v105
    v_fmac_f32 v237, v41, v137
    v_fmac_f32 v235, v34, v106
    v_fmac_f32 v237, v42, v138
    v_fmac_f32 v235, v35, v107
    v_fmac_f32 v237, v43, v139
    v_fmac_f32 v235, v36, v108
    v_fmac_f32 v237, v44, v140
    v_fmac_f32 v235, v37, v109
    v_fmac_f32 v237, v45, v141
    v_fmac_f32 v235, v38, v110
    v_fmac_f32 v237, v46, v142
    v_fmac_f32 v235, v39, v111
    v_fmac_f32 v237, v47, v143
    v_mul_f32 v239, v48, v136
    v_mul_f32 v241, v56, v136
    s_setprio 1
    s_waitcnt vmcnt(5) lgkmcnt(0)
    v_mfma_f32_32x32x16_bf16 v[0:15], v[72:75], v[184:187], 0
    ds_read_b64_tr_b16 v[176:177], v246 offset:0
    ds_read_b64_tr_b16 v[178:179], v246 offset:1024
    ds_read_b64_tr_b16 v[180:181], v247 offset:0
    ds_read_b64_tr_b16 v[182:183], v247 offset:1024
    v_fmac_f32 v239, v49, v137
    v_fmac_f32 v241, v57, v137
    s_mov_b32 m0, s71
    v_mfma_f32_32x32x16_bf16 v[16:31], v[76:79], v[184:187], 0
    buffer_load_dwordx4 v224, s[4:7], s42 offen sc1 lds
    buffer_load_dwordx4 v225, s[72:75], s42 offen offset:1024 sc1 lds
    v_fmac_f32 v239, v50, v138
    v_fmac_f32 v241, v58, v138
    v_fmac_f32 v239, v51, v139
    v_fmac_f32 v241, v59, v139
    v_fmac_f32 v239, v52, v140
    v_mfma_f32_32x32x16_bf16 v[32:47], v[72:75], v[188:191], 0
    v_fmac_f32 v241, v60, v140
    v_fmac_f32 v239, v53, v141
    v_fmac_f32 v241, v61, v141
    v_fmac_f32 v239, v54, v142
    v_fmac_f32 v241, v62, v142
    v_fmac_f32 v239, v55, v143
    v_fmac_f32 v241, v63, v143
    v_mfma_f32_32x32x16_bf16 v[48:63], v[76:79], v[188:191], 0
    v_permlane32_swap_b32 v234, v236
    v_permlane32_swap_b32 v235, v237
    v_permlane32_swap_b32 v240, v238
    s_waitcnt vmcnt(6) lgkmcnt(0)
    v_mfma_f32_32x32x16_bf16 v[0:15], v[64:67], v[176:179], v[0:15]
    ds_read_b64_tr_b16 v[184:185], v246 offset:2048
    ds_read_b64_tr_b16 v[188:189], v247 offset:2048
    v_permlane32_swap_b32 v241, v239
    v_add_f32 v234, v234, v236
    v_add_f32 v235, v235, v237
    s_mov_b32 m0, s68
    v_mfma_f32_32x32x16_bf16 v[16:31], v[68:71], v[176:179], v[16:31]
    buffer_load_dwordx4 v226, s[4:7], s42 offen sc1 lds
    v_add_f32 v240, v240, v238
    v_add_f32 v241, v241, v239
    s_set_gpr_idx_on s31, gpr_idx(DST)
    s_nop 0
    v_cvt_pk_bf16_f32 v192, v234, v235
    v_cvt_pk_bf16_f32 v193, v240, v241
    s_set_gpr_idx_off
    v_mfma_f32_32x32x16_bf16 v[32:47], v[64:67], v[180:183], v[32:47]
    v_mfma_f32_32x32x16_bf16 v[48:63], v[68:71], v[180:183], v[48:63]
    s_waitcnt vmcnt(5) lgkmcnt(0)
    v_mfma_f32_32x32x8_bf16 v[0:15], v[80:81], v[184:185], v[0:15]
    ds_read_b64_tr_b16 v[176:177], v246 offset:4096
    ds_read_b64_tr_b16 v[178:179], v246 offset:5120
    ds_read_b64_tr_b16 v[180:181], v247 offset:4096
    ds_read_b64_tr_b16 v[182:183], v247 offset:5120
    s_mov_b32 m0, s69
    v_mfma_f32_32x32x8_bf16 v[16:31], v[84:85], v[184:185], v[16:31]
    buffer_load_dwordx4 v222, s[4:7], s43 offen sc1 lds
    buffer_load_dwordx4 v223, s[72:75], s43 offen offset:1024 sc1 lds
    v_mfma_f32_32x32x8_bf16 v[32:47], v[80:81], v[188:189], v[32:47]
    s_nop 2
    v_mul_f32 v234, v0, v144
    v_mul_f32 v236, v8, v112
    v_fmac_f32 v234, v1, v145
    v_fmac_f32 v236, v9, v113
    v_fmac_f32 v234, v2, v146
    v_fmac_f32 v236, v10, v114
    v_fmac_f32 v234, v3, v147
    v_mfma_f32_32x32x8_bf16 v[48:63], v[84:85], v[188:189], v[48:63]
    s_setprio 0
    v_fmac_f32 v236, v11, v115
    v_fmac_f32 v234, v4, v148
    v_fmac_f32 v236, v12, v116
    v_fmac_f32 v234, v5, v149
    v_fmac_f32 v236, v13, v117
    v_fmac_f32 v234, v6, v150
    v_fmac_f32 v236, v14, v118
    v_fmac_f32 v234, v7, v151
    v_fmac_f32 v236, v15, v119
    v_mul_f32 v238, v16, v160
    v_mul_f32 v240, v24, v160
    v_fmac_f32 v238, v17, v161
    v_fmac_f32 v240, v25, v161
    v_fmac_f32 v238, v18, v162
    v_fmac_f32 v240, v26, v162
    v_fmac_f32 v238, v19, v163
    v_fmac_f32 v240, v27, v163
    v_fmac_f32 v238, v20, v164
    v_fmac_f32 v240, v28, v164
    v_fmac_f32 v238, v21, v165
    v_fmac_f32 v240, v29, v165
    v_fmac_f32 v238, v22, v166
    v_fmac_f32 v240, v30, v166
    v_fmac_f32 v238, v23, v167
    v_fmac_f32 v240, v31, v167
    v_mul_f32 v235, v32, v152
    v_mul_f32 v237, v40, v120
    v_fmac_f32 v235, v33, v153
    v_fmac_f32 v237, v41, v121
    v_fmac_f32 v235, v34, v154
    v_fmac_f32 v237, v42, v122
    v_fmac_f32 v235, v35, v155
    v_fmac_f32 v237, v43, v123
    v_fmac_f32 v235, v36, v156
    v_fmac_f32 v237, v44, v124
    v_fmac_f32 v235, v37, v157
    v_fmac_f32 v237, v45, v125
    v_fmac_f32 v235, v38, v158
    v_fmac_f32 v237, v46, v126
    v_fmac_f32 v235, v39, v159
    v_fmac_f32 v237, v47, v127
    v_mul_f32 v239, v48, v168
    v_mul_f32 v241, v56, v168
    v_fmac_f32 v239, v49, v169
    v_fmac_f32 v241, v57, v169
    s_setprio 1
    s_waitcnt vmcnt(3) lgkmcnt(0)
    v_mfma_f32_32x32x16_bf16 v[0:15], v[64:67], v[176:179], 0
    ds_read_b64_tr_b16 v[184:185], v246 offset:6144
    ds_read_b64_tr_b16 v[186:187], v246 offset:7168
    ds_read_b64_tr_b16 v[188:189], v247 offset:6144
    ds_read_b64_tr_b16 v[190:191], v247 offset:7168
    v_fmac_f32 v239, v50, v170
    v_fmac_f32 v241, v58, v170
    s_mov_b32 m0, s70
    v_mfma_f32_32x32x16_bf16 v[16:31], v[68:71], v[176:179], 0
    buffer_load_dwordx4 v224, s[4:7], s43 offen sc1 lds
    buffer_load_dwordx4 v225, s[72:75], s43 offen offset:1024 sc1 lds
    v_fmac_f32 v239, v51, v171
    v_fmac_f32 v241, v59, v171
    v_fmac_f32 v239, v52, v172
    v_fmac_f32 v241, v60, v172
    v_fmac_f32 v239, v53, v173
    v_mfma_f32_32x32x16_bf16 v[32:47], v[64:67], v[180:183], 0
    v_add_u32 v222, s48, v251
    ds_read2_b32 v[222:223], v222 offset0:1 offset1:3
    v_fmac_f32 v241, v61, v173
    v_fmac_f32 v239, v54, v174
    v_fmac_f32 v241, v62, v174
    v_fmac_f32 v239, v55, v175
    v_fmac_f32 v241, v63, v175
    v_mfma_f32_32x32x16_bf16 v[48:63], v[68:71], v[180:183], 0
    s_waitcnt vmcnt(4) lgkmcnt(1)
    v_mfma_f32_32x32x16_bf16 v[0:15], v[72:75], v[184:187], v[0:15]
    ds_read_b64_tr_b16 v[176:177], v246 offset:0
    ds_read_b64_tr_b16 v[180:181], v247 offset:0
    s_mov_b32 m0, s71
    v_mfma_f32_32x32x16_bf16 v[16:31], v[76:79], v[184:187], v[16:31]
    buffer_load_dwordx4 v226, s[4:7], s43 offen sc1 lds
    s_waitcnt lgkmcnt(2)
    v_mad_u32_u16 v222, v222, s39, v248 op_sel:[1,0,0,0]
    v_mad_u32_u16 v223, v223, s39, v248 op_sel:[1,0,0,0]
    v_mfma_f32_32x32x16_bf16 v[32:47], v[72:75], v[188:191], v[32:47]
    v_add_u32 v224, s49, v251
    ds_read2_b32 v[224:225], v224 offset0:1 offset1:3
    v_mfma_f32_32x32x16_bf16 v[48:63], v[76:79], v[188:191], v[48:63]
    s_waitcnt vmcnt(3) lgkmcnt(1)
    v_mfma_f32_32x32x8_bf16 v[0:15], v[80:81], v[176:177], v[0:15]
    ds_read_b64_tr_b16 v[184:185], v246 offset:2048
    ds_read_b64_tr_b16 v[186:187], v246 offset:3072
    ds_read_b64_tr_b16 v[188:189], v247 offset:2048
    ds_read_b64_tr_b16 v[190:191], v247 offset:3072
    s_mov_b32 m0, s68
    v_mfma_f32_32x32x8_bf16 v[16:31], v[84:85], v[176:177], v[16:31]
    buffer_load_dwordx4 v222, s[4:7], s44 offen sc1 lds
    buffer_load_dwordx4 v223, s[72:75], s44 offen offset:1024 sc1 lds
    s_waitcnt lgkmcnt(4)
    v_mad_u32_u16 v224, v224, s39, v248 op_sel:[1,0,0,0]
    v_mad_u32_u16 v225, v225, s39, v248 op_sel:[1,0,0,0]
    v_mfma_f32_32x32x8_bf16 v[32:47], v[80:81], v[180:181], v[32:47]
    v_add_u32 v226, s50, v251
    ds_read2_b32 v[226:227], v226 offset0:1 offset1:3
    v_mul_f32 v242, v0, v144
    v_fma_f32 v238, v8, v160, -v238
    v_fmac_f32 v242, v1, v145
    v_fmac_f32 v238, v9, v161
    v_fmac_f32 v242, v2, v146
    v_mfma_f32_32x32x8_bf16 v[48:63], v[84:85], v[180:181], v[48:63]
    s_setprio 0
    v_fmac_f32 v238, v10, v162
    v_fmac_f32 v242, v3, v147
    v_fmac_f32 v238, v11, v163
    v_fmac_f32 v242, v4, v148
    v_fmac_f32 v238, v12, v164
    v_fmac_f32 v242, v5, v149
    v_fmac_f32 v238, v13, v165
    v_fmac_f32 v242, v6, v150
    v_fmac_f32 v238, v14, v166
    v_fmac_f32 v242, v7, v151
    v_fmac_f32 v238, v15, v167
    v_fmac_f32 v236, v16, v112
    v_mul_f32 v244, v24, v160
    v_fmac_f32 v236, v17, v113
    v_fmac_f32 v244, v25, v161
    v_fmac_f32 v236, v18, v114
    v_fmac_f32 v244, v26, v162
    v_fmac_f32 v236, v19, v115
    v_fmac_f32 v244, v27, v163
    v_fmac_f32 v236, v20, v116
    v_fmac_f32 v244, v28, v164
    v_fmac_f32 v236, v21, v117
    v_fmac_f32 v244, v29, v165
    v_fmac_f32 v236, v22, v118
    v_fmac_f32 v244, v30, v166
    v_fmac_f32 v236, v23, v119
    v_fmac_f32 v244, v31, v167
    v_mul_f32 v243, v32, v152
    v_fma_f32 v239, v40, v168, -v239
    v_fmac_f32 v243, v33, v153
    v_fmac_f32 v239, v41, v169
    v_fmac_f32 v243, v34, v154
    v_fmac_f32 v239, v42, v170
    v_fmac_f32 v243, v35, v155
    v_fmac_f32 v239, v43, v171
    v_fmac_f32 v243, v36, v156
    v_fmac_f32 v239, v44, v172
    v_fmac_f32 v243, v37, v157
    v_fmac_f32 v239, v45, v173
    v_fmac_f32 v243, v38, v158
    v_fmac_f32 v239, v46, v174
    v_fmac_f32 v243, v39, v159
    v_fmac_f32 v239, v47, v175
    v_fmac_f32 v237, v48, v120
    v_mul_f32 v245, v56, v168
    v_fmac_f32 v237, v49, v121
    v_fmac_f32 v245, v57, v169
    v_fmac_f32 v237, v50, v122
    s_setprio 1
    s_waitcnt vmcnt(3) lgkmcnt(1)
    v_mfma_f32_32x32x16_bf16 v[0:15], v[64:67], v[184:187], 0
    ds_read_b64_tr_b16 v[176:177], v246 offset:4096
    ds_read_b64_tr_b16 v[178:179], v246 offset:5120
    ds_read_b64_tr_b16 v[180:181], v247 offset:4096
    ds_read_b64_tr_b16 v[182:183], v247 offset:5120
    v_fmac_f32 v245, v58, v170
    v_fmac_f32 v237, v51, v123
    s_mov_b32 m0, s69
    v_mfma_f32_32x32x16_bf16 v[16:31], v[68:71], v[184:187], 0
    buffer_load_dwordx4 v224, s[4:7], s45 offen sc1 lds
    buffer_load_dwordx4 v225, s[72:75], s45 offen offset:1024 sc1 lds
    s_waitcnt lgkmcnt(4)
    v_mad_u32_u16 v226, v226, s39, v248 op_sel:[1,0,0,0]
    v_mad_u32_u16 v227, v227, s39, v248 op_sel:[1,0,0,0]
    v_fmac_f32 v245, v59, v171
    v_fmac_f32 v237, v52, v124
    v_mfma_f32_32x32x16_bf16 v[32:47], v[64:67], v[188:191], 0
    v_fmac_f32 v245, v60, v172
    v_fmac_f32 v237, v53, v125
    v_fmac_f32 v245, v61, v173
    v_fmac_f32 v237, v54, v126
    v_fmac_f32 v245, v62, v174
    v_fmac_f32 v237, v55, v127
    v_fmac_f32 v245, v63, v175
    v_mfma_f32_32x32x16_bf16 v[48:63], v[68:71], v[188:191], 0
    v_permlane32_swap_b32 v242, v234
    v_permlane32_swap_b32 v243, v235
    v_add_f32 v242, v242, v234
    v_add_f32 v243, v243, v235
    s_waitcnt vmcnt(4) lgkmcnt(0)
    v_mfma_f32_32x32x16_bf16 v[0:15], v[72:75], v[176:179], v[0:15]
    ds_read_b64_tr_b16 v[184:185], v246 offset:6144
    ds_read_b64_tr_b16 v[188:189], v247 offset:6144
    s_set_gpr_idx_on s31, gpr_idx(DST)
    s_nop 0
    v_cvt_pk_bf16_f32 v194, v242, v243
    s_set_gpr_idx_off
    s_mov_b32 s32, s31
    s_mov_b32 m0, s70
    v_mfma_f32_32x32x16_bf16 v[16:31], v[76:79], v[176:179], v[16:31]
    buffer_load_dwordx4 v226, s[4:7], s46 offen sc1 lds
    buffer_load_dwordx4 v227, s[72:75], s46 offen offset:1024 sc1 lds
    s_sub_u32 s26, s48, s29
    s_mov_b32 s29, s48
    s_mov_b32 s30, s3
    s_bfe_u32 s56, s3, 0x40012
    s_mov_b32 s31, s35
    v_mfma_f32_32x32x16_bf16 v[32:47], v[72:75], v[180:183], v[32:47]
    s_cmp_eq_u32 s34, 0
    s_cselect_b32 s56, s56, 0
    v_mfma_f32_32x32x16_bf16 v[48:63], v[76:79], v[180:183], v[48:63]
    s_waitcnt vmcnt(4) lgkmcnt(0)
    v_mfma_f32_32x32x8_bf16 v[0:15], v[80:81], v[184:185], v[0:15]
    ds_read_b64_tr_b16 v[176:177], v246 offset:0
    ds_read_b64_tr_b16 v[178:179], v246 offset:1024
    ds_read_b64_tr_b16 v[180:181], v247 offset:0
    ds_read_b64_tr_b16 v[182:183], v247 offset:1024
    s_mov_b32 m0, s71
    v_mfma_f32_32x32x8_bf16 v[16:31], v[84:85], v[184:185], v[16:31]
    s_cmp_eq_u32 s33, 4
    s_cbranch_scc1 K2_g4_34
    buffer_load_dwordx4 v224, s[4:7], s47 offen sc1 lds
    buffer_load_dwordx4 v225, s[72:75], s47 offen offset:1024 sc1 lds
K2_back_35:
    v_mfma_f32_32x32x8_bf16 v[32:47], v[80:81], v[188:189], v[32:47]
    s_nop 0
    v_mul_f32 v242, v0, v144
    v_fma_f32 v240, v8, v160, -v240
    v_fmac_f32 v242, v1, v145
    v_fmac_f32 v240, v9, v161
    v_fmac_f32 v242, v2, v146
    v_fmac_f32 v240, v10, v162
    v_fmac_f32 v242, v3, v147
    v_mfma_f32_32x32x8_bf16 v[48:63], v[84:85], v[188:189], v[48:63]
    s_setprio 0
    v_fmac_f32 v240, v11, v163
    v_fmac_f32 v242, v4, v148
    v_fmac_f32 v240, v12, v164
    v_fmac_f32 v242, v5, v149
    v_fmac_f32 v240, v13, v165
    v_fmac_f32 v242, v6, v150
    v_fmac_f32 v240, v14, v166
    v_fmac_f32 v242, v7, v151
    v_fmac_f32 v240, v15, v167
    v_add_u32 v249, s26, v249
    v_add_u32 v250, s26, v250
    v_fma_f32 v244, v16, v160, -v244
    v_fmac_f32 v236, v24, v112
    v_fmac_f32 v244, v17, v161
    v_fmac_f32 v236, v25, v113
    v_fmac_f32 v244, v18, v162
    v_fmac_f32 v236, v26, v114
    v_fmac_f32 v244, v19, v163
    v_fmac_f32 v236, v27, v115
    v_fmac_f32 v244, v20, v164
    v_fmac_f32 v236, v28, v116
    v_fmac_f32 v244, v21, v165
    v_fmac_f32 v236, v29, v117
    v_fmac_f32 v244, v22, v166
    v_fmac_f32 v236, v30, v118
    v_fmac_f32 v244, v23, v167
    v_fmac_f32 v236, v31, v119
    ds_read_b64_tr_b16 v[0:1], v249 offset:0
    ds_read_b64_tr_b16 v[2:3], v249 offset:32
    ds_read_u16_d16_hi v16, v250 offset:0
    v_mul_f32 v243, v32, v152
    v_fma_f32 v241, v40, v168, -v241
    v_fmac_f32 v243, v33, v153
    v_fmac_f32 v241, v41, v169
    v_fmac_f32 v243, v34, v154
    v_fmac_f32 v241, v42, v170
    v_fmac_f32 v243, v35, v155
    v_fmac_f32 v241, v43, v171
    v_fmac_f32 v243, v36, v156
    v_fmac_f32 v241, v44, v172
    v_fmac_f32 v243, v37, v157
    v_fmac_f32 v241, v45, v173
    v_fmac_f32 v243, v38, v158
    v_fmac_f32 v241, v46, v174
    v_fmac_f32 v243, v39, v159
    v_fmac_f32 v241, v47, v175
    ds_read_b64_tr_b16 v[4:5], v249 offset:512
    ds_read_b64_tr_b16 v[6:7], v249 offset:544
    ds_read_u16_d16_hi v17, v250 offset:128
    v_fma_f32 v245, v48, v168, -v245
    v_fmac_f32 v237, v56, v120
    v_fmac_f32 v245, v49, v169
    v_fmac_f32 v237, v57, v121
    v_fmac_f32 v245, v50, v170
    v_fmac_f32 v237, v58, v122
    v_fmac_f32 v245, v51, v171
    v_fmac_f32 v237, v59, v123
    v_fmac_f32 v245, v52, v172
    v_fmac_f32 v237, v60, v124
    v_fmac_f32 v245, v53, v173
    v_fmac_f32 v237, v61, v125
    v_fmac_f32 v245, v54, v174
    v_fmac_f32 v237, v62, v126
    v_fmac_f32 v245, v55, v175
    v_fmac_f32 v237, v63, v127
    s_cmp_eq_u32 s56, 5
    s_cbranch_scc1 K2_U20
    s_cmp_eq_u32 s56, 6
    s_cbranch_scc1 K2_U3h0
    s_branch K2_DSP0
K2_U30:
    s_setprio 1
    ds_read_b64_tr_b16 v[8:9], v249 offset:1024
    ds_read_b64_tr_b16 v[10:11], v249 offset:1056
    ds_read_u16_d16_hi v18, v250 offset:256
    s_waitcnt lgkmcnt(3)
    v_lshlrev_b32 v20, 16, v0
    v_and_b32 v21, 0xffff0000, v0
    v_lshlrev_b32 v22, 16, v1
    v_and_b32 v23, 0xffff0000, v1
    v_lshlrev_b32 v24, 16, v2
    v_and_b32 v25, 0xffff0000, v2
    v_lshlrev_b32 v26, 16, v3
    v_and_b32 v27, 0xffff0000, v3
    v_mul_f32_dpp v36, v16, v20 row_newbcast:8 row_mask:0xf bank_mask:0xf
    v_mul_f32_dpp v37, v16, v21 row_newbcast:9 row_mask:0xf bank_mask:0xf
    v_mul_f32_dpp v38, v16, v22 row_newbcast:10 row_mask:0xf bank_mask:0xf
    v_mul_f32_dpp v39, v16, v23 row_newbcast:11 row_mask:0xf bank_mask:0xf
    v_mul_f32_dpp v40, v16, v24 row_newbcast:12 row_mask:0xf bank_mask:0xf
    v_mul_f32_dpp v41, v16, v25 row_newbcast:13 row_mask:0xf bank_mask:0xf
    v_mul_f32_dpp v42, v16, v26 row_newbcast:14 row_mask:0xf bank_mask:0xf
    v_mul_f32_dpp v43, v16, v27 row_newbcast:15 row_mask:0xf bank_mask:0xf
    v_cvt_pk_bf16_f32 v68, v36, v37
    v_cvt_pk_bf16_f32 v69, v38, v39
    v_cvt_pk_bf16_f32 v70, v40, v41
    v_cvt_pk_bf16_f32 v71, v42, v43
    v_mul_f32_dpp v20, v16, v20 row_newbcast:0 row_mask:0xa bank_mask:0xf
    v_mul_f32_dpp v21, v16, v21 row_newbcast:1 row_mask:0xa bank_mask:0xf
    v_mul_f32_dpp v22, v16, v22 row_newbcast:2 row_mask:0xa bank_mask:0xf
    v_mul_f32_dpp v23, v16, v23 row_newbcast:3 row_mask:0xa bank_mask:0xf
    v_mul_f32_dpp v24, v16, v24 row_newbcast:4 row_mask:0xa bank_mask:0xf
    v_mul_f32_dpp v25, v16, v25 row_newbcast:5 row_mask:0xa bank_mask:0xf
    v_mul_f32_dpp v26, v16, v26 row_newbcast:6 row_mask:0xa bank_mask:0xf
    v_mul_f32_dpp v27, v16, v27 row_newbcast:7 row_mask:0xa bank_mask:0xf
    v_cvt_pk_bf16_f32 v64, v20, v21
    v_cvt_pk_bf16_f32 v65, v22, v23
    v_cvt_pk_bf16_f32 v66, v24, v25
    v_cvt_pk_bf16_f32 v67, v26, v27
    v_lshlrev_b32 v28, 16, v4
    v_and_b32 v29, 0xffff0000, v4
    v_lshlrev_b32 v30, 16, v5
    v_and_b32 v31, 0xffff0000, v5
    v_lshlrev_b32 v32, 16, v6
    v_and_b32 v33, 0xffff0000, v6
    v_lshlrev_b32 v34, 16, v7
    v_and_b32 v35, 0xffff0000, v7
    v_mul_f32_dpp v36, v17, v28 row_newbcast:8 row_mask:0xf bank_mask:0xf
    v_mul_f32_dpp v37, v17, v29 row_newbcast:9 row_mask:0xf bank_mask:0xf
    v_mul_f32_dpp v38, v17, v30 row_newbcast:10 row_mask:0xf bank_mask:0xf
    v_mul_f32_dpp v39, v17, v31 row_newbcast:11 row_mask:0xf bank_mask:0xf
    v_mul_f32_dpp v40, v17, v32 row_newbcast:12 row_mask:0xf bank_mask:0xf
    v_mul_f32_dpp v41, v17, v33 row_newbcast:13 row_mask:0xf bank_mask:0xf
    v_mul_f32_dpp v42, v17, v34 row_newbcast:14 row_mask:0xf bank_mask:0xf
    v_mul_f32_dpp v43, v17, v35 row_newbcast:15 row_mask:0xf bank_mask:0xf
    v_cvt_pk_bf16_f32 v76, v36, v37
    v_cvt_pk_bf16_f32 v77, v38, v39
    v_cvt_pk_bf16_f32 v78, v40, v41
    v_cvt_pk_bf16_f32 v79, v42, v43
    v_mul_f32_dpp v28, v17, v28 row_newbcast:0 row_mask:0xa bank_mask:0xf
    v_mul_f32_dpp v29, v17, v29 row_newbcast:1 row_mask:0xa bank_mask:0xf
    v_mul_f32_dpp v30, v17, v30 row_newbcast:2 row_mask:0xa bank_mask:0xf
    v_mul_f32_dpp v31, v17, v31 row_newbcast:3 row_mask:0xa bank_mask:0xf
    v_mul_f32_dpp v32, v17, v32 row_newbcast:4 row_mask:0xa bank_mask:0xf
    v_mul_f32_dpp v33, v17, v33 row_newbcast:5 row_mask:0xa bank_mask:0xf
    v_mul_f32_dpp v34, v17, v34 row_newbcast:6 row_mask:0xa bank_mask:0xf
    v_mul_f32_dpp v35, v17, v35 row_newbcast:7 row_mask:0xa bank_mask:0xf
    v_cvt_pk_bf16_f32 v72, v28, v29
    v_cvt_pk_bf16_f32 v73, v30, v31
    v_cvt_pk_bf16_f32 v74, v32, v33
    v_cvt_pk_bf16_f32 v75, v34, v35
    s_waitcnt lgkmcnt(0)
    v_lshlrev_b32 v20, 16, v8
    v_and_b32 v21, 0xffff0000, v8
    v_lshlrev_b32 v22, 16, v9
    v_and_b32 v23, 0xffff0000, v9
    v_lshlrev_b32 v24, 16, v10
    v_and_b32 v25, 0xffff0000, v10
    v_lshlrev_b32 v26, 16, v11
    v_and_b32 v27, 0xffff0000, v11
    v_mul_f32_dpp v36, v18, v20 row_newbcast:8 row_mask:0xf bank_mask:0xf
    v_mul_f32_dpp v37, v18, v21 row_newbcast:9 row_mask:0xf bank_mask:0xf
    v_mul_f32_dpp v38, v18, v22 row_newbcast:10 row_mask:0xf bank_mask:0xf
    v_mul_f32_dpp v39, v18, v23 row_newbcast:11 row_mask:0xf bank_mask:0xf
    v_mul_f32_dpp v40, v18, v24 row_newbcast:12 row_mask:0xf bank_mask:0xf
    v_mul_f32_dpp v41, v18, v25 row_newbcast:13 row_mask:0xf bank_mask:0xf
    v_mul_f32_dpp v42, v18, v26 row_newbcast:14 row_mask:0xf bank_mask:0xf
    v_mul_f32_dpp v43, v18, v27 row_newbcast:15 row_mask:0xf bank_mask:0xf
    v_cvt_pk_bf16_f32 v84, v36, v37
    v_cvt_pk_bf16_f32 v85, v38, v39
    v_cvt_pk_bf16_f32 v86, v40, v41
    v_cvt_pk_bf16_f32 v87, v42, v43
    v_mul_f32_dpp v20, v18, v20 row_newbcast:0 row_mask:0xa bank_mask:0xf
    v_mul_f32_dpp v21, v18, v21 row_newbcast:1 row_mask:0xa bank_mask:0xf
    v_mul_f32_dpp v22, v18, v22 row_newbcast:2 row_mask:0xa bank_mask:0xf
    v_mul_f32_dpp v23, v18, v23 row_newbcast:3 row_mask:0xa bank_mask:0xf
    v_mul_f32_dpp v24, v18, v24 row_newbcast:4 row_mask:0xa bank_mask:0xf
    v_mul_f32_dpp v25, v18, v25 row_newbcast:5 row_mask:0xa bank_mask:0xf
    v_mul_f32_dpp v26, v18, v26 row_newbcast:6 row_mask:0xa bank_mask:0xf
    v_mul_f32_dpp v27, v18, v27 row_newbcast:7 row_mask:0xa bank_mask:0xf
    v_cvt_pk_bf16_f32 v80, v20, v21
    v_cvt_pk_bf16_f32 v81, v22, v23
    v_cvt_pk_bf16_f32 v82, v24, v25
    v_cvt_pk_bf16_f32 v83, v26, v27
    s_waitcnt vmcnt(4)
    v_mfma_f32_32x32x16_bf16 v[0:15], v[64:67], v[176:179], 0
    ds_read_b64_tr_b16 v[184:185], v246 offset:2048
    ds_read_b64_tr_b16 v[186:187], v246 offset:3072
    ds_read_b64_tr_b16 v[188:189], v247 offset:2048
    ds_read_b64_tr_b16 v[190:191], v247 offset:3072
    s_mov_b32 m0, s68
    v_mfma_f32_32x32x16_bf16 v[16:31], v[68:71], v[176:179], 0
    buffer_load_dwordx4 v222, s[4:7], s41 offen sc1 lds
    buffer_load_dwordx4 v223, s[72:75], s41 offen offset:1024 sc1 lds
    v_permlane32_swap_b32 v242, v236
    v_permlane32_swap_b32 v243, v237
    s_add_u32 s38, s38, 1
    v_mfma_f32_32x32x16_bf16 v[32:47], v[64:67], v[180:183], 0
    v_permlane32_swap_b32 v244, v238
    v_permlane32_swap_b32 v245, v239
    v_permlane32_swap_b32 v240, v241
    v_add_f32 v242, v242, v236
    v_mfma_f32_32x32x16_bf16 v[48:63], v[68:71], v[180:183], 0
    v_add_f32 v243, v243, v237
    v_add_f32 v244, v244, v238
    v_add_f32 v245, v245, v239
    v_add_f32 v240, -v240, -v241
    v_mov_b32 v254, s52
    v_mov_b32 v255, s38
    s_waitcnt vmcnt(4) lgkmcnt(0)
    v_mfma_f32_32x32x16_bf16 v[0:15], v[72:75], v[184:187], v[0:15]
    ds_read_b64_tr_b16 v[176:177], v246 offset:4096
    ds_read_b64_tr_b16 v[178:179], v246 offset:5120
    ds_read_b64_tr_b16 v[180:181], v247 offset:4096
    ds_read_b64_tr_b16 v[182:183], v247 offset:5120
    s_lshl_b32 s58, s38, 3
    s_add_u32 s58, s58, s20
    s_mov_b32 m0, s69
    v_mfma_f32_32x32x16_bf16 v[16:31], v[76:79], v[184:187], v[16:31]
    buffer_load_dwordx4 v226, s[4:7], s41 offen sc1 lds
    buffer_load_dwordx4 v227, s[72:75], s41 offen offset:1024 sc1 lds
    s_set_gpr_idx_on s32, gpr_idx(DST)
    s_nop 0
    v_cvt_pk_bf16_f32 v195, v242, v243
    v_cvt_pk_bf16_f32 v196, v244, v245
    v_cvt_pk_bf16_f32 v197, v240, v240
    s_set_gpr_idx_off
    s_mov_b64 exec, 1
    ds_write_b32 v254, v255
    s_mov_b64 exec, -1
    s_cmp_lt_u32 s58, s22
    s_cbranch_scc0 K2_dyn_40
K2_back_41:
    v_readlane_b32 s3, v253, s58
    s_lshl_b32 s44, s34, 7
    s_and_b32 s48, s3, 0x3ffff
    s_bfe_u32 s33, s3, 0x30013
    s_mul_i32 s35, s38, 6
    s_cmp_eq_u32 s34, 0
    s_cselect_b32 s35, s35, s48
    s_mov_b32 s45, s44
    s_xor_b32 s47, s44, 256
    s_add_u32 s49, s48, 128
    s_add_u32 s60, s48, 256
    s_cmp_eq_u32 s33, 3
    s_cselect_b32 s46, s44, s47
    s_cselect_b32 s50, s60, s48
    s_sub_u32 s60, s33, 2
    s_cmp_lt_u32 s60, 2
    s_cbranch_scc0 K2_rare_46
K2_back_47:
    v_mfma_f32_32x32x16_bf16 v[32:47], v[72:75], v[188:191], v[32:47]
    v_add_u32 v233, s48, v230
    ds_read_b32 v232, v233
    ds_read_b32 v233, v233 offset:1024
    v_mfma_f32_32x32x16_bf16 v[48:63], v[76:79], v[188:191], v[48:63]
    s_waitcnt vmcnt(4) lgkmcnt(3)
    v_mfma_f32_32x32x16_bf16 v[0:15], v[80:83], v[176:179], v[0:15]
    ds_read_b64_tr_b16 v[184:185], v246 offset:6144
    ds_read_b64_tr_b16 v[186:187], v246 offset:7168
    ds_read_b64_tr_b16 v[188:189], v247 offset:6144
    ds_read_b64_tr_b16 v[190:191], v247 offset:7168
    s_mov_b32 m0, s70
    v_mfma_f32_32x32x16_bf16 v[16:31], v[84:87], v[176:179], v[16:31]
    buffer_load_dwordx4 v222, s[4:7], s42 offen sc1 lds
    buffer_load_dwordx4 v223, s[72:75], s42 offen offset:1024 sc1 lds
    v_mfma_f32_32x32x16_bf16 v[32:47], v[80:83], v[180:183], v[32:47]
    s_nop 2
    v_mul_f32 v234, v0, v96
    v_mul_f32 v236, v8, v128
    v_fmac_f32 v234, v1, v97
    v_fmac_f32 v236, v9, v129
    v_fmac_f32 v234, v2, v98
    v_fmac_f32 v236, v10, v130
    v_fmac_f32 v234, v3, v99
    v_mfma_f32_32x32x16_bf16 v[48:63], v[84:87], v[180:183], v[48:63]
    s_setprio 0
    s_waitcnt lgkmcnt(4)
    v_or_b32 v232, v232, v231
    v_or_b32 v233, v233, v231
    s_cmp_lg_u32 s34, 0
    s_cbranch_scc1 K2_dum_51
    s_cmp_eq_u32 s33, 4
    s_cbranch_scc1 K2_a4_52
K2_b4_54:
    s_add_u32 m0, s48, 512
    s_add_u32 s65, s48, 1536
    buffer_load_dwordx4 v232, s[16:19], 0 offen  lds
    s_mov_b32 m0, s65
    s_mov_b32 exec_hi, 0
    buffer_load_dwordx4 v233, s[16:19], 0 offen  lds
    s_mov_b32 exec_hi, -1
K2_back_53:
    v_fmac_f32 v236, v11, v131
    v_fmac_f32 v234, v4, v100
    v_fmac_f32 v236, v12, v132
    v_fmac_f32 v234, v5, v101
    v_fmac_f32 v236, v13, v133
    v_fmac_f32 v234, v6, v102
    v_fmac_f32 v236, v14, v134
    v_fmac_f32 v234, v7, v103
    v_fmac_f32 v236, v15, v135
    v_mul_f32 v238, v16, v128
    v_mul_f32 v240, v24, v128
    v_fmac_f32 v238, v17, v129
    v_fmac_f32 v240, v25, v129
    v_fmac_f32 v238, v18, v130
    v_fmac_f32 v240, v26, v130
    v_fmac_f32 v238, v19, v131
    v_fmac_f32 v240, v27, v131
    v_fmac_f32 v238, v20, v132
    v_fmac_f32 v240, v28, v132
    v_fmac_f32 v238, v21, v133
    v_fmac_f32 v240, v29, v133
    v_fmac_f32 v238, v22, v134
    v_fmac_f32 v240, v30, v134
    v_fmac_f32 v238, v23, v135
    v_fmac_f32 v240, v31, v135
    v_mul_f32 v235, v32, v104
    v_mul_f32 v237, v40, v136
    v_fmac_f32 v235, v33, v105
    v_fmac_f32 v237, v41, v137
    v_fmac_f32 v235, v34, v106
    v_fmac_f32 v237, v42, v138
    v_fmac_f32 v235, v35, v107
    v_fmac_f32 v237, v43, v139
    v_fmac_f32 v235, v36, v108
    v_fmac_f32 v237, v44, v140
    v_fmac_f32 v235, v37, v109
    v_fmac_f32 v237, v45, v141
    v_fmac_f32 v235, v38, v110
    v_fmac_f32 v237, v46, v142
    v_fmac_f32 v235, v39, v111
    v_fmac_f32 v237, v47, v143
    v_mul_f32 v239, v48, v136
    v_mul_f32 v241, v56, v136
    s_setprio 1
    s_waitcnt vmcnt(6) lgkmcnt(0)
    v_mfma_f32_32x32x16_bf16 v[0:15], v[72:75], v[184:187], 0
    ds_read_b64_tr_b16 v[176:177], v246 offset:0
    ds_read_b64_tr_b16 v[178:179], v246 offset:1024
    ds_read_b64_tr_b16 v[180:181], v247 offset:0
    ds_read_b64_tr_b16 v[182:183], v247 offset:1024
    v_fmac_f32 v239, v49, v137
    v_fmac_f32 v241, v57, v137
    s_mov_b32 m0, s71
    v_mfma_f32_32x32x16_bf16 v[16:31], v[76:79], v[184:187], 0
    buffer_load_dwordx4 v224, s[4:7], s42 offen sc1 lds
    buffer_load_dwordx4 v225, s[72:75], s42 offen offset:1024 sc1 lds
    v_fmac_f32 v239, v50, v138
    v_fmac_f32 v241, v58, v138
    v_fmac_f32 v239, v51, v139
    v_fmac_f32 v241, v59, v139
    v_fmac_f32 v239, v52, v140
    v_mfma_f32_32x32x16_bf16 v[32:47], v[72:75], v[188:191], 0
    v_fmac_f32 v241, v60, v140
    v_fmac_f32 v239, v53, v141
    v_fmac_f32 v241, v61, v141
    v_fmac_f32 v239, v54, v142
    v_fmac_f32 v241, v62, v142
    v_fmac_f32 v239, v55, v143
    v_fmac_f32 v241, v63, v143
    v_mfma_f32_32x32x16_bf16 v[48:63], v[76:79], v[188:191], 0
    v_permlane32_swap_b32 v234, v236
    v_permlane32_swap_b32 v235, v237
    v_permlane32_swap_b32 v240, v238
    s_waitcnt vmcnt(6) lgkmcnt(0)
    v_mfma_f32_32x32x16_bf16 v[0:15], v[64:67], v[176:179], v[0:15]
    ds_read_b64_tr_b16 v[184:185], v246 offset:2048
    ds_read_b64_tr_b16 v[186:187], v246 offset:3072
    ds_read_b64_tr_b16 v[188:189], v247 offset:2048
    ds_read_b64_tr_b16 v[190:191], v247 offset:3072
    v_permlane32_swap_b32 v241, v239
    s_mov_b32 m0, s68
    v_mfma_f32_32x32x16_bf16 v[16:31], v[68:71], v[176:179], v[16:31]
    buffer_load_dwordx4 v226, s[4:7], s42 offen sc1 lds
    buffer_load_dwordx4 v227, s[72:75], s42 offen offset:1024 sc1 lds
    v_add_f32 v234, v234, v236
    v_add_f32 v235, v235, v237
    v_add_f32 v240, v240, v238
    v_add_f32 v241, v241, v239
    v_mfma_f32_32x32x16_bf16 v[32:47], v[64:67], v[180:183], v[32:47]
    s_set_gpr_idx_on s31, gpr_idx(DST)
    s_nop 0
    v_cvt_pk_bf16_f32 v192, v234, v235
    v_cvt_pk_bf16_f32 v193, v240, v241
    s_set_gpr_idx_off
    v_mfma_f32_32x32x16_bf16 v[48:63], v[68:71], v[180:183], v[48:63]
    s_waitcnt vmcnt(6) lgkmcnt(0)
    v_mfma_f32_32x32x16_bf16 v[0:15], v[80:83], v[184:187], v[0:15]
    ds_read_b64_tr_b16 v[176:177], v246 offset:4096
    ds_read_b64_tr_b16 v[178:179], v246 offset:5120
    ds_read_b64_tr_b16 v[180:181], v247 offset:4096
    ds_read_b64_tr_b16 v[182:183], v247 offset:5120
    s_mov_b32 m0, s69
    v_mfma_f32_32x32x16_bf16 v[16:31], v[84:87], v[184:187], v[16:31]
    buffer_load_dwordx4 v222, s[4:7], s43 offen sc1 lds
    buffer_load_dwordx4 v223, s[72:75], s43 offen offset:1024 sc1 lds
    v_mfma_f32_32x32x16_bf16 v[32:47], v[80:83], v[188:191], v[32:47]
    s_nop 2
    v_mul_f32 v234, v0, v144
    v_mul_f32 v236, v8, v112
    v_fmac_f32 v234, v1, v145
    v_fmac_f32 v236, v9, v113
    v_fmac_f32 v234, v2, v146
    v_fmac_f32 v236, v10, v114
    v_fmac_f32 v234, v3, v147
    v_mfma_f32_32x32x16_bf16 v[48:63], v[84:87], v[188:191], v[48:63]
    s_setprio 0
    v_fmac_f32 v236, v11, v115
    v_fmac_f32 v234, v4, v148
    v_fmac_f32 v236, v12, v116
    v_fmac_f32 v234, v5, v149
    v_fmac_f32 v236, v13, v117
    v_fmac_f32 v234, v6, v150
    v_fmac_f32 v236, v14, v118
    v_fmac_f32 v234, v7, v151
    v_fmac_f32 v236, v15, v119
    v_mul_f32 v238, v16, v160
    v_mul_f32 v240, v24, v160
    v_fmac_f32 v238, v17, v161
    v_fmac_f32 v240, v25, v161
    v_fmac_f32 v238, v18, v162
    v_fmac_f32 v240, v26, v162
    v_fmac_f32 v238, v19, v163
    v_fmac_f32 v240, v27, v163
    v_fmac_f32 v238, v20, v164
    v_fmac_f32 v240, v28, v164
    v_fmac_f32 v238, v21, v165
    v_fmac_f32 v240, v29, v165
    v_fmac_f32 v238, v22, v166
    v_fmac_f32 v240, v30, v166
    v_fmac_f32 v238, v23, v167
    v_fmac_f32 v240, v31, v167
    v_mul_f32 v235, v32, v152
    v_mul_f32 v237, v40, v120
    v_fmac_f32 v235, v33, v153
    v_fmac_f32 v237, v41, v121
    v_fmac_f32 v235, v34, v154
    v_fmac_f32 v237, v42, v122
    v_fmac_f32 v235, v35, v155
    v_fmac_f32 v237, v43, v123
    v_fmac_f32 v235, v36, v156
    v_fmac_f32 v237, v44, v124
    v_fmac_f32 v235, v37, v157
    v_fmac_f32 v237, v45, v125
    v_fmac_f32 v235, v38, v158
    v_fmac_f32 v237, v46, v126
    v_fmac_f32 v235, v39, v159
    v_fmac_f32 v237, v47, v127
    v_mul_f32 v239, v48, v168
    v_mul_f32 v241, v56, v168
    v_fmac_f32 v239, v49, v169
    v_fmac_f32 v241, v57, v169
    s_setprio 1
    s_waitcnt vmcnt(4) lgkmcnt(0)
    v_mfma_f32_32x32x16_bf16 v[0:15], v[64:67], v[176:179], 0
    ds_read_b64_tr_b16 v[184:185], v246 offset:6144
    ds_read_b64_tr_b16 v[186:187], v246 offset:7168
    ds_read_b64_tr_b16 v[188:189], v247 offset:6144
    ds_read_b64_tr_b16 v[190:191], v247 offset:7168
    v_fmac_f32 v239, v50, v170
    v_fmac_f32 v241, v58, v170
    s_mov_b32 m0, s70
    v_mfma_f32_32x32x16_bf16 v[16:31], v[68:71], v[176:179], 0
    buffer_load_dwordx4 v224, s[4:7], s43 offen sc1 lds
    buffer_load_dwordx4 v225, s[72:75], s43 offen offset:1024 sc1 lds
    v_fmac_f32 v239, v51, v171
    v_fmac_f32 v241, v59, v171
    v_fmac_f32 v239, v52, v172
    v_fmac_f32 v241, v60, v172
    v_fmac_f32 v239, v53, v173
    v_mfma_f32_32x32x16_bf16 v[32:47], v[64:67], v[180:183], 0
    v_add_u32 v222, s48, v251
    ds_read2_b32 v[222:223], v222 offset0:1 offset1:3
    v_fmac_f32 v241, v61, v173
    v_fmac_f32 v239, v54, v174
    v_fmac_f32 v241, v62, v174
    v_fmac_f32 v239, v55, v175
    v_fmac_f32 v241, v63, v175
    v_mfma_f32_32x32x16_bf16 v[48:63], v[68:71], v[180:183], 0
    s_waitcnt vmcnt(4) lgkmcnt(1)
    v_mfma_f32_32x32x16_bf16 v[0:15], v[72:75], v[184:187], v[0:15]
    ds_read_b64_tr_b16 v[176:177], v246 offset:0
    ds_read_b64_tr_b16 v[178:179], v246 offset:1024
    ds_read_b64_tr_b16 v[180:181], v247 offset:0
    ds_read_b64_tr_b16 v[182:183], v247 offset:1024
    s_mov_b32 m0, s71
    v_mfma_f32_32x32x16_bf16 v[16:31], v[76:79], v[184:187], v[16:31]
    buffer_load_dwordx4 v226, s[4:7], s43 offen sc1 lds
    buffer_load_dwordx4 v227, s[72:75], s43 offen offset:1024 sc1 lds
    s_waitcnt lgkmcnt(4)
    v_mad_u32_u16 v222, v222, s39, v248 op_sel:[1,0,0,0]
    v_mad_u32_u16 v223, v223, s39, v248 op_sel:[1,0,0,0]
    v_mfma_f32_32x32x16_bf16 v[32:47], v[72:75], v[188:191], v[32:47]
    v_add_u32 v224, s49, v251
    ds_read2_b32 v[224:225], v224 offset0:1 offset1:3
    v_mfma_f32_32x32x16_bf16 v[48:63], v[76:79], v[188:191], v[48:63]
    s_waitcnt vmcnt(4) lgkmcnt(1)
    v_mfma_f32_32x32x16_bf16 v[0:15], v[80:83], v[176:179], v[0:15]
    ds_read_b64_tr_b16 v[184:185], v246 offset:2048
    ds_read_b64_tr_b16 v[186:187], v246 offset:3072
    ds_read_b64_tr_b16 v[188:189], v247 offset:2048
    ds_read_b64_tr_b16 v[190:191], v247 offset:3072
    s_mov_b32 m0, s68
    v_mfma_f32_32x32x16_bf16 v[16:31], v[84:87], v[176:179], v[16:31]
    buffer_load_dwordx4 v222, s[4:7], s44 offen sc1 lds
    buffer_load_dwordx4 v223, s[72:75], s44 offen offset:1024 sc1 lds
    s_waitcnt lgkmcnt(4)
    v_mad_u32_u16 v224, v224, s39, v248 op_sel:[1,0,0,0]
    v_mad_u32_u16 v225, v225, s39, v248 op_sel:[1,0,0,0]
    v_mfma_f32_32x32x16_bf16 v[32:47], v[80:83], v[180:183], v[32:47]
    v_add_u32 v226, s50, v251
    ds_read2_b32 v[226:227], v226 offset0:1 offset1:3
    v_mul_f32 v242, v0, v144
    v_fma_f32 v238, v8, v160, -v238
    v_fmac_f32 v242, v1, v145
    v_fmac_f32 v238, v9, v161
    v_fmac_f32 v242, v2, v146
    v_mfma_f32_32x32x16_bf16 v[48:63], v[84:87], v[180:183], v[48:63]
    s_setprio 0
    v_fmac_f32 v238, v10, v162
    v_fmac_f32 v242, v3, v147
    v_fmac_f32 v238, v11, v163
    v_fmac_f32 v242, v4, v148
    v_fmac_f32 v238, v12, v164
    v_fmac_f32 v242, v5, v149
    v_fmac_f32 v238, v13, v165
    v_fmac_f32 v242, v6, v150
    v_fmac_f32 v238, v14, v166
    v_fmac_f32 v242, v7, v151
    v_fmac_f32 v238, v15, v167
    v_fmac_f32 v236, v16, v112
    v_mul_f32 v244, v24, v160
    v_fmac_f32 v236, v17, v113
    v_fmac_f32 v244, v25, v161
    v_fmac_f32 v236, v18, v114
    v_fmac_f32 v244, v26, v162
    v_fmac_f32 v236, v19, v115
    v_fmac_f32 v244, v27, v163
    v_fmac_f32 v236, v20, v116
    v_fmac_f32 v244, v28, v164
    v_fmac_f32 v236, v21, v117
    v_fmac_f32 v244, v29, v165
    v_fmac_f32 v236, v22, v118
    v_fmac_f32 v244, v30, v166
    v_fmac_f32 v236, v23, v119
    v_fmac_f32 v244, v31, v167
    v_mul_f32 v243, v32, v152
    v_fma_f32 v239, v40, v168, -v239
    v_fmac_f32 v243, v33, v153
    v_fmac_f32 v239, v41, v169
    v_fmac_f32 v243, v34, v154
    v_fmac_f32 v239, v42, v170
    v_fmac_f32 v243, v35, v155
    v_fmac_f32 v239, v43, v171
    v_fmac_f32 v243, v36, v156
    v_fmac_f32 v239, v44, v172
    v_fmac_f32 v243, v37, v157
    v_fmac_f32 v239, v45, v173
    v_fmac_f32 v243, v38, v158
    v_fmac_f32 v239, v46, v174
    v_fmac_f32 v243, v39, v159
    v_fmac_f32 v239, v47, v175
    v_fmac_f32 v237, v48, v120
    v_mul_f32 v245, v56, v168
    v_fmac_f32 v237, v49, v121
    v_fmac_f32 v245, v57, v169
    v_fmac_f32 v237, v50, v122
    s_setprio 1
    s_waitcnt vmcnt(4) lgkmcnt(1)
    v_mfma_f32_32x32x16_bf16 v[0:15], v[64:67], v[184:187], 0
    ds_read_b64_tr_b16 v[176:177], v246 offset:4096
    ds_read_b64_tr_b16 v[178:179], v246 offset:5120
    ds_read_b64_tr_b16 v[180:181], v247 offset:4096
    ds_read_b64_tr_b16 v[182:183], v247 offset:5120
    v_fmac_f32 v245, v58, v170
    v_fmac_f32 v237, v51, v123
    s_mov_b32 m0, s69
    v_mfma_f32_32x32x16_bf16 v[16:31], v[68:71], v[184:187], 0
    buffer_load_dwordx4 v224, s[4:7], s45 offen sc1 lds
    buffer_load_dwordx4 v225, s[72:75], s45 offen offset:1024 sc1 lds
    s_waitcnt lgkmcnt(4)
    v_mad_u32_u16 v226, v226, s39, v248 op_sel:[1,0,0,0]
    v_mad_u32_u16 v227, v227, s39, v248 op_sel:[1,0,0,0]
    v_fmac_f32 v245, v59, v171
    v_fmac_f32 v237, v52, v124
    v_mfma_f32_32x32x16_bf16 v[32:47], v[64:67], v[188:191], 0
    v_fmac_f32 v245, v60, v172
    v_fmac_f32 v237, v53, v125
    v_fmac_f32 v245, v61, v173
    v_fmac_f32 v237, v54, v126
    v_fmac_f32 v245, v62, v174
    v_fmac_f32 v237, v55, v127
    v_fmac_f32 v245, v63, v175
    v_mfma_f32_32x32x16_bf16 v[48:63], v[68:71], v[188:191], 0
    v_permlane32_swap_b32 v242, v234
    v_permlane32_swap_b32 v243, v235
    v_add_f32 v242, v242, v234
    v_add_f32 v243, v243, v235
    s_waitcnt vmcnt(4) lgkmcnt(0)
    v_mfma_f32_32x32x16_bf16 v[0:15], v[72:75], v[176:179], v[0:15]
    ds_read_b64_tr_b16 v[184:185], v246 offset:6144
    ds_read_b64_tr_b16 v[186:187], v246 offset:7168
    ds_read_b64_tr_b16 v[188:189], v247 offset:6144
    ds_read_b64_tr_b16 v[190:191], v247 offset:7168
    s_mov_b32 m0, s70
    v_mfma_f32_32x32x16_bf16 v[16:31], v[76:79], v[176:179], v[16:31]
    buffer_load_dwordx4 v226, s[4:7], s46 offen sc1 lds
    buffer_load_dwordx4 v227, s[72:75], s46 offen offset:1024 sc1 lds
    s_set_gpr_idx_on s31, gpr_idx(DST)
    s_nop 0
    v_cvt_pk_bf16_f32 v194, v242, v243
    s_set_gpr_idx_off
    s_sub_u32 s26, s48, s29
    s_mov_b32 s29, s48
    v_mfma_f32_32x32x16_bf16 v[32:47], v[72:75], v[180:183], v[32:47]
    s_mov_b32 s30, s3
    s_bfe_u32 s56, s3, 0x40012
    s_cmp_eq_u32 s34, 0
    s_cselect_b32 s56, s56, 0
    s_mov_b32 s32, s31
    s_mov_b32 s31, s35
    v_mfma_f32_32x32x16_bf16 v[48:63], v[76:79], v[180:183], v[48:63]
    s_waitcnt vmcnt(4) lgkmcnt(0)
    v_mfma_f32_32x32x16_bf16 v[0:15], v[80:83], v[184:187], v[0:15]
    ds_read_b64_tr_b16 v[176:177], v246 offset:0
    ds_read_b64_tr_b16 v[178:179], v246 offset:1024
    ds_read_b64_tr_b16 v[180:181], v247 offset:0
    ds_read_b64_tr_b16 v[182:183], v247 offset:1024
    s_mov_b32 m0, s71
    v_mfma_f32_32x32x16_bf16 v[16:31], v[84:87], v[184:187], v[16:31]
    s_cmp_eq_u32 s33, 4
    s_cbranch_scc1 K2_g4_49
    buffer_load_dwordx4 v224, s[4:7], s47 offen sc1 lds
    buffer_load_dwordx4 v225, s[72:75], s47 offen offset:1024 sc1 lds
K2_back_50:
    v_mfma_f32_32x32x16_bf16 v[32:47], v[80:83], v[188:191], v[32:47]
    s_nop 0
    v_mul_f32 v242, v0, v144
    v_fma_f32 v240, v8, v160, -v240
    v_fmac_f32 v242, v1, v145
    v_fmac_f32 v240, v9, v161
    v_fmac_f32 v242, v2, v146
    v_fmac_f32 v240, v10, v162
    v_fmac_f32 v242, v3, v147
    v_mfma_f32_32x32x16_bf16 v[48:63], v[84:87], v[188:191], v[48:63]
    s_setprio 0
    v_fmac_f32 v240, v11, v163
    v_fmac_f32 v242, v4, v148
    v_fmac_f32 v240, v12, v164
    v_fmac_f32 v242, v5, v149
    v_fmac_f32 v240, v13, v165
    v_fmac_f32 v242, v6, v150
    v_fmac_f32 v240, v14, v166
    v_fmac_f32 v242, v7, v151
    v_fmac_f32 v240, v15, v167
    v_add_u32 v249, s26, v249
    v_add_u32 v250, s26, v250
    v_fma_f32 v244, v16, v160, -v244
    v_fmac_f32 v236, v24, v112
    v_fmac_f32 v244, v17, v161
    v_fmac_f32 v236, v25, v113
    v_fmac_f32 v244, v18, v162
    v_fmac_f32 v236, v26, v114
    v_fmac_f32 v244, v19, v163
    v_fmac_f32 v236, v27, v115
    v_fmac_f32 v244, v20, v164
    v_fmac_f32 v236, v28, v116
    v_fmac_f32 v244, v21, v165
    v_fmac_f32 v236, v29, v117
    v_fmac_f32 v244, v22, v166
    v_fmac_f32 v236, v30, v118
    v_fmac_f32 v244, v23, v167
    v_fmac_f32 v236, v31, v119
    ds_read_b64_tr_b16 v[0:1], v249 offset:0
    ds_read_b64_tr_b16 v[2:3], v249 offset:32
    ds_read_u16_d16_hi v16, v250 offset:0
    v_mul_f32 v243, v32, v152
    v_fma_f32 v241, v40, v168, -v241
    v_fmac_f32 v243, v33, v153
    v_fmac_f32 v241, v41, v169
    v_fmac_f32 v243, v34, v154
    v_fmac_f32 v241, v42, v170
    v_fmac_f32 v243, v35, v155
    v_fmac_f32 v241, v43, v171
    v_fmac_f32 v243, v36, v156
    v_fmac_f32 v241, v44, v172
    v_fmac_f32 v243, v37, v157
    v_fmac_f32 v241, v45, v173
    v_fmac_f32 v243, v38, v158
    v_fmac_f32 v241, v46, v174
    v_fmac_f32 v243, v39, v159
    v_fmac_f32 v241, v47, v175
    ds_read_b64_tr_b16 v[4:5], v249 offset:512
    ds_read_b64_tr_b16 v[6:7], v249 offset:544
    ds_read_u16_d16_hi v17, v250 offset:128
    v_fma_f32 v245, v48, v168, -v245
    v_fmac_f32 v237, v56, v120
    v_fmac_f32 v245, v49, v169
    v_fmac_f32 v237, v57, v121
    v_fmac_f32 v245, v50, v170
    v_fmac_f32 v237, v58, v122
    v_fmac_f32 v245, v51, v171
    v_fmac_f32 v237, v59, v123
    v_fmac_f32 v245, v52, v172
    v_fmac_f32 v237, v60, v124
    v_fmac_f32 v245, v53, v173
    v_fmac_f32 v237, v61, v125
    v_fmac_f32 v245, v54, v174
    v_fmac_f32 v237, v62, v126
    v_fmac_f32 v245, v55, v175
    v_fmac_f32 v237, v63, v127
    s_cmp_eq_u32 s56, 5
    s_cbranch_scc1 K2_U20
    s_cmp_eq_u32 s56, 6
    s_cbranch_scc1 K2_U3h0
    s_branch K2_DSP0
K2_PAD_U21:
    s_branch K2_HOP
K2_U21:
    s_setprio 1
    s_waitcnt lgkmcnt(0)
    v_lshlrev_b32 v20, 16, v0
    v_and_b32 v21, 0xffff0000, v0
    v_lshlrev_b32 v22, 16, v1
    v_and_b32 v23, 0xffff0000, v1
    v_lshlrev_b32 v24, 16, v2
    v_and_b32 v25, 0xffff0000, v2
    v_lshlrev_b32 v26, 16, v3
    v_and_b32 v27, 0xffff0000, v3
    v_mul_f32_dpp v36, v16, v20 row_newbcast:8 row_mask:0xf bank_mask:0xf
    v_mul_f32_dpp v37, v16, v21 row_newbcast:9 row_mask:0xf bank_mask:0xf
    v_mul_f32_dpp v38, v16, v22 row_newbcast:10 row_mask:0xf bank_mask:0xf
    v_mul_f32_dpp v39, v16, v23 row_newbcast:11 row_mask:0xf bank_mask:0xf
    v_mul_f32_dpp v40, v16, v24 row_newbcast:12 row_mask:0xf bank_mask:0xf
    v_mul_f32_dpp v41, v16, v25 row_newbcast:13 row_mask:0xf bank_mask:0xf
    v_mul_f32_dpp v42, v16, v26 row_newbcast:14 row_mask:0xf bank_mask:0xf
    v_mul_f32_dpp v43, v16, v27 row_newbcast:15 row_mask:0xf bank_mask:0xf
    v_cvt_pk_bf16_f32 v68, v36, v37
    v_cvt_pk_bf16_f32 v69, v38, v39
    v_cvt_pk_bf16_f32 v70, v40, v41
    v_cvt_pk_bf16_f32 v71, v42, v43
    v_mul_f32_dpp v20, v16, v20 row_newbcast:0 row_mask:0xa bank_mask:0xf
    v_mul_f32_dpp v21, v16, v21 row_newbcast:1 row_mask:0xa bank_mask:0xf
    v_mul_f32_dpp v22, v16, v22 row_newbcast:2 row_mask:0xa bank_mask:0xf
    v_mul_f32_dpp v23, v16, v23 row_newbcast:3 row_mask:0xa bank_mask:0xf
    v_mul_f32_dpp v24, v16, v24 row_newbcast:4 row_mask:0xa bank_mask:0xf
    v_mul_f32_dpp v25, v16, v25 row_newbcast:5 row_mask:0xa bank_mask:0xf
    v_mul_f32_dpp v26, v16, v26 row_newbcast:6 row_mask:0xa bank_mask:0xf
    v_mul_f32_dpp v27, v16, v27 row_newbcast:7 row_mask:0xa bank_mask:0xf
    v_cvt_pk_bf16_f32 v64, v20, v21
    v_cvt_pk_bf16_f32 v65, v22, v23
    v_cvt_pk_bf16_f32 v66, v24, v25
    v_cvt_pk_bf16_f32 v67, v26, v27
    v_lshlrev_b32 v28, 16, v4
    v_and_b32 v29, 0xffff0000, v4
    v_lshlrev_b32 v30, 16, v5
    v_and_b32 v31, 0xffff0000, v5
    v_lshlrev_b32 v32, 16, v6
    v_and_b32 v33, 0xffff0000, v6
    v_lshlrev_b32 v34, 16, v7
    v_and_b32 v35, 0xffff0000, v7
    v_mul_f32_dpp v36, v17, v28 row_newbcast:8 row_mask:0xf bank_mask:0xf
    v_mul_f32_dpp v37, v17, v29 row_newbcast:9 row_mask:0xf bank_mask:0xf
    v_mul_f32_dpp v38, v17, v30 row_newbcast:10 row_mask:0xf bank_mask:0xf
    v_mul_f32_dpp v39, v17, v31 row_newbcast:11 row_mask:0xf bank_mask:0xf
    v_mul_f32_dpp v40, v17, v32 row_newbcast:12 row_mask:0xf bank_mask:0xf
    v_mul_f32_dpp v41, v17, v33 row_newbcast:13 row_mask:0xf bank_mask:0xf
    v_mul_f32_dpp v42, v17, v34 row_newbcast:14 row_mask:0xf bank_mask:0xf
    v_mul_f32_dpp v43, v17, v35 row_newbcast:15 row_mask:0xf bank_mask:0xf
    v_cvt_pk_bf16_f32 v76, v36, v37
    v_cvt_pk_bf16_f32 v77, v38, v39
    v_cvt_pk_bf16_f32 v78, v40, v41
    v_cvt_pk_bf16_f32 v79, v42, v43
    v_mul_f32_dpp v28, v17, v28 row_newbcast:0 row_mask:0xa bank_mask:0xf
    v_mul_f32_dpp v29, v17, v29 row_newbcast:1 row_mask:0xa bank_mask:0xf
    v_mul_f32_dpp v30, v17, v30 row_newbcast:2 row_mask:0xa bank_mask:0xf
    v_mul_f32_dpp v31, v17, v31 row_newbcast:3 row_mask:0xa bank_mask:0xf
    v_mul_f32_dpp v32, v17, v32 row_newbcast:4 row_mask:0xa bank_mask:0xf
    v_mul_f32_dpp v33, v17, v33 row_newbcast:5 row_mask:0xa bank_mask:0xf
    v_mul_f32_dpp v34, v17, v34 row_newbcast:6 row_mask:0xa bank_mask:0xf
    v_mul_f32_dpp v35, v17, v35 row_newbcast:7 row_mask:0xa bank_mask:0xf
    v_cvt_pk_bf16_f32 v72, v28, v29
    v_cvt_pk_bf16_f32 v73, v30, v31
    v_cvt_pk_bf16_f32 v74, v32, v33
    v_cvt_pk_bf16_f32 v75, v34, v35
    s_waitcnt vmcnt(4)
    v_mfma_f32_32x32x16_bf16 v[0:15], v[64:67], v[176:179], 0
    ds_read_b64_tr_b16 v[184:185], v246 offset:2048
    ds_read_b64_tr_b16 v[186:187], v246 offset:3072
    ds_read_b64_tr_b16 v[188:189], v247 offset:2048
    ds_read_b64_tr_b16 v[190:191], v247 offset:3072
    s_mov_b32 m0, s68
    v_mfma_f32_32x32x16_bf16 v[16:31], v[68:71], v[176:179], 0
    buffer_load_dwordx4 v222, s[4:7], s42 offen sc1 lds
    buffer_load_dwordx4 v223, s[72:75], s42 offen offset:1024 sc1 lds
    v_permlane32_swap_b32 v242, v236
    v_permlane32_swap_b32 v243, v237
    v_mfma_f32_32x32x16_bf16 v[32:47], v[64:67], v[180:183], 0
    v_permlane32_swap_b32 v244, v238
    v_permlane32_swap_b32 v245, v239
    v_permlane32_swap_b32 v240, v241
    v_add_f32 v242, v242, v236
    v_mfma_f32_32x32x16_bf16 v[48:63], v[68:71], v[180:183], 0
    v_add_f32 v243, v243, v237
    v_add_f32 v244, v244, v238
    v_add_f32 v245, v245, v239
    v_add_f32 v240, -v240, -v241
    v_sub_u32 v241, v230, v231
    v_cvt_pk_bf16_f32 v242, v242, v243
    s_mov_b64 exec, 0x1ff
    ds_add_rtn_u32 v232, v254, v255
    s_mov_b64 exec, -1
    s_waitcnt vmcnt(4) lgkmcnt(1)
    v_mfma_f32_32x32x16_bf16 v[0:15], v[72:75], v[184:187], v[0:15]
    ds_read_b64_tr_b16 v[176:177], v246 offset:4096
    ds_read_b64_tr_b16 v[178:179], v246 offset:5120
    ds_read_b64_tr_b16 v[180:181], v247 offset:4096
    ds_read_b64_tr_b16 v[182:183], v247 offset:5120
    v_cvt_pk_bf16_f32 v244, v244, v245
    v_cvt_pk_bf16_f32 v240, v240, v240
    s_mov_b32 m0, s69
    v_mfma_f32_32x32x16_bf16 v[16:31], v[76:79], v[184:187], v[16:31]
    buffer_load_dwordx4 v224, s[4:7], s42 offen sc1 lds
    buffer_load_dwordx4 v225, s[72:75], s42 offen offset:1024 sc1 lds
    ds_write2st64_b32 v230, v242, v244 offset0:3 offset1:4
    ds_write_b16 v241, v240 offset:1280
    s_waitcnt lgkmcnt(6)
    v_readlane_b32 s58, v232, 8
    v_mfma_f32_32x32x16_bf16 v[32:47], v[72:75], v[188:191], v[32:47]
    s_cmp_lt_u32 s58, s22
    s_cbranch_scc0 K2_nul_55
    s_nop 0
    v_readlane_b32 s3, v253, s58
    s_nop 0
    s_bfe_u32 s58, s3, 0x60016
    s_and_b32 s59, s58, 7
    s_lshr_b32 s60, s58, 3
K2_chk_57:
    v_readlane_b32 s61, v232, s59
    s_nop 0
    s_cmp_gt_u32 s61, s60
    s_cbranch_scc0 K2_spin_56
K2_back_58:
    v_mfma_f32_32x32x16_bf16 v[48:63], v[76:79], v[188:191], v[48:63]
    s_setprio 0
    s_lshl_b32 s44, s34, 7
    s_and_b32 s48, s3, 0x3ffff
    s_bfe_u32 s33, s3, 0x30013
    s_mov_b32 s35, s48
    s_mov_b32 s45, s44
    s_xor_b32 s47, s44, 256
    v_mul_f32 v234, v0, v96
    v_mul_f32 v236, v8, v128
    v_fmac_f32 v234, v1, v97
    v_fmac_f32 v236, v9, v129
    v_fmac_f32 v234, v2, v98
    v_fmac_f32 v236, v10, v130
    v_fmac_f32 v234, v3, v99
    v_fmac_f32 v236, v11, v131
    v_fmac_f32 v234, v4, v100
    v_fmac_f32 v236, v12, v132
    v_fmac_f32 v234, v5, v101
    v_fmac_f32 v236, v13, v133
    v_fmac_f32 v234, v6, v102
    v_fmac_f32 v236, v14, v134
    v_fmac_f32 v234, v7, v103
    v_fmac_f32 v236, v15, v135
    v_mul_f32 v238, v16, v128
    v_mul_f32 v240, v24, v128
    v_fmac_f32 v238, v17, v129
    v_fmac_f32 v240, v25, v129
    v_fmac_f32 v238, v18, v130
    v_fmac_f32 v240, v26, v130
    v_fmac_f32 v238, v19, v131
    v_fmac_f32 v240, v27, v131
    v_fmac_f32 v238, v20, v132
    v_fmac_f32 v240, v28, v132
    v_fmac_f32 v238, v21, v133
    v_fmac_f32 v240, v29, v133
    v_fmac_f32 v238, v22, v134
    v_fmac_f32 v240, v30, v134
    v_fmac_f32 v238, v23, v135
    v_fmac_f32 v240, v31, v135
    v_mul_f32 v235, v32, v104
    v_mul_f32 v237, v40, v136
    v_fmac_f32 v235, v33, v105
    v_fmac_f32 v237, v41, v137
    v_fmac_f32 v235, v34, v106
    v_fmac_f32 v237, v42, v138
    v_fmac_f32 v235, v35, v107
    v_fmac_f32 v237, v43, v139
    v_fmac_f32 v235, v36, v108
    v_fmac_f32 v237, v44, v140
    v_fmac_f32 v235, v37, v109
    v_fmac_f32 v237, v45, v141
    v_fmac_f32 v235, v38, v110
    v_fmac_f32 v237, v46, v142
    v_fmac_f32 v235, v39, v111
    v_fmac_f32 v237, v47, v143
    v_mul_f32 v239, v48, v136
    v_mul_f32 v241, v56, v136
    v_fmac_f32 v239, v49, v137
    v_fmac_f32 v241, v57, v137
    s_setprio 1
    s_waitcnt vmcnt(4) lgkmcnt(2)
    v_mfma_f32_32x32x16_bf16 v[0:15], v[64:67], v[176:179], 0
    ds_read_b64_tr_b16 v[184:185], v246 offset:6144
    ds_read_b64_tr_b16 v[186:187], v246 offset:7168
    ds_read_b64_tr_b16 v[188:189], v247 offset:6144
    ds_read_b64_tr_b16 v[190:191], v247 offset:7168
    v_fmac_f32 v239, v50, v138
    v_fmac_f32 v241, v58, v138
    s_mov_b32 m0, s70
    v_mfma_f32_32x32x16_bf16 v[16:31], v[68:71], v[176:179], 0
    buffer_load_dwordx4 v222, s[4:7], s43 offen sc1 lds
    buffer_load_dwordx4 v223, s[72:75], s43 offen offset:1024 sc1 lds
    v_fmac_f32 v239, v51, v139
    v_fmac_f32 v241, v59, v139
    v_fmac_f32 v239, v52, v140
    v_fmac_f32 v241, v60, v140
    v_fmac_f32 v239, v53, v141
    v_mfma_f32_32x32x16_bf16 v[32:47], v[64:67], v[180:183], 0
    s_add_u32 s49, s48, 128
    s_add_u32 s60, s48, 256
    s_cmp_eq_u32 s33, 3
    s_cselect_b32 s46, s44, s47
    s_cselect_b32 s50, s60, s48
    s_sub_u32 s60, s33, 2
    s_cmp_lt_u32 s60, 2
    s_cbranch_scc0 K2_rare_59
K2_back_60:
    v_add_u32 v222, s48, v251
    ds_read2_b32 v[222:223], v222 offset0:1 offset1:3
    v_fmac_f32 v241, v61, v141
    v_fmac_f32 v239, v54, v142
    v_fmac_f32 v241, v62, v142
    v_fmac_f32 v239, v55, v143
    v_fmac_f32 v241, v63, v143
    v_mfma_f32_32x32x16_bf16 v[48:63], v[68:71], v[180:183], 0
    v_permlane32_swap_b32 v234, v236
    v_permlane32_swap_b32 v235, v237
    v_permlane32_swap_b32 v240, v238
    s_waitcnt vmcnt(4) lgkmcnt(1)
    v_mfma_f32_32x32x16_bf16 v[0:15], v[72:75], v[184:187], v[0:15]
    ds_read_b64_tr_b16 v[176:177], v246 offset:0
    ds_read_b64_tr_b16 v[178:179], v246 offset:1024
    ds_read_b64_tr_b16 v[180:181], v247 offset:0
    ds_read_b64_tr_b16 v[182:183], v247 offset:1024
    v_permlane32_swap_b32 v241, v239
    s_mov_b32 m0, s71
    v_mfma_f32_32x32x16_bf16 v[16:31], v[76:79], v[184:187], v[16:31]
    buffer_load_dwordx4 v224, s[4:7], s43 offen sc1 lds
    buffer_load_dwordx4 v225, s[72:75], s43 offen offset:1024 sc1 lds
    s_waitcnt lgkmcnt(4)
    v_mad_u32_u16 v222, v222, s39, v248 op_sel:[1,0,0,0]
    v_mad_u32_u16 v223, v223, s39, v248 op_sel:[1,0,0,0]
    v_lshl_add_u32 v230, v252, 1, s31
    v_add_f32 v234, v234, v236
    v_add_f32 v235, v235, v237
    v_add_f32 v240, v240, v238
    v_add_f32 v241, v241, v239
    v_cvt_pk_bf16_f32 v234, v234, v235
    v_cvt_pk_bf16_f32 v240, v240, v241
    ds_write2st64_b32 v230, v234, v240 offset0:0 offset1:1
    v_mfma_f32_32x32x16_bf16 v[32:47], v[72:75], v[188:191], v[32:47]
    v_add_u32 v224, s49, v251
    ds_read2_b32 v[224:225], v224 offset0:1 offset1:3
    v_mul_f32 v234, v0, v144
    v_mul_f32 v236, v8, v112
    v_fmac_f32 v234, v1, v145
    v_fmac_f32 v236, v9, v113
    v_fmac_f32 v234, v2, v146
    v_mfma_f32_32x32x16_bf16 v[48:63], v[76:79], v[188:191], v[48:63]
    s_setprio 0
    v_fmac_f32 v236, v10, v114
    v_fmac_f32 v234, v3, v147
    v_fmac_f32 v236, v11, v115
    v_fmac_f32 v234, v4, v148
    v_fmac_f32 v236, v12, v116
    v_fmac_f32 v234, v5, v149
    v_fmac_f32 v236, v13, v117
    v_fmac_f32 v234, v6, v150
    v_fmac_f32 v236, v14, v118
    v_fmac_f32 v234, v7, v151
    v_fmac_f32 v236, v15, v119
    v_mul_f32 v238, v16, v160
    v_mul_f32 v240, v24, v160
    v_fmac_f32 v238, v17, v161
    v_fmac_f32 v240, v25, v161
    v_fmac_f32 v238, v18, v162
    v_fmac_f32 v240, v26, v162
    v_fmac_f32 v238, v19, v163
    v_fmac_f32 v240, v27, v163
    v_fmac_f32 v238, v20, v164
    v_fmac_f32 v240, v28, v164
    v_fmac_f32 v238, v21, v165
    v_fmac_f32 v240, v29, v165
    v_fmac_f32 v238, v22, v166
    v_fmac_f32 v240, v30, v166
    v_fmac_f32 v238, v23, v167
    v_fmac_f32 v240, v31, v167
    v_mul_f32 v235, v32, v152
    v_mul_f32 v237, v40, v120
    v_fmac_f32 v235, v33, v153
    v_fmac_f32 v237, v41, v121
    v_fmac_f32 v235, v34, v154
    v_fmac_f32 v237, v42, v122
    v_fmac_f32 v235, v35, v155
    v_fmac_f32 v237, v43, v123
    v_fmac_f32 v235, v36, v156
    v_fmac_f32 v237, v44, v124
    v_fmac_f32 v235, v37, v157
    v_fmac_f32 v237, v45, v125
    v_fmac_f32 v235, v38, v158
    v_fmac_f32 v237, v46, v126
    v_fmac_f32 v235, v39, v159
    v_fmac_f32 v237, v47, v127
    v_mul_f32 v239, v48, v168
    v_mul_f32 v241, v56, v168
    v_fmac_f32 v239, v49, v169
    v_fmac_f32 v241, v57, v169
    v_fmac_f32 v239, v50, v170
    v_fmac_f32 v241, v58, v170
    v_fmac_f32 v239, v51, v171
    s_setprio 1
    s_waitcnt vmcnt(4) lgkmcnt(2)
    v_mfma_f32_32x32x16_bf16 v[0:15], v[64:67], v[176:179], 0
    ds_read_b64_tr_b16 v[184:185], v246 offset:2048
    ds_read_b64_tr_b16 v[186:187], v246 offset:3072
    ds_read_b64_tr_b16 v[188:189], v247 offset:2048
    ds_read_b64_tr_b16 v[190:191], v247 offset:3072
    v_fmac_f32 v241, v59, v171
    v_fmac_f32 v239, v52, v172
    s_mov_b32 m0, s68
    v_mfma_f32_32x32x16_bf16 v[16:31], v[68:71], v[176:179], 0
    buffer_load_dwordx4 v222, s[4:7], s44 offen sc1 lds
    buffer_load_dwordx4 v223, s[72:75], s44 offen offset:1024 sc1 lds
    s_waitcnt lgkmcnt(4)
    v_mad_u32_u16 v224, v224, s39, v248 op_sel:[1,0,0,0]
    v_mad_u32_u16 v225, v225, s39, v248 op_sel:[1,0,0,0]
    v_fmac_f32 v241, v60, v172
    v_fmac_f32 v239, v53, v173
    v_mfma_f32_32x32x16_bf16 v[32:47], v[64:67], v[180:183], 0
    v_add_u32 v226, s50, v251
    ds_read2_b32 v[226:227], v226 offset0:1 offset1:3
    v_fmac_f32 v241, v61, v173
    v_fmac_f32 v239, v54, v174
    v_fmac_f32 v241, v62, v174
    v_fmac_f32 v239, v55, v175
    v_fmac_f32 v241, v63, v175
    v_mfma_f32_32x32x16_bf16 v[48:63], v[68:71], v[180:183], 0
    s_waitcnt vmcnt(4) lgkmcnt(1)
    v_mfma_f32_32x32x16_bf16 v[0:15], v[72:75], v[184:187], v[0:15]
    ds_read_b64_tr_b16 v[176:177], v246 offset:4096
    ds_read_b64_tr_b16 v[178:179], v246 offset:5120
    ds_read_b64_tr_b16 v[180:181], v247 offset:4096
    ds_read_b64_tr_b16 v[182:183], v247 offset:5120
    s_mov_b32 m0, s69
    v_mfma_f32_32x32x16_bf16 v[16:31], v[76:79], v[184:187], v[16:31]
    buffer_load_dwordx4 v224, s[4:7], s45 offen sc1 lds
    buffer_load_dwordx4 v225, s[72:75], s45 offen offset:1024 sc1 lds
    s_waitcnt lgkmcnt(4)
    v_mad_u32_u16 v226, v226, s39, v248 op_sel:[1,0,0,0]
    v_mad_u32_u16 v227, v227, s39, v248 op_sel:[1,0,0,0]
    v_mfma_f32_32x32x16_bf16 v[32:47], v[72:75], v[188:191], v[32:47]
    v_mul_f32 v242, v0, v144
    v_fma_f32 v238, v8, v160, -v238
    v_fmac_f32 v242, v1, v145
    v_fmac_f32 v238, v9, v161
    v_fmac_f32 v242, v2, v146
    v_fmac_f32 v238, v10, v162
    v_fmac_f32 v242, v3, v147
    v_mfma_f32_32x32x16_bf16 v[48:63], v[76:79], v[188:191], v[48:63]
    s_setprio 0
    v_fmac_f32 v238, v11, v163
    v_fmac_f32 v242, v4, v148
    v_fmac_f32 v238, v12, v164
    v_fmac_f32 v242, v5, v149
    v_fmac_f32 v238, v13, v165
    v_fmac_f32 v242, v6, v150
    v_fmac_f32 v238, v14, v166
    v_fmac_f32 v242, v7, v151
    v_fmac_f32 v238, v15, v167
    v_fmac_f32 v236, v16, v112
    v_mul_f32 v244, v24, v160
    v_fmac_f32 v236, v17, v113
    v_fmac_f32 v244, v25, v161
    v_fmac_f32 v236, v18, v114
    v_fmac_f32 v244, v26, v162
    v_fmac_f32 v236, v19, v115
    v_fmac_f32 v244, v27, v163
    v_fmac_f32 v236, v20, v116
    v_fmac_f32 v244, v28, v164
    v_fmac_f32 v236, v21, v117
    v_fmac_f32 v244, v29, v165
    v_fmac_f32 v236, v22, v118
    v_fmac_f32 v244, v30, v166
    v_fmac_f32 v236, v23, v119
    v_fmac_f32 v244, v31, v167
    v_mul_f32 v243, v32, v152
    v_fma_f32 v239, v40, v168, -v239
    v_fmac_f32 v243, v33, v153
    v_fmac_f32 v239, v41, v169
    v_fmac_f32 v243, v34, v154
    v_fmac_f32 v239, v42, v170
    v_fmac_f32 v243, v35, v155
    v_fmac_f32 v239, v43, v171
    v_fmac_f32 v243, v36, v156
    v_fmac_f32 v239, v44, v172
    v_fmac_f32 v243, v37, v157
    v_fmac_f32 v239, v45, v173
    v_fmac_f32 v243, v38, v158
    v_fmac_f32 v239, v46, v174
    v_fmac_f32 v243, v39, v159
    v_fmac_f32 v239, v47, v175
    v_fmac_f32 v237, v48, v120
    v_mul_f32 v245, v56, v168
    s_setprio 1
    s_waitcnt vmcnt(4) lgkmcnt(0)
    v_mfma_f32_32x32x16_bf16 v[0:15], v[64:67], v[176:179], 0
    ds_read_b64_tr_b16 v[184:185], v246 offset:6144
    ds_read_b64_tr_b16 v[186:187], v246 offset:7168
    ds_read_b64_tr_b16 v[188:189], v247 offset:6144
    ds_read_b64_tr_b16 v[190:191], v247 offset:7168
    v_fmac_f32 v237, v49, v121
    v_fmac_f32 v245, v57, v169
    s_mov_b32 m0, s70
    v_mfma_f32_32x32x16_bf16 v[16:31], v[68:71], v[176:179], 0
    buffer_load_dwordx4 v226, s[4:7], s46 offen sc1 lds
    buffer_load_dwordx4 v227, s[72:75], s46 offen offset:1024 sc1 lds
    v_fmac_f32 v237, v50, v122
    v_fmac_f32 v245, v58, v170
    v_fmac_f32 v237, v51, v123
    v_fmac_f32 v245, v59, v171
    v_fmac_f32 v237, v52, v124
    v_mfma_f32_32x32x16_bf16 v[32:47], v[64:67], v[180:183], 0
    v_fmac_f32 v245, v60, v172
    v_fmac_f32 v237, v53, v125
    v_fmac_f32 v245, v61, v173
    v_fmac_f32 v237, v54, v126
    v_fmac_f32 v245, v62, v174
    v_fmac_f32 v237, v55, v127
    v_fmac_f32 v245, v63, v175
    v_mfma_f32_32x32x16_bf16 v[48:63], v[68:71], v[180:183], 0
    v_permlane32_swap_b32 v242, v234
    v_permlane32_swap_b32 v243, v235
    v_add_f32 v242, v242, v234
    v_add_f32 v243, v243, v235
    s_waitcnt vmcnt(4) lgkmcnt(0)
    v_mfma_f32_32x32x16_bf16 v[0:15], v[72:75], v[184:187], v[0:15]
    ds_read_b64_tr_b16 v[176:177], v246 offset:0
    ds_read_b64_tr_b16 v[178:179], v246 offset:1024
    ds_read_b64_tr_b16 v[180:181], v247 offset:0
    ds_read_b64_tr_b16 v[182:183], v247 offset:1024
    v_cvt_pk_bf16_f32 v242, v242, v243
    ds_write_b32 v230, v242 offset:512
    s_mov_b32 m0, s71
    v_mfma_f32_32x32x16_bf16 v[16:31], v[76:79], v[184:187], v[16:31]
    s_cmp_eq_u32 s33, 4
    s_cbranch_scc1 K2_g4_62
    buffer_load_dwordx4 v224, s[4:7], s47 offen sc1 lds
    buffer_load_dwordx4 v225, s[72:75], s47 offen offset:1024 sc1 lds
K2_back_63:
    s_sub_u32 s26, s48, s29
    s_mov_b32 s29, s48
    s_mov_b32 s30, s3
    s_bfe_u32 s56, s3, 0x40012
    s_cmp_lg_u32 s36, 0
    s_cselect_b32 s56, s56, 0
    v_mfma_f32_32x32x16_bf16 v[32:47], v[72:75], v[188:191], v[32:47]
    s_mov_b32 s32, s31
    s_mov_b32 s31, s35
    v_mul_f32 v242, v0, v144
    v_fma_f32 v240, v8, v160, -v240
    v_fmac_f32 v242, v1, v145
    v_fmac_f32 v240, v9, v161
    v_fmac_f32 v242, v2, v146
    v_mfma_f32_32x32x16_bf16 v[48:63], v[76:79], v[188:191], v[48:63]
    s_setprio 0
    v_fmac_f32 v240, v10, v162
    v_fmac_f32 v242, v3, v147
    v_fmac_f32 v240, v11, v163
    v_fmac_f32 v242, v4, v148
    v_fmac_f32 v240, v12, v164
    v_fmac_f32 v242, v5, v149
    v_fmac_f32 v240, v13, v165
    v_fmac_f32 v242, v6, v150
    v_fmac_f32 v240, v14, v166
    v_fmac_f32 v242, v7, v151
    v_fmac_f32 v240, v15, v167
    v_add_u32 v249, s26, v249
    v_add_u32 v250, s26, v250
    v_fma_f32 v244, v16, v160, -v244
    v_fmac_f32 v236, v24, v112
    v_fmac_f32 v244, v17, v161
    v_fmac_f32 v236, v25, v113
    v_fmac_f32 v244, v18, v162
    v_fmac_f32 v236, v26, v114
    v_fmac_f32 v244, v19, v163
    v_fmac_f32 v236, v27, v115
    v_fmac_f32 v244, v20, v164
    v_fmac_f32 v236, v28, v116
    v_fmac_f32 v244, v21, v165
    v_fmac_f32 v236, v29, v117
    v_fmac_f32 v244, v22, v166
    v_fmac_f32 v236, v30, v118
    v_fmac_f32 v244, v23, v167
    v_fmac_f32 v236, v31, v119
    ds_read_b64_tr_b16 v[0:1], v249 offset:0
    ds_read_b64_tr_b16 v[2:3], v249 offset:32
    ds_read_u16_d16_hi v16, v250 offset:0
    v_mul_f32 v243, v32, v152
    v_fma_f32 v241, v40, v168, -v241
    v_fmac_f32 v243, v33, v153
    v_fmac_f32 v241, v41, v169
    v_fmac_f32 v243, v34, v154
    v_fmac_f32 v241, v42, v170
    v_fmac_f32 v243, v35, v155
    v_fmac_f32 v241, v43, v171
    v_fmac_f32 v243, v36, v156
    v_fmac_f32 v241, v44, v172
    v_fmac_f32 v243, v37, v157
    v_fmac_f32 v241, v45, v173
    v_fmac_f32 v243, v38, v158
    v_fmac_f32 v241, v46, v174
    v_fmac_f32 v243, v39, v159
    v_fmac_f32 v241, v47, v175
    ds_read_b64_tr_b16 v[4:5], v249 offset:512
    ds_read_b64_tr_b16 v[6:7], v249 offset:544
    ds_read_u16_d16_hi v17, v250 offset:128
    v_fma_f32 v245, v48, v168, -v245
    v_fmac_f32 v237, v56, v120
    v_fmac_f32 v245, v49, v169
    v_fmac_f32 v237, v57, v121
    v_fmac_f32 v245, v50, v170
    v_fmac_f32 v237, v58, v122
    v_fmac_f32 v245, v51, v171
    v_fmac_f32 v237, v59, v123
    v_fmac_f32 v245, v52, v172
    v_fmac_f32 v237, v60, v124
    v_fmac_f32 v245, v53, v173
    v_fmac_f32 v237, v61, v125
    v_fmac_f32 v245, v54, v174
    v_fmac_f32 v237, v62, v126
    v_fmac_f32 v245, v55, v175
    v_fmac_f32 v237, v63, v127
    s_cmp_eq_u32 s56, 5
    s_cbranch_scc1 K2_U21
    s_cmp_eq_u32 s56, 6
    s_cbranch_scc1 K2_U3h1
    s_branch K2_DSP1
K2_PAD_U31:
    s_branch K2_HOP
K2_U3h1:
    s_setprio 1
    ds_read_b64_tr_b16 v[8:9], v249 offset:1024
    ds_read_u16_d16_hi v18, v250 offset:256
    s_waitcnt lgkmcnt(2)
    v_lshlrev_b32 v20, 16, v0
    v_and_b32 v21, 0xffff0000, v0
    v_lshlrev_b32 v22, 16, v1
    v_and_b32 v23, 0xffff0000, v1
    v_lshlrev_b32 v24, 16, v2
    v_and_b32 v25, 0xffff0000, v2
    v_lshlrev_b32 v26, 16, v3
    v_and_b32 v27, 0xffff0000, v3
    v_mul_f32_dpp v36, v16, v20 row_newbcast:8 row_mask:0xf bank_mask:0xf
    v_mul_f32_dpp v37, v16, v21 row_newbcast:9 row_mask:0xf bank_mask:0xf
    v_mul_f32_dpp v38, v16, v22 row_newbcast:10 row_mask:0xf bank_mask:0xf
    v_mul_f32_dpp v39, v16, v23 row_newbcast:11 row_mask:0xf bank_mask:0xf
    v_mul_f32_dpp v40, v16, v24 row_newbcast:12 row_mask:0xf bank_mask:0xf
    v_mul_f32_dpp v41, v16, v25 row_newbcast:13 row_mask:0xf bank_mask:0xf
    v_mul_f32_dpp v42, v16, v26 row_newbcast:14 row_mask:0xf bank_mask:0xf
    v_mul_f32_dpp v43, v16, v27 row_newbcast:15 row_mask:0xf bank_mask:0xf
    v_cvt_pk_bf16_f32 v68, v36, v37
    v_cvt_pk_bf16_f32 v69, v38, v39
    v_cvt_pk_bf16_f32 v70, v40, v41
    v_cvt_pk_bf16_f32 v71, v42, v43
    v_mul_f32_dpp v20, v16, v20 row_newbcast:0 row_mask:0xa bank_mask:0xf
    v_mul_f32_dpp v21, v16, v21 row_newbcast:1 row_mask:0xa bank_mask:0xf
    v_mul_f32_dpp v22, v16, v22 row_newbcast:2 row_mask:0xa bank_mask:0xf
    v_mul_f32_dpp v23, v16, v23 row_newbcast:3 row_mask:0xa bank_mask:0xf
    v_mul_f32_dpp v24, v16, v24 row_newbcast:4 row_mask:0xa bank_mask:0xf
    v_mul_f32_dpp v25, v16, v25 row_newbcast:5 row_mask:0xa bank_mask:0xf
    v_mul_f32_dpp v26, v16, v26 row_newbcast:6 row_mask:0xa bank_mask:0xf
    v_mul_f32_dpp v27, v16, v27 row_newbcast:7 row_mask:0xa bank_mask:0xf
    v_cvt_pk_bf16_f32 v64, v20, v21
    v_cvt_pk_bf16_f32 v65, v22, v23
    v_cvt_pk_bf16_f32 v66, v24, v25
    v_cvt_pk_bf16_f32 v67, v26, v27
    v_lshlrev_b32 v28, 16, v4
    v_and_b32 v29, 0xffff0000, v4
    v_lshlrev_b32 v30, 16, v5
    v_and_b32 v31, 0xffff0000, v5
    v_lshlrev_b32 v32, 16, v6
    v_and_b32 v33, 0xffff0000, v6
    v_lshlrev_b32 v34, 16, v7
    v_and_b32 v35, 0xffff0000, v7
    v_mul_f32_dpp v36, v17, v28 row_newbcast:8 row_mask:0xf bank_mask:0xf
    v_mul_f32_dpp v37, v17, v29 row_newbcast:9 row_mask:0xf bank_mask:0xf
    v_mul_f32_dpp v38, v17, v30 row_newbcast:10 row_mask:0xf bank_mask:0xf
    v_mul_f32_dpp v39, v17, v31 row_newbcast:11 row_mask:0xf bank_mask:0xf
    v_mul_f32_dpp v40, v17, v32 row_newbcast:12 row_mask:0xf bank_mask:0xf
    v_mul_f32_dpp v41, v17, v33 row_newbcast:13 row_mask:0xf bank_mask:0xf
    v_mul_f32_dpp v42, v17, v34 row_newbcast:14 row_mask:0xf bank_mask:0xf
    v_mul_f32_dpp v43, v17, v35 row_newbcast:15 row_mask:0xf bank_mask:0xf
    v_cvt_pk_bf16_f32 v76, v36, v37
    v_cvt_pk_bf16_f32 v77, v38, v39
    v_cvt_pk_bf16_f32 v78, v40, v41
    v_cvt_pk_bf16_f32 v79, v42, v43
    v_mul_f32_dpp v28, v17, v28 row_newbcast:0 row_mask:0xa bank_mask:0xf
    v_mul_f32_dpp v29, v17, v29 row_newbcast:1 row_mask:0xa bank_mask:0xf
    v_mul_f32_dpp v30, v17, v30 row_newbcast:2 row_mask:0xa bank_mask:0xf
    v_mul_f32_dpp v31, v17, v31 row_newbcast:3 row_mask:0xa bank_mask:0xf
    v_mul_f32_dpp v32, v17, v32 row_newbcast:4 row_mask:0xa bank_mask:0xf
    v_mul_f32_dpp v33, v17, v33 row_newbcast:5 row_mask:0xa bank_mask:0xf
    v_mul_f32_dpp v34, v17, v34 row_newbcast:6 row_mask:0xa bank_mask:0xf
    v_mul_f32_dpp v35, v17, v35 row_newbcast:7 row_mask:0xa bank_mask:0xf
    v_cvt_pk_bf16_f32 v72, v28, v29
    v_cvt_pk_bf16_f32 v73, v30, v31
    v_cvt_pk_bf16_f32 v74, v32, v33
    v_cvt_pk_bf16_f32 v75, v34, v35
    s_waitcnt lgkmcnt(0)
    v_lshlrev_b32 v20, 16, v8
    v_and_b32 v21, 0xffff0000, v8
    v_lshlrev_b32 v22, 16, v9
    v_and_b32 v23, 0xffff0000, v9
    v_mul_f32_dpp v36, v18, v20 row_newbcast:8 row_mask:0xf bank_mask:0xf
    v_mul_f32_dpp v37, v18, v21 row_newbcast:9 row_mask:0xf bank_mask:0xf
    v_mul_f32_dpp v38, v18, v22 row_newbcast:10 row_mask:0xf bank_mask:0xf
    v_mul_f32_dpp v39, v18, v23 row_newbcast:11 row_mask:0xf bank_mask:0xf
    v_cvt_pk_bf16_f32 v84, v36, v37
    v_cvt_pk_bf16_f32 v85, v38, v39
    v_mul_f32_dpp v20, v18, v20 row_newbcast:0 row_mask:0xa bank_mask:0xf
    v_mul_f32_dpp v21, v18, v21 row_newbcast:1 row_mask:0xa bank_mask:0xf
    v_mul_f32_dpp v22, v18, v22 row_newbcast:2 row_mask:0xa bank_mask:0xf
    v_mul_f32_dpp v23, v18, v23 row_newbcast:3 row_mask:0xa bank_mask:0xf
    v_cvt_pk_bf16_f32 v80, v20, v21
    v_cvt_pk_bf16_f32 v81, v22, v23
    s_waitcnt vmcnt(4)
    v_mfma_f32_32x32x16_bf16 v[0:15], v[64:67], v[176:179], 0
    ds_read_b64_tr_b16 v[184:185], v246 offset:2048
    ds_read_b64_tr_b16 v[186:187], v246 offset:3072
    ds_read_b64_tr_b16 v[188:189], v247 offset:2048
    ds_read_b64_tr_b16 v[190:191], v247 offset:3072
    s_mov_b32 m0, s68
    v_mfma_f32_32x32x16_bf16 v[16:31], v[68:71], v[176:179], 0
    buffer_load_dwordx4 v222, s[4:7], s41 offen sc1 lds
    buffer_load_dwordx4 v223, s[72:75], s41 offen offset:1024 sc1 lds
    v_permlane32_swap_b32 v242, v236
    v_permlane32_swap_b32 v243, v237
    v_mfma_f32_32x32x16_bf16 v[32:47], v[64:67], v[180:183], 0
    v_permlane32_swap_b32 v244, v238
    v_permlane32_swap_b32 v245, v239
    v_permlane32_swap_b32 v240, v241
    v_add_f32 v242, v242, v236
    v_mfma_f32_32x32x16_bf16 v[48:63], v[68:71], v[180:183], 0
    v_add_f32 v243, v243, v237
    v_add_f32 v244, v244, v238
    v_add_f32 v245, v245, v239
    v_add_f32 v240, -v240, -v241
    v_sub_u32 v241, v230, v231
    v_cvt_pk_bf16_f32 v242, v242, v243
    s_mov_b64 exec, 0x1ff
    ds_add_rtn_u32 v232, v254, v255
    s_mov_b64 exec, -1
    s_waitcnt vmcnt(4) lgkmcnt(1)
    v_mfma_f32_32x32x16_bf16 v[0:15], v[72:75], v[184:187], v[0:15]
    ds_read_b64_tr_b16 v[176:177], v246 offset:4096
    ds_read_b64_tr_b16 v[180:181], v247 offset:4096
    v_cvt_pk_bf16_f32 v244, v244, v245
    v_cvt_pk_bf16_f32 v240, v240, v240
    ds_write2st64_b32 v230, v242, v244 offset0:3 offset1:4
    ds_write_b16 v241, v240 offset:1280
    s_mov_b32 m0, s69
    v_mfma_f32_32x32x16_bf16 v[16:31], v[76:79], v[184:187], v[16:31]
    buffer_load_dwordx4 v226, s[4:7], s41 offen sc1 lds
    s_waitcnt lgkmcnt(4)
    v_readlane_b32 s58, v232, 8
    v_mfma_f32_32x32x16_bf16 v[32:47], v[72:75], v[188:191], v[32:47]
    s_cmp_lt_u32 s58, s22
    s_cbranch_scc0 K2_nul_64
    s_nop 0
    v_readlane_b32 s3, v253, s58
    s_nop 0
    s_bfe_u32 s58, s3, 0x60016
    s_and_b32 s59, s58, 7
    s_lshr_b32 s60, s58, 3
K2_chk_66:
    v_readlane_b32 s61, v232, s59
    s_nop 0
    s_cmp_gt_u32 s61, s60
    s_cbranch_scc0 K2_spin_65
K2_back_67:
    v_mfma_f32_32x32x16_bf16 v[48:63], v[76:79], v[188:191], v[48:63]
    s_lshl_b32 s44, s34, 7
    s_and_b32 s48, s3, 0x3ffff
    s_bfe_u32 s33, s3, 0x30013
    s_mov_b32 s35, s48
    s_mov_b32 s45, s44
    s_xor_b32 s47, s44, 256
    s_waitcnt vmcnt(3) lgkmcnt(2)
    v_mfma_f32_32x32x8_bf16 v[0:15], v[80:81], v[176:177], v[0:15]
    ds_read_b64_tr_b16 v[184:185], v246 offset:6144
    ds_read_b64_tr_b16 v[186:187], v246 offset:7168
    ds_read_b64_tr_b16 v[188:189], v247 offset:6144
    ds_read_b64_tr_b16 v[190:191], v247 offset:7168
    s_add_u32 s49, s48, 128
    s_add_u32 s60, s48, 256
    s_mov_b32 m0, s70
    v_mfma_f32_32x32x8_bf16 v[16:31], v[84:85], v[176:177], v[16:31]
    buffer_load_dwordx4 v222, s[4:7], s42 offen sc1 lds
    buffer_load_dwordx4 v223, s[72:75], s42 offen offset:1024 sc1 lds
    s_cmp_eq_u32 s33, 3
    s_cselect_b32 s46, s44, s47
    s_cselect_b32 s50, s60, s48
    v_mfma_f32_32x32x8_bf16 v[32:47], v[80:81], v[180:181], v[32:47]
    s_sub_u32 s60, s33, 2
    s_cmp_lt_u32 s60, 2
    s_cbranch_scc0 K2_rare_68
K2_back_69:
    v_mul_f32 v234, v0, v96
    v_mul_f32 v236, v8, v128
    v_fmac_f32 v234, v1, v97
    v_fmac_f32 v236, v9, v129
    v_mfma_f32_32x32x8_bf16 v[48:63], v[84:85], v[180:181], v[48:63]
    s_setprio 0
    v_fmac_f32 v234, v2, v98
    v_fmac_f32 v236, v10, v130
    v_fmac_f32 v234, v3, v99
    v_fmac_f32 v236, v11, v131
    v_fmac_f32 v234, v4, v100
    v_fmac_f32 v236, v12, v132
    v_fmac_f32 v234, v5, v101
    v_fmac_f32 v236, v13, v133
    v_fmac_f32 v234, v6, v102
    v_fmac_f32 v236, v14, v134
    v_fmac_f32 v234, v7, v103
    v_fmac_f32 v236, v15, v135
    v_mul_f32 v238, v16, v128
    v_mul_f32 v240, v24, v128
    v_fmac_f32 v238, v17, v129
    v_fmac_f32 v240, v25, v129
    v_fmac_f32 v238, v18, v130
    v_fmac_f32 v240, v26, v130
    v_fmac_f32 v238, v19, v131
    v_fmac_f32 v240, v27, v131
    v_fmac_f32 v238, v20, v132
    v_fmac_f32 v240, v28, v132
    v_fmac_f32 v238, v21, v133
    v_fmac_f32 v240, v29, v133
    v_fmac_f32 v238, v22, v134
    v_fmac_f32 v240, v30, v134
    v_fmac_f32 v238, v23, v135
    v_fmac_f32 v240, v31, v135
    v_mul_f32 v235, v32, v104
    v_mul_f32 v237, v40, v136
    v_fmac_f32 v235, v33, v105
    v_fmac_f32 v237, v41, v137
    v_fmac_f32 v235, v34, v106
    v_fmac_f32 v237, v42, v138
    v_fmac_f32 v235, v35, v107
    v_fmac_f32 v237, v43, v139
    v_fmac_f32 v235, v36, v108
    v_fmac_f32 v237, v44, v140
    v_fmac_f32 v235, v37, v109
    v_fmac_f32 v237, v45, v141
    v_fmac_f32 v235, v38, v110
    v_fmac_f32 v237, v46, v142
    v_fmac_f32 v235, v39, v111
    v_fmac_f32 v237, v47, v143
    v_mul_f32 v239, v48, v136
    v_mul_f32 v241, v56, v136
    s_setprio 1
    s_waitcnt vmcnt(3) lgkmcnt(0)
    v_mfma_f32_32x32x16_bf16 v[0:15], v[72:75], v[184:187], 0
    ds_read_b64_tr_b16 v[176:177], v246 offset:0
    ds_read_b64_tr_b16 v[178:179], v246 offset:1024
    ds_read_b64_tr_b16 v[180:181], v247 offset:0
    ds_read_b64_tr_b16 v[182:183], v247 offset:1024
    v_fmac_f32 v239, v49, v137
    v_fmac_f32 v241, v57, v137
    s_mov_b32 m0, s71
    v_mfma_f32_32x32x16_bf16 v[16:31], v[76:79], v[184:187], 0
    buffer_load_dwordx4 v224, s[4:7], s42 offen sc1 lds
    buffer_load_dwordx4 v225, s[72:75], s42 offen offset:1024 sc1 lds
    v_fmac_f32 v239, v50, v138
    v_fmac_f32 v241, v58, v138
    v_fmac_f32 v239, v51, v139
    v_fmac_f32 v241, v59, v139
    v_fmac_f32 v239, v52, v140
    v_mfma_f32_32x32x16_bf16 v[32:47], v[72:75], v[188:191], 0
    v_fmac_f32 v241, v60, v140
    v_fmac_f32 v239, v53, v141
    v_fmac_f32 v241, v61, v141
    v_fmac_f32 v239, v54, v142
    v_fmac_f32 v241, v62, v142
    v_fmac_f32 v239, v55, v143
    v_fmac_f32 v241, v63, v143
    v_mfma_f32_32x32x16_bf16 v[48:63], v[76:79], v[188:191], 0
    v_permlane32_swap_b32 v234, v236
    v_permlane32_swap_b32 v235, v237
    v_permlane32_swap_b32 v240, v238
    s_waitcnt vmcnt(4) lgkmcnt(0)
    v_mfma_f32_32x32x16_bf16 v[0:15], v[64:67], v[176:179], v[0:15]
    ds_read_b64_tr_b16 v[184:185], v246 offset:2048
    ds_read_b64_tr_b16 v[188:189], v247 offset:2048
    v_permlane32_swap_b32 v241, v239
    v_lshl_add_u32 v230, v252, 1, s31
    v_add_f32 v234, v234, v236
    s_mov_b32 m0, s68
    v_mfma_f32_32x32x16_bf16 v[16:31], v[68:71], v[176:179], v[16:31]
    buffer_load_dwordx4 v226, s[4:7], s42 offen sc1 lds
    v_add_f32 v235, v235, v237
    v_add_f32 v240, v240, v238
    v_add_f32 v241, v241, v239
    v_cvt_pk_bf16_f32 v234, v234, v235
    v_cvt_pk_bf16_f32 v240, v240, v241
    ds_write2st64_b32 v230, v234, v240 offset0:0 offset1:1
    v_mfma_f32_32x32x16_bf16 v[32:47], v[64:67], v[180:183], v[32:47]
    v_mfma_f32_32x32x16_bf16 v[48:63], v[68:71], v[180:183], v[48:63]
    s_waitcnt vmcnt(3) lgkmcnt(1)
    v_mfma_f32_32x32x8_bf16 v[0:15], v[80:81], v[184:185], v[0:15]
    ds_read_b64_tr_b16 v[176:177], v246 offset:4096
    ds_read_b64_tr_b16 v[178:179], v246 offset:5120
    ds_read_b64_tr_b16 v[180:181], v247 offset:4096
    ds_read_b64_tr_b16 v[182:183], v247 offset:5120
    s_mov_b32 m0, s69
    v_mfma_f32_32x32x8_bf16 v[16:31], v[84:85], v[184:185], v[16:31]
    buffer_load_dwordx4 v222, s[4:7], s43 offen sc1 lds
    buffer_load_dwordx4 v223, s[72:75], s43 offen offset:1024 sc1 lds
    v_mfma_f32_32x32x8_bf16 v[32:47], v[80:81], v[188:189], v[32:47]
    s_nop 2
    v_mul_f32 v234, v0, v144
    v_mul_f32 v236, v8, v112
    v_fmac_f32 v234, v1, v145
    v_fmac_f32 v236, v9, v113
    v_fmac_f32 v234, v2, v146
    v_fmac_f32 v236, v10, v114
    v_fmac_f32 v234, v3, v147
    v_mfma_f32_32x32x8_bf16 v[48:63], v[84:85], v[188:189], v[48:63]
    s_setprio 0
    v_fmac_f32 v236, v11, v115
    v_fmac_f32 v234, v4, v148
    v_fmac_f32 v236, v12, v116
    v_fmac_f32 v234, v5, v149
    v_fmac_f32 v236, v13, v117
    v_fmac_f32 v234, v6, v150
    v_fmac_f32 v236, v14, v118
    v_fmac_f32 v234, v7, v151
    v_fmac_f32 v236, v15, v119
    v_mul_f32 v238, v16, v160
    v_mul_f32 v240, v24, v160
    v_fmac_f32 v238, v17, v161
    v_fmac_f32 v240, v25, v161
    v_fmac_f32 v238, v18, v162
    v_fmac_f32 v240, v26, v162
    v_fmac_f32 v238, v19, v163
    v_fmac_f32 v240, v27, v163
    v_fmac_f32 v238, v20, v164
    v_fmac_f32 v240, v28, v164
    v_fmac_f32 v238, v21, v165
    v_fmac_f32 v240, v29, v165
    v_fmac_f32 v238, v22, v166
    v_fmac_f32 v240, v30, v166
    v_fmac_f32 v238, v23, v167
    v_fmac_f32 v240, v31, v167
    v_mul_f32 v235, v32, v152
    v_mul_f32 v237, v40, v120
    v_fmac_f32 v235, v33, v153
    v_fmac_f32 v237, v41, v121
    v_fmac_f32 v235, v34, v154
    v_fmac_f32 v237, v42, v122
    v_fmac_f32 v235, v35, v155
    v_fmac_f32 v237, v43, v123
    v_fmac_f32 v235, v36, v156
    v_fmac_f32 v237, v44, v124
    v_fmac_f32 v235, v37, v157
    v_fmac_f32 v237, v45, v125
    v_fmac_f32 v235, v38, v158
    v_fmac_f32 v237, v46, v126
    v_fmac_f32 v235, v39, v159
    v_fmac_f32 v237, v47, v127
    v_mul_f32 v239, v48, v168
    v_mul_f32 v241, v56, v168
    v_fmac_f32 v239, v49, v169
    v_fmac_f32 v241, v57, v169
    s_setprio 1
    s_waitcnt vmcnt(3) lgkmcnt(0)
    v_mfma_f32_32x32x16_bf16 v[0:15], v[64:67], v[176:179], 0
    ds_read_b64_tr_b16 v[184:185], v246 offset:6144
    ds_read_b64_tr_b16 v[186:187], v246 offset:7168
    ds_read_b64_tr_b16 v[188:189], v247 offset:6144
    ds_read_b64_tr_b16 v[190:191], v247 offset:7168
    v_fmac_f32 v239, v50, v170
    v_fmac_f32 v241, v58, v170
    s_mov_b32 m0, s70
    v_mfma_f32_32x32x16_bf16 v[16:31], v[68:71], v[176:179], 0
    buffer_load_dwordx4 v224, s[4:7], s43 offen sc1 lds
    buffer_load_dwordx4 v225, s[72:75], s43 offen offset:1024 sc1 lds
    v_fmac_f32 v239, v51, v171
    v_fmac_f32 v241, v59, v171
    v_fmac_f32 v239, v52, v172
    v_fmac_f32 v241, v60, v172
    v_fmac_f32 v239, v53, v173
    v_mfma_f32_32x32x16_bf16 v[32:47], v[64:67], v[180:183], 0
    v_add_u32 v222, s48, v251
    ds_read2_b32 v[222:223], v222 offset0:1 offset1:3
    v_fmac_f32 v241, v61, v173
    v_fmac_f32 v239, v54, v174
    v_fmac_f32 v241, v62, v174
    v_fmac_f32 v239, v55, v175
    v_fmac_f32 v241, v63, v175
    v_mfma_f32_32x32x16_bf16 v[48:63], v[68:71], v[180:183], 0
    s_waitcnt vmcnt(4) lgkmcnt(1)
    v_mfma_f32_32x32x16_bf16 v[0:15], v[72:75], v[184:187], v[0:15]
    ds_read_b64_tr_b16 v[176:177], v246 offset:0
    ds_read_b64_tr_b16 v[180:181], v247 offset:0
    s_mov_b32 m0, s71
    v_mfma_f32_32x32x16_bf16 v[16:31], v[76:79], v[184:187], v[16:31]
    buffer_load_dwordx4 v226, s[4:7], s43 offen sc1 lds
    s_waitcnt lgkmcnt(2)
    v_mad_u32_u16 v222, v222, s39, v248 op_sel:[1,0,0,0]
    v_mad_u32_u16 v223, v223, s39, v248 op_sel:[1,0,0,0]
    v_mfma_f32_32x32x16_bf16 v[32:47], v[72:75], v[188:191], v[32:47]
    v_add_u32 v224, s49, v251
    ds_read2_b32 v[224:225], v224 offset0:1 offset1:3
    v_mfma_f32_32x32x16_bf16 v[48:63], v[76:79], v[188:191], v[48:63]
    s_waitcnt vmcnt(3) lgkmcnt(1)
    v_mfma_f32_32x32x8_bf16 v[0:15], v[80:81], v[176:177], v[0:15]
    ds_read_b64_tr_b16 v[184:185], v246 offset:2048
    ds_read_b64_tr_b16 v[186:187], v246 offset:3072
    ds_read_b64_tr_b16 v[188:189], v247 offset:2048
    ds_read_b64_tr_b16 v[190:191], v247 offset:3072
    s_mov_b32 m0, s68
    v_mfma_f32_32x32x8_bf16 v[16:31], v[84:85], v[176:177], v[16:31]
    buffer_load_dwordx4 v222, s[4:7], s44 offen sc1 lds
    buffer_load_dwordx4 v223, s[72:75], s44 offen offset:1024 sc1 lds
    s_waitcnt lgkmcnt(4)
    v_mad_u32_u16 v224, v224, s39, v248 op_sel:[1,0,0,0]
    v_mad_u32_u16 v225, v225, s39, v248 op_sel:[1,0,0,0]
    v_mfma_f32_32x32x8_bf16 v[32:47], v[80:81], v[180:181], v[32:47]
    v_add_u32 v226, s50, v251
    ds_read2_b32 v[226:227], v226 offset0:1 offset1:3
    v_mul_f32 v242, v0, v144
    v_fma_f32 v238, v8, v160, -v238
    v_fmac_f32 v242, v1, v145
    v_fmac_f32 v238, v9, v161
    v_fmac_f32 v242, v2, v146
    v_mfma_f32_32x32x8_bf16 v[48:63], v[84:85], v[180:181], v[48:63]
    s_setprio 0
    v_fmac_f32 v238, v10, v162
    v_fmac_f32 v242, v3, v147
    v_fmac_f32 v238, v11, v163
    v_fmac_f32 v242, v4, v148
    v_fmac_f32 v238, v12, v164
    v_fmac_f32 v242, v5, v149
    v_fmac_f32 v238, v13, v165
    v_fmac_f32 v242, v6, v150
    v_fmac_f32 v238, v14, v166
    v_fmac_f32 v242, v7, v151
    v_fmac_f32 v238, v15, v167
    v_fmac_f32 v236, v16, v112
    v_mul_f32 v244, v24, v160
    v_fmac_f32 v236, v17, v113
    v_fmac_f32 v244, v25, v161
    v_fmac_f32 v236, v18, v114
    v_fmac_f32 v244, v26, v162
    v_fmac_f32 v236, v19, v115
    v_fmac_f32 v244, v27, v163
    v_fmac_f32 v236, v20, v116
    v_fmac_f32 v244, v28, v164
    v_fmac_f32 v236, v21, v117
    v_fmac_f32 v244, v29, v165
    v_fmac_f32 v236, v22, v118
    v_fmac_f32 v244, v30, v166
    v_fmac_f32 v236, v23, v119
    v_fmac_f32 v244, v31, v167
    v_mul_f32 v243, v32, v152
    v_fma_f32 v239, v40, v168, -v239
    v_fmac_f32 v243, v33, v153
    v_fmac_f32 v239, v41, v169
    v_fmac_f32 v243, v34, v154
    v_fmac_f32 v239, v42, v170
    v_fmac_f32 v243, v35, v155
    v_fmac_f32 v239, v43, v171
    v_fmac_f32 v243, v36, v156
    v_fmac_f32 v239, v44, v172
    v_fmac_f32 v243, v37, v157
    v_fmac_f32 v239, v45, v173
    v_fmac_f32 v243, v38, v158
    v_fmac_f32 v239, v46, v174
    v_fmac_f32 v243, v39, v159
    v_fmac_f32 v239, v47, v175
    v_fmac_f32 v237, v48, v120
    v_mul_f32 v245, v56, v168
    v_fmac_f32 v237, v49, v121
    v_fmac_f32 v245, v57, v169
    v_fmac_f32 v237, v50, v122
    s_setprio 1
    s_waitcnt vmcnt(3) lgkmcnt(1)
    v_mfma_f32_32x32x16_bf16 v[0:15], v[64:67], v[184:187], 0
    ds_read_b64_tr_b16 v[176:177], v246 offset:4096
    ds_read_b64_tr_b16 v[178:179], v246 offset:5120
    ds_read_b64_tr_b16 v[180:181], v247 offset:4096
    ds_read_b64_tr_b16 v[182:183], v247 offset:5120
    v_fmac_f32 v245, v58, v170
    v_fmac_f32 v237, v51, v123
    s_mov_b32 m0, s69
    v_mfma_f32_32x32x16_bf16 v[16:31], v[68:71], v[184:187], 0
    buffer_load_dwordx4 v224, s[4:7], s45 offen sc1 lds
    buffer_load_dwordx4 v225, s[72:75], s45 offen offset:1024 sc1 lds
    s_waitcnt lgkmcnt(4)
    v_mad_u32_u16 v226, v226, s39, v248 op_sel:[1,0,0,0]
    v_mad_u32_u16 v227, v227, s39, v248 op_sel:[1,0,0,0]
    v_fmac_f32 v245, v59, v171
    v_fmac_f32 v237, v52, v124
    v_mfma_f32_32x32x16_bf16 v[32:47], v[64:67], v[188:191], 0
    v_fmac_f32 v245, v60, v172
    v_fmac_f32 v237, v53, v125
    v_fmac_f32 v245, v61, v173
    v_fmac_f32 v237, v54, v126
    v_fmac_f32 v245, v62, v174
    v_fmac_f32 v237, v55, v127
    v_fmac_f32 v245, v63, v175
    v_mfma_f32_32x32x16_bf16 v[48:63], v[68:71], v[188:191], 0
    v_permlane32_swap_b32 v242, v234
    v_permlane32_swap_b32 v243, v235
    v_add_f32 v242, v242, v234
    v_add_f32 v243, v243, v235
    s_waitcnt vmcnt(4) lgkmcnt(0)
    v_mfma_f32_32x32x16_bf16 v[0:15], v[72:75], v[176:179], v[0:15]
    ds_read_b64_tr_b16 v[184:185], v246 offset:6144
    ds_read_b64_tr_b16 v[188:189], v247 offset:6144
    v_cvt_pk_bf16_f32 v242, v242, v243
    ds_write_b32 v230, v242 offset:512
    s_mov_b32 s32, s31
    s_mov_b32 s31, s35
    s_mov_b32 m0, s70
    v_mfma_f32_32x32x16_bf16 v[16:31], v[76:79], v[176:179], v[16:31]
    buffer_load_dwordx4 v226, s[4:7], s46 offen sc1 lds
    buffer_load_dwordx4 v227, s[72:75], s46 offen offset:1024 sc1 lds
    s_sub_u32 s26, s48, s29
    s_mov_b32 s29, s48
    s_mov_b32 s30, s3
    s_bfe_u32 s56, s3, 0x40012
    v_mfma_f32_32x32x16_bf16 v[32:47], v[72:75], v[180:183], v[32:47]
    s_cmp_lg_u32 s36, 0
    s_cselect_b32 s56, s56, 0
    v_mfma_f32_32x32x16_bf16 v[48:63], v[76:79], v[180:183], v[48:63]
    s_waitcnt vmcnt(4) lgkmcnt(1)
    v_mfma_f32_32x32x8_bf16 v[0:15], v[80:81], v[184:185], v[0:15]
    ds_read_b64_tr_b16 v[176:177], v246 offset:0
    ds_read_b64_tr_b16 v[178:179], v246 offset:1024
    ds_read_b64_tr_b16 v[180:181], v247 offset:0
    ds_read_b64_tr_b16 v[182:183], v247 offset:1024
    s_mov_b32 m0, s71
    v_mfma_f32_32x32x8_bf16 v[16:31], v[84:85], v[184:185], v[16:31]
    s_cmp_eq_u32 s33, 4
    s_cbranch_scc1 K2_g4_71
    buffer_load_dwordx4 v224, s[4:7], s47 offen sc1 lds
    buffer_load_dwordx4 v225, s[72:75], s47 offen offset:1024 sc1 lds
K2_back_72:
    v_mfma_f32_32x32x8_bf16 v[32:47], v[80:81], v[188:189], v[32:47]
    s_nop 0
    v_mul_f32 v242, v0, v144
    v_fma_f32 v240, v8, v160, -v240
    v_fmac_f32 v242, v1, v145
    v_fmac_f32 v240, v9, v161
    v_fmac_f32 v242, v2, v146
    v_fmac_f32 v240, v10, v162
    v_fmac_f32 v242, v3, v147
    v_mfma_f32_32x32x8_bf16 v[48:63], v[84:85], v[188:189], v[48:63]
    s_setprio 0
    v_fmac_f32 v240, v11, v163
    v_fmac_f32 v242, v4, v148
    v_fmac_f32 v240, v12, v164
    v_fmac_f32 v242, v5, v149
    v_fmac_f32 v240, v13, v165
    v_fmac_f32 v242, v6, v150
    v_fmac_f32 v240, v14, v166
    v_fmac_f32 v242, v7, v151
    v_fmac_f32 v240, v15, v167
    v_add_u32 v249, s26, v249
    v_add_u32 v250, s26, v250
    v_fma_f32 v244, v16, v160, -v244
    v_fmac_f32 v236, v24, v112
    v_fmac_f32 v244, v17, v161
    v_fmac_f32 v236, v25, v113
    v_fmac_f32 v244, v18, v162
    v_fmac_f32 v236, v26, v114
    v_fmac_f32 v244, v19, v163
    v_fmac_f32 v236, v27, v115
    v_fmac_f32 v244, v20, v164
    v_fmac_f32 v236, v28, v116
    v_fmac_f32 v244, v21, v165
    v_fmac_f32 v236, v29, v117
    v_fmac_f32 v244, v22, v166
    v_fmac_f32 v236, v30, v118
    v_fmac_f32 v244, v23, v167
    v_fmac_f32 v236, v31, v119
    ds_read_b64_tr_b16 v[0:1], v249 offset:0
    ds_read_b64_tr_b16 v[2:3], v249 offset:32
    ds_read_u16_d16_hi v16, v250 offset:0
    v_mul_f32 v243, v32, v152
    v_fma_f32 v241, v40, v168, -v241
    v_fmac_f32 v243, v33, v153
    v_fmac_f32 v241, v41, v169
    v_fmac_f32 v243, v34, v154
    v_fmac_f32 v241, v42, v170
    v_fmac_f32 v243, v35, v155
    v_fmac_f32 v241, v43, v171
    v_fmac_f32 v243, v36, v156
    v_fmac_f32 v241, v44, v172
    v_fmac_f32 v243, v37, v157
    v_fmac_f32 v241, v45, v173
    v_fmac_f32 v243, v38, v158
    v_fmac_f32 v241, v46, v174
    v_fmac_f32 v243, v39, v159
    v_fmac_f32 v241, v47, v175
    ds_read_b64_tr_b16 v[4:5], v249 offset:512
    ds_read_b64_tr_b16 v[6:7], v249 offset:544
    ds_read_u16_d16_hi v17, v250 offset:128
    v_fma_f32 v245, v48, v168, -v245
    v_fmac_f32 v237, v56, v120
    v_fmac_f32 v245, v49, v169
    v_fmac_f32 v237, v57, v121
    v_fmac_f32 v245, v50, v170
    v_fmac_f32 v237, v58, v122
    v_fmac_f32 v245, v51, v171
    v_fmac_f32 v237, v59, v123
    v_fmac_f32 v245, v52, v172
    v_fmac_f32 v237, v60, v124
    v_fmac_f32 v245, v53, v173
    v_fmac_f32 v237, v61, v125
    v_fmac_f32 v245, v54, v174
    v_fmac_f32 v237, v62, v126
    v_fmac_f32 v245, v55, v175
    v_fmac_f32 v237, v63, v127
    s_cmp_eq_u32 s56, 5
    s_cbranch_scc1 K2_U21
    s_cmp_eq_u32 s56, 6
    s_cbranch_scc1 K2_U3h1
    s_branch K2_DSP1
K2_U31:
    s_setprio 1
    ds_read_b64_tr_b16 v[8:9], v249 offset:1024
    ds_read_b64_tr_b16 v[10:11], v249 offset:1056
    ds_read_u16_d16_hi v18, v250 offset:256
    s_waitcnt lgkmcnt(3)
    v_lshlrev_b32 v20, 16, v0
    v_and_b32 v21, 0xffff0000, v0
    v_lshlrev_b32 v22, 16, v1
    v_and_b32 v23, 0xffff0000, v1
    v_lshlrev_b32 v24, 16, v2
    v_and_b32 v25, 0xffff0000, v2
    v_lshlrev_b32 v26, 16, v3
    v_and_b32 v27, 0xffff0000, v3
    v_mul_f32_dpp v36, v16, v20 row_newbcast:8 row_mask:0xf bank_mask:0xf
    v_mul_f32_dpp v37, v16, v21 row_newbcast:9 row_mask:0xf bank_mask:0xf
    v_mul_f32_dpp v38, v16, v22 row_newbcast:10 row_mask:0xf bank_mask:0xf
    v_mul_f32_dpp v39, v16, v23 row_newbcast:11 row_mask:0xf bank_mask:0xf
    v_mul_f32_dpp v40, v16, v24 row_newbcast:12 row_mask:0xf bank_mask:0xf
    v_mul_f32_dpp v41, v16, v25 row_newbcast:13 row_mask:0xf bank_mask:0xf
    v_mul_f32_dpp v42, v16, v26 row_newbcast:14 row_mask:0xf bank_mask:0xf
    v_mul_f32_dpp v43, v16, v27 row_newbcast:15 row_mask:0xf bank_mask:0xf
    v_cvt_pk_bf16_f32 v68, v36, v37
    v_cvt_pk_bf16_f32 v69, v38, v39
    v_cvt_pk_bf16_f32 v70, v40, v41
    v_cvt_pk_bf16_f32 v71, v42, v43
    v_mul_f32_dpp v20, v16, v20 row_newbcast:0 row_mask:0xa bank_mask:0xf
    v_mul_f32_dpp v21, v16, v21 row_newbcast:1 row_mask:0xa bank_mask:0xf
    v_mul_f32_dpp v22, v16, v22 row_newbcast:2 row_mask:0xa bank_mask:0xf
    v_mul_f32_dpp v23, v16, v23 row_newbcast:3 row_mask:0xa bank_mask:0xf
    v_mul_f32_dpp v24, v16, v24 row_newbcast:4 row_mask:0xa bank_mask:0xf
    v_mul_f32_dpp v25, v16, v25 row_newbcast:5 row_mask:0xa bank_mask:0xf
    v_mul_f32_dpp v26, v16, v26 row_newbcast:6 row_mask:0xa bank_mask:0xf
    v_mul_f32_dpp v27, v16, v27 row_newbcast:7 row_mask:0xa bank_mask:0xf
    v_cvt_pk_bf16_f32 v64, v20, v21
    v_cvt_pk_bf16_f32 v65, v22, v23
    v_cvt_pk_bf16_f32 v66, v24, v25
    v_cvt_pk_bf16_f32 v67, v26, v27
    v_lshlrev_b32 v28, 16, v4
    v_and_b32 v29, 0xffff0000, v4
    v_lshlrev_b32 v30, 16, v5
    v_and_b32 v31, 0xffff0000, v5
    v_lshlrev_b32 v32, 16, v6
    v_and_b32 v33, 0xffff0000, v6
    v_lshlrev_b32 v34, 16, v7
    v_and_b32 v35, 0xffff0000, v7
    v_mul_f32_dpp v36, v17, v28 row_newbcast:8 row_mask:0xf bank_mask:0xf
    v_mul_f32_dpp v37, v17, v29 row_newbcast:9 row_mask:0xf bank_mask:0xf
    v_mul_f32_dpp v38, v17, v30 row_newbcast:10 row_mask:0xf bank_mask:0xf
    v_mul_f32_dpp v39, v17, v31 row_newbcast:11 row_mask:0xf bank_mask:0xf
    v_mul_f32_dpp v40, v17, v32 row_newbcast:12 row_mask:0xf bank_mask:0xf
    v_mul_f32_dpp v41, v17, v33 row_newbcast:13 row_mask:0xf bank_mask:0xf
    v_mul_f32_dpp v42, v17, v34 row_newbcast:14 row_mask:0xf bank_mask:0xf
    v_mul_f32_dpp v43, v17, v35 row_newbcast:15 row_mask:0xf bank_mask:0xf
    v_cvt_pk_bf16_f32 v76, v36, v37
    v_cvt_pk_bf16_f32 v77, v38, v39
    v_cvt_pk_bf16_f32 v78, v40, v41
    v_cvt_pk_bf16_f32 v79, v42, v43
    v_mul_f32_dpp v28, v17, v28 row_newbcast:0 row_mask:0xa bank_mask:0xf
    v_mul_f32_dpp v29, v17, v29 row_newbcast:1 row_mask:0xa bank_mask:0xf
    v_mul_f32_dpp v30, v17, v30 row_newbcast:2 row_mask:0xa bank_mask:0xf
    v_mul_f32_dpp v31, v17, v31 row_newbcast:3 row_mask:0xa bank_mask:0xf
    v_mul_f32_dpp v32, v17, v32 row_newbcast:4 row_mask:0xa bank_mask:0xf
    v_mul_f32_dpp v33, v17, v33 row_newbcast:5 row_mask:0xa bank_mask:0xf
    v_mul_f32_dpp v34, v17, v34 row_newbcast:6 row_mask:0xa bank_mask:0xf
    v_mul_f32_dpp v35, v17, v35 row_newbcast:7 row_mask:0xa bank_mask:0xf
    v_cvt_pk_bf16_f32 v72, v28, v29
    v_cvt_pk_bf16_f32 v73, v30, v31
    v_cvt_pk_bf16_f32 v74, v32, v33
    v_cvt_pk_bf16_f32 v75, v34, v35
    s_waitcnt lgkmcnt(0)
    v_lshlrev_b32 v20, 16, v8
    v_and_b32 v21, 0xffff0000, v8
    v_lshlrev_b32 v22, 16, v9
    v_and_b32 v23, 0xffff0000, v9
    v_lshlrev_b32 v24, 16, v10
    v_and_b32 v25, 0xffff0000, v10
    v_lshlrev_b32 v26, 16, v11
    v_and_b32 v27, 0xffff0000, v11
    v_mul_f32_dpp v36, v18, v20 row_newbcast:8 row_mask:0xf bank_mask:0xf
    v_mul_f32_dpp v37, v18, v21 row_newbcast:9 row_mask:0xf bank_mask:0xf
    v_mul_f32_dpp v38, v18, v22 row_newbcast:10 row_mask:0xf bank_mask:0xf
    v_mul_f32_dpp v39, v18, v23 row_newbcast:11 row_mask:0xf bank_mask:0xf
    v_mul_f32_dpp v40, v18, v24 row_newbcast:12 row_mask:0xf bank_mask:0xf
    v_mul_f32_dpp v41, v18, v25 row_newbcast:13 row_mask:0xf bank_mask:0xf
    v_mul_f32_dpp v42, v18, v26 row_newbcast:14 row_mask:0xf bank_mask:0xf
    v_mul_f32_dpp v43, v18, v27 row_newbcast:15 row_mask:0xf bank_mask:0xf
    v_cvt_pk_bf16_f32 v84, v36, v37
    v_cvt_pk_bf16_f32 v85, v38, v39
    v_cvt_pk_bf16_f32 v86, v40, v41
    v_cvt_pk_bf16_f32 v87, v42, v43
    v_mul_f32_dpp v20, v18, v20 row_newbcast:0 row_mask:0xa bank_mask:0xf
    v_mul_f32_dpp v21, v18, v21 row_newbcast:1 row_mask:0xa bank_mask:0xf
    v_mul_f32_dpp v22, v18, v22 row_newbcast:2 row_mask:0xa bank_mask:0xf
    v_mul_f32_dpp v23, v18, v23 row_newbcast:3 row_mask:0xa bank_mask:0xf
    v_mul_f32_dpp v24, v18, v24 row_newbcast:4 row_mask:0xa bank_mask:0xf
    v_mul_f32_dpp v25, v18, v25 row_newbcast:5 row_mask:0xa bank_mask:0xf
    v_mul_f32_dpp v26, v18, v26 row_newbcast:6 row_mask:0xa bank_mask:0xf
    v_mul_f32_dpp v27, v18, v27 row_newbcast:7 row_mask:0xa bank_mask:0xf
    v_cvt_pk_bf16_f32 v80, v20, v21
    v_cvt_pk_bf16_f32 v81, v22, v23
    v_cvt_pk_bf16_f32 v82, v24, v25
    v_cvt_pk_bf16_f32 v83, v26, v27
    s_waitcnt vmcnt(4)
    v_mfma_f32_32x32x16_bf16 v[0:15], v[64:67], v[176:179], 0
    ds_read_b64_tr_b16 v[184:185], v246 offset:2048
    ds_read_b64_tr_b16 v[186:187], v246 offset:3072
    ds_read_b64_tr_b16 v[188:189], v247 offset:2048
    ds_read_b64_tr_b16 v[190:191], v247 offset:3072
    s_mov_b32 m0, s68
    v_mfma_f32_32x32x16_bf16 v[16:31], v[68:71], v[176:179], 0
    buffer_load_dwordx4 v222, s[4:7], s41 offen sc1 lds
    buffer_load_dwordx4 v223, s[72:75], s41 offen offset:1024 sc1 lds
    v_permlane32_swap_b32 v242, v236
    v_permlane32_swap_b32 v243, v237
    v_mfma_f32_32x32x16_bf16 v[32:47], v[64:67], v[180:183], 0
    v_permlane32_swap_b32 v244, v238
    v_permlane32_swap_b32 v245, v239
    v_permlane32_swap_b32 v240, v241
    v_add_f32 v242, v242, v236
    v_mfma_f32_32x32x16_bf16 v[48:63], v[68:71], v[180:183], 0
    v_add_f32 v243, v243, v237
    v_add_f32 v244, v244, v238
    v_add_f32 v245, v245, v239
    v_add_f32 v240, -v240, -v241
    v_sub_u32 v241, v230, v231
    v_cvt_pk_bf16_f32 v242, v242, v243
    s_mov_b64 exec, 0x1ff
    ds_add_rtn_u32 v232, v254, v255
    s_mov_b64 exec, -1
    s_waitcnt vmcnt(4) lgkmcnt(1)
    v_mfma_f32_32x32x16_bf16 v[0:15], v[72:75], v[184:187], v[0:15]
    ds_read_b64_tr_b16 v[176:177], v246 offset:4096
    ds_read_b64_tr_b16 v[178:179], v246 offset:5120
    ds_read_b64_tr_b16 v[180:181], v247 offset:4096
    ds_read_b64_tr_b16 v[182:183], v247 offset:5120
    v_cvt_pk_bf16_f32 v244, v244, v245
    v_cvt_pk_bf16_f32 v240, v240, v240
    s_mov_b32 m0, s69
    v_mfma_f32_32x32x16_bf16 v[16:31], v[76:79], v[184:187], v[16:31]
    buffer_load_dwordx4 v226, s[4:7], s41 offen sc1 lds
    buffer_load_dwordx4 v227, s[72:75], s41 offen offset:1024 sc1 lds
    ds_write2st64_b32 v230, v242, v244 offset0:3 offset1:4
    ds_write_b16 v241, v240 offset:1280
    s_waitcnt lgkmcnt(6)
    v_readlane_b32 s58, v232, 8
    v_mfma_f32_32x32x16_bf16 v[32:47], v[72:75], v[188:191], v[32:47]
    s_cmp_lt_u32 s58, s22
    s_cbranch_scc0 K2_nul_73
    s_nop 0
    v_readlane_b32 s3, v253, s58
    s_nop 0
    s_bfe_u32 s58, s3, 0x60016
    s_and_b32 s59, s58, 7
    s_lshr_b32 s60, s58, 3
K2_chk_75:
    v_readlane_b32 s61, v232, s59
    s_nop 0
    s_cmp_gt_u32 s61, s60
    s_cbranch_scc0 K2_spin_74
K2_back_76:
    v_mfma_f32_32x32x16_bf16 v[48:63], v[76:79], v[188:191], v[48:63]
    s_lshl_b32 s44, s34, 7
    s_and_b32 s48, s3, 0x3ffff
    s_bfe_u32 s33, s3, 0x30013
    s_mov_b32 s35, s48
    s_mov_b32 s45, s44
    s_xor_b32 s47, s44, 256
    s_waitcnt vmcnt(4) lgkmcnt(2)
    v_mfma_f32_32x32x16_bf16 v[0:15], v[80:83], v[176:179], v[0:15]
    ds_read_b64_tr_b16 v[184:185], v246 offset:6144
    ds_read_b64_tr_b16 v[186:187], v246 offset:7168
    ds_read_b64_tr_b16 v[188:189], v247 offset:6144
    ds_read_b64_tr_b16 v[190:191], v247 offset:7168
    s_add_u32 s49, s48, 128
    s_add_u32 s60, s48, 256
    s_mov_b32 m0, s70
    v_mfma_f32_32x32x16_bf16 v[16:31], v[84:87], v[176:179], v[16:31]
    buffer_load_dwordx4 v222, s[4:7], s42 offen sc1 lds
    buffer_load_dwordx4 v223, s[72:75], s42 offen offset:1024 sc1 lds
    s_cmp_eq_u32 s33, 3
    s_cselect_b32 s46, s44, s47
    s_cselect_b32 s50, s60, s48
    v_mfma_f32_32x32x16_bf16 v[32:47], v[80:83], v[180:183], v[32:47]
    s_sub_u32 s60, s33, 2
    s_cmp_lt_u32 s60, 2
    s_cbranch_scc0 K2_rare_77
K2_back_78:
    v_mul_f32 v234, v0, v96
    v_mul_f32 v236, v8, v128
    v_fmac_f32 v234, v1, v97
    v_fmac_f32 v236, v9, v129
    v_mfma_f32_32x32x16_bf16 v[48:63], v[84:87], v[180:183], v[48:63]
    s_setprio 0
    v_fmac_f32 v234, v2, v98
    v_fmac_f32 v236, v10, v130
    v_fmac_f32 v234, v3, v99
    v_fmac_f32 v236, v11, v131
    v_fmac_f32 v234, v4, v100
    v_fmac_f32 v236, v12, v132
    v_fmac_f32 v234, v5, v101
    v_fmac_f32 v236, v13, v133
    v_fmac_f32 v234, v6, v102
    v_fmac_f32 v236, v14, v134
    v_fmac_f32 v234, v7, v103
    v_fmac_f32 v236, v15, v135
    v_mul_f32 v238, v16, v128
    v_mul_f32 v240, v24, v128
    v_fmac_f32 v238, v17, v129
    v_fmac_f32 v240, v25, v129
    v_fmac_f32 v238, v18, v130
    v_fmac_f32 v240, v26, v130
    v_fmac_f32 v238, v19, v131
    v_fmac_f32 v240, v27, v131
    v_fmac_f32 v238, v20, v132
    v_fmac_f32 v240, v28, v132
    v_fmac_f32 v238, v21, v133
    v_fmac_f32 v240, v29, v133
    v_fmac_f32 v238, v22, v134
    v_fmac_f32 v240, v30, v134
    v_fmac_f32 v238, v23, v135
    v_fmac_f32 v240, v31, v135
    v_mul_f32 v235, v32, v104
    v_mul_f32 v237, v40, v136
    v_fmac_f32 v235, v33, v105
    v_fmac_f32 v237, v41, v137
    v_fmac_f32 v235, v34, v106
    v_fmac_f32 v237, v42, v138
    v_fmac_f32 v235, v35, v107
    v_fmac_f32 v237, v43, v139
    v_fmac_f32 v235, v36, v108
    v_fmac_f32 v237, v44, v140
    v_fmac_f32 v235, v37, v109
    v_fmac_f32 v237, v45, v141
    v_fmac_f32 v235, v38, v110
    v_fmac_f32 v237, v46, v142
    v_fmac_f32 v235, v39, v111
    v_fmac_f32 v237, v47, v143
    v_mul_f32 v239, v48, v136
    v_mul_f32 v241, v56, v136
    s_setprio 1
    s_waitcnt vmcnt(4) lgkmcnt(0)
    v_mfma_f32_32x32x16_bf16 v[0:15], v[72:75], v[184:187], 0
    ds_read_b64_tr_b16 v[176:177], v246 offset:0
    ds_read_b64_tr_b16 v[178:179], v246 offset:1024
    ds_read_b64_tr_b16 v[180:181], v247 offset:0
    ds_read_b64_tr_b16 v[182:183], v247 offset:1024
    v_fmac_f32 v239, v49, v137
    v_fmac_f32 v241, v57, v137
    s_mov_b32 m0, s71
    v_mfma_f32_32x32x16_bf16 v[16:31], v[76:79], v[184:187], 0
    buffer_load_dwordx4 v224, s[4:7], s42 offen sc1 lds
    buffer_load_dwordx4 v225, s[72:75], s42 offen offset:1024 sc1 lds
    v_fmac_f32 v239, v50, v138
    v_fmac_f32 v241, v58, v138
    v_fmac_f32 v239, v51, v139
    v_fmac_f32 v241, v59, v139
    v_fmac_f32 v239, v52, v140
    v_mfma_f32_32x32x16_bf16 v[32:47], v[72:75], v[188:191], 0
    v_fmac_f32 v241, v60, v140
    v_fmac_f32 v239, v53, v141
    v_fmac_f32 v241, v61, v141
    v_fmac_f32 v239, v54, v142
    v_fmac_f32 v241, v62, v142
    v_fmac_f32 v239, v55, v143
    v_fmac_f32 v241, v63, v143
    v_mfma_f32_32x32x16_bf16 v[48:63], v[76:79], v[188:191], 0
    v_permlane32_swap_b32 v234, v236
    v_permlane32_swap_b32 v235, v237
    v_permlane32_swap_b32 v240, v238
    s_waitcnt vmcnt(4) lgkmcnt(0)
    v_mfma_f32_32x32x16_bf16 v[0:15], v[64:67], v[176:179], v[0:15]
    ds_read_b64_tr_b16 v[184:185], v246 offset:2048
    ds_read_b64_tr_b16 v[186:187], v246 offset:3072
    ds_read_b64_tr_b16 v[188:189], v247 offset:2048
    ds_read_b64_tr_b16 v[190:191], v247 offset:3072
    v_permlane32_swap_b32 v241, v239
    s_mov_b32 m0, s68
    v_mfma_f32_32x32x16_bf16 v[16:31], v[68:71], v[176:179], v[16:31]
    buffer_load_dwordx4 v226, s[4:7], s42 offen sc1 lds
    buffer_load_dwordx4 v227, s[72:75], s42 offen offset:1024 sc1 lds
    v_lshl_add_u32 v230, v252, 1, s31
    v_add_f32 v234, v234, v236
    v_add_f32 v235, v235, v237
    v_add_f32 v240, v240, v238
    v_add_f32 v241, v241, v239
    v_mfma_f32_32x32x16_bf16 v[32:47], v[64:67], v[180:183], v[32:47]
    v_cvt_pk_bf16_f32 v234, v234, v235
    v_cvt_pk_bf16_f32 v240, v240, v241
    ds_write2st64_b32 v230, v234, v240 offset0:0 offset1:1
    v_mfma_f32_32x32x16_bf16 v[48:63], v[68:71], v[180:183], v[48:63]
    s_waitcnt vmcnt(4) lgkmcnt(1)
    v_mfma_f32_32x32x16_bf16 v[0:15], v[80:83], v[184:187], v[0:15]
    ds_read_b64_tr_b16 v[176:177], v246 offset:4096
    ds_read_b64_tr_b16 v[178:179], v246 offset:5120
    ds_read_b64_tr_b16 v[180:181], v247 offset:4096
    ds_read_b64_tr_b16 v[182:183], v247 offset:5120
    s_mov_b32 m0, s69
    v_mfma_f32_32x32x16_bf16 v[16:31], v[84:87], v[184:187], v[16:31]
    buffer_load_dwordx4 v222, s[4:7], s43 offen sc1 lds
    buffer_load_dwordx4 v223, s[72:75], s43 offen offset:1024 sc1 lds
    v_mfma_f32_32x32x16_bf16 v[32:47], v[80:83], v[188:191], v[32:47]
    s_nop 2
    v_mul_f32 v234, v0, v144
    v_mul_f32 v236, v8, v112
    v_fmac_f32 v234, v1, v145
    v_fmac_f32 v236, v9, v113
    v_fmac_f32 v234, v2, v146
    v_fmac_f32 v236, v10, v114
    v_fmac_f32 v234, v3, v147
    v_mfma_f32_32x32x16_bf16 v[48:63], v[84:87], v[188:191], v[48:63]
    s_setprio 0
    v_fmac_f32 v236, v11, v115
    v_fmac_f32 v234, v4, v148
    v_fmac_f32 v236, v12, v116
    v_fmac_f32 v234, v5, v149
    v_fmac_f32 v236, v13, v117
    v_fmac_f32 v234, v6, v150
    v_fmac_f32 v236, v14, v118
    v_fmac_f32 v234, v7, v151
    v_fmac_f32 v236, v15, v119
    v_mul_f32 v238, v16, v160
    v_mul_f32 v240, v24, v160
    v_fmac_f32 v238, v17, v161
    v_fmac_f32 v240, v25, v161
    v_fmac_f32 v238, v18, v162
    v_fmac_f32 v240, v26, v162
    v_fmac_f32 v238, v19, v163
    v_fmac_f32 v240, v27, v163
    v_fmac_f32 v238, v20, v164
    v_fmac_f32 v240, v28, v164
    v_fmac_f32 v238, v21, v165
    v_fmac_f32 v240, v29, v165
    v_fmac_f32 v238, v22, v166
    v_fmac_f32 v240, v30, v166
    v_fmac_f32 v238, v23, v167
    v_fmac_f32 v240, v31, v167
    v_mul_f32 v235, v32, v152
    v_mul_f32 v237, v40, v120
    v_fmac_f32 v235, v33, v153
    v_fmac_f32 v237, v41, v121
    v_fmac_f32 v235, v34, v154
    v_fmac_f32 v237, v42, v122
    v_fmac_f32 v235, v35, v155
    v_fmac_f32 v237, v43, v123
    v_fmac_f32 v235, v36, v156
    v_fmac_f32 v237, v44, v124
    v_fmac_f32 v235, v37, v157
    v_fmac_f32 v237, v45, v125
    v_fmac_f32 v235, v38, v158
    v_fmac_f32 v237, v46, v126
    v_fmac_f32 v235, v39, v159
    v_fmac_f32 v237, v47, v127
    v_mul_f32 v239, v48, v168
    v_mul_f32 v241, v56, v168
    v_fmac_f32 v239, v49, v169
    v_fmac_f32 v241, v57, v169
    s_setprio 1
    s_waitcnt vmcnt(4) lgkmcnt(0)
    v_mfma_f32_32x32x16_bf16 v[0:15], v[64:67], v[176:179], 0
    ds_read_b64_tr_b16 v[184:185], v246 offset:6144
    ds_read_b64_tr_b16 v[186:187], v246 offset:7168
    ds_read_b64_tr_b16 v[188:189], v247 offset:6144
    ds_read_b64_tr_b16 v[190:191], v247 offset:7168
    v_fmac_f32 v239, v50, v170
    v_fmac_f32 v241, v58, v170
    s_mov_b32 m0, s70
    v_mfma_f32_32x32x16_bf16 v[16:31], v[68:71], v[176:179], 0
    buffer_load_dwordx4 v224, s[4:7], s43 offen sc1 lds
    buffer_load_dwordx4 v225, s[72:75], s43 offen offset:1024 sc1 lds
    v_fmac_f32 v239, v51, v171
    v_fmac_f32 v241, v59, v171
    v_fmac_f32 v239, v52, v172
    v_fmac_f32 v241, v60, v172
    v_fmac_f32 v239, v53, v173
    v_mfma_f32_32x32x16_bf16 v[32:47], v[64:67], v[180:183], 0
    v_add_u32 v222, s48, v251
    ds_read2_b32 v[222:223], v222 offset0:1 offset1:3
    v_fmac_f32 v241, v61, v173
    v_fmac_f32 v239, v54, v174
    v_fmac_f32 v241, v62, v174
    v_fmac_f32 v239, v55, v175
    v_fmac_f32 v241, v63, v175
    v_mfma_f32_32x32x16_bf16 v[48:63], v[68:71], v[180:183], 0
    s_waitcnt vmcnt(4) lgkmcnt(1)
    v_mfma_f32_32x32x16_bf16 v[0:15], v[72:75], v[184:187], v[0:15]
    ds_read_b64_tr_b16 v[176:177], v246 offset:0
    ds_read_b64_tr_b16 v[178:179], v246 offset:1024
    ds_read_b64_tr_b16 v[180:181], v247 offset:0
    ds_read_b64_tr_b16 v[182:183], v247 offset:1024
    s_mov_b32 m0, s71
    v_mfma_f32_32x32x16_bf16 v[16:31], v[76:79], v[184:187], v[16:31]
    buffer_load_dwordx4 v226, s[4:7], s43 offen sc1 lds
    buffer_load_dwordx4 v227, s[72:75], s43 offen offset:1024 sc1 lds
    s_waitcnt lgkmcnt(4)
    v_mad_u32_u16 v222, v222, s39, v248 op_sel:[1,0,0,0]
    v_mad_u32_u16 v223, v223, s39, v248 op_sel:[1,0,0,0]
    v_mfma_f32_32x32x16_bf16 v[32:47], v[72:75], v[188:191], v[32:47]
    v_add_u32 v224, s49, v251
    ds_read2_b32 v[224:225], v224 offset0:1 offset1:3
    v_mfma_f32_32x32x16_bf16 v[48:63], v[76:79], v[188:191], v[48:63]
    s_waitcnt vmcnt(4) lgkmcnt(1)
    v_mfma_f32_32x32x16_bf16 v[0:15], v[80:83], v[176:179], v[0:15]
    ds_read_b64_tr_b16 v[184:185], v246 offset:2048
    ds_read_b64_tr_b16 v[186:187], v246 offset:3072
    ds_read_b64_tr_b16 v[188:189], v247 offset:2048
    ds_read_b64_tr_b16 v[190:191], v247 offset:3072
    s_mov_b32 m0, s68
    v_mfma_f32_32x32x16_bf16 v[16:31], v[84:87], v[176:179], v[16:31]
    buffer_load_dwordx4 v222, s[4:7], s44 offen sc1 lds
    buffer_load_dwordx4 v223, s[72:75], s44 offen offset:1024 sc1 lds
    s_waitcnt lgkmcnt(4)
    v_mad_u32_u16 v224, v224, s39, v248 op_sel:[1,0,0,0]
    v_mad_u32_u16 v225, v225, s39, v248 op_sel:[1,0,0,0]
    v_mfma_f32_32x32x16_bf16 v[32:47], v[80:83], v[180:183], v[32:47]
    v_add_u32 v226, s50, v251
    ds_read2_b32 v[226:227], v226 offset0:1 offset1:3
    v_mul_f32 v242, v0, v144
    v_fma_f32 v238, v8, v160, -v238
    v_fmac_f32 v242, v1, v145
    v_fmac_f32 v238, v9, v161
    v_fmac_f32 v242, v2, v146
    v_mfma_f32_32x32x16_bf16 v[48:63], v[84:87], v[180:183], v[48:63]
    s_setprio 0
    v_fmac_f32 v238, v10, v162
    v_fmac_f32 v242, v3, v147
    v_fmac_f32 v238, v11, v163
    v_fmac_f32 v242, v4, v148
    v_fmac_f32 v238, v12, v164
    v_fmac_f32 v242, v5, v149
    v_fmac_f32 v238, v13, v165
    v_fmac_f32 v242, v6, v150
    v_fmac_f32 v238, v14, v166
    v_fmac_f32 v242, v7, v151
    v_fmac_f32 v238, v15, v167
    v_fmac_f32 v236, v16, v112
    v_mul_f32 v244, v24, v160
    v_fmac_f32 v236, v17, v113
    v_fmac_f32 v244, v25, v161
    v_fmac_f32 v236, v18, v114
    v_fmac_f32 v244, v26, v162
    v_fmac_f32 v236, v19, v115
    v_fmac_f32 v244, v27, v163
    v_fmac_f32 v236, v20, v116
    v_fmac_f32 v244, v28, v164
    v_fmac_f32 v236, v21, v117
    v_fmac_f32 v244, v29, v165
    v_fmac_f32 v236, v22, v118
    v_fmac_f32 v244, v30, v166
    v_fmac_f32 v236, v23, v119
    v_fmac_f32 v244, v31, v167
    v_mul_f32 v243, v32, v152
    v_fma_f32 v239, v40, v168, -v239
    v_fmac_f32 v243, v33, v153
    v_fmac_f32 v239, v41, v169
    v_fmac_f32 v243, v34, v154
    v_fmac_f32 v239, v42, v170
    v_fmac_f32 v243, v35, v155
    v_fmac_f32 v239, v43, v171
    v_fmac_f32 v243, v36, v156
    v_fmac_f32 v239, v44, v172
    v_fmac_f32 v243, v37, v157
    v_fmac_f32 v239, v45, v173
    v_fmac_f32 v243, v38, v158
    v_fmac_f32 v239, v46, v174
    v_fmac_f32 v243, v39, v159
    v_fmac_f32 v239, v47, v175
    v_fmac_f32 v237, v48, v120
    v_mul_f32 v245, v56, v168
    v_fmac_f32 v237, v49, v121
    v_fmac_f32 v245, v57, v169
    v_fmac_f32 v237, v50, v122
    s_setprio 1
    s_waitcnt vmcnt(4) lgkmcnt(1)
    v_mfma_f32_32x32x16_bf16 v[0:15], v[64:67], v[184:187], 0
    ds_read_b64_tr_b16 v[176:177], v246 offset:4096
    ds_read_b64_tr_b16 v[178:179], v246 offset:5120
    ds_read_b64_tr_b16 v[180:181], v247 offset:4096
    ds_read_b64_tr_b16 v[182:183], v247 offset:5120
    v_fmac_f32 v245, v58, v170
    v_fmac_f32 v237, v51, v123
    s_mov_b32 m0, s69
    v_mfma_f32_32x32x16_bf16 v[16:31], v[68:71], v[184:187], 0
    buffer_load_dwordx4 v224, s[4:7], s45 offen sc1 lds
    buffer_load_dwordx4 v225, s[72:75], s45 offen offset:1024 sc1 lds
    s_waitcnt lgkmcnt(4)
    v_mad_u32_u16 v226, v226, s39, v248 op_sel:[1,0,0,0]
    v_mad_u32_u16 v227, v227, s39, v248 op_sel:[1,0,0,0]
    v_fmac_f32 v245, v59, v171
    v_fmac_f32 v237, v52, v124
    v_mfma_f32_32x32x16_bf16 v[32:47], v[64:67], v[188:191], 0
    v_fmac_f32 v245, v60, v172
    v_fmac_f32 v237, v53, v125
    v_fmac_f32 v245, v61, v173
    v_fmac_f32 v237, v54, v126
    v_fmac_f32 v245, v62, v174
    v_fmac_f32 v237, v55, v127
    v_fmac_f32 v245, v63, v175
    v_mfma_f32_32x32x16_bf16 v[48:63], v[68:71], v[188:191], 0
    v_permlane32_swap_b32 v242, v234
    v_permlane32_swap_b32 v243, v235
    v_add_f32 v242, v242, v234
    v_add_f32 v243, v243, v235
    s_waitcnt vmcnt(4) lgkmcnt(0)
    v_mfma_f32_32x32x16_bf16 v[0:15], v[72:75], v[176:179], v[0:15]
    ds_read_b64_tr_b16 v[184:185], v246 offset:6144
    ds_read_b64_tr_b16 v[186:187], v246 offset:7168
    ds_read_b64_tr_b16 v[188:189], v247 offset:6144
    ds_read_b64_tr_b16 v[190:191], v247 offset:7168
    v_cvt_pk_bf16_f32 v242, v242, v243
    ds_write_b32 v230, v242 offset:512
    s_mov_b32 m0, s70
    v_mfma_f32_32x32x16_bf16 v[16:31], v[76:79], v[176:179], v[16:31]
    buffer_load_dwordx4 v226, s[4:7], s46 offen sc1 lds
    buffer_load_dwordx4 v227, s[72:75], s46 offen offset:1024 sc1 lds
    s_sub_u32 s26, s48, s29
    s_mov_b32 s29, s48
    s_mov_b32 s30, s3
    s_bfe_u32 s56, s3, 0x40012
    s_mov_b32 s32, s31
    v_mfma_f32_32x32x16_bf16 v[32:47], v[72:75], v[180:183], v[32:47]
    s_cmp_lg_u32 s36, 0
    s_cselect_b32 s56, s56, 0
    s_mov_b32 s31, s35
    v_mfma_f32_32x32x16_bf16 v[48:63], v[76:79], v[180:183], v[48:63]
    s_waitcnt vmcnt(4) lgkmcnt(1)
    v_mfma_f32_32x32x16_bf16 v[0:15], v[80:83], v[184:187], v[0:15]
    ds_read_b64_tr_b16 v[176:177], v246 offset:0
    ds_read_b64_tr_b16 v[178:179], v246 offset:1024
    ds_read_b64_tr_b16 v[180:181], v247 offset:0
    ds_read_b64_tr_b16 v[182:183], v247 offset:1024
    s_mov_b32 m0, s71
    v_mfma_f32_32x32x16_bf16 v[16:31], v[84:87], v[184:187], v[16:31]
    s_cmp_eq_u32 s33, 4
    s_cbranch_scc1 K2_g4_80
    buffer_load_dwordx4 v224, s[4:7], s47 offen sc1 lds
    buffer_load_dwordx4 v225, s[72:75], s47 offen offset:1024 sc1 lds
K2_back_81:
    v_mfma_f32_32x32x16_bf16 v[32:47], v[80:83], v[188:191], v[32:47]
    s_nop 0
    v_mul_f32 v242, v0, v144
    v_fma_f32 v240, v8, v160, -v240
    v_fmac_f32 v242, v1, v145
    v_fmac_f32 v240, v9, v161
    v_fmac_f32 v242, v2, v146
    v_fmac_f32 v240, v10, v162
    v_fmac_f32 v242, v3, v147
    v_mfma_f32_32x32x16_bf16 v[48:63], v[84:87], v[188:191], v[48:63]
    s_setprio 0
    v_fmac_f32 v240, v11, v163
    v_fmac_f32 v242, v4, v148
    v_fmac_f32 v240, v12, v164
    v_fmac_f32 v242, v5, v149
    v_fmac_f32 v240, v13, v165
    v_fmac_f32 v242, v6, v150
    v_fmac_f32 v240, v14, v166
    v_fmac_f32 v242, v7, v151
    v_fmac_f32 v240, v15, v167
    v_add_u32 v249, s26, v249
    v_add_u32 v250, s26, v250
    v_fma_f32 v244, v16, v160, -v244
    v_fmac_f32 v236, v24, v112
    v_fmac_f32 v244, v17, v161
    v_fmac_f32 v236, v25, v113
    v_fmac_f32 v244, v18, v162
    v_fmac_f32 v236, v26, v114
    v_fmac_f32 v244, v19, v163
    v_fmac_f32 v236, v27, v115
    v_fmac_f32 v244, v20, v164
    v_fmac_f32 v236, v28, v116
    v_fmac_f32 v244, v21, v165
    v_fmac_f32 v236, v29, v117
    v_fmac_f32 v244, v22, v166
    v_fmac_f32 v236, v30, v118
    v_fmac_f32 v244, v23, v167
    v_fmac_f32 v236, v31, v119
    ds_read_b64_tr_b16 v[0:1], v249 offset:0
    ds_read_b64_tr_b16 v[2:3], v249 offset:32
    ds_read_u16_d16_hi v16, v250 offset:0
    v_mul_f32 v243, v32, v152
    v_fma_f32 v241, v40, v168, -v241
    v_fmac_f32 v243, v33, v153
    v_fmac_f32 v241, v41, v169
    v_fmac_f32 v243, v34, v154
    v_fmac_f32 v241, v42, v170
    v_fmac_f32 v243, v35, v155
    v_fmac_f32 v241, v43, v171
    v_fmac_f32 v243, v36, v156
    v_fmac_f32 v241, v44, v172
    v_fmac_f32 v243, v37, v157
    v_fmac_f32 v241, v45, v173
    v_fmac_f32 v243, v38, v158
    v_fmac_f32 v241, v46, v174
    v_fmac_f32 v243, v39, v159
    v_fmac_f32 v241, v47, v175
    ds_read_b64_tr_b16 v[4:5], v249 offset:512
    ds_read_b64_tr_b16 v[6:7], v249 offset:544
    ds_read_u16_d16_hi v17, v250 offset:128
    v_fma_f32 v245, v48, v168, -v245
    v_fmac_f32 v237, v56, v120
    v_fmac_f32 v245, v49, v169
    v_fmac_f32 v237, v57, v121
    v_fmac_f32 v245, v50, v170
    v_fmac_f32 v237, v58, v122
    v_fmac_f32 v245, v51, v171
    v_fmac_f32 v237, v59, v123
    v_fmac_f32 v245, v52, v172
    v_fmac_f32 v237, v60, v124
    v_fmac_f32 v245, v53, v173
    v_fmac_f32 v237, v61, v125
    v_fmac_f32 v245, v54, v174
    v_fmac_f32 v237, v62, v126
    v_fmac_f32 v245, v55, v175
    v_fmac_f32 v237, v63, v127
    s_cmp_eq_u32 s56, 5
    s_cbranch_scc1 K2_U21
    s_cmp_eq_u32 s56, 6
    s_cbranch_scc1 K2_U3h1
    s_branch K2_DSP1
K2_U2h1:
    s_setprio 1
    s_waitcnt lgkmcnt(0)
    v_lshlrev_b32 v20, 16, v0
    v_and_b32 v21, 0xffff0000, v0
    v_lshlrev_b32 v22, 16, v1
    v_and_b32 v23, 0xffff0000, v1
    v_lshlrev_b32 v24, 16, v2
    v_and_b32 v25, 0xffff0000, v2
    v_lshlrev_b32 v26, 16, v3
    v_and_b32 v27, 0xffff0000, v3
    v_mul_f32_dpp v36, v16, v20 row_newbcast:8 row_mask:0xf bank_mask:0xf
    v_mul_f32_dpp v37, v16, v21 row_newbcast:9 row_mask:0xf bank_mask:0xf
    v_mul_f32_dpp v38, v16, v22 row_newbcast:10 row_mask:0xf bank_mask:0xf
    v_mul_f32_dpp v39, v16, v23 row_newbcast:11 row_mask:0xf bank_mask:0xf
    v_mul_f32_dpp v40, v16, v24 row_newbcast:12 row_mask:0xf bank_mask:0xf
    v_mul_f32_dpp v41, v16, v25 row_newbcast:13 row_mask:0xf bank_mask:0xf
    v_mul_f32_dpp v42, v16, v26 row_newbcast:14 row_mask:0xf bank_mask:0xf
    v_mul_f32_dpp v43, v16, v27 row_newbcast:15 row_mask:0xf bank_mask:0xf
    v_cvt_pk_bf16_f32 v68, v36, v37
    v_cvt_pk_bf16_f32 v69, v38, v39
    v_cvt_pk_bf16_f32 v70, v40, v41
    v_cvt_pk_bf16_f32 v71, v42, v43
    v_mul_f32_dpp v20, v16, v20 row_newbcast:0 row_mask:0xa bank_mask:0xf
    v_mul_f32_dpp v21, v16, v21 row_newbcast:1 row_mask:0xa bank_mask:0xf
    v_mul_f32_dpp v22, v16, v22 row_newbcast:2 row_mask:0xa bank_mask:0xf
    v_mul_f32_dpp v23, v16, v23 row_newbcast:3 row_mask:0xa bank_mask:0xf
    v_mul_f32_dpp v24, v16, v24 row_newbcast:4 row_mask:0xa bank_mask:0xf
    v_mul_f32_dpp v25, v16, v25 row_newbcast:5 row_mask:0xa bank_mask:0xf
    v_mul_f32_dpp v26, v16, v26 row_newbcast:6 row_mask:0xa bank_mask:0xf
    v_mul_f32_dpp v27, v16, v27 row_newbcast:7 row_mask:0xa bank_mask:0xf
    v_cvt_pk_bf16_f32 v64, v20, v21
    v_cvt_pk_bf16_f32 v65, v22, v23
    v_cvt_pk_bf16_f32 v66, v24, v25
    v_cvt_pk_bf16_f32 v67, v26, v27
    v_lshlrev_b32 v28, 16, v4
    v_and_b32 v29, 0xffff0000, v4
    v_lshlrev_b32 v30, 16, v5
    v_and_b32 v31, 0xffff0000, v5
    v_mul_f32_dpp v36, v17, v28 row_newbcast:8 row_mask:0xf bank_mask:0xf
    v_mul_f32_dpp v37, v17, v29 row_newbcast:9 row_mask:0xf bank_mask:0xf
    v_mul_f32_dpp v38, v17, v30 row_newbcast:10 row_mask:0xf bank_mask:0xf
    v_mul_f32_dpp v39, v17, v31 row_newbcast:11 row_mask:0xf bank_mask:0xf
    v_cvt_pk_bf16_f32 v76, v36, v37
    v_cvt_pk_bf16_f32 v77, v38, v39
    v_mul_f32_dpp v28, v17, v28 row_newbcast:0 row_mask:0xa bank_mask:0xf
    v_mul_f32_dpp v29, v17, v29 row_newbcast:1 row_mask:0xa bank_mask:0xf
    v_mul_f32_dpp v30, v17, v30 row_newbcast:2 row_mask:0xa bank_mask:0xf
    v_mul_f32_dpp v31, v17, v31 row_newbcast:3 row_mask:0xa bank_mask:0xf
    v_cvt_pk_bf16_f32 v72, v28, v29
    v_cvt_pk_bf16_f32 v73, v30, v31
    s_waitcnt vmcnt(4)
    v_mfma_f32_32x32x16_bf16 v[0:15], v[64:67], v[176:179], 0
    ds_read_b64_tr_b16 v[184:185], v246 offset:2048
    ds_read_b64_tr_b16 v[188:189], v247 offset:2048
    s_mov_b32 m0, s68
    v_mfma_f32_32x32x16_bf16 v[16:31], v[68:71], v[176:179], 0
    buffer_load_dwordx4 v222, s[4:7], s42 offen sc1 lds
    buffer_load_dwordx4 v223, s[72:75], s42 offen offset:1024 sc1 lds
    v_permlane32_swap_b32 v242, v236
    v_permlane32_swap_b32 v243, v237
    v_mfma_f32_32x32x16_bf16 v[32:47], v[64:67], v[180:183], 0
    v_permlane32_swap_b32 v244, v238
    v_permlane32_swap_b32 v245, v239
    v_permlane32_swap_b32 v240, v241
    v_add_f32 v242, v242, v236
    v_mfma_f32_32x32x16_bf16 v[48:63], v[68:71], v[180:183], 0
    v_add_f32 v243, v243, v237
    v_add_f32 v244, v244, v238
    v_add_f32 v245, v245, v239
    v_add_f32 v240, -v240, -v241
    v_sub_u32 v241, v230, v231
    v_cvt_pk_bf16_f32 v242, v242, v243
    s_mov_b64 exec, 0x1ff
    ds_add_rtn_u32 v232, v254, v255
    s_mov_b64 exec, -1
    s_waitcnt vmcnt(4) lgkmcnt(1)
    v_mfma_f32_32x32x8_bf16 v[0:15], v[72:73], v[184:185], v[0:15]
    ds_read_b64_tr_b16 v[176:177], v246 offset:4096
    ds_read_b64_tr_b16 v[178:179], v246 offset:5120
    ds_read_b64_tr_b16 v[180:181], v247 offset:4096
    ds_read_b64_tr_b16 v[182:183], v247 offset:5120
    v_cvt_pk_bf16_f32 v244, v244, v245
    v_cvt_pk_bf16_f32 v240, v240, v240
    s_mov_b32 m0, s69
    v_mfma_f32_32x32x8_bf16 v[16:31], v[76:77], v[184:185], v[16:31]
    buffer_load_dwordx4 v224, s[4:7], s42 offen sc1 lds
    ds_write2st64_b32 v230, v242, v244 offset0:3 offset1:4
    ds_write_b16 v241, v240 offset:1280
    s_waitcnt lgkmcnt(6)
    v_readlane_b32 s58, v232, 8
    v_mfma_f32_32x32x8_bf16 v[32:47], v[72:73], v[188:189], v[32:47]
    s_cmp_lt_u32 s58, s22
    s_cbranch_scc0 K2_nul_82
    s_nop 0
    v_readlane_b32 s3, v253, s58
    s_nop 0
    s_bfe_u32 s58, s3, 0x60016
    s_and_b32 s59, s58, 7
    s_lshr_b32 s60, s58, 3
K2_chk_84:
    v_readlane_b32 s61, v232, s59
    s_nop 0
    s_cmp_gt_u32 s61, s60
    s_cbranch_scc0 K2_spin_83
K2_back_85:
    v_mfma_f32_32x32x8_bf16 v[48:63], v[76:77], v[188:189], v[48:63]
    s_setprio 0
    s_lshl_b32 s44, s34, 7
    s_and_b32 s48, s3, 0x3ffff
    s_bfe_u32 s33, s3, 0x30013
    s_mov_b32 s35, s48
    s_mov_b32 s45, s44
    s_xor_b32 s47, s44, 256
    v_mul_f32 v234, v0, v96
    v_mul_f32 v236, v8, v128
    v_fmac_f32 v234, v1, v97
    v_fmac_f32 v236, v9, v129
    v_fmac_f32 v234, v2, v98
    v_fmac_f32 v236, v10, v130
    v_fmac_f32 v234, v3, v99
    v_fmac_f32 v236, v11, v131
    v_fmac_f32 v234, v4, v100
    v_fmac_f32 v236, v12, v132
    v_fmac_f32 v234, v5, v101
    v_fmac_f32 v236, v13, v133
    v_fmac_f32 v234, v6, v102
    v_fmac_f32 v236, v14, v134
    v_fmac_f32 v234, v7, v103
    v_fmac_f32 v236, v15, v135
    v_mul_f32 v238, v16, v128
    v_mul_f32 v240, v24, v128
    v_fmac_f32 v238, v17, v129
    v_fmac_f32 v240, v25, v129
    v_fmac_f32 v238, v18, v130
    v_fmac_f32 v240, v26, v130
    v_fmac_f32 v238, v19, v131
    v_fmac_f32 v240, v27, v131
    v_fmac_f32 v238, v20, v132
    v_fmac_f32 v240, v28, v132
    v_fmac_f32 v238, v21, v133
    v_fmac_f32 v240, v29, v133
    v_fmac_f32 v238, v22, v134
    v_fmac_f32 v240, v30, v134
    v_fmac_f32 v238, v23, v135
    v_fmac_f32 v240, v31, v135
    v_mul_f32 v235, v32, v104
    v_mul_f32 v237, v40, v136
    v_fmac_f32 v235, v33, v105
    v_fmac_f32 v237, v41, v137
    v_fmac_f32 v235, v34, v106
    v_fmac_f32 v237, v42, v138
    v_fmac_f32 v235, v35, v107
    v_fmac_f32 v237, v43, v139
    v_fmac_f32 v235, v36, v108
    v_fmac_f32 v237, v44, v140
    v_fmac_f32 v235, v37, v109
    v_fmac_f32 v237, v45, v141
    v_fmac_f32 v235, v38, v110
    v_fmac_f32 v237, v46, v142
    v_fmac_f32 v235, v39, v111
    v_fmac_f32 v237, v47, v143
    v_mul_f32 v239, v48, v136
    v_mul_f32 v241, v56, v136
    s_setprio 1
    s_waitcnt vmcnt(3) lgkmcnt(2)
    v_mfma_f32_32x32x16_bf16 v[0:15], v[64:67], v[176:179], 0
    ds_read_b64_tr_b16 v[184:185], v246 offset:6144
    ds_read_b64_tr_b16 v[188:189], v247 offset:6144
    v_fmac_f32 v239, v49, v137
    v_fmac_f32 v241, v57, v137
    v_fmac_f32 v239, v50, v138
    v_fmac_f32 v241, v58, v138
    s_mov_b32 m0, s70
    v_mfma_f32_32x32x16_bf16 v[16:31], v[68:71], v[176:179], 0
    buffer_load_dwordx4 v222, s[4:7], s43 offen sc1 lds
    buffer_load_dwordx4 v223, s[72:75], s43 offen offset:1024 sc1 lds
    v_fmac_f32 v239, v51, v139
    v_fmac_f32 v241, v59, v139
    v_fmac_f32 v239, v52, v140
    v_fmac_f32 v241, v60, v140
    v_fmac_f32 v239, v53, v141
    v_mfma_f32_32x32x16_bf16 v[32:47], v[64:67], v[180:183], 0
    s_add_u32 s49, s48, 128
    s_add_u32 s60, s48, 256
    s_cmp_eq_u32 s33, 3
    s_cselect_b32 s46, s44, s47
    s_cselect_b32 s50, s60, s48
    s_sub_u32 s60, s33, 2
    s_cmp_lt_u32 s60, 2
    s_cbranch_scc0 K2_rare_86
K2_back_87:
    v_add_u32 v222, s48, v251
    ds_read2_b32 v[222:223], v222 offset0:1 offset1:3
    v_fmac_f32 v241, v61, v141
    v_fmac_f32 v239, v54, v142
    v_fmac_f32 v241, v62, v142
    v_fmac_f32 v239, v55, v143
    v_fmac_f32 v241, v63, v143
    v_mfma_f32_32x32x16_bf16 v[48:63], v[68:71], v[180:183], 0
    v_permlane32_swap_b32 v234, v236
    v_permlane32_swap_b32 v235, v237
    v_permlane32_swap_b32 v240, v238
    s_waitcnt vmcnt(3) lgkmcnt(1)
    v_mfma_f32_32x32x8_bf16 v[0:15], v[72:73], v[184:185], v[0:15]
    ds_read_b64_tr_b16 v[176:177], v246 offset:0
    ds_read_b64_tr_b16 v[178:179], v246 offset:1024
    ds_read_b64_tr_b16 v[180:181], v247 offset:0
    ds_read_b64_tr_b16 v[182:183], v247 offset:1024
    v_permlane32_swap_b32 v241, v239
    s_mov_b32 m0, s71
    v_mfma_f32_32x32x8_bf16 v[16:31], v[76:77], v[184:185], v[16:31]
    buffer_load_dwordx4 v224, s[4:7], s43 offen sc1 lds
    s_waitcnt lgkmcnt(4)
    v_mad_u32_u16 v222, v222, s39, v248 op_sel:[1,0,0,0]
    v_mad_u32_u16 v223, v223, s39, v248 op_sel:[1,0,0,0]
    v_lshl_add_u32 v230, v252, 1, s31
    v_add_f32 v234, v234, v236
    v_add_f32 v235, v235, v237
    v_add_f32 v240, v240, v238
    v_add_f32 v241, v241, v239
    v_cvt_pk_bf16_f32 v234, v234, v235
    v_cvt_pk_bf16_f32 v240, v240, v241
    ds_write2st64_b32 v230, v234, v240 offset0:0 offset1:1
    v_mfma_f32_32x32x8_bf16 v[32:47], v[72:73], v[188:189], v[32:47]
    v_add_u32 v224, s49, v251
    ds_read2_b32 v[224:225], v224 offset0:1 offset1:3
    v_mul_f32 v234, v0, v144
    v_mul_f32 v236, v8, v112
    v_fmac_f32 v234, v1, v145
    v_fmac_f32 v236, v9, v113
    v_fmac_f32 v234, v2, v146
    v_mfma_f32_32x32x8_bf16 v[48:63], v[76:77], v[188:189], v[48:63]
    s_setprio 0
    v_fmac_f32 v236, v10, v114
    v_fmac_f32 v234, v3, v147
    v_fmac_f32 v236, v11, v115
    v_fmac_f32 v234, v4, v148
    v_fmac_f32 v236, v12, v116
    v_fmac_f32 v234, v5, v149
    v_fmac_f32 v236, v13, v117
    v_fmac_f32 v234, v6, v150
    v_fmac_f32 v236, v14, v118
    v_fmac_f32 v234, v7, v151
    v_fmac_f32 v236, v15, v119
    v_mul_f32 v238, v16, v160
    v_mul_f32 v240, v24, v160
    v_fmac_f32 v238, v17, v161
    v_fmac_f32 v240, v25, v161
    v_fmac_f32 v238, v18, v162
    v_fmac_f32 v240, v26, v162
    v_fmac_f32 v238, v19, v163
    v_fmac_f32 v240, v27, v163
    v_fmac_f32 v238, v20, v164
    v_fmac_f32 v240, v28, v164
    v_fmac_f32 v238, v21, v165
    v_fmac_f32 v240, v29, v165
    v_fmac_f32 v238, v22, v166
    v_fmac_f32 v240, v30, v166
    v_fmac_f32 v238, v23, v167
    v_fmac_f32 v240, v31, v167
    v_mul_f32 v235, v32, v152
    v_mul_f32 v237, v40, v120
    v_fmac_f32 v235, v33, v153
    v_fmac_f32 v237, v41, v121
    v_fmac_f32 v235, v34, v154
    v_fmac_f32 v237, v42, v122
    v_fmac_f32 v235, v35, v155
    v_fmac_f32 v237, v43, v123
    v_fmac_f32 v235, v36, v156
    v_fmac_f32 v237, v44, v124
    v_fmac_f32 v235, v37, v157
    v_fmac_f32 v237, v45, v125
    v_fmac_f32 v235, v38, v158
    v_fmac_f32 v237, v46, v126
    v_fmac_f32 v235, v39, v159
    v_fmac_f32 v237, v47, v127
    v_mul_f32 v239, v48, v168
    v_mul_f32 v241, v56, v168
    v_fmac_f32 v239, v49, v169
    v_fmac_f32 v241, v57, v169
    v_fmac_f32 v239, v50, v170
    s_setprio 1
    s_waitcnt vmcnt(3) lgkmcnt(2)
    v_mfma_f32_32x32x16_bf16 v[0:15], v[64:67], v[176:179], 0
    ds_read_b64_tr_b16 v[184:185], v246 offset:2048
    ds_read_b64_tr_b16 v[188:189], v247 offset:2048
    v_fmac_f32 v241, v58, v170
    v_fmac_f32 v239, v51, v171
    v_fmac_f32 v241, v59, v171
    v_fmac_f32 v239, v52, v172
    s_mov_b32 m0, s68
    v_mfma_f32_32x32x16_bf16 v[16:31], v[68:71], v[176:179], 0
    buffer_load_dwordx4 v222, s[4:7], s44 offen sc1 lds
    buffer_load_dwordx4 v223, s[72:75], s44 offen offset:1024 sc1 lds
    s_waitcnt lgkmcnt(2)
    v_mad_u32_u16 v224, v224, s39, v248 op_sel:[1,0,0,0]
    v_mad_u32_u16 v225, v225, s39, v248 op_sel:[1,0,0,0]
    v_fmac_f32 v241, v60, v172
    v_fmac_f32 v239, v53, v173
    v_mfma_f32_32x32x16_bf16 v[32:47], v[64:67], v[180:183], 0
    v_add_u32 v226, s50, v251
    ds_read2_b32 v[226:227], v226 offset0:1 offset1:3
    v_fmac_f32 v241, v61, v173
    v_fmac_f32 v239, v54, v174
    v_fmac_f32 v241, v62, v174
    v_fmac_f32 v239, v55, v175
    v_fmac_f32 v241, v63, v175
    v_mfma_f32_32x32x16_bf16 v[48:63], v[68:71], v[180:183], 0
    s_waitcnt vmcnt(3) lgkmcnt(1)
    v_mfma_f32_32x32x8_bf16 v[0:15], v[72:73], v[184:185], v[0:15]
    ds_read_b64_tr_b16 v[176:177], v246 offset:4096
    ds_read_b64_tr_b16 v[178:179], v246 offset:5120
    ds_read_b64_tr_b16 v[180:181], v247 offset:4096
    ds_read_b64_tr_b16 v[182:183], v247 offset:5120
    s_mov_b32 m0, s69
    v_mfma_f32_32x32x8_bf16 v[16:31], v[76:77], v[184:185], v[16:31]
    buffer_load_dwordx4 v224, s[4:7], s45 offen sc1 lds
    buffer_load_dwordx4 v225, s[72:75], s45 offen offset:1024 sc1 lds
    s_waitcnt lgkmcnt(4)
    v_mad_u32_u16 v226, v226, s39, v248 op_sel:[1,0,0,0]
    v_mad_u32_u16 v227, v227, s39, v248 op_sel:[1,0,0,0]
    v_mfma_f32_32x32x8_bf16 v[32:47], v[72:73], v[188:189], v[32:47]
    v_mul_f32 v242, v0, v144
    v_fma_f32 v238, v8, v160, -v238
    v_fmac_f32 v242, v1, v145
    v_fmac_f32 v238, v9, v161
    v_fmac_f32 v242, v2, v146
    v_fmac_f32 v238, v10, v162
    v_fmac_f32 v242, v3, v147
    v_mfma_f32_32x32x8_bf16 v[48:63], v[76:77], v[188:189], v[48:63]
    s_setprio 0
    v_fmac_f32 v238, v11, v163
    v_fmac_f32 v242, v4, v148
    v_fmac_f32 v238, v12, v164
    v_fmac_f32 v242, v5, v149
    v_fmac_f32 v238, v13, v165
    v_fmac_f32 v242, v6, v150
    v_fmac_f32 v238, v14, v166
    v_fmac_f32 v242, v7, v151
    v_fmac_f32 v238, v15, v167
    v_fmac_f32 v236, v16, v112
    v_mul_f32 v244, v24, v160
    v_fmac_f32 v236, v17, v113
    v_fmac_f32 v244, v25, v161
    v_fmac_f32 v236, v18, v114
    v_fmac_f32 v244, v26, v162
    v_fmac_f32 v236, v19, v115
    v_fmac_f32 v244, v27, v163
    v_fmac_f32 v236, v20, v116
    v_fmac_f32 v244, v28, v164
    v_fmac_f32 v236, v21, v117
    v_fmac_f32 v244, v29, v165
    v_fmac_f32 v236, v22, v118
    v_fmac_f32 v244, v30, v166
    v_fmac_f32 v236, v23, v119
    v_fmac_f32 v244, v31, v167
    v_mul_f32 v243, v32, v152
    v_fma_f32 v239, v40, v168, -v239
    v_fmac_f32 v243, v33, v153
    v_fmac_f32 v239, v41, v169
    v_fmac_f32 v243, v34, v154
    v_fmac_f32 v239, v42, v170
    v_fmac_f32 v243, v35, v155
    v_fmac_f32 v239, v43, v171
    v_fmac_f32 v243, v36, v156
    v_fmac_f32 v239, v44, v172
    v_fmac_f32 v243, v37, v157
    v_fmac_f32 v239, v45, v173
    v_fmac_f32 v243, v38, v158
    v_fmac_f32 v239, v46, v174
    v_fmac_f32 v243, v39, v159
    v_fmac_f32 v239, v47, v175
    s_setprio 1
    s_waitcnt vmcnt(4) lgkmcnt(0)
    v_mfma_f32_32x32x16_bf16 v[0:15], v[64:67], v[176:179], 0
    ds_read_b64_tr_b16 v[184:185], v246 offset:6144
    ds_read_b64_tr_b16 v[188:189], v247 offset:6144
    v_fmac_f32 v237, v48, v120
    v_mul_f32 v245, v56, v168
    v_fmac_f32 v237, v49, v121
    v_fmac_f32 v245, v57, v169
    s_mov_b32 m0, s70
    v_mfma_f32_32x32x16_bf16 v[16:31], v[68:71], v[176:179], 0
    buffer_load_dwordx4 v226, s[4:7], s46 offen sc1 lds
    buffer_load_dwordx4 v227, s[72:75], s46 offen offset:1024 sc1 lds
    v_fmac_f32 v237, v50, v122
    v_fmac_f32 v245, v58, v170
    v_fmac_f32 v237, v51, v123
    v_fmac_f32 v245, v59, v171
    v_fmac_f32 v237, v52, v124
    v_mfma_f32_32x32x16_bf16 v[32:47], v[64:67], v[180:183], 0
    v_fmac_f32 v245, v60, v172
    v_fmac_f32 v237, v53, v125
    v_fmac_f32 v245, v61, v173
    v_fmac_f32 v237, v54, v126
    v_fmac_f32 v245, v62, v174
    v_fmac_f32 v237, v55, v127
    v_fmac_f32 v245, v63, v175
    v_mfma_f32_32x32x16_bf16 v[48:63], v[68:71], v[180:183], 0
    v_permlane32_swap_b32 v242, v234
    v_permlane32_swap_b32 v243, v235
    v_add_f32 v242, v242, v234
    v_add_f32 v243, v243, v235
    s_waitcnt vmcnt(4) lgkmcnt(0)
    v_mfma_f32_32x32x8_bf16 v[0:15], v[72:73], v[184:185], v[0:15]
    ds_read_b64_tr_b16 v[176:177], v246 offset:0
    ds_read_b64_tr_b16 v[178:179], v246 offset:1024
    ds_read_b64_tr_b16 v[180:181], v247 offset:0
    ds_read_b64_tr_b16 v[182:183], v247 offset:1024
    v_cvt_pk_bf16_f32 v242, v242, v243
    ds_write_b32 v230, v242 offset:512
    s_mov_b32 m0, s71
    v_mfma_f32_32x32x8_bf16 v[16:31], v[76:77], v[184:185], v[16:31]
    s_cmp_eq_u32 s33, 4
    s_cbranch_scc1 K2_g4_89
    buffer_load_dwordx4 v224, s[4:7], s47 offen sc1 lds
    buffer_load_dwordx4 v225, s[72:75], s47 offen offset:1024 sc1 lds
K2_back_90:
    s_sub_u32 s26, s48, s29
    s_mov_b32 s29, s48
    s_mov_b32 s30, s3
    s_bfe_u32 s56, s3, 0x40012
    s_cmp_lg_u32 s36, 0
    s_cselect_b32 s56, s56, 0
    v_mfma_f32_32x32x8_bf16 v[32:47], v[72:73], v[188:189], v[32:47]
    s_mov_b32 s32, s31
    s_mov_b32 s31, s35
    v_mul_f32 v242, v0, v144
    v_fma_f32 v240, v8, v160, -v240
    v_fmac_f32 v242, v1, v145
    v_fmac_f32 v240, v9, v161
    v_fmac_f32 v242, v2, v146
    v_mfma_f32_32x32x8_bf16 v[48:63], v[76:77], v[188:189], v[48:63]
    s_setprio 0
    v_fmac_f32 v240, v10, v162
    v_fmac_f32 v242, v3, v147
    v_fmac_f32 v240, v11, v163
    v_fmac_f32 v242, v4, v148
    v_fmac_f32 v240, v12, v164
    v_fmac_f32 v242, v5, v149
    v_fmac_f32 v240, v13, v165
    v_fmac_f32 v242, v6, v150
    v_fmac_f32 v240, v14, v166
    v_fmac_f32 v242, v7, v151
    v_fmac_f32 v240, v15, v167
    v_add_u32 v249, s26, v249
    v_add_u32 v250, s26, v250
    v_fma_f32 v244, v16, v160, -v244
    v_fmac_f32 v236, v24, v112
    v_fmac_f32 v244, v17, v161
    v_fmac_f32 v236, v25, v113
    v_fmac_f32 v244, v18, v162
    v_fmac_f32 v236, v26, v114
    v_fmac_f32 v244, v19, v163
    v_fmac_f32 v236, v27, v115
    v_fmac_f32 v244, v20, v164
    v_fmac_f32 v236, v28, v116
    v_fmac_f32 v244, v21, v165
    v_fmac_f32 v236, v29, v117
    v_fmac_f32 v244, v22, v166
    v_fmac_f32 v236, v30, v118
    v_fmac_f32 v244, v23, v167
    v_fmac_f32 v236, v31, v119
    ds_read_b64_tr_b16 v[0:1], v249 offset:0
    ds_read_b64_tr_b16 v[2:3], v249 offset:32
    ds_read_u16_d16_hi v16, v250 offset:0
    v_mul_f32 v243, v32, v152
    v_fma_f32 v241, v40, v168, -v241
    v_fmac_f32 v243, v33, v153
    v_fmac_f32 v241, v41, v169
    v_fmac_f32 v243, v34, v154
    v_fmac_f32 v241, v42, v170
    v_fmac_f32 v243, v35, v155
    v_fmac_f32 v241, v43, v171
    v_fmac_f32 v243, v36, v156
    v_fmac_f32 v241, v44, v172
    v_fmac_f32 v243, v37, v157
    v_fmac_f32 v241, v45, v173
    v_fmac_f32 v243, v38, v158
    v_fmac_f32 v241, v46, v174
    v_fmac_f32 v243, v39, v159
    v_fmac_f32 v241, v47, v175
    ds_read_b64_tr_b16 v[4:5], v249 offset:512
    ds_read_b64_tr_b16 v[6:7], v249 offset:544
    ds_read_u16_d16_hi v17, v250 offset:128
    v_fma_f32 v245, v48, v168, -v245
    v_fmac_f32 v237, v56, v120
    v_fmac_f32 v245, v49, v169
    v_fmac_f32 v237, v57, v121
    v_fmac_f32 v245, v50, v170
    v_fmac_f32 v237, v58, v122
    v_fmac_f32 v245, v51, v171
    v_fmac_f32 v237, v59, v123
    v_fmac_f32 v245, v52, v172
    v_fmac_f32 v237, v60, v124
    v_fmac_f32 v245, v53, v173
    v_fmac_f32 v237, v61, v125
    v_fmac_f32 v245, v54, v174
    v_fmac_f32 v237, v62, v126
    v_fmac_f32 v245, v55, v175
    v_fmac_f32 v237, v63, v127
    s_cmp_eq_u32 s56, 5
    s_cbranch_scc1 K2_U21
    s_cmp_eq_u32 s56, 6
    s_cbranch_scc1 K2_U3h1
    s_branch K2_DSP1
K2_PAD_SW:
    s_branch K2_HOP
K2_DSP0:
    s_cmp_eq_u32 s56, 4
    s_cbranch_scc1 K2_U20
    s_cmp_eq_u32 s56, 7
    s_cbranch_scc1 K2_U30
    s_cmp_gt_u32 s56, 7
    s_cbranch_scc1 K2_U40
    s_cmp_lg_u32 s56, 0
    s_cbranch_scc1 K2_U10
    s_branch K2_SWITCH
K2_DSP1:
    s_cmp_eq_u32 s56, 4
    s_cbranch_scc1 K2_U2h1
    s_cmp_eq_u32 s56, 7
    s_cbranch_scc1 K2_U31
    s_cmp_gt_u32 s56, 7
    s_cbranch_scc1 K2_U41
    s_cmp_lg_u32 s56, 0
    s_cbranch_scc1 K2_U11
    s_branch K2_TAIL
K2_SWITCH:
    v_lshlrev_b32 v60, 3, v252
    s_mov_b32 s64, 7176192
    buffer_load_dwordx4 v[56:59], v60, s[8:11], s64 offen sc1
    v_permlane32_swap_b32 v242, v236
    v_permlane32_swap_b32 v243, v237
    v_permlane32_swap_b32 v244, v238
    v_permlane32_swap_b32 v245, v239
    v_permlane32_swap_b32 v240, v241
    v_add_f32 v242, v242, v236
    v_add_f32 v243, v243, v237
    v_add_f32 v244, v244, v238
    v_add_f32 v245, v245, v239
    v_add_f32 v240, -v240, -v241
    s_set_gpr_idx_on s32, gpr_idx(DST)
    s_nop 0
    v_cvt_pk_bf16_f32 v195, v242, v243
    v_cvt_pk_bf16_f32 v196, v244, v245
    v_cvt_pk_bf16_f32 v197, v240, v240
    s_set_gpr_idx_off
    v_lshl_add_u32 v230, v252, 1, s35
    v_lshrrev_b32 v231, 6, v252
    v_mul_u32_u24 v231, 126, v231
    v_bfe_u32 v61, v253, 22, 6
    v_lshlrev_b32 v62, 21, v252
    s_mov_b32 s58, 264241152
    v_lshlrev_b32 v61, 2, v61
    v_bfi_b32 v62, s58, v62, v253
    ds_bpermute_b32 v253, v61, v62
    v_lshrrev_b32 v254, 6, v252
    v_bfe_u32 v255, v252, 3, 2
    v_lshl_add_u32 v254, v254, 2, v255
    v_mul_u32_u24 v254, 640, v254
    v_bfe_u32 v255, v252, 5, 1
    v_lshl_add_u32 v254, v255, 5, v254
    v_and_b32 v255, 6, v252
    v_lshl_add_u32 v254, v255, 2, v254
    v_add_u32 v254, 152832, v254
    ds_read_b64_tr_b16 v[104:105], v254 offset:0
    ds_read_b64_tr_b16 v[106:107], v254 offset:5120
    ds_read_b64_tr_b16 v[108:109], v254 offset:64
    ds_read_b64_tr_b16 v[110:111], v254 offset:5184
    ds_read_b64_tr_b16 v[120:121], v254 offset:128
    ds_read_b64_tr_b16 v[122:123], v254 offset:5248
    ds_read_b64_tr_b16 v[124:125], v254 offset:192
    ds_read_b64_tr_b16 v[126:127], v254 offset:5312
    ds_read_b64_tr_b16 v[136:137], v254 offset:256
    ds_read_b64_tr_b16 v[138:139], v254 offset:5376
    ds_read_b64_tr_b16 v[140:141], v254 offset:320
    ds_read_b64_tr_b16 v[142:143], v254 offset:5440
    ds_read_b64_tr_b16 v[152:153], v254 offset:384
    ds_read_b64_tr_b16 v[154:155], v254 offset:5504
    ds_read_b64_tr_b16 v[156:157], v254 offset:448
    ds_read_b64_tr_b16 v[158:159], v254 offset:5568
    ds_read_b64_tr_b16 v[168:169], v254 offset:512
    ds_read_b64_tr_b16 v[170:171], v254 offset:5632
    ds_read_b64_tr_b16 v[172:173], v254 offset:576
    ds_read_b64_tr_b16 v[174:175], v254 offset:5696
    s_movk_i32 s40, 128
    s_movk_i32 s41, 384
    s_movk_i32 s42, 640
    s_movk_i32 s43, 896
    v_lshl_add_u32 v254, v252, 1, s53
    v_bfe_u32 v255, v252, 4, 1
    s_waitcnt lgkmcnt(15)
    v_lshlrev_b32 v96, 16, v104
    v_and_b32 v97, 0xffff0000, v104
    v_lshlrev_b32 v98, 16, v105
    v_and_b32 v99, 0xffff0000, v105
    v_lshlrev_b32 v100, 16, v106
    v_and_b32 v101, 0xffff0000, v106
    v_lshlrev_b32 v102, 16, v107
    v_and_b32 v103, 0xffff0000, v107
    v_lshlrev_b32 v104, 16, v108
    v_and_b32 v105, 0xffff0000, v108
    v_lshlrev_b32 v106, 16, v109
    v_and_b32 v107, 0xffff0000, v109
    v_lshlrev_b32 v108, 16, v110
    v_and_b32 v109, 0xffff0000, v110
    v_lshlrev_b32 v110, 16, v111
    v_and_b32 v111, 0xffff0000, v111
    s_waitcnt lgkmcnt(12)
    v_lshlrev_b32 v112, 16, v120
    v_and_b32 v113, 0xffff0000, v120
    v_lshlrev_b32 v114, 16, v121
    v_and_b32 v115, 0xffff0000, v121
    v_lshlrev_b32 v116, 16, v122
    v_and_b32 v117, 0xffff0000, v122
    v_lshlrev_b32 v118, 16, v123
    v_and_b32 v119, 0xffff0000, v123
    v_lshlrev_b32 v120, 16, v124
    v_and_b32 v121, 0xffff0000, v124
    v_lshlrev_b32 v122, 16, v125
    v_and_b32 v123, 0xffff0000, v125
    v_lshlrev_b32 v124, 16, v126
    v_and_b32 v125, 0xffff0000, v126
    v_lshlrev_b32 v126, 16, v127
    v_and_b32 v127, 0xffff0000, v127
    s_waitcnt lgkmcnt(8)
    v_lshlrev_b32 v128, 16, v136
    v_and_b32 v129, 0xffff0000, v136
    v_lshlrev_b32 v130, 16, v137
    v_and_b32 v131, 0xffff0000, v137
    v_lshlrev_b32 v132, 16, v138
    v_and_b32 v133, 0xffff0000, v138
    v_lshlrev_b32 v134, 16, v139
    v_and_b32 v135, 0xffff0000, v139
    v_lshlrev_b32 v136, 16, v140
    v_and_b32 v137, 0xffff0000, v140
    v_lshlrev_b32 v138, 16, v141
    v_and_b32 v139, 0xffff0000, v141
    v_lshlrev_b32 v140, 16, v142
    v_and_b32 v141, 0xffff0000, v142
    v_lshlrev_b32 v142, 16, v143
    v_and_b32 v143, 0xffff0000, v143
    s_waitcnt lgkmcnt(4)
    v_lshlrev_b32 v144, 16, v152
    v_and_b32 v145, 0xffff0000, v152
    v_lshlrev_b32 v146, 16, v153
    v_and_b32 v147, 0xffff0000, v153
    v_lshlrev_b32 v148, 16, v154
    v_and_b32 v149, 0xffff0000, v154
    v_lshlrev_b32 v150, 16, v155
    v_and_b32 v151, 0xffff0000, v155
    v_lshlrev_b32 v152, 16, v156
    v_and_b32 v153, 0xffff0000, v156
    v_lshlrev_b32 v154, 16, v157
    v_and_b32 v155, 0xffff0000, v157
    v_lshlrev_b32 v156, 16, v158
    v_and_b32 v157, 0xffff0000, v158
    v_lshlrev_b32 v158, 16, v159
    v_and_b32 v159, 0xffff0000, v159
    s_waitcnt lgkmcnt(0)
    v_lshlrev_b32 v160, 16, v168
    v_and_b32 v161, 0xffff0000, v168
    v_lshlrev_b32 v162, 16, v169
    v_and_b32 v163, 0xffff0000, v169
    v_lshlrev_b32 v164, 16, v170
    v_and_b32 v165, 0xffff0000, v170
    v_lshlrev_b32 v166, 16, v171
    v_and_b32 v167, 0xffff0000, v171
    v_lshlrev_b32 v168, 16, v172
    v_and_b32 v169, 0xffff0000, v172
    v_lshlrev_b32 v170, 16, v173
    v_and_b32 v171, 0xffff0000, v173
    v_lshlrev_b32 v172, 16, v174
    v_and_b32 v173, 0xffff0000, v174
    v_lshlrev_b32 v174, 16, v175
    v_and_b32 v175, 0xffff0000, v175
K2_FLGW:
    s_or_b32 s58, s54, s20
    s_waitcnt vmcnt(0)
    v_xor_b32 v56, s2, v56
    v_xor_b32 v57, s2, v57
    v_xor_b32 v58, s2, v58
    v_xor_b32 v59, s2, v59
    v_or3_b32 v56, v56, v57, v58
    v_or_b32 v56, v56, v59
    v_cmp_ne_u32 vcc, 0, v56
    s_nop 0
    s_cbranch_vccnz K2_FLGR
    s_cmp_eq_u32 s58, 0
    s_cbranch_scc1 K2_FLGY
K2_FLGOK:
    s_cmp_eq_u32 s36, 0
    s_cbranch_scc1 K2_TAIL2
    s_mov_b32 s29, s48
    s_mov_b32 s32, s31
    s_mov_b32 s30, s3
    s_mov_b32 s31, s35
    s_bfe_u32 s56, s3, 0x40012
    s_cmp_eq_u32 s56, 5
    s_cbranch_scc1 K2_U21
    s_cmp_eq_u32 s56, 6
    s_cbranch_scc1 K2_U3h1
    s_branch K2_DSP1
K2_dum_4:
    v_mov_b32 v232, -1
    s_mov_b32 m0, 163312
    s_mov_b64 exec, 1
    buffer_load_dwordx4 v232, s[16:19], 0 offen lds
    buffer_load_dwordx4 v232, s[16:19], 0 offen lds
    s_mov_b64 exec, -1
    s_branch K2_back_6
K2_nul_12:
    s_mov_b32 s58, 63
    s_mov_b32 s36, 0
    s_branch K2_back_15
K2_spin_13:
    s_sub_u32 s27, s27, 1
    s_cbranch_scc1 K2_END
    ds_read_b32 v232, v254
    s_waitcnt lgkmcnt(0)
    s_branch K2_chk_14
K2_dyn_10:
    v_lshl_add_u32 v254, v252, 1, s53
    v_bfe_u32 v255, v252, 4, 1
    s_mov_b64 exec, 0x1ff
    ds_add_rtn_u32 v232, v254, v255
    s_mov_b64 exec, -1
    s_waitcnt lgkmcnt(0)
    v_readlane_b32 s58, v232, 8
    s_nop 0
    s_cmp_lt_u32 s58, s22
    s_cbranch_scc0 K2_nul_12
    s_nop 0
    v_readlane_b32 s3, v253, s58
    s_nop 0
    s_bfe_u32 s58, s3, 0x60016
    s_and_b32 s59, s58, 7
    s_lshr_b32 s60, s58, 3
K2_chk_14:
    v_readlane_b32 s61, v232, s59
    s_nop 0
    s_cmp_gt_u32 s61, s60
    s_cbranch_scc0 K2_spin_13
K2_back_15:
    s_mov_b32 s34, 1
    s_branch K2_back_11
K2_dum_21:
    v_mov_b32 v232, -1
    s_mov_b32 m0, 163312
    s_mov_b64 exec, 1
    buffer_load_dwordx4 v232, s[16:19], 0 offen lds
    buffer_load_dwordx4 v232, s[16:19], 0 offen lds
    s_mov_b64 exec, -1
    s_branch K2_back_23
K2_nul_27:
    s_mov_b32 s58, 63
    s_mov_b32 s36, 0
    s_branch K2_back_30
K2_spin_28:
    s_sub_u32 s27, s27, 1
    s_cbranch_scc1 K2_END
    ds_read_b32 v232, v254
    s_waitcnt lgkmcnt(0)
    s_branch K2_chk_29
K2_dyn_25:
    v_lshl_add_u32 v254, v252, 1, s53
    v_bfe_u32 v255, v252, 4, 1
    s_mov_b64 exec, 0x1ff
    ds_add_rtn_u32 v232, v254, v255
    s_mov_b64 exec, -1
    s_waitcnt lgkmcnt(0)
    v_readlane_b32 s58, v232, 8
    s_nop 0
    s_cmp_lt_u32 s58, s22
    s_cbranch_scc0 K2_nul_27
    s_nop 0
    v_readlane_b32 s3, v253, s58
    s_nop 0
    s_bfe_u32 s58, s3, 0x60016
    s_and_b32 s59, s58, 7
    s_lshr_b32 s60, s58, 3
K2_chk_29:
    v_readlane_b32 s61, v232, s59
    s_nop 0
    s_cmp_gt_u32 s61, s60
    s_cbranch_scc0 K2_spin_28
K2_back_30:
    s_mov_b32 s34, 1
    s_branch K2_back_26
K2_dum_36:
    v_mov_b32 v232, -1
    s_mov_b32 m0, 163312
    s_mov_b64 exec, 1
    buffer_load_dwordx4 v232, s[16:19], 0 offen lds
    buffer_load_dwordx4 v232, s[16:19], 0 offen lds
    s_mov_b64 exec, -1
    s_branch K2_back_38
K2_nul_42:
    s_mov_b32 s58, 63
    s_mov_b32 s36, 0
    s_branch K2_back_45
K2_spin_43:
    s_sub_u32 s27, s27, 1
    s_cbranch_scc1 K2_END
    ds_read_b32 v232, v254
    s_waitcnt lgkmcnt(0)
    s_branch K2_chk_44
K2_dyn_40:
    v_lshl_add_u32 v254, v252, 1, s53
    v_bfe_u32 v255, v252, 4, 1
    s_mov_b64 exec, 0x1ff
    ds_add_rtn_u32 v232, v254, v255
    s_mov_b64 exec, -1
    s_waitcnt lgkmcnt(0)
    v_readlane_b32 s58, v232, 8
    s_nop 0
    s_cmp_lt_u32 s58, s22
    s_cbranch_scc0 K2_nul_42
    s_nop 0
    v_readlane_b32 s3, v253, s58
    s_nop 0
    s_bfe_u32 s58, s3, 0x60016
    s_and_b32 s59, s58, 7
    s_lshr_b32 s60, s58, 3
K2_chk_44:
    v_readlane_b32 s61, v232, s59
    s_nop 0
    s_cmp_gt_u32 s61, s60
    s_cbranch_scc0 K2_spin_43
K2_back_45:
    s_mov_b32 s34, 1
    s_branch K2_back_41
K2_dum_51:
    v_mov_b32 v232, -1
    s_mov_b32 m0, 163312
    s_mov_b64 exec, 1
    buffer_load_dwordx4 v232, s[16:19], 0 offen lds
    buffer_load_dwordx4 v232, s[16:19], 0 offen lds
    s_mov_b64 exec, -1
    s_branch K2_back_53
K2_nul_55:
    s_mov_b32 s3, 949760
    s_mov_b32 s36, 0
    s_branch K2_back_58
K2_spin_56:
    s_sub_u32 s27, s27, 1
    s_cbranch_scc1 K2_END
    ds_read_b32 v232, v254
    s_waitcnt lgkmcnt(0)
    s_branch K2_chk_57
K2_nul_64:
    s_mov_b32 s3, 949760
    s_mov_b32 s36, 0
    s_branch K2_back_67
K2_spin_65:
    s_sub_u32 s27, s27, 1
    s_cbranch_scc1 K2_END
    ds_read_b32 v232, v254
    s_waitcnt lgkmcnt(0)
    s_branch K2_chk_66
K2_nul_73:
    s_mov_b32 s3, 949760
    s_mov_b32 s36, 0
    s_branch K2_back_76
K2_spin_74:
    s_sub_u32 s27, s27, 1
    s_cbranch_scc1 K2_END
    ds_read_b32 v232, v254
    s_waitcnt lgkmcnt(0)
    s_branch K2_chk_75
K2_nul_82:
    s_mov_b32 s3, 949760
    s_mov_b32 s36, 0
    s_branch K2_back_85
K2_spin_83:
    s_sub_u32 s27, s27, 1
    s_cbranch_scc1 K2_END
    ds_read_b32 v232, v254
    s_waitcnt lgkmcnt(0)
    s_branch K2_chk_84
K2_PAD_TL:
    s_branch K2_HOP
K2_TAIL2:
    v_lshlrev_b32 v229, 3, v252
    s_mul_i32 s58, s20, 20480
    s_add_u32 s58, s58, 6946816
    s_mul_i32 s59, s20, 8224
    buffer_load_dwordx4 v[96:99], v229, s[8:11], s58 offen offset:0 sc1
    buffer_load_dwordx4 v[100:103], v229, s[8:11], s58 offen offset:1024 sc1
    buffer_load_dwordx4 v[104:107], v229, s[8:11], s58 offen offset:2048 sc1
    buffer_load_dwordx4 v[108:111], v229, s[8:11], s58 offen offset:3072 sc1
    s_add_u32 s58, s58, 4096
    buffer_load_dwordx4 v[128:131], v229, s[8:11], s58 offen offset:0 sc1
    buffer_load_dwordx4 v[132:135], v229, s[8:11], s58 offen offset:1024 sc1
    buffer_load_dwordx4 v[136:139], v229, s[8:11], s58 offen offset:2048 sc1
    buffer_load_dwordx4 v[140:143], v229, s[8:11], s58 offen offset:3072 sc1
    v_lshl_add_u32 v228, v252, 1, s59
    v_lshrrev_b32 v226, 6, v252
    v_mul_u32_u24 v226, 126, v226
    v_sub_u32 v226, v228, v226
    s_branch K2_TAIL3
K2_TAIL:
    v_lshlrev_b32 v229, 3, v252
    s_mul_i32 s58, s20, 20480
    s_add_u32 s58, s58, 6946816
    s_mul_i32 s59, s20, 8224
    buffer_load_dwordx4 v[96:99], v229, s[8:11], s58 offen offset:0 sc1
    v_permlane32_swap_b32 v242, v236
    v_permlane32_swap_b32 v243, v237
    v_permlane32_swap_b32 v244, v238
    buffer_load_dwordx4 v[100:103], v229, s[8:11], s58 offen offset:1024 sc1
    v_permlane32_swap_b32 v245, v239
    v_permlane32_swap_b32 v240, v241
    v_add_f32 v242, v242, v236
    buffer_load_dwordx4 v[104:107], v229, s[8:11], s58 offen offset:2048 sc1
    v_add_f32 v243, v243, v237
    v_add_f32 v244, v244, v238
    v_add_f32 v245, v245, v239
    buffer_load_dwordx4 v[108:111], v229, s[8:11], s58 offen offset:3072 sc1
    v_add_f32 v240, -v240, -v241
    v_sub_u32 v241, v230, v231
    v_cvt_pk_bf16_f32 v242, v242, v243
    s_add_u32 s58, s58, 4096
    buffer_load_dwordx4 v[128:131], v229, s[8:11], s58 offen offset:0 sc1
    v_cvt_pk_bf16_f32 v244, v244, v245
    v_cvt_pk_bf16_f32 v240, v240, v240
    ds_write2st64_b32 v230, v242, v244 offset0:3 offset1:4
    buffer_load_dwordx4 v[132:135], v229, s[8:11], s58 offen offset:1024 sc1
    ds_write_b16 v241, v240 offset:1280
    v_lshl_add_u32 v228, v252, 1, s59
    v_lshrrev_b32 v226, 6, v252
    buffer_load_dwordx4 v[136:139], v229, s[8:11], s58 offen offset:2048 sc1
    v_mul_u32_u24 v226, 126, v226
    v_sub_u32 v226, v228, v226
    buffer_load_dwordx4 v[140:143], v229, s[8:11], s58 offen offset:3072 sc1
K2_TAIL3:
    s_waitcnt vmcnt(8)
    ds_write2st64_b32 v228, v192, v193 offset0:0 offset1:1
    ds_write2st64_b32 v228, v194, v195 offset0:2 offset1:3
    s_add_u32 s58, s58, 4096
    buffer_load_dwordx4 v[112:115], v229, s[8:11], s58 offen offset:0 sc1
    v_bfe_u32 v48, v252, 1, 4
    v_lshrrev_b32 v49, 5, v252
    ds_write_b16 v226, v197 offset:1280
    ds_write2st64_b32 v228, v196, v198 offset0:4 offset1:6
    buffer_load_dwordx4 v[116:119], v229, s[8:11], s58 offen offset:1024 sc1
    v_lshrrev_b32 v55, 3, v48
    v_lshlrev_b32 v52, 4, v49
    ds_write2st64_b32 v228, v199, v200 offset0:7 offset1:8
    ds_write2st64_b32 v228, v201, v202 offset0:9 offset1:10
    buffer_load_dwordx4 v[120:123], v229, s[8:11], s58 offen offset:2048 sc1
    v_lshl_add_u32 v54, v55, 2, v48
    v_and_b32 v54, 7, v54
    ds_write_b16 v226, v203 offset:2816
    ds_write2st64_b32 v228, v204, v205 offset0:12 offset1:13
    buffer_load_dwordx4 v[124:127], v229, s[8:11], s58 offen offset:3072 sc1
    v_and_b32 v50, 7, v48
    v_mul_u32_u24 v50, 8224, v50
    ds_write2st64_b32 v228, v206, v207 offset0:14 offset1:15
    ds_write2st64_b32 v228, v208, v210 offset0:16 offset1:18
    s_add_u32 s58, s58, 4096
    buffer_load_dwordx4 v[144:147], v229, s[8:11], s58 offen offset:0 sc1
    v_mul_u32_u24 v51, 1536, v55
    v_add_u32 v50, v50, v51
    ds_write_b16 v226, v209 offset:4352
    ds_write2st64_b32 v228, v211, v212 offset0:19 offset1:20
    buffer_load_dwordx4 v[148:151], v229, s[8:11], s58 offen offset:1024 sc1
    v_add_u32 v222, v50, v52
    v_mul_u32_u24 v51, 8224, v54
    ds_write2st64_b32 v228, v213, v214 offset0:21 offset1:22
    ds_write2st64_b32 v228, v216, v217 offset0:24 offset1:25
    buffer_load_dwordx4 v[152:155], v229, s[8:11], s58 offen offset:2048 sc1
    v_add_u32 v232, v51, v52
    v_lshl_add_u32 v247, v55, 7, v232
    ds_write_b16 v226, v215 offset:5888
    ds_write2st64_b32 v228, v218, v219 offset0:26 offset1:27
    buffer_load_dwordx4 v[156:159], v229, s[8:11], s58 offen offset:3072 sc1
    v_mul_u32_u24 v51, 2080, v48
    s_mov_b32 s60, 65536
    ds_write_b32 v228, v220 offset:7168
    ds_write_b16 v226, v221 offset:7424
    s_add_u32 s58, s58, 4096
    buffer_load_dwordx4 v[160:163], v229, s[8:11], s58 offen offset:0 sc1
    v_add3_u32 v223, v51, v52, s60
    v_mul_u32_u24 v51, 2080, v54
    buffer_load_dwordx4 v[164:167], v229, s[8:11], s58 offen offset:1024 sc1
    s_mov_b32 s60, 132096
    v_add3_u32 v225, v51, v52, s60
    buffer_load_dwordx4 v[168:171], v229, s[8:11], s58 offen offset:2048 sc1
    v_lshl_add_u32 v248, v55, 7, v225
    s_lshl_b32 s60, s20, 5
    buffer_load_dwordx4 v[172:175], v229, s[8:11], s58 offen offset:3072 sc1
    v_lshl_add_u32 v49, v49, 3, s60
    s_mov_b32 s60, 65536
    v_add3_u32 v255, v51, v49, s60
    v_lshl_add_u32 v246, v55, 9, v255
    v_bfe_u32 v53, v48, 2, 1
    v_lshl_add_u32 v49, v53, 4, v49
    v_add_u32 v254, v50, v49
    s_and_b32 s64, s55, s28
    s_waitcnt lgkmcnt(0)
    s_barrier
    s_cmp_eq_u32 s64, 0
    s_cbranch_scc1 K2_MULTI
    s_setprio 3
    ds_read_b128 v[48:51], v222 offset:0
    ds_read_b128 v[52:55], v222 offset:64
    ds_read_b128 v[56:59], v222 offset:896
    ds_read_b128 v[60:63], v222 offset:960
    ds_read_b128 v[64:67], v223 offset:0
    ds_read_b128 v[68:71], v223 offset:64
    ds_read_b128 v[72:75], v223 offset:896
    ds_read_b128 v[76:79], v223 offset:960
    ds_read_b128 v[80:83], v222 offset:3072
    ds_read_b128 v[84:87], v222 offset:3136
    ds_read_b128 v[88:91], v222 offset:3968
    s_waitcnt vmcnt(19) lgkmcnt(9)
    v_mfma_f32_16x16x32_bf16 v[0:3], v[96:99], v[48:51], 0
    ds_read_b128 v[92:95], v222 offset:4032
    s_waitcnt vmcnt(18)
    v_mfma_f32_16x16x32_bf16 v[0:3], v[100:103], v[52:55], v[0:3]
    ds_read_b128 v[48:51], v223 offset:33280
    s_waitcnt vmcnt(17) lgkmcnt(9)
    v_mfma_f32_16x16x32_bf16 v[0:3], v[104:107], v[56:59], v[0:3]
    s_bfe_u32 s60, s20, 0x10002
    s_lshl_b32 s60, s60, 4
    ds_read_b128 v[52:55], v223 offset:33344
    s_waitcnt vmcnt(16)
    v_mfma_f32_16x16x32_bf16 v[0:3], v[108:111], v[60:63], v[0:3]
    s_add_u32 s59, s59, s60
    v_add_u32 v228, s59, v229
    ds_read_b128 v[56:59], v223 offset:34176
    s_waitcnt vmcnt(15) lgkmcnt(9)
    v_mfma_f32_16x16x32_bf16 v[0:3], v[128:131], v[64:67], v[0:3]
    s_mul_i32 s60, s20, 2080
    s_add_u32 s60, s60, 65536
    ds_read_b128 v[60:63], v223 offset:34240
    s_waitcnt vmcnt(14)
    v_mfma_f32_16x16x32_bf16 v[0:3], v[132:135], v[68:71], v[0:3]
    v_add_u32 v249, s60, v229
    s_mov_b32 s63, 0xbfb8aa3b
    ds_read_b128 v[64:67], v232 offset:6144
    s_waitcnt vmcnt(13) lgkmcnt(9)
    v_mfma_f32_16x16x32_bf16 v[0:3], v[136:139], v[72:75], v[0:3]
    s_add_u32 s40, s20, s21
    s_lshl_b32 s40, s40, 10
    ds_read_b128 v[68:71], v232 offset:6208
    s_waitcnt vmcnt(12)
    v_mfma_f32_16x16x32_bf16 v[0:3], v[140:143], v[76:79], v[0:3]
    s_add_u32 s41, s40, 8192
    s_add_u32 s42, s40, 16384
    ds_read_b128 v[72:75], v232 offset:7040
    s_waitcnt lgkmcnt(9)
    v_mfma_f32_16x16x32_bf16 v[16:19], v[96:99], v[80:83], 0
    s_add_u32 s43, s40, 24576
    s_add_u32 s44, s40, 32768
    ds_read_b128 v[76:79], v232 offset:7104
    v_mfma_f32_16x16x32_bf16 v[16:19], v[100:103], v[84:87], v[16:19]
    ds_read_b128 v[80:83], v225 offset:0
    s_waitcnt lgkmcnt(9)
    v_mfma_f32_16x16x32_bf16 v[16:19], v[104:107], v[88:91], v[16:19]
    ds_read_b128 v[84:87], v225 offset:64
    v_mfma_f32_16x16x32_bf16 v[16:19], v[108:111], v[92:95], v[16:19]
    v_mul_f32 v204, s63, v0
    v_mul_f32 v205, s63, v1
    ds_read_b128 v[88:91], v225 offset:896
    s_waitcnt lgkmcnt(9)
    v_mfma_f32_16x16x32_bf16 v[16:19], v[128:131], v[48:51], v[16:19]
    v_mul_f32 v206, s63, v2
    ds_read_b128 v[92:95], v225 offset:960
    v_mfma_f32_16x16x32_bf16 v[16:19], v[132:135], v[52:55], v[16:19]
    v_mul_f32 v207, s63, v3
    ds_read_b128 v[48:51], v222 offset:128
    s_waitcnt lgkmcnt(9)
    v_mfma_f32_16x16x32_bf16 v[16:19], v[136:139], v[56:59], v[16:19]
    v_exp_f32 v204, v204
    ds_read_b128 v[52:55], v222 offset:384
    v_mfma_f32_16x16x32_bf16 v[16:19], v[140:143], v[60:63], v[16:19]
    v_exp_f32 v205, v205
    ds_read_b128 v[56:59], v222 offset:256
    s_waitcnt lgkmcnt(9)
    v_mfma_f32_16x16x32_bf16 v[32:35], v[96:99], v[64:67], 0
    v_exp_f32 v206, v206
    ds_read_b128 v[60:63], v222 offset:192
    v_mfma_f32_16x16x32_bf16 v[32:35], v[100:103], v[68:71], v[32:35]
    v_exp_f32 v207, v207
    s_setprio 2
    ds_read_b128 v[64:67], v222 offset:448
    s_waitcnt lgkmcnt(9)
    v_mfma_f32_16x16x32_bf16 v[32:35], v[104:107], v[72:75], v[32:35]
    v_add_f32 v204, 1.0, v204
    ds_read_b128 v[68:71], v222 offset:320
    v_mfma_f32_16x16x32_bf16 v[32:35], v[108:111], v[76:79], v[32:35]
    v_add_f32 v205, 1.0, v205
    v_add_f32 v206, 1.0, v206
    ds_read_b128 v[72:75], v222 offset:640
    s_waitcnt lgkmcnt(9)
    v_mfma_f32_16x16x32_bf16 v[32:35], v[128:131], v[80:83], v[32:35]
    v_add_f32 v207, 1.0, v207
    ds_read_b128 v[76:79], v222 offset:512
    v_mfma_f32_16x16x32_bf16 v[32:35], v[132:135], v[84:87], v[32:35]
    v_rcp_f32 v204, v204
    ds_read_b128 v[80:83], v222 offset:768
    s_waitcnt lgkmcnt(9)
    v_mfma_f32_16x16x32_bf16 v[32:35], v[136:139], v[88:91], v[32:35]
    v_rcp_f32 v205, v205
    ds_read_b128 v[84:87], v222 offset:704
    v_mfma_f32_16x16x32_bf16 v[32:35], v[140:143], v[92:95], v[32:35]
    v_rcp_f32 v206, v206
    ds_read_b128 v[88:91], v222 offset:576
    s_waitcnt vmcnt(11) lgkmcnt(9)
    v_mfma_f32_16x16x32_bf16 v[4:7], v[112:115], v[48:51], 0
    v_rcp_f32 v207, v207
    ds_read_b128 v[92:95], v222 offset:832
    v_mfma_f32_16x16x32_bf16 v[8:11], v[112:115], v[52:55], 0
    v_cvt_pk_bf16_f32 v176, v0, v1
    ds_read_b128 v[48:51], v222 offset:1024
    s_waitcnt lgkmcnt(9)
    v_mfma_f32_16x16x32_bf16 v[12:15], v[112:115], v[56:59], 0
    v_cvt_pk_bf16_f32 v177, v2, v3
    ds_read_b128 v[52:55], v222 offset:1280
    s_waitcnt vmcnt(10)
    v_mfma_f32_16x16x32_bf16 v[4:7], v[116:119], v[60:63], v[4:7]
    v_mul_f32 v208, s63, v16
    v_mul_f32 v209, s63, v17
    ds_read_b128 v[56:59], v222 offset:1152
    s_waitcnt lgkmcnt(9)
    v_mfma_f32_16x16x32_bf16 v[8:11], v[116:119], v[64:67], v[8:11]
    v_mul_f32 v210, s63, v18
    ds_read_b128 v[60:63], v222 offset:1088
    v_mfma_f32_16x16x32_bf16 v[12:15], v[116:119], v[68:71], v[12:15]
    v_mul_f32 v211, s63, v19
    ds_read_b128 v[64:67], v222 offset:1344
    s_waitcnt vmcnt(9) lgkmcnt(9)
    v_mfma_f32_16x16x32_bf16 v[4:7], v[120:123], v[72:75], v[4:7]
    v_exp_f32 v208, v208
    ds_read_b128 v[68:71], v222 offset:1216
    v_mfma_f32_16x16x32_bf16 v[8:11], v[120:123], v[76:79], v[8:11]
    v_exp_f32 v209, v209
    ds_read_b128 v[72:75], v223 offset:128
    s_waitcnt lgkmcnt(9)
    v_mfma_f32_16x16x32_bf16 v[12:15], v[120:123], v[80:83], v[12:15]
    v_exp_f32 v210, v210
    ds_read_b128 v[76:79], v223 offset:384
    s_waitcnt vmcnt(8)
    v_mfma_f32_16x16x32_bf16 v[4:7], v[124:127], v[84:87], v[4:7]
    v_exp_f32 v211, v211
    ds_read_b128 v[80:83], v223 offset:256
    s_waitcnt lgkmcnt(9)
    v_mfma_f32_16x16x32_bf16 v[8:11], v[124:127], v[88:91], v[8:11]
    v_add_f32 v208, 1.0, v208
    ds_read_b128 v[84:87], v223 offset:192
    v_mfma_f32_16x16x32_bf16 v[12:15], v[124:127], v[92:95], v[12:15]
    v_add_f32 v209, 1.0, v209
    v_add_f32 v210, 1.0, v210
    ds_read_b128 v[88:91], v223 offset:448
    s_waitcnt vmcnt(7) lgkmcnt(9)
    v_mfma_f32_16x16x32_bf16 v[4:7], v[144:147], v[48:51], v[4:7]
    v_add_f32 v211, 1.0, v211
    s_setprio 1
    ds_read_b128 v[92:95], v223 offset:320
    v_mfma_f32_16x16x32_bf16 v[8:11], v[144:147], v[52:55], v[8:11]
    v_rcp_f32 v208, v208
    ds_read_b128 v[48:51], v223 offset:640
    s_waitcnt lgkmcnt(9)
    v_mfma_f32_16x16x32_bf16 v[12:15], v[144:147], v[56:59], v[12:15]
    v_rcp_f32 v209, v209
    ds_read_b128 v[52:55], v223 offset:512
    s_waitcnt vmcnt(6)
    v_mfma_f32_16x16x32_bf16 v[4:7], v[148:151], v[60:63], v[4:7]
    v_rcp_f32 v210, v210
    ds_read_b128 v[56:59], v223 offset:768
    s_waitcnt lgkmcnt(9)
    v_mfma_f32_16x16x32_bf16 v[8:11], v[148:151], v[64:67], v[8:11]
    v_rcp_f32 v211, v211
    ds_read_b128 v[60:63], v223 offset:704
    v_mfma_f32_16x16x32_bf16 v[12:15], v[148:151], v[68:71], v[12:15]
K2_PAD_T2:
    s_cbranch_execz K2_HOP
    v_cvt_pk_bf16_f32 v184, v16, v17
    ds_read_b128 v[64:67], v223 offset:576
    s_waitcnt vmcnt(5) lgkmcnt(9)
    v_mfma_f32_16x16x32_bf16 v[4:7], v[152:155], v[72:75], v[4:7]
    v_cvt_pk_bf16_f32 v185, v18, v19
    ds_read_b128 v[68:71], v223 offset:832
    v_mfma_f32_16x16x32_bf16 v[8:11], v[152:155], v[76:79], v[8:11]
    v_mul_f32 v212, s63, v32
    v_mul_f32 v213, s63, v33
    ds_read_b128 v[72:75], v223 offset:1024
    s_waitcnt lgkmcnt(9)
    v_mfma_f32_16x16x32_bf16 v[12:15], v[152:155], v[80:83], v[12:15]
    v_mul_f32 v214, s63, v34
    ds_read_b128 v[76:79], v223 offset:1280
    s_waitcnt vmcnt(4)
    v_mfma_f32_16x16x32_bf16 v[4:7], v[156:159], v[84:87], v[4:7]
    v_mul_f32 v215, s63, v35
    ds_read_b128 v[80:83], v223 offset:1152
    s_waitcnt lgkmcnt(9)
    v_mfma_f32_16x16x32_bf16 v[8:11], v[156:159], v[88:91], v[8:11]
    v_exp_f32 v212, v212
    ds_read_b128 v[84:87], v223 offset:1088
    v_mfma_f32_16x16x32_bf16 v[12:15], v[156:159], v[92:95], v[12:15]
    v_exp_f32 v213, v213
    ds_read_b128 v[88:91], v223 offset:1344
    s_waitcnt vmcnt(3) lgkmcnt(9)
    v_mfma_f32_16x16x32_bf16 v[4:7], v[160:163], v[48:51], v[4:7]
    v_exp_f32 v214, v214
    ds_read_b128 v[92:95], v223 offset:1216
    v_mfma_f32_16x16x32_bf16 v[8:11], v[160:163], v[52:55], v[8:11]
    v_exp_f32 v215, v215
    ds_read_b128 v[48:51], v222 offset:3200
    s_waitcnt lgkmcnt(9)
    v_mfma_f32_16x16x32_bf16 v[12:15], v[160:163], v[56:59], v[12:15]
    v_add_f32 v212, 1.0, v212
    ds_read_b128 v[52:55], v222 offset:3456
    s_waitcnt vmcnt(2)
    v_mfma_f32_16x16x32_bf16 v[4:7], v[164:167], v[60:63], v[4:7]
    v_add_f32 v213, 1.0, v213
    v_add_f32 v214, 1.0, v214
    ds_read_b128 v[56:59], v222 offset:3328
    s_waitcnt lgkmcnt(9)
    v_mfma_f32_16x16x32_bf16 v[8:11], v[164:167], v[64:67], v[8:11]
    v_add_f32 v215, 1.0, v215
    ds_read_b128 v[60:63], v222 offset:3264
    v_mfma_f32_16x16x32_bf16 v[12:15], v[164:167], v[68:71], v[12:15]
    v_rcp_f32 v212, v212
    s_setprio 0
    ds_read_b128 v[64:67], v222 offset:3520
    s_waitcnt vmcnt(1) lgkmcnt(9)
    v_mfma_f32_16x16x32_bf16 v[4:7], v[168:171], v[72:75], v[4:7]
    v_rcp_f32 v213, v213
    ds_read_b128 v[68:71], v222 offset:3392
    v_mfma_f32_16x16x32_bf16 v[8:11], v[168:171], v[76:79], v[8:11]
    v_rcp_f32 v214, v214
    ds_read_b128 v[72:75], v222 offset:3712
    s_waitcnt lgkmcnt(9)
    v_mfma_f32_16x16x32_bf16 v[12:15], v[168:171], v[80:83], v[12:15]
    v_rcp_f32 v215, v215
    ds_read_b128 v[76:79], v222 offset:3584
    s_waitcnt vmcnt(0)
    v_mfma_f32_16x16x32_bf16 v[4:7], v[172:175], v[84:87], v[4:7]
    v_cvt_pk_bf16_f32 v220, v32, v33
    ds_read_b128 v[80:83], v222 offset:3840
    s_waitcnt lgkmcnt(9)
    v_mfma_f32_16x16x32_bf16 v[8:11], v[172:175], v[88:91], v[8:11]
    v_cvt_pk_bf16_f32 v221, v34, v35
    ds_read_b128 v[84:87], v222 offset:3776
    v_mfma_f32_16x16x32_bf16 v[12:15], v[172:175], v[92:95], v[12:15]
    ds_read_b128 v[88:91], v222 offset:3648
    s_waitcnt lgkmcnt(9)
    v_mfma_f32_16x16x32_bf16 v[20:23], v[112:115], v[48:51], 0
    ds_read_b128 v[92:95], v222 offset:3904
    v_mfma_f32_16x16x32_bf16 v[24:27], v[112:115], v[52:55], 0
    ds_read_b128 v[48:51], v222 offset:4096
    s_waitcnt lgkmcnt(9)
    v_mfma_f32_16x16x32_bf16 v[28:31], v[112:115], v[56:59], 0
    s_barrier
    s_setprio 3
    ds_read_b128 v[52:55], v222 offset:4352
    v_mfma_f32_16x16x32_bf16 v[20:23], v[116:119], v[60:63], v[20:23]
    v_mul_f32 v4, v4, v204
    ds_read_b128 v[56:59], v222 offset:4224
    s_waitcnt lgkmcnt(9)
    v_mfma_f32_16x16x32_bf16 v[24:27], v[116:119], v[64:67], v[24:27]
    v_mul_f32 v5, v5, v205
    ds_read_b128 v[60:63], v222 offset:4160
    v_mfma_f32_16x16x32_bf16 v[28:31], v[116:119], v[68:71], v[28:31]
    v_mul_f32 v6, v6, v206
    ds_read_b128 v[64:67], v222 offset:4416
    s_waitcnt lgkmcnt(9)
    v_mfma_f32_16x16x32_bf16 v[20:23], v[120:123], v[72:75], v[20:23]
    v_mul_f32 v7, v7, v207
    ds_read_b128 v[68:71], v222 offset:4288
    v_mfma_f32_16x16x32_bf16 v[24:27], v[120:123], v[76:79], v[24:27]
    v_cvt_pk_bf16_f32 v178, v4, v5
    ds_read_b128 v[72:75], v223 offset:33408
    s_waitcnt lgkmcnt(9)
    v_mfma_f32_16x16x32_bf16 v[28:31], v[120:123], v[80:83], v[28:31]
    v_cvt_pk_bf16_f32 v179, v6, v7
    ds_read_b128 v[76:79], v223 offset:33664
    v_mfma_f32_16x16x32_bf16 v[20:23], v[124:127], v[84:87], v[20:23]
    v_mul_f32 v8, v8, v204
    ds_read_b128 v[80:83], v223 offset:33536
    s_waitcnt lgkmcnt(9)
    v_mfma_f32_16x16x32_bf16 v[24:27], v[124:127], v[88:91], v[24:27]
    v_mul_f32 v9, v9, v205
    ds_read_b128 v[84:87], v223 offset:33472
    v_mfma_f32_16x16x32_bf16 v[28:31], v[124:127], v[92:95], v[28:31]
    v_mul_f32 v10, v10, v206
    ds_read_b128 v[88:91], v223 offset:33728
    s_waitcnt lgkmcnt(9)
    v_mfma_f32_16x16x32_bf16 v[20:23], v[144:147], v[48:51], v[20:23]
    v_mul_f32 v11, v11, v207
    s_setprio 2
    ds_read_b128 v[92:95], v223 offset:33600
    v_mfma_f32_16x16x32_bf16 v[24:27], v[144:147], v[52:55], v[24:27]
    v_cvt_pk_bf16_f32 v180, v8, v9
    ds_read_b128 v[48:51], v223 offset:33920
    s_waitcnt lgkmcnt(9)
    v_mfma_f32_16x16x32_bf16 v[28:31], v[144:147], v[56:59], v[28:31]
    v_cvt_pk_bf16_f32 v181, v10, v11
    ds_read_b128 v[52:55], v223 offset:33792
    v_mfma_f32_16x16x32_bf16 v[20:23], v[148:151], v[60:63], v[20:23]
    v_mul_f32 v12, v12, v204
    ds_read_b128 v[56:59], v223 offset:34048
    s_waitcnt lgkmcnt(9)
    v_mfma_f32_16x16x32_bf16 v[24:27], v[148:151], v[64:67], v[24:27]
    v_mul_f32 v13, v13, v205
    ds_read_b128 v[60:63], v223 offset:33984
    v_mfma_f32_16x16x32_bf16 v[28:31], v[148:151], v[68:71], v[28:31]
    v_mul_f32 v14, v14, v206
    ds_read_b128 v[64:67], v223 offset:33856
    s_waitcnt lgkmcnt(9)
    v_mfma_f32_16x16x32_bf16 v[20:23], v[152:155], v[72:75], v[20:23]
    v_mul_f32 v15, v15, v207
    ds_read_b128 v[68:71], v223 offset:34112
    v_mfma_f32_16x16x32_bf16 v[24:27], v[152:155], v[76:79], v[24:27]
    v_cvt_pk_bf16_f32 v182, v12, v13
    ds_read_b128 v[72:75], v223 offset:34304
    s_waitcnt lgkmcnt(9)
    v_mfma_f32_16x16x32_bf16 v[28:31], v[152:155], v[80:83], v[28:31]
    v_cvt_pk_bf16_f32 v183, v14, v15
    ds_read_b128 v[76:79], v223 offset:34560
    v_mfma_f32_16x16x32_bf16 v[20:23], v[156:159], v[84:87], v[20:23]
    ds_write_b64 v254, v[176:177] offset:0
    ds_write_b64 v254, v[178:179] offset:256
    ds_write_b64 v254, v[180:181] offset:512
    ds_write_b64 v254, v[182:183] offset:768
    ds_write_b64 v255, v[220:221] offset:0
    ds_read_b128 v[80:83], v223 offset:34432
    s_waitcnt lgkmcnt(14)
    v_mfma_f32_16x16x32_bf16 v[24:27], v[156:159], v[88:91], v[24:27]
    ds_read_b128 v[84:87], v223 offset:34368
    v_mfma_f32_16x16x32_bf16 v[28:31], v[156:159], v[92:95], v[28:31]
    s_setprio 1
    ds_read_b128 v[88:91], v223 offset:34624
    s_waitcnt lgkmcnt(14)
    v_mfma_f32_16x16x32_bf16 v[20:23], v[160:163], v[48:51], v[20:23]
    ds_read_b128 v[92:95], v223 offset:34496
    v_mfma_f32_16x16x32_bf16 v[24:27], v[160:163], v[52:55], v[24:27]
    ds_read_b128 v[48:51], v247 offset:6272
    s_waitcnt lgkmcnt(14)
    v_mfma_f32_16x16x32_bf16 v[28:31], v[160:163], v[56:59], v[28:31]
    ds_read_b128 v[52:55], v232 offset:6528
    v_mfma_f32_16x16x32_bf16 v[20:23], v[164:167], v[60:63], v[20:23]
    ds_read_b128 v[56:59], v247 offset:6336
    s_waitcnt lgkmcnt(14)
    v_mfma_f32_16x16x32_bf16 v[24:27], v[164:167], v[64:67], v[24:27]
    ds_read_b128 v[60:63], v232 offset:6592
    v_mfma_f32_16x16x32_bf16 v[28:31], v[164:167], v[68:71], v[28:31]
    ds_read_b128 v[64:67], v247 offset:6784
    s_waitcnt lgkmcnt(14)
    v_mfma_f32_16x16x32_bf16 v[20:23], v[168:171], v[72:75], v[20:23]
    ds_read_b128 v[68:71], v232 offset:6656
    v_mfma_f32_16x16x32_bf16 v[24:27], v[168:171], v[76:79], v[24:27]
    ds_read_b128 v[72:75], v247 offset:6848
    s_waitcnt lgkmcnt(9)
    v_mfma_f32_16x16x32_bf16 v[28:31], v[168:171], v[80:83], v[28:31]
    ds_read_b128 v[76:79], v232 offset:6720
    v_mfma_f32_16x16x32_bf16 v[20:23], v[172:175], v[84:87], v[20:23]
    s_setprio 0
    ds_read_b128 v[80:83], v247 offset:7168
    s_waitcnt lgkmcnt(9)
    v_mfma_f32_16x16x32_bf16 v[24:27], v[172:175], v[88:91], v[24:27]
    ds_read_b128 v[84:87], v232 offset:7424
    v_mfma_f32_16x16x32_bf16 v[28:31], v[172:175], v[92:95], v[28:31]
    ds_read_b128 v[88:91], v247 offset:7232
    s_waitcnt lgkmcnt(9)
    v_mfma_f32_16x16x32_bf16 v[36:39], v[112:115], v[48:51], 0
    ds_read_b128 v[92:95], v232 offset:7488
    v_mfma_f32_16x16x32_bf16 v[40:43], v[112:115], v[52:55], 0
    ds_read_b128 v[48:51], v248 offset:128
    s_waitcnt lgkmcnt(9)
    v_mfma_f32_16x16x32_bf16 v[36:39], v[116:119], v[56:59], v[36:39]
    s_barrier
    ds_read_b128 v[192:195], v228 offset:0
    ds_read_b128 v[196:199], v228 offset:1536
    s_setprio 3
    ds_read_b128 v[52:55], v225 offset:384
    v_mfma_f32_16x16x32_bf16 v[40:43], v[116:119], v[60:63], v[40:43]
    v_mul_f32 v20, v20, v208
    v_mul_f32 v21, v21, v209
    ds_read_b128 v[56:59], v248 offset:192
    s_waitcnt lgkmcnt(11)
    v_mfma_f32_16x16x32_bf16 v[36:39], v[120:123], v[64:67], v[36:39]
    v_mul_f32 v22, v22, v210
    ds_read_b128 v[60:63], v225 offset:448
    v_mfma_f32_16x16x32_bf16 v[40:43], v[120:123], v[68:71], v[40:43]
    v_mul_f32 v23, v23, v211
    ds_read_b128 v[64:67], v248 offset:640
    s_waitcnt lgkmcnt(11)
    v_mfma_f32_16x16x32_bf16 v[36:39], v[124:127], v[72:75], v[36:39]
    v_cvt_pk_bf16_f32 v186, v20, v21
    ds_read_b128 v[68:71], v225 offset:512
    v_mfma_f32_16x16x32_bf16 v[40:43], v[124:127], v[76:79], v[40:43]
    v_cvt_pk_bf16_f32 v187, v22, v23
    ds_read_b128 v[72:75], v248 offset:704
    s_waitcnt lgkmcnt(11)
    v_mfma_f32_16x16x32_bf16 v[36:39], v[144:147], v[80:83], v[36:39]
    v_mul_f32 v24, v24, v208
    v_mul_f32 v25, v25, v209
    s_waitcnt lgkmcnt(6)
    buffer_store_dwordx4 v[192:195], v229, s[12:15], s40 offen sc1
    buffer_store_dwordx4 v[196:199], v229, s[12:15], s41 offen sc1
    s_setprio 2
    ds_read_b128 v[76:79], v225 offset:576
    v_mfma_f32_16x16x32_bf16 v[40:43], v[144:147], v[84:87], v[40:43]
    v_mul_f32 v26, v26, v210
    ds_read_b128 v[80:83], v248 offset:1024
    v_mfma_f32_16x16x32_bf16 v[36:39], v[148:151], v[88:91], v[36:39]
    v_mul_f32 v27, v27, v211
    ds_read_b128 v[84:87], v225 offset:1280
    v_mfma_f32_16x16x32_bf16 v[40:43], v[148:151], v[92:95], v[40:43]
    v_cvt_pk_bf16_f32 v188, v24, v25
    ds_read_b128 v[88:91], v248 offset:1088
    s_waitcnt lgkmcnt(9)
    v_mfma_f32_16x16x32_bf16 v[36:39], v[152:155], v[48:51], v[36:39]
    v_cvt_pk_bf16_f32 v189, v26, v27
    ds_read_b128 v[92:95], v225 offset:1344
    v_mfma_f32_16x16x32_bf16 v[40:43], v[152:155], v[52:55], v[40:43]
    v_mul_f32 v28, v28, v208
    v_mul_f32 v29, v29, v209
    s_waitcnt lgkmcnt(8)
    v_mfma_f32_16x16x32_bf16 v[36:39], v[156:159], v[56:59], v[36:39]
    v_mul_f32 v30, v30, v210
    v_mfma_f32_16x16x32_bf16 v[40:43], v[156:159], v[60:63], v[40:43]
    v_mul_f32 v31, v31, v211
    s_setprio 1
    s_waitcnt lgkmcnt(6)
    v_mfma_f32_16x16x32_bf16 v[36:39], v[160:163], v[64:67], v[36:39]
    v_cvt_pk_bf16_f32 v190, v28, v29
    v_mfma_f32_16x16x32_bf16 v[40:43], v[160:163], v[68:71], v[40:43]
    v_cvt_pk_bf16_f32 v191, v30, v31
    s_waitcnt lgkmcnt(4)
    v_mfma_f32_16x16x32_bf16 v[36:39], v[164:167], v[72:75], v[36:39]
    ds_write_b64 v254, v[184:185] offset:3072
    ds_write_b64 v254, v[186:187] offset:3328
    ds_write_b64 v254, v[188:189] offset:3584
    ds_write_b64 v254, v[190:191] offset:3840
    v_mfma_f32_16x16x32_bf16 v[40:43], v[164:167], v[76:79], v[40:43]
    s_waitcnt lgkmcnt(6)
    v_mfma_f32_16x16x32_bf16 v[36:39], v[168:171], v[80:83], v[36:39]
    v_mfma_f32_16x16x32_bf16 v[40:43], v[168:171], v[84:87], v[40:43]
    s_setprio 0
    s_waitcnt lgkmcnt(4)
    v_mfma_f32_16x16x32_bf16 v[36:39], v[172:175], v[88:91], v[36:39]
    v_mfma_f32_16x16x32_bf16 v[40:43], v[172:175], v[92:95], v[40:43]
    s_nop 6
    v_mul_f32 v36, v36, v212
    v_mul_f32 v37, v37, v213
    v_mul_f32 v38, v38, v214
    v_mul_f32 v39, v39, v215
    v_cvt_pk_bf16_f32 v178, v36, v37
    v_cvt_pk_bf16_f32 v179, v38, v39
    v_mul_f32 v40, v40, v212
    v_mul_f32 v41, v41, v213
    v_mul_f32 v42, v42, v214
    v_mul_f32 v43, v43, v215
    v_cvt_pk_bf16_f32 v180, v40, v41
    v_cvt_pk_bf16_f32 v181, v42, v43
    ds_write_b64 v246, v[178:179] offset:256
    ds_write_b64 v255, v[180:181] offset:512
    s_waitcnt lgkmcnt(0)
    s_barrier
    ds_read_b128 v[192:195], v228 offset:3072
    ds_read_b128 v[196:199], v228 offset:4608
    ds_read_b128 v[200:203], v249
    s_waitcnt lgkmcnt(1)
    buffer_store_dwordx4 v[192:195], v229, s[12:15], s42 offen sc1
    buffer_store_dwordx4 v[196:199], v229, s[12:15], s43 offen sc1
K2_LASTROW:
    s_add_u32 s59, s20, 32
    s_cmp_ge_u32 s59, s22
    s_cbranch_scc1 K2_FIN
    s_waitcnt lgkmcnt(0)
    buffer_store_dwordx4 v[200:203], v229, s[12:15], s44 offen sc1
K2_FIN:
    s_endpgm
K2_MULTI:
    ds_read_b128 v[48:51], v222 offset:0
    ds_read_b128 v[52:55], v222 offset:64
    ds_read_b128 v[56:59], v222 offset:896
    ds_read_b128 v[60:63], v222 offset:960
    ds_read_b128 v[64:67], v223 offset:0
    ds_read_b128 v[68:71], v223 offset:64
    ds_read_b128 v[72:75], v223 offset:896
    ds_read_b128 v[76:79], v223 offset:960
    ds_read_b128 v[80:83], v222 offset:3072
    ds_read_b128 v[84:87], v222 offset:3136
    ds_read_b128 v[88:91], v222 offset:3968
    s_waitcnt vmcnt(19) lgkmcnt(9)
    v_mfma_f32_16x16x32_bf16 v[0:3], v[96:99], v[48:51], 0
    ds_read_b128 v[92:95], v222 offset:4032
    s_waitcnt vmcnt(18)
    v_mfma_f32_16x16x32_bf16 v[0:3], v[100:103], v[52:55], v[0:3]
    ds_read_b128 v[48:51], v223 offset:33280
    s_waitcnt vmcnt(17) lgkmcnt(9)
    v_mfma_f32_16x16x32_bf16 v[0:3], v[104:107], v[56:59], v[0:3]
    ds_read_b128 v[52:55], v223 offset:33344
    s_waitcnt vmcnt(16)
    v_mfma_f32_16x16x32_bf16 v[0:3], v[108:111], v[60:63], v[0:3]
    ds_read_b128 v[56:59], v223 offset:34176
    s_waitcnt vmcnt(15) lgkmcnt(9)
    v_mfma_f32_16x16x32_bf16 v[0:3], v[128:131], v[64:67], v[0:3]
    ds_read_b128 v[60:63], v223 offset:34240
    s_waitcnt vmcnt(14)
    v_mfma_f32_16x16x32_bf16 v[0:3], v[132:135], v[68:71], v[0:3]
    ds_read_b128 v[64:67], v232 offset:6144
    s_waitcnt vmcnt(13) lgkmcnt(9)
    v_mfma_f32_16x16x32_bf16 v[0:3], v[136:139], v[72:75], v[0:3]
    ds_read_b128 v[68:71], v232 offset:6208
    s_waitcnt vmcnt(12)
    v_mfma_f32_16x16x32_bf16 v[0:3], v[140:143], v[76:79], v[0:3]
    ds_read_b128 v[72:75], v232 offset:7040
    s_waitcnt lgkmcnt(9)
    v_mfma_f32_16x16x32_bf16 v[16:19], v[96:99], v[80:83], 0
    ds_read_b128 v[76:79], v232 offset:7104
    v_mfma_f32_16x16x32_bf16 v[16:19], v[100:103], v[84:87], v[16:19]
    ds_read_b128 v[80:83], v225 offset:0
    s_waitcnt lgkmcnt(9)
    v_mfma_f32_16x16x32_bf16 v[16:19], v[104:107], v[88:91], v[16:19]
    ds_read_b128 v[84:87], v225 offset:64
    v_mfma_f32_16x16x32_bf16 v[16:19], v[108:111], v[92:95], v[16:19]
    ds_read_b128 v[88:91], v225 offset:896
    s_waitcnt lgkmcnt(9)
    v_mfma_f32_16x16x32_bf16 v[16:19], v[128:131], v[48:51], v[16:19]
    ds_read_b128 v[92:95], v225 offset:960
    v_mfma_f32_16x16x32_bf16 v[16:19], v[132:135], v[52:55], v[16:19]
    ds_read_b128 v[48:51], v222 offset:128
    s_waitcnt lgkmcnt(9)
    v_mfma_f32_16x16x32_bf16 v[16:19], v[136:139], v[56:59], v[16:19]
    ds_read_b128 v[52:55], v222 offset:384
    v_mfma_f32_16x16x32_bf16 v[16:19], v[140:143], v[60:63], v[16:19]
    ds_read_b128 v[56:59], v222 offset:256
    s_waitcnt lgkmcnt(9)
    v_mfma_f32_16x16x32_bf16 v[32:35], v[96:99], v[64:67], 0
    ds_read_b128 v[60:63], v222 offset:192
    v_mfma_f32_16x16x32_bf16 v[32:35], v[100:103], v[68:71], v[32:35]
    ds_read_b128 v[64:67], v222 offset:448
    s_waitcnt lgkmcnt(9)
    v_mfma_f32_16x16x32_bf16 v[32:35], v[104:107], v[72:75], v[32:35]
    ds_read_b128 v[68:71], v222 offset:320
    v_mfma_f32_16x16x32_bf16 v[32:35], v[108:111], v[76:79], v[32:35]
    ds_read_b128 v[72:75], v222 offset:640
    s_waitcnt lgkmcnt(9)
    v_mfma_f32_16x16x32_bf16 v[32:35], v[128:131], v[80:83], v[32:35]
    ds_read_b128 v[76:79], v222 offset:512
    v_mfma_f32_16x16x32_bf16 v[32:35], v[132:135], v[84:87], v[32:35]
    ds_read_b128 v[80:83], v222 offset:768
    s_waitcnt lgkmcnt(9)
    v_mfma_f32_16x16x32_bf16 v[32:35], v[136:139], v[88:91], v[32:35]
    ds_read_b128 v[84:87], v222 offset:704
    v_mfma_f32_16x16x32_bf16 v[32:35], v[140:143], v[92:95], v[32:35]
    ds_read_b128 v[88:91], v222 offset:576
    s_waitcnt vmcnt(11) lgkmcnt(9)
    v_mfma_f32_16x16x32_bf16 v[4:7], v[112:115], v[48:51], 0
    ds_read_b128 v[92:95], v222 offset:832
    v_mfma_f32_16x16x32_bf16 v[8:11], v[112:115], v[52:55], 0
    ds_read_b128 v[48:51], v222 offset:1024
    s_waitcnt lgkmcnt(9)
    v_mfma_f32_16x16x32_bf16 v[12:15], v[112:115], v[56:59], 0
    ds_read_b128 v[52:55], v222 offset:1280
    s_waitcnt vmcnt(10)
    v_mfma_f32_16x16x32_bf16 v[4:7], v[116:119], v[60:63], v[4:7]
    ds_read_b128 v[56:59], v222 offset:1152
    s_waitcnt lgkmcnt(9)
    v_mfma_f32_16x16x32_bf16 v[8:11], v[116:119], v[64:67], v[8:11]
    ds_read_b128 v[60:63], v222 offset:1088
    v_mfma_f32_16x16x32_bf16 v[12:15], v[116:119], v[68:71], v[12:15]
    ds_read_b128 v[64:67], v222 offset:1344
    s_waitcnt vmcnt(9) lgkmcnt(9)
    v_mfma_f32_16x16x32_bf16 v[4:7], v[120:123], v[72:75], v[4:7]
    ds_read_b128 v[68:71], v222 offset:1216
    v_mfma_f32_16x16x32_bf16 v[8:11], v[120:123], v[76:79], v[8:11]
    ds_read_b128 v[72:75], v223 offset:128
    s_waitcnt lgkmcnt(9)
    v_mfma_f32_16x16x32_bf16 v[12:15], v[120:123], v[80:83], v[12:15]
    ds_read_b128 v[76:79], v223 offset:384
    s_waitcnt vmcnt(8)
    v_mfma_f32_16x16x32_bf16 v[4:7], v[124:127], v[84:87], v[4:7]
    ds_read_b128 v[80:83], v223 offset:256
    s_waitcnt lgkmcnt(9)
    v_mfma_f32_16x16x32_bf16 v[8:11], v[124:127], v[88:91], v[8:11]
    ds_read_b128 v[84:87], v223 offset:192
    v_mfma_f32_16x16x32_bf16 v[12:15], v[124:127], v[92:95], v[12:15]
    ds_read_b128 v[88:91], v223 offset:448
    s_waitcnt vmcnt(7) lgkmcnt(9)
    v_mfma_f32_16x16x32_bf16 v[4:7], v[144:147], v[48:51], v[4:7]
    ds_read_b128 v[92:95], v223 offset:320
    v_mfma_f32_16x16x32_bf16 v[8:11], v[144:147], v[52:55], v[8:11]
    ds_read_b128 v[48:51], v223 offset:640
    s_waitcnt lgkmcnt(9)
    v_mfma_f32_16x16x32_bf16 v[12:15], v[144:147], v[56:59], v[12:15]
    ds_read_b128 v[52:55], v223 offset:512
    s_waitcnt vmcnt(6)
    v_mfma_f32_16x16x32_bf16 v[4:7], v[148:151], v[60:63], v[4:7]
    ds_read_b128 v[56:59], v223 offset:768
    s_waitcnt lgkmcnt(9)
    v_mfma_f32_16x16x32_bf16 v[8:11], v[148:151], v[64:67], v[8:11]
    ds_read_b128 v[60:63], v223 offset:704
    v_mfma_f32_16x16x32_bf16 v[12:15], v[148:151], v[68:71], v[12:15]
    ds_read_b128 v[64:67], v223 offset:576
    s_waitcnt vmcnt(5) lgkmcnt(9)
    v_mfma_f32_16x16x32_bf16 v[4:7], v[152:155], v[72:75], v[4:7]
    ds_read_b128 v[68:71], v223 offset:832
    v_mfma_f32_16x16x32_bf16 v[8:11], v[152:155], v[76:79], v[8:11]
    ds_read_b128 v[72:75], v223 offset:1024
    s_waitcnt lgkmcnt(9)
    v_mfma_f32_16x16x32_bf16 v[12:15], v[152:155], v[80:83], v[12:15]
    ds_read_b128 v[76:79], v223 offset:1280
    s_waitcnt vmcnt(4)
    v_mfma_f32_16x16x32_bf16 v[4:7], v[156:159], v[84:87], v[4:7]
    ds_read_b128 v[80:83], v223 offset:1152
    s_waitcnt lgkmcnt(9)
    v_mfma_f32_16x16x32_bf16 v[8:11], v[156:159], v[88:91], v[8:11]
    ds_read_b128 v[84:87], v223 offset:1088
    v_mfma_f32_16x16x32_bf16 v[12:15], v[156:159], v[92:95], v[12:15]
    ds_read_b128 v[88:91], v223 offset:1344
    s_waitcnt vmcnt(3) lgkmcnt(9)
    v_mfma_f32_16x16x32_bf16 v[4:7], v[160:163], v[48:51], v[4:7]
    ds_read_b128 v[92:95], v223 offset:1216
    v_mfma_f32_16x16x32_bf16 v[8:11], v[160:163], v[52:55], v[8:11]
    ds_read_b128 v[48:51], v222 offset:3200
    s_waitcnt lgkmcnt(9)
    v_mfma_f32_16x16x32_bf16 v[12:15], v[160:163], v[56:59], v[12:15]
    ds_read_b128 v[52:55], v222 offset:3456
    s_waitcnt vmcnt(2)
    v_mfma_f32_16x16x32_bf16 v[4:7], v[164:167], v[60:63], v[4:7]
    ds_read_b128 v[56:59], v222 offset:3328
    s_waitcnt lgkmcnt(9)
    v_mfma_f32_16x16x32_bf16 v[8:11], v[164:167], v[64:67], v[8:11]
    ds_read_b128 v[60:63], v222 offset:3264
    v_mfma_f32_16x16x32_bf16 v[12:15], v[164:167], v[68:71], v[12:15]
    ds_read_b128 v[64:67], v222 offset:3520
    s_waitcnt vmcnt(1) lgkmcnt(9)
    v_mfma_f32_16x16x32_bf16 v[4:7], v[168:171], v[72:75], v[4:7]
    ds_read_b128 v[68:71], v222 offset:3392
    v_mfma_f32_16x16x32_bf16 v[8:11], v[168:171], v[76:79], v[8:11]
    ds_read_b128 v[72:75], v222 offset:3712
    s_waitcnt lgkmcnt(9)
    v_mfma_f32_16x16x32_bf16 v[12:15], v[168:171], v[80:83], v[12:15]
    ds_read_b128 v[76:79], v222 offset:3584
    s_waitcnt vmcnt(0)
    v_mfma_f32_16x16x32_bf16 v[4:7], v[172:175], v[84:87], v[4:7]
    ds_read_b128 v[80:83], v222 offset:3840
    s_waitcnt lgkmcnt(9)
    v_mfma_f32_16x16x32_bf16 v[8:11], v[172:175], v[88:91], v[8:11]
    ds_read_b128 v[84:87], v222 offset:3776
    v_mfma_f32_16x16x32_bf16 v[12:15], v[172:175], v[92:95], v[12:15]
    ds_read_b128 v[88:91], v222 offset:3648
    s_waitcnt lgkmcnt(9)
    v_mfma_f32_16x16x32_bf16 v[20:23], v[112:115], v[48:51], 0
    ds_read_b128 v[92:95], v222 offset:3904
    v_mfma_f32_16x16x32_bf16 v[24:27], v[112:115], v[52:55], 0
    ds_read_b128 v[48:51], v222 offset:4096
    s_waitcnt lgkmcnt(9)
    v_mfma_f32_16x16x32_bf16 v[28:31], v[112:115], v[56:59], 0
    ds_read_b128 v[52:55], v222 offset:4352
    v_mfma_f32_16x16x32_bf16 v[20:23], v[116:119], v[60:63], v[20:23]
    ds_read_b128 v[56:59], v222 offset:4224
    s_waitcnt lgkmcnt(9)
    v_mfma_f32_16x16x32_bf16 v[24:27], v[116:119], v[64:67], v[24:27]
    ds_read_b128 v[60:63], v222 offset:4160
    v_mfma_f32_16x16x32_bf16 v[28:31], v[116:119], v[68:71], v[28:31]
    ds_read_b128 v[64:67], v222 offset:4416
    s_waitcnt lgkmcnt(9)
    v_mfma_f32_16x16x32_bf16 v[20:23], v[120:123], v[72:75], v[20:23]
    ds_read_b128 v[68:71], v222 offset:4288
    v_mfma_f32_16x16x32_bf16 v[24:27], v[120:123], v[76:79], v[24:27]
    ds_read_b128 v[72:75], v223 offset:33408
    s_waitcnt lgkmcnt(9)
    v_mfma_f32_16x16x32_bf16 v[28:31], v[120:123], v[80:83], v[28:31]
    ds_read_b128 v[76:79], v223 offset:33664
    v_mfma_f32_16x16x32_bf16 v[20:23], v[124:127], v[84:87], v[20:23]
    ds_read_b128 v[80:83], v223 offset:33536
    s_waitcnt lgkmcnt(9)
    v_mfma_f32_16x16x32_bf16 v[24:27], v[124:127], v[88:91], v[24:27]
    ds_read_b128 v[84:87], v223 offset:33472
    v_mfma_f32_16x16x32_bf16 v[28:31], v[124:127], v[92:95], v[28:31]
    ds_read_b128 v[88:91], v223 offset:33728
    s_waitcnt lgkmcnt(9)
    v_mfma_f32_16x16x32_bf16 v[20:23], v[144:147], v[48:51], v[20:23]
    ds_read_b128 v[92:95], v223 offset:33600
    v_mfma_f32_16x16x32_bf16 v[24:27], v[144:147], v[52:55], v[24:27]
    ds_read_b128 v[48:51], v223 offset:33920
    s_waitcnt lgkmcnt(9)
    v_mfma_f32_16x16x32_bf16 v[28:31], v[144:147], v[56:59], v[28:31]
    ds_read_b128 v[52:55], v223 offset:33792
    v_mfma_f32_16x16x32_bf16 v[20:23], v[148:151], v[60:63], v[20:23]
    ds_read_b128 v[56:59], v223 offset:34048
    s_waitcnt lgkmcnt(9)
    v_mfma_f32_16x16x32_bf16 v[24:27], v[148:151], v[64:67], v[24:27]
    ds_read_b128 v[60:63], v223 offset:33984
    v_mfma_f32_16x16x32_bf16 v[28:31], v[148:151], v[68:71], v[28:31]
    ds_read_b128 v[64:67], v223 offset:33856
    s_waitcnt lgkmcnt(9)
    v_mfma_f32_16x16x32_bf16 v[20:23], v[152:155], v[72:75], v[20:23]
    ds_read_b128 v[68:71], v223 offset:34112
    v_mfma_f32_16x16x32_bf16 v[24:27], v[152:155], v[76:79], v[24:27]
    ds_read_b128 v[72:75], v223 offset:34304
    s_waitcnt lgkmcnt(9)
    v_mfma_f32_16x16x32_bf16 v[28:31], v[152:155], v[80:83], v[28:31]
    ds_read_b128 v[76:79], v223 offset:34560
    v_mfma_f32_16x16x32_bf16 v[20:23], v[156:159], v[84:87], v[20:23]
    ds_read_b128 v[80:83], v223 offset:34432
    s_waitcnt lgkmcnt(9)
    v_mfma_f32_16x16x32_bf16 v[24:27], v[156:159], v[88:91], v[24:27]
    ds_read_b128 v[84:87], v223 offset:34368
    v_mfma_f32_16x16x32_bf16 v[28:31], v[156:159], v[92:95], v[28:31]
    ds_read_b128 v[88:91], v223 offset:34624
    s_waitcnt lgkmcnt(9)
    v_mfma_f32_16x16x32_bf16 v[20:23], v[160:163], v[48:51], v[20:23]
    ds_read_b128 v[92:95], v223 offset:34496
    v_mfma_f32_16x16x32_bf16 v[24:27], v[160:163], v[52:55], v[24:27]
    ds_read_b128 v[48:51], v247 offset:6272
    s_waitcnt lgkmcnt(9)
    v_mfma_f32_16x16x32_bf16 v[28:31], v[160:163], v[56:59], v[28:31]
    ds_read_b128 v[52:55], v232 offset:6528
    v_mfma_f32_16x16x32_bf16 v[20:23], v[164:167], v[60:63], v[20:23]
    ds_read_b128 v[56:59], v247 offset:6336
    s_waitcnt lgkmcnt(9)
    v_mfma_f32_16x16x32_bf16 v[24:27], v[164:167], v[64:67], v[24:27]
    ds_read_b128 v[60:63], v232 offset:6592
    v_mfma_f32_16x16x32_bf16 v[28:31], v[164:167], v[68:71], v[28:31]
    ds_read_b128 v[64:67], v247 offset:6784
    s_waitcnt lgkmcnt(9)
    v_mfma_f32_16x16x32_bf16 v[20:23], v[168:171], v[72:75], v[20:23]
    ds_read_b128 v[68:71], v232 offset:6656
    v_mfma_f32_16x16x32_bf16 v[24:27], v[168:171], v[76:79], v[24:27]
    ds_read_b128 v[72:75], v247 offset:6848
    s_waitcnt lgkmcnt(9)
    v_mfma_f32_16x16x32_bf16 v[28:31], v[168:171], v[80:83], v[28:31]
    ds_read_b128 v[76:79], v232 offset:6720
    v_mfma_f32_16x16x32_bf16 v[20:23], v[172:175], v[84:87], v[20:23]
    ds_read_b128 v[80:83], v247 offset:7168
    s_waitcnt lgkmcnt(9)
    v_mfma_f32_16x16x32_bf16 v[24:27], v[172:175], v[88:91], v[24:27]
    ds_read_b128 v[84:87], v232 offset:7424
    v_mfma_f32_16x16x32_bf16 v[28:31], v[172:175], v[92:95], v[28:31]
    ds_read_b128 v[88:91], v247 offset:7232
    s_waitcnt lgkmcnt(9)
    v_mfma_f32_16x16x32_bf16 v[36:39], v[112:115], v[48:51], 0
    ds_read_b128 v[92:95], v232 offset:7488
    v_mfma_f32_16x16x32_bf16 v[40:43], v[112:115], v[52:55], 0
    ds_read_b128 v[48:51], v248 offset:128
    s_waitcnt lgkmcnt(9)
    v_mfma_f32_16x16x32_bf16 v[36:39], v[116:119], v[56:59], v[36:39]
    ds_read_b128 v[52:55], v225 offset:384
    v_mfma_f32_16x16x32_bf16 v[40:43], v[116:119], v[60:63], v[40:43]
    ds_read_b128 v[56:59], v248 offset:192
    s_waitcnt lgkmcnt(9)
    v_mfma_f32_16x16x32_bf16 v[36:39], v[120:123], v[64:67], v[36:39]
    ds_read_b128 v[60:63], v225 offset:448
    v_mfma_f32_16x16x32_bf16 v[40:43], v[120:123], v[68:71], v[40:43]
    ds_read_b128 v[64:67], v248 offset:640
    s_waitcnt lgkmcnt(9)
    v_mfma_f32_16x16x32_bf16 v[36:39], v[124:127], v[72:75], v[36:39]
    ds_read_b128 v[68:71], v225 offset:512
    v_mfma_f32_16x16x32_bf16 v[40:43], v[124:127], v[76:79], v[40:43]
    ds_read_b128 v[72:75], v248 offset:704
    s_waitcnt lgkmcnt(9)
    v_mfma_f32_16x16x32_bf16 v[36:39], v[144:147], v[80:83], v[36:39]
    ds_read_b128 v[76:79], v225 offset:576
    v_mfma_f32_16x16x32_bf16 v[40:43], v[144:147], v[84:87], v[40:43]
    ds_read_b128 v[80:83], v248 offset:1024
    s_waitcnt lgkmcnt(9)
    v_mfma_f32_16x16x32_bf16 v[36:39], v[148:151], v[88:91], v[36:39]
    ds_read_b128 v[84:87], v225 offset:1280
    v_mfma_f32_16x16x32_bf16 v[40:43], v[148:151], v[92:95], v[40:43]
    ds_read_b128 v[88:91], v248 offset:1088
    s_waitcnt lgkmcnt(9)
    v_mfma_f32_16x16x32_bf16 v[36:39], v[152:155], v[48:51], v[36:39]
    ds_read_b128 v[92:95], v225 offset:1344
    v_mfma_f32_16x16x32_bf16 v[40:43], v[152:155], v[52:55], v[40:43]
    s_waitcnt lgkmcnt(8)
    v_mfma_f32_16x16x32_bf16 v[36:39], v[156:159], v[56:59], v[36:39]
    v_mfma_f32_16x16x32_bf16 v[40:43], v[156:159], v[60:63], v[40:43]
    s_waitcnt lgkmcnt(6)
    v_mfma_f32_16x16x32_bf16 v[36:39], v[160:163], v[64:67], v[36:39]
    v_mfma_f32_16x16x32_bf16 v[40:43], v[160:163], v[68:71], v[40:43]
    s_waitcnt lgkmcnt(4)
    v_mfma_f32_16x16x32_bf16 v[36:39], v[164:167], v[72:75], v[36:39]
    v_mfma_f32_16x16x32_bf16 v[40:43], v[164:167], v[76:79], v[40:43]
    s_waitcnt lgkmcnt(2)
    v_mfma_f32_16x16x32_bf16 v[36:39], v[168:171], v[80:83], v[36:39]
    v_mfma_f32_16x16x32_bf16 v[40:43], v[168:171], v[84:87], v[40:43]
    s_waitcnt lgkmcnt(0)
    v_mfma_f32_16x16x32_bf16 v[36:39], v[172:175], v[88:91], v[36:39]
    v_mfma_f32_16x16x32_bf16 v[40:43], v[172:175], v[92:95], v[40:43]
    s_lshl_b32 s60, s54, 9
    s_lshl_b32 s61, s20, 6
    s_add_u32 s60, s60, s61
    s_mul_i32 s60, s60, 192
    s_add_u32 s60, s60, 10485760
    v_mul_u32_u24 v227, 96, v252
    s_cmp_lg_u32 s28, 0
    s_cbranch_scc1 K2_NOACC
    buffer_load_dwordx4 v[48:51], v227, s[8:11], s60 offen offset:0
    buffer_load_dwordx4 v[52:55], v227, s[8:11], s60 offen offset:16
    buffer_load_dwordx4 v[56:59], v227, s[8:11], s60 offen offset:32
    buffer_load_dwordx4 v[60:63], v227, s[8:11], s60 offen offset:48
    buffer_load_dwordx4 v[64:67], v227, s[8:11], s60 offen offset:64
    buffer_load_dwordx4 v[68:71], v227, s[8:11], s60 offen offset:80
    buffer_load_dwordx4 v[72:75], v227, s[8:11], s60 offen offset:96
    buffer_load_dwordx4 v[76:79], v227, s[8:11], s60 offen offset:112
    buffer_load_dwordx4 v[80:83], v227, s[8:11], s60 offen offset:128
    buffer_load_dwordx4 v[84:87], v227, s[8:11], s60 offen offset:144
    buffer_load_dwordx4 v[88:91], v227, s[8:11], s60 offen offset:160
    s_waitcnt vmcnt(0)
    v_add_f32 v0, v0, v48
    v_add_f32 v1, v1, v49
    v_add_f32 v2, v2, v50
    v_add_f32 v3, v3, v51
    v_add_f32 v4, v4, v52
    v_add_f32 v5, v5, v53
    v_add_f32 v6, v6, v54
    v_add_f32 v7, v7, v55
    v_add_f32 v8, v8, v56
    v_add_f32 v9, v9, v57
    v_add_f32 v10, v10, v58
    v_add_f32 v11, v11, v59
    v_add_f32 v12, v12, v60
    v_add_f32 v13, v13, v61
    v_add_f32 v14, v14, v62
    v_add_f32 v15, v15, v63
    v_add_f32 v16, v16, v64
    v_add_f32 v17, v17, v65
    v_add_f32 v18, v18, v66
    v_add_f32 v19, v19, v67
    v_add_f32 v20, v20, v68
    v_add_f32 v21, v21, v69
    v_add_f32 v22, v22, v70
    v_add_f32 v23, v23, v71
    v_add_f32 v24, v24, v72
    v_add_f32 v25, v25, v73
    v_add_f32 v26, v26, v74
    v_add_f32 v27, v27, v75
    v_add_f32 v28, v28, v76
    v_add_f32 v29, v29, v77
    v_add_f32 v30, v30, v78
    v_add_f32 v31, v31, v79
    v_add_f32 v32, v32, v80
    v_add_f32 v33, v33, v81
    v_add_f32 v34, v34, v82
    v_add_f32 v35, v35, v83
    v_add_f32 v36, v36, v84
    v_add_f32 v37, v37, v85
    v_add_f32 v38, v38, v86
    v_add_f32 v39, v39, v87
    v_add_f32 v40, v40, v88
    v_add_f32 v41, v41, v89
    v_add_f32 v42, v42, v90
    v_add_f32 v43, v43, v91
K2_NOACC:
    s_barrier
    s_cmp_eq_u32 s55, 0
    s_cbranch_scc1 K2_SPILL
    s_bfe_u32 s60, s20, 0x10002
    s_lshl_b32 s60, s60, 4
    s_add_u32 s59, s59, s60
    v_add_u32 v228, s59, v229
    s_mul_i32 s60, s20, 2080
    s_add_u32 s60, s60, 65536
    v_add_u32 v249, s60, v229
    s_mov_b32 s63, 0xbfb8aa3b
    s_add_u32 s40, s20, s21
    s_lshl_b32 s40, s40, 10
    s_add_u32 s41, s40, 8192
    s_add_u32 s42, s40, 16384
    s_add_u32 s43, s40, 24576
    s_add_u32 s44, s40, 32768
    v_mul_f32 v204, s63, v0
    v_mul_f32 v205, s63, v1
    v_mul_f32 v206, s63, v2
    v_mul_f32 v207, s63, v3
    v_exp_f32 v204, v204
    v_exp_f32 v205, v205
    v_exp_f32 v206, v206
    v_exp_f32 v207, v207
    v_add_f32 v204, 1.0, v204
    v_add_f32 v205, 1.0, v205
    v_add_f32 v206, 1.0, v206
    v_add_f32 v207, 1.0, v207
    v_rcp_f32 v204, v204
    v_rcp_f32 v205, v205
    v_rcp_f32 v206, v206
    v_rcp_f32 v207, v207
    v_cvt_pk_bf16_f32 v176, v0, v1
    v_cvt_pk_bf16_f32 v177, v2, v3
    v_mul_f32 v4, v4, v204
    v_mul_f32 v5, v5, v205
    v_mul_f32 v6, v6, v206
    v_mul_f32 v7, v7, v207
    v_cvt_pk_bf16_f32 v178, v4, v5
    v_cvt_pk_bf16_f32 v179, v6, v7
    v_mul_f32 v8, v8, v204
    v_mul_f32 v9, v9, v205
    v_mul_f32 v10, v10, v206
    v_mul_f32 v11, v11, v207
    v_cvt_pk_bf16_f32 v180, v8, v9
    v_cvt_pk_bf16_f32 v181, v10, v11
    v_mul_f32 v12, v12, v204
    v_mul_f32 v13, v13, v205
    v_mul_f32 v14, v14, v206
    v_mul_f32 v15, v15, v207
    v_cvt_pk_bf16_f32 v182, v12, v13
    v_cvt_pk_bf16_f32 v183, v14, v15
    ds_write_b64 v254, v[176:177] offset:0
    ds_write_b64 v254, v[178:179] offset:256
    ds_write_b64 v254, v[180:181] offset:512
    ds_write_b64 v254, v[182:183] offset:768
    s_waitcnt lgkmcnt(0)
    s_barrier
    ds_read_b128 v[192:195], v228 offset:0
    ds_read_b128 v[196:199], v228 offset:1536
    s_waitcnt lgkmcnt(0)
    buffer_store_dwordx4 v[192:195], v229, s[12:15], s40 offen sc1
    buffer_store_dwordx4 v[196:199], v229, s[12:15], s41 offen sc1
    v_mul_f32 v208, s63, v16
    v_mul_f32 v209, s63, v17
    v_mul_f32 v210, s63, v18
    v_mul_f32 v211, s63, v19
    v_exp_f32 v208, v208
    v_exp_f32 v209, v209
    v_exp_f32 v210, v210
    v_exp_f32 v211, v211
    v_add_f32 v208, 1.0, v208
    v_add_f32 v209, 1.0, v209
    v_add_f32 v210, 1.0, v210
    v_add_f32 v211, 1.0, v211
    v_rcp_f32 v208, v208
    v_rcp_f32 v209, v209
    v_rcp_f32 v210, v210
    v_rcp_f32 v211, v211
    v_cvt_pk_bf16_f32 v184, v16, v17
    v_cvt_pk_bf16_f32 v185, v18, v19
    v_mul_f32 v20, v20, v208
    v_mul_f32 v21, v21, v209
    v_mul_f32 v22, v22, v210
    v_mul_f32 v23, v23, v211
    v_cvt_pk_bf16_f32 v186, v20, v21
    v_cvt_pk_bf16_f32 v187, v22, v23
    v_mul_f32 v24, v24, v208
    v_mul_f32 v25, v25, v209
    v_mul_f32 v26, v26, v210
    v_mul_f32 v27, v27, v211
    v_cvt_pk_bf16_f32 v188, v24, v25
    v_cvt_pk_bf16_f32 v189, v26, v27
    v_mul_f32 v28, v28, v208
    v_mul_f32 v29, v29, v209
    v_mul_f32 v30, v30, v210
    v_mul_f32 v31, v31, v211
    v_cvt_pk_bf16_f32 v190, v28, v29
    v_cvt_pk_bf16_f32 v191, v30, v31
    ds_write_b64 v254, v[184:185] offset:3072
    ds_write_b64 v254, v[186:187] offset:3328
    ds_write_b64 v254, v[188:189] offset:3584
    ds_write_b64 v254, v[190:191] offset:3840
    s_waitcnt lgkmcnt(0)
    s_barrier
    ds_read_b128 v[192:195], v228 offset:3072
    ds_read_b128 v[196:199], v228 offset:4608
    s_waitcnt lgkmcnt(0)
    buffer_store_dwordx4 v[192:195], v229, s[12:15], s42 offen sc1
    buffer_store_dwordx4 v[196:199], v229, s[12:15], s43 offen sc1
    v_mul_f32 v212, s63, v32
    v_mul_f32 v213, s63, v33
    v_mul_f32 v214, s63, v34
    v_mul_f32 v215, s63, v35
    v_exp_f32 v212, v212
    v_exp_f32 v213, v213
    v_exp_f32 v214, v214
    v_exp_f32 v215, v215
    v_add_f32 v212, 1.0, v212
    v_add_f32 v213, 1.0, v213
    v_add_f32 v214, 1.0, v214
    v_add_f32 v215, 1.0, v215
    v_rcp_f32 v212, v212
    v_rcp_f32 v213, v213
    v_rcp_f32 v214, v214
    v_rcp_f32 v215, v215
    v_cvt_pk_bf16_f32 v220, v32, v33
    v_cvt_pk_bf16_f32 v221, v34, v35
    v_mul_f32 v36, v36, v212
    v_mul_f32 v37, v37, v213
    v_mul_f32 v38, v38, v214
    v_mul_f32 v39, v39, v215
    v_cvt_pk_bf16_f32 v178, v36, v37
    v_cvt_pk_bf16_f32 v179, v38, v39
    v_mul_f32 v40, v40, v212
    v_mul_f32 v41, v41, v213
    v_mul_f32 v42, v42, v214
    v_mul_f32 v43, v43, v215
    v_cvt_pk_bf16_f32 v180, v40, v41
    v_cvt_pk_bf16_f32 v181, v42, v43
    ds_write_b64 v255, v[220:221] offset:0
    ds_write_b64 v246, v[178:179] offset:256
    ds_write_b64 v255, v[180:181] offset:512
    s_waitcnt lgkmcnt(0)
    s_barrier
    ds_read_b128 v[200:203], v249
    s_branch K2_LASTROW
K2_SPILL:
    buffer_store_dwordx4 v[0:3], v227, s[8:11], s60 offen offset:0
    buffer_store_dwordx4 v[4:7], v227, s[8:11], s60 offen offset:16
    buffer_store_dwordx4 v[8:11], v227, s[8:11], s60 offen offset:32
    buffer_store_dwordx4 v[12:15], v227, s[8:11], s60 offen offset:48
    buffer_store_dwordx4 v[16:19], v227, s[8:11], s60 offen offset:64
    buffer_store_dwordx4 v[20:23], v227, s[8:11], s60 offen offset:80
    buffer_store_dwordx4 v[24:27], v227, s[8:11], s60 offen offset:96
    buffer_store_dwordx4 v[28:31], v227, s[8:11], s60 offen offset:112
    buffer_store_dwordx4 v[32:35], v227, s[8:11], s60 offen offset:128
    buffer_store_dwordx4 v[36:39], v227, s[8:11], s60 offen offset:144
    buffer_store_dwordx4 v[40:43], v227, s[8:11], s60 offen offset:160
    s_mov_b32 s28, 0
    s_waitcnt vmcnt(0)
    s_cmp_lt_u32 s24, s25
    s_cbranch_scc1 K2_LOAD
    s_add_u32 s23, s23, 20
    s_branch K2_WINDOW
KS_FLS:
    s_sub_u32 s25, s25, 1
    s_cbranch_scc1 K2_END
    v_mov_b32 v62, 163460
    ds_read_b32 v62, v62
    s_branch KS_JOIN2
K2_NOW0:
    buffer_load_dwordx4 v[76:79], v72, s[8:11], s67 offen sc1
    s_branch K2_W0
K2_WINDOW:
    s_mov_b32 s24, 0
    s_mov_b32 s25, 1
K2_LOAD:
    v_mbcnt_lo_u32_b32 v176, -1, 0
    v_mbcnt_hi_u32_b32 v176, -1, v176
    s_lshl_b32 s58, s20, 6
    v_add_u32 v177, s58, v176
    v_lshlrev_b32 v70, 4, v176
    s_mov_b32 s58, 7110656
    buffer_load_dwordx4 v[136:139], v70, s[8:11], s58 offen offset:0 sc1
    buffer_load_dwordx4 v[140:143], v70, s[8:11], s58 offen offset:1024 sc1
    s_mov_b32 s58, 7112704
    buffer_load_dwordx4 v[144:147], v70, s[8:11], s58 offen offset:0 sc1
    buffer_load_dwordx4 v[148:151], v70, s[8:11], s58 offen offset:1024 sc1
    s_mov_b32 s58, 7114752
    buffer_load_dwordx4 v[152:155], v70, s[8:11], s58 offen offset:0 sc1
    buffer_load_dwordx4 v[156:159], v70, s[8:11], s58 offen offset:1024 sc1
    s_mov_b32 s58, 7116800
    buffer_load_dwordx4 v[160:163], v70, s[8:11], s58 offen offset:0 sc1
    buffer_load_dwordx4 v[164:167], v70, s[8:11], s58 offen offset:1024 sc1
    s_mov_b32 s58, 7118848
    buffer_load_dwordx4 v[168:171], v70, s[8:11], s58 offen offset:0 sc1
    buffer_load_dwordx4 v[172:175], v70, s[8:11], s58 offen offset:1024 sc1
    s_mul_i32 s58, s20, 10400
    s_add_u32 s58, s58, 65536
    s_add_u32 s59, s58, 512
    v_and_b32 v76, 31, v176
    v_lshrrev_b32 v77, 5, v176
    v_mov_b32 v80, 0
    v_mul_u32_u24 v77, 2080, v77
    v_mov_b32 v81, 0xffff0000
    v_lshl_add_u32 v78, v76, 4, v77
    v_mov_b32 v82, 0
    v_add_u32 v78, s58, v78
    v_mov_b32 v83, v81
    v_add_u32 v85, 16, v176
    v_lshlrev_b32 v84, 5, v176
    v_lshrrev_b32 v85, 6, v85
    v_mul_u32_u24 v85, 1532, v85
    v_sub_u32 v84, v84, v85
    v_mov_b32 v85, -1
    v_add_u32 v84, s59, v84
    ds_write_b32 v84, v85 offset:0
    ds_write_b32 v84, v85 offset:2080
    ds_write_b32 v84, v85 offset:4160
    ds_write_b32 v84, v85 offset:6240
    ds_write_b32 v84, v85 offset:8320
    s_mov_b32 exec_hi, 0
    ds_write_b128 v78, v[80:83] offset:0
    ds_write_b128 v78, v[80:83] offset:2080
    ds_write_b128 v78, v[80:83] offset:4160
    ds_write_b128 v78, v[80:83] offset:6240
    ds_write_b128 v78, v[80:83] offset:8320
    s_mov_b32 exec_hi, -1
    s_cmp_lg_u32 s20, 7
    s_cbranch_scc1 K2_NOH
    v_mov_b32 v76, 0
    v_mov_b32 v77, -1
    v_lshlrev_b32 v78, 2, v176
    v_add_u32 v78, 163072, v78
    s_mov_b64 exec, 0x1ff
    ds_write_b32 v78, v76 offset:192
    s_mov_b32 exec_lo, 1
    ds_write_b32 v78, v76 offset:232
    s_mov_b32 exec_lo, -1
    ds_write_b32 v78, v77 offset:256
    s_mov_b64 exec, -1
    s_cmp_lg_u32 s24, 0
    s_cbranch_scc1 K2_NOH
    s_mov_b32 exec_hi, 0xffff
    ds_write_b32 v78, v76
    s_mov_b64 exec, 1
    ds_write_b32 v78, v76 offset:228
    s_mov_b64 exec, -1
K2_NOH:
    s_waitcnt lgkmcnt(0)
    s_barrier
    s_branch K2_CELLS
K2_LD_GEN:
    s_mov_b64 exec, s[42:43]
    s_cbranch_execz K2_LD_DONE
    buffer_load_dwordx4 v[4:7], v182, s[8:11], 0 offen sc1
    s_mov_b64 exec, s[44:45]
    s_cbranch_execz K2_LD_DONE
    buffer_load_dwordx4 v[8:11], v183, s[8:11], 0 offen sc1
    s_mov_b64 exec, s[46:47]
    s_cbranch_execz K2_LD_DONE
    buffer_load_dwordx4 v[12:15], v184, s[8:11], 0 offen sc1
    s_mov_b64 exec, s[48:49]
    s_cbranch_execz K2_LD_DONE
    buffer_load_dwordx4 v[16:19], v181, s[8:11], 0 offen offset:128 sc1
    s_mov_b64 exec, s[50:51]
    s_cbranch_execz K2_LD_DONE
    buffer_load_dwordx4 v[20:23], v181, s[8:11], 0 offen offset:160 sc1
    s_mov_b64 exec, s[90:91]
    s_cbranch_execz K2_LD_DONE
    buffer_load_dwordx4 v[24:27], v181, s[8:11], 0 offen offset:192 sc1
    s_mov_b64 exec, s[92:93]
    s_cbranch_execz K2_LD_DONE
    buffer_load_dwordx4 v[28:31], v181, s[8:11], 0 offen offset:224 sc1
    s_mov_b64 exec, s[94:95]
    s_cbranch_execz K2_LD_DONE
    buffer_load_dwordx4 v[32:35], v181, s[8:11], 0 offen offset:256 sc1
    s_mov_b64 exec, s[96:97]
    s_cbranch_execz K2_LD_DONE
    buffer_load_dwordx4 v[36:39], v181, s[8:11], 0 offen offset:288 sc1
    s_branch K2_LD_DONE
K2_WLATE:
    s_waitcnt vmcnt(0)
    v_lshlrev_b32 v96, 16, v136
    v_and_b32 v97, 0xffff0000, v136
    v_lshlrev_b32 v98, 16, v137
    v_and_b32 v99, 0xffff0000, v137
    v_lshlrev_b32 v100, 16, v138
    v_and_b32 v101, 0xffff0000, v138
    v_lshlrev_b32 v102, 16, v139
    v_and_b32 v103, 0xffff0000, v139
    v_lshlrev_b32 v104, 16, v140
    v_and_b32 v105, 0xffff0000, v140
    v_lshlrev_b32 v106, 16, v141
    v_and_b32 v107, 0xffff0000, v141
    v_lshlrev_b32 v108, 16, v142
    v_and_b32 v109, 0xffff0000, v142
    v_lshlrev_b32 v110, 16, v143
    v_and_b32 v111, 0xffff0000, v143
    v_lshlrev_b32 v112, 16, v144
    v_and_b32 v113, 0xffff0000, v144
    v_lshlrev_b32 v114, 16, v145
    v_and_b32 v115, 0xffff0000, v145
    v_lshlrev_b32 v116, 16, v146
    v_and_b32 v117, 0xffff0000, v146
    v_lshlrev_b32 v118, 16, v147
    v_and_b32 v119, 0xffff0000, v147
    v_lshlrev_b32 v120, 16, v148
    v_and_b32 v121, 0xffff0000, v148
    v_lshlrev_b32 v122, 16, v149
    v_and_b32 v123, 0xffff0000, v149
    v_lshlrev_b32 v124, 16, v150
    v_and_b32 v125, 0xffff0000, v150
    v_lshlrev_b32 v126, 16, v151
    v_and_b32 v127, 0xffff0000, v151
    v_lshlrev_b32 v128, 16, v152
    v_and_b32 v129, 0xffff0000, v152
    v_lshlrev_b32 v130, 16, v153
    v_and_b32 v131, 0xffff0000, v153
    v_lshlrev_b32 v132, 16, v154
    v_and_b32 v133, 0xffff0000, v154
    v_lshlrev_b32 v134, 16, v155
    v_and_b32 v135, 0xffff0000, v155
    v_lshlrev_b32 v136, 16, v156
    v_and_b32 v137, 0xffff0000, v156
    v_lshlrev_b32 v138, 16, v157
    v_and_b32 v139, 0xffff0000, v157
    v_lshlrev_b32 v140, 16, v158
    v_and_b32 v141, 0xffff0000, v158
    v_lshlrev_b32 v142, 16, v159
    v_and_b32 v143, 0xffff0000, v159
    v_lshlrev_b32 v144, 16, v160
    v_and_b32 v145, 0xffff0000, v160
    v_lshlrev_b32 v146, 16, v161
    v_and_b32 v147, 0xffff0000, v161
    v_lshlrev_b32 v148, 16, v162
    v_and_b32 v149, 0xffff0000, v162
    v_lshlrev_b32 v150, 16, v163
    v_and_b32 v151, 0xffff0000, v163
    v_lshlrev_b32 v152, 16, v164
    v_and_b32 v153, 0xffff0000, v164
    v_lshlrev_b32 v154, 16, v165
    v_and_b32 v155, 0xffff0000, v165
    v_lshlrev_b32 v156, 16, v166
    v_and_b32 v157, 0xffff0000, v166
    v_lshlrev_b32 v158, 16, v167
    v_and_b32 v159, 0xffff0000, v167
    v_lshlrev_b32 v160, 16, v168
    v_and_b32 v161, 0xffff0000, v168
    v_lshlrev_b32 v162, 16, v169
    v_and_b32 v163, 0xffff0000, v169
    v_lshlrev_b32 v164, 16, v170
    v_and_b32 v165, 0xffff0000, v170
    v_lshlrev_b32 v166, 16, v171
    v_and_b32 v167, 0xffff0000, v171
    v_lshlrev_b32 v168, 16, v172
    v_and_b32 v169, 0xffff0000, v172
    v_lshlrev_b32 v170, 16, v173
    v_and_b32 v171, 0xffff0000, v173
    v_lshlrev_b32 v172, 16, v174
    v_and_b32 v173, 0xffff0000, v174
    v_lshlrev_b32 v174, 16, v175
    v_and_b32 v175, 0xffff0000, v175
    s_branch K2_NOWRAW
K2_RT0:
    s_sub_u32 s60, s60, 1
    s_cbranch_scc1 K2_END
    buffer_load_dwordx4 v[0:3], v181, s[8:11], 0 offen offset:0 sc1
    s_waitcnt vmcnt(0)
    s_branch K2_CK0
K2_RT1:
    s_sub_u32 s60, s60, 1
    s_cbranch_scc1 K2_END
    buffer_load_dwordx4 v[4:7], v182, s[8:11], 0 offen sc1
    s_waitcnt vmcnt(0)
    s_branch K2_CK1
K2_RT2:
    s_sub_u32 s60, s60, 1
    s_cbranch_scc1 K2_END
    buffer_load_dwordx4 v[8:11], v183, s[8:11], 0 offen sc1
    s_waitcnt vmcnt(0)
    s_branch K2_CK2
K2_RT3:
    s_sub_u32 s60, s60, 1
    s_cbranch_scc1 K2_END
    buffer_load_dwordx4 v[12:15], v184, s[8:11], 0 offen sc1
    s_waitcnt vmcnt(0)
    s_branch K2_CK3
K2_RT4:
    s_sub_u32 s60, s60, 1
    s_cbranch_scc1 K2_END
    buffer_load_dwordx4 v[16:19], v181, s[8:11], 0 offen offset:128 sc1
    s_waitcnt vmcnt(0)
    s_branch K2_CK4
K2_RT5:
    s_sub_u32 s60, s60, 1
    s_cbranch_scc1 K2_END
    buffer_load_dwordx4 v[20:23], v181, s[8:11], 0 offen offset:160 sc1
    s_waitcnt vmcnt(0)
    s_branch K2_CK5
K2_RT6:
    s_sub_u32 s60, s60, 1
    s_cbranch_scc1 K2_END
    buffer_load_dwordx4 v[24:27], v181, s[8:11], 0 offen offset:192 sc1
    s_waitcnt vmcnt(0)
    s_branch K2_CK6
K2_RT7:
    s_sub_u32 s60, s60, 1
    s_cbranch_scc1 K2_END
    buffer_load_dwordx4 v[28:31], v181, s[8:11], 0 offen offset:224 sc1
    s_waitcnt vmcnt(0)
    s_branch K2_CK7
K2_RT8:
    s_sub_u32 s60, s60, 1
    s_cbranch_scc1 K2_END
    buffer_load_dwordx4 v[32:35], v181, s[8:11], 0 offen offset:256 sc1
    s_waitcnt vmcnt(0)
    s_branch K2_CK8
K2_RT9:
    s_sub_u32 s60, s60, 1
    s_cbranch_scc1 K2_END
    buffer_load_dwordx4 v[36:39], v181, s[8:11], 0 offen offset:288 sc1
    s_waitcnt vmcnt(0)
    s_branch K2_CK9
K2_RK_LOAD:
    s_waitcnt vmcnt(0)
    s_mov_b64 exec, s[40:41]
    s_cbranch_execz K2_RK_B
    v_lshrrev_b32 v50, 24, v3
    buffer_load_dword v40, v179, s[8:11], s66 offen offset:0
    v_mad_u32_u24 v50, v50, s58, v202
    v_and_b32 v3, 0xffffff, v3
    s_mov_b64 exec, s[42:43]
    s_cbranch_execz K2_RK_B
    v_lshrrev_b32 v51, 24, v7
    buffer_load_dword v41, v185, s[8:11], s66 offen
    v_mad_u32_u24 v51, v51, s58, v202
    v_and_b32 v7, 0xffffff, v7
    s_mov_b64 exec, s[44:45]
    s_cbranch_execz K2_RK_B
    v_lshrrev_b32 v52, 24, v11
    buffer_load_dword v42, v186, s[8:11], s66 offen
    v_mad_u32_u24 v52, v52, s58, v202
    v_and_b32 v11, 0xffffff, v11
    s_mov_b64 exec, s[46:47]
    s_cbranch_execz K2_RK_B
    v_lshrrev_b32 v53, 24, v15
    buffer_load_dword v43, v187, s[8:11], s66 offen
    v_mad_u32_u24 v53, v53, s58, v202
    v_and_b32 v15, 0xffffff, v15
    s_mov_b64 exec, s[48:49]
    s_cbranch_execz K2_RK_B
    v_lshrrev_b32 v54, 24, v19
    buffer_load_dword v44, v179, s[8:11], s66 offen offset:32
    v_mad_u32_u24 v54, v54, s58, v202
    v_and_b32 v19, 0xffffff, v19
    s_mov_b64 exec, s[50:51]
    s_cbranch_execz K2_RK_B
    v_lshrrev_b32 v55, 24, v23
    buffer_load_dword v45, v179, s[8:11], s66 offen offset:40
    v_mad_u32_u24 v55, v55, s58, v202
    v_and_b32 v23, 0xffffff, v23
    s_mov_b64 exec, s[90:91]
    s_cbranch_execz K2_RK_B
    v_lshrrev_b32 v56, 24, v27
    buffer_load_dword v46, v179, s[8:11], s66 offen offset:48
    v_mad_u32_u24 v56, v56, s58, v202
    v_and_b32 v27, 0xffffff, v27
    s_mov_b64 exec, s[92:93]
    s_cbranch_execz K2_RK_B
    v_lshrrev_b32 v57, 24, v31
    buffer_load_dword v47, v179, s[8:11], s66 offen offset:56
    v_mad_u32_u24 v57, v57, s58, v202
    v_and_b32 v31, 0xffffff, v31
    s_mov_b64 exec, s[94:95]
    s_cbranch_execz K2_RK_B
    v_lshrrev_b32 v58, 24, v35
    buffer_load_dword v48, v179, s[8:11], s66 offen offset:64
    v_mad_u32_u24 v58, v58, s58, v202
    v_and_b32 v35, 0xffffff, v35
    s_mov_b64 exec, s[96:97]
    s_cbranch_execz K2_RK_B
    v_lshrrev_b32 v59, 24, v39
    buffer_load_dword v49, v179, s[8:11], s66 offen offset:72
    v_mad_u32_u24 v59, v59, s58, v202
    v_and_b32 v39, 0xffffff, v39
K2_RK_B:
    s_mov_b64 exec, -1
    s_mul_i32 s62, s24, 48
    s_waitcnt vmcnt(0)
    v_subrev_u32 v40, s62, v40
    v_subrev_u32 v41, s62, v41
    v_subrev_u32 v42, s62, v42
    v_subrev_u32 v43, s62, v43
    v_subrev_u32 v44, s62, v44
    v_subrev_u32 v45, s62, v45
    v_subrev_u32 v46, s62, v46
    v_subrev_u32 v47, s62, v47
    v_subrev_u32 v48, s62, v48
    v_subrev_u32 v49, s62, v49
    s_branch K2_RK_DONE
K2_BIG:
    s_cmp_lg_u32 s24, 0
    s_cbranch_scc1 K2_TOK
    s_movk_i32 s26, 48
    v_mov_b32 v197, v193
    s_nop 1
    v_max_u32_dpp v197, v197, v197 row_shr:1 row_mask:0xf bank_mask:0xf bound_ctrl:0
    s_nop 1
    v_max_u32_dpp v197, v197, v197 row_shr:2 row_mask:0xf bank_mask:0xf bound_ctrl:0
    s_nop 1
    v_max_u32_dpp v197, v197, v197 row_shr:4 row_mask:0xf bank_mask:0xf bound_ctrl:0
    s_nop 1
    v_max_u32_dpp v197, v197, v197 row_shr:8 row_mask:0xf bank_mask:0xf bound_ctrl:0
    s_nop 1
    v_max_u32_dpp v197, v197, v197 row_bcast:15 row_mask:0xa bank_mask:0xf
    s_nop 1
    v_max_u32_dpp v197, v197, v197 row_bcast:31 row_mask:0xc bank_mask:0xf
    s_nop 0
    v_readlane_b32 s25, v197, 63
    s_nop 0
    s_add_u32 s25, s25, 47
    s_mul_i32 s25, s25, 43691
    s_lshr_b32 s25, s25, 21
    s_mov_b64 exec, s[40:41]
    s_cbranch_execz K2_SV_DONE
    buffer_store_dword v40, v179, s[8:11], s66 offen offset:0
    s_mov_b64 exec, s[42:43]
    s_cbranch_execz K2_SV_DONE
    buffer_store_dword v41, v185, s[8:11], s66 offen
    s_mov_b64 exec, s[44:45]
    s_cbranch_execz K2_SV_DONE
    buffer_store_dword v42, v186, s[8:11], s66 offen
    s_mov_b64 exec, s[46:47]
    s_cbranch_execz K2_SV_DONE
    buffer_store_dword v43, v187, s[8:11], s66 offen
    s_mov_b64 exec, s[48:49]
    s_cbranch_execz K2_SV_DONE
    buffer_store_dword v44, v179, s[8:11], s66 offen offset:32
    s_mov_b64 exec, s[50:51]
    s_cbranch_execz K2_SV_DONE
    buffer_store_dword v45, v179, s[8:11], s66 offen offset:40
    s_mov_b64 exec, s[90:91]
    s_cbranch_execz K2_SV_DONE
    buffer_store_dword v46, v179, s[8:11], s66 offen offset:48
    s_mov_b64 exec, s[92:93]
    s_cbranch_execz K2_SV_DONE
    buffer_store_dword v47, v179, s[8:11], s66 offen offset:56
    s_mov_b64 exec, s[94:95]
    s_cbranch_execz K2_SV_DONE
    buffer_store_dword v48, v179, s[8:11], s66 offen offset:64
    s_mov_b64 exec, s[96:97]
    s_cbranch_execz K2_SV_DONE
    buffer_store_dword v49, v179, s[8:11], s66 offen offset:72
K2_SV_DONE:
    s_mov_b64 exec, -1
    s_branch K2_TOK
K2_rare_1:
    s_cmp_eq_u32 s33, 4
    s_cbranch_scc1 K2_four_3
    s_mov_b32 s49, s48
    s_xor_b32 s45, s44, 256
    s_xor_b32 s46, s44, 512
    s_xor_b32 s47, s44, 768
    s_branch K2_back_2
K2_four_3:
    s_add_u32 s50, s48, 256
    s_mov_b32 s46, s44
    s_mov_b32 s47, s44
    s_branch K2_back_2
K2_a4_5:
    v_add_u32 v254, s48, v230
    ds_read_b32 v254, v254 offset:4
    s_lshr_b32 s65, s3, 28
    s_mul_i32 s66, s22, 2080
    s_lshl_b32 s65, s65, 9
    s_add_u32 s65, s65, s66
    s_add_u32 s65, s65, 65536
    s_mov_b32 m0, s65
    s_mov_b32 exec_hi, 0
    s_waitcnt lgkmcnt(0)
    v_or_b32 v254, v254, v231
    buffer_load_dwordx4 v254, s[16:19], 0 offen  lds
    s_mov_b32 exec_hi, -1
    s_branch K2_b4_7
K2_g4_8:
    s_add_u32 s51, s48, 384
    v_add_u32 v228, s51, v251
    ds_read2_b32 v[228:229], v228 offset0:1 offset1:3
    s_waitcnt lgkmcnt(0)
    v_mad_u32_u16 v228, v228, s39, v248 op_sel:[1,0,0,0]
    v_mad_u32_u16 v229, v229, s39, v248 op_sel:[1,0,0,0]
    buffer_load_dwordx4 v228, s[4:7], s47 offen sc1 lds
    buffer_load_dwordx4 v229, s[72:75], s47 offen offset:1024 sc1 lds
    s_branch K2_back_9
K2_rare_16:
    s_cmp_eq_u32 s33, 4
    s_cbranch_scc1 K2_four_18
    s_mov_b32 s49, s48
    s_xor_b32 s45, s44, 256
    s_xor_b32 s46, s44, 512
    s_xor_b32 s47, s44, 768
    s_branch K2_back_17
K2_four_18:
    s_add_u32 s50, s48, 256
    s_mov_b32 s46, s44
    s_mov_b32 s47, s44
    s_branch K2_back_17
K2_g4_19:
    s_add_u32 s51, s48, 384
    v_add_u32 v228, s51, v251
    ds_read2_b32 v[228:229], v228 offset0:1 offset1:3
    s_waitcnt lgkmcnt(0)
    v_mad_u32_u16 v228, v228, s39, v248 op_sel:[1,0,0,0]
    v_mad_u32_u16 v229, v229, s39, v248 op_sel:[1,0,0,0]
    buffer_load_dwordx4 v228, s[4:7], s47 offen sc1 lds
    buffer_load_dwordx4 v229, s[72:75], s47 offen offset:1024 sc1 lds
    s_branch K2_back_20
K2_a4_22:
    v_add_u32 v254, s48, v230
    ds_read_b32 v254, v254 offset:4
    s_lshr_b32 s65, s3, 28
    s_mul_i32 s66, s22, 2080
    s_lshl_b32 s65, s65, 9
    s_add_u32 s65, s65, s66
    s_add_u32 s65, s65, 65536
    s_mov_b32 m0, s65
    s_mov_b32 exec_hi, 0
    s_waitcnt lgkmcnt(0)
    v_or_b32 v254, v254, v231
    buffer_load_dwordx4 v254, s[16:19], 0 offen  lds
    s_mov_b32 exec_hi, -1
    s_branch K2_b4_24
K2_rare_31:
    s_cmp_eq_u32 s33, 4
    s_cbranch_scc1 K2_four_33
    s_mov_b32 s49, s48
    s_xor_b32 s45, s44, 256
    s_xor_b32 s46, s44, 512
    s_xor_b32 s47, s44, 768
    s_branch K2_back_32
K2_four_33:
    s_add_u32 s50, s48, 256
    s_mov_b32 s46, s44
    s_mov_b32 s47, s44
    s_branch K2_back_32
K2_g4_34:
    s_add_u32 s51, s48, 384
    v_add_u32 v228, s51, v251
    ds_read2_b32 v[228:229], v228 offset0:1 offset1:3
    s_waitcnt lgkmcnt(0)
    v_mad_u32_u16 v228, v228, s39, v248 op_sel:[1,0,0,0]
    v_mad_u32_u16 v229, v229, s39, v248 op_sel:[1,0,0,0]
    buffer_load_dwordx4 v228, s[4:7], s47 offen sc1 lds
    buffer_load_dwordx4 v229, s[72:75], s47 offen offset:1024 sc1 lds
    s_branch K2_back_35
K2_a4_37:
    v_add_u32 v254, s48, v230
    ds_read_b32 v254, v254 offset:4
    s_lshr_b32 s65, s3, 28
    s_mul_i32 s66, s22, 2080
    s_lshl_b32 s65, s65, 9
    s_add_u32 s65, s65, s66
    s_add_u32 s65, s65, 65536
    s_mov_b32 m0, s65
    s_mov_b32 exec_hi, 0
    s_waitcnt lgkmcnt(0)
    v_or_b32 v254, v254, v231
    buffer_load_dwordx4 v254, s[16:19], 0 offen  lds
    s_mov_b32 exec_hi, -1
    s_branch K2_b4_39
K2_rare_46:
    s_cmp_eq_u32 s33, 4
    s_cbranch_scc1 K2_four_48
    s_mov_b32 s49, s48
    s_xor_b32 s45, s44, 256
    s_xor_b32 s46, s44, 512
    s_xor_b32 s47, s44, 768
    s_branch K2_back_47
K2_four_48:
    s_add_u32 s50, s48, 256
    s_mov_b32 s46, s44
    s_mov_b32 s47, s44
    s_branch K2_back_47
K2_g4_49:
    s_add_u32 s51, s48, 384
    v_add_u32 v228, s51, v251
    ds_read2_b32 v[228:229], v228 offset0:1 offset1:3
    s_waitcnt lgkmcnt(0)
    v_mad_u32_u16 v228, v228, s39, v248 op_sel:[1,0,0,0]
    v_mad_u32_u16 v229, v229, s39, v248 op_sel:[1,0,0,0]
    buffer_load_dwordx4 v228, s[4:7], s47 offen sc1 lds
    buffer_load_dwordx4 v229, s[72:75], s47 offen offset:1024 sc1 lds
    s_branch K2_back_50
K2_a4_52:
    v_add_u32 v254, s48, v230
    ds_read_b32 v254, v254 offset:4
    s_lshr_b32 s65, s3, 28
    s_mul_i32 s66, s22, 2080
    s_lshl_b32 s65, s65, 9
    s_add_u32 s65, s65, s66
    s_add_u32 s65, s65, 65536
    s_mov_b32 m0, s65
    s_mov_b32 exec_hi, 0
    s_waitcnt lgkmcnt(0)
    v_or_b32 v254, v254, v231
    buffer_load_dwordx4 v254, s[16:19], 0 offen  lds
    s_mov_b32 exec_hi, -1
    s_branch K2_b4_54
K2_rare_59:
    s_cmp_eq_u32 s33, 4
    s_cbranch_scc1 K2_four_61
    s_mov_b32 s49, s48
    s_xor_b32 s45, s44, 256
    s_xor_b32 s46, s44, 512
    s_xor_b32 s47, s44, 768
    s_branch K2_back_60
K2_four_61:
    s_add_u32 s50, s48, 256
    s_mov_b32 s46, s44
    s_mov_b32 s47, s44
    s_branch K2_back_60
K2_g4_62:
    s_add_u32 s51, s48, 384
    v_add_u32 v228, s51, v251
    ds_read2_b32 v[228:229], v228 offset0:1 offset1:3
    s_waitcnt lgkmcnt(0)
    v_mad_u32_u16 v228, v228, s39, v248 op_sel:[1,0,0,0]
    v_mad_u32_u16 v229, v229, s39, v248 op_sel:[1,0,0,0]
    buffer_load_dwordx4 v228, s[4:7], s47 offen sc1 lds
    buffer_load_dwordx4 v229, s[72:75], s47 offen offset:1024 sc1 lds
    s_branch K2_back_63
K2_rare_68:
    s_cmp_eq_u32 s33, 4
    s_cbranch_scc1 K2_four_70
    s_mov_b32 s49, s48
    s_xor_b32 s45, s44, 256
    s_xor_b32 s46, s44, 512
    s_xor_b32 s47, s44, 768
    s_branch K2_back_69
K2_four_70:
    s_add_u32 s50, s48, 256
    s_mov_b32 s46, s44
    s_mov_b32 s47, s44
    s_branch K2_back_69
K2_g4_71:
    s_add_u32 s51, s48, 384
    v_add_u32 v228, s51, v251
    ds_read2_b32 v[228:229], v228 offset0:1 offset1:3
    s_waitcnt lgkmcnt(0)
    v_mad_u32_u16 v228, v228, s39, v248 op_sel:[1,0,0,0]
    v_mad_u32_u16 v229, v229, s39, v248 op_sel:[1,0,0,0]
    buffer_load_dwordx4 v228, s[4:7], s47 offen sc1 lds
    buffer_load_dwordx4 v229, s[72:75], s47 offen offset:1024 sc1 lds
    s_branch K2_back_72
K2_rare_77:
    s_cmp_eq_u32 s33, 4
    s_cbranch_scc1 K2_four_79
    s_mov_b32 s49, s48
    s_xor_b32 s45, s44, 256
    s_xor_b32 s46, s44, 512
    s_xor_b32 s47, s44, 768
    s_branch K2_back_78
K2_four_79:
    s_add_u32 s50, s48, 256
    s_mov_b32 s46, s44
    s_mov_b32 s47, s44
    s_branch K2_back_78
K2_g4_80:
    s_add_u32 s51, s48, 384
    v_add_u32 v228, s51, v251
    ds_read2_b32 v[228:229], v228 offset0:1 offset1:3
    s_waitcnt lgkmcnt(0)
    v_mad_u32_u16 v228, v228, s39, v248 op_sel:[1,0,0,0]
    v_mad_u32_u16 v229, v229, s39, v248 op_sel:[1,0,0,0]
    buffer_load_dwordx4 v228, s[4:7], s47 offen sc1 lds
    buffer_load_dwordx4 v229, s[72:75], s47 offen offset:1024 sc1 lds
    s_branch K2_back_81
K2_rare_86:
    s_cmp_eq_u32 s33, 4
    s_cbranch_scc1 K2_four_88
    s_mov_b32 s49, s48
    s_xor_b32 s45, s44, 256
    s_xor_b32 s46, s44, 512
    s_xor_b32 s47, s44, 768
    s_branch K2_back_87
K2_four_88:
    s_add_u32 s50, s48, 256
    s_mov_b32 s46, s44
    s_mov_b32 s47, s44
    s_branch K2_back_87
K2_g4_89:
    s_add_u32 s51, s48, 384
    v_add_u32 v228, s51, v251
    ds_read2_b32 v[228:229], v228 offset0:1 offset1:3
    s_waitcnt lgkmcnt(0)
    v_mad_u32_u16 v228, v228, s39, v248 op_sel:[1,0,0,0]
    v_mad_u32_u16 v229, v229, s39, v248 op_sel:[1,0,0,0]
    buffer_load_dwordx4 v228, s[4:7], s47 offen sc1 lds
    buffer_load_dwordx4 v229, s[72:75], s47 offen offset:1024 sc1 lds
    s_branch K2_back_90
K2_U10:
    s_setprio 1
    s_add_u32 s38, s38, 1
    v_mov_b32 v254, s52
    v_mov_b32 v255, s38
    s_lshl_b32 s58, s38, 3
    s_add_u32 s58, s58, s20
    s_mov_b64 exec, 1
    ds_write_b32 v254, v255
    s_mov_b64 exec, -1
    s_cmp_lt_u32 s58, s22
    s_cbranch_scc0 K2_dyn_91
K2_back_92:
    s_waitcnt lgkmcnt(4)
    v_lshlrev_b32 v20, 16, v0
    v_and_b32 v21, 0xffff0000, v0
    v_lshlrev_b32 v22, 16, v1
    v_and_b32 v23, 0xffff0000, v1
    v_lshlrev_b32 v24, 16, v2
    v_and_b32 v25, 0xffff0000, v2
    v_lshlrev_b32 v26, 16, v3
    v_and_b32 v27, 0xffff0000, v3
    v_mul_f32_dpp v36, v16, v20 row_newbcast:8 row_mask:0xf bank_mask:0xf
    v_mul_f32_dpp v37, v16, v21 row_newbcast:9 row_mask:0xf bank_mask:0xf
    v_mul_f32_dpp v38, v16, v22 row_newbcast:10 row_mask:0xf bank_mask:0xf
    v_mul_f32_dpp v39, v16, v23 row_newbcast:11 row_mask:0xf bank_mask:0xf
    v_mul_f32_dpp v40, v16, v24 row_newbcast:12 row_mask:0xf bank_mask:0xf
    v_mul_f32_dpp v41, v16, v25 row_newbcast:13 row_mask:0xf bank_mask:0xf
    v_mul_f32_dpp v42, v16, v26 row_newbcast:14 row_mask:0xf bank_mask:0xf
    v_mul_f32_dpp v43, v16, v27 row_newbcast:15 row_mask:0xf bank_mask:0xf
    v_cvt_pk_bf16_f32 v68, v36, v37
    v_cvt_pk_bf16_f32 v69, v38, v39
    v_cvt_pk_bf16_f32 v70, v40, v41
    v_cvt_pk_bf16_f32 v71, v42, v43
    v_mul_f32_dpp v20, v16, v20 row_newbcast:0 row_mask:0xa bank_mask:0xf
    v_mul_f32_dpp v21, v16, v21 row_newbcast:1 row_mask:0xa bank_mask:0xf
    v_mul_f32_dpp v22, v16, v22 row_newbcast:2 row_mask:0xa bank_mask:0xf
    v_mul_f32_dpp v23, v16, v23 row_newbcast:3 row_mask:0xa bank_mask:0xf
    v_mul_f32_dpp v24, v16, v24 row_newbcast:4 row_mask:0xa bank_mask:0xf
    v_mul_f32_dpp v25, v16, v25 row_newbcast:5 row_mask:0xa bank_mask:0xf
    v_mul_f32_dpp v26, v16, v26 row_newbcast:6 row_mask:0xa bank_mask:0xf
    v_mul_f32_dpp v27, v16, v27 row_newbcast:7 row_mask:0xa bank_mask:0xf
    v_cvt_pk_bf16_f32 v64, v20, v21
    v_cvt_pk_bf16_f32 v65, v22, v23
    v_cvt_pk_bf16_f32 v66, v24, v25
    v_cvt_pk_bf16_f32 v67, v26, v27
    v_readlane_b32 s3, v253, s58
    s_lshl_b32 s44, s34, 7
    s_and_b32 s48, s3, 0x3ffff
    s_bfe_u32 s33, s3, 0x30013
    s_mul_i32 s35, s38, 6
    s_cmp_eq_u32 s34, 0
    s_cselect_b32 s35, s35, s48
    s_mov_b32 s45, s44
    s_xor_b32 s47, s44, 256
    s_add_u32 s49, s48, 128
    s_add_u32 s60, s48, 256
    s_cmp_eq_u32 s33, 3
    s_cselect_b32 s46, s44, s47
    s_cselect_b32 s50, s60, s48
    s_sub_u32 s60, s33, 2
    s_cmp_lt_u32 s60, 2
    s_cbranch_scc0 K2_rare_97
K2_back_98:
    v_add_u32 v233, s48, v230
    ds_read_b32 v232, v233
    ds_read_b32 v233, v233 offset:1024
    v_add_u32 v222, s48, v251
    ds_read2_b32 v[222:223], v222 offset0:1 offset1:3
    v_add_u32 v224, s49, v251
    ds_read2_b32 v[224:225], v224 offset0:1 offset1:3
    v_add_u32 v226, s50, v251
    ds_read2_b32 v[226:227], v226 offset0:1 offset1:3
    s_waitcnt lgkmcnt(3)
    v_or_b32 v232, v232, v231
    v_or_b32 v233, v233, v231
    s_cmp_lg_u32 s34, 0
    s_cbranch_scc1 K2_dum_100
    s_cmp_eq_u32 s33, 4
    s_cbranch_scc1 K2_a4_101
K2_b4_103:
    s_add_u32 m0, s48, 512
    s_add_u32 s65, s48, 1536
    buffer_load_dwordx4 v232, s[16:19], 0 offen  lds
    s_mov_b32 m0, s65
    s_mov_b32 exec_hi, 0
    buffer_load_dwordx4 v233, s[16:19], 0 offen  lds
    s_mov_b32 exec_hi, -1
K2_back_102:
    s_waitcnt lgkmcnt(2)
    v_mad_u32_u16 v222, v222, s39, v248 op_sel:[1,0,0,0]
    v_mad_u32_u16 v223, v223, s39, v248 op_sel:[1,0,0,0]
    s_waitcnt lgkmcnt(1)
    v_mad_u32_u16 v224, v224, s39, v248 op_sel:[1,0,0,0]
    v_mad_u32_u16 v225, v225, s39, v248 op_sel:[1,0,0,0]
    s_waitcnt lgkmcnt(0)
    v_mad_u32_u16 v226, v226, s39, v248 op_sel:[1,0,0,0]
    v_mad_u32_u16 v227, v227, s39, v248 op_sel:[1,0,0,0]
    s_waitcnt vmcnt(6)
    v_mfma_f32_32x32x16_bf16 v[0:15], v[64:67], v[176:179], 0
    ds_read_b64_tr_b16 v[184:185], v246 offset:2048
    ds_read_b64_tr_b16 v[186:187], v246 offset:3072
    ds_read_b64_tr_b16 v[188:189], v247 offset:2048
    ds_read_b64_tr_b16 v[190:191], v247 offset:3072
    s_mov_b32 m0, s68
    v_mfma_f32_32x32x16_bf16 v[16:31], v[68:71], v[176:179], 0
    buffer_load_dwordx4 v222, s[4:7], s44 offen sc1 lds
    buffer_load_dwordx4 v223, s[72:75], s44 offen offset:1024 sc1 lds
    v_permlane32_swap_b32 v242, v236
    v_permlane32_swap_b32 v243, v237
    v_mfma_f32_32x32x16_bf16 v[32:47], v[64:67], v[180:183], 0
    v_permlane32_swap_b32 v244, v238
    v_permlane32_swap_b32 v245, v239
    v_permlane32_swap_b32 v240, v241
    v_add_f32 v242, v242, v236
    v_mfma_f32_32x32x16_bf16 v[48:63], v[68:71], v[180:183], 0
    s_setprio 0
    v_add_f32 v243, v243, v237
    v_add_f32 v244, v244, v238
    v_add_f32 v245, v245, v239
    v_add_f32 v240, -v240, -v241
    s_set_gpr_idx_on s32, gpr_idx(DST)
    s_nop 0
    v_cvt_pk_bf16_f32 v195, v242, v243
    v_cvt_pk_bf16_f32 v196, v244, v245
    v_cvt_pk_bf16_f32 v197, v240, v240
    s_set_gpr_idx_off
    v_mul_f32 v234, v0, v96
    v_mul_f32 v236, v8, v128
    v_fmac_f32 v234, v1, v97
    v_fmac_f32 v236, v9, v129
    v_fmac_f32 v234, v2, v98
    v_fmac_f32 v236, v10, v130
    v_fmac_f32 v234, v3, v99
    v_fmac_f32 v236, v11, v131
    v_fmac_f32 v234, v4, v100
    v_fmac_f32 v236, v12, v132
    v_fmac_f32 v234, v5, v101
    v_fmac_f32 v236, v13, v133
    v_fmac_f32 v234, v6, v102
    v_fmac_f32 v236, v14, v134
    v_fmac_f32 v234, v7, v103
    v_fmac_f32 v236, v15, v135
    v_mul_f32 v238, v16, v128
    v_mul_f32 v240, v24, v128
    v_fmac_f32 v238, v17, v129
    v_fmac_f32 v240, v25, v129
    v_fmac_f32 v238, v18, v130
    v_fmac_f32 v240, v26, v130
    v_fmac_f32 v238, v19, v131
    v_fmac_f32 v240, v27, v131
    v_fmac_f32 v238, v20, v132
    v_fmac_f32 v240, v28, v132
    v_fmac_f32 v238, v21, v133
    v_fmac_f32 v240, v29, v133
    v_fmac_f32 v238, v22, v134
    v_fmac_f32 v240, v30, v134
    v_fmac_f32 v238, v23, v135
    v_fmac_f32 v240, v31, v135
    v_mul_f32 v235, v32, v104
    v_mul_f32 v237, v40, v136
    v_fmac_f32 v235, v33, v105
    v_fmac_f32 v237, v41, v137
    v_fmac_f32 v235, v34, v106
    v_fmac_f32 v237, v42, v138
    v_fmac_f32 v235, v35, v107
    v_fmac_f32 v237, v43, v139
    v_fmac_f32 v235, v36, v108
    v_fmac_f32 v237, v44, v140
    v_fmac_f32 v235, v37, v109
    v_fmac_f32 v237, v45, v141
    v_fmac_f32 v235, v38, v110
    v_fmac_f32 v237, v46, v142
    v_fmac_f32 v235, v39, v111
    v_fmac_f32 v237, v47, v143
    v_mul_f32 v239, v48, v136
    v_mul_f32 v241, v56, v136
    v_fmac_f32 v239, v49, v137
    v_fmac_f32 v241, v57, v137
    v_fmac_f32 v239, v50, v138
    v_fmac_f32 v241, v58, v138
    v_fmac_f32 v239, v51, v139
    v_fmac_f32 v241, v59, v139
    v_fmac_f32 v239, v52, v140
    v_fmac_f32 v241, v60, v140
    v_fmac_f32 v239, v53, v141
    v_fmac_f32 v241, v61, v141
    v_fmac_f32 v239, v54, v142
    v_fmac_f32 v241, v62, v142
    v_fmac_f32 v239, v55, v143
    v_fmac_f32 v241, v63, v143
    s_setprio 1
    s_waitcnt vmcnt(6) lgkmcnt(0)
    v_mfma_f32_32x32x16_bf16 v[0:15], v[64:67], v[184:187], 0
    ds_read_b64_tr_b16 v[176:177], v246 offset:4096
    ds_read_b64_tr_b16 v[178:179], v246 offset:5120
    ds_read_b64_tr_b16 v[180:181], v247 offset:4096
    ds_read_b64_tr_b16 v[182:183], v247 offset:5120
    s_mov_b32 m0, s69
    v_mfma_f32_32x32x16_bf16 v[16:31], v[68:71], v[184:187], 0
    buffer_load_dwordx4 v224, s[4:7], s45 offen sc1 lds
    buffer_load_dwordx4 v225, s[72:75], s45 offen offset:1024 sc1 lds
    v_permlane32_swap_b32 v234, v236
    v_permlane32_swap_b32 v235, v237
    v_mfma_f32_32x32x16_bf16 v[32:47], v[64:67], v[188:191], 0
    v_permlane32_swap_b32 v240, v238
    v_permlane32_swap_b32 v241, v239
    v_add_f32 v234, v234, v236
    v_add_f32 v235, v235, v237
    v_add_f32 v240, v240, v238
    v_mfma_f32_32x32x16_bf16 v[48:63], v[68:71], v[188:191], 0
    s_setprio 0
    v_add_f32 v241, v241, v239
    s_set_gpr_idx_on s31, gpr_idx(DST)
    s_nop 0
    v_cvt_pk_bf16_f32 v192, v234, v235
    v_cvt_pk_bf16_f32 v193, v240, v241
    s_set_gpr_idx_off
    v_mul_f32 v234, v0, v144
    v_mul_f32 v236, v8, v112
    v_fmac_f32 v234, v1, v145
    v_fmac_f32 v236, v9, v113
    v_fmac_f32 v234, v2, v146
    v_fmac_f32 v236, v10, v114
    v_fmac_f32 v234, v3, v147
    v_fmac_f32 v236, v11, v115
    v_fmac_f32 v234, v4, v148
    v_fmac_f32 v236, v12, v116
    v_fmac_f32 v234, v5, v149
    v_fmac_f32 v236, v13, v117
    v_fmac_f32 v234, v6, v150
    v_fmac_f32 v236, v14, v118
    v_fmac_f32 v234, v7, v151
    v_fmac_f32 v236, v15, v119
    v_mul_f32 v238, v16, v160
    v_mul_f32 v240, v24, v160
    v_fmac_f32 v238, v17, v161
    v_fmac_f32 v240, v25, v161
    v_fmac_f32 v238, v18, v162
    v_fmac_f32 v240, v26, v162
    v_fmac_f32 v238, v19, v163
    v_fmac_f32 v240, v27, v163
    v_fmac_f32 v238, v20, v164
    v_fmac_f32 v240, v28, v164
    v_fmac_f32 v238, v21, v165
    v_fmac_f32 v240, v29, v165
    v_fmac_f32 v238, v22, v166
    v_fmac_f32 v240, v30, v166
    v_fmac_f32 v238, v23, v167
    v_fmac_f32 v240, v31, v167
    v_mul_f32 v235, v32, v152
    v_mul_f32 v237, v40, v120
    v_fmac_f32 v235, v33, v153
    v_fmac_f32 v237, v41, v121
    v_fmac_f32 v235, v34, v154
    v_fmac_f32 v237, v42, v122
    v_fmac_f32 v235, v35, v155
    v_fmac_f32 v237, v43, v123
    v_fmac_f32 v235, v36, v156
    v_fmac_f32 v237, v44, v124
    v_fmac_f32 v235, v37, v157
    v_fmac_f32 v237, v45, v125
    v_fmac_f32 v235, v38, v158
    v_fmac_f32 v237, v46, v126
    v_fmac_f32 v235, v39, v159
    v_fmac_f32 v237, v47, v127
    v_mul_f32 v239, v48, v168
    v_mul_f32 v241, v56, v168
    v_fmac_f32 v239, v49, v169
    v_fmac_f32 v241, v57, v169
    v_fmac_f32 v239, v50, v170
    v_fmac_f32 v241, v58, v170
    v_fmac_f32 v239, v51, v171
    v_fmac_f32 v241, v59, v171
    v_fmac_f32 v239, v52, v172
    v_fmac_f32 v241, v60, v172
    v_fmac_f32 v239, v53, v173
    v_fmac_f32 v241, v61, v173
    v_fmac_f32 v239, v54, v174
    v_fmac_f32 v241, v62, v174
    v_fmac_f32 v239, v55, v175
    v_fmac_f32 v241, v63, v175
    s_setprio 1
    s_waitcnt vmcnt(6) lgkmcnt(0)
    v_mfma_f32_32x32x16_bf16 v[0:15], v[64:67], v[176:179], 0
    ds_read_b64_tr_b16 v[184:185], v246 offset:6144
    ds_read_b64_tr_b16 v[186:187], v246 offset:7168
    ds_read_b64_tr_b16 v[188:189], v247 offset:6144
    ds_read_b64_tr_b16 v[190:191], v247 offset:7168
    s_mov_b32 m0, s70
    v_mfma_f32_32x32x16_bf16 v[16:31], v[68:71], v[176:179], 0
    buffer_load_dwordx4 v226, s[4:7], s46 offen sc1 lds
    buffer_load_dwordx4 v227, s[72:75], s46 offen offset:1024 sc1 lds
    s_sub_u32 s26, s48, s29
    s_mov_b32 s29, s48
    s_mov_b32 s30, s3
    s_bfe_u32 s56, s3, 0x40012
    v_mfma_f32_32x32x16_bf16 v[32:47], v[64:67], v[180:183], 0
    s_cmp_eq_u32 s34, 0
    s_cselect_b32 s56, s56, 0
    v_mfma_f32_32x32x16_bf16 v[48:63], v[68:71], v[180:183], 0
    s_setprio 0
    v_mul_f32 v242, v0, v144
    v_fma_f32 v238, v8, v160, -v238
    v_fmac_f32 v242, v1, v145
    v_fmac_f32 v238, v9, v161
    v_fmac_f32 v242, v2, v146
    v_fmac_f32 v238, v10, v162
    v_fmac_f32 v242, v3, v147
    v_fmac_f32 v238, v11, v163
    v_fmac_f32 v242, v4, v148
    v_fmac_f32 v238, v12, v164
    v_fmac_f32 v242, v5, v149
    v_fmac_f32 v238, v13, v165
    v_fmac_f32 v242, v6, v150
    v_fmac_f32 v238, v14, v166
    v_fmac_f32 v242, v7, v151
    v_fmac_f32 v238, v15, v167
    v_fmac_f32 v236, v16, v112
    v_mul_f32 v244, v24, v160
    v_fmac_f32 v236, v17, v113
    v_fmac_f32 v244, v25, v161
    v_fmac_f32 v236, v18, v114
    v_fmac_f32 v244, v26, v162
    v_fmac_f32 v236, v19, v115
    v_fmac_f32 v244, v27, v163
    v_fmac_f32 v236, v20, v116
    v_fmac_f32 v244, v28, v164
    v_fmac_f32 v236, v21, v117
    v_fmac_f32 v244, v29, v165
    v_fmac_f32 v236, v22, v118
    v_fmac_f32 v244, v30, v166
    v_fmac_f32 v236, v23, v119
    v_fmac_f32 v244, v31, v167
    v_mul_f32 v243, v32, v152
    v_fma_f32 v239, v40, v168, -v239
    v_fmac_f32 v243, v33, v153
    v_fmac_f32 v239, v41, v169
    v_fmac_f32 v243, v34, v154
    v_fmac_f32 v239, v42, v170
    v_fmac_f32 v243, v35, v155
    v_fmac_f32 v239, v43, v171
    v_fmac_f32 v243, v36, v156
    v_fmac_f32 v239, v44, v172
    v_fmac_f32 v243, v37, v157
    v_fmac_f32 v239, v45, v173
    v_fmac_f32 v243, v38, v158
    v_fmac_f32 v239, v46, v174
    v_fmac_f32 v243, v39, v159
    v_fmac_f32 v239, v47, v175
    v_fmac_f32 v237, v48, v120
    v_mul_f32 v245, v56, v168
    v_fmac_f32 v237, v49, v121
    v_fmac_f32 v245, v57, v169
    v_fmac_f32 v237, v50, v122
    v_fmac_f32 v245, v58, v170
    v_fmac_f32 v237, v51, v123
    v_fmac_f32 v245, v59, v171
    v_fmac_f32 v237, v52, v124
    v_fmac_f32 v245, v60, v172
    v_fmac_f32 v237, v53, v125
    v_fmac_f32 v245, v61, v173
    v_fmac_f32 v237, v54, v126
    v_fmac_f32 v245, v62, v174
    v_fmac_f32 v237, v55, v127
    v_fmac_f32 v245, v63, v175
    s_setprio 1
    s_waitcnt vmcnt(4) lgkmcnt(0)
    v_mfma_f32_32x32x16_bf16 v[0:15], v[64:67], v[184:187], 0
    ds_read_b64_tr_b16 v[176:177], v246 offset:0
    ds_read_b64_tr_b16 v[178:179], v246 offset:1024
    ds_read_b64_tr_b16 v[180:181], v247 offset:0
    ds_read_b64_tr_b16 v[182:183], v247 offset:1024
    s_mov_b32 m0, s71
    v_mfma_f32_32x32x16_bf16 v[16:31], v[68:71], v[184:187], 0
    s_cmp_eq_u32 s33, 4
    s_cbranch_scc1 K2_g4_104
    buffer_load_dwordx4 v224, s[4:7], s47 offen sc1 lds
    buffer_load_dwordx4 v225, s[72:75], s47 offen offset:1024 sc1 lds
K2_back_105:
    v_permlane32_swap_b32 v242, v234
    v_mfma_f32_32x32x16_bf16 v[32:47], v[64:67], v[188:191], 0
    v_permlane32_swap_b32 v243, v235
    v_add_f32 v242, v242, v234
    v_add_f32 v243, v243, v235
    s_set_gpr_idx_on s31, gpr_idx(DST)
    s_nop 0
    v_cvt_pk_bf16_f32 v194, v242, v243
    s_set_gpr_idx_off
    s_mov_b32 s32, s31
    s_mov_b32 s31, s35
    v_mfma_f32_32x32x16_bf16 v[48:63], v[68:71], v[188:191], 0
    s_setprio 0
    v_mul_f32 v242, v0, v144
    v_fma_f32 v240, v8, v160, -v240
    v_fmac_f32 v242, v1, v145
    v_fmac_f32 v240, v9, v161
    v_fmac_f32 v242, v2, v146
    v_fmac_f32 v240, v10, v162
    v_fmac_f32 v242, v3, v147
    v_fmac_f32 v240, v11, v163
    v_fmac_f32 v242, v4, v148
    v_fmac_f32 v240, v12, v164
    v_fmac_f32 v242, v5, v149
    v_fmac_f32 v240, v13, v165
    v_fmac_f32 v242, v6, v150
    v_fmac_f32 v240, v14, v166
    v_fmac_f32 v242, v7, v151
    v_fmac_f32 v240, v15, v167
    v_add_u32 v249, s26, v249
    v_add_u32 v250, s26, v250
    v_fma_f32 v244, v16, v160, -v244
    v_fmac_f32 v236, v24, v112
    v_fmac_f32 v244, v17, v161
    v_fmac_f32 v236, v25, v113
    v_fmac_f32 v244, v18, v162
    v_fmac_f32 v236, v26, v114
    v_fmac_f32 v244, v19, v163
    v_fmac_f32 v236, v27, v115
    v_fmac_f32 v244, v20, v164
    v_fmac_f32 v236, v28, v116
    v_fmac_f32 v244, v21, v165
    v_fmac_f32 v236, v29, v117
    v_fmac_f32 v244, v22, v166
    v_fmac_f32 v236, v30, v118
    v_fmac_f32 v244, v23, v167
    v_fmac_f32 v236, v31, v119
    ds_read_b64_tr_b16 v[0:1], v249 offset:0
    ds_read_b64_tr_b16 v[2:3], v249 offset:32
    ds_read_u16_d16_hi v16, v250 offset:0
    v_mul_f32 v243, v32, v152
    v_fma_f32 v241, v40, v168, -v241
    v_fmac_f32 v243, v33, v153
    v_fmac_f32 v241, v41, v169
    v_fmac_f32 v243, v34, v154
    v_fmac_f32 v241, v42, v170
    v_fmac_f32 v243, v35, v155
    v_fmac_f32 v241, v43, v171
    v_fmac_f32 v243, v36, v156
    v_fmac_f32 v241, v44, v172
    v_fmac_f32 v243, v37, v157
    v_fmac_f32 v241, v45, v173
    v_fmac_f32 v243, v38, v158
    v_fmac_f32 v241, v46, v174
    v_fmac_f32 v243, v39, v159
    v_fmac_f32 v241, v47, v175
    ds_read_b64_tr_b16 v[4:5], v249 offset:512
    ds_read_b64_tr_b16 v[6:7], v249 offset:544
    ds_read_u16_d16_hi v17, v250 offset:128
    v_fma_f32 v245, v48, v168, -v245
    v_fmac_f32 v237, v56, v120
    v_fmac_f32 v245, v49, v169
    v_fmac_f32 v237, v57, v121
    v_fmac_f32 v245, v50, v170
    v_fmac_f32 v237, v58, v122
    v_fmac_f32 v245, v51, v171
    v_fmac_f32 v237, v59, v123
    v_fmac_f32 v245, v52, v172
    v_fmac_f32 v237, v60, v124
    v_fmac_f32 v245, v53, v173
    v_fmac_f32 v237, v61, v125
    v_fmac_f32 v245, v54, v174
    v_fmac_f32 v237, v62, v126
    v_fmac_f32 v245, v55, v175
    v_fmac_f32 v237, v63, v127
    s_cmp_eq_u32 s56, 5
    s_cbranch_scc1 K2_U20
    s_cmp_eq_u32 s56, 6
    s_cbranch_scc1 K2_U3h0
    s_branch K2_DSP0
K2_U40:
    s_setprio 1
    ds_read_b64_tr_b16 v[8:9], v249 offset:1024
    ds_read_b64_tr_b16 v[10:11], v249 offset:1056
    ds_read_u16_d16_hi v18, v250 offset:256
    s_lshr_b32 s65, s30, 28
    s_mul_i32 s66, s22, 2080
    s_lshl_b32 s65, s65, 9
    s_add_u32 s65, s65, s66
    s_add_u32 s65, s65, 65536
    s_sub_u32 s65, s65, s29
    s_sub_u32 s65, s65, 512
    v_add_u32 v56, s65, v249
    ds_read_b64_tr_b16 v[12:13], v56 offset:0
    ds_read_b64_tr_b16 v[14:15], v56 offset:32
    ds_read_u16_d16_hi v19, v250 offset:384
    s_waitcnt lgkmcnt(6)
    v_lshlrev_b32 v20, 16, v0
    v_and_b32 v21, 0xffff0000, v0
    v_lshlrev_b32 v22, 16, v1
    v_and_b32 v23, 0xffff0000, v1
    v_lshlrev_b32 v24, 16, v2
    v_and_b32 v25, 0xffff0000, v2
    v_lshlrev_b32 v26, 16, v3
    v_and_b32 v27, 0xffff0000, v3
    v_mul_f32_dpp v36, v16, v20 row_newbcast:8 row_mask:0xf bank_mask:0xf
    v_mul_f32_dpp v37, v16, v21 row_newbcast:9 row_mask:0xf bank_mask:0xf
    v_mul_f32_dpp v38, v16, v22 row_newbcast:10 row_mask:0xf bank_mask:0xf
    v_mul_f32_dpp v39, v16, v23 row_newbcast:11 row_mask:0xf bank_mask:0xf
    v_mul_f32_dpp v40, v16, v24 row_newbcast:12 row_mask:0xf bank_mask:0xf
    v_mul_f32_dpp v41, v16, v25 row_newbcast:13 row_mask:0xf bank_mask:0xf
    v_mul_f32_dpp v42, v16, v26 row_newbcast:14 row_mask:0xf bank_mask:0xf
    v_mul_f32_dpp v43, v16, v27 row_newbcast:15 row_mask:0xf bank_mask:0xf
    v_cvt_pk_bf16_f32 v68, v36, v37
    v_cvt_pk_bf16_f32 v69, v38, v39
    v_cvt_pk_bf16_f32 v70, v40, v41
    v_cvt_pk_bf16_f32 v71, v42, v43
    v_mul_f32_dpp v20, v16, v20 row_newbcast:0 row_mask:0xa bank_mask:0xf
    v_mul_f32_dpp v21, v16, v21 row_newbcast:1 row_mask:0xa bank_mask:0xf
    v_mul_f32_dpp v22, v16, v22 row_newbcast:2 row_mask:0xa bank_mask:0xf
    v_mul_f32_dpp v23, v16, v23 row_newbcast:3 row_mask:0xa bank_mask:0xf
    v_mul_f32_dpp v24, v16, v24 row_newbcast:4 row_mask:0xa bank_mask:0xf
    v_mul_f32_dpp v25, v16, v25 row_newbcast:5 row_mask:0xa bank_mask:0xf
    v_mul_f32_dpp v26, v16, v26 row_newbcast:6 row_mask:0xa bank_mask:0xf
    v_mul_f32_dpp v27, v16, v27 row_newbcast:7 row_mask:0xa bank_mask:0xf
    v_cvt_pk_bf16_f32 v64, v20, v21
    v_cvt_pk_bf16_f32 v65, v22, v23
    v_cvt_pk_bf16_f32 v66, v24, v25
    v_cvt_pk_bf16_f32 v67, v26, v27
    v_lshlrev_b32 v28, 16, v4
    v_and_b32 v29, 0xffff0000, v4
    v_lshlrev_b32 v30, 16, v5
    v_and_b32 v31, 0xffff0000, v5
    v_lshlrev_b32 v32, 16, v6
    v_and_b32 v33, 0xffff0000, v6
    v_lshlrev_b32 v34, 16, v7
    v_and_b32 v35, 0xffff0000, v7
    v_mul_f32_dpp v36, v17, v28 row_newbcast:8 row_mask:0xf bank_mask:0xf
    v_mul_f32_dpp v37, v17, v29 row_newbcast:9 row_mask:0xf bank_mask:0xf
    v_mul_f32_dpp v38, v17, v30 row_newbcast:10 row_mask:0xf bank_mask:0xf
    v_mul_f32_dpp v39, v17, v31 row_newbcast:11 row_mask:0xf bank_mask:0xf
    v_mul_f32_dpp v40, v17, v32 row_newbcast:12 row_mask:0xf bank_mask:0xf
    v_mul_f32_dpp v41, v17, v33 row_newbcast:13 row_mask:0xf bank_mask:0xf
    v_mul_f32_dpp v42, v17, v34 row_newbcast:14 row_mask:0xf bank_mask:0xf
    v_mul_f32_dpp v43, v17, v35 row_newbcast:15 row_mask:0xf bank_mask:0xf
    v_cvt_pk_bf16_f32 v76, v36, v37
    v_cvt_pk_bf16_f32 v77, v38, v39
    v_cvt_pk_bf16_f32 v78, v40, v41
    v_cvt_pk_bf16_f32 v79, v42, v43
    v_mul_f32_dpp v28, v17, v28 row_newbcast:0 row_mask:0xa bank_mask:0xf
    v_mul_f32_dpp v29, v17, v29 row_newbcast:1 row_mask:0xa bank_mask:0xf
    v_mul_f32_dpp v30, v17, v30 row_newbcast:2 row_mask:0xa bank_mask:0xf
    v_mul_f32_dpp v31, v17, v31 row_newbcast:3 row_mask:0xa bank_mask:0xf
    v_mul_f32_dpp v32, v17, v32 row_newbcast:4 row_mask:0xa bank_mask:0xf
    v_mul_f32_dpp v33, v17, v33 row_newbcast:5 row_mask:0xa bank_mask:0xf
    v_mul_f32_dpp v34, v17, v34 row_newbcast:6 row_mask:0xa bank_mask:0xf
    v_mul_f32_dpp v35, v17, v35 row_newbcast:7 row_mask:0xa bank_mask:0xf
    v_cvt_pk_bf16_f32 v72, v28, v29
    v_cvt_pk_bf16_f32 v73, v30, v31
    v_cvt_pk_bf16_f32 v74, v32, v33
    v_cvt_pk_bf16_f32 v75, v34, v35
    s_waitcnt lgkmcnt(3)
    v_lshlrev_b32 v20, 16, v8
    v_and_b32 v21, 0xffff0000, v8
    v_lshlrev_b32 v22, 16, v9
    v_and_b32 v23, 0xffff0000, v9
    v_lshlrev_b32 v24, 16, v10
    v_and_b32 v25, 0xffff0000, v10
    v_lshlrev_b32 v26, 16, v11
    v_and_b32 v27, 0xffff0000, v11
    v_mul_f32_dpp v36, v18, v20 row_newbcast:8 row_mask:0xf bank_mask:0xf
    v_mul_f32_dpp v37, v18, v21 row_newbcast:9 row_mask:0xf bank_mask:0xf
    v_mul_f32_dpp v38, v18, v22 row_newbcast:10 row_mask:0xf bank_mask:0xf
    v_mul_f32_dpp v39, v18, v23 row_newbcast:11 row_mask:0xf bank_mask:0xf
    v_mul_f32_dpp v40, v18, v24 row_newbcast:12 row_mask:0xf bank_mask:0xf
    v_mul_f32_dpp v41, v18, v25 row_newbcast:13 row_mask:0xf bank_mask:0xf
    v_mul_f32_dpp v42, v18, v26 row_newbcast:14 row_mask:0xf bank_mask:0xf
    v_mul_f32_dpp v43, v18, v27 row_newbcast:15 row_mask:0xf bank_mask:0xf
    v_cvt_pk_bf16_f32 v84, v36, v37
    v_cvt_pk_bf16_f32 v85, v38, v39
    v_cvt_pk_bf16_f32 v86, v40, v41
    v_cvt_pk_bf16_f32 v87, v42, v43
    v_mul_f32_dpp v20, v18, v20 row_newbcast:0 row_mask:0xa bank_mask:0xf
    v_mul_f32_dpp v21, v18, v21 row_newbcast:1 row_mask:0xa bank_mask:0xf
    v_mul_f32_dpp v22, v18, v22 row_newbcast:2 row_mask:0xa bank_mask:0xf
    v_mul_f32_dpp v23, v18, v23 row_newbcast:3 row_mask:0xa bank_mask:0xf
    v_mul_f32_dpp v24, v18, v24 row_newbcast:4 row_mask:0xa bank_mask:0xf
    v_mul_f32_dpp v25, v18, v25 row_newbcast:5 row_mask:0xa bank_mask:0xf
    v_mul_f32_dpp v26, v18, v26 row_newbcast:6 row_mask:0xa bank_mask:0xf
    v_mul_f32_dpp v27, v18, v27 row_newbcast:7 row_mask:0xa bank_mask:0xf
    v_cvt_pk_bf16_f32 v80, v20, v21
    v_cvt_pk_bf16_f32 v81, v22, v23
    v_cvt_pk_bf16_f32 v82, v24, v25
    v_cvt_pk_bf16_f32 v83, v26, v27
    s_waitcnt lgkmcnt(0)
    v_lshlrev_b32 v28, 16, v12
    v_and_b32 v29, 0xffff0000, v12
    v_lshlrev_b32 v30, 16, v13
    v_and_b32 v31, 0xffff0000, v13
    v_lshlrev_b32 v32, 16, v14
    v_and_b32 v33, 0xffff0000, v14
    v_lshlrev_b32 v34, 16, v15
    v_and_b32 v35, 0xffff0000, v15
    v_mul_f32_dpp v36, v19, v28 row_newbcast:8 row_mask:0xf bank_mask:0xf
    v_mul_f32_dpp v37, v19, v29 row_newbcast:9 row_mask:0xf bank_mask:0xf
    v_mul_f32_dpp v38, v19, v30 row_newbcast:10 row_mask:0xf bank_mask:0xf
    v_mul_f32_dpp v39, v19, v31 row_newbcast:11 row_mask:0xf bank_mask:0xf
    v_mul_f32_dpp v40, v19, v32 row_newbcast:12 row_mask:0xf bank_mask:0xf
    v_mul_f32_dpp v41, v19, v33 row_newbcast:13 row_mask:0xf bank_mask:0xf
    v_mul_f32_dpp v42, v19, v34 row_newbcast:14 row_mask:0xf bank_mask:0xf
    v_mul_f32_dpp v43, v19, v35 row_newbcast:15 row_mask:0xf bank_mask:0xf
    v_cvt_pk_bf16_f32 v92, v36, v37
    v_cvt_pk_bf16_f32 v93, v38, v39
    v_cvt_pk_bf16_f32 v94, v40, v41
    v_cvt_pk_bf16_f32 v95, v42, v43
    v_mul_f32_dpp v28, v19, v28 row_newbcast:0 row_mask:0xa bank_mask:0xf
    v_mul_f32_dpp v29, v19, v29 row_newbcast:1 row_mask:0xa bank_mask:0xf
    v_mul_f32_dpp v30, v19, v30 row_newbcast:2 row_mask:0xa bank_mask:0xf
    v_mul_f32_dpp v31, v19, v31 row_newbcast:3 row_mask:0xa bank_mask:0xf
    v_mul_f32_dpp v32, v19, v32 row_newbcast:4 row_mask:0xa bank_mask:0xf
    v_mul_f32_dpp v33, v19, v33 row_newbcast:5 row_mask:0xa bank_mask:0xf
    v_mul_f32_dpp v34, v19, v34 row_newbcast:6 row_mask:0xa bank_mask:0xf
    v_mul_f32_dpp v35, v19, v35 row_newbcast:7 row_mask:0xa bank_mask:0xf
    v_cvt_pk_bf16_f32 v88, v28, v29
    v_cvt_pk_bf16_f32 v89, v30, v31
    v_cvt_pk_bf16_f32 v90, v32, v33
    v_cvt_pk_bf16_f32 v91, v34, v35
    s_waitcnt vmcnt(4)
    v_mfma_f32_32x32x16_bf16 v[0:15], v[64:67], v[176:179], 0
    ds_read_b64_tr_b16 v[184:185], v246 offset:2048
    ds_read_b64_tr_b16 v[186:187], v246 offset:3072
    ds_read_b64_tr_b16 v[188:189], v247 offset:2048
    ds_read_b64_tr_b16 v[190:191], v247 offset:3072
    s_mov_b32 m0, s68
    v_mfma_f32_32x32x16_bf16 v[16:31], v[68:71], v[176:179], 0
    buffer_load_dwordx4 v222, s[4:7], s41 offen sc1 lds
    buffer_load_dwordx4 v223, s[72:75], s41 offen offset:1024 sc1 lds
    v_permlane32_swap_b32 v242, v236
    v_permlane32_swap_b32 v243, v237
    s_add_u32 s38, s38, 1
    v_mfma_f32_32x32x16_bf16 v[32:47], v[64:67], v[180:183], 0
    v_permlane32_swap_b32 v244, v238
    v_permlane32_swap_b32 v245, v239
    v_permlane32_swap_b32 v240, v241
    v_add_f32 v242, v242, v236
    v_mfma_f32_32x32x16_bf16 v[48:63], v[68:71], v[180:183], 0
    v_add_f32 v243, v243, v237
    v_add_f32 v244, v244, v238
    v_add_f32 v245, v245, v239
    v_add_f32 v240, -v240, -v241
    v_mov_b32 v254, s52
    v_mov_b32 v255, s38
    s_waitcnt vmcnt(4) lgkmcnt(0)
    v_mfma_f32_32x32x16_bf16 v[0:15], v[72:75], v[184:187], v[0:15]
    ds_read_b64_tr_b16 v[176:177], v246 offset:4096
    ds_read_b64_tr_b16 v[178:179], v246 offset:5120
    ds_read_b64_tr_b16 v[180:181], v247 offset:4096
    ds_read_b64_tr_b16 v[182:183], v247 offset:5120
    s_lshl_b32 s58, s38, 3
    s_add_u32 s58, s58, s20
    s_mov_b32 m0, s69
    v_mfma_f32_32x32x16_bf16 v[16:31], v[76:79], v[184:187], v[16:31]
    buffer_load_dwordx4 v224, s[4:7], s41 offen sc1 lds
    buffer_load_dwordx4 v225, s[72:75], s41 offen offset:1024 sc1 lds
    s_set_gpr_idx_on s32, gpr_idx(DST)
    s_nop 0
    v_cvt_pk_bf16_f32 v195, v242, v243
    v_cvt_pk_bf16_f32 v196, v244, v245
    v_cvt_pk_bf16_f32 v197, v240, v240
    s_set_gpr_idx_off
    s_mov_b64 exec, 1
    ds_write_b32 v254, v255
    s_mov_b64 exec, -1
    s_cmp_lt_u32 s58, s22
    s_cbranch_scc0 K2_dyn_106
K2_back_107:
    v_readlane_b32 s3, v253, s58
    s_lshl_b32 s44, s34, 7
    s_and_b32 s48, s3, 0x3ffff
    s_bfe_u32 s33, s3, 0x30013
    s_mul_i32 s35, s38, 6
    s_cmp_eq_u32 s34, 0
    s_cselect_b32 s35, s35, s48
    s_mov_b32 s45, s44
    s_xor_b32 s47, s44, 256
    s_add_u32 s49, s48, 128
    s_add_u32 s60, s48, 256
    s_cmp_eq_u32 s33, 3
    s_cselect_b32 s46, s44, s47
    s_cselect_b32 s50, s60, s48
    s_sub_u32 s60, s33, 2
    s_cmp_lt_u32 s60, 2
    s_cbranch_scc0 K2_rare_112
K2_back_113:
    v_mfma_f32_32x32x16_bf16 v[32:47], v[72:75], v[188:191], v[32:47]
    v_add_u32 v233, s48, v230
    ds_read_b32 v232, v233
    ds_read_b32 v233, v233 offset:1024
    v_mfma_f32_32x32x16_bf16 v[48:63], v[76:79], v[188:191], v[48:63]
    s_waitcnt vmcnt(4) lgkmcnt(3)
    v_mfma_f32_32x32x16_bf16 v[0:15], v[80:83], v[176:179], v[0:15]
    ds_read_b64_tr_b16 v[184:185], v246 offset:6144
    ds_read_b64_tr_b16 v[186:187], v246 offset:7168
    ds_read_b64_tr_b16 v[188:189], v247 offset:6144
    ds_read_b64_tr_b16 v[190:191], v247 offset:7168
    s_mov_b32 m0, s70
    v_mfma_f32_32x32x16_bf16 v[16:31], v[84:87], v[176:179], v[16:31]
    buffer_load_dwordx4 v226, s[4:7], s41 offen sc1 lds
    buffer_load_dwordx4 v227, s[72:75], s41 offen offset:1024 sc1 lds
    v_mfma_f32_32x32x16_bf16 v[32:47], v[80:83], v[180:183], v[32:47]
    v_mfma_f32_32x32x16_bf16 v[48:63], v[84:87], v[180:183], v[48:63]
    s_waitcnt lgkmcnt(4)
    v_or_b32 v232, v232, v231
    v_or_b32 v233, v233, v231
    s_cmp_lg_u32 s34, 0
    s_cbranch_scc1 K2_dum_117
    s_cmp_eq_u32 s33, 4
    s_cbranch_scc1 K2_a4_118
K2_b4_120:
    s_add_u32 m0, s48, 512
    s_add_u32 s65, s48, 1536
    buffer_load_dwordx4 v232, s[16:19], 0 offen  lds
    s_mov_b32 m0, s65
    s_mov_b32 exec_hi, 0
    buffer_load_dwordx4 v233, s[16:19], 0 offen  lds
    s_mov_b32 exec_hi, -1
K2_back_119:
    s_waitcnt vmcnt(6) lgkmcnt(0)
    v_mfma_f32_32x32x16_bf16 v[0:15], v[88:91], v[184:187], v[0:15]
    ds_read_b64_tr_b16 v[176:177], v246 offset:0
    ds_read_b64_tr_b16 v[178:179], v246 offset:1024
    ds_read_b64_tr_b16 v[180:181], v247 offset:0
    ds_read_b64_tr_b16 v[182:183], v247 offset:1024
    s_mov_b32 m0, s71
    v_mfma_f32_32x32x16_bf16 v[16:31], v[92:95], v[184:187], v[16:31]
    buffer_load_dwordx4 v228, s[4:7], s41 offen sc1 lds
    buffer_load_dwordx4 v229, s[72:75], s41 offen offset:1024 sc1 lds
    v_mfma_f32_32x32x16_bf16 v[32:47], v[88:91], v[188:191], v[32:47]
    s_nop 2
    v_mul_f32 v234, v0, v96
    v_mul_f32 v236, v8, v128
    v_fmac_f32 v234, v1, v97
    v_fmac_f32 v236, v9, v129
    v_fmac_f32 v234, v2, v98
    v_fmac_f32 v236, v10, v130
    v_fmac_f32 v234, v3, v99
    v_mfma_f32_32x32x16_bf16 v[48:63], v[92:95], v[188:191], v[48:63]
    s_setprio 0
    v_fmac_f32 v236, v11, v131
    v_fmac_f32 v234, v4, v100
    v_fmac_f32 v236, v12, v132
    v_fmac_f32 v234, v5, v101
    v_fmac_f32 v236, v13, v133
    v_fmac_f32 v234, v6, v102
    v_fmac_f32 v236, v14, v134
    v_fmac_f32 v234, v7, v103
    v_fmac_f32 v236, v15, v135
    v_mul_f32 v238, v16, v128
    v_mul_f32 v240, v24, v128
    v_fmac_f32 v238, v17, v129
    v_fmac_f32 v240, v25, v129
    v_fmac_f32 v238, v18, v130
    v_fmac_f32 v240, v26, v130
    v_fmac_f32 v238, v19, v131
    v_fmac_f32 v240, v27, v131
    v_fmac_f32 v238, v20, v132
    v_fmac_f32 v240, v28, v132
    v_fmac_f32 v238, v21, v133
    v_fmac_f32 v240, v29, v133
    v_fmac_f32 v238, v22, v134
    v_fmac_f32 v240, v30, v134
    v_fmac_f32 v238, v23, v135
    v_fmac_f32 v240, v31, v135
    v_mul_f32 v235, v32, v104
    v_mul_f32 v237, v40, v136
    v_fmac_f32 v235, v33, v105
    v_fmac_f32 v237, v41, v137
    v_fmac_f32 v235, v34, v106
    v_fmac_f32 v237, v42, v138
    v_fmac_f32 v235, v35, v107
    v_fmac_f32 v237, v43, v139
    v_fmac_f32 v235, v36, v108
    v_fmac_f32 v237, v44, v140
    v_fmac_f32 v235, v37, v109
    v_fmac_f32 v237, v45, v141
    v_fmac_f32 v235, v38, v110
    v_fmac_f32 v237, v46, v142
    v_fmac_f32 v235, v39, v111
    v_fmac_f32 v237, v47, v143
    v_mul_f32 v239, v48, v136
    v_mul_f32 v241, v56, v136
    s_setprio 1
    s_waitcnt vmcnt(6) lgkmcnt(0)
    v_mfma_f32_32x32x16_bf16 v[0:15], v[64:67], v[176:179], 0
    ds_read_b64_tr_b16 v[184:185], v246 offset:2048
    ds_read_b64_tr_b16 v[186:187], v246 offset:3072
    ds_read_b64_tr_b16 v[188:189], v247 offset:2048
    ds_read_b64_tr_b16 v[190:191], v247 offset:3072
    v_fmac_f32 v239, v49, v137
    v_fmac_f32 v241, v57, v137
    s_mov_b32 m0, s68
    v_mfma_f32_32x32x16_bf16 v[16:31], v[68:71], v[176:179], 0
    buffer_load_dwordx4 v222, s[4:7], s42 offen sc1 lds
    buffer_load_dwordx4 v223, s[72:75], s42 offen offset:1024 sc1 lds
    v_fmac_f32 v239, v50, v138
    v_fmac_f32 v241, v58, v138
    v_fmac_f32 v239, v51, v139
    v_fmac_f32 v241, v59, v139
    v_fmac_f32 v239, v52, v140
    v_mfma_f32_32x32x16_bf16 v[32:47], v[64:67], v[180:183], 0
    v_fmac_f32 v241, v60, v140
    v_fmac_f32 v239, v53, v141
    v_fmac_f32 v241, v61, v141
    v_fmac_f32 v239, v54, v142
    v_fmac_f32 v241, v62, v142
    v_fmac_f32 v239, v55, v143
    v_fmac_f32 v241, v63, v143
    v_mfma_f32_32x32x16_bf16 v[48:63], v[68:71], v[180:183], 0
    v_permlane32_swap_b32 v234, v236
    v_permlane32_swap_b32 v235, v237
    v_permlane32_swap_b32 v240, v238
    s_waitcnt vmcnt(6) lgkmcnt(0)
    v_mfma_f32_32x32x16_bf16 v[0:15], v[72:75], v[184:187], v[0:15]
    ds_read_b64_tr_b16 v[176:177], v246 offset:4096
    ds_read_b64_tr_b16 v[178:179], v246 offset:5120
    ds_read_b64_tr_b16 v[180:181], v247 offset:4096
    ds_read_b64_tr_b16 v[182:183], v247 offset:5120
    v_permlane32_swap_b32 v241, v239
    s_mov_b32 m0, s69
    v_mfma_f32_32x32x16_bf16 v[16:31], v[76:79], v[184:187], v[16:31]
    buffer_load_dwordx4 v224, s[4:7], s42 offen sc1 lds
    buffer_load_dwordx4 v225, s[72:75], s42 offen offset:1024 sc1 lds
    v_add_f32 v234, v234, v236
    v_add_f32 v235, v235, v237
    v_add_f32 v240, v240, v238
    v_add_f32 v241, v241, v239
    v_mfma_f32_32x32x16_bf16 v[32:47], v[72:75], v[188:191], v[32:47]
    s_set_gpr_idx_on s31, gpr_idx(DST)
    s_nop 0
    v_cvt_pk_bf16_f32 v192, v234, v235
    v_cvt_pk_bf16_f32 v193, v240, v241
    s_set_gpr_idx_off
    v_mfma_f32_32x32x16_bf16 v[48:63], v[76:79], v[188:191], v[48:63]
    s_waitcnt vmcnt(4) lgkmcnt(0)
    v_mfma_f32_32x32x16_bf16 v[0:15], v[80:83], v[176:179], v[0:15]
    ds_read_b64_tr_b16 v[184:185], v246 offset:6144
    ds_read_b64_tr_b16 v[186:187], v246 offset:7168
    ds_read_b64_tr_b16 v[188:189], v247 offset:6144
    ds_read_b64_tr_b16 v[190:191], v247 offset:7168
    s_mov_b32 m0, s70
    v_mfma_f32_32x32x16_bf16 v[16:31], v[84:87], v[176:179], v[16:31]
    buffer_load_dwordx4 v226, s[4:7], s42 offen sc1 lds
    buffer_load_dwordx4 v227, s[72:75], s42 offen offset:1024 sc1 lds
    v_mfma_f32_32x32x16_bf16 v[32:47], v[80:83], v[180:183], v[32:47]
    v_mfma_f32_32x32x16_bf16 v[48:63], v[84:87], v[180:183], v[48:63]
    s_waitcnt vmcnt(4) lgkmcnt(0)
    v_mfma_f32_32x32x16_bf16 v[0:15], v[88:91], v[184:187], v[0:15]
    ds_read_b64_tr_b16 v[176:177], v246 offset:0
    ds_read_b64_tr_b16 v[178:179], v246 offset:1024
    ds_read_b64_tr_b16 v[180:181], v247 offset:0
    ds_read_b64_tr_b16 v[182:183], v247 offset:1024
    s_mov_b32 m0, s71
    v_mfma_f32_32x32x16_bf16 v[16:31], v[92:95], v[184:187], v[16:31]
    buffer_load_dwordx4 v228, s[4:7], s42 offen sc1 lds
    buffer_load_dwordx4 v229, s[72:75], s42 offen offset:1024 sc1 lds
    v_mfma_f32_32x32x16_bf16 v[32:47], v[88:91], v[188:191], v[32:47]
    s_nop 2
    v_mul_f32 v234, v0, v144
    v_mul_f32 v236, v8, v112
    v_fmac_f32 v234, v1, v145
    v_fmac_f32 v236, v9, v113
    v_fmac_f32 v234, v2, v146
    v_fmac_f32 v236, v10, v114
    v_fmac_f32 v234, v3, v147
    v_mfma_f32_32x32x16_bf16 v[48:63], v[92:95], v[188:191], v[48:63]
    s_setprio 0
    v_fmac_f32 v236, v11, v115
    v_fmac_f32 v234, v4, v148
    v_fmac_f32 v236, v12, v116
    v_fmac_f32 v234, v5, v149
    v_fmac_f32 v236, v13, v117
    v_fmac_f32 v234, v6, v150
    v_fmac_f32 v236, v14, v118
    v_fmac_f32 v234, v7, v151
    v_fmac_f32 v236, v15, v119
    v_mul_f32 v238, v16, v160
    v_mul_f32 v240, v24, v160
    v_fmac_f32 v238, v17, v161
    v_fmac_f32 v240, v25, v161
    v_fmac_f32 v238, v18, v162
    v_fmac_f32 v240, v26, v162
    v_fmac_f32 v238, v19, v163
    v_fmac_f32 v240, v27, v163
    v_fmac_f32 v238, v20, v164
    v_fmac_f32 v240, v28, v164
    v_fmac_f32 v238, v21, v165
    v_fmac_f32 v240, v29, v165
    v_fmac_f32 v238, v22, v166
    v_fmac_f32 v240, v30, v166
    v_fmac_f32 v238, v23, v167
    v_fmac_f32 v240, v31, v167
    v_mul_f32 v235, v32, v152
    v_mul_f32 v237, v40, v120
    v_fmac_f32 v235, v33, v153
    v_fmac_f32 v237, v41, v121
    v_fmac_f32 v235, v34, v154
    v_fmac_f32 v237, v42, v122
    v_fmac_f32 v235, v35, v155
    v_fmac_f32 v237, v43, v123
    v_fmac_f32 v235, v36, v156
    v_fmac_f32 v237, v44, v124
    v_fmac_f32 v235, v37, v157
    v_fmac_f32 v237, v45, v125
    v_fmac_f32 v235, v38, v158
    v_fmac_f32 v237, v46, v126
    v_fmac_f32 v235, v39, v159
    v_fmac_f32 v237, v47, v127
    v_mul_f32 v239, v48, v168
    v_mul_f32 v241, v56, v168
    s_setprio 1
    s_waitcnt vmcnt(4) lgkmcnt(0)
    v_mfma_f32_32x32x16_bf16 v[0:15], v[64:67], v[176:179], 0
    ds_read_b64_tr_b16 v[184:185], v246 offset:2048
    ds_read_b64_tr_b16 v[186:187], v246 offset:3072
    ds_read_b64_tr_b16 v[188:189], v247 offset:2048
    ds_read_b64_tr_b16 v[190:191], v247 offset:3072
    v_fmac_f32 v239, v49, v169
    v_fmac_f32 v241, v57, v169
    s_mov_b32 m0, s68
    v_mfma_f32_32x32x16_bf16 v[16:31], v[68:71], v[176:179], 0
    buffer_load_dwordx4 v222, s[4:7], s43 offen sc1 lds
    buffer_load_dwordx4 v223, s[72:75], s43 offen offset:1024 sc1 lds
    v_fmac_f32 v239, v50, v170
    v_fmac_f32 v241, v58, v170
    v_fmac_f32 v239, v51, v171
    v_fmac_f32 v241, v59, v171
    v_fmac_f32 v239, v52, v172
    v_mfma_f32_32x32x16_bf16 v[32:47], v[64:67], v[180:183], 0
    v_fmac_f32 v241, v60, v172
    v_fmac_f32 v239, v53, v173
    v_fmac_f32 v241, v61, v173
    v_fmac_f32 v239, v54, v174
    v_fmac_f32 v241, v62, v174
    v_fmac_f32 v239, v55, v175
    v_fmac_f32 v241, v63, v175
    v_mfma_f32_32x32x16_bf16 v[48:63], v[68:71], v[180:183], 0
    s_waitcnt vmcnt(4) lgkmcnt(0)
    v_mfma_f32_32x32x16_bf16 v[0:15], v[72:75], v[184:187], v[0:15]
    ds_read_b64_tr_b16 v[176:177], v246 offset:4096
    ds_read_b64_tr_b16 v[178:179], v246 offset:5120
    ds_read_b64_tr_b16 v[180:181], v247 offset:4096
    ds_read_b64_tr_b16 v[182:183], v247 offset:5120
    s_mov_b32 m0, s69
    v_mfma_f32_32x32x16_bf16 v[16:31], v[76:79], v[184:187], v[16:31]
    buffer_load_dwordx4 v224, s[4:7], s43 offen sc1 lds
    buffer_load_dwordx4 v225, s[72:75], s43 offen offset:1024 sc1 lds
    v_mfma_f32_32x32x16_bf16 v[32:47], v[72:75], v[188:191], v[32:47]
    v_mfma_f32_32x32x16_bf16 v[48:63], v[76:79], v[188:191], v[48:63]
    s_waitcnt vmcnt(4) lgkmcnt(0)
    v_mfma_f32_32x32x16_bf16 v[0:15], v[80:83], v[176:179], v[0:15]
    ds_read_b64_tr_b16 v[184:185], v246 offset:6144
    ds_read_b64_tr_b16 v[186:187], v246 offset:7168
    ds_read_b64_tr_b16 v[188:189], v247 offset:6144
    ds_read_b64_tr_b16 v[190:191], v247 offset:7168
    s_mov_b32 m0, s70
    v_mfma_f32_32x32x16_bf16 v[16:31], v[84:87], v[176:179], v[16:31]
    buffer_load_dwordx4 v226, s[4:7], s43 offen sc1 lds
    buffer_load_dwordx4 v227, s[72:75], s43 offen offset:1024 sc1 lds
    v_mfma_f32_32x32x16_bf16 v[32:47], v[80:83], v[180:183], v[32:47]
    v_add_u32 v222, s48, v251
    ds_read2_b32 v[222:223], v222 offset0:1 offset1:3
    v_mfma_f32_32x32x16_bf16 v[48:63], v[84:87], v[180:183], v[48:63]
    s_waitcnt vmcnt(4) lgkmcnt(1)
    v_mfma_f32_32x32x16_bf16 v[0:15], v[88:91], v[184:187], v[0:15]
    ds_read_b64_tr_b16 v[176:177], v246 offset:0
    ds_read_b64_tr_b16 v[178:179], v246 offset:1024
    ds_read_b64_tr_b16 v[180:181], v247 offset:0
    ds_read_b64_tr_b16 v[182:183], v247 offset:1024
    s_mov_b32 m0, s71
    v_mfma_f32_32x32x16_bf16 v[16:31], v[92:95], v[184:187], v[16:31]
    buffer_load_dwordx4 v228, s[4:7], s43 offen sc1 lds
    buffer_load_dwordx4 v229, s[72:75], s43 offen offset:1024 sc1 lds
    s_waitcnt lgkmcnt(4)
    v_mad_u32_u16 v222, v222, s39, v248 op_sel:[1,0,0,0]
    v_mad_u32_u16 v223, v223, s39, v248 op_sel:[1,0,0,0]
    v_mfma_f32_32x32x16_bf16 v[32:47], v[88:91], v[188:191], v[32:47]
    v_add_u32 v224, s49, v251
    ds_read2_b32 v[224:225], v224 offset0:1 offset1:3
    v_mul_f32 v242, v0, v144
    v_fma_f32 v238, v8, v160, -v238
    v_fmac_f32 v242, v1, v145
    v_fmac_f32 v238, v9, v161
    v_fmac_f32 v242, v2, v146
    v_mfma_f32_32x32x16_bf16 v[48:63], v[92:95], v[188:191], v[48:63]
    s_setprio 0
    v_fmac_f32 v238, v10, v162
    v_fmac_f32 v242, v3, v147
    v_fmac_f32 v238, v11, v163
    v_fmac_f32 v242, v4, v148
    v_fmac_f32 v238, v12, v164
    v_fmac_f32 v242, v5, v149
    v_fmac_f32 v238, v13, v165
    v_fmac_f32 v242, v6, v150
    v_fmac_f32 v238, v14, v166
    v_fmac_f32 v242, v7, v151
    v_fmac_f32 v238, v15, v167
    v_fmac_f32 v236, v16, v112
    v_mul_f32 v244, v24, v160
    v_fmac_f32 v236, v17, v113
    v_fmac_f32 v244, v25, v161
    v_fmac_f32 v236, v18, v114
    v_fmac_f32 v244, v26, v162
    v_fmac_f32 v236, v19, v115
    v_fmac_f32 v244, v27, v163
    v_fmac_f32 v236, v20, v116
    v_fmac_f32 v244, v28, v164
    v_fmac_f32 v236, v21, v117
    v_fmac_f32 v244, v29, v165
    v_fmac_f32 v236, v22, v118
    v_fmac_f32 v244, v30, v166
    v_fmac_f32 v236, v23, v119
    v_fmac_f32 v244, v31, v167
    v_mul_f32 v243, v32, v152
    v_fma_f32 v239, v40, v168, -v239
    v_fmac_f32 v243, v33, v153
    v_fmac_f32 v239, v41, v169
    v_fmac_f32 v243, v34, v154
    v_fmac_f32 v239, v42, v170
    v_fmac_f32 v243, v35, v155
    v_fmac_f32 v239, v43, v171
    v_fmac_f32 v243, v36, v156
    v_fmac_f32 v239, v44, v172
    v_fmac_f32 v243, v37, v157
    v_fmac_f32 v239, v45, v173
    v_fmac_f32 v243, v38, v158
    v_fmac_f32 v239, v46, v174
    v_fmac_f32 v243, v39, v159
    v_fmac_f32 v239, v47, v175
    v_fmac_f32 v237, v48, v120
    v_mul_f32 v245, v56, v168
    v_fmac_f32 v237, v49, v121
    v_fmac_f32 v245, v57, v169
    v_fmac_f32 v237, v50, v122
    v_fmac_f32 v245, v58, v170
    v_fmac_f32 v237, v51, v123
    s_setprio 1
    s_waitcnt vmcnt(4) lgkmcnt(1)
    v_mfma_f32_32x32x16_bf16 v[0:15], v[64:67], v[176:179], 0
    ds_read_b64_tr_b16 v[184:185], v246 offset:2048
    ds_read_b64_tr_b16 v[186:187], v246 offset:3072
    ds_read_b64_tr_b16 v[188:189], v247 offset:2048
    ds_read_b64_tr_b16 v[190:191], v247 offset:3072
    v_fmac_f32 v245, v59, v171
    v_fmac_f32 v237, v52, v124
    s_mov_b32 m0, s68
    v_mfma_f32_32x32x16_bf16 v[16:31], v[68:71], v[176:179], 0
    buffer_load_dwordx4 v222, s[4:7], s44 offen sc1 lds
    buffer_load_dwordx4 v223, s[72:75], s44 offen offset:1024 sc1 lds
    s_waitcnt lgkmcnt(4)
    v_mad_u32_u16 v224, v224, s39, v248 op_sel:[1,0,0,0]
    v_mad_u32_u16 v225, v225, s39, v248 op_sel:[1,0,0,0]
    v_fmac_f32 v245, v60, v172
    v_fmac_f32 v237, v53, v125
    v_mfma_f32_32x32x16_bf16 v[32:47], v[64:67], v[180:183], 0
    v_add_u32 v226, s50, v251
    ds_read2_b32 v[226:227], v226 offset0:1 offset1:3
    v_fmac_f32 v245, v61, v173
    v_fmac_f32 v237, v54, v126
    v_fmac_f32 v245, v62, v174
    v_fmac_f32 v237, v55, v127
    v_fmac_f32 v245, v63, v175
    v_mfma_f32_32x32x16_bf16 v[48:63], v[68:71], v[180:183], 0
    v_permlane32_swap_b32 v242, v234
    v_permlane32_swap_b32 v243, v235
    v_add_f32 v242, v242, v234
    v_add_f32 v243, v243, v235
    s_waitcnt vmcnt(4) lgkmcnt(1)
    v_mfma_f32_32x32x16_bf16 v[0:15], v[72:75], v[184:187], v[0:15]
    ds_read_b64_tr_b16 v[176:177], v246 offset:4096
    ds_read_b64_tr_b16 v[178:179], v246 offset:5120
    ds_read_b64_tr_b16 v[180:181], v247 offset:4096
    ds_read_b64_tr_b16 v[182:183], v247 offset:5120
    s_mov_b32 m0, s69
    v_mfma_f32_32x32x16_bf16 v[16:31], v[76:79], v[184:187], v[16:31]
    buffer_load_dwordx4 v224, s[4:7], s45 offen sc1 lds
    buffer_load_dwordx4 v225, s[72:75], s45 offen offset:1024 sc1 lds
    s_waitcnt lgkmcnt(4)
    v_mad_u32_u16 v226, v226, s39, v248 op_sel:[1,0,0,0]
    v_mad_u32_u16 v227, v227, s39, v248 op_sel:[1,0,0,0]
    v_mfma_f32_32x32x16_bf16 v[32:47], v[72:75], v[188:191], v[32:47]
    s_set_gpr_idx_on s31, gpr_idx(DST)
    s_nop 0
    v_cvt_pk_bf16_f32 v194, v242, v243
    s_set_gpr_idx_off
    v_mfma_f32_32x32x16_bf16 v[48:63], v[76:79], v[188:191], v[48:63]
    s_waitcnt vmcnt(4) lgkmcnt(0)
    v_mfma_f32_32x32x16_bf16 v[0:15], v[80:83], v[176:179], v[0:15]
    ds_read_b64_tr_b16 v[184:185], v246 offset:6144
    ds_read_b64_tr_b16 v[186:187], v246 offset:7168
    ds_read_b64_tr_b16 v[188:189], v247 offset:6144
    ds_read_b64_tr_b16 v[190:191], v247 offset:7168
    s_mov_b32 s32, s31
    s_mov_b32 s31, s35
    s_mov_b32 m0, s70
    v_mfma_f32_32x32x16_bf16 v[16:31], v[84:87], v[176:179], v[16:31]
    buffer_load_dwordx4 v226, s[4:7], s46 offen sc1 lds
    buffer_load_dwordx4 v227, s[72:75], s46 offen offset:1024 sc1 lds
    s_sub_u32 s26, s48, s29
    s_mov_b32 s29, s48
    s_mov_b32 s30, s3
    s_bfe_u32 s56, s3, 0x40012
    v_mfma_f32_32x32x16_bf16 v[32:47], v[80:83], v[180:183], v[32:47]
    s_cmp_eq_u32 s34, 0
    s_cselect_b32 s56, s56, 0
    v_mfma_f32_32x32x16_bf16 v[48:63], v[84:87], v[180:183], v[48:63]
    s_waitcnt vmcnt(4) lgkmcnt(0)
    v_mfma_f32_32x32x16_bf16 v[0:15], v[88:91], v[184:187], v[0:15]
    ds_read_b64_tr_b16 v[176:177], v246 offset:0
    ds_read_b64_tr_b16 v[178:179], v246 offset:1024
    ds_read_b64_tr_b16 v[180:181], v247 offset:0
    ds_read_b64_tr_b16 v[182:183], v247 offset:1024
    s_mov_b32 m0, s71
    v_mfma_f32_32x32x16_bf16 v[16:31], v[92:95], v[184:187], v[16:31]
    s_cmp_eq_u32 s33, 4
    s_cbranch_scc1 K2_g4_115
    buffer_load_dwordx4 v224, s[4:7], s47 offen sc1 lds
    buffer_load_dwordx4 v225, s[72:75], s47 offen offset:1024 sc1 lds
K2_back_116:
    v_mfma_f32_32x32x16_bf16 v[32:47], v[88:91], v[188:191], v[32:47]
    s_nop 0
    v_mul_f32 v242, v0, v144
    v_fma_f32 v240, v8, v160, -v240
    v_fmac_f32 v242, v1, v145
    v_fmac_f32 v240, v9, v161
    v_fmac_f32 v242, v2, v146
    v_fmac_f32 v240, v10, v162
    v_fmac_f32 v242, v3, v147
    v_mfma_f32_32x32x16_bf16 v[48:63], v[92:95], v[188:191], v[48:63]
    s_setprio 0
    v_fmac_f32 v240, v11, v163
    v_fmac_f32 v242, v4, v148
    v_fmac_f32 v240, v12, v164
    v_fmac_f32 v242, v5, v149
    v_fmac_f32 v240, v13, v165
    v_fmac_f32 v242, v6, v150
    v_fmac_f32 v240, v14, v166
    v_fmac_f32 v242, v7, v151
    v_fmac_f32 v240, v15, v167
    v_add_u32 v249, s26, v249
    v_add_u32 v250, s26, v250
    v_fma_f32 v244, v16, v160, -v244
    v_fmac_f32 v236, v24, v112
    v_fmac_f32 v244, v17, v161
    v_fmac_f32 v236, v25, v113
    v_fmac_f32 v244, v18, v162
    v_fmac_f32 v236, v26, v114
    v_fmac_f32 v244, v19, v163
    v_fmac_f32 v236, v27, v115
    v_fmac_f32 v244, v20, v164
    v_fmac_f32 v236, v28, v116
    v_fmac_f32 v244, v21, v165
    v_fmac_f32 v236, v29, v117
    v_fmac_f32 v244, v22, v166
    v_fmac_f32 v236, v30, v118
    v_fmac_f32 v244, v23, v167
    v_fmac_f32 v236, v31, v119
    ds_read_b64_tr_b16 v[0:1], v249 offset:0
    ds_read_b64_tr_b16 v[2:3], v249 offset:32
    ds_read_u16_d16_hi v16, v250 offset:0
    v_mul_f32 v243, v32, v152
    v_fma_f32 v241, v40, v168, -v241
    v_fmac_f32 v243, v33, v153
    v_fmac_f32 v241, v41, v169
    v_fmac_f32 v243, v34, v154
    v_fmac_f32 v241, v42, v170
    v_fmac_f32 v243, v35, v155
    v_fmac_f32 v241, v43, v171
    v_fmac_f32 v243, v36, v156
    v_fmac_f32 v241, v44, v172
    v_fmac_f32 v243, v37, v157
    v_fmac_f32 v241, v45, v173
    v_fmac_f32 v243, v38, v158
    v_fmac_f32 v241, v46, v174
    v_fmac_f32 v243, v39, v159
    v_fmac_f32 v241, v47, v175
    ds_read_b64_tr_b16 v[4:5], v249 offset:512
    ds_read_b64_tr_b16 v[6:7], v249 offset:544
    ds_read_u16_d16_hi v17, v250 offset:128
    v_fma_f32 v245, v48, v168, -v245
    v_fmac_f32 v237, v56, v120
    v_fmac_f32 v245, v49, v169
    v_fmac_f32 v237, v57, v121
    v_fmac_f32 v245, v50, v170
    v_fmac_f32 v237, v58, v122
    v_fmac_f32 v245, v51, v171
    v_fmac_f32 v237, v59, v123
    v_fmac_f32 v245, v52, v172
    v_fmac_f32 v237, v60, v124
    v_fmac_f32 v245, v53, v173
    v_fmac_f32 v237, v61, v125
    v_fmac_f32 v245, v54, v174
    v_fmac_f32 v237, v62, v126
    v_fmac_f32 v245, v55, v175
    v_fmac_f32 v237, v63, v127
    s_cmp_eq_u32 s56, 5
    s_cbranch_scc1 K2_U20
    s_cmp_eq_u32 s56, 6
    s_cbranch_scc1 K2_U3h0
    s_branch K2_DSP0
K2_U11:
    s_setprio 1
    s_mov_b64 exec, 0x1ff
    ds_add_rtn_u32 v232, v254, v255
    s_mov_b64 exec, -1
    s_waitcnt lgkmcnt(4)
    v_lshlrev_b32 v20, 16, v0
    v_and_b32 v21, 0xffff0000, v0
    v_lshlrev_b32 v22, 16, v1
    v_and_b32 v23, 0xffff0000, v1
    v_lshlrev_b32 v24, 16, v2
    v_and_b32 v25, 0xffff0000, v2
    v_lshlrev_b32 v26, 16, v3
    v_and_b32 v27, 0xffff0000, v3
    v_mul_f32_dpp v36, v16, v20 row_newbcast:8 row_mask:0xf bank_mask:0xf
    v_mul_f32_dpp v37, v16, v21 row_newbcast:9 row_mask:0xf bank_mask:0xf
    v_mul_f32_dpp v38, v16, v22 row_newbcast:10 row_mask:0xf bank_mask:0xf
    v_mul_f32_dpp v39, v16, v23 row_newbcast:11 row_mask:0xf bank_mask:0xf
    v_mul_f32_dpp v40, v16, v24 row_newbcast:12 row_mask:0xf bank_mask:0xf
    v_mul_f32_dpp v41, v16, v25 row_newbcast:13 row_mask:0xf bank_mask:0xf
    v_mul_f32_dpp v42, v16, v26 row_newbcast:14 row_mask:0xf bank_mask:0xf
    v_mul_f32_dpp v43, v16, v27 row_newbcast:15 row_mask:0xf bank_mask:0xf
    v_cvt_pk_bf16_f32 v68, v36, v37
    v_cvt_pk_bf16_f32 v69, v38, v39
    v_cvt_pk_bf16_f32 v70, v40, v41
    v_cvt_pk_bf16_f32 v71, v42, v43
    v_mul_f32_dpp v20, v16, v20 row_newbcast:0 row_mask:0xa bank_mask:0xf
    v_mul_f32_dpp v21, v16, v21 row_newbcast:1 row_mask:0xa bank_mask:0xf
    v_mul_f32_dpp v22, v16, v22 row_newbcast:2 row_mask:0xa bank_mask:0xf
    v_mul_f32_dpp v23, v16, v23 row_newbcast:3 row_mask:0xa bank_mask:0xf
    v_mul_f32_dpp v24, v16, v24 row_newbcast:4 row_mask:0xa bank_mask:0xf
    v_mul_f32_dpp v25, v16, v25 row_newbcast:5 row_mask:0xa bank_mask:0xf
    v_mul_f32_dpp v26, v16, v26 row_newbcast:6 row_mask:0xa bank_mask:0xf
    v_mul_f32_dpp v27, v16, v27 row_newbcast:7 row_mask:0xa bank_mask:0xf
    v_cvt_pk_bf16_f32 v64, v20, v21
    v_cvt_pk_bf16_f32 v65, v22, v23
    v_cvt_pk_bf16_f32 v66, v24, v25
    v_cvt_pk_bf16_f32 v67, v26, v27
    s_waitcnt lgkmcnt(0)
    v_readlane_b32 s58, v232, 8
    s_nop 0
    s_cmp_lt_u32 s58, s22
    s_cbranch_scc0 K2_nul_121
    s_nop 0
    v_readlane_b32 s3, v253, s58
    s_nop 0
    s_bfe_u32 s58, s3, 0x60016
    s_and_b32 s59, s58, 7
    s_lshr_b32 s60, s58, 3
K2_chk_123:
    v_readlane_b32 s61, v232, s59
    s_nop 0
    s_cmp_gt_u32 s61, s60
    s_cbranch_scc0 K2_spin_122
K2_back_124:
    s_lshl_b32 s44, s34, 7
    s_and_b32 s48, s3, 0x3ffff
    s_bfe_u32 s33, s3, 0x30013
    s_mov_b32 s35, s48
    s_mov_b32 s45, s44
    s_xor_b32 s47, s44, 256
    s_add_u32 s49, s48, 128
    s_add_u32 s60, s48, 256
    s_cmp_eq_u32 s33, 3
    s_cselect_b32 s46, s44, s47
    s_cselect_b32 s50, s60, s48
    s_sub_u32 s60, s33, 2
    s_cmp_lt_u32 s60, 2
    s_cbranch_scc0 K2_rare_125
K2_back_126:
    v_add_u32 v222, s48, v251
    ds_read2_b32 v[222:223], v222 offset0:1 offset1:3
    v_add_u32 v224, s49, v251
    ds_read2_b32 v[224:225], v224 offset0:1 offset1:3
    v_add_u32 v226, s50, v251
    ds_read2_b32 v[226:227], v226 offset0:1 offset1:3
    s_waitcnt lgkmcnt(2)
    v_mad_u32_u16 v222, v222, s39, v248 op_sel:[1,0,0,0]
    v_mad_u32_u16 v223, v223, s39, v248 op_sel:[1,0,0,0]
    s_waitcnt lgkmcnt(1)
    v_mad_u32_u16 v224, v224, s39, v248 op_sel:[1,0,0,0]
    v_mad_u32_u16 v225, v225, s39, v248 op_sel:[1,0,0,0]
    s_waitcnt lgkmcnt(0)
    v_mad_u32_u16 v226, v226, s39, v248 op_sel:[1,0,0,0]
    v_mad_u32_u16 v227, v227, s39, v248 op_sel:[1,0,0,0]
    s_waitcnt vmcnt(4)
    v_mfma_f32_32x32x16_bf16 v[0:15], v[64:67], v[176:179], 0
    ds_read_b64_tr_b16 v[184:185], v246 offset:2048
    ds_read_b64_tr_b16 v[186:187], v246 offset:3072
    ds_read_b64_tr_b16 v[188:189], v247 offset:2048
    ds_read_b64_tr_b16 v[190:191], v247 offset:3072
    s_mov_b32 m0, s68
    v_mfma_f32_32x32x16_bf16 v[16:31], v[68:71], v[176:179], 0
    buffer_load_dwordx4 v222, s[4:7], s44 offen sc1 lds
    buffer_load_dwordx4 v223, s[72:75], s44 offen offset:1024 sc1 lds
    v_permlane32_swap_b32 v242, v236
    v_permlane32_swap_b32 v243, v237
    v_mfma_f32_32x32x16_bf16 v[32:47], v[64:67], v[180:183], 0
    v_permlane32_swap_b32 v244, v238
    v_permlane32_swap_b32 v245, v239
    v_permlane32_swap_b32 v240, v241
    v_add_f32 v242, v242, v236
    v_mfma_f32_32x32x16_bf16 v[48:63], v[68:71], v[180:183], 0
    s_setprio 0
    v_add_f32 v243, v243, v237
    v_add_f32 v244, v244, v238
    v_add_f32 v245, v245, v239
    v_add_f32 v240, -v240, -v241
    v_sub_u32 v241, v230, v231
    v_cvt_pk_bf16_f32 v242, v242, v243
    v_cvt_pk_bf16_f32 v244, v244, v245
    v_cvt_pk_bf16_f32 v240, v240, v240
    ds_write2st64_b32 v230, v242, v244 offset0:3 offset1:4
    ds_write_b16 v241, v240 offset:1280
    v_mul_f32 v234, v0, v96
    v_mul_f32 v236, v8, v128
    v_fmac_f32 v234, v1, v97
    v_fmac_f32 v236, v9, v129
    v_fmac_f32 v234, v2, v98
    v_fmac_f32 v236, v10, v130
    v_fmac_f32 v234, v3, v99
    v_fmac_f32 v236, v11, v131
    v_fmac_f32 v234, v4, v100
    v_fmac_f32 v236, v12, v132
    v_fmac_f32 v234, v5, v101
    v_fmac_f32 v236, v13, v133
    v_fmac_f32 v234, v6, v102
    v_fmac_f32 v236, v14, v134
    v_fmac_f32 v234, v7, v103
    v_fmac_f32 v236, v15, v135
    v_mul_f32 v238, v16, v128
    v_mul_f32 v240, v24, v128
    v_fmac_f32 v238, v17, v129
    v_fmac_f32 v240, v25, v129
    v_fmac_f32 v238, v18, v130
    v_fmac_f32 v240, v26, v130
    v_fmac_f32 v238, v19, v131
    v_fmac_f32 v240, v27, v131
    v_fmac_f32 v238, v20, v132
    v_fmac_f32 v240, v28, v132
    v_fmac_f32 v238, v21, v133
    v_fmac_f32 v240, v29, v133
    v_fmac_f32 v238, v22, v134
    v_fmac_f32 v240, v30, v134
    v_fmac_f32 v238, v23, v135
    v_fmac_f32 v240, v31, v135
    v_mul_f32 v235, v32, v104
    v_mul_f32 v237, v40, v136
    v_fmac_f32 v235, v33, v105
    v_fmac_f32 v237, v41, v137
    v_fmac_f32 v235, v34, v106
    v_fmac_f32 v237, v42, v138
    v_fmac_f32 v235, v35, v107
    v_fmac_f32 v237, v43, v139
    v_fmac_f32 v235, v36, v108
    v_fmac_f32 v237, v44, v140
    v_fmac_f32 v235, v37, v109
    v_fmac_f32 v237, v45, v141
    v_fmac_f32 v235, v38, v110
    v_fmac_f32 v237, v46, v142
    v_fmac_f32 v235, v39, v111
    v_fmac_f32 v237, v47, v143
    v_mul_f32 v239, v48, v136
    v_mul_f32 v241, v56, v136
    v_fmac_f32 v239, v49, v137
    v_fmac_f32 v241, v57, v137
    v_fmac_f32 v239, v50, v138
    v_fmac_f32 v241, v58, v138
    v_fmac_f32 v239, v51, v139
    v_fmac_f32 v241, v59, v139
    v_fmac_f32 v239, v52, v140
    v_fmac_f32 v241, v60, v140
    v_fmac_f32 v239, v53, v141
    v_fmac_f32 v241, v61, v141
    v_fmac_f32 v239, v54, v142
    v_fmac_f32 v241, v62, v142
    v_fmac_f32 v239, v55, v143
    v_fmac_f32 v241, v63, v143
    s_setprio 1
    s_waitcnt vmcnt(4) lgkmcnt(2)
    v_mfma_f32_32x32x16_bf16 v[0:15], v[64:67], v[184:187], 0
    ds_read_b64_tr_b16 v[176:177], v246 offset:4096
    ds_read_b64_tr_b16 v[178:179], v246 offset:5120
    ds_read_b64_tr_b16 v[180:181], v247 offset:4096
    ds_read_b64_tr_b16 v[182:183], v247 offset:5120
    s_mov_b32 m0, s69
    v_mfma_f32_32x32x16_bf16 v[16:31], v[68:71], v[184:187], 0
    buffer_load_dwordx4 v224, s[4:7], s45 offen sc1 lds
    buffer_load_dwordx4 v225, s[72:75], s45 offen offset:1024 sc1 lds
    v_permlane32_swap_b32 v234, v236
    v_permlane32_swap_b32 v235, v237
    v_mfma_f32_32x32x16_bf16 v[32:47], v[64:67], v[188:191], 0
    v_permlane32_swap_b32 v240, v238
    v_permlane32_swap_b32 v241, v239
    v_lshl_add_u32 v230, v252, 1, s31
    v_add_f32 v234, v234, v236
    v_add_f32 v235, v235, v237
    v_mfma_f32_32x32x16_bf16 v[48:63], v[68:71], v[188:191], 0
    s_setprio 0
    v_add_f32 v240, v240, v238
    v_add_f32 v241, v241, v239
    v_cvt_pk_bf16_f32 v234, v234, v235
    v_cvt_pk_bf16_f32 v240, v240, v241
    ds_write2st64_b32 v230, v234, v240 offset0:0 offset1:1
    v_mul_f32 v234, v0, v144
    v_mul_f32 v236, v8, v112
    v_fmac_f32 v234, v1, v145
    v_fmac_f32 v236, v9, v113
    v_fmac_f32 v234, v2, v146
    v_fmac_f32 v236, v10, v114
    v_fmac_f32 v234, v3, v147
    v_fmac_f32 v236, v11, v115
    v_fmac_f32 v234, v4, v148
    v_fmac_f32 v236, v12, v116
    v_fmac_f32 v234, v5, v149
    v_fmac_f32 v236, v13, v117
    v_fmac_f32 v234, v6, v150
    v_fmac_f32 v236, v14, v118
    v_fmac_f32 v234, v7, v151
    v_fmac_f32 v236, v15, v119
    v_mul_f32 v238, v16, v160
    v_mul_f32 v240, v24, v160
    v_fmac_f32 v238, v17, v161
    v_fmac_f32 v240, v25, v161
    v_fmac_f32 v238, v18, v162
    v_fmac_f32 v240, v26, v162
    v_fmac_f32 v238, v19, v163
    v_fmac_f32 v240, v27, v163
    v_fmac_f32 v238, v20, v164
    v_fmac_f32 v240, v28, v164
    v_fmac_f32 v238, v21, v165
    v_fmac_f32 v240, v29, v165
    v_fmac_f32 v238, v22, v166
    v_fmac_f32 v240, v30, v166
    v_fmac_f32 v238, v23, v167
    v_fmac_f32 v240, v31, v167
    v_mul_f32 v235, v32, v152
    v_mul_f32 v237, v40, v120
    v_fmac_f32 v235, v33, v153
    v_fmac_f32 v237, v41, v121
    v_fmac_f32 v235, v34, v154
    v_fmac_f32 v237, v42, v122
    v_fmac_f32 v235, v35, v155
    v_fmac_f32 v237, v43, v123
    v_fmac_f32 v235, v36, v156
    v_fmac_f32 v237, v44, v124
    v_fmac_f32 v235, v37, v157
    v_fmac_f32 v237, v45, v125
    v_fmac_f32 v235, v38, v158
    v_fmac_f32 v237, v46, v126
    v_fmac_f32 v235, v39, v159
    v_fmac_f32 v237, v47, v127
    v_mul_f32 v239, v48, v168
    v_mul_f32 v241, v56, v168
    v_fmac_f32 v239, v49, v169
    v_fmac_f32 v241, v57, v169
    v_fmac_f32 v239, v50, v170
    v_fmac_f32 v241, v58, v170
    v_fmac_f32 v239, v51, v171
    v_fmac_f32 v241, v59, v171
    v_fmac_f32 v239, v52, v172
    v_fmac_f32 v241, v60, v172
    v_fmac_f32 v239, v53, v173
    v_fmac_f32 v241, v61, v173
    v_fmac_f32 v239, v54, v174
    v_fmac_f32 v241, v62, v174
    v_fmac_f32 v239, v55, v175
    v_fmac_f32 v241, v63, v175
    s_setprio 1
    s_waitcnt vmcnt(4) lgkmcnt(1)
    v_mfma_f32_32x32x16_bf16 v[0:15], v[64:67], v[176:179], 0
    ds_read_b64_tr_b16 v[184:185], v246 offset:6144
    ds_read_b64_tr_b16 v[186:187], v246 offset:7168
    ds_read_b64_tr_b16 v[188:189], v247 offset:6144
    ds_read_b64_tr_b16 v[190:191], v247 offset:7168
    s_mov_b32 s32, s31
    s_mov_b32 s31, s35
    s_mov_b32 m0, s70
    v_mfma_f32_32x32x16_bf16 v[16:31], v[68:71], v[176:179], 0
    buffer_load_dwordx4 v226, s[4:7], s46 offen sc1 lds
    buffer_load_dwordx4 v227, s[72:75], s46 offen offset:1024 sc1 lds
    s_sub_u32 s26, s48, s29
    s_mov_b32 s29, s48
    s_mov_b32 s30, s3
    s_bfe_u32 s56, s3, 0x40012
    v_mfma_f32_32x32x16_bf16 v[32:47], v[64:67], v[180:183], 0
    s_cmp_lg_u32 s36, 0
    s_cselect_b32 s56, s56, 0
    v_mfma_f32_32x32x16_bf16 v[48:63], v[68:71], v[180:183], 0
    s_setprio 0
    v_mul_f32 v242, v0, v144
    v_fma_f32 v238, v8, v160, -v238
    v_fmac_f32 v242, v1, v145
    v_fmac_f32 v238, v9, v161
    v_fmac_f32 v242, v2, v146
    v_fmac_f32 v238, v10, v162
    v_fmac_f32 v242, v3, v147
    v_fmac_f32 v238, v11, v163
    v_fmac_f32 v242, v4, v148
    v_fmac_f32 v238, v12, v164
    v_fmac_f32 v242, v5, v149
    v_fmac_f32 v238, v13, v165
    v_fmac_f32 v242, v6, v150
    v_fmac_f32 v238, v14, v166
    v_fmac_f32 v242, v7, v151
    v_fmac_f32 v238, v15, v167
    v_fmac_f32 v236, v16, v112
    v_mul_f32 v244, v24, v160
    v_fmac_f32 v236, v17, v113
    v_fmac_f32 v244, v25, v161
    v_fmac_f32 v236, v18, v114
    v_fmac_f32 v244, v26, v162
    v_fmac_f32 v236, v19, v115
    v_fmac_f32 v244, v27, v163
    v_fmac_f32 v236, v20, v116
    v_fmac_f32 v244, v28, v164
    v_fmac_f32 v236, v21, v117
    v_fmac_f32 v244, v29, v165
    v_fmac_f32 v236, v22, v118
    v_fmac_f32 v244, v30, v166
    v_fmac_f32 v236, v23, v119
    v_fmac_f32 v244, v31, v167
    v_mul_f32 v243, v32, v152
    v_fma_f32 v239, v40, v168, -v239
    v_fmac_f32 v243, v33, v153
    v_fmac_f32 v239, v41, v169
    v_fmac_f32 v243, v34, v154
    v_fmac_f32 v239, v42, v170
    v_fmac_f32 v243, v35, v155
    v_fmac_f32 v239, v43, v171
    v_fmac_f32 v243, v36, v156
    v_fmac_f32 v239, v44, v172
    v_fmac_f32 v243, v37, v157
    v_fmac_f32 v239, v45, v173
    v_fmac_f32 v243, v38, v158
    v_fmac_f32 v239, v46, v174
    v_fmac_f32 v243, v39, v159
    v_fmac_f32 v239, v47, v175
    v_fmac_f32 v237, v48, v120
    v_mul_f32 v245, v56, v168
    v_fmac_f32 v237, v49, v121
    v_fmac_f32 v245, v57, v169
    v_fmac_f32 v237, v50, v122
    v_fmac_f32 v245, v58, v170
    v_fmac_f32 v237, v51, v123
    v_fmac_f32 v245, v59, v171
    v_fmac_f32 v237, v52, v124
    v_fmac_f32 v245, v60, v172
    v_fmac_f32 v237, v53, v125
    v_fmac_f32 v245, v61, v173
    v_fmac_f32 v237, v54, v126
    v_fmac_f32 v245, v62, v174
    v_fmac_f32 v237, v55, v127
    v_fmac_f32 v245, v63, v175
    s_setprio 1
    s_waitcnt vmcnt(4) lgkmcnt(0)
    v_mfma_f32_32x32x16_bf16 v[0:15], v[64:67], v[184:187], 0
    ds_read_b64_tr_b16 v[176:177], v246 offset:0
    ds_read_b64_tr_b16 v[178:179], v246 offset:1024
    ds_read_b64_tr_b16 v[180:181], v247 offset:0
    ds_read_b64_tr_b16 v[182:183], v247 offset:1024
    s_mov_b32 m0, s71
    v_mfma_f32_32x32x16_bf16 v[16:31], v[68:71], v[184:187], 0
    s_cmp_eq_u32 s33, 4
    s_cbranch_scc1 K2_g4_128
    buffer_load_dwordx4 v224, s[4:7], s47 offen sc1 lds
    buffer_load_dwordx4 v225, s[72:75], s47 offen offset:1024 sc1 lds
K2_back_129:
    v_permlane32_swap_b32 v242, v234
    v_mfma_f32_32x32x16_bf16 v[32:47], v[64:67], v[188:191], 0
    v_permlane32_swap_b32 v243, v235
    v_add_f32 v242, v242, v234
    v_add_f32 v243, v243, v235
    v_cvt_pk_bf16_f32 v242, v242, v243
    ds_write_b32 v230, v242 offset:512
    v_mfma_f32_32x32x16_bf16 v[48:63], v[68:71], v[188:191], 0
    s_setprio 0
    v_mul_f32 v242, v0, v144
    v_fma_f32 v240, v8, v160, -v240
    v_fmac_f32 v242, v1, v145
    v_fmac_f32 v240, v9, v161
    v_fmac_f32 v242, v2, v146
    v_fmac_f32 v240, v10, v162
    v_fmac_f32 v242, v3, v147
    v_fmac_f32 v240, v11, v163
    v_fmac_f32 v242, v4, v148
    v_fmac_f32 v240, v12, v164
    v_fmac_f32 v242, v5, v149
    v_fmac_f32 v240, v13, v165
    v_fmac_f32 v242, v6, v150
    v_fmac_f32 v240, v14, v166
    v_fmac_f32 v242, v7, v151
    v_fmac_f32 v240, v15, v167
    v_add_u32 v249, s26, v249
    v_add_u32 v250, s26, v250
    v_fma_f32 v244, v16, v160, -v244
    v_fmac_f32 v236, v24, v112
    v_fmac_f32 v244, v17, v161
    v_fmac_f32 v236, v25, v113
    v_fmac_f32 v244, v18, v162
    v_fmac_f32 v236, v26, v114
    v_fmac_f32 v244, v19, v163
    v_fmac_f32 v236, v27, v115
    v_fmac_f32 v244, v20, v164
    v_fmac_f32 v236, v28, v116
    v_fmac_f32 v244, v21, v165
    v_fmac_f32 v236, v29, v117
    v_fmac_f32 v244, v22, v166
    v_fmac_f32 v236, v30, v118
    v_fmac_f32 v244, v23, v167
    v_fmac_f32 v236, v31, v119
    ds_read_b64_tr_b16 v[0:1], v249 offset:0
    ds_read_b64_tr_b16 v[2:3], v249 offset:32
    ds_read_u16_d16_hi v16, v250 offset:0
    v_mul_f32 v243, v32, v152
    v_fma_f32 v241, v40, v168, -v241
    v_fmac_f32 v243, v33, v153
    v_fmac_f32 v241, v41, v169
    v_fmac_f32 v243, v34, v154
    v_fmac_f32 v241, v42, v170
    v_fmac_f32 v243, v35, v155
    v_fmac_f32 v241, v43, v171
    v_fmac_f32 v243, v36, v156
    v_fmac_f32 v241, v44, v172
    v_fmac_f32 v243, v37, v157
    v_fmac_f32 v241, v45, v173
    v_fmac_f32 v243, v38, v158
    v_fmac_f32 v241, v46, v174
    v_fmac_f32 v243, v39, v159
    v_fmac_f32 v241, v47, v175
    ds_read_b64_tr_b16 v[4:5], v249 offset:512
    ds_read_b64_tr_b16 v[6:7], v249 offset:544
    ds_read_u16_d16_hi v17, v250 offset:128
    v_fma_f32 v245, v48, v168, -v245
    v_fmac_f32 v237, v56, v120
    v_fmac_f32 v245, v49, v169
    v_fmac_f32 v237, v57, v121
    v_fmac_f32 v245, v50, v170
    v_fmac_f32 v237, v58, v122
    v_fmac_f32 v245, v51, v171
    v_fmac_f32 v237, v59, v123
    v_fmac_f32 v245, v52, v172
    v_fmac_f32 v237, v60, v124
    v_fmac_f32 v245, v53, v173
    v_fmac_f32 v237, v61, v125
    v_fmac_f32 v245, v54, v174
    v_fmac_f32 v237, v62, v126
    v_fmac_f32 v245, v55, v175
    v_fmac_f32 v237, v63, v127
    s_cmp_eq_u32 s56, 5
    s_cbranch_scc1 K2_U21
    s_cmp_eq_u32 s56, 6
    s_cbranch_scc1 K2_U3h1
    s_branch K2_DSP1
K2_U41:
    s_setprio 1
    ds_read_b64_tr_b16 v[8:9], v249 offset:1024
    ds_read_b64_tr_b16 v[10:11], v249 offset:1056
    ds_read_u16_d16_hi v18, v250 offset:256
    s_lshr_b32 s65, s30, 28
    s_mul_i32 s66, s22, 2080
    s_lshl_b32 s65, s65, 9
    s_add_u32 s65, s65, s66
    s_add_u32 s65, s65, 65536
    s_sub_u32 s65, s65, s29
    s_sub_u32 s65, s65, 512
    v_add_u32 v56, s65, v249
    ds_read_b64_tr_b16 v[12:13], v56 offset:0
    ds_read_b64_tr_b16 v[14:15], v56 offset:32
    ds_read_u16_d16_hi v19, v250 offset:384
    s_waitcnt lgkmcnt(6)
    v_lshlrev_b32 v20, 16, v0
    v_and_b32 v21, 0xffff0000, v0
    v_lshlrev_b32 v22, 16, v1
    v_and_b32 v23, 0xffff0000, v1
    v_lshlrev_b32 v24, 16, v2
    v_and_b32 v25, 0xffff0000, v2
    v_lshlrev_b32 v26, 16, v3
    v_and_b32 v27, 0xffff0000, v3
    v_mul_f32_dpp v36, v16, v20 row_newbcast:8 row_mask:0xf bank_mask:0xf
    v_mul_f32_dpp v37, v16, v21 row_newbcast:9 row_mask:0xf bank_mask:0xf
    v_mul_f32_dpp v38, v16, v22 row_newbcast:10 row_mask:0xf bank_mask:0xf
    v_mul_f32_dpp v39, v16, v23 row_newbcast:11 row_mask:0xf bank_mask:0xf
    v_mul_f32_dpp v40, v16, v24 row_newbcast:12 row_mask:0xf bank_mask:0xf
    v_mul_f32_dpp v41, v16, v25 row_newbcast:13 row_mask:0xf bank_mask:0xf
    v_mul_f32_dpp v42, v16, v26 row_newbcast:14 row_mask:0xf bank_mask:0xf
    v_mul_f32_dpp v43, v16, v27 row_newbcast:15 row_mask:0xf bank_mask:0xf
    v_cvt_pk_bf16_f32 v68, v36, v37
    v_cvt_pk_bf16_f32 v69, v38, v39
    v_cvt_pk_bf16_f32 v70, v40, v41
    v_cvt_pk_bf16_f32 v71, v42, v43
    v_mul_f32_dpp v20, v16, v20 row_newbcast:0 row_mask:0xa bank_mask:0xf
    v_mul_f32_dpp v21, v16, v21 row_newbcast:1 row_mask:0xa bank_mask:0xf
    v_mul_f32_dpp v22, v16, v22 row_newbcast:2 row_mask:0xa bank_mask:0xf
    v_mul_f32_dpp v23, v16, v23 row_newbcast:3 row_mask:0xa bank_mask:0xf
    v_mul_f32_dpp v24, v16, v24 row_newbcast:4 row_mask:0xa bank_mask:0xf
    v_mul_f32_dpp v25, v16, v25 row_newbcast:5 row_mask:0xa bank_mask:0xf
    v_mul_f32_dpp v26, v16, v26 row_newbcast:6 row_mask:0xa bank_mask:0xf
    v_mul_f32_dpp v27, v16, v27 row_newbcast:7 row_mask:0xa bank_mask:0xf
    v_cvt_pk_bf16_f32 v64, v20, v21
    v_cvt_pk_bf16_f32 v65, v22, v23
    v_cvt_pk_bf16_f32 v66, v24, v25
    v_cvt_pk_bf16_f32 v67, v26, v27
    v_lshlrev_b32 v28, 16, v4
    v_and_b32 v29, 0xffff0000, v4
    v_lshlrev_b32 v30, 16, v5
    v_and_b32 v31, 0xffff0000, v5
    v_lshlrev_b32 v32, 16, v6
    v_and_b32 v33, 0xffff0000, v6
    v_lshlrev_b32 v34, 16, v7
    v_and_b32 v35, 0xffff0000, v7
    v_mul_f32_dpp v36, v17, v28 row_newbcast:8 row_mask:0xf bank_mask:0xf
    v_mul_f32_dpp v37, v17, v29 row_newbcast:9 row_mask:0xf bank_mask:0xf
    v_mul_f32_dpp v38, v17, v30 row_newbcast:10 row_mask:0xf bank_mask:0xf
    v_mul_f32_dpp v39, v17, v31 row_newbcast:11 row_mask:0xf bank_mask:0xf
    v_mul_f32_dpp v40, v17, v32 row_newbcast:12 row_mask:0xf bank_mask:0xf
    v_mul_f32_dpp v41, v17, v33 row_newbcast:13 row_mask:0xf bank_mask:0xf
    v_mul_f32_dpp v42, v17, v34 row_newbcast:14 row_mask:0xf bank_mask:0xf
    v_mul_f32_dpp v43, v17, v35 row_newbcast:15 row_mask:0xf bank_mask:0xf
    v_cvt_pk_bf16_f32 v76, v36, v37
    v_cvt_pk_bf16_f32 v77, v38, v39
    v_cvt_pk_bf16_f32 v78, v40, v41
    v_cvt_pk_bf16_f32 v79, v42, v43
    v_mul_f32_dpp v28, v17, v28 row_newbcast:0 row_mask:0xa bank_mask:0xf
    v_mul_f32_dpp v29, v17, v29 row_newbcast:1 row_mask:0xa bank_mask:0xf
    v_mul_f32_dpp v30, v17, v30 row_newbcast:2 row_mask:0xa bank_mask:0xf
    v_mul_f32_dpp v31, v17, v31 row_newbcast:3 row_mask:0xa bank_mask:0xf
    v_mul_f32_dpp v32, v17, v32 row_newbcast:4 row_mask:0xa bank_mask:0xf
    v_mul_f32_dpp v33, v17, v33 row_newbcast:5 row_mask:0xa bank_mask:0xf
    v_mul_f32_dpp v34, v17, v34 row_newbcast:6 row_mask:0xa bank_mask:0xf
    v_mul_f32_dpp v35, v17, v35 row_newbcast:7 row_mask:0xa bank_mask:0xf
    v_cvt_pk_bf16_f32 v72, v28, v29
    v_cvt_pk_bf16_f32 v73, v30, v31
    v_cvt_pk_bf16_f32 v74, v32, v33
    v_cvt_pk_bf16_f32 v75, v34, v35
    s_waitcnt lgkmcnt(3)
    v_lshlrev_b32 v20, 16, v8
    v_and_b32 v21, 0xffff0000, v8
    v_lshlrev_b32 v22, 16, v9
    v_and_b32 v23, 0xffff0000, v9
    v_lshlrev_b32 v24, 16, v10
    v_and_b32 v25, 0xffff0000, v10
    v_lshlrev_b32 v26, 16, v11
    v_and_b32 v27, 0xffff0000, v11
    v_mul_f32_dpp v36, v18, v20 row_newbcast:8 row_mask:0xf bank_mask:0xf
    v_mul_f32_dpp v37, v18, v21 row_newbcast:9 row_mask:0xf bank_mask:0xf
    v_mul_f32_dpp v38, v18, v22 row_newbcast:10 row_mask:0xf bank_mask:0xf
    v_mul_f32_dpp v39, v18, v23 row_newbcast:11 row_mask:0xf bank_mask:0xf
    v_mul_f32_dpp v40, v18, v24 row_newbcast:12 row_mask:0xf bank_mask:0xf
    v_mul_f32_dpp v41, v18, v25 row_newbcast:13 row_mask:0xf bank_mask:0xf
    v_mul_f32_dpp v42, v18, v26 row_newbcast:14 row_mask:0xf bank_mask:0xf
    v_mul_f32_dpp v43, v18, v27 row_newbcast:15 row_mask:0xf bank_mask:0xf
    v_cvt_pk_bf16_f32 v84, v36, v37
    v_cvt_pk_bf16_f32 v85, v38, v39
    v_cvt_pk_bf16_f32 v86, v40, v41
    v_cvt_pk_bf16_f32 v87, v42, v43
    v_mul_f32_dpp v20, v18, v20 row_newbcast:0 row_mask:0xa bank_mask:0xf
    v_mul_f32_dpp v21, v18, v21 row_newbcast:1 row_mask:0xa bank_mask:0xf
    v_mul_f32_dpp v22, v18, v22 row_newbcast:2 row_mask:0xa bank_mask:0xf
    v_mul_f32_dpp v23, v18, v23 row_newbcast:3 row_mask:0xa bank_mask:0xf
    v_mul_f32_dpp v24, v18, v24 row_newbcast:4 row_mask:0xa bank_mask:0xf
    v_mul_f32_dpp v25, v18, v25 row_newbcast:5 row_mask:0xa bank_mask:0xf
    v_mul_f32_dpp v26, v18, v26 row_newbcast:6 row_mask:0xa bank_mask:0xf
    v_mul_f32_dpp v27, v18, v27 row_newbcast:7 row_mask:0xa bank_mask:0xf
    v_cvt_pk_bf16_f32 v80, v20, v21
    v_cvt_pk_bf16_f32 v81, v22, v23
    v_cvt_pk_bf16_f32 v82, v24, v25
    v_cvt_pk_bf16_f32 v83, v26, v27
    s_waitcnt lgkmcnt(0)
    v_lshlrev_b32 v28, 16, v12
    v_and_b32 v29, 0xffff0000, v12
    v_lshlrev_b32 v30, 16, v13
    v_and_b32 v31, 0xffff0000, v13
    v_lshlrev_b32 v32, 16, v14
    v_and_b32 v33, 0xffff0000, v14
    v_lshlrev_b32 v34, 16, v15
    v_and_b32 v35, 0xffff0000, v15
    v_mul_f32_dpp v36, v19, v28 row_newbcast:8 row_mask:0xf bank_mask:0xf
    v_mul_f32_dpp v37, v19, v29 row_newbcast:9 row_mask:0xf bank_mask:0xf
    v_mul_f32_dpp v38, v19, v30 row_newbcast:10 row_mask:0xf bank_mask:0xf
    v_mul_f32_dpp v39, v19, v31 row_newbcast:11 row_mask:0xf bank_mask:0xf
    v_mul_f32_dpp v40, v19, v32 row_newbcast:12 row_mask:0xf bank_mask:0xf
    v_mul_f32_dpp v41, v19, v33 row_newbcast:13 row_mask:0xf bank_mask:0xf
    v_mul_f32_dpp v42, v19, v34 row_newbcast:14 row_mask:0xf bank_mask:0xf
    v_mul_f32_dpp v43, v19, v35 row_newbcast:15 row_mask:0xf bank_mask:0xf
    v_cvt_pk_bf16_f32 v92, v36, v37
    v_cvt_pk_bf16_f32 v93, v38, v39
    v_cvt_pk_bf16_f32 v94, v40, v41
    v_cvt_pk_bf16_f32 v95, v42, v43
    v_mul_f32_dpp v28, v19, v28 row_newbcast:0 row_mask:0xa bank_mask:0xf
    v_mul_f32_dpp v29, v19, v29 row_newbcast:1 row_mask:0xa bank_mask:0xf
    v_mul_f32_dpp v30, v19, v30 row_newbcast:2 row_mask:0xa bank_mask:0xf
    v_mul_f32_dpp v31, v19, v31 row_newbcast:3 row_mask:0xa bank_mask:0xf
    v_mul_f32_dpp v32, v19, v32 row_newbcast:4 row_mask:0xa bank_mask:0xf
    v_mul_f32_dpp v33, v19, v33 row_newbcast:5 row_mask:0xa bank_mask:0xf
    v_mul_f32_dpp v34, v19, v34 row_newbcast:6 row_mask:0xa bank_mask:0xf
    v_mul_f32_dpp v35, v19, v35 row_newbcast:7 row_mask:0xa bank_mask:0xf
    v_cvt_pk_bf16_f32 v88, v28, v29
    v_cvt_pk_bf16_f32 v89, v30, v31
    v_cvt_pk_bf16_f32 v90, v32, v33
    v_cvt_pk_bf16_f32 v91, v34, v35
    s_waitcnt vmcnt(4)
    v_mfma_f32_32x32x16_bf16 v[0:15], v[64:67], v[176:179], 0
    ds_read_b64_tr_b16 v[184:185], v246 offset:2048
    ds_read_b64_tr_b16 v[186:187], v246 offset:3072
    ds_read_b64_tr_b16 v[188:189], v247 offset:2048
    ds_read_b64_tr_b16 v[190:191], v247 offset:3072
    s_mov_b32 m0, s68
    v_mfma_f32_32x32x16_bf16 v[16:31], v[68:71], v[176:179], 0
    buffer_load_dwordx4 v222, s[4:7], s41 offen sc1 lds
    buffer_load_dwordx4 v223, s[72:75], s41 offen offset:1024 sc1 lds
    v_permlane32_swap_b32 v242, v236
    v_permlane32_swap_b32 v243, v237
    v_mfma_f32_32x32x16_bf16 v[32:47], v[64:67], v[180:183], 0
    v_permlane32_swap_b32 v244, v238
    v_permlane32_swap_b32 v245, v239
    v_permlane32_swap_b32 v240, v241
    v_add_f32 v242, v242, v236
    v_mfma_f32_32x32x16_bf16 v[48:63], v[68:71], v[180:183], 0
    v_add_f32 v243, v243, v237
    v_add_f32 v244, v244, v238
    v_add_f32 v245, v245, v239
    v_add_f32 v240, -v240, -v241
    v_sub_u32 v241, v230, v231
    v_cvt_pk_bf16_f32 v242, v242, v243
    s_mov_b64 exec, 0x1ff
    ds_add_rtn_u32 v232, v254, v255
    s_mov_b64 exec, -1
    s_waitcnt vmcnt(4) lgkmcnt(1)
    v_mfma_f32_32x32x16_bf16 v[0:15], v[72:75], v[184:187], v[0:15]
    ds_read_b64_tr_b16 v[176:177], v246 offset:4096
    ds_read_b64_tr_b16 v[178:179], v246 offset:5120
    ds_read_b64_tr_b16 v[180:181], v247 offset:4096
    ds_read_b64_tr_b16 v[182:183], v247 offset:5120
    v_cvt_pk_bf16_f32 v244, v244, v245
    v_cvt_pk_bf16_f32 v240, v240, v240
    s_mov_b32 m0, s69
    v_mfma_f32_32x32x16_bf16 v[16:31], v[76:79], v[184:187], v[16:31]
    buffer_load_dwordx4 v224, s[4:7], s41 offen sc1 lds
    buffer_load_dwordx4 v225, s[72:75], s41 offen offset:1024 sc1 lds
    ds_write2st64_b32 v230, v242, v244 offset0:3 offset1:4
    ds_write_b16 v241, v240 offset:1280
    s_waitcnt lgkmcnt(6)
    v_readlane_b32 s58, v232, 8
    v_mfma_f32_32x32x16_bf16 v[32:47], v[72:75], v[188:191], v[32:47]
    s_cmp_lt_u32 s58, s22
    s_cbranch_scc0 K2_nul_130
    s_nop 0
    v_readlane_b32 s3, v253, s58
    s_nop 0
    s_bfe_u32 s58, s3, 0x60016
    s_and_b32 s59, s58, 7
    s_lshr_b32 s60, s58, 3
K2_chk_132:
    v_readlane_b32 s61, v232, s59
    s_nop 0
    s_cmp_gt_u32 s61, s60
    s_cbranch_scc0 K2_spin_131
K2_back_133:
    v_mfma_f32_32x32x16_bf16 v[48:63], v[76:79], v[188:191], v[48:63]
    s_lshl_b32 s44, s34, 7
    s_and_b32 s48, s3, 0x3ffff
    s_bfe_u32 s33, s3, 0x30013
    s_mov_b32 s35, s48
    s_mov_b32 s45, s44
    s_xor_b32 s47, s44, 256
    s_waitcnt vmcnt(4) lgkmcnt(2)
    v_mfma_f32_32x32x16_bf16 v[0:15], v[80:83], v[176:179], v[0:15]
    ds_read_b64_tr_b16 v[184:185], v246 offset:6144
    ds_read_b64_tr_b16 v[186:187], v246 offset:7168
    ds_read_b64_tr_b16 v[188:189], v247 offset:6144
    ds_read_b64_tr_b16 v[190:191], v247 offset:7168
    s_add_u32 s49, s48, 128
    s_add_u32 s60, s48, 256
    s_mov_b32 m0, s70
    v_mfma_f32_32x32x16_bf16 v[16:31], v[84:87], v[176:179], v[16:31]
    buffer_load_dwordx4 v226, s[4:7], s41 offen sc1 lds
    buffer_load_dwordx4 v227, s[72:75], s41 offen offset:1024 sc1 lds
    s_cmp_eq_u32 s33, 3
    s_cselect_b32 s46, s44, s47
    s_cselect_b32 s50, s60, s48
    v_mfma_f32_32x32x16_bf16 v[32:47], v[80:83], v[180:183], v[32:47]
    s_sub_u32 s60, s33, 2
    s_cmp_lt_u32 s60, 2
    s_cbranch_scc0 K2_rare_134
K2_back_135:
    v_mfma_f32_32x32x16_bf16 v[48:63], v[84:87], v[180:183], v[48:63]
    s_waitcnt vmcnt(4) lgkmcnt(0)
    v_mfma_f32_32x32x16_bf16 v[0:15], v[88:91], v[184:187], v[0:15]
    ds_read_b64_tr_b16 v[176:177], v246 offset:0
    ds_read_b64_tr_b16 v[178:179], v246 offset:1024
    ds_read_b64_tr_b16 v[180:181], v247 offset:0
    ds_read_b64_tr_b16 v[182:183], v247 offset:1024
    s_mov_b32 m0, s71
    v_mfma_f32_32x32x16_bf16 v[16:31], v[92:95], v[184:187], v[16:31]
    buffer_load_dwordx4 v228, s[4:7], s41 offen sc1 lds
    buffer_load_dwordx4 v229, s[72:75], s41 offen offset:1024 sc1 lds
    v_mfma_f32_32x32x16_bf16 v[32:47], v[88:91], v[188:191], v[32:47]
    s_nop 2
    v_mul_f32 v234, v0, v96
    v_mul_f32 v236, v8, v128
    v_fmac_f32 v234, v1, v97
    v_fmac_f32 v236, v9, v129
    v_fmac_f32 v234, v2, v98
    v_fmac_f32 v236, v10, v130
    v_fmac_f32 v234, v3, v99
    v_mfma_f32_32x32x16_bf16 v[48:63], v[92:95], v[188:191], v[48:63]
    s_setprio 0
    v_fmac_f32 v236, v11, v131
    v_fmac_f32 v234, v4, v100
    v_fmac_f32 v236, v12, v132
    v_fmac_f32 v234, v5, v101
    v_fmac_f32 v236, v13, v133
    v_fmac_f32 v234, v6, v102
    v_fmac_f32 v236, v14, v134
    v_fmac_f32 v234, v7, v103
    v_fmac_f32 v236, v15, v135
    v_mul_f32 v238, v16, v128
    v_mul_f32 v240, v24, v128
    v_fmac_f32 v238, v17, v129
    v_fmac_f32 v240, v25, v129
    v_fmac_f32 v238, v18, v130
    v_fmac_f32 v240, v26, v130
    v_fmac_f32 v238, v19, v131
    v_fmac_f32 v240, v27, v131
    v_fmac_f32 v238, v20, v132
    v_fmac_f32 v240, v28, v132
    v_fmac_f32 v238, v21, v133
    v_fmac_f32 v240, v29, v133
    v_fmac_f32 v238, v22, v134
    v_fmac_f32 v240, v30, v134
    v_fmac_f32 v238, v23, v135
    v_fmac_f32 v240, v31, v135
    v_mul_f32 v235, v32, v104
    v_mul_f32 v237, v40, v136
    v_fmac_f32 v235, v33, v105
    v_fmac_f32 v237, v41, v137
    v_fmac_f32 v235, v34, v106
    v_fmac_f32 v237, v42, v138
    v_fmac_f32 v235, v35, v107
    v_fmac_f32 v237, v43, v139
    v_fmac_f32 v235, v36, v108
    v_fmac_f32 v237, v44, v140
    v_fmac_f32 v235, v37, v109
    v_fmac_f32 v237, v45, v141
    v_fmac_f32 v235, v38, v110
    v_fmac_f32 v237, v46, v142
    v_fmac_f32 v235, v39, v111
    v_fmac_f32 v237, v47, v143
    v_mul_f32 v239, v48, v136
    v_mul_f32 v241, v56, v136
    s_setprio 1
    s_waitcnt vmcnt(4) lgkmcnt(0)
    v_mfma_f32_32x32x16_bf16 v[0:15], v[64:67], v[176:179], 0
    ds_read_b64_tr_b16 v[184:185], v246 offset:2048
    ds_read_b64_tr_b16 v[186:187], v246 offset:3072
    ds_read_b64_tr_b16 v[188:189], v247 offset:2048
    ds_read_b64_tr_b16 v[190:191], v247 offset:3072
    v_fmac_f32 v239, v49, v137
    v_fmac_f32 v241, v57, v137
    s_mov_b32 m0, s68
    v_mfma_f32_32x32x16_bf16 v[16:31], v[68:71], v[176:179], 0
    buffer_load_dwordx4 v222, s[4:7], s42 offen sc1 lds
    buffer_load_dwordx4 v223, s[72:75], s42 offen offset:1024 sc1 lds
    v_fmac_f32 v239, v50, v138
    v_fmac_f32 v241, v58, v138
    v_fmac_f32 v239, v51, v139
    v_fmac_f32 v241, v59, v139
    v_fmac_f32 v239, v52, v140
    v_mfma_f32_32x32x16_bf16 v[32:47], v[64:67], v[180:183], 0
    v_fmac_f32 v241, v60, v140
    v_fmac_f32 v239, v53, v141
    v_fmac_f32 v241, v61, v141
    v_fmac_f32 v239, v54, v142
    v_fmac_f32 v241, v62, v142
    v_fmac_f32 v239, v55, v143
    v_fmac_f32 v241, v63, v143
    v_mfma_f32_32x32x16_bf16 v[48:63], v[68:71], v[180:183], 0
    v_permlane32_swap_b32 v234, v236
    v_permlane32_swap_b32 v235, v237
    v_permlane32_swap_b32 v240, v238
    s_waitcnt vmcnt(4) lgkmcnt(0)
    v_mfma_f32_32x32x16_bf16 v[0:15], v[72:75], v[184:187], v[0:15]
    ds_read_b64_tr_b16 v[176:177], v246 offset:4096
    ds_read_b64_tr_b16 v[178:179], v246 offset:5120
    ds_read_b64_tr_b16 v[180:181], v247 offset:4096
    ds_read_b64_tr_b16 v[182:183], v247 offset:5120
    v_permlane32_swap_b32 v241, v239
    s_mov_b32 m0, s69
    v_mfma_f32_32x32x16_bf16 v[16:31], v[76:79], v[184:187], v[16:31]
    buffer_load_dwordx4 v224, s[4:7], s42 offen sc1 lds
    buffer_load_dwordx4 v225, s[72:75], s42 offen offset:1024 sc1 lds
    v_lshl_add_u32 v230, v252, 1, s31
    v_add_f32 v234, v234, v236
    v_add_f32 v235, v235, v237
    v_add_f32 v240, v240, v238
    v_add_f32 v241, v241, v239
    v_mfma_f32_32x32x16_bf16 v[32:47], v[72:75], v[188:191], v[32:47]
    v_cvt_pk_bf16_f32 v234, v234, v235
    v_cvt_pk_bf16_f32 v240, v240, v241
    ds_write2st64_b32 v230, v234, v240 offset0:0 offset1:1
    v_mfma_f32_32x32x16_bf16 v[48:63], v[76:79], v[188:191], v[48:63]
    s_waitcnt vmcnt(4) lgkmcnt(1)
    v_mfma_f32_32x32x16_bf16 v[0:15], v[80:83], v[176:179], v[0:15]
    ds_read_b64_tr_b16 v[184:185], v246 offset:6144
    ds_read_b64_tr_b16 v[186:187], v246 offset:7168
    ds_read_b64_tr_b16 v[188:189], v247 offset:6144
    ds_read_b64_tr_b16 v[190:191], v247 offset:7168
    s_mov_b32 m0, s70
    v_mfma_f32_32x32x16_bf16 v[16:31], v[84:87], v[176:179], v[16:31]
    buffer_load_dwordx4 v226, s[4:7], s42 offen sc1 lds
    buffer_load_dwordx4 v227, s[72:75], s42 offen offset:1024 sc1 lds
    v_mfma_f32_32x32x16_bf16 v[32:47], v[80:83], v[180:183], v[32:47]
    v_mfma_f32_32x32x16_bf16 v[48:63], v[84:87], v[180:183], v[48:63]
    s_waitcnt vmcnt(4) lgkmcnt(0)
    v_mfma_f32_32x32x16_bf16 v[0:15], v[88:91], v[184:187], v[0:15]
    ds_read_b64_tr_b16 v[176:177], v246 offset:0
    ds_read_b64_tr_b16 v[178:179], v246 offset:1024
    ds_read_b64_tr_b16 v[180:181], v247 offset:0
    ds_read_b64_tr_b16 v[182:183], v247 offset:1024
    s_mov_b32 m0, s71
    v_mfma_f32_32x32x16_bf16 v[16:31], v[92:95], v[184:187], v[16:31]
    buffer_load_dwordx4 v228, s[4:7], s42 offen sc1 lds
    buffer_load_dwordx4 v229, s[72:75], s42 offen offset:1024 sc1 lds
    v_mfma_f32_32x32x16_bf16 v[32:47], v[88:91], v[188:191], v[32:47]
    s_nop 2
    v_mul_f32 v234, v0, v144
    v_mul_f32 v236, v8, v112
    v_fmac_f32 v234, v1, v145
    v_fmac_f32 v236, v9, v113
    v_fmac_f32 v234, v2, v146
    v_fmac_f32 v236, v10, v114
    v_fmac_f32 v234, v3, v147
    v_mfma_f32_32x32x16_bf16 v[48:63], v[92:95], v[188:191], v[48:63]
    s_setprio 0
    v_fmac_f32 v236, v11, v115
    v_fmac_f32 v234, v4, v148
    v_fmac_f32 v236, v12, v116
    v_fmac_f32 v234, v5, v149
    v_fmac_f32 v236, v13, v117
    v_fmac_f32 v234, v6, v150
    v_fmac_f32 v236, v14, v118
    v_fmac_f32 v234, v7, v151
    v_fmac_f32 v236, v15, v119
    v_mul_f32 v238, v16, v160
    v_mul_f32 v240, v24, v160
    v_fmac_f32 v238, v17, v161
    v_fmac_f32 v240, v25, v161
    v_fmac_f32 v238, v18, v162
    v_fmac_f32 v240, v26, v162
    v_fmac_f32 v238, v19, v163
    v_fmac_f32 v240, v27, v163
    v_fmac_f32 v238, v20, v164
    v_fmac_f32 v240, v28, v164
    v_fmac_f32 v238, v21, v165
    v_fmac_f32 v240, v29, v165
    v_fmac_f32 v238, v22, v166
    v_fmac_f32 v240, v30, v166
    v_fmac_f32 v238, v23, v167
    v_fmac_f32 v240, v31, v167
    v_mul_f32 v235, v32, v152
    v_mul_f32 v237, v40, v120
    v_fmac_f32 v235, v33, v153
    v_fmac_f32 v237, v41, v121
    v_fmac_f32 v235, v34, v154
    v_fmac_f32 v237, v42, v122
    v_fmac_f32 v235, v35, v155
    v_fmac_f32 v237, v43, v123
    v_fmac_f32 v235, v36, v156
    v_fmac_f32 v237, v44, v124
    v_fmac_f32 v235, v37, v157
    v_fmac_f32 v237, v45, v125
    v_fmac_f32 v235, v38, v158
    v_fmac_f32 v237, v46, v126
    v_fmac_f32 v235, v39, v159
    v_fmac_f32 v237, v47, v127
    v_mul_f32 v239, v48, v168
    v_mul_f32 v241, v56, v168
    s_setprio 1
    s_waitcnt vmcnt(4) lgkmcnt(0)
    v_mfma_f32_32x32x16_bf16 v[0:15], v[64:67], v[176:179], 0
    ds_read_b64_tr_b16 v[184:185], v246 offset:2048
    ds_read_b64_tr_b16 v[186:187], v246 offset:3072
    ds_read_b64_tr_b16 v[188:189], v247 offset:2048
    ds_read_b64_tr_b16 v[190:191], v247 offset:3072
    v_fmac_f32 v239, v49, v169
    v_fmac_f32 v241, v57, v169
    s_mov_b32 m0, s68
    v_mfma_f32_32x32x16_bf16 v[16:31], v[68:71], v[176:179], 0
    buffer_load_dwordx4 v222, s[4:7], s43 offen sc1 lds
    buffer_load_dwordx4 v223, s[72:75], s43 offen offset:1024 sc1 lds
    v_fmac_f32 v239, v50, v170
    v_fmac_f32 v241, v58, v170
    v_fmac_f32 v239, v51, v171
    v_fmac_f32 v241, v59, v171
    v_fmac_f32 v239, v52, v172
    v_mfma_f32_32x32x16_bf16 v[32:47], v[64:67], v[180:183], 0
    v_fmac_f32 v241, v60, v172
    v_fmac_f32 v239, v53, v173
    v_fmac_f32 v241, v61, v173
    v_fmac_f32 v239, v54, v174
    v_fmac_f32 v241, v62, v174
    v_fmac_f32 v239, v55, v175
    v_fmac_f32 v241, v63, v175
    v_mfma_f32_32x32x16_bf16 v[48:63], v[68:71], v[180:183], 0
    s_waitcnt vmcnt(4) lgkmcnt(0)
    v_mfma_f32_32x32x16_bf16 v[0:15], v[72:75], v[184:187], v[0:15]
    ds_read_b64_tr_b16 v[176:177], v246 offset:4096
    ds_read_b64_tr_b16 v[178:179], v246 offset:5120
    ds_read_b64_tr_b16 v[180:181], v247 offset:4096
    ds_read_b64_tr_b16 v[182:183], v247 offset:5120
    s_mov_b32 m0, s69
    v_mfma_f32_32x32x16_bf16 v[16:31], v[76:79], v[184:187], v[16:31]
    buffer_load_dwordx4 v224, s[4:7], s43 offen sc1 lds
    buffer_load_dwordx4 v225, s[72:75], s43 offen offset:1024 sc1 lds
    v_mfma_f32_32x32x16_bf16 v[32:47], v[72:75], v[188:191], v[32:47]
    v_mfma_f32_32x32x16_bf16 v[48:63], v[76:79], v[188:191], v[48:63]
    s_waitcnt vmcnt(4) lgkmcnt(0)
    v_mfma_f32_32x32x16_bf16 v[0:15], v[80:83], v[176:179], v[0:15]
    ds_read_b64_tr_b16 v[184:185], v246 offset:6144
    ds_read_b64_tr_b16 v[186:187], v246 offset:7168
    ds_read_b64_tr_b16 v[188:189], v247 offset:6144
    ds_read_b64_tr_b16 v[190:191], v247 offset:7168
    s_mov_b32 m0, s70
    v_mfma_f32_32x32x16_bf16 v[16:31], v[84:87], v[176:179], v[16:31]
    buffer_load_dwordx4 v226, s[4:7], s43 offen sc1 lds
    buffer_load_dwordx4 v227, s[72:75], s43 offen offset:1024 sc1 lds
    v_mfma_f32_32x32x16_bf16 v[32:47], v[80:83], v[180:183], v[32:47]
    v_add_u32 v222, s48, v251
    ds_read2_b32 v[222:223], v222 offset0:1 offset1:3
    v_mfma_f32_32x32x16_bf16 v[48:63], v[84:87], v[180:183], v[48:63]
    s_waitcnt vmcnt(4) lgkmcnt(1)
    v_mfma_f32_32x32x16_bf16 v[0:15], v[88:91], v[184:187], v[0:15]
    ds_read_b64_tr_b16 v[176:177], v246 offset:0
    ds_read_b64_tr_b16 v[178:179], v246 offset:1024
    ds_read_b64_tr_b16 v[180:181], v247 offset:0
    ds_read_b64_tr_b16 v[182:183], v247 offset:1024
    s_mov_b32 m0, s71
    v_mfma_f32_32x32x16_bf16 v[16:31], v[92:95], v[184:187], v[16:31]
    buffer_load_dwordx4 v228, s[4:7], s43 offen sc1 lds
    buffer_load_dwordx4 v229, s[72:75], s43 offen offset:1024 sc1 lds
    s_waitcnt lgkmcnt(4)
    v_mad_u32_u16 v222, v222, s39, v248 op_sel:[1,0,0,0]
    v_mad_u32_u16 v223, v223, s39, v248 op_sel:[1,0,0,0]
    v_mfma_f32_32x32x16_bf16 v[32:47], v[88:91], v[188:191], v[32:47]
    v_add_u32 v224, s49, v251
    ds_read2_b32 v[224:225], v224 offset0:1 offset1:3
    v_mul_f32 v242, v0, v144
    v_fma_f32 v238, v8, v160, -v238
    v_fmac_f32 v242, v1, v145
    v_fmac_f32 v238, v9, v161
    v_fmac_f32 v242, v2, v146
    v_mfma_f32_32x32x16_bf16 v[48:63], v[92:95], v[188:191], v[48:63]
    s_setprio 0
    v_fmac_f32 v238, v10, v162
    v_fmac_f32 v242, v3, v147
    v_fmac_f32 v238, v11, v163
    v_fmac_f32 v242, v4, v148
    v_fmac_f32 v238, v12, v164
    v_fmac_f32 v242, v5, v149
    v_fmac_f32 v238, v13, v165
    v_fmac_f32 v242, v6, v150
    v_fmac_f32 v238, v14, v166
    v_fmac_f32 v242, v7, v151
    v_fmac_f32 v238, v15, v167
    v_fmac_f32 v236, v16, v112
    v_mul_f32 v244, v24, v160
    v_fmac_f32 v236, v17, v113
    v_fmac_f32 v244, v25, v161
    v_fmac_f32 v236, v18, v114
    v_fmac_f32 v244, v26, v162
    v_fmac_f32 v236, v19, v115
    v_fmac_f32 v244, v27, v163
    v_fmac_f32 v236, v20, v116
    v_fmac_f32 v244, v28, v164
    v_fmac_f32 v236, v21, v117
    v_fmac_f32 v244, v29, v165
    v_fmac_f32 v236, v22, v118
    v_fmac_f32 v244, v30, v166
    v_fmac_f32 v236, v23, v119
    v_fmac_f32 v244, v31, v167
    v_mul_f32 v243, v32, v152
    v_fma_f32 v239, v40, v168, -v239
    v_fmac_f32 v243, v33, v153
    v_fmac_f32 v239, v41, v169
    v_fmac_f32 v243, v34, v154
    v_fmac_f32 v239, v42, v170
    v_fmac_f32 v243, v35, v155
    v_fmac_f32 v239, v43, v171
    v_fmac_f32 v243, v36, v156
    v_fmac_f32 v239, v44, v172
    v_fmac_f32 v243, v37, v157
    v_fmac_f32 v239, v45, v173
    v_fmac_f32 v243, v38, v158
    v_fmac_f32 v239, v46, v174
    v_fmac_f32 v243, v39, v159
    v_fmac_f32 v239, v47, v175
    v_fmac_f32 v237, v48, v120
    v_mul_f32 v245, v56, v168
    v_fmac_f32 v237, v49, v121
    v_fmac_f32 v245, v57, v169
    v_fmac_f32 v237, v50, v122
    v_fmac_f32 v245, v58, v170
    v_fmac_f32 v237, v51, v123
    s_setprio 1
    s_waitcnt vmcnt(4) lgkmcnt(1)
    v_mfma_f32_32x32x16_bf16 v[0:15], v[64:67], v[176:179], 0
    ds_read_b64_tr_b16 v[184:185], v246 offset:2048
    ds_read_b64_tr_b16 v[186:187], v246 offset:3072
    ds_read_b64_tr_b16 v[188:189], v247 offset:2048
    ds_read_b64_tr_b16 v[190:191], v247 offset:3072
    v_fmac_f32 v245, v59, v171
    v_fmac_f32 v237, v52, v124
    s_mov_b32 m0, s68
    v_mfma_f32_32x32x16_bf16 v[16:31], v[68:71], v[176:179], 0
    buffer_load_dwordx4 v222, s[4:7], s44 offen sc1 lds
    buffer_load_dwordx4 v223, s[72:75], s44 offen offset:1024 sc1 lds
    s_waitcnt lgkmcnt(4)
    v_mad_u32_u16 v224, v224, s39, v248 op_sel:[1,0,0,0]
    v_mad_u32_u16 v225, v225, s39, v248 op_sel:[1,0,0,0]
    v_fmac_f32 v245, v60, v172
    v_fmac_f32 v237, v53, v125
    v_mfma_f32_32x32x16_bf16 v[32:47], v[64:67], v[180:183], 0
    v_add_u32 v226, s50, v251
    ds_read2_b32 v[226:227], v226 offset0:1 offset1:3
    v_fmac_f32 v245, v61, v173
    v_fmac_f32 v237, v54, v126
    v_fmac_f32 v245, v62, v174
    v_fmac_f32 v237, v55, v127
    v_fmac_f32 v245, v63, v175
    v_mfma_f32_32x32x16_bf16 v[48:63], v[68:71], v[180:183], 0
    v_permlane32_swap_b32 v242, v234
    v_permlane32_swap_b32 v243, v235
    v_add_f32 v242, v242, v234
    v_add_f32 v243, v243, v235
    s_waitcnt vmcnt(4) lgkmcnt(1)
    v_mfma_f32_32x32x16_bf16 v[0:15], v[72:75], v[184:187], v[0:15]
    ds_read_b64_tr_b16 v[176:177], v246 offset:4096
    ds_read_b64_tr_b16 v[178:179], v246 offset:5120
    ds_read_b64_tr_b16 v[180:181], v247 offset:4096
    ds_read_b64_tr_b16 v[182:183], v247 offset:5120
    v_cvt_pk_bf16_f32 v242, v242, v243
    ds_write_b32 v230, v242 offset:512
    s_mov_b32 m0, s69
    v_mfma_f32_32x32x16_bf16 v[16:31], v[76:79], v[184:187], v[16:31]
    buffer_load_dwordx4 v224, s[4:7], s45 offen sc1 lds
    buffer_load_dwordx4 v225, s[72:75], s45 offen offset:1024 sc1 lds
    s_waitcnt lgkmcnt(5)
    v_mad_u32_u16 v226, v226, s39, v248 op_sel:[1,0,0,0]
    v_mad_u32_u16 v227, v227, s39, v248 op_sel:[1,0,0,0]
    v_mfma_f32_32x32x16_bf16 v[32:47], v[72:75], v[188:191], v[32:47]
    v_mfma_f32_32x32x16_bf16 v[48:63], v[76:79], v[188:191], v[48:63]
    s_waitcnt vmcnt(4) lgkmcnt(1)
    v_mfma_f32_32x32x16_bf16 v[0:15], v[80:83], v[176:179], v[0:15]
    ds_read_b64_tr_b16 v[184:185], v246 offset:6144
    ds_read_b64_tr_b16 v[186:187], v246 offset:7168
    ds_read_b64_tr_b16 v[188:189], v247 offset:6144
    ds_read_b64_tr_b16 v[190:191], v247 offset:7168
    s_mov_b32 s32, s31
    s_mov_b32 s31, s35
    s_mov_b32 m0, s70
    v_mfma_f32_32x32x16_bf16 v[16:31], v[84:87], v[176:179], v[16:31]
    buffer_load_dwordx4 v226, s[4:7], s46 offen sc1 lds
    buffer_load_dwordx4 v227, s[72:75], s46 offen offset:1024 sc1 lds
    s_sub_u32 s26, s48, s29
    s_mov_b32 s29, s48
    s_mov_b32 s30, s3
    s_bfe_u32 s56, s3, 0x40012
    v_mfma_f32_32x32x16_bf16 v[32:47], v[80:83], v[180:183], v[32:47]
    s_cmp_lg_u32 s36, 0
    s_cselect_b32 s56, s56, 0
    v_mfma_f32_32x32x16_bf16 v[48:63], v[84:87], v[180:183], v[48:63]
    s_waitcnt vmcnt(4) lgkmcnt(0)
    v_mfma_f32_32x32x16_bf16 v[0:15], v[88:91], v[184:187], v[0:15]
    ds_read_b64_tr_b16 v[176:177], v246 offset:0
    ds_read_b64_tr_b16 v[178:179], v246 offset:1024
    ds_read_b64_tr_b16 v[180:181], v247 offset:0
    ds_read_b64_tr_b16 v[182:183], v247 offset:1024
    s_mov_b32 m0, s71
    v_mfma_f32_32x32x16_bf16 v[16:31], v[92:95], v[184:187], v[16:31]
    s_cmp_eq_u32 s33, 4
    s_cbranch_scc1 K2_g4_137
    buffer_load_dwordx4 v224, s[4:7], s47 offen sc1 lds
    buffer_load_dwordx4 v225, s[72:75], s47 offen offset:1024 sc1 lds
K2_back_138:
    v_mfma_f32_32x32x16_bf16 v[32:47], v[88:91], v[188:191], v[32:47]
    s_nop 0
    v_mul_f32 v242, v0, v144
    v_fma_f32 v240, v8, v160, -v240
    v_fmac_f32 v242, v1, v145
    v_fmac_f32 v240, v9, v161
    v_fmac_f32 v242, v2, v146
    v_fmac_f32 v240, v10, v162
    v_fmac_f32 v242, v3, v147
    v_mfma_f32_32x32x16_bf16 v[48:63], v[92:95], v[188:191], v[48:63]
    s_setprio 0
    v_fmac_f32 v240, v11, v163
    v_fmac_f32 v242, v4, v148
    v_fmac_f32 v240, v12, v164
    v_fmac_f32 v242, v5, v149
    v_fmac_f32 v240, v13, v165
    v_fmac_f32 v242, v6, v150
    v_fmac_f32 v240, v14, v166
    v_fmac_f32 v242, v7, v151
    v_fmac_f32 v240, v15, v167
    v_add_u32 v249, s26, v249
    v_add_u32 v250, s26, v250
    v_fma_f32 v244, v16, v160, -v244
    v_fmac_f32 v236, v24, v112
    v_fmac_f32 v244, v17, v161
    v_fmac_f32 v236, v25, v113
    v_fmac_f32 v244, v18, v162
    v_fmac_f32 v236, v26, v114
    v_fmac_f32 v244, v19, v163
    v_fmac_f32 v236, v27, v115
    v_fmac_f32 v244, v20, v164
    v_fmac_f32 v236, v28, v116
    v_fmac_f32 v244, v21, v165
    v_fmac_f32 v236, v29, v117
    v_fmac_f32 v244, v22, v166
    v_fmac_f32 v236, v30, v118
    v_fmac_f32 v244, v23, v167
    v_fmac_f32 v236, v31, v119
    ds_read_b64_tr_b16 v[0:1], v249 offset:0
    ds_read_b64_tr_b16 v[2:3], v249 offset:32
    ds_read_u16_d16_hi v16, v250 offset:0
    v_mul_f32 v243, v32, v152
    v_fma_f32 v241, v40, v168, -v241
    v_fmac_f32 v243, v33, v153
    v_fmac_f32 v241, v41, v169
    v_fmac_f32 v243, v34, v154
    v_fmac_f32 v241, v42, v170
    v_fmac_f32 v243, v35, v155
    v_fmac_f32 v241, v43, v171
    v_fmac_f32 v243, v36, v156
    v_fmac_f32 v241, v44, v172
    v_fmac_f32 v243, v37, v157
    v_fmac_f32 v241, v45, v173
    v_fmac_f32 v243, v38, v158
    v_fmac_f32 v241, v46, v174
    v_fmac_f32 v243, v39, v159
    v_fmac_f32 v241, v47, v175
    ds_read_b64_tr_b16 v[4:5], v249 offset:512
    ds_read_b64_tr_b16 v[6:7], v249 offset:544
    ds_read_u16_d16_hi v17, v250 offset:128
    v_fma_f32 v245, v48, v168, -v245
    v_fmac_f32 v237, v56, v120
    v_fmac_f32 v245, v49, v169
    v_fmac_f32 v237, v57, v121
    v_fmac_f32 v245, v50, v170
    v_fmac_f32 v237, v58, v122
    v_fmac_f32 v245, v51, v171
    v_fmac_f32 v237, v59, v123
    v_fmac_f32 v245, v52, v172
    v_fmac_f32 v237, v60, v124
    v_fmac_f32 v245, v53, v173
    v_fmac_f32 v237, v61, v125
    v_fmac_f32 v245, v54, v174
    v_fmac_f32 v237, v62, v126
    v_fmac_f32 v245, v55, v175
    v_fmac_f32 v237, v63, v127
    s_cmp_eq_u32 s56, 5
    s_cbranch_scc1 K2_U21
    s_cmp_eq_u32 s56, 6
    s_cbranch_scc1 K2_U3h1
    s_branch K2_DSP1
K2_FLGR:
    s_sub_u32 s27, s27, 16
    s_cbranch_scc1 K2_END
    buffer_load_dwordx4 v[56:59], v60, s[8:11], s64 offen sc1
    s_branch K2_FLGW
K2_FLGY:
    v_mov_b32 v56, s2
    v_mov_b32 v57, 7178240
    s_mov_b64 exec, 1
    buffer_store_dword v56, v57, s[8:11], 0 offen sc1
    s_mov_b64 exec, -1
    s_branch K2_FLGOK
K2_nul_93:
    s_mov_b32 s58, 63
    s_mov_b32 s36, 0
    s_branch K2_back_96
K2_spin_94:
    s_sub_u32 s27, s27, 1
    s_cbranch_scc1 K2_END
    ds_read_b32 v232, v254
    s_waitcnt lgkmcnt(0)
    s_branch K2_chk_95
K2_dyn_91:
    v_lshl_add_u32 v254, v252, 1, s53
    v_bfe_u32 v255, v252, 4, 1
    s_mov_b64 exec, 0x1ff
    ds_add_rtn_u32 v232, v254, v255
    s_mov_b64 exec, -1
    s_waitcnt lgkmcnt(0)
    v_readlane_b32 s58, v232, 8
    s_nop 0
    s_cmp_lt_u32 s58, s22
    s_cbranch_scc0 K2_nul_93
    s_nop 0
    v_readlane_b32 s3, v253, s58
    s_nop 0
    s_bfe_u32 s58, s3, 0x60016
    s_and_b32 s59, s58, 7
    s_lshr_b32 s60, s58, 3
K2_chk_95:
    v_readlane_b32 s61, v232, s59
    s_nop 0
    s_cmp_gt_u32 s61, s60
    s_cbranch_scc0 K2_spin_94
K2_back_96:
    s_mov_b32 s34, 1
    s_branch K2_back_92
K2_rare_97:
    s_cmp_eq_u32 s33, 4
    s_cbranch_scc1 K2_four_99
    s_mov_b32 s49, s48
    s_xor_b32 s45, s44, 256
    s_xor_b32 s46, s44, 512
    s_xor_b32 s47, s44, 768
    s_branch K2_back_98
K2_four_99:
    s_add_u32 s50, s48, 256
    s_mov_b32 s46, s44
    s_mov_b32 s47, s44
    s_branch K2_back_98
K2_dum_100:
    v_mov_b32 v232, -1
    s_mov_b32 m0, 163312
    s_mov_b64 exec, 1
    buffer_load_dwordx4 v232, s[16:19], 0 offen lds
    buffer_load_dwordx4 v232, s[16:19], 0 offen lds
    s_mov_b64 exec, -1
    s_branch K2_back_102
K2_a4_101:
    v_add_u32 v254, s48, v230
    ds_read_b32 v254, v254 offset:4
    s_lshr_b32 s65, s3, 28
    s_mul_i32 s66, s22, 2080
    s_lshl_b32 s65, s65, 9
    s_add_u32 s65, s65, s66
    s_add_u32 s65, s65, 65536
    s_mov_b32 m0, s65
    s_mov_b32 exec_hi, 0
    s_waitcnt lgkmcnt(0)
    v_or_b32 v254, v254, v231
    buffer_load_dwordx4 v254, s[16:19], 0 offen  lds
    s_mov_b32 exec_hi, -1
    s_branch K2_b4_103
K2_g4_104:
    s_add_u32 s51, s48, 384
    v_add_u32 v228, s51, v251
    ds_read2_b32 v[228:229], v228 offset0:1 offset1:3
    s_waitcnt lgkmcnt(0)
    v_mad_u32_u16 v228, v228, s39, v248 op_sel:[1,0,0,0]
    v_mad_u32_u16 v229, v229, s39, v248 op_sel:[1,0,0,0]
    buffer_load_dwordx4 v228, s[4:7], s47 offen sc1 lds
    buffer_load_dwordx4 v229, s[72:75], s47 offen offset:1024 sc1 lds
    s_branch K2_back_105
K2_nul_108:
    s_mov_b32 s58, 63
    s_mov_b32 s36, 0
    s_branch K2_back_111
K2_spin_109:
    s_sub_u32 s27, s27, 1
    s_cbranch_scc1 K2_END
    ds_read_b32 v232, v254
    s_waitcnt lgkmcnt(0)
    s_branch K2_chk_110
K2_dyn_106:
    v_lshl_add_u32 v254, v252, 1, s53
    v_bfe_u32 v255, v252, 4, 1
    s_mov_b64 exec, 0x1ff
    ds_add_rtn_u32 v232, v254, v255
    s_mov_b64 exec, -1
    s_waitcnt lgkmcnt(0)
    v_readlane_b32 s58, v232, 8
    s_nop 0
    s_cmp_lt_u32 s58, s22
    s_cbranch_scc0 K2_nul_108
    s_nop 0
    v_readlane_b32 s3, v253, s58
    s_nop 0
    s_bfe_u32 s58, s3, 0x60016
    s_and_b32 s59, s58, 7
    s_lshr_b32 s60, s58, 3
K2_chk_110:
    v_readlane_b32 s61, v232, s59
    s_nop 0
    s_cmp_gt_u32 s61, s60
    s_cbranch_scc0 K2_spin_109
K2_back_111:
    s_mov_b32 s34, 1
    s_branch K2_back_107
K2_rare_112:
    s_cmp_eq_u32 s33, 4
    s_cbranch_scc1 K2_four_114
    s_mov_b32 s49, s48
    s_xor_b32 s45, s44, 256
    s_xor_b32 s46, s44, 512
    s_xor_b32 s47, s44, 768
    s_branch K2_back_113
K2_four_114:
    s_add_u32 s50, s48, 256
    s_mov_b32 s46, s44
    s_mov_b32 s47, s44
    s_branch K2_back_113
K2_g4_115:
    s_add_u32 s51, s48, 384
    v_add_u32 v228, s51, v251
    ds_read2_b32 v[228:229], v228 offset0:1 offset1:3
    s_waitcnt lgkmcnt(0)
    v_mad_u32_u16 v228, v228, s39, v248 op_sel:[1,0,0,0]
    v_mad_u32_u16 v229, v229, s39, v248 op_sel:[1,0,0,0]
    buffer_load_dwordx4 v228, s[4:7], s47 offen sc1 lds
    buffer_load_dwordx4 v229, s[72:75], s47 offen offset:1024 sc1 lds
    s_branch K2_back_116
K2_dum_117:
    v_mov_b32 v232, -1
    s_mov_b32 m0, 163312
    s_mov_b64 exec, 1
    buffer_load_dwordx4 v232, s[16:19], 0 offen lds
    buffer_load_dwordx4 v232, s[16:19], 0 offen lds
    s_mov_b64 exec, -1
    s_branch K2_back_119
K2_a4_118:
    v_add_u32 v254, s48, v230
    ds_read_b32 v254, v254 offset:4
    s_lshr_b32 s65, s3, 28
    s_mul_i32 s66, s22, 2080
    s_lshl_b32 s65, s65, 9
    s_add_u32 s65, s65, s66
    s_add_u32 s65, s65, 65536
    s_mov_b32 m0, s65
    s_mov_b32 exec_hi, 0
    s_waitcnt lgkmcnt(0)
    v_or_b32 v254, v254, v231
    buffer_load_dwordx4 v254, s[16:19], 0 offen  lds
    s_mov_b32 exec_hi, -1
    s_branch K2_b4_120
K2_nul_121:
    s_mov_b32 s3, 949760
    s_mov_b32 s36, 0
    s_branch K2_back_124
K2_spin_122:
    s_sub_u32 s27, s27, 1
    s_cbranch_scc1 K2_END
    ds_read_b32 v232, v254
    s_waitcnt lgkmcnt(0)
    s_branch K2_chk_123
K2_rare_125:
    s_cmp_eq_u32 s33, 4
    s_cbranch_scc1 K2_four_127
    s_mov_b32 s49, s48
    s_xor_b32 s45, s44, 256
    s_xor_b32 s46, s44, 512
    s_xor_b32 s47, s44, 768
    s_branch K2_back_126
K2_four_127:
    s_add_u32 s50, s48, 256
    s_mov_b32 s46, s44
    s_mov_b32 s47, s44
    s_branch K2_back_126
K2_g4_128:
    s_add_u32 s51, s48, 384
    v_add_u32 v228, s51, v251
    ds_read2_b32 v[228:229], v228 offset0:1 offset1:3
    s_waitcnt lgkmcnt(0)
    v_mad_u32_u16 v228, v228, s39, v248 op_sel:[1,0,0,0]
    v_mad_u32_u16 v229, v229, s39, v248 op_sel:[1,0,0,0]
    buffer_load_dwordx4 v228, s[4:7], s47 offen sc1 lds
    buffer_load_dwordx4 v229, s[72:75], s47 offen offset:1024 sc1 lds
    s_branch K2_back_129
K2_nul_130:
    s_mov_b32 s3, 949760
    s_mov_b32 s36, 0
    s_branch K2_back_133
K2_spin_131:
    s_sub_u32 s27, s27, 1
    s_cbranch_scc1 K2_END
    ds_read_b32 v232, v254
    s_waitcnt lgkmcnt(0)
    s_branch K2_chk_132
K2_rare_134:
    s_cmp_eq_u32 s33, 4
    s_cbranch_scc1 K2_four_136
    s_mov_b32 s49, s48
    s_xor_b32 s45, s44, 256
    s_xor_b32 s46, s44, 512
    s_xor_b32 s47, s44, 768
    s_branch K2_back_135
K2_four_136:
    s_add_u32 s50, s48, 256
    s_mov_b32 s46, s44
    s_mov_b32 s47, s44
    s_branch K2_back_135
K2_g4_137:
    s_add_u32 s51, s48, 384
    v_add_u32 v228, s51, v251
    ds_read2_b32 v[228:229], v228 offset0:1 offset1:3
    s_waitcnt lgkmcnt(0)
    v_mad_u32_u16 v228, v228, s39, v248 op_sel:[1,0,0,0]
    v_mad_u32_u16 v229, v229, s39, v248 op_sel:[1,0,0,0]
    buffer_load_dwordx4 v228, s[4:7], s47 offen sc1 lds
    buffer_load_dwordx4 v229, s[72:75], s47 offen offset:1024 sc1 lds
    s_branch K2_back_138
K2_END:
    s_endpgm
.section .rodata,"a"
.p2align 6
.amdhsa_kernel standalone__tensor_product_equiv_equiformer__graph_kernel
  .amdhsa_next_free_vgpr 256
  .amdhsa_next_free_sgpr 102
  .amdhsa_accum_offset 256
  .amdhsa_group_segment_fixed_size 0
  .amdhsa_kernarg_size 96
  .amdhsa_user_sgpr_count 2
  .amdhsa_user_sgpr_kernarg_segment_ptr 1
  .amdhsa_system_sgpr_workgroup_id_x 1
  .amdhsa_float_denorm_mode_32 3
.end_amdhsa_kernel
```

```asm
; @launch grid=(256,1,1) block=(512,1,1) lds=163840
.amdgcn_target "amdgcn-amd-amdhsa--gfx950"
.text
.globl standalone__tensor_product_equiv_equiformer__graph_kernel
.p2align 8
.type standalone__tensor_product_equiv_equiformer__graph_kernel,@function
standalone__tensor_product_equiv_equiformer__graph_kernel:
    s_cmp_ge_u32 s2, 256
    s_cbranch_scc1 K2_END
    s_load_dwordx16 s[80:95], s[0:1], 0
    s_load_dwordx4 s[96:99], s[0:1], 72
    s_load_dwordx2 s[100:101], s[0:1], 88
    v_lshrrev_b32 v1, 6, v0
    s_mov_b32 s54, s2
    v_readfirstlane_b32 s20, v1
    s_mov_b64 exec, 0
    s_cmp_eq_u32 s20, 0
    s_cbranch_scc1 K2_PAD_S1
    s_cmp_eq_u32 s20, 1
    s_cbranch_scc1 K2_PAD_S2
    s_cmp_eq_u32 s20, 5
    s_cbranch_scc1 K2_PAD_H1
    s_cmp_eq_u32 s20, 6
    s_cbranch_scc1 K2_PAD_H2
    s_cmp_eq_u32 s20, 2
    s_cbranch_scc1 K2_PAD_H3
KS_HOP0:
    s_mov_b64 exec, -1
    v_and_b32 v8, 63, v0
    v_lshlrev_b32 v9, 4, v8
    v_mov_b32 v6, 0
    v_lshlrev_b32 v5, 4, v0
    v_mul_u32_u24 v4, 24, v0
    s_mul_i32 s64, s2, 5120
    s_mul_i32 s65, s2, 7680
    v_mov_b32 v176, v8
    v_mov_b32 v177, v0
    s_movk_i32 s39, 1024
    s_lshl_b32 s37, s20, 13
    s_mov_b32 s53, 163264
    s_lshl_b32 s52, s20, 2
    s_add_u32 s52, s52, s53
    s_add_u32 s68, s37, 0
    s_add_u32 s69, s37, 2048
    s_add_u32 s70, s37, 4096
    s_add_u32 s71, s37, 6144
    s_waitcnt lgkmcnt(0)
    s_mov_b32 s8, s100
    s_and_b32 s9, s101, 0xffff
    s_mov_b32 s10, 37748736
    s_mov_b32 s11, 0x20000
    s_cmp_lg_u32 s20, 7
    s_cbranch_scc1 KS_NOTAG
    s_mov_b32 s24, 7178240
    s_mov_b64 exec, 1
    buffer_load_dword v14, v6, s[8:11], s24 offen sc1
    s_mov_b64 exec, -1
    s_mov_b32 s60, s98
    s_and_b32 s61, s99, 0xffff
    s_mov_b32 s62, 256
    s_mov_b32 s63, 0x20000
    s_barrier
    v_mov_b32 v76, 0
    v_mov_b32 v77, -1
    v_lshlrev_b32 v78, 2, v8
    v_add_u32 v78, 163072, v78
    s_mov_b64 exec, 0x1ff
    ds_write_b32 v78, v76 offset:192
    s_mov_b32 exec_lo, 1
    ds_write_b32 v78, v76 offset:232
    s_mov_b32 exec_lo, -1
    ds_write_b32 v78, v77 offset:256
    s_mov_b64 exec, -1
    s_mov_b32 exec_hi, 0xffff
    ds_write_b32 v78, v76
    s_mov_b64 exec, 1
    ds_write_b32 v78, v76 offset:228
    s_mov_b64 exec, -1
    s_mov_b64 exec, 1
    buffer_load_dword v15, v6, s[60:63], 0 offen sc1
    v_mov_b32 v12, 163456
    s_mov_b32 s24, 1664525
    s_waitcnt vmcnt(1)
    v_mul_lo_u32 v59, v14, s24
    v_add_u32 v59, 1013904223, v59
    ds_write2_b32 v12, v59, v6 offset0:0 offset1:1
    s_waitcnt lgkmcnt(0)
    s_barrier
    s_waitcnt vmcnt(0)
    v_mov_b32 v62, v15
    ds_write_b32 v12, v15 offset:4
    v_cmp_ne_u32 vcc, 0, v15
    s_mov_b32 s24, 0x40000
    s_waitcnt lgkmcnt(0)
    s_barrier
    s_cbranch_vccnz KS_FLOK
KS_FLW:
    s_sub_u32 s24, s24, 1
    s_cbranch_scc1 K2_END
    buffer_load_dword v62, v6, s[60:63], 0 offen sc1
    s_waitcnt vmcnt(0)
    v_cmp_ne_u32 vcc, 0, v62
    s_nop 0
    s_cbranch_vccz KS_FLW
    ds_write_b32 v12, v62 offset:4
KS_FLOK:
    s_mov_b64 exec, -1
    s_branch KS_JOIN
KS_H0:
    s_barrier
    s_branch KS_HELP
K2_PAD_S1:
    s_branch KS_HOP0
KS_NOTAG:
    s_cmp_ge_u32 s20, 5
    s_cbranch_scc1 KS_HELP
    s_cmp_ge_u32 s2, 250
    s_cbranch_scc1 KS_IDLE
    s_mov_b32 s40, s88
    s_and_b32 s41, s89, 0xffff
    s_mov_b32 s42, 1280000
    s_mov_b32 s43, 0x20000
    buffer_load_dwordx4 v[12:15], v5, s[40:43], s64 offen
    s_mov_b32 s44, s86
    s_and_b32 s45, s87, 0xffff
    s_mov_b32 s46, 1280000
    s_mov_b32 s47, 0x20000
    s_mov_b32 s48, s82
    s_and_b32 s49, s83, 0xffff
    s_mov_b32 s50, 1920000
    s_mov_b32 s51, 0x20000
    buffer_load_dwordx4 v[16:19], v5, s[44:47], s64 offen
    buffer_load_dwordx4 v[20:23], v4, s[48:51], s65 offen
    buffer_load_dwordx2 v[24:25], v4, s[48:51], s65 offen offset:16
    v_lshlrev_b32 v2, 2, v0
    s_lshl_b32 s64, s64, 3
    v_lshl_add_u32 v3, v0, 7, s64
    v_mov_b32 v7, 1
    s_cmp_eq_u32 s20, 4
    s_cbranch_scc1 KS_NOCLR
    ds_write_b32 v2, v6
KS_NOCLR:
    s_waitcnt lgkmcnt(0)
    s_barrier
    s_mov_b64 exec, 0
    s_cmp_eq_u32 s20, 0
    s_cbranch_scc1 K2_PAD_B3
    s_cmp_eq_u32 s20, 1
    s_cbranch_scc1 K2_PAD_LD
    s_cmp_eq_u32 s20, 2
    s_cbranch_scc1 K2_PAD_NW
    s_cmp_eq_u32 s20, 3
    s_cbranch_scc1 K2_PAD_SC
    s_cmp_eq_u32 s20, 4
    s_cbranch_scc1 K2_PAD_SD
KS_HOP:
    s_mov_b64 exec, -1
    s_mov_b32 s58, 214749
    s_movk_i32 s59, 625
    s_waitcnt vmcnt(3)
    v_mul_u32_u24 v28, s58, v12
    v_and_b32 v40, 0xffffff, v28
    v_lshrrev_b32 v32, 26, v28
    v_add_u32 v40, 8187281, v40
    v_bfe_u32 v36, v28, 24, 2
    v_lshlrev_b32 v32, 2, v32
    v_lshrrev_b32 v40, 24, v40
    v_lshl_or_b32 v32, v36, 8, v32
    v_lshl_or_b32 v32, v40, 7, v32
    ds_add_rtn_u32 v36, v32, v7
    v_mul_u32_u24 v29, s58, v13
    v_and_b32 v41, 0xffffff, v29
    v_lshrrev_b32 v33, 26, v29
    v_add_u32 v41, 8187281, v41
    v_bfe_u32 v37, v29, 24, 2
    v_lshlrev_b32 v33, 2, v33
    v_lshrrev_b32 v41, 24, v41
    v_lshl_or_b32 v33, v37, 8, v33
    v_lshl_or_b32 v33, v41, 7, v33
    ds_add_rtn_u32 v37, v33, v7
    v_mul_u32_u24 v30, s58, v14
    v_and_b32 v42, 0xffffff, v30
    v_lshrrev_b32 v34, 26, v30
    v_add_u32 v42, 8187281, v42
    v_bfe_u32 v38, v30, 24, 2
    v_lshlrev_b32 v34, 2, v34
    v_lshrrev_b32 v42, 24, v42
    v_lshl_or_b32 v34, v38, 8, v34
    v_lshl_or_b32 v34, v42, 7, v34
    ds_add_rtn_u32 v38, v34, v7
    v_mul_u32_u24 v31, s58, v15
    v_and_b32 v43, 0xffffff, v31
    v_lshrrev_b32 v35, 26, v31
    v_add_u32 v43, 8187281, v43
    v_bfe_u32 v39, v31, 24, 2
    v_lshlrev_b32 v35, 2, v35
    v_lshrrev_b32 v43, 24, v43
    v_lshl_or_b32 v35, v39, 8, v35
    v_lshl_or_b32 v35, v43, 7, v35
    ds_add_rtn_u32 v39, v35, v7
    v_lshrrev_b32 v28, 24, v28
    v_mad_u32_u24 v28, v28, s59, 7
    v_lshrrev_b32 v28, 3, v28
    v_mad_u32_u24 v28, v40, 40, v28
    v_sub_u32 v28, v12, v28
    v_add_u32 v12, 0, v3
    v_lshl_or_b32 v28, v28, 26, v12
    v_lshrrev_b32 v29, 24, v29
    v_mad_u32_u24 v29, v29, s59, 7
    v_lshrrev_b32 v29, 3, v29
    v_mad_u32_u24 v29, v41, 40, v29
    v_sub_u32 v29, v13, v29
    v_add_u32 v13, 32, v3
    v_lshl_or_b32 v29, v29, 26, v13
    v_lshrrev_b32 v30, 24, v30
    v_mad_u32_u24 v30, v30, s59, 7
    v_lshrrev_b32 v30, 3, v30
    v_mad_u32_u24 v30, v42, 40, v30
    v_sub_u32 v30, v14, v30
    v_add_u32 v14, 64, v3
    v_lshl_or_b32 v30, v30, 26, v14
    v_lshrrev_b32 v31, 24, v31
    v_mad_u32_u24 v31, v31, s59, 7
    v_lshrrev_b32 v31, 3, v31
    v_mad_u32_u24 v31, v43, 40, v31
    v_sub_u32 v31, v15, v31
    v_add_u32 v15, 96, v3
    v_lshl_or_b32 v31, v31, 26, v15
K2_PAD_S2:
    s_cbranch_execz KS_HOP0
    v_mov_b32 v59, 163456
    s_mul_i32 s65, s2, 1152
    s_add_u32 s65, s65, 6291456
    s_mul_i32 s64, s2, 20608
    s_waitcnt lgkmcnt(0)
    s_barrier
    ds_read_b128 v[40:43], v9
    ds_read_b32 v59, v59
    s_waitcnt lgkmcnt(1)
    v_add_u32 v45, v40, v41
    v_add_u32 v46, v45, v42
    v_add_u32 v47, v46, v43
    v_mov_b32 v58, v47
    s_nop 1
    v_add_u32_dpp v58, v58, v58 row_shr:1 row_mask:0xf bank_mask:0xf bound_ctrl:0
    s_nop 1
    v_add_u32_dpp v58, v58, v58 row_shr:2 row_mask:0xf bank_mask:0xf bound_ctrl:0
    s_nop 1
    v_add_u32_dpp v58, v58, v58 row_shr:4 row_mask:0xf bank_mask:0xf bound_ctrl:0
    s_nop 1
    v_add_u32_dpp v58, v58, v58 row_shr:8 row_mask:0xf bank_mask:0xf bound_ctrl:0
    s_nop 1
    v_add_u32_dpp v58, v58, v58 row_bcast:15 row_mask:0xa bank_mask:0xf
    s_nop 1
    v_add_u32_dpp v58, v58, v58 row_bcast:31 row_mask:0xc bank_mask:0xf
    v_sub_u32 v48, v58, v47
    v_add_u32 v49, v48, v40
    v_add_u32 v50, v48, v45
    v_add_u32 v51, v48, v46
    ds_write_b128 v9, v[48:51] offset:1024
    s_waitcnt lgkmcnt(1)
    s_cmp_lg_u32 s20, 4
    s_cbranch_scc1 KS_NOPUB
    v_lshl_or_b32 v56, v49, 11, v48
    v_lshl_or_b32 v57, v51, 11, v50
    v_lshl_or_b32 v56, v59, 22, v56
    v_lshl_or_b32 v57, v59, 22, v57
    buffer_store_dwordx4 v[56:59], v9, s[8:11], s65 offen sc1
KS_NOPUB:
    s_waitcnt lgkmcnt(0)
    ds_read_b32 v32, v32 offset:1024
    ds_read_b32 v33, v33 offset:1024
    ds_read_b32 v34, v34 offset:1024
    ds_read_b32 v35, v35 offset:1024
    s_cbranch_scc1 KS_PUB0
    s_waitcnt vmcnt(1)
    s_branch KS_PUB1
KS_PUB0:
    s_waitcnt vmcnt(0)
KS_PUB1:
    v_and_b32 v60, 0xffff, v59
    v_and_b32 v61, 0xffff0000, v59
    s_mov_b32 s58, 0xffff0000
    v_mov_b32 v40, v20
    v_lshl_or_b32 v41, v21, 16, v60
    v_or_b32 v42, v61, v16
    v_mov_b32 v43, v28
    v_alignbit_b32 v44, v22, v21, 16
    v_and_or_b32 v45, v22, s58, v60
    v_or_b32 v46, v61, v17
    v_mov_b32 v47, v29
    v_mov_b32 v48, v23
    v_lshl_or_b32 v49, v24, 16, v60
    v_or_b32 v50, v61, v18
    v_mov_b32 v51, v30
    v_alignbit_b32 v52, v25, v24, 16
    v_and_or_b32 v53, v25, s58, v60
    v_or_b32 v54, v61, v19
    v_mov_b32 v55, v31
    s_waitcnt lgkmcnt(0)
    v_add_lshl_u32 v32, v32, v36, 4
    ds_write_b128 v32, v[40:43] offset:2048
    v_add_lshl_u32 v33, v33, v37, 4
    ds_write_b128 v33, v[44:47] offset:2048
    v_add_lshl_u32 v34, v34, v38, 4
    ds_write_b128 v34, v[48:51] offset:2048
    v_add_lshl_u32 v35, v35, v39, 4
    ds_write_b128 v35, v[52:55] offset:2048
    v_mov_b32 v62, 163460
    s_waitcnt lgkmcnt(0)
    s_barrier
    ds_read_b32 v62, v62
    ds_read_b128 v[12:15], v5 offset:2048
    ds_read_b128 v[16:19], v5 offset:7168
    ds_read_b128 v[20:23], v5 offset:12288
    ds_read_b128 v[24:27], v5 offset:17408
    s_waitcnt lgkmcnt(3)
    buffer_store_dwordx4 v[12:15], v5, s[8:11], s64 offen sc1
    s_add_u32 s64, s64, 5120
    s_waitcnt lgkmcnt(2)
    buffer_store_dwordx4 v[16:19], v5, s[8:11], s64 offen sc1
    s_add_u32 s64, s64, 5120
    s_waitcnt lgkmcnt(1)
    buffer_store_dwordx4 v[20:23], v5, s[8:11], s64 offen sc1
    s_add_u32 s64, s64, 5120
    s_waitcnt lgkmcnt(0)
    buffer_store_dwordx4 v[24:27], v5, s[8:11], s64 offen sc1
    s_branch KS_JOIN
K2_PAD_B3:
    s_branch KS_HOP
KS_B3:
    v_mov_b32 v59, 163456
    ds_read_b32 v59, v59
    v_mov_b32 v62, 163460
    s_waitcnt lgkmcnt(0)
    s_barrier
    ds_read_b32 v62, v62
KS_JOIN:
    v_readfirstlane_b32 s2, v59
    s_mov_b32 s25, 0x400000
KS_JOIN2:
    s_waitcnt lgkmcnt(0)
    v_readfirstlane_b32 s24, v62
    s_nop 0
    s_cmp_eq_u32 s24, 0
    s_cbranch_scc1 KS_FLS
    s_bfe_u32 s24, s24, 0x10001
    s_xor_b32 s54, s54, s24
    s_lshr_b32 s21, s54, 1
    s_mul_i32 s21, s21, 625
    s_add_u32 s22, s21, 632
    s_add_u32 s21, s21, 7
    s_lshr_b32 s21, s21, 3
    s_lshr_b32 s22, s22, 3
    s_add_u32 s24, s21, 40
    s_sub_u32 s22, s22, s24
    s_bitcmp1_b32 s54, 0
    s_cselect_b32 s21, s24, s21
    s_cselect_b32 s22, s22, 40
    s_mov_b32 s23, 0
    s_mov_b32 s28, 1
    s_mov_b32 s24, 0
    s_mov_b32 s25, 1
K2_CELLS:
    v_lshrrev_b32 v178, 1, v177
    v_min_u32 v178, 249, v178
    v_mul_u32_u24 v72, 1152, v178
    s_and_b32 s58, s54, 7
    s_lshl_b32 s58, s58, 7
    s_lshr_b32 s59, s54, 5
    s_lshl_b32 s59, s59, 4
    s_add_u32 s67, s58, s59
    s_add_u32 s67, s67, 6291456
    s_cmp_eq_u32 s28, 0
    s_cbranch_scc1 K2_NOSRD
    s_mov_b32 s4, s80
    s_and_b32 s5, s81, 0xffff
    s_mov_b32 s6, 10240000
    s_mov_b32 s7, 0x20000
    s_mov_b32 s12, s96
    s_and_b32 s13, s97, 0xffff
    s_mov_b32 s14, 10240000
    s_mov_b32 s15, 0x20000
    s_mov_b32 s16, s84
    s_and_b32 s17, s85, 0xffff
    s_mov_b32 s18, 10240000
    s_mov_b32 s19, 0x20000
    s_sub_u32 s80, s80, 1024
    s_subb_u32 s81, s81, 0
    s_mov_b32 s72, s80
    s_and_b32 s73, s81, 0xffff
    s_mov_b32 s74, 10241024
    s_mov_b32 s75, 0x20000
    s_mov_b64 exec, 0
    s_cmp_eq_u32 s20, 0
    s_cbranch_scc1 K2_PAD_U20
    s_cmp_eq_u32 s20, 1
    s_cbranch_scc1 K2_PAD_U30
    s_cmp_eq_u32 s20, 2
    s_cbranch_scc1 K2_PAD_U21
    s_cmp_eq_u32 s20, 3
    s_cbranch_scc1 K2_PAD_U31
    s_cmp_eq_u32 s20, 4
    s_cbranch_scc1 K2_PAD_SW
    s_cmp_eq_u32 s20, 5
    s_cbranch_scc1 K2_PAD_TL
    s_cmp_eq_u32 s20, 6
    s_cbranch_scc1 K2_PAD_T2
K2_HOP:
    s_mov_b64 exec, -1
K2_NOSRD:
    v_and_b32 v84, 15, v176
    v_lshrrev_b32 v85, 5, v176
    v_bfe_u32 v86, v176, 4, 1
    v_lshrrev_b32 v87, 2, v84
    v_and_b32 v88, 3, v84
    v_lshl_add_u32 v89, v85, 2, v87
    v_lshlrev_b32 v249, 6, v89
    v_lshl_add_u32 v249, v88, 3, v249
    v_add_u32 v249, 512, v249
    v_lshrrev_b32 v90, 3, v84
    v_lshl_add_u32 v90, v90, 1, v86
    v_sub_u32 v90, v90, 1 clamp
    v_lshlrev_b32 v250, 1, v90
    v_lshl_add_u32 v91, v85, 2, v88
    v_lshl_add_u32 v250, v91, 4, v250
    v_and_b32 v91, 1, v87
    v_lshl_add_u32 v250, v91, 3, v250
    v_lshrrev_b32 v90, 1, v88
    v_lshl_add_u32 v90, v86, 1, v90
    v_bfe_u32 v91, v87, 1, 1
    v_lshlrev_b32 v91, 2, v91
    v_xor_b32 v90, v90, v91
    v_lshlrev_b32 v90, 4, v90
    v_lshl_add_u32 v90, v89, 7, v90
    v_and_b32 v91, 1, v88
    v_lshl_add_u32 v90, v91, 3, v90
    v_add_u32 v246, s37, v90
    v_xor_b32 v247, 64, v246
    v_lshrrev_b32 v90, 3, v176
    v_lshlrev_b32 v251, 4, v90
    v_bfe_u32 v90, v90, 1, 1
    v_lshlrev_b32 v90, 2, v90
    v_and_b32 v91, 7, v176
    v_xor_b32 v90, v90, v91
    v_lshlrev_b32 v248, 4, v90
    v_lshlrev_b32 v252, 1, v176
    v_mov_b32 v228, -1
    v_mov_b32 v229, -1
    v_and_b32 v231, 1, v176
    v_lshlrev_b32 v231, 4, v231
    v_lshrrev_b32 v90, 1, v176
    v_lshlrev_b32 v90, 5, v90
    v_add_u32 v230, 512, v90
    s_cmp_eq_u32 s28, 0
    s_cbranch_scc1 K2_NOW0
    v_lshrrev_b32 v60, 6, v252
    v_bfe_u32 v61, v252, 3, 2
    v_lshl_add_u32 v60, v60, 2, v61
    v_mul_u32_u24 v60, 640, v60
    v_bfe_u32 v61, v252, 5, 1
    v_lshl_add_u32 v60, v61, 5, v60
    v_and_b32 v61, 6, v252
    v_lshl_add_u32 v60, v61, 2, v60
    v_add_u32 v60, 24576, v60
    ds_read_b64_tr_b16 v[136:137], v60 offset:0
    ds_read_b64_tr_b16 v[138:139], v60 offset:5120
    ds_read_b64_tr_b16 v[140:141], v60 offset:64
    ds_read_b64_tr_b16 v[142:143], v60 offset:5184
    ds_read_b64_tr_b16 v[144:145], v60 offset:128
    ds_read_b64_tr_b16 v[146:147], v60 offset:5248
    ds_read_b64_tr_b16 v[148:149], v60 offset:192
    ds_read_b64_tr_b16 v[150:151], v60 offset:5312
    ds_read_b64_tr_b16 v[152:153], v60 offset:256
    ds_read_b64_tr_b16 v[154:155], v60 offset:5376
    ds_read_b64_tr_b16 v[156:157], v60 offset:320
    ds_read_b64_tr_b16 v[158:159], v60 offset:5440
    ds_read_b64_tr_b16 v[160:161], v60 offset:384
    ds_read_b64_tr_b16 v[162:163], v60 offset:5504
    ds_read_b64_tr_b16 v[164:165], v60 offset:448
    ds_read_b64_tr_b16 v[166:167], v60 offset:5568
    ds_read_b64_tr_b16 v[168:169], v60 offset:512
    ds_read_b64_tr_b16 v[170:171], v60 offset:5632
    ds_read_b64_tr_b16 v[172:173], v60 offset:576
    ds_read_b64_tr_b16 v[174:175], v60 offset:5696
    s_waitcnt lgkmcnt(0)
    v_lshlrev_b32 v96, 16, v136
    v_and_b32 v97, 0xffff0000, v136
    v_lshlrev_b32 v98, 16, v137
    v_and_b32 v99, 0xffff0000, v137
    v_lshlrev_b32 v100, 16, v138
    v_and_b32 v101, 0xffff0000, v138
    v_lshlrev_b32 v102, 16, v139
    v_and_b32 v103, 0xffff0000, v139
    v_lshlrev_b32 v104, 16, v140
    v_and_b32 v105, 0xffff0000, v140
    v_lshlrev_b32 v106, 16, v141
    v_and_b32 v107, 0xffff0000, v141
    v_lshlrev_b32 v108, 16, v142
    v_and_b32 v109, 0xffff0000, v142
    v_lshlrev_b32 v110, 16, v143
    v_and_b32 v111, 0xffff0000, v143
    v_lshlrev_b32 v112, 16, v144
    v_and_b32 v113, 0xffff0000, v144
    v_lshlrev_b32 v114, 16, v145
    v_and_b32 v115, 0xffff0000, v145
    v_lshlrev_b32 v116, 16, v146
    v_and_b32 v117, 0xffff0000, v146
    v_lshlrev_b32 v118, 16, v147
    v_and_b32 v119, 0xffff0000, v147
    v_lshlrev_b32 v120, 16, v148
    v_and_b32 v121, 0xffff0000, v148
    v_lshlrev_b32 v122, 16, v149
    v_and_b32 v123, 0xffff0000, v149
    v_lshlrev_b32 v124, 16, v150
    v_and_b32 v125, 0xffff0000, v150
    v_lshlrev_b32 v126, 16, v151
    v_and_b32 v127, 0xffff0000, v151
    buffer_load_dwordx4 v[76:79], v72, s[8:11], s67 offen sc1
    v_lshlrev_b32 v128, 16, v152
    v_and_b32 v129, 0xffff0000, v152
    v_lshlrev_b32 v130, 16, v153
    v_and_b32 v131, 0xffff0000, v153
    v_lshlrev_b32 v132, 16, v154
    v_and_b32 v133, 0xffff0000, v154
    v_lshlrev_b32 v134, 16, v155
    v_and_b32 v135, 0xffff0000, v155
    v_lshlrev_b32 v136, 16, v156
    v_and_b32 v137, 0xffff0000, v156
    v_lshlrev_b32 v138, 16, v157
    v_and_b32 v139, 0xffff0000, v157
    v_lshlrev_b32 v140, 16, v158
    v_and_b32 v141, 0xffff0000, v158
    v_lshlrev_b32 v142, 16, v159
    v_and_b32 v143, 0xffff0000, v159
    v_lshlrev_b32 v144, 16, v160
    v_and_b32 v145, 0xffff0000, v160
    v_lshlrev_b32 v146, 16, v161
    v_and_b32 v147, 0xffff0000, v161
    v_lshlrev_b32 v148, 16, v162
    v_and_b32 v149, 0xffff0000, v162
    v_lshlrev_b32 v150, 16, v163
    v_and_b32 v151, 0xffff0000, v163
    v_lshlrev_b32 v152, 16, v164
    v_and_b32 v153, 0xffff0000, v164
    v_lshlrev_b32 v154, 16, v165
    v_and_b32 v155, 0xffff0000, v165
    v_lshlrev_b32 v156, 16, v166
    v_and_b32 v157, 0xffff0000, v166
    v_lshlrev_b32 v158, 16, v167
    v_and_b32 v159, 0xffff0000, v167
    v_lshlrev_b32 v160, 16, v168
    v_and_b32 v161, 0xffff0000, v168
    v_lshlrev_b32 v162, 16, v169
    v_and_b32 v163, 0xffff0000, v169
    v_lshlrev_b32 v164, 16, v170
    v_and_b32 v165, 0xffff0000, v170
    v_lshlrev_b32 v166, 16, v171
    v_and_b32 v167, 0xffff0000, v171
    v_lshlrev_b32 v168, 16, v172
    v_and_b32 v169, 0xffff0000, v172
    v_lshlrev_b32 v170, 16, v173
    v_and_b32 v171, 0xffff0000, v173
    v_lshlrev_b32 v172, 16, v174
    v_and_b32 v173, 0xffff0000, v174
    v_lshlrev_b32 v174, 16, v175
    v_and_b32 v175, 0xffff0000, v175
K2_W0:
    s_lshl_b32 s59, s2, 22
    s_mov_b32 s60, 0x40000
    s_bfe_u32 s61, s54, 0x10004
    s_bfe_u32 s62, s54, 0x10003
    s_add_u32 s63, s61, s62
    s_mul_i32 s62, s62, 11
    s_sub_u32 s64, 11, s62
    v_cmp_gt_u32 vcc, 500, v177
    s_nop 0
    s_mov_b64 s[56:57], vcc
K2_POLL:
    s_waitcnt vmcnt(0)
    v_xor_b32 v73, s59, v76
    v_xor_b32 v74, s59, v77
    v_or_b32 v73, v73, v74
    v_xor_b32 v74, s2, v79
    v_lshrrev_b32 v73, 22, v73
    v_or_b32 v73, v73, v74
    v_cmp_ne_u32 vcc, 0, v73
    s_nop 0
    s_cbranch_vccz K2_POLLED
    s_sub_u32 s60, s60, 1
    s_cbranch_scc1 K2_END
    s_mov_b64 exec, vcc
    buffer_load_dwordx4 v[76:79], v72, s[8:11], s67 offen sc1
    s_mov_b64 exec, -1
    s_branch K2_POLL
K2_PAD_LD:
    s_branch KS_HOP
K2_POLLED:
    s_set_gpr_idx_on s61, gpr_idx(SRC0)
    s_nop 0
    v_bfe_u32 v179, v76, s62, 11
    s_set_gpr_idx_idx s63
    s_nop 0
    v_bfe_u32 v73, v76, s64, 11
    s_set_gpr_idx_off
    v_sub_u32 v73, v73, v179
    v_cndmask_b32 v73, 0, v73, s[56:57]
    v_and_b32 v1, 1, v177
    v_add_u32 v1, s23, v1
    v_sub_u32 v180, v73, v1
    v_add_u32 v179, v179, v1
    v_mul_u32_u24 v181, 20608, v178
    v_lshl_add_u32 v181, v179, 4, v181
    v_cmp_lt_i32 s[40:41], 0, v180
    v_add_u32 v182, 32, v181
    s_mov_b32 s65, 0
    s_mov_b64 exec, s[40:41]
    buffer_load_dwordx4 v[0:3], v181, s[8:11], 0 offen offset:0 sc1
    s_mov_b64 exec, -1
    v_cmp_lt_i32 s[42:43], 2, v180
    v_cmp_lt_i32 s[44:45], 4, v180
    v_cmp_lt_i32 s[46:47], 6, v180
    v_cmp_lt_i32 s[48:49], 8, v180
    v_cmp_lt_i32 s[50:51], 10, v180
    v_cmp_lt_i32 s[90:91], 12, v180
    v_cmp_lt_i32 s[92:93], 14, v180
    v_cmp_lt_i32 s[94:95], 16, v180
    v_cmp_lt_i32 s[96:97], 18, v180
    v_add_u32 v183, 64, v181
    v_add_u32 v184, 96, v181
    v_subrev_u32 v62, 1, v180
    v_ashrrev_i32 v62, 1, v62
    v_med3_i32 v62, v62, 0, 9
    s_cmp_eq_u64 s[42:43], 0
    s_cbranch_scc1 K2_LD_DONE
    v_mov_b32 v63, v62
    s_nop 1
    v_add_u32_dpp v63, v63, v63 row_shr:1 row_mask:0xf bank_mask:0xf bound_ctrl:0
    s_nop 1
    v_add_u32_dpp v63, v63, v63 row_shr:2 row_mask:0xf bank_mask:0xf bound_ctrl:0
    s_nop 1
    v_add_u32_dpp v63, v63, v63 row_shr:4 row_mask:0xf bank_mask:0xf bound_ctrl:0
    s_nop 1
    v_add_u32_dpp v63, v63, v63 row_shr:8 row_mask:0xf bank_mask:0xf bound_ctrl:0
    s_nop 1
    v_add_u32_dpp v63, v63, v63 row_bcast:15 row_mask:0xa bank_mask:0xf
    s_nop 1
    v_add_u32_dpp v63, v63, v63 row_bcast:31 row_mask:0xc bank_mask:0xf
    s_lshl_b32 s58, s20, 10
    s_add_u32 s58, s58, 45056
    v_readlane_b32 s59, v63, 63
    v_sub_u32 v63, v63, v62
    v_lshl_add_u32 v64, v63, 2, s58
    v_lshlrev_b32 v63, 5, v63
    v_sub_u32 v63, v182, v63
    s_cmp_gt_u32 s59, 189
    s_cbranch_scc1 K2_LD_GEN
    s_mov_b64 exec, s[42:43]
    s_cbranch_execz K2_LD_L
    ds_write_b32 v64, v63 offset:0
    s_mov_b64 exec, s[44:45]
    s_cbranch_execz K2_LD_L
    ds_write_b32 v64, v63 offset:4
    s_mov_b64 exec, s[46:47]
    s_cbranch_execz K2_LD_L
    ds_write_b32 v64, v63 offset:8
    s_mov_b64 exec, s[48:49]
    s_cbranch_execz K2_LD_L
    ds_write_b32 v64, v63 offset:12
    s_mov_b64 exec, s[50:51]
    s_cbranch_execz K2_LD_L
    ds_write_b32 v64, v63 offset:16
    s_mov_b64 exec, s[90:91]
    s_cbranch_execz K2_LD_L
    ds_write_b32 v64, v63 offset:20
    s_mov_b64 exec, s[92:93]
    s_cbranch_execz K2_LD_L
    ds_write_b32 v64, v63 offset:24
    s_mov_b64 exec, s[94:95]
    s_cbranch_execz K2_LD_L
    ds_write_b32 v64, v63 offset:28
    s_mov_b64 exec, s[96:97]
    s_cbranch_execz K2_LD_L
    ds_write_b32 v64, v63 offset:32
K2_LD_L:
    s_mov_b64 exec, -1
    v_lshl_add_u32 v63, v176, 2, s58
    v_lshlrev_b32 v62, 5, v176
    s_waitcnt lgkmcnt(0)
    ds_read_b32 v64, v63 offset:0
    ds_read_b32 v65, v63 offset:252
    ds_read_b32 v66, v63 offset:504
    s_min_u32 s60, s59, 63
    s_sub_u32 s59, s59, s60
    s_bfm_b64 s[42:43], s60, 0
    s_min_u32 s60, s59, 63
    s_sub_u32 s59, s59, s60
    s_bfm_b64 s[44:45], s60, 0
    s_min_u32 s60, s59, 63
    s_sub_u32 s59, s59, s60
    s_bfm_b64 s[46:47], s60, 0
    s_mov_b64 s[48:49], 0
    s_mov_b32 s65, 1
    s_mov_b32 s60, 0
    s_waitcnt lgkmcnt(2)
    v_add3_u32 v182, v62, v64, s60
    s_mov_b64 exec, s[42:43]
    buffer_load_dwordx4 v[4:7], v182, s[8:11], 0 offen sc1
    s_mov_b32 s60, 2016
    s_waitcnt lgkmcnt(1)
    v_add3_u32 v183, v62, v65, s60
    s_mov_b64 exec, s[44:45]
    buffer_load_dwordx4 v[8:11], v183, s[8:11], 0 offen sc1
    s_mov_b32 s60, 4032
    s_waitcnt lgkmcnt(0)
    v_add3_u32 v184, v62, v66, s60
    s_mov_b64 exec, s[46:47]
    buffer_load_dwordx4 v[12:15], v184, s[8:11], 0 offen sc1
K2_LD_DONE:
    s_mov_b64 exec, -1
    s_cmp_eq_u32 s28, 0
    s_cbranch_scc1 K2_WLATE
K2_NOWRAW:
K2_PAD_NW:
    s_cbranch_execz KS_HOP
    v_lshrrev_b32 v179, 2, v181
    v_lshrrev_b32 v185, 2, v182
    v_lshrrev_b32 v186, 2, v183
    v_lshrrev_b32 v187, 2, v184
    s_mov_b32 s66, 7340032
    v_mov_b32 v201, 1
    s_movk_i32 s58, 520
    s_movk_i32 s59, 2080
    s_mov_b32 s60, 0x40000
    s_mov_b32 s61, 0xffff
    v_mov_b32 v202, 65536
    s_cmp_lg_u32 s24, 0
    s_cbranch_scc1 K2_RK_LOAD
    v_cmp_lt_i32 vcc, 20, v180
    s_nop 0
    s_cbranch_vccz K2_NOMORE
    v_mov_b32 v61, 163300
    ds_write_b32 v61, v201
K2_NOMORE:
    s_mov_b32 s62, 82176
    s_cmp_eq_u32 s65, 0
    s_waitcnt vmcnt(3)
    s_cbranch_scc0 K2_ARR
    s_waitcnt vmcnt(0)
K2_ARR:
    s_mov_b64 exec, s[40:41]
    s_cbranch_execz K2_RK_A
K2_CK0:
    v_bfi_b32 v192, s61, v1, v2
    v_lshrrev_b32 v50, 24, v3
    v_cmp_ne_u32 vcc, s2, v192
    v_add_u32 v40, 163072, v50
    s_cbranch_vccnz K2_RT0
    ds_add_rtn_u32 v40, v40, v201
    v_mad_u32_u24 v50, v50, s58, v202
    s_mov_b64 exec, s[42:43]
    s_cbranch_execz K2_RK_A
    s_waitcnt vmcnt(2)
K2_CK1:
    v_bfi_b32 v192, s61, v5, v6
    v_lshrrev_b32 v51, 24, v7
    v_cmp_ne_u32 vcc, s2, v192
    v_add_u32 v41, 163072, v51
    s_cbranch_vccnz K2_RT1
    ds_add_rtn_u32 v41, v41, v201
    v_mad_u32_u24 v51, v51, s58, v202
    s_mov_b64 exec, s[44:45]
    s_cbranch_execz K2_RK_A
    s_waitcnt vmcnt(1)
K2_CK2:
    v_bfi_b32 v192, s61, v9, v10
    v_lshrrev_b32 v52, 24, v11
    v_cmp_ne_u32 vcc, s2, v192
    v_add_u32 v42, 163072, v52
    s_cbranch_vccnz K2_RT2
    ds_add_rtn_u32 v42, v42, v201
    v_mad_u32_u24 v52, v52, s58, v202
    s_mov_b64 exec, s[46:47]
    s_cbranch_execz K2_RK_A
    s_waitcnt vmcnt(0)
K2_CK3:
    v_bfi_b32 v192, s61, v13, v14
    v_lshrrev_b32 v53, 24, v15
    v_cmp_ne_u32 vcc, s2, v192
    v_add_u32 v43, 163072, v53
    s_cbranch_vccnz K2_RT3
    ds_add_rtn_u32 v43, v43, v201
    v_mad_u32_u24 v53, v53, s58, v202
    s_mov_b64 exec, s[48:49]
    s_cbranch_execz K2_RK_A
K2_CK4:
    v_bfi_b32 v192, s61, v17, v18
    v_lshrrev_b32 v54, 24, v19
    v_cmp_ne_u32 vcc, s2, v192
    v_add_u32 v44, 163072, v54
    s_cbranch_vccnz K2_RT4
    ds_add_rtn_u32 v44, v44, v201
    v_mad_u32_u24 v54, v54, s58, v202
    s_mov_b64 exec, s[50:51]
    s_cbranch_execz K2_RK_A
K2_CK5:
    v_bfi_b32 v192, s61, v21, v22
    v_lshrrev_b32 v55, 24, v23
    v_cmp_ne_u32 vcc, s2, v192
    v_add_u32 v45, 163072, v55
    s_cbranch_vccnz K2_RT5
    ds_add_rtn_u32 v45, v45, v201
    v_mad_u32_u24 v55, v55, s58, v202
    s_mov_b64 exec, s[90:91]
    s_cbranch_execz K2_RK_A
K2_CK6:
    v_bfi_b32 v192, s61, v25, v26
    v_lshrrev_b32 v56, 24, v27
    v_cmp_ne_u32 vcc, s2, v192
    v_add_u32 v46, 163072, v56
    s_cbranch_vccnz K2_RT6
    ds_add_rtn_u32 v46, v46, v201
    v_mad_u32_u24 v56, v56, s58, v202
    s_mov_b64 exec, s[92:93]
    s_cbranch_execz K2_RK_A
K2_CK7:
    v_bfi_b32 v192, s61, v29, v30
    v_lshrrev_b32 v57, 24, v31
    v_cmp_ne_u32 vcc, s2, v192
    v_add_u32 v47, 163072, v57
    s_cbranch_vccnz K2_RT7
    ds_add_rtn_u32 v47, v47, v201
    v_mad_u32_u24 v57, v57, s58, v202
    s_mov_b64 exec, s[94:95]
    s_cbranch_execz K2_RK_A
K2_CK8:
    v_bfi_b32 v192, s61, v33, v34
    v_lshrrev_b32 v58, 24, v35
    v_cmp_ne_u32 vcc, s2, v192
    v_add_u32 v48, 163072, v58
    s_cbranch_vccnz K2_RT8
    ds_add_rtn_u32 v48, v48, v201
    v_mad_u32_u24 v58, v58, s58, v202
    s_mov_b64 exec, s[96:97]
    s_cbranch_execz K2_RK_A
K2_CK9:
    v_bfi_b32 v192, s61, v37, v38
    v_lshrrev_b32 v59, 24, v39
    v_cmp_ne_u32 vcc, s2, v192
    v_add_u32 v49, 163072, v59
    s_cbranch_vccnz K2_RT9
    ds_add_rtn_u32 v49, v49, v201
    v_mad_u32_u24 v59, v59, s58, v202
K2_RK_A:
    s_mov_b64 exec, -1
    s_mov_b64 exec, s[40:41]
    s_cbranch_execz K2_TP
    v_cmp_gt_u32 vcc, s62, v50
    v_and_b32 v3, 0xffffff, v3
    s_mov_b64 exec, vcc
    buffer_load_dword v245, v3, s[16:19], 0 offen
    s_mov_b64 exec, s[42:43]
    s_cbranch_execz K2_TP
    v_cmp_gt_u32 vcc, s62, v51
    v_and_b32 v7, 0xffffff, v7
    s_mov_b64 exec, vcc
    buffer_load_dword v245, v7, s[16:19], 0 offen
    s_mov_b64 exec, s[44:45]
    s_cbranch_execz K2_TP
    v_cmp_gt_u32 vcc, s62, v52
    v_and_b32 v11, 0xffffff, v11
    s_mov_b64 exec, vcc
    buffer_load_dword v245, v11, s[16:19], 0 offen
    s_mov_b64 exec, s[46:47]
    s_cbranch_execz K2_TP
    v_cmp_gt_u32 vcc, s62, v53
    v_and_b32 v15, 0xffffff, v15
    s_mov_b64 exec, vcc
    buffer_load_dword v245, v15, s[16:19], 0 offen
    s_mov_b64 exec, s[48:49]
    s_cbranch_execz K2_TP
    v_cmp_gt_u32 vcc, s62, v54
    v_and_b32 v19, 0xffffff, v19
    s_mov_b64 exec, vcc
    buffer_load_dword v245, v19, s[16:19], 0 offen
    s_mov_b64 exec, s[50:51]
    s_cbranch_execz K2_TP
    v_cmp_gt_u32 vcc, s62, v55
    v_and_b32 v23, 0xffffff, v23
    s_mov_b64 exec, vcc
    buffer_load_dword v245, v23, s[16:19], 0 offen
    s_mov_b64 exec, s[90:91]
    s_cbranch_execz K2_TP
    v_cmp_gt_u32 vcc, s62, v56
    v_and_b32 v27, 0xffffff, v27
    s_mov_b64 exec, vcc
    buffer_load_dword v245, v27, s[16:19], 0 offen
    s_mov_b64 exec, s[92:93]
    s_cbranch_execz K2_TP
    v_cmp_gt_u32 vcc, s62, v57
    v_and_b32 v31, 0xffffff, v31
    s_mov_b64 exec, vcc
    buffer_load_dword v245, v31, s[16:19], 0 offen
    s_mov_b64 exec, s[94:95]
    s_cbranch_execz K2_TP
    v_cmp_gt_u32 vcc, s62, v58
    v_and_b32 v35, 0xffffff, v35
    s_mov_b64 exec, vcc
    buffer_load_dword v245, v35, s[16:19], 0 offen
    s_mov_b64 exec, s[96:97]
    s_cbranch_execz K2_TP
    v_cmp_gt_u32 vcc, s62, v59
    v_and_b32 v39, 0xffffff, v39
    s_mov_b64 exec, vcc
    buffer_load_dword v245, v39, s[16:19], 0 offen
K2_TP:
    s_mov_b64 exec, -1
K2_RK_DONE:
K2_PAD_SC:
    s_cbranch_execz KS_HOP
    s_mul_i32 s67, s24, 48
    s_movk_i32 s58, -1532
    s_waitcnt lgkmcnt(0)
    s_mov_b64 exec, s[40:41]
    s_cbranch_execz K2_SC_DONE
    v_cmpx_gt_u32 vcc, 64, v40
    v_bfe_u32 v194, v40, 3, 1
    v_add_u32 v193, 16, v40
    v_lshl_or_b32 v194, v40, 1, v194
    v_bfi_b32 v194, 15, v194, v40
    v_lshrrev_b32 v193, 6, v193
    v_alignbit_b32 v1, v2, v1, 16
    v_lshl_add_u32 v195, v194, 3, v50
    v_lshl_add_u32 v194, v194, 5, v50
    ds_write_b64 v195, v[0:1]
    v_mad_i32_i24 v194, v193, s58, v194
    ds_write_b32 v194, v3 offset:512
    s_mov_b64 exec, s[42:43]
    s_cbranch_execz K2_SC_DONE
    v_cmpx_gt_u32 vcc, 64, v41
    v_bfe_u32 v194, v41, 3, 1
    v_add_u32 v193, 16, v41
    v_lshl_or_b32 v194, v41, 1, v194
    v_bfi_b32 v194, 15, v194, v41
    v_lshrrev_b32 v193, 6, v193
    v_alignbit_b32 v5, v6, v5, 16
    v_lshl_add_u32 v195, v194, 3, v51
    v_lshl_add_u32 v194, v194, 5, v51
    ds_write_b64 v195, v[4:5]
    v_mad_i32_i24 v194, v193, s58, v194
    ds_write_b32 v194, v7 offset:512
    s_mov_b64 exec, s[44:45]
    s_cbranch_execz K2_SC_DONE
    v_cmpx_gt_u32 vcc, 64, v42
    v_bfe_u32 v194, v42, 3, 1
    v_add_u32 v193, 16, v42
    v_lshl_or_b32 v194, v42, 1, v194
    v_bfi_b32 v194, 15, v194, v42
    v_lshrrev_b32 v193, 6, v193
    v_alignbit_b32 v9, v10, v9, 16
    v_lshl_add_u32 v195, v194, 3, v52
    v_lshl_add_u32 v194, v194, 5, v52
    ds_write_b64 v195, v[8:9]
    v_mad_i32_i24 v194, v193, s58, v194
    ds_write_b32 v194, v11 offset:512
    s_mov_b64 exec, s[46:47]
    s_cbranch_execz K2_SC_DONE
    v_cmpx_gt_u32 vcc, 64, v43
    v_bfe_u32 v194, v43, 3, 1
    v_add_u32 v193, 16, v43
    v_lshl_or_b32 v194, v43, 1, v194
    v_bfi_b32 v194, 15, v194, v43
    v_lshrrev_b32 v193, 6, v193
    v_alignbit_b32 v13, v14, v13, 16
    v_lshl_add_u32 v195, v194, 3, v53
    v_lshl_add_u32 v194, v194, 5, v53
    ds_write_b64 v195, v[12:13]
    v_mad_i32_i24 v194, v193, s58, v194
    ds_write_b32 v194, v15 offset:512
    s_mov_b64 exec, s[48:49]
    s_cbranch_execz K2_SC_DONE
    v_cmpx_gt_u32 vcc, 64, v44
    v_bfe_u32 v194, v44, 3, 1
    v_add_u32 v193, 16, v44
    v_lshl_or_b32 v194, v44, 1, v194
    v_bfi_b32 v194, 15, v194, v44
    v_lshrrev_b32 v193, 6, v193
    v_alignbit_b32 v17, v18, v17, 16
    v_lshl_add_u32 v195, v194, 3, v54
    v_lshl_add_u32 v194, v194, 5, v54
    ds_write_b64 v195, v[16:17]
    v_mad_i32_i24 v194, v193, s58, v194
    ds_write_b32 v194, v19 offset:512
    s_mov_b64 exec, s[50:51]
    s_cbranch_execz K2_SC_DONE
    v_cmpx_gt_u32 vcc, 64, v45
    v_bfe_u32 v194, v45, 3, 1
    v_add_u32 v193, 16, v45
    v_lshl_or_b32 v194, v45, 1, v194
    v_bfi_b32 v194, 15, v194, v45
    v_lshrrev_b32 v193, 6, v193
    v_alignbit_b32 v21, v22, v21, 16
    v_lshl_add_u32 v195, v194, 3, v55
    v_lshl_add_u32 v194, v194, 5, v55
    ds_write_b64 v195, v[20:21]
    v_mad_i32_i24 v194, v193, s58, v194
    ds_write_b32 v194, v23 offset:512
    s_mov_b64 exec, s[90:91]
    s_cbranch_execz K2_SC_DONE
    v_cmpx_gt_u32 vcc, 64, v46
    v_bfe_u32 v194, v46, 3, 1
    v_add_u32 v193, 16, v46
    v_lshl_or_b32 v194, v46, 1, v194
    v_bfi_b32 v194, 15, v194, v46
    v_lshrrev_b32 v193, 6, v193
    v_alignbit_b32 v25, v26, v25, 16
    v_lshl_add_u32 v195, v194, 3, v56
    v_lshl_add_u32 v194, v194, 5, v56
    ds_write_b64 v195, v[24:25]
    v_mad_i32_i24 v194, v193, s58, v194
    ds_write_b32 v194, v27 offset:512
    s_mov_b64 exec, s[92:93]
    s_cbranch_execz K2_SC_DONE
    v_cmpx_gt_u32 vcc, 64, v47
    v_bfe_u32 v194, v47, 3, 1
    v_add_u32 v193, 16, v47
    v_lshl_or_b32 v194, v47, 1, v194
    v_bfi_b32 v194, 15, v194, v47
    v_lshrrev_b32 v193, 6, v193
    v_alignbit_b32 v29, v30, v29, 16
    v_lshl_add_u32 v195, v194, 3, v57
    v_lshl_add_u32 v194, v194, 5, v57
    ds_write_b64 v195, v[28:29]
    v_mad_i32_i24 v194, v193, s58, v194
    ds_write_b32 v194, v31 offset:512
    s_mov_b64 exec, s[94:95]
    s_cbranch_execz K2_SC_DONE
    v_cmpx_gt_u32 vcc, 64, v48
    v_bfe_u32 v194, v48, 3, 1
    v_add_u32 v193, 16, v48
    v_lshl_or_b32 v194, v48, 1, v194
    v_bfi_b32 v194, 15, v194, v48
    v_lshrrev_b32 v193, 6, v193
    v_alignbit_b32 v33, v34, v33, 16
    v_lshl_add_u32 v195, v194, 3, v58
    v_lshl_add_u32 v194, v194, 5, v58
    ds_write_b64 v195, v[32:33]
    v_mad_i32_i24 v194, v193, s58, v194
    ds_write_b32 v194, v35 offset:512
    s_mov_b64 exec, s[96:97]
    s_cbranch_execz K2_SC_DONE
    v_cmpx_gt_u32 vcc, 64, v49
    v_bfe_u32 v194, v49, 3, 1
    v_add_u32 v193, 16, v49
    v_lshl_or_b32 v194, v49, 1, v194
    v_bfi_b32 v194, 15, v194, v49
    v_lshrrev_b32 v193, 6, v193
    v_alignbit_b32 v37, v38, v37, 16
    v_lshl_add_u32 v195, v194, 3, v59
    v_lshl_add_u32 v194, v194, 5, v59
    ds_write_b64 v195, v[36:37]
    v_mad_i32_i24 v194, v193, s58, v194
    ds_write_b32 v194, v39 offset:512
K2_SC_DONE:
    s_mov_b64 exec, -1
K2_PAD_SD:
    s_cbranch_execz KS_HOP
    v_lshlrev_b32 v192, 2, v176
    v_add_u32 v192, 163072, v192
    v_mov_b32 v200, 163300
    s_cmp_eq_u32 s24, 0
    s_cselect_b32 s26, 64, 48
    s_waitcnt lgkmcnt(0)
    s_barrier
    ds_read_b32 v193, v192
    ds_read_b32 v200, v200
    v_cmp_gt_u32 s[56:57], s22, v176
    v_mad_u32_u24 v195, v176, s59, v202
    s_waitcnt lgkmcnt(0)
    v_cndmask_b32 v193, 0, v193, s[56:57]
    v_readfirstlane_b32 s27, v200
    v_cmp_lt_u32 s[62:63], 48, v193
    v_cmp_lt_u32 vcc, 64, v193
    s_bcnt1_i32_b64 s60, s[62:63]
    v_mbcnt_lo_u32_b32 v198, s62, 0
    v_mbcnt_hi_u32_b32 v198, s63, v198
    s_cbranch_vccnz K2_BIG
    s_cmp_gt_u32 s60, 8
    s_cbranch_scc1 K2_BIG
K2_TOK:
    v_subrev_u32 v194, s67, v193
    v_max_i32 v194, 1, v194
    v_min_i32 v194, s26, v194
    v_add_u32 v194, 15, v194
    v_lshrrev_b32 v194, 3, v194
    v_lshl_or_b32 v195, v194, 18, v195
    v_lshl_or_b32 v195, v198, 28, v195
    v_mov_b32 v197, 949760
    v_cndmask_b32 v253, v197, v195, s[56:57]
    s_movk_i32 s40, 0
    s_movk_i32 s41, 256
    s_movk_i32 s42, 512
    s_movk_i32 s43, 768
    s_add_u32 s24, s24, 1
    s_cmp_ge_u32 s24, s25
    s_cselect_b32 s55, 1, 0
    s_cmp_eq_u32 s27, 0
    s_cselect_b32 s55, s55, 0
    s_mov_b32 s27, 0x400000
    s_mov_b32 s38, 0
    s_mov_b32 s34, 0
    s_mov_b32 s35, 0
    s_mov_b32 s36, 1
    s_mov_b32 s31, 0
    s_mov_b32 s58, s20
    v_readlane_b32 s3, v253, s58
    s_lshl_b32 s44, s34, 7
    s_and_b32 s48, s3, 0x3ffff
    s_bfe_u32 s33, s3, 0x30013
    s_mul_i32 s35, s38, 6
    s_cmp_eq_u32 s34, 0
    s_cselect_b32 s35, s35, s48
    s_mov_b32 s45, s44
    s_xor_b32 s47, s44, 256
    s_add_u32 s49, s48, 128
    s_add_u32 s60, s48, 256
    s_cmp_eq_u32 s33, 3
    s_cselect_b32 s46, s44, s47
    s_cselect_b32 s50, s60, s48
    s_sub_u32 s60, s33, 2
    s_cmp_lt_u32 s60, 2
    s_cbranch_scc0 K2_rare_1
K2_back_2:
    v_add_u32 v233, s48, v230
    ds_read_b32 v232, v233
    ds_read_b32 v233, v233 offset:1024
    v_add_u32 v222, s48, v251
    ds_read2_b32 v[222:223], v222 offset0:1 offset1:3
    v_add_u32 v224, s49, v251
    ds_read2_b32 v[224:225], v224 offset0:1 offset1:3
    v_add_u32 v226, s50, v251
    ds_read2_b32 v[226:227], v226 offset0:1 offset1:3
    s_waitcnt lgkmcnt(3)
    v_or_b32 v232, v232, v231
    v_or_b32 v233, v233, v231
    s_cmp_lg_u32 s34, 0
    s_cbranch_scc1 K2_dum_4
    s_cmp_eq_u32 s33, 4
    s_cbranch_scc1 K2_a4_5
K2_b4_7:
    s_add_u32 m0, s48, 512
    s_add_u32 s65, s48, 1536
    buffer_load_dwordx4 v232, s[16:19], 0 offen  lds
    s_mov_b32 m0, s65
    s_mov_b32 exec_hi, 0
    buffer_load_dwordx4 v233, s[16:19], 0 offen  lds
    s_mov_b32 exec_hi, -1
K2_back_6:
    s_waitcnt lgkmcnt(2)
    v_mad_u32_u16 v222, v222, s39, v248 op_sel:[1,0,0,0]
    v_mad_u32_u16 v223, v223, s39, v248 op_sel:[1,0,0,0]
    s_waitcnt lgkmcnt(1)
    v_mad_u32_u16 v224, v224, s39, v248 op_sel:[1,0,0,0]
    v_mad_u32_u16 v225, v225, s39, v248 op_sel:[1,0,0,0]
    s_waitcnt lgkmcnt(0)
    v_mad_u32_u16 v226, v226, s39, v248 op_sel:[1,0,0,0]
    v_mad_u32_u16 v227, v227, s39, v248 op_sel:[1,0,0,0]
    s_mov_b32 m0, s68
    s_nop 0
    buffer_load_dwordx4 v222, s[4:7], s44 offen sc1 lds
    buffer_load_dwordx4 v223, s[72:75], s44 offen offset:1024 sc1 lds
    s_mov_b32 m0, s69
    s_nop 0
    buffer_load_dwordx4 v224, s[4:7], s45 offen sc1 lds
    buffer_load_dwordx4 v225, s[72:75], s45 offen offset:1024 sc1 lds
    s_mov_b32 m0, s70
    s_nop 0
    buffer_load_dwordx4 v226, s[4:7], s46 offen sc1 lds
    buffer_load_dwordx4 v227, s[72:75], s46 offen offset:1024 sc1 lds
    s_mov_b32 m0, s71
    s_cmp_eq_u32 s33, 4
    s_cbranch_scc1 K2_g4_8
    buffer_load_dwordx4 v224, s[4:7], s47 offen sc1 lds
    buffer_load_dwordx4 v225, s[72:75], s47 offen offset:1024 sc1 lds
K2_back_9:
    v_add_u32 v249, s48, v249
    v_add_u32 v250, s48, v250
    v_bfe_u32 v192, v253, 18, 4
    s_sub_u32 s58, s22, 16
    v_cmp_le_u32 vcc, 6, v192
    v_cmp_gt_u32 s[60:61], s58, v176
    s_nop 0
    s_or_b64 vcc, vcc, s[60:61]
    v_mbcnt_lo_u32_b32 v192, vcc_lo, 0
    v_mbcnt_hi_u32_b32 v192, vcc_hi, v192
    s_bcnt1_i32_b64 s58, vcc
    v_sub_u32 v193, v176, v192
    v_add_u32 v193, s58, v193
    v_cndmask_b32 v192, v193, v192, vcc
    v_lshlrev_b32 v192, 2, v192
    ds_permute_b32 v193, v192, v176
    s_waitcnt lgkmcnt(0)
    v_lshl_or_b32 v253, v193, 22, v253
    s_waitcnt vmcnt(6)
    ds_read_b64_tr_b16 v[176:177], v246 offset:0
    ds_read_b64_tr_b16 v[178:179], v246 offset:1024
    ds_read_b64_tr_b16 v[180:181], v247 offset:0
    ds_read_b64_tr_b16 v[182:183], v247 offset:1024
    ds_read_b64_tr_b16 v[0:1], v249 offset:0
    ds_read_b64_tr_b16 v[2:3], v249 offset:32
    ds_read_u16_d16_hi v16, v250 offset:0
    ds_read_b64_tr_b16 v[4:5], v249 offset:512
    ds_read_b64_tr_b16 v[6:7], v249 offset:544
    ds_read_u16_d16_hi v17, v250 offset:128
    s_mov_b32 s29, s48
    s_mov_b32 s32, s31
    s_mov_b32 s30, s3
    s_mov_b32 s31, s35
    s_bfe_u32 s56, s3, 0x40012
    s_cmp_eq_u32 s56, 5
    s_cbranch_scc1 K2_U20
    s_cmp_eq_u32 s56, 6
    s_cbranch_scc1 K2_U3h0
    s_branch K2_DSP0
K2_PAD_H1:
    s_branch KS_HOP0
KS_HELP:
    s_mov_b32 s30, 0
    s_cmp_eq_u32 s20, 6
    s_cbranch_scc1 KS_RAW
    s_mov_b32 s30, 2
    s_cmp_ge_u32 s2, 170
    s_cbranch_scc1 KS_NOW
    s_mov_b32 s30, 1
    v_and_b32 v1, 15, v8
    v_lshrrev_b32 v3, 4, v8
    s_cmp_ge_u32 s2, 160
    s_cbranch_scc1 K1_WT
    s_cmp_ge_u32 s2, 64
    s_cbranch_scc1 K1_S1
    s_lshr_b32 s24, s2, 3
    s_and_b32 s25, s2, 7
    s_lshr_b32 s26, s25, 2
    s_bfe_u32 s27, s25, 0x10001
    s_and_b32 s28, s25, 1
    s_mov_b32 s60, s92
    s_and_b32 s61, s93, 0xffff
    s_mov_b32 s62, 65536
    s_mov_b32 s63, 0x20000
    s_branch K1_SC
K1_S1:
    s_sub_u32 s29, s2, 64
    s_mul_i32 s24, s29, 43
    s_lshr_b32 s24, s24, 9
    s_mul_i32 s25, s24, 12
    s_sub_u32 s25, s29, s25
    s_cmp_ge_u32 s25, 6
    s_cselect_b32 s26, 1, 0
    s_mul_i32 s27, s26, 6
    s_sub_u32 s27, s25, s27
    s_lshr_b32 s27, s27, 1
    s_and_b32 s28, s25, 1
    s_add_u32 s25, s25, 8
    s_mov_b32 s60, s94
    s_and_b32 s61, s95, 0xffff
    s_mov_b32 s62, 98304
    s_mov_b32 s63, 0x20000
K1_SC:
    s_lshl_b32 s27, s27, 7
    s_lshl_b32 s26, s26, 6
    s_lshl_b32 s28, s28, 4
    s_add_u32 s27, s27, s26
    s_add_u32 s27, s27, s28
    s_lshl_b32 s27, s27, 8
    s_lshl_b32 s26, s24, 5
    s_add_u32 s27, s27, s26
    s_add_u32 s29, s27, 8192
    v_lshlrev_b32 v3, 10, v3
    v_lshl_add_u32 v3, v1, 1, v3
    buffer_load_ushort v64, v3, s[60:63], s27 offen offset:0
    buffer_load_ushort v65, v3, s[60:63], s29 offen offset:0
    buffer_load_ushort v66, v3, s[60:63], s27 offen offset:256
    buffer_load_ushort v67, v3, s[60:63], s29 offen offset:256
    buffer_load_ushort v68, v3, s[60:63], s27 offen offset:512
    buffer_load_ushort v69, v3, s[60:63], s29 offen offset:512
    buffer_load_ushort v70, v3, s[60:63], s27 offen offset:768
    buffer_load_ushort v71, v3, s[60:63], s29 offen offset:768
    s_mul_i32 s24, s24, 20
    s_add_u32 s24, s24, s25
    s_lshl_b32 s24, s24, 10
    s_add_u32 s24, s24, 6946816
    s_branch K1_GO
K1_WT:
    s_sub_u32 s24, s2, 160
    s_lshr_b32 s27, s24, 1
    s_and_b32 s28, s24, 1
    s_lshl_b32 s27, s27, 8
    s_lshl_b32 s28, s28, 6
    s_add_u32 s27, s27, s28
    s_add_u32 s29, s27, 10240
    s_mov_b32 s60, s90
    s_and_b32 s61, s91, 0xffff
    s_mov_b32 s62, 20480
    s_mov_b32 s63, 0x20000
    v_and_b32 v1, 31, v8
    v_lshrrev_b32 v3, 5, v8
    v_mul_u32_u24 v3, 5120, v3
    v_lshl_add_u32 v3, v1, 1, v3
    buffer_load_ushort v64, v3, s[60:63], s27 offen offset:0
    buffer_load_ushort v65, v3, s[60:63], s27 offen offset:1280
    buffer_load_ushort v66, v3, s[60:63], s27 offen offset:2560
    buffer_load_ushort v67, v3, s[60:63], s27 offen offset:3840
    buffer_load_ushort v68, v3, s[60:63], s29 offen offset:0
    buffer_load_ushort v69, v3, s[60:63], s29 offen offset:1280
    buffer_load_ushort v70, v3, s[60:63], s29 offen offset:2560
    buffer_load_ushort v71, v3, s[60:63], s29 offen offset:3840
    s_lshl_b32 s24, s24, 10
    s_add_u32 s24, s24, 7110656
K1_GO:
KS_NOW:
    s_barrier
K2_PAD_H2:
    s_cbranch_execz KS_HOP0
    v_and_b32 v76, 31, v8
    v_lshrrev_b32 v77, 5, v8
    v_mov_b32 v80, 0
    v_mul_u32_u24 v77, 2080, v77
    v_mov_b32 v81, 0xffff0000
    v_lshl_add_u32 v78, v76, 4, v77
    v_mov_b32 v82, 0
    v_add_u32 v78, 65536, v78
    v_mov_b32 v83, v81
    v_add_u32 v79, 41600, v78
    ds_write_b128 v78, v[80:83] offset:0
    ds_write_b128 v78, v[80:83] offset:4160
    ds_write_b128 v78, v[80:83] offset:8320
    ds_write_b128 v78, v[80:83] offset:12480
    ds_write_b128 v78, v[80:83] offset:16640
    ds_write_b128 v78, v[80:83] offset:20800
    ds_write_b128 v78, v[80:83] offset:24960
    ds_write_b128 v78, v[80:83] offset:29120
    ds_write_b128 v78, v[80:83] offset:33280
    ds_write_b128 v78, v[80:83] offset:37440
    ds_write_b128 v79, v[80:83] offset:0
    ds_write_b128 v79, v[80:83] offset:4160
    ds_write_b128 v79, v[80:83] offset:8320
    ds_write_b128 v79, v[80:83] offset:12480
    ds_write_b128 v79, v[80:83] offset:16640
    ds_write_b128 v79, v[80:83] offset:20800
    ds_write_b128 v79, v[80:83] offset:24960
    ds_write_b128 v79, v[80:83] offset:29120
    ds_write_b128 v79, v[80:83] offset:33280
    ds_write_b128 v79, v[80:83] offset:37440
KS_FILL:
    v_mov_b32 v59, 163456
    s_barrier
    ds_read_b32 v59, v59
    s_waitcnt vmcnt(0) lgkmcnt(0)
    s_cmp_eq_u32 s30, 0
    s_cbranch_scc1 KS_B3
    s_cmp_eq_u32 s30, 2
    s_cbranch_scc1 KS_NOST
    v_lshl_or_b32 v40, v65, 16, v64
    v_lshl_or_b32 v41, v67, 16, v66
    v_lshl_or_b32 v42, v69, 16, v68
    v_lshl_or_b32 v43, v71, 16, v70
    buffer_store_dwordx4 v[40:43], v9, s[8:11], s24 offen sc1
KS_NOST:
    v_mov_b32 v62, 163460
    s_waitcnt lgkmcnt(0)
    s_barrier
    ds_read_b32 v62, v62
    s_lshl_b32 s24, s2, 2
    s_add_u32 s24, s24, 7176192
    s_mov_b64 exec, 1
    s_waitcnt vmcnt(0)
    buffer_store_dword v59, v6, s[8:11], s24 offen sc1
    s_mov_b64 exec, -1
    s_branch KS_JOIN
K2_PAD_H3:
    s_branch KS_HOP0
KS_RAW:
    s_cmp_lg_u32 s2, 0
    s_cbranch_scc1 KS_NOX
    s_mov_b32 s60, s98
    s_and_b32 s61, s99, 0xffff
    s_mov_b32 s62, 256
    s_mov_b32 s63, 0x20000
    s_getreg_b32 s24, hwreg(HW_REG_XCC_ID, 0, 1)
    s_add_u32 s24, s24, 1
    v_mov_b32 v10, s24
    v_mov_b32 v11, 0
    s_mov_b64 exec, 1
    buffer_atomic_cmpswap v[10:11], v6, s[60:63], 0 offen sc1
    s_mov_b64 exec, -1
KS_NOX:
    s_barrier
    s_mov_b32 s60, s90
    s_and_b32 s61, s91, 0xffff
    s_mov_b32 s62, 20480
    s_mov_b32 s63, 0x20000
    v_lshrrev_b32 v10, 3, v8
    v_and_b32 v11, 7, v8
    v_lshlrev_b32 v10, 8, v10
    v_lshl_add_u32 v10, v11, 4, v10
    s_mov_b32 m0, 24576
    s_movk_i32 s24, 0
    buffer_load_dwordx4 v10, s[60:63], s24 offen lds
    s_mov_b32 m0, 25600
    s_movk_i32 s24, 2048
    buffer_load_dwordx4 v10, s[60:63], s24 offen lds
    s_mov_b32 m0, 26624
    s_movk_i32 s24, 4096
    buffer_load_dwordx4 v10, s[60:63], s24 offen lds
    s_mov_b32 m0, 27648
    s_movk_i32 s24, 6144
    buffer_load_dwordx4 v10, s[60:63], s24 offen lds
    s_mov_b32 m0, 28672
    s_movk_i32 s24, 8192
    buffer_load_dwordx4 v10, s[60:63], s24 offen lds
    s_mov_b32 m0, 29696
    s_movk_i32 s24, 10240
    buffer_load_dwordx4 v10, s[60:63], s24 offen lds
    s_mov_b32 m0, 30720
    s_movk_i32 s24, 12288
    buffer_load_dwordx4 v10, s[60:63], s24 offen lds
    s_mov_b32 m0, 31744
    s_movk_i32 s24, 14336
    buffer_load_dwordx4 v10, s[60:63], s24 offen lds
    s_mov_b32 m0, 32768
    s_movk_i32 s24, 16384
    buffer_load_dwordx4 v10, s[60:63], s24 offen lds
    s_mov_b32 m0, 33792
    s_movk_i32 s24, 18432
    buffer_load_dwordx4 v10, s[60:63], s24 offen lds
    s_mov_b32 m0, 152832
    s_movk_i32 s24, 128
    buffer_load_dwordx4 v10, s[60:63], s24 offen lds
    s_mov_b32 m0, 153856
    s_movk_i32 s24, 2176
    buffer_load_dwordx4 v10, s[60:63], s24 offen lds
    s_mov_b32 m0, 154880
    s_movk_i32 s24, 4224
    buffer_load_dwordx4 v10, s[60:63], s24 offen lds
    s_mov_b32 m0, 155904
    s_movk_i32 s24, 6272
    buffer_load_dwordx4 v10, s[60:63], s24 offen lds
    s_mov_b32 m0, 156928
    s_movk_i32 s24, 8320
    buffer_load_dwordx4 v10, s[60:63], s24 offen lds
    s_mov_b32 m0, 157952
    s_movk_i32 s24, 10368
    buffer_load_dwordx4 v10, s[60:63], s24 offen lds
    s_mov_b32 m0, 158976
    s_movk_i32 s24, 12416
    buffer_load_dwordx4 v10, s[60:63], s24 offen lds
    s_mov_b32 m0, 160000
    s_movk_i32 s24, 14464
    buffer_load_dwordx4 v10, s[60:63], s24 offen lds
    s_mov_b32 m0, 161024
    s_movk_i32 s24, 16512
    buffer_load_dwordx4 v10, s[60:63], s24 offen lds
    s_mov_b32 m0, 162048
    s_movk_i32 s24, 18560
    buffer_load_dwordx4 v10, s[60:63], s24 offen lds
    v_add_u32 v85, 16, v8
    v_lshlrev_b32 v84, 5, v8
    v_lshrrev_b32 v85, 6, v85
    v_mul_u32_u24 v85, 1532, v85
    v_sub_u32 v84, v84, v85
    v_mov_b32 v85, -1
    v_add_u32 v84, 66048, v84
    v_add_u32 v86, 41600, v84
    ds_write_b32 v84, v85 offset:0
    ds_write_b32 v84, v85 offset:2080
    ds_write_b32 v84, v85 offset:4160
    ds_write_b32 v84, v85 offset:6240
    ds_write_b32 v84, v85 offset:8320
    ds_write_b32 v84, v85 offset:10400
    ds_write_b32 v84, v85 offset:12480
    ds_write_b32 v84, v85 offset:14560
    ds_write_b32 v84, v85 offset:16640
    ds_write_b32 v84, v85 offset:18720
    ds_write_b32 v84, v85 offset:20800
    ds_write_b32 v84, v85 offset:22880
    ds_write_b32 v84, v85 offset:24960
    ds_write_b32 v84, v85 offset:27040
    ds_write_b32 v84, v85 offset:29120
    ds_write_b32 v84, v85 offset:31200
    ds_write_b32 v84, v85 offset:33280
    ds_write_b32 v84, v85 offset:35360
    ds_write_b32 v84, v85 offset:37440
    ds_write_b32 v84, v85 offset:39520
    ds_write_b32 v86, v85 offset:0
    ds_write_b32 v86, v85 offset:2080
    ds_write_b32 v86, v85 offset:4160
    ds_write_b32 v86, v85 offset:6240
    ds_write_b32 v86, v85 offset:8320
    ds_write_b32 v86, v85 offset:10400
    ds_write_b32 v86, v85 offset:12480
    ds_write_b32 v86, v85 offset:14560
    ds_write_b32 v86, v85 offset:16640
    ds_write_b32 v86, v85 offset:18720
    ds_write_b32 v86, v85 offset:20800
    ds_write_b32 v86, v85 offset:22880
    ds_write_b32 v86, v85 offset:24960
    ds_write_b32 v86, v85 offset:27040
    ds_write_b32 v86, v85 offset:29120
    ds_write_b32 v86, v85 offset:31200
    ds_write_b32 v86, v85 offset:33280
    ds_write_b32 v86, v85 offset:35360
    ds_write_b32 v86, v85 offset:37440
    ds_write_b32 v86, v85 offset:39520
    s_branch KS_FILL
KS_IDLE:
    s_barrier
    s_barrier
    s_branch KS_B3
K2_PAD_U20:
    s_branch K2_HOP
K2_U20:
    s_setprio 1
    s_waitcnt lgkmcnt(0)
    v_lshlrev_b32 v20, 16, v0
    v_and_b32 v21, 0xffff0000, v0
    v_lshlrev_b32 v22, 16, v1
    v_and_b32 v23, 0xffff0000, v1
    v_lshlrev_b32 v24, 16, v2
    v_and_b32 v25, 0xffff0000, v2
    v_lshlrev_b32 v26, 16, v3
    v_and_b32 v27, 0xffff0000, v3
    v_mul_f32_dpp v36, v16, v20 row_newbcast:8 row_mask:0xf bank_mask:0xf
    v_mul_f32_dpp v37, v16, v21 row_newbcast:9 row_mask:0xf bank_mask:0xf
    v_mul_f32_dpp v38, v16, v22 row_newbcast:10 row_mask:0xf bank_mask:0xf
    v_mul_f32_dpp v39, v16, v23 row_newbcast:11 row_mask:0xf bank_mask:0xf
    v_mul_f32_dpp v40, v16, v24 row_newbcast:12 row_mask:0xf bank_mask:0xf
    v_mul_f32_dpp v41, v16, v25 row_newbcast:13 row_mask:0xf bank_mask:0xf
    v_mul_f32_dpp v42, v16, v26 row_newbcast:14 row_mask:0xf bank_mask:0xf
    v_mul_f32_dpp v43, v16, v27 row_newbcast:15 row_mask:0xf bank_mask:0xf
    v_cvt_pk_bf16_f32 v68, v36, v37
    v_cvt_pk_bf16_f32 v69, v38, v39
    v_cvt_pk_bf16_f32 v70, v40, v41
    v_cvt_pk_bf16_f32 v71, v42, v43
    v_mul_f32_dpp v20, v16, v20 row_newbcast:0 row_mask:0xa bank_mask:0xf
    v_mul_f32_dpp v21, v16, v21 row_newbcast:1 row_mask:0xa bank_mask:0xf
    v_mul_f32_dpp v22, v16, v22 row_newbcast:2 row_mask:0xa bank_mask:0xf
    v_mul_f32_dpp v23, v16, v23 row_newbcast:3 row_mask:0xa bank_mask:0xf
    v_mul_f32_dpp v24, v16, v24 row_newbcast:4 row_mask:0xa bank_mask:0xf
    v_mul_f32_dpp v25, v16, v25 row_newbcast:5 row_mask:0xa bank_mask:0xf
    v_mul_f32_dpp v26, v16, v26 row_newbcast:6 row_mask:0xa bank_mask:0xf
    v_mul_f32_dpp v27, v16, v27 row_newbcast:7 row_mask:0xa bank_mask:0xf
    v_cvt_pk_bf16_f32 v64, v20, v21
    v_cvt_pk_bf16_f32 v65, v22, v23
    v_cvt_pk_bf16_f32 v66, v24, v25
    v_cvt_pk_bf16_f32 v67, v26, v27
    v_lshlrev_b32 v28, 16, v4
    v_and_b32 v29, 0xffff0000, v4
    v_lshlrev_b32 v30, 16, v5
    v_and_b32 v31, 0xffff0000, v5
    v_lshlrev_b32 v32, 16, v6
    v_and_b32 v33, 0xffff0000, v6
    v_lshlrev_b32 v34, 16, v7
    v_and_b32 v35, 0xffff0000, v7
    v_mul_f32_dpp v36, v17, v28 row_newbcast:8 row_mask:0xf bank_mask:0xf
    v_mul_f32_dpp v37, v17, v29 row_newbcast:9 row_mask:0xf bank_mask:0xf
    v_mul_f32_dpp v38, v17, v30 row_newbcast:10 row_mask:0xf bank_mask:0xf
    v_mul_f32_dpp v39, v17, v31 row_newbcast:11 row_mask:0xf bank_mask:0xf
    v_mul_f32_dpp v40, v17, v32 row_newbcast:12 row_mask:0xf bank_mask:0xf
    v_mul_f32_dpp v41, v17, v33 row_newbcast:13 row_mask:0xf bank_mask:0xf
    v_mul_f32_dpp v42, v17, v34 row_newbcast:14 row_mask:0xf bank_mask:0xf
    v_mul_f32_dpp v43, v17, v35 row_newbcast:15 row_mask:0xf bank_mask:0xf
    v_cvt_pk_bf16_f32 v76, v36, v37
    v_cvt_pk_bf16_f32 v77, v38, v39
    v_cvt_pk_bf16_f32 v78, v40, v41
    v_cvt_pk_bf16_f32 v79, v42, v43
    v_mul_f32_dpp v28, v17, v28 row_newbcast:0 row_mask:0xa bank_mask:0xf
    v_mul_f32_dpp v29, v17, v29 row_newbcast:1 row_mask:0xa bank_mask:0xf
    v_mul_f32_dpp v30, v17, v30 row_newbcast:2 row_mask:0xa bank_mask:0xf
    v_mul_f32_dpp v31, v17, v31 row_newbcast:3 row_mask:0xa bank_mask:0xf
    v_mul_f32_dpp v32, v17, v32 row_newbcast:4 row_mask:0xa bank_mask:0xf
    v_mul_f32_dpp v33, v17, v33 row_newbcast:5 row_mask:0xa bank_mask:0xf
    v_mul_f32_dpp v34, v17, v34 row_newbcast:6 row_mask:0xa bank_mask:0xf
    v_mul_f32_dpp v35, v17, v35 row_newbcast:7 row_mask:0xa bank_mask:0xf
    v_cvt_pk_bf16_f32 v72, v28, v29
    v_cvt_pk_bf16_f32 v73, v30, v31
    v_cvt_pk_bf16_f32 v74, v32, v33
    v_cvt_pk_bf16_f32 v75, v34, v35
    s_waitcnt vmcnt(4)
    v_mfma_f32_32x32x16_bf16 v[0:15], v[64:67], v[176:179], 0
    ds_read_b64_tr_b16 v[184:185], v246 offset:2048
    ds_read_b64_tr_b16 v[186:187], v246 offset:3072
    ds_read_b64_tr_b16 v[188:189], v247 offset:2048
    ds_read_b64_tr_b16 v[190:191], v247 offset:3072
    s_mov_b32 m0, s68
    v_mfma_f32_32x32x16_bf16 v[16:31], v[68:71], v[176:179], 0
    buffer_load_dwordx4 v222, s[4:7], s42 offen sc1 lds
    buffer_load_dwordx4 v223, s[72:75], s42 offen offset:1024 sc1 lds
    v_permlane32_swap_b32 v242, v236
    v_permlane32_swap_b32 v243, v237
    s_add_u32 s38, s38, 1
    v_mfma_f32_32x32x16_bf16 v[32:47], v[64:67], v[180:183], 0
    v_permlane32_swap_b32 v244, v238
    v_permlane32_swap_b32 v245, v239
    v_permlane32_swap_b32 v240, v241
    v_add_f32 v242, v242, v236
    v_mfma_f32_32x32x16_bf16 v[48:63], v[68:71], v[180:183], 0
    v_add_f32 v243, v243, v237
    v_add_f32 v244, v244, v238
    v_add_f32 v245, v245, v239
    v_add_f32 v240, -v240, -v241
    v_mov_b32 v254, s52
    v_mov_b32 v255, s38
    s_waitcnt vmcnt(4) lgkmcnt(0)
    v_mfma_f32_32x32x16_bf16 v[0:15], v[72:75], v[184:187], v[0:15]
    ds_read_b64_tr_b16 v[176:177], v246 offset:4096
    ds_read_b64_tr_b16 v[178:179], v246 offset:5120
    ds_read_b64_tr_b16 v[180:181], v247 offset:4096
    ds_read_b64_tr_b16 v[182:183], v247 offset:5120
    s_lshl_b32 s58, s38, 3
    s_add_u32 s58, s58, s20
    s_mov_b32 m0, s69
    v_mfma_f32_32x32x16_bf16 v[16:31], v[76:79], v[184:187], v[16:31]
    buffer_load_dwordx4 v224, s[4:7], s42 offen sc1 lds
    buffer_load_dwordx4 v225, s[72:75], s42 offen offset:1024 sc1 lds
    s_set_gpr_idx_on s32, gpr_idx(DST)
    s_nop 0
    v_cvt_pk_bf16_f32 v195, v242, v243
    v_cvt_pk_bf16_f32 v196, v244, v245
    v_cvt_pk_bf16_f32 v197, v240, v240
    s_set_gpr_idx_off
    s_mov_b64 exec, 1
    ds_write_b32 v254, v255
    s_mov_b64 exec, -1
    s_cmp_lt_u32 s58, s22
    s_cbranch_scc0 K2_dyn_10
K2_back_11:
    v_readlane_b32 s3, v253, s58
    s_lshl_b32 s44, s34, 7
    s_and_b32 s48, s3, 0x3ffff
    s_bfe_u32 s33, s3, 0x30013
    s_mul_i32 s35, s38, 6
    s_cmp_eq_u32 s34, 0
    s_cselect_b32 s35, s35, s48
    s_mov_b32 s45, s44
    s_xor_b32 s47, s44, 256
    s_add_u32 s49, s48, 128
    s_add_u32 s60, s48, 256
    s_cmp_eq_u32 s33, 3
    s_cselect_b32 s46, s44, s47
    s_cselect_b32 s50, s60, s48
    s_sub_u32 s60, s33, 2
    s_cmp_lt_u32 s60, 2
    s_cbranch_scc0 K2_rare_16
K2_back_17:
    v_mfma_f32_32x32x16_bf16 v[32:47], v[72:75], v[188:191], v[32:47]
    v_add_u32 v233, s48, v230
    ds_read_b32 v232, v233
    ds_read_b32 v233, v233 offset:1024
    v_mul_f32 v234, v0, v96
    v_mul_f32 v236, v8, v128
    v_fmac_f32 v234, v1, v97
    v_fmac_f32 v236, v9, v129
    v_mfma_f32_32x32x16_bf16 v[48:63], v[76:79], v[188:191], v[48:63]
    s_setprio 0
    v_fmac_f32 v234, v2, v98
    v_fmac_f32 v236, v10, v130
    v_fmac_f32 v234, v3, v99
    v_fmac_f32 v236, v11, v131
    v_fmac_f32 v234, v4, v100
    v_fmac_f32 v236, v12, v132
    v_fmac_f32 v234, v5, v101
    v_fmac_f32 v236, v13, v133
    v_fmac_f32 v234, v6, v102
    v_fmac_f32 v236, v14, v134
    v_fmac_f32 v234, v7, v103
    v_fmac_f32 v236, v15, v135
    v_mul_f32 v238, v16, v128
    v_mul_f32 v240, v24, v128
    v_fmac_f32 v238, v17, v129
    v_fmac_f32 v240, v25, v129
    v_fmac_f32 v238, v18, v130
    v_fmac_f32 v240, v26, v130
    v_fmac_f32 v238, v19, v131
    v_fmac_f32 v240, v27, v131
    v_fmac_f32 v238, v20, v132
    v_fmac_f32 v240, v28, v132
    v_fmac_f32 v238, v21, v133
    v_fmac_f32 v240, v29, v133
    v_fmac_f32 v238, v22, v134
    v_fmac_f32 v240, v30, v134
    v_fmac_f32 v238, v23, v135
    v_fmac_f32 v240, v31, v135
    v_mul_f32 v235, v32, v104
    v_mul_f32 v237, v40, v136
    v_fmac_f32 v235, v33, v105
    v_fmac_f32 v237, v41, v137
    v_fmac_f32 v235, v34, v106
    v_fmac_f32 v237, v42, v138
    v_fmac_f32 v235, v35, v107
    v_fmac_f32 v237, v43, v139
    v_fmac_f32 v235, v36, v108
    v_fmac_f32 v237, v44, v140
    v_fmac_f32 v235, v37, v109
    v_fmac_f32 v237, v45, v141
    v_fmac_f32 v235, v38, v110
    v_fmac_f32 v237, v46, v142
    v_fmac_f32 v235, v39, v111
    v_fmac_f32 v237, v47, v143
    v_mul_f32 v239, v48, v136
    v_mul_f32 v241, v56, v136
    v_fmac_f32 v239, v49, v137
    v_fmac_f32 v241, v57, v137
    s_setprio 1
    s_waitcnt vmcnt(4) lgkmcnt(3)
    v_mfma_f32_32x32x16_bf16 v[0:15], v[64:67], v[176:179], 0
    ds_read_b64_tr_b16 v[184:185], v246 offset:6144
    ds_read_b64_tr_b16 v[186:187], v246 offset:7168
    ds_read_b64_tr_b16 v[188:189], v247 offset:6144
    ds_read_b64_tr_b16 v[190:191], v247 offset:7168
    v_fmac_f32 v239, v50, v138
    v_fmac_f32 v241, v58, v138
    s_mov_b32 m0, s70
    v_mfma_f32_32x32x16_bf16 v[16:31], v[68:71], v[176:179], 0
    buffer_load_dwordx4 v222, s[4:7], s43 offen sc1 lds
    buffer_load_dwordx4 v223, s[72:75], s43 offen offset:1024 sc1 lds
    v_fmac_f32 v239, v51, v139
    v_fmac_f32 v241, v59, v139
    v_fmac_f32 v239, v52, v140
    v_fmac_f32 v241, v60, v140
    v_fmac_f32 v239, v53, v141
    v_mfma_f32_32x32x16_bf16 v[32:47], v[64:67], v[180:183], 0
    v_add_u32 v222, s48, v251
    ds_read2_b32 v[222:223], v222 offset0:1 offset1:3
    v_fmac_f32 v241, v61, v141
    v_fmac_f32 v239, v54, v142
    v_fmac_f32 v241, v62, v142
    v_fmac_f32 v239, v55, v143
    v_fmac_f32 v241, v63, v143
    v_mfma_f32_32x32x16_bf16 v[48:63], v[68:71], v[180:183], 0
    v_permlane32_swap_b32 v234, v236
    v_permlane32_swap_b32 v235, v237
    v_permlane32_swap_b32 v240, v238
    s_waitcnt lgkmcnt(5)
    v_or_b32 v232, v232, v231
    v_or_b32 v233, v233, v231
    s_cmp_lg_u32 s34, 0
    s_cbranch_scc1 K2_dum_21
    s_cmp_eq_u32 s33, 4
    s_cbranch_scc1 K2_a4_22
K2_b4_24:
    s_add_u32 m0, s48, 512
    s_add_u32 s65, s48, 1536
    buffer_load_dwordx4 v232, s[16:19], 0 offen  lds
    s_mov_b32 m0, s65
    s_mov_b32 exec_hi, 0
    buffer_load_dwordx4 v233, s[16:19], 0 offen  lds
    s_mov_b32 exec_hi, -1
K2_back_23:
    s_waitcnt vmcnt(6) lgkmcnt(1)
    v_mfma_f32_32x32x16_bf16 v[0:15], v[72:75], v[184:187], v[0:15]
    ds_read_b64_tr_b16 v[176:177], v246 offset:0
    ds_read_b64_tr_b16 v[178:179], v246 offset:1024
    ds_read_b64_tr_b16 v[180:181], v247 offset:0
    ds_read_b64_tr_b16 v[182:183], v247 offset:1024
    v_permlane32_swap_b32 v241, v239
    s_mov_b32 m0, s71
    v_mfma_f32_32x32x16_bf16 v[16:31], v[76:79], v[184:187], v[16:31]
    buffer_load_dwordx4 v224, s[4:7], s43 offen sc1 lds
    buffer_load_dwordx4 v225, s[72:75], s43 offen offset:1024 sc1 lds
    s_waitcnt lgkmcnt(4)
    v_mad_u32_u16 v222, v222, s39, v248 op_sel:[1,0,0,0]
    v_mad_u32_u16 v223, v223, s39, v248 op_sel:[1,0,0,0]
    v_add_f32 v234, v234, v236
    v_add_f32 v235, v235, v237
    v_add_f32 v240, v240, v238
    v_add_f32 v241, v241, v239
    s_set_gpr_idx_on s31, gpr_idx(DST)
    s_nop 0
    v_cvt_pk_bf16_f32 v192, v234, v235
    v_cvt_pk_bf16_f32 v193, v240, v241
    s_set_gpr_idx_off
    v_mfma_f32_32x32x16_bf16 v[32:47], v[72:75], v[188:191], v[32:47]
    v_add_u32 v224, s49, v251
    ds_read2_b32 v[224:225], v224 offset0:1 offset1:3
    v_mul_f32 v234, v0, v144
    v_mul_f32 v236, v8, v112
    v_fmac_f32 v234, v1, v145
    v_fmac_f32 v236, v9, v113
    v_fmac_f32 v234, v2, v146
    v_mfma_f32_32x32x16_bf16 v[48:63], v[76:79], v[188:191], v[48:63]
    s_setprio 0
    v_fmac_f32 v236, v10, v114
    v_fmac_f32 v234, v3, v147
    v_fmac_f32 v236, v11, v115
    v_fmac_f32 v234, v4, v148
    v_fmac_f32 v236, v12, v116
    v_fmac_f32 v234, v5, v149
    v_fmac_f32 v236, v13, v117
    v_fmac_f32 v234, v6, v150
    v_fmac_f32 v236, v14, v118
    v_fmac_f32 v234, v7, v151
    v_fmac_f32 v236, v15, v119
    v_mul_f32 v238, v16, v160
    v_mul_f32 v240, v24, v160
    v_fmac_f32 v238, v17, v161
    v_fmac_f32 v240, v25, v161
    v_fmac_f32 v238, v18, v162
    v_fmac_f32 v240, v26, v162
    v_fmac_f32 v238, v19, v163
    v_fmac_f32 v240, v27, v163
    v_fmac_f32 v238, v20, v164
    v_fmac_f32 v240, v28, v164
    v_fmac_f32 v238, v21, v165
    v_fmac_f32 v240, v29, v165
    v_fmac_f32 v238, v22, v166
    v_fmac_f32 v240, v30, v166
    v_fmac_f32 v238, v23, v167
    v_fmac_f32 v240, v31, v167
    v_mul_f32 v235, v32, v152
    v_mul_f32 v237, v40, v120
    v_fmac_f32 v235, v33, v153
    v_fmac_f32 v237, v41, v121
    v_fmac_f32 v235, v34, v154
    v_fmac_f32 v237, v42, v122
    v_fmac_f32 v235, v35, v155
    v_fmac_f32 v237, v43, v123
    v_fmac_f32 v235, v36, v156
    v_fmac_f32 v237, v44, v124
    v_fmac_f32 v235, v37, v157
    v_fmac_f32 v237, v45, v125
    v_fmac_f32 v235, v38, v158
    v_fmac_f32 v237, v46, v126
    v_fmac_f32 v235, v39, v159
    v_fmac_f32 v237, v47, v127
    v_mul_f32 v239, v48, v168
    v_mul_f32 v241, v56, v168
    v_fmac_f32 v239, v49, v169
    v_fmac_f32 v241, v57, v169
    v_fmac_f32 v239, v50, v170
    v_fmac_f32 v241, v58, v170
    v_fmac_f32 v239, v51, v171
    s_setprio 1
    s_waitcnt vmcnt(6) lgkmcnt(1)
    v_mfma_f32_32x32x16_bf16 v[0:15], v[64:67], v[176:179], 0
    ds_read_b64_tr_b16 v[184:185], v246 offset:2048
    ds_read_b64_tr_b16 v[186:187], v246 offset:3072
    ds_read_b64_tr_b16 v[188:189], v247 offset:2048
    ds_read_b64_tr_b16 v[190:191], v247 offset:3072
    v_fmac_f32 v241, v59, v171
    v_fmac_f32 v239, v52, v172
    s_mov_b32 m0, s68
    v_mfma_f32_32x32x16_bf16 v[16:31], v[68:71], v[176:179], 0
    buffer_load_dwordx4 v222, s[4:7], s44 offen sc1 lds
    buffer_load_dwordx4 v223, s[72:75], s44 offen offset:1024 sc1 lds
    s_waitcnt lgkmcnt(4)
    v_mad_u32_u16 v224, v224, s39, v248 op_sel:[1,0,0,0]
    v_mad_u32_u16 v225, v225, s39, v248 op_sel:[1,0,0,0]
    v_fmac_f32 v241, v60, v172
    v_fmac_f32 v239, v53, v173
    v_mfma_f32_32x32x16_bf16 v[32:47], v[64:67], v[180:183], 0
    v_add_u32 v226, s50, v251
    ds_read2_b32 v[226:227], v226 offset0:1 offset1:3
    v_fmac_f32 v241, v61, v173
    v_fmac_f32 v239, v54, v174
    v_fmac_f32 v241, v62, v174
    v_fmac_f32 v239, v55, v175
    v_fmac_f32 v241, v63, v175
    v_mfma_f32_32x32x16_bf16 v[48:63], v[68:71], v[180:183], 0
    s_waitcnt vmcnt(6) lgkmcnt(1)
    v_mfma_f32_32x32x16_bf16 v[0:15], v[72:75], v[184:187], v[0:15]
    ds_read_b64_tr_b16 v[176:177], v246 offset:4096
    ds_read_b64_tr_b16 v[178:179], v246 offset:5120
    ds_read_b64_tr_b16 v[180:181], v247 offset:4096
    ds_read_b64_tr_b16 v[182:183], v247 offset:5120
    s_mov_b32 m0, s69
    v_mfma_f32_32x32x16_bf16 v[16:31], v[76:79], v[184:187], v[16:31]
    buffer_load_dwordx4 v224, s[4:7], s45 offen sc1 lds
    buffer_load_dwordx4 v225, s[72:75], s45 offen offset:1024 sc1 lds
    s_waitcnt lgkmcnt(4)
    v_mad_u32_u16 v226, v226, s39, v248 op_sel:[1,0,0,0]
    v_mad_u32_u16 v227, v227, s39, v248 op_sel:[1,0,0,0]
    v_mfma_f32_32x32x16_bf16 v[32:47], v[72:75], v[188:191], v[32:47]
    v_mul_f32 v242, v0, v144
    v_fma_f32 v238, v8, v160, -v238
    v_fmac_f32 v242, v1, v145
    v_fmac_f32 v238, v9, v161
    v_fmac_f32 v242, v2, v146
    v_fmac_f32 v238, v10, v162
    v_fmac_f32 v242, v3, v147
    v_mfma_f32_32x32x16_bf16 v[48:63], v[76:79], v[188:191], v[48:63]
    s_setprio 0
    v_fmac_f32 v238, v11, v163
    v_fmac_f32 v242, v4, v148
    v_fmac_f32 v238, v12, v164
    v_fmac_f32 v242, v5, v149
    v_fmac_f32 v238, v13, v165
    v_fmac_f32 v242, v6, v150
    v_fmac_f32 v238, v14, v166
    v_fmac_f32 v242, v7, v151
    v_fmac_f32 v238, v15, v167
    v_fmac_f32 v236, v16, v112
    v_mul_f32 v244, v24, v160
    v_fmac_f32 v236, v17, v113
    v_fmac_f32 v244, v25, v161
    v_fmac_f32 v236, v18, v114
    v_fmac_f32 v244, v26, v162
    v_fmac_f32 v236, v19, v115
    v_fmac_f32 v244, v27, v163
    v_fmac_f32 v236, v20, v116
    v_fmac_f32 v244, v28, v164
    v_fmac_f32 v236, v21, v117
    v_fmac_f32 v244, v29, v165
    v_fmac_f32 v236, v22, v118
    v_fmac_f32 v244, v30, v166
    v_fmac_f32 v236, v23, v119
    v_fmac_f32 v244, v31, v167
    v_mul_f32 v243, v32, v152
    v_fma_f32 v239, v40, v168, -v239
    v_fmac_f32 v243, v33, v153
    v_fmac_f32 v239, v41, v169
    v_fmac_f32 v243, v34, v154
    v_fmac_f32 v239, v42, v170
    v_fmac_f32 v243, v35, v155
    v_fmac_f32 v239, v43, v171
    v_fmac_f32 v243, v36, v156
    v_fmac_f32 v239, v44, v172
    v_fmac_f32 v243, v37, v157
    v_fmac_f32 v239, v45, v173
    v_fmac_f32 v243, v38, v158
    v_fmac_f32 v239, v46, v174
    v_fmac_f32 v243, v39, v159
    v_fmac_f32 v239, v47, v175
    v_fmac_f32 v237, v48, v120
    v_mul_f32 v245, v56, v168
    s_setprio 1
    s_waitcnt vmcnt(4) lgkmcnt(0)
    v_mfma_f32_32x32x16_bf16 v[0:15], v[64:67], v[176:179], 0
    ds_read_b64_tr_b16 v[184:185], v246 offset:6144
    ds_read_b64_tr_b16 v[186:187], v246 offset:7168
    ds_read_b64_tr_b16 v[188:189], v247 offset:6144
    ds_read_b64_tr_b16 v[190:191], v247 offset:7168
    v_fmac_f32 v237, v49, v121
    v_fmac_f32 v245, v57, v169
    s_mov_b32 m0, s70
    v_mfma_f32_32x32x16_bf16 v[16:31], v[68:71], v[176:179], 0
    buffer_load_dwordx4 v226, s[4:7], s46 offen sc1 lds
    buffer_load_dwordx4 v227, s[72:75], s46 offen offset:1024 sc1 lds
    v_fmac_f32 v237, v50, v122
    v_fmac_f32 v245, v58, v170
    v_fmac_f32 v237, v51, v123
    v_fmac_f32 v245, v59, v171
    v_fmac_f32 v237, v52, v124
    v_mfma_f32_32x32x16_bf16 v[32:47], v[64:67], v[180:183], 0
    v_fmac_f32 v245, v60, v172
    v_fmac_f32 v237, v53, v125
    v_fmac_f32 v245, v61, v173
    v_fmac_f32 v237, v54, v126
    v_fmac_f32 v245, v62, v174
    v_fmac_f32 v237, v55, v127
    v_fmac_f32 v245, v63, v175
    v_mfma_f32_32x32x16_bf16 v[48:63], v[68:71], v[180:183], 0
    v_permlane32_swap_b32 v242, v234
    v_permlane32_swap_b32 v243, v235
    v_add_f32 v242, v242, v234
    v_add_f32 v243, v243, v235
    s_waitcnt vmcnt(4) lgkmcnt(0)
    v_mfma_f32_32x32x16_bf16 v[0:15], v[72:75], v[184:187], v[0:15]
    ds_read_b64_tr_b16 v[176:177], v246 offset:0
    ds_read_b64_tr_b16 v[178:179], v246 offset:1024
    ds_read_b64_tr_b16 v[180:181], v247 offset:0
    ds_read_b64_tr_b16 v[182:183], v247 offset:1024
    s_sub_u32 s26, s48, s29
    s_mov_b32 s29, s48
    s_mov_b32 m0, s71
    v_mfma_f32_32x32x16_bf16 v[16:31], v[76:79], v[184:187], v[16:31]
    s_cmp_eq_u32 s33, 4
    s_cbranch_scc1 K2_g4_19
    buffer_load_dwordx4 v224, s[4:7], s47 offen sc1 lds
    buffer_load_dwordx4 v225, s[72:75], s47 offen offset:1024 sc1 lds
K2_back_20:
    s_set_gpr_idx_on s31, gpr_idx(DST)
    s_nop 0
    v_cvt_pk_bf16_f32 v194, v242, v243
    s_set_gpr_idx_off
    s_mov_b32 s30, s3
    s_bfe_u32 s56, s3, 0x40012
    s_cmp_eq_u32 s34, 0
    s_cselect_b32 s56, s56, 0
    v_mfma_f32_32x32x16_bf16 v[32:47], v[72:75], v[188:191], v[32:47]
    s_mov_b32 s32, s31
    s_mov_b32 s31, s35
    v_mul_f32 v242, v0, v144
    v_fma_f32 v240, v8, v160, -v240
    v_fmac_f32 v242, v1, v145
    v_fmac_f32 v240, v9, v161
    v_fmac_f32 v242, v2, v146
    v_mfma_f32_32x32x16_bf16 v[48:63], v[76:79], v[188:191], v[48:63]
    s_setprio 0
    v_fmac_f32 v240, v10, v162
    v_fmac_f32 v242, v3, v147
    v_fmac_f32 v240, v11, v163
    v_fmac_f32 v242, v4, v148
    v_fmac_f32 v240, v12, v164
    v_fmac_f32 v242, v5, v149
    v_fmac_f32 v240, v13, v165
    v_fmac_f32 v242, v6, v150
    v_fmac_f32 v240, v14, v166
    v_fmac_f32 v242, v7, v151
    v_fmac_f32 v240, v15, v167
    v_add_u32 v249, s26, v249
    v_add_u32 v250, s26, v250
    v_fma_f32 v244, v16, v160, -v244
    v_fmac_f32 v236, v24, v112
    v_fmac_f32 v244, v17, v161
    v_fmac_f32 v236, v25, v113
    v_fmac_f32 v244, v18, v162
    v_fmac_f32 v236, v26, v114
    v_fmac_f32 v244, v19, v163
    v_fmac_f32 v236, v27, v115
    v_fmac_f32 v244, v20, v164
    v_fmac_f32 v236, v28, v116
    v_fmac_f32 v244, v21, v165
    v_fmac_f32 v236, v29, v117
    v_fmac_f32 v244, v22, v166
    v_fmac_f32 v236, v30, v118
    v_fmac_f32 v244, v23, v167
    v_fmac_f32 v236, v31, v119
    ds_read_b64_tr_b16 v[0:1], v249 offset:0
    ds_read_b64_tr_b16 v[2:3], v249 offset:32
    ds_read_u16_d16_hi v16, v250 offset:0
    v_mul_f32 v243, v32, v152
    v_fma_f32 v241, v40, v168, -v241
    v_fmac_f32 v243, v33, v153
    v_fmac_f32 v241, v41, v169
    v_fmac_f32 v243, v34, v154
    v_fmac_f32 v241, v42, v170
    v_fmac_f32 v243, v35, v155
    v_fmac_f32 v241, v43, v171
    v_fmac_f32 v243, v36, v156
    v_fmac_f32 v241, v44, v172
    v_fmac_f32 v243, v37, v157
    v_fmac_f32 v241, v45, v173
    v_fmac_f32 v243, v38, v158
    v_fmac_f32 v241, v46, v174
    v_fmac_f32 v243, v39, v159
    v_fmac_f32 v241, v47, v175
    ds_read_b64_tr_b16 v[4:5], v249 offset:512
    ds_read_b64_tr_b16 v[6:7], v249 offset:544
    ds_read_u16_d16_hi v17, v250 offset:128
    v_fma_f32 v245, v48, v168, -v245
    v_fmac_f32 v237, v56, v120
    v_fmac_f32 v245, v49, v169
    v_fmac_f32 v237, v57, v121
    v_fmac_f32 v245, v50, v170
    v_fmac_f32 v237, v58, v122
    v_fmac_f32 v245, v51, v171
    v_fmac_f32 v237, v59, v123
    v_fmac_f32 v245, v52, v172
    v_fmac_f32 v237, v60, v124
    v_fmac_f32 v245, v53, v173
    v_fmac_f32 v237, v61, v125
    v_fmac_f32 v245, v54, v174
    v_fmac_f32 v237, v62, v126
    v_fmac_f32 v245, v55, v175
    v_fmac_f32 v237, v63, v127
    s_cmp_eq_u32 s56, 5
    s_cbranch_scc1 K2_U20
    s_cmp_eq_u32 s56, 6
    s_cbranch_scc1 K2_U3h0
    s_branch K2_DSP0
K2_PAD_U30:
    s_branch K2_HOP
K2_U3h0:
    s_setprio 1
    ds_read_b64_tr_b16 v[8:9], v249 offset:1024
    ds_read_u16_d16_hi v18, v250 offset:256
    s_waitcnt lgkmcnt(2)
    v_lshlrev_b32 v20, 16, v0
    v_and_b32 v21, 0xffff0000, v0
    v_lshlrev_b32 v22, 16, v1
    v_and_b32 v23, 0xffff0000, v1
    v_lshlrev_b32 v24, 16, v2
    v_and_b32 v25, 0xffff0000, v2
    v_lshlrev_b32 v26, 16, v3
    v_and_b32 v27, 0xffff0000, v3
    v_mul_f32_dpp v36, v16, v20 row_newbcast:8 row_mask:0xf bank_mask:0xf
    v_mul_f32_dpp v37, v16, v21 row_newbcast:9 row_mask:0xf bank_mask:0xf
    v_mul_f32_dpp v38, v16, v22 row_newbcast:10 row_mask:0xf bank_mask:0xf
    v_mul_f32_dpp v39, v16, v23 row_newbcast:11 row_mask:0xf bank_mask:0xf
    v_mul_f32_dpp v40, v16, v24 row_newbcast:12 row_mask:0xf bank_mask:0xf
    v_mul_f32_dpp v41, v16, v25 row_newbcast:13 row_mask:0xf bank_mask:0xf
    v_mul_f32_dpp v42, v16, v26 row_newbcast:14 row_mask:0xf bank_mask:0xf
    v_mul_f32_dpp v43, v16, v27 row_newbcast:15 row_mask:0xf bank_mask:0xf
    v_cvt_pk_bf16_f32 v68, v36, v37
    v_cvt_pk_bf16_f32 v69, v38, v39
    v_cvt_pk_bf16_f32 v70, v40, v41
    v_cvt_pk_bf16_f32 v71, v42, v43
    v_mul_f32_dpp v20, v16, v20 row_newbcast:0 row_mask:0xa bank_mask:0xf
    v_mul_f32_dpp v21, v16, v21 row_newbcast:1 row_mask:0xa bank_mask:0xf
    v_mul_f32_dpp v22, v16, v22 row_newbcast:2 row_mask:0xa bank_mask:0xf
    v_mul_f32_dpp v23, v16, v23 row_newbcast:3 row_mask:0xa bank_mask:0xf
    v_mul_f32_dpp v24, v16, v24 row_newbcast:4 row_mask:0xa bank_mask:0xf
    v_mul_f32_dpp v25, v16, v25 row_newbcast:5 row_mask:0xa bank_mask:0xf
    v_mul_f32_dpp v26, v16, v26 row_newbcast:6 row_mask:0xa bank_mask:0xf
    v_mul_f32_dpp v27, v16, v27 row_newbcast:7 row_mask:0xa bank_mask:0xf
    v_cvt_pk_bf16_f32 v64, v20, v21
    v_cvt_pk_bf16_f32 v65, v22, v23
    v_cvt_pk_bf16_f32 v66, v24, v25
    v_cvt_pk_bf16_f32 v67, v26, v27
    v_lshlrev_b32 v28, 16, v4
    v_and_b32 v29, 0xffff0000, v4
    v_lshlrev_b32 v30, 16, v5
    v_and_b32 v31, 0xffff0000, v5
    v_lshlrev_b32 v32, 16, v6
    v_and_b32 v33, 0xffff0000, v6
    v_lshlrev_b32 v34, 16, v7
    v_and_b32 v35, 0xffff0000, v7
    v_mul_f32_dpp v36, v17, v28 row_newbcast:8 row_mask:0xf bank_mask:0xf
    v_mul_f32_dpp v37, v17, v29 row_newbcast:9 row_mask:0xf bank_mask:0xf
    v_mul_f32_dpp v38, v17, v30 row_newbcast:10 row_mask:0xf bank_mask:0xf
    v_mul_f32_dpp v39, v17, v31 row_newbcast:11 row_mask:0xf bank_mask:0xf
    v_mul_f32_dpp v40, v17, v32 row_newbcast:12 row_mask:0xf bank_mask:0xf
    v_mul_f32_dpp v41, v17, v33 row_newbcast:13 row_mask:0xf bank_mask:0xf
    v_mul_f32_dpp v42, v17, v34 row_newbcast:14 row_mask:0xf bank_mask:0xf
    v_mul_f32_dpp v43, v17, v35 row_newbcast:15 row_mask:0xf bank_mask:0xf
    v_cvt_pk_bf16_f32 v76, v36, v37
    v_cvt_pk_bf16_f32 v77, v38, v39
    v_cvt_pk_bf16_f32 v78, v40, v41
    v_cvt_pk_bf16_f32 v79, v42, v43
    v_mul_f32_dpp v28, v17, v28 row_newbcast:0 row_mask:0xa bank_mask:0xf
    v_mul_f32_dpp v29, v17, v29 row_newbcast:1 row_mask:0xa bank_mask:0xf
    v_mul_f32_dpp v30, v17, v30 row_newbcast:2 row_mask:0xa bank_mask:0xf
    v_mul_f32_dpp v31, v17, v31 row_newbcast:3 row_mask:0xa bank_mask:0xf
    v_mul_f32_dpp v32, v17, v32 row_newbcast:4 row_mask:0xa bank_mask:0xf
    v_mul_f32_dpp v33, v17, v33 row_newbcast:5 row_mask:0xa bank_mask:0xf
    v_mul_f32_dpp v34, v17, v34 row_newbcast:6 row_mask:0xa bank_mask:0xf
    v_mul_f32_dpp v35, v17, v35 row_newbcast:7 row_mask:0xa bank_mask:0xf
    v_cvt_pk_bf16_f32 v72, v28, v29
    v_cvt_pk_bf16_f32 v73, v30, v31
    v_cvt_pk_bf16_f32 v74, v32, v33
    v_cvt_pk_bf16_f32 v75, v34, v35
    s_waitcnt lgkmcnt(0)
    v_lshlrev_b32 v20, 16, v8
    v_and_b32 v21, 0xffff0000, v8
    v_lshlrev_b32 v22, 16, v9
    v_and_b32 v23, 0xffff0000, v9
    v_mul_f32_dpp v36, v18, v20 row_newbcast:8 row_mask:0xf bank_mask:0xf
    v_mul_f32_dpp v37, v18, v21 row_newbcast:9 row_mask:0xf bank_mask:0xf
    v_mul_f32_dpp v38, v18, v22 row_newbcast:10 row_mask:0xf bank_mask:0xf
    v_mul_f32_dpp v39, v18, v23 row_newbcast:11 row_mask:0xf bank_mask:0xf
    v_cvt_pk_bf16_f32 v84, v36, v37
    v_cvt_pk_bf16_f32 v85, v38, v39
    v_mul_f32_dpp v20, v18, v20 row_newbcast:0 row_mask:0xa bank_mask:0xf
    v_mul_f32_dpp v21, v18, v21 row_newbcast:1 row_mask:0xa bank_mask:0xf
    v_mul_f32_dpp v22, v18, v22 row_newbcast:2 row_mask:0xa bank_mask:0xf
    v_mul_f32_dpp v23, v18, v23 row_newbcast:3 row_mask:0xa bank_mask:0xf
    v_cvt_pk_bf16_f32 v80, v20, v21
    v_cvt_pk_bf16_f32 v81, v22, v23
    s_waitcnt vmcnt(4)
    v_mfma_f32_32x32x16_bf16 v[0:15], v[64:67], v[176:179], 0
    ds_read_b64_tr_b16 v[184:185], v246 offset:2048
    ds_read_b64_tr_b16 v[186:187], v246 offset:3072
    ds_read_b64_tr_b16 v[188:189], v247 offset:2048
    ds_read_b64_tr_b16 v[190:191], v247 offset:3072
    s_mov_b32 m0, s68
    v_mfma_f32_32x32x16_bf16 v[16:31], v[68:71], v[176:179], 0
    buffer_load_dwordx4 v222, s[4:7], s41 offen sc1 lds
    buffer_load_dwordx4 v223, s[72:75], s41 offen offset:1024 sc1 lds
    v_permlane32_swap_b32 v242, v236
    v_permlane32_swap_b32 v243, v237
    s_add_u32 s38, s38, 1
    v_mfma_f32_32x32x16_bf16 v[32:47], v[64:67], v[180:183], 0
    v_permlane32_swap_b32 v244, v238
    v_permlane32_swap_b32 v245, v239
    v_permlane32_swap_b32 v240, v241
    v_add_f32 v242, v242, v236
    v_mfma_f32_32x32x16_bf16 v[48:63], v[68:71], v[180:183], 0
    v_add_f32 v243, v243, v237
    v_add_f32 v244, v244, v238
    v_add_f32 v245, v245, v239
    v_add_f32 v240, -v240, -v241
    v_mov_b32 v254, s52
    v_mov_b32 v255, s38
    s_waitcnt vmcnt(4) lgkmcnt(0)
    v_mfma_f32_32x32x16_bf16 v[0:15], v[72:75], v[184:187], v[0:15]
    ds_read_b64_tr_b16 v[176:177], v246 offset:4096
    ds_read_b64_tr_b16 v[180:181], v247 offset:4096
    s_lshl_b32 s58, s38, 3
    s_add_u32 s58, s58, s20
    s_mov_b32 m0, s69
    v_mfma_f32_32x32x16_bf16 v[16:31], v[76:79], v[184:187], v[16:31]
    buffer_load_dwordx4 v226, s[4:7], s41 offen sc1 lds
    s_set_gpr_idx_on s32, gpr_idx(DST)
    s_nop 0
    v_cvt_pk_bf16_f32 v195, v242, v243
    v_cvt_pk_bf16_f32 v196, v244, v245
    v_cvt_pk_bf16_f32 v197, v240, v240
    s_set_gpr_idx_off
    s_mov_b64 exec, 1
    ds_write_b32 v254, v255
    s_mov_b64 exec, -1
    s_cmp_lt_u32 s58, s22
    s_cbranch_scc0 K2_dyn_25
K2_back_26:
    v_readlane_b32 s3, v253, s58
    s_lshl_b32 s44, s34, 7
    s_and_b32 s48, s3, 0x3ffff
    s_bfe_u32 s33, s3, 0x30013
    s_mul_i32 s35, s38, 6
    s_cmp_eq_u32 s34, 0
    s_cselect_b32 s35, s35, s48
    s_mov_b32 s45, s44
    s_xor_b32 s47, s44, 256
    s_add_u32 s49, s48, 128
    s_add_u32 s60, s48, 256
    s_cmp_eq_u32 s33, 3
    s_cselect_b32 s46, s44, s47
    s_cselect_b32 s50, s60, s48
    s_sub_u32 s60, s33, 2
    s_cmp_lt_u32 s60, 2
    s_cbranch_scc0 K2_rare_31
K2_back_32:
    v_mfma_f32_32x32x16_bf16 v[32:47], v[72:75], v[188:191], v[32:47]
    v_add_u32 v233, s48, v230
    ds_read_b32 v232, v233
    ds_read_b32 v233, v233 offset:1024
    v_mfma_f32_32x32x16_bf16 v[48:63], v[76:79], v[188:191], v[48:63]
    s_waitcnt vmcnt(3) lgkmcnt(3)
    v_mfma_f32_32x32x8_bf16 v[0:15], v[80:81], v[176:177], v[0:15]
    ds_read_b64_tr_b16 v[184:185], v246 offset:6144
    ds_read_b64_tr_b16 v[186:187], v246 offset:7168
    ds_read_b64_tr_b16 v[188:189], v247 offset:6144
    ds_read_b64_tr_b16 v[190:191], v247 offset:7168
    s_mov_b32 m0, s70
    v_mfma_f32_32x32x8_bf16 v[16:31], v[84:85], v[176:177], v[16:31]
    buffer_load_dwordx4 v222, s[4:7], s42 offen sc1 lds
    buffer_load_dwordx4 v223, s[72:75], s42 offen offset:1024 sc1 lds
    v_mfma_f32_32x32x8_bf16 v[32:47], v[80:81], v[180:181], v[32:47]
    s_nop 2
    v_mul_f32 v234, v0, v96
    v_mul_f32 v236, v8, v128
    v_fmac_f32 v234, v1, v97
    v_fmac_f32 v236, v9, v129
    v_fmac_f32 v234, v2, v98
    v_fmac_f32 v236, v10, v130
    v_fmac_f32 v234, v3, v99
    v_mfma_f32_32x32x8_bf16 v[48:63], v[84:85], v[180:181], v[48:63]
    s_setprio 0
    s_waitcnt lgkmcnt(4)
    v_or_b32 v232, v232, v231
    v_or_b32 v233, v233, v231
    s_cmp_lg_u32 s34, 0
    s_cbranch_scc1 K2_dum_36
    s_cmp_eq_u32 s33, 4
    s_cbranch_scc1 K2_a4_37
K2_b4_39:
    s_add_u32 m0, s48, 512
    s_add_u32 s65, s48, 1536
    buffer_load_dwordx4 v232, s[16:19], 0 offen  lds
    s_mov_b32 m0, s65
    s_mov_b32 exec_hi, 0
    buffer_load_dwordx4 v233, s[16:19], 0 offen  lds
    s_mov_b32 exec_hi, -1
K2_back_38:
    v_fmac_f32 v236, v11, v131
    v_fmac_f32 v234, v4, v100
    v_fmac_f32 v236, v12, v132
    v_fmac_f32 v234, v5, v101
    v_fmac_f32 v236, v13, v133
    v_fmac_f32 v234, v6, v102
    v_fmac_f32 v236, v14, v134
    v_fmac_f32 v234, v7, v103
    v_fmac_f32 v236, v15, v135
    v_mul_f32 v238, v16, v128
    v_mul_f32 v240, v24, v128
    v_fmac_f32 v238, v17, v129
    v_fmac_f32 v240, v25, v129
    v_fmac_f32 v238, v18, v130
    v_fmac_f32 v240, v26, v130
    v_fmac_f32 v238, v19, v131
    v_fmac_f32 v240, v27, v131
    v_fmac_f32 v238, v20, v132
    v_fmac_f32 v240, v28, v132
    v_fmac_f32 v238, v21, v133
    v_fmac_f32 v240, v29, v133
    v_fmac_f32 v238, v22, v134
    v_fmac_f32 v240, v30, v134
    v_fmac_f32 v238, v23, v135
    v_fmac_f32 v240, v31, v135
    v_mul_f32 v235, v32, v104
    v_mul_f32 v237, v40, v136
    v_fmac_f32 v235, v33, v105
    v_fmac_f32 v237, v41, v137
    v_fmac_f32 v235, v34, v106
    v_fmac_f32 v237, v42, v138
    v_fmac_f32 v235, v35, v107
    v_fmac_f32 v237, v43, v139
    v_fmac_f32 v235, v36, v108
    v_fmac_f32 v237, v44, v140
    v_fmac_f32 v235, v37, v109
    v_fmac_f32 v237, v45, v141
    v_fmac_f32 v235, v38, v110
    v_fmac_f32 v237, v46, v142
    v_fmac_f32 v235, v39, v111
    v_fmac_f32 v237, v47, v143
    v_mul_f32 v239, v48, v136
    v_mul_f32 v241, v56, v136
    s_setprio 1
    s_waitcnt vmcnt(5) lgkmcnt(0)
    v_mfma_f32_32x32x16_bf16 v[0:15], v[72:75], v[184:187], 0
    ds_read_b64_tr_b16 v[176:177], v246 offset:0
    ds_read_b64_tr_b16 v[178:179], v246 offset:1024
    ds_read_b64_tr_b16 v[180:181], v247 offset:0
    ds_read_b64_tr_b16 v[182:183], v247 offset:1024
    v_fmac_f32 v239, v49, v137
    v_fmac_f32 v241, v57, v137
    s_mov_b32 m0, s71
    v_mfma_f32_32x32x16_bf16 v[16:31], v[76:79], v[184:187], 0
    buffer_load_dwordx4 v224, s[4:7], s42 offen sc1 lds
    buffer_load_dwordx4 v225, s[72:75], s42 offen offset:1024 sc1 lds
    v_fmac_f32 v239, v50, v138
    v_fmac_f32 v241, v58, v138
    v_fmac_f32 v239, v51, v139
    v_fmac_f32 v241, v59, v139
    v_fmac_f32 v239, v52, v140
    v_mfma_f32_32x32x16_bf16 v[32:47], v[72:75], v[188:191], 0
    v_fmac_f32 v241, v60, v140
    v_fmac_f32 v239, v53, v141
    v_fmac_f32 v241, v61, v141
    v_fmac_f32 v239, v54, v142
    v_fmac_f32 v241, v62, v142
    v_fmac_f32 v239, v55, v143
    v_fmac_f32 v241, v63, v143
    v_mfma_f32_32x32x16_bf16 v[48:63], v[76:79], v[188:191], 0
    v_permlane32_swap_b32 v234, v236
    v_permlane32_swap_b32 v235, v237
    v_permlane32_swap_b32 v240, v238
    s_waitcnt vmcnt(6) lgkmcnt(0)
    v_mfma_f32_32x32x16_bf16 v[0:15], v[64:67], v[176:179], v[0:15]
    ds_read_b64_tr_b16 v[184:185], v246 offset:2048
    ds_read_b64_tr_b16 v[188:189], v247 offset:2048
    v_permlane32_swap_b32 v241, v239
    v_add_f32 v234, v234, v236
    v_add_f32 v235, v235, v237
    s_mov_b32 m0, s68
    v_mfma_f32_32x32x16_bf16 v[16:31], v[68:71], v[176:179], v[16:31]
    buffer_load_dwordx4 v226, s[4:7], s42 offen sc1 lds
    v_add_f32 v240, v240, v238
    v_add_f32 v241, v241, v239
    s_set_gpr_idx_on s31, gpr_idx(DST)
    s_nop 0
    v_cvt_pk_bf16_f32 v192, v234, v235
    v_cvt_pk_bf16_f32 v193, v240, v241
    s_set_gpr_idx_off
    v_mfma_f32_32x32x16_bf16 v[32:47], v[64:67], v[180:183], v[32:47]
    v_mfma_f32_32x32x16_bf16 v[48:63], v[68:71], v[180:183], v[48:63]
    s_waitcnt vmcnt(5) lgkmcnt(0)
    v_mfma_f32_32x32x8_bf16 v[0:15], v[80:81], v[184:185], v[0:15]
    ds_read_b64_tr_b16 v[176:177], v246 offset:4096
    ds_read_b64_tr_b16 v[178:179], v246 offset:5120
    ds_read_b64_tr_b16 v[180:181], v247 offset:4096
    ds_read_b64_tr_b16 v[182:183], v247 offset:5120
    s_mov_b32 m0, s69
    v_mfma_f32_32x32x8_bf16 v[16:31], v[84:85], v[184:185], v[16:31]
    buffer_load_dwordx4 v222, s[4:7], s43 offen sc1 lds
    buffer_load_dwordx4 v223, s[72:75], s43 offen offset:1024 sc1 lds
    v_mfma_f32_32x32x8_bf16 v[32:47], v[80:81], v[188:189], v[32:47]
    s_nop 2
    v_mul_f32 v234, v0, v144
    v_mul_f32 v236, v8, v112
    v_fmac_f32 v234, v1, v145
    v_fmac_f32 v236, v9, v113
    v_fmac_f32 v234, v2, v146
    v_fmac_f32 v236, v10, v114
    v_fmac_f32 v234, v3, v147
    v_mfma_f32_32x32x8_bf16 v[48:63], v[84:85], v[188:189], v[48:63]
    s_setprio 0
    v_fmac_f32 v236, v11, v115
    v_fmac_f32 v234, v4, v148
    v_fmac_f32 v236, v12, v116
    v_fmac_f32 v234, v5, v149
    v_fmac_f32 v236, v13, v117
    v_fmac_f32 v234, v6, v150
    v_fmac_f32 v236, v14, v118
    v_fmac_f32 v234, v7, v151
    v_fmac_f32 v236, v15, v119
    v_mul_f32 v238, v16, v160
    v_mul_f32 v240, v24, v160
    v_fmac_f32 v238, v17, v161
    v_fmac_f32 v240, v25, v161
    v_fmac_f32 v238, v18, v162
    v_fmac_f32 v240, v26, v162
    v_fmac_f32 v238, v19, v163
    v_fmac_f32 v240, v27, v163
    v_fmac_f32 v238, v20, v164
    v_fmac_f32 v240, v28, v164
    v_fmac_f32 v238, v21, v165
    v_fmac_f32 v240, v29, v165
    v_fmac_f32 v238, v22, v166
    v_fmac_f32 v240, v30, v166
    v_fmac_f32 v238, v23, v167
    v_fmac_f32 v240, v31, v167
    v_mul_f32 v235, v32, v152
    v_mul_f32 v237, v40, v120
    v_fmac_f32 v235, v33, v153
    v_fmac_f32 v237, v41, v121
    v_fmac_f32 v235, v34, v154
    v_fmac_f32 v237, v42, v122
    v_fmac_f32 v235, v35, v155
    v_fmac_f32 v237, v43, v123
    v_fmac_f32 v235, v36, v156
    v_fmac_f32 v237, v44, v124
    v_fmac_f32 v235, v37, v157
    v_fmac_f32 v237, v45, v125
    v_fmac_f32 v235, v38, v158
    v_fmac_f32 v237, v46, v126
    v_fmac_f32 v235, v39, v159
    v_fmac_f32 v237, v47, v127
    v_mul_f32 v239, v48, v168
    v_mul_f32 v241, v56, v168
    v_fmac_f32 v239, v49, v169
    v_fmac_f32 v241, v57, v169
    s_setprio 1
    s_waitcnt vmcnt(3) lgkmcnt(0)
    v_mfma_f32_32x32x16_bf16 v[0:15], v[64:67], v[176:179], 0
    ds_read_b64_tr_b16 v[184:185], v246 offset:6144
    ds_read_b64_tr_b16 v[186:187], v246 offset:7168
    ds_read_b64_tr_b16 v[188:189], v247 offset:6144
    ds_read_b64_tr_b16 v[190:191], v247 offset:7168
    v_fmac_f32 v239, v50, v170
    v_fmac_f32 v241, v58, v170
    s_mov_b32 m0, s70
    v_mfma_f32_32x32x16_bf16 v[16:31], v[68:71], v[176:179], 0
    buffer_load_dwordx4 v224, s[4:7], s43 offen sc1 lds
    buffer_load_dwordx4 v225, s[72:75], s43 offen offset:1024 sc1 lds
    v_fmac_f32 v239, v51, v171
    v_fmac_f32 v241, v59, v171
    v_fmac_f32 v239, v52, v172
    v_fmac_f32 v241, v60, v172
    v_fmac_f32 v239, v53, v173
    v_mfma_f32_32x32x16_bf16 v[32:47], v[64:67], v[180:183], 0
    v_add_u32 v222, s48, v251
    ds_read2_b32 v[222:223], v222 offset0:1 offset1:3
    v_fmac_f32 v241, v61, v173
    v_fmac_f32 v239, v54, v174
    v_fmac_f32 v241, v62, v174
    v_fmac_f32 v239, v55, v175
    v_fmac_f32 v241, v63, v175
    v_mfma_f32_32x32x16_bf16 v[48:63], v[68:71], v[180:183], 0
    s_waitcnt vmcnt(4) lgkmcnt(1)
    v_mfma_f32_32x32x16_bf16 v[0:15], v[72:75], v[184:187], v[0:15]
    ds_read_b64_tr_b16 v[176:177], v246 offset:0
    ds_read_b64_tr_b16 v[180:181], v247 offset:0
    s_mov_b32 m0, s71
    v_mfma_f32_32x32x16_bf16 v[16:31], v[76:79], v[184:187], v[16:31]
    buffer_load_dwordx4 v226, s[4:7], s43 offen sc1 lds
    s_waitcnt lgkmcnt(2)
    v_mad_u32_u16 v222, v222, s39, v248 op_sel:[1,0,0,0]
    v_mad_u32_u16 v223, v223, s39, v248 op_sel:[1,0,0,0]
    v_mfma_f32_32x32x16_bf16 v[32:47], v[72:75], v[188:191], v[32:47]
    v_add_u32 v224, s49, v251
    ds_read2_b32 v[224:225], v224 offset0:1 offset1:3
    v_mfma_f32_32x32x16_bf16 v[48:63], v[76:79], v[188:191], v[48:63]
    s_waitcnt vmcnt(3) lgkmcnt(1)
    v_mfma_f32_32x32x8_bf16 v[0:15], v[80:81], v[176:177], v[0:15]
    ds_read_b64_tr_b16 v[184:185], v246 offset:2048
    ds_read_b64_tr_b16 v[186:187], v246 offset:3072
    ds_read_b64_tr_b16 v[188:189], v247 offset:2048
    ds_read_b64_tr_b16 v[190:191], v247 offset:3072
    s_mov_b32 m0, s68
    v_mfma_f32_32x32x8_bf16 v[16:31], v[84:85], v[176:177], v[16:31]
    buffer_load_dwordx4 v222, s[4:7], s44 offen sc1 lds
    buffer_load_dwordx4 v223, s[72:75], s44 offen offset:1024 sc1 lds
    s_waitcnt lgkmcnt(4)
    v_mad_u32_u16 v224, v224, s39, v248 op_sel:[1,0,0,0]
    v_mad_u32_u16 v225, v225, s39, v248 op_sel:[1,0,0,0]
    v_mfma_f32_32x32x8_bf16 v[32:47], v[80:81], v[180:181], v[32:47]
    v_add_u32 v226, s50, v251
    ds_read2_b32 v[226:227], v226 offset0:1 offset1:3
    v_mul_f32 v242, v0, v144
    v_fma_f32 v238, v8, v160, -v238
    v_fmac_f32 v242, v1, v145
    v_fmac_f32 v238, v9, v161
    v_fmac_f32 v242, v2, v146
    v_mfma_f32_32x32x8_bf16 v[48:63], v[84:85], v[180:181], v[48:63]
    s_setprio 0
    v_fmac_f32 v238, v10, v162
    v_fmac_f32 v242, v3, v147
    v_fmac_f32 v238, v11, v163
    v_fmac_f32 v242, v4, v148
    v_fmac_f32 v238, v12, v164
    v_fmac_f32 v242, v5, v149
    v_fmac_f32 v238, v13, v165
    v_fmac_f32 v242, v6, v150
    v_fmac_f32 v238, v14, v166
    v_fmac_f32 v242, v7, v151
    v_fmac_f32 v238, v15, v167
    v_fmac_f32 v236, v16, v112
    v_mul_f32 v244, v24, v160
    v_fmac_f32 v236, v17, v113
    v_fmac_f32 v244, v25, v161
    v_fmac_f32 v236, v18, v114
    v_fmac_f32 v244, v26, v162
    v_fmac_f32 v236, v19, v115
    v_fmac_f32 v244, v27, v163
    v_fmac_f32 v236, v20, v116
    v_fmac_f32 v244, v28, v164
    v_fmac_f32 v236, v21, v117
    v_fmac_f32 v244, v29, v165
    v_fmac_f32 v236, v22, v118
    v_fmac_f32 v244, v30, v166
    v_fmac_f32 v236, v23, v119
    v_fmac_f32 v244, v31, v167
    v_mul_f32 v243, v32, v152
    v_fma_f32 v239, v40, v168, -v239
    v_fmac_f32 v243, v33, v153
    v_fmac_f32 v239, v41, v169
    v_fmac_f32 v243, v34, v154
    v_fmac_f32 v239, v42, v170
    v_fmac_f32 v243, v35, v155
    v_fmac_f32 v239, v43, v171
    v_fmac_f32 v243, v36, v156
    v_fmac_f32 v239, v44, v172
    v_fmac_f32 v243, v37, v157
    v_fmac_f32 v239, v45, v173
    v_fmac_f32 v243, v38, v158
    v_fmac_f32 v239, v46, v174
    v_fmac_f32 v243, v39, v159
    v_fmac_f32 v239, v47, v175
    v_fmac_f32 v237, v48, v120
    v_mul_f32 v245, v56, v168
    v_fmac_f32 v237, v49, v121
    v_fmac_f32 v245, v57, v169
    v_fmac_f32 v237, v50, v122
    s_setprio 1
    s_waitcnt vmcnt(3) lgkmcnt(1)
    v_mfma_f32_32x32x16_bf16 v[0:15], v[64:67], v[184:187], 0
    ds_read_b64_tr_b16 v[176:177], v246 offset:4096
    ds_read_b64_tr_b16 v[178:179], v246 offset:5120
    ds_read_b64_tr_b16 v[180:181], v247 offset:4096
    ds_read_b64_tr_b16 v[182:183], v247 offset:5120
    v_fmac_f32 v245, v58, v170
    v_fmac_f32 v237, v51, v123
    s_mov_b32 m0, s69
    v_mfma_f32_32x32x16_bf16 v[16:31], v[68:71], v[184:187], 0
    buffer_load_dwordx4 v224, s[4:7], s45 offen sc1 lds
    buffer_load_dwordx4 v225, s[72:75], s45 offen offset:1024 sc1 lds
    s_waitcnt lgkmcnt(4)
    v_mad_u32_u16 v226, v226, s39, v248 op_sel:[1,0,0,0]
    v_mad_u32_u16 v227, v227, s39, v248 op_sel:[1,0,0,0]
    v_fmac_f32 v245, v59, v171
    v_fmac_f32 v237, v52, v124
    v_mfma_f32_32x32x16_bf16 v[32:47], v[64:67], v[188:191], 0
    v_fmac_f32 v245, v60, v172
    v_fmac_f32 v237, v53, v125
    v_fmac_f32 v245, v61, v173
    v_fmac_f32 v237, v54, v126
    v_fmac_f32 v245, v62, v174
    v_fmac_f32 v237, v55, v127
    v_fmac_f32 v245, v63, v175
    v_mfma_f32_32x32x16_bf16 v[48:63], v[68:71], v[188:191], 0
    v_permlane32_swap_b32 v242, v234
    v_permlane32_swap_b32 v243, v235
    v_add_f32 v242, v242, v234
    v_add_f32 v243, v243, v235
    s_waitcnt vmcnt(4) lgkmcnt(0)
    v_mfma_f32_32x32x16_bf16 v[0:15], v[72:75], v[176:179], v[0:15]
    ds_read_b64_tr_b16 v[184:185], v246 offset:6144
    ds_read_b64_tr_b16 v[188:189], v247 offset:6144
    s_set_gpr_idx_on s31, gpr_idx(DST)
    s_nop 0
    v_cvt_pk_bf16_f32 v194, v242, v243
    s_set_gpr_idx_off
    s_mov_b32 s32, s31
    s_mov_b32 m0, s70
    v_mfma_f32_32x32x16_bf16 v[16:31], v[76:79], v[176:179], v[16:31]
    buffer_load_dwordx4 v226, s[4:7], s46 offen sc1 lds
    buffer_load_dwordx4 v227, s[72:75], s46 offen offset:1024 sc1 lds
    s_sub_u32 s26, s48, s29
    s_mov_b32 s29, s48
    s_mov_b32 s30, s3
    s_bfe_u32 s56, s3, 0x40012
    s_mov_b32 s31, s35
    v_mfma_f32_32x32x16_bf16 v[32:47], v[72:75], v[180:183], v[32:47]
    s_cmp_eq_u32 s34, 0
    s_cselect_b32 s56, s56, 0
    v_mfma_f32_32x32x16_bf16 v[48:63], v[76:79], v[180:183], v[48:63]
    s_waitcnt vmcnt(4) lgkmcnt(0)
    v_mfma_f32_32x32x8_bf16 v[0:15], v[80:81], v[184:185], v[0:15]
    ds_read_b64_tr_b16 v[176:177], v246 offset:0
    ds_read_b64_tr_b16 v[178:179], v246 offset:1024
    ds_read_b64_tr_b16 v[180:181], v247 offset:0
    ds_read_b64_tr_b16 v[182:183], v247 offset:1024
    s_mov_b32 m0, s71
    v_mfma_f32_32x32x8_bf16 v[16:31], v[84:85], v[184:185], v[16:31]
    s_cmp_eq_u32 s33, 4
    s_cbranch_scc1 K2_g4_34
    buffer_load_dwordx4 v224, s[4:7], s47 offen sc1 lds
    buffer_load_dwordx4 v225, s[72:75], s47 offen offset:1024 sc1 lds
K2_back_35:
    v_mfma_f32_32x32x8_bf16 v[32:47], v[80:81], v[188:189], v[32:47]
    s_nop 0
    v_mul_f32 v242, v0, v144
    v_fma_f32 v240, v8, v160, -v240
    v_fmac_f32 v242, v1, v145
    v_fmac_f32 v240, v9, v161
    v_fmac_f32 v242, v2, v146
    v_fmac_f32 v240, v10, v162
    v_fmac_f32 v242, v3, v147
    v_mfma_f32_32x32x8_bf16 v[48:63], v[84:85], v[188:189], v[48:63]
    s_setprio 0
    v_fmac_f32 v240, v11, v163
    v_fmac_f32 v242, v4, v148
    v_fmac_f32 v240, v12, v164
    v_fmac_f32 v242, v5, v149
    v_fmac_f32 v240, v13, v165
    v_fmac_f32 v242, v6, v150
    v_fmac_f32 v240, v14, v166
    v_fmac_f32 v242, v7, v151
    v_fmac_f32 v240, v15, v167
    v_add_u32 v249, s26, v249
    v_add_u32 v250, s26, v250
    v_fma_f32 v244, v16, v160, -v244
    v_fmac_f32 v236, v24, v112
    v_fmac_f32 v244, v17, v161
    v_fmac_f32 v236, v25, v113
    v_fmac_f32 v244, v18, v162
    v_fmac_f32 v236, v26, v114
    v_fmac_f32 v244, v19, v163
    v_fmac_f32 v236, v27, v115
    v_fmac_f32 v244, v20, v164
    v_fmac_f32 v236, v28, v116
    v_fmac_f32 v244, v21, v165
    v_fmac_f32 v236, v29, v117
    v_fmac_f32 v244, v22, v166
    v_fmac_f32 v236, v30, v118
    v_fmac_f32 v244, v23, v167
    v_fmac_f32 v236, v31, v119
    ds_read_b64_tr_b16 v[0:1], v249 offset:0
    ds_read_b64_tr_b16 v[2:3], v249 offset:32
    ds_read_u16_d16_hi v16, v250 offset:0
    v_mul_f32 v243, v32, v152
    v_fma_f32 v241, v40, v168, -v241
    v_fmac_f32 v243, v33, v153
    v_fmac_f32 v241, v41, v169
    v_fmac_f32 v243, v34, v154
    v_fmac_f32 v241, v42, v170
    v_fmac_f32 v243, v35, v155
    v_fmac_f32 v241, v43, v171
    v_fmac_f32 v243, v36, v156
    v_fmac_f32 v241, v44, v172
    v_fmac_f32 v243, v37, v157
    v_fmac_f32 v241, v45, v173
    v_fmac_f32 v243, v38, v158
    v_fmac_f32 v241, v46, v174
    v_fmac_f32 v243, v39, v159
    v_fmac_f32 v241, v47, v175
    ds_read_b64_tr_b16 v[4:5], v249 offset:512
    ds_read_b64_tr_b16 v[6:7], v249 offset:544
    ds_read_u16_d16_hi v17, v250 offset:128
    v_fma_f32 v245, v48, v168, -v245
    v_fmac_f32 v237, v56, v120
    v_fmac_f32 v245, v49, v169
    v_fmac_f32 v237, v57, v121
    v_fmac_f32 v245, v50, v170
    v_fmac_f32 v237, v58, v122
    v_fmac_f32 v245, v51, v171
    v_fmac_f32 v237, v59, v123
    v_fmac_f32 v245, v52, v172
    v_fmac_f32 v237, v60, v124
    v_fmac_f32 v245, v53, v173
    v_fmac_f32 v237, v61, v125
    v_fmac_f32 v245, v54, v174
    v_fmac_f32 v237, v62, v126
    v_fmac_f32 v245, v55, v175
    v_fmac_f32 v237, v63, v127
    s_cmp_eq_u32 s56, 5
    s_cbranch_scc1 K2_U20
    s_cmp_eq_u32 s56, 6
    s_cbranch_scc1 K2_U3h0
    s_branch K2_DSP0
K2_U30:
    s_setprio 1
    ds_read_b64_tr_b16 v[8:9], v249 offset:1024
    ds_read_b64_tr_b16 v[10:11], v249 offset:1056
    ds_read_u16_d16_hi v18, v250 offset:256
    s_waitcnt lgkmcnt(3)
    v_lshlrev_b32 v20, 16, v0
    v_and_b32 v21, 0xffff0000, v0
    v_lshlrev_b32 v22, 16, v1
    v_and_b32 v23, 0xffff0000, v1
    v_lshlrev_b32 v24, 16, v2
    v_and_b32 v25, 0xffff0000, v2
    v_lshlrev_b32 v26, 16, v3
    v_and_b32 v27, 0xffff0000, v3
    v_mul_f32_dpp v36, v16, v20 row_newbcast:8 row_mask:0xf bank_mask:0xf
    v_mul_f32_dpp v37, v16, v21 row_newbcast:9 row_mask:0xf bank_mask:0xf
    v_mul_f32_dpp v38, v16, v22 row_newbcast:10 row_mask:0xf bank_mask:0xf
    v_mul_f32_dpp v39, v16, v23 row_newbcast:11 row_mask:0xf bank_mask:0xf
    v_mul_f32_dpp v40, v16, v24 row_newbcast:12 row_mask:0xf bank_mask:0xf
    v_mul_f32_dpp v41, v16, v25 row_newbcast:13 row_mask:0xf bank_mask:0xf
    v_mul_f32_dpp v42, v16, v26 row_newbcast:14 row_mask:0xf bank_mask:0xf
    v_mul_f32_dpp v43, v16, v27 row_newbcast:15 row_mask:0xf bank_mask:0xf
    v_cvt_pk_bf16_f32 v68, v36, v37
    v_cvt_pk_bf16_f32 v69, v38, v39
    v_cvt_pk_bf16_f32 v70, v40, v41
    v_cvt_pk_bf16_f32 v71, v42, v43
    v_mul_f32_dpp v20, v16, v20 row_newbcast:0 row_mask:0xa bank_mask:0xf
    v_mul_f32_dpp v21, v16, v21 row_newbcast:1 row_mask:0xa bank_mask:0xf
    v_mul_f32_dpp v22, v16, v22 row_newbcast:2 row_mask:0xa bank_mask:0xf
    v_mul_f32_dpp v23, v16, v23 row_newbcast:3 row_mask:0xa bank_mask:0xf
    v_mul_f32_dpp v24, v16, v24 row_newbcast:4 row_mask:0xa bank_mask:0xf
    v_mul_f32_dpp v25, v16, v25 row_newbcast:5 row_mask:0xa bank_mask:0xf
    v_mul_f32_dpp v26, v16, v26 row_newbcast:6 row_mask:0xa bank_mask:0xf
    v_mul_f32_dpp v27, v16, v27 row_newbcast:7 row_mask:0xa bank_mask:0xf
    v_cvt_pk_bf16_f32 v64, v20, v21
    v_cvt_pk_bf16_f32 v65, v22, v23
    v_cvt_pk_bf16_f32 v66, v24, v25
    v_cvt_pk_bf16_f32 v67, v26, v27
    v_lshlrev_b32 v28, 16, v4
    v_and_b32 v29, 0xffff0000, v4
    v_lshlrev_b32 v30, 16, v5
    v_and_b32 v31, 0xffff0000, v5
    v_lshlrev_b32 v32, 16, v6
    v_and_b32 v33, 0xffff0000, v6
    v_lshlrev_b32 v34, 16, v7
    v_and_b32 v35, 0xffff0000, v7
    v_mul_f32_dpp v36, v17, v28 row_newbcast:8 row_mask:0xf bank_mask:0xf
    v_mul_f32_dpp v37, v17, v29 row_newbcast:9 row_mask:0xf bank_mask:0xf
    v_mul_f32_dpp v38, v17, v30 row_newbcast:10 row_mask:0xf bank_mask:0xf
    v_mul_f32_dpp v39, v17, v31 row_newbcast:11 row_mask:0xf bank_mask:0xf
    v_mul_f32_dpp v40, v17, v32 row_newbcast:12 row_mask:0xf bank_mask:0xf
    v_mul_f32_dpp v41, v17, v33 row_newbcast:13 row_mask:0xf bank_mask:0xf
    v_mul_f32_dpp v42, v17, v34 row_newbcast:14 row_mask:0xf bank_mask:0xf
    v_mul_f32_dpp v43, v17, v35 row_newbcast:15 row_mask:0xf bank_mask:0xf
    v_cvt_pk_bf16_f32 v76, v36, v37
    v_cvt_pk_bf16_f32 v77, v38, v39
    v_cvt_pk_bf16_f32 v78, v40, v41
    v_cvt_pk_bf16_f32 v79, v42, v43
    v_mul_f32_dpp v28, v17, v28 row_newbcast:0 row_mask:0xa bank_mask:0xf
    v_mul_f32_dpp v29, v17, v29 row_newbcast:1 row_mask:0xa bank_mask:0xf
    v_mul_f32_dpp v30, v17, v30 row_newbcast:2 row_mask:0xa bank_mask:0xf
    v_mul_f32_dpp v31, v17, v31 row_newbcast:3 row_mask:0xa bank_mask:0xf
    v_mul_f32_dpp v32, v17, v32 row_newbcast:4 row_mask:0xa bank_mask:0xf
    v_mul_f32_dpp v33, v17, v33 row_newbcast:5 row_mask:0xa bank_mask:0xf
    v_mul_f32_dpp v34, v17, v34 row_newbcast:6 row_mask:0xa bank_mask:0xf
    v_mul_f32_dpp v35, v17, v35 row_newbcast:7 row_mask:0xa bank_mask:0xf
    v_cvt_pk_bf16_f32 v72, v28, v29
    v_cvt_pk_bf16_f32 v73, v30, v31
    v_cvt_pk_bf16_f32 v74, v32, v33
    v_cvt_pk_bf16_f32 v75, v34, v35
    s_waitcnt lgkmcnt(0)
    v_lshlrev_b32 v20, 16, v8
    v_and_b32 v21, 0xffff0000, v8
    v_lshlrev_b32 v22, 16, v9
    v_and_b32 v23, 0xffff0000, v9
    v_lshlrev_b32 v24, 16, v10
    v_and_b32 v25, 0xffff0000, v10
    v_lshlrev_b32 v26, 16, v11
    v_and_b32 v27, 0xffff0000, v11
    v_mul_f32_dpp v36, v18, v20 row_newbcast:8 row_mask:0xf bank_mask:0xf
    v_mul_f32_dpp v37, v18, v21 row_newbcast:9 row_mask:0xf bank_mask:0xf
    v_mul_f32_dpp v38, v18, v22 row_newbcast:10 row_mask:0xf bank_mask:0xf
    v_mul_f32_dpp v39, v18, v23 row_newbcast:11 row_mask:0xf bank_mask:0xf
    v_mul_f32_dpp v40, v18, v24 row_newbcast:12 row_mask:0xf bank_mask:0xf
    v_mul_f32_dpp v41, v18, v25 row_newbcast:13 row_mask:0xf bank_mask:0xf
    v_mul_f32_dpp v42, v18, v26 row_newbcast:14 row_mask:0xf bank_mask:0xf
    v_mul_f32_dpp v43, v18, v27 row_newbcast:15 row_mask:0xf bank_mask:0xf
    v_cvt_pk_bf16_f32 v84, v36, v37
    v_cvt_pk_bf16_f32 v85, v38, v39
    v_cvt_pk_bf16_f32 v86, v40, v41
    v_cvt_pk_bf16_f32 v87, v42, v43
    v_mul_f32_dpp v20, v18, v20 row_newbcast:0 row_mask:0xa bank_mask:0xf
    v_mul_f32_dpp v21, v18, v21 row_newbcast:1 row_mask:0xa bank_mask:0xf
    v_mul_f32_dpp v22, v18, v22 row_newbcast:2 row_mask:0xa bank_mask:0xf
    v_mul_f32_dpp v23, v18, v23 row_newbcast:3 row_mask:0xa bank_mask:0xf
    v_mul_f32_dpp v24, v18, v24 row_newbcast:4 row_mask:0xa bank_mask:0xf
    v_mul_f32_dpp v25, v18, v25 row_newbcast:5 row_mask:0xa bank_mask:0xf
    v_mul_f32_dpp v26, v18, v26 row_newbcast:6 row_mask:0xa bank_mask:0xf
    v_mul_f32_dpp v27, v18, v27 row_newbcast:7 row_mask:0xa bank_mask:0xf
    v_cvt_pk_bf16_f32 v80, v20, v21
    v_cvt_pk_bf16_f32 v81, v22, v23
    v_cvt_pk_bf16_f32 v82, v24, v25
    v_cvt_pk_bf16_f32 v83, v26, v27
    s_waitcnt vmcnt(4)
    v_mfma_f32_32x32x16_bf16 v[0:15], v[64:67], v[176:179], 0
    ds_read_b64_tr_b16 v[184:185], v246 offset:2048
    ds_read_b64_tr_b16 v[186:187], v246 offset:3072
    ds_read_b64_tr_b16 v[188:189], v247 offset:2048
    ds_read_b64_tr_b16 v[190:191], v247 offset:3072
    s_mov_b32 m0, s68
    v_mfma_f32_32x32x16_bf16 v[16:31], v[68:71], v[176:179], 0
    buffer_load_dwordx4 v222, s[4:7], s41 offen sc1 lds
    buffer_load_dwordx4 v223, s[72:75], s41 offen offset:1024 sc1 lds
    v_permlane32_swap_b32 v242, v236
    v_permlane32_swap_b32 v243, v237
    s_add_u32 s38, s38, 1
    v_mfma_f32_32x32x16_bf16 v[32:47], v[64:67], v[180:183], 0
    v_permlane32_swap_b32 v244, v238
    v_permlane32_swap_b32 v245, v239
    v_permlane32_swap_b32 v240, v241
    v_add_f32 v242, v242, v236
    v_mfma_f32_32x32x16_bf16 v[48:63], v[68:71], v[180:183], 0
    v_add_f32 v243, v243, v237
    v_add_f32 v244, v244, v238
    v_add_f32 v245, v245, v239
    v_add_f32 v240, -v240, -v241
    v_mov_b32 v254, s52
    v_mov_b32 v255, s38
    s_waitcnt vmcnt(4) lgkmcnt(0)
    v_mfma_f32_32x32x16_bf16 v[0:15], v[72:75], v[184:187], v[0:15]
    ds_read_b64_tr_b16 v[176:177], v246 offset:4096
    ds_read_b64_tr_b16 v[178:179], v246 offset:5120
    ds_read_b64_tr_b16 v[180:181], v247 offset:4096
    ds_read_b64_tr_b16 v[182:183], v247 offset:5120
    s_lshl_b32 s58, s38, 3
    s_add_u32 s58, s58, s20
    s_mov_b32 m0, s69
    v_mfma_f32_32x32x16_bf16 v[16:31], v[76:79], v[184:187], v[16:31]
    buffer_load_dwordx4 v226, s[4:7], s41 offen sc1 lds
    buffer_load_dwordx4 v227, s[72:75], s41 offen offset:1024 sc1 lds
    s_set_gpr_idx_on s32, gpr_idx(DST)
    s_nop 0
    v_cvt_pk_bf16_f32 v195, v242, v243
    v_cvt_pk_bf16_f32 v196, v244, v245
    v_cvt_pk_bf16_f32 v197, v240, v240
    s_set_gpr_idx_off
    s_mov_b64 exec, 1
    ds_write_b32 v254, v255
    s_mov_b64 exec, -1
    s_cmp_lt_u32 s58, s22
    s_cbranch_scc0 K2_dyn_40
K2_back_41:
    v_readlane_b32 s3, v253, s58
    s_lshl_b32 s44, s34, 7
    s_and_b32 s48, s3, 0x3ffff
    s_bfe_u32 s33, s3, 0x30013
    s_mul_i32 s35, s38, 6
    s_cmp_eq_u32 s34, 0
    s_cselect_b32 s35, s35, s48
    s_mov_b32 s45, s44
    s_xor_b32 s47, s44, 256
    s_add_u32 s49, s48, 128
    s_add_u32 s60, s48, 256
    s_cmp_eq_u32 s33, 3
    s_cselect_b32 s46, s44, s47
    s_cselect_b32 s50, s60, s48
    s_sub_u32 s60, s33, 2
    s_cmp_lt_u32 s60, 2
    s_cbranch_scc0 K2_rare_46
K2_back_47:
    v_mfma_f32_32x32x16_bf16 v[32:47], v[72:75], v[188:191], v[32:47]
    v_add_u32 v233, s48, v230
    ds_read_b32 v232, v233
    ds_read_b32 v233, v233 offset:1024
    v_mfma_f32_32x32x16_bf16 v[48:63], v[76:79], v[188:191], v[48:63]
    s_waitcnt vmcnt(4) lgkmcnt(3)
    v_mfma_f32_32x32x16_bf16 v[0:15], v[80:83], v[176:179], v[0:15]
    ds_read_b64_tr_b16 v[184:185], v246 offset:6144
    ds_read_b64_tr_b16 v[186:187], v246 offset:7168
    ds_read_b64_tr_b16 v[188:189], v247 offset:6144
    ds_read_b64_tr_b16 v[190:191], v247 offset:7168
    s_mov_b32 m0, s70
    v_mfma_f32_32x32x16_bf16 v[16:31], v[84:87], v[176:179], v[16:31]
    buffer_load_dwordx4 v222, s[4:7], s42 offen sc1 lds
    buffer_load_dwordx4 v223, s[72:75], s42 offen offset:1024 sc1 lds
    v_mfma_f32_32x32x16_bf16 v[32:47], v[80:83], v[180:183], v[32:47]
    s_nop 2
    v_mul_f32 v234, v0, v96
    v_mul_f32 v236, v8, v128
    v_fmac_f32 v234, v1, v97
    v_fmac_f32 v236, v9, v129
    v_fmac_f32 v234, v2, v98
    v_fmac_f32 v236, v10, v130
    v_fmac_f32 v234, v3, v99
    v_mfma_f32_32x32x16_bf16 v[48:63], v[84:87], v[180:183], v[48:63]
    s_setprio 0
    s_waitcnt lgkmcnt(4)
    v_or_b32 v232, v232, v231
    v_or_b32 v233, v233, v231
    s_cmp_lg_u32 s34, 0
    s_cbranch_scc1 K2_dum_51
    s_cmp_eq_u32 s33, 4
    s_cbranch_scc1 K2_a4_52
K2_b4_54:
    s_add_u32 m0, s48, 512
    s_add_u32 s65, s48, 1536
    buffer_load_dwordx4 v232, s[16:19], 0 offen  lds
    s_mov_b32 m0, s65
    s_mov_b32 exec_hi, 0
    buffer_load_dwordx4 v233, s[16:19], 0 offen  lds
    s_mov_b32 exec_hi, -1
K2_back_53:
    v_fmac_f32 v236, v11, v131
    v_fmac_f32 v234, v4, v100
    v_fmac_f32 v236, v12, v132
    v_fmac_f32 v234, v5, v101
    v_fmac_f32 v236, v13, v133
    v_fmac_f32 v234, v6, v102
    v_fmac_f32 v236, v14, v134
    v_fmac_f32 v234, v7, v103
    v_fmac_f32 v236, v15, v135
    v_mul_f32 v238, v16, v128
    v_mul_f32 v240, v24, v128
    v_fmac_f32 v238, v17, v129
    v_fmac_f32 v240, v25, v129
    v_fmac_f32 v238, v18, v130
    v_fmac_f32 v240, v26, v130
    v_fmac_f32 v238, v19, v131
    v_fmac_f32 v240, v27, v131
    v_fmac_f32 v238, v20, v132
    v_fmac_f32 v240, v28, v132
    v_fmac_f32 v238, v21, v133
    v_fmac_f32 v240, v29, v133
    v_fmac_f32 v238, v22, v134
    v_fmac_f32 v240, v30, v134
    v_fmac_f32 v238, v23, v135
    v_fmac_f32 v240, v31, v135
    v_mul_f32 v235, v32, v104
    v_mul_f32 v237, v40, v136
    v_fmac_f32 v235, v33, v105
    v_fmac_f32 v237, v41, v137
    v_fmac_f32 v235, v34, v106
    v_fmac_f32 v237, v42, v138
    v_fmac_f32 v235, v35, v107
    v_fmac_f32 v237, v43, v139
    v_fmac_f32 v235, v36, v108
    v_fmac_f32 v237, v44, v140
    v_fmac_f32 v235, v37, v109
    v_fmac_f32 v237, v45, v141
    v_fmac_f32 v235, v38, v110
    v_fmac_f32 v237, v46, v142
    v_fmac_f32 v235, v39, v111
    v_fmac_f32 v237, v47, v143
    v_mul_f32 v239, v48, v136
    v_mul_f32 v241, v56, v136
    s_setprio 1
    s_waitcnt vmcnt(6) lgkmcnt(0)
    v_mfma_f32_32x32x16_bf16 v[0:15], v[72:75], v[184:187], 0
    ds_read_b64_tr_b16 v[176:177], v246 offset:0
    ds_read_b64_tr_b16 v[178:179], v246 offset:1024
    ds_read_b64_tr_b16 v[180:181], v247 offset:0
    ds_read_b64_tr_b16 v[182:183], v247 offset:1024
    v_fmac_f32 v239, v49, v137
    v_fmac_f32 v241, v57, v137
    s_mov_b32 m0, s71
    v_mfma_f32_32x32x16_bf16 v[16:31], v[76:79], v[184:187], 0
    buffer_load_dwordx4 v224, s[4:7], s42 offen sc1 lds
    buffer_load_dwordx4 v225, s[72:75], s42 offen offset:1024 sc1 lds
    v_fmac_f32 v239, v50, v138
    v_fmac_f32 v241, v58, v138
    v_fmac_f32 v239, v51, v139
    v_fmac_f32 v241, v59, v139
    v_fmac_f32 v239, v52, v140
    v_mfma_f32_32x32x16_bf16 v[32:47], v[72:75], v[188:191], 0
    v_fmac_f32 v241, v60, v140
    v_fmac_f32 v239, v53, v141
    v_fmac_f32 v241, v61, v141
    v_fmac_f32 v239, v54, v142
    v_fmac_f32 v241, v62, v142
    v_fmac_f32 v239, v55, v143
    v_fmac_f32 v241, v63, v143
    v_mfma_f32_32x32x16_bf16 v[48:63], v[76:79], v[188:191], 0
    v_permlane32_swap_b32 v234, v236
    v_permlane32_swap_b32 v235, v237
    v_permlane32_swap_b32 v240, v238
    s_waitcnt vmcnt(6) lgkmcnt(0)
    v_mfma_f32_32x32x16_bf16 v[0:15], v[64:67], v[176:179], v[0:15]
    ds_read_b64_tr_b16 v[184:185], v246 offset:2048
    ds_read_b64_tr_b16 v[186:187], v246 offset:3072
    ds_read_b64_tr_b16 v[188:189], v247 offset:2048
    ds_read_b64_tr_b16 v[190:191], v247 offset:3072
    v_permlane32_swap_b32 v241, v239
    s_mov_b32 m0, s68
    v_mfma_f32_32x32x16_bf16 v[16:31], v[68:71], v[176:179], v[16:31]
    buffer_load_dwordx4 v226, s[4:7], s42 offen sc1 lds
    buffer_load_dwordx4 v227, s[72:75], s42 offen offset:1024 sc1 lds
    v_add_f32 v234, v234, v236
    v_add_f32 v235, v235, v237
    v_add_f32 v240, v240, v238
    v_add_f32 v241, v241, v239
    v_mfma_f32_32x32x16_bf16 v[32:47], v[64:67], v[180:183], v[32:47]
    s_set_gpr_idx_on s31, gpr_idx(DST)
    s_nop 0
    v_cvt_pk_bf16_f32 v192, v234, v235
    v_cvt_pk_bf16_f32 v193, v240, v241
    s_set_gpr_idx_off
    v_mfma_f32_32x32x16_bf16 v[48:63], v[68:71], v[180:183], v[48:63]
    s_waitcnt vmcnt(6) lgkmcnt(0)
    v_mfma_f32_32x32x16_bf16 v[0:15], v[80:83], v[184:187], v[0:15]
    ds_read_b64_tr_b16 v[176:177], v246 offset:4096
    ds_read_b64_tr_b16 v[178:179], v246 offset:5120
    ds_read_b64_tr_b16 v[180:181], v247 offset:4096
    ds_read_b64_tr_b16 v[182:183], v247 offset:5120
    s_mov_b32 m0, s69
    v_mfma_f32_32x32x16_bf16 v[16:31], v[84:87], v[184:187], v[16:31]
    buffer_load_dwordx4 v222, s[4:7], s43 offen sc1 lds
    buffer_load_dwordx4 v223, s[72:75], s43 offen offset:1024 sc1 lds
    v_mfma_f32_32x32x16_bf16 v[32:47], v[80:83], v[188:191], v[32:47]
    s_nop 2
    v_mul_f32 v234, v0, v144
    v_mul_f32 v236, v8, v112
    v_fmac_f32 v234, v1, v145
    v_fmac_f32 v236, v9, v113
    v_fmac_f32 v234, v2, v146
    v_fmac_f32 v236, v10, v114
    v_fmac_f32 v234, v3, v147
    v_mfma_f32_32x32x16_bf16 v[48:63], v[84:87], v[188:191], v[48:63]
    s_setprio 0
    v_fmac_f32 v236, v11, v115
    v_fmac_f32 v234, v4, v148
    v_fmac_f32 v236, v12, v116
    v_fmac_f32 v234, v5, v149
    v_fmac_f32 v236, v13, v117
    v_fmac_f32 v234, v6, v150
    v_fmac_f32 v236, v14, v118
    v_fmac_f32 v234, v7, v151
    v_fmac_f32 v236, v15, v119
    v_mul_f32 v238, v16, v160
    v_mul_f32 v240, v24, v160
    v_fmac_f32 v238, v17, v161
    v_fmac_f32 v240, v25, v161
    v_fmac_f32 v238, v18, v162
    v_fmac_f32 v240, v26, v162
    v_fmac_f32 v238, v19, v163
    v_fmac_f32 v240, v27, v163
    v_fmac_f32 v238, v20, v164
    v_fmac_f32 v240, v28, v164
    v_fmac_f32 v238, v21, v165
    v_fmac_f32 v240, v29, v165
    v_fmac_f32 v238, v22, v166
    v_fmac_f32 v240, v30, v166
    v_fmac_f32 v238, v23, v167
    v_fmac_f32 v240, v31, v167
    v_mul_f32 v235, v32, v152
    v_mul_f32 v237, v40, v120
    v_fmac_f32 v235, v33, v153
    v_fmac_f32 v237, v41, v121
    v_fmac_f32 v235, v34, v154
    v_fmac_f32 v237, v42, v122
    v_fmac_f32 v235, v35, v155
    v_fmac_f32 v237, v43, v123
    v_fmac_f32 v235, v36, v156
    v_fmac_f32 v237, v44, v124
    v_fmac_f32 v235, v37, v157
    v_fmac_f32 v237, v45, v125
    v_fmac_f32 v235, v38, v158
    v_fmac_f32 v237, v46, v126
    v_fmac_f32 v235, v39, v159
    v_fmac_f32 v237, v47, v127
    v_mul_f32 v239, v48, v168
    v_mul_f32 v241, v56, v168
    v_fmac_f32 v239, v49, v169
    v_fmac_f32 v241, v57, v169
    s_setprio 1
    s_waitcnt vmcnt(4) lgkmcnt(0)
    v_mfma_f32_32x32x16_bf16 v[0:15], v[64:67], v[176:179], 0
    ds_read_b64_tr_b16 v[184:185], v246 offset:6144
    ds_read_b64_tr_b16 v[186:187], v246 offset:7168
    ds_read_b64_tr_b16 v[188:189], v247 offset:6144
    ds_read_b64_tr_b16 v[190:191], v247 offset:7168
    v_fmac_f32 v239, v50, v170
    v_fmac_f32 v241, v58, v170
    s_mov_b32 m0, s70
    v_mfma_f32_32x32x16_bf16 v[16:31], v[68:71], v[176:179], 0
    buffer_load_dwordx4 v224, s[4:7], s43 offen sc1 lds
    buffer_load_dwordx4 v225, s[72:75], s43 offen offset:1024 sc1 lds
    v_fmac_f32 v239, v51, v171
    v_fmac_f32 v241, v59, v171
    v_fmac_f32 v239, v52, v172
    v_fmac_f32 v241, v60, v172
    v_fmac_f32 v239, v53, v173
    v_mfma_f32_32x32x16_bf16 v[32:47], v[64:67], v[180:183], 0
    v_add_u32 v222, s48, v251
    ds_read2_b32 v[222:223], v222 offset0:1 offset1:3
    v_fmac_f32 v241, v61, v173
    v_fmac_f32 v239, v54, v174
    v_fmac_f32 v241, v62, v174
    v_fmac_f32 v239, v55, v175
    v_fmac_f32 v241, v63, v175
    v_mfma_f32_32x32x16_bf16 v[48:63], v[68:71], v[180:183], 0
    s_waitcnt vmcnt(4) lgkmcnt(1)
    v_mfma_f32_32x32x16_bf16 v[0:15], v[72:75], v[184:187], v[0:15]
    ds_read_b64_tr_b16 v[176:177], v246 offset:0
    ds_read_b64_tr_b16 v[178:179], v246 offset:1024
    ds_read_b64_tr_b16 v[180:181], v247 offset:0
    ds_read_b64_tr_b16 v[182:183], v247 offset:1024
    s_mov_b32 m0, s71
    v_mfma_f32_32x32x16_bf16 v[16:31], v[76:79], v[184:187], v[16:31]
    buffer_load_dwordx4 v226, s[4:7], s43 offen sc1 lds
    buffer_load_dwordx4 v227, s[72:75], s43 offen offset:1024 sc1 lds
    s_waitcnt lgkmcnt(4)
    v_mad_u32_u16 v222, v222, s39, v248 op_sel:[1,0,0,0]
    v_mad_u32_u16 v223, v223, s39, v248 op_sel:[1,0,0,0]
    v_mfma_f32_32x32x16_bf16 v[32:47], v[72:75], v[188:191], v[32:47]
    v_add_u32 v224, s49, v251
    ds_read2_b32 v[224:225], v224 offset0:1 offset1:3
    v_mfma_f32_32x32x16_bf16 v[48:63], v[76:79], v[188:191], v[48:63]
    s_waitcnt vmcnt(4) lgkmcnt(1)
    v_mfma_f32_32x32x16_bf16 v[0:15], v[80:83], v[176:179], v[0:15]
    ds_read_b64_tr_b16 v[184:185], v246 offset:2048
    ds_read_b64_tr_b16 v[186:187], v246 offset:3072
    ds_read_b64_tr_b16 v[188:189], v247 offset:2048
    ds_read_b64_tr_b16 v[190:191], v247 offset:3072
    s_mov_b32 m0, s68
    v_mfma_f32_32x32x16_bf16 v[16:31], v[84:87], v[176:179], v[16:31]
    buffer_load_dwordx4 v222, s[4:7], s44 offen sc1 lds
    buffer_load_dwordx4 v223, s[72:75], s44 offen offset:1024 sc1 lds
    s_waitcnt lgkmcnt(4)
    v_mad_u32_u16 v224, v224, s39, v248 op_sel:[1,0,0,0]
    v_mad_u32_u16 v225, v225, s39, v248 op_sel:[1,0,0,0]
    v_mfma_f32_32x32x16_bf16 v[32:47], v[80:83], v[180:183], v[32:47]
    v_add_u32 v226, s50, v251
    ds_read2_b32 v[226:227], v226 offset0:1 offset1:3
    v_mul_f32 v242, v0, v144
    v_fma_f32 v238, v8, v160, -v238
    v_fmac_f32 v242, v1, v145
    v_fmac_f32 v238, v9, v161
    v_fmac_f32 v242, v2, v146
    v_mfma_f32_32x32x16_bf16 v[48:63], v[84:87], v[180:183], v[48:63]
    s_setprio 0
    v_fmac_f32 v238, v10, v162
    v_fmac_f32 v242, v3, v147
    v_fmac_f32 v238, v11, v163
    v_fmac_f32 v242, v4, v148
    v_fmac_f32 v238, v12, v164
    v_fmac_f32 v242, v5, v149
    v_fmac_f32 v238, v13, v165
    v_fmac_f32 v242, v6, v150
    v_fmac_f32 v238, v14, v166
    v_fmac_f32 v242, v7, v151
    v_fmac_f32 v238, v15, v167
    v_fmac_f32 v236, v16, v112
    v_mul_f32 v244, v24, v160
    v_fmac_f32 v236, v17, v113
    v_fmac_f32 v244, v25, v161
    v_fmac_f32 v236, v18, v114
    v_fmac_f32 v244, v26, v162
    v_fmac_f32 v236, v19, v115
    v_fmac_f32 v244, v27, v163
    v_fmac_f32 v236, v20, v116
    v_fmac_f32 v244, v28, v164
    v_fmac_f32 v236, v21, v117
    v_fmac_f32 v244, v29, v165
    v_fmac_f32 v236, v22, v118
    v_fmac_f32 v244, v30, v166
    v_fmac_f32 v236, v23, v119
    v_fmac_f32 v244, v31, v167
    v_mul_f32 v243, v32, v152
    v_fma_f32 v239, v40, v168, -v239
    v_fmac_f32 v243, v33, v153
    v_fmac_f32 v239, v41, v169
    v_fmac_f32 v243, v34, v154
    v_fmac_f32 v239, v42, v170
    v_fmac_f32 v243, v35, v155
    v_fmac_f32 v239, v43, v171
    v_fmac_f32 v243, v36, v156
    v_fmac_f32 v239, v44, v172
    v_fmac_f32 v243, v37, v157
    v_fmac_f32 v239, v45, v173
    v_fmac_f32 v243, v38, v158
    v_fmac_f32 v239, v46, v174
    v_fmac_f32 v243, v39, v159
    v_fmac_f32 v239, v47, v175
    v_fmac_f32 v237, v48, v120
    v_mul_f32 v245, v56, v168
    v_fmac_f32 v237, v49, v121
    v_fmac_f32 v245, v57, v169
    v_fmac_f32 v237, v50, v122
    s_setprio 1
    s_waitcnt vmcnt(4) lgkmcnt(1)
    v_mfma_f32_32x32x16_bf16 v[0:15], v[64:67], v[184:187], 0
    ds_read_b64_tr_b16 v[176:177], v246 offset:4096
    ds_read_b64_tr_b16 v[178:179], v246 offset:5120
    ds_read_b64_tr_b16 v[180:181], v247 offset:4096
    ds_read_b64_tr_b16 v[182:183], v247 offset:5120
    v_fmac_f32 v245, v58, v170
    v_fmac_f32 v237, v51, v123
    s_mov_b32 m0, s69
    v_mfma_f32_32x32x16_bf16 v[16:31], v[68:71], v[184:187], 0
    buffer_load_dwordx4 v224, s[4:7], s45 offen sc1 lds
    buffer_load_dwordx4 v225, s[72:75], s45 offen offset:1024 sc1 lds
    s_waitcnt lgkmcnt(4)
    v_mad_u32_u16 v226, v226, s39, v248 op_sel:[1,0,0,0]
    v_mad_u32_u16 v227, v227, s39, v248 op_sel:[1,0,0,0]
    v_fmac_f32 v245, v59, v171
    v_fmac_f32 v237, v52, v124
    v_mfma_f32_32x32x16_bf16 v[32:47], v[64:67], v[188:191], 0
    v_fmac_f32 v245, v60, v172
    v_fmac_f32 v237, v53, v125
    v_fmac_f32 v245, v61, v173
    v_fmac_f32 v237, v54, v126
    v_fmac_f32 v245, v62, v174
    v_fmac_f32 v237, v55, v127
    v_fmac_f32 v245, v63, v175
    v_mfma_f32_32x32x16_bf16 v[48:63], v[68:71], v[188:191], 0
    v_permlane32_swap_b32 v242, v234
    v_permlane32_swap_b32 v243, v235
    v_add_f32 v242, v242, v234
    v_add_f32 v243, v243, v235
    s_waitcnt vmcnt(4) lgkmcnt(0)
    v_mfma_f32_32x32x16_bf16 v[0:15], v[72:75], v[176:179], v[0:15]
    ds_read_b64_tr_b16 v[184:185], v246 offset:6144
    ds_read_b64_tr_b16 v[186:187], v246 offset:7168
    ds_read_b64_tr_b16 v[188:189], v247 offset:6144
    ds_read_b64_tr_b16 v[190:191], v247 offset:7168
    s_mov_b32 m0, s70
    v_mfma_f32_32x32x16_bf16 v[16:31], v[76:79], v[176:179], v[16:31]
    buffer_load_dwordx4 v226, s[4:7], s46 offen sc1 lds
    buffer_load_dwordx4 v227, s[72:75], s46 offen offset:1024 sc1 lds
    s_set_gpr_idx_on s31, gpr_idx(DST)
    s_nop 0
    v_cvt_pk_bf16_f32 v194, v242, v243
    s_set_gpr_idx_off
    s_sub_u32 s26, s48, s29
    s_mov_b32 s29, s48
    v_mfma_f32_32x32x16_bf16 v[32:47], v[72:75], v[180:183], v[32:47]
    s_mov_b32 s30, s3
    s_bfe_u32 s56, s3, 0x40012
    s_cmp_eq_u32 s34, 0
    s_cselect_b32 s56, s56, 0
    s_mov_b32 s32, s31
    s_mov_b32 s31, s35
    v_mfma_f32_32x32x16_bf16 v[48:63], v[76:79], v[180:183], v[48:63]
    s_waitcnt vmcnt(4) lgkmcnt(0)
    v_mfma_f32_32x32x16_bf16 v[0:15], v[80:83], v[184:187], v[0:15]
    ds_read_b64_tr_b16 v[176:177], v246 offset:0
    ds_read_b64_tr_b16 v[178:179], v246 offset:1024
    ds_read_b64_tr_b16 v[180:181], v247 offset:0
    ds_read_b64_tr_b16 v[182:183], v247 offset:1024
    s_mov_b32 m0, s71
    v_mfma_f32_32x32x16_bf16 v[16:31], v[84:87], v[184:187], v[16:31]
    s_cmp_eq_u32 s33, 4
    s_cbranch_scc1 K2_g4_49
    buffer_load_dwordx4 v224, s[4:7], s47 offen sc1 lds
    buffer_load_dwordx4 v225, s[72:75], s47 offen offset:1024 sc1 lds
K2_back_50:
    v_mfma_f32_32x32x16_bf16 v[32:47], v[80:83], v[188:191], v[32:47]
    s_nop 0
    v_mul_f32 v242, v0, v144
    v_fma_f32 v240, v8, v160, -v240
    v_fmac_f32 v242, v1, v145
    v_fmac_f32 v240, v9, v161
    v_fmac_f32 v242, v2, v146
    v_fmac_f32 v240, v10, v162
    v_fmac_f32 v242, v3, v147
    v_mfma_f32_32x32x16_bf16 v[48:63], v[84:87], v[188:191], v[48:63]
    s_setprio 0
    v_fmac_f32 v240, v11, v163
    v_fmac_f32 v242, v4, v148
    v_fmac_f32 v240, v12, v164
    v_fmac_f32 v242, v5, v149
    v_fmac_f32 v240, v13, v165
    v_fmac_f32 v242, v6, v150
    v_fmac_f32 v240, v14, v166
    v_fmac_f32 v242, v7, v151
    v_fmac_f32 v240, v15, v167
    v_add_u32 v249, s26, v249
    v_add_u32 v250, s26, v250
    v_fma_f32 v244, v16, v160, -v244
    v_fmac_f32 v236, v24, v112
    v_fmac_f32 v244, v17, v161
    v_fmac_f32 v236, v25, v113
    v_fmac_f32 v244, v18, v162
    v_fmac_f32 v236, v26, v114
    v_fmac_f32 v244, v19, v163
    v_fmac_f32 v236, v27, v115
    v_fmac_f32 v244, v20, v164
    v_fmac_f32 v236, v28, v116
    v_fmac_f32 v244, v21, v165
    v_fmac_f32 v236, v29, v117
    v_fmac_f32 v244, v22, v166
    v_fmac_f32 v236, v30, v118
    v_fmac_f32 v244, v23, v167
    v_fmac_f32 v236, v31, v119
    ds_read_b64_tr_b16 v[0:1], v249 offset:0
    ds_read_b64_tr_b16 v[2:3], v249 offset:32
    ds_read_u16_d16_hi v16, v250 offset:0
    v_mul_f32 v243, v32, v152
    v_fma_f32 v241, v40, v168, -v241
    v_fmac_f32 v243, v33, v153
    v_fmac_f32 v241, v41, v169
    v_fmac_f32 v243, v34, v154
    v_fmac_f32 v241, v42, v170
    v_fmac_f32 v243, v35, v155
    v_fmac_f32 v241, v43, v171
    v_fmac_f32 v243, v36, v156
    v_fmac_f32 v241, v44, v172
    v_fmac_f32 v243, v37, v157
    v_fmac_f32 v241, v45, v173
    v_fmac_f32 v243, v38, v158
    v_fmac_f32 v241, v46, v174
    v_fmac_f32 v243, v39, v159
    v_fmac_f32 v241, v47, v175
    ds_read_b64_tr_b16 v[4:5], v249 offset:512
    ds_read_b64_tr_b16 v[6:7], v249 offset:544
    ds_read_u16_d16_hi v17, v250 offset:128
    v_fma_f32 v245, v48, v168, -v245
    v_fmac_f32 v237, v56, v120
    v_fmac_f32 v245, v49, v169
    v_fmac_f32 v237, v57, v121
    v_fmac_f32 v245, v50, v170
    v_fmac_f32 v237, v58, v122
    v_fmac_f32 v245, v51, v171
    v_fmac_f32 v237, v59, v123
    v_fmac_f32 v245, v52, v172
    v_fmac_f32 v237, v60, v124
    v_fmac_f32 v245, v53, v173
    v_fmac_f32 v237, v61, v125
    v_fmac_f32 v245, v54, v174
    v_fmac_f32 v237, v62, v126
    v_fmac_f32 v245, v55, v175
    v_fmac_f32 v237, v63, v127
    s_cmp_eq_u32 s56, 5
    s_cbranch_scc1 K2_U20
    s_cmp_eq_u32 s56, 6
    s_cbranch_scc1 K2_U3h0
    s_branch K2_DSP0
K2_PAD_U21:
    s_branch K2_HOP
K2_U21:
    s_setprio 1
    s_waitcnt lgkmcnt(0)
    v_lshlrev_b32 v20, 16, v0
    v_and_b32 v21, 0xffff0000, v0
    v_lshlrev_b32 v22, 16, v1
    v_and_b32 v23, 0xffff0000, v1
    v_lshlrev_b32 v24, 16, v2
    v_and_b32 v25, 0xffff0000, v2
    v_lshlrev_b32 v26, 16, v3
    v_and_b32 v27, 0xffff0000, v3
    v_mul_f32_dpp v36, v16, v20 row_newbcast:8 row_mask:0xf bank_mask:0xf
    v_mul_f32_dpp v37, v16, v21 row_newbcast:9 row_mask:0xf bank_mask:0xf
    v_mul_f32_dpp v38, v16, v22 row_newbcast:10 row_mask:0xf bank_mask:0xf
    v_mul_f32_dpp v39, v16, v23 row_newbcast:11 row_mask:0xf bank_mask:0xf
    v_mul_f32_dpp v40, v16, v24 row_newbcast:12 row_mask:0xf bank_mask:0xf
    v_mul_f32_dpp v41, v16, v25 row_newbcast:13 row_mask:0xf bank_mask:0xf
    v_mul_f32_dpp v42, v16, v26 row_newbcast:14 row_mask:0xf bank_mask:0xf
    v_mul_f32_dpp v43, v16, v27 row_newbcast:15 row_mask:0xf bank_mask:0xf
    v_cvt_pk_bf16_f32 v68, v36, v37
    v_cvt_pk_bf16_f32 v69, v38, v39
    v_cvt_pk_bf16_f32 v70, v40, v41
    v_cvt_pk_bf16_f32 v71, v42, v43
    v_mul_f32_dpp v20, v16, v20 row_newbcast:0 row_mask:0xa bank_mask:0xf
    v_mul_f32_dpp v21, v16, v21 row_newbcast:1 row_mask:0xa bank_mask:0xf
    v_mul_f32_dpp v22, v16, v22 row_newbcast:2 row_mask:0xa bank_mask:0xf
    v_mul_f32_dpp v23, v16, v23 row_newbcast:3 row_mask:0xa bank_mask:0xf
    v_mul_f32_dpp v24, v16, v24 row_newbcast:4 row_mask:0xa bank_mask:0xf
    v_mul_f32_dpp v25, v16, v25 row_newbcast:5 row_mask:0xa bank_mask:0xf
    v_mul_f32_dpp v26, v16, v26 row_newbcast:6 row_mask:0xa bank_mask:0xf
    v_mul_f32_dpp v27, v16, v27 row_newbcast:7 row_mask:0xa bank_mask:0xf
    v_cvt_pk_bf16_f32 v64, v20, v21
    v_cvt_pk_bf16_f32 v65, v22, v23
    v_cvt_pk_bf16_f32 v66, v24, v25
    v_cvt_pk_bf16_f32 v67, v26, v27
    v_lshlrev_b32 v28, 16, v4
    v_and_b32 v29, 0xffff0000, v4
    v_lshlrev_b32 v30, 16, v5
    v_and_b32 v31, 0xffff0000, v5
    v_lshlrev_b32 v32, 16, v6
    v_and_b32 v33, 0xffff0000, v6
    v_lshlrev_b32 v34, 16, v7
    v_and_b32 v35, 0xffff0000, v7
    v_mul_f32_dpp v36, v17, v28 row_newbcast:8 row_mask:0xf bank_mask:0xf
    v_mul_f32_dpp v37, v17, v29 row_newbcast:9 row_mask:0xf bank_mask:0xf
    v_mul_f32_dpp v38, v17, v30 row_newbcast:10 row_mask:0xf bank_mask:0xf
    v_mul_f32_dpp v39, v17, v31 row_newbcast:11 row_mask:0xf bank_mask:0xf
    v_mul_f32_dpp v40, v17, v32 row_newbcast:12 row_mask:0xf bank_mask:0xf
    v_mul_f32_dpp v41, v17, v33 row_newbcast:13 row_mask:0xf bank_mask:0xf
    v_mul_f32_dpp v42, v17, v34 row_newbcast:14 row_mask:0xf bank_mask:0xf
    v_mul_f32_dpp v43, v17, v35 row_newbcast:15 row_mask:0xf bank_mask:0xf
    v_cvt_pk_bf16_f32 v76, v36, v37
    v_cvt_pk_bf16_f32 v77, v38, v39
    v_cvt_pk_bf16_f32 v78, v40, v41
    v_cvt_pk_bf16_f32 v79, v42, v43
    v_mul_f32_dpp v28, v17, v28 row_newbcast:0 row_mask:0xa bank_mask:0xf
    v_mul_f32_dpp v29, v17, v29 row_newbcast:1 row_mask:0xa bank_mask:0xf
    v_mul_f32_dpp v30, v17, v30 row_newbcast:2 row_mask:0xa bank_mask:0xf
    v_mul_f32_dpp v31, v17, v31 row_newbcast:3 row_mask:0xa bank_mask:0xf
    v_mul_f32_dpp v32, v17, v32 row_newbcast:4 row_mask:0xa bank_mask:0xf
    v_mul_f32_dpp v33, v17, v33 row_newbcast:5 row_mask:0xa bank_mask:0xf
    v_mul_f32_dpp v34, v17, v34 row_newbcast:6 row_mask:0xa bank_mask:0xf
    v_mul_f32_dpp v35, v17, v35 row_newbcast:7 row_mask:0xa bank_mask:0xf
    v_cvt_pk_bf16_f32 v72, v28, v29
    v_cvt_pk_bf16_f32 v73, v30, v31
    v_cvt_pk_bf16_f32 v74, v32, v33
    v_cvt_pk_bf16_f32 v75, v34, v35
    s_waitcnt vmcnt(4)
    v_mfma_f32_32x32x16_bf16 v[0:15], v[64:67], v[176:179], 0
    ds_read_b64_tr_b16 v[184:185], v246 offset:2048
    ds_read_b64_tr_b16 v[186:187], v246 offset:3072
    ds_read_b64_tr_b16 v[188:189], v247 offset:2048
    ds_read_b64_tr_b16 v[190:191], v247 offset:3072
    s_mov_b32 m0, s68
    v_mfma_f32_32x32x16_bf16 v[16:31], v[68:71], v[176:179], 0
    buffer_load_dwordx4 v222, s[4:7], s42 offen sc1 lds
    buffer_load_dwordx4 v223, s[72:75], s42 offen offset:1024 sc1 lds
    v_permlane32_swap_b32 v242, v236
    v_permlane32_swap_b32 v243, v237
    v_mfma_f32_32x32x16_bf16 v[32:47], v[64:67], v[180:183], 0
    v_permlane32_swap_b32 v244, v238
    v_permlane32_swap_b32 v245, v239
    v_permlane32_swap_b32 v240, v241
    v_add_f32 v242, v242, v236
    v_mfma_f32_32x32x16_bf16 v[48:63], v[68:71], v[180:183], 0
    v_add_f32 v243, v243, v237
    v_add_f32 v244, v244, v238
    v_add_f32 v245, v245, v239
    v_add_f32 v240, -v240, -v241
    v_sub_u32 v241, v230, v231
    v_cvt_pk_bf16_f32 v242, v242, v243
    s_mov_b64 exec, 0x1ff
    ds_add_rtn_u32 v232, v254, v255
    s_mov_b64 exec, -1
    s_waitcnt vmcnt(4) lgkmcnt(1)
    v_mfma_f32_32x32x16_bf16 v[0:15], v[72:75], v[184:187], v[0:15]
    ds_read_b64_tr_b16 v[176:177], v246 offset:4096
    ds_read_b64_tr_b16 v[178:179], v246 offset:5120
    ds_read_b64_tr_b16 v[180:181], v247 offset:4096
    ds_read_b64_tr_b16 v[182:183], v247 offset:5120
    v_cvt_pk_bf16_f32 v244, v244, v245
    v_cvt_pk_bf16_f32 v240, v240, v240
    s_mov_b32 m0, s69
    v_mfma_f32_32x32x16_bf16 v[16:31], v[76:79], v[184:187], v[16:31]
    buffer_load_dwordx4 v224, s[4:7], s42 offen sc1 lds
    buffer_load_dwordx4 v225, s[72:75], s42 offen offset:1024 sc1 lds
    ds_write2st64_b32 v230, v242, v244 offset0:3 offset1:4
    ds_write_b16 v241, v240 offset:1280
    s_waitcnt lgkmcnt(6)
    v_readlane_b32 s58, v232, 8
    v_mfma_f32_32x32x16_bf16 v[32:47], v[72:75], v[188:191], v[32:47]
    s_cmp_lt_u32 s58, s22
    s_cbranch_scc0 K2_nul_55
    s_nop 0
    v_readlane_b32 s3, v253, s58
    s_nop 0
    s_bfe_u32 s58, s3, 0x60016
    s_and_b32 s59, s58, 7
    s_lshr_b32 s60, s58, 3
K2_chk_57:
    v_readlane_b32 s61, v232, s59
    s_nop 0
    s_cmp_gt_u32 s61, s60
    s_cbranch_scc0 K2_spin_56
K2_back_58:
    v_mfma_f32_32x32x16_bf16 v[48:63], v[76:79], v[188:191], v[48:63]
    s_setprio 0
    s_lshl_b32 s44, s34, 7
    s_and_b32 s48, s3, 0x3ffff
    s_bfe_u32 s33, s3, 0x30013
    s_mov_b32 s35, s48
    s_mov_b32 s45, s44
    s_xor_b32 s47, s44, 256
    v_mul_f32 v234, v0, v96
    v_mul_f32 v236, v8, v128
    v_fmac_f32 v234, v1, v97
    v_fmac_f32 v236, v9, v129
    v_fmac_f32 v234, v2, v98
    v_fmac_f32 v236, v10, v130
    v_fmac_f32 v234, v3, v99
    v_fmac_f32 v236, v11, v131
    v_fmac_f32 v234, v4, v100
    v_fmac_f32 v236, v12, v132
    v_fmac_f32 v234, v5, v101
    v_fmac_f32 v236, v13, v133
    v_fmac_f32 v234, v6, v102
    v_fmac_f32 v236, v14, v134
    v_fmac_f32 v234, v7, v103
    v_fmac_f32 v236, v15, v135
    v_mul_f32 v238, v16, v128
    v_mul_f32 v240, v24, v128
    v_fmac_f32 v238, v17, v129
    v_fmac_f32 v240, v25, v129
    v_fmac_f32 v238, v18, v130
    v_fmac_f32 v240, v26, v130
    v_fmac_f32 v238, v19, v131
    v_fmac_f32 v240, v27, v131
    v_fmac_f32 v238, v20, v132
    v_fmac_f32 v240, v28, v132
    v_fmac_f32 v238, v21, v133
    v_fmac_f32 v240, v29, v133
    v_fmac_f32 v238, v22, v134
    v_fmac_f32 v240, v30, v134
    v_fmac_f32 v238, v23, v135
    v_fmac_f32 v240, v31, v135
    v_mul_f32 v235, v32, v104
    v_mul_f32 v237, v40, v136
    v_fmac_f32 v235, v33, v105
    v_fmac_f32 v237, v41, v137
    v_fmac_f32 v235, v34, v106
    v_fmac_f32 v237, v42, v138
    v_fmac_f32 v235, v35, v107
    v_fmac_f32 v237, v43, v139
    v_fmac_f32 v235, v36, v108
    v_fmac_f32 v237, v44, v140
    v_fmac_f32 v235, v37, v109
    v_fmac_f32 v237, v45, v141
    v_fmac_f32 v235, v38, v110
    v_fmac_f32 v237, v46, v142
    v_fmac_f32 v235, v39, v111
    v_fmac_f32 v237, v47, v143
    v_mul_f32 v239, v48, v136
    v_mul_f32 v241, v56, v136
    v_fmac_f32 v239, v49, v137
    v_fmac_f32 v241, v57, v137
    s_setprio 1
    s_waitcnt vmcnt(4) lgkmcnt(2)
    v_mfma_f32_32x32x16_bf16 v[0:15], v[64:67], v[176:179], 0
    ds_read_b64_tr_b16 v[184:185], v246 offset:6144
    ds_read_b64_tr_b16 v[186:187], v246 offset:7168
    ds_read_b64_tr_b16 v[188:189], v247 offset:6144
    ds_read_b64_tr_b16 v[190:191], v247 offset:7168
    v_fmac_f32 v239, v50, v138
    v_fmac_f32 v241, v58, v138
    s_mov_b32 m0, s70
    v_mfma_f32_32x32x16_bf16 v[16:31], v[68:71], v[176:179], 0
    buffer_load_dwordx4 v222, s[4:7], s43 offen sc1 lds
    buffer_load_dwordx4 v223, s[72:75], s43 offen offset:1024 sc1 lds
    v_fmac_f32 v239, v51, v139
    v_fmac_f32 v241, v59, v139
    v_fmac_f32 v239, v52, v140
    v_fmac_f32 v241, v60, v140
    v_fmac_f32 v239, v53, v141
    v_mfma_f32_32x32x16_bf16 v[32:47], v[64:67], v[180:183], 0
    s_add_u32 s49, s48, 128
    s_add_u32 s60, s48, 256
    s_cmp_eq_u32 s33, 3
    s_cselect_b32 s46, s44, s47
    s_cselect_b32 s50, s60, s48
    s_sub_u32 s60, s33, 2
    s_cmp_lt_u32 s60, 2
    s_cbranch_scc0 K2_rare_59
K2_back_60:
    v_add_u32 v222, s48, v251
    ds_read2_b32 v[222:223], v222 offset0:1 offset1:3
    v_fmac_f32 v241, v61, v141
    v_fmac_f32 v239, v54, v142
    v_fmac_f32 v241, v62, v142
    v_fmac_f32 v239, v55, v143
    v_fmac_f32 v241, v63, v143
    v_mfma_f32_32x32x16_bf16 v[48:63], v[68:71], v[180:183], 0
    v_permlane32_swap_b32 v234, v236
    v_permlane32_swap_b32 v235, v237
    v_permlane32_swap_b32 v240, v238
    s_waitcnt vmcnt(4) lgkmcnt(1)
    v_mfma_f32_32x32x16_bf16 v[0:15], v[72:75], v[184:187], v[0:15]
    ds_read_b64_tr_b16 v[176:177], v246 offset:0
    ds_read_b64_tr_b16 v[178:179], v246 offset:1024
    ds_read_b64_tr_b16 v[180:181], v247 offset:0
    ds_read_b64_tr_b16 v[182:183], v247 offset:1024
    v_permlane32_swap_b32 v241, v239
    s_mov_b32 m0, s71
    v_mfma_f32_32x32x16_bf16 v[16:31], v[76:79], v[184:187], v[16:31]
    buffer_load_dwordx4 v224, s[4:7], s43 offen sc1 lds
    buffer_load_dwordx4 v225, s[72:75], s43 offen offset:1024 sc1 lds
    s_waitcnt lgkmcnt(4)
    v_mad_u32_u16 v222, v222, s39, v248 op_sel:[1,0,0,0]
    v_mad_u32_u16 v223, v223, s39, v248 op_sel:[1,0,0,0]
    v_lshl_add_u32 v230, v252, 1, s31
    v_add_f32 v234, v234, v236
    v_add_f32 v235, v235, v237
    v_add_f32 v240, v240, v238
    v_add_f32 v241, v241, v239
    v_cvt_pk_bf16_f32 v234, v234, v235
    v_cvt_pk_bf16_f32 v240, v240, v241
    ds_write2st64_b32 v230, v234, v240 offset0:0 offset1:1
    v_mfma_f32_32x32x16_bf16 v[32:47], v[72:75], v[188:191], v[32:47]
    v_add_u32 v224, s49, v251
    ds_read2_b32 v[224:225], v224 offset0:1 offset1:3
    v_mul_f32 v234, v0, v144
    v_mul_f32 v236, v8, v112
    v_fmac_f32 v234, v1, v145
    v_fmac_f32 v236, v9, v113
    v_fmac_f32 v234, v2, v146
    v_mfma_f32_32x32x16_bf16 v[48:63], v[76:79], v[188:191], v[48:63]
    s_setprio 0
    v_fmac_f32 v236, v10, v114
    v_fmac_f32 v234, v3, v147
    v_fmac_f32 v236, v11, v115
    v_fmac_f32 v234, v4, v148
    v_fmac_f32 v236, v12, v116
    v_fmac_f32 v234, v5, v149
    v_fmac_f32 v236, v13, v117
    v_fmac_f32 v234, v6, v150
    v_fmac_f32 v236, v14, v118
    v_fmac_f32 v234, v7, v151
    v_fmac_f32 v236, v15, v119
    v_mul_f32 v238, v16, v160
    v_mul_f32 v240, v24, v160
    v_fmac_f32 v238, v17, v161
    v_fmac_f32 v240, v25, v161
    v_fmac_f32 v238, v18, v162
    v_fmac_f32 v240, v26, v162
    v_fmac_f32 v238, v19, v163
    v_fmac_f32 v240, v27, v163
    v_fmac_f32 v238, v20, v164
    v_fmac_f32 v240, v28, v164
    v_fmac_f32 v238, v21, v165
    v_fmac_f32 v240, v29, v165
    v_fmac_f32 v238, v22, v166
    v_fmac_f32 v240, v30, v166
    v_fmac_f32 v238, v23, v167
    v_fmac_f32 v240, v31, v167
    v_mul_f32 v235, v32, v152
    v_mul_f32 v237, v40, v120
    v_fmac_f32 v235, v33, v153
    v_fmac_f32 v237, v41, v121
    v_fmac_f32 v235, v34, v154
    v_fmac_f32 v237, v42, v122
    v_fmac_f32 v235, v35, v155
    v_fmac_f32 v237, v43, v123
    v_fmac_f32 v235, v36, v156
    v_fmac_f32 v237, v44, v124
    v_fmac_f32 v235, v37, v157
    v_fmac_f32 v237, v45, v125
    v_fmac_f32 v235, v38, v158
    v_fmac_f32 v237, v46, v126
    v_fmac_f32 v235, v39, v159
    v_fmac_f32 v237, v47, v127
    v_mul_f32 v239, v48, v168
    v_mul_f32 v241, v56, v168
    v_fmac_f32 v239, v49, v169
    v_fmac_f32 v241, v57, v169
    v_fmac_f32 v239, v50, v170
    v_fmac_f32 v241, v58, v170
    v_fmac_f32 v239, v51, v171
    s_setprio 1
    s_waitcnt vmcnt(4) lgkmcnt(2)
    v_mfma_f32_32x32x16_bf16 v[0:15], v[64:67], v[176:179], 0
    ds_read_b64_tr_b16 v[184:185], v246 offset:2048
    ds_read_b64_tr_b16 v[186:187], v246 offset:3072
    ds_read_b64_tr_b16 v[188:189], v247 offset:2048
    ds_read_b64_tr_b16 v[190:191], v247 offset:3072
    v_fmac_f32 v241, v59, v171
    v_fmac_f32 v239, v52, v172
    s_mov_b32 m0, s68
    v_mfma_f32_32x32x16_bf16 v[16:31], v[68:71], v[176:179], 0
    buffer_load_dwordx4 v222, s[4:7], s44 offen sc1 lds
    buffer_load_dwordx4 v223, s[72:75], s44 offen offset:1024 sc1 lds
    s_waitcnt lgkmcnt(4)
    v_mad_u32_u16 v224, v224, s39, v248 op_sel:[1,0,0,0]
    v_mad_u32_u16 v225, v225, s39, v248 op_sel:[1,0,0,0]
    v_fmac_f32 v241, v60, v172
    v_fmac_f32 v239, v53, v173
    v_mfma_f32_32x32x16_bf16 v[32:47], v[64:67], v[180:183], 0
    v_add_u32 v226, s50, v251
    ds_read2_b32 v[226:227], v226 offset0:1 offset1:3
    v_fmac_f32 v241, v61, v173
    v_fmac_f32 v239, v54, v174
    v_fmac_f32 v241, v62, v174
    v_fmac_f32 v239, v55, v175
    v_fmac_f32 v241, v63, v175
    v_mfma_f32_32x32x16_bf16 v[48:63], v[68:71], v[180:183], 0
    s_waitcnt vmcnt(4) lgkmcnt(1)
    v_mfma_f32_32x32x16_bf16 v[0:15], v[72:75], v[184:187], v[0:15]
    ds_read_b64_tr_b16 v[176:177], v246 offset:4096
    ds_read_b64_tr_b16 v[178:179], v246 offset:5120
    ds_read_b64_tr_b16 v[180:181], v247 offset:4096
    ds_read_b64_tr_b16 v[182:183], v247 offset:5120
    s_mov_b32 m0, s69
    v_mfma_f32_32x32x16_bf16 v[16:31], v[76:79], v[184:187], v[16:31]
    buffer_load_dwordx4 v224, s[4:7], s45 offen sc1 lds
    buffer_load_dwordx4 v225, s[72:75], s45 offen offset:1024 sc1 lds
    s_waitcnt lgkmcnt(4)
    v_mad_u32_u16 v226, v226, s39, v248 op_sel:[1,0,0,0]
    v_mad_u32_u16 v227, v227, s39, v248 op_sel:[1,0,0,0]
    v_mfma_f32_32x32x16_bf16 v[32:47], v[72:75], v[188:191], v[32:47]
    v_mul_f32 v242, v0, v144
    v_fma_f32 v238, v8, v160, -v238
    v_fmac_f32 v242, v1, v145
    v_fmac_f32 v238, v9, v161
    v_fmac_f32 v242, v2, v146
    v_fmac_f32 v238, v10, v162
    v_fmac_f32 v242, v3, v147
    v_mfma_f32_32x32x16_bf16 v[48:63], v[76:79], v[188:191], v[48:63]
    s_setprio 0
    v_fmac_f32 v238, v11, v163
    v_fmac_f32 v242, v4, v148
    v_fmac_f32 v238, v12, v164
    v_fmac_f32 v242, v5, v149
    v_fmac_f32 v238, v13, v165
    v_fmac_f32 v242, v6, v150
    v_fmac_f32 v238, v14, v166
    v_fmac_f32 v242, v7, v151
    v_fmac_f32 v238, v15, v167
    v_fmac_f32 v236, v16, v112
    v_mul_f32 v244, v24, v160
    v_fmac_f32 v236, v17, v113
    v_fmac_f32 v244, v25, v161
    v_fmac_f32 v236, v18, v114
    v_fmac_f32 v244, v26, v162
    v_fmac_f32 v236, v19, v115
    v_fmac_f32 v244, v27, v163
    v_fmac_f32 v236, v20, v116
    v_fmac_f32 v244, v28, v164
    v_fmac_f32 v236, v21, v117
    v_fmac_f32 v244, v29, v165
    v_fmac_f32 v236, v22, v118
    v_fmac_f32 v244, v30, v166
    v_fmac_f32 v236, v23, v119
    v_fmac_f32 v244, v31, v167
    v_mul_f32 v243, v32, v152
    v_fma_f32 v239, v40, v168, -v239
    v_fmac_f32 v243, v33, v153
    v_fmac_f32 v239, v41, v169
    v_fmac_f32 v243, v34, v154
    v_fmac_f32 v239, v42, v170
    v_fmac_f32 v243, v35, v155
    v_fmac_f32 v239, v43, v171
    v_fmac_f32 v243, v36, v156
    v_fmac_f32 v239, v44, v172
    v_fmac_f32 v243, v37, v157
    v_fmac_f32 v239, v45, v173
    v_fmac_f32 v243, v38, v158
    v_fmac_f32 v239, v46, v174
    v_fmac_f32 v243, v39, v159
    v_fmac_f32 v239, v47, v175
    v_fmac_f32 v237, v48, v120
    v_mul_f32 v245, v56, v168
    s_setprio 1
    s_waitcnt vmcnt(4) lgkmcnt(0)
    v_mfma_f32_32x32x16_bf16 v[0:15], v[64:67], v[176:179], 0
    ds_read_b64_tr_b16 v[184:185], v246 offset:6144
    ds_read_b64_tr_b16 v[186:187], v246 offset:7168
    ds_read_b64_tr_b16 v[188:189], v247 offset:6144
    ds_read_b64_tr_b16 v[190:191], v247 offset:7168
    v_fmac_f32 v237, v49, v121
    v_fmac_f32 v245, v57, v169
    s_mov_b32 m0, s70
    v_mfma_f32_32x32x16_bf16 v[16:31], v[68:71], v[176:179], 0
    buffer_load_dwordx4 v226, s[4:7], s46 offen sc1 lds
    buffer_load_dwordx4 v227, s[72:75], s46 offen offset:1024 sc1 lds
    v_fmac_f32 v237, v50, v122
    v_fmac_f32 v245, v58, v170
    v_fmac_f32 v237, v51, v123
    v_fmac_f32 v245, v59, v171
    v_fmac_f32 v237, v52, v124
    v_mfma_f32_32x32x16_bf16 v[32:47], v[64:67], v[180:183], 0
    v_fmac_f32 v245, v60, v172
    v_fmac_f32 v237, v53, v125
    v_fmac_f32 v245, v61, v173
    v_fmac_f32 v237, v54, v126
    v_fmac_f32 v245, v62, v174
    v_fmac_f32 v237, v55, v127
    v_fmac_f32 v245, v63, v175
    v_mfma_f32_32x32x16_bf16 v[48:63], v[68:71], v[180:183], 0
    v_permlane32_swap_b32 v242, v234
    v_permlane32_swap_b32 v243, v235
    v_add_f32 v242, v242, v234
    v_add_f32 v243, v243, v235
    s_waitcnt vmcnt(4) lgkmcnt(0)
    v_mfma_f32_32x32x16_bf16 v[0:15], v[72:75], v[184:187], v[0:15]
    ds_read_b64_tr_b16 v[176:177], v246 offset:0
    ds_read_b64_tr_b16 v[178:179], v246 offset:1024
    ds_read_b64_tr_b16 v[180:181], v247 offset:0
    ds_read_b64_tr_b16 v[182:183], v247 offset:1024
    v_cvt_pk_bf16_f32 v242, v242, v243
    ds_write_b32 v230, v242 offset:512
    s_mov_b32 m0, s71
    v_mfma_f32_32x32x16_bf16 v[16:31], v[76:79], v[184:187], v[16:31]
    s_cmp_eq_u32 s33, 4
    s_cbranch_scc1 K2_g4_62
    buffer_load_dwordx4 v224, s[4:7], s47 offen sc1 lds
    buffer_load_dwordx4 v225, s[72:75], s47 offen offset:1024 sc1 lds
K2_back_63:
    s_sub_u32 s26, s48, s29
    s_mov_b32 s29, s48
    s_mov_b32 s30, s3
    s_bfe_u32 s56, s3, 0x40012
    s_cmp_lg_u32 s36, 0
    s_cselect_b32 s56, s56, 0
    v_mfma_f32_32x32x16_bf16 v[32:47], v[72:75], v[188:191], v[32:47]
    s_mov_b32 s32, s31
    s_mov_b32 s31, s35
    v_mul_f32 v242, v0, v144
    v_fma_f32 v240, v8, v160, -v240
    v_fmac_f32 v242, v1, v145
    v_fmac_f32 v240, v9, v161
    v_fmac_f32 v242, v2, v146
    v_mfma_f32_32x32x16_bf16 v[48:63], v[76:79], v[188:191], v[48:63]
    s_setprio 0
    v_fmac_f32 v240, v10, v162
    v_fmac_f32 v242, v3, v147
    v_fmac_f32 v240, v11, v163
    v_fmac_f32 v242, v4, v148
    v_fmac_f32 v240, v12, v164
    v_fmac_f32 v242, v5, v149
    v_fmac_f32 v240, v13, v165
    v_fmac_f32 v242, v6, v150
    v_fmac_f32 v240, v14, v166
    v_fmac_f32 v242, v7, v151
    v_fmac_f32 v240, v15, v167
    v_add_u32 v249, s26, v249
    v_add_u32 v250, s26, v250
    v_fma_f32 v244, v16, v160, -v244
    v_fmac_f32 v236, v24, v112
    v_fmac_f32 v244, v17, v161
    v_fmac_f32 v236, v25, v113
    v_fmac_f32 v244, v18, v162
    v_fmac_f32 v236, v26, v114
    v_fmac_f32 v244, v19, v163
    v_fmac_f32 v236, v27, v115
    v_fmac_f32 v244, v20, v164
    v_fmac_f32 v236, v28, v116
    v_fmac_f32 v244, v21, v165
    v_fmac_f32 v236, v29, v117
    v_fmac_f32 v244, v22, v166
    v_fmac_f32 v236, v30, v118
    v_fmac_f32 v244, v23, v167
    v_fmac_f32 v236, v31, v119
    ds_read_b64_tr_b16 v[0:1], v249 offset:0
    ds_read_b64_tr_b16 v[2:3], v249 offset:32
    ds_read_u16_d16_hi v16, v250 offset:0
    v_mul_f32 v243, v32, v152
    v_fma_f32 v241, v40, v168, -v241
    v_fmac_f32 v243, v33, v153
    v_fmac_f32 v241, v41, v169
    v_fmac_f32 v243, v34, v154
    v_fmac_f32 v241, v42, v170
    v_fmac_f32 v243, v35, v155
    v_fmac_f32 v241, v43, v171
    v_fmac_f32 v243, v36, v156
    v_fmac_f32 v241, v44, v172
    v_fmac_f32 v243, v37, v157
    v_fmac_f32 v241, v45, v173
    v_fmac_f32 v243, v38, v158
    v_fmac_f32 v241, v46, v174
    v_fmac_f32 v243, v39, v159
    v_fmac_f32 v241, v47, v175
    ds_read_b64_tr_b16 v[4:5], v249 offset:512
    ds_read_b64_tr_b16 v[6:7], v249 offset:544
    ds_read_u16_d16_hi v17, v250 offset:128
    v_fma_f32 v245, v48, v168, -v245
    v_fmac_f32 v237, v56, v120
    v_fmac_f32 v245, v49, v169
    v_fmac_f32 v237, v57, v121
    v_fmac_f32 v245, v50, v170
    v_fmac_f32 v237, v58, v122
    v_fmac_f32 v245, v51, v171
    v_fmac_f32 v237, v59, v123
    v_fmac_f32 v245, v52, v172
    v_fmac_f32 v237, v60, v124
    v_fmac_f32 v245, v53, v173
    v_fmac_f32 v237, v61, v125
    v_fmac_f32 v245, v54, v174
    v_fmac_f32 v237, v62, v126
    v_fmac_f32 v245, v55, v175
    v_fmac_f32 v237, v63, v127
    s_cmp_eq_u32 s56, 5
    s_cbranch_scc1 K2_U21
    s_cmp_eq_u32 s56, 6
    s_cbranch_scc1 K2_U3h1
    s_branch K2_DSP1
K2_PAD_U31:
    s_branch K2_HOP
K2_U3h1:
    s_setprio 1
    ds_read_b64_tr_b16 v[8:9], v249 offset:1024
    ds_read_u16_d16_hi v18, v250 offset:256
    s_waitcnt lgkmcnt(2)
    v_lshlrev_b32 v20, 16, v0
    v_and_b32 v21, 0xffff0000, v0
    v_lshlrev_b32 v22, 16, v1
    v_and_b32 v23, 0xffff0000, v1
    v_lshlrev_b32 v24, 16, v2
    v_and_b32 v25, 0xffff0000, v2
    v_lshlrev_b32 v26, 16, v3
    v_and_b32 v27, 0xffff0000, v3
    v_mul_f32_dpp v36, v16, v20 row_newbcast:8 row_mask:0xf bank_mask:0xf
    v_mul_f32_dpp v37, v16, v21 row_newbcast:9 row_mask:0xf bank_mask:0xf
    v_mul_f32_dpp v38, v16, v22 row_newbcast:10 row_mask:0xf bank_mask:0xf
    v_mul_f32_dpp v39, v16, v23 row_newbcast:11 row_mask:0xf bank_mask:0xf
    v_mul_f32_dpp v40, v16, v24 row_newbcast:12 row_mask:0xf bank_mask:0xf
    v_mul_f32_dpp v41, v16, v25 row_newbcast:13 row_mask:0xf bank_mask:0xf
    v_mul_f32_dpp v42, v16, v26 row_newbcast:14 row_mask:0xf bank_mask:0xf
    v_mul_f32_dpp v43, v16, v27 row_newbcast:15 row_mask:0xf bank_mask:0xf
    v_cvt_pk_bf16_f32 v68, v36, v37
    v_cvt_pk_bf16_f32 v69, v38, v39
    v_cvt_pk_bf16_f32 v70, v40, v41
    v_cvt_pk_bf16_f32 v71, v42, v43
    v_mul_f32_dpp v20, v16, v20 row_newbcast:0 row_mask:0xa bank_mask:0xf
    v_mul_f32_dpp v21, v16, v21 row_newbcast:1 row_mask:0xa bank_mask:0xf
    v_mul_f32_dpp v22, v16, v22 row_newbcast:2 row_mask:0xa bank_mask:0xf
    v_mul_f32_dpp v23, v16, v23 row_newbcast:3 row_mask:0xa bank_mask:0xf
    v_mul_f32_dpp v24, v16, v24 row_newbcast:4 row_mask:0xa bank_mask:0xf
    v_mul_f32_dpp v25, v16, v25 row_newbcast:5 row_mask:0xa bank_mask:0xf
    v_mul_f32_dpp v26, v16, v26 row_newbcast:6 row_mask:0xa bank_mask:0xf
    v_mul_f32_dpp v27, v16, v27 row_newbcast:7 row_mask:0xa bank_mask:0xf
    v_cvt_pk_bf16_f32 v64, v20, v21
    v_cvt_pk_bf16_f32 v65, v22, v23
    v_cvt_pk_bf16_f32 v66, v24, v25
    v_cvt_pk_bf16_f32 v67, v26, v27
    v_lshlrev_b32 v28, 16, v4
    v_and_b32 v29, 0xffff0000, v4
    v_lshlrev_b32 v30, 16, v5
    v_and_b32 v31, 0xffff0000, v5
    v_lshlrev_b32 v32, 16, v6
    v_and_b32 v33, 0xffff0000, v6
    v_lshlrev_b32 v34, 16, v7
    v_and_b32 v35, 0xffff0000, v7
    v_mul_f32_dpp v36, v17, v28 row_newbcast:8 row_mask:0xf bank_mask:0xf
    v_mul_f32_dpp v37, v17, v29 row_newbcast:9 row_mask:0xf bank_mask:0xf
    v_mul_f32_dpp v38, v17, v30 row_newbcast:10 row_mask:0xf bank_mask:0xf
    v_mul_f32_dpp v39, v17, v31 row_newbcast:11 row_mask:0xf bank_mask:0xf
    v_mul_f32_dpp v40, v17, v32 row_newbcast:12 row_mask:0xf bank_mask:0xf
    v_mul_f32_dpp v41, v17, v33 row_newbcast:13 row_mask:0xf bank_mask:0xf
    v_mul_f32_dpp v42, v17, v34 row_newbcast:14 row_mask:0xf bank_mask:0xf
    v_mul_f32_dpp v43, v17, v35 row_newbcast:15 row_mask:0xf bank_mask:0xf
    v_cvt_pk_bf16_f32 v76, v36, v37
    v_cvt_pk_bf16_f32 v77, v38, v39
    v_cvt_pk_bf16_f32 v78, v40, v41
    v_cvt_pk_bf16_f32 v79, v42, v43
    v_mul_f32_dpp v28, v17, v28 row_newbcast:0 row_mask:0xa bank_mask:0xf
    v_mul_f32_dpp v29, v17, v29 row_newbcast:1 row_mask:0xa bank_mask:0xf
    v_mul_f32_dpp v30, v17, v30 row_newbcast:2 row_mask:0xa bank_mask:0xf
    v_mul_f32_dpp v31, v17, v31 row_newbcast:3 row_mask:0xa bank_mask:0xf
    v_mul_f32_dpp v32, v17, v32 row_newbcast:4 row_mask:0xa bank_mask:0xf
    v_mul_f32_dpp v33, v17, v33 row_newbcast:5 row_mask:0xa bank_mask:0xf
    v_mul_f32_dpp v34, v17, v34 row_newbcast:6 row_mask:0xa bank_mask:0xf
    v_mul_f32_dpp v35, v17, v35 row_newbcast:7 row_mask:0xa bank_mask:0xf
    v_cvt_pk_bf16_f32 v72, v28, v29
    v_cvt_pk_bf16_f32 v73, v30, v31
    v_cvt_pk_bf16_f32 v74, v32, v33
    v_cvt_pk_bf16_f32 v75, v34, v35
    s_waitcnt lgkmcnt(0)
    v_lshlrev_b32 v20, 16, v8
    v_and_b32 v21, 0xffff0000, v8
    v_lshlrev_b32 v22, 16, v9
    v_and_b32 v23, 0xffff0000, v9
    v_mul_f32_dpp v36, v18, v20 row_newbcast:8 row_mask:0xf bank_mask:0xf
    v_mul_f32_dpp v37, v18, v21 row_newbcast:9 row_mask:0xf bank_mask:0xf
    v_mul_f32_dpp v38, v18, v22 row_newbcast:10 row_mask:0xf bank_mask:0xf
    v_mul_f32_dpp v39, v18, v23 row_newbcast:11 row_mask:0xf bank_mask:0xf
    v_cvt_pk_bf16_f32 v84, v36, v37
    v_cvt_pk_bf16_f32 v85, v38, v39
    v_mul_f32_dpp v20, v18, v20 row_newbcast:0 row_mask:0xa bank_mask:0xf
    v_mul_f32_dpp v21, v18, v21 row_newbcast:1 row_mask:0xa bank_mask:0xf
    v_mul_f32_dpp v22, v18, v22 row_newbcast:2 row_mask:0xa bank_mask:0xf
    v_mul_f32_dpp v23, v18, v23 row_newbcast:3 row_mask:0xa bank_mask:0xf
    v_cvt_pk_bf16_f32 v80, v20, v21
    v_cvt_pk_bf16_f32 v81, v22, v23
    s_waitcnt vmcnt(4)
    v_mfma_f32_32x32x16_bf16 v[0:15], v[64:67], v[176:179], 0
    ds_read_b64_tr_b16 v[184:185], v246 offset:2048
    ds_read_b64_tr_b16 v[186:187], v246 offset:3072
    ds_read_b64_tr_b16 v[188:189], v247 offset:2048
    ds_read_b64_tr_b16 v[190:191], v247 offset:3072
    s_mov_b32 m0, s68
    v_mfma_f32_32x32x16_bf16 v[16:31], v[68:71], v[176:179], 0
    buffer_load_dwordx4 v222, s[4:7], s41 offen sc1 lds
    buffer_load_dwordx4 v223, s[72:75], s41 offen offset:1024 sc1 lds
    v_permlane32_swap_b32 v242, v236
    v_permlane32_swap_b32 v243, v237
    v_mfma_f32_32x32x16_bf16 v[32:47], v[64:67], v[180:183], 0
    v_permlane32_swap_b32 v244, v238
    v_permlane32_swap_b32 v245, v239
    v_permlane32_swap_b32 v240, v241
    v_add_f32 v242, v242, v236
    v_mfma_f32_32x32x16_bf16 v[48:63], v[68:71], v[180:183], 0
    v_add_f32 v243, v243, v237
    v_add_f32 v244, v244, v238
    v_add_f32 v245, v245, v239
    v_add_f32 v240, -v240, -v241
    v_sub_u32 v241, v230, v231
    v_cvt_pk_bf16_f32 v242, v242, v243
    s_mov_b64 exec, 0x1ff
    ds_add_rtn_u32 v232, v254, v255
    s_mov_b64 exec, -1
    s_waitcnt vmcnt(4) lgkmcnt(1)
    v_mfma_f32_32x32x16_bf16 v[0:15], v[72:75], v[184:187], v[0:15]
    ds_read_b64_tr_b16 v[176:177], v246 offset:4096
    ds_read_b64_tr_b16 v[180:181], v247 offset:4096
    v_cvt_pk_bf16_f32 v244, v244, v245
    v_cvt_pk_bf16_f32 v240, v240, v240
    ds_write2st64_b32 v230, v242, v244 offset0:3 offset1:4
    ds_write_b16 v241, v240 offset:1280
    s_mov_b32 m0, s69
    v_mfma_f32_32x32x16_bf16 v[16:31], v[76:79], v[184:187], v[16:31]
    buffer_load_dwordx4 v226, s[4:7], s41 offen sc1 lds
    s_waitcnt lgkmcnt(4)
    v_readlane_b32 s58, v232, 8
    v_mfma_f32_32x32x16_bf16 v[32:47], v[72:75], v[188:191], v[32:47]
    s_cmp_lt_u32 s58, s22
    s_cbranch_scc0 K2_nul_64
    s_nop 0
    v_readlane_b32 s3, v253, s58
    s_nop 0
    s_bfe_u32 s58, s3, 0x60016
    s_and_b32 s59, s58, 7
    s_lshr_b32 s60, s58, 3
K2_chk_66:
    v_readlane_b32 s61, v232, s59
    s_nop 0
    s_cmp_gt_u32 s61, s60
    s_cbranch_scc0 K2_spin_65
K2_back_67:
    v_mfma_f32_32x32x16_bf16 v[48:63], v[76:79], v[188:191], v[48:63]
    s_lshl_b32 s44, s34, 7
    s_and_b32 s48, s3, 0x3ffff
    s_bfe_u32 s33, s3, 0x30013
    s_mov_b32 s35, s48
    s_mov_b32 s45, s44
    s_xor_b32 s47, s44, 256
    s_waitcnt vmcnt(3) lgkmcnt(2)
    v_mfma_f32_32x32x8_bf16 v[0:15], v[80:81], v[176:177], v[0:15]
    ds_read_b64_tr_b16 v[184:185], v246 offset:6144
    ds_read_b64_tr_b16 v[186:187], v246 offset:7168
    ds_read_b64_tr_b16 v[188:189], v247 offset:6144
    ds_read_b64_tr_b16 v[190:191], v247 offset:7168
    s_add_u32 s49, s48, 128
    s_add_u32 s60, s48, 256
    s_mov_b32 m0, s70
    v_mfma_f32_32x32x8_bf16 v[16:31], v[84:85], v[176:177], v[16:31]
    buffer_load_dwordx4 v222, s[4:7], s42 offen sc1 lds
    buffer_load_dwordx4 v223, s[72:75], s42 offen offset:1024 sc1 lds
    s_cmp_eq_u32 s33, 3
    s_cselect_b32 s46, s44, s47
    s_cselect_b32 s50, s60, s48
    v_mfma_f32_32x32x8_bf16 v[32:47], v[80:81], v[180:181], v[32:47]
    s_sub_u32 s60, s33, 2
    s_cmp_lt_u32 s60, 2
    s_cbranch_scc0 K2_rare_68
K2_back_69:
    v_mul_f32 v234, v0, v96
    v_mul_f32 v236, v8, v128
    v_fmac_f32 v234, v1, v97
    v_fmac_f32 v236, v9, v129
    v_mfma_f32_32x32x8_bf16 v[48:63], v[84:85], v[180:181], v[48:63]
    s_setprio 0
    v_fmac_f32 v234, v2, v98
    v_fmac_f32 v236, v10, v130
    v_fmac_f32 v234, v3, v99
    v_fmac_f32 v236, v11, v131
    v_fmac_f32 v234, v4, v100
    v_fmac_f32 v236, v12, v132
    v_fmac_f32 v234, v5, v101
    v_fmac_f32 v236, v13, v133
    v_fmac_f32 v234, v6, v102
    v_fmac_f32 v236, v14, v134
    v_fmac_f32 v234, v7, v103
    v_fmac_f32 v236, v15, v135
    v_mul_f32 v238, v16, v128
    v_mul_f32 v240, v24, v128
    v_fmac_f32 v238, v17, v129
    v_fmac_f32 v240, v25, v129
    v_fmac_f32 v238, v18, v130
    v_fmac_f32 v240, v26, v130
    v_fmac_f32 v238, v19, v131
    v_fmac_f32 v240, v27, v131
    v_fmac_f32 v238, v20, v132
    v_fmac_f32 v240, v28, v132
    v_fmac_f32 v238, v21, v133
    v_fmac_f32 v240, v29, v133
    v_fmac_f32 v238, v22, v134
    v_fmac_f32 v240, v30, v134
    v_fmac_f32 v238, v23, v135
    v_fmac_f32 v240, v31, v135
    v_mul_f32 v235, v32, v104
    v_mul_f32 v237, v40, v136
    v_fmac_f32 v235, v33, v105
    v_fmac_f32 v237, v41, v137
    v_fmac_f32 v235, v34, v106
    v_fmac_f32 v237, v42, v138
    v_fmac_f32 v235, v35, v107
    v_fmac_f32 v237, v43, v139
    v_fmac_f32 v235, v36, v108
    v_fmac_f32 v237, v44, v140
    v_fmac_f32 v235, v37, v109
    v_fmac_f32 v237, v45, v141
    v_fmac_f32 v235, v38, v110
    v_fmac_f32 v237, v46, v142
    v_fmac_f32 v235, v39, v111
    v_fmac_f32 v237, v47, v143
    v_mul_f32 v239, v48, v136
    v_mul_f32 v241, v56, v136
    s_setprio 1
    s_waitcnt vmcnt(3) lgkmcnt(0)
    v_mfma_f32_32x32x16_bf16 v[0:15], v[72:75], v[184:187], 0
    ds_read_b64_tr_b16 v[176:177], v246 offset:0
    ds_read_b64_tr_b16 v[178:179], v246 offset:1024
    ds_read_b64_tr_b16 v[180:181], v247 offset:0
    ds_read_b64_tr_b16 v[182:183], v247 offset:1024
    v_fmac_f32 v239, v49, v137
    v_fmac_f32 v241, v57, v137
    s_mov_b32 m0, s71
    v_mfma_f32_32x32x16_bf16 v[16:31], v[76:79], v[184:187], 0
    buffer_load_dwordx4 v224, s[4:7], s42 offen sc1 lds
    buffer_load_dwordx4 v225, s[72:75], s42 offen offset:1024 sc1 lds
    v_fmac_f32 v239, v50, v138
    v_fmac_f32 v241, v58, v138
    v_fmac_f32 v239, v51, v139
    v_fmac_f32 v241, v59, v139
    v_fmac_f32 v239, v52, v140
    v_mfma_f32_32x32x16_bf16 v[32:47], v[72:75], v[188:191], 0
    v_fmac_f32 v241, v60, v140
    v_fmac_f32 v239, v53, v141
    v_fmac_f32 v241, v61, v141
    v_fmac_f32 v239, v54, v142
    v_fmac_f32 v241, v62, v142
    v_fmac_f32 v239, v55, v143
    v_fmac_f32 v241, v63, v143
    v_mfma_f32_32x32x16_bf16 v[48:63], v[76:79], v[188:191], 0
    v_permlane32_swap_b32 v234, v236
    v_permlane32_swap_b32 v235, v237
    v_permlane32_swap_b32 v240, v238
    s_waitcnt vmcnt(4) lgkmcnt(0)
    v_mfma_f32_32x32x16_bf16 v[0:15], v[64:67], v[176:179], v[0:15]
    ds_read_b64_tr_b16 v[184:185], v246 offset:2048
    ds_read_b64_tr_b16 v[188:189], v247 offset:2048
    v_permlane32_swap_b32 v241, v239
    v_lshl_add_u32 v230, v252, 1, s31
    v_add_f32 v234, v234, v236
    s_mov_b32 m0, s68
    v_mfma_f32_32x32x16_bf16 v[16:31], v[68:71], v[176:179], v[16:31]
    buffer_load_dwordx4 v226, s[4:7], s42 offen sc1 lds
    v_add_f32 v235, v235, v237
    v_add_f32 v240, v240, v238
    v_add_f32 v241, v241, v239
    v_cvt_pk_bf16_f32 v234, v234, v235
    v_cvt_pk_bf16_f32 v240, v240, v241
    ds_write2st64_b32 v230, v234, v240 offset0:0 offset1:1
    v_mfma_f32_32x32x16_bf16 v[32:47], v[64:67], v[180:183], v[32:47]
    v_mfma_f32_32x32x16_bf16 v[48:63], v[68:71], v[180:183], v[48:63]
    s_waitcnt vmcnt(3) lgkmcnt(1)
    v_mfma_f32_32x32x8_bf16 v[0:15], v[80:81], v[184:185], v[0:15]
    ds_read_b64_tr_b16 v[176:177], v246 offset:4096
    ds_read_b64_tr_b16 v[178:179], v246 offset:5120
    ds_read_b64_tr_b16 v[180:181], v247 offset:4096
    ds_read_b64_tr_b16 v[182:183], v247 offset:5120
    s_mov_b32 m0, s69
    v_mfma_f32_32x32x8_bf16 v[16:31], v[84:85], v[184:185], v[16:31]
    buffer_load_dwordx4 v222, s[4:7], s43 offen sc1 lds
    buffer_load_dwordx4 v223, s[72:75], s43 offen offset:1024 sc1 lds
    v_mfma_f32_32x32x8_bf16 v[32:47], v[80:81], v[188:189], v[32:47]
    s_nop 2
    v_mul_f32 v234, v0, v144
    v_mul_f32 v236, v8, v112
    v_fmac_f32 v234, v1, v145
    v_fmac_f32 v236, v9, v113
    v_fmac_f32 v234, v2, v146
    v_fmac_f32 v236, v10, v114
    v_fmac_f32 v234, v3, v147
    v_mfma_f32_32x32x8_bf16 v[48:63], v[84:85], v[188:189], v[48:63]
    s_setprio 0
    v_fmac_f32 v236, v11, v115
    v_fmac_f32 v234, v4, v148
    v_fmac_f32 v236, v12, v116
    v_fmac_f32 v234, v5, v149
    v_fmac_f32 v236, v13, v117
    v_fmac_f32 v234, v6, v150
    v_fmac_f32 v236, v14, v118
    v_fmac_f32 v234, v7, v151
    v_fmac_f32 v236, v15, v119
    v_mul_f32 v238, v16, v160
    v_mul_f32 v240, v24, v160
    v_fmac_f32 v238, v17, v161
    v_fmac_f32 v240, v25, v161
    v_fmac_f32 v238, v18, v162
    v_fmac_f32 v240, v26, v162
    v_fmac_f32 v238, v19, v163
    v_fmac_f32 v240, v27, v163
    v_fmac_f32 v238, v20, v164
    v_fmac_f32 v240, v28, v164
    v_fmac_f32 v238, v21, v165
    v_fmac_f32 v240, v29, v165
    v_fmac_f32 v238, v22, v166
    v_fmac_f32 v240, v30, v166
    v_fmac_f32 v238, v23, v167
    v_fmac_f32 v240, v31, v167
    v_mul_f32 v235, v32, v152
    v_mul_f32 v237, v40, v120
    v_fmac_f32 v235, v33, v153
    v_fmac_f32 v237, v41, v121
    v_fmac_f32 v235, v34, v154
    v_fmac_f32 v237, v42, v122
    v_fmac_f32 v235, v35, v155
    v_fmac_f32 v237, v43, v123
    v_fmac_f32 v235, v36, v156
    v_fmac_f32 v237, v44, v124
    v_fmac_f32 v235, v37, v157
    v_fmac_f32 v237, v45, v125
    v_fmac_f32 v235, v38, v158
    v_fmac_f32 v237, v46, v126
    v_fmac_f32 v235, v39, v159
    v_fmac_f32 v237, v47, v127
    v_mul_f32 v239, v48, v168
    v_mul_f32 v241, v56, v168
    v_fmac_f32 v239, v49, v169
    v_fmac_f32 v241, v57, v169
    s_setprio 1
    s_waitcnt vmcnt(3) lgkmcnt(0)
    v_mfma_f32_32x32x16_bf16 v[0:15], v[64:67], v[176:179], 0
    ds_read_b64_tr_b16 v[184:185], v246 offset:6144
    ds_read_b64_tr_b16 v[186:187], v246 offset:7168
    ds_read_b64_tr_b16 v[188:189], v247 offset:6144
    ds_read_b64_tr_b16 v[190:191], v247 offset:7168
    v_fmac_f32 v239, v50, v170
    v_fmac_f32 v241, v58, v170
    s_mov_b32 m0, s70
    v_mfma_f32_32x32x16_bf16 v[16:31], v[68:71], v[176:179], 0
    buffer_load_dwordx4 v224, s[4:7], s43 offen sc1 lds
    buffer_load_dwordx4 v225, s[72:75], s43 offen offset:1024 sc1 lds
    v_fmac_f32 v239, v51, v171
    v_fmac_f32 v241, v59, v171
    v_fmac_f32 v239, v52, v172
    v_fmac_f32 v241, v60, v172
    v_fmac_f32 v239, v53, v173
    v_mfma_f32_32x32x16_bf16 v[32:47], v[64:67], v[180:183], 0
    v_add_u32 v222, s48, v251
    ds_read2_b32 v[222:223], v222 offset0:1 offset1:3
    v_fmac_f32 v241, v61, v173
    v_fmac_f32 v239, v54, v174
    v_fmac_f32 v241, v62, v174
    v_fmac_f32 v239, v55, v175
    v_fmac_f32 v241, v63, v175
    v_mfma_f32_32x32x16_bf16 v[48:63], v[68:71], v[180:183], 0
    s_waitcnt vmcnt(4) lgkmcnt(1)
    v_mfma_f32_32x32x16_bf16 v[0:15], v[72:75], v[184:187], v[0:15]
    ds_read_b64_tr_b16 v[176:177], v246 offset:0
    ds_read_b64_tr_b16 v[180:181], v247 offset:0
    s_mov_b32 m0, s71
    v_mfma_f32_32x32x16_bf16 v[16:31], v[76:79], v[184:187], v[16:31]
    buffer_load_dwordx4 v226, s[4:7], s43 offen sc1 lds
    s_waitcnt lgkmcnt(2)
    v_mad_u32_u16 v222, v222, s39, v248 op_sel:[1,0,0,0]
    v_mad_u32_u16 v223, v223, s39, v248 op_sel:[1,0,0,0]
    v_mfma_f32_32x32x16_bf16 v[32:47], v[72:75], v[188:191], v[32:47]
    v_add_u32 v224, s49, v251
    ds_read2_b32 v[224:225], v224 offset0:1 offset1:3
    v_mfma_f32_32x32x16_bf16 v[48:63], v[76:79], v[188:191], v[48:63]
    s_waitcnt vmcnt(3) lgkmcnt(1)
    v_mfma_f32_32x32x8_bf16 v[0:15], v[80:81], v[176:177], v[0:15]
    ds_read_b64_tr_b16 v[184:185], v246 offset:2048
    ds_read_b64_tr_b16 v[186:187], v246 offset:3072
    ds_read_b64_tr_b16 v[188:189], v247 offset:2048
    ds_read_b64_tr_b16 v[190:191], v247 offset:3072
    s_mov_b32 m0, s68
    v_mfma_f32_32x32x8_bf16 v[16:31], v[84:85], v[176:177], v[16:31]
    buffer_load_dwordx4 v222, s[4:7], s44 offen sc1 lds
    buffer_load_dwordx4 v223, s[72:75], s44 offen offset:1024 sc1 lds
    s_waitcnt lgkmcnt(4)
    v_mad_u32_u16 v224, v224, s39, v248 op_sel:[1,0,0,0]
    v_mad_u32_u16 v225, v225, s39, v248 op_sel:[1,0,0,0]
    v_mfma_f32_32x32x8_bf16 v[32:47], v[80:81], v[180:181], v[32:47]
    v_add_u32 v226, s50, v251
    ds_read2_b32 v[226:227], v226 offset0:1 offset1:3
    v_mul_f32 v242, v0, v144
    v_fma_f32 v238, v8, v160, -v238
    v_fmac_f32 v242, v1, v145
    v_fmac_f32 v238, v9, v161
    v_fmac_f32 v242, v2, v146
    v_mfma_f32_32x32x8_bf16 v[48:63], v[84:85], v[180:181], v[48:63]
    s_setprio 0
    v_fmac_f32 v238, v10, v162
    v_fmac_f32 v242, v3, v147
    v_fmac_f32 v238, v11, v163
    v_fmac_f32 v242, v4, v148
    v_fmac_f32 v238, v12, v164
    v_fmac_f32 v242, v5, v149
    v_fmac_f32 v238, v13, v165
    v_fmac_f32 v242, v6, v150
    v_fmac_f32 v238, v14, v166
    v_fmac_f32 v242, v7, v151
    v_fmac_f32 v238, v15, v167
    v_fmac_f32 v236, v16, v112
    v_mul_f32 v244, v24, v160
    v_fmac_f32 v236, v17, v113
    v_fmac_f32 v244, v25, v161
    v_fmac_f32 v236, v18, v114
    v_fmac_f32 v244, v26, v162
    v_fmac_f32 v236, v19, v115
    v_fmac_f32 v244, v27, v163
    v_fmac_f32 v236, v20, v116
    v_fmac_f32 v244, v28, v164
    v_fmac_f32 v236, v21, v117
    v_fmac_f32 v244, v29, v165
    v_fmac_f32 v236, v22, v118
    v_fmac_f32 v244, v30, v166
    v_fmac_f32 v236, v23, v119
    v_fmac_f32 v244, v31, v167
    v_mul_f32 v243, v32, v152
    v_fma_f32 v239, v40, v168, -v239
    v_fmac_f32 v243, v33, v153
    v_fmac_f32 v239, v41, v169
    v_fmac_f32 v243, v34, v154
    v_fmac_f32 v239, v42, v170
    v_fmac_f32 v243, v35, v155
    v_fmac_f32 v239, v43, v171
    v_fmac_f32 v243, v36, v156
    v_fmac_f32 v239, v44, v172
    v_fmac_f32 v243, v37, v157
    v_fmac_f32 v239, v45, v173
    v_fmac_f32 v243, v38, v158
    v_fmac_f32 v239, v46, v174
    v_fmac_f32 v243, v39, v159
    v_fmac_f32 v239, v47, v175
    v_fmac_f32 v237, v48, v120
    v_mul_f32 v245, v56, v168
    v_fmac_f32 v237, v49, v121
    v_fmac_f32 v245, v57, v169
    v_fmac_f32 v237, v50, v122
    s_setprio 1
    s_waitcnt vmcnt(3) lgkmcnt(1)
    v_mfma_f32_32x32x16_bf16 v[0:15], v[64:67], v[184:187], 0
    ds_read_b64_tr_b16 v[176:177], v246 offset:4096
    ds_read_b64_tr_b16 v[178:179], v246 offset:5120
    ds_read_b64_tr_b16 v[180:181], v247 offset:4096
    ds_read_b64_tr_b16 v[182:183], v247 offset:5120
    v_fmac_f32 v245, v58, v170
    v_fmac_f32 v237, v51, v123
    s_mov_b32 m0, s69
    v_mfma_f32_32x32x16_bf16 v[16:31], v[68:71], v[184:187], 0
    buffer_load_dwordx4 v224, s[4:7], s45 offen sc1 lds
    buffer_load_dwordx4 v225, s[72:75], s45 offen offset:1024 sc1 lds
    s_waitcnt lgkmcnt(4)
    v_mad_u32_u16 v226, v226, s39, v248 op_sel:[1,0,0,0]
    v_mad_u32_u16 v227, v227, s39, v248 op_sel:[1,0,0,0]
    v_fmac_f32 v245, v59, v171
    v_fmac_f32 v237, v52, v124
    v_mfma_f32_32x32x16_bf16 v[32:47], v[64:67], v[188:191], 0
    v_fmac_f32 v245, v60, v172
    v_fmac_f32 v237, v53, v125
    v_fmac_f32 v245, v61, v173
    v_fmac_f32 v237, v54, v126
    v_fmac_f32 v245, v62, v174
    v_fmac_f32 v237, v55, v127
    v_fmac_f32 v245, v63, v175
    v_mfma_f32_32x32x16_bf16 v[48:63], v[68:71], v[188:191], 0
    v_permlane32_swap_b32 v242, v234
    v_permlane32_swap_b32 v243, v235
    v_add_f32 v242, v242, v234
    v_add_f32 v243, v243, v235
    s_waitcnt vmcnt(4) lgkmcnt(0)
    v_mfma_f32_32x32x16_bf16 v[0:15], v[72:75], v[176:179], v[0:15]
    ds_read_b64_tr_b16 v[184:185], v246 offset:6144
    ds_read_b64_tr_b16 v[188:189], v247 offset:6144
    v_cvt_pk_bf16_f32 v242, v242, v243
    ds_write_b32 v230, v242 offset:512
    s_mov_b32 s32, s31
    s_mov_b32 s31, s35
    s_mov_b32 m0, s70
    v_mfma_f32_32x32x16_bf16 v[16:31], v[76:79], v[176:179], v[16:31]
    buffer_load_dwordx4 v226, s[4:7], s46 offen sc1 lds
    buffer_load_dwordx4 v227, s[72:75], s46 offen offset:1024 sc1 lds
    s_sub_u32 s26, s48, s29
    s_mov_b32 s29, s48
    s_mov_b32 s30, s3
    s_bfe_u32 s56, s3, 0x40012
    v_mfma_f32_32x32x16_bf16 v[32:47], v[72:75], v[180:183], v[32:47]
    s_cmp_lg_u32 s36, 0
    s_cselect_b32 s56, s56, 0
    v_mfma_f32_32x32x16_bf16 v[48:63], v[76:79], v[180:183], v[48:63]
    s_waitcnt vmcnt(4) lgkmcnt(1)
    v_mfma_f32_32x32x8_bf16 v[0:15], v[80:81], v[184:185], v[0:15]
    ds_read_b64_tr_b16 v[176:177], v246 offset:0
    ds_read_b64_tr_b16 v[178:179], v246 offset:1024
    ds_read_b64_tr_b16 v[180:181], v247 offset:0
    ds_read_b64_tr_b16 v[182:183], v247 offset:1024
    s_mov_b32 m0, s71
    v_mfma_f32_32x32x8_bf16 v[16:31], v[84:85], v[184:185], v[16:31]
    s_cmp_eq_u32 s33, 4
    s_cbranch_scc1 K2_g4_71
    buffer_load_dwordx4 v224, s[4:7], s47 offen sc1 lds
    buffer_load_dwordx4 v225, s[72:75], s47 offen offset:1024 sc1 lds
K2_back_72:
    v_mfma_f32_32x32x8_bf16 v[32:47], v[80:81], v[188:189], v[32:47]
    s_nop 0
    v_mul_f32 v242, v0, v144
    v_fma_f32 v240, v8, v160, -v240
    v_fmac_f32 v242, v1, v145
    v_fmac_f32 v240, v9, v161
    v_fmac_f32 v242, v2, v146
    v_fmac_f32 v240, v10, v162
    v_fmac_f32 v242, v3, v147
    v_mfma_f32_32x32x8_bf16 v[48:63], v[84:85], v[188:189], v[48:63]
    s_setprio 0
    v_fmac_f32 v240, v11, v163
    v_fmac_f32 v242, v4, v148
    v_fmac_f32 v240, v12, v164
    v_fmac_f32 v242, v5, v149
    v_fmac_f32 v240, v13, v165
    v_fmac_f32 v242, v6, v150
    v_fmac_f32 v240, v14, v166
    v_fmac_f32 v242, v7, v151
    v_fmac_f32 v240, v15, v167
    v_add_u32 v249, s26, v249
    v_add_u32 v250, s26, v250
    v_fma_f32 v244, v16, v160, -v244
    v_fmac_f32 v236, v24, v112
    v_fmac_f32 v244, v17, v161
    v_fmac_f32 v236, v25, v113
    v_fmac_f32 v244, v18, v162
    v_fmac_f32 v236, v26, v114
    v_fmac_f32 v244, v19, v163
    v_fmac_f32 v236, v27, v115
    v_fmac_f32 v244, v20, v164
    v_fmac_f32 v236, v28, v116
    v_fmac_f32 v244, v21, v165
    v_fmac_f32 v236, v29, v117
    v_fmac_f32 v244, v22, v166
    v_fmac_f32 v236, v30, v118
    v_fmac_f32 v244, v23, v167
    v_fmac_f32 v236, v31, v119
    ds_read_b64_tr_b16 v[0:1], v249 offset:0
    ds_read_b64_tr_b16 v[2:3], v249 offset:32
    ds_read_u16_d16_hi v16, v250 offset:0
    v_mul_f32 v243, v32, v152
    v_fma_f32 v241, v40, v168, -v241
    v_fmac_f32 v243, v33, v153
    v_fmac_f32 v241, v41, v169
    v_fmac_f32 v243, v34, v154
    v_fmac_f32 v241, v42, v170
    v_fmac_f32 v243, v35, v155
    v_fmac_f32 v241, v43, v171
    v_fmac_f32 v243, v36, v156
    v_fmac_f32 v241, v44, v172
    v_fmac_f32 v243, v37, v157
    v_fmac_f32 v241, v45, v173
    v_fmac_f32 v243, v38, v158
    v_fmac_f32 v241, v46, v174
    v_fmac_f32 v243, v39, v159
    v_fmac_f32 v241, v47, v175
    ds_read_b64_tr_b16 v[4:5], v249 offset:512
    ds_read_b64_tr_b16 v[6:7], v249 offset:544
    ds_read_u16_d16_hi v17, v250 offset:128
    v_fma_f32 v245, v48, v168, -v245
    v_fmac_f32 v237, v56, v120
    v_fmac_f32 v245, v49, v169
    v_fmac_f32 v237, v57, v121
    v_fmac_f32 v245, v50, v170
    v_fmac_f32 v237, v58, v122
    v_fmac_f32 v245, v51, v171
    v_fmac_f32 v237, v59, v123
    v_fmac_f32 v245, v52, v172
    v_fmac_f32 v237, v60, v124
    v_fmac_f32 v245, v53, v173
    v_fmac_f32 v237, v61, v125
    v_fmac_f32 v245, v54, v174
    v_fmac_f32 v237, v62, v126
    v_fmac_f32 v245, v55, v175
    v_fmac_f32 v237, v63, v127
    s_cmp_eq_u32 s56, 5
    s_cbranch_scc1 K2_U21
    s_cmp_eq_u32 s56, 6
    s_cbranch_scc1 K2_U3h1
    s_branch K2_DSP1
K2_U31:
    s_setprio 1
    ds_read_b64_tr_b16 v[8:9], v249 offset:1024
    ds_read_b64_tr_b16 v[10:11], v249 offset:1056
    ds_read_u16_d16_hi v18, v250 offset:256
    s_waitcnt lgkmcnt(3)
    v_lshlrev_b32 v20, 16, v0
    v_and_b32 v21, 0xffff0000, v0
    v_lshlrev_b32 v22, 16, v1
    v_and_b32 v23, 0xffff0000, v1
    v_lshlrev_b32 v24, 16, v2
    v_and_b32 v25, 0xffff0000, v2
    v_lshlrev_b32 v26, 16, v3
    v_and_b32 v27, 0xffff0000, v3
    v_mul_f32_dpp v36, v16, v20 row_newbcast:8 row_mask:0xf bank_mask:0xf
    v_mul_f32_dpp v37, v16, v21 row_newbcast:9 row_mask:0xf bank_mask:0xf
    v_mul_f32_dpp v38, v16, v22 row_newbcast:10 row_mask:0xf bank_mask:0xf
    v_mul_f32_dpp v39, v16, v23 row_newbcast:11 row_mask:0xf bank_mask:0xf
    v_mul_f32_dpp v40, v16, v24 row_newbcast:12 row_mask:0xf bank_mask:0xf
    v_mul_f32_dpp v41, v16, v25 row_newbcast:13 row_mask:0xf bank_mask:0xf
    v_mul_f32_dpp v42, v16, v26 row_newbcast:14 row_mask:0xf bank_mask:0xf
    v_mul_f32_dpp v43, v16, v27 row_newbcast:15 row_mask:0xf bank_mask:0xf
    v_cvt_pk_bf16_f32 v68, v36, v37
    v_cvt_pk_bf16_f32 v69, v38, v39
    v_cvt_pk_bf16_f32 v70, v40, v41
    v_cvt_pk_bf16_f32 v71, v42, v43
    v_mul_f32_dpp v20, v16, v20 row_newbcast:0 row_mask:0xa bank_mask:0xf
    v_mul_f32_dpp v21, v16, v21 row_newbcast:1 row_mask:0xa bank_mask:0xf
    v_mul_f32_dpp v22, v16, v22 row_newbcast:2 row_mask:0xa bank_mask:0xf
    v_mul_f32_dpp v23, v16, v23 row_newbcast:3 row_mask:0xa bank_mask:0xf
    v_mul_f32_dpp v24, v16, v24 row_newbcast:4 row_mask:0xa bank_mask:0xf
    v_mul_f32_dpp v25, v16, v25 row_newbcast:5 row_mask:0xa bank_mask:0xf
    v_mul_f32_dpp v26, v16, v26 row_newbcast:6 row_mask:0xa bank_mask:0xf
    v_mul_f32_dpp v27, v16, v27 row_newbcast:7 row_mask:0xa bank_mask:0xf
    v_cvt_pk_bf16_f32 v64, v20, v21
    v_cvt_pk_bf16_f32 v65, v22, v23
    v_cvt_pk_bf16_f32 v66, v24, v25
    v_cvt_pk_bf16_f32 v67, v26, v27
    v_lshlrev_b32 v28, 16, v4
    v_and_b32 v29, 0xffff0000, v4
    v_lshlrev_b32 v30, 16, v5
    v_and_b32 v31, 0xffff0000, v5
    v_lshlrev_b32 v32, 16, v6
    v_and_b32 v33, 0xffff0000, v6
    v_lshlrev_b32 v34, 16, v7
    v_and_b32 v35, 0xffff0000, v7
    v_mul_f32_dpp v36, v17, v28 row_newbcast:8 row_mask:0xf bank_mask:0xf
    v_mul_f32_dpp v37, v17, v29 row_newbcast:9 row_mask:0xf bank_mask:0xf
    v_mul_f32_dpp v38, v17, v30 row_newbcast:10 row_mask:0xf bank_mask:0xf
    v_mul_f32_dpp v39, v17, v31 row_newbcast:11 row_mask:0xf bank_mask:0xf
    v_mul_f32_dpp v40, v17, v32 row_newbcast:12 row_mask:0xf bank_mask:0xf
    v_mul_f32_dpp v41, v17, v33 row_newbcast:13 row_mask:0xf bank_mask:0xf
    v_mul_f32_dpp v42, v17, v34 row_newbcast:14 row_mask:0xf bank_mask:0xf
    v_mul_f32_dpp v43, v17, v35 row_newbcast:15 row_mask:0xf bank_mask:0xf
    v_cvt_pk_bf16_f32 v76, v36, v37
    v_cvt_pk_bf16_f32 v77, v38, v39
    v_cvt_pk_bf16_f32 v78, v40, v41
    v_cvt_pk_bf16_f32 v79, v42, v43
    v_mul_f32_dpp v28, v17, v28 row_newbcast:0 row_mask:0xa bank_mask:0xf
    v_mul_f32_dpp v29, v17, v29 row_newbcast:1 row_mask:0xa bank_mask:0xf
    v_mul_f32_dpp v30, v17, v30 row_newbcast:2 row_mask:0xa bank_mask:0xf
    v_mul_f32_dpp v31, v17, v31 row_newbcast:3 row_mask:0xa bank_mask:0xf
    v_mul_f32_dpp v32, v17, v32 row_newbcast:4 row_mask:0xa bank_mask:0xf
    v_mul_f32_dpp v33, v17, v33 row_newbcast:5 row_mask:0xa bank_mask:0xf
    v_mul_f32_dpp v34, v17, v34 row_newbcast:6 row_mask:0xa bank_mask:0xf
    v_mul_f32_dpp v35, v17, v35 row_newbcast:7 row_mask:0xa bank_mask:0xf
    v_cvt_pk_bf16_f32 v72, v28, v29
    v_cvt_pk_bf16_f32 v73, v30, v31
    v_cvt_pk_bf16_f32 v74, v32, v33
    v_cvt_pk_bf16_f32 v75, v34, v35
    s_waitcnt lgkmcnt(0)
    v_lshlrev_b32 v20, 16, v8
    v_and_b32 v21, 0xffff0000, v8
    v_lshlrev_b32 v22, 16, v9
    v_and_b32 v23, 0xffff0000, v9
    v_lshlrev_b32 v24, 16, v10
    v_and_b32 v25, 0xffff0000, v10
    v_lshlrev_b32 v26, 16, v11
    v_and_b32 v27, 0xffff0000, v11
    v_mul_f32_dpp v36, v18, v20 row_newbcast:8 row_mask:0xf bank_mask:0xf
    v_mul_f32_dpp v37, v18, v21 row_newbcast:9 row_mask:0xf bank_mask:0xf
    v_mul_f32_dpp v38, v18, v22 row_newbcast:10 row_mask:0xf bank_mask:0xf
    v_mul_f32_dpp v39, v18, v23 row_newbcast:11 row_mask:0xf bank_mask:0xf
    v_mul_f32_dpp v40, v18, v24 row_newbcast:12 row_mask:0xf bank_mask:0xf
    v_mul_f32_dpp v41, v18, v25 row_newbcast:13 row_mask:0xf bank_mask:0xf
    v_mul_f32_dpp v42, v18, v26 row_newbcast:14 row_mask:0xf bank_mask:0xf
    v_mul_f32_dpp v43, v18, v27 row_newbcast:15 row_mask:0xf bank_mask:0xf
    v_cvt_pk_bf16_f32 v84, v36, v37
    v_cvt_pk_bf16_f32 v85, v38, v39
    v_cvt_pk_bf16_f32 v86, v40, v41
    v_cvt_pk_bf16_f32 v87, v42, v43
    v_mul_f32_dpp v20, v18, v20 row_newbcast:0 row_mask:0xa bank_mask:0xf
    v_mul_f32_dpp v21, v18, v21 row_newbcast:1 row_mask:0xa bank_mask:0xf
    v_mul_f32_dpp v22, v18, v22 row_newbcast:2 row_mask:0xa bank_mask:0xf
    v_mul_f32_dpp v23, v18, v23 row_newbcast:3 row_mask:0xa bank_mask:0xf
    v_mul_f32_dpp v24, v18, v24 row_newbcast:4 row_mask:0xa bank_mask:0xf
    v_mul_f32_dpp v25, v18, v25 row_newbcast:5 row_mask:0xa bank_mask:0xf
    v_mul_f32_dpp v26, v18, v26 row_newbcast:6 row_mask:0xa bank_mask:0xf
    v_mul_f32_dpp v27, v18, v27 row_newbcast:7 row_mask:0xa bank_mask:0xf
    v_cvt_pk_bf16_f32 v80, v20, v21
    v_cvt_pk_bf16_f32 v81, v22, v23
    v_cvt_pk_bf16_f32 v82, v24, v25
    v_cvt_pk_bf16_f32 v83, v26, v27
    s_waitcnt vmcnt(4)
    v_mfma_f32_32x32x16_bf16 v[0:15], v[64:67], v[176:179], 0
    ds_read_b64_tr_b16 v[184:185], v246 offset:2048
    ds_read_b64_tr_b16 v[186:187], v246 offset:3072
    ds_read_b64_tr_b16 v[188:189], v247 offset:2048
    ds_read_b64_tr_b16 v[190:191], v247 offset:3072
    s_mov_b32 m0, s68
    v_mfma_f32_32x32x16_bf16 v[16:31], v[68:71], v[176:179], 0
    buffer_load_dwordx4 v222, s[4:7], s41 offen sc1 lds
    buffer_load_dwordx4 v223, s[72:75], s41 offen offset:1024 sc1 lds
    v_permlane32_swap_b32 v242, v236
    v_permlane32_swap_b32 v243, v237
    v_mfma_f32_32x32x16_bf16 v[32:47], v[64:67], v[180:183], 0
    v_permlane32_swap_b32 v244, v238
    v_permlane32_swap_b32 v245, v239
    v_permlane32_swap_b32 v240, v241
    v_add_f32 v242, v242, v236
    v_mfma_f32_32x32x16_bf16 v[48:63], v[68:71], v[180:183], 0
    v_add_f32 v243, v243, v237
    v_add_f32 v244, v244, v238
    v_add_f32 v245, v245, v239
    v_add_f32 v240, -v240, -v241
    v_sub_u32 v241, v230, v231
    v_cvt_pk_bf16_f32 v242, v242, v243
    s_mov_b64 exec, 0x1ff
    ds_add_rtn_u32 v232, v254, v255
    s_mov_b64 exec, -1
    s_waitcnt vmcnt(4) lgkmcnt(1)
    v_mfma_f32_32x32x16_bf16 v[0:15], v[72:75], v[184:187], v[0:15]
    ds_read_b64_tr_b16 v[176:177], v246 offset:4096
    ds_read_b64_tr_b16 v[178:179], v246 offset:5120
    ds_read_b64_tr_b16 v[180:181], v247 offset:4096
    ds_read_b64_tr_b16 v[182:183], v247 offset:5120
    v_cvt_pk_bf16_f32 v244, v244, v245
    v_cvt_pk_bf16_f32 v240, v240, v240
    s_mov_b32 m0, s69
    v_mfma_f32_32x32x16_bf16 v[16:31], v[76:79], v[184:187], v[16:31]
    buffer_load_dwordx4 v226, s[4:7], s41 offen sc1 lds
    buffer_load_dwordx4 v227, s[72:75], s41 offen offset:1024 sc1 lds
    ds_write2st64_b32 v230, v242, v244 offset0:3 offset1:4
    ds_write_b16 v241, v240 offset:1280
    s_waitcnt lgkmcnt(6)
    v_readlane_b32 s58, v232, 8
    v_mfma_f32_32x32x16_bf16 v[32:47], v[72:75], v[188:191], v[32:47]
    s_cmp_lt_u32 s58, s22
    s_cbranch_scc0 K2_nul_73
    s_nop 0
    v_readlane_b32 s3, v253, s58
    s_nop 0
    s_bfe_u32 s58, s3, 0x60016
    s_and_b32 s59, s58, 7
    s_lshr_b32 s60, s58, 3
K2_chk_75:
    v_readlane_b32 s61, v232, s59
    s_nop 0
    s_cmp_gt_u32 s61, s60
    s_cbranch_scc0 K2_spin_74
K2_back_76:
    v_mfma_f32_32x32x16_bf16 v[48:63], v[76:79], v[188:191], v[48:63]
    s_lshl_b32 s44, s34, 7
    s_and_b32 s48, s3, 0x3ffff
    s_bfe_u32 s33, s3, 0x30013
    s_mov_b32 s35, s48
    s_mov_b32 s45, s44
    s_xor_b32 s47, s44, 256
    s_waitcnt vmcnt(4) lgkmcnt(2)
    v_mfma_f32_32x32x16_bf16 v[0:15], v[80:83], v[176:179], v[0:15]
    ds_read_b64_tr_b16 v[184:185], v246 offset:6144
    ds_read_b64_tr_b16 v[186:187], v246 offset:7168
    ds_read_b64_tr_b16 v[188:189], v247 offset:6144
    ds_read_b64_tr_b16 v[190:191], v247 offset:7168
    s_add_u32 s49, s48, 128
    s_add_u32 s60, s48, 256
    s_mov_b32 m0, s70
    v_mfma_f32_32x32x16_bf16 v[16:31], v[84:87], v[176:179], v[16:31]
    buffer_load_dwordx4 v222, s[4:7], s42 offen sc1 lds
    buffer_load_dwordx4 v223, s[72:75], s42 offen offset:1024 sc1 lds
    s_cmp_eq_u32 s33, 3
    s_cselect_b32 s46, s44, s47
    s_cselect_b32 s50, s60, s48
    v_mfma_f32_32x32x16_bf16 v[32:47], v[80:83], v[180:183], v[32:47]
    s_sub_u32 s60, s33, 2
    s_cmp_lt_u32 s60, 2
    s_cbranch_scc0 K2_rare_77
K2_back_78:
    v_mul_f32 v234, v0, v96
    v_mul_f32 v236, v8, v128
    v_fmac_f32 v234, v1, v97
    v_fmac_f32 v236, v9, v129
    v_mfma_f32_32x32x16_bf16 v[48:63], v[84:87], v[180:183], v[48:63]
    s_setprio 0
    v_fmac_f32 v234, v2, v98
    v_fmac_f32 v236, v10, v130
    v_fmac_f32 v234, v3, v99
    v_fmac_f32 v236, v11, v131
    v_fmac_f32 v234, v4, v100
    v_fmac_f32 v236, v12, v132
    v_fmac_f32 v234, v5, v101
    v_fmac_f32 v236, v13, v133
    v_fmac_f32 v234, v6, v102
    v_fmac_f32 v236, v14, v134
    v_fmac_f32 v234, v7, v103
    v_fmac_f32 v236, v15, v135
    v_mul_f32 v238, v16, v128
    v_mul_f32 v240, v24, v128
    v_fmac_f32 v238, v17, v129
    v_fmac_f32 v240, v25, v129
    v_fmac_f32 v238, v18, v130
    v_fmac_f32 v240, v26, v130
    v_fmac_f32 v238, v19, v131
    v_fmac_f32 v240, v27, v131
    v_fmac_f32 v238, v20, v132
    v_fmac_f32 v240, v28, v132
    v_fmac_f32 v238, v21, v133
    v_fmac_f32 v240, v29, v133
    v_fmac_f32 v238, v22, v134
    v_fmac_f32 v240, v30, v134
    v_fmac_f32 v238, v23, v135
    v_fmac_f32 v240, v31, v135
    v_mul_f32 v235, v32, v104
    v_mul_f32 v237, v40, v136
    v_fmac_f32 v235, v33, v105
    v_fmac_f32 v237, v41, v137
    v_fmac_f32 v235, v34, v106
    v_fmac_f32 v237, v42, v138
    v_fmac_f32 v235, v35, v107
    v_fmac_f32 v237, v43, v139
    v_fmac_f32 v235, v36, v108
    v_fmac_f32 v237, v44, v140
    v_fmac_f32 v235, v37, v109
    v_fmac_f32 v237, v45, v141
    v_fmac_f32 v235, v38, v110
    v_fmac_f32 v237, v46, v142
    v_fmac_f32 v235, v39, v111
    v_fmac_f32 v237, v47, v143
    v_mul_f32 v239, v48, v136
    v_mul_f32 v241, v56, v136
    s_setprio 1
    s_waitcnt vmcnt(4) lgkmcnt(0)
    v_mfma_f32_32x32x16_bf16 v[0:15], v[72:75], v[184:187], 0
    ds_read_b64_tr_b16 v[176:177], v246 offset:0
    ds_read_b64_tr_b16 v[178:179], v246 offset:1024
    ds_read_b64_tr_b16 v[180:181], v247 offset:0
    ds_read_b64_tr_b16 v[182:183], v247 offset:1024
    v_fmac_f32 v239, v49, v137
    v_fmac_f32 v241, v57, v137
    s_mov_b32 m0, s71
    v_mfma_f32_32x32x16_bf16 v[16:31], v[76:79], v[184:187], 0
    buffer_load_dwordx4 v224, s[4:7], s42 offen sc1 lds
    buffer_load_dwordx4 v225, s[72:75], s42 offen offset:1024 sc1 lds
    v_fmac_f32 v239, v50, v138
    v_fmac_f32 v241, v58, v138
    v_fmac_f32 v239, v51, v139
    v_fmac_f32 v241, v59, v139
    v_fmac_f32 v239, v52, v140
    v_mfma_f32_32x32x16_bf16 v[32:47], v[72:75], v[188:191], 0
    v_fmac_f32 v241, v60, v140
    v_fmac_f32 v239, v53, v141
    v_fmac_f32 v241, v61, v141
    v_fmac_f32 v239, v54, v142
    v_fmac_f32 v241, v62, v142
    v_fmac_f32 v239, v55, v143
    v_fmac_f32 v241, v63, v143
    v_mfma_f32_32x32x16_bf16 v[48:63], v[76:79], v[188:191], 0
    v_permlane32_swap_b32 v234, v236
    v_permlane32_swap_b32 v235, v237
    v_permlane32_swap_b32 v240, v238
    s_waitcnt vmcnt(4) lgkmcnt(0)
    v_mfma_f32_32x32x16_bf16 v[0:15], v[64:67], v[176:179], v[0:15]
    ds_read_b64_tr_b16 v[184:185], v246 offset:2048
    ds_read_b64_tr_b16 v[186:187], v246 offset:3072
    ds_read_b64_tr_b16 v[188:189], v247 offset:2048
    ds_read_b64_tr_b16 v[190:191], v247 offset:3072
    v_permlane32_swap_b32 v241, v239
    s_mov_b32 m0, s68
    v_mfma_f32_32x32x16_bf16 v[16:31], v[68:71], v[176:179], v[16:31]
    buffer_load_dwordx4 v226, s[4:7], s42 offen sc1 lds
    buffer_load_dwordx4 v227, s[72:75], s42 offen offset:1024 sc1 lds
    v_lshl_add_u32 v230, v252, 1, s31
    v_add_f32 v234, v234, v236
    v_add_f32 v235, v235, v237
    v_add_f32 v240, v240, v238
    v_add_f32 v241, v241, v239
    v_mfma_f32_32x32x16_bf16 v[32:47], v[64:67], v[180:183], v[32:47]
    v_cvt_pk_bf16_f32 v234, v234, v235
    v_cvt_pk_bf16_f32 v240, v240, v241
    ds_write2st64_b32 v230, v234, v240 offset0:0 offset1:1
    v_mfma_f32_32x32x16_bf16 v[48:63], v[68:71], v[180:183], v[48:63]
    s_waitcnt vmcnt(4) lgkmcnt(1)
    v_mfma_f32_32x32x16_bf16 v[0:15], v[80:83], v[184:187], v[0:15]
    ds_read_b64_tr_b16 v[176:177], v246 offset:4096
    ds_read_b64_tr_b16 v[178:179], v246 offset:5120
    ds_read_b64_tr_b16 v[180:181], v247 offset:4096
    ds_read_b64_tr_b16 v[182:183], v247 offset:5120
    s_mov_b32 m0, s69
    v_mfma_f32_32x32x16_bf16 v[16:31], v[84:87], v[184:187], v[16:31]
    buffer_load_dwordx4 v222, s[4:7], s43 offen sc1 lds
    buffer_load_dwordx4 v223, s[72:75], s43 offen offset:1024 sc1 lds
    v_mfma_f32_32x32x16_bf16 v[32:47], v[80:83], v[188:191], v[32:47]
    s_nop 2
    v_mul_f32 v234, v0, v144
    v_mul_f32 v236, v8, v112
    v_fmac_f32 v234, v1, v145
    v_fmac_f32 v236, v9, v113
    v_fmac_f32 v234, v2, v146
    v_fmac_f32 v236, v10, v114
    v_fmac_f32 v234, v3, v147
    v_mfma_f32_32x32x16_bf16 v[48:63], v[84:87], v[188:191], v[48:63]
    s_setprio 0
    v_fmac_f32 v236, v11, v115
    v_fmac_f32 v234, v4, v148
    v_fmac_f32 v236, v12, v116
    v_fmac_f32 v234, v5, v149
    v_fmac_f32 v236, v13, v117
    v_fmac_f32 v234, v6, v150
    v_fmac_f32 v236, v14, v118
    v_fmac_f32 v234, v7, v151
    v_fmac_f32 v236, v15, v119
    v_mul_f32 v238, v16, v160
    v_mul_f32 v240, v24, v160
    v_fmac_f32 v238, v17, v161
    v_fmac_f32 v240, v25, v161
    v_fmac_f32 v238, v18, v162
    v_fmac_f32 v240, v26, v162
    v_fmac_f32 v238, v19, v163
    v_fmac_f32 v240, v27, v163
    v_fmac_f32 v238, v20, v164
    v_fmac_f32 v240, v28, v164
    v_fmac_f32 v238, v21, v165
    v_fmac_f32 v240, v29, v165
    v_fmac_f32 v238, v22, v166
    v_fmac_f32 v240, v30, v166
    v_fmac_f32 v238, v23, v167
    v_fmac_f32 v240, v31, v167
    v_mul_f32 v235, v32, v152
    v_mul_f32 v237, v40, v120
    v_fmac_f32 v235, v33, v153
    v_fmac_f32 v237, v41, v121
    v_fmac_f32 v235, v34, v154
    v_fmac_f32 v237, v42, v122
    v_fmac_f32 v235, v35, v155
    v_fmac_f32 v237, v43, v123
    v_fmac_f32 v235, v36, v156
    v_fmac_f32 v237, v44, v124
    v_fmac_f32 v235, v37, v157
    v_fmac_f32 v237, v45, v125
    v_fmac_f32 v235, v38, v158
    v_fmac_f32 v237, v46, v126
    v_fmac_f32 v235, v39, v159
    v_fmac_f32 v237, v47, v127
    v_mul_f32 v239, v48, v168
    v_mul_f32 v241, v56, v168
    v_fmac_f32 v239, v49, v169
    v_fmac_f32 v241, v57, v169
    s_setprio 1
    s_waitcnt vmcnt(4) lgkmcnt(0)
    v_mfma_f32_32x32x16_bf16 v[0:15], v[64:67], v[176:179], 0
    ds_read_b64_tr_b16 v[184:185], v246 offset:6144
    ds_read_b64_tr_b16 v[186:187], v246 offset:7168
    ds_read_b64_tr_b16 v[188:189], v247 offset:6144
    ds_read_b64_tr_b16 v[190:191], v247 offset:7168
    v_fmac_f32 v239, v50, v170
    v_fmac_f32 v241, v58, v170
    s_mov_b32 m0, s70
    v_mfma_f32_32x32x16_bf16 v[16:31], v[68:71], v[176:179], 0
    buffer_load_dwordx4 v224, s[4:7], s43 offen sc1 lds
    buffer_load_dwordx4 v225, s[72:75], s43 offen offset:1024 sc1 lds
    v_fmac_f32 v239, v51, v171
    v_fmac_f32 v241, v59, v171
    v_fmac_f32 v239, v52, v172
    v_fmac_f32 v241, v60, v172
    v_fmac_f32 v239, v53, v173
    v_mfma_f32_32x32x16_bf16 v[32:47], v[64:67], v[180:183], 0
    v_add_u32 v222, s48, v251
    ds_read2_b32 v[222:223], v222 offset0:1 offset1:3
    v_fmac_f32 v241, v61, v173
    v_fmac_f32 v239, v54, v174
    v_fmac_f32 v241, v62, v174
    v_fmac_f32 v239, v55, v175
    v_fmac_f32 v241, v63, v175
    v_mfma_f32_32x32x16_bf16 v[48:63], v[68:71], v[180:183], 0
    s_waitcnt vmcnt(4) lgkmcnt(1)
    v_mfma_f32_32x32x16_bf16 v[0:15], v[72:75], v[184:187], v[0:15]
    ds_read_b64_tr_b16 v[176:177], v246 offset:0
    ds_read_b64_tr_b16 v[178:179], v246 offset:1024
    ds_read_b64_tr_b16 v[180:181], v247 offset:0
    ds_read_b64_tr_b16 v[182:183], v247 offset:1024
    s_mov_b32 m0, s71
    v_mfma_f32_32x32x16_bf16 v[16:31], v[76:79], v[184:187], v[16:31]
    buffer_load_dwordx4 v226, s[4:7], s43 offen sc1 lds
    buffer_load_dwordx4 v227, s[72:75], s43 offen offset:1024 sc1 lds
    s_waitcnt lgkmcnt(4)
    v_mad_u32_u16 v222, v222, s39, v248 op_sel:[1,0,0,0]
    v_mad_u32_u16 v223, v223, s39, v248 op_sel:[1,0,0,0]
    v_mfma_f32_32x32x16_bf16 v[32:47], v[72:75], v[188:191], v[32:47]
    v_add_u32 v224, s49, v251
    ds_read2_b32 v[224:225], v224 offset0:1 offset1:3
    v_mfma_f32_32x32x16_bf16 v[48:63], v[76:79], v[188:191], v[48:63]
    s_waitcnt vmcnt(4) lgkmcnt(1)
    v_mfma_f32_32x32x16_bf16 v[0:15], v[80:83], v[176:179], v[0:15]
    ds_read_b64_tr_b16 v[184:185], v246 offset:2048
    ds_read_b64_tr_b16 v[186:187], v246 offset:3072
    ds_read_b64_tr_b16 v[188:189], v247 offset:2048
    ds_read_b64_tr_b16 v[190:191], v247 offset:3072
    s_mov_b32 m0, s68
    v_mfma_f32_32x32x16_bf16 v[16:31], v[84:87], v[176:179], v[16:31]
    buffer_load_dwordx4 v222, s[4:7], s44 offen sc1 lds
    buffer_load_dwordx4 v223, s[72:75], s44 offen offset:1024 sc1 lds
    s_waitcnt lgkmcnt(4)
    v_mad_u32_u16 v224, v224, s39, v248 op_sel:[1,0,0,0]
    v_mad_u32_u16 v225, v225, s39, v248 op_sel:[1,0,0,0]
    v_mfma_f32_32x32x16_bf16 v[32:47], v[80:83], v[180:183], v[32:47]
    v_add_u32 v226, s50, v251
    ds_read2_b32 v[226:227], v226 offset0:1 offset1:3
    v_mul_f32 v242, v0, v144
    v_fma_f32 v238, v8, v160, -v238
    v_fmac_f32 v242, v1, v145
    v_fmac_f32 v238, v9, v161
    v_fmac_f32 v242, v2, v146
    v_mfma_f32_32x32x16_bf16 v[48:63], v[84:87], v[180:183], v[48:63]
    s_setprio 0
    v_fmac_f32 v238, v10, v162
    v_fmac_f32 v242, v3, v147
    v_fmac_f32 v238, v11, v163
    v_fmac_f32 v242, v4, v148
    v_fmac_f32 v238, v12, v164
    v_fmac_f32 v242, v5, v149
    v_fmac_f32 v238, v13, v165
    v_fmac_f32 v242, v6, v150
    v_fmac_f32 v238, v14, v166
    v_fmac_f32 v242, v7, v151
    v_fmac_f32 v238, v15, v167
    v_fmac_f32 v236, v16, v112
    v_mul_f32 v244, v24, v160
    v_fmac_f32 v236, v17, v113
    v_fmac_f32 v244, v25, v161
    v_fmac_f32 v236, v18, v114
    v_fmac_f32 v244, v26, v162
    v_fmac_f32 v236, v19, v115
    v_fmac_f32 v244, v27, v163
    v_fmac_f32 v236, v20, v116
    v_fmac_f32 v244, v28, v164
    v_fmac_f32 v236, v21, v117
    v_fmac_f32 v244, v29, v165
    v_fmac_f32 v236, v22, v118
    v_fmac_f32 v244, v30, v166
    v_fmac_f32 v236, v23, v119
    v_fmac_f32 v244, v31, v167
    v_mul_f32 v243, v32, v152
    v_fma_f32 v239, v40, v168, -v239
    v_fmac_f32 v243, v33, v153
    v_fmac_f32 v239, v41, v169
    v_fmac_f32 v243, v34, v154
    v_fmac_f32 v239, v42, v170
    v_fmac_f32 v243, v35, v155
    v_fmac_f32 v239, v43, v171
    v_fmac_f32 v243, v36, v156
    v_fmac_f32 v239, v44, v172
    v_fmac_f32 v243, v37, v157
    v_fmac_f32 v239, v45, v173
    v_fmac_f32 v243, v38, v158
    v_fmac_f32 v239, v46, v174
    v_fmac_f32 v243, v39, v159
    v_fmac_f32 v239, v47, v175
    v_fmac_f32 v237, v48, v120
    v_mul_f32 v245, v56, v168
    v_fmac_f32 v237, v49, v121
    v_fmac_f32 v245, v57, v169
    v_fmac_f32 v237, v50, v122
    s_setprio 1
    s_waitcnt vmcnt(4) lgkmcnt(1)
    v_mfma_f32_32x32x16_bf16 v[0:15], v[64:67], v[184:187], 0
    ds_read_b64_tr_b16 v[176:177], v246 offset:4096
    ds_read_b64_tr_b16 v[178:179], v246 offset:5120
    ds_read_b64_tr_b16 v[180:181], v247 offset:4096
    ds_read_b64_tr_b16 v[182:183], v247 offset:5120
    v_fmac_f32 v245, v58, v170
    v_fmac_f32 v237, v51, v123
    s_mov_b32 m0, s69
    v_mfma_f32_32x32x16_bf16 v[16:31], v[68:71], v[184:187], 0
    buffer_load_dwordx4 v224, s[4:7], s45 offen sc1 lds
    buffer_load_dwordx4 v225, s[72:75], s45 offen offset:1024 sc1 lds
    s_waitcnt lgkmcnt(4)
    v_mad_u32_u16 v226, v226, s39, v248 op_sel:[1,0,0,0]
    v_mad_u32_u16 v227, v227, s39, v248 op_sel:[1,0,0,0]
    v_fmac_f32 v245, v59, v171
    v_fmac_f32 v237, v52, v124
    v_mfma_f32_32x32x16_bf16 v[32:47], v[64:67], v[188:191], 0
    v_fmac_f32 v245, v60, v172
    v_fmac_f32 v237, v53, v125
    v_fmac_f32 v245, v61, v173
    v_fmac_f32 v237, v54, v126
    v_fmac_f32 v245, v62, v174
    v_fmac_f32 v237, v55, v127
    v_fmac_f32 v245, v63, v175
    v_mfma_f32_32x32x16_bf16 v[48:63], v[68:71], v[188:191], 0
    v_permlane32_swap_b32 v242, v234
    v_permlane32_swap_b32 v243, v235
    v_add_f32 v242, v242, v234
    v_add_f32 v243, v243, v235
    s_waitcnt vmcnt(4) lgkmcnt(0)
    v_mfma_f32_32x32x16_bf16 v[0:15], v[72:75], v[176:179], v[0:15]
    ds_read_b64_tr_b16 v[184:185], v246 offset:6144
    ds_read_b64_tr_b16 v[186:187], v246 offset:7168
    ds_read_b64_tr_b16 v[188:189], v247 offset:6144
    ds_read_b64_tr_b16 v[190:191], v247 offset:7168
    v_cvt_pk_bf16_f32 v242, v242, v243
    ds_write_b32 v230, v242 offset:512
    s_mov_b32 m0, s70
    v_mfma_f32_32x32x16_bf16 v[16:31], v[76:79], v[176:179], v[16:31]
    buffer_load_dwordx4 v226, s[4:7], s46 offen sc1 lds
    buffer_load_dwordx4 v227, s[72:75], s46 offen offset:1024 sc1 lds
    s_sub_u32 s26, s48, s29
    s_mov_b32 s29, s48
    s_mov_b32 s30, s3
    s_bfe_u32 s56, s3, 0x40012
    s_mov_b32 s32, s31
    v_mfma_f32_32x32x16_bf16 v[32:47], v[72:75], v[180:183], v[32:47]
    s_cmp_lg_u32 s36, 0
    s_cselect_b32 s56, s56, 0
    s_mov_b32 s31, s35
    v_mfma_f32_32x32x16_bf16 v[48:63], v[76:79], v[180:183], v[48:63]
    s_waitcnt vmcnt(4) lgkmcnt(1)
    v_mfma_f32_32x32x16_bf16 v[0:15], v[80:83], v[184:187], v[0:15]
    ds_read_b64_tr_b16 v[176:177], v246 offset:0
    ds_read_b64_tr_b16 v[178:179], v246 offset:1024
    ds_read_b64_tr_b16 v[180:181], v247 offset:0
    ds_read_b64_tr_b16 v[182:183], v247 offset:1024
    s_mov_b32 m0, s71
    v_mfma_f32_32x32x16_bf16 v[16:31], v[84:87], v[184:187], v[16:31]
    s_cmp_eq_u32 s33, 4
    s_cbranch_scc1 K2_g4_80
    buffer_load_dwordx4 v224, s[4:7], s47 offen sc1 lds
    buffer_load_dwordx4 v225, s[72:75], s47 offen offset:1024 sc1 lds
K2_back_81:
    v_mfma_f32_32x32x16_bf16 v[32:47], v[80:83], v[188:191], v[32:47]
    s_nop 0
    v_mul_f32 v242, v0, v144
    v_fma_f32 v240, v8, v160, -v240
    v_fmac_f32 v242, v1, v145
    v_fmac_f32 v240, v9, v161
    v_fmac_f32 v242, v2, v146
    v_fmac_f32 v240, v10, v162
    v_fmac_f32 v242, v3, v147
    v_mfma_f32_32x32x16_bf16 v[48:63], v[84:87], v[188:191], v[48:63]
    s_setprio 0
    v_fmac_f32 v240, v11, v163
    v_fmac_f32 v242, v4, v148
    v_fmac_f32 v240, v12, v164
    v_fmac_f32 v242, v5, v149
    v_fmac_f32 v240, v13, v165
    v_fmac_f32 v242, v6, v150
    v_fmac_f32 v240, v14, v166
    v_fmac_f32 v242, v7, v151
    v_fmac_f32 v240, v15, v167
    v_add_u32 v249, s26, v249
    v_add_u32 v250, s26, v250
    v_fma_f32 v244, v16, v160, -v244
    v_fmac_f32 v236, v24, v112
    v_fmac_f32 v244, v17, v161
    v_fmac_f32 v236, v25, v113
    v_fmac_f32 v244, v18, v162
    v_fmac_f32 v236, v26, v114
    v_fmac_f32 v244, v19, v163
    v_fmac_f32 v236, v27, v115
    v_fmac_f32 v244, v20, v164
    v_fmac_f32 v236, v28, v116
    v_fmac_f32 v244, v21, v165
    v_fmac_f32 v236, v29, v117
    v_fmac_f32 v244, v22, v166
    v_fmac_f32 v236, v30, v118
    v_fmac_f32 v244, v23, v167
    v_fmac_f32 v236, v31, v119
    ds_read_b64_tr_b16 v[0:1], v249 offset:0
    ds_read_b64_tr_b16 v[2:3], v249 offset:32
    ds_read_u16_d16_hi v16, v250 offset:0
    v_mul_f32 v243, v32, v152
    v_fma_f32 v241, v40, v168, -v241
    v_fmac_f32 v243, v33, v153
    v_fmac_f32 v241, v41, v169
    v_fmac_f32 v243, v34, v154
    v_fmac_f32 v241, v42, v170
    v_fmac_f32 v243, v35, v155
    v_fmac_f32 v241, v43, v171
    v_fmac_f32 v243, v36, v156
    v_fmac_f32 v241, v44, v172
    v_fmac_f32 v243, v37, v157
    v_fmac_f32 v241, v45, v173
    v_fmac_f32 v243, v38, v158
    v_fmac_f32 v241, v46, v174
    v_fmac_f32 v243, v39, v159
    v_fmac_f32 v241, v47, v175
    ds_read_b64_tr_b16 v[4:5], v249 offset:512
    ds_read_b64_tr_b16 v[6:7], v249 offset:544
    ds_read_u16_d16_hi v17, v250 offset:128
    v_fma_f32 v245, v48, v168, -v245
    v_fmac_f32 v237, v56, v120
    v_fmac_f32 v245, v49, v169
    v_fmac_f32 v237, v57, v121
    v_fmac_f32 v245, v50, v170
    v_fmac_f32 v237, v58, v122
    v_fmac_f32 v245, v51, v171
    v_fmac_f32 v237, v59, v123
    v_fmac_f32 v245, v52, v172
    v_fmac_f32 v237, v60, v124
    v_fmac_f32 v245, v53, v173
    v_fmac_f32 v237, v61, v125
    v_fmac_f32 v245, v54, v174
    v_fmac_f32 v237, v62, v126
    v_fmac_f32 v245, v55, v175
    v_fmac_f32 v237, v63, v127
    s_cmp_eq_u32 s56, 5
    s_cbranch_scc1 K2_U21
    s_cmp_eq_u32 s56, 6
    s_cbranch_scc1 K2_U3h1
    s_branch K2_DSP1
K2_U2h1:
    s_setprio 1
    s_waitcnt lgkmcnt(0)
    v_lshlrev_b32 v20, 16, v0
    v_and_b32 v21, 0xffff0000, v0
    v_lshlrev_b32 v22, 16, v1
    v_and_b32 v23, 0xffff0000, v1
    v_lshlrev_b32 v24, 16, v2
    v_and_b32 v25, 0xffff0000, v2
    v_lshlrev_b32 v26, 16, v3
    v_and_b32 v27, 0xffff0000, v3
    v_mul_f32_dpp v36, v16, v20 row_newbcast:8 row_mask:0xf bank_mask:0xf
    v_mul_f32_dpp v37, v16, v21 row_newbcast:9 row_mask:0xf bank_mask:0xf
    v_mul_f32_dpp v38, v16, v22 row_newbcast:10 row_mask:0xf bank_mask:0xf
    v_mul_f32_dpp v39, v16, v23 row_newbcast:11 row_mask:0xf bank_mask:0xf
    v_mul_f32_dpp v40, v16, v24 row_newbcast:12 row_mask:0xf bank_mask:0xf
    v_mul_f32_dpp v41, v16, v25 row_newbcast:13 row_mask:0xf bank_mask:0xf
    v_mul_f32_dpp v42, v16, v26 row_newbcast:14 row_mask:0xf bank_mask:0xf
    v_mul_f32_dpp v43, v16, v27 row_newbcast:15 row_mask:0xf bank_mask:0xf
    v_cvt_pk_bf16_f32 v68, v36, v37
    v_cvt_pk_bf16_f32 v69, v38, v39
    v_cvt_pk_bf16_f32 v70, v40, v41
    v_cvt_pk_bf16_f32 v71, v42, v43
    v_mul_f32_dpp v20, v16, v20 row_newbcast:0 row_mask:0xa bank_mask:0xf
    v_mul_f32_dpp v21, v16, v21 row_newbcast:1 row_mask:0xa bank_mask:0xf
    v_mul_f32_dpp v22, v16, v22 row_newbcast:2 row_mask:0xa bank_mask:0xf
    v_mul_f32_dpp v23, v16, v23 row_newbcast:3 row_mask:0xa bank_mask:0xf
    v_mul_f32_dpp v24, v16, v24 row_newbcast:4 row_mask:0xa bank_mask:0xf
    v_mul_f32_dpp v25, v16, v25 row_newbcast:5 row_mask:0xa bank_mask:0xf
    v_mul_f32_dpp v26, v16, v26 row_newbcast:6 row_mask:0xa bank_mask:0xf
    v_mul_f32_dpp v27, v16, v27 row_newbcast:7 row_mask:0xa bank_mask:0xf
    v_cvt_pk_bf16_f32 v64, v20, v21
    v_cvt_pk_bf16_f32 v65, v22, v23
    v_cvt_pk_bf16_f32 v66, v24, v25
    v_cvt_pk_bf16_f32 v67, v26, v27
    v_lshlrev_b32 v28, 16, v4
    v_and_b32 v29, 0xffff0000, v4
    v_lshlrev_b32 v30, 16, v5
    v_and_b32 v31, 0xffff0000, v5
    v_mul_f32_dpp v36, v17, v28 row_newbcast:8 row_mask:0xf bank_mask:0xf
    v_mul_f32_dpp v37, v17, v29 row_newbcast:9 row_mask:0xf bank_mask:0xf
    v_mul_f32_dpp v38, v17, v30 row_newbcast:10 row_mask:0xf bank_mask:0xf
    v_mul_f32_dpp v39, v17, v31 row_newbcast:11 row_mask:0xf bank_mask:0xf
    v_cvt_pk_bf16_f32 v76, v36, v37
    v_cvt_pk_bf16_f32 v77, v38, v39
    v_mul_f32_dpp v28, v17, v28 row_newbcast:0 row_mask:0xa bank_mask:0xf
    v_mul_f32_dpp v29, v17, v29 row_newbcast:1 row_mask:0xa bank_mask:0xf
    v_mul_f32_dpp v30, v17, v30 row_newbcast:2 row_mask:0xa bank_mask:0xf
    v_mul_f32_dpp v31, v17, v31 row_newbcast:3 row_mask:0xa bank_mask:0xf
    v_cvt_pk_bf16_f32 v72, v28, v29
    v_cvt_pk_bf16_f32 v73, v30, v31
    s_waitcnt vmcnt(4)
    v_mfma_f32_32x32x16_bf16 v[0:15], v[64:67], v[176:179], 0
    ds_read_b64_tr_b16 v[184:185], v246 offset:2048
    ds_read_b64_tr_b16 v[188:189], v247 offset:2048
    s_mov_b32 m0, s68
    v_mfma_f32_32x32x16_bf16 v[16:31], v[68:71], v[176:179], 0
    buffer_load_dwordx4 v222, s[4:7], s42 offen sc1 lds
    buffer_load_dwordx4 v223, s[72:75], s42 offen offset:1024 sc1 lds
    v_permlane32_swap_b32 v242, v236
    v_permlane32_swap_b32 v243, v237
    v_mfma_f32_32x32x16_bf16 v[32:47], v[64:67], v[180:183], 0
    v_permlane32_swap_b32 v244, v238
    v_permlane32_swap_b32 v245, v239
    v_permlane32_swap_b32 v240, v241
    v_add_f32 v242, v242, v236
    v_mfma_f32_32x32x16_bf16 v[48:63], v[68:71], v[180:183], 0
    v_add_f32 v243, v243, v237
    v_add_f32 v244, v244, v238
    v_add_f32 v245, v245, v239
    v_add_f32 v240, -v240, -v241
    v_sub_u32 v241, v230, v231
    v_cvt_pk_bf16_f32 v242, v242, v243
    s_mov_b64 exec, 0x1ff
    ds_add_rtn_u32 v232, v254, v255
    s_mov_b64 exec, -1
    s_waitcnt vmcnt(4) lgkmcnt(1)
    v_mfma_f32_32x32x8_bf16 v[0:15], v[72:73], v[184:185], v[0:15]
    ds_read_b64_tr_b16 v[176:177], v246 offset:4096
    ds_read_b64_tr_b16 v[178:179], v246 offset:5120
    ds_read_b64_tr_b16 v[180:181], v247 offset:4096
    ds_read_b64_tr_b16 v[182:183], v247 offset:5120
    v_cvt_pk_bf16_f32 v244, v244, v245
    v_cvt_pk_bf16_f32 v240, v240, v240
    s_mov_b32 m0, s69
    v_mfma_f32_32x32x8_bf16 v[16:31], v[76:77], v[184:185], v[16:31]
    buffer_load_dwordx4 v224, s[4:7], s42 offen sc1 lds
    ds_write2st64_b32 v230, v242, v244 offset0:3 offset1:4
    ds_write_b16 v241, v240 offset:1280
    s_waitcnt lgkmcnt(6)
    v_readlane_b32 s58, v232, 8
    v_mfma_f32_32x32x8_bf16 v[32:47], v[72:73], v[188:189], v[32:47]
    s_cmp_lt_u32 s58, s22
    s_cbranch_scc0 K2_nul_82
    s_nop 0
    v_readlane_b32 s3, v253, s58
    s_nop 0
    s_bfe_u32 s58, s3, 0x60016
    s_and_b32 s59, s58, 7
    s_lshr_b32 s60, s58, 3
K2_chk_84:
    v_readlane_b32 s61, v232, s59
    s_nop 0
    s_cmp_gt_u32 s61, s60
    s_cbranch_scc0 K2_spin_83
K2_back_85:
    v_mfma_f32_32x32x8_bf16 v[48:63], v[76:77], v[188:189], v[48:63]
    s_setprio 0
    s_lshl_b32 s44, s34, 7
    s_and_b32 s48, s3, 0x3ffff
    s_bfe_u32 s33, s3, 0x30013
    s_mov_b32 s35, s48
    s_mov_b32 s45, s44
    s_xor_b32 s47, s44, 256
    v_mul_f32 v234, v0, v96
    v_mul_f32 v236, v8, v128
    v_fmac_f32 v234, v1, v97
    v_fmac_f32 v236, v9, v129
    v_fmac_f32 v234, v2, v98
    v_fmac_f32 v236, v10, v130
    v_fmac_f32 v234, v3, v99
    v_fmac_f32 v236, v11, v131
    v_fmac_f32 v234, v4, v100
    v_fmac_f32 v236, v12, v132
    v_fmac_f32 v234, v5, v101
    v_fmac_f32 v236, v13, v133
    v_fmac_f32 v234, v6, v102
    v_fmac_f32 v236, v14, v134
    v_fmac_f32 v234, v7, v103
    v_fmac_f32 v236, v15, v135
    v_mul_f32 v238, v16, v128
    v_mul_f32 v240, v24, v128
    v_fmac_f32 v238, v17, v129
    v_fmac_f32 v240, v25, v129
    v_fmac_f32 v238, v18, v130
    v_fmac_f32 v240, v26, v130
    v_fmac_f32 v238, v19, v131
    v_fmac_f32 v240, v27, v131
    v_fmac_f32 v238, v20, v132
    v_fmac_f32 v240, v28, v132
    v_fmac_f32 v238, v21, v133
    v_fmac_f32 v240, v29, v133
    v_fmac_f32 v238, v22, v134
    v_fmac_f32 v240, v30, v134
    v_fmac_f32 v238, v23, v135
    v_fmac_f32 v240, v31, v135
    v_mul_f32 v235, v32, v104
    v_mul_f32 v237, v40, v136
    v_fmac_f32 v235, v33, v105
    v_fmac_f32 v237, v41, v137
    v_fmac_f32 v235, v34, v106
    v_fmac_f32 v237, v42, v138
    v_fmac_f32 v235, v35, v107
    v_fmac_f32 v237, v43, v139
    v_fmac_f32 v235, v36, v108
    v_fmac_f32 v237, v44, v140
    v_fmac_f32 v235, v37, v109
    v_fmac_f32 v237, v45, v141
    v_fmac_f32 v235, v38, v110
    v_fmac_f32 v237, v46, v142
    v_fmac_f32 v235, v39, v111
    v_fmac_f32 v237, v47, v143
    v_mul_f32 v239, v48, v136
    v_mul_f32 v241, v56, v136
    s_setprio 1
    s_waitcnt vmcnt(3) lgkmcnt(2)
    v_mfma_f32_32x32x16_bf16 v[0:15], v[64:67], v[176:179], 0
    ds_read_b64_tr_b16 v[184:185], v246 offset:6144
    ds_read_b64_tr_b16 v[188:189], v247 offset:6144
    v_fmac_f32 v239, v49, v137
    v_fmac_f32 v241, v57, v137
    v_fmac_f32 v239, v50, v138
    v_fmac_f32 v241, v58, v138
    s_mov_b32 m0, s70
    v_mfma_f32_32x32x16_bf16 v[16:31], v[68:71], v[176:179], 0
    buffer_load_dwordx4 v222, s[4:7], s43 offen sc1 lds
    buffer_load_dwordx4 v223, s[72:75], s43 offen offset:1024 sc1 lds
    v_fmac_f32 v239, v51, v139
    v_fmac_f32 v241, v59, v139
    v_fmac_f32 v239, v52, v140
    v_fmac_f32 v241, v60, v140
    v_fmac_f32 v239, v53, v141
    v_mfma_f32_32x32x16_bf16 v[32:47], v[64:67], v[180:183], 0
    s_add_u32 s49, s48, 128
    s_add_u32 s60, s48, 256
    s_cmp_eq_u32 s33, 3
    s_cselect_b32 s46, s44, s47
    s_cselect_b32 s50, s60, s48
    s_sub_u32 s60, s33, 2
    s_cmp_lt_u32 s60, 2
    s_cbranch_scc0 K2_rare_86
K2_back_87:
    v_add_u32 v222, s48, v251
    ds_read2_b32 v[222:223], v222 offset0:1 offset1:3
    v_fmac_f32 v241, v61, v141
    v_fmac_f32 v239, v54, v142
    v_fmac_f32 v241, v62, v142
    v_fmac_f32 v239, v55, v143
    v_fmac_f32 v241, v63, v143
    v_mfma_f32_32x32x16_bf16 v[48:63], v[68:71], v[180:183], 0
    v_permlane32_swap_b32 v234, v236
    v_permlane32_swap_b32 v235, v237
    v_permlane32_swap_b32 v240, v238
    s_waitcnt vmcnt(3) lgkmcnt(1)
    v_mfma_f32_32x32x8_bf16 v[0:15], v[72:73], v[184:185], v[0:15]
    ds_read_b64_tr_b16 v[176:177], v246 offset:0
    ds_read_b64_tr_b16 v[178:179], v246 offset:1024
    ds_read_b64_tr_b16 v[180:181], v247 offset:0
    ds_read_b64_tr_b16 v[182:183], v247 offset:1024
    v_permlane32_swap_b32 v241, v239
    s_mov_b32 m0, s71
    v_mfma_f32_32x32x8_bf16 v[16:31], v[76:77], v[184:185], v[16:31]
    buffer_load_dwordx4 v224, s[4:7], s43 offen sc1 lds
    s_waitcnt lgkmcnt(4)
    v_mad_u32_u16 v222, v222, s39, v248 op_sel:[1,0,0,0]
    v_mad_u32_u16 v223, v223, s39, v248 op_sel:[1,0,0,0]
    v_lshl_add_u32 v230, v252, 1, s31
    v_add_f32 v234, v234, v236
    v_add_f32 v235, v235, v237
    v_add_f32 v240, v240, v238
    v_add_f32 v241, v241, v239
    v_cvt_pk_bf16_f32 v234, v234, v235
    v_cvt_pk_bf16_f32 v240, v240, v241
    ds_write2st64_b32 v230, v234, v240 offset0:0 offset1:1
    v_mfma_f32_32x32x8_bf16 v[32:47], v[72:73], v[188:189], v[32:47]
    v_add_u32 v224, s49, v251
    ds_read2_b32 v[224:225], v224 offset0:1 offset1:3
    v_mul_f32 v234, v0, v144
    v_mul_f32 v236, v8, v112
    v_fmac_f32 v234, v1, v145
    v_fmac_f32 v236, v9, v113
    v_fmac_f32 v234, v2, v146
    v_mfma_f32_32x32x8_bf16 v[48:63], v[76:77], v[188:189], v[48:63]
    s_setprio 0
    v_fmac_f32 v236, v10, v114
    v_fmac_f32 v234, v3, v147
    v_fmac_f32 v236, v11, v115
    v_fmac_f32 v234, v4, v148
    v_fmac_f32 v236, v12, v116
    v_fmac_f32 v234, v5, v149
    v_fmac_f32 v236, v13, v117
    v_fmac_f32 v234, v6, v150
    v_fmac_f32 v236, v14, v118
    v_fmac_f32 v234, v7, v151
    v_fmac_f32 v236, v15, v119
    v_mul_f32 v238, v16, v160
    v_mul_f32 v240, v24, v160
    v_fmac_f32 v238, v17, v161
    v_fmac_f32 v240, v25, v161
    v_fmac_f32 v238, v18, v162
    v_fmac_f32 v240, v26, v162
    v_fmac_f32 v238, v19, v163
    v_fmac_f32 v240, v27, v163
    v_fmac_f32 v238, v20, v164
    v_fmac_f32 v240, v28, v164
    v_fmac_f32 v238, v21, v165
    v_fmac_f32 v240, v29, v165
    v_fmac_f32 v238, v22, v166
    v_fmac_f32 v240, v30, v166
    v_fmac_f32 v238, v23, v167
    v_fmac_f32 v240, v31, v167
    v_mul_f32 v235, v32, v152
    v_mul_f32 v237, v40, v120
    v_fmac_f32 v235, v33, v153
    v_fmac_f32 v237, v41, v121
    v_fmac_f32 v235, v34, v154
    v_fmac_f32 v237, v42, v122
    v_fmac_f32 v235, v35, v155
    v_fmac_f32 v237, v43, v123
    v_fmac_f32 v235, v36, v156
    v_fmac_f32 v237, v44, v124
    v_fmac_f32 v235, v37, v157
    v_fmac_f32 v237, v45, v125
    v_fmac_f32 v235, v38, v158
    v_fmac_f32 v237, v46, v126
    v_fmac_f32 v235, v39, v159
    v_fmac_f32 v237, v47, v127
    v_mul_f32 v239, v48, v168
    v_mul_f32 v241, v56, v168
    v_fmac_f32 v239, v49, v169
    v_fmac_f32 v241, v57, v169
    v_fmac_f32 v239, v50, v170
    s_setprio 1
    s_waitcnt vmcnt(3) lgkmcnt(2)
    v_mfma_f32_32x32x16_bf16 v[0:15], v[64:67], v[176:179], 0
    ds_read_b64_tr_b16 v[184:185], v246 offset:2048
    ds_read_b64_tr_b16 v[188:189], v247 offset:2048
    v_fmac_f32 v241, v58, v170
    v_fmac_f32 v239, v51, v171
    v_fmac_f32 v241, v59, v171
    v_fmac_f32 v239, v52, v172
    s_mov_b32 m0, s68
    v_mfma_f32_32x32x16_bf16 v[16:31], v[68:71], v[176:179], 0
    buffer_load_dwordx4 v222, s[4:7], s44 offen sc1 lds
    buffer_load_dwordx4 v223, s[72:75], s44 offen offset:1024 sc1 lds
    s_waitcnt lgkmcnt(2)
    v_mad_u32_u16 v224, v224, s39, v248 op_sel:[1,0,0,0]
    v_mad_u32_u16 v225, v225, s39, v248 op_sel:[1,0,0,0]
    v_fmac_f32 v241, v60, v172
    v_fmac_f32 v239, v53, v173
    v_mfma_f32_32x32x16_bf16 v[32:47], v[64:67], v[180:183], 0
    v_add_u32 v226, s50, v251
    ds_read2_b32 v[226:227], v226 offset0:1 offset1:3
    v_fmac_f32 v241, v61, v173
    v_fmac_f32 v239, v54, v174
    v_fmac_f32 v241, v62, v174
    v_fmac_f32 v239, v55, v175
    v_fmac_f32 v241, v63, v175
    v_mfma_f32_32x32x16_bf16 v[48:63], v[68:71], v[180:183], 0
    s_waitcnt vmcnt(3) lgkmcnt(1)
    v_mfma_f32_32x32x8_bf16 v[0:15], v[72:73], v[184:185], v[0:15]
    ds_read_b64_tr_b16 v[176:177], v246 offset:4096
    ds_read_b64_tr_b16 v[178:179], v246 offset:5120
    ds_read_b64_tr_b16 v[180:181], v247 offset:4096
    ds_read_b64_tr_b16 v[182:183], v247 offset:5120
    s_mov_b32 m0, s69
    v_mfma_f32_32x32x8_bf16 v[16:31], v[76:77], v[184:185], v[16:31]
    buffer_load_dwordx4 v224, s[4:7], s45 offen sc1 lds
    buffer_load_dwordx4 v225, s[72:75], s45 offen offset:1024 sc1 lds
    s_waitcnt lgkmcnt(4)
    v_mad_u32_u16 v226, v226, s39, v248 op_sel:[1,0,0,0]
    v_mad_u32_u16 v227, v227, s39, v248 op_sel:[1,0,0,0]
    v_mfma_f32_32x32x8_bf16 v[32:47], v[72:73], v[188:189], v[32:47]
    v_mul_f32 v242, v0, v144
    v_fma_f32 v238, v8, v160, -v238
    v_fmac_f32 v242, v1, v145
    v_fmac_f32 v238, v9, v161
    v_fmac_f32 v242, v2, v146
    v_fmac_f32 v238, v10, v162
    v_fmac_f32 v242, v3, v147
    v_mfma_f32_32x32x8_bf16 v[48:63], v[76:77], v[188:189], v[48:63]
    s_setprio 0
    v_fmac_f32 v238, v11, v163
    v_fmac_f32 v242, v4, v148
    v_fmac_f32 v238, v12, v164
    v_fmac_f32 v242, v5, v149
    v_fmac_f32 v238, v13, v165
    v_fmac_f32 v242, v6, v150
    v_fmac_f32 v238, v14, v166
    v_fmac_f32 v242, v7, v151
    v_fmac_f32 v238, v15, v167
    v_fmac_f32 v236, v16, v112
    v_mul_f32 v244, v24, v160
    v_fmac_f32 v236, v17, v113
    v_fmac_f32 v244, v25, v161
    v_fmac_f32 v236, v18, v114
    v_fmac_f32 v244, v26, v162
    v_fmac_f32 v236, v19, v115
    v_fmac_f32 v244, v27, v163
    v_fmac_f32 v236, v20, v116
    v_fmac_f32 v244, v28, v164
    v_fmac_f32 v236, v21, v117
    v_fmac_f32 v244, v29, v165
    v_fmac_f32 v236, v22, v118
    v_fmac_f32 v244, v30, v166
    v_fmac_f32 v236, v23, v119
    v_fmac_f32 v244, v31, v167
    v_mul_f32 v243, v32, v152
    v_fma_f32 v239, v40, v168, -v239
    v_fmac_f32 v243, v33, v153
    v_fmac_f32 v239, v41, v169
    v_fmac_f32 v243, v34, v154
    v_fmac_f32 v239, v42, v170
    v_fmac_f32 v243, v35, v155
    v_fmac_f32 v239, v43, v171
    v_fmac_f32 v243, v36, v156
    v_fmac_f32 v239, v44, v172
    v_fmac_f32 v243, v37, v157
    v_fmac_f32 v239, v45, v173
    v_fmac_f32 v243, v38, v158
    v_fmac_f32 v239, v46, v174
    v_fmac_f32 v243, v39, v159
    v_fmac_f32 v239, v47, v175
    s_setprio 1
    s_waitcnt vmcnt(4) lgkmcnt(0)
    v_mfma_f32_32x32x16_bf16 v[0:15], v[64:67], v[176:179], 0
    ds_read_b64_tr_b16 v[184:185], v246 offset:6144
    ds_read_b64_tr_b16 v[188:189], v247 offset:6144
    v_fmac_f32 v237, v48, v120
    v_mul_f32 v245, v56, v168
    v_fmac_f32 v237, v49, v121
    v_fmac_f32 v245, v57, v169
    s_mov_b32 m0, s70
    v_mfma_f32_32x32x16_bf16 v[16:31], v[68:71], v[176:179], 0
    buffer_load_dwordx4 v226, s[4:7], s46 offen sc1 lds
    buffer_load_dwordx4 v227, s[72:75], s46 offen offset:1024 sc1 lds
    v_fmac_f32 v237, v50, v122
    v_fmac_f32 v245, v58, v170
    v_fmac_f32 v237, v51, v123
    v_fmac_f32 v245, v59, v171
    v_fmac_f32 v237, v52, v124
    v_mfma_f32_32x32x16_bf16 v[32:47], v[64:67], v[180:183], 0
    v_fmac_f32 v245, v60, v172
    v_fmac_f32 v237, v53, v125
    v_fmac_f32 v245, v61, v173
    v_fmac_f32 v237, v54, v126
    v_fmac_f32 v245, v62, v174
    v_fmac_f32 v237, v55, v127
    v_fmac_f32 v245, v63, v175
    v_mfma_f32_32x32x16_bf16 v[48:63], v[68:71], v[180:183], 0
    v_permlane32_swap_b32 v242, v234
    v_permlane32_swap_b32 v243, v235
    v_add_f32 v242, v242, v234
    v_add_f32 v243, v243, v235
    s_waitcnt vmcnt(4) lgkmcnt(0)
    v_mfma_f32_32x32x8_bf16 v[0:15], v[72:73], v[184:185], v[0:15]
    ds_read_b64_tr_b16 v[176:177], v246 offset:0
    ds_read_b64_tr_b16 v[178:179], v246 offset:1024
    ds_read_b64_tr_b16 v[180:181], v247 offset:0
    ds_read_b64_tr_b16 v[182:183], v247 offset:1024
    v_cvt_pk_bf16_f32 v242, v242, v243
    ds_write_b32 v230, v242 offset:512
    s_mov_b32 m0, s71
    v_mfma_f32_32x32x8_bf16 v[16:31], v[76:77], v[184:185], v[16:31]
    s_cmp_eq_u32 s33, 4
    s_cbranch_scc1 K2_g4_89
    buffer_load_dwordx4 v224, s[4:7], s47 offen sc1 lds
    buffer_load_dwordx4 v225, s[72:75], s47 offen offset:1024 sc1 lds
K2_back_90:
    s_sub_u32 s26, s48, s29
    s_mov_b32 s29, s48
    s_mov_b32 s30, s3
    s_bfe_u32 s56, s3, 0x40012
    s_cmp_lg_u32 s36, 0
    s_cselect_b32 s56, s56, 0
    v_mfma_f32_32x32x8_bf16 v[32:47], v[72:73], v[188:189], v[32:47]
    s_mov_b32 s32, s31
    s_mov_b32 s31, s35
    v_mul_f32 v242, v0, v144
    v_fma_f32 v240, v8, v160, -v240
    v_fmac_f32 v242, v1, v145
    v_fmac_f32 v240, v9, v161
    v_fmac_f32 v242, v2, v146
    v_mfma_f32_32x32x8_bf16 v[48:63], v[76:77], v[188:189], v[48:63]
    s_setprio 0
    v_fmac_f32 v240, v10, v162
    v_fmac_f32 v242, v3, v147
    v_fmac_f32 v240, v11, v163
    v_fmac_f32 v242, v4, v148
    v_fmac_f32 v240, v12, v164
    v_fmac_f32 v242, v5, v149
    v_fmac_f32 v240, v13, v165
    v_fmac_f32 v242, v6, v150
    v_fmac_f32 v240, v14, v166
    v_fmac_f32 v242, v7, v151
    v_fmac_f32 v240, v15, v167
    v_add_u32 v249, s26, v249
    v_add_u32 v250, s26, v250
    v_fma_f32 v244, v16, v160, -v244
    v_fmac_f32 v236, v24, v112
    v_fmac_f32 v244, v17, v161
    v_fmac_f32 v236, v25, v113
    v_fmac_f32 v244, v18, v162
    v_fmac_f32 v236, v26, v114
    v_fmac_f32 v244, v19, v163
    v_fmac_f32 v236, v27, v115
    v_fmac_f32 v244, v20, v164
    v_fmac_f32 v236, v28, v116
    v_fmac_f32 v244, v21, v165
    v_fmac_f32 v236, v29, v117
    v_fmac_f32 v244, v22, v166
    v_fmac_f32 v236, v30, v118
    v_fmac_f32 v244, v23, v167
    v_fmac_f32 v236, v31, v119
    ds_read_b64_tr_b16 v[0:1], v249 offset:0
    ds_read_b64_tr_b16 v[2:3], v249 offset:32
    ds_read_u16_d16_hi v16, v250 offset:0
    v_mul_f32 v243, v32, v152
    v_fma_f32 v241, v40, v168, -v241
    v_fmac_f32 v243, v33, v153
    v_fmac_f32 v241, v41, v169
    v_fmac_f32 v243, v34, v154
    v_fmac_f32 v241, v42, v170
    v_fmac_f32 v243, v35, v155
    v_fmac_f32 v241, v43, v171
    v_fmac_f32 v243, v36, v156
    v_fmac_f32 v241, v44, v172
    v_fmac_f32 v243, v37, v157
    v_fmac_f32 v241, v45, v173
    v_fmac_f32 v243, v38, v158
    v_fmac_f32 v241, v46, v174
    v_fmac_f32 v243, v39, v159
    v_fmac_f32 v241, v47, v175
    ds_read_b64_tr_b16 v[4:5], v249 offset:512
    ds_read_b64_tr_b16 v[6:7], v249 offset:544
    ds_read_u16_d16_hi v17, v250 offset:128
    v_fma_f32 v245, v48, v168, -v245
    v_fmac_f32 v237, v56, v120
    v_fmac_f32 v245, v49, v169
    v_fmac_f32 v237, v57, v121
    v_fmac_f32 v245, v50, v170
    v_fmac_f32 v237, v58, v122
    v_fmac_f32 v245, v51, v171
    v_fmac_f32 v237, v59, v123
    v_fmac_f32 v245, v52, v172
    v_fmac_f32 v237, v60, v124
    v_fmac_f32 v245, v53, v173
    v_fmac_f32 v237, v61, v125
    v_fmac_f32 v245, v54, v174
    v_fmac_f32 v237, v62, v126
    v_fmac_f32 v245, v55, v175
    v_fmac_f32 v237, v63, v127
    s_cmp_eq_u32 s56, 5
    s_cbranch_scc1 K2_U21
    s_cmp_eq_u32 s56, 6
    s_cbranch_scc1 K2_U3h1
    s_branch K2_DSP1
K2_PAD_SW:
    s_branch K2_HOP
K2_DSP0:
    s_cmp_eq_u32 s56, 4
    s_cbranch_scc1 K2_U20
    s_cmp_eq_u32 s56, 7
    s_cbranch_scc1 K2_U30
    s_cmp_gt_u32 s56, 7
    s_cbranch_scc1 K2_U40
    s_cmp_lg_u32 s56, 0
    s_cbranch_scc1 K2_U10
    s_branch K2_SWITCH
K2_DSP1:
    s_cmp_eq_u32 s56, 4
    s_cbranch_scc1 K2_U2h1
    s_cmp_eq_u32 s56, 7
    s_cbranch_scc1 K2_U31
    s_cmp_gt_u32 s56, 7
    s_cbranch_scc1 K2_U41
    s_cmp_lg_u32 s56, 0
    s_cbranch_scc1 K2_U11
    s_branch K2_TAIL
K2_SWITCH:
    v_lshlrev_b32 v60, 3, v252
    s_mov_b32 s64, 7176192
    buffer_load_dwordx4 v[56:59], v60, s[8:11], s64 offen sc1
    v_permlane32_swap_b32 v242, v236
    v_permlane32_swap_b32 v243, v237
    v_permlane32_swap_b32 v244, v238
    v_permlane32_swap_b32 v245, v239
    v_permlane32_swap_b32 v240, v241
    v_add_f32 v242, v242, v236
    v_add_f32 v243, v243, v237
    v_add_f32 v244, v244, v238
    v_add_f32 v245, v245, v239
    v_add_f32 v240, -v240, -v241
    s_set_gpr_idx_on s32, gpr_idx(DST)
    s_nop 0
    v_cvt_pk_bf16_f32 v195, v242, v243
    v_cvt_pk_bf16_f32 v196, v244, v245
    v_cvt_pk_bf16_f32 v197, v240, v240
    s_set_gpr_idx_off
    v_lshl_add_u32 v230, v252, 1, s35
    v_lshrrev_b32 v231, 6, v252
    v_mul_u32_u24 v231, 126, v231
    v_bfe_u32 v61, v253, 22, 6
    v_lshlrev_b32 v62, 21, v252
    s_mov_b32 s58, 264241152
    v_lshlrev_b32 v61, 2, v61
    v_bfi_b32 v62, s58, v62, v253
    ds_bpermute_b32 v253, v61, v62
    v_lshrrev_b32 v254, 6, v252
    v_bfe_u32 v255, v252, 3, 2
    v_lshl_add_u32 v254, v254, 2, v255
    v_mul_u32_u24 v254, 640, v254
    v_bfe_u32 v255, v252, 5, 1
    v_lshl_add_u32 v254, v255, 5, v254
    v_and_b32 v255, 6, v252
    v_lshl_add_u32 v254, v255, 2, v254
    v_add_u32 v254, 152832, v254
    ds_read_b64_tr_b16 v[104:105], v254 offset:0
    ds_read_b64_tr_b16 v[106:107], v254 offset:5120
    ds_read_b64_tr_b16 v[108:109], v254 offset:64
    ds_read_b64_tr_b16 v[110:111], v254 offset:5184
    ds_read_b64_tr_b16 v[120:121], v254 offset:128
    ds_read_b64_tr_b16 v[122:123], v254 offset:5248
    ds_read_b64_tr_b16 v[124:125], v254 offset:192
    ds_read_b64_tr_b16 v[126:127], v254 offset:5312
    ds_read_b64_tr_b16 v[136:137], v254 offset:256
    ds_read_b64_tr_b16 v[138:139], v254 offset:5376
    ds_read_b64_tr_b16 v[140:141], v254 offset:320
    ds_read_b64_tr_b16 v[142:143], v254 offset:5440
    ds_read_b64_tr_b16 v[152:153], v254 offset:384
    ds_read_b64_tr_b16 v[154:155], v254 offset:5504
    ds_read_b64_tr_b16 v[156:157], v254 offset:448
    ds_read_b64_tr_b16 v[158:159], v254 offset:5568
    ds_read_b64_tr_b16 v[168:169], v254 offset:512
    ds_read_b64_tr_b16 v[170:171], v254 offset:5632
    ds_read_b64_tr_b16 v[172:173], v254 offset:576
    ds_read_b64_tr_b16 v[174:175], v254 offset:5696
    s_movk_i32 s40, 128
    s_movk_i32 s41, 384
    s_movk_i32 s42, 640
    s_movk_i32 s43, 896
    v_lshl_add_u32 v254, v252, 1, s53
    v_bfe_u32 v255, v252, 4, 1
    s_waitcnt lgkmcnt(15)
    v_lshlrev_b32 v96, 16, v104
    v_and_b32 v97, 0xffff0000, v104
    v_lshlrev_b32 v98, 16, v105
    v_and_b32 v99, 0xffff0000, v105
    v_lshlrev_b32 v100, 16, v106
    v_and_b32 v101, 0xffff0000, v106
    v_lshlrev_b32 v102, 16, v107
    v_and_b32 v103, 0xffff0000, v107
    v_lshlrev_b32 v104, 16, v108
    v_and_b32 v105, 0xffff0000, v108
    v_lshlrev_b32 v106, 16, v109
    v_and_b32 v107, 0xffff0000, v109
    v_lshlrev_b32 v108, 16, v110
    v_and_b32 v109, 0xffff0000, v110
    v_lshlrev_b32 v110, 16, v111
    v_and_b32 v111, 0xffff0000, v111
    s_waitcnt lgkmcnt(12)
    v_lshlrev_b32 v112, 16, v120
    v_and_b32 v113, 0xffff0000, v120
    v_lshlrev_b32 v114, 16, v121
    v_and_b32 v115, 0xffff0000, v121
    v_lshlrev_b32 v116, 16, v122
    v_and_b32 v117, 0xffff0000, v122
    v_lshlrev_b32 v118, 16, v123
    v_and_b32 v119, 0xffff0000, v123
    v_lshlrev_b32 v120, 16, v124
    v_and_b32 v121, 0xffff0000, v124
    v_lshlrev_b32 v122, 16, v125
    v_and_b32 v123, 0xffff0000, v125
    v_lshlrev_b32 v124, 16, v126
    v_and_b32 v125, 0xffff0000, v126
    v_lshlrev_b32 v126, 16, v127
    v_and_b32 v127, 0xffff0000, v127
    s_waitcnt lgkmcnt(8)
    v_lshlrev_b32 v128, 16, v136
    v_and_b32 v129, 0xffff0000, v136
    v_lshlrev_b32 v130, 16, v137
    v_and_b32 v131, 0xffff0000, v137
    v_lshlrev_b32 v132, 16, v138
    v_and_b32 v133, 0xffff0000, v138
    v_lshlrev_b32 v134, 16, v139
    v_and_b32 v135, 0xffff0000, v139
    v_lshlrev_b32 v136, 16, v140
    v_and_b32 v137, 0xffff0000, v140
    v_lshlrev_b32 v138, 16, v141
    v_and_b32 v139, 0xffff0000, v141
    v_lshlrev_b32 v140, 16, v142
    v_and_b32 v141, 0xffff0000, v142
    v_lshlrev_b32 v142, 16, v143
    v_and_b32 v143, 0xffff0000, v143
    s_waitcnt lgkmcnt(4)
    v_lshlrev_b32 v144, 16, v152
    v_and_b32 v145, 0xffff0000, v152
    v_lshlrev_b32 v146, 16, v153
    v_and_b32 v147, 0xffff0000, v153
    v_lshlrev_b32 v148, 16, v154
    v_and_b32 v149, 0xffff0000, v154
    v_lshlrev_b32 v150, 16, v155
    v_and_b32 v151, 0xffff0000, v155
    v_lshlrev_b32 v152, 16, v156
    v_and_b32 v153, 0xffff0000, v156
    v_lshlrev_b32 v154, 16, v157
    v_and_b32 v155, 0xffff0000, v157
    v_lshlrev_b32 v156, 16, v158
    v_and_b32 v157, 0xffff0000, v158
    v_lshlrev_b32 v158, 16, v159
    v_and_b32 v159, 0xffff0000, v159
    s_waitcnt lgkmcnt(0)
    v_lshlrev_b32 v160, 16, v168
    v_and_b32 v161, 0xffff0000, v168
    v_lshlrev_b32 v162, 16, v169
    v_and_b32 v163, 0xffff0000, v169
    v_lshlrev_b32 v164, 16, v170
    v_and_b32 v165, 0xffff0000, v170
    v_lshlrev_b32 v166, 16, v171
    v_and_b32 v167, 0xffff0000, v171
    v_lshlrev_b32 v168, 16, v172
    v_and_b32 v169, 0xffff0000, v172
    v_lshlrev_b32 v170, 16, v173
    v_and_b32 v171, 0xffff0000, v173
    v_lshlrev_b32 v172, 16, v174
    v_and_b32 v173, 0xffff0000, v174
    v_lshlrev_b32 v174, 16, v175
    v_and_b32 v175, 0xffff0000, v175
K2_FLGW:
    s_or_b32 s58, s54, s20
    s_waitcnt vmcnt(0)
    v_xor_b32 v56, s2, v56
    v_xor_b32 v57, s2, v57
    v_xor_b32 v58, s2, v58
    v_xor_b32 v59, s2, v59
    v_or3_b32 v56, v56, v57, v58
    v_or_b32 v56, v56, v59
    v_cmp_ne_u32 vcc, 0, v56
    s_nop 0
    s_cbranch_vccnz K2_FLGR
    s_cmp_eq_u32 s58, 0
    s_cbranch_scc1 K2_FLGY
K2_FLGOK:
    s_cmp_eq_u32 s36, 0
    s_cbranch_scc1 K2_TAIL2
    s_mov_b32 s29, s48
    s_mov_b32 s32, s31
    s_mov_b32 s30, s3
    s_mov_b32 s31, s35
    s_bfe_u32 s56, s3, 0x40012
    s_cmp_eq_u32 s56, 5
    s_cbranch_scc1 K2_U21
    s_cmp_eq_u32 s56, 6
    s_cbranch_scc1 K2_U3h1
    s_branch K2_DSP1
K2_dum_4:
    v_mov_b32 v232, -1
    s_mov_b32 m0, 163312
    s_mov_b64 exec, 1
    buffer_load_dwordx4 v232, s[16:19], 0 offen lds
    buffer_load_dwordx4 v232, s[16:19], 0 offen lds
    s_mov_b64 exec, -1
    s_branch K2_back_6
K2_nul_12:
    s_mov_b32 s58, 63
    s_mov_b32 s36, 0
    s_branch K2_back_15
K2_spin_13:
    s_sub_u32 s27, s27, 1
    s_cbranch_scc1 K2_END
    ds_read_b32 v232, v254
    s_waitcnt lgkmcnt(0)
    s_branch K2_chk_14
K2_dyn_10:
    v_lshl_add_u32 v254, v252, 1, s53
    v_bfe_u32 v255, v252, 4, 1
    s_mov_b64 exec, 0x1ff
    ds_add_rtn_u32 v232, v254, v255
    s_mov_b64 exec, -1
    s_waitcnt lgkmcnt(0)
    v_readlane_b32 s58, v232, 8
    s_nop 0
    s_cmp_lt_u32 s58, s22
    s_cbranch_scc0 K2_nul_12
    s_nop 0
    v_readlane_b32 s3, v253, s58
    s_nop 0
    s_bfe_u32 s58, s3, 0x60016
    s_and_b32 s59, s58, 7
    s_lshr_b32 s60, s58, 3
K2_chk_14:
    v_readlane_b32 s61, v232, s59
    s_nop 0
    s_cmp_gt_u32 s61, s60
    s_cbranch_scc0 K2_spin_13
K2_back_15:
    s_mov_b32 s34, 1
    s_branch K2_back_11
K2_dum_21:
    v_mov_b32 v232, -1
    s_mov_b32 m0, 163312
    s_mov_b64 exec, 1
    buffer_load_dwordx4 v232, s[16:19], 0 offen lds
    buffer_load_dwordx4 v232, s[16:19], 0 offen lds
    s_mov_b64 exec, -1
    s_branch K2_back_23
K2_nul_27:
    s_mov_b32 s58, 63
    s_mov_b32 s36, 0
    s_branch K2_back_30
K2_spin_28:
    s_sub_u32 s27, s27, 1
    s_cbranch_scc1 K2_END
    ds_read_b32 v232, v254
    s_waitcnt lgkmcnt(0)
    s_branch K2_chk_29
K2_dyn_25:
    v_lshl_add_u32 v254, v252, 1, s53
    v_bfe_u32 v255, v252, 4, 1
    s_mov_b64 exec, 0x1ff
    ds_add_rtn_u32 v232, v254, v255
    s_mov_b64 exec, -1
    s_waitcnt lgkmcnt(0)
    v_readlane_b32 s58, v232, 8
    s_nop 0
    s_cmp_lt_u32 s58, s22
    s_cbranch_scc0 K2_nul_27
    s_nop 0
    v_readlane_b32 s3, v253, s58
    s_nop 0
    s_bfe_u32 s58, s3, 0x60016
    s_and_b32 s59, s58, 7
    s_lshr_b32 s60, s58, 3
K2_chk_29:
    v_readlane_b32 s61, v232, s59
    s_nop 0
    s_cmp_gt_u32 s61, s60
    s_cbranch_scc0 K2_spin_28
K2_back_30:
    s_mov_b32 s34, 1
    s_branch K2_back_26
K2_dum_36:
    v_mov_b32 v232, -1
    s_mov_b32 m0, 163312
    s_mov_b64 exec, 1
    buffer_load_dwordx4 v232, s[16:19], 0 offen lds
    buffer_load_dwordx4 v232, s[16:19], 0 offen lds
    s_mov_b64 exec, -1
    s_branch K2_back_38
K2_nul_42:
    s_mov_b32 s58, 63
    s_mov_b32 s36, 0
    s_branch K2_back_45
K2_spin_43:
    s_sub_u32 s27, s27, 1
    s_cbranch_scc1 K2_END
    ds_read_b32 v232, v254
    s_waitcnt lgkmcnt(0)
    s_branch K2_chk_44
K2_dyn_40:
    v_lshl_add_u32 v254, v252, 1, s53
    v_bfe_u32 v255, v252, 4, 1
    s_mov_b64 exec, 0x1ff
    ds_add_rtn_u32 v232, v254, v255
    s_mov_b64 exec, -1
    s_waitcnt lgkmcnt(0)
    v_readlane_b32 s58, v232, 8
    s_nop 0
    s_cmp_lt_u32 s58, s22
    s_cbranch_scc0 K2_nul_42
    s_nop 0
    v_readlane_b32 s3, v253, s58
    s_nop 0
    s_bfe_u32 s58, s3, 0x60016
    s_and_b32 s59, s58, 7
    s_lshr_b32 s60, s58, 3
K2_chk_44:
    v_readlane_b32 s61, v232, s59
    s_nop 0
    s_cmp_gt_u32 s61, s60
    s_cbranch_scc0 K2_spin_43
K2_back_45:
    s_mov_b32 s34, 1
    s_branch K2_back_41
K2_dum_51:
    v_mov_b32 v232, -1
    s_mov_b32 m0, 163312
    s_mov_b64 exec, 1
    buffer_load_dwordx4 v232, s[16:19], 0 offen lds
    buffer_load_dwordx4 v232, s[16:19], 0 offen lds
    s_mov_b64 exec, -1
    s_branch K2_back_53
K2_nul_55:
    s_mov_b32 s3, 949760
    s_mov_b32 s36, 0
    s_branch K2_back_58
K2_spin_56:
    s_sub_u32 s27, s27, 1
    s_cbranch_scc1 K2_END
    ds_read_b32 v232, v254
    s_waitcnt lgkmcnt(0)
    s_branch K2_chk_57
K2_nul_64:
    s_mov_b32 s3, 949760
    s_mov_b32 s36, 0
    s_branch K2_back_67
K2_spin_65:
    s_sub_u32 s27, s27, 1
    s_cbranch_scc1 K2_END
    ds_read_b32 v232, v254
    s_waitcnt lgkmcnt(0)
    s_branch K2_chk_66
K2_nul_73:
    s_mov_b32 s3, 949760
    s_mov_b32 s36, 0
    s_branch K2_back_76
K2_spin_74:
    s_sub_u32 s27, s27, 1
    s_cbranch_scc1 K2_END
    ds_read_b32 v232, v254
    s_waitcnt lgkmcnt(0)
    s_branch K2_chk_75
K2_nul_82:
    s_mov_b32 s3, 949760
    s_mov_b32 s36, 0
    s_branch K2_back_85
K2_spin_83:
    s_sub_u32 s27, s27, 1
    s_cbranch_scc1 K2_END
    ds_read_b32 v232, v254
    s_waitcnt lgkmcnt(0)
    s_branch K2_chk_84
K2_PAD_TL:
    s_branch K2_HOP
K2_TAIL2:
    v_lshlrev_b32 v229, 3, v252
    s_mul_i32 s58, s20, 20480
    s_add_u32 s58, s58, 6946816
    s_mul_i32 s59, s20, 8224
    buffer_load_dwordx4 v[96:99], v229, s[8:11], s58 offen offset:0 sc1
    buffer_load_dwordx4 v[100:103], v229, s[8:11], s58 offen offset:1024 sc1
    buffer_load_dwordx4 v[104:107], v229, s[8:11], s58 offen offset:2048 sc1
    buffer_load_dwordx4 v[108:111], v229, s[8:11], s58 offen offset:3072 sc1
    s_add_u32 s58, s58, 4096
    buffer_load_dwordx4 v[128:131], v229, s[8:11], s58 offen offset:0 sc1
    buffer_load_dwordx4 v[132:135], v229, s[8:11], s58 offen offset:1024 sc1
    buffer_load_dwordx4 v[136:139], v229, s[8:11], s58 offen offset:2048 sc1
    buffer_load_dwordx4 v[140:143], v229, s[8:11], s58 offen offset:3072 sc1
    v_lshl_add_u32 v228, v252, 1, s59
    v_lshrrev_b32 v226, 6, v252
    v_mul_u32_u24 v226, 126, v226
    v_sub_u32 v226, v228, v226
    s_branch K2_TAIL3
K2_TAIL:
    v_lshlrev_b32 v229, 3, v252
    s_mul_i32 s58, s20, 20480
    s_add_u32 s58, s58, 6946816
    s_mul_i32 s59, s20, 8224
    buffer_load_dwordx4 v[96:99], v229, s[8:11], s58 offen offset:0 sc1
    v_permlane32_swap_b32 v242, v236
    v_permlane32_swap_b32 v243, v237
    v_permlane32_swap_b32 v244, v238
    buffer_load_dwordx4 v[100:103], v229, s[8:11], s58 offen offset:1024 sc1
    v_permlane32_swap_b32 v245, v239
    v_permlane32_swap_b32 v240, v241
    v_add_f32 v242, v242, v236
    buffer_load_dwordx4 v[104:107], v229, s[8:11], s58 offen offset:2048 sc1
    v_add_f32 v243, v243, v237
    v_add_f32 v244, v244, v238
    v_add_f32 v245, v245, v239
    buffer_load_dwordx4 v[108:111], v229, s[8:11], s58 offen offset:3072 sc1
    v_add_f32 v240, -v240, -v241
    v_sub_u32 v241, v230, v231
    v_cvt_pk_bf16_f32 v242, v242, v243
    s_add_u32 s58, s58, 4096
    buffer_load_dwordx4 v[128:131], v229, s[8:11], s58 offen offset:0 sc1
    v_cvt_pk_bf16_f32 v244, v244, v245
    v_cvt_pk_bf16_f32 v240, v240, v240
    ds_write2st64_b32 v230, v242, v244 offset0:3 offset1:4
    buffer_load_dwordx4 v[132:135], v229, s[8:11], s58 offen offset:1024 sc1
    ds_write_b16 v241, v240 offset:1280
    v_lshl_add_u32 v228, v252, 1, s59
    v_lshrrev_b32 v226, 6, v252
    buffer_load_dwordx4 v[136:139], v229, s[8:11], s58 offen offset:2048 sc1
    v_mul_u32_u24 v226, 126, v226
    v_sub_u32 v226, v228, v226
    buffer_load_dwordx4 v[140:143], v229, s[8:11], s58 offen offset:3072 sc1
K2_TAIL3:
    s_waitcnt vmcnt(8)
    ds_write2st64_b32 v228, v192, v193 offset0:0 offset1:1
    ds_write2st64_b32 v228, v194, v195 offset0:2 offset1:3
    s_add_u32 s58, s58, 4096
    buffer_load_dwordx4 v[112:115], v229, s[8:11], s58 offen offset:0 sc1
    v_bfe_u32 v48, v252, 1, 4
    v_lshrrev_b32 v49, 5, v252
    ds_write_b16 v226, v197 offset:1280
    ds_write2st64_b32 v228, v196, v198 offset0:4 offset1:6
    buffer_load_dwordx4 v[116:119], v229, s[8:11], s58 offen offset:1024 sc1
    v_lshrrev_b32 v55, 3, v48
    v_lshlrev_b32 v52, 4, v49
    ds_write2st64_b32 v228, v199, v200 offset0:7 offset1:8
    ds_write2st64_b32 v228, v201, v202 offset0:9 offset1:10
    buffer_load_dwordx4 v[120:123], v229, s[8:11], s58 offen offset:2048 sc1
    v_lshl_add_u32 v54, v55, 2, v48
    v_and_b32 v54, 7, v54
    ds_write_b16 v226, v203 offset:2816
    ds_write2st64_b32 v228, v204, v205 offset0:12 offset1:13
    buffer_load_dwordx4 v[124:127], v229, s[8:11], s58 offen offset:3072 sc1
    v_and_b32 v50, 7, v48
    v_mul_u32_u24 v50, 8224, v50
    ds_write2st64_b32 v228, v206, v207 offset0:14 offset1:15
    ds_write2st64_b32 v228, v208, v210 offset0:16 offset1:18
    s_add_u32 s58, s58, 4096
    buffer_load_dwordx4 v[144:147], v229, s[8:11], s58 offen offset:0 sc1
    v_mul_u32_u24 v51, 1536, v55
    v_add_u32 v50, v50, v51
    ds_write_b16 v226, v209 offset:4352
    ds_write2st64_b32 v228, v211, v212 offset0:19 offset1:20
    buffer_load_dwordx4 v[148:151], v229, s[8:11], s58 offen offset:1024 sc1
    v_add_u32 v222, v50, v52
    v_mul_u32_u24 v51, 8224, v54
    ds_write2st64_b32 v228, v213, v214 offset0:21 offset1:22
    ds_write2st64_b32 v228, v216, v217 offset0:24 offset1:25
    buffer_load_dwordx4 v[152:155], v229, s[8:11], s58 offen offset:2048 sc1
    v_add_u32 v232, v51, v52
    v_lshl_add_u32 v247, v55, 7, v232
    ds_write_b16 v226, v215 offset:5888
    ds_write2st64_b32 v228, v218, v219 offset0:26 offset1:27
    buffer_load_dwordx4 v[156:159], v229, s[8:11], s58 offen offset:3072 sc1
    v_mul_u32_u24 v51, 2080, v48
    s_mov_b32 s60, 65536
    ds_write_b32 v228, v220 offset:7168
    ds_write_b16 v226, v221 offset:7424
    s_add_u32 s58, s58, 4096
    buffer_load_dwordx4 v[160:163], v229, s[8:11], s58 offen offset:0 sc1
    v_add3_u32 v223, v51, v52, s60
    v_mul_u32_u24 v51, 2080, v54
    buffer_load_dwordx4 v[164:167], v229, s[8:11], s58 offen offset:1024 sc1
    s_mov_b32 s60, 132096
    v_add3_u32 v225, v51, v52, s60
    buffer_load_dwordx4 v[168:171], v229, s[8:11], s58 offen offset:2048 sc1
    v_lshl_add_u32 v248, v55, 7, v225
    s_lshl_b32 s60, s20, 5
    buffer_load_dwordx4 v[172:175], v229, s[8:11], s58 offen offset:3072 sc1
    v_lshl_add_u32 v49, v49, 3, s60
    s_mov_b32 s60, 65536
    v_add3_u32 v255, v51, v49, s60
    v_lshl_add_u32 v246, v55, 9, v255
    v_bfe_u32 v53, v48, 2, 1
    v_lshl_add_u32 v49, v53, 4, v49
    v_add_u32 v254, v50, v49
    s_and_b32 s64, s55, s28
    s_waitcnt lgkmcnt(0)
    s_barrier
    s_cmp_eq_u32 s64, 0
    s_cbranch_scc1 K2_MULTI
    s_setprio 3
    ds_read_b128 v[48:51], v222 offset:0
    ds_read_b128 v[52:55], v222 offset:64
    ds_read_b128 v[56:59], v222 offset:896
    ds_read_b128 v[60:63], v222 offset:960
    ds_read_b128 v[64:67], v223 offset:0
    ds_read_b128 v[68:71], v223 offset:64
    ds_read_b128 v[72:75], v223 offset:896
    ds_read_b128 v[76:79], v223 offset:960
    ds_read_b128 v[80:83], v222 offset:3072
    ds_read_b128 v[84:87], v222 offset:3136
    ds_read_b128 v[88:91], v222 offset:3968
    s_waitcnt vmcnt(19) lgkmcnt(9)
    v_mfma_f32_16x16x32_bf16 v[0:3], v[96:99], v[48:51], 0
    ds_read_b128 v[92:95], v222 offset:4032
    s_waitcnt vmcnt(18)
    v_mfma_f32_16x16x32_bf16 v[0:3], v[100:103], v[52:55], v[0:3]
    ds_read_b128 v[48:51], v223 offset:33280
    s_waitcnt vmcnt(17) lgkmcnt(9)
    v_mfma_f32_16x16x32_bf16 v[0:3], v[104:107], v[56:59], v[0:3]
    s_bfe_u32 s60, s20, 0x10002
    s_lshl_b32 s60, s60, 4
    ds_read_b128 v[52:55], v223 offset:33344
    s_waitcnt vmcnt(16)
    v_mfma_f32_16x16x32_bf16 v[0:3], v[108:111], v[60:63], v[0:3]
    s_add_u32 s59, s59, s60
    v_add_u32 v228, s59, v229
    ds_read_b128 v[56:59], v223 offset:34176
    s_waitcnt vmcnt(15) lgkmcnt(9)
    v_mfma_f32_16x16x32_bf16 v[0:3], v[128:131], v[64:67], v[0:3]
    s_mul_i32 s60, s20, 2080
    s_add_u32 s60, s60, 65536
    ds_read_b128 v[60:63], v223 offset:34240
    s_waitcnt vmcnt(14)
    v_mfma_f32_16x16x32_bf16 v[0:3], v[132:135], v[68:71], v[0:3]
    v_add_u32 v249, s60, v229
    s_mov_b32 s63, 0xbfb8aa3b
    ds_read_b128 v[64:67], v232 offset:6144
    s_waitcnt vmcnt(13) lgkmcnt(9)
    v_mfma_f32_16x16x32_bf16 v[0:3], v[136:139], v[72:75], v[0:3]
    s_add_u32 s40, s20, s21
    s_lshl_b32 s40, s40, 10
    ds_read_b128 v[68:71], v232 offset:6208
    s_waitcnt vmcnt(12)
    v_mfma_f32_16x16x32_bf16 v[0:3], v[140:143], v[76:79], v[0:3]
    s_add_u32 s41, s40, 8192
    s_add_u32 s42, s40, 16384
    ds_read_b128 v[72:75], v232 offset:7040
    s_waitcnt lgkmcnt(9)
    v_mfma_f32_16x16x32_bf16 v[16:19], v[96:99], v[80:83], 0
    s_add_u32 s43, s40, 24576
    s_add_u32 s44, s40, 32768
    ds_read_b128 v[76:79], v232 offset:7104
    v_mfma_f32_16x16x32_bf16 v[16:19], v[100:103], v[84:87], v[16:19]
    ds_read_b128 v[80:83], v225 offset:0
    s_waitcnt lgkmcnt(9)
    v_mfma_f32_16x16x32_bf16 v[16:19], v[104:107], v[88:91], v[16:19]
    ds_read_b128 v[84:87], v225 offset:64
    v_mfma_f32_16x16x32_bf16 v[16:19], v[108:111], v[92:95], v[16:19]
    v_mul_f32 v204, s63, v0
    v_mul_f32 v205, s63, v1
    ds_read_b128 v[88:91], v225 offset:896
    s_waitcnt lgkmcnt(9)
    v_mfma_f32_16x16x32_bf16 v[16:19], v[128:131], v[48:51], v[16:19]
    v_mul_f32 v206, s63, v2
    ds_read_b128 v[92:95], v225 offset:960
    v_mfma_f32_16x16x32_bf16 v[16:19], v[132:135], v[52:55], v[16:19]
    v_mul_f32 v207, s63, v3
    ds_read_b128 v[48:51], v222 offset:128
    s_waitcnt lgkmcnt(9)
    v_mfma_f32_16x16x32_bf16 v[16:19], v[136:139], v[56:59], v[16:19]
    v_exp_f32 v204, v204
    ds_read_b128 v[52:55], v222 offset:384
    v_mfma_f32_16x16x32_bf16 v[16:19], v[140:143], v[60:63], v[16:19]
    v_exp_f32 v205, v205
    ds_read_b128 v[56:59], v222 offset:256
    s_waitcnt lgkmcnt(9)
    v_mfma_f32_16x16x32_bf16 v[32:35], v[96:99], v[64:67], 0
    v_exp_f32 v206, v206
    ds_read_b128 v[60:63], v222 offset:192
    v_mfma_f32_16x16x32_bf16 v[32:35], v[100:103], v[68:71], v[32:35]
    v_exp_f32 v207, v207
    s_setprio 2
    ds_read_b128 v[64:67], v222 offset:448
    s_waitcnt lgkmcnt(9)
    v_mfma_f32_16x16x32_bf16 v[32:35], v[104:107], v[72:75], v[32:35]
    v_add_f32 v204, 1.0, v204
    ds_read_b128 v[68:71], v222 offset:320
    v_mfma_f32_16x16x32_bf16 v[32:35], v[108:111], v[76:79], v[32:35]
    v_add_f32 v205, 1.0, v205
    v_add_f32 v206, 1.0, v206
    ds_read_b128 v[72:75], v222 offset:640
    s_waitcnt lgkmcnt(9)
    v_mfma_f32_16x16x32_bf16 v[32:35], v[128:131], v[80:83], v[32:35]
    v_add_f32 v207, 1.0, v207
    ds_read_b128 v[76:79], v222 offset:512
    v_mfma_f32_16x16x32_bf16 v[32:35], v[132:135], v[84:87], v[32:35]
    v_rcp_f32 v204, v204
    ds_read_b128 v[80:83], v222 offset:768
    s_waitcnt lgkmcnt(9)
    v_mfma_f32_16x16x32_bf16 v[32:35], v[136:139], v[88:91], v[32:35]
    v_rcp_f32 v205, v205
    ds_read_b128 v[84:87], v222 offset:704
    v_mfma_f32_16x16x32_bf16 v[32:35], v[140:143], v[92:95], v[32:35]
    v_rcp_f32 v206, v206
    ds_read_b128 v[88:91], v222 offset:576
    s_waitcnt vmcnt(11) lgkmcnt(9)
    v_mfma_f32_16x16x32_bf16 v[4:7], v[112:115], v[48:51], 0
    v_rcp_f32 v207, v207
    ds_read_b128 v[92:95], v222 offset:832
    v_mfma_f32_16x16x32_bf16 v[8:11], v[112:115], v[52:55], 0
    v_cvt_pk_bf16_f32 v176, v0, v1
    ds_read_b128 v[48:51], v222 offset:1024
    s_waitcnt lgkmcnt(9)
    v_mfma_f32_16x16x32_bf16 v[12:15], v[112:115], v[56:59], 0
    v_cvt_pk_bf16_f32 v177, v2, v3
    ds_read_b128 v[52:55], v222 offset:1280
    s_waitcnt vmcnt(10)
    v_mfma_f32_16x16x32_bf16 v[4:7], v[116:119], v[60:63], v[4:7]
    v_mul_f32 v208, s63, v16
    v_mul_f32 v209, s63, v17
    ds_read_b128 v[56:59], v222 offset:1152
    s_waitcnt lgkmcnt(9)
    v_mfma_f32_16x16x32_bf16 v[8:11], v[116:119], v[64:67], v[8:11]
    v_mul_f32 v210, s63, v18
    ds_read_b128 v[60:63], v222 offset:1088
    v_mfma_f32_16x16x32_bf16 v[12:15], v[116:119], v[68:71], v[12:15]
    v_mul_f32 v211, s63, v19
    ds_read_b128 v[64:67], v222 offset:1344
    s_waitcnt vmcnt(9) lgkmcnt(9)
    v_mfma_f32_16x16x32_bf16 v[4:7], v[120:123], v[72:75], v[4:7]
    v_exp_f32 v208, v208
    ds_read_b128 v[68:71], v222 offset:1216
    v_mfma_f32_16x16x32_bf16 v[8:11], v[120:123], v[76:79], v[8:11]
    v_exp_f32 v209, v209
    ds_read_b128 v[72:75], v223 offset:128
    s_waitcnt lgkmcnt(9)
    v_mfma_f32_16x16x32_bf16 v[12:15], v[120:123], v[80:83], v[12:15]
    v_exp_f32 v210, v210
    ds_read_b128 v[76:79], v223 offset:384
    s_waitcnt vmcnt(8)
    v_mfma_f32_16x16x32_bf16 v[4:7], v[124:127], v[84:87], v[4:7]
    v_exp_f32 v211, v211
    ds_read_b128 v[80:83], v223 offset:256
    s_waitcnt lgkmcnt(9)
    v_mfma_f32_16x16x32_bf16 v[8:11], v[124:127], v[88:91], v[8:11]
    v_add_f32 v208, 1.0, v208
    ds_read_b128 v[84:87], v223 offset:192
    v_mfma_f32_16x16x32_bf16 v[12:15], v[124:127], v[92:95], v[12:15]
    v_add_f32 v209, 1.0, v209
    v_add_f32 v210, 1.0, v210
    ds_read_b128 v[88:91], v223 offset:448
    s_waitcnt vmcnt(7) lgkmcnt(9)
    v_mfma_f32_16x16x32_bf16 v[4:7], v[144:147], v[48:51], v[4:7]
    v_add_f32 v211, 1.0, v211
    s_setprio 1
    ds_read_b128 v[92:95], v223 offset:320
    v_mfma_f32_16x16x32_bf16 v[8:11], v[144:147], v[52:55], v[8:11]
    v_rcp_f32 v208, v208
    ds_read_b128 v[48:51], v223 offset:640
    s_waitcnt lgkmcnt(9)
    v_mfma_f32_16x16x32_bf16 v[12:15], v[144:147], v[56:59], v[12:15]
    v_rcp_f32 v209, v209
    ds_read_b128 v[52:55], v223 offset:512
    s_waitcnt vmcnt(6)
    v_mfma_f32_16x16x32_bf16 v[4:7], v[148:151], v[60:63], v[4:7]
    v_rcp_f32 v210, v210
    ds_read_b128 v[56:59], v223 offset:768
    s_waitcnt lgkmcnt(9)
    v_mfma_f32_16x16x32_bf16 v[8:11], v[148:151], v[64:67], v[8:11]
    v_rcp_f32 v211, v211
    ds_read_b128 v[60:63], v223 offset:704
    v_mfma_f32_16x16x32_bf16 v[12:15], v[148:151], v[68:71], v[12:15]
K2_PAD_T2:
    s_cbranch_execz K2_HOP
    v_cvt_pk_bf16_f32 v184, v16, v17
    ds_read_b128 v[64:67], v223 offset:576
    s_waitcnt vmcnt(5) lgkmcnt(9)
    v_mfma_f32_16x16x32_bf16 v[4:7], v[152:155], v[72:75], v[4:7]
    v_cvt_pk_bf16_f32 v185, v18, v19
    ds_read_b128 v[68:71], v223 offset:832
    v_mfma_f32_16x16x32_bf16 v[8:11], v[152:155], v[76:79], v[8:11]
    v_mul_f32 v212, s63, v32
    v_mul_f32 v213, s63, v33
    ds_read_b128 v[72:75], v223 offset:1024
    s_waitcnt lgkmcnt(9)
    v_mfma_f32_16x16x32_bf16 v[12:15], v[152:155], v[80:83], v[12:15]
    v_mul_f32 v214, s63, v34
    ds_read_b128 v[76:79], v223 offset:1280
    s_waitcnt vmcnt(4)
    v_mfma_f32_16x16x32_bf16 v[4:7], v[156:159], v[84:87], v[4:7]
    v_mul_f32 v215, s63, v35
    ds_read_b128 v[80:83], v223 offset:1152
    s_waitcnt lgkmcnt(9)
    v_mfma_f32_16x16x32_bf16 v[8:11], v[156:159], v[88:91], v[8:11]
    v_exp_f32 v212, v212
    ds_read_b128 v[84:87], v223 offset:1088
    v_mfma_f32_16x16x32_bf16 v[12:15], v[156:159], v[92:95], v[12:15]
    v_exp_f32 v213, v213
    ds_read_b128 v[88:91], v223 offset:1344
    s_waitcnt vmcnt(3) lgkmcnt(9)
    v_mfma_f32_16x16x32_bf16 v[4:7], v[160:163], v[48:51], v[4:7]
    v_exp_f32 v214, v214
    ds_read_b128 v[92:95], v223 offset:1216
    v_mfma_f32_16x16x32_bf16 v[8:11], v[160:163], v[52:55], v[8:11]
    v_exp_f32 v215, v215
    ds_read_b128 v[48:51], v222 offset:3200
    s_waitcnt lgkmcnt(9)
    v_mfma_f32_16x16x32_bf16 v[12:15], v[160:163], v[56:59], v[12:15]
    v_add_f32 v212, 1.0, v212
    ds_read_b128 v[52:55], v222 offset:3456
    s_waitcnt vmcnt(2)
    v_mfma_f32_16x16x32_bf16 v[4:7], v[164:167], v[60:63], v[4:7]
    v_add_f32 v213, 1.0, v213
    v_add_f32 v214, 1.0, v214
    ds_read_b128 v[56:59], v222 offset:3328
    s_waitcnt lgkmcnt(9)
    v_mfma_f32_16x16x32_bf16 v[8:11], v[164:167], v[64:67], v[8:11]
    v_add_f32 v215, 1.0, v215
    ds_read_b128 v[60:63], v222 offset:3264
    v_mfma_f32_16x16x32_bf16 v[12:15], v[164:167], v[68:71], v[12:15]
    v_rcp_f32 v212, v212
    s_setprio 0
    ds_read_b128 v[64:67], v222 offset:3520
    s_waitcnt vmcnt(1) lgkmcnt(9)
    v_mfma_f32_16x16x32_bf16 v[4:7], v[168:171], v[72:75], v[4:7]
    v_rcp_f32 v213, v213
    ds_read_b128 v[68:71], v222 offset:3392
    v_mfma_f32_16x16x32_bf16 v[8:11], v[168:171], v[76:79], v[8:11]
    v_rcp_f32 v214, v214
    ds_read_b128 v[72:75], v222 offset:3712
    s_waitcnt lgkmcnt(9)
    v_mfma_f32_16x16x32_bf16 v[12:15], v[168:171], v[80:83], v[12:15]
    v_rcp_f32 v215, v215
    ds_read_b128 v[76:79], v222 offset:3584
    s_waitcnt vmcnt(0)
    v_mfma_f32_16x16x32_bf16 v[4:7], v[172:175], v[84:87], v[4:7]
    v_cvt_pk_bf16_f32 v220, v32, v33
    ds_read_b128 v[80:83], v222 offset:3840
    s_waitcnt lgkmcnt(9)
    v_mfma_f32_16x16x32_bf16 v[8:11], v[172:175], v[88:91], v[8:11]
    v_cvt_pk_bf16_f32 v221, v34, v35
    ds_read_b128 v[84:87], v222 offset:3776
    v_mfma_f32_16x16x32_bf16 v[12:15], v[172:175], v[92:95], v[12:15]
    ds_read_b128 v[88:91], v222 offset:3648
    s_waitcnt lgkmcnt(9)
    v_mfma_f32_16x16x32_bf16 v[20:23], v[112:115], v[48:51], 0
    ds_read_b128 v[92:95], v222 offset:3904
    v_mfma_f32_16x16x32_bf16 v[24:27], v[112:115], v[52:55], 0
    ds_read_b128 v[48:51], v222 offset:4096
    s_waitcnt lgkmcnt(9)
    v_mfma_f32_16x16x32_bf16 v[28:31], v[112:115], v[56:59], 0
    s_barrier
    s_setprio 3
    ds_read_b128 v[52:55], v222 offset:4352
    v_mfma_f32_16x16x32_bf16 v[20:23], v[116:119], v[60:63], v[20:23]
    v_mul_f32 v4, v4, v204
    ds_read_b128 v[56:59], v222 offset:4224
    s_waitcnt lgkmcnt(9)
    v_mfma_f32_16x16x32_bf16 v[24:27], v[116:119], v[64:67], v[24:27]
    v_mul_f32 v5, v5, v205
    ds_read_b128 v[60:63], v222 offset:4160
    v_mfma_f32_16x16x32_bf16 v[28:31], v[116:119], v[68:71], v[28:31]
    v_mul_f32 v6, v6, v206
    ds_read_b128 v[64:67], v222 offset:4416
    s_waitcnt lgkmcnt(9)
    v_mfma_f32_16x16x32_bf16 v[20:23], v[120:123], v[72:75], v[20:23]
    v_mul_f32 v7, v7, v207
    ds_read_b128 v[68:71], v222 offset:4288
    v_mfma_f32_16x16x32_bf16 v[24:27], v[120:123], v[76:79], v[24:27]
    v_cvt_pk_bf16_f32 v178, v4, v5
    ds_read_b128 v[72:75], v223 offset:33408
    s_waitcnt lgkmcnt(9)
    v_mfma_f32_16x16x32_bf16 v[28:31], v[120:123], v[80:83], v[28:31]
    v_cvt_pk_bf16_f32 v179, v6, v7
    ds_read_b128 v[76:79], v223 offset:33664
    v_mfma_f32_16x16x32_bf16 v[20:23], v[124:127], v[84:87], v[20:23]
    v_mul_f32 v8, v8, v204
    ds_read_b128 v[80:83], v223 offset:33536
    s_waitcnt lgkmcnt(9)
    v_mfma_f32_16x16x32_bf16 v[24:27], v[124:127], v[88:91], v[24:27]
    v_mul_f32 v9, v9, v205
    ds_read_b128 v[84:87], v223 offset:33472
    v_mfma_f32_16x16x32_bf16 v[28:31], v[124:127], v[92:95], v[28:31]
    v_mul_f32 v10, v10, v206
    ds_read_b128 v[88:91], v223 offset:33728
    s_waitcnt lgkmcnt(9)
    v_mfma_f32_16x16x32_bf16 v[20:23], v[144:147], v[48:51], v[20:23]
    v_mul_f32 v11, v11, v207
    s_setprio 2
    ds_read_b128 v[92:95], v223 offset:33600
    v_mfma_f32_16x16x32_bf16 v[24:27], v[144:147], v[52:55], v[24:27]
    v_cvt_pk_bf16_f32 v180, v8, v9
    ds_read_b128 v[48:51], v223 offset:33920
    s_waitcnt lgkmcnt(9)
    v_mfma_f32_16x16x32_bf16 v[28:31], v[144:147], v[56:59], v[28:31]
    v_cvt_pk_bf16_f32 v181, v10, v11
    ds_read_b128 v[52:55], v223 offset:33792
    v_mfma_f32_16x16x32_bf16 v[20:23], v[148:151], v[60:63], v[20:23]
    v_mul_f32 v12, v12, v204
    ds_read_b128 v[56:59], v223 offset:34048
    s_waitcnt lgkmcnt(9)
    v_mfma_f32_16x16x32_bf16 v[24:27], v[148:151], v[64:67], v[24:27]
    v_mul_f32 v13, v13, v205
    ds_read_b128 v[60:63], v223 offset:33984
    v_mfma_f32_16x16x32_bf16 v[28:31], v[148:151], v[68:71], v[28:31]
    v_mul_f32 v14, v14, v206
    ds_read_b128 v[64:67], v223 offset:33856
    s_waitcnt lgkmcnt(9)
    v_mfma_f32_16x16x32_bf16 v[20:23], v[152:155], v[72:75], v[20:23]
    v_mul_f32 v15, v15, v207
    ds_read_b128 v[68:71], v223 offset:34112
    v_mfma_f32_16x16x32_bf16 v[24:27], v[152:155], v[76:79], v[24:27]
    v_cvt_pk_bf16_f32 v182, v12, v13
    ds_read_b128 v[72:75], v223 offset:34304
    s_waitcnt lgkmcnt(9)
    v_mfma_f32_16x16x32_bf16 v[28:31], v[152:155], v[80:83], v[28:31]
    v_cvt_pk_bf16_f32 v183, v14, v15
    ds_read_b128 v[76:79], v223 offset:34560
    v_mfma_f32_16x16x32_bf16 v[20:23], v[156:159], v[84:87], v[20:23]
    ds_write_b64 v254, v[176:177] offset:0
    ds_write_b64 v254, v[178:179] offset:256
    ds_write_b64 v254, v[180:181] offset:512
    ds_write_b64 v254, v[182:183] offset:768
    ds_write_b64 v255, v[220:221] offset:0
    ds_read_b128 v[80:83], v223 offset:34432
    s_waitcnt lgkmcnt(14)
    v_mfma_f32_16x16x32_bf16 v[24:27], v[156:159], v[88:91], v[24:27]
    ds_read_b128 v[84:87], v223 offset:34368
    v_mfma_f32_16x16x32_bf16 v[28:31], v[156:159], v[92:95], v[28:31]
    s_setprio 1
    ds_read_b128 v[88:91], v223 offset:34624
    s_waitcnt lgkmcnt(14)
    v_mfma_f32_16x16x32_bf16 v[20:23], v[160:163], v[48:51], v[20:23]
    ds_read_b128 v[92:95], v223 offset:34496
    v_mfma_f32_16x16x32_bf16 v[24:27], v[160:163], v[52:55], v[24:27]
    ds_read_b128 v[48:51], v247 offset:6272
    s_waitcnt lgkmcnt(14)
    v_mfma_f32_16x16x32_bf16 v[28:31], v[160:163], v[56:59], v[28:31]
    ds_read_b128 v[52:55], v232 offset:6528
    v_mfma_f32_16x16x32_bf16 v[20:23], v[164:167], v[60:63], v[20:23]
    ds_read_b128 v[56:59], v247 offset:6336
    s_waitcnt lgkmcnt(14)
    v_mfma_f32_16x16x32_bf16 v[24:27], v[164:167], v[64:67], v[24:27]
    ds_read_b128 v[60:63], v232 offset:6592
    v_mfma_f32_16x16x32_bf16 v[28:31], v[164:167], v[68:71], v[28:31]
    ds_read_b128 v[64:67], v247 offset:6784
    s_waitcnt lgkmcnt(14)
    v_mfma_f32_16x16x32_bf16 v[20:23], v[168:171], v[72:75], v[20:23]
    ds_read_b128 v[68:71], v232 offset:6656
    v_mfma_f32_16x16x32_bf16 v[24:27], v[168:171], v[76:79], v[24:27]
    ds_read_b128 v[72:75], v247 offset:6848
    s_waitcnt lgkmcnt(9)
    v_mfma_f32_16x16x32_bf16 v[28:31], v[168:171], v[80:83], v[28:31]
    ds_read_b128 v[76:79], v232 offset:6720
    v_mfma_f32_16x16x32_bf16 v[20:23], v[172:175], v[84:87], v[20:23]
    s_setprio 0
    ds_read_b128 v[80:83], v247 offset:7168
    s_waitcnt lgkmcnt(9)
    v_mfma_f32_16x16x32_bf16 v[24:27], v[172:175], v[88:91], v[24:27]
    ds_read_b128 v[84:87], v232 offset:7424
    v_mfma_f32_16x16x32_bf16 v[28:31], v[172:175], v[92:95], v[28:31]
    ds_read_b128 v[88:91], v247 offset:7232
    s_waitcnt lgkmcnt(9)
    v_mfma_f32_16x16x32_bf16 v[36:39], v[112:115], v[48:51], 0
    ds_read_b128 v[92:95], v232 offset:7488
    v_mfma_f32_16x16x32_bf16 v[40:43], v[112:115], v[52:55], 0
    ds_read_b128 v[48:51], v248 offset:128
    s_waitcnt lgkmcnt(9)
    v_mfma_f32_16x16x32_bf16 v[36:39], v[116:119], v[56:59], v[36:39]
    s_barrier
    ds_read_b128 v[192:195], v228 offset:0
    ds_read_b128 v[196:199], v228 offset:1536
    s_setprio 3
    ds_read_b128 v[52:55], v225 offset:384
    v_mfma_f32_16x16x32_bf16 v[40:43], v[116:119], v[60:63], v[40:43]
    v_mul_f32 v20, v20, v208
    v_mul_f32 v21, v21, v209
    ds_read_b128 v[56:59], v248 offset:192
    s_waitcnt lgkmcnt(11)
    v_mfma_f32_16x16x32_bf16 v[36:39], v[120:123], v[64:67], v[36:39]
    v_mul_f32 v22, v22, v210
    ds_read_b128 v[60:63], v225 offset:448
    v_mfma_f32_16x16x32_bf16 v[40:43], v[120:123], v[68:71], v[40:43]
    v_mul_f32 v23, v23, v211
    ds_read_b128 v[64:67], v248 offset:640
    s_waitcnt lgkmcnt(11)
    v_mfma_f32_16x16x32_bf16 v[36:39], v[124:127], v[72:75], v[36:39]
    v_cvt_pk_bf16_f32 v186, v20, v21
    ds_read_b128 v[68:71], v225 offset:512
    v_mfma_f32_16x16x32_bf16 v[40:43], v[124:127], v[76:79], v[40:43]
    v_cvt_pk_bf16_f32 v187, v22, v23
    ds_read_b128 v[72:75], v248 offset:704
    s_waitcnt lgkmcnt(11)
    v_mfma_f32_16x16x32_bf16 v[36:39], v[144:147], v[80:83], v[36:39]
    v_mul_f32 v24, v24, v208
    v_mul_f32 v25, v25, v209
    s_waitcnt lgkmcnt(6)
    buffer_store_dwordx4 v[192:195], v229, s[12:15], s40 offen sc1
    buffer_store_dwordx4 v[196:199], v229, s[12:15], s41 offen sc1
    s_setprio 2
    ds_read_b128 v[76:79], v225 offset:576
    v_mfma_f32_16x16x32_bf16 v[40:43], v[144:147], v[84:87], v[40:43]
    v_mul_f32 v26, v26, v210
    ds_read_b128 v[80:83], v248 offset:1024
    v_mfma_f32_16x16x32_bf16 v[36:39], v[148:151], v[88:91], v[36:39]
    v_mul_f32 v27, v27, v211
    ds_read_b128 v[84:87], v225 offset:1280
    v_mfma_f32_16x16x32_bf16 v[40:43], v[148:151], v[92:95], v[40:43]
    v_cvt_pk_bf16_f32 v188, v24, v25
    ds_read_b128 v[88:91], v248 offset:1088
    s_waitcnt lgkmcnt(9)
    v_mfma_f32_16x16x32_bf16 v[36:39], v[152:155], v[48:51], v[36:39]
    v_cvt_pk_bf16_f32 v189, v26, v27
    ds_read_b128 v[92:95], v225 offset:1344
    v_mfma_f32_16x16x32_bf16 v[40:43], v[152:155], v[52:55], v[40:43]
    v_mul_f32 v28, v28, v208
    v_mul_f32 v29, v29, v209
    s_waitcnt lgkmcnt(8)
    v_mfma_f32_16x16x32_bf16 v[36:39], v[156:159], v[56:59], v[36:39]
    v_mul_f32 v30, v30, v210
    v_mfma_f32_16x16x32_bf16 v[40:43], v[156:159], v[60:63], v[40:43]
    v_mul_f32 v31, v31, v211
    s_setprio 1
    s_waitcnt lgkmcnt(6)
    v_mfma_f32_16x16x32_bf16 v[36:39], v[160:163], v[64:67], v[36:39]
    v_cvt_pk_bf16_f32 v190, v28, v29
    v_mfma_f32_16x16x32_bf16 v[40:43], v[160:163], v[68:71], v[40:43]
    v_cvt_pk_bf16_f32 v191, v30, v31
    s_waitcnt lgkmcnt(4)
    v_mfma_f32_16x16x32_bf16 v[36:39], v[164:167], v[72:75], v[36:39]
    ds_write_b64 v254, v[184:185] offset:3072
    ds_write_b64 v254, v[186:187] offset:3328
    ds_write_b64 v254, v[188:189] offset:3584
    ds_write_b64 v254, v[190:191] offset:3840
    v_mfma_f32_16x16x32_bf16 v[40:43], v[164:167], v[76:79], v[40:43]
    s_waitcnt lgkmcnt(6)
    v_mfma_f32_16x16x32_bf16 v[36:39], v[168:171], v[80:83], v[36:39]
    v_mfma_f32_16x16x32_bf16 v[40:43], v[168:171], v[84:87], v[40:43]
    s_setprio 0
    s_waitcnt lgkmcnt(4)
    v_mfma_f32_16x16x32_bf16 v[36:39], v[172:175], v[88:91], v[36:39]
    v_mfma_f32_16x16x32_bf16 v[40:43], v[172:175], v[92:95], v[40:43]
    s_nop 6
    v_mul_f32 v36, v36, v212
    v_mul_f32 v37, v37, v213
    v_mul_f32 v38, v38, v214
    v_mul_f32 v39, v39, v215
    v_cvt_pk_bf16_f32 v178, v36, v37
    v_cvt_pk_bf16_f32 v179, v38, v39
    v_mul_f32 v40, v40, v212
    v_mul_f32 v41, v41, v213
    v_mul_f32 v42, v42, v214
    v_mul_f32 v43, v43, v215
    v_cvt_pk_bf16_f32 v180, v40, v41
    v_cvt_pk_bf16_f32 v181, v42, v43
    ds_write_b64 v246, v[178:179] offset:256
    ds_write_b64 v255, v[180:181] offset:512
    s_waitcnt lgkmcnt(0)
    s_barrier
    ds_read_b128 v[192:195], v228 offset:3072
    ds_read_b128 v[196:199], v228 offset:4608
    ds_read_b128 v[200:203], v249
    s_waitcnt lgkmcnt(1)
    buffer_store_dwordx4 v[192:195], v229, s[12:15], s42 offen sc1
    buffer_store_dwordx4 v[196:199], v229, s[12:15], s43 offen sc1
K2_LASTROW:
    s_add_u32 s59, s20, 32
    s_cmp_ge_u32 s59, s22
    s_cbranch_scc1 K2_FIN
    s_waitcnt lgkmcnt(0)
    buffer_store_dwordx4 v[200:203], v229, s[12:15], s44 offen sc1
K2_FIN:
    s_endpgm
K2_MULTI:
    ds_read_b128 v[48:51], v222 offset:0
    ds_read_b128 v[52:55], v222 offset:64
    ds_read_b128 v[56:59], v222 offset:896
    ds_read_b128 v[60:63], v222 offset:960
    ds_read_b128 v[64:67], v223 offset:0
    ds_read_b128 v[68:71], v223 offset:64
    ds_read_b128 v[72:75], v223 offset:896
    ds_read_b128 v[76:79], v223 offset:960
    ds_read_b128 v[80:83], v222 offset:3072
    ds_read_b128 v[84:87], v222 offset:3136
    ds_read_b128 v[88:91], v222 offset:3968
    s_waitcnt vmcnt(19) lgkmcnt(9)
    v_mfma_f32_16x16x32_bf16 v[0:3], v[96:99], v[48:51], 0
    ds_read_b128 v[92:95], v222 offset:4032
    s_waitcnt vmcnt(18)
    v_mfma_f32_16x16x32_bf16 v[0:3], v[100:103], v[52:55], v[0:3]
    ds_read_b128 v[48:51], v223 offset:33280
    s_waitcnt vmcnt(17) lgkmcnt(9)
    v_mfma_f32_16x16x32_bf16 v[0:3], v[104:107], v[56:59], v[0:3]
    ds_read_b128 v[52:55], v223 offset:33344
    s_waitcnt vmcnt(16)
    v_mfma_f32_16x16x32_bf16 v[0:3], v[108:111], v[60:63], v[0:3]
    ds_read_b128 v[56:59], v223 offset:34176
    s_waitcnt vmcnt(15) lgkmcnt(9)
    v_mfma_f32_16x16x32_bf16 v[0:3], v[128:131], v[64:67], v[0:3]
    ds_read_b128 v[60:63], v223 offset:34240
    s_waitcnt vmcnt(14)
    v_mfma_f32_16x16x32_bf16 v[0:3], v[132:135], v[68:71], v[0:3]
    ds_read_b128 v[64:67], v232 offset:6144
    s_waitcnt vmcnt(13) lgkmcnt(9)
    v_mfma_f32_16x16x32_bf16 v[0:3], v[136:139], v[72:75], v[0:3]
    ds_read_b128 v[68:71], v232 offset:6208
    s_waitcnt vmcnt(12)
    v_mfma_f32_16x16x32_bf16 v[0:3], v[140:143], v[76:79], v[0:3]
    ds_read_b128 v[72:75], v232 offset:7040
    s_waitcnt lgkmcnt(9)
    v_mfma_f32_16x16x32_bf16 v[16:19], v[96:99], v[80:83], 0
    ds_read_b128 v[76:79], v232 offset:7104
    v_mfma_f32_16x16x32_bf16 v[16:19], v[100:103], v[84:87], v[16:19]
    ds_read_b128 v[80:83], v225 offset:0
    s_waitcnt lgkmcnt(9)
    v_mfma_f32_16x16x32_bf16 v[16:19], v[104:107], v[88:91], v[16:19]
    ds_read_b128 v[84:87], v225 offset:64
    v_mfma_f32_16x16x32_bf16 v[16:19], v[108:111], v[92:95], v[16:19]
    ds_read_b128 v[88:91], v225 offset:896
    s_waitcnt lgkmcnt(9)
    v_mfma_f32_16x16x32_bf16 v[16:19], v[128:131], v[48:51], v[16:19]
    ds_read_b128 v[92:95], v225 offset:960
    v_mfma_f32_16x16x32_bf16 v[16:19], v[132:135], v[52:55], v[16:19]
    ds_read_b128 v[48:51], v222 offset:128
    s_waitcnt lgkmcnt(9)
    v_mfma_f32_16x16x32_bf16 v[16:19], v[136:139], v[56:59], v[16:19]
    ds_read_b128 v[52:55], v222 offset:384
    v_mfma_f32_16x16x32_bf16 v[16:19], v[140:143], v[60:63], v[16:19]
    ds_read_b128 v[56:59], v222 offset:256
    s_waitcnt lgkmcnt(9)
    v_mfma_f32_16x16x32_bf16 v[32:35], v[96:99], v[64:67], 0
    ds_read_b128 v[60:63], v222 offset:192
    v_mfma_f32_16x16x32_bf16 v[32:35], v[100:103], v[68:71], v[32:35]
    ds_read_b128 v[64:67], v222 offset:448
    s_waitcnt lgkmcnt(9)
    v_mfma_f32_16x16x32_bf16 v[32:35], v[104:107], v[72:75], v[32:35]
    ds_read_b128 v[68:71], v222 offset:320
    v_mfma_f32_16x16x32_bf16 v[32:35], v[108:111], v[76:79], v[32:35]
    ds_read_b128 v[72:75], v222 offset:640
    s_waitcnt lgkmcnt(9)
    v_mfma_f32_16x16x32_bf16 v[32:35], v[128:131], v[80:83], v[32:35]
    ds_read_b128 v[76:79], v222 offset:512
    v_mfma_f32_16x16x32_bf16 v[32:35], v[132:135], v[84:87], v[32:35]
    ds_read_b128 v[80:83], v222 offset:768
    s_waitcnt lgkmcnt(9)
    v_mfma_f32_16x16x32_bf16 v[32:35], v[136:139], v[88:91], v[32:35]
    ds_read_b128 v[84:87], v222 offset:704
    v_mfma_f32_16x16x32_bf16 v[32:35], v[140:143], v[92:95], v[32:35]
    ds_read_b128 v[88:91], v222 offset:576
    s_waitcnt vmcnt(11) lgkmcnt(9)
    v_mfma_f32_16x16x32_bf16 v[4:7], v[112:115], v[48:51], 0
    ds_read_b128 v[92:95], v222 offset:832
    v_mfma_f32_16x16x32_bf16 v[8:11], v[112:115], v[52:55], 0
    ds_read_b128 v[48:51], v222 offset:1024
    s_waitcnt lgkmcnt(9)
    v_mfma_f32_16x16x32_bf16 v[12:15], v[112:115], v[56:59], 0
    ds_read_b128 v[52:55], v222 offset:1280
    s_waitcnt vmcnt(10)
    v_mfma_f32_16x16x32_bf16 v[4:7], v[116:119], v[60:63], v[4:7]
    ds_read_b128 v[56:59], v222 offset:1152
    s_waitcnt lgkmcnt(9)
    v_mfma_f32_16x16x32_bf16 v[8:11], v[116:119], v[64:67], v[8:11]
    ds_read_b128 v[60:63], v222 offset:1088
    v_mfma_f32_16x16x32_bf16 v[12:15], v[116:119], v[68:71], v[12:15]
    ds_read_b128 v[64:67], v222 offset:1344
    s_waitcnt vmcnt(9) lgkmcnt(9)
    v_mfma_f32_16x16x32_bf16 v[4:7], v[120:123], v[72:75], v[4:7]
    ds_read_b128 v[68:71], v222 offset:1216
    v_mfma_f32_16x16x32_bf16 v[8:11], v[120:123], v[76:79], v[8:11]
    ds_read_b128 v[72:75], v223 offset:128
    s_waitcnt lgkmcnt(9)
    v_mfma_f32_16x16x32_bf16 v[12:15], v[120:123], v[80:83], v[12:15]
    ds_read_b128 v[76:79], v223 offset:384
    s_waitcnt vmcnt(8)
    v_mfma_f32_16x16x32_bf16 v[4:7], v[124:127], v[84:87], v[4:7]
    ds_read_b128 v[80:83], v223 offset:256
    s_waitcnt lgkmcnt(9)
    v_mfma_f32_16x16x32_bf16 v[8:11], v[124:127], v[88:91], v[8:11]
    ds_read_b128 v[84:87], v223 offset:192
    v_mfma_f32_16x16x32_bf16 v[12:15], v[124:127], v[92:95], v[12:15]
    ds_read_b128 v[88:91], v223 offset:448
    s_waitcnt vmcnt(7) lgkmcnt(9)
    v_mfma_f32_16x16x32_bf16 v[4:7], v[144:147], v[48:51], v[4:7]
    ds_read_b128 v[92:95], v223 offset:320
    v_mfma_f32_16x16x32_bf16 v[8:11], v[144:147], v[52:55], v[8:11]
    ds_read_b128 v[48:51], v223 offset:640
    s_waitcnt lgkmcnt(9)
    v_mfma_f32_16x16x32_bf16 v[12:15], v[144:147], v[56:59], v[12:15]
    ds_read_b128 v[52:55], v223 offset:512
    s_waitcnt vmcnt(6)
    v_mfma_f32_16x16x32_bf16 v[4:7], v[148:151], v[60:63], v[4:7]
    ds_read_b128 v[56:59], v223 offset:768
    s_waitcnt lgkmcnt(9)
    v_mfma_f32_16x16x32_bf16 v[8:11], v[148:151], v[64:67], v[8:11]
    ds_read_b128 v[60:63], v223 offset:704
    v_mfma_f32_16x16x32_bf16 v[12:15], v[148:151], v[68:71], v[12:15]
    ds_read_b128 v[64:67], v223 offset:576
    s_waitcnt vmcnt(5) lgkmcnt(9)
    v_mfma_f32_16x16x32_bf16 v[4:7], v[152:155], v[72:75], v[4:7]
    ds_read_b128 v[68:71], v223 offset:832
    v_mfma_f32_16x16x32_bf16 v[8:11], v[152:155], v[76:79], v[8:11]
    ds_read_b128 v[72:75], v223 offset:1024
    s_waitcnt lgkmcnt(9)
    v_mfma_f32_16x16x32_bf16 v[12:15], v[152:155], v[80:83], v[12:15]
    ds_read_b128 v[76:79], v223 offset:1280
    s_waitcnt vmcnt(4)
    v_mfma_f32_16x16x32_bf16 v[4:7], v[156:159], v[84:87], v[4:7]
    ds_read_b128 v[80:83], v223 offset:1152
    s_waitcnt lgkmcnt(9)
    v_mfma_f32_16x16x32_bf16 v[8:11], v[156:159], v[88:91], v[8:11]
    ds_read_b128 v[84:87], v223 offset:1088
    v_mfma_f32_16x16x32_bf16 v[12:15], v[156:159], v[92:95], v[12:15]
    ds_read_b128 v[88:91], v223 offset:1344
    s_waitcnt vmcnt(3) lgkmcnt(9)
    v_mfma_f32_16x16x32_bf16 v[4:7], v[160:163], v[48:51], v[4:7]
    ds_read_b128 v[92:95], v223 offset:1216
    v_mfma_f32_16x16x32_bf16 v[8:11], v[160:163], v[52:55], v[8:11]
    ds_read_b128 v[48:51], v222 offset:3200
    s_waitcnt lgkmcnt(9)
    v_mfma_f32_16x16x32_bf16 v[12:15], v[160:163], v[56:59], v[12:15]
    ds_read_b128 v[52:55], v222 offset:3456
    s_waitcnt vmcnt(2)
    v_mfma_f32_16x16x32_bf16 v[4:7], v[164:167], v[60:63], v[4:7]
    ds_read_b128 v[56:59], v222 offset:3328
    s_waitcnt lgkmcnt(9)
    v_mfma_f32_16x16x32_bf16 v[8:11], v[164:167], v[64:67], v[8:11]
    ds_read_b128 v[60:63], v222 offset:3264
    v_mfma_f32_16x16x32_bf16 v[12:15], v[164:167], v[68:71], v[12:15]
    ds_read_b128 v[64:67], v222 offset:3520
    s_waitcnt vmcnt(1) lgkmcnt(9)
    v_mfma_f32_16x16x32_bf16 v[4:7], v[168:171], v[72:75], v[4:7]
    ds_read_b128 v[68:71], v222 offset:3392
    v_mfma_f32_16x16x32_bf16 v[8:11], v[168:171], v[76:79], v[8:11]
    ds_read_b128 v[72:75], v222 offset:3712
    s_waitcnt lgkmcnt(9)
    v_mfma_f32_16x16x32_bf16 v[12:15], v[168:171], v[80:83], v[12:15]
    ds_read_b128 v[76:79], v222 offset:3584
    s_waitcnt vmcnt(0)
    v_mfma_f32_16x16x32_bf16 v[4:7], v[172:175], v[84:87], v[4:7]
    ds_read_b128 v[80:83], v222 offset:3840
    s_waitcnt lgkmcnt(9)
    v_mfma_f32_16x16x32_bf16 v[8:11], v[172:175], v[88:91], v[8:11]
    ds_read_b128 v[84:87], v222 offset:3776
    v_mfma_f32_16x16x32_bf16 v[12:15], v[172:175], v[92:95], v[12:15]
    ds_read_b128 v[88:91], v222 offset:3648
    s_waitcnt lgkmcnt(9)
    v_mfma_f32_16x16x32_bf16 v[20:23], v[112:115], v[48:51], 0
    ds_read_b128 v[92:95], v222 offset:3904
    v_mfma_f32_16x16x32_bf16 v[24:27], v[112:115], v[52:55], 0
    ds_read_b128 v[48:51], v222 offset:4096
    s_waitcnt lgkmcnt(9)
    v_mfma_f32_16x16x32_bf16 v[28:31], v[112:115], v[56:59], 0
    ds_read_b128 v[52:55], v222 offset:4352
    v_mfma_f32_16x16x32_bf16 v[20:23], v[116:119], v[60:63], v[20:23]
    ds_read_b128 v[56:59], v222 offset:4224
    s_waitcnt lgkmcnt(9)
    v_mfma_f32_16x16x32_bf16 v[24:27], v[116:119], v[64:67], v[24:27]
    ds_read_b128 v[60:63], v222 offset:4160
    v_mfma_f32_16x16x32_bf16 v[28:31], v[116:119], v[68:71], v[28:31]
    ds_read_b128 v[64:67], v222 offset:4416
    s_waitcnt lgkmcnt(9)
    v_mfma_f32_16x16x32_bf16 v[20:23], v[120:123], v[72:75], v[20:23]
    ds_read_b128 v[68:71], v222 offset:4288
    v_mfma_f32_16x16x32_bf16 v[24:27], v[120:123], v[76:79], v[24:27]
    ds_read_b128 v[72:75], v223 offset:33408
    s_waitcnt lgkmcnt(9)
    v_mfma_f32_16x16x32_bf16 v[28:31], v[120:123], v[80:83], v[28:31]
    ds_read_b128 v[76:79], v223 offset:33664
    v_mfma_f32_16x16x32_bf16 v[20:23], v[124:127], v[84:87], v[20:23]
    ds_read_b128 v[80:83], v223 offset:33536
    s_waitcnt lgkmcnt(9)
    v_mfma_f32_16x16x32_bf16 v[24:27], v[124:127], v[88:91], v[24:27]
    ds_read_b128 v[84:87], v223 offset:33472
    v_mfma_f32_16x16x32_bf16 v[28:31], v[124:127], v[92:95], v[28:31]
    ds_read_b128 v[88:91], v223 offset:33728
    s_waitcnt lgkmcnt(9)
    v_mfma_f32_16x16x32_bf16 v[20:23], v[144:147], v[48:51], v[20:23]
    ds_read_b128 v[92:95], v223 offset:33600
    v_mfma_f32_16x16x32_bf16 v[24:27], v[144:147], v[52:55], v[24:27]
    ds_read_b128 v[48:51], v223 offset:33920
    s_waitcnt lgkmcnt(9)
    v_mfma_f32_16x16x32_bf16 v[28:31], v[144:147], v[56:59], v[28:31]
    ds_read_b128 v[52:55], v223 offset:33792
    v_mfma_f32_16x16x32_bf16 v[20:23], v[148:151], v[60:63], v[20:23]
    ds_read_b128 v[56:59], v223 offset:34048
    s_waitcnt lgkmcnt(9)
    v_mfma_f32_16x16x32_bf16 v[24:27], v[148:151], v[64:67], v[24:27]
    ds_read_b128 v[60:63], v223 offset:33984
    v_mfma_f32_16x16x32_bf16 v[28:31], v[148:151], v[68:71], v[28:31]
    ds_read_b128 v[64:67], v223 offset:33856
    s_waitcnt lgkmcnt(9)
    v_mfma_f32_16x16x32_bf16 v[20:23], v[152:155], v[72:75], v[20:23]
    ds_read_b128 v[68:71], v223 offset:34112
    v_mfma_f32_16x16x32_bf16 v[24:27], v[152:155], v[76:79], v[24:27]
    ds_read_b128 v[72:75], v223 offset:34304
    s_waitcnt lgkmcnt(9)
    v_mfma_f32_16x16x32_bf16 v[28:31], v[152:155], v[80:83], v[28:31]
    ds_read_b128 v[76:79], v223 offset:34560
    v_mfma_f32_16x16x32_bf16 v[20:23], v[156:159], v[84:87], v[20:23]
    ds_read_b128 v[80:83], v223 offset:34432
    s_waitcnt lgkmcnt(9)
    v_mfma_f32_16x16x32_bf16 v[24:27], v[156:159], v[88:91], v[24:27]
    ds_read_b128 v[84:87], v223 offset:34368
    v_mfma_f32_16x16x32_bf16 v[28:31], v[156:159], v[92:95], v[28:31]
    ds_read_b128 v[88:91], v223 offset:34624
    s_waitcnt lgkmcnt(9)
    v_mfma_f32_16x16x32_bf16 v[20:23], v[160:163], v[48:51], v[20:23]
    ds_read_b128 v[92:95], v223 offset:34496
    v_mfma_f32_16x16x32_bf16 v[24:27], v[160:163], v[52:55], v[24:27]
    ds_read_b128 v[48:51], v247 offset:6272
    s_waitcnt lgkmcnt(9)
    v_mfma_f32_16x16x32_bf16 v[28:31], v[160:163], v[56:59], v[28:31]
    ds_read_b128 v[52:55], v232 offset:6528
    v_mfma_f32_16x16x32_bf16 v[20:23], v[164:167], v[60:63], v[20:23]
    ds_read_b128 v[56:59], v247 offset:6336
    s_waitcnt lgkmcnt(9)
    v_mfma_f32_16x16x32_bf16 v[24:27], v[164:167], v[64:67], v[24:27]
    ds_read_b128 v[60:63], v232 offset:6592
    v_mfma_f32_16x16x32_bf16 v[28:31], v[164:167], v[68:71], v[28:31]
    ds_read_b128 v[64:67], v247 offset:6784
    s_waitcnt lgkmcnt(9)
    v_mfma_f32_16x16x32_bf16 v[20:23], v[168:171], v[72:75], v[20:23]
    ds_read_b128 v[68:71], v232 offset:6656
    v_mfma_f32_16x16x32_bf16 v[24:27], v[168:171], v[76:79], v[24:27]
    ds_read_b128 v[72:75], v247 offset:6848
    s_waitcnt lgkmcnt(9)
    v_mfma_f32_16x16x32_bf16 v[28:31], v[168:171], v[80:83], v[28:31]
    ds_read_b128 v[76:79], v232 offset:6720
    v_mfma_f32_16x16x32_bf16 v[20:23], v[172:175], v[84:87], v[20:23]
    ds_read_b128 v[80:83], v247 offset:7168
    s_waitcnt lgkmcnt(9)
    v_mfma_f32_16x16x32_bf16 v[24:27], v[172:175], v[88:91], v[24:27]
    ds_read_b128 v[84:87], v232 offset:7424
    v_mfma_f32_16x16x32_bf16 v[28:31], v[172:175], v[92:95], v[28:31]
    ds_read_b128 v[88:91], v247 offset:7232
    s_waitcnt lgkmcnt(9)
    v_mfma_f32_16x16x32_bf16 v[36:39], v[112:115], v[48:51], 0
    ds_read_b128 v[92:95], v232 offset:7488
    v_mfma_f32_16x16x32_bf16 v[40:43], v[112:115], v[52:55], 0
    ds_read_b128 v[48:51], v248 offset:128
    s_waitcnt lgkmcnt(9)
    v_mfma_f32_16x16x32_bf16 v[36:39], v[116:119], v[56:59], v[36:39]
    ds_read_b128 v[52:55], v225 offset:384
    v_mfma_f32_16x16x32_bf16 v[40:43], v[116:119], v[60:63], v[40:43]
    ds_read_b128 v[56:59], v248 offset:192
    s_waitcnt lgkmcnt(9)
    v_mfma_f32_16x16x32_bf16 v[36:39], v[120:123], v[64:67], v[36:39]
    ds_read_b128 v[60:63], v225 offset:448
    v_mfma_f32_16x16x32_bf16 v[40:43], v[120:123], v[68:71], v[40:43]
    ds_read_b128 v[64:67], v248 offset:640
    s_waitcnt lgkmcnt(9)
    v_mfma_f32_16x16x32_bf16 v[36:39], v[124:127], v[72:75], v[36:39]
    ds_read_b128 v[68:71], v225 offset:512
    v_mfma_f32_16x16x32_bf16 v[40:43], v[124:127], v[76:79], v[40:43]
    ds_read_b128 v[72:75], v248 offset:704
    s_waitcnt lgkmcnt(9)
    v_mfma_f32_16x16x32_bf16 v[36:39], v[144:147], v[80:83], v[36:39]
    ds_read_b128 v[76:79], v225 offset:576
    v_mfma_f32_16x16x32_bf16 v[40:43], v[144:147], v[84:87], v[40:43]
    ds_read_b128 v[80:83], v248 offset:1024
    s_waitcnt lgkmcnt(9)
    v_mfma_f32_16x16x32_bf16 v[36:39], v[148:151], v[88:91], v[36:39]
    ds_read_b128 v[84:87], v225 offset:1280
    v_mfma_f32_16x16x32_bf16 v[40:43], v[148:151], v[92:95], v[40:43]
    ds_read_b128 v[88:91], v248 offset:1088
    s_waitcnt lgkmcnt(9)
    v_mfma_f32_16x16x32_bf16 v[36:39], v[152:155], v[48:51], v[36:39]
    ds_read_b128 v[92:95], v225 offset:1344
    v_mfma_f32_16x16x32_bf16 v[40:43], v[152:155], v[52:55], v[40:43]
    s_waitcnt lgkmcnt(8)
    v_mfma_f32_16x16x32_bf16 v[36:39], v[156:159], v[56:59], v[36:39]
    v_mfma_f32_16x16x32_bf16 v[40:43], v[156:159], v[60:63], v[40:43]
    s_waitcnt lgkmcnt(6)
    v_mfma_f32_16x16x32_bf16 v[36:39], v[160:163], v[64:67], v[36:39]
    v_mfma_f32_16x16x32_bf16 v[40:43], v[160:163], v[68:71], v[40:43]
    s_waitcnt lgkmcnt(4)
    v_mfma_f32_16x16x32_bf16 v[36:39], v[164:167], v[72:75], v[36:39]
    v_mfma_f32_16x16x32_bf16 v[40:43], v[164:167], v[76:79], v[40:43]
    s_waitcnt lgkmcnt(2)
    v_mfma_f32_16x16x32_bf16 v[36:39], v[168:171], v[80:83], v[36:39]
    v_mfma_f32_16x16x32_bf16 v[40:43], v[168:171], v[84:87], v[40:43]
    s_waitcnt lgkmcnt(0)
    v_mfma_f32_16x16x32_bf16 v[36:39], v[172:175], v[88:91], v[36:39]
    v_mfma_f32_16x16x32_bf16 v[40:43], v[172:175], v[92:95], v[40:43]
    s_lshl_b32 s60, s54, 9
    s_lshl_b32 s61, s20, 6
    s_add_u32 s60, s60, s61
    s_mul_i32 s60, s60, 192
    s_add_u32 s60, s60, 10485760
    v_mul_u32_u24 v227, 96, v252
    s_cmp_lg_u32 s28, 0
    s_cbranch_scc1 K2_NOACC
    buffer_load_dwordx4 v[48:51], v227, s[8:11], s60 offen offset:0
    buffer_load_dwordx4 v[52:55], v227, s[8:11], s60 offen offset:16
    buffer_load_dwordx4 v[56:59], v227, s[8:11], s60 offen offset:32
    buffer_load_dwordx4 v[60:63], v227, s[8:11], s60 offen offset:48
    buffer_load_dwordx4 v[64:67], v227, s[8:11], s60 offen offset:64
    buffer_load_dwordx4 v[68:71], v227, s[8:11], s60 offen offset:80
    buffer_load_dwordx4 v[72:75], v227, s[8:11], s60 offen offset:96
    buffer_load_dwordx4 v[76:79], v227, s[8:11], s60 offen offset:112
    buffer_load_dwordx4 v[80:83], v227, s[8:11], s60 offen offset:128
    buffer_load_dwordx4 v[84:87], v227, s[8:11], s60 offen offset:144
    buffer_load_dwordx4 v[88:91], v227, s[8:11], s60 offen offset:160
    s_waitcnt vmcnt(0)
    v_add_f32 v0, v0, v48
    v_add_f32 v1, v1, v49
    v_add_f32 v2, v2, v50
    v_add_f32 v3, v3, v51
    v_add_f32 v4, v4, v52
    v_add_f32 v5, v5, v53
    v_add_f32 v6, v6, v54
    v_add_f32 v7, v7, v55
    v_add_f32 v8, v8, v56
    v_add_f32 v9, v9, v57
    v_add_f32 v10, v10, v58
    v_add_f32 v11, v11, v59
    v_add_f32 v12, v12, v60
    v_add_f32 v13, v13, v61
    v_add_f32 v14, v14, v62
    v_add_f32 v15, v15, v63
    v_add_f32 v16, v16, v64
    v_add_f32 v17, v17, v65
    v_add_f32 v18, v18, v66
    v_add_f32 v19, v19, v67
    v_add_f32 v20, v20, v68
    v_add_f32 v21, v21, v69
    v_add_f32 v22, v22, v70
    v_add_f32 v23, v23, v71
    v_add_f32 v24, v24, v72
    v_add_f32 v25, v25, v73
    v_add_f32 v26, v26, v74
    v_add_f32 v27, v27, v75
    v_add_f32 v28, v28, v76
    v_add_f32 v29, v29, v77
    v_add_f32 v30, v30, v78
    v_add_f32 v31, v31, v79
    v_add_f32 v32, v32, v80
    v_add_f32 v33, v33, v81
    v_add_f32 v34, v34, v82
    v_add_f32 v35, v35, v83
    v_add_f32 v36, v36, v84
    v_add_f32 v37, v37, v85
    v_add_f32 v38, v38, v86
    v_add_f32 v39, v39, v87
    v_add_f32 v40, v40, v88
    v_add_f32 v41, v41, v89
    v_add_f32 v42, v42, v90
    v_add_f32 v43, v43, v91
K2_NOACC:
    s_barrier
    s_cmp_eq_u32 s55, 0
    s_cbranch_scc1 K2_SPILL
    s_bfe_u32 s60, s20, 0x10002
    s_lshl_b32 s60, s60, 4
    s_add_u32 s59, s59, s60
    v_add_u32 v228, s59, v229
    s_mul_i32 s60, s20, 2080
    s_add_u32 s60, s60, 65536
    v_add_u32 v249, s60, v229
    s_mov_b32 s63, 0xbfb8aa3b
    s_add_u32 s40, s20, s21
    s_lshl_b32 s40, s40, 10
    s_add_u32 s41, s40, 8192
    s_add_u32 s42, s40, 16384
    s_add_u32 s43, s40, 24576
    s_add_u32 s44, s40, 32768
    v_mul_f32 v204, s63, v0
    v_mul_f32 v205, s63, v1
    v_mul_f32 v206, s63, v2
    v_mul_f32 v207, s63, v3
    v_exp_f32 v204, v204
    v_exp_f32 v205, v205
    v_exp_f32 v206, v206
    v_exp_f32 v207, v207
    v_add_f32 v204, 1.0, v204
    v_add_f32 v205, 1.0, v205
    v_add_f32 v206, 1.0, v206
    v_add_f32 v207, 1.0, v207
    v_rcp_f32 v204, v204
    v_rcp_f32 v205, v205
    v_rcp_f32 v206, v206
    v_rcp_f32 v207, v207
    v_cvt_pk_bf16_f32 v176, v0, v1
    v_cvt_pk_bf16_f32 v177, v2, v3
    v_mul_f32 v4, v4, v204
    v_mul_f32 v5, v5, v205
    v_mul_f32 v6, v6, v206
    v_mul_f32 v7, v7, v207
    v_cvt_pk_bf16_f32 v178, v4, v5
    v_cvt_pk_bf16_f32 v179, v6, v7
    v_mul_f32 v8, v8, v204
    v_mul_f32 v9, v9, v205
    v_mul_f32 v10, v10, v206
    v_mul_f32 v11, v11, v207
    v_cvt_pk_bf16_f32 v180, v8, v9
    v_cvt_pk_bf16_f32 v181, v10, v11
    v_mul_f32 v12, v12, v204
    v_mul_f32 v13, v13, v205
    v_mul_f32 v14, v14, v206
    v_mul_f32 v15, v15, v207
    v_cvt_pk_bf16_f32 v182, v12, v13
    v_cvt_pk_bf16_f32 v183, v14, v15
    ds_write_b64 v254, v[176:177] offset:0
    ds_write_b64 v254, v[178:179] offset:256
    ds_write_b64 v254, v[180:181] offset:512
    ds_write_b64 v254, v[182:183] offset:768
    s_waitcnt lgkmcnt(0)
    s_barrier
    ds_read_b128 v[192:195], v228 offset:0
    ds_read_b128 v[196:199], v228 offset:1536
    s_waitcnt lgkmcnt(0)
    buffer_store_dwordx4 v[192:195], v229, s[12:15], s40 offen sc1
    buffer_store_dwordx4 v[196:199], v229, s[12:15], s41 offen sc1
    v_mul_f32 v208, s63, v16
    v_mul_f32 v209, s63, v17
    v_mul_f32 v210, s63, v18
    v_mul_f32 v211, s63, v19
    v_exp_f32 v208, v208
    v_exp_f32 v209, v209
    v_exp_f32 v210, v210
    v_exp_f32 v211, v211
    v_add_f32 v208, 1.0, v208
    v_add_f32 v209, 1.0, v209
    v_add_f32 v210, 1.0, v210
    v_add_f32 v211, 1.0, v211
    v_rcp_f32 v208, v208
    v_rcp_f32 v209, v209
    v_rcp_f32 v210, v210
    v_rcp_f32 v211, v211
    v_cvt_pk_bf16_f32 v184, v16, v17
    v_cvt_pk_bf16_f32 v185, v18, v19
    v_mul_f32 v20, v20, v208
    v_mul_f32 v21, v21, v209
    v_mul_f32 v22, v22, v210
    v_mul_f32 v23, v23, v211
    v_cvt_pk_bf16_f32 v186, v20, v21
    v_cvt_pk_bf16_f32 v187, v22, v23
    v_mul_f32 v24, v24, v208
    v_mul_f32 v25, v25, v209
    v_mul_f32 v26, v26, v210
    v_mul_f32 v27, v27, v211
    v_cvt_pk_bf16_f32 v188, v24, v25
    v_cvt_pk_bf16_f32 v189, v26, v27
    v_mul_f32 v28, v28, v208
    v_mul_f32 v29, v29, v209
    v_mul_f32 v30, v30, v210
    v_mul_f32 v31, v31, v211
    v_cvt_pk_bf16_f32 v190, v28, v29
    v_cvt_pk_bf16_f32 v191, v30, v31
    ds_write_b64 v254, v[184:185] offset:3072
    ds_write_b64 v254, v[186:187] offset:3328
    ds_write_b64 v254, v[188:189] offset:3584
    ds_write_b64 v254, v[190:191] offset:3840
    s_waitcnt lgkmcnt(0)
    s_barrier
    ds_read_b128 v[192:195], v228 offset:3072
    ds_read_b128 v[196:199], v228 offset:4608
    s_waitcnt lgkmcnt(0)
    buffer_store_dwordx4 v[192:195], v229, s[12:15], s42 offen sc1
    buffer_store_dwordx4 v[196:199], v229, s[12:15], s43 offen sc1
    v_mul_f32 v212, s63, v32
    v_mul_f32 v213, s63, v33
    v_mul_f32 v214, s63, v34
    v_mul_f32 v215, s63, v35
    v_exp_f32 v212, v212
    v_exp_f32 v213, v213
    v_exp_f32 v214, v214
    v_exp_f32 v215, v215
    v_add_f32 v212, 1.0, v212
    v_add_f32 v213, 1.0, v213
    v_add_f32 v214, 1.0, v214
    v_add_f32 v215, 1.0, v215
    v_rcp_f32 v212, v212
    v_rcp_f32 v213, v213
    v_rcp_f32 v214, v214
    v_rcp_f32 v215, v215
    v_cvt_pk_bf16_f32 v220, v32, v33
    v_cvt_pk_bf16_f32 v221, v34, v35
    v_mul_f32 v36, v36, v212
    v_mul_f32 v37, v37, v213
    v_mul_f32 v38, v38, v214
    v_mul_f32 v39, v39, v215
    v_cvt_pk_bf16_f32 v178, v36, v37
    v_cvt_pk_bf16_f32 v179, v38, v39
    v_mul_f32 v40, v40, v212
    v_mul_f32 v41, v41, v213
    v_mul_f32 v42, v42, v214
    v_mul_f32 v43, v43, v215
    v_cvt_pk_bf16_f32 v180, v40, v41
    v_cvt_pk_bf16_f32 v181, v42, v43
    ds_write_b64 v255, v[220:221] offset:0
    ds_write_b64 v246, v[178:179] offset:256
    ds_write_b64 v255, v[180:181] offset:512
    s_waitcnt lgkmcnt(0)
    s_barrier
    ds_read_b128 v[200:203], v249
    s_branch K2_LASTROW
K2_SPILL:
    buffer_store_dwordx4 v[0:3], v227, s[8:11], s60 offen offset:0
    buffer_store_dwordx4 v[4:7], v227, s[8:11], s60 offen offset:16
    buffer_store_dwordx4 v[8:11], v227, s[8:11], s60 offen offset:32
    buffer_store_dwordx4 v[12:15], v227, s[8:11], s60 offen offset:48
    buffer_store_dwordx4 v[16:19], v227, s[8:11], s60 offen offset:64
    buffer_store_dwordx4 v[20:23], v227, s[8:11], s60 offen offset:80
    buffer_store_dwordx4 v[24:27], v227, s[8:11], s60 offen offset:96
    buffer_store_dwordx4 v[28:31], v227, s[8:11], s60 offen offset:112
    buffer_store_dwordx4 v[32:35], v227, s[8:11], s60 offen offset:128
    buffer_store_dwordx4 v[36:39], v227, s[8:11], s60 offen offset:144
    buffer_store_dwordx4 v[40:43], v227, s[8:11], s60 offen offset:160
    s_mov_b32 s28, 0
    s_waitcnt vmcnt(0)
    s_cmp_lt_u32 s24, s25
    s_cbranch_scc1 K2_LOAD
    s_add_u32 s23, s23, 20
    s_branch K2_WINDOW
KS_FLS:
    s_sub_u32 s25, s25, 1
    s_cbranch_scc1 K2_END
    v_mov_b32 v62, 163460
    ds_read_b32 v62, v62
    s_branch KS_JOIN2
K2_NOW0:
    buffer_load_dwordx4 v[76:79], v72, s[8:11], s67 offen sc1
    s_branch K2_W0
K2_WINDOW:
    s_mov_b32 s24, 0
    s_mov_b32 s25, 1
K2_LOAD:
    v_mbcnt_lo_u32_b32 v176, -1, 0
    v_mbcnt_hi_u32_b32 v176, -1, v176
    s_lshl_b32 s58, s20, 6
    v_add_u32 v177, s58, v176
    v_lshlrev_b32 v70, 4, v176
    s_mov_b32 s58, 7110656
    buffer_load_dwordx4 v[136:139], v70, s[8:11], s58 offen offset:0 sc1
    buffer_load_dwordx4 v[140:143], v70, s[8:11], s58 offen offset:1024 sc1
    s_mov_b32 s58, 7112704
    buffer_load_dwordx4 v[144:147], v70, s[8:11], s58 offen offset:0 sc1
    buffer_load_dwordx4 v[148:151], v70, s[8:11], s58 offen offset:1024 sc1
    s_mov_b32 s58, 7114752
    buffer_load_dwordx4 v[152:155], v70, s[8:11], s58 offen offset:0 sc1
    buffer_load_dwordx4 v[156:159], v70, s[8:11], s58 offen offset:1024 sc1
    s_mov_b32 s58, 7116800
    buffer_load_dwordx4 v[160:163], v70, s[8:11], s58 offen offset:0 sc1
    buffer_load_dwordx4 v[164:167], v70, s[8:11], s58 offen offset:1024 sc1
    s_mov_b32 s58, 7118848
    buffer_load_dwordx4 v[168:171], v70, s[8:11], s58 offen offset:0 sc1
    buffer_load_dwordx4 v[172:175], v70, s[8:11], s58 offen offset:1024 sc1
    s_mul_i32 s58, s20, 10400
    s_add_u32 s58, s58, 65536
    s_add_u32 s59, s58, 512
    v_and_b32 v76, 31, v176
    v_lshrrev_b32 v77, 5, v176
    v_mov_b32 v80, 0
    v_mul_u32_u24 v77, 2080, v77
    v_mov_b32 v81, 0xffff0000
    v_lshl_add_u32 v78, v76, 4, v77
    v_mov_b32 v82, 0
    v_add_u32 v78, s58, v78
    v_mov_b32 v83, v81
    v_add_u32 v85, 16, v176
    v_lshlrev_b32 v84, 5, v176
    v_lshrrev_b32 v85, 6, v85
    v_mul_u32_u24 v85, 1532, v85
    v_sub_u32 v84, v84, v85
    v_mov_b32 v85, -1
    v_add_u32 v84, s59, v84
    ds_write_b32 v84, v85 offset:0
    ds_write_b32 v84, v85 offset:2080
    ds_write_b32 v84, v85 offset:4160
    ds_write_b32 v84, v85 offset:6240
    ds_write_b32 v84, v85 offset:8320
    s_mov_b32 exec_hi, 0
    ds_write_b128 v78, v[80:83] offset:0
    ds_write_b128 v78, v[80:83] offset:2080
    ds_write_b128 v78, v[80:83] offset:4160
    ds_write_b128 v78, v[80:83] offset:6240
    ds_write_b128 v78, v[80:83] offset:8320
    s_mov_b32 exec_hi, -1
    s_cmp_lg_u32 s20, 7
    s_cbranch_scc1 K2_NOH
    v_mov_b32 v76, 0
    v_mov_b32 v77, -1
    v_lshlrev_b32 v78, 2, v176
    v_add_u32 v78, 163072, v78
    s_mov_b64 exec, 0x1ff
    ds_write_b32 v78, v76 offset:192
    s_mov_b32 exec_lo, 1
    ds_write_b32 v78, v76 offset:232
    s_mov_b32 exec_lo, -1
    ds_write_b32 v78, v77 offset:256
    s_mov_b64 exec, -1
    s_cmp_lg_u32 s24, 0
    s_cbranch_scc1 K2_NOH
    s_mov_b32 exec_hi, 0xffff
    ds_write_b32 v78, v76
    s_mov_b64 exec, 1
    ds_write_b32 v78, v76 offset:228
    s_mov_b64 exec, -1
K2_NOH:
    s_waitcnt lgkmcnt(0)
    s_barrier
    s_branch K2_CELLS
K2_LD_GEN:
    s_mov_b64 exec, s[42:43]
    s_cbranch_execz K2_LD_DONE
    buffer_load_dwordx4 v[4:7], v182, s[8:11], 0 offen sc1
    s_mov_b64 exec, s[44:45]
    s_cbranch_execz K2_LD_DONE
    buffer_load_dwordx4 v[8:11], v183, s[8:11], 0 offen sc1
    s_mov_b64 exec, s[46:47]
    s_cbranch_execz K2_LD_DONE
    buffer_load_dwordx4 v[12:15], v184, s[8:11], 0 offen sc1
    s_mov_b64 exec, s[48:49]
    s_cbranch_execz K2_LD_DONE
    buffer_load_dwordx4 v[16:19], v181, s[8:11], 0 offen offset:128 sc1
    s_mov_b64 exec, s[50:51]
    s_cbranch_execz K2_LD_DONE
    buffer_load_dwordx4 v[20:23], v181, s[8:11], 0 offen offset:160 sc1
    s_mov_b64 exec, s[90:91]
    s_cbranch_execz K2_LD_DONE
    buffer_load_dwordx4 v[24:27], v181, s[8:11], 0 offen offset:192 sc1
    s_mov_b64 exec, s[92:93]
    s_cbranch_execz K2_LD_DONE
    buffer_load_dwordx4 v[28:31], v181, s[8:11], 0 offen offset:224 sc1
    s_mov_b64 exec, s[94:95]
    s_cbranch_execz K2_LD_DONE
    buffer_load_dwordx4 v[32:35], v181, s[8:11], 0 offen offset:256 sc1
    s_mov_b64 exec, s[96:97]
    s_cbranch_execz K2_LD_DONE
    buffer_load_dwordx4 v[36:39], v181, s[8:11], 0 offen offset:288 sc1
    s_branch K2_LD_DONE
K2_WLATE:
    s_waitcnt vmcnt(0)
    v_lshlrev_b32 v96, 16, v136
    v_and_b32 v97, 0xffff0000, v136
    v_lshlrev_b32 v98, 16, v137
    v_and_b32 v99, 0xffff0000, v137
    v_lshlrev_b32 v100, 16, v138
    v_and_b32 v101, 0xffff0000, v138
    v_lshlrev_b32 v102, 16, v139
    v_and_b32 v103, 0xffff0000, v139
    v_lshlrev_b32 v104, 16, v140
    v_and_b32 v105, 0xffff0000, v140
    v_lshlrev_b32 v106, 16, v141
    v_and_b32 v107, 0xffff0000, v141
    v_lshlrev_b32 v108, 16, v142
    v_and_b32 v109, 0xffff0000, v142
    v_lshlrev_b32 v110, 16, v143
    v_and_b32 v111, 0xffff0000, v143
    v_lshlrev_b32 v112, 16, v144
    v_and_b32 v113, 0xffff0000, v144
    v_lshlrev_b32 v114, 16, v145
    v_and_b32 v115, 0xffff0000, v145
    v_lshlrev_b32 v116, 16, v146
    v_and_b32 v117, 0xffff0000, v146
    v_lshlrev_b32 v118, 16, v147
    v_and_b32 v119, 0xffff0000, v147
    v_lshlrev_b32 v120, 16, v148
    v_and_b32 v121, 0xffff0000, v148
    v_lshlrev_b32 v122, 16, v149
    v_and_b32 v123, 0xffff0000, v149
    v_lshlrev_b32 v124, 16, v150
    v_and_b32 v125, 0xffff0000, v150
    v_lshlrev_b32 v126, 16, v151
    v_and_b32 v127, 0xffff0000, v151
    v_lshlrev_b32 v128, 16, v152
    v_and_b32 v129, 0xffff0000, v152
    v_lshlrev_b32 v130, 16, v153
    v_and_b32 v131, 0xffff0000, v153
    v_lshlrev_b32 v132, 16, v154
    v_and_b32 v133, 0xffff0000, v154
    v_lshlrev_b32 v134, 16, v155
    v_and_b32 v135, 0xffff0000, v155
    v_lshlrev_b32 v136, 16, v156
    v_and_b32 v137, 0xffff0000, v156
    v_lshlrev_b32 v138, 16, v157
    v_and_b32 v139, 0xffff0000, v157
    v_lshlrev_b32 v140, 16, v158
    v_and_b32 v141, 0xffff0000, v158
    v_lshlrev_b32 v142, 16, v159
    v_and_b32 v143, 0xffff0000, v159
    v_lshlrev_b32 v144, 16, v160
    v_and_b32 v145, 0xffff0000, v160
    v_lshlrev_b32 v146, 16, v161
    v_and_b32 v147, 0xffff0000, v161
    v_lshlrev_b32 v148, 16, v162
    v_and_b32 v149, 0xffff0000, v162
    v_lshlrev_b32 v150, 16, v163
    v_and_b32 v151, 0xffff0000, v163
    v_lshlrev_b32 v152, 16, v164
    v_and_b32 v153, 0xffff0000, v164
    v_lshlrev_b32 v154, 16, v165
    v_and_b32 v155, 0xffff0000, v165
    v_lshlrev_b32 v156, 16, v166
    v_and_b32 v157, 0xffff0000, v166
    v_lshlrev_b32 v158, 16, v167
    v_and_b32 v159, 0xffff0000, v167
    v_lshlrev_b32 v160, 16, v168
    v_and_b32 v161, 0xffff0000, v168
    v_lshlrev_b32 v162, 16, v169
    v_and_b32 v163, 0xffff0000, v169
    v_lshlrev_b32 v164, 16, v170
    v_and_b32 v165, 0xffff0000, v170
    v_lshlrev_b32 v166, 16, v171
    v_and_b32 v167, 0xffff0000, v171
    v_lshlrev_b32 v168, 16, v172
    v_and_b32 v169, 0xffff0000, v172
    v_lshlrev_b32 v170, 16, v173
    v_and_b32 v171, 0xffff0000, v173
    v_lshlrev_b32 v172, 16, v174
    v_and_b32 v173, 0xffff0000, v174
    v_lshlrev_b32 v174, 16, v175
    v_and_b32 v175, 0xffff0000, v175
    s_branch K2_NOWRAW
K2_RT0:
    s_sub_u32 s60, s60, 1
    s_cbranch_scc1 K2_END
    s_mov_b64 exec, vcc
    buffer_load_dwordx4 v[0:3], v181, s[8:11], 0 offen offset:0 sc1
    s_mov_b64 exec, s[40:41]
    s_waitcnt vmcnt(0)
    s_branch K2_CK0
K2_RT1:
    s_sub_u32 s60, s60, 1
    s_cbranch_scc1 K2_END
    s_mov_b64 exec, vcc
    buffer_load_dwordx4 v[4:7], v182, s[8:11], 0 offen sc1
    s_mov_b64 exec, s[42:43]
    s_waitcnt vmcnt(0)
    s_branch K2_CK1
K2_RT2:
    s_sub_u32 s60, s60, 1
    s_cbranch_scc1 K2_END
    s_mov_b64 exec, vcc
    buffer_load_dwordx4 v[8:11], v183, s[8:11], 0 offen sc1
    s_mov_b64 exec, s[44:45]
    s_waitcnt vmcnt(0)
    s_branch K2_CK2
K2_RT3:
    s_sub_u32 s60, s60, 1
    s_cbranch_scc1 K2_END
    s_mov_b64 exec, vcc
    buffer_load_dwordx4 v[12:15], v184, s[8:11], 0 offen sc1
    s_mov_b64 exec, s[46:47]
    s_waitcnt vmcnt(0)
    s_branch K2_CK3
K2_RT4:
    s_sub_u32 s60, s60, 1
    s_cbranch_scc1 K2_END
    s_mov_b64 exec, vcc
    buffer_load_dwordx4 v[16:19], v181, s[8:11], 0 offen offset:128 sc1
    s_mov_b64 exec, s[48:49]
    s_waitcnt vmcnt(0)
    s_branch K2_CK4
K2_RT5:
    s_sub_u32 s60, s60, 1
    s_cbranch_scc1 K2_END
    s_mov_b64 exec, vcc
    buffer_load_dwordx4 v[20:23], v181, s[8:11], 0 offen offset:160 sc1
    s_mov_b64 exec, s[50:51]
    s_waitcnt vmcnt(0)
    s_branch K2_CK5
K2_RT6:
    s_sub_u32 s60, s60, 1
    s_cbranch_scc1 K2_END
    s_mov_b64 exec, vcc
    buffer_load_dwordx4 v[24:27], v181, s[8:11], 0 offen offset:192 sc1
    s_mov_b64 exec, s[90:91]
    s_waitcnt vmcnt(0)
    s_branch K2_CK6
K2_RT7:
    s_sub_u32 s60, s60, 1
    s_cbranch_scc1 K2_END
    s_mov_b64 exec, vcc
    buffer_load_dwordx4 v[28:31], v181, s[8:11], 0 offen offset:224 sc1
    s_mov_b64 exec, s[92:93]
    s_waitcnt vmcnt(0)
    s_branch K2_CK7
K2_RT8:
    s_sub_u32 s60, s60, 1
    s_cbranch_scc1 K2_END
    s_mov_b64 exec, vcc
    buffer_load_dwordx4 v[32:35], v181, s[8:11], 0 offen offset:256 sc1
    s_mov_b64 exec, s[94:95]
    s_waitcnt vmcnt(0)
    s_branch K2_CK8
K2_RT9:
    s_sub_u32 s60, s60, 1
    s_cbranch_scc1 K2_END
    s_mov_b64 exec, vcc
    buffer_load_dwordx4 v[36:39], v181, s[8:11], 0 offen offset:288 sc1
    s_mov_b64 exec, s[96:97]
    s_waitcnt vmcnt(0)
    s_branch K2_CK9
K2_RK_LOAD:
    s_waitcnt vmcnt(0)
    s_mov_b64 exec, s[40:41]
    s_cbranch_execz K2_RK_B
    v_lshrrev_b32 v50, 24, v3
    buffer_load_dword v40, v179, s[8:11], s66 offen offset:0
    v_mad_u32_u24 v50, v50, s58, v202
    v_and_b32 v3, 0xffffff, v3
    s_mov_b64 exec, s[42:43]
    s_cbranch_execz K2_RK_B
    v_lshrrev_b32 v51, 24, v7
    buffer_load_dword v41, v185, s[8:11], s66 offen
    v_mad_u32_u24 v51, v51, s58, v202
    v_and_b32 v7, 0xffffff, v7
    s_mov_b64 exec, s[44:45]
    s_cbranch_execz K2_RK_B
    v_lshrrev_b32 v52, 24, v11
    buffer_load_dword v42, v186, s[8:11], s66 offen
    v_mad_u32_u24 v52, v52, s58, v202
    v_and_b32 v11, 0xffffff, v11
    s_mov_b64 exec, s[46:47]
    s_cbranch_execz K2_RK_B
    v_lshrrev_b32 v53, 24, v15
    buffer_load_dword v43, v187, s[8:11], s66 offen
    v_mad_u32_u24 v53, v53, s58, v202
    v_and_b32 v15, 0xffffff, v15
    s_mov_b64 exec, s[48:49]
    s_cbranch_execz K2_RK_B
    v_lshrrev_b32 v54, 24, v19
    buffer_load_dword v44, v179, s[8:11], s66 offen offset:32
    v_mad_u32_u24 v54, v54, s58, v202
    v_and_b32 v19, 0xffffff, v19
    s_mov_b64 exec, s[50:51]
    s_cbranch_execz K2_RK_B
    v_lshrrev_b32 v55, 24, v23
    buffer_load_dword v45, v179, s[8:11], s66 offen offset:40
    v_mad_u32_u24 v55, v55, s58, v202
    v_and_b32 v23, 0xffffff, v23
    s_mov_b64 exec, s[90:91]
    s_cbranch_execz K2_RK_B
    v_lshrrev_b32 v56, 24, v27
    buffer_load_dword v46, v179, s[8:11], s66 offen offset:48
    v_mad_u32_u24 v56, v56, s58, v202
    v_and_b32 v27, 0xffffff, v27
    s_mov_b64 exec, s[92:93]
    s_cbranch_execz K2_RK_B
    v_lshrrev_b32 v57, 24, v31
    buffer_load_dword v47, v179, s[8:11], s66 offen offset:56
    v_mad_u32_u24 v57, v57, s58, v202
    v_and_b32 v31, 0xffffff, v31
    s_mov_b64 exec, s[94:95]
    s_cbranch_execz K2_RK_B
    v_lshrrev_b32 v58, 24, v35
    buffer_load_dword v48, v179, s[8:11], s66 offen offset:64
    v_mad_u32_u24 v58, v58, s58, v202
    v_and_b32 v35, 0xffffff, v35
    s_mov_b64 exec, s[96:97]
    s_cbranch_execz K2_RK_B
    v_lshrrev_b32 v59, 24, v39
    buffer_load_dword v49, v179, s[8:11], s66 offen offset:72
    v_mad_u32_u24 v59, v59, s58, v202
    v_and_b32 v39, 0xffffff, v39
K2_RK_B:
    s_mov_b64 exec, -1
    s_mul_i32 s62, s24, 48
    s_waitcnt vmcnt(0)
    v_subrev_u32 v40, s62, v40
    v_subrev_u32 v41, s62, v41
    v_subrev_u32 v42, s62, v42
    v_subrev_u32 v43, s62, v43
    v_subrev_u32 v44, s62, v44
    v_subrev_u32 v45, s62, v45
    v_subrev_u32 v46, s62, v46
    v_subrev_u32 v47, s62, v47
    v_subrev_u32 v48, s62, v48
    v_subrev_u32 v49, s62, v49
    s_branch K2_RK_DONE
K2_BIG:
    s_cmp_lg_u32 s24, 0
    s_cbranch_scc1 K2_TOK
    s_movk_i32 s26, 48
    v_mov_b32 v197, v193
    s_nop 1
    v_max_u32_dpp v197, v197, v197 row_shr:1 row_mask:0xf bank_mask:0xf bound_ctrl:0
    s_nop 1
    v_max_u32_dpp v197, v197, v197 row_shr:2 row_mask:0xf bank_mask:0xf bound_ctrl:0
    s_nop 1
    v_max_u32_dpp v197, v197, v197 row_shr:4 row_mask:0xf bank_mask:0xf bound_ctrl:0
    s_nop 1
    v_max_u32_dpp v197, v197, v197 row_shr:8 row_mask:0xf bank_mask:0xf bound_ctrl:0
    s_nop 1
    v_max_u32_dpp v197, v197, v197 row_bcast:15 row_mask:0xa bank_mask:0xf
    s_nop 1
    v_max_u32_dpp v197, v197, v197 row_bcast:31 row_mask:0xc bank_mask:0xf
    s_nop 0
    v_readlane_b32 s25, v197, 63
    s_nop 0
    s_add_u32 s25, s25, 47
    s_mul_i32 s25, s25, 43691
    s_lshr_b32 s25, s25, 21
    s_mov_b64 exec, s[40:41]
    s_cbranch_execz K2_SV_DONE
    buffer_store_dword v40, v179, s[8:11], s66 offen offset:0
    s_mov_b64 exec, s[42:43]
    s_cbranch_execz K2_SV_DONE
    buffer_store_dword v41, v185, s[8:11], s66 offen
    s_mov_b64 exec, s[44:45]
    s_cbranch_execz K2_SV_DONE
    buffer_store_dword v42, v186, s[8:11], s66 offen
    s_mov_b64 exec, s[46:47]
    s_cbranch_execz K2_SV_DONE
    buffer_store_dword v43, v187, s[8:11], s66 offen
    s_mov_b64 exec, s[48:49]
    s_cbranch_execz K2_SV_DONE
    buffer_store_dword v44, v179, s[8:11], s66 offen offset:32
    s_mov_b64 exec, s[50:51]
    s_cbranch_execz K2_SV_DONE
    buffer_store_dword v45, v179, s[8:11], s66 offen offset:40
    s_mov_b64 exec, s[90:91]
    s_cbranch_execz K2_SV_DONE
    buffer_store_dword v46, v179, s[8:11], s66 offen offset:48
    s_mov_b64 exec, s[92:93]
    s_cbranch_execz K2_SV_DONE
    buffer_store_dword v47, v179, s[8:11], s66 offen offset:56
    s_mov_b64 exec, s[94:95]
    s_cbranch_execz K2_SV_DONE
    buffer_store_dword v48, v179, s[8:11], s66 offen offset:64
    s_mov_b64 exec, s[96:97]
    s_cbranch_execz K2_SV_DONE
    buffer_store_dword v49, v179, s[8:11], s66 offen offset:72
K2_SV_DONE:
    s_mov_b64 exec, -1
    s_branch K2_TOK
K2_rare_1:
    s_cmp_eq_u32 s33, 4
    s_cbranch_scc1 K2_four_3
    s_mov_b32 s49, s48
    s_xor_b32 s45, s44, 256
    s_xor_b32 s46, s44, 512
    s_xor_b32 s47, s44, 768
    s_branch K2_back_2
K2_four_3:
    s_add_u32 s50, s48, 256
    s_mov_b32 s46, s44
    s_mov_b32 s47, s44
    s_branch K2_back_2
K2_a4_5:
    v_add_u32 v254, s48, v230
    ds_read_b32 v254, v254 offset:4
    s_lshr_b32 s65, s3, 28
    s_mul_i32 s66, s22, 2080
    s_lshl_b32 s65, s65, 9
    s_add_u32 s65, s65, s66
    s_add_u32 s65, s65, 65536
    s_mov_b32 m0, s65
    s_mov_b32 exec_hi, 0
    s_waitcnt lgkmcnt(0)
    v_or_b32 v254, v254, v231
    buffer_load_dwordx4 v254, s[16:19], 0 offen  lds
    s_mov_b32 exec_hi, -1
    s_branch K2_b4_7
K2_g4_8:
    s_add_u32 s51, s48, 384
    v_add_u32 v228, s51, v251
    ds_read2_b32 v[228:229], v228 offset0:1 offset1:3
    s_waitcnt lgkmcnt(0)
    v_mad_u32_u16 v228, v228, s39, v248 op_sel:[1,0,0,0]
    v_mad_u32_u16 v229, v229, s39, v248 op_sel:[1,0,0,0]
    buffer_load_dwordx4 v228, s[4:7], s47 offen sc1 lds
    buffer_load_dwordx4 v229, s[72:75], s47 offen offset:1024 sc1 lds
    s_branch K2_back_9
K2_rare_16:
    s_cmp_eq_u32 s33, 4
    s_cbranch_scc1 K2_four_18
    s_mov_b32 s49, s48
    s_xor_b32 s45, s44, 256
    s_xor_b32 s46, s44, 512
    s_xor_b32 s47, s44, 768
    s_branch K2_back_17
K2_four_18:
    s_add_u32 s50, s48, 256
    s_mov_b32 s46, s44
    s_mov_b32 s47, s44
    s_branch K2_back_17
K2_g4_19:
    s_add_u32 s51, s48, 384
    v_add_u32 v228, s51, v251
    ds_read2_b32 v[228:229], v228 offset0:1 offset1:3
    s_waitcnt lgkmcnt(0)
    v_mad_u32_u16 v228, v228, s39, v248 op_sel:[1,0,0,0]
    v_mad_u32_u16 v229, v229, s39, v248 op_sel:[1,0,0,0]
    buffer_load_dwordx4 v228, s[4:7], s47 offen sc1 lds
    buffer_load_dwordx4 v229, s[72:75], s47 offen offset:1024 sc1 lds
    s_branch K2_back_20
K2_a4_22:
    v_add_u32 v254, s48, v230
    ds_read_b32 v254, v254 offset:4
    s_lshr_b32 s65, s3, 28
    s_mul_i32 s66, s22, 2080
    s_lshl_b32 s65, s65, 9
    s_add_u32 s65, s65, s66
    s_add_u32 s65, s65, 65536
    s_mov_b32 m0, s65
    s_mov_b32 exec_hi, 0
    s_waitcnt lgkmcnt(0)
    v_or_b32 v254, v254, v231
    buffer_load_dwordx4 v254, s[16:19], 0 offen  lds
    s_mov_b32 exec_hi, -1
    s_branch K2_b4_24
K2_rare_31:
    s_cmp_eq_u32 s33, 4
    s_cbranch_scc1 K2_four_33
    s_mov_b32 s49, s48
    s_xor_b32 s45, s44, 256
    s_xor_b32 s46, s44, 512
    s_xor_b32 s47, s44, 768
    s_branch K2_back_32
K2_four_33:
    s_add_u32 s50, s48, 256
    s_mov_b32 s46, s44
    s_mov_b32 s47, s44
    s_branch K2_back_32
K2_g4_34:
    s_add_u32 s51, s48, 384
    v_add_u32 v228, s51, v251
    ds_read2_b32 v[228:229], v228 offset0:1 offset1:3
    s_waitcnt lgkmcnt(0)
    v_mad_u32_u16 v228, v228, s39, v248 op_sel:[1,0,0,0]
    v_mad_u32_u16 v229, v229, s39, v248 op_sel:[1,0,0,0]
    buffer_load_dwordx4 v228, s[4:7], s47 offen sc1 lds
    buffer_load_dwordx4 v229, s[72:75], s47 offen offset:1024 sc1 lds
    s_branch K2_back_35
K2_a4_37:
    v_add_u32 v254, s48, v230
    ds_read_b32 v254, v254 offset:4
    s_lshr_b32 s65, s3, 28
    s_mul_i32 s66, s22, 2080
    s_lshl_b32 s65, s65, 9
    s_add_u32 s65, s65, s66
    s_add_u32 s65, s65, 65536
    s_mov_b32 m0, s65
    s_mov_b32 exec_hi, 0
    s_waitcnt lgkmcnt(0)
    v_or_b32 v254, v254, v231
    buffer_load_dwordx4 v254, s[16:19], 0 offen  lds
    s_mov_b32 exec_hi, -1
    s_branch K2_b4_39
K2_rare_46:
    s_cmp_eq_u32 s33, 4
    s_cbranch_scc1 K2_four_48
    s_mov_b32 s49, s48
    s_xor_b32 s45, s44, 256
    s_xor_b32 s46, s44, 512
    s_xor_b32 s47, s44, 768
    s_branch K2_back_47
K2_four_48:
    s_add_u32 s50, s48, 256
    s_mov_b32 s46, s44
    s_mov_b32 s47, s44
    s_branch K2_back_47
K2_g4_49:
    s_add_u32 s51, s48, 384
    v_add_u32 v228, s51, v251
    ds_read2_b32 v[228:229], v228 offset0:1 offset1:3
    s_waitcnt lgkmcnt(0)
    v_mad_u32_u16 v228, v228, s39, v248 op_sel:[1,0,0,0]
    v_mad_u32_u16 v229, v229, s39, v248 op_sel:[1,0,0,0]
    buffer_load_dwordx4 v228, s[4:7], s47 offen sc1 lds
    buffer_load_dwordx4 v229, s[72:75], s47 offen offset:1024 sc1 lds
    s_branch K2_back_50
K2_a4_52:
    v_add_u32 v254, s48, v230
    ds_read_b32 v254, v254 offset:4
    s_lshr_b32 s65, s3, 28
    s_mul_i32 s66, s22, 2080
    s_lshl_b32 s65, s65, 9
    s_add_u32 s65, s65, s66
    s_add_u32 s65, s65, 65536
    s_mov_b32 m0, s65
    s_mov_b32 exec_hi, 0
    s_waitcnt lgkmcnt(0)
    v_or_b32 v254, v254, v231
    buffer_load_dwordx4 v254, s[16:19], 0 offen  lds
    s_mov_b32 exec_hi, -1
    s_branch K2_b4_54
K2_rare_59:
    s_cmp_eq_u32 s33, 4
    s_cbranch_scc1 K2_four_61
    s_mov_b32 s49, s48
    s_xor_b32 s45, s44, 256
    s_xor_b32 s46, s44, 512
    s_xor_b32 s47, s44, 768
    s_branch K2_back_60
K2_four_61:
    s_add_u32 s50, s48, 256
    s_mov_b32 s46, s44
    s_mov_b32 s47, s44
    s_branch K2_back_60
K2_g4_62:
    s_add_u32 s51, s48, 384
    v_add_u32 v228, s51, v251
    ds_read2_b32 v[228:229], v228 offset0:1 offset1:3
    s_waitcnt lgkmcnt(0)
    v_mad_u32_u16 v228, v228, s39, v248 op_sel:[1,0,0,0]
    v_mad_u32_u16 v229, v229, s39, v248 op_sel:[1,0,0,0]
    buffer_load_dwordx4 v228, s[4:7], s47 offen sc1 lds
    buffer_load_dwordx4 v229, s[72:75], s47 offen offset:1024 sc1 lds
    s_branch K2_back_63
K2_rare_68:
    s_cmp_eq_u32 s33, 4
    s_cbranch_scc1 K2_four_70
    s_mov_b32 s49, s48
    s_xor_b32 s45, s44, 256
    s_xor_b32 s46, s44, 512
    s_xor_b32 s47, s44, 768
    s_branch K2_back_69
K2_four_70:
    s_add_u32 s50, s48, 256
    s_mov_b32 s46, s44
    s_mov_b32 s47, s44
    s_branch K2_back_69
K2_g4_71:
    s_add_u32 s51, s48, 384
    v_add_u32 v228, s51, v251
    ds_read2_b32 v[228:229], v228 offset0:1 offset1:3
    s_waitcnt lgkmcnt(0)
    v_mad_u32_u16 v228, v228, s39, v248 op_sel:[1,0,0,0]
    v_mad_u32_u16 v229, v229, s39, v248 op_sel:[1,0,0,0]
    buffer_load_dwordx4 v228, s[4:7], s47 offen sc1 lds
    buffer_load_dwordx4 v229, s[72:75], s47 offen offset:1024 sc1 lds
    s_branch K2_back_72
K2_rare_77:
    s_cmp_eq_u32 s33, 4
    s_cbranch_scc1 K2_four_79
    s_mov_b32 s49, s48
    s_xor_b32 s45, s44, 256
    s_xor_b32 s46, s44, 512
    s_xor_b32 s47, s44, 768
    s_branch K2_back_78
K2_four_79:
    s_add_u32 s50, s48, 256
    s_mov_b32 s46, s44
    s_mov_b32 s47, s44
    s_branch K2_back_78
K2_g4_80:
    s_add_u32 s51, s48, 384
    v_add_u32 v228, s51, v251
    ds_read2_b32 v[228:229], v228 offset0:1 offset1:3
    s_waitcnt lgkmcnt(0)
    v_mad_u32_u16 v228, v228, s39, v248 op_sel:[1,0,0,0]
    v_mad_u32_u16 v229, v229, s39, v248 op_sel:[1,0,0,0]
    buffer_load_dwordx4 v228, s[4:7], s47 offen sc1 lds
    buffer_load_dwordx4 v229, s[72:75], s47 offen offset:1024 sc1 lds
    s_branch K2_back_81
K2_rare_86:
    s_cmp_eq_u32 s33, 4
    s_cbranch_scc1 K2_four_88
    s_mov_b32 s49, s48
    s_xor_b32 s45, s44, 256
    s_xor_b32 s46, s44, 512
    s_xor_b32 s47, s44, 768
    s_branch K2_back_87
K2_four_88:
    s_add_u32 s50, s48, 256
    s_mov_b32 s46, s44
    s_mov_b32 s47, s44
    s_branch K2_back_87
K2_g4_89:
    s_add_u32 s51, s48, 384
    v_add_u32 v228, s51, v251
    ds_read2_b32 v[228:229], v228 offset0:1 offset1:3
    s_waitcnt lgkmcnt(0)
    v_mad_u32_u16 v228, v228, s39, v248 op_sel:[1,0,0,0]
    v_mad_u32_u16 v229, v229, s39, v248 op_sel:[1,0,0,0]
    buffer_load_dwordx4 v228, s[4:7], s47 offen sc1 lds
    buffer_load_dwordx4 v229, s[72:75], s47 offen offset:1024 sc1 lds
    s_branch K2_back_90
K2_U10:
    s_setprio 1
    s_add_u32 s38, s38, 1
    v_mov_b32 v254, s52
    v_mov_b32 v255, s38
    s_lshl_b32 s58, s38, 3
    s_add_u32 s58, s58, s20
    s_mov_b64 exec, 1
    ds_write_b32 v254, v255
    s_mov_b64 exec, -1
    s_cmp_lt_u32 s58, s22
    s_cbranch_scc0 K2_dyn_91
K2_back_92:
    s_waitcnt lgkmcnt(4)
    v_lshlrev_b32 v20, 16, v0
    v_and_b32 v21, 0xffff0000, v0
    v_lshlrev_b32 v22, 16, v1
    v_and_b32 v23, 0xffff0000, v1
    v_lshlrev_b32 v24, 16, v2
    v_and_b32 v25, 0xffff0000, v2
    v_lshlrev_b32 v26, 16, v3
    v_and_b32 v27, 0xffff0000, v3
    v_mul_f32_dpp v36, v16, v20 row_newbcast:8 row_mask:0xf bank_mask:0xf
    v_mul_f32_dpp v37, v16, v21 row_newbcast:9 row_mask:0xf bank_mask:0xf
    v_mul_f32_dpp v38, v16, v22 row_newbcast:10 row_mask:0xf bank_mask:0xf
    v_mul_f32_dpp v39, v16, v23 row_newbcast:11 row_mask:0xf bank_mask:0xf
    v_mul_f32_dpp v40, v16, v24 row_newbcast:12 row_mask:0xf bank_mask:0xf
    v_mul_f32_dpp v41, v16, v25 row_newbcast:13 row_mask:0xf bank_mask:0xf
    v_mul_f32_dpp v42, v16, v26 row_newbcast:14 row_mask:0xf bank_mask:0xf
    v_mul_f32_dpp v43, v16, v27 row_newbcast:15 row_mask:0xf bank_mask:0xf
    v_cvt_pk_bf16_f32 v68, v36, v37
    v_cvt_pk_bf16_f32 v69, v38, v39
    v_cvt_pk_bf16_f32 v70, v40, v41
    v_cvt_pk_bf16_f32 v71, v42, v43
    v_mul_f32_dpp v20, v16, v20 row_newbcast:0 row_mask:0xa bank_mask:0xf
    v_mul_f32_dpp v21, v16, v21 row_newbcast:1 row_mask:0xa bank_mask:0xf
    v_mul_f32_dpp v22, v16, v22 row_newbcast:2 row_mask:0xa bank_mask:0xf
    v_mul_f32_dpp v23, v16, v23 row_newbcast:3 row_mask:0xa bank_mask:0xf
    v_mul_f32_dpp v24, v16, v24 row_newbcast:4 row_mask:0xa bank_mask:0xf
    v_mul_f32_dpp v25, v16, v25 row_newbcast:5 row_mask:0xa bank_mask:0xf
    v_mul_f32_dpp v26, v16, v26 row_newbcast:6 row_mask:0xa bank_mask:0xf
    v_mul_f32_dpp v27, v16, v27 row_newbcast:7 row_mask:0xa bank_mask:0xf
    v_cvt_pk_bf16_f32 v64, v20, v21
    v_cvt_pk_bf16_f32 v65, v22, v23
    v_cvt_pk_bf16_f32 v66, v24, v25
    v_cvt_pk_bf16_f32 v67, v26, v27
    v_readlane_b32 s3, v253, s58
    s_lshl_b32 s44, s34, 7
    s_and_b32 s48, s3, 0x3ffff
    s_bfe_u32 s33, s3, 0x30013
    s_mul_i32 s35, s38, 6
    s_cmp_eq_u32 s34, 0
    s_cselect_b32 s35, s35, s48
    s_mov_b32 s45, s44
    s_xor_b32 s47, s44, 256
    s_add_u32 s49, s48, 128
    s_add_u32 s60, s48, 256
    s_cmp_eq_u32 s33, 3
    s_cselect_b32 s46, s44, s47
    s_cselect_b32 s50, s60, s48
    s_sub_u32 s60, s33, 2
    s_cmp_lt_u32 s60, 2
    s_cbranch_scc0 K2_rare_97
K2_back_98:
    v_add_u32 v233, s48, v230
    ds_read_b32 v232, v233
    ds_read_b32 v233, v233 offset:1024
    v_add_u32 v222, s48, v251
    ds_read2_b32 v[222:223], v222 offset0:1 offset1:3
    v_add_u32 v224, s49, v251
    ds_read2_b32 v[224:225], v224 offset0:1 offset1:3
    v_add_u32 v226, s50, v251
    ds_read2_b32 v[226:227], v226 offset0:1 offset1:3
    s_waitcnt lgkmcnt(3)
    v_or_b32 v232, v232, v231
    v_or_b32 v233, v233, v231
    s_cmp_lg_u32 s34, 0
    s_cbranch_scc1 K2_dum_100
    s_cmp_eq_u32 s33, 4
    s_cbranch_scc1 K2_a4_101
K2_b4_103:
    s_add_u32 m0, s48, 512
    s_add_u32 s65, s48, 1536
    buffer_load_dwordx4 v232, s[16:19], 0 offen  lds
    s_mov_b32 m0, s65
    s_mov_b32 exec_hi, 0
    buffer_load_dwordx4 v233, s[16:19], 0 offen  lds
    s_mov_b32 exec_hi, -1
K2_back_102:
    s_waitcnt lgkmcnt(2)
    v_mad_u32_u16 v222, v222, s39, v248 op_sel:[1,0,0,0]
    v_mad_u32_u16 v223, v223, s39, v248 op_sel:[1,0,0,0]
    s_waitcnt lgkmcnt(1)
    v_mad_u32_u16 v224, v224, s39, v248 op_sel:[1,0,0,0]
    v_mad_u32_u16 v225, v225, s39, v248 op_sel:[1,0,0,0]
    s_waitcnt lgkmcnt(0)
    v_mad_u32_u16 v226, v226, s39, v248 op_sel:[1,0,0,0]
    v_mad_u32_u16 v227, v227, s39, v248 op_sel:[1,0,0,0]
    s_waitcnt vmcnt(6)
    v_mfma_f32_32x32x16_bf16 v[0:15], v[64:67], v[176:179], 0
    ds_read_b64_tr_b16 v[184:185], v246 offset:2048
    ds_read_b64_tr_b16 v[186:187], v246 offset:3072
    ds_read_b64_tr_b16 v[188:189], v247 offset:2048
    ds_read_b64_tr_b16 v[190:191], v247 offset:3072
    s_mov_b32 m0, s68
    v_mfma_f32_32x32x16_bf16 v[16:31], v[68:71], v[176:179], 0
    buffer_load_dwordx4 v222, s[4:7], s44 offen sc1 lds
    buffer_load_dwordx4 v223, s[72:75], s44 offen offset:1024 sc1 lds
    v_permlane32_swap_b32 v242, v236
    v_permlane32_swap_b32 v243, v237
    v_mfma_f32_32x32x16_bf16 v[32:47], v[64:67], v[180:183], 0
    v_permlane32_swap_b32 v244, v238
    v_permlane32_swap_b32 v245, v239
    v_permlane32_swap_b32 v240, v241
    v_add_f32 v242, v242, v236
    v_mfma_f32_32x32x16_bf16 v[48:63], v[68:71], v[180:183], 0
    s_setprio 0
    v_add_f32 v243, v243, v237
    v_add_f32 v244, v244, v238
    v_add_f32 v245, v245, v239
    v_add_f32 v240, -v240, -v241
    s_set_gpr_idx_on s32, gpr_idx(DST)
    s_nop 0
    v_cvt_pk_bf16_f32 v195, v242, v243
    v_cvt_pk_bf16_f32 v196, v244, v245
    v_cvt_pk_bf16_f32 v197, v240, v240
    s_set_gpr_idx_off
    v_mul_f32 v234, v0, v96
    v_mul_f32 v236, v8, v128
    v_fmac_f32 v234, v1, v97
    v_fmac_f32 v236, v9, v129
    v_fmac_f32 v234, v2, v98
    v_fmac_f32 v236, v10, v130
    v_fmac_f32 v234, v3, v99
    v_fmac_f32 v236, v11, v131
    v_fmac_f32 v234, v4, v100
    v_fmac_f32 v236, v12, v132
    v_fmac_f32 v234, v5, v101
    v_fmac_f32 v236, v13, v133
    v_fmac_f32 v234, v6, v102
    v_fmac_f32 v236, v14, v134
    v_fmac_f32 v234, v7, v103
    v_fmac_f32 v236, v15, v135
    v_mul_f32 v238, v16, v128
    v_mul_f32 v240, v24, v128
    v_fmac_f32 v238, v17, v129
    v_fmac_f32 v240, v25, v129
    v_fmac_f32 v238, v18, v130
    v_fmac_f32 v240, v26, v130
    v_fmac_f32 v238, v19, v131
    v_fmac_f32 v240, v27, v131
    v_fmac_f32 v238, v20, v132
    v_fmac_f32 v240, v28, v132
    v_fmac_f32 v238, v21, v133
    v_fmac_f32 v240, v29, v133
    v_fmac_f32 v238, v22, v134
    v_fmac_f32 v240, v30, v134
    v_fmac_f32 v238, v23, v135
    v_fmac_f32 v240, v31, v135
    v_mul_f32 v235, v32, v104
    v_mul_f32 v237, v40, v136
    v_fmac_f32 v235, v33, v105
    v_fmac_f32 v237, v41, v137
    v_fmac_f32 v235, v34, v106
    v_fmac_f32 v237, v42, v138
    v_fmac_f32 v235, v35, v107
    v_fmac_f32 v237, v43, v139
    v_fmac_f32 v235, v36, v108
    v_fmac_f32 v237, v44, v140
    v_fmac_f32 v235, v37, v109
    v_fmac_f32 v237, v45, v141
    v_fmac_f32 v235, v38, v110
    v_fmac_f32 v237, v46, v142
    v_fmac_f32 v235, v39, v111
    v_fmac_f32 v237, v47, v143
    v_mul_f32 v239, v48, v136
    v_mul_f32 v241, v56, v136
    v_fmac_f32 v239, v49, v137
    v_fmac_f32 v241, v57, v137
    v_fmac_f32 v239, v50, v138
    v_fmac_f32 v241, v58, v138
    v_fmac_f32 v239, v51, v139
    v_fmac_f32 v241, v59, v139
    v_fmac_f32 v239, v52, v140
    v_fmac_f32 v241, v60, v140
    v_fmac_f32 v239, v53, v141
    v_fmac_f32 v241, v61, v141
    v_fmac_f32 v239, v54, v142
    v_fmac_f32 v241, v62, v142
    v_fmac_f32 v239, v55, v143
    v_fmac_f32 v241, v63, v143
    s_setprio 1
    s_waitcnt vmcnt(6) lgkmcnt(0)
    v_mfma_f32_32x32x16_bf16 v[0:15], v[64:67], v[184:187], 0
    ds_read_b64_tr_b16 v[176:177], v246 offset:4096
    ds_read_b64_tr_b16 v[178:179], v246 offset:5120
    ds_read_b64_tr_b16 v[180:181], v247 offset:4096
    ds_read_b64_tr_b16 v[182:183], v247 offset:5120
    s_mov_b32 m0, s69
    v_mfma_f32_32x32x16_bf16 v[16:31], v[68:71], v[184:187], 0
    buffer_load_dwordx4 v224, s[4:7], s45 offen sc1 lds
    buffer_load_dwordx4 v225, s[72:75], s45 offen offset:1024 sc1 lds
    v_permlane32_swap_b32 v234, v236
    v_permlane32_swap_b32 v235, v237
    v_mfma_f32_32x32x16_bf16 v[32:47], v[64:67], v[188:191], 0
    v_permlane32_swap_b32 v240, v238
    v_permlane32_swap_b32 v241, v239
    v_add_f32 v234, v234, v236
    v_add_f32 v235, v235, v237
    v_add_f32 v240, v240, v238
    v_mfma_f32_32x32x16_bf16 v[48:63], v[68:71], v[188:191], 0
    s_setprio 0
    v_add_f32 v241, v241, v239
    s_set_gpr_idx_on s31, gpr_idx(DST)
    s_nop 0
    v_cvt_pk_bf16_f32 v192, v234, v235
    v_cvt_pk_bf16_f32 v193, v240, v241
    s_set_gpr_idx_off
    v_mul_f32 v234, v0, v144
    v_mul_f32 v236, v8, v112
    v_fmac_f32 v234, v1, v145
    v_fmac_f32 v236, v9, v113
    v_fmac_f32 v234, v2, v146
    v_fmac_f32 v236, v10, v114
    v_fmac_f32 v234, v3, v147
    v_fmac_f32 v236, v11, v115
    v_fmac_f32 v234, v4, v148
    v_fmac_f32 v236, v12, v116
    v_fmac_f32 v234, v5, v149
    v_fmac_f32 v236, v13, v117
    v_fmac_f32 v234, v6, v150
    v_fmac_f32 v236, v14, v118
    v_fmac_f32 v234, v7, v151
    v_fmac_f32 v236, v15, v119
    v_mul_f32 v238, v16, v160
    v_mul_f32 v240, v24, v160
    v_fmac_f32 v238, v17, v161
    v_fmac_f32 v240, v25, v161
    v_fmac_f32 v238, v18, v162
    v_fmac_f32 v240, v26, v162
    v_fmac_f32 v238, v19, v163
    v_fmac_f32 v240, v27, v163
    v_fmac_f32 v238, v20, v164
    v_fmac_f32 v240, v28, v164
    v_fmac_f32 v238, v21, v165
    v_fmac_f32 v240, v29, v165
    v_fmac_f32 v238, v22, v166
    v_fmac_f32 v240, v30, v166
    v_fmac_f32 v238, v23, v167
    v_fmac_f32 v240, v31, v167
    v_mul_f32 v235, v32, v152
    v_mul_f32 v237, v40, v120
    v_fmac_f32 v235, v33, v153
    v_fmac_f32 v237, v41, v121
    v_fmac_f32 v235, v34, v154
    v_fmac_f32 v237, v42, v122
    v_fmac_f32 v235, v35, v155
    v_fmac_f32 v237, v43, v123
    v_fmac_f32 v235, v36, v156
    v_fmac_f32 v237, v44, v124
    v_fmac_f32 v235, v37, v157
    v_fmac_f32 v237, v45, v125
    v_fmac_f32 v235, v38, v158
    v_fmac_f32 v237, v46, v126
    v_fmac_f32 v235, v39, v159
    v_fmac_f32 v237, v47, v127
    v_mul_f32 v239, v48, v168
    v_mul_f32 v241, v56, v168
    v_fmac_f32 v239, v49, v169
    v_fmac_f32 v241, v57, v169
    v_fmac_f32 v239, v50, v170
    v_fmac_f32 v241, v58, v170
    v_fmac_f32 v239, v51, v171
    v_fmac_f32 v241, v59, v171
    v_fmac_f32 v239, v52, v172
    v_fmac_f32 v241, v60, v172
    v_fmac_f32 v239, v53, v173
    v_fmac_f32 v241, v61, v173
    v_fmac_f32 v239, v54, v174
    v_fmac_f32 v241, v62, v174
    v_fmac_f32 v239, v55, v175
    v_fmac_f32 v241, v63, v175
    s_setprio 1
    s_waitcnt vmcnt(6) lgkmcnt(0)
    v_mfma_f32_32x32x16_bf16 v[0:15], v[64:67], v[176:179], 0
    ds_read_b64_tr_b16 v[184:185], v246 offset:6144
    ds_read_b64_tr_b16 v[186:187], v246 offset:7168
    ds_read_b64_tr_b16 v[188:189], v247 offset:6144
    ds_read_b64_tr_b16 v[190:191], v247 offset:7168
    s_mov_b32 m0, s70
    v_mfma_f32_32x32x16_bf16 v[16:31], v[68:71], v[176:179], 0
    buffer_load_dwordx4 v226, s[4:7], s46 offen sc1 lds
    buffer_load_dwordx4 v227, s[72:75], s46 offen offset:1024 sc1 lds
    s_sub_u32 s26, s48, s29
    s_mov_b32 s29, s48
    s_mov_b32 s30, s3
    s_bfe_u32 s56, s3, 0x40012
    v_mfma_f32_32x32x16_bf16 v[32:47], v[64:67], v[180:183], 0
    s_cmp_eq_u32 s34, 0
    s_cselect_b32 s56, s56, 0
    v_mfma_f32_32x32x16_bf16 v[48:63], v[68:71], v[180:183], 0
    s_setprio 0
    v_mul_f32 v242, v0, v144
    v_fma_f32 v238, v8, v160, -v238
    v_fmac_f32 v242, v1, v145
    v_fmac_f32 v238, v9, v161
    v_fmac_f32 v242, v2, v146
    v_fmac_f32 v238, v10, v162
    v_fmac_f32 v242, v3, v147
    v_fmac_f32 v238, v11, v163
    v_fmac_f32 v242, v4, v148
    v_fmac_f32 v238, v12, v164
    v_fmac_f32 v242, v5, v149
    v_fmac_f32 v238, v13, v165
    v_fmac_f32 v242, v6, v150
    v_fmac_f32 v238, v14, v166
    v_fmac_f32 v242, v7, v151
    v_fmac_f32 v238, v15, v167
    v_fmac_f32 v236, v16, v112
    v_mul_f32 v244, v24, v160
    v_fmac_f32 v236, v17, v113
    v_fmac_f32 v244, v25, v161
    v_fmac_f32 v236, v18, v114
    v_fmac_f32 v244, v26, v162
    v_fmac_f32 v236, v19, v115
    v_fmac_f32 v244, v27, v163
    v_fmac_f32 v236, v20, v116
    v_fmac_f32 v244, v28, v164
    v_fmac_f32 v236, v21, v117
    v_fmac_f32 v244, v29, v165
    v_fmac_f32 v236, v22, v118
    v_fmac_f32 v244, v30, v166
    v_fmac_f32 v236, v23, v119
    v_fmac_f32 v244, v31, v167
    v_mul_f32 v243, v32, v152
    v_fma_f32 v239, v40, v168, -v239
    v_fmac_f32 v243, v33, v153
    v_fmac_f32 v239, v41, v169
    v_fmac_f32 v243, v34, v154
    v_fmac_f32 v239, v42, v170
    v_fmac_f32 v243, v35, v155
    v_fmac_f32 v239, v43, v171
    v_fmac_f32 v243, v36, v156
    v_fmac_f32 v239, v44, v172
    v_fmac_f32 v243, v37, v157
    v_fmac_f32 v239, v45, v173
    v_fmac_f32 v243, v38, v158
    v_fmac_f32 v239, v46, v174
    v_fmac_f32 v243, v39, v159
    v_fmac_f32 v239, v47, v175
    v_fmac_f32 v237, v48, v120
    v_mul_f32 v245, v56, v168
    v_fmac_f32 v237, v49, v121
    v_fmac_f32 v245, v57, v169
    v_fmac_f32 v237, v50, v122
    v_fmac_f32 v245, v58, v170
    v_fmac_f32 v237, v51, v123
    v_fmac_f32 v245, v59, v171
    v_fmac_f32 v237, v52, v124
    v_fmac_f32 v245, v60, v172
    v_fmac_f32 v237, v53, v125
    v_fmac_f32 v245, v61, v173
    v_fmac_f32 v237, v54, v126
    v_fmac_f32 v245, v62, v174
    v_fmac_f32 v237, v55, v127
    v_fmac_f32 v245, v63, v175
    s_setprio 1
    s_waitcnt vmcnt(4) lgkmcnt(0)
    v_mfma_f32_32x32x16_bf16 v[0:15], v[64:67], v[184:187], 0
    ds_read_b64_tr_b16 v[176:177], v246 offset:0
    ds_read_b64_tr_b16 v[178:179], v246 offset:1024
    ds_read_b64_tr_b16 v[180:181], v247 offset:0
    ds_read_b64_tr_b16 v[182:183], v247 offset:1024
    s_mov_b32 m0, s71
    v_mfma_f32_32x32x16_bf16 v[16:31], v[68:71], v[184:187], 0
    s_cmp_eq_u32 s33, 4
    s_cbranch_scc1 K2_g4_104
    buffer_load_dwordx4 v224, s[4:7], s47 offen sc1 lds
    buffer_load_dwordx4 v225, s[72:75], s47 offen offset:1024 sc1 lds
K2_back_105:
    v_permlane32_swap_b32 v242, v234
    v_mfma_f32_32x32x16_bf16 v[32:47], v[64:67], v[188:191], 0
    v_permlane32_swap_b32 v243, v235
    v_add_f32 v242, v242, v234
    v_add_f32 v243, v243, v235
    s_set_gpr_idx_on s31, gpr_idx(DST)
    s_nop 0
    v_cvt_pk_bf16_f32 v194, v242, v243
    s_set_gpr_idx_off
    s_mov_b32 s32, s31
    s_mov_b32 s31, s35
    v_mfma_f32_32x32x16_bf16 v[48:63], v[68:71], v[188:191], 0
    s_setprio 0
    v_mul_f32 v242, v0, v144
    v_fma_f32 v240, v8, v160, -v240
    v_fmac_f32 v242, v1, v145
    v_fmac_f32 v240, v9, v161
    v_fmac_f32 v242, v2, v146
    v_fmac_f32 v240, v10, v162
    v_fmac_f32 v242, v3, v147
    v_fmac_f32 v240, v11, v163
    v_fmac_f32 v242, v4, v148
    v_fmac_f32 v240, v12, v164
    v_fmac_f32 v242, v5, v149
    v_fmac_f32 v240, v13, v165
    v_fmac_f32 v242, v6, v150
    v_fmac_f32 v240, v14, v166
    v_fmac_f32 v242, v7, v151
    v_fmac_f32 v240, v15, v167
    v_add_u32 v249, s26, v249
    v_add_u32 v250, s26, v250
    v_fma_f32 v244, v16, v160, -v244
    v_fmac_f32 v236, v24, v112
    v_fmac_f32 v244, v17, v161
    v_fmac_f32 v236, v25, v113
    v_fmac_f32 v244, v18, v162
    v_fmac_f32 v236, v26, v114
    v_fmac_f32 v244, v19, v163
    v_fmac_f32 v236, v27, v115
    v_fmac_f32 v244, v20, v164
    v_fmac_f32 v236, v28, v116
    v_fmac_f32 v244, v21, v165
    v_fmac_f32 v236, v29, v117
    v_fmac_f32 v244, v22, v166
    v_fmac_f32 v236, v30, v118
    v_fmac_f32 v244, v23, v167
    v_fmac_f32 v236, v31, v119
    ds_read_b64_tr_b16 v[0:1], v249 offset:0
    ds_read_b64_tr_b16 v[2:3], v249 offset:32
    ds_read_u16_d16_hi v16, v250 offset:0
    v_mul_f32 v243, v32, v152
    v_fma_f32 v241, v40, v168, -v241
    v_fmac_f32 v243, v33, v153
    v_fmac_f32 v241, v41, v169
    v_fmac_f32 v243, v34, v154
    v_fmac_f32 v241, v42, v170
    v_fmac_f32 v243, v35, v155
    v_fmac_f32 v241, v43, v171
    v_fmac_f32 v243, v36, v156
    v_fmac_f32 v241, v44, v172
    v_fmac_f32 v243, v37, v157
    v_fmac_f32 v241, v45, v173
    v_fmac_f32 v243, v38, v158
    v_fmac_f32 v241, v46, v174
    v_fmac_f32 v243, v39, v159
    v_fmac_f32 v241, v47, v175
    ds_read_b64_tr_b16 v[4:5], v249 offset:512
    ds_read_b64_tr_b16 v[6:7], v249 offset:544
    ds_read_u16_d16_hi v17, v250 offset:128
    v_fma_f32 v245, v48, v168, -v245
    v_fmac_f32 v237, v56, v120
    v_fmac_f32 v245, v49, v169
    v_fmac_f32 v237, v57, v121
    v_fmac_f32 v245, v50, v170
    v_fmac_f32 v237, v58, v122
    v_fmac_f32 v245, v51, v171
    v_fmac_f32 v237, v59, v123
    v_fmac_f32 v245, v52, v172
    v_fmac_f32 v237, v60, v124
    v_fmac_f32 v245, v53, v173
    v_fmac_f32 v237, v61, v125
    v_fmac_f32 v245, v54, v174
    v_fmac_f32 v237, v62, v126
    v_fmac_f32 v245, v55, v175
    v_fmac_f32 v237, v63, v127
    s_cmp_eq_u32 s56, 5
    s_cbranch_scc1 K2_U20
    s_cmp_eq_u32 s56, 6
    s_cbranch_scc1 K2_U3h0
    s_branch K2_DSP0
K2_U40:
    s_setprio 1
    ds_read_b64_tr_b16 v[8:9], v249 offset:1024
    ds_read_b64_tr_b16 v[10:11], v249 offset:1056
    ds_read_u16_d16_hi v18, v250 offset:256
    s_lshr_b32 s65, s30, 28
    s_mul_i32 s66, s22, 2080
    s_lshl_b32 s65, s65, 9
    s_add_u32 s65, s65, s66
    s_add_u32 s65, s65, 65536
    s_sub_u32 s65, s65, s29
    s_sub_u32 s65, s65, 512
    v_add_u32 v56, s65, v249
    ds_read_b64_tr_b16 v[12:13], v56 offset:0
    ds_read_b64_tr_b16 v[14:15], v56 offset:32
    ds_read_u16_d16_hi v19, v250 offset:384
    s_waitcnt lgkmcnt(6)
    v_lshlrev_b32 v20, 16, v0
    v_and_b32 v21, 0xffff0000, v0
    v_lshlrev_b32 v22, 16, v1
    v_and_b32 v23, 0xffff0000, v1
    v_lshlrev_b32 v24, 16, v2
    v_and_b32 v25, 0xffff0000, v2
    v_lshlrev_b32 v26, 16, v3
    v_and_b32 v27, 0xffff0000, v3
    v_mul_f32_dpp v36, v16, v20 row_newbcast:8 row_mask:0xf bank_mask:0xf
    v_mul_f32_dpp v37, v16, v21 row_newbcast:9 row_mask:0xf bank_mask:0xf
    v_mul_f32_dpp v38, v16, v22 row_newbcast:10 row_mask:0xf bank_mask:0xf
    v_mul_f32_dpp v39, v16, v23 row_newbcast:11 row_mask:0xf bank_mask:0xf
    v_mul_f32_dpp v40, v16, v24 row_newbcast:12 row_mask:0xf bank_mask:0xf
    v_mul_f32_dpp v41, v16, v25 row_newbcast:13 row_mask:0xf bank_mask:0xf
    v_mul_f32_dpp v42, v16, v26 row_newbcast:14 row_mask:0xf bank_mask:0xf
    v_mul_f32_dpp v43, v16, v27 row_newbcast:15 row_mask:0xf bank_mask:0xf
    v_cvt_pk_bf16_f32 v68, v36, v37
    v_cvt_pk_bf16_f32 v69, v38, v39
    v_cvt_pk_bf16_f32 v70, v40, v41
    v_cvt_pk_bf16_f32 v71, v42, v43
    v_mul_f32_dpp v20, v16, v20 row_newbcast:0 row_mask:0xa bank_mask:0xf
    v_mul_f32_dpp v21, v16, v21 row_newbcast:1 row_mask:0xa bank_mask:0xf
    v_mul_f32_dpp v22, v16, v22 row_newbcast:2 row_mask:0xa bank_mask:0xf
    v_mul_f32_dpp v23, v16, v23 row_newbcast:3 row_mask:0xa bank_mask:0xf
    v_mul_f32_dpp v24, v16, v24 row_newbcast:4 row_mask:0xa bank_mask:0xf
    v_mul_f32_dpp v25, v16, v25 row_newbcast:5 row_mask:0xa bank_mask:0xf
    v_mul_f32_dpp v26, v16, v26 row_newbcast:6 row_mask:0xa bank_mask:0xf
    v_mul_f32_dpp v27, v16, v27 row_newbcast:7 row_mask:0xa bank_mask:0xf
    v_cvt_pk_bf16_f32 v64, v20, v21
    v_cvt_pk_bf16_f32 v65, v22, v23
    v_cvt_pk_bf16_f32 v66, v24, v25
    v_cvt_pk_bf16_f32 v67, v26, v27
    v_lshlrev_b32 v28, 16, v4
    v_and_b32 v29, 0xffff0000, v4
    v_lshlrev_b32 v30, 16, v5
    v_and_b32 v31, 0xffff0000, v5
    v_lshlrev_b32 v32, 16, v6
    v_and_b32 v33, 0xffff0000, v6
    v_lshlrev_b32 v34, 16, v7
    v_and_b32 v35, 0xffff0000, v7
    v_mul_f32_dpp v36, v17, v28 row_newbcast:8 row_mask:0xf bank_mask:0xf
    v_mul_f32_dpp v37, v17, v29 row_newbcast:9 row_mask:0xf bank_mask:0xf
    v_mul_f32_dpp v38, v17, v30 row_newbcast:10 row_mask:0xf bank_mask:0xf
    v_mul_f32_dpp v39, v17, v31 row_newbcast:11 row_mask:0xf bank_mask:0xf
    v_mul_f32_dpp v40, v17, v32 row_newbcast:12 row_mask:0xf bank_mask:0xf
    v_mul_f32_dpp v41, v17, v33 row_newbcast:13 row_mask:0xf bank_mask:0xf
    v_mul_f32_dpp v42, v17, v34 row_newbcast:14 row_mask:0xf bank_mask:0xf
    v_mul_f32_dpp v43, v17, v35 row_newbcast:15 row_mask:0xf bank_mask:0xf
    v_cvt_pk_bf16_f32 v76, v36, v37
    v_cvt_pk_bf16_f32 v77, v38, v39
    v_cvt_pk_bf16_f32 v78, v40, v41
    v_cvt_pk_bf16_f32 v79, v42, v43
    v_mul_f32_dpp v28, v17, v28 row_newbcast:0 row_mask:0xa bank_mask:0xf
    v_mul_f32_dpp v29, v17, v29 row_newbcast:1 row_mask:0xa bank_mask:0xf
    v_mul_f32_dpp v30, v17, v30 row_newbcast:2 row_mask:0xa bank_mask:0xf
    v_mul_f32_dpp v31, v17, v31 row_newbcast:3 row_mask:0xa bank_mask:0xf
    v_mul_f32_dpp v32, v17, v32 row_newbcast:4 row_mask:0xa bank_mask:0xf
    v_mul_f32_dpp v33, v17, v33 row_newbcast:5 row_mask:0xa bank_mask:0xf
    v_mul_f32_dpp v34, v17, v34 row_newbcast:6 row_mask:0xa bank_mask:0xf
    v_mul_f32_dpp v35, v17, v35 row_newbcast:7 row_mask:0xa bank_mask:0xf
    v_cvt_pk_bf16_f32 v72, v28, v29
    v_cvt_pk_bf16_f32 v73, v30, v31
    v_cvt_pk_bf16_f32 v74, v32, v33
    v_cvt_pk_bf16_f32 v75, v34, v35
    s_waitcnt lgkmcnt(3)
    v_lshlrev_b32 v20, 16, v8
    v_and_b32 v21, 0xffff0000, v8
    v_lshlrev_b32 v22, 16, v9
    v_and_b32 v23, 0xffff0000, v9
    v_lshlrev_b32 v24, 16, v10
    v_and_b32 v25, 0xffff0000, v10
    v_lshlrev_b32 v26, 16, v11
    v_and_b32 v27, 0xffff0000, v11
    v_mul_f32_dpp v36, v18, v20 row_newbcast:8 row_mask:0xf bank_mask:0xf
    v_mul_f32_dpp v37, v18, v21 row_newbcast:9 row_mask:0xf bank_mask:0xf
    v_mul_f32_dpp v38, v18, v22 row_newbcast:10 row_mask:0xf bank_mask:0xf
    v_mul_f32_dpp v39, v18, v23 row_newbcast:11 row_mask:0xf bank_mask:0xf
    v_mul_f32_dpp v40, v18, v24 row_newbcast:12 row_mask:0xf bank_mask:0xf
    v_mul_f32_dpp v41, v18, v25 row_newbcast:13 row_mask:0xf bank_mask:0xf
    v_mul_f32_dpp v42, v18, v26 row_newbcast:14 row_mask:0xf bank_mask:0xf
    v_mul_f32_dpp v43, v18, v27 row_newbcast:15 row_mask:0xf bank_mask:0xf
    v_cvt_pk_bf16_f32 v84, v36, v37
    v_cvt_pk_bf16_f32 v85, v38, v39
    v_cvt_pk_bf16_f32 v86, v40, v41
    v_cvt_pk_bf16_f32 v87, v42, v43
    v_mul_f32_dpp v20, v18, v20 row_newbcast:0 row_mask:0xa bank_mask:0xf
    v_mul_f32_dpp v21, v18, v21 row_newbcast:1 row_mask:0xa bank_mask:0xf
    v_mul_f32_dpp v22, v18, v22 row_newbcast:2 row_mask:0xa bank_mask:0xf
    v_mul_f32_dpp v23, v18, v23 row_newbcast:3 row_mask:0xa bank_mask:0xf
    v_mul_f32_dpp v24, v18, v24 row_newbcast:4 row_mask:0xa bank_mask:0xf
    v_mul_f32_dpp v25, v18, v25 row_newbcast:5 row_mask:0xa bank_mask:0xf
    v_mul_f32_dpp v26, v18, v26 row_newbcast:6 row_mask:0xa bank_mask:0xf
    v_mul_f32_dpp v27, v18, v27 row_newbcast:7 row_mask:0xa bank_mask:0xf
    v_cvt_pk_bf16_f32 v80, v20, v21
    v_cvt_pk_bf16_f32 v81, v22, v23
    v_cvt_pk_bf16_f32 v82, v24, v25
    v_cvt_pk_bf16_f32 v83, v26, v27
    s_waitcnt lgkmcnt(0)
    v_lshlrev_b32 v28, 16, v12
    v_and_b32 v29, 0xffff0000, v12
    v_lshlrev_b32 v30, 16, v13
    v_and_b32 v31, 0xffff0000, v13
    v_lshlrev_b32 v32, 16, v14
    v_and_b32 v33, 0xffff0000, v14
    v_lshlrev_b32 v34, 16, v15
    v_and_b32 v35, 0xffff0000, v15
    v_mul_f32_dpp v36, v19, v28 row_newbcast:8 row_mask:0xf bank_mask:0xf
    v_mul_f32_dpp v37, v19, v29 row_newbcast:9 row_mask:0xf bank_mask:0xf
    v_mul_f32_dpp v38, v19, v30 row_newbcast:10 row_mask:0xf bank_mask:0xf
    v_mul_f32_dpp v39, v19, v31 row_newbcast:11 row_mask:0xf bank_mask:0xf
    v_mul_f32_dpp v40, v19, v32 row_newbcast:12 row_mask:0xf bank_mask:0xf
    v_mul_f32_dpp v41, v19, v33 row_newbcast:13 row_mask:0xf bank_mask:0xf
    v_mul_f32_dpp v42, v19, v34 row_newbcast:14 row_mask:0xf bank_mask:0xf
    v_mul_f32_dpp v43, v19, v35 row_newbcast:15 row_mask:0xf bank_mask:0xf
    v_cvt_pk_bf16_f32 v92, v36, v37
    v_cvt_pk_bf16_f32 v93, v38, v39
    v_cvt_pk_bf16_f32 v94, v40, v41
    v_cvt_pk_bf16_f32 v95, v42, v43
    v_mul_f32_dpp v28, v19, v28 row_newbcast:0 row_mask:0xa bank_mask:0xf
    v_mul_f32_dpp v29, v19, v29 row_newbcast:1 row_mask:0xa bank_mask:0xf
    v_mul_f32_dpp v30, v19, v30 row_newbcast:2 row_mask:0xa bank_mask:0xf
    v_mul_f32_dpp v31, v19, v31 row_newbcast:3 row_mask:0xa bank_mask:0xf
    v_mul_f32_dpp v32, v19, v32 row_newbcast:4 row_mask:0xa bank_mask:0xf
    v_mul_f32_dpp v33, v19, v33 row_newbcast:5 row_mask:0xa bank_mask:0xf
    v_mul_f32_dpp v34, v19, v34 row_newbcast:6 row_mask:0xa bank_mask:0xf
    v_mul_f32_dpp v35, v19, v35 row_newbcast:7 row_mask:0xa bank_mask:0xf
    v_cvt_pk_bf16_f32 v88, v28, v29
    v_cvt_pk_bf16_f32 v89, v30, v31
    v_cvt_pk_bf16_f32 v90, v32, v33
    v_cvt_pk_bf16_f32 v91, v34, v35
    s_waitcnt vmcnt(4)
    v_mfma_f32_32x32x16_bf16 v[0:15], v[64:67], v[176:179], 0
    ds_read_b64_tr_b16 v[184:185], v246 offset:2048
    ds_read_b64_tr_b16 v[186:187], v246 offset:3072
    ds_read_b64_tr_b16 v[188:189], v247 offset:2048
    ds_read_b64_tr_b16 v[190:191], v247 offset:3072
    s_mov_b32 m0, s68
    v_mfma_f32_32x32x16_bf16 v[16:31], v[68:71], v[176:179], 0
    buffer_load_dwordx4 v222, s[4:7], s41 offen sc1 lds
    buffer_load_dwordx4 v223, s[72:75], s41 offen offset:1024 sc1 lds
    v_permlane32_swap_b32 v242, v236
    v_permlane32_swap_b32 v243, v237
    s_add_u32 s38, s38, 1
    v_mfma_f32_32x32x16_bf16 v[32:47], v[64:67], v[180:183], 0
    v_permlane32_swap_b32 v244, v238
    v_permlane32_swap_b32 v245, v239
    v_permlane32_swap_b32 v240, v241
    v_add_f32 v242, v242, v236
    v_mfma_f32_32x32x16_bf16 v[48:63], v[68:71], v[180:183], 0
    v_add_f32 v243, v243, v237
    v_add_f32 v244, v244, v238
    v_add_f32 v245, v245, v239
    v_add_f32 v240, -v240, -v241
    v_mov_b32 v254, s52
    v_mov_b32 v255, s38
    s_waitcnt vmcnt(4) lgkmcnt(0)
    v_mfma_f32_32x32x16_bf16 v[0:15], v[72:75], v[184:187], v[0:15]
    ds_read_b64_tr_b16 v[176:177], v246 offset:4096
    ds_read_b64_tr_b16 v[178:179], v246 offset:5120
    ds_read_b64_tr_b16 v[180:181], v247 offset:4096
    ds_read_b64_tr_b16 v[182:183], v247 offset:5120
    s_lshl_b32 s58, s38, 3
    s_add_u32 s58, s58, s20
    s_mov_b32 m0, s69
    v_mfma_f32_32x32x16_bf16 v[16:31], v[76:79], v[184:187], v[16:31]
    buffer_load_dwordx4 v224, s[4:7], s41 offen sc1 lds
    buffer_load_dwordx4 v225, s[72:75], s41 offen offset:1024 sc1 lds
    s_set_gpr_idx_on s32, gpr_idx(DST)
    s_nop 0
    v_cvt_pk_bf16_f32 v195, v242, v243
    v_cvt_pk_bf16_f32 v196, v244, v245
    v_cvt_pk_bf16_f32 v197, v240, v240
    s_set_gpr_idx_off
    s_mov_b64 exec, 1
    ds_write_b32 v254, v255
    s_mov_b64 exec, -1
    s_cmp_lt_u32 s58, s22
    s_cbranch_scc0 K2_dyn_106
K2_back_107:
    v_readlane_b32 s3, v253, s58
    s_lshl_b32 s44, s34, 7
    s_and_b32 s48, s3, 0x3ffff
    s_bfe_u32 s33, s3, 0x30013
    s_mul_i32 s35, s38, 6
    s_cmp_eq_u32 s34, 0
    s_cselect_b32 s35, s35, s48
    s_mov_b32 s45, s44
    s_xor_b32 s47, s44, 256
    s_add_u32 s49, s48, 128
    s_add_u32 s60, s48, 256
    s_cmp_eq_u32 s33, 3
    s_cselect_b32 s46, s44, s47
    s_cselect_b32 s50, s60, s48
    s_sub_u32 s60, s33, 2
    s_cmp_lt_u32 s60, 2
    s_cbranch_scc0 K2_rare_112
K2_back_113:
    v_mfma_f32_32x32x16_bf16 v[32:47], v[72:75], v[188:191], v[32:47]
    v_add_u32 v233, s48, v230
    ds_read_b32 v232, v233
    ds_read_b32 v233, v233 offset:1024
    v_mfma_f32_32x32x16_bf16 v[48:63], v[76:79], v[188:191], v[48:63]
    s_waitcnt vmcnt(4) lgkmcnt(3)
    v_mfma_f32_32x32x16_bf16 v[0:15], v[80:83], v[176:179], v[0:15]
    ds_read_b64_tr_b16 v[184:185], v246 offset:6144
    ds_read_b64_tr_b16 v[186:187], v246 offset:7168
    ds_read_b64_tr_b16 v[188:189], v247 offset:6144
    ds_read_b64_tr_b16 v[190:191], v247 offset:7168
    s_mov_b32 m0, s70
    v_mfma_f32_32x32x16_bf16 v[16:31], v[84:87], v[176:179], v[16:31]
    buffer_load_dwordx4 v226, s[4:7], s41 offen sc1 lds
    buffer_load_dwordx4 v227, s[72:75], s41 offen offset:1024 sc1 lds
    v_mfma_f32_32x32x16_bf16 v[32:47], v[80:83], v[180:183], v[32:47]
    v_mfma_f32_32x32x16_bf16 v[48:63], v[84:87], v[180:183], v[48:63]
    s_waitcnt lgkmcnt(4)
    v_or_b32 v232, v232, v231
    v_or_b32 v233, v233, v231
    s_cmp_lg_u32 s34, 0
    s_cbranch_scc1 K2_dum_117
    s_cmp_eq_u32 s33, 4
    s_cbranch_scc1 K2_a4_118
K2_b4_120:
    s_add_u32 m0, s48, 512
    s_add_u32 s65, s48, 1536
    buffer_load_dwordx4 v232, s[16:19], 0 offen  lds
    s_mov_b32 m0, s65
    s_mov_b32 exec_hi, 0
    buffer_load_dwordx4 v233, s[16:19], 0 offen  lds
    s_mov_b32 exec_hi, -1
K2_back_119:
    s_waitcnt vmcnt(6) lgkmcnt(0)
    v_mfma_f32_32x32x16_bf16 v[0:15], v[88:91], v[184:187], v[0:15]
    ds_read_b64_tr_b16 v[176:177], v246 offset:0
    ds_read_b64_tr_b16 v[178:179], v246 offset:1024
    ds_read_b64_tr_b16 v[180:181], v247 offset:0
    ds_read_b64_tr_b16 v[182:183], v247 offset:1024
    s_mov_b32 m0, s71
    v_mfma_f32_32x32x16_bf16 v[16:31], v[92:95], v[184:187], v[16:31]
    buffer_load_dwordx4 v228, s[4:7], s41 offen sc1 lds
    buffer_load_dwordx4 v229, s[72:75], s41 offen offset:1024 sc1 lds
    v_mfma_f32_32x32x16_bf16 v[32:47], v[88:91], v[188:191], v[32:47]
    s_nop 2
    v_mul_f32 v234, v0, v96
    v_mul_f32 v236, v8, v128
    v_fmac_f32 v234, v1, v97
    v_fmac_f32 v236, v9, v129
    v_fmac_f32 v234, v2, v98
    v_fmac_f32 v236, v10, v130
    v_fmac_f32 v234, v3, v99
    v_mfma_f32_32x32x16_bf16 v[48:63], v[92:95], v[188:191], v[48:63]
    s_setprio 0
    v_fmac_f32 v236, v11, v131
    v_fmac_f32 v234, v4, v100
    v_fmac_f32 v236, v12, v132
    v_fmac_f32 v234, v5, v101
    v_fmac_f32 v236, v13, v133
    v_fmac_f32 v234, v6, v102
    v_fmac_f32 v236, v14, v134
    v_fmac_f32 v234, v7, v103
    v_fmac_f32 v236, v15, v135
    v_mul_f32 v238, v16, v128
    v_mul_f32 v240, v24, v128
    v_fmac_f32 v238, v17, v129
    v_fmac_f32 v240, v25, v129
    v_fmac_f32 v238, v18, v130
    v_fmac_f32 v240, v26, v130
    v_fmac_f32 v238, v19, v131
    v_fmac_f32 v240, v27, v131
    v_fmac_f32 v238, v20, v132
    v_fmac_f32 v240, v28, v132
    v_fmac_f32 v238, v21, v133
    v_fmac_f32 v240, v29, v133
    v_fmac_f32 v238, v22, v134
    v_fmac_f32 v240, v30, v134
    v_fmac_f32 v238, v23, v135
    v_fmac_f32 v240, v31, v135
    v_mul_f32 v235, v32, v104
    v_mul_f32 v237, v40, v136
    v_fmac_f32 v235, v33, v105
    v_fmac_f32 v237, v41, v137
    v_fmac_f32 v235, v34, v106
    v_fmac_f32 v237, v42, v138
    v_fmac_f32 v235, v35, v107
    v_fmac_f32 v237, v43, v139
    v_fmac_f32 v235, v36, v108
    v_fmac_f32 v237, v44, v140
    v_fmac_f32 v235, v37, v109
    v_fmac_f32 v237, v45, v141
    v_fmac_f32 v235, v38, v110
    v_fmac_f32 v237, v46, v142
    v_fmac_f32 v235, v39, v111
    v_fmac_f32 v237, v47, v143
    v_mul_f32 v239, v48, v136
    v_mul_f32 v241, v56, v136
    s_setprio 1
    s_waitcnt vmcnt(6) lgkmcnt(0)
    v_mfma_f32_32x32x16_bf16 v[0:15], v[64:67], v[176:179], 0
    ds_read_b64_tr_b16 v[184:185], v246 offset:2048
    ds_read_b64_tr_b16 v[186:187], v246 offset:3072
    ds_read_b64_tr_b16 v[188:189], v247 offset:2048
    ds_read_b64_tr_b16 v[190:191], v247 offset:3072
    v_fmac_f32 v239, v49, v137
    v_fmac_f32 v241, v57, v137
    s_mov_b32 m0, s68
    v_mfma_f32_32x32x16_bf16 v[16:31], v[68:71], v[176:179], 0
    buffer_load_dwordx4 v222, s[4:7], s42 offen sc1 lds
    buffer_load_dwordx4 v223, s[72:75], s42 offen offset:1024 sc1 lds
    v_fmac_f32 v239, v50, v138
    v_fmac_f32 v241, v58, v138
    v_fmac_f32 v239, v51, v139
    v_fmac_f32 v241, v59, v139
    v_fmac_f32 v239, v52, v140
    v_mfma_f32_32x32x16_bf16 v[32:47], v[64:67], v[180:183], 0
    v_fmac_f32 v241, v60, v140
    v_fmac_f32 v239, v53, v141
    v_fmac_f32 v241, v61, v141
    v_fmac_f32 v239, v54, v142
    v_fmac_f32 v241, v62, v142
    v_fmac_f32 v239, v55, v143
    v_fmac_f32 v241, v63, v143
    v_mfma_f32_32x32x16_bf16 v[48:63], v[68:71], v[180:183], 0
    v_permlane32_swap_b32 v234, v236
    v_permlane32_swap_b32 v235, v237
    v_permlane32_swap_b32 v240, v238
    s_waitcnt vmcnt(6) lgkmcnt(0)
    v_mfma_f32_32x32x16_bf16 v[0:15], v[72:75], v[184:187], v[0:15]
    ds_read_b64_tr_b16 v[176:177], v246 offset:4096
    ds_read_b64_tr_b16 v[178:179], v246 offset:5120
    ds_read_b64_tr_b16 v[180:181], v247 offset:4096
    ds_read_b64_tr_b16 v[182:183], v247 offset:5120
    v_permlane32_swap_b32 v241, v239
    s_mov_b32 m0, s69
    v_mfma_f32_32x32x16_bf16 v[16:31], v[76:79], v[184:187], v[16:31]
    buffer_load_dwordx4 v224, s[4:7], s42 offen sc1 lds
    buffer_load_dwordx4 v225, s[72:75], s42 offen offset:1024 sc1 lds
    v_add_f32 v234, v234, v236
    v_add_f32 v235, v235, v237
    v_add_f32 v240, v240, v238
    v_add_f32 v241, v241, v239
    v_mfma_f32_32x32x16_bf16 v[32:47], v[72:75], v[188:191], v[32:47]
    s_set_gpr_idx_on s31, gpr_idx(DST)
    s_nop 0
    v_cvt_pk_bf16_f32 v192, v234, v235
    v_cvt_pk_bf16_f32 v193, v240, v241
    s_set_gpr_idx_off
    v_mfma_f32_32x32x16_bf16 v[48:63], v[76:79], v[188:191], v[48:63]
    s_waitcnt vmcnt(4) lgkmcnt(0)
    v_mfma_f32_32x32x16_bf16 v[0:15], v[80:83], v[176:179], v[0:15]
    ds_read_b64_tr_b16 v[184:185], v246 offset:6144
    ds_read_b64_tr_b16 v[186:187], v246 offset:7168
    ds_read_b64_tr_b16 v[188:189], v247 offset:6144
    ds_read_b64_tr_b16 v[190:191], v247 offset:7168
    s_mov_b32 m0, s70
    v_mfma_f32_32x32x16_bf16 v[16:31], v[84:87], v[176:179], v[16:31]
    buffer_load_dwordx4 v226, s[4:7], s42 offen sc1 lds
    buffer_load_dwordx4 v227, s[72:75], s42 offen offset:1024 sc1 lds
    v_mfma_f32_32x32x16_bf16 v[32:47], v[80:83], v[180:183], v[32:47]
    v_mfma_f32_32x32x16_bf16 v[48:63], v[84:87], v[180:183], v[48:63]
    s_waitcnt vmcnt(4) lgkmcnt(0)
    v_mfma_f32_32x32x16_bf16 v[0:15], v[88:91], v[184:187], v[0:15]
    ds_read_b64_tr_b16 v[176:177], v246 offset:0
    ds_read_b64_tr_b16 v[178:179], v246 offset:1024
    ds_read_b64_tr_b16 v[180:181], v247 offset:0
    ds_read_b64_tr_b16 v[182:183], v247 offset:1024
    s_mov_b32 m0, s71
    v_mfma_f32_32x32x16_bf16 v[16:31], v[92:95], v[184:187], v[16:31]
    buffer_load_dwordx4 v228, s[4:7], s42 offen sc1 lds
    buffer_load_dwordx4 v229, s[72:75], s42 offen offset:1024 sc1 lds
    v_mfma_f32_32x32x16_bf16 v[32:47], v[88:91], v[188:191], v[32:47]
    s_nop 2
    v_mul_f32 v234, v0, v144
    v_mul_f32 v236, v8, v112
    v_fmac_f32 v234, v1, v145
    v_fmac_f32 v236, v9, v113
    v_fmac_f32 v234, v2, v146
    v_fmac_f32 v236, v10, v114
    v_fmac_f32 v234, v3, v147
    v_mfma_f32_32x32x16_bf16 v[48:63], v[92:95], v[188:191], v[48:63]
    s_setprio 0
    v_fmac_f32 v236, v11, v115
    v_fmac_f32 v234, v4, v148
    v_fmac_f32 v236, v12, v116
    v_fmac_f32 v234, v5, v149
    v_fmac_f32 v236, v13, v117
    v_fmac_f32 v234, v6, v150
    v_fmac_f32 v236, v14, v118
    v_fmac_f32 v234, v7, v151
    v_fmac_f32 v236, v15, v119
    v_mul_f32 v238, v16, v160
    v_mul_f32 v240, v24, v160
    v_fmac_f32 v238, v17, v161
    v_fmac_f32 v240, v25, v161
    v_fmac_f32 v238, v18, v162
    v_fmac_f32 v240, v26, v162
    v_fmac_f32 v238, v19, v163
    v_fmac_f32 v240, v27, v163
    v_fmac_f32 v238, v20, v164
    v_fmac_f32 v240, v28, v164
    v_fmac_f32 v238, v21, v165
    v_fmac_f32 v240, v29, v165
    v_fmac_f32 v238, v22, v166
    v_fmac_f32 v240, v30, v166
    v_fmac_f32 v238, v23, v167
    v_fmac_f32 v240, v31, v167
    v_mul_f32 v235, v32, v152
    v_mul_f32 v237, v40, v120
    v_fmac_f32 v235, v33, v153
    v_fmac_f32 v237, v41, v121
    v_fmac_f32 v235, v34, v154
    v_fmac_f32 v237, v42, v122
    v_fmac_f32 v235, v35, v155
    v_fmac_f32 v237, v43, v123
    v_fmac_f32 v235, v36, v156
    v_fmac_f32 v237, v44, v124
    v_fmac_f32 v235, v37, v157
    v_fmac_f32 v237, v45, v125
    v_fmac_f32 v235, v38, v158
    v_fmac_f32 v237, v46, v126
    v_fmac_f32 v235, v39, v159
    v_fmac_f32 v237, v47, v127
    v_mul_f32 v239, v48, v168
    v_mul_f32 v241, v56, v168
    s_setprio 1
    s_waitcnt vmcnt(4) lgkmcnt(0)
    v_mfma_f32_32x32x16_bf16 v[0:15], v[64:67], v[176:179], 0
    ds_read_b64_tr_b16 v[184:185], v246 offset:2048
    ds_read_b64_tr_b16 v[186:187], v246 offset:3072
    ds_read_b64_tr_b16 v[188:189], v247 offset:2048
    ds_read_b64_tr_b16 v[190:191], v247 offset:3072
    v_fmac_f32 v239, v49, v169
    v_fmac_f32 v241, v57, v169
    s_mov_b32 m0, s68
    v_mfma_f32_32x32x16_bf16 v[16:31], v[68:71], v[176:179], 0
    buffer_load_dwordx4 v222, s[4:7], s43 offen sc1 lds
    buffer_load_dwordx4 v223, s[72:75], s43 offen offset:1024 sc1 lds
    v_fmac_f32 v239, v50, v170
    v_fmac_f32 v241, v58, v170
    v_fmac_f32 v239, v51, v171
    v_fmac_f32 v241, v59, v171
    v_fmac_f32 v239, v52, v172
    v_mfma_f32_32x32x16_bf16 v[32:47], v[64:67], v[180:183], 0
    v_fmac_f32 v241, v60, v172
    v_fmac_f32 v239, v53, v173
    v_fmac_f32 v241, v61, v173
    v_fmac_f32 v239, v54, v174
    v_fmac_f32 v241, v62, v174
    v_fmac_f32 v239, v55, v175
    v_fmac_f32 v241, v63, v175
    v_mfma_f32_32x32x16_bf16 v[48:63], v[68:71], v[180:183], 0
    s_waitcnt vmcnt(4) lgkmcnt(0)
    v_mfma_f32_32x32x16_bf16 v[0:15], v[72:75], v[184:187], v[0:15]
    ds_read_b64_tr_b16 v[176:177], v246 offset:4096
    ds_read_b64_tr_b16 v[178:179], v246 offset:5120
    ds_read_b64_tr_b16 v[180:181], v247 offset:4096
    ds_read_b64_tr_b16 v[182:183], v247 offset:5120
    s_mov_b32 m0, s69
    v_mfma_f32_32x32x16_bf16 v[16:31], v[76:79], v[184:187], v[16:31]
    buffer_load_dwordx4 v224, s[4:7], s43 offen sc1 lds
    buffer_load_dwordx4 v225, s[72:75], s43 offen offset:1024 sc1 lds
    v_mfma_f32_32x32x16_bf16 v[32:47], v[72:75], v[188:191], v[32:47]
    v_mfma_f32_32x32x16_bf16 v[48:63], v[76:79], v[188:191], v[48:63]
    s_waitcnt vmcnt(4) lgkmcnt(0)
    v_mfma_f32_32x32x16_bf16 v[0:15], v[80:83], v[176:179], v[0:15]
    ds_read_b64_tr_b16 v[184:185], v246 offset:6144
    ds_read_b64_tr_b16 v[186:187], v246 offset:7168
    ds_read_b64_tr_b16 v[188:189], v247 offset:6144
    ds_read_b64_tr_b16 v[190:191], v247 offset:7168
    s_mov_b32 m0, s70
    v_mfma_f32_32x32x16_bf16 v[16:31], v[84:87], v[176:179], v[16:31]
    buffer_load_dwordx4 v226, s[4:7], s43 offen sc1 lds
    buffer_load_dwordx4 v227, s[72:75], s43 offen offset:1024 sc1 lds
    v_mfma_f32_32x32x16_bf16 v[32:47], v[80:83], v[180:183], v[32:47]
    v_add_u32 v222, s48, v251
    ds_read2_b32 v[222:223], v222 offset0:1 offset1:3
    v_mfma_f32_32x32x16_bf16 v[48:63], v[84:87], v[180:183], v[48:63]
    s_waitcnt vmcnt(4) lgkmcnt(1)
    v_mfma_f32_32x32x16_bf16 v[0:15], v[88:91], v[184:187], v[0:15]
    ds_read_b64_tr_b16 v[176:177], v246 offset:0
    ds_read_b64_tr_b16 v[178:179], v246 offset:1024
    ds_read_b64_tr_b16 v[180:181], v247 offset:0
    ds_read_b64_tr_b16 v[182:183], v247 offset:1024
    s_mov_b32 m0, s71
    v_mfma_f32_32x32x16_bf16 v[16:31], v[92:95], v[184:187], v[16:31]
    buffer_load_dwordx4 v228, s[4:7], s43 offen sc1 lds
    buffer_load_dwordx4 v229, s[72:75], s43 offen offset:1024 sc1 lds
    s_waitcnt lgkmcnt(4)
    v_mad_u32_u16 v222, v222, s39, v248 op_sel:[1,0,0,0]
    v_mad_u32_u16 v223, v223, s39, v248 op_sel:[1,0,0,0]
    v_mfma_f32_32x32x16_bf16 v[32:47], v[88:91], v[188:191], v[32:47]
    v_add_u32 v224, s49, v251
    ds_read2_b32 v[224:225], v224 offset0:1 offset1:3
    v_mul_f32 v242, v0, v144
    v_fma_f32 v238, v8, v160, -v238
    v_fmac_f32 v242, v1, v145
    v_fmac_f32 v238, v9, v161
    v_fmac_f32 v242, v2, v146
    v_mfma_f32_32x32x16_bf16 v[48:63], v[92:95], v[188:191], v[48:63]
    s_setprio 0
    v_fmac_f32 v238, v10, v162
    v_fmac_f32 v242, v3, v147
    v_fmac_f32 v238, v11, v163
    v_fmac_f32 v242, v4, v148
    v_fmac_f32 v238, v12, v164
    v_fmac_f32 v242, v5, v149
    v_fmac_f32 v238, v13, v165
    v_fmac_f32 v242, v6, v150
    v_fmac_f32 v238, v14, v166
    v_fmac_f32 v242, v7, v151
    v_fmac_f32 v238, v15, v167
    v_fmac_f32 v236, v16, v112
    v_mul_f32 v244, v24, v160
    v_fmac_f32 v236, v17, v113
    v_fmac_f32 v244, v25, v161
    v_fmac_f32 v236, v18, v114
    v_fmac_f32 v244, v26, v162
    v_fmac_f32 v236, v19, v115
    v_fmac_f32 v244, v27, v163
    v_fmac_f32 v236, v20, v116
    v_fmac_f32 v244, v28, v164
    v_fmac_f32 v236, v21, v117
    v_fmac_f32 v244, v29, v165
    v_fmac_f32 v236, v22, v118
    v_fmac_f32 v244, v30, v166
    v_fmac_f32 v236, v23, v119
    v_fmac_f32 v244, v31, v167
    v_mul_f32 v243, v32, v152
    v_fma_f32 v239, v40, v168, -v239
    v_fmac_f32 v243, v33, v153
    v_fmac_f32 v239, v41, v169
    v_fmac_f32 v243, v34, v154
    v_fmac_f32 v239, v42, v170
    v_fmac_f32 v243, v35, v155
    v_fmac_f32 v239, v43, v171
    v_fmac_f32 v243, v36, v156
    v_fmac_f32 v239, v44, v172
    v_fmac_f32 v243, v37, v157
    v_fmac_f32 v239, v45, v173
    v_fmac_f32 v243, v38, v158
    v_fmac_f32 v239, v46, v174
    v_fmac_f32 v243, v39, v159
    v_fmac_f32 v239, v47, v175
    v_fmac_f32 v237, v48, v120
    v_mul_f32 v245, v56, v168
    v_fmac_f32 v237, v49, v121
    v_fmac_f32 v245, v57, v169
    v_fmac_f32 v237, v50, v122
    v_fmac_f32 v245, v58, v170
    v_fmac_f32 v237, v51, v123
    s_setprio 1
    s_waitcnt vmcnt(4) lgkmcnt(1)
    v_mfma_f32_32x32x16_bf16 v[0:15], v[64:67], v[176:179], 0
    ds_read_b64_tr_b16 v[184:185], v246 offset:2048
    ds_read_b64_tr_b16 v[186:187], v246 offset:3072
    ds_read_b64_tr_b16 v[188:189], v247 offset:2048
    ds_read_b64_tr_b16 v[190:191], v247 offset:3072
    v_fmac_f32 v245, v59, v171
    v_fmac_f32 v237, v52, v124
    s_mov_b32 m0, s68
    v_mfma_f32_32x32x16_bf16 v[16:31], v[68:71], v[176:179], 0
    buffer_load_dwordx4 v222, s[4:7], s44 offen sc1 lds
    buffer_load_dwordx4 v223, s[72:75], s44 offen offset:1024 sc1 lds
    s_waitcnt lgkmcnt(4)
    v_mad_u32_u16 v224, v224, s39, v248 op_sel:[1,0,0,0]
    v_mad_u32_u16 v225, v225, s39, v248 op_sel:[1,0,0,0]
    v_fmac_f32 v245, v60, v172
    v_fmac_f32 v237, v53, v125
    v_mfma_f32_32x32x16_bf16 v[32:47], v[64:67], v[180:183], 0
    v_add_u32 v226, s50, v251
    ds_read2_b32 v[226:227], v226 offset0:1 offset1:3
    v_fmac_f32 v245, v61, v173
    v_fmac_f32 v237, v54, v126
    v_fmac_f32 v245, v62, v174
    v_fmac_f32 v237, v55, v127
    v_fmac_f32 v245, v63, v175
    v_mfma_f32_32x32x16_bf16 v[48:63], v[68:71], v[180:183], 0
    v_permlane32_swap_b32 v242, v234
    v_permlane32_swap_b32 v243, v235
    v_add_f32 v242, v242, v234
    v_add_f32 v243, v243, v235
    s_waitcnt vmcnt(4) lgkmcnt(1)
    v_mfma_f32_32x32x16_bf16 v[0:15], v[72:75], v[184:187], v[0:15]
    ds_read_b64_tr_b16 v[176:177], v246 offset:4096
    ds_read_b64_tr_b16 v[178:179], v246 offset:5120
    ds_read_b64_tr_b16 v[180:181], v247 offset:4096
    ds_read_b64_tr_b16 v[182:183], v247 offset:5120
    s_mov_b32 m0, s69
    v_mfma_f32_32x32x16_bf16 v[16:31], v[76:79], v[184:187], v[16:31]
    buffer_load_dwordx4 v224, s[4:7], s45 offen sc1 lds
    buffer_load_dwordx4 v225, s[72:75], s45 offen offset:1024 sc1 lds
    s_waitcnt lgkmcnt(4)
    v_mad_u32_u16 v226, v226, s39, v248 op_sel:[1,0,0,0]
    v_mad_u32_u16 v227, v227, s39, v248 op_sel:[1,0,0,0]
    v_mfma_f32_32x32x16_bf16 v[32:47], v[72:75], v[188:191], v[32:47]
    s_set_gpr_idx_on s31, gpr_idx(DST)
    s_nop 0
    v_cvt_pk_bf16_f32 v194, v242, v243
    s_set_gpr_idx_off
    v_mfma_f32_32x32x16_bf16 v[48:63], v[76:79], v[188:191], v[48:63]
    s_waitcnt vmcnt(4) lgkmcnt(0)
    v_mfma_f32_32x32x16_bf16 v[0:15], v[80:83], v[176:179], v[0:15]
    ds_read_b64_tr_b16 v[184:185], v246 offset:6144
    ds_read_b64_tr_b16 v[186:187], v246 offset:7168
    ds_read_b64_tr_b16 v[188:189], v247 offset:6144
    ds_read_b64_tr_b16 v[190:191], v247 offset:7168
    s_mov_b32 s32, s31
    s_mov_b32 s31, s35
    s_mov_b32 m0, s70
    v_mfma_f32_32x32x16_bf16 v[16:31], v[84:87], v[176:179], v[16:31]
    buffer_load_dwordx4 v226, s[4:7], s46 offen sc1 lds
    buffer_load_dwordx4 v227, s[72:75], s46 offen offset:1024 sc1 lds
    s_sub_u32 s26, s48, s29
    s_mov_b32 s29, s48
    s_mov_b32 s30, s3
    s_bfe_u32 s56, s3, 0x40012
    v_mfma_f32_32x32x16_bf16 v[32:47], v[80:83], v[180:183], v[32:47]
    s_cmp_eq_u32 s34, 0
    s_cselect_b32 s56, s56, 0
    v_mfma_f32_32x32x16_bf16 v[48:63], v[84:87], v[180:183], v[48:63]
    s_waitcnt vmcnt(4) lgkmcnt(0)
    v_mfma_f32_32x32x16_bf16 v[0:15], v[88:91], v[184:187], v[0:15]
    ds_read_b64_tr_b16 v[176:177], v246 offset:0
    ds_read_b64_tr_b16 v[178:179], v246 offset:1024
    ds_read_b64_tr_b16 v[180:181], v247 offset:0
    ds_read_b64_tr_b16 v[182:183], v247 offset:1024
    s_mov_b32 m0, s71
    v_mfma_f32_32x32x16_bf16 v[16:31], v[92:95], v[184:187], v[16:31]
    s_cmp_eq_u32 s33, 4
    s_cbranch_scc1 K2_g4_115
    buffer_load_dwordx4 v224, s[4:7], s47 offen sc1 lds
    buffer_load_dwordx4 v225, s[72:75], s47 offen offset:1024 sc1 lds
K2_back_116:
    v_mfma_f32_32x32x16_bf16 v[32:47], v[88:91], v[188:191], v[32:47]
    s_nop 0
    v_mul_f32 v242, v0, v144
    v_fma_f32 v240, v8, v160, -v240
    v_fmac_f32 v242, v1, v145
    v_fmac_f32 v240, v9, v161
    v_fmac_f32 v242, v2, v146
    v_fmac_f32 v240, v10, v162
    v_fmac_f32 v242, v3, v147
    v_mfma_f32_32x32x16_bf16 v[48:63], v[92:95], v[188:191], v[48:63]
    s_setprio 0
    v_fmac_f32 v240, v11, v163
    v_fmac_f32 v242, v4, v148
    v_fmac_f32 v240, v12, v164
    v_fmac_f32 v242, v5, v149
    v_fmac_f32 v240, v13, v165
    v_fmac_f32 v242, v6, v150
    v_fmac_f32 v240, v14, v166
    v_fmac_f32 v242, v7, v151
    v_fmac_f32 v240, v15, v167
    v_add_u32 v249, s26, v249
    v_add_u32 v250, s26, v250
    v_fma_f32 v244, v16, v160, -v244
    v_fmac_f32 v236, v24, v112
    v_fmac_f32 v244, v17, v161
    v_fmac_f32 v236, v25, v113
    v_fmac_f32 v244, v18, v162
    v_fmac_f32 v236, v26, v114
    v_fmac_f32 v244, v19, v163
    v_fmac_f32 v236, v27, v115
    v_fmac_f32 v244, v20, v164
    v_fmac_f32 v236, v28, v116
    v_fmac_f32 v244, v21, v165
    v_fmac_f32 v236, v29, v117
    v_fmac_f32 v244, v22, v166
    v_fmac_f32 v236, v30, v118
    v_fmac_f32 v244, v23, v167
    v_fmac_f32 v236, v31, v119
    ds_read_b64_tr_b16 v[0:1], v249 offset:0
    ds_read_b64_tr_b16 v[2:3], v249 offset:32
    ds_read_u16_d16_hi v16, v250 offset:0
    v_mul_f32 v243, v32, v152
    v_fma_f32 v241, v40, v168, -v241
    v_fmac_f32 v243, v33, v153
    v_fmac_f32 v241, v41, v169
    v_fmac_f32 v243, v34, v154
    v_fmac_f32 v241, v42, v170
    v_fmac_f32 v243, v35, v155
    v_fmac_f32 v241, v43, v171
    v_fmac_f32 v243, v36, v156
    v_fmac_f32 v241, v44, v172
    v_fmac_f32 v243, v37, v157
    v_fmac_f32 v241, v45, v173
    v_fmac_f32 v243, v38, v158
    v_fmac_f32 v241, v46, v174
    v_fmac_f32 v243, v39, v159
    v_fmac_f32 v241, v47, v175
    ds_read_b64_tr_b16 v[4:5], v249 offset:512
    ds_read_b64_tr_b16 v[6:7], v249 offset:544
    ds_read_u16_d16_hi v17, v250 offset:128
    v_fma_f32 v245, v48, v168, -v245
    v_fmac_f32 v237, v56, v120
    v_fmac_f32 v245, v49, v169
    v_fmac_f32 v237, v57, v121
    v_fmac_f32 v245, v50, v170
    v_fmac_f32 v237, v58, v122
    v_fmac_f32 v245, v51, v171
    v_fmac_f32 v237, v59, v123
    v_fmac_f32 v245, v52, v172
    v_fmac_f32 v237, v60, v124
    v_fmac_f32 v245, v53, v173
    v_fmac_f32 v237, v61, v125
    v_fmac_f32 v245, v54, v174
    v_fmac_f32 v237, v62, v126
    v_fmac_f32 v245, v55, v175
    v_fmac_f32 v237, v63, v127
    s_cmp_eq_u32 s56, 5
    s_cbranch_scc1 K2_U20
    s_cmp_eq_u32 s56, 6
    s_cbranch_scc1 K2_U3h0
    s_branch K2_DSP0
K2_U11:
    s_setprio 1
    s_mov_b64 exec, 0x1ff
    ds_add_rtn_u32 v232, v254, v255
    s_mov_b64 exec, -1
    s_waitcnt lgkmcnt(4)
    v_lshlrev_b32 v20, 16, v0
    v_and_b32 v21, 0xffff0000, v0
    v_lshlrev_b32 v22, 16, v1
    v_and_b32 v23, 0xffff0000, v1
    v_lshlrev_b32 v24, 16, v2
    v_and_b32 v25, 0xffff0000, v2
    v_lshlrev_b32 v26, 16, v3
    v_and_b32 v27, 0xffff0000, v3
    v_mul_f32_dpp v36, v16, v20 row_newbcast:8 row_mask:0xf bank_mask:0xf
    v_mul_f32_dpp v37, v16, v21 row_newbcast:9 row_mask:0xf bank_mask:0xf
    v_mul_f32_dpp v38, v16, v22 row_newbcast:10 row_mask:0xf bank_mask:0xf
    v_mul_f32_dpp v39, v16, v23 row_newbcast:11 row_mask:0xf bank_mask:0xf
    v_mul_f32_dpp v40, v16, v24 row_newbcast:12 row_mask:0xf bank_mask:0xf
    v_mul_f32_dpp v41, v16, v25 row_newbcast:13 row_mask:0xf bank_mask:0xf
    v_mul_f32_dpp v42, v16, v26 row_newbcast:14 row_mask:0xf bank_mask:0xf
    v_mul_f32_dpp v43, v16, v27 row_newbcast:15 row_mask:0xf bank_mask:0xf
    v_cvt_pk_bf16_f32 v68, v36, v37
    v_cvt_pk_bf16_f32 v69, v38, v39
    v_cvt_pk_bf16_f32 v70, v40, v41
    v_cvt_pk_bf16_f32 v71, v42, v43
    v_mul_f32_dpp v20, v16, v20 row_newbcast:0 row_mask:0xa bank_mask:0xf
    v_mul_f32_dpp v21, v16, v21 row_newbcast:1 row_mask:0xa bank_mask:0xf
    v_mul_f32_dpp v22, v16, v22 row_newbcast:2 row_mask:0xa bank_mask:0xf
    v_mul_f32_dpp v23, v16, v23 row_newbcast:3 row_mask:0xa bank_mask:0xf
    v_mul_f32_dpp v24, v16, v24 row_newbcast:4 row_mask:0xa bank_mask:0xf
    v_mul_f32_dpp v25, v16, v25 row_newbcast:5 row_mask:0xa bank_mask:0xf
    v_mul_f32_dpp v26, v16, v26 row_newbcast:6 row_mask:0xa bank_mask:0xf
    v_mul_f32_dpp v27, v16, v27 row_newbcast:7 row_mask:0xa bank_mask:0xf
    v_cvt_pk_bf16_f32 v64, v20, v21
    v_cvt_pk_bf16_f32 v65, v22, v23
    v_cvt_pk_bf16_f32 v66, v24, v25
    v_cvt_pk_bf16_f32 v67, v26, v27
    s_waitcnt lgkmcnt(0)
    v_readlane_b32 s58, v232, 8
    s_nop 0
    s_cmp_lt_u32 s58, s22
    s_cbranch_scc0 K2_nul_121
    s_nop 0
    v_readlane_b32 s3, v253, s58
    s_nop 0
    s_bfe_u32 s58, s3, 0x60016
    s_and_b32 s59, s58, 7
    s_lshr_b32 s60, s58, 3
K2_chk_123:
    v_readlane_b32 s61, v232, s59
    s_nop 0
    s_cmp_gt_u32 s61, s60
    s_cbranch_scc0 K2_spin_122
K2_back_124:
    s_lshl_b32 s44, s34, 7
    s_and_b32 s48, s3, 0x3ffff
    s_bfe_u32 s33, s3, 0x30013
    s_mov_b32 s35, s48
    s_mov_b32 s45, s44
    s_xor_b32 s47, s44, 256
    s_add_u32 s49, s48, 128
    s_add_u32 s60, s48, 256
    s_cmp_eq_u32 s33, 3
    s_cselect_b32 s46, s44, s47
    s_cselect_b32 s50, s60, s48
    s_sub_u32 s60, s33, 2
    s_cmp_lt_u32 s60, 2
    s_cbranch_scc0 K2_rare_125
K2_back_126:
    v_add_u32 v222, s48, v251
    ds_read2_b32 v[222:223], v222 offset0:1 offset1:3
    v_add_u32 v224, s49, v251
    ds_read2_b32 v[224:225], v224 offset0:1 offset1:3
    v_add_u32 v226, s50, v251
    ds_read2_b32 v[226:227], v226 offset0:1 offset1:3
    s_waitcnt lgkmcnt(2)
    v_mad_u32_u16 v222, v222, s39, v248 op_sel:[1,0,0,0]
    v_mad_u32_u16 v223, v223, s39, v248 op_sel:[1,0,0,0]
    s_waitcnt lgkmcnt(1)
    v_mad_u32_u16 v224, v224, s39, v248 op_sel:[1,0,0,0]
    v_mad_u32_u16 v225, v225, s39, v248 op_sel:[1,0,0,0]
    s_waitcnt lgkmcnt(0)
    v_mad_u32_u16 v226, v226, s39, v248 op_sel:[1,0,0,0]
    v_mad_u32_u16 v227, v227, s39, v248 op_sel:[1,0,0,0]
    s_waitcnt vmcnt(4)
    v_mfma_f32_32x32x16_bf16 v[0:15], v[64:67], v[176:179], 0
    ds_read_b64_tr_b16 v[184:185], v246 offset:2048
    ds_read_b64_tr_b16 v[186:187], v246 offset:3072
    ds_read_b64_tr_b16 v[188:189], v247 offset:2048
    ds_read_b64_tr_b16 v[190:191], v247 offset:3072
    s_mov_b32 m0, s68
    v_mfma_f32_32x32x16_bf16 v[16:31], v[68:71], v[176:179], 0
    buffer_load_dwordx4 v222, s[4:7], s44 offen sc1 lds
    buffer_load_dwordx4 v223, s[72:75], s44 offen offset:1024 sc1 lds
    v_permlane32_swap_b32 v242, v236
    v_permlane32_swap_b32 v243, v237
    v_mfma_f32_32x32x16_bf16 v[32:47], v[64:67], v[180:183], 0
    v_permlane32_swap_b32 v244, v238
    v_permlane32_swap_b32 v245, v239
    v_permlane32_swap_b32 v240, v241
    v_add_f32 v242, v242, v236
    v_mfma_f32_32x32x16_bf16 v[48:63], v[68:71], v[180:183], 0
    s_setprio 0
    v_add_f32 v243, v243, v237
    v_add_f32 v244, v244, v238
    v_add_f32 v245, v245, v239
    v_add_f32 v240, -v240, -v241
    v_sub_u32 v241, v230, v231
    v_cvt_pk_bf16_f32 v242, v242, v243
    v_cvt_pk_bf16_f32 v244, v244, v245
    v_cvt_pk_bf16_f32 v240, v240, v240
    ds_write2st64_b32 v230, v242, v244 offset0:3 offset1:4
    ds_write_b16 v241, v240 offset:1280
    v_mul_f32 v234, v0, v96
    v_mul_f32 v236, v8, v128
    v_fmac_f32 v234, v1, v97
    v_fmac_f32 v236, v9, v129
    v_fmac_f32 v234, v2, v98
    v_fmac_f32 v236, v10, v130
    v_fmac_f32 v234, v3, v99
    v_fmac_f32 v236, v11, v131
    v_fmac_f32 v234, v4, v100
    v_fmac_f32 v236, v12, v132
    v_fmac_f32 v234, v5, v101
    v_fmac_f32 v236, v13, v133
    v_fmac_f32 v234, v6, v102
    v_fmac_f32 v236, v14, v134
    v_fmac_f32 v234, v7, v103
    v_fmac_f32 v236, v15, v135
    v_mul_f32 v238, v16, v128
    v_mul_f32 v240, v24, v128
    v_fmac_f32 v238, v17, v129
    v_fmac_f32 v240, v25, v129
    v_fmac_f32 v238, v18, v130
    v_fmac_f32 v240, v26, v130
    v_fmac_f32 v238, v19, v131
    v_fmac_f32 v240, v27, v131
    v_fmac_f32 v238, v20, v132
    v_fmac_f32 v240, v28, v132
    v_fmac_f32 v238, v21, v133
    v_fmac_f32 v240, v29, v133
    v_fmac_f32 v238, v22, v134
    v_fmac_f32 v240, v30, v134
    v_fmac_f32 v238, v23, v135
    v_fmac_f32 v240, v31, v135
    v_mul_f32 v235, v32, v104
    v_mul_f32 v237, v40, v136
    v_fmac_f32 v235, v33, v105
    v_fmac_f32 v237, v41, v137
    v_fmac_f32 v235, v34, v106
    v_fmac_f32 v237, v42, v138
    v_fmac_f32 v235, v35, v107
    v_fmac_f32 v237, v43, v139
    v_fmac_f32 v235, v36, v108
    v_fmac_f32 v237, v44, v140
    v_fmac_f32 v235, v37, v109
    v_fmac_f32 v237, v45, v141
    v_fmac_f32 v235, v38, v110
    v_fmac_f32 v237, v46, v142
    v_fmac_f32 v235, v39, v111
    v_fmac_f32 v237, v47, v143
    v_mul_f32 v239, v48, v136
    v_mul_f32 v241, v56, v136
    v_fmac_f32 v239, v49, v137
    v_fmac_f32 v241, v57, v137
    v_fmac_f32 v239, v50, v138
    v_fmac_f32 v241, v58, v138
    v_fmac_f32 v239, v51, v139
    v_fmac_f32 v241, v59, v139
    v_fmac_f32 v239, v52, v140
    v_fmac_f32 v241, v60, v140
    v_fmac_f32 v239, v53, v141
    v_fmac_f32 v241, v61, v141
    v_fmac_f32 v239, v54, v142
    v_fmac_f32 v241, v62, v142
    v_fmac_f32 v239, v55, v143
    v_fmac_f32 v241, v63, v143
    s_setprio 1
    s_waitcnt vmcnt(4) lgkmcnt(2)
    v_mfma_f32_32x32x16_bf16 v[0:15], v[64:67], v[184:187], 0
    ds_read_b64_tr_b16 v[176:177], v246 offset:4096
    ds_read_b64_tr_b16 v[178:179], v246 offset:5120
    ds_read_b64_tr_b16 v[180:181], v247 offset:4096
    ds_read_b64_tr_b16 v[182:183], v247 offset:5120
    s_mov_b32 m0, s69
    v_mfma_f32_32x32x16_bf16 v[16:31], v[68:71], v[184:187], 0
    buffer_load_dwordx4 v224, s[4:7], s45 offen sc1 lds
    buffer_load_dwordx4 v225, s[72:75], s45 offen offset:1024 sc1 lds
    v_permlane32_swap_b32 v234, v236
    v_permlane32_swap_b32 v235, v237
    v_mfma_f32_32x32x16_bf16 v[32:47], v[64:67], v[188:191], 0
    v_permlane32_swap_b32 v240, v238
    v_permlane32_swap_b32 v241, v239
    v_lshl_add_u32 v230, v252, 1, s31
    v_add_f32 v234, v234, v236
    v_add_f32 v235, v235, v237
    v_mfma_f32_32x32x16_bf16 v[48:63], v[68:71], v[188:191], 0
    s_setprio 0
    v_add_f32 v240, v240, v238
    v_add_f32 v241, v241, v239
    v_cvt_pk_bf16_f32 v234, v234, v235
    v_cvt_pk_bf16_f32 v240, v240, v241
    ds_write2st64_b32 v230, v234, v240 offset0:0 offset1:1
    v_mul_f32 v234, v0, v144
    v_mul_f32 v236, v8, v112
    v_fmac_f32 v234, v1, v145
    v_fmac_f32 v236, v9, v113
    v_fmac_f32 v234, v2, v146
    v_fmac_f32 v236, v10, v114
    v_fmac_f32 v234, v3, v147
    v_fmac_f32 v236, v11, v115
    v_fmac_f32 v234, v4, v148
    v_fmac_f32 v236, v12, v116
    v_fmac_f32 v234, v5, v149
    v_fmac_f32 v236, v13, v117
    v_fmac_f32 v234, v6, v150
    v_fmac_f32 v236, v14, v118
    v_fmac_f32 v234, v7, v151
    v_fmac_f32 v236, v15, v119
    v_mul_f32 v238, v16, v160
    v_mul_f32 v240, v24, v160
    v_fmac_f32 v238, v17, v161
    v_fmac_f32 v240, v25, v161
    v_fmac_f32 v238, v18, v162
    v_fmac_f32 v240, v26, v162
    v_fmac_f32 v238, v19, v163
    v_fmac_f32 v240, v27, v163
    v_fmac_f32 v238, v20, v164
    v_fmac_f32 v240, v28, v164
    v_fmac_f32 v238, v21, v165
    v_fmac_f32 v240, v29, v165
    v_fmac_f32 v238, v22, v166
    v_fmac_f32 v240, v30, v166
    v_fmac_f32 v238, v23, v167
    v_fmac_f32 v240, v31, v167
    v_mul_f32 v235, v32, v152
    v_mul_f32 v237, v40, v120
    v_fmac_f32 v235, v33, v153
    v_fmac_f32 v237, v41, v121
    v_fmac_f32 v235, v34, v154
    v_fmac_f32 v237, v42, v122
    v_fmac_f32 v235, v35, v155
    v_fmac_f32 v237, v43, v123
    v_fmac_f32 v235, v36, v156
    v_fmac_f32 v237, v44, v124
    v_fmac_f32 v235, v37, v157
    v_fmac_f32 v237, v45, v125
    v_fmac_f32 v235, v38, v158
    v_fmac_f32 v237, v46, v126
    v_fmac_f32 v235, v39, v159
    v_fmac_f32 v237, v47, v127
    v_mul_f32 v239, v48, v168
    v_mul_f32 v241, v56, v168
    v_fmac_f32 v239, v49, v169
    v_fmac_f32 v241, v57, v169
    v_fmac_f32 v239, v50, v170
    v_fmac_f32 v241, v58, v170
    v_fmac_f32 v239, v51, v171
    v_fmac_f32 v241, v59, v171
    v_fmac_f32 v239, v52, v172
    v_fmac_f32 v241, v60, v172
    v_fmac_f32 v239, v53, v173
    v_fmac_f32 v241, v61, v173
    v_fmac_f32 v239, v54, v174
    v_fmac_f32 v241, v62, v174
    v_fmac_f32 v239, v55, v175
    v_fmac_f32 v241, v63, v175
    s_setprio 1
    s_waitcnt vmcnt(4) lgkmcnt(1)
    v_mfma_f32_32x32x16_bf16 v[0:15], v[64:67], v[176:179], 0
    ds_read_b64_tr_b16 v[184:185], v246 offset:6144
    ds_read_b64_tr_b16 v[186:187], v246 offset:7168
    ds_read_b64_tr_b16 v[188:189], v247 offset:6144
    ds_read_b64_tr_b16 v[190:191], v247 offset:7168
    s_mov_b32 s32, s31
    s_mov_b32 s31, s35
    s_mov_b32 m0, s70
    v_mfma_f32_32x32x16_bf16 v[16:31], v[68:71], v[176:179], 0
    buffer_load_dwordx4 v226, s[4:7], s46 offen sc1 lds
    buffer_load_dwordx4 v227, s[72:75], s46 offen offset:1024 sc1 lds
    s_sub_u32 s26, s48, s29
    s_mov_b32 s29, s48
    s_mov_b32 s30, s3
    s_bfe_u32 s56, s3, 0x40012
    v_mfma_f32_32x32x16_bf16 v[32:47], v[64:67], v[180:183], 0
    s_cmp_lg_u32 s36, 0
    s_cselect_b32 s56, s56, 0
    v_mfma_f32_32x32x16_bf16 v[48:63], v[68:71], v[180:183], 0
    s_setprio 0
    v_mul_f32 v242, v0, v144
    v_fma_f32 v238, v8, v160, -v238
    v_fmac_f32 v242, v1, v145
    v_fmac_f32 v238, v9, v161
    v_fmac_f32 v242, v2, v146
    v_fmac_f32 v238, v10, v162
    v_fmac_f32 v242, v3, v147
    v_fmac_f32 v238, v11, v163
    v_fmac_f32 v242, v4, v148
    v_fmac_f32 v238, v12, v164
    v_fmac_f32 v242, v5, v149
    v_fmac_f32 v238, v13, v165
    v_fmac_f32 v242, v6, v150
    v_fmac_f32 v238, v14, v166
    v_fmac_f32 v242, v7, v151
    v_fmac_f32 v238, v15, v167
    v_fmac_f32 v236, v16, v112
    v_mul_f32 v244, v24, v160
    v_fmac_f32 v236, v17, v113
    v_fmac_f32 v244, v25, v161
    v_fmac_f32 v236, v18, v114
    v_fmac_f32 v244, v26, v162
    v_fmac_f32 v236, v19, v115
    v_fmac_f32 v244, v27, v163
    v_fmac_f32 v236, v20, v116
    v_fmac_f32 v244, v28, v164
    v_fmac_f32 v236, v21, v117
    v_fmac_f32 v244, v29, v165
    v_fmac_f32 v236, v22, v118
    v_fmac_f32 v244, v30, v166
    v_fmac_f32 v236, v23, v119
    v_fmac_f32 v244, v31, v167
    v_mul_f32 v243, v32, v152
    v_fma_f32 v239, v40, v168, -v239
    v_fmac_f32 v243, v33, v153
    v_fmac_f32 v239, v41, v169
    v_fmac_f32 v243, v34, v154
    v_fmac_f32 v239, v42, v170
    v_fmac_f32 v243, v35, v155
    v_fmac_f32 v239, v43, v171
    v_fmac_f32 v243, v36, v156
    v_fmac_f32 v239, v44, v172
    v_fmac_f32 v243, v37, v157
    v_fmac_f32 v239, v45, v173
    v_fmac_f32 v243, v38, v158
    v_fmac_f32 v239, v46, v174
    v_fmac_f32 v243, v39, v159
    v_fmac_f32 v239, v47, v175
    v_fmac_f32 v237, v48, v120
    v_mul_f32 v245, v56, v168
    v_fmac_f32 v237, v49, v121
    v_fmac_f32 v245, v57, v169
    v_fmac_f32 v237, v50, v122
    v_fmac_f32 v245, v58, v170
    v_fmac_f32 v237, v51, v123
    v_fmac_f32 v245, v59, v171
    v_fmac_f32 v237, v52, v124
    v_fmac_f32 v245, v60, v172
    v_fmac_f32 v237, v53, v125
    v_fmac_f32 v245, v61, v173
    v_fmac_f32 v237, v54, v126
    v_fmac_f32 v245, v62, v174
    v_fmac_f32 v237, v55, v127
    v_fmac_f32 v245, v63, v175
    s_setprio 1
    s_waitcnt vmcnt(4) lgkmcnt(0)
    v_mfma_f32_32x32x16_bf16 v[0:15], v[64:67], v[184:187], 0
    ds_read_b64_tr_b16 v[176:177], v246 offset:0
    ds_read_b64_tr_b16 v[178:179], v246 offset:1024
    ds_read_b64_tr_b16 v[180:181], v247 offset:0
    ds_read_b64_tr_b16 v[182:183], v247 offset:1024
    s_mov_b32 m0, s71
    v_mfma_f32_32x32x16_bf16 v[16:31], v[68:71], v[184:187], 0
    s_cmp_eq_u32 s33, 4
    s_cbranch_scc1 K2_g4_128
    buffer_load_dwordx4 v224, s[4:7], s47 offen sc1 lds
    buffer_load_dwordx4 v225, s[72:75], s47 offen offset:1024 sc1 lds
K2_back_129:
    v_permlane32_swap_b32 v242, v234
    v_mfma_f32_32x32x16_bf16 v[32:47], v[64:67], v[188:191], 0
    v_permlane32_swap_b32 v243, v235
    v_add_f32 v242, v242, v234
    v_add_f32 v243, v243, v235
    v_cvt_pk_bf16_f32 v242, v242, v243
    ds_write_b32 v230, v242 offset:512
    v_mfma_f32_32x32x16_bf16 v[48:63], v[68:71], v[188:191], 0
    s_setprio 0
    v_mul_f32 v242, v0, v144
    v_fma_f32 v240, v8, v160, -v240
    v_fmac_f32 v242, v1, v145
    v_fmac_f32 v240, v9, v161
    v_fmac_f32 v242, v2, v146
    v_fmac_f32 v240, v10, v162
    v_fmac_f32 v242, v3, v147
    v_fmac_f32 v240, v11, v163
    v_fmac_f32 v242, v4, v148
    v_fmac_f32 v240, v12, v164
    v_fmac_f32 v242, v5, v149
    v_fmac_f32 v240, v13, v165
    v_fmac_f32 v242, v6, v150
    v_fmac_f32 v240, v14, v166
    v_fmac_f32 v242, v7, v151
    v_fmac_f32 v240, v15, v167
    v_add_u32 v249, s26, v249
    v_add_u32 v250, s26, v250
    v_fma_f32 v244, v16, v160, -v244
    v_fmac_f32 v236, v24, v112
    v_fmac_f32 v244, v17, v161
    v_fmac_f32 v236, v25, v113
    v_fmac_f32 v244, v18, v162
    v_fmac_f32 v236, v26, v114
    v_fmac_f32 v244, v19, v163
    v_fmac_f32 v236, v27, v115
    v_fmac_f32 v244, v20, v164
    v_fmac_f32 v236, v28, v116
    v_fmac_f32 v244, v21, v165
    v_fmac_f32 v236, v29, v117
    v_fmac_f32 v244, v22, v166
    v_fmac_f32 v236, v30, v118
    v_fmac_f32 v244, v23, v167
    v_fmac_f32 v236, v31, v119
    ds_read_b64_tr_b16 v[0:1], v249 offset:0
    ds_read_b64_tr_b16 v[2:3], v249 offset:32
    ds_read_u16_d16_hi v16, v250 offset:0
    v_mul_f32 v243, v32, v152
    v_fma_f32 v241, v40, v168, -v241
    v_fmac_f32 v243, v33, v153
    v_fmac_f32 v241, v41, v169
    v_fmac_f32 v243, v34, v154
    v_fmac_f32 v241, v42, v170
    v_fmac_f32 v243, v35, v155
    v_fmac_f32 v241, v43, v171
    v_fmac_f32 v243, v36, v156
    v_fmac_f32 v241, v44, v172
    v_fmac_f32 v243, v37, v157
    v_fmac_f32 v241, v45, v173
    v_fmac_f32 v243, v38, v158
    v_fmac_f32 v241, v46, v174
    v_fmac_f32 v243, v39, v159
    v_fmac_f32 v241, v47, v175
    ds_read_b64_tr_b16 v[4:5], v249 offset:512
    ds_read_b64_tr_b16 v[6:7], v249 offset:544
    ds_read_u16_d16_hi v17, v250 offset:128
    v_fma_f32 v245, v48, v168, -v245
    v_fmac_f32 v237, v56, v120
    v_fmac_f32 v245, v49, v169
    v_fmac_f32 v237, v57, v121
    v_fmac_f32 v245, v50, v170
    v_fmac_f32 v237, v58, v122
    v_fmac_f32 v245, v51, v171
    v_fmac_f32 v237, v59, v123
    v_fmac_f32 v245, v52, v172
    v_fmac_f32 v237, v60, v124
    v_fmac_f32 v245, v53, v173
    v_fmac_f32 v237, v61, v125
    v_fmac_f32 v245, v54, v174
    v_fmac_f32 v237, v62, v126
    v_fmac_f32 v245, v55, v175
    v_fmac_f32 v237, v63, v127
    s_cmp_eq_u32 s56, 5
    s_cbranch_scc1 K2_U21
    s_cmp_eq_u32 s56, 6
    s_cbranch_scc1 K2_U3h1
    s_branch K2_DSP1
K2_U41:
    s_setprio 1
    ds_read_b64_tr_b16 v[8:9], v249 offset:1024
    ds_read_b64_tr_b16 v[10:11], v249 offset:1056
    ds_read_u16_d16_hi v18, v250 offset:256
    s_lshr_b32 s65, s30, 28
    s_mul_i32 s66, s22, 2080
    s_lshl_b32 s65, s65, 9
    s_add_u32 s65, s65, s66
    s_add_u32 s65, s65, 65536
    s_sub_u32 s65, s65, s29
    s_sub_u32 s65, s65, 512
    v_add_u32 v56, s65, v249
    ds_read_b64_tr_b16 v[12:13], v56 offset:0
    ds_read_b64_tr_b16 v[14:15], v56 offset:32
    ds_read_u16_d16_hi v19, v250 offset:384
    s_waitcnt lgkmcnt(6)
    v_lshlrev_b32 v20, 16, v0
    v_and_b32 v21, 0xffff0000, v0
    v_lshlrev_b32 v22, 16, v1
    v_and_b32 v23, 0xffff0000, v1
    v_lshlrev_b32 v24, 16, v2
    v_and_b32 v25, 0xffff0000, v2
    v_lshlrev_b32 v26, 16, v3
    v_and_b32 v27, 0xffff0000, v3
    v_mul_f32_dpp v36, v16, v20 row_newbcast:8 row_mask:0xf bank_mask:0xf
    v_mul_f32_dpp v37, v16, v21 row_newbcast:9 row_mask:0xf bank_mask:0xf
    v_mul_f32_dpp v38, v16, v22 row_newbcast:10 row_mask:0xf bank_mask:0xf
    v_mul_f32_dpp v39, v16, v23 row_newbcast:11 row_mask:0xf bank_mask:0xf
    v_mul_f32_dpp v40, v16, v24 row_newbcast:12 row_mask:0xf bank_mask:0xf
    v_mul_f32_dpp v41, v16, v25 row_newbcast:13 row_mask:0xf bank_mask:0xf
    v_mul_f32_dpp v42, v16, v26 row_newbcast:14 row_mask:0xf bank_mask:0xf
    v_mul_f32_dpp v43, v16, v27 row_newbcast:15 row_mask:0xf bank_mask:0xf
    v_cvt_pk_bf16_f32 v68, v36, v37
    v_cvt_pk_bf16_f32 v69, v38, v39
    v_cvt_pk_bf16_f32 v70, v40, v41
    v_cvt_pk_bf16_f32 v71, v42, v43
    v_mul_f32_dpp v20, v16, v20 row_newbcast:0 row_mask:0xa bank_mask:0xf
    v_mul_f32_dpp v21, v16, v21 row_newbcast:1 row_mask:0xa bank_mask:0xf
    v_mul_f32_dpp v22, v16, v22 row_newbcast:2 row_mask:0xa bank_mask:0xf
    v_mul_f32_dpp v23, v16, v23 row_newbcast:3 row_mask:0xa bank_mask:0xf
    v_mul_f32_dpp v24, v16, v24 row_newbcast:4 row_mask:0xa bank_mask:0xf
    v_mul_f32_dpp v25, v16, v25 row_newbcast:5 row_mask:0xa bank_mask:0xf
    v_mul_f32_dpp v26, v16, v26 row_newbcast:6 row_mask:0xa bank_mask:0xf
    v_mul_f32_dpp v27, v16, v27 row_newbcast:7 row_mask:0xa bank_mask:0xf
    v_cvt_pk_bf16_f32 v64, v20, v21
    v_cvt_pk_bf16_f32 v65, v22, v23
    v_cvt_pk_bf16_f32 v66, v24, v25
    v_cvt_pk_bf16_f32 v67, v26, v27
    v_lshlrev_b32 v28, 16, v4
    v_and_b32 v29, 0xffff0000, v4
    v_lshlrev_b32 v30, 16, v5
    v_and_b32 v31, 0xffff0000, v5
    v_lshlrev_b32 v32, 16, v6
    v_and_b32 v33, 0xffff0000, v6
    v_lshlrev_b32 v34, 16, v7
    v_and_b32 v35, 0xffff0000, v7
    v_mul_f32_dpp v36, v17, v28 row_newbcast:8 row_mask:0xf bank_mask:0xf
    v_mul_f32_dpp v37, v17, v29 row_newbcast:9 row_mask:0xf bank_mask:0xf
    v_mul_f32_dpp v38, v17, v30 row_newbcast:10 row_mask:0xf bank_mask:0xf
    v_mul_f32_dpp v39, v17, v31 row_newbcast:11 row_mask:0xf bank_mask:0xf
    v_mul_f32_dpp v40, v17, v32 row_newbcast:12 row_mask:0xf bank_mask:0xf
    v_mul_f32_dpp v41, v17, v33 row_newbcast:13 row_mask:0xf bank_mask:0xf
    v_mul_f32_dpp v42, v17, v34 row_newbcast:14 row_mask:0xf bank_mask:0xf
    v_mul_f32_dpp v43, v17, v35 row_newbcast:15 row_mask:0xf bank_mask:0xf
    v_cvt_pk_bf16_f32 v76, v36, v37
    v_cvt_pk_bf16_f32 v77, v38, v39
    v_cvt_pk_bf16_f32 v78, v40, v41
    v_cvt_pk_bf16_f32 v79, v42, v43
    v_mul_f32_dpp v28, v17, v28 row_newbcast:0 row_mask:0xa bank_mask:0xf
    v_mul_f32_dpp v29, v17, v29 row_newbcast:1 row_mask:0xa bank_mask:0xf
    v_mul_f32_dpp v30, v17, v30 row_newbcast:2 row_mask:0xa bank_mask:0xf
    v_mul_f32_dpp v31, v17, v31 row_newbcast:3 row_mask:0xa bank_mask:0xf
    v_mul_f32_dpp v32, v17, v32 row_newbcast:4 row_mask:0xa bank_mask:0xf
    v_mul_f32_dpp v33, v17, v33 row_newbcast:5 row_mask:0xa bank_mask:0xf
    v_mul_f32_dpp v34, v17, v34 row_newbcast:6 row_mask:0xa bank_mask:0xf
    v_mul_f32_dpp v35, v17, v35 row_newbcast:7 row_mask:0xa bank_mask:0xf
    v_cvt_pk_bf16_f32 v72, v28, v29
    v_cvt_pk_bf16_f32 v73, v30, v31
    v_cvt_pk_bf16_f32 v74, v32, v33
    v_cvt_pk_bf16_f32 v75, v34, v35
    s_waitcnt lgkmcnt(3)
    v_lshlrev_b32 v20, 16, v8
    v_and_b32 v21, 0xffff0000, v8
    v_lshlrev_b32 v22, 16, v9
    v_and_b32 v23, 0xffff0000, v9
    v_lshlrev_b32 v24, 16, v10
    v_and_b32 v25, 0xffff0000, v10
    v_lshlrev_b32 v26, 16, v11
    v_and_b32 v27, 0xffff0000, v11
    v_mul_f32_dpp v36, v18, v20 row_newbcast:8 row_mask:0xf bank_mask:0xf
    v_mul_f32_dpp v37, v18, v21 row_newbcast:9 row_mask:0xf bank_mask:0xf
    v_mul_f32_dpp v38, v18, v22 row_newbcast:10 row_mask:0xf bank_mask:0xf
    v_mul_f32_dpp v39, v18, v23 row_newbcast:11 row_mask:0xf bank_mask:0xf
    v_mul_f32_dpp v40, v18, v24 row_newbcast:12 row_mask:0xf bank_mask:0xf
    v_mul_f32_dpp v41, v18, v25 row_newbcast:13 row_mask:0xf bank_mask:0xf
    v_mul_f32_dpp v42, v18, v26 row_newbcast:14 row_mask:0xf bank_mask:0xf
    v_mul_f32_dpp v43, v18, v27 row_newbcast:15 row_mask:0xf bank_mask:0xf
    v_cvt_pk_bf16_f32 v84, v36, v37
    v_cvt_pk_bf16_f32 v85, v38, v39
    v_cvt_pk_bf16_f32 v86, v40, v41
    v_cvt_pk_bf16_f32 v87, v42, v43
    v_mul_f32_dpp v20, v18, v20 row_newbcast:0 row_mask:0xa bank_mask:0xf
    v_mul_f32_dpp v21, v18, v21 row_newbcast:1 row_mask:0xa bank_mask:0xf
    v_mul_f32_dpp v22, v18, v22 row_newbcast:2 row_mask:0xa bank_mask:0xf
    v_mul_f32_dpp v23, v18, v23 row_newbcast:3 row_mask:0xa bank_mask:0xf
    v_mul_f32_dpp v24, v18, v24 row_newbcast:4 row_mask:0xa bank_mask:0xf
    v_mul_f32_dpp v25, v18, v25 row_newbcast:5 row_mask:0xa bank_mask:0xf
    v_mul_f32_dpp v26, v18, v26 row_newbcast:6 row_mask:0xa bank_mask:0xf
    v_mul_f32_dpp v27, v18, v27 row_newbcast:7 row_mask:0xa bank_mask:0xf
    v_cvt_pk_bf16_f32 v80, v20, v21
    v_cvt_pk_bf16_f32 v81, v22, v23
    v_cvt_pk_bf16_f32 v82, v24, v25
    v_cvt_pk_bf16_f32 v83, v26, v27
    s_waitcnt lgkmcnt(0)
    v_lshlrev_b32 v28, 16, v12
    v_and_b32 v29, 0xffff0000, v12
    v_lshlrev_b32 v30, 16, v13
    v_and_b32 v31, 0xffff0000, v13
    v_lshlrev_b32 v32, 16, v14
    v_and_b32 v33, 0xffff0000, v14
    v_lshlrev_b32 v34, 16, v15
    v_and_b32 v35, 0xffff0000, v15
    v_mul_f32_dpp v36, v19, v28 row_newbcast:8 row_mask:0xf bank_mask:0xf
    v_mul_f32_dpp v37, v19, v29 row_newbcast:9 row_mask:0xf bank_mask:0xf
    v_mul_f32_dpp v38, v19, v30 row_newbcast:10 row_mask:0xf bank_mask:0xf
    v_mul_f32_dpp v39, v19, v31 row_newbcast:11 row_mask:0xf bank_mask:0xf
    v_mul_f32_dpp v40, v19, v32 row_newbcast:12 row_mask:0xf bank_mask:0xf
    v_mul_f32_dpp v41, v19, v33 row_newbcast:13 row_mask:0xf bank_mask:0xf
    v_mul_f32_dpp v42, v19, v34 row_newbcast:14 row_mask:0xf bank_mask:0xf
    v_mul_f32_dpp v43, v19, v35 row_newbcast:15 row_mask:0xf bank_mask:0xf
    v_cvt_pk_bf16_f32 v92, v36, v37
    v_cvt_pk_bf16_f32 v93, v38, v39
    v_cvt_pk_bf16_f32 v94, v40, v41
    v_cvt_pk_bf16_f32 v95, v42, v43
    v_mul_f32_dpp v28, v19, v28 row_newbcast:0 row_mask:0xa bank_mask:0xf
    v_mul_f32_dpp v29, v19, v29 row_newbcast:1 row_mask:0xa bank_mask:0xf
    v_mul_f32_dpp v30, v19, v30 row_newbcast:2 row_mask:0xa bank_mask:0xf
    v_mul_f32_dpp v31, v19, v31 row_newbcast:3 row_mask:0xa bank_mask:0xf
    v_mul_f32_dpp v32, v19, v32 row_newbcast:4 row_mask:0xa bank_mask:0xf
    v_mul_f32_dpp v33, v19, v33 row_newbcast:5 row_mask:0xa bank_mask:0xf
    v_mul_f32_dpp v34, v19, v34 row_newbcast:6 row_mask:0xa bank_mask:0xf
    v_mul_f32_dpp v35, v19, v35 row_newbcast:7 row_mask:0xa bank_mask:0xf
    v_cvt_pk_bf16_f32 v88, v28, v29
    v_cvt_pk_bf16_f32 v89, v30, v31
    v_cvt_pk_bf16_f32 v90, v32, v33
    v_cvt_pk_bf16_f32 v91, v34, v35
    s_waitcnt vmcnt(4)
    v_mfma_f32_32x32x16_bf16 v[0:15], v[64:67], v[176:179], 0
    ds_read_b64_tr_b16 v[184:185], v246 offset:2048
    ds_read_b64_tr_b16 v[186:187], v246 offset:3072
    ds_read_b64_tr_b16 v[188:189], v247 offset:2048
    ds_read_b64_tr_b16 v[190:191], v247 offset:3072
    s_mov_b32 m0, s68
    v_mfma_f32_32x32x16_bf16 v[16:31], v[68:71], v[176:179], 0
    buffer_load_dwordx4 v222, s[4:7], s41 offen sc1 lds
    buffer_load_dwordx4 v223, s[72:75], s41 offen offset:1024 sc1 lds
    v_permlane32_swap_b32 v242, v236
    v_permlane32_swap_b32 v243, v237
    v_mfma_f32_32x32x16_bf16 v[32:47], v[64:67], v[180:183], 0
    v_permlane32_swap_b32 v244, v238
    v_permlane32_swap_b32 v245, v239
    v_permlane32_swap_b32 v240, v241
    v_add_f32 v242, v242, v236
    v_mfma_f32_32x32x16_bf16 v[48:63], v[68:71], v[180:183], 0
    v_add_f32 v243, v243, v237
    v_add_f32 v244, v244, v238
    v_add_f32 v245, v245, v239
    v_add_f32 v240, -v240, -v241
    v_sub_u32 v241, v230, v231
    v_cvt_pk_bf16_f32 v242, v242, v243
    s_mov_b64 exec, 0x1ff
    ds_add_rtn_u32 v232, v254, v255
    s_mov_b64 exec, -1
    s_waitcnt vmcnt(4) lgkmcnt(1)
    v_mfma_f32_32x32x16_bf16 v[0:15], v[72:75], v[184:187], v[0:15]
    ds_read_b64_tr_b16 v[176:177], v246 offset:4096
    ds_read_b64_tr_b16 v[178:179], v246 offset:5120
    ds_read_b64_tr_b16 v[180:181], v247 offset:4096
    ds_read_b64_tr_b16 v[182:183], v247 offset:5120
    v_cvt_pk_bf16_f32 v244, v244, v245
    v_cvt_pk_bf16_f32 v240, v240, v240
    s_mov_b32 m0, s69
    v_mfma_f32_32x32x16_bf16 v[16:31], v[76:79], v[184:187], v[16:31]
    buffer_load_dwordx4 v224, s[4:7], s41 offen sc1 lds
    buffer_load_dwordx4 v225, s[72:75], s41 offen offset:1024 sc1 lds
    ds_write2st64_b32 v230, v242, v244 offset0:3 offset1:4
    ds_write_b16 v241, v240 offset:1280
    s_waitcnt lgkmcnt(6)
    v_readlane_b32 s58, v232, 8
    v_mfma_f32_32x32x16_bf16 v[32:47], v[72:75], v[188:191], v[32:47]
    s_cmp_lt_u32 s58, s22
    s_cbranch_scc0 K2_nul_130
    s_nop 0
    v_readlane_b32 s3, v253, s58
    s_nop 0
    s_bfe_u32 s58, s3, 0x60016
    s_and_b32 s59, s58, 7
    s_lshr_b32 s60, s58, 3
K2_chk_132:
    v_readlane_b32 s61, v232, s59
    s_nop 0
    s_cmp_gt_u32 s61, s60
    s_cbranch_scc0 K2_spin_131
K2_back_133:
    v_mfma_f32_32x32x16_bf16 v[48:63], v[76:79], v[188:191], v[48:63]
    s_lshl_b32 s44, s34, 7
    s_and_b32 s48, s3, 0x3ffff
    s_bfe_u32 s33, s3, 0x30013
    s_mov_b32 s35, s48
    s_mov_b32 s45, s44
    s_xor_b32 s47, s44, 256
    s_waitcnt vmcnt(4) lgkmcnt(2)
    v_mfma_f32_32x32x16_bf16 v[0:15], v[80:83], v[176:179], v[0:15]
    ds_read_b64_tr_b16 v[184:185], v246 offset:6144
    ds_read_b64_tr_b16 v[186:187], v246 offset:7168
    ds_read_b64_tr_b16 v[188:189], v247 offset:6144
    ds_read_b64_tr_b16 v[190:191], v247 offset:7168
    s_add_u32 s49, s48, 128
    s_add_u32 s60, s48, 256
    s_mov_b32 m0, s70
    v_mfma_f32_32x32x16_bf16 v[16:31], v[84:87], v[176:179], v[16:31]
    buffer_load_dwordx4 v226, s[4:7], s41 offen sc1 lds
    buffer_load_dwordx4 v227, s[72:75], s41 offen offset:1024 sc1 lds
    s_cmp_eq_u32 s33, 3
    s_cselect_b32 s46, s44, s47
    s_cselect_b32 s50, s60, s48
    v_mfma_f32_32x32x16_bf16 v[32:47], v[80:83], v[180:183], v[32:47]
    s_sub_u32 s60, s33, 2
    s_cmp_lt_u32 s60, 2
    s_cbranch_scc0 K2_rare_134
K2_back_135:
    v_mfma_f32_32x32x16_bf16 v[48:63], v[84:87], v[180:183], v[48:63]
    s_waitcnt vmcnt(4) lgkmcnt(0)
    v_mfma_f32_32x32x16_bf16 v[0:15], v[88:91], v[184:187], v[0:15]
    ds_read_b64_tr_b16 v[176:177], v246 offset:0
    ds_read_b64_tr_b16 v[178:179], v246 offset:1024
    ds_read_b64_tr_b16 v[180:181], v247 offset:0
    ds_read_b64_tr_b16 v[182:183], v247 offset:1024
    s_mov_b32 m0, s71
    v_mfma_f32_32x32x16_bf16 v[16:31], v[92:95], v[184:187], v[16:31]
    buffer_load_dwordx4 v228, s[4:7], s41 offen sc1 lds
    buffer_load_dwordx4 v229, s[72:75], s41 offen offset:1024 sc1 lds
    v_mfma_f32_32x32x16_bf16 v[32:47], v[88:91], v[188:191], v[32:47]
    s_nop 2
    v_mul_f32 v234, v0, v96
    v_mul_f32 v236, v8, v128
    v_fmac_f32 v234, v1, v97
    v_fmac_f32 v236, v9, v129
    v_fmac_f32 v234, v2, v98
    v_fmac_f32 v236, v10, v130
    v_fmac_f32 v234, v3, v99
    v_mfma_f32_32x32x16_bf16 v[48:63], v[92:95], v[188:191], v[48:63]
    s_setprio 0
    v_fmac_f32 v236, v11, v131
    v_fmac_f32 v234, v4, v100
    v_fmac_f32 v236, v12, v132
    v_fmac_f32 v234, v5, v101
    v_fmac_f32 v236, v13, v133
    v_fmac_f32 v234, v6, v102
    v_fmac_f32 v236, v14, v134
    v_fmac_f32 v234, v7, v103
    v_fmac_f32 v236, v15, v135
    v_mul_f32 v238, v16, v128
    v_mul_f32 v240, v24, v128
    v_fmac_f32 v238, v17, v129
    v_fmac_f32 v240, v25, v129
    v_fmac_f32 v238, v18, v130
    v_fmac_f32 v240, v26, v130
    v_fmac_f32 v238, v19, v131
    v_fmac_f32 v240, v27, v131
    v_fmac_f32 v238, v20, v132
    v_fmac_f32 v240, v28, v132
    v_fmac_f32 v238, v21, v133
    v_fmac_f32 v240, v29, v133
    v_fmac_f32 v238, v22, v134
    v_fmac_f32 v240, v30, v134
    v_fmac_f32 v238, v23, v135
    v_fmac_f32 v240, v31, v135
    v_mul_f32 v235, v32, v104
    v_mul_f32 v237, v40, v136
    v_fmac_f32 v235, v33, v105
    v_fmac_f32 v237, v41, v137
    v_fmac_f32 v235, v34, v106
    v_fmac_f32 v237, v42, v138
    v_fmac_f32 v235, v35, v107
    v_fmac_f32 v237, v43, v139
    v_fmac_f32 v235, v36, v108
    v_fmac_f32 v237, v44, v140
    v_fmac_f32 v235, v37, v109
    v_fmac_f32 v237, v45, v141
    v_fmac_f32 v235, v38, v110
    v_fmac_f32 v237, v46, v142
    v_fmac_f32 v235, v39, v111
    v_fmac_f32 v237, v47, v143
    v_mul_f32 v239, v48, v136
    v_mul_f32 v241, v56, v136
    s_setprio 1
    s_waitcnt vmcnt(4) lgkmcnt(0)
    v_mfma_f32_32x32x16_bf16 v[0:15], v[64:67], v[176:179], 0
    ds_read_b64_tr_b16 v[184:185], v246 offset:2048
    ds_read_b64_tr_b16 v[186:187], v246 offset:3072
    ds_read_b64_tr_b16 v[188:189], v247 offset:2048
    ds_read_b64_tr_b16 v[190:191], v247 offset:3072
    v_fmac_f32 v239, v49, v137
    v_fmac_f32 v241, v57, v137
    s_mov_b32 m0, s68
    v_mfma_f32_32x32x16_bf16 v[16:31], v[68:71], v[176:179], 0
    buffer_load_dwordx4 v222, s[4:7], s42 offen sc1 lds
    buffer_load_dwordx4 v223, s[72:75], s42 offen offset:1024 sc1 lds
    v_fmac_f32 v239, v50, v138
    v_fmac_f32 v241, v58, v138
    v_fmac_f32 v239, v51, v139
    v_fmac_f32 v241, v59, v139
    v_fmac_f32 v239, v52, v140
    v_mfma_f32_32x32x16_bf16 v[32:47], v[64:67], v[180:183], 0
    v_fmac_f32 v241, v60, v140
    v_fmac_f32 v239, v53, v141
    v_fmac_f32 v241, v61, v141
    v_fmac_f32 v239, v54, v142
    v_fmac_f32 v241, v62, v142
    v_fmac_f32 v239, v55, v143
    v_fmac_f32 v241, v63, v143
    v_mfma_f32_32x32x16_bf16 v[48:63], v[68:71], v[180:183], 0
    v_permlane32_swap_b32 v234, v236
    v_permlane32_swap_b32 v235, v237
    v_permlane32_swap_b32 v240, v238
    s_waitcnt vmcnt(4) lgkmcnt(0)
    v_mfma_f32_32x32x16_bf16 v[0:15], v[72:75], v[184:187], v[0:15]
    ds_read_b64_tr_b16 v[176:177], v246 offset:4096
    ds_read_b64_tr_b16 v[178:179], v246 offset:5120
    ds_read_b64_tr_b16 v[180:181], v247 offset:4096
    ds_read_b64_tr_b16 v[182:183], v247 offset:5120
    v_permlane32_swap_b32 v241, v239
    s_mov_b32 m0, s69
    v_mfma_f32_32x32x16_bf16 v[16:31], v[76:79], v[184:187], v[16:31]
    buffer_load_dwordx4 v224, s[4:7], s42 offen sc1 lds
    buffer_load_dwordx4 v225, s[72:75], s42 offen offset:1024 sc1 lds
    v_lshl_add_u32 v230, v252, 1, s31
    v_add_f32 v234, v234, v236
    v_add_f32 v235, v235, v237
    v_add_f32 v240, v240, v238
    v_add_f32 v241, v241, v239
    v_mfma_f32_32x32x16_bf16 v[32:47], v[72:75], v[188:191], v[32:47]
    v_cvt_pk_bf16_f32 v234, v234, v235
    v_cvt_pk_bf16_f32 v240, v240, v241
    ds_write2st64_b32 v230, v234, v240 offset0:0 offset1:1
    v_mfma_f32_32x32x16_bf16 v[48:63], v[76:79], v[188:191], v[48:63]
    s_waitcnt vmcnt(4) lgkmcnt(1)
    v_mfma_f32_32x32x16_bf16 v[0:15], v[80:83], v[176:179], v[0:15]
    ds_read_b64_tr_b16 v[184:185], v246 offset:6144
    ds_read_b64_tr_b16 v[186:187], v246 offset:7168
    ds_read_b64_tr_b16 v[188:189], v247 offset:6144
    ds_read_b64_tr_b16 v[190:191], v247 offset:7168
    s_mov_b32 m0, s70
    v_mfma_f32_32x32x16_bf16 v[16:31], v[84:87], v[176:179], v[16:31]
    buffer_load_dwordx4 v226, s[4:7], s42 offen sc1 lds
    buffer_load_dwordx4 v227, s[72:75], s42 offen offset:1024 sc1 lds
    v_mfma_f32_32x32x16_bf16 v[32:47], v[80:83], v[180:183], v[32:47]
    v_mfma_f32_32x32x16_bf16 v[48:63], v[84:87], v[180:183], v[48:63]
    s_waitcnt vmcnt(4) lgkmcnt(0)
    v_mfma_f32_32x32x16_bf16 v[0:15], v[88:91], v[184:187], v[0:15]
    ds_read_b64_tr_b16 v[176:177], v246 offset:0
    ds_read_b64_tr_b16 v[178:179], v246 offset:1024
    ds_read_b64_tr_b16 v[180:181], v247 offset:0
    ds_read_b64_tr_b16 v[182:183], v247 offset:1024
    s_mov_b32 m0, s71
    v_mfma_f32_32x32x16_bf16 v[16:31], v[92:95], v[184:187], v[16:31]
    buffer_load_dwordx4 v228, s[4:7], s42 offen sc1 lds
    buffer_load_dwordx4 v229, s[72:75], s42 offen offset:1024 sc1 lds
    v_mfma_f32_32x32x16_bf16 v[32:47], v[88:91], v[188:191], v[32:47]
    s_nop 2
    v_mul_f32 v234, v0, v144
    v_mul_f32 v236, v8, v112
    v_fmac_f32 v234, v1, v145
    v_fmac_f32 v236, v9, v113
    v_fmac_f32 v234, v2, v146
    v_fmac_f32 v236, v10, v114
    v_fmac_f32 v234, v3, v147
    v_mfma_f32_32x32x16_bf16 v[48:63], v[92:95], v[188:191], v[48:63]
    s_setprio 0
    v_fmac_f32 v236, v11, v115
    v_fmac_f32 v234, v4, v148
    v_fmac_f32 v236, v12, v116
    v_fmac_f32 v234, v5, v149
    v_fmac_f32 v236, v13, v117
    v_fmac_f32 v234, v6, v150
    v_fmac_f32 v236, v14, v118
    v_fmac_f32 v234, v7, v151
    v_fmac_f32 v236, v15, v119
    v_mul_f32 v238, v16, v160
    v_mul_f32 v240, v24, v160
    v_fmac_f32 v238, v17, v161
    v_fmac_f32 v240, v25, v161
    v_fmac_f32 v238, v18, v162
    v_fmac_f32 v240, v26, v162
    v_fmac_f32 v238, v19, v163
    v_fmac_f32 v240, v27, v163
    v_fmac_f32 v238, v20, v164
    v_fmac_f32 v240, v28, v164
    v_fmac_f32 v238, v21, v165
    v_fmac_f32 v240, v29, v165
    v_fmac_f32 v238, v22, v166
    v_fmac_f32 v240, v30, v166
    v_fmac_f32 v238, v23, v167
    v_fmac_f32 v240, v31, v167
    v_mul_f32 v235, v32, v152
    v_mul_f32 v237, v40, v120
    v_fmac_f32 v235, v33, v153
    v_fmac_f32 v237, v41, v121
    v_fmac_f32 v235, v34, v154
    v_fmac_f32 v237, v42, v122
    v_fmac_f32 v235, v35, v155
    v_fmac_f32 v237, v43, v123
    v_fmac_f32 v235, v36, v156
    v_fmac_f32 v237, v44, v124
    v_fmac_f32 v235, v37, v157
    v_fmac_f32 v237, v45, v125
    v_fmac_f32 v235, v38, v158
    v_fmac_f32 v237, v46, v126
    v_fmac_f32 v235, v39, v159
    v_fmac_f32 v237, v47, v127
    v_mul_f32 v239, v48, v168
    v_mul_f32 v241, v56, v168
    s_setprio 1
    s_waitcnt vmcnt(4) lgkmcnt(0)
    v_mfma_f32_32x32x16_bf16 v[0:15], v[64:67], v[176:179], 0
    ds_read_b64_tr_b16 v[184:185], v246 offset:2048
    ds_read_b64_tr_b16 v[186:187], v246 offset:3072
    ds_read_b64_tr_b16 v[188:189], v247 offset:2048
    ds_read_b64_tr_b16 v[190:191], v247 offset:3072
    v_fmac_f32 v239, v49, v169
    v_fmac_f32 v241, v57, v169
    s_mov_b32 m0, s68
    v_mfma_f32_32x32x16_bf16 v[16:31], v[68:71], v[176:179], 0
    buffer_load_dwordx4 v222, s[4:7], s43 offen sc1 lds
    buffer_load_dwordx4 v223, s[72:75], s43 offen offset:1024 sc1 lds
    v_fmac_f32 v239, v50, v170
    v_fmac_f32 v241, v58, v170
    v_fmac_f32 v239, v51, v171
    v_fmac_f32 v241, v59, v171
    v_fmac_f32 v239, v52, v172
    v_mfma_f32_32x32x16_bf16 v[32:47], v[64:67], v[180:183], 0
    v_fmac_f32 v241, v60, v172
    v_fmac_f32 v239, v53, v173
    v_fmac_f32 v241, v61, v173
    v_fmac_f32 v239, v54, v174
    v_fmac_f32 v241, v62, v174
    v_fmac_f32 v239, v55, v175
    v_fmac_f32 v241, v63, v175
    v_mfma_f32_32x32x16_bf16 v[48:63], v[68:71], v[180:183], 0
    s_waitcnt vmcnt(4) lgkmcnt(0)
    v_mfma_f32_32x32x16_bf16 v[0:15], v[72:75], v[184:187], v[0:15]
    ds_read_b64_tr_b16 v[176:177], v246 offset:4096
    ds_read_b64_tr_b16 v[178:179], v246 offset:5120
    ds_read_b64_tr_b16 v[180:181], v247 offset:4096
    ds_read_b64_tr_b16 v[182:183], v247 offset:5120
    s_mov_b32 m0, s69
    v_mfma_f32_32x32x16_bf16 v[16:31], v[76:79], v[184:187], v[16:31]
    buffer_load_dwordx4 v224, s[4:7], s43 offen sc1 lds
    buffer_load_dwordx4 v225, s[72:75], s43 offen offset:1024 sc1 lds
    v_mfma_f32_32x32x16_bf16 v[32:47], v[72:75], v[188:191], v[32:47]
    v_mfma_f32_32x32x16_bf16 v[48:63], v[76:79], v[188:191], v[48:63]
    s_waitcnt vmcnt(4) lgkmcnt(0)
    v_mfma_f32_32x32x16_bf16 v[0:15], v[80:83], v[176:179], v[0:15]
    ds_read_b64_tr_b16 v[184:185], v246 offset:6144
    ds_read_b64_tr_b16 v[186:187], v246 offset:7168
    ds_read_b64_tr_b16 v[188:189], v247 offset:6144
    ds_read_b64_tr_b16 v[190:191], v247 offset:7168
    s_mov_b32 m0, s70
    v_mfma_f32_32x32x16_bf16 v[16:31], v[84:87], v[176:179], v[16:31]
    buffer_load_dwordx4 v226, s[4:7], s43 offen sc1 lds
    buffer_load_dwordx4 v227, s[72:75], s43 offen offset:1024 sc1 lds
    v_mfma_f32_32x32x16_bf16 v[32:47], v[80:83], v[180:183], v[32:47]
    v_add_u32 v222, s48, v251
    ds_read2_b32 v[222:223], v222 offset0:1 offset1:3
    v_mfma_f32_32x32x16_bf16 v[48:63], v[84:87], v[180:183], v[48:63]
    s_waitcnt vmcnt(4) lgkmcnt(1)
    v_mfma_f32_32x32x16_bf16 v[0:15], v[88:91], v[184:187], v[0:15]
    ds_read_b64_tr_b16 v[176:177], v246 offset:0
    ds_read_b64_tr_b16 v[178:179], v246 offset:1024
    ds_read_b64_tr_b16 v[180:181], v247 offset:0
    ds_read_b64_tr_b16 v[182:183], v247 offset:1024
    s_mov_b32 m0, s71
    v_mfma_f32_32x32x16_bf16 v[16:31], v[92:95], v[184:187], v[16:31]
    buffer_load_dwordx4 v228, s[4:7], s43 offen sc1 lds
    buffer_load_dwordx4 v229, s[72:75], s43 offen offset:1024 sc1 lds
    s_waitcnt lgkmcnt(4)
    v_mad_u32_u16 v222, v222, s39, v248 op_sel:[1,0,0,0]
    v_mad_u32_u16 v223, v223, s39, v248 op_sel:[1,0,0,0]
    v_mfma_f32_32x32x16_bf16 v[32:47], v[88:91], v[188:191], v[32:47]
    v_add_u32 v224, s49, v251
    ds_read2_b32 v[224:225], v224 offset0:1 offset1:3
    v_mul_f32 v242, v0, v144
    v_fma_f32 v238, v8, v160, -v238
    v_fmac_f32 v242, v1, v145
    v_fmac_f32 v238, v9, v161
    v_fmac_f32 v242, v2, v146
    v_mfma_f32_32x32x16_bf16 v[48:63], v[92:95], v[188:191], v[48:63]
    s_setprio 0
    v_fmac_f32 v238, v10, v162
    v_fmac_f32 v242, v3, v147
    v_fmac_f32 v238, v11, v163
    v_fmac_f32 v242, v4, v148
    v_fmac_f32 v238, v12, v164
    v_fmac_f32 v242, v5, v149
    v_fmac_f32 v238, v13, v165
    v_fmac_f32 v242, v6, v150
    v_fmac_f32 v238, v14, v166
    v_fmac_f32 v242, v7, v151
    v_fmac_f32 v238, v15, v167
    v_fmac_f32 v236, v16, v112
    v_mul_f32 v244, v24, v160
    v_fmac_f32 v236, v17, v113
    v_fmac_f32 v244, v25, v161
    v_fmac_f32 v236, v18, v114
    v_fmac_f32 v244, v26, v162
    v_fmac_f32 v236, v19, v115
    v_fmac_f32 v244, v27, v163
    v_fmac_f32 v236, v20, v116
    v_fmac_f32 v244, v28, v164
    v_fmac_f32 v236, v21, v117
    v_fmac_f32 v244, v29, v165
    v_fmac_f32 v236, v22, v118
    v_fmac_f32 v244, v30, v166
    v_fmac_f32 v236, v23, v119
    v_fmac_f32 v244, v31, v167
    v_mul_f32 v243, v32, v152
    v_fma_f32 v239, v40, v168, -v239
    v_fmac_f32 v243, v33, v153
    v_fmac_f32 v239, v41, v169
    v_fmac_f32 v243, v34, v154
    v_fmac_f32 v239, v42, v170
    v_fmac_f32 v243, v35, v155
    v_fmac_f32 v239, v43, v171
    v_fmac_f32 v243, v36, v156
    v_fmac_f32 v239, v44, v172
    v_fmac_f32 v243, v37, v157
    v_fmac_f32 v239, v45, v173
    v_fmac_f32 v243, v38, v158
    v_fmac_f32 v239, v46, v174
    v_fmac_f32 v243, v39, v159
    v_fmac_f32 v239, v47, v175
    v_fmac_f32 v237, v48, v120
    v_mul_f32 v245, v56, v168
    v_fmac_f32 v237, v49, v121
    v_fmac_f32 v245, v57, v169
    v_fmac_f32 v237, v50, v122
    v_fmac_f32 v245, v58, v170
    v_fmac_f32 v237, v51, v123
    s_setprio 1
    s_waitcnt vmcnt(4) lgkmcnt(1)
    v_mfma_f32_32x32x16_bf16 v[0:15], v[64:67], v[176:179], 0
    ds_read_b64_tr_b16 v[184:185], v246 offset:2048
    ds_read_b64_tr_b16 v[186:187], v246 offset:3072
    ds_read_b64_tr_b16 v[188:189], v247 offset:2048
    ds_read_b64_tr_b16 v[190:191], v247 offset:3072
    v_fmac_f32 v245, v59, v171
    v_fmac_f32 v237, v52, v124
    s_mov_b32 m0, s68
    v_mfma_f32_32x32x16_bf16 v[16:31], v[68:71], v[176:179], 0
    buffer_load_dwordx4 v222, s[4:7], s44 offen sc1 lds
    buffer_load_dwordx4 v223, s[72:75], s44 offen offset:1024 sc1 lds
    s_waitcnt lgkmcnt(4)
    v_mad_u32_u16 v224, v224, s39, v248 op_sel:[1,0,0,0]
    v_mad_u32_u16 v225, v225, s39, v248 op_sel:[1,0,0,0]
    v_fmac_f32 v245, v60, v172
    v_fmac_f32 v237, v53, v125
    v_mfma_f32_32x32x16_bf16 v[32:47], v[64:67], v[180:183], 0
    v_add_u32 v226, s50, v251
    ds_read2_b32 v[226:227], v226 offset0:1 offset1:3
    v_fmac_f32 v245, v61, v173
    v_fmac_f32 v237, v54, v126
    v_fmac_f32 v245, v62, v174
    v_fmac_f32 v237, v55, v127
    v_fmac_f32 v245, v63, v175
    v_mfma_f32_32x32x16_bf16 v[48:63], v[68:71], v[180:183], 0
    v_permlane32_swap_b32 v242, v234
    v_permlane32_swap_b32 v243, v235
    v_add_f32 v242, v242, v234
    v_add_f32 v243, v243, v235
    s_waitcnt vmcnt(4) lgkmcnt(1)
    v_mfma_f32_32x32x16_bf16 v[0:15], v[72:75], v[184:187], v[0:15]
    ds_read_b64_tr_b16 v[176:177], v246 offset:4096
    ds_read_b64_tr_b16 v[178:179], v246 offset:5120
    ds_read_b64_tr_b16 v[180:181], v247 offset:4096
    ds_read_b64_tr_b16 v[182:183], v247 offset:5120
    v_cvt_pk_bf16_f32 v242, v242, v243
    ds_write_b32 v230, v242 offset:512
    s_mov_b32 m0, s69
    v_mfma_f32_32x32x16_bf16 v[16:31], v[76:79], v[184:187], v[16:31]
    buffer_load_dwordx4 v224, s[4:7], s45 offen sc1 lds
    buffer_load_dwordx4 v225, s[72:75], s45 offen offset:1024 sc1 lds
    s_waitcnt lgkmcnt(5)
    v_mad_u32_u16 v226, v226, s39, v248 op_sel:[1,0,0,0]
    v_mad_u32_u16 v227, v227, s39, v248 op_sel:[1,0,0,0]
    v_mfma_f32_32x32x16_bf16 v[32:47], v[72:75], v[188:191], v[32:47]
    v_mfma_f32_32x32x16_bf16 v[48:63], v[76:79], v[188:191], v[48:63]
    s_waitcnt vmcnt(4) lgkmcnt(1)
    v_mfma_f32_32x32x16_bf16 v[0:15], v[80:83], v[176:179], v[0:15]
    ds_read_b64_tr_b16 v[184:185], v246 offset:6144
    ds_read_b64_tr_b16 v[186:187], v246 offset:7168
    ds_read_b64_tr_b16 v[188:189], v247 offset:6144
    ds_read_b64_tr_b16 v[190:191], v247 offset:7168
    s_mov_b32 s32, s31
    s_mov_b32 s31, s35
    s_mov_b32 m0, s70
    v_mfma_f32_32x32x16_bf16 v[16:31], v[84:87], v[176:179], v[16:31]
    buffer_load_dwordx4 v226, s[4:7], s46 offen sc1 lds
    buffer_load_dwordx4 v227, s[72:75], s46 offen offset:1024 sc1 lds
    s_sub_u32 s26, s48, s29
    s_mov_b32 s29, s48
    s_mov_b32 s30, s3
    s_bfe_u32 s56, s3, 0x40012
    v_mfma_f32_32x32x16_bf16 v[32:47], v[80:83], v[180:183], v[32:47]
    s_cmp_lg_u32 s36, 0
    s_cselect_b32 s56, s56, 0
    v_mfma_f32_32x32x16_bf16 v[48:63], v[84:87], v[180:183], v[48:63]
    s_waitcnt vmcnt(4) lgkmcnt(0)
    v_mfma_f32_32x32x16_bf16 v[0:15], v[88:91], v[184:187], v[0:15]
    ds_read_b64_tr_b16 v[176:177], v246 offset:0
    ds_read_b64_tr_b16 v[178:179], v246 offset:1024
    ds_read_b64_tr_b16 v[180:181], v247 offset:0
    ds_read_b64_tr_b16 v[182:183], v247 offset:1024
    s_mov_b32 m0, s71
    v_mfma_f32_32x32x16_bf16 v[16:31], v[92:95], v[184:187], v[16:31]
    s_cmp_eq_u32 s33, 4
    s_cbranch_scc1 K2_g4_137
    buffer_load_dwordx4 v224, s[4:7], s47 offen sc1 lds
    buffer_load_dwordx4 v225, s[72:75], s47 offen offset:1024 sc1 lds
K2_back_138:
    v_mfma_f32_32x32x16_bf16 v[32:47], v[88:91], v[188:191], v[32:47]
    s_nop 0
    v_mul_f32 v242, v0, v144
    v_fma_f32 v240, v8, v160, -v240
    v_fmac_f32 v242, v1, v145
    v_fmac_f32 v240, v9, v161
    v_fmac_f32 v242, v2, v146
    v_fmac_f32 v240, v10, v162
    v_fmac_f32 v242, v3, v147
    v_mfma_f32_32x32x16_bf16 v[48:63], v[92:95], v[188:191], v[48:63]
    s_setprio 0
    v_fmac_f32 v240, v11, v163
    v_fmac_f32 v242, v4, v148
    v_fmac_f32 v240, v12, v164
    v_fmac_f32 v242, v5, v149
    v_fmac_f32 v240, v13, v165
    v_fmac_f32 v242, v6, v150
    v_fmac_f32 v240, v14, v166
    v_fmac_f32 v242, v7, v151
    v_fmac_f32 v240, v15, v167
    v_add_u32 v249, s26, v249
    v_add_u32 v250, s26, v250
    v_fma_f32 v244, v16, v160, -v244
    v_fmac_f32 v236, v24, v112
    v_fmac_f32 v244, v17, v161
    v_fmac_f32 v236, v25, v113
    v_fmac_f32 v244, v18, v162
    v_fmac_f32 v236, v26, v114
    v_fmac_f32 v244, v19, v163
    v_fmac_f32 v236, v27, v115
    v_fmac_f32 v244, v20, v164
    v_fmac_f32 v236, v28, v116
    v_fmac_f32 v244, v21, v165
    v_fmac_f32 v236, v29, v117
    v_fmac_f32 v244, v22, v166
    v_fmac_f32 v236, v30, v118
    v_fmac_f32 v244, v23, v167
    v_fmac_f32 v236, v31, v119
    ds_read_b64_tr_b16 v[0:1], v249 offset:0
    ds_read_b64_tr_b16 v[2:3], v249 offset:32
    ds_read_u16_d16_hi v16, v250 offset:0
    v_mul_f32 v243, v32, v152
    v_fma_f32 v241, v40, v168, -v241
    v_fmac_f32 v243, v33, v153
    v_fmac_f32 v241, v41, v169
    v_fmac_f32 v243, v34, v154
    v_fmac_f32 v241, v42, v170
    v_fmac_f32 v243, v35, v155
    v_fmac_f32 v241, v43, v171
    v_fmac_f32 v243, v36, v156
    v_fmac_f32 v241, v44, v172
    v_fmac_f32 v243, v37, v157
    v_fmac_f32 v241, v45, v173
    v_fmac_f32 v243, v38, v158
    v_fmac_f32 v241, v46, v174
    v_fmac_f32 v243, v39, v159
    v_fmac_f32 v241, v47, v175
    ds_read_b64_tr_b16 v[4:5], v249 offset:512
    ds_read_b64_tr_b16 v[6:7], v249 offset:544
    ds_read_u16_d16_hi v17, v250 offset:128
    v_fma_f32 v245, v48, v168, -v245
    v_fmac_f32 v237, v56, v120
    v_fmac_f32 v245, v49, v169
    v_fmac_f32 v237, v57, v121
    v_fmac_f32 v245, v50, v170
    v_fmac_f32 v237, v58, v122
    v_fmac_f32 v245, v51, v171
    v_fmac_f32 v237, v59, v123
    v_fmac_f32 v245, v52, v172
    v_fmac_f32 v237, v60, v124
    v_fmac_f32 v245, v53, v173
    v_fmac_f32 v237, v61, v125
    v_fmac_f32 v245, v54, v174
    v_fmac_f32 v237, v62, v126
    v_fmac_f32 v245, v55, v175
    v_fmac_f32 v237, v63, v127
    s_cmp_eq_u32 s56, 5
    s_cbranch_scc1 K2_U21
    s_cmp_eq_u32 s56, 6
    s_cbranch_scc1 K2_U3h1
    s_branch K2_DSP1
K2_FLGR:
    s_sub_u32 s27, s27, 16
    s_cbranch_scc1 K2_END
    buffer_load_dwordx4 v[56:59], v60, s[8:11], s64 offen sc1
    s_branch K2_FLGW
K2_FLGY:
    v_mov_b32 v56, s2
    v_mov_b32 v57, 7178240
    s_mov_b64 exec, 1
    buffer_store_dword v56, v57, s[8:11], 0 offen sc1
    s_mov_b64 exec, -1
    s_branch K2_FLGOK
K2_nul_93:
    s_mov_b32 s58, 63
    s_mov_b32 s36, 0
    s_branch K2_back_96
K2_spin_94:
    s_sub_u32 s27, s27, 1
    s_cbranch_scc1 K2_END
    ds_read_b32 v232, v254
    s_waitcnt lgkmcnt(0)
    s_branch K2_chk_95
K2_dyn_91:
    v_lshl_add_u32 v254, v252, 1, s53
    v_bfe_u32 v255, v252, 4, 1
    s_mov_b64 exec, 0x1ff
    ds_add_rtn_u32 v232, v254, v255
    s_mov_b64 exec, -1
    s_waitcnt lgkmcnt(0)
    v_readlane_b32 s58, v232, 8
    s_nop 0
    s_cmp_lt_u32 s58, s22
    s_cbranch_scc0 K2_nul_93
    s_nop 0
    v_readlane_b32 s3, v253, s58
    s_nop 0
    s_bfe_u32 s58, s3, 0x60016
    s_and_b32 s59, s58, 7
    s_lshr_b32 s60, s58, 3
K2_chk_95:
    v_readlane_b32 s61, v232, s59
    s_nop 0
    s_cmp_gt_u32 s61, s60
    s_cbranch_scc0 K2_spin_94
K2_back_96:
    s_mov_b32 s34, 1
    s_branch K2_back_92
K2_rare_97:
    s_cmp_eq_u32 s33, 4
    s_cbranch_scc1 K2_four_99
    s_mov_b32 s49, s48
    s_xor_b32 s45, s44, 256
    s_xor_b32 s46, s44, 512
    s_xor_b32 s47, s44, 768
    s_branch K2_back_98
K2_four_99:
    s_add_u32 s50, s48, 256
    s_mov_b32 s46, s44
    s_mov_b32 s47, s44
    s_branch K2_back_98
K2_dum_100:
    v_mov_b32 v232, -1
    s_mov_b32 m0, 163312
    s_mov_b64 exec, 1
    buffer_load_dwordx4 v232, s[16:19], 0 offen lds
    buffer_load_dwordx4 v232, s[16:19], 0 offen lds
    s_mov_b64 exec, -1
    s_branch K2_back_102
K2_a4_101:
    v_add_u32 v254, s48, v230
    ds_read_b32 v254, v254 offset:4
    s_lshr_b32 s65, s3, 28
    s_mul_i32 s66, s22, 2080
    s_lshl_b32 s65, s65, 9
    s_add_u32 s65, s65, s66
    s_add_u32 s65, s65, 65536
    s_mov_b32 m0, s65
    s_mov_b32 exec_hi, 0
    s_waitcnt lgkmcnt(0)
    v_or_b32 v254, v254, v231
    buffer_load_dwordx4 v254, s[16:19], 0 offen  lds
    s_mov_b32 exec_hi, -1
    s_branch K2_b4_103
K2_g4_104:
    s_add_u32 s51, s48, 384
    v_add_u32 v228, s51, v251
    ds_read2_b32 v[228:229], v228 offset0:1 offset1:3
    s_waitcnt lgkmcnt(0)
    v_mad_u32_u16 v228, v228, s39, v248 op_sel:[1,0,0,0]
    v_mad_u32_u16 v229, v229, s39, v248 op_sel:[1,0,0,0]
    buffer_load_dwordx4 v228, s[4:7], s47 offen sc1 lds
    buffer_load_dwordx4 v229, s[72:75], s47 offen offset:1024 sc1 lds
    s_branch K2_back_105
K2_nul_108:
    s_mov_b32 s58, 63
    s_mov_b32 s36, 0
    s_branch K2_back_111
K2_spin_109:
    s_sub_u32 s27, s27, 1
    s_cbranch_scc1 K2_END
    ds_read_b32 v232, v254
    s_waitcnt lgkmcnt(0)
    s_branch K2_chk_110
K2_dyn_106:
    v_lshl_add_u32 v254, v252, 1, s53
    v_bfe_u32 v255, v252, 4, 1
    s_mov_b64 exec, 0x1ff
    ds_add_rtn_u32 v232, v254, v255
    s_mov_b64 exec, -1
    s_waitcnt lgkmcnt(0)
    v_readlane_b32 s58, v232, 8
    s_nop 0
    s_cmp_lt_u32 s58, s22
    s_cbranch_scc0 K2_nul_108
    s_nop 0
    v_readlane_b32 s3, v253, s58
    s_nop 0
    s_bfe_u32 s58, s3, 0x60016
    s_and_b32 s59, s58, 7
    s_lshr_b32 s60, s58, 3
K2_chk_110:
    v_readlane_b32 s61, v232, s59
    s_nop 0
    s_cmp_gt_u32 s61, s60
    s_cbranch_scc0 K2_spin_109
K2_back_111:
    s_mov_b32 s34, 1
    s_branch K2_back_107
K2_rare_112:
    s_cmp_eq_u32 s33, 4
    s_cbranch_scc1 K2_four_114
    s_mov_b32 s49, s48
    s_xor_b32 s45, s44, 256
    s_xor_b32 s46, s44, 512
    s_xor_b32 s47, s44, 768
    s_branch K2_back_113
K2_four_114:
    s_add_u32 s50, s48, 256
    s_mov_b32 s46, s44
    s_mov_b32 s47, s44
    s_branch K2_back_113
K2_g4_115:
    s_add_u32 s51, s48, 384
    v_add_u32 v228, s51, v251
    ds_read2_b32 v[228:229], v228 offset0:1 offset1:3
    s_waitcnt lgkmcnt(0)
    v_mad_u32_u16 v228, v228, s39, v248 op_sel:[1,0,0,0]
    v_mad_u32_u16 v229, v229, s39, v248 op_sel:[1,0,0,0]
    buffer_load_dwordx4 v228, s[4:7], s47 offen sc1 lds
    buffer_load_dwordx4 v229, s[72:75], s47 offen offset:1024 sc1 lds
    s_branch K2_back_116
K2_dum_117:
    v_mov_b32 v232, -1
    s_mov_b32 m0, 163312
    s_mov_b64 exec, 1
    buffer_load_dwordx4 v232, s[16:19], 0 offen lds
    buffer_load_dwordx4 v232, s[16:19], 0 offen lds
    s_mov_b64 exec, -1
    s_branch K2_back_119
K2_a4_118:
    v_add_u32 v254, s48, v230
    ds_read_b32 v254, v254 offset:4
    s_lshr_b32 s65, s3, 28
    s_mul_i32 s66, s22, 2080
    s_lshl_b32 s65, s65, 9
    s_add_u32 s65, s65, s66
    s_add_u32 s65, s65, 65536
    s_mov_b32 m0, s65
    s_mov_b32 exec_hi, 0
    s_waitcnt lgkmcnt(0)
    v_or_b32 v254, v254, v231
    buffer_load_dwordx4 v254, s[16:19], 0 offen  lds
    s_mov_b32 exec_hi, -1
    s_branch K2_b4_120
K2_nul_121:
    s_mov_b32 s3, 949760
    s_mov_b32 s36, 0
    s_branch K2_back_124
K2_spin_122:
    s_sub_u32 s27, s27, 1
    s_cbranch_scc1 K2_END
    ds_read_b32 v232, v254
    s_waitcnt lgkmcnt(0)
    s_branch K2_chk_123
K2_rare_125:
    s_cmp_eq_u32 s33, 4
    s_cbranch_scc1 K2_four_127
    s_mov_b32 s49, s48
    s_xor_b32 s45, s44, 256
    s_xor_b32 s46, s44, 512
    s_xor_b32 s47, s44, 768
    s_branch K2_back_126
K2_four_127:
    s_add_u32 s50, s48, 256
    s_mov_b32 s46, s44
    s_mov_b32 s47, s44
    s_branch K2_back_126
K2_g4_128:
    s_add_u32 s51, s48, 384
    v_add_u32 v228, s51, v251
    ds_read2_b32 v[228:229], v228 offset0:1 offset1:3
    s_waitcnt lgkmcnt(0)
    v_mad_u32_u16 v228, v228, s39, v248 op_sel:[1,0,0,0]
    v_mad_u32_u16 v229, v229, s39, v248 op_sel:[1,0,0,0]
    buffer_load_dwordx4 v228, s[4:7], s47 offen sc1 lds
    buffer_load_dwordx4 v229, s[72:75], s47 offen offset:1024 sc1 lds
    s_branch K2_back_129
K2_nul_130:
    s_mov_b32 s3, 949760
    s_mov_b32 s36, 0
    s_branch K2_back_133
K2_spin_131:
    s_sub_u32 s27, s27, 1
    s_cbranch_scc1 K2_END
    ds_read_b32 v232, v254
    s_waitcnt lgkmcnt(0)
    s_branch K2_chk_132
K2_rare_134:
    s_cmp_eq_u32 s33, 4
    s_cbranch_scc1 K2_four_136
    s_mov_b32 s49, s48
    s_xor_b32 s45, s44, 256
    s_xor_b32 s46, s44, 512
    s_xor_b32 s47, s44, 768
    s_branch K2_back_135
K2_four_136:
    s_add_u32 s50, s48, 256
    s_mov_b32 s46, s44
    s_mov_b32 s47, s44
    s_branch K2_back_135
K2_g4_137:
    s_add_u32 s51, s48, 384
    v_add_u32 v228, s51, v251
    ds_read2_b32 v[228:229], v228 offset0:1 offset1:3
    s_waitcnt lgkmcnt(0)
    v_mad_u32_u16 v228, v228, s39, v248 op_sel:[1,0,0,0]
    v_mad_u32_u16 v229, v229, s39, v248 op_sel:[1,0,0,0]
    buffer_load_dwordx4 v228, s[4:7], s47 offen sc1 lds
    buffer_load_dwordx4 v229, s[72:75], s47 offen offset:1024 sc1 lds
    s_branch K2_back_138
K2_END:
    s_endpgm
.section .rodata,"a"
.p2align 6
.amdhsa_kernel standalone__tensor_product_equiv_equiformer__graph_kernel
  .amdhsa_next_free_vgpr 256
  .amdhsa_next_free_sgpr 102
  .amdhsa_accum_offset 256
  .amdhsa_group_segment_fixed_size 0
  .amdhsa_kernarg_size 96
  .amdhsa_user_sgpr_count 2
  .amdhsa_user_sgpr_kernarg_segment_ptr 1
  .amdhsa_system_sgpr_workgroup_id_x 1
  .amdhsa_float_denorm_mode_32 3
.end_amdhsa_kernel
```

```asm
; @launch grid=(256,1,1) block=(512,1,1) lds=163840
.amdgcn_target "amdgcn-amd-amdhsa--gfx950"
.text
.globl standalone__tensor_product_equiv_equiformer__graph_kernel
.p2align 8
.type standalone__tensor_product_equiv_equiformer__graph_kernel,@function
standalone__tensor_product_equiv_equiformer__graph_kernel:
    s_cmp_ge_u32 s2, 256
    s_cbranch_scc1 K2_END
    s_load_dwordx16 s[80:95], s[0:1], 0
    s_load_dwordx4 s[96:99], s[0:1], 72
    s_load_dwordx2 s[100:101], s[0:1], 88
    v_lshrrev_b32 v1, 6, v0
    s_mov_b32 s54, s2
    v_readfirstlane_b32 s20, v1
    s_mov_b64 exec, 0
    s_cmp_eq_u32 s20, 0
    s_cbranch_scc1 K2_PAD_S1
    s_cmp_eq_u32 s20, 1
    s_cbranch_scc1 K2_PAD_S2
    s_cmp_eq_u32 s20, 5
    s_cbranch_scc1 K2_PAD_H1
    s_cmp_eq_u32 s20, 6
    s_cbranch_scc1 K2_PAD_H2
    s_cmp_eq_u32 s20, 2
    s_cbranch_scc1 K2_PAD_H3
KS_HOP0:
    s_mov_b64 exec, -1
    v_and_b32 v8, 63, v0
    v_lshlrev_b32 v9, 4, v8
    v_mov_b32 v6, 0
    v_lshlrev_b32 v5, 4, v0
    v_mul_u32_u24 v4, 24, v0
    s_mul_i32 s64, s2, 5120
    s_mul_i32 s65, s2, 7680
    v_mov_b32 v176, v8
    v_mov_b32 v177, v0
    s_movk_i32 s39, 1024
    s_lshl_b32 s37, s20, 13
    s_mov_b32 s53, 163264
    s_lshl_b32 s52, s20, 2
    s_add_u32 s52, s52, s53
    s_add_u32 s68, s37, 0
    s_add_u32 s69, s37, 2048
    s_add_u32 s70, s37, 4096
    s_add_u32 s71, s37, 6144
    s_waitcnt lgkmcnt(0)
    s_mov_b32 s8, s100
    s_and_b32 s9, s101, 0xffff
    s_mov_b32 s10, 37748736
    s_mov_b32 s11, 0x20000
    s_cmp_lg_u32 s20, 7
    s_cbranch_scc1 KS_NOTAG
    s_mov_b32 s24, 7178240
    s_mov_b64 exec, 1
    buffer_load_dword v14, v6, s[8:11], s24 offen sc1
    s_mov_b64 exec, -1
    s_mov_b32 s60, s98
    s_and_b32 s61, s99, 0xffff
    s_mov_b32 s62, 256
    s_mov_b32 s63, 0x20000
    s_barrier
    v_mov_b32 v76, 0
    v_mov_b32 v77, -1
    v_lshlrev_b32 v78, 2, v8
    v_add_u32 v78, 163072, v78
    s_mov_b64 exec, 0x1ff
    ds_write_b32 v78, v76 offset:192
    s_mov_b32 exec_lo, 1
    ds_write_b32 v78, v76 offset:232
    s_mov_b32 exec_lo, -1
    ds_write_b32 v78, v77 offset:256
    s_mov_b64 exec, -1
    s_mov_b32 exec_hi, 0xffff
    ds_write_b32 v78, v76
    s_mov_b64 exec, 1
    ds_write_b32 v78, v76 offset:228
    s_mov_b64 exec, -1
    s_mov_b64 exec, 1
    buffer_load_dword v15, v6, s[60:63], 0 offen sc1
    v_mov_b32 v12, 163456
    s_mov_b32 s24, 1664525
    s_waitcnt vmcnt(1)
    v_mul_lo_u32 v59, v14, s24
    v_add_u32 v59, 1013904223, v59
    ds_write2_b32 v12, v59, v6 offset0:0 offset1:1
    s_waitcnt lgkmcnt(0)
    s_barrier
    s_waitcnt vmcnt(0)
    v_mov_b32 v62, v15
    ds_write_b32 v12, v15 offset:4
    v_cmp_ne_u32 vcc, 0, v15
    s_mov_b32 s24, 0x40000
    s_waitcnt lgkmcnt(0)
    s_barrier
    s_cbranch_vccnz KS_FLOK
KS_FLW:
    s_sub_u32 s24, s24, 1
    s_cbranch_scc1 K2_END
    buffer_load_dword v62, v6, s[60:63], 0 offen sc1
    s_waitcnt vmcnt(0)
    v_cmp_ne_u32 vcc, 0, v62
    s_nop 0
    s_cbranch_vccz KS_FLW
    ds_write_b32 v12, v62 offset:4
KS_FLOK:
    s_mov_b64 exec, -1
    s_branch KS_JOIN
KS_H0:
    s_barrier
    s_branch KS_HELP
K2_PAD_S1:
    s_branch KS_HOP0
KS_NOTAG:
    s_cmp_ge_u32 s20, 5
    s_cbranch_scc1 KS_HELP
    s_cmp_ge_u32 s2, 250
    s_cbranch_scc1 KS_IDLE
    s_mov_b32 s40, s88
    s_and_b32 s41, s89, 0xffff
    s_mov_b32 s42, 1280000
    s_mov_b32 s43, 0x20000
    buffer_load_dwordx4 v[12:15], v5, s[40:43], s64 offen
    s_mov_b32 s44, s86
    s_and_b32 s45, s87, 0xffff
    s_mov_b32 s46, 1280000
    s_mov_b32 s47, 0x20000
    s_mov_b32 s48, s82
    s_and_b32 s49, s83, 0xffff
    s_mov_b32 s50, 1920000
    s_mov_b32 s51, 0x20000
    buffer_load_dwordx4 v[16:19], v5, s[44:47], s64 offen
    buffer_load_dwordx4 v[20:23], v4, s[48:51], s65 offen
    buffer_load_dwordx2 v[24:25], v4, s[48:51], s65 offen offset:16
    v_lshlrev_b32 v2, 2, v0
    s_lshl_b32 s64, s64, 3
    v_lshl_add_u32 v3, v0, 7, s64
    v_mov_b32 v7, 1
    s_cmp_eq_u32 s20, 4
    s_cbranch_scc1 KS_NOCLR
    ds_write_b32 v2, v6
KS_NOCLR:
    s_waitcnt lgkmcnt(0)
    s_barrier
    s_mov_b64 exec, 0
    s_cmp_eq_u32 s20, 0
    s_cbranch_scc1 K2_PAD_B3
    s_cmp_eq_u32 s20, 1
    s_cbranch_scc1 K2_PAD_LD
    s_cmp_eq_u32 s20, 2
    s_cbranch_scc1 K2_PAD_NW
    s_cmp_eq_u32 s20, 3
    s_cbranch_scc1 K2_PAD_SC
    s_cmp_eq_u32 s20, 4
    s_cbranch_scc1 K2_PAD_SD
KS_HOP:
    s_mov_b64 exec, -1
    s_mov_b32 s58, 214749
    s_movk_i32 s59, 625
    s_waitcnt vmcnt(3)
    v_mul_u32_u24 v28, s58, v12
    v_and_b32 v40, 0xffffff, v28
    v_lshrrev_b32 v32, 26, v28
    v_add_u32 v40, 8187281, v40
    v_bfe_u32 v36, v28, 24, 2
    v_lshlrev_b32 v32, 2, v32
    v_lshrrev_b32 v40, 24, v40
    v_lshl_or_b32 v32, v36, 8, v32
    v_lshl_or_b32 v32, v40, 7, v32
    ds_add_rtn_u32 v36, v32, v7
    v_mul_u32_u24 v29, s58, v13
    v_and_b32 v41, 0xffffff, v29
    v_lshrrev_b32 v33, 26, v29
    v_add_u32 v41, 8187281, v41
    v_bfe_u32 v37, v29, 24, 2
    v_lshlrev_b32 v33, 2, v33
    v_lshrrev_b32 v41, 24, v41
    v_lshl_or_b32 v33, v37, 8, v33
    v_lshl_or_b32 v33, v41, 7, v33
    ds_add_rtn_u32 v37, v33, v7
    v_mul_u32_u24 v30, s58, v14
    v_and_b32 v42, 0xffffff, v30
    v_lshrrev_b32 v34, 26, v30
    v_add_u32 v42, 8187281, v42
    v_bfe_u32 v38, v30, 24, 2
    v_lshlrev_b32 v34, 2, v34
    v_lshrrev_b32 v42, 24, v42
    v_lshl_or_b32 v34, v38, 8, v34
    v_lshl_or_b32 v34, v42, 7, v34
    ds_add_rtn_u32 v38, v34, v7
    v_mul_u32_u24 v31, s58, v15
    v_and_b32 v43, 0xffffff, v31
    v_lshrrev_b32 v35, 26, v31
    v_add_u32 v43, 8187281, v43
    v_bfe_u32 v39, v31, 24, 2
    v_lshlrev_b32 v35, 2, v35
    v_lshrrev_b32 v43, 24, v43
    v_lshl_or_b32 v35, v39, 8, v35
    v_lshl_or_b32 v35, v43, 7, v35
    ds_add_rtn_u32 v39, v35, v7
    v_lshrrev_b32 v28, 24, v28
    v_mad_u32_u24 v28, v28, s59, 7
    v_lshrrev_b32 v28, 3, v28
    v_mad_u32_u24 v28, v40, 40, v28
    v_sub_u32 v28, v12, v28
    v_add_u32 v12, 0, v3
    v_lshl_or_b32 v28, v28, 26, v12
    v_lshrrev_b32 v29, 24, v29
    v_mad_u32_u24 v29, v29, s59, 7
    v_lshrrev_b32 v29, 3, v29
    v_mad_u32_u24 v29, v41, 40, v29
    v_sub_u32 v29, v13, v29
    v_add_u32 v13, 32, v3
    v_lshl_or_b32 v29, v29, 26, v13
    v_lshrrev_b32 v30, 24, v30
    v_mad_u32_u24 v30, v30, s59, 7
    v_lshrrev_b32 v30, 3, v30
    v_mad_u32_u24 v30, v42, 40, v30
    v_sub_u32 v30, v14, v30
    v_add_u32 v14, 64, v3
    v_lshl_or_b32 v30, v30, 26, v14
    v_lshrrev_b32 v31, 24, v31
    v_mad_u32_u24 v31, v31, s59, 7
    v_lshrrev_b32 v31, 3, v31
    v_mad_u32_u24 v31, v43, 40, v31
    v_sub_u32 v31, v15, v31
    v_add_u32 v15, 96, v3
    v_lshl_or_b32 v31, v31, 26, v15
K2_PAD_S2:
    s_cbranch_execz KS_HOP0
    v_mov_b32 v59, 163456
    s_mul_i32 s65, s2, 1152
    s_add_u32 s65, s65, 6291456
    s_mul_i32 s64, s2, 20608
    s_waitcnt lgkmcnt(0)
    s_barrier
    ds_read_b128 v[40:43], v9
    ds_read_b32 v59, v59
    s_waitcnt lgkmcnt(1)
    v_add_u32 v45, v40, v41
    v_add_u32 v46, v45, v42
    v_add_u32 v47, v46, v43
    v_mov_b32 v58, v47
    s_nop 1
    v_add_u32_dpp v58, v58, v58 row_shr:1 row_mask:0xf bank_mask:0xf bound_ctrl:0
    s_nop 1
    v_add_u32_dpp v58, v58, v58 row_shr:2 row_mask:0xf bank_mask:0xf bound_ctrl:0
    s_nop 1
    v_add_u32_dpp v58, v58, v58 row_shr:4 row_mask:0xf bank_mask:0xf bound_ctrl:0
    s_nop 1
    v_add_u32_dpp v58, v58, v58 row_shr:8 row_mask:0xf bank_mask:0xf bound_ctrl:0
    s_nop 1
    v_add_u32_dpp v58, v58, v58 row_bcast:15 row_mask:0xa bank_mask:0xf
    s_nop 1
    v_add_u32_dpp v58, v58, v58 row_bcast:31 row_mask:0xc bank_mask:0xf
    v_sub_u32 v48, v58, v47
    v_add_u32 v49, v48, v40
    v_add_u32 v50, v48, v45
    v_add_u32 v51, v48, v46
    ds_write_b128 v9, v[48:51] offset:1024
    s_waitcnt lgkmcnt(1)
    s_cmp_lg_u32 s20, 4
    s_cbranch_scc1 KS_NOPUB
    v_lshl_or_b32 v56, v49, 11, v48
    v_lshl_or_b32 v57, v51, 11, v50
    v_lshl_or_b32 v56, v59, 22, v56
    v_lshl_or_b32 v57, v59, 22, v57
    buffer_store_dwordx4 v[56:59], v9, s[8:11], s65 offen sc1
KS_NOPUB:
    s_waitcnt lgkmcnt(0)
    ds_read_b32 v32, v32 offset:1024
    ds_read_b32 v33, v33 offset:1024
    ds_read_b32 v34, v34 offset:1024
    ds_read_b32 v35, v35 offset:1024
    s_cbranch_scc1 KS_PUB0
    s_waitcnt vmcnt(1)
    s_branch KS_PUB1
KS_PUB0:
    s_waitcnt vmcnt(0)
KS_PUB1:
    v_and_b32 v60, 0xffff, v59
    v_and_b32 v61, 0xffff0000, v59
    s_mov_b32 s58, 0xffff0000
    v_mov_b32 v40, v20
    v_lshl_or_b32 v41, v21, 16, v60
    v_or_b32 v42, v61, v16
    v_mov_b32 v43, v28
    v_alignbit_b32 v44, v22, v21, 16
    v_and_or_b32 v45, v22, s58, v60
    v_or_b32 v46, v61, v17
    v_mov_b32 v47, v29
    v_mov_b32 v48, v23
    v_lshl_or_b32 v49, v24, 16, v60
    v_or_b32 v50, v61, v18
    v_mov_b32 v51, v30
    v_alignbit_b32 v52, v25, v24, 16
    v_and_or_b32 v53, v25, s58, v60
    v_or_b32 v54, v61, v19
    v_mov_b32 v55, v31
    s_waitcnt lgkmcnt(0)
    v_add_lshl_u32 v32, v32, v36, 4
    ds_write_b128 v32, v[40:43] offset:2048
    v_add_lshl_u32 v33, v33, v37, 4
    ds_write_b128 v33, v[44:47] offset:2048
    v_add_lshl_u32 v34, v34, v38, 4
    ds_write_b128 v34, v[48:51] offset:2048
    v_add_lshl_u32 v35, v35, v39, 4
    ds_write_b128 v35, v[52:55] offset:2048
    v_mov_b32 v62, 163460
    s_waitcnt lgkmcnt(0)
    s_barrier
    ds_read_b32 v62, v62
    ds_read_b128 v[12:15], v5 offset:2048
    ds_read_b128 v[16:19], v5 offset:7168
    ds_read_b128 v[20:23], v5 offset:12288
    ds_read_b128 v[24:27], v5 offset:17408
    s_waitcnt lgkmcnt(3)
    buffer_store_dwordx4 v[12:15], v5, s[8:11], s64 offen sc1
    s_add_u32 s64, s64, 5120
    s_waitcnt lgkmcnt(2)
    buffer_store_dwordx4 v[16:19], v5, s[8:11], s64 offen sc1
    s_add_u32 s64, s64, 5120
    s_waitcnt lgkmcnt(1)
    buffer_store_dwordx4 v[20:23], v5, s[8:11], s64 offen sc1
    s_add_u32 s64, s64, 5120
    s_waitcnt lgkmcnt(0)
    buffer_store_dwordx4 v[24:27], v5, s[8:11], s64 offen sc1
    s_branch KS_JOIN
K2_PAD_B3:
    s_branch KS_HOP
KS_B3:
    v_mov_b32 v59, 163456
    ds_read_b32 v59, v59
    v_mov_b32 v62, 163460
    s_waitcnt lgkmcnt(0)
    s_barrier
    ds_read_b32 v62, v62
KS_JOIN:
    v_readfirstlane_b32 s2, v59
    s_mov_b32 s25, 0x400000
KS_JOIN2:
    s_waitcnt lgkmcnt(0)
    v_readfirstlane_b32 s24, v62
    s_nop 0
    s_cmp_eq_u32 s24, 0
    s_cbranch_scc1 KS_FLS
    s_bfe_u32 s24, s24, 0x10001
    s_xor_b32 s54, s54, s24
    s_lshr_b32 s21, s54, 1
    s_mul_i32 s21, s21, 625
    s_add_u32 s22, s21, 632
    s_add_u32 s21, s21, 7
    s_lshr_b32 s21, s21, 3
    s_lshr_b32 s22, s22, 3
    s_add_u32 s24, s21, 40
    s_sub_u32 s22, s22, s24
    s_bitcmp1_b32 s54, 0
    s_cselect_b32 s21, s24, s21
    s_cselect_b32 s22, s22, 40
    s_mov_b32 s23, 0
    s_mov_b32 s28, 1
    s_mov_b32 s24, 0
    s_mov_b32 s25, 1
K2_CELLS:
    v_lshrrev_b32 v178, 1, v177
    v_min_u32 v178, 249, v178
    v_mul_u32_u24 v72, 1152, v178
    s_and_b32 s58, s54, 7
    s_lshl_b32 s58, s58, 7
    s_lshr_b32 s59, s54, 5
    s_lshl_b32 s59, s59, 4
    s_add_u32 s67, s58, s59
    s_add_u32 s67, s67, 6291456
    s_cmp_eq_u32 s28, 0
    s_cbranch_scc1 K2_NOSRD
    s_mov_b32 s4, s80
    s_and_b32 s5, s81, 0xffff
    s_mov_b32 s6, 10240000
    s_mov_b32 s7, 0x20000
    s_mov_b32 s12, s96
    s_and_b32 s13, s97, 0xffff
    s_mov_b32 s14, 10240000
    s_mov_b32 s15, 0x20000
    s_mov_b32 s16, s84
    s_and_b32 s17, s85, 0xffff
    s_mov_b32 s18, 10240000
    s_mov_b32 s19, 0x20000
    s_sub_u32 s80, s80, 1024
    s_subb_u32 s81, s81, 0
    s_mov_b32 s72, s80
    s_and_b32 s73, s81, 0xffff
    s_mov_b32 s74, 10241024
    s_mov_b32 s75, 0x20000
K2_NOSRD:
    v_and_b32 v84, 15, v176
    v_lshrrev_b32 v85, 5, v176
    v_bfe_u32 v86, v176, 4, 1
    v_lshrrev_b32 v87, 2, v84
    v_and_b32 v88, 3, v84
    v_lshl_add_u32 v89, v85, 2, v87
    v_lshlrev_b32 v249, 6, v89
    v_lshl_add_u32 v249, v88, 3, v249
    v_add_u32 v249, 512, v249
    v_lshrrev_b32 v90, 3, v84
    v_lshl_add_u32 v90, v90, 1, v86
    v_sub_u32 v90, v90, 1 clamp
    v_lshlrev_b32 v250, 1, v90
    v_lshl_add_u32 v91, v85, 2, v88
    v_lshl_add_u32 v250, v91, 4, v250
    v_and_b32 v91, 1, v87
    v_lshl_add_u32 v250, v91, 3, v250
    v_lshrrev_b32 v90, 1, v88
    v_lshl_add_u32 v90, v86, 1, v90
    v_bfe_u32 v91, v87, 1, 1
    v_lshlrev_b32 v91, 2, v91
    v_xor_b32 v90, v90, v91
    v_lshlrev_b32 v90, 4, v90
    v_lshl_add_u32 v90, v89, 7, v90
    v_and_b32 v91, 1, v88
    v_lshl_add_u32 v90, v91, 3, v90
    v_add_u32 v246, s37, v90
    v_xor_b32 v247, 64, v246
    v_lshrrev_b32 v90, 3, v176
    v_lshlrev_b32 v251, 4, v90
    v_bfe_u32 v90, v90, 1, 1
    v_lshlrev_b32 v90, 2, v90
    v_and_b32 v91, 7, v176
    v_xor_b32 v90, v90, v91
    v_lshlrev_b32 v248, 4, v90
    v_lshlrev_b32 v252, 1, v176
    v_mov_b32 v228, -1
    v_mov_b32 v229, -1
    v_and_b32 v231, 1, v176
    v_lshlrev_b32 v231, 4, v231
    v_lshrrev_b32 v90, 1, v176
    v_lshlrev_b32 v90, 5, v90
    v_add_u32 v230, 512, v90
    s_cmp_eq_u32 s28, 0
    s_cbranch_scc1 K2_NOW0
    v_lshrrev_b32 v60, 6, v252
    v_bfe_u32 v61, v252, 3, 2
    v_lshl_add_u32 v60, v60, 2, v61
    v_mul_u32_u24 v60, 640, v60
    v_bfe_u32 v61, v252, 5, 1
    v_lshl_add_u32 v60, v61, 5, v60
    v_and_b32 v61, 6, v252
    v_lshl_add_u32 v60, v61, 2, v60
    v_add_u32 v60, 24576, v60
    ds_read_b64_tr_b16 v[136:137], v60 offset:0
    ds_read_b64_tr_b16 v[138:139], v60 offset:5120
    ds_read_b64_tr_b16 v[140:141], v60 offset:64
    ds_read_b64_tr_b16 v[142:143], v60 offset:5184
    ds_read_b64_tr_b16 v[144:145], v60 offset:128
    ds_read_b64_tr_b16 v[146:147], v60 offset:5248
    ds_read_b64_tr_b16 v[148:149], v60 offset:192
    ds_read_b64_tr_b16 v[150:151], v60 offset:5312
    ds_read_b64_tr_b16 v[152:153], v60 offset:256
    ds_read_b64_tr_b16 v[154:155], v60 offset:5376
    ds_read_b64_tr_b16 v[156:157], v60 offset:320
    ds_read_b64_tr_b16 v[158:159], v60 offset:5440
    ds_read_b64_tr_b16 v[160:161], v60 offset:384
    ds_read_b64_tr_b16 v[162:163], v60 offset:5504
    ds_read_b64_tr_b16 v[164:165], v60 offset:448
    ds_read_b64_tr_b16 v[166:167], v60 offset:5568
    ds_read_b64_tr_b16 v[168:169], v60 offset:512
    ds_read_b64_tr_b16 v[170:171], v60 offset:5632
    ds_read_b64_tr_b16 v[172:173], v60 offset:576
    ds_read_b64_tr_b16 v[174:175], v60 offset:5696
    s_waitcnt lgkmcnt(0)
    v_lshlrev_b32 v96, 16, v136
    v_and_b32 v97, 0xffff0000, v136
    v_lshlrev_b32 v98, 16, v137
    v_and_b32 v99, 0xffff0000, v137
    v_lshlrev_b32 v100, 16, v138
    v_and_b32 v101, 0xffff0000, v138
    v_lshlrev_b32 v102, 16, v139
    v_and_b32 v103, 0xffff0000, v139
    v_lshlrev_b32 v104, 16, v140
    v_and_b32 v105, 0xffff0000, v140
    v_lshlrev_b32 v106, 16, v141
    v_and_b32 v107, 0xffff0000, v141
    v_lshlrev_b32 v108, 16, v142
    v_and_b32 v109, 0xffff0000, v142
    v_lshlrev_b32 v110, 16, v143
    v_and_b32 v111, 0xffff0000, v143
    v_lshlrev_b32 v112, 16, v144
    v_and_b32 v113, 0xffff0000, v144
    v_lshlrev_b32 v114, 16, v145
    v_and_b32 v115, 0xffff0000, v145
    v_lshlrev_b32 v116, 16, v146
    v_and_b32 v117, 0xffff0000, v146
    v_lshlrev_b32 v118, 16, v147
    v_and_b32 v119, 0xffff0000, v147
    v_lshlrev_b32 v120, 16, v148
    v_and_b32 v121, 0xffff0000, v148
    v_lshlrev_b32 v122, 16, v149
    v_and_b32 v123, 0xffff0000, v149
    v_lshlrev_b32 v124, 16, v150
    v_and_b32 v125, 0xffff0000, v150
    v_lshlrev_b32 v126, 16, v151
    v_and_b32 v127, 0xffff0000, v151
    buffer_load_dwordx4 v[76:79], v72, s[8:11], s67 offen sc1
    s_mov_b64 exec, 0
    s_cmp_eq_u32 s20, 0
    s_cbranch_scc1 K2_PAD_U20
    s_cmp_eq_u32 s20, 1
    s_cbranch_scc1 K2_PAD_U30
    s_cmp_eq_u32 s20, 2
    s_cbranch_scc1 K2_PAD_U21
    s_cmp_eq_u32 s20, 3
    s_cbranch_scc1 K2_PAD_U31
    s_cmp_eq_u32 s20, 7
    s_cbranch_scc1 K2_PAD_SW
    s_cmp_eq_u32 s20, 5
    s_cbranch_scc1 K2_PAD_TL
    s_cmp_eq_u32 s20, 6
    s_cbranch_scc1 K2_PAD_T2
K2_HOP:
    s_mov_b64 exec, -1
    v_lshlrev_b32 v128, 16, v152
    v_and_b32 v129, 0xffff0000, v152
    v_lshlrev_b32 v130, 16, v153
    v_and_b32 v131, 0xffff0000, v153
    v_lshlrev_b32 v132, 16, v154
    v_and_b32 v133, 0xffff0000, v154
    v_lshlrev_b32 v134, 16, v155
    v_and_b32 v135, 0xffff0000, v155
    v_lshlrev_b32 v136, 16, v156
    v_and_b32 v137, 0xffff0000, v156
    v_lshlrev_b32 v138, 16, v157
    v_and_b32 v139, 0xffff0000, v157
    v_lshlrev_b32 v140, 16, v158
    v_and_b32 v141, 0xffff0000, v158
    v_lshlrev_b32 v142, 16, v159
    v_and_b32 v143, 0xffff0000, v159
    v_lshlrev_b32 v144, 16, v160
    v_and_b32 v145, 0xffff0000, v160
    v_lshlrev_b32 v146, 16, v161
    v_and_b32 v147, 0xffff0000, v161
    v_lshlrev_b32 v148, 16, v162
    v_and_b32 v149, 0xffff0000, v162
    v_lshlrev_b32 v150, 16, v163
    v_and_b32 v151, 0xffff0000, v163
    v_lshlrev_b32 v152, 16, v164
    v_and_b32 v153, 0xffff0000, v164
    v_lshlrev_b32 v154, 16, v165
    v_and_b32 v155, 0xffff0000, v165
    v_lshlrev_b32 v156, 16, v166
    v_and_b32 v157, 0xffff0000, v166
    v_lshlrev_b32 v158, 16, v167
    v_and_b32 v159, 0xffff0000, v167
    v_lshlrev_b32 v160, 16, v168
    v_and_b32 v161, 0xffff0000, v168
    v_lshlrev_b32 v162, 16, v169
    v_and_b32 v163, 0xffff0000, v169
    v_lshlrev_b32 v164, 16, v170
    v_and_b32 v165, 0xffff0000, v170
    v_lshlrev_b32 v166, 16, v171
    v_and_b32 v167, 0xffff0000, v171
    v_lshlrev_b32 v168, 16, v172
    v_and_b32 v169, 0xffff0000, v172
    v_lshlrev_b32 v170, 16, v173
    v_and_b32 v171, 0xffff0000, v173
    v_lshlrev_b32 v172, 16, v174
    v_and_b32 v173, 0xffff0000, v174
    v_lshlrev_b32 v174, 16, v175
    v_and_b32 v175, 0xffff0000, v175
K2_W0:
    s_lshl_b32 s59, s2, 22
    s_mov_b32 s60, 0x40000
    s_bfe_u32 s61, s54, 0x10004
    s_bfe_u32 s62, s54, 0x10003
    s_add_u32 s63, s61, s62
    s_mul_i32 s62, s62, 11
    s_sub_u32 s64, 11, s62
    v_cmp_gt_u32 vcc, 500, v177
    s_nop 0
    s_mov_b64 s[56:57], vcc
K2_POLL:
    s_waitcnt vmcnt(0)
    v_xor_b32 v73, s59, v76
    v_xor_b32 v74, s59, v77
    v_or_b32 v73, v73, v74
    v_xor_b32 v74, s2, v79
    v_lshrrev_b32 v73, 22, v73
    v_or_b32 v73, v73, v74
    v_cmp_ne_u32 vcc, 0, v73
    s_nop 0
    s_cbranch_vccz K2_POLLED
    s_sub_u32 s60, s60, 1
    s_cbranch_scc1 K2_END
    s_mov_b64 exec, vcc
    buffer_load_dwordx4 v[76:79], v72, s[8:11], s67 offen sc1
    s_mov_b64 exec, -1
    s_branch K2_POLL
K2_PAD_LD:
    s_branch KS_HOP
K2_POLLED:
    s_set_gpr_idx_on s61, gpr_idx(SRC0)
    s_nop 0
    v_bfe_u32 v179, v76, s62, 11
    s_set_gpr_idx_idx s63
    s_nop 0
    v_bfe_u32 v73, v76, s64, 11
    s_set_gpr_idx_off
    v_sub_u32 v73, v73, v179
    v_cndmask_b32 v73, 0, v73, s[56:57]
    v_and_b32 v1, 1, v177
    v_add_u32 v1, s23, v1
    v_sub_u32 v180, v73, v1
    v_add_u32 v179, v179, v1
    v_mul_u32_u24 v181, 20608, v178
    v_lshl_add_u32 v181, v179, 4, v181
    v_cmp_lt_i32 s[40:41], 0, v180
    v_add_u32 v182, 32, v181
    s_mov_b32 s65, 0
    s_mov_b64 exec, s[40:41]
    buffer_load_dwordx4 v[0:3], v181, s[8:11], 0 offen offset:0 sc1
    s_mov_b64 exec, -1
    v_cmp_lt_i32 s[42:43], 2, v180
    v_cmp_lt_i32 s[44:45], 4, v180
    v_cmp_lt_i32 s[46:47], 6, v180
    v_cmp_lt_i32 s[48:49], 8, v180
    v_cmp_lt_i32 s[50:51], 10, v180
    v_cmp_lt_i32 s[90:91], 12, v180
    v_cmp_lt_i32 s[92:93], 14, v180
    v_cmp_lt_i32 s[94:95], 16, v180
    v_cmp_lt_i32 s[96:97], 18, v180
    v_add_u32 v183, 64, v181
    v_add_u32 v184, 96, v181
    v_subrev_u32 v62, 1, v180
    v_ashrrev_i32 v62, 1, v62
    v_med3_i32 v62, v62, 0, 9
    s_cmp_eq_u64 s[42:43], 0
    s_cbranch_scc1 K2_LD_DONE
    v_mov_b32 v63, v62
    s_nop 1
    v_add_u32_dpp v63, v63, v63 row_shr:1 row_mask:0xf bank_mask:0xf bound_ctrl:0
    s_nop 1
    v_add_u32_dpp v63, v63, v63 row_shr:2 row_mask:0xf bank_mask:0xf bound_ctrl:0
    s_nop 1
    v_add_u32_dpp v63, v63, v63 row_shr:4 row_mask:0xf bank_mask:0xf bound_ctrl:0
    s_nop 1
    v_add_u32_dpp v63, v63, v63 row_shr:8 row_mask:0xf bank_mask:0xf bound_ctrl:0
    s_nop 1
    v_add_u32_dpp v63, v63, v63 row_bcast:15 row_mask:0xa bank_mask:0xf
    s_nop 1
    v_add_u32_dpp v63, v63, v63 row_bcast:31 row_mask:0xc bank_mask:0xf
    s_lshl_b32 s58, s20, 10
    s_add_u32 s58, s58, 45056
    v_readlane_b32 s59, v63, 63
    v_sub_u32 v63, v63, v62
    v_lshl_add_u32 v64, v63, 2, s58
    v_lshlrev_b32 v63, 5, v63
    v_sub_u32 v63, v182, v63
    s_cmp_gt_u32 s59, 189
    s_cbranch_scc1 K2_LD_GEN
    s_mov_b64 exec, s[42:43]
    s_cbranch_execz K2_LD_L
    ds_write_b32 v64, v63 offset:0
    s_mov_b64 exec, s[44:45]
    s_cbranch_execz K2_LD_L
    ds_write_b32 v64, v63 offset:4
    s_mov_b64 exec, s[46:47]
    s_cbranch_execz K2_LD_L
    ds_write_b32 v64, v63 offset:8
    s_mov_b64 exec, s[48:49]
    s_cbranch_execz K2_LD_L
    ds_write_b32 v64, v63 offset:12
    s_mov_b64 exec, s[50:51]
    s_cbranch_execz K2_LD_L
    ds_write_b32 v64, v63 offset:16
    s_mov_b64 exec, s[90:91]
    s_cbranch_execz K2_LD_L
    ds_write_b32 v64, v63 offset:20
    s_mov_b64 exec, s[92:93]
    s_cbranch_execz K2_LD_L
    ds_write_b32 v64, v63 offset:24
    s_mov_b64 exec, s[94:95]
    s_cbranch_execz K2_LD_L
    ds_write_b32 v64, v63 offset:28
    s_mov_b64 exec, s[96:97]
    s_cbranch_execz K2_LD_L
    ds_write_b32 v64, v63 offset:32
K2_LD_L:
    s_mov_b64 exec, -1
    v_lshl_add_u32 v63, v176, 2, s58
    v_lshlrev_b32 v62, 5, v176
    s_waitcnt lgkmcnt(0)
    ds_read_b32 v64, v63 offset:0
    ds_read_b32 v65, v63 offset:252
    ds_read_b32 v66, v63 offset:504
    s_min_u32 s60, s59, 63
    s_sub_u32 s59, s59, s60
    s_bfm_b64 s[42:43], s60, 0
    s_min_u32 s60, s59, 63
    s_sub_u32 s59, s59, s60
    s_bfm_b64 s[44:45], s60, 0
    s_min_u32 s60, s59, 63
    s_sub_u32 s59, s59, s60
    s_bfm_b64 s[46:47], s60, 0
    s_mov_b64 s[48:49], 0
    s_mov_b32 s65, 1
    s_mov_b32 s60, 0
    s_waitcnt lgkmcnt(2)
    v_add3_u32 v182, v62, v64, s60
    s_mov_b64 exec, s[42:43]
    buffer_load_dwordx4 v[4:7], v182, s[8:11], 0 offen sc1
    s_mov_b32 s60, 2016
    s_waitcnt lgkmcnt(1)
    v_add3_u32 v183, v62, v65, s60
    s_mov_b64 exec, s[44:45]
    buffer_load_dwordx4 v[8:11], v183, s[8:11], 0 offen sc1
    s_mov_b32 s60, 4032
    s_waitcnt lgkmcnt(0)
    v_add3_u32 v184, v62, v66, s60
    s_mov_b64 exec, s[46:47]
    buffer_load_dwordx4 v[12:15], v184, s[8:11], 0 offen sc1
K2_LD_DONE:
    s_mov_b64 exec, -1
    s_cmp_eq_u32 s28, 0
    s_cbranch_scc1 K2_WLATE
K2_NOWRAW:
K2_PAD_NW:
    s_cbranch_execz KS_HOP
    v_lshrrev_b32 v179, 2, v181
    v_lshrrev_b32 v185, 2, v182
    v_lshrrev_b32 v186, 2, v183
    v_lshrrev_b32 v187, 2, v184
    s_mov_b32 s66, 7340032
    v_mov_b32 v201, 1
    s_movk_i32 s58, 520
    s_movk_i32 s59, 2080
    s_mov_b32 s60, 0x40000
    s_mov_b32 s61, 0xffff
    v_mov_b32 v202, 65536
    s_cmp_lg_u32 s24, 0
    s_cbranch_scc1 K2_RK_LOAD
    v_cmp_lt_i32 vcc, 20, v180
    s_nop 0
    s_cbranch_vccz K2_NOMORE
    v_mov_b32 v61, 163300
    ds_write_b32 v61, v201
K2_NOMORE:
    s_mov_b32 s62, 82176
    s_cmp_eq_u32 s65, 0
    s_waitcnt vmcnt(3)
    s_cbranch_scc0 K2_ARR
    s_waitcnt vmcnt(0)
K2_ARR:
    s_mov_b64 exec, s[40:41]
    s_cbranch_execz K2_RK_A
K2_CK0:
    v_bfi_b32 v192, s61, v1, v2
    v_lshrrev_b32 v50, 24, v3
    v_cmp_ne_u32 vcc, s2, v192
    v_add_u32 v40, 163072, v50
    s_cbranch_vccnz K2_RT0
    ds_add_rtn_u32 v40, v40, v201
    v_mad_u32_u24 v50, v50, s58, v202
    s_mov_b64 exec, s[42:43]
    s_cbranch_execz K2_RK_A
    s_waitcnt vmcnt(2)
K2_CK1:
    v_bfi_b32 v192, s61, v5, v6
    v_lshrrev_b32 v51, 24, v7
    v_cmp_ne_u32 vcc, s2, v192
    v_add_u32 v41, 163072, v51
    s_cbranch_vccnz K2_RT1
    ds_add_rtn_u32 v41, v41, v201
    v_mad_u32_u24 v51, v51, s58, v202
    s_mov_b64 exec, s[44:45]
    s_cbranch_execz K2_RK_A
    s_waitcnt vmcnt(1)
K2_CK2:
    v_bfi_b32 v192, s61, v9, v10
    v_lshrrev_b32 v52, 24, v11
    v_cmp_ne_u32 vcc, s2, v192
    v_add_u32 v42, 163072, v52
    s_cbranch_vccnz K2_RT2
    ds_add_rtn_u32 v42, v42, v201
    v_mad_u32_u24 v52, v52, s58, v202
    s_mov_b64 exec, s[46:47]
    s_cbranch_execz K2_RK_A
    s_waitcnt vmcnt(0)
K2_CK3:
    v_bfi_b32 v192, s61, v13, v14
    v_lshrrev_b32 v53, 24, v15
    v_cmp_ne_u32 vcc, s2, v192
    v_add_u32 v43, 163072, v53
    s_cbranch_vccnz K2_RT3
    ds_add_rtn_u32 v43, v43, v201
    v_mad_u32_u24 v53, v53, s58, v202
    s_mov_b64 exec, s[48:49]
    s_cbranch_execz K2_RK_A
K2_CK4:
    v_bfi_b32 v192, s61, v17, v18
    v_lshrrev_b32 v54, 24, v19
    v_cmp_ne_u32 vcc, s2, v192
    v_add_u32 v44, 163072, v54
    s_cbranch_vccnz K2_RT4
    ds_add_rtn_u32 v44, v44, v201
    v_mad_u32_u24 v54, v54, s58, v202
    s_mov_b64 exec, s[50:51]
    s_cbranch_execz K2_RK_A
K2_CK5:
    v_bfi_b32 v192, s61, v21, v22
    v_lshrrev_b32 v55, 24, v23
    v_cmp_ne_u32 vcc, s2, v192
    v_add_u32 v45, 163072, v55
    s_cbranch_vccnz K2_RT5
    ds_add_rtn_u32 v45, v45, v201
    v_mad_u32_u24 v55, v55, s58, v202
    s_mov_b64 exec, s[90:91]
    s_cbranch_execz K2_RK_A
K2_CK6:
    v_bfi_b32 v192, s61, v25, v26
    v_lshrrev_b32 v56, 24, v27
    v_cmp_ne_u32 vcc, s2, v192
    v_add_u32 v46, 163072, v56
    s_cbranch_vccnz K2_RT6
    ds_add_rtn_u32 v46, v46, v201
    v_mad_u32_u24 v56, v56, s58, v202
    s_mov_b64 exec, s[92:93]
    s_cbranch_execz K2_RK_A
K2_CK7:
    v_bfi_b32 v192, s61, v29, v30
    v_lshrrev_b32 v57, 24, v31
    v_cmp_ne_u32 vcc, s2, v192
    v_add_u32 v47, 163072, v57
    s_cbranch_vccnz K2_RT7
    ds_add_rtn_u32 v47, v47, v201
    v_mad_u32_u24 v57, v57, s58, v202
    s_mov_b64 exec, s[94:95]
    s_cbranch_execz K2_RK_A
K2_CK8:
    v_bfi_b32 v192, s61, v33, v34
    v_lshrrev_b32 v58, 24, v35
    v_cmp_ne_u32 vcc, s2, v192
    v_add_u32 v48, 163072, v58
    s_cbranch_vccnz K2_RT8
    ds_add_rtn_u32 v48, v48, v201
    v_mad_u32_u24 v58, v58, s58, v202
    s_mov_b64 exec, s[96:97]
    s_cbranch_execz K2_RK_A
K2_CK9:
    v_bfi_b32 v192, s61, v37, v38
    v_lshrrev_b32 v59, 24, v39
    v_cmp_ne_u32 vcc, s2, v192
    v_add_u32 v49, 163072, v59
    s_cbranch_vccnz K2_RT9
    ds_add_rtn_u32 v49, v49, v201
    v_mad_u32_u24 v59, v59, s58, v202
K2_RK_A:
    s_mov_b64 exec, -1
    s_mov_b64 exec, s[40:41]
    s_cbranch_execz K2_TP
    v_cmp_gt_u32 vcc, s62, v50
    v_and_b32 v3, 0xffffff, v3
    s_mov_b64 exec, vcc
    buffer_load_dword v245, v3, s[16:19], 0 offen
    s_mov_b64 exec, s[42:43]
    s_cbranch_execz K2_TP
    v_cmp_gt_u32 vcc, s62, v51
    v_and_b32 v7, 0xffffff, v7
    s_mov_b64 exec, vcc
    buffer_load_dword v245, v7, s[16:19], 0 offen
    s_mov_b64 exec, s[44:45]
    s_cbranch_execz K2_TP
    v_cmp_gt_u32 vcc, s62, v52
    v_and_b32 v11, 0xffffff, v11
    s_mov_b64 exec, vcc
    buffer_load_dword v245, v11, s[16:19], 0 offen
    s_mov_b64 exec, s[46:47]
    s_cbranch_execz K2_TP
    v_cmp_gt_u32 vcc, s62, v53
    v_and_b32 v15, 0xffffff, v15
    s_mov_b64 exec, vcc
    buffer_load_dword v245, v15, s[16:19], 0 offen
    s_mov_b64 exec, s[48:49]
    s_cbranch_execz K2_TP
    v_cmp_gt_u32 vcc, s62, v54
    v_and_b32 v19, 0xffffff, v19
    s_mov_b64 exec, vcc
    buffer_load_dword v245, v19, s[16:19], 0 offen
    s_mov_b64 exec, s[50:51]
    s_cbranch_execz K2_TP
    v_cmp_gt_u32 vcc, s62, v55
    v_and_b32 v23, 0xffffff, v23
    s_mov_b64 exec, vcc
    buffer_load_dword v245, v23, s[16:19], 0 offen
    s_mov_b64 exec, s[90:91]
    s_cbranch_execz K2_TP
    v_cmp_gt_u32 vcc, s62, v56
    v_and_b32 v27, 0xffffff, v27
    s_mov_b64 exec, vcc
    buffer_load_dword v245, v27, s[16:19], 0 offen
    s_mov_b64 exec, s[92:93]
    s_cbranch_execz K2_TP
    v_cmp_gt_u32 vcc, s62, v57
    v_and_b32 v31, 0xffffff, v31
    s_mov_b64 exec, vcc
    buffer_load_dword v245, v31, s[16:19], 0 offen
    s_mov_b64 exec, s[94:95]
    s_cbranch_execz K2_TP
    v_cmp_gt_u32 vcc, s62, v58
    v_and_b32 v35, 0xffffff, v35
    s_mov_b64 exec, vcc
    buffer_load_dword v245, v35, s[16:19], 0 offen
    s_mov_b64 exec, s[96:97]
    s_cbranch_execz K2_TP
    v_cmp_gt_u32 vcc, s62, v59
    v_and_b32 v39, 0xffffff, v39
    s_mov_b64 exec, vcc
    buffer_load_dword v245, v39, s[16:19], 0 offen
K2_TP:
    s_mov_b64 exec, -1
K2_RK_DONE:
K2_PAD_SC:
    s_cbranch_execz KS_HOP
    s_mul_i32 s67, s24, 48
    s_movk_i32 s58, -1532
    s_waitcnt lgkmcnt(0)
    s_mov_b64 exec, s[40:41]
    s_cbranch_execz K2_SC_DONE
    v_cmpx_gt_u32 vcc, 64, v40
    v_bfe_u32 v194, v40, 3, 1
    v_add_u32 v193, 16, v40
    v_lshl_or_b32 v194, v40, 1, v194
    v_bfi_b32 v194, 15, v194, v40
    v_lshrrev_b32 v193, 6, v193
    v_alignbit_b32 v1, v2, v1, 16
    v_lshl_add_u32 v195, v194, 3, v50
    v_lshl_add_u32 v194, v194, 5, v50
    ds_write_b64 v195, v[0:1]
    v_mad_i32_i24 v194, v193, s58, v194
    ds_write_b32 v194, v3 offset:512
    s_mov_b64 exec, s[42:43]
    s_cbranch_execz K2_SC_DONE
    v_cmpx_gt_u32 vcc, 64, v41
    v_bfe_u32 v194, v41, 3, 1
    v_add_u32 v193, 16, v41
    v_lshl_or_b32 v194, v41, 1, v194
    v_bfi_b32 v194, 15, v194, v41
    v_lshrrev_b32 v193, 6, v193
    v_alignbit_b32 v5, v6, v5, 16
    v_lshl_add_u32 v195, v194, 3, v51
    v_lshl_add_u32 v194, v194, 5, v51
    ds_write_b64 v195, v[4:5]
    v_mad_i32_i24 v194, v193, s58, v194
    ds_write_b32 v194, v7 offset:512
    s_mov_b64 exec, s[44:45]
    s_cbranch_execz K2_SC_DONE
    v_cmpx_gt_u32 vcc, 64, v42
    v_bfe_u32 v194, v42, 3, 1
    v_add_u32 v193, 16, v42
    v_lshl_or_b32 v194, v42, 1, v194
    v_bfi_b32 v194, 15, v194, v42
    v_lshrrev_b32 v193, 6, v193
    v_alignbit_b32 v9, v10, v9, 16
    v_lshl_add_u32 v195, v194, 3, v52
    v_lshl_add_u32 v194, v194, 5, v52
    ds_write_b64 v195, v[8:9]
    v_mad_i32_i24 v194, v193, s58, v194
    ds_write_b32 v194, v11 offset:512
    s_mov_b64 exec, s[46:47]
    s_cbranch_execz K2_SC_DONE
    v_cmpx_gt_u32 vcc, 64, v43
    v_bfe_u32 v194, v43, 3, 1
    v_add_u32 v193, 16, v43
    v_lshl_or_b32 v194, v43, 1, v194
    v_bfi_b32 v194, 15, v194, v43
    v_lshrrev_b32 v193, 6, v193
    v_alignbit_b32 v13, v14, v13, 16
    v_lshl_add_u32 v195, v194, 3, v53
    v_lshl_add_u32 v194, v194, 5, v53
    ds_write_b64 v195, v[12:13]
    v_mad_i32_i24 v194, v193, s58, v194
    ds_write_b32 v194, v15 offset:512
    s_mov_b64 exec, s[48:49]
    s_cbranch_execz K2_SC_DONE
    v_cmpx_gt_u32 vcc, 64, v44
    v_bfe_u32 v194, v44, 3, 1
    v_add_u32 v193, 16, v44
    v_lshl_or_b32 v194, v44, 1, v194
    v_bfi_b32 v194, 15, v194, v44
    v_lshrrev_b32 v193, 6, v193
    v_alignbit_b32 v17, v18, v17, 16
    v_lshl_add_u32 v195, v194, 3, v54
    v_lshl_add_u32 v194, v194, 5, v54
    ds_write_b64 v195, v[16:17]
    v_mad_i32_i24 v194, v193, s58, v194
    ds_write_b32 v194, v19 offset:512
    s_mov_b64 exec, s[50:51]
    s_cbranch_execz K2_SC_DONE
    v_cmpx_gt_u32 vcc, 64, v45
    v_bfe_u32 v194, v45, 3, 1
    v_add_u32 v193, 16, v45
    v_lshl_or_b32 v194, v45, 1, v194
    v_bfi_b32 v194, 15, v194, v45
    v_lshrrev_b32 v193, 6, v193
    v_alignbit_b32 v21, v22, v21, 16
    v_lshl_add_u32 v195, v194, 3, v55
    v_lshl_add_u32 v194, v194, 5, v55
    ds_write_b64 v195, v[20:21]
    v_mad_i32_i24 v194, v193, s58, v194
    ds_write_b32 v194, v23 offset:512
    s_mov_b64 exec, s[90:91]
    s_cbranch_execz K2_SC_DONE
    v_cmpx_gt_u32 vcc, 64, v46
    v_bfe_u32 v194, v46, 3, 1
    v_add_u32 v193, 16, v46
    v_lshl_or_b32 v194, v46, 1, v194
    v_bfi_b32 v194, 15, v194, v46
    v_lshrrev_b32 v193, 6, v193
    v_alignbit_b32 v25, v26, v25, 16
    v_lshl_add_u32 v195, v194, 3, v56
    v_lshl_add_u32 v194, v194, 5, v56
    ds_write_b64 v195, v[24:25]
    v_mad_i32_i24 v194, v193, s58, v194
    ds_write_b32 v194, v27 offset:512
    s_mov_b64 exec, s[92:93]
    s_cbranch_execz K2_SC_DONE
    v_cmpx_gt_u32 vcc, 64, v47
    v_bfe_u32 v194, v47, 3, 1
    v_add_u32 v193, 16, v47
    v_lshl_or_b32 v194, v47, 1, v194
    v_bfi_b32 v194, 15, v194, v47
    v_lshrrev_b32 v193, 6, v193
    v_alignbit_b32 v29, v30, v29, 16
    v_lshl_add_u32 v195, v194, 3, v57
    v_lshl_add_u32 v194, v194, 5, v57
    ds_write_b64 v195, v[28:29]
    v_mad_i32_i24 v194, v193, s58, v194
    ds_write_b32 v194, v31 offset:512
    s_mov_b64 exec, s[94:95]
    s_cbranch_execz K2_SC_DONE
    v_cmpx_gt_u32 vcc, 64, v48
    v_bfe_u32 v194, v48, 3, 1
    v_add_u32 v193, 16, v48
    v_lshl_or_b32 v194, v48, 1, v194
    v_bfi_b32 v194, 15, v194, v48
    v_lshrrev_b32 v193, 6, v193
    v_alignbit_b32 v33, v34, v33, 16
    v_lshl_add_u32 v195, v194, 3, v58
    v_lshl_add_u32 v194, v194, 5, v58
    ds_write_b64 v195, v[32:33]
    v_mad_i32_i24 v194, v193, s58, v194
    ds_write_b32 v194, v35 offset:512
    s_mov_b64 exec, s[96:97]
    s_cbranch_execz K2_SC_DONE
    v_cmpx_gt_u32 vcc, 64, v49
    v_bfe_u32 v194, v49, 3, 1
    v_add_u32 v193, 16, v49
    v_lshl_or_b32 v194, v49, 1, v194
    v_bfi_b32 v194, 15, v194, v49
    v_lshrrev_b32 v193, 6, v193
    v_alignbit_b32 v37, v38, v37, 16
    v_lshl_add_u32 v195, v194, 3, v59
    v_lshl_add_u32 v194, v194, 5, v59
    ds_write_b64 v195, v[36:37]
    v_mad_i32_i24 v194, v193, s58, v194
    ds_write_b32 v194, v39 offset:512
K2_SC_DONE:
    s_mov_b64 exec, -1
K2_PAD_SD:
    s_cbranch_execz KS_HOP
    v_lshlrev_b32 v192, 2, v176
    v_add_u32 v192, 163072, v192
    v_mov_b32 v200, 163300
    s_cmp_eq_u32 s24, 0
    s_cselect_b32 s26, 64, 48
    s_waitcnt lgkmcnt(0)
    s_barrier
    ds_read_b32 v193, v192
    ds_read_b32 v200, v200
    v_cmp_gt_u32 s[56:57], s22, v176
    v_mad_u32_u24 v195, v176, s59, v202
    s_waitcnt lgkmcnt(0)
    v_cndmask_b32 v193, 0, v193, s[56:57]
    v_readfirstlane_b32 s27, v200
    v_cmp_lt_u32 s[62:63], 48, v193
    v_cmp_lt_u32 vcc, 64, v193
    s_bcnt1_i32_b64 s60, s[62:63]
    v_mbcnt_lo_u32_b32 v198, s62, 0
    v_mbcnt_hi_u32_b32 v198, s63, v198
    s_cbranch_vccnz K2_BIG
    s_cmp_gt_u32 s60, 8
    s_cbranch_scc1 K2_BIG
K2_TOK:
    v_subrev_u32 v194, s67, v193
    v_max_i32 v194, 1, v194
    v_min_i32 v194, s26, v194
    v_add_u32 v194, 15, v194
    v_lshrrev_b32 v194, 3, v194
    v_lshl_or_b32 v195, v194, 18, v195
    v_lshl_or_b32 v195, v198, 28, v195
    v_mov_b32 v197, 949760
    v_cndmask_b32 v253, v197, v195, s[56:57]
    s_movk_i32 s40, 0
    s_movk_i32 s41, 256
    s_movk_i32 s42, 512
    s_movk_i32 s43, 768
    s_add_u32 s24, s24, 1
    s_cmp_ge_u32 s24, s25
    s_cselect_b32 s55, 1, 0
    s_cmp_eq_u32 s27, 0
    s_cselect_b32 s55, s55, 0
    s_mov_b32 s27, 0x400000
    s_mov_b32 s38, 0
    s_mov_b32 s34, 0
    s_mov_b32 s35, 0
    s_mov_b32 s36, 1
    s_mov_b32 s31, 0
    s_mov_b32 s58, s20
    v_readlane_b32 s3, v253, s58
    s_lshl_b32 s44, s34, 7
    s_and_b32 s48, s3, 0x3ffff
    s_bfe_u32 s33, s3, 0x30013
    s_mul_i32 s35, s38, 6
    s_cmp_eq_u32 s34, 0
    s_cselect_b32 s35, s35, s48
    s_mov_b32 s45, s44
    s_xor_b32 s47, s44, 256
    s_add_u32 s49, s48, 128
    s_add_u32 s60, s48, 256
    s_cmp_eq_u32 s33, 3
    s_cselect_b32 s46, s44, s47
    s_cselect_b32 s50, s60, s48
    s_sub_u32 s60, s33, 2
    s_cmp_lt_u32 s60, 2
    s_cbranch_scc0 K2_rare_1
K2_back_2:
    v_add_u32 v233, s48, v230
    ds_read_b32 v232, v233
    ds_read_b32 v233, v233 offset:1024
    v_add_u32 v222, s48, v251
    ds_read2_b32 v[222:223], v222 offset0:1 offset1:3
    v_add_u32 v224, s49, v251
    ds_read2_b32 v[224:225], v224 offset0:1 offset1:3
    v_add_u32 v226, s50, v251
    ds_read2_b32 v[226:227], v226 offset0:1 offset1:3
    s_waitcnt lgkmcnt(3)
    v_or_b32 v232, v232, v231
    v_or_b32 v233, v233, v231
    s_cmp_lg_u32 s34, 0
    s_cbranch_scc1 K2_dum_4
    s_cmp_eq_u32 s33, 4
    s_cbranch_scc1 K2_a4_5
K2_b4_7:
    s_add_u32 m0, s48, 512
    s_add_u32 s65, s48, 1536
    buffer_load_dwordx4 v232, s[16:19], 0 offen  lds
    s_mov_b32 m0, s65
    s_mov_b32 exec_hi, 0
    buffer_load_dwordx4 v233, s[16:19], 0 offen  lds
    s_mov_b32 exec_hi, -1
K2_back_6:
    s_waitcnt lgkmcnt(2)
    v_mad_u32_u16 v222, v222, s39, v248 op_sel:[1,0,0,0]
    v_mad_u32_u16 v223, v223, s39, v248 op_sel:[1,0,0,0]
    s_waitcnt lgkmcnt(1)
    v_mad_u32_u16 v224, v224, s39, v248 op_sel:[1,0,0,0]
    v_mad_u32_u16 v225, v225, s39, v248 op_sel:[1,0,0,0]
    s_waitcnt lgkmcnt(0)
    v_mad_u32_u16 v226, v226, s39, v248 op_sel:[1,0,0,0]
    v_mad_u32_u16 v227, v227, s39, v248 op_sel:[1,0,0,0]
    s_mov_b32 m0, s68
    s_nop 0
    buffer_load_dwordx4 v222, s[4:7], s44 offen sc1 lds
    buffer_load_dwordx4 v223, s[72:75], s44 offen offset:1024 sc1 lds
    s_mov_b32 m0, s69
    s_nop 0
    buffer_load_dwordx4 v224, s[4:7], s45 offen sc1 lds
    buffer_load_dwordx4 v225, s[72:75], s45 offen offset:1024 sc1 lds
    s_mov_b32 m0, s70
    s_nop 0
    buffer_load_dwordx4 v226, s[4:7], s46 offen sc1 lds
    buffer_load_dwordx4 v227, s[72:75], s46 offen offset:1024 sc1 lds
    s_mov_b32 m0, s71
    s_cmp_eq_u32 s33, 4
    s_cbranch_scc1 K2_g4_8
    buffer_load_dwordx4 v224, s[4:7], s47 offen sc1 lds
    buffer_load_dwordx4 v225, s[72:75], s47 offen offset:1024 sc1 lds
K2_back_9:
    v_add_u32 v249, s48, v249
    v_add_u32 v250, s48, v250
    v_bfe_u32 v192, v253, 18, 4
    s_sub_u32 s58, s22, 16
    v_cmp_le_u32 vcc, 6, v192
    v_cmp_gt_u32 s[60:61], s58, v176
    s_nop 0
    s_or_b64 vcc, vcc, s[60:61]
    v_mbcnt_lo_u32_b32 v192, vcc_lo, 0
    v_mbcnt_hi_u32_b32 v192, vcc_hi, v192
    s_bcnt1_i32_b64 s58, vcc
    v_sub_u32 v193, v176, v192
    v_add_u32 v193, s58, v193
    v_cndmask_b32 v192, v193, v192, vcc
    v_lshlrev_b32 v192, 2, v192
    ds_permute_b32 v193, v192, v176
    s_waitcnt lgkmcnt(0)
    v_lshl_or_b32 v253, v193, 22, v253
    s_waitcnt vmcnt(6)
    ds_read_b64_tr_b16 v[176:177], v246 offset:0
    ds_read_b64_tr_b16 v[178:179], v246 offset:1024
    ds_read_b64_tr_b16 v[180:181], v247 offset:0
    ds_read_b64_tr_b16 v[182:183], v247 offset:1024
    ds_read_b64_tr_b16 v[0:1], v249 offset:0
    ds_read_b64_tr_b16 v[2:3], v249 offset:32
    ds_read_u16_d16_hi v16, v250 offset:0
    ds_read_b64_tr_b16 v[4:5], v249 offset:512
    ds_read_b64_tr_b16 v[6:7], v249 offset:544
    ds_read_u16_d16_hi v17, v250 offset:128
    s_mov_b32 s29, s48
    s_mov_b32 s32, s31
    s_mov_b32 s30, s3
    s_mov_b32 s31, s35
    s_bfe_u32 s56, s3, 0x40012
    s_cmp_eq_u32 s56, 5
    s_cbranch_scc1 K2_U20
    s_cmp_eq_u32 s56, 6
    s_cbranch_scc1 K2_U3h0
    s_branch K2_DSP0
K2_PAD_H1:
    s_branch KS_HOP0
KS_HELP:
    s_mov_b32 s30, 0
    s_cmp_eq_u32 s20, 6
    s_cbranch_scc1 KS_RAW
    s_mov_b32 s30, 2
    s_cmp_ge_u32 s2, 170
    s_cbranch_scc1 KS_NOW
    s_mov_b32 s30, 1
    v_and_b32 v1, 15, v8
    v_lshrrev_b32 v3, 4, v8
    s_cmp_ge_u32 s2, 160
    s_cbranch_scc1 K1_WT
    s_cmp_ge_u32 s2, 64
    s_cbranch_scc1 K1_S1
    s_lshr_b32 s24, s2, 3
    s_and_b32 s25, s2, 7
    s_lshr_b32 s26, s25, 2
    s_bfe_u32 s27, s25, 0x10001
    s_and_b32 s28, s25, 1
    s_mov_b32 s60, s92
    s_and_b32 s61, s93, 0xffff
    s_mov_b32 s62, 65536
    s_mov_b32 s63, 0x20000
    s_branch K1_SC
K1_S1:
    s_sub_u32 s29, s2, 64
    s_mul_i32 s24, s29, 43
    s_lshr_b32 s24, s24, 9
    s_mul_i32 s25, s24, 12
    s_sub_u32 s25, s29, s25
    s_cmp_ge_u32 s25, 6
    s_cselect_b32 s26, 1, 0
    s_mul_i32 s27, s26, 6
    s_sub_u32 s27, s25, s27
    s_lshr_b32 s27, s27, 1
    s_and_b32 s28, s25, 1
    s_add_u32 s25, s25, 8
    s_mov_b32 s60, s94
    s_and_b32 s61, s95, 0xffff
    s_mov_b32 s62, 98304
    s_mov_b32 s63, 0x20000
K1_SC:
    s_lshl_b32 s27, s27, 7
    s_lshl_b32 s26, s26, 6
    s_lshl_b32 s28, s28, 4
    s_add_u32 s27, s27, s26
    s_add_u32 s27, s27, s28
    s_lshl_b32 s27, s27, 8
    s_lshl_b32 s26, s24, 5
    s_add_u32 s27, s27, s26
    s_add_u32 s29, s27, 8192
    v_lshlrev_b32 v3, 10, v3
    v_lshl_add_u32 v3, v1, 1, v3
    buffer_load_ushort v64, v3, s[60:63], s27 offen offset:0
    buffer_load_ushort v65, v3, s[60:63], s29 offen offset:0
    buffer_load_ushort v66, v3, s[60:63], s27 offen offset:256
    buffer_load_ushort v67, v3, s[60:63], s29 offen offset:256
    buffer_load_ushort v68, v3, s[60:63], s27 offen offset:512
    buffer_load_ushort v69, v3, s[60:63], s29 offen offset:512
    buffer_load_ushort v70, v3, s[60:63], s27 offen offset:768
    buffer_load_ushort v71, v3, s[60:63], s29 offen offset:768
    s_mul_i32 s24, s24, 20
    s_add_u32 s24, s24, s25
    s_lshl_b32 s24, s24, 10
    s_add_u32 s24, s24, 6946816
    s_branch K1_GO
K1_WT:
    s_sub_u32 s24, s2, 160
    s_lshr_b32 s27, s24, 1
    s_and_b32 s28, s24, 1
    s_lshl_b32 s27, s27, 8
    s_lshl_b32 s28, s28, 6
    s_add_u32 s27, s27, s28
    s_add_u32 s29, s27, 10240
    s_mov_b32 s60, s90
    s_and_b32 s61, s91, 0xffff
    s_mov_b32 s62, 20480
    s_mov_b32 s63, 0x20000
    v_and_b32 v1, 31, v8
    v_lshrrev_b32 v3, 5, v8
    v_mul_u32_u24 v3, 5120, v3
    v_lshl_add_u32 v3, v1, 1, v3
    buffer_load_ushort v64, v3, s[60:63], s27 offen offset:0
    buffer_load_ushort v65, v3, s[60:63], s27 offen offset:1280
    buffer_load_ushort v66, v3, s[60:63], s27 offen offset:2560
    buffer_load_ushort v67, v3, s[60:63], s27 offen offset:3840
    buffer_load_ushort v68, v3, s[60:63], s29 offen offset:0
    buffer_load_ushort v69, v3, s[60:63], s29 offen offset:1280
    buffer_load_ushort v70, v3, s[60:63], s29 offen offset:2560
    buffer_load_ushort v71, v3, s[60:63], s29 offen offset:3840
    s_lshl_b32 s24, s24, 10
    s_add_u32 s24, s24, 7110656
K1_GO:
KS_NOW:
    s_barrier
K2_PAD_H2:
    s_cbranch_execz KS_HOP0
    v_and_b32 v76, 31, v8
    v_lshrrev_b32 v77, 5, v8
    v_mov_b32 v80, 0
    v_mul_u32_u24 v77, 2080, v77
    v_mov_b32 v81, 0xffff0000
    v_lshl_add_u32 v78, v76, 4, v77
    v_mov_b32 v82, 0
    v_add_u32 v78, 65536, v78
    v_mov_b32 v83, v81
    v_add_u32 v79, 41600, v78
    ds_write_b128 v78, v[80:83] offset:0
    ds_write_b128 v78, v[80:83] offset:4160
    ds_write_b128 v78, v[80:83] offset:8320
    ds_write_b128 v78, v[80:83] offset:12480
    ds_write_b128 v78, v[80:83] offset:16640
    ds_write_b128 v78, v[80:83] offset:20800
    ds_write_b128 v78, v[80:83] offset:24960
    ds_write_b128 v78, v[80:83] offset:29120
    ds_write_b128 v78, v[80:83] offset:33280
    ds_write_b128 v78, v[80:83] offset:37440
    ds_write_b128 v79, v[80:83] offset:0
    ds_write_b128 v79, v[80:83] offset:4160
    ds_write_b128 v79, v[80:83] offset:8320
    ds_write_b128 v79, v[80:83] offset:12480
    ds_write_b128 v79, v[80:83] offset:16640
    ds_write_b128 v79, v[80:83] offset:20800
    ds_write_b128 v79, v[80:83] offset:24960
    ds_write_b128 v79, v[80:83] offset:29120
    ds_write_b128 v79, v[80:83] offset:33280
    ds_write_b128 v79, v[80:83] offset:37440
KS_FILL:
    v_mov_b32 v59, 163456
    s_barrier
    ds_read_b32 v59, v59
    s_waitcnt vmcnt(0) lgkmcnt(0)
    s_cmp_eq_u32 s30, 0
    s_cbranch_scc1 KS_B3
    s_cmp_eq_u32 s30, 2
    s_cbranch_scc1 KS_NOST
    v_lshl_or_b32 v40, v65, 16, v64
    v_lshl_or_b32 v41, v67, 16, v66
    v_lshl_or_b32 v42, v69, 16, v68
    v_lshl_or_b32 v43, v71, 16, v70
    buffer_store_dwordx4 v[40:43], v9, s[8:11], s24 offen sc1
KS_NOST:
    v_mov_b32 v62, 163460
    s_waitcnt lgkmcnt(0)
    s_barrier
    ds_read_b32 v62, v62
    s_lshl_b32 s24, s2, 2
    s_add_u32 s24, s24, 7176192
    s_mov_b64 exec, 1
    s_waitcnt vmcnt(0)
    buffer_store_dword v59, v6, s[8:11], s24 offen sc1
    s_mov_b64 exec, -1
    s_branch KS_JOIN
K2_PAD_H3:
    s_branch KS_HOP0
KS_RAW:
    s_cmp_lg_u32 s2, 0
    s_cbranch_scc1 KS_NOX
    s_mov_b32 s60, s98
    s_and_b32 s61, s99, 0xffff
    s_mov_b32 s62, 256
    s_mov_b32 s63, 0x20000
    s_getreg_b32 s24, hwreg(HW_REG_XCC_ID, 0, 1)
    s_add_u32 s24, s24, 1
    v_mov_b32 v10, s24
    v_mov_b32 v11, 0
    s_mov_b64 exec, 1
    buffer_atomic_cmpswap v[10:11], v6, s[60:63], 0 offen sc1
    s_mov_b64 exec, -1
KS_NOX:
    s_barrier
    s_mov_b32 s60, s90
    s_and_b32 s61, s91, 0xffff
    s_mov_b32 s62, 20480
    s_mov_b32 s63, 0x20000
    v_lshrrev_b32 v10, 3, v8
    v_and_b32 v11, 7, v8
    v_lshlrev_b32 v10, 8, v10
    v_lshl_add_u32 v10, v11, 4, v10
    s_mov_b32 m0, 24576
    s_movk_i32 s24, 0
    buffer_load_dwordx4 v10, s[60:63], s24 offen lds
    s_mov_b32 m0, 25600
    s_movk_i32 s24, 2048
    buffer_load_dwordx4 v10, s[60:63], s24 offen lds
    s_mov_b32 m0, 26624
    s_movk_i32 s24, 4096
    buffer_load_dwordx4 v10, s[60:63], s24 offen lds
    s_mov_b32 m0, 27648
    s_movk_i32 s24, 6144
    buffer_load_dwordx4 v10, s[60:63], s24 offen lds
    s_mov_b32 m0, 28672
    s_movk_i32 s24, 8192
    buffer_load_dwordx4 v10, s[60:63], s24 offen lds
    s_mov_b32 m0, 29696
    s_movk_i32 s24, 10240
    buffer_load_dwordx4 v10, s[60:63], s24 offen lds
    s_mov_b32 m0, 30720
    s_movk_i32 s24, 12288
    buffer_load_dwordx4 v10, s[60:63], s24 offen lds
    s_mov_b32 m0, 31744
    s_movk_i32 s24, 14336
    buffer_load_dwordx4 v10, s[60:63], s24 offen lds
    s_mov_b32 m0, 32768
    s_movk_i32 s24, 16384
    buffer_load_dwordx4 v10, s[60:63], s24 offen lds
    s_mov_b32 m0, 33792
    s_movk_i32 s24, 18432
    buffer_load_dwordx4 v10, s[60:63], s24 offen lds
    s_mov_b32 m0, 152832
    s_movk_i32 s24, 128
    buffer_load_dwordx4 v10, s[60:63], s24 offen lds
    s_mov_b32 m0, 153856
    s_movk_i32 s24, 2176
    buffer_load_dwordx4 v10, s[60:63], s24 offen lds
    s_mov_b32 m0, 154880
    s_movk_i32 s24, 4224
    buffer_load_dwordx4 v10, s[60:63], s24 offen lds
    s_mov_b32 m0, 155904
    s_movk_i32 s24, 6272
    buffer_load_dwordx4 v10, s[60:63], s24 offen lds
    s_mov_b32 m0, 156928
    s_movk_i32 s24, 8320
    buffer_load_dwordx4 v10, s[60:63], s24 offen lds
    s_mov_b32 m0, 157952
    s_movk_i32 s24, 10368
    buffer_load_dwordx4 v10, s[60:63], s24 offen lds
    s_mov_b32 m0, 158976
    s_movk_i32 s24, 12416
    buffer_load_dwordx4 v10, s[60:63], s24 offen lds
    s_mov_b32 m0, 160000
    s_movk_i32 s24, 14464
    buffer_load_dwordx4 v10, s[60:63], s24 offen lds
    s_mov_b32 m0, 161024
    s_movk_i32 s24, 16512
    buffer_load_dwordx4 v10, s[60:63], s24 offen lds
    s_mov_b32 m0, 162048
    s_movk_i32 s24, 18560
    buffer_load_dwordx4 v10, s[60:63], s24 offen lds
    v_add_u32 v85, 16, v8
    v_lshlrev_b32 v84, 5, v8
    v_lshrrev_b32 v85, 6, v85
    v_mul_u32_u24 v85, 1532, v85
    v_sub_u32 v84, v84, v85
    v_mov_b32 v85, -1
    v_add_u32 v84, 66048, v84
    v_add_u32 v86, 41600, v84
    ds_write_b32 v84, v85 offset:0
    ds_write_b32 v84, v85 offset:2080
    ds_write_b32 v84, v85 offset:4160
    ds_write_b32 v84, v85 offset:6240
    ds_write_b32 v84, v85 offset:8320
    ds_write_b32 v84, v85 offset:10400
    ds_write_b32 v84, v85 offset:12480
    ds_write_b32 v84, v85 offset:14560
    ds_write_b32 v84, v85 offset:16640
    ds_write_b32 v84, v85 offset:18720
    ds_write_b32 v84, v85 offset:20800
    ds_write_b32 v84, v85 offset:22880
    ds_write_b32 v84, v85 offset:24960
    ds_write_b32 v84, v85 offset:27040
    ds_write_b32 v84, v85 offset:29120
    ds_write_b32 v84, v85 offset:31200
    ds_write_b32 v84, v85 offset:33280
    ds_write_b32 v84, v85 offset:35360
    ds_write_b32 v84, v85 offset:37440
    ds_write_b32 v84, v85 offset:39520
    ds_write_b32 v86, v85 offset:0
    ds_write_b32 v86, v85 offset:2080
    ds_write_b32 v86, v85 offset:4160
    ds_write_b32 v86, v85 offset:6240
    ds_write_b32 v86, v85 offset:8320
    ds_write_b32 v86, v85 offset:10400
    ds_write_b32 v86, v85 offset:12480
    ds_write_b32 v86, v85 offset:14560
    ds_write_b32 v86, v85 offset:16640
    ds_write_b32 v86, v85 offset:18720
    ds_write_b32 v86, v85 offset:20800
    ds_write_b32 v86, v85 offset:22880
    ds_write_b32 v86, v85 offset:24960
    ds_write_b32 v86, v85 offset:27040
    ds_write_b32 v86, v85 offset:29120
    ds_write_b32 v86, v85 offset:31200
    ds_write_b32 v86, v85 offset:33280
    ds_write_b32 v86, v85 offset:35360
    ds_write_b32 v86, v85 offset:37440
    ds_write_b32 v86, v85 offset:39520
    s_branch KS_FILL
KS_IDLE:
    s_barrier
    s_barrier
    s_branch KS_B3
K2_PAD_U20:
    s_branch K2_HOP
K2_U20:
    s_setprio 1
    s_waitcnt lgkmcnt(0)
    v_lshlrev_b32 v20, 16, v0
    v_and_b32 v21, 0xffff0000, v0
    v_lshlrev_b32 v22, 16, v1
    v_and_b32 v23, 0xffff0000, v1
    v_lshlrev_b32 v24, 16, v2
    v_and_b32 v25, 0xffff0000, v2
    v_lshlrev_b32 v26, 16, v3
    v_and_b32 v27, 0xffff0000, v3
    v_mul_f32_dpp v36, v16, v20 row_newbcast:8 row_mask:0xf bank_mask:0xf
    v_mul_f32_dpp v37, v16, v21 row_newbcast:9 row_mask:0xf bank_mask:0xf
    v_mul_f32_dpp v38, v16, v22 row_newbcast:10 row_mask:0xf bank_mask:0xf
    v_mul_f32_dpp v39, v16, v23 row_newbcast:11 row_mask:0xf bank_mask:0xf
    v_mul_f32_dpp v40, v16, v24 row_newbcast:12 row_mask:0xf bank_mask:0xf
    v_mul_f32_dpp v41, v16, v25 row_newbcast:13 row_mask:0xf bank_mask:0xf
    v_mul_f32_dpp v42, v16, v26 row_newbcast:14 row_mask:0xf bank_mask:0xf
    v_mul_f32_dpp v43, v16, v27 row_newbcast:15 row_mask:0xf bank_mask:0xf
    v_cvt_pk_bf16_f32 v68, v36, v37
    v_cvt_pk_bf16_f32 v69, v38, v39
    v_cvt_pk_bf16_f32 v70, v40, v41
    v_cvt_pk_bf16_f32 v71, v42, v43
    v_mul_f32_dpp v20, v16, v20 row_newbcast:0 row_mask:0xa bank_mask:0xf
    v_mul_f32_dpp v21, v16, v21 row_newbcast:1 row_mask:0xa bank_mask:0xf
    v_mul_f32_dpp v22, v16, v22 row_newbcast:2 row_mask:0xa bank_mask:0xf
    v_mul_f32_dpp v23, v16, v23 row_newbcast:3 row_mask:0xa bank_mask:0xf
    v_mul_f32_dpp v24, v16, v24 row_newbcast:4 row_mask:0xa bank_mask:0xf
    v_mul_f32_dpp v25, v16, v25 row_newbcast:5 row_mask:0xa bank_mask:0xf
    v_mul_f32_dpp v26, v16, v26 row_newbcast:6 row_mask:0xa bank_mask:0xf
    v_mul_f32_dpp v27, v16, v27 row_newbcast:7 row_mask:0xa bank_mask:0xf
    v_cvt_pk_bf16_f32 v64, v20, v21
    v_cvt_pk_bf16_f32 v65, v22, v23
    v_cvt_pk_bf16_f32 v66, v24, v25
    v_cvt_pk_bf16_f32 v67, v26, v27
    v_lshlrev_b32 v28, 16, v4
    v_and_b32 v29, 0xffff0000, v4
    v_lshlrev_b32 v30, 16, v5
    v_and_b32 v31, 0xffff0000, v5
    v_lshlrev_b32 v32, 16, v6
    v_and_b32 v33, 0xffff0000, v6
    v_lshlrev_b32 v34, 16, v7
    v_and_b32 v35, 0xffff0000, v7
    v_mul_f32_dpp v36, v17, v28 row_newbcast:8 row_mask:0xf bank_mask:0xf
    v_mul_f32_dpp v37, v17, v29 row_newbcast:9 row_mask:0xf bank_mask:0xf
    v_mul_f32_dpp v38, v17, v30 row_newbcast:10 row_mask:0xf bank_mask:0xf
    v_mul_f32_dpp v39, v17, v31 row_newbcast:11 row_mask:0xf bank_mask:0xf
    v_mul_f32_dpp v40, v17, v32 row_newbcast:12 row_mask:0xf bank_mask:0xf
    v_mul_f32_dpp v41, v17, v33 row_newbcast:13 row_mask:0xf bank_mask:0xf
    v_mul_f32_dpp v42, v17, v34 row_newbcast:14 row_mask:0xf bank_mask:0xf
    v_mul_f32_dpp v43, v17, v35 row_newbcast:15 row_mask:0xf bank_mask:0xf
    v_cvt_pk_bf16_f32 v76, v36, v37
    v_cvt_pk_bf16_f32 v77, v38, v39
    v_cvt_pk_bf16_f32 v78, v40, v41
    v_cvt_pk_bf16_f32 v79, v42, v43
    v_mul_f32_dpp v28, v17, v28 row_newbcast:0 row_mask:0xa bank_mask:0xf
    v_mul_f32_dpp v29, v17, v29 row_newbcast:1 row_mask:0xa bank_mask:0xf
    v_mul_f32_dpp v30, v17, v30 row_newbcast:2 row_mask:0xa bank_mask:0xf
    v_mul_f32_dpp v31, v17, v31 row_newbcast:3 row_mask:0xa bank_mask:0xf
    v_mul_f32_dpp v32, v17, v32 row_newbcast:4 row_mask:0xa bank_mask:0xf
    v_mul_f32_dpp v33, v17, v33 row_newbcast:5 row_mask:0xa bank_mask:0xf
    v_mul_f32_dpp v34, v17, v34 row_newbcast:6 row_mask:0xa bank_mask:0xf
    v_mul_f32_dpp v35, v17, v35 row_newbcast:7 row_mask:0xa bank_mask:0xf
    v_cvt_pk_bf16_f32 v72, v28, v29
    v_cvt_pk_bf16_f32 v73, v30, v31
    v_cvt_pk_bf16_f32 v74, v32, v33
    v_cvt_pk_bf16_f32 v75, v34, v35
    s_waitcnt vmcnt(4)
    v_mfma_f32_32x32x16_bf16 v[0:15], v[64:67], v[176:179], 0
    ds_read_b64_tr_b16 v[184:185], v246 offset:2048
    ds_read_b64_tr_b16 v[186:187], v246 offset:3072
    ds_read_b64_tr_b16 v[188:189], v247 offset:2048
    ds_read_b64_tr_b16 v[190:191], v247 offset:3072
    s_mov_b32 m0, s68
    v_mfma_f32_32x32x16_bf16 v[16:31], v[68:71], v[176:179], 0
    buffer_load_dwordx4 v222, s[4:7], s42 offen sc1 lds
    buffer_load_dwordx4 v223, s[72:75], s42 offen offset:1024 sc1 lds
    v_permlane32_swap_b32 v242, v236
    v_permlane32_swap_b32 v243, v237
    s_add_u32 s38, s38, 1
    v_mfma_f32_32x32x16_bf16 v[32:47], v[64:67], v[180:183], 0
    v_permlane32_swap_b32 v244, v238
    v_permlane32_swap_b32 v245, v239
    v_permlane32_swap_b32 v240, v241
    v_add_f32 v242, v242, v236
    v_mfma_f32_32x32x16_bf16 v[48:63], v[68:71], v[180:183], 0
    v_add_f32 v243, v243, v237
    v_add_f32 v244, v244, v238
    v_add_f32 v245, v245, v239
    v_add_f32 v240, -v240, -v241
    v_mov_b32 v254, s52
    v_mov_b32 v255, s38
    s_waitcnt vmcnt(4) lgkmcnt(0)
    v_mfma_f32_32x32x16_bf16 v[0:15], v[72:75], v[184:187], v[0:15]
    ds_read_b64_tr_b16 v[176:177], v246 offset:4096
    ds_read_b64_tr_b16 v[178:179], v246 offset:5120
    ds_read_b64_tr_b16 v[180:181], v247 offset:4096
    ds_read_b64_tr_b16 v[182:183], v247 offset:5120
    s_lshl_b32 s58, s38, 3
    s_add_u32 s58, s58, s20
    s_mov_b32 m0, s69
    v_mfma_f32_32x32x16_bf16 v[16:31], v[76:79], v[184:187], v[16:31]
    buffer_load_dwordx4 v224, s[4:7], s42 offen sc1 lds
    buffer_load_dwordx4 v225, s[72:75], s42 offen offset:1024 sc1 lds
    s_set_gpr_idx_on s32, gpr_idx(DST)
    s_nop 0
    v_cvt_pk_bf16_f32 v195, v242, v243
    v_cvt_pk_bf16_f32 v196, v244, v245
    v_cvt_pk_bf16_f32 v197, v240, v240
    s_set_gpr_idx_off
    s_mov_b64 exec, 1
    ds_write_b32 v254, v255
    s_mov_b64 exec, -1
    s_cmp_lt_u32 s58, s22
    s_cbranch_scc0 K2_dyn_10
K2_back_11:
    v_readlane_b32 s3, v253, s58
    s_lshl_b32 s44, s34, 7
    s_and_b32 s48, s3, 0x3ffff
    s_bfe_u32 s33, s3, 0x30013
    s_mul_i32 s35, s38, 6
    s_cmp_eq_u32 s34, 0
    s_cselect_b32 s35, s35, s48
    s_mov_b32 s45, s44
    s_xor_b32 s47, s44, 256
    s_add_u32 s49, s48, 128
    s_add_u32 s60, s48, 256
    s_cmp_eq_u32 s33, 3
    s_cselect_b32 s46, s44, s47
    s_cselect_b32 s50, s60, s48
    s_sub_u32 s60, s33, 2
    s_cmp_lt_u32 s60, 2
    s_cbranch_scc0 K2_rare_16
K2_back_17:
    v_mfma_f32_32x32x16_bf16 v[32:47], v[72:75], v[188:191], v[32:47]
    v_add_u32 v233, s48, v230
    ds_read_b32 v232, v233
    ds_read_b32 v233, v233 offset:1024
    v_mul_f32 v234, v0, v96
    v_mul_f32 v236, v8, v128
    v_fmac_f32 v234, v1, v97
    v_fmac_f32 v236, v9, v129
    v_mfma_f32_32x32x16_bf16 v[48:63], v[76:79], v[188:191], v[48:63]
    s_setprio 0
    v_fmac_f32 v234, v2, v98
    v_fmac_f32 v236, v10, v130
    v_fmac_f32 v234, v3, v99
    v_fmac_f32 v236, v11, v131
    v_fmac_f32 v234, v4, v100
    v_fmac_f32 v236, v12, v132
    v_fmac_f32 v234, v5, v101
    v_fmac_f32 v236, v13, v133
    v_fmac_f32 v234, v6, v102
    v_fmac_f32 v236, v14, v134
    v_fmac_f32 v234, v7, v103
    v_fmac_f32 v236, v15, v135
    v_mul_f32 v238, v16, v128
    v_mul_f32 v240, v24, v128
    v_fmac_f32 v238, v17, v129
    v_fmac_f32 v240, v25, v129
    v_fmac_f32 v238, v18, v130
    v_fmac_f32 v240, v26, v130
    v_fmac_f32 v238, v19, v131
    v_fmac_f32 v240, v27, v131
    v_fmac_f32 v238, v20, v132
    v_fmac_f32 v240, v28, v132
    v_fmac_f32 v238, v21, v133
    v_fmac_f32 v240, v29, v133
    v_fmac_f32 v238, v22, v134
    v_fmac_f32 v240, v30, v134
    v_fmac_f32 v238, v23, v135
    v_fmac_f32 v240, v31, v135
    v_mul_f32 v235, v32, v104
    v_mul_f32 v237, v40, v136
    v_fmac_f32 v235, v33, v105
    v_fmac_f32 v237, v41, v137
    v_fmac_f32 v235, v34, v106
    v_fmac_f32 v237, v42, v138
    v_fmac_f32 v235, v35, v107
    v_fmac_f32 v237, v43, v139
    v_fmac_f32 v235, v36, v108
    v_fmac_f32 v237, v44, v140
    v_fmac_f32 v235, v37, v109
    v_fmac_f32 v237, v45, v141
    v_fmac_f32 v235, v38, v110
    v_fmac_f32 v237, v46, v142
    v_fmac_f32 v235, v39, v111
    v_fmac_f32 v237, v47, v143
    v_mul_f32 v239, v48, v136
    v_mul_f32 v241, v56, v136
    v_fmac_f32 v239, v49, v137
    v_fmac_f32 v241, v57, v137
    s_setprio 1
    s_waitcnt vmcnt(4) lgkmcnt(3)
    v_mfma_f32_32x32x16_bf16 v[0:15], v[64:67], v[176:179], 0
    ds_read_b64_tr_b16 v[184:185], v246 offset:6144
    ds_read_b64_tr_b16 v[186:187], v246 offset:7168
    ds_read_b64_tr_b16 v[188:189], v247 offset:6144
    ds_read_b64_tr_b16 v[190:191], v247 offset:7168
    v_fmac_f32 v239, v50, v138
    v_fmac_f32 v241, v58, v138
    s_mov_b32 m0, s70
    v_mfma_f32_32x32x16_bf16 v[16:31], v[68:71], v[176:179], 0
    buffer_load_dwordx4 v222, s[4:7], s43 offen sc1 lds
    buffer_load_dwordx4 v223, s[72:75], s43 offen offset:1024 sc1 lds
    v_fmac_f32 v239, v51, v139
    v_fmac_f32 v241, v59, v139
    v_fmac_f32 v239, v52, v140
    v_fmac_f32 v241, v60, v140
    v_fmac_f32 v239, v53, v141
    v_mfma_f32_32x32x16_bf16 v[32:47], v[64:67], v[180:183], 0
    v_add_u32 v222, s48, v251
    ds_read2_b32 v[222:223], v222 offset0:1 offset1:3
    v_fmac_f32 v241, v61, v141
    v_fmac_f32 v239, v54, v142
    v_fmac_f32 v241, v62, v142
    v_fmac_f32 v239, v55, v143
    v_fmac_f32 v241, v63, v143
    v_mfma_f32_32x32x16_bf16 v[48:63], v[68:71], v[180:183], 0
    v_permlane32_swap_b32 v234, v236
    v_permlane32_swap_b32 v235, v237
    v_permlane32_swap_b32 v240, v238
    s_waitcnt lgkmcnt(5)
    v_or_b32 v232, v232, v231
    v_or_b32 v233, v233, v231
    s_cmp_lg_u32 s34, 0
    s_cbranch_scc1 K2_dum_21
    s_cmp_eq_u32 s33, 4
    s_cbranch_scc1 K2_a4_22
K2_b4_24:
    s_add_u32 m0, s48, 512
    s_add_u32 s65, s48, 1536
    buffer_load_dwordx4 v232, s[16:19], 0 offen  lds
    s_mov_b32 m0, s65
    s_mov_b32 exec_hi, 0
    buffer_load_dwordx4 v233, s[16:19], 0 offen  lds
    s_mov_b32 exec_hi, -1
K2_back_23:
    s_waitcnt vmcnt(6) lgkmcnt(1)
    v_mfma_f32_32x32x16_bf16 v[0:15], v[72:75], v[184:187], v[0:15]
    ds_read_b64_tr_b16 v[176:177], v246 offset:0
    ds_read_b64_tr_b16 v[178:179], v246 offset:1024
    ds_read_b64_tr_b16 v[180:181], v247 offset:0
    ds_read_b64_tr_b16 v[182:183], v247 offset:1024
    v_permlane32_swap_b32 v241, v239
    s_mov_b32 m0, s71
    v_mfma_f32_32x32x16_bf16 v[16:31], v[76:79], v[184:187], v[16:31]
    buffer_load_dwordx4 v224, s[4:7], s43 offen sc1 lds
    buffer_load_dwordx4 v225, s[72:75], s43 offen offset:1024 sc1 lds
    s_waitcnt lgkmcnt(4)
    v_mad_u32_u16 v222, v222, s39, v248 op_sel:[1,0,0,0]
    v_mad_u32_u16 v223, v223, s39, v248 op_sel:[1,0,0,0]
    v_add_f32 v234, v234, v236
    v_add_f32 v235, v235, v237
    v_add_f32 v240, v240, v238
    v_add_f32 v241, v241, v239
    s_set_gpr_idx_on s31, gpr_idx(DST)
    s_nop 0
    v_cvt_pk_bf16_f32 v192, v234, v235
    v_cvt_pk_bf16_f32 v193, v240, v241
    s_set_gpr_idx_off
    v_mfma_f32_32x32x16_bf16 v[32:47], v[72:75], v[188:191], v[32:47]
    v_add_u32 v224, s49, v251
    ds_read2_b32 v[224:225], v224 offset0:1 offset1:3
    v_mul_f32 v234, v0, v144
    v_mul_f32 v236, v8, v112
    v_fmac_f32 v234, v1, v145
    v_fmac_f32 v236, v9, v113
    v_fmac_f32 v234, v2, v146
    v_mfma_f32_32x32x16_bf16 v[48:63], v[76:79], v[188:191], v[48:63]
    s_setprio 0
    v_fmac_f32 v236, v10, v114
    v_fmac_f32 v234, v3, v147
    v_fmac_f32 v236, v11, v115
    v_fmac_f32 v234, v4, v148
    v_fmac_f32 v236, v12, v116
    v_fmac_f32 v234, v5, v149
    v_fmac_f32 v236, v13, v117
    v_fmac_f32 v234, v6, v150
    v_fmac_f32 v236, v14, v118
    v_fmac_f32 v234, v7, v151
    v_fmac_f32 v236, v15, v119
    v_mul_f32 v238, v16, v160
    v_mul_f32 v240, v24, v160
    v_fmac_f32 v238, v17, v161
    v_fmac_f32 v240, v25, v161
    v_fmac_f32 v238, v18, v162
    v_fmac_f32 v240, v26, v162
    v_fmac_f32 v238, v19, v163
    v_fmac_f32 v240, v27, v163
    v_fmac_f32 v238, v20, v164
    v_fmac_f32 v240, v28, v164
    v_fmac_f32 v238, v21, v165
    v_fmac_f32 v240, v29, v165
    v_fmac_f32 v238, v22, v166
    v_fmac_f32 v240, v30, v166
    v_fmac_f32 v238, v23, v167
    v_fmac_f32 v240, v31, v167
    v_mul_f32 v235, v32, v152
    v_mul_f32 v237, v40, v120
    v_fmac_f32 v235, v33, v153
    v_fmac_f32 v237, v41, v121
    v_fmac_f32 v235, v34, v154
    v_fmac_f32 v237, v42, v122
    v_fmac_f32 v235, v35, v155
    v_fmac_f32 v237, v43, v123
    v_fmac_f32 v235, v36, v156
    v_fmac_f32 v237, v44, v124
    v_fmac_f32 v235, v37, v157
    v_fmac_f32 v237, v45, v125
    v_fmac_f32 v235, v38, v158
    v_fmac_f32 v237, v46, v126
    v_fmac_f32 v235, v39, v159
    v_fmac_f32 v237, v47, v127
    v_mul_f32 v239, v48, v168
    v_mul_f32 v241, v56, v168
    v_fmac_f32 v239, v49, v169
    v_fmac_f32 v241, v57, v169
    v_fmac_f32 v239, v50, v170
    v_fmac_f32 v241, v58, v170
    v_fmac_f32 v239, v51, v171
    s_setprio 1
    s_waitcnt vmcnt(6) lgkmcnt(1)
    v_mfma_f32_32x32x16_bf16 v[0:15], v[64:67], v[176:179], 0
    ds_read_b64_tr_b16 v[184:185], v246 offset:2048
    ds_read_b64_tr_b16 v[186:187], v246 offset:3072
    ds_read_b64_tr_b16 v[188:189], v247 offset:2048
    ds_read_b64_tr_b16 v[190:191], v247 offset:3072
    v_fmac_f32 v241, v59, v171
    v_fmac_f32 v239, v52, v172
    s_mov_b32 m0, s68
    v_mfma_f32_32x32x16_bf16 v[16:31], v[68:71], v[176:179], 0
    buffer_load_dwordx4 v222, s[4:7], s44 offen sc1 lds
    buffer_load_dwordx4 v223, s[72:75], s44 offen offset:1024 sc1 lds
    s_waitcnt lgkmcnt(4)
    v_mad_u32_u16 v224, v224, s39, v248 op_sel:[1,0,0,0]
    v_mad_u32_u16 v225, v225, s39, v248 op_sel:[1,0,0,0]
    v_fmac_f32 v241, v60, v172
    v_fmac_f32 v239, v53, v173
    v_mfma_f32_32x32x16_bf16 v[32:47], v[64:67], v[180:183], 0
    v_add_u32 v226, s50, v251
    ds_read2_b32 v[226:227], v226 offset0:1 offset1:3
    v_fmac_f32 v241, v61, v173
    v_fmac_f32 v239, v54, v174
    v_fmac_f32 v241, v62, v174
    v_fmac_f32 v239, v55, v175
    v_fmac_f32 v241, v63, v175
    v_mfma_f32_32x32x16_bf16 v[48:63], v[68:71], v[180:183], 0
    s_waitcnt vmcnt(6) lgkmcnt(1)
    v_mfma_f32_32x32x16_bf16 v[0:15], v[72:75], v[184:187], v[0:15]
    ds_read_b64_tr_b16 v[176:177], v246 offset:4096
    ds_read_b64_tr_b16 v[178:179], v246 offset:5120
    ds_read_b64_tr_b16 v[180:181], v247 offset:4096
    ds_read_b64_tr_b16 v[182:183], v247 offset:5120
    s_mov_b32 m0, s69
    v_mfma_f32_32x32x16_bf16 v[16:31], v[76:79], v[184:187], v[16:31]
    buffer_load_dwordx4 v224, s[4:7], s45 offen sc1 lds
    buffer_load_dwordx4 v225, s[72:75], s45 offen offset:1024 sc1 lds
    s_waitcnt lgkmcnt(4)
    v_mad_u32_u16 v226, v226, s39, v248 op_sel:[1,0,0,0]
    v_mad_u32_u16 v227, v227, s39, v248 op_sel:[1,0,0,0]
    v_mfma_f32_32x32x16_bf16 v[32:47], v[72:75], v[188:191], v[32:47]
    v_mul_f32 v242, v0, v144
    v_fma_f32 v238, v8, v160, -v238
    v_fmac_f32 v242, v1, v145
    v_fmac_f32 v238, v9, v161
    v_fmac_f32 v242, v2, v146
    v_fmac_f32 v238, v10, v162
    v_fmac_f32 v242, v3, v147
    v_mfma_f32_32x32x16_bf16 v[48:63], v[76:79], v[188:191], v[48:63]
    s_setprio 0
    v_fmac_f32 v238, v11, v163
    v_fmac_f32 v242, v4, v148
    v_fmac_f32 v238, v12, v164
    v_fmac_f32 v242, v5, v149
    v_fmac_f32 v238, v13, v165
    v_fmac_f32 v242, v6, v150
    v_fmac_f32 v238, v14, v166
    v_fmac_f32 v242, v7, v151
    v_fmac_f32 v238, v15, v167
    v_fmac_f32 v236, v16, v112
    v_mul_f32 v244, v24, v160
    v_fmac_f32 v236, v17, v113
    v_fmac_f32 v244, v25, v161
    v_fmac_f32 v236, v18, v114
    v_fmac_f32 v244, v26, v162
    v_fmac_f32 v236, v19, v115
    v_fmac_f32 v244, v27, v163
    v_fmac_f32 v236, v20, v116
    v_fmac_f32 v244, v28, v164
    v_fmac_f32 v236, v21, v117
    v_fmac_f32 v244, v29, v165
    v_fmac_f32 v236, v22, v118
    v_fmac_f32 v244, v30, v166
    v_fmac_f32 v236, v23, v119
    v_fmac_f32 v244, v31, v167
    v_mul_f32 v243, v32, v152
    v_fma_f32 v239, v40, v168, -v239
    v_fmac_f32 v243, v33, v153
    v_fmac_f32 v239, v41, v169
    v_fmac_f32 v243, v34, v154
    v_fmac_f32 v239, v42, v170
    v_fmac_f32 v243, v35, v155
    v_fmac_f32 v239, v43, v171
    v_fmac_f32 v243, v36, v156
    v_fmac_f32 v239, v44, v172
    v_fmac_f32 v243, v37, v157
    v_fmac_f32 v239, v45, v173
    v_fmac_f32 v243, v38, v158
    v_fmac_f32 v239, v46, v174
    v_fmac_f32 v243, v39, v159
    v_fmac_f32 v239, v47, v175
    v_fmac_f32 v237, v48, v120
    v_mul_f32 v245, v56, v168
    s_setprio 1
    s_waitcnt vmcnt(4) lgkmcnt(0)
    v_mfma_f32_32x32x16_bf16 v[0:15], v[64:67], v[176:179], 0
    ds_read_b64_tr_b16 v[184:185], v246 offset:6144
    ds_read_b64_tr_b16 v[186:187], v246 offset:7168
    ds_read_b64_tr_b16 v[188:189], v247 offset:6144
    ds_read_b64_tr_b16 v[190:191], v247 offset:7168
    v_fmac_f32 v237, v49, v121
    v_fmac_f32 v245, v57, v169
    s_mov_b32 m0, s70
    v_mfma_f32_32x32x16_bf16 v[16:31], v[68:71], v[176:179], 0
    buffer_load_dwordx4 v226, s[4:7], s46 offen sc1 lds
    buffer_load_dwordx4 v227, s[72:75], s46 offen offset:1024 sc1 lds
    v_fmac_f32 v237, v50, v122
    v_fmac_f32 v245, v58, v170
    v_fmac_f32 v237, v51, v123
    v_fmac_f32 v245, v59, v171
    v_fmac_f32 v237, v52, v124
    v_mfma_f32_32x32x16_bf16 v[32:47], v[64:67], v[180:183], 0
    v_fmac_f32 v245, v60, v172
    v_fmac_f32 v237, v53, v125
    v_fmac_f32 v245, v61, v173
    v_fmac_f32 v237, v54, v126
    v_fmac_f32 v245, v62, v174
    v_fmac_f32 v237, v55, v127
    v_fmac_f32 v245, v63, v175
    v_mfma_f32_32x32x16_bf16 v[48:63], v[68:71], v[180:183], 0
    v_permlane32_swap_b32 v242, v234
    v_permlane32_swap_b32 v243, v235
    v_add_f32 v242, v242, v234
    v_add_f32 v243, v243, v235
    s_waitcnt vmcnt(4) lgkmcnt(0)
    v_mfma_f32_32x32x16_bf16 v[0:15], v[72:75], v[184:187], v[0:15]
    ds_read_b64_tr_b16 v[176:177], v246 offset:0
    ds_read_b64_tr_b16 v[178:179], v246 offset:1024
    ds_read_b64_tr_b16 v[180:181], v247 offset:0
    ds_read_b64_tr_b16 v[182:183], v247 offset:1024
    s_sub_u32 s26, s48, s29
    s_mov_b32 s29, s48
    s_mov_b32 m0, s71
    v_mfma_f32_32x32x16_bf16 v[16:31], v[76:79], v[184:187], v[16:31]
    s_cmp_eq_u32 s33, 4
    s_cbranch_scc1 K2_g4_19
    buffer_load_dwordx4 v224, s[4:7], s47 offen sc1 lds
    buffer_load_dwordx4 v225, s[72:75], s47 offen offset:1024 sc1 lds
K2_back_20:
    s_set_gpr_idx_on s31, gpr_idx(DST)
    s_nop 0
    v_cvt_pk_bf16_f32 v194, v242, v243
    s_set_gpr_idx_off
    s_mov_b32 s30, s3
    s_bfe_u32 s56, s3, 0x40012
    s_cmp_eq_u32 s34, 0
    s_cselect_b32 s56, s56, 0
    v_mfma_f32_32x32x16_bf16 v[32:47], v[72:75], v[188:191], v[32:47]
    s_mov_b32 s32, s31
    s_mov_b32 s31, s35
    v_mul_f32 v242, v0, v144
    v_fma_f32 v240, v8, v160, -v240
    v_fmac_f32 v242, v1, v145
    v_fmac_f32 v240, v9, v161
    v_fmac_f32 v242, v2, v146
    v_mfma_f32_32x32x16_bf16 v[48:63], v[76:79], v[188:191], v[48:63]
    s_setprio 0
    v_fmac_f32 v240, v10, v162
    v_fmac_f32 v242, v3, v147
    v_fmac_f32 v240, v11, v163
    v_fmac_f32 v242, v4, v148
    v_fmac_f32 v240, v12, v164
    v_fmac_f32 v242, v5, v149
    v_fmac_f32 v240, v13, v165
    v_fmac_f32 v242, v6, v150
    v_fmac_f32 v240, v14, v166
    v_fmac_f32 v242, v7, v151
    v_fmac_f32 v240, v15, v167
    v_add_u32 v249, s26, v249
    v_add_u32 v250, s26, v250
    v_fma_f32 v244, v16, v160, -v244
    v_fmac_f32 v236, v24, v112
    v_fmac_f32 v244, v17, v161
    v_fmac_f32 v236, v25, v113
    v_fmac_f32 v244, v18, v162
    v_fmac_f32 v236, v26, v114
    v_fmac_f32 v244, v19, v163
    v_fmac_f32 v236, v27, v115
    v_fmac_f32 v244, v20, v164
    v_fmac_f32 v236, v28, v116
    v_fmac_f32 v244, v21, v165
    v_fmac_f32 v236, v29, v117
    v_fmac_f32 v244, v22, v166
    v_fmac_f32 v236, v30, v118
    v_fmac_f32 v244, v23, v167
    v_fmac_f32 v236, v31, v119
    ds_read_b64_tr_b16 v[0:1], v249 offset:0
    ds_read_b64_tr_b16 v[2:3], v249 offset:32
    ds_read_u16_d16_hi v16, v250 offset:0
    v_mul_f32 v243, v32, v152
    v_fma_f32 v241, v40, v168, -v241
    v_fmac_f32 v243, v33, v153
    v_fmac_f32 v241, v41, v169
    v_fmac_f32 v243, v34, v154
    v_fmac_f32 v241, v42, v170
    v_fmac_f32 v243, v35, v155
    v_fmac_f32 v241, v43, v171
    v_fmac_f32 v243, v36, v156
    v_fmac_f32 v241, v44, v172
    v_fmac_f32 v243, v37, v157
    v_fmac_f32 v241, v45, v173
    v_fmac_f32 v243, v38, v158
    v_fmac_f32 v241, v46, v174
    v_fmac_f32 v243, v39, v159
    v_fmac_f32 v241, v47, v175
    ds_read_b64_tr_b16 v[4:5], v249 offset:512
    ds_read_b64_tr_b16 v[6:7], v249 offset:544
    ds_read_u16_d16_hi v17, v250 offset:128
    v_fma_f32 v245, v48, v168, -v245
    v_fmac_f32 v237, v56, v120
    v_fmac_f32 v245, v49, v169
    v_fmac_f32 v237, v57, v121
    v_fmac_f32 v245, v50, v170
    v_fmac_f32 v237, v58, v122
    v_fmac_f32 v245, v51, v171
    v_fmac_f32 v237, v59, v123
    v_fmac_f32 v245, v52, v172
    v_fmac_f32 v237, v60, v124
    v_fmac_f32 v245, v53, v173
    v_fmac_f32 v237, v61, v125
    v_fmac_f32 v245, v54, v174
    v_fmac_f32 v237, v62, v126
    v_fmac_f32 v245, v55, v175
    v_fmac_f32 v237, v63, v127
    s_cmp_eq_u32 s56, 5
    s_cbranch_scc1 K2_U20
    s_cmp_eq_u32 s56, 6
    s_cbranch_scc1 K2_U3h0
    s_branch K2_DSP0
K2_PAD_U30:
    s_branch K2_HOP
K2_U3h0:
    s_setprio 1
    ds_read_b64_tr_b16 v[8:9], v249 offset:1024
    ds_read_u16_d16_hi v18, v250 offset:256
    s_waitcnt lgkmcnt(2)
    v_lshlrev_b32 v20, 16, v0
    v_and_b32 v21, 0xffff0000, v0
    v_lshlrev_b32 v22, 16, v1
    v_and_b32 v23, 0xffff0000, v1
    v_lshlrev_b32 v24, 16, v2
    v_and_b32 v25, 0xffff0000, v2
    v_lshlrev_b32 v26, 16, v3
    v_and_b32 v27, 0xffff0000, v3
    v_mul_f32_dpp v36, v16, v20 row_newbcast:8 row_mask:0xf bank_mask:0xf
    v_mul_f32_dpp v37, v16, v21 row_newbcast:9 row_mask:0xf bank_mask:0xf
    v_mul_f32_dpp v38, v16, v22 row_newbcast:10 row_mask:0xf bank_mask:0xf
    v_mul_f32_dpp v39, v16, v23 row_newbcast:11 row_mask:0xf bank_mask:0xf
    v_mul_f32_dpp v40, v16, v24 row_newbcast:12 row_mask:0xf bank_mask:0xf
    v_mul_f32_dpp v41, v16, v25 row_newbcast:13 row_mask:0xf bank_mask:0xf
    v_mul_f32_dpp v42, v16, v26 row_newbcast:14 row_mask:0xf bank_mask:0xf
    v_mul_f32_dpp v43, v16, v27 row_newbcast:15 row_mask:0xf bank_mask:0xf
    v_cvt_pk_bf16_f32 v68, v36, v37
    v_cvt_pk_bf16_f32 v69, v38, v39
    v_cvt_pk_bf16_f32 v70, v40, v41
    v_cvt_pk_bf16_f32 v71, v42, v43
    v_mul_f32_dpp v20, v16, v20 row_newbcast:0 row_mask:0xa bank_mask:0xf
    v_mul_f32_dpp v21, v16, v21 row_newbcast:1 row_mask:0xa bank_mask:0xf
    v_mul_f32_dpp v22, v16, v22 row_newbcast:2 row_mask:0xa bank_mask:0xf
    v_mul_f32_dpp v23, v16, v23 row_newbcast:3 row_mask:0xa bank_mask:0xf
    v_mul_f32_dpp v24, v16, v24 row_newbcast:4 row_mask:0xa bank_mask:0xf
    v_mul_f32_dpp v25, v16, v25 row_newbcast:5 row_mask:0xa bank_mask:0xf
    v_mul_f32_dpp v26, v16, v26 row_newbcast:6 row_mask:0xa bank_mask:0xf
    v_mul_f32_dpp v27, v16, v27 row_newbcast:7 row_mask:0xa bank_mask:0xf
    v_cvt_pk_bf16_f32 v64, v20, v21
    v_cvt_pk_bf16_f32 v65, v22, v23
    v_cvt_pk_bf16_f32 v66, v24, v25
    v_cvt_pk_bf16_f32 v67, v26, v27
    v_lshlrev_b32 v28, 16, v4
    v_and_b32 v29, 0xffff0000, v4
    v_lshlrev_b32 v30, 16, v5
    v_and_b32 v31, 0xffff0000, v5
    v_lshlrev_b32 v32, 16, v6
    v_and_b32 v33, 0xffff0000, v6
    v_lshlrev_b32 v34, 16, v7
    v_and_b32 v35, 0xffff0000, v7
    v_mul_f32_dpp v36, v17, v28 row_newbcast:8 row_mask:0xf bank_mask:0xf
    v_mul_f32_dpp v37, v17, v29 row_newbcast:9 row_mask:0xf bank_mask:0xf
    v_mul_f32_dpp v38, v17, v30 row_newbcast:10 row_mask:0xf bank_mask:0xf
    v_mul_f32_dpp v39, v17, v31 row_newbcast:11 row_mask:0xf bank_mask:0xf
    v_mul_f32_dpp v40, v17, v32 row_newbcast:12 row_mask:0xf bank_mask:0xf
    v_mul_f32_dpp v41, v17, v33 row_newbcast:13 row_mask:0xf bank_mask:0xf
    v_mul_f32_dpp v42, v17, v34 row_newbcast:14 row_mask:0xf bank_mask:0xf
    v_mul_f32_dpp v43, v17, v35 row_newbcast:15 row_mask:0xf bank_mask:0xf
    v_cvt_pk_bf16_f32 v76, v36, v37
    v_cvt_pk_bf16_f32 v77, v38, v39
    v_cvt_pk_bf16_f32 v78, v40, v41
    v_cvt_pk_bf16_f32 v79, v42, v43
    v_mul_f32_dpp v28, v17, v28 row_newbcast:0 row_mask:0xa bank_mask:0xf
    v_mul_f32_dpp v29, v17, v29 row_newbcast:1 row_mask:0xa bank_mask:0xf
    v_mul_f32_dpp v30, v17, v30 row_newbcast:2 row_mask:0xa bank_mask:0xf
    v_mul_f32_dpp v31, v17, v31 row_newbcast:3 row_mask:0xa bank_mask:0xf
    v_mul_f32_dpp v32, v17, v32 row_newbcast:4 row_mask:0xa bank_mask:0xf
    v_mul_f32_dpp v33, v17, v33 row_newbcast:5 row_mask:0xa bank_mask:0xf
    v_mul_f32_dpp v34, v17, v34 row_newbcast:6 row_mask:0xa bank_mask:0xf
    v_mul_f32_dpp v35, v17, v35 row_newbcast:7 row_mask:0xa bank_mask:0xf
    v_cvt_pk_bf16_f32 v72, v28, v29
    v_cvt_pk_bf16_f32 v73, v30, v31
    v_cvt_pk_bf16_f32 v74, v32, v33
    v_cvt_pk_bf16_f32 v75, v34, v35
    s_waitcnt lgkmcnt(0)
    v_lshlrev_b32 v20, 16, v8
    v_and_b32 v21, 0xffff0000, v8
    v_lshlrev_b32 v22, 16, v9
    v_and_b32 v23, 0xffff0000, v9
    v_mul_f32_dpp v36, v18, v20 row_newbcast:8 row_mask:0xf bank_mask:0xf
    v_mul_f32_dpp v37, v18, v21 row_newbcast:9 row_mask:0xf bank_mask:0xf
    v_mul_f32_dpp v38, v18, v22 row_newbcast:10 row_mask:0xf bank_mask:0xf
    v_mul_f32_dpp v39, v18, v23 row_newbcast:11 row_mask:0xf bank_mask:0xf
    v_cvt_pk_bf16_f32 v84, v36, v37
    v_cvt_pk_bf16_f32 v85, v38, v39
    v_mul_f32_dpp v20, v18, v20 row_newbcast:0 row_mask:0xa bank_mask:0xf
    v_mul_f32_dpp v21, v18, v21 row_newbcast:1 row_mask:0xa bank_mask:0xf
    v_mul_f32_dpp v22, v18, v22 row_newbcast:2 row_mask:0xa bank_mask:0xf
    v_mul_f32_dpp v23, v18, v23 row_newbcast:3 row_mask:0xa bank_mask:0xf
    v_cvt_pk_bf16_f32 v80, v20, v21
    v_cvt_pk_bf16_f32 v81, v22, v23
    s_waitcnt vmcnt(4)
    v_mfma_f32_32x32x16_bf16 v[0:15], v[64:67], v[176:179], 0
    ds_read_b64_tr_b16 v[184:185], v246 offset:2048
    ds_read_b64_tr_b16 v[186:187], v246 offset:3072
    ds_read_b64_tr_b16 v[188:189], v247 offset:2048
    ds_read_b64_tr_b16 v[190:191], v247 offset:3072
    s_mov_b32 m0, s68
    v_mfma_f32_32x32x16_bf16 v[16:31], v[68:71], v[176:179], 0
    buffer_load_dwordx4 v222, s[4:7], s41 offen sc1 lds
    buffer_load_dwordx4 v223, s[72:75], s41 offen offset:1024 sc1 lds
    v_permlane32_swap_b32 v242, v236
    v_permlane32_swap_b32 v243, v237
    s_add_u32 s38, s38, 1
    v_mfma_f32_32x32x16_bf16 v[32:47], v[64:67], v[180:183], 0
    v_permlane32_swap_b32 v244, v238
    v_permlane32_swap_b32 v245, v239
    v_permlane32_swap_b32 v240, v241
    v_add_f32 v242, v242, v236
    v_mfma_f32_32x32x16_bf16 v[48:63], v[68:71], v[180:183], 0
    v_add_f32 v243, v243, v237
    v_add_f32 v244, v244, v238
    v_add_f32 v245, v245, v239
    v_add_f32 v240, -v240, -v241
    v_mov_b32 v254, s52
    v_mov_b32 v255, s38
    s_waitcnt vmcnt(4) lgkmcnt(0)
    v_mfma_f32_32x32x16_bf16 v[0:15], v[72:75], v[184:187], v[0:15]
    ds_read_b64_tr_b16 v[176:177], v246 offset:4096
    ds_read_b64_tr_b16 v[180:181], v247 offset:4096
    s_lshl_b32 s58, s38, 3
    s_add_u32 s58, s58, s20
    s_mov_b32 m0, s69
    v_mfma_f32_32x32x16_bf16 v[16:31], v[76:79], v[184:187], v[16:31]
    buffer_load_dwordx4 v226, s[4:7], s41 offen sc1 lds
    s_set_gpr_idx_on s32, gpr_idx(DST)
    s_nop 0
    v_cvt_pk_bf16_f32 v195, v242, v243
    v_cvt_pk_bf16_f32 v196, v244, v245
    v_cvt_pk_bf16_f32 v197, v240, v240
    s_set_gpr_idx_off
    s_mov_b64 exec, 1
    ds_write_b32 v254, v255
    s_mov_b64 exec, -1
    s_cmp_lt_u32 s58, s22
    s_cbranch_scc0 K2_dyn_25
K2_back_26:
    v_readlane_b32 s3, v253, s58
    s_lshl_b32 s44, s34, 7
    s_and_b32 s48, s3, 0x3ffff
    s_bfe_u32 s33, s3, 0x30013
    s_mul_i32 s35, s38, 6
    s_cmp_eq_u32 s34, 0
    s_cselect_b32 s35, s35, s48
    s_mov_b32 s45, s44
    s_xor_b32 s47, s44, 256
    s_add_u32 s49, s48, 128
    s_add_u32 s60, s48, 256
    s_cmp_eq_u32 s33, 3
    s_cselect_b32 s46, s44, s47
    s_cselect_b32 s50, s60, s48
    s_sub_u32 s60, s33, 2
    s_cmp_lt_u32 s60, 2
    s_cbranch_scc0 K2_rare_31
K2_back_32:
    v_mfma_f32_32x32x16_bf16 v[32:47], v[72:75], v[188:191], v[32:47]
    v_add_u32 v233, s48, v230
    ds_read_b32 v232, v233
    ds_read_b32 v233, v233 offset:1024
    v_mfma_f32_32x32x16_bf16 v[48:63], v[76:79], v[188:191], v[48:63]
    s_waitcnt vmcnt(3) lgkmcnt(3)
    v_mfma_f32_32x32x8_bf16 v[0:15], v[80:81], v[176:177], v[0:15]
    ds_read_b64_tr_b16 v[184:185], v246 offset:6144
    ds_read_b64_tr_b16 v[186:187], v246 offset:7168
    ds_read_b64_tr_b16 v[188:189], v247 offset:6144
    ds_read_b64_tr_b16 v[190:191], v247 offset:7168
    s_mov_b32 m0, s70
    v_mfma_f32_32x32x8_bf16 v[16:31], v[84:85], v[176:177], v[16:31]
    buffer_load_dwordx4 v222, s[4:7], s42 offen sc1 lds
    buffer_load_dwordx4 v223, s[72:75], s42 offen offset:1024 sc1 lds
    v_mfma_f32_32x32x8_bf16 v[32:47], v[80:81], v[180:181], v[32:47]
    s_nop 2
    v_mul_f32 v234, v0, v96
    v_mul_f32 v236, v8, v128
    v_fmac_f32 v234, v1, v97
    v_fmac_f32 v236, v9, v129
    v_fmac_f32 v234, v2, v98
    v_fmac_f32 v236, v10, v130
    v_fmac_f32 v234, v3, v99
    v_mfma_f32_32x32x8_bf16 v[48:63], v[84:85], v[180:181], v[48:63]
    s_setprio 0
    s_waitcnt lgkmcnt(4)
    v_or_b32 v232, v232, v231
    v_or_b32 v233, v233, v231
    s_cmp_lg_u32 s34, 0
    s_cbranch_scc1 K2_dum_36
    s_cmp_eq_u32 s33, 4
    s_cbranch_scc1 K2_a4_37
K2_b4_39:
    s_add_u32 m0, s48, 512
    s_add_u32 s65, s48, 1536
    buffer_load_dwordx4 v232, s[16:19], 0 offen  lds
    s_mov_b32 m0, s65
    s_mov_b32 exec_hi, 0
    buffer_load_dwordx4 v233, s[16:19], 0 offen  lds
    s_mov_b32 exec_hi, -1
K2_back_38:
    v_fmac_f32 v236, v11, v131
    v_fmac_f32 v234, v4, v100
    v_fmac_f32 v236, v12, v132
    v_fmac_f32 v234, v5, v101
    v_fmac_f32 v236, v13, v133
    v_fmac_f32 v234, v6, v102
    v_fmac_f32 v236, v14, v134
    v_fmac_f32 v234, v7, v103
    v_fmac_f32 v236, v15, v135
    v_mul_f32 v238, v16, v128
    v_mul_f32 v240, v24, v128
    v_fmac_f32 v238, v17, v129
    v_fmac_f32 v240, v25, v129
    v_fmac_f32 v238, v18, v130
    v_fmac_f32 v240, v26, v130
    v_fmac_f32 v238, v19, v131
    v_fmac_f32 v240, v27, v131
    v_fmac_f32 v238, v20, v132
    v_fmac_f32 v240, v28, v132
    v_fmac_f32 v238, v21, v133
    v_fmac_f32 v240, v29, v133
    v_fmac_f32 v238, v22, v134
    v_fmac_f32 v240, v30, v134
    v_fmac_f32 v238, v23, v135
    v_fmac_f32 v240, v31, v135
    v_mul_f32 v235, v32, v104
    v_mul_f32 v237, v40, v136
    v_fmac_f32 v235, v33, v105
    v_fmac_f32 v237, v41, v137
    v_fmac_f32 v235, v34, v106
    v_fmac_f32 v237, v42, v138
    v_fmac_f32 v235, v35, v107
    v_fmac_f32 v237, v43, v139
    v_fmac_f32 v235, v36, v108
    v_fmac_f32 v237, v44, v140
    v_fmac_f32 v235, v37, v109
    v_fmac_f32 v237, v45, v141
    v_fmac_f32 v235, v38, v110
    v_fmac_f32 v237, v46, v142
    v_fmac_f32 v235, v39, v111
    v_fmac_f32 v237, v47, v143
    v_mul_f32 v239, v48, v136
    v_mul_f32 v241, v56, v136
    s_setprio 1
    s_waitcnt vmcnt(5) lgkmcnt(0)
    v_mfma_f32_32x32x16_bf16 v[0:15], v[72:75], v[184:187], 0
    ds_read_b64_tr_b16 v[176:177], v246 offset:0
    ds_read_b64_tr_b16 v[178:179], v246 offset:1024
    ds_read_b64_tr_b16 v[180:181], v247 offset:0
    ds_read_b64_tr_b16 v[182:183], v247 offset:1024
    v_fmac_f32 v239, v49, v137
    v_fmac_f32 v241, v57, v137
    s_mov_b32 m0, s71
    v_mfma_f32_32x32x16_bf16 v[16:31], v[76:79], v[184:187], 0
    buffer_load_dwordx4 v224, s[4:7], s42 offen sc1 lds
    buffer_load_dwordx4 v225, s[72:75], s42 offen offset:1024 sc1 lds
    v_fmac_f32 v239, v50, v138
    v_fmac_f32 v241, v58, v138
    v_fmac_f32 v239, v51, v139
    v_fmac_f32 v241, v59, v139
    v_fmac_f32 v239, v52, v140
    v_mfma_f32_32x32x16_bf16 v[32:47], v[72:75], v[188:191], 0
    v_fmac_f32 v241, v60, v140
    v_fmac_f32 v239, v53, v141
    v_fmac_f32 v241, v61, v141
    v_fmac_f32 v239, v54, v142
    v_fmac_f32 v241, v62, v142
    v_fmac_f32 v239, v55, v143
    v_fmac_f32 v241, v63, v143
    v_mfma_f32_32x32x16_bf16 v[48:63], v[76:79], v[188:191], 0
    v_permlane32_swap_b32 v234, v236
    v_permlane32_swap_b32 v235, v237
    v_permlane32_swap_b32 v240, v238
    s_waitcnt vmcnt(6) lgkmcnt(0)
    v_mfma_f32_32x32x16_bf16 v[0:15], v[64:67], v[176:179], v[0:15]
    ds_read_b64_tr_b16 v[184:185], v246 offset:2048
    ds_read_b64_tr_b16 v[188:189], v247 offset:2048
    v_permlane32_swap_b32 v241, v239
    v_add_f32 v234, v234, v236
    v_add_f32 v235, v235, v237
    s_mov_b32 m0, s68
    v_mfma_f32_32x32x16_bf16 v[16:31], v[68:71], v[176:179], v[16:31]
    buffer_load_dwordx4 v226, s[4:7], s42 offen sc1 lds
    v_add_f32 v240, v240, v238
    v_add_f32 v241, v241, v239
    s_set_gpr_idx_on s31, gpr_idx(DST)
    s_nop 0
    v_cvt_pk_bf16_f32 v192, v234, v235
    v_cvt_pk_bf16_f32 v193, v240, v241
    s_set_gpr_idx_off
    v_mfma_f32_32x32x16_bf16 v[32:47], v[64:67], v[180:183], v[32:47]
    v_mfma_f32_32x32x16_bf16 v[48:63], v[68:71], v[180:183], v[48:63]
    s_waitcnt vmcnt(5) lgkmcnt(0)
    v_mfma_f32_32x32x8_bf16 v[0:15], v[80:81], v[184:185], v[0:15]
    ds_read_b64_tr_b16 v[176:177], v246 offset:4096
    ds_read_b64_tr_b16 v[178:179], v246 offset:5120
    ds_read_b64_tr_b16 v[180:181], v247 offset:4096
    ds_read_b64_tr_b16 v[182:183], v247 offset:5120
    s_mov_b32 m0, s69
    v_mfma_f32_32x32x8_bf16 v[16:31], v[84:85], v[184:185], v[16:31]
    buffer_load_dwordx4 v222, s[4:7], s43 offen sc1 lds
    buffer_load_dwordx4 v223, s[72:75], s43 offen offset:1024 sc1 lds
    v_mfma_f32_32x32x8_bf16 v[32:47], v[80:81], v[188:189], v[32:47]
    s_nop 2
    v_mul_f32 v234, v0, v144
    v_mul_f32 v236, v8, v112
    v_fmac_f32 v234, v1, v145
    v_fmac_f32 v236, v9, v113
    v_fmac_f32 v234, v2, v146
    v_fmac_f32 v236, v10, v114
    v_fmac_f32 v234, v3, v147
    v_mfma_f32_32x32x8_bf16 v[48:63], v[84:85], v[188:189], v[48:63]
    s_setprio 0
    v_fmac_f32 v236, v11, v115
    v_fmac_f32 v234, v4, v148
    v_fmac_f32 v236, v12, v116
    v_fmac_f32 v234, v5, v149
    v_fmac_f32 v236, v13, v117
    v_fmac_f32 v234, v6, v150
    v_fmac_f32 v236, v14, v118
    v_fmac_f32 v234, v7, v151
    v_fmac_f32 v236, v15, v119
    v_mul_f32 v238, v16, v160
    v_mul_f32 v240, v24, v160
    v_fmac_f32 v238, v17, v161
    v_fmac_f32 v240, v25, v161
    v_fmac_f32 v238, v18, v162
    v_fmac_f32 v240, v26, v162
    v_fmac_f32 v238, v19, v163
    v_fmac_f32 v240, v27, v163
    v_fmac_f32 v238, v20, v164
    v_fmac_f32 v240, v28, v164
    v_fmac_f32 v238, v21, v165
    v_fmac_f32 v240, v29, v165
    v_fmac_f32 v238, v22, v166
    v_fmac_f32 v240, v30, v166
    v_fmac_f32 v238, v23, v167
    v_fmac_f32 v240, v31, v167
    v_mul_f32 v235, v32, v152
    v_mul_f32 v237, v40, v120
    v_fmac_f32 v235, v33, v153
    v_fmac_f32 v237, v41, v121
    v_fmac_f32 v235, v34, v154
    v_fmac_f32 v237, v42, v122
    v_fmac_f32 v235, v35, v155
    v_fmac_f32 v237, v43, v123
    v_fmac_f32 v235, v36, v156
    v_fmac_f32 v237, v44, v124
    v_fmac_f32 v235, v37, v157
    v_fmac_f32 v237, v45, v125
    v_fmac_f32 v235, v38, v158
    v_fmac_f32 v237, v46, v126
    v_fmac_f32 v235, v39, v159
    v_fmac_f32 v237, v47, v127
    v_mul_f32 v239, v48, v168
    v_mul_f32 v241, v56, v168
    v_fmac_f32 v239, v49, v169
    v_fmac_f32 v241, v57, v169
    s_setprio 1
    s_waitcnt vmcnt(3) lgkmcnt(0)
    v_mfma_f32_32x32x16_bf16 v[0:15], v[64:67], v[176:179], 0
    ds_read_b64_tr_b16 v[184:185], v246 offset:6144
    ds_read_b64_tr_b16 v[186:187], v246 offset:7168
    ds_read_b64_tr_b16 v[188:189], v247 offset:6144
    ds_read_b64_tr_b16 v[190:191], v247 offset:7168
    v_fmac_f32 v239, v50, v170
    v_fmac_f32 v241, v58, v170
    s_mov_b32 m0, s70
    v_mfma_f32_32x32x16_bf16 v[16:31], v[68:71], v[176:179], 0
    buffer_load_dwordx4 v224, s[4:7], s43 offen sc1 lds
    buffer_load_dwordx4 v225, s[72:75], s43 offen offset:1024 sc1 lds
    v_fmac_f32 v239, v51, v171
    v_fmac_f32 v241, v59, v171
    v_fmac_f32 v239, v52, v172
    v_fmac_f32 v241, v60, v172
    v_fmac_f32 v239, v53, v173
    v_mfma_f32_32x32x16_bf16 v[32:47], v[64:67], v[180:183], 0
    v_add_u32 v222, s48, v251
    ds_read2_b32 v[222:223], v222 offset0:1 offset1:3
    v_fmac_f32 v241, v61, v173
    v_fmac_f32 v239, v54, v174
    v_fmac_f32 v241, v62, v174
    v_fmac_f32 v239, v55, v175
    v_fmac_f32 v241, v63, v175
    v_mfma_f32_32x32x16_bf16 v[48:63], v[68:71], v[180:183], 0
    s_waitcnt vmcnt(4) lgkmcnt(1)
    v_mfma_f32_32x32x16_bf16 v[0:15], v[72:75], v[184:187], v[0:15]
    ds_read_b64_tr_b16 v[176:177], v246 offset:0
    ds_read_b64_tr_b16 v[180:181], v247 offset:0
    s_mov_b32 m0, s71
    v_mfma_f32_32x32x16_bf16 v[16:31], v[76:79], v[184:187], v[16:31]
    buffer_load_dwordx4 v226, s[4:7], s43 offen sc1 lds
    s_waitcnt lgkmcnt(2)
    v_mad_u32_u16 v222, v222, s39, v248 op_sel:[1,0,0,0]
    v_mad_u32_u16 v223, v223, s39, v248 op_sel:[1,0,0,0]
    v_mfma_f32_32x32x16_bf16 v[32:47], v[72:75], v[188:191], v[32:47]
    v_add_u32 v224, s49, v251
    ds_read2_b32 v[224:225], v224 offset0:1 offset1:3
    v_mfma_f32_32x32x16_bf16 v[48:63], v[76:79], v[188:191], v[48:63]
    s_waitcnt vmcnt(3) lgkmcnt(1)
    v_mfma_f32_32x32x8_bf16 v[0:15], v[80:81], v[176:177], v[0:15]
    ds_read_b64_tr_b16 v[184:185], v246 offset:2048
    ds_read_b64_tr_b16 v[186:187], v246 offset:3072
    ds_read_b64_tr_b16 v[188:189], v247 offset:2048
    ds_read_b64_tr_b16 v[190:191], v247 offset:3072
    s_mov_b32 m0, s68
    v_mfma_f32_32x32x8_bf16 v[16:31], v[84:85], v[176:177], v[16:31]
    buffer_load_dwordx4 v222, s[4:7], s44 offen sc1 lds
    buffer_load_dwordx4 v223, s[72:75], s44 offen offset:1024 sc1 lds
    s_waitcnt lgkmcnt(4)
    v_mad_u32_u16 v224, v224, s39, v248 op_sel:[1,0,0,0]
    v_mad_u32_u16 v225, v225, s39, v248 op_sel:[1,0,0,0]
    v_mfma_f32_32x32x8_bf16 v[32:47], v[80:81], v[180:181], v[32:47]
    v_add_u32 v226, s50, v251
    ds_read2_b32 v[226:227], v226 offset0:1 offset1:3
    v_mul_f32 v242, v0, v144
    v_fma_f32 v238, v8, v160, -v238
    v_fmac_f32 v242, v1, v145
    v_fmac_f32 v238, v9, v161
    v_fmac_f32 v242, v2, v146
    v_mfma_f32_32x32x8_bf16 v[48:63], v[84:85], v[180:181], v[48:63]
    s_setprio 0
    v_fmac_f32 v238, v10, v162
    v_fmac_f32 v242, v3, v147
    v_fmac_f32 v238, v11, v163
    v_fmac_f32 v242, v4, v148
    v_fmac_f32 v238, v12, v164
    v_fmac_f32 v242, v5, v149
    v_fmac_f32 v238, v13, v165
    v_fmac_f32 v242, v6, v150
    v_fmac_f32 v238, v14, v166
    v_fmac_f32 v242, v7, v151
    v_fmac_f32 v238, v15, v167
    v_fmac_f32 v236, v16, v112
    v_mul_f32 v244, v24, v160
    v_fmac_f32 v236, v17, v113
    v_fmac_f32 v244, v25, v161
    v_fmac_f32 v236, v18, v114
    v_fmac_f32 v244, v26, v162
    v_fmac_f32 v236, v19, v115
    v_fmac_f32 v244, v27, v163
    v_fmac_f32 v236, v20, v116
    v_fmac_f32 v244, v28, v164
    v_fmac_f32 v236, v21, v117
    v_fmac_f32 v244, v29, v165
    v_fmac_f32 v236, v22, v118
    v_fmac_f32 v244, v30, v166
    v_fmac_f32 v236, v23, v119
    v_fmac_f32 v244, v31, v167
    v_mul_f32 v243, v32, v152
    v_fma_f32 v239, v40, v168, -v239
    v_fmac_f32 v243, v33, v153
    v_fmac_f32 v239, v41, v169
    v_fmac_f32 v243, v34, v154
    v_fmac_f32 v239, v42, v170
    v_fmac_f32 v243, v35, v155
    v_fmac_f32 v239, v43, v171
    v_fmac_f32 v243, v36, v156
    v_fmac_f32 v239, v44, v172
    v_fmac_f32 v243, v37, v157
    v_fmac_f32 v239, v45, v173
    v_fmac_f32 v243, v38, v158
    v_fmac_f32 v239, v46, v174
    v_fmac_f32 v243, v39, v159
    v_fmac_f32 v239, v47, v175
    v_fmac_f32 v237, v48, v120
    v_mul_f32 v245, v56, v168
    v_fmac_f32 v237, v49, v121
    v_fmac_f32 v245, v57, v169
    v_fmac_f32 v237, v50, v122
    s_setprio 1
    s_waitcnt vmcnt(3) lgkmcnt(1)
    v_mfma_f32_32x32x16_bf16 v[0:15], v[64:67], v[184:187], 0
    ds_read_b64_tr_b16 v[176:177], v246 offset:4096
    ds_read_b64_tr_b16 v[178:179], v246 offset:5120
    ds_read_b64_tr_b16 v[180:181], v247 offset:4096
    ds_read_b64_tr_b16 v[182:183], v247 offset:5120
    v_fmac_f32 v245, v58, v170
    v_fmac_f32 v237, v51, v123
    s_mov_b32 m0, s69
    v_mfma_f32_32x32x16_bf16 v[16:31], v[68:71], v[184:187], 0
    buffer_load_dwordx4 v224, s[4:7], s45 offen sc1 lds
    buffer_load_dwordx4 v225, s[72:75], s45 offen offset:1024 sc1 lds
    s_waitcnt lgkmcnt(4)
    v_mad_u32_u16 v226, v226, s39, v248 op_sel:[1,0,0,0]
    v_mad_u32_u16 v227, v227, s39, v248 op_sel:[1,0,0,0]
    v_fmac_f32 v245, v59, v171
    v_fmac_f32 v237, v52, v124
    v_mfma_f32_32x32x16_bf16 v[32:47], v[64:67], v[188:191], 0
    v_fmac_f32 v245, v60, v172
    v_fmac_f32 v237, v53, v125
    v_fmac_f32 v245, v61, v173
    v_fmac_f32 v237, v54, v126
    v_fmac_f32 v245, v62, v174
    v_fmac_f32 v237, v55, v127
    v_fmac_f32 v245, v63, v175
    v_mfma_f32_32x32x16_bf16 v[48:63], v[68:71], v[188:191], 0
    v_permlane32_swap_b32 v242, v234
    v_permlane32_swap_b32 v243, v235
    v_add_f32 v242, v242, v234
    v_add_f32 v243, v243, v235
    s_waitcnt vmcnt(4) lgkmcnt(0)
    v_mfma_f32_32x32x16_bf16 v[0:15], v[72:75], v[176:179], v[0:15]
    ds_read_b64_tr_b16 v[184:185], v246 offset:6144
    ds_read_b64_tr_b16 v[188:189], v247 offset:6144
    s_set_gpr_idx_on s31, gpr_idx(DST)
    s_nop 0
    v_cvt_pk_bf16_f32 v194, v242, v243
    s_set_gpr_idx_off
    s_mov_b32 s32, s31
    s_mov_b32 m0, s70
    v_mfma_f32_32x32x16_bf16 v[16:31], v[76:79], v[176:179], v[16:31]
    buffer_load_dwordx4 v226, s[4:7], s46 offen sc1 lds
    buffer_load_dwordx4 v227, s[72:75], s46 offen offset:1024 sc1 lds
    s_sub_u32 s26, s48, s29
    s_mov_b32 s29, s48
    s_mov_b32 s30, s3
    s_bfe_u32 s56, s3, 0x40012
    s_mov_b32 s31, s35
    v_mfma_f32_32x32x16_bf16 v[32:47], v[72:75], v[180:183], v[32:47]
    s_cmp_eq_u32 s34, 0
    s_cselect_b32 s56, s56, 0
    v_mfma_f32_32x32x16_bf16 v[48:63], v[76:79], v[180:183], v[48:63]
    s_waitcnt vmcnt(4) lgkmcnt(0)
    v_mfma_f32_32x32x8_bf16 v[0:15], v[80:81], v[184:185], v[0:15]
    ds_read_b64_tr_b16 v[176:177], v246 offset:0
    ds_read_b64_tr_b16 v[178:179], v246 offset:1024
    ds_read_b64_tr_b16 v[180:181], v247 offset:0
    ds_read_b64_tr_b16 v[182:183], v247 offset:1024
    s_mov_b32 m0, s71
    v_mfma_f32_32x32x8_bf16 v[16:31], v[84:85], v[184:185], v[16:31]
    s_cmp_eq_u32 s33, 4
    s_cbranch_scc1 K2_g4_34
    buffer_load_dwordx4 v224, s[4:7], s47 offen sc1 lds
    buffer_load_dwordx4 v225, s[72:75], s47 offen offset:1024 sc1 lds
K2_back_35:
    v_mfma_f32_32x32x8_bf16 v[32:47], v[80:81], v[188:189], v[32:47]
    s_nop 0
    v_mul_f32 v242, v0, v144
    v_fma_f32 v240, v8, v160, -v240
    v_fmac_f32 v242, v1, v145
    v_fmac_f32 v240, v9, v161
    v_fmac_f32 v242, v2, v146
    v_fmac_f32 v240, v10, v162
    v_fmac_f32 v242, v3, v147
    v_mfma_f32_32x32x8_bf16 v[48:63], v[84:85], v[188:189], v[48:63]
    s_setprio 0
    v_fmac_f32 v240, v11, v163
    v_fmac_f32 v242, v4, v148
    v_fmac_f32 v240, v12, v164
    v_fmac_f32 v242, v5, v149
    v_fmac_f32 v240, v13, v165
    v_fmac_f32 v242, v6, v150
    v_fmac_f32 v240, v14, v166
    v_fmac_f32 v242, v7, v151
    v_fmac_f32 v240, v15, v167
    v_add_u32 v249, s26, v249
    v_add_u32 v250, s26, v250
    v_fma_f32 v244, v16, v160, -v244
    v_fmac_f32 v236, v24, v112
    v_fmac_f32 v244, v17, v161
    v_fmac_f32 v236, v25, v113
    v_fmac_f32 v244, v18, v162
    v_fmac_f32 v236, v26, v114
    v_fmac_f32 v244, v19, v163
    v_fmac_f32 v236, v27, v115
    v_fmac_f32 v244, v20, v164
    v_fmac_f32 v236, v28, v116
    v_fmac_f32 v244, v21, v165
    v_fmac_f32 v236, v29, v117
    v_fmac_f32 v244, v22, v166
    v_fmac_f32 v236, v30, v118
    v_fmac_f32 v244, v23, v167
    v_fmac_f32 v236, v31, v119
    ds_read_b64_tr_b16 v[0:1], v249 offset:0
    ds_read_b64_tr_b16 v[2:3], v249 offset:32
    ds_read_u16_d16_hi v16, v250 offset:0
    v_mul_f32 v243, v32, v152
    v_fma_f32 v241, v40, v168, -v241
    v_fmac_f32 v243, v33, v153
    v_fmac_f32 v241, v41, v169
    v_fmac_f32 v243, v34, v154
    v_fmac_f32 v241, v42, v170
    v_fmac_f32 v243, v35, v155
    v_fmac_f32 v241, v43, v171
    v_fmac_f32 v243, v36, v156
    v_fmac_f32 v241, v44, v172
    v_fmac_f32 v243, v37, v157
    v_fmac_f32 v241, v45, v173
    v_fmac_f32 v243, v38, v158
    v_fmac_f32 v241, v46, v174
    v_fmac_f32 v243, v39, v159
    v_fmac_f32 v241, v47, v175
    ds_read_b64_tr_b16 v[4:5], v249 offset:512
    ds_read_b64_tr_b16 v[6:7], v249 offset:544
    ds_read_u16_d16_hi v17, v250 offset:128
    v_fma_f32 v245, v48, v168, -v245
    v_fmac_f32 v237, v56, v120
    v_fmac_f32 v245, v49, v169
    v_fmac_f32 v237, v57, v121
    v_fmac_f32 v245, v50, v170
    v_fmac_f32 v237, v58, v122
    v_fmac_f32 v245, v51, v171
    v_fmac_f32 v237, v59, v123
    v_fmac_f32 v245, v52, v172
    v_fmac_f32 v237, v60, v124
    v_fmac_f32 v245, v53, v173
    v_fmac_f32 v237, v61, v125
    v_fmac_f32 v245, v54, v174
    v_fmac_f32 v237, v62, v126
    v_fmac_f32 v245, v55, v175
    v_fmac_f32 v237, v63, v127
    s_cmp_eq_u32 s56, 5
    s_cbranch_scc1 K2_U20
    s_cmp_eq_u32 s56, 6
    s_cbranch_scc1 K2_U3h0
    s_branch K2_DSP0
K2_U30:
    s_setprio 1
    ds_read_b64_tr_b16 v[8:9], v249 offset:1024
    ds_read_b64_tr_b16 v[10:11], v249 offset:1056
    ds_read_u16_d16_hi v18, v250 offset:256
    s_waitcnt lgkmcnt(3)
    v_lshlrev_b32 v20, 16, v0
    v_and_b32 v21, 0xffff0000, v0
    v_lshlrev_b32 v22, 16, v1
    v_and_b32 v23, 0xffff0000, v1
    v_lshlrev_b32 v24, 16, v2
    v_and_b32 v25, 0xffff0000, v2
    v_lshlrev_b32 v26, 16, v3
    v_and_b32 v27, 0xffff0000, v3
    v_mul_f32_dpp v36, v16, v20 row_newbcast:8 row_mask:0xf bank_mask:0xf
    v_mul_f32_dpp v37, v16, v21 row_newbcast:9 row_mask:0xf bank_mask:0xf
    v_mul_f32_dpp v38, v16, v22 row_newbcast:10 row_mask:0xf bank_mask:0xf
    v_mul_f32_dpp v39, v16, v23 row_newbcast:11 row_mask:0xf bank_mask:0xf
    v_mul_f32_dpp v40, v16, v24 row_newbcast:12 row_mask:0xf bank_mask:0xf
    v_mul_f32_dpp v41, v16, v25 row_newbcast:13 row_mask:0xf bank_mask:0xf
    v_mul_f32_dpp v42, v16, v26 row_newbcast:14 row_mask:0xf bank_mask:0xf
    v_mul_f32_dpp v43, v16, v27 row_newbcast:15 row_mask:0xf bank_mask:0xf
    v_cvt_pk_bf16_f32 v68, v36, v37
    v_cvt_pk_bf16_f32 v69, v38, v39
    v_cvt_pk_bf16_f32 v70, v40, v41
    v_cvt_pk_bf16_f32 v71, v42, v43
    v_mul_f32_dpp v20, v16, v20 row_newbcast:0 row_mask:0xa bank_mask:0xf
    v_mul_f32_dpp v21, v16, v21 row_newbcast:1 row_mask:0xa bank_mask:0xf
    v_mul_f32_dpp v22, v16, v22 row_newbcast:2 row_mask:0xa bank_mask:0xf
    v_mul_f32_dpp v23, v16, v23 row_newbcast:3 row_mask:0xa bank_mask:0xf
    v_mul_f32_dpp v24, v16, v24 row_newbcast:4 row_mask:0xa bank_mask:0xf
    v_mul_f32_dpp v25, v16, v25 row_newbcast:5 row_mask:0xa bank_mask:0xf
    v_mul_f32_dpp v26, v16, v26 row_newbcast:6 row_mask:0xa bank_mask:0xf
    v_mul_f32_dpp v27, v16, v27 row_newbcast:7 row_mask:0xa bank_mask:0xf
    v_cvt_pk_bf16_f32 v64, v20, v21
    v_cvt_pk_bf16_f32 v65, v22, v23
    v_cvt_pk_bf16_f32 v66, v24, v25
    v_cvt_pk_bf16_f32 v67, v26, v27
    v_lshlrev_b32 v28, 16, v4
    v_and_b32 v29, 0xffff0000, v4
    v_lshlrev_b32 v30, 16, v5
    v_and_b32 v31, 0xffff0000, v5
    v_lshlrev_b32 v32, 16, v6
    v_and_b32 v33, 0xffff0000, v6
    v_lshlrev_b32 v34, 16, v7
    v_and_b32 v35, 0xffff0000, v7
    v_mul_f32_dpp v36, v17, v28 row_newbcast:8 row_mask:0xf bank_mask:0xf
    v_mul_f32_dpp v37, v17, v29 row_newbcast:9 row_mask:0xf bank_mask:0xf
    v_mul_f32_dpp v38, v17, v30 row_newbcast:10 row_mask:0xf bank_mask:0xf
    v_mul_f32_dpp v39, v17, v31 row_newbcast:11 row_mask:0xf bank_mask:0xf
    v_mul_f32_dpp v40, v17, v32 row_newbcast:12 row_mask:0xf bank_mask:0xf
    v_mul_f32_dpp v41, v17, v33 row_newbcast:13 row_mask:0xf bank_mask:0xf
    v_mul_f32_dpp v42, v17, v34 row_newbcast:14 row_mask:0xf bank_mask:0xf
    v_mul_f32_dpp v43, v17, v35 row_newbcast:15 row_mask:0xf bank_mask:0xf
    v_cvt_pk_bf16_f32 v76, v36, v37
    v_cvt_pk_bf16_f32 v77, v38, v39
    v_cvt_pk_bf16_f32 v78, v40, v41
    v_cvt_pk_bf16_f32 v79, v42, v43
    v_mul_f32_dpp v28, v17, v28 row_newbcast:0 row_mask:0xa bank_mask:0xf
    v_mul_f32_dpp v29, v17, v29 row_newbcast:1 row_mask:0xa bank_mask:0xf
    v_mul_f32_dpp v30, v17, v30 row_newbcast:2 row_mask:0xa bank_mask:0xf
    v_mul_f32_dpp v31, v17, v31 row_newbcast:3 row_mask:0xa bank_mask:0xf
    v_mul_f32_dpp v32, v17, v32 row_newbcast:4 row_mask:0xa bank_mask:0xf
    v_mul_f32_dpp v33, v17, v33 row_newbcast:5 row_mask:0xa bank_mask:0xf
    v_mul_f32_dpp v34, v17, v34 row_newbcast:6 row_mask:0xa bank_mask:0xf
    v_mul_f32_dpp v35, v17, v35 row_newbcast:7 row_mask:0xa bank_mask:0xf
    v_cvt_pk_bf16_f32 v72, v28, v29
    v_cvt_pk_bf16_f32 v73, v30, v31
    v_cvt_pk_bf16_f32 v74, v32, v33
    v_cvt_pk_bf16_f32 v75, v34, v35
    s_waitcnt lgkmcnt(0)
    v_lshlrev_b32 v20, 16, v8
    v_and_b32 v21, 0xffff0000, v8
    v_lshlrev_b32 v22, 16, v9
    v_and_b32 v23, 0xffff0000, v9
    v_lshlrev_b32 v24, 16, v10
    v_and_b32 v25, 0xffff0000, v10
    v_lshlrev_b32 v26, 16, v11
    v_and_b32 v27, 0xffff0000, v11
    v_mul_f32_dpp v36, v18, v20 row_newbcast:8 row_mask:0xf bank_mask:0xf
    v_mul_f32_dpp v37, v18, v21 row_newbcast:9 row_mask:0xf bank_mask:0xf
    v_mul_f32_dpp v38, v18, v22 row_newbcast:10 row_mask:0xf bank_mask:0xf
    v_mul_f32_dpp v39, v18, v23 row_newbcast:11 row_mask:0xf bank_mask:0xf
    v_mul_f32_dpp v40, v18, v24 row_newbcast:12 row_mask:0xf bank_mask:0xf
    v_mul_f32_dpp v41, v18, v25 row_newbcast:13 row_mask:0xf bank_mask:0xf
    v_mul_f32_dpp v42, v18, v26 row_newbcast:14 row_mask:0xf bank_mask:0xf
    v_mul_f32_dpp v43, v18, v27 row_newbcast:15 row_mask:0xf bank_mask:0xf
    v_cvt_pk_bf16_f32 v84, v36, v37
    v_cvt_pk_bf16_f32 v85, v38, v39
    v_cvt_pk_bf16_f32 v86, v40, v41
    v_cvt_pk_bf16_f32 v87, v42, v43
    v_mul_f32_dpp v20, v18, v20 row_newbcast:0 row_mask:0xa bank_mask:0xf
    v_mul_f32_dpp v21, v18, v21 row_newbcast:1 row_mask:0xa bank_mask:0xf
    v_mul_f32_dpp v22, v18, v22 row_newbcast:2 row_mask:0xa bank_mask:0xf
    v_mul_f32_dpp v23, v18, v23 row_newbcast:3 row_mask:0xa bank_mask:0xf
    v_mul_f32_dpp v24, v18, v24 row_newbcast:4 row_mask:0xa bank_mask:0xf
    v_mul_f32_dpp v25, v18, v25 row_newbcast:5 row_mask:0xa bank_mask:0xf
    v_mul_f32_dpp v26, v18, v26 row_newbcast:6 row_mask:0xa bank_mask:0xf
    v_mul_f32_dpp v27, v18, v27 row_newbcast:7 row_mask:0xa bank_mask:0xf
    v_cvt_pk_bf16_f32 v80, v20, v21
    v_cvt_pk_bf16_f32 v81, v22, v23
    v_cvt_pk_bf16_f32 v82, v24, v25
    v_cvt_pk_bf16_f32 v83, v26, v27
    s_waitcnt vmcnt(4)
    v_mfma_f32_32x32x16_bf16 v[0:15], v[64:67], v[176:179], 0
    ds_read_b64_tr_b16 v[184:185], v246 offset:2048
    ds_read_b64_tr_b16 v[186:187], v246 offset:3072
    ds_read_b64_tr_b16 v[188:189], v247 offset:2048
    ds_read_b64_tr_b16 v[190:191], v247 offset:3072
    s_mov_b32 m0, s68
    v_mfma_f32_32x32x16_bf16 v[16:31], v[68:71], v[176:179], 0
    buffer_load_dwordx4 v222, s[4:7], s41 offen sc1 lds
    buffer_load_dwordx4 v223, s[72:75], s41 offen offset:1024 sc1 lds
    v_permlane32_swap_b32 v242, v236
    v_permlane32_swap_b32 v243, v237
    s_add_u32 s38, s38, 1
    v_mfma_f32_32x32x16_bf16 v[32:47], v[64:67], v[180:183], 0
    v_permlane32_swap_b32 v244, v238
    v_permlane32_swap_b32 v245, v239
    v_permlane32_swap_b32 v240, v241
    v_add_f32 v242, v242, v236
    v_mfma_f32_32x32x16_bf16 v[48:63], v[68:71], v[180:183], 0
    v_add_f32 v243, v243, v237
    v_add_f32 v244, v244, v238
    v_add_f32 v245, v245, v239
    v_add_f32 v240, -v240, -v241
    v_mov_b32 v254, s52
    v_mov_b32 v255, s38
    s_waitcnt vmcnt(4) lgkmcnt(0)
    v_mfma_f32_32x32x16_bf16 v[0:15], v[72:75], v[184:187], v[0:15]
    ds_read_b64_tr_b16 v[176:177], v246 offset:4096
    ds_read_b64_tr_b16 v[178:179], v246 offset:5120
    ds_read_b64_tr_b16 v[180:181], v247 offset:4096
    ds_read_b64_tr_b16 v[182:183], v247 offset:5120
    s_lshl_b32 s58, s38, 3
    s_add_u32 s58, s58, s20
    s_mov_b32 m0, s69
    v_mfma_f32_32x32x16_bf16 v[16:31], v[76:79], v[184:187], v[16:31]
    buffer_load_dwordx4 v226, s[4:7], s41 offen sc1 lds
    buffer_load_dwordx4 v227, s[72:75], s41 offen offset:1024 sc1 lds
    s_set_gpr_idx_on s32, gpr_idx(DST)
    s_nop 0
    v_cvt_pk_bf16_f32 v195, v242, v243
    v_cvt_pk_bf16_f32 v196, v244, v245
    v_cvt_pk_bf16_f32 v197, v240, v240
    s_set_gpr_idx_off
    s_mov_b64 exec, 1
    ds_write_b32 v254, v255
    s_mov_b64 exec, -1
    s_cmp_lt_u32 s58, s22
    s_cbranch_scc0 K2_dyn_40
K2_back_41:
    v_readlane_b32 s3, v253, s58
    s_lshl_b32 s44, s34, 7
    s_and_b32 s48, s3, 0x3ffff
    s_bfe_u32 s33, s3, 0x30013
    s_mul_i32 s35, s38, 6
    s_cmp_eq_u32 s34, 0
    s_cselect_b32 s35, s35, s48
    s_mov_b32 s45, s44
    s_xor_b32 s47, s44, 256
    s_add_u32 s49, s48, 128
    s_add_u32 s60, s48, 256
    s_cmp_eq_u32 s33, 3
    s_cselect_b32 s46, s44, s47
    s_cselect_b32 s50, s60, s48
    s_sub_u32 s60, s33, 2
    s_cmp_lt_u32 s60, 2
    s_cbranch_scc0 K2_rare_46
K2_back_47:
    v_mfma_f32_32x32x16_bf16 v[32:47], v[72:75], v[188:191], v[32:47]
    v_add_u32 v233, s48, v230
    ds_read_b32 v232, v233
    ds_read_b32 v233, v233 offset:1024
    v_mfma_f32_32x32x16_bf16 v[48:63], v[76:79], v[188:191], v[48:63]
    s_waitcnt vmcnt(4) lgkmcnt(3)
    v_mfma_f32_32x32x16_bf16 v[0:15], v[80:83], v[176:179], v[0:15]
    ds_read_b64_tr_b16 v[184:185], v246 offset:6144
    ds_read_b64_tr_b16 v[186:187], v246 offset:7168
    ds_read_b64_tr_b16 v[188:189], v247 offset:6144
    ds_read_b64_tr_b16 v[190:191], v247 offset:7168
    s_mov_b32 m0, s70
    v_mfma_f32_32x32x16_bf16 v[16:31], v[84:87], v[176:179], v[16:31]
    buffer_load_dwordx4 v222, s[4:7], s42 offen sc1 lds
    buffer_load_dwordx4 v223, s[72:75], s42 offen offset:1024 sc1 lds
    v_mfma_f32_32x32x16_bf16 v[32:47], v[80:83], v[180:183], v[32:47]
    s_nop 2
    v_mul_f32 v234, v0, v96
    v_mul_f32 v236, v8, v128
    v_fmac_f32 v234, v1, v97
    v_fmac_f32 v236, v9, v129
    v_fmac_f32 v234, v2, v98
    v_fmac_f32 v236, v10, v130
    v_fmac_f32 v234, v3, v99
    v_mfma_f32_32x32x16_bf16 v[48:63], v[84:87], v[180:183], v[48:63]
    s_setprio 0
    s_waitcnt lgkmcnt(4)
    v_or_b32 v232, v232, v231
    v_or_b32 v233, v233, v231
    s_cmp_lg_u32 s34, 0
    s_cbranch_scc1 K2_dum_51
    s_cmp_eq_u32 s33, 4
    s_cbranch_scc1 K2_a4_52
K2_b4_54:
    s_add_u32 m0, s48, 512
    s_add_u32 s65, s48, 1536
    buffer_load_dwordx4 v232, s[16:19], 0 offen  lds
    s_mov_b32 m0, s65
    s_mov_b32 exec_hi, 0
    buffer_load_dwordx4 v233, s[16:19], 0 offen  lds
    s_mov_b32 exec_hi, -1
K2_back_53:
    v_fmac_f32 v236, v11, v131
    v_fmac_f32 v234, v4, v100
    v_fmac_f32 v236, v12, v132
    v_fmac_f32 v234, v5, v101
    v_fmac_f32 v236, v13, v133
    v_fmac_f32 v234, v6, v102
    v_fmac_f32 v236, v14, v134
    v_fmac_f32 v234, v7, v103
    v_fmac_f32 v236, v15, v135
    v_mul_f32 v238, v16, v128
    v_mul_f32 v240, v24, v128
    v_fmac_f32 v238, v17, v129
    v_fmac_f32 v240, v25, v129
    v_fmac_f32 v238, v18, v130
    v_fmac_f32 v240, v26, v130
    v_fmac_f32 v238, v19, v131
    v_fmac_f32 v240, v27, v131
    v_fmac_f32 v238, v20, v132
    v_fmac_f32 v240, v28, v132
    v_fmac_f32 v238, v21, v133
    v_fmac_f32 v240, v29, v133
    v_fmac_f32 v238, v22, v134
    v_fmac_f32 v240, v30, v134
    v_fmac_f32 v238, v23, v135
    v_fmac_f32 v240, v31, v135
    v_mul_f32 v235, v32, v104
    v_mul_f32 v237, v40, v136
    v_fmac_f32 v235, v33, v105
    v_fmac_f32 v237, v41, v137
    v_fmac_f32 v235, v34, v106
    v_fmac_f32 v237, v42, v138
    v_fmac_f32 v235, v35, v107
    v_fmac_f32 v237, v43, v139
    v_fmac_f32 v235, v36, v108
    v_fmac_f32 v237, v44, v140
    v_fmac_f32 v235, v37, v109
    v_fmac_f32 v237, v45, v141
    v_fmac_f32 v235, v38, v110
    v_fmac_f32 v237, v46, v142
    v_fmac_f32 v235, v39, v111
    v_fmac_f32 v237, v47, v143
    v_mul_f32 v239, v48, v136
    v_mul_f32 v241, v56, v136
    s_setprio 1
    s_waitcnt vmcnt(6) lgkmcnt(0)
    v_mfma_f32_32x32x16_bf16 v[0:15], v[72:75], v[184:187], 0
    ds_read_b64_tr_b16 v[176:177], v246 offset:0
    ds_read_b64_tr_b16 v[178:179], v246 offset:1024
    ds_read_b64_tr_b16 v[180:181], v247 offset:0
    ds_read_b64_tr_b16 v[182:183], v247 offset:1024
    v_fmac_f32 v239, v49, v137
    v_fmac_f32 v241, v57, v137
    s_mov_b32 m0, s71
    v_mfma_f32_32x32x16_bf16 v[16:31], v[76:79], v[184:187], 0
    buffer_load_dwordx4 v224, s[4:7], s42 offen sc1 lds
    buffer_load_dwordx4 v225, s[72:75], s42 offen offset:1024 sc1 lds
    v_fmac_f32 v239, v50, v138
    v_fmac_f32 v241, v58, v138
    v_fmac_f32 v239, v51, v139
    v_fmac_f32 v241, v59, v139
    v_fmac_f32 v239, v52, v140
    v_mfma_f32_32x32x16_bf16 v[32:47], v[72:75], v[188:191], 0
    v_fmac_f32 v241, v60, v140
    v_fmac_f32 v239, v53, v141
    v_fmac_f32 v241, v61, v141
    v_fmac_f32 v239, v54, v142
    v_fmac_f32 v241, v62, v142
    v_fmac_f32 v239, v55, v143
    v_fmac_f32 v241, v63, v143
    v_mfma_f32_32x32x16_bf16 v[48:63], v[76:79], v[188:191], 0
    v_permlane32_swap_b32 v234, v236
    v_permlane32_swap_b32 v235, v237
    v_permlane32_swap_b32 v240, v238
    s_waitcnt vmcnt(6) lgkmcnt(0)
    v_mfma_f32_32x32x16_bf16 v[0:15], v[64:67], v[176:179], v[0:15]
    ds_read_b64_tr_b16 v[184:185], v246 offset:2048
    ds_read_b64_tr_b16 v[186:187], v246 offset:3072
    ds_read_b64_tr_b16 v[188:189], v247 offset:2048
    ds_read_b64_tr_b16 v[190:191], v247 offset:3072
    v_permlane32_swap_b32 v241, v239
    s_mov_b32 m0, s68
    v_mfma_f32_32x32x16_bf16 v[16:31], v[68:71], v[176:179], v[16:31]
    buffer_load_dwordx4 v226, s[4:7], s42 offen sc1 lds
    buffer_load_dwordx4 v227, s[72:75], s42 offen offset:1024 sc1 lds
    v_add_f32 v234, v234, v236
    v_add_f32 v235, v235, v237
    v_add_f32 v240, v240, v238
    v_add_f32 v241, v241, v239
    v_mfma_f32_32x32x16_bf16 v[32:47], v[64:67], v[180:183], v[32:47]
    s_set_gpr_idx_on s31, gpr_idx(DST)
    s_nop 0
    v_cvt_pk_bf16_f32 v192, v234, v235
    v_cvt_pk_bf16_f32 v193, v240, v241
    s_set_gpr_idx_off
    v_mfma_f32_32x32x16_bf16 v[48:63], v[68:71], v[180:183], v[48:63]
    s_waitcnt vmcnt(6) lgkmcnt(0)
    v_mfma_f32_32x32x16_bf16 v[0:15], v[80:83], v[184:187], v[0:15]
    ds_read_b64_tr_b16 v[176:177], v246 offset:4096
    ds_read_b64_tr_b16 v[178:179], v246 offset:5120
    ds_read_b64_tr_b16 v[180:181], v247 offset:4096
    ds_read_b64_tr_b16 v[182:183], v247 offset:5120
    s_mov_b32 m0, s69
    v_mfma_f32_32x32x16_bf16 v[16:31], v[84:87], v[184:187], v[16:31]
    buffer_load_dwordx4 v222, s[4:7], s43 offen sc1 lds
    buffer_load_dwordx4 v223, s[72:75], s43 offen offset:1024 sc1 lds
    v_mfma_f32_32x32x16_bf16 v[32:47], v[80:83], v[188:191], v[32:47]
    s_nop 2
    v_mul_f32 v234, v0, v144
    v_mul_f32 v236, v8, v112
    v_fmac_f32 v234, v1, v145
    v_fmac_f32 v236, v9, v113
    v_fmac_f32 v234, v2, v146
    v_fmac_f32 v236, v10, v114
    v_fmac_f32 v234, v3, v147
    v_mfma_f32_32x32x16_bf16 v[48:63], v[84:87], v[188:191], v[48:63]
    s_setprio 0
    v_fmac_f32 v236, v11, v115
    v_fmac_f32 v234, v4, v148
    v_fmac_f32 v236, v12, v116
    v_fmac_f32 v234, v5, v149
    v_fmac_f32 v236, v13, v117
    v_fmac_f32 v234, v6, v150
    v_fmac_f32 v236, v14, v118
    v_fmac_f32 v234, v7, v151
    v_fmac_f32 v236, v15, v119
    v_mul_f32 v238, v16, v160
    v_mul_f32 v240, v24, v160
    v_fmac_f32 v238, v17, v161
    v_fmac_f32 v240, v25, v161
    v_fmac_f32 v238, v18, v162
    v_fmac_f32 v240, v26, v162
    v_fmac_f32 v238, v19, v163
    v_fmac_f32 v240, v27, v163
    v_fmac_f32 v238, v20, v164
    v_fmac_f32 v240, v28, v164
    v_fmac_f32 v238, v21, v165
    v_fmac_f32 v240, v29, v165
    v_fmac_f32 v238, v22, v166
    v_fmac_f32 v240, v30, v166
    v_fmac_f32 v238, v23, v167
    v_fmac_f32 v240, v31, v167
    v_mul_f32 v235, v32, v152
    v_mul_f32 v237, v40, v120
    v_fmac_f32 v235, v33, v153
    v_fmac_f32 v237, v41, v121
    v_fmac_f32 v235, v34, v154
    v_fmac_f32 v237, v42, v122
    v_fmac_f32 v235, v35, v155
    v_fmac_f32 v237, v43, v123
    v_fmac_f32 v235, v36, v156
    v_fmac_f32 v237, v44, v124
    v_fmac_f32 v235, v37, v157
    v_fmac_f32 v237, v45, v125
    v_fmac_f32 v235, v38, v158
    v_fmac_f32 v237, v46, v126
    v_fmac_f32 v235, v39, v159
    v_fmac_f32 v237, v47, v127
    v_mul_f32 v239, v48, v168
    v_mul_f32 v241, v56, v168
    v_fmac_f32 v239, v49, v169
    v_fmac_f32 v241, v57, v169
    s_setprio 1
    s_waitcnt vmcnt(4) lgkmcnt(0)
    v_mfma_f32_32x32x16_bf16 v[0:15], v[64:67], v[176:179], 0
    ds_read_b64_tr_b16 v[184:185], v246 offset:6144
    ds_read_b64_tr_b16 v[186:187], v246 offset:7168
    ds_read_b64_tr_b16 v[188:189], v247 offset:6144
    ds_read_b64_tr_b16 v[190:191], v247 offset:7168
    v_fmac_f32 v239, v50, v170
    v_fmac_f32 v241, v58, v170
    s_mov_b32 m0, s70
    v_mfma_f32_32x32x16_bf16 v[16:31], v[68:71], v[176:179], 0
    buffer_load_dwordx4 v224, s[4:7], s43 offen sc1 lds
    buffer_load_dwordx4 v225, s[72:75], s43 offen offset:1024 sc1 lds
    v_fmac_f32 v239, v51, v171
    v_fmac_f32 v241, v59, v171
    v_fmac_f32 v239, v52, v172
    v_fmac_f32 v241, v60, v172
    v_fmac_f32 v239, v53, v173
    v_mfma_f32_32x32x16_bf16 v[32:47], v[64:67], v[180:183], 0
    v_add_u32 v222, s48, v251
    ds_read2_b32 v[222:223], v222 offset0:1 offset1:3
    v_fmac_f32 v241, v61, v173
    v_fmac_f32 v239, v54, v174
    v_fmac_f32 v241, v62, v174
    v_fmac_f32 v239, v55, v175
    v_fmac_f32 v241, v63, v175
    v_mfma_f32_32x32x16_bf16 v[48:63], v[68:71], v[180:183], 0
    s_waitcnt vmcnt(4) lgkmcnt(1)
    v_mfma_f32_32x32x16_bf16 v[0:15], v[72:75], v[184:187], v[0:15]
    ds_read_b64_tr_b16 v[176:177], v246 offset:0
    ds_read_b64_tr_b16 v[178:179], v246 offset:1024
    ds_read_b64_tr_b16 v[180:181], v247 offset:0
    ds_read_b64_tr_b16 v[182:183], v247 offset:1024
    s_mov_b32 m0, s71
    v_mfma_f32_32x32x16_bf16 v[16:31], v[76:79], v[184:187], v[16:31]
    buffer_load_dwordx4 v226, s[4:7], s43 offen sc1 lds
    buffer_load_dwordx4 v227, s[72:75], s43 offen offset:1024 sc1 lds
    s_waitcnt lgkmcnt(4)
    v_mad_u32_u16 v222, v222, s39, v248 op_sel:[1,0,0,0]
    v_mad_u32_u16 v223, v223, s39, v248 op_sel:[1,0,0,0]
    v_mfma_f32_32x32x16_bf16 v[32:47], v[72:75], v[188:191], v[32:47]
    v_add_u32 v224, s49, v251
    ds_read2_b32 v[224:225], v224 offset0:1 offset1:3
    v_mfma_f32_32x32x16_bf16 v[48:63], v[76:79], v[188:191], v[48:63]
    s_waitcnt vmcnt(4) lgkmcnt(1)
    v_mfma_f32_32x32x16_bf16 v[0:15], v[80:83], v[176:179], v[0:15]
    ds_read_b64_tr_b16 v[184:185], v246 offset:2048
    ds_read_b64_tr_b16 v[186:187], v246 offset:3072
    ds_read_b64_tr_b16 v[188:189], v247 offset:2048
    ds_read_b64_tr_b16 v[190:191], v247 offset:3072
    s_mov_b32 m0, s68
    v_mfma_f32_32x32x16_bf16 v[16:31], v[84:87], v[176:179], v[16:31]
    buffer_load_dwordx4 v222, s[4:7], s44 offen sc1 lds
    buffer_load_dwordx4 v223, s[72:75], s44 offen offset:1024 sc1 lds
    s_waitcnt lgkmcnt(4)
    v_mad_u32_u16 v224, v224, s39, v248 op_sel:[1,0,0,0]
    v_mad_u32_u16 v225, v225, s39, v248 op_sel:[1,0,0,0]
    v_mfma_f32_32x32x16_bf16 v[32:47], v[80:83], v[180:183], v[32:47]
    v_add_u32 v226, s50, v251
    ds_read2_b32 v[226:227], v226 offset0:1 offset1:3
    v_mul_f32 v242, v0, v144
    v_fma_f32 v238, v8, v160, -v238
    v_fmac_f32 v242, v1, v145
    v_fmac_f32 v238, v9, v161
    v_fmac_f32 v242, v2, v146
    v_mfma_f32_32x32x16_bf16 v[48:63], v[84:87], v[180:183], v[48:63]
    s_setprio 0
    v_fmac_f32 v238, v10, v162
    v_fmac_f32 v242, v3, v147
    v_fmac_f32 v238, v11, v163
    v_fmac_f32 v242, v4, v148
    v_fmac_f32 v238, v12, v164
    v_fmac_f32 v242, v5, v149
    v_fmac_f32 v238, v13, v165
    v_fmac_f32 v242, v6, v150
    v_fmac_f32 v238, v14, v166
    v_fmac_f32 v242, v7, v151
    v_fmac_f32 v238, v15, v167
    v_fmac_f32 v236, v16, v112
    v_mul_f32 v244, v24, v160
    v_fmac_f32 v236, v17, v113
    v_fmac_f32 v244, v25, v161
    v_fmac_f32 v236, v18, v114
    v_fmac_f32 v244, v26, v162
    v_fmac_f32 v236, v19, v115
    v_fmac_f32 v244, v27, v163
    v_fmac_f32 v236, v20, v116
    v_fmac_f32 v244, v28, v164
    v_fmac_f32 v236, v21, v117
    v_fmac_f32 v244, v29, v165
    v_fmac_f32 v236, v22, v118
    v_fmac_f32 v244, v30, v166
    v_fmac_f32 v236, v23, v119
    v_fmac_f32 v244, v31, v167
    v_mul_f32 v243, v32, v152
    v_fma_f32 v239, v40, v168, -v239
    v_fmac_f32 v243, v33, v153
    v_fmac_f32 v239, v41, v169
    v_fmac_f32 v243, v34, v154
    v_fmac_f32 v239, v42, v170
    v_fmac_f32 v243, v35, v155
    v_fmac_f32 v239, v43, v171
    v_fmac_f32 v243, v36, v156
    v_fmac_f32 v239, v44, v172
    v_fmac_f32 v243, v37, v157
    v_fmac_f32 v239, v45, v173
    v_fmac_f32 v243, v38, v158
    v_fmac_f32 v239, v46, v174
    v_fmac_f32 v243, v39, v159
    v_fmac_f32 v239, v47, v175
    v_fmac_f32 v237, v48, v120
    v_mul_f32 v245, v56, v168
    v_fmac_f32 v237, v49, v121
    v_fmac_f32 v245, v57, v169
    v_fmac_f32 v237, v50, v122
    s_setprio 1
    s_waitcnt vmcnt(4) lgkmcnt(1)
    v_mfma_f32_32x32x16_bf16 v[0:15], v[64:67], v[184:187], 0
    ds_read_b64_tr_b16 v[176:177], v246 offset:4096
    ds_read_b64_tr_b16 v[178:179], v246 offset:5120
    ds_read_b64_tr_b16 v[180:181], v247 offset:4096
    ds_read_b64_tr_b16 v[182:183], v247 offset:5120
    v_fmac_f32 v245, v58, v170
    v_fmac_f32 v237, v51, v123
    s_mov_b32 m0, s69
    v_mfma_f32_32x32x16_bf16 v[16:31], v[68:71], v[184:187], 0
    buffer_load_dwordx4 v224, s[4:7], s45 offen sc1 lds
    buffer_load_dwordx4 v225, s[72:75], s45 offen offset:1024 sc1 lds
    s_waitcnt lgkmcnt(4)
    v_mad_u32_u16 v226, v226, s39, v248 op_sel:[1,0,0,0]
    v_mad_u32_u16 v227, v227, s39, v248 op_sel:[1,0,0,0]
    v_fmac_f32 v245, v59, v171
    v_fmac_f32 v237, v52, v124
    v_mfma_f32_32x32x16_bf16 v[32:47], v[64:67], v[188:191], 0
    v_fmac_f32 v245, v60, v172
    v_fmac_f32 v237, v53, v125
    v_fmac_f32 v245, v61, v173
    v_fmac_f32 v237, v54, v126
    v_fmac_f32 v245, v62, v174
    v_fmac_f32 v237, v55, v127
    v_fmac_f32 v245, v63, v175
    v_mfma_f32_32x32x16_bf16 v[48:63], v[68:71], v[188:191], 0
    v_permlane32_swap_b32 v242, v234
    v_permlane32_swap_b32 v243, v235
    v_add_f32 v242, v242, v234
    v_add_f32 v243, v243, v235
    s_waitcnt vmcnt(4) lgkmcnt(0)
    v_mfma_f32_32x32x16_bf16 v[0:15], v[72:75], v[176:179], v[0:15]
    ds_read_b64_tr_b16 v[184:185], v246 offset:6144
    ds_read_b64_tr_b16 v[186:187], v246 offset:7168
    ds_read_b64_tr_b16 v[188:189], v247 offset:6144
    ds_read_b64_tr_b16 v[190:191], v247 offset:7168
    s_mov_b32 m0, s70
    v_mfma_f32_32x32x16_bf16 v[16:31], v[76:79], v[176:179], v[16:31]
    buffer_load_dwordx4 v226, s[4:7], s46 offen sc1 lds
    buffer_load_dwordx4 v227, s[72:75], s46 offen offset:1024 sc1 lds
    s_set_gpr_idx_on s31, gpr_idx(DST)
    s_nop 0
    v_cvt_pk_bf16_f32 v194, v242, v243
    s_set_gpr_idx_off
    s_sub_u32 s26, s48, s29
    s_mov_b32 s29, s48
    v_mfma_f32_32x32x16_bf16 v[32:47], v[72:75], v[180:183], v[32:47]
    s_mov_b32 s30, s3
    s_bfe_u32 s56, s3, 0x40012
    s_cmp_eq_u32 s34, 0
    s_cselect_b32 s56, s56, 0
    s_mov_b32 s32, s31
    s_mov_b32 s31, s35
    v_mfma_f32_32x32x16_bf16 v[48:63], v[76:79], v[180:183], v[48:63]
    s_waitcnt vmcnt(4) lgkmcnt(0)
    v_mfma_f32_32x32x16_bf16 v[0:15], v[80:83], v[184:187], v[0:15]
    ds_read_b64_tr_b16 v[176:177], v246 offset:0
    ds_read_b64_tr_b16 v[178:179], v246 offset:1024
    ds_read_b64_tr_b16 v[180:181], v247 offset:0
    ds_read_b64_tr_b16 v[182:183], v247 offset:1024
    s_mov_b32 m0, s71
    v_mfma_f32_32x32x16_bf16 v[16:31], v[84:87], v[184:187], v[16:31]
    s_cmp_eq_u32 s33, 4
    s_cbranch_scc1 K2_g4_49
    buffer_load_dwordx4 v224, s[4:7], s47 offen sc1 lds
    buffer_load_dwordx4 v225, s[72:75], s47 offen offset:1024 sc1 lds
K2_back_50:
    v_mfma_f32_32x32x16_bf16 v[32:47], v[80:83], v[188:191], v[32:47]
    s_nop 0
    v_mul_f32 v242, v0, v144
    v_fma_f32 v240, v8, v160, -v240
    v_fmac_f32 v242, v1, v145
    v_fmac_f32 v240, v9, v161
    v_fmac_f32 v242, v2, v146
    v_fmac_f32 v240, v10, v162
    v_fmac_f32 v242, v3, v147
    v_mfma_f32_32x32x16_bf16 v[48:63], v[84:87], v[188:191], v[48:63]
    s_setprio 0
    v_fmac_f32 v240, v11, v163
    v_fmac_f32 v242, v4, v148
    v_fmac_f32 v240, v12, v164
    v_fmac_f32 v242, v5, v149
    v_fmac_f32 v240, v13, v165
    v_fmac_f32 v242, v6, v150
    v_fmac_f32 v240, v14, v166
    v_fmac_f32 v242, v7, v151
    v_fmac_f32 v240, v15, v167
    v_add_u32 v249, s26, v249
    v_add_u32 v250, s26, v250
    v_fma_f32 v244, v16, v160, -v244
    v_fmac_f32 v236, v24, v112
    v_fmac_f32 v244, v17, v161
    v_fmac_f32 v236, v25, v113
    v_fmac_f32 v244, v18, v162
    v_fmac_f32 v236, v26, v114
    v_fmac_f32 v244, v19, v163
    v_fmac_f32 v236, v27, v115
    v_fmac_f32 v244, v20, v164
    v_fmac_f32 v236, v28, v116
    v_fmac_f32 v244, v21, v165
    v_fmac_f32 v236, v29, v117
    v_fmac_f32 v244, v22, v166
    v_fmac_f32 v236, v30, v118
    v_fmac_f32 v244, v23, v167
    v_fmac_f32 v236, v31, v119
    ds_read_b64_tr_b16 v[0:1], v249 offset:0
    ds_read_b64_tr_b16 v[2:3], v249 offset:32
    ds_read_u16_d16_hi v16, v250 offset:0
    v_mul_f32 v243, v32, v152
    v_fma_f32 v241, v40, v168, -v241
    v_fmac_f32 v243, v33, v153
    v_fmac_f32 v241, v41, v169
    v_fmac_f32 v243, v34, v154
    v_fmac_f32 v241, v42, v170
    v_fmac_f32 v243, v35, v155
    v_fmac_f32 v241, v43, v171
    v_fmac_f32 v243, v36, v156
    v_fmac_f32 v241, v44, v172
    v_fmac_f32 v243, v37, v157
    v_fmac_f32 v241, v45, v173
    v_fmac_f32 v243, v38, v158
    v_fmac_f32 v241, v46, v174
    v_fmac_f32 v243, v39, v159
    v_fmac_f32 v241, v47, v175
    ds_read_b64_tr_b16 v[4:5], v249 offset:512
    ds_read_b64_tr_b16 v[6:7], v249 offset:544
    ds_read_u16_d16_hi v17, v250 offset:128
    v_fma_f32 v245, v48, v168, -v245
    v_fmac_f32 v237, v56, v120
    v_fmac_f32 v245, v49, v169
    v_fmac_f32 v237, v57, v121
    v_fmac_f32 v245, v50, v170
    v_fmac_f32 v237, v58, v122
    v_fmac_f32 v245, v51, v171
    v_fmac_f32 v237, v59, v123
    v_fmac_f32 v245, v52, v172
    v_fmac_f32 v237, v60, v124
    v_fmac_f32 v245, v53, v173
    v_fmac_f32 v237, v61, v125
    v_fmac_f32 v245, v54, v174
    v_fmac_f32 v237, v62, v126
    v_fmac_f32 v245, v55, v175
    v_fmac_f32 v237, v63, v127
    s_cmp_eq_u32 s56, 5
    s_cbranch_scc1 K2_U20
    s_cmp_eq_u32 s56, 6
    s_cbranch_scc1 K2_U3h0
    s_branch K2_DSP0
K2_PAD_U21:
    s_branch K2_HOP
K2_U21:
    s_setprio 1
    s_waitcnt lgkmcnt(0)
    v_lshlrev_b32 v20, 16, v0
    v_and_b32 v21, 0xffff0000, v0
    v_lshlrev_b32 v22, 16, v1
    v_and_b32 v23, 0xffff0000, v1
    v_lshlrev_b32 v24, 16, v2
    v_and_b32 v25, 0xffff0000, v2
    v_lshlrev_b32 v26, 16, v3
    v_and_b32 v27, 0xffff0000, v3
    v_mul_f32_dpp v36, v16, v20 row_newbcast:8 row_mask:0xf bank_mask:0xf
    v_mul_f32_dpp v37, v16, v21 row_newbcast:9 row_mask:0xf bank_mask:0xf
    v_mul_f32_dpp v38, v16, v22 row_newbcast:10 row_mask:0xf bank_mask:0xf
    v_mul_f32_dpp v39, v16, v23 row_newbcast:11 row_mask:0xf bank_mask:0xf
    v_mul_f32_dpp v40, v16, v24 row_newbcast:12 row_mask:0xf bank_mask:0xf
    v_mul_f32_dpp v41, v16, v25 row_newbcast:13 row_mask:0xf bank_mask:0xf
    v_mul_f32_dpp v42, v16, v26 row_newbcast:14 row_mask:0xf bank_mask:0xf
    v_mul_f32_dpp v43, v16, v27 row_newbcast:15 row_mask:0xf bank_mask:0xf
    v_cvt_pk_bf16_f32 v68, v36, v37
    v_cvt_pk_bf16_f32 v69, v38, v39
    v_cvt_pk_bf16_f32 v70, v40, v41
    v_cvt_pk_bf16_f32 v71, v42, v43
    v_mul_f32_dpp v20, v16, v20 row_newbcast:0 row_mask:0xa bank_mask:0xf
    v_mul_f32_dpp v21, v16, v21 row_newbcast:1 row_mask:0xa bank_mask:0xf
    v_mul_f32_dpp v22, v16, v22 row_newbcast:2 row_mask:0xa bank_mask:0xf
    v_mul_f32_dpp v23, v16, v23 row_newbcast:3 row_mask:0xa bank_mask:0xf
    v_mul_f32_dpp v24, v16, v24 row_newbcast:4 row_mask:0xa bank_mask:0xf
    v_mul_f32_dpp v25, v16, v25 row_newbcast:5 row_mask:0xa bank_mask:0xf
    v_mul_f32_dpp v26, v16, v26 row_newbcast:6 row_mask:0xa bank_mask:0xf
    v_mul_f32_dpp v27, v16, v27 row_newbcast:7 row_mask:0xa bank_mask:0xf
    v_cvt_pk_bf16_f32 v64, v20, v21
    v_cvt_pk_bf16_f32 v65, v22, v23
    v_cvt_pk_bf16_f32 v66, v24, v25
    v_cvt_pk_bf16_f32 v67, v26, v27
    v_lshlrev_b32 v28, 16, v4
    v_and_b32 v29, 0xffff0000, v4
    v_lshlrev_b32 v30, 16, v5
    v_and_b32 v31, 0xffff0000, v5
    v_lshlrev_b32 v32, 16, v6
    v_and_b32 v33, 0xffff0000, v6
    v_lshlrev_b32 v34, 16, v7
    v_and_b32 v35, 0xffff0000, v7
    v_mul_f32_dpp v36, v17, v28 row_newbcast:8 row_mask:0xf bank_mask:0xf
    v_mul_f32_dpp v37, v17, v29 row_newbcast:9 row_mask:0xf bank_mask:0xf
    v_mul_f32_dpp v38, v17, v30 row_newbcast:10 row_mask:0xf bank_mask:0xf
    v_mul_f32_dpp v39, v17, v31 row_newbcast:11 row_mask:0xf bank_mask:0xf
    v_mul_f32_dpp v40, v17, v32 row_newbcast:12 row_mask:0xf bank_mask:0xf
    v_mul_f32_dpp v41, v17, v33 row_newbcast:13 row_mask:0xf bank_mask:0xf
    v_mul_f32_dpp v42, v17, v34 row_newbcast:14 row_mask:0xf bank_mask:0xf
    v_mul_f32_dpp v43, v17, v35 row_newbcast:15 row_mask:0xf bank_mask:0xf
    v_cvt_pk_bf16_f32 v76, v36, v37
    v_cvt_pk_bf16_f32 v77, v38, v39
    v_cvt_pk_bf16_f32 v78, v40, v41
    v_cvt_pk_bf16_f32 v79, v42, v43
    v_mul_f32_dpp v28, v17, v28 row_newbcast:0 row_mask:0xa bank_mask:0xf
    v_mul_f32_dpp v29, v17, v29 row_newbcast:1 row_mask:0xa bank_mask:0xf
    v_mul_f32_dpp v30, v17, v30 row_newbcast:2 row_mask:0xa bank_mask:0xf
    v_mul_f32_dpp v31, v17, v31 row_newbcast:3 row_mask:0xa bank_mask:0xf
    v_mul_f32_dpp v32, v17, v32 row_newbcast:4 row_mask:0xa bank_mask:0xf
    v_mul_f32_dpp v33, v17, v33 row_newbcast:5 row_mask:0xa bank_mask:0xf
    v_mul_f32_dpp v34, v17, v34 row_newbcast:6 row_mask:0xa bank_mask:0xf
    v_mul_f32_dpp v35, v17, v35 row_newbcast:7 row_mask:0xa bank_mask:0xf
    v_cvt_pk_bf16_f32 v72, v28, v29
    v_cvt_pk_bf16_f32 v73, v30, v31
    v_cvt_pk_bf16_f32 v74, v32, v33
    v_cvt_pk_bf16_f32 v75, v34, v35
    s_waitcnt vmcnt(4)
    v_mfma_f32_32x32x16_bf16 v[0:15], v[64:67], v[176:179], 0
    ds_read_b64_tr_b16 v[184:185], v246 offset:2048
    ds_read_b64_tr_b16 v[186:187], v246 offset:3072
    ds_read_b64_tr_b16 v[188:189], v247 offset:2048
    ds_read_b64_tr_b16 v[190:191], v247 offset:3072
    s_mov_b32 m0, s68
    v_mfma_f32_32x32x16_bf16 v[16:31], v[68:71], v[176:179], 0
    buffer_load_dwordx4 v222, s[4:7], s42 offen sc1 lds
    buffer_load_dwordx4 v223, s[72:75], s42 offen offset:1024 sc1 lds
    v_permlane32_swap_b32 v242, v236
    v_permlane32_swap_b32 v243, v237
    v_mfma_f32_32x32x16_bf16 v[32:47], v[64:67], v[180:183], 0
    v_permlane32_swap_b32 v244, v238
    v_permlane32_swap_b32 v245, v239
    v_permlane32_swap_b32 v240, v241
    v_add_f32 v242, v242, v236
    v_mfma_f32_32x32x16_bf16 v[48:63], v[68:71], v[180:183], 0
    v_add_f32 v243, v243, v237
    v_add_f32 v244, v244, v238
    v_add_f32 v245, v245, v239
    v_add_f32 v240, -v240, -v241
    v_sub_u32 v241, v230, v231
    v_cvt_pk_bf16_f32 v242, v242, v243
    s_mov_b64 exec, 0x1ff
    ds_add_rtn_u32 v232, v254, v255
    s_mov_b64 exec, -1
    s_waitcnt vmcnt(4) lgkmcnt(1)
    v_mfma_f32_32x32x16_bf16 v[0:15], v[72:75], v[184:187], v[0:15]
    ds_read_b64_tr_b16 v[176:177], v246 offset:4096
    ds_read_b64_tr_b16 v[178:179], v246 offset:5120
    ds_read_b64_tr_b16 v[180:181], v247 offset:4096
    ds_read_b64_tr_b16 v[182:183], v247 offset:5120
    v_cvt_pk_bf16_f32 v244, v244, v245
    v_cvt_pk_bf16_f32 v240, v240, v240
    s_mov_b32 m0, s69
    v_mfma_f32_32x32x16_bf16 v[16:31], v[76:79], v[184:187], v[16:31]
    buffer_load_dwordx4 v224, s[4:7], s42 offen sc1 lds
    buffer_load_dwordx4 v225, s[72:75], s42 offen offset:1024 sc1 lds
    ds_write2st64_b32 v230, v242, v244 offset0:3 offset1:4
    ds_write_b16 v241, v240 offset:1280
    s_waitcnt lgkmcnt(6)
    v_readlane_b32 s58, v232, 8
    v_mfma_f32_32x32x16_bf16 v[32:47], v[72:75], v[188:191], v[32:47]
    s_cmp_lt_u32 s58, s22
    s_cbranch_scc0 K2_nul_55
    s_nop 0
    v_readlane_b32 s3, v253, s58
    s_nop 0
    s_bfe_u32 s58, s3, 0x60016
    s_and_b32 s59, s58, 7
    s_lshr_b32 s60, s58, 3
K2_chk_57:
    v_readlane_b32 s61, v232, s59
    s_nop 0
    s_cmp_gt_u32 s61, s60
    s_cbranch_scc0 K2_spin_56
K2_back_58:
    v_mfma_f32_32x32x16_bf16 v[48:63], v[76:79], v[188:191], v[48:63]
    s_setprio 0
    s_lshl_b32 s44, s34, 7
    s_and_b32 s48, s3, 0x3ffff
    s_bfe_u32 s33, s3, 0x30013
    s_mov_b32 s35, s48
    s_mov_b32 s45, s44
    s_xor_b32 s47, s44, 256
    v_mul_f32 v234, v0, v96
    v_mul_f32 v236, v8, v128
    v_fmac_f32 v234, v1, v97
    v_fmac_f32 v236, v9, v129
    v_fmac_f32 v234, v2, v98
    v_fmac_f32 v236, v10, v130
    v_fmac_f32 v234, v3, v99
    v_fmac_f32 v236, v11, v131
    v_fmac_f32 v234, v4, v100
    v_fmac_f32 v236, v12, v132
    v_fmac_f32 v234, v5, v101
    v_fmac_f32 v236, v13, v133
    v_fmac_f32 v234, v6, v102
    v_fmac_f32 v236, v14, v134
    v_fmac_f32 v234, v7, v103
    v_fmac_f32 v236, v15, v135
    v_mul_f32 v238, v16, v128
    v_mul_f32 v240, v24, v128
    v_fmac_f32 v238, v17, v129
    v_fmac_f32 v240, v25, v129
    v_fmac_f32 v238, v18, v130
    v_fmac_f32 v240, v26, v130
    v_fmac_f32 v238, v19, v131
    v_fmac_f32 v240, v27, v131
    v_fmac_f32 v238, v20, v132
    v_fmac_f32 v240, v28, v132
    v_fmac_f32 v238, v21, v133
    v_fmac_f32 v240, v29, v133
    v_fmac_f32 v238, v22, v134
    v_fmac_f32 v240, v30, v134
    v_fmac_f32 v238, v23, v135
    v_fmac_f32 v240, v31, v135
    v_mul_f32 v235, v32, v104
    v_mul_f32 v237, v40, v136
    v_fmac_f32 v235, v33, v105
    v_fmac_f32 v237, v41, v137
    v_fmac_f32 v235, v34, v106
    v_fmac_f32 v237, v42, v138
    v_fmac_f32 v235, v35, v107
    v_fmac_f32 v237, v43, v139
    v_fmac_f32 v235, v36, v108
    v_fmac_f32 v237, v44, v140
    v_fmac_f32 v235, v37, v109
    v_fmac_f32 v237, v45, v141
    v_fmac_f32 v235, v38, v110
    v_fmac_f32 v237, v46, v142
    v_fmac_f32 v235, v39, v111
    v_fmac_f32 v237, v47, v143
    v_mul_f32 v239, v48, v136
    v_mul_f32 v241, v56, v136
    v_fmac_f32 v239, v49, v137
    v_fmac_f32 v241, v57, v137
    s_setprio 1
    s_waitcnt vmcnt(4) lgkmcnt(2)
    v_mfma_f32_32x32x16_bf16 v[0:15], v[64:67], v[176:179], 0
    ds_read_b64_tr_b16 v[184:185], v246 offset:6144
    ds_read_b64_tr_b16 v[186:187], v246 offset:7168
    ds_read_b64_tr_b16 v[188:189], v247 offset:6144
    ds_read_b64_tr_b16 v[190:191], v247 offset:7168
    v_fmac_f32 v239, v50, v138
    v_fmac_f32 v241, v58, v138
    s_mov_b32 m0, s70
    v_mfma_f32_32x32x16_bf16 v[16:31], v[68:71], v[176:179], 0
    buffer_load_dwordx4 v222, s[4:7], s43 offen sc1 lds
    buffer_load_dwordx4 v223, s[72:75], s43 offen offset:1024 sc1 lds
    v_fmac_f32 v239, v51, v139
    v_fmac_f32 v241, v59, v139
    v_fmac_f32 v239, v52, v140
    v_fmac_f32 v241, v60, v140
    v_fmac_f32 v239, v53, v141
    v_mfma_f32_32x32x16_bf16 v[32:47], v[64:67], v[180:183], 0
    s_add_u32 s49, s48, 128
    s_add_u32 s60, s48, 256
    s_cmp_eq_u32 s33, 3
    s_cselect_b32 s46, s44, s47
    s_cselect_b32 s50, s60, s48
    s_sub_u32 s60, s33, 2
    s_cmp_lt_u32 s60, 2
    s_cbranch_scc0 K2_rare_59
K2_back_60:
    v_add_u32 v222, s48, v251
    ds_read2_b32 v[222:223], v222 offset0:1 offset1:3
    v_fmac_f32 v241, v61, v141
    v_fmac_f32 v239, v54, v142
    v_fmac_f32 v241, v62, v142
    v_fmac_f32 v239, v55, v143
    v_fmac_f32 v241, v63, v143
    v_mfma_f32_32x32x16_bf16 v[48:63], v[68:71], v[180:183], 0
    v_permlane32_swap_b32 v234, v236
    v_permlane32_swap_b32 v235, v237
    v_permlane32_swap_b32 v240, v238
    s_waitcnt vmcnt(4) lgkmcnt(1)
    v_mfma_f32_32x32x16_bf16 v[0:15], v[72:75], v[184:187], v[0:15]
    ds_read_b64_tr_b16 v[176:177], v246 offset:0
    ds_read_b64_tr_b16 v[178:179], v246 offset:1024
    ds_read_b64_tr_b16 v[180:181], v247 offset:0
    ds_read_b64_tr_b16 v[182:183], v247 offset:1024
    v_permlane32_swap_b32 v241, v239
    s_mov_b32 m0, s71
    v_mfma_f32_32x32x16_bf16 v[16:31], v[76:79], v[184:187], v[16:31]
    buffer_load_dwordx4 v224, s[4:7], s43 offen sc1 lds
    buffer_load_dwordx4 v225, s[72:75], s43 offen offset:1024 sc1 lds
    s_waitcnt lgkmcnt(4)
    v_mad_u32_u16 v222, v222, s39, v248 op_sel:[1,0,0,0]
    v_mad_u32_u16 v223, v223, s39, v248 op_sel:[1,0,0,0]
    v_lshl_add_u32 v230, v252, 1, s31
    v_add_f32 v234, v234, v236
    v_add_f32 v235, v235, v237
    v_add_f32 v240, v240, v238
    v_add_f32 v241, v241, v239
    v_cvt_pk_bf16_f32 v234, v234, v235
    v_cvt_pk_bf16_f32 v240, v240, v241
    ds_write2st64_b32 v230, v234, v240 offset0:0 offset1:1
    v_mfma_f32_32x32x16_bf16 v[32:47], v[72:75], v[188:191], v[32:47]
    v_add_u32 v224, s49, v251
    ds_read2_b32 v[224:225], v224 offset0:1 offset1:3
    v_mul_f32 v234, v0, v144
    v_mul_f32 v236, v8, v112
    v_fmac_f32 v234, v1, v145
    v_fmac_f32 v236, v9, v113
    v_fmac_f32 v234, v2, v146
    v_mfma_f32_32x32x16_bf16 v[48:63], v[76:79], v[188:191], v[48:63]
    s_setprio 0
    v_fmac_f32 v236, v10, v114
    v_fmac_f32 v234, v3, v147
    v_fmac_f32 v236, v11, v115
    v_fmac_f32 v234, v4, v148
    v_fmac_f32 v236, v12, v116
    v_fmac_f32 v234, v5, v149
    v_fmac_f32 v236, v13, v117
    v_fmac_f32 v234, v6, v150
    v_fmac_f32 v236, v14, v118
    v_fmac_f32 v234, v7, v151
    v_fmac_f32 v236, v15, v119
    v_mul_f32 v238, v16, v160
    v_mul_f32 v240, v24, v160
    v_fmac_f32 v238, v17, v161
    v_fmac_f32 v240, v25, v161
    v_fmac_f32 v238, v18, v162
    v_fmac_f32 v240, v26, v162
    v_fmac_f32 v238, v19, v163
    v_fmac_f32 v240, v27, v163
    v_fmac_f32 v238, v20, v164
    v_fmac_f32 v240, v28, v164
    v_fmac_f32 v238, v21, v165
    v_fmac_f32 v240, v29, v165
    v_fmac_f32 v238, v22, v166
    v_fmac_f32 v240, v30, v166
    v_fmac_f32 v238, v23, v167
    v_fmac_f32 v240, v31, v167
    v_mul_f32 v235, v32, v152
    v_mul_f32 v237, v40, v120
    v_fmac_f32 v235, v33, v153
    v_fmac_f32 v237, v41, v121
    v_fmac_f32 v235, v34, v154
    v_fmac_f32 v237, v42, v122
    v_fmac_f32 v235, v35, v155
    v_fmac_f32 v237, v43, v123
    v_fmac_f32 v235, v36, v156
    v_fmac_f32 v237, v44, v124
    v_fmac_f32 v235, v37, v157
    v_fmac_f32 v237, v45, v125
    v_fmac_f32 v235, v38, v158
    v_fmac_f32 v237, v46, v126
    v_fmac_f32 v235, v39, v159
    v_fmac_f32 v237, v47, v127
    v_mul_f32 v239, v48, v168
    v_mul_f32 v241, v56, v168
    v_fmac_f32 v239, v49, v169
    v_fmac_f32 v241, v57, v169
    v_fmac_f32 v239, v50, v170
    v_fmac_f32 v241, v58, v170
    v_fmac_f32 v239, v51, v171
    s_setprio 1
    s_waitcnt vmcnt(4) lgkmcnt(2)
    v_mfma_f32_32x32x16_bf16 v[0:15], v[64:67], v[176:179], 0
    ds_read_b64_tr_b16 v[184:185], v246 offset:2048
    ds_read_b64_tr_b16 v[186:187], v246 offset:3072
    ds_read_b64_tr_b16 v[188:189], v247 offset:2048
    ds_read_b64_tr_b16 v[190:191], v247 offset:3072
    v_fmac_f32 v241, v59, v171
    v_fmac_f32 v239, v52, v172
    s_mov_b32 m0, s68
    v_mfma_f32_32x32x16_bf16 v[16:31], v[68:71], v[176:179], 0
    buffer_load_dwordx4 v222, s[4:7], s44 offen sc1 lds
    buffer_load_dwordx4 v223, s[72:75], s44 offen offset:1024 sc1 lds
    s_waitcnt lgkmcnt(4)
    v_mad_u32_u16 v224, v224, s39, v248 op_sel:[1,0,0,0]
    v_mad_u32_u16 v225, v225, s39, v248 op_sel:[1,0,0,0]
    v_fmac_f32 v241, v60, v172
    v_fmac_f32 v239, v53, v173
    v_mfma_f32_32x32x16_bf16 v[32:47], v[64:67], v[180:183], 0
    v_add_u32 v226, s50, v251
    ds_read2_b32 v[226:227], v226 offset0:1 offset1:3
    v_fmac_f32 v241, v61, v173
    v_fmac_f32 v239, v54, v174
    v_fmac_f32 v241, v62, v174
    v_fmac_f32 v239, v55, v175
    v_fmac_f32 v241, v63, v175
    v_mfma_f32_32x32x16_bf16 v[48:63], v[68:71], v[180:183], 0
    s_waitcnt vmcnt(4) lgkmcnt(1)
    v_mfma_f32_32x32x16_bf16 v[0:15], v[72:75], v[184:187], v[0:15]
    ds_read_b64_tr_b16 v[176:177], v246 offset:4096
    ds_read_b64_tr_b16 v[178:179], v246 offset:5120
    ds_read_b64_tr_b16 v[180:181], v247 offset:4096
    ds_read_b64_tr_b16 v[182:183], v247 offset:5120
    s_mov_b32 m0, s69
    v_mfma_f32_32x32x16_bf16 v[16:31], v[76:79], v[184:187], v[16:31]
    buffer_load_dwordx4 v224, s[4:7], s45 offen sc1 lds
    buffer_load_dwordx4 v225, s[72:75], s45 offen offset:1024 sc1 lds
    s_waitcnt lgkmcnt(4)
    v_mad_u32_u16 v226, v226, s39, v248 op_sel:[1,0,0,0]
    v_mad_u32_u16 v227, v227, s39, v248 op_sel:[1,0,0,0]
    v_mfma_f32_32x32x16_bf16 v[32:47], v[72:75], v[188:191], v[32:47]
    v_mul_f32 v242, v0, v144
    v_fma_f32 v238, v8, v160, -v238
    v_fmac_f32 v242, v1, v145
    v_fmac_f32 v238, v9, v161
    v_fmac_f32 v242, v2, v146
    v_fmac_f32 v238, v10, v162
    v_fmac_f32 v242, v3, v147
    v_mfma_f32_32x32x16_bf16 v[48:63], v[76:79], v[188:191], v[48:63]
    s_setprio 0
    v_fmac_f32 v238, v11, v163
    v_fmac_f32 v242, v4, v148
    v_fmac_f32 v238, v12, v164
    v_fmac_f32 v242, v5, v149
    v_fmac_f32 v238, v13, v165
    v_fmac_f32 v242, v6, v150
    v_fmac_f32 v238, v14, v166
    v_fmac_f32 v242, v7, v151
    v_fmac_f32 v238, v15, v167
    v_fmac_f32 v236, v16, v112
    v_mul_f32 v244, v24, v160
    v_fmac_f32 v236, v17, v113
    v_fmac_f32 v244, v25, v161
    v_fmac_f32 v236, v18, v114
    v_fmac_f32 v244, v26, v162
    v_fmac_f32 v236, v19, v115
    v_fmac_f32 v244, v27, v163
    v_fmac_f32 v236, v20, v116
    v_fmac_f32 v244, v28, v164
    v_fmac_f32 v236, v21, v117
    v_fmac_f32 v244, v29, v165
    v_fmac_f32 v236, v22, v118
    v_fmac_f32 v244, v30, v166
    v_fmac_f32 v236, v23, v119
    v_fmac_f32 v244, v31, v167
    v_mul_f32 v243, v32, v152
    v_fma_f32 v239, v40, v168, -v239
    v_fmac_f32 v243, v33, v153
    v_fmac_f32 v239, v41, v169
    v_fmac_f32 v243, v34, v154
    v_fmac_f32 v239, v42, v170
    v_fmac_f32 v243, v35, v155
    v_fmac_f32 v239, v43, v171
    v_fmac_f32 v243, v36, v156
    v_fmac_f32 v239, v44, v172
    v_fmac_f32 v243, v37, v157
    v_fmac_f32 v239, v45, v173
    v_fmac_f32 v243, v38, v158
    v_fmac_f32 v239, v46, v174
    v_fmac_f32 v243, v39, v159
    v_fmac_f32 v239, v47, v175
    v_fmac_f32 v237, v48, v120
    v_mul_f32 v245, v56, v168
    s_setprio 1
    s_waitcnt vmcnt(4) lgkmcnt(0)
    v_mfma_f32_32x32x16_bf16 v[0:15], v[64:67], v[176:179], 0
    ds_read_b64_tr_b16 v[184:185], v246 offset:6144
    ds_read_b64_tr_b16 v[186:187], v246 offset:7168
    ds_read_b64_tr_b16 v[188:189], v247 offset:6144
    ds_read_b64_tr_b16 v[190:191], v247 offset:7168
    v_fmac_f32 v237, v49, v121
    v_fmac_f32 v245, v57, v169
    s_mov_b32 m0, s70
    v_mfma_f32_32x32x16_bf16 v[16:31], v[68:71], v[176:179], 0
    buffer_load_dwordx4 v226, s[4:7], s46 offen sc1 lds
    buffer_load_dwordx4 v227, s[72:75], s46 offen offset:1024 sc1 lds
    v_fmac_f32 v237, v50, v122
    v_fmac_f32 v245, v58, v170
    v_fmac_f32 v237, v51, v123
    v_fmac_f32 v245, v59, v171
    v_fmac_f32 v237, v52, v124
    v_mfma_f32_32x32x16_bf16 v[32:47], v[64:67], v[180:183], 0
    v_fmac_f32 v245, v60, v172
    v_fmac_f32 v237, v53, v125
    v_fmac_f32 v245, v61, v173
    v_fmac_f32 v237, v54, v126
    v_fmac_f32 v245, v62, v174
    v_fmac_f32 v237, v55, v127
    v_fmac_f32 v245, v63, v175
    v_mfma_f32_32x32x16_bf16 v[48:63], v[68:71], v[180:183], 0
    v_permlane32_swap_b32 v242, v234
    v_permlane32_swap_b32 v243, v235
    v_add_f32 v242, v242, v234
    v_add_f32 v243, v243, v235
    s_waitcnt vmcnt(4) lgkmcnt(0)
    v_mfma_f32_32x32x16_bf16 v[0:15], v[72:75], v[184:187], v[0:15]
    ds_read_b64_tr_b16 v[176:177], v246 offset:0
    ds_read_b64_tr_b16 v[178:179], v246 offset:1024
    ds_read_b64_tr_b16 v[180:181], v247 offset:0
    ds_read_b64_tr_b16 v[182:183], v247 offset:1024
    v_cvt_pk_bf16_f32 v242, v242, v243
    ds_write_b32 v230, v242 offset:512
    s_mov_b32 m0, s71
    v_mfma_f32_32x32x16_bf16 v[16:31], v[76:79], v[184:187], v[16:31]
    s_cmp_eq_u32 s33, 4
    s_cbranch_scc1 K2_g4_62
    buffer_load_dwordx4 v224, s[4:7], s47 offen sc1 lds
    buffer_load_dwordx4 v225, s[72:75], s47 offen offset:1024 sc1 lds
K2_back_63:
    s_sub_u32 s26, s48, s29
    s_mov_b32 s29, s48
    s_mov_b32 s30, s3
    s_bfe_u32 s56, s3, 0x40012
    s_cmp_lg_u32 s36, 0
    s_cselect_b32 s56, s56, 0
    v_mfma_f32_32x32x16_bf16 v[32:47], v[72:75], v[188:191], v[32:47]
    s_mov_b32 s32, s31
    s_mov_b32 s31, s35
    v_mul_f32 v242, v0, v144
    v_fma_f32 v240, v8, v160, -v240
    v_fmac_f32 v242, v1, v145
    v_fmac_f32 v240, v9, v161
    v_fmac_f32 v242, v2, v146
    v_mfma_f32_32x32x16_bf16 v[48:63], v[76:79], v[188:191], v[48:63]
    s_setprio 0
    v_fmac_f32 v240, v10, v162
    v_fmac_f32 v242, v3, v147
    v_fmac_f32 v240, v11, v163
    v_fmac_f32 v242, v4, v148
    v_fmac_f32 v240, v12, v164
    v_fmac_f32 v242, v5, v149
    v_fmac_f32 v240, v13, v165
    v_fmac_f32 v242, v6, v150
    v_fmac_f32 v240, v14, v166
    v_fmac_f32 v242, v7, v151
    v_fmac_f32 v240, v15, v167
    v_add_u32 v249, s26, v249
    v_add_u32 v250, s26, v250
    v_fma_f32 v244, v16, v160, -v244
    v_fmac_f32 v236, v24, v112
    v_fmac_f32 v244, v17, v161
    v_fmac_f32 v236, v25, v113
    v_fmac_f32 v244, v18, v162
    v_fmac_f32 v236, v26, v114
    v_fmac_f32 v244, v19, v163
    v_fmac_f32 v236, v27, v115
    v_fmac_f32 v244, v20, v164
    v_fmac_f32 v236, v28, v116
    v_fmac_f32 v244, v21, v165
    v_fmac_f32 v236, v29, v117
    v_fmac_f32 v244, v22, v166
    v_fmac_f32 v236, v30, v118
    v_fmac_f32 v244, v23, v167
    v_fmac_f32 v236, v31, v119
    ds_read_b64_tr_b16 v[0:1], v249 offset:0
    ds_read_b64_tr_b16 v[2:3], v249 offset:32
    ds_read_u16_d16_hi v16, v250 offset:0
    v_mul_f32 v243, v32, v152
    v_fma_f32 v241, v40, v168, -v241
    v_fmac_f32 v243, v33, v153
    v_fmac_f32 v241, v41, v169
    v_fmac_f32 v243, v34, v154
    v_fmac_f32 v241, v42, v170
    v_fmac_f32 v243, v35, v155
    v_fmac_f32 v241, v43, v171
    v_fmac_f32 v243, v36, v156
    v_fmac_f32 v241, v44, v172
    v_fmac_f32 v243, v37, v157
    v_fmac_f32 v241, v45, v173
    v_fmac_f32 v243, v38, v158
    v_fmac_f32 v241, v46, v174
    v_fmac_f32 v243, v39, v159
    v_fmac_f32 v241, v47, v175
    ds_read_b64_tr_b16 v[4:5], v249 offset:512
    ds_read_b64_tr_b16 v[6:7], v249 offset:544
    ds_read_u16_d16_hi v17, v250 offset:128
    v_fma_f32 v245, v48, v168, -v245
    v_fmac_f32 v237, v56, v120
    v_fmac_f32 v245, v49, v169
    v_fmac_f32 v237, v57, v121
    v_fmac_f32 v245, v50, v170
    v_fmac_f32 v237, v58, v122
    v_fmac_f32 v245, v51, v171
    v_fmac_f32 v237, v59, v123
    v_fmac_f32 v245, v52, v172
    v_fmac_f32 v237, v60, v124
    v_fmac_f32 v245, v53, v173
    v_fmac_f32 v237, v61, v125
    v_fmac_f32 v245, v54, v174
    v_fmac_f32 v237, v62, v126
    v_fmac_f32 v245, v55, v175
    v_fmac_f32 v237, v63, v127
    s_cmp_eq_u32 s56, 5
    s_cbranch_scc1 K2_U21
    s_cmp_eq_u32 s56, 6
    s_cbranch_scc1 K2_U3h1
    s_branch K2_DSP1
K2_PAD_U31:
    s_branch K2_HOP
K2_U3h1:
    s_setprio 1
    ds_read_b64_tr_b16 v[8:9], v249 offset:1024
    ds_read_u16_d16_hi v18, v250 offset:256
    s_waitcnt lgkmcnt(2)
    v_lshlrev_b32 v20, 16, v0
    v_and_b32 v21, 0xffff0000, v0
    v_lshlrev_b32 v22, 16, v1
    v_and_b32 v23, 0xffff0000, v1
    v_lshlrev_b32 v24, 16, v2
    v_and_b32 v25, 0xffff0000, v2
    v_lshlrev_b32 v26, 16, v3
    v_and_b32 v27, 0xffff0000, v3
    v_mul_f32_dpp v36, v16, v20 row_newbcast:8 row_mask:0xf bank_mask:0xf
    v_mul_f32_dpp v37, v16, v21 row_newbcast:9 row_mask:0xf bank_mask:0xf
    v_mul_f32_dpp v38, v16, v22 row_newbcast:10 row_mask:0xf bank_mask:0xf
    v_mul_f32_dpp v39, v16, v23 row_newbcast:11 row_mask:0xf bank_mask:0xf
    v_mul_f32_dpp v40, v16, v24 row_newbcast:12 row_mask:0xf bank_mask:0xf
    v_mul_f32_dpp v41, v16, v25 row_newbcast:13 row_mask:0xf bank_mask:0xf
    v_mul_f32_dpp v42, v16, v26 row_newbcast:14 row_mask:0xf bank_mask:0xf
    v_mul_f32_dpp v43, v16, v27 row_newbcast:15 row_mask:0xf bank_mask:0xf
    v_cvt_pk_bf16_f32 v68, v36, v37
    v_cvt_pk_bf16_f32 v69, v38, v39
    v_cvt_pk_bf16_f32 v70, v40, v41
    v_cvt_pk_bf16_f32 v71, v42, v43
    v_mul_f32_dpp v20, v16, v20 row_newbcast:0 row_mask:0xa bank_mask:0xf
    v_mul_f32_dpp v21, v16, v21 row_newbcast:1 row_mask:0xa bank_mask:0xf
    v_mul_f32_dpp v22, v16, v22 row_newbcast:2 row_mask:0xa bank_mask:0xf
    v_mul_f32_dpp v23, v16, v23 row_newbcast:3 row_mask:0xa bank_mask:0xf
    v_mul_f32_dpp v24, v16, v24 row_newbcast:4 row_mask:0xa bank_mask:0xf
    v_mul_f32_dpp v25, v16, v25 row_newbcast:5 row_mask:0xa bank_mask:0xf
    v_mul_f32_dpp v26, v16, v26 row_newbcast:6 row_mask:0xa bank_mask:0xf
    v_mul_f32_dpp v27, v16, v27 row_newbcast:7 row_mask:0xa bank_mask:0xf
    v_cvt_pk_bf16_f32 v64, v20, v21
    v_cvt_pk_bf16_f32 v65, v22, v23
    v_cvt_pk_bf16_f32 v66, v24, v25
    v_cvt_pk_bf16_f32 v67, v26, v27
    v_lshlrev_b32 v28, 16, v4
    v_and_b32 v29, 0xffff0000, v4
    v_lshlrev_b32 v30, 16, v5
    v_and_b32 v31, 0xffff0000, v5
    v_lshlrev_b32 v32, 16, v6
    v_and_b32 v33, 0xffff0000, v6
    v_lshlrev_b32 v34, 16, v7
    v_and_b32 v35, 0xffff0000, v7
    v_mul_f32_dpp v36, v17, v28 row_newbcast:8 row_mask:0xf bank_mask:0xf
    v_mul_f32_dpp v37, v17, v29 row_newbcast:9 row_mask:0xf bank_mask:0xf
    v_mul_f32_dpp v38, v17, v30 row_newbcast:10 row_mask:0xf bank_mask:0xf
    v_mul_f32_dpp v39, v17, v31 row_newbcast:11 row_mask:0xf bank_mask:0xf
    v_mul_f32_dpp v40, v17, v32 row_newbcast:12 row_mask:0xf bank_mask:0xf
    v_mul_f32_dpp v41, v17, v33 row_newbcast:13 row_mask:0xf bank_mask:0xf
    v_mul_f32_dpp v42, v17, v34 row_newbcast:14 row_mask:0xf bank_mask:0xf
    v_mul_f32_dpp v43, v17, v35 row_newbcast:15 row_mask:0xf bank_mask:0xf
    v_cvt_pk_bf16_f32 v76, v36, v37
    v_cvt_pk_bf16_f32 v77, v38, v39
    v_cvt_pk_bf16_f32 v78, v40, v41
    v_cvt_pk_bf16_f32 v79, v42, v43
    v_mul_f32_dpp v28, v17, v28 row_newbcast:0 row_mask:0xa bank_mask:0xf
    v_mul_f32_dpp v29, v17, v29 row_newbcast:1 row_mask:0xa bank_mask:0xf
    v_mul_f32_dpp v30, v17, v30 row_newbcast:2 row_mask:0xa bank_mask:0xf
    v_mul_f32_dpp v31, v17, v31 row_newbcast:3 row_mask:0xa bank_mask:0xf
    v_mul_f32_dpp v32, v17, v32 row_newbcast:4 row_mask:0xa bank_mask:0xf
    v_mul_f32_dpp v33, v17, v33 row_newbcast:5 row_mask:0xa bank_mask:0xf
    v_mul_f32_dpp v34, v17, v34 row_newbcast:6 row_mask:0xa bank_mask:0xf
    v_mul_f32_dpp v35, v17, v35 row_newbcast:7 row_mask:0xa bank_mask:0xf
    v_cvt_pk_bf16_f32 v72, v28, v29
    v_cvt_pk_bf16_f32 v73, v30, v31
    v_cvt_pk_bf16_f32 v74, v32, v33
    v_cvt_pk_bf16_f32 v75, v34, v35
    s_waitcnt lgkmcnt(0)
    v_lshlrev_b32 v20, 16, v8
    v_and_b32 v21, 0xffff0000, v8
    v_lshlrev_b32 v22, 16, v9
    v_and_b32 v23, 0xffff0000, v9
    v_mul_f32_dpp v36, v18, v20 row_newbcast:8 row_mask:0xf bank_mask:0xf
    v_mul_f32_dpp v37, v18, v21 row_newbcast:9 row_mask:0xf bank_mask:0xf
    v_mul_f32_dpp v38, v18, v22 row_newbcast:10 row_mask:0xf bank_mask:0xf
    v_mul_f32_dpp v39, v18, v23 row_newbcast:11 row_mask:0xf bank_mask:0xf
    v_cvt_pk_bf16_f32 v84, v36, v37
    v_cvt_pk_bf16_f32 v85, v38, v39
    v_mul_f32_dpp v20, v18, v20 row_newbcast:0 row_mask:0xa bank_mask:0xf
    v_mul_f32_dpp v21, v18, v21 row_newbcast:1 row_mask:0xa bank_mask:0xf
    v_mul_f32_dpp v22, v18, v22 row_newbcast:2 row_mask:0xa bank_mask:0xf
    v_mul_f32_dpp v23, v18, v23 row_newbcast:3 row_mask:0xa bank_mask:0xf
    v_cvt_pk_bf16_f32 v80, v20, v21
    v_cvt_pk_bf16_f32 v81, v22, v23
    s_waitcnt vmcnt(4)
    v_mfma_f32_32x32x16_bf16 v[0:15], v[64:67], v[176:179], 0
    ds_read_b64_tr_b16 v[184:185], v246 offset:2048
    ds_read_b64_tr_b16 v[186:187], v246 offset:3072
    ds_read_b64_tr_b16 v[188:189], v247 offset:2048
    ds_read_b64_tr_b16 v[190:191], v247 offset:3072
    s_mov_b32 m0, s68
    v_mfma_f32_32x32x16_bf16 v[16:31], v[68:71], v[176:179], 0
    buffer_load_dwordx4 v222, s[4:7], s41 offen sc1 lds
    buffer_load_dwordx4 v223, s[72:75], s41 offen offset:1024 sc1 lds
    v_permlane32_swap_b32 v242, v236
    v_permlane32_swap_b32 v243, v237
    v_mfma_f32_32x32x16_bf16 v[32:47], v[64:67], v[180:183], 0
    v_permlane32_swap_b32 v244, v238
    v_permlane32_swap_b32 v245, v239
    v_permlane32_swap_b32 v240, v241
    v_add_f32 v242, v242, v236
    v_mfma_f32_32x32x16_bf16 v[48:63], v[68:71], v[180:183], 0
    v_add_f32 v243, v243, v237
    v_add_f32 v244, v244, v238
    v_add_f32 v245, v245, v239
    v_add_f32 v240, -v240, -v241
    v_sub_u32 v241, v230, v231
    v_cvt_pk_bf16_f32 v242, v242, v243
    s_mov_b64 exec, 0x1ff
    ds_add_rtn_u32 v232, v254, v255
    s_mov_b64 exec, -1
    s_waitcnt vmcnt(4) lgkmcnt(1)
    v_mfma_f32_32x32x16_bf16 v[0:15], v[72:75], v[184:187], v[0:15]
    ds_read_b64_tr_b16 v[176:177], v246 offset:4096
    ds_read_b64_tr_b16 v[180:181], v247 offset:4096
    v_cvt_pk_bf16_f32 v244, v244, v245
    v_cvt_pk_bf16_f32 v240, v240, v240
    ds_write2st64_b32 v230, v242, v244 offset0:3 offset1:4
    ds_write_b16 v241, v240 offset:1280
    s_mov_b32 m0, s69
    v_mfma_f32_32x32x16_bf16 v[16:31], v[76:79], v[184:187], v[16:31]
    buffer_load_dwordx4 v226, s[4:7], s41 offen sc1 lds
    s_waitcnt lgkmcnt(4)
    v_readlane_b32 s58, v232, 8
    v_mfma_f32_32x32x16_bf16 v[32:47], v[72:75], v[188:191], v[32:47]
    s_cmp_lt_u32 s58, s22
    s_cbranch_scc0 K2_nul_64
    s_nop 0
    v_readlane_b32 s3, v253, s58
    s_nop 0
    s_bfe_u32 s58, s3, 0x60016
    s_and_b32 s59, s58, 7
    s_lshr_b32 s60, s58, 3
K2_chk_66:
    v_readlane_b32 s61, v232, s59
    s_nop 0
    s_cmp_gt_u32 s61, s60
    s_cbranch_scc0 K2_spin_65
K2_back_67:
    v_mfma_f32_32x32x16_bf16 v[48:63], v[76:79], v[188:191], v[48:63]
    s_lshl_b32 s44, s34, 7
    s_and_b32 s48, s3, 0x3ffff
    s_bfe_u32 s33, s3, 0x30013
    s_mov_b32 s35, s48
    s_mov_b32 s45, s44
    s_xor_b32 s47, s44, 256
    s_waitcnt vmcnt(3) lgkmcnt(2)
    v_mfma_f32_32x32x8_bf16 v[0:15], v[80:81], v[176:177], v[0:15]
    ds_read_b64_tr_b16 v[184:185], v246 offset:6144
    ds_read_b64_tr_b16 v[186:187], v246 offset:7168
    ds_read_b64_tr_b16 v[188:189], v247 offset:6144
    ds_read_b64_tr_b16 v[190:191], v247 offset:7168
    s_add_u32 s49, s48, 128
    s_add_u32 s60, s48, 256
    s_mov_b32 m0, s70
    v_mfma_f32_32x32x8_bf16 v[16:31], v[84:85], v[176:177], v[16:31]
    buffer_load_dwordx4 v222, s[4:7], s42 offen sc1 lds
    buffer_load_dwordx4 v223, s[72:75], s42 offen offset:1024 sc1 lds
    s_cmp_eq_u32 s33, 3
    s_cselect_b32 s46, s44, s47
    s_cselect_b32 s50, s60, s48
    v_mfma_f32_32x32x8_bf16 v[32:47], v[80:81], v[180:181], v[32:47]
    s_sub_u32 s60, s33, 2
    s_cmp_lt_u32 s60, 2
    s_cbranch_scc0 K2_rare_68
K2_back_69:
    v_mul_f32 v234, v0, v96
    v_mul_f32 v236, v8, v128
    v_fmac_f32 v234, v1, v97
    v_fmac_f32 v236, v9, v129
    v_mfma_f32_32x32x8_bf16 v[48:63], v[84:85], v[180:181], v[48:63]
    s_setprio 0
    v_fmac_f32 v234, v2, v98
    v_fmac_f32 v236, v10, v130
    v_fmac_f32 v234, v3, v99
    v_fmac_f32 v236, v11, v131
    v_fmac_f32 v234, v4, v100
    v_fmac_f32 v236, v12, v132
    v_fmac_f32 v234, v5, v101
    v_fmac_f32 v236, v13, v133
    v_fmac_f32 v234, v6, v102
    v_fmac_f32 v236, v14, v134
    v_fmac_f32 v234, v7, v103
    v_fmac_f32 v236, v15, v135
    v_mul_f32 v238, v16, v128
    v_mul_f32 v240, v24, v128
    v_fmac_f32 v238, v17, v129
    v_fmac_f32 v240, v25, v129
    v_fmac_f32 v238, v18, v130
    v_fmac_f32 v240, v26, v130
    v_fmac_f32 v238, v19, v131
    v_fmac_f32 v240, v27, v131
    v_fmac_f32 v238, v20, v132
    v_fmac_f32 v240, v28, v132
    v_fmac_f32 v238, v21, v133
    v_fmac_f32 v240, v29, v133
    v_fmac_f32 v238, v22, v134
    v_fmac_f32 v240, v30, v134
    v_fmac_f32 v238, v23, v135
    v_fmac_f32 v240, v31, v135
    v_mul_f32 v235, v32, v104
    v_mul_f32 v237, v40, v136
    v_fmac_f32 v235, v33, v105
    v_fmac_f32 v237, v41, v137
    v_fmac_f32 v235, v34, v106
    v_fmac_f32 v237, v42, v138
    v_fmac_f32 v235, v35, v107
    v_fmac_f32 v237, v43, v139
    v_fmac_f32 v235, v36, v108
    v_fmac_f32 v237, v44, v140
    v_fmac_f32 v235, v37, v109
    v_fmac_f32 v237, v45, v141
    v_fmac_f32 v235, v38, v110
    v_fmac_f32 v237, v46, v142
    v_fmac_f32 v235, v39, v111
    v_fmac_f32 v237, v47, v143
    v_mul_f32 v239, v48, v136
    v_mul_f32 v241, v56, v136
    s_setprio 1
    s_waitcnt vmcnt(3) lgkmcnt(0)
    v_mfma_f32_32x32x16_bf16 v[0:15], v[72:75], v[184:187], 0
    ds_read_b64_tr_b16 v[176:177], v246 offset:0
    ds_read_b64_tr_b16 v[178:179], v246 offset:1024
    ds_read_b64_tr_b16 v[180:181], v247 offset:0
    ds_read_b64_tr_b16 v[182:183], v247 offset:1024
    v_fmac_f32 v239, v49, v137
    v_fmac_f32 v241, v57, v137
    s_mov_b32 m0, s71
    v_mfma_f32_32x32x16_bf16 v[16:31], v[76:79], v[184:187], 0
    buffer_load_dwordx4 v224, s[4:7], s42 offen sc1 lds
    buffer_load_dwordx4 v225, s[72:75], s42 offen offset:1024 sc1 lds
    v_fmac_f32 v239, v50, v138
    v_fmac_f32 v241, v58, v138
    v_fmac_f32 v239, v51, v139
    v_fmac_f32 v241, v59, v139
    v_fmac_f32 v239, v52, v140
    v_mfma_f32_32x32x16_bf16 v[32:47], v[72:75], v[188:191], 0
    v_fmac_f32 v241, v60, v140
    v_fmac_f32 v239, v53, v141
    v_fmac_f32 v241, v61, v141
    v_fmac_f32 v239, v54, v142
    v_fmac_f32 v241, v62, v142
    v_fmac_f32 v239, v55, v143
    v_fmac_f32 v241, v63, v143
    v_mfma_f32_32x32x16_bf16 v[48:63], v[76:79], v[188:191], 0
    v_permlane32_swap_b32 v234, v236
    v_permlane32_swap_b32 v235, v237
    v_permlane32_swap_b32 v240, v238
    s_waitcnt vmcnt(4) lgkmcnt(0)
    v_mfma_f32_32x32x16_bf16 v[0:15], v[64:67], v[176:179], v[0:15]
    ds_read_b64_tr_b16 v[184:185], v246 offset:2048
    ds_read_b64_tr_b16 v[188:189], v247 offset:2048
    v_permlane32_swap_b32 v241, v239
    v_lshl_add_u32 v230, v252, 1, s31
    v_add_f32 v234, v234, v236
    s_mov_b32 m0, s68
    v_mfma_f32_32x32x16_bf16 v[16:31], v[68:71], v[176:179], v[16:31]
    buffer_load_dwordx4 v226, s[4:7], s42 offen sc1 lds
    v_add_f32 v235, v235, v237
    v_add_f32 v240, v240, v238
    v_add_f32 v241, v241, v239
    v_cvt_pk_bf16_f32 v234, v234, v235
    v_cvt_pk_bf16_f32 v240, v240, v241
    ds_write2st64_b32 v230, v234, v240 offset0:0 offset1:1
    v_mfma_f32_32x32x16_bf16 v[32:47], v[64:67], v[180:183], v[32:47]
    v_mfma_f32_32x32x16_bf16 v[48:63], v[68:71], v[180:183], v[48:63]
    s_waitcnt vmcnt(3) lgkmcnt(1)
    v_mfma_f32_32x32x8_bf16 v[0:15], v[80:81], v[184:185], v[0:15]
    ds_read_b64_tr_b16 v[176:177], v246 offset:4096
    ds_read_b64_tr_b16 v[178:179], v246 offset:5120
    ds_read_b64_tr_b16 v[180:181], v247 offset:4096
    ds_read_b64_tr_b16 v[182:183], v247 offset:5120
    s_mov_b32 m0, s69
    v_mfma_f32_32x32x8_bf16 v[16:31], v[84:85], v[184:185], v[16:31]
    buffer_load_dwordx4 v222, s[4:7], s43 offen sc1 lds
    buffer_load_dwordx4 v223, s[72:75], s43 offen offset:1024 sc1 lds
    v_mfma_f32_32x32x8_bf16 v[32:47], v[80:81], v[188:189], v[32:47]
    s_nop 2
    v_mul_f32 v234, v0, v144
    v_mul_f32 v236, v8, v112
    v_fmac_f32 v234, v1, v145
    v_fmac_f32 v236, v9, v113
    v_fmac_f32 v234, v2, v146
    v_fmac_f32 v236, v10, v114
    v_fmac_f32 v234, v3, v147
    v_mfma_f32_32x32x8_bf16 v[48:63], v[84:85], v[188:189], v[48:63]
    s_setprio 0
    v_fmac_f32 v236, v11, v115
    v_fmac_f32 v234, v4, v148
    v_fmac_f32 v236, v12, v116
    v_fmac_f32 v234, v5, v149
    v_fmac_f32 v236, v13, v117
    v_fmac_f32 v234, v6, v150
    v_fmac_f32 v236, v14, v118
    v_fmac_f32 v234, v7, v151
    v_fmac_f32 v236, v15, v119
    v_mul_f32 v238, v16, v160
    v_mul_f32 v240, v24, v160
    v_fmac_f32 v238, v17, v161
    v_fmac_f32 v240, v25, v161
    v_fmac_f32 v238, v18, v162
    v_fmac_f32 v240, v26, v162
    v_fmac_f32 v238, v19, v163
    v_fmac_f32 v240, v27, v163
    v_fmac_f32 v238, v20, v164
    v_fmac_f32 v240, v28, v164
    v_fmac_f32 v238, v21, v165
    v_fmac_f32 v240, v29, v165
    v_fmac_f32 v238, v22, v166
    v_fmac_f32 v240, v30, v166
    v_fmac_f32 v238, v23, v167
    v_fmac_f32 v240, v31, v167
    v_mul_f32 v235, v32, v152
    v_mul_f32 v237, v40, v120
    v_fmac_f32 v235, v33, v153
    v_fmac_f32 v237, v41, v121
    v_fmac_f32 v235, v34, v154
    v_fmac_f32 v237, v42, v122
    v_fmac_f32 v235, v35, v155
    v_fmac_f32 v237, v43, v123
    v_fmac_f32 v235, v36, v156
    v_fmac_f32 v237, v44, v124
    v_fmac_f32 v235, v37, v157
    v_fmac_f32 v237, v45, v125
    v_fmac_f32 v235, v38, v158
    v_fmac_f32 v237, v46, v126
    v_fmac_f32 v235, v39, v159
    v_fmac_f32 v237, v47, v127
    v_mul_f32 v239, v48, v168
    v_mul_f32 v241, v56, v168
    v_fmac_f32 v239, v49, v169
    v_fmac_f32 v241, v57, v169
    s_setprio 1
    s_waitcnt vmcnt(3) lgkmcnt(0)
    v_mfma_f32_32x32x16_bf16 v[0:15], v[64:67], v[176:179], 0
    ds_read_b64_tr_b16 v[184:185], v246 offset:6144
    ds_read_b64_tr_b16 v[186:187], v246 offset:7168
    ds_read_b64_tr_b16 v[188:189], v247 offset:6144
    ds_read_b64_tr_b16 v[190:191], v247 offset:7168
    v_fmac_f32 v239, v50, v170
    v_fmac_f32 v241, v58, v170
    s_mov_b32 m0, s70
    v_mfma_f32_32x32x16_bf16 v[16:31], v[68:71], v[176:179], 0
    buffer_load_dwordx4 v224, s[4:7], s43 offen sc1 lds
    buffer_load_dwordx4 v225, s[72:75], s43 offen offset:1024 sc1 lds
    v_fmac_f32 v239, v51, v171
    v_fmac_f32 v241, v59, v171
    v_fmac_f32 v239, v52, v172
    v_fmac_f32 v241, v60, v172
    v_fmac_f32 v239, v53, v173
    v_mfma_f32_32x32x16_bf16 v[32:47], v[64:67], v[180:183], 0
    v_add_u32 v222, s48, v251
    ds_read2_b32 v[222:223], v222 offset0:1 offset1:3
    v_fmac_f32 v241, v61, v173
    v_fmac_f32 v239, v54, v174
    v_fmac_f32 v241, v62, v174
    v_fmac_f32 v239, v55, v175
    v_fmac_f32 v241, v63, v175
    v_mfma_f32_32x32x16_bf16 v[48:63], v[68:71], v[180:183], 0
    s_waitcnt vmcnt(4) lgkmcnt(1)
    v_mfma_f32_32x32x16_bf16 v[0:15], v[72:75], v[184:187], v[0:15]
    ds_read_b64_tr_b16 v[176:177], v246 offset:0
    ds_read_b64_tr_b16 v[180:181], v247 offset:0
    s_mov_b32 m0, s71
    v_mfma_f32_32x32x16_bf16 v[16:31], v[76:79], v[184:187], v[16:31]
    buffer_load_dwordx4 v226, s[4:7], s43 offen sc1 lds
    s_waitcnt lgkmcnt(2)
    v_mad_u32_u16 v222, v222, s39, v248 op_sel:[1,0,0,0]
    v_mad_u32_u16 v223, v223, s39, v248 op_sel:[1,0,0,0]
    v_mfma_f32_32x32x16_bf16 v[32:47], v[72:75], v[188:191], v[32:47]
    v_add_u32 v224, s49, v251
    ds_read2_b32 v[224:225], v224 offset0:1 offset1:3
    v_mfma_f32_32x32x16_bf16 v[48:63], v[76:79], v[188:191], v[48:63]
    s_waitcnt vmcnt(3) lgkmcnt(1)
    v_mfma_f32_32x32x8_bf16 v[0:15], v[80:81], v[176:177], v[0:15]
    ds_read_b64_tr_b16 v[184:185], v246 offset:2048
    ds_read_b64_tr_b16 v[186:187], v246 offset:3072
    ds_read_b64_tr_b16 v[188:189], v247 offset:2048
    ds_read_b64_tr_b16 v[190:191], v247 offset:3072
    s_mov_b32 m0, s68
    v_mfma_f32_32x32x8_bf16 v[16:31], v[84:85], v[176:177], v[16:31]
    buffer_load_dwordx4 v222, s[4:7], s44 offen sc1 lds
    buffer_load_dwordx4 v223, s[72:75], s44 offen offset:1024 sc1 lds
    s_waitcnt lgkmcnt(4)
    v_mad_u32_u16 v224, v224, s39, v248 op_sel:[1,0,0,0]
    v_mad_u32_u16 v225, v225, s39, v248 op_sel:[1,0,0,0]
    v_mfma_f32_32x32x8_bf16 v[32:47], v[80:81], v[180:181], v[32:47]
    v_add_u32 v226, s50, v251
    ds_read2_b32 v[226:227], v226 offset0:1 offset1:3
    v_mul_f32 v242, v0, v144
    v_fma_f32 v238, v8, v160, -v238
    v_fmac_f32 v242, v1, v145
    v_fmac_f32 v238, v9, v161
    v_fmac_f32 v242, v2, v146
    v_mfma_f32_32x32x8_bf16 v[48:63], v[84:85], v[180:181], v[48:63]
    s_setprio 0
    v_fmac_f32 v238, v10, v162
    v_fmac_f32 v242, v3, v147
    v_fmac_f32 v238, v11, v163
    v_fmac_f32 v242, v4, v148
    v_fmac_f32 v238, v12, v164
    v_fmac_f32 v242, v5, v149
    v_fmac_f32 v238, v13, v165
    v_fmac_f32 v242, v6, v150
    v_fmac_f32 v238, v14, v166
    v_fmac_f32 v242, v7, v151
    v_fmac_f32 v238, v15, v167
    v_fmac_f32 v236, v16, v112
    v_mul_f32 v244, v24, v160
    v_fmac_f32 v236, v17, v113
    v_fmac_f32 v244, v25, v161
    v_fmac_f32 v236, v18, v114
    v_fmac_f32 v244, v26, v162
    v_fmac_f32 v236, v19, v115
    v_fmac_f32 v244, v27, v163
    v_fmac_f32 v236, v20, v116
    v_fmac_f32 v244, v28, v164
    v_fmac_f32 v236, v21, v117
    v_fmac_f32 v244, v29, v165
    v_fmac_f32 v236, v22, v118
    v_fmac_f32 v244, v30, v166
    v_fmac_f32 v236, v23, v119
    v_fmac_f32 v244, v31, v167
    v_mul_f32 v243, v32, v152
    v_fma_f32 v239, v40, v168, -v239
    v_fmac_f32 v243, v33, v153
    v_fmac_f32 v239, v41, v169
    v_fmac_f32 v243, v34, v154
    v_fmac_f32 v239, v42, v170
    v_fmac_f32 v243, v35, v155
    v_fmac_f32 v239, v43, v171
    v_fmac_f32 v243, v36, v156
    v_fmac_f32 v239, v44, v172
    v_fmac_f32 v243, v37, v157
    v_fmac_f32 v239, v45, v173
    v_fmac_f32 v243, v38, v158
    v_fmac_f32 v239, v46, v174
    v_fmac_f32 v243, v39, v159
    v_fmac_f32 v239, v47, v175
    v_fmac_f32 v237, v48, v120
    v_mul_f32 v245, v56, v168
    v_fmac_f32 v237, v49, v121
    v_fmac_f32 v245, v57, v169
    v_fmac_f32 v237, v50, v122
    s_setprio 1
    s_waitcnt vmcnt(3) lgkmcnt(1)
    v_mfma_f32_32x32x16_bf16 v[0:15], v[64:67], v[184:187], 0
    ds_read_b64_tr_b16 v[176:177], v246 offset:4096
    ds_read_b64_tr_b16 v[178:179], v246 offset:5120
    ds_read_b64_tr_b16 v[180:181], v247 offset:4096
    ds_read_b64_tr_b16 v[182:183], v247 offset:5120
    v_fmac_f32 v245, v58, v170
    v_fmac_f32 v237, v51, v123
    s_mov_b32 m0, s69
    v_mfma_f32_32x32x16_bf16 v[16:31], v[68:71], v[184:187], 0
    buffer_load_dwordx4 v224, s[4:7], s45 offen sc1 lds
    buffer_load_dwordx4 v225, s[72:75], s45 offen offset:1024 sc1 lds
    s_waitcnt lgkmcnt(4)
    v_mad_u32_u16 v226, v226, s39, v248 op_sel:[1,0,0,0]
    v_mad_u32_u16 v227, v227, s39, v248 op_sel:[1,0,0,0]
    v_fmac_f32 v245, v59, v171
    v_fmac_f32 v237, v52, v124
    v_mfma_f32_32x32x16_bf16 v[32:47], v[64:67], v[188:191], 0
    v_fmac_f32 v245, v60, v172
    v_fmac_f32 v237, v53, v125
    v_fmac_f32 v245, v61, v173
    v_fmac_f32 v237, v54, v126
    v_fmac_f32 v245, v62, v174
    v_fmac_f32 v237, v55, v127
    v_fmac_f32 v245, v63, v175
    v_mfma_f32_32x32x16_bf16 v[48:63], v[68:71], v[188:191], 0
    v_permlane32_swap_b32 v242, v234
    v_permlane32_swap_b32 v243, v235
    v_add_f32 v242, v242, v234
    v_add_f32 v243, v243, v235
    s_waitcnt vmcnt(4) lgkmcnt(0)
    v_mfma_f32_32x32x16_bf16 v[0:15], v[72:75], v[176:179], v[0:15]
    ds_read_b64_tr_b16 v[184:185], v246 offset:6144
    ds_read_b64_tr_b16 v[188:189], v247 offset:6144
    v_cvt_pk_bf16_f32 v242, v242, v243
    ds_write_b32 v230, v242 offset:512
    s_mov_b32 s32, s31
    s_mov_b32 s31, s35
    s_mov_b32 m0, s70
    v_mfma_f32_32x32x16_bf16 v[16:31], v[76:79], v[176:179], v[16:31]
    buffer_load_dwordx4 v226, s[4:7], s46 offen sc1 lds
    buffer_load_dwordx4 v227, s[72:75], s46 offen offset:1024 sc1 lds
    s_sub_u32 s26, s48, s29
    s_mov_b32 s29, s48
    s_mov_b32 s30, s3
    s_bfe_u32 s56, s3, 0x40012
    v_mfma_f32_32x32x16_bf16 v[32:47], v[72:75], v[180:183], v[32:47]
    s_cmp_lg_u32 s36, 0
    s_cselect_b32 s56, s56, 0
    v_mfma_f32_32x32x16_bf16 v[48:63], v[76:79], v[180:183], v[48:63]
    s_waitcnt vmcnt(4) lgkmcnt(1)
    v_mfma_f32_32x32x8_bf16 v[0:15], v[80:81], v[184:185], v[0:15]
    ds_read_b64_tr_b16 v[176:177], v246 offset:0
    ds_read_b64_tr_b16 v[178:179], v246 offset:1024
    ds_read_b64_tr_b16 v[180:181], v247 offset:0
    ds_read_b64_tr_b16 v[182:183], v247 offset:1024
    s_mov_b32 m0, s71
    v_mfma_f32_32x32x8_bf16 v[16:31], v[84:85], v[184:185], v[16:31]
    s_cmp_eq_u32 s33, 4
    s_cbranch_scc1 K2_g4_71
    buffer_load_dwordx4 v224, s[4:7], s47 offen sc1 lds
    buffer_load_dwordx4 v225, s[72:75], s47 offen offset:1024 sc1 lds
K2_back_72:
    v_mfma_f32_32x32x8_bf16 v[32:47], v[80:81], v[188:189], v[32:47]
    s_nop 0
    v_mul_f32 v242, v0, v144
    v_fma_f32 v240, v8, v160, -v240
    v_fmac_f32 v242, v1, v145
    v_fmac_f32 v240, v9, v161
    v_fmac_f32 v242, v2, v146
    v_fmac_f32 v240, v10, v162
    v_fmac_f32 v242, v3, v147
    v_mfma_f32_32x32x8_bf16 v[48:63], v[84:85], v[188:189], v[48:63]
    s_setprio 0
    v_fmac_f32 v240, v11, v163
    v_fmac_f32 v242, v4, v148
    v_fmac_f32 v240, v12, v164
    v_fmac_f32 v242, v5, v149
    v_fmac_f32 v240, v13, v165
    v_fmac_f32 v242, v6, v150
    v_fmac_f32 v240, v14, v166
    v_fmac_f32 v242, v7, v151
    v_fmac_f32 v240, v15, v167
    v_add_u32 v249, s26, v249
    v_add_u32 v250, s26, v250
    v_fma_f32 v244, v16, v160, -v244
    v_fmac_f32 v236, v24, v112
    v_fmac_f32 v244, v17, v161
    v_fmac_f32 v236, v25, v113
    v_fmac_f32 v244, v18, v162
    v_fmac_f32 v236, v26, v114
    v_fmac_f32 v244, v19, v163
    v_fmac_f32 v236, v27, v115
    v_fmac_f32 v244, v20, v164
    v_fmac_f32 v236, v28, v116
    v_fmac_f32 v244, v21, v165
    v_fmac_f32 v236, v29, v117
    v_fmac_f32 v244, v22, v166
    v_fmac_f32 v236, v30, v118
    v_fmac_f32 v244, v23, v167
    v_fmac_f32 v236, v31, v119
    ds_read_b64_tr_b16 v[0:1], v249 offset:0
    ds_read_b64_tr_b16 v[2:3], v249 offset:32
    ds_read_u16_d16_hi v16, v250 offset:0
    v_mul_f32 v243, v32, v152
    v_fma_f32 v241, v40, v168, -v241
    v_fmac_f32 v243, v33, v153
    v_fmac_f32 v241, v41, v169
    v_fmac_f32 v243, v34, v154
    v_fmac_f32 v241, v42, v170
    v_fmac_f32 v243, v35, v155
    v_fmac_f32 v241, v43, v171
    v_fmac_f32 v243, v36, v156
    v_fmac_f32 v241, v44, v172
    v_fmac_f32 v243, v37, v157
    v_fmac_f32 v241, v45, v173
    v_fmac_f32 v243, v38, v158
    v_fmac_f32 v241, v46, v174
    v_fmac_f32 v243, v39, v159
    v_fmac_f32 v241, v47, v175
    ds_read_b64_tr_b16 v[4:5], v249 offset:512
    ds_read_b64_tr_b16 v[6:7], v249 offset:544
    ds_read_u16_d16_hi v17, v250 offset:128
    v_fma_f32 v245, v48, v168, -v245
    v_fmac_f32 v237, v56, v120
    v_fmac_f32 v245, v49, v169
    v_fmac_f32 v237, v57, v121
    v_fmac_f32 v245, v50, v170
    v_fmac_f32 v237, v58, v122
    v_fmac_f32 v245, v51, v171
    v_fmac_f32 v237, v59, v123
    v_fmac_f32 v245, v52, v172
    v_fmac_f32 v237, v60, v124
    v_fmac_f32 v245, v53, v173
    v_fmac_f32 v237, v61, v125
    v_fmac_f32 v245, v54, v174
    v_fmac_f32 v237, v62, v126
    v_fmac_f32 v245, v55, v175
    v_fmac_f32 v237, v63, v127
    s_cmp_eq_u32 s56, 5
    s_cbranch_scc1 K2_U21
    s_cmp_eq_u32 s56, 6
    s_cbranch_scc1 K2_U3h1
    s_branch K2_DSP1
K2_U31:
    s_setprio 1
    ds_read_b64_tr_b16 v[8:9], v249 offset:1024
    ds_read_b64_tr_b16 v[10:11], v249 offset:1056
    ds_read_u16_d16_hi v18, v250 offset:256
    s_waitcnt lgkmcnt(3)
    v_lshlrev_b32 v20, 16, v0
    v_and_b32 v21, 0xffff0000, v0
    v_lshlrev_b32 v22, 16, v1
    v_and_b32 v23, 0xffff0000, v1
    v_lshlrev_b32 v24, 16, v2
    v_and_b32 v25, 0xffff0000, v2
    v_lshlrev_b32 v26, 16, v3
    v_and_b32 v27, 0xffff0000, v3
    v_mul_f32_dpp v36, v16, v20 row_newbcast:8 row_mask:0xf bank_mask:0xf
    v_mul_f32_dpp v37, v16, v21 row_newbcast:9 row_mask:0xf bank_mask:0xf
    v_mul_f32_dpp v38, v16, v22 row_newbcast:10 row_mask:0xf bank_mask:0xf
    v_mul_f32_dpp v39, v16, v23 row_newbcast:11 row_mask:0xf bank_mask:0xf
    v_mul_f32_dpp v40, v16, v24 row_newbcast:12 row_mask:0xf bank_mask:0xf
    v_mul_f32_dpp v41, v16, v25 row_newbcast:13 row_mask:0xf bank_mask:0xf
    v_mul_f32_dpp v42, v16, v26 row_newbcast:14 row_mask:0xf bank_mask:0xf
    v_mul_f32_dpp v43, v16, v27 row_newbcast:15 row_mask:0xf bank_mask:0xf
    v_cvt_pk_bf16_f32 v68, v36, v37
    v_cvt_pk_bf16_f32 v69, v38, v39
    v_cvt_pk_bf16_f32 v70, v40, v41
    v_cvt_pk_bf16_f32 v71, v42, v43
    v_mul_f32_dpp v20, v16, v20 row_newbcast:0 row_mask:0xa bank_mask:0xf
    v_mul_f32_dpp v21, v16, v21 row_newbcast:1 row_mask:0xa bank_mask:0xf
    v_mul_f32_dpp v22, v16, v22 row_newbcast:2 row_mask:0xa bank_mask:0xf
    v_mul_f32_dpp v23, v16, v23 row_newbcast:3 row_mask:0xa bank_mask:0xf
    v_mul_f32_dpp v24, v16, v24 row_newbcast:4 row_mask:0xa bank_mask:0xf
    v_mul_f32_dpp v25, v16, v25 row_newbcast:5 row_mask:0xa bank_mask:0xf
    v_mul_f32_dpp v26, v16, v26 row_newbcast:6 row_mask:0xa bank_mask:0xf
    v_mul_f32_dpp v27, v16, v27 row_newbcast:7 row_mask:0xa bank_mask:0xf
    v_cvt_pk_bf16_f32 v64, v20, v21
    v_cvt_pk_bf16_f32 v65, v22, v23
    v_cvt_pk_bf16_f32 v66, v24, v25
    v_cvt_pk_bf16_f32 v67, v26, v27
    v_lshlrev_b32 v28, 16, v4
    v_and_b32 v29, 0xffff0000, v4
    v_lshlrev_b32 v30, 16, v5
    v_and_b32 v31, 0xffff0000, v5
    v_lshlrev_b32 v32, 16, v6
    v_and_b32 v33, 0xffff0000, v6
    v_lshlrev_b32 v34, 16, v7
    v_and_b32 v35, 0xffff0000, v7
    v_mul_f32_dpp v36, v17, v28 row_newbcast:8 row_mask:0xf bank_mask:0xf
    v_mul_f32_dpp v37, v17, v29 row_newbcast:9 row_mask:0xf bank_mask:0xf
    v_mul_f32_dpp v38, v17, v30 row_newbcast:10 row_mask:0xf bank_mask:0xf
    v_mul_f32_dpp v39, v17, v31 row_newbcast:11 row_mask:0xf bank_mask:0xf
    v_mul_f32_dpp v40, v17, v32 row_newbcast:12 row_mask:0xf bank_mask:0xf
    v_mul_f32_dpp v41, v17, v33 row_newbcast:13 row_mask:0xf bank_mask:0xf
    v_mul_f32_dpp v42, v17, v34 row_newbcast:14 row_mask:0xf bank_mask:0xf
    v_mul_f32_dpp v43, v17, v35 row_newbcast:15 row_mask:0xf bank_mask:0xf
    v_cvt_pk_bf16_f32 v76, v36, v37
    v_cvt_pk_bf16_f32 v77, v38, v39
    v_cvt_pk_bf16_f32 v78, v40, v41
    v_cvt_pk_bf16_f32 v79, v42, v43
    v_mul_f32_dpp v28, v17, v28 row_newbcast:0 row_mask:0xa bank_mask:0xf
    v_mul_f32_dpp v29, v17, v29 row_newbcast:1 row_mask:0xa bank_mask:0xf
    v_mul_f32_dpp v30, v17, v30 row_newbcast:2 row_mask:0xa bank_mask:0xf
    v_mul_f32_dpp v31, v17, v31 row_newbcast:3 row_mask:0xa bank_mask:0xf
    v_mul_f32_dpp v32, v17, v32 row_newbcast:4 row_mask:0xa bank_mask:0xf
    v_mul_f32_dpp v33, v17, v33 row_newbcast:5 row_mask:0xa bank_mask:0xf
    v_mul_f32_dpp v34, v17, v34 row_newbcast:6 row_mask:0xa bank_mask:0xf
    v_mul_f32_dpp v35, v17, v35 row_newbcast:7 row_mask:0xa bank_mask:0xf
    v_cvt_pk_bf16_f32 v72, v28, v29
    v_cvt_pk_bf16_f32 v73, v30, v31
    v_cvt_pk_bf16_f32 v74, v32, v33
    v_cvt_pk_bf16_f32 v75, v34, v35
    s_waitcnt lgkmcnt(0)
    v_lshlrev_b32 v20, 16, v8
    v_and_b32 v21, 0xffff0000, v8
    v_lshlrev_b32 v22, 16, v9
    v_and_b32 v23, 0xffff0000, v9
    v_lshlrev_b32 v24, 16, v10
    v_and_b32 v25, 0xffff0000, v10
    v_lshlrev_b32 v26, 16, v11
    v_and_b32 v27, 0xffff0000, v11
    v_mul_f32_dpp v36, v18, v20 row_newbcast:8 row_mask:0xf bank_mask:0xf
    v_mul_f32_dpp v37, v18, v21 row_newbcast:9 row_mask:0xf bank_mask:0xf
    v_mul_f32_dpp v38, v18, v22 row_newbcast:10 row_mask:0xf bank_mask:0xf
    v_mul_f32_dpp v39, v18, v23 row_newbcast:11 row_mask:0xf bank_mask:0xf
    v_mul_f32_dpp v40, v18, v24 row_newbcast:12 row_mask:0xf bank_mask:0xf
    v_mul_f32_dpp v41, v18, v25 row_newbcast:13 row_mask:0xf bank_mask:0xf
    v_mul_f32_dpp v42, v18, v26 row_newbcast:14 row_mask:0xf bank_mask:0xf
    v_mul_f32_dpp v43, v18, v27 row_newbcast:15 row_mask:0xf bank_mask:0xf
    v_cvt_pk_bf16_f32 v84, v36, v37
    v_cvt_pk_bf16_f32 v85, v38, v39
    v_cvt_pk_bf16_f32 v86, v40, v41
    v_cvt_pk_bf16_f32 v87, v42, v43
    v_mul_f32_dpp v20, v18, v20 row_newbcast:0 row_mask:0xa bank_mask:0xf
    v_mul_f32_dpp v21, v18, v21 row_newbcast:1 row_mask:0xa bank_mask:0xf
    v_mul_f32_dpp v22, v18, v22 row_newbcast:2 row_mask:0xa bank_mask:0xf
    v_mul_f32_dpp v23, v18, v23 row_newbcast:3 row_mask:0xa bank_mask:0xf
    v_mul_f32_dpp v24, v18, v24 row_newbcast:4 row_mask:0xa bank_mask:0xf
    v_mul_f32_dpp v25, v18, v25 row_newbcast:5 row_mask:0xa bank_mask:0xf
    v_mul_f32_dpp v26, v18, v26 row_newbcast:6 row_mask:0xa bank_mask:0xf
    v_mul_f32_dpp v27, v18, v27 row_newbcast:7 row_mask:0xa bank_mask:0xf
    v_cvt_pk_bf16_f32 v80, v20, v21
    v_cvt_pk_bf16_f32 v81, v22, v23
    v_cvt_pk_bf16_f32 v82, v24, v25
    v_cvt_pk_bf16_f32 v83, v26, v27
    s_waitcnt vmcnt(4)
    v_mfma_f32_32x32x16_bf16 v[0:15], v[64:67], v[176:179], 0
    ds_read_b64_tr_b16 v[184:185], v246 offset:2048
    ds_read_b64_tr_b16 v[186:187], v246 offset:3072
    ds_read_b64_tr_b16 v[188:189], v247 offset:2048
    ds_read_b64_tr_b16 v[190:191], v247 offset:3072
    s_mov_b32 m0, s68
    v_mfma_f32_32x32x16_bf16 v[16:31], v[68:71], v[176:179], 0
    buffer_load_dwordx4 v222, s[4:7], s41 offen sc1 lds
    buffer_load_dwordx4 v223, s[72:75], s41 offen offset:1024 sc1 lds
    v_permlane32_swap_b32 v242, v236
    v_permlane32_swap_b32 v243, v237
    v_mfma_f32_32x32x16_bf16 v[32:47], v[64:67], v[180:183], 0
    v_permlane32_swap_b32 v244, v238
    v_permlane32_swap_b32 v245, v239
    v_permlane32_swap_b32 v240, v241
    v_add_f32 v242, v242, v236
    v_mfma_f32_32x32x16_bf16 v[48:63], v[68:71], v[180:183], 0
    v_add_f32 v243, v243, v237
    v_add_f32 v244, v244, v238
    v_add_f32 v245, v245, v239
    v_add_f32 v240, -v240, -v241
    v_sub_u32 v241, v230, v231
    v_cvt_pk_bf16_f32 v242, v242, v243
    s_mov_b64 exec, 0x1ff
    ds_add_rtn_u32 v232, v254, v255
    s_mov_b64 exec, -1
    s_waitcnt vmcnt(4) lgkmcnt(1)
    v_mfma_f32_32x32x16_bf16 v[0:15], v[72:75], v[184:187], v[0:15]
    ds_read_b64_tr_b16 v[176:177], v246 offset:4096
    ds_read_b64_tr_b16 v[178:179], v246 offset:5120
    ds_read_b64_tr_b16 v[180:181], v247 offset:4096
    ds_read_b64_tr_b16 v[182:183], v247 offset:5120
    v_cvt_pk_bf16_f32 v244, v244, v245
    v_cvt_pk_bf16_f32 v240, v240, v240
    s_mov_b32 m0, s69
    v_mfma_f32_32x32x16_bf16 v[16:31], v[76:79], v[184:187], v[16:31]
    buffer_load_dwordx4 v226, s[4:7], s41 offen sc1 lds
    buffer_load_dwordx4 v227, s[72:75], s41 offen offset:1024 sc1 lds
    ds_write2st64_b32 v230, v242, v244 offset0:3 offset1:4
    ds_write_b16 v241, v240 offset:1280
    s_waitcnt lgkmcnt(6)
    v_readlane_b32 s58, v232, 8
    v_mfma_f32_32x32x16_bf16 v[32:47], v[72:75], v[188:191], v[32:47]
    s_cmp_lt_u32 s58, s22
    s_cbranch_scc0 K2_nul_73
    s_nop 0
    v_readlane_b32 s3, v253, s58
    s_nop 0
    s_bfe_u32 s58, s3, 0x60016
    s_and_b32 s59, s58, 7
    s_lshr_b32 s60, s58, 3
K2_chk_75:
    v_readlane_b32 s61, v232, s59
    s_nop 0
    s_cmp_gt_u32 s61, s60
    s_cbranch_scc0 K2_spin_74
K2_back_76:
    v_mfma_f32_32x32x16_bf16 v[48:63], v[76:79], v[188:191], v[48:63]
    s_lshl_b32 s44, s34, 7
    s_and_b32 s48, s3, 0x3ffff
    s_bfe_u32 s33, s3, 0x30013
    s_mov_b32 s35, s48
    s_mov_b32 s45, s44
    s_xor_b32 s47, s44, 256
    s_waitcnt vmcnt(4) lgkmcnt(2)
    v_mfma_f32_32x32x16_bf16 v[0:15], v[80:83], v[176:179], v[0:15]
    ds_read_b64_tr_b16 v[184:185], v246 offset:6144
    ds_read_b64_tr_b16 v[186:187], v246 offset:7168
    ds_read_b64_tr_b16 v[188:189], v247 offset:6144
    ds_read_b64_tr_b16 v[190:191], v247 offset:7168
    s_add_u32 s49, s48, 128
    s_add_u32 s60, s48, 256
    s_mov_b32 m0, s70
    v_mfma_f32_32x32x16_bf16 v[16:31], v[84:87], v[176:179], v[16:31]
    buffer_load_dwordx4 v222, s[4:7], s42 offen sc1 lds
    buffer_load_dwordx4 v223, s[72:75], s42 offen offset:1024 sc1 lds
    s_cmp_eq_u32 s33, 3
    s_cselect_b32 s46, s44, s47
    s_cselect_b32 s50, s60, s48
    v_mfma_f32_32x32x16_bf16 v[32:47], v[80:83], v[180:183], v[32:47]
    s_sub_u32 s60, s33, 2
    s_cmp_lt_u32 s60, 2
    s_cbranch_scc0 K2_rare_77
K2_back_78:
    v_mul_f32 v234, v0, v96
    v_mul_f32 v236, v8, v128
    v_fmac_f32 v234, v1, v97
    v_fmac_f32 v236, v9, v129
    v_mfma_f32_32x32x16_bf16 v[48:63], v[84:87], v[180:183], v[48:63]
    s_setprio 0
    v_fmac_f32 v234, v2, v98
    v_fmac_f32 v236, v10, v130
    v_fmac_f32 v234, v3, v99
    v_fmac_f32 v236, v11, v131
    v_fmac_f32 v234, v4, v100
    v_fmac_f32 v236, v12, v132
    v_fmac_f32 v234, v5, v101
    v_fmac_f32 v236, v13, v133
    v_fmac_f32 v234, v6, v102
    v_fmac_f32 v236, v14, v134
    v_fmac_f32 v234, v7, v103
    v_fmac_f32 v236, v15, v135
    v_mul_f32 v238, v16, v128
    v_mul_f32 v240, v24, v128
    v_fmac_f32 v238, v17, v129
    v_fmac_f32 v240, v25, v129
    v_fmac_f32 v238, v18, v130
    v_fmac_f32 v240, v26, v130
    v_fmac_f32 v238, v19, v131
    v_fmac_f32 v240, v27, v131
    v_fmac_f32 v238, v20, v132
    v_fmac_f32 v240, v28, v132
    v_fmac_f32 v238, v21, v133
    v_fmac_f32 v240, v29, v133
    v_fmac_f32 v238, v22, v134
    v_fmac_f32 v240, v30, v134
    v_fmac_f32 v238, v23, v135
    v_fmac_f32 v240, v31, v135
    v_mul_f32 v235, v32, v104
    v_mul_f32 v237, v40, v136
    v_fmac_f32 v235, v33, v105
    v_fmac_f32 v237, v41, v137
    v_fmac_f32 v235, v34, v106
    v_fmac_f32 v237, v42, v138
    v_fmac_f32 v235, v35, v107
    v_fmac_f32 v237, v43, v139
    v_fmac_f32 v235, v36, v108
    v_fmac_f32 v237, v44, v140
    v_fmac_f32 v235, v37, v109
    v_fmac_f32 v237, v45, v141
    v_fmac_f32 v235, v38, v110
    v_fmac_f32 v237, v46, v142
    v_fmac_f32 v235, v39, v111
    v_fmac_f32 v237, v47, v143
    v_mul_f32 v239, v48, v136
    v_mul_f32 v241, v56, v136
    s_setprio 1
    s_waitcnt vmcnt(4) lgkmcnt(0)
    v_mfma_f32_32x32x16_bf16 v[0:15], v[72:75], v[184:187], 0
    ds_read_b64_tr_b16 v[176:177], v246 offset:0
    ds_read_b64_tr_b16 v[178:179], v246 offset:1024
    ds_read_b64_tr_b16 v[180:181], v247 offset:0
    ds_read_b64_tr_b16 v[182:183], v247 offset:1024
    v_fmac_f32 v239, v49, v137
    v_fmac_f32 v241, v57, v137
    s_mov_b32 m0, s71
    v_mfma_f32_32x32x16_bf16 v[16:31], v[76:79], v[184:187], 0
    buffer_load_dwordx4 v224, s[4:7], s42 offen sc1 lds
    buffer_load_dwordx4 v225, s[72:75], s42 offen offset:1024 sc1 lds
    v_fmac_f32 v239, v50, v138
    v_fmac_f32 v241, v58, v138
    v_fmac_f32 v239, v51, v139
    v_fmac_f32 v241, v59, v139
    v_fmac_f32 v239, v52, v140
    v_mfma_f32_32x32x16_bf16 v[32:47], v[72:75], v[188:191], 0
    v_fmac_f32 v241, v60, v140
    v_fmac_f32 v239, v53, v141
    v_fmac_f32 v241, v61, v141
    v_fmac_f32 v239, v54, v142
    v_fmac_f32 v241, v62, v142
    v_fmac_f32 v239, v55, v143
    v_fmac_f32 v241, v63, v143
    v_mfma_f32_32x32x16_bf16 v[48:63], v[76:79], v[188:191], 0
    v_permlane32_swap_b32 v234, v236
    v_permlane32_swap_b32 v235, v237
    v_permlane32_swap_b32 v240, v238
    s_waitcnt vmcnt(4) lgkmcnt(0)
    v_mfma_f32_32x32x16_bf16 v[0:15], v[64:67], v[176:179], v[0:15]
    ds_read_b64_tr_b16 v[184:185], v246 offset:2048
    ds_read_b64_tr_b16 v[186:187], v246 offset:3072
    ds_read_b64_tr_b16 v[188:189], v247 offset:2048
    ds_read_b64_tr_b16 v[190:191], v247 offset:3072
    v_permlane32_swap_b32 v241, v239
    s_mov_b32 m0, s68
    v_mfma_f32_32x32x16_bf16 v[16:31], v[68:71], v[176:179], v[16:31]
    buffer_load_dwordx4 v226, s[4:7], s42 offen sc1 lds
    buffer_load_dwordx4 v227, s[72:75], s42 offen offset:1024 sc1 lds
    v_lshl_add_u32 v230, v252, 1, s31
    v_add_f32 v234, v234, v236
    v_add_f32 v235, v235, v237
    v_add_f32 v240, v240, v238
    v_add_f32 v241, v241, v239
    v_mfma_f32_32x32x16_bf16 v[32:47], v[64:67], v[180:183], v[32:47]
    v_cvt_pk_bf16_f32 v234, v234, v235
    v_cvt_pk_bf16_f32 v240, v240, v241
    ds_write2st64_b32 v230, v234, v240 offset0:0 offset1:1
    v_mfma_f32_32x32x16_bf16 v[48:63], v[68:71], v[180:183], v[48:63]
    s_waitcnt vmcnt(4) lgkmcnt(1)
    v_mfma_f32_32x32x16_bf16 v[0:15], v[80:83], v[184:187], v[0:15]
    ds_read_b64_tr_b16 v[176:177], v246 offset:4096
    ds_read_b64_tr_b16 v[178:179], v246 offset:5120
    ds_read_b64_tr_b16 v[180:181], v247 offset:4096
    ds_read_b64_tr_b16 v[182:183], v247 offset:5120
    s_mov_b32 m0, s69
    v_mfma_f32_32x32x16_bf16 v[16:31], v[84:87], v[184:187], v[16:31]
    buffer_load_dwordx4 v222, s[4:7], s43 offen sc1 lds
    buffer_load_dwordx4 v223, s[72:75], s43 offen offset:1024 sc1 lds
    v_mfma_f32_32x32x16_bf16 v[32:47], v[80:83], v[188:191], v[32:47]
    s_nop 2
    v_mul_f32 v234, v0, v144
    v_mul_f32 v236, v8, v112
    v_fmac_f32 v234, v1, v145
    v_fmac_f32 v236, v9, v113
    v_fmac_f32 v234, v2, v146
    v_fmac_f32 v236, v10, v114
    v_fmac_f32 v234, v3, v147
    v_mfma_f32_32x32x16_bf16 v[48:63], v[84:87], v[188:191], v[48:63]
    s_setprio 0
    v_fmac_f32 v236, v11, v115
    v_fmac_f32 v234, v4, v148
    v_fmac_f32 v236, v12, v116
    v_fmac_f32 v234, v5, v149
    v_fmac_f32 v236, v13, v117
    v_fmac_f32 v234, v6, v150
    v_fmac_f32 v236, v14, v118
    v_fmac_f32 v234, v7, v151
    v_fmac_f32 v236, v15, v119
    v_mul_f32 v238, v16, v160
    v_mul_f32 v240, v24, v160
    v_fmac_f32 v238, v17, v161
    v_fmac_f32 v240, v25, v161
    v_fmac_f32 v238, v18, v162
    v_fmac_f32 v240, v26, v162
    v_fmac_f32 v238, v19, v163
    v_fmac_f32 v240, v27, v163
    v_fmac_f32 v238, v20, v164
    v_fmac_f32 v240, v28, v164
    v_fmac_f32 v238, v21, v165
    v_fmac_f32 v240, v29, v165
    v_fmac_f32 v238, v22, v166
    v_fmac_f32 v240, v30, v166
    v_fmac_f32 v238, v23, v167
    v_fmac_f32 v240, v31, v167
    v_mul_f32 v235, v32, v152
    v_mul_f32 v237, v40, v120
    v_fmac_f32 v235, v33, v153
    v_fmac_f32 v237, v41, v121
    v_fmac_f32 v235, v34, v154
    v_fmac_f32 v237, v42, v122
    v_fmac_f32 v235, v35, v155
    v_fmac_f32 v237, v43, v123
    v_fmac_f32 v235, v36, v156
    v_fmac_f32 v237, v44, v124
    v_fmac_f32 v235, v37, v157
    v_fmac_f32 v237, v45, v125
    v_fmac_f32 v235, v38, v158
    v_fmac_f32 v237, v46, v126
    v_fmac_f32 v235, v39, v159
    v_fmac_f32 v237, v47, v127
    v_mul_f32 v239, v48, v168
    v_mul_f32 v241, v56, v168
    v_fmac_f32 v239, v49, v169
    v_fmac_f32 v241, v57, v169
    s_setprio 1
    s_waitcnt vmcnt(4) lgkmcnt(0)
    v_mfma_f32_32x32x16_bf16 v[0:15], v[64:67], v[176:179], 0
    ds_read_b64_tr_b16 v[184:185], v246 offset:6144
    ds_read_b64_tr_b16 v[186:187], v246 offset:7168
    ds_read_b64_tr_b16 v[188:189], v247 offset:6144
    ds_read_b64_tr_b16 v[190:191], v247 offset:7168
    v_fmac_f32 v239, v50, v170
    v_fmac_f32 v241, v58, v170
    s_mov_b32 m0, s70
    v_mfma_f32_32x32x16_bf16 v[16:31], v[68:71], v[176:179], 0
    buffer_load_dwordx4 v224, s[4:7], s43 offen sc1 lds
    buffer_load_dwordx4 v225, s[72:75], s43 offen offset:1024 sc1 lds
    v_fmac_f32 v239, v51, v171
    v_fmac_f32 v241, v59, v171
    v_fmac_f32 v239, v52, v172
    v_fmac_f32 v241, v60, v172
    v_fmac_f32 v239, v53, v173
    v_mfma_f32_32x32x16_bf16 v[32:47], v[64:67], v[180:183], 0
    v_add_u32 v222, s48, v251
    ds_read2_b32 v[222:223], v222 offset0:1 offset1:3
    v_fmac_f32 v241, v61, v173
    v_fmac_f32 v239, v54, v174
    v_fmac_f32 v241, v62, v174
    v_fmac_f32 v239, v55, v175
    v_fmac_f32 v241, v63, v175
    v_mfma_f32_32x32x16_bf16 v[48:63], v[68:71], v[180:183], 0
    s_waitcnt vmcnt(4) lgkmcnt(1)
    v_mfma_f32_32x32x16_bf16 v[0:15], v[72:75], v[184:187], v[0:15]
    ds_read_b64_tr_b16 v[176:177], v246 offset:0
    ds_read_b64_tr_b16 v[178:179], v246 offset:1024
    ds_read_b64_tr_b16 v[180:181], v247 offset:0
    ds_read_b64_tr_b16 v[182:183], v247 offset:1024
    s_mov_b32 m0, s71
    v_mfma_f32_32x32x16_bf16 v[16:31], v[76:79], v[184:187], v[16:31]
    buffer_load_dwordx4 v226, s[4:7], s43 offen sc1 lds
    buffer_load_dwordx4 v227, s[72:75], s43 offen offset:1024 sc1 lds
    s_waitcnt lgkmcnt(4)
    v_mad_u32_u16 v222, v222, s39, v248 op_sel:[1,0,0,0]
    v_mad_u32_u16 v223, v223, s39, v248 op_sel:[1,0,0,0]
    v_mfma_f32_32x32x16_bf16 v[32:47], v[72:75], v[188:191], v[32:47]
    v_add_u32 v224, s49, v251
    ds_read2_b32 v[224:225], v224 offset0:1 offset1:3
    v_mfma_f32_32x32x16_bf16 v[48:63], v[76:79], v[188:191], v[48:63]
    s_waitcnt vmcnt(4) lgkmcnt(1)
    v_mfma_f32_32x32x16_bf16 v[0:15], v[80:83], v[176:179], v[0:15]
    ds_read_b64_tr_b16 v[184:185], v246 offset:2048
    ds_read_b64_tr_b16 v[186:187], v246 offset:3072
    ds_read_b64_tr_b16 v[188:189], v247 offset:2048
    ds_read_b64_tr_b16 v[190:191], v247 offset:3072
    s_mov_b32 m0, s68
    v_mfma_f32_32x32x16_bf16 v[16:31], v[84:87], v[176:179], v[16:31]
    buffer_load_dwordx4 v222, s[4:7], s44 offen sc1 lds
    buffer_load_dwordx4 v223, s[72:75], s44 offen offset:1024 sc1 lds
    s_waitcnt lgkmcnt(4)
    v_mad_u32_u16 v224, v224, s39, v248 op_sel:[1,0,0,0]
    v_mad_u32_u16 v225, v225, s39, v248 op_sel:[1,0,0,0]
    v_mfma_f32_32x32x16_bf16 v[32:47], v[80:83], v[180:183], v[32:47]
    v_add_u32 v226, s50, v251
    ds_read2_b32 v[226:227], v226 offset0:1 offset1:3
    v_mul_f32 v242, v0, v144
    v_fma_f32 v238, v8, v160, -v238
    v_fmac_f32 v242, v1, v145
    v_fmac_f32 v238, v9, v161
    v_fmac_f32 v242, v2, v146
    v_mfma_f32_32x32x16_bf16 v[48:63], v[84:87], v[180:183], v[48:63]
    s_setprio 0
    v_fmac_f32 v238, v10, v162
    v_fmac_f32 v242, v3, v147
    v_fmac_f32 v238, v11, v163
    v_fmac_f32 v242, v4, v148
    v_fmac_f32 v238, v12, v164
    v_fmac_f32 v242, v5, v149
    v_fmac_f32 v238, v13, v165
    v_fmac_f32 v242, v6, v150
    v_fmac_f32 v238, v14, v166
    v_fmac_f32 v242, v7, v151
    v_fmac_f32 v238, v15, v167
    v_fmac_f32 v236, v16, v112
    v_mul_f32 v244, v24, v160
    v_fmac_f32 v236, v17, v113
    v_fmac_f32 v244, v25, v161
    v_fmac_f32 v236, v18, v114
    v_fmac_f32 v244, v26, v162
    v_fmac_f32 v236, v19, v115
    v_fmac_f32 v244, v27, v163
    v_fmac_f32 v236, v20, v116
    v_fmac_f32 v244, v28, v164
    v_fmac_f32 v236, v21, v117
    v_fmac_f32 v244, v29, v165
    v_fmac_f32 v236, v22, v118
    v_fmac_f32 v244, v30, v166
    v_fmac_f32 v236, v23, v119
    v_fmac_f32 v244, v31, v167
    v_mul_f32 v243, v32, v152
    v_fma_f32 v239, v40, v168, -v239
    v_fmac_f32 v243, v33, v153
    v_fmac_f32 v239, v41, v169
    v_fmac_f32 v243, v34, v154
    v_fmac_f32 v239, v42, v170
    v_fmac_f32 v243, v35, v155
    v_fmac_f32 v239, v43, v171
    v_fmac_f32 v243, v36, v156
    v_fmac_f32 v239, v44, v172
    v_fmac_f32 v243, v37, v157
    v_fmac_f32 v239, v45, v173
    v_fmac_f32 v243, v38, v158
    v_fmac_f32 v239, v46, v174
    v_fmac_f32 v243, v39, v159
    v_fmac_f32 v239, v47, v175
    v_fmac_f32 v237, v48, v120
    v_mul_f32 v245, v56, v168
    v_fmac_f32 v237, v49, v121
    v_fmac_f32 v245, v57, v169
    v_fmac_f32 v237, v50, v122
    s_setprio 1
    s_waitcnt vmcnt(4) lgkmcnt(1)
    v_mfma_f32_32x32x16_bf16 v[0:15], v[64:67], v[184:187], 0
    ds_read_b64_tr_b16 v[176:177], v246 offset:4096
    ds_read_b64_tr_b16 v[178:179], v246 offset:5120
    ds_read_b64_tr_b16 v[180:181], v247 offset:4096
    ds_read_b64_tr_b16 v[182:183], v247 offset:5120
    v_fmac_f32 v245, v58, v170
    v_fmac_f32 v237, v51, v123
    s_mov_b32 m0, s69
    v_mfma_f32_32x32x16_bf16 v[16:31], v[68:71], v[184:187], 0
    buffer_load_dwordx4 v224, s[4:7], s45 offen sc1 lds
    buffer_load_dwordx4 v225, s[72:75], s45 offen offset:1024 sc1 lds
    s_waitcnt lgkmcnt(4)
    v_mad_u32_u16 v226, v226, s39, v248 op_sel:[1,0,0,0]
    v_mad_u32_u16 v227, v227, s39, v248 op_sel:[1,0,0,0]
    v_fmac_f32 v245, v59, v171
    v_fmac_f32 v237, v52, v124
    v_mfma_f32_32x32x16_bf16 v[32:47], v[64:67], v[188:191], 0
    v_fmac_f32 v245, v60, v172
    v_fmac_f32 v237, v53, v125
    v_fmac_f32 v245, v61, v173
    v_fmac_f32 v237, v54, v126
    v_fmac_f32 v245, v62, v174
    v_fmac_f32 v237, v55, v127
    v_fmac_f32 v245, v63, v175
    v_mfma_f32_32x32x16_bf16 v[48:63], v[68:71], v[188:191], 0
    v_permlane32_swap_b32 v242, v234
    v_permlane32_swap_b32 v243, v235
    v_add_f32 v242, v242, v234
    v_add_f32 v243, v243, v235
    s_waitcnt vmcnt(4) lgkmcnt(0)
    v_mfma_f32_32x32x16_bf16 v[0:15], v[72:75], v[176:179], v[0:15]
    ds_read_b64_tr_b16 v[184:185], v246 offset:6144
    ds_read_b64_tr_b16 v[186:187], v246 offset:7168
    ds_read_b64_tr_b16 v[188:189], v247 offset:6144
    ds_read_b64_tr_b16 v[190:191], v247 offset:7168
    v_cvt_pk_bf16_f32 v242, v242, v243
    ds_write_b32 v230, v242 offset:512
    s_mov_b32 m0, s70
    v_mfma_f32_32x32x16_bf16 v[16:31], v[76:79], v[176:179], v[16:31]
    buffer_load_dwordx4 v226, s[4:7], s46 offen sc1 lds
    buffer_load_dwordx4 v227, s[72:75], s46 offen offset:1024 sc1 lds
    s_sub_u32 s26, s48, s29
    s_mov_b32 s29, s48
    s_mov_b32 s30, s3
    s_bfe_u32 s56, s3, 0x40012
    s_mov_b32 s32, s31
    v_mfma_f32_32x32x16_bf16 v[32:47], v[72:75], v[180:183], v[32:47]
    s_cmp_lg_u32 s36, 0
    s_cselect_b32 s56, s56, 0
    s_mov_b32 s31, s35
    v_mfma_f32_32x32x16_bf16 v[48:63], v[76:79], v[180:183], v[48:63]
    s_waitcnt vmcnt(4) lgkmcnt(1)
    v_mfma_f32_32x32x16_bf16 v[0:15], v[80:83], v[184:187], v[0:15]
    ds_read_b64_tr_b16 v[176:177], v246 offset:0
    ds_read_b64_tr_b16 v[178:179], v246 offset:1024
    ds_read_b64_tr_b16 v[180:181], v247 offset:0
    ds_read_b64_tr_b16 v[182:183], v247 offset:1024
    s_mov_b32 m0, s71
    v_mfma_f32_32x32x16_bf16 v[16:31], v[84:87], v[184:187], v[16:31]
    s_cmp_eq_u32 s33, 4
    s_cbranch_scc1 K2_g4_80
    buffer_load_dwordx4 v224, s[4:7], s47 offen sc1 lds
    buffer_load_dwordx4 v225, s[72:75], s47 offen offset:1024 sc1 lds
K2_back_81:
    v_mfma_f32_32x32x16_bf16 v[32:47], v[80:83], v[188:191], v[32:47]
    s_nop 0
    v_mul_f32 v242, v0, v144
    v_fma_f32 v240, v8, v160, -v240
    v_fmac_f32 v242, v1, v145
    v_fmac_f32 v240, v9, v161
    v_fmac_f32 v242, v2, v146
    v_fmac_f32 v240, v10, v162
    v_fmac_f32 v242, v3, v147
    v_mfma_f32_32x32x16_bf16 v[48:63], v[84:87], v[188:191], v[48:63]
    s_setprio 0
    v_fmac_f32 v240, v11, v163
    v_fmac_f32 v242, v4, v148
    v_fmac_f32 v240, v12, v164
    v_fmac_f32 v242, v5, v149
    v_fmac_f32 v240, v13, v165
    v_fmac_f32 v242, v6, v150
    v_fmac_f32 v240, v14, v166
    v_fmac_f32 v242, v7, v151
    v_fmac_f32 v240, v15, v167
    v_add_u32 v249, s26, v249
    v_add_u32 v250, s26, v250
    v_fma_f32 v244, v16, v160, -v244
    v_fmac_f32 v236, v24, v112
    v_fmac_f32 v244, v17, v161
    v_fmac_f32 v236, v25, v113
    v_fmac_f32 v244, v18, v162
    v_fmac_f32 v236, v26, v114
    v_fmac_f32 v244, v19, v163
    v_fmac_f32 v236, v27, v115
    v_fmac_f32 v244, v20, v164
    v_fmac_f32 v236, v28, v116
    v_fmac_f32 v244, v21, v165
    v_fmac_f32 v236, v29, v117
    v_fmac_f32 v244, v22, v166
    v_fmac_f32 v236, v30, v118
    v_fmac_f32 v244, v23, v167
    v_fmac_f32 v236, v31, v119
    ds_read_b64_tr_b16 v[0:1], v249 offset:0
    ds_read_b64_tr_b16 v[2:3], v249 offset:32
    ds_read_u16_d16_hi v16, v250 offset:0
    v_mul_f32 v243, v32, v152
    v_fma_f32 v241, v40, v168, -v241
    v_fmac_f32 v243, v33, v153
    v_fmac_f32 v241, v41, v169
    v_fmac_f32 v243, v34, v154
    v_fmac_f32 v241, v42, v170
    v_fmac_f32 v243, v35, v155
    v_fmac_f32 v241, v43, v171
    v_fmac_f32 v243, v36, v156
    v_fmac_f32 v241, v44, v172
    v_fmac_f32 v243, v37, v157
    v_fmac_f32 v241, v45, v173
    v_fmac_f32 v243, v38, v158
    v_fmac_f32 v241, v46, v174
    v_fmac_f32 v243, v39, v159
    v_fmac_f32 v241, v47, v175
    ds_read_b64_tr_b16 v[4:5], v249 offset:512
    ds_read_b64_tr_b16 v[6:7], v249 offset:544
    ds_read_u16_d16_hi v17, v250 offset:128
    v_fma_f32 v245, v48, v168, -v245
    v_fmac_f32 v237, v56, v120
    v_fmac_f32 v245, v49, v169
    v_fmac_f32 v237, v57, v121
    v_fmac_f32 v245, v50, v170
    v_fmac_f32 v237, v58, v122
    v_fmac_f32 v245, v51, v171
    v_fmac_f32 v237, v59, v123
    v_fmac_f32 v245, v52, v172
    v_fmac_f32 v237, v60, v124
    v_fmac_f32 v245, v53, v173
    v_fmac_f32 v237, v61, v125
    v_fmac_f32 v245, v54, v174
    v_fmac_f32 v237, v62, v126
    v_fmac_f32 v245, v55, v175
    v_fmac_f32 v237, v63, v127
    s_cmp_eq_u32 s56, 5
    s_cbranch_scc1 K2_U21
    s_cmp_eq_u32 s56, 6
    s_cbranch_scc1 K2_U3h1
    s_branch K2_DSP1
K2_U2h1:
    s_setprio 1
    s_waitcnt lgkmcnt(0)
    v_lshlrev_b32 v20, 16, v0
    v_and_b32 v21, 0xffff0000, v0
    v_lshlrev_b32 v22, 16, v1
    v_and_b32 v23, 0xffff0000, v1
    v_lshlrev_b32 v24, 16, v2
    v_and_b32 v25, 0xffff0000, v2
    v_lshlrev_b32 v26, 16, v3
    v_and_b32 v27, 0xffff0000, v3
    v_mul_f32_dpp v36, v16, v20 row_newbcast:8 row_mask:0xf bank_mask:0xf
    v_mul_f32_dpp v37, v16, v21 row_newbcast:9 row_mask:0xf bank_mask:0xf
    v_mul_f32_dpp v38, v16, v22 row_newbcast:10 row_mask:0xf bank_mask:0xf
    v_mul_f32_dpp v39, v16, v23 row_newbcast:11 row_mask:0xf bank_mask:0xf
    v_mul_f32_dpp v40, v16, v24 row_newbcast:12 row_mask:0xf bank_mask:0xf
    v_mul_f32_dpp v41, v16, v25 row_newbcast:13 row_mask:0xf bank_mask:0xf
    v_mul_f32_dpp v42, v16, v26 row_newbcast:14 row_mask:0xf bank_mask:0xf
    v_mul_f32_dpp v43, v16, v27 row_newbcast:15 row_mask:0xf bank_mask:0xf
    v_cvt_pk_bf16_f32 v68, v36, v37
    v_cvt_pk_bf16_f32 v69, v38, v39
    v_cvt_pk_bf16_f32 v70, v40, v41
    v_cvt_pk_bf16_f32 v71, v42, v43
    v_mul_f32_dpp v20, v16, v20 row_newbcast:0 row_mask:0xa bank_mask:0xf
    v_mul_f32_dpp v21, v16, v21 row_newbcast:1 row_mask:0xa bank_mask:0xf
    v_mul_f32_dpp v22, v16, v22 row_newbcast:2 row_mask:0xa bank_mask:0xf
    v_mul_f32_dpp v23, v16, v23 row_newbcast:3 row_mask:0xa bank_mask:0xf
    v_mul_f32_dpp v24, v16, v24 row_newbcast:4 row_mask:0xa bank_mask:0xf
    v_mul_f32_dpp v25, v16, v25 row_newbcast:5 row_mask:0xa bank_mask:0xf
    v_mul_f32_dpp v26, v16, v26 row_newbcast:6 row_mask:0xa bank_mask:0xf
    v_mul_f32_dpp v27, v16, v27 row_newbcast:7 row_mask:0xa bank_mask:0xf
    v_cvt_pk_bf16_f32 v64, v20, v21
    v_cvt_pk_bf16_f32 v65, v22, v23
    v_cvt_pk_bf16_f32 v66, v24, v25
    v_cvt_pk_bf16_f32 v67, v26, v27
    v_lshlrev_b32 v28, 16, v4
    v_and_b32 v29, 0xffff0000, v4
    v_lshlrev_b32 v30, 16, v5
    v_and_b32 v31, 0xffff0000, v5
    v_mul_f32_dpp v36, v17, v28 row_newbcast:8 row_mask:0xf bank_mask:0xf
    v_mul_f32_dpp v37, v17, v29 row_newbcast:9 row_mask:0xf bank_mask:0xf
    v_mul_f32_dpp v38, v17, v30 row_newbcast:10 row_mask:0xf bank_mask:0xf
    v_mul_f32_dpp v39, v17, v31 row_newbcast:11 row_mask:0xf bank_mask:0xf
    v_cvt_pk_bf16_f32 v76, v36, v37
    v_cvt_pk_bf16_f32 v77, v38, v39
    v_mul_f32_dpp v28, v17, v28 row_newbcast:0 row_mask:0xa bank_mask:0xf
    v_mul_f32_dpp v29, v17, v29 row_newbcast:1 row_mask:0xa bank_mask:0xf
    v_mul_f32_dpp v30, v17, v30 row_newbcast:2 row_mask:0xa bank_mask:0xf
    v_mul_f32_dpp v31, v17, v31 row_newbcast:3 row_mask:0xa bank_mask:0xf
    v_cvt_pk_bf16_f32 v72, v28, v29
    v_cvt_pk_bf16_f32 v73, v30, v31
    s_waitcnt vmcnt(4)
    v_mfma_f32_32x32x16_bf16 v[0:15], v[64:67], v[176:179], 0
    ds_read_b64_tr_b16 v[184:185], v246 offset:2048
    ds_read_b64_tr_b16 v[188:189], v247 offset:2048
    s_mov_b32 m0, s68
    v_mfma_f32_32x32x16_bf16 v[16:31], v[68:71], v[176:179], 0
    buffer_load_dwordx4 v222, s[4:7], s42 offen sc1 lds
    buffer_load_dwordx4 v223, s[72:75], s42 offen offset:1024 sc1 lds
    v_permlane32_swap_b32 v242, v236
    v_permlane32_swap_b32 v243, v237
    v_mfma_f32_32x32x16_bf16 v[32:47], v[64:67], v[180:183], 0
    v_permlane32_swap_b32 v244, v238
    v_permlane32_swap_b32 v245, v239
    v_permlane32_swap_b32 v240, v241
    v_add_f32 v242, v242, v236
    v_mfma_f32_32x32x16_bf16 v[48:63], v[68:71], v[180:183], 0
    v_add_f32 v243, v243, v237
    v_add_f32 v244, v244, v238
    v_add_f32 v245, v245, v239
    v_add_f32 v240, -v240, -v241
    v_sub_u32 v241, v230, v231
    v_cvt_pk_bf16_f32 v242, v242, v243
    s_mov_b64 exec, 0x1ff
    ds_add_rtn_u32 v232, v254, v255
    s_mov_b64 exec, -1
    s_waitcnt vmcnt(4) lgkmcnt(1)
    v_mfma_f32_32x32x8_bf16 v[0:15], v[72:73], v[184:185], v[0:15]
    ds_read_b64_tr_b16 v[176:177], v246 offset:4096
    ds_read_b64_tr_b16 v[178:179], v246 offset:5120
    ds_read_b64_tr_b16 v[180:181], v247 offset:4096
    ds_read_b64_tr_b16 v[182:183], v247 offset:5120
    v_cvt_pk_bf16_f32 v244, v244, v245
    v_cvt_pk_bf16_f32 v240, v240, v240
    s_mov_b32 m0, s69
    v_mfma_f32_32x32x8_bf16 v[16:31], v[76:77], v[184:185], v[16:31]
    buffer_load_dwordx4 v224, s[4:7], s42 offen sc1 lds
    ds_write2st64_b32 v230, v242, v244 offset0:3 offset1:4
    ds_write_b16 v241, v240 offset:1280
    s_waitcnt lgkmcnt(6)
    v_readlane_b32 s58, v232, 8
    v_mfma_f32_32x32x8_bf16 v[32:47], v[72:73], v[188:189], v[32:47]
    s_cmp_lt_u32 s58, s22
    s_cbranch_scc0 K2_nul_82
    s_nop 0
    v_readlane_b32 s3, v253, s58
    s_nop 0
    s_bfe_u32 s58, s3, 0x60016
    s_and_b32 s59, s58, 7
    s_lshr_b32 s60, s58, 3
K2_chk_84:
    v_readlane_b32 s61, v232, s59
    s_nop 0
    s_cmp_gt_u32 s61, s60
    s_cbranch_scc0 K2_spin_83
K2_back_85:
    v_mfma_f32_32x32x8_bf16 v[48:63], v[76:77], v[188:189], v[48:63]
    s_setprio 0
    s_lshl_b32 s44, s34, 7
    s_and_b32 s48, s3, 0x3ffff
    s_bfe_u32 s33, s3, 0x30013
    s_mov_b32 s35, s48
    s_mov_b32 s45, s44
    s_xor_b32 s47, s44, 256
    v_mul_f32 v234, v0, v96
    v_mul_f32 v236, v8, v128
    v_fmac_f32 v234, v1, v97
    v_fmac_f32 v236, v9, v129
    v_fmac_f32 v234, v2, v98
    v_fmac_f32 v236, v10, v130
    v_fmac_f32 v234, v3, v99
    v_fmac_f32 v236, v11, v131
    v_fmac_f32 v234, v4, v100
    v_fmac_f32 v236, v12, v132
    v_fmac_f32 v234, v5, v101
    v_fmac_f32 v236, v13, v133
    v_fmac_f32 v234, v6, v102
    v_fmac_f32 v236, v14, v134
    v_fmac_f32 v234, v7, v103
    v_fmac_f32 v236, v15, v135
    v_mul_f32 v238, v16, v128
    v_mul_f32 v240, v24, v128
    v_fmac_f32 v238, v17, v129
    v_fmac_f32 v240, v25, v129
    v_fmac_f32 v238, v18, v130
    v_fmac_f32 v240, v26, v130
    v_fmac_f32 v238, v19, v131
    v_fmac_f32 v240, v27, v131
    v_fmac_f32 v238, v20, v132
    v_fmac_f32 v240, v28, v132
    v_fmac_f32 v238, v21, v133
    v_fmac_f32 v240, v29, v133
    v_fmac_f32 v238, v22, v134
    v_fmac_f32 v240, v30, v134
    v_fmac_f32 v238, v23, v135
    v_fmac_f32 v240, v31, v135
    v_mul_f32 v235, v32, v104
    v_mul_f32 v237, v40, v136
    v_fmac_f32 v235, v33, v105
    v_fmac_f32 v237, v41, v137
    v_fmac_f32 v235, v34, v106
    v_fmac_f32 v237, v42, v138
    v_fmac_f32 v235, v35, v107
    v_fmac_f32 v237, v43, v139
    v_fmac_f32 v235, v36, v108
    v_fmac_f32 v237, v44, v140
    v_fmac_f32 v235, v37, v109
    v_fmac_f32 v237, v45, v141
    v_fmac_f32 v235, v38, v110
    v_fmac_f32 v237, v46, v142
    v_fmac_f32 v235, v39, v111
    v_fmac_f32 v237, v47, v143
    v_mul_f32 v239, v48, v136
    v_mul_f32 v241, v56, v136
    s_setprio 1
    s_waitcnt vmcnt(3) lgkmcnt(2)
    v_mfma_f32_32x32x16_bf16 v[0:15], v[64:67], v[176:179], 0
    ds_read_b64_tr_b16 v[184:185], v246 offset:6144
    ds_read_b64_tr_b16 v[188:189], v247 offset:6144
    v_fmac_f32 v239, v49, v137
    v_fmac_f32 v241, v57, v137
    v_fmac_f32 v239, v50, v138
    v_fmac_f32 v241, v58, v138
    s_mov_b32 m0, s70
    v_mfma_f32_32x32x16_bf16 v[16:31], v[68:71], v[176:179], 0
    buffer_load_dwordx4 v222, s[4:7], s43 offen sc1 lds
    buffer_load_dwordx4 v223, s[72:75], s43 offen offset:1024 sc1 lds
    v_fmac_f32 v239, v51, v139
    v_fmac_f32 v241, v59, v139
    v_fmac_f32 v239, v52, v140
    v_fmac_f32 v241, v60, v140
    v_fmac_f32 v239, v53, v141
    v_mfma_f32_32x32x16_bf16 v[32:47], v[64:67], v[180:183], 0
    s_add_u32 s49, s48, 128
    s_add_u32 s60, s48, 256
    s_cmp_eq_u32 s33, 3
    s_cselect_b32 s46, s44, s47
    s_cselect_b32 s50, s60, s48
    s_sub_u32 s60, s33, 2
    s_cmp_lt_u32 s60, 2
    s_cbranch_scc0 K2_rare_86
K2_back_87:
    v_add_u32 v222, s48, v251
    ds_read2_b32 v[222:223], v222 offset0:1 offset1:3
    v_fmac_f32 v241, v61, v141
    v_fmac_f32 v239, v54, v142
    v_fmac_f32 v241, v62, v142
    v_fmac_f32 v239, v55, v143
    v_fmac_f32 v241, v63, v143
    v_mfma_f32_32x32x16_bf16 v[48:63], v[68:71], v[180:183], 0
    v_permlane32_swap_b32 v234, v236
    v_permlane32_swap_b32 v235, v237
    v_permlane32_swap_b32 v240, v238
    s_waitcnt vmcnt(3) lgkmcnt(1)
    v_mfma_f32_32x32x8_bf16 v[0:15], v[72:73], v[184:185], v[0:15]
    ds_read_b64_tr_b16 v[176:177], v246 offset:0
    ds_read_b64_tr_b16 v[178:179], v246 offset:1024
    ds_read_b64_tr_b16 v[180:181], v247 offset:0
    ds_read_b64_tr_b16 v[182:183], v247 offset:1024
    v_permlane32_swap_b32 v241, v239
    s_mov_b32 m0, s71
    v_mfma_f32_32x32x8_bf16 v[16:31], v[76:77], v[184:185], v[16:31]
    buffer_load_dwordx4 v224, s[4:7], s43 offen sc1 lds
    s_waitcnt lgkmcnt(4)
    v_mad_u32_u16 v222, v222, s39, v248 op_sel:[1,0,0,0]
    v_mad_u32_u16 v223, v223, s39, v248 op_sel:[1,0,0,0]
    v_lshl_add_u32 v230, v252, 1, s31
    v_add_f32 v234, v234, v236
    v_add_f32 v235, v235, v237
    v_add_f32 v240, v240, v238
    v_add_f32 v241, v241, v239
    v_cvt_pk_bf16_f32 v234, v234, v235
    v_cvt_pk_bf16_f32 v240, v240, v241
    ds_write2st64_b32 v230, v234, v240 offset0:0 offset1:1
    v_mfma_f32_32x32x8_bf16 v[32:47], v[72:73], v[188:189], v[32:47]
    v_add_u32 v224, s49, v251
    ds_read2_b32 v[224:225], v224 offset0:1 offset1:3
    v_mul_f32 v234, v0, v144
    v_mul_f32 v236, v8, v112
    v_fmac_f32 v234, v1, v145
    v_fmac_f32 v236, v9, v113
    v_fmac_f32 v234, v2, v146
    v_mfma_f32_32x32x8_bf16 v[48:63], v[76:77], v[188:189], v[48:63]
    s_setprio 0
    v_fmac_f32 v236, v10, v114
    v_fmac_f32 v234, v3, v147
    v_fmac_f32 v236, v11, v115
    v_fmac_f32 v234, v4, v148
    v_fmac_f32 v236, v12, v116
    v_fmac_f32 v234, v5, v149
    v_fmac_f32 v236, v13, v117
    v_fmac_f32 v234, v6, v150
    v_fmac_f32 v236, v14, v118
    v_fmac_f32 v234, v7, v151
    v_fmac_f32 v236, v15, v119
    v_mul_f32 v238, v16, v160
    v_mul_f32 v240, v24, v160
    v_fmac_f32 v238, v17, v161
    v_fmac_f32 v240, v25, v161
    v_fmac_f32 v238, v18, v162
    v_fmac_f32 v240, v26, v162
    v_fmac_f32 v238, v19, v163
    v_fmac_f32 v240, v27, v163
    v_fmac_f32 v238, v20, v164
    v_fmac_f32 v240, v28, v164
    v_fmac_f32 v238, v21, v165
    v_fmac_f32 v240, v29, v165
    v_fmac_f32 v238, v22, v166
    v_fmac_f32 v240, v30, v166
    v_fmac_f32 v238, v23, v167
    v_fmac_f32 v240, v31, v167
    v_mul_f32 v235, v32, v152
    v_mul_f32 v237, v40, v120
    v_fmac_f32 v235, v33, v153
    v_fmac_f32 v237, v41, v121
    v_fmac_f32 v235, v34, v154
    v_fmac_f32 v237, v42, v122
    v_fmac_f32 v235, v35, v155
    v_fmac_f32 v237, v43, v123
    v_fmac_f32 v235, v36, v156
    v_fmac_f32 v237, v44, v124
    v_fmac_f32 v235, v37, v157
    v_fmac_f32 v237, v45, v125
    v_fmac_f32 v235, v38, v158
    v_fmac_f32 v237, v46, v126
    v_fmac_f32 v235, v39, v159
    v_fmac_f32 v237, v47, v127
    v_mul_f32 v239, v48, v168
    v_mul_f32 v241, v56, v168
    v_fmac_f32 v239, v49, v169
    v_fmac_f32 v241, v57, v169
    v_fmac_f32 v239, v50, v170
    s_setprio 1
    s_waitcnt vmcnt(3) lgkmcnt(2)
    v_mfma_f32_32x32x16_bf16 v[0:15], v[64:67], v[176:179], 0
    ds_read_b64_tr_b16 v[184:185], v246 offset:2048
    ds_read_b64_tr_b16 v[188:189], v247 offset:2048
    v_fmac_f32 v241, v58, v170
    v_fmac_f32 v239, v51, v171
    v_fmac_f32 v241, v59, v171
    v_fmac_f32 v239, v52, v172
    s_mov_b32 m0, s68
    v_mfma_f32_32x32x16_bf16 v[16:31], v[68:71], v[176:179], 0
    buffer_load_dwordx4 v222, s[4:7], s44 offen sc1 lds
    buffer_load_dwordx4 v223, s[72:75], s44 offen offset:1024 sc1 lds
    s_waitcnt lgkmcnt(2)
    v_mad_u32_u16 v224, v224, s39, v248 op_sel:[1,0,0,0]
    v_mad_u32_u16 v225, v225, s39, v248 op_sel:[1,0,0,0]
    v_fmac_f32 v241, v60, v172
    v_fmac_f32 v239, v53, v173
    v_mfma_f32_32x32x16_bf16 v[32:47], v[64:67], v[180:183], 0
    v_add_u32 v226, s50, v251
    ds_read2_b32 v[226:227], v226 offset0:1 offset1:3
    v_fmac_f32 v241, v61, v173
    v_fmac_f32 v239, v54, v174
    v_fmac_f32 v241, v62, v174
    v_fmac_f32 v239, v55, v175
    v_fmac_f32 v241, v63, v175
    v_mfma_f32_32x32x16_bf16 v[48:63], v[68:71], v[180:183], 0
    s_waitcnt vmcnt(3) lgkmcnt(1)
    v_mfma_f32_32x32x8_bf16 v[0:15], v[72:73], v[184:185], v[0:15]
    ds_read_b64_tr_b16 v[176:177], v246 offset:4096
    ds_read_b64_tr_b16 v[178:179], v246 offset:5120
    ds_read_b64_tr_b16 v[180:181], v247 offset:4096
    ds_read_b64_tr_b16 v[182:183], v247 offset:5120
    s_mov_b32 m0, s69
    v_mfma_f32_32x32x8_bf16 v[16:31], v[76:77], v[184:185], v[16:31]
    buffer_load_dwordx4 v224, s[4:7], s45 offen sc1 lds
    buffer_load_dwordx4 v225, s[72:75], s45 offen offset:1024 sc1 lds
    s_waitcnt lgkmcnt(4)
    v_mad_u32_u16 v226, v226, s39, v248 op_sel:[1,0,0,0]
    v_mad_u32_u16 v227, v227, s39, v248 op_sel:[1,0,0,0]
    v_mfma_f32_32x32x8_bf16 v[32:47], v[72:73], v[188:189], v[32:47]
    v_mul_f32 v242, v0, v144
    v_fma_f32 v238, v8, v160, -v238
    v_fmac_f32 v242, v1, v145
    v_fmac_f32 v238, v9, v161
    v_fmac_f32 v242, v2, v146
    v_fmac_f32 v238, v10, v162
    v_fmac_f32 v242, v3, v147
    v_mfma_f32_32x32x8_bf16 v[48:63], v[76:77], v[188:189], v[48:63]
    s_setprio 0
    v_fmac_f32 v238, v11, v163
    v_fmac_f32 v242, v4, v148
    v_fmac_f32 v238, v12, v164
    v_fmac_f32 v242, v5, v149
    v_fmac_f32 v238, v13, v165
    v_fmac_f32 v242, v6, v150
    v_fmac_f32 v238, v14, v166
    v_fmac_f32 v242, v7, v151
    v_fmac_f32 v238, v15, v167
    v_fmac_f32 v236, v16, v112
    v_mul_f32 v244, v24, v160
    v_fmac_f32 v236, v17, v113
    v_fmac_f32 v244, v25, v161
    v_fmac_f32 v236, v18, v114
    v_fmac_f32 v244, v26, v162
    v_fmac_f32 v236, v19, v115
    v_fmac_f32 v244, v27, v163
    v_fmac_f32 v236, v20, v116
    v_fmac_f32 v244, v28, v164
    v_fmac_f32 v236, v21, v117
    v_fmac_f32 v244, v29, v165
    v_fmac_f32 v236, v22, v118
    v_fmac_f32 v244, v30, v166
    v_fmac_f32 v236, v23, v119
    v_fmac_f32 v244, v31, v167
    v_mul_f32 v243, v32, v152
    v_fma_f32 v239, v40, v168, -v239
    v_fmac_f32 v243, v33, v153
    v_fmac_f32 v239, v41, v169
    v_fmac_f32 v243, v34, v154
    v_fmac_f32 v239, v42, v170
    v_fmac_f32 v243, v35, v155
    v_fmac_f32 v239, v43, v171
    v_fmac_f32 v243, v36, v156
    v_fmac_f32 v239, v44, v172
    v_fmac_f32 v243, v37, v157
    v_fmac_f32 v239, v45, v173
    v_fmac_f32 v243, v38, v158
    v_fmac_f32 v239, v46, v174
    v_fmac_f32 v243, v39, v159
    v_fmac_f32 v239, v47, v175
    s_setprio 1
    s_waitcnt vmcnt(4) lgkmcnt(0)
    v_mfma_f32_32x32x16_bf16 v[0:15], v[64:67], v[176:179], 0
    ds_read_b64_tr_b16 v[184:185], v246 offset:6144
    ds_read_b64_tr_b16 v[188:189], v247 offset:6144
    v_fmac_f32 v237, v48, v120
    v_mul_f32 v245, v56, v168
    v_fmac_f32 v237, v49, v121
    v_fmac_f32 v245, v57, v169
    s_mov_b32 m0, s70
    v_mfma_f32_32x32x16_bf16 v[16:31], v[68:71], v[176:179], 0
    buffer_load_dwordx4 v226, s[4:7], s46 offen sc1 lds
    buffer_load_dwordx4 v227, s[72:75], s46 offen offset:1024 sc1 lds
    v_fmac_f32 v237, v50, v122
    v_fmac_f32 v245, v58, v170
    v_fmac_f32 v237, v51, v123
    v_fmac_f32 v245, v59, v171
    v_fmac_f32 v237, v52, v124
    v_mfma_f32_32x32x16_bf16 v[32:47], v[64:67], v[180:183], 0
    v_fmac_f32 v245, v60, v172
    v_fmac_f32 v237, v53, v125
    v_fmac_f32 v245, v61, v173
    v_fmac_f32 v237, v54, v126
    v_fmac_f32 v245, v62, v174
    v_fmac_f32 v237, v55, v127
    v_fmac_f32 v245, v63, v175
    v_mfma_f32_32x32x16_bf16 v[48:63], v[68:71], v[180:183], 0
    v_permlane32_swap_b32 v242, v234
    v_permlane32_swap_b32 v243, v235
    v_add_f32 v242, v242, v234
    v_add_f32 v243, v243, v235
    s_waitcnt vmcnt(4) lgkmcnt(0)
    v_mfma_f32_32x32x8_bf16 v[0:15], v[72:73], v[184:185], v[0:15]
    ds_read_b64_tr_b16 v[176:177], v246 offset:0
    ds_read_b64_tr_b16 v[178:179], v246 offset:1024
    ds_read_b64_tr_b16 v[180:181], v247 offset:0
    ds_read_b64_tr_b16 v[182:183], v247 offset:1024
    v_cvt_pk_bf16_f32 v242, v242, v243
    ds_write_b32 v230, v242 offset:512
    s_mov_b32 m0, s71
    v_mfma_f32_32x32x8_bf16 v[16:31], v[76:77], v[184:185], v[16:31]
    s_cmp_eq_u32 s33, 4
    s_cbranch_scc1 K2_g4_89
    buffer_load_dwordx4 v224, s[4:7], s47 offen sc1 lds
    buffer_load_dwordx4 v225, s[72:75], s47 offen offset:1024 sc1 lds
K2_back_90:
    s_sub_u32 s26, s48, s29
    s_mov_b32 s29, s48
    s_mov_b32 s30, s3
    s_bfe_u32 s56, s3, 0x40012
    s_cmp_lg_u32 s36, 0
    s_cselect_b32 s56, s56, 0
    v_mfma_f32_32x32x8_bf16 v[32:47], v[72:73], v[188:189], v[32:47]
    s_mov_b32 s32, s31
    s_mov_b32 s31, s35
    v_mul_f32 v242, v0, v144
    v_fma_f32 v240, v8, v160, -v240
    v_fmac_f32 v242, v1, v145
    v_fmac_f32 v240, v9, v161
    v_fmac_f32 v242, v2, v146
    v_mfma_f32_32x32x8_bf16 v[48:63], v[76:77], v[188:189], v[48:63]
    s_setprio 0
    v_fmac_f32 v240, v10, v162
    v_fmac_f32 v242, v3, v147
    v_fmac_f32 v240, v11, v163
    v_fmac_f32 v242, v4, v148
    v_fmac_f32 v240, v12, v164
    v_fmac_f32 v242, v5, v149
    v_fmac_f32 v240, v13, v165
    v_fmac_f32 v242, v6, v150
    v_fmac_f32 v240, v14, v166
    v_fmac_f32 v242, v7, v151
    v_fmac_f32 v240, v15, v167
    v_add_u32 v249, s26, v249
    v_add_u32 v250, s26, v250
    v_fma_f32 v244, v16, v160, -v244
    v_fmac_f32 v236, v24, v112
    v_fmac_f32 v244, v17, v161
    v_fmac_f32 v236, v25, v113
    v_fmac_f32 v244, v18, v162
    v_fmac_f32 v236, v26, v114
    v_fmac_f32 v244, v19, v163
    v_fmac_f32 v236, v27, v115
    v_fmac_f32 v244, v20, v164
    v_fmac_f32 v236, v28, v116
    v_fmac_f32 v244, v21, v165
    v_fmac_f32 v236, v29, v117
    v_fmac_f32 v244, v22, v166
    v_fmac_f32 v236, v30, v118
    v_fmac_f32 v244, v23, v167
    v_fmac_f32 v236, v31, v119
    ds_read_b64_tr_b16 v[0:1], v249 offset:0
    ds_read_b64_tr_b16 v[2:3], v249 offset:32
    ds_read_u16_d16_hi v16, v250 offset:0
    v_mul_f32 v243, v32, v152
    v_fma_f32 v241, v40, v168, -v241
    v_fmac_f32 v243, v33, v153
    v_fmac_f32 v241, v41, v169
    v_fmac_f32 v243, v34, v154
    v_fmac_f32 v241, v42, v170
    v_fmac_f32 v243, v35, v155
    v_fmac_f32 v241, v43, v171
    v_fmac_f32 v243, v36, v156
    v_fmac_f32 v241, v44, v172
    v_fmac_f32 v243, v37, v157
    v_fmac_f32 v241, v45, v173
    v_fmac_f32 v243, v38, v158
    v_fmac_f32 v241, v46, v174
    v_fmac_f32 v243, v39, v159
    v_fmac_f32 v241, v47, v175
    ds_read_b64_tr_b16 v[4:5], v249 offset:512
    ds_read_b64_tr_b16 v[6:7], v249 offset:544
    ds_read_u16_d16_hi v17, v250 offset:128
    v_fma_f32 v245, v48, v168, -v245
    v_fmac_f32 v237, v56, v120
    v_fmac_f32 v245, v49, v169
    v_fmac_f32 v237, v57, v121
    v_fmac_f32 v245, v50, v170
    v_fmac_f32 v237, v58, v122
    v_fmac_f32 v245, v51, v171
    v_fmac_f32 v237, v59, v123
    v_fmac_f32 v245, v52, v172
    v_fmac_f32 v237, v60, v124
    v_fmac_f32 v245, v53, v173
    v_fmac_f32 v237, v61, v125
    v_fmac_f32 v245, v54, v174
    v_fmac_f32 v237, v62, v126
    v_fmac_f32 v245, v55, v175
    v_fmac_f32 v237, v63, v127
    s_cmp_eq_u32 s56, 5
    s_cbranch_scc1 K2_U21
    s_cmp_eq_u32 s56, 6
    s_cbranch_scc1 K2_U3h1
    s_branch K2_DSP1
K2_PAD_SW:
    s_branch K2_HOP
K2_DSP0:
    s_cmp_eq_u32 s56, 4
    s_cbranch_scc1 K2_U20
    s_cmp_eq_u32 s56, 7
    s_cbranch_scc1 K2_U30
    s_cmp_gt_u32 s56, 7
    s_cbranch_scc1 K2_U40
    s_cmp_lg_u32 s56, 0
    s_cbranch_scc1 K2_U10
    s_branch K2_SWITCH
K2_DSP1:
    s_cmp_eq_u32 s56, 4
    s_cbranch_scc1 K2_U2h1
    s_cmp_eq_u32 s56, 7
    s_cbranch_scc1 K2_U31
    s_cmp_gt_u32 s56, 7
    s_cbranch_scc1 K2_U41
    s_cmp_lg_u32 s56, 0
    s_cbranch_scc1 K2_U11
    s_branch K2_TAIL
K2_SWITCH:
    v_lshlrev_b32 v60, 3, v252
    s_mov_b32 s64, 7176192
    buffer_load_dwordx4 v[56:59], v60, s[8:11], s64 offen sc1
    v_permlane32_swap_b32 v242, v236
    v_permlane32_swap_b32 v243, v237
    v_permlane32_swap_b32 v244, v238
    v_permlane32_swap_b32 v245, v239
    v_permlane32_swap_b32 v240, v241
    v_add_f32 v242, v242, v236
    v_add_f32 v243, v243, v237
    v_add_f32 v244, v244, v238
    v_add_f32 v245, v245, v239
    v_add_f32 v240, -v240, -v241
    s_set_gpr_idx_on s32, gpr_idx(DST)
    s_nop 0
    v_cvt_pk_bf16_f32 v195, v242, v243
    v_cvt_pk_bf16_f32 v196, v244, v245
    v_cvt_pk_bf16_f32 v197, v240, v240
    s_set_gpr_idx_off
    v_lshl_add_u32 v230, v252, 1, s35
    v_lshrrev_b32 v231, 6, v252
    v_mul_u32_u24 v231, 126, v231
    v_bfe_u32 v61, v253, 22, 6
    v_lshlrev_b32 v62, 21, v252
    s_mov_b32 s58, 264241152
    v_lshlrev_b32 v61, 2, v61
    v_bfi_b32 v62, s58, v62, v253
    ds_bpermute_b32 v253, v61, v62
    v_lshrrev_b32 v254, 6, v252
    v_bfe_u32 v255, v252, 3, 2
    v_lshl_add_u32 v254, v254, 2, v255
    v_mul_u32_u24 v254, 640, v254
    v_bfe_u32 v255, v252, 5, 1
    v_lshl_add_u32 v254, v255, 5, v254
    v_and_b32 v255, 6, v252
    v_lshl_add_u32 v254, v255, 2, v254
    v_add_u32 v254, 152832, v254
    ds_read_b64_tr_b16 v[104:105], v254 offset:0
    ds_read_b64_tr_b16 v[106:107], v254 offset:5120
    ds_read_b64_tr_b16 v[108:109], v254 offset:64
    ds_read_b64_tr_b16 v[110:111], v254 offset:5184
    ds_read_b64_tr_b16 v[120:121], v254 offset:128
    ds_read_b64_tr_b16 v[122:123], v254 offset:5248
    ds_read_b64_tr_b16 v[124:125], v254 offset:192
    ds_read_b64_tr_b16 v[126:127], v254 offset:5312
    ds_read_b64_tr_b16 v[136:137], v254 offset:256
    ds_read_b64_tr_b16 v[138:139], v254 offset:5376
    ds_read_b64_tr_b16 v[140:141], v254 offset:320
    ds_read_b64_tr_b16 v[142:143], v254 offset:5440
    ds_read_b64_tr_b16 v[152:153], v254 offset:384
    ds_read_b64_tr_b16 v[154:155], v254 offset:5504
    ds_read_b64_tr_b16 v[156:157], v254 offset:448
    ds_read_b64_tr_b16 v[158:159], v254 offset:5568
    ds_read_b64_tr_b16 v[168:169], v254 offset:512
    ds_read_b64_tr_b16 v[170:171], v254 offset:5632
    ds_read_b64_tr_b16 v[172:173], v254 offset:576
    ds_read_b64_tr_b16 v[174:175], v254 offset:5696
    s_movk_i32 s40, 128
    s_movk_i32 s41, 384
    s_movk_i32 s42, 640
    s_movk_i32 s43, 896
    v_lshl_add_u32 v254, v252, 1, s53
    v_bfe_u32 v255, v252, 4, 1
    s_waitcnt lgkmcnt(15)
    v_lshlrev_b32 v96, 16, v104
    v_and_b32 v97, 0xffff0000, v104
    v_lshlrev_b32 v98, 16, v105
    v_and_b32 v99, 0xffff0000, v105
    v_lshlrev_b32 v100, 16, v106
    v_and_b32 v101, 0xffff0000, v106
    v_lshlrev_b32 v102, 16, v107
    v_and_b32 v103, 0xffff0000, v107
    v_lshlrev_b32 v104, 16, v108
    v_and_b32 v105, 0xffff0000, v108
    v_lshlrev_b32 v106, 16, v109
    v_and_b32 v107, 0xffff0000, v109
    v_lshlrev_b32 v108, 16, v110
    v_and_b32 v109, 0xffff0000, v110
    v_lshlrev_b32 v110, 16, v111
    v_and_b32 v111, 0xffff0000, v111
    s_waitcnt lgkmcnt(12)
    v_lshlrev_b32 v112, 16, v120
    v_and_b32 v113, 0xffff0000, v120
    v_lshlrev_b32 v114, 16, v121
    v_and_b32 v115, 0xffff0000, v121
    v_lshlrev_b32 v116, 16, v122
    v_and_b32 v117, 0xffff0000, v122
    v_lshlrev_b32 v118, 16, v123
    v_and_b32 v119, 0xffff0000, v123
    v_lshlrev_b32 v120, 16, v124
    v_and_b32 v121, 0xffff0000, v124
    v_lshlrev_b32 v122, 16, v125
    v_and_b32 v123, 0xffff0000, v125
    v_lshlrev_b32 v124, 16, v126
    v_and_b32 v125, 0xffff0000, v126
    v_lshlrev_b32 v126, 16, v127
    v_and_b32 v127, 0xffff0000, v127
    s_waitcnt lgkmcnt(8)
    v_lshlrev_b32 v128, 16, v136
    v_and_b32 v129, 0xffff0000, v136
    v_lshlrev_b32 v130, 16, v137
    v_and_b32 v131, 0xffff0000, v137
    v_lshlrev_b32 v132, 16, v138
    v_and_b32 v133, 0xffff0000, v138
    v_lshlrev_b32 v134, 16, v139
    v_and_b32 v135, 0xffff0000, v139
    v_lshlrev_b32 v136, 16, v140
    v_and_b32 v137, 0xffff0000, v140
    v_lshlrev_b32 v138, 16, v141
    v_and_b32 v139, 0xffff0000, v141
    v_lshlrev_b32 v140, 16, v142
    v_and_b32 v141, 0xffff0000, v142
    v_lshlrev_b32 v142, 16, v143
    v_and_b32 v143, 0xffff0000, v143
    s_waitcnt lgkmcnt(4)
    v_lshlrev_b32 v144, 16, v152
    v_and_b32 v145, 0xffff0000, v152
    v_lshlrev_b32 v146, 16, v153
    v_and_b32 v147, 0xffff0000, v153
    v_lshlrev_b32 v148, 16, v154
    v_and_b32 v149, 0xffff0000, v154
    v_lshlrev_b32 v150, 16, v155
    v_and_b32 v151, 0xffff0000, v155
    v_lshlrev_b32 v152, 16, v156
    v_and_b32 v153, 0xffff0000, v156
    v_lshlrev_b32 v154, 16, v157
    v_and_b32 v155, 0xffff0000, v157
    v_lshlrev_b32 v156, 16, v158
    v_and_b32 v157, 0xffff0000, v158
    v_lshlrev_b32 v158, 16, v159
    v_and_b32 v159, 0xffff0000, v159
    s_waitcnt lgkmcnt(0)
    v_lshlrev_b32 v160, 16, v168
    v_and_b32 v161, 0xffff0000, v168
    v_lshlrev_b32 v162, 16, v169
    v_and_b32 v163, 0xffff0000, v169
    v_lshlrev_b32 v164, 16, v170
    v_and_b32 v165, 0xffff0000, v170
    v_lshlrev_b32 v166, 16, v171
    v_and_b32 v167, 0xffff0000, v171
    v_lshlrev_b32 v168, 16, v172
    v_and_b32 v169, 0xffff0000, v172
    v_lshlrev_b32 v170, 16, v173
    v_and_b32 v171, 0xffff0000, v173
    v_lshlrev_b32 v172, 16, v174
    v_and_b32 v173, 0xffff0000, v174
    v_lshlrev_b32 v174, 16, v175
    v_and_b32 v175, 0xffff0000, v175
K2_FLGW:
    s_or_b32 s58, s54, s20
    s_waitcnt vmcnt(0)
    v_xor_b32 v56, s2, v56
    v_xor_b32 v57, s2, v57
    v_xor_b32 v58, s2, v58
    v_xor_b32 v59, s2, v59
    v_or3_b32 v56, v56, v57, v58
    v_or_b32 v56, v56, v59
    v_cmp_ne_u32 vcc, 0, v56
    s_nop 0
    s_cbranch_vccnz K2_FLGR
    s_cmp_eq_u32 s58, 0
    s_cbranch_scc1 K2_FLGY
K2_FLGOK:
    s_cmp_eq_u32 s36, 0
    s_cbranch_scc1 K2_TAIL2
    s_mov_b32 s29, s48
    s_mov_b32 s32, s31
    s_mov_b32 s30, s3
    s_mov_b32 s31, s35
    s_bfe_u32 s56, s3, 0x40012
    s_cmp_eq_u32 s56, 5
    s_cbranch_scc1 K2_U21
    s_cmp_eq_u32 s56, 6
    s_cbranch_scc1 K2_U3h1
    s_branch K2_DSP1
K2_dum_4:
    v_mov_b32 v232, -1
    s_mov_b32 m0, 163312
    s_mov_b64 exec, 1
    buffer_load_dwordx4 v232, s[16:19], 0 offen lds
    buffer_load_dwordx4 v232, s[16:19], 0 offen lds
    s_mov_b64 exec, -1
    s_branch K2_back_6
K2_nul_12:
    s_mov_b32 s58, 63
    s_mov_b32 s36, 0
    s_branch K2_back_15
K2_spin_13:
    s_sub_u32 s27, s27, 1
    s_cbranch_scc1 K2_END
    ds_read_b32 v232, v254
    s_waitcnt lgkmcnt(0)
    s_branch K2_chk_14
K2_dyn_10:
    v_lshl_add_u32 v254, v252, 1, s53
    v_bfe_u32 v255, v252, 4, 1
    s_mov_b64 exec, 0x1ff
    ds_add_rtn_u32 v232, v254, v255
    s_mov_b64 exec, -1
    s_waitcnt lgkmcnt(0)
    v_readlane_b32 s58, v232, 8
    s_nop 0
    s_cmp_lt_u32 s58, s22
    s_cbranch_scc0 K2_nul_12
    s_nop 0
    v_readlane_b32 s3, v253, s58
    s_nop 0
    s_bfe_u32 s58, s3, 0x60016
    s_and_b32 s59, s58, 7
    s_lshr_b32 s60, s58, 3
K2_chk_14:
    v_readlane_b32 s61, v232, s59
    s_nop 0
    s_cmp_gt_u32 s61, s60
    s_cbranch_scc0 K2_spin_13
K2_back_15:
    s_mov_b32 s34, 1
    s_branch K2_back_11
K2_dum_21:
    v_mov_b32 v232, -1
    s_mov_b32 m0, 163312
    s_mov_b64 exec, 1
    buffer_load_dwordx4 v232, s[16:19], 0 offen lds
    buffer_load_dwordx4 v232, s[16:19], 0 offen lds
    s_mov_b64 exec, -1
    s_branch K2_back_23
K2_nul_27:
    s_mov_b32 s58, 63
    s_mov_b32 s36, 0
    s_branch K2_back_30
K2_spin_28:
    s_sub_u32 s27, s27, 1
    s_cbranch_scc1 K2_END
    ds_read_b32 v232, v254
    s_waitcnt lgkmcnt(0)
    s_branch K2_chk_29
K2_dyn_25:
    v_lshl_add_u32 v254, v252, 1, s53
    v_bfe_u32 v255, v252, 4, 1
    s_mov_b64 exec, 0x1ff
    ds_add_rtn_u32 v232, v254, v255
    s_mov_b64 exec, -1
    s_waitcnt lgkmcnt(0)
    v_readlane_b32 s58, v232, 8
    s_nop 0
    s_cmp_lt_u32 s58, s22
    s_cbranch_scc0 K2_nul_27
    s_nop 0
    v_readlane_b32 s3, v253, s58
    s_nop 0
    s_bfe_u32 s58, s3, 0x60016
    s_and_b32 s59, s58, 7
    s_lshr_b32 s60, s58, 3
K2_chk_29:
    v_readlane_b32 s61, v232, s59
    s_nop 0
    s_cmp_gt_u32 s61, s60
    s_cbranch_scc0 K2_spin_28
K2_back_30:
    s_mov_b32 s34, 1
    s_branch K2_back_26
K2_dum_36:
    v_mov_b32 v232, -1
    s_mov_b32 m0, 163312
    s_mov_b64 exec, 1
    buffer_load_dwordx4 v232, s[16:19], 0 offen lds
    buffer_load_dwordx4 v232, s[16:19], 0 offen lds
    s_mov_b64 exec, -1
    s_branch K2_back_38
K2_nul_42:
    s_mov_b32 s58, 63
    s_mov_b32 s36, 0
    s_branch K2_back_45
K2_spin_43:
    s_sub_u32 s27, s27, 1
    s_cbranch_scc1 K2_END
    ds_read_b32 v232, v254
    s_waitcnt lgkmcnt(0)
    s_branch K2_chk_44
K2_dyn_40:
    v_lshl_add_u32 v254, v252, 1, s53
    v_bfe_u32 v255, v252, 4, 1
    s_mov_b64 exec, 0x1ff
    ds_add_rtn_u32 v232, v254, v255
    s_mov_b64 exec, -1
    s_waitcnt lgkmcnt(0)
    v_readlane_b32 s58, v232, 8
    s_nop 0
    s_cmp_lt_u32 s58, s22
    s_cbranch_scc0 K2_nul_42
    s_nop 0
    v_readlane_b32 s3, v253, s58
    s_nop 0
    s_bfe_u32 s58, s3, 0x60016
    s_and_b32 s59, s58, 7
    s_lshr_b32 s60, s58, 3
K2_chk_44:
    v_readlane_b32 s61, v232, s59
    s_nop 0
    s_cmp_gt_u32 s61, s60
    s_cbranch_scc0 K2_spin_43
K2_back_45:
    s_mov_b32 s34, 1
    s_branch K2_back_41
K2_dum_51:
    v_mov_b32 v232, -1
    s_mov_b32 m0, 163312
    s_mov_b64 exec, 1
    buffer_load_dwordx4 v232, s[16:19], 0 offen lds
    buffer_load_dwordx4 v232, s[16:19], 0 offen lds
    s_mov_b64 exec, -1
    s_branch K2_back_53
K2_nul_55:
    s_mov_b32 s3, 949760
    s_mov_b32 s36, 0
    s_branch K2_back_58
K2_spin_56:
    s_sub_u32 s27, s27, 1
    s_cbranch_scc1 K2_END
    ds_read_b32 v232, v254
    s_waitcnt lgkmcnt(0)
    s_branch K2_chk_57
K2_nul_64:
    s_mov_b32 s3, 949760
    s_mov_b32 s36, 0
    s_branch K2_back_67
K2_spin_65:
    s_sub_u32 s27, s27, 1
    s_cbranch_scc1 K2_END
    ds_read_b32 v232, v254
    s_waitcnt lgkmcnt(0)
    s_branch K2_chk_66
K2_nul_73:
    s_mov_b32 s3, 949760
    s_mov_b32 s36, 0
    s_branch K2_back_76
K2_spin_74:
    s_sub_u32 s27, s27, 1
    s_cbranch_scc1 K2_END
    ds_read_b32 v232, v254
    s_waitcnt lgkmcnt(0)
    s_branch K2_chk_75
K2_nul_82:
    s_mov_b32 s3, 949760
    s_mov_b32 s36, 0
    s_branch K2_back_85
K2_spin_83:
    s_sub_u32 s27, s27, 1
    s_cbranch_scc1 K2_END
    ds_read_b32 v232, v254
    s_waitcnt lgkmcnt(0)
    s_branch K2_chk_84
K2_PAD_TL:
    s_branch K2_HOP
K2_TAIL2:
    v_lshlrev_b32 v229, 3, v252
    s_mul_i32 s58, s20, 20480
    s_add_u32 s58, s58, 6946816
    s_mul_i32 s59, s20, 8224
    buffer_load_dwordx4 v[96:99], v229, s[8:11], s58 offen offset:0 sc1
    buffer_load_dwordx4 v[100:103], v229, s[8:11], s58 offen offset:1024 sc1
    buffer_load_dwordx4 v[104:107], v229, s[8:11], s58 offen offset:2048 sc1
    buffer_load_dwordx4 v[108:111], v229, s[8:11], s58 offen offset:3072 sc1
    s_add_u32 s58, s58, 4096
    buffer_load_dwordx4 v[128:131], v229, s[8:11], s58 offen offset:0 sc1
    buffer_load_dwordx4 v[132:135], v229, s[8:11], s58 offen offset:1024 sc1
    buffer_load_dwordx4 v[136:139], v229, s[8:11], s58 offen offset:2048 sc1
    buffer_load_dwordx4 v[140:143], v229, s[8:11], s58 offen offset:3072 sc1
    v_lshl_add_u32 v228, v252, 1, s59
    v_lshrrev_b32 v226, 6, v252
    v_mul_u32_u24 v226, 126, v226
    v_sub_u32 v226, v228, v226
    s_branch K2_TAIL3
K2_TAIL:
    v_lshlrev_b32 v229, 3, v252
    s_mul_i32 s58, s20, 20480
    s_add_u32 s58, s58, 6946816
    s_mul_i32 s59, s20, 8224
    buffer_load_dwordx4 v[96:99], v229, s[8:11], s58 offen offset:0 sc1
    v_permlane32_swap_b32 v242, v236
    v_permlane32_swap_b32 v243, v237
    v_permlane32_swap_b32 v244, v238
    buffer_load_dwordx4 v[100:103], v229, s[8:11], s58 offen offset:1024 sc1
    v_permlane32_swap_b32 v245, v239
    v_permlane32_swap_b32 v240, v241
    v_add_f32 v242, v242, v236
    buffer_load_dwordx4 v[104:107], v229, s[8:11], s58 offen offset:2048 sc1
    v_add_f32 v243, v243, v237
    v_add_f32 v244, v244, v238
    v_add_f32 v245, v245, v239
    buffer_load_dwordx4 v[108:111], v229, s[8:11], s58 offen offset:3072 sc1
    v_add_f32 v240, -v240, -v241
    v_sub_u32 v241, v230, v231
    v_cvt_pk_bf16_f32 v242, v242, v243
    s_add_u32 s58, s58, 4096
    buffer_load_dwordx4 v[128:131], v229, s[8:11], s58 offen offset:0 sc1
    v_cvt_pk_bf16_f32 v244, v244, v245
    v_cvt_pk_bf16_f32 v240, v240, v240
    ds_write2st64_b32 v230, v242, v244 offset0:3 offset1:4
    buffer_load_dwordx4 v[132:135], v229, s[8:11], s58 offen offset:1024 sc1
    ds_write_b16 v241, v240 offset:1280
    v_lshl_add_u32 v228, v252, 1, s59
    v_lshrrev_b32 v226, 6, v252
    buffer_load_dwordx4 v[136:139], v229, s[8:11], s58 offen offset:2048 sc1
    v_mul_u32_u24 v226, 126, v226
    v_sub_u32 v226, v228, v226
    buffer_load_dwordx4 v[140:143], v229, s[8:11], s58 offen offset:3072 sc1
K2_TAIL3:
    s_waitcnt vmcnt(8)
    ds_write2st64_b32 v228, v192, v193 offset0:0 offset1:1
    ds_write2st64_b32 v228, v194, v195 offset0:2 offset1:3
    s_add_u32 s58, s58, 4096
    buffer_load_dwordx4 v[112:115], v229, s[8:11], s58 offen offset:0 sc1
    v_bfe_u32 v48, v252, 1, 4
    v_lshrrev_b32 v49, 5, v252
    ds_write_b16 v226, v197 offset:1280
    ds_write2st64_b32 v228, v196, v198 offset0:4 offset1:6
    buffer_load_dwordx4 v[116:119], v229, s[8:11], s58 offen offset:1024 sc1
    v_lshrrev_b32 v55, 3, v48
    v_lshlrev_b32 v52, 4, v49
    ds_write2st64_b32 v228, v199, v200 offset0:7 offset1:8
    ds_write2st64_b32 v228, v201, v202 offset0:9 offset1:10
    buffer_load_dwordx4 v[120:123], v229, s[8:11], s58 offen offset:2048 sc1
    v_lshl_add_u32 v54, v55, 2, v48
    v_and_b32 v54, 7, v54
    ds_write_b16 v226, v203 offset:2816
    ds_write2st64_b32 v228, v204, v205 offset0:12 offset1:13
    buffer_load_dwordx4 v[124:127], v229, s[8:11], s58 offen offset:3072 sc1
    v_and_b32 v50, 7, v48
    v_mul_u32_u24 v50, 8224, v50
    ds_write2st64_b32 v228, v206, v207 offset0:14 offset1:15
    ds_write2st64_b32 v228, v208, v210 offset0:16 offset1:18
    s_add_u32 s58, s58, 4096
    buffer_load_dwordx4 v[144:147], v229, s[8:11], s58 offen offset:0 sc1
    v_mul_u32_u24 v51, 1536, v55
    v_add_u32 v50, v50, v51
    ds_write_b16 v226, v209 offset:4352
    ds_write2st64_b32 v228, v211, v212 offset0:19 offset1:20
    buffer_load_dwordx4 v[148:151], v229, s[8:11], s58 offen offset:1024 sc1
    v_add_u32 v222, v50, v52
    v_mul_u32_u24 v51, 8224, v54
    ds_write2st64_b32 v228, v213, v214 offset0:21 offset1:22
    ds_write2st64_b32 v228, v216, v217 offset0:24 offset1:25
    buffer_load_dwordx4 v[152:155], v229, s[8:11], s58 offen offset:2048 sc1
    v_add_u32 v232, v51, v52
    v_lshl_add_u32 v247, v55, 7, v232
    ds_write_b16 v226, v215 offset:5888
    ds_write2st64_b32 v228, v218, v219 offset0:26 offset1:27
    buffer_load_dwordx4 v[156:159], v229, s[8:11], s58 offen offset:3072 sc1
    v_mul_u32_u24 v51, 2080, v48
    s_mov_b32 s60, 65536
    ds_write_b32 v228, v220 offset:7168
    ds_write_b16 v226, v221 offset:7424
    s_add_u32 s58, s58, 4096
    buffer_load_dwordx4 v[160:163], v229, s[8:11], s58 offen offset:0 sc1
    v_add3_u32 v223, v51, v52, s60
    v_mul_u32_u24 v51, 2080, v54
    buffer_load_dwordx4 v[164:167], v229, s[8:11], s58 offen offset:1024 sc1
    s_mov_b32 s60, 132096
    v_add3_u32 v225, v51, v52, s60
    buffer_load_dwordx4 v[168:171], v229, s[8:11], s58 offen offset:2048 sc1
    v_lshl_add_u32 v248, v55, 7, v225
    s_lshl_b32 s60, s20, 5
    buffer_load_dwordx4 v[172:175], v229, s[8:11], s58 offen offset:3072 sc1
    v_lshl_add_u32 v49, v49, 3, s60
    s_mov_b32 s60, 65536
    v_add3_u32 v255, v51, v49, s60
    v_lshl_add_u32 v246, v55, 9, v255
    v_bfe_u32 v53, v48, 2, 1
    v_lshl_add_u32 v49, v53, 4, v49
    v_add_u32 v254, v50, v49
    s_and_b32 s64, s55, s28
    s_waitcnt lgkmcnt(0)
    s_barrier
    s_cmp_eq_u32 s64, 0
    s_cbranch_scc1 K2_MULTI
    s_setprio 3
    ds_read_b128 v[48:51], v222 offset:0
    ds_read_b128 v[52:55], v222 offset:64
    ds_read_b128 v[56:59], v222 offset:896
    ds_read_b128 v[60:63], v222 offset:960
    ds_read_b128 v[64:67], v223 offset:0
    ds_read_b128 v[68:71], v223 offset:64
    ds_read_b128 v[72:75], v223 offset:896
    ds_read_b128 v[76:79], v223 offset:960
    ds_read_b128 v[80:83], v222 offset:3072
    ds_read_b128 v[84:87], v222 offset:3136
    ds_read_b128 v[88:91], v222 offset:3968
    s_waitcnt vmcnt(19) lgkmcnt(9)
    v_mfma_f32_16x16x32_bf16 v[0:3], v[96:99], v[48:51], 0
    ds_read_b128 v[92:95], v222 offset:4032
    s_waitcnt vmcnt(18)
    v_mfma_f32_16x16x32_bf16 v[0:3], v[100:103], v[52:55], v[0:3]
    ds_read_b128 v[48:51], v223 offset:33280
    s_waitcnt vmcnt(17) lgkmcnt(9)
    v_mfma_f32_16x16x32_bf16 v[0:3], v[104:107], v[56:59], v[0:3]
    s_bfe_u32 s60, s20, 0x10002
    s_lshl_b32 s60, s60, 4
    ds_read_b128 v[52:55], v223 offset:33344
    s_waitcnt vmcnt(16)
    v_mfma_f32_16x16x32_bf16 v[0:3], v[108:111], v[60:63], v[0:3]
    s_add_u32 s59, s59, s60
    v_add_u32 v228, s59, v229
    ds_read_b128 v[56:59], v223 offset:34176
    s_waitcnt vmcnt(15) lgkmcnt(9)
    v_mfma_f32_16x16x32_bf16 v[0:3], v[128:131], v[64:67], v[0:3]
    s_mul_i32 s60, s20, 2080
    s_add_u32 s60, s60, 65536
    ds_read_b128 v[60:63], v223 offset:34240
    s_waitcnt vmcnt(14)
    v_mfma_f32_16x16x32_bf16 v[0:3], v[132:135], v[68:71], v[0:3]
    v_add_u32 v249, s60, v229
    s_mov_b32 s63, 0xbfb8aa3b
    ds_read_b128 v[64:67], v232 offset:6144
    s_waitcnt vmcnt(13) lgkmcnt(9)
    v_mfma_f32_16x16x32_bf16 v[0:3], v[136:139], v[72:75], v[0:3]
    s_add_u32 s40, s20, s21
    s_lshl_b32 s40, s40, 10
    ds_read_b128 v[68:71], v232 offset:6208
    s_waitcnt vmcnt(12)
    v_mfma_f32_16x16x32_bf16 v[0:3], v[140:143], v[76:79], v[0:3]
    s_add_u32 s41, s40, 8192
    s_add_u32 s42, s40, 16384
    ds_read_b128 v[72:75], v232 offset:7040
    s_waitcnt lgkmcnt(9)
    v_mfma_f32_16x16x32_bf16 v[16:19], v[96:99], v[80:83], 0
    s_add_u32 s43, s40, 24576
    s_add_u32 s44, s40, 32768
    ds_read_b128 v[76:79], v232 offset:7104
    v_mfma_f32_16x16x32_bf16 v[16:19], v[100:103], v[84:87], v[16:19]
    ds_read_b128 v[80:83], v225 offset:0
    s_waitcnt lgkmcnt(9)
    v_mfma_f32_16x16x32_bf16 v[16:19], v[104:107], v[88:91], v[16:19]
    ds_read_b128 v[84:87], v225 offset:64
    v_mfma_f32_16x16x32_bf16 v[16:19], v[108:111], v[92:95], v[16:19]
    v_mul_f32 v204, s63, v0
    v_mul_f32 v205, s63, v1
    ds_read_b128 v[88:91], v225 offset:896
    s_waitcnt lgkmcnt(9)
    v_mfma_f32_16x16x32_bf16 v[16:19], v[128:131], v[48:51], v[16:19]
    v_mul_f32 v206, s63, v2
    ds_read_b128 v[92:95], v225 offset:960
    v_mfma_f32_16x16x32_bf16 v[16:19], v[132:135], v[52:55], v[16:19]
    v_mul_f32 v207, s63, v3
    ds_read_b128 v[48:51], v222 offset:128
    s_waitcnt lgkmcnt(9)
    v_mfma_f32_16x16x32_bf16 v[16:19], v[136:139], v[56:59], v[16:19]
    v_exp_f32 v204, v204
    ds_read_b128 v[52:55], v222 offset:384
    v_mfma_f32_16x16x32_bf16 v[16:19], v[140:143], v[60:63], v[16:19]
    v_exp_f32 v205, v205
    ds_read_b128 v[56:59], v222 offset:256
    s_waitcnt lgkmcnt(9)
    v_mfma_f32_16x16x32_bf16 v[32:35], v[96:99], v[64:67], 0
    v_exp_f32 v206, v206
    ds_read_b128 v[60:63], v222 offset:192
    v_mfma_f32_16x16x32_bf16 v[32:35], v[100:103], v[68:71], v[32:35]
    v_exp_f32 v207, v207
    s_setprio 2
    ds_read_b128 v[64:67], v222 offset:448
    s_waitcnt lgkmcnt(9)
    v_mfma_f32_16x16x32_bf16 v[32:35], v[104:107], v[72:75], v[32:35]
    v_add_f32 v204, 1.0, v204
    ds_read_b128 v[68:71], v222 offset:320
    v_mfma_f32_16x16x32_bf16 v[32:35], v[108:111], v[76:79], v[32:35]
    v_add_f32 v205, 1.0, v205
    v_add_f32 v206, 1.0, v206
    ds_read_b128 v[72:75], v222 offset:640
    s_waitcnt lgkmcnt(9)
    v_mfma_f32_16x16x32_bf16 v[32:35], v[128:131], v[80:83], v[32:35]
    v_add_f32 v207, 1.0, v207
    ds_read_b128 v[76:79], v222 offset:512
    v_mfma_f32_16x16x32_bf16 v[32:35], v[132:135], v[84:87], v[32:35]
    v_rcp_f32 v204, v204
    ds_read_b128 v[80:83], v222 offset:768
    s_waitcnt lgkmcnt(9)
    v_mfma_f32_16x16x32_bf16 v[32:35], v[136:139], v[88:91], v[32:35]
    v_rcp_f32 v205, v205
    ds_read_b128 v[84:87], v222 offset:704
    v_mfma_f32_16x16x32_bf16 v[32:35], v[140:143], v[92:95], v[32:35]
    v_rcp_f32 v206, v206
    ds_read_b128 v[88:91], v222 offset:576
    s_waitcnt vmcnt(11) lgkmcnt(9)
    v_mfma_f32_16x16x32_bf16 v[4:7], v[112:115], v[48:51], 0
    v_rcp_f32 v207, v207
    ds_read_b128 v[92:95], v222 offset:832
    v_mfma_f32_16x16x32_bf16 v[8:11], v[112:115], v[52:55], 0
    v_cvt_pk_bf16_f32 v176, v0, v1
    ds_read_b128 v[48:51], v222 offset:1024
    s_waitcnt lgkmcnt(9)
    v_mfma_f32_16x16x32_bf16 v[12:15], v[112:115], v[56:59], 0
    v_cvt_pk_bf16_f32 v177, v2, v3
    ds_read_b128 v[52:55], v222 offset:1280
    s_waitcnt vmcnt(10)
    v_mfma_f32_16x16x32_bf16 v[4:7], v[116:119], v[60:63], v[4:7]
    v_mul_f32 v208, s63, v16
    v_mul_f32 v209, s63, v17
    ds_read_b128 v[56:59], v222 offset:1152
    s_waitcnt lgkmcnt(9)
    v_mfma_f32_16x16x32_bf16 v[8:11], v[116:119], v[64:67], v[8:11]
    v_mul_f32 v210, s63, v18
    ds_read_b128 v[60:63], v222 offset:1088
    v_mfma_f32_16x16x32_bf16 v[12:15], v[116:119], v[68:71], v[12:15]
    v_mul_f32 v211, s63, v19
    ds_read_b128 v[64:67], v222 offset:1344
    s_waitcnt vmcnt(9) lgkmcnt(9)
    v_mfma_f32_16x16x32_bf16 v[4:7], v[120:123], v[72:75], v[4:7]
    v_exp_f32 v208, v208
    ds_read_b128 v[68:71], v222 offset:1216
    v_mfma_f32_16x16x32_bf16 v[8:11], v[120:123], v[76:79], v[8:11]
    v_exp_f32 v209, v209
    ds_read_b128 v[72:75], v223 offset:128
    s_waitcnt lgkmcnt(9)
    v_mfma_f32_16x16x32_bf16 v[12:15], v[120:123], v[80:83], v[12:15]
    v_exp_f32 v210, v210
    ds_read_b128 v[76:79], v223 offset:384
    s_waitcnt vmcnt(8)
    v_mfma_f32_16x16x32_bf16 v[4:7], v[124:127], v[84:87], v[4:7]
    v_exp_f32 v211, v211
    ds_read_b128 v[80:83], v223 offset:256
    s_waitcnt lgkmcnt(9)
    v_mfma_f32_16x16x32_bf16 v[8:11], v[124:127], v[88:91], v[8:11]
    v_add_f32 v208, 1.0, v208
    ds_read_b128 v[84:87], v223 offset:192
    v_mfma_f32_16x16x32_bf16 v[12:15], v[124:127], v[92:95], v[12:15]
    v_add_f32 v209, 1.0, v209
    v_add_f32 v210, 1.0, v210
    ds_read_b128 v[88:91], v223 offset:448
    s_waitcnt vmcnt(7) lgkmcnt(9)
    v_mfma_f32_16x16x32_bf16 v[4:7], v[144:147], v[48:51], v[4:7]
    v_add_f32 v211, 1.0, v211
    s_setprio 1
    ds_read_b128 v[92:95], v223 offset:320
    v_mfma_f32_16x16x32_bf16 v[8:11], v[144:147], v[52:55], v[8:11]
    v_rcp_f32 v208, v208
    ds_read_b128 v[48:51], v223 offset:640
    s_waitcnt lgkmcnt(9)
    v_mfma_f32_16x16x32_bf16 v[12:15], v[144:147], v[56:59], v[12:15]
    v_rcp_f32 v209, v209
    ds_read_b128 v[52:55], v223 offset:512
    s_waitcnt vmcnt(6)
    v_mfma_f32_16x16x32_bf16 v[4:7], v[148:151], v[60:63], v[4:7]
    v_rcp_f32 v210, v210
    ds_read_b128 v[56:59], v223 offset:768
    s_waitcnt lgkmcnt(9)
    v_mfma_f32_16x16x32_bf16 v[8:11], v[148:151], v[64:67], v[8:11]
    v_rcp_f32 v211, v211
    ds_read_b128 v[60:63], v223 offset:704
    v_mfma_f32_16x16x32_bf16 v[12:15], v[148:151], v[68:71], v[12:15]
K2_PAD_T2:
    s_cbranch_execz K2_HOP
    v_cvt_pk_bf16_f32 v184, v16, v17
    ds_read_b128 v[64:67], v223 offset:576
    s_waitcnt vmcnt(5) lgkmcnt(9)
    v_mfma_f32_16x16x32_bf16 v[4:7], v[152:155], v[72:75], v[4:7]
    v_cvt_pk_bf16_f32 v185, v18, v19
    ds_read_b128 v[68:71], v223 offset:832
    v_mfma_f32_16x16x32_bf16 v[8:11], v[152:155], v[76:79], v[8:11]
    v_mul_f32 v212, s63, v32
    v_mul_f32 v213, s63, v33
    ds_read_b128 v[72:75], v223 offset:1024
    s_waitcnt lgkmcnt(9)
    v_mfma_f32_16x16x32_bf16 v[12:15], v[152:155], v[80:83], v[12:15]
    v_mul_f32 v214, s63, v34
    ds_read_b128 v[76:79], v223 offset:1280
    s_waitcnt vmcnt(4)
    v_mfma_f32_16x16x32_bf16 v[4:7], v[156:159], v[84:87], v[4:7]
    v_mul_f32 v215, s63, v35
    ds_read_b128 v[80:83], v223 offset:1152
    s_waitcnt lgkmcnt(9)
    v_mfma_f32_16x16x32_bf16 v[8:11], v[156:159], v[88:91], v[8:11]
    v_exp_f32 v212, v212
    ds_read_b128 v[84:87], v223 offset:1088
    v_mfma_f32_16x16x32_bf16 v[12:15], v[156:159], v[92:95], v[12:15]
    v_exp_f32 v213, v213
    ds_read_b128 v[88:91], v223 offset:1344
    s_waitcnt vmcnt(3) lgkmcnt(9)
    v_mfma_f32_16x16x32_bf16 v[4:7], v[160:163], v[48:51], v[4:7]
    v_exp_f32 v214, v214
    ds_read_b128 v[92:95], v223 offset:1216
    v_mfma_f32_16x16x32_bf16 v[8:11], v[160:163], v[52:55], v[8:11]
    v_exp_f32 v215, v215
    ds_read_b128 v[48:51], v222 offset:3200
    s_waitcnt lgkmcnt(9)
    v_mfma_f32_16x16x32_bf16 v[12:15], v[160:163], v[56:59], v[12:15]
    v_add_f32 v212, 1.0, v212
    ds_read_b128 v[52:55], v222 offset:3456
    s_waitcnt vmcnt(2)
    v_mfma_f32_16x16x32_bf16 v[4:7], v[164:167], v[60:63], v[4:7]
    v_add_f32 v213, 1.0, v213
    v_add_f32 v214, 1.0, v214
    ds_read_b128 v[56:59], v222 offset:3328
    s_waitcnt lgkmcnt(9)
    v_mfma_f32_16x16x32_bf16 v[8:11], v[164:167], v[64:67], v[8:11]
    v_add_f32 v215, 1.0, v215
    ds_read_b128 v[60:63], v222 offset:3264
    v_mfma_f32_16x16x32_bf16 v[12:15], v[164:167], v[68:71], v[12:15]
    v_rcp_f32 v212, v212
    s_setprio 0
    ds_read_b128 v[64:67], v222 offset:3520
    s_waitcnt vmcnt(1) lgkmcnt(9)
    v_mfma_f32_16x16x32_bf16 v[4:7], v[168:171], v[72:75], v[4:7]
    v_rcp_f32 v213, v213
    ds_read_b128 v[68:71], v222 offset:3392
    v_mfma_f32_16x16x32_bf16 v[8:11], v[168:171], v[76:79], v[8:11]
    v_rcp_f32 v214, v214
    ds_read_b128 v[72:75], v222 offset:3712
    s_waitcnt lgkmcnt(9)
    v_mfma_f32_16x16x32_bf16 v[12:15], v[168:171], v[80:83], v[12:15]
    v_rcp_f32 v215, v215
    ds_read_b128 v[76:79], v222 offset:3584
    s_waitcnt vmcnt(0)
    v_mfma_f32_16x16x32_bf16 v[4:7], v[172:175], v[84:87], v[4:7]
    v_cvt_pk_bf16_f32 v220, v32, v33
    ds_read_b128 v[80:83], v222 offset:3840
    s_waitcnt lgkmcnt(9)
    v_mfma_f32_16x16x32_bf16 v[8:11], v[172:175], v[88:91], v[8:11]
    v_cvt_pk_bf16_f32 v221, v34, v35
    ds_read_b128 v[84:87], v222 offset:3776
    v_mfma_f32_16x16x32_bf16 v[12:15], v[172:175], v[92:95], v[12:15]
    ds_read_b128 v[88:91], v222 offset:3648
    s_waitcnt lgkmcnt(9)
    v_mfma_f32_16x16x32_bf16 v[20:23], v[112:115], v[48:51], 0
    ds_read_b128 v[92:95], v222 offset:3904
    v_mfma_f32_16x16x32_bf16 v[24:27], v[112:115], v[52:55], 0
    ds_read_b128 v[48:51], v222 offset:4096
    s_waitcnt lgkmcnt(9)
    v_mfma_f32_16x16x32_bf16 v[28:31], v[112:115], v[56:59], 0
    s_barrier
    s_setprio 3
    ds_read_b128 v[52:55], v222 offset:4352
    v_mfma_f32_16x16x32_bf16 v[20:23], v[116:119], v[60:63], v[20:23]
    v_mul_f32 v4, v4, v204
    ds_read_b128 v[56:59], v222 offset:4224
    s_waitcnt lgkmcnt(9)
    v_mfma_f32_16x16x32_bf16 v[24:27], v[116:119], v[64:67], v[24:27]
    v_mul_f32 v5, v5, v205
    ds_read_b128 v[60:63], v222 offset:4160
    v_mfma_f32_16x16x32_bf16 v[28:31], v[116:119], v[68:71], v[28:31]
    v_mul_f32 v6, v6, v206
    ds_read_b128 v[64:67], v222 offset:4416
    s_waitcnt lgkmcnt(9)
    v_mfma_f32_16x16x32_bf16 v[20:23], v[120:123], v[72:75], v[20:23]
    v_mul_f32 v7, v7, v207
    ds_read_b128 v[68:71], v222 offset:4288
    v_mfma_f32_16x16x32_bf16 v[24:27], v[120:123], v[76:79], v[24:27]
    v_cvt_pk_bf16_f32 v178, v4, v5
    ds_read_b128 v[72:75], v223 offset:33408
    s_waitcnt lgkmcnt(9)
    v_mfma_f32_16x16x32_bf16 v[28:31], v[120:123], v[80:83], v[28:31]
    v_cvt_pk_bf16_f32 v179, v6, v7
    ds_read_b128 v[76:79], v223 offset:33664
    v_mfma_f32_16x16x32_bf16 v[20:23], v[124:127], v[84:87], v[20:23]
    v_mul_f32 v8, v8, v204
    ds_read_b128 v[80:83], v223 offset:33536
    s_waitcnt lgkmcnt(9)
    v_mfma_f32_16x16x32_bf16 v[24:27], v[124:127], v[88:91], v[24:27]
    v_mul_f32 v9, v9, v205
    ds_read_b128 v[84:87], v223 offset:33472
    v_mfma_f32_16x16x32_bf16 v[28:31], v[124:127], v[92:95], v[28:31]
    v_mul_f32 v10, v10, v206
    ds_read_b128 v[88:91], v223 offset:33728
    s_waitcnt lgkmcnt(9)
    v_mfma_f32_16x16x32_bf16 v[20:23], v[144:147], v[48:51], v[20:23]
    v_mul_f32 v11, v11, v207
    s_setprio 2
    ds_read_b128 v[92:95], v223 offset:33600
    v_mfma_f32_16x16x32_bf16 v[24:27], v[144:147], v[52:55], v[24:27]
    v_cvt_pk_bf16_f32 v180, v8, v9
    ds_read_b128 v[48:51], v223 offset:33920
    s_waitcnt lgkmcnt(9)
    v_mfma_f32_16x16x32_bf16 v[28:31], v[144:147], v[56:59], v[28:31]
    v_cvt_pk_bf16_f32 v181, v10, v11
    ds_read_b128 v[52:55], v223 offset:33792
    v_mfma_f32_16x16x32_bf16 v[20:23], v[148:151], v[60:63], v[20:23]
    v_mul_f32 v12, v12, v204
    ds_read_b128 v[56:59], v223 offset:34048
    s_waitcnt lgkmcnt(9)
    v_mfma_f32_16x16x32_bf16 v[24:27], v[148:151], v[64:67], v[24:27]
    v_mul_f32 v13, v13, v205
    ds_read_b128 v[60:63], v223 offset:33984
    v_mfma_f32_16x16x32_bf16 v[28:31], v[148:151], v[68:71], v[28:31]
    v_mul_f32 v14, v14, v206
    ds_read_b128 v[64:67], v223 offset:33856
    s_waitcnt lgkmcnt(9)
    v_mfma_f32_16x16x32_bf16 v[20:23], v[152:155], v[72:75], v[20:23]
    v_mul_f32 v15, v15, v207
    ds_read_b128 v[68:71], v223 offset:34112
    v_mfma_f32_16x16x32_bf16 v[24:27], v[152:155], v[76:79], v[24:27]
    v_cvt_pk_bf16_f32 v182, v12, v13
    ds_read_b128 v[72:75], v223 offset:34304
    s_waitcnt lgkmcnt(9)
    v_mfma_f32_16x16x32_bf16 v[28:31], v[152:155], v[80:83], v[28:31]
    v_cvt_pk_bf16_f32 v183, v14, v15
    ds_read_b128 v[76:79], v223 offset:34560
    v_mfma_f32_16x16x32_bf16 v[20:23], v[156:159], v[84:87], v[20:23]
    ds_write_b64 v254, v[176:177] offset:0
    ds_write_b64 v254, v[178:179] offset:256
    ds_write_b64 v254, v[180:181] offset:512
    ds_write_b64 v254, v[182:183] offset:768
    ds_write_b64 v255, v[220:221] offset:0
    ds_read_b128 v[80:83], v223 offset:34432
    s_waitcnt lgkmcnt(14)
    v_mfma_f32_16x16x32_bf16 v[24:27], v[156:159], v[88:91], v[24:27]
    ds_read_b128 v[84:87], v223 offset:34368
    v_mfma_f32_16x16x32_bf16 v[28:31], v[156:159], v[92:95], v[28:31]
    s_setprio 1
    ds_read_b128 v[88:91], v223 offset:34624
    s_waitcnt lgkmcnt(14)
    v_mfma_f32_16x16x32_bf16 v[20:23], v[160:163], v[48:51], v[20:23]
    ds_read_b128 v[92:95], v223 offset:34496
    v_mfma_f32_16x16x32_bf16 v[24:27], v[160:163], v[52:55], v[24:27]
    ds_read_b128 v[48:51], v247 offset:6272
    s_waitcnt lgkmcnt(14)
    v_mfma_f32_16x16x32_bf16 v[28:31], v[160:163], v[56:59], v[28:31]
    ds_read_b128 v[52:55], v232 offset:6528
    v_mfma_f32_16x16x32_bf16 v[20:23], v[164:167], v[60:63], v[20:23]
    ds_read_b128 v[56:59], v247 offset:6336
    s_waitcnt lgkmcnt(14)
    v_mfma_f32_16x16x32_bf16 v[24:27], v[164:167], v[64:67], v[24:27]
    ds_read_b128 v[60:63], v232 offset:6592
    v_mfma_f32_16x16x32_bf16 v[28:31], v[164:167], v[68:71], v[28:31]
    ds_read_b128 v[64:67], v247 offset:6784
    s_waitcnt lgkmcnt(14)
    v_mfma_f32_16x16x32_bf16 v[20:23], v[168:171], v[72:75], v[20:23]
    ds_read_b128 v[68:71], v232 offset:6656
    v_mfma_f32_16x16x32_bf16 v[24:27], v[168:171], v[76:79], v[24:27]
    ds_read_b128 v[72:75], v247 offset:6848
    s_waitcnt lgkmcnt(9)
    v_mfma_f32_16x16x32_bf16 v[28:31], v[168:171], v[80:83], v[28:31]
    ds_read_b128 v[76:79], v232 offset:6720
    v_mfma_f32_16x16x32_bf16 v[20:23], v[172:175], v[84:87], v[20:23]
    s_setprio 0
    ds_read_b128 v[80:83], v247 offset:7168
    s_waitcnt lgkmcnt(9)
    v_mfma_f32_16x16x32_bf16 v[24:27], v[172:175], v[88:91], v[24:27]
    ds_read_b128 v[84:87], v232 offset:7424
    v_mfma_f32_16x16x32_bf16 v[28:31], v[172:175], v[92:95], v[28:31]
    ds_read_b128 v[88:91], v247 offset:7232
    s_waitcnt lgkmcnt(9)
    v_mfma_f32_16x16x32_bf16 v[36:39], v[112:115], v[48:51], 0
    ds_read_b128 v[92:95], v232 offset:7488
    v_mfma_f32_16x16x32_bf16 v[40:43], v[112:115], v[52:55], 0
    ds_read_b128 v[48:51], v248 offset:128
    s_waitcnt lgkmcnt(9)
    v_mfma_f32_16x16x32_bf16 v[36:39], v[116:119], v[56:59], v[36:39]
    s_barrier
    ds_read_b128 v[192:195], v228 offset:0
    ds_read_b128 v[196:199], v228 offset:1536
    s_setprio 3
    ds_read_b128 v[52:55], v225 offset:384
    v_mfma_f32_16x16x32_bf16 v[40:43], v[116:119], v[60:63], v[40:43]
    v_mul_f32 v20, v20, v208
    v_mul_f32 v21, v21, v209
    ds_read_b128 v[56:59], v248 offset:192
    s_waitcnt lgkmcnt(11)
    v_mfma_f32_16x16x32_bf16 v[36:39], v[120:123], v[64:67], v[36:39]
    v_mul_f32 v22, v22, v210
    ds_read_b128 v[60:63], v225 offset:448
    v_mfma_f32_16x16x32_bf16 v[40:43], v[120:123], v[68:71], v[40:43]
    v_mul_f32 v23, v23, v211
    ds_read_b128 v[64:67], v248 offset:640
    s_waitcnt lgkmcnt(11)
    v_mfma_f32_16x16x32_bf16 v[36:39], v[124:127], v[72:75], v[36:39]
    v_cvt_pk_bf16_f32 v186, v20, v21
    ds_read_b128 v[68:71], v225 offset:512
    v_mfma_f32_16x16x32_bf16 v[40:43], v[124:127], v[76:79], v[40:43]
    v_cvt_pk_bf16_f32 v187, v22, v23
    ds_read_b128 v[72:75], v248 offset:704
    s_waitcnt lgkmcnt(11)
    v_mfma_f32_16x16x32_bf16 v[36:39], v[144:147], v[80:83], v[36:39]
    v_mul_f32 v24, v24, v208
    v_mul_f32 v25, v25, v209
    s_waitcnt lgkmcnt(6)
    buffer_store_dwordx4 v[192:195], v229, s[12:15], s40 offen sc1
    buffer_store_dwordx4 v[196:199], v229, s[12:15], s41 offen sc1
    s_setprio 2
    ds_read_b128 v[76:79], v225 offset:576
    v_mfma_f32_16x16x32_bf16 v[40:43], v[144:147], v[84:87], v[40:43]
    v_mul_f32 v26, v26, v210
    ds_read_b128 v[80:83], v248 offset:1024
    v_mfma_f32_16x16x32_bf16 v[36:39], v[148:151], v[88:91], v[36:39]
    v_mul_f32 v27, v27, v211
    ds_read_b128 v[84:87], v225 offset:1280
    v_mfma_f32_16x16x32_bf16 v[40:43], v[148:151], v[92:95], v[40:43]
    v_cvt_pk_bf16_f32 v188, v24, v25
    ds_read_b128 v[88:91], v248 offset:1088
    s_waitcnt lgkmcnt(9)
    v_mfma_f32_16x16x32_bf16 v[36:39], v[152:155], v[48:51], v[36:39]
    v_cvt_pk_bf16_f32 v189, v26, v27
    ds_read_b128 v[92:95], v225 offset:1344
    v_mfma_f32_16x16x32_bf16 v[40:43], v[152:155], v[52:55], v[40:43]
    v_mul_f32 v28, v28, v208
    v_mul_f32 v29, v29, v209
    s_waitcnt lgkmcnt(8)
    v_mfma_f32_16x16x32_bf16 v[36:39], v[156:159], v[56:59], v[36:39]
    v_mul_f32 v30, v30, v210
    v_mfma_f32_16x16x32_bf16 v[40:43], v[156:159], v[60:63], v[40:43]
    v_mul_f32 v31, v31, v211
    s_setprio 1
    s_waitcnt lgkmcnt(6)
    v_mfma_f32_16x16x32_bf16 v[36:39], v[160:163], v[64:67], v[36:39]
    v_cvt_pk_bf16_f32 v190, v28, v29
    v_mfma_f32_16x16x32_bf16 v[40:43], v[160:163], v[68:71], v[40:43]
    v_cvt_pk_bf16_f32 v191, v30, v31
    s_waitcnt lgkmcnt(4)
    v_mfma_f32_16x16x32_bf16 v[36:39], v[164:167], v[72:75], v[36:39]
    ds_write_b64 v254, v[184:185] offset:3072
    ds_write_b64 v254, v[186:187] offset:3328
    ds_write_b64 v254, v[188:189] offset:3584
    ds_write_b64 v254, v[190:191] offset:3840
    v_mfma_f32_16x16x32_bf16 v[40:43], v[164:167], v[76:79], v[40:43]
    s_waitcnt lgkmcnt(6)
    v_mfma_f32_16x16x32_bf16 v[36:39], v[168:171], v[80:83], v[36:39]
    v_mfma_f32_16x16x32_bf16 v[40:43], v[168:171], v[84:87], v[40:43]
    s_setprio 0
    s_waitcnt lgkmcnt(4)
    v_mfma_f32_16x16x32_bf16 v[36:39], v[172:175], v[88:91], v[36:39]
    v_mfma_f32_16x16x32_bf16 v[40:43], v[172:175], v[92:95], v[40:43]
    s_nop 6
    v_mul_f32 v36, v36, v212
    v_mul_f32 v37, v37, v213
    v_mul_f32 v38, v38, v214
    v_mul_f32 v39, v39, v215
    v_cvt_pk_bf16_f32 v178, v36, v37
    v_cvt_pk_bf16_f32 v179, v38, v39
    v_mul_f32 v40, v40, v212
    v_mul_f32 v41, v41, v213
    v_mul_f32 v42, v42, v214
    v_mul_f32 v43, v43, v215
    v_cvt_pk_bf16_f32 v180, v40, v41
    v_cvt_pk_bf16_f32 v181, v42, v43
    ds_write_b64 v246, v[178:179] offset:256
    ds_write_b64 v255, v[180:181] offset:512
    s_waitcnt lgkmcnt(0)
    s_barrier
    ds_read_b128 v[192:195], v228 offset:3072
    ds_read_b128 v[196:199], v228 offset:4608
    ds_read_b128 v[200:203], v249
    s_waitcnt lgkmcnt(1)
    buffer_store_dwordx4 v[192:195], v229, s[12:15], s42 offen sc1
    buffer_store_dwordx4 v[196:199], v229, s[12:15], s43 offen sc1
K2_LASTROW:
    s_add_u32 s59, s20, 32
    s_cmp_ge_u32 s59, s22
    s_cbranch_scc1 K2_FIN
    s_waitcnt lgkmcnt(0)
    buffer_store_dwordx4 v[200:203], v229, s[12:15], s44 offen sc1
K2_FIN:
    s_endpgm
K2_MULTI:
    ds_read_b128 v[48:51], v222 offset:0
    ds_read_b128 v[52:55], v222 offset:64
    ds_read_b128 v[56:59], v222 offset:896
    ds_read_b128 v[60:63], v222 offset:960
    ds_read_b128 v[64:67], v223 offset:0
    ds_read_b128 v[68:71], v223 offset:64
    ds_read_b128 v[72:75], v223 offset:896
    ds_read_b128 v[76:79], v223 offset:960
    ds_read_b128 v[80:83], v222 offset:3072
    ds_read_b128 v[84:87], v222 offset:3136
    ds_read_b128 v[88:91], v222 offset:3968
    s_waitcnt vmcnt(19) lgkmcnt(9)
    v_mfma_f32_16x16x32_bf16 v[0:3], v[96:99], v[48:51], 0
    ds_read_b128 v[92:95], v222 offset:4032
    s_waitcnt vmcnt(18)
    v_mfma_f32_16x16x32_bf16 v[0:3], v[100:103], v[52:55], v[0:3]
    ds_read_b128 v[48:51], v223 offset:33280
    s_waitcnt vmcnt(17) lgkmcnt(9)
    v_mfma_f32_16x16x32_bf16 v[0:3], v[104:107], v[56:59], v[0:3]
    ds_read_b128 v[52:55], v223 offset:33344
    s_waitcnt vmcnt(16)
    v_mfma_f32_16x16x32_bf16 v[0:3], v[108:111], v[60:63], v[0:3]
    ds_read_b128 v[56:59], v223 offset:34176
    s_waitcnt vmcnt(15) lgkmcnt(9)
    v_mfma_f32_16x16x32_bf16 v[0:3], v[128:131], v[64:67], v[0:3]
    ds_read_b128 v[60:63], v223 offset:34240
    s_waitcnt vmcnt(14)
    v_mfma_f32_16x16x32_bf16 v[0:3], v[132:135], v[68:71], v[0:3]
    ds_read_b128 v[64:67], v232 offset:6144
    s_waitcnt vmcnt(13) lgkmcnt(9)
    v_mfma_f32_16x16x32_bf16 v[0:3], v[136:139], v[72:75], v[0:3]
    ds_read_b128 v[68:71], v232 offset:6208
    s_waitcnt vmcnt(12)
    v_mfma_f32_16x16x32_bf16 v[0:3], v[140:143], v[76:79], v[0:3]
    ds_read_b128 v[72:75], v232 offset:7040
    s_waitcnt lgkmcnt(9)
    v_mfma_f32_16x16x32_bf16 v[16:19], v[96:99], v[80:83], 0
    ds_read_b128 v[76:79], v232 offset:7104
    v_mfma_f32_16x16x32_bf16 v[16:19], v[100:103], v[84:87], v[16:19]
    ds_read_b128 v[80:83], v225 offset:0
    s_waitcnt lgkmcnt(9)
    v_mfma_f32_16x16x32_bf16 v[16:19], v[104:107], v[88:91], v[16:19]
    ds_read_b128 v[84:87], v225 offset:64
    v_mfma_f32_16x16x32_bf16 v[16:19], v[108:111], v[92:95], v[16:19]
    ds_read_b128 v[88:91], v225 offset:896
    s_waitcnt lgkmcnt(9)
    v_mfma_f32_16x16x32_bf16 v[16:19], v[128:131], v[48:51], v[16:19]
    ds_read_b128 v[92:95], v225 offset:960
    v_mfma_f32_16x16x32_bf16 v[16:19], v[132:135], v[52:55], v[16:19]
    ds_read_b128 v[48:51], v222 offset:128
    s_waitcnt lgkmcnt(9)
    v_mfma_f32_16x16x32_bf16 v[16:19], v[136:139], v[56:59], v[16:19]
    ds_read_b128 v[52:55], v222 offset:384
    v_mfma_f32_16x16x32_bf16 v[16:19], v[140:143], v[60:63], v[16:19]
    ds_read_b128 v[56:59], v222 offset:256
    s_waitcnt lgkmcnt(9)
    v_mfma_f32_16x16x32_bf16 v[32:35], v[96:99], v[64:67], 0
    ds_read_b128 v[60:63], v222 offset:192
    v_mfma_f32_16x16x32_bf16 v[32:35], v[100:103], v[68:71], v[32:35]
    ds_read_b128 v[64:67], v222 offset:448
    s_waitcnt lgkmcnt(9)
    v_mfma_f32_16x16x32_bf16 v[32:35], v[104:107], v[72:75], v[32:35]
    ds_read_b128 v[68:71], v222 offset:320
    v_mfma_f32_16x16x32_bf16 v[32:35], v[108:111], v[76:79], v[32:35]
    ds_read_b128 v[72:75], v222 offset:640
    s_waitcnt lgkmcnt(9)
    v_mfma_f32_16x16x32_bf16 v[32:35], v[128:131], v[80:83], v[32:35]
    ds_read_b128 v[76:79], v222 offset:512
    v_mfma_f32_16x16x32_bf16 v[32:35], v[132:135], v[84:87], v[32:35]
    ds_read_b128 v[80:83], v222 offset:768
    s_waitcnt lgkmcnt(9)
    v_mfma_f32_16x16x32_bf16 v[32:35], v[136:139], v[88:91], v[32:35]
    ds_read_b128 v[84:87], v222 offset:704
    v_mfma_f32_16x16x32_bf16 v[32:35], v[140:143], v[92:95], v[32:35]
    ds_read_b128 v[88:91], v222 offset:576
    s_waitcnt vmcnt(11) lgkmcnt(9)
    v_mfma_f32_16x16x32_bf16 v[4:7], v[112:115], v[48:51], 0
    ds_read_b128 v[92:95], v222 offset:832
    v_mfma_f32_16x16x32_bf16 v[8:11], v[112:115], v[52:55], 0
    ds_read_b128 v[48:51], v222 offset:1024
    s_waitcnt lgkmcnt(9)
    v_mfma_f32_16x16x32_bf16 v[12:15], v[112:115], v[56:59], 0
    ds_read_b128 v[52:55], v222 offset:1280
    s_waitcnt vmcnt(10)
    v_mfma_f32_16x16x32_bf16 v[4:7], v[116:119], v[60:63], v[4:7]
    ds_read_b128 v[56:59], v222 offset:1152
    s_waitcnt lgkmcnt(9)
    v_mfma_f32_16x16x32_bf16 v[8:11], v[116:119], v[64:67], v[8:11]
    ds_read_b128 v[60:63], v222 offset:1088
    v_mfma_f32_16x16x32_bf16 v[12:15], v[116:119], v[68:71], v[12:15]
    ds_read_b128 v[64:67], v222 offset:1344
    s_waitcnt vmcnt(9) lgkmcnt(9)
    v_mfma_f32_16x16x32_bf16 v[4:7], v[120:123], v[72:75], v[4:7]
    ds_read_b128 v[68:71], v222 offset:1216
    v_mfma_f32_16x16x32_bf16 v[8:11], v[120:123], v[76:79], v[8:11]
    ds_read_b128 v[72:75], v223 offset:128
    s_waitcnt lgkmcnt(9)
    v_mfma_f32_16x16x32_bf16 v[12:15], v[120:123], v[80:83], v[12:15]
    ds_read_b128 v[76:79], v223 offset:384
    s_waitcnt vmcnt(8)
    v_mfma_f32_16x16x32_bf16 v[4:7], v[124:127], v[84:87], v[4:7]
    ds_read_b128 v[80:83], v223 offset:256
    s_waitcnt lgkmcnt(9)
    v_mfma_f32_16x16x32_bf16 v[8:11], v[124:127], v[88:91], v[8:11]
    ds_read_b128 v[84:87], v223 offset:192
    v_mfma_f32_16x16x32_bf16 v[12:15], v[124:127], v[92:95], v[12:15]
    ds_read_b128 v[88:91], v223 offset:448
    s_waitcnt vmcnt(7) lgkmcnt(9)
    v_mfma_f32_16x16x32_bf16 v[4:7], v[144:147], v[48:51], v[4:7]
    ds_read_b128 v[92:95], v223 offset:320
    v_mfma_f32_16x16x32_bf16 v[8:11], v[144:147], v[52:55], v[8:11]
    ds_read_b128 v[48:51], v223 offset:640
    s_waitcnt lgkmcnt(9)
    v_mfma_f32_16x16x32_bf16 v[12:15], v[144:147], v[56:59], v[12:15]
    ds_read_b128 v[52:55], v223 offset:512
    s_waitcnt vmcnt(6)
    v_mfma_f32_16x16x32_bf16 v[4:7], v[148:151], v[60:63], v[4:7]
    ds_read_b128 v[56:59], v223 offset:768
    s_waitcnt lgkmcnt(9)
    v_mfma_f32_16x16x32_bf16 v[8:11], v[148:151], v[64:67], v[8:11]
    ds_read_b128 v[60:63], v223 offset:704
    v_mfma_f32_16x16x32_bf16 v[12:15], v[148:151], v[68:71], v[12:15]
    ds_read_b128 v[64:67], v223 offset:576
    s_waitcnt vmcnt(5) lgkmcnt(9)
    v_mfma_f32_16x16x32_bf16 v[4:7], v[152:155], v[72:75], v[4:7]
    ds_read_b128 v[68:71], v223 offset:832
    v_mfma_f32_16x16x32_bf16 v[8:11], v[152:155], v[76:79], v[8:11]
    ds_read_b128 v[72:75], v223 offset:1024
    s_waitcnt lgkmcnt(9)
    v_mfma_f32_16x16x32_bf16 v[12:15], v[152:155], v[80:83], v[12:15]
    ds_read_b128 v[76:79], v223 offset:1280
    s_waitcnt vmcnt(4)
    v_mfma_f32_16x16x32_bf16 v[4:7], v[156:159], v[84:87], v[4:7]
    ds_read_b128 v[80:83], v223 offset:1152
    s_waitcnt lgkmcnt(9)
    v_mfma_f32_16x16x32_bf16 v[8:11], v[156:159], v[88:91], v[8:11]
    ds_read_b128 v[84:87], v223 offset:1088
    v_mfma_f32_16x16x32_bf16 v[12:15], v[156:159], v[92:95], v[12:15]
    ds_read_b128 v[88:91], v223 offset:1344
    s_waitcnt vmcnt(3) lgkmcnt(9)
    v_mfma_f32_16x16x32_bf16 v[4:7], v[160:163], v[48:51], v[4:7]
    ds_read_b128 v[92:95], v223 offset:1216
    v_mfma_f32_16x16x32_bf16 v[8:11], v[160:163], v[52:55], v[8:11]
    ds_read_b128 v[48:51], v222 offset:3200
    s_waitcnt lgkmcnt(9)
    v_mfma_f32_16x16x32_bf16 v[12:15], v[160:163], v[56:59], v[12:15]
    ds_read_b128 v[52:55], v222 offset:3456
    s_waitcnt vmcnt(2)
    v_mfma_f32_16x16x32_bf16 v[4:7], v[164:167], v[60:63], v[4:7]
    ds_read_b128 v[56:59], v222 offset:3328
    s_waitcnt lgkmcnt(9)
    v_mfma_f32_16x16x32_bf16 v[8:11], v[164:167], v[64:67], v[8:11]
    ds_read_b128 v[60:63], v222 offset:3264
    v_mfma_f32_16x16x32_bf16 v[12:15], v[164:167], v[68:71], v[12:15]
    ds_read_b128 v[64:67], v222 offset:3520
    s_waitcnt vmcnt(1) lgkmcnt(9)
    v_mfma_f32_16x16x32_bf16 v[4:7], v[168:171], v[72:75], v[4:7]
    ds_read_b128 v[68:71], v222 offset:3392
    v_mfma_f32_16x16x32_bf16 v[8:11], v[168:171], v[76:79], v[8:11]
    ds_read_b128 v[72:75], v222 offset:3712
    s_waitcnt lgkmcnt(9)
    v_mfma_f32_16x16x32_bf16 v[12:15], v[168:171], v[80:83], v[12:15]
    ds_read_b128 v[76:79], v222 offset:3584
    s_waitcnt vmcnt(0)
    v_mfma_f32_16x16x32_bf16 v[4:7], v[172:175], v[84:87], v[4:7]
    ds_read_b128 v[80:83], v222 offset:3840
    s_waitcnt lgkmcnt(9)
    v_mfma_f32_16x16x32_bf16 v[8:11], v[172:175], v[88:91], v[8:11]
    ds_read_b128 v[84:87], v222 offset:3776
    v_mfma_f32_16x16x32_bf16 v[12:15], v[172:175], v[92:95], v[12:15]
    ds_read_b128 v[88:91], v222 offset:3648
    s_waitcnt lgkmcnt(9)
    v_mfma_f32_16x16x32_bf16 v[20:23], v[112:115], v[48:51], 0
    ds_read_b128 v[92:95], v222 offset:3904
    v_mfma_f32_16x16x32_bf16 v[24:27], v[112:115], v[52:55], 0
    ds_read_b128 v[48:51], v222 offset:4096
    s_waitcnt lgkmcnt(9)
    v_mfma_f32_16x16x32_bf16 v[28:31], v[112:115], v[56:59], 0
    ds_read_b128 v[52:55], v222 offset:4352
    v_mfma_f32_16x16x32_bf16 v[20:23], v[116:119], v[60:63], v[20:23]
    ds_read_b128 v[56:59], v222 offset:4224
    s_waitcnt lgkmcnt(9)
    v_mfma_f32_16x16x32_bf16 v[24:27], v[116:119], v[64:67], v[24:27]
    ds_read_b128 v[60:63], v222 offset:4160
    v_mfma_f32_16x16x32_bf16 v[28:31], v[116:119], v[68:71], v[28:31]
    ds_read_b128 v[64:67], v222 offset:4416
    s_waitcnt lgkmcnt(9)
    v_mfma_f32_16x16x32_bf16 v[20:23], v[120:123], v[72:75], v[20:23]
    ds_read_b128 v[68:71], v222 offset:4288
    v_mfma_f32_16x16x32_bf16 v[24:27], v[120:123], v[76:79], v[24:27]
    ds_read_b128 v[72:75], v223 offset:33408
    s_waitcnt lgkmcnt(9)
    v_mfma_f32_16x16x32_bf16 v[28:31], v[120:123], v[80:83], v[28:31]
    ds_read_b128 v[76:79], v223 offset:33664
    v_mfma_f32_16x16x32_bf16 v[20:23], v[124:127], v[84:87], v[20:23]
    ds_read_b128 v[80:83], v223 offset:33536
    s_waitcnt lgkmcnt(9)
    v_mfma_f32_16x16x32_bf16 v[24:27], v[124:127], v[88:91], v[24:27]
    ds_read_b128 v[84:87], v223 offset:33472
    v_mfma_f32_16x16x32_bf16 v[28:31], v[124:127], v[92:95], v[28:31]
    ds_read_b128 v[88:91], v223 offset:33728
    s_waitcnt lgkmcnt(9)
    v_mfma_f32_16x16x32_bf16 v[20:23], v[144:147], v[48:51], v[20:23]
    ds_read_b128 v[92:95], v223 offset:33600
    v_mfma_f32_16x16x32_bf16 v[24:27], v[144:147], v[52:55], v[24:27]
    ds_read_b128 v[48:51], v223 offset:33920
    s_waitcnt lgkmcnt(9)
    v_mfma_f32_16x16x32_bf16 v[28:31], v[144:147], v[56:59], v[28:31]
    ds_read_b128 v[52:55], v223 offset:33792
    v_mfma_f32_16x16x32_bf16 v[20:23], v[148:151], v[60:63], v[20:23]
    ds_read_b128 v[56:59], v223 offset:34048
    s_waitcnt lgkmcnt(9)
    v_mfma_f32_16x16x32_bf16 v[24:27], v[148:151], v[64:67], v[24:27]
    ds_read_b128 v[60:63], v223 offset:33984
    v_mfma_f32_16x16x32_bf16 v[28:31], v[148:151], v[68:71], v[28:31]
    ds_read_b128 v[64:67], v223 offset:33856
    s_waitcnt lgkmcnt(9)
    v_mfma_f32_16x16x32_bf16 v[20:23], v[152:155], v[72:75], v[20:23]
    ds_read_b128 v[68:71], v223 offset:34112
    v_mfma_f32_16x16x32_bf16 v[24:27], v[152:155], v[76:79], v[24:27]
    ds_read_b128 v[72:75], v223 offset:34304
    s_waitcnt lgkmcnt(9)
    v_mfma_f32_16x16x32_bf16 v[28:31], v[152:155], v[80:83], v[28:31]
    ds_read_b128 v[76:79], v223 offset:34560
    v_mfma_f32_16x16x32_bf16 v[20:23], v[156:159], v[84:87], v[20:23]
    ds_read_b128 v[80:83], v223 offset:34432
    s_waitcnt lgkmcnt(9)
    v_mfma_f32_16x16x32_bf16 v[24:27], v[156:159], v[88:91], v[24:27]
    ds_read_b128 v[84:87], v223 offset:34368
    v_mfma_f32_16x16x32_bf16 v[28:31], v[156:159], v[92:95], v[28:31]
    ds_read_b128 v[88:91], v223 offset:34624
    s_waitcnt lgkmcnt(9)
    v_mfma_f32_16x16x32_bf16 v[20:23], v[160:163], v[48:51], v[20:23]
    ds_read_b128 v[92:95], v223 offset:34496
    v_mfma_f32_16x16x32_bf16 v[24:27], v[160:163], v[52:55], v[24:27]
    ds_read_b128 v[48:51], v247 offset:6272
    s_waitcnt lgkmcnt(9)
    v_mfma_f32_16x16x32_bf16 v[28:31], v[160:163], v[56:59], v[28:31]
    ds_read_b128 v[52:55], v232 offset:6528
    v_mfma_f32_16x16x32_bf16 v[20:23], v[164:167], v[60:63], v[20:23]
    ds_read_b128 v[56:59], v247 offset:6336
    s_waitcnt lgkmcnt(9)
    v_mfma_f32_16x16x32_bf16 v[24:27], v[164:167], v[64:67], v[24:27]
    ds_read_b128 v[60:63], v232 offset:6592
    v_mfma_f32_16x16x32_bf16 v[28:31], v[164:167], v[68:71], v[28:31]
    ds_read_b128 v[64:67], v247 offset:6784
    s_waitcnt lgkmcnt(9)
    v_mfma_f32_16x16x32_bf16 v[20:23], v[168:171], v[72:75], v[20:23]
    ds_read_b128 v[68:71], v232 offset:6656
    v_mfma_f32_16x16x32_bf16 v[24:27], v[168:171], v[76:79], v[24:27]
    ds_read_b128 v[72:75], v247 offset:6848
    s_waitcnt lgkmcnt(9)
    v_mfma_f32_16x16x32_bf16 v[28:31], v[168:171], v[80:83], v[28:31]
    ds_read_b128 v[76:79], v232 offset:6720
    v_mfma_f32_16x16x32_bf16 v[20:23], v[172:175], v[84:87], v[20:23]
    ds_read_b128 v[80:83], v247 offset:7168
    s_waitcnt lgkmcnt(9)
    v_mfma_f32_16x16x32_bf16 v[24:27], v[172:175], v[88:91], v[24:27]
    ds_read_b128 v[84:87], v232 offset:7424
    v_mfma_f32_16x16x32_bf16 v[28:31], v[172:175], v[92:95], v[28:31]
    ds_read_b128 v[88:91], v247 offset:7232
    s_waitcnt lgkmcnt(9)
    v_mfma_f32_16x16x32_bf16 v[36:39], v[112:115], v[48:51], 0
    ds_read_b128 v[92:95], v232 offset:7488
    v_mfma_f32_16x16x32_bf16 v[40:43], v[112:115], v[52:55], 0
    ds_read_b128 v[48:51], v248 offset:128
    s_waitcnt lgkmcnt(9)
    v_mfma_f32_16x16x32_bf16 v[36:39], v[116:119], v[56:59], v[36:39]
    ds_read_b128 v[52:55], v225 offset:384
    v_mfma_f32_16x16x32_bf16 v[40:43], v[116:119], v[60:63], v[40:43]
    ds_read_b128 v[56:59], v248 offset:192
    s_waitcnt lgkmcnt(9)
    v_mfma_f32_16x16x32_bf16 v[36:39], v[120:123], v[64:67], v[36:39]
    ds_read_b128 v[60:63], v225 offset:448
    v_mfma_f32_16x16x32_bf16 v[40:43], v[120:123], v[68:71], v[40:43]
    ds_read_b128 v[64:67], v248 offset:640
    s_waitcnt lgkmcnt(9)
    v_mfma_f32_16x16x32_bf16 v[36:39], v[124:127], v[72:75], v[36:39]
    ds_read_b128 v[68:71], v225 offset:512
    v_mfma_f32_16x16x32_bf16 v[40:43], v[124:127], v[76:79], v[40:43]
    ds_read_b128 v[72:75], v248 offset:704
    s_waitcnt lgkmcnt(9)
    v_mfma_f32_16x16x32_bf16 v[36:39], v[144:147], v[80:83], v[36:39]
    ds_read_b128 v[76:79], v225 offset:576
    v_mfma_f32_16x16x32_bf16 v[40:43], v[144:147], v[84:87], v[40:43]
    ds_read_b128 v[80:83], v248 offset:1024
    s_waitcnt lgkmcnt(9)
    v_mfma_f32_16x16x32_bf16 v[36:39], v[148:151], v[88:91], v[36:39]
    ds_read_b128 v[84:87], v225 offset:1280
    v_mfma_f32_16x16x32_bf16 v[40:43], v[148:151], v[92:95], v[40:43]
    ds_read_b128 v[88:91], v248 offset:1088
    s_waitcnt lgkmcnt(9)
    v_mfma_f32_16x16x32_bf16 v[36:39], v[152:155], v[48:51], v[36:39]
    ds_read_b128 v[92:95], v225 offset:1344
    v_mfma_f32_16x16x32_bf16 v[40:43], v[152:155], v[52:55], v[40:43]
    s_waitcnt lgkmcnt(8)
    v_mfma_f32_16x16x32_bf16 v[36:39], v[156:159], v[56:59], v[36:39]
    v_mfma_f32_16x16x32_bf16 v[40:43], v[156:159], v[60:63], v[40:43]
    s_waitcnt lgkmcnt(6)
    v_mfma_f32_16x16x32_bf16 v[36:39], v[160:163], v[64:67], v[36:39]
    v_mfma_f32_16x16x32_bf16 v[40:43], v[160:163], v[68:71], v[40:43]
    s_waitcnt lgkmcnt(4)
    v_mfma_f32_16x16x32_bf16 v[36:39], v[164:167], v[72:75], v[36:39]
    v_mfma_f32_16x16x32_bf16 v[40:43], v[164:167], v[76:79], v[40:43]
    s_waitcnt lgkmcnt(2)
    v_mfma_f32_16x16x32_bf16 v[36:39], v[168:171], v[80:83], v[36:39]
    v_mfma_f32_16x16x32_bf16 v[40:43], v[168:171], v[84:87], v[40:43]
    s_waitcnt lgkmcnt(0)
    v_mfma_f32_16x16x32_bf16 v[36:39], v[172:175], v[88:91], v[36:39]
    v_mfma_f32_16x16x32_bf16 v[40:43], v[172:175], v[92:95], v[40:43]
    s_lshl_b32 s60, s54, 9
    s_lshl_b32 s61, s20, 6
    s_add_u32 s60, s60, s61
    s_mul_i32 s60, s60, 192
    s_add_u32 s60, s60, 10485760
    v_mul_u32_u24 v227, 96, v252
    s_cmp_lg_u32 s28, 0
    s_cbranch_scc1 K2_NOACC
    buffer_load_dwordx4 v[48:51], v227, s[8:11], s60 offen offset:0
    buffer_load_dwordx4 v[52:55], v227, s[8:11], s60 offen offset:16
    buffer_load_dwordx4 v[56:59], v227, s[8:11], s60 offen offset:32
    buffer_load_dwordx4 v[60:63], v227, s[8:11], s60 offen offset:48
    buffer_load_dwordx4 v[64:67], v227, s[8:11], s60 offen offset:64
    buffer_load_dwordx4 v[68:71], v227, s[8:11], s60 offen offset:80
    buffer_load_dwordx4 v[72:75], v227, s[8:11], s60 offen offset:96
    buffer_load_dwordx4 v[76:79], v227, s[8:11], s60 offen offset:112
    buffer_load_dwordx4 v[80:83], v227, s[8:11], s60 offen offset:128
    buffer_load_dwordx4 v[84:87], v227, s[8:11], s60 offen offset:144
    buffer_load_dwordx4 v[88:91], v227, s[8:11], s60 offen offset:160
    s_waitcnt vmcnt(0)
    v_add_f32 v0, v0, v48
    v_add_f32 v1, v1, v49
    v_add_f32 v2, v2, v50
    v_add_f32 v3, v3, v51
    v_add_f32 v4, v4, v52
    v_add_f32 v5, v5, v53
    v_add_f32 v6, v6, v54
    v_add_f32 v7, v7, v55
    v_add_f32 v8, v8, v56
    v_add_f32 v9, v9, v57
    v_add_f32 v10, v10, v58
    v_add_f32 v11, v11, v59
    v_add_f32 v12, v12, v60
    v_add_f32 v13, v13, v61
    v_add_f32 v14, v14, v62
    v_add_f32 v15, v15, v63
    v_add_f32 v16, v16, v64
    v_add_f32 v17, v17, v65
    v_add_f32 v18, v18, v66
    v_add_f32 v19, v19, v67
    v_add_f32 v20, v20, v68
    v_add_f32 v21, v21, v69
    v_add_f32 v22, v22, v70
    v_add_f32 v23, v23, v71
    v_add_f32 v24, v24, v72
    v_add_f32 v25, v25, v73
    v_add_f32 v26, v26, v74
    v_add_f32 v27, v27, v75
    v_add_f32 v28, v28, v76
    v_add_f32 v29, v29, v77
    v_add_f32 v30, v30, v78
    v_add_f32 v31, v31, v79
    v_add_f32 v32, v32, v80
    v_add_f32 v33, v33, v81
    v_add_f32 v34, v34, v82
    v_add_f32 v35, v35, v83
    v_add_f32 v36, v36, v84
    v_add_f32 v37, v37, v85
    v_add_f32 v38, v38, v86
    v_add_f32 v39, v39, v87
    v_add_f32 v40, v40, v88
    v_add_f32 v41, v41, v89
    v_add_f32 v42, v42, v90
    v_add_f32 v43, v43, v91
K2_NOACC:
    s_barrier
    s_cmp_eq_u32 s55, 0
    s_cbranch_scc1 K2_SPILL
    s_bfe_u32 s60, s20, 0x10002
    s_lshl_b32 s60, s60, 4
    s_add_u32 s59, s59, s60
    v_add_u32 v228, s59, v229
    s_mul_i32 s60, s20, 2080
    s_add_u32 s60, s60, 65536
    v_add_u32 v249, s60, v229
    s_mov_b32 s63, 0xbfb8aa3b
    s_add_u32 s40, s20, s21
    s_lshl_b32 s40, s40, 10
    s_add_u32 s41, s40, 8192
    s_add_u32 s42, s40, 16384
    s_add_u32 s43, s40, 24576
    s_add_u32 s44, s40, 32768
    v_mul_f32 v204, s63, v0
    v_mul_f32 v205, s63, v1
    v_mul_f32 v206, s63, v2
    v_mul_f32 v207, s63, v3
    v_exp_f32 v204, v204
    v_exp_f32 v205, v205
    v_exp_f32 v206, v206
    v_exp_f32 v207, v207
    v_add_f32 v204, 1.0, v204
    v_add_f32 v205, 1.0, v205
    v_add_f32 v206, 1.0, v206
    v_add_f32 v207, 1.0, v207
    v_rcp_f32 v204, v204
    v_rcp_f32 v205, v205
    v_rcp_f32 v206, v206
    v_rcp_f32 v207, v207
    v_cvt_pk_bf16_f32 v176, v0, v1
    v_cvt_pk_bf16_f32 v177, v2, v3
    v_mul_f32 v4, v4, v204
    v_mul_f32 v5, v5, v205
    v_mul_f32 v6, v6, v206
    v_mul_f32 v7, v7, v207
    v_cvt_pk_bf16_f32 v178, v4, v5
    v_cvt_pk_bf16_f32 v179, v6, v7
    v_mul_f32 v8, v8, v204
    v_mul_f32 v9, v9, v205
    v_mul_f32 v10, v10, v206
    v_mul_f32 v11, v11, v207
    v_cvt_pk_bf16_f32 v180, v8, v9
    v_cvt_pk_bf16_f32 v181, v10, v11
    v_mul_f32 v12, v12, v204
    v_mul_f32 v13, v13, v205
    v_mul_f32 v14, v14, v206
    v_mul_f32 v15, v15, v207
    v_cvt_pk_bf16_f32 v182, v12, v13
    v_cvt_pk_bf16_f32 v183, v14, v15
    ds_write_b64 v254, v[176:177] offset:0
    ds_write_b64 v254, v[178:179] offset:256
    ds_write_b64 v254, v[180:181] offset:512
    ds_write_b64 v254, v[182:183] offset:768
    s_waitcnt lgkmcnt(0)
    s_barrier
    ds_read_b128 v[192:195], v228 offset:0
    ds_read_b128 v[196:199], v228 offset:1536
    s_waitcnt lgkmcnt(0)
    buffer_store_dwordx4 v[192:195], v229, s[12:15], s40 offen sc1
    buffer_store_dwordx4 v[196:199], v229, s[12:15], s41 offen sc1
    v_mul_f32 v208, s63, v16
    v_mul_f32 v209, s63, v17
    v_mul_f32 v210, s63, v18
    v_mul_f32 v211, s63, v19
    v_exp_f32 v208, v208
    v_exp_f32 v209, v209
    v_exp_f32 v210, v210
    v_exp_f32 v211, v211
    v_add_f32 v208, 1.0, v208
    v_add_f32 v209, 1.0, v209
    v_add_f32 v210, 1.0, v210
    v_add_f32 v211, 1.0, v211
    v_rcp_f32 v208, v208
    v_rcp_f32 v209, v209
    v_rcp_f32 v210, v210
    v_rcp_f32 v211, v211
    v_cvt_pk_bf16_f32 v184, v16, v17
    v_cvt_pk_bf16_f32 v185, v18, v19
    v_mul_f32 v20, v20, v208
    v_mul_f32 v21, v21, v209
    v_mul_f32 v22, v22, v210
    v_mul_f32 v23, v23, v211
    v_cvt_pk_bf16_f32 v186, v20, v21
    v_cvt_pk_bf16_f32 v187, v22, v23
    v_mul_f32 v24, v24, v208
    v_mul_f32 v25, v25, v209
    v_mul_f32 v26, v26, v210
    v_mul_f32 v27, v27, v211
    v_cvt_pk_bf16_f32 v188, v24, v25
    v_cvt_pk_bf16_f32 v189, v26, v27
    v_mul_f32 v28, v28, v208
    v_mul_f32 v29, v29, v209
    v_mul_f32 v30, v30, v210
    v_mul_f32 v31, v31, v211
    v_cvt_pk_bf16_f32 v190, v28, v29
    v_cvt_pk_bf16_f32 v191, v30, v31
    ds_write_b64 v254, v[184:185] offset:3072
    ds_write_b64 v254, v[186:187] offset:3328
    ds_write_b64 v254, v[188:189] offset:3584
    ds_write_b64 v254, v[190:191] offset:3840
    s_waitcnt lgkmcnt(0)
    s_barrier
    ds_read_b128 v[192:195], v228 offset:3072
    ds_read_b128 v[196:199], v228 offset:4608
    s_waitcnt lgkmcnt(0)
    buffer_store_dwordx4 v[192:195], v229, s[12:15], s42 offen sc1
    buffer_store_dwordx4 v[196:199], v229, s[12:15], s43 offen sc1
    v_mul_f32 v212, s63, v32
    v_mul_f32 v213, s63, v33
    v_mul_f32 v214, s63, v34
    v_mul_f32 v215, s63, v35
    v_exp_f32 v212, v212
    v_exp_f32 v213, v213
    v_exp_f32 v214, v214
    v_exp_f32 v215, v215
    v_add_f32 v212, 1.0, v212
    v_add_f32 v213, 1.0, v213
    v_add_f32 v214, 1.0, v214
    v_add_f32 v215, 1.0, v215
    v_rcp_f32 v212, v212
    v_rcp_f32 v213, v213
    v_rcp_f32 v214, v214
    v_rcp_f32 v215, v215
    v_cvt_pk_bf16_f32 v220, v32, v33
    v_cvt_pk_bf16_f32 v221, v34, v35
    v_mul_f32 v36, v36, v212
    v_mul_f32 v37, v37, v213
    v_mul_f32 v38, v38, v214
    v_mul_f32 v39, v39, v215
    v_cvt_pk_bf16_f32 v178, v36, v37
    v_cvt_pk_bf16_f32 v179, v38, v39
    v_mul_f32 v40, v40, v212
    v_mul_f32 v41, v41, v213
    v_mul_f32 v42, v42, v214
    v_mul_f32 v43, v43, v215
    v_cvt_pk_bf16_f32 v180, v40, v41
    v_cvt_pk_bf16_f32 v181, v42, v43
    ds_write_b64 v255, v[220:221] offset:0
    ds_write_b64 v246, v[178:179] offset:256
    ds_write_b64 v255, v[180:181] offset:512
    s_waitcnt lgkmcnt(0)
    s_barrier
    ds_read_b128 v[200:203], v249
    s_branch K2_LASTROW
K2_SPILL:
    buffer_store_dwordx4 v[0:3], v227, s[8:11], s60 offen offset:0
    buffer_store_dwordx4 v[4:7], v227, s[8:11], s60 offen offset:16
    buffer_store_dwordx4 v[8:11], v227, s[8:11], s60 offen offset:32
    buffer_store_dwordx4 v[12:15], v227, s[8:11], s60 offen offset:48
    buffer_store_dwordx4 v[16:19], v227, s[8:11], s60 offen offset:64
    buffer_store_dwordx4 v[20:23], v227, s[8:11], s60 offen offset:80
    buffer_store_dwordx4 v[24:27], v227, s[8:11], s60 offen offset:96
    buffer_store_dwordx4 v[28:31], v227, s[8:11], s60 offen offset:112
    buffer_store_dwordx4 v[32:35], v227, s[8:11], s60 offen offset:128
    buffer_store_dwordx4 v[36:39], v227, s[8:11], s60 offen offset:144
    buffer_store_dwordx4 v[40:43], v227, s[8:11], s60 offen offset:160
    s_mov_b32 s28, 0
    s_waitcnt vmcnt(0)
    s_cmp_lt_u32 s24, s25
    s_cbranch_scc1 K2_LOAD
    s_add_u32 s23, s23, 20
    s_branch K2_WINDOW
KS_FLS:
    s_sub_u32 s25, s25, 1
    s_cbranch_scc1 K2_END
    v_mov_b32 v62, 163460
    ds_read_b32 v62, v62
    s_branch KS_JOIN2
K2_NOW0:
    buffer_load_dwordx4 v[76:79], v72, s[8:11], s67 offen sc1
    s_branch K2_W0
K2_WINDOW:
    s_mov_b32 s24, 0
    s_mov_b32 s25, 1
K2_LOAD:
    v_mbcnt_lo_u32_b32 v176, -1, 0
    v_mbcnt_hi_u32_b32 v176, -1, v176
    s_lshl_b32 s58, s20, 6
    v_add_u32 v177, s58, v176
    v_lshlrev_b32 v70, 4, v176
    s_mov_b32 s58, 7110656
    buffer_load_dwordx4 v[136:139], v70, s[8:11], s58 offen offset:0 sc1
    buffer_load_dwordx4 v[140:143], v70, s[8:11], s58 offen offset:1024 sc1
    s_mov_b32 s58, 7112704
    buffer_load_dwordx4 v[144:147], v70, s[8:11], s58 offen offset:0 sc1
    buffer_load_dwordx4 v[148:151], v70, s[8:11], s58 offen offset:1024 sc1
    s_mov_b32 s58, 7114752
    buffer_load_dwordx4 v[152:155], v70, s[8:11], s58 offen offset:0 sc1
    buffer_load_dwordx4 v[156:159], v70, s[8:11], s58 offen offset:1024 sc1
    s_mov_b32 s58, 7116800
    buffer_load_dwordx4 v[160:163], v70, s[8:11], s58 offen offset:0 sc1
    buffer_load_dwordx4 v[164:167], v70, s[8:11], s58 offen offset:1024 sc1
    s_mov_b32 s58, 7118848
    buffer_load_dwordx4 v[168:171], v70, s[8:11], s58 offen offset:0 sc1
    buffer_load_dwordx4 v[172:175], v70, s[8:11], s58 offen offset:1024 sc1
    s_mul_i32 s58, s20, 10400
    s_add_u32 s58, s58, 65536
    s_add_u32 s59, s58, 512
    v_and_b32 v76, 31, v176
    v_lshrrev_b32 v77, 5, v176
    v_mov_b32 v80, 0
    v_mul_u32_u24 v77, 2080, v77
    v_mov_b32 v81, 0xffff0000
    v_lshl_add_u32 v78, v76, 4, v77
    v_mov_b32 v82, 0
    v_add_u32 v78, s58, v78
    v_mov_b32 v83, v81
    v_add_u32 v85, 16, v176
    v_lshlrev_b32 v84, 5, v176
    v_lshrrev_b32 v85, 6, v85
    v_mul_u32_u24 v85, 1532, v85
    v_sub_u32 v84, v84, v85
    v_mov_b32 v85, -1
    v_add_u32 v84, s59, v84
    ds_write_b32 v84, v85 offset:0
    ds_write_b32 v84, v85 offset:2080
    ds_write_b32 v84, v85 offset:4160
    ds_write_b32 v84, v85 offset:6240
    ds_write_b32 v84, v85 offset:8320
    s_mov_b32 exec_hi, 0
    ds_write_b128 v78, v[80:83] offset:0
    ds_write_b128 v78, v[80:83] offset:2080
    ds_write_b128 v78, v[80:83] offset:4160
    ds_write_b128 v78, v[80:83] offset:6240
    ds_write_b128 v78, v[80:83] offset:8320
    s_mov_b32 exec_hi, -1
    s_cmp_lg_u32 s20, 7
    s_cbranch_scc1 K2_NOH
    v_mov_b32 v76, 0
    v_mov_b32 v77, -1
    v_lshlrev_b32 v78, 2, v176
    v_add_u32 v78, 163072, v78
    s_mov_b64 exec, 0x1ff
    ds_write_b32 v78, v76 offset:192
    s_mov_b32 exec_lo, 1
    ds_write_b32 v78, v76 offset:232
    s_mov_b32 exec_lo, -1
    ds_write_b32 v78, v77 offset:256
    s_mov_b64 exec, -1
    s_cmp_lg_u32 s24, 0
    s_cbranch_scc1 K2_NOH
    s_mov_b32 exec_hi, 0xffff
    ds_write_b32 v78, v76
    s_mov_b64 exec, 1
    ds_write_b32 v78, v76 offset:228
    s_mov_b64 exec, -1
K2_NOH:
    s_waitcnt lgkmcnt(0)
    s_barrier
    s_branch K2_CELLS
K2_LD_GEN:
    s_mov_b64 exec, s[42:43]
    s_cbranch_execz K2_LD_DONE
    buffer_load_dwordx4 v[4:7], v182, s[8:11], 0 offen sc1
    s_mov_b64 exec, s[44:45]
    s_cbranch_execz K2_LD_DONE
    buffer_load_dwordx4 v[8:11], v183, s[8:11], 0 offen sc1
    s_mov_b64 exec, s[46:47]
    s_cbranch_execz K2_LD_DONE
    buffer_load_dwordx4 v[12:15], v184, s[8:11], 0 offen sc1
    s_mov_b64 exec, s[48:49]
    s_cbranch_execz K2_LD_DONE
    buffer_load_dwordx4 v[16:19], v181, s[8:11], 0 offen offset:128 sc1
    s_mov_b64 exec, s[50:51]
    s_cbranch_execz K2_LD_DONE
    buffer_load_dwordx4 v[20:23], v181, s[8:11], 0 offen offset:160 sc1
    s_mov_b64 exec, s[90:91]
    s_cbranch_execz K2_LD_DONE
    buffer_load_dwordx4 v[24:27], v181, s[8:11], 0 offen offset:192 sc1
    s_mov_b64 exec, s[92:93]
    s_cbranch_execz K2_LD_DONE
    buffer_load_dwordx4 v[28:31], v181, s[8:11], 0 offen offset:224 sc1
    s_mov_b64 exec, s[94:95]
    s_cbranch_execz K2_LD_DONE
    buffer_load_dwordx4 v[32:35], v181, s[8:11], 0 offen offset:256 sc1
    s_mov_b64 exec, s[96:97]
    s_cbranch_execz K2_LD_DONE
    buffer_load_dwordx4 v[36:39], v181, s[8:11], 0 offen offset:288 sc1
    s_branch K2_LD_DONE
K2_WLATE:
    s_waitcnt vmcnt(0)
    v_lshlrev_b32 v96, 16, v136
    v_and_b32 v97, 0xffff0000, v136
    v_lshlrev_b32 v98, 16, v137
    v_and_b32 v99, 0xffff0000, v137
    v_lshlrev_b32 v100, 16, v138
    v_and_b32 v101, 0xffff0000, v138
    v_lshlrev_b32 v102, 16, v139
    v_and_b32 v103, 0xffff0000, v139
    v_lshlrev_b32 v104, 16, v140
    v_and_b32 v105, 0xffff0000, v140
    v_lshlrev_b32 v106, 16, v141
    v_and_b32 v107, 0xffff0000, v141
    v_lshlrev_b32 v108, 16, v142
    v_and_b32 v109, 0xffff0000, v142
    v_lshlrev_b32 v110, 16, v143
    v_and_b32 v111, 0xffff0000, v143
    v_lshlrev_b32 v112, 16, v144
    v_and_b32 v113, 0xffff0000, v144
    v_lshlrev_b32 v114, 16, v145
    v_and_b32 v115, 0xffff0000, v145
    v_lshlrev_b32 v116, 16, v146
    v_and_b32 v117, 0xffff0000, v146
    v_lshlrev_b32 v118, 16, v147
    v_and_b32 v119, 0xffff0000, v147
    v_lshlrev_b32 v120, 16, v148
    v_and_b32 v121, 0xffff0000, v148
    v_lshlrev_b32 v122, 16, v149
    v_and_b32 v123, 0xffff0000, v149
    v_lshlrev_b32 v124, 16, v150
    v_and_b32 v125, 0xffff0000, v150
    v_lshlrev_b32 v126, 16, v151
    v_and_b32 v127, 0xffff0000, v151
    v_lshlrev_b32 v128, 16, v152
    v_and_b32 v129, 0xffff0000, v152
    v_lshlrev_b32 v130, 16, v153
    v_and_b32 v131, 0xffff0000, v153
    v_lshlrev_b32 v132, 16, v154
    v_and_b32 v133, 0xffff0000, v154
    v_lshlrev_b32 v134, 16, v155
    v_and_b32 v135, 0xffff0000, v155
    v_lshlrev_b32 v136, 16, v156
    v_and_b32 v137, 0xffff0000, v156
    v_lshlrev_b32 v138, 16, v157
    v_and_b32 v139, 0xffff0000, v157
    v_lshlrev_b32 v140, 16, v158
    v_and_b32 v141, 0xffff0000, v158
    v_lshlrev_b32 v142, 16, v159
    v_and_b32 v143, 0xffff0000, v159
    v_lshlrev_b32 v144, 16, v160
    v_and_b32 v145, 0xffff0000, v160
    v_lshlrev_b32 v146, 16, v161
    v_and_b32 v147, 0xffff0000, v161
    v_lshlrev_b32 v148, 16, v162
    v_and_b32 v149, 0xffff0000, v162
    v_lshlrev_b32 v150, 16, v163
    v_and_b32 v151, 0xffff0000, v163
    v_lshlrev_b32 v152, 16, v164
    v_and_b32 v153, 0xffff0000, v164
    v_lshlrev_b32 v154, 16, v165
    v_and_b32 v155, 0xffff0000, v165
    v_lshlrev_b32 v156, 16, v166
    v_and_b32 v157, 0xffff0000, v166
    v_lshlrev_b32 v158, 16, v167
    v_and_b32 v159, 0xffff0000, v167
    v_lshlrev_b32 v160, 16, v168
    v_and_b32 v161, 0xffff0000, v168
    v_lshlrev_b32 v162, 16, v169
    v_and_b32 v163, 0xffff0000, v169
    v_lshlrev_b32 v164, 16, v170
    v_and_b32 v165, 0xffff0000, v170
    v_lshlrev_b32 v166, 16, v171
    v_and_b32 v167, 0xffff0000, v171
    v_lshlrev_b32 v168, 16, v172
    v_and_b32 v169, 0xffff0000, v172
    v_lshlrev_b32 v170, 16, v173
    v_and_b32 v171, 0xffff0000, v173
    v_lshlrev_b32 v172, 16, v174
    v_and_b32 v173, 0xffff0000, v174
    v_lshlrev_b32 v174, 16, v175
    v_and_b32 v175, 0xffff0000, v175
    s_branch K2_NOWRAW
K2_RT0:
    s_sub_u32 s60, s60, 1
    s_cbranch_scc1 K2_END
    s_mov_b64 exec, vcc
    buffer_load_dwordx4 v[0:3], v181, s[8:11], 0 offen offset:0 sc1
    s_mov_b64 exec, s[40:41]
    s_waitcnt vmcnt(0)
    s_branch K2_CK0
K2_RT1:
    s_sub_u32 s60, s60, 1
    s_cbranch_scc1 K2_END
    s_mov_b64 exec, vcc
    buffer_load_dwordx4 v[4:7], v182, s[8:11], 0 offen sc1
    s_mov_b64 exec, s[42:43]
    s_waitcnt vmcnt(0)
    s_branch K2_CK1
K2_RT2:
    s_sub_u32 s60, s60, 1
    s_cbranch_scc1 K2_END
    s_mov_b64 exec, vcc
    buffer_load_dwordx4 v[8:11], v183, s[8:11], 0 offen sc1
    s_mov_b64 exec, s[44:45]
    s_waitcnt vmcnt(0)
    s_branch K2_CK2
K2_RT3:
    s_sub_u32 s60, s60, 1
    s_cbranch_scc1 K2_END
    s_mov_b64 exec, vcc
    buffer_load_dwordx4 v[12:15], v184, s[8:11], 0 offen sc1
    s_mov_b64 exec, s[46:47]
    s_waitcnt vmcnt(0)
    s_branch K2_CK3
K2_RT4:
    s_sub_u32 s60, s60, 1
    s_cbranch_scc1 K2_END
    s_mov_b64 exec, vcc
    buffer_load_dwordx4 v[16:19], v181, s[8:11], 0 offen offset:128 sc1
    s_mov_b64 exec, s[48:49]
    s_waitcnt vmcnt(0)
    s_branch K2_CK4
K2_RT5:
    s_sub_u32 s60, s60, 1
    s_cbranch_scc1 K2_END
    s_mov_b64 exec, vcc
    buffer_load_dwordx4 v[20:23], v181, s[8:11], 0 offen offset:160 sc1
    s_mov_b64 exec, s[50:51]
    s_waitcnt vmcnt(0)
    s_branch K2_CK5
K2_RT6:
    s_sub_u32 s60, s60, 1
    s_cbranch_scc1 K2_END
    s_mov_b64 exec, vcc
    buffer_load_dwordx4 v[24:27], v181, s[8:11], 0 offen offset:192 sc1
    s_mov_b64 exec, s[90:91]
    s_waitcnt vmcnt(0)
    s_branch K2_CK6
K2_RT7:
    s_sub_u32 s60, s60, 1
    s_cbranch_scc1 K2_END
    s_mov_b64 exec, vcc
    buffer_load_dwordx4 v[28:31], v181, s[8:11], 0 offen offset:224 sc1
    s_mov_b64 exec, s[92:93]
    s_waitcnt vmcnt(0)
    s_branch K2_CK7
K2_RT8:
    s_sub_u32 s60, s60, 1
    s_cbranch_scc1 K2_END
    s_mov_b64 exec, vcc
    buffer_load_dwordx4 v[32:35], v181, s[8:11], 0 offen offset:256 sc1
    s_mov_b64 exec, s[94:95]
    s_waitcnt vmcnt(0)
    s_branch K2_CK8
K2_RT9:
    s_sub_u32 s60, s60, 1
    s_cbranch_scc1 K2_END
    s_mov_b64 exec, vcc
    buffer_load_dwordx4 v[36:39], v181, s[8:11], 0 offen offset:288 sc1
    s_mov_b64 exec, s[96:97]
    s_waitcnt vmcnt(0)
    s_branch K2_CK9
K2_RK_LOAD:
    s_waitcnt vmcnt(0)
    s_mov_b64 exec, s[40:41]
    s_cbranch_execz K2_RK_B
    v_lshrrev_b32 v50, 24, v3
    buffer_load_dword v40, v179, s[8:11], s66 offen offset:0
    v_mad_u32_u24 v50, v50, s58, v202
    v_and_b32 v3, 0xffffff, v3
    s_mov_b64 exec, s[42:43]
    s_cbranch_execz K2_RK_B
    v_lshrrev_b32 v51, 24, v7
    buffer_load_dword v41, v185, s[8:11], s66 offen
    v_mad_u32_u24 v51, v51, s58, v202
    v_and_b32 v7, 0xffffff, v7
    s_mov_b64 exec, s[44:45]
    s_cbranch_execz K2_RK_B
    v_lshrrev_b32 v52, 24, v11
    buffer_load_dword v42, v186, s[8:11], s66 offen
    v_mad_u32_u24 v52, v52, s58, v202
    v_and_b32 v11, 0xffffff, v11
    s_mov_b64 exec, s[46:47]
    s_cbranch_execz K2_RK_B
    v_lshrrev_b32 v53, 24, v15
    buffer_load_dword v43, v187, s[8:11], s66 offen
    v_mad_u32_u24 v53, v53, s58, v202
    v_and_b32 v15, 0xffffff, v15
    s_mov_b64 exec, s[48:49]
    s_cbranch_execz K2_RK_B
    v_lshrrev_b32 v54, 24, v19
    buffer_load_dword v44, v179, s[8:11], s66 offen offset:32
    v_mad_u32_u24 v54, v54, s58, v202
    v_and_b32 v19, 0xffffff, v19
    s_mov_b64 exec, s[50:51]
    s_cbranch_execz K2_RK_B
    v_lshrrev_b32 v55, 24, v23
    buffer_load_dword v45, v179, s[8:11], s66 offen offset:40
    v_mad_u32_u24 v55, v55, s58, v202
    v_and_b32 v23, 0xffffff, v23
    s_mov_b64 exec, s[90:91]
    s_cbranch_execz K2_RK_B
    v_lshrrev_b32 v56, 24, v27
    buffer_load_dword v46, v179, s[8:11], s66 offen offset:48
    v_mad_u32_u24 v56, v56, s58, v202
    v_and_b32 v27, 0xffffff, v27
    s_mov_b64 exec, s[92:93]
    s_cbranch_execz K2_RK_B
    v_lshrrev_b32 v57, 24, v31
    buffer_load_dword v47, v179, s[8:11], s66 offen offset:56
    v_mad_u32_u24 v57, v57, s58, v202
    v_and_b32 v31, 0xffffff, v31
    s_mov_b64 exec, s[94:95]
    s_cbranch_execz K2_RK_B
    v_lshrrev_b32 v58, 24, v35
    buffer_load_dword v48, v179, s[8:11], s66 offen offset:64
    v_mad_u32_u24 v58, v58, s58, v202
    v_and_b32 v35, 0xffffff, v35
    s_mov_b64 exec, s[96:97]
    s_cbranch_execz K2_RK_B
    v_lshrrev_b32 v59, 24, v39
    buffer_load_dword v49, v179, s[8:11], s66 offen offset:72
    v_mad_u32_u24 v59, v59, s58, v202
    v_and_b32 v39, 0xffffff, v39
K2_RK_B:
    s_mov_b64 exec, -1
    s_mul_i32 s62, s24, 48
    s_waitcnt vmcnt(0)
    v_subrev_u32 v40, s62, v40
    v_subrev_u32 v41, s62, v41
    v_subrev_u32 v42, s62, v42
    v_subrev_u32 v43, s62, v43
    v_subrev_u32 v44, s62, v44
    v_subrev_u32 v45, s62, v45
    v_subrev_u32 v46, s62, v46
    v_subrev_u32 v47, s62, v47
    v_subrev_u32 v48, s62, v48
    v_subrev_u32 v49, s62, v49
    s_branch K2_RK_DONE
K2_BIG:
    s_cmp_lg_u32 s24, 0
    s_cbranch_scc1 K2_TOK
    s_movk_i32 s26, 48
    v_mov_b32 v197, v193
    s_nop 1
    v_max_u32_dpp v197, v197, v197 row_shr:1 row_mask:0xf bank_mask:0xf bound_ctrl:0
    s_nop 1
    v_max_u32_dpp v197, v197, v197 row_shr:2 row_mask:0xf bank_mask:0xf bound_ctrl:0
    s_nop 1
    v_max_u32_dpp v197, v197, v197 row_shr:4 row_mask:0xf bank_mask:0xf bound_ctrl:0
    s_nop 1
    v_max_u32_dpp v197, v197, v197 row_shr:8 row_mask:0xf bank_mask:0xf bound_ctrl:0
    s_nop 1
    v_max_u32_dpp v197, v197, v197 row_bcast:15 row_mask:0xa bank_mask:0xf
    s_nop 1
    v_max_u32_dpp v197, v197, v197 row_bcast:31 row_mask:0xc bank_mask:0xf
    s_nop 0
    v_readlane_b32 s25, v197, 63
    s_nop 0
    s_add_u32 s25, s25, 47
    s_mul_i32 s25, s25, 43691
    s_lshr_b32 s25, s25, 21
    s_mov_b64 exec, s[40:41]
    s_cbranch_execz K2_SV_DONE
    buffer_store_dword v40, v179, s[8:11], s66 offen offset:0
    s_mov_b64 exec, s[42:43]
    s_cbranch_execz K2_SV_DONE
    buffer_store_dword v41, v185, s[8:11], s66 offen
    s_mov_b64 exec, s[44:45]
    s_cbranch_execz K2_SV_DONE
    buffer_store_dword v42, v186, s[8:11], s66 offen
    s_mov_b64 exec, s[46:47]
    s_cbranch_execz K2_SV_DONE
    buffer_store_dword v43, v187, s[8:11], s66 offen
    s_mov_b64 exec, s[48:49]
    s_cbranch_execz K2_SV_DONE
    buffer_store_dword v44, v179, s[8:11], s66 offen offset:32
    s_mov_b64 exec, s[50:51]
    s_cbranch_execz K2_SV_DONE
    buffer_store_dword v45, v179, s[8:11], s66 offen offset:40
    s_mov_b64 exec, s[90:91]
    s_cbranch_execz K2_SV_DONE
    buffer_store_dword v46, v179, s[8:11], s66 offen offset:48
    s_mov_b64 exec, s[92:93]
    s_cbranch_execz K2_SV_DONE
    buffer_store_dword v47, v179, s[8:11], s66 offen offset:56
    s_mov_b64 exec, s[94:95]
    s_cbranch_execz K2_SV_DONE
    buffer_store_dword v48, v179, s[8:11], s66 offen offset:64
    s_mov_b64 exec, s[96:97]
    s_cbranch_execz K2_SV_DONE
    buffer_store_dword v49, v179, s[8:11], s66 offen offset:72
K2_SV_DONE:
    s_mov_b64 exec, -1
    s_branch K2_TOK
K2_rare_1:
    s_cmp_eq_u32 s33, 4
    s_cbranch_scc1 K2_four_3
    s_mov_b32 s49, s48
    s_xor_b32 s45, s44, 256
    s_xor_b32 s46, s44, 512
    s_xor_b32 s47, s44, 768
    s_branch K2_back_2
K2_four_3:
    s_add_u32 s50, s48, 256
    s_mov_b32 s46, s44
    s_mov_b32 s47, s44
    s_branch K2_back_2
K2_a4_5:
    v_add_u32 v254, s48, v230
    ds_read_b32 v254, v254 offset:4
    s_lshr_b32 s65, s3, 28
    s_mul_i32 s66, s22, 2080
    s_lshl_b32 s65, s65, 9
    s_add_u32 s65, s65, s66
    s_add_u32 s65, s65, 65536
    s_mov_b32 m0, s65
    s_mov_b32 exec_hi, 0
    s_waitcnt lgkmcnt(0)
    v_or_b32 v254, v254, v231
    buffer_load_dwordx4 v254, s[16:19], 0 offen  lds
    s_mov_b32 exec_hi, -1
    s_branch K2_b4_7
K2_g4_8:
    s_add_u32 s51, s48, 384
    v_add_u32 v228, s51, v251
    ds_read2_b32 v[228:229], v228 offset0:1 offset1:3
    s_waitcnt lgkmcnt(0)
    v_mad_u32_u16 v228, v228, s39, v248 op_sel:[1,0,0,0]
    v_mad_u32_u16 v229, v229, s39, v248 op_sel:[1,0,0,0]
    buffer_load_dwordx4 v228, s[4:7], s47 offen sc1 lds
    buffer_load_dwordx4 v229, s[72:75], s47 offen offset:1024 sc1 lds
    s_branch K2_back_9
K2_rare_16:
    s_cmp_eq_u32 s33, 4
    s_cbranch_scc1 K2_four_18
    s_mov_b32 s49, s48
    s_xor_b32 s45, s44, 256
    s_xor_b32 s46, s44, 512
    s_xor_b32 s47, s44, 768
    s_branch K2_back_17
K2_four_18:
    s_add_u32 s50, s48, 256
    s_mov_b32 s46, s44
    s_mov_b32 s47, s44
    s_branch K2_back_17
K2_g4_19:
    s_add_u32 s51, s48, 384
    v_add_u32 v228, s51, v251
    ds_read2_b32 v[228:229], v228 offset0:1 offset1:3
    s_waitcnt lgkmcnt(0)
    v_mad_u32_u16 v228, v228, s39, v248 op_sel:[1,0,0,0]
    v_mad_u32_u16 v229, v229, s39, v248 op_sel:[1,0,0,0]
    buffer_load_dwordx4 v228, s[4:7], s47 offen sc1 lds
    buffer_load_dwordx4 v229, s[72:75], s47 offen offset:1024 sc1 lds
    s_branch K2_back_20
K2_a4_22:
    v_add_u32 v254, s48, v230
    ds_read_b32 v254, v254 offset:4
    s_lshr_b32 s65, s3, 28
    s_mul_i32 s66, s22, 2080
    s_lshl_b32 s65, s65, 9
    s_add_u32 s65, s65, s66
    s_add_u32 s65, s65, 65536
    s_mov_b32 m0, s65
    s_mov_b32 exec_hi, 0
    s_waitcnt lgkmcnt(0)
    v_or_b32 v254, v254, v231
    buffer_load_dwordx4 v254, s[16:19], 0 offen  lds
    s_mov_b32 exec_hi, -1
    s_branch K2_b4_24
K2_rare_31:
    s_cmp_eq_u32 s33, 4
    s_cbranch_scc1 K2_four_33
    s_mov_b32 s49, s48
    s_xor_b32 s45, s44, 256
    s_xor_b32 s46, s44, 512
    s_xor_b32 s47, s44, 768
    s_branch K2_back_32
K2_four_33:
    s_add_u32 s50, s48, 256
    s_mov_b32 s46, s44
    s_mov_b32 s47, s44
    s_branch K2_back_32
K2_g4_34:
    s_add_u32 s51, s48, 384
    v_add_u32 v228, s51, v251
    ds_read2_b32 v[228:229], v228 offset0:1 offset1:3
    s_waitcnt lgkmcnt(0)
    v_mad_u32_u16 v228, v228, s39, v248 op_sel:[1,0,0,0]
    v_mad_u32_u16 v229, v229, s39, v248 op_sel:[1,0,0,0]
    buffer_load_dwordx4 v228, s[4:7], s47 offen sc1 lds
    buffer_load_dwordx4 v229, s[72:75], s47 offen offset:1024 sc1 lds
    s_branch K2_back_35
K2_a4_37:
    v_add_u32 v254, s48, v230
    ds_read_b32 v254, v254 offset:4
    s_lshr_b32 s65, s3, 28
    s_mul_i32 s66, s22, 2080
    s_lshl_b32 s65, s65, 9
    s_add_u32 s65, s65, s66
    s_add_u32 s65, s65, 65536
    s_mov_b32 m0, s65
    s_mov_b32 exec_hi, 0
    s_waitcnt lgkmcnt(0)
    v_or_b32 v254, v254, v231
    buffer_load_dwordx4 v254, s[16:19], 0 offen  lds
    s_mov_b32 exec_hi, -1
    s_branch K2_b4_39
K2_rare_46:
    s_cmp_eq_u32 s33, 4
    s_cbranch_scc1 K2_four_48
    s_mov_b32 s49, s48
    s_xor_b32 s45, s44, 256
    s_xor_b32 s46, s44, 512
    s_xor_b32 s47, s44, 768
    s_branch K2_back_47
K2_four_48:
    s_add_u32 s50, s48, 256
    s_mov_b32 s46, s44
    s_mov_b32 s47, s44
    s_branch K2_back_47
K2_g4_49:
    s_add_u32 s51, s48, 384
    v_add_u32 v228, s51, v251
    ds_read2_b32 v[228:229], v228 offset0:1 offset1:3
    s_waitcnt lgkmcnt(0)
    v_mad_u32_u16 v228, v228, s39, v248 op_sel:[1,0,0,0]
    v_mad_u32_u16 v229, v229, s39, v248 op_sel:[1,0,0,0]
    buffer_load_dwordx4 v228, s[4:7], s47 offen sc1 lds
    buffer_load_dwordx4 v229, s[72:75], s47 offen offset:1024 sc1 lds
    s_branch K2_back_50
K2_a4_52:
    v_add_u32 v254, s48, v230
    ds_read_b32 v254, v254 offset:4
    s_lshr_b32 s65, s3, 28
    s_mul_i32 s66, s22, 2080
    s_lshl_b32 s65, s65, 9
    s_add_u32 s65, s65, s66
    s_add_u32 s65, s65, 65536
    s_mov_b32 m0, s65
    s_mov_b32 exec_hi, 0
    s_waitcnt lgkmcnt(0)
    v_or_b32 v254, v254, v231
    buffer_load_dwordx4 v254, s[16:19], 0 offen  lds
    s_mov_b32 exec_hi, -1
    s_branch K2_b4_54
K2_rare_59:
    s_cmp_eq_u32 s33, 4
    s_cbranch_scc1 K2_four_61
    s_mov_b32 s49, s48
    s_xor_b32 s45, s44, 256
    s_xor_b32 s46, s44, 512
    s_xor_b32 s47, s44, 768
    s_branch K2_back_60
K2_four_61:
    s_add_u32 s50, s48, 256
    s_mov_b32 s46, s44
    s_mov_b32 s47, s44
    s_branch K2_back_60
K2_g4_62:
    s_add_u32 s51, s48, 384
    v_add_u32 v228, s51, v251
    ds_read2_b32 v[228:229], v228 offset0:1 offset1:3
    s_waitcnt lgkmcnt(0)
    v_mad_u32_u16 v228, v228, s39, v248 op_sel:[1,0,0,0]
    v_mad_u32_u16 v229, v229, s39, v248 op_sel:[1,0,0,0]
    buffer_load_dwordx4 v228, s[4:7], s47 offen sc1 lds
    buffer_load_dwordx4 v229, s[72:75], s47 offen offset:1024 sc1 lds
    s_branch K2_back_63
K2_rare_68:
    s_cmp_eq_u32 s33, 4
    s_cbranch_scc1 K2_four_70
    s_mov_b32 s49, s48
    s_xor_b32 s45, s44, 256
    s_xor_b32 s46, s44, 512
    s_xor_b32 s47, s44, 768
    s_branch K2_back_69
K2_four_70:
    s_add_u32 s50, s48, 256
    s_mov_b32 s46, s44
    s_mov_b32 s47, s44
    s_branch K2_back_69
K2_g4_71:
    s_add_u32 s51, s48, 384
    v_add_u32 v228, s51, v251
    ds_read2_b32 v[228:229], v228 offset0:1 offset1:3
    s_waitcnt lgkmcnt(0)
    v_mad_u32_u16 v228, v228, s39, v248 op_sel:[1,0,0,0]
    v_mad_u32_u16 v229, v229, s39, v248 op_sel:[1,0,0,0]
    buffer_load_dwordx4 v228, s[4:7], s47 offen sc1 lds
    buffer_load_dwordx4 v229, s[72:75], s47 offen offset:1024 sc1 lds
    s_branch K2_back_72
K2_rare_77:
    s_cmp_eq_u32 s33, 4
    s_cbranch_scc1 K2_four_79
    s_mov_b32 s49, s48
    s_xor_b32 s45, s44, 256
    s_xor_b32 s46, s44, 512
    s_xor_b32 s47, s44, 768
    s_branch K2_back_78
K2_four_79:
    s_add_u32 s50, s48, 256
    s_mov_b32 s46, s44
    s_mov_b32 s47, s44
    s_branch K2_back_78
K2_g4_80:
    s_add_u32 s51, s48, 384
    v_add_u32 v228, s51, v251
    ds_read2_b32 v[228:229], v228 offset0:1 offset1:3
    s_waitcnt lgkmcnt(0)
    v_mad_u32_u16 v228, v228, s39, v248 op_sel:[1,0,0,0]
    v_mad_u32_u16 v229, v229, s39, v248 op_sel:[1,0,0,0]
    buffer_load_dwordx4 v228, s[4:7], s47 offen sc1 lds
    buffer_load_dwordx4 v229, s[72:75], s47 offen offset:1024 sc1 lds
    s_branch K2_back_81
K2_rare_86:
    s_cmp_eq_u32 s33, 4
    s_cbranch_scc1 K2_four_88
    s_mov_b32 s49, s48
    s_xor_b32 s45, s44, 256
    s_xor_b32 s46, s44, 512
    s_xor_b32 s47, s44, 768
    s_branch K2_back_87
K2_four_88:
    s_add_u32 s50, s48, 256
    s_mov_b32 s46, s44
    s_mov_b32 s47, s44
    s_branch K2_back_87
K2_g4_89:
    s_add_u32 s51, s48, 384
    v_add_u32 v228, s51, v251
    ds_read2_b32 v[228:229], v228 offset0:1 offset1:3
    s_waitcnt lgkmcnt(0)
    v_mad_u32_u16 v228, v228, s39, v248 op_sel:[1,0,0,0]
    v_mad_u32_u16 v229, v229, s39, v248 op_sel:[1,0,0,0]
    buffer_load_dwordx4 v228, s[4:7], s47 offen sc1 lds
    buffer_load_dwordx4 v229, s[72:75], s47 offen offset:1024 sc1 lds
    s_branch K2_back_90
K2_U10:
    s_setprio 1
    s_add_u32 s38, s38, 1
    v_mov_b32 v254, s52
    v_mov_b32 v255, s38
    s_lshl_b32 s58, s38, 3
    s_add_u32 s58, s58, s20
    s_mov_b64 exec, 1
    ds_write_b32 v254, v255
    s_mov_b64 exec, -1
    s_cmp_lt_u32 s58, s22
    s_cbranch_scc0 K2_dyn_91
K2_back_92:
    s_waitcnt lgkmcnt(4)
    v_lshlrev_b32 v20, 16, v0
    v_and_b32 v21, 0xffff0000, v0
    v_lshlrev_b32 v22, 16, v1
    v_and_b32 v23, 0xffff0000, v1
    v_lshlrev_b32 v24, 16, v2
    v_and_b32 v25, 0xffff0000, v2
    v_lshlrev_b32 v26, 16, v3
    v_and_b32 v27, 0xffff0000, v3
    v_mul_f32_dpp v36, v16, v20 row_newbcast:8 row_mask:0xf bank_mask:0xf
    v_mul_f32_dpp v37, v16, v21 row_newbcast:9 row_mask:0xf bank_mask:0xf
    v_mul_f32_dpp v38, v16, v22 row_newbcast:10 row_mask:0xf bank_mask:0xf
    v_mul_f32_dpp v39, v16, v23 row_newbcast:11 row_mask:0xf bank_mask:0xf
    v_mul_f32_dpp v40, v16, v24 row_newbcast:12 row_mask:0xf bank_mask:0xf
    v_mul_f32_dpp v41, v16, v25 row_newbcast:13 row_mask:0xf bank_mask:0xf
    v_mul_f32_dpp v42, v16, v26 row_newbcast:14 row_mask:0xf bank_mask:0xf
    v_mul_f32_dpp v43, v16, v27 row_newbcast:15 row_mask:0xf bank_mask:0xf
    v_cvt_pk_bf16_f32 v68, v36, v37
    v_cvt_pk_bf16_f32 v69, v38, v39
    v_cvt_pk_bf16_f32 v70, v40, v41
    v_cvt_pk_bf16_f32 v71, v42, v43
    v_mul_f32_dpp v20, v16, v20 row_newbcast:0 row_mask:0xa bank_mask:0xf
    v_mul_f32_dpp v21, v16, v21 row_newbcast:1 row_mask:0xa bank_mask:0xf
    v_mul_f32_dpp v22, v16, v22 row_newbcast:2 row_mask:0xa bank_mask:0xf
    v_mul_f32_dpp v23, v16, v23 row_newbcast:3 row_mask:0xa bank_mask:0xf
    v_mul_f32_dpp v24, v16, v24 row_newbcast:4 row_mask:0xa bank_mask:0xf
    v_mul_f32_dpp v25, v16, v25 row_newbcast:5 row_mask:0xa bank_mask:0xf
    v_mul_f32_dpp v26, v16, v26 row_newbcast:6 row_mask:0xa bank_mask:0xf
    v_mul_f32_dpp v27, v16, v27 row_newbcast:7 row_mask:0xa bank_mask:0xf
    v_cvt_pk_bf16_f32 v64, v20, v21
    v_cvt_pk_bf16_f32 v65, v22, v23
    v_cvt_pk_bf16_f32 v66, v24, v25
    v_cvt_pk_bf16_f32 v67, v26, v27
    v_readlane_b32 s3, v253, s58
    s_lshl_b32 s44, s34, 7
    s_and_b32 s48, s3, 0x3ffff
    s_bfe_u32 s33, s3, 0x30013
    s_mul_i32 s35, s38, 6
    s_cmp_eq_u32 s34, 0
    s_cselect_b32 s35, s35, s48
    s_mov_b32 s45, s44
    s_xor_b32 s47, s44, 256
    s_add_u32 s49, s48, 128
    s_add_u32 s60, s48, 256
    s_cmp_eq_u32 s33, 3
    s_cselect_b32 s46, s44, s47
    s_cselect_b32 s50, s60, s48
    s_sub_u32 s60, s33, 2
    s_cmp_lt_u32 s60, 2
    s_cbranch_scc0 K2_rare_97
K2_back_98:
    v_add_u32 v233, s48, v230
    ds_read_b32 v232, v233
    ds_read_b32 v233, v233 offset:1024
    v_add_u32 v222, s48, v251
    ds_read2_b32 v[222:223], v222 offset0:1 offset1:3
    v_add_u32 v224, s49, v251
    ds_read2_b32 v[224:225], v224 offset0:1 offset1:3
    v_add_u32 v226, s50, v251
    ds_read2_b32 v[226:227], v226 offset0:1 offset1:3
    s_waitcnt lgkmcnt(3)
    v_or_b32 v232, v232, v231
    v_or_b32 v233, v233, v231
    s_cmp_lg_u32 s34, 0
    s_cbranch_scc1 K2_dum_100
    s_cmp_eq_u32 s33, 4
    s_cbranch_scc1 K2_a4_101
K2_b4_103:
    s_add_u32 m0, s48, 512
    s_add_u32 s65, s48, 1536
    buffer_load_dwordx4 v232, s[16:19], 0 offen  lds
    s_mov_b32 m0, s65
    s_mov_b32 exec_hi, 0
    buffer_load_dwordx4 v233, s[16:19], 0 offen  lds
    s_mov_b32 exec_hi, -1
K2_back_102:
    s_waitcnt lgkmcnt(2)
    v_mad_u32_u16 v222, v222, s39, v248 op_sel:[1,0,0,0]
    v_mad_u32_u16 v223, v223, s39, v248 op_sel:[1,0,0,0]
    s_waitcnt lgkmcnt(1)
    v_mad_u32_u16 v224, v224, s39, v248 op_sel:[1,0,0,0]
    v_mad_u32_u16 v225, v225, s39, v248 op_sel:[1,0,0,0]
    s_waitcnt lgkmcnt(0)
    v_mad_u32_u16 v226, v226, s39, v248 op_sel:[1,0,0,0]
    v_mad_u32_u16 v227, v227, s39, v248 op_sel:[1,0,0,0]
    s_waitcnt vmcnt(6)
    v_mfma_f32_32x32x16_bf16 v[0:15], v[64:67], v[176:179], 0
    ds_read_b64_tr_b16 v[184:185], v246 offset:2048
    ds_read_b64_tr_b16 v[186:187], v246 offset:3072
    ds_read_b64_tr_b16 v[188:189], v247 offset:2048
    ds_read_b64_tr_b16 v[190:191], v247 offset:3072
    s_mov_b32 m0, s68
    v_mfma_f32_32x32x16_bf16 v[16:31], v[68:71], v[176:179], 0
    buffer_load_dwordx4 v222, s[4:7], s44 offen sc1 lds
    buffer_load_dwordx4 v223, s[72:75], s44 offen offset:1024 sc1 lds
    v_permlane32_swap_b32 v242, v236
    v_permlane32_swap_b32 v243, v237
    v_mfma_f32_32x32x16_bf16 v[32:47], v[64:67], v[180:183], 0
    v_permlane32_swap_b32 v244, v238
    v_permlane32_swap_b32 v245, v239
    v_permlane32_swap_b32 v240, v241
    v_add_f32 v242, v242, v236
    v_mfma_f32_32x32x16_bf16 v[48:63], v[68:71], v[180:183], 0
    s_setprio 0
    v_add_f32 v243, v243, v237
    v_add_f32 v244, v244, v238
    v_add_f32 v245, v245, v239
    v_add_f32 v240, -v240, -v241
    s_set_gpr_idx_on s32, gpr_idx(DST)
    s_nop 0
    v_cvt_pk_bf16_f32 v195, v242, v243
    v_cvt_pk_bf16_f32 v196, v244, v245
    v_cvt_pk_bf16_f32 v197, v240, v240
    s_set_gpr_idx_off
    v_mul_f32 v234, v0, v96
    v_mul_f32 v236, v8, v128
    v_fmac_f32 v234, v1, v97
    v_fmac_f32 v236, v9, v129
    v_fmac_f32 v234, v2, v98
    v_fmac_f32 v236, v10, v130
    v_fmac_f32 v234, v3, v99
    v_fmac_f32 v236, v11, v131
    v_fmac_f32 v234, v4, v100
    v_fmac_f32 v236, v12, v132
    v_fmac_f32 v234, v5, v101
    v_fmac_f32 v236, v13, v133
    v_fmac_f32 v234, v6, v102
    v_fmac_f32 v236, v14, v134
    v_fmac_f32 v234, v7, v103
    v_fmac_f32 v236, v15, v135
    v_mul_f32 v238, v16, v128
    v_mul_f32 v240, v24, v128
    v_fmac_f32 v238, v17, v129
    v_fmac_f32 v240, v25, v129
    v_fmac_f32 v238, v18, v130
    v_fmac_f32 v240, v26, v130
    v_fmac_f32 v238, v19, v131
    v_fmac_f32 v240, v27, v131
    v_fmac_f32 v238, v20, v132
    v_fmac_f32 v240, v28, v132
    v_fmac_f32 v238, v21, v133
    v_fmac_f32 v240, v29, v133
    v_fmac_f32 v238, v22, v134
    v_fmac_f32 v240, v30, v134
    v_fmac_f32 v238, v23, v135
    v_fmac_f32 v240, v31, v135
    v_mul_f32 v235, v32, v104
    v_mul_f32 v237, v40, v136
    v_fmac_f32 v235, v33, v105
    v_fmac_f32 v237, v41, v137
    v_fmac_f32 v235, v34, v106
    v_fmac_f32 v237, v42, v138
    v_fmac_f32 v235, v35, v107
    v_fmac_f32 v237, v43, v139
    v_fmac_f32 v235, v36, v108
    v_fmac_f32 v237, v44, v140
    v_fmac_f32 v235, v37, v109
    v_fmac_f32 v237, v45, v141
    v_fmac_f32 v235, v38, v110
    v_fmac_f32 v237, v46, v142
    v_fmac_f32 v235, v39, v111
    v_fmac_f32 v237, v47, v143
    v_mul_f32 v239, v48, v136
    v_mul_f32 v241, v56, v136
    v_fmac_f32 v239, v49, v137
    v_fmac_f32 v241, v57, v137
    v_fmac_f32 v239, v50, v138
    v_fmac_f32 v241, v58, v138
    v_fmac_f32 v239, v51, v139
    v_fmac_f32 v241, v59, v139
    v_fmac_f32 v239, v52, v140
    v_fmac_f32 v241, v60, v140
    v_fmac_f32 v239, v53, v141
    v_fmac_f32 v241, v61, v141
    v_fmac_f32 v239, v54, v142
    v_fmac_f32 v241, v62, v142
    v_fmac_f32 v239, v55, v143
    v_fmac_f32 v241, v63, v143
    s_setprio 1
    s_waitcnt vmcnt(6) lgkmcnt(0)
    v_mfma_f32_32x32x16_bf16 v[0:15], v[64:67], v[184:187], 0
    ds_read_b64_tr_b16 v[176:177], v246 offset:4096
    ds_read_b64_tr_b16 v[178:179], v246 offset:5120
    ds_read_b64_tr_b16 v[180:181], v247 offset:4096
    ds_read_b64_tr_b16 v[182:183], v247 offset:5120
    s_mov_b32 m0, s69
    v_mfma_f32_32x32x16_bf16 v[16:31], v[68:71], v[184:187], 0
    buffer_load_dwordx4 v224, s[4:7], s45 offen sc1 lds
    buffer_load_dwordx4 v225, s[72:75], s45 offen offset:1024 sc1 lds
    v_permlane32_swap_b32 v234, v236
    v_permlane32_swap_b32 v235, v237
    v_mfma_f32_32x32x16_bf16 v[32:47], v[64:67], v[188:191], 0
    v_permlane32_swap_b32 v240, v238
    v_permlane32_swap_b32 v241, v239
    v_add_f32 v234, v234, v236
    v_add_f32 v235, v235, v237
    v_add_f32 v240, v240, v238
    v_mfma_f32_32x32x16_bf16 v[48:63], v[68:71], v[188:191], 0
    s_setprio 0
    v_add_f32 v241, v241, v239
    s_set_gpr_idx_on s31, gpr_idx(DST)
    s_nop 0
    v_cvt_pk_bf16_f32 v192, v234, v235
    v_cvt_pk_bf16_f32 v193, v240, v241
    s_set_gpr_idx_off
    v_mul_f32 v234, v0, v144
    v_mul_f32 v236, v8, v112
    v_fmac_f32 v234, v1, v145
    v_fmac_f32 v236, v9, v113
    v_fmac_f32 v234, v2, v146
    v_fmac_f32 v236, v10, v114
    v_fmac_f32 v234, v3, v147
    v_fmac_f32 v236, v11, v115
    v_fmac_f32 v234, v4, v148
    v_fmac_f32 v236, v12, v116
    v_fmac_f32 v234, v5, v149
    v_fmac_f32 v236, v13, v117
    v_fmac_f32 v234, v6, v150
    v_fmac_f32 v236, v14, v118
    v_fmac_f32 v234, v7, v151
    v_fmac_f32 v236, v15, v119
    v_mul_f32 v238, v16, v160
    v_mul_f32 v240, v24, v160
    v_fmac_f32 v238, v17, v161
    v_fmac_f32 v240, v25, v161
    v_fmac_f32 v238, v18, v162
    v_fmac_f32 v240, v26, v162
    v_fmac_f32 v238, v19, v163
    v_fmac_f32 v240, v27, v163
    v_fmac_f32 v238, v20, v164
    v_fmac_f32 v240, v28, v164
    v_fmac_f32 v238, v21, v165
    v_fmac_f32 v240, v29, v165
    v_fmac_f32 v238, v22, v166
    v_fmac_f32 v240, v30, v166
    v_fmac_f32 v238, v23, v167
    v_fmac_f32 v240, v31, v167
    v_mul_f32 v235, v32, v152
    v_mul_f32 v237, v40, v120
    v_fmac_f32 v235, v33, v153
    v_fmac_f32 v237, v41, v121
    v_fmac_f32 v235, v34, v154
    v_fmac_f32 v237, v42, v122
    v_fmac_f32 v235, v35, v155
    v_fmac_f32 v237, v43, v123
    v_fmac_f32 v235, v36, v156
    v_fmac_f32 v237, v44, v124
    v_fmac_f32 v235, v37, v157
    v_fmac_f32 v237, v45, v125
    v_fmac_f32 v235, v38, v158
    v_fmac_f32 v237, v46, v126
    v_fmac_f32 v235, v39, v159
    v_fmac_f32 v237, v47, v127
    v_mul_f32 v239, v48, v168
    v_mul_f32 v241, v56, v168
    v_fmac_f32 v239, v49, v169
    v_fmac_f32 v241, v57, v169
    v_fmac_f32 v239, v50, v170
    v_fmac_f32 v241, v58, v170
    v_fmac_f32 v239, v51, v171
    v_fmac_f32 v241, v59, v171
    v_fmac_f32 v239, v52, v172
    v_fmac_f32 v241, v60, v172
    v_fmac_f32 v239, v53, v173
    v_fmac_f32 v241, v61, v173
    v_fmac_f32 v239, v54, v174
    v_fmac_f32 v241, v62, v174
    v_fmac_f32 v239, v55, v175
    v_fmac_f32 v241, v63, v175
    s_setprio 1
    s_waitcnt vmcnt(6) lgkmcnt(0)
    v_mfma_f32_32x32x16_bf16 v[0:15], v[64:67], v[176:179], 0
    ds_read_b64_tr_b16 v[184:185], v246 offset:6144
    ds_read_b64_tr_b16 v[186:187], v246 offset:7168
    ds_read_b64_tr_b16 v[188:189], v247 offset:6144
    ds_read_b64_tr_b16 v[190:191], v247 offset:7168
    s_mov_b32 m0, s70
    v_mfma_f32_32x32x16_bf16 v[16:31], v[68:71], v[176:179], 0
    buffer_load_dwordx4 v226, s[4:7], s46 offen sc1 lds
    buffer_load_dwordx4 v227, s[72:75], s46 offen offset:1024 sc1 lds
    s_sub_u32 s26, s48, s29
    s_mov_b32 s29, s48
    s_mov_b32 s30, s3
    s_bfe_u32 s56, s3, 0x40012
    v_mfma_f32_32x32x16_bf16 v[32:47], v[64:67], v[180:183], 0
    s_cmp_eq_u32 s34, 0
    s_cselect_b32 s56, s56, 0
    v_mfma_f32_32x32x16_bf16 v[48:63], v[68:71], v[180:183], 0
    s_setprio 0
    v_mul_f32 v242, v0, v144
    v_fma_f32 v238, v8, v160, -v238
    v_fmac_f32 v242, v1, v145
    v_fmac_f32 v238, v9, v161
    v_fmac_f32 v242, v2, v146
    v_fmac_f32 v238, v10, v162
    v_fmac_f32 v242, v3, v147
    v_fmac_f32 v238, v11, v163
    v_fmac_f32 v242, v4, v148
    v_fmac_f32 v238, v12, v164
    v_fmac_f32 v242, v5, v149
    v_fmac_f32 v238, v13, v165
    v_fmac_f32 v242, v6, v150
    v_fmac_f32 v238, v14, v166
    v_fmac_f32 v242, v7, v151
    v_fmac_f32 v238, v15, v167
    v_fmac_f32 v236, v16, v112
    v_mul_f32 v244, v24, v160
    v_fmac_f32 v236, v17, v113
    v_fmac_f32 v244, v25, v161
    v_fmac_f32 v236, v18, v114
    v_fmac_f32 v244, v26, v162
    v_fmac_f32 v236, v19, v115
    v_fmac_f32 v244, v27, v163
    v_fmac_f32 v236, v20, v116
    v_fmac_f32 v244, v28, v164
    v_fmac_f32 v236, v21, v117
    v_fmac_f32 v244, v29, v165
    v_fmac_f32 v236, v22, v118
    v_fmac_f32 v244, v30, v166
    v_fmac_f32 v236, v23, v119
    v_fmac_f32 v244, v31, v167
    v_mul_f32 v243, v32, v152
    v_fma_f32 v239, v40, v168, -v239
    v_fmac_f32 v243, v33, v153
    v_fmac_f32 v239, v41, v169
    v_fmac_f32 v243, v34, v154
    v_fmac_f32 v239, v42, v170
    v_fmac_f32 v243, v35, v155
    v_fmac_f32 v239, v43, v171
    v_fmac_f32 v243, v36, v156
    v_fmac_f32 v239, v44, v172
    v_fmac_f32 v243, v37, v157
    v_fmac_f32 v239, v45, v173
    v_fmac_f32 v243, v38, v158
    v_fmac_f32 v239, v46, v174
    v_fmac_f32 v243, v39, v159
    v_fmac_f32 v239, v47, v175
    v_fmac_f32 v237, v48, v120
    v_mul_f32 v245, v56, v168
    v_fmac_f32 v237, v49, v121
    v_fmac_f32 v245, v57, v169
    v_fmac_f32 v237, v50, v122
    v_fmac_f32 v245, v58, v170
    v_fmac_f32 v237, v51, v123
    v_fmac_f32 v245, v59, v171
    v_fmac_f32 v237, v52, v124
    v_fmac_f32 v245, v60, v172
    v_fmac_f32 v237, v53, v125
    v_fmac_f32 v245, v61, v173
    v_fmac_f32 v237, v54, v126
    v_fmac_f32 v245, v62, v174
    v_fmac_f32 v237, v55, v127
    v_fmac_f32 v245, v63, v175
    s_setprio 1
    s_waitcnt vmcnt(4) lgkmcnt(0)
    v_mfma_f32_32x32x16_bf16 v[0:15], v[64:67], v[184:187], 0
    ds_read_b64_tr_b16 v[176:177], v246 offset:0
    ds_read_b64_tr_b16 v[178:179], v246 offset:1024
    ds_read_b64_tr_b16 v[180:181], v247 offset:0
    ds_read_b64_tr_b16 v[182:183], v247 offset:1024
    s_mov_b32 m0, s71
    v_mfma_f32_32x32x16_bf16 v[16:31], v[68:71], v[184:187], 0
    s_cmp_eq_u32 s33, 4
    s_cbranch_scc1 K2_g4_104
    buffer_load_dwordx4 v224, s[4:7], s47 offen sc1 lds
    buffer_load_dwordx4 v225, s[72:75], s47 offen offset:1024 sc1 lds
K2_back_105:
    v_permlane32_swap_b32 v242, v234
    v_mfma_f32_32x32x16_bf16 v[32:47], v[64:67], v[188:191], 0
    v_permlane32_swap_b32 v243, v235
    v_add_f32 v242, v242, v234
    v_add_f32 v243, v243, v235
    s_set_gpr_idx_on s31, gpr_idx(DST)
    s_nop 0
    v_cvt_pk_bf16_f32 v194, v242, v243
    s_set_gpr_idx_off
    s_mov_b32 s32, s31
    s_mov_b32 s31, s35
    v_mfma_f32_32x32x16_bf16 v[48:63], v[68:71], v[188:191], 0
    s_setprio 0
    v_mul_f32 v242, v0, v144
    v_fma_f32 v240, v8, v160, -v240
    v_fmac_f32 v242, v1, v145
    v_fmac_f32 v240, v9, v161
    v_fmac_f32 v242, v2, v146
    v_fmac_f32 v240, v10, v162
    v_fmac_f32 v242, v3, v147
    v_fmac_f32 v240, v11, v163
    v_fmac_f32 v242, v4, v148
    v_fmac_f32 v240, v12, v164
    v_fmac_f32 v242, v5, v149
    v_fmac_f32 v240, v13, v165
    v_fmac_f32 v242, v6, v150
    v_fmac_f32 v240, v14, v166
    v_fmac_f32 v242, v7, v151
    v_fmac_f32 v240, v15, v167
    v_add_u32 v249, s26, v249
    v_add_u32 v250, s26, v250
    v_fma_f32 v244, v16, v160, -v244
    v_fmac_f32 v236, v24, v112
    v_fmac_f32 v244, v17, v161
    v_fmac_f32 v236, v25, v113
    v_fmac_f32 v244, v18, v162
    v_fmac_f32 v236, v26, v114
    v_fmac_f32 v244, v19, v163
    v_fmac_f32 v236, v27, v115
    v_fmac_f32 v244, v20, v164
    v_fmac_f32 v236, v28, v116
    v_fmac_f32 v244, v21, v165
    v_fmac_f32 v236, v29, v117
    v_fmac_f32 v244, v22, v166
    v_fmac_f32 v236, v30, v118
    v_fmac_f32 v244, v23, v167
    v_fmac_f32 v236, v31, v119
    ds_read_b64_tr_b16 v[0:1], v249 offset:0
    ds_read_b64_tr_b16 v[2:3], v249 offset:32
    ds_read_u16_d16_hi v16, v250 offset:0
    v_mul_f32 v243, v32, v152
    v_fma_f32 v241, v40, v168, -v241
    v_fmac_f32 v243, v33, v153
    v_fmac_f32 v241, v41, v169
    v_fmac_f32 v243, v34, v154
    v_fmac_f32 v241, v42, v170
    v_fmac_f32 v243, v35, v155
    v_fmac_f32 v241, v43, v171
    v_fmac_f32 v243, v36, v156
    v_fmac_f32 v241, v44, v172
    v_fmac_f32 v243, v37, v157
    v_fmac_f32 v241, v45, v173
    v_fmac_f32 v243, v38, v158
    v_fmac_f32 v241, v46, v174
    v_fmac_f32 v243, v39, v159
    v_fmac_f32 v241, v47, v175
    ds_read_b64_tr_b16 v[4:5], v249 offset:512
    ds_read_b64_tr_b16 v[6:7], v249 offset:544
    ds_read_u16_d16_hi v17, v250 offset:128
    v_fma_f32 v245, v48, v168, -v245
    v_fmac_f32 v237, v56, v120
    v_fmac_f32 v245, v49, v169
    v_fmac_f32 v237, v57, v121
    v_fmac_f32 v245, v50, v170
    v_fmac_f32 v237, v58, v122
    v_fmac_f32 v245, v51, v171
    v_fmac_f32 v237, v59, v123
    v_fmac_f32 v245, v52, v172
    v_fmac_f32 v237, v60, v124
    v_fmac_f32 v245, v53, v173
    v_fmac_f32 v237, v61, v125
    v_fmac_f32 v245, v54, v174
    v_fmac_f32 v237, v62, v126
    v_fmac_f32 v245, v55, v175
    v_fmac_f32 v237, v63, v127
    s_cmp_eq_u32 s56, 5
    s_cbranch_scc1 K2_U20
    s_cmp_eq_u32 s56, 6
    s_cbranch_scc1 K2_U3h0
    s_branch K2_DSP0
K2_U40:
    s_setprio 1
    ds_read_b64_tr_b16 v[8:9], v249 offset:1024
    ds_read_b64_tr_b16 v[10:11], v249 offset:1056
    ds_read_u16_d16_hi v18, v250 offset:256
    s_lshr_b32 s65, s30, 28
    s_mul_i32 s66, s22, 2080
    s_lshl_b32 s65, s65, 9
    s_add_u32 s65, s65, s66
    s_add_u32 s65, s65, 65536
    s_sub_u32 s65, s65, s29
    s_sub_u32 s65, s65, 512
    v_add_u32 v56, s65, v249
    ds_read_b64_tr_b16 v[12:13], v56 offset:0
    ds_read_b64_tr_b16 v[14:15], v56 offset:32
    ds_read_u16_d16_hi v19, v250 offset:384
    s_waitcnt lgkmcnt(6)
    v_lshlrev_b32 v20, 16, v0
    v_and_b32 v21, 0xffff0000, v0
    v_lshlrev_b32 v22, 16, v1
    v_and_b32 v23, 0xffff0000, v1
    v_lshlrev_b32 v24, 16, v2
    v_and_b32 v25, 0xffff0000, v2
    v_lshlrev_b32 v26, 16, v3
    v_and_b32 v27, 0xffff0000, v3
    v_mul_f32_dpp v36, v16, v20 row_newbcast:8 row_mask:0xf bank_mask:0xf
    v_mul_f32_dpp v37, v16, v21 row_newbcast:9 row_mask:0xf bank_mask:0xf
    v_mul_f32_dpp v38, v16, v22 row_newbcast:10 row_mask:0xf bank_mask:0xf
    v_mul_f32_dpp v39, v16, v23 row_newbcast:11 row_mask:0xf bank_mask:0xf
    v_mul_f32_dpp v40, v16, v24 row_newbcast:12 row_mask:0xf bank_mask:0xf
    v_mul_f32_dpp v41, v16, v25 row_newbcast:13 row_mask:0xf bank_mask:0xf
    v_mul_f32_dpp v42, v16, v26 row_newbcast:14 row_mask:0xf bank_mask:0xf
    v_mul_f32_dpp v43, v16, v27 row_newbcast:15 row_mask:0xf bank_mask:0xf
    v_cvt_pk_bf16_f32 v68, v36, v37
    v_cvt_pk_bf16_f32 v69, v38, v39
    v_cvt_pk_bf16_f32 v70, v40, v41
    v_cvt_pk_bf16_f32 v71, v42, v43
    v_mul_f32_dpp v20, v16, v20 row_newbcast:0 row_mask:0xa bank_mask:0xf
    v_mul_f32_dpp v21, v16, v21 row_newbcast:1 row_mask:0xa bank_mask:0xf
    v_mul_f32_dpp v22, v16, v22 row_newbcast:2 row_mask:0xa bank_mask:0xf
    v_mul_f32_dpp v23, v16, v23 row_newbcast:3 row_mask:0xa bank_mask:0xf
    v_mul_f32_dpp v24, v16, v24 row_newbcast:4 row_mask:0xa bank_mask:0xf
    v_mul_f32_dpp v25, v16, v25 row_newbcast:5 row_mask:0xa bank_mask:0xf
    v_mul_f32_dpp v26, v16, v26 row_newbcast:6 row_mask:0xa bank_mask:0xf
    v_mul_f32_dpp v27, v16, v27 row_newbcast:7 row_mask:0xa bank_mask:0xf
    v_cvt_pk_bf16_f32 v64, v20, v21
    v_cvt_pk_bf16_f32 v65, v22, v23
    v_cvt_pk_bf16_f32 v66, v24, v25
    v_cvt_pk_bf16_f32 v67, v26, v27
    v_lshlrev_b32 v28, 16, v4
    v_and_b32 v29, 0xffff0000, v4
    v_lshlrev_b32 v30, 16, v5
    v_and_b32 v31, 0xffff0000, v5
    v_lshlrev_b32 v32, 16, v6
    v_and_b32 v33, 0xffff0000, v6
    v_lshlrev_b32 v34, 16, v7
    v_and_b32 v35, 0xffff0000, v7
    v_mul_f32_dpp v36, v17, v28 row_newbcast:8 row_mask:0xf bank_mask:0xf
    v_mul_f32_dpp v37, v17, v29 row_newbcast:9 row_mask:0xf bank_mask:0xf
    v_mul_f32_dpp v38, v17, v30 row_newbcast:10 row_mask:0xf bank_mask:0xf
    v_mul_f32_dpp v39, v17, v31 row_newbcast:11 row_mask:0xf bank_mask:0xf
    v_mul_f32_dpp v40, v17, v32 row_newbcast:12 row_mask:0xf bank_mask:0xf
    v_mul_f32_dpp v41, v17, v33 row_newbcast:13 row_mask:0xf bank_mask:0xf
    v_mul_f32_dpp v42, v17, v34 row_newbcast:14 row_mask:0xf bank_mask:0xf
    v_mul_f32_dpp v43, v17, v35 row_newbcast:15 row_mask:0xf bank_mask:0xf
    v_cvt_pk_bf16_f32 v76, v36, v37
    v_cvt_pk_bf16_f32 v77, v38, v39
    v_cvt_pk_bf16_f32 v78, v40, v41
    v_cvt_pk_bf16_f32 v79, v42, v43
    v_mul_f32_dpp v28, v17, v28 row_newbcast:0 row_mask:0xa bank_mask:0xf
    v_mul_f32_dpp v29, v17, v29 row_newbcast:1 row_mask:0xa bank_mask:0xf
    v_mul_f32_dpp v30, v17, v30 row_newbcast:2 row_mask:0xa bank_mask:0xf
    v_mul_f32_dpp v31, v17, v31 row_newbcast:3 row_mask:0xa bank_mask:0xf
    v_mul_f32_dpp v32, v17, v32 row_newbcast:4 row_mask:0xa bank_mask:0xf
    v_mul_f32_dpp v33, v17, v33 row_newbcast:5 row_mask:0xa bank_mask:0xf
    v_mul_f32_dpp v34, v17, v34 row_newbcast:6 row_mask:0xa bank_mask:0xf
    v_mul_f32_dpp v35, v17, v35 row_newbcast:7 row_mask:0xa bank_mask:0xf
    v_cvt_pk_bf16_f32 v72, v28, v29
    v_cvt_pk_bf16_f32 v73, v30, v31
    v_cvt_pk_bf16_f32 v74, v32, v33
    v_cvt_pk_bf16_f32 v75, v34, v35
    s_waitcnt lgkmcnt(3)
    v_lshlrev_b32 v20, 16, v8
    v_and_b32 v21, 0xffff0000, v8
    v_lshlrev_b32 v22, 16, v9
    v_and_b32 v23, 0xffff0000, v9
    v_lshlrev_b32 v24, 16, v10
    v_and_b32 v25, 0xffff0000, v10
    v_lshlrev_b32 v26, 16, v11
    v_and_b32 v27, 0xffff0000, v11
    v_mul_f32_dpp v36, v18, v20 row_newbcast:8 row_mask:0xf bank_mask:0xf
    v_mul_f32_dpp v37, v18, v21 row_newbcast:9 row_mask:0xf bank_mask:0xf
    v_mul_f32_dpp v38, v18, v22 row_newbcast:10 row_mask:0xf bank_mask:0xf
    v_mul_f32_dpp v39, v18, v23 row_newbcast:11 row_mask:0xf bank_mask:0xf
    v_mul_f32_dpp v40, v18, v24 row_newbcast:12 row_mask:0xf bank_mask:0xf
    v_mul_f32_dpp v41, v18, v25 row_newbcast:13 row_mask:0xf bank_mask:0xf
    v_mul_f32_dpp v42, v18, v26 row_newbcast:14 row_mask:0xf bank_mask:0xf
    v_mul_f32_dpp v43, v18, v27 row_newbcast:15 row_mask:0xf bank_mask:0xf
    v_cvt_pk_bf16_f32 v84, v36, v37
    v_cvt_pk_bf16_f32 v85, v38, v39
    v_cvt_pk_bf16_f32 v86, v40, v41
    v_cvt_pk_bf16_f32 v87, v42, v43
    v_mul_f32_dpp v20, v18, v20 row_newbcast:0 row_mask:0xa bank_mask:0xf
    v_mul_f32_dpp v21, v18, v21 row_newbcast:1 row_mask:0xa bank_mask:0xf
    v_mul_f32_dpp v22, v18, v22 row_newbcast:2 row_mask:0xa bank_mask:0xf
    v_mul_f32_dpp v23, v18, v23 row_newbcast:3 row_mask:0xa bank_mask:0xf
    v_mul_f32_dpp v24, v18, v24 row_newbcast:4 row_mask:0xa bank_mask:0xf
    v_mul_f32_dpp v25, v18, v25 row_newbcast:5 row_mask:0xa bank_mask:0xf
    v_mul_f32_dpp v26, v18, v26 row_newbcast:6 row_mask:0xa bank_mask:0xf
    v_mul_f32_dpp v27, v18, v27 row_newbcast:7 row_mask:0xa bank_mask:0xf
    v_cvt_pk_bf16_f32 v80, v20, v21
    v_cvt_pk_bf16_f32 v81, v22, v23
    v_cvt_pk_bf16_f32 v82, v24, v25
    v_cvt_pk_bf16_f32 v83, v26, v27
    s_waitcnt lgkmcnt(0)
    v_lshlrev_b32 v28, 16, v12
    v_and_b32 v29, 0xffff0000, v12
    v_lshlrev_b32 v30, 16, v13
    v_and_b32 v31, 0xffff0000, v13
    v_lshlrev_b32 v32, 16, v14
    v_and_b32 v33, 0xffff0000, v14
    v_lshlrev_b32 v34, 16, v15
    v_and_b32 v35, 0xffff0000, v15
    v_mul_f32_dpp v36, v19, v28 row_newbcast:8 row_mask:0xf bank_mask:0xf
    v_mul_f32_dpp v37, v19, v29 row_newbcast:9 row_mask:0xf bank_mask:0xf
    v_mul_f32_dpp v38, v19, v30 row_newbcast:10 row_mask:0xf bank_mask:0xf
    v_mul_f32_dpp v39, v19, v31 row_newbcast:11 row_mask:0xf bank_mask:0xf
    v_mul_f32_dpp v40, v19, v32 row_newbcast:12 row_mask:0xf bank_mask:0xf
    v_mul_f32_dpp v41, v19, v33 row_newbcast:13 row_mask:0xf bank_mask:0xf
    v_mul_f32_dpp v42, v19, v34 row_newbcast:14 row_mask:0xf bank_mask:0xf
    v_mul_f32_dpp v43, v19, v35 row_newbcast:15 row_mask:0xf bank_mask:0xf
    v_cvt_pk_bf16_f32 v92, v36, v37
    v_cvt_pk_bf16_f32 v93, v38, v39
    v_cvt_pk_bf16_f32 v94, v40, v41
    v_cvt_pk_bf16_f32 v95, v42, v43
    v_mul_f32_dpp v28, v19, v28 row_newbcast:0 row_mask:0xa bank_mask:0xf
    v_mul_f32_dpp v29, v19, v29 row_newbcast:1 row_mask:0xa bank_mask:0xf
    v_mul_f32_dpp v30, v19, v30 row_newbcast:2 row_mask:0xa bank_mask:0xf
    v_mul_f32_dpp v31, v19, v31 row_newbcast:3 row_mask:0xa bank_mask:0xf
    v_mul_f32_dpp v32, v19, v32 row_newbcast:4 row_mask:0xa bank_mask:0xf
    v_mul_f32_dpp v33, v19, v33 row_newbcast:5 row_mask:0xa bank_mask:0xf
    v_mul_f32_dpp v34, v19, v34 row_newbcast:6 row_mask:0xa bank_mask:0xf
    v_mul_f32_dpp v35, v19, v35 row_newbcast:7 row_mask:0xa bank_mask:0xf
    v_cvt_pk_bf16_f32 v88, v28, v29
    v_cvt_pk_bf16_f32 v89, v30, v31
    v_cvt_pk_bf16_f32 v90, v32, v33
    v_cvt_pk_bf16_f32 v91, v34, v35
    s_waitcnt vmcnt(4)
    v_mfma_f32_32x32x16_bf16 v[0:15], v[64:67], v[176:179], 0
    ds_read_b64_tr_b16 v[184:185], v246 offset:2048
    ds_read_b64_tr_b16 v[186:187], v246 offset:3072
    ds_read_b64_tr_b16 v[188:189], v247 offset:2048
    ds_read_b64_tr_b16 v[190:191], v247 offset:3072
    s_mov_b32 m0, s68
    v_mfma_f32_32x32x16_bf16 v[16:31], v[68:71], v[176:179], 0
    buffer_load_dwordx4 v222, s[4:7], s41 offen sc1 lds
    buffer_load_dwordx4 v223, s[72:75], s41 offen offset:1024 sc1 lds
    v_permlane32_swap_b32 v242, v236
    v_permlane32_swap_b32 v243, v237
    s_add_u32 s38, s38, 1
    v_mfma_f32_32x32x16_bf16 v[32:47], v[64:67], v[180:183], 0
    v_permlane32_swap_b32 v244, v238
    v_permlane32_swap_b32 v245, v239
    v_permlane32_swap_b32 v240, v241
    v_add_f32 v242, v242, v236
    v_mfma_f32_32x32x16_bf16 v[48:63], v[68:71], v[180:183], 0
    v_add_f32 v243, v243, v237
    v_add_f32 v244, v244, v238
    v_add_f32 v245, v245, v239
    v_add_f32 v240, -v240, -v241
    v_mov_b32 v254, s52
    v_mov_b32 v255, s38
    s_waitcnt vmcnt(4) lgkmcnt(0)
    v_mfma_f32_32x32x16_bf16 v[0:15], v[72:75], v[184:187], v[0:15]
    ds_read_b64_tr_b16 v[176:177], v246 offset:4096
    ds_read_b64_tr_b16 v[178:179], v246 offset:5120
    ds_read_b64_tr_b16 v[180:181], v247 offset:4096
    ds_read_b64_tr_b16 v[182:183], v247 offset:5120
    s_lshl_b32 s58, s38, 3
    s_add_u32 s58, s58, s20
    s_mov_b32 m0, s69
    v_mfma_f32_32x32x16_bf16 v[16:31], v[76:79], v[184:187], v[16:31]
    buffer_load_dwordx4 v224, s[4:7], s41 offen sc1 lds
    buffer_load_dwordx4 v225, s[72:75], s41 offen offset:1024 sc1 lds
    s_set_gpr_idx_on s32, gpr_idx(DST)
    s_nop 0
    v_cvt_pk_bf16_f32 v195, v242, v243
    v_cvt_pk_bf16_f32 v196, v244, v245
    v_cvt_pk_bf16_f32 v197, v240, v240
    s_set_gpr_idx_off
    s_mov_b64 exec, 1
    ds_write_b32 v254, v255
    s_mov_b64 exec, -1
    s_cmp_lt_u32 s58, s22
    s_cbranch_scc0 K2_dyn_106
K2_back_107:
    v_readlane_b32 s3, v253, s58
    s_lshl_b32 s44, s34, 7
    s_and_b32 s48, s3, 0x3ffff
    s_bfe_u32 s33, s3, 0x30013
    s_mul_i32 s35, s38, 6
    s_cmp_eq_u32 s34, 0
    s_cselect_b32 s35, s35, s48
    s_mov_b32 s45, s44
    s_xor_b32 s47, s44, 256
    s_add_u32 s49, s48, 128
    s_add_u32 s60, s48, 256
    s_cmp_eq_u32 s33, 3
    s_cselect_b32 s46, s44, s47
    s_cselect_b32 s50, s60, s48
    s_sub_u32 s60, s33, 2
    s_cmp_lt_u32 s60, 2
    s_cbranch_scc0 K2_rare_112
K2_back_113:
    v_mfma_f32_32x32x16_bf16 v[32:47], v[72:75], v[188:191], v[32:47]
    v_add_u32 v233, s48, v230
    ds_read_b32 v232, v233
    ds_read_b32 v233, v233 offset:1024
    v_mfma_f32_32x32x16_bf16 v[48:63], v[76:79], v[188:191], v[48:63]
    s_waitcnt vmcnt(4) lgkmcnt(3)
    v_mfma_f32_32x32x16_bf16 v[0:15], v[80:83], v[176:179], v[0:15]
    ds_read_b64_tr_b16 v[184:185], v246 offset:6144
    ds_read_b64_tr_b16 v[186:187], v246 offset:7168
    ds_read_b64_tr_b16 v[188:189], v247 offset:6144
    ds_read_b64_tr_b16 v[190:191], v247 offset:7168
    s_mov_b32 m0, s70
    v_mfma_f32_32x32x16_bf16 v[16:31], v[84:87], v[176:179], v[16:31]
    buffer_load_dwordx4 v226, s[4:7], s41 offen sc1 lds
    buffer_load_dwordx4 v227, s[72:75], s41 offen offset:1024 sc1 lds
    v_mfma_f32_32x32x16_bf16 v[32:47], v[80:83], v[180:183], v[32:47]
    v_mfma_f32_32x32x16_bf16 v[48:63], v[84:87], v[180:183], v[48:63]
    s_waitcnt lgkmcnt(4)
    v_or_b32 v232, v232, v231
    v_or_b32 v233, v233, v231
    s_cmp_lg_u32 s34, 0
    s_cbranch_scc1 K2_dum_117
    s_cmp_eq_u32 s33, 4
    s_cbranch_scc1 K2_a4_118
K2_b4_120:
    s_add_u32 m0, s48, 512
    s_add_u32 s65, s48, 1536
    buffer_load_dwordx4 v232, s[16:19], 0 offen  lds
    s_mov_b32 m0, s65
    s_mov_b32 exec_hi, 0
    buffer_load_dwordx4 v233, s[16:19], 0 offen  lds
    s_mov_b32 exec_hi, -1
K2_back_119:
    s_waitcnt vmcnt(6) lgkmcnt(0)
    v_mfma_f32_32x32x16_bf16 v[0:15], v[88:91], v[184:187], v[0:15]
    ds_read_b64_tr_b16 v[176:177], v246 offset:0
    ds_read_b64_tr_b16 v[178:179], v246 offset:1024
    ds_read_b64_tr_b16 v[180:181], v247 offset:0
    ds_read_b64_tr_b16 v[182:183], v247 offset:1024
    s_mov_b32 m0, s71
    v_mfma_f32_32x32x16_bf16 v[16:31], v[92:95], v[184:187], v[16:31]
    buffer_load_dwordx4 v228, s[4:7], s41 offen sc1 lds
    buffer_load_dwordx4 v229, s[72:75], s41 offen offset:1024 sc1 lds
    v_mfma_f32_32x32x16_bf16 v[32:47], v[88:91], v[188:191], v[32:47]
    s_nop 2
    v_mul_f32 v234, v0, v96
    v_mul_f32 v236, v8, v128
    v_fmac_f32 v234, v1, v97
    v_fmac_f32 v236, v9, v129
    v_fmac_f32 v234, v2, v98
    v_fmac_f32 v236, v10, v130
    v_fmac_f32 v234, v3, v99
    v_mfma_f32_32x32x16_bf16 v[48:63], v[92:95], v[188:191], v[48:63]
    s_setprio 0
    v_fmac_f32 v236, v11, v131
    v_fmac_f32 v234, v4, v100
    v_fmac_f32 v236, v12, v132
    v_fmac_f32 v234, v5, v101
    v_fmac_f32 v236, v13, v133
    v_fmac_f32 v234, v6, v102
    v_fmac_f32 v236, v14, v134
    v_fmac_f32 v234, v7, v103
    v_fmac_f32 v236, v15, v135
    v_mul_f32 v238, v16, v128
    v_mul_f32 v240, v24, v128
    v_fmac_f32 v238, v17, v129
    v_fmac_f32 v240, v25, v129
    v_fmac_f32 v238, v18, v130
    v_fmac_f32 v240, v26, v130
    v_fmac_f32 v238, v19, v131
    v_fmac_f32 v240, v27, v131
    v_fmac_f32 v238, v20, v132
    v_fmac_f32 v240, v28, v132
    v_fmac_f32 v238, v21, v133
    v_fmac_f32 v240, v29, v133
    v_fmac_f32 v238, v22, v134
    v_fmac_f32 v240, v30, v134
    v_fmac_f32 v238, v23, v135
    v_fmac_f32 v240, v31, v135
    v_mul_f32 v235, v32, v104
    v_mul_f32 v237, v40, v136
    v_fmac_f32 v235, v33, v105
    v_fmac_f32 v237, v41, v137
    v_fmac_f32 v235, v34, v106
    v_fmac_f32 v237, v42, v138
    v_fmac_f32 v235, v35, v107
    v_fmac_f32 v237, v43, v139
    v_fmac_f32 v235, v36, v108
    v_fmac_f32 v237, v44, v140
    v_fmac_f32 v235, v37, v109
    v_fmac_f32 v237, v45, v141
    v_fmac_f32 v235, v38, v110
    v_fmac_f32 v237, v46, v142
    v_fmac_f32 v235, v39, v111
    v_fmac_f32 v237, v47, v143
    v_mul_f32 v239, v48, v136
    v_mul_f32 v241, v56, v136
    s_setprio 1
    s_waitcnt vmcnt(6) lgkmcnt(0)
    v_mfma_f32_32x32x16_bf16 v[0:15], v[64:67], v[176:179], 0
    ds_read_b64_tr_b16 v[184:185], v246 offset:2048
    ds_read_b64_tr_b16 v[186:187], v246 offset:3072
    ds_read_b64_tr_b16 v[188:189], v247 offset:2048
    ds_read_b64_tr_b16 v[190:191], v247 offset:3072
    v_fmac_f32 v239, v49, v137
    v_fmac_f32 v241, v57, v137
    s_mov_b32 m0, s68
    v_mfma_f32_32x32x16_bf16 v[16:31], v[68:71], v[176:179], 0
    buffer_load_dwordx4 v222, s[4:7], s42 offen sc1 lds
    buffer_load_dwordx4 v223, s[72:75], s42 offen offset:1024 sc1 lds
    v_fmac_f32 v239, v50, v138
    v_fmac_f32 v241, v58, v138
    v_fmac_f32 v239, v51, v139
    v_fmac_f32 v241, v59, v139
    v_fmac_f32 v239, v52, v140
    v_mfma_f32_32x32x16_bf16 v[32:47], v[64:67], v[180:183], 0
    v_fmac_f32 v241, v60, v140
    v_fmac_f32 v239, v53, v141
    v_fmac_f32 v241, v61, v141
    v_fmac_f32 v239, v54, v142
    v_fmac_f32 v241, v62, v142
    v_fmac_f32 v239, v55, v143
    v_fmac_f32 v241, v63, v143
    v_mfma_f32_32x32x16_bf16 v[48:63], v[68:71], v[180:183], 0
    v_permlane32_swap_b32 v234, v236
    v_permlane32_swap_b32 v235, v237
    v_permlane32_swap_b32 v240, v238
    s_waitcnt vmcnt(6) lgkmcnt(0)
    v_mfma_f32_32x32x16_bf16 v[0:15], v[72:75], v[184:187], v[0:15]
    ds_read_b64_tr_b16 v[176:177], v246 offset:4096
    ds_read_b64_tr_b16 v[178:179], v246 offset:5120
    ds_read_b64_tr_b16 v[180:181], v247 offset:4096
    ds_read_b64_tr_b16 v[182:183], v247 offset:5120
    v_permlane32_swap_b32 v241, v239
    s_mov_b32 m0, s69
    v_mfma_f32_32x32x16_bf16 v[16:31], v[76:79], v[184:187], v[16:31]
    buffer_load_dwordx4 v224, s[4:7], s42 offen sc1 lds
    buffer_load_dwordx4 v225, s[72:75], s42 offen offset:1024 sc1 lds
    v_add_f32 v234, v234, v236
    v_add_f32 v235, v235, v237
    v_add_f32 v240, v240, v238
    v_add_f32 v241, v241, v239
    v_mfma_f32_32x32x16_bf16 v[32:47], v[72:75], v[188:191], v[32:47]
    s_set_gpr_idx_on s31, gpr_idx(DST)
    s_nop 0
    v_cvt_pk_bf16_f32 v192, v234, v235
    v_cvt_pk_bf16_f32 v193, v240, v241
    s_set_gpr_idx_off
    v_mfma_f32_32x32x16_bf16 v[48:63], v[76:79], v[188:191], v[48:63]
    s_waitcnt vmcnt(4) lgkmcnt(0)
    v_mfma_f32_32x32x16_bf16 v[0:15], v[80:83], v[176:179], v[0:15]
    ds_read_b64_tr_b16 v[184:185], v246 offset:6144
    ds_read_b64_tr_b16 v[186:187], v246 offset:7168
    ds_read_b64_tr_b16 v[188:189], v247 offset:6144
    ds_read_b64_tr_b16 v[190:191], v247 offset:7168
    s_mov_b32 m0, s70
    v_mfma_f32_32x32x16_bf16 v[16:31], v[84:87], v[176:179], v[16:31]
    buffer_load_dwordx4 v226, s[4:7], s42 offen sc1 lds
    buffer_load_dwordx4 v227, s[72:75], s42 offen offset:1024 sc1 lds
    v_mfma_f32_32x32x16_bf16 v[32:47], v[80:83], v[180:183], v[32:47]
    v_mfma_f32_32x32x16_bf16 v[48:63], v[84:87], v[180:183], v[48:63]
    s_waitcnt vmcnt(4) lgkmcnt(0)
    v_mfma_f32_32x32x16_bf16 v[0:15], v[88:91], v[184:187], v[0:15]
    ds_read_b64_tr_b16 v[176:177], v246 offset:0
    ds_read_b64_tr_b16 v[178:179], v246 offset:1024
    ds_read_b64_tr_b16 v[180:181], v247 offset:0
    ds_read_b64_tr_b16 v[182:183], v247 offset:1024
    s_mov_b32 m0, s71
    v_mfma_f32_32x32x16_bf16 v[16:31], v[92:95], v[184:187], v[16:31]
    buffer_load_dwordx4 v228, s[4:7], s42 offen sc1 lds
    buffer_load_dwordx4 v229, s[72:75], s42 offen offset:1024 sc1 lds
    v_mfma_f32_32x32x16_bf16 v[32:47], v[88:91], v[188:191], v[32:47]
    s_nop 2
    v_mul_f32 v234, v0, v144
    v_mul_f32 v236, v8, v112
    v_fmac_f32 v234, v1, v145
    v_fmac_f32 v236, v9, v113
    v_fmac_f32 v234, v2, v146
    v_fmac_f32 v236, v10, v114
    v_fmac_f32 v234, v3, v147
    v_mfma_f32_32x32x16_bf16 v[48:63], v[92:95], v[188:191], v[48:63]
    s_setprio 0
    v_fmac_f32 v236, v11, v115
    v_fmac_f32 v234, v4, v148
    v_fmac_f32 v236, v12, v116
    v_fmac_f32 v234, v5, v149
    v_fmac_f32 v236, v13, v117
    v_fmac_f32 v234, v6, v150
    v_fmac_f32 v236, v14, v118
    v_fmac_f32 v234, v7, v151
    v_fmac_f32 v236, v15, v119
    v_mul_f32 v238, v16, v160
    v_mul_f32 v240, v24, v160
    v_fmac_f32 v238, v17, v161
    v_fmac_f32 v240, v25, v161
    v_fmac_f32 v238, v18, v162
    v_fmac_f32 v240, v26, v162
    v_fmac_f32 v238, v19, v163
    v_fmac_f32 v240, v27, v163
    v_fmac_f32 v238, v20, v164
    v_fmac_f32 v240, v28, v164
    v_fmac_f32 v238, v21, v165
    v_fmac_f32 v240, v29, v165
    v_fmac_f32 v238, v22, v166
    v_fmac_f32 v240, v30, v166
    v_fmac_f32 v238, v23, v167
    v_fmac_f32 v240, v31, v167
    v_mul_f32 v235, v32, v152
    v_mul_f32 v237, v40, v120
    v_fmac_f32 v235, v33, v153
    v_fmac_f32 v237, v41, v121
    v_fmac_f32 v235, v34, v154
    v_fmac_f32 v237, v42, v122
    v_fmac_f32 v235, v35, v155
    v_fmac_f32 v237, v43, v123
    v_fmac_f32 v235, v36, v156
    v_fmac_f32 v237, v44, v124
    v_fmac_f32 v235, v37, v157
    v_fmac_f32 v237, v45, v125
    v_fmac_f32 v235, v38, v158
    v_fmac_f32 v237, v46, v126
    v_fmac_f32 v235, v39, v159
    v_fmac_f32 v237, v47, v127
    v_mul_f32 v239, v48, v168
    v_mul_f32 v241, v56, v168
    s_setprio 1
    s_waitcnt vmcnt(4) lgkmcnt(0)
    v_mfma_f32_32x32x16_bf16 v[0:15], v[64:67], v[176:179], 0
    ds_read_b64_tr_b16 v[184:185], v246 offset:2048
    ds_read_b64_tr_b16 v[186:187], v246 offset:3072
    ds_read_b64_tr_b16 v[188:189], v247 offset:2048
    ds_read_b64_tr_b16 v[190:191], v247 offset:3072
    v_fmac_f32 v239, v49, v169
    v_fmac_f32 v241, v57, v169
    s_mov_b32 m0, s68
    v_mfma_f32_32x32x16_bf16 v[16:31], v[68:71], v[176:179], 0
    buffer_load_dwordx4 v222, s[4:7], s43 offen sc1 lds
    buffer_load_dwordx4 v223, s[72:75], s43 offen offset:1024 sc1 lds
    v_fmac_f32 v239, v50, v170
    v_fmac_f32 v241, v58, v170
    v_fmac_f32 v239, v51, v171
    v_fmac_f32 v241, v59, v171
    v_fmac_f32 v239, v52, v172
    v_mfma_f32_32x32x16_bf16 v[32:47], v[64:67], v[180:183], 0
    v_fmac_f32 v241, v60, v172
    v_fmac_f32 v239, v53, v173
    v_fmac_f32 v241, v61, v173
    v_fmac_f32 v239, v54, v174
    v_fmac_f32 v241, v62, v174
    v_fmac_f32 v239, v55, v175
    v_fmac_f32 v241, v63, v175
    v_mfma_f32_32x32x16_bf16 v[48:63], v[68:71], v[180:183], 0
    s_waitcnt vmcnt(4) lgkmcnt(0)
    v_mfma_f32_32x32x16_bf16 v[0:15], v[72:75], v[184:187], v[0:15]
    ds_read_b64_tr_b16 v[176:177], v246 offset:4096
    ds_read_b64_tr_b16 v[178:179], v246 offset:5120
    ds_read_b64_tr_b16 v[180:181], v247 offset:4096
    ds_read_b64_tr_b16 v[182:183], v247 offset:5120
    s_mov_b32 m0, s69
    v_mfma_f32_32x32x16_bf16 v[16:31], v[76:79], v[184:187], v[16:31]
    buffer_load_dwordx4 v224, s[4:7], s43 offen sc1 lds
    buffer_load_dwordx4 v225, s[72:75], s43 offen offset:1024 sc1 lds
    v_mfma_f32_32x32x16_bf16 v[32:47], v[72:75], v[188:191], v[32:47]
    v_mfma_f32_32x32x16_bf16 v[48:63], v[76:79], v[188:191], v[48:63]
    s_waitcnt vmcnt(4) lgkmcnt(0)
    v_mfma_f32_32x32x16_bf16 v[0:15], v[80:83], v[176:179], v[0:15]
    ds_read_b64_tr_b16 v[184:185], v246 offset:6144
    ds_read_b64_tr_b16 v[186:187], v246 offset:7168
    ds_read_b64_tr_b16 v[188:189], v247 offset:6144
    ds_read_b64_tr_b16 v[190:191], v247 offset:7168
    s_mov_b32 m0, s70
    v_mfma_f32_32x32x16_bf16 v[16:31], v[84:87], v[176:179], v[16:31]
    buffer_load_dwordx4 v226, s[4:7], s43 offen sc1 lds
    buffer_load_dwordx4 v227, s[72:75], s43 offen offset:1024 sc1 lds
    v_mfma_f32_32x32x16_bf16 v[32:47], v[80:83], v[180:183], v[32:47]
    v_add_u32 v222, s48, v251
    ds_read2_b32 v[222:223], v222 offset0:1 offset1:3
    v_mfma_f32_32x32x16_bf16 v[48:63], v[84:87], v[180:183], v[48:63]
    s_waitcnt vmcnt(4) lgkmcnt(1)
    v_mfma_f32_32x32x16_bf16 v[0:15], v[88:91], v[184:187], v[0:15]
    ds_read_b64_tr_b16 v[176:177], v246 offset:0
    ds_read_b64_tr_b16 v[178:179], v246 offset:1024
    ds_read_b64_tr_b16 v[180:181], v247 offset:0
    ds_read_b64_tr_b16 v[182:183], v247 offset:1024
    s_mov_b32 m0, s71
    v_mfma_f32_32x32x16_bf16 v[16:31], v[92:95], v[184:187], v[16:31]
    buffer_load_dwordx4 v228, s[4:7], s43 offen sc1 lds
    buffer_load_dwordx4 v229, s[72:75], s43 offen offset:1024 sc1 lds
    s_waitcnt lgkmcnt(4)
    v_mad_u32_u16 v222, v222, s39, v248 op_sel:[1,0,0,0]
    v_mad_u32_u16 v223, v223, s39, v248 op_sel:[1,0,0,0]
    v_mfma_f32_32x32x16_bf16 v[32:47], v[88:91], v[188:191], v[32:47]
    v_add_u32 v224, s49, v251
    ds_read2_b32 v[224:225], v224 offset0:1 offset1:3
    v_mul_f32 v242, v0, v144
    v_fma_f32 v238, v8, v160, -v238
    v_fmac_f32 v242, v1, v145
    v_fmac_f32 v238, v9, v161
    v_fmac_f32 v242, v2, v146
    v_mfma_f32_32x32x16_bf16 v[48:63], v[92:95], v[188:191], v[48:63]
    s_setprio 0
    v_fmac_f32 v238, v10, v162
    v_fmac_f32 v242, v3, v147
    v_fmac_f32 v238, v11, v163
    v_fmac_f32 v242, v4, v148
    v_fmac_f32 v238, v12, v164
    v_fmac_f32 v242, v5, v149
    v_fmac_f32 v238, v13, v165
    v_fmac_f32 v242, v6, v150
    v_fmac_f32 v238, v14, v166
    v_fmac_f32 v242, v7, v151
    v_fmac_f32 v238, v15, v167
    v_fmac_f32 v236, v16, v112
    v_mul_f32 v244, v24, v160
    v_fmac_f32 v236, v17, v113
    v_fmac_f32 v244, v25, v161
    v_fmac_f32 v236, v18, v114
    v_fmac_f32 v244, v26, v162
    v_fmac_f32 v236, v19, v115
    v_fmac_f32 v244, v27, v163
    v_fmac_f32 v236, v20, v116
    v_fmac_f32 v244, v28, v164
    v_fmac_f32 v236, v21, v117
    v_fmac_f32 v244, v29, v165
    v_fmac_f32 v236, v22, v118
    v_fmac_f32 v244, v30, v166
    v_fmac_f32 v236, v23, v119
    v_fmac_f32 v244, v31, v167
    v_mul_f32 v243, v32, v152
    v_fma_f32 v239, v40, v168, -v239
    v_fmac_f32 v243, v33, v153
    v_fmac_f32 v239, v41, v169
    v_fmac_f32 v243, v34, v154
    v_fmac_f32 v239, v42, v170
    v_fmac_f32 v243, v35, v155
    v_fmac_f32 v239, v43, v171
    v_fmac_f32 v243, v36, v156
    v_fmac_f32 v239, v44, v172
    v_fmac_f32 v243, v37, v157
    v_fmac_f32 v239, v45, v173
    v_fmac_f32 v243, v38, v158
    v_fmac_f32 v239, v46, v174
    v_fmac_f32 v243, v39, v159
    v_fmac_f32 v239, v47, v175
    v_fmac_f32 v237, v48, v120
    v_mul_f32 v245, v56, v168
    v_fmac_f32 v237, v49, v121
    v_fmac_f32 v245, v57, v169
    v_fmac_f32 v237, v50, v122
    v_fmac_f32 v245, v58, v170
    v_fmac_f32 v237, v51, v123
    s_setprio 1
    s_waitcnt vmcnt(4) lgkmcnt(1)
    v_mfma_f32_32x32x16_bf16 v[0:15], v[64:67], v[176:179], 0
    ds_read_b64_tr_b16 v[184:185], v246 offset:2048
    ds_read_b64_tr_b16 v[186:187], v246 offset:3072
    ds_read_b64_tr_b16 v[188:189], v247 offset:2048
    ds_read_b64_tr_b16 v[190:191], v247 offset:3072
    v_fmac_f32 v245, v59, v171
    v_fmac_f32 v237, v52, v124
    s_mov_b32 m0, s68
    v_mfma_f32_32x32x16_bf16 v[16:31], v[68:71], v[176:179], 0
    buffer_load_dwordx4 v222, s[4:7], s44 offen sc1 lds
    buffer_load_dwordx4 v223, s[72:75], s44 offen offset:1024 sc1 lds
    s_waitcnt lgkmcnt(4)
    v_mad_u32_u16 v224, v224, s39, v248 op_sel:[1,0,0,0]
    v_mad_u32_u16 v225, v225, s39, v248 op_sel:[1,0,0,0]
    v_fmac_f32 v245, v60, v172
    v_fmac_f32 v237, v53, v125
    v_mfma_f32_32x32x16_bf16 v[32:47], v[64:67], v[180:183], 0
    v_add_u32 v226, s50, v251
    ds_read2_b32 v[226:227], v226 offset0:1 offset1:3
    v_fmac_f32 v245, v61, v173
    v_fmac_f32 v237, v54, v126
    v_fmac_f32 v245, v62, v174
    v_fmac_f32 v237, v55, v127
    v_fmac_f32 v245, v63, v175
    v_mfma_f32_32x32x16_bf16 v[48:63], v[68:71], v[180:183], 0
    v_permlane32_swap_b32 v242, v234
    v_permlane32_swap_b32 v243, v235
    v_add_f32 v242, v242, v234
    v_add_f32 v243, v243, v235
    s_waitcnt vmcnt(4) lgkmcnt(1)
    v_mfma_f32_32x32x16_bf16 v[0:15], v[72:75], v[184:187], v[0:15]
    ds_read_b64_tr_b16 v[176:177], v246 offset:4096
    ds_read_b64_tr_b16 v[178:179], v246 offset:5120
    ds_read_b64_tr_b16 v[180:181], v247 offset:4096
    ds_read_b64_tr_b16 v[182:183], v247 offset:5120
    s_mov_b32 m0, s69
    v_mfma_f32_32x32x16_bf16 v[16:31], v[76:79], v[184:187], v[16:31]
    buffer_load_dwordx4 v224, s[4:7], s45 offen sc1 lds
    buffer_load_dwordx4 v225, s[72:75], s45 offen offset:1024 sc1 lds
    s_waitcnt lgkmcnt(4)
    v_mad_u32_u16 v226, v226, s39, v248 op_sel:[1,0,0,0]
    v_mad_u32_u16 v227, v227, s39, v248 op_sel:[1,0,0,0]
    v_mfma_f32_32x32x16_bf16 v[32:47], v[72:75], v[188:191], v[32:47]
    s_set_gpr_idx_on s31, gpr_idx(DST)
    s_nop 0
    v_cvt_pk_bf16_f32 v194, v242, v243
    s_set_gpr_idx_off
    v_mfma_f32_32x32x16_bf16 v[48:63], v[76:79], v[188:191], v[48:63]
    s_waitcnt vmcnt(4) lgkmcnt(0)
    v_mfma_f32_32x32x16_bf16 v[0:15], v[80:83], v[176:179], v[0:15]
    ds_read_b64_tr_b16 v[184:185], v246 offset:6144
    ds_read_b64_tr_b16 v[186:187], v246 offset:7168
    ds_read_b64_tr_b16 v[188:189], v247 offset:6144
    ds_read_b64_tr_b16 v[190:191], v247 offset:7168
    s_mov_b32 s32, s31
    s_mov_b32 s31, s35
    s_mov_b32 m0, s70
    v_mfma_f32_32x32x16_bf16 v[16:31], v[84:87], v[176:179], v[16:31]
    buffer_load_dwordx4 v226, s[4:7], s46 offen sc1 lds
    buffer_load_dwordx4 v227, s[72:75], s46 offen offset:1024 sc1 lds
    s_sub_u32 s26, s48, s29
    s_mov_b32 s29, s48
    s_mov_b32 s30, s3
    s_bfe_u32 s56, s3, 0x40012
    v_mfma_f32_32x32x16_bf16 v[32:47], v[80:83], v[180:183], v[32:47]
    s_cmp_eq_u32 s34, 0
    s_cselect_b32 s56, s56, 0
    v_mfma_f32_32x32x16_bf16 v[48:63], v[84:87], v[180:183], v[48:63]
    s_waitcnt vmcnt(4) lgkmcnt(0)
    v_mfma_f32_32x32x16_bf16 v[0:15], v[88:91], v[184:187], v[0:15]
    ds_read_b64_tr_b16 v[176:177], v246 offset:0
    ds_read_b64_tr_b16 v[178:179], v246 offset:1024
    ds_read_b64_tr_b16 v[180:181], v247 offset:0
    ds_read_b64_tr_b16 v[182:183], v247 offset:1024
    s_mov_b32 m0, s71
    v_mfma_f32_32x32x16_bf16 v[16:31], v[92:95], v[184:187], v[16:31]
    s_cmp_eq_u32 s33, 4
    s_cbranch_scc1 K2_g4_115
    buffer_load_dwordx4 v224, s[4:7], s47 offen sc1 lds
    buffer_load_dwordx4 v225, s[72:75], s47 offen offset:1024 sc1 lds
K2_back_116:
    v_mfma_f32_32x32x16_bf16 v[32:47], v[88:91], v[188:191], v[32:47]
    s_nop 0
    v_mul_f32 v242, v0, v144
    v_fma_f32 v240, v8, v160, -v240
    v_fmac_f32 v242, v1, v145
    v_fmac_f32 v240, v9, v161
    v_fmac_f32 v242, v2, v146
    v_fmac_f32 v240, v10, v162
    v_fmac_f32 v242, v3, v147
    v_mfma_f32_32x32x16_bf16 v[48:63], v[92:95], v[188:191], v[48:63]
    s_setprio 0
    v_fmac_f32 v240, v11, v163
    v_fmac_f32 v242, v4, v148
    v_fmac_f32 v240, v12, v164
    v_fmac_f32 v242, v5, v149
    v_fmac_f32 v240, v13, v165
    v_fmac_f32 v242, v6, v150
    v_fmac_f32 v240, v14, v166
    v_fmac_f32 v242, v7, v151
    v_fmac_f32 v240, v15, v167
    v_add_u32 v249, s26, v249
    v_add_u32 v250, s26, v250
    v_fma_f32 v244, v16, v160, -v244
    v_fmac_f32 v236, v24, v112
    v_fmac_f32 v244, v17, v161
    v_fmac_f32 v236, v25, v113
    v_fmac_f32 v244, v18, v162
    v_fmac_f32 v236, v26, v114
    v_fmac_f32 v244, v19, v163
    v_fmac_f32 v236, v27, v115
    v_fmac_f32 v244, v20, v164
    v_fmac_f32 v236, v28, v116
    v_fmac_f32 v244, v21, v165
    v_fmac_f32 v236, v29, v117
    v_fmac_f32 v244, v22, v166
    v_fmac_f32 v236, v30, v118
    v_fmac_f32 v244, v23, v167
    v_fmac_f32 v236, v31, v119
    ds_read_b64_tr_b16 v[0:1], v249 offset:0
    ds_read_b64_tr_b16 v[2:3], v249 offset:32
    ds_read_u16_d16_hi v16, v250 offset:0
    v_mul_f32 v243, v32, v152
    v_fma_f32 v241, v40, v168, -v241
    v_fmac_f32 v243, v33, v153
    v_fmac_f32 v241, v41, v169
    v_fmac_f32 v243, v34, v154
    v_fmac_f32 v241, v42, v170
    v_fmac_f32 v243, v35, v155
    v_fmac_f32 v241, v43, v171
    v_fmac_f32 v243, v36, v156
    v_fmac_f32 v241, v44, v172
    v_fmac_f32 v243, v37, v157
    v_fmac_f32 v241, v45, v173
    v_fmac_f32 v243, v38, v158
    v_fmac_f32 v241, v46, v174
    v_fmac_f32 v243, v39, v159
    v_fmac_f32 v241, v47, v175
    ds_read_b64_tr_b16 v[4:5], v249 offset:512
    ds_read_b64_tr_b16 v[6:7], v249 offset:544
    ds_read_u16_d16_hi v17, v250 offset:128
    v_fma_f32 v245, v48, v168, -v245
    v_fmac_f32 v237, v56, v120
    v_fmac_f32 v245, v49, v169
    v_fmac_f32 v237, v57, v121
    v_fmac_f32 v245, v50, v170
    v_fmac_f32 v237, v58, v122
    v_fmac_f32 v245, v51, v171
    v_fmac_f32 v237, v59, v123
    v_fmac_f32 v245, v52, v172
    v_fmac_f32 v237, v60, v124
    v_fmac_f32 v245, v53, v173
    v_fmac_f32 v237, v61, v125
    v_fmac_f32 v245, v54, v174
    v_fmac_f32 v237, v62, v126
    v_fmac_f32 v245, v55, v175
    v_fmac_f32 v237, v63, v127
    s_cmp_eq_u32 s56, 5
    s_cbranch_scc1 K2_U20
    s_cmp_eq_u32 s56, 6
    s_cbranch_scc1 K2_U3h0
    s_branch K2_DSP0
K2_U11:
    s_setprio 1
    s_mov_b64 exec, 0x1ff
    ds_add_rtn_u32 v232, v254, v255
    s_mov_b64 exec, -1
    s_waitcnt lgkmcnt(4)
    v_lshlrev_b32 v20, 16, v0
    v_and_b32 v21, 0xffff0000, v0
    v_lshlrev_b32 v22, 16, v1
    v_and_b32 v23, 0xffff0000, v1
    v_lshlrev_b32 v24, 16, v2
    v_and_b32 v25, 0xffff0000, v2
    v_lshlrev_b32 v26, 16, v3
    v_and_b32 v27, 0xffff0000, v3
    v_mul_f32_dpp v36, v16, v20 row_newbcast:8 row_mask:0xf bank_mask:0xf
    v_mul_f32_dpp v37, v16, v21 row_newbcast:9 row_mask:0xf bank_mask:0xf
    v_mul_f32_dpp v38, v16, v22 row_newbcast:10 row_mask:0xf bank_mask:0xf
    v_mul_f32_dpp v39, v16, v23 row_newbcast:11 row_mask:0xf bank_mask:0xf
    v_mul_f32_dpp v40, v16, v24 row_newbcast:12 row_mask:0xf bank_mask:0xf
    v_mul_f32_dpp v41, v16, v25 row_newbcast:13 row_mask:0xf bank_mask:0xf
    v_mul_f32_dpp v42, v16, v26 row_newbcast:14 row_mask:0xf bank_mask:0xf
    v_mul_f32_dpp v43, v16, v27 row_newbcast:15 row_mask:0xf bank_mask:0xf
    v_cvt_pk_bf16_f32 v68, v36, v37
    v_cvt_pk_bf16_f32 v69, v38, v39
    v_cvt_pk_bf16_f32 v70, v40, v41
    v_cvt_pk_bf16_f32 v71, v42, v43
    v_mul_f32_dpp v20, v16, v20 row_newbcast:0 row_mask:0xa bank_mask:0xf
    v_mul_f32_dpp v21, v16, v21 row_newbcast:1 row_mask:0xa bank_mask:0xf
    v_mul_f32_dpp v22, v16, v22 row_newbcast:2 row_mask:0xa bank_mask:0xf
    v_mul_f32_dpp v23, v16, v23 row_newbcast:3 row_mask:0xa bank_mask:0xf
    v_mul_f32_dpp v24, v16, v24 row_newbcast:4 row_mask:0xa bank_mask:0xf
    v_mul_f32_dpp v25, v16, v25 row_newbcast:5 row_mask:0xa bank_mask:0xf
    v_mul_f32_dpp v26, v16, v26 row_newbcast:6 row_mask:0xa bank_mask:0xf
    v_mul_f32_dpp v27, v16, v27 row_newbcast:7 row_mask:0xa bank_mask:0xf
    v_cvt_pk_bf16_f32 v64, v20, v21
    v_cvt_pk_bf16_f32 v65, v22, v23
    v_cvt_pk_bf16_f32 v66, v24, v25
    v_cvt_pk_bf16_f32 v67, v26, v27
    s_waitcnt lgkmcnt(0)
    v_readlane_b32 s58, v232, 8
    s_nop 0
    s_cmp_lt_u32 s58, s22
    s_cbranch_scc0 K2_nul_121
    s_nop 0
    v_readlane_b32 s3, v253, s58
    s_nop 0
    s_bfe_u32 s58, s3, 0x60016
    s_and_b32 s59, s58, 7
    s_lshr_b32 s60, s58, 3
K2_chk_123:
    v_readlane_b32 s61, v232, s59
    s_nop 0
    s_cmp_gt_u32 s61, s60
    s_cbranch_scc0 K2_spin_122
K2_back_124:
    s_lshl_b32 s44, s34, 7
    s_and_b32 s48, s3, 0x3ffff
    s_bfe_u32 s33, s3, 0x30013
    s_mov_b32 s35, s48
    s_mov_b32 s45, s44
    s_xor_b32 s47, s44, 256
    s_add_u32 s49, s48, 128
    s_add_u32 s60, s48, 256
    s_cmp_eq_u32 s33, 3
    s_cselect_b32 s46, s44, s47
    s_cselect_b32 s50, s60, s48
    s_sub_u32 s60, s33, 2
    s_cmp_lt_u32 s60, 2
    s_cbranch_scc0 K2_rare_125
K2_back_126:
    v_add_u32 v222, s48, v251
    ds_read2_b32 v[222:223], v222 offset0:1 offset1:3
    v_add_u32 v224, s49, v251
    ds_read2_b32 v[224:225], v224 offset0:1 offset1:3
    v_add_u32 v226, s50, v251
    ds_read2_b32 v[226:227], v226 offset0:1 offset1:3
    s_waitcnt lgkmcnt(2)
    v_mad_u32_u16 v222, v222, s39, v248 op_sel:[1,0,0,0]
    v_mad_u32_u16 v223, v223, s39, v248 op_sel:[1,0,0,0]
    s_waitcnt lgkmcnt(1)
    v_mad_u32_u16 v224, v224, s39, v248 op_sel:[1,0,0,0]
    v_mad_u32_u16 v225, v225, s39, v248 op_sel:[1,0,0,0]
    s_waitcnt lgkmcnt(0)
    v_mad_u32_u16 v226, v226, s39, v248 op_sel:[1,0,0,0]
    v_mad_u32_u16 v227, v227, s39, v248 op_sel:[1,0,0,0]
    s_waitcnt vmcnt(4)
    v_mfma_f32_32x32x16_bf16 v[0:15], v[64:67], v[176:179], 0
    ds_read_b64_tr_b16 v[184:185], v246 offset:2048
    ds_read_b64_tr_b16 v[186:187], v246 offset:3072
    ds_read_b64_tr_b16 v[188:189], v247 offset:2048
    ds_read_b64_tr_b16 v[190:191], v247 offset:3072
    s_mov_b32 m0, s68
    v_mfma_f32_32x32x16_bf16 v[16:31], v[68:71], v[176:179], 0
    buffer_load_dwordx4 v222, s[4:7], s44 offen sc1 lds
    buffer_load_dwordx4 v223, s[72:75], s44 offen offset:1024 sc1 lds
    v_permlane32_swap_b32 v242, v236
    v_permlane32_swap_b32 v243, v237
    v_mfma_f32_32x32x16_bf16 v[32:47], v[64:67], v[180:183], 0
    v_permlane32_swap_b32 v244, v238
    v_permlane32_swap_b32 v245, v239
    v_permlane32_swap_b32 v240, v241
    v_add_f32 v242, v242, v236
    v_mfma_f32_32x32x16_bf16 v[48:63], v[68:71], v[180:183], 0
    s_setprio 0
    v_add_f32 v243, v243, v237
    v_add_f32 v244, v244, v238
    v_add_f32 v245, v245, v239
    v_add_f32 v240, -v240, -v241
    v_sub_u32 v241, v230, v231
    v_cvt_pk_bf16_f32 v242, v242, v243
    v_cvt_pk_bf16_f32 v244, v244, v245
    v_cvt_pk_bf16_f32 v240, v240, v240
    ds_write2st64_b32 v230, v242, v244 offset0:3 offset1:4
    ds_write_b16 v241, v240 offset:1280
    v_mul_f32 v234, v0, v96
    v_mul_f32 v236, v8, v128
    v_fmac_f32 v234, v1, v97
    v_fmac_f32 v236, v9, v129
    v_fmac_f32 v234, v2, v98
    v_fmac_f32 v236, v10, v130
    v_fmac_f32 v234, v3, v99
    v_fmac_f32 v236, v11, v131
    v_fmac_f32 v234, v4, v100
    v_fmac_f32 v236, v12, v132
    v_fmac_f32 v234, v5, v101
    v_fmac_f32 v236, v13, v133
    v_fmac_f32 v234, v6, v102
    v_fmac_f32 v236, v14, v134
    v_fmac_f32 v234, v7, v103
    v_fmac_f32 v236, v15, v135
    v_mul_f32 v238, v16, v128
    v_mul_f32 v240, v24, v128
    v_fmac_f32 v238, v17, v129
    v_fmac_f32 v240, v25, v129
    v_fmac_f32 v238, v18, v130
    v_fmac_f32 v240, v26, v130
    v_fmac_f32 v238, v19, v131
    v_fmac_f32 v240, v27, v131
    v_fmac_f32 v238, v20, v132
    v_fmac_f32 v240, v28, v132
    v_fmac_f32 v238, v21, v133
    v_fmac_f32 v240, v29, v133
    v_fmac_f32 v238, v22, v134
    v_fmac_f32 v240, v30, v134
    v_fmac_f32 v238, v23, v135
    v_fmac_f32 v240, v31, v135
    v_mul_f32 v235, v32, v104
    v_mul_f32 v237, v40, v136
    v_fmac_f32 v235, v33, v105
    v_fmac_f32 v237, v41, v137
    v_fmac_f32 v235, v34, v106
    v_fmac_f32 v237, v42, v138
    v_fmac_f32 v235, v35, v107
    v_fmac_f32 v237, v43, v139
    v_fmac_f32 v235, v36, v108
    v_fmac_f32 v237, v44, v140
    v_fmac_f32 v235, v37, v109
    v_fmac_f32 v237, v45, v141
    v_fmac_f32 v235, v38, v110
    v_fmac_f32 v237, v46, v142
    v_fmac_f32 v235, v39, v111
    v_fmac_f32 v237, v47, v143
    v_mul_f32 v239, v48, v136
    v_mul_f32 v241, v56, v136
    v_fmac_f32 v239, v49, v137
    v_fmac_f32 v241, v57, v137
    v_fmac_f32 v239, v50, v138
    v_fmac_f32 v241, v58, v138
    v_fmac_f32 v239, v51, v139
    v_fmac_f32 v241, v59, v139
    v_fmac_f32 v239, v52, v140
    v_fmac_f32 v241, v60, v140
    v_fmac_f32 v239, v53, v141
    v_fmac_f32 v241, v61, v141
    v_fmac_f32 v239, v54, v142
    v_fmac_f32 v241, v62, v142
    v_fmac_f32 v239, v55, v143
    v_fmac_f32 v241, v63, v143
    s_setprio 1
    s_waitcnt vmcnt(4) lgkmcnt(2)
    v_mfma_f32_32x32x16_bf16 v[0:15], v[64:67], v[184:187], 0
    ds_read_b64_tr_b16 v[176:177], v246 offset:4096
    ds_read_b64_tr_b16 v[178:179], v246 offset:5120
    ds_read_b64_tr_b16 v[180:181], v247 offset:4096
    ds_read_b64_tr_b16 v[182:183], v247 offset:5120
    s_mov_b32 m0, s69
    v_mfma_f32_32x32x16_bf16 v[16:31], v[68:71], v[184:187], 0
    buffer_load_dwordx4 v224, s[4:7], s45 offen sc1 lds
    buffer_load_dwordx4 v225, s[72:75], s45 offen offset:1024 sc1 lds
    v_permlane32_swap_b32 v234, v236
    v_permlane32_swap_b32 v235, v237
    v_mfma_f32_32x32x16_bf16 v[32:47], v[64:67], v[188:191], 0
    v_permlane32_swap_b32 v240, v238
    v_permlane32_swap_b32 v241, v239
    v_lshl_add_u32 v230, v252, 1, s31
    v_add_f32 v234, v234, v236
    v_add_f32 v235, v235, v237
    v_mfma_f32_32x32x16_bf16 v[48:63], v[68:71], v[188:191], 0
    s_setprio 0
    v_add_f32 v240, v240, v238
    v_add_f32 v241, v241, v239
    v_cvt_pk_bf16_f32 v234, v234, v235
    v_cvt_pk_bf16_f32 v240, v240, v241
    ds_write2st64_b32 v230, v234, v240 offset0:0 offset1:1
    v_mul_f32 v234, v0, v144
    v_mul_f32 v236, v8, v112
    v_fmac_f32 v234, v1, v145
    v_fmac_f32 v236, v9, v113
    v_fmac_f32 v234, v2, v146
    v_fmac_f32 v236, v10, v114
    v_fmac_f32 v234, v3, v147
    v_fmac_f32 v236, v11, v115
    v_fmac_f32 v234, v4, v148
    v_fmac_f32 v236, v12, v116
    v_fmac_f32 v234, v5, v149
    v_fmac_f32 v236, v13, v117
    v_fmac_f32 v234, v6, v150
    v_fmac_f32 v236, v14, v118
    v_fmac_f32 v234, v7, v151
    v_fmac_f32 v236, v15, v119
    v_mul_f32 v238, v16, v160
    v_mul_f32 v240, v24, v160
    v_fmac_f32 v238, v17, v161
    v_fmac_f32 v240, v25, v161
    v_fmac_f32 v238, v18, v162
    v_fmac_f32 v240, v26, v162
    v_fmac_f32 v238, v19, v163
    v_fmac_f32 v240, v27, v163
    v_fmac_f32 v238, v20, v164
    v_fmac_f32 v240, v28, v164
    v_fmac_f32 v238, v21, v165
    v_fmac_f32 v240, v29, v165
    v_fmac_f32 v238, v22, v166
    v_fmac_f32 v240, v30, v166
    v_fmac_f32 v238, v23, v167
    v_fmac_f32 v240, v31, v167
    v_mul_f32 v235, v32, v152
    v_mul_f32 v237, v40, v120
    v_fmac_f32 v235, v33, v153
    v_fmac_f32 v237, v41, v121
    v_fmac_f32 v235, v34, v154
    v_fmac_f32 v237, v42, v122
    v_fmac_f32 v235, v35, v155
    v_fmac_f32 v237, v43, v123
    v_fmac_f32 v235, v36, v156
    v_fmac_f32 v237, v44, v124
    v_fmac_f32 v235, v37, v157
    v_fmac_f32 v237, v45, v125
    v_fmac_f32 v235, v38, v158
    v_fmac_f32 v237, v46, v126
    v_fmac_f32 v235, v39, v159
    v_fmac_f32 v237, v47, v127
    v_mul_f32 v239, v48, v168
    v_mul_f32 v241, v56, v168
    v_fmac_f32 v239, v49, v169
    v_fmac_f32 v241, v57, v169
    v_fmac_f32 v239, v50, v170
    v_fmac_f32 v241, v58, v170
    v_fmac_f32 v239, v51, v171
    v_fmac_f32 v241, v59, v171
    v_fmac_f32 v239, v52, v172
    v_fmac_f32 v241, v60, v172
    v_fmac_f32 v239, v53, v173
    v_fmac_f32 v241, v61, v173
    v_fmac_f32 v239, v54, v174
    v_fmac_f32 v241, v62, v174
    v_fmac_f32 v239, v55, v175
    v_fmac_f32 v241, v63, v175
    s_setprio 1
    s_waitcnt vmcnt(4) lgkmcnt(1)
    v_mfma_f32_32x32x16_bf16 v[0:15], v[64:67], v[176:179], 0
    ds_read_b64_tr_b16 v[184:185], v246 offset:6144
    ds_read_b64_tr_b16 v[186:187], v246 offset:7168
    ds_read_b64_tr_b16 v[188:189], v247 offset:6144
    ds_read_b64_tr_b16 v[190:191], v247 offset:7168
    s_mov_b32 s32, s31
    s_mov_b32 s31, s35
    s_mov_b32 m0, s70
    v_mfma_f32_32x32x16_bf16 v[16:31], v[68:71], v[176:179], 0
    buffer_load_dwordx4 v226, s[4:7], s46 offen sc1 lds
    buffer_load_dwordx4 v227, s[72:75], s46 offen offset:1024 sc1 lds
    s_sub_u32 s26, s48, s29
    s_mov_b32 s29, s48
    s_mov_b32 s30, s3
    s_bfe_u32 s56, s3, 0x40012
    v_mfma_f32_32x32x16_bf16 v[32:47], v[64:67], v[180:183], 0
    s_cmp_lg_u32 s36, 0
    s_cselect_b32 s56, s56, 0
    v_mfma_f32_32x32x16_bf16 v[48:63], v[68:71], v[180:183], 0
    s_setprio 0
    v_mul_f32 v242, v0, v144
    v_fma_f32 v238, v8, v160, -v238
    v_fmac_f32 v242, v1, v145
    v_fmac_f32 v238, v9, v161
    v_fmac_f32 v242, v2, v146
    v_fmac_f32 v238, v10, v162
    v_fmac_f32 v242, v3, v147
    v_fmac_f32 v238, v11, v163
    v_fmac_f32 v242, v4, v148
    v_fmac_f32 v238, v12, v164
    v_fmac_f32 v242, v5, v149
    v_fmac_f32 v238, v13, v165
    v_fmac_f32 v242, v6, v150
    v_fmac_f32 v238, v14, v166
    v_fmac_f32 v242, v7, v151
    v_fmac_f32 v238, v15, v167
    v_fmac_f32 v236, v16, v112
    v_mul_f32 v244, v24, v160
    v_fmac_f32 v236, v17, v113
    v_fmac_f32 v244, v25, v161
    v_fmac_f32 v236, v18, v114
    v_fmac_f32 v244, v26, v162
    v_fmac_f32 v236, v19, v115
    v_fmac_f32 v244, v27, v163
    v_fmac_f32 v236, v20, v116
    v_fmac_f32 v244, v28, v164
    v_fmac_f32 v236, v21, v117
    v_fmac_f32 v244, v29, v165
    v_fmac_f32 v236, v22, v118
    v_fmac_f32 v244, v30, v166
    v_fmac_f32 v236, v23, v119
    v_fmac_f32 v244, v31, v167
    v_mul_f32 v243, v32, v152
    v_fma_f32 v239, v40, v168, -v239
    v_fmac_f32 v243, v33, v153
    v_fmac_f32 v239, v41, v169
    v_fmac_f32 v243, v34, v154
    v_fmac_f32 v239, v42, v170
    v_fmac_f32 v243, v35, v155
    v_fmac_f32 v239, v43, v171
    v_fmac_f32 v243, v36, v156
    v_fmac_f32 v239, v44, v172
    v_fmac_f32 v243, v37, v157
    v_fmac_f32 v239, v45, v173
    v_fmac_f32 v243, v38, v158
    v_fmac_f32 v239, v46, v174
    v_fmac_f32 v243, v39, v159
    v_fmac_f32 v239, v47, v175
    v_fmac_f32 v237, v48, v120
    v_mul_f32 v245, v56, v168
    v_fmac_f32 v237, v49, v121
    v_fmac_f32 v245, v57, v169
    v_fmac_f32 v237, v50, v122
    v_fmac_f32 v245, v58, v170
    v_fmac_f32 v237, v51, v123
    v_fmac_f32 v245, v59, v171
    v_fmac_f32 v237, v52, v124
    v_fmac_f32 v245, v60, v172
    v_fmac_f32 v237, v53, v125
    v_fmac_f32 v245, v61, v173
    v_fmac_f32 v237, v54, v126
    v_fmac_f32 v245, v62, v174
    v_fmac_f32 v237, v55, v127
    v_fmac_f32 v245, v63, v175
    s_setprio 1
    s_waitcnt vmcnt(4) lgkmcnt(0)
    v_mfma_f32_32x32x16_bf16 v[0:15], v[64:67], v[184:187], 0
    ds_read_b64_tr_b16 v[176:177], v246 offset:0
    ds_read_b64_tr_b16 v[178:179], v246 offset:1024
    ds_read_b64_tr_b16 v[180:181], v247 offset:0
    ds_read_b64_tr_b16 v[182:183], v247 offset:1024
    s_mov_b32 m0, s71
    v_mfma_f32_32x32x16_bf16 v[16:31], v[68:71], v[184:187], 0
    s_cmp_eq_u32 s33, 4
    s_cbranch_scc1 K2_g4_128
    buffer_load_dwordx4 v224, s[4:7], s47 offen sc1 lds
    buffer_load_dwordx4 v225, s[72:75], s47 offen offset:1024 sc1 lds
K2_back_129:
    v_permlane32_swap_b32 v242, v234
    v_mfma_f32_32x32x16_bf16 v[32:47], v[64:67], v[188:191], 0
    v_permlane32_swap_b32 v243, v235
    v_add_f32 v242, v242, v234
    v_add_f32 v243, v243, v235
    v_cvt_pk_bf16_f32 v242, v242, v243
    ds_write_b32 v230, v242 offset:512
    v_mfma_f32_32x32x16_bf16 v[48:63], v[68:71], v[188:191], 0
    s_setprio 0
    v_mul_f32 v242, v0, v144
    v_fma_f32 v240, v8, v160, -v240
    v_fmac_f32 v242, v1, v145
    v_fmac_f32 v240, v9, v161
    v_fmac_f32 v242, v2, v146
    v_fmac_f32 v240, v10, v162
    v_fmac_f32 v242, v3, v147
    v_fmac_f32 v240, v11, v163
    v_fmac_f32 v242, v4, v148
    v_fmac_f32 v240, v12, v164
    v_fmac_f32 v242, v5, v149
    v_fmac_f32 v240, v13, v165
    v_fmac_f32 v242, v6, v150
    v_fmac_f32 v240, v14, v166
    v_fmac_f32 v242, v7, v151
    v_fmac_f32 v240, v15, v167
    v_add_u32 v249, s26, v249
    v_add_u32 v250, s26, v250
    v_fma_f32 v244, v16, v160, -v244
    v_fmac_f32 v236, v24, v112
    v_fmac_f32 v244, v17, v161
    v_fmac_f32 v236, v25, v113
    v_fmac_f32 v244, v18, v162
    v_fmac_f32 v236, v26, v114
    v_fmac_f32 v244, v19, v163
    v_fmac_f32 v236, v27, v115
    v_fmac_f32 v244, v20, v164
    v_fmac_f32 v236, v28, v116
    v_fmac_f32 v244, v21, v165
    v_fmac_f32 v236, v29, v117
    v_fmac_f32 v244, v22, v166
    v_fmac_f32 v236, v30, v118
    v_fmac_f32 v244, v23, v167
    v_fmac_f32 v236, v31, v119
    ds_read_b64_tr_b16 v[0:1], v249 offset:0
    ds_read_b64_tr_b16 v[2:3], v249 offset:32
    ds_read_u16_d16_hi v16, v250 offset:0
    v_mul_f32 v243, v32, v152
    v_fma_f32 v241, v40, v168, -v241
    v_fmac_f32 v243, v33, v153
    v_fmac_f32 v241, v41, v169
    v_fmac_f32 v243, v34, v154
    v_fmac_f32 v241, v42, v170
    v_fmac_f32 v243, v35, v155
    v_fmac_f32 v241, v43, v171
    v_fmac_f32 v243, v36, v156
    v_fmac_f32 v241, v44, v172
    v_fmac_f32 v243, v37, v157
    v_fmac_f32 v241, v45, v173
    v_fmac_f32 v243, v38, v158
    v_fmac_f32 v241, v46, v174
    v_fmac_f32 v243, v39, v159
    v_fmac_f32 v241, v47, v175
    ds_read_b64_tr_b16 v[4:5], v249 offset:512
    ds_read_b64_tr_b16 v[6:7], v249 offset:544
    ds_read_u16_d16_hi v17, v250 offset:128
    v_fma_f32 v245, v48, v168, -v245
    v_fmac_f32 v237, v56, v120
    v_fmac_f32 v245, v49, v169
    v_fmac_f32 v237, v57, v121
    v_fmac_f32 v245, v50, v170
    v_fmac_f32 v237, v58, v122
    v_fmac_f32 v245, v51, v171
    v_fmac_f32 v237, v59, v123
    v_fmac_f32 v245, v52, v172
    v_fmac_f32 v237, v60, v124
    v_fmac_f32 v245, v53, v173
    v_fmac_f32 v237, v61, v125
    v_fmac_f32 v245, v54, v174
    v_fmac_f32 v237, v62, v126
    v_fmac_f32 v245, v55, v175
    v_fmac_f32 v237, v63, v127
    s_cmp_eq_u32 s56, 5
    s_cbranch_scc1 K2_U21
    s_cmp_eq_u32 s56, 6
    s_cbranch_scc1 K2_U3h1
    s_branch K2_DSP1
K2_U41:
    s_setprio 1
    ds_read_b64_tr_b16 v[8:9], v249 offset:1024
    ds_read_b64_tr_b16 v[10:11], v249 offset:1056
    ds_read_u16_d16_hi v18, v250 offset:256
    s_lshr_b32 s65, s30, 28
    s_mul_i32 s66, s22, 2080
    s_lshl_b32 s65, s65, 9
    s_add_u32 s65, s65, s66
    s_add_u32 s65, s65, 65536
    s_sub_u32 s65, s65, s29
    s_sub_u32 s65, s65, 512
    v_add_u32 v56, s65, v249
    ds_read_b64_tr_b16 v[12:13], v56 offset:0
    ds_read_b64_tr_b16 v[14:15], v56 offset:32
    ds_read_u16_d16_hi v19, v250 offset:384
    s_waitcnt lgkmcnt(6)
    v_lshlrev_b32 v20, 16, v0
    v_and_b32 v21, 0xffff0000, v0
    v_lshlrev_b32 v22, 16, v1
    v_and_b32 v23, 0xffff0000, v1
    v_lshlrev_b32 v24, 16, v2
    v_and_b32 v25, 0xffff0000, v2
    v_lshlrev_b32 v26, 16, v3
    v_and_b32 v27, 0xffff0000, v3
    v_mul_f32_dpp v36, v16, v20 row_newbcast:8 row_mask:0xf bank_mask:0xf
    v_mul_f32_dpp v37, v16, v21 row_newbcast:9 row_mask:0xf bank_mask:0xf
    v_mul_f32_dpp v38, v16, v22 row_newbcast:10 row_mask:0xf bank_mask:0xf
    v_mul_f32_dpp v39, v16, v23 row_newbcast:11 row_mask:0xf bank_mask:0xf
    v_mul_f32_dpp v40, v16, v24 row_newbcast:12 row_mask:0xf bank_mask:0xf
    v_mul_f32_dpp v41, v16, v25 row_newbcast:13 row_mask:0xf bank_mask:0xf
    v_mul_f32_dpp v42, v16, v26 row_newbcast:14 row_mask:0xf bank_mask:0xf
    v_mul_f32_dpp v43, v16, v27 row_newbcast:15 row_mask:0xf bank_mask:0xf
    v_cvt_pk_bf16_f32 v68, v36, v37
    v_cvt_pk_bf16_f32 v69, v38, v39
    v_cvt_pk_bf16_f32 v70, v40, v41
    v_cvt_pk_bf16_f32 v71, v42, v43
    v_mul_f32_dpp v20, v16, v20 row_newbcast:0 row_mask:0xa bank_mask:0xf
    v_mul_f32_dpp v21, v16, v21 row_newbcast:1 row_mask:0xa bank_mask:0xf
    v_mul_f32_dpp v22, v16, v22 row_newbcast:2 row_mask:0xa bank_mask:0xf
    v_mul_f32_dpp v23, v16, v23 row_newbcast:3 row_mask:0xa bank_mask:0xf
    v_mul_f32_dpp v24, v16, v24 row_newbcast:4 row_mask:0xa bank_mask:0xf
    v_mul_f32_dpp v25, v16, v25 row_newbcast:5 row_mask:0xa bank_mask:0xf
    v_mul_f32_dpp v26, v16, v26 row_newbcast:6 row_mask:0xa bank_mask:0xf
    v_mul_f32_dpp v27, v16, v27 row_newbcast:7 row_mask:0xa bank_mask:0xf
    v_cvt_pk_bf16_f32 v64, v20, v21
    v_cvt_pk_bf16_f32 v65, v22, v23
    v_cvt_pk_bf16_f32 v66, v24, v25
    v_cvt_pk_bf16_f32 v67, v26, v27
    v_lshlrev_b32 v28, 16, v4
    v_and_b32 v29, 0xffff0000, v4
    v_lshlrev_b32 v30, 16, v5
    v_and_b32 v31, 0xffff0000, v5
    v_lshlrev_b32 v32, 16, v6
    v_and_b32 v33, 0xffff0000, v6
    v_lshlrev_b32 v34, 16, v7
    v_and_b32 v35, 0xffff0000, v7
    v_mul_f32_dpp v36, v17, v28 row_newbcast:8 row_mask:0xf bank_mask:0xf
    v_mul_f32_dpp v37, v17, v29 row_newbcast:9 row_mask:0xf bank_mask:0xf
    v_mul_f32_dpp v38, v17, v30 row_newbcast:10 row_mask:0xf bank_mask:0xf
    v_mul_f32_dpp v39, v17, v31 row_newbcast:11 row_mask:0xf bank_mask:0xf
    v_mul_f32_dpp v40, v17, v32 row_newbcast:12 row_mask:0xf bank_mask:0xf
    v_mul_f32_dpp v41, v17, v33 row_newbcast:13 row_mask:0xf bank_mask:0xf
    v_mul_f32_dpp v42, v17, v34 row_newbcast:14 row_mask:0xf bank_mask:0xf
    v_mul_f32_dpp v43, v17, v35 row_newbcast:15 row_mask:0xf bank_mask:0xf
    v_cvt_pk_bf16_f32 v76, v36, v37
    v_cvt_pk_bf16_f32 v77, v38, v39
    v_cvt_pk_bf16_f32 v78, v40, v41
    v_cvt_pk_bf16_f32 v79, v42, v43
    v_mul_f32_dpp v28, v17, v28 row_newbcast:0 row_mask:0xa bank_mask:0xf
    v_mul_f32_dpp v29, v17, v29 row_newbcast:1 row_mask:0xa bank_mask:0xf
    v_mul_f32_dpp v30, v17, v30 row_newbcast:2 row_mask:0xa bank_mask:0xf
    v_mul_f32_dpp v31, v17, v31 row_newbcast:3 row_mask:0xa bank_mask:0xf
    v_mul_f32_dpp v32, v17, v32 row_newbcast:4 row_mask:0xa bank_mask:0xf
    v_mul_f32_dpp v33, v17, v33 row_newbcast:5 row_mask:0xa bank_mask:0xf
    v_mul_f32_dpp v34, v17, v34 row_newbcast:6 row_mask:0xa bank_mask:0xf
    v_mul_f32_dpp v35, v17, v35 row_newbcast:7 row_mask:0xa bank_mask:0xf
    v_cvt_pk_bf16_f32 v72, v28, v29
    v_cvt_pk_bf16_f32 v73, v30, v31
    v_cvt_pk_bf16_f32 v74, v32, v33
    v_cvt_pk_bf16_f32 v75, v34, v35
    s_waitcnt lgkmcnt(3)
    v_lshlrev_b32 v20, 16, v8
    v_and_b32 v21, 0xffff0000, v8
    v_lshlrev_b32 v22, 16, v9
    v_and_b32 v23, 0xffff0000, v9
    v_lshlrev_b32 v24, 16, v10
    v_and_b32 v25, 0xffff0000, v10
    v_lshlrev_b32 v26, 16, v11
    v_and_b32 v27, 0xffff0000, v11
    v_mul_f32_dpp v36, v18, v20 row_newbcast:8 row_mask:0xf bank_mask:0xf
    v_mul_f32_dpp v37, v18, v21 row_newbcast:9 row_mask:0xf bank_mask:0xf
    v_mul_f32_dpp v38, v18, v22 row_newbcast:10 row_mask:0xf bank_mask:0xf
    v_mul_f32_dpp v39, v18, v23 row_newbcast:11 row_mask:0xf bank_mask:0xf
    v_mul_f32_dpp v40, v18, v24 row_newbcast:12 row_mask:0xf bank_mask:0xf
    v_mul_f32_dpp v41, v18, v25 row_newbcast:13 row_mask:0xf bank_mask:0xf
    v_mul_f32_dpp v42, v18, v26 row_newbcast:14 row_mask:0xf bank_mask:0xf
    v_mul_f32_dpp v43, v18, v27 row_newbcast:15 row_mask:0xf bank_mask:0xf
    v_cvt_pk_bf16_f32 v84, v36, v37
    v_cvt_pk_bf16_f32 v85, v38, v39
    v_cvt_pk_bf16_f32 v86, v40, v41
    v_cvt_pk_bf16_f32 v87, v42, v43
    v_mul_f32_dpp v20, v18, v20 row_newbcast:0 row_mask:0xa bank_mask:0xf
    v_mul_f32_dpp v21, v18, v21 row_newbcast:1 row_mask:0xa bank_mask:0xf
    v_mul_f32_dpp v22, v18, v22 row_newbcast:2 row_mask:0xa bank_mask:0xf
    v_mul_f32_dpp v23, v18, v23 row_newbcast:3 row_mask:0xa bank_mask:0xf
    v_mul_f32_dpp v24, v18, v24 row_newbcast:4 row_mask:0xa bank_mask:0xf
    v_mul_f32_dpp v25, v18, v25 row_newbcast:5 row_mask:0xa bank_mask:0xf
    v_mul_f32_dpp v26, v18, v26 row_newbcast:6 row_mask:0xa bank_mask:0xf
    v_mul_f32_dpp v27, v18, v27 row_newbcast:7 row_mask:0xa bank_mask:0xf
    v_cvt_pk_bf16_f32 v80, v20, v21
    v_cvt_pk_bf16_f32 v81, v22, v23
    v_cvt_pk_bf16_f32 v82, v24, v25
    v_cvt_pk_bf16_f32 v83, v26, v27
    s_waitcnt lgkmcnt(0)
    v_lshlrev_b32 v28, 16, v12
    v_and_b32 v29, 0xffff0000, v12
    v_lshlrev_b32 v30, 16, v13
    v_and_b32 v31, 0xffff0000, v13
    v_lshlrev_b32 v32, 16, v14
    v_and_b32 v33, 0xffff0000, v14
    v_lshlrev_b32 v34, 16, v15
    v_and_b32 v35, 0xffff0000, v15
    v_mul_f32_dpp v36, v19, v28 row_newbcast:8 row_mask:0xf bank_mask:0xf
    v_mul_f32_dpp v37, v19, v29 row_newbcast:9 row_mask:0xf bank_mask:0xf
    v_mul_f32_dpp v38, v19, v30 row_newbcast:10 row_mask:0xf bank_mask:0xf
    v_mul_f32_dpp v39, v19, v31 row_newbcast:11 row_mask:0xf bank_mask:0xf
    v_mul_f32_dpp v40, v19, v32 row_newbcast:12 row_mask:0xf bank_mask:0xf
    v_mul_f32_dpp v41, v19, v33 row_newbcast:13 row_mask:0xf bank_mask:0xf
    v_mul_f32_dpp v42, v19, v34 row_newbcast:14 row_mask:0xf bank_mask:0xf
    v_mul_f32_dpp v43, v19, v35 row_newbcast:15 row_mask:0xf bank_mask:0xf
    v_cvt_pk_bf16_f32 v92, v36, v37
    v_cvt_pk_bf16_f32 v93, v38, v39
    v_cvt_pk_bf16_f32 v94, v40, v41
    v_cvt_pk_bf16_f32 v95, v42, v43
    v_mul_f32_dpp v28, v19, v28 row_newbcast:0 row_mask:0xa bank_mask:0xf
    v_mul_f32_dpp v29, v19, v29 row_newbcast:1 row_mask:0xa bank_mask:0xf
    v_mul_f32_dpp v30, v19, v30 row_newbcast:2 row_mask:0xa bank_mask:0xf
    v_mul_f32_dpp v31, v19, v31 row_newbcast:3 row_mask:0xa bank_mask:0xf
    v_mul_f32_dpp v32, v19, v32 row_newbcast:4 row_mask:0xa bank_mask:0xf
    v_mul_f32_dpp v33, v19, v33 row_newbcast:5 row_mask:0xa bank_mask:0xf
    v_mul_f32_dpp v34, v19, v34 row_newbcast:6 row_mask:0xa bank_mask:0xf
    v_mul_f32_dpp v35, v19, v35 row_newbcast:7 row_mask:0xa bank_mask:0xf
    v_cvt_pk_bf16_f32 v88, v28, v29
    v_cvt_pk_bf16_f32 v89, v30, v31
    v_cvt_pk_bf16_f32 v90, v32, v33
    v_cvt_pk_bf16_f32 v91, v34, v35
    s_waitcnt vmcnt(4)
    v_mfma_f32_32x32x16_bf16 v[0:15], v[64:67], v[176:179], 0
    ds_read_b64_tr_b16 v[184:185], v246 offset:2048
    ds_read_b64_tr_b16 v[186:187], v246 offset:3072
    ds_read_b64_tr_b16 v[188:189], v247 offset:2048
    ds_read_b64_tr_b16 v[190:191], v247 offset:3072
    s_mov_b32 m0, s68
    v_mfma_f32_32x32x16_bf16 v[16:31], v[68:71], v[176:179], 0
    buffer_load_dwordx4 v222, s[4:7], s41 offen sc1 lds
    buffer_load_dwordx4 v223, s[72:75], s41 offen offset:1024 sc1 lds
    v_permlane32_swap_b32 v242, v236
    v_permlane32_swap_b32 v243, v237
    v_mfma_f32_32x32x16_bf16 v[32:47], v[64:67], v[180:183], 0
    v_permlane32_swap_b32 v244, v238
    v_permlane32_swap_b32 v245, v239
    v_permlane32_swap_b32 v240, v241
    v_add_f32 v242, v242, v236
    v_mfma_f32_32x32x16_bf16 v[48:63], v[68:71], v[180:183], 0
    v_add_f32 v243, v243, v237
    v_add_f32 v244, v244, v238
    v_add_f32 v245, v245, v239
    v_add_f32 v240, -v240, -v241
    v_sub_u32 v241, v230, v231
    v_cvt_pk_bf16_f32 v242, v242, v243
    s_mov_b64 exec, 0x1ff
    ds_add_rtn_u32 v232, v254, v255
    s_mov_b64 exec, -1
    s_waitcnt vmcnt(4) lgkmcnt(1)
    v_mfma_f32_32x32x16_bf16 v[0:15], v[72:75], v[184:187], v[0:15]
    ds_read_b64_tr_b16 v[176:177], v246 offset:4096
    ds_read_b64_tr_b16 v[178:179], v246 offset:5120
    ds_read_b64_tr_b16 v[180:181], v247 offset:4096
    ds_read_b64_tr_b16 v[182:183], v247 offset:5120
    v_cvt_pk_bf16_f32 v244, v244, v245
    v_cvt_pk_bf16_f32 v240, v240, v240
    s_mov_b32 m0, s69
    v_mfma_f32_32x32x16_bf16 v[16:31], v[76:79], v[184:187], v[16:31]
    buffer_load_dwordx4 v224, s[4:7], s41 offen sc1 lds
    buffer_load_dwordx4 v225, s[72:75], s41 offen offset:1024 sc1 lds
    ds_write2st64_b32 v230, v242, v244 offset0:3 offset1:4
    ds_write_b16 v241, v240 offset:1280
    s_waitcnt lgkmcnt(6)
    v_readlane_b32 s58, v232, 8
    v_mfma_f32_32x32x16_bf16 v[32:47], v[72:75], v[188:191], v[32:47]
    s_cmp_lt_u32 s58, s22
    s_cbranch_scc0 K2_nul_130
    s_nop 0
    v_readlane_b32 s3, v253, s58
    s_nop 0
    s_bfe_u32 s58, s3, 0x60016
    s_and_b32 s59, s58, 7
    s_lshr_b32 s60, s58, 3
K2_chk_132:
    v_readlane_b32 s61, v232, s59
    s_nop 0
    s_cmp_gt_u32 s61, s60
    s_cbranch_scc0 K2_spin_131
K2_back_133:
    v_mfma_f32_32x32x16_bf16 v[48:63], v[76:79], v[188:191], v[48:63]
    s_lshl_b32 s44, s34, 7
    s_and_b32 s48, s3, 0x3ffff
    s_bfe_u32 s33, s3, 0x30013
    s_mov_b32 s35, s48
    s_mov_b32 s45, s44
    s_xor_b32 s47, s44, 256
    s_waitcnt vmcnt(4) lgkmcnt(2)
    v_mfma_f32_32x32x16_bf16 v[0:15], v[80:83], v[176:179], v[0:15]
    ds_read_b64_tr_b16 v[184:185], v246 offset:6144
    ds_read_b64_tr_b16 v[186:187], v246 offset:7168
    ds_read_b64_tr_b16 v[188:189], v247 offset:6144
    ds_read_b64_tr_b16 v[190:191], v247 offset:7168
    s_add_u32 s49, s48, 128
    s_add_u32 s60, s48, 256
    s_mov_b32 m0, s70
    v_mfma_f32_32x32x16_bf16 v[16:31], v[84:87], v[176:179], v[16:31]
    buffer_load_dwordx4 v226, s[4:7], s41 offen sc1 lds
    buffer_load_dwordx4 v227, s[72:75], s41 offen offset:1024 sc1 lds
    s_cmp_eq_u32 s33, 3
    s_cselect_b32 s46, s44, s47
    s_cselect_b32 s50, s60, s48
    v_mfma_f32_32x32x16_bf16 v[32:47], v[80:83], v[180:183], v[32:47]
    s_sub_u32 s60, s33, 2
    s_cmp_lt_u32 s60, 2
    s_cbranch_scc0 K2_rare_134
K2_back_135:
    v_mfma_f32_32x32x16_bf16 v[48:63], v[84:87], v[180:183], v[48:63]
    s_waitcnt vmcnt(4) lgkmcnt(0)
    v_mfma_f32_32x32x16_bf16 v[0:15], v[88:91], v[184:187], v[0:15]
    ds_read_b64_tr_b16 v[176:177], v246 offset:0
    ds_read_b64_tr_b16 v[178:179], v246 offset:1024
    ds_read_b64_tr_b16 v[180:181], v247 offset:0
    ds_read_b64_tr_b16 v[182:183], v247 offset:1024
    s_mov_b32 m0, s71
    v_mfma_f32_32x32x16_bf16 v[16:31], v[92:95], v[184:187], v[16:31]
    buffer_load_dwordx4 v228, s[4:7], s41 offen sc1 lds
    buffer_load_dwordx4 v229, s[72:75], s41 offen offset:1024 sc1 lds
    v_mfma_f32_32x32x16_bf16 v[32:47], v[88:91], v[188:191], v[32:47]
    s_nop 2
    v_mul_f32 v234, v0, v96
    v_mul_f32 v236, v8, v128
    v_fmac_f32 v234, v1, v97
    v_fmac_f32 v236, v9, v129
    v_fmac_f32 v234, v2, v98
    v_fmac_f32 v236, v10, v130
    v_fmac_f32 v234, v3, v99
    v_mfma_f32_32x32x16_bf16 v[48:63], v[92:95], v[188:191], v[48:63]
    s_setprio 0
    v_fmac_f32 v236, v11, v131
    v_fmac_f32 v234, v4, v100
    v_fmac_f32 v236, v12, v132
    v_fmac_f32 v234, v5, v101
    v_fmac_f32 v236, v13, v133
    v_fmac_f32 v234, v6, v102
    v_fmac_f32 v236, v14, v134
    v_fmac_f32 v234, v7, v103
    v_fmac_f32 v236, v15, v135
    v_mul_f32 v238, v16, v128
    v_mul_f32 v240, v24, v128
    v_fmac_f32 v238, v17, v129
    v_fmac_f32 v240, v25, v129
    v_fmac_f32 v238, v18, v130
    v_fmac_f32 v240, v26, v130
    v_fmac_f32 v238, v19, v131
    v_fmac_f32 v240, v27, v131
    v_fmac_f32 v238, v20, v132
    v_fmac_f32 v240, v28, v132
    v_fmac_f32 v238, v21, v133
    v_fmac_f32 v240, v29, v133
    v_fmac_f32 v238, v22, v134
    v_fmac_f32 v240, v30, v134
    v_fmac_f32 v238, v23, v135
    v_fmac_f32 v240, v31, v135
    v_mul_f32 v235, v32, v104
    v_mul_f32 v237, v40, v136
    v_fmac_f32 v235, v33, v105
    v_fmac_f32 v237, v41, v137
    v_fmac_f32 v235, v34, v106
    v_fmac_f32 v237, v42, v138
    v_fmac_f32 v235, v35, v107
    v_fmac_f32 v237, v43, v139
    v_fmac_f32 v235, v36, v108
    v_fmac_f32 v237, v44, v140
    v_fmac_f32 v235, v37, v109
    v_fmac_f32 v237, v45, v141
    v_fmac_f32 v235, v38, v110
    v_fmac_f32 v237, v46, v142
    v_fmac_f32 v235, v39, v111
    v_fmac_f32 v237, v47, v143
    v_mul_f32 v239, v48, v136
    v_mul_f32 v241, v56, v136
    s_setprio 1
    s_waitcnt vmcnt(4) lgkmcnt(0)
    v_mfma_f32_32x32x16_bf16 v[0:15], v[64:67], v[176:179], 0
    ds_read_b64_tr_b16 v[184:185], v246 offset:2048
    ds_read_b64_tr_b16 v[186:187], v246 offset:3072
    ds_read_b64_tr_b16 v[188:189], v247 offset:2048
    ds_read_b64_tr_b16 v[190:191], v247 offset:3072
    v_fmac_f32 v239, v49, v137
    v_fmac_f32 v241, v57, v137
    s_mov_b32 m0, s68
    v_mfma_f32_32x32x16_bf16 v[16:31], v[68:71], v[176:179], 0
    buffer_load_dwordx4 v222, s[4:7], s42 offen sc1 lds
    buffer_load_dwordx4 v223, s[72:75], s42 offen offset:1024 sc1 lds
    v_fmac_f32 v239, v50, v138
    v_fmac_f32 v241, v58, v138
    v_fmac_f32 v239, v51, v139
    v_fmac_f32 v241, v59, v139
    v_fmac_f32 v239, v52, v140
    v_mfma_f32_32x32x16_bf16 v[32:47], v[64:67], v[180:183], 0
    v_fmac_f32 v241, v60, v140
    v_fmac_f32 v239, v53, v141
    v_fmac_f32 v241, v61, v141
    v_fmac_f32 v239, v54, v142
    v_fmac_f32 v241, v62, v142
    v_fmac_f32 v239, v55, v143
    v_fmac_f32 v241, v63, v143
    v_mfma_f32_32x32x16_bf16 v[48:63], v[68:71], v[180:183], 0
    v_permlane32_swap_b32 v234, v236
    v_permlane32_swap_b32 v235, v237
    v_permlane32_swap_b32 v240, v238
    s_waitcnt vmcnt(4) lgkmcnt(0)
    v_mfma_f32_32x32x16_bf16 v[0:15], v[72:75], v[184:187], v[0:15]
    ds_read_b64_tr_b16 v[176:177], v246 offset:4096
    ds_read_b64_tr_b16 v[178:179], v246 offset:5120
    ds_read_b64_tr_b16 v[180:181], v247 offset:4096
    ds_read_b64_tr_b16 v[182:183], v247 offset:5120
    v_permlane32_swap_b32 v241, v239
    s_mov_b32 m0, s69
    v_mfma_f32_32x32x16_bf16 v[16:31], v[76:79], v[184:187], v[16:31]
    buffer_load_dwordx4 v224, s[4:7], s42 offen sc1 lds
    buffer_load_dwordx4 v225, s[72:75], s42 offen offset:1024 sc1 lds
    v_lshl_add_u32 v230, v252, 1, s31
    v_add_f32 v234, v234, v236
    v_add_f32 v235, v235, v237
    v_add_f32 v240, v240, v238
    v_add_f32 v241, v241, v239
    v_mfma_f32_32x32x16_bf16 v[32:47], v[72:75], v[188:191], v[32:47]
    v_cvt_pk_bf16_f32 v234, v234, v235
    v_cvt_pk_bf16_f32 v240, v240, v241
    ds_write2st64_b32 v230, v234, v240 offset0:0 offset1:1
    v_mfma_f32_32x32x16_bf16 v[48:63], v[76:79], v[188:191], v[48:63]
    s_waitcnt vmcnt(4) lgkmcnt(1)
    v_mfma_f32_32x32x16_bf16 v[0:15], v[80:83], v[176:179], v[0:15]
    ds_read_b64_tr_b16 v[184:185], v246 offset:6144
    ds_read_b64_tr_b16 v[186:187], v246 offset:7168
    ds_read_b64_tr_b16 v[188:189], v247 offset:6144
    ds_read_b64_tr_b16 v[190:191], v247 offset:7168
    s_mov_b32 m0, s70
    v_mfma_f32_32x32x16_bf16 v[16:31], v[84:87], v[176:179], v[16:31]
    buffer_load_dwordx4 v226, s[4:7], s42 offen sc1 lds
    buffer_load_dwordx4 v227, s[72:75], s42 offen offset:1024 sc1 lds
    v_mfma_f32_32x32x16_bf16 v[32:47], v[80:83], v[180:183], v[32:47]
    v_mfma_f32_32x32x16_bf16 v[48:63], v[84:87], v[180:183], v[48:63]
    s_waitcnt vmcnt(4) lgkmcnt(0)
    v_mfma_f32_32x32x16_bf16 v[0:15], v[88:91], v[184:187], v[0:15]
    ds_read_b64_tr_b16 v[176:177], v246 offset:0
    ds_read_b64_tr_b16 v[178:179], v246 offset:1024
    ds_read_b64_tr_b16 v[180:181], v247 offset:0
    ds_read_b64_tr_b16 v[182:183], v247 offset:1024
    s_mov_b32 m0, s71
    v_mfma_f32_32x32x16_bf16 v[16:31], v[92:95], v[184:187], v[16:31]
    buffer_load_dwordx4 v228, s[4:7], s42 offen sc1 lds
    buffer_load_dwordx4 v229, s[72:75], s42 offen offset:1024 sc1 lds
    v_mfma_f32_32x32x16_bf16 v[32:47], v[88:91], v[188:191], v[32:47]
    s_nop 2
    v_mul_f32 v234, v0, v144
    v_mul_f32 v236, v8, v112
    v_fmac_f32 v234, v1, v145
    v_fmac_f32 v236, v9, v113
    v_fmac_f32 v234, v2, v146
    v_fmac_f32 v236, v10, v114
    v_fmac_f32 v234, v3, v147
    v_mfma_f32_32x32x16_bf16 v[48:63], v[92:95], v[188:191], v[48:63]
    s_setprio 0
    v_fmac_f32 v236, v11, v115
    v_fmac_f32 v234, v4, v148
    v_fmac_f32 v236, v12, v116
    v_fmac_f32 v234, v5, v149
    v_fmac_f32 v236, v13, v117
    v_fmac_f32 v234, v6, v150
    v_fmac_f32 v236, v14, v118
    v_fmac_f32 v234, v7, v151
    v_fmac_f32 v236, v15, v119
    v_mul_f32 v238, v16, v160
    v_mul_f32 v240, v24, v160
    v_fmac_f32 v238, v17, v161
    v_fmac_f32 v240, v25, v161
    v_fmac_f32 v238, v18, v162
    v_fmac_f32 v240, v26, v162
    v_fmac_f32 v238, v19, v163
    v_fmac_f32 v240, v27, v163
    v_fmac_f32 v238, v20, v164
    v_fmac_f32 v240, v28, v164
    v_fmac_f32 v238, v21, v165
    v_fmac_f32 v240, v29, v165
    v_fmac_f32 v238, v22, v166
    v_fmac_f32 v240, v30, v166
    v_fmac_f32 v238, v23, v167
    v_fmac_f32 v240, v31, v167
    v_mul_f32 v235, v32, v152
    v_mul_f32 v237, v40, v120
    v_fmac_f32 v235, v33, v153
    v_fmac_f32 v237, v41, v121
    v_fmac_f32 v235, v34, v154
    v_fmac_f32 v237, v42, v122
    v_fmac_f32 v235, v35, v155
    v_fmac_f32 v237, v43, v123
    v_fmac_f32 v235, v36, v156
    v_fmac_f32 v237, v44, v124
    v_fmac_f32 v235, v37, v157
    v_fmac_f32 v237, v45, v125
    v_fmac_f32 v235, v38, v158
    v_fmac_f32 v237, v46, v126
    v_fmac_f32 v235, v39, v159
    v_fmac_f32 v237, v47, v127
    v_mul_f32 v239, v48, v168
    v_mul_f32 v241, v56, v168
    s_setprio 1
    s_waitcnt vmcnt(4) lgkmcnt(0)
    v_mfma_f32_32x32x16_bf16 v[0:15], v[64:67], v[176:179], 0
    ds_read_b64_tr_b16 v[184:185], v246 offset:2048
    ds_read_b64_tr_b16 v[186:187], v246 offset:3072
    ds_read_b64_tr_b16 v[188:189], v247 offset:2048
    ds_read_b64_tr_b16 v[190:191], v247 offset:3072
    v_fmac_f32 v239, v49, v169
    v_fmac_f32 v241, v57, v169
    s_mov_b32 m0, s68
    v_mfma_f32_32x32x16_bf16 v[16:31], v[68:71], v[176:179], 0
    buffer_load_dwordx4 v222, s[4:7], s43 offen sc1 lds
    buffer_load_dwordx4 v223, s[72:75], s43 offen offset:1024 sc1 lds
    v_fmac_f32 v239, v50, v170
    v_fmac_f32 v241, v58, v170
    v_fmac_f32 v239, v51, v171
    v_fmac_f32 v241, v59, v171
    v_fmac_f32 v239, v52, v172
    v_mfma_f32_32x32x16_bf16 v[32:47], v[64:67], v[180:183], 0
    v_fmac_f32 v241, v60, v172
    v_fmac_f32 v239, v53, v173
    v_fmac_f32 v241, v61, v173
    v_fmac_f32 v239, v54, v174
    v_fmac_f32 v241, v62, v174
    v_fmac_f32 v239, v55, v175
    v_fmac_f32 v241, v63, v175
    v_mfma_f32_32x32x16_bf16 v[48:63], v[68:71], v[180:183], 0
    s_waitcnt vmcnt(4) lgkmcnt(0)
    v_mfma_f32_32x32x16_bf16 v[0:15], v[72:75], v[184:187], v[0:15]
    ds_read_b64_tr_b16 v[176:177], v246 offset:4096
    ds_read_b64_tr_b16 v[178:179], v246 offset:5120
    ds_read_b64_tr_b16 v[180:181], v247 offset:4096
    ds_read_b64_tr_b16 v[182:183], v247 offset:5120
    s_mov_b32 m0, s69
    v_mfma_f32_32x32x16_bf16 v[16:31], v[76:79], v[184:187], v[16:31]
    buffer_load_dwordx4 v224, s[4:7], s43 offen sc1 lds
    buffer_load_dwordx4 v225, s[72:75], s43 offen offset:1024 sc1 lds
    v_mfma_f32_32x32x16_bf16 v[32:47], v[72:75], v[188:191], v[32:47]
    v_mfma_f32_32x32x16_bf16 v[48:63], v[76:79], v[188:191], v[48:63]
    s_waitcnt vmcnt(4) lgkmcnt(0)
    v_mfma_f32_32x32x16_bf16 v[0:15], v[80:83], v[176:179], v[0:15]
    ds_read_b64_tr_b16 v[184:185], v246 offset:6144
    ds_read_b64_tr_b16 v[186:187], v246 offset:7168
    ds_read_b64_tr_b16 v[188:189], v247 offset:6144
    ds_read_b64_tr_b16 v[190:191], v247 offset:7168
    s_mov_b32 m0, s70
    v_mfma_f32_32x32x16_bf16 v[16:31], v[84:87], v[176:179], v[16:31]
    buffer_load_dwordx4 v226, s[4:7], s43 offen sc1 lds
    buffer_load_dwordx4 v227, s[72:75], s43 offen offset:1024 sc1 lds
    v_mfma_f32_32x32x16_bf16 v[32:47], v[80:83], v[180:183], v[32:47]
    v_add_u32 v222, s48, v251
    ds_read2_b32 v[222:223], v222 offset0:1 offset1:3
    v_mfma_f32_32x32x16_bf16 v[48:63], v[84:87], v[180:183], v[48:63]
    s_waitcnt vmcnt(4) lgkmcnt(1)
    v_mfma_f32_32x32x16_bf16 v[0:15], v[88:91], v[184:187], v[0:15]
    ds_read_b64_tr_b16 v[176:177], v246 offset:0
    ds_read_b64_tr_b16 v[178:179], v246 offset:1024
    ds_read_b64_tr_b16 v[180:181], v247 offset:0
    ds_read_b64_tr_b16 v[182:183], v247 offset:1024
    s_mov_b32 m0, s71
    v_mfma_f32_32x32x16_bf16 v[16:31], v[92:95], v[184:187], v[16:31]
    buffer_load_dwordx4 v228, s[4:7], s43 offen sc1 lds
    buffer_load_dwordx4 v229, s[72:75], s43 offen offset:1024 sc1 lds
    s_waitcnt lgkmcnt(4)
    v_mad_u32_u16 v222, v222, s39, v248 op_sel:[1,0,0,0]
    v_mad_u32_u16 v223, v223, s39, v248 op_sel:[1,0,0,0]
    v_mfma_f32_32x32x16_bf16 v[32:47], v[88:91], v[188:191], v[32:47]
    v_add_u32 v224, s49, v251
    ds_read2_b32 v[224:225], v224 offset0:1 offset1:3
    v_mul_f32 v242, v0, v144
    v_fma_f32 v238, v8, v160, -v238
    v_fmac_f32 v242, v1, v145
    v_fmac_f32 v238, v9, v161
    v_fmac_f32 v242, v2, v146
    v_mfma_f32_32x32x16_bf16 v[48:63], v[92:95], v[188:191], v[48:63]
    s_setprio 0
    v_fmac_f32 v238, v10, v162
    v_fmac_f32 v242, v3, v147
    v_fmac_f32 v238, v11, v163
    v_fmac_f32 v242, v4, v148
    v_fmac_f32 v238, v12, v164
    v_fmac_f32 v242, v5, v149
    v_fmac_f32 v238, v13, v165
    v_fmac_f32 v242, v6, v150
    v_fmac_f32 v238, v14, v166
    v_fmac_f32 v242, v7, v151
    v_fmac_f32 v238, v15, v167
    v_fmac_f32 v236, v16, v112
    v_mul_f32 v244, v24, v160
    v_fmac_f32 v236, v17, v113
    v_fmac_f32 v244, v25, v161
    v_fmac_f32 v236, v18, v114
    v_fmac_f32 v244, v26, v162
    v_fmac_f32 v236, v19, v115
    v_fmac_f32 v244, v27, v163
    v_fmac_f32 v236, v20, v116
    v_fmac_f32 v244, v28, v164
    v_fmac_f32 v236, v21, v117
    v_fmac_f32 v244, v29, v165
    v_fmac_f32 v236, v22, v118
    v_fmac_f32 v244, v30, v166
    v_fmac_f32 v236, v23, v119
    v_fmac_f32 v244, v31, v167
    v_mul_f32 v243, v32, v152
    v_fma_f32 v239, v40, v168, -v239
    v_fmac_f32 v243, v33, v153
    v_fmac_f32 v239, v41, v169
    v_fmac_f32 v243, v34, v154
    v_fmac_f32 v239, v42, v170
    v_fmac_f32 v243, v35, v155
    v_fmac_f32 v239, v43, v171
    v_fmac_f32 v243, v36, v156
    v_fmac_f32 v239, v44, v172
    v_fmac_f32 v243, v37, v157
    v_fmac_f32 v239, v45, v173
    v_fmac_f32 v243, v38, v158
    v_fmac_f32 v239, v46, v174
    v_fmac_f32 v243, v39, v159
    v_fmac_f32 v239, v47, v175
    v_fmac_f32 v237, v48, v120
    v_mul_f32 v245, v56, v168
    v_fmac_f32 v237, v49, v121
    v_fmac_f32 v245, v57, v169
    v_fmac_f32 v237, v50, v122
    v_fmac_f32 v245, v58, v170
    v_fmac_f32 v237, v51, v123
    s_setprio 1
    s_waitcnt vmcnt(4) lgkmcnt(1)
    v_mfma_f32_32x32x16_bf16 v[0:15], v[64:67], v[176:179], 0
    ds_read_b64_tr_b16 v[184:185], v246 offset:2048
    ds_read_b64_tr_b16 v[186:187], v246 offset:3072
    ds_read_b64_tr_b16 v[188:189], v247 offset:2048
    ds_read_b64_tr_b16 v[190:191], v247 offset:3072
    v_fmac_f32 v245, v59, v171
    v_fmac_f32 v237, v52, v124
    s_mov_b32 m0, s68
    v_mfma_f32_32x32x16_bf16 v[16:31], v[68:71], v[176:179], 0
    buffer_load_dwordx4 v222, s[4:7], s44 offen sc1 lds
    buffer_load_dwordx4 v223, s[72:75], s44 offen offset:1024 sc1 lds
    s_waitcnt lgkmcnt(4)
    v_mad_u32_u16 v224, v224, s39, v248 op_sel:[1,0,0,0]
    v_mad_u32_u16 v225, v225, s39, v248 op_sel:[1,0,0,0]
    v_fmac_f32 v245, v60, v172
    v_fmac_f32 v237, v53, v125
    v_mfma_f32_32x32x16_bf16 v[32:47], v[64:67], v[180:183], 0
    v_add_u32 v226, s50, v251
    ds_read2_b32 v[226:227], v226 offset0:1 offset1:3
    v_fmac_f32 v245, v61, v173
    v_fmac_f32 v237, v54, v126
    v_fmac_f32 v245, v62, v174
    v_fmac_f32 v237, v55, v127
    v_fmac_f32 v245, v63, v175
    v_mfma_f32_32x32x16_bf16 v[48:63], v[68:71], v[180:183], 0
    v_permlane32_swap_b32 v242, v234
    v_permlane32_swap_b32 v243, v235
    v_add_f32 v242, v242, v234
    v_add_f32 v243, v243, v235
    s_waitcnt vmcnt(4) lgkmcnt(1)
    v_mfma_f32_32x32x16_bf16 v[0:15], v[72:75], v[184:187], v[0:15]
    ds_read_b64_tr_b16 v[176:177], v246 offset:4096
    ds_read_b64_tr_b16 v[178:179], v246 offset:5120
    ds_read_b64_tr_b16 v[180:181], v247 offset:4096
    ds_read_b64_tr_b16 v[182:183], v247 offset:5120
    v_cvt_pk_bf16_f32 v242, v242, v243
    ds_write_b32 v230, v242 offset:512
    s_mov_b32 m0, s69
    v_mfma_f32_32x32x16_bf16 v[16:31], v[76:79], v[184:187], v[16:31]
    buffer_load_dwordx4 v224, s[4:7], s45 offen sc1 lds
    buffer_load_dwordx4 v225, s[72:75], s45 offen offset:1024 sc1 lds
    s_waitcnt lgkmcnt(5)
    v_mad_u32_u16 v226, v226, s39, v248 op_sel:[1,0,0,0]
    v_mad_u32_u16 v227, v227, s39, v248 op_sel:[1,0,0,0]
    v_mfma_f32_32x32x16_bf16 v[32:47], v[72:75], v[188:191], v[32:47]
    v_mfma_f32_32x32x16_bf16 v[48:63], v[76:79], v[188:191], v[48:63]
    s_waitcnt vmcnt(4) lgkmcnt(1)
    v_mfma_f32_32x32x16_bf16 v[0:15], v[80:83], v[176:179], v[0:15]
    ds_read_b64_tr_b16 v[184:185], v246 offset:6144
    ds_read_b64_tr_b16 v[186:187], v246 offset:7168
    ds_read_b64_tr_b16 v[188:189], v247 offset:6144
    ds_read_b64_tr_b16 v[190:191], v247 offset:7168
    s_mov_b32 s32, s31
    s_mov_b32 s31, s35
    s_mov_b32 m0, s70
    v_mfma_f32_32x32x16_bf16 v[16:31], v[84:87], v[176:179], v[16:31]
    buffer_load_dwordx4 v226, s[4:7], s46 offen sc1 lds
    buffer_load_dwordx4 v227, s[72:75], s46 offen offset:1024 sc1 lds
    s_sub_u32 s26, s48, s29
    s_mov_b32 s29, s48
    s_mov_b32 s30, s3
    s_bfe_u32 s56, s3, 0x40012
    v_mfma_f32_32x32x16_bf16 v[32:47], v[80:83], v[180:183], v[32:47]
    s_cmp_lg_u32 s36, 0
    s_cselect_b32 s56, s56, 0
    v_mfma_f32_32x32x16_bf16 v[48:63], v[84:87], v[180:183], v[48:63]
    s_waitcnt vmcnt(4) lgkmcnt(0)
    v_mfma_f32_32x32x16_bf16 v[0:15], v[88:91], v[184:187], v[0:15]
    ds_read_b64_tr_b16 v[176:177], v246 offset:0
    ds_read_b64_tr_b16 v[178:179], v246 offset:1024
    ds_read_b64_tr_b16 v[180:181], v247 offset:0
    ds_read_b64_tr_b16 v[182:183], v247 offset:1024
    s_mov_b32 m0, s71
    v_mfma_f32_32x32x16_bf16 v[16:31], v[92:95], v[184:187], v[16:31]
    s_cmp_eq_u32 s33, 4
    s_cbranch_scc1 K2_g4_137
    buffer_load_dwordx4 v224, s[4:7], s47 offen sc1 lds
    buffer_load_dwordx4 v225, s[72:75], s47 offen offset:1024 sc1 lds
K2_back_138:
    v_mfma_f32_32x32x16_bf16 v[32:47], v[88:91], v[188:191], v[32:47]
    s_nop 0
    v_mul_f32 v242, v0, v144
    v_fma_f32 v240, v8, v160, -v240
    v_fmac_f32 v242, v1, v145
    v_fmac_f32 v240, v9, v161
    v_fmac_f32 v242, v2, v146
    v_fmac_f32 v240, v10, v162
    v_fmac_f32 v242, v3, v147
    v_mfma_f32_32x32x16_bf16 v[48:63], v[92:95], v[188:191], v[48:63]
    s_setprio 0
    v_fmac_f32 v240, v11, v163
    v_fmac_f32 v242, v4, v148
    v_fmac_f32 v240, v12, v164
    v_fmac_f32 v242, v5, v149
    v_fmac_f32 v240, v13, v165
    v_fmac_f32 v242, v6, v150
    v_fmac_f32 v240, v14, v166
    v_fmac_f32 v242, v7, v151
    v_fmac_f32 v240, v15, v167
    v_add_u32 v249, s26, v249
    v_add_u32 v250, s26, v250
    v_fma_f32 v244, v16, v160, -v244
    v_fmac_f32 v236, v24, v112
    v_fmac_f32 v244, v17, v161
    v_fmac_f32 v236, v25, v113
    v_fmac_f32 v244, v18, v162
    v_fmac_f32 v236, v26, v114
    v_fmac_f32 v244, v19, v163
    v_fmac_f32 v236, v27, v115
    v_fmac_f32 v244, v20, v164
    v_fmac_f32 v236, v28, v116
    v_fmac_f32 v244, v21, v165
    v_fmac_f32 v236, v29, v117
    v_fmac_f32 v244, v22, v166
    v_fmac_f32 v236, v30, v118
    v_fmac_f32 v244, v23, v167
    v_fmac_f32 v236, v31, v119
    ds_read_b64_tr_b16 v[0:1], v249 offset:0
    ds_read_b64_tr_b16 v[2:3], v249 offset:32
    ds_read_u16_d16_hi v16, v250 offset:0
    v_mul_f32 v243, v32, v152
    v_fma_f32 v241, v40, v168, -v241
    v_fmac_f32 v243, v33, v153
    v_fmac_f32 v241, v41, v169
    v_fmac_f32 v243, v34, v154
    v_fmac_f32 v241, v42, v170
    v_fmac_f32 v243, v35, v155
    v_fmac_f32 v241, v43, v171
    v_fmac_f32 v243, v36, v156
    v_fmac_f32 v241, v44, v172
    v_fmac_f32 v243, v37, v157
    v_fmac_f32 v241, v45, v173
    v_fmac_f32 v243, v38, v158
    v_fmac_f32 v241, v46, v174
    v_fmac_f32 v243, v39, v159
    v_fmac_f32 v241, v47, v175
    ds_read_b64_tr_b16 v[4:5], v249 offset:512
    ds_read_b64_tr_b16 v[6:7], v249 offset:544
    ds_read_u16_d16_hi v17, v250 offset:128
    v_fma_f32 v245, v48, v168, -v245
    v_fmac_f32 v237, v56, v120
    v_fmac_f32 v245, v49, v169
    v_fmac_f32 v237, v57, v121
    v_fmac_f32 v245, v50, v170
    v_fmac_f32 v237, v58, v122
    v_fmac_f32 v245, v51, v171
    v_fmac_f32 v237, v59, v123
    v_fmac_f32 v245, v52, v172
    v_fmac_f32 v237, v60, v124
    v_fmac_f32 v245, v53, v173
    v_fmac_f32 v237, v61, v125
    v_fmac_f32 v245, v54, v174
    v_fmac_f32 v237, v62, v126
    v_fmac_f32 v245, v55, v175
    v_fmac_f32 v237, v63, v127
    s_cmp_eq_u32 s56, 5
    s_cbranch_scc1 K2_U21
    s_cmp_eq_u32 s56, 6
    s_cbranch_scc1 K2_U3h1
    s_branch K2_DSP1
K2_FLGR:
    s_sub_u32 s27, s27, 16
    s_cbranch_scc1 K2_END
    buffer_load_dwordx4 v[56:59], v60, s[8:11], s64 offen sc1
    s_branch K2_FLGW
K2_FLGY:
    v_mov_b32 v56, s2
    v_mov_b32 v57, 7178240
    s_mov_b64 exec, 1
    buffer_store_dword v56, v57, s[8:11], 0 offen sc1
    s_mov_b64 exec, -1
    s_branch K2_FLGOK
K2_nul_93:
    s_mov_b32 s58, 63
    s_mov_b32 s36, 0
    s_branch K2_back_96
K2_spin_94:
    s_sub_u32 s27, s27, 1
    s_cbranch_scc1 K2_END
    ds_read_b32 v232, v254
    s_waitcnt lgkmcnt(0)
    s_branch K2_chk_95
K2_dyn_91:
    v_lshl_add_u32 v254, v252, 1, s53
    v_bfe_u32 v255, v252, 4, 1
    s_mov_b64 exec, 0x1ff
    ds_add_rtn_u32 v232, v254, v255
    s_mov_b64 exec, -1
    s_waitcnt lgkmcnt(0)
    v_readlane_b32 s58, v232, 8
    s_nop 0
    s_cmp_lt_u32 s58, s22
    s_cbranch_scc0 K2_nul_93
    s_nop 0
    v_readlane_b32 s3, v253, s58
    s_nop 0
    s_bfe_u32 s58, s3, 0x60016
    s_and_b32 s59, s58, 7
    s_lshr_b32 s60, s58, 3
K2_chk_95:
    v_readlane_b32 s61, v232, s59
    s_nop 0
    s_cmp_gt_u32 s61, s60
    s_cbranch_scc0 K2_spin_94
K2_back_96:
    s_mov_b32 s34, 1
    s_branch K2_back_92
K2_rare_97:
    s_cmp_eq_u32 s33, 4
    s_cbranch_scc1 K2_four_99
    s_mov_b32 s49, s48
    s_xor_b32 s45, s44, 256
    s_xor_b32 s46, s44, 512
    s_xor_b32 s47, s44, 768
    s_branch K2_back_98
K2_four_99:
    s_add_u32 s50, s48, 256
    s_mov_b32 s46, s44
    s_mov_b32 s47, s44
    s_branch K2_back_98
K2_dum_100:
    v_mov_b32 v232, -1
    s_mov_b32 m0, 163312
    s_mov_b64 exec, 1
    buffer_load_dwordx4 v232, s[16:19], 0 offen lds
    buffer_load_dwordx4 v232, s[16:19], 0 offen lds
    s_mov_b64 exec, -1
    s_branch K2_back_102
K2_a4_101:
    v_add_u32 v254, s48, v230
    ds_read_b32 v254, v254 offset:4
    s_lshr_b32 s65, s3, 28
    s_mul_i32 s66, s22, 2080
    s_lshl_b32 s65, s65, 9
    s_add_u32 s65, s65, s66
    s_add_u32 s65, s65, 65536
    s_mov_b32 m0, s65
    s_mov_b32 exec_hi, 0
    s_waitcnt lgkmcnt(0)
    v_or_b32 v254, v254, v231
    buffer_load_dwordx4 v254, s[16:19], 0 offen  lds
    s_mov_b32 exec_hi, -1
    s_branch K2_b4_103
K2_g4_104:
    s_add_u32 s51, s48, 384
    v_add_u32 v228, s51, v251
    ds_read2_b32 v[228:229], v228 offset0:1 offset1:3
    s_waitcnt lgkmcnt(0)
    v_mad_u32_u16 v228, v228, s39, v248 op_sel:[1,0,0,0]
    v_mad_u32_u16 v229, v229, s39, v248 op_sel:[1,0,0,0]
    buffer_load_dwordx4 v228, s[4:7], s47 offen sc1 lds
    buffer_load_dwordx4 v229, s[72:75], s47 offen offset:1024 sc1 lds
    s_branch K2_back_105
K2_nul_108:
    s_mov_b32 s58, 63
    s_mov_b32 s36, 0
    s_branch K2_back_111
K2_spin_109:
    s_sub_u32 s27, s27, 1
    s_cbranch_scc1 K2_END
    ds_read_b32 v232, v254
    s_waitcnt lgkmcnt(0)
    s_branch K2_chk_110
K2_dyn_106:
    v_lshl_add_u32 v254, v252, 1, s53
    v_bfe_u32 v255, v252, 4, 1
    s_mov_b64 exec, 0x1ff
    ds_add_rtn_u32 v232, v254, v255
    s_mov_b64 exec, -1
    s_waitcnt lgkmcnt(0)
    v_readlane_b32 s58, v232, 8
    s_nop 0
    s_cmp_lt_u32 s58, s22
    s_cbranch_scc0 K2_nul_108
    s_nop 0
    v_readlane_b32 s3, v253, s58
    s_nop 0
    s_bfe_u32 s58, s3, 0x60016
    s_and_b32 s59, s58, 7
    s_lshr_b32 s60, s58, 3
K2_chk_110:
    v_readlane_b32 s61, v232, s59
    s_nop 0
    s_cmp_gt_u32 s61, s60
    s_cbranch_scc0 K2_spin_109
K2_back_111:
    s_mov_b32 s34, 1
    s_branch K2_back_107
K2_rare_112:
    s_cmp_eq_u32 s33, 4
    s_cbranch_scc1 K2_four_114
    s_mov_b32 s49, s48
    s_xor_b32 s45, s44, 256
    s_xor_b32 s46, s44, 512
    s_xor_b32 s47, s44, 768
    s_branch K2_back_113
K2_four_114:
    s_add_u32 s50, s48, 256
    s_mov_b32 s46, s44
    s_mov_b32 s47, s44
    s_branch K2_back_113
K2_g4_115:
    s_add_u32 s51, s48, 384
    v_add_u32 v228, s51, v251
    ds_read2_b32 v[228:229], v228 offset0:1 offset1:3
    s_waitcnt lgkmcnt(0)
    v_mad_u32_u16 v228, v228, s39, v248 op_sel:[1,0,0,0]
    v_mad_u32_u16 v229, v229, s39, v248 op_sel:[1,0,0,0]
    buffer_load_dwordx4 v228, s[4:7], s47 offen sc1 lds
    buffer_load_dwordx4 v229, s[72:75], s47 offen offset:1024 sc1 lds
    s_branch K2_back_116
K2_dum_117:
    v_mov_b32 v232, -1
    s_mov_b32 m0, 163312
    s_mov_b64 exec, 1
    buffer_load_dwordx4 v232, s[16:19], 0 offen lds
    buffer_load_dwordx4 v232, s[16:19], 0 offen lds
    s_mov_b64 exec, -1
    s_branch K2_back_119
K2_a4_118:
    v_add_u32 v254, s48, v230
    ds_read_b32 v254, v254 offset:4
    s_lshr_b32 s65, s3, 28
    s_mul_i32 s66, s22, 2080
    s_lshl_b32 s65, s65, 9
    s_add_u32 s65, s65, s66
    s_add_u32 s65, s65, 65536
    s_mov_b32 m0, s65
    s_mov_b32 exec_hi, 0
    s_waitcnt lgkmcnt(0)
    v_or_b32 v254, v254, v231
    buffer_load_dwordx4 v254, s[16:19], 0 offen  lds
    s_mov_b32 exec_hi, -1
    s_branch K2_b4_120
K2_nul_121:
    s_mov_b32 s3, 949760
    s_mov_b32 s36, 0
    s_branch K2_back_124
K2_spin_122:
    s_sub_u32 s27, s27, 1
    s_cbranch_scc1 K2_END
    ds_read_b32 v232, v254
    s_waitcnt lgkmcnt(0)
    s_branch K2_chk_123
K2_rare_125:
    s_cmp_eq_u32 s33, 4
    s_cbranch_scc1 K2_four_127
    s_mov_b32 s49, s48
    s_xor_b32 s45, s44, 256
    s_xor_b32 s46, s44, 512
    s_xor_b32 s47, s44, 768
    s_branch K2_back_126
K2_four_127:
    s_add_u32 s50, s48, 256
    s_mov_b32 s46, s44
    s_mov_b32 s47, s44
    s_branch K2_back_126
K2_g4_128:
    s_add_u32 s51, s48, 384
    v_add_u32 v228, s51, v251
    ds_read2_b32 v[228:229], v228 offset0:1 offset1:3
    s_waitcnt lgkmcnt(0)
    v_mad_u32_u16 v228, v228, s39, v248 op_sel:[1,0,0,0]
    v_mad_u32_u16 v229, v229, s39, v248 op_sel:[1,0,0,0]
    buffer_load_dwordx4 v228, s[4:7], s47 offen sc1 lds
    buffer_load_dwordx4 v229, s[72:75], s47 offen offset:1024 sc1 lds
    s_branch K2_back_129
K2_nul_130:
    s_mov_b32 s3, 949760
    s_mov_b32 s36, 0
    s_branch K2_back_133
K2_spin_131:
    s_sub_u32 s27, s27, 1
    s_cbranch_scc1 K2_END
    ds_read_b32 v232, v254
    s_waitcnt lgkmcnt(0)
    s_branch K2_chk_132
K2_rare_134:
    s_cmp_eq_u32 s33, 4
    s_cbranch_scc1 K2_four_136
    s_mov_b32 s49, s48
    s_xor_b32 s45, s44, 256
    s_xor_b32 s46, s44, 512
    s_xor_b32 s47, s44, 768
    s_branch K2_back_135
K2_four_136:
    s_add_u32 s50, s48, 256
    s_mov_b32 s46, s44
    s_mov_b32 s47, s44
    s_branch K2_back_135
K2_g4_137:
    s_add_u32 s51, s48, 384
    v_add_u32 v228, s51, v251
    ds_read2_b32 v[228:229], v228 offset0:1 offset1:3
    s_waitcnt lgkmcnt(0)
    v_mad_u32_u16 v228, v228, s39, v248 op_sel:[1,0,0,0]
    v_mad_u32_u16 v229, v229, s39, v248 op_sel:[1,0,0,0]
    buffer_load_dwordx4 v228, s[4:7], s47 offen sc1 lds
    buffer_load_dwordx4 v229, s[72:75], s47 offen offset:1024 sc1 lds
    s_branch K2_back_138
K2_END:
    s_endpgm
.section .rodata,"a"
.p2align 6
.amdhsa_kernel standalone__tensor_product_equiv_equiformer__graph_kernel
  .amdhsa_next_free_vgpr 256
  .amdhsa_next_free_sgpr 102
  .amdhsa_accum_offset 256
  .amdhsa_group_segment_fixed_size 0
  .amdhsa_kernarg_size 96
  .amdhsa_user_sgpr_count 2
  .amdhsa_user_sgpr_kernarg_segment_ptr 1
  .amdhsa_system_sgpr_workgroup_id_x 1
  .amdhsa_float_denorm_mode_32 3
.end_amdhsa_kernel
```

```asm
; @launch grid=(256,1,1) block=(512,1,1) lds=163840
.amdgcn_target "amdgcn-amd-amdhsa--gfx950"
.text
.globl standalone__tensor_product_equiv_equiformer__graph_kernel
.p2align 8
.type standalone__tensor_product_equiv_equiformer__graph_kernel,@function
standalone__tensor_product_equiv_equiformer__graph_kernel:
    s_cmp_ge_u32 s2, 256
    s_cbranch_scc1 K2_END
    s_load_dwordx16 s[80:95], s[0:1], 0
    s_load_dwordx4 s[96:99], s[0:1], 72
    s_load_dwordx2 s[100:101], s[0:1], 88
    v_lshrrev_b32 v1, 6, v0
    s_mov_b32 s54, s2
    v_readfirstlane_b32 s20, v1
    s_mov_b64 exec, 0
    s_cmp_eq_u32 s20, 0
    s_cbranch_scc1 K2_PAD_S1
    s_cmp_eq_u32 s20, 1
    s_cbranch_scc1 K2_PAD_S2
    s_cmp_eq_u32 s20, 5
    s_cbranch_scc1 K2_PAD_H1
    s_cmp_eq_u32 s20, 6
    s_cbranch_scc1 K2_PAD_H2
    s_cmp_eq_u32 s20, 2
    s_cbranch_scc1 K2_PAD_H3
KS_HOP0:
    s_mov_b64 exec, -1
    v_and_b32 v8, 63, v0
    v_lshlrev_b32 v9, 4, v8
    v_mov_b32 v6, 0
    v_lshlrev_b32 v5, 4, v0
    v_mul_u32_u24 v4, 24, v0
    s_mul_i32 s64, s2, 5120
    s_mul_i32 s65, s2, 7680
    v_mov_b32 v176, v8
    v_mov_b32 v177, v0
    s_movk_i32 s39, 1024
    s_lshl_b32 s37, s20, 13
    s_mov_b32 s53, 163264
    s_lshl_b32 s52, s20, 2
    s_add_u32 s52, s52, s53
    s_add_u32 s68, s37, 0
    s_add_u32 s69, s37, 2048
    s_add_u32 s70, s37, 4096
    s_add_u32 s71, s37, 6144
    s_waitcnt lgkmcnt(0)
    s_mov_b32 s8, s100
    s_and_b32 s9, s101, 0xffff
    s_mov_b32 s10, 37748736
    s_mov_b32 s11, 0x20000
    s_cmp_lg_u32 s20, 7
    s_cbranch_scc1 KS_NOTAG
    s_mov_b32 s24, 7178240
    s_mov_b64 exec, 1
    buffer_load_dword v14, v6, s[8:11], s24 offen sc1
    s_mov_b64 exec, -1
    s_mov_b32 s60, s98
    s_and_b32 s61, s99, 0xffff
    s_mov_b32 s62, 256
    s_mov_b32 s63, 0x20000
    s_barrier
    v_mov_b32 v76, 0
    v_mov_b32 v77, -1
    v_lshlrev_b32 v78, 2, v8
    v_add_u32 v78, 163072, v78
    s_mov_b64 exec, 0x1ff
    ds_write_b32 v78, v76 offset:192
    s_mov_b32 exec_lo, 1
    ds_write_b32 v78, v76 offset:228
    s_mov_b32 exec_lo, -1
    ds_write_b32 v78, v77 offset:256
    s_mov_b64 exec, -1
    s_mov_b32 exec_hi, 0xffff
    ds_write_b32 v78, v76
    s_mov_b64 exec, 1
    ds_write_b32 v78, v76 offset:232
    s_mov_b64 exec, -1
    s_mov_b64 exec, 1
    buffer_load_dword v15, v6, s[60:63], 0 offen sc1
    v_mov_b32 v12, 163456
    s_mov_b32 s24, 1664525
    s_waitcnt vmcnt(1)
    v_mul_lo_u32 v59, v14, s24
    v_add_u32 v59, 1013904223, v59
    ds_write2_b32 v12, v59, v6 offset0:0 offset1:1
    s_waitcnt lgkmcnt(0)
    s_barrier
    s_waitcnt vmcnt(0)
    v_mov_b32 v62, v15
    ds_write_b32 v12, v15 offset:4
    v_cmp_ne_u32 vcc, 0, v15
    s_mov_b32 s24, 0x40000
    s_waitcnt lgkmcnt(0)
    s_barrier
    s_cbranch_vccnz KS_FLOK
KS_FLW:
    s_sub_u32 s24, s24, 1
    s_cbranch_scc1 K2_END
    buffer_load_dword v62, v6, s[60:63], 0 offen sc1
    s_waitcnt vmcnt(0)
    v_cmp_ne_u32 vcc, 0, v62
    s_nop 0
    s_cbranch_vccz KS_FLW
    ds_write_b32 v12, v62 offset:4
KS_FLOK:
    s_mov_b64 exec, -1
    s_branch KS_JOIN
KS_H0:
    s_barrier
    s_branch KS_HELP
K2_PAD_S1:
    s_branch KS_HOP0
KS_NOTAG:
    s_cmp_ge_u32 s20, 5
    s_cbranch_scc1 KS_HELP
    s_cmp_ge_u32 s2, 250
    s_cbranch_scc1 KS_IDLE
    s_mov_b32 s40, s88
    s_and_b32 s41, s89, 0xffff
    s_mov_b32 s42, 1280000
    s_mov_b32 s43, 0x20000
    buffer_load_dwordx4 v[12:15], v5, s[40:43], s64 offen
    s_mov_b32 s44, s86
    s_and_b32 s45, s87, 0xffff
    s_mov_b32 s46, 1280000
    s_mov_b32 s47, 0x20000
    s_mov_b32 s48, s82
    s_and_b32 s49, s83, 0xffff
    s_mov_b32 s50, 1920000
    s_mov_b32 s51, 0x20000
    buffer_load_dwordx4 v[16:19], v5, s[44:47], s64 offen
    buffer_load_dwordx4 v[20:23], v4, s[48:51], s65 offen
    buffer_load_dwordx2 v[24:25], v4, s[48:51], s65 offen offset:16
    v_lshlrev_b32 v2, 2, v0
    s_lshl_b32 s64, s64, 3
    v_lshl_add_u32 v3, v0, 7, s64
    v_mov_b32 v7, 1
    s_setprio 2
    s_cmp_eq_u32 s20, 4
    s_cbranch_scc1 KS_NOCLR
    s_setprio 1
    ds_write_b32 v2, v6
KS_NOCLR:
    s_waitcnt lgkmcnt(0)
    s_barrier
    s_mov_b64 exec, 0
    s_cmp_eq_u32 s20, 0
    s_cbranch_scc1 K2_PAD_B3
    s_cmp_eq_u32 s20, 1
    s_cbranch_scc1 K2_PAD_LD
    s_cmp_eq_u32 s20, 2
    s_cbranch_scc1 K2_PAD_NW
    s_cmp_eq_u32 s20, 3
    s_cbranch_scc1 K2_PAD_SC
    s_cmp_eq_u32 s20, 4
    s_cbranch_scc1 K2_PAD_SD
KS_HOP:
    s_mov_b64 exec, -1
    s_mov_b32 s58, 214749
    s_movk_i32 s59, 625
    s_waitcnt vmcnt(3)
    v_mul_u32_u24 v28, s58, v12
    v_and_b32 v40, 0xffffff, v28
    v_lshrrev_b32 v32, 26, v28
    v_add_u32 v40, 8187281, v40
    v_bfe_u32 v36, v28, 24, 2
    v_lshlrev_b32 v32, 2, v32
    v_lshrrev_b32 v40, 24, v40
    v_lshl_or_b32 v32, v36, 8, v32
    v_lshl_or_b32 v32, v40, 7, v32
    ds_add_rtn_u32 v36, v32, v7
    v_mul_u32_u24 v29, s58, v13
    v_and_b32 v41, 0xffffff, v29
    v_lshrrev_b32 v33, 26, v29
    v_add_u32 v41, 8187281, v41
    v_bfe_u32 v37, v29, 24, 2
    v_lshlrev_b32 v33, 2, v33
    v_lshrrev_b32 v41, 24, v41
    v_lshl_or_b32 v33, v37, 8, v33
    v_lshl_or_b32 v33, v41, 7, v33
    ds_add_rtn_u32 v37, v33, v7
    v_mul_u32_u24 v30, s58, v14
    v_and_b32 v42, 0xffffff, v30
    v_lshrrev_b32 v34, 26, v30
    v_add_u32 v42, 8187281, v42
    v_bfe_u32 v38, v30, 24, 2
    v_lshlrev_b32 v34, 2, v34
    v_lshrrev_b32 v42, 24, v42
    v_lshl_or_b32 v34, v38, 8, v34
    v_lshl_or_b32 v34, v42, 7, v34
    ds_add_rtn_u32 v38, v34, v7
    v_mul_u32_u24 v31, s58, v15
    v_and_b32 v43, 0xffffff, v31
    v_lshrrev_b32 v35, 26, v31
    v_add_u32 v43, 8187281, v43
    v_bfe_u32 v39, v31, 24, 2
    v_lshlrev_b32 v35, 2, v35
    v_lshrrev_b32 v43, 24, v43
    v_lshl_or_b32 v35, v39, 8, v35
    v_lshl_or_b32 v35, v43, 7, v35
    ds_add_rtn_u32 v39, v35, v7
    v_lshrrev_b32 v28, 24, v28
    v_mad_u32_u24 v28, v28, s59, 7
    v_lshrrev_b32 v28, 3, v28
    v_mad_u32_u24 v28, v40, 40, v28
    v_sub_u32 v28, v12, v28
    v_add_u32 v12, 0, v3
    v_lshl_or_b32 v28, v28, 26, v12
    v_lshrrev_b32 v29, 24, v29
    v_mad_u32_u24 v29, v29, s59, 7
    v_lshrrev_b32 v29, 3, v29
    v_mad_u32_u24 v29, v41, 40, v29
    v_sub_u32 v29, v13, v29
    v_add_u32 v13, 32, v3
    v_lshl_or_b32 v29, v29, 26, v13
    v_lshrrev_b32 v30, 24, v30
    v_mad_u32_u24 v30, v30, s59, 7
    v_lshrrev_b32 v30, 3, v30
    v_mad_u32_u24 v30, v42, 40, v30
    v_sub_u32 v30, v14, v30
    v_add_u32 v14, 64, v3
    v_lshl_or_b32 v30, v30, 26, v14
    v_lshrrev_b32 v31, 24, v31
    v_mad_u32_u24 v31, v31, s59, 7
    v_lshrrev_b32 v31, 3, v31
    v_mad_u32_u24 v31, v43, 40, v31
    v_sub_u32 v31, v15, v31
    v_add_u32 v15, 96, v3
    v_lshl_or_b32 v31, v31, 26, v15
K2_PAD_S2:
    s_cbranch_execz KS_HOP0
    v_mov_b32 v59, 163456
    s_mul_i32 s65, s2, 1152
    s_add_u32 s65, s65, 6291456
    s_mul_i32 s64, s2, 20608
    s_waitcnt lgkmcnt(0)
    s_barrier
    ds_read_b128 v[40:43], v9
    ds_read_b32 v59, v59
    s_waitcnt lgkmcnt(1)
    v_add_u32 v45, v40, v41
    v_add_u32 v46, v45, v42
    v_add_u32 v47, v46, v43
    v_mov_b32 v58, v47
    s_nop 1
    v_add_u32_dpp v58, v58, v58 row_shr:1 row_mask:0xf bank_mask:0xf bound_ctrl:0
    s_nop 1
    v_add_u32_dpp v58, v58, v58 row_shr:2 row_mask:0xf bank_mask:0xf bound_ctrl:0
    s_nop 1
    v_add_u32_dpp v58, v58, v58 row_shr:4 row_mask:0xf bank_mask:0xf bound_ctrl:0
    s_nop 1
    v_add_u32_dpp v58, v58, v58 row_shr:8 row_mask:0xf bank_mask:0xf bound_ctrl:0
    s_nop 1
    v_add_u32_dpp v58, v58, v58 row_bcast:15 row_mask:0xa bank_mask:0xf
    s_nop 1
    v_add_u32_dpp v58, v58, v58 row_bcast:31 row_mask:0xc bank_mask:0xf
    v_sub_u32 v48, v58, v47
    v_add_u32 v49, v48, v40
    v_add_u32 v50, v48, v45
    v_add_u32 v51, v48, v46
    ds_write_b128 v9, v[48:51] offset:1024
    s_waitcnt lgkmcnt(1)
    s_cmp_lg_u32 s20, 4
    s_cbranch_scc1 KS_NOPUB
    v_lshl_or_b32 v56, v49, 11, v48
    v_lshl_or_b32 v57, v51, 11, v50
    v_lshl_or_b32 v56, v59, 22, v56
    v_lshl_or_b32 v57, v59, 22, v57
    buffer_store_dwordx4 v[56:59], v9, s[8:11], s65 offen sc1
KS_NOPUB:
    s_waitcnt lgkmcnt(0)
    ds_read_b32 v32, v32 offset:1024
    ds_read_b32 v33, v33 offset:1024
    ds_read_b32 v34, v34 offset:1024
    ds_read_b32 v35, v35 offset:1024
    s_cbranch_scc1 KS_PUB0
    s_waitcnt vmcnt(1)
    s_branch KS_PUB1
KS_PUB0:
    s_waitcnt vmcnt(0)
KS_PUB1:
    v_and_b32 v60, 0xffff, v59
    v_and_b32 v61, 0xffff0000, v59
    s_mov_b32 s58, 0xffff0000
    v_mov_b32 v40, v20
    v_lshl_or_b32 v41, v21, 16, v60
    v_or_b32 v42, v61, v16
    v_mov_b32 v43, v28
    v_alignbit_b32 v44, v22, v21, 16
    v_and_or_b32 v45, v22, s58, v60
    v_or_b32 v46, v61, v17
    v_mov_b32 v47, v29
    v_mov_b32 v48, v23
    v_lshl_or_b32 v49, v24, 16, v60
    v_or_b32 v50, v61, v18
    v_mov_b32 v51, v30
    v_alignbit_b32 v52, v25, v24, 16
    v_and_or_b32 v53, v25, s58, v60
    v_or_b32 v54, v61, v19
    v_mov_b32 v55, v31
    s_waitcnt lgkmcnt(0)
    v_add_lshl_u32 v32, v32, v36, 4
    ds_write_b128 v32, v[40:43] offset:2048
    v_add_lshl_u32 v33, v33, v37, 4
    ds_write_b128 v33, v[44:47] offset:2048
    v_add_lshl_u32 v34, v34, v38, 4
    ds_write_b128 v34, v[48:51] offset:2048
    v_add_lshl_u32 v35, v35, v39, 4
    ds_write_b128 v35, v[52:55] offset:2048
    v_mov_b32 v62, 163460
    s_waitcnt lgkmcnt(0)
    s_barrier
    ds_read_b32 v62, v62
    ds_read_b128 v[12:15], v5 offset:2048
    ds_read_b128 v[16:19], v5 offset:7168
    ds_read_b128 v[20:23], v5 offset:12288
    ds_read_b128 v[24:27], v5 offset:17408
    s_waitcnt lgkmcnt(3)
    buffer_store_dwordx4 v[12:15], v5, s[8:11], s64 offen sc1
    s_add_u32 s64, s64, 5120
    s_waitcnt lgkmcnt(2)
    buffer_store_dwordx4 v[16:19], v5, s[8:11], s64 offen sc1
    s_add_u32 s64, s64, 5120
    s_waitcnt lgkmcnt(1)
    buffer_store_dwordx4 v[20:23], v5, s[8:11], s64 offen sc1
    s_add_u32 s64, s64, 5120
    s_waitcnt lgkmcnt(0)
    buffer_store_dwordx4 v[24:27], v5, s[8:11], s64 offen sc1
    s_branch KS_JOIN
K2_PAD_B3:
    s_branch KS_HOP
KS_B3:
    v_mov_b32 v59, 163456
    ds_read_b32 v59, v59
    v_mov_b32 v62, 163460
    s_waitcnt lgkmcnt(0)
    s_barrier
    ds_read_b32 v62, v62
KS_JOIN:
    s_setprio 0
    v_readfirstlane_b32 s2, v59
    s_mov_b32 s25, 0x400000
KS_JOIN2:
    s_waitcnt lgkmcnt(0)
    v_readfirstlane_b32 s24, v62
    s_nop 0
    s_cmp_eq_u32 s24, 0
    s_cbranch_scc1 KS_FLS
    s_bfe_u32 s24, s24, 0x10001
    s_xor_b32 s54, s54, s24
    s_lshr_b32 s21, s54, 1
    s_mul_i32 s21, s21, 625
    s_add_u32 s22, s21, 632
    s_add_u32 s21, s21, 7
    s_lshr_b32 s21, s21, 3
    s_lshr_b32 s22, s22, 3
    s_add_u32 s24, s21, 40
    s_sub_u32 s22, s22, s24
    s_bitcmp1_b32 s54, 0
    s_cselect_b32 s21, s24, s21
    s_cselect_b32 s22, s22, 40
    s_mov_b32 s23, 0
    s_mov_b32 s28, 1
    s_mov_b32 s24, 0
    s_mov_b32 s25, 1
K2_CELLS:
    v_lshrrev_b32 v178, 1, v177
    v_min_u32 v178, 249, v178
    v_mul_u32_u24 v72, 1152, v178
    s_and_b32 s58, s54, 7
    s_lshl_b32 s58, s58, 7
    s_lshr_b32 s59, s54, 5
    s_lshl_b32 s59, s59, 4
    s_add_u32 s67, s58, s59
    s_add_u32 s67, s67, 6291456
    s_cmp_eq_u32 s28, 0
    s_cbranch_scc1 K2_NOSRD
    s_mov_b32 s4, s80
    s_and_b32 s5, s81, 0xffff
    s_mov_b32 s6, 10240000
    s_mov_b32 s7, 0x20000
    s_mov_b32 s12, s96
    s_and_b32 s13, s97, 0xffff
    s_mov_b32 s14, 10240000
    s_mov_b32 s15, 0x20000
    s_mov_b32 s16, s84
    s_and_b32 s17, s85, 0xffff
    s_mov_b32 s18, 10240000
    s_mov_b32 s19, 0x20000
    s_sub_u32 s80, s80, 1024
    s_subb_u32 s81, s81, 0
    s_mov_b32 s72, s80
    s_and_b32 s73, s81, 0xffff
    s_mov_b32 s74, 10241024
    s_mov_b32 s75, 0x20000
K2_NOSRD:
    v_and_b32 v84, 15, v176
    v_lshrrev_b32 v85, 5, v176
    v_bfe_u32 v86, v176, 4, 1
    v_lshrrev_b32 v87, 2, v84
    v_and_b32 v88, 3, v84
    v_lshl_add_u32 v89, v85, 2, v87
    v_lshlrev_b32 v249, 6, v89
    v_lshl_add_u32 v249, v88, 3, v249
    v_add_u32 v249, 512, v249
    v_lshrrev_b32 v90, 3, v84
    v_lshl_add_u32 v90, v90, 1, v86
    v_sub_u32 v90, v90, 1 clamp
    v_lshlrev_b32 v250, 1, v90
    v_lshl_add_u32 v91, v85, 2, v88
    v_lshl_add_u32 v250, v91, 4, v250
    v_and_b32 v91, 1, v87
    v_lshl_add_u32 v250, v91, 3, v250
    v_lshrrev_b32 v90, 1, v88
    v_lshl_add_u32 v90, v86, 1, v90
    v_bfe_u32 v91, v87, 1, 1
    v_lshlrev_b32 v91, 2, v91
    v_xor_b32 v90, v90, v91
    v_lshlrev_b32 v90, 4, v90
    v_lshl_add_u32 v90, v89, 7, v90
    v_and_b32 v91, 1, v88
    v_lshl_add_u32 v90, v91, 3, v90
    v_add_u32 v246, s37, v90
    v_xor_b32 v247, 64, v246
    v_lshrrev_b32 v90, 3, v176
    v_lshlrev_b32 v251, 4, v90
    v_bfe_u32 v90, v90, 1, 1
    v_lshlrev_b32 v90, 2, v90
    v_and_b32 v91, 7, v176
    v_xor_b32 v90, v90, v91
    v_lshlrev_b32 v248, 4, v90
    v_lshlrev_b32 v252, 1, v176
    v_mov_b32 v228, -1
    v_mov_b32 v229, -1
    v_and_b32 v231, 1, v176
    v_lshlrev_b32 v231, 4, v231
    v_lshrrev_b32 v90, 1, v176
    v_lshlrev_b32 v90, 5, v90
    v_add_u32 v230, 512, v90
    s_cmp_eq_u32 s28, 0
    s_cbranch_scc1 K2_NOW0
    v_lshrrev_b32 v60, 6, v252
    v_bfe_u32 v61, v252, 3, 2
    v_lshl_add_u32 v60, v60, 2, v61
    v_mul_u32_u24 v60, 640, v60
    v_bfe_u32 v61, v252, 5, 1
    v_lshl_add_u32 v60, v61, 5, v60
    v_and_b32 v61, 6, v252
    v_lshl_add_u32 v60, v61, 2, v60
    v_add_u32 v60, 24576, v60
    ds_read_b64_tr_b16 v[136:137], v60 offset:0
    ds_read_b64_tr_b16 v[138:139], v60 offset:5120
    ds_read_b64_tr_b16 v[140:141], v60 offset:64
    ds_read_b64_tr_b16 v[142:143], v60 offset:5184
    ds_read_b64_tr_b16 v[144:145], v60 offset:128
    ds_read_b64_tr_b16 v[146:147], v60 offset:5248
    ds_read_b64_tr_b16 v[148:149], v60 offset:192
    ds_read_b64_tr_b16 v[150:151], v60 offset:5312
    ds_read_b64_tr_b16 v[152:153], v60 offset:256
    ds_read_b64_tr_b16 v[154:155], v60 offset:5376
    ds_read_b64_tr_b16 v[156:157], v60 offset:320
    ds_read_b64_tr_b16 v[158:159], v60 offset:5440
    ds_read_b64_tr_b16 v[160:161], v60 offset:384
    ds_read_b64_tr_b16 v[162:163], v60 offset:5504
    ds_read_b64_tr_b16 v[164:165], v60 offset:448
    ds_read_b64_tr_b16 v[166:167], v60 offset:5568
    ds_read_b64_tr_b16 v[168:169], v60 offset:512
    ds_read_b64_tr_b16 v[170:171], v60 offset:5632
    ds_read_b64_tr_b16 v[172:173], v60 offset:576
    ds_read_b64_tr_b16 v[174:175], v60 offset:5696
    s_waitcnt lgkmcnt(0)
    v_lshlrev_b32 v96, 16, v136
    v_and_b32 v97, 0xffff0000, v136
    v_lshlrev_b32 v98, 16, v137
    v_and_b32 v99, 0xffff0000, v137
    v_lshlrev_b32 v100, 16, v138
    v_and_b32 v101, 0xffff0000, v138
    v_lshlrev_b32 v102, 16, v139
    v_and_b32 v103, 0xffff0000, v139
    v_lshlrev_b32 v104, 16, v140
    v_and_b32 v105, 0xffff0000, v140
    v_lshlrev_b32 v106, 16, v141
    v_and_b32 v107, 0xffff0000, v141
    v_lshlrev_b32 v108, 16, v142
    v_and_b32 v109, 0xffff0000, v142
    v_lshlrev_b32 v110, 16, v143
    v_and_b32 v111, 0xffff0000, v143
    v_lshlrev_b32 v112, 16, v144
    v_and_b32 v113, 0xffff0000, v144
    v_lshlrev_b32 v114, 16, v145
    v_and_b32 v115, 0xffff0000, v145
    v_lshlrev_b32 v116, 16, v146
    v_and_b32 v117, 0xffff0000, v146
    v_lshlrev_b32 v118, 16, v147
    v_and_b32 v119, 0xffff0000, v147
    v_lshlrev_b32 v120, 16, v148
    v_and_b32 v121, 0xffff0000, v148
    v_lshlrev_b32 v122, 16, v149
    v_and_b32 v123, 0xffff0000, v149
    v_lshlrev_b32 v124, 16, v150
    v_and_b32 v125, 0xffff0000, v150
    v_lshlrev_b32 v126, 16, v151
    v_and_b32 v127, 0xffff0000, v151
    buffer_load_dwordx4 v[76:79], v72, s[8:11], s67 offen sc1
    s_mov_b64 exec, 0
    s_cmp_eq_u32 s20, 0
    s_cbranch_scc1 K2_PAD_U20
    s_cmp_eq_u32 s20, 1
    s_cbranch_scc1 K2_PAD_U30
    s_cmp_eq_u32 s20, 2
    s_cbranch_scc1 K2_PAD_U21
    s_cmp_eq_u32 s20, 3
    s_cbranch_scc1 K2_PAD_U31
    s_cmp_eq_u32 s20, 7
    s_cbranch_scc1 K2_PAD_SW
    s_cmp_eq_u32 s20, 5
    s_cbranch_scc1 K2_PAD_TL
    s_cmp_eq_u32 s20, 6
    s_cbranch_scc1 K2_PAD_T2
K2_HOP:
    s_mov_b64 exec, -1
    v_lshlrev_b32 v128, 16, v152
    v_and_b32 v129, 0xffff0000, v152
    v_lshlrev_b32 v130, 16, v153
    v_and_b32 v131, 0xffff0000, v153
    v_lshlrev_b32 v132, 16, v154
    v_and_b32 v133, 0xffff0000, v154
    v_lshlrev_b32 v134, 16, v155
    v_and_b32 v135, 0xffff0000, v155
    v_lshlrev_b32 v136, 16, v156
    v_and_b32 v137, 0xffff0000, v156
    v_lshlrev_b32 v138, 16, v157
    v_and_b32 v139, 0xffff0000, v157
    v_lshlrev_b32 v140, 16, v158
    v_and_b32 v141, 0xffff0000, v158
    v_lshlrev_b32 v142, 16, v159
    v_and_b32 v143, 0xffff0000, v159
    v_lshlrev_b32 v144, 16, v160
    v_and_b32 v145, 0xffff0000, v160
    v_lshlrev_b32 v146, 16, v161
    v_and_b32 v147, 0xffff0000, v161
    v_lshlrev_b32 v148, 16, v162
    v_and_b32 v149, 0xffff0000, v162
    v_lshlrev_b32 v150, 16, v163
    v_and_b32 v151, 0xffff0000, v163
    v_lshlrev_b32 v152, 16, v164
    v_and_b32 v153, 0xffff0000, v164
    v_lshlrev_b32 v154, 16, v165
    v_and_b32 v155, 0xffff0000, v165
    v_lshlrev_b32 v156, 16, v166
    v_and_b32 v157, 0xffff0000, v166
    v_lshlrev_b32 v158, 16, v167
    v_and_b32 v159, 0xffff0000, v167
    v_lshlrev_b32 v160, 16, v168
    v_and_b32 v161, 0xffff0000, v168
    v_lshlrev_b32 v162, 16, v169
    v_and_b32 v163, 0xffff0000, v169
    v_lshlrev_b32 v164, 16, v170
    v_and_b32 v165, 0xffff0000, v170
    v_lshlrev_b32 v166, 16, v171
    v_and_b32 v167, 0xffff0000, v171
    v_lshlrev_b32 v168, 16, v172
    v_and_b32 v169, 0xffff0000, v172
    v_lshlrev_b32 v170, 16, v173
    v_and_b32 v171, 0xffff0000, v173
    v_lshlrev_b32 v172, 16, v174
    v_and_b32 v173, 0xffff0000, v174
    v_lshlrev_b32 v174, 16, v175
    v_and_b32 v175, 0xffff0000, v175
K2_W0:
    s_lshl_b32 s59, s2, 22
    s_mov_b32 s60, 0x40000
    s_bfe_u32 s61, s54, 0x10004
    s_bfe_u32 s62, s54, 0x10003
    s_add_u32 s63, s61, s62
    s_mul_i32 s62, s62, 11
    s_sub_u32 s64, 11, s62
    v_cmp_gt_u32 vcc, 500, v177
    s_nop 0
    s_mov_b64 s[56:57], vcc
K2_POLL:
    s_waitcnt vmcnt(0)
    v_xor_b32 v73, s59, v76
    v_xor_b32 v74, s59, v77
    v_or_b32 v73, v73, v74
    v_xor_b32 v74, s2, v79
    v_lshrrev_b32 v73, 22, v73
    v_or_b32 v73, v73, v74
    v_cmp_ne_u32 vcc, 0, v73
    s_nop 0
    s_cbranch_vccz K2_POLLED
    s_sub_u32 s60, s60, 1
    s_cbranch_scc1 K2_END
    s_mov_b64 exec, vcc
    buffer_load_dwordx4 v[76:79], v72, s[8:11], s67 offen sc1
    s_mov_b64 exec, -1
    s_branch K2_POLL
K2_PAD_LD:
    s_branch KS_HOP
K2_POLLED:
    s_set_gpr_idx_on s61, gpr_idx(SRC0)
    s_nop 0
    v_bfe_u32 v179, v76, s62, 11
    s_set_gpr_idx_idx s63
    s_nop 0
    v_bfe_u32 v73, v76, s64, 11
    s_set_gpr_idx_off
    v_sub_u32 v73, v73, v179
    v_cndmask_b32 v73, 0, v73, s[56:57]
    v_and_b32 v1, 1, v177
    v_add_u32 v1, s23, v1
    v_sub_u32 v180, v73, v1
    v_add_u32 v179, v179, v1
    v_mul_u32_u24 v181, 20608, v178
    v_lshl_add_u32 v181, v179, 4, v181
    v_cmp_lt_i32 s[40:41], 0, v180
    v_add_u32 v182, 32, v181
    s_mov_b32 s65, 0
    s_mov_b64 exec, s[40:41]
    buffer_load_dwordx4 v[0:3], v181, s[8:11], 0 offen offset:0 sc1
    s_mov_b64 exec, -1
    v_cmp_lt_i32 s[42:43], 2, v180
    v_cmp_lt_i32 s[44:45], 4, v180
    v_cmp_lt_i32 s[46:47], 6, v180
    v_cmp_lt_i32 s[48:49], 8, v180
    v_cmp_lt_i32 s[50:51], 10, v180
    v_cmp_lt_i32 s[90:91], 12, v180
    v_cmp_lt_i32 s[92:93], 14, v180
    v_cmp_lt_i32 s[94:95], 16, v180
    v_cmp_lt_i32 s[96:97], 18, v180
    v_add_u32 v183, 64, v181
    v_add_u32 v184, 96, v181
    v_subrev_u32 v62, 1, v180
    v_ashrrev_i32 v62, 1, v62
    v_med3_i32 v62, v62, 0, 9
    s_cmp_eq_u64 s[42:43], 0
    s_cbranch_scc1 K2_LD_DONE
    v_mov_b32 v63, v62
    s_nop 1
    v_add_u32_dpp v63, v63, v63 row_shr:1 row_mask:0xf bank_mask:0xf bound_ctrl:0
    s_nop 1
    v_add_u32_dpp v63, v63, v63 row_shr:2 row_mask:0xf bank_mask:0xf bound_ctrl:0
    s_nop 1
    v_add_u32_dpp v63, v63, v63 row_shr:4 row_mask:0xf bank_mask:0xf bound_ctrl:0
    s_nop 1
    v_add_u32_dpp v63, v63, v63 row_shr:8 row_mask:0xf bank_mask:0xf bound_ctrl:0
    s_nop 1
    v_add_u32_dpp v63, v63, v63 row_bcast:15 row_mask:0xa bank_mask:0xf
    s_nop 1
    v_add_u32_dpp v63, v63, v63 row_bcast:31 row_mask:0xc bank_mask:0xf
    s_lshl_b32 s58, s20, 10
    s_add_u32 s58, s58, 45056
    v_readlane_b32 s59, v63, 63
    v_sub_u32 v63, v63, v62
    v_lshl_add_u32 v64, v63, 2, s58
    v_lshlrev_b32 v63, 5, v63
    v_sub_u32 v63, v182, v63
    s_cmp_gt_u32 s59, 189
    s_cbranch_scc1 K2_LD_GEN
    s_mov_b64 exec, s[42:43]
    s_cbranch_execz K2_LD_L
    ds_write_b32 v64, v63 offset:0
    s_mov_b64 exec, s[44:45]
    s_cbranch_execz K2_LD_L
    ds_write_b32 v64, v63 offset:4
    s_mov_b64 exec, s[46:47]
    s_cbranch_execz K2_LD_L
    ds_write_b32 v64, v63 offset:8
    s_mov_b64 exec, s[48:49]
    s_cbranch_execz K2_LD_L
    ds_write_b32 v64, v63 offset:12
    s_mov_b64 exec, s[50:51]
    s_cbranch_execz K2_LD_L
    ds_write_b32 v64, v63 offset:16
    s_mov_b64 exec, s[90:91]
    s_cbranch_execz K2_LD_L
    ds_write_b32 v64, v63 offset:20
    s_mov_b64 exec, s[92:93]
    s_cbranch_execz K2_LD_L
    ds_write_b32 v64, v63 offset:24
    s_mov_b64 exec, s[94:95]
    s_cbranch_execz K2_LD_L
    ds_write_b32 v64, v63 offset:28
    s_mov_b64 exec, s[96:97]
    s_cbranch_execz K2_LD_L
    ds_write_b32 v64, v63 offset:32
K2_LD_L:
    s_mov_b64 exec, -1
    v_lshl_add_u32 v63, v176, 2, s58
    v_lshlrev_b32 v62, 5, v176
    s_waitcnt lgkmcnt(0)
    ds_read_b32 v64, v63 offset:0
    ds_read_b32 v65, v63 offset:252
    ds_read_b32 v66, v63 offset:504
    s_min_u32 s60, s59, 63
    s_sub_u32 s59, s59, s60
    s_bfm_b64 s[42:43], s60, 0
    s_min_u32 s60, s59, 63
    s_sub_u32 s59, s59, s60
    s_bfm_b64 s[44:45], s60, 0
    s_min_u32 s60, s59, 63
    s_sub_u32 s59, s59, s60
    s_bfm_b64 s[46:47], s60, 0
    s_mov_b64 s[48:49], 0
    s_mov_b32 s65, 1
    s_mov_b32 s60, 0
    s_waitcnt lgkmcnt(2)
    v_add3_u32 v182, v62, v64, s60
    s_mov_b64 exec, s[42:43]
    buffer_load_dwordx4 v[4:7], v182, s[8:11], 0 offen sc1
    s_mov_b32 s60, 2016
    s_waitcnt lgkmcnt(1)
    v_add3_u32 v183, v62, v65, s60
    s_mov_b64 exec, s[44:45]
    buffer_load_dwordx4 v[8:11], v183, s[8:11], 0 offen sc1
    s_mov_b32 s60, 4032
    s_waitcnt lgkmcnt(0)
    v_add3_u32 v184, v62, v66, s60
    s_mov_b64 exec, s[46:47]
    buffer_load_dwordx4 v[12:15], v184, s[8:11], 0 offen sc1
K2_LD_DONE:
    s_mov_b64 exec, -1
    s_cmp_eq_u32 s28, 0
    s_cbranch_scc1 K2_WLATE
K2_NOWRAW:
K2_PAD_NW:
    s_cbranch_execz KS_HOP
    v_lshrrev_b32 v179, 2, v181
    v_lshrrev_b32 v185, 2, v182
    v_lshrrev_b32 v186, 2, v183
    v_lshrrev_b32 v187, 2, v184
    s_mov_b32 s66, 7340032
    v_mov_b32 v201, 1
    s_movk_i32 s58, 520
    s_movk_i32 s59, 2080
    s_mov_b32 s60, 0x40000
    s_mov_b32 s61, 0xffff
    v_mov_b32 v202, 65536
    s_cmp_lg_u32 s24, 0
    s_cbranch_scc1 K2_RK_LOAD
    v_cmp_lt_i32 vcc, 20, v180
    s_nop 0
    s_cbranch_vccz K2_NOMORE
    v_mov_b32 v61, 163304
    ds_write_b32 v61, v201
K2_NOMORE:
    s_mov_b32 s62, 82176
    s_cmp_eq_u32 s65, 0
    s_waitcnt vmcnt(3)
    s_cbranch_scc0 K2_ARR
    s_waitcnt vmcnt(0)
K2_ARR:
    s_mov_b64 exec, s[40:41]
    s_cbranch_execz K2_RK_A
K2_CK0:
    v_bfi_b32 v192, s61, v1, v2
    v_lshrrev_b32 v50, 24, v3
    v_cmp_ne_u32 vcc, s2, v192
    v_add_u32 v40, 163072, v50
    s_cbranch_vccnz K2_RT0
    ds_add_rtn_u32 v40, v40, v201
    v_mad_u32_u24 v50, v50, s58, v202
    s_mov_b64 exec, s[42:43]
    s_cbranch_execz K2_RK_A
    s_waitcnt vmcnt(2)
K2_CK1:
    v_bfi_b32 v192, s61, v5, v6
    v_lshrrev_b32 v51, 24, v7
    v_cmp_ne_u32 vcc, s2, v192
    v_add_u32 v41, 163072, v51
    s_cbranch_vccnz K2_RT1
    ds_add_rtn_u32 v41, v41, v201
    v_mad_u32_u24 v51, v51, s58, v202
    s_mov_b64 exec, s[44:45]
    s_cbranch_execz K2_RK_A
    s_waitcnt vmcnt(1)
K2_CK2:
    v_bfi_b32 v192, s61, v9, v10
    v_lshrrev_b32 v52, 24, v11
    v_cmp_ne_u32 vcc, s2, v192
    v_add_u32 v42, 163072, v52
    s_cbranch_vccnz K2_RT2
    ds_add_rtn_u32 v42, v42, v201
    v_mad_u32_u24 v52, v52, s58, v202
    s_mov_b64 exec, s[46:47]
    s_cbranch_execz K2_RK_A
    s_waitcnt vmcnt(0)
K2_CK3:
    v_bfi_b32 v192, s61, v13, v14
    v_lshrrev_b32 v53, 24, v15
    v_cmp_ne_u32 vcc, s2, v192
    v_add_u32 v43, 163072, v53
    s_cbranch_vccnz K2_RT3
    ds_add_rtn_u32 v43, v43, v201
    v_mad_u32_u24 v53, v53, s58, v202
    s_mov_b64 exec, s[48:49]
    s_cbranch_execz K2_RK_A
K2_CK4:
    v_bfi_b32 v192, s61, v17, v18
    v_lshrrev_b32 v54, 24, v19
    v_cmp_ne_u32 vcc, s2, v192
    v_add_u32 v44, 163072, v54
    s_cbranch_vccnz K2_RT4
    ds_add_rtn_u32 v44, v44, v201
    v_mad_u32_u24 v54, v54, s58, v202
    s_mov_b64 exec, s[50:51]
    s_cbranch_execz K2_RK_A
K2_CK5:
    v_bfi_b32 v192, s61, v21, v22
    v_lshrrev_b32 v55, 24, v23
    v_cmp_ne_u32 vcc, s2, v192
    v_add_u32 v45, 163072, v55
    s_cbranch_vccnz K2_RT5
    ds_add_rtn_u32 v45, v45, v201
    v_mad_u32_u24 v55, v55, s58, v202
    s_mov_b64 exec, s[90:91]
    s_cbranch_execz K2_RK_A
K2_CK6:
    v_bfi_b32 v192, s61, v25, v26
    v_lshrrev_b32 v56, 24, v27
    v_cmp_ne_u32 vcc, s2, v192
    v_add_u32 v46, 163072, v56
    s_cbranch_vccnz K2_RT6
    ds_add_rtn_u32 v46, v46, v201
    v_mad_u32_u24 v56, v56, s58, v202
    s_mov_b64 exec, s[92:93]
    s_cbranch_execz K2_RK_A
K2_CK7:
    v_bfi_b32 v192, s61, v29, v30
    v_lshrrev_b32 v57, 24, v31
    v_cmp_ne_u32 vcc, s2, v192
    v_add_u32 v47, 163072, v57
    s_cbranch_vccnz K2_RT7
    ds_add_rtn_u32 v47, v47, v201
    v_mad_u32_u24 v57, v57, s58, v202
    s_mov_b64 exec, s[94:95]
    s_cbranch_execz K2_RK_A
K2_CK8:
    v_bfi_b32 v192, s61, v33, v34
    v_lshrrev_b32 v58, 24, v35
    v_cmp_ne_u32 vcc, s2, v192
    v_add_u32 v48, 163072, v58
    s_cbranch_vccnz K2_RT8
    ds_add_rtn_u32 v48, v48, v201
    v_mad_u32_u24 v58, v58, s58, v202
    s_mov_b64 exec, s[96:97]
    s_cbranch_execz K2_RK_A
K2_CK9:
    v_bfi_b32 v192, s61, v37, v38
    v_lshrrev_b32 v59, 24, v39
    v_cmp_ne_u32 vcc, s2, v192
    v_add_u32 v49, 163072, v59
    s_cbranch_vccnz K2_RT9
    ds_add_rtn_u32 v49, v49, v201
    v_mad_u32_u24 v59, v59, s58, v202
K2_RK_A:
    s_mov_b64 exec, -1
    s_mov_b64 exec, s[40:41]
    s_cbranch_execz K2_TP
    v_cmp_gt_u32 vcc, s62, v50
    v_and_b32 v3, 0xffffff, v3
    s_mov_b64 exec, vcc
    buffer_load_dword v245, v3, s[16:19], 0 offen
    s_mov_b64 exec, s[42:43]
    s_cbranch_execz K2_TP
    v_cmp_gt_u32 vcc, s62, v51
    v_and_b32 v7, 0xffffff, v7
    s_mov_b64 exec, vcc
    buffer_load_dword v245, v7, s[16:19], 0 offen
    s_mov_b64 exec, s[44:45]
    s_cbranch_execz K2_TP
    v_cmp_gt_u32 vcc, s62, v52
    v_and_b32 v11, 0xffffff, v11
    s_mov_b64 exec, vcc
    buffer_load_dword v245, v11, s[16:19], 0 offen
    s_mov_b64 exec, s[46:47]
    s_cbranch_execz K2_TP
    v_cmp_gt_u32 vcc, s62, v53
    v_and_b32 v15, 0xffffff, v15
    s_mov_b64 exec, vcc
    buffer_load_dword v245, v15, s[16:19], 0 offen
    s_mov_b64 exec, s[48:49]
    s_cbranch_execz K2_TP
    v_cmp_gt_u32 vcc, s62, v54
    v_and_b32 v19, 0xffffff, v19
    s_mov_b64 exec, vcc
    buffer_load_dword v245, v19, s[16:19], 0 offen
    s_mov_b64 exec, s[50:51]
    s_cbranch_execz K2_TP
    v_cmp_gt_u32 vcc, s62, v55
    v_and_b32 v23, 0xffffff, v23
    s_mov_b64 exec, vcc
    buffer_load_dword v245, v23, s[16:19], 0 offen
    s_mov_b64 exec, s[90:91]
    s_cbranch_execz K2_TP
    v_cmp_gt_u32 vcc, s62, v56
    v_and_b32 v27, 0xffffff, v27
    s_mov_b64 exec, vcc
    buffer_load_dword v245, v27, s[16:19], 0 offen
    s_mov_b64 exec, s[92:93]
    s_cbranch_execz K2_TP
    v_cmp_gt_u32 vcc, s62, v57
    v_and_b32 v31, 0xffffff, v31
    s_mov_b64 exec, vcc
    buffer_load_dword v245, v31, s[16:19], 0 offen
    s_mov_b64 exec, s[94:95]
    s_cbranch_execz K2_TP
    v_cmp_gt_u32 vcc, s62, v58
    v_and_b32 v35, 0xffffff, v35
    s_mov_b64 exec, vcc
    buffer_load_dword v245, v35, s[16:19], 0 offen
    s_mov_b64 exec, s[96:97]
    s_cbranch_execz K2_TP
    v_cmp_gt_u32 vcc, s62, v59
    v_and_b32 v39, 0xffffff, v39
    s_mov_b64 exec, vcc
    buffer_load_dword v245, v39, s[16:19], 0 offen
K2_TP:
    s_mov_b64 exec, -1
K2_RK_DONE:
K2_PAD_SC:
    s_cbranch_execz KS_HOP
    s_mul_i32 s67, s24, 48
    s_movk_i32 s58, -1532
    s_waitcnt lgkmcnt(0)
    s_mov_b64 exec, s[40:41]
    s_cbranch_execz K2_SC_DONE
    v_cmpx_gt_u32 vcc, 64, v40
    v_bfe_u32 v194, v40, 3, 1
    v_add_u32 v193, 16, v40
    v_lshl_or_b32 v194, v40, 1, v194
    v_bfi_b32 v194, 15, v194, v40
    v_lshrrev_b32 v193, 6, v193
    v_alignbit_b32 v1, v2, v1, 16
    v_lshl_add_u32 v195, v194, 3, v50
    v_lshl_add_u32 v194, v194, 5, v50
    ds_write_b64 v195, v[0:1]
    v_mad_i32_i24 v194, v193, s58, v194
    ds_write_b32 v194, v3 offset:512
    s_mov_b64 exec, s[42:43]
    s_cbranch_execz K2_SC_DONE
    v_cmpx_gt_u32 vcc, 64, v41
    v_bfe_u32 v194, v41, 3, 1
    v_add_u32 v193, 16, v41
    v_lshl_or_b32 v194, v41, 1, v194
    v_bfi_b32 v194, 15, v194, v41
    v_lshrrev_b32 v193, 6, v193
    v_alignbit_b32 v5, v6, v5, 16
    v_lshl_add_u32 v195, v194, 3, v51
    v_lshl_add_u32 v194, v194, 5, v51
    ds_write_b64 v195, v[4:5]
    v_mad_i32_i24 v194, v193, s58, v194
    ds_write_b32 v194, v7 offset:512
    s_mov_b64 exec, s[44:45]
    s_cbranch_execz K2_SC_DONE
    v_cmpx_gt_u32 vcc, 64, v42
    v_bfe_u32 v194, v42, 3, 1
    v_add_u32 v193, 16, v42
    v_lshl_or_b32 v194, v42, 1, v194
    v_bfi_b32 v194, 15, v194, v42
    v_lshrrev_b32 v193, 6, v193
    v_alignbit_b32 v9, v10, v9, 16
    v_lshl_add_u32 v195, v194, 3, v52
    v_lshl_add_u32 v194, v194, 5, v52
    ds_write_b64 v195, v[8:9]
    v_mad_i32_i24 v194, v193, s58, v194
    ds_write_b32 v194, v11 offset:512
    s_mov_b64 exec, s[46:47]
    s_cbranch_execz K2_SC_DONE
    v_cmpx_gt_u32 vcc, 64, v43
    v_bfe_u32 v194, v43, 3, 1
    v_add_u32 v193, 16, v43
    v_lshl_or_b32 v194, v43, 1, v194
    v_bfi_b32 v194, 15, v194, v43
    v_lshrrev_b32 v193, 6, v193
    v_alignbit_b32 v13, v14, v13, 16
    v_lshl_add_u32 v195, v194, 3, v53
    v_lshl_add_u32 v194, v194, 5, v53
    ds_write_b64 v195, v[12:13]
    v_mad_i32_i24 v194, v193, s58, v194
    ds_write_b32 v194, v15 offset:512
    s_mov_b64 exec, s[48:49]
    s_cbranch_execz K2_SC_DONE
    v_cmpx_gt_u32 vcc, 64, v44
    v_bfe_u32 v194, v44, 3, 1
    v_add_u32 v193, 16, v44
    v_lshl_or_b32 v194, v44, 1, v194
    v_bfi_b32 v194, 15, v194, v44
    v_lshrrev_b32 v193, 6, v193
    v_alignbit_b32 v17, v18, v17, 16
    v_lshl_add_u32 v195, v194, 3, v54
    v_lshl_add_u32 v194, v194, 5, v54
    ds_write_b64 v195, v[16:17]
    v_mad_i32_i24 v194, v193, s58, v194
    ds_write_b32 v194, v19 offset:512
    s_mov_b64 exec, s[50:51]
    s_cbranch_execz K2_SC_DONE
    v_cmpx_gt_u32 vcc, 64, v45
    v_bfe_u32 v194, v45, 3, 1
    v_add_u32 v193, 16, v45
    v_lshl_or_b32 v194, v45, 1, v194
    v_bfi_b32 v194, 15, v194, v45
    v_lshrrev_b32 v193, 6, v193
    v_alignbit_b32 v21, v22, v21, 16
    v_lshl_add_u32 v195, v194, 3, v55
    v_lshl_add_u32 v194, v194, 5, v55
    ds_write_b64 v195, v[20:21]
    v_mad_i32_i24 v194, v193, s58, v194
    ds_write_b32 v194, v23 offset:512
    s_mov_b64 exec, s[90:91]
    s_cbranch_execz K2_SC_DONE
    v_cmpx_gt_u32 vcc, 64, v46
    v_bfe_u32 v194, v46, 3, 1
    v_add_u32 v193, 16, v46
    v_lshl_or_b32 v194, v46, 1, v194
    v_bfi_b32 v194, 15, v194, v46
    v_lshrrev_b32 v193, 6, v193
    v_alignbit_b32 v25, v26, v25, 16
    v_lshl_add_u32 v195, v194, 3, v56
    v_lshl_add_u32 v194, v194, 5, v56
    ds_write_b64 v195, v[24:25]
    v_mad_i32_i24 v194, v193, s58, v194
    ds_write_b32 v194, v27 offset:512
    s_mov_b64 exec, s[92:93]
    s_cbranch_execz K2_SC_DONE
    v_cmpx_gt_u32 vcc, 64, v47
    v_bfe_u32 v194, v47, 3, 1
    v_add_u32 v193, 16, v47
    v_lshl_or_b32 v194, v47, 1, v194
    v_bfi_b32 v194, 15, v194, v47
    v_lshrrev_b32 v193, 6, v193
    v_alignbit_b32 v29, v30, v29, 16
    v_lshl_add_u32 v195, v194, 3, v57
    v_lshl_add_u32 v194, v194, 5, v57
    ds_write_b64 v195, v[28:29]
    v_mad_i32_i24 v194, v193, s58, v194
    ds_write_b32 v194, v31 offset:512
    s_mov_b64 exec, s[94:95]
    s_cbranch_execz K2_SC_DONE
    v_cmpx_gt_u32 vcc, 64, v48
    v_bfe_u32 v194, v48, 3, 1
    v_add_u32 v193, 16, v48
    v_lshl_or_b32 v194, v48, 1, v194
    v_bfi_b32 v194, 15, v194, v48
    v_lshrrev_b32 v193, 6, v193
    v_alignbit_b32 v33, v34, v33, 16
    v_lshl_add_u32 v195, v194, 3, v58
    v_lshl_add_u32 v194, v194, 5, v58
    ds_write_b64 v195, v[32:33]
    v_mad_i32_i24 v194, v193, s58, v194
    ds_write_b32 v194, v35 offset:512
    s_mov_b64 exec, s[96:97]
    s_cbranch_execz K2_SC_DONE
    v_cmpx_gt_u32 vcc, 64, v49
    v_bfe_u32 v194, v49, 3, 1
    v_add_u32 v193, 16, v49
    v_lshl_or_b32 v194, v49, 1, v194
    v_bfi_b32 v194, 15, v194, v49
    v_lshrrev_b32 v193, 6, v193
    v_alignbit_b32 v37, v38, v37, 16
    v_lshl_add_u32 v195, v194, 3, v59
    v_lshl_add_u32 v194, v194, 5, v59
    ds_write_b64 v195, v[36:37]
    v_mad_i32_i24 v194, v193, s58, v194
    ds_write_b32 v194, v39 offset:512
K2_SC_DONE:
    s_mov_b64 exec, -1
K2_PAD_SD:
    s_cbranch_execz KS_HOP
    v_lshlrev_b32 v192, 2, v176
    v_add_u32 v192, 163072, v192
    v_mov_b32 v200, 163304
    s_cmp_eq_u32 s24, 0
    s_cselect_b32 s26, 64, 48
    s_waitcnt lgkmcnt(0)
    s_barrier
    ds_read_b32 v193, v192
    ds_read_b32 v200, v200
    v_cmp_gt_u32 s[56:57], s22, v176
    v_mad_u32_u24 v195, v176, s59, v202
    s_waitcnt lgkmcnt(0)
    v_cndmask_b32 v193, 0, v193, s[56:57]
    v_readfirstlane_b32 s27, v200
    v_cmp_lt_u32 s[62:63], 48, v193
    v_cmp_lt_u32 vcc, 64, v193
    s_bcnt1_i32_b64 s60, s[62:63]
    v_mbcnt_lo_u32_b32 v198, s62, 0
    v_mbcnt_hi_u32_b32 v198, s63, v198
    s_cbranch_vccnz K2_BIG
    s_cmp_gt_u32 s60, 8
    s_cbranch_scc1 K2_BIG
K2_TOK:
    v_subrev_u32 v194, s67, v193
    v_max_i32 v194, 1, v194
    v_min_i32 v194, s26, v194
    v_add_u32 v194, 15, v194
    v_lshrrev_b32 v194, 3, v194
    v_lshl_or_b32 v195, v194, 18, v195
    v_lshl_or_b32 v195, v198, 28, v195
    v_mov_b32 v197, 949760
    v_cndmask_b32 v253, v197, v195, s[56:57]
    s_movk_i32 s40, 0
    s_movk_i32 s41, 256
    s_movk_i32 s42, 512
    s_movk_i32 s43, 768
    s_add_u32 s24, s24, 1
    s_cmp_ge_u32 s24, s25
    s_cselect_b32 s55, 1, 0
    s_cmp_eq_u32 s27, 0
    s_cselect_b32 s55, s55, 0
    s_mov_b32 s27, 0x400000
    s_mov_b32 s38, 0
    s_mov_b32 s34, 0
    s_mov_b32 s35, 0
    s_mov_b32 s36, 1
    s_mov_b32 s31, 0
    s_mov_b32 s58, s20
    v_readlane_b32 s3, v253, s58
    s_lshl_b32 s44, s34, 7
    s_and_b32 s48, s3, 0x3ffff
    s_bfe_u32 s33, s3, 0x30013
    s_mul_i32 s35, s38, 6
    s_cmp_eq_u32 s34, 0
    s_cselect_b32 s35, s35, s48
    s_mov_b32 s45, s44
    s_xor_b32 s47, s44, 256
    s_add_u32 s49, s48, 128
    s_add_u32 s60, s48, 256
    s_cmp_eq_u32 s33, 3
    s_cselect_b32 s46, s44, s47
    s_cselect_b32 s50, s60, s48
    s_sub_u32 s60, s33, 2
    s_cmp_lt_u32 s60, 2
    s_cbranch_scc0 K2_rare_1
K2_back_2:
    v_add_u32 v233, s48, v230
    ds_read_b32 v232, v233
    ds_read_b32 v233, v233 offset:1024
    v_add_u32 v222, s48, v251
    ds_read2_b32 v[222:223], v222 offset0:1 offset1:3
    v_add_u32 v224, s49, v251
    ds_read2_b32 v[224:225], v224 offset0:1 offset1:3
    v_add_u32 v226, s50, v251
    ds_read2_b32 v[226:227], v226 offset0:1 offset1:3
    s_waitcnt lgkmcnt(3)
    v_or_b32 v232, v232, v231
    v_or_b32 v233, v233, v231
    s_cmp_lg_u32 s34, 0
    s_cbranch_scc1 K2_dum_4
    s_cmp_eq_u32 s33, 4
    s_cbranch_scc1 K2_a4_5
K2_b4_7:
    s_add_u32 m0, s48, 512
    s_add_u32 s65, s48, 1536
    buffer_load_dwordx4 v232, s[16:19], 0 offen  lds
    s_mov_b32 m0, s65
    s_mov_b32 exec_hi, 0
    buffer_load_dwordx4 v233, s[16:19], 0 offen  lds
    s_mov_b32 exec_hi, -1
K2_back_6:
    s_waitcnt lgkmcnt(2)
    v_mad_u32_u16 v222, v222, s39, v248 op_sel:[1,0,0,0]
    v_mad_u32_u16 v223, v223, s39, v248 op_sel:[1,0,0,0]
    s_waitcnt lgkmcnt(1)
    v_mad_u32_u16 v224, v224, s39, v248 op_sel:[1,0,0,0]
    v_mad_u32_u16 v225, v225, s39, v248 op_sel:[1,0,0,0]
    s_waitcnt lgkmcnt(0)
    v_mad_u32_u16 v226, v226, s39, v248 op_sel:[1,0,0,0]
    v_mad_u32_u16 v227, v227, s39, v248 op_sel:[1,0,0,0]
    s_mov_b32 m0, s68
    s_nop 0
    buffer_load_dwordx4 v222, s[4:7], s44 offen sc1 lds
    buffer_load_dwordx4 v223, s[72:75], s44 offen offset:1024 sc1 lds
    s_mov_b32 m0, s69
    s_nop 0
    buffer_load_dwordx4 v224, s[4:7], s45 offen sc1 lds
    buffer_load_dwordx4 v225, s[72:75], s45 offen offset:1024 sc1 lds
    s_mov_b32 m0, s70
    s_nop 0
    buffer_load_dwordx4 v226, s[4:7], s46 offen sc1 lds
    buffer_load_dwordx4 v227, s[72:75], s46 offen offset:1024 sc1 lds
    s_mov_b32 m0, s71
    s_cmp_eq_u32 s33, 4
    s_cbranch_scc1 K2_g4_8
    buffer_load_dwordx4 v224, s[4:7], s47 offen sc1 lds
    buffer_load_dwordx4 v225, s[72:75], s47 offen offset:1024 sc1 lds
K2_back_9:
    v_add_u32 v249, s48, v249
    v_add_u32 v250, s48, v250
    v_bfe_u32 v192, v253, 18, 4
    s_sub_u32 s58, s22, 16
    v_cmp_le_u32 vcc, 6, v192
    v_cmp_gt_u32 s[60:61], s58, v176
    s_nop 0
    s_or_b64 vcc, vcc, s[60:61]
    v_mbcnt_lo_u32_b32 v192, vcc_lo, 0
    v_mbcnt_hi_u32_b32 v192, vcc_hi, v192
    s_bcnt1_i32_b64 s58, vcc
    v_sub_u32 v193, v176, v192
    v_add_u32 v193, s58, v193
    v_cndmask_b32 v192, v193, v192, vcc
    v_lshlrev_b32 v192, 2, v192
    ds_permute_b32 v193, v192, v176
    s_waitcnt lgkmcnt(0)
    v_lshl_or_b32 v253, v193, 22, v253
    s_waitcnt vmcnt(6)
    ds_read_b64_tr_b16 v[176:177], v246 offset:0
    ds_read_b64_tr_b16 v[178:179], v246 offset:1024
    ds_read_b64_tr_b16 v[180:181], v247 offset:0
    ds_read_b64_tr_b16 v[182:183], v247 offset:1024
    ds_read_b64_tr_b16 v[0:1], v249 offset:0
    ds_read_b64_tr_b16 v[2:3], v249 offset:32
    ds_read_u16_d16_hi v16, v250 offset:0
    ds_read_b64_tr_b16 v[4:5], v249 offset:512
    ds_read_b64_tr_b16 v[6:7], v249 offset:544
    ds_read_u16_d16_hi v17, v250 offset:128
    s_mov_b32 s29, s48
    s_mov_b32 s32, s31
    s_mov_b32 s30, s3
    s_mov_b32 s31, s35
    s_bfe_u32 s56, s3, 0x40012
    s_cmp_eq_u32 s56, 5
    s_cbranch_scc1 K2_U20
    s_cmp_eq_u32 s56, 6
    s_cbranch_scc1 K2_U3h0
    s_branch K2_DSP0
K2_PAD_H1:
    s_branch KS_HOP0
KS_HELP:
    s_mov_b32 s30, 0
    s_cmp_eq_u32 s20, 6
    s_cbranch_scc1 KS_RAW
    s_mov_b32 s30, 2
    s_cmp_ge_u32 s2, 170
    s_cbranch_scc1 KS_NOW
    s_mov_b32 s30, 1
    v_and_b32 v1, 15, v8
    v_lshrrev_b32 v3, 4, v8
    s_cmp_ge_u32 s2, 160
    s_cbranch_scc1 K1_WT
    s_cmp_ge_u32 s2, 64
    s_cbranch_scc1 K1_S1
    s_lshr_b32 s24, s2, 3
    s_and_b32 s25, s2, 7
    s_lshr_b32 s26, s25, 2
    s_bfe_u32 s27, s25, 0x10001
    s_and_b32 s28, s25, 1
    s_mov_b32 s60, s92
    s_and_b32 s61, s93, 0xffff
    s_mov_b32 s62, 65536
    s_mov_b32 s63, 0x20000
    s_branch K1_SC
K1_S1:
    s_sub_u32 s29, s2, 64
    s_mul_i32 s24, s29, 43
    s_lshr_b32 s24, s24, 9
    s_mul_i32 s25, s24, 12
    s_sub_u32 s25, s29, s25
    s_cmp_ge_u32 s25, 6
    s_cselect_b32 s26, 1, 0
    s_mul_i32 s27, s26, 6
    s_sub_u32 s27, s25, s27
    s_lshr_b32 s27, s27, 1
    s_and_b32 s28, s25, 1
    s_add_u32 s25, s25, 8
    s_mov_b32 s60, s94
    s_and_b32 s61, s95, 0xffff
    s_mov_b32 s62, 98304
    s_mov_b32 s63, 0x20000
K1_SC:
    s_lshl_b32 s27, s27, 7
    s_lshl_b32 s26, s26, 6
    s_lshl_b32 s28, s28, 4
    s_add_u32 s27, s27, s26
    s_add_u32 s27, s27, s28
    s_lshl_b32 s27, s27, 8
    s_lshl_b32 s26, s24, 5
    s_add_u32 s27, s27, s26
    s_add_u32 s29, s27, 8192
    v_lshlrev_b32 v3, 10, v3
    v_lshl_add_u32 v3, v1, 1, v3
    buffer_load_ushort v64, v3, s[60:63], s27 offen offset:0
    buffer_load_ushort v65, v3, s[60:63], s29 offen offset:0
    buffer_load_ushort v66, v3, s[60:63], s27 offen offset:256
    buffer_load_ushort v67, v3, s[60:63], s29 offen offset:256
    buffer_load_ushort v68, v3, s[60:63], s27 offen offset:512
    buffer_load_ushort v69, v3, s[60:63], s29 offen offset:512
    buffer_load_ushort v70, v3, s[60:63], s27 offen offset:768
    buffer_load_ushort v71, v3, s[60:63], s29 offen offset:768
    s_mul_i32 s24, s24, 20
    s_add_u32 s24, s24, s25
    s_lshl_b32 s24, s24, 10
    s_add_u32 s24, s24, 6946816
    s_branch K1_GO
K1_WT:
    s_sub_u32 s24, s2, 160
    s_lshr_b32 s27, s24, 1
    s_and_b32 s28, s24, 1
    s_lshl_b32 s27, s27, 8
    s_lshl_b32 s28, s28, 6
    s_add_u32 s27, s27, s28
    s_add_u32 s29, s27, 10240
    s_mov_b32 s60, s90
    s_and_b32 s61, s91, 0xffff
    s_mov_b32 s62, 20480
    s_mov_b32 s63, 0x20000
    v_and_b32 v1, 31, v8
    v_lshrrev_b32 v3, 5, v8
    v_mul_u32_u24 v3, 5120, v3
    v_lshl_add_u32 v3, v1, 1, v3
    buffer_load_ushort v64, v3, s[60:63], s27 offen offset:0
    buffer_load_ushort v65, v3, s[60:63], s27 offen offset:1280
    buffer_load_ushort v66, v3, s[60:63], s27 offen offset:2560
    buffer_load_ushort v67, v3, s[60:63], s27 offen offset:3840
    buffer_load_ushort v68, v3, s[60:63], s29 offen offset:0
    buffer_load_ushort v69, v3, s[60:63], s29 offen offset:1280
    buffer_load_ushort v70, v3, s[60:63], s29 offen offset:2560
    buffer_load_ushort v71, v3, s[60:63], s29 offen offset:3840
    s_lshl_b32 s24, s24, 10
    s_add_u32 s24, s24, 7110656
K1_GO:
KS_NOW:
    s_barrier
K2_PAD_H2:
    s_cbranch_execz KS_HOP0
    v_and_b32 v76, 31, v8
    v_lshrrev_b32 v77, 5, v8
    v_mov_b32 v80, 0
    v_mul_u32_u24 v77, 2080, v77
    v_mov_b32 v81, 0xffff0000
    v_lshl_add_u32 v78, v76, 4, v77
    v_mov_b32 v82, 0
    v_add_u32 v78, 65536, v78
    v_mov_b32 v83, v81
    v_add_u32 v79, 41600, v78
    ds_write_b128 v78, v[80:83] offset:0
    ds_write_b128 v78, v[80:83] offset:4160
    ds_write_b128 v78, v[80:83] offset:8320
    ds_write_b128 v78, v[80:83] offset:12480
    ds_write_b128 v78, v[80:83] offset:16640
    ds_write_b128 v78, v[80:83] offset:20800
    ds_write_b128 v78, v[80:83] offset:24960
    ds_write_b128 v78, v[80:83] offset:29120
    ds_write_b128 v78, v[80:83] offset:33280
    ds_write_b128 v78, v[80:83] offset:37440
    ds_write_b128 v79, v[80:83] offset:0
    ds_write_b128 v79, v[80:83] offset:4160
    ds_write_b128 v79, v[80:83] offset:8320
    ds_write_b128 v79, v[80:83] offset:12480
    ds_write_b128 v79, v[80:83] offset:16640
    ds_write_b128 v79, v[80:83] offset:20800
    ds_write_b128 v79, v[80:83] offset:24960
    ds_write_b128 v79, v[80:83] offset:29120
    ds_write_b128 v79, v[80:83] offset:33280
    ds_write_b128 v79, v[80:83] offset:37440
KS_FILL:
    v_mov_b32 v59, 163456
    s_barrier
    ds_read_b32 v59, v59
    s_waitcnt vmcnt(0) lgkmcnt(0)
    s_cmp_eq_u32 s30, 0
    s_cbranch_scc1 KS_B3
    s_cmp_eq_u32 s30, 2
    s_cbranch_scc1 KS_NOST
    v_lshl_or_b32 v40, v65, 16, v64
    v_lshl_or_b32 v41, v67, 16, v66
    v_lshl_or_b32 v42, v69, 16, v68
    v_lshl_or_b32 v43, v71, 16, v70
    buffer_store_dwordx4 v[40:43], v9, s[8:11], s24 offen sc1
KS_NOST:
    v_mov_b32 v62, 163460
    s_waitcnt lgkmcnt(0)
    s_barrier
    ds_read_b32 v62, v62
    s_lshl_b32 s24, s2, 2
    s_add_u32 s24, s24, 7176192
    s_mov_b64 exec, 1
    s_waitcnt vmcnt(0)
    buffer_store_dword v59, v6, s[8:11], s24 offen sc1
    s_mov_b64 exec, -1
    s_branch KS_JOIN
K2_PAD_H3:
    s_branch KS_HOP0
KS_RAW:
    s_cmp_lg_u32 s2, 0
    s_cbranch_scc1 KS_NOX
    s_mov_b32 s60, s98
    s_and_b32 s61, s99, 0xffff
    s_mov_b32 s62, 256
    s_mov_b32 s63, 0x20000
    s_getreg_b32 s24, hwreg(HW_REG_XCC_ID, 0, 1)
    s_add_u32 s24, s24, 1
    v_mov_b32 v10, s24
    v_mov_b32 v11, 0
    s_mov_b64 exec, 1
    buffer_atomic_cmpswap v[10:11], v6, s[60:63], 0 offen sc1
    s_mov_b64 exec, -1
KS_NOX:
    s_barrier
    s_mov_b32 s60, s90
    s_and_b32 s61, s91, 0xffff
    s_mov_b32 s62, 20480
    s_mov_b32 s63, 0x20000
    v_lshrrev_b32 v10, 3, v8
    v_and_b32 v11, 7, v8
    v_lshlrev_b32 v10, 8, v10
    v_lshl_add_u32 v10, v11, 4, v10
    s_mov_b32 m0, 24576
    s_movk_i32 s24, 0
    buffer_load_dwordx4 v10, s[60:63], s24 offen lds
    s_mov_b32 m0, 25600
    s_movk_i32 s24, 2048
    buffer_load_dwordx4 v10, s[60:63], s24 offen lds
    s_mov_b32 m0, 26624
    s_movk_i32 s24, 4096
    buffer_load_dwordx4 v10, s[60:63], s24 offen lds
    s_mov_b32 m0, 27648
    s_movk_i32 s24, 6144
    buffer_load_dwordx4 v10, s[60:63], s24 offen lds
    s_mov_b32 m0, 28672
    s_movk_i32 s24, 8192
    buffer_load_dwordx4 v10, s[60:63], s24 offen lds
    s_mov_b32 m0, 29696
    s_movk_i32 s24, 10240
    buffer_load_dwordx4 v10, s[60:63], s24 offen lds
    s_mov_b32 m0, 30720
    s_movk_i32 s24, 12288
    buffer_load_dwordx4 v10, s[60:63], s24 offen lds
    s_mov_b32 m0, 31744
    s_movk_i32 s24, 14336
    buffer_load_dwordx4 v10, s[60:63], s24 offen lds
    s_mov_b32 m0, 32768
    s_movk_i32 s24, 16384
    buffer_load_dwordx4 v10, s[60:63], s24 offen lds
    s_mov_b32 m0, 33792
    s_movk_i32 s24, 18432
    buffer_load_dwordx4 v10, s[60:63], s24 offen lds
    s_mov_b32 m0, 152832
    s_movk_i32 s24, 128
    buffer_load_dwordx4 v10, s[60:63], s24 offen lds
    s_mov_b32 m0, 153856
    s_movk_i32 s24, 2176
    buffer_load_dwordx4 v10, s[60:63], s24 offen lds
    s_mov_b32 m0, 154880
    s_movk_i32 s24, 4224
    buffer_load_dwordx4 v10, s[60:63], s24 offen lds
    s_mov_b32 m0, 155904
    s_movk_i32 s24, 6272
    buffer_load_dwordx4 v10, s[60:63], s24 offen lds
    s_mov_b32 m0, 156928
    s_movk_i32 s24, 8320
    buffer_load_dwordx4 v10, s[60:63], s24 offen lds
    s_mov_b32 m0, 157952
    s_movk_i32 s24, 10368
    buffer_load_dwordx4 v10, s[60:63], s24 offen lds
    s_mov_b32 m0, 158976
    s_movk_i32 s24, 12416
    buffer_load_dwordx4 v10, s[60:63], s24 offen lds
    s_mov_b32 m0, 160000
    s_movk_i32 s24, 14464
    buffer_load_dwordx4 v10, s[60:63], s24 offen lds
    s_mov_b32 m0, 161024
    s_movk_i32 s24, 16512
    buffer_load_dwordx4 v10, s[60:63], s24 offen lds
    s_mov_b32 m0, 162048
    s_movk_i32 s24, 18560
    buffer_load_dwordx4 v10, s[60:63], s24 offen lds
    v_add_u32 v85, 16, v8
    v_lshlrev_b32 v84, 5, v8
    v_lshrrev_b32 v85, 6, v85
    v_mul_u32_u24 v85, 1532, v85
    v_sub_u32 v84, v84, v85
    v_mov_b32 v85, -1
    v_add_u32 v84, 66048, v84
    v_add_u32 v86, 41600, v84
    ds_write_b32 v84, v85 offset:0
    ds_write_b32 v84, v85 offset:2080
    ds_write_b32 v84, v85 offset:4160
    ds_write_b32 v84, v85 offset:6240
    ds_write_b32 v84, v85 offset:8320
    ds_write_b32 v84, v85 offset:10400
    ds_write_b32 v84, v85 offset:12480
    ds_write_b32 v84, v85 offset:14560
    ds_write_b32 v84, v85 offset:16640
    ds_write_b32 v84, v85 offset:18720
    ds_write_b32 v84, v85 offset:20800
    ds_write_b32 v84, v85 offset:22880
    ds_write_b32 v84, v85 offset:24960
    ds_write_b32 v84, v85 offset:27040
    ds_write_b32 v84, v85 offset:29120
    ds_write_b32 v84, v85 offset:31200
    ds_write_b32 v84, v85 offset:33280
    ds_write_b32 v84, v85 offset:35360
    ds_write_b32 v84, v85 offset:37440
    ds_write_b32 v84, v85 offset:39520
    ds_write_b32 v86, v85 offset:0
    ds_write_b32 v86, v85 offset:2080
    ds_write_b32 v86, v85 offset:4160
    ds_write_b32 v86, v85 offset:6240
    ds_write_b32 v86, v85 offset:8320
    ds_write_b32 v86, v85 offset:10400
    ds_write_b32 v86, v85 offset:12480
    ds_write_b32 v86, v85 offset:14560
    ds_write_b32 v86, v85 offset:16640
    ds_write_b32 v86, v85 offset:18720
    ds_write_b32 v86, v85 offset:20800
    ds_write_b32 v86, v85 offset:22880
    ds_write_b32 v86, v85 offset:24960
    ds_write_b32 v86, v85 offset:27040
    ds_write_b32 v86, v85 offset:29120
    ds_write_b32 v86, v85 offset:31200
    ds_write_b32 v86, v85 offset:33280
    ds_write_b32 v86, v85 offset:35360
    ds_write_b32 v86, v85 offset:37440
    ds_write_b32 v86, v85 offset:39520
    s_branch KS_FILL
KS_IDLE:
    s_barrier
    s_barrier
    s_branch KS_B3
K2_PAD_U20:
    s_branch K2_HOP
K2_U20:
    s_setprio 1
    s_waitcnt lgkmcnt(0)
    v_lshlrev_b32 v20, 16, v0
    v_and_b32 v21, 0xffff0000, v0
    v_lshlrev_b32 v22, 16, v1
    v_and_b32 v23, 0xffff0000, v1
    v_lshlrev_b32 v24, 16, v2
    v_and_b32 v25, 0xffff0000, v2
    v_lshlrev_b32 v26, 16, v3
    v_and_b32 v27, 0xffff0000, v3
    v_mul_f32_dpp v36, v16, v20 row_newbcast:8 row_mask:0xf bank_mask:0xf
    v_mul_f32_dpp v37, v16, v21 row_newbcast:9 row_mask:0xf bank_mask:0xf
    v_mul_f32_dpp v38, v16, v22 row_newbcast:10 row_mask:0xf bank_mask:0xf
    v_mul_f32_dpp v39, v16, v23 row_newbcast:11 row_mask:0xf bank_mask:0xf
    v_mul_f32_dpp v40, v16, v24 row_newbcast:12 row_mask:0xf bank_mask:0xf
    v_mul_f32_dpp v41, v16, v25 row_newbcast:13 row_mask:0xf bank_mask:0xf
    v_mul_f32_dpp v42, v16, v26 row_newbcast:14 row_mask:0xf bank_mask:0xf
    v_mul_f32_dpp v43, v16, v27 row_newbcast:15 row_mask:0xf bank_mask:0xf
    v_cvt_pk_bf16_f32 v68, v36, v37
    v_cvt_pk_bf16_f32 v69, v38, v39
    v_cvt_pk_bf16_f32 v70, v40, v41
    v_cvt_pk_bf16_f32 v71, v42, v43
    v_mul_f32_dpp v20, v16, v20 row_newbcast:0 row_mask:0xa bank_mask:0xf
    v_mul_f32_dpp v21, v16, v21 row_newbcast:1 row_mask:0xa bank_mask:0xf
    v_mul_f32_dpp v22, v16, v22 row_newbcast:2 row_mask:0xa bank_mask:0xf
    v_mul_f32_dpp v23, v16, v23 row_newbcast:3 row_mask:0xa bank_mask:0xf
    v_mul_f32_dpp v24, v16, v24 row_newbcast:4 row_mask:0xa bank_mask:0xf
    v_mul_f32_dpp v25, v16, v25 row_newbcast:5 row_mask:0xa bank_mask:0xf
    v_mul_f32_dpp v26, v16, v26 row_newbcast:6 row_mask:0xa bank_mask:0xf
    v_mul_f32_dpp v27, v16, v27 row_newbcast:7 row_mask:0xa bank_mask:0xf
    v_cvt_pk_bf16_f32 v64, v20, v21
    v_cvt_pk_bf16_f32 v65, v22, v23
    v_cvt_pk_bf16_f32 v66, v24, v25
    v_cvt_pk_bf16_f32 v67, v26, v27
    v_lshlrev_b32 v28, 16, v4
    v_and_b32 v29, 0xffff0000, v4
    v_lshlrev_b32 v30, 16, v5
    v_and_b32 v31, 0xffff0000, v5
    v_lshlrev_b32 v32, 16, v6
    v_and_b32 v33, 0xffff0000, v6
    v_lshlrev_b32 v34, 16, v7
    v_and_b32 v35, 0xffff0000, v7
    v_mul_f32_dpp v36, v17, v28 row_newbcast:8 row_mask:0xf bank_mask:0xf
    v_mul_f32_dpp v37, v17, v29 row_newbcast:9 row_mask:0xf bank_mask:0xf
    v_mul_f32_dpp v38, v17, v30 row_newbcast:10 row_mask:0xf bank_mask:0xf
    v_mul_f32_dpp v39, v17, v31 row_newbcast:11 row_mask:0xf bank_mask:0xf
    v_mul_f32_dpp v40, v17, v32 row_newbcast:12 row_mask:0xf bank_mask:0xf
    v_mul_f32_dpp v41, v17, v33 row_newbcast:13 row_mask:0xf bank_mask:0xf
    v_mul_f32_dpp v42, v17, v34 row_newbcast:14 row_mask:0xf bank_mask:0xf
    v_mul_f32_dpp v43, v17, v35 row_newbcast:15 row_mask:0xf bank_mask:0xf
    v_cvt_pk_bf16_f32 v76, v36, v37
    v_cvt_pk_bf16_f32 v77, v38, v39
    v_cvt_pk_bf16_f32 v78, v40, v41
    v_cvt_pk_bf16_f32 v79, v42, v43
    v_mul_f32_dpp v28, v17, v28 row_newbcast:0 row_mask:0xa bank_mask:0xf
    v_mul_f32_dpp v29, v17, v29 row_newbcast:1 row_mask:0xa bank_mask:0xf
    v_mul_f32_dpp v30, v17, v30 row_newbcast:2 row_mask:0xa bank_mask:0xf
    v_mul_f32_dpp v31, v17, v31 row_newbcast:3 row_mask:0xa bank_mask:0xf
    v_mul_f32_dpp v32, v17, v32 row_newbcast:4 row_mask:0xa bank_mask:0xf
    v_mul_f32_dpp v33, v17, v33 row_newbcast:5 row_mask:0xa bank_mask:0xf
    v_mul_f32_dpp v34, v17, v34 row_newbcast:6 row_mask:0xa bank_mask:0xf
    v_mul_f32_dpp v35, v17, v35 row_newbcast:7 row_mask:0xa bank_mask:0xf
    v_cvt_pk_bf16_f32 v72, v28, v29
    v_cvt_pk_bf16_f32 v73, v30, v31
    v_cvt_pk_bf16_f32 v74, v32, v33
    v_cvt_pk_bf16_f32 v75, v34, v35
    s_waitcnt vmcnt(4)
    v_mfma_f32_32x32x16_bf16 v[0:15], v[64:67], v[176:179], 0
    ds_read_b64_tr_b16 v[184:185], v246 offset:2048
    ds_read_b64_tr_b16 v[186:187], v246 offset:3072
    ds_read_b64_tr_b16 v[188:189], v247 offset:2048
    ds_read_b64_tr_b16 v[190:191], v247 offset:3072
    s_mov_b32 m0, s68
    v_mfma_f32_32x32x16_bf16 v[16:31], v[68:71], v[176:179], 0
    buffer_load_dwordx4 v222, s[4:7], s42 offen sc1 lds
    buffer_load_dwordx4 v223, s[72:75], s42 offen offset:1024 sc1 lds
    v_permlane32_swap_b32 v242, v236
    v_permlane32_swap_b32 v243, v237
    s_add_u32 s38, s38, 1
    v_mfma_f32_32x32x16_bf16 v[32:47], v[64:67], v[180:183], 0
    v_permlane32_swap_b32 v244, v238
    v_permlane32_swap_b32 v245, v239
    v_permlane32_swap_b32 v240, v241
    v_add_f32 v242, v242, v236
    v_mfma_f32_32x32x16_bf16 v[48:63], v[68:71], v[180:183], 0
    v_add_f32 v243, v243, v237
    v_add_f32 v244, v244, v238
    v_add_f32 v245, v245, v239
    v_add_f32 v240, -v240, -v241
    v_mov_b32 v254, s52
    v_mov_b32 v255, s38
    s_waitcnt vmcnt(4) lgkmcnt(0)
    v_mfma_f32_32x32x16_bf16 v[0:15], v[72:75], v[184:187], v[0:15]
    ds_read_b64_tr_b16 v[176:177], v246 offset:4096
    ds_read_b64_tr_b16 v[178:179], v246 offset:5120
    ds_read_b64_tr_b16 v[180:181], v247 offset:4096
    ds_read_b64_tr_b16 v[182:183], v247 offset:5120
    s_lshl_b32 s58, s38, 3
    s_add_u32 s58, s58, s20
    s_mov_b32 m0, s69
    v_mfma_f32_32x32x16_bf16 v[16:31], v[76:79], v[184:187], v[16:31]
    buffer_load_dwordx4 v224, s[4:7], s42 offen sc1 lds
    buffer_load_dwordx4 v225, s[72:75], s42 offen offset:1024 sc1 lds
    s_set_gpr_idx_on s32, gpr_idx(DST)
    s_nop 0
    v_cvt_pk_bf16_f32 v195, v242, v243
    v_cvt_pk_bf16_f32 v196, v244, v245
    v_cvt_pk_bf16_f32 v197, v240, v240
    s_set_gpr_idx_off
    s_mov_b64 exec, 1
    ds_write_b32 v254, v255
    s_mov_b64 exec, -1
    s_cmp_lt_u32 s58, s22
    s_cbranch_scc0 K2_dyn_10
K2_back_11:
    v_readlane_b32 s3, v253, s58
    s_lshl_b32 s44, s34, 7
    s_and_b32 s48, s3, 0x3ffff
    s_bfe_u32 s33, s3, 0x30013
    s_mul_i32 s35, s38, 6
    s_cmp_eq_u32 s34, 0
    s_cselect_b32 s35, s35, s48
    s_mov_b32 s45, s44
    s_xor_b32 s47, s44, 256
    s_add_u32 s49, s48, 128
    s_add_u32 s60, s48, 256
    s_cmp_eq_u32 s33, 3
    s_cselect_b32 s46, s44, s47
    s_cselect_b32 s50, s60, s48
    s_sub_u32 s60, s33, 2
    s_cmp_lt_u32 s60, 2
    s_cbranch_scc0 K2_rare_16
K2_back_17:
    v_mfma_f32_32x32x16_bf16 v[32:47], v[72:75], v[188:191], v[32:47]
    v_add_u32 v233, s48, v230
    ds_read_b32 v232, v233
    ds_read_b32 v233, v233 offset:1024
    v_mul_f32 v234, v0, v96
    v_mul_f32 v236, v8, v128
    v_fmac_f32 v234, v1, v97
    v_fmac_f32 v236, v9, v129
    v_mfma_f32_32x32x16_bf16 v[48:63], v[76:79], v[188:191], v[48:63]
    s_setprio 0
    v_fmac_f32 v234, v2, v98
    v_fmac_f32 v236, v10, v130
    v_fmac_f32 v234, v3, v99
    v_fmac_f32 v236, v11, v131
    v_fmac_f32 v234, v4, v100
    v_fmac_f32 v236, v12, v132
    v_fmac_f32 v234, v5, v101
    v_fmac_f32 v236, v13, v133
    v_fmac_f32 v234, v6, v102
    v_fmac_f32 v236, v14, v134
    v_fmac_f32 v234, v7, v103
    v_fmac_f32 v236, v15, v135
    v_mul_f32 v238, v16, v128
    v_mul_f32 v240, v24, v128
    v_fmac_f32 v238, v17, v129
    v_fmac_f32 v240, v25, v129
    v_fmac_f32 v238, v18, v130
    v_fmac_f32 v240, v26, v130
    v_fmac_f32 v238, v19, v131
    v_fmac_f32 v240, v27, v131
    v_fmac_f32 v238, v20, v132
    v_fmac_f32 v240, v28, v132
    v_fmac_f32 v238, v21, v133
    v_fmac_f32 v240, v29, v133
    v_fmac_f32 v238, v22, v134
    v_fmac_f32 v240, v30, v134
    v_fmac_f32 v238, v23, v135
    v_fmac_f32 v240, v31, v135
    v_mul_f32 v235, v32, v104
    v_mul_f32 v237, v40, v136
    v_fmac_f32 v235, v33, v105
    v_fmac_f32 v237, v41, v137
    v_fmac_f32 v235, v34, v106
    v_fmac_f32 v237, v42, v138
    v_fmac_f32 v235, v35, v107
    v_fmac_f32 v237, v43, v139
    v_fmac_f32 v235, v36, v108
    v_fmac_f32 v237, v44, v140
    v_fmac_f32 v235, v37, v109
    v_fmac_f32 v237, v45, v141
    v_fmac_f32 v235, v38, v110
    v_fmac_f32 v237, v46, v142
    v_fmac_f32 v235, v39, v111
    v_fmac_f32 v237, v47, v143
    v_mul_f32 v239, v48, v136
    v_mul_f32 v241, v56, v136
    v_fmac_f32 v239, v49, v137
    v_fmac_f32 v241, v57, v137
    s_setprio 1
    s_waitcnt vmcnt(4) lgkmcnt(3)
    v_mfma_f32_32x32x16_bf16 v[0:15], v[64:67], v[176:179], 0
    ds_read_b64_tr_b16 v[184:185], v246 offset:6144
    ds_read_b64_tr_b16 v[186:187], v246 offset:7168
    ds_read_b64_tr_b16 v[188:189], v247 offset:6144
    ds_read_b64_tr_b16 v[190:191], v247 offset:7168
    v_fmac_f32 v239, v50, v138
    v_fmac_f32 v241, v58, v138
    s_mov_b32 m0, s70
    v_mfma_f32_32x32x16_bf16 v[16:31], v[68:71], v[176:179], 0
    buffer_load_dwordx4 v222, s[4:7], s43 offen sc1 lds
    buffer_load_dwordx4 v223, s[72:75], s43 offen offset:1024 sc1 lds
    v_fmac_f32 v239, v51, v139
    v_fmac_f32 v241, v59, v139
    v_fmac_f32 v239, v52, v140
    v_fmac_f32 v241, v60, v140
    v_fmac_f32 v239, v53, v141
    v_mfma_f32_32x32x16_bf16 v[32:47], v[64:67], v[180:183], 0
    v_add_u32 v222, s48, v251
    ds_read2_b32 v[222:223], v222 offset0:1 offset1:3
    v_fmac_f32 v241, v61, v141
    v_fmac_f32 v239, v54, v142
    v_fmac_f32 v241, v62, v142
    v_fmac_f32 v239, v55, v143
    v_fmac_f32 v241, v63, v143
    v_mfma_f32_32x32x16_bf16 v[48:63], v[68:71], v[180:183], 0
    v_permlane32_swap_b32 v234, v236
    v_permlane32_swap_b32 v235, v237
    v_permlane32_swap_b32 v240, v238
    s_waitcnt lgkmcnt(5)
    v_or_b32 v232, v232, v231
    v_or_b32 v233, v233, v231
    s_cmp_lg_u32 s34, 0
    s_cbranch_scc1 K2_dum_21
    s_cmp_eq_u32 s33, 4
    s_cbranch_scc1 K2_a4_22
K2_b4_24:
    s_add_u32 m0, s48, 512
    s_add_u32 s65, s48, 1536
    buffer_load_dwordx4 v232, s[16:19], 0 offen  lds
    s_mov_b32 m0, s65
    s_mov_b32 exec_hi, 0
    buffer_load_dwordx4 v233, s[16:19], 0 offen  lds
    s_mov_b32 exec_hi, -1
K2_back_23:
    s_waitcnt vmcnt(6) lgkmcnt(1)
    v_mfma_f32_32x32x16_bf16 v[0:15], v[72:75], v[184:187], v[0:15]
    ds_read_b64_tr_b16 v[176:177], v246 offset:0
    ds_read_b64_tr_b16 v[178:179], v246 offset:1024
    ds_read_b64_tr_b16 v[180:181], v247 offset:0
    ds_read_b64_tr_b16 v[182:183], v247 offset:1024
    v_permlane32_swap_b32 v241, v239
    s_mov_b32 m0, s71
    v_mfma_f32_32x32x16_bf16 v[16:31], v[76:79], v[184:187], v[16:31]
    buffer_load_dwordx4 v224, s[4:7], s43 offen sc1 lds
    buffer_load_dwordx4 v225, s[72:75], s43 offen offset:1024 sc1 lds
    s_waitcnt lgkmcnt(4)
    v_mad_u32_u16 v222, v222, s39, v248 op_sel:[1,0,0,0]
    v_mad_u32_u16 v223, v223, s39, v248 op_sel:[1,0,0,0]
    v_add_f32 v234, v234, v236
    v_add_f32 v235, v235, v237
    v_add_f32 v240, v240, v238
    v_add_f32 v241, v241, v239
    s_set_gpr_idx_on s31, gpr_idx(DST)
    s_nop 0
    v_cvt_pk_bf16_f32 v192, v234, v235
    v_cvt_pk_bf16_f32 v193, v240, v241
    s_set_gpr_idx_off
    v_mfma_f32_32x32x16_bf16 v[32:47], v[72:75], v[188:191], v[32:47]
    v_add_u32 v224, s49, v251
    ds_read2_b32 v[224:225], v224 offset0:1 offset1:3
    v_mul_f32 v234, v0, v144
    v_mul_f32 v236, v8, v112
    v_fmac_f32 v234, v1, v145
    v_fmac_f32 v236, v9, v113
    v_fmac_f32 v234, v2, v146
    v_mfma_f32_32x32x16_bf16 v[48:63], v[76:79], v[188:191], v[48:63]
    s_setprio 0
    v_fmac_f32 v236, v10, v114
    v_fmac_f32 v234, v3, v147
    v_fmac_f32 v236, v11, v115
    v_fmac_f32 v234, v4, v148
    v_fmac_f32 v236, v12, v116
    v_fmac_f32 v234, v5, v149
    v_fmac_f32 v236, v13, v117
    v_fmac_f32 v234, v6, v150
    v_fmac_f32 v236, v14, v118
    v_fmac_f32 v234, v7, v151
    v_fmac_f32 v236, v15, v119
    v_mul_f32 v238, v16, v160
    v_mul_f32 v240, v24, v160
    v_fmac_f32 v238, v17, v161
    v_fmac_f32 v240, v25, v161
    v_fmac_f32 v238, v18, v162
    v_fmac_f32 v240, v26, v162
    v_fmac_f32 v238, v19, v163
    v_fmac_f32 v240, v27, v163
    v_fmac_f32 v238, v20, v164
    v_fmac_f32 v240, v28, v164
    v_fmac_f32 v238, v21, v165
    v_fmac_f32 v240, v29, v165
    v_fmac_f32 v238, v22, v166
    v_fmac_f32 v240, v30, v166
    v_fmac_f32 v238, v23, v167
    v_fmac_f32 v240, v31, v167
    v_mul_f32 v235, v32, v152
    v_mul_f32 v237, v40, v120
    v_fmac_f32 v235, v33, v153
    v_fmac_f32 v237, v41, v121
    v_fmac_f32 v235, v34, v154
    v_fmac_f32 v237, v42, v122
    v_fmac_f32 v235, v35, v155
    v_fmac_f32 v237, v43, v123
    v_fmac_f32 v235, v36, v156
    v_fmac_f32 v237, v44, v124
    v_fmac_f32 v235, v37, v157
    v_fmac_f32 v237, v45, v125
    v_fmac_f32 v235, v38, v158
    v_fmac_f32 v237, v46, v126
    v_fmac_f32 v235, v39, v159
    v_fmac_f32 v237, v47, v127
    v_mul_f32 v239, v48, v168
    v_mul_f32 v241, v56, v168
    v_fmac_f32 v239, v49, v169
    v_fmac_f32 v241, v57, v169
    v_fmac_f32 v239, v50, v170
    v_fmac_f32 v241, v58, v170
    v_fmac_f32 v239, v51, v171
    s_setprio 1
    s_waitcnt vmcnt(6) lgkmcnt(1)
    v_mfma_f32_32x32x16_bf16 v[0:15], v[64:67], v[176:179], 0
    ds_read_b64_tr_b16 v[184:185], v246 offset:2048
    ds_read_b64_tr_b16 v[186:187], v246 offset:3072
    ds_read_b64_tr_b16 v[188:189], v247 offset:2048
    ds_read_b64_tr_b16 v[190:191], v247 offset:3072
    v_fmac_f32 v241, v59, v171
    v_fmac_f32 v239, v52, v172
    s_mov_b32 m0, s68
    v_mfma_f32_32x32x16_bf16 v[16:31], v[68:71], v[176:179], 0
    buffer_load_dwordx4 v222, s[4:7], s44 offen sc1 lds
    buffer_load_dwordx4 v223, s[72:75], s44 offen offset:1024 sc1 lds
    s_waitcnt lgkmcnt(4)
    v_mad_u32_u16 v224, v224, s39, v248 op_sel:[1,0,0,0]
    v_mad_u32_u16 v225, v225, s39, v248 op_sel:[1,0,0,0]
    v_fmac_f32 v241, v60, v172
    v_fmac_f32 v239, v53, v173
    v_mfma_f32_32x32x16_bf16 v[32:47], v[64:67], v[180:183], 0
    v_add_u32 v226, s50, v251
    ds_read2_b32 v[226:227], v226 offset0:1 offset1:3
    v_fmac_f32 v241, v61, v173
    v_fmac_f32 v239, v54, v174
    v_fmac_f32 v241, v62, v174
    v_fmac_f32 v239, v55, v175
    v_fmac_f32 v241, v63, v175
    v_mfma_f32_32x32x16_bf16 v[48:63], v[68:71], v[180:183], 0
    s_waitcnt vmcnt(6) lgkmcnt(1)
    v_mfma_f32_32x32x16_bf16 v[0:15], v[72:75], v[184:187], v[0:15]
    ds_read_b64_tr_b16 v[176:177], v246 offset:4096
    ds_read_b64_tr_b16 v[178:179], v246 offset:5120
    ds_read_b64_tr_b16 v[180:181], v247 offset:4096
    ds_read_b64_tr_b16 v[182:183], v247 offset:5120
    s_mov_b32 m0, s69
    v_mfma_f32_32x32x16_bf16 v[16:31], v[76:79], v[184:187], v[16:31]
    buffer_load_dwordx4 v224, s[4:7], s45 offen sc1 lds
    buffer_load_dwordx4 v225, s[72:75], s45 offen offset:1024 sc1 lds
    s_waitcnt lgkmcnt(4)
    v_mad_u32_u16 v226, v226, s39, v248 op_sel:[1,0,0,0]
    v_mad_u32_u16 v227, v227, s39, v248 op_sel:[1,0,0,0]
    v_mfma_f32_32x32x16_bf16 v[32:47], v[72:75], v[188:191], v[32:47]
    v_mul_f32 v242, v0, v144
    v_fma_f32 v238, v8, v160, -v238
    v_fmac_f32 v242, v1, v145
    v_fmac_f32 v238, v9, v161
    v_fmac_f32 v242, v2, v146
    v_fmac_f32 v238, v10, v162
    v_fmac_f32 v242, v3, v147
    v_mfma_f32_32x32x16_bf16 v[48:63], v[76:79], v[188:191], v[48:63]
    s_setprio 0
    v_fmac_f32 v238, v11, v163
    v_fmac_f32 v242, v4, v148
    v_fmac_f32 v238, v12, v164
    v_fmac_f32 v242, v5, v149
    v_fmac_f32 v238, v13, v165
    v_fmac_f32 v242, v6, v150
    v_fmac_f32 v238, v14, v166
    v_fmac_f32 v242, v7, v151
    v_fmac_f32 v238, v15, v167
    v_fmac_f32 v236, v16, v112
    v_mul_f32 v244, v24, v160
    v_fmac_f32 v236, v17, v113
    v_fmac_f32 v244, v25, v161
    v_fmac_f32 v236, v18, v114
    v_fmac_f32 v244, v26, v162
    v_fmac_f32 v236, v19, v115
    v_fmac_f32 v244, v27, v163
    v_fmac_f32 v236, v20, v116
    v_fmac_f32 v244, v28, v164
    v_fmac_f32 v236, v21, v117
    v_fmac_f32 v244, v29, v165
    v_fmac_f32 v236, v22, v118
    v_fmac_f32 v244, v30, v166
    v_fmac_f32 v236, v23, v119
    v_fmac_f32 v244, v31, v167
    v_mul_f32 v243, v32, v152
    v_fma_f32 v239, v40, v168, -v239
    v_fmac_f32 v243, v33, v153
    v_fmac_f32 v239, v41, v169
    v_fmac_f32 v243, v34, v154
    v_fmac_f32 v239, v42, v170
    v_fmac_f32 v243, v35, v155
    v_fmac_f32 v239, v43, v171
    v_fmac_f32 v243, v36, v156
    v_fmac_f32 v239, v44, v172
    v_fmac_f32 v243, v37, v157
    v_fmac_f32 v239, v45, v173
    v_fmac_f32 v243, v38, v158
    v_fmac_f32 v239, v46, v174
    v_fmac_f32 v243, v39, v159
    v_fmac_f32 v239, v47, v175
    v_fmac_f32 v237, v48, v120
    v_mul_f32 v245, v56, v168
    s_setprio 1
    s_waitcnt vmcnt(4) lgkmcnt(0)
    v_mfma_f32_32x32x16_bf16 v[0:15], v[64:67], v[176:179], 0
    ds_read_b64_tr_b16 v[184:185], v246 offset:6144
    ds_read_b64_tr_b16 v[186:187], v246 offset:7168
    ds_read_b64_tr_b16 v[188:189], v247 offset:6144
    ds_read_b64_tr_b16 v[190:191], v247 offset:7168
    v_fmac_f32 v237, v49, v121
    v_fmac_f32 v245, v57, v169
    s_mov_b32 m0, s70
    v_mfma_f32_32x32x16_bf16 v[16:31], v[68:71], v[176:179], 0
    buffer_load_dwordx4 v226, s[4:7], s46 offen sc1 lds
    buffer_load_dwordx4 v227, s[72:75], s46 offen offset:1024 sc1 lds
    v_fmac_f32 v237, v50, v122
    v_fmac_f32 v245, v58, v170
    v_fmac_f32 v237, v51, v123
    v_fmac_f32 v245, v59, v171
    v_fmac_f32 v237, v52, v124
    v_mfma_f32_32x32x16_bf16 v[32:47], v[64:67], v[180:183], 0
    v_fmac_f32 v245, v60, v172
    v_fmac_f32 v237, v53, v125
    v_fmac_f32 v245, v61, v173
    v_fmac_f32 v237, v54, v126
    v_fmac_f32 v245, v62, v174
    v_fmac_f32 v237, v55, v127
    v_fmac_f32 v245, v63, v175
    v_mfma_f32_32x32x16_bf16 v[48:63], v[68:71], v[180:183], 0
    v_permlane32_swap_b32 v242, v234
    v_permlane32_swap_b32 v243, v235
    v_add_f32 v242, v242, v234
    v_add_f32 v243, v243, v235
    s_waitcnt vmcnt(4) lgkmcnt(0)
    v_mfma_f32_32x32x16_bf16 v[0:15], v[72:75], v[184:187], v[0:15]
    ds_read_b64_tr_b16 v[176:177], v246 offset:0
    ds_read_b64_tr_b16 v[178:179], v246 offset:1024
    ds_read_b64_tr_b16 v[180:181], v247 offset:0
    ds_read_b64_tr_b16 v[182:183], v247 offset:1024
    s_sub_u32 s26, s48, s29
    s_mov_b32 s29, s48
    s_mov_b32 m0, s71
    v_mfma_f32_32x32x16_bf16 v[16:31], v[76:79], v[184:187], v[16:31]
    s_cmp_eq_u32 s33, 4
    s_cbranch_scc1 K2_g4_19
    buffer_load_dwordx4 v224, s[4:7], s47 offen sc1 lds
    buffer_load_dwordx4 v225, s[72:75], s47 offen offset:1024 sc1 lds
K2_back_20:
    s_set_gpr_idx_on s31, gpr_idx(DST)
    s_nop 0
    v_cvt_pk_bf16_f32 v194, v242, v243
    s_set_gpr_idx_off
    s_mov_b32 s30, s3
    s_bfe_u32 s56, s3, 0x40012
    s_cmp_eq_u32 s34, 0
    s_cselect_b32 s56, s56, 0
    v_mfma_f32_32x32x16_bf16 v[32:47], v[72:75], v[188:191], v[32:47]
    s_mov_b32 s32, s31
    s_mov_b32 s31, s35
    v_mul_f32 v242, v0, v144
    v_fma_f32 v240, v8, v160, -v240
    v_fmac_f32 v242, v1, v145
    v_fmac_f32 v240, v9, v161
    v_fmac_f32 v242, v2, v146
    v_mfma_f32_32x32x16_bf16 v[48:63], v[76:79], v[188:191], v[48:63]
    s_setprio 0
    v_fmac_f32 v240, v10, v162
    v_fmac_f32 v242, v3, v147
    v_fmac_f32 v240, v11, v163
    v_fmac_f32 v242, v4, v148
    v_fmac_f32 v240, v12, v164
    v_fmac_f32 v242, v5, v149
    v_fmac_f32 v240, v13, v165
    v_fmac_f32 v242, v6, v150
    v_fmac_f32 v240, v14, v166
    v_fmac_f32 v242, v7, v151
    v_fmac_f32 v240, v15, v167
    v_add_u32 v249, s26, v249
    v_add_u32 v250, s26, v250
    v_fma_f32 v244, v16, v160, -v244
    v_fmac_f32 v236, v24, v112
    v_fmac_f32 v244, v17, v161
    v_fmac_f32 v236, v25, v113
    v_fmac_f32 v244, v18, v162
    v_fmac_f32 v236, v26, v114
    v_fmac_f32 v244, v19, v163
    v_fmac_f32 v236, v27, v115
    v_fmac_f32 v244, v20, v164
    v_fmac_f32 v236, v28, v116
    v_fmac_f32 v244, v21, v165
    v_fmac_f32 v236, v29, v117
    v_fmac_f32 v244, v22, v166
    v_fmac_f32 v236, v30, v118
    v_fmac_f32 v244, v23, v167
    v_fmac_f32 v236, v31, v119
    ds_read_b64_tr_b16 v[0:1], v249 offset:0
    ds_read_b64_tr_b16 v[2:3], v249 offset:32
    ds_read_u16_d16_hi v16, v250 offset:0
    v_mul_f32 v243, v32, v152
    v_fma_f32 v241, v40, v168, -v241
    v_fmac_f32 v243, v33, v153
    v_fmac_f32 v241, v41, v169
    v_fmac_f32 v243, v34, v154
    v_fmac_f32 v241, v42, v170
    v_fmac_f32 v243, v35, v155
    v_fmac_f32 v241, v43, v171
    v_fmac_f32 v243, v36, v156
    v_fmac_f32 v241, v44, v172
    v_fmac_f32 v243, v37, v157
    v_fmac_f32 v241, v45, v173
    v_fmac_f32 v243, v38, v158
    v_fmac_f32 v241, v46, v174
    v_fmac_f32 v243, v39, v159
    v_fmac_f32 v241, v47, v175
    ds_read_b64_tr_b16 v[4:5], v249 offset:512
    ds_read_b64_tr_b16 v[6:7], v249 offset:544
    ds_read_u16_d16_hi v17, v250 offset:128
    v_fma_f32 v245, v48, v168, -v245
    v_fmac_f32 v237, v56, v120
    v_fmac_f32 v245, v49, v169
    v_fmac_f32 v237, v57, v121
    v_fmac_f32 v245, v50, v170
    v_fmac_f32 v237, v58, v122
    v_fmac_f32 v245, v51, v171
    v_fmac_f32 v237, v59, v123
    v_fmac_f32 v245, v52, v172
    v_fmac_f32 v237, v60, v124
    v_fmac_f32 v245, v53, v173
    v_fmac_f32 v237, v61, v125
    v_fmac_f32 v245, v54, v174
    v_fmac_f32 v237, v62, v126
    v_fmac_f32 v245, v55, v175
    v_fmac_f32 v237, v63, v127
    s_cmp_eq_u32 s56, 5
    s_cbranch_scc1 K2_U20
    s_cmp_eq_u32 s56, 6
    s_cbranch_scc1 K2_U3h0
    s_branch K2_DSP0
K2_PAD_U30:
    s_branch K2_HOP
K2_U3h0:
    s_setprio 1
    ds_read_b64_tr_b16 v[8:9], v249 offset:1024
    ds_read_u16_d16_hi v18, v250 offset:256
    s_waitcnt lgkmcnt(2)
    v_lshlrev_b32 v20, 16, v0
    v_and_b32 v21, 0xffff0000, v0
    v_lshlrev_b32 v22, 16, v1
    v_and_b32 v23, 0xffff0000, v1
    v_lshlrev_b32 v24, 16, v2
    v_and_b32 v25, 0xffff0000, v2
    v_lshlrev_b32 v26, 16, v3
    v_and_b32 v27, 0xffff0000, v3
    v_mul_f32_dpp v36, v16, v20 row_newbcast:8 row_mask:0xf bank_mask:0xf
    v_mul_f32_dpp v37, v16, v21 row_newbcast:9 row_mask:0xf bank_mask:0xf
    v_mul_f32_dpp v38, v16, v22 row_newbcast:10 row_mask:0xf bank_mask:0xf
    v_mul_f32_dpp v39, v16, v23 row_newbcast:11 row_mask:0xf bank_mask:0xf
    v_mul_f32_dpp v40, v16, v24 row_newbcast:12 row_mask:0xf bank_mask:0xf
    v_mul_f32_dpp v41, v16, v25 row_newbcast:13 row_mask:0xf bank_mask:0xf
    v_mul_f32_dpp v42, v16, v26 row_newbcast:14 row_mask:0xf bank_mask:0xf
    v_mul_f32_dpp v43, v16, v27 row_newbcast:15 row_mask:0xf bank_mask:0xf
    v_cvt_pk_bf16_f32 v68, v36, v37
    v_cvt_pk_bf16_f32 v69, v38, v39
    v_cvt_pk_bf16_f32 v70, v40, v41
    v_cvt_pk_bf16_f32 v71, v42, v43
    v_mul_f32_dpp v20, v16, v20 row_newbcast:0 row_mask:0xa bank_mask:0xf
    v_mul_f32_dpp v21, v16, v21 row_newbcast:1 row_mask:0xa bank_mask:0xf
    v_mul_f32_dpp v22, v16, v22 row_newbcast:2 row_mask:0xa bank_mask:0xf
    v_mul_f32_dpp v23, v16, v23 row_newbcast:3 row_mask:0xa bank_mask:0xf
    v_mul_f32_dpp v24, v16, v24 row_newbcast:4 row_mask:0xa bank_mask:0xf
    v_mul_f32_dpp v25, v16, v25 row_newbcast:5 row_mask:0xa bank_mask:0xf
    v_mul_f32_dpp v26, v16, v26 row_newbcast:6 row_mask:0xa bank_mask:0xf
    v_mul_f32_dpp v27, v16, v27 row_newbcast:7 row_mask:0xa bank_mask:0xf
    v_cvt_pk_bf16_f32 v64, v20, v21
    v_cvt_pk_bf16_f32 v65, v22, v23
    v_cvt_pk_bf16_f32 v66, v24, v25
    v_cvt_pk_bf16_f32 v67, v26, v27
    v_lshlrev_b32 v28, 16, v4
    v_and_b32 v29, 0xffff0000, v4
    v_lshlrev_b32 v30, 16, v5
    v_and_b32 v31, 0xffff0000, v5
    v_lshlrev_b32 v32, 16, v6
    v_and_b32 v33, 0xffff0000, v6
    v_lshlrev_b32 v34, 16, v7
    v_and_b32 v35, 0xffff0000, v7
    v_mul_f32_dpp v36, v17, v28 row_newbcast:8 row_mask:0xf bank_mask:0xf
    v_mul_f32_dpp v37, v17, v29 row_newbcast:9 row_mask:0xf bank_mask:0xf
    v_mul_f32_dpp v38, v17, v30 row_newbcast:10 row_mask:0xf bank_mask:0xf
    v_mul_f32_dpp v39, v17, v31 row_newbcast:11 row_mask:0xf bank_mask:0xf
    v_mul_f32_dpp v40, v17, v32 row_newbcast:12 row_mask:0xf bank_mask:0xf
    v_mul_f32_dpp v41, v17, v33 row_newbcast:13 row_mask:0xf bank_mask:0xf
    v_mul_f32_dpp v42, v17, v34 row_newbcast:14 row_mask:0xf bank_mask:0xf
    v_mul_f32_dpp v43, v17, v35 row_newbcast:15 row_mask:0xf bank_mask:0xf
    v_cvt_pk_bf16_f32 v76, v36, v37
    v_cvt_pk_bf16_f32 v77, v38, v39
    v_cvt_pk_bf16_f32 v78, v40, v41
    v_cvt_pk_bf16_f32 v79, v42, v43
    v_mul_f32_dpp v28, v17, v28 row_newbcast:0 row_mask:0xa bank_mask:0xf
    v_mul_f32_dpp v29, v17, v29 row_newbcast:1 row_mask:0xa bank_mask:0xf
    v_mul_f32_dpp v30, v17, v30 row_newbcast:2 row_mask:0xa bank_mask:0xf
    v_mul_f32_dpp v31, v17, v31 row_newbcast:3 row_mask:0xa bank_mask:0xf
    v_mul_f32_dpp v32, v17, v32 row_newbcast:4 row_mask:0xa bank_mask:0xf
    v_mul_f32_dpp v33, v17, v33 row_newbcast:5 row_mask:0xa bank_mask:0xf
    v_mul_f32_dpp v34, v17, v34 row_newbcast:6 row_mask:0xa bank_mask:0xf
    v_mul_f32_dpp v35, v17, v35 row_newbcast:7 row_mask:0xa bank_mask:0xf
    v_cvt_pk_bf16_f32 v72, v28, v29
    v_cvt_pk_bf16_f32 v73, v30, v31
    v_cvt_pk_bf16_f32 v74, v32, v33
    v_cvt_pk_bf16_f32 v75, v34, v35
    s_waitcnt lgkmcnt(0)
    v_lshlrev_b32 v20, 16, v8
    v_and_b32 v21, 0xffff0000, v8
    v_lshlrev_b32 v22, 16, v9
    v_and_b32 v23, 0xffff0000, v9
    v_mul_f32_dpp v36, v18, v20 row_newbcast:8 row_mask:0xf bank_mask:0xf
    v_mul_f32_dpp v37, v18, v21 row_newbcast:9 row_mask:0xf bank_mask:0xf
    v_mul_f32_dpp v38, v18, v22 row_newbcast:10 row_mask:0xf bank_mask:0xf
    v_mul_f32_dpp v39, v18, v23 row_newbcast:11 row_mask:0xf bank_mask:0xf
    v_cvt_pk_bf16_f32 v84, v36, v37
    v_cvt_pk_bf16_f32 v85, v38, v39
    v_mul_f32_dpp v20, v18, v20 row_newbcast:0 row_mask:0xa bank_mask:0xf
    v_mul_f32_dpp v21, v18, v21 row_newbcast:1 row_mask:0xa bank_mask:0xf
    v_mul_f32_dpp v22, v18, v22 row_newbcast:2 row_mask:0xa bank_mask:0xf
    v_mul_f32_dpp v23, v18, v23 row_newbcast:3 row_mask:0xa bank_mask:0xf
    v_cvt_pk_bf16_f32 v80, v20, v21
    v_cvt_pk_bf16_f32 v81, v22, v23
    s_waitcnt vmcnt(4)
    v_mfma_f32_32x32x16_bf16 v[0:15], v[64:67], v[176:179], 0
    ds_read_b64_tr_b16 v[184:185], v246 offset:2048
    ds_read_b64_tr_b16 v[186:187], v246 offset:3072
    ds_read_b64_tr_b16 v[188:189], v247 offset:2048
    ds_read_b64_tr_b16 v[190:191], v247 offset:3072
    s_mov_b32 m0, s68
    v_mfma_f32_32x32x16_bf16 v[16:31], v[68:71], v[176:179], 0
    buffer_load_dwordx4 v222, s[4:7], s41 offen sc1 lds
    buffer_load_dwordx4 v223, s[72:75], s41 offen offset:1024 sc1 lds
    v_permlane32_swap_b32 v242, v236
    v_permlane32_swap_b32 v243, v237
    s_add_u32 s38, s38, 1
    v_mfma_f32_32x32x16_bf16 v[32:47], v[64:67], v[180:183], 0
    v_permlane32_swap_b32 v244, v238
    v_permlane32_swap_b32 v245, v239
    v_permlane32_swap_b32 v240, v241
    v_add_f32 v242, v242, v236
    v_mfma_f32_32x32x16_bf16 v[48:63], v[68:71], v[180:183], 0
    v_add_f32 v243, v243, v237
    v_add_f32 v244, v244, v238
    v_add_f32 v245, v245, v239
    v_add_f32 v240, -v240, -v241
    v_mov_b32 v254, s52
    v_mov_b32 v255, s38
    s_waitcnt vmcnt(4) lgkmcnt(0)
    v_mfma_f32_32x32x16_bf16 v[0:15], v[72:75], v[184:187], v[0:15]
    ds_read_b64_tr_b16 v[176:177], v246 offset:4096
    ds_read_b64_tr_b16 v[180:181], v247 offset:4096
    s_lshl_b32 s58, s38, 3
    s_add_u32 s58, s58, s20
    s_mov_b32 m0, s69
    v_mfma_f32_32x32x16_bf16 v[16:31], v[76:79], v[184:187], v[16:31]
    buffer_load_dwordx4 v226, s[4:7], s41 offen sc1 lds
    s_set_gpr_idx_on s32, gpr_idx(DST)
    s_nop 0
    v_cvt_pk_bf16_f32 v195, v242, v243
    v_cvt_pk_bf16_f32 v196, v244, v245
    v_cvt_pk_bf16_f32 v197, v240, v240
    s_set_gpr_idx_off
    s_mov_b64 exec, 1
    ds_write_b32 v254, v255
    s_mov_b64 exec, -1
    s_cmp_lt_u32 s58, s22
    s_cbranch_scc0 K2_dyn_25
K2_back_26:
    v_readlane_b32 s3, v253, s58
    s_lshl_b32 s44, s34, 7
    s_and_b32 s48, s3, 0x3ffff
    s_bfe_u32 s33, s3, 0x30013
    s_mul_i32 s35, s38, 6
    s_cmp_eq_u32 s34, 0
    s_cselect_b32 s35, s35, s48
    s_mov_b32 s45, s44
    s_xor_b32 s47, s44, 256
    s_add_u32 s49, s48, 128
    s_add_u32 s60, s48, 256
    s_cmp_eq_u32 s33, 3
    s_cselect_b32 s46, s44, s47
    s_cselect_b32 s50, s60, s48
    s_sub_u32 s60, s33, 2
    s_cmp_lt_u32 s60, 2
    s_cbranch_scc0 K2_rare_31
K2_back_32:
    v_mfma_f32_32x32x16_bf16 v[32:47], v[72:75], v[188:191], v[32:47]
    v_add_u32 v233, s48, v230
    ds_read_b32 v232, v233
    ds_read_b32 v233, v233 offset:1024
    v_mfma_f32_32x32x16_bf16 v[48:63], v[76:79], v[188:191], v[48:63]
    s_waitcnt vmcnt(3) lgkmcnt(3)
    v_mfma_f32_32x32x8_bf16 v[0:15], v[80:81], v[176:177], v[0:15]
    ds_read_b64_tr_b16 v[184:185], v246 offset:6144
    ds_read_b64_tr_b16 v[186:187], v246 offset:7168
    ds_read_b64_tr_b16 v[188:189], v247 offset:6144
    ds_read_b64_tr_b16 v[190:191], v247 offset:7168
    s_mov_b32 m0, s70
    v_mfma_f32_32x32x8_bf16 v[16:31], v[84:85], v[176:177], v[16:31]
    buffer_load_dwordx4 v222, s[4:7], s42 offen sc1 lds
    buffer_load_dwordx4 v223, s[72:75], s42 offen offset:1024 sc1 lds
    v_mfma_f32_32x32x8_bf16 v[32:47], v[80:81], v[180:181], v[32:47]
    s_nop 2
    v_mul_f32 v234, v0, v96
    v_mul_f32 v236, v8, v128
    v_fmac_f32 v234, v1, v97
    v_fmac_f32 v236, v9, v129
    v_fmac_f32 v234, v2, v98
    v_fmac_f32 v236, v10, v130
    v_fmac_f32 v234, v3, v99
    v_mfma_f32_32x32x8_bf16 v[48:63], v[84:85], v[180:181], v[48:63]
    s_setprio 0
    s_waitcnt lgkmcnt(4)
    v_or_b32 v232, v232, v231
    v_or_b32 v233, v233, v231
    s_cmp_lg_u32 s34, 0
    s_cbranch_scc1 K2_dum_36
    s_cmp_eq_u32 s33, 4
    s_cbranch_scc1 K2_a4_37
K2_b4_39:
    s_add_u32 m0, s48, 512
    s_add_u32 s65, s48, 1536
    buffer_load_dwordx4 v232, s[16:19], 0 offen  lds
    s_mov_b32 m0, s65
    s_mov_b32 exec_hi, 0
    buffer_load_dwordx4 v233, s[16:19], 0 offen  lds
    s_mov_b32 exec_hi, -1
K2_back_38:
    v_fmac_f32 v236, v11, v131
    v_fmac_f32 v234, v4, v100
    v_fmac_f32 v236, v12, v132
    v_fmac_f32 v234, v5, v101
    v_fmac_f32 v236, v13, v133
    v_fmac_f32 v234, v6, v102
    v_fmac_f32 v236, v14, v134
    v_fmac_f32 v234, v7, v103
    v_fmac_f32 v236, v15, v135
    v_mul_f32 v238, v16, v128
    v_mul_f32 v240, v24, v128
    v_fmac_f32 v238, v17, v129
    v_fmac_f32 v240, v25, v129
    v_fmac_f32 v238, v18, v130
    v_fmac_f32 v240, v26, v130
    v_fmac_f32 v238, v19, v131
    v_fmac_f32 v240, v27, v131
    v_fmac_f32 v238, v20, v132
    v_fmac_f32 v240, v28, v132
    v_fmac_f32 v238, v21, v133
    v_fmac_f32 v240, v29, v133
    v_fmac_f32 v238, v22, v134
    v_fmac_f32 v240, v30, v134
    v_fmac_f32 v238, v23, v135
    v_fmac_f32 v240, v31, v135
    v_mul_f32 v235, v32, v104
    v_mul_f32 v237, v40, v136
    v_fmac_f32 v235, v33, v105
    v_fmac_f32 v237, v41, v137
    v_fmac_f32 v235, v34, v106
    v_fmac_f32 v237, v42, v138
    v_fmac_f32 v235, v35, v107
    v_fmac_f32 v237, v43, v139
    v_fmac_f32 v235, v36, v108
    v_fmac_f32 v237, v44, v140
    v_fmac_f32 v235, v37, v109
    v_fmac_f32 v237, v45, v141
    v_fmac_f32 v235, v38, v110
    v_fmac_f32 v237, v46, v142
    v_fmac_f32 v235, v39, v111
    v_fmac_f32 v237, v47, v143
    v_mul_f32 v239, v48, v136
    v_mul_f32 v241, v56, v136
    s_setprio 1
    s_waitcnt vmcnt(5) lgkmcnt(0)
    v_mfma_f32_32x32x16_bf16 v[0:15], v[72:75], v[184:187], 0
    ds_read_b64_tr_b16 v[176:177], v246 offset:0
    ds_read_b64_tr_b16 v[178:179], v246 offset:1024
    ds_read_b64_tr_b16 v[180:181], v247 offset:0
    ds_read_b64_tr_b16 v[182:183], v247 offset:1024
    v_fmac_f32 v239, v49, v137
    v_fmac_f32 v241, v57, v137
    s_mov_b32 m0, s71
    v_mfma_f32_32x32x16_bf16 v[16:31], v[76:79], v[184:187], 0
    buffer_load_dwordx4 v224, s[4:7], s42 offen sc1 lds
    buffer_load_dwordx4 v225, s[72:75], s42 offen offset:1024 sc1 lds
    v_fmac_f32 v239, v50, v138
    v_fmac_f32 v241, v58, v138
    v_fmac_f32 v239, v51, v139
    v_fmac_f32 v241, v59, v139
    v_fmac_f32 v239, v52, v140
    v_mfma_f32_32x32x16_bf16 v[32:47], v[72:75], v[188:191], 0
    v_fmac_f32 v241, v60, v140
    v_fmac_f32 v239, v53, v141
    v_fmac_f32 v241, v61, v141
    v_fmac_f32 v239, v54, v142
    v_fmac_f32 v241, v62, v142
    v_fmac_f32 v239, v55, v143
    v_fmac_f32 v241, v63, v143
    v_mfma_f32_32x32x16_bf16 v[48:63], v[76:79], v[188:191], 0
    v_permlane32_swap_b32 v234, v236
    v_permlane32_swap_b32 v235, v237
    v_permlane32_swap_b32 v240, v238
    s_waitcnt vmcnt(6) lgkmcnt(0)
    v_mfma_f32_32x32x16_bf16 v[0:15], v[64:67], v[176:179], v[0:15]
    ds_read_b64_tr_b16 v[184:185], v246 offset:2048
    ds_read_b64_tr_b16 v[188:189], v247 offset:2048
    v_permlane32_swap_b32 v241, v239
    v_add_f32 v234, v234, v236
    v_add_f32 v235, v235, v237
    s_mov_b32 m0, s68
    v_mfma_f32_32x32x16_bf16 v[16:31], v[68:71], v[176:179], v[16:31]
    buffer_load_dwordx4 v226, s[4:7], s42 offen sc1 lds
    v_add_f32 v240, v240, v238
    v_add_f32 v241, v241, v239
    s_set_gpr_idx_on s31, gpr_idx(DST)
    s_nop 0
    v_cvt_pk_bf16_f32 v192, v234, v235
    v_cvt_pk_bf16_f32 v193, v240, v241
    s_set_gpr_idx_off
    v_mfma_f32_32x32x16_bf16 v[32:47], v[64:67], v[180:183], v[32:47]
    v_mfma_f32_32x32x16_bf16 v[48:63], v[68:71], v[180:183], v[48:63]
    s_waitcnt vmcnt(5) lgkmcnt(0)
    v_mfma_f32_32x32x8_bf16 v[0:15], v[80:81], v[184:185], v[0:15]
    ds_read_b64_tr_b16 v[176:177], v246 offset:4096
    ds_read_b64_tr_b16 v[178:179], v246 offset:5120
    ds_read_b64_tr_b16 v[180:181], v247 offset:4096
    ds_read_b64_tr_b16 v[182:183], v247 offset:5120
    s_mov_b32 m0, s69
    v_mfma_f32_32x32x8_bf16 v[16:31], v[84:85], v[184:185], v[16:31]
    buffer_load_dwordx4 v222, s[4:7], s43 offen sc1 lds
    buffer_load_dwordx4 v223, s[72:75], s43 offen offset:1024 sc1 lds
    v_mfma_f32_32x32x8_bf16 v[32:47], v[80:81], v[188:189], v[32:47]
    s_nop 2
    v_mul_f32 v234, v0, v144
    v_mul_f32 v236, v8, v112
    v_fmac_f32 v234, v1, v145
    v_fmac_f32 v236, v9, v113
    v_fmac_f32 v234, v2, v146
    v_fmac_f32 v236, v10, v114
    v_fmac_f32 v234, v3, v147
    v_mfma_f32_32x32x8_bf16 v[48:63], v[84:85], v[188:189], v[48:63]
    s_setprio 0
    v_fmac_f32 v236, v11, v115
    v_fmac_f32 v234, v4, v148
    v_fmac_f32 v236, v12, v116
    v_fmac_f32 v234, v5, v149
    v_fmac_f32 v236, v13, v117
    v_fmac_f32 v234, v6, v150
    v_fmac_f32 v236, v14, v118
    v_fmac_f32 v234, v7, v151
    v_fmac_f32 v236, v15, v119
    v_mul_f32 v238, v16, v160
    v_mul_f32 v240, v24, v160
    v_fmac_f32 v238, v17, v161
    v_fmac_f32 v240, v25, v161
    v_fmac_f32 v238, v18, v162
    v_fmac_f32 v240, v26, v162
    v_fmac_f32 v238, v19, v163
    v_fmac_f32 v240, v27, v163
    v_fmac_f32 v238, v20, v164
    v_fmac_f32 v240, v28, v164
    v_fmac_f32 v238, v21, v165
    v_fmac_f32 v240, v29, v165
    v_fmac_f32 v238, v22, v166
    v_fmac_f32 v240, v30, v166
    v_fmac_f32 v238, v23, v167
    v_fmac_f32 v240, v31, v167
    v_mul_f32 v235, v32, v152
    v_mul_f32 v237, v40, v120
    v_fmac_f32 v235, v33, v153
    v_fmac_f32 v237, v41, v121
    v_fmac_f32 v235, v34, v154
    v_fmac_f32 v237, v42, v122
    v_fmac_f32 v235, v35, v155
    v_fmac_f32 v237, v43, v123
    v_fmac_f32 v235, v36, v156
    v_fmac_f32 v237, v44, v124
    v_fmac_f32 v235, v37, v157
    v_fmac_f32 v237, v45, v125
    v_fmac_f32 v235, v38, v158
    v_fmac_f32 v237, v46, v126
    v_fmac_f32 v235, v39, v159
    v_fmac_f32 v237, v47, v127
    v_mul_f32 v239, v48, v168
    v_mul_f32 v241, v56, v168
    v_fmac_f32 v239, v49, v169
    v_fmac_f32 v241, v57, v169
    s_setprio 1
    s_waitcnt vmcnt(3) lgkmcnt(0)
    v_mfma_f32_32x32x16_bf16 v[0:15], v[64:67], v[176:179], 0
    ds_read_b64_tr_b16 v[184:185], v246 offset:6144
    ds_read_b64_tr_b16 v[186:187], v246 offset:7168
    ds_read_b64_tr_b16 v[188:189], v247 offset:6144
    ds_read_b64_tr_b16 v[190:191], v247 offset:7168
    v_fmac_f32 v239, v50, v170
    v_fmac_f32 v241, v58, v170
    s_mov_b32 m0, s70
    v_mfma_f32_32x32x16_bf16 v[16:31], v[68:71], v[176:179], 0
    buffer_load_dwordx4 v224, s[4:7], s43 offen sc1 lds
    buffer_load_dwordx4 v225, s[72:75], s43 offen offset:1024 sc1 lds
    v_fmac_f32 v239, v51, v171
    v_fmac_f32 v241, v59, v171
    v_fmac_f32 v239, v52, v172
    v_fmac_f32 v241, v60, v172
    v_fmac_f32 v239, v53, v173
    v_mfma_f32_32x32x16_bf16 v[32:47], v[64:67], v[180:183], 0
    v_add_u32 v222, s48, v251
    ds_read2_b32 v[222:223], v222 offset0:1 offset1:3
    v_fmac_f32 v241, v61, v173
    v_fmac_f32 v239, v54, v174
    v_fmac_f32 v241, v62, v174
    v_fmac_f32 v239, v55, v175
    v_fmac_f32 v241, v63, v175
    v_mfma_f32_32x32x16_bf16 v[48:63], v[68:71], v[180:183], 0
    s_waitcnt vmcnt(4) lgkmcnt(1)
    v_mfma_f32_32x32x16_bf16 v[0:15], v[72:75], v[184:187], v[0:15]
    ds_read_b64_tr_b16 v[176:177], v246 offset:0
    ds_read_b64_tr_b16 v[180:181], v247 offset:0
    s_mov_b32 m0, s71
    v_mfma_f32_32x32x16_bf16 v[16:31], v[76:79], v[184:187], v[16:31]
    buffer_load_dwordx4 v226, s[4:7], s43 offen sc1 lds
    s_waitcnt lgkmcnt(2)
    v_mad_u32_u16 v222, v222, s39, v248 op_sel:[1,0,0,0]
    v_mad_u32_u16 v223, v223, s39, v248 op_sel:[1,0,0,0]
    v_mfma_f32_32x32x16_bf16 v[32:47], v[72:75], v[188:191], v[32:47]
    v_add_u32 v224, s49, v251
    ds_read2_b32 v[224:225], v224 offset0:1 offset1:3
    v_mfma_f32_32x32x16_bf16 v[48:63], v[76:79], v[188:191], v[48:63]
    s_waitcnt vmcnt(3) lgkmcnt(1)
    v_mfma_f32_32x32x8_bf16 v[0:15], v[80:81], v[176:177], v[0:15]
    ds_read_b64_tr_b16 v[184:185], v246 offset:2048
    ds_read_b64_tr_b16 v[186:187], v246 offset:3072
    ds_read_b64_tr_b16 v[188:189], v247 offset:2048
    ds_read_b64_tr_b16 v[190:191], v247 offset:3072
    s_mov_b32 m0, s68
    v_mfma_f32_32x32x8_bf16 v[16:31], v[84:85], v[176:177], v[16:31]
    buffer_load_dwordx4 v222, s[4:7], s44 offen sc1 lds
    buffer_load_dwordx4 v223, s[72:75], s44 offen offset:1024 sc1 lds
    s_waitcnt lgkmcnt(4)
    v_mad_u32_u16 v224, v224, s39, v248 op_sel:[1,0,0,0]
    v_mad_u32_u16 v225, v225, s39, v248 op_sel:[1,0,0,0]
    v_mfma_f32_32x32x8_bf16 v[32:47], v[80:81], v[180:181], v[32:47]
    v_add_u32 v226, s50, v251
    ds_read2_b32 v[226:227], v226 offset0:1 offset1:3
    v_mul_f32 v242, v0, v144
    v_fma_f32 v238, v8, v160, -v238
    v_fmac_f32 v242, v1, v145
    v_fmac_f32 v238, v9, v161
    v_fmac_f32 v242, v2, v146
    v_mfma_f32_32x32x8_bf16 v[48:63], v[84:85], v[180:181], v[48:63]
    s_setprio 0
    v_fmac_f32 v238, v10, v162
    v_fmac_f32 v242, v3, v147
    v_fmac_f32 v238, v11, v163
    v_fmac_f32 v242, v4, v148
    v_fmac_f32 v238, v12, v164
    v_fmac_f32 v242, v5, v149
    v_fmac_f32 v238, v13, v165
    v_fmac_f32 v242, v6, v150
    v_fmac_f32 v238, v14, v166
    v_fmac_f32 v242, v7, v151
    v_fmac_f32 v238, v15, v167
    v_fmac_f32 v236, v16, v112
    v_mul_f32 v244, v24, v160
    v_fmac_f32 v236, v17, v113
    v_fmac_f32 v244, v25, v161
    v_fmac_f32 v236, v18, v114
    v_fmac_f32 v244, v26, v162
    v_fmac_f32 v236, v19, v115
    v_fmac_f32 v244, v27, v163
    v_fmac_f32 v236, v20, v116
    v_fmac_f32 v244, v28, v164
    v_fmac_f32 v236, v21, v117
    v_fmac_f32 v244, v29, v165
    v_fmac_f32 v236, v22, v118
    v_fmac_f32 v244, v30, v166
    v_fmac_f32 v236, v23, v119
    v_fmac_f32 v244, v31, v167
    v_mul_f32 v243, v32, v152
    v_fma_f32 v239, v40, v168, -v239
    v_fmac_f32 v243, v33, v153
    v_fmac_f32 v239, v41, v169
    v_fmac_f32 v243, v34, v154
    v_fmac_f32 v239, v42, v170
    v_fmac_f32 v243, v35, v155
    v_fmac_f32 v239, v43, v171
    v_fmac_f32 v243, v36, v156
    v_fmac_f32 v239, v44, v172
    v_fmac_f32 v243, v37, v157
    v_fmac_f32 v239, v45, v173
    v_fmac_f32 v243, v38, v158
    v_fmac_f32 v239, v46, v174
    v_fmac_f32 v243, v39, v159
    v_fmac_f32 v239, v47, v175
    v_fmac_f32 v237, v48, v120
    v_mul_f32 v245, v56, v168
    v_fmac_f32 v237, v49, v121
    v_fmac_f32 v245, v57, v169
    v_fmac_f32 v237, v50, v122
    s_setprio 1
    s_waitcnt vmcnt(3) lgkmcnt(1)
    v_mfma_f32_32x32x16_bf16 v[0:15], v[64:67], v[184:187], 0
    ds_read_b64_tr_b16 v[176:177], v246 offset:4096
    ds_read_b64_tr_b16 v[178:179], v246 offset:5120
    ds_read_b64_tr_b16 v[180:181], v247 offset:4096
    ds_read_b64_tr_b16 v[182:183], v247 offset:5120
    v_fmac_f32 v245, v58, v170
    v_fmac_f32 v237, v51, v123
    s_mov_b32 m0, s69
    v_mfma_f32_32x32x16_bf16 v[16:31], v[68:71], v[184:187], 0
    buffer_load_dwordx4 v224, s[4:7], s45 offen sc1 lds
    buffer_load_dwordx4 v225, s[72:75], s45 offen offset:1024 sc1 lds
    s_waitcnt lgkmcnt(4)
    v_mad_u32_u16 v226, v226, s39, v248 op_sel:[1,0,0,0]
    v_mad_u32_u16 v227, v227, s39, v248 op_sel:[1,0,0,0]
    v_fmac_f32 v245, v59, v171
    v_fmac_f32 v237, v52, v124
    v_mfma_f32_32x32x16_bf16 v[32:47], v[64:67], v[188:191], 0
    v_fmac_f32 v245, v60, v172
    v_fmac_f32 v237, v53, v125
    v_fmac_f32 v245, v61, v173
    v_fmac_f32 v237, v54, v126
    v_fmac_f32 v245, v62, v174
    v_fmac_f32 v237, v55, v127
    v_fmac_f32 v245, v63, v175
    v_mfma_f32_32x32x16_bf16 v[48:63], v[68:71], v[188:191], 0
    v_permlane32_swap_b32 v242, v234
    v_permlane32_swap_b32 v243, v235
    v_add_f32 v242, v242, v234
    v_add_f32 v243, v243, v235
    s_waitcnt vmcnt(4) lgkmcnt(0)
    v_mfma_f32_32x32x16_bf16 v[0:15], v[72:75], v[176:179], v[0:15]
    ds_read_b64_tr_b16 v[184:185], v246 offset:6144
    ds_read_b64_tr_b16 v[188:189], v247 offset:6144
    s_set_gpr_idx_on s31, gpr_idx(DST)
    s_nop 0
    v_cvt_pk_bf16_f32 v194, v242, v243
    s_set_gpr_idx_off
    s_mov_b32 s32, s31
    s_mov_b32 m0, s70
    v_mfma_f32_32x32x16_bf16 v[16:31], v[76:79], v[176:179], v[16:31]
    buffer_load_dwordx4 v226, s[4:7], s46 offen sc1 lds
    buffer_load_dwordx4 v227, s[72:75], s46 offen offset:1024 sc1 lds
    s_sub_u32 s26, s48, s29
    s_mov_b32 s29, s48
    s_mov_b32 s30, s3
    s_bfe_u32 s56, s3, 0x40012
    s_mov_b32 s31, s35
    v_mfma_f32_32x32x16_bf16 v[32:47], v[72:75], v[180:183], v[32:47]
    s_cmp_eq_u32 s34, 0
    s_cselect_b32 s56, s56, 0
    v_mfma_f32_32x32x16_bf16 v[48:63], v[76:79], v[180:183], v[48:63]
    s_waitcnt vmcnt(4) lgkmcnt(0)
    v_mfma_f32_32x32x8_bf16 v[0:15], v[80:81], v[184:185], v[0:15]
    ds_read_b64_tr_b16 v[176:177], v246 offset:0
    ds_read_b64_tr_b16 v[178:179], v246 offset:1024
    ds_read_b64_tr_b16 v[180:181], v247 offset:0
    ds_read_b64_tr_b16 v[182:183], v247 offset:1024
    s_mov_b32 m0, s71
    v_mfma_f32_32x32x8_bf16 v[16:31], v[84:85], v[184:185], v[16:31]
    s_cmp_eq_u32 s33, 4
    s_cbranch_scc1 K2_g4_34
    buffer_load_dwordx4 v224, s[4:7], s47 offen sc1 lds
    buffer_load_dwordx4 v225, s[72:75], s47 offen offset:1024 sc1 lds
K2_back_35:
    v_mfma_f32_32x32x8_bf16 v[32:47], v[80:81], v[188:189], v[32:47]
    s_nop 0
    v_mul_f32 v242, v0, v144
    v_fma_f32 v240, v8, v160, -v240
    v_fmac_f32 v242, v1, v145
    v_fmac_f32 v240, v9, v161
    v_fmac_f32 v242, v2, v146
    v_fmac_f32 v240, v10, v162
    v_fmac_f32 v242, v3, v147
    v_mfma_f32_32x32x8_bf16 v[48:63], v[84:85], v[188:189], v[48:63]
    s_setprio 0
    v_fmac_f32 v240, v11, v163
    v_fmac_f32 v242, v4, v148
    v_fmac_f32 v240, v12, v164
    v_fmac_f32 v242, v5, v149
    v_fmac_f32 v240, v13, v165
    v_fmac_f32 v242, v6, v150
    v_fmac_f32 v240, v14, v166
    v_fmac_f32 v242, v7, v151
    v_fmac_f32 v240, v15, v167
    v_add_u32 v249, s26, v249
    v_add_u32 v250, s26, v250
    v_fma_f32 v244, v16, v160, -v244
    v_fmac_f32 v236, v24, v112
    v_fmac_f32 v244, v17, v161
    v_fmac_f32 v236, v25, v113
    v_fmac_f32 v244, v18, v162
    v_fmac_f32 v236, v26, v114
    v_fmac_f32 v244, v19, v163
    v_fmac_f32 v236, v27, v115
    v_fmac_f32 v244, v20, v164
    v_fmac_f32 v236, v28, v116
    v_fmac_f32 v244, v21, v165
    v_fmac_f32 v236, v29, v117
    v_fmac_f32 v244, v22, v166
    v_fmac_f32 v236, v30, v118
    v_fmac_f32 v244, v23, v167
    v_fmac_f32 v236, v31, v119
    ds_read_b64_tr_b16 v[0:1], v249 offset:0
    ds_read_b64_tr_b16 v[2:3], v249 offset:32
    ds_read_u16_d16_hi v16, v250 offset:0
    v_mul_f32 v243, v32, v152
    v_fma_f32 v241, v40, v168, -v241
    v_fmac_f32 v243, v33, v153
    v_fmac_f32 v241, v41, v169
    v_fmac_f32 v243, v34, v154
    v_fmac_f32 v241, v42, v170
    v_fmac_f32 v243, v35, v155
    v_fmac_f32 v241, v43, v171
    v_fmac_f32 v243, v36, v156
    v_fmac_f32 v241, v44, v172
    v_fmac_f32 v243, v37, v157
    v_fmac_f32 v241, v45, v173
    v_fmac_f32 v243, v38, v158
    v_fmac_f32 v241, v46, v174
    v_fmac_f32 v243, v39, v159
    v_fmac_f32 v241, v47, v175
    ds_read_b64_tr_b16 v[4:5], v249 offset:512
    ds_read_b64_tr_b16 v[6:7], v249 offset:544
    ds_read_u16_d16_hi v17, v250 offset:128
    v_fma_f32 v245, v48, v168, -v245
    v_fmac_f32 v237, v56, v120
    v_fmac_f32 v245, v49, v169
    v_fmac_f32 v237, v57, v121
    v_fmac_f32 v245, v50, v170
    v_fmac_f32 v237, v58, v122
    v_fmac_f32 v245, v51, v171
    v_fmac_f32 v237, v59, v123
    v_fmac_f32 v245, v52, v172
    v_fmac_f32 v237, v60, v124
    v_fmac_f32 v245, v53, v173
    v_fmac_f32 v237, v61, v125
    v_fmac_f32 v245, v54, v174
    v_fmac_f32 v237, v62, v126
    v_fmac_f32 v245, v55, v175
    v_fmac_f32 v237, v63, v127
    s_cmp_eq_u32 s56, 5
    s_cbranch_scc1 K2_U20
    s_cmp_eq_u32 s56, 6
    s_cbranch_scc1 K2_U3h0
    s_branch K2_DSP0
K2_U30:
    s_setprio 1
    ds_read_b64_tr_b16 v[8:9], v249 offset:1024
    ds_read_b64_tr_b16 v[10:11], v249 offset:1056
    ds_read_u16_d16_hi v18, v250 offset:256
    s_waitcnt lgkmcnt(3)
    v_lshlrev_b32 v20, 16, v0
    v_and_b32 v21, 0xffff0000, v0
    v_lshlrev_b32 v22, 16, v1
    v_and_b32 v23, 0xffff0000, v1
    v_lshlrev_b32 v24, 16, v2
    v_and_b32 v25, 0xffff0000, v2
    v_lshlrev_b32 v26, 16, v3
    v_and_b32 v27, 0xffff0000, v3
    v_mul_f32_dpp v36, v16, v20 row_newbcast:8 row_mask:0xf bank_mask:0xf
    v_mul_f32_dpp v37, v16, v21 row_newbcast:9 row_mask:0xf bank_mask:0xf
    v_mul_f32_dpp v38, v16, v22 row_newbcast:10 row_mask:0xf bank_mask:0xf
    v_mul_f32_dpp v39, v16, v23 row_newbcast:11 row_mask:0xf bank_mask:0xf
    v_mul_f32_dpp v40, v16, v24 row_newbcast:12 row_mask:0xf bank_mask:0xf
    v_mul_f32_dpp v41, v16, v25 row_newbcast:13 row_mask:0xf bank_mask:0xf
    v_mul_f32_dpp v42, v16, v26 row_newbcast:14 row_mask:0xf bank_mask:0xf
    v_mul_f32_dpp v43, v16, v27 row_newbcast:15 row_mask:0xf bank_mask:0xf
    v_cvt_pk_bf16_f32 v68, v36, v37
    v_cvt_pk_bf16_f32 v69, v38, v39
    v_cvt_pk_bf16_f32 v70, v40, v41
    v_cvt_pk_bf16_f32 v71, v42, v43
    v_mul_f32_dpp v20, v16, v20 row_newbcast:0 row_mask:0xa bank_mask:0xf
    v_mul_f32_dpp v21, v16, v21 row_newbcast:1 row_mask:0xa bank_mask:0xf
    v_mul_f32_dpp v22, v16, v22 row_newbcast:2 row_mask:0xa bank_mask:0xf
    v_mul_f32_dpp v23, v16, v23 row_newbcast:3 row_mask:0xa bank_mask:0xf
    v_mul_f32_dpp v24, v16, v24 row_newbcast:4 row_mask:0xa bank_mask:0xf
    v_mul_f32_dpp v25, v16, v25 row_newbcast:5 row_mask:0xa bank_mask:0xf
    v_mul_f32_dpp v26, v16, v26 row_newbcast:6 row_mask:0xa bank_mask:0xf
    v_mul_f32_dpp v27, v16, v27 row_newbcast:7 row_mask:0xa bank_mask:0xf
    v_cvt_pk_bf16_f32 v64, v20, v21
    v_cvt_pk_bf16_f32 v65, v22, v23
    v_cvt_pk_bf16_f32 v66, v24, v25
    v_cvt_pk_bf16_f32 v67, v26, v27
    v_lshlrev_b32 v28, 16, v4
    v_and_b32 v29, 0xffff0000, v4
    v_lshlrev_b32 v30, 16, v5
    v_and_b32 v31, 0xffff0000, v5
    v_lshlrev_b32 v32, 16, v6
    v_and_b32 v33, 0xffff0000, v6
    v_lshlrev_b32 v34, 16, v7
    v_and_b32 v35, 0xffff0000, v7
    v_mul_f32_dpp v36, v17, v28 row_newbcast:8 row_mask:0xf bank_mask:0xf
    v_mul_f32_dpp v37, v17, v29 row_newbcast:9 row_mask:0xf bank_mask:0xf
    v_mul_f32_dpp v38, v17, v30 row_newbcast:10 row_mask:0xf bank_mask:0xf
    v_mul_f32_dpp v39, v17, v31 row_newbcast:11 row_mask:0xf bank_mask:0xf
    v_mul_f32_dpp v40, v17, v32 row_newbcast:12 row_mask:0xf bank_mask:0xf
    v_mul_f32_dpp v41, v17, v33 row_newbcast:13 row_mask:0xf bank_mask:0xf
    v_mul_f32_dpp v42, v17, v34 row_newbcast:14 row_mask:0xf bank_mask:0xf
    v_mul_f32_dpp v43, v17, v35 row_newbcast:15 row_mask:0xf bank_mask:0xf
    v_cvt_pk_bf16_f32 v76, v36, v37
    v_cvt_pk_bf16_f32 v77, v38, v39
    v_cvt_pk_bf16_f32 v78, v40, v41
    v_cvt_pk_bf16_f32 v79, v42, v43
    v_mul_f32_dpp v28, v17, v28 row_newbcast:0 row_mask:0xa bank_mask:0xf
    v_mul_f32_dpp v29, v17, v29 row_newbcast:1 row_mask:0xa bank_mask:0xf
    v_mul_f32_dpp v30, v17, v30 row_newbcast:2 row_mask:0xa bank_mask:0xf
    v_mul_f32_dpp v31, v17, v31 row_newbcast:3 row_mask:0xa bank_mask:0xf
    v_mul_f32_dpp v32, v17, v32 row_newbcast:4 row_mask:0xa bank_mask:0xf
    v_mul_f32_dpp v33, v17, v33 row_newbcast:5 row_mask:0xa bank_mask:0xf
    v_mul_f32_dpp v34, v17, v34 row_newbcast:6 row_mask:0xa bank_mask:0xf
    v_mul_f32_dpp v35, v17, v35 row_newbcast:7 row_mask:0xa bank_mask:0xf
    v_cvt_pk_bf16_f32 v72, v28, v29
    v_cvt_pk_bf16_f32 v73, v30, v31
    v_cvt_pk_bf16_f32 v74, v32, v33
    v_cvt_pk_bf16_f32 v75, v34, v35
    s_waitcnt lgkmcnt(0)
    v_lshlrev_b32 v20, 16, v8
    v_and_b32 v21, 0xffff0000, v8
    v_lshlrev_b32 v22, 16, v9
    v_and_b32 v23, 0xffff0000, v9
    v_lshlrev_b32 v24, 16, v10
    v_and_b32 v25, 0xffff0000, v10
    v_lshlrev_b32 v26, 16, v11
    v_and_b32 v27, 0xffff0000, v11
    v_mul_f32_dpp v36, v18, v20 row_newbcast:8 row_mask:0xf bank_mask:0xf
    v_mul_f32_dpp v37, v18, v21 row_newbcast:9 row_mask:0xf bank_mask:0xf
    v_mul_f32_dpp v38, v18, v22 row_newbcast:10 row_mask:0xf bank_mask:0xf
    v_mul_f32_dpp v39, v18, v23 row_newbcast:11 row_mask:0xf bank_mask:0xf
    v_mul_f32_dpp v40, v18, v24 row_newbcast:12 row_mask:0xf bank_mask:0xf
    v_mul_f32_dpp v41, v18, v25 row_newbcast:13 row_mask:0xf bank_mask:0xf
    v_mul_f32_dpp v42, v18, v26 row_newbcast:14 row_mask:0xf bank_mask:0xf
    v_mul_f32_dpp v43, v18, v27 row_newbcast:15 row_mask:0xf bank_mask:0xf
    v_cvt_pk_bf16_f32 v84, v36, v37
    v_cvt_pk_bf16_f32 v85, v38, v39
    v_cvt_pk_bf16_f32 v86, v40, v41
    v_cvt_pk_bf16_f32 v87, v42, v43
    v_mul_f32_dpp v20, v18, v20 row_newbcast:0 row_mask:0xa bank_mask:0xf
    v_mul_f32_dpp v21, v18, v21 row_newbcast:1 row_mask:0xa bank_mask:0xf
    v_mul_f32_dpp v22, v18, v22 row_newbcast:2 row_mask:0xa bank_mask:0xf
    v_mul_f32_dpp v23, v18, v23 row_newbcast:3 row_mask:0xa bank_mask:0xf
    v_mul_f32_dpp v24, v18, v24 row_newbcast:4 row_mask:0xa bank_mask:0xf
    v_mul_f32_dpp v25, v18, v25 row_newbcast:5 row_mask:0xa bank_mask:0xf
    v_mul_f32_dpp v26, v18, v26 row_newbcast:6 row_mask:0xa bank_mask:0xf
    v_mul_f32_dpp v27, v18, v27 row_newbcast:7 row_mask:0xa bank_mask:0xf
    v_cvt_pk_bf16_f32 v80, v20, v21
    v_cvt_pk_bf16_f32 v81, v22, v23
    v_cvt_pk_bf16_f32 v82, v24, v25
    v_cvt_pk_bf16_f32 v83, v26, v27
    s_waitcnt vmcnt(4)
    v_mfma_f32_32x32x16_bf16 v[0:15], v[64:67], v[176:179], 0
    ds_read_b64_tr_b16 v[184:185], v246 offset:2048
    ds_read_b64_tr_b16 v[186:187], v246 offset:3072
    ds_read_b64_tr_b16 v[188:189], v247 offset:2048
    ds_read_b64_tr_b16 v[190:191], v247 offset:3072
    s_mov_b32 m0, s68
    v_mfma_f32_32x32x16_bf16 v[16:31], v[68:71], v[176:179], 0
    buffer_load_dwordx4 v222, s[4:7], s41 offen sc1 lds
    buffer_load_dwordx4 v223, s[72:75], s41 offen offset:1024 sc1 lds
    v_permlane32_swap_b32 v242, v236
    v_permlane32_swap_b32 v243, v237
    s_add_u32 s38, s38, 1
    v_mfma_f32_32x32x16_bf16 v[32:47], v[64:67], v[180:183], 0
    v_permlane32_swap_b32 v244, v238
    v_permlane32_swap_b32 v245, v239
    v_permlane32_swap_b32 v240, v241
    v_add_f32 v242, v242, v236
    v_mfma_f32_32x32x16_bf16 v[48:63], v[68:71], v[180:183], 0
    v_add_f32 v243, v243, v237
    v_add_f32 v244, v244, v238
    v_add_f32 v245, v245, v239
    v_add_f32 v240, -v240, -v241
    v_mov_b32 v254, s52
    v_mov_b32 v255, s38
    s_waitcnt vmcnt(4) lgkmcnt(0)
    v_mfma_f32_32x32x16_bf16 v[0:15], v[72:75], v[184:187], v[0:15]
    ds_read_b64_tr_b16 v[176:177], v246 offset:4096
    ds_read_b64_tr_b16 v[178:179], v246 offset:5120
    ds_read_b64_tr_b16 v[180:181], v247 offset:4096
    ds_read_b64_tr_b16 v[182:183], v247 offset:5120
    s_lshl_b32 s58, s38, 3
    s_add_u32 s58, s58, s20
    s_mov_b32 m0, s69
    v_mfma_f32_32x32x16_bf16 v[16:31], v[76:79], v[184:187], v[16:31]
    buffer_load_dwordx4 v226, s[4:7], s41 offen sc1 lds
    buffer_load_dwordx4 v227, s[72:75], s41 offen offset:1024 sc1 lds
    s_set_gpr_idx_on s32, gpr_idx(DST)
    s_nop 0
    v_cvt_pk_bf16_f32 v195, v242, v243
    v_cvt_pk_bf16_f32 v196, v244, v245
    v_cvt_pk_bf16_f32 v197, v240, v240
    s_set_gpr_idx_off
    s_mov_b64 exec, 1
    ds_write_b32 v254, v255
    s_mov_b64 exec, -1
    s_cmp_lt_u32 s58, s22
    s_cbranch_scc0 K2_dyn_40
K2_back_41:
    v_readlane_b32 s3, v253, s58
    s_lshl_b32 s44, s34, 7
    s_and_b32 s48, s3, 0x3ffff
    s_bfe_u32 s33, s3, 0x30013
    s_mul_i32 s35, s38, 6
    s_cmp_eq_u32 s34, 0
    s_cselect_b32 s35, s35, s48
    s_mov_b32 s45, s44
    s_xor_b32 s47, s44, 256
    s_add_u32 s49, s48, 128
    s_add_u32 s60, s48, 256
    s_cmp_eq_u32 s33, 3
    s_cselect_b32 s46, s44, s47
    s_cselect_b32 s50, s60, s48
    s_sub_u32 s60, s33, 2
    s_cmp_lt_u32 s60, 2
    s_cbranch_scc0 K2_rare_46
K2_back_47:
    v_mfma_f32_32x32x16_bf16 v[32:47], v[72:75], v[188:191], v[32:47]
    v_add_u32 v233, s48, v230
    ds_read_b32 v232, v233
    ds_read_b32 v233, v233 offset:1024
    v_mfma_f32_32x32x16_bf16 v[48:63], v[76:79], v[188:191], v[48:63]
    s_waitcnt vmcnt(4) lgkmcnt(3)
    v_mfma_f32_32x32x16_bf16 v[0:15], v[80:83], v[176:179], v[0:15]
    ds_read_b64_tr_b16 v[184:185], v246 offset:6144
    ds_read_b64_tr_b16 v[186:187], v246 offset:7168
    ds_read_b64_tr_b16 v[188:189], v247 offset:6144
    ds_read_b64_tr_b16 v[190:191], v247 offset:7168
    s_mov_b32 m0, s70
    v_mfma_f32_32x32x16_bf16 v[16:31], v[84:87], v[176:179], v[16:31]
    buffer_load_dwordx4 v222, s[4:7], s42 offen sc1 lds
    buffer_load_dwordx4 v223, s[72:75], s42 offen offset:1024 sc1 lds
    v_mfma_f32_32x32x16_bf16 v[32:47], v[80:83], v[180:183], v[32:47]
    s_nop 2
    v_mul_f32 v234, v0, v96
    v_mul_f32 v236, v8, v128
    v_fmac_f32 v234, v1, v97
    v_fmac_f32 v236, v9, v129
    v_fmac_f32 v234, v2, v98
    v_fmac_f32 v236, v10, v130
    v_fmac_f32 v234, v3, v99
    v_mfma_f32_32x32x16_bf16 v[48:63], v[84:87], v[180:183], v[48:63]
    s_setprio 0
    s_waitcnt lgkmcnt(4)
    v_or_b32 v232, v232, v231
    v_or_b32 v233, v233, v231
    s_cmp_lg_u32 s34, 0
    s_cbranch_scc1 K2_dum_51
    s_cmp_eq_u32 s33, 4
    s_cbranch_scc1 K2_a4_52
K2_b4_54:
    s_add_u32 m0, s48, 512
    s_add_u32 s65, s48, 1536
    buffer_load_dwordx4 v232, s[16:19], 0 offen  lds
    s_mov_b32 m0, s65
    s_mov_b32 exec_hi, 0
    buffer_load_dwordx4 v233, s[16:19], 0 offen  lds
    s_mov_b32 exec_hi, -1
K2_back_53:
    v_fmac_f32 v236, v11, v131
    v_fmac_f32 v234, v4, v100
    v_fmac_f32 v236, v12, v132
    v_fmac_f32 v234, v5, v101
    v_fmac_f32 v236, v13, v133
    v_fmac_f32 v234, v6, v102
    v_fmac_f32 v236, v14, v134
    v_fmac_f32 v234, v7, v103
    v_fmac_f32 v236, v15, v135
    v_mul_f32 v238, v16, v128
    v_mul_f32 v240, v24, v128
    v_fmac_f32 v238, v17, v129
    v_fmac_f32 v240, v25, v129
    v_fmac_f32 v238, v18, v130
    v_fmac_f32 v240, v26, v130
    v_fmac_f32 v238, v19, v131
    v_fmac_f32 v240, v27, v131
    v_fmac_f32 v238, v20, v132
    v_fmac_f32 v240, v28, v132
    v_fmac_f32 v238, v21, v133
    v_fmac_f32 v240, v29, v133
    v_fmac_f32 v238, v22, v134
    v_fmac_f32 v240, v30, v134
    v_fmac_f32 v238, v23, v135
    v_fmac_f32 v240, v31, v135
    v_mul_f32 v235, v32, v104
    v_mul_f32 v237, v40, v136
    v_fmac_f32 v235, v33, v105
    v_fmac_f32 v237, v41, v137
    v_fmac_f32 v235, v34, v106
    v_fmac_f32 v237, v42, v138
    v_fmac_f32 v235, v35, v107
    v_fmac_f32 v237, v43, v139
    v_fmac_f32 v235, v36, v108
    v_fmac_f32 v237, v44, v140
    v_fmac_f32 v235, v37, v109
    v_fmac_f32 v237, v45, v141
    v_fmac_f32 v235, v38, v110
    v_fmac_f32 v237, v46, v142
    v_fmac_f32 v235, v39, v111
    v_fmac_f32 v237, v47, v143
    v_mul_f32 v239, v48, v136
    v_mul_f32 v241, v56, v136
    s_setprio 1
    s_waitcnt vmcnt(6) lgkmcnt(0)
    v_mfma_f32_32x32x16_bf16 v[0:15], v[72:75], v[184:187], 0
    ds_read_b64_tr_b16 v[176:177], v246 offset:0
    ds_read_b64_tr_b16 v[178:179], v246 offset:1024
    ds_read_b64_tr_b16 v[180:181], v247 offset:0
    ds_read_b64_tr_b16 v[182:183], v247 offset:1024
    v_fmac_f32 v239, v49, v137
    v_fmac_f32 v241, v57, v137
    s_mov_b32 m0, s71
    v_mfma_f32_32x32x16_bf16 v[16:31], v[76:79], v[184:187], 0
    buffer_load_dwordx4 v224, s[4:7], s42 offen sc1 lds
    buffer_load_dwordx4 v225, s[72:75], s42 offen offset:1024 sc1 lds
    v_fmac_f32 v239, v50, v138
    v_fmac_f32 v241, v58, v138
    v_fmac_f32 v239, v51, v139
    v_fmac_f32 v241, v59, v139
    v_fmac_f32 v239, v52, v140
    v_mfma_f32_32x32x16_bf16 v[32:47], v[72:75], v[188:191], 0
    v_fmac_f32 v241, v60, v140
    v_fmac_f32 v239, v53, v141
    v_fmac_f32 v241, v61, v141
    v_fmac_f32 v239, v54, v142
    v_fmac_f32 v241, v62, v142
    v_fmac_f32 v239, v55, v143
    v_fmac_f32 v241, v63, v143
    v_mfma_f32_32x32x16_bf16 v[48:63], v[76:79], v[188:191], 0
    v_permlane32_swap_b32 v234, v236
    v_permlane32_swap_b32 v235, v237
    v_permlane32_swap_b32 v240, v238
    s_waitcnt vmcnt(6) lgkmcnt(0)
    v_mfma_f32_32x32x16_bf16 v[0:15], v[64:67], v[176:179], v[0:15]
    ds_read_b64_tr_b16 v[184:185], v246 offset:2048
    ds_read_b64_tr_b16 v[186:187], v246 offset:3072
    ds_read_b64_tr_b16 v[188:189], v247 offset:2048
    ds_read_b64_tr_b16 v[190:191], v247 offset:3072
    v_permlane32_swap_b32 v241, v239
    s_mov_b32 m0, s68
    v_mfma_f32_32x32x16_bf16 v[16:31], v[68:71], v[176:179], v[16:31]
    buffer_load_dwordx4 v226, s[4:7], s42 offen sc1 lds
    buffer_load_dwordx4 v227, s[72:75], s42 offen offset:1024 sc1 lds
    v_add_f32 v234, v234, v236
    v_add_f32 v235, v235, v237
    v_add_f32 v240, v240, v238
    v_add_f32 v241, v241, v239
    v_mfma_f32_32x32x16_bf16 v[32:47], v[64:67], v[180:183], v[32:47]
    s_set_gpr_idx_on s31, gpr_idx(DST)
    s_nop 0
    v_cvt_pk_bf16_f32 v192, v234, v235
    v_cvt_pk_bf16_f32 v193, v240, v241
    s_set_gpr_idx_off
    v_mfma_f32_32x32x16_bf16 v[48:63], v[68:71], v[180:183], v[48:63]
    s_waitcnt vmcnt(6) lgkmcnt(0)
    v_mfma_f32_32x32x16_bf16 v[0:15], v[80:83], v[184:187], v[0:15]
    ds_read_b64_tr_b16 v[176:177], v246 offset:4096
    ds_read_b64_tr_b16 v[178:179], v246 offset:5120
    ds_read_b64_tr_b16 v[180:181], v247 offset:4096
    ds_read_b64_tr_b16 v[182:183], v247 offset:5120
    s_mov_b32 m0, s69
    v_mfma_f32_32x32x16_bf16 v[16:31], v[84:87], v[184:187], v[16:31]
    buffer_load_dwordx4 v222, s[4:7], s43 offen sc1 lds
    buffer_load_dwordx4 v223, s[72:75], s43 offen offset:1024 sc1 lds
    v_mfma_f32_32x32x16_bf16 v[32:47], v[80:83], v[188:191], v[32:47]
    s_nop 2
    v_mul_f32 v234, v0, v144
    v_mul_f32 v236, v8, v112
    v_fmac_f32 v234, v1, v145
    v_fmac_f32 v236, v9, v113
    v_fmac_f32 v234, v2, v146
    v_fmac_f32 v236, v10, v114
    v_fmac_f32 v234, v3, v147
    v_mfma_f32_32x32x16_bf16 v[48:63], v[84:87], v[188:191], v[48:63]
    s_setprio 0
    v_fmac_f32 v236, v11, v115
    v_fmac_f32 v234, v4, v148
    v_fmac_f32 v236, v12, v116
    v_fmac_f32 v234, v5, v149
    v_fmac_f32 v236, v13, v117
    v_fmac_f32 v234, v6, v150
    v_fmac_f32 v236, v14, v118
    v_fmac_f32 v234, v7, v151
    v_fmac_f32 v236, v15, v119
    v_mul_f32 v238, v16, v160
    v_mul_f32 v240, v24, v160
    v_fmac_f32 v238, v17, v161
    v_fmac_f32 v240, v25, v161
    v_fmac_f32 v238, v18, v162
    v_fmac_f32 v240, v26, v162
    v_fmac_f32 v238, v19, v163
    v_fmac_f32 v240, v27, v163
    v_fmac_f32 v238, v20, v164
    v_fmac_f32 v240, v28, v164
    v_fmac_f32 v238, v21, v165
    v_fmac_f32 v240, v29, v165
    v_fmac_f32 v238, v22, v166
    v_fmac_f32 v240, v30, v166
    v_fmac_f32 v238, v23, v167
    v_fmac_f32 v240, v31, v167
    v_mul_f32 v235, v32, v152
    v_mul_f32 v237, v40, v120
    v_fmac_f32 v235, v33, v153
    v_fmac_f32 v237, v41, v121
    v_fmac_f32 v235, v34, v154
    v_fmac_f32 v237, v42, v122
    v_fmac_f32 v235, v35, v155
    v_fmac_f32 v237, v43, v123
    v_fmac_f32 v235, v36, v156
    v_fmac_f32 v237, v44, v124
    v_fmac_f32 v235, v37, v157
    v_fmac_f32 v237, v45, v125
    v_fmac_f32 v235, v38, v158
    v_fmac_f32 v237, v46, v126
    v_fmac_f32 v235, v39, v159
    v_fmac_f32 v237, v47, v127
    v_mul_f32 v239, v48, v168
    v_mul_f32 v241, v56, v168
    v_fmac_f32 v239, v49, v169
    v_fmac_f32 v241, v57, v169
    s_setprio 1
    s_waitcnt vmcnt(4) lgkmcnt(0)
    v_mfma_f32_32x32x16_bf16 v[0:15], v[64:67], v[176:179], 0
    ds_read_b64_tr_b16 v[184:185], v246 offset:6144
    ds_read_b64_tr_b16 v[186:187], v246 offset:7168
    ds_read_b64_tr_b16 v[188:189], v247 offset:6144
    ds_read_b64_tr_b16 v[190:191], v247 offset:7168
    v_fmac_f32 v239, v50, v170
    v_fmac_f32 v241, v58, v170
    s_mov_b32 m0, s70
    v_mfma_f32_32x32x16_bf16 v[16:31], v[68:71], v[176:179], 0
    buffer_load_dwordx4 v224, s[4:7], s43 offen sc1 lds
    buffer_load_dwordx4 v225, s[72:75], s43 offen offset:1024 sc1 lds
    v_fmac_f32 v239, v51, v171
    v_fmac_f32 v241, v59, v171
    v_fmac_f32 v239, v52, v172
    v_fmac_f32 v241, v60, v172
    v_fmac_f32 v239, v53, v173
    v_mfma_f32_32x32x16_bf16 v[32:47], v[64:67], v[180:183], 0
    v_add_u32 v222, s48, v251
    ds_read2_b32 v[222:223], v222 offset0:1 offset1:3
    v_fmac_f32 v241, v61, v173
    v_fmac_f32 v239, v54, v174
    v_fmac_f32 v241, v62, v174
    v_fmac_f32 v239, v55, v175
    v_fmac_f32 v241, v63, v175
    v_mfma_f32_32x32x16_bf16 v[48:63], v[68:71], v[180:183], 0
    s_waitcnt vmcnt(4) lgkmcnt(1)
    v_mfma_f32_32x32x16_bf16 v[0:15], v[72:75], v[184:187], v[0:15]
    ds_read_b64_tr_b16 v[176:177], v246 offset:0
    ds_read_b64_tr_b16 v[178:179], v246 offset:1024
    ds_read_b64_tr_b16 v[180:181], v247 offset:0
    ds_read_b64_tr_b16 v[182:183], v247 offset:1024
    s_mov_b32 m0, s71
    v_mfma_f32_32x32x16_bf16 v[16:31], v[76:79], v[184:187], v[16:31]
    buffer_load_dwordx4 v226, s[4:7], s43 offen sc1 lds
    buffer_load_dwordx4 v227, s[72:75], s43 offen offset:1024 sc1 lds
    s_waitcnt lgkmcnt(4)
    v_mad_u32_u16 v222, v222, s39, v248 op_sel:[1,0,0,0]
    v_mad_u32_u16 v223, v223, s39, v248 op_sel:[1,0,0,0]
    v_mfma_f32_32x32x16_bf16 v[32:47], v[72:75], v[188:191], v[32:47]
    v_add_u32 v224, s49, v251
    ds_read2_b32 v[224:225], v224 offset0:1 offset1:3
    v_mfma_f32_32x32x16_bf16 v[48:63], v[76:79], v[188:191], v[48:63]
    s_waitcnt vmcnt(4) lgkmcnt(1)
    v_mfma_f32_32x32x16_bf16 v[0:15], v[80:83], v[176:179], v[0:15]
    ds_read_b64_tr_b16 v[184:185], v246 offset:2048
    ds_read_b64_tr_b16 v[186:187], v246 offset:3072
    ds_read_b64_tr_b16 v[188:189], v247 offset:2048
    ds_read_b64_tr_b16 v[190:191], v247 offset:3072
    s_mov_b32 m0, s68
    v_mfma_f32_32x32x16_bf16 v[16:31], v[84:87], v[176:179], v[16:31]
    buffer_load_dwordx4 v222, s[4:7], s44 offen sc1 lds
    buffer_load_dwordx4 v223, s[72:75], s44 offen offset:1024 sc1 lds
    s_waitcnt lgkmcnt(4)
    v_mad_u32_u16 v224, v224, s39, v248 op_sel:[1,0,0,0]
    v_mad_u32_u16 v225, v225, s39, v248 op_sel:[1,0,0,0]
    v_mfma_f32_32x32x16_bf16 v[32:47], v[80:83], v[180:183], v[32:47]
    v_add_u32 v226, s50, v251
    ds_read2_b32 v[226:227], v226 offset0:1 offset1:3
    v_mul_f32 v242, v0, v144
    v_fma_f32 v238, v8, v160, -v238
    v_fmac_f32 v242, v1, v145
    v_fmac_f32 v238, v9, v161
    v_fmac_f32 v242, v2, v146
    v_mfma_f32_32x32x16_bf16 v[48:63], v[84:87], v[180:183], v[48:63]
    s_setprio 0
    v_fmac_f32 v238, v10, v162
    v_fmac_f32 v242, v3, v147
    v_fmac_f32 v238, v11, v163
    v_fmac_f32 v242, v4, v148
    v_fmac_f32 v238, v12, v164
    v_fmac_f32 v242, v5, v149
    v_fmac_f32 v238, v13, v165
    v_fmac_f32 v242, v6, v150
    v_fmac_f32 v238, v14, v166
    v_fmac_f32 v242, v7, v151
    v_fmac_f32 v238, v15, v167
    v_fmac_f32 v236, v16, v112
    v_mul_f32 v244, v24, v160
    v_fmac_f32 v236, v17, v113
    v_fmac_f32 v244, v25, v161
    v_fmac_f32 v236, v18, v114
    v_fmac_f32 v244, v26, v162
    v_fmac_f32 v236, v19, v115
    v_fmac_f32 v244, v27, v163
    v_fmac_f32 v236, v20, v116
    v_fmac_f32 v244, v28, v164
    v_fmac_f32 v236, v21, v117
    v_fmac_f32 v244, v29, v165
    v_fmac_f32 v236, v22, v118
    v_fmac_f32 v244, v30, v166
    v_fmac_f32 v236, v23, v119
    v_fmac_f32 v244, v31, v167
    v_mul_f32 v243, v32, v152
    v_fma_f32 v239, v40, v168, -v239
    v_fmac_f32 v243, v33, v153
    v_fmac_f32 v239, v41, v169
    v_fmac_f32 v243, v34, v154
    v_fmac_f32 v239, v42, v170
    v_fmac_f32 v243, v35, v155
    v_fmac_f32 v239, v43, v171
    v_fmac_f32 v243, v36, v156
    v_fmac_f32 v239, v44, v172
    v_fmac_f32 v243, v37, v157
    v_fmac_f32 v239, v45, v173
    v_fmac_f32 v243, v38, v158
    v_fmac_f32 v239, v46, v174
    v_fmac_f32 v243, v39, v159
    v_fmac_f32 v239, v47, v175
    v_fmac_f32 v237, v48, v120
    v_mul_f32 v245, v56, v168
    v_fmac_f32 v237, v49, v121
    v_fmac_f32 v245, v57, v169
    v_fmac_f32 v237, v50, v122
    s_setprio 1
    s_waitcnt vmcnt(4) lgkmcnt(1)
    v_mfma_f32_32x32x16_bf16 v[0:15], v[64:67], v[184:187], 0
    ds_read_b64_tr_b16 v[176:177], v246 offset:4096
    ds_read_b64_tr_b16 v[178:179], v246 offset:5120
    ds_read_b64_tr_b16 v[180:181], v247 offset:4096
    ds_read_b64_tr_b16 v[182:183], v247 offset:5120
    v_fmac_f32 v245, v58, v170
    v_fmac_f32 v237, v51, v123
    s_mov_b32 m0, s69
    v_mfma_f32_32x32x16_bf16 v[16:31], v[68:71], v[184:187], 0
    buffer_load_dwordx4 v224, s[4:7], s45 offen sc1 lds
    buffer_load_dwordx4 v225, s[72:75], s45 offen offset:1024 sc1 lds
    s_waitcnt lgkmcnt(4)
    v_mad_u32_u16 v226, v226, s39, v248 op_sel:[1,0,0,0]
    v_mad_u32_u16 v227, v227, s39, v248 op_sel:[1,0,0,0]
    v_fmac_f32 v245, v59, v171
    v_fmac_f32 v237, v52, v124
    v_mfma_f32_32x32x16_bf16 v[32:47], v[64:67], v[188:191], 0
    v_fmac_f32 v245, v60, v172
    v_fmac_f32 v237, v53, v125
    v_fmac_f32 v245, v61, v173
    v_fmac_f32 v237, v54, v126
    v_fmac_f32 v245, v62, v174
    v_fmac_f32 v237, v55, v127
    v_fmac_f32 v245, v63, v175
    v_mfma_f32_32x32x16_bf16 v[48:63], v[68:71], v[188:191], 0
    v_permlane32_swap_b32 v242, v234
    v_permlane32_swap_b32 v243, v235
    v_add_f32 v242, v242, v234
    v_add_f32 v243, v243, v235
    s_waitcnt vmcnt(4) lgkmcnt(0)
    v_mfma_f32_32x32x16_bf16 v[0:15], v[72:75], v[176:179], v[0:15]
    ds_read_b64_tr_b16 v[184:185], v246 offset:6144
    ds_read_b64_tr_b16 v[186:187], v246 offset:7168
    ds_read_b64_tr_b16 v[188:189], v247 offset:6144
    ds_read_b64_tr_b16 v[190:191], v247 offset:7168
    s_mov_b32 m0, s70
    v_mfma_f32_32x32x16_bf16 v[16:31], v[76:79], v[176:179], v[16:31]
    buffer_load_dwordx4 v226, s[4:7], s46 offen sc1 lds
    buffer_load_dwordx4 v227, s[72:75], s46 offen offset:1024 sc1 lds
    s_set_gpr_idx_on s31, gpr_idx(DST)
    s_nop 0
    v_cvt_pk_bf16_f32 v194, v242, v243
    s_set_gpr_idx_off
    s_sub_u32 s26, s48, s29
    s_mov_b32 s29, s48
    v_mfma_f32_32x32x16_bf16 v[32:47], v[72:75], v[180:183], v[32:47]
    s_mov_b32 s30, s3
    s_bfe_u32 s56, s3, 0x40012
    s_cmp_eq_u32 s34, 0
    s_cselect_b32 s56, s56, 0
    s_mov_b32 s32, s31
    s_mov_b32 s31, s35
    v_mfma_f32_32x32x16_bf16 v[48:63], v[76:79], v[180:183], v[48:63]
    s_waitcnt vmcnt(4) lgkmcnt(0)
    v_mfma_f32_32x32x16_bf16 v[0:15], v[80:83], v[184:187], v[0:15]
    ds_read_b64_tr_b16 v[176:177], v246 offset:0
    ds_read_b64_tr_b16 v[178:179], v246 offset:1024
    ds_read_b64_tr_b16 v[180:181], v247 offset:0
    ds_read_b64_tr_b16 v[182:183], v247 offset:1024
    s_mov_b32 m0, s71
    v_mfma_f32_32x32x16_bf16 v[16:31], v[84:87], v[184:187], v[16:31]
    s_cmp_eq_u32 s33, 4
    s_cbranch_scc1 K2_g4_49
    buffer_load_dwordx4 v224, s[4:7], s47 offen sc1 lds
    buffer_load_dwordx4 v225, s[72:75], s47 offen offset:1024 sc1 lds
K2_back_50:
    v_mfma_f32_32x32x16_bf16 v[32:47], v[80:83], v[188:191], v[32:47]
    s_nop 0
    v_mul_f32 v242, v0, v144
    v_fma_f32 v240, v8, v160, -v240
    v_fmac_f32 v242, v1, v145
    v_fmac_f32 v240, v9, v161
    v_fmac_f32 v242, v2, v146
    v_fmac_f32 v240, v10, v162
    v_fmac_f32 v242, v3, v147
    v_mfma_f32_32x32x16_bf16 v[48:63], v[84:87], v[188:191], v[48:63]
    s_setprio 0
    v_fmac_f32 v240, v11, v163
    v_fmac_f32 v242, v4, v148
    v_fmac_f32 v240, v12, v164
    v_fmac_f32 v242, v5, v149
    v_fmac_f32 v240, v13, v165
    v_fmac_f32 v242, v6, v150
    v_fmac_f32 v240, v14, v166
    v_fmac_f32 v242, v7, v151
    v_fmac_f32 v240, v15, v167
    v_add_u32 v249, s26, v249
    v_add_u32 v250, s26, v250
    v_fma_f32 v244, v16, v160, -v244
    v_fmac_f32 v236, v24, v112
    v_fmac_f32 v244, v17, v161
    v_fmac_f32 v236, v25, v113
    v_fmac_f32 v244, v18, v162
    v_fmac_f32 v236, v26, v114
    v_fmac_f32 v244, v19, v163
    v_fmac_f32 v236, v27, v115
    v_fmac_f32 v244, v20, v164
    v_fmac_f32 v236, v28, v116
    v_fmac_f32 v244, v21, v165
    v_fmac_f32 v236, v29, v117
    v_fmac_f32 v244, v22, v166
    v_fmac_f32 v236, v30, v118
    v_fmac_f32 v244, v23, v167
    v_fmac_f32 v236, v31, v119
    ds_read_b64_tr_b16 v[0:1], v249 offset:0
    ds_read_b64_tr_b16 v[2:3], v249 offset:32
    ds_read_u16_d16_hi v16, v250 offset:0
    v_mul_f32 v243, v32, v152
    v_fma_f32 v241, v40, v168, -v241
    v_fmac_f32 v243, v33, v153
    v_fmac_f32 v241, v41, v169
    v_fmac_f32 v243, v34, v154
    v_fmac_f32 v241, v42, v170
    v_fmac_f32 v243, v35, v155
    v_fmac_f32 v241, v43, v171
    v_fmac_f32 v243, v36, v156
    v_fmac_f32 v241, v44, v172
    v_fmac_f32 v243, v37, v157
    v_fmac_f32 v241, v45, v173
    v_fmac_f32 v243, v38, v158
    v_fmac_f32 v241, v46, v174
    v_fmac_f32 v243, v39, v159
    v_fmac_f32 v241, v47, v175
    ds_read_b64_tr_b16 v[4:5], v249 offset:512
    ds_read_b64_tr_b16 v[6:7], v249 offset:544
    ds_read_u16_d16_hi v17, v250 offset:128
    v_fma_f32 v245, v48, v168, -v245
    v_fmac_f32 v237, v56, v120
    v_fmac_f32 v245, v49, v169
    v_fmac_f32 v237, v57, v121
    v_fmac_f32 v245, v50, v170
    v_fmac_f32 v237, v58, v122
    v_fmac_f32 v245, v51, v171
    v_fmac_f32 v237, v59, v123
    v_fmac_f32 v245, v52, v172
    v_fmac_f32 v237, v60, v124
    v_fmac_f32 v245, v53, v173
    v_fmac_f32 v237, v61, v125
    v_fmac_f32 v245, v54, v174
    v_fmac_f32 v237, v62, v126
    v_fmac_f32 v245, v55, v175
    v_fmac_f32 v237, v63, v127
    s_cmp_eq_u32 s56, 5
    s_cbranch_scc1 K2_U20
    s_cmp_eq_u32 s56, 6
    s_cbranch_scc1 K2_U3h0
    s_branch K2_DSP0
K2_PAD_U21:
    s_branch K2_HOP
K2_U21:
    s_setprio 1
    s_waitcnt lgkmcnt(0)
    v_lshlrev_b32 v20, 16, v0
    v_and_b32 v21, 0xffff0000, v0
    v_lshlrev_b32 v22, 16, v1
    v_and_b32 v23, 0xffff0000, v1
    v_lshlrev_b32 v24, 16, v2
    v_and_b32 v25, 0xffff0000, v2
    v_lshlrev_b32 v26, 16, v3
    v_and_b32 v27, 0xffff0000, v3
    v_mul_f32_dpp v36, v16, v20 row_newbcast:8 row_mask:0xf bank_mask:0xf
    v_mul_f32_dpp v37, v16, v21 row_newbcast:9 row_mask:0xf bank_mask:0xf
    v_mul_f32_dpp v38, v16, v22 row_newbcast:10 row_mask:0xf bank_mask:0xf
    v_mul_f32_dpp v39, v16, v23 row_newbcast:11 row_mask:0xf bank_mask:0xf
    v_mul_f32_dpp v40, v16, v24 row_newbcast:12 row_mask:0xf bank_mask:0xf
    v_mul_f32_dpp v41, v16, v25 row_newbcast:13 row_mask:0xf bank_mask:0xf
    v_mul_f32_dpp v42, v16, v26 row_newbcast:14 row_mask:0xf bank_mask:0xf
    v_mul_f32_dpp v43, v16, v27 row_newbcast:15 row_mask:0xf bank_mask:0xf
    v_cvt_pk_bf16_f32 v68, v36, v37
    v_cvt_pk_bf16_f32 v69, v38, v39
    v_cvt_pk_bf16_f32 v70, v40, v41
    v_cvt_pk_bf16_f32 v71, v42, v43
    v_mul_f32_dpp v20, v16, v20 row_newbcast:0 row_mask:0xa bank_mask:0xf
    v_mul_f32_dpp v21, v16, v21 row_newbcast:1 row_mask:0xa bank_mask:0xf
    v_mul_f32_dpp v22, v16, v22 row_newbcast:2 row_mask:0xa bank_mask:0xf
    v_mul_f32_dpp v23, v16, v23 row_newbcast:3 row_mask:0xa bank_mask:0xf
    v_mul_f32_dpp v24, v16, v24 row_newbcast:4 row_mask:0xa bank_mask:0xf
    v_mul_f32_dpp v25, v16, v25 row_newbcast:5 row_mask:0xa bank_mask:0xf
    v_mul_f32_dpp v26, v16, v26 row_newbcast:6 row_mask:0xa bank_mask:0xf
    v_mul_f32_dpp v27, v16, v27 row_newbcast:7 row_mask:0xa bank_mask:0xf
    v_cvt_pk_bf16_f32 v64, v20, v21
    v_cvt_pk_bf16_f32 v65, v22, v23
    v_cvt_pk_bf16_f32 v66, v24, v25
    v_cvt_pk_bf16_f32 v67, v26, v27
    v_lshlrev_b32 v28, 16, v4
    v_and_b32 v29, 0xffff0000, v4
    v_lshlrev_b32 v30, 16, v5
    v_and_b32 v31, 0xffff0000, v5
    v_lshlrev_b32 v32, 16, v6
    v_and_b32 v33, 0xffff0000, v6
    v_lshlrev_b32 v34, 16, v7
    v_and_b32 v35, 0xffff0000, v7
    v_mul_f32_dpp v36, v17, v28 row_newbcast:8 row_mask:0xf bank_mask:0xf
    v_mul_f32_dpp v37, v17, v29 row_newbcast:9 row_mask:0xf bank_mask:0xf
    v_mul_f32_dpp v38, v17, v30 row_newbcast:10 row_mask:0xf bank_mask:0xf
    v_mul_f32_dpp v39, v17, v31 row_newbcast:11 row_mask:0xf bank_mask:0xf
    v_mul_f32_dpp v40, v17, v32 row_newbcast:12 row_mask:0xf bank_mask:0xf
    v_mul_f32_dpp v41, v17, v33 row_newbcast:13 row_mask:0xf bank_mask:0xf
    v_mul_f32_dpp v42, v17, v34 row_newbcast:14 row_mask:0xf bank_mask:0xf
    v_mul_f32_dpp v43, v17, v35 row_newbcast:15 row_mask:0xf bank_mask:0xf
    v_cvt_pk_bf16_f32 v76, v36, v37
    v_cvt_pk_bf16_f32 v77, v38, v39
    v_cvt_pk_bf16_f32 v78, v40, v41
    v_cvt_pk_bf16_f32 v79, v42, v43
    v_mul_f32_dpp v28, v17, v28 row_newbcast:0 row_mask:0xa bank_mask:0xf
    v_mul_f32_dpp v29, v17, v29 row_newbcast:1 row_mask:0xa bank_mask:0xf
    v_mul_f32_dpp v30, v17, v30 row_newbcast:2 row_mask:0xa bank_mask:0xf
    v_mul_f32_dpp v31, v17, v31 row_newbcast:3 row_mask:0xa bank_mask:0xf
    v_mul_f32_dpp v32, v17, v32 row_newbcast:4 row_mask:0xa bank_mask:0xf
    v_mul_f32_dpp v33, v17, v33 row_newbcast:5 row_mask:0xa bank_mask:0xf
    v_mul_f32_dpp v34, v17, v34 row_newbcast:6 row_mask:0xa bank_mask:0xf
    v_mul_f32_dpp v35, v17, v35 row_newbcast:7 row_mask:0xa bank_mask:0xf
    v_cvt_pk_bf16_f32 v72, v28, v29
    v_cvt_pk_bf16_f32 v73, v30, v31
    v_cvt_pk_bf16_f32 v74, v32, v33
    v_cvt_pk_bf16_f32 v75, v34, v35
    s_waitcnt vmcnt(4)
    v_mfma_f32_32x32x16_bf16 v[0:15], v[64:67], v[176:179], 0
    ds_read_b64_tr_b16 v[184:185], v246 offset:2048
    ds_read_b64_tr_b16 v[186:187], v246 offset:3072
    ds_read_b64_tr_b16 v[188:189], v247 offset:2048
    ds_read_b64_tr_b16 v[190:191], v247 offset:3072
    s_mov_b32 m0, s68
    v_mfma_f32_32x32x16_bf16 v[16:31], v[68:71], v[176:179], 0
    buffer_load_dwordx4 v222, s[4:7], s42 offen sc1 lds
    buffer_load_dwordx4 v223, s[72:75], s42 offen offset:1024 sc1 lds
    v_permlane32_swap_b32 v242, v236
    v_permlane32_swap_b32 v243, v237
    v_mfma_f32_32x32x16_bf16 v[32:47], v[64:67], v[180:183], 0
    v_permlane32_swap_b32 v244, v238
    v_permlane32_swap_b32 v245, v239
    v_permlane32_swap_b32 v240, v241
    v_add_f32 v242, v242, v236
    v_mfma_f32_32x32x16_bf16 v[48:63], v[68:71], v[180:183], 0
    v_add_f32 v243, v243, v237
    v_add_f32 v244, v244, v238
    v_add_f32 v245, v245, v239
    v_add_f32 v240, -v240, -v241
    v_sub_u32 v241, v230, v231
    v_cvt_pk_bf16_f32 v242, v242, v243
    s_mov_b64 exec, 0x3ff
    ds_add_rtn_u32 v232, v254, v255
    s_mov_b64 exec, -1
    s_waitcnt vmcnt(4) lgkmcnt(1)
    v_mfma_f32_32x32x16_bf16 v[0:15], v[72:75], v[184:187], v[0:15]
    ds_read_b64_tr_b16 v[176:177], v246 offset:4096
    ds_read_b64_tr_b16 v[178:179], v246 offset:5120
    ds_read_b64_tr_b16 v[180:181], v247 offset:4096
    ds_read_b64_tr_b16 v[182:183], v247 offset:5120
    v_cvt_pk_bf16_f32 v244, v244, v245
    v_cvt_pk_bf16_f32 v240, v240, v240
    s_mov_b32 m0, s69
    v_mfma_f32_32x32x16_bf16 v[16:31], v[76:79], v[184:187], v[16:31]
    buffer_load_dwordx4 v224, s[4:7], s42 offen sc1 lds
    buffer_load_dwordx4 v225, s[72:75], s42 offen offset:1024 sc1 lds
    ds_write2st64_b32 v230, v242, v244 offset0:3 offset1:4
    ds_write_b16 v241, v240 offset:1280
    s_waitcnt lgkmcnt(6)
    v_readlane_b32 s58, v232, 8
    v_mfma_f32_32x32x16_bf16 v[32:47], v[72:75], v[188:191], v[32:47]
    s_cmp_lt_u32 s58, s22
    s_cbranch_scc0 K2_nul_55
    s_nop 0
    v_readlane_b32 s3, v253, s58
    s_nop 0
    s_bfe_u32 s58, s3, 0x60016
    s_and_b32 s59, s58, 7
    s_lshr_b32 s60, s58, 3
K2_chk_57:
    v_readlane_b32 s61, v232, s59
    s_nop 0
    s_cmp_gt_u32 s61, s60
    s_cbranch_scc0 K2_spin_56
K2_back_58:
    v_mfma_f32_32x32x16_bf16 v[48:63], v[76:79], v[188:191], v[48:63]
    s_setprio 0
    s_lshl_b32 s44, s34, 7
    s_and_b32 s48, s3, 0x3ffff
    s_bfe_u32 s33, s3, 0x30013
    s_mov_b32 s35, s48
    s_mov_b32 s45, s44
    s_xor_b32 s47, s44, 256
    v_mul_f32 v234, v0, v96
    v_mul_f32 v236, v8, v128
    v_fmac_f32 v234, v1, v97
    v_fmac_f32 v236, v9, v129
    v_fmac_f32 v234, v2, v98
    v_fmac_f32 v236, v10, v130
    v_fmac_f32 v234, v3, v99
    v_fmac_f32 v236, v11, v131
    v_fmac_f32 v234, v4, v100
    v_fmac_f32 v236, v12, v132
    v_fmac_f32 v234, v5, v101
    v_fmac_f32 v236, v13, v133
    v_fmac_f32 v234, v6, v102
    v_fmac_f32 v236, v14, v134
    v_fmac_f32 v234, v7, v103
    v_fmac_f32 v236, v15, v135
    v_mul_f32 v238, v16, v128
    v_mul_f32 v240, v24, v128
    v_fmac_f32 v238, v17, v129
    v_fmac_f32 v240, v25, v129
    v_fmac_f32 v238, v18, v130
    v_fmac_f32 v240, v26, v130
    v_fmac_f32 v238, v19, v131
    v_fmac_f32 v240, v27, v131
    v_fmac_f32 v238, v20, v132
    v_fmac_f32 v240, v28, v132
    v_fmac_f32 v238, v21, v133
    v_fmac_f32 v240, v29, v133
    v_fmac_f32 v238, v22, v134
    v_fmac_f32 v240, v30, v134
    v_fmac_f32 v238, v23, v135
    v_fmac_f32 v240, v31, v135
    v_mul_f32 v235, v32, v104
    v_mul_f32 v237, v40, v136
    v_fmac_f32 v235, v33, v105
    v_fmac_f32 v237, v41, v137
    v_fmac_f32 v235, v34, v106
    v_fmac_f32 v237, v42, v138
    v_fmac_f32 v235, v35, v107
    v_fmac_f32 v237, v43, v139
    v_fmac_f32 v235, v36, v108
    v_fmac_f32 v237, v44, v140
    v_fmac_f32 v235, v37, v109
    v_fmac_f32 v237, v45, v141
    v_fmac_f32 v235, v38, v110
    v_fmac_f32 v237, v46, v142
    v_fmac_f32 v235, v39, v111
    v_fmac_f32 v237, v47, v143
    v_mul_f32 v239, v48, v136
    v_mul_f32 v241, v56, v136
    v_fmac_f32 v239, v49, v137
    v_fmac_f32 v241, v57, v137
    s_setprio 1
    s_waitcnt vmcnt(4) lgkmcnt(2)
    v_mfma_f32_32x32x16_bf16 v[0:15], v[64:67], v[176:179], 0
    ds_read_b64_tr_b16 v[184:185], v246 offset:6144
    ds_read_b64_tr_b16 v[186:187], v246 offset:7168
    ds_read_b64_tr_b16 v[188:189], v247 offset:6144
    ds_read_b64_tr_b16 v[190:191], v247 offset:7168
    v_fmac_f32 v239, v50, v138
    v_fmac_f32 v241, v58, v138
    s_mov_b32 m0, s70
    v_mfma_f32_32x32x16_bf16 v[16:31], v[68:71], v[176:179], 0
    buffer_load_dwordx4 v222, s[4:7], s43 offen sc1 lds
    buffer_load_dwordx4 v223, s[72:75], s43 offen offset:1024 sc1 lds
    v_fmac_f32 v239, v51, v139
    v_fmac_f32 v241, v59, v139
    v_fmac_f32 v239, v52, v140
    v_fmac_f32 v241, v60, v140
    v_fmac_f32 v239, v53, v141
    v_mfma_f32_32x32x16_bf16 v[32:47], v[64:67], v[180:183], 0
    s_add_u32 s49, s48, 128
    s_add_u32 s60, s48, 256
    s_cmp_eq_u32 s33, 3
    s_cselect_b32 s46, s44, s47
    s_cselect_b32 s50, s60, s48
    s_sub_u32 s60, s33, 2
    s_cmp_lt_u32 s60, 2
    s_cbranch_scc0 K2_rare_59
K2_back_60:
    v_add_u32 v222, s48, v251
    ds_read2_b32 v[222:223], v222 offset0:1 offset1:3
    v_fmac_f32 v241, v61, v141
    v_fmac_f32 v239, v54, v142
    v_fmac_f32 v241, v62, v142
    v_fmac_f32 v239, v55, v143
    v_fmac_f32 v241, v63, v143
    v_mfma_f32_32x32x16_bf16 v[48:63], v[68:71], v[180:183], 0
    v_permlane32_swap_b32 v234, v236
    v_permlane32_swap_b32 v235, v237
    v_permlane32_swap_b32 v240, v238
    s_waitcnt vmcnt(4) lgkmcnt(1)
    v_mfma_f32_32x32x16_bf16 v[0:15], v[72:75], v[184:187], v[0:15]
    ds_read_b64_tr_b16 v[176:177], v246 offset:0
    ds_read_b64_tr_b16 v[178:179], v246 offset:1024
    ds_read_b64_tr_b16 v[180:181], v247 offset:0
    ds_read_b64_tr_b16 v[182:183], v247 offset:1024
    v_permlane32_swap_b32 v241, v239
    s_mov_b32 m0, s71
    v_mfma_f32_32x32x16_bf16 v[16:31], v[76:79], v[184:187], v[16:31]
    buffer_load_dwordx4 v224, s[4:7], s43 offen sc1 lds
    buffer_load_dwordx4 v225, s[72:75], s43 offen offset:1024 sc1 lds
    s_waitcnt lgkmcnt(4)
    v_mad_u32_u16 v222, v222, s39, v248 op_sel:[1,0,0,0]
    v_mad_u32_u16 v223, v223, s39, v248 op_sel:[1,0,0,0]
    v_lshl_add_u32 v230, v252, 1, s31
    v_add_f32 v234, v234, v236
    v_add_f32 v235, v235, v237
    v_add_f32 v240, v240, v238
    v_add_f32 v241, v241, v239
    v_cvt_pk_bf16_f32 v234, v234, v235
    v_cvt_pk_bf16_f32 v240, v240, v241
    ds_write2st64_b32 v230, v234, v240 offset0:0 offset1:1
    v_mfma_f32_32x32x16_bf16 v[32:47], v[72:75], v[188:191], v[32:47]
    v_add_u32 v224, s49, v251
    ds_read2_b32 v[224:225], v224 offset0:1 offset1:3
    v_mul_f32 v234, v0, v144
    v_mul_f32 v236, v8, v112
    v_fmac_f32 v234, v1, v145
    v_fmac_f32 v236, v9, v113
    v_fmac_f32 v234, v2, v146
    v_mfma_f32_32x32x16_bf16 v[48:63], v[76:79], v[188:191], v[48:63]
    s_setprio 0
    v_fmac_f32 v236, v10, v114
    v_fmac_f32 v234, v3, v147
    v_fmac_f32 v236, v11, v115
    v_fmac_f32 v234, v4, v148
    v_fmac_f32 v236, v12, v116
    v_fmac_f32 v234, v5, v149
    v_fmac_f32 v236, v13, v117
    v_fmac_f32 v234, v6, v150
    v_fmac_f32 v236, v14, v118
    v_fmac_f32 v234, v7, v151
    v_fmac_f32 v236, v15, v119
    v_mul_f32 v238, v16, v160
    v_mul_f32 v240, v24, v160
    v_fmac_f32 v238, v17, v161
    v_fmac_f32 v240, v25, v161
    v_fmac_f32 v238, v18, v162
    v_fmac_f32 v240, v26, v162
    v_fmac_f32 v238, v19, v163
    v_fmac_f32 v240, v27, v163
    v_fmac_f32 v238, v20, v164
    v_fmac_f32 v240, v28, v164
    v_fmac_f32 v238, v21, v165
    v_fmac_f32 v240, v29, v165
    v_fmac_f32 v238, v22, v166
    v_fmac_f32 v240, v30, v166
    v_fmac_f32 v238, v23, v167
    v_fmac_f32 v240, v31, v167
    v_mul_f32 v235, v32, v152
    v_mul_f32 v237, v40, v120
    v_fmac_f32 v235, v33, v153
    v_fmac_f32 v237, v41, v121
    v_fmac_f32 v235, v34, v154
    v_fmac_f32 v237, v42, v122
    v_fmac_f32 v235, v35, v155
    v_fmac_f32 v237, v43, v123
    v_fmac_f32 v235, v36, v156
    v_fmac_f32 v237, v44, v124
    v_fmac_f32 v235, v37, v157
    v_fmac_f32 v237, v45, v125
    v_fmac_f32 v235, v38, v158
    v_fmac_f32 v237, v46, v126
    v_fmac_f32 v235, v39, v159
    v_fmac_f32 v237, v47, v127
    v_mul_f32 v239, v48, v168
    v_mul_f32 v241, v56, v168
    v_fmac_f32 v239, v49, v169
    v_fmac_f32 v241, v57, v169
    v_fmac_f32 v239, v50, v170
    v_fmac_f32 v241, v58, v170
    v_fmac_f32 v239, v51, v171
    s_setprio 1
    s_waitcnt vmcnt(4) lgkmcnt(2)
    v_mfma_f32_32x32x16_bf16 v[0:15], v[64:67], v[176:179], 0
    ds_read_b64_tr_b16 v[184:185], v246 offset:2048
    ds_read_b64_tr_b16 v[186:187], v246 offset:3072
    ds_read_b64_tr_b16 v[188:189], v247 offset:2048
    ds_read_b64_tr_b16 v[190:191], v247 offset:3072
    v_fmac_f32 v241, v59, v171
    v_fmac_f32 v239, v52, v172
    s_mov_b32 m0, s68
    v_mfma_f32_32x32x16_bf16 v[16:31], v[68:71], v[176:179], 0
    buffer_load_dwordx4 v222, s[4:7], s44 offen sc1 lds
    buffer_load_dwordx4 v223, s[72:75], s44 offen offset:1024 sc1 lds
    s_waitcnt lgkmcnt(4)
    v_mad_u32_u16 v224, v224, s39, v248 op_sel:[1,0,0,0]
    v_mad_u32_u16 v225, v225, s39, v248 op_sel:[1,0,0,0]
    v_fmac_f32 v241, v60, v172
    v_fmac_f32 v239, v53, v173
    v_mfma_f32_32x32x16_bf16 v[32:47], v[64:67], v[180:183], 0
    v_add_u32 v226, s50, v251
    ds_read2_b32 v[226:227], v226 offset0:1 offset1:3
    v_fmac_f32 v241, v61, v173
    v_fmac_f32 v239, v54, v174
    v_fmac_f32 v241, v62, v174
    v_fmac_f32 v239, v55, v175
    v_fmac_f32 v241, v63, v175
    v_mfma_f32_32x32x16_bf16 v[48:63], v[68:71], v[180:183], 0
    s_waitcnt vmcnt(4) lgkmcnt(1)
    v_mfma_f32_32x32x16_bf16 v[0:15], v[72:75], v[184:187], v[0:15]
    ds_read_b64_tr_b16 v[176:177], v246 offset:4096
    ds_read_b64_tr_b16 v[178:179], v246 offset:5120
    ds_read_b64_tr_b16 v[180:181], v247 offset:4096
    ds_read_b64_tr_b16 v[182:183], v247 offset:5120
    s_mov_b32 m0, s69
    v_mfma_f32_32x32x16_bf16 v[16:31], v[76:79], v[184:187], v[16:31]
    buffer_load_dwordx4 v224, s[4:7], s45 offen sc1 lds
    buffer_load_dwordx4 v225, s[72:75], s45 offen offset:1024 sc1 lds
    s_waitcnt lgkmcnt(4)
    v_mad_u32_u16 v226, v226, s39, v248 op_sel:[1,0,0,0]
    v_mad_u32_u16 v227, v227, s39, v248 op_sel:[1,0,0,0]
    v_mfma_f32_32x32x16_bf16 v[32:47], v[72:75], v[188:191], v[32:47]
    v_mul_f32 v242, v0, v144
    v_fma_f32 v238, v8, v160, -v238
    v_fmac_f32 v242, v1, v145
    v_fmac_f32 v238, v9, v161
    v_fmac_f32 v242, v2, v146
    v_fmac_f32 v238, v10, v162
    v_fmac_f32 v242, v3, v147
    v_mfma_f32_32x32x16_bf16 v[48:63], v[76:79], v[188:191], v[48:63]
    s_setprio 0
    v_fmac_f32 v238, v11, v163
    v_fmac_f32 v242, v4, v148
    v_fmac_f32 v238, v12, v164
    v_fmac_f32 v242, v5, v149
    v_fmac_f32 v238, v13, v165
    v_fmac_f32 v242, v6, v150
    v_fmac_f32 v238, v14, v166
    v_fmac_f32 v242, v7, v151
    v_fmac_f32 v238, v15, v167
    v_fmac_f32 v236, v16, v112
    v_mul_f32 v244, v24, v160
    v_fmac_f32 v236, v17, v113
    v_fmac_f32 v244, v25, v161
    v_fmac_f32 v236, v18, v114
    v_fmac_f32 v244, v26, v162
    v_fmac_f32 v236, v19, v115
    v_fmac_f32 v244, v27, v163
    v_fmac_f32 v236, v20, v116
    v_fmac_f32 v244, v28, v164
    v_fmac_f32 v236, v21, v117
    v_fmac_f32 v244, v29, v165
    v_fmac_f32 v236, v22, v118
    v_fmac_f32 v244, v30, v166
    v_fmac_f32 v236, v23, v119
    v_fmac_f32 v244, v31, v167
    v_mul_f32 v243, v32, v152
    v_fma_f32 v239, v40, v168, -v239
    v_fmac_f32 v243, v33, v153
    v_fmac_f32 v239, v41, v169
    v_fmac_f32 v243, v34, v154
    v_fmac_f32 v239, v42, v170
    v_fmac_f32 v243, v35, v155
    v_fmac_f32 v239, v43, v171
    v_fmac_f32 v243, v36, v156
    v_fmac_f32 v239, v44, v172
    v_fmac_f32 v243, v37, v157
    v_fmac_f32 v239, v45, v173
    v_fmac_f32 v243, v38, v158
    v_fmac_f32 v239, v46, v174
    v_fmac_f32 v243, v39, v159
    v_fmac_f32 v239, v47, v175
    v_fmac_f32 v237, v48, v120
    v_mul_f32 v245, v56, v168
    s_setprio 1
    s_waitcnt vmcnt(4) lgkmcnt(0)
    v_mfma_f32_32x32x16_bf16 v[0:15], v[64:67], v[176:179], 0
    ds_read_b64_tr_b16 v[184:185], v246 offset:6144
    ds_read_b64_tr_b16 v[186:187], v246 offset:7168
    ds_read_b64_tr_b16 v[188:189], v247 offset:6144
    ds_read_b64_tr_b16 v[190:191], v247 offset:7168
    v_fmac_f32 v237, v49, v121
    v_fmac_f32 v245, v57, v169
    s_mov_b32 m0, s70
    v_mfma_f32_32x32x16_bf16 v[16:31], v[68:71], v[176:179], 0
    buffer_load_dwordx4 v226, s[4:7], s46 offen sc1 lds
    buffer_load_dwordx4 v227, s[72:75], s46 offen offset:1024 sc1 lds
    v_fmac_f32 v237, v50, v122
    v_fmac_f32 v245, v58, v170
    v_fmac_f32 v237, v51, v123
    v_fmac_f32 v245, v59, v171
    v_fmac_f32 v237, v52, v124
    v_mfma_f32_32x32x16_bf16 v[32:47], v[64:67], v[180:183], 0
    v_fmac_f32 v245, v60, v172
    v_fmac_f32 v237, v53, v125
    v_fmac_f32 v245, v61, v173
    v_fmac_f32 v237, v54, v126
    v_fmac_f32 v245, v62, v174
    v_fmac_f32 v237, v55, v127
    v_fmac_f32 v245, v63, v175
    v_mfma_f32_32x32x16_bf16 v[48:63], v[68:71], v[180:183], 0
    v_permlane32_swap_b32 v242, v234
    v_permlane32_swap_b32 v243, v235
    v_add_f32 v242, v242, v234
    v_add_f32 v243, v243, v235
    s_waitcnt vmcnt(4) lgkmcnt(0)
    v_mfma_f32_32x32x16_bf16 v[0:15], v[72:75], v[184:187], v[0:15]
    ds_read_b64_tr_b16 v[176:177], v246 offset:0
    ds_read_b64_tr_b16 v[178:179], v246 offset:1024
    ds_read_b64_tr_b16 v[180:181], v247 offset:0
    ds_read_b64_tr_b16 v[182:183], v247 offset:1024
    v_cvt_pk_bf16_f32 v242, v242, v243
    ds_write_b32 v230, v242 offset:512
    s_mov_b32 m0, s71
    v_mfma_f32_32x32x16_bf16 v[16:31], v[76:79], v[184:187], v[16:31]
    s_cmp_eq_u32 s33, 4
    s_cbranch_scc1 K2_g4_62
    buffer_load_dwordx4 v224, s[4:7], s47 offen sc1 lds
    buffer_load_dwordx4 v225, s[72:75], s47 offen offset:1024 sc1 lds
K2_back_63:
    s_sub_u32 s26, s48, s29
    s_mov_b32 s29, s48
    s_mov_b32 s30, s3
    s_bfe_u32 s56, s3, 0x40012
    s_cmp_lg_u32 s36, 0
    s_cselect_b32 s56, s56, 0
    v_mfma_f32_32x32x16_bf16 v[32:47], v[72:75], v[188:191], v[32:47]
    s_mov_b32 s32, s31
    s_mov_b32 s31, s35
    v_mul_f32 v242, v0, v144
    v_fma_f32 v240, v8, v160, -v240
    v_fmac_f32 v242, v1, v145
    v_fmac_f32 v240, v9, v161
    v_fmac_f32 v242, v2, v146
    v_mfma_f32_32x32x16_bf16 v[48:63], v[76:79], v[188:191], v[48:63]
    s_setprio 0
    v_fmac_f32 v240, v10, v162
    v_fmac_f32 v242, v3, v147
    v_fmac_f32 v240, v11, v163
    v_fmac_f32 v242, v4, v148
    v_fmac_f32 v240, v12, v164
    v_fmac_f32 v242, v5, v149
    v_fmac_f32 v240, v13, v165
    v_fmac_f32 v242, v6, v150
    v_fmac_f32 v240, v14, v166
    v_fmac_f32 v242, v7, v151
    v_fmac_f32 v240, v15, v167
    v_add_u32 v249, s26, v249
    v_add_u32 v250, s26, v250
    v_fma_f32 v244, v16, v160, -v244
    v_fmac_f32 v236, v24, v112
    v_fmac_f32 v244, v17, v161
    v_fmac_f32 v236, v25, v113
    v_fmac_f32 v244, v18, v162
    v_fmac_f32 v236, v26, v114
    v_fmac_f32 v244, v19, v163
    v_fmac_f32 v236, v27, v115
    v_fmac_f32 v244, v20, v164
    v_fmac_f32 v236, v28, v116
    v_fmac_f32 v244, v21, v165
    v_fmac_f32 v236, v29, v117
    v_fmac_f32 v244, v22, v166
    v_fmac_f32 v236, v30, v118
    v_fmac_f32 v244, v23, v167
    v_fmac_f32 v236, v31, v119
    ds_read_b64_tr_b16 v[0:1], v249 offset:0
    ds_read_b64_tr_b16 v[2:3], v249 offset:32
    ds_read_u16_d16_hi v16, v250 offset:0
    v_mul_f32 v243, v32, v152
    v_fma_f32 v241, v40, v168, -v241
    v_fmac_f32 v243, v33, v153
    v_fmac_f32 v241, v41, v169
    v_fmac_f32 v243, v34, v154
    v_fmac_f32 v241, v42, v170
    v_fmac_f32 v243, v35, v155
    v_fmac_f32 v241, v43, v171
    v_fmac_f32 v243, v36, v156
    v_fmac_f32 v241, v44, v172
    v_fmac_f32 v243, v37, v157
    v_fmac_f32 v241, v45, v173
    v_fmac_f32 v243, v38, v158
    v_fmac_f32 v241, v46, v174
    v_fmac_f32 v243, v39, v159
    v_fmac_f32 v241, v47, v175
    ds_read_b64_tr_b16 v[4:5], v249 offset:512
    ds_read_b64_tr_b16 v[6:7], v249 offset:544
    ds_read_u16_d16_hi v17, v250 offset:128
    v_fma_f32 v245, v48, v168, -v245
    v_fmac_f32 v237, v56, v120
    v_fmac_f32 v245, v49, v169
    v_fmac_f32 v237, v57, v121
    v_fmac_f32 v245, v50, v170
    v_fmac_f32 v237, v58, v122
    v_fmac_f32 v245, v51, v171
    v_fmac_f32 v237, v59, v123
    v_fmac_f32 v245, v52, v172
    v_fmac_f32 v237, v60, v124
    v_fmac_f32 v245, v53, v173
    v_fmac_f32 v237, v61, v125
    v_fmac_f32 v245, v54, v174
    v_fmac_f32 v237, v62, v126
    v_fmac_f32 v245, v55, v175
    v_fmac_f32 v237, v63, v127
    s_cmp_eq_u32 s56, 5
    s_cbranch_scc1 K2_U21
    s_cmp_eq_u32 s56, 6
    s_cbranch_scc1 K2_U3h1
    s_branch K2_DSP1
K2_PAD_U31:
    s_branch K2_HOP
K2_U3h1:
    s_setprio 1
    ds_read_b64_tr_b16 v[8:9], v249 offset:1024
    ds_read_u16_d16_hi v18, v250 offset:256
    s_waitcnt lgkmcnt(2)
    v_lshlrev_b32 v20, 16, v0
    v_and_b32 v21, 0xffff0000, v0
    v_lshlrev_b32 v22, 16, v1
    v_and_b32 v23, 0xffff0000, v1
    v_lshlrev_b32 v24, 16, v2
    v_and_b32 v25, 0xffff0000, v2
    v_lshlrev_b32 v26, 16, v3
    v_and_b32 v27, 0xffff0000, v3
    v_mul_f32_dpp v36, v16, v20 row_newbcast:8 row_mask:0xf bank_mask:0xf
    v_mul_f32_dpp v37, v16, v21 row_newbcast:9 row_mask:0xf bank_mask:0xf
    v_mul_f32_dpp v38, v16, v22 row_newbcast:10 row_mask:0xf bank_mask:0xf
    v_mul_f32_dpp v39, v16, v23 row_newbcast:11 row_mask:0xf bank_mask:0xf
    v_mul_f32_dpp v40, v16, v24 row_newbcast:12 row_mask:0xf bank_mask:0xf
    v_mul_f32_dpp v41, v16, v25 row_newbcast:13 row_mask:0xf bank_mask:0xf
    v_mul_f32_dpp v42, v16, v26 row_newbcast:14 row_mask:0xf bank_mask:0xf
    v_mul_f32_dpp v43, v16, v27 row_newbcast:15 row_mask:0xf bank_mask:0xf
    v_cvt_pk_bf16_f32 v68, v36, v37
    v_cvt_pk_bf16_f32 v69, v38, v39
    v_cvt_pk_bf16_f32 v70, v40, v41
    v_cvt_pk_bf16_f32 v71, v42, v43
    v_mul_f32_dpp v20, v16, v20 row_newbcast:0 row_mask:0xa bank_mask:0xf
    v_mul_f32_dpp v21, v16, v21 row_newbcast:1 row_mask:0xa bank_mask:0xf
    v_mul_f32_dpp v22, v16, v22 row_newbcast:2 row_mask:0xa bank_mask:0xf
    v_mul_f32_dpp v23, v16, v23 row_newbcast:3 row_mask:0xa bank_mask:0xf
    v_mul_f32_dpp v24, v16, v24 row_newbcast:4 row_mask:0xa bank_mask:0xf
    v_mul_f32_dpp v25, v16, v25 row_newbcast:5 row_mask:0xa bank_mask:0xf
    v_mul_f32_dpp v26, v16, v26 row_newbcast:6 row_mask:0xa bank_mask:0xf
    v_mul_f32_dpp v27, v16, v27 row_newbcast:7 row_mask:0xa bank_mask:0xf
    v_cvt_pk_bf16_f32 v64, v20, v21
    v_cvt_pk_bf16_f32 v65, v22, v23
    v_cvt_pk_bf16_f32 v66, v24, v25
    v_cvt_pk_bf16_f32 v67, v26, v27
    v_lshlrev_b32 v28, 16, v4
    v_and_b32 v29, 0xffff0000, v4
    v_lshlrev_b32 v30, 16, v5
    v_and_b32 v31, 0xffff0000, v5
    v_lshlrev_b32 v32, 16, v6
    v_and_b32 v33, 0xffff0000, v6
    v_lshlrev_b32 v34, 16, v7
    v_and_b32 v35, 0xffff0000, v7
    v_mul_f32_dpp v36, v17, v28 row_newbcast:8 row_mask:0xf bank_mask:0xf
    v_mul_f32_dpp v37, v17, v29 row_newbcast:9 row_mask:0xf bank_mask:0xf
    v_mul_f32_dpp v38, v17, v30 row_newbcast:10 row_mask:0xf bank_mask:0xf
    v_mul_f32_dpp v39, v17, v31 row_newbcast:11 row_mask:0xf bank_mask:0xf
    v_mul_f32_dpp v40, v17, v32 row_newbcast:12 row_mask:0xf bank_mask:0xf
    v_mul_f32_dpp v41, v17, v33 row_newbcast:13 row_mask:0xf bank_mask:0xf
    v_mul_f32_dpp v42, v17, v34 row_newbcast:14 row_mask:0xf bank_mask:0xf
    v_mul_f32_dpp v43, v17, v35 row_newbcast:15 row_mask:0xf bank_mask:0xf
    v_cvt_pk_bf16_f32 v76, v36, v37
    v_cvt_pk_bf16_f32 v77, v38, v39
    v_cvt_pk_bf16_f32 v78, v40, v41
    v_cvt_pk_bf16_f32 v79, v42, v43
    v_mul_f32_dpp v28, v17, v28 row_newbcast:0 row_mask:0xa bank_mask:0xf
    v_mul_f32_dpp v29, v17, v29 row_newbcast:1 row_mask:0xa bank_mask:0xf
    v_mul_f32_dpp v30, v17, v30 row_newbcast:2 row_mask:0xa bank_mask:0xf
    v_mul_f32_dpp v31, v17, v31 row_newbcast:3 row_mask:0xa bank_mask:0xf
    v_mul_f32_dpp v32, v17, v32 row_newbcast:4 row_mask:0xa bank_mask:0xf
    v_mul_f32_dpp v33, v17, v33 row_newbcast:5 row_mask:0xa bank_mask:0xf
    v_mul_f32_dpp v34, v17, v34 row_newbcast:6 row_mask:0xa bank_mask:0xf
    v_mul_f32_dpp v35, v17, v35 row_newbcast:7 row_mask:0xa bank_mask:0xf
    v_cvt_pk_bf16_f32 v72, v28, v29
    v_cvt_pk_bf16_f32 v73, v30, v31
    v_cvt_pk_bf16_f32 v74, v32, v33
    v_cvt_pk_bf16_f32 v75, v34, v35
    s_waitcnt lgkmcnt(0)
    v_lshlrev_b32 v20, 16, v8
    v_and_b32 v21, 0xffff0000, v8
    v_lshlrev_b32 v22, 16, v9
    v_and_b32 v23, 0xffff0000, v9
    v_mul_f32_dpp v36, v18, v20 row_newbcast:8 row_mask:0xf bank_mask:0xf
    v_mul_f32_dpp v37, v18, v21 row_newbcast:9 row_mask:0xf bank_mask:0xf
    v_mul_f32_dpp v38, v18, v22 row_newbcast:10 row_mask:0xf bank_mask:0xf
    v_mul_f32_dpp v39, v18, v23 row_newbcast:11 row_mask:0xf bank_mask:0xf
    v_cvt_pk_bf16_f32 v84, v36, v37
    v_cvt_pk_bf16_f32 v85, v38, v39
    v_mul_f32_dpp v20, v18, v20 row_newbcast:0 row_mask:0xa bank_mask:0xf
    v_mul_f32_dpp v21, v18, v21 row_newbcast:1 row_mask:0xa bank_mask:0xf
    v_mul_f32_dpp v22, v18, v22 row_newbcast:2 row_mask:0xa bank_mask:0xf
    v_mul_f32_dpp v23, v18, v23 row_newbcast:3 row_mask:0xa bank_mask:0xf
    v_cvt_pk_bf16_f32 v80, v20, v21
    v_cvt_pk_bf16_f32 v81, v22, v23
    s_waitcnt vmcnt(4)
    v_mfma_f32_32x32x16_bf16 v[0:15], v[64:67], v[176:179], 0
    ds_read_b64_tr_b16 v[184:185], v246 offset:2048
    ds_read_b64_tr_b16 v[186:187], v246 offset:3072
    ds_read_b64_tr_b16 v[188:189], v247 offset:2048
    ds_read_b64_tr_b16 v[190:191], v247 offset:3072
    s_mov_b32 m0, s68
    v_mfma_f32_32x32x16_bf16 v[16:31], v[68:71], v[176:179], 0
    buffer_load_dwordx4 v222, s[4:7], s41 offen sc1 lds
    buffer_load_dwordx4 v223, s[72:75], s41 offen offset:1024 sc1 lds
    v_permlane32_swap_b32 v242, v236
    v_permlane32_swap_b32 v243, v237
    v_mfma_f32_32x32x16_bf16 v[32:47], v[64:67], v[180:183], 0
    v_permlane32_swap_b32 v244, v238
    v_permlane32_swap_b32 v245, v239
    v_permlane32_swap_b32 v240, v241
    v_add_f32 v242, v242, v236
    v_mfma_f32_32x32x16_bf16 v[48:63], v[68:71], v[180:183], 0
    v_add_f32 v243, v243, v237
    v_add_f32 v244, v244, v238
    v_add_f32 v245, v245, v239
    v_add_f32 v240, -v240, -v241
    v_sub_u32 v241, v230, v231
    v_cvt_pk_bf16_f32 v242, v242, v243
    s_mov_b64 exec, 0x3ff
    ds_add_rtn_u32 v232, v254, v255
    s_mov_b64 exec, -1
    s_waitcnt vmcnt(4) lgkmcnt(1)
    v_mfma_f32_32x32x16_bf16 v[0:15], v[72:75], v[184:187], v[0:15]
    ds_read_b64_tr_b16 v[176:177], v246 offset:4096
    ds_read_b64_tr_b16 v[180:181], v247 offset:4096
    v_cvt_pk_bf16_f32 v244, v244, v245
    v_cvt_pk_bf16_f32 v240, v240, v240
    ds_write2st64_b32 v230, v242, v244 offset0:3 offset1:4
    ds_write_b16 v241, v240 offset:1280
    s_mov_b32 m0, s69
    v_mfma_f32_32x32x16_bf16 v[16:31], v[76:79], v[184:187], v[16:31]
    buffer_load_dwordx4 v226, s[4:7], s41 offen sc1 lds
    s_waitcnt lgkmcnt(4)
    v_readlane_b32 s58, v232, 8
    v_mfma_f32_32x32x16_bf16 v[32:47], v[72:75], v[188:191], v[32:47]
    s_cmp_lt_u32 s58, s22
    s_cbranch_scc0 K2_nul_64
    s_nop 0
    v_readlane_b32 s3, v253, s58
    s_nop 0
    s_bfe_u32 s58, s3, 0x60016
    s_and_b32 s59, s58, 7
    s_lshr_b32 s60, s58, 3
K2_chk_66:
    v_readlane_b32 s61, v232, s59
    s_nop 0
    s_cmp_gt_u32 s61, s60
    s_cbranch_scc0 K2_spin_65
K2_back_67:
    v_mfma_f32_32x32x16_bf16 v[48:63], v[76:79], v[188:191], v[48:63]
    s_lshl_b32 s44, s34, 7
    s_and_b32 s48, s3, 0x3ffff
    s_bfe_u32 s33, s3, 0x30013
    s_mov_b32 s35, s48
    s_mov_b32 s45, s44
    s_xor_b32 s47, s44, 256
    s_waitcnt vmcnt(3) lgkmcnt(2)
    v_mfma_f32_32x32x8_bf16 v[0:15], v[80:81], v[176:177], v[0:15]
    ds_read_b64_tr_b16 v[184:185], v246 offset:6144
    ds_read_b64_tr_b16 v[186:187], v246 offset:7168
    ds_read_b64_tr_b16 v[188:189], v247 offset:6144
    ds_read_b64_tr_b16 v[190:191], v247 offset:7168
    s_add_u32 s49, s48, 128
    s_add_u32 s60, s48, 256
    s_mov_b32 m0, s70
    v_mfma_f32_32x32x8_bf16 v[16:31], v[84:85], v[176:177], v[16:31]
    buffer_load_dwordx4 v222, s[4:7], s42 offen sc1 lds
    buffer_load_dwordx4 v223, s[72:75], s42 offen offset:1024 sc1 lds
    s_cmp_eq_u32 s33, 3
    s_cselect_b32 s46, s44, s47
    s_cselect_b32 s50, s60, s48
    v_mfma_f32_32x32x8_bf16 v[32:47], v[80:81], v[180:181], v[32:47]
    s_sub_u32 s60, s33, 2
    s_cmp_lt_u32 s60, 2
    s_cbranch_scc0 K2_rare_68
K2_back_69:
    v_mul_f32 v234, v0, v96
    v_mul_f32 v236, v8, v128
    v_fmac_f32 v234, v1, v97
    v_fmac_f32 v236, v9, v129
    v_mfma_f32_32x32x8_bf16 v[48:63], v[84:85], v[180:181], v[48:63]
    s_setprio 0
    v_fmac_f32 v234, v2, v98
    v_fmac_f32 v236, v10, v130
    v_fmac_f32 v234, v3, v99
    v_fmac_f32 v236, v11, v131
    v_fmac_f32 v234, v4, v100
    v_fmac_f32 v236, v12, v132
    v_fmac_f32 v234, v5, v101
    v_fmac_f32 v236, v13, v133
    v_fmac_f32 v234, v6, v102
    v_fmac_f32 v236, v14, v134
    v_fmac_f32 v234, v7, v103
    v_fmac_f32 v236, v15, v135
    v_mul_f32 v238, v16, v128
    v_mul_f32 v240, v24, v128
    v_fmac_f32 v238, v17, v129
    v_fmac_f32 v240, v25, v129
    v_fmac_f32 v238, v18, v130
    v_fmac_f32 v240, v26, v130
    v_fmac_f32 v238, v19, v131
    v_fmac_f32 v240, v27, v131
    v_fmac_f32 v238, v20, v132
    v_fmac_f32 v240, v28, v132
    v_fmac_f32 v238, v21, v133
    v_fmac_f32 v240, v29, v133
    v_fmac_f32 v238, v22, v134
    v_fmac_f32 v240, v30, v134
    v_fmac_f32 v238, v23, v135
    v_fmac_f32 v240, v31, v135
    v_mul_f32 v235, v32, v104
    v_mul_f32 v237, v40, v136
    v_fmac_f32 v235, v33, v105
    v_fmac_f32 v237, v41, v137
    v_fmac_f32 v235, v34, v106
    v_fmac_f32 v237, v42, v138
    v_fmac_f32 v235, v35, v107
    v_fmac_f32 v237, v43, v139
    v_fmac_f32 v235, v36, v108
    v_fmac_f32 v237, v44, v140
    v_fmac_f32 v235, v37, v109
    v_fmac_f32 v237, v45, v141
    v_fmac_f32 v235, v38, v110
    v_fmac_f32 v237, v46, v142
    v_fmac_f32 v235, v39, v111
    v_fmac_f32 v237, v47, v143
    v_mul_f32 v239, v48, v136
    v_mul_f32 v241, v56, v136
    s_setprio 1
    s_waitcnt vmcnt(3) lgkmcnt(0)
    v_mfma_f32_32x32x16_bf16 v[0:15], v[72:75], v[184:187], 0
    ds_read_b64_tr_b16 v[176:177], v246 offset:0
    ds_read_b64_tr_b16 v[178:179], v246 offset:1024
    ds_read_b64_tr_b16 v[180:181], v247 offset:0
    ds_read_b64_tr_b16 v[182:183], v247 offset:1024
    v_fmac_f32 v239, v49, v137
    v_fmac_f32 v241, v57, v137
    s_mov_b32 m0, s71
    v_mfma_f32_32x32x16_bf16 v[16:31], v[76:79], v[184:187], 0
    buffer_load_dwordx4 v224, s[4:7], s42 offen sc1 lds
    buffer_load_dwordx4 v225, s[72:75], s42 offen offset:1024 sc1 lds
    v_fmac_f32 v239, v50, v138
    v_fmac_f32 v241, v58, v138
    v_fmac_f32 v239, v51, v139
    v_fmac_f32 v241, v59, v139
    v_fmac_f32 v239, v52, v140
    v_mfma_f32_32x32x16_bf16 v[32:47], v[72:75], v[188:191], 0
    v_fmac_f32 v241, v60, v140
    v_fmac_f32 v239, v53, v141
    v_fmac_f32 v241, v61, v141
    v_fmac_f32 v239, v54, v142
    v_fmac_f32 v241, v62, v142
    v_fmac_f32 v239, v55, v143
    v_fmac_f32 v241, v63, v143
    v_mfma_f32_32x32x16_bf16 v[48:63], v[76:79], v[188:191], 0
    v_permlane32_swap_b32 v234, v236
    v_permlane32_swap_b32 v235, v237
    v_permlane32_swap_b32 v240, v238
    s_waitcnt vmcnt(4) lgkmcnt(0)
    v_mfma_f32_32x32x16_bf16 v[0:15], v[64:67], v[176:179], v[0:15]
    ds_read_b64_tr_b16 v[184:185], v246 offset:2048
    ds_read_b64_tr_b16 v[188:189], v247 offset:2048
    v_permlane32_swap_b32 v241, v239
    v_lshl_add_u32 v230, v252, 1, s31
    v_add_f32 v234, v234, v236
    s_mov_b32 m0, s68
    v_mfma_f32_32x32x16_bf16 v[16:31], v[68:71], v[176:179], v[16:31]
    buffer_load_dwordx4 v226, s[4:7], s42 offen sc1 lds
    v_add_f32 v235, v235, v237
    v_add_f32 v240, v240, v238
    v_add_f32 v241, v241, v239
    v_cvt_pk_bf16_f32 v234, v234, v235
    v_cvt_pk_bf16_f32 v240, v240, v241
    ds_write2st64_b32 v230, v234, v240 offset0:0 offset1:1
    v_mfma_f32_32x32x16_bf16 v[32:47], v[64:67], v[180:183], v[32:47]
    v_mfma_f32_32x32x16_bf16 v[48:63], v[68:71], v[180:183], v[48:63]
    s_waitcnt vmcnt(3) lgkmcnt(1)
    v_mfma_f32_32x32x8_bf16 v[0:15], v[80:81], v[184:185], v[0:15]
    ds_read_b64_tr_b16 v[176:177], v246 offset:4096
    ds_read_b64_tr_b16 v[178:179], v246 offset:5120
    ds_read_b64_tr_b16 v[180:181], v247 offset:4096
    ds_read_b64_tr_b16 v[182:183], v247 offset:5120
    s_mov_b32 m0, s69
    v_mfma_f32_32x32x8_bf16 v[16:31], v[84:85], v[184:185], v[16:31]
    buffer_load_dwordx4 v222, s[4:7], s43 offen sc1 lds
    buffer_load_dwordx4 v223, s[72:75], s43 offen offset:1024 sc1 lds
    v_mfma_f32_32x32x8_bf16 v[32:47], v[80:81], v[188:189], v[32:47]
    s_nop 2
    v_mul_f32 v234, v0, v144
    v_mul_f32 v236, v8, v112
    v_fmac_f32 v234, v1, v145
    v_fmac_f32 v236, v9, v113
    v_fmac_f32 v234, v2, v146
    v_fmac_f32 v236, v10, v114
    v_fmac_f32 v234, v3, v147
    v_mfma_f32_32x32x8_bf16 v[48:63], v[84:85], v[188:189], v[48:63]
    s_setprio 0
    v_fmac_f32 v236, v11, v115
    v_fmac_f32 v234, v4, v148
    v_fmac_f32 v236, v12, v116
    v_fmac_f32 v234, v5, v149
    v_fmac_f32 v236, v13, v117
    v_fmac_f32 v234, v6, v150
    v_fmac_f32 v236, v14, v118
    v_fmac_f32 v234, v7, v151
    v_fmac_f32 v236, v15, v119
    v_mul_f32 v238, v16, v160
    v_mul_f32 v240, v24, v160
    v_fmac_f32 v238, v17, v161
    v_fmac_f32 v240, v25, v161
    v_fmac_f32 v238, v18, v162
    v_fmac_f32 v240, v26, v162
    v_fmac_f32 v238, v19, v163
    v_fmac_f32 v240, v27, v163
    v_fmac_f32 v238, v20, v164
    v_fmac_f32 v240, v28, v164
    v_fmac_f32 v238, v21, v165
    v_fmac_f32 v240, v29, v165
    v_fmac_f32 v238, v22, v166
    v_fmac_f32 v240, v30, v166
    v_fmac_f32 v238, v23, v167
    v_fmac_f32 v240, v31, v167
    v_mul_f32 v235, v32, v152
    v_mul_f32 v237, v40, v120
    v_fmac_f32 v235, v33, v153
    v_fmac_f32 v237, v41, v121
    v_fmac_f32 v235, v34, v154
    v_fmac_f32 v237, v42, v122
    v_fmac_f32 v235, v35, v155
    v_fmac_f32 v237, v43, v123
    v_fmac_f32 v235, v36, v156
    v_fmac_f32 v237, v44, v124
    v_fmac_f32 v235, v37, v157
    v_fmac_f32 v237, v45, v125
    v_fmac_f32 v235, v38, v158
    v_fmac_f32 v237, v46, v126
    v_fmac_f32 v235, v39, v159
    v_fmac_f32 v237, v47, v127
    v_mul_f32 v239, v48, v168
    v_mul_f32 v241, v56, v168
    v_fmac_f32 v239, v49, v169
    v_fmac_f32 v241, v57, v169
    s_setprio 1
    s_waitcnt vmcnt(3) lgkmcnt(0)
    v_mfma_f32_32x32x16_bf16 v[0:15], v[64:67], v[176:179], 0
    ds_read_b64_tr_b16 v[184:185], v246 offset:6144
    ds_read_b64_tr_b16 v[186:187], v246 offset:7168
    ds_read_b64_tr_b16 v[188:189], v247 offset:6144
    ds_read_b64_tr_b16 v[190:191], v247 offset:7168
    v_fmac_f32 v239, v50, v170
    v_fmac_f32 v241, v58, v170
    s_mov_b32 m0, s70
    v_mfma_f32_32x32x16_bf16 v[16:31], v[68:71], v[176:179], 0
    buffer_load_dwordx4 v224, s[4:7], s43 offen sc1 lds
    buffer_load_dwordx4 v225, s[72:75], s43 offen offset:1024 sc1 lds
    v_fmac_f32 v239, v51, v171
    v_fmac_f32 v241, v59, v171
    v_fmac_f32 v239, v52, v172
    v_fmac_f32 v241, v60, v172
    v_fmac_f32 v239, v53, v173
    v_mfma_f32_32x32x16_bf16 v[32:47], v[64:67], v[180:183], 0
    v_add_u32 v222, s48, v251
    ds_read2_b32 v[222:223], v222 offset0:1 offset1:3
    v_fmac_f32 v241, v61, v173
    v_fmac_f32 v239, v54, v174
    v_fmac_f32 v241, v62, v174
    v_fmac_f32 v239, v55, v175
    v_fmac_f32 v241, v63, v175
    v_mfma_f32_32x32x16_bf16 v[48:63], v[68:71], v[180:183], 0
    s_waitcnt vmcnt(4) lgkmcnt(1)
    v_mfma_f32_32x32x16_bf16 v[0:15], v[72:75], v[184:187], v[0:15]
    ds_read_b64_tr_b16 v[176:177], v246 offset:0
    ds_read_b64_tr_b16 v[180:181], v247 offset:0
    s_mov_b32 m0, s71
    v_mfma_f32_32x32x16_bf16 v[16:31], v[76:79], v[184:187], v[16:31]
    buffer_load_dwordx4 v226, s[4:7], s43 offen sc1 lds
    s_waitcnt lgkmcnt(2)
    v_mad_u32_u16 v222, v222, s39, v248 op_sel:[1,0,0,0]
    v_mad_u32_u16 v223, v223, s39, v248 op_sel:[1,0,0,0]
    v_mfma_f32_32x32x16_bf16 v[32:47], v[72:75], v[188:191], v[32:47]
    v_add_u32 v224, s49, v251
    ds_read2_b32 v[224:225], v224 offset0:1 offset1:3
    v_mfma_f32_32x32x16_bf16 v[48:63], v[76:79], v[188:191], v[48:63]
    s_waitcnt vmcnt(3) lgkmcnt(1)
    v_mfma_f32_32x32x8_bf16 v[0:15], v[80:81], v[176:177], v[0:15]
    ds_read_b64_tr_b16 v[184:185], v246 offset:2048
    ds_read_b64_tr_b16 v[186:187], v246 offset:3072
    ds_read_b64_tr_b16 v[188:189], v247 offset:2048
    ds_read_b64_tr_b16 v[190:191], v247 offset:3072
    s_mov_b32 m0, s68
    v_mfma_f32_32x32x8_bf16 v[16:31], v[84:85], v[176:177], v[16:31]
    buffer_load_dwordx4 v222, s[4:7], s44 offen sc1 lds
    buffer_load_dwordx4 v223, s[72:75], s44 offen offset:1024 sc1 lds
    s_waitcnt lgkmcnt(4)
    v_mad_u32_u16 v224, v224, s39, v248 op_sel:[1,0,0,0]
    v_mad_u32_u16 v225, v225, s39, v248 op_sel:[1,0,0,0]
    v_mfma_f32_32x32x8_bf16 v[32:47], v[80:81], v[180:181], v[32:47]
    v_add_u32 v226, s50, v251
    ds_read2_b32 v[226:227], v226 offset0:1 offset1:3
    v_mul_f32 v242, v0, v144
    v_fma_f32 v238, v8, v160, -v238
    v_fmac_f32 v242, v1, v145
    v_fmac_f32 v238, v9, v161
    v_fmac_f32 v242, v2, v146
    v_mfma_f32_32x32x8_bf16 v[48:63], v[84:85], v[180:181], v[48:63]
    s_setprio 0
    v_fmac_f32 v238, v10, v162
    v_fmac_f32 v242, v3, v147
    v_fmac_f32 v238, v11, v163
    v_fmac_f32 v242, v4, v148
    v_fmac_f32 v238, v12, v164
    v_fmac_f32 v242, v5, v149
    v_fmac_f32 v238, v13, v165
    v_fmac_f32 v242, v6, v150
    v_fmac_f32 v238, v14, v166
    v_fmac_f32 v242, v7, v151
    v_fmac_f32 v238, v15, v167
    v_fmac_f32 v236, v16, v112
    v_mul_f32 v244, v24, v160
    v_fmac_f32 v236, v17, v113
    v_fmac_f32 v244, v25, v161
    v_fmac_f32 v236, v18, v114
    v_fmac_f32 v244, v26, v162
    v_fmac_f32 v236, v19, v115
    v_fmac_f32 v244, v27, v163
    v_fmac_f32 v236, v20, v116
    v_fmac_f32 v244, v28, v164
    v_fmac_f32 v236, v21, v117
    v_fmac_f32 v244, v29, v165
    v_fmac_f32 v236, v22, v118
    v_fmac_f32 v244, v30, v166
    v_fmac_f32 v236, v23, v119
    v_fmac_f32 v244, v31, v167
    v_mul_f32 v243, v32, v152
    v_fma_f32 v239, v40, v168, -v239
    v_fmac_f32 v243, v33, v153
    v_fmac_f32 v239, v41, v169
    v_fmac_f32 v243, v34, v154
    v_fmac_f32 v239, v42, v170
    v_fmac_f32 v243, v35, v155
    v_fmac_f32 v239, v43, v171
    v_fmac_f32 v243, v36, v156
    v_fmac_f32 v239, v44, v172
    v_fmac_f32 v243, v37, v157
    v_fmac_f32 v239, v45, v173
    v_fmac_f32 v243, v38, v158
    v_fmac_f32 v239, v46, v174
    v_fmac_f32 v243, v39, v159
    v_fmac_f32 v239, v47, v175
    v_fmac_f32 v237, v48, v120
    v_mul_f32 v245, v56, v168
    v_fmac_f32 v237, v49, v121
    v_fmac_f32 v245, v57, v169
    v_fmac_f32 v237, v50, v122
    s_setprio 1
    s_waitcnt vmcnt(3) lgkmcnt(1)
    v_mfma_f32_32x32x16_bf16 v[0:15], v[64:67], v[184:187], 0
    ds_read_b64_tr_b16 v[176:177], v246 offset:4096
    ds_read_b64_tr_b16 v[178:179], v246 offset:5120
    ds_read_b64_tr_b16 v[180:181], v247 offset:4096
    ds_read_b64_tr_b16 v[182:183], v247 offset:5120
    v_fmac_f32 v245, v58, v170
    v_fmac_f32 v237, v51, v123
    s_mov_b32 m0, s69
    v_mfma_f32_32x32x16_bf16 v[16:31], v[68:71], v[184:187], 0
    buffer_load_dwordx4 v224, s[4:7], s45 offen sc1 lds
    buffer_load_dwordx4 v225, s[72:75], s45 offen offset:1024 sc1 lds
    s_waitcnt lgkmcnt(4)
    v_mad_u32_u16 v226, v226, s39, v248 op_sel:[1,0,0,0]
    v_mad_u32_u16 v227, v227, s39, v248 op_sel:[1,0,0,0]
    v_fmac_f32 v245, v59, v171
    v_fmac_f32 v237, v52, v124
    v_mfma_f32_32x32x16_bf16 v[32:47], v[64:67], v[188:191], 0
    v_fmac_f32 v245, v60, v172
    v_fmac_f32 v237, v53, v125
    v_fmac_f32 v245, v61, v173
    v_fmac_f32 v237, v54, v126
    v_fmac_f32 v245, v62, v174
    v_fmac_f32 v237, v55, v127
    v_fmac_f32 v245, v63, v175
    v_mfma_f32_32x32x16_bf16 v[48:63], v[68:71], v[188:191], 0
    v_permlane32_swap_b32 v242, v234
    v_permlane32_swap_b32 v243, v235
    v_add_f32 v242, v242, v234
    v_add_f32 v243, v243, v235
    s_waitcnt vmcnt(4) lgkmcnt(0)
    v_mfma_f32_32x32x16_bf16 v[0:15], v[72:75], v[176:179], v[0:15]
    ds_read_b64_tr_b16 v[184:185], v246 offset:6144
    ds_read_b64_tr_b16 v[188:189], v247 offset:6144
    v_cvt_pk_bf16_f32 v242, v242, v243
    ds_write_b32 v230, v242 offset:512
    s_mov_b32 s32, s31
    s_mov_b32 s31, s35
    s_mov_b32 m0, s70
    v_mfma_f32_32x32x16_bf16 v[16:31], v[76:79], v[176:179], v[16:31]
    buffer_load_dwordx4 v226, s[4:7], s46 offen sc1 lds
    buffer_load_dwordx4 v227, s[72:75], s46 offen offset:1024 sc1 lds
    s_sub_u32 s26, s48, s29
    s_mov_b32 s29, s48
    s_mov_b32 s30, s3
    s_bfe_u32 s56, s3, 0x40012
    v_mfma_f32_32x32x16_bf16 v[32:47], v[72:75], v[180:183], v[32:47]
    s_cmp_lg_u32 s36, 0
    s_cselect_b32 s56, s56, 0
    v_mfma_f32_32x32x16_bf16 v[48:63], v[76:79], v[180:183], v[48:63]
    s_waitcnt vmcnt(4) lgkmcnt(1)
    v_mfma_f32_32x32x8_bf16 v[0:15], v[80:81], v[184:185], v[0:15]
    ds_read_b64_tr_b16 v[176:177], v246 offset:0
    ds_read_b64_tr_b16 v[178:179], v246 offset:1024
    ds_read_b64_tr_b16 v[180:181], v247 offset:0
    ds_read_b64_tr_b16 v[182:183], v247 offset:1024
    s_mov_b32 m0, s71
    v_mfma_f32_32x32x8_bf16 v[16:31], v[84:85], v[184:185], v[16:31]
    s_cmp_eq_u32 s33, 4
    s_cbranch_scc1 K2_g4_71
    buffer_load_dwordx4 v224, s[4:7], s47 offen sc1 lds
    buffer_load_dwordx4 v225, s[72:75], s47 offen offset:1024 sc1 lds
K2_back_72:
    v_mfma_f32_32x32x8_bf16 v[32:47], v[80:81], v[188:189], v[32:47]
    s_nop 0
    v_mul_f32 v242, v0, v144
    v_fma_f32 v240, v8, v160, -v240
    v_fmac_f32 v242, v1, v145
    v_fmac_f32 v240, v9, v161
    v_fmac_f32 v242, v2, v146
    v_fmac_f32 v240, v10, v162
    v_fmac_f32 v242, v3, v147
    v_mfma_f32_32x32x8_bf16 v[48:63], v[84:85], v[188:189], v[48:63]
    s_setprio 0
    v_fmac_f32 v240, v11, v163
    v_fmac_f32 v242, v4, v148
    v_fmac_f32 v240, v12, v164
    v_fmac_f32 v242, v5, v149
    v_fmac_f32 v240, v13, v165
    v_fmac_f32 v242, v6, v150
    v_fmac_f32 v240, v14, v166
    v_fmac_f32 v242, v7, v151
    v_fmac_f32 v240, v15, v167
    v_add_u32 v249, s26, v249
    v_add_u32 v250, s26, v250
    v_fma_f32 v244, v16, v160, -v244
    v_fmac_f32 v236, v24, v112
    v_fmac_f32 v244, v17, v161
    v_fmac_f32 v236, v25, v113
    v_fmac_f32 v244, v18, v162
    v_fmac_f32 v236, v26, v114
    v_fmac_f32 v244, v19, v163
    v_fmac_f32 v236, v27, v115
    v_fmac_f32 v244, v20, v164
    v_fmac_f32 v236, v28, v116
    v_fmac_f32 v244, v21, v165
    v_fmac_f32 v236, v29, v117
    v_fmac_f32 v244, v22, v166
    v_fmac_f32 v236, v30, v118
    v_fmac_f32 v244, v23, v167
    v_fmac_f32 v236, v31, v119
    ds_read_b64_tr_b16 v[0:1], v249 offset:0
    ds_read_b64_tr_b16 v[2:3], v249 offset:32
    ds_read_u16_d16_hi v16, v250 offset:0
    v_mul_f32 v243, v32, v152
    v_fma_f32 v241, v40, v168, -v241
    v_fmac_f32 v243, v33, v153
    v_fmac_f32 v241, v41, v169
    v_fmac_f32 v243, v34, v154
    v_fmac_f32 v241, v42, v170
    v_fmac_f32 v243, v35, v155
    v_fmac_f32 v241, v43, v171
    v_fmac_f32 v243, v36, v156
    v_fmac_f32 v241, v44, v172
    v_fmac_f32 v243, v37, v157
    v_fmac_f32 v241, v45, v173
    v_fmac_f32 v243, v38, v158
    v_fmac_f32 v241, v46, v174
    v_fmac_f32 v243, v39, v159
    v_fmac_f32 v241, v47, v175
    ds_read_b64_tr_b16 v[4:5], v249 offset:512
    ds_read_b64_tr_b16 v[6:7], v249 offset:544
    ds_read_u16_d16_hi v17, v250 offset:128
    v_fma_f32 v245, v48, v168, -v245
    v_fmac_f32 v237, v56, v120
    v_fmac_f32 v245, v49, v169
    v_fmac_f32 v237, v57, v121
    v_fmac_f32 v245, v50, v170
    v_fmac_f32 v237, v58, v122
    v_fmac_f32 v245, v51, v171
    v_fmac_f32 v237, v59, v123
    v_fmac_f32 v245, v52, v172
    v_fmac_f32 v237, v60, v124
    v_fmac_f32 v245, v53, v173
    v_fmac_f32 v237, v61, v125
    v_fmac_f32 v245, v54, v174
    v_fmac_f32 v237, v62, v126
    v_fmac_f32 v245, v55, v175
    v_fmac_f32 v237, v63, v127
    s_cmp_eq_u32 s56, 5
    s_cbranch_scc1 K2_U21
    s_cmp_eq_u32 s56, 6
    s_cbranch_scc1 K2_U3h1
    s_branch K2_DSP1
K2_U31:
    s_setprio 1
    ds_read_b64_tr_b16 v[8:9], v249 offset:1024
    ds_read_b64_tr_b16 v[10:11], v249 offset:1056
    ds_read_u16_d16_hi v18, v250 offset:256
    s_waitcnt lgkmcnt(3)
    v_lshlrev_b32 v20, 16, v0
    v_and_b32 v21, 0xffff0000, v0
    v_lshlrev_b32 v22, 16, v1
    v_and_b32 v23, 0xffff0000, v1
    v_lshlrev_b32 v24, 16, v2
    v_and_b32 v25, 0xffff0000, v2
    v_lshlrev_b32 v26, 16, v3
    v_and_b32 v27, 0xffff0000, v3
    v_mul_f32_dpp v36, v16, v20 row_newbcast:8 row_mask:0xf bank_mask:0xf
    v_mul_f32_dpp v37, v16, v21 row_newbcast:9 row_mask:0xf bank_mask:0xf
    v_mul_f32_dpp v38, v16, v22 row_newbcast:10 row_mask:0xf bank_mask:0xf
    v_mul_f32_dpp v39, v16, v23 row_newbcast:11 row_mask:0xf bank_mask:0xf
    v_mul_f32_dpp v40, v16, v24 row_newbcast:12 row_mask:0xf bank_mask:0xf
    v_mul_f32_dpp v41, v16, v25 row_newbcast:13 row_mask:0xf bank_mask:0xf
    v_mul_f32_dpp v42, v16, v26 row_newbcast:14 row_mask:0xf bank_mask:0xf
    v_mul_f32_dpp v43, v16, v27 row_newbcast:15 row_mask:0xf bank_mask:0xf
    v_cvt_pk_bf16_f32 v68, v36, v37
    v_cvt_pk_bf16_f32 v69, v38, v39
    v_cvt_pk_bf16_f32 v70, v40, v41
    v_cvt_pk_bf16_f32 v71, v42, v43
    v_mul_f32_dpp v20, v16, v20 row_newbcast:0 row_mask:0xa bank_mask:0xf
    v_mul_f32_dpp v21, v16, v21 row_newbcast:1 row_mask:0xa bank_mask:0xf
    v_mul_f32_dpp v22, v16, v22 row_newbcast:2 row_mask:0xa bank_mask:0xf
    v_mul_f32_dpp v23, v16, v23 row_newbcast:3 row_mask:0xa bank_mask:0xf
    v_mul_f32_dpp v24, v16, v24 row_newbcast:4 row_mask:0xa bank_mask:0xf
    v_mul_f32_dpp v25, v16, v25 row_newbcast:5 row_mask:0xa bank_mask:0xf
    v_mul_f32_dpp v26, v16, v26 row_newbcast:6 row_mask:0xa bank_mask:0xf
    v_mul_f32_dpp v27, v16, v27 row_newbcast:7 row_mask:0xa bank_mask:0xf
    v_cvt_pk_bf16_f32 v64, v20, v21
    v_cvt_pk_bf16_f32 v65, v22, v23
    v_cvt_pk_bf16_f32 v66, v24, v25
    v_cvt_pk_bf16_f32 v67, v26, v27
    v_lshlrev_b32 v28, 16, v4
    v_and_b32 v29, 0xffff0000, v4
    v_lshlrev_b32 v30, 16, v5
    v_and_b32 v31, 0xffff0000, v5
    v_lshlrev_b32 v32, 16, v6
    v_and_b32 v33, 0xffff0000, v6
    v_lshlrev_b32 v34, 16, v7
    v_and_b32 v35, 0xffff0000, v7
    v_mul_f32_dpp v36, v17, v28 row_newbcast:8 row_mask:0xf bank_mask:0xf
    v_mul_f32_dpp v37, v17, v29 row_newbcast:9 row_mask:0xf bank_mask:0xf
    v_mul_f32_dpp v38, v17, v30 row_newbcast:10 row_mask:0xf bank_mask:0xf
    v_mul_f32_dpp v39, v17, v31 row_newbcast:11 row_mask:0xf bank_mask:0xf
    v_mul_f32_dpp v40, v17, v32 row_newbcast:12 row_mask:0xf bank_mask:0xf
    v_mul_f32_dpp v41, v17, v33 row_newbcast:13 row_mask:0xf bank_mask:0xf
    v_mul_f32_dpp v42, v17, v34 row_newbcast:14 row_mask:0xf bank_mask:0xf
    v_mul_f32_dpp v43, v17, v35 row_newbcast:15 row_mask:0xf bank_mask:0xf
    v_cvt_pk_bf16_f32 v76, v36, v37
    v_cvt_pk_bf16_f32 v77, v38, v39
    v_cvt_pk_bf16_f32 v78, v40, v41
    v_cvt_pk_bf16_f32 v79, v42, v43
    v_mul_f32_dpp v28, v17, v28 row_newbcast:0 row_mask:0xa bank_mask:0xf
    v_mul_f32_dpp v29, v17, v29 row_newbcast:1 row_mask:0xa bank_mask:0xf
    v_mul_f32_dpp v30, v17, v30 row_newbcast:2 row_mask:0xa bank_mask:0xf
    v_mul_f32_dpp v31, v17, v31 row_newbcast:3 row_mask:0xa bank_mask:0xf
    v_mul_f32_dpp v32, v17, v32 row_newbcast:4 row_mask:0xa bank_mask:0xf
    v_mul_f32_dpp v33, v17, v33 row_newbcast:5 row_mask:0xa bank_mask:0xf
    v_mul_f32_dpp v34, v17, v34 row_newbcast:6 row_mask:0xa bank_mask:0xf
    v_mul_f32_dpp v35, v17, v35 row_newbcast:7 row_mask:0xa bank_mask:0xf
    v_cvt_pk_bf16_f32 v72, v28, v29
    v_cvt_pk_bf16_f32 v73, v30, v31
    v_cvt_pk_bf16_f32 v74, v32, v33
    v_cvt_pk_bf16_f32 v75, v34, v35
    s_waitcnt lgkmcnt(0)
    v_lshlrev_b32 v20, 16, v8
    v_and_b32 v21, 0xffff0000, v8
    v_lshlrev_b32 v22, 16, v9
    v_and_b32 v23, 0xffff0000, v9
    v_lshlrev_b32 v24, 16, v10
    v_and_b32 v25, 0xffff0000, v10
    v_lshlrev_b32 v26, 16, v11
    v_and_b32 v27, 0xffff0000, v11
    v_mul_f32_dpp v36, v18, v20 row_newbcast:8 row_mask:0xf bank_mask:0xf
    v_mul_f32_dpp v37, v18, v21 row_newbcast:9 row_mask:0xf bank_mask:0xf
    v_mul_f32_dpp v38, v18, v22 row_newbcast:10 row_mask:0xf bank_mask:0xf
    v_mul_f32_dpp v39, v18, v23 row_newbcast:11 row_mask:0xf bank_mask:0xf
    v_mul_f32_dpp v40, v18, v24 row_newbcast:12 row_mask:0xf bank_mask:0xf
    v_mul_f32_dpp v41, v18, v25 row_newbcast:13 row_mask:0xf bank_mask:0xf
    v_mul_f32_dpp v42, v18, v26 row_newbcast:14 row_mask:0xf bank_mask:0xf
    v_mul_f32_dpp v43, v18, v27 row_newbcast:15 row_mask:0xf bank_mask:0xf
    v_cvt_pk_bf16_f32 v84, v36, v37
    v_cvt_pk_bf16_f32 v85, v38, v39
    v_cvt_pk_bf16_f32 v86, v40, v41
    v_cvt_pk_bf16_f32 v87, v42, v43
    v_mul_f32_dpp v20, v18, v20 row_newbcast:0 row_mask:0xa bank_mask:0xf
    v_mul_f32_dpp v21, v18, v21 row_newbcast:1 row_mask:0xa bank_mask:0xf
    v_mul_f32_dpp v22, v18, v22 row_newbcast:2 row_mask:0xa bank_mask:0xf
    v_mul_f32_dpp v23, v18, v23 row_newbcast:3 row_mask:0xa bank_mask:0xf
    v_mul_f32_dpp v24, v18, v24 row_newbcast:4 row_mask:0xa bank_mask:0xf
    v_mul_f32_dpp v25, v18, v25 row_newbcast:5 row_mask:0xa bank_mask:0xf
    v_mul_f32_dpp v26, v18, v26 row_newbcast:6 row_mask:0xa bank_mask:0xf
    v_mul_f32_dpp v27, v18, v27 row_newbcast:7 row_mask:0xa bank_mask:0xf
    v_cvt_pk_bf16_f32 v80, v20, v21
    v_cvt_pk_bf16_f32 v81, v22, v23
    v_cvt_pk_bf16_f32 v82, v24, v25
    v_cvt_pk_bf16_f32 v83, v26, v27
    s_waitcnt vmcnt(4)
    v_mfma_f32_32x32x16_bf16 v[0:15], v[64:67], v[176:179], 0
    ds_read_b64_tr_b16 v[184:185], v246 offset:2048
    ds_read_b64_tr_b16 v[186:187], v246 offset:3072
    ds_read_b64_tr_b16 v[188:189], v247 offset:2048
    ds_read_b64_tr_b16 v[190:191], v247 offset:3072
    s_mov_b32 m0, s68
    v_mfma_f32_32x32x16_bf16 v[16:31], v[68:71], v[176:179], 0
    buffer_load_dwordx4 v222, s[4:7], s41 offen sc1 lds
    buffer_load_dwordx4 v223, s[72:75], s41 offen offset:1024 sc1 lds
    v_permlane32_swap_b32 v242, v236
    v_permlane32_swap_b32 v243, v237
    v_mfma_f32_32x32x16_bf16 v[32:47], v[64:67], v[180:183], 0
    v_permlane32_swap_b32 v244, v238
    v_permlane32_swap_b32 v245, v239
    v_permlane32_swap_b32 v240, v241
    v_add_f32 v242, v242, v236
    v_mfma_f32_32x32x16_bf16 v[48:63], v[68:71], v[180:183], 0
    v_add_f32 v243, v243, v237
    v_add_f32 v244, v244, v238
    v_add_f32 v245, v245, v239
    v_add_f32 v240, -v240, -v241
    v_sub_u32 v241, v230, v231
    v_cvt_pk_bf16_f32 v242, v242, v243
    s_mov_b64 exec, 0x3ff
    ds_add_rtn_u32 v232, v254, v255
    s_mov_b64 exec, -1
    s_waitcnt vmcnt(4) lgkmcnt(1)
    v_mfma_f32_32x32x16_bf16 v[0:15], v[72:75], v[184:187], v[0:15]
    ds_read_b64_tr_b16 v[176:177], v246 offset:4096
    ds_read_b64_tr_b16 v[178:179], v246 offset:5120
    ds_read_b64_tr_b16 v[180:181], v247 offset:4096
    ds_read_b64_tr_b16 v[182:183], v247 offset:5120
    v_cvt_pk_bf16_f32 v244, v244, v245
    v_cvt_pk_bf16_f32 v240, v240, v240
    s_mov_b32 m0, s69
    v_mfma_f32_32x32x16_bf16 v[16:31], v[76:79], v[184:187], v[16:31]
    buffer_load_dwordx4 v226, s[4:7], s41 offen sc1 lds
    buffer_load_dwordx4 v227, s[72:75], s41 offen offset:1024 sc1 lds
    ds_write2st64_b32 v230, v242, v244 offset0:3 offset1:4
    ds_write_b16 v241, v240 offset:1280
    s_waitcnt lgkmcnt(6)
    v_readlane_b32 s58, v232, 8
    v_mfma_f32_32x32x16_bf16 v[32:47], v[72:75], v[188:191], v[32:47]
    s_cmp_lt_u32 s58, s22
    s_cbranch_scc0 K2_nul_73
    s_nop 0
    v_readlane_b32 s3, v253, s58
    s_nop 0
    s_bfe_u32 s58, s3, 0x60016
    s_and_b32 s59, s58, 7
    s_lshr_b32 s60, s58, 3
K2_chk_75:
    v_readlane_b32 s61, v232, s59
    s_nop 0
    s_cmp_gt_u32 s61, s60
    s_cbranch_scc0 K2_spin_74
K2_back_76:
    v_mfma_f32_32x32x16_bf16 v[48:63], v[76:79], v[188:191], v[48:63]
    s_lshl_b32 s44, s34, 7
    s_and_b32 s48, s3, 0x3ffff
    s_bfe_u32 s33, s3, 0x30013
    s_mov_b32 s35, s48
    s_mov_b32 s45, s44
    s_xor_b32 s47, s44, 256
    s_waitcnt vmcnt(4) lgkmcnt(2)
    v_mfma_f32_32x32x16_bf16 v[0:15], v[80:83], v[176:179], v[0:15]
    ds_read_b64_tr_b16 v[184:185], v246 offset:6144
    ds_read_b64_tr_b16 v[186:187], v246 offset:7168
    ds_read_b64_tr_b16 v[188:189], v247 offset:6144
    ds_read_b64_tr_b16 v[190:191], v247 offset:7168
    s_add_u32 s49, s48, 128
    s_add_u32 s60, s48, 256
    s_mov_b32 m0, s70
    v_mfma_f32_32x32x16_bf16 v[16:31], v[84:87], v[176:179], v[16:31]
    buffer_load_dwordx4 v222, s[4:7], s42 offen sc1 lds
    buffer_load_dwordx4 v223, s[72:75], s42 offen offset:1024 sc1 lds
    s_cmp_eq_u32 s33, 3
    s_cselect_b32 s46, s44, s47
    s_cselect_b32 s50, s60, s48
    v_mfma_f32_32x32x16_bf16 v[32:47], v[80:83], v[180:183], v[32:47]
    s_sub_u32 s60, s33, 2
    s_cmp_lt_u32 s60, 2
    s_cbranch_scc0 K2_rare_77
K2_back_78:
    v_mul_f32 v234, v0, v96
    v_mul_f32 v236, v8, v128
    v_fmac_f32 v234, v1, v97
    v_fmac_f32 v236, v9, v129
    v_mfma_f32_32x32x16_bf16 v[48:63], v[84:87], v[180:183], v[48:63]
    s_setprio 0
    v_fmac_f32 v234, v2, v98
    v_fmac_f32 v236, v10, v130
    v_fmac_f32 v234, v3, v99
    v_fmac_f32 v236, v11, v131
    v_fmac_f32 v234, v4, v100
    v_fmac_f32 v236, v12, v132
    v_fmac_f32 v234, v5, v101
    v_fmac_f32 v236, v13, v133
    v_fmac_f32 v234, v6, v102
    v_fmac_f32 v236, v14, v134
    v_fmac_f32 v234, v7, v103
    v_fmac_f32 v236, v15, v135
    v_mul_f32 v238, v16, v128
    v_mul_f32 v240, v24, v128
    v_fmac_f32 v238, v17, v129
    v_fmac_f32 v240, v25, v129
    v_fmac_f32 v238, v18, v130
    v_fmac_f32 v240, v26, v130
    v_fmac_f32 v238, v19, v131
    v_fmac_f32 v240, v27, v131
    v_fmac_f32 v238, v20, v132
    v_fmac_f32 v240, v28, v132
    v_fmac_f32 v238, v21, v133
    v_fmac_f32 v240, v29, v133
    v_fmac_f32 v238, v22, v134
    v_fmac_f32 v240, v30, v134
    v_fmac_f32 v238, v23, v135
    v_fmac_f32 v240, v31, v135
    v_mul_f32 v235, v32, v104
    v_mul_f32 v237, v40, v136
    v_fmac_f32 v235, v33, v105
    v_fmac_f32 v237, v41, v137
    v_fmac_f32 v235, v34, v106
    v_fmac_f32 v237, v42, v138
    v_fmac_f32 v235, v35, v107
    v_fmac_f32 v237, v43, v139
    v_fmac_f32 v235, v36, v108
    v_fmac_f32 v237, v44, v140
    v_fmac_f32 v235, v37, v109
    v_fmac_f32 v237, v45, v141
    v_fmac_f32 v235, v38, v110
    v_fmac_f32 v237, v46, v142
    v_fmac_f32 v235, v39, v111
    v_fmac_f32 v237, v47, v143
    v_mul_f32 v239, v48, v136
    v_mul_f32 v241, v56, v136
    s_setprio 1
    s_waitcnt vmcnt(4) lgkmcnt(0)
    v_mfma_f32_32x32x16_bf16 v[0:15], v[72:75], v[184:187], 0
    ds_read_b64_tr_b16 v[176:177], v246 offset:0
    ds_read_b64_tr_b16 v[178:179], v246 offset:1024
    ds_read_b64_tr_b16 v[180:181], v247 offset:0
    ds_read_b64_tr_b16 v[182:183], v247 offset:1024
    v_fmac_f32 v239, v49, v137
    v_fmac_f32 v241, v57, v137
    s_mov_b32 m0, s71
    v_mfma_f32_32x32x16_bf16 v[16:31], v[76:79], v[184:187], 0
    buffer_load_dwordx4 v224, s[4:7], s42 offen sc1 lds
    buffer_load_dwordx4 v225, s[72:75], s42 offen offset:1024 sc1 lds
    v_fmac_f32 v239, v50, v138
    v_fmac_f32 v241, v58, v138
    v_fmac_f32 v239, v51, v139
    v_fmac_f32 v241, v59, v139
    v_fmac_f32 v239, v52, v140
    v_mfma_f32_32x32x16_bf16 v[32:47], v[72:75], v[188:191], 0
    v_fmac_f32 v241, v60, v140
    v_fmac_f32 v239, v53, v141
    v_fmac_f32 v241, v61, v141
    v_fmac_f32 v239, v54, v142
    v_fmac_f32 v241, v62, v142
    v_fmac_f32 v239, v55, v143
    v_fmac_f32 v241, v63, v143
    v_mfma_f32_32x32x16_bf16 v[48:63], v[76:79], v[188:191], 0
    v_permlane32_swap_b32 v234, v236
    v_permlane32_swap_b32 v235, v237
    v_permlane32_swap_b32 v240, v238
    s_waitcnt vmcnt(4) lgkmcnt(0)
    v_mfma_f32_32x32x16_bf16 v[0:15], v[64:67], v[176:179], v[0:15]
    ds_read_b64_tr_b16 v[184:185], v246 offset:2048
    ds_read_b64_tr_b16 v[186:187], v246 offset:3072
    ds_read_b64_tr_b16 v[188:189], v247 offset:2048
    ds_read_b64_tr_b16 v[190:191], v247 offset:3072
    v_permlane32_swap_b32 v241, v239
    s_mov_b32 m0, s68
    v_mfma_f32_32x32x16_bf16 v[16:31], v[68:71], v[176:179], v[16:31]
    buffer_load_dwordx4 v226, s[4:7], s42 offen sc1 lds
    buffer_load_dwordx4 v227, s[72:75], s42 offen offset:1024 sc1 lds
    v_lshl_add_u32 v230, v252, 1, s31
    v_add_f32 v234, v234, v236
    v_add_f32 v235, v235, v237
    v_add_f32 v240, v240, v238
    v_add_f32 v241, v241, v239
    v_mfma_f32_32x32x16_bf16 v[32:47], v[64:67], v[180:183], v[32:47]
    v_cvt_pk_bf16_f32 v234, v234, v235
    v_cvt_pk_bf16_f32 v240, v240, v241
    ds_write2st64_b32 v230, v234, v240 offset0:0 offset1:1
    v_mfma_f32_32x32x16_bf16 v[48:63], v[68:71], v[180:183], v[48:63]
    s_waitcnt vmcnt(4) lgkmcnt(1)
    v_mfma_f32_32x32x16_bf16 v[0:15], v[80:83], v[184:187], v[0:15]
    ds_read_b64_tr_b16 v[176:177], v246 offset:4096
    ds_read_b64_tr_b16 v[178:179], v246 offset:5120
    ds_read_b64_tr_b16 v[180:181], v247 offset:4096
    ds_read_b64_tr_b16 v[182:183], v247 offset:5120
    s_mov_b32 m0, s69
    v_mfma_f32_32x32x16_bf16 v[16:31], v[84:87], v[184:187], v[16:31]
    buffer_load_dwordx4 v222, s[4:7], s43 offen sc1 lds
    buffer_load_dwordx4 v223, s[72:75], s43 offen offset:1024 sc1 lds
    v_mfma_f32_32x32x16_bf16 v[32:47], v[80:83], v[188:191], v[32:47]
    s_nop 2
    v_mul_f32 v234, v0, v144
    v_mul_f32 v236, v8, v112
    v_fmac_f32 v234, v1, v145
    v_fmac_f32 v236, v9, v113
    v_fmac_f32 v234, v2, v146
    v_fmac_f32 v236, v10, v114
    v_fmac_f32 v234, v3, v147
    v_mfma_f32_32x32x16_bf16 v[48:63], v[84:87], v[188:191], v[48:63]
    s_setprio 0
    v_fmac_f32 v236, v11, v115
    v_fmac_f32 v234, v4, v148
    v_fmac_f32 v236, v12, v116
    v_fmac_f32 v234, v5, v149
    v_fmac_f32 v236, v13, v117
    v_fmac_f32 v234, v6, v150
    v_fmac_f32 v236, v14, v118
    v_fmac_f32 v234, v7, v151
    v_fmac_f32 v236, v15, v119
    v_mul_f32 v238, v16, v160
    v_mul_f32 v240, v24, v160
    v_fmac_f32 v238, v17, v161
    v_fmac_f32 v240, v25, v161
    v_fmac_f32 v238, v18, v162
    v_fmac_f32 v240, v26, v162
    v_fmac_f32 v238, v19, v163
    v_fmac_f32 v240, v27, v163
    v_fmac_f32 v238, v20, v164
    v_fmac_f32 v240, v28, v164
    v_fmac_f32 v238, v21, v165
    v_fmac_f32 v240, v29, v165
    v_fmac_f32 v238, v22, v166
    v_fmac_f32 v240, v30, v166
    v_fmac_f32 v238, v23, v167
    v_fmac_f32 v240, v31, v167
    v_mul_f32 v235, v32, v152
    v_mul_f32 v237, v40, v120
    v_fmac_f32 v235, v33, v153
    v_fmac_f32 v237, v41, v121
    v_fmac_f32 v235, v34, v154
    v_fmac_f32 v237, v42, v122
    v_fmac_f32 v235, v35, v155
    v_fmac_f32 v237, v43, v123
    v_fmac_f32 v235, v36, v156
    v_fmac_f32 v237, v44, v124
    v_fmac_f32 v235, v37, v157
    v_fmac_f32 v237, v45, v125
    v_fmac_f32 v235, v38, v158
    v_fmac_f32 v237, v46, v126
    v_fmac_f32 v235, v39, v159
    v_fmac_f32 v237, v47, v127
    v_mul_f32 v239, v48, v168
    v_mul_f32 v241, v56, v168
    v_fmac_f32 v239, v49, v169
    v_fmac_f32 v241, v57, v169
    s_setprio 1
    s_waitcnt vmcnt(4) lgkmcnt(0)
    v_mfma_f32_32x32x16_bf16 v[0:15], v[64:67], v[176:179], 0
    ds_read_b64_tr_b16 v[184:185], v246 offset:6144
    ds_read_b64_tr_b16 v[186:187], v246 offset:7168
    ds_read_b64_tr_b16 v[188:189], v247 offset:6144
    ds_read_b64_tr_b16 v[190:191], v247 offset:7168
    v_fmac_f32 v239, v50, v170
    v_fmac_f32 v241, v58, v170
    s_mov_b32 m0, s70
    v_mfma_f32_32x32x16_bf16 v[16:31], v[68:71], v[176:179], 0
    buffer_load_dwordx4 v224, s[4:7], s43 offen sc1 lds
    buffer_load_dwordx4 v225, s[72:75], s43 offen offset:1024 sc1 lds
    v_fmac_f32 v239, v51, v171
    v_fmac_f32 v241, v59, v171
    v_fmac_f32 v239, v52, v172
    v_fmac_f32 v241, v60, v172
    v_fmac_f32 v239, v53, v173
    v_mfma_f32_32x32x16_bf16 v[32:47], v[64:67], v[180:183], 0
    v_add_u32 v222, s48, v251
    ds_read2_b32 v[222:223], v222 offset0:1 offset1:3
    v_fmac_f32 v241, v61, v173
    v_fmac_f32 v239, v54, v174
    v_fmac_f32 v241, v62, v174
    v_fmac_f32 v239, v55, v175
    v_fmac_f32 v241, v63, v175
    v_mfma_f32_32x32x16_bf16 v[48:63], v[68:71], v[180:183], 0
    s_waitcnt vmcnt(4) lgkmcnt(1)
    v_mfma_f32_32x32x16_bf16 v[0:15], v[72:75], v[184:187], v[0:15]
    ds_read_b64_tr_b16 v[176:177], v246 offset:0
    ds_read_b64_tr_b16 v[178:179], v246 offset:1024
    ds_read_b64_tr_b16 v[180:181], v247 offset:0
    ds_read_b64_tr_b16 v[182:183], v247 offset:1024
    s_mov_b32 m0, s71
    v_mfma_f32_32x32x16_bf16 v[16:31], v[76:79], v[184:187], v[16:31]
    buffer_load_dwordx4 v226, s[4:7], s43 offen sc1 lds
    buffer_load_dwordx4 v227, s[72:75], s43 offen offset:1024 sc1 lds
    s_waitcnt lgkmcnt(4)
    v_mad_u32_u16 v222, v222, s39, v248 op_sel:[1,0,0,0]
    v_mad_u32_u16 v223, v223, s39, v248 op_sel:[1,0,0,0]
    v_mfma_f32_32x32x16_bf16 v[32:47], v[72:75], v[188:191], v[32:47]
    v_add_u32 v224, s49, v251
    ds_read2_b32 v[224:225], v224 offset0:1 offset1:3
    v_mfma_f32_32x32x16_bf16 v[48:63], v[76:79], v[188:191], v[48:63]
    s_waitcnt vmcnt(4) lgkmcnt(1)
    v_mfma_f32_32x32x16_bf16 v[0:15], v[80:83], v[176:179], v[0:15]
    ds_read_b64_tr_b16 v[184:185], v246 offset:2048
    ds_read_b64_tr_b16 v[186:187], v246 offset:3072
    ds_read_b64_tr_b16 v[188:189], v247 offset:2048
    ds_read_b64_tr_b16 v[190:191], v247 offset:3072
    s_mov_b32 m0, s68
    v_mfma_f32_32x32x16_bf16 v[16:31], v[84:87], v[176:179], v[16:31]
    buffer_load_dwordx4 v222, s[4:7], s44 offen sc1 lds
    buffer_load_dwordx4 v223, s[72:75], s44 offen offset:1024 sc1 lds
    s_waitcnt lgkmcnt(4)
    v_mad_u32_u16 v224, v224, s39, v248 op_sel:[1,0,0,0]
    v_mad_u32_u16 v225, v225, s39, v248 op_sel:[1,0,0,0]
    v_mfma_f32_32x32x16_bf16 v[32:47], v[80:83], v[180:183], v[32:47]
    v_add_u32 v226, s50, v251
    ds_read2_b32 v[226:227], v226 offset0:1 offset1:3
    v_mul_f32 v242, v0, v144
    v_fma_f32 v238, v8, v160, -v238
    v_fmac_f32 v242, v1, v145
    v_fmac_f32 v238, v9, v161
    v_fmac_f32 v242, v2, v146
    v_mfma_f32_32x32x16_bf16 v[48:63], v[84:87], v[180:183], v[48:63]
    s_setprio 0
    v_fmac_f32 v238, v10, v162
    v_fmac_f32 v242, v3, v147
    v_fmac_f32 v238, v11, v163
    v_fmac_f32 v242, v4, v148
    v_fmac_f32 v238, v12, v164
    v_fmac_f32 v242, v5, v149
    v_fmac_f32 v238, v13, v165
    v_fmac_f32 v242, v6, v150
    v_fmac_f32 v238, v14, v166
    v_fmac_f32 v242, v7, v151
    v_fmac_f32 v238, v15, v167
    v_fmac_f32 v236, v16, v112
    v_mul_f32 v244, v24, v160
    v_fmac_f32 v236, v17, v113
    v_fmac_f32 v244, v25, v161
    v_fmac_f32 v236, v18, v114
    v_fmac_f32 v244, v26, v162
    v_fmac_f32 v236, v19, v115
    v_fmac_f32 v244, v27, v163
    v_fmac_f32 v236, v20, v116
    v_fmac_f32 v244, v28, v164
    v_fmac_f32 v236, v21, v117
    v_fmac_f32 v244, v29, v165
    v_fmac_f32 v236, v22, v118
    v_fmac_f32 v244, v30, v166
    v_fmac_f32 v236, v23, v119
    v_fmac_f32 v244, v31, v167
    v_mul_f32 v243, v32, v152
    v_fma_f32 v239, v40, v168, -v239
    v_fmac_f32 v243, v33, v153
    v_fmac_f32 v239, v41, v169
    v_fmac_f32 v243, v34, v154
    v_fmac_f32 v239, v42, v170
    v_fmac_f32 v243, v35, v155
    v_fmac_f32 v239, v43, v171
    v_fmac_f32 v243, v36, v156
    v_fmac_f32 v239, v44, v172
    v_fmac_f32 v243, v37, v157
    v_fmac_f32 v239, v45, v173
    v_fmac_f32 v243, v38, v158
    v_fmac_f32 v239, v46, v174
    v_fmac_f32 v243, v39, v159
    v_fmac_f32 v239, v47, v175
    v_fmac_f32 v237, v48, v120
    v_mul_f32 v245, v56, v168
    v_fmac_f32 v237, v49, v121
    v_fmac_f32 v245, v57, v169
    v_fmac_f32 v237, v50, v122
    s_setprio 1
    s_waitcnt vmcnt(4) lgkmcnt(1)
    v_mfma_f32_32x32x16_bf16 v[0:15], v[64:67], v[184:187], 0
    ds_read_b64_tr_b16 v[176:177], v246 offset:4096
    ds_read_b64_tr_b16 v[178:179], v246 offset:5120
    ds_read_b64_tr_b16 v[180:181], v247 offset:4096
    ds_read_b64_tr_b16 v[182:183], v247 offset:5120
    v_fmac_f32 v245, v58, v170
    v_fmac_f32 v237, v51, v123
    s_mov_b32 m0, s69
    v_mfma_f32_32x32x16_bf16 v[16:31], v[68:71], v[184:187], 0
    buffer_load_dwordx4 v224, s[4:7], s45 offen sc1 lds
    buffer_load_dwordx4 v225, s[72:75], s45 offen offset:1024 sc1 lds
    s_waitcnt lgkmcnt(4)
    v_mad_u32_u16 v226, v226, s39, v248 op_sel:[1,0,0,0]
    v_mad_u32_u16 v227, v227, s39, v248 op_sel:[1,0,0,0]
    v_fmac_f32 v245, v59, v171
    v_fmac_f32 v237, v52, v124
    v_mfma_f32_32x32x16_bf16 v[32:47], v[64:67], v[188:191], 0
    v_fmac_f32 v245, v60, v172
    v_fmac_f32 v237, v53, v125
    v_fmac_f32 v245, v61, v173
    v_fmac_f32 v237, v54, v126
    v_fmac_f32 v245, v62, v174
    v_fmac_f32 v237, v55, v127
    v_fmac_f32 v245, v63, v175
    v_mfma_f32_32x32x16_bf16 v[48:63], v[68:71], v[188:191], 0
    v_permlane32_swap_b32 v242, v234
    v_permlane32_swap_b32 v243, v235
    v_add_f32 v242, v242, v234
    v_add_f32 v243, v243, v235
    s_waitcnt vmcnt(4) lgkmcnt(0)
    v_mfma_f32_32x32x16_bf16 v[0:15], v[72:75], v[176:179], v[0:15]
    ds_read_b64_tr_b16 v[184:185], v246 offset:6144
    ds_read_b64_tr_b16 v[186:187], v246 offset:7168
    ds_read_b64_tr_b16 v[188:189], v247 offset:6144
    ds_read_b64_tr_b16 v[190:191], v247 offset:7168
    v_cvt_pk_bf16_f32 v242, v242, v243
    ds_write_b32 v230, v242 offset:512
    s_mov_b32 m0, s70
    v_mfma_f32_32x32x16_bf16 v[16:31], v[76:79], v[176:179], v[16:31]
    buffer_load_dwordx4 v226, s[4:7], s46 offen sc1 lds
    buffer_load_dwordx4 v227, s[72:75], s46 offen offset:1024 sc1 lds
    s_sub_u32 s26, s48, s29
    s_mov_b32 s29, s48
    s_mov_b32 s30, s3
    s_bfe_u32 s56, s3, 0x40012
    s_mov_b32 s32, s31
    v_mfma_f32_32x32x16_bf16 v[32:47], v[72:75], v[180:183], v[32:47]
    s_cmp_lg_u32 s36, 0
    s_cselect_b32 s56, s56, 0
    s_mov_b32 s31, s35
    v_mfma_f32_32x32x16_bf16 v[48:63], v[76:79], v[180:183], v[48:63]
    s_waitcnt vmcnt(4) lgkmcnt(1)
    v_mfma_f32_32x32x16_bf16 v[0:15], v[80:83], v[184:187], v[0:15]
    ds_read_b64_tr_b16 v[176:177], v246 offset:0
    ds_read_b64_tr_b16 v[178:179], v246 offset:1024
    ds_read_b64_tr_b16 v[180:181], v247 offset:0
    ds_read_b64_tr_b16 v[182:183], v247 offset:1024
    s_mov_b32 m0, s71
    v_mfma_f32_32x32x16_bf16 v[16:31], v[84:87], v[184:187], v[16:31]
    s_cmp_eq_u32 s33, 4
    s_cbranch_scc1 K2_g4_80
    buffer_load_dwordx4 v224, s[4:7], s47 offen sc1 lds
    buffer_load_dwordx4 v225, s[72:75], s47 offen offset:1024 sc1 lds
K2_back_81:
    v_mfma_f32_32x32x16_bf16 v[32:47], v[80:83], v[188:191], v[32:47]
    s_nop 0
    v_mul_f32 v242, v0, v144
    v_fma_f32 v240, v8, v160, -v240
    v_fmac_f32 v242, v1, v145
    v_fmac_f32 v240, v9, v161
    v_fmac_f32 v242, v2, v146
    v_fmac_f32 v240, v10, v162
    v_fmac_f32 v242, v3, v147
    v_mfma_f32_32x32x16_bf16 v[48:63], v[84:87], v[188:191], v[48:63]
    s_setprio 0
    v_fmac_f32 v240, v11, v163
    v_fmac_f32 v242, v4, v148
    v_fmac_f32 v240, v12, v164
    v_fmac_f32 v242, v5, v149
    v_fmac_f32 v240, v13, v165
    v_fmac_f32 v242, v6, v150
    v_fmac_f32 v240, v14, v166
    v_fmac_f32 v242, v7, v151
    v_fmac_f32 v240, v15, v167
    v_add_u32 v249, s26, v249
    v_add_u32 v250, s26, v250
    v_fma_f32 v244, v16, v160, -v244
    v_fmac_f32 v236, v24, v112
    v_fmac_f32 v244, v17, v161
    v_fmac_f32 v236, v25, v113
    v_fmac_f32 v244, v18, v162
    v_fmac_f32 v236, v26, v114
    v_fmac_f32 v244, v19, v163
    v_fmac_f32 v236, v27, v115
    v_fmac_f32 v244, v20, v164
    v_fmac_f32 v236, v28, v116
    v_fmac_f32 v244, v21, v165
    v_fmac_f32 v236, v29, v117
    v_fmac_f32 v244, v22, v166
    v_fmac_f32 v236, v30, v118
    v_fmac_f32 v244, v23, v167
    v_fmac_f32 v236, v31, v119
    ds_read_b64_tr_b16 v[0:1], v249 offset:0
    ds_read_b64_tr_b16 v[2:3], v249 offset:32
    ds_read_u16_d16_hi v16, v250 offset:0
    v_mul_f32 v243, v32, v152
    v_fma_f32 v241, v40, v168, -v241
    v_fmac_f32 v243, v33, v153
    v_fmac_f32 v241, v41, v169
    v_fmac_f32 v243, v34, v154
    v_fmac_f32 v241, v42, v170
    v_fmac_f32 v243, v35, v155
    v_fmac_f32 v241, v43, v171
    v_fmac_f32 v243, v36, v156
    v_fmac_f32 v241, v44, v172
    v_fmac_f32 v243, v37, v157
    v_fmac_f32 v241, v45, v173
    v_fmac_f32 v243, v38, v158
    v_fmac_f32 v241, v46, v174
    v_fmac_f32 v243, v39, v159
    v_fmac_f32 v241, v47, v175
    ds_read_b64_tr_b16 v[4:5], v249 offset:512
    ds_read_b64_tr_b16 v[6:7], v249 offset:544
    ds_read_u16_d16_hi v17, v250 offset:128
    v_fma_f32 v245, v48, v168, -v245
    v_fmac_f32 v237, v56, v120
    v_fmac_f32 v245, v49, v169
    v_fmac_f32 v237, v57, v121
    v_fmac_f32 v245, v50, v170
    v_fmac_f32 v237, v58, v122
    v_fmac_f32 v245, v51, v171
    v_fmac_f32 v237, v59, v123
    v_fmac_f32 v245, v52, v172
    v_fmac_f32 v237, v60, v124
    v_fmac_f32 v245, v53, v173
    v_fmac_f32 v237, v61, v125
    v_fmac_f32 v245, v54, v174
    v_fmac_f32 v237, v62, v126
    v_fmac_f32 v245, v55, v175
    v_fmac_f32 v237, v63, v127
    s_cmp_eq_u32 s56, 5
    s_cbranch_scc1 K2_U21
    s_cmp_eq_u32 s56, 6
    s_cbranch_scc1 K2_U3h1
    s_branch K2_DSP1
K2_U2h1:
    s_setprio 1
    s_waitcnt lgkmcnt(0)
    v_lshlrev_b32 v20, 16, v0
    v_and_b32 v21, 0xffff0000, v0
    v_lshlrev_b32 v22, 16, v1
    v_and_b32 v23, 0xffff0000, v1
    v_lshlrev_b32 v24, 16, v2
    v_and_b32 v25, 0xffff0000, v2
    v_lshlrev_b32 v26, 16, v3
    v_and_b32 v27, 0xffff0000, v3
    v_mul_f32_dpp v36, v16, v20 row_newbcast:8 row_mask:0xf bank_mask:0xf
    v_mul_f32_dpp v37, v16, v21 row_newbcast:9 row_mask:0xf bank_mask:0xf
    v_mul_f32_dpp v38, v16, v22 row_newbcast:10 row_mask:0xf bank_mask:0xf
    v_mul_f32_dpp v39, v16, v23 row_newbcast:11 row_mask:0xf bank_mask:0xf
    v_mul_f32_dpp v40, v16, v24 row_newbcast:12 row_mask:0xf bank_mask:0xf
    v_mul_f32_dpp v41, v16, v25 row_newbcast:13 row_mask:0xf bank_mask:0xf
    v_mul_f32_dpp v42, v16, v26 row_newbcast:14 row_mask:0xf bank_mask:0xf
    v_mul_f32_dpp v43, v16, v27 row_newbcast:15 row_mask:0xf bank_mask:0xf
    v_cvt_pk_bf16_f32 v68, v36, v37
    v_cvt_pk_bf16_f32 v69, v38, v39
    v_cvt_pk_bf16_f32 v70, v40, v41
    v_cvt_pk_bf16_f32 v71, v42, v43
    v_mul_f32_dpp v20, v16, v20 row_newbcast:0 row_mask:0xa bank_mask:0xf
    v_mul_f32_dpp v21, v16, v21 row_newbcast:1 row_mask:0xa bank_mask:0xf
    v_mul_f32_dpp v22, v16, v22 row_newbcast:2 row_mask:0xa bank_mask:0xf
    v_mul_f32_dpp v23, v16, v23 row_newbcast:3 row_mask:0xa bank_mask:0xf
    v_mul_f32_dpp v24, v16, v24 row_newbcast:4 row_mask:0xa bank_mask:0xf
    v_mul_f32_dpp v25, v16, v25 row_newbcast:5 row_mask:0xa bank_mask:0xf
    v_mul_f32_dpp v26, v16, v26 row_newbcast:6 row_mask:0xa bank_mask:0xf
    v_mul_f32_dpp v27, v16, v27 row_newbcast:7 row_mask:0xa bank_mask:0xf
    v_cvt_pk_bf16_f32 v64, v20, v21
    v_cvt_pk_bf16_f32 v65, v22, v23
    v_cvt_pk_bf16_f32 v66, v24, v25
    v_cvt_pk_bf16_f32 v67, v26, v27
    v_lshlrev_b32 v28, 16, v4
    v_and_b32 v29, 0xffff0000, v4
    v_lshlrev_b32 v30, 16, v5
    v_and_b32 v31, 0xffff0000, v5
    v_mul_f32_dpp v36, v17, v28 row_newbcast:8 row_mask:0xf bank_mask:0xf
    v_mul_f32_dpp v37, v17, v29 row_newbcast:9 row_mask:0xf bank_mask:0xf
    v_mul_f32_dpp v38, v17, v30 row_newbcast:10 row_mask:0xf bank_mask:0xf
    v_mul_f32_dpp v39, v17, v31 row_newbcast:11 row_mask:0xf bank_mask:0xf
    v_cvt_pk_bf16_f32 v76, v36, v37
    v_cvt_pk_bf16_f32 v77, v38, v39
    v_mul_f32_dpp v28, v17, v28 row_newbcast:0 row_mask:0xa bank_mask:0xf
    v_mul_f32_dpp v29, v17, v29 row_newbcast:1 row_mask:0xa bank_mask:0xf
    v_mul_f32_dpp v30, v17, v30 row_newbcast:2 row_mask:0xa bank_mask:0xf
    v_mul_f32_dpp v31, v17, v31 row_newbcast:3 row_mask:0xa bank_mask:0xf
    v_cvt_pk_bf16_f32 v72, v28, v29
    v_cvt_pk_bf16_f32 v73, v30, v31
    s_waitcnt vmcnt(4)
    v_mfma_f32_32x32x16_bf16 v[0:15], v[64:67], v[176:179], 0
    ds_read_b64_tr_b16 v[184:185], v246 offset:2048
    ds_read_b64_tr_b16 v[188:189], v247 offset:2048
    s_mov_b32 m0, s68
    v_mfma_f32_32x32x16_bf16 v[16:31], v[68:71], v[176:179], 0
    buffer_load_dwordx4 v222, s[4:7], s42 offen sc1 lds
    buffer_load_dwordx4 v223, s[72:75], s42 offen offset:1024 sc1 lds
    v_permlane32_swap_b32 v242, v236
    v_permlane32_swap_b32 v243, v237
    v_mfma_f32_32x32x16_bf16 v[32:47], v[64:67], v[180:183], 0
    v_permlane32_swap_b32 v244, v238
    v_permlane32_swap_b32 v245, v239
    v_permlane32_swap_b32 v240, v241
    v_add_f32 v242, v242, v236
    v_mfma_f32_32x32x16_bf16 v[48:63], v[68:71], v[180:183], 0
    v_add_f32 v243, v243, v237
    v_add_f32 v244, v244, v238
    v_add_f32 v245, v245, v239
    v_add_f32 v240, -v240, -v241
    v_sub_u32 v241, v230, v231
    v_cvt_pk_bf16_f32 v242, v242, v243
    s_mov_b64 exec, 0x3ff
    ds_add_rtn_u32 v232, v254, v255
    s_mov_b64 exec, -1
    s_waitcnt vmcnt(4) lgkmcnt(1)
    v_mfma_f32_32x32x8_bf16 v[0:15], v[72:73], v[184:185], v[0:15]
    ds_read_b64_tr_b16 v[176:177], v246 offset:4096
    ds_read_b64_tr_b16 v[178:179], v246 offset:5120
    ds_read_b64_tr_b16 v[180:181], v247 offset:4096
    ds_read_b64_tr_b16 v[182:183], v247 offset:5120
    v_cvt_pk_bf16_f32 v244, v244, v245
    v_cvt_pk_bf16_f32 v240, v240, v240
    s_mov_b32 m0, s69
    v_mfma_f32_32x32x8_bf16 v[16:31], v[76:77], v[184:185], v[16:31]
    buffer_load_dwordx4 v224, s[4:7], s42 offen sc1 lds
    ds_write2st64_b32 v230, v242, v244 offset0:3 offset1:4
    ds_write_b16 v241, v240 offset:1280
    s_waitcnt lgkmcnt(6)
    v_readlane_b32 s58, v232, 8
    v_mfma_f32_32x32x8_bf16 v[32:47], v[72:73], v[188:189], v[32:47]
    s_cmp_lt_u32 s58, s22
    s_cbranch_scc0 K2_nul_82
    s_nop 0
    v_readlane_b32 s3, v253, s58
    s_nop 0
    s_bfe_u32 s58, s3, 0x60016
    s_and_b32 s59, s58, 7
    s_lshr_b32 s60, s58, 3
K2_chk_84:
    v_readlane_b32 s61, v232, s59
    s_nop 0
    s_cmp_gt_u32 s61, s60
    s_cbranch_scc0 K2_spin_83
K2_back_85:
    v_mfma_f32_32x32x8_bf16 v[48:63], v[76:77], v[188:189], v[48:63]
    s_setprio 0
    s_lshl_b32 s44, s34, 7
    s_and_b32 s48, s3, 0x3ffff
    s_bfe_u32 s33, s3, 0x30013
    s_mov_b32 s35, s48
    s_mov_b32 s45, s44
    s_xor_b32 s47, s44, 256
    v_mul_f32 v234, v0, v96
    v_mul_f32 v236, v8, v128
    v_fmac_f32 v234, v1, v97
    v_fmac_f32 v236, v9, v129
    v_fmac_f32 v234, v2, v98
    v_fmac_f32 v236, v10, v130
    v_fmac_f32 v234, v3, v99
    v_fmac_f32 v236, v11, v131
    v_fmac_f32 v234, v4, v100
    v_fmac_f32 v236, v12, v132
    v_fmac_f32 v234, v5, v101
    v_fmac_f32 v236, v13, v133
    v_fmac_f32 v234, v6, v102
    v_fmac_f32 v236, v14, v134
    v_fmac_f32 v234, v7, v103
    v_fmac_f32 v236, v15, v135
    v_mul_f32 v238, v16, v128
    v_mul_f32 v240, v24, v128
    v_fmac_f32 v238, v17, v129
    v_fmac_f32 v240, v25, v129
    v_fmac_f32 v238, v18, v130
    v_fmac_f32 v240, v26, v130
    v_fmac_f32 v238, v19, v131
    v_fmac_f32 v240, v27, v131
    v_fmac_f32 v238, v20, v132
    v_fmac_f32 v240, v28, v132
    v_fmac_f32 v238, v21, v133
    v_fmac_f32 v240, v29, v133
    v_fmac_f32 v238, v22, v134
    v_fmac_f32 v240, v30, v134
    v_fmac_f32 v238, v23, v135
    v_fmac_f32 v240, v31, v135
    v_mul_f32 v235, v32, v104
    v_mul_f32 v237, v40, v136
    v_fmac_f32 v235, v33, v105
    v_fmac_f32 v237, v41, v137
    v_fmac_f32 v235, v34, v106
    v_fmac_f32 v237, v42, v138
    v_fmac_f32 v235, v35, v107
    v_fmac_f32 v237, v43, v139
    v_fmac_f32 v235, v36, v108
    v_fmac_f32 v237, v44, v140
    v_fmac_f32 v235, v37, v109
    v_fmac_f32 v237, v45, v141
    v_fmac_f32 v235, v38, v110
    v_fmac_f32 v237, v46, v142
    v_fmac_f32 v235, v39, v111
    v_fmac_f32 v237, v47, v143
    v_mul_f32 v239, v48, v136
    v_mul_f32 v241, v56, v136
    s_setprio 1
    s_waitcnt vmcnt(3) lgkmcnt(2)
    v_mfma_f32_32x32x16_bf16 v[0:15], v[64:67], v[176:179], 0
    ds_read_b64_tr_b16 v[184:185], v246 offset:6144
    ds_read_b64_tr_b16 v[188:189], v247 offset:6144
    v_fmac_f32 v239, v49, v137
    v_fmac_f32 v241, v57, v137
    v_fmac_f32 v239, v50, v138
    v_fmac_f32 v241, v58, v138
    s_mov_b32 m0, s70
    v_mfma_f32_32x32x16_bf16 v[16:31], v[68:71], v[176:179], 0
    buffer_load_dwordx4 v222, s[4:7], s43 offen sc1 lds
    buffer_load_dwordx4 v223, s[72:75], s43 offen offset:1024 sc1 lds
    v_fmac_f32 v239, v51, v139
    v_fmac_f32 v241, v59, v139
    v_fmac_f32 v239, v52, v140
    v_fmac_f32 v241, v60, v140
    v_fmac_f32 v239, v53, v141
    v_mfma_f32_32x32x16_bf16 v[32:47], v[64:67], v[180:183], 0
    s_add_u32 s49, s48, 128
    s_add_u32 s60, s48, 256
    s_cmp_eq_u32 s33, 3
    s_cselect_b32 s46, s44, s47
    s_cselect_b32 s50, s60, s48
    s_sub_u32 s60, s33, 2
    s_cmp_lt_u32 s60, 2
    s_cbranch_scc0 K2_rare_86
K2_back_87:
    v_add_u32 v222, s48, v251
    ds_read2_b32 v[222:223], v222 offset0:1 offset1:3
    v_fmac_f32 v241, v61, v141
    v_fmac_f32 v239, v54, v142
    v_fmac_f32 v241, v62, v142
    v_fmac_f32 v239, v55, v143
    v_fmac_f32 v241, v63, v143
    v_mfma_f32_32x32x16_bf16 v[48:63], v[68:71], v[180:183], 0
    v_permlane32_swap_b32 v234, v236
    v_permlane32_swap_b32 v235, v237
    v_permlane32_swap_b32 v240, v238
    s_waitcnt vmcnt(3) lgkmcnt(1)
    v_mfma_f32_32x32x8_bf16 v[0:15], v[72:73], v[184:185], v[0:15]
    ds_read_b64_tr_b16 v[176:177], v246 offset:0
    ds_read_b64_tr_b16 v[178:179], v246 offset:1024
    ds_read_b64_tr_b16 v[180:181], v247 offset:0
    ds_read_b64_tr_b16 v[182:183], v247 offset:1024
    v_permlane32_swap_b32 v241, v239
    s_mov_b32 m0, s71
    v_mfma_f32_32x32x8_bf16 v[16:31], v[76:77], v[184:185], v[16:31]
    buffer_load_dwordx4 v224, s[4:7], s43 offen sc1 lds
    s_waitcnt lgkmcnt(4)
    v_mad_u32_u16 v222, v222, s39, v248 op_sel:[1,0,0,0]
    v_mad_u32_u16 v223, v223, s39, v248 op_sel:[1,0,0,0]
    v_lshl_add_u32 v230, v252, 1, s31
    v_add_f32 v234, v234, v236
    v_add_f32 v235, v235, v237
    v_add_f32 v240, v240, v238
    v_add_f32 v241, v241, v239
    v_cvt_pk_bf16_f32 v234, v234, v235
    v_cvt_pk_bf16_f32 v240, v240, v241
    ds_write2st64_b32 v230, v234, v240 offset0:0 offset1:1
    v_mfma_f32_32x32x8_bf16 v[32:47], v[72:73], v[188:189], v[32:47]
    v_add_u32 v224, s49, v251
    ds_read2_b32 v[224:225], v224 offset0:1 offset1:3
    v_mul_f32 v234, v0, v144
    v_mul_f32 v236, v8, v112
    v_fmac_f32 v234, v1, v145
    v_fmac_f32 v236, v9, v113
    v_fmac_f32 v234, v2, v146
    v_mfma_f32_32x32x8_bf16 v[48:63], v[76:77], v[188:189], v[48:63]
    s_setprio 0
    v_fmac_f32 v236, v10, v114
    v_fmac_f32 v234, v3, v147
    v_fmac_f32 v236, v11, v115
    v_fmac_f32 v234, v4, v148
    v_fmac_f32 v236, v12, v116
    v_fmac_f32 v234, v5, v149
    v_fmac_f32 v236, v13, v117
    v_fmac_f32 v234, v6, v150
    v_fmac_f32 v236, v14, v118
    v_fmac_f32 v234, v7, v151
    v_fmac_f32 v236, v15, v119
    v_mul_f32 v238, v16, v160
    v_mul_f32 v240, v24, v160
    v_fmac_f32 v238, v17, v161
    v_fmac_f32 v240, v25, v161
    v_fmac_f32 v238, v18, v162
    v_fmac_f32 v240, v26, v162
    v_fmac_f32 v238, v19, v163
    v_fmac_f32 v240, v27, v163
    v_fmac_f32 v238, v20, v164
    v_fmac_f32 v240, v28, v164
    v_fmac_f32 v238, v21, v165
    v_fmac_f32 v240, v29, v165
    v_fmac_f32 v238, v22, v166
    v_fmac_f32 v240, v30, v166
    v_fmac_f32 v238, v23, v167
    v_fmac_f32 v240, v31, v167
    v_mul_f32 v235, v32, v152
    v_mul_f32 v237, v40, v120
    v_fmac_f32 v235, v33, v153
    v_fmac_f32 v237, v41, v121
    v_fmac_f32 v235, v34, v154
    v_fmac_f32 v237, v42, v122
    v_fmac_f32 v235, v35, v155
    v_fmac_f32 v237, v43, v123
    v_fmac_f32 v235, v36, v156
    v_fmac_f32 v237, v44, v124
    v_fmac_f32 v235, v37, v157
    v_fmac_f32 v237, v45, v125
    v_fmac_f32 v235, v38, v158
    v_fmac_f32 v237, v46, v126
    v_fmac_f32 v235, v39, v159
    v_fmac_f32 v237, v47, v127
    v_mul_f32 v239, v48, v168
    v_mul_f32 v241, v56, v168
    v_fmac_f32 v239, v49, v169
    v_fmac_f32 v241, v57, v169
    v_fmac_f32 v239, v50, v170
    s_setprio 1
    s_waitcnt vmcnt(3) lgkmcnt(2)
    v_mfma_f32_32x32x16_bf16 v[0:15], v[64:67], v[176:179], 0
    ds_read_b64_tr_b16 v[184:185], v246 offset:2048
    ds_read_b64_tr_b16 v[188:189], v247 offset:2048
    v_fmac_f32 v241, v58, v170
    v_fmac_f32 v239, v51, v171
    v_fmac_f32 v241, v59, v171
    v_fmac_f32 v239, v52, v172
    s_mov_b32 m0, s68
    v_mfma_f32_32x32x16_bf16 v[16:31], v[68:71], v[176:179], 0
    buffer_load_dwordx4 v222, s[4:7], s44 offen sc1 lds
    buffer_load_dwordx4 v223, s[72:75], s44 offen offset:1024 sc1 lds
    s_waitcnt lgkmcnt(2)
    v_mad_u32_u16 v224, v224, s39, v248 op_sel:[1,0,0,0]
    v_mad_u32_u16 v225, v225, s39, v248 op_sel:[1,0,0,0]
    v_fmac_f32 v241, v60, v172
    v_fmac_f32 v239, v53, v173
    v_mfma_f32_32x32x16_bf16 v[32:47], v[64:67], v[180:183], 0
    v_add_u32 v226, s50, v251
    ds_read2_b32 v[226:227], v226 offset0:1 offset1:3
    v_fmac_f32 v241, v61, v173
    v_fmac_f32 v239, v54, v174
    v_fmac_f32 v241, v62, v174
    v_fmac_f32 v239, v55, v175
    v_fmac_f32 v241, v63, v175
    v_mfma_f32_32x32x16_bf16 v[48:63], v[68:71], v[180:183], 0
    s_waitcnt vmcnt(3) lgkmcnt(1)
    v_mfma_f32_32x32x8_bf16 v[0:15], v[72:73], v[184:185], v[0:15]
    ds_read_b64_tr_b16 v[176:177], v246 offset:4096
    ds_read_b64_tr_b16 v[178:179], v246 offset:5120
    ds_read_b64_tr_b16 v[180:181], v247 offset:4096
    ds_read_b64_tr_b16 v[182:183], v247 offset:5120
    s_mov_b32 m0, s69
    v_mfma_f32_32x32x8_bf16 v[16:31], v[76:77], v[184:185], v[16:31]
    buffer_load_dwordx4 v224, s[4:7], s45 offen sc1 lds
    buffer_load_dwordx4 v225, s[72:75], s45 offen offset:1024 sc1 lds
    s_waitcnt lgkmcnt(4)
    v_mad_u32_u16 v226, v226, s39, v248 op_sel:[1,0,0,0]
    v_mad_u32_u16 v227, v227, s39, v248 op_sel:[1,0,0,0]
    v_mfma_f32_32x32x8_bf16 v[32:47], v[72:73], v[188:189], v[32:47]
    v_mul_f32 v242, v0, v144
    v_fma_f32 v238, v8, v160, -v238
    v_fmac_f32 v242, v1, v145
    v_fmac_f32 v238, v9, v161
    v_fmac_f32 v242, v2, v146
    v_fmac_f32 v238, v10, v162
    v_fmac_f32 v242, v3, v147
    v_mfma_f32_32x32x8_bf16 v[48:63], v[76:77], v[188:189], v[48:63]
    s_setprio 0
    v_fmac_f32 v238, v11, v163
    v_fmac_f32 v242, v4, v148
    v_fmac_f32 v238, v12, v164
    v_fmac_f32 v242, v5, v149
    v_fmac_f32 v238, v13, v165
    v_fmac_f32 v242, v6, v150
    v_fmac_f32 v238, v14, v166
    v_fmac_f32 v242, v7, v151
    v_fmac_f32 v238, v15, v167
    v_fmac_f32 v236, v16, v112
    v_mul_f32 v244, v24, v160
    v_fmac_f32 v236, v17, v113
    v_fmac_f32 v244, v25, v161
    v_fmac_f32 v236, v18, v114
    v_fmac_f32 v244, v26, v162
    v_fmac_f32 v236, v19, v115
    v_fmac_f32 v244, v27, v163
    v_fmac_f32 v236, v20, v116
    v_fmac_f32 v244, v28, v164
    v_fmac_f32 v236, v21, v117
    v_fmac_f32 v244, v29, v165
    v_fmac_f32 v236, v22, v118
    v_fmac_f32 v244, v30, v166
    v_fmac_f32 v236, v23, v119
    v_fmac_f32 v244, v31, v167
    v_mul_f32 v243, v32, v152
    v_fma_f32 v239, v40, v168, -v239
    v_fmac_f32 v243, v33, v153
    v_fmac_f32 v239, v41, v169
    v_fmac_f32 v243, v34, v154
    v_fmac_f32 v239, v42, v170
    v_fmac_f32 v243, v35, v155
    v_fmac_f32 v239, v43, v171
    v_fmac_f32 v243, v36, v156
    v_fmac_f32 v239, v44, v172
    v_fmac_f32 v243, v37, v157
    v_fmac_f32 v239, v45, v173
    v_fmac_f32 v243, v38, v158
    v_fmac_f32 v239, v46, v174
    v_fmac_f32 v243, v39, v159
    v_fmac_f32 v239, v47, v175
    s_setprio 1
    s_waitcnt vmcnt(4) lgkmcnt(0)
    v_mfma_f32_32x32x16_bf16 v[0:15], v[64:67], v[176:179], 0
    ds_read_b64_tr_b16 v[184:185], v246 offset:6144
    ds_read_b64_tr_b16 v[188:189], v247 offset:6144
    v_fmac_f32 v237, v48, v120
    v_mul_f32 v245, v56, v168
    v_fmac_f32 v237, v49, v121
    v_fmac_f32 v245, v57, v169
    s_mov_b32 m0, s70
    v_mfma_f32_32x32x16_bf16 v[16:31], v[68:71], v[176:179], 0
    buffer_load_dwordx4 v226, s[4:7], s46 offen sc1 lds
    buffer_load_dwordx4 v227, s[72:75], s46 offen offset:1024 sc1 lds
    v_fmac_f32 v237, v50, v122
    v_fmac_f32 v245, v58, v170
    v_fmac_f32 v237, v51, v123
    v_fmac_f32 v245, v59, v171
    v_fmac_f32 v237, v52, v124
    v_mfma_f32_32x32x16_bf16 v[32:47], v[64:67], v[180:183], 0
    v_fmac_f32 v245, v60, v172
    v_fmac_f32 v237, v53, v125
    v_fmac_f32 v245, v61, v173
    v_fmac_f32 v237, v54, v126
    v_fmac_f32 v245, v62, v174
    v_fmac_f32 v237, v55, v127
    v_fmac_f32 v245, v63, v175
    v_mfma_f32_32x32x16_bf16 v[48:63], v[68:71], v[180:183], 0
    v_permlane32_swap_b32 v242, v234
    v_permlane32_swap_b32 v243, v235
    v_add_f32 v242, v242, v234
    v_add_f32 v243, v243, v235
    s_waitcnt vmcnt(4) lgkmcnt(0)
    v_mfma_f32_32x32x8_bf16 v[0:15], v[72:73], v[184:185], v[0:15]
    ds_read_b64_tr_b16 v[176:177], v246 offset:0
    ds_read_b64_tr_b16 v[178:179], v246 offset:1024
    ds_read_b64_tr_b16 v[180:181], v247 offset:0
    ds_read_b64_tr_b16 v[182:183], v247 offset:1024
    v_cvt_pk_bf16_f32 v242, v242, v243
    ds_write_b32 v230, v242 offset:512
    s_mov_b32 m0, s71
    v_mfma_f32_32x32x8_bf16 v[16:31], v[76:77], v[184:185], v[16:31]
    s_cmp_eq_u32 s33, 4
    s_cbranch_scc1 K2_g4_89
    buffer_load_dwordx4 v224, s[4:7], s47 offen sc1 lds
    buffer_load_dwordx4 v225, s[72:75], s47 offen offset:1024 sc1 lds
K2_back_90:
    s_sub_u32 s26, s48, s29
    s_mov_b32 s29, s48
    s_mov_b32 s30, s3
    s_bfe_u32 s56, s3, 0x40012
    s_cmp_lg_u32 s36, 0
    s_cselect_b32 s56, s56, 0
    v_mfma_f32_32x32x8_bf16 v[32:47], v[72:73], v[188:189], v[32:47]
    s_mov_b32 s32, s31
    s_mov_b32 s31, s35
    v_mul_f32 v242, v0, v144
    v_fma_f32 v240, v8, v160, -v240
    v_fmac_f32 v242, v1, v145
    v_fmac_f32 v240, v9, v161
    v_fmac_f32 v242, v2, v146
    v_mfma_f32_32x32x8_bf16 v[48:63], v[76:77], v[188:189], v[48:63]
    s_setprio 0
    v_fmac_f32 v240, v10, v162
    v_fmac_f32 v242, v3, v147
    v_fmac_f32 v240, v11, v163
    v_fmac_f32 v242, v4, v148
    v_fmac_f32 v240, v12, v164
    v_fmac_f32 v242, v5, v149
    v_fmac_f32 v240, v13, v165
    v_fmac_f32 v242, v6, v150
    v_fmac_f32 v240, v14, v166
    v_fmac_f32 v242, v7, v151
    v_fmac_f32 v240, v15, v167
    v_add_u32 v249, s26, v249
    v_add_u32 v250, s26, v250
    v_fma_f32 v244, v16, v160, -v244
    v_fmac_f32 v236, v24, v112
    v_fmac_f32 v244, v17, v161
    v_fmac_f32 v236, v25, v113
    v_fmac_f32 v244, v18, v162
    v_fmac_f32 v236, v26, v114
    v_fmac_f32 v244, v19, v163
    v_fmac_f32 v236, v27, v115
    v_fmac_f32 v244, v20, v164
    v_fmac_f32 v236, v28, v116
    v_fmac_f32 v244, v21, v165
    v_fmac_f32 v236, v29, v117
    v_fmac_f32 v244, v22, v166
    v_fmac_f32 v236, v30, v118
    v_fmac_f32 v244, v23, v167
    v_fmac_f32 v236, v31, v119
    ds_read_b64_tr_b16 v[0:1], v249 offset:0
    ds_read_b64_tr_b16 v[2:3], v249 offset:32
    ds_read_u16_d16_hi v16, v250 offset:0
    v_mul_f32 v243, v32, v152
    v_fma_f32 v241, v40, v168, -v241
    v_fmac_f32 v243, v33, v153
    v_fmac_f32 v241, v41, v169
    v_fmac_f32 v243, v34, v154
    v_fmac_f32 v241, v42, v170
    v_fmac_f32 v243, v35, v155
    v_fmac_f32 v241, v43, v171
    v_fmac_f32 v243, v36, v156
    v_fmac_f32 v241, v44, v172
    v_fmac_f32 v243, v37, v157
    v_fmac_f32 v241, v45, v173
    v_fmac_f32 v243, v38, v158
    v_fmac_f32 v241, v46, v174
    v_fmac_f32 v243, v39, v159
    v_fmac_f32 v241, v47, v175
    ds_read_b64_tr_b16 v[4:5], v249 offset:512
    ds_read_b64_tr_b16 v[6:7], v249 offset:544
    ds_read_u16_d16_hi v17, v250 offset:128
    v_fma_f32 v245, v48, v168, -v245
    v_fmac_f32 v237, v56, v120
    v_fmac_f32 v245, v49, v169
    v_fmac_f32 v237, v57, v121
    v_fmac_f32 v245, v50, v170
    v_fmac_f32 v237, v58, v122
    v_fmac_f32 v245, v51, v171
    v_fmac_f32 v237, v59, v123
    v_fmac_f32 v245, v52, v172
    v_fmac_f32 v237, v60, v124
    v_fmac_f32 v245, v53, v173
    v_fmac_f32 v237, v61, v125
    v_fmac_f32 v245, v54, v174
    v_fmac_f32 v237, v62, v126
    v_fmac_f32 v245, v55, v175
    v_fmac_f32 v237, v63, v127
    s_cmp_eq_u32 s56, 5
    s_cbranch_scc1 K2_U21
    s_cmp_eq_u32 s56, 6
    s_cbranch_scc1 K2_U3h1
    s_branch K2_DSP1
K2_PAD_SW:
    s_branch K2_HOP
K2_DSP0:
    s_cmp_eq_u32 s56, 4
    s_cbranch_scc1 K2_U20
    s_cmp_eq_u32 s56, 7
    s_cbranch_scc1 K2_U30
    s_cmp_gt_u32 s56, 7
    s_cbranch_scc1 K2_U40
    s_cmp_lg_u32 s56, 0
    s_cbranch_scc1 K2_U10
    s_branch K2_SWITCH
K2_DSP1:
    s_cmp_eq_u32 s56, 4
    s_cbranch_scc1 K2_U2h1
    s_cmp_eq_u32 s56, 7
    s_cbranch_scc1 K2_U31
    s_cmp_gt_u32 s56, 7
    s_cbranch_scc1 K2_U41
    s_cmp_lg_u32 s56, 0
    s_cbranch_scc1 K2_U11
    s_branch K2_TAIL
K2_SWITCH:
    v_lshlrev_b32 v60, 3, v252
    s_mov_b32 s64, 7176192
    buffer_load_dwordx4 v[56:59], v60, s[8:11], s64 offen sc1
    v_permlane32_swap_b32 v242, v236
    v_permlane32_swap_b32 v243, v237
    v_permlane32_swap_b32 v244, v238
    v_permlane32_swap_b32 v245, v239
    v_permlane32_swap_b32 v240, v241
    v_add_f32 v242, v242, v236
    v_add_f32 v243, v243, v237
    v_add_f32 v244, v244, v238
    v_add_f32 v245, v245, v239
    v_add_f32 v240, -v240, -v241
    s_set_gpr_idx_on s32, gpr_idx(DST)
    s_nop 0
    v_cvt_pk_bf16_f32 v195, v242, v243
    v_cvt_pk_bf16_f32 v196, v244, v245
    v_cvt_pk_bf16_f32 v197, v240, v240
    s_set_gpr_idx_off
    v_lshl_add_u32 v230, v252, 1, s35
    v_lshrrev_b32 v231, 6, v252
    v_mul_u32_u24 v231, 126, v231
    v_bfe_u32 v61, v253, 22, 6
    v_lshlrev_b32 v62, 21, v252
    s_mov_b32 s58, 264241152
    v_lshlrev_b32 v61, 2, v61
    v_bfi_b32 v62, s58, v62, v253
    ds_bpermute_b32 v253, v61, v62
    v_lshrrev_b32 v254, 6, v252
    v_bfe_u32 v255, v252, 3, 2
    v_lshl_add_u32 v254, v254, 2, v255
    v_mul_u32_u24 v254, 640, v254
    v_bfe_u32 v255, v252, 5, 1
    v_lshl_add_u32 v254, v255, 5, v254
    v_and_b32 v255, 6, v252
    v_lshl_add_u32 v254, v255, 2, v254
    v_add_u32 v254, 152832, v254
    ds_read_b64_tr_b16 v[104:105], v254 offset:0
    ds_read_b64_tr_b16 v[106:107], v254 offset:5120
    ds_read_b64_tr_b16 v[108:109], v254 offset:64
    ds_read_b64_tr_b16 v[110:111], v254 offset:5184
    ds_read_b64_tr_b16 v[120:121], v254 offset:128
    ds_read_b64_tr_b16 v[122:123], v254 offset:5248
    ds_read_b64_tr_b16 v[124:125], v254 offset:192
    ds_read_b64_tr_b16 v[126:127], v254 offset:5312
    ds_read_b64_tr_b16 v[136:137], v254 offset:256
    ds_read_b64_tr_b16 v[138:139], v254 offset:5376
    ds_read_b64_tr_b16 v[140:141], v254 offset:320
    ds_read_b64_tr_b16 v[142:143], v254 offset:5440
    ds_read_b64_tr_b16 v[152:153], v254 offset:384
    ds_read_b64_tr_b16 v[154:155], v254 offset:5504
    ds_read_b64_tr_b16 v[156:157], v254 offset:448
    ds_read_b64_tr_b16 v[158:159], v254 offset:5568
    ds_read_b64_tr_b16 v[168:169], v254 offset:512
    ds_read_b64_tr_b16 v[170:171], v254 offset:5632
    ds_read_b64_tr_b16 v[172:173], v254 offset:576
    ds_read_b64_tr_b16 v[174:175], v254 offset:5696
    s_movk_i32 s40, 128
    s_movk_i32 s41, 384
    s_movk_i32 s42, 640
    s_movk_i32 s43, 896
    v_lshl_add_u32 v254, v252, 1, s53
    v_cmp_eq_u32 vcc, 16, v252
    s_nop 1
    v_cndmask_b32 v255, 0, 1, vcc
    s_waitcnt lgkmcnt(15)
    v_lshlrev_b32 v96, 16, v104
    v_and_b32 v97, 0xffff0000, v104
    v_lshlrev_b32 v98, 16, v105
    v_and_b32 v99, 0xffff0000, v105
    v_lshlrev_b32 v100, 16, v106
    v_and_b32 v101, 0xffff0000, v106
    v_lshlrev_b32 v102, 16, v107
    v_and_b32 v103, 0xffff0000, v107
    v_lshlrev_b32 v104, 16, v108
    v_and_b32 v105, 0xffff0000, v108
    v_lshlrev_b32 v106, 16, v109
    v_and_b32 v107, 0xffff0000, v109
    v_lshlrev_b32 v108, 16, v110
    v_and_b32 v109, 0xffff0000, v110
    v_lshlrev_b32 v110, 16, v111
    v_and_b32 v111, 0xffff0000, v111
    s_waitcnt lgkmcnt(12)
    v_lshlrev_b32 v112, 16, v120
    v_and_b32 v113, 0xffff0000, v120
    v_lshlrev_b32 v114, 16, v121
    v_and_b32 v115, 0xffff0000, v121
    v_lshlrev_b32 v116, 16, v122
    v_and_b32 v117, 0xffff0000, v122
    v_lshlrev_b32 v118, 16, v123
    v_and_b32 v119, 0xffff0000, v123
    v_lshlrev_b32 v120, 16, v124
    v_and_b32 v121, 0xffff0000, v124
    v_lshlrev_b32 v122, 16, v125
    v_and_b32 v123, 0xffff0000, v125
    v_lshlrev_b32 v124, 16, v126
    v_and_b32 v125, 0xffff0000, v126
    v_lshlrev_b32 v126, 16, v127
    v_and_b32 v127, 0xffff0000, v127
    s_waitcnt lgkmcnt(8)
    v_lshlrev_b32 v128, 16, v136
    v_and_b32 v129, 0xffff0000, v136
    v_lshlrev_b32 v130, 16, v137
    v_and_b32 v131, 0xffff0000, v137
    v_lshlrev_b32 v132, 16, v138
    v_and_b32 v133, 0xffff0000, v138
    v_lshlrev_b32 v134, 16, v139
    v_and_b32 v135, 0xffff0000, v139
    v_lshlrev_b32 v136, 16, v140
    v_and_b32 v137, 0xffff0000, v140
    v_lshlrev_b32 v138, 16, v141
    v_and_b32 v139, 0xffff0000, v141
    v_lshlrev_b32 v140, 16, v142
    v_and_b32 v141, 0xffff0000, v142
    v_lshlrev_b32 v142, 16, v143
    v_and_b32 v143, 0xffff0000, v143
    s_waitcnt lgkmcnt(4)
    v_lshlrev_b32 v144, 16, v152
    v_and_b32 v145, 0xffff0000, v152
    v_lshlrev_b32 v146, 16, v153
    v_and_b32 v147, 0xffff0000, v153
    v_lshlrev_b32 v148, 16, v154
    v_and_b32 v149, 0xffff0000, v154
    v_lshlrev_b32 v150, 16, v155
    v_and_b32 v151, 0xffff0000, v155
    v_lshlrev_b32 v152, 16, v156
    v_and_b32 v153, 0xffff0000, v156
    v_lshlrev_b32 v154, 16, v157
    v_and_b32 v155, 0xffff0000, v157
    v_lshlrev_b32 v156, 16, v158
    v_and_b32 v157, 0xffff0000, v158
    v_lshlrev_b32 v158, 16, v159
    v_and_b32 v159, 0xffff0000, v159
    s_waitcnt lgkmcnt(0)
    v_lshlrev_b32 v160, 16, v168
    v_and_b32 v161, 0xffff0000, v168
    v_lshlrev_b32 v162, 16, v169
    v_and_b32 v163, 0xffff0000, v169
    v_lshlrev_b32 v164, 16, v170
    v_and_b32 v165, 0xffff0000, v170
    v_lshlrev_b32 v166, 16, v171
    v_and_b32 v167, 0xffff0000, v171
    v_lshlrev_b32 v168, 16, v172
    v_and_b32 v169, 0xffff0000, v172
    v_lshlrev_b32 v170, 16, v173
    v_and_b32 v171, 0xffff0000, v173
    v_lshlrev_b32 v172, 16, v174
    v_and_b32 v173, 0xffff0000, v174
    v_lshlrev_b32 v174, 16, v175
    v_and_b32 v175, 0xffff0000, v175
    s_waitcnt vmcnt(0)
K2_FLGW:
    s_or_b32 s58, s54, s20
    v_xor_b32 v56, s2, v56
    v_xor_b32 v57, s2, v57
    v_xor_b32 v58, s2, v58
    v_xor_b32 v59, s2, v59
    v_or3_b32 v56, v56, v57, v58
    v_or_b32 v56, v56, v59
    v_cmp_ne_u32 vcc, 0, v56
    s_nop 0
    s_cbranch_vccnz K2_FLGR
    s_cmp_eq_u32 s58, 0
    s_cbranch_scc1 K2_FLGY
K2_FLGOK:
    s_cmp_eq_u32 s36, 0
    s_cbranch_scc1 K2_TAIL2
    s_mov_b32 s29, s48
    s_mov_b32 s32, s31
    s_mov_b32 s30, s3
    s_mov_b32 s31, s35
    s_bfe_u32 s56, s3, 0x40012
    s_cmp_eq_u32 s56, 5
    s_cbranch_scc1 K2_U21
    s_cmp_eq_u32 s56, 6
    s_cbranch_scc1 K2_U3h1
    s_branch K2_DSP1
K2_dum_4:
    v_mov_b32 v232, -1
    s_mov_b32 m0, 163312
    s_mov_b64 exec, 1
    buffer_load_dwordx4 v232, s[16:19], 0 offen lds
    buffer_load_dwordx4 v232, s[16:19], 0 offen lds
    s_mov_b64 exec, -1
    s_branch K2_back_6
K2_nul_12:
    s_mov_b32 s58, 63
    s_mov_b32 s36, 0
    s_branch K2_back_15
K2_spin_13:
    s_sub_u32 s27, s27, 1
    s_cbranch_scc1 K2_END
    ds_read_b32 v232, v254
    s_waitcnt lgkmcnt(0)
    s_branch K2_chk_14
K2_dyn_10:
    v_lshl_add_u32 v254, v252, 1, s53
    v_cmp_eq_u32 vcc, 16, v252
    s_nop 1
    v_cndmask_b32 v255, 0, 1, vcc
    s_mov_b64 exec, 0x3ff
    ds_add_rtn_u32 v232, v254, v255
    s_mov_b64 exec, -1
    s_waitcnt lgkmcnt(0)
    v_readlane_b32 s58, v232, 8
    s_nop 0
    s_mov_b32 s0, s58
    s_cmp_lt_u32 s58, s22
    s_cbranch_scc0 K2_nul_12
    v_readlane_b32 s3, v253, s58
    s_nop 0
    s_bfe_u32 s58, s3, 0x60016
    s_and_b32 s59, s58, 7
    s_lshr_b32 s60, s58, 3
K2_chk_14:
    v_readlane_b32 s61, v232, s59
    s_nop 0
    s_cmp_gt_u32 s61, s60
    s_cbranch_scc0 K2_spin_13
K2_back_15:
    s_mov_b32 s34, 1
    s_branch K2_back_11
K2_dum_21:
    v_mov_b32 v232, -1
    s_mov_b32 m0, 163312
    s_mov_b64 exec, 1
    buffer_load_dwordx4 v232, s[16:19], 0 offen lds
    buffer_load_dwordx4 v232, s[16:19], 0 offen lds
    s_mov_b64 exec, -1
    s_branch K2_back_23
K2_nul_27:
    s_mov_b32 s58, 63
    s_mov_b32 s36, 0
    s_branch K2_back_30
K2_spin_28:
    s_sub_u32 s27, s27, 1
    s_cbranch_scc1 K2_END
    ds_read_b32 v232, v254
    s_waitcnt lgkmcnt(0)
    s_branch K2_chk_29
K2_dyn_25:
    v_lshl_add_u32 v254, v252, 1, s53
    v_cmp_eq_u32 vcc, 16, v252
    s_nop 1
    v_cndmask_b32 v255, 0, 1, vcc
    s_mov_b64 exec, 0x3ff
    ds_add_rtn_u32 v232, v254, v255
    s_mov_b64 exec, -1
    s_waitcnt lgkmcnt(0)
    v_readlane_b32 s58, v232, 8
    s_nop 0
    s_mov_b32 s0, s58
    s_cmp_lt_u32 s58, s22
    s_cbranch_scc0 K2_nul_27
    v_readlane_b32 s3, v253, s58
    s_nop 0
    s_bfe_u32 s58, s3, 0x60016
    s_and_b32 s59, s58, 7
    s_lshr_b32 s60, s58, 3
K2_chk_29:
    v_readlane_b32 s61, v232, s59
    s_nop 0
    s_cmp_gt_u32 s61, s60
    s_cbranch_scc0 K2_spin_28
K2_back_30:
    s_mov_b32 s34, 1
    s_branch K2_back_26
K2_dum_36:
    v_mov_b32 v232, -1
    s_mov_b32 m0, 163312
    s_mov_b64 exec, 1
    buffer_load_dwordx4 v232, s[16:19], 0 offen lds
    buffer_load_dwordx4 v232, s[16:19], 0 offen lds
    s_mov_b64 exec, -1
    s_branch K2_back_38
K2_nul_42:
    s_mov_b32 s58, 63
    s_mov_b32 s36, 0
    s_branch K2_back_45
K2_spin_43:
    s_sub_u32 s27, s27, 1
    s_cbranch_scc1 K2_END
    ds_read_b32 v232, v254
    s_waitcnt lgkmcnt(0)
    s_branch K2_chk_44
K2_dyn_40:
    v_lshl_add_u32 v254, v252, 1, s53
    v_cmp_eq_u32 vcc, 16, v252
    s_nop 1
    v_cndmask_b32 v255, 0, 1, vcc
    s_mov_b64 exec, 0x3ff
    ds_add_rtn_u32 v232, v254, v255
    s_mov_b64 exec, -1
    s_waitcnt lgkmcnt(0)
    v_readlane_b32 s58, v232, 8
    s_nop 0
    s_mov_b32 s0, s58
    s_cmp_lt_u32 s58, s22
    s_cbranch_scc0 K2_nul_42
    v_readlane_b32 s3, v253, s58
    s_nop 0
    s_bfe_u32 s58, s3, 0x60016
    s_and_b32 s59, s58, 7
    s_lshr_b32 s60, s58, 3
K2_chk_44:
    v_readlane_b32 s61, v232, s59
    s_nop 0
    s_cmp_gt_u32 s61, s60
    s_cbranch_scc0 K2_spin_43
K2_back_45:
    s_mov_b32 s34, 1
    s_branch K2_back_41
K2_dum_51:
    v_mov_b32 v232, -1
    s_mov_b32 m0, 163312
    s_mov_b64 exec, 1
    buffer_load_dwordx4 v232, s[16:19], 0 offen lds
    buffer_load_dwordx4 v232, s[16:19], 0 offen lds
    s_mov_b64 exec, -1
    s_branch K2_back_53
K2_nul_55:
    s_mov_b32 s3, 949760
    s_mov_b32 s36, 0
    s_branch K2_back_58
K2_spin_56:
    s_sub_u32 s27, s27, 1
    s_cbranch_scc1 K2_END
    ds_read_b32 v232, v254
    s_waitcnt lgkmcnt(0)
    s_branch K2_chk_57
K2_nul_64:
    s_mov_b32 s3, 949760
    s_mov_b32 s36, 0
    s_branch K2_back_67
K2_spin_65:
    s_sub_u32 s27, s27, 1
    s_cbranch_scc1 K2_END
    ds_read_b32 v232, v254
    s_waitcnt lgkmcnt(0)
    s_branch K2_chk_66
K2_nul_73:
    s_mov_b32 s3, 949760
    s_mov_b32 s36, 0
    s_branch K2_back_76
K2_spin_74:
    s_sub_u32 s27, s27, 1
    s_cbranch_scc1 K2_END
    ds_read_b32 v232, v254
    s_waitcnt lgkmcnt(0)
    s_branch K2_chk_75
K2_nul_82:
    s_mov_b32 s3, 949760
    s_mov_b32 s36, 0
    s_branch K2_back_85
K2_spin_83:
    s_sub_u32 s27, s27, 1
    s_cbranch_scc1 K2_END
    ds_read_b32 v232, v254
    s_waitcnt lgkmcnt(0)
    s_branch K2_chk_84
K2_PAD_TL:
    s_branch K2_HOP
K2_TAIL2:
    v_lshlrev_b32 v229, 3, v252
    s_mul_i32 s58, s20, 20480
    s_add_u32 s58, s58, 6946816
    s_mul_i32 s59, s20, 8224
    buffer_load_dwordx4 v[96:99], v229, s[8:11], s58 offen offset:0 sc1
    buffer_load_dwordx4 v[100:103], v229, s[8:11], s58 offen offset:1024 sc1
    buffer_load_dwordx4 v[104:107], v229, s[8:11], s58 offen offset:2048 sc1
    buffer_load_dwordx4 v[108:111], v229, s[8:11], s58 offen offset:3072 sc1
    s_add_u32 s58, s58, 4096
    buffer_load_dwordx4 v[128:131], v229, s[8:11], s58 offen offset:0 sc1
    buffer_load_dwordx4 v[132:135], v229, s[8:11], s58 offen offset:1024 sc1
    buffer_load_dwordx4 v[136:139], v229, s[8:11], s58 offen offset:2048 sc1
    buffer_load_dwordx4 v[140:143], v229, s[8:11], s58 offen offset:3072 sc1
    v_lshl_add_u32 v228, v252, 1, s59
    v_lshrrev_b32 v226, 6, v252
    v_mul_u32_u24 v226, 126, v226
    v_sub_u32 v226, v228, v226
    s_branch K2_TAIL3
K2_TAIL:
    v_lshlrev_b32 v229, 3, v252
    s_mul_i32 s58, s20, 20480
    s_add_u32 s58, s58, 6946816
    s_mul_i32 s59, s20, 8224
    buffer_load_dwordx4 v[96:99], v229, s[8:11], s58 offen offset:0 sc1
    v_permlane32_swap_b32 v242, v236
    v_permlane32_swap_b32 v243, v237
    v_permlane32_swap_b32 v244, v238
    buffer_load_dwordx4 v[100:103], v229, s[8:11], s58 offen offset:1024 sc1
    v_permlane32_swap_b32 v245, v239
    v_permlane32_swap_b32 v240, v241
    v_add_f32 v242, v242, v236
    buffer_load_dwordx4 v[104:107], v229, s[8:11], s58 offen offset:2048 sc1
    v_add_f32 v243, v243, v237
    v_add_f32 v244, v244, v238
    v_add_f32 v245, v245, v239
    buffer_load_dwordx4 v[108:111], v229, s[8:11], s58 offen offset:3072 sc1
    v_add_f32 v240, -v240, -v241
    v_sub_u32 v241, v230, v231
    v_cvt_pk_bf16_f32 v242, v242, v243
    s_add_u32 s58, s58, 4096
    buffer_load_dwordx4 v[128:131], v229, s[8:11], s58 offen offset:0 sc1
    v_cvt_pk_bf16_f32 v244, v244, v245
    v_cvt_pk_bf16_f32 v240, v240, v240
    ds_write2st64_b32 v230, v242, v244 offset0:3 offset1:4
    buffer_load_dwordx4 v[132:135], v229, s[8:11], s58 offen offset:1024 sc1
    ds_write_b16 v241, v240 offset:1280
    v_lshl_add_u32 v228, v252, 1, s59
    v_lshrrev_b32 v226, 6, v252
    buffer_load_dwordx4 v[136:139], v229, s[8:11], s58 offen offset:2048 sc1
    v_mul_u32_u24 v226, 126, v226
    v_sub_u32 v226, v228, v226
    buffer_load_dwordx4 v[140:143], v229, s[8:11], s58 offen offset:3072 sc1
K2_TAIL3:
    s_waitcnt vmcnt(8)
    ds_write2st64_b32 v228, v192, v193 offset0:0 offset1:1
    ds_write2st64_b32 v228, v194, v195 offset0:2 offset1:3
    s_add_u32 s58, s58, 4096
    buffer_load_dwordx4 v[112:115], v229, s[8:11], s58 offen offset:0 sc1
    v_bfe_u32 v48, v252, 1, 4
    v_lshrrev_b32 v49, 5, v252
    ds_write_b16 v226, v197 offset:1280
    ds_write2st64_b32 v228, v196, v198 offset0:4 offset1:6
    buffer_load_dwordx4 v[116:119], v229, s[8:11], s58 offen offset:1024 sc1
    v_lshrrev_b32 v55, 3, v48
    v_lshlrev_b32 v52, 4, v49
    ds_write2st64_b32 v228, v199, v200 offset0:7 offset1:8
    ds_write2st64_b32 v228, v201, v202 offset0:9 offset1:10
    buffer_load_dwordx4 v[120:123], v229, s[8:11], s58 offen offset:2048 sc1
    v_lshl_add_u32 v54, v55, 2, v48
    v_and_b32 v54, 7, v54
    ds_write_b16 v226, v203 offset:2816
    ds_write2st64_b32 v228, v204, v205 offset0:12 offset1:13
    buffer_load_dwordx4 v[124:127], v229, s[8:11], s58 offen offset:3072 sc1
    v_and_b32 v50, 7, v48
    v_mul_u32_u24 v50, 8224, v50
    ds_write2st64_b32 v228, v206, v207 offset0:14 offset1:15
    ds_write2st64_b32 v228, v208, v210 offset0:16 offset1:18
    s_add_u32 s58, s58, 4096
    buffer_load_dwordx4 v[144:147], v229, s[8:11], s58 offen offset:0 sc1
    v_mul_u32_u24 v51, 1536, v55
    v_add_u32 v50, v50, v51
    ds_write_b16 v226, v209 offset:4352
    ds_write2st64_b32 v228, v211, v212 offset0:19 offset1:20
    buffer_load_dwordx4 v[148:151], v229, s[8:11], s58 offen offset:1024 sc1
    v_add_u32 v222, v50, v52
    v_mul_u32_u24 v51, 8224, v54
    ds_write2st64_b32 v228, v213, v214 offset0:21 offset1:22
    ds_write2st64_b32 v228, v216, v217 offset0:24 offset1:25
    buffer_load_dwordx4 v[152:155], v229, s[8:11], s58 offen offset:2048 sc1
    v_add_u32 v232, v51, v52
    v_lshl_add_u32 v247, v55, 7, v232
    ds_write_b16 v226, v215 offset:5888
    ds_write2st64_b32 v228, v218, v219 offset0:26 offset1:27
    buffer_load_dwordx4 v[156:159], v229, s[8:11], s58 offen offset:3072 sc1
    v_mul_u32_u24 v51, 2080, v48
    s_mov_b32 s60, 65536
    ds_write_b32 v228, v220 offset:7168
    ds_write_b16 v226, v221 offset:7424
    s_add_u32 s58, s58, 4096
    buffer_load_dwordx4 v[160:163], v229, s[8:11], s58 offen offset:0 sc1
    v_add3_u32 v223, v51, v52, s60
    v_mul_u32_u24 v51, 2080, v54
    buffer_load_dwordx4 v[164:167], v229, s[8:11], s58 offen offset:1024 sc1
    s_mov_b32 s60, 132096
    v_add3_u32 v225, v51, v52, s60
    buffer_load_dwordx4 v[168:171], v229, s[8:11], s58 offen offset:2048 sc1
    v_lshl_add_u32 v248, v55, 7, v225
    s_lshl_b32 s60, s20, 5
    buffer_load_dwordx4 v[172:175], v229, s[8:11], s58 offen offset:3072 sc1
    v_lshl_add_u32 v49, v49, 3, s60
    s_mov_b32 s60, 65536
    v_add3_u32 v255, v51, v49, s60
    v_lshl_add_u32 v246, v55, 9, v255
    v_bfe_u32 v53, v48, 2, 1
    v_lshl_add_u32 v49, v53, 4, v49
    v_add_u32 v254, v50, v49
    s_and_b32 s64, s55, s28
    s_waitcnt lgkmcnt(0)
    s_barrier
    s_cmp_eq_u32 s64, 0
    s_cbranch_scc1 K2_MULTI
    s_setprio 3
    ds_read_b128 v[48:51], v222 offset:0
    ds_read_b128 v[52:55], v222 offset:64
    ds_read_b128 v[56:59], v222 offset:896
    ds_read_b128 v[60:63], v222 offset:960
    ds_read_b128 v[64:67], v223 offset:0
    ds_read_b128 v[68:71], v223 offset:64
    ds_read_b128 v[72:75], v223 offset:896
    ds_read_b128 v[76:79], v223 offset:960
    ds_read_b128 v[80:83], v222 offset:3072
    ds_read_b128 v[84:87], v222 offset:3136
    ds_read_b128 v[88:91], v222 offset:3968
    s_waitcnt vmcnt(19) lgkmcnt(9)
    v_mfma_f32_16x16x32_bf16 v[0:3], v[96:99], v[48:51], 0
    ds_read_b128 v[92:95], v222 offset:4032
    s_waitcnt vmcnt(18)
    v_mfma_f32_16x16x32_bf16 v[0:3], v[100:103], v[52:55], v[0:3]
    ds_read_b128 v[48:51], v223 offset:33280
    s_waitcnt vmcnt(17) lgkmcnt(9)
    v_mfma_f32_16x16x32_bf16 v[0:3], v[104:107], v[56:59], v[0:3]
    s_bfe_u32 s60, s20, 0x10002
    s_lshl_b32 s60, s60, 4
    ds_read_b128 v[52:55], v223 offset:33344
    s_waitcnt vmcnt(16)
    v_mfma_f32_16x16x32_bf16 v[0:3], v[108:111], v[60:63], v[0:3]
    s_add_u32 s59, s59, s60
    v_add_u32 v228, s59, v229
    ds_read_b128 v[56:59], v223 offset:34176
    s_waitcnt vmcnt(15) lgkmcnt(9)
    v_mfma_f32_16x16x32_bf16 v[0:3], v[128:131], v[64:67], v[0:3]
    s_mul_i32 s60, s20, 2080
    s_add_u32 s60, s60, 65536
    ds_read_b128 v[60:63], v223 offset:34240
    s_waitcnt vmcnt(14)
    v_mfma_f32_16x16x32_bf16 v[0:3], v[132:135], v[68:71], v[0:3]
    v_add_u32 v249, s60, v229
    s_mov_b32 s63, 0xbfb8aa3b
    ds_read_b128 v[64:67], v232 offset:6144
    s_waitcnt vmcnt(13) lgkmcnt(9)
    v_mfma_f32_16x16x32_bf16 v[0:3], v[136:139], v[72:75], v[0:3]
    s_add_u32 s40, s20, s21
    s_lshl_b32 s40, s40, 10
    ds_read_b128 v[68:71], v232 offset:6208
    s_waitcnt vmcnt(12)
    v_mfma_f32_16x16x32_bf16 v[0:3], v[140:143], v[76:79], v[0:3]
    s_add_u32 s41, s40, 8192
    s_add_u32 s42, s40, 16384
    ds_read_b128 v[72:75], v232 offset:7040
    s_waitcnt lgkmcnt(9)
    v_mfma_f32_16x16x32_bf16 v[16:19], v[96:99], v[80:83], 0
    s_add_u32 s43, s40, 24576
    s_add_u32 s44, s40, 32768
    ds_read_b128 v[76:79], v232 offset:7104
    v_mfma_f32_16x16x32_bf16 v[16:19], v[100:103], v[84:87], v[16:19]
    ds_read_b128 v[80:83], v225 offset:0
    s_waitcnt lgkmcnt(9)
    v_mfma_f32_16x16x32_bf16 v[16:19], v[104:107], v[88:91], v[16:19]
    ds_read_b128 v[84:87], v225 offset:64
    v_mfma_f32_16x16x32_bf16 v[16:19], v[108:111], v[92:95], v[16:19]
    v_mul_f32 v204, s63, v0
    v_mul_f32 v205, s63, v1
    ds_read_b128 v[88:91], v225 offset:896
    s_waitcnt lgkmcnt(9)
    v_mfma_f32_16x16x32_bf16 v[16:19], v[128:131], v[48:51], v[16:19]
    v_mul_f32 v206, s63, v2
    ds_read_b128 v[92:95], v225 offset:960
    v_mfma_f32_16x16x32_bf16 v[16:19], v[132:135], v[52:55], v[16:19]
    v_mul_f32 v207, s63, v3
    ds_read_b128 v[48:51], v222 offset:128
    s_waitcnt lgkmcnt(9)
    v_mfma_f32_16x16x32_bf16 v[16:19], v[136:139], v[56:59], v[16:19]
    v_exp_f32 v204, v204
    ds_read_b128 v[52:55], v222 offset:384
    v_mfma_f32_16x16x32_bf16 v[16:19], v[140:143], v[60:63], v[16:19]
    v_exp_f32 v205, v205
    ds_read_b128 v[56:59], v222 offset:256
    s_waitcnt lgkmcnt(9)
    v_mfma_f32_16x16x32_bf16 v[32:35], v[96:99], v[64:67], 0
    v_exp_f32 v206, v206
    ds_read_b128 v[60:63], v222 offset:192
    v_mfma_f32_16x16x32_bf16 v[32:35], v[100:103], v[68:71], v[32:35]
    v_exp_f32 v207, v207
    s_setprio 2
    ds_read_b128 v[64:67], v222 offset:448
    s_waitcnt lgkmcnt(9)
    v_mfma_f32_16x16x32_bf16 v[32:35], v[104:107], v[72:75], v[32:35]
    v_add_f32 v204, 1.0, v204
    ds_read_b128 v[68:71], v222 offset:320
    v_mfma_f32_16x16x32_bf16 v[32:35], v[108:111], v[76:79], v[32:35]
    v_add_f32 v205, 1.0, v205
    v_add_f32 v206, 1.0, v206
    ds_read_b128 v[72:75], v222 offset:640
    s_waitcnt lgkmcnt(9)
    v_mfma_f32_16x16x32_bf16 v[32:35], v[128:131], v[80:83], v[32:35]
    v_add_f32 v207, 1.0, v207
    ds_read_b128 v[76:79], v222 offset:512
    v_mfma_f32_16x16x32_bf16 v[32:35], v[132:135], v[84:87], v[32:35]
    v_rcp_f32 v204, v204
    ds_read_b128 v[80:83], v222 offset:768
    s_waitcnt lgkmcnt(9)
    v_mfma_f32_16x16x32_bf16 v[32:35], v[136:139], v[88:91], v[32:35]
    v_rcp_f32 v205, v205
    ds_read_b128 v[84:87], v222 offset:704
    v_mfma_f32_16x16x32_bf16 v[32:35], v[140:143], v[92:95], v[32:35]
    v_rcp_f32 v206, v206
    ds_read_b128 v[88:91], v222 offset:576
    s_waitcnt vmcnt(11) lgkmcnt(9)
    v_mfma_f32_16x16x32_bf16 v[4:7], v[112:115], v[48:51], 0
    v_rcp_f32 v207, v207
    ds_read_b128 v[92:95], v222 offset:832
    v_mfma_f32_16x16x32_bf16 v[8:11], v[112:115], v[52:55], 0
    v_cvt_pk_bf16_f32 v176, v0, v1
    ds_read_b128 v[48:51], v222 offset:1024
    s_waitcnt lgkmcnt(9)
    v_mfma_f32_16x16x32_bf16 v[12:15], v[112:115], v[56:59], 0
    v_cvt_pk_bf16_f32 v177, v2, v3
    ds_read_b128 v[52:55], v222 offset:1280
    s_waitcnt vmcnt(10)
    v_mfma_f32_16x16x32_bf16 v[4:7], v[116:119], v[60:63], v[4:7]
    v_mul_f32 v208, s63, v16
    v_mul_f32 v209, s63, v17
    ds_read_b128 v[56:59], v222 offset:1152
    s_waitcnt lgkmcnt(9)
    v_mfma_f32_16x16x32_bf16 v[8:11], v[116:119], v[64:67], v[8:11]
    v_mul_f32 v210, s63, v18
    ds_read_b128 v[60:63], v222 offset:1088
    v_mfma_f32_16x16x32_bf16 v[12:15], v[116:119], v[68:71], v[12:15]
    v_mul_f32 v211, s63, v19
    ds_read_b128 v[64:67], v222 offset:1344
    s_waitcnt vmcnt(9) lgkmcnt(9)
    v_mfma_f32_16x16x32_bf16 v[4:7], v[120:123], v[72:75], v[4:7]
    v_exp_f32 v208, v208
    ds_read_b128 v[68:71], v222 offset:1216
    v_mfma_f32_16x16x32_bf16 v[8:11], v[120:123], v[76:79], v[8:11]
    v_exp_f32 v209, v209
    ds_read_b128 v[72:75], v223 offset:128
    s_waitcnt lgkmcnt(9)
    v_mfma_f32_16x16x32_bf16 v[12:15], v[120:123], v[80:83], v[12:15]
    v_exp_f32 v210, v210
    ds_read_b128 v[76:79], v223 offset:384
    s_waitcnt vmcnt(8)
    v_mfma_f32_16x16x32_bf16 v[4:7], v[124:127], v[84:87], v[4:7]
    v_exp_f32 v211, v211
    ds_read_b128 v[80:83], v223 offset:256
    s_waitcnt lgkmcnt(9)
    v_mfma_f32_16x16x32_bf16 v[8:11], v[124:127], v[88:91], v[8:11]
    v_add_f32 v208, 1.0, v208
    ds_read_b128 v[84:87], v223 offset:192
    v_mfma_f32_16x16x32_bf16 v[12:15], v[124:127], v[92:95], v[12:15]
    v_add_f32 v209, 1.0, v209
    v_add_f32 v210, 1.0, v210
    ds_read_b128 v[88:91], v223 offset:448
    s_waitcnt vmcnt(7) lgkmcnt(9)
    v_mfma_f32_16x16x32_bf16 v[4:7], v[144:147], v[48:51], v[4:7]
    v_add_f32 v211, 1.0, v211
    s_setprio 1
    ds_read_b128 v[92:95], v223 offset:320
    v_mfma_f32_16x16x32_bf16 v[8:11], v[144:147], v[52:55], v[8:11]
    v_rcp_f32 v208, v208
    ds_read_b128 v[48:51], v223 offset:640
    s_waitcnt lgkmcnt(9)
    v_mfma_f32_16x16x32_bf16 v[12:15], v[144:147], v[56:59], v[12:15]
    v_rcp_f32 v209, v209
    ds_read_b128 v[52:55], v223 offset:512
    s_waitcnt vmcnt(6)
    v_mfma_f32_16x16x32_bf16 v[4:7], v[148:151], v[60:63], v[4:7]
    v_rcp_f32 v210, v210
    ds_read_b128 v[56:59], v223 offset:768
    s_waitcnt lgkmcnt(9)
    v_mfma_f32_16x16x32_bf16 v[8:11], v[148:151], v[64:67], v[8:11]
    v_rcp_f32 v211, v211
    ds_read_b128 v[60:63], v223 offset:704
    v_mfma_f32_16x16x32_bf16 v[12:15], v[148:151], v[68:71], v[12:15]
K2_PAD_T2:
    s_cbranch_execz K2_HOP
    v_cvt_pk_bf16_f32 v184, v16, v17
    ds_read_b128 v[64:67], v223 offset:576
    s_waitcnt vmcnt(5) lgkmcnt(9)
    v_mfma_f32_16x16x32_bf16 v[4:7], v[152:155], v[72:75], v[4:7]
    v_cvt_pk_bf16_f32 v185, v18, v19
    ds_read_b128 v[68:71], v223 offset:832
    v_mfma_f32_16x16x32_bf16 v[8:11], v[152:155], v[76:79], v[8:11]
    v_mul_f32 v212, s63, v32
    v_mul_f32 v213, s63, v33
    ds_read_b128 v[72:75], v223 offset:1024
    s_waitcnt lgkmcnt(9)
    v_mfma_f32_16x16x32_bf16 v[12:15], v[152:155], v[80:83], v[12:15]
    v_mul_f32 v214, s63, v34
    ds_read_b128 v[76:79], v223 offset:1280
    s_waitcnt vmcnt(4)
    v_mfma_f32_16x16x32_bf16 v[4:7], v[156:159], v[84:87], v[4:7]
    v_mul_f32 v215, s63, v35
    ds_read_b128 v[80:83], v223 offset:1152
    s_waitcnt lgkmcnt(9)
    v_mfma_f32_16x16x32_bf16 v[8:11], v[156:159], v[88:91], v[8:11]
    v_exp_f32 v212, v212
    ds_read_b128 v[84:87], v223 offset:1088
    v_mfma_f32_16x16x32_bf16 v[12:15], v[156:159], v[92:95], v[12:15]
    v_exp_f32 v213, v213
    ds_read_b128 v[88:91], v223 offset:1344
    s_waitcnt vmcnt(3) lgkmcnt(9)
    v_mfma_f32_16x16x32_bf16 v[4:7], v[160:163], v[48:51], v[4:7]
    v_exp_f32 v214, v214
    ds_read_b128 v[92:95], v223 offset:1216
    v_mfma_f32_16x16x32_bf16 v[8:11], v[160:163], v[52:55], v[8:11]
    v_exp_f32 v215, v215
    ds_read_b128 v[48:51], v222 offset:3200
    s_waitcnt lgkmcnt(9)
    v_mfma_f32_16x16x32_bf16 v[12:15], v[160:163], v[56:59], v[12:15]
    v_add_f32 v212, 1.0, v212
    ds_read_b128 v[52:55], v222 offset:3456
    s_waitcnt vmcnt(2)
    v_mfma_f32_16x16x32_bf16 v[4:7], v[164:167], v[60:63], v[4:7]
    v_add_f32 v213, 1.0, v213
    v_add_f32 v214, 1.0, v214
    ds_read_b128 v[56:59], v222 offset:3328
    s_waitcnt lgkmcnt(9)
    v_mfma_f32_16x16x32_bf16 v[8:11], v[164:167], v[64:67], v[8:11]
    v_add_f32 v215, 1.0, v215
    ds_read_b128 v[60:63], v222 offset:3264
    v_mfma_f32_16x16x32_bf16 v[12:15], v[164:167], v[68:71], v[12:15]
    v_rcp_f32 v212, v212
    s_setprio 0
    ds_read_b128 v[64:67], v222 offset:3520
    s_waitcnt vmcnt(1) lgkmcnt(9)
    v_mfma_f32_16x16x32_bf16 v[4:7], v[168:171], v[72:75], v[4:7]
    v_rcp_f32 v213, v213
    ds_read_b128 v[68:71], v222 offset:3392
    v_mfma_f32_16x16x32_bf16 v[8:11], v[168:171], v[76:79], v[8:11]
    v_rcp_f32 v214, v214
    ds_read_b128 v[72:75], v222 offset:3712
    s_waitcnt lgkmcnt(9)
    v_mfma_f32_16x16x32_bf16 v[12:15], v[168:171], v[80:83], v[12:15]
    v_rcp_f32 v215, v215
    ds_read_b128 v[76:79], v222 offset:3584
    s_waitcnt vmcnt(0)
    v_mfma_f32_16x16x32_bf16 v[4:7], v[172:175], v[84:87], v[4:7]
    v_cvt_pk_bf16_f32 v220, v32, v33
    ds_read_b128 v[80:83], v222 offset:3840
    s_waitcnt lgkmcnt(9)
    v_mfma_f32_16x16x32_bf16 v[8:11], v[172:175], v[88:91], v[8:11]
    v_cvt_pk_bf16_f32 v221, v34, v35
    ds_read_b128 v[84:87], v222 offset:3776
    v_mfma_f32_16x16x32_bf16 v[12:15], v[172:175], v[92:95], v[12:15]
    ds_read_b128 v[88:91], v222 offset:3648
    s_waitcnt lgkmcnt(9)
    v_mfma_f32_16x16x32_bf16 v[20:23], v[112:115], v[48:51], 0
    ds_read_b128 v[92:95], v222 offset:3904
    v_mfma_f32_16x16x32_bf16 v[24:27], v[112:115], v[52:55], 0
    ds_read_b128 v[48:51], v222 offset:4096
    s_waitcnt lgkmcnt(9)
    v_mfma_f32_16x16x32_bf16 v[28:31], v[112:115], v[56:59], 0
    s_barrier
    s_setprio 3
    ds_read_b128 v[52:55], v222 offset:4352
    v_mfma_f32_16x16x32_bf16 v[20:23], v[116:119], v[60:63], v[20:23]
    v_mul_f32 v4, v4, v204
    ds_read_b128 v[56:59], v222 offset:4224
    s_waitcnt lgkmcnt(9)
    v_mfma_f32_16x16x32_bf16 v[24:27], v[116:119], v[64:67], v[24:27]
    v_mul_f32 v5, v5, v205
    ds_read_b128 v[60:63], v222 offset:4160
    v_mfma_f32_16x16x32_bf16 v[28:31], v[116:119], v[68:71], v[28:31]
    v_mul_f32 v6, v6, v206
    ds_read_b128 v[64:67], v222 offset:4416
    s_waitcnt lgkmcnt(9)
    v_mfma_f32_16x16x32_bf16 v[20:23], v[120:123], v[72:75], v[20:23]
    v_mul_f32 v7, v7, v207
    ds_read_b128 v[68:71], v222 offset:4288
    v_mfma_f32_16x16x32_bf16 v[24:27], v[120:123], v[76:79], v[24:27]
    v_cvt_pk_bf16_f32 v178, v4, v5
    ds_read_b128 v[72:75], v223 offset:33408
    s_waitcnt lgkmcnt(9)
    v_mfma_f32_16x16x32_bf16 v[28:31], v[120:123], v[80:83], v[28:31]
    v_cvt_pk_bf16_f32 v179, v6, v7
    ds_read_b128 v[76:79], v223 offset:33664
    v_mfma_f32_16x16x32_bf16 v[20:23], v[124:127], v[84:87], v[20:23]
    v_mul_f32 v8, v8, v204
    ds_read_b128 v[80:83], v223 offset:33536
    s_waitcnt lgkmcnt(9)
    v_mfma_f32_16x16x32_bf16 v[24:27], v[124:127], v[88:91], v[24:27]
    v_mul_f32 v9, v9, v205
    ds_read_b128 v[84:87], v223 offset:33472
    v_mfma_f32_16x16x32_bf16 v[28:31], v[124:127], v[92:95], v[28:31]
    v_mul_f32 v10, v10, v206
    ds_read_b128 v[88:91], v223 offset:33728
    s_waitcnt lgkmcnt(9)
    v_mfma_f32_16x16x32_bf16 v[20:23], v[144:147], v[48:51], v[20:23]
    v_mul_f32 v11, v11, v207
    s_setprio 2
    ds_read_b128 v[92:95], v223 offset:33600
    v_mfma_f32_16x16x32_bf16 v[24:27], v[144:147], v[52:55], v[24:27]
    v_cvt_pk_bf16_f32 v180, v8, v9
    ds_read_b128 v[48:51], v223 offset:33920
    s_waitcnt lgkmcnt(9)
    v_mfma_f32_16x16x32_bf16 v[28:31], v[144:147], v[56:59], v[28:31]
    v_cvt_pk_bf16_f32 v181, v10, v11
    ds_read_b128 v[52:55], v223 offset:33792
    v_mfma_f32_16x16x32_bf16 v[20:23], v[148:151], v[60:63], v[20:23]
    v_mul_f32 v12, v12, v204
    ds_read_b128 v[56:59], v223 offset:34048
    s_waitcnt lgkmcnt(9)
    v_mfma_f32_16x16x32_bf16 v[24:27], v[148:151], v[64:67], v[24:27]
    v_mul_f32 v13, v13, v205
    ds_read_b128 v[60:63], v223 offset:33984
    v_mfma_f32_16x16x32_bf16 v[28:31], v[148:151], v[68:71], v[28:31]
    v_mul_f32 v14, v14, v206
    ds_read_b128 v[64:67], v223 offset:33856
    s_waitcnt lgkmcnt(9)
    v_mfma_f32_16x16x32_bf16 v[20:23], v[152:155], v[72:75], v[20:23]
    v_mul_f32 v15, v15, v207
    ds_read_b128 v[68:71], v223 offset:34112
    v_mfma_f32_16x16x32_bf16 v[24:27], v[152:155], v[76:79], v[24:27]
    v_cvt_pk_bf16_f32 v182, v12, v13
    ds_read_b128 v[72:75], v223 offset:34304
    s_waitcnt lgkmcnt(9)
    v_mfma_f32_16x16x32_bf16 v[28:31], v[152:155], v[80:83], v[28:31]
    v_cvt_pk_bf16_f32 v183, v14, v15
    ds_read_b128 v[76:79], v223 offset:34560
    v_mfma_f32_16x16x32_bf16 v[20:23], v[156:159], v[84:87], v[20:23]
    ds_write_b64 v254, v[176:177] offset:0
    ds_write_b64 v254, v[178:179] offset:256
    ds_write_b64 v254, v[180:181] offset:512
    ds_write_b64 v254, v[182:183] offset:768
    ds_write_b64 v255, v[220:221] offset:0
    ds_read_b128 v[80:83], v223 offset:34432
    s_waitcnt lgkmcnt(14)
    v_mfma_f32_16x16x32_bf16 v[24:27], v[156:159], v[88:91], v[24:27]
    ds_read_b128 v[84:87], v223 offset:34368
    v_mfma_f32_16x16x32_bf16 v[28:31], v[156:159], v[92:95], v[28:31]
    s_setprio 1
    ds_read_b128 v[88:91], v223 offset:34624
    s_waitcnt lgkmcnt(14)
    v_mfma_f32_16x16x32_bf16 v[20:23], v[160:163], v[48:51], v[20:23]
    ds_read_b128 v[92:95], v223 offset:34496
    v_mfma_f32_16x16x32_bf16 v[24:27], v[160:163], v[52:55], v[24:27]
    ds_read_b128 v[48:51], v247 offset:6272
    s_waitcnt lgkmcnt(14)
    v_mfma_f32_16x16x32_bf16 v[28:31], v[160:163], v[56:59], v[28:31]
    ds_read_b128 v[52:55], v232 offset:6528
    v_mfma_f32_16x16x32_bf16 v[20:23], v[164:167], v[60:63], v[20:23]
    ds_read_b128 v[56:59], v247 offset:6336
    s_waitcnt lgkmcnt(14)
    v_mfma_f32_16x16x32_bf16 v[24:27], v[164:167], v[64:67], v[24:27]
    ds_read_b128 v[60:63], v232 offset:6592
    v_mfma_f32_16x16x32_bf16 v[28:31], v[164:167], v[68:71], v[28:31]
    ds_read_b128 v[64:67], v247 offset:6784
    s_waitcnt lgkmcnt(14)
    v_mfma_f32_16x16x32_bf16 v[20:23], v[168:171], v[72:75], v[20:23]
    ds_read_b128 v[68:71], v232 offset:6656
    v_mfma_f32_16x16x32_bf16 v[24:27], v[168:171], v[76:79], v[24:27]
    ds_read_b128 v[72:75], v247 offset:6848
    s_waitcnt lgkmcnt(9)
    v_mfma_f32_16x16x32_bf16 v[28:31], v[168:171], v[80:83], v[28:31]
    ds_read_b128 v[76:79], v232 offset:6720
    v_mfma_f32_16x16x32_bf16 v[20:23], v[172:175], v[84:87], v[20:23]
    s_setprio 0
    ds_read_b128 v[80:83], v247 offset:7168
    s_waitcnt lgkmcnt(9)
    v_mfma_f32_16x16x32_bf16 v[24:27], v[172:175], v[88:91], v[24:27]
    ds_read_b128 v[84:87], v232 offset:7424
    v_mfma_f32_16x16x32_bf16 v[28:31], v[172:175], v[92:95], v[28:31]
    ds_read_b128 v[88:91], v247 offset:7232
    s_waitcnt lgkmcnt(9)
    v_mfma_f32_16x16x32_bf16 v[36:39], v[112:115], v[48:51], 0
    ds_read_b128 v[92:95], v232 offset:7488
    v_mfma_f32_16x16x32_bf16 v[40:43], v[112:115], v[52:55], 0
    ds_read_b128 v[48:51], v248 offset:128
    s_waitcnt lgkmcnt(9)
    v_mfma_f32_16x16x32_bf16 v[36:39], v[116:119], v[56:59], v[36:39]
    s_barrier
    ds_read_b128 v[192:195], v228 offset:0
    ds_read_b128 v[196:199], v228 offset:1536
    s_setprio 3
    ds_read_b128 v[52:55], v225 offset:384
    v_mfma_f32_16x16x32_bf16 v[40:43], v[116:119], v[60:63], v[40:43]
    v_mul_f32 v20, v20, v208
    v_mul_f32 v21, v21, v209
    ds_read_b128 v[56:59], v248 offset:192
    s_waitcnt lgkmcnt(11)
    v_mfma_f32_16x16x32_bf16 v[36:39], v[120:123], v[64:67], v[36:39]
    v_mul_f32 v22, v22, v210
    ds_read_b128 v[60:63], v225 offset:448
    v_mfma_f32_16x16x32_bf16 v[40:43], v[120:123], v[68:71], v[40:43]
    v_mul_f32 v23, v23, v211
    ds_read_b128 v[64:67], v248 offset:640
    s_waitcnt lgkmcnt(11)
    v_mfma_f32_16x16x32_bf16 v[36:39], v[124:127], v[72:75], v[36:39]
    v_cvt_pk_bf16_f32 v186, v20, v21
    ds_read_b128 v[68:71], v225 offset:512
    v_mfma_f32_16x16x32_bf16 v[40:43], v[124:127], v[76:79], v[40:43]
    v_cvt_pk_bf16_f32 v187, v22, v23
    ds_read_b128 v[72:75], v248 offset:704
    s_waitcnt lgkmcnt(11)
    v_mfma_f32_16x16x32_bf16 v[36:39], v[144:147], v[80:83], v[36:39]
    v_mul_f32 v24, v24, v208
    v_mul_f32 v25, v25, v209
    s_waitcnt lgkmcnt(6)
    buffer_store_dwordx4 v[192:195], v229, s[12:15], s40 offen sc1
    buffer_store_dwordx4 v[196:199], v229, s[12:15], s41 offen sc1
    s_setprio 2
    ds_read_b128 v[76:79], v225 offset:576
    v_mfma_f32_16x16x32_bf16 v[40:43], v[144:147], v[84:87], v[40:43]
    v_mul_f32 v26, v26, v210
    ds_read_b128 v[80:83], v248 offset:1024
    v_mfma_f32_16x16x32_bf16 v[36:39], v[148:151], v[88:91], v[36:39]
    v_mul_f32 v27, v27, v211
    ds_read_b128 v[84:87], v225 offset:1280
    v_mfma_f32_16x16x32_bf16 v[40:43], v[148:151], v[92:95], v[40:43]
    v_cvt_pk_bf16_f32 v188, v24, v25
    ds_read_b128 v[88:91], v248 offset:1088
    s_waitcnt lgkmcnt(9)
    v_mfma_f32_16x16x32_bf16 v[36:39], v[152:155], v[48:51], v[36:39]
    v_cvt_pk_bf16_f32 v189, v26, v27
    ds_read_b128 v[92:95], v225 offset:1344
    v_mfma_f32_16x16x32_bf16 v[40:43], v[152:155], v[52:55], v[40:43]
    v_mul_f32 v28, v28, v208
    v_mul_f32 v29, v29, v209
    s_waitcnt lgkmcnt(8)
    v_mfma_f32_16x16x32_bf16 v[36:39], v[156:159], v[56:59], v[36:39]
    v_mul_f32 v30, v30, v210
    v_mfma_f32_16x16x32_bf16 v[40:43], v[156:159], v[60:63], v[40:43]
    v_mul_f32 v31, v31, v211
    s_setprio 1
    s_waitcnt lgkmcnt(6)
    v_mfma_f32_16x16x32_bf16 v[36:39], v[160:163], v[64:67], v[36:39]
    v_cvt_pk_bf16_f32 v190, v28, v29
    v_mfma_f32_16x16x32_bf16 v[40:43], v[160:163], v[68:71], v[40:43]
    v_cvt_pk_bf16_f32 v191, v30, v31
    s_waitcnt lgkmcnt(4)
    v_mfma_f32_16x16x32_bf16 v[36:39], v[164:167], v[72:75], v[36:39]
    ds_write_b64 v254, v[184:185] offset:3072
    ds_write_b64 v254, v[186:187] offset:3328
    ds_write_b64 v254, v[188:189] offset:3584
    ds_write_b64 v254, v[190:191] offset:3840
    v_mfma_f32_16x16x32_bf16 v[40:43], v[164:167], v[76:79], v[40:43]
    s_waitcnt lgkmcnt(6)
    v_mfma_f32_16x16x32_bf16 v[36:39], v[168:171], v[80:83], v[36:39]
    v_mfma_f32_16x16x32_bf16 v[40:43], v[168:171], v[84:87], v[40:43]
    s_setprio 0
    s_waitcnt lgkmcnt(4)
    v_mfma_f32_16x16x32_bf16 v[36:39], v[172:175], v[88:91], v[36:39]
    v_mfma_f32_16x16x32_bf16 v[40:43], v[172:175], v[92:95], v[40:43]
    s_nop 6
    v_mul_f32 v36, v36, v212
    v_mul_f32 v37, v37, v213
    v_mul_f32 v38, v38, v214
    v_mul_f32 v39, v39, v215
    v_cvt_pk_bf16_f32 v178, v36, v37
    v_cvt_pk_bf16_f32 v179, v38, v39
    v_mul_f32 v40, v40, v212
    v_mul_f32 v41, v41, v213
    v_mul_f32 v42, v42, v214
    v_mul_f32 v43, v43, v215
    v_cvt_pk_bf16_f32 v180, v40, v41
    v_cvt_pk_bf16_f32 v181, v42, v43
    ds_write_b64 v246, v[178:179] offset:256
    ds_write_b64 v255, v[180:181] offset:512
    s_waitcnt lgkmcnt(0)
    s_barrier
    ds_read_b128 v[192:195], v228 offset:3072
    ds_read_b128 v[196:199], v228 offset:4608
    ds_read_b128 v[200:203], v249
    s_waitcnt lgkmcnt(1)
    buffer_store_dwordx4 v[192:195], v229, s[12:15], s42 offen sc1
    buffer_store_dwordx4 v[196:199], v229, s[12:15], s43 offen sc1
K2_LASTROW:
    s_add_u32 s59, s20, 32
    s_cmp_ge_u32 s59, s22
    s_cbranch_scc1 K2_FIN
    s_waitcnt lgkmcnt(0)
    buffer_store_dwordx4 v[200:203], v229, s[12:15], s44 offen sc1
K2_FIN:
    s_endpgm
K2_MULTI:
    ds_read_b128 v[48:51], v222 offset:0
    ds_read_b128 v[52:55], v222 offset:64
    ds_read_b128 v[56:59], v222 offset:896
    ds_read_b128 v[60:63], v222 offset:960
    ds_read_b128 v[64:67], v223 offset:0
    ds_read_b128 v[68:71], v223 offset:64
    ds_read_b128 v[72:75], v223 offset:896
    ds_read_b128 v[76:79], v223 offset:960
    ds_read_b128 v[80:83], v222 offset:3072
    ds_read_b128 v[84:87], v222 offset:3136
    ds_read_b128 v[88:91], v222 offset:3968
    s_waitcnt vmcnt(19) lgkmcnt(9)
    v_mfma_f32_16x16x32_bf16 v[0:3], v[96:99], v[48:51], 0
    ds_read_b128 v[92:95], v222 offset:4032
    s_waitcnt vmcnt(18)
    v_mfma_f32_16x16x32_bf16 v[0:3], v[100:103], v[52:55], v[0:3]
    ds_read_b128 v[48:51], v223 offset:33280
    s_waitcnt vmcnt(17) lgkmcnt(9)
    v_mfma_f32_16x16x32_bf16 v[0:3], v[104:107], v[56:59], v[0:3]
    ds_read_b128 v[52:55], v223 offset:33344
    s_waitcnt vmcnt(16)
    v_mfma_f32_16x16x32_bf16 v[0:3], v[108:111], v[60:63], v[0:3]
    ds_read_b128 v[56:59], v223 offset:34176
    s_waitcnt vmcnt(15) lgkmcnt(9)
    v_mfma_f32_16x16x32_bf16 v[0:3], v[128:131], v[64:67], v[0:3]
    ds_read_b128 v[60:63], v223 offset:34240
    s_waitcnt vmcnt(14)
    v_mfma_f32_16x16x32_bf16 v[0:3], v[132:135], v[68:71], v[0:3]
    ds_read_b128 v[64:67], v232 offset:6144
    s_waitcnt vmcnt(13) lgkmcnt(9)
    v_mfma_f32_16x16x32_bf16 v[0:3], v[136:139], v[72:75], v[0:3]
    ds_read_b128 v[68:71], v232 offset:6208
    s_waitcnt vmcnt(12)
    v_mfma_f32_16x16x32_bf16 v[0:3], v[140:143], v[76:79], v[0:3]
    ds_read_b128 v[72:75], v232 offset:7040
    s_waitcnt lgkmcnt(9)
    v_mfma_f32_16x16x32_bf16 v[16:19], v[96:99], v[80:83], 0
    ds_read_b128 v[76:79], v232 offset:7104
    v_mfma_f32_16x16x32_bf16 v[16:19], v[100:103], v[84:87], v[16:19]
    ds_read_b128 v[80:83], v225 offset:0
    s_waitcnt lgkmcnt(9)
    v_mfma_f32_16x16x32_bf16 v[16:19], v[104:107], v[88:91], v[16:19]
    ds_read_b128 v[84:87], v225 offset:64
    v_mfma_f32_16x16x32_bf16 v[16:19], v[108:111], v[92:95], v[16:19]
    ds_read_b128 v[88:91], v225 offset:896
    s_waitcnt lgkmcnt(9)
    v_mfma_f32_16x16x32_bf16 v[16:19], v[128:131], v[48:51], v[16:19]
    ds_read_b128 v[92:95], v225 offset:960
    v_mfma_f32_16x16x32_bf16 v[16:19], v[132:135], v[52:55], v[16:19]
    ds_read_b128 v[48:51], v222 offset:128
    s_waitcnt lgkmcnt(9)
    v_mfma_f32_16x16x32_bf16 v[16:19], v[136:139], v[56:59], v[16:19]
    ds_read_b128 v[52:55], v222 offset:384
    v_mfma_f32_16x16x32_bf16 v[16:19], v[140:143], v[60:63], v[16:19]
    ds_read_b128 v[56:59], v222 offset:256
    s_waitcnt lgkmcnt(9)
    v_mfma_f32_16x16x32_bf16 v[32:35], v[96:99], v[64:67], 0
    ds_read_b128 v[60:63], v222 offset:192
    v_mfma_f32_16x16x32_bf16 v[32:35], v[100:103], v[68:71], v[32:35]
    ds_read_b128 v[64:67], v222 offset:448
    s_waitcnt lgkmcnt(9)
    v_mfma_f32_16x16x32_bf16 v[32:35], v[104:107], v[72:75], v[32:35]
    ds_read_b128 v[68:71], v222 offset:320
    v_mfma_f32_16x16x32_bf16 v[32:35], v[108:111], v[76:79], v[32:35]
    ds_read_b128 v[72:75], v222 offset:640
    s_waitcnt lgkmcnt(9)
    v_mfma_f32_16x16x32_bf16 v[32:35], v[128:131], v[80:83], v[32:35]
    ds_read_b128 v[76:79], v222 offset:512
    v_mfma_f32_16x16x32_bf16 v[32:35], v[132:135], v[84:87], v[32:35]
    ds_read_b128 v[80:83], v222 offset:768
    s_waitcnt lgkmcnt(9)
    v_mfma_f32_16x16x32_bf16 v[32:35], v[136:139], v[88:91], v[32:35]
    ds_read_b128 v[84:87], v222 offset:704
    v_mfma_f32_16x16x32_bf16 v[32:35], v[140:143], v[92:95], v[32:35]
    ds_read_b128 v[88:91], v222 offset:576
    s_waitcnt vmcnt(11) lgkmcnt(9)
    v_mfma_f32_16x16x32_bf16 v[4:7], v[112:115], v[48:51], 0
    ds_read_b128 v[92:95], v222 offset:832
    v_mfma_f32_16x16x32_bf16 v[8:11], v[112:115], v[52:55], 0
    ds_read_b128 v[48:51], v222 offset:1024
    s_waitcnt lgkmcnt(9)
    v_mfma_f32_16x16x32_bf16 v[12:15], v[112:115], v[56:59], 0
    ds_read_b128 v[52:55], v222 offset:1280
    s_waitcnt vmcnt(10)
    v_mfma_f32_16x16x32_bf16 v[4:7], v[116:119], v[60:63], v[4:7]
    ds_read_b128 v[56:59], v222 offset:1152
    s_waitcnt lgkmcnt(9)
    v_mfma_f32_16x16x32_bf16 v[8:11], v[116:119], v[64:67], v[8:11]
    ds_read_b128 v[60:63], v222 offset:1088
    v_mfma_f32_16x16x32_bf16 v[12:15], v[116:119], v[68:71], v[12:15]
    ds_read_b128 v[64:67], v222 offset:1344
    s_waitcnt vmcnt(9) lgkmcnt(9)
    v_mfma_f32_16x16x32_bf16 v[4:7], v[120:123], v[72:75], v[4:7]
    ds_read_b128 v[68:71], v222 offset:1216
    v_mfma_f32_16x16x32_bf16 v[8:11], v[120:123], v[76:79], v[8:11]
    ds_read_b128 v[72:75], v223 offset:128
    s_waitcnt lgkmcnt(9)
    v_mfma_f32_16x16x32_bf16 v[12:15], v[120:123], v[80:83], v[12:15]
    ds_read_b128 v[76:79], v223 offset:384
    s_waitcnt vmcnt(8)
    v_mfma_f32_16x16x32_bf16 v[4:7], v[124:127], v[84:87], v[4:7]
    ds_read_b128 v[80:83], v223 offset:256
    s_waitcnt lgkmcnt(9)
    v_mfma_f32_16x16x32_bf16 v[8:11], v[124:127], v[88:91], v[8:11]
    ds_read_b128 v[84:87], v223 offset:192
    v_mfma_f32_16x16x32_bf16 v[12:15], v[124:127], v[92:95], v[12:15]
    ds_read_b128 v[88:91], v223 offset:448
    s_waitcnt vmcnt(7) lgkmcnt(9)
    v_mfma_f32_16x16x32_bf16 v[4:7], v[144:147], v[48:51], v[4:7]
    ds_read_b128 v[92:95], v223 offset:320
    v_mfma_f32_16x16x32_bf16 v[8:11], v[144:147], v[52:55], v[8:11]
    ds_read_b128 v[48:51], v223 offset:640
    s_waitcnt lgkmcnt(9)
    v_mfma_f32_16x16x32_bf16 v[12:15], v[144:147], v[56:59], v[12:15]
    ds_read_b128 v[52:55], v223 offset:512
    s_waitcnt vmcnt(6)
    v_mfma_f32_16x16x32_bf16 v[4:7], v[148:151], v[60:63], v[4:7]
    ds_read_b128 v[56:59], v223 offset:768
    s_waitcnt lgkmcnt(9)
    v_mfma_f32_16x16x32_bf16 v[8:11], v[148:151], v[64:67], v[8:11]
    ds_read_b128 v[60:63], v223 offset:704
    v_mfma_f32_16x16x32_bf16 v[12:15], v[148:151], v[68:71], v[12:15]
    ds_read_b128 v[64:67], v223 offset:576
    s_waitcnt vmcnt(5) lgkmcnt(9)
    v_mfma_f32_16x16x32_bf16 v[4:7], v[152:155], v[72:75], v[4:7]
    ds_read_b128 v[68:71], v223 offset:832
    v_mfma_f32_16x16x32_bf16 v[8:11], v[152:155], v[76:79], v[8:11]
    ds_read_b128 v[72:75], v223 offset:1024
    s_waitcnt lgkmcnt(9)
    v_mfma_f32_16x16x32_bf16 v[12:15], v[152:155], v[80:83], v[12:15]
    ds_read_b128 v[76:79], v223 offset:1280
    s_waitcnt vmcnt(4)
    v_mfma_f32_16x16x32_bf16 v[4:7], v[156:159], v[84:87], v[4:7]
    ds_read_b128 v[80:83], v223 offset:1152
    s_waitcnt lgkmcnt(9)
    v_mfma_f32_16x16x32_bf16 v[8:11], v[156:159], v[88:91], v[8:11]
    ds_read_b128 v[84:87], v223 offset:1088
    v_mfma_f32_16x16x32_bf16 v[12:15], v[156:159], v[92:95], v[12:15]
    ds_read_b128 v[88:91], v223 offset:1344
    s_waitcnt vmcnt(3) lgkmcnt(9)
    v_mfma_f32_16x16x32_bf16 v[4:7], v[160:163], v[48:51], v[4:7]
    ds_read_b128 v[92:95], v223 offset:1216
    v_mfma_f32_16x16x32_bf16 v[8:11], v[160:163], v[52:55], v[8:11]
    ds_read_b128 v[48:51], v222 offset:3200
    s_waitcnt lgkmcnt(9)
    v_mfma_f32_16x16x32_bf16 v[12:15], v[160:163], v[56:59], v[12:15]
    ds_read_b128 v[52:55], v222 offset:3456
    s_waitcnt vmcnt(2)
    v_mfma_f32_16x16x32_bf16 v[4:7], v[164:167], v[60:63], v[4:7]
    ds_read_b128 v[56:59], v222 offset:3328
    s_waitcnt lgkmcnt(9)
    v_mfma_f32_16x16x32_bf16 v[8:11], v[164:167], v[64:67], v[8:11]
    ds_read_b128 v[60:63], v222 offset:3264
    v_mfma_f32_16x16x32_bf16 v[12:15], v[164:167], v[68:71], v[12:15]
    ds_read_b128 v[64:67], v222 offset:3520
    s_waitcnt vmcnt(1) lgkmcnt(9)
    v_mfma_f32_16x16x32_bf16 v[4:7], v[168:171], v[72:75], v[4:7]
    ds_read_b128 v[68:71], v222 offset:3392
    v_mfma_f32_16x16x32_bf16 v[8:11], v[168:171], v[76:79], v[8:11]
    ds_read_b128 v[72:75], v222 offset:3712
    s_waitcnt lgkmcnt(9)
    v_mfma_f32_16x16x32_bf16 v[12:15], v[168:171], v[80:83], v[12:15]
    ds_read_b128 v[76:79], v222 offset:3584
    s_waitcnt vmcnt(0)
    v_mfma_f32_16x16x32_bf16 v[4:7], v[172:175], v[84:87], v[4:7]
    ds_read_b128 v[80:83], v222 offset:3840
    s_waitcnt lgkmcnt(9)
    v_mfma_f32_16x16x32_bf16 v[8:11], v[172:175], v[88:91], v[8:11]
    ds_read_b128 v[84:87], v222 offset:3776
    v_mfma_f32_16x16x32_bf16 v[12:15], v[172:175], v[92:95], v[12:15]
    ds_read_b128 v[88:91], v222 offset:3648
    s_waitcnt lgkmcnt(9)
    v_mfma_f32_16x16x32_bf16 v[20:23], v[112:115], v[48:51], 0
    ds_read_b128 v[92:95], v222 offset:3904
    v_mfma_f32_16x16x32_bf16 v[24:27], v[112:115], v[52:55], 0
    ds_read_b128 v[48:51], v222 offset:4096
    s_waitcnt lgkmcnt(9)
    v_mfma_f32_16x16x32_bf16 v[28:31], v[112:115], v[56:59], 0
    ds_read_b128 v[52:55], v222 offset:4352
    v_mfma_f32_16x16x32_bf16 v[20:23], v[116:119], v[60:63], v[20:23]
    ds_read_b128 v[56:59], v222 offset:4224
    s_waitcnt lgkmcnt(9)
    v_mfma_f32_16x16x32_bf16 v[24:27], v[116:119], v[64:67], v[24:27]
    ds_read_b128 v[60:63], v222 offset:4160
    v_mfma_f32_16x16x32_bf16 v[28:31], v[116:119], v[68:71], v[28:31]
    ds_read_b128 v[64:67], v222 offset:4416
    s_waitcnt lgkmcnt(9)
    v_mfma_f32_16x16x32_bf16 v[20:23], v[120:123], v[72:75], v[20:23]
    ds_read_b128 v[68:71], v222 offset:4288
    v_mfma_f32_16x16x32_bf16 v[24:27], v[120:123], v[76:79], v[24:27]
    ds_read_b128 v[72:75], v223 offset:33408
    s_waitcnt lgkmcnt(9)
    v_mfma_f32_16x16x32_bf16 v[28:31], v[120:123], v[80:83], v[28:31]
    ds_read_b128 v[76:79], v223 offset:33664
    v_mfma_f32_16x16x32_bf16 v[20:23], v[124:127], v[84:87], v[20:23]
    ds_read_b128 v[80:83], v223 offset:33536
    s_waitcnt lgkmcnt(9)
    v_mfma_f32_16x16x32_bf16 v[24:27], v[124:127], v[88:91], v[24:27]
    ds_read_b128 v[84:87], v223 offset:33472
    v_mfma_f32_16x16x32_bf16 v[28:31], v[124:127], v[92:95], v[28:31]
    ds_read_b128 v[88:91], v223 offset:33728
    s_waitcnt lgkmcnt(9)
    v_mfma_f32_16x16x32_bf16 v[20:23], v[144:147], v[48:51], v[20:23]
    ds_read_b128 v[92:95], v223 offset:33600
    v_mfma_f32_16x16x32_bf16 v[24:27], v[144:147], v[52:55], v[24:27]
    ds_read_b128 v[48:51], v223 offset:33920
    s_waitcnt lgkmcnt(9)
    v_mfma_f32_16x16x32_bf16 v[28:31], v[144:147], v[56:59], v[28:31]
    ds_read_b128 v[52:55], v223 offset:33792
    v_mfma_f32_16x16x32_bf16 v[20:23], v[148:151], v[60:63], v[20:23]
    ds_read_b128 v[56:59], v223 offset:34048
    s_waitcnt lgkmcnt(9)
    v_mfma_f32_16x16x32_bf16 v[24:27], v[148:151], v[64:67], v[24:27]
    ds_read_b128 v[60:63], v223 offset:33984
    v_mfma_f32_16x16x32_bf16 v[28:31], v[148:151], v[68:71], v[28:31]
    ds_read_b128 v[64:67], v223 offset:33856
    s_waitcnt lgkmcnt(9)
    v_mfma_f32_16x16x32_bf16 v[20:23], v[152:155], v[72:75], v[20:23]
    ds_read_b128 v[68:71], v223 offset:34112
    v_mfma_f32_16x16x32_bf16 v[24:27], v[152:155], v[76:79], v[24:27]
    ds_read_b128 v[72:75], v223 offset:34304
    s_waitcnt lgkmcnt(9)
    v_mfma_f32_16x16x32_bf16 v[28:31], v[152:155], v[80:83], v[28:31]
    ds_read_b128 v[76:79], v223 offset:34560
    v_mfma_f32_16x16x32_bf16 v[20:23], v[156:159], v[84:87], v[20:23]
    ds_read_b128 v[80:83], v223 offset:34432
    s_waitcnt lgkmcnt(9)
    v_mfma_f32_16x16x32_bf16 v[24:27], v[156:159], v[88:91], v[24:27]
    ds_read_b128 v[84:87], v223 offset:34368
    v_mfma_f32_16x16x32_bf16 v[28:31], v[156:159], v[92:95], v[28:31]
    ds_read_b128 v[88:91], v223 offset:34624
    s_waitcnt lgkmcnt(9)
    v_mfma_f32_16x16x32_bf16 v[20:23], v[160:163], v[48:51], v[20:23]
    ds_read_b128 v[92:95], v223 offset:34496
    v_mfma_f32_16x16x32_bf16 v[24:27], v[160:163], v[52:55], v[24:27]
    ds_read_b128 v[48:51], v247 offset:6272
    s_waitcnt lgkmcnt(9)
    v_mfma_f32_16x16x32_bf16 v[28:31], v[160:163], v[56:59], v[28:31]
    ds_read_b128 v[52:55], v232 offset:6528
    v_mfma_f32_16x16x32_bf16 v[20:23], v[164:167], v[60:63], v[20:23]
    ds_read_b128 v[56:59], v247 offset:6336
    s_waitcnt lgkmcnt(9)
    v_mfma_f32_16x16x32_bf16 v[24:27], v[164:167], v[64:67], v[24:27]
    ds_read_b128 v[60:63], v232 offset:6592
    v_mfma_f32_16x16x32_bf16 v[28:31], v[164:167], v[68:71], v[28:31]
    ds_read_b128 v[64:67], v247 offset:6784
    s_waitcnt lgkmcnt(9)
    v_mfma_f32_16x16x32_bf16 v[20:23], v[168:171], v[72:75], v[20:23]
    ds_read_b128 v[68:71], v232 offset:6656
    v_mfma_f32_16x16x32_bf16 v[24:27], v[168:171], v[76:79], v[24:27]
    ds_read_b128 v[72:75], v247 offset:6848
    s_waitcnt lgkmcnt(9)
    v_mfma_f32_16x16x32_bf16 v[28:31], v[168:171], v[80:83], v[28:31]
    ds_read_b128 v[76:79], v232 offset:6720
    v_mfma_f32_16x16x32_bf16 v[20:23], v[172:175], v[84:87], v[20:23]
    ds_read_b128 v[80:83], v247 offset:7168
    s_waitcnt lgkmcnt(9)
    v_mfma_f32_16x16x32_bf16 v[24:27], v[172:175], v[88:91], v[24:27]
    ds_read_b128 v[84:87], v232 offset:7424
    v_mfma_f32_16x16x32_bf16 v[28:31], v[172:175], v[92:95], v[28:31]
    ds_read_b128 v[88:91], v247 offset:7232
    s_waitcnt lgkmcnt(9)
    v_mfma_f32_16x16x32_bf16 v[36:39], v[112:115], v[48:51], 0
    ds_read_b128 v[92:95], v232 offset:7488
    v_mfma_f32_16x16x32_bf16 v[40:43], v[112:115], v[52:55], 0
    ds_read_b128 v[48:51], v248 offset:128
    s_waitcnt lgkmcnt(9)
    v_mfma_f32_16x16x32_bf16 v[36:39], v[116:119], v[56:59], v[36:39]
    ds_read_b128 v[52:55], v225 offset:384
    v_mfma_f32_16x16x32_bf16 v[40:43], v[116:119], v[60:63], v[40:43]
    ds_read_b128 v[56:59], v248 offset:192
    s_waitcnt lgkmcnt(9)
    v_mfma_f32_16x16x32_bf16 v[36:39], v[120:123], v[64:67], v[36:39]
    ds_read_b128 v[60:63], v225 offset:448
    v_mfma_f32_16x16x32_bf16 v[40:43], v[120:123], v[68:71], v[40:43]
    ds_read_b128 v[64:67], v248 offset:640
    s_waitcnt lgkmcnt(9)
    v_mfma_f32_16x16x32_bf16 v[36:39], v[124:127], v[72:75], v[36:39]
    ds_read_b128 v[68:71], v225 offset:512
    v_mfma_f32_16x16x32_bf16 v[40:43], v[124:127], v[76:79], v[40:43]
    ds_read_b128 v[72:75], v248 offset:704
    s_waitcnt lgkmcnt(9)
    v_mfma_f32_16x16x32_bf16 v[36:39], v[144:147], v[80:83], v[36:39]
    ds_read_b128 v[76:79], v225 offset:576
    v_mfma_f32_16x16x32_bf16 v[40:43], v[144:147], v[84:87], v[40:43]
    ds_read_b128 v[80:83], v248 offset:1024
    s_waitcnt lgkmcnt(9)
    v_mfma_f32_16x16x32_bf16 v[36:39], v[148:151], v[88:91], v[36:39]
    ds_read_b128 v[84:87], v225 offset:1280
    v_mfma_f32_16x16x32_bf16 v[40:43], v[148:151], v[92:95], v[40:43]
    ds_read_b128 v[88:91], v248 offset:1088
    s_waitcnt lgkmcnt(9)
    v_mfma_f32_16x16x32_bf16 v[36:39], v[152:155], v[48:51], v[36:39]
    ds_read_b128 v[92:95], v225 offset:1344
    v_mfma_f32_16x16x32_bf16 v[40:43], v[152:155], v[52:55], v[40:43]
    s_waitcnt lgkmcnt(8)
    v_mfma_f32_16x16x32_bf16 v[36:39], v[156:159], v[56:59], v[36:39]
    v_mfma_f32_16x16x32_bf16 v[40:43], v[156:159], v[60:63], v[40:43]
    s_waitcnt lgkmcnt(6)
    v_mfma_f32_16x16x32_bf16 v[36:39], v[160:163], v[64:67], v[36:39]
    v_mfma_f32_16x16x32_bf16 v[40:43], v[160:163], v[68:71], v[40:43]
    s_waitcnt lgkmcnt(4)
    v_mfma_f32_16x16x32_bf16 v[36:39], v[164:167], v[72:75], v[36:39]
    v_mfma_f32_16x16x32_bf16 v[40:43], v[164:167], v[76:79], v[40:43]
    s_waitcnt lgkmcnt(2)
    v_mfma_f32_16x16x32_bf16 v[36:39], v[168:171], v[80:83], v[36:39]
    v_mfma_f32_16x16x32_bf16 v[40:43], v[168:171], v[84:87], v[40:43]
    s_waitcnt lgkmcnt(0)
    v_mfma_f32_16x16x32_bf16 v[36:39], v[172:175], v[88:91], v[36:39]
    v_mfma_f32_16x16x32_bf16 v[40:43], v[172:175], v[92:95], v[40:43]
    s_lshl_b32 s60, s54, 9
    s_lshl_b32 s61, s20, 6
    s_add_u32 s60, s60, s61
    s_mul_i32 s60, s60, 192
    s_add_u32 s60, s60, 10485760
    v_mul_u32_u24 v227, 96, v252
    s_cmp_lg_u32 s28, 0
    s_cbranch_scc1 K2_NOACC
    buffer_load_dwordx4 v[48:51], v227, s[8:11], s60 offen offset:0
    buffer_load_dwordx4 v[52:55], v227, s[8:11], s60 offen offset:16
    buffer_load_dwordx4 v[56:59], v227, s[8:11], s60 offen offset:32
    buffer_load_dwordx4 v[60:63], v227, s[8:11], s60 offen offset:48
    buffer_load_dwordx4 v[64:67], v227, s[8:11], s60 offen offset:64
    buffer_load_dwordx4 v[68:71], v227, s[8:11], s60 offen offset:80
    buffer_load_dwordx4 v[72:75], v227, s[8:11], s60 offen offset:96
    buffer_load_dwordx4 v[76:79], v227, s[8:11], s60 offen offset:112
    buffer_load_dwordx4 v[80:83], v227, s[8:11], s60 offen offset:128
    buffer_load_dwordx4 v[84:87], v227, s[8:11], s60 offen offset:144
    buffer_load_dwordx4 v[88:91], v227, s[8:11], s60 offen offset:160
    s_waitcnt vmcnt(0)
    v_add_f32 v0, v0, v48
    v_add_f32 v1, v1, v49
    v_add_f32 v2, v2, v50
    v_add_f32 v3, v3, v51
    v_add_f32 v4, v4, v52
    v_add_f32 v5, v5, v53
    v_add_f32 v6, v6, v54
    v_add_f32 v7, v7, v55
    v_add_f32 v8, v8, v56
    v_add_f32 v9, v9, v57
    v_add_f32 v10, v10, v58
    v_add_f32 v11, v11, v59
    v_add_f32 v12, v12, v60
    v_add_f32 v13, v13, v61
    v_add_f32 v14, v14, v62
    v_add_f32 v15, v15, v63
    v_add_f32 v16, v16, v64
    v_add_f32 v17, v17, v65
    v_add_f32 v18, v18, v66
    v_add_f32 v19, v19, v67
    v_add_f32 v20, v20, v68
    v_add_f32 v21, v21, v69
    v_add_f32 v22, v22, v70
    v_add_f32 v23, v23, v71
    v_add_f32 v24, v24, v72
    v_add_f32 v25, v25, v73
    v_add_f32 v26, v26, v74
    v_add_f32 v27, v27, v75
    v_add_f32 v28, v28, v76
    v_add_f32 v29, v29, v77
    v_add_f32 v30, v30, v78
    v_add_f32 v31, v31, v79
    v_add_f32 v32, v32, v80
    v_add_f32 v33, v33, v81
    v_add_f32 v34, v34, v82
    v_add_f32 v35, v35, v83
    v_add_f32 v36, v36, v84
    v_add_f32 v37, v37, v85
    v_add_f32 v38, v38, v86
    v_add_f32 v39, v39, v87
    v_add_f32 v40, v40, v88
    v_add_f32 v41, v41, v89
    v_add_f32 v42, v42, v90
    v_add_f32 v43, v43, v91
K2_NOACC:
    s_barrier
    s_cmp_eq_u32 s55, 0
    s_cbranch_scc1 K2_SPILL
    s_bfe_u32 s60, s20, 0x10002
    s_lshl_b32 s60, s60, 4
    s_add_u32 s59, s59, s60
    v_add_u32 v228, s59, v229
    s_mul_i32 s60, s20, 2080
    s_add_u32 s60, s60, 65536
    v_add_u32 v249, s60, v229
    s_mov_b32 s63, 0xbfb8aa3b
    s_add_u32 s40, s20, s21
    s_lshl_b32 s40, s40, 10
    s_add_u32 s41, s40, 8192
    s_add_u32 s42, s40, 16384
    s_add_u32 s43, s40, 24576
    s_add_u32 s44, s40, 32768
    v_mul_f32 v204, s63, v0
    v_mul_f32 v205, s63, v1
    v_mul_f32 v206, s63, v2
    v_mul_f32 v207, s63, v3
    v_exp_f32 v204, v204
    v_exp_f32 v205, v205
    v_exp_f32 v206, v206
    v_exp_f32 v207, v207
    v_add_f32 v204, 1.0, v204
    v_add_f32 v205, 1.0, v205
    v_add_f32 v206, 1.0, v206
    v_add_f32 v207, 1.0, v207
    v_rcp_f32 v204, v204
    v_rcp_f32 v205, v205
    v_rcp_f32 v206, v206
    v_rcp_f32 v207, v207
    v_cvt_pk_bf16_f32 v176, v0, v1
    v_cvt_pk_bf16_f32 v177, v2, v3
    v_mul_f32 v4, v4, v204
    v_mul_f32 v5, v5, v205
    v_mul_f32 v6, v6, v206
    v_mul_f32 v7, v7, v207
    v_cvt_pk_bf16_f32 v178, v4, v5
    v_cvt_pk_bf16_f32 v179, v6, v7
    v_mul_f32 v8, v8, v204
    v_mul_f32 v9, v9, v205
    v_mul_f32 v10, v10, v206
    v_mul_f32 v11, v11, v207
    v_cvt_pk_bf16_f32 v180, v8, v9
    v_cvt_pk_bf16_f32 v181, v10, v11
    v_mul_f32 v12, v12, v204
    v_mul_f32 v13, v13, v205
    v_mul_f32 v14, v14, v206
    v_mul_f32 v15, v15, v207
    v_cvt_pk_bf16_f32 v182, v12, v13
    v_cvt_pk_bf16_f32 v183, v14, v15
    ds_write_b64 v254, v[176:177] offset:0
    ds_write_b64 v254, v[178:179] offset:256
    ds_write_b64 v254, v[180:181] offset:512
    ds_write_b64 v254, v[182:183] offset:768
    s_waitcnt lgkmcnt(0)
    s_barrier
    ds_read_b128 v[192:195], v228 offset:0
    ds_read_b128 v[196:199], v228 offset:1536
    s_waitcnt lgkmcnt(0)
    buffer_store_dwordx4 v[192:195], v229, s[12:15], s40 offen sc1
    buffer_store_dwordx4 v[196:199], v229, s[12:15], s41 offen sc1
    v_mul_f32 v208, s63, v16
    v_mul_f32 v209, s63, v17
    v_mul_f32 v210, s63, v18
    v_mul_f32 v211, s63, v19
    v_exp_f32 v208, v208
    v_exp_f32 v209, v209
    v_exp_f32 v210, v210
    v_exp_f32 v211, v211
    v_add_f32 v208, 1.0, v208
    v_add_f32 v209, 1.0, v209
    v_add_f32 v210, 1.0, v210
    v_add_f32 v211, 1.0, v211
    v_rcp_f32 v208, v208
    v_rcp_f32 v209, v209
    v_rcp_f32 v210, v210
    v_rcp_f32 v211, v211
    v_cvt_pk_bf16_f32 v184, v16, v17
    v_cvt_pk_bf16_f32 v185, v18, v19
    v_mul_f32 v20, v20, v208
    v_mul_f32 v21, v21, v209
    v_mul_f32 v22, v22, v210
    v_mul_f32 v23, v23, v211
    v_cvt_pk_bf16_f32 v186, v20, v21
    v_cvt_pk_bf16_f32 v187, v22, v23
    v_mul_f32 v24, v24, v208
    v_mul_f32 v25, v25, v209
    v_mul_f32 v26, v26, v210
    v_mul_f32 v27, v27, v211
    v_cvt_pk_bf16_f32 v188, v24, v25
    v_cvt_pk_bf16_f32 v189, v26, v27
    v_mul_f32 v28, v28, v208
    v_mul_f32 v29, v29, v209
    v_mul_f32 v30, v30, v210
    v_mul_f32 v31, v31, v211
    v_cvt_pk_bf16_f32 v190, v28, v29
    v_cvt_pk_bf16_f32 v191, v30, v31
    ds_write_b64 v254, v[184:185] offset:3072
    ds_write_b64 v254, v[186:187] offset:3328
    ds_write_b64 v254, v[188:189] offset:3584
    ds_write_b64 v254, v[190:191] offset:3840
    s_waitcnt lgkmcnt(0)
    s_barrier
    ds_read_b128 v[192:195], v228 offset:3072
    ds_read_b128 v[196:199], v228 offset:4608
    s_waitcnt lgkmcnt(0)
    buffer_store_dwordx4 v[192:195], v229, s[12:15], s42 offen sc1
    buffer_store_dwordx4 v[196:199], v229, s[12:15], s43 offen sc1
    v_mul_f32 v212, s63, v32
    v_mul_f32 v213, s63, v33
    v_mul_f32 v214, s63, v34
    v_mul_f32 v215, s63, v35
    v_exp_f32 v212, v212
    v_exp_f32 v213, v213
    v_exp_f32 v214, v214
    v_exp_f32 v215, v215
    v_add_f32 v212, 1.0, v212
    v_add_f32 v213, 1.0, v213
    v_add_f32 v214, 1.0, v214
    v_add_f32 v215, 1.0, v215
    v_rcp_f32 v212, v212
    v_rcp_f32 v213, v213
    v_rcp_f32 v214, v214
    v_rcp_f32 v215, v215
    v_cvt_pk_bf16_f32 v220, v32, v33
    v_cvt_pk_bf16_f32 v221, v34, v35
    v_mul_f32 v36, v36, v212
    v_mul_f32 v37, v37, v213
    v_mul_f32 v38, v38, v214
    v_mul_f32 v39, v39, v215
    v_cvt_pk_bf16_f32 v178, v36, v37
    v_cvt_pk_bf16_f32 v179, v38, v39
    v_mul_f32 v40, v40, v212
    v_mul_f32 v41, v41, v213
    v_mul_f32 v42, v42, v214
    v_mul_f32 v43, v43, v215
    v_cvt_pk_bf16_f32 v180, v40, v41
    v_cvt_pk_bf16_f32 v181, v42, v43
    ds_write_b64 v255, v[220:221] offset:0
    ds_write_b64 v246, v[178:179] offset:256
    ds_write_b64 v255, v[180:181] offset:512
    s_waitcnt lgkmcnt(0)
    s_barrier
    ds_read_b128 v[200:203], v249
    s_branch K2_LASTROW
K2_SPILL:
    buffer_store_dwordx4 v[0:3], v227, s[8:11], s60 offen offset:0
    buffer_store_dwordx4 v[4:7], v227, s[8:11], s60 offen offset:16
    buffer_store_dwordx4 v[8:11], v227, s[8:11], s60 offen offset:32
    buffer_store_dwordx4 v[12:15], v227, s[8:11], s60 offen offset:48
    buffer_store_dwordx4 v[16:19], v227, s[8:11], s60 offen offset:64
    buffer_store_dwordx4 v[20:23], v227, s[8:11], s60 offen offset:80
    buffer_store_dwordx4 v[24:27], v227, s[8:11], s60 offen offset:96
    buffer_store_dwordx4 v[28:31], v227, s[8:11], s60 offen offset:112
    buffer_store_dwordx4 v[32:35], v227, s[8:11], s60 offen offset:128
    buffer_store_dwordx4 v[36:39], v227, s[8:11], s60 offen offset:144
    buffer_store_dwordx4 v[40:43], v227, s[8:11], s60 offen offset:160
    s_mov_b32 s28, 0
    s_waitcnt vmcnt(0)
    s_cmp_lt_u32 s24, s25
    s_cbranch_scc1 K2_LOAD
    s_add_u32 s23, s23, 20
    s_branch K2_WINDOW
KS_FLS:
    s_sub_u32 s25, s25, 1
    s_cbranch_scc1 K2_END
    v_mov_b32 v62, 163460
    ds_read_b32 v62, v62
    s_branch KS_JOIN2
K2_NOW0:
    buffer_load_dwordx4 v[76:79], v72, s[8:11], s67 offen sc1
    s_branch K2_W0
K2_WINDOW:
    s_mov_b32 s24, 0
    s_mov_b32 s25, 1
K2_LOAD:
    v_mbcnt_lo_u32_b32 v176, -1, 0
    v_mbcnt_hi_u32_b32 v176, -1, v176
    s_lshl_b32 s58, s20, 6
    v_add_u32 v177, s58, v176
    v_lshlrev_b32 v70, 4, v176
    s_mov_b32 s58, 7110656
    buffer_load_dwordx4 v[136:139], v70, s[8:11], s58 offen offset:0 sc1
    buffer_load_dwordx4 v[140:143], v70, s[8:11], s58 offen offset:1024 sc1
    s_mov_b32 s58, 7112704
    buffer_load_dwordx4 v[144:147], v70, s[8:11], s58 offen offset:0 sc1
    buffer_load_dwordx4 v[148:151], v70, s[8:11], s58 offen offset:1024 sc1
    s_mov_b32 s58, 7114752
    buffer_load_dwordx4 v[152:155], v70, s[8:11], s58 offen offset:0 sc1
    buffer_load_dwordx4 v[156:159], v70, s[8:11], s58 offen offset:1024 sc1
    s_mov_b32 s58, 7116800
    buffer_load_dwordx4 v[160:163], v70, s[8:11], s58 offen offset:0 sc1
    buffer_load_dwordx4 v[164:167], v70, s[8:11], s58 offen offset:1024 sc1
    s_mov_b32 s58, 7118848
    buffer_load_dwordx4 v[168:171], v70, s[8:11], s58 offen offset:0 sc1
    buffer_load_dwordx4 v[172:175], v70, s[8:11], s58 offen offset:1024 sc1
    s_mul_i32 s58, s20, 10400
    s_add_u32 s58, s58, 65536
    s_add_u32 s59, s58, 512
    v_and_b32 v76, 31, v176
    v_lshrrev_b32 v77, 5, v176
    v_mov_b32 v80, 0
    v_mul_u32_u24 v77, 2080, v77
    v_mov_b32 v81, 0xffff0000
    v_lshl_add_u32 v78, v76, 4, v77
    v_mov_b32 v82, 0
    v_add_u32 v78, s58, v78
    v_mov_b32 v83, v81
    v_add_u32 v85, 16, v176
    v_lshlrev_b32 v84, 5, v176
    v_lshrrev_b32 v85, 6, v85
    v_mul_u32_u24 v85, 1532, v85
    v_sub_u32 v84, v84, v85
    v_mov_b32 v85, -1
    v_add_u32 v84, s59, v84
    ds_write_b32 v84, v85 offset:0
    ds_write_b32 v84, v85 offset:2080
    ds_write_b32 v84, v85 offset:4160
    ds_write_b32 v84, v85 offset:6240
    ds_write_b32 v84, v85 offset:8320
    s_mov_b32 exec_hi, 0
    ds_write_b128 v78, v[80:83] offset:0
    ds_write_b128 v78, v[80:83] offset:2080
    ds_write_b128 v78, v[80:83] offset:4160
    ds_write_b128 v78, v[80:83] offset:6240
    ds_write_b128 v78, v[80:83] offset:8320
    s_mov_b32 exec_hi, -1
    s_cmp_lg_u32 s20, 7
    s_cbranch_scc1 K2_NOH
    v_mov_b32 v76, 0
    v_mov_b32 v77, -1
    v_lshlrev_b32 v78, 2, v176
    v_add_u32 v78, 163072, v78
    s_mov_b64 exec, 0x1ff
    ds_write_b32 v78, v76 offset:192
    s_mov_b32 exec_lo, 1
    s_mov_b32 exec_lo, -1
    ds_write_b32 v78, v77 offset:256
    s_mov_b64 exec, -1
    s_cmp_lg_u32 s24, 0
    s_cbranch_scc1 K2_NOH
    s_mov_b32 exec_hi, 0xffff
    ds_write_b32 v78, v76
    s_mov_b64 exec, 1
    ds_write_b32 v78, v76 offset:232
    s_mov_b64 exec, -1
K2_NOH:
    s_waitcnt lgkmcnt(0)
    s_barrier
    s_branch K2_CELLS
K2_LD_GEN:
    s_mov_b64 exec, s[42:43]
    s_cbranch_execz K2_LD_DONE
    buffer_load_dwordx4 v[4:7], v182, s[8:11], 0 offen sc1
    s_mov_b64 exec, s[44:45]
    s_cbranch_execz K2_LD_DONE
    buffer_load_dwordx4 v[8:11], v183, s[8:11], 0 offen sc1
    s_mov_b64 exec, s[46:47]
    s_cbranch_execz K2_LD_DONE
    buffer_load_dwordx4 v[12:15], v184, s[8:11], 0 offen sc1
    s_mov_b64 exec, s[48:49]
    s_cbranch_execz K2_LD_DONE
    buffer_load_dwordx4 v[16:19], v181, s[8:11], 0 offen offset:128 sc1
    s_mov_b64 exec, s[50:51]
    s_cbranch_execz K2_LD_DONE
    buffer_load_dwordx4 v[20:23], v181, s[8:11], 0 offen offset:160 sc1
    s_mov_b64 exec, s[90:91]
    s_cbranch_execz K2_LD_DONE
    buffer_load_dwordx4 v[24:27], v181, s[8:11], 0 offen offset:192 sc1
    s_mov_b64 exec, s[92:93]
    s_cbranch_execz K2_LD_DONE
    buffer_load_dwordx4 v[28:31], v181, s[8:11], 0 offen offset:224 sc1
    s_mov_b64 exec, s[94:95]
    s_cbranch_execz K2_LD_DONE
    buffer_load_dwordx4 v[32:35], v181, s[8:11], 0 offen offset:256 sc1
    s_mov_b64 exec, s[96:97]
    s_cbranch_execz K2_LD_DONE
    buffer_load_dwordx4 v[36:39], v181, s[8:11], 0 offen offset:288 sc1
    s_branch K2_LD_DONE
K2_WLATE:
    s_waitcnt vmcnt(0)
    v_lshlrev_b32 v96, 16, v136
    v_and_b32 v97, 0xffff0000, v136
    v_lshlrev_b32 v98, 16, v137
    v_and_b32 v99, 0xffff0000, v137
    v_lshlrev_b32 v100, 16, v138
    v_and_b32 v101, 0xffff0000, v138
    v_lshlrev_b32 v102, 16, v139
    v_and_b32 v103, 0xffff0000, v139
    v_lshlrev_b32 v104, 16, v140
    v_and_b32 v105, 0xffff0000, v140
    v_lshlrev_b32 v106, 16, v141
    v_and_b32 v107, 0xffff0000, v141
    v_lshlrev_b32 v108, 16, v142
    v_and_b32 v109, 0xffff0000, v142
    v_lshlrev_b32 v110, 16, v143
    v_and_b32 v111, 0xffff0000, v143
    v_lshlrev_b32 v112, 16, v144
    v_and_b32 v113, 0xffff0000, v144
    v_lshlrev_b32 v114, 16, v145
    v_and_b32 v115, 0xffff0000, v145
    v_lshlrev_b32 v116, 16, v146
    v_and_b32 v117, 0xffff0000, v146
    v_lshlrev_b32 v118, 16, v147
    v_and_b32 v119, 0xffff0000, v147
    v_lshlrev_b32 v120, 16, v148
    v_and_b32 v121, 0xffff0000, v148
    v_lshlrev_b32 v122, 16, v149
    v_and_b32 v123, 0xffff0000, v149
    v_lshlrev_b32 v124, 16, v150
    v_and_b32 v125, 0xffff0000, v150
    v_lshlrev_b32 v126, 16, v151
    v_and_b32 v127, 0xffff0000, v151
    v_lshlrev_b32 v128, 16, v152
    v_and_b32 v129, 0xffff0000, v152
    v_lshlrev_b32 v130, 16, v153
    v_and_b32 v131, 0xffff0000, v153
    v_lshlrev_b32 v132, 16, v154
    v_and_b32 v133, 0xffff0000, v154
    v_lshlrev_b32 v134, 16, v155
    v_and_b32 v135, 0xffff0000, v155
    v_lshlrev_b32 v136, 16, v156
    v_and_b32 v137, 0xffff0000, v156
    v_lshlrev_b32 v138, 16, v157
    v_and_b32 v139, 0xffff0000, v157
    v_lshlrev_b32 v140, 16, v158
    v_and_b32 v141, 0xffff0000, v158
    v_lshlrev_b32 v142, 16, v159
    v_and_b32 v143, 0xffff0000, v159
    v_lshlrev_b32 v144, 16, v160
    v_and_b32 v145, 0xffff0000, v160
    v_lshlrev_b32 v146, 16, v161
    v_and_b32 v147, 0xffff0000, v161
    v_lshlrev_b32 v148, 16, v162
    v_and_b32 v149, 0xffff0000, v162
    v_lshlrev_b32 v150, 16, v163
    v_and_b32 v151, 0xffff0000, v163
    v_lshlrev_b32 v152, 16, v164
    v_and_b32 v153, 0xffff0000, v164
    v_lshlrev_b32 v154, 16, v165
    v_and_b32 v155, 0xffff0000, v165
    v_lshlrev_b32 v156, 16, v166
    v_and_b32 v157, 0xffff0000, v166
    v_lshlrev_b32 v158, 16, v167
    v_and_b32 v159, 0xffff0000, v167
    v_lshlrev_b32 v160, 16, v168
    v_and_b32 v161, 0xffff0000, v168
    v_lshlrev_b32 v162, 16, v169
    v_and_b32 v163, 0xffff0000, v169
    v_lshlrev_b32 v164, 16, v170
    v_and_b32 v165, 0xffff0000, v170
    v_lshlrev_b32 v166, 16, v171
    v_and_b32 v167, 0xffff0000, v171
    v_lshlrev_b32 v168, 16, v172
    v_and_b32 v169, 0xffff0000, v172
    v_lshlrev_b32 v170, 16, v173
    v_and_b32 v171, 0xffff0000, v173
    v_lshlrev_b32 v172, 16, v174
    v_and_b32 v173, 0xffff0000, v174
    v_lshlrev_b32 v174, 16, v175
    v_and_b32 v175, 0xffff0000, v175
    s_branch K2_NOWRAW
K2_RT0:
    s_sub_u32 s60, s60, 1
    s_cbranch_scc1 K2_END
    s_mov_b64 exec, vcc
    buffer_load_dwordx4 v[0:3], v181, s[8:11], 0 offen offset:0 sc1
    s_mov_b64 exec, s[40:41]
    s_waitcnt vmcnt(0)
    s_branch K2_CK0
K2_RT1:
    s_sub_u32 s60, s60, 1
    s_cbranch_scc1 K2_END
    s_mov_b64 exec, vcc
    buffer_load_dwordx4 v[4:7], v182, s[8:11], 0 offen sc1
    s_mov_b64 exec, s[42:43]
    s_waitcnt vmcnt(0)
    s_branch K2_CK1
K2_RT2:
    s_sub_u32 s60, s60, 1
    s_cbranch_scc1 K2_END
    s_mov_b64 exec, vcc
    buffer_load_dwordx4 v[8:11], v183, s[8:11], 0 offen sc1
    s_mov_b64 exec, s[44:45]
    s_waitcnt vmcnt(0)
    s_branch K2_CK2
K2_RT3:
    s_sub_u32 s60, s60, 1
    s_cbranch_scc1 K2_END
    s_mov_b64 exec, vcc
    buffer_load_dwordx4 v[12:15], v184, s[8:11], 0 offen sc1
    s_mov_b64 exec, s[46:47]
    s_waitcnt vmcnt(0)
    s_branch K2_CK3
K2_RT4:
    s_sub_u32 s60, s60, 1
    s_cbranch_scc1 K2_END
    s_mov_b64 exec, vcc
    buffer_load_dwordx4 v[16:19], v181, s[8:11], 0 offen offset:128 sc1
    s_mov_b64 exec, s[48:49]
    s_waitcnt vmcnt(0)
    s_branch K2_CK4
K2_RT5:
    s_sub_u32 s60, s60, 1
    s_cbranch_scc1 K2_END
    s_mov_b64 exec, vcc
    buffer_load_dwordx4 v[20:23], v181, s[8:11], 0 offen offset:160 sc1
    s_mov_b64 exec, s[50:51]
    s_waitcnt vmcnt(0)
    s_branch K2_CK5
K2_RT6:
    s_sub_u32 s60, s60, 1
    s_cbranch_scc1 K2_END
    s_mov_b64 exec, vcc
    buffer_load_dwordx4 v[24:27], v181, s[8:11], 0 offen offset:192 sc1
    s_mov_b64 exec, s[90:91]
    s_waitcnt vmcnt(0)
    s_branch K2_CK6
K2_RT7:
    s_sub_u32 s60, s60, 1
    s_cbranch_scc1 K2_END
    s_mov_b64 exec, vcc
    buffer_load_dwordx4 v[28:31], v181, s[8:11], 0 offen offset:224 sc1
    s_mov_b64 exec, s[92:93]
    s_waitcnt vmcnt(0)
    s_branch K2_CK7
K2_RT8:
    s_sub_u32 s60, s60, 1
    s_cbranch_scc1 K2_END
    s_mov_b64 exec, vcc
    buffer_load_dwordx4 v[32:35], v181, s[8:11], 0 offen offset:256 sc1
    s_mov_b64 exec, s[94:95]
    s_waitcnt vmcnt(0)
    s_branch K2_CK8
K2_RT9:
    s_sub_u32 s60, s60, 1
    s_cbranch_scc1 K2_END
    s_mov_b64 exec, vcc
    buffer_load_dwordx4 v[36:39], v181, s[8:11], 0 offen offset:288 sc1
    s_mov_b64 exec, s[96:97]
    s_waitcnt vmcnt(0)
    s_branch K2_CK9
K2_RK_LOAD:
    s_waitcnt vmcnt(0)
    s_mov_b64 exec, s[40:41]
    s_cbranch_execz K2_RK_B
    v_lshrrev_b32 v50, 24, v3
    buffer_load_dword v40, v179, s[8:11], s66 offen offset:0
    v_mad_u32_u24 v50, v50, s58, v202
    v_and_b32 v3, 0xffffff, v3
    s_mov_b64 exec, s[42:43]
    s_cbranch_execz K2_RK_B
    v_lshrrev_b32 v51, 24, v7
    buffer_load_dword v41, v185, s[8:11], s66 offen
    v_mad_u32_u24 v51, v51, s58, v202
    v_and_b32 v7, 0xffffff, v7
    s_mov_b64 exec, s[44:45]
    s_cbranch_execz K2_RK_B
    v_lshrrev_b32 v52, 24, v11
    buffer_load_dword v42, v186, s[8:11], s66 offen
    v_mad_u32_u24 v52, v52, s58, v202
    v_and_b32 v11, 0xffffff, v11
    s_mov_b64 exec, s[46:47]
    s_cbranch_execz K2_RK_B
    v_lshrrev_b32 v53, 24, v15
    buffer_load_dword v43, v187, s[8:11], s66 offen
    v_mad_u32_u24 v53, v53, s58, v202
    v_and_b32 v15, 0xffffff, v15
    s_mov_b64 exec, s[48:49]
    s_cbranch_execz K2_RK_B
    v_lshrrev_b32 v54, 24, v19
    buffer_load_dword v44, v179, s[8:11], s66 offen offset:32
    v_mad_u32_u24 v54, v54, s58, v202
    v_and_b32 v19, 0xffffff, v19
    s_mov_b64 exec, s[50:51]
    s_cbranch_execz K2_RK_B
    v_lshrrev_b32 v55, 24, v23
    buffer_load_dword v45, v179, s[8:11], s66 offen offset:40
    v_mad_u32_u24 v55, v55, s58, v202
    v_and_b32 v23, 0xffffff, v23
    s_mov_b64 exec, s[90:91]
    s_cbranch_execz K2_RK_B
    v_lshrrev_b32 v56, 24, v27
    buffer_load_dword v46, v179, s[8:11], s66 offen offset:48
    v_mad_u32_u24 v56, v56, s58, v202
    v_and_b32 v27, 0xffffff, v27
    s_mov_b64 exec, s[92:93]
    s_cbranch_execz K2_RK_B
    v_lshrrev_b32 v57, 24, v31
    buffer_load_dword v47, v179, s[8:11], s66 offen offset:56
    v_mad_u32_u24 v57, v57, s58, v202
    v_and_b32 v31, 0xffffff, v31
    s_mov_b64 exec, s[94:95]
    s_cbranch_execz K2_RK_B
    v_lshrrev_b32 v58, 24, v35
    buffer_load_dword v48, v179, s[8:11], s66 offen offset:64
    v_mad_u32_u24 v58, v58, s58, v202
    v_and_b32 v35, 0xffffff, v35
    s_mov_b64 exec, s[96:97]
    s_cbranch_execz K2_RK_B
    v_lshrrev_b32 v59, 24, v39
    buffer_load_dword v49, v179, s[8:11], s66 offen offset:72
    v_mad_u32_u24 v59, v59, s58, v202
    v_and_b32 v39, 0xffffff, v39
K2_RK_B:
    s_mov_b64 exec, -1
    s_mul_i32 s62, s24, 48
    s_waitcnt vmcnt(0)
    v_subrev_u32 v40, s62, v40
    v_subrev_u32 v41, s62, v41
    v_subrev_u32 v42, s62, v42
    v_subrev_u32 v43, s62, v43
    v_subrev_u32 v44, s62, v44
    v_subrev_u32 v45, s62, v45
    v_subrev_u32 v46, s62, v46
    v_subrev_u32 v47, s62, v47
    v_subrev_u32 v48, s62, v48
    v_subrev_u32 v49, s62, v49
    s_branch K2_RK_DONE
K2_BIG:
    s_cmp_lg_u32 s24, 0
    s_cbranch_scc1 K2_TOK
    s_movk_i32 s26, 48
    v_mov_b32 v197, v193
    s_nop 1
    v_max_u32_dpp v197, v197, v197 row_shr:1 row_mask:0xf bank_mask:0xf bound_ctrl:0
    s_nop 1
    v_max_u32_dpp v197, v197, v197 row_shr:2 row_mask:0xf bank_mask:0xf bound_ctrl:0
    s_nop 1
    v_max_u32_dpp v197, v197, v197 row_shr:4 row_mask:0xf bank_mask:0xf bound_ctrl:0
    s_nop 1
    v_max_u32_dpp v197, v197, v197 row_shr:8 row_mask:0xf bank_mask:0xf bound_ctrl:0
    s_nop 1
    v_max_u32_dpp v197, v197, v197 row_bcast:15 row_mask:0xa bank_mask:0xf
    s_nop 1
    v_max_u32_dpp v197, v197, v197 row_bcast:31 row_mask:0xc bank_mask:0xf
    s_nop 0
    v_readlane_b32 s25, v197, 63
    s_nop 0
    s_add_u32 s25, s25, 47
    s_mul_i32 s25, s25, 43691
    s_lshr_b32 s25, s25, 21
    s_mov_b64 exec, s[40:41]
    s_cbranch_execz K2_SV_DONE
    buffer_store_dword v40, v179, s[8:11], s66 offen offset:0
    s_mov_b64 exec, s[42:43]
    s_cbranch_execz K2_SV_DONE
    buffer_store_dword v41, v185, s[8:11], s66 offen
    s_mov_b64 exec, s[44:45]
    s_cbranch_execz K2_SV_DONE
    buffer_store_dword v42, v186, s[8:11], s66 offen
    s_mov_b64 exec, s[46:47]
    s_cbranch_execz K2_SV_DONE
    buffer_store_dword v43, v187, s[8:11], s66 offen
    s_mov_b64 exec, s[48:49]
    s_cbranch_execz K2_SV_DONE
    buffer_store_dword v44, v179, s[8:11], s66 offen offset:32
    s_mov_b64 exec, s[50:51]
    s_cbranch_execz K2_SV_DONE
    buffer_store_dword v45, v179, s[8:11], s66 offen offset:40
    s_mov_b64 exec, s[90:91]
    s_cbranch_execz K2_SV_DONE
    buffer_store_dword v46, v179, s[8:11], s66 offen offset:48
    s_mov_b64 exec, s[92:93]
    s_cbranch_execz K2_SV_DONE
    buffer_store_dword v47, v179, s[8:11], s66 offen offset:56
    s_mov_b64 exec, s[94:95]
    s_cbranch_execz K2_SV_DONE
    buffer_store_dword v48, v179, s[8:11], s66 offen offset:64
    s_mov_b64 exec, s[96:97]
    s_cbranch_execz K2_SV_DONE
    buffer_store_dword v49, v179, s[8:11], s66 offen offset:72
K2_SV_DONE:
    s_mov_b64 exec, -1
    s_branch K2_TOK
K2_rare_1:
    s_cmp_eq_u32 s33, 4
    s_cbranch_scc1 K2_four_3
    s_mov_b32 s49, s48
    s_xor_b32 s45, s44, 256
    s_xor_b32 s46, s44, 512
    s_xor_b32 s47, s44, 768
    s_branch K2_back_2
K2_four_3:
    s_add_u32 s50, s48, 256
    s_mov_b32 s46, s44
    s_mov_b32 s47, s44
    s_branch K2_back_2
K2_a4_5:
    v_add_u32 v254, s48, v230
    ds_read_b32 v254, v254 offset:4
    s_lshr_b32 s65, s3, 28
    s_mul_i32 s66, s22, 2080
    s_lshl_b32 s65, s65, 9
    s_add_u32 s65, s65, s66
    s_add_u32 s65, s65, 65536
    s_mov_b32 m0, s65
    s_mov_b32 exec_hi, 0
    s_waitcnt lgkmcnt(0)
    v_or_b32 v254, v254, v231
    buffer_load_dwordx4 v254, s[16:19], 0 offen  lds
    s_mov_b32 exec_hi, -1
    s_branch K2_b4_7
K2_g4_8:
    s_add_u32 s51, s48, 384
    v_add_u32 v228, s51, v251
    ds_read2_b32 v[228:229], v228 offset0:1 offset1:3
    s_waitcnt lgkmcnt(0)
    v_mad_u32_u16 v228, v228, s39, v248 op_sel:[1,0,0,0]
    v_mad_u32_u16 v229, v229, s39, v248 op_sel:[1,0,0,0]
    buffer_load_dwordx4 v228, s[4:7], s47 offen sc1 lds
    buffer_load_dwordx4 v229, s[72:75], s47 offen offset:1024 sc1 lds
    s_branch K2_back_9
K2_rare_16:
    s_cmp_eq_u32 s33, 4
    s_cbranch_scc1 K2_four_18
    s_mov_b32 s49, s48
    s_xor_b32 s45, s44, 256
    s_xor_b32 s46, s44, 512
    s_xor_b32 s47, s44, 768
    s_branch K2_back_17
K2_four_18:
    s_add_u32 s50, s48, 256
    s_mov_b32 s46, s44
    s_mov_b32 s47, s44
    s_branch K2_back_17
K2_g4_19:
    s_add_u32 s51, s48, 384
    v_add_u32 v228, s51, v251
    ds_read2_b32 v[228:229], v228 offset0:1 offset1:3
    s_waitcnt lgkmcnt(0)
    v_mad_u32_u16 v228, v228, s39, v248 op_sel:[1,0,0,0]
    v_mad_u32_u16 v229, v229, s39, v248 op_sel:[1,0,0,0]
    buffer_load_dwordx4 v228, s[4:7], s47 offen sc1 lds
    buffer_load_dwordx4 v229, s[72:75], s47 offen offset:1024 sc1 lds
    s_branch K2_back_20
K2_a4_22:
    v_add_u32 v254, s48, v230
    ds_read_b32 v254, v254 offset:4
    s_lshr_b32 s65, s3, 28
    s_mul_i32 s66, s22, 2080
    s_lshl_b32 s65, s65, 9
    s_add_u32 s65, s65, s66
    s_add_u32 s65, s65, 65536
    s_mov_b32 m0, s65
    s_mov_b32 exec_hi, 0
    s_waitcnt lgkmcnt(0)
    v_or_b32 v254, v254, v231
    buffer_load_dwordx4 v254, s[16:19], 0 offen  lds
    s_mov_b32 exec_hi, -1
    s_branch K2_b4_24
K2_rare_31:
    s_cmp_eq_u32 s33, 4
    s_cbranch_scc1 K2_four_33
    s_mov_b32 s49, s48
    s_xor_b32 s45, s44, 256
    s_xor_b32 s46, s44, 512
    s_xor_b32 s47, s44, 768
    s_branch K2_back_32
K2_four_33:
    s_add_u32 s50, s48, 256
    s_mov_b32 s46, s44
    s_mov_b32 s47, s44
    s_branch K2_back_32
K2_g4_34:
    s_add_u32 s51, s48, 384
    v_add_u32 v228, s51, v251
    ds_read2_b32 v[228:229], v228 offset0:1 offset1:3
    s_waitcnt lgkmcnt(0)
    v_mad_u32_u16 v228, v228, s39, v248 op_sel:[1,0,0,0]
    v_mad_u32_u16 v229, v229, s39, v248 op_sel:[1,0,0,0]
    buffer_load_dwordx4 v228, s[4:7], s47 offen sc1 lds
    buffer_load_dwordx4 v229, s[72:75], s47 offen offset:1024 sc1 lds
    s_branch K2_back_35
K2_a4_37:
    v_add_u32 v254, s48, v230
    ds_read_b32 v254, v254 offset:4
    s_lshr_b32 s65, s3, 28
    s_mul_i32 s66, s22, 2080
    s_lshl_b32 s65, s65, 9
    s_add_u32 s65, s65, s66
    s_add_u32 s65, s65, 65536
    s_mov_b32 m0, s65
    s_mov_b32 exec_hi, 0
    s_waitcnt lgkmcnt(0)
    v_or_b32 v254, v254, v231
    buffer_load_dwordx4 v254, s[16:19], 0 offen  lds
    s_mov_b32 exec_hi, -1
    s_branch K2_b4_39
K2_rare_46:
    s_cmp_eq_u32 s33, 4
    s_cbranch_scc1 K2_four_48
    s_mov_b32 s49, s48
    s_xor_b32 s45, s44, 256
    s_xor_b32 s46, s44, 512
    s_xor_b32 s47, s44, 768
    s_branch K2_back_47
K2_four_48:
    s_add_u32 s50, s48, 256
    s_mov_b32 s46, s44
    s_mov_b32 s47, s44
    s_branch K2_back_47
K2_g4_49:
    s_add_u32 s51, s48, 384
    v_add_u32 v228, s51, v251
    ds_read2_b32 v[228:229], v228 offset0:1 offset1:3
    s_waitcnt lgkmcnt(0)
    v_mad_u32_u16 v228, v228, s39, v248 op_sel:[1,0,0,0]
    v_mad_u32_u16 v229, v229, s39, v248 op_sel:[1,0,0,0]
    buffer_load_dwordx4 v228, s[4:7], s47 offen sc1 lds
    buffer_load_dwordx4 v229, s[72:75], s47 offen offset:1024 sc1 lds
    s_branch K2_back_50
K2_a4_52:
    v_add_u32 v254, s48, v230
    ds_read_b32 v254, v254 offset:4
    s_lshr_b32 s65, s3, 28
    s_mul_i32 s66, s22, 2080
    s_lshl_b32 s65, s65, 9
    s_add_u32 s65, s65, s66
    s_add_u32 s65, s65, 65536
    s_mov_b32 m0, s65
    s_mov_b32 exec_hi, 0
    s_waitcnt lgkmcnt(0)
    v_or_b32 v254, v254, v231
    buffer_load_dwordx4 v254, s[16:19], 0 offen  lds
    s_mov_b32 exec_hi, -1
    s_branch K2_b4_54
K2_rare_59:
    s_cmp_eq_u32 s33, 4
    s_cbranch_scc1 K2_four_61
    s_mov_b32 s49, s48
    s_xor_b32 s45, s44, 256
    s_xor_b32 s46, s44, 512
    s_xor_b32 s47, s44, 768
    s_branch K2_back_60
K2_four_61:
    s_add_u32 s50, s48, 256
    s_mov_b32 s46, s44
    s_mov_b32 s47, s44
    s_branch K2_back_60
K2_g4_62:
    s_add_u32 s51, s48, 384
    v_add_u32 v228, s51, v251
    ds_read2_b32 v[228:229], v228 offset0:1 offset1:3
    s_waitcnt lgkmcnt(0)
    v_mad_u32_u16 v228, v228, s39, v248 op_sel:[1,0,0,0]
    v_mad_u32_u16 v229, v229, s39, v248 op_sel:[1,0,0,0]
    buffer_load_dwordx4 v228, s[4:7], s47 offen sc1 lds
    buffer_load_dwordx4 v229, s[72:75], s47 offen offset:1024 sc1 lds
    s_branch K2_back_63
K2_rare_68:
    s_cmp_eq_u32 s33, 4
    s_cbranch_scc1 K2_four_70
    s_mov_b32 s49, s48
    s_xor_b32 s45, s44, 256
    s_xor_b32 s46, s44, 512
    s_xor_b32 s47, s44, 768
    s_branch K2_back_69
K2_four_70:
    s_add_u32 s50, s48, 256
    s_mov_b32 s46, s44
    s_mov_b32 s47, s44
    s_branch K2_back_69
K2_g4_71:
    s_add_u32 s51, s48, 384
    v_add_u32 v228, s51, v251
    ds_read2_b32 v[228:229], v228 offset0:1 offset1:3
    s_waitcnt lgkmcnt(0)
    v_mad_u32_u16 v228, v228, s39, v248 op_sel:[1,0,0,0]
    v_mad_u32_u16 v229, v229, s39, v248 op_sel:[1,0,0,0]
    buffer_load_dwordx4 v228, s[4:7], s47 offen sc1 lds
    buffer_load_dwordx4 v229, s[72:75], s47 offen offset:1024 sc1 lds
    s_branch K2_back_72
K2_rare_77:
    s_cmp_eq_u32 s33, 4
    s_cbranch_scc1 K2_four_79
    s_mov_b32 s49, s48
    s_xor_b32 s45, s44, 256
    s_xor_b32 s46, s44, 512
    s_xor_b32 s47, s44, 768
    s_branch K2_back_78
K2_four_79:
    s_add_u32 s50, s48, 256
    s_mov_b32 s46, s44
    s_mov_b32 s47, s44
    s_branch K2_back_78
K2_g4_80:
    s_add_u32 s51, s48, 384
    v_add_u32 v228, s51, v251
    ds_read2_b32 v[228:229], v228 offset0:1 offset1:3
    s_waitcnt lgkmcnt(0)
    v_mad_u32_u16 v228, v228, s39, v248 op_sel:[1,0,0,0]
    v_mad_u32_u16 v229, v229, s39, v248 op_sel:[1,0,0,0]
    buffer_load_dwordx4 v228, s[4:7], s47 offen sc1 lds
    buffer_load_dwordx4 v229, s[72:75], s47 offen offset:1024 sc1 lds
    s_branch K2_back_81
K2_rare_86:
    s_cmp_eq_u32 s33, 4
    s_cbranch_scc1 K2_four_88
    s_mov_b32 s49, s48
    s_xor_b32 s45, s44, 256
    s_xor_b32 s46, s44, 512
    s_xor_b32 s47, s44, 768
    s_branch K2_back_87
K2_four_88:
    s_add_u32 s50, s48, 256
    s_mov_b32 s46, s44
    s_mov_b32 s47, s44
    s_branch K2_back_87
K2_g4_89:
    s_add_u32 s51, s48, 384
    v_add_u32 v228, s51, v251
    ds_read2_b32 v[228:229], v228 offset0:1 offset1:3
    s_waitcnt lgkmcnt(0)
    v_mad_u32_u16 v228, v228, s39, v248 op_sel:[1,0,0,0]
    v_mad_u32_u16 v229, v229, s39, v248 op_sel:[1,0,0,0]
    buffer_load_dwordx4 v228, s[4:7], s47 offen sc1 lds
    buffer_load_dwordx4 v229, s[72:75], s47 offen offset:1024 sc1 lds
    s_branch K2_back_90
K2_U10:
    s_setprio 1
    s_add_u32 s38, s38, 1
    v_mov_b32 v254, s52
    v_mov_b32 v255, s38
    s_lshl_b32 s58, s38, 3
    s_add_u32 s58, s58, s20
    s_mov_b64 exec, 1
    ds_write_b32 v254, v255
    s_mov_b64 exec, -1
    s_cmp_lt_u32 s58, s22
    s_cbranch_scc0 K2_dyn_91
K2_back_92:
    s_waitcnt lgkmcnt(4)
    v_lshlrev_b32 v20, 16, v0
    v_and_b32 v21, 0xffff0000, v0
    v_lshlrev_b32 v22, 16, v1
    v_and_b32 v23, 0xffff0000, v1
    v_lshlrev_b32 v24, 16, v2
    v_and_b32 v25, 0xffff0000, v2
    v_lshlrev_b32 v26, 16, v3
    v_and_b32 v27, 0xffff0000, v3
    v_mul_f32_dpp v36, v16, v20 row_newbcast:8 row_mask:0xf bank_mask:0xf
    v_mul_f32_dpp v37, v16, v21 row_newbcast:9 row_mask:0xf bank_mask:0xf
    v_mul_f32_dpp v38, v16, v22 row_newbcast:10 row_mask:0xf bank_mask:0xf
    v_mul_f32_dpp v39, v16, v23 row_newbcast:11 row_mask:0xf bank_mask:0xf
    v_mul_f32_dpp v40, v16, v24 row_newbcast:12 row_mask:0xf bank_mask:0xf
    v_mul_f32_dpp v41, v16, v25 row_newbcast:13 row_mask:0xf bank_mask:0xf
    v_mul_f32_dpp v42, v16, v26 row_newbcast:14 row_mask:0xf bank_mask:0xf
    v_mul_f32_dpp v43, v16, v27 row_newbcast:15 row_mask:0xf bank_mask:0xf
    v_cvt_pk_bf16_f32 v68, v36, v37
    v_cvt_pk_bf16_f32 v69, v38, v39
    v_cvt_pk_bf16_f32 v70, v40, v41
    v_cvt_pk_bf16_f32 v71, v42, v43
    v_mul_f32_dpp v20, v16, v20 row_newbcast:0 row_mask:0xa bank_mask:0xf
    v_mul_f32_dpp v21, v16, v21 row_newbcast:1 row_mask:0xa bank_mask:0xf
    v_mul_f32_dpp v22, v16, v22 row_newbcast:2 row_mask:0xa bank_mask:0xf
    v_mul_f32_dpp v23, v16, v23 row_newbcast:3 row_mask:0xa bank_mask:0xf
    v_mul_f32_dpp v24, v16, v24 row_newbcast:4 row_mask:0xa bank_mask:0xf
    v_mul_f32_dpp v25, v16, v25 row_newbcast:5 row_mask:0xa bank_mask:0xf
    v_mul_f32_dpp v26, v16, v26 row_newbcast:6 row_mask:0xa bank_mask:0xf
    v_mul_f32_dpp v27, v16, v27 row_newbcast:7 row_mask:0xa bank_mask:0xf
    v_cvt_pk_bf16_f32 v64, v20, v21
    v_cvt_pk_bf16_f32 v65, v22, v23
    v_cvt_pk_bf16_f32 v66, v24, v25
    v_cvt_pk_bf16_f32 v67, v26, v27
    v_readlane_b32 s3, v253, s58
    s_lshl_b32 s44, s34, 7
    s_and_b32 s48, s3, 0x3ffff
    s_bfe_u32 s33, s3, 0x30013
    s_mul_i32 s35, s38, 6
    s_cmp_eq_u32 s34, 0
    s_cselect_b32 s35, s35, s48
    s_mov_b32 s45, s44
    s_xor_b32 s47, s44, 256
    s_add_u32 s49, s48, 128
    s_add_u32 s60, s48, 256
    s_cmp_eq_u32 s33, 3
    s_cselect_b32 s46, s44, s47
    s_cselect_b32 s50, s60, s48
    s_sub_u32 s60, s33, 2
    s_cmp_lt_u32 s60, 2
    s_cbranch_scc0 K2_rare_97
K2_back_98:
    v_add_u32 v233, s48, v230
    ds_read_b32 v232, v233
    ds_read_b32 v233, v233 offset:1024
    v_add_u32 v222, s48, v251
    ds_read2_b32 v[222:223], v222 offset0:1 offset1:3
    v_add_u32 v224, s49, v251
    ds_read2_b32 v[224:225], v224 offset0:1 offset1:3
    v_add_u32 v226, s50, v251
    ds_read2_b32 v[226:227], v226 offset0:1 offset1:3
    s_waitcnt lgkmcnt(3)
    v_or_b32 v232, v232, v231
    v_or_b32 v233, v233, v231
    s_cmp_lg_u32 s34, 0
    s_cbranch_scc1 K2_dum_100
    s_cmp_eq_u32 s33, 4
    s_cbranch_scc1 K2_a4_101
K2_b4_103:
    s_add_u32 m0, s48, 512
    s_add_u32 s65, s48, 1536
    buffer_load_dwordx4 v232, s[16:19], 0 offen  lds
    s_mov_b32 m0, s65
    s_mov_b32 exec_hi, 0
    buffer_load_dwordx4 v233, s[16:19], 0 offen  lds
    s_mov_b32 exec_hi, -1
K2_back_102:
    s_waitcnt lgkmcnt(2)
    v_mad_u32_u16 v222, v222, s39, v248 op_sel:[1,0,0,0]
    v_mad_u32_u16 v223, v223, s39, v248 op_sel:[1,0,0,0]
    s_waitcnt lgkmcnt(1)
    v_mad_u32_u16 v224, v224, s39, v248 op_sel:[1,0,0,0]
    v_mad_u32_u16 v225, v225, s39, v248 op_sel:[1,0,0,0]
    s_waitcnt lgkmcnt(0)
    v_mad_u32_u16 v226, v226, s39, v248 op_sel:[1,0,0,0]
    v_mad_u32_u16 v227, v227, s39, v248 op_sel:[1,0,0,0]
    s_waitcnt vmcnt(6)
    v_mfma_f32_32x32x16_bf16 v[0:15], v[64:67], v[176:179], 0
    ds_read_b64_tr_b16 v[184:185], v246 offset:2048
    ds_read_b64_tr_b16 v[186:187], v246 offset:3072
    ds_read_b64_tr_b16 v[188:189], v247 offset:2048
    ds_read_b64_tr_b16 v[190:191], v247 offset:3072
    s_mov_b32 m0, s68
    v_mfma_f32_32x32x16_bf16 v[16:31], v[68:71], v[176:179], 0
    buffer_load_dwordx4 v222, s[4:7], s44 offen sc1 lds
    buffer_load_dwordx4 v223, s[72:75], s44 offen offset:1024 sc1 lds
    v_permlane32_swap_b32 v242, v236
    v_permlane32_swap_b32 v243, v237
    v_mfma_f32_32x32x16_bf16 v[32:47], v[64:67], v[180:183], 0
    v_permlane32_swap_b32 v244, v238
    v_permlane32_swap_b32 v245, v239
    v_permlane32_swap_b32 v240, v241
    v_add_f32 v242, v242, v236
    v_mfma_f32_32x32x16_bf16 v[48:63], v[68:71], v[180:183], 0
    s_setprio 0
    v_add_f32 v243, v243, v237
    v_add_f32 v244, v244, v238
    v_add_f32 v245, v245, v239
    v_add_f32 v240, -v240, -v241
    s_set_gpr_idx_on s32, gpr_idx(DST)
    s_nop 0
    v_cvt_pk_bf16_f32 v195, v242, v243
    v_cvt_pk_bf16_f32 v196, v244, v245
    v_cvt_pk_bf16_f32 v197, v240, v240
    s_set_gpr_idx_off
    v_mul_f32 v234, v0, v96
    v_mul_f32 v236, v8, v128
    v_fmac_f32 v234, v1, v97
    v_fmac_f32 v236, v9, v129
    v_fmac_f32 v234, v2, v98
    v_fmac_f32 v236, v10, v130
    v_fmac_f32 v234, v3, v99
    v_fmac_f32 v236, v11, v131
    v_fmac_f32 v234, v4, v100
    v_fmac_f32 v236, v12, v132
    v_fmac_f32 v234, v5, v101
    v_fmac_f32 v236, v13, v133
    v_fmac_f32 v234, v6, v102
    v_fmac_f32 v236, v14, v134
    v_fmac_f32 v234, v7, v103
    v_fmac_f32 v236, v15, v135
    v_mul_f32 v238, v16, v128
    v_mul_f32 v240, v24, v128
    v_fmac_f32 v238, v17, v129
    v_fmac_f32 v240, v25, v129
    v_fmac_f32 v238, v18, v130
    v_fmac_f32 v240, v26, v130
    v_fmac_f32 v238, v19, v131
    v_fmac_f32 v240, v27, v131
    v_fmac_f32 v238, v20, v132
    v_fmac_f32 v240, v28, v132
    v_fmac_f32 v238, v21, v133
    v_fmac_f32 v240, v29, v133
    v_fmac_f32 v238, v22, v134
    v_fmac_f32 v240, v30, v134
    v_fmac_f32 v238, v23, v135
    v_fmac_f32 v240, v31, v135
    v_mul_f32 v235, v32, v104
    v_mul_f32 v237, v40, v136
    v_fmac_f32 v235, v33, v105
    v_fmac_f32 v237, v41, v137
    v_fmac_f32 v235, v34, v106
    v_fmac_f32 v237, v42, v138
    v_fmac_f32 v235, v35, v107
    v_fmac_f32 v237, v43, v139
    v_fmac_f32 v235, v36, v108
    v_fmac_f32 v237, v44, v140
    v_fmac_f32 v235, v37, v109
    v_fmac_f32 v237, v45, v141
    v_fmac_f32 v235, v38, v110
    v_fmac_f32 v237, v46, v142
    v_fmac_f32 v235, v39, v111
    v_fmac_f32 v237, v47, v143
    v_mul_f32 v239, v48, v136
    v_mul_f32 v241, v56, v136
    v_fmac_f32 v239, v49, v137
    v_fmac_f32 v241, v57, v137
    v_fmac_f32 v239, v50, v138
    v_fmac_f32 v241, v58, v138
    v_fmac_f32 v239, v51, v139
    v_fmac_f32 v241, v59, v139
    v_fmac_f32 v239, v52, v140
    v_fmac_f32 v241, v60, v140
    v_fmac_f32 v239, v53, v141
    v_fmac_f32 v241, v61, v141
    v_fmac_f32 v239, v54, v142
    v_fmac_f32 v241, v62, v142
    v_fmac_f32 v239, v55, v143
    v_fmac_f32 v241, v63, v143
    s_setprio 1
    s_waitcnt vmcnt(6) lgkmcnt(0)
    v_mfma_f32_32x32x16_bf16 v[0:15], v[64:67], v[184:187], 0
    ds_read_b64_tr_b16 v[176:177], v246 offset:4096
    ds_read_b64_tr_b16 v[178:179], v246 offset:5120
    ds_read_b64_tr_b16 v[180:181], v247 offset:4096
    ds_read_b64_tr_b16 v[182:183], v247 offset:5120
    s_mov_b32 m0, s69
    v_mfma_f32_32x32x16_bf16 v[16:31], v[68:71], v[184:187], 0
    buffer_load_dwordx4 v224, s[4:7], s45 offen sc1 lds
    buffer_load_dwordx4 v225, s[72:75], s45 offen offset:1024 sc1 lds
    v_permlane32_swap_b32 v234, v236
    v_permlane32_swap_b32 v235, v237
    v_mfma_f32_32x32x16_bf16 v[32:47], v[64:67], v[188:191], 0
    v_permlane32_swap_b32 v240, v238
    v_permlane32_swap_b32 v241, v239
    v_add_f32 v234, v234, v236
    v_add_f32 v235, v235, v237
    v_add_f32 v240, v240, v238
    v_mfma_f32_32x32x16_bf16 v[48:63], v[68:71], v[188:191], 0
    s_setprio 0
    v_add_f32 v241, v241, v239
    s_set_gpr_idx_on s31, gpr_idx(DST)
    s_nop 0
    v_cvt_pk_bf16_f32 v192, v234, v235
    v_cvt_pk_bf16_f32 v193, v240, v241
    s_set_gpr_idx_off
    v_mul_f32 v234, v0, v144
    v_mul_f32 v236, v8, v112
    v_fmac_f32 v234, v1, v145
    v_fmac_f32 v236, v9, v113
    v_fmac_f32 v234, v2, v146
    v_fmac_f32 v236, v10, v114
    v_fmac_f32 v234, v3, v147
    v_fmac_f32 v236, v11, v115
    v_fmac_f32 v234, v4, v148
    v_fmac_f32 v236, v12, v116
    v_fmac_f32 v234, v5, v149
    v_fmac_f32 v236, v13, v117
    v_fmac_f32 v234, v6, v150
    v_fmac_f32 v236, v14, v118
    v_fmac_f32 v234, v7, v151
    v_fmac_f32 v236, v15, v119
    v_mul_f32 v238, v16, v160
    v_mul_f32 v240, v24, v160
    v_fmac_f32 v238, v17, v161
    v_fmac_f32 v240, v25, v161
    v_fmac_f32 v238, v18, v162
    v_fmac_f32 v240, v26, v162
    v_fmac_f32 v238, v19, v163
    v_fmac_f32 v240, v27, v163
    v_fmac_f32 v238, v20, v164
    v_fmac_f32 v240, v28, v164
    v_fmac_f32 v238, v21, v165
    v_fmac_f32 v240, v29, v165
    v_fmac_f32 v238, v22, v166
    v_fmac_f32 v240, v30, v166
    v_fmac_f32 v238, v23, v167
    v_fmac_f32 v240, v31, v167
    v_mul_f32 v235, v32, v152
    v_mul_f32 v237, v40, v120
    v_fmac_f32 v235, v33, v153
    v_fmac_f32 v237, v41, v121
    v_fmac_f32 v235, v34, v154
    v_fmac_f32 v237, v42, v122
    v_fmac_f32 v235, v35, v155
    v_fmac_f32 v237, v43, v123
    v_fmac_f32 v235, v36, v156
    v_fmac_f32 v237, v44, v124
    v_fmac_f32 v235, v37, v157
    v_fmac_f32 v237, v45, v125
    v_fmac_f32 v235, v38, v158
    v_fmac_f32 v237, v46, v126
    v_fmac_f32 v235, v39, v159
    v_fmac_f32 v237, v47, v127
    v_mul_f32 v239, v48, v168
    v_mul_f32 v241, v56, v168
    v_fmac_f32 v239, v49, v169
    v_fmac_f32 v241, v57, v169
    v_fmac_f32 v239, v50, v170
    v_fmac_f32 v241, v58, v170
    v_fmac_f32 v239, v51, v171
    v_fmac_f32 v241, v59, v171
    v_fmac_f32 v239, v52, v172
    v_fmac_f32 v241, v60, v172
    v_fmac_f32 v239, v53, v173
    v_fmac_f32 v241, v61, v173
    v_fmac_f32 v239, v54, v174
    v_fmac_f32 v241, v62, v174
    v_fmac_f32 v239, v55, v175
    v_fmac_f32 v241, v63, v175
    s_setprio 1
    s_waitcnt vmcnt(6) lgkmcnt(0)
    v_mfma_f32_32x32x16_bf16 v[0:15], v[64:67], v[176:179], 0
    ds_read_b64_tr_b16 v[184:185], v246 offset:6144
    ds_read_b64_tr_b16 v[186:187], v246 offset:7168
    ds_read_b64_tr_b16 v[188:189], v247 offset:6144
    ds_read_b64_tr_b16 v[190:191], v247 offset:7168
    s_mov_b32 m0, s70
    v_mfma_f32_32x32x16_bf16 v[16:31], v[68:71], v[176:179], 0
    buffer_load_dwordx4 v226, s[4:7], s46 offen sc1 lds
    buffer_load_dwordx4 v227, s[72:75], s46 offen offset:1024 sc1 lds
    s_sub_u32 s26, s48, s29
    s_mov_b32 s29, s48
    s_mov_b32 s30, s3
    s_bfe_u32 s56, s3, 0x40012
    v_mfma_f32_32x32x16_bf16 v[32:47], v[64:67], v[180:183], 0
    s_cmp_eq_u32 s34, 0
    s_cselect_b32 s56, s56, 0
    v_mfma_f32_32x32x16_bf16 v[48:63], v[68:71], v[180:183], 0
    s_setprio 0
    v_mul_f32 v242, v0, v144
    v_fma_f32 v238, v8, v160, -v238
    v_fmac_f32 v242, v1, v145
    v_fmac_f32 v238, v9, v161
    v_fmac_f32 v242, v2, v146
    v_fmac_f32 v238, v10, v162
    v_fmac_f32 v242, v3, v147
    v_fmac_f32 v238, v11, v163
    v_fmac_f32 v242, v4, v148
    v_fmac_f32 v238, v12, v164
    v_fmac_f32 v242, v5, v149
    v_fmac_f32 v238, v13, v165
    v_fmac_f32 v242, v6, v150
    v_fmac_f32 v238, v14, v166
    v_fmac_f32 v242, v7, v151
    v_fmac_f32 v238, v15, v167
    v_fmac_f32 v236, v16, v112
    v_mul_f32 v244, v24, v160
    v_fmac_f32 v236, v17, v113
    v_fmac_f32 v244, v25, v161
    v_fmac_f32 v236, v18, v114
    v_fmac_f32 v244, v26, v162
    v_fmac_f32 v236, v19, v115
    v_fmac_f32 v244, v27, v163
    v_fmac_f32 v236, v20, v116
    v_fmac_f32 v244, v28, v164
    v_fmac_f32 v236, v21, v117
    v_fmac_f32 v244, v29, v165
    v_fmac_f32 v236, v22, v118
    v_fmac_f32 v244, v30, v166
    v_fmac_f32 v236, v23, v119
    v_fmac_f32 v244, v31, v167
    v_mul_f32 v243, v32, v152
    v_fma_f32 v239, v40, v168, -v239
    v_fmac_f32 v243, v33, v153
    v_fmac_f32 v239, v41, v169
    v_fmac_f32 v243, v34, v154
    v_fmac_f32 v239, v42, v170
    v_fmac_f32 v243, v35, v155
    v_fmac_f32 v239, v43, v171
    v_fmac_f32 v243, v36, v156
    v_fmac_f32 v239, v44, v172
    v_fmac_f32 v243, v37, v157
    v_fmac_f32 v239, v45, v173
    v_fmac_f32 v243, v38, v158
    v_fmac_f32 v239, v46, v174
    v_fmac_f32 v243, v39, v159
    v_fmac_f32 v239, v47, v175
    v_fmac_f32 v237, v48, v120
    v_mul_f32 v245, v56, v168
    v_fmac_f32 v237, v49, v121
    v_fmac_f32 v245, v57, v169
    v_fmac_f32 v237, v50, v122
    v_fmac_f32 v245, v58, v170
    v_fmac_f32 v237, v51, v123
    v_fmac_f32 v245, v59, v171
    v_fmac_f32 v237, v52, v124
    v_fmac_f32 v245, v60, v172
    v_fmac_f32 v237, v53, v125
    v_fmac_f32 v245, v61, v173
    v_fmac_f32 v237, v54, v126
    v_fmac_f32 v245, v62, v174
    v_fmac_f32 v237, v55, v127
    v_fmac_f32 v245, v63, v175
    s_setprio 1
    s_waitcnt vmcnt(4) lgkmcnt(0)
    v_mfma_f32_32x32x16_bf16 v[0:15], v[64:67], v[184:187], 0
    ds_read_b64_tr_b16 v[176:177], v246 offset:0
    ds_read_b64_tr_b16 v[178:179], v246 offset:1024
    ds_read_b64_tr_b16 v[180:181], v247 offset:0
    ds_read_b64_tr_b16 v[182:183], v247 offset:1024
    s_mov_b32 m0, s71
    v_mfma_f32_32x32x16_bf16 v[16:31], v[68:71], v[184:187], 0
    s_cmp_eq_u32 s33, 4
    s_cbranch_scc1 K2_g4_104
    buffer_load_dwordx4 v224, s[4:7], s47 offen sc1 lds
    buffer_load_dwordx4 v225, s[72:75], s47 offen offset:1024 sc1 lds
K2_back_105:
    v_permlane32_swap_b32 v242, v234
    v_mfma_f32_32x32x16_bf16 v[32:47], v[64:67], v[188:191], 0
    v_permlane32_swap_b32 v243, v235
    v_add_f32 v242, v242, v234
    v_add_f32 v243, v243, v235
    s_set_gpr_idx_on s31, gpr_idx(DST)
    s_nop 0
    v_cvt_pk_bf16_f32 v194, v242, v243
    s_set_gpr_idx_off
    s_mov_b32 s32, s31
    s_mov_b32 s31, s35
    v_mfma_f32_32x32x16_bf16 v[48:63], v[68:71], v[188:191], 0
    s_setprio 0
    v_mul_f32 v242, v0, v144
    v_fma_f32 v240, v8, v160, -v240
    v_fmac_f32 v242, v1, v145
    v_fmac_f32 v240, v9, v161
    v_fmac_f32 v242, v2, v146
    v_fmac_f32 v240, v10, v162
    v_fmac_f32 v242, v3, v147
    v_fmac_f32 v240, v11, v163
    v_fmac_f32 v242, v4, v148
    v_fmac_f32 v240, v12, v164
    v_fmac_f32 v242, v5, v149
    v_fmac_f32 v240, v13, v165
    v_fmac_f32 v242, v6, v150
    v_fmac_f32 v240, v14, v166
    v_fmac_f32 v242, v7, v151
    v_fmac_f32 v240, v15, v167
    v_add_u32 v249, s26, v249
    v_add_u32 v250, s26, v250
    v_fma_f32 v244, v16, v160, -v244
    v_fmac_f32 v236, v24, v112
    v_fmac_f32 v244, v17, v161
    v_fmac_f32 v236, v25, v113
    v_fmac_f32 v244, v18, v162
    v_fmac_f32 v236, v26, v114
    v_fmac_f32 v244, v19, v163
    v_fmac_f32 v236, v27, v115
    v_fmac_f32 v244, v20, v164
    v_fmac_f32 v236, v28, v116
    v_fmac_f32 v244, v21, v165
    v_fmac_f32 v236, v29, v117
    v_fmac_f32 v244, v22, v166
    v_fmac_f32 v236, v30, v118
    v_fmac_f32 v244, v23, v167
    v_fmac_f32 v236, v31, v119
    ds_read_b64_tr_b16 v[0:1], v249 offset:0
    ds_read_b64_tr_b16 v[2:3], v249 offset:32
    ds_read_u16_d16_hi v16, v250 offset:0
    v_mul_f32 v243, v32, v152
    v_fma_f32 v241, v40, v168, -v241
    v_fmac_f32 v243, v33, v153
    v_fmac_f32 v241, v41, v169
    v_fmac_f32 v243, v34, v154
    v_fmac_f32 v241, v42, v170
    v_fmac_f32 v243, v35, v155
    v_fmac_f32 v241, v43, v171
    v_fmac_f32 v243, v36, v156
    v_fmac_f32 v241, v44, v172
    v_fmac_f32 v243, v37, v157
    v_fmac_f32 v241, v45, v173
    v_fmac_f32 v243, v38, v158
    v_fmac_f32 v241, v46, v174
    v_fmac_f32 v243, v39, v159
    v_fmac_f32 v241, v47, v175
    ds_read_b64_tr_b16 v[4:5], v249 offset:512
    ds_read_b64_tr_b16 v[6:7], v249 offset:544
    ds_read_u16_d16_hi v17, v250 offset:128
    v_fma_f32 v245, v48, v168, -v245
    v_fmac_f32 v237, v56, v120
    v_fmac_f32 v245, v49, v169
    v_fmac_f32 v237, v57, v121
    v_fmac_f32 v245, v50, v170
    v_fmac_f32 v237, v58, v122
    v_fmac_f32 v245, v51, v171
    v_fmac_f32 v237, v59, v123
    v_fmac_f32 v245, v52, v172
    v_fmac_f32 v237, v60, v124
    v_fmac_f32 v245, v53, v173
    v_fmac_f32 v237, v61, v125
    v_fmac_f32 v245, v54, v174
    v_fmac_f32 v237, v62, v126
    v_fmac_f32 v245, v55, v175
    v_fmac_f32 v237, v63, v127
    s_cmp_eq_u32 s56, 5
    s_cbranch_scc1 K2_U20
    s_cmp_eq_u32 s56, 6
    s_cbranch_scc1 K2_U3h0
    s_branch K2_DSP0
K2_U40:
    s_setprio 1
    ds_read_b64_tr_b16 v[8:9], v249 offset:1024
    ds_read_b64_tr_b16 v[10:11], v249 offset:1056
    ds_read_u16_d16_hi v18, v250 offset:256
    s_lshr_b32 s65, s30, 28
    s_mul_i32 s66, s22, 2080
    s_lshl_b32 s65, s65, 9
    s_add_u32 s65, s65, s66
    s_add_u32 s65, s65, 65536
    s_sub_u32 s65, s65, s29
    s_sub_u32 s65, s65, 512
    v_add_u32 v56, s65, v249
    ds_read_b64_tr_b16 v[12:13], v56 offset:0
    ds_read_b64_tr_b16 v[14:15], v56 offset:32
    ds_read_u16_d16_hi v19, v250 offset:384
    s_waitcnt lgkmcnt(6)
    v_lshlrev_b32 v20, 16, v0
    v_and_b32 v21, 0xffff0000, v0
    v_lshlrev_b32 v22, 16, v1
    v_and_b32 v23, 0xffff0000, v1
    v_lshlrev_b32 v24, 16, v2
    v_and_b32 v25, 0xffff0000, v2
    v_lshlrev_b32 v26, 16, v3
    v_and_b32 v27, 0xffff0000, v3
    v_mul_f32_dpp v36, v16, v20 row_newbcast:8 row_mask:0xf bank_mask:0xf
    v_mul_f32_dpp v37, v16, v21 row_newbcast:9 row_mask:0xf bank_mask:0xf
    v_mul_f32_dpp v38, v16, v22 row_newbcast:10 row_mask:0xf bank_mask:0xf
    v_mul_f32_dpp v39, v16, v23 row_newbcast:11 row_mask:0xf bank_mask:0xf
    v_mul_f32_dpp v40, v16, v24 row_newbcast:12 row_mask:0xf bank_mask:0xf
    v_mul_f32_dpp v41, v16, v25 row_newbcast:13 row_mask:0xf bank_mask:0xf
    v_mul_f32_dpp v42, v16, v26 row_newbcast:14 row_mask:0xf bank_mask:0xf
    v_mul_f32_dpp v43, v16, v27 row_newbcast:15 row_mask:0xf bank_mask:0xf
    v_cvt_pk_bf16_f32 v68, v36, v37
    v_cvt_pk_bf16_f32 v69, v38, v39
    v_cvt_pk_bf16_f32 v70, v40, v41
    v_cvt_pk_bf16_f32 v71, v42, v43
    v_mul_f32_dpp v20, v16, v20 row_newbcast:0 row_mask:0xa bank_mask:0xf
    v_mul_f32_dpp v21, v16, v21 row_newbcast:1 row_mask:0xa bank_mask:0xf
    v_mul_f32_dpp v22, v16, v22 row_newbcast:2 row_mask:0xa bank_mask:0xf
    v_mul_f32_dpp v23, v16, v23 row_newbcast:3 row_mask:0xa bank_mask:0xf
    v_mul_f32_dpp v24, v16, v24 row_newbcast:4 row_mask:0xa bank_mask:0xf
    v_mul_f32_dpp v25, v16, v25 row_newbcast:5 row_mask:0xa bank_mask:0xf
    v_mul_f32_dpp v26, v16, v26 row_newbcast:6 row_mask:0xa bank_mask:0xf
    v_mul_f32_dpp v27, v16, v27 row_newbcast:7 row_mask:0xa bank_mask:0xf
    v_cvt_pk_bf16_f32 v64, v20, v21
    v_cvt_pk_bf16_f32 v65, v22, v23
    v_cvt_pk_bf16_f32 v66, v24, v25
    v_cvt_pk_bf16_f32 v67, v26, v27
    v_lshlrev_b32 v28, 16, v4
    v_and_b32 v29, 0xffff0000, v4
    v_lshlrev_b32 v30, 16, v5
    v_and_b32 v31, 0xffff0000, v5
    v_lshlrev_b32 v32, 16, v6
    v_and_b32 v33, 0xffff0000, v6
    v_lshlrev_b32 v34, 16, v7
    v_and_b32 v35, 0xffff0000, v7
    v_mul_f32_dpp v36, v17, v28 row_newbcast:8 row_mask:0xf bank_mask:0xf
    v_mul_f32_dpp v37, v17, v29 row_newbcast:9 row_mask:0xf bank_mask:0xf
    v_mul_f32_dpp v38, v17, v30 row_newbcast:10 row_mask:0xf bank_mask:0xf
    v_mul_f32_dpp v39, v17, v31 row_newbcast:11 row_mask:0xf bank_mask:0xf
    v_mul_f32_dpp v40, v17, v32 row_newbcast:12 row_mask:0xf bank_mask:0xf
    v_mul_f32_dpp v41, v17, v33 row_newbcast:13 row_mask:0xf bank_mask:0xf
    v_mul_f32_dpp v42, v17, v34 row_newbcast:14 row_mask:0xf bank_mask:0xf
    v_mul_f32_dpp v43, v17, v35 row_newbcast:15 row_mask:0xf bank_mask:0xf
    v_cvt_pk_bf16_f32 v76, v36, v37
    v_cvt_pk_bf16_f32 v77, v38, v39
    v_cvt_pk_bf16_f32 v78, v40, v41
    v_cvt_pk_bf16_f32 v79, v42, v43
    v_mul_f32_dpp v28, v17, v28 row_newbcast:0 row_mask:0xa bank_mask:0xf
    v_mul_f32_dpp v29, v17, v29 row_newbcast:1 row_mask:0xa bank_mask:0xf
    v_mul_f32_dpp v30, v17, v30 row_newbcast:2 row_mask:0xa bank_mask:0xf
    v_mul_f32_dpp v31, v17, v31 row_newbcast:3 row_mask:0xa bank_mask:0xf
    v_mul_f32_dpp v32, v17, v32 row_newbcast:4 row_mask:0xa bank_mask:0xf
    v_mul_f32_dpp v33, v17, v33 row_newbcast:5 row_mask:0xa bank_mask:0xf
    v_mul_f32_dpp v34, v17, v34 row_newbcast:6 row_mask:0xa bank_mask:0xf
    v_mul_f32_dpp v35, v17, v35 row_newbcast:7 row_mask:0xa bank_mask:0xf
    v_cvt_pk_bf16_f32 v72, v28, v29
    v_cvt_pk_bf16_f32 v73, v30, v31
    v_cvt_pk_bf16_f32 v74, v32, v33
    v_cvt_pk_bf16_f32 v75, v34, v35
    s_waitcnt lgkmcnt(3)
    v_lshlrev_b32 v20, 16, v8
    v_and_b32 v21, 0xffff0000, v8
    v_lshlrev_b32 v22, 16, v9
    v_and_b32 v23, 0xffff0000, v9
    v_lshlrev_b32 v24, 16, v10
    v_and_b32 v25, 0xffff0000, v10
    v_lshlrev_b32 v26, 16, v11
    v_and_b32 v27, 0xffff0000, v11
    v_mul_f32_dpp v36, v18, v20 row_newbcast:8 row_mask:0xf bank_mask:0xf
    v_mul_f32_dpp v37, v18, v21 row_newbcast:9 row_mask:0xf bank_mask:0xf
    v_mul_f32_dpp v38, v18, v22 row_newbcast:10 row_mask:0xf bank_mask:0xf
    v_mul_f32_dpp v39, v18, v23 row_newbcast:11 row_mask:0xf bank_mask:0xf
    v_mul_f32_dpp v40, v18, v24 row_newbcast:12 row_mask:0xf bank_mask:0xf
    v_mul_f32_dpp v41, v18, v25 row_newbcast:13 row_mask:0xf bank_mask:0xf
    v_mul_f32_dpp v42, v18, v26 row_newbcast:14 row_mask:0xf bank_mask:0xf
    v_mul_f32_dpp v43, v18, v27 row_newbcast:15 row_mask:0xf bank_mask:0xf
    v_cvt_pk_bf16_f32 v84, v36, v37
    v_cvt_pk_bf16_f32 v85, v38, v39
    v_cvt_pk_bf16_f32 v86, v40, v41
    v_cvt_pk_bf16_f32 v87, v42, v43
    v_mul_f32_dpp v20, v18, v20 row_newbcast:0 row_mask:0xa bank_mask:0xf
    v_mul_f32_dpp v21, v18, v21 row_newbcast:1 row_mask:0xa bank_mask:0xf
    v_mul_f32_dpp v22, v18, v22 row_newbcast:2 row_mask:0xa bank_mask:0xf
    v_mul_f32_dpp v23, v18, v23 row_newbcast:3 row_mask:0xa bank_mask:0xf
    v_mul_f32_dpp v24, v18, v24 row_newbcast:4 row_mask:0xa bank_mask:0xf
    v_mul_f32_dpp v25, v18, v25 row_newbcast:5 row_mask:0xa bank_mask:0xf
    v_mul_f32_dpp v26, v18, v26 row_newbcast:6 row_mask:0xa bank_mask:0xf
    v_mul_f32_dpp v27, v18, v27 row_newbcast:7 row_mask:0xa bank_mask:0xf
    v_cvt_pk_bf16_f32 v80, v20, v21
    v_cvt_pk_bf16_f32 v81, v22, v23
    v_cvt_pk_bf16_f32 v82, v24, v25
    v_cvt_pk_bf16_f32 v83, v26, v27
    s_waitcnt lgkmcnt(0)
    v_lshlrev_b32 v28, 16, v12
    v_and_b32 v29, 0xffff0000, v12
    v_lshlrev_b32 v30, 16, v13
    v_and_b32 v31, 0xffff0000, v13
    v_lshlrev_b32 v32, 16, v14
    v_and_b32 v33, 0xffff0000, v14
    v_lshlrev_b32 v34, 16, v15
    v_and_b32 v35, 0xffff0000, v15
    v_mul_f32_dpp v36, v19, v28 row_newbcast:8 row_mask:0xf bank_mask:0xf
    v_mul_f32_dpp v37, v19, v29 row_newbcast:9 row_mask:0xf bank_mask:0xf
    v_mul_f32_dpp v38, v19, v30 row_newbcast:10 row_mask:0xf bank_mask:0xf
    v_mul_f32_dpp v39, v19, v31 row_newbcast:11 row_mask:0xf bank_mask:0xf
    v_mul_f32_dpp v40, v19, v32 row_newbcast:12 row_mask:0xf bank_mask:0xf
    v_mul_f32_dpp v41, v19, v33 row_newbcast:13 row_mask:0xf bank_mask:0xf
    v_mul_f32_dpp v42, v19, v34 row_newbcast:14 row_mask:0xf bank_mask:0xf
    v_mul_f32_dpp v43, v19, v35 row_newbcast:15 row_mask:0xf bank_mask:0xf
    v_cvt_pk_bf16_f32 v92, v36, v37
    v_cvt_pk_bf16_f32 v93, v38, v39
    v_cvt_pk_bf16_f32 v94, v40, v41
    v_cvt_pk_bf16_f32 v95, v42, v43
    v_mul_f32_dpp v28, v19, v28 row_newbcast:0 row_mask:0xa bank_mask:0xf
    v_mul_f32_dpp v29, v19, v29 row_newbcast:1 row_mask:0xa bank_mask:0xf
    v_mul_f32_dpp v30, v19, v30 row_newbcast:2 row_mask:0xa bank_mask:0xf
    v_mul_f32_dpp v31, v19, v31 row_newbcast:3 row_mask:0xa bank_mask:0xf
    v_mul_f32_dpp v32, v19, v32 row_newbcast:4 row_mask:0xa bank_mask:0xf
    v_mul_f32_dpp v33, v19, v33 row_newbcast:5 row_mask:0xa bank_mask:0xf
    v_mul_f32_dpp v34, v19, v34 row_newbcast:6 row_mask:0xa bank_mask:0xf
    v_mul_f32_dpp v35, v19, v35 row_newbcast:7 row_mask:0xa bank_mask:0xf
    v_cvt_pk_bf16_f32 v88, v28, v29
    v_cvt_pk_bf16_f32 v89, v30, v31
    v_cvt_pk_bf16_f32 v90, v32, v33
    v_cvt_pk_bf16_f32 v91, v34, v35
    s_waitcnt vmcnt(4)
    v_mfma_f32_32x32x16_bf16 v[0:15], v[64:67], v[176:179], 0
    ds_read_b64_tr_b16 v[184:185], v246 offset:2048
    ds_read_b64_tr_b16 v[186:187], v246 offset:3072
    ds_read_b64_tr_b16 v[188:189], v247 offset:2048
    ds_read_b64_tr_b16 v[190:191], v247 offset:3072
    s_mov_b32 m0, s68
    v_mfma_f32_32x32x16_bf16 v[16:31], v[68:71], v[176:179], 0
    buffer_load_dwordx4 v222, s[4:7], s41 offen sc1 lds
    buffer_load_dwordx4 v223, s[72:75], s41 offen offset:1024 sc1 lds
    v_permlane32_swap_b32 v242, v236
    v_permlane32_swap_b32 v243, v237
    s_add_u32 s38, s38, 1
    v_mfma_f32_32x32x16_bf16 v[32:47], v[64:67], v[180:183], 0
    v_permlane32_swap_b32 v244, v238
    v_permlane32_swap_b32 v245, v239
    v_permlane32_swap_b32 v240, v241
    v_add_f32 v242, v242, v236
    v_mfma_f32_32x32x16_bf16 v[48:63], v[68:71], v[180:183], 0
    v_add_f32 v243, v243, v237
    v_add_f32 v244, v244, v238
    v_add_f32 v245, v245, v239
    v_add_f32 v240, -v240, -v241
    v_mov_b32 v254, s52
    v_mov_b32 v255, s38
    s_waitcnt vmcnt(4) lgkmcnt(0)
    v_mfma_f32_32x32x16_bf16 v[0:15], v[72:75], v[184:187], v[0:15]
    ds_read_b64_tr_b16 v[176:177], v246 offset:4096
    ds_read_b64_tr_b16 v[178:179], v246 offset:5120
    ds_read_b64_tr_b16 v[180:181], v247 offset:4096
    ds_read_b64_tr_b16 v[182:183], v247 offset:5120
    s_lshl_b32 s58, s38, 3
    s_add_u32 s58, s58, s20
    s_mov_b32 m0, s69
    v_mfma_f32_32x32x16_bf16 v[16:31], v[76:79], v[184:187], v[16:31]
    buffer_load_dwordx4 v224, s[4:7], s41 offen sc1 lds
    buffer_load_dwordx4 v225, s[72:75], s41 offen offset:1024 sc1 lds
    s_set_gpr_idx_on s32, gpr_idx(DST)
    s_nop 0
    v_cvt_pk_bf16_f32 v195, v242, v243
    v_cvt_pk_bf16_f32 v196, v244, v245
    v_cvt_pk_bf16_f32 v197, v240, v240
    s_set_gpr_idx_off
    s_mov_b64 exec, 1
    ds_write_b32 v254, v255
    s_mov_b64 exec, -1
    s_cmp_lt_u32 s58, s22
    s_cbranch_scc0 K2_dyn_106
K2_back_107:
    v_readlane_b32 s3, v253, s58
    s_lshl_b32 s44, s34, 7
    s_and_b32 s48, s3, 0x3ffff
    s_bfe_u32 s33, s3, 0x30013
    s_mul_i32 s35, s38, 6
    s_cmp_eq_u32 s34, 0
    s_cselect_b32 s35, s35, s48
    s_mov_b32 s45, s44
    s_xor_b32 s47, s44, 256
    s_add_u32 s49, s48, 128
    s_add_u32 s60, s48, 256
    s_cmp_eq_u32 s33, 3
    s_cselect_b32 s46, s44, s47
    s_cselect_b32 s50, s60, s48
    s_sub_u32 s60, s33, 2
    s_cmp_lt_u32 s60, 2
    s_cbranch_scc0 K2_rare_112
K2_back_113:
    v_mfma_f32_32x32x16_bf16 v[32:47], v[72:75], v[188:191], v[32:47]
    v_add_u32 v233, s48, v230
    ds_read_b32 v232, v233
    ds_read_b32 v233, v233 offset:1024
    v_mfma_f32_32x32x16_bf16 v[48:63], v[76:79], v[188:191], v[48:63]
    s_waitcnt vmcnt(4) lgkmcnt(3)
    v_mfma_f32_32x32x16_bf16 v[0:15], v[80:83], v[176:179], v[0:15]
    ds_read_b64_tr_b16 v[184:185], v246 offset:6144
    ds_read_b64_tr_b16 v[186:187], v246 offset:7168
    ds_read_b64_tr_b16 v[188:189], v247 offset:6144
    ds_read_b64_tr_b16 v[190:191], v247 offset:7168
    s_mov_b32 m0, s70
    v_mfma_f32_32x32x16_bf16 v[16:31], v[84:87], v[176:179], v[16:31]
    buffer_load_dwordx4 v226, s[4:7], s41 offen sc1 lds
    buffer_load_dwordx4 v227, s[72:75], s41 offen offset:1024 sc1 lds
    v_mfma_f32_32x32x16_bf16 v[32:47], v[80:83], v[180:183], v[32:47]
    v_mfma_f32_32x32x16_bf16 v[48:63], v[84:87], v[180:183], v[48:63]
    s_waitcnt lgkmcnt(4)
    v_or_b32 v232, v232, v231
    v_or_b32 v233, v233, v231
    s_cmp_lg_u32 s34, 0
    s_cbranch_scc1 K2_dum_117
    s_cmp_eq_u32 s33, 4
    s_cbranch_scc1 K2_a4_118
K2_b4_120:
    s_add_u32 m0, s48, 512
    s_add_u32 s65, s48, 1536
    buffer_load_dwordx4 v232, s[16:19], 0 offen  lds
    s_mov_b32 m0, s65
    s_mov_b32 exec_hi, 0
    buffer_load_dwordx4 v233, s[16:19], 0 offen  lds
    s_mov_b32 exec_hi, -1
K2_back_119:
    s_waitcnt vmcnt(6) lgkmcnt(0)
    v_mfma_f32_32x32x16_bf16 v[0:15], v[88:91], v[184:187], v[0:15]
    ds_read_b64_tr_b16 v[176:177], v246 offset:0
    ds_read_b64_tr_b16 v[178:179], v246 offset:1024
    ds_read_b64_tr_b16 v[180:181], v247 offset:0
    ds_read_b64_tr_b16 v[182:183], v247 offset:1024
    s_mov_b32 m0, s71
    v_mfma_f32_32x32x16_bf16 v[16:31], v[92:95], v[184:187], v[16:31]
    buffer_load_dwordx4 v228, s[4:7], s41 offen sc1 lds
    buffer_load_dwordx4 v229, s[72:75], s41 offen offset:1024 sc1 lds
    v_mfma_f32_32x32x16_bf16 v[32:47], v[88:91], v[188:191], v[32:47]
    s_nop 2
    v_mul_f32 v234, v0, v96
    v_mul_f32 v236, v8, v128
    v_fmac_f32 v234, v1, v97
    v_fmac_f32 v236, v9, v129
    v_fmac_f32 v234, v2, v98
    v_fmac_f32 v236, v10, v130
    v_fmac_f32 v234, v3, v99
    v_mfma_f32_32x32x16_bf16 v[48:63], v[92:95], v[188:191], v[48:63]
    s_setprio 0
    v_fmac_f32 v236, v11, v131
    v_fmac_f32 v234, v4, v100
    v_fmac_f32 v236, v12, v132
    v_fmac_f32 v234, v5, v101
    v_fmac_f32 v236, v13, v133
    v_fmac_f32 v234, v6, v102
    v_fmac_f32 v236, v14, v134
    v_fmac_f32 v234, v7, v103
    v_fmac_f32 v236, v15, v135
    v_mul_f32 v238, v16, v128
    v_mul_f32 v240, v24, v128
    v_fmac_f32 v238, v17, v129
    v_fmac_f32 v240, v25, v129
    v_fmac_f32 v238, v18, v130
    v_fmac_f32 v240, v26, v130
    v_fmac_f32 v238, v19, v131
    v_fmac_f32 v240, v27, v131
    v_fmac_f32 v238, v20, v132
    v_fmac_f32 v240, v28, v132
    v_fmac_f32 v238, v21, v133
    v_fmac_f32 v240, v29, v133
    v_fmac_f32 v238, v22, v134
    v_fmac_f32 v240, v30, v134
    v_fmac_f32 v238, v23, v135
    v_fmac_f32 v240, v31, v135
    v_mul_f32 v235, v32, v104
    v_mul_f32 v237, v40, v136
    v_fmac_f32 v235, v33, v105
    v_fmac_f32 v237, v41, v137
    v_fmac_f32 v235, v34, v106
    v_fmac_f32 v237, v42, v138
    v_fmac_f32 v235, v35, v107
    v_fmac_f32 v237, v43, v139
    v_fmac_f32 v235, v36, v108
    v_fmac_f32 v237, v44, v140
    v_fmac_f32 v235, v37, v109
    v_fmac_f32 v237, v45, v141
    v_fmac_f32 v235, v38, v110
    v_fmac_f32 v237, v46, v142
    v_fmac_f32 v235, v39, v111
    v_fmac_f32 v237, v47, v143
    v_mul_f32 v239, v48, v136
    v_mul_f32 v241, v56, v136
    s_setprio 1
    s_waitcnt vmcnt(6) lgkmcnt(0)
    v_mfma_f32_32x32x16_bf16 v[0:15], v[64:67], v[176:179], 0
    ds_read_b64_tr_b16 v[184:185], v246 offset:2048
    ds_read_b64_tr_b16 v[186:187], v246 offset:3072
    ds_read_b64_tr_b16 v[188:189], v247 offset:2048
    ds_read_b64_tr_b16 v[190:191], v247 offset:3072
    v_fmac_f32 v239, v49, v137
    v_fmac_f32 v241, v57, v137
    s_mov_b32 m0, s68
    v_mfma_f32_32x32x16_bf16 v[16:31], v[68:71], v[176:179], 0
    buffer_load_dwordx4 v222, s[4:7], s42 offen sc1 lds
    buffer_load_dwordx4 v223, s[72:75], s42 offen offset:1024 sc1 lds
    v_fmac_f32 v239, v50, v138
    v_fmac_f32 v241, v58, v138
    v_fmac_f32 v239, v51, v139
    v_fmac_f32 v241, v59, v139
    v_fmac_f32 v239, v52, v140
    v_mfma_f32_32x32x16_bf16 v[32:47], v[64:67], v[180:183], 0
    v_fmac_f32 v241, v60, v140
    v_fmac_f32 v239, v53, v141
    v_fmac_f32 v241, v61, v141
    v_fmac_f32 v239, v54, v142
    v_fmac_f32 v241, v62, v142
    v_fmac_f32 v239, v55, v143
    v_fmac_f32 v241, v63, v143
    v_mfma_f32_32x32x16_bf16 v[48:63], v[68:71], v[180:183], 0
    v_permlane32_swap_b32 v234, v236
    v_permlane32_swap_b32 v235, v237
    v_permlane32_swap_b32 v240, v238
    s_waitcnt vmcnt(6) lgkmcnt(0)
    v_mfma_f32_32x32x16_bf16 v[0:15], v[72:75], v[184:187], v[0:15]
    ds_read_b64_tr_b16 v[176:177], v246 offset:4096
    ds_read_b64_tr_b16 v[178:179], v246 offset:5120
    ds_read_b64_tr_b16 v[180:181], v247 offset:4096
    ds_read_b64_tr_b16 v[182:183], v247 offset:5120
    v_permlane32_swap_b32 v241, v239
    s_mov_b32 m0, s69
    v_mfma_f32_32x32x16_bf16 v[16:31], v[76:79], v[184:187], v[16:31]
    buffer_load_dwordx4 v224, s[4:7], s42 offen sc1 lds
    buffer_load_dwordx4 v225, s[72:75], s42 offen offset:1024 sc1 lds
    v_add_f32 v234, v234, v236
    v_add_f32 v235, v235, v237
    v_add_f32 v240, v240, v238
    v_add_f32 v241, v241, v239
    v_mfma_f32_32x32x16_bf16 v[32:47], v[72:75], v[188:191], v[32:47]
    s_set_gpr_idx_on s31, gpr_idx(DST)
    s_nop 0
    v_cvt_pk_bf16_f32 v192, v234, v235
    v_cvt_pk_bf16_f32 v193, v240, v241
    s_set_gpr_idx_off
    v_mfma_f32_32x32x16_bf16 v[48:63], v[76:79], v[188:191], v[48:63]
    s_waitcnt vmcnt(4) lgkmcnt(0)
    v_mfma_f32_32x32x16_bf16 v[0:15], v[80:83], v[176:179], v[0:15]
    ds_read_b64_tr_b16 v[184:185], v246 offset:6144
    ds_read_b64_tr_b16 v[186:187], v246 offset:7168
    ds_read_b64_tr_b16 v[188:189], v247 offset:6144
    ds_read_b64_tr_b16 v[190:191], v247 offset:7168
    s_mov_b32 m0, s70
    v_mfma_f32_32x32x16_bf16 v[16:31], v[84:87], v[176:179], v[16:31]
    buffer_load_dwordx4 v226, s[4:7], s42 offen sc1 lds
    buffer_load_dwordx4 v227, s[72:75], s42 offen offset:1024 sc1 lds
    v_mfma_f32_32x32x16_bf16 v[32:47], v[80:83], v[180:183], v[32:47]
    v_mfma_f32_32x32x16_bf16 v[48:63], v[84:87], v[180:183], v[48:63]
    s_waitcnt vmcnt(4) lgkmcnt(0)
    v_mfma_f32_32x32x16_bf16 v[0:15], v[88:91], v[184:187], v[0:15]
    ds_read_b64_tr_b16 v[176:177], v246 offset:0
    ds_read_b64_tr_b16 v[178:179], v246 offset:1024
    ds_read_b64_tr_b16 v[180:181], v247 offset:0
    ds_read_b64_tr_b16 v[182:183], v247 offset:1024
    s_mov_b32 m0, s71
    v_mfma_f32_32x32x16_bf16 v[16:31], v[92:95], v[184:187], v[16:31]
    buffer_load_dwordx4 v228, s[4:7], s42 offen sc1 lds
    buffer_load_dwordx4 v229, s[72:75], s42 offen offset:1024 sc1 lds
    v_mfma_f32_32x32x16_bf16 v[32:47], v[88:91], v[188:191], v[32:47]
    s_nop 2
    v_mul_f32 v234, v0, v144
    v_mul_f32 v236, v8, v112
    v_fmac_f32 v234, v1, v145
    v_fmac_f32 v236, v9, v113
    v_fmac_f32 v234, v2, v146
    v_fmac_f32 v236, v10, v114
    v_fmac_f32 v234, v3, v147
    v_mfma_f32_32x32x16_bf16 v[48:63], v[92:95], v[188:191], v[48:63]
    s_setprio 0
    v_fmac_f32 v236, v11, v115
    v_fmac_f32 v234, v4, v148
    v_fmac_f32 v236, v12, v116
    v_fmac_f32 v234, v5, v149
    v_fmac_f32 v236, v13, v117
    v_fmac_f32 v234, v6, v150
    v_fmac_f32 v236, v14, v118
    v_fmac_f32 v234, v7, v151
    v_fmac_f32 v236, v15, v119
    v_mul_f32 v238, v16, v160
    v_mul_f32 v240, v24, v160
    v_fmac_f32 v238, v17, v161
    v_fmac_f32 v240, v25, v161
    v_fmac_f32 v238, v18, v162
    v_fmac_f32 v240, v26, v162
    v_fmac_f32 v238, v19, v163
    v_fmac_f32 v240, v27, v163
    v_fmac_f32 v238, v20, v164
    v_fmac_f32 v240, v28, v164
    v_fmac_f32 v238, v21, v165
    v_fmac_f32 v240, v29, v165
    v_fmac_f32 v238, v22, v166
    v_fmac_f32 v240, v30, v166
    v_fmac_f32 v238, v23, v167
    v_fmac_f32 v240, v31, v167
    v_mul_f32 v235, v32, v152
    v_mul_f32 v237, v40, v120
    v_fmac_f32 v235, v33, v153
    v_fmac_f32 v237, v41, v121
    v_fmac_f32 v235, v34, v154
    v_fmac_f32 v237, v42, v122
    v_fmac_f32 v235, v35, v155
    v_fmac_f32 v237, v43, v123
    v_fmac_f32 v235, v36, v156
    v_fmac_f32 v237, v44, v124
    v_fmac_f32 v235, v37, v157
    v_fmac_f32 v237, v45, v125
    v_fmac_f32 v235, v38, v158
    v_fmac_f32 v237, v46, v126
    v_fmac_f32 v235, v39, v159
    v_fmac_f32 v237, v47, v127
    v_mul_f32 v239, v48, v168
    v_mul_f32 v241, v56, v168
    s_setprio 1
    s_waitcnt vmcnt(4) lgkmcnt(0)
    v_mfma_f32_32x32x16_bf16 v[0:15], v[64:67], v[176:179], 0
    ds_read_b64_tr_b16 v[184:185], v246 offset:2048
    ds_read_b64_tr_b16 v[186:187], v246 offset:3072
    ds_read_b64_tr_b16 v[188:189], v247 offset:2048
    ds_read_b64_tr_b16 v[190:191], v247 offset:3072
    v_fmac_f32 v239, v49, v169
    v_fmac_f32 v241, v57, v169
    s_mov_b32 m0, s68
    v_mfma_f32_32x32x16_bf16 v[16:31], v[68:71], v[176:179], 0
    buffer_load_dwordx4 v222, s[4:7], s43 offen sc1 lds
    buffer_load_dwordx4 v223, s[72:75], s43 offen offset:1024 sc1 lds
    v_fmac_f32 v239, v50, v170
    v_fmac_f32 v241, v58, v170
    v_fmac_f32 v239, v51, v171
    v_fmac_f32 v241, v59, v171
    v_fmac_f32 v239, v52, v172
    v_mfma_f32_32x32x16_bf16 v[32:47], v[64:67], v[180:183], 0
    v_fmac_f32 v241, v60, v172
    v_fmac_f32 v239, v53, v173
    v_fmac_f32 v241, v61, v173
    v_fmac_f32 v239, v54, v174
    v_fmac_f32 v241, v62, v174
    v_fmac_f32 v239, v55, v175
    v_fmac_f32 v241, v63, v175
    v_mfma_f32_32x32x16_bf16 v[48:63], v[68:71], v[180:183], 0
    s_waitcnt vmcnt(4) lgkmcnt(0)
    v_mfma_f32_32x32x16_bf16 v[0:15], v[72:75], v[184:187], v[0:15]
    ds_read_b64_tr_b16 v[176:177], v246 offset:4096
    ds_read_b64_tr_b16 v[178:179], v246 offset:5120
    ds_read_b64_tr_b16 v[180:181], v247 offset:4096
    ds_read_b64_tr_b16 v[182:183], v247 offset:5120
    s_mov_b32 m0, s69
    v_mfma_f32_32x32x16_bf16 v[16:31], v[76:79], v[184:187], v[16:31]
    buffer_load_dwordx4 v224, s[4:7], s43 offen sc1 lds
    buffer_load_dwordx4 v225, s[72:75], s43 offen offset:1024 sc1 lds
    v_mfma_f32_32x32x16_bf16 v[32:47], v[72:75], v[188:191], v[32:47]
    v_mfma_f32_32x32x16_bf16 v[48:63], v[76:79], v[188:191], v[48:63]
    s_waitcnt vmcnt(4) lgkmcnt(0)
    v_mfma_f32_32x32x16_bf16 v[0:15], v[80:83], v[176:179], v[0:15]
    ds_read_b64_tr_b16 v[184:185], v246 offset:6144
    ds_read_b64_tr_b16 v[186:187], v246 offset:7168
    ds_read_b64_tr_b16 v[188:189], v247 offset:6144
    ds_read_b64_tr_b16 v[190:191], v247 offset:7168
    s_mov_b32 m0, s70
    v_mfma_f32_32x32x16_bf16 v[16:31], v[84:87], v[176:179], v[16:31]
    buffer_load_dwordx4 v226, s[4:7], s43 offen sc1 lds
    buffer_load_dwordx4 v227, s[72:75], s43 offen offset:1024 sc1 lds
    v_mfma_f32_32x32x16_bf16 v[32:47], v[80:83], v[180:183], v[32:47]
    v_add_u32 v222, s48, v251
    ds_read2_b32 v[222:223], v222 offset0:1 offset1:3
    v_mfma_f32_32x32x16_bf16 v[48:63], v[84:87], v[180:183], v[48:63]
    s_waitcnt vmcnt(4) lgkmcnt(1)
    v_mfma_f32_32x32x16_bf16 v[0:15], v[88:91], v[184:187], v[0:15]
    ds_read_b64_tr_b16 v[176:177], v246 offset:0
    ds_read_b64_tr_b16 v[178:179], v246 offset:1024
    ds_read_b64_tr_b16 v[180:181], v247 offset:0
    ds_read_b64_tr_b16 v[182:183], v247 offset:1024
    s_mov_b32 m0, s71
    v_mfma_f32_32x32x16_bf16 v[16:31], v[92:95], v[184:187], v[16:31]
    buffer_load_dwordx4 v228, s[4:7], s43 offen sc1 lds
    buffer_load_dwordx4 v229, s[72:75], s43 offen offset:1024 sc1 lds
    s_waitcnt lgkmcnt(4)
    v_mad_u32_u16 v222, v222, s39, v248 op_sel:[1,0,0,0]
    v_mad_u32_u16 v223, v223, s39, v248 op_sel:[1,0,0,0]
    v_mfma_f32_32x32x16_bf16 v[32:47], v[88:91], v[188:191], v[32:47]
    v_add_u32 v224, s49, v251
    ds_read2_b32 v[224:225], v224 offset0:1 offset1:3
    v_mul_f32 v242, v0, v144
    v_fma_f32 v238, v8, v160, -v238
    v_fmac_f32 v242, v1, v145
    v_fmac_f32 v238, v9, v161
    v_fmac_f32 v242, v2, v146
    v_mfma_f32_32x32x16_bf16 v[48:63], v[92:95], v[188:191], v[48:63]
    s_setprio 0
    v_fmac_f32 v238, v10, v162
    v_fmac_f32 v242, v3, v147
    v_fmac_f32 v238, v11, v163
    v_fmac_f32 v242, v4, v148
    v_fmac_f32 v238, v12, v164
    v_fmac_f32 v242, v5, v149
    v_fmac_f32 v238, v13, v165
    v_fmac_f32 v242, v6, v150
    v_fmac_f32 v238, v14, v166
    v_fmac_f32 v242, v7, v151
    v_fmac_f32 v238, v15, v167
    v_fmac_f32 v236, v16, v112
    v_mul_f32 v244, v24, v160
    v_fmac_f32 v236, v17, v113
    v_fmac_f32 v244, v25, v161
    v_fmac_f32 v236, v18, v114
    v_fmac_f32 v244, v26, v162
    v_fmac_f32 v236, v19, v115
    v_fmac_f32 v244, v27, v163
    v_fmac_f32 v236, v20, v116
    v_fmac_f32 v244, v28, v164
    v_fmac_f32 v236, v21, v117
    v_fmac_f32 v244, v29, v165
    v_fmac_f32 v236, v22, v118
    v_fmac_f32 v244, v30, v166
    v_fmac_f32 v236, v23, v119
    v_fmac_f32 v244, v31, v167
    v_mul_f32 v243, v32, v152
    v_fma_f32 v239, v40, v168, -v239
    v_fmac_f32 v243, v33, v153
    v_fmac_f32 v239, v41, v169
    v_fmac_f32 v243, v34, v154
    v_fmac_f32 v239, v42, v170
    v_fmac_f32 v243, v35, v155
    v_fmac_f32 v239, v43, v171
    v_fmac_f32 v243, v36, v156
    v_fmac_f32 v239, v44, v172
    v_fmac_f32 v243, v37, v157
    v_fmac_f32 v239, v45, v173
    v_fmac_f32 v243, v38, v158
    v_fmac_f32 v239, v46, v174
    v_fmac_f32 v243, v39, v159
    v_fmac_f32 v239, v47, v175
    v_fmac_f32 v237, v48, v120
    v_mul_f32 v245, v56, v168
    v_fmac_f32 v237, v49, v121
    v_fmac_f32 v245, v57, v169
    v_fmac_f32 v237, v50, v122
    v_fmac_f32 v245, v58, v170
    v_fmac_f32 v237, v51, v123
    s_setprio 1
    s_waitcnt vmcnt(4) lgkmcnt(1)
    v_mfma_f32_32x32x16_bf16 v[0:15], v[64:67], v[176:179], 0
    ds_read_b64_tr_b16 v[184:185], v246 offset:2048
    ds_read_b64_tr_b16 v[186:187], v246 offset:3072
    ds_read_b64_tr_b16 v[188:189], v247 offset:2048
    ds_read_b64_tr_b16 v[190:191], v247 offset:3072
    v_fmac_f32 v245, v59, v171
    v_fmac_f32 v237, v52, v124
    s_mov_b32 m0, s68
    v_mfma_f32_32x32x16_bf16 v[16:31], v[68:71], v[176:179], 0
    buffer_load_dwordx4 v222, s[4:7], s44 offen sc1 lds
    buffer_load_dwordx4 v223, s[72:75], s44 offen offset:1024 sc1 lds
    s_waitcnt lgkmcnt(4)
    v_mad_u32_u16 v224, v224, s39, v248 op_sel:[1,0,0,0]
    v_mad_u32_u16 v225, v225, s39, v248 op_sel:[1,0,0,0]
    v_fmac_f32 v245, v60, v172
    v_fmac_f32 v237, v53, v125
    v_mfma_f32_32x32x16_bf16 v[32:47], v[64:67], v[180:183], 0
    v_add_u32 v226, s50, v251
    ds_read2_b32 v[226:227], v226 offset0:1 offset1:3
    v_fmac_f32 v245, v61, v173
    v_fmac_f32 v237, v54, v126
    v_fmac_f32 v245, v62, v174
    v_fmac_f32 v237, v55, v127
    v_fmac_f32 v245, v63, v175
    v_mfma_f32_32x32x16_bf16 v[48:63], v[68:71], v[180:183], 0
    v_permlane32_swap_b32 v242, v234
    v_permlane32_swap_b32 v243, v235
    v_add_f32 v242, v242, v234
    v_add_f32 v243, v243, v235
    s_waitcnt vmcnt(4) lgkmcnt(1)
    v_mfma_f32_32x32x16_bf16 v[0:15], v[72:75], v[184:187], v[0:15]
    ds_read_b64_tr_b16 v[176:177], v246 offset:4096
    ds_read_b64_tr_b16 v[178:179], v246 offset:5120
    ds_read_b64_tr_b16 v[180:181], v247 offset:4096
    ds_read_b64_tr_b16 v[182:183], v247 offset:5120
    s_mov_b32 m0, s69
    v_mfma_f32_32x32x16_bf16 v[16:31], v[76:79], v[184:187], v[16:31]
    buffer_load_dwordx4 v224, s[4:7], s45 offen sc1 lds
    buffer_load_dwordx4 v225, s[72:75], s45 offen offset:1024 sc1 lds
    s_waitcnt lgkmcnt(4)
    v_mad_u32_u16 v226, v226, s39, v248 op_sel:[1,0,0,0]
    v_mad_u32_u16 v227, v227, s39, v248 op_sel:[1,0,0,0]
    v_mfma_f32_32x32x16_bf16 v[32:47], v[72:75], v[188:191], v[32:47]
    s_set_gpr_idx_on s31, gpr_idx(DST)
    s_nop 0
    v_cvt_pk_bf16_f32 v194, v242, v243
    s_set_gpr_idx_off
    v_mfma_f32_32x32x16_bf16 v[48:63], v[76:79], v[188:191], v[48:63]
    s_waitcnt vmcnt(4) lgkmcnt(0)
    v_mfma_f32_32x32x16_bf16 v[0:15], v[80:83], v[176:179], v[0:15]
    ds_read_b64_tr_b16 v[184:185], v246 offset:6144
    ds_read_b64_tr_b16 v[186:187], v246 offset:7168
    ds_read_b64_tr_b16 v[188:189], v247 offset:6144
    ds_read_b64_tr_b16 v[190:191], v247 offset:7168
    s_mov_b32 s32, s31
    s_mov_b32 s31, s35
    s_mov_b32 m0, s70
    v_mfma_f32_32x32x16_bf16 v[16:31], v[84:87], v[176:179], v[16:31]
    buffer_load_dwordx4 v226, s[4:7], s46 offen sc1 lds
    buffer_load_dwordx4 v227, s[72:75], s46 offen offset:1024 sc1 lds
    s_sub_u32 s26, s48, s29
    s_mov_b32 s29, s48
    s_mov_b32 s30, s3
    s_bfe_u32 s56, s3, 0x40012
    v_mfma_f32_32x32x16_bf16 v[32:47], v[80:83], v[180:183], v[32:47]
    s_cmp_eq_u32 s34, 0
    s_cselect_b32 s56, s56, 0
    v_mfma_f32_32x32x16_bf16 v[48:63], v[84:87], v[180:183], v[48:63]
    s_waitcnt vmcnt(4) lgkmcnt(0)
    v_mfma_f32_32x32x16_bf16 v[0:15], v[88:91], v[184:187], v[0:15]
    ds_read_b64_tr_b16 v[176:177], v246 offset:0
    ds_read_b64_tr_b16 v[178:179], v246 offset:1024
    ds_read_b64_tr_b16 v[180:181], v247 offset:0
    ds_read_b64_tr_b16 v[182:183], v247 offset:1024
    s_mov_b32 m0, s71
    v_mfma_f32_32x32x16_bf16 v[16:31], v[92:95], v[184:187], v[16:31]
    s_cmp_eq_u32 s33, 4
    s_cbranch_scc1 K2_g4_115
    buffer_load_dwordx4 v224, s[4:7], s47 offen sc1 lds
    buffer_load_dwordx4 v225, s[72:75], s47 offen offset:1024 sc1 lds
K2_back_116:
    v_mfma_f32_32x32x16_bf16 v[32:47], v[88:91], v[188:191], v[32:47]
    s_nop 0
    v_mul_f32 v242, v0, v144
    v_fma_f32 v240, v8, v160, -v240
    v_fmac_f32 v242, v1, v145
    v_fmac_f32 v240, v9, v161
    v_fmac_f32 v242, v2, v146
    v_fmac_f32 v240, v10, v162
    v_fmac_f32 v242, v3, v147
    v_mfma_f32_32x32x16_bf16 v[48:63], v[92:95], v[188:191], v[48:63]
    s_setprio 0
    v_fmac_f32 v240, v11, v163
    v_fmac_f32 v242, v4, v148
    v_fmac_f32 v240, v12, v164
    v_fmac_f32 v242, v5, v149
    v_fmac_f32 v240, v13, v165
    v_fmac_f32 v242, v6, v150
    v_fmac_f32 v240, v14, v166
    v_fmac_f32 v242, v7, v151
    v_fmac_f32 v240, v15, v167
    v_add_u32 v249, s26, v249
    v_add_u32 v250, s26, v250
    v_fma_f32 v244, v16, v160, -v244
    v_fmac_f32 v236, v24, v112
    v_fmac_f32 v244, v17, v161
    v_fmac_f32 v236, v25, v113
    v_fmac_f32 v244, v18, v162
    v_fmac_f32 v236, v26, v114
    v_fmac_f32 v244, v19, v163
    v_fmac_f32 v236, v27, v115
    v_fmac_f32 v244, v20, v164
    v_fmac_f32 v236, v28, v116
    v_fmac_f32 v244, v21, v165
    v_fmac_f32 v236, v29, v117
    v_fmac_f32 v244, v22, v166
    v_fmac_f32 v236, v30, v118
    v_fmac_f32 v244, v23, v167
    v_fmac_f32 v236, v31, v119
    ds_read_b64_tr_b16 v[0:1], v249 offset:0
    ds_read_b64_tr_b16 v[2:3], v249 offset:32
    ds_read_u16_d16_hi v16, v250 offset:0
    v_mul_f32 v243, v32, v152
    v_fma_f32 v241, v40, v168, -v241
    v_fmac_f32 v243, v33, v153
    v_fmac_f32 v241, v41, v169
    v_fmac_f32 v243, v34, v154
    v_fmac_f32 v241, v42, v170
    v_fmac_f32 v243, v35, v155
    v_fmac_f32 v241, v43, v171
    v_fmac_f32 v243, v36, v156
    v_fmac_f32 v241, v44, v172
    v_fmac_f32 v243, v37, v157
    v_fmac_f32 v241, v45, v173
    v_fmac_f32 v243, v38, v158
    v_fmac_f32 v241, v46, v174
    v_fmac_f32 v243, v39, v159
    v_fmac_f32 v241, v47, v175
    ds_read_b64_tr_b16 v[4:5], v249 offset:512
    ds_read_b64_tr_b16 v[6:7], v249 offset:544
    ds_read_u16_d16_hi v17, v250 offset:128
    v_fma_f32 v245, v48, v168, -v245
    v_fmac_f32 v237, v56, v120
    v_fmac_f32 v245, v49, v169
    v_fmac_f32 v237, v57, v121
    v_fmac_f32 v245, v50, v170
    v_fmac_f32 v237, v58, v122
    v_fmac_f32 v245, v51, v171
    v_fmac_f32 v237, v59, v123
    v_fmac_f32 v245, v52, v172
    v_fmac_f32 v237, v60, v124
    v_fmac_f32 v245, v53, v173
    v_fmac_f32 v237, v61, v125
    v_fmac_f32 v245, v54, v174
    v_fmac_f32 v237, v62, v126
    v_fmac_f32 v245, v55, v175
    v_fmac_f32 v237, v63, v127
    s_cmp_eq_u32 s56, 5
    s_cbranch_scc1 K2_U20
    s_cmp_eq_u32 s56, 6
    s_cbranch_scc1 K2_U3h0
    s_branch K2_DSP0
K2_U11:
    s_setprio 1
    s_mov_b64 exec, 0x3ff
    ds_add_rtn_u32 v232, v254, v255
    s_mov_b64 exec, -1
    s_waitcnt lgkmcnt(4)
    v_lshlrev_b32 v20, 16, v0
    v_and_b32 v21, 0xffff0000, v0
    v_lshlrev_b32 v22, 16, v1
    v_and_b32 v23, 0xffff0000, v1
    v_lshlrev_b32 v24, 16, v2
    v_and_b32 v25, 0xffff0000, v2
    v_lshlrev_b32 v26, 16, v3
    v_and_b32 v27, 0xffff0000, v3
    v_mul_f32_dpp v36, v16, v20 row_newbcast:8 row_mask:0xf bank_mask:0xf
    v_mul_f32_dpp v37, v16, v21 row_newbcast:9 row_mask:0xf bank_mask:0xf
    v_mul_f32_dpp v38, v16, v22 row_newbcast:10 row_mask:0xf bank_mask:0xf
    v_mul_f32_dpp v39, v16, v23 row_newbcast:11 row_mask:0xf bank_mask:0xf
    v_mul_f32_dpp v40, v16, v24 row_newbcast:12 row_mask:0xf bank_mask:0xf
    v_mul_f32_dpp v41, v16, v25 row_newbcast:13 row_mask:0xf bank_mask:0xf
    v_mul_f32_dpp v42, v16, v26 row_newbcast:14 row_mask:0xf bank_mask:0xf
    v_mul_f32_dpp v43, v16, v27 row_newbcast:15 row_mask:0xf bank_mask:0xf
    v_cvt_pk_bf16_f32 v68, v36, v37
    v_cvt_pk_bf16_f32 v69, v38, v39
    v_cvt_pk_bf16_f32 v70, v40, v41
    v_cvt_pk_bf16_f32 v71, v42, v43
    v_mul_f32_dpp v20, v16, v20 row_newbcast:0 row_mask:0xa bank_mask:0xf
    v_mul_f32_dpp v21, v16, v21 row_newbcast:1 row_mask:0xa bank_mask:0xf
    v_mul_f32_dpp v22, v16, v22 row_newbcast:2 row_mask:0xa bank_mask:0xf
    v_mul_f32_dpp v23, v16, v23 row_newbcast:3 row_mask:0xa bank_mask:0xf
    v_mul_f32_dpp v24, v16, v24 row_newbcast:4 row_mask:0xa bank_mask:0xf
    v_mul_f32_dpp v25, v16, v25 row_newbcast:5 row_mask:0xa bank_mask:0xf
    v_mul_f32_dpp v26, v16, v26 row_newbcast:6 row_mask:0xa bank_mask:0xf
    v_mul_f32_dpp v27, v16, v27 row_newbcast:7 row_mask:0xa bank_mask:0xf
    v_cvt_pk_bf16_f32 v64, v20, v21
    v_cvt_pk_bf16_f32 v65, v22, v23
    v_cvt_pk_bf16_f32 v66, v24, v25
    v_cvt_pk_bf16_f32 v67, v26, v27
    s_waitcnt lgkmcnt(0)
    v_readlane_b32 s58, v232, 8
    s_nop 0
    s_cmp_lt_u32 s58, s22
    s_cbranch_scc0 K2_nul_121
    s_nop 0
    v_readlane_b32 s3, v253, s58
    s_nop 0
    s_bfe_u32 s58, s3, 0x60016
    s_and_b32 s59, s58, 7
    s_lshr_b32 s60, s58, 3
K2_chk_123:
    v_readlane_b32 s61, v232, s59
    s_nop 0
    s_cmp_gt_u32 s61, s60
    s_cbranch_scc0 K2_spin_122
K2_back_124:
    s_lshl_b32 s44, s34, 7
    s_and_b32 s48, s3, 0x3ffff
    s_bfe_u32 s33, s3, 0x30013
    s_mov_b32 s35, s48
    s_mov_b32 s45, s44
    s_xor_b32 s47, s44, 256
    s_add_u32 s49, s48, 128
    s_add_u32 s60, s48, 256
    s_cmp_eq_u32 s33, 3
    s_cselect_b32 s46, s44, s47
    s_cselect_b32 s50, s60, s48
    s_sub_u32 s60, s33, 2
    s_cmp_lt_u32 s60, 2
    s_cbranch_scc0 K2_rare_125
K2_back_126:
    v_add_u32 v222, s48, v251
    ds_read2_b32 v[222:223], v222 offset0:1 offset1:3
    v_add_u32 v224, s49, v251
    ds_read2_b32 v[224:225], v224 offset0:1 offset1:3
    v_add_u32 v226, s50, v251
    ds_read2_b32 v[226:227], v226 offset0:1 offset1:3
    s_waitcnt lgkmcnt(2)
    v_mad_u32_u16 v222, v222, s39, v248 op_sel:[1,0,0,0]
    v_mad_u32_u16 v223, v223, s39, v248 op_sel:[1,0,0,0]
    s_waitcnt lgkmcnt(1)
    v_mad_u32_u16 v224, v224, s39, v248 op_sel:[1,0,0,0]
    v_mad_u32_u16 v225, v225, s39, v248 op_sel:[1,0,0,0]
    s_waitcnt lgkmcnt(0)
    v_mad_u32_u16 v226, v226, s39, v248 op_sel:[1,0,0,0]
    v_mad_u32_u16 v227, v227, s39, v248 op_sel:[1,0,0,0]
    s_waitcnt vmcnt(4)
    v_mfma_f32_32x32x16_bf16 v[0:15], v[64:67], v[176:179], 0
    ds_read_b64_tr_b16 v[184:185], v246 offset:2048
    ds_read_b64_tr_b16 v[186:187], v246 offset:3072
    ds_read_b64_tr_b16 v[188:189], v247 offset:2048
    ds_read_b64_tr_b16 v[190:191], v247 offset:3072
    s_mov_b32 m0, s68
    v_mfma_f32_32x32x16_bf16 v[16:31], v[68:71], v[176:179], 0
    buffer_load_dwordx4 v222, s[4:7], s44 offen sc1 lds
    buffer_load_dwordx4 v223, s[72:75], s44 offen offset:1024 sc1 lds
    v_permlane32_swap_b32 v242, v236
    v_permlane32_swap_b32 v243, v237
    v_mfma_f32_32x32x16_bf16 v[32:47], v[64:67], v[180:183], 0
    v_permlane32_swap_b32 v244, v238
    v_permlane32_swap_b32 v245, v239
    v_permlane32_swap_b32 v240, v241
    v_add_f32 v242, v242, v236
    v_mfma_f32_32x32x16_bf16 v[48:63], v[68:71], v[180:183], 0
    s_setprio 0
    v_add_f32 v243, v243, v237
    v_add_f32 v244, v244, v238
    v_add_f32 v245, v245, v239
    v_add_f32 v240, -v240, -v241
    v_sub_u32 v241, v230, v231
    v_cvt_pk_bf16_f32 v242, v242, v243
    v_cvt_pk_bf16_f32 v244, v244, v245
    v_cvt_pk_bf16_f32 v240, v240, v240
    ds_write2st64_b32 v230, v242, v244 offset0:3 offset1:4
    ds_write_b16 v241, v240 offset:1280
    v_mul_f32 v234, v0, v96
    v_mul_f32 v236, v8, v128
    v_fmac_f32 v234, v1, v97
    v_fmac_f32 v236, v9, v129
    v_fmac_f32 v234, v2, v98
    v_fmac_f32 v236, v10, v130
    v_fmac_f32 v234, v3, v99
    v_fmac_f32 v236, v11, v131
    v_fmac_f32 v234, v4, v100
    v_fmac_f32 v236, v12, v132
    v_fmac_f32 v234, v5, v101
    v_fmac_f32 v236, v13, v133
    v_fmac_f32 v234, v6, v102
    v_fmac_f32 v236, v14, v134
    v_fmac_f32 v234, v7, v103
    v_fmac_f32 v236, v15, v135
    v_mul_f32 v238, v16, v128
    v_mul_f32 v240, v24, v128
    v_fmac_f32 v238, v17, v129
    v_fmac_f32 v240, v25, v129
    v_fmac_f32 v238, v18, v130
    v_fmac_f32 v240, v26, v130
    v_fmac_f32 v238, v19, v131
    v_fmac_f32 v240, v27, v131
    v_fmac_f32 v238, v20, v132
    v_fmac_f32 v240, v28, v132
    v_fmac_f32 v238, v21, v133
    v_fmac_f32 v240, v29, v133
    v_fmac_f32 v238, v22, v134
    v_fmac_f32 v240, v30, v134
    v_fmac_f32 v238, v23, v135
    v_fmac_f32 v240, v31, v135
    v_mul_f32 v235, v32, v104
    v_mul_f32 v237, v40, v136
    v_fmac_f32 v235, v33, v105
    v_fmac_f32 v237, v41, v137
    v_fmac_f32 v235, v34, v106
    v_fmac_f32 v237, v42, v138
    v_fmac_f32 v235, v35, v107
    v_fmac_f32 v237, v43, v139
    v_fmac_f32 v235, v36, v108
    v_fmac_f32 v237, v44, v140
    v_fmac_f32 v235, v37, v109
    v_fmac_f32 v237, v45, v141
    v_fmac_f32 v235, v38, v110
    v_fmac_f32 v237, v46, v142
    v_fmac_f32 v235, v39, v111
    v_fmac_f32 v237, v47, v143
    v_mul_f32 v239, v48, v136
    v_mul_f32 v241, v56, v136
    v_fmac_f32 v239, v49, v137
    v_fmac_f32 v241, v57, v137
    v_fmac_f32 v239, v50, v138
    v_fmac_f32 v241, v58, v138
    v_fmac_f32 v239, v51, v139
    v_fmac_f32 v241, v59, v139
    v_fmac_f32 v239, v52, v140
    v_fmac_f32 v241, v60, v140
    v_fmac_f32 v239, v53, v141
    v_fmac_f32 v241, v61, v141
    v_fmac_f32 v239, v54, v142
    v_fmac_f32 v241, v62, v142
    v_fmac_f32 v239, v55, v143
    v_fmac_f32 v241, v63, v143
    s_setprio 1
    s_waitcnt vmcnt(4) lgkmcnt(2)
    v_mfma_f32_32x32x16_bf16 v[0:15], v[64:67], v[184:187], 0
    ds_read_b64_tr_b16 v[176:177], v246 offset:4096
    ds_read_b64_tr_b16 v[178:179], v246 offset:5120
    ds_read_b64_tr_b16 v[180:181], v247 offset:4096
    ds_read_b64_tr_b16 v[182:183], v247 offset:5120
    s_mov_b32 m0, s69
    v_mfma_f32_32x32x16_bf16 v[16:31], v[68:71], v[184:187], 0
    buffer_load_dwordx4 v224, s[4:7], s45 offen sc1 lds
    buffer_load_dwordx4 v225, s[72:75], s45 offen offset:1024 sc1 lds
    v_permlane32_swap_b32 v234, v236
    v_permlane32_swap_b32 v235, v237
    v_mfma_f32_32x32x16_bf16 v[32:47], v[64:67], v[188:191], 0
    v_permlane32_swap_b32 v240, v238
    v_permlane32_swap_b32 v241, v239
    v_lshl_add_u32 v230, v252, 1, s31
    v_add_f32 v234, v234, v236
    v_add_f32 v235, v235, v237
    v_mfma_f32_32x32x16_bf16 v[48:63], v[68:71], v[188:191], 0
    s_setprio 0
    v_add_f32 v240, v240, v238
    v_add_f32 v241, v241, v239
    v_cvt_pk_bf16_f32 v234, v234, v235
    v_cvt_pk_bf16_f32 v240, v240, v241
    ds_write2st64_b32 v230, v234, v240 offset0:0 offset1:1
    v_mul_f32 v234, v0, v144
    v_mul_f32 v236, v8, v112
    v_fmac_f32 v234, v1, v145
    v_fmac_f32 v236, v9, v113
    v_fmac_f32 v234, v2, v146
    v_fmac_f32 v236, v10, v114
    v_fmac_f32 v234, v3, v147
    v_fmac_f32 v236, v11, v115
    v_fmac_f32 v234, v4, v148
    v_fmac_f32 v236, v12, v116
    v_fmac_f32 v234, v5, v149
    v_fmac_f32 v236, v13, v117
    v_fmac_f32 v234, v6, v150
    v_fmac_f32 v236, v14, v118
    v_fmac_f32 v234, v7, v151
    v_fmac_f32 v236, v15, v119
    v_mul_f32 v238, v16, v160
    v_mul_f32 v240, v24, v160
    v_fmac_f32 v238, v17, v161
    v_fmac_f32 v240, v25, v161
    v_fmac_f32 v238, v18, v162
    v_fmac_f32 v240, v26, v162
    v_fmac_f32 v238, v19, v163
    v_fmac_f32 v240, v27, v163
    v_fmac_f32 v238, v20, v164
    v_fmac_f32 v240, v28, v164
    v_fmac_f32 v238, v21, v165
    v_fmac_f32 v240, v29, v165
    v_fmac_f32 v238, v22, v166
    v_fmac_f32 v240, v30, v166
    v_fmac_f32 v238, v23, v167
    v_fmac_f32 v240, v31, v167
    v_mul_f32 v235, v32, v152
    v_mul_f32 v237, v40, v120
    v_fmac_f32 v235, v33, v153
    v_fmac_f32 v237, v41, v121
    v_fmac_f32 v235, v34, v154
    v_fmac_f32 v237, v42, v122
    v_fmac_f32 v235, v35, v155
    v_fmac_f32 v237, v43, v123
    v_fmac_f32 v235, v36, v156
    v_fmac_f32 v237, v44, v124
    v_fmac_f32 v235, v37, v157
    v_fmac_f32 v237, v45, v125
    v_fmac_f32 v235, v38, v158
    v_fmac_f32 v237, v46, v126
    v_fmac_f32 v235, v39, v159
    v_fmac_f32 v237, v47, v127
    v_mul_f32 v239, v48, v168
    v_mul_f32 v241, v56, v168
    v_fmac_f32 v239, v49, v169
    v_fmac_f32 v241, v57, v169
    v_fmac_f32 v239, v50, v170
    v_fmac_f32 v241, v58, v170
    v_fmac_f32 v239, v51, v171
    v_fmac_f32 v241, v59, v171
    v_fmac_f32 v239, v52, v172
    v_fmac_f32 v241, v60, v172
    v_fmac_f32 v239, v53, v173
    v_fmac_f32 v241, v61, v173
    v_fmac_f32 v239, v54, v174
    v_fmac_f32 v241, v62, v174
    v_fmac_f32 v239, v55, v175
    v_fmac_f32 v241, v63, v175
    s_setprio 1
    s_waitcnt vmcnt(4) lgkmcnt(1)
    v_mfma_f32_32x32x16_bf16 v[0:15], v[64:67], v[176:179], 0
    ds_read_b64_tr_b16 v[184:185], v246 offset:6144
    ds_read_b64_tr_b16 v[186:187], v246 offset:7168
    ds_read_b64_tr_b16 v[188:189], v247 offset:6144
    ds_read_b64_tr_b16 v[190:191], v247 offset:7168
    s_mov_b32 s32, s31
    s_mov_b32 s31, s35
    s_mov_b32 m0, s70
    v_mfma_f32_32x32x16_bf16 v[16:31], v[68:71], v[176:179], 0
    buffer_load_dwordx4 v226, s[4:7], s46 offen sc1 lds
    buffer_load_dwordx4 v227, s[72:75], s46 offen offset:1024 sc1 lds
    s_sub_u32 s26, s48, s29
    s_mov_b32 s29, s48
    s_mov_b32 s30, s3
    s_bfe_u32 s56, s3, 0x40012
    v_mfma_f32_32x32x16_bf16 v[32:47], v[64:67], v[180:183], 0
    s_cmp_lg_u32 s36, 0
    s_cselect_b32 s56, s56, 0
    v_mfma_f32_32x32x16_bf16 v[48:63], v[68:71], v[180:183], 0
    s_setprio 0
    v_mul_f32 v242, v0, v144
    v_fma_f32 v238, v8, v160, -v238
    v_fmac_f32 v242, v1, v145
    v_fmac_f32 v238, v9, v161
    v_fmac_f32 v242, v2, v146
    v_fmac_f32 v238, v10, v162
    v_fmac_f32 v242, v3, v147
    v_fmac_f32 v238, v11, v163
    v_fmac_f32 v242, v4, v148
    v_fmac_f32 v238, v12, v164
    v_fmac_f32 v242, v5, v149
    v_fmac_f32 v238, v13, v165
    v_fmac_f32 v242, v6, v150
    v_fmac_f32 v238, v14, v166
    v_fmac_f32 v242, v7, v151
    v_fmac_f32 v238, v15, v167
    v_fmac_f32 v236, v16, v112
    v_mul_f32 v244, v24, v160
    v_fmac_f32 v236, v17, v113
    v_fmac_f32 v244, v25, v161
    v_fmac_f32 v236, v18, v114
    v_fmac_f32 v244, v26, v162
    v_fmac_f32 v236, v19, v115
    v_fmac_f32 v244, v27, v163
    v_fmac_f32 v236, v20, v116
    v_fmac_f32 v244, v28, v164
    v_fmac_f32 v236, v21, v117
    v_fmac_f32 v244, v29, v165
    v_fmac_f32 v236, v22, v118
    v_fmac_f32 v244, v30, v166
    v_fmac_f32 v236, v23, v119
    v_fmac_f32 v244, v31, v167
    v_mul_f32 v243, v32, v152
    v_fma_f32 v239, v40, v168, -v239
    v_fmac_f32 v243, v33, v153
    v_fmac_f32 v239, v41, v169
    v_fmac_f32 v243, v34, v154
    v_fmac_f32 v239, v42, v170
    v_fmac_f32 v243, v35, v155
    v_fmac_f32 v239, v43, v171
    v_fmac_f32 v243, v36, v156
    v_fmac_f32 v239, v44, v172
    v_fmac_f32 v243, v37, v157
    v_fmac_f32 v239, v45, v173
    v_fmac_f32 v243, v38, v158
    v_fmac_f32 v239, v46, v174
    v_fmac_f32 v243, v39, v159
    v_fmac_f32 v239, v47, v175
    v_fmac_f32 v237, v48, v120
    v_mul_f32 v245, v56, v168
    v_fmac_f32 v237, v49, v121
    v_fmac_f32 v245, v57, v169
    v_fmac_f32 v237, v50, v122
    v_fmac_f32 v245, v58, v170
    v_fmac_f32 v237, v51, v123
    v_fmac_f32 v245, v59, v171
    v_fmac_f32 v237, v52, v124
    v_fmac_f32 v245, v60, v172
    v_fmac_f32 v237, v53, v125
    v_fmac_f32 v245, v61, v173
    v_fmac_f32 v237, v54, v126
    v_fmac_f32 v245, v62, v174
    v_fmac_f32 v237, v55, v127
    v_fmac_f32 v245, v63, v175
    s_setprio 1
    s_waitcnt vmcnt(4) lgkmcnt(0)
    v_mfma_f32_32x32x16_bf16 v[0:15], v[64:67], v[184:187], 0
    ds_read_b64_tr_b16 v[176:177], v246 offset:0
    ds_read_b64_tr_b16 v[178:179], v246 offset:1024
    ds_read_b64_tr_b16 v[180:181], v247 offset:0
    ds_read_b64_tr_b16 v[182:183], v247 offset:1024
    s_mov_b32 m0, s71
    v_mfma_f32_32x32x16_bf16 v[16:31], v[68:71], v[184:187], 0
    s_cmp_eq_u32 s33, 4
    s_cbranch_scc1 K2_g4_128
    buffer_load_dwordx4 v224, s[4:7], s47 offen sc1 lds
    buffer_load_dwordx4 v225, s[72:75], s47 offen offset:1024 sc1 lds
K2_back_129:
    v_permlane32_swap_b32 v242, v234
    v_mfma_f32_32x32x16_bf16 v[32:47], v[64:67], v[188:191], 0
    v_permlane32_swap_b32 v243, v235
    v_add_f32 v242, v242, v234
    v_add_f32 v243, v243, v235
    v_cvt_pk_bf16_f32 v242, v242, v243
    ds_write_b32 v230, v242 offset:512
    v_mfma_f32_32x32x16_bf16 v[48:63], v[68:71], v[188:191], 0
    s_setprio 0
    v_mul_f32 v242, v0, v144
    v_fma_f32 v240, v8, v160, -v240
    v_fmac_f32 v242, v1, v145
    v_fmac_f32 v240, v9, v161
    v_fmac_f32 v242, v2, v146
    v_fmac_f32 v240, v10, v162
    v_fmac_f32 v242, v3, v147
    v_fmac_f32 v240, v11, v163
    v_fmac_f32 v242, v4, v148
    v_fmac_f32 v240, v12, v164
    v_fmac_f32 v242, v5, v149
    v_fmac_f32 v240, v13, v165
    v_fmac_f32 v242, v6, v150
    v_fmac_f32 v240, v14, v166
    v_fmac_f32 v242, v7, v151
    v_fmac_f32 v240, v15, v167
    v_add_u32 v249, s26, v249
    v_add_u32 v250, s26, v250
    v_fma_f32 v244, v16, v160, -v244
    v_fmac_f32 v236, v24, v112
    v_fmac_f32 v244, v17, v161
    v_fmac_f32 v236, v25, v113
    v_fmac_f32 v244, v18, v162
    v_fmac_f32 v236, v26, v114
    v_fmac_f32 v244, v19, v163
    v_fmac_f32 v236, v27, v115
    v_fmac_f32 v244, v20, v164
    v_fmac_f32 v236, v28, v116
    v_fmac_f32 v244, v21, v165
    v_fmac_f32 v236, v29, v117
    v_fmac_f32 v244, v22, v166
    v_fmac_f32 v236, v30, v118
    v_fmac_f32 v244, v23, v167
    v_fmac_f32 v236, v31, v119
    ds_read_b64_tr_b16 v[0:1], v249 offset:0
    ds_read_b64_tr_b16 v[2:3], v249 offset:32
    ds_read_u16_d16_hi v16, v250 offset:0
    v_mul_f32 v243, v32, v152
    v_fma_f32 v241, v40, v168, -v241
    v_fmac_f32 v243, v33, v153
    v_fmac_f32 v241, v41, v169
    v_fmac_f32 v243, v34, v154
    v_fmac_f32 v241, v42, v170
    v_fmac_f32 v243, v35, v155
    v_fmac_f32 v241, v43, v171
    v_fmac_f32 v243, v36, v156
    v_fmac_f32 v241, v44, v172
    v_fmac_f32 v243, v37, v157
    v_fmac_f32 v241, v45, v173
    v_fmac_f32 v243, v38, v158
    v_fmac_f32 v241, v46, v174
    v_fmac_f32 v243, v39, v159
    v_fmac_f32 v241, v47, v175
    ds_read_b64_tr_b16 v[4:5], v249 offset:512
    ds_read_b64_tr_b16 v[6:7], v249 offset:544
    ds_read_u16_d16_hi v17, v250 offset:128
    v_fma_f32 v245, v48, v168, -v245
    v_fmac_f32 v237, v56, v120
    v_fmac_f32 v245, v49, v169
    v_fmac_f32 v237, v57, v121
    v_fmac_f32 v245, v50, v170
    v_fmac_f32 v237, v58, v122
    v_fmac_f32 v245, v51, v171
    v_fmac_f32 v237, v59, v123
    v_fmac_f32 v245, v52, v172
    v_fmac_f32 v237, v60, v124
    v_fmac_f32 v245, v53, v173
    v_fmac_f32 v237, v61, v125
    v_fmac_f32 v245, v54, v174
    v_fmac_f32 v237, v62, v126
    v_fmac_f32 v245, v55, v175
    v_fmac_f32 v237, v63, v127
    s_cmp_eq_u32 s56, 5
    s_cbranch_scc1 K2_U21
    s_cmp_eq_u32 s56, 6
    s_cbranch_scc1 K2_U3h1
    s_branch K2_DSP1
K2_U41:
    s_setprio 1
    ds_read_b64_tr_b16 v[8:9], v249 offset:1024
    ds_read_b64_tr_b16 v[10:11], v249 offset:1056
    ds_read_u16_d16_hi v18, v250 offset:256
    s_lshr_b32 s65, s30, 28
    s_mul_i32 s66, s22, 2080
    s_lshl_b32 s65, s65, 9
    s_add_u32 s65, s65, s66
    s_add_u32 s65, s65, 65536
    s_sub_u32 s65, s65, s29
    s_sub_u32 s65, s65, 512
    v_add_u32 v56, s65, v249
    ds_read_b64_tr_b16 v[12:13], v56 offset:0
    ds_read_b64_tr_b16 v[14:15], v56 offset:32
    ds_read_u16_d16_hi v19, v250 offset:384
    s_waitcnt lgkmcnt(6)
    v_lshlrev_b32 v20, 16, v0
    v_and_b32 v21, 0xffff0000, v0
    v_lshlrev_b32 v22, 16, v1
    v_and_b32 v23, 0xffff0000, v1
    v_lshlrev_b32 v24, 16, v2
    v_and_b32 v25, 0xffff0000, v2
    v_lshlrev_b32 v26, 16, v3
    v_and_b32 v27, 0xffff0000, v3
    v_mul_f32_dpp v36, v16, v20 row_newbcast:8 row_mask:0xf bank_mask:0xf
    v_mul_f32_dpp v37, v16, v21 row_newbcast:9 row_mask:0xf bank_mask:0xf
    v_mul_f32_dpp v38, v16, v22 row_newbcast:10 row_mask:0xf bank_mask:0xf
    v_mul_f32_dpp v39, v16, v23 row_newbcast:11 row_mask:0xf bank_mask:0xf
    v_mul_f32_dpp v40, v16, v24 row_newbcast:12 row_mask:0xf bank_mask:0xf
    v_mul_f32_dpp v41, v16, v25 row_newbcast:13 row_mask:0xf bank_mask:0xf
    v_mul_f32_dpp v42, v16, v26 row_newbcast:14 row_mask:0xf bank_mask:0xf
    v_mul_f32_dpp v43, v16, v27 row_newbcast:15 row_mask:0xf bank_mask:0xf
    v_cvt_pk_bf16_f32 v68, v36, v37
    v_cvt_pk_bf16_f32 v69, v38, v39
    v_cvt_pk_bf16_f32 v70, v40, v41
    v_cvt_pk_bf16_f32 v71, v42, v43
    v_mul_f32_dpp v20, v16, v20 row_newbcast:0 row_mask:0xa bank_mask:0xf
    v_mul_f32_dpp v21, v16, v21 row_newbcast:1 row_mask:0xa bank_mask:0xf
    v_mul_f32_dpp v22, v16, v22 row_newbcast:2 row_mask:0xa bank_mask:0xf
    v_mul_f32_dpp v23, v16, v23 row_newbcast:3 row_mask:0xa bank_mask:0xf
    v_mul_f32_dpp v24, v16, v24 row_newbcast:4 row_mask:0xa bank_mask:0xf
    v_mul_f32_dpp v25, v16, v25 row_newbcast:5 row_mask:0xa bank_mask:0xf
    v_mul_f32_dpp v26, v16, v26 row_newbcast:6 row_mask:0xa bank_mask:0xf
    v_mul_f32_dpp v27, v16, v27 row_newbcast:7 row_mask:0xa bank_mask:0xf
    v_cvt_pk_bf16_f32 v64, v20, v21
    v_cvt_pk_bf16_f32 v65, v22, v23
    v_cvt_pk_bf16_f32 v66, v24, v25
    v_cvt_pk_bf16_f32 v67, v26, v27
    v_lshlrev_b32 v28, 16, v4
    v_and_b32 v29, 0xffff0000, v4
    v_lshlrev_b32 v30, 16, v5
    v_and_b32 v31, 0xffff0000, v5
    v_lshlrev_b32 v32, 16, v6
    v_and_b32 v33, 0xffff0000, v6
    v_lshlrev_b32 v34, 16, v7
    v_and_b32 v35, 0xffff0000, v7
    v_mul_f32_dpp v36, v17, v28 row_newbcast:8 row_mask:0xf bank_mask:0xf
    v_mul_f32_dpp v37, v17, v29 row_newbcast:9 row_mask:0xf bank_mask:0xf
    v_mul_f32_dpp v38, v17, v30 row_newbcast:10 row_mask:0xf bank_mask:0xf
    v_mul_f32_dpp v39, v17, v31 row_newbcast:11 row_mask:0xf bank_mask:0xf
    v_mul_f32_dpp v40, v17, v32 row_newbcast:12 row_mask:0xf bank_mask:0xf
    v_mul_f32_dpp v41, v17, v33 row_newbcast:13 row_mask:0xf bank_mask:0xf
    v_mul_f32_dpp v42, v17, v34 row_newbcast:14 row_mask:0xf bank_mask:0xf
    v_mul_f32_dpp v43, v17, v35 row_newbcast:15 row_mask:0xf bank_mask:0xf
    v_cvt_pk_bf16_f32 v76, v36, v37
    v_cvt_pk_bf16_f32 v77, v38, v39
    v_cvt_pk_bf16_f32 v78, v40, v41
    v_cvt_pk_bf16_f32 v79, v42, v43
    v_mul_f32_dpp v28, v17, v28 row_newbcast:0 row_mask:0xa bank_mask:0xf
    v_mul_f32_dpp v29, v17, v29 row_newbcast:1 row_mask:0xa bank_mask:0xf
    v_mul_f32_dpp v30, v17, v30 row_newbcast:2 row_mask:0xa bank_mask:0xf
    v_mul_f32_dpp v31, v17, v31 row_newbcast:3 row_mask:0xa bank_mask:0xf
    v_mul_f32_dpp v32, v17, v32 row_newbcast:4 row_mask:0xa bank_mask:0xf
    v_mul_f32_dpp v33, v17, v33 row_newbcast:5 row_mask:0xa bank_mask:0xf
    v_mul_f32_dpp v34, v17, v34 row_newbcast:6 row_mask:0xa bank_mask:0xf
    v_mul_f32_dpp v35, v17, v35 row_newbcast:7 row_mask:0xa bank_mask:0xf
    v_cvt_pk_bf16_f32 v72, v28, v29
    v_cvt_pk_bf16_f32 v73, v30, v31
    v_cvt_pk_bf16_f32 v74, v32, v33
    v_cvt_pk_bf16_f32 v75, v34, v35
    s_waitcnt lgkmcnt(3)
    v_lshlrev_b32 v20, 16, v8
    v_and_b32 v21, 0xffff0000, v8
    v_lshlrev_b32 v22, 16, v9
    v_and_b32 v23, 0xffff0000, v9
    v_lshlrev_b32 v24, 16, v10
    v_and_b32 v25, 0xffff0000, v10
    v_lshlrev_b32 v26, 16, v11
    v_and_b32 v27, 0xffff0000, v11
    v_mul_f32_dpp v36, v18, v20 row_newbcast:8 row_mask:0xf bank_mask:0xf
    v_mul_f32_dpp v37, v18, v21 row_newbcast:9 row_mask:0xf bank_mask:0xf
    v_mul_f32_dpp v38, v18, v22 row_newbcast:10 row_mask:0xf bank_mask:0xf
    v_mul_f32_dpp v39, v18, v23 row_newbcast:11 row_mask:0xf bank_mask:0xf
    v_mul_f32_dpp v40, v18, v24 row_newbcast:12 row_mask:0xf bank_mask:0xf
    v_mul_f32_dpp v41, v18, v25 row_newbcast:13 row_mask:0xf bank_mask:0xf
    v_mul_f32_dpp v42, v18, v26 row_newbcast:14 row_mask:0xf bank_mask:0xf
    v_mul_f32_dpp v43, v18, v27 row_newbcast:15 row_mask:0xf bank_mask:0xf
    v_cvt_pk_bf16_f32 v84, v36, v37
    v_cvt_pk_bf16_f32 v85, v38, v39
    v_cvt_pk_bf16_f32 v86, v40, v41
    v_cvt_pk_bf16_f32 v87, v42, v43
    v_mul_f32_dpp v20, v18, v20 row_newbcast:0 row_mask:0xa bank_mask:0xf
    v_mul_f32_dpp v21, v18, v21 row_newbcast:1 row_mask:0xa bank_mask:0xf
    v_mul_f32_dpp v22, v18, v22 row_newbcast:2 row_mask:0xa bank_mask:0xf
    v_mul_f32_dpp v23, v18, v23 row_newbcast:3 row_mask:0xa bank_mask:0xf
    v_mul_f32_dpp v24, v18, v24 row_newbcast:4 row_mask:0xa bank_mask:0xf
    v_mul_f32_dpp v25, v18, v25 row_newbcast:5 row_mask:0xa bank_mask:0xf
    v_mul_f32_dpp v26, v18, v26 row_newbcast:6 row_mask:0xa bank_mask:0xf
    v_mul_f32_dpp v27, v18, v27 row_newbcast:7 row_mask:0xa bank_mask:0xf
    v_cvt_pk_bf16_f32 v80, v20, v21
    v_cvt_pk_bf16_f32 v81, v22, v23
    v_cvt_pk_bf16_f32 v82, v24, v25
    v_cvt_pk_bf16_f32 v83, v26, v27
    s_waitcnt lgkmcnt(0)
    v_lshlrev_b32 v28, 16, v12
    v_and_b32 v29, 0xffff0000, v12
    v_lshlrev_b32 v30, 16, v13
    v_and_b32 v31, 0xffff0000, v13
    v_lshlrev_b32 v32, 16, v14
    v_and_b32 v33, 0xffff0000, v14
    v_lshlrev_b32 v34, 16, v15
    v_and_b32 v35, 0xffff0000, v15
    v_mul_f32_dpp v36, v19, v28 row_newbcast:8 row_mask:0xf bank_mask:0xf
    v_mul_f32_dpp v37, v19, v29 row_newbcast:9 row_mask:0xf bank_mask:0xf
    v_mul_f32_dpp v38, v19, v30 row_newbcast:10 row_mask:0xf bank_mask:0xf
    v_mul_f32_dpp v39, v19, v31 row_newbcast:11 row_mask:0xf bank_mask:0xf
    v_mul_f32_dpp v40, v19, v32 row_newbcast:12 row_mask:0xf bank_mask:0xf
    v_mul_f32_dpp v41, v19, v33 row_newbcast:13 row_mask:0xf bank_mask:0xf
    v_mul_f32_dpp v42, v19, v34 row_newbcast:14 row_mask:0xf bank_mask:0xf
    v_mul_f32_dpp v43, v19, v35 row_newbcast:15 row_mask:0xf bank_mask:0xf
    v_cvt_pk_bf16_f32 v92, v36, v37
    v_cvt_pk_bf16_f32 v93, v38, v39
    v_cvt_pk_bf16_f32 v94, v40, v41
    v_cvt_pk_bf16_f32 v95, v42, v43
    v_mul_f32_dpp v28, v19, v28 row_newbcast:0 row_mask:0xa bank_mask:0xf
    v_mul_f32_dpp v29, v19, v29 row_newbcast:1 row_mask:0xa bank_mask:0xf
    v_mul_f32_dpp v30, v19, v30 row_newbcast:2 row_mask:0xa bank_mask:0xf
    v_mul_f32_dpp v31, v19, v31 row_newbcast:3 row_mask:0xa bank_mask:0xf
    v_mul_f32_dpp v32, v19, v32 row_newbcast:4 row_mask:0xa bank_mask:0xf
    v_mul_f32_dpp v33, v19, v33 row_newbcast:5 row_mask:0xa bank_mask:0xf
    v_mul_f32_dpp v34, v19, v34 row_newbcast:6 row_mask:0xa bank_mask:0xf
    v_mul_f32_dpp v35, v19, v35 row_newbcast:7 row_mask:0xa bank_mask:0xf
    v_cvt_pk_bf16_f32 v88, v28, v29
    v_cvt_pk_bf16_f32 v89, v30, v31
    v_cvt_pk_bf16_f32 v90, v32, v33
    v_cvt_pk_bf16_f32 v91, v34, v35
    s_waitcnt vmcnt(4)
    v_mfma_f32_32x32x16_bf16 v[0:15], v[64:67], v[176:179], 0
    ds_read_b64_tr_b16 v[184:185], v246 offset:2048
    ds_read_b64_tr_b16 v[186:187], v246 offset:3072
    ds_read_b64_tr_b16 v[188:189], v247 offset:2048
    ds_read_b64_tr_b16 v[190:191], v247 offset:3072
    s_mov_b32 m0, s68
    v_mfma_f32_32x32x16_bf16 v[16:31], v[68:71], v[176:179], 0
    buffer_load_dwordx4 v222, s[4:7], s41 offen sc1 lds
    buffer_load_dwordx4 v223, s[72:75], s41 offen offset:1024 sc1 lds
    v_permlane32_swap_b32 v242, v236
    v_permlane32_swap_b32 v243, v237
    v_mfma_f32_32x32x16_bf16 v[32:47], v[64:67], v[180:183], 0
    v_permlane32_swap_b32 v244, v238
    v_permlane32_swap_b32 v245, v239
    v_permlane32_swap_b32 v240, v241
    v_add_f32 v242, v242, v236
    v_mfma_f32_32x32x16_bf16 v[48:63], v[68:71], v[180:183], 0
    v_add_f32 v243, v243, v237
    v_add_f32 v244, v244, v238
    v_add_f32 v245, v245, v239
    v_add_f32 v240, -v240, -v241
    v_sub_u32 v241, v230, v231
    v_cvt_pk_bf16_f32 v242, v242, v243
    s_mov_b64 exec, 0x3ff
    ds_add_rtn_u32 v232, v254, v255
    s_mov_b64 exec, -1
    s_waitcnt vmcnt(4) lgkmcnt(1)
    v_mfma_f32_32x32x16_bf16 v[0:15], v[72:75], v[184:187], v[0:15]
    ds_read_b64_tr_b16 v[176:177], v246 offset:4096
    ds_read_b64_tr_b16 v[178:179], v246 offset:5120
    ds_read_b64_tr_b16 v[180:181], v247 offset:4096
    ds_read_b64_tr_b16 v[182:183], v247 offset:5120
    v_cvt_pk_bf16_f32 v244, v244, v245
    v_cvt_pk_bf16_f32 v240, v240, v240
    s_mov_b32 m0, s69
    v_mfma_f32_32x32x16_bf16 v[16:31], v[76:79], v[184:187], v[16:31]
    buffer_load_dwordx4 v224, s[4:7], s41 offen sc1 lds
    buffer_load_dwordx4 v225, s[72:75], s41 offen offset:1024 sc1 lds
    ds_write2st64_b32 v230, v242, v244 offset0:3 offset1:4
    ds_write_b16 v241, v240 offset:1280
    s_waitcnt lgkmcnt(6)
    v_readlane_b32 s58, v232, 8
    v_mfma_f32_32x32x16_bf16 v[32:47], v[72:75], v[188:191], v[32:47]
    s_cmp_lt_u32 s58, s22
    s_cbranch_scc0 K2_nul_130
    s_nop 0
    v_readlane_b32 s3, v253, s58
    s_nop 0
    s_bfe_u32 s58, s3, 0x60016
    s_and_b32 s59, s58, 7
    s_lshr_b32 s60, s58, 3
K2_chk_132:
    v_readlane_b32 s61, v232, s59
    s_nop 0
    s_cmp_gt_u32 s61, s60
    s_cbranch_scc0 K2_spin_131
K2_back_133:
    v_mfma_f32_32x32x16_bf16 v[48:63], v[76:79], v[188:191], v[48:63]
    s_lshl_b32 s44, s34, 7
    s_and_b32 s48, s3, 0x3ffff
    s_bfe_u32 s33, s3, 0x30013
    s_mov_b32 s35, s48
    s_mov_b32 s45, s44
    s_xor_b32 s47, s44, 256
    s_waitcnt vmcnt(4) lgkmcnt(2)
    v_mfma_f32_32x32x16_bf16 v[0:15], v[80:83], v[176:179], v[0:15]
    ds_read_b64_tr_b16 v[184:185], v246 offset:6144
    ds_read_b64_tr_b16 v[186:187], v246 offset:7168
    ds_read_b64_tr_b16 v[188:189], v247 offset:6144
    ds_read_b64_tr_b16 v[190:191], v247 offset:7168
    s_add_u32 s49, s48, 128
    s_add_u32 s60, s48, 256
    s_mov_b32 m0, s70
    v_mfma_f32_32x32x16_bf16 v[16:31], v[84:87], v[176:179], v[16:31]
    buffer_load_dwordx4 v226, s[4:7], s41 offen sc1 lds
    buffer_load_dwordx4 v227, s[72:75], s41 offen offset:1024 sc1 lds
    s_cmp_eq_u32 s33, 3
    s_cselect_b32 s46, s44, s47
    s_cselect_b32 s50, s60, s48
    v_mfma_f32_32x32x16_bf16 v[32:47], v[80:83], v[180:183], v[32:47]
    s_sub_u32 s60, s33, 2
    s_cmp_lt_u32 s60, 2
    s_cbranch_scc0 K2_rare_134
K2_back_135:
    v_mfma_f32_32x32x16_bf16 v[48:63], v[84:87], v[180:183], v[48:63]
    s_waitcnt vmcnt(4) lgkmcnt(0)
    v_mfma_f32_32x32x16_bf16 v[0:15], v[88:91], v[184:187], v[0:15]
    ds_read_b64_tr_b16 v[176:177], v246 offset:0
    ds_read_b64_tr_b16 v[178:179], v246 offset:1024
    ds_read_b64_tr_b16 v[180:181], v247 offset:0
    ds_read_b64_tr_b16 v[182:183], v247 offset:1024
    s_mov_b32 m0, s71
    v_mfma_f32_32x32x16_bf16 v[16:31], v[92:95], v[184:187], v[16:31]
    buffer_load_dwordx4 v228, s[4:7], s41 offen sc1 lds
    buffer_load_dwordx4 v229, s[72:75], s41 offen offset:1024 sc1 lds
    v_mfma_f32_32x32x16_bf16 v[32:47], v[88:91], v[188:191], v[32:47]
    s_nop 2
    v_mul_f32 v234, v0, v96
    v_mul_f32 v236, v8, v128
    v_fmac_f32 v234, v1, v97
    v_fmac_f32 v236, v9, v129
    v_fmac_f32 v234, v2, v98
    v_fmac_f32 v236, v10, v130
    v_fmac_f32 v234, v3, v99
    v_mfma_f32_32x32x16_bf16 v[48:63], v[92:95], v[188:191], v[48:63]
    s_setprio 0
    v_fmac_f32 v236, v11, v131
    v_fmac_f32 v234, v4, v100
    v_fmac_f32 v236, v12, v132
    v_fmac_f32 v234, v5, v101
    v_fmac_f32 v236, v13, v133
    v_fmac_f32 v234, v6, v102
    v_fmac_f32 v236, v14, v134
    v_fmac_f32 v234, v7, v103
    v_fmac_f32 v236, v15, v135
    v_mul_f32 v238, v16, v128
    v_mul_f32 v240, v24, v128
    v_fmac_f32 v238, v17, v129
    v_fmac_f32 v240, v25, v129
    v_fmac_f32 v238, v18, v130
    v_fmac_f32 v240, v26, v130
    v_fmac_f32 v238, v19, v131
    v_fmac_f32 v240, v27, v131
    v_fmac_f32 v238, v20, v132
    v_fmac_f32 v240, v28, v132
    v_fmac_f32 v238, v21, v133
    v_fmac_f32 v240, v29, v133
    v_fmac_f32 v238, v22, v134
    v_fmac_f32 v240, v30, v134
    v_fmac_f32 v238, v23, v135
    v_fmac_f32 v240, v31, v135
    v_mul_f32 v235, v32, v104
    v_mul_f32 v237, v40, v136
    v_fmac_f32 v235, v33, v105
    v_fmac_f32 v237, v41, v137
    v_fmac_f32 v235, v34, v106
    v_fmac_f32 v237, v42, v138
    v_fmac_f32 v235, v35, v107
    v_fmac_f32 v237, v43, v139
    v_fmac_f32 v235, v36, v108
    v_fmac_f32 v237, v44, v140
    v_fmac_f32 v235, v37, v109
    v_fmac_f32 v237, v45, v141
    v_fmac_f32 v235, v38, v110
    v_fmac_f32 v237, v46, v142
    v_fmac_f32 v235, v39, v111
    v_fmac_f32 v237, v47, v143
    v_mul_f32 v239, v48, v136
    v_mul_f32 v241, v56, v136
    s_setprio 1
    s_waitcnt vmcnt(4) lgkmcnt(0)
    v_mfma_f32_32x32x16_bf16 v[0:15], v[64:67], v[176:179], 0
    ds_read_b64_tr_b16 v[184:185], v246 offset:2048
    ds_read_b64_tr_b16 v[186:187], v246 offset:3072
    ds_read_b64_tr_b16 v[188:189], v247 offset:2048
    ds_read_b64_tr_b16 v[190:191], v247 offset:3072
    v_fmac_f32 v239, v49, v137
    v_fmac_f32 v241, v57, v137
    s_mov_b32 m0, s68
    v_mfma_f32_32x32x16_bf16 v[16:31], v[68:71], v[176:179], 0
    buffer_load_dwordx4 v222, s[4:7], s42 offen sc1 lds
    buffer_load_dwordx4 v223, s[72:75], s42 offen offset:1024 sc1 lds
    v_fmac_f32 v239, v50, v138
    v_fmac_f32 v241, v58, v138
    v_fmac_f32 v239, v51, v139
    v_fmac_f32 v241, v59, v139
    v_fmac_f32 v239, v52, v140
    v_mfma_f32_32x32x16_bf16 v[32:47], v[64:67], v[180:183], 0
    v_fmac_f32 v241, v60, v140
    v_fmac_f32 v239, v53, v141
    v_fmac_f32 v241, v61, v141
    v_fmac_f32 v239, v54, v142
    v_fmac_f32 v241, v62, v142
    v_fmac_f32 v239, v55, v143
    v_fmac_f32 v241, v63, v143
    v_mfma_f32_32x32x16_bf16 v[48:63], v[68:71], v[180:183], 0
    v_permlane32_swap_b32 v234, v236
    v_permlane32_swap_b32 v235, v237
    v_permlane32_swap_b32 v240, v238
    s_waitcnt vmcnt(4) lgkmcnt(0)
    v_mfma_f32_32x32x16_bf16 v[0:15], v[72:75], v[184:187], v[0:15]
    ds_read_b64_tr_b16 v[176:177], v246 offset:4096
    ds_read_b64_tr_b16 v[178:179], v246 offset:5120
    ds_read_b64_tr_b16 v[180:181], v247 offset:4096
    ds_read_b64_tr_b16 v[182:183], v247 offset:5120
    v_permlane32_swap_b32 v241, v239
    s_mov_b32 m0, s69
    v_mfma_f32_32x32x16_bf16 v[16:31], v[76:79], v[184:187], v[16:31]
    buffer_load_dwordx4 v224, s[4:7], s42 offen sc1 lds
    buffer_load_dwordx4 v225, s[72:75], s42 offen offset:1024 sc1 lds
    v_lshl_add_u32 v230, v252, 1, s31
    v_add_f32 v234, v234, v236
    v_add_f32 v235, v235, v237
    v_add_f32 v240, v240, v238
    v_add_f32 v241, v241, v239
    v_mfma_f32_32x32x16_bf16 v[32:47], v[72:75], v[188:191], v[32:47]
    v_cvt_pk_bf16_f32 v234, v234, v235
    v_cvt_pk_bf16_f32 v240, v240, v241
    ds_write2st64_b32 v230, v234, v240 offset0:0 offset1:1
    v_mfma_f32_32x32x16_bf16 v[48:63], v[76:79], v[188:191], v[48:63]
    s_waitcnt vmcnt(4) lgkmcnt(1)
    v_mfma_f32_32x32x16_bf16 v[0:15], v[80:83], v[176:179], v[0:15]
    ds_read_b64_tr_b16 v[184:185], v246 offset:6144
    ds_read_b64_tr_b16 v[186:187], v246 offset:7168
    ds_read_b64_tr_b16 v[188:189], v247 offset:6144
    ds_read_b64_tr_b16 v[190:191], v247 offset:7168
    s_mov_b32 m0, s70
    v_mfma_f32_32x32x16_bf16 v[16:31], v[84:87], v[176:179], v[16:31]
    buffer_load_dwordx4 v226, s[4:7], s42 offen sc1 lds
    buffer_load_dwordx4 v227, s[72:75], s42 offen offset:1024 sc1 lds
    v_mfma_f32_32x32x16_bf16 v[32:47], v[80:83], v[180:183], v[32:47]
    v_mfma_f32_32x32x16_bf16 v[48:63], v[84:87], v[180:183], v[48:63]
    s_waitcnt vmcnt(4) lgkmcnt(0)
    v_mfma_f32_32x32x16_bf16 v[0:15], v[88:91], v[184:187], v[0:15]
    ds_read_b64_tr_b16 v[176:177], v246 offset:0
    ds_read_b64_tr_b16 v[178:179], v246 offset:1024
    ds_read_b64_tr_b16 v[180:181], v247 offset:0
    ds_read_b64_tr_b16 v[182:183], v247 offset:1024
    s_mov_b32 m0, s71
    v_mfma_f32_32x32x16_bf16 v[16:31], v[92:95], v[184:187], v[16:31]
    buffer_load_dwordx4 v228, s[4:7], s42 offen sc1 lds
    buffer_load_dwordx4 v229, s[72:75], s42 offen offset:1024 sc1 lds
    v_mfma_f32_32x32x16_bf16 v[32:47], v[88:91], v[188:191], v[32:47]
    s_nop 2
    v_mul_f32 v234, v0, v144
    v_mul_f32 v236, v8, v112
    v_fmac_f32 v234, v1, v145
    v_fmac_f32 v236, v9, v113
    v_fmac_f32 v234, v2, v146
    v_fmac_f32 v236, v10, v114
    v_fmac_f32 v234, v3, v147
    v_mfma_f32_32x32x16_bf16 v[48:63], v[92:95], v[188:191], v[48:63]
    s_setprio 0
    v_fmac_f32 v236, v11, v115
    v_fmac_f32 v234, v4, v148
    v_fmac_f32 v236, v12, v116
    v_fmac_f32 v234, v5, v149
    v_fmac_f32 v236, v13, v117
    v_fmac_f32 v234, v6, v150
    v_fmac_f32 v236, v14, v118
    v_fmac_f32 v234, v7, v151
    v_fmac_f32 v236, v15, v119
    v_mul_f32 v238, v16, v160
    v_mul_f32 v240, v24, v160
    v_fmac_f32 v238, v17, v161
    v_fmac_f32 v240, v25, v161
    v_fmac_f32 v238, v18, v162
    v_fmac_f32 v240, v26, v162
    v_fmac_f32 v238, v19, v163
    v_fmac_f32 v240, v27, v163
    v_fmac_f32 v238, v20, v164
    v_fmac_f32 v240, v28, v164
    v_fmac_f32 v238, v21, v165
    v_fmac_f32 v240, v29, v165
    v_fmac_f32 v238, v22, v166
    v_fmac_f32 v240, v30, v166
    v_fmac_f32 v238, v23, v167
    v_fmac_f32 v240, v31, v167
    v_mul_f32 v235, v32, v152
    v_mul_f32 v237, v40, v120
    v_fmac_f32 v235, v33, v153
    v_fmac_f32 v237, v41, v121
    v_fmac_f32 v235, v34, v154
    v_fmac_f32 v237, v42, v122
    v_fmac_f32 v235, v35, v155
    v_fmac_f32 v237, v43, v123
    v_fmac_f32 v235, v36, v156
    v_fmac_f32 v237, v44, v124
    v_fmac_f32 v235, v37, v157
    v_fmac_f32 v237, v45, v125
    v_fmac_f32 v235, v38, v158
    v_fmac_f32 v237, v46, v126
    v_fmac_f32 v235, v39, v159
    v_fmac_f32 v237, v47, v127
    v_mul_f32 v239, v48, v168
    v_mul_f32 v241, v56, v168
    s_setprio 1
    s_waitcnt vmcnt(4) lgkmcnt(0)
    v_mfma_f32_32x32x16_bf16 v[0:15], v[64:67], v[176:179], 0
    ds_read_b64_tr_b16 v[184:185], v246 offset:2048
    ds_read_b64_tr_b16 v[186:187], v246 offset:3072
    ds_read_b64_tr_b16 v[188:189], v247 offset:2048
    ds_read_b64_tr_b16 v[190:191], v247 offset:3072
    v_fmac_f32 v239, v49, v169
    v_fmac_f32 v241, v57, v169
    s_mov_b32 m0, s68
    v_mfma_f32_32x32x16_bf16 v[16:31], v[68:71], v[176:179], 0
    buffer_load_dwordx4 v222, s[4:7], s43 offen sc1 lds
    buffer_load_dwordx4 v223, s[72:75], s43 offen offset:1024 sc1 lds
    v_fmac_f32 v239, v50, v170
    v_fmac_f32 v241, v58, v170
    v_fmac_f32 v239, v51, v171
    v_fmac_f32 v241, v59, v171
    v_fmac_f32 v239, v52, v172
    v_mfma_f32_32x32x16_bf16 v[32:47], v[64:67], v[180:183], 0
    v_fmac_f32 v241, v60, v172
    v_fmac_f32 v239, v53, v173
    v_fmac_f32 v241, v61, v173
    v_fmac_f32 v239, v54, v174
    v_fmac_f32 v241, v62, v174
    v_fmac_f32 v239, v55, v175
    v_fmac_f32 v241, v63, v175
    v_mfma_f32_32x32x16_bf16 v[48:63], v[68:71], v[180:183], 0
    s_waitcnt vmcnt(4) lgkmcnt(0)
    v_mfma_f32_32x32x16_bf16 v[0:15], v[72:75], v[184:187], v[0:15]
    ds_read_b64_tr_b16 v[176:177], v246 offset:4096
    ds_read_b64_tr_b16 v[178:179], v246 offset:5120
    ds_read_b64_tr_b16 v[180:181], v247 offset:4096
    ds_read_b64_tr_b16 v[182:183], v247 offset:5120
    s_mov_b32 m0, s69
    v_mfma_f32_32x32x16_bf16 v[16:31], v[76:79], v[184:187], v[16:31]
    buffer_load_dwordx4 v224, s[4:7], s43 offen sc1 lds
    buffer_load_dwordx4 v225, s[72:75], s43 offen offset:1024 sc1 lds
    v_mfma_f32_32x32x16_bf16 v[32:47], v[72:75], v[188:191], v[32:47]
    v_mfma_f32_32x32x16_bf16 v[48:63], v[76:79], v[188:191], v[48:63]
    s_waitcnt vmcnt(4) lgkmcnt(0)
    v_mfma_f32_32x32x16_bf16 v[0:15], v[80:83], v[176:179], v[0:15]
    ds_read_b64_tr_b16 v[184:185], v246 offset:6144
    ds_read_b64_tr_b16 v[186:187], v246 offset:7168
    ds_read_b64_tr_b16 v[188:189], v247 offset:6144
    ds_read_b64_tr_b16 v[190:191], v247 offset:7168
    s_mov_b32 m0, s70
    v_mfma_f32_32x32x16_bf16 v[16:31], v[84:87], v[176:179], v[16:31]
    buffer_load_dwordx4 v226, s[4:7], s43 offen sc1 lds
    buffer_load_dwordx4 v227, s[72:75], s43 offen offset:1024 sc1 lds
    v_mfma_f32_32x32x16_bf16 v[32:47], v[80:83], v[180:183], v[32:47]
    v_add_u32 v222, s48, v251
    ds_read2_b32 v[222:223], v222 offset0:1 offset1:3
    v_mfma_f32_32x32x16_bf16 v[48:63], v[84:87], v[180:183], v[48:63]
    s_waitcnt vmcnt(4) lgkmcnt(1)
    v_mfma_f32_32x32x16_bf16 v[0:15], v[88:91], v[184:187], v[0:15]
    ds_read_b64_tr_b16 v[176:177], v246 offset:0
    ds_read_b64_tr_b16 v[178:179], v246 offset:1024
    ds_read_b64_tr_b16 v[180:181], v247 offset:0
    ds_read_b64_tr_b16 v[182:183], v247 offset:1024
    s_mov_b32 m0, s71
    v_mfma_f32_32x32x16_bf16 v[16:31], v[92:95], v[184:187], v[16:31]
    buffer_load_dwordx4 v228, s[4:7], s43 offen sc1 lds
    buffer_load_dwordx4 v229, s[72:75], s43 offen offset:1024 sc1 lds
    s_waitcnt lgkmcnt(4)
    v_mad_u32_u16 v222, v222, s39, v248 op_sel:[1,0,0,0]
    v_mad_u32_u16 v223, v223, s39, v248 op_sel:[1,0,0,0]
    v_mfma_f32_32x32x16_bf16 v[32:47], v[88:91], v[188:191], v[32:47]
    v_add_u32 v224, s49, v251
    ds_read2_b32 v[224:225], v224 offset0:1 offset1:3
    v_mul_f32 v242, v0, v144
    v_fma_f32 v238, v8, v160, -v238
    v_fmac_f32 v242, v1, v145
    v_fmac_f32 v238, v9, v161
    v_fmac_f32 v242, v2, v146
    v_mfma_f32_32x32x16_bf16 v[48:63], v[92:95], v[188:191], v[48:63]
    s_setprio 0
    v_fmac_f32 v238, v10, v162
    v_fmac_f32 v242, v3, v147
    v_fmac_f32 v238, v11, v163
    v_fmac_f32 v242, v4, v148
    v_fmac_f32 v238, v12, v164
    v_fmac_f32 v242, v5, v149
    v_fmac_f32 v238, v13, v165
    v_fmac_f32 v242, v6, v150
    v_fmac_f32 v238, v14, v166
    v_fmac_f32 v242, v7, v151
    v_fmac_f32 v238, v15, v167
    v_fmac_f32 v236, v16, v112
    v_mul_f32 v244, v24, v160
    v_fmac_f32 v236, v17, v113
    v_fmac_f32 v244, v25, v161
    v_fmac_f32 v236, v18, v114
    v_fmac_f32 v244, v26, v162
    v_fmac_f32 v236, v19, v115
    v_fmac_f32 v244, v27, v163
    v_fmac_f32 v236, v20, v116
    v_fmac_f32 v244, v28, v164
    v_fmac_f32 v236, v21, v117
    v_fmac_f32 v244, v29, v165
    v_fmac_f32 v236, v22, v118
    v_fmac_f32 v244, v30, v166
    v_fmac_f32 v236, v23, v119
    v_fmac_f32 v244, v31, v167
    v_mul_f32 v243, v32, v152
    v_fma_f32 v239, v40, v168, -v239
    v_fmac_f32 v243, v33, v153
    v_fmac_f32 v239, v41, v169
    v_fmac_f32 v243, v34, v154
    v_fmac_f32 v239, v42, v170
    v_fmac_f32 v243, v35, v155
    v_fmac_f32 v239, v43, v171
    v_fmac_f32 v243, v36, v156
    v_fmac_f32 v239, v44, v172
    v_fmac_f32 v243, v37, v157
    v_fmac_f32 v239, v45, v173
    v_fmac_f32 v243, v38, v158
    v_fmac_f32 v239, v46, v174
    v_fmac_f32 v243, v39, v159
    v_fmac_f32 v239, v47, v175
    v_fmac_f32 v237, v48, v120
    v_mul_f32 v245, v56, v168
    v_fmac_f32 v237, v49, v121
    v_fmac_f32 v245, v57, v169
    v_fmac_f32 v237, v50, v122
    v_fmac_f32 v245, v58, v170
    v_fmac_f32 v237, v51, v123
    s_setprio 1
    s_waitcnt vmcnt(4) lgkmcnt(1)
    v_mfma_f32_32x32x16_bf16 v[0:15], v[64:67], v[176:179], 0
    ds_read_b64_tr_b16 v[184:185], v246 offset:2048
    ds_read_b64_tr_b16 v[186:187], v246 offset:3072
    ds_read_b64_tr_b16 v[188:189], v247 offset:2048
    ds_read_b64_tr_b16 v[190:191], v247 offset:3072
    v_fmac_f32 v245, v59, v171
    v_fmac_f32 v237, v52, v124
    s_mov_b32 m0, s68
    v_mfma_f32_32x32x16_bf16 v[16:31], v[68:71], v[176:179], 0
    buffer_load_dwordx4 v222, s[4:7], s44 offen sc1 lds
    buffer_load_dwordx4 v223, s[72:75], s44 offen offset:1024 sc1 lds
    s_waitcnt lgkmcnt(4)
    v_mad_u32_u16 v224, v224, s39, v248 op_sel:[1,0,0,0]
    v_mad_u32_u16 v225, v225, s39, v248 op_sel:[1,0,0,0]
    v_fmac_f32 v245, v60, v172
    v_fmac_f32 v237, v53, v125
    v_mfma_f32_32x32x16_bf16 v[32:47], v[64:67], v[180:183], 0
    v_add_u32 v226, s50, v251
    ds_read2_b32 v[226:227], v226 offset0:1 offset1:3
    v_fmac_f32 v245, v61, v173
    v_fmac_f32 v237, v54, v126
    v_fmac_f32 v245, v62, v174
    v_fmac_f32 v237, v55, v127
    v_fmac_f32 v245, v63, v175
    v_mfma_f32_32x32x16_bf16 v[48:63], v[68:71], v[180:183], 0
    v_permlane32_swap_b32 v242, v234
    v_permlane32_swap_b32 v243, v235
    v_add_f32 v242, v242, v234
    v_add_f32 v243, v243, v235
    s_waitcnt vmcnt(4) lgkmcnt(1)
    v_mfma_f32_32x32x16_bf16 v[0:15], v[72:75], v[184:187], v[0:15]
    ds_read_b64_tr_b16 v[176:177], v246 offset:4096
    ds_read_b64_tr_b16 v[178:179], v246 offset:5120
    ds_read_b64_tr_b16 v[180:181], v247 offset:4096
    ds_read_b64_tr_b16 v[182:183], v247 offset:5120
    v_cvt_pk_bf16_f32 v242, v242, v243
    ds_write_b32 v230, v242 offset:512
    s_mov_b32 m0, s69
    v_mfma_f32_32x32x16_bf16 v[16:31], v[76:79], v[184:187], v[16:31]
    buffer_load_dwordx4 v224, s[4:7], s45 offen sc1 lds
    buffer_load_dwordx4 v225, s[72:75], s45 offen offset:1024 sc1 lds
    s_waitcnt lgkmcnt(5)
    v_mad_u32_u16 v226, v226, s39, v248 op_sel:[1,0,0,0]
    v_mad_u32_u16 v227, v227, s39, v248 op_sel:[1,0,0,0]
    v_mfma_f32_32x32x16_bf16 v[32:47], v[72:75], v[188:191], v[32:47]
    v_mfma_f32_32x32x16_bf16 v[48:63], v[76:79], v[188:191], v[48:63]
    s_waitcnt vmcnt(4) lgkmcnt(1)
    v_mfma_f32_32x32x16_bf16 v[0:15], v[80:83], v[176:179], v[0:15]
    ds_read_b64_tr_b16 v[184:185], v246 offset:6144
    ds_read_b64_tr_b16 v[186:187], v246 offset:7168
    ds_read_b64_tr_b16 v[188:189], v247 offset:6144
    ds_read_b64_tr_b16 v[190:191], v247 offset:7168
    s_mov_b32 s32, s31
    s_mov_b32 s31, s35
    s_mov_b32 m0, s70
    v_mfma_f32_32x32x16_bf16 v[16:31], v[84:87], v[176:179], v[16:31]
    buffer_load_dwordx4 v226, s[4:7], s46 offen sc1 lds
    buffer_load_dwordx4 v227, s[72:75], s46 offen offset:1024 sc1 lds
    s_sub_u32 s26, s48, s29
    s_mov_b32 s29, s48
    s_mov_b32 s30, s3
    s_bfe_u32 s56, s3, 0x40012
    v_mfma_f32_32x32x16_bf16 v[32:47], v[80:83], v[180:183], v[32:47]
    s_cmp_lg_u32 s36, 0
    s_cselect_b32 s56, s56, 0
    v_mfma_f32_32x32x16_bf16 v[48:63], v[84:87], v[180:183], v[48:63]
    s_waitcnt vmcnt(4) lgkmcnt(0)
    v_mfma_f32_32x32x16_bf16 v[0:15], v[88:91], v[184:187], v[0:15]
    ds_read_b64_tr_b16 v[176:177], v246 offset:0
    ds_read_b64_tr_b16 v[178:179], v246 offset:1024
    ds_read_b64_tr_b16 v[180:181], v247 offset:0
    ds_read_b64_tr_b16 v[182:183], v247 offset:1024
    s_mov_b32 m0, s71
    v_mfma_f32_32x32x16_bf16 v[16:31], v[92:95], v[184:187], v[16:31]
    s_cmp_eq_u32 s33, 4
    s_cbranch_scc1 K2_g4_137
    buffer_load_dwordx4 v224, s[4:7], s47 offen sc1 lds
    buffer_load_dwordx4 v225, s[72:75], s47 offen offset:1024 sc1 lds
K2_back_138:
    v_mfma_f32_32x32x16_bf16 v[32:47], v[88:91], v[188:191], v[32:47]
    s_nop 0
    v_mul_f32 v242, v0, v144
    v_fma_f32 v240, v8, v160, -v240
    v_fmac_f32 v242, v1, v145
    v_fmac_f32 v240, v9, v161
    v_fmac_f32 v242, v2, v146
    v_fmac_f32 v240, v10, v162
    v_fmac_f32 v242, v3, v147
    v_mfma_f32_32x32x16_bf16 v[48:63], v[92:95], v[188:191], v[48:63]
    s_setprio 0
    v_fmac_f32 v240, v11, v163
    v_fmac_f32 v242, v4, v148
    v_fmac_f32 v240, v12, v164
    v_fmac_f32 v242, v5, v149
    v_fmac_f32 v240, v13, v165
    v_fmac_f32 v242, v6, v150
    v_fmac_f32 v240, v14, v166
    v_fmac_f32 v242, v7, v151
    v_fmac_f32 v240, v15, v167
    v_add_u32 v249, s26, v249
    v_add_u32 v250, s26, v250
    v_fma_f32 v244, v16, v160, -v244
    v_fmac_f32 v236, v24, v112
    v_fmac_f32 v244, v17, v161
    v_fmac_f32 v236, v25, v113
    v_fmac_f32 v244, v18, v162
    v_fmac_f32 v236, v26, v114
    v_fmac_f32 v244, v19, v163
    v_fmac_f32 v236, v27, v115
    v_fmac_f32 v244, v20, v164
    v_fmac_f32 v236, v28, v116
    v_fmac_f32 v244, v21, v165
    v_fmac_f32 v236, v29, v117
    v_fmac_f32 v244, v22, v166
    v_fmac_f32 v236, v30, v118
    v_fmac_f32 v244, v23, v167
    v_fmac_f32 v236, v31, v119
    ds_read_b64_tr_b16 v[0:1], v249 offset:0
    ds_read_b64_tr_b16 v[2:3], v249 offset:32
    ds_read_u16_d16_hi v16, v250 offset:0
    v_mul_f32 v243, v32, v152
    v_fma_f32 v241, v40, v168, -v241
    v_fmac_f32 v243, v33, v153
    v_fmac_f32 v241, v41, v169
    v_fmac_f32 v243, v34, v154
    v_fmac_f32 v241, v42, v170
    v_fmac_f32 v243, v35, v155
    v_fmac_f32 v241, v43, v171
    v_fmac_f32 v243, v36, v156
    v_fmac_f32 v241, v44, v172
    v_fmac_f32 v243, v37, v157
    v_fmac_f32 v241, v45, v173
    v_fmac_f32 v243, v38, v158
    v_fmac_f32 v241, v46, v174
    v_fmac_f32 v243, v39, v159
    v_fmac_f32 v241, v47, v175
    ds_read_b64_tr_b16 v[4:5], v249 offset:512
    ds_read_b64_tr_b16 v[6:7], v249 offset:544
    ds_read_u16_d16_hi v17, v250 offset:128
    v_fma_f32 v245, v48, v168, -v245
    v_fmac_f32 v237, v56, v120
    v_fmac_f32 v245, v49, v169
    v_fmac_f32 v237, v57, v121
    v_fmac_f32 v245, v50, v170
    v_fmac_f32 v237, v58, v122
    v_fmac_f32 v245, v51, v171
    v_fmac_f32 v237, v59, v123
    v_fmac_f32 v245, v52, v172
    v_fmac_f32 v237, v60, v124
    v_fmac_f32 v245, v53, v173
    v_fmac_f32 v237, v61, v125
    v_fmac_f32 v245, v54, v174
    v_fmac_f32 v237, v62, v126
    v_fmac_f32 v245, v55, v175
    v_fmac_f32 v237, v63, v127
    s_cmp_eq_u32 s56, 5
    s_cbranch_scc1 K2_U21
    s_cmp_eq_u32 s56, 6
    s_cbranch_scc1 K2_U3h1
    s_branch K2_DSP1
K2_FLGR:
    s_sub_u32 s27, s27, 16
    s_cbranch_scc1 K2_END
    buffer_load_dwordx4 v[56:59], v60, s[8:11], s64 offen sc1
    s_waitcnt vmcnt(0)
    s_branch K2_FLGW
K2_FLGY:
    v_mov_b32 v56, s2
    v_mov_b32 v57, 7178240
    s_mov_b64 exec, 1
    buffer_store_dword v56, v57, s[8:11], 0 offen sc1
    s_mov_b64 exec, -1
    s_branch K2_FLGOK
K2_nul_93:
    s_mov_b32 s58, 63
    s_mov_b32 s36, 0
    s_branch K2_back_96
K2_spin_94:
    s_sub_u32 s27, s27, 1
    s_cbranch_scc1 K2_END
    ds_read_b32 v232, v254
    s_waitcnt lgkmcnt(0)
    s_branch K2_chk_95
K2_dyn_91:
    v_lshl_add_u32 v254, v252, 1, s53
    v_cmp_eq_u32 vcc, 16, v252
    s_nop 1
    v_cndmask_b32 v255, 0, 1, vcc
    s_mov_b64 exec, 0x3ff
    ds_add_rtn_u32 v232, v254, v255
    s_mov_b64 exec, -1
    s_waitcnt lgkmcnt(0)
    v_readlane_b32 s58, v232, 8
    s_nop 0
    s_mov_b32 s0, s58
    s_cmp_lt_u32 s58, s22
    s_cbranch_scc0 K2_nul_93
    v_readlane_b32 s3, v253, s58
    s_nop 0
    s_bfe_u32 s58, s3, 0x60016
    s_and_b32 s59, s58, 7
    s_lshr_b32 s60, s58, 3
K2_chk_95:
    v_readlane_b32 s61, v232, s59
    s_nop 0
    s_cmp_gt_u32 s61, s60
    s_cbranch_scc0 K2_spin_94
K2_back_96:
    s_mov_b32 s34, 1
    s_branch K2_back_92
K2_rare_97:
    s_cmp_eq_u32 s33, 4
    s_cbranch_scc1 K2_four_99
    s_mov_b32 s49, s48
    s_xor_b32 s45, s44, 256
    s_xor_b32 s46, s44, 512
    s_xor_b32 s47, s44, 768
    s_branch K2_back_98
K2_four_99:
    s_add_u32 s50, s48, 256
    s_mov_b32 s46, s44
    s_mov_b32 s47, s44
    s_branch K2_back_98
K2_dum_100:
    v_mov_b32 v232, -1
    s_mov_b32 m0, 163312
    s_mov_b64 exec, 1
    buffer_load_dwordx4 v232, s[16:19], 0 offen lds
    buffer_load_dwordx4 v232, s[16:19], 0 offen lds
    s_mov_b64 exec, -1
    s_branch K2_back_102
K2_a4_101:
    v_add_u32 v254, s48, v230
    ds_read_b32 v254, v254 offset:4
    s_lshr_b32 s65, s3, 28
    s_mul_i32 s66, s22, 2080
    s_lshl_b32 s65, s65, 9
    s_add_u32 s65, s65, s66
    s_add_u32 s65, s65, 65536
    s_mov_b32 m0, s65
    s_mov_b32 exec_hi, 0
    s_waitcnt lgkmcnt(0)
    v_or_b32 v254, v254, v231
    buffer_load_dwordx4 v254, s[16:19], 0 offen  lds
    s_mov_b32 exec_hi, -1
    s_branch K2_b4_103
K2_g4_104:
    s_add_u32 s51, s48, 384
    v_add_u32 v228, s51, v251
    ds_read2_b32 v[228:229], v228 offset0:1 offset1:3
    s_waitcnt lgkmcnt(0)
    v_mad_u32_u16 v228, v228, s39, v248 op_sel:[1,0,0,0]
    v_mad_u32_u16 v229, v229, s39, v248 op_sel:[1,0,0,0]
    buffer_load_dwordx4 v228, s[4:7], s47 offen sc1 lds
    buffer_load_dwordx4 v229, s[72:75], s47 offen offset:1024 sc1 lds
    s_branch K2_back_105
K2_nul_108:
    s_mov_b32 s58, 63
    s_mov_b32 s36, 0
    s_branch K2_back_111
K2_spin_109:
    s_sub_u32 s27, s27, 1
    s_cbranch_scc1 K2_END
    ds_read_b32 v232, v254
    s_waitcnt lgkmcnt(0)
    s_branch K2_chk_110
K2_dyn_106:
    v_lshl_add_u32 v254, v252, 1, s53
    v_cmp_eq_u32 vcc, 16, v252
    s_nop 1
    v_cndmask_b32 v255, 0, 1, vcc
    s_mov_b64 exec, 0x3ff
    ds_add_rtn_u32 v232, v254, v255
    s_mov_b64 exec, -1
    s_waitcnt lgkmcnt(0)
    v_readlane_b32 s58, v232, 8
    s_nop 0
    s_mov_b32 s0, s58
    s_cmp_lt_u32 s58, s22
    s_cbranch_scc0 K2_nul_108
    v_readlane_b32 s3, v253, s58
    s_nop 0
    s_bfe_u32 s58, s3, 0x60016
    s_and_b32 s59, s58, 7
    s_lshr_b32 s60, s58, 3
K2_chk_110:
    v_readlane_b32 s61, v232, s59
    s_nop 0
    s_cmp_gt_u32 s61, s60
    s_cbranch_scc0 K2_spin_109
K2_back_111:
    s_mov_b32 s34, 1
    s_branch K2_back_107
K2_rare_112:
    s_cmp_eq_u32 s33, 4
    s_cbranch_scc1 K2_four_114
    s_mov_b32 s49, s48
    s_xor_b32 s45, s44, 256
    s_xor_b32 s46, s44, 512
    s_xor_b32 s47, s44, 768
    s_branch K2_back_113
K2_four_114:
    s_add_u32 s50, s48, 256
    s_mov_b32 s46, s44
    s_mov_b32 s47, s44
    s_branch K2_back_113
K2_g4_115:
    s_add_u32 s51, s48, 384
    v_add_u32 v228, s51, v251
    ds_read2_b32 v[228:229], v228 offset0:1 offset1:3
    s_waitcnt lgkmcnt(0)
    v_mad_u32_u16 v228, v228, s39, v248 op_sel:[1,0,0,0]
    v_mad_u32_u16 v229, v229, s39, v248 op_sel:[1,0,0,0]
    buffer_load_dwordx4 v228, s[4:7], s47 offen sc1 lds
    buffer_load_dwordx4 v229, s[72:75], s47 offen offset:1024 sc1 lds
    s_branch K2_back_116
K2_dum_117:
    v_mov_b32 v232, -1
    s_mov_b32 m0, 163312
    s_mov_b64 exec, 1
    buffer_load_dwordx4 v232, s[16:19], 0 offen lds
    buffer_load_dwordx4 v232, s[16:19], 0 offen lds
    s_mov_b64 exec, -1
    s_branch K2_back_119
K2_a4_118:
    v_add_u32 v254, s48, v230
    ds_read_b32 v254, v254 offset:4
    s_lshr_b32 s65, s3, 28
    s_mul_i32 s66, s22, 2080
    s_lshl_b32 s65, s65, 9
    s_add_u32 s65, s65, s66
    s_add_u32 s65, s65, 65536
    s_mov_b32 m0, s65
    s_mov_b32 exec_hi, 0
    s_waitcnt lgkmcnt(0)
    v_or_b32 v254, v254, v231
    buffer_load_dwordx4 v254, s[16:19], 0 offen  lds
    s_mov_b32 exec_hi, -1
    s_branch K2_b4_120
K2_nul_121:
    s_mov_b32 s3, 949760
    s_mov_b32 s36, 0
    s_branch K2_back_124
K2_spin_122:
    s_sub_u32 s27, s27, 1
    s_cbranch_scc1 K2_END
    ds_read_b32 v232, v254
    s_waitcnt lgkmcnt(0)
    s_branch K2_chk_123
K2_rare_125:
    s_cmp_eq_u32 s33, 4
    s_cbranch_scc1 K2_four_127
    s_mov_b32 s49, s48
    s_xor_b32 s45, s44, 256
    s_xor_b32 s46, s44, 512
    s_xor_b32 s47, s44, 768
    s_branch K2_back_126
K2_four_127:
    s_add_u32 s50, s48, 256
    s_mov_b32 s46, s44
    s_mov_b32 s47, s44
    s_branch K2_back_126
K2_g4_128:
    s_add_u32 s51, s48, 384
    v_add_u32 v228, s51, v251
    ds_read2_b32 v[228:229], v228 offset0:1 offset1:3
    s_waitcnt lgkmcnt(0)
    v_mad_u32_u16 v228, v228, s39, v248 op_sel:[1,0,0,0]
    v_mad_u32_u16 v229, v229, s39, v248 op_sel:[1,0,0,0]
    buffer_load_dwordx4 v228, s[4:7], s47 offen sc1 lds
    buffer_load_dwordx4 v229, s[72:75], s47 offen offset:1024 sc1 lds
    s_branch K2_back_129
K2_nul_130:
    s_mov_b32 s3, 949760
    s_mov_b32 s36, 0
    s_branch K2_back_133
K2_spin_131:
    s_sub_u32 s27, s27, 1
    s_cbranch_scc1 K2_END
    ds_read_b32 v232, v254
    s_waitcnt lgkmcnt(0)
    s_branch K2_chk_132
K2_rare_134:
    s_cmp_eq_u32 s33, 4
    s_cbranch_scc1 K2_four_136
    s_mov_b32 s49, s48
    s_xor_b32 s45, s44, 256
    s_xor_b32 s46, s44, 512
    s_xor_b32 s47, s44, 768
    s_branch K2_back_135
K2_four_136:
    s_add_u32 s50, s48, 256
    s_mov_b32 s46, s44
    s_mov_b32 s47, s44
    s_branch K2_back_135
K2_g4_137:
    s_add_u32 s51, s48, 384
    v_add_u32 v228, s51, v251
    ds_read2_b32 v[228:229], v228 offset0:1 offset1:3
    s_waitcnt lgkmcnt(0)
    v_mad_u32_u16 v228, v228, s39, v248 op_sel:[1,0,0,0]
    v_mad_u32_u16 v229, v229, s39, v248 op_sel:[1,0,0,0]
    buffer_load_dwordx4 v228, s[4:7], s47 offen sc1 lds
    buffer_load_dwordx4 v229, s[72:75], s47 offen offset:1024 sc1 lds
    s_branch K2_back_138
K2_END:
    s_endpgm
.section .rodata,"a"
.p2align 6
.amdhsa_kernel standalone__tensor_product_equiv_equiformer__graph_kernel
  .amdhsa_next_free_vgpr 256
  .amdhsa_next_free_sgpr 102
  .amdhsa_accum_offset 256
  .amdhsa_group_segment_fixed_size 0
  .amdhsa_kernarg_size 96
  .amdhsa_user_sgpr_count 2
  .amdhsa_user_sgpr_kernarg_segment_ptr 1
  .amdhsa_system_sgpr_workgroup_id_x 1
  .amdhsa_float_denorm_mode_32 3
.end_amdhsa_kernel
```

```asm
; @launch grid=(256,1,1) block=(512,1,1) lds=163840
.amdgcn_target "amdgcn-amd-amdhsa--gfx950"
.text
.globl standalone__tensor_product_equiv_equiformer__graph_kernel
.p2align 8
.type standalone__tensor_product_equiv_equiformer__graph_kernel,@function
standalone__tensor_product_equiv_equiformer__graph_kernel:
    s_cmp_ge_u32 s2, 256
    s_cbranch_scc1 K2_END
    s_load_dwordx16 s[80:95], s[0:1], 0
    s_load_dwordx4 s[96:99], s[0:1], 72
    s_load_dwordx2 s[100:101], s[0:1], 88
    v_lshrrev_b32 v1, 6, v0
    s_mov_b32 s54, s2
    v_readfirstlane_b32 s20, v1
    s_mov_b64 exec, 0
    s_cmp_eq_u32 s20, 0
    s_cbranch_scc1 K2_PAD_S1
    s_cmp_eq_u32 s20, 1
    s_cbranch_scc1 K2_PAD_S2
    s_cmp_eq_u32 s20, 5
    s_cbranch_scc1 K2_PAD_H1
    s_cmp_eq_u32 s20, 6
    s_cbranch_scc1 K2_PAD_H2
    s_cmp_eq_u32 s20, 2
    s_cbranch_scc1 K2_PAD_H3
KS_HOP0:
    s_mov_b64 exec, -1
    v_and_b32 v8, 63, v0
    v_lshlrev_b32 v9, 4, v8
    v_mov_b32 v6, 0
    v_lshlrev_b32 v5, 4, v0
    v_mul_u32_u24 v4, 24, v0
    s_mul_i32 s64, s2, 5120
    s_mul_i32 s65, s2, 7680
    v_mov_b32 v176, v8
    v_mov_b32 v177, v0
    s_movk_i32 s39, 1024
    s_lshl_b32 s37, s20, 13
    s_mov_b32 s53, 163264
    s_lshl_b32 s52, s20, 2
    s_add_u32 s52, s52, s53
    s_add_u32 s68, s37, 0
    s_add_u32 s69, s37, 2048
    s_add_u32 s70, s37, 4096
    s_add_u32 s71, s37, 6144
    s_waitcnt lgkmcnt(0)
    s_mov_b32 s8, s100
    s_and_b32 s9, s101, 0xffff
    s_mov_b32 s10, 37748736
    s_mov_b32 s11, 0x20000
    s_cmp_lg_u32 s20, 7
    s_cbranch_scc1 KS_NOTAG
    s_mov_b32 s24, 7178240
    s_mov_b64 exec, 1
    buffer_load_dword v14, v6, s[8:11], s24 offen sc1
    s_mov_b64 exec, -1
    s_mov_b32 s60, s98
    s_and_b32 s61, s99, 0xffff
    s_mov_b32 s62, 256
    s_mov_b32 s63, 0x20000
    s_barrier
    v_mov_b32 v76, 0
    v_mov_b32 v77, -1
    v_lshlrev_b32 v78, 2, v8
    v_add_u32 v78, 163072, v78
    s_mov_b64 exec, 0x1ff
    ds_write_b32 v78, v76 offset:192
    s_mov_b32 exec_lo, 1
    ds_write_b32 v78, v76 offset:228
    s_mov_b32 exec_lo, -1
    ds_write_b32 v78, v77 offset:256
    s_mov_b64 exec, -1
    s_mov_b32 exec_hi, 0xffff
    ds_write_b32 v78, v76
    s_mov_b64 exec, 1
    ds_write_b32 v78, v76 offset:232
    s_mov_b64 exec, -1
    s_mov_b64 exec, 1
    buffer_load_dword v15, v6, s[60:63], 0 offen sc1
    v_mov_b32 v12, 163456
    s_mov_b32 s24, 1664525
    s_waitcnt vmcnt(1)
    v_mul_lo_u32 v59, v14, s24
    v_add_u32 v59, 1013904223, v59
    ds_write2_b32 v12, v59, v6 offset0:0 offset1:1
    s_waitcnt lgkmcnt(0)
    s_barrier
    s_waitcnt vmcnt(0)
    v_mov_b32 v62, v15
    ds_write_b32 v12, v15 offset:4
    v_cmp_ne_u32 vcc, 0, v15
    s_mov_b32 s24, 0x40000
    s_waitcnt lgkmcnt(0)
    s_barrier
    s_cbranch_vccnz KS_FLOK
KS_FLW:
    s_sub_u32 s24, s24, 1
    s_cbranch_scc1 K2_END
    buffer_load_dword v62, v6, s[60:63], 0 offen sc1
    s_waitcnt vmcnt(0)
    v_cmp_ne_u32 vcc, 0, v62
    s_nop 0
    s_cbranch_vccz KS_FLW
    ds_write_b32 v12, v62 offset:4
KS_FLOK:
    s_mov_b64 exec, -1
    s_branch KS_JOIN
KS_H0:
    s_barrier
    s_branch KS_HELP
K2_PAD_S1:
    s_branch KS_HOP0
KS_NOTAG:
    s_cmp_ge_u32 s20, 5
    s_cbranch_scc1 KS_HELP
    s_cmp_ge_u32 s2, 250
    s_cbranch_scc1 KS_IDLE
    s_mov_b32 s40, s88
    s_and_b32 s41, s89, 0xffff
    s_mov_b32 s42, 1280000
    s_mov_b32 s43, 0x20000
    buffer_load_dwordx4 v[12:15], v5, s[40:43], s64 offen
    s_mov_b32 s44, s86
    s_and_b32 s45, s87, 0xffff
    s_mov_b32 s46, 1280000
    s_mov_b32 s47, 0x20000
    s_mov_b32 s48, s82
    s_and_b32 s49, s83, 0xffff
    s_mov_b32 s50, 1920000
    s_mov_b32 s51, 0x20000
    buffer_load_dwordx4 v[16:19], v5, s[44:47], s64 offen
    buffer_load_dwordx4 v[20:23], v4, s[48:51], s65 offen
    buffer_load_dwordx2 v[24:25], v4, s[48:51], s65 offen offset:16
    v_lshlrev_b32 v2, 2, v0
    s_lshl_b32 s64, s64, 3
    v_lshl_add_u32 v3, v0, 7, s64
    v_mov_b32 v7, 1
    s_setprio 2
    s_cmp_eq_u32 s20, 4
    s_cbranch_scc1 KS_NOCLR
    s_setprio 1
    ds_write_b32 v2, v6
KS_NOCLR:
    s_waitcnt lgkmcnt(0)
    s_barrier
    s_mov_b64 exec, 0
    s_cmp_eq_u32 s20, 0
    s_cbranch_scc1 K2_PAD_B3
    s_cmp_eq_u32 s20, 1
    s_cbranch_scc1 K2_PAD_LD
    s_cmp_eq_u32 s20, 2
    s_cbranch_scc1 K2_PAD_NW
    s_cmp_eq_u32 s20, 3
    s_cbranch_scc1 K2_PAD_SC
    s_cmp_eq_u32 s20, 4
    s_cbranch_scc1 K2_PAD_SD
KS_HOP:
    s_mov_b64 exec, -1
    s_mov_b32 s58, 214749
    s_movk_i32 s59, 625
    s_waitcnt vmcnt(3)
    v_mul_u32_u24 v28, s58, v12
    v_and_b32 v40, 0xffffff, v28
    v_lshrrev_b32 v32, 26, v28
    v_add_u32 v40, 8187281, v40
    v_bfe_u32 v36, v28, 24, 2
    v_lshlrev_b32 v32, 2, v32
    v_lshrrev_b32 v40, 24, v40
    v_lshl_or_b32 v32, v36, 8, v32
    v_lshl_or_b32 v32, v40, 7, v32
    ds_add_rtn_u32 v36, v32, v7
    v_mul_u32_u24 v29, s58, v13
    v_and_b32 v41, 0xffffff, v29
    v_lshrrev_b32 v33, 26, v29
    v_add_u32 v41, 8187281, v41
    v_bfe_u32 v37, v29, 24, 2
    v_lshlrev_b32 v33, 2, v33
    v_lshrrev_b32 v41, 24, v41
    v_lshl_or_b32 v33, v37, 8, v33
    v_lshl_or_b32 v33, v41, 7, v33
    ds_add_rtn_u32 v37, v33, v7
    v_mul_u32_u24 v30, s58, v14
    v_and_b32 v42, 0xffffff, v30
    v_lshrrev_b32 v34, 26, v30
    v_add_u32 v42, 8187281, v42
    v_bfe_u32 v38, v30, 24, 2
    v_lshlrev_b32 v34, 2, v34
    v_lshrrev_b32 v42, 24, v42
    v_lshl_or_b32 v34, v38, 8, v34
    v_lshl_or_b32 v34, v42, 7, v34
    ds_add_rtn_u32 v38, v34, v7
    v_mul_u32_u24 v31, s58, v15
    v_and_b32 v43, 0xffffff, v31
    v_lshrrev_b32 v35, 26, v31
    v_add_u32 v43, 8187281, v43
    v_bfe_u32 v39, v31, 24, 2
    v_lshlrev_b32 v35, 2, v35
    v_lshrrev_b32 v43, 24, v43
    v_lshl_or_b32 v35, v39, 8, v35
    v_lshl_or_b32 v35, v43, 7, v35
    ds_add_rtn_u32 v39, v35, v7
    v_lshrrev_b32 v28, 24, v28
    v_mad_u32_u24 v28, v28, s59, 7
    v_lshrrev_b32 v28, 3, v28
    v_mad_u32_u24 v28, v40, 40, v28
    v_sub_u32 v28, v12, v28
    v_add_u32 v12, 0, v3
    v_lshl_or_b32 v28, v28, 26, v12
    v_lshrrev_b32 v29, 24, v29
    v_mad_u32_u24 v29, v29, s59, 7
    v_lshrrev_b32 v29, 3, v29
    v_mad_u32_u24 v29, v41, 40, v29
    v_sub_u32 v29, v13, v29
    v_add_u32 v13, 32, v3
    v_lshl_or_b32 v29, v29, 26, v13
    v_lshrrev_b32 v30, 24, v30
    v_mad_u32_u24 v30, v30, s59, 7
    v_lshrrev_b32 v30, 3, v30
    v_mad_u32_u24 v30, v42, 40, v30
    v_sub_u32 v30, v14, v30
    v_add_u32 v14, 64, v3
    v_lshl_or_b32 v30, v30, 26, v14
    v_lshrrev_b32 v31, 24, v31
    v_mad_u32_u24 v31, v31, s59, 7
    v_lshrrev_b32 v31, 3, v31
    v_mad_u32_u24 v31, v43, 40, v31
    v_sub_u32 v31, v15, v31
    v_add_u32 v15, 96, v3
    v_lshl_or_b32 v31, v31, 26, v15
K2_PAD_S2:
    s_cbranch_execz KS_HOP0
    v_mov_b32 v59, 163456
    s_mul_i32 s65, s2, 1152
    s_add_u32 s65, s65, 6291456
    s_mul_i32 s64, s2, 20608
    s_waitcnt lgkmcnt(0)
    s_barrier
    ds_read_b128 v[40:43], v9
    ds_read_b32 v59, v59
    s_waitcnt lgkmcnt(1)
    v_add_u32 v45, v40, v41
    v_add_u32 v46, v45, v42
    v_add_u32 v47, v46, v43
    v_mov_b32 v58, v47
    s_nop 1
    v_add_u32_dpp v58, v58, v58 row_shr:1 row_mask:0xf bank_mask:0xf bound_ctrl:0
    s_nop 1
    v_add_u32_dpp v58, v58, v58 row_shr:2 row_mask:0xf bank_mask:0xf bound_ctrl:0
    s_nop 1
    v_add_u32_dpp v58, v58, v58 row_shr:4 row_mask:0xf bank_mask:0xf bound_ctrl:0
    s_nop 1
    v_add_u32_dpp v58, v58, v58 row_shr:8 row_mask:0xf bank_mask:0xf bound_ctrl:0
    s_nop 1
    v_add_u32_dpp v58, v58, v58 row_bcast:15 row_mask:0xa bank_mask:0xf
    s_nop 1
    v_add_u32_dpp v58, v58, v58 row_bcast:31 row_mask:0xc bank_mask:0xf
    v_sub_u32 v48, v58, v47
    v_add_u32 v49, v48, v40
    v_add_u32 v50, v48, v45
    v_add_u32 v51, v48, v46
    ds_write_b128 v9, v[48:51] offset:1024
    s_waitcnt lgkmcnt(1)
    s_cmp_lg_u32 s20, 4
    s_cbranch_scc1 KS_NOPUB
    v_lshl_or_b32 v56, v49, 11, v48
    v_lshl_or_b32 v57, v51, 11, v50
    v_lshl_or_b32 v56, v59, 22, v56
    v_lshl_or_b32 v57, v59, 22, v57
    buffer_store_dwordx4 v[56:59], v9, s[8:11], s65 offen sc1
KS_NOPUB:
    s_waitcnt lgkmcnt(0)
    ds_read_b32 v32, v32 offset:1024
    ds_read_b32 v33, v33 offset:1024
    ds_read_b32 v34, v34 offset:1024
    ds_read_b32 v35, v35 offset:1024
    s_cbranch_scc1 KS_PUB0
    s_waitcnt vmcnt(1)
    s_branch KS_PUB1
KS_PUB0:
    s_waitcnt vmcnt(0)
KS_PUB1:
    v_and_b32 v60, 0xffff, v59
    v_and_b32 v61, 0xffff0000, v59
    s_mov_b32 s58, 0xffff0000
    v_xor_b32 v40, 0x80000000, v20
    v_lshl_or_b32 v41, v21, 16, v60
    v_or_b32 v42, v61, v16
    v_mov_b32 v43, v28
    v_alignbit_b32 v44, v22, v21, 16
    v_and_or_b32 v45, v22, s58, v60
    v_xor_b32 v44, 0x80000000, v44
    v_or_b32 v46, v61, v17
    v_mov_b32 v47, v29
    v_xor_b32 v48, 0x80000000, v23
    v_lshl_or_b32 v49, v24, 16, v60
    v_or_b32 v50, v61, v18
    v_mov_b32 v51, v30
    v_alignbit_b32 v52, v25, v24, 16
    v_and_or_b32 v53, v25, s58, v60
    v_xor_b32 v52, 0x80000000, v52
    v_or_b32 v54, v61, v19
    v_mov_b32 v55, v31
    s_waitcnt lgkmcnt(0)
    v_add_lshl_u32 v32, v32, v36, 4
    ds_write_b128 v32, v[40:43] offset:2048
    v_add_lshl_u32 v33, v33, v37, 4
    ds_write_b128 v33, v[44:47] offset:2048
    v_add_lshl_u32 v34, v34, v38, 4
    ds_write_b128 v34, v[48:51] offset:2048
    v_add_lshl_u32 v35, v35, v39, 4
    ds_write_b128 v35, v[52:55] offset:2048
    v_mov_b32 v62, 163460
    s_waitcnt lgkmcnt(0)
    s_barrier
    ds_read_b32 v62, v62
    ds_read_b128 v[12:15], v5 offset:2048
    ds_read_b128 v[16:19], v5 offset:7168
    ds_read_b128 v[20:23], v5 offset:12288
    ds_read_b128 v[24:27], v5 offset:17408
    s_waitcnt lgkmcnt(3)
    buffer_store_dwordx4 v[12:15], v5, s[8:11], s64 offen sc1
    s_add_u32 s64, s64, 5120
    s_waitcnt lgkmcnt(2)
    buffer_store_dwordx4 v[16:19], v5, s[8:11], s64 offen sc1
    s_add_u32 s64, s64, 5120
    s_waitcnt lgkmcnt(1)
    buffer_store_dwordx4 v[20:23], v5, s[8:11], s64 offen sc1
    s_add_u32 s64, s64, 5120
    s_waitcnt lgkmcnt(0)
    buffer_store_dwordx4 v[24:27], v5, s[8:11], s64 offen sc1
    s_branch KS_JOIN
K2_PAD_B3:
    s_branch KS_HOP
KS_B3:
    v_mov_b32 v59, 163456
    ds_read_b32 v59, v59
    v_mov_b32 v62, 163460
    s_waitcnt lgkmcnt(0)
    s_barrier
    ds_read_b32 v62, v62
KS_JOIN:
    s_setprio 0
    v_readfirstlane_b32 s2, v59
    s_mov_b32 s25, 0x400000
KS_JOIN2:
    s_waitcnt lgkmcnt(0)
    v_readfirstlane_b32 s24, v62
    s_nop 0
    s_cmp_eq_u32 s24, 0
    s_cbranch_scc1 KS_FLS
    s_bfe_u32 s24, s24, 0x10001
    s_xor_b32 s54, s54, s24
    s_lshr_b32 s21, s54, 1
    s_mul_i32 s21, s21, 625
    s_add_u32 s22, s21, 632
    s_add_u32 s21, s21, 7
    s_lshr_b32 s21, s21, 3
    s_lshr_b32 s22, s22, 3
    s_add_u32 s24, s21, 40
    s_sub_u32 s22, s22, s24
    s_bitcmp1_b32 s54, 0
    s_cselect_b32 s21, s24, s21
    s_cselect_b32 s22, s22, 40
    s_mov_b32 s23, 0
    s_mov_b32 s28, 1
    s_mov_b32 s24, 0
    s_mov_b32 s25, 1
K2_CELLS:
    v_lshrrev_b32 v178, 1, v177
    v_min_u32 v178, 249, v178
    v_mul_u32_u24 v72, 1152, v178
    s_and_b32 s58, s54, 7
    s_lshl_b32 s58, s58, 7
    s_lshr_b32 s59, s54, 5
    s_lshl_b32 s59, s59, 4
    s_add_u32 s67, s58, s59
    s_add_u32 s67, s67, 6291456
    s_cmp_eq_u32 s28, 0
    s_cbranch_scc1 K2_NOSRD
    s_mov_b32 s4, s80
    s_and_b32 s5, s81, 0xffff
    s_mov_b32 s6, 10240000
    s_mov_b32 s7, 0x20000
    s_mov_b32 s12, s96
    s_and_b32 s13, s97, 0xffff
    s_mov_b32 s14, 10240000
    s_mov_b32 s15, 0x20000
    s_mov_b32 s16, s84
    s_and_b32 s17, s85, 0xffff
    s_mov_b32 s18, 10240000
    s_mov_b32 s19, 0x20000
    s_sub_u32 s80, s80, 1024
    s_subb_u32 s81, s81, 0
    s_mov_b32 s72, s80
    s_and_b32 s73, s81, 0xffff
    s_mov_b32 s74, 10241024
    s_mov_b32 s75, 0x20000
K2_NOSRD:
    v_and_b32 v84, 15, v176
    v_lshrrev_b32 v85, 5, v176
    v_bfe_u32 v86, v176, 4, 1
    v_lshrrev_b32 v87, 2, v84
    v_and_b32 v88, 3, v84
    v_lshl_add_u32 v89, v85, 2, v87
    v_lshlrev_b32 v249, 6, v89
    v_lshl_add_u32 v249, v88, 3, v249
    v_add_u32 v249, 512, v249
    v_lshrrev_b32 v90, 3, v84
    v_lshl_add_u32 v90, v90, 1, v86
    v_sub_u32 v90, v90, 1 clamp
    v_lshlrev_b32 v250, 1, v90
    v_lshl_add_u32 v91, v85, 2, v88
    v_lshl_add_u32 v250, v91, 4, v250
    v_and_b32 v91, 1, v87
    v_lshl_add_u32 v250, v91, 3, v250
    v_lshrrev_b32 v90, 1, v88
    v_lshl_add_u32 v90, v86, 1, v90
    v_bfe_u32 v91, v87, 1, 1
    v_lshlrev_b32 v91, 2, v91
    v_xor_b32 v90, v90, v91
    v_lshlrev_b32 v90, 4, v90
    v_lshl_add_u32 v90, v89, 7, v90
    v_and_b32 v91, 1, v88
    v_lshl_add_u32 v90, v91, 3, v90
    v_add_u32 v246, s37, v90
    v_xor_b32 v247, 64, v246
    v_lshrrev_b32 v90, 3, v176
    v_lshlrev_b32 v251, 4, v90
    v_bfe_u32 v90, v90, 1, 1
    v_lshlrev_b32 v90, 2, v90
    v_and_b32 v91, 7, v176
    v_xor_b32 v90, v90, v91
    v_lshlrev_b32 v248, 4, v90
    v_lshlrev_b32 v252, 1, v176
    v_and_b32 v233, 1, v176
    v_lshlrev_b32 v233, 4, v233
    v_lshrrev_b32 v90, 1, v176
    v_lshlrev_b32 v90, 5, v90
    v_add_u32 v232, 512, v90
    s_cmp_eq_u32 s28, 0
    s_cbranch_scc1 K2_NOW0
    v_lshrrev_b32 v60, 6, v252
    v_bfe_u32 v61, v252, 3, 2
    v_lshl_add_u32 v60, v60, 2, v61
    v_mul_u32_u24 v60, 640, v60
    v_bfe_u32 v61, v252, 5, 1
    v_lshl_add_u32 v60, v61, 5, v60
    v_and_b32 v61, 6, v252
    v_lshl_add_u32 v60, v61, 2, v60
    v_add_u32 v60, 24576, v60
    ds_read_b64_tr_b16 v[136:137], v60 offset:0
    ds_read_b64_tr_b16 v[138:139], v60 offset:5120
    ds_read_b64_tr_b16 v[140:141], v60 offset:64
    ds_read_b64_tr_b16 v[142:143], v60 offset:5184
    ds_read_b64_tr_b16 v[144:145], v60 offset:128
    ds_read_b64_tr_b16 v[146:147], v60 offset:5248
    ds_read_b64_tr_b16 v[148:149], v60 offset:192
    ds_read_b64_tr_b16 v[150:151], v60 offset:5312
    ds_read_b64_tr_b16 v[152:153], v60 offset:256
    ds_read_b64_tr_b16 v[154:155], v60 offset:5376
    ds_read_b64_tr_b16 v[156:157], v60 offset:320
    ds_read_b64_tr_b16 v[158:159], v60 offset:5440
    ds_read_b64_tr_b16 v[160:161], v60 offset:384
    ds_read_b64_tr_b16 v[162:163], v60 offset:5504
    ds_read_b64_tr_b16 v[164:165], v60 offset:448
    ds_read_b64_tr_b16 v[166:167], v60 offset:5568
    ds_read_b64_tr_b16 v[168:169], v60 offset:512
    ds_read_b64_tr_b16 v[170:171], v60 offset:5632
    ds_read_b64_tr_b16 v[172:173], v60 offset:576
    ds_read_b64_tr_b16 v[174:175], v60 offset:5696
    s_waitcnt lgkmcnt(0)
    v_lshlrev_b32 v96, 16, v136
    v_and_b32 v97, 0xffff0000, v136
    v_lshlrev_b32 v98, 16, v137
    v_and_b32 v99, 0xffff0000, v137
    v_lshlrev_b32 v100, 16, v138
    v_and_b32 v101, 0xffff0000, v138
    v_lshlrev_b32 v102, 16, v139
    v_and_b32 v103, 0xffff0000, v139
    v_lshlrev_b32 v104, 16, v140
    v_and_b32 v105, 0xffff0000, v140
    v_lshlrev_b32 v106, 16, v141
    v_and_b32 v107, 0xffff0000, v141
    v_lshlrev_b32 v108, 16, v142
    v_and_b32 v109, 0xffff0000, v142
    v_lshlrev_b32 v110, 16, v143
    v_and_b32 v111, 0xffff0000, v143
    v_lshlrev_b32 v112, 16, v144
    v_and_b32 v113, 0xffff0000, v144
    v_lshlrev_b32 v114, 16, v145
    v_and_b32 v115, 0xffff0000, v145
    v_lshlrev_b32 v116, 16, v146
    v_and_b32 v117, 0xffff0000, v146
    v_lshlrev_b32 v118, 16, v147
    v_and_b32 v119, 0xffff0000, v147
    v_lshlrev_b32 v120, 16, v148
    v_and_b32 v121, 0xffff0000, v148
    v_lshlrev_b32 v122, 16, v149
    v_and_b32 v123, 0xffff0000, v149
    v_lshlrev_b32 v124, 16, v150
    v_and_b32 v125, 0xffff0000, v150
    v_lshlrev_b32 v126, 16, v151
    v_and_b32 v127, 0xffff0000, v151
    buffer_load_dwordx4 v[76:79], v72, s[8:11], s67 offen sc1
    s_mov_b64 exec, 0
    s_cmp_eq_u32 s20, 0
    s_cbranch_scc1 K2_PAD_U20
    s_cmp_eq_u32 s20, 1
    s_cbranch_scc1 K2_PAD_U30
    s_cmp_eq_u32 s20, 2
    s_cbranch_scc1 K2_PAD_U21
    s_cmp_eq_u32 s20, 3
    s_cbranch_scc1 K2_PAD_U31
    s_cmp_eq_u32 s20, 7
    s_cbranch_scc1 K2_PAD_SW
    s_cmp_eq_u32 s20, 5
    s_cbranch_scc1 K2_PAD_TL
    s_cmp_eq_u32 s20, 6
    s_cbranch_scc1 K2_PAD_T2
K2_HOP:
    s_mov_b64 exec, -1
    v_lshlrev_b32 v128, 16, v152
    v_and_b32 v129, 0xffff0000, v152
    v_lshlrev_b32 v130, 16, v153
    v_and_b32 v131, 0xffff0000, v153
    v_lshlrev_b32 v132, 16, v154
    v_and_b32 v133, 0xffff0000, v154
    v_lshlrev_b32 v134, 16, v155
    v_and_b32 v135, 0xffff0000, v155
    v_lshlrev_b32 v136, 16, v156
    v_and_b32 v137, 0xffff0000, v156
    v_lshlrev_b32 v138, 16, v157
    v_and_b32 v139, 0xffff0000, v157
    v_lshlrev_b32 v140, 16, v158
    v_and_b32 v141, 0xffff0000, v158
    v_lshlrev_b32 v142, 16, v159
    v_and_b32 v143, 0xffff0000, v159
    v_lshlrev_b32 v144, 16, v160
    v_and_b32 v145, 0xffff0000, v160
    v_lshlrev_b32 v146, 16, v161
    v_and_b32 v147, 0xffff0000, v161
    v_lshlrev_b32 v148, 16, v162
    v_and_b32 v149, 0xffff0000, v162
    v_lshlrev_b32 v150, 16, v163
    v_and_b32 v151, 0xffff0000, v163
    v_lshlrev_b32 v152, 16, v164
    v_and_b32 v153, 0xffff0000, v164
    v_lshlrev_b32 v154, 16, v165
    v_and_b32 v155, 0xffff0000, v165
    v_lshlrev_b32 v156, 16, v166
    v_and_b32 v157, 0xffff0000, v166
    v_lshlrev_b32 v158, 16, v167
    v_and_b32 v159, 0xffff0000, v167
    v_lshlrev_b32 v160, 16, v168
    v_and_b32 v161, 0xffff0000, v168
    v_lshlrev_b32 v162, 16, v169
    v_and_b32 v163, 0xffff0000, v169
    v_lshlrev_b32 v164, 16, v170
    v_and_b32 v165, 0xffff0000, v170
    v_lshlrev_b32 v166, 16, v171
    v_and_b32 v167, 0xffff0000, v171
    v_lshlrev_b32 v168, 16, v172
    v_and_b32 v169, 0xffff0000, v172
    v_lshlrev_b32 v170, 16, v173
    v_and_b32 v171, 0xffff0000, v173
    v_lshlrev_b32 v172, 16, v174
    v_and_b32 v173, 0xffff0000, v174
    v_lshlrev_b32 v174, 16, v175
    v_and_b32 v175, 0xffff0000, v175
K2_W0:
    s_lshl_b32 s59, s2, 22
    s_mov_b32 s60, 0x40000
    s_bfe_u32 s61, s54, 0x10004
    s_bfe_u32 s62, s54, 0x10003
    s_add_u32 s63, s61, s62
    s_mul_i32 s62, s62, 11
    s_sub_u32 s64, 11, s62
    v_cmp_gt_u32 vcc, 500, v177
    s_nop 0
    s_mov_b64 s[56:57], vcc
K2_POLL:
    s_waitcnt vmcnt(0)
    v_xor_b32 v73, s59, v76
    v_xor_b32 v74, s59, v77
    v_or_b32 v73, v73, v74
    v_xor_b32 v74, s2, v79
    v_lshrrev_b32 v73, 22, v73
    v_or_b32 v73, v73, v74
    v_cmp_ne_u32 vcc, 0, v73
    s_nop 0
    s_cbranch_vccz K2_POLLED
    s_sub_u32 s60, s60, 1
    s_cbranch_scc1 K2_END
    s_mov_b64 exec, vcc
    buffer_load_dwordx4 v[76:79], v72, s[8:11], s67 offen sc1
    s_mov_b64 exec, -1
    s_branch K2_POLL
K2_PAD_LD:
    s_branch KS_HOP
K2_POLLED:
    s_set_gpr_idx_on s61, gpr_idx(SRC0)
    s_nop 0
    v_bfe_u32 v179, v76, s62, 11
    s_set_gpr_idx_idx s63
    s_nop 0
    v_bfe_u32 v73, v76, s64, 11
    s_set_gpr_idx_off
    v_sub_u32 v73, v73, v179
    v_cndmask_b32 v73, 0, v73, s[56:57]
    v_and_b32 v1, 1, v177
    v_add_u32 v1, s23, v1
    v_sub_u32 v180, v73, v1
    v_add_u32 v179, v179, v1
    v_mul_u32_u24 v181, 20608, v178
    v_lshl_add_u32 v181, v179, 4, v181
    v_cmp_lt_i32 s[40:41], 0, v180
    v_add_u32 v182, 32, v181
    s_mov_b32 s65, 0
    s_mov_b64 exec, s[40:41]
    buffer_load_dwordx4 v[0:3], v181, s[8:11], 0 offen offset:0 sc1
    s_mov_b64 exec, -1
    v_cmp_lt_i32 s[42:43], 2, v180
    v_cmp_lt_i32 s[44:45], 4, v180
    v_cmp_lt_i32 s[46:47], 6, v180
    v_cmp_lt_i32 s[48:49], 8, v180
    v_cmp_lt_i32 s[50:51], 10, v180
    v_cmp_lt_i32 s[90:91], 12, v180
    v_cmp_lt_i32 s[92:93], 14, v180
    v_cmp_lt_i32 s[94:95], 16, v180
    v_cmp_lt_i32 s[96:97], 18, v180
    v_add_u32 v183, 64, v181
    v_add_u32 v184, 96, v181
    v_subrev_u32 v62, 1, v180
    v_ashrrev_i32 v62, 1, v62
    v_med3_i32 v62, v62, 0, 9
    s_cmp_eq_u64 s[42:43], 0
    s_cbranch_scc1 K2_LD_DONE
    v_mov_b32 v63, v62
    s_nop 1
    v_add_u32_dpp v63, v63, v63 row_shr:1 row_mask:0xf bank_mask:0xf bound_ctrl:0
    s_nop 1
    v_add_u32_dpp v63, v63, v63 row_shr:2 row_mask:0xf bank_mask:0xf bound_ctrl:0
    s_nop 1
    v_add_u32_dpp v63, v63, v63 row_shr:4 row_mask:0xf bank_mask:0xf bound_ctrl:0
    s_nop 1
    v_add_u32_dpp v63, v63, v63 row_shr:8 row_mask:0xf bank_mask:0xf bound_ctrl:0
    s_nop 1
    v_add_u32_dpp v63, v63, v63 row_bcast:15 row_mask:0xa bank_mask:0xf
    s_nop 1
    v_add_u32_dpp v63, v63, v63 row_bcast:31 row_mask:0xc bank_mask:0xf
    s_lshl_b32 s58, s20, 10
    s_add_u32 s58, s58, 45056
    v_readlane_b32 s59, v63, 63
    v_sub_u32 v63, v63, v62
    v_lshl_add_u32 v64, v63, 2, s58
    v_lshlrev_b32 v63, 5, v63
    v_sub_u32 v63, v182, v63
    s_cmp_gt_u32 s59, 189
    s_cbranch_scc1 K2_LD_GEN
    s_mov_b64 exec, s[42:43]
    s_cbranch_execz K2_LD_L
    ds_write_b32 v64, v63 offset:0
    s_mov_b64 exec, s[44:45]
    s_cbranch_execz K2_LD_L
    ds_write_b32 v64, v63 offset:4
    s_mov_b64 exec, s[46:47]
    s_cbranch_execz K2_LD_L
    ds_write_b32 v64, v63 offset:8
    s_mov_b64 exec, s[48:49]
    s_cbranch_execz K2_LD_L
    ds_write_b32 v64, v63 offset:12
    s_mov_b64 exec, s[50:51]
    s_cbranch_execz K2_LD_L
    ds_write_b32 v64, v63 offset:16
    s_mov_b64 exec, s[90:91]
    s_cbranch_execz K2_LD_L
    ds_write_b32 v64, v63 offset:20
    s_mov_b64 exec, s[92:93]
    s_cbranch_execz K2_LD_L
    ds_write_b32 v64, v63 offset:24
    s_mov_b64 exec, s[94:95]
    s_cbranch_execz K2_LD_L
    ds_write_b32 v64, v63 offset:28
    s_mov_b64 exec, s[96:97]
    s_cbranch_execz K2_LD_L
    ds_write_b32 v64, v63 offset:32
K2_LD_L:
    s_mov_b64 exec, -1
    v_lshl_add_u32 v63, v176, 2, s58
    v_lshlrev_b32 v62, 5, v176
    s_waitcnt lgkmcnt(0)
    ds_read_b32 v64, v63 offset:0
    ds_read_b32 v65, v63 offset:252
    ds_read_b32 v66, v63 offset:504
    s_min_u32 s60, s59, 63
    s_sub_u32 s59, s59, s60
    s_bfm_b64 s[42:43], s60, 0
    s_min_u32 s60, s59, 63
    s_sub_u32 s59, s59, s60
    s_bfm_b64 s[44:45], s60, 0
    s_min_u32 s60, s59, 63
    s_sub_u32 s59, s59, s60
    s_bfm_b64 s[46:47], s60, 0
    s_mov_b64 s[48:49], 0
    s_mov_b32 s65, 1
    s_mov_b32 s60, 0
    s_waitcnt lgkmcnt(2)
    v_add3_u32 v182, v62, v64, s60
    s_mov_b64 exec, s[42:43]
    buffer_load_dwordx4 v[4:7], v182, s[8:11], 0 offen sc1
    s_mov_b32 s60, 2016
    s_waitcnt lgkmcnt(1)
    v_add3_u32 v183, v62, v65, s60
    s_mov_b64 exec, s[44:45]
    buffer_load_dwordx4 v[8:11], v183, s[8:11], 0 offen sc1
    s_mov_b32 s60, 4032
    s_waitcnt lgkmcnt(0)
    v_add3_u32 v184, v62, v66, s60
    s_mov_b64 exec, s[46:47]
    buffer_load_dwordx4 v[12:15], v184, s[8:11], 0 offen sc1
K2_LD_DONE:
    s_mov_b64 exec, -1
    s_cmp_eq_u32 s28, 0
    s_cbranch_scc1 K2_WLATE
K2_NOWRAW:
K2_PAD_NW:
    s_cbranch_execz KS_HOP
    v_lshrrev_b32 v179, 2, v181
    v_lshrrev_b32 v185, 2, v182
    v_lshrrev_b32 v186, 2, v183
    v_lshrrev_b32 v187, 2, v184
    s_mov_b32 s66, 7340032
    v_mov_b32 v201, 1
    s_movk_i32 s58, 520
    s_movk_i32 s59, 2080
    s_mov_b32 s60, 0x40000
    s_mov_b32 s61, 0xffff
    v_mov_b32 v202, 65536
    s_cmp_lg_u32 s24, 0
    s_cbranch_scc1 K2_RK_LOAD
    v_cmp_lt_i32 vcc, 20, v180
    s_nop 0
    s_cbranch_vccz K2_NOMORE
    v_mov_b32 v61, 163304
    ds_write_b32 v61, v201
K2_NOMORE:
    s_mov_b32 s62, 82176
    s_cmp_eq_u32 s65, 0
    s_waitcnt vmcnt(3)
    s_cbranch_scc0 K2_ARR
    s_waitcnt vmcnt(0)
K2_ARR:
    s_mov_b64 exec, s[40:41]
    s_cbranch_execz K2_RK_A
K2_CK0:
    v_bfi_b32 v192, s61, v1, v2
    v_lshrrev_b32 v50, 24, v3
    v_cmp_ne_u32 vcc, s2, v192
    v_add_u32 v40, 163072, v50
    s_cbranch_vccnz K2_RT0
    ds_add_rtn_u32 v40, v40, v201
    v_mad_u32_u24 v50, v50, s58, v202
    s_mov_b64 exec, s[42:43]
    s_cbranch_execz K2_RK_A
    s_waitcnt vmcnt(2)
K2_CK1:
    v_bfi_b32 v192, s61, v5, v6
    v_lshrrev_b32 v51, 24, v7
    v_cmp_ne_u32 vcc, s2, v192
    v_add_u32 v41, 163072, v51
    s_cbranch_vccnz K2_RT1
    ds_add_rtn_u32 v41, v41, v201
    v_mad_u32_u24 v51, v51, s58, v202
    s_mov_b64 exec, s[44:45]
    s_cbranch_execz K2_RK_A
    s_waitcnt vmcnt(1)
K2_CK2:
    v_bfi_b32 v192, s61, v9, v10
    v_lshrrev_b32 v52, 24, v11
    v_cmp_ne_u32 vcc, s2, v192
    v_add_u32 v42, 163072, v52
    s_cbranch_vccnz K2_RT2
    ds_add_rtn_u32 v42, v42, v201
    v_mad_u32_u24 v52, v52, s58, v202
    s_mov_b64 exec, s[46:47]
    s_cbranch_execz K2_RK_A
    s_waitcnt vmcnt(0)
K2_CK3:
    v_bfi_b32 v192, s61, v13, v14
    v_lshrrev_b32 v53, 24, v15
    v_cmp_ne_u32 vcc, s2, v192
    v_add_u32 v43, 163072, v53
    s_cbranch_vccnz K2_RT3
    ds_add_rtn_u32 v43, v43, v201
    v_mad_u32_u24 v53, v53, s58, v202
    s_mov_b64 exec, s[48:49]
    s_cbranch_execz K2_RK_A
K2_CK4:
    v_bfi_b32 v192, s61, v17, v18
    v_lshrrev_b32 v54, 24, v19
    v_cmp_ne_u32 vcc, s2, v192
    v_add_u32 v44, 163072, v54
    s_cbranch_vccnz K2_RT4
    ds_add_rtn_u32 v44, v44, v201
    v_mad_u32_u24 v54, v54, s58, v202
    s_mov_b64 exec, s[50:51]
    s_cbranch_execz K2_RK_A
K2_CK5:
    v_bfi_b32 v192, s61, v21, v22
    v_lshrrev_b32 v55, 24, v23
    v_cmp_ne_u32 vcc, s2, v192
    v_add_u32 v45, 163072, v55
    s_cbranch_vccnz K2_RT5
    ds_add_rtn_u32 v45, v45, v201
    v_mad_u32_u24 v55, v55, s58, v202
    s_mov_b64 exec, s[90:91]
    s_cbranch_execz K2_RK_A
K2_CK6:
    v_bfi_b32 v192, s61, v25, v26
    v_lshrrev_b32 v56, 24, v27
    v_cmp_ne_u32 vcc, s2, v192
    v_add_u32 v46, 163072, v56
    s_cbranch_vccnz K2_RT6
    ds_add_rtn_u32 v46, v46, v201
    v_mad_u32_u24 v56, v56, s58, v202
    s_mov_b64 exec, s[92:93]
    s_cbranch_execz K2_RK_A
K2_CK7:
    v_bfi_b32 v192, s61, v29, v30
    v_lshrrev_b32 v57, 24, v31
    v_cmp_ne_u32 vcc, s2, v192
    v_add_u32 v47, 163072, v57
    s_cbranch_vccnz K2_RT7
    ds_add_rtn_u32 v47, v47, v201
    v_mad_u32_u24 v57, v57, s58, v202
    s_mov_b64 exec, s[94:95]
    s_cbranch_execz K2_RK_A
K2_CK8:
    v_bfi_b32 v192, s61, v33, v34
    v_lshrrev_b32 v58, 24, v35
    v_cmp_ne_u32 vcc, s2, v192
    v_add_u32 v48, 163072, v58
    s_cbranch_vccnz K2_RT8
    ds_add_rtn_u32 v48, v48, v201
    v_mad_u32_u24 v58, v58, s58, v202
    s_mov_b64 exec, s[96:97]
    s_cbranch_execz K2_RK_A
K2_CK9:
    v_bfi_b32 v192, s61, v37, v38
    v_lshrrev_b32 v59, 24, v39
    v_cmp_ne_u32 vcc, s2, v192
    v_add_u32 v49, 163072, v59
    s_cbranch_vccnz K2_RT9
    ds_add_rtn_u32 v49, v49, v201
    v_mad_u32_u24 v59, v59, s58, v202
K2_RK_A:
    s_mov_b64 exec, -1
    s_mov_b64 exec, s[40:41]
    s_cbranch_execz K2_TP
    v_cmp_gt_u32 vcc, s62, v50
    v_and_b32 v3, 0xffffff, v3
    s_mov_b64 exec, vcc
    buffer_load_dword v245, v3, s[16:19], 0 offen
    s_mov_b64 exec, s[42:43]
    s_cbranch_execz K2_TP
    v_cmp_gt_u32 vcc, s62, v51
    v_and_b32 v7, 0xffffff, v7
    s_mov_b64 exec, vcc
    buffer_load_dword v245, v7, s[16:19], 0 offen
    s_mov_b64 exec, s[44:45]
    s_cbranch_execz K2_TP
    v_cmp_gt_u32 vcc, s62, v52
    v_and_b32 v11, 0xffffff, v11
    s_mov_b64 exec, vcc
    buffer_load_dword v245, v11, s[16:19], 0 offen
    s_mov_b64 exec, s[46:47]
    s_cbranch_execz K2_TP
    v_cmp_gt_u32 vcc, s62, v53
    v_and_b32 v15, 0xffffff, v15
    s_mov_b64 exec, vcc
    buffer_load_dword v245, v15, s[16:19], 0 offen
    s_mov_b64 exec, s[48:49]
    s_cbranch_execz K2_TP
    v_cmp_gt_u32 vcc, s62, v54
    v_and_b32 v19, 0xffffff, v19
    s_mov_b64 exec, vcc
    buffer_load_dword v245, v19, s[16:19], 0 offen
    s_mov_b64 exec, s[50:51]
    s_cbranch_execz K2_TP
    v_cmp_gt_u32 vcc, s62, v55
    v_and_b32 v23, 0xffffff, v23
    s_mov_b64 exec, vcc
    buffer_load_dword v245, v23, s[16:19], 0 offen
    s_mov_b64 exec, s[90:91]
    s_cbranch_execz K2_TP
    v_cmp_gt_u32 vcc, s62, v56
    v_and_b32 v27, 0xffffff, v27
    s_mov_b64 exec, vcc
    buffer_load_dword v245, v27, s[16:19], 0 offen
    s_mov_b64 exec, s[92:93]
    s_cbranch_execz K2_TP
    v_cmp_gt_u32 vcc, s62, v57
    v_and_b32 v31, 0xffffff, v31
    s_mov_b64 exec, vcc
    buffer_load_dword v245, v31, s[16:19], 0 offen
    s_mov_b64 exec, s[94:95]
    s_cbranch_execz K2_TP
    v_cmp_gt_u32 vcc, s62, v58
    v_and_b32 v35, 0xffffff, v35
    s_mov_b64 exec, vcc
    buffer_load_dword v245, v35, s[16:19], 0 offen
    s_mov_b64 exec, s[96:97]
    s_cbranch_execz K2_TP
    v_cmp_gt_u32 vcc, s62, v59
    v_and_b32 v39, 0xffffff, v39
    s_mov_b64 exec, vcc
    buffer_load_dword v245, v39, s[16:19], 0 offen
K2_TP:
    s_mov_b64 exec, -1
K2_RK_DONE:
K2_PAD_SC:
    s_cbranch_execz KS_HOP
    s_mul_i32 s67, s24, 48
    s_movk_i32 s58, -1532
    s_waitcnt lgkmcnt(0)
    s_mov_b64 exec, s[40:41]
    s_cbranch_execz K2_SC_DONE
    v_cmpx_gt_u32 vcc, 64, v40
    v_bfe_u32 v194, v40, 3, 1
    v_add_u32 v193, 16, v40
    v_lshl_or_b32 v194, v40, 1, v194
    v_bfi_b32 v194, 15, v194, v40
    v_lshrrev_b32 v193, 6, v193
    v_alignbit_b32 v1, v2, v1, 16
    v_lshl_add_u32 v195, v194, 3, v50
    v_lshl_add_u32 v194, v194, 5, v50
    ds_write_b64 v195, v[0:1]
    v_mad_i32_i24 v194, v193, s58, v194
    ds_write_b32 v194, v3 offset:512
    s_mov_b64 exec, s[42:43]
    s_cbranch_execz K2_SC_DONE
    v_cmpx_gt_u32 vcc, 64, v41
    v_bfe_u32 v194, v41, 3, 1
    v_add_u32 v193, 16, v41
    v_lshl_or_b32 v194, v41, 1, v194
    v_bfi_b32 v194, 15, v194, v41
    v_lshrrev_b32 v193, 6, v193
    v_alignbit_b32 v5, v6, v5, 16
    v_lshl_add_u32 v195, v194, 3, v51
    v_lshl_add_u32 v194, v194, 5, v51
    ds_write_b64 v195, v[4:5]
    v_mad_i32_i24 v194, v193, s58, v194
    ds_write_b32 v194, v7 offset:512
    s_mov_b64 exec, s[44:45]
    s_cbranch_execz K2_SC_DONE
    v_cmpx_gt_u32 vcc, 64, v42
    v_bfe_u32 v194, v42, 3, 1
    v_add_u32 v193, 16, v42
    v_lshl_or_b32 v194, v42, 1, v194
    v_bfi_b32 v194, 15, v194, v42
    v_lshrrev_b32 v193, 6, v193
    v_alignbit_b32 v9, v10, v9, 16
    v_lshl_add_u32 v195, v194, 3, v52
    v_lshl_add_u32 v194, v194, 5, v52
    ds_write_b64 v195, v[8:9]
    v_mad_i32_i24 v194, v193, s58, v194
    ds_write_b32 v194, v11 offset:512
    s_mov_b64 exec, s[46:47]
    s_cbranch_execz K2_SC_DONE
    v_cmpx_gt_u32 vcc, 64, v43
    v_bfe_u32 v194, v43, 3, 1
    v_add_u32 v193, 16, v43
    v_lshl_or_b32 v194, v43, 1, v194
    v_bfi_b32 v194, 15, v194, v43
    v_lshrrev_b32 v193, 6, v193
    v_alignbit_b32 v13, v14, v13, 16
    v_lshl_add_u32 v195, v194, 3, v53
    v_lshl_add_u32 v194, v194, 5, v53
    ds_write_b64 v195, v[12:13]
    v_mad_i32_i24 v194, v193, s58, v194
    ds_write_b32 v194, v15 offset:512
    s_mov_b64 exec, s[48:49]
    s_cbranch_execz K2_SC_DONE
    v_cmpx_gt_u32 vcc, 64, v44
    v_bfe_u32 v194, v44, 3, 1
    v_add_u32 v193, 16, v44
    v_lshl_or_b32 v194, v44, 1, v194
    v_bfi_b32 v194, 15, v194, v44
    v_lshrrev_b32 v193, 6, v193
    v_alignbit_b32 v17, v18, v17, 16
    v_lshl_add_u32 v195, v194, 3, v54
    v_lshl_add_u32 v194, v194, 5, v54
    ds_write_b64 v195, v[16:17]
    v_mad_i32_i24 v194, v193, s58, v194
    ds_write_b32 v194, v19 offset:512
    s_mov_b64 exec, s[50:51]
    s_cbranch_execz K2_SC_DONE
    v_cmpx_gt_u32 vcc, 64, v45
    v_bfe_u32 v194, v45, 3, 1
    v_add_u32 v193, 16, v45
    v_lshl_or_b32 v194, v45, 1, v194
    v_bfi_b32 v194, 15, v194, v45
    v_lshrrev_b32 v193, 6, v193
    v_alignbit_b32 v21, v22, v21, 16
    v_lshl_add_u32 v195, v194, 3, v55
    v_lshl_add_u32 v194, v194, 5, v55
    ds_write_b64 v195, v[20:21]
    v_mad_i32_i24 v194, v193, s58, v194
    ds_write_b32 v194, v23 offset:512
    s_mov_b64 exec, s[90:91]
    s_cbranch_execz K2_SC_DONE
    v_cmpx_gt_u32 vcc, 64, v46
    v_bfe_u32 v194, v46, 3, 1
    v_add_u32 v193, 16, v46
    v_lshl_or_b32 v194, v46, 1, v194
    v_bfi_b32 v194, 15, v194, v46
    v_lshrrev_b32 v193, 6, v193
    v_alignbit_b32 v25, v26, v25, 16
    v_lshl_add_u32 v195, v194, 3, v56
    v_lshl_add_u32 v194, v194, 5, v56
    ds_write_b64 v195, v[24:25]
    v_mad_i32_i24 v194, v193, s58, v194
    ds_write_b32 v194, v27 offset:512
    s_mov_b64 exec, s[92:93]
    s_cbranch_execz K2_SC_DONE
    v_cmpx_gt_u32 vcc, 64, v47
    v_bfe_u32 v194, v47, 3, 1
    v_add_u32 v193, 16, v47
    v_lshl_or_b32 v194, v47, 1, v194
    v_bfi_b32 v194, 15, v194, v47
    v_lshrrev_b32 v193, 6, v193
    v_alignbit_b32 v29, v30, v29, 16
    v_lshl_add_u32 v195, v194, 3, v57
    v_lshl_add_u32 v194, v194, 5, v57
    ds_write_b64 v195, v[28:29]
    v_mad_i32_i24 v194, v193, s58, v194
    ds_write_b32 v194, v31 offset:512
    s_mov_b64 exec, s[94:95]
    s_cbranch_execz K2_SC_DONE
    v_cmpx_gt_u32 vcc, 64, v48
    v_bfe_u32 v194, v48, 3, 1
    v_add_u32 v193, 16, v48
    v_lshl_or_b32 v194, v48, 1, v194
    v_bfi_b32 v194, 15, v194, v48
    v_lshrrev_b32 v193, 6, v193
    v_alignbit_b32 v33, v34, v33, 16
    v_lshl_add_u32 v195, v194, 3, v58
    v_lshl_add_u32 v194, v194, 5, v58
    ds_write_b64 v195, v[32:33]
    v_mad_i32_i24 v194, v193, s58, v194
    ds_write_b32 v194, v35 offset:512
    s_mov_b64 exec, s[96:97]
    s_cbranch_execz K2_SC_DONE
    v_cmpx_gt_u32 vcc, 64, v49
    v_bfe_u32 v194, v49, 3, 1
    v_add_u32 v193, 16, v49
    v_lshl_or_b32 v194, v49, 1, v194
    v_bfi_b32 v194, 15, v194, v49
    v_lshrrev_b32 v193, 6, v193
    v_alignbit_b32 v37, v38, v37, 16
    v_lshl_add_u32 v195, v194, 3, v59
    v_lshl_add_u32 v194, v194, 5, v59
    ds_write_b64 v195, v[36:37]
    v_mad_i32_i24 v194, v193, s58, v194
    ds_write_b32 v194, v39 offset:512
K2_SC_DONE:
    s_mov_b64 exec, -1
K2_PAD_SD:
    s_cbranch_execz KS_HOP
    v_lshlrev_b32 v192, 2, v176
    v_add_u32 v192, 163072, v192
    v_mov_b32 v200, 163304
    s_cmp_eq_u32 s24, 0
    s_cselect_b32 s26, 64, 48
    s_waitcnt lgkmcnt(0)
    s_barrier
    ds_read_b32 v193, v192
    ds_read_b32 v200, v200
    v_cmp_gt_u32 s[56:57], s22, v176
    v_mad_u32_u24 v195, v176, s59, v202
    s_waitcnt lgkmcnt(0)
    v_cndmask_b32 v193, 0, v193, s[56:57]
    v_readfirstlane_b32 s27, v200
    v_cmp_lt_u32 s[62:63], 48, v193
    v_cmp_lt_u32 vcc, 64, v193
    s_bcnt1_i32_b64 s60, s[62:63]
    v_mbcnt_lo_u32_b32 v198, s62, 0
    v_mbcnt_hi_u32_b32 v198, s63, v198
    s_cbranch_vccnz K2_BIG
    s_cmp_gt_u32 s60, 8
    s_cbranch_scc1 K2_BIG
K2_TOK:
    v_subrev_u32 v194, s67, v193
    v_max_i32 v194, 1, v194
    v_min_i32 v194, s26, v194
    v_add_u32 v194, 15, v194
    v_lshrrev_b32 v194, 3, v194
    v_lshl_or_b32 v195, v194, 18, v195
    v_lshl_or_b32 v195, v198, 28, v195
    v_mov_b32 v197, 949760
    v_cndmask_b32 v253, v197, v195, s[56:57]
    s_movk_i32 s40, 0
    s_movk_i32 s41, 256
    s_movk_i32 s42, 512
    s_movk_i32 s43, 768
    s_add_u32 s24, s24, 1
    s_cmp_ge_u32 s24, s25
    s_cselect_b32 s55, 1, 0
    s_cmp_eq_u32 s27, 0
    s_cselect_b32 s55, s55, 0
    s_mov_b32 s27, 0x400000
    s_mov_b32 s38, 0
    s_mov_b32 s34, 0
    s_mov_b32 s35, 0
    s_mov_b32 s36, 1
    s_mov_b32 s31, 0
    s_mov_b32 s58, s20
    v_readlane_b32 s3, v253, s58
    s_lshl_b32 s44, s34, 7
    s_and_b32 s48, s3, 0x3ffff
    s_bfe_u32 s33, s3, 0x30013
    s_mul_i32 s35, s38, 6
    s_cmp_eq_u32 s34, 0
    s_cselect_b32 s35, s35, s48
    s_mov_b32 s45, s44
    s_xor_b32 s47, s44, 256
    s_add_u32 s49, s48, 128
    s_add_u32 s60, s48, 256
    s_cmp_eq_u32 s33, 3
    s_cselect_b32 s46, s44, s47
    s_cselect_b32 s50, s60, s48
    s_sub_u32 s60, s33, 2
    s_cmp_lt_u32 s60, 2
    s_cbranch_scc0 K2_rare_1
K2_back_2:
    v_mov_b32 v44, -1
    v_mov_b32 v45, -1
    v_add_u32 v43, s48, v232
    ds_read_b32 v42, v43
    ds_read_b32 v43, v43 offset:1024
    v_add_u32 v222, s48, v251
    ds_read2_b32 v[222:223], v222 offset0:1 offset1:3
    v_add_u32 v224, s49, v251
    ds_read2_b32 v[224:225], v224 offset0:1 offset1:3
    v_add_u32 v226, s50, v251
    ds_read2_b32 v[226:227], v226 offset0:1 offset1:3
    s_waitcnt lgkmcnt(3)
    v_or_b32 v42, v42, v233
    v_or_b32 v43, v43, v233
    s_cmp_lg_u32 s34, 0
    s_cbranch_scc1 K2_dum_4
    s_cmp_eq_u32 s33, 4
    s_cbranch_scc1 K2_a4_5
K2_b4_7:
    s_add_u32 m0, s48, 512
    s_add_u32 s65, s48, 1536
    buffer_load_dwordx4 v42, s[16:19], 0 offen  lds
    s_mov_b32 m0, s65
    s_mov_b32 exec_hi, 0
    buffer_load_dwordx4 v43, s[16:19], 0 offen  lds
    s_mov_b32 exec_hi, -1
K2_back_6:
    s_waitcnt lgkmcnt(2)
    v_mad_u32_u16 v222, v222, s39, v248 op_sel:[1,0,0,0]
    v_mad_u32_u16 v223, v223, s39, v248 op_sel:[1,0,0,0]
    s_waitcnt lgkmcnt(1)
    v_mad_u32_u16 v224, v224, s39, v248 op_sel:[1,0,0,0]
    v_mad_u32_u16 v225, v225, s39, v248 op_sel:[1,0,0,0]
    s_waitcnt lgkmcnt(0)
    v_mad_u32_u16 v226, v226, s39, v248 op_sel:[1,0,0,0]
    v_mad_u32_u16 v227, v227, s39, v248 op_sel:[1,0,0,0]
    s_mov_b32 m0, s68
    s_nop 0
    buffer_load_dwordx4 v222, s[4:7], s44 offen sc1 lds
    buffer_load_dwordx4 v223, s[72:75], s44 offen offset:1024 sc1 lds
    s_mov_b32 m0, s69
    s_nop 0
    buffer_load_dwordx4 v224, s[4:7], s45 offen sc1 lds
    buffer_load_dwordx4 v225, s[72:75], s45 offen offset:1024 sc1 lds
    s_mov_b32 m0, s70
    s_nop 0
    buffer_load_dwordx4 v226, s[4:7], s46 offen sc1 lds
    buffer_load_dwordx4 v227, s[72:75], s46 offen offset:1024 sc1 lds
    s_mov_b32 m0, s71
    s_cmp_eq_u32 s33, 4
    s_cbranch_scc1 K2_g4_8
    buffer_load_dwordx4 v224, s[4:7], s47 offen sc1 lds
    buffer_load_dwordx4 v225, s[72:75], s47 offen offset:1024 sc1 lds
K2_back_9:
    v_add_u32 v249, s48, v249
    v_add_u32 v250, s48, v250
    v_bfe_u32 v192, v253, 18, 4
    s_sub_u32 s58, s22, 16
    v_cmp_le_u32 vcc, 6, v192
    v_cmp_gt_u32 s[60:61], s58, v176
    s_nop 0
    s_or_b64 vcc, vcc, s[60:61]
    v_mbcnt_lo_u32_b32 v192, vcc_lo, 0
    v_mbcnt_hi_u32_b32 v192, vcc_hi, v192
    s_bcnt1_i32_b64 s58, vcc
    v_sub_u32 v193, v176, v192
    v_add_u32 v193, s58, v193
    v_cndmask_b32 v192, v193, v192, vcc
    v_lshlrev_b32 v192, 2, v192
    ds_permute_b32 v193, v192, v176
    s_waitcnt lgkmcnt(0)
    v_lshl_or_b32 v253, v193, 22, v253
    s_waitcnt vmcnt(6)
    ds_read_b64_tr_b16 v[176:177], v246 offset:0
    ds_read_b64_tr_b16 v[178:179], v246 offset:1024
    ds_read_b64_tr_b16 v[180:181], v247 offset:0
    ds_read_b64_tr_b16 v[182:183], v247 offset:1024
    ds_read_b64_tr_b16 v[0:1], v249 offset:0
    ds_read_b64_tr_b16 v[2:3], v249 offset:32
    ds_read_u16_d16_hi v40, v250 offset:0
    ds_read_b64_tr_b16 v[4:5], v249 offset:512
    ds_read_b64_tr_b16 v[6:7], v249 offset:544
    ds_read_u16_d16_hi v41, v250 offset:128
    s_mov_b32 s29, s48
    s_mov_b32 s32, s31
    s_mov_b32 s30, s3
    s_mov_b32 s31, s35
    s_bfe_u32 s56, s3, 0x40012
    s_cmp_eq_u32 s56, 5
    s_cbranch_scc1 K2_U20
    s_cmp_eq_u32 s56, 6
    s_cbranch_scc1 K2_U3h0
    s_branch K2_DSP0
K2_PAD_H1:
    s_branch KS_HOP0
KS_HELP:
    s_mov_b32 s30, 0
    s_cmp_eq_u32 s20, 6
    s_cbranch_scc1 KS_RAW
    s_mov_b32 s30, 2
    s_cmp_ge_u32 s2, 170
    s_cbranch_scc1 KS_NOW
    s_mov_b32 s30, 1
    v_and_b32 v1, 15, v8
    v_lshrrev_b32 v3, 4, v8
    s_cmp_ge_u32 s2, 160
    s_cbranch_scc1 K1_WT
    s_cmp_ge_u32 s2, 64
    s_cbranch_scc1 K1_S1
    s_lshr_b32 s24, s2, 3
    s_and_b32 s25, s2, 7
    s_lshr_b32 s26, s25, 2
    s_bfe_u32 s27, s25, 0x10001
    s_and_b32 s28, s25, 1
    s_mov_b32 s60, s92
    s_and_b32 s61, s93, 0xffff
    s_mov_b32 s62, 65536
    s_mov_b32 s63, 0x20000
    s_branch K1_SC
K1_S1:
    s_sub_u32 s29, s2, 64
    s_mul_i32 s24, s29, 43
    s_lshr_b32 s24, s24, 9
    s_mul_i32 s25, s24, 12
    s_sub_u32 s25, s29, s25
    s_cmp_ge_u32 s25, 6
    s_cselect_b32 s26, 1, 0
    s_mul_i32 s27, s26, 6
    s_sub_u32 s27, s25, s27
    s_lshr_b32 s27, s27, 1
    s_and_b32 s28, s25, 1
    s_add_u32 s25, s25, 8
    s_mov_b32 s60, s94
    s_and_b32 s61, s95, 0xffff
    s_mov_b32 s62, 98304
    s_mov_b32 s63, 0x20000
K1_SC:
    s_lshl_b32 s27, s27, 7
    s_lshl_b32 s26, s26, 6
    s_lshl_b32 s28, s28, 4
    s_add_u32 s27, s27, s26
    s_add_u32 s27, s27, s28
    s_lshl_b32 s27, s27, 8
    s_lshl_b32 s26, s24, 5
    s_add_u32 s27, s27, s26
    s_add_u32 s29, s27, 8192
    v_lshlrev_b32 v3, 10, v3
    v_lshl_add_u32 v3, v1, 1, v3
    buffer_load_ushort v64, v3, s[60:63], s27 offen offset:0
    buffer_load_ushort v65, v3, s[60:63], s29 offen offset:0
    buffer_load_ushort v66, v3, s[60:63], s27 offen offset:256
    buffer_load_ushort v67, v3, s[60:63], s29 offen offset:256
    buffer_load_ushort v68, v3, s[60:63], s27 offen offset:512
    buffer_load_ushort v69, v3, s[60:63], s29 offen offset:512
    buffer_load_ushort v70, v3, s[60:63], s27 offen offset:768
    buffer_load_ushort v71, v3, s[60:63], s29 offen offset:768
    s_mul_i32 s24, s24, 20
    s_add_u32 s24, s24, s25
    s_lshl_b32 s24, s24, 10
    s_add_u32 s24, s24, 6946816
    s_branch K1_GO
K1_WT:
    s_sub_u32 s24, s2, 160
    s_lshr_b32 s27, s24, 1
    s_and_b32 s28, s24, 1
    s_lshl_b32 s27, s27, 8
    s_lshl_b32 s28, s28, 6
    s_add_u32 s27, s27, s28
    s_add_u32 s29, s27, 10240
    s_mov_b32 s60, s90
    s_and_b32 s61, s91, 0xffff
    s_mov_b32 s62, 20480
    s_mov_b32 s63, 0x20000
    v_and_b32 v1, 31, v8
    v_lshrrev_b32 v3, 5, v8
    v_mul_u32_u24 v3, 5120, v3
    v_lshl_add_u32 v3, v1, 1, v3
    buffer_load_ushort v64, v3, s[60:63], s27 offen offset:0
    buffer_load_ushort v65, v3, s[60:63], s27 offen offset:1280
    buffer_load_ushort v66, v3, s[60:63], s27 offen offset:2560
    buffer_load_ushort v67, v3, s[60:63], s27 offen offset:3840
    buffer_load_ushort v68, v3, s[60:63], s29 offen offset:0
    buffer_load_ushort v69, v3, s[60:63], s29 offen offset:1280
    buffer_load_ushort v70, v3, s[60:63], s29 offen offset:2560
    buffer_load_ushort v71, v3, s[60:63], s29 offen offset:3840
    s_lshl_b32 s24, s24, 10
    s_add_u32 s24, s24, 7110656
K1_GO:
KS_NOW:
    s_barrier
K2_PAD_H2:
    s_cbranch_execz KS_HOP0
    v_and_b32 v76, 31, v8
    v_lshrrev_b32 v77, 5, v8
    v_mov_b32 v80, 0
    v_mul_u32_u24 v77, 2080, v77
    v_mov_b32 v81, 0xffff0000
    v_lshl_add_u32 v78, v76, 4, v77
    v_mov_b32 v82, 0
    v_add_u32 v78, 65536, v78
    v_mov_b32 v83, v81
    v_add_u32 v79, 41600, v78
    ds_write_b128 v78, v[80:83] offset:0
    ds_write_b128 v78, v[80:83] offset:4160
    ds_write_b128 v78, v[80:83] offset:8320
    ds_write_b128 v78, v[80:83] offset:12480
    ds_write_b128 v78, v[80:83] offset:16640
    ds_write_b128 v78, v[80:83] offset:20800
    ds_write_b128 v78, v[80:83] offset:24960
    ds_write_b128 v78, v[80:83] offset:29120
    ds_write_b128 v78, v[80:83] offset:33280
    ds_write_b128 v78, v[80:83] offset:37440
    ds_write_b128 v79, v[80:83] offset:0
    ds_write_b128 v79, v[80:83] offset:4160
    ds_write_b128 v79, v[80:83] offset:8320
    ds_write_b128 v79, v[80:83] offset:12480
    ds_write_b128 v79, v[80:83] offset:16640
    ds_write_b128 v79, v[80:83] offset:20800
    ds_write_b128 v79, v[80:83] offset:24960
    ds_write_b128 v79, v[80:83] offset:29120
    ds_write_b128 v79, v[80:83] offset:33280
    ds_write_b128 v79, v[80:83] offset:37440
KS_FILL:
    v_mov_b32 v59, 163456
    s_barrier
    ds_read_b32 v59, v59
    s_waitcnt vmcnt(0) lgkmcnt(0)
    s_cmp_eq_u32 s30, 0
    s_cbranch_scc1 KS_B3
    s_cmp_eq_u32 s30, 2
    s_cbranch_scc1 KS_NOST
    v_lshl_or_b32 v40, v65, 16, v64
    v_lshl_or_b32 v41, v67, 16, v66
    v_lshl_or_b32 v42, v69, 16, v68
    v_lshl_or_b32 v43, v71, 16, v70
    buffer_store_dwordx4 v[40:43], v9, s[8:11], s24 offen sc1
KS_NOST:
    v_mov_b32 v62, 163460
    s_waitcnt lgkmcnt(0)
    s_barrier
    ds_read_b32 v62, v62
    s_lshl_b32 s24, s2, 2
    s_add_u32 s24, s24, 7176192
    s_mov_b64 exec, 1
    s_waitcnt vmcnt(0)
    buffer_store_dword v59, v6, s[8:11], s24 offen sc1
    s_mov_b64 exec, -1
    s_branch KS_JOIN
K2_PAD_H3:
    s_branch KS_HOP0
KS_RAW:
    s_cmp_lg_u32 s2, 0
    s_cbranch_scc1 KS_NOX
    s_mov_b32 s60, s98
    s_and_b32 s61, s99, 0xffff
    s_mov_b32 s62, 256
    s_mov_b32 s63, 0x20000
    s_getreg_b32 s24, hwreg(HW_REG_XCC_ID, 0, 1)
    s_add_u32 s24, s24, 1
    v_mov_b32 v10, s24
    v_mov_b32 v11, 0
    s_mov_b64 exec, 1
    buffer_atomic_cmpswap v[10:11], v6, s[60:63], 0 offen sc1
    s_mov_b64 exec, -1
KS_NOX:
    s_barrier
    s_mov_b32 s60, s90
    s_and_b32 s61, s91, 0xffff
    s_mov_b32 s62, 20480
    s_mov_b32 s63, 0x20000
    v_lshrrev_b32 v10, 3, v8
    v_and_b32 v11, 7, v8
    v_lshlrev_b32 v10, 8, v10
    v_lshl_add_u32 v10, v11, 4, v10
    s_mov_b32 m0, 24576
    s_movk_i32 s24, 0
    buffer_load_dwordx4 v10, s[60:63], s24 offen lds
    s_mov_b32 m0, 25600
    s_movk_i32 s24, 2048
    buffer_load_dwordx4 v10, s[60:63], s24 offen lds
    s_mov_b32 m0, 26624
    s_movk_i32 s24, 4096
    buffer_load_dwordx4 v10, s[60:63], s24 offen lds
    s_mov_b32 m0, 27648
    s_movk_i32 s24, 6144
    buffer_load_dwordx4 v10, s[60:63], s24 offen lds
    s_mov_b32 m0, 28672
    s_movk_i32 s24, 8192
    buffer_load_dwordx4 v10, s[60:63], s24 offen lds
    s_mov_b32 m0, 29696
    s_movk_i32 s24, 10240
    buffer_load_dwordx4 v10, s[60:63], s24 offen lds
    s_mov_b32 m0, 30720
    s_movk_i32 s24, 12288
    buffer_load_dwordx4 v10, s[60:63], s24 offen lds
    s_mov_b32 m0, 31744
    s_movk_i32 s24, 14336
    buffer_load_dwordx4 v10, s[60:63], s24 offen lds
    s_mov_b32 m0, 32768
    s_movk_i32 s24, 16384
    buffer_load_dwordx4 v10, s[60:63], s24 offen lds
    s_mov_b32 m0, 33792
    s_movk_i32 s24, 18432
    buffer_load_dwordx4 v10, s[60:63], s24 offen lds
    s_mov_b32 m0, 152832
    s_movk_i32 s24, 128
    buffer_load_dwordx4 v10, s[60:63], s24 offen lds
    s_mov_b32 m0, 153856
    s_movk_i32 s24, 2176
    buffer_load_dwordx4 v10, s[60:63], s24 offen lds
    s_mov_b32 m0, 154880
    s_movk_i32 s24, 4224
    buffer_load_dwordx4 v10, s[60:63], s24 offen lds
    s_mov_b32 m0, 155904
    s_movk_i32 s24, 6272
    buffer_load_dwordx4 v10, s[60:63], s24 offen lds
    s_mov_b32 m0, 156928
    s_movk_i32 s24, 8320
    buffer_load_dwordx4 v10, s[60:63], s24 offen lds
    s_mov_b32 m0, 157952
    s_movk_i32 s24, 10368
    buffer_load_dwordx4 v10, s[60:63], s24 offen lds
    s_mov_b32 m0, 158976
    s_movk_i32 s24, 12416
    buffer_load_dwordx4 v10, s[60:63], s24 offen lds
    s_mov_b32 m0, 160000
    s_movk_i32 s24, 14464
    buffer_load_dwordx4 v10, s[60:63], s24 offen lds
    s_mov_b32 m0, 161024
    s_movk_i32 s24, 16512
    buffer_load_dwordx4 v10, s[60:63], s24 offen lds
    s_mov_b32 m0, 162048
    s_movk_i32 s24, 18560
    buffer_load_dwordx4 v10, s[60:63], s24 offen lds
    v_add_u32 v85, 16, v8
    v_lshlrev_b32 v84, 5, v8
    v_lshrrev_b32 v85, 6, v85
    v_mul_u32_u24 v85, 1532, v85
    v_sub_u32 v84, v84, v85
    v_mov_b32 v85, -1
    v_add_u32 v84, 66048, v84
    v_add_u32 v86, 41600, v84
    ds_write_b32 v84, v85 offset:0
    ds_write_b32 v84, v85 offset:2080
    ds_write_b32 v84, v85 offset:4160
    ds_write_b32 v84, v85 offset:6240
    ds_write_b32 v84, v85 offset:8320
    ds_write_b32 v84, v85 offset:10400
    ds_write_b32 v84, v85 offset:12480
    ds_write_b32 v84, v85 offset:14560
    ds_write_b32 v84, v85 offset:16640
    ds_write_b32 v84, v85 offset:18720
    ds_write_b32 v84, v85 offset:20800
    ds_write_b32 v84, v85 offset:22880
    ds_write_b32 v84, v85 offset:24960
    ds_write_b32 v84, v85 offset:27040
    ds_write_b32 v84, v85 offset:29120
    ds_write_b32 v84, v85 offset:31200
    ds_write_b32 v84, v85 offset:33280
    ds_write_b32 v84, v85 offset:35360
    ds_write_b32 v84, v85 offset:37440
    ds_write_b32 v84, v85 offset:39520
    ds_write_b32 v86, v85 offset:0
    ds_write_b32 v86, v85 offset:2080
    ds_write_b32 v86, v85 offset:4160
    ds_write_b32 v86, v85 offset:6240
    ds_write_b32 v86, v85 offset:8320
    ds_write_b32 v86, v85 offset:10400
    ds_write_b32 v86, v85 offset:12480
    ds_write_b32 v86, v85 offset:14560
    ds_write_b32 v86, v85 offset:16640
    ds_write_b32 v86, v85 offset:18720
    ds_write_b32 v86, v85 offset:20800
    ds_write_b32 v86, v85 offset:22880
    ds_write_b32 v86, v85 offset:24960
    ds_write_b32 v86, v85 offset:27040
    ds_write_b32 v86, v85 offset:29120
    ds_write_b32 v86, v85 offset:31200
    ds_write_b32 v86, v85 offset:33280
    ds_write_b32 v86, v85 offset:35360
    ds_write_b32 v86, v85 offset:37440
    ds_write_b32 v86, v85 offset:39520
    s_branch KS_FILL
KS_IDLE:
    s_barrier
    s_barrier
    s_branch KS_B3
K2_PAD_U20:
    s_branch K2_HOP
K2_U20:
    s_setprio 1
    s_waitcnt lgkmcnt(0)
    v_lshlrev_b32 v16, 16, v0
    v_and_b32 v17, 0xffff0000, v0
    v_lshlrev_b32 v18, 16, v1
    v_and_b32 v19, 0xffff0000, v1
    v_lshlrev_b32 v20, 16, v2
    v_and_b32 v21, 0xffff0000, v2
    v_lshlrev_b32 v22, 16, v3
    v_and_b32 v23, 0xffff0000, v3
    v_mul_f32_dpp v32, v40, v16 row_newbcast:8 row_mask:0xf bank_mask:0xf
    v_mul_f32_dpp v33, v40, v17 row_newbcast:9 row_mask:0xf bank_mask:0xf
    v_mul_f32_dpp v34, v40, v18 row_newbcast:10 row_mask:0xf bank_mask:0xf
    v_mul_f32_dpp v35, v40, v19 row_newbcast:11 row_mask:0xf bank_mask:0xf
    v_mul_f32_dpp v36, v40, v20 row_newbcast:12 row_mask:0xf bank_mask:0xf
    v_mul_f32_dpp v37, v40, v21 row_newbcast:13 row_mask:0xf bank_mask:0xf
    v_mul_f32_dpp v38, v40, v22 row_newbcast:14 row_mask:0xf bank_mask:0xf
    v_mul_f32_dpp v39, v40, v23 row_newbcast:15 row_mask:0xf bank_mask:0xf
    v_cvt_pk_bf16_f32 v84, v32, v33
    v_cvt_pk_bf16_f32 v85, v34, v35
    v_cvt_pk_bf16_f32 v86, v36, v37
    v_cvt_pk_bf16_f32 v87, v38, v39
    v_mul_f32_dpp v16, v40, v16 row_newbcast:0 row_mask:0xa bank_mask:0xf
    v_mul_f32_dpp v17, v40, v17 row_newbcast:1 row_mask:0xa bank_mask:0xf
    v_mul_f32_dpp v18, v40, v18 row_newbcast:2 row_mask:0xa bank_mask:0xf
    v_mul_f32_dpp v19, v40, v19 row_newbcast:3 row_mask:0xa bank_mask:0xf
    v_mul_f32_dpp v20, v40, v20 row_newbcast:4 row_mask:0xa bank_mask:0xf
    v_mul_f32_dpp v21, v40, v21 row_newbcast:5 row_mask:0xa bank_mask:0xf
    v_mul_f32_dpp v22, v40, v22 row_newbcast:6 row_mask:0xa bank_mask:0xf
    v_mul_f32_dpp v23, v40, v23 row_newbcast:7 row_mask:0xa bank_mask:0xf
    v_cvt_pk_bf16_f32 v80, v16, v17
    v_cvt_pk_bf16_f32 v81, v18, v19
    v_cvt_pk_bf16_f32 v82, v20, v21
    v_cvt_pk_bf16_f32 v83, v22, v23
    v_lshlrev_b32 v24, 16, v4
    v_and_b32 v25, 0xffff0000, v4
    v_lshlrev_b32 v26, 16, v5
    v_and_b32 v27, 0xffff0000, v5
    v_lshlrev_b32 v28, 16, v6
    v_and_b32 v29, 0xffff0000, v6
    v_lshlrev_b32 v30, 16, v7
    v_and_b32 v31, 0xffff0000, v7
    v_mul_f32_dpp v32, v41, v24 row_newbcast:8 row_mask:0xf bank_mask:0xf
    v_mul_f32_dpp v33, v41, v25 row_newbcast:9 row_mask:0xf bank_mask:0xf
    v_mul_f32_dpp v34, v41, v26 row_newbcast:10 row_mask:0xf bank_mask:0xf
    v_mul_f32_dpp v35, v41, v27 row_newbcast:11 row_mask:0xf bank_mask:0xf
    v_mul_f32_dpp v36, v41, v28 row_newbcast:12 row_mask:0xf bank_mask:0xf
    v_mul_f32_dpp v37, v41, v29 row_newbcast:13 row_mask:0xf bank_mask:0xf
    v_mul_f32_dpp v38, v41, v30 row_newbcast:14 row_mask:0xf bank_mask:0xf
    v_mul_f32_dpp v39, v41, v31 row_newbcast:15 row_mask:0xf bank_mask:0xf
    v_cvt_pk_bf16_f32 v92, v32, v33
    v_cvt_pk_bf16_f32 v93, v34, v35
    v_cvt_pk_bf16_f32 v94, v36, v37
    v_cvt_pk_bf16_f32 v95, v38, v39
    v_mul_f32_dpp v24, v41, v24 row_newbcast:0 row_mask:0xa bank_mask:0xf
    v_mul_f32_dpp v25, v41, v25 row_newbcast:1 row_mask:0xa bank_mask:0xf
    v_mul_f32_dpp v26, v41, v26 row_newbcast:2 row_mask:0xa bank_mask:0xf
    v_mul_f32_dpp v27, v41, v27 row_newbcast:3 row_mask:0xa bank_mask:0xf
    v_mul_f32_dpp v28, v41, v28 row_newbcast:4 row_mask:0xa bank_mask:0xf
    v_mul_f32_dpp v29, v41, v29 row_newbcast:5 row_mask:0xa bank_mask:0xf
    v_mul_f32_dpp v30, v41, v30 row_newbcast:6 row_mask:0xa bank_mask:0xf
    v_mul_f32_dpp v31, v41, v31 row_newbcast:7 row_mask:0xa bank_mask:0xf
    v_cvt_pk_bf16_f32 v88, v24, v25
    v_cvt_pk_bf16_f32 v89, v26, v27
    v_cvt_pk_bf16_f32 v90, v28, v29
    v_cvt_pk_bf16_f32 v91, v30, v31
    s_waitcnt vmcnt(4)
    v_mfma_f32_32x32x16_bf16 v[8:23], v[80:83], v[176:179], 0
    ds_read_b64_tr_b16 v[184:185], v246 offset:2048
    ds_read_b64_tr_b16 v[186:187], v246 offset:3072
    ds_read_b64_tr_b16 v[188:189], v247 offset:2048
    ds_read_b64_tr_b16 v[190:191], v247 offset:3072
    s_mov_b32 m0, s68
    v_mfma_f32_32x32x16_bf16 v[24:39], v[84:87], v[176:179], 0
    buffer_load_dwordx4 v222, s[4:7], s42 offen sc1 lds
    buffer_load_dwordx4 v223, s[72:75], s42 offen offset:1024 sc1 lds
    v_permlane32_swap_b32 v236, v234
    v_permlane32_swap_b32 v237, v235
    s_add_u32 s38, s38, 1
    v_mfma_f32_32x32x16_bf16 v[48:63], v[80:83], v[180:183], 0
    v_permlane32_swap_b32 v240, v238
    v_permlane32_swap_b32 v241, v239
    v_add_f32 v236, v236, v234
    v_add_f32 v237, v237, v235
    v_add_f32 v240, -v240, -v238
    v_mfma_f32_32x32x16_bf16 v[64:79], v[84:87], v[180:183], 0
    v_add_f32 v241, -v241, -v239
    s_set_gpr_idx_on s32, gpr_idx(DST)
    s_nop 0
    v_cvt_pk_bf16_f32 v194, v236, v237
    v_cvt_pk_bf16_f32 v195, v240, v241
    s_set_gpr_idx_off
    v_mov_b32 v254, s52
    s_waitcnt vmcnt(4) lgkmcnt(0)
    v_mfma_f32_32x32x16_bf16 v[8:23], v[88:91], v[184:187], v[8:23]
    ds_read_b64_tr_b16 v[176:177], v246 offset:4096
    ds_read_b64_tr_b16 v[178:179], v246 offset:5120
    ds_read_b64_tr_b16 v[180:181], v247 offset:4096
    ds_read_b64_tr_b16 v[182:183], v247 offset:5120
    v_mov_b32 v255, s38
    s_lshl_b32 s58, s38, 3
    s_mov_b32 m0, s69
    v_mfma_f32_32x32x16_bf16 v[24:39], v[92:95], v[184:187], v[24:39]
    buffer_load_dwordx4 v224, s[4:7], s42 offen sc1 lds
    buffer_load_dwordx4 v225, s[72:75], s42 offen offset:1024 sc1 lds
    s_add_u32 s58, s58, s20
    s_mov_b64 exec, 1
    ds_write_b32 v254, v255
    s_mov_b64 exec, -1
    s_cmp_lt_u32 s58, s22
    s_cbranch_scc0 K2_dyn_10
K2_back_11:
    v_readlane_b32 s3, v253, s58
    s_lshl_b32 s44, s34, 7
    s_and_b32 s48, s3, 0x3ffff
    s_bfe_u32 s33, s3, 0x30013
    s_mul_i32 s35, s38, 6
    s_cmp_eq_u32 s34, 0
    s_cselect_b32 s35, s35, s48
    s_mov_b32 s45, s44
    s_xor_b32 s47, s44, 256
    s_add_u32 s49, s48, 128
    s_add_u32 s60, s48, 256
    s_cmp_eq_u32 s33, 3
    s_cselect_b32 s46, s44, s47
    s_cselect_b32 s50, s60, s48
    s_sub_u32 s60, s33, 2
    s_cmp_lt_u32 s60, 2
    s_cbranch_scc0 K2_rare_16
K2_back_17:
    v_mfma_f32_32x32x16_bf16 v[48:63], v[88:91], v[188:191], v[48:63]
    v_add_u32 v43, s48, v232
    ds_read_b32 v42, v43
    ds_read_b32 v43, v43 offset:1024
    v_mul_f32 v234, v8, v96
    v_mul_f32 v236, v16, v128
    v_fmac_f32 v234, v9, v97
    v_fmac_f32 v236, v17, v129
    v_mfma_f32_32x32x16_bf16 v[64:79], v[92:95], v[188:191], v[64:79]
    s_setprio 0
    v_fmac_f32 v234, v10, v98
    v_fmac_f32 v236, v18, v130
    v_fmac_f32 v234, v11, v99
    v_fmac_f32 v236, v19, v131
    v_fmac_f32 v234, v12, v100
    v_fmac_f32 v236, v20, v132
    v_fmac_f32 v234, v13, v101
    v_fmac_f32 v236, v21, v133
    v_fmac_f32 v234, v14, v102
    v_fmac_f32 v236, v22, v134
    v_fmac_f32 v234, v15, v103
    v_fmac_f32 v236, v23, v135
    v_mul_f32 v238, v24, v128
    v_mul_f32 v240, v32, v128
    v_fmac_f32 v238, v25, v129
    v_fmac_f32 v240, v33, v129
    v_fmac_f32 v238, v26, v130
    v_fmac_f32 v240, v34, v130
    v_fmac_f32 v238, v27, v131
    v_fmac_f32 v240, v35, v131
    v_fmac_f32 v238, v28, v132
    v_fmac_f32 v240, v36, v132
    v_fmac_f32 v238, v29, v133
    v_fmac_f32 v240, v37, v133
    v_fmac_f32 v238, v30, v134
    v_fmac_f32 v240, v38, v134
    v_fmac_f32 v238, v31, v135
    v_fmac_f32 v240, v39, v135
    v_mul_f32 v235, v48, v104
    v_mul_f32 v237, v56, v136
    v_fmac_f32 v235, v49, v105
    v_fmac_f32 v237, v57, v137
    v_fmac_f32 v235, v50, v106
    v_fmac_f32 v237, v58, v138
    v_fmac_f32 v235, v51, v107
    v_fmac_f32 v237, v59, v139
    v_fmac_f32 v235, v52, v108
    v_fmac_f32 v237, v60, v140
    v_fmac_f32 v235, v53, v109
    v_fmac_f32 v237, v61, v141
    v_fmac_f32 v235, v54, v110
    v_fmac_f32 v237, v62, v142
    v_fmac_f32 v235, v55, v111
    v_fmac_f32 v237, v63, v143
    v_mul_f32 v239, v64, v136
    v_mul_f32 v241, v72, v136
    v_fmac_f32 v239, v65, v137
    v_fmac_f32 v241, v73, v137
    s_setprio 1
    s_waitcnt vmcnt(4) lgkmcnt(3)
    v_mfma_f32_32x32x16_bf16 v[24:39], v[84:87], v[176:179], 0
    ds_read_b64_tr_b16 v[184:185], v246 offset:6144
    ds_read_b64_tr_b16 v[186:187], v246 offset:7168
    ds_read_b64_tr_b16 v[188:189], v247 offset:6144
    ds_read_b64_tr_b16 v[190:191], v247 offset:7168
    v_fmac_f32 v239, v66, v138
    v_fmac_f32 v241, v74, v138
    s_mov_b32 m0, s70
    v_mfma_f32_32x32x16_bf16 v[8:23], v[80:83], v[176:179], 0
    buffer_load_dwordx4 v222, s[4:7], s43 offen sc1 lds
    buffer_load_dwordx4 v223, s[72:75], s43 offen offset:1024 sc1 lds
    v_fmac_f32 v239, v67, v139
    v_fmac_f32 v241, v75, v139
    v_fmac_f32 v239, v68, v140
    v_fmac_f32 v241, v76, v140
    v_fmac_f32 v239, v69, v141
    v_mfma_f32_32x32x16_bf16 v[48:63], v[80:83], v[180:183], 0
    v_add_u32 v222, s48, v251
    ds_read2_b32 v[222:223], v222 offset0:1 offset1:3
    v_fmac_f32 v241, v77, v141
    v_fmac_f32 v239, v70, v142
    v_fmac_f32 v241, v78, v142
    v_fmac_f32 v239, v71, v143
    v_fmac_f32 v241, v79, v143
    v_mfma_f32_32x32x16_bf16 v[64:79], v[84:87], v[180:183], 0
    v_permlane32_swap_b32 v234, v236
    v_permlane32_swap_b32 v235, v237
    v_permlane32_swap_b32 v238, v239
    s_waitcnt lgkmcnt(5)
    v_or_b32 v42, v42, v233
    v_or_b32 v43, v43, v233
    s_cmp_lg_u32 s34, 0
    s_cbranch_scc1 K2_dum_21
    s_cmp_eq_u32 s33, 4
    s_cbranch_scc1 K2_a4_22
K2_b4_24:
    s_add_u32 m0, s48, 512
    s_add_u32 s65, s48, 1536
    buffer_load_dwordx4 v42, s[16:19], 0 offen  lds
    s_mov_b32 m0, s65
    s_mov_b32 exec_hi, 0
    buffer_load_dwordx4 v43, s[16:19], 0 offen  lds
    s_mov_b32 exec_hi, -1
K2_back_23:
    s_waitcnt vmcnt(6) lgkmcnt(1)
    v_mfma_f32_32x32x16_bf16 v[24:39], v[92:95], v[184:187], v[24:39]
    ds_read_b64_tr_b16 v[176:177], v246 offset:0
    ds_read_b64_tr_b16 v[178:179], v246 offset:1024
    ds_read_b64_tr_b16 v[180:181], v247 offset:0
    ds_read_b64_tr_b16 v[182:183], v247 offset:1024
    v_add_f32 v234, v234, v236
    v_add_f32 v235, v235, v237
    s_mov_b32 m0, s71
    v_mfma_f32_32x32x16_bf16 v[8:23], v[88:91], v[184:187], v[8:23]
    buffer_load_dwordx4 v224, s[4:7], s43 offen sc1 lds
    buffer_load_dwordx4 v225, s[72:75], s43 offen offset:1024 sc1 lds
    s_waitcnt lgkmcnt(4)
    v_mad_u32_u16 v222, v222, s39, v248 op_sel:[1,0,0,0]
    v_mad_u32_u16 v223, v223, s39, v248 op_sel:[1,0,0,0]
    v_add_f32 v238, -v238, -v239
    s_set_gpr_idx_on s31, gpr_idx(DST)
    s_nop 0
    v_cvt_pk_bf16_f32 v192, v234, v235
    v_cvt_pk_bf16_f32 v197, v238, v238
    s_set_gpr_idx_off
    v_mfma_f32_32x32x16_bf16 v[48:63], v[88:91], v[188:191], v[48:63]
    v_add_u32 v224, s49, v251
    ds_read2_b32 v[224:225], v224 offset0:1 offset1:3
    v_mul_f32 v236, v24, v160
    v_mul_f32 v238, v32, v160
    v_fmac_f32 v236, v25, v161
    v_fmac_f32 v238, v33, v161
    v_fmac_f32 v236, v26, v162
    v_mfma_f32_32x32x16_bf16 v[64:79], v[92:95], v[188:191], v[64:79]
    s_setprio 0
    v_fmac_f32 v238, v34, v162
    v_fmac_f32 v236, v27, v163
    v_fmac_f32 v238, v35, v163
    v_fmac_f32 v236, v28, v164
    v_fmac_f32 v238, v36, v164
    v_fmac_f32 v236, v29, v165
    v_fmac_f32 v238, v37, v165
    v_fmac_f32 v236, v30, v166
    v_fmac_f32 v238, v38, v166
    v_fmac_f32 v236, v31, v167
    v_fmac_f32 v238, v39, v167
    v_mul_f32 v234, v8, v144
    v_mul_f32 v235, v48, v152
    v_fmac_f32 v234, v9, v145
    v_fmac_f32 v235, v49, v153
    v_fmac_f32 v234, v10, v146
    v_fmac_f32 v235, v50, v154
    v_fmac_f32 v234, v11, v147
    v_fmac_f32 v235, v51, v155
    v_fmac_f32 v234, v12, v148
    v_fmac_f32 v235, v52, v156
    v_fmac_f32 v234, v13, v149
    v_fmac_f32 v235, v53, v157
    v_fmac_f32 v234, v14, v150
    v_fmac_f32 v235, v54, v158
    v_fmac_f32 v234, v15, v151
    v_fmac_f32 v235, v55, v159
    v_mul_f32 v237, v64, v168
    v_mul_f32 v239, v72, v168
    v_fmac_f32 v237, v65, v169
    v_fmac_f32 v239, v73, v169
    v_fmac_f32 v237, v66, v170
    v_fmac_f32 v239, v74, v170
    v_fmac_f32 v237, v67, v171
    s_setprio 1
    s_waitcnt vmcnt(6) lgkmcnt(1)
    v_mfma_f32_32x32x16_bf16 v[24:39], v[80:83], v[176:179], 0
    ds_read_b64_tr_b16 v[184:185], v246 offset:2048
    ds_read_b64_tr_b16 v[186:187], v246 offset:3072
    ds_read_b64_tr_b16 v[188:189], v247 offset:2048
    ds_read_b64_tr_b16 v[190:191], v247 offset:3072
    v_fmac_f32 v239, v75, v171
    v_fmac_f32 v237, v68, v172
    s_mov_b32 m0, s68
    v_mfma_f32_32x32x16_bf16 v[0:15], v[84:87], v[176:179], 0
    buffer_load_dwordx4 v222, s[4:7], s44 offen sc1 lds
    buffer_load_dwordx4 v223, s[72:75], s44 offen offset:1024 sc1 lds
    s_waitcnt lgkmcnt(4)
    v_mad_u32_u16 v224, v224, s39, v248 op_sel:[1,0,0,0]
    v_mad_u32_u16 v225, v225, s39, v248 op_sel:[1,0,0,0]
    v_fmac_f32 v239, v76, v172
    v_fmac_f32 v237, v69, v173
    v_mfma_f32_32x32x16_bf16 v[40:55], v[84:87], v[180:183], 0
    v_add_u32 v226, s50, v251
    ds_read2_b32 v[226:227], v226 offset0:1 offset1:3
    v_fmac_f32 v239, v77, v173
    v_fmac_f32 v237, v70, v174
    v_fmac_f32 v239, v78, v174
    v_fmac_f32 v237, v71, v175
    v_fmac_f32 v239, v79, v175
    v_mfma_f32_32x32x16_bf16 v[64:79], v[80:83], v[180:183], 0
    v_permlane32_swap_b32 v234, v240
    v_permlane32_swap_b32 v235, v241
    v_add_f32 v234, v234, v240
    v_add_f32 v235, v235, v241
    s_waitcnt vmcnt(6) lgkmcnt(1)
    v_mfma_f32_32x32x16_bf16 v[24:39], v[88:91], v[184:187], v[24:39]
    ds_read_b64_tr_b16 v[176:177], v246 offset:4096
    ds_read_b64_tr_b16 v[178:179], v246 offset:5120
    ds_read_b64_tr_b16 v[180:181], v247 offset:4096
    ds_read_b64_tr_b16 v[182:183], v247 offset:5120
    s_mov_b32 m0, s69
    v_mfma_f32_32x32x16_bf16 v[0:15], v[92:95], v[184:187], v[0:15]
    buffer_load_dwordx4 v224, s[4:7], s45 offen sc1 lds
    buffer_load_dwordx4 v225, s[72:75], s45 offen offset:1024 sc1 lds
    s_waitcnt lgkmcnt(4)
    v_mad_u32_u16 v226, v226, s39, v248 op_sel:[1,0,0,0]
    v_mad_u32_u16 v227, v227, s39, v248 op_sel:[1,0,0,0]
    s_set_gpr_idx_on s31, gpr_idx(DST)
    s_nop 0
    v_cvt_pk_bf16_f32 v193, v234, v235
    s_set_gpr_idx_off
    v_mfma_f32_32x32x16_bf16 v[40:55], v[92:95], v[188:191], v[40:55]
    v_mul_f32 v240, v24, v144
    v_fmac_f32 v236, v32, v160
    v_fmac_f32 v240, v25, v145
    v_fmac_f32 v236, v33, v161
    v_fmac_f32 v240, v26, v146
    v_fmac_f32 v236, v34, v162
    v_fmac_f32 v240, v27, v147
    v_mfma_f32_32x32x16_bf16 v[64:79], v[88:91], v[188:191], v[64:79]
    s_setprio 0
    v_fmac_f32 v236, v35, v163
    v_fmac_f32 v240, v28, v148
    v_fmac_f32 v236, v36, v164
    v_fmac_f32 v240, v29, v149
    v_fmac_f32 v236, v37, v165
    v_fmac_f32 v240, v30, v150
    v_fmac_f32 v236, v38, v166
    v_fmac_f32 v240, v31, v151
    v_fmac_f32 v236, v39, v167
    v_mul_f32 v234, v0, v112
    v_mul_f32 v235, v40, v120
    v_fmac_f32 v234, v1, v113
    v_fmac_f32 v235, v41, v121
    v_fmac_f32 v234, v2, v114
    v_fmac_f32 v235, v42, v122
    v_fmac_f32 v234, v3, v115
    v_fmac_f32 v235, v43, v123
    v_fmac_f32 v234, v4, v116
    v_fmac_f32 v235, v44, v124
    v_fmac_f32 v234, v5, v117
    v_fmac_f32 v235, v45, v125
    v_fmac_f32 v234, v6, v118
    v_fmac_f32 v235, v46, v126
    v_fmac_f32 v234, v7, v119
    v_fmac_f32 v235, v47, v127
    v_mul_f32 v241, v64, v152
    v_fmac_f32 v237, v72, v168
    s_setprio 1
    s_waitcnt vmcnt(4) lgkmcnt(0)
    v_mfma_f32_32x32x16_bf16 v[24:39], v[80:83], v[176:179], 0
    ds_read_b64_tr_b16 v[184:185], v246 offset:6144
    ds_read_b64_tr_b16 v[186:187], v246 offset:7168
    ds_read_b64_tr_b16 v[188:189], v247 offset:6144
    ds_read_b64_tr_b16 v[190:191], v247 offset:7168
    v_fmac_f32 v241, v65, v153
    v_fmac_f32 v237, v73, v169
    s_mov_b32 m0, s70
    v_mfma_f32_32x32x16_bf16 v[8:23], v[84:87], v[176:179], v[8:23]
    buffer_load_dwordx4 v226, s[4:7], s46 offen sc1 lds
    buffer_load_dwordx4 v227, s[72:75], s46 offen offset:1024 sc1 lds
    v_fmac_f32 v241, v66, v154
    v_fmac_f32 v237, v74, v170
    v_fmac_f32 v241, v67, v155
    v_fmac_f32 v237, v75, v171
    v_fmac_f32 v241, v68, v156
    v_mfma_f32_32x32x16_bf16 v[48:63], v[84:87], v[180:183], v[48:63]
    v_fmac_f32 v237, v76, v172
    v_fmac_f32 v241, v69, v157
    v_fmac_f32 v237, v77, v173
    v_fmac_f32 v241, v70, v158
    v_fmac_f32 v237, v78, v174
    v_fmac_f32 v241, v71, v159
    v_fmac_f32 v237, v79, v175
    v_mfma_f32_32x32x16_bf16 v[64:79], v[80:83], v[180:183], 0
    v_permlane32_swap_b32 v236, v240
    v_permlane32_swap_b32 v237, v241
    v_add_f32 v236, v236, v240
    v_add_f32 v237, v237, v241
    s_waitcnt vmcnt(4) lgkmcnt(0)
    v_mfma_f32_32x32x16_bf16 v[24:39], v[88:91], v[184:187], v[24:39]
    ds_read_b64_tr_b16 v[176:177], v246 offset:0
    ds_read_b64_tr_b16 v[178:179], v246 offset:1024
    ds_read_b64_tr_b16 v[180:181], v247 offset:0
    ds_read_b64_tr_b16 v[182:183], v247 offset:1024
    s_sub_u32 s26, s48, s29
    s_mov_b32 s29, s48
    s_mov_b32 m0, s71
    v_mfma_f32_32x32x16_bf16 v[8:23], v[92:95], v[184:187], v[8:23]
    s_cmp_eq_u32 s33, 4
    s_cbranch_scc1 K2_g4_19
    buffer_load_dwordx4 v224, s[4:7], s47 offen sc1 lds
    buffer_load_dwordx4 v225, s[72:75], s47 offen offset:1024 sc1 lds
K2_back_20:
    s_set_gpr_idx_on s31, gpr_idx(DST)
    s_nop 0
    v_cvt_pk_bf16_f32 v196, v236, v237
    s_set_gpr_idx_off
    s_mov_b32 s30, s3
    s_bfe_u32 s56, s3, 0x40012
    s_cmp_eq_u32 s34, 0
    s_cselect_b32 s56, s56, 0
    v_mfma_f32_32x32x16_bf16 v[48:63], v[92:95], v[188:191], v[48:63]
    s_mov_b32 s32, s31
    s_mov_b32 s31, s35
    v_mul_f32 v236, v24, v144
    v_fma_f32 v238, v32, v160, -v238
    v_fmac_f32 v236, v25, v145
    v_fmac_f32 v238, v33, v161
    v_fmac_f32 v236, v26, v146
    v_mfma_f32_32x32x16_bf16 v[64:79], v[88:91], v[188:191], v[64:79]
    s_setprio 0
    v_fmac_f32 v238, v34, v162
    v_fmac_f32 v236, v27, v147
    v_fmac_f32 v238, v35, v163
    v_fmac_f32 v236, v28, v148
    v_fmac_f32 v238, v36, v164
    v_fmac_f32 v236, v29, v149
    v_fmac_f32 v238, v37, v165
    v_fmac_f32 v236, v30, v150
    v_fmac_f32 v238, v38, v166
    v_fmac_f32 v236, v31, v151
    v_fmac_f32 v238, v39, v167
    v_add_u32 v249, s26, v249
    v_add_u32 v250, s26, v250
    v_mul_f32 v240, v8, v160
    v_fma_f32 v234, v16, v112, -v234
    v_fmac_f32 v240, v9, v161
    v_fmac_f32 v234, v17, v113
    v_fmac_f32 v240, v10, v162
    v_fmac_f32 v234, v18, v114
    v_fmac_f32 v240, v11, v163
    v_fmac_f32 v234, v19, v115
    v_fmac_f32 v240, v12, v164
    v_fmac_f32 v234, v20, v116
    v_fmac_f32 v240, v13, v165
    v_fmac_f32 v234, v21, v117
    v_fmac_f32 v240, v14, v166
    v_fmac_f32 v234, v22, v118
    v_fmac_f32 v240, v15, v167
    v_fmac_f32 v234, v23, v119
    ds_read_b64_tr_b16 v[0:1], v249 offset:0
    ds_read_b64_tr_b16 v[2:3], v249 offset:32
    ds_read_u16_d16_hi v40, v250 offset:0
    v_mul_f32 v241, v48, v168
    v_fma_f32 v235, v56, v120, -v235
    v_fmac_f32 v241, v49, v169
    v_fmac_f32 v235, v57, v121
    v_fmac_f32 v241, v50, v170
    v_fmac_f32 v235, v58, v122
    v_fmac_f32 v241, v51, v171
    v_fmac_f32 v235, v59, v123
    v_fmac_f32 v241, v52, v172
    v_fmac_f32 v235, v60, v124
    v_fmac_f32 v241, v53, v173
    v_fmac_f32 v235, v61, v125
    v_fmac_f32 v241, v54, v174
    v_fmac_f32 v235, v62, v126
    v_fmac_f32 v241, v55, v175
    v_fmac_f32 v235, v63, v127
    ds_read_b64_tr_b16 v[4:5], v249 offset:512
    ds_read_b64_tr_b16 v[6:7], v249 offset:544
    ds_read_u16_d16_hi v41, v250 offset:128
    v_mul_f32 v237, v64, v152
    v_fma_f32 v239, v72, v168, -v239
    v_fmac_f32 v237, v65, v153
    v_fmac_f32 v239, v73, v169
    v_fmac_f32 v237, v66, v154
    v_fmac_f32 v239, v74, v170
    v_fmac_f32 v237, v67, v155
    v_fmac_f32 v239, v75, v171
    v_fmac_f32 v237, v68, v156
    v_fmac_f32 v239, v76, v172
    v_fmac_f32 v237, v69, v157
    v_fmac_f32 v239, v77, v173
    v_fmac_f32 v237, v70, v158
    v_fmac_f32 v239, v78, v174
    v_fmac_f32 v237, v71, v159
    v_fmac_f32 v239, v79, v175
    s_cmp_eq_u32 s56, 5
    s_cbranch_scc1 K2_U20
    s_cmp_eq_u32 s56, 6
    s_cbranch_scc1 K2_U3h0
    s_branch K2_DSP0
K2_PAD_U30:
    s_branch K2_HOP
K2_U3h0:
    s_setprio 1
    ds_read_b64_tr_b16 v[8:9], v249 offset:1024
    ds_read_u16_d16_hi v42, v250 offset:256
    s_waitcnt lgkmcnt(2)
    v_lshlrev_b32 v16, 16, v0
    v_and_b32 v17, 0xffff0000, v0
    v_lshlrev_b32 v18, 16, v1
    v_and_b32 v19, 0xffff0000, v1
    v_lshlrev_b32 v20, 16, v2
    v_and_b32 v21, 0xffff0000, v2
    v_lshlrev_b32 v22, 16, v3
    v_and_b32 v23, 0xffff0000, v3
    v_mul_f32_dpp v32, v40, v16 row_newbcast:8 row_mask:0xf bank_mask:0xf
    v_mul_f32_dpp v33, v40, v17 row_newbcast:9 row_mask:0xf bank_mask:0xf
    v_mul_f32_dpp v34, v40, v18 row_newbcast:10 row_mask:0xf bank_mask:0xf
    v_mul_f32_dpp v35, v40, v19 row_newbcast:11 row_mask:0xf bank_mask:0xf
    v_mul_f32_dpp v36, v40, v20 row_newbcast:12 row_mask:0xf bank_mask:0xf
    v_mul_f32_dpp v37, v40, v21 row_newbcast:13 row_mask:0xf bank_mask:0xf
    v_mul_f32_dpp v38, v40, v22 row_newbcast:14 row_mask:0xf bank_mask:0xf
    v_mul_f32_dpp v39, v40, v23 row_newbcast:15 row_mask:0xf bank_mask:0xf
    v_cvt_pk_bf16_f32 v84, v32, v33
    v_cvt_pk_bf16_f32 v85, v34, v35
    v_cvt_pk_bf16_f32 v86, v36, v37
    v_cvt_pk_bf16_f32 v87, v38, v39
    v_mul_f32_dpp v16, v40, v16 row_newbcast:0 row_mask:0xa bank_mask:0xf
    v_mul_f32_dpp v17, v40, v17 row_newbcast:1 row_mask:0xa bank_mask:0xf
    v_mul_f32_dpp v18, v40, v18 row_newbcast:2 row_mask:0xa bank_mask:0xf
    v_mul_f32_dpp v19, v40, v19 row_newbcast:3 row_mask:0xa bank_mask:0xf
    v_mul_f32_dpp v20, v40, v20 row_newbcast:4 row_mask:0xa bank_mask:0xf
    v_mul_f32_dpp v21, v40, v21 row_newbcast:5 row_mask:0xa bank_mask:0xf
    v_mul_f32_dpp v22, v40, v22 row_newbcast:6 row_mask:0xa bank_mask:0xf
    v_mul_f32_dpp v23, v40, v23 row_newbcast:7 row_mask:0xa bank_mask:0xf
    v_cvt_pk_bf16_f32 v80, v16, v17
    v_cvt_pk_bf16_f32 v81, v18, v19
    v_cvt_pk_bf16_f32 v82, v20, v21
    v_cvt_pk_bf16_f32 v83, v22, v23
    v_lshlrev_b32 v24, 16, v4
    v_and_b32 v25, 0xffff0000, v4
    v_lshlrev_b32 v26, 16, v5
    v_and_b32 v27, 0xffff0000, v5
    v_lshlrev_b32 v28, 16, v6
    v_and_b32 v29, 0xffff0000, v6
    v_lshlrev_b32 v30, 16, v7
    v_and_b32 v31, 0xffff0000, v7
    v_mul_f32_dpp v32, v41, v24 row_newbcast:8 row_mask:0xf bank_mask:0xf
    v_mul_f32_dpp v33, v41, v25 row_newbcast:9 row_mask:0xf bank_mask:0xf
    v_mul_f32_dpp v34, v41, v26 row_newbcast:10 row_mask:0xf bank_mask:0xf
    v_mul_f32_dpp v35, v41, v27 row_newbcast:11 row_mask:0xf bank_mask:0xf
    v_mul_f32_dpp v36, v41, v28 row_newbcast:12 row_mask:0xf bank_mask:0xf
    v_mul_f32_dpp v37, v41, v29 row_newbcast:13 row_mask:0xf bank_mask:0xf
    v_mul_f32_dpp v38, v41, v30 row_newbcast:14 row_mask:0xf bank_mask:0xf
    v_mul_f32_dpp v39, v41, v31 row_newbcast:15 row_mask:0xf bank_mask:0xf
    v_cvt_pk_bf16_f32 v92, v32, v33
    v_cvt_pk_bf16_f32 v93, v34, v35
    v_cvt_pk_bf16_f32 v94, v36, v37
    v_cvt_pk_bf16_f32 v95, v38, v39
    v_mul_f32_dpp v24, v41, v24 row_newbcast:0 row_mask:0xa bank_mask:0xf
    v_mul_f32_dpp v25, v41, v25 row_newbcast:1 row_mask:0xa bank_mask:0xf
    v_mul_f32_dpp v26, v41, v26 row_newbcast:2 row_mask:0xa bank_mask:0xf
    v_mul_f32_dpp v27, v41, v27 row_newbcast:3 row_mask:0xa bank_mask:0xf
    v_mul_f32_dpp v28, v41, v28 row_newbcast:4 row_mask:0xa bank_mask:0xf
    v_mul_f32_dpp v29, v41, v29 row_newbcast:5 row_mask:0xa bank_mask:0xf
    v_mul_f32_dpp v30, v41, v30 row_newbcast:6 row_mask:0xa bank_mask:0xf
    v_mul_f32_dpp v31, v41, v31 row_newbcast:7 row_mask:0xa bank_mask:0xf
    v_cvt_pk_bf16_f32 v88, v24, v25
    v_cvt_pk_bf16_f32 v89, v26, v27
    v_cvt_pk_bf16_f32 v90, v28, v29
    v_cvt_pk_bf16_f32 v91, v30, v31
    s_waitcnt lgkmcnt(0)
    v_lshlrev_b32 v16, 16, v8
    v_and_b32 v17, 0xffff0000, v8
    v_lshlrev_b32 v18, 16, v9
    v_and_b32 v19, 0xffff0000, v9
    v_mul_f32_dpp v32, v42, v16 row_newbcast:8 row_mask:0xf bank_mask:0xf
    v_mul_f32_dpp v33, v42, v17 row_newbcast:9 row_mask:0xf bank_mask:0xf
    v_mul_f32_dpp v34, v42, v18 row_newbcast:10 row_mask:0xf bank_mask:0xf
    v_mul_f32_dpp v35, v42, v19 row_newbcast:11 row_mask:0xf bank_mask:0xf
    v_cvt_pk_bf16_f32 v242, v32, v33
    v_cvt_pk_bf16_f32 v243, v34, v35
    v_mul_f32_dpp v16, v42, v16 row_newbcast:0 row_mask:0xa bank_mask:0xf
    v_mul_f32_dpp v17, v42, v17 row_newbcast:1 row_mask:0xa bank_mask:0xf
    v_mul_f32_dpp v18, v42, v18 row_newbcast:2 row_mask:0xa bank_mask:0xf
    v_mul_f32_dpp v19, v42, v19 row_newbcast:3 row_mask:0xa bank_mask:0xf
    v_cvt_pk_bf16_f32 v228, v16, v17
    v_cvt_pk_bf16_f32 v229, v18, v19
    s_waitcnt vmcnt(4)
    v_mfma_f32_32x32x16_bf16 v[8:23], v[80:83], v[176:179], 0
    ds_read_b64_tr_b16 v[184:185], v246 offset:2048
    ds_read_b64_tr_b16 v[186:187], v246 offset:3072
    ds_read_b64_tr_b16 v[188:189], v247 offset:2048
    ds_read_b64_tr_b16 v[190:191], v247 offset:3072
    s_mov_b32 m0, s68
    v_mfma_f32_32x32x16_bf16 v[24:39], v[84:87], v[176:179], 0
    buffer_load_dwordx4 v222, s[4:7], s41 offen sc1 lds
    buffer_load_dwordx4 v223, s[72:75], s41 offen offset:1024 sc1 lds
    v_permlane32_swap_b32 v236, v234
    v_permlane32_swap_b32 v237, v235
    s_add_u32 s38, s38, 1
    v_mfma_f32_32x32x16_bf16 v[48:63], v[80:83], v[180:183], 0
    v_permlane32_swap_b32 v240, v238
    v_permlane32_swap_b32 v241, v239
    v_add_f32 v236, v236, v234
    v_add_f32 v237, v237, v235
    v_add_f32 v240, -v240, -v238
    v_mfma_f32_32x32x16_bf16 v[64:79], v[84:87], v[180:183], 0
    v_add_f32 v241, -v241, -v239
    s_set_gpr_idx_on s32, gpr_idx(DST)
    s_nop 0
    v_cvt_pk_bf16_f32 v194, v236, v237
    v_cvt_pk_bf16_f32 v195, v240, v241
    s_set_gpr_idx_off
    v_mov_b32 v254, s52
    s_waitcnt vmcnt(4) lgkmcnt(0)
    v_mfma_f32_32x32x16_bf16 v[8:23], v[88:91], v[184:187], v[8:23]
    ds_read_b64_tr_b16 v[176:177], v246 offset:4096
    ds_read_b64_tr_b16 v[180:181], v247 offset:4096
    v_mov_b32 v255, s38
    s_lshl_b32 s58, s38, 3
    s_add_u32 s58, s58, s20
    s_mov_b32 m0, s69
    v_mfma_f32_32x32x16_bf16 v[24:39], v[92:95], v[184:187], v[24:39]
    buffer_load_dwordx4 v226, s[4:7], s41 offen sc1 lds
    s_mov_b64 exec, 1
    ds_write_b32 v254, v255
    s_mov_b64 exec, -1
    s_cmp_lt_u32 s58, s22
    s_cbranch_scc0 K2_dyn_25
K2_back_26:
    v_readlane_b32 s3, v253, s58
    s_lshl_b32 s44, s34, 7
    s_and_b32 s48, s3, 0x3ffff
    s_bfe_u32 s33, s3, 0x30013
    s_mul_i32 s35, s38, 6
    s_cmp_eq_u32 s34, 0
    s_cselect_b32 s35, s35, s48
    s_mov_b32 s45, s44
    s_xor_b32 s47, s44, 256
    s_add_u32 s49, s48, 128
    s_add_u32 s60, s48, 256
    s_cmp_eq_u32 s33, 3
    s_cselect_b32 s46, s44, s47
    s_cselect_b32 s50, s60, s48
    s_sub_u32 s60, s33, 2
    s_cmp_lt_u32 s60, 2
    s_cbranch_scc0 K2_rare_31
K2_back_32:
    v_mfma_f32_32x32x16_bf16 v[48:63], v[88:91], v[188:191], v[48:63]
    v_add_u32 v43, s48, v232
    ds_read_b32 v42, v43
    ds_read_b32 v43, v43 offset:1024
    v_mfma_f32_32x32x16_bf16 v[64:79], v[92:95], v[188:191], v[64:79]
    s_waitcnt vmcnt(3) lgkmcnt(3)
    v_mfma_f32_32x32x8_bf16 v[8:23], v[228:229], v[176:177], v[8:23]
    ds_read_b64_tr_b16 v[184:185], v246 offset:6144
    ds_read_b64_tr_b16 v[186:187], v246 offset:7168
    ds_read_b64_tr_b16 v[188:189], v247 offset:6144
    ds_read_b64_tr_b16 v[190:191], v247 offset:7168
    s_mov_b32 m0, s70
    v_mfma_f32_32x32x8_bf16 v[24:39], v[242:243], v[176:177], v[24:39]
    buffer_load_dwordx4 v222, s[4:7], s42 offen sc1 lds
    buffer_load_dwordx4 v223, s[72:75], s42 offen offset:1024 sc1 lds
    v_mfma_f32_32x32x8_bf16 v[48:63], v[228:229], v[180:181], v[48:63]
    s_nop 2
    v_mul_f32 v234, v8, v96
    v_mul_f32 v236, v16, v128
    v_fmac_f32 v234, v9, v97
    v_fmac_f32 v236, v17, v129
    v_fmac_f32 v234, v10, v98
    v_fmac_f32 v236, v18, v130
    v_fmac_f32 v234, v11, v99
    v_mfma_f32_32x32x8_bf16 v[64:79], v[242:243], v[180:181], v[64:79]
    s_setprio 0
    s_waitcnt lgkmcnt(4)
    v_or_b32 v42, v42, v233
    v_or_b32 v43, v43, v233
    s_cmp_lg_u32 s34, 0
    s_cbranch_scc1 K2_dum_36
    s_cmp_eq_u32 s33, 4
    s_cbranch_scc1 K2_a4_37
K2_b4_39:
    s_add_u32 m0, s48, 512
    s_add_u32 s65, s48, 1536
    buffer_load_dwordx4 v42, s[16:19], 0 offen  lds
    s_mov_b32 m0, s65
    s_mov_b32 exec_hi, 0
    buffer_load_dwordx4 v43, s[16:19], 0 offen  lds
    s_mov_b32 exec_hi, -1
K2_back_38:
    v_fmac_f32 v236, v19, v131
    v_fmac_f32 v234, v12, v100
    v_fmac_f32 v236, v20, v132
    v_fmac_f32 v234, v13, v101
    v_fmac_f32 v236, v21, v133
    v_fmac_f32 v234, v14, v102
    v_fmac_f32 v236, v22, v134
    v_fmac_f32 v234, v15, v103
    v_fmac_f32 v236, v23, v135
    v_mul_f32 v238, v24, v128
    v_mul_f32 v240, v32, v128
    v_fmac_f32 v238, v25, v129
    v_fmac_f32 v240, v33, v129
    v_fmac_f32 v238, v26, v130
    v_fmac_f32 v240, v34, v130
    v_fmac_f32 v238, v27, v131
    v_fmac_f32 v240, v35, v131
    v_fmac_f32 v238, v28, v132
    v_fmac_f32 v240, v36, v132
    v_fmac_f32 v238, v29, v133
    v_fmac_f32 v240, v37, v133
    v_fmac_f32 v238, v30, v134
    v_fmac_f32 v240, v38, v134
    v_fmac_f32 v238, v31, v135
    v_fmac_f32 v240, v39, v135
    v_mul_f32 v235, v48, v104
    v_mul_f32 v237, v56, v136
    v_fmac_f32 v235, v49, v105
    v_fmac_f32 v237, v57, v137
    v_fmac_f32 v235, v50, v106
    v_fmac_f32 v237, v58, v138
    v_fmac_f32 v235, v51, v107
    v_fmac_f32 v237, v59, v139
    v_fmac_f32 v235, v52, v108
    v_fmac_f32 v237, v60, v140
    v_fmac_f32 v235, v53, v109
    v_fmac_f32 v237, v61, v141
    v_fmac_f32 v235, v54, v110
    v_fmac_f32 v237, v62, v142
    v_fmac_f32 v235, v55, v111
    v_fmac_f32 v237, v63, v143
    v_mul_f32 v239, v64, v136
    v_mul_f32 v241, v72, v136
    s_setprio 1
    s_waitcnt vmcnt(5) lgkmcnt(0)
    v_mfma_f32_32x32x16_bf16 v[24:39], v[92:95], v[184:187], 0
    ds_read_b64_tr_b16 v[176:177], v246 offset:0
    ds_read_b64_tr_b16 v[178:179], v246 offset:1024
    ds_read_b64_tr_b16 v[180:181], v247 offset:0
    ds_read_b64_tr_b16 v[182:183], v247 offset:1024
    v_fmac_f32 v239, v65, v137
    v_fmac_f32 v241, v73, v137
    s_mov_b32 m0, s71
    v_mfma_f32_32x32x16_bf16 v[8:23], v[88:91], v[184:187], 0
    buffer_load_dwordx4 v224, s[4:7], s42 offen sc1 lds
    buffer_load_dwordx4 v225, s[72:75], s42 offen offset:1024 sc1 lds
    v_fmac_f32 v239, v66, v138
    v_fmac_f32 v241, v74, v138
    v_fmac_f32 v239, v67, v139
    v_fmac_f32 v241, v75, v139
    v_fmac_f32 v239, v68, v140
    v_mfma_f32_32x32x16_bf16 v[48:63], v[88:91], v[188:191], 0
    v_fmac_f32 v241, v76, v140
    v_fmac_f32 v239, v69, v141
    v_fmac_f32 v241, v77, v141
    v_fmac_f32 v239, v70, v142
    v_fmac_f32 v241, v78, v142
    v_fmac_f32 v239, v71, v143
    v_fmac_f32 v241, v79, v143
    v_mfma_f32_32x32x16_bf16 v[64:79], v[92:95], v[188:191], 0
    v_permlane32_swap_b32 v234, v236
    v_permlane32_swap_b32 v235, v237
    v_permlane32_swap_b32 v238, v239
    s_waitcnt vmcnt(6) lgkmcnt(0)
    v_mfma_f32_32x32x16_bf16 v[24:39], v[84:87], v[176:179], v[24:39]
    ds_read_b64_tr_b16 v[184:185], v246 offset:2048
    ds_read_b64_tr_b16 v[188:189], v247 offset:2048
    v_add_f32 v234, v234, v236
    v_add_f32 v235, v235, v237
    v_add_f32 v238, -v238, -v239
    s_mov_b32 m0, s68
    v_mfma_f32_32x32x16_bf16 v[8:23], v[80:83], v[176:179], v[8:23]
    buffer_load_dwordx4 v226, s[4:7], s42 offen sc1 lds
    s_set_gpr_idx_on s31, gpr_idx(DST)
    s_nop 0
    v_cvt_pk_bf16_f32 v192, v234, v235
    v_cvt_pk_bf16_f32 v197, v238, v238
    s_set_gpr_idx_off
    v_mfma_f32_32x32x16_bf16 v[48:63], v[80:83], v[180:183], v[48:63]
    v_mfma_f32_32x32x16_bf16 v[64:79], v[84:87], v[180:183], v[64:79]
    s_waitcnt vmcnt(5) lgkmcnt(0)
    v_mfma_f32_32x32x8_bf16 v[24:39], v[242:243], v[184:185], v[24:39]
    ds_read_b64_tr_b16 v[176:177], v246 offset:4096
    ds_read_b64_tr_b16 v[178:179], v246 offset:5120
    ds_read_b64_tr_b16 v[180:181], v247 offset:4096
    ds_read_b64_tr_b16 v[182:183], v247 offset:5120
    s_mov_b32 m0, s69
    v_mfma_f32_32x32x8_bf16 v[8:23], v[228:229], v[184:185], v[8:23]
    buffer_load_dwordx4 v222, s[4:7], s43 offen sc1 lds
    buffer_load_dwordx4 v223, s[72:75], s43 offen offset:1024 sc1 lds
    v_mfma_f32_32x32x8_bf16 v[48:63], v[228:229], v[188:189], v[48:63]
    s_nop 2
    v_mul_f32 v236, v24, v160
    v_mul_f32 v238, v32, v160
    v_fmac_f32 v236, v25, v161
    v_fmac_f32 v238, v33, v161
    v_fmac_f32 v236, v26, v162
    v_fmac_f32 v238, v34, v162
    v_fmac_f32 v236, v27, v163
    v_mfma_f32_32x32x8_bf16 v[64:79], v[242:243], v[188:189], v[64:79]
    s_setprio 0
    v_fmac_f32 v238, v35, v163
    v_fmac_f32 v236, v28, v164
    v_fmac_f32 v238, v36, v164
    v_fmac_f32 v236, v29, v165
    v_fmac_f32 v238, v37, v165
    v_fmac_f32 v236, v30, v166
    v_fmac_f32 v238, v38, v166
    v_fmac_f32 v236, v31, v167
    v_fmac_f32 v238, v39, v167
    v_mul_f32 v234, v8, v144
    v_mul_f32 v235, v48, v152
    v_fmac_f32 v234, v9, v145
    v_fmac_f32 v235, v49, v153
    v_fmac_f32 v234, v10, v146
    v_fmac_f32 v235, v50, v154
    v_fmac_f32 v234, v11, v147
    v_fmac_f32 v235, v51, v155
    v_fmac_f32 v234, v12, v148
    v_fmac_f32 v235, v52, v156
    v_fmac_f32 v234, v13, v149
    v_fmac_f32 v235, v53, v157
    v_fmac_f32 v234, v14, v150
    v_fmac_f32 v235, v54, v158
    v_fmac_f32 v234, v15, v151
    v_fmac_f32 v235, v55, v159
    v_mul_f32 v237, v64, v168
    v_mul_f32 v239, v72, v168
    v_fmac_f32 v237, v65, v169
    v_fmac_f32 v239, v73, v169
    s_setprio 1
    s_waitcnt vmcnt(3) lgkmcnt(0)
    v_mfma_f32_32x32x16_bf16 v[24:39], v[80:83], v[176:179], 0
    ds_read_b64_tr_b16 v[184:185], v246 offset:6144
    ds_read_b64_tr_b16 v[186:187], v246 offset:7168
    ds_read_b64_tr_b16 v[188:189], v247 offset:6144
    ds_read_b64_tr_b16 v[190:191], v247 offset:7168
    v_fmac_f32 v237, v66, v170
    v_fmac_f32 v239, v74, v170
    s_mov_b32 m0, s70
    v_mfma_f32_32x32x16_bf16 v[0:15], v[84:87], v[176:179], 0
    buffer_load_dwordx4 v224, s[4:7], s43 offen sc1 lds
    buffer_load_dwordx4 v225, s[72:75], s43 offen offset:1024 sc1 lds
    v_fmac_f32 v237, v67, v171
    v_fmac_f32 v239, v75, v171
    v_fmac_f32 v237, v68, v172
    v_fmac_f32 v239, v76, v172
    v_fmac_f32 v237, v69, v173
    v_mfma_f32_32x32x16_bf16 v[40:55], v[84:87], v[180:183], 0
    v_add_u32 v222, s48, v251
    ds_read2_b32 v[222:223], v222 offset0:1 offset1:3
    v_fmac_f32 v239, v77, v173
    v_fmac_f32 v237, v70, v174
    v_fmac_f32 v239, v78, v174
    v_fmac_f32 v237, v71, v175
    v_fmac_f32 v239, v79, v175
    v_mfma_f32_32x32x16_bf16 v[64:79], v[80:83], v[180:183], 0
    v_permlane32_swap_b32 v234, v240
    v_permlane32_swap_b32 v235, v241
    v_add_f32 v234, v234, v240
    v_add_f32 v235, v235, v241
    s_waitcnt vmcnt(4) lgkmcnt(1)
    v_mfma_f32_32x32x16_bf16 v[24:39], v[88:91], v[184:187], v[24:39]
    ds_read_b64_tr_b16 v[176:177], v246 offset:0
    ds_read_b64_tr_b16 v[180:181], v247 offset:0
    s_set_gpr_idx_on s31, gpr_idx(DST)
    s_nop 0
    v_cvt_pk_bf16_f32 v193, v234, v235
    s_set_gpr_idx_off
    s_mov_b32 m0, s71
    v_mfma_f32_32x32x16_bf16 v[0:15], v[92:95], v[184:187], v[0:15]
    buffer_load_dwordx4 v226, s[4:7], s43 offen sc1 lds
    s_waitcnt lgkmcnt(2)
    v_mad_u32_u16 v222, v222, s39, v248 op_sel:[1,0,0,0]
    v_mad_u32_u16 v223, v223, s39, v248 op_sel:[1,0,0,0]
    v_mfma_f32_32x32x16_bf16 v[40:55], v[92:95], v[188:191], v[40:55]
    v_add_u32 v224, s49, v251
    ds_read2_b32 v[224:225], v224 offset0:1 offset1:3
    v_mfma_f32_32x32x16_bf16 v[64:79], v[88:91], v[188:191], v[64:79]
    s_waitcnt vmcnt(3) lgkmcnt(1)
    v_mfma_f32_32x32x8_bf16 v[24:39], v[228:229], v[176:177], v[24:39]
    ds_read_b64_tr_b16 v[184:185], v246 offset:2048
    ds_read_b64_tr_b16 v[186:187], v246 offset:3072
    ds_read_b64_tr_b16 v[188:189], v247 offset:2048
    ds_read_b64_tr_b16 v[190:191], v247 offset:3072
    s_mov_b32 m0, s68
    v_mfma_f32_32x32x8_bf16 v[0:15], v[242:243], v[176:177], v[0:15]
    buffer_load_dwordx4 v222, s[4:7], s44 offen sc1 lds
    buffer_load_dwordx4 v223, s[72:75], s44 offen offset:1024 sc1 lds
    s_waitcnt lgkmcnt(4)
    v_mad_u32_u16 v224, v224, s39, v248 op_sel:[1,0,0,0]
    v_mad_u32_u16 v225, v225, s39, v248 op_sel:[1,0,0,0]
    v_mfma_f32_32x32x8_bf16 v[40:55], v[242:243], v[180:181], v[40:55]
    v_add_u32 v226, s50, v251
    ds_read2_b32 v[226:227], v226 offset0:1 offset1:3
    v_mul_f32 v240, v24, v144
    v_fmac_f32 v236, v32, v160
    v_fmac_f32 v240, v25, v145
    v_fmac_f32 v236, v33, v161
    v_fmac_f32 v240, v26, v146
    v_mfma_f32_32x32x8_bf16 v[64:79], v[228:229], v[180:181], v[64:79]
    s_setprio 0
    v_fmac_f32 v236, v34, v162
    v_fmac_f32 v240, v27, v147
    v_fmac_f32 v236, v35, v163
    v_fmac_f32 v240, v28, v148
    v_fmac_f32 v236, v36, v164
    v_fmac_f32 v240, v29, v149
    v_fmac_f32 v236, v37, v165
    v_fmac_f32 v240, v30, v150
    v_fmac_f32 v236, v38, v166
    v_fmac_f32 v240, v31, v151
    v_fmac_f32 v236, v39, v167
    v_mul_f32 v234, v0, v112
    v_mul_f32 v235, v40, v120
    v_fmac_f32 v234, v1, v113
    v_fmac_f32 v235, v41, v121
    v_fmac_f32 v234, v2, v114
    v_fmac_f32 v235, v42, v122
    v_fmac_f32 v234, v3, v115
    v_fmac_f32 v235, v43, v123
    v_fmac_f32 v234, v4, v116
    v_fmac_f32 v235, v44, v124
    v_fmac_f32 v234, v5, v117
    v_fmac_f32 v235, v45, v125
    v_fmac_f32 v234, v6, v118
    v_fmac_f32 v235, v46, v126
    v_fmac_f32 v234, v7, v119
    v_fmac_f32 v235, v47, v127
    v_mul_f32 v241, v64, v152
    v_fmac_f32 v237, v72, v168
    v_fmac_f32 v241, v65, v153
    v_fmac_f32 v237, v73, v169
    v_fmac_f32 v241, v66, v154
    s_setprio 1
    s_waitcnt vmcnt(3) lgkmcnt(1)
    v_mfma_f32_32x32x16_bf16 v[24:39], v[80:83], v[184:187], 0
    ds_read_b64_tr_b16 v[176:177], v246 offset:4096
    ds_read_b64_tr_b16 v[178:179], v246 offset:5120
    ds_read_b64_tr_b16 v[180:181], v247 offset:4096
    ds_read_b64_tr_b16 v[182:183], v247 offset:5120
    v_fmac_f32 v237, v74, v170
    v_fmac_f32 v241, v67, v155
    s_mov_b32 m0, s69
    v_mfma_f32_32x32x16_bf16 v[8:23], v[84:87], v[184:187], v[8:23]
    buffer_load_dwordx4 v224, s[4:7], s45 offen sc1 lds
    buffer_load_dwordx4 v225, s[72:75], s45 offen offset:1024 sc1 lds
    s_waitcnt lgkmcnt(4)
    v_mad_u32_u16 v226, v226, s39, v248 op_sel:[1,0,0,0]
    v_mad_u32_u16 v227, v227, s39, v248 op_sel:[1,0,0,0]
    v_fmac_f32 v237, v75, v171
    v_fmac_f32 v241, v68, v156
    v_mfma_f32_32x32x16_bf16 v[48:63], v[84:87], v[188:191], v[48:63]
    v_fmac_f32 v237, v76, v172
    v_fmac_f32 v241, v69, v157
    v_fmac_f32 v237, v77, v173
    v_fmac_f32 v241, v70, v158
    v_fmac_f32 v237, v78, v174
    v_fmac_f32 v241, v71, v159
    v_fmac_f32 v237, v79, v175
    v_mfma_f32_32x32x16_bf16 v[64:79], v[80:83], v[188:191], 0
    v_permlane32_swap_b32 v236, v240
    v_permlane32_swap_b32 v237, v241
    v_add_f32 v236, v236, v240
    v_add_f32 v237, v237, v241
    s_waitcnt vmcnt(4) lgkmcnt(0)
    v_mfma_f32_32x32x16_bf16 v[24:39], v[88:91], v[176:179], v[24:39]
    ds_read_b64_tr_b16 v[184:185], v246 offset:6144
    ds_read_b64_tr_b16 v[188:189], v247 offset:6144
    s_set_gpr_idx_on s31, gpr_idx(DST)
    s_nop 0
    v_cvt_pk_bf16_f32 v196, v236, v237
    s_set_gpr_idx_off
    s_mov_b32 s32, s31
    s_mov_b32 m0, s70
    v_mfma_f32_32x32x16_bf16 v[8:23], v[92:95], v[176:179], v[8:23]
    buffer_load_dwordx4 v226, s[4:7], s46 offen sc1 lds
    buffer_load_dwordx4 v227, s[72:75], s46 offen offset:1024 sc1 lds
    s_sub_u32 s26, s48, s29
    s_mov_b32 s29, s48
    s_mov_b32 s30, s3
    s_bfe_u32 s56, s3, 0x40012
    s_mov_b32 s31, s35
    v_mfma_f32_32x32x16_bf16 v[48:63], v[92:95], v[180:183], v[48:63]
    s_cmp_eq_u32 s34, 0
    s_cselect_b32 s56, s56, 0
    v_mfma_f32_32x32x16_bf16 v[64:79], v[88:91], v[180:183], v[64:79]
    s_waitcnt vmcnt(4) lgkmcnt(0)
    v_mfma_f32_32x32x8_bf16 v[24:39], v[228:229], v[184:185], v[24:39]
    ds_read_b64_tr_b16 v[176:177], v246 offset:0
    ds_read_b64_tr_b16 v[178:179], v246 offset:1024
    ds_read_b64_tr_b16 v[180:181], v247 offset:0
    ds_read_b64_tr_b16 v[182:183], v247 offset:1024
    s_mov_b32 m0, s71
    v_mfma_f32_32x32x8_bf16 v[8:23], v[242:243], v[184:185], v[8:23]
    s_cmp_eq_u32 s33, 4
    s_cbranch_scc1 K2_g4_34
    buffer_load_dwordx4 v224, s[4:7], s47 offen sc1 lds
    buffer_load_dwordx4 v225, s[72:75], s47 offen offset:1024 sc1 lds
K2_back_35:
    v_mfma_f32_32x32x8_bf16 v[48:63], v[242:243], v[188:189], v[48:63]
    s_nop 0
    v_mul_f32 v236, v24, v144
    v_fma_f32 v238, v32, v160, -v238
    v_fmac_f32 v236, v25, v145
    v_fmac_f32 v238, v33, v161
    v_fmac_f32 v236, v26, v146
    v_fmac_f32 v238, v34, v162
    v_fmac_f32 v236, v27, v147
    v_mfma_f32_32x32x8_bf16 v[64:79], v[228:229], v[188:189], v[64:79]
    s_setprio 0
    v_fmac_f32 v238, v35, v163
    v_fmac_f32 v236, v28, v148
    v_fmac_f32 v238, v36, v164
    v_fmac_f32 v236, v29, v149
    v_fmac_f32 v238, v37, v165
    v_fmac_f32 v236, v30, v150
    v_fmac_f32 v238, v38, v166
    v_fmac_f32 v236, v31, v151
    v_fmac_f32 v238, v39, v167
    v_add_u32 v249, s26, v249
    v_add_u32 v250, s26, v250
    v_mul_f32 v240, v8, v160
    v_fma_f32 v234, v16, v112, -v234
    v_fmac_f32 v240, v9, v161
    v_fmac_f32 v234, v17, v113
    v_fmac_f32 v240, v10, v162
    v_fmac_f32 v234, v18, v114
    v_fmac_f32 v240, v11, v163
    v_fmac_f32 v234, v19, v115
    v_fmac_f32 v240, v12, v164
    v_fmac_f32 v234, v20, v116
    v_fmac_f32 v240, v13, v165
    v_fmac_f32 v234, v21, v117
    v_fmac_f32 v240, v14, v166
    v_fmac_f32 v234, v22, v118
    v_fmac_f32 v240, v15, v167
    v_fmac_f32 v234, v23, v119
    ds_read_b64_tr_b16 v[0:1], v249 offset:0
    ds_read_b64_tr_b16 v[2:3], v249 offset:32
    ds_read_u16_d16_hi v40, v250 offset:0
    v_mul_f32 v241, v48, v168
    v_fma_f32 v235, v56, v120, -v235
    v_fmac_f32 v241, v49, v169
    v_fmac_f32 v235, v57, v121
    v_fmac_f32 v241, v50, v170
    v_fmac_f32 v235, v58, v122
    v_fmac_f32 v241, v51, v171
    v_fmac_f32 v235, v59, v123
    v_fmac_f32 v241, v52, v172
    v_fmac_f32 v235, v60, v124
    v_fmac_f32 v241, v53, v173
    v_fmac_f32 v235, v61, v125
    v_fmac_f32 v241, v54, v174
    v_fmac_f32 v235, v62, v126
    v_fmac_f32 v241, v55, v175
    v_fmac_f32 v235, v63, v127
    ds_read_b64_tr_b16 v[4:5], v249 offset:512
    ds_read_b64_tr_b16 v[6:7], v249 offset:544
    ds_read_u16_d16_hi v41, v250 offset:128
    v_mul_f32 v237, v64, v152
    v_fma_f32 v239, v72, v168, -v239
    v_fmac_f32 v237, v65, v153
    v_fmac_f32 v239, v73, v169
    v_fmac_f32 v237, v66, v154
    v_fmac_f32 v239, v74, v170
    v_fmac_f32 v237, v67, v155
    v_fmac_f32 v239, v75, v171
    v_fmac_f32 v237, v68, v156
    v_fmac_f32 v239, v76, v172
    v_fmac_f32 v237, v69, v157
    v_fmac_f32 v239, v77, v173
    v_fmac_f32 v237, v70, v158
    v_fmac_f32 v239, v78, v174
    v_fmac_f32 v237, v71, v159
    v_fmac_f32 v239, v79, v175
    s_cmp_eq_u32 s56, 5
    s_cbranch_scc1 K2_U20
    s_cmp_eq_u32 s56, 6
    s_cbranch_scc1 K2_U3h0
    s_branch K2_DSP0
K2_U30:
    s_setprio 1
    ds_read_b64_tr_b16 v[8:9], v249 offset:1024
    ds_read_b64_tr_b16 v[10:11], v249 offset:1056
    ds_read_u16_d16_hi v42, v250 offset:256
    s_waitcnt lgkmcnt(3)
    v_lshlrev_b32 v16, 16, v0
    v_and_b32 v17, 0xffff0000, v0
    v_lshlrev_b32 v18, 16, v1
    v_and_b32 v19, 0xffff0000, v1
    v_lshlrev_b32 v20, 16, v2
    v_and_b32 v21, 0xffff0000, v2
    v_lshlrev_b32 v22, 16, v3
    v_and_b32 v23, 0xffff0000, v3
    v_mul_f32_dpp v32, v40, v16 row_newbcast:8 row_mask:0xf bank_mask:0xf
    v_mul_f32_dpp v33, v40, v17 row_newbcast:9 row_mask:0xf bank_mask:0xf
    v_mul_f32_dpp v34, v40, v18 row_newbcast:10 row_mask:0xf bank_mask:0xf
    v_mul_f32_dpp v35, v40, v19 row_newbcast:11 row_mask:0xf bank_mask:0xf
    v_mul_f32_dpp v36, v40, v20 row_newbcast:12 row_mask:0xf bank_mask:0xf
    v_mul_f32_dpp v37, v40, v21 row_newbcast:13 row_mask:0xf bank_mask:0xf
    v_mul_f32_dpp v38, v40, v22 row_newbcast:14 row_mask:0xf bank_mask:0xf
    v_mul_f32_dpp v39, v40, v23 row_newbcast:15 row_mask:0xf bank_mask:0xf
    v_cvt_pk_bf16_f32 v84, v32, v33
    v_cvt_pk_bf16_f32 v85, v34, v35
    v_cvt_pk_bf16_f32 v86, v36, v37
    v_cvt_pk_bf16_f32 v87, v38, v39
    v_mul_f32_dpp v16, v40, v16 row_newbcast:0 row_mask:0xa bank_mask:0xf
    v_mul_f32_dpp v17, v40, v17 row_newbcast:1 row_mask:0xa bank_mask:0xf
    v_mul_f32_dpp v18, v40, v18 row_newbcast:2 row_mask:0xa bank_mask:0xf
    v_mul_f32_dpp v19, v40, v19 row_newbcast:3 row_mask:0xa bank_mask:0xf
    v_mul_f32_dpp v20, v40, v20 row_newbcast:4 row_mask:0xa bank_mask:0xf
    v_mul_f32_dpp v21, v40, v21 row_newbcast:5 row_mask:0xa bank_mask:0xf
    v_mul_f32_dpp v22, v40, v22 row_newbcast:6 row_mask:0xa bank_mask:0xf
    v_mul_f32_dpp v23, v40, v23 row_newbcast:7 row_mask:0xa bank_mask:0xf
    v_cvt_pk_bf16_f32 v80, v16, v17
    v_cvt_pk_bf16_f32 v81, v18, v19
    v_cvt_pk_bf16_f32 v82, v20, v21
    v_cvt_pk_bf16_f32 v83, v22, v23
    v_lshlrev_b32 v24, 16, v4
    v_and_b32 v25, 0xffff0000, v4
    v_lshlrev_b32 v26, 16, v5
    v_and_b32 v27, 0xffff0000, v5
    v_lshlrev_b32 v28, 16, v6
    v_and_b32 v29, 0xffff0000, v6
    v_lshlrev_b32 v30, 16, v7
    v_and_b32 v31, 0xffff0000, v7
    v_mul_f32_dpp v32, v41, v24 row_newbcast:8 row_mask:0xf bank_mask:0xf
    v_mul_f32_dpp v33, v41, v25 row_newbcast:9 row_mask:0xf bank_mask:0xf
    v_mul_f32_dpp v34, v41, v26 row_newbcast:10 row_mask:0xf bank_mask:0xf
    v_mul_f32_dpp v35, v41, v27 row_newbcast:11 row_mask:0xf bank_mask:0xf
    v_mul_f32_dpp v36, v41, v28 row_newbcast:12 row_mask:0xf bank_mask:0xf
    v_mul_f32_dpp v37, v41, v29 row_newbcast:13 row_mask:0xf bank_mask:0xf
    v_mul_f32_dpp v38, v41, v30 row_newbcast:14 row_mask:0xf bank_mask:0xf
    v_mul_f32_dpp v39, v41, v31 row_newbcast:15 row_mask:0xf bank_mask:0xf
    v_cvt_pk_bf16_f32 v92, v32, v33
    v_cvt_pk_bf16_f32 v93, v34, v35
    v_cvt_pk_bf16_f32 v94, v36, v37
    v_cvt_pk_bf16_f32 v95, v38, v39
    v_mul_f32_dpp v24, v41, v24 row_newbcast:0 row_mask:0xa bank_mask:0xf
    v_mul_f32_dpp v25, v41, v25 row_newbcast:1 row_mask:0xa bank_mask:0xf
    v_mul_f32_dpp v26, v41, v26 row_newbcast:2 row_mask:0xa bank_mask:0xf
    v_mul_f32_dpp v27, v41, v27 row_newbcast:3 row_mask:0xa bank_mask:0xf
    v_mul_f32_dpp v28, v41, v28 row_newbcast:4 row_mask:0xa bank_mask:0xf
    v_mul_f32_dpp v29, v41, v29 row_newbcast:5 row_mask:0xa bank_mask:0xf
    v_mul_f32_dpp v30, v41, v30 row_newbcast:6 row_mask:0xa bank_mask:0xf
    v_mul_f32_dpp v31, v41, v31 row_newbcast:7 row_mask:0xa bank_mask:0xf
    v_cvt_pk_bf16_f32 v88, v24, v25
    v_cvt_pk_bf16_f32 v89, v26, v27
    v_cvt_pk_bf16_f32 v90, v28, v29
    v_cvt_pk_bf16_f32 v91, v30, v31
    s_waitcnt lgkmcnt(0)
    v_lshlrev_b32 v16, 16, v8
    v_and_b32 v17, 0xffff0000, v8
    v_lshlrev_b32 v18, 16, v9
    v_and_b32 v19, 0xffff0000, v9
    v_lshlrev_b32 v20, 16, v10
    v_and_b32 v21, 0xffff0000, v10
    v_lshlrev_b32 v22, 16, v11
    v_and_b32 v23, 0xffff0000, v11
    v_mul_f32_dpp v32, v42, v16 row_newbcast:8 row_mask:0xf bank_mask:0xf
    v_mul_f32_dpp v33, v42, v17 row_newbcast:9 row_mask:0xf bank_mask:0xf
    v_mul_f32_dpp v34, v42, v18 row_newbcast:10 row_mask:0xf bank_mask:0xf
    v_mul_f32_dpp v35, v42, v19 row_newbcast:11 row_mask:0xf bank_mask:0xf
    v_mul_f32_dpp v36, v42, v20 row_newbcast:12 row_mask:0xf bank_mask:0xf
    v_mul_f32_dpp v37, v42, v21 row_newbcast:13 row_mask:0xf bank_mask:0xf
    v_mul_f32_dpp v38, v42, v22 row_newbcast:14 row_mask:0xf bank_mask:0xf
    v_mul_f32_dpp v39, v42, v23 row_newbcast:15 row_mask:0xf bank_mask:0xf
    v_cvt_pk_bf16_f32 v242, v32, v33
    v_cvt_pk_bf16_f32 v243, v34, v35
    v_cvt_pk_bf16_f32 v244, v36, v37
    v_cvt_pk_bf16_f32 v245, v38, v39
    v_mul_f32_dpp v16, v42, v16 row_newbcast:0 row_mask:0xa bank_mask:0xf
    v_mul_f32_dpp v17, v42, v17 row_newbcast:1 row_mask:0xa bank_mask:0xf
    v_mul_f32_dpp v18, v42, v18 row_newbcast:2 row_mask:0xa bank_mask:0xf
    v_mul_f32_dpp v19, v42, v19 row_newbcast:3 row_mask:0xa bank_mask:0xf
    v_mul_f32_dpp v20, v42, v20 row_newbcast:4 row_mask:0xa bank_mask:0xf
    v_mul_f32_dpp v21, v42, v21 row_newbcast:5 row_mask:0xa bank_mask:0xf
    v_mul_f32_dpp v22, v42, v22 row_newbcast:6 row_mask:0xa bank_mask:0xf
    v_mul_f32_dpp v23, v42, v23 row_newbcast:7 row_mask:0xa bank_mask:0xf
    v_cvt_pk_bf16_f32 v228, v16, v17
    v_cvt_pk_bf16_f32 v229, v18, v19
    v_cvt_pk_bf16_f32 v230, v20, v21
    v_cvt_pk_bf16_f32 v231, v22, v23
    s_waitcnt vmcnt(4)
    v_mfma_f32_32x32x16_bf16 v[8:23], v[80:83], v[176:179], 0
    ds_read_b64_tr_b16 v[184:185], v246 offset:2048
    ds_read_b64_tr_b16 v[186:187], v246 offset:3072
    ds_read_b64_tr_b16 v[188:189], v247 offset:2048
    ds_read_b64_tr_b16 v[190:191], v247 offset:3072
    s_mov_b32 m0, s68
    v_mfma_f32_32x32x16_bf16 v[24:39], v[84:87], v[176:179], 0
    buffer_load_dwordx4 v222, s[4:7], s41 offen sc1 lds
    buffer_load_dwordx4 v223, s[72:75], s41 offen offset:1024 sc1 lds
    v_permlane32_swap_b32 v236, v234
    v_permlane32_swap_b32 v237, v235
    s_add_u32 s38, s38, 1
    v_mfma_f32_32x32x16_bf16 v[48:63], v[80:83], v[180:183], 0
    v_permlane32_swap_b32 v240, v238
    v_permlane32_swap_b32 v241, v239
    v_add_f32 v236, v236, v234
    v_add_f32 v237, v237, v235
    v_add_f32 v240, -v240, -v238
    v_mfma_f32_32x32x16_bf16 v[64:79], v[84:87], v[180:183], 0
    v_add_f32 v241, -v241, -v239
    s_set_gpr_idx_on s32, gpr_idx(DST)
    s_nop 0
    v_cvt_pk_bf16_f32 v194, v236, v237
    v_cvt_pk_bf16_f32 v195, v240, v241
    s_set_gpr_idx_off
    v_mov_b32 v254, s52
    s_waitcnt vmcnt(4) lgkmcnt(0)
    v_mfma_f32_32x32x16_bf16 v[8:23], v[88:91], v[184:187], v[8:23]
    ds_read_b64_tr_b16 v[176:177], v246 offset:4096
    ds_read_b64_tr_b16 v[178:179], v246 offset:5120
    ds_read_b64_tr_b16 v[180:181], v247 offset:4096
    ds_read_b64_tr_b16 v[182:183], v247 offset:5120
    v_mov_b32 v255, s38
    s_lshl_b32 s58, s38, 3
    s_mov_b32 m0, s69
    v_mfma_f32_32x32x16_bf16 v[24:39], v[92:95], v[184:187], v[24:39]
    buffer_load_dwordx4 v226, s[4:7], s41 offen sc1 lds
    buffer_load_dwordx4 v227, s[72:75], s41 offen offset:1024 sc1 lds
    s_add_u32 s58, s58, s20
    s_mov_b64 exec, 1
    ds_write_b32 v254, v255
    s_mov_b64 exec, -1
    s_cmp_lt_u32 s58, s22
    s_cbranch_scc0 K2_dyn_40
K2_back_41:
    v_readlane_b32 s3, v253, s58
    s_lshl_b32 s44, s34, 7
    s_and_b32 s48, s3, 0x3ffff
    s_bfe_u32 s33, s3, 0x30013
    s_mul_i32 s35, s38, 6
    s_cmp_eq_u32 s34, 0
    s_cselect_b32 s35, s35, s48
    s_mov_b32 s45, s44
    s_xor_b32 s47, s44, 256
    s_add_u32 s49, s48, 128
    s_add_u32 s60, s48, 256
    s_cmp_eq_u32 s33, 3
    s_cselect_b32 s46, s44, s47
    s_cselect_b32 s50, s60, s48
    s_sub_u32 s60, s33, 2
    s_cmp_lt_u32 s60, 2
    s_cbranch_scc0 K2_rare_46
K2_back_47:
    v_mfma_f32_32x32x16_bf16 v[48:63], v[88:91], v[188:191], v[48:63]
    v_add_u32 v43, s48, v232
    ds_read_b32 v42, v43
    ds_read_b32 v43, v43 offset:1024
    v_mfma_f32_32x32x16_bf16 v[64:79], v[92:95], v[188:191], v[64:79]
    s_waitcnt vmcnt(4) lgkmcnt(3)
    v_mfma_f32_32x32x16_bf16 v[8:23], v[228:231], v[176:179], v[8:23]
    ds_read_b64_tr_b16 v[184:185], v246 offset:6144
    ds_read_b64_tr_b16 v[186:187], v246 offset:7168
    ds_read_b64_tr_b16 v[188:189], v247 offset:6144
    ds_read_b64_tr_b16 v[190:191], v247 offset:7168
    s_mov_b32 m0, s70
    v_mfma_f32_32x32x16_bf16 v[24:39], v[242:245], v[176:179], v[24:39]
    buffer_load_dwordx4 v222, s[4:7], s42 offen sc1 lds
    buffer_load_dwordx4 v223, s[72:75], s42 offen offset:1024 sc1 lds
    v_mfma_f32_32x32x16_bf16 v[48:63], v[228:231], v[180:183], v[48:63]
    s_nop 2
    v_mul_f32 v234, v8, v96
    v_mul_f32 v236, v16, v128
    v_fmac_f32 v234, v9, v97
    v_fmac_f32 v236, v17, v129
    v_fmac_f32 v234, v10, v98
    v_fmac_f32 v236, v18, v130
    v_fmac_f32 v234, v11, v99
    v_mfma_f32_32x32x16_bf16 v[64:79], v[242:245], v[180:183], v[64:79]
    s_setprio 0
    s_waitcnt lgkmcnt(4)
    v_or_b32 v42, v42, v233
    v_or_b32 v43, v43, v233
    s_cmp_lg_u32 s34, 0
    s_cbranch_scc1 K2_dum_51
    s_cmp_eq_u32 s33, 4
    s_cbranch_scc1 K2_a4_52
K2_b4_54:
    s_add_u32 m0, s48, 512
    s_add_u32 s65, s48, 1536
    buffer_load_dwordx4 v42, s[16:19], 0 offen  lds
    s_mov_b32 m0, s65
    s_mov_b32 exec_hi, 0
    buffer_load_dwordx4 v43, s[16:19], 0 offen  lds
    s_mov_b32 exec_hi, -1
K2_back_53:
    v_fmac_f32 v236, v19, v131
    v_fmac_f32 v234, v12, v100
    v_fmac_f32 v236, v20, v132
    v_fmac_f32 v234, v13, v101
    v_fmac_f32 v236, v21, v133
    v_fmac_f32 v234, v14, v102
    v_fmac_f32 v236, v22, v134
    v_fmac_f32 v234, v15, v103
    v_fmac_f32 v236, v23, v135
    v_mul_f32 v238, v24, v128
    v_mul_f32 v240, v32, v128
    v_fmac_f32 v238, v25, v129
    v_fmac_f32 v240, v33, v129
    v_fmac_f32 v238, v26, v130
    v_fmac_f32 v240, v34, v130
    v_fmac_f32 v238, v27, v131
    v_fmac_f32 v240, v35, v131
    v_fmac_f32 v238, v28, v132
    v_fmac_f32 v240, v36, v132
    v_fmac_f32 v238, v29, v133
    v_fmac_f32 v240, v37, v133
    v_fmac_f32 v238, v30, v134
    v_fmac_f32 v240, v38, v134
    v_fmac_f32 v238, v31, v135
    v_fmac_f32 v240, v39, v135
    v_mul_f32 v235, v48, v104
    v_mul_f32 v237, v56, v136
    v_fmac_f32 v235, v49, v105
    v_fmac_f32 v237, v57, v137
    v_fmac_f32 v235, v50, v106
    v_fmac_f32 v237, v58, v138
    v_fmac_f32 v235, v51, v107
    v_fmac_f32 v237, v59, v139
    v_fmac_f32 v235, v52, v108
    v_fmac_f32 v237, v60, v140
    v_fmac_f32 v235, v53, v109
    v_fmac_f32 v237, v61, v141
    v_fmac_f32 v235, v54, v110
    v_fmac_f32 v237, v62, v142
    v_fmac_f32 v235, v55, v111
    v_fmac_f32 v237, v63, v143
    v_mul_f32 v239, v64, v136
    v_mul_f32 v241, v72, v136
    s_setprio 1
    s_waitcnt vmcnt(6) lgkmcnt(0)
    v_mfma_f32_32x32x16_bf16 v[24:39], v[92:95], v[184:187], 0
    ds_read_b64_tr_b16 v[176:177], v246 offset:0
    ds_read_b64_tr_b16 v[178:179], v246 offset:1024
    ds_read_b64_tr_b16 v[180:181], v247 offset:0
    ds_read_b64_tr_b16 v[182:183], v247 offset:1024
    v_fmac_f32 v239, v65, v137
    v_fmac_f32 v241, v73, v137
    s_mov_b32 m0, s71
    v_mfma_f32_32x32x16_bf16 v[8:23], v[88:91], v[184:187], 0
    buffer_load_dwordx4 v224, s[4:7], s42 offen sc1 lds
    buffer_load_dwordx4 v225, s[72:75], s42 offen offset:1024 sc1 lds
    v_fmac_f32 v239, v66, v138
    v_fmac_f32 v241, v74, v138
    v_fmac_f32 v239, v67, v139
    v_fmac_f32 v241, v75, v139
    v_fmac_f32 v239, v68, v140
    v_mfma_f32_32x32x16_bf16 v[48:63], v[88:91], v[188:191], 0
    v_fmac_f32 v241, v76, v140
    v_fmac_f32 v239, v69, v141
    v_fmac_f32 v241, v77, v141
    v_fmac_f32 v239, v70, v142
    v_fmac_f32 v241, v78, v142
    v_fmac_f32 v239, v71, v143
    v_fmac_f32 v241, v79, v143
    v_mfma_f32_32x32x16_bf16 v[64:79], v[92:95], v[188:191], 0
    v_permlane32_swap_b32 v234, v236
    v_permlane32_swap_b32 v235, v237
    v_permlane32_swap_b32 v238, v239
    s_waitcnt vmcnt(6) lgkmcnt(0)
    v_mfma_f32_32x32x16_bf16 v[24:39], v[84:87], v[176:179], v[24:39]
    ds_read_b64_tr_b16 v[184:185], v246 offset:2048
    ds_read_b64_tr_b16 v[186:187], v246 offset:3072
    ds_read_b64_tr_b16 v[188:189], v247 offset:2048
    ds_read_b64_tr_b16 v[190:191], v247 offset:3072
    v_add_f32 v234, v234, v236
    v_add_f32 v235, v235, v237
    s_mov_b32 m0, s68
    v_mfma_f32_32x32x16_bf16 v[8:23], v[80:83], v[176:179], v[8:23]
    buffer_load_dwordx4 v226, s[4:7], s42 offen sc1 lds
    buffer_load_dwordx4 v227, s[72:75], s42 offen offset:1024 sc1 lds
    v_add_f32 v238, -v238, -v239
    s_set_gpr_idx_on s31, gpr_idx(DST)
    s_nop 0
    v_cvt_pk_bf16_f32 v192, v234, v235
    v_cvt_pk_bf16_f32 v197, v238, v238
    s_set_gpr_idx_off
    v_mfma_f32_32x32x16_bf16 v[48:63], v[80:83], v[180:183], v[48:63]
    v_mfma_f32_32x32x16_bf16 v[64:79], v[84:87], v[180:183], v[64:79]
    s_waitcnt vmcnt(6) lgkmcnt(0)
    v_mfma_f32_32x32x16_bf16 v[24:39], v[242:245], v[184:187], v[24:39]
    ds_read_b64_tr_b16 v[176:177], v246 offset:4096
    ds_read_b64_tr_b16 v[178:179], v246 offset:5120
    ds_read_b64_tr_b16 v[180:181], v247 offset:4096
    ds_read_b64_tr_b16 v[182:183], v247 offset:5120
    s_mov_b32 m0, s69
    v_mfma_f32_32x32x16_bf16 v[8:23], v[228:231], v[184:187], v[8:23]
    buffer_load_dwordx4 v222, s[4:7], s43 offen sc1 lds
    buffer_load_dwordx4 v223, s[72:75], s43 offen offset:1024 sc1 lds
    v_mfma_f32_32x32x16_bf16 v[48:63], v[228:231], v[188:191], v[48:63]
    s_nop 2
    v_mul_f32 v236, v24, v160
    v_mul_f32 v238, v32, v160
    v_fmac_f32 v236, v25, v161
    v_fmac_f32 v238, v33, v161
    v_fmac_f32 v236, v26, v162
    v_fmac_f32 v238, v34, v162
    v_fmac_f32 v236, v27, v163
    v_mfma_f32_32x32x16_bf16 v[64:79], v[242:245], v[188:191], v[64:79]
    s_setprio 0
    v_fmac_f32 v238, v35, v163
    v_fmac_f32 v236, v28, v164
    v_fmac_f32 v238, v36, v164
    v_fmac_f32 v236, v29, v165
    v_fmac_f32 v238, v37, v165
    v_fmac_f32 v236, v30, v166
    v_fmac_f32 v238, v38, v166
    v_fmac_f32 v236, v31, v167
    v_fmac_f32 v238, v39, v167
    v_mul_f32 v234, v8, v144
    v_mul_f32 v235, v48, v152
    v_fmac_f32 v234, v9, v145
    v_fmac_f32 v235, v49, v153
    v_fmac_f32 v234, v10, v146
    v_fmac_f32 v235, v50, v154
    v_fmac_f32 v234, v11, v147
    v_fmac_f32 v235, v51, v155
    v_fmac_f32 v234, v12, v148
    v_fmac_f32 v235, v52, v156
    v_fmac_f32 v234, v13, v149
    v_fmac_f32 v235, v53, v157
    v_fmac_f32 v234, v14, v150
    v_fmac_f32 v235, v54, v158
    v_fmac_f32 v234, v15, v151
    v_fmac_f32 v235, v55, v159
    v_mul_f32 v237, v64, v168
    v_mul_f32 v239, v72, v168
    v_fmac_f32 v237, v65, v169
    v_fmac_f32 v239, v73, v169
    s_setprio 1
    s_waitcnt vmcnt(4) lgkmcnt(0)
    v_mfma_f32_32x32x16_bf16 v[24:39], v[80:83], v[176:179], 0
    ds_read_b64_tr_b16 v[184:185], v246 offset:6144
    ds_read_b64_tr_b16 v[186:187], v246 offset:7168
    ds_read_b64_tr_b16 v[188:189], v247 offset:6144
    ds_read_b64_tr_b16 v[190:191], v247 offset:7168
    v_fmac_f32 v237, v66, v170
    v_fmac_f32 v239, v74, v170
    s_mov_b32 m0, s70
    v_mfma_f32_32x32x16_bf16 v[0:15], v[84:87], v[176:179], 0
    buffer_load_dwordx4 v224, s[4:7], s43 offen sc1 lds
    buffer_load_dwordx4 v225, s[72:75], s43 offen offset:1024 sc1 lds
    v_fmac_f32 v237, v67, v171
    v_fmac_f32 v239, v75, v171
    v_fmac_f32 v237, v68, v172
    v_fmac_f32 v239, v76, v172
    v_fmac_f32 v237, v69, v173
    v_mfma_f32_32x32x16_bf16 v[40:55], v[84:87], v[180:183], 0
    v_add_u32 v222, s48, v251
    ds_read2_b32 v[222:223], v222 offset0:1 offset1:3
    v_fmac_f32 v239, v77, v173
    v_fmac_f32 v237, v70, v174
    v_fmac_f32 v239, v78, v174
    v_fmac_f32 v237, v71, v175
    v_fmac_f32 v239, v79, v175
    v_mfma_f32_32x32x16_bf16 v[64:79], v[80:83], v[180:183], 0
    v_permlane32_swap_b32 v234, v240
    v_permlane32_swap_b32 v235, v241
    v_add_f32 v234, v234, v240
    v_add_f32 v235, v235, v241
    s_waitcnt vmcnt(4) lgkmcnt(1)
    v_mfma_f32_32x32x16_bf16 v[24:39], v[88:91], v[184:187], v[24:39]
    ds_read_b64_tr_b16 v[176:177], v246 offset:0
    ds_read_b64_tr_b16 v[178:179], v246 offset:1024
    ds_read_b64_tr_b16 v[180:181], v247 offset:0
    ds_read_b64_tr_b16 v[182:183], v247 offset:1024
    s_mov_b32 m0, s71
    v_mfma_f32_32x32x16_bf16 v[0:15], v[92:95], v[184:187], v[0:15]
    buffer_load_dwordx4 v226, s[4:7], s43 offen sc1 lds
    buffer_load_dwordx4 v227, s[72:75], s43 offen offset:1024 sc1 lds
    s_waitcnt lgkmcnt(4)
    v_mad_u32_u16 v222, v222, s39, v248 op_sel:[1,0,0,0]
    v_mad_u32_u16 v223, v223, s39, v248 op_sel:[1,0,0,0]
    v_mfma_f32_32x32x16_bf16 v[40:55], v[92:95], v[188:191], v[40:55]
    v_add_u32 v224, s49, v251
    ds_read2_b32 v[224:225], v224 offset0:1 offset1:3
    s_set_gpr_idx_on s31, gpr_idx(DST)
    s_nop 0
    v_cvt_pk_bf16_f32 v193, v234, v235
    s_set_gpr_idx_off
    v_mfma_f32_32x32x16_bf16 v[64:79], v[88:91], v[188:191], v[64:79]
    s_waitcnt vmcnt(4) lgkmcnt(1)
    v_mfma_f32_32x32x16_bf16 v[24:39], v[228:231], v[176:179], v[24:39]
    ds_read_b64_tr_b16 v[184:185], v246 offset:2048
    ds_read_b64_tr_b16 v[186:187], v246 offset:3072
    ds_read_b64_tr_b16 v[188:189], v247 offset:2048
    ds_read_b64_tr_b16 v[190:191], v247 offset:3072
    s_mov_b32 m0, s68
    v_mfma_f32_32x32x16_bf16 v[0:15], v[242:245], v[176:179], v[0:15]
    buffer_load_dwordx4 v222, s[4:7], s44 offen sc1 lds
    buffer_load_dwordx4 v223, s[72:75], s44 offen offset:1024 sc1 lds
    s_waitcnt lgkmcnt(4)
    v_mad_u32_u16 v224, v224, s39, v248 op_sel:[1,0,0,0]
    v_mad_u32_u16 v225, v225, s39, v248 op_sel:[1,0,0,0]
    v_mfma_f32_32x32x16_bf16 v[40:55], v[242:245], v[180:183], v[40:55]
    v_add_u32 v226, s50, v251
    ds_read2_b32 v[226:227], v226 offset0:1 offset1:3
    v_mul_f32 v240, v24, v144
    v_fmac_f32 v236, v32, v160
    v_fmac_f32 v240, v25, v145
    v_fmac_f32 v236, v33, v161
    v_fmac_f32 v240, v26, v146
    v_mfma_f32_32x32x16_bf16 v[64:79], v[228:231], v[180:183], v[64:79]
    s_setprio 0
    v_fmac_f32 v236, v34, v162
    v_fmac_f32 v240, v27, v147
    v_fmac_f32 v236, v35, v163
    v_fmac_f32 v240, v28, v148
    v_fmac_f32 v236, v36, v164
    v_fmac_f32 v240, v29, v149
    v_fmac_f32 v236, v37, v165
    v_fmac_f32 v240, v30, v150
    v_fmac_f32 v236, v38, v166
    v_fmac_f32 v240, v31, v151
    v_fmac_f32 v236, v39, v167
    v_mul_f32 v234, v0, v112
    v_mul_f32 v235, v40, v120
    v_fmac_f32 v234, v1, v113
    v_fmac_f32 v235, v41, v121
    v_fmac_f32 v234, v2, v114
    v_fmac_f32 v235, v42, v122
    v_fmac_f32 v234, v3, v115
    v_fmac_f32 v235, v43, v123
    v_fmac_f32 v234, v4, v116
    v_fmac_f32 v235, v44, v124
    v_fmac_f32 v234, v5, v117
    v_fmac_f32 v235, v45, v125
    v_fmac_f32 v234, v6, v118
    v_fmac_f32 v235, v46, v126
    v_fmac_f32 v234, v7, v119
    v_fmac_f32 v235, v47, v127
    v_mul_f32 v241, v64, v152
    v_fmac_f32 v237, v72, v168
    v_fmac_f32 v241, v65, v153
    v_fmac_f32 v237, v73, v169
    v_fmac_f32 v241, v66, v154
    s_setprio 1
    s_waitcnt vmcnt(4) lgkmcnt(1)
    v_mfma_f32_32x32x16_bf16 v[24:39], v[80:83], v[184:187], 0
    ds_read_b64_tr_b16 v[176:177], v246 offset:4096
    ds_read_b64_tr_b16 v[178:179], v246 offset:5120
    ds_read_b64_tr_b16 v[180:181], v247 offset:4096
    ds_read_b64_tr_b16 v[182:183], v247 offset:5120
    v_fmac_f32 v237, v74, v170
    v_fmac_f32 v241, v67, v155
    s_mov_b32 m0, s69
    v_mfma_f32_32x32x16_bf16 v[8:23], v[84:87], v[184:187], v[8:23]
    buffer_load_dwordx4 v224, s[4:7], s45 offen sc1 lds
    buffer_load_dwordx4 v225, s[72:75], s45 offen offset:1024 sc1 lds
    s_waitcnt lgkmcnt(4)
    v_mad_u32_u16 v226, v226, s39, v248 op_sel:[1,0,0,0]
    v_mad_u32_u16 v227, v227, s39, v248 op_sel:[1,0,0,0]
    v_fmac_f32 v237, v75, v171
    v_fmac_f32 v241, v68, v156
    v_mfma_f32_32x32x16_bf16 v[48:63], v[84:87], v[188:191], v[48:63]
    v_fmac_f32 v237, v76, v172
    v_fmac_f32 v241, v69, v157
    v_fmac_f32 v237, v77, v173
    v_fmac_f32 v241, v70, v158
    v_fmac_f32 v237, v78, v174
    v_fmac_f32 v241, v71, v159
    v_fmac_f32 v237, v79, v175
    v_mfma_f32_32x32x16_bf16 v[64:79], v[80:83], v[188:191], 0
    v_permlane32_swap_b32 v236, v240
    v_permlane32_swap_b32 v237, v241
    v_add_f32 v236, v236, v240
    v_add_f32 v237, v237, v241
    s_waitcnt vmcnt(4) lgkmcnt(0)
    v_mfma_f32_32x32x16_bf16 v[24:39], v[88:91], v[176:179], v[24:39]
    ds_read_b64_tr_b16 v[184:185], v246 offset:6144
    ds_read_b64_tr_b16 v[186:187], v246 offset:7168
    ds_read_b64_tr_b16 v[188:189], v247 offset:6144
    ds_read_b64_tr_b16 v[190:191], v247 offset:7168
    s_mov_b32 m0, s70
    v_mfma_f32_32x32x16_bf16 v[8:23], v[92:95], v[176:179], v[8:23]
    buffer_load_dwordx4 v226, s[4:7], s46 offen sc1 lds
    buffer_load_dwordx4 v227, s[72:75], s46 offen offset:1024 sc1 lds
    s_set_gpr_idx_on s31, gpr_idx(DST)
    s_nop 0
    v_cvt_pk_bf16_f32 v196, v236, v237
    s_set_gpr_idx_off
    s_sub_u32 s26, s48, s29
    s_mov_b32 s29, s48
    v_mfma_f32_32x32x16_bf16 v[48:63], v[92:95], v[180:183], v[48:63]
    s_mov_b32 s30, s3
    s_bfe_u32 s56, s3, 0x40012
    s_cmp_eq_u32 s34, 0
    s_cselect_b32 s56, s56, 0
    s_mov_b32 s32, s31
    s_mov_b32 s31, s35
    v_mfma_f32_32x32x16_bf16 v[64:79], v[88:91], v[180:183], v[64:79]
    s_waitcnt vmcnt(4) lgkmcnt(0)
    v_mfma_f32_32x32x16_bf16 v[24:39], v[228:231], v[184:187], v[24:39]
    ds_read_b64_tr_b16 v[176:177], v246 offset:0
    ds_read_b64_tr_b16 v[178:179], v246 offset:1024
    ds_read_b64_tr_b16 v[180:181], v247 offset:0
    ds_read_b64_tr_b16 v[182:183], v247 offset:1024
    s_mov_b32 m0, s71
    v_mfma_f32_32x32x16_bf16 v[8:23], v[242:245], v[184:187], v[8:23]
    s_cmp_eq_u32 s33, 4
    s_cbranch_scc1 K2_g4_49
    buffer_load_dwordx4 v224, s[4:7], s47 offen sc1 lds
    buffer_load_dwordx4 v225, s[72:75], s47 offen offset:1024 sc1 lds
K2_back_50:
    v_mfma_f32_32x32x16_bf16 v[48:63], v[242:245], v[188:191], v[48:63]
    s_nop 0
    v_mul_f32 v236, v24, v144
    v_fma_f32 v238, v32, v160, -v238
    v_fmac_f32 v236, v25, v145
    v_fmac_f32 v238, v33, v161
    v_fmac_f32 v236, v26, v146
    v_fmac_f32 v238, v34, v162
    v_fmac_f32 v236, v27, v147
    v_mfma_f32_32x32x16_bf16 v[64:79], v[228:231], v[188:191], v[64:79]
    s_setprio 0
    v_fmac_f32 v238, v35, v163
    v_fmac_f32 v236, v28, v148
    v_fmac_f32 v238, v36, v164
    v_fmac_f32 v236, v29, v149
    v_fmac_f32 v238, v37, v165
    v_fmac_f32 v236, v30, v150
    v_fmac_f32 v238, v38, v166
    v_fmac_f32 v236, v31, v151
    v_fmac_f32 v238, v39, v167
    v_add_u32 v249, s26, v249
    v_add_u32 v250, s26, v250
    v_mul_f32 v240, v8, v160
    v_fma_f32 v234, v16, v112, -v234
    v_fmac_f32 v240, v9, v161
    v_fmac_f32 v234, v17, v113
    v_fmac_f32 v240, v10, v162
    v_fmac_f32 v234, v18, v114
    v_fmac_f32 v240, v11, v163
    v_fmac_f32 v234, v19, v115
    v_fmac_f32 v240, v12, v164
    v_fmac_f32 v234, v20, v116
    v_fmac_f32 v240, v13, v165
    v_fmac_f32 v234, v21, v117
    v_fmac_f32 v240, v14, v166
    v_fmac_f32 v234, v22, v118
    v_fmac_f32 v240, v15, v167
    v_fmac_f32 v234, v23, v119
    ds_read_b64_tr_b16 v[0:1], v249 offset:0
    ds_read_b64_tr_b16 v[2:3], v249 offset:32
    ds_read_u16_d16_hi v40, v250 offset:0
    v_mul_f32 v241, v48, v168
    v_fma_f32 v235, v56, v120, -v235
    v_fmac_f32 v241, v49, v169
    v_fmac_f32 v235, v57, v121
    v_fmac_f32 v241, v50, v170
    v_fmac_f32 v235, v58, v122
    v_fmac_f32 v241, v51, v171
    v_fmac_f32 v235, v59, v123
    v_fmac_f32 v241, v52, v172
    v_fmac_f32 v235, v60, v124
    v_fmac_f32 v241, v53, v173
    v_fmac_f32 v235, v61, v125
    v_fmac_f32 v241, v54, v174
    v_fmac_f32 v235, v62, v126
    v_fmac_f32 v241, v55, v175
    v_fmac_f32 v235, v63, v127
    ds_read_b64_tr_b16 v[4:5], v249 offset:512
    ds_read_b64_tr_b16 v[6:7], v249 offset:544
    ds_read_u16_d16_hi v41, v250 offset:128
    v_mul_f32 v237, v64, v152
    v_fma_f32 v239, v72, v168, -v239
    v_fmac_f32 v237, v65, v153
    v_fmac_f32 v239, v73, v169
    v_fmac_f32 v237, v66, v154
    v_fmac_f32 v239, v74, v170
    v_fmac_f32 v237, v67, v155
    v_fmac_f32 v239, v75, v171
    v_fmac_f32 v237, v68, v156
    v_fmac_f32 v239, v76, v172
    v_fmac_f32 v237, v69, v157
    v_fmac_f32 v239, v77, v173
    v_fmac_f32 v237, v70, v158
    v_fmac_f32 v239, v78, v174
    v_fmac_f32 v237, v71, v159
    v_fmac_f32 v239, v79, v175
    s_cmp_eq_u32 s56, 5
    s_cbranch_scc1 K2_U20
    s_cmp_eq_u32 s56, 6
    s_cbranch_scc1 K2_U3h0
    s_branch K2_DSP0
K2_PAD_U21:
    s_branch K2_HOP
K2_U21:
    s_setprio 1
    s_waitcnt lgkmcnt(0)
    v_lshlrev_b32 v16, 16, v0
    v_and_b32 v17, 0xffff0000, v0
    v_lshlrev_b32 v18, 16, v1
    v_and_b32 v19, 0xffff0000, v1
    v_lshlrev_b32 v20, 16, v2
    v_and_b32 v21, 0xffff0000, v2
    v_lshlrev_b32 v22, 16, v3
    v_and_b32 v23, 0xffff0000, v3
    v_mul_f32_dpp v32, v40, v16 row_newbcast:8 row_mask:0xf bank_mask:0xf
    v_mul_f32_dpp v33, v40, v17 row_newbcast:9 row_mask:0xf bank_mask:0xf
    v_mul_f32_dpp v34, v40, v18 row_newbcast:10 row_mask:0xf bank_mask:0xf
    v_mul_f32_dpp v35, v40, v19 row_newbcast:11 row_mask:0xf bank_mask:0xf
    v_mul_f32_dpp v36, v40, v20 row_newbcast:12 row_mask:0xf bank_mask:0xf
    v_mul_f32_dpp v37, v40, v21 row_newbcast:13 row_mask:0xf bank_mask:0xf
    v_mul_f32_dpp v38, v40, v22 row_newbcast:14 row_mask:0xf bank_mask:0xf
    v_mul_f32_dpp v39, v40, v23 row_newbcast:15 row_mask:0xf bank_mask:0xf
    v_cvt_pk_bf16_f32 v84, v32, v33
    v_cvt_pk_bf16_f32 v85, v34, v35
    v_cvt_pk_bf16_f32 v86, v36, v37
    v_cvt_pk_bf16_f32 v87, v38, v39
    v_mul_f32_dpp v16, v40, v16 row_newbcast:0 row_mask:0xa bank_mask:0xf
    v_mul_f32_dpp v17, v40, v17 row_newbcast:1 row_mask:0xa bank_mask:0xf
    v_mul_f32_dpp v18, v40, v18 row_newbcast:2 row_mask:0xa bank_mask:0xf
    v_mul_f32_dpp v19, v40, v19 row_newbcast:3 row_mask:0xa bank_mask:0xf
    v_mul_f32_dpp v20, v40, v20 row_newbcast:4 row_mask:0xa bank_mask:0xf
    v_mul_f32_dpp v21, v40, v21 row_newbcast:5 row_mask:0xa bank_mask:0xf
    v_mul_f32_dpp v22, v40, v22 row_newbcast:6 row_mask:0xa bank_mask:0xf
    v_mul_f32_dpp v23, v40, v23 row_newbcast:7 row_mask:0xa bank_mask:0xf
    v_cvt_pk_bf16_f32 v80, v16, v17
    v_cvt_pk_bf16_f32 v81, v18, v19
    v_cvt_pk_bf16_f32 v82, v20, v21
    v_cvt_pk_bf16_f32 v83, v22, v23
    v_lshlrev_b32 v24, 16, v4
    v_and_b32 v25, 0xffff0000, v4
    v_lshlrev_b32 v26, 16, v5
    v_and_b32 v27, 0xffff0000, v5
    v_lshlrev_b32 v28, 16, v6
    v_and_b32 v29, 0xffff0000, v6
    v_lshlrev_b32 v30, 16, v7
    v_and_b32 v31, 0xffff0000, v7
    v_mul_f32_dpp v32, v41, v24 row_newbcast:8 row_mask:0xf bank_mask:0xf
    v_mul_f32_dpp v33, v41, v25 row_newbcast:9 row_mask:0xf bank_mask:0xf
    v_mul_f32_dpp v34, v41, v26 row_newbcast:10 row_mask:0xf bank_mask:0xf
    v_mul_f32_dpp v35, v41, v27 row_newbcast:11 row_mask:0xf bank_mask:0xf
    v_mul_f32_dpp v36, v41, v28 row_newbcast:12 row_mask:0xf bank_mask:0xf
    v_mul_f32_dpp v37, v41, v29 row_newbcast:13 row_mask:0xf bank_mask:0xf
    v_mul_f32_dpp v38, v41, v30 row_newbcast:14 row_mask:0xf bank_mask:0xf
    v_mul_f32_dpp v39, v41, v31 row_newbcast:15 row_mask:0xf bank_mask:0xf
    v_cvt_pk_bf16_f32 v92, v32, v33
    v_cvt_pk_bf16_f32 v93, v34, v35
    v_cvt_pk_bf16_f32 v94, v36, v37
    v_cvt_pk_bf16_f32 v95, v38, v39
    v_mul_f32_dpp v24, v41, v24 row_newbcast:0 row_mask:0xa bank_mask:0xf
    v_mul_f32_dpp v25, v41, v25 row_newbcast:1 row_mask:0xa bank_mask:0xf
    v_mul_f32_dpp v26, v41, v26 row_newbcast:2 row_mask:0xa bank_mask:0xf
    v_mul_f32_dpp v27, v41, v27 row_newbcast:3 row_mask:0xa bank_mask:0xf
    v_mul_f32_dpp v28, v41, v28 row_newbcast:4 row_mask:0xa bank_mask:0xf
    v_mul_f32_dpp v29, v41, v29 row_newbcast:5 row_mask:0xa bank_mask:0xf
    v_mul_f32_dpp v30, v41, v30 row_newbcast:6 row_mask:0xa bank_mask:0xf
    v_mul_f32_dpp v31, v41, v31 row_newbcast:7 row_mask:0xa bank_mask:0xf
    v_cvt_pk_bf16_f32 v88, v24, v25
    v_cvt_pk_bf16_f32 v89, v26, v27
    v_cvt_pk_bf16_f32 v90, v28, v29
    v_cvt_pk_bf16_f32 v91, v30, v31
    s_waitcnt vmcnt(4)
    v_mfma_f32_32x32x16_bf16 v[8:23], v[80:83], v[176:179], 0
    ds_read_b64_tr_b16 v[184:185], v246 offset:2048
    ds_read_b64_tr_b16 v[186:187], v246 offset:3072
    ds_read_b64_tr_b16 v[188:189], v247 offset:2048
    ds_read_b64_tr_b16 v[190:191], v247 offset:3072
    s_mov_b32 m0, s68
    v_mfma_f32_32x32x16_bf16 v[24:39], v[84:87], v[176:179], 0
    buffer_load_dwordx4 v222, s[4:7], s42 offen sc1 lds
    buffer_load_dwordx4 v223, s[72:75], s42 offen offset:1024 sc1 lds
    v_permlane32_swap_b32 v236, v234
    v_permlane32_swap_b32 v237, v235
    v_mfma_f32_32x32x16_bf16 v[48:63], v[80:83], v[180:183], 0
    v_permlane32_swap_b32 v240, v238
    v_permlane32_swap_b32 v241, v239
    v_add_f32 v236, v236, v234
    v_add_f32 v237, v237, v235
    v_add_f32 v240, -v240, -v238
    v_mfma_f32_32x32x16_bf16 v[64:79], v[84:87], v[180:183], 0
    v_add_f32 v241, -v241, -v239
    v_cvt_pk_bf16_f32 v236, v236, v237
    v_cvt_pk_bf16_f32 v240, v240, v241
    ds_write2st64_b32 v232, v236, v240 offset0:2 offset1:3
    s_mov_b64 exec, 0x1ff
    ds_add_rtn_u32 v42, v254, v251
    s_mov_b64 exec, -1
    s_waitcnt vmcnt(4) lgkmcnt(2)
    v_mfma_f32_32x32x16_bf16 v[8:23], v[88:91], v[184:187], v[8:23]
    ds_read_b64_tr_b16 v[176:177], v246 offset:4096
    ds_read_b64_tr_b16 v[178:179], v246 offset:5120
    ds_read_b64_tr_b16 v[180:181], v247 offset:4096
    ds_read_b64_tr_b16 v[182:183], v247 offset:5120
    s_mov_b32 m0, s69
    v_mfma_f32_32x32x16_bf16 v[24:39], v[92:95], v[184:187], v[24:39]
    buffer_load_dwordx4 v224, s[4:7], s42 offen sc1 lds
    buffer_load_dwordx4 v225, s[72:75], s42 offen offset:1024 sc1 lds
    s_waitcnt lgkmcnt(4)
    v_readlane_b32 s58, v42, 8
    v_mfma_f32_32x32x16_bf16 v[48:63], v[88:91], v[188:191], v[48:63]
    s_lshr_b32 s58, s58, 4
    s_cmp_lt_u32 s58, s22
    s_cbranch_scc0 K2_nul_55
    v_readlane_b32 s3, v253, s58
    s_nop 0
    s_bfe_u32 s58, s3, 0x60016
    s_and_b32 s59, s58, 7
    s_lshr_b32 s60, s58, 3
K2_chk_57:
    v_readlane_b32 s61, v42, s59
    s_nop 0
    s_cmp_gt_u32 s61, s60
    s_cbranch_scc0 K2_spin_56
K2_back_58:
    v_mfma_f32_32x32x16_bf16 v[64:79], v[92:95], v[188:191], v[64:79]
    s_setprio 0
    s_lshl_b32 s44, s34, 7
    s_and_b32 s48, s3, 0x3ffff
    s_bfe_u32 s33, s3, 0x30013
    s_mov_b32 s35, s48
    s_mov_b32 s45, s44
    s_xor_b32 s47, s44, 256
    v_mul_f32 v234, v8, v96
    v_mul_f32 v236, v16, v128
    v_fmac_f32 v234, v9, v97
    v_fmac_f32 v236, v17, v129
    v_fmac_f32 v234, v10, v98
    v_fmac_f32 v236, v18, v130
    v_fmac_f32 v234, v11, v99
    v_fmac_f32 v236, v19, v131
    v_fmac_f32 v234, v12, v100
    v_fmac_f32 v236, v20, v132
    v_fmac_f32 v234, v13, v101
    v_fmac_f32 v236, v21, v133
    v_fmac_f32 v234, v14, v102
    v_fmac_f32 v236, v22, v134
    v_fmac_f32 v234, v15, v103
    v_fmac_f32 v236, v23, v135
    v_mul_f32 v238, v24, v128
    v_mul_f32 v240, v32, v128
    v_fmac_f32 v238, v25, v129
    v_fmac_f32 v240, v33, v129
    v_fmac_f32 v238, v26, v130
    v_fmac_f32 v240, v34, v130
    v_fmac_f32 v238, v27, v131
    v_fmac_f32 v240, v35, v131
    v_fmac_f32 v238, v28, v132
    v_fmac_f32 v240, v36, v132
    v_fmac_f32 v238, v29, v133
    v_fmac_f32 v240, v37, v133
    v_fmac_f32 v238, v30, v134
    v_fmac_f32 v240, v38, v134
    v_fmac_f32 v238, v31, v135
    v_fmac_f32 v240, v39, v135
    v_mul_f32 v235, v48, v104
    v_mul_f32 v237, v56, v136
    v_fmac_f32 v235, v49, v105
    v_fmac_f32 v237, v57, v137
    v_fmac_f32 v235, v50, v106
    v_fmac_f32 v237, v58, v138
    v_fmac_f32 v235, v51, v107
    v_fmac_f32 v237, v59, v139
    v_fmac_f32 v235, v52, v108
    v_fmac_f32 v237, v60, v140
    v_fmac_f32 v235, v53, v109
    v_fmac_f32 v237, v61, v141
    v_fmac_f32 v235, v54, v110
    v_fmac_f32 v237, v62, v142
    v_fmac_f32 v235, v55, v111
    v_fmac_f32 v237, v63, v143
    v_mul_f32 v239, v64, v136
    v_mul_f32 v241, v72, v136
    v_fmac_f32 v239, v65, v137
    v_fmac_f32 v241, v73, v137
    s_setprio 1
    s_waitcnt vmcnt(4) lgkmcnt(0)
    v_mfma_f32_32x32x16_bf16 v[24:39], v[84:87], v[176:179], 0
    ds_read_b64_tr_b16 v[184:185], v246 offset:6144
    ds_read_b64_tr_b16 v[186:187], v246 offset:7168
    ds_read_b64_tr_b16 v[188:189], v247 offset:6144
    ds_read_b64_tr_b16 v[190:191], v247 offset:7168
    v_fmac_f32 v239, v66, v138
    v_fmac_f32 v241, v74, v138
    s_mov_b32 m0, s70
    v_mfma_f32_32x32x16_bf16 v[8:23], v[80:83], v[176:179], 0
    buffer_load_dwordx4 v222, s[4:7], s43 offen sc1 lds
    buffer_load_dwordx4 v223, s[72:75], s43 offen offset:1024 sc1 lds
    v_fmac_f32 v239, v67, v139
    v_fmac_f32 v241, v75, v139
    v_fmac_f32 v239, v68, v140
    v_fmac_f32 v241, v76, v140
    v_fmac_f32 v239, v69, v141
    v_mfma_f32_32x32x16_bf16 v[48:63], v[80:83], v[180:183], 0
    s_add_u32 s49, s48, 128
    s_add_u32 s60, s48, 256
    s_cmp_eq_u32 s33, 3
    s_cselect_b32 s46, s44, s47
    s_cselect_b32 s50, s60, s48
    s_sub_u32 s60, s33, 2
    s_cmp_lt_u32 s60, 2
    s_cbranch_scc0 K2_rare_59
K2_back_60:
    v_add_u32 v222, s48, v251
    ds_read2_b32 v[222:223], v222 offset0:1 offset1:3
    v_fmac_f32 v241, v77, v141
    v_fmac_f32 v239, v70, v142
    v_fmac_f32 v241, v78, v142
    v_fmac_f32 v239, v71, v143
    v_fmac_f32 v241, v79, v143
    v_mfma_f32_32x32x16_bf16 v[64:79], v[84:87], v[180:183], 0
    v_permlane32_swap_b32 v234, v236
    v_permlane32_swap_b32 v235, v237
    v_permlane32_swap_b32 v238, v239
    s_waitcnt vmcnt(4) lgkmcnt(1)
    v_mfma_f32_32x32x16_bf16 v[24:39], v[92:95], v[184:187], v[24:39]
    ds_read_b64_tr_b16 v[176:177], v246 offset:0
    ds_read_b64_tr_b16 v[178:179], v246 offset:1024
    ds_read_b64_tr_b16 v[180:181], v247 offset:0
    ds_read_b64_tr_b16 v[182:183], v247 offset:1024
    v_lshl_add_u32 v232, v252, 1, s31
    v_add_f32 v234, v234, v236
    s_mov_b32 m0, s71
    v_mfma_f32_32x32x16_bf16 v[8:23], v[88:91], v[184:187], v[8:23]
    buffer_load_dwordx4 v224, s[4:7], s43 offen sc1 lds
    buffer_load_dwordx4 v225, s[72:75], s43 offen offset:1024 sc1 lds
    s_waitcnt lgkmcnt(4)
    v_mad_u32_u16 v222, v222, s39, v248 op_sel:[1,0,0,0]
    v_mad_u32_u16 v223, v223, s39, v248 op_sel:[1,0,0,0]
    v_add_f32 v235, v235, v237
    v_add_f32 v238, -v238, -v239
    v_sub_u32 v239, v232, v233
    v_cvt_pk_bf16_f32 v234, v234, v235
    v_cvt_pk_bf16_f32 v238, v238, v238
    ds_write_b32 v232, v234 offset:0
    ds_write_b16 v239, v238 offset:1280
    v_mfma_f32_32x32x16_bf16 v[48:63], v[88:91], v[188:191], v[48:63]
    v_add_u32 v224, s49, v251
    ds_read2_b32 v[224:225], v224 offset0:1 offset1:3
    v_mul_f32 v236, v24, v160
    v_mul_f32 v238, v32, v160
    v_fmac_f32 v236, v25, v161
    v_fmac_f32 v238, v33, v161
    v_fmac_f32 v236, v26, v162
    v_mfma_f32_32x32x16_bf16 v[64:79], v[92:95], v[188:191], v[64:79]
    s_setprio 0
    v_fmac_f32 v238, v34, v162
    v_fmac_f32 v236, v27, v163
    v_fmac_f32 v238, v35, v163
    v_fmac_f32 v236, v28, v164
    v_fmac_f32 v238, v36, v164
    v_fmac_f32 v236, v29, v165
    v_fmac_f32 v238, v37, v165
    v_fmac_f32 v236, v30, v166
    v_fmac_f32 v238, v38, v166
    v_fmac_f32 v236, v31, v167
    v_fmac_f32 v238, v39, v167
    v_mul_f32 v234, v8, v144
    v_mul_f32 v235, v48, v152
    v_fmac_f32 v234, v9, v145
    v_fmac_f32 v235, v49, v153
    v_fmac_f32 v234, v10, v146
    v_fmac_f32 v235, v50, v154
    v_fmac_f32 v234, v11, v147
    v_fmac_f32 v235, v51, v155
    v_fmac_f32 v234, v12, v148
    v_fmac_f32 v235, v52, v156
    v_fmac_f32 v234, v13, v149
    v_fmac_f32 v235, v53, v157
    v_fmac_f32 v234, v14, v150
    v_fmac_f32 v235, v54, v158
    v_fmac_f32 v234, v15, v151
    v_fmac_f32 v235, v55, v159
    v_mul_f32 v237, v64, v168
    v_mul_f32 v239, v72, v168
    v_fmac_f32 v237, v65, v169
    v_fmac_f32 v239, v73, v169
    v_fmac_f32 v237, v66, v170
    v_fmac_f32 v239, v74, v170
    v_fmac_f32 v237, v67, v171
    s_setprio 1
    s_waitcnt vmcnt(4) lgkmcnt(3)
    v_mfma_f32_32x32x16_bf16 v[24:39], v[80:83], v[176:179], 0
    ds_read_b64_tr_b16 v[184:185], v246 offset:2048
    ds_read_b64_tr_b16 v[186:187], v246 offset:3072
    ds_read_b64_tr_b16 v[188:189], v247 offset:2048
    ds_read_b64_tr_b16 v[190:191], v247 offset:3072
    v_fmac_f32 v239, v75, v171
    v_fmac_f32 v237, v68, v172
    s_mov_b32 m0, s68
    v_mfma_f32_32x32x16_bf16 v[0:15], v[84:87], v[176:179], 0
    buffer_load_dwordx4 v222, s[4:7], s44 offen sc1 lds
    buffer_load_dwordx4 v223, s[72:75], s44 offen offset:1024 sc1 lds
    s_waitcnt lgkmcnt(4)
    v_mad_u32_u16 v224, v224, s39, v248 op_sel:[1,0,0,0]
    v_mad_u32_u16 v225, v225, s39, v248 op_sel:[1,0,0,0]
    v_fmac_f32 v239, v76, v172
    v_fmac_f32 v237, v69, v173
    v_mfma_f32_32x32x16_bf16 v[40:55], v[84:87], v[180:183], 0
    v_add_u32 v226, s50, v251
    ds_read2_b32 v[226:227], v226 offset0:1 offset1:3
    v_fmac_f32 v239, v77, v173
    v_fmac_f32 v237, v70, v174
    v_fmac_f32 v239, v78, v174
    v_fmac_f32 v237, v71, v175
    v_fmac_f32 v239, v79, v175
    v_mfma_f32_32x32x16_bf16 v[64:79], v[80:83], v[180:183], 0
    v_permlane32_swap_b32 v234, v240
    v_permlane32_swap_b32 v235, v241
    v_add_f32 v234, v234, v240
    v_add_f32 v235, v235, v241
    s_waitcnt vmcnt(4) lgkmcnt(1)
    v_mfma_f32_32x32x16_bf16 v[24:39], v[88:91], v[184:187], v[24:39]
    ds_read_b64_tr_b16 v[176:177], v246 offset:4096
    ds_read_b64_tr_b16 v[178:179], v246 offset:5120
    ds_read_b64_tr_b16 v[180:181], v247 offset:4096
    ds_read_b64_tr_b16 v[182:183], v247 offset:5120
    v_cvt_pk_bf16_f32 v234, v234, v235
    ds_write_b32 v232, v234 offset:256
    s_mov_b32 m0, s69
    v_mfma_f32_32x32x16_bf16 v[0:15], v[92:95], v[184:187], v[0:15]
    buffer_load_dwordx4 v224, s[4:7], s45 offen sc1 lds
    buffer_load_dwordx4 v225, s[72:75], s45 offen offset:1024 sc1 lds
    s_waitcnt lgkmcnt(5)
    v_mad_u32_u16 v226, v226, s39, v248 op_sel:[1,0,0,0]
    v_mad_u32_u16 v227, v227, s39, v248 op_sel:[1,0,0,0]
    v_mfma_f32_32x32x16_bf16 v[40:55], v[92:95], v[188:191], v[40:55]
    v_mul_f32 v240, v24, v144
    v_fmac_f32 v236, v32, v160
    v_fmac_f32 v240, v25, v145
    v_fmac_f32 v236, v33, v161
    v_fmac_f32 v240, v26, v146
    v_fmac_f32 v236, v34, v162
    v_fmac_f32 v240, v27, v147
    v_mfma_f32_32x32x16_bf16 v[64:79], v[88:91], v[188:191], v[64:79]
    s_setprio 0
    v_fmac_f32 v236, v35, v163
    v_fmac_f32 v240, v28, v148
    v_fmac_f32 v236, v36, v164
    v_fmac_f32 v240, v29, v149
    v_fmac_f32 v236, v37, v165
    v_fmac_f32 v240, v30, v150
    v_fmac_f32 v236, v38, v166
    v_fmac_f32 v240, v31, v151
    v_fmac_f32 v236, v39, v167
    v_mul_f32 v234, v0, v112
    v_mul_f32 v235, v40, v120
    v_fmac_f32 v234, v1, v113
    v_fmac_f32 v235, v41, v121
    v_fmac_f32 v234, v2, v114
    v_fmac_f32 v235, v42, v122
    v_fmac_f32 v234, v3, v115
    v_fmac_f32 v235, v43, v123
    v_fmac_f32 v234, v4, v116
    v_fmac_f32 v235, v44, v124
    v_fmac_f32 v234, v5, v117
    v_fmac_f32 v235, v45, v125
    v_fmac_f32 v234, v6, v118
    v_fmac_f32 v235, v46, v126
    v_fmac_f32 v234, v7, v119
    v_fmac_f32 v235, v47, v127
    v_mul_f32 v241, v64, v152
    v_fmac_f32 v237, v72, v168
    s_setprio 1
    s_waitcnt vmcnt(4) lgkmcnt(1)
    v_mfma_f32_32x32x16_bf16 v[24:39], v[80:83], v[176:179], 0
    ds_read_b64_tr_b16 v[184:185], v246 offset:6144
    ds_read_b64_tr_b16 v[186:187], v246 offset:7168
    ds_read_b64_tr_b16 v[188:189], v247 offset:6144
    ds_read_b64_tr_b16 v[190:191], v247 offset:7168
    v_fmac_f32 v241, v65, v153
    v_fmac_f32 v237, v73, v169
    s_mov_b32 m0, s70
    v_mfma_f32_32x32x16_bf16 v[8:23], v[84:87], v[176:179], v[8:23]
    buffer_load_dwordx4 v226, s[4:7], s46 offen sc1 lds
    buffer_load_dwordx4 v227, s[72:75], s46 offen offset:1024 sc1 lds
    v_fmac_f32 v241, v66, v154
    v_fmac_f32 v237, v74, v170
    v_fmac_f32 v241, v67, v155
    v_fmac_f32 v237, v75, v171
    v_fmac_f32 v241, v68, v156
    v_mfma_f32_32x32x16_bf16 v[48:63], v[84:87], v[180:183], v[48:63]
    v_fmac_f32 v237, v76, v172
    v_fmac_f32 v241, v69, v157
    v_fmac_f32 v237, v77, v173
    v_fmac_f32 v241, v70, v158
    v_fmac_f32 v237, v78, v174
    v_fmac_f32 v241, v71, v159
    v_fmac_f32 v237, v79, v175
    v_mfma_f32_32x32x16_bf16 v[64:79], v[80:83], v[180:183], 0
    v_permlane32_swap_b32 v236, v240
    v_permlane32_swap_b32 v237, v241
    v_add_f32 v236, v236, v240
    v_add_f32 v237, v237, v241
    s_waitcnt vmcnt(4) lgkmcnt(0)
    v_mfma_f32_32x32x16_bf16 v[24:39], v[88:91], v[184:187], v[24:39]
    ds_read_b64_tr_b16 v[176:177], v246 offset:0
    ds_read_b64_tr_b16 v[178:179], v246 offset:1024
    ds_read_b64_tr_b16 v[180:181], v247 offset:0
    ds_read_b64_tr_b16 v[182:183], v247 offset:1024
    v_cvt_pk_bf16_f32 v236, v236, v237
    ds_write_b32 v232, v236 offset:1024
    s_mov_b32 m0, s71
    v_mfma_f32_32x32x16_bf16 v[8:23], v[92:95], v[184:187], v[8:23]
    s_cmp_eq_u32 s33, 4
    s_cbranch_scc1 K2_g4_62
    buffer_load_dwordx4 v224, s[4:7], s47 offen sc1 lds
    buffer_load_dwordx4 v225, s[72:75], s47 offen offset:1024 sc1 lds
K2_back_63:
    s_sub_u32 s26, s48, s29
    s_mov_b32 s29, s48
    s_mov_b32 s30, s3
    s_bfe_u32 s56, s3, 0x40012
    s_cmp_lg_u32 s36, 0
    s_cselect_b32 s56, s56, 0
    v_mfma_f32_32x32x16_bf16 v[48:63], v[92:95], v[188:191], v[48:63]
    s_mov_b32 s32, s31
    s_mov_b32 s31, s35
    v_mul_f32 v236, v24, v144
    v_fma_f32 v238, v32, v160, -v238
    v_fmac_f32 v236, v25, v145
    v_fmac_f32 v238, v33, v161
    v_fmac_f32 v236, v26, v146
    v_mfma_f32_32x32x16_bf16 v[64:79], v[88:91], v[188:191], v[64:79]
    s_setprio 0
    v_fmac_f32 v238, v34, v162
    v_fmac_f32 v236, v27, v147
    v_fmac_f32 v238, v35, v163
    v_fmac_f32 v236, v28, v148
    v_fmac_f32 v238, v36, v164
    v_fmac_f32 v236, v29, v149
    v_fmac_f32 v238, v37, v165
    v_fmac_f32 v236, v30, v150
    v_fmac_f32 v238, v38, v166
    v_fmac_f32 v236, v31, v151
    v_fmac_f32 v238, v39, v167
    v_add_u32 v249, s26, v249
    v_add_u32 v250, s26, v250
    v_mul_f32 v240, v8, v160
    v_fma_f32 v234, v16, v112, -v234
    v_fmac_f32 v240, v9, v161
    v_fmac_f32 v234, v17, v113
    v_fmac_f32 v240, v10, v162
    v_fmac_f32 v234, v18, v114
    v_fmac_f32 v240, v11, v163
    v_fmac_f32 v234, v19, v115
    v_fmac_f32 v240, v12, v164
    v_fmac_f32 v234, v20, v116
    v_fmac_f32 v240, v13, v165
    v_fmac_f32 v234, v21, v117
    v_fmac_f32 v240, v14, v166
    v_fmac_f32 v234, v22, v118
    v_fmac_f32 v240, v15, v167
    v_fmac_f32 v234, v23, v119
    ds_read_b64_tr_b16 v[0:1], v249 offset:0
    ds_read_b64_tr_b16 v[2:3], v249 offset:32
    ds_read_u16_d16_hi v40, v250 offset:0
    v_mul_f32 v241, v48, v168
    v_fma_f32 v235, v56, v120, -v235
    v_fmac_f32 v241, v49, v169
    v_fmac_f32 v235, v57, v121
    v_fmac_f32 v241, v50, v170
    v_fmac_f32 v235, v58, v122
    v_fmac_f32 v241, v51, v171
    v_fmac_f32 v235, v59, v123
    v_fmac_f32 v241, v52, v172
    v_fmac_f32 v235, v60, v124
    v_fmac_f32 v241, v53, v173
    v_fmac_f32 v235, v61, v125
    v_fmac_f32 v241, v54, v174
    v_fmac_f32 v235, v62, v126
    v_fmac_f32 v241, v55, v175
    v_fmac_f32 v235, v63, v127
    ds_read_b64_tr_b16 v[4:5], v249 offset:512
    ds_read_b64_tr_b16 v[6:7], v249 offset:544
    ds_read_u16_d16_hi v41, v250 offset:128
    v_mul_f32 v237, v64, v152
    v_fma_f32 v239, v72, v168, -v239
    v_fmac_f32 v237, v65, v153
    v_fmac_f32 v239, v73, v169
    v_fmac_f32 v237, v66, v154
    v_fmac_f32 v239, v74, v170
    v_fmac_f32 v237, v67, v155
    v_fmac_f32 v239, v75, v171
    v_fmac_f32 v237, v68, v156
    v_fmac_f32 v239, v76, v172
    v_fmac_f32 v237, v69, v157
    v_fmac_f32 v239, v77, v173
    v_fmac_f32 v237, v70, v158
    v_fmac_f32 v239, v78, v174
    v_fmac_f32 v237, v71, v159
    v_fmac_f32 v239, v79, v175
    s_cmp_eq_u32 s56, 5
    s_cbranch_scc1 K2_U21
    s_cmp_eq_u32 s56, 6
    s_cbranch_scc1 K2_U3h1
    s_branch K2_DSP1
K2_PAD_U31:
    s_branch K2_HOP
K2_U3h1:
    s_setprio 1
    ds_read_b64_tr_b16 v[8:9], v249 offset:1024
    ds_read_u16_d16_hi v42, v250 offset:256
    s_waitcnt lgkmcnt(2)
    v_lshlrev_b32 v16, 16, v0
    v_and_b32 v17, 0xffff0000, v0
    v_lshlrev_b32 v18, 16, v1
    v_and_b32 v19, 0xffff0000, v1
    v_lshlrev_b32 v20, 16, v2
    v_and_b32 v21, 0xffff0000, v2
    v_lshlrev_b32 v22, 16, v3
    v_and_b32 v23, 0xffff0000, v3
    v_mul_f32_dpp v32, v40, v16 row_newbcast:8 row_mask:0xf bank_mask:0xf
    v_mul_f32_dpp v33, v40, v17 row_newbcast:9 row_mask:0xf bank_mask:0xf
    v_mul_f32_dpp v34, v40, v18 row_newbcast:10 row_mask:0xf bank_mask:0xf
    v_mul_f32_dpp v35, v40, v19 row_newbcast:11 row_mask:0xf bank_mask:0xf
    v_mul_f32_dpp v36, v40, v20 row_newbcast:12 row_mask:0xf bank_mask:0xf
    v_mul_f32_dpp v37, v40, v21 row_newbcast:13 row_mask:0xf bank_mask:0xf
    v_mul_f32_dpp v38, v40, v22 row_newbcast:14 row_mask:0xf bank_mask:0xf
    v_mul_f32_dpp v39, v40, v23 row_newbcast:15 row_mask:0xf bank_mask:0xf
    v_cvt_pk_bf16_f32 v84, v32, v33
    v_cvt_pk_bf16_f32 v85, v34, v35
    v_cvt_pk_bf16_f32 v86, v36, v37
    v_cvt_pk_bf16_f32 v87, v38, v39
    v_mul_f32_dpp v16, v40, v16 row_newbcast:0 row_mask:0xa bank_mask:0xf
    v_mul_f32_dpp v17, v40, v17 row_newbcast:1 row_mask:0xa bank_mask:0xf
    v_mul_f32_dpp v18, v40, v18 row_newbcast:2 row_mask:0xa bank_mask:0xf
    v_mul_f32_dpp v19, v40, v19 row_newbcast:3 row_mask:0xa bank_mask:0xf
    v_mul_f32_dpp v20, v40, v20 row_newbcast:4 row_mask:0xa bank_mask:0xf
    v_mul_f32_dpp v21, v40, v21 row_newbcast:5 row_mask:0xa bank_mask:0xf
    v_mul_f32_dpp v22, v40, v22 row_newbcast:6 row_mask:0xa bank_mask:0xf
    v_mul_f32_dpp v23, v40, v23 row_newbcast:7 row_mask:0xa bank_mask:0xf
    v_cvt_pk_bf16_f32 v80, v16, v17
    v_cvt_pk_bf16_f32 v81, v18, v19
    v_cvt_pk_bf16_f32 v82, v20, v21
    v_cvt_pk_bf16_f32 v83, v22, v23
    v_lshlrev_b32 v24, 16, v4
    v_and_b32 v25, 0xffff0000, v4
    v_lshlrev_b32 v26, 16, v5
    v_and_b32 v27, 0xffff0000, v5
    v_lshlrev_b32 v28, 16, v6
    v_and_b32 v29, 0xffff0000, v6
    v_lshlrev_b32 v30, 16, v7
    v_and_b32 v31, 0xffff0000, v7
    v_mul_f32_dpp v32, v41, v24 row_newbcast:8 row_mask:0xf bank_mask:0xf
    v_mul_f32_dpp v33, v41, v25 row_newbcast:9 row_mask:0xf bank_mask:0xf
    v_mul_f32_dpp v34, v41, v26 row_newbcast:10 row_mask:0xf bank_mask:0xf
    v_mul_f32_dpp v35, v41, v27 row_newbcast:11 row_mask:0xf bank_mask:0xf
    v_mul_f32_dpp v36, v41, v28 row_newbcast:12 row_mask:0xf bank_mask:0xf
    v_mul_f32_dpp v37, v41, v29 row_newbcast:13 row_mask:0xf bank_mask:0xf
    v_mul_f32_dpp v38, v41, v30 row_newbcast:14 row_mask:0xf bank_mask:0xf
    v_mul_f32_dpp v39, v41, v31 row_newbcast:15 row_mask:0xf bank_mask:0xf
    v_cvt_pk_bf16_f32 v92, v32, v33
    v_cvt_pk_bf16_f32 v93, v34, v35
    v_cvt_pk_bf16_f32 v94, v36, v37
    v_cvt_pk_bf16_f32 v95, v38, v39
    v_mul_f32_dpp v24, v41, v24 row_newbcast:0 row_mask:0xa bank_mask:0xf
    v_mul_f32_dpp v25, v41, v25 row_newbcast:1 row_mask:0xa bank_mask:0xf
    v_mul_f32_dpp v26, v41, v26 row_newbcast:2 row_mask:0xa bank_mask:0xf
    v_mul_f32_dpp v27, v41, v27 row_newbcast:3 row_mask:0xa bank_mask:0xf
    v_mul_f32_dpp v28, v41, v28 row_newbcast:4 row_mask:0xa bank_mask:0xf
    v_mul_f32_dpp v29, v41, v29 row_newbcast:5 row_mask:0xa bank_mask:0xf
    v_mul_f32_dpp v30, v41, v30 row_newbcast:6 row_mask:0xa bank_mask:0xf
    v_mul_f32_dpp v31, v41, v31 row_newbcast:7 row_mask:0xa bank_mask:0xf
    v_cvt_pk_bf16_f32 v88, v24, v25
    v_cvt_pk_bf16_f32 v89, v26, v27
    v_cvt_pk_bf16_f32 v90, v28, v29
    v_cvt_pk_bf16_f32 v91, v30, v31
    s_waitcnt lgkmcnt(0)
    v_lshlrev_b32 v16, 16, v8
    v_and_b32 v17, 0xffff0000, v8
    v_lshlrev_b32 v18, 16, v9
    v_and_b32 v19, 0xffff0000, v9
    v_mul_f32_dpp v32, v42, v16 row_newbcast:8 row_mask:0xf bank_mask:0xf
    v_mul_f32_dpp v33, v42, v17 row_newbcast:9 row_mask:0xf bank_mask:0xf
    v_mul_f32_dpp v34, v42, v18 row_newbcast:10 row_mask:0xf bank_mask:0xf
    v_mul_f32_dpp v35, v42, v19 row_newbcast:11 row_mask:0xf bank_mask:0xf
    v_cvt_pk_bf16_f32 v242, v32, v33
    v_cvt_pk_bf16_f32 v243, v34, v35
    v_mul_f32_dpp v16, v42, v16 row_newbcast:0 row_mask:0xa bank_mask:0xf
    v_mul_f32_dpp v17, v42, v17 row_newbcast:1 row_mask:0xa bank_mask:0xf
    v_mul_f32_dpp v18, v42, v18 row_newbcast:2 row_mask:0xa bank_mask:0xf
    v_mul_f32_dpp v19, v42, v19 row_newbcast:3 row_mask:0xa bank_mask:0xf
    v_cvt_pk_bf16_f32 v228, v16, v17
    v_cvt_pk_bf16_f32 v229, v18, v19
    s_waitcnt vmcnt(4)
    v_mfma_f32_32x32x16_bf16 v[8:23], v[80:83], v[176:179], 0
    ds_read_b64_tr_b16 v[184:185], v246 offset:2048
    ds_read_b64_tr_b16 v[186:187], v246 offset:3072
    ds_read_b64_tr_b16 v[188:189], v247 offset:2048
    ds_read_b64_tr_b16 v[190:191], v247 offset:3072
    s_mov_b32 m0, s68
    v_mfma_f32_32x32x16_bf16 v[24:39], v[84:87], v[176:179], 0
    buffer_load_dwordx4 v222, s[4:7], s41 offen sc1 lds
    buffer_load_dwordx4 v223, s[72:75], s41 offen offset:1024 sc1 lds
    v_permlane32_swap_b32 v236, v234
    v_permlane32_swap_b32 v237, v235
    v_mfma_f32_32x32x16_bf16 v[48:63], v[80:83], v[180:183], 0
    v_permlane32_swap_b32 v240, v238
    v_permlane32_swap_b32 v241, v239
    v_add_f32 v236, v236, v234
    v_add_f32 v237, v237, v235
    v_add_f32 v240, -v240, -v238
    v_mfma_f32_32x32x16_bf16 v[64:79], v[84:87], v[180:183], 0
    v_add_f32 v241, -v241, -v239
    v_cvt_pk_bf16_f32 v236, v236, v237
    v_cvt_pk_bf16_f32 v240, v240, v241
    ds_write2st64_b32 v232, v236, v240 offset0:2 offset1:3
    s_mov_b64 exec, 0x1ff
    ds_add_rtn_u32 v42, v254, v251
    s_mov_b64 exec, -1
    s_waitcnt vmcnt(4) lgkmcnt(2)
    v_mfma_f32_32x32x16_bf16 v[8:23], v[88:91], v[184:187], v[8:23]
    ds_read_b64_tr_b16 v[176:177], v246 offset:4096
    ds_read_b64_tr_b16 v[180:181], v247 offset:4096
    s_mov_b32 m0, s69
    v_mfma_f32_32x32x16_bf16 v[24:39], v[92:95], v[184:187], v[24:39]
    buffer_load_dwordx4 v226, s[4:7], s41 offen sc1 lds
    s_waitcnt lgkmcnt(2)
    v_readlane_b32 s58, v42, 8
    v_mfma_f32_32x32x16_bf16 v[48:63], v[88:91], v[188:191], v[48:63]
    s_lshr_b32 s58, s58, 4
    s_cmp_lt_u32 s58, s22
    s_cbranch_scc0 K2_nul_64
    v_readlane_b32 s3, v253, s58
    s_nop 0
    s_bfe_u32 s58, s3, 0x60016
    s_and_b32 s59, s58, 7
    s_lshr_b32 s60, s58, 3
K2_chk_66:
    v_readlane_b32 s61, v42, s59
    s_nop 0
    s_cmp_gt_u32 s61, s60
    s_cbranch_scc0 K2_spin_65
K2_back_67:
    v_mfma_f32_32x32x16_bf16 v[64:79], v[92:95], v[188:191], v[64:79]
    s_lshl_b32 s44, s34, 7
    s_and_b32 s48, s3, 0x3ffff
    s_bfe_u32 s33, s3, 0x30013
    s_mov_b32 s35, s48
    s_mov_b32 s45, s44
    s_xor_b32 s47, s44, 256
    s_waitcnt vmcnt(3) lgkmcnt(0)
    v_mfma_f32_32x32x8_bf16 v[8:23], v[228:229], v[176:177], v[8:23]
    ds_read_b64_tr_b16 v[184:185], v246 offset:6144
    ds_read_b64_tr_b16 v[186:187], v246 offset:7168
    ds_read_b64_tr_b16 v[188:189], v247 offset:6144
    ds_read_b64_tr_b16 v[190:191], v247 offset:7168
    s_add_u32 s49, s48, 128
    s_add_u32 s60, s48, 256
    s_mov_b32 m0, s70
    v_mfma_f32_32x32x8_bf16 v[24:39], v[242:243], v[176:177], v[24:39]
    buffer_load_dwordx4 v222, s[4:7], s42 offen sc1 lds
    buffer_load_dwordx4 v223, s[72:75], s42 offen offset:1024 sc1 lds
    s_cmp_eq_u32 s33, 3
    s_cselect_b32 s46, s44, s47
    s_cselect_b32 s50, s60, s48
    v_mfma_f32_32x32x8_bf16 v[48:63], v[228:229], v[180:181], v[48:63]
    s_sub_u32 s60, s33, 2
    s_cmp_lt_u32 s60, 2
    s_cbranch_scc0 K2_rare_68
K2_back_69:
    v_mul_f32 v234, v8, v96
    v_mul_f32 v236, v16, v128
    v_fmac_f32 v234, v9, v97
    v_fmac_f32 v236, v17, v129
    v_mfma_f32_32x32x8_bf16 v[64:79], v[242:243], v[180:181], v[64:79]
    s_setprio 0
    v_fmac_f32 v234, v10, v98
    v_fmac_f32 v236, v18, v130
    v_fmac_f32 v234, v11, v99
    v_fmac_f32 v236, v19, v131
    v_fmac_f32 v234, v12, v100
    v_fmac_f32 v236, v20, v132
    v_fmac_f32 v234, v13, v101
    v_fmac_f32 v236, v21, v133
    v_fmac_f32 v234, v14, v102
    v_fmac_f32 v236, v22, v134
    v_fmac_f32 v234, v15, v103
    v_fmac_f32 v236, v23, v135
    v_mul_f32 v238, v24, v128
    v_mul_f32 v240, v32, v128
    v_fmac_f32 v238, v25, v129
    v_fmac_f32 v240, v33, v129
    v_fmac_f32 v238, v26, v130
    v_fmac_f32 v240, v34, v130
    v_fmac_f32 v238, v27, v131
    v_fmac_f32 v240, v35, v131
    v_fmac_f32 v238, v28, v132
    v_fmac_f32 v240, v36, v132
    v_fmac_f32 v238, v29, v133
    v_fmac_f32 v240, v37, v133
    v_fmac_f32 v238, v30, v134
    v_fmac_f32 v240, v38, v134
    v_fmac_f32 v238, v31, v135
    v_fmac_f32 v240, v39, v135
    v_mul_f32 v235, v48, v104
    v_mul_f32 v237, v56, v136
    v_fmac_f32 v235, v49, v105
    v_fmac_f32 v237, v57, v137
    v_fmac_f32 v235, v50, v106
    v_fmac_f32 v237, v58, v138
    v_fmac_f32 v235, v51, v107
    v_fmac_f32 v237, v59, v139
    v_fmac_f32 v235, v52, v108
    v_fmac_f32 v237, v60, v140
    v_fmac_f32 v235, v53, v109
    v_fmac_f32 v237, v61, v141
    v_fmac_f32 v235, v54, v110
    v_fmac_f32 v237, v62, v142
    v_fmac_f32 v235, v55, v111
    v_fmac_f32 v237, v63, v143
    v_mul_f32 v239, v64, v136
    v_mul_f32 v241, v72, v136
    s_setprio 1
    s_waitcnt vmcnt(3) lgkmcnt(0)
    v_mfma_f32_32x32x16_bf16 v[24:39], v[92:95], v[184:187], 0
    ds_read_b64_tr_b16 v[176:177], v246 offset:0
    ds_read_b64_tr_b16 v[178:179], v246 offset:1024
    ds_read_b64_tr_b16 v[180:181], v247 offset:0
    ds_read_b64_tr_b16 v[182:183], v247 offset:1024
    v_fmac_f32 v239, v65, v137
    v_fmac_f32 v241, v73, v137
    s_mov_b32 m0, s71
    v_mfma_f32_32x32x16_bf16 v[8:23], v[88:91], v[184:187], 0
    buffer_load_dwordx4 v224, s[4:7], s42 offen sc1 lds
    buffer_load_dwordx4 v225, s[72:75], s42 offen offset:1024 sc1 lds
    v_fmac_f32 v239, v66, v138
    v_fmac_f32 v241, v74, v138
    v_fmac_f32 v239, v67, v139
    v_fmac_f32 v241, v75, v139
    v_fmac_f32 v239, v68, v140
    v_mfma_f32_32x32x16_bf16 v[48:63], v[88:91], v[188:191], 0
    v_fmac_f32 v241, v76, v140
    v_fmac_f32 v239, v69, v141
    v_fmac_f32 v241, v77, v141
    v_fmac_f32 v239, v70, v142
    v_fmac_f32 v241, v78, v142
    v_fmac_f32 v239, v71, v143
    v_fmac_f32 v241, v79, v143
    v_mfma_f32_32x32x16_bf16 v[64:79], v[92:95], v[188:191], 0
    v_permlane32_swap_b32 v234, v236
    v_permlane32_swap_b32 v235, v237
    v_permlane32_swap_b32 v238, v239
    s_waitcnt vmcnt(4) lgkmcnt(0)
    v_mfma_f32_32x32x16_bf16 v[24:39], v[84:87], v[176:179], v[24:39]
    ds_read_b64_tr_b16 v[184:185], v246 offset:2048
    ds_read_b64_tr_b16 v[188:189], v247 offset:2048
    v_lshl_add_u32 v232, v252, 1, s31
    v_add_f32 v234, v234, v236
    v_add_f32 v235, v235, v237
    v_add_f32 v238, -v238, -v239
    s_mov_b32 m0, s68
    v_mfma_f32_32x32x16_bf16 v[8:23], v[80:83], v[176:179], v[8:23]
    buffer_load_dwordx4 v226, s[4:7], s42 offen sc1 lds
    v_sub_u32 v239, v232, v233
    v_cvt_pk_bf16_f32 v234, v234, v235
    v_cvt_pk_bf16_f32 v238, v238, v238
    ds_write_b32 v232, v234 offset:0
    ds_write_b16 v239, v238 offset:1280
    v_mfma_f32_32x32x16_bf16 v[48:63], v[80:83], v[180:183], v[48:63]
    v_mfma_f32_32x32x16_bf16 v[64:79], v[84:87], v[180:183], v[64:79]
    s_waitcnt vmcnt(3) lgkmcnt(2)
    v_mfma_f32_32x32x8_bf16 v[24:39], v[242:243], v[184:185], v[24:39]
    ds_read_b64_tr_b16 v[176:177], v246 offset:4096
    ds_read_b64_tr_b16 v[178:179], v246 offset:5120
    ds_read_b64_tr_b16 v[180:181], v247 offset:4096
    ds_read_b64_tr_b16 v[182:183], v247 offset:5120
    s_mov_b32 m0, s69
    v_mfma_f32_32x32x8_bf16 v[8:23], v[228:229], v[184:185], v[8:23]
    buffer_load_dwordx4 v222, s[4:7], s43 offen sc1 lds
    buffer_load_dwordx4 v223, s[72:75], s43 offen offset:1024 sc1 lds
    v_mfma_f32_32x32x8_bf16 v[48:63], v[228:229], v[188:189], v[48:63]
    s_nop 2
    v_mul_f32 v236, v24, v160
    v_mul_f32 v238, v32, v160
    v_fmac_f32 v236, v25, v161
    v_fmac_f32 v238, v33, v161
    v_fmac_f32 v236, v26, v162
    v_fmac_f32 v238, v34, v162
    v_fmac_f32 v236, v27, v163
    v_mfma_f32_32x32x8_bf16 v[64:79], v[242:243], v[188:189], v[64:79]
    s_setprio 0
    v_fmac_f32 v238, v35, v163
    v_fmac_f32 v236, v28, v164
    v_fmac_f32 v238, v36, v164
    v_fmac_f32 v236, v29, v165
    v_fmac_f32 v238, v37, v165
    v_fmac_f32 v236, v30, v166
    v_fmac_f32 v238, v38, v166
    v_fmac_f32 v236, v31, v167
    v_fmac_f32 v238, v39, v167
    v_mul_f32 v234, v8, v144
    v_mul_f32 v235, v48, v152
    v_fmac_f32 v234, v9, v145
    v_fmac_f32 v235, v49, v153
    v_fmac_f32 v234, v10, v146
    v_fmac_f32 v235, v50, v154
    v_fmac_f32 v234, v11, v147
    v_fmac_f32 v235, v51, v155
    v_fmac_f32 v234, v12, v148
    v_fmac_f32 v235, v52, v156
    v_fmac_f32 v234, v13, v149
    v_fmac_f32 v235, v53, v157
    v_fmac_f32 v234, v14, v150
    v_fmac_f32 v235, v54, v158
    v_fmac_f32 v234, v15, v151
    v_fmac_f32 v235, v55, v159
    v_mul_f32 v237, v64, v168
    v_mul_f32 v239, v72, v168
    v_fmac_f32 v237, v65, v169
    v_fmac_f32 v239, v73, v169
    s_setprio 1
    s_waitcnt vmcnt(3) lgkmcnt(0)
    v_mfma_f32_32x32x16_bf16 v[24:39], v[80:83], v[176:179], 0
    ds_read_b64_tr_b16 v[184:185], v246 offset:6144
    ds_read_b64_tr_b16 v[186:187], v246 offset:7168
    ds_read_b64_tr_b16 v[188:189], v247 offset:6144
    ds_read_b64_tr_b16 v[190:191], v247 offset:7168
    v_fmac_f32 v237, v66, v170
    v_fmac_f32 v239, v74, v170
    s_mov_b32 m0, s70
    v_mfma_f32_32x32x16_bf16 v[0:15], v[84:87], v[176:179], 0
    buffer_load_dwordx4 v224, s[4:7], s43 offen sc1 lds
    buffer_load_dwordx4 v225, s[72:75], s43 offen offset:1024 sc1 lds
    v_fmac_f32 v237, v67, v171
    v_fmac_f32 v239, v75, v171
    v_fmac_f32 v237, v68, v172
    v_fmac_f32 v239, v76, v172
    v_fmac_f32 v237, v69, v173
    v_mfma_f32_32x32x16_bf16 v[40:55], v[84:87], v[180:183], 0
    v_add_u32 v222, s48, v251
    ds_read2_b32 v[222:223], v222 offset0:1 offset1:3
    v_fmac_f32 v239, v77, v173
    v_fmac_f32 v237, v70, v174
    v_fmac_f32 v239, v78, v174
    v_fmac_f32 v237, v71, v175
    v_fmac_f32 v239, v79, v175
    v_mfma_f32_32x32x16_bf16 v[64:79], v[80:83], v[180:183], 0
    v_permlane32_swap_b32 v234, v240
    v_permlane32_swap_b32 v235, v241
    v_add_f32 v234, v234, v240
    v_add_f32 v235, v235, v241
    s_waitcnt vmcnt(4) lgkmcnt(1)
    v_mfma_f32_32x32x16_bf16 v[24:39], v[88:91], v[184:187], v[24:39]
    ds_read_b64_tr_b16 v[176:177], v246 offset:0
    ds_read_b64_tr_b16 v[180:181], v247 offset:0
    v_cvt_pk_bf16_f32 v234, v234, v235
    ds_write_b32 v232, v234 offset:256
    s_mov_b32 m0, s71
    v_mfma_f32_32x32x16_bf16 v[0:15], v[92:95], v[184:187], v[0:15]
    buffer_load_dwordx4 v226, s[4:7], s43 offen sc1 lds
    s_waitcnt lgkmcnt(3)
    v_mad_u32_u16 v222, v222, s39, v248 op_sel:[1,0,0,0]
    v_mad_u32_u16 v223, v223, s39, v248 op_sel:[1,0,0,0]
    v_mfma_f32_32x32x16_bf16 v[40:55], v[92:95], v[188:191], v[40:55]
    v_add_u32 v224, s49, v251
    ds_read2_b32 v[224:225], v224 offset0:1 offset1:3
    v_mfma_f32_32x32x16_bf16 v[64:79], v[88:91], v[188:191], v[64:79]
    s_waitcnt vmcnt(3) lgkmcnt(2)
    v_mfma_f32_32x32x8_bf16 v[24:39], v[228:229], v[176:177], v[24:39]
    ds_read_b64_tr_b16 v[184:185], v246 offset:2048
    ds_read_b64_tr_b16 v[186:187], v246 offset:3072
    ds_read_b64_tr_b16 v[188:189], v247 offset:2048
    ds_read_b64_tr_b16 v[190:191], v247 offset:3072
    s_mov_b32 m0, s68
    v_mfma_f32_32x32x8_bf16 v[0:15], v[242:243], v[176:177], v[0:15]
    buffer_load_dwordx4 v222, s[4:7], s44 offen sc1 lds
    buffer_load_dwordx4 v223, s[72:75], s44 offen offset:1024 sc1 lds
    s_waitcnt lgkmcnt(4)
    v_mad_u32_u16 v224, v224, s39, v248 op_sel:[1,0,0,0]
    v_mad_u32_u16 v225, v225, s39, v248 op_sel:[1,0,0,0]
    v_mfma_f32_32x32x8_bf16 v[40:55], v[242:243], v[180:181], v[40:55]
    v_add_u32 v226, s50, v251
    ds_read2_b32 v[226:227], v226 offset0:1 offset1:3
    v_mul_f32 v240, v24, v144
    v_fmac_f32 v236, v32, v160
    v_fmac_f32 v240, v25, v145
    v_fmac_f32 v236, v33, v161
    v_fmac_f32 v240, v26, v146
    v_mfma_f32_32x32x8_bf16 v[64:79], v[228:229], v[180:181], v[64:79]
    s_setprio 0
    v_fmac_f32 v236, v34, v162
    v_fmac_f32 v240, v27, v147
    v_fmac_f32 v236, v35, v163
    v_fmac_f32 v240, v28, v148
    v_fmac_f32 v236, v36, v164
    v_fmac_f32 v240, v29, v149
    v_fmac_f32 v236, v37, v165
    v_fmac_f32 v240, v30, v150
    v_fmac_f32 v236, v38, v166
    v_fmac_f32 v240, v31, v151
    v_fmac_f32 v236, v39, v167
    v_mul_f32 v234, v0, v112
    v_mul_f32 v235, v40, v120
    v_fmac_f32 v234, v1, v113
    v_fmac_f32 v235, v41, v121
    v_fmac_f32 v234, v2, v114
    v_fmac_f32 v235, v42, v122
    v_fmac_f32 v234, v3, v115
    v_fmac_f32 v235, v43, v123
    v_fmac_f32 v234, v4, v116
    v_fmac_f32 v235, v44, v124
    v_fmac_f32 v234, v5, v117
    v_fmac_f32 v235, v45, v125
    v_fmac_f32 v234, v6, v118
    v_fmac_f32 v235, v46, v126
    v_fmac_f32 v234, v7, v119
    v_fmac_f32 v235, v47, v127
    v_mul_f32 v241, v64, v152
    v_fmac_f32 v237, v72, v168
    v_fmac_f32 v241, v65, v153
    v_fmac_f32 v237, v73, v169
    v_fmac_f32 v241, v66, v154
    s_setprio 1
    s_waitcnt vmcnt(3) lgkmcnt(1)
    v_mfma_f32_32x32x16_bf16 v[24:39], v[80:83], v[184:187], 0
    ds_read_b64_tr_b16 v[176:177], v246 offset:4096
    ds_read_b64_tr_b16 v[178:179], v246 offset:5120
    ds_read_b64_tr_b16 v[180:181], v247 offset:4096
    ds_read_b64_tr_b16 v[182:183], v247 offset:5120
    v_fmac_f32 v237, v74, v170
    v_fmac_f32 v241, v67, v155
    s_mov_b32 m0, s69
    v_mfma_f32_32x32x16_bf16 v[8:23], v[84:87], v[184:187], v[8:23]
    buffer_load_dwordx4 v224, s[4:7], s45 offen sc1 lds
    buffer_load_dwordx4 v225, s[72:75], s45 offen offset:1024 sc1 lds
    s_waitcnt lgkmcnt(4)
    v_mad_u32_u16 v226, v226, s39, v248 op_sel:[1,0,0,0]
    v_mad_u32_u16 v227, v227, s39, v248 op_sel:[1,0,0,0]
    v_fmac_f32 v237, v75, v171
    v_fmac_f32 v241, v68, v156
    v_mfma_f32_32x32x16_bf16 v[48:63], v[84:87], v[188:191], v[48:63]
    v_fmac_f32 v237, v76, v172
    v_fmac_f32 v241, v69, v157
    v_fmac_f32 v237, v77, v173
    v_fmac_f32 v241, v70, v158
    v_fmac_f32 v237, v78, v174
    v_fmac_f32 v241, v71, v159
    v_fmac_f32 v237, v79, v175
    v_mfma_f32_32x32x16_bf16 v[64:79], v[80:83], v[188:191], 0
    v_permlane32_swap_b32 v236, v240
    v_permlane32_swap_b32 v237, v241
    v_add_f32 v236, v236, v240
    v_add_f32 v237, v237, v241
    s_waitcnt vmcnt(4) lgkmcnt(0)
    v_mfma_f32_32x32x16_bf16 v[24:39], v[88:91], v[176:179], v[24:39]
    ds_read_b64_tr_b16 v[184:185], v246 offset:6144
    ds_read_b64_tr_b16 v[188:189], v247 offset:6144
    v_cvt_pk_bf16_f32 v236, v236, v237
    ds_write_b32 v232, v236 offset:1024
    s_mov_b32 s32, s31
    s_mov_b32 s31, s35
    s_mov_b32 m0, s70
    v_mfma_f32_32x32x16_bf16 v[8:23], v[92:95], v[176:179], v[8:23]
    buffer_load_dwordx4 v226, s[4:7], s46 offen sc1 lds
    buffer_load_dwordx4 v227, s[72:75], s46 offen offset:1024 sc1 lds
    s_sub_u32 s26, s48, s29
    s_mov_b32 s29, s48
    s_mov_b32 s30, s3
    s_bfe_u32 s56, s3, 0x40012
    v_mfma_f32_32x32x16_bf16 v[48:63], v[92:95], v[180:183], v[48:63]
    s_cmp_lg_u32 s36, 0
    s_cselect_b32 s56, s56, 0
    v_mfma_f32_32x32x16_bf16 v[64:79], v[88:91], v[180:183], v[64:79]
    s_waitcnt vmcnt(4) lgkmcnt(1)
    v_mfma_f32_32x32x8_bf16 v[24:39], v[228:229], v[184:185], v[24:39]
    ds_read_b64_tr_b16 v[176:177], v246 offset:0
    ds_read_b64_tr_b16 v[178:179], v246 offset:1024
    ds_read_b64_tr_b16 v[180:181], v247 offset:0
    ds_read_b64_tr_b16 v[182:183], v247 offset:1024
    s_mov_b32 m0, s71
    v_mfma_f32_32x32x8_bf16 v[8:23], v[242:243], v[184:185], v[8:23]
    s_cmp_eq_u32 s33, 4
    s_cbranch_scc1 K2_g4_71
    buffer_load_dwordx4 v224, s[4:7], s47 offen sc1 lds
    buffer_load_dwordx4 v225, s[72:75], s47 offen offset:1024 sc1 lds
K2_back_72:
    v_mfma_f32_32x32x8_bf16 v[48:63], v[242:243], v[188:189], v[48:63]
    s_nop 0
    v_mul_f32 v236, v24, v144
    v_fma_f32 v238, v32, v160, -v238
    v_fmac_f32 v236, v25, v145
    v_fmac_f32 v238, v33, v161
    v_fmac_f32 v236, v26, v146
    v_fmac_f32 v238, v34, v162
    v_fmac_f32 v236, v27, v147
    v_mfma_f32_32x32x8_bf16 v[64:79], v[228:229], v[188:189], v[64:79]
    s_setprio 0
    v_fmac_f32 v238, v35, v163
    v_fmac_f32 v236, v28, v148
    v_fmac_f32 v238, v36, v164
    v_fmac_f32 v236, v29, v149
    v_fmac_f32 v238, v37, v165
    v_fmac_f32 v236, v30, v150
    v_fmac_f32 v238, v38, v166
    v_fmac_f32 v236, v31, v151
    v_fmac_f32 v238, v39, v167
    v_add_u32 v249, s26, v249
    v_add_u32 v250, s26, v250
    v_mul_f32 v240, v8, v160
    v_fma_f32 v234, v16, v112, -v234
    v_fmac_f32 v240, v9, v161
    v_fmac_f32 v234, v17, v113
    v_fmac_f32 v240, v10, v162
    v_fmac_f32 v234, v18, v114
    v_fmac_f32 v240, v11, v163
    v_fmac_f32 v234, v19, v115
    v_fmac_f32 v240, v12, v164
    v_fmac_f32 v234, v20, v116
    v_fmac_f32 v240, v13, v165
    v_fmac_f32 v234, v21, v117
    v_fmac_f32 v240, v14, v166
    v_fmac_f32 v234, v22, v118
    v_fmac_f32 v240, v15, v167
    v_fmac_f32 v234, v23, v119
    ds_read_b64_tr_b16 v[0:1], v249 offset:0
    ds_read_b64_tr_b16 v[2:3], v249 offset:32
    ds_read_u16_d16_hi v40, v250 offset:0
    v_mul_f32 v241, v48, v168
    v_fma_f32 v235, v56, v120, -v235
    v_fmac_f32 v241, v49, v169
    v_fmac_f32 v235, v57, v121
    v_fmac_f32 v241, v50, v170
    v_fmac_f32 v235, v58, v122
    v_fmac_f32 v241, v51, v171
    v_fmac_f32 v235, v59, v123
    v_fmac_f32 v241, v52, v172
    v_fmac_f32 v235, v60, v124
    v_fmac_f32 v241, v53, v173
    v_fmac_f32 v235, v61, v125
    v_fmac_f32 v241, v54, v174
    v_fmac_f32 v235, v62, v126
    v_fmac_f32 v241, v55, v175
    v_fmac_f32 v235, v63, v127
    ds_read_b64_tr_b16 v[4:5], v249 offset:512
    ds_read_b64_tr_b16 v[6:7], v249 offset:544
    ds_read_u16_d16_hi v41, v250 offset:128
    v_mul_f32 v237, v64, v152
    v_fma_f32 v239, v72, v168, -v239
    v_fmac_f32 v237, v65, v153
    v_fmac_f32 v239, v73, v169
    v_fmac_f32 v237, v66, v154
    v_fmac_f32 v239, v74, v170
    v_fmac_f32 v237, v67, v155
    v_fmac_f32 v239, v75, v171
    v_fmac_f32 v237, v68, v156
    v_fmac_f32 v239, v76, v172
    v_fmac_f32 v237, v69, v157
    v_fmac_f32 v239, v77, v173
    v_fmac_f32 v237, v70, v158
    v_fmac_f32 v239, v78, v174
    v_fmac_f32 v237, v71, v159
    v_fmac_f32 v239, v79, v175
    s_cmp_eq_u32 s56, 5
    s_cbranch_scc1 K2_U21
    s_cmp_eq_u32 s56, 6
    s_cbranch_scc1 K2_U3h1
    s_branch K2_DSP1
K2_U31:
    s_setprio 1
    ds_read_b64_tr_b16 v[8:9], v249 offset:1024
    ds_read_b64_tr_b16 v[10:11], v249 offset:1056
    ds_read_u16_d16_hi v42, v250 offset:256
    s_waitcnt lgkmcnt(3)
    v_lshlrev_b32 v16, 16, v0
    v_and_b32 v17, 0xffff0000, v0
    v_lshlrev_b32 v18, 16, v1
    v_and_b32 v19, 0xffff0000, v1
    v_lshlrev_b32 v20, 16, v2
    v_and_b32 v21, 0xffff0000, v2
    v_lshlrev_b32 v22, 16, v3
    v_and_b32 v23, 0xffff0000, v3
    v_mul_f32_dpp v32, v40, v16 row_newbcast:8 row_mask:0xf bank_mask:0xf
    v_mul_f32_dpp v33, v40, v17 row_newbcast:9 row_mask:0xf bank_mask:0xf
    v_mul_f32_dpp v34, v40, v18 row_newbcast:10 row_mask:0xf bank_mask:0xf
    v_mul_f32_dpp v35, v40, v19 row_newbcast:11 row_mask:0xf bank_mask:0xf
    v_mul_f32_dpp v36, v40, v20 row_newbcast:12 row_mask:0xf bank_mask:0xf
    v_mul_f32_dpp v37, v40, v21 row_newbcast:13 row_mask:0xf bank_mask:0xf
    v_mul_f32_dpp v38, v40, v22 row_newbcast:14 row_mask:0xf bank_mask:0xf
    v_mul_f32_dpp v39, v40, v23 row_newbcast:15 row_mask:0xf bank_mask:0xf
    v_cvt_pk_bf16_f32 v84, v32, v33
    v_cvt_pk_bf16_f32 v85, v34, v35
    v_cvt_pk_bf16_f32 v86, v36, v37
    v_cvt_pk_bf16_f32 v87, v38, v39
    v_mul_f32_dpp v16, v40, v16 row_newbcast:0 row_mask:0xa bank_mask:0xf
    v_mul_f32_dpp v17, v40, v17 row_newbcast:1 row_mask:0xa bank_mask:0xf
    v_mul_f32_dpp v18, v40, v18 row_newbcast:2 row_mask:0xa bank_mask:0xf
    v_mul_f32_dpp v19, v40, v19 row_newbcast:3 row_mask:0xa bank_mask:0xf
    v_mul_f32_dpp v20, v40, v20 row_newbcast:4 row_mask:0xa bank_mask:0xf
    v_mul_f32_dpp v21, v40, v21 row_newbcast:5 row_mask:0xa bank_mask:0xf
    v_mul_f32_dpp v22, v40, v22 row_newbcast:6 row_mask:0xa bank_mask:0xf
    v_mul_f32_dpp v23, v40, v23 row_newbcast:7 row_mask:0xa bank_mask:0xf
    v_cvt_pk_bf16_f32 v80, v16, v17
    v_cvt_pk_bf16_f32 v81, v18, v19
    v_cvt_pk_bf16_f32 v82, v20, v21
    v_cvt_pk_bf16_f32 v83, v22, v23
    v_lshlrev_b32 v24, 16, v4
    v_and_b32 v25, 0xffff0000, v4
    v_lshlrev_b32 v26, 16, v5
    v_and_b32 v27, 0xffff0000, v5
    v_lshlrev_b32 v28, 16, v6
    v_and_b32 v29, 0xffff0000, v6
    v_lshlrev_b32 v30, 16, v7
    v_and_b32 v31, 0xffff0000, v7
    v_mul_f32_dpp v32, v41, v24 row_newbcast:8 row_mask:0xf bank_mask:0xf
    v_mul_f32_dpp v33, v41, v25 row_newbcast:9 row_mask:0xf bank_mask:0xf
    v_mul_f32_dpp v34, v41, v26 row_newbcast:10 row_mask:0xf bank_mask:0xf
    v_mul_f32_dpp v35, v41, v27 row_newbcast:11 row_mask:0xf bank_mask:0xf
    v_mul_f32_dpp v36, v41, v28 row_newbcast:12 row_mask:0xf bank_mask:0xf
    v_mul_f32_dpp v37, v41, v29 row_newbcast:13 row_mask:0xf bank_mask:0xf
    v_mul_f32_dpp v38, v41, v30 row_newbcast:14 row_mask:0xf bank_mask:0xf
    v_mul_f32_dpp v39, v41, v31 row_newbcast:15 row_mask:0xf bank_mask:0xf
    v_cvt_pk_bf16_f32 v92, v32, v33
    v_cvt_pk_bf16_f32 v93, v34, v35
    v_cvt_pk_bf16_f32 v94, v36, v37
    v_cvt_pk_bf16_f32 v95, v38, v39
    v_mul_f32_dpp v24, v41, v24 row_newbcast:0 row_mask:0xa bank_mask:0xf
    v_mul_f32_dpp v25, v41, v25 row_newbcast:1 row_mask:0xa bank_mask:0xf
    v_mul_f32_dpp v26, v41, v26 row_newbcast:2 row_mask:0xa bank_mask:0xf
    v_mul_f32_dpp v27, v41, v27 row_newbcast:3 row_mask:0xa bank_mask:0xf
    v_mul_f32_dpp v28, v41, v28 row_newbcast:4 row_mask:0xa bank_mask:0xf
    v_mul_f32_dpp v29, v41, v29 row_newbcast:5 row_mask:0xa bank_mask:0xf
    v_mul_f32_dpp v30, v41, v30 row_newbcast:6 row_mask:0xa bank_mask:0xf
    v_mul_f32_dpp v31, v41, v31 row_newbcast:7 row_mask:0xa bank_mask:0xf
    v_cvt_pk_bf16_f32 v88, v24, v25
    v_cvt_pk_bf16_f32 v89, v26, v27
    v_cvt_pk_bf16_f32 v90, v28, v29
    v_cvt_pk_bf16_f32 v91, v30, v31
    s_waitcnt lgkmcnt(0)
    v_lshlrev_b32 v16, 16, v8
    v_and_b32 v17, 0xffff0000, v8
    v_lshlrev_b32 v18, 16, v9
    v_and_b32 v19, 0xffff0000, v9
    v_lshlrev_b32 v20, 16, v10
    v_and_b32 v21, 0xffff0000, v10
    v_lshlrev_b32 v22, 16, v11
    v_and_b32 v23, 0xffff0000, v11
    v_mul_f32_dpp v32, v42, v16 row_newbcast:8 row_mask:0xf bank_mask:0xf
    v_mul_f32_dpp v33, v42, v17 row_newbcast:9 row_mask:0xf bank_mask:0xf
    v_mul_f32_dpp v34, v42, v18 row_newbcast:10 row_mask:0xf bank_mask:0xf
    v_mul_f32_dpp v35, v42, v19 row_newbcast:11 row_mask:0xf bank_mask:0xf
    v_mul_f32_dpp v36, v42, v20 row_newbcast:12 row_mask:0xf bank_mask:0xf
    v_mul_f32_dpp v37, v42, v21 row_newbcast:13 row_mask:0xf bank_mask:0xf
    v_mul_f32_dpp v38, v42, v22 row_newbcast:14 row_mask:0xf bank_mask:0xf
    v_mul_f32_dpp v39, v42, v23 row_newbcast:15 row_mask:0xf bank_mask:0xf
    v_cvt_pk_bf16_f32 v242, v32, v33
    v_cvt_pk_bf16_f32 v243, v34, v35
    v_cvt_pk_bf16_f32 v244, v36, v37
    v_cvt_pk_bf16_f32 v245, v38, v39
    v_mul_f32_dpp v16, v42, v16 row_newbcast:0 row_mask:0xa bank_mask:0xf
    v_mul_f32_dpp v17, v42, v17 row_newbcast:1 row_mask:0xa bank_mask:0xf
    v_mul_f32_dpp v18, v42, v18 row_newbcast:2 row_mask:0xa bank_mask:0xf
    v_mul_f32_dpp v19, v42, v19 row_newbcast:3 row_mask:0xa bank_mask:0xf
    v_mul_f32_dpp v20, v42, v20 row_newbcast:4 row_mask:0xa bank_mask:0xf
    v_mul_f32_dpp v21, v42, v21 row_newbcast:5 row_mask:0xa bank_mask:0xf
    v_mul_f32_dpp v22, v42, v22 row_newbcast:6 row_mask:0xa bank_mask:0xf
    v_mul_f32_dpp v23, v42, v23 row_newbcast:7 row_mask:0xa bank_mask:0xf
    v_cvt_pk_bf16_f32 v228, v16, v17
    v_cvt_pk_bf16_f32 v229, v18, v19
    v_cvt_pk_bf16_f32 v230, v20, v21
    v_cvt_pk_bf16_f32 v231, v22, v23
    s_waitcnt vmcnt(4)
    v_mfma_f32_32x32x16_bf16 v[8:23], v[80:83], v[176:179], 0
    ds_read_b64_tr_b16 v[184:185], v246 offset:2048
    ds_read_b64_tr_b16 v[186:187], v246 offset:3072
    ds_read_b64_tr_b16 v[188:189], v247 offset:2048
    ds_read_b64_tr_b16 v[190:191], v247 offset:3072
    s_mov_b32 m0, s68
    v_mfma_f32_32x32x16_bf16 v[24:39], v[84:87], v[176:179], 0
    buffer_load_dwordx4 v222, s[4:7], s41 offen sc1 lds
    buffer_load_dwordx4 v223, s[72:75], s41 offen offset:1024 sc1 lds
    v_permlane32_swap_b32 v236, v234
    v_permlane32_swap_b32 v237, v235
    v_mfma_f32_32x32x16_bf16 v[48:63], v[80:83], v[180:183], 0
    v_permlane32_swap_b32 v240, v238
    v_permlane32_swap_b32 v241, v239
    v_add_f32 v236, v236, v234
    v_add_f32 v237, v237, v235
    v_add_f32 v240, -v240, -v238
    v_mfma_f32_32x32x16_bf16 v[64:79], v[84:87], v[180:183], 0
    v_add_f32 v241, -v241, -v239
    v_cvt_pk_bf16_f32 v236, v236, v237
    v_cvt_pk_bf16_f32 v240, v240, v241
    ds_write2st64_b32 v232, v236, v240 offset0:2 offset1:3
    s_mov_b64 exec, 0x1ff
    ds_add_rtn_u32 v42, v254, v251
    s_mov_b64 exec, -1
    s_waitcnt vmcnt(4) lgkmcnt(2)
    v_mfma_f32_32x32x16_bf16 v[8:23], v[88:91], v[184:187], v[8:23]
    ds_read_b64_tr_b16 v[176:177], v246 offset:4096
    ds_read_b64_tr_b16 v[178:179], v246 offset:5120
    ds_read_b64_tr_b16 v[180:181], v247 offset:4096
    ds_read_b64_tr_b16 v[182:183], v247 offset:5120
    s_mov_b32 m0, s69
    v_mfma_f32_32x32x16_bf16 v[24:39], v[92:95], v[184:187], v[24:39]
    buffer_load_dwordx4 v226, s[4:7], s41 offen sc1 lds
    buffer_load_dwordx4 v227, s[72:75], s41 offen offset:1024 sc1 lds
    s_waitcnt lgkmcnt(4)
    v_readlane_b32 s58, v42, 8
    v_mfma_f32_32x32x16_bf16 v[48:63], v[88:91], v[188:191], v[48:63]
    s_lshr_b32 s58, s58, 4
    s_cmp_lt_u32 s58, s22
    s_cbranch_scc0 K2_nul_73
    v_readlane_b32 s3, v253, s58
    s_nop 0
    s_bfe_u32 s58, s3, 0x60016
    s_and_b32 s59, s58, 7
    s_lshr_b32 s60, s58, 3
K2_chk_75:
    v_readlane_b32 s61, v42, s59
    s_nop 0
    s_cmp_gt_u32 s61, s60
    s_cbranch_scc0 K2_spin_74
K2_back_76:
    v_mfma_f32_32x32x16_bf16 v[64:79], v[92:95], v[188:191], v[64:79]
    s_lshl_b32 s44, s34, 7
    s_and_b32 s48, s3, 0x3ffff
    s_bfe_u32 s33, s3, 0x30013
    s_mov_b32 s35, s48
    s_mov_b32 s45, s44
    s_xor_b32 s47, s44, 256
    s_waitcnt vmcnt(4) lgkmcnt(0)
    v_mfma_f32_32x32x16_bf16 v[8:23], v[228:231], v[176:179], v[8:23]
    ds_read_b64_tr_b16 v[184:185], v246 offset:6144
    ds_read_b64_tr_b16 v[186:187], v246 offset:7168
    ds_read_b64_tr_b16 v[188:189], v247 offset:6144
    ds_read_b64_tr_b16 v[190:191], v247 offset:7168
    s_add_u32 s49, s48, 128
    s_add_u32 s60, s48, 256
    s_mov_b32 m0, s70
    v_mfma_f32_32x32x16_bf16 v[24:39], v[242:245], v[176:179], v[24:39]
    buffer_load_dwordx4 v222, s[4:7], s42 offen sc1 lds
    buffer_load_dwordx4 v223, s[72:75], s42 offen offset:1024 sc1 lds
    s_cmp_eq_u32 s33, 3
    s_cselect_b32 s46, s44, s47
    s_cselect_b32 s50, s60, s48
    v_mfma_f32_32x32x16_bf16 v[48:63], v[228:231], v[180:183], v[48:63]
    s_sub_u32 s60, s33, 2
    s_cmp_lt_u32 s60, 2
    s_cbranch_scc0 K2_rare_77
K2_back_78:
    v_mul_f32 v234, v8, v96
    v_mul_f32 v236, v16, v128
    v_fmac_f32 v234, v9, v97
    v_fmac_f32 v236, v17, v129
    v_mfma_f32_32x32x16_bf16 v[64:79], v[242:245], v[180:183], v[64:79]
    s_setprio 0
    v_fmac_f32 v234, v10, v98
    v_fmac_f32 v236, v18, v130
    v_fmac_f32 v234, v11, v99
    v_fmac_f32 v236, v19, v131
    v_fmac_f32 v234, v12, v100
    v_fmac_f32 v236, v20, v132
    v_fmac_f32 v234, v13, v101
    v_fmac_f32 v236, v21, v133
    v_fmac_f32 v234, v14, v102
    v_fmac_f32 v236, v22, v134
    v_fmac_f32 v234, v15, v103
    v_fmac_f32 v236, v23, v135
    v_mul_f32 v238, v24, v128
    v_mul_f32 v240, v32, v128
    v_fmac_f32 v238, v25, v129
    v_fmac_f32 v240, v33, v129
    v_fmac_f32 v238, v26, v130
    v_fmac_f32 v240, v34, v130
    v_fmac_f32 v238, v27, v131
    v_fmac_f32 v240, v35, v131
    v_fmac_f32 v238, v28, v132
    v_fmac_f32 v240, v36, v132
    v_fmac_f32 v238, v29, v133
    v_fmac_f32 v240, v37, v133
    v_fmac_f32 v238, v30, v134
    v_fmac_f32 v240, v38, v134
    v_fmac_f32 v238, v31, v135
    v_fmac_f32 v240, v39, v135
    v_mul_f32 v235, v48, v104
    v_mul_f32 v237, v56, v136
    v_fmac_f32 v235, v49, v105
    v_fmac_f32 v237, v57, v137
    v_fmac_f32 v235, v50, v106
    v_fmac_f32 v237, v58, v138
    v_fmac_f32 v235, v51, v107
    v_fmac_f32 v237, v59, v139
    v_fmac_f32 v235, v52, v108
    v_fmac_f32 v237, v60, v140
    v_fmac_f32 v235, v53, v109
    v_fmac_f32 v237, v61, v141
    v_fmac_f32 v235, v54, v110
    v_fmac_f32 v237, v62, v142
    v_fmac_f32 v235, v55, v111
    v_fmac_f32 v237, v63, v143
    v_mul_f32 v239, v64, v136
    v_mul_f32 v241, v72, v136
    s_setprio 1
    s_waitcnt vmcnt(4) lgkmcnt(0)
    v_mfma_f32_32x32x16_bf16 v[24:39], v[92:95], v[184:187], 0
    ds_read_b64_tr_b16 v[176:177], v246 offset:0
    ds_read_b64_tr_b16 v[178:179], v246 offset:1024
    ds_read_b64_tr_b16 v[180:181], v247 offset:0
    ds_read_b64_tr_b16 v[182:183], v247 offset:1024
    v_fmac_f32 v239, v65, v137
    v_fmac_f32 v241, v73, v137
    s_mov_b32 m0, s71
    v_mfma_f32_32x32x16_bf16 v[8:23], v[88:91], v[184:187], 0
    buffer_load_dwordx4 v224, s[4:7], s42 offen sc1 lds
    buffer_load_dwordx4 v225, s[72:75], s42 offen offset:1024 sc1 lds
    v_fmac_f32 v239, v66, v138
    v_fmac_f32 v241, v74, v138
    v_fmac_f32 v239, v67, v139
    v_fmac_f32 v241, v75, v139
    v_fmac_f32 v239, v68, v140
    v_mfma_f32_32x32x16_bf16 v[48:63], v[88:91], v[188:191], 0
    v_fmac_f32 v241, v76, v140
    v_fmac_f32 v239, v69, v141
    v_fmac_f32 v241, v77, v141
    v_fmac_f32 v239, v70, v142
    v_fmac_f32 v241, v78, v142
    v_fmac_f32 v239, v71, v143
    v_fmac_f32 v241, v79, v143
    v_mfma_f32_32x32x16_bf16 v[64:79], v[92:95], v[188:191], 0
    v_permlane32_swap_b32 v234, v236
    v_permlane32_swap_b32 v235, v237
    v_permlane32_swap_b32 v238, v239
    s_waitcnt vmcnt(4) lgkmcnt(0)
    v_mfma_f32_32x32x16_bf16 v[24:39], v[84:87], v[176:179], v[24:39]
    ds_read_b64_tr_b16 v[184:185], v246 offset:2048
    ds_read_b64_tr_b16 v[186:187], v246 offset:3072
    ds_read_b64_tr_b16 v[188:189], v247 offset:2048
    ds_read_b64_tr_b16 v[190:191], v247 offset:3072
    v_lshl_add_u32 v232, v252, 1, s31
    v_add_f32 v234, v234, v236
    s_mov_b32 m0, s68
    v_mfma_f32_32x32x16_bf16 v[8:23], v[80:83], v[176:179], v[8:23]
    buffer_load_dwordx4 v226, s[4:7], s42 offen sc1 lds
    buffer_load_dwordx4 v227, s[72:75], s42 offen offset:1024 sc1 lds
    v_add_f32 v235, v235, v237
    v_add_f32 v238, -v238, -v239
    v_sub_u32 v239, v232, v233
    v_cvt_pk_bf16_f32 v234, v234, v235
    v_cvt_pk_bf16_f32 v238, v238, v238
    v_mfma_f32_32x32x16_bf16 v[48:63], v[80:83], v[180:183], v[48:63]
    ds_write_b32 v232, v234 offset:0
    ds_write_b16 v239, v238 offset:1280
    v_mfma_f32_32x32x16_bf16 v[64:79], v[84:87], v[180:183], v[64:79]
    s_waitcnt vmcnt(4) lgkmcnt(2)
    v_mfma_f32_32x32x16_bf16 v[24:39], v[242:245], v[184:187], v[24:39]
    ds_read_b64_tr_b16 v[176:177], v246 offset:4096
    ds_read_b64_tr_b16 v[178:179], v246 offset:5120
    ds_read_b64_tr_b16 v[180:181], v247 offset:4096
    ds_read_b64_tr_b16 v[182:183], v247 offset:5120
    s_mov_b32 m0, s69
    v_mfma_f32_32x32x16_bf16 v[8:23], v[228:231], v[184:187], v[8:23]
    buffer_load_dwordx4 v222, s[4:7], s43 offen sc1 lds
    buffer_load_dwordx4 v223, s[72:75], s43 offen offset:1024 sc1 lds
    v_mfma_f32_32x32x16_bf16 v[48:63], v[228:231], v[188:191], v[48:63]
    s_nop 2
    v_mul_f32 v236, v24, v160
    v_mul_f32 v238, v32, v160
    v_fmac_f32 v236, v25, v161
    v_fmac_f32 v238, v33, v161
    v_fmac_f32 v236, v26, v162
    v_fmac_f32 v238, v34, v162
    v_fmac_f32 v236, v27, v163
    v_mfma_f32_32x32x16_bf16 v[64:79], v[242:245], v[188:191], v[64:79]
    s_setprio 0
    v_fmac_f32 v238, v35, v163
    v_fmac_f32 v236, v28, v164
    v_fmac_f32 v238, v36, v164
    v_fmac_f32 v236, v29, v165
    v_fmac_f32 v238, v37, v165
    v_fmac_f32 v236, v30, v166
    v_fmac_f32 v238, v38, v166
    v_fmac_f32 v236, v31, v167
    v_fmac_f32 v238, v39, v167
    v_mul_f32 v234, v8, v144
    v_mul_f32 v235, v48, v152
    v_fmac_f32 v234, v9, v145
    v_fmac_f32 v235, v49, v153
    v_fmac_f32 v234, v10, v146
    v_fmac_f32 v235, v50, v154
    v_fmac_f32 v234, v11, v147
    v_fmac_f32 v235, v51, v155
    v_fmac_f32 v234, v12, v148
    v_fmac_f32 v235, v52, v156
    v_fmac_f32 v234, v13, v149
    v_fmac_f32 v235, v53, v157
    v_fmac_f32 v234, v14, v150
    v_fmac_f32 v235, v54, v158
    v_fmac_f32 v234, v15, v151
    v_fmac_f32 v235, v55, v159
    v_mul_f32 v237, v64, v168
    v_mul_f32 v239, v72, v168
    v_fmac_f32 v237, v65, v169
    v_fmac_f32 v239, v73, v169
    s_setprio 1
    s_waitcnt vmcnt(4) lgkmcnt(0)
    v_mfma_f32_32x32x16_bf16 v[24:39], v[80:83], v[176:179], 0
    ds_read_b64_tr_b16 v[184:185], v246 offset:6144
    ds_read_b64_tr_b16 v[186:187], v246 offset:7168
    ds_read_b64_tr_b16 v[188:189], v247 offset:6144
    ds_read_b64_tr_b16 v[190:191], v247 offset:7168
    v_fmac_f32 v237, v66, v170
    v_fmac_f32 v239, v74, v170
    s_mov_b32 m0, s70
    v_mfma_f32_32x32x16_bf16 v[0:15], v[84:87], v[176:179], 0
    buffer_load_dwordx4 v224, s[4:7], s43 offen sc1 lds
    buffer_load_dwordx4 v225, s[72:75], s43 offen offset:1024 sc1 lds
    v_fmac_f32 v237, v67, v171
    v_fmac_f32 v239, v75, v171
    v_fmac_f32 v237, v68, v172
    v_fmac_f32 v239, v76, v172
    v_fmac_f32 v237, v69, v173
    v_mfma_f32_32x32x16_bf16 v[40:55], v[84:87], v[180:183], 0
    v_add_u32 v222, s48, v251
    ds_read2_b32 v[222:223], v222 offset0:1 offset1:3
    v_fmac_f32 v239, v77, v173
    v_fmac_f32 v237, v70, v174
    v_fmac_f32 v239, v78, v174
    v_fmac_f32 v237, v71, v175
    v_fmac_f32 v239, v79, v175
    v_mfma_f32_32x32x16_bf16 v[64:79], v[80:83], v[180:183], 0
    v_permlane32_swap_b32 v234, v240
    v_permlane32_swap_b32 v235, v241
    v_add_f32 v234, v234, v240
    v_add_f32 v235, v235, v241
    s_waitcnt vmcnt(4) lgkmcnt(1)
    v_mfma_f32_32x32x16_bf16 v[24:39], v[88:91], v[184:187], v[24:39]
    ds_read_b64_tr_b16 v[176:177], v246 offset:0
    ds_read_b64_tr_b16 v[178:179], v246 offset:1024
    ds_read_b64_tr_b16 v[180:181], v247 offset:0
    ds_read_b64_tr_b16 v[182:183], v247 offset:1024
    v_cvt_pk_bf16_f32 v234, v234, v235
    ds_write_b32 v232, v234 offset:256
    s_mov_b32 m0, s71
    v_mfma_f32_32x32x16_bf16 v[0:15], v[92:95], v[184:187], v[0:15]
    buffer_load_dwordx4 v226, s[4:7], s43 offen sc1 lds
    buffer_load_dwordx4 v227, s[72:75], s43 offen offset:1024 sc1 lds
    s_waitcnt lgkmcnt(5)
    v_mad_u32_u16 v222, v222, s39, v248 op_sel:[1,0,0,0]
    v_mad_u32_u16 v223, v223, s39, v248 op_sel:[1,0,0,0]
    v_mfma_f32_32x32x16_bf16 v[40:55], v[92:95], v[188:191], v[40:55]
    v_add_u32 v224, s49, v251
    ds_read2_b32 v[224:225], v224 offset0:1 offset1:3
    v_mfma_f32_32x32x16_bf16 v[64:79], v[88:91], v[188:191], v[64:79]
    s_waitcnt vmcnt(4) lgkmcnt(2)
    v_mfma_f32_32x32x16_bf16 v[24:39], v[228:231], v[176:179], v[24:39]
    ds_read_b64_tr_b16 v[184:185], v246 offset:2048
    ds_read_b64_tr_b16 v[186:187], v246 offset:3072
    ds_read_b64_tr_b16 v[188:189], v247 offset:2048
    ds_read_b64_tr_b16 v[190:191], v247 offset:3072
    s_mov_b32 m0, s68
    v_mfma_f32_32x32x16_bf16 v[0:15], v[242:245], v[176:179], v[0:15]
    buffer_load_dwordx4 v222, s[4:7], s44 offen sc1 lds
    buffer_load_dwordx4 v223, s[72:75], s44 offen offset:1024 sc1 lds
    s_waitcnt lgkmcnt(4)
    v_mad_u32_u16 v224, v224, s39, v248 op_sel:[1,0,0,0]
    v_mad_u32_u16 v225, v225, s39, v248 op_sel:[1,0,0,0]
    v_mfma_f32_32x32x16_bf16 v[40:55], v[242:245], v[180:183], v[40:55]
    v_add_u32 v226, s50, v251
    ds_read2_b32 v[226:227], v226 offset0:1 offset1:3
    v_mul_f32 v240, v24, v144
    v_fmac_f32 v236, v32, v160
    v_fmac_f32 v240, v25, v145
    v_fmac_f32 v236, v33, v161
    v_fmac_f32 v240, v26, v146
    v_mfma_f32_32x32x16_bf16 v[64:79], v[228:231], v[180:183], v[64:79]
    s_setprio 0
    v_fmac_f32 v236, v34, v162
    v_fmac_f32 v240, v27, v147
    v_fmac_f32 v236, v35, v163
    v_fmac_f32 v240, v28, v148
    v_fmac_f32 v236, v36, v164
    v_fmac_f32 v240, v29, v149
    v_fmac_f32 v236, v37, v165
    v_fmac_f32 v240, v30, v150
    v_fmac_f32 v236, v38, v166
    v_fmac_f32 v240, v31, v151
    v_fmac_f32 v236, v39, v167
    v_mul_f32 v234, v0, v112
    v_mul_f32 v235, v40, v120
    v_fmac_f32 v234, v1, v113
    v_fmac_f32 v235, v41, v121
    v_fmac_f32 v234, v2, v114
    v_fmac_f32 v235, v42, v122
    v_fmac_f32 v234, v3, v115
    v_fmac_f32 v235, v43, v123
    v_fmac_f32 v234, v4, v116
    v_fmac_f32 v235, v44, v124
    v_fmac_f32 v234, v5, v117
    v_fmac_f32 v235, v45, v125
    v_fmac_f32 v234, v6, v118
    v_fmac_f32 v235, v46, v126
    v_fmac_f32 v234, v7, v119
    v_fmac_f32 v235, v47, v127
    v_mul_f32 v241, v64, v152
    v_fmac_f32 v237, v72, v168
    v_fmac_f32 v241, v65, v153
    v_fmac_f32 v237, v73, v169
    v_fmac_f32 v241, v66, v154
    s_setprio 1
    s_waitcnt vmcnt(4) lgkmcnt(1)
    v_mfma_f32_32x32x16_bf16 v[24:39], v[80:83], v[184:187], 0
    ds_read_b64_tr_b16 v[176:177], v246 offset:4096
    ds_read_b64_tr_b16 v[178:179], v246 offset:5120
    ds_read_b64_tr_b16 v[180:181], v247 offset:4096
    ds_read_b64_tr_b16 v[182:183], v247 offset:5120
    v_fmac_f32 v237, v74, v170
    v_fmac_f32 v241, v67, v155
    s_mov_b32 m0, s69
    v_mfma_f32_32x32x16_bf16 v[8:23], v[84:87], v[184:187], v[8:23]
    buffer_load_dwordx4 v224, s[4:7], s45 offen sc1 lds
    buffer_load_dwordx4 v225, s[72:75], s45 offen offset:1024 sc1 lds
    s_waitcnt lgkmcnt(4)
    v_mad_u32_u16 v226, v226, s39, v248 op_sel:[1,0,0,0]
    v_mad_u32_u16 v227, v227, s39, v248 op_sel:[1,0,0,0]
    v_fmac_f32 v237, v75, v171
    v_fmac_f32 v241, v68, v156
    v_mfma_f32_32x32x16_bf16 v[48:63], v[84:87], v[188:191], v[48:63]
    v_fmac_f32 v237, v76, v172
    v_fmac_f32 v241, v69, v157
    v_fmac_f32 v237, v77, v173
    v_fmac_f32 v241, v70, v158
    v_fmac_f32 v237, v78, v174
    v_fmac_f32 v241, v71, v159
    v_fmac_f32 v237, v79, v175
    v_mfma_f32_32x32x16_bf16 v[64:79], v[80:83], v[188:191], 0
    v_permlane32_swap_b32 v236, v240
    v_permlane32_swap_b32 v237, v241
    v_add_f32 v236, v236, v240
    v_add_f32 v237, v237, v241
    s_waitcnt vmcnt(4) lgkmcnt(0)
    v_mfma_f32_32x32x16_bf16 v[24:39], v[88:91], v[176:179], v[24:39]
    ds_read_b64_tr_b16 v[184:185], v246 offset:6144
    ds_read_b64_tr_b16 v[186:187], v246 offset:7168
    ds_read_b64_tr_b16 v[188:189], v247 offset:6144
    ds_read_b64_tr_b16 v[190:191], v247 offset:7168
    v_cvt_pk_bf16_f32 v236, v236, v237
    ds_write_b32 v232, v236 offset:1024
    s_mov_b32 m0, s70
    v_mfma_f32_32x32x16_bf16 v[8:23], v[92:95], v[176:179], v[8:23]
    buffer_load_dwordx4 v226, s[4:7], s46 offen sc1 lds
    buffer_load_dwordx4 v227, s[72:75], s46 offen offset:1024 sc1 lds
    s_sub_u32 s26, s48, s29
    s_mov_b32 s29, s48
    s_mov_b32 s30, s3
    s_bfe_u32 s56, s3, 0x40012
    s_mov_b32 s32, s31
    v_mfma_f32_32x32x16_bf16 v[48:63], v[92:95], v[180:183], v[48:63]
    s_cmp_lg_u32 s36, 0
    s_cselect_b32 s56, s56, 0
    s_mov_b32 s31, s35
    v_mfma_f32_32x32x16_bf16 v[64:79], v[88:91], v[180:183], v[64:79]
    s_waitcnt vmcnt(4) lgkmcnt(1)
    v_mfma_f32_32x32x16_bf16 v[24:39], v[228:231], v[184:187], v[24:39]
    ds_read_b64_tr_b16 v[176:177], v246 offset:0
    ds_read_b64_tr_b16 v[178:179], v246 offset:1024
    ds_read_b64_tr_b16 v[180:181], v247 offset:0
    ds_read_b64_tr_b16 v[182:183], v247 offset:1024
    s_mov_b32 m0, s71
    v_mfma_f32_32x32x16_bf16 v[8:23], v[242:245], v[184:187], v[8:23]
    s_cmp_eq_u32 s33, 4
    s_cbranch_scc1 K2_g4_80
    buffer_load_dwordx4 v224, s[4:7], s47 offen sc1 lds
    buffer_load_dwordx4 v225, s[72:75], s47 offen offset:1024 sc1 lds
K2_back_81:
    v_mfma_f32_32x32x16_bf16 v[48:63], v[242:245], v[188:191], v[48:63]
    s_nop 0
    v_mul_f32 v236, v24, v144
    v_fma_f32 v238, v32, v160, -v238
    v_fmac_f32 v236, v25, v145
    v_fmac_f32 v238, v33, v161
    v_fmac_f32 v236, v26, v146
    v_fmac_f32 v238, v34, v162
    v_fmac_f32 v236, v27, v147
    v_mfma_f32_32x32x16_bf16 v[64:79], v[228:231], v[188:191], v[64:79]
    s_setprio 0
    v_fmac_f32 v238, v35, v163
    v_fmac_f32 v236, v28, v148
    v_fmac_f32 v238, v36, v164
    v_fmac_f32 v236, v29, v149
    v_fmac_f32 v238, v37, v165
    v_fmac_f32 v236, v30, v150
    v_fmac_f32 v238, v38, v166
    v_fmac_f32 v236, v31, v151
    v_fmac_f32 v238, v39, v167
    v_add_u32 v249, s26, v249
    v_add_u32 v250, s26, v250
    v_mul_f32 v240, v8, v160
    v_fma_f32 v234, v16, v112, -v234
    v_fmac_f32 v240, v9, v161
    v_fmac_f32 v234, v17, v113
    v_fmac_f32 v240, v10, v162
    v_fmac_f32 v234, v18, v114
    v_fmac_f32 v240, v11, v163
    v_fmac_f32 v234, v19, v115
    v_fmac_f32 v240, v12, v164
    v_fmac_f32 v234, v20, v116
    v_fmac_f32 v240, v13, v165
    v_fmac_f32 v234, v21, v117
    v_fmac_f32 v240, v14, v166
    v_fmac_f32 v234, v22, v118
    v_fmac_f32 v240, v15, v167
    v_fmac_f32 v234, v23, v119
    ds_read_b64_tr_b16 v[0:1], v249 offset:0
    ds_read_b64_tr_b16 v[2:3], v249 offset:32
    ds_read_u16_d16_hi v40, v250 offset:0
    v_mul_f32 v241, v48, v168
    v_fma_f32 v235, v56, v120, -v235
    v_fmac_f32 v241, v49, v169
    v_fmac_f32 v235, v57, v121
    v_fmac_f32 v241, v50, v170
    v_fmac_f32 v235, v58, v122
    v_fmac_f32 v241, v51, v171
    v_fmac_f32 v235, v59, v123
    v_fmac_f32 v241, v52, v172
    v_fmac_f32 v235, v60, v124
    v_fmac_f32 v241, v53, v173
    v_fmac_f32 v235, v61, v125
    v_fmac_f32 v241, v54, v174
    v_fmac_f32 v235, v62, v126
    v_fmac_f32 v241, v55, v175
    v_fmac_f32 v235, v63, v127
    ds_read_b64_tr_b16 v[4:5], v249 offset:512
    ds_read_b64_tr_b16 v[6:7], v249 offset:544
    ds_read_u16_d16_hi v41, v250 offset:128
    v_mul_f32 v237, v64, v152
    v_fma_f32 v239, v72, v168, -v239
    v_fmac_f32 v237, v65, v153
    v_fmac_f32 v239, v73, v169
    v_fmac_f32 v237, v66, v154
    v_fmac_f32 v239, v74, v170
    v_fmac_f32 v237, v67, v155
    v_fmac_f32 v239, v75, v171
    v_fmac_f32 v237, v68, v156
    v_fmac_f32 v239, v76, v172
    v_fmac_f32 v237, v69, v157
    v_fmac_f32 v239, v77, v173
    v_fmac_f32 v237, v70, v158
    v_fmac_f32 v239, v78, v174
    v_fmac_f32 v237, v71, v159
    v_fmac_f32 v239, v79, v175
    s_cmp_eq_u32 s56, 5
    s_cbranch_scc1 K2_U21
    s_cmp_eq_u32 s56, 6
    s_cbranch_scc1 K2_U3h1
    s_branch K2_DSP1
K2_U2h1:
    s_setprio 1
    s_waitcnt lgkmcnt(0)
    v_lshlrev_b32 v16, 16, v0
    v_and_b32 v17, 0xffff0000, v0
    v_lshlrev_b32 v18, 16, v1
    v_and_b32 v19, 0xffff0000, v1
    v_lshlrev_b32 v20, 16, v2
    v_and_b32 v21, 0xffff0000, v2
    v_lshlrev_b32 v22, 16, v3
    v_and_b32 v23, 0xffff0000, v3
    v_mul_f32_dpp v32, v40, v16 row_newbcast:8 row_mask:0xf bank_mask:0xf
    v_mul_f32_dpp v33, v40, v17 row_newbcast:9 row_mask:0xf bank_mask:0xf
    v_mul_f32_dpp v34, v40, v18 row_newbcast:10 row_mask:0xf bank_mask:0xf
    v_mul_f32_dpp v35, v40, v19 row_newbcast:11 row_mask:0xf bank_mask:0xf
    v_mul_f32_dpp v36, v40, v20 row_newbcast:12 row_mask:0xf bank_mask:0xf
    v_mul_f32_dpp v37, v40, v21 row_newbcast:13 row_mask:0xf bank_mask:0xf
    v_mul_f32_dpp v38, v40, v22 row_newbcast:14 row_mask:0xf bank_mask:0xf
    v_mul_f32_dpp v39, v40, v23 row_newbcast:15 row_mask:0xf bank_mask:0xf
    v_cvt_pk_bf16_f32 v84, v32, v33
    v_cvt_pk_bf16_f32 v85, v34, v35
    v_cvt_pk_bf16_f32 v86, v36, v37
    v_cvt_pk_bf16_f32 v87, v38, v39
    v_mul_f32_dpp v16, v40, v16 row_newbcast:0 row_mask:0xa bank_mask:0xf
    v_mul_f32_dpp v17, v40, v17 row_newbcast:1 row_mask:0xa bank_mask:0xf
    v_mul_f32_dpp v18, v40, v18 row_newbcast:2 row_mask:0xa bank_mask:0xf
    v_mul_f32_dpp v19, v40, v19 row_newbcast:3 row_mask:0xa bank_mask:0xf
    v_mul_f32_dpp v20, v40, v20 row_newbcast:4 row_mask:0xa bank_mask:0xf
    v_mul_f32_dpp v21, v40, v21 row_newbcast:5 row_mask:0xa bank_mask:0xf
    v_mul_f32_dpp v22, v40, v22 row_newbcast:6 row_mask:0xa bank_mask:0xf
    v_mul_f32_dpp v23, v40, v23 row_newbcast:7 row_mask:0xa bank_mask:0xf
    v_cvt_pk_bf16_f32 v80, v16, v17
    v_cvt_pk_bf16_f32 v81, v18, v19
    v_cvt_pk_bf16_f32 v82, v20, v21
    v_cvt_pk_bf16_f32 v83, v22, v23
    v_lshlrev_b32 v24, 16, v4
    v_and_b32 v25, 0xffff0000, v4
    v_lshlrev_b32 v26, 16, v5
    v_and_b32 v27, 0xffff0000, v5
    v_mul_f32_dpp v32, v41, v24 row_newbcast:8 row_mask:0xf bank_mask:0xf
    v_mul_f32_dpp v33, v41, v25 row_newbcast:9 row_mask:0xf bank_mask:0xf
    v_mul_f32_dpp v34, v41, v26 row_newbcast:10 row_mask:0xf bank_mask:0xf
    v_mul_f32_dpp v35, v41, v27 row_newbcast:11 row_mask:0xf bank_mask:0xf
    v_cvt_pk_bf16_f32 v92, v32, v33
    v_cvt_pk_bf16_f32 v93, v34, v35
    v_mul_f32_dpp v24, v41, v24 row_newbcast:0 row_mask:0xa bank_mask:0xf
    v_mul_f32_dpp v25, v41, v25 row_newbcast:1 row_mask:0xa bank_mask:0xf
    v_mul_f32_dpp v26, v41, v26 row_newbcast:2 row_mask:0xa bank_mask:0xf
    v_mul_f32_dpp v27, v41, v27 row_newbcast:3 row_mask:0xa bank_mask:0xf
    v_cvt_pk_bf16_f32 v88, v24, v25
    v_cvt_pk_bf16_f32 v89, v26, v27
    s_waitcnt vmcnt(4)
    v_mfma_f32_32x32x16_bf16 v[8:23], v[80:83], v[176:179], 0
    ds_read_b64_tr_b16 v[184:185], v246 offset:2048
    ds_read_b64_tr_b16 v[188:189], v247 offset:2048
    s_mov_b32 m0, s68
    v_mfma_f32_32x32x16_bf16 v[24:39], v[84:87], v[176:179], 0
    buffer_load_dwordx4 v222, s[4:7], s42 offen sc1 lds
    buffer_load_dwordx4 v223, s[72:75], s42 offen offset:1024 sc1 lds
    v_permlane32_swap_b32 v236, v234
    v_permlane32_swap_b32 v237, v235
    v_mfma_f32_32x32x16_bf16 v[48:63], v[80:83], v[180:183], 0
    v_permlane32_swap_b32 v240, v238
    v_permlane32_swap_b32 v241, v239
    v_add_f32 v236, v236, v234
    v_add_f32 v237, v237, v235
    v_add_f32 v240, -v240, -v238
    v_mfma_f32_32x32x16_bf16 v[64:79], v[84:87], v[180:183], 0
    v_add_f32 v241, -v241, -v239
    v_cvt_pk_bf16_f32 v236, v236, v237
    v_cvt_pk_bf16_f32 v240, v240, v241
    ds_write2st64_b32 v232, v236, v240 offset0:2 offset1:3
    s_mov_b64 exec, 0x1ff
    ds_add_rtn_u32 v42, v254, v251
    s_mov_b64 exec, -1
    s_waitcnt vmcnt(4) lgkmcnt(2)
    v_mfma_f32_32x32x8_bf16 v[8:23], v[88:89], v[184:185], v[8:23]
    ds_read_b64_tr_b16 v[176:177], v246 offset:4096
    ds_read_b64_tr_b16 v[178:179], v246 offset:5120
    ds_read_b64_tr_b16 v[180:181], v247 offset:4096
    ds_read_b64_tr_b16 v[182:183], v247 offset:5120
    s_mov_b32 m0, s69
    v_mfma_f32_32x32x8_bf16 v[24:39], v[92:93], v[184:185], v[24:39]
    buffer_load_dwordx4 v224, s[4:7], s42 offen sc1 lds
    s_waitcnt lgkmcnt(4)
    v_readlane_b32 s58, v42, 8
    v_mfma_f32_32x32x8_bf16 v[48:63], v[88:89], v[188:189], v[48:63]
    s_lshr_b32 s58, s58, 4
    s_cmp_lt_u32 s58, s22
    s_cbranch_scc0 K2_nul_82
    v_readlane_b32 s3, v253, s58
    s_nop 0
    s_bfe_u32 s58, s3, 0x60016
    s_and_b32 s59, s58, 7
    s_lshr_b32 s60, s58, 3
K2_chk_84:
    v_readlane_b32 s61, v42, s59
    s_nop 0
    s_cmp_gt_u32 s61, s60
    s_cbranch_scc0 K2_spin_83
K2_back_85:
    v_mfma_f32_32x32x8_bf16 v[64:79], v[92:93], v[188:189], v[64:79]
    s_setprio 0
    s_lshl_b32 s44, s34, 7
    s_and_b32 s48, s3, 0x3ffff
    s_bfe_u32 s33, s3, 0x30013
    s_mov_b32 s35, s48
    s_mov_b32 s45, s44
    s_xor_b32 s47, s44, 256
    v_mul_f32 v234, v8, v96
    v_mul_f32 v236, v16, v128
    v_fmac_f32 v234, v9, v97
    v_fmac_f32 v236, v17, v129
    v_fmac_f32 v234, v10, v98
    v_fmac_f32 v236, v18, v130
    v_fmac_f32 v234, v11, v99
    v_fmac_f32 v236, v19, v131
    v_fmac_f32 v234, v12, v100
    v_fmac_f32 v236, v20, v132
    v_fmac_f32 v234, v13, v101
    v_fmac_f32 v236, v21, v133
    v_fmac_f32 v234, v14, v102
    v_fmac_f32 v236, v22, v134
    v_fmac_f32 v234, v15, v103
    v_fmac_f32 v236, v23, v135
    v_mul_f32 v238, v24, v128
    v_mul_f32 v240, v32, v128
    v_fmac_f32 v238, v25, v129
    v_fmac_f32 v240, v33, v129
    v_fmac_f32 v238, v26, v130
    v_fmac_f32 v240, v34, v130
    v_fmac_f32 v238, v27, v131
    v_fmac_f32 v240, v35, v131
    v_fmac_f32 v238, v28, v132
    v_fmac_f32 v240, v36, v132
    v_fmac_f32 v238, v29, v133
    v_fmac_f32 v240, v37, v133
    v_fmac_f32 v238, v30, v134
    v_fmac_f32 v240, v38, v134
    v_fmac_f32 v238, v31, v135
    v_fmac_f32 v240, v39, v135
    v_mul_f32 v235, v48, v104
    v_mul_f32 v237, v56, v136
    v_fmac_f32 v235, v49, v105
    v_fmac_f32 v237, v57, v137
    v_fmac_f32 v235, v50, v106
    v_fmac_f32 v237, v58, v138
    v_fmac_f32 v235, v51, v107
    v_fmac_f32 v237, v59, v139
    v_fmac_f32 v235, v52, v108
    v_fmac_f32 v237, v60, v140
    v_fmac_f32 v235, v53, v109
    v_fmac_f32 v237, v61, v141
    v_fmac_f32 v235, v54, v110
    v_fmac_f32 v237, v62, v142
    v_fmac_f32 v235, v55, v111
    v_fmac_f32 v237, v63, v143
    v_mul_f32 v239, v64, v136
    v_mul_f32 v241, v72, v136
    s_setprio 1
    s_waitcnt vmcnt(3) lgkmcnt(0)
    v_mfma_f32_32x32x16_bf16 v[24:39], v[84:87], v[176:179], 0
    ds_read_b64_tr_b16 v[184:185], v246 offset:6144
    ds_read_b64_tr_b16 v[188:189], v247 offset:6144
    v_fmac_f32 v239, v65, v137
    v_fmac_f32 v241, v73, v137
    v_fmac_f32 v239, v66, v138
    v_fmac_f32 v241, v74, v138
    s_mov_b32 m0, s70
    v_mfma_f32_32x32x16_bf16 v[8:23], v[80:83], v[176:179], 0
    buffer_load_dwordx4 v222, s[4:7], s43 offen sc1 lds
    buffer_load_dwordx4 v223, s[72:75], s43 offen offset:1024 sc1 lds
    v_fmac_f32 v239, v67, v139
    v_fmac_f32 v241, v75, v139
    v_fmac_f32 v239, v68, v140
    v_fmac_f32 v241, v76, v140
    v_fmac_f32 v239, v69, v141
    v_mfma_f32_32x32x16_bf16 v[48:63], v[80:83], v[180:183], 0
    s_add_u32 s49, s48, 128
    s_add_u32 s60, s48, 256
    s_cmp_eq_u32 s33, 3
    s_cselect_b32 s46, s44, s47
    s_cselect_b32 s50, s60, s48
    s_sub_u32 s60, s33, 2
    s_cmp_lt_u32 s60, 2
    s_cbranch_scc0 K2_rare_86
K2_back_87:
    v_add_u32 v222, s48, v251
    ds_read2_b32 v[222:223], v222 offset0:1 offset1:3
    v_fmac_f32 v241, v77, v141
    v_fmac_f32 v239, v70, v142
    v_fmac_f32 v241, v78, v142
    v_fmac_f32 v239, v71, v143
    v_fmac_f32 v241, v79, v143
    v_mfma_f32_32x32x16_bf16 v[64:79], v[84:87], v[180:183], 0
    v_permlane32_swap_b32 v234, v236
    v_permlane32_swap_b32 v235, v237
    v_permlane32_swap_b32 v238, v239
    s_waitcnt vmcnt(3) lgkmcnt(1)
    v_mfma_f32_32x32x8_bf16 v[24:39], v[92:93], v[184:185], v[24:39]
    ds_read_b64_tr_b16 v[176:177], v246 offset:0
    ds_read_b64_tr_b16 v[178:179], v246 offset:1024
    ds_read_b64_tr_b16 v[180:181], v247 offset:0
    ds_read_b64_tr_b16 v[182:183], v247 offset:1024
    v_lshl_add_u32 v232, v252, 1, s31
    v_add_f32 v234, v234, v236
    s_mov_b32 m0, s71
    v_mfma_f32_32x32x8_bf16 v[8:23], v[88:89], v[184:185], v[8:23]
    buffer_load_dwordx4 v224, s[4:7], s43 offen sc1 lds
    s_waitcnt lgkmcnt(4)
    v_mad_u32_u16 v222, v222, s39, v248 op_sel:[1,0,0,0]
    v_mad_u32_u16 v223, v223, s39, v248 op_sel:[1,0,0,0]
    v_add_f32 v235, v235, v237
    v_add_f32 v238, -v238, -v239
    v_sub_u32 v239, v232, v233
    v_cvt_pk_bf16_f32 v234, v234, v235
    v_cvt_pk_bf16_f32 v238, v238, v238
    ds_write_b32 v232, v234 offset:0
    ds_write_b16 v239, v238 offset:1280
    v_mfma_f32_32x32x8_bf16 v[48:63], v[88:89], v[188:189], v[48:63]
    v_add_u32 v224, s49, v251
    ds_read2_b32 v[224:225], v224 offset0:1 offset1:3
    v_mul_f32 v236, v24, v160
    v_mul_f32 v238, v32, v160
    v_fmac_f32 v236, v25, v161
    v_fmac_f32 v238, v33, v161
    v_fmac_f32 v236, v26, v162
    v_mfma_f32_32x32x8_bf16 v[64:79], v[92:93], v[188:189], v[64:79]
    s_setprio 0
    v_fmac_f32 v238, v34, v162
    v_fmac_f32 v236, v27, v163
    v_fmac_f32 v238, v35, v163
    v_fmac_f32 v236, v28, v164
    v_fmac_f32 v238, v36, v164
    v_fmac_f32 v236, v29, v165
    v_fmac_f32 v238, v37, v165
    v_fmac_f32 v236, v30, v166
    v_fmac_f32 v238, v38, v166
    v_fmac_f32 v236, v31, v167
    v_fmac_f32 v238, v39, v167
    v_mul_f32 v234, v8, v144
    v_mul_f32 v235, v48, v152
    v_fmac_f32 v234, v9, v145
    v_fmac_f32 v235, v49, v153
    v_fmac_f32 v234, v10, v146
    v_fmac_f32 v235, v50, v154
    v_fmac_f32 v234, v11, v147
    v_fmac_f32 v235, v51, v155
    v_fmac_f32 v234, v12, v148
    v_fmac_f32 v235, v52, v156
    v_fmac_f32 v234, v13, v149
    v_fmac_f32 v235, v53, v157
    v_fmac_f32 v234, v14, v150
    v_fmac_f32 v235, v54, v158
    v_fmac_f32 v234, v15, v151
    v_fmac_f32 v235, v55, v159
    v_mul_f32 v237, v64, v168
    v_mul_f32 v239, v72, v168
    v_fmac_f32 v237, v65, v169
    v_fmac_f32 v239, v73, v169
    v_fmac_f32 v237, v66, v170
    s_setprio 1
    s_waitcnt vmcnt(3) lgkmcnt(3)
    v_mfma_f32_32x32x16_bf16 v[24:39], v[80:83], v[176:179], 0
    ds_read_b64_tr_b16 v[184:185], v246 offset:2048
    ds_read_b64_tr_b16 v[188:189], v247 offset:2048
    v_fmac_f32 v239, v74, v170
    v_fmac_f32 v237, v67, v171
    v_fmac_f32 v239, v75, v171
    v_fmac_f32 v237, v68, v172
    s_mov_b32 m0, s68
    v_mfma_f32_32x32x16_bf16 v[0:15], v[84:87], v[176:179], 0
    buffer_load_dwordx4 v222, s[4:7], s44 offen sc1 lds
    buffer_load_dwordx4 v223, s[72:75], s44 offen offset:1024 sc1 lds
    s_waitcnt lgkmcnt(2)
    v_mad_u32_u16 v224, v224, s39, v248 op_sel:[1,0,0,0]
    v_mad_u32_u16 v225, v225, s39, v248 op_sel:[1,0,0,0]
    v_fmac_f32 v239, v76, v172
    v_fmac_f32 v237, v69, v173
    v_mfma_f32_32x32x16_bf16 v[40:55], v[84:87], v[180:183], 0
    v_add_u32 v226, s50, v251
    ds_read2_b32 v[226:227], v226 offset0:1 offset1:3
    v_fmac_f32 v239, v77, v173
    v_fmac_f32 v237, v70, v174
    v_fmac_f32 v239, v78, v174
    v_fmac_f32 v237, v71, v175
    v_fmac_f32 v239, v79, v175
    v_mfma_f32_32x32x16_bf16 v[64:79], v[80:83], v[180:183], 0
    v_permlane32_swap_b32 v234, v240
    v_permlane32_swap_b32 v235, v241
    v_add_f32 v234, v234, v240
    v_add_f32 v235, v235, v241
    s_waitcnt vmcnt(3) lgkmcnt(1)
    v_mfma_f32_32x32x8_bf16 v[24:39], v[88:89], v[184:185], v[24:39]
    ds_read_b64_tr_b16 v[176:177], v246 offset:4096
    ds_read_b64_tr_b16 v[178:179], v246 offset:5120
    ds_read_b64_tr_b16 v[180:181], v247 offset:4096
    ds_read_b64_tr_b16 v[182:183], v247 offset:5120
    v_cvt_pk_bf16_f32 v234, v234, v235
    ds_write_b32 v232, v234 offset:256
    s_mov_b32 m0, s69
    v_mfma_f32_32x32x8_bf16 v[0:15], v[92:93], v[184:185], v[0:15]
    buffer_load_dwordx4 v224, s[4:7], s45 offen sc1 lds
    buffer_load_dwordx4 v225, s[72:75], s45 offen offset:1024 sc1 lds
    s_waitcnt lgkmcnt(5)
    v_mad_u32_u16 v226, v226, s39, v248 op_sel:[1,0,0,0]
    v_mad_u32_u16 v227, v227, s39, v248 op_sel:[1,0,0,0]
    v_mfma_f32_32x32x8_bf16 v[40:55], v[92:93], v[188:189], v[40:55]
    v_mul_f32 v240, v24, v144
    v_fmac_f32 v236, v32, v160
    v_fmac_f32 v240, v25, v145
    v_fmac_f32 v236, v33, v161
    v_fmac_f32 v240, v26, v146
    v_fmac_f32 v236, v34, v162
    v_fmac_f32 v240, v27, v147
    v_mfma_f32_32x32x8_bf16 v[64:79], v[88:89], v[188:189], v[64:79]
    s_setprio 0
    v_fmac_f32 v236, v35, v163
    v_fmac_f32 v240, v28, v148
    v_fmac_f32 v236, v36, v164
    v_fmac_f32 v240, v29, v149
    v_fmac_f32 v236, v37, v165
    v_fmac_f32 v240, v30, v150
    v_fmac_f32 v236, v38, v166
    v_fmac_f32 v240, v31, v151
    v_fmac_f32 v236, v39, v167
    v_mul_f32 v234, v0, v112
    v_mul_f32 v235, v40, v120
    v_fmac_f32 v234, v1, v113
    v_fmac_f32 v235, v41, v121
    v_fmac_f32 v234, v2, v114
    v_fmac_f32 v235, v42, v122
    v_fmac_f32 v234, v3, v115
    v_fmac_f32 v235, v43, v123
    v_fmac_f32 v234, v4, v116
    v_fmac_f32 v235, v44, v124
    v_fmac_f32 v234, v5, v117
    v_fmac_f32 v235, v45, v125
    v_fmac_f32 v234, v6, v118
    v_fmac_f32 v235, v46, v126
    v_fmac_f32 v234, v7, v119
    v_fmac_f32 v235, v47, v127
    s_setprio 1
    s_waitcnt vmcnt(4) lgkmcnt(1)
    v_mfma_f32_32x32x16_bf16 v[24:39], v[80:83], v[176:179], 0
    ds_read_b64_tr_b16 v[184:185], v246 offset:6144
    ds_read_b64_tr_b16 v[188:189], v247 offset:6144
    v_mul_f32 v241, v64, v152
    v_fmac_f32 v237, v72, v168
    v_fmac_f32 v241, v65, v153
    v_fmac_f32 v237, v73, v169
    s_mov_b32 m0, s70
    v_mfma_f32_32x32x16_bf16 v[8:23], v[84:87], v[176:179], v[8:23]
    buffer_load_dwordx4 v226, s[4:7], s46 offen sc1 lds
    buffer_load_dwordx4 v227, s[72:75], s46 offen offset:1024 sc1 lds
    v_fmac_f32 v241, v66, v154
    v_fmac_f32 v237, v74, v170
    v_fmac_f32 v241, v67, v155
    v_fmac_f32 v237, v75, v171
    v_fmac_f32 v241, v68, v156
    v_mfma_f32_32x32x16_bf16 v[48:63], v[84:87], v[180:183], v[48:63]
    v_fmac_f32 v237, v76, v172
    v_fmac_f32 v241, v69, v157
    v_fmac_f32 v237, v77, v173
    v_fmac_f32 v241, v70, v158
    v_fmac_f32 v237, v78, v174
    v_fmac_f32 v241, v71, v159
    v_fmac_f32 v237, v79, v175
    v_mfma_f32_32x32x16_bf16 v[64:79], v[80:83], v[180:183], 0
    v_permlane32_swap_b32 v236, v240
    v_permlane32_swap_b32 v237, v241
    v_add_f32 v236, v236, v240
    v_add_f32 v237, v237, v241
    s_waitcnt vmcnt(4) lgkmcnt(0)
    v_mfma_f32_32x32x8_bf16 v[24:39], v[88:89], v[184:185], v[24:39]
    ds_read_b64_tr_b16 v[176:177], v246 offset:0
    ds_read_b64_tr_b16 v[178:179], v246 offset:1024
    ds_read_b64_tr_b16 v[180:181], v247 offset:0
    ds_read_b64_tr_b16 v[182:183], v247 offset:1024
    v_cvt_pk_bf16_f32 v236, v236, v237
    ds_write_b32 v232, v236 offset:1024
    s_mov_b32 m0, s71
    v_mfma_f32_32x32x8_bf16 v[8:23], v[92:93], v[184:185], v[8:23]
    s_cmp_eq_u32 s33, 4
    s_cbranch_scc1 K2_g4_89
    buffer_load_dwordx4 v224, s[4:7], s47 offen sc1 lds
    buffer_load_dwordx4 v225, s[72:75], s47 offen offset:1024 sc1 lds
K2_back_90:
    s_sub_u32 s26, s48, s29
    s_mov_b32 s29, s48
    s_mov_b32 s30, s3
    s_bfe_u32 s56, s3, 0x40012
    s_cmp_lg_u32 s36, 0
    s_cselect_b32 s56, s56, 0
    v_mfma_f32_32x32x8_bf16 v[48:63], v[92:93], v[188:189], v[48:63]
    s_mov_b32 s32, s31
    s_mov_b32 s31, s35
    v_mul_f32 v236, v24, v144
    v_fma_f32 v238, v32, v160, -v238
    v_fmac_f32 v236, v25, v145
    v_fmac_f32 v238, v33, v161
    v_fmac_f32 v236, v26, v146
    v_mfma_f32_32x32x8_bf16 v[64:79], v[88:89], v[188:189], v[64:79]
    s_setprio 0
    v_fmac_f32 v238, v34, v162
    v_fmac_f32 v236, v27, v147
    v_fmac_f32 v238, v35, v163
    v_fmac_f32 v236, v28, v148
    v_fmac_f32 v238, v36, v164
    v_fmac_f32 v236, v29, v149
    v_fmac_f32 v238, v37, v165
    v_fmac_f32 v236, v30, v150
    v_fmac_f32 v238, v38, v166
    v_fmac_f32 v236, v31, v151
    v_fmac_f32 v238, v39, v167
    v_add_u32 v249, s26, v249
    v_add_u32 v250, s26, v250
    v_mul_f32 v240, v8, v160
    v_fma_f32 v234, v16, v112, -v234
    v_fmac_f32 v240, v9, v161
    v_fmac_f32 v234, v17, v113
    v_fmac_f32 v240, v10, v162
    v_fmac_f32 v234, v18, v114
    v_fmac_f32 v240, v11, v163
    v_fmac_f32 v234, v19, v115
    v_fmac_f32 v240, v12, v164
    v_fmac_f32 v234, v20, v116
    v_fmac_f32 v240, v13, v165
    v_fmac_f32 v234, v21, v117
    v_fmac_f32 v240, v14, v166
    v_fmac_f32 v234, v22, v118
    v_fmac_f32 v240, v15, v167
    v_fmac_f32 v234, v23, v119
    ds_read_b64_tr_b16 v[0:1], v249 offset:0
    ds_read_b64_tr_b16 v[2:3], v249 offset:32
    ds_read_u16_d16_hi v40, v250 offset:0
    v_mul_f32 v241, v48, v168
    v_fma_f32 v235, v56, v120, -v235
    v_fmac_f32 v241, v49, v169
    v_fmac_f32 v235, v57, v121
    v_fmac_f32 v241, v50, v170
    v_fmac_f32 v235, v58, v122
    v_fmac_f32 v241, v51, v171
    v_fmac_f32 v235, v59, v123
    v_fmac_f32 v241, v52, v172
    v_fmac_f32 v235, v60, v124
    v_fmac_f32 v241, v53, v173
    v_fmac_f32 v235, v61, v125
    v_fmac_f32 v241, v54, v174
    v_fmac_f32 v235, v62, v126
    v_fmac_f32 v241, v55, v175
    v_fmac_f32 v235, v63, v127
    ds_read_b64_tr_b16 v[4:5], v249 offset:512
    ds_read_b64_tr_b16 v[6:7], v249 offset:544
    ds_read_u16_d16_hi v41, v250 offset:128
    v_mul_f32 v237, v64, v152
    v_fma_f32 v239, v72, v168, -v239
    v_fmac_f32 v237, v65, v153
    v_fmac_f32 v239, v73, v169
    v_fmac_f32 v237, v66, v154
    v_fmac_f32 v239, v74, v170
    v_fmac_f32 v237, v67, v155
    v_fmac_f32 v239, v75, v171
    v_fmac_f32 v237, v68, v156
    v_fmac_f32 v239, v76, v172
    v_fmac_f32 v237, v69, v157
    v_fmac_f32 v239, v77, v173
    v_fmac_f32 v237, v70, v158
    v_fmac_f32 v239, v78, v174
    v_fmac_f32 v237, v71, v159
    v_fmac_f32 v239, v79, v175
    s_cmp_eq_u32 s56, 5
    s_cbranch_scc1 K2_U21
    s_cmp_eq_u32 s56, 6
    s_cbranch_scc1 K2_U3h1
    s_branch K2_DSP1
K2_PAD_SW:
    s_branch K2_HOP
K2_DSP0:
    s_cmp_eq_u32 s56, 4
    s_cbranch_scc1 K2_U20
    s_cmp_eq_u32 s56, 7
    s_cbranch_scc1 K2_U30
    s_cmp_gt_u32 s56, 7
    s_cbranch_scc1 K2_U40
    s_cmp_lg_u32 s56, 0
    s_cbranch_scc1 K2_U10
    s_branch K2_SWITCH
K2_DSP1:
    s_cmp_eq_u32 s56, 4
    s_cbranch_scc1 K2_U2h1
    s_cmp_eq_u32 s56, 7
    s_cbranch_scc1 K2_U31
    s_cmp_gt_u32 s56, 7
    s_cbranch_scc1 K2_U41
    s_cmp_lg_u32 s56, 0
    s_cbranch_scc1 K2_U11
    s_branch K2_TAIL
K2_SWITCH:
    v_lshlrev_b32 v60, 3, v252
    s_mov_b32 s64, 7176192
    buffer_load_dwordx4 v[56:59], v60, s[8:11], s64 offen sc1
    v_permlane32_swap_b32 v236, v234
    v_permlane32_swap_b32 v237, v235
    v_permlane32_swap_b32 v240, v238
    v_permlane32_swap_b32 v241, v239
    v_add_f32 v236, v236, v234
    v_add_f32 v237, v237, v235
    v_add_f32 v240, -v240, -v238
    v_add_f32 v241, -v241, -v239
    s_set_gpr_idx_on s32, gpr_idx(DST)
    s_nop 0
    v_cvt_pk_bf16_f32 v194, v236, v237
    v_cvt_pk_bf16_f32 v195, v240, v241
    s_set_gpr_idx_off
    v_bfe_u32 v61, v253, 22, 6
    v_lshlrev_b32 v62, 21, v252
    s_mov_b32 s58, 264241152
    v_lshlrev_b32 v61, 2, v61
    v_bfi_b32 v62, s58, v62, v253
    ds_bpermute_b32 v253, v61, v62
    v_lshrrev_b32 v254, 6, v252
    v_bfe_u32 v255, v252, 3, 2
    v_lshl_add_u32 v254, v254, 2, v255
    v_mul_u32_u24 v254, 640, v254
    v_bfe_u32 v255, v252, 5, 1
    v_lshl_add_u32 v254, v255, 5, v254
    v_and_b32 v255, 6, v252
    v_lshl_add_u32 v254, v255, 2, v254
    v_add_u32 v254, 152832, v254
    ds_read_b64_tr_b16 v[104:105], v254 offset:0
    ds_read_b64_tr_b16 v[106:107], v254 offset:5120
    ds_read_b64_tr_b16 v[108:109], v254 offset:64
    ds_read_b64_tr_b16 v[110:111], v254 offset:5184
    ds_read_b64_tr_b16 v[120:121], v254 offset:128
    ds_read_b64_tr_b16 v[122:123], v254 offset:5248
    ds_read_b64_tr_b16 v[124:125], v254 offset:192
    ds_read_b64_tr_b16 v[126:127], v254 offset:5312
    ds_read_b64_tr_b16 v[136:137], v254 offset:256
    ds_read_b64_tr_b16 v[138:139], v254 offset:5376
    ds_read_b64_tr_b16 v[140:141], v254 offset:320
    ds_read_b64_tr_b16 v[142:143], v254 offset:5440
    ds_read_b64_tr_b16 v[152:153], v254 offset:384
    ds_read_b64_tr_b16 v[154:155], v254 offset:5504
    ds_read_b64_tr_b16 v[156:157], v254 offset:448
    ds_read_b64_tr_b16 v[158:159], v254 offset:5568
    ds_read_b64_tr_b16 v[168:169], v254 offset:512
    ds_read_b64_tr_b16 v[170:171], v254 offset:5632
    ds_read_b64_tr_b16 v[172:173], v254 offset:576
    ds_read_b64_tr_b16 v[174:175], v254 offset:5696
    s_movk_i32 s40, 128
    s_movk_i32 s41, 384
    s_movk_i32 s42, 640
    s_movk_i32 s43, 896
    v_lshl_add_u32 v254, v252, 1, s53
    v_lshl_add_u32 v232, v252, 1, s35
    v_lshrrev_b32 v233, 6, v252
    v_mul_u32_u24 v233, 126, v233
    s_waitcnt lgkmcnt(15)
    v_lshlrev_b32 v96, 16, v104
    v_and_b32 v97, 0xffff0000, v104
    v_lshlrev_b32 v98, 16, v105
    v_and_b32 v99, 0xffff0000, v105
    v_lshlrev_b32 v100, 16, v106
    v_and_b32 v101, 0xffff0000, v106
    v_lshlrev_b32 v102, 16, v107
    v_and_b32 v103, 0xffff0000, v107
    v_lshlrev_b32 v104, 16, v108
    v_and_b32 v105, 0xffff0000, v108
    v_lshlrev_b32 v106, 16, v109
    v_and_b32 v107, 0xffff0000, v109
    v_lshlrev_b32 v108, 16, v110
    v_and_b32 v109, 0xffff0000, v110
    v_lshlrev_b32 v110, 16, v111
    v_and_b32 v111, 0xffff0000, v111
    s_waitcnt lgkmcnt(12)
    v_lshlrev_b32 v112, 16, v120
    v_and_b32 v113, 0xffff0000, v120
    v_lshlrev_b32 v114, 16, v121
    v_and_b32 v115, 0xffff0000, v121
    v_lshlrev_b32 v116, 16, v122
    v_and_b32 v117, 0xffff0000, v122
    v_lshlrev_b32 v118, 16, v123
    v_and_b32 v119, 0xffff0000, v123
    v_lshlrev_b32 v120, 16, v124
    v_and_b32 v121, 0xffff0000, v124
    v_lshlrev_b32 v122, 16, v125
    v_and_b32 v123, 0xffff0000, v125
    v_lshlrev_b32 v124, 16, v126
    v_and_b32 v125, 0xffff0000, v126
    v_lshlrev_b32 v126, 16, v127
    v_and_b32 v127, 0xffff0000, v127
    s_waitcnt lgkmcnt(8)
    v_lshlrev_b32 v128, 16, v136
    v_and_b32 v129, 0xffff0000, v136
    v_lshlrev_b32 v130, 16, v137
    v_and_b32 v131, 0xffff0000, v137
    v_lshlrev_b32 v132, 16, v138
    v_and_b32 v133, 0xffff0000, v138
    v_lshlrev_b32 v134, 16, v139
    v_and_b32 v135, 0xffff0000, v139
    v_lshlrev_b32 v136, 16, v140
    v_and_b32 v137, 0xffff0000, v140
    v_lshlrev_b32 v138, 16, v141
    v_and_b32 v139, 0xffff0000, v141
    v_lshlrev_b32 v140, 16, v142
    v_and_b32 v141, 0xffff0000, v142
    v_lshlrev_b32 v142, 16, v143
    v_and_b32 v143, 0xffff0000, v143
    s_waitcnt lgkmcnt(4)
    v_lshlrev_b32 v144, 16, v152
    v_and_b32 v145, 0xffff0000, v152
    v_lshlrev_b32 v146, 16, v153
    v_and_b32 v147, 0xffff0000, v153
    v_lshlrev_b32 v148, 16, v154
    v_and_b32 v149, 0xffff0000, v154
    v_lshlrev_b32 v150, 16, v155
    v_and_b32 v151, 0xffff0000, v155
    v_lshlrev_b32 v152, 16, v156
    v_and_b32 v153, 0xffff0000, v156
    v_lshlrev_b32 v154, 16, v157
    v_and_b32 v155, 0xffff0000, v157
    v_lshlrev_b32 v156, 16, v158
    v_and_b32 v157, 0xffff0000, v158
    v_lshlrev_b32 v158, 16, v159
    v_and_b32 v159, 0xffff0000, v159
    s_waitcnt lgkmcnt(0)
    v_lshlrev_b32 v160, 16, v168
    v_and_b32 v161, 0xffff0000, v168
    v_lshlrev_b32 v162, 16, v169
    v_and_b32 v163, 0xffff0000, v169
    v_lshlrev_b32 v164, 16, v170
    v_and_b32 v165, 0xffff0000, v170
    v_lshlrev_b32 v166, 16, v171
    v_and_b32 v167, 0xffff0000, v171
    v_lshlrev_b32 v168, 16, v172
    v_and_b32 v169, 0xffff0000, v172
    v_lshlrev_b32 v170, 16, v173
    v_and_b32 v171, 0xffff0000, v173
    v_lshlrev_b32 v172, 16, v174
    v_and_b32 v173, 0xffff0000, v174
    v_lshlrev_b32 v174, 16, v175
    v_and_b32 v175, 0xffff0000, v175
    s_waitcnt vmcnt(0)
K2_FLGW:
    s_or_b32 s58, s54, s20
    v_xor_b32 v56, s2, v56
    v_xor_b32 v57, s2, v57
    v_xor_b32 v58, s2, v58
    v_xor_b32 v59, s2, v59
    v_or3_b32 v56, v56, v57, v58
    v_or_b32 v56, v56, v59
    v_cmp_ne_u32 vcc, 0, v56
    s_nop 0
    s_cbranch_vccnz K2_FLGR
    s_cmp_eq_u32 s58, 0
    s_cbranch_scc1 K2_FLGY
K2_FLGOK:
    s_cmp_eq_u32 s36, 0
    s_cbranch_scc1 K2_TAIL2
    s_mov_b32 s29, s48
    s_mov_b32 s32, s31
    s_mov_b32 s30, s3
    s_mov_b32 s31, s35
    s_bfe_u32 s56, s3, 0x40012
    s_cmp_eq_u32 s56, 5
    s_cbranch_scc1 K2_U21
    s_cmp_eq_u32 s56, 6
    s_cbranch_scc1 K2_U3h1
    s_branch K2_DSP1
K2_dum_4:
    v_mov_b32 v42, -1
    s_mov_b32 m0, 163312
    s_mov_b64 exec, 1
    buffer_load_dwordx4 v42, s[16:19], 0 offen lds
    buffer_load_dwordx4 v42, s[16:19], 0 offen lds
    s_mov_b64 exec, -1
    s_branch K2_back_6
K2_nul_12:
    s_mov_b32 s58, 63
    s_mov_b32 s36, 0
    s_branch K2_back_15
K2_spin_13:
    s_sub_u32 s27, s27, 1
    s_cbranch_scc1 K2_END
    ds_read_b32 v42, v254
    s_waitcnt lgkmcnt(0)
    s_branch K2_chk_14
K2_dyn_10:
    v_lshl_add_u32 v254, v252, 1, s53
    s_mov_b64 exec, 0x1ff
    ds_add_rtn_u32 v42, v254, v251
    s_mov_b64 exec, -1
    s_waitcnt lgkmcnt(0)
    v_readlane_b32 s58, v42, 8
    s_nop 0
    s_lshr_b32 s58, s58, 4
    s_cmp_lt_u32 s58, s22
    s_cbranch_scc0 K2_nul_12
    v_readlane_b32 s3, v253, s58
    s_nop 0
    s_bfe_u32 s58, s3, 0x60016
    s_and_b32 s59, s58, 7
    s_lshr_b32 s60, s58, 3
K2_chk_14:
    v_readlane_b32 s61, v42, s59
    s_nop 0
    s_cmp_gt_u32 s61, s60
    s_cbranch_scc0 K2_spin_13
K2_back_15:
    s_mov_b32 s34, 1
    s_branch K2_back_11
K2_dum_21:
    v_mov_b32 v42, -1
    s_mov_b32 m0, 163312
    s_mov_b64 exec, 1
    buffer_load_dwordx4 v42, s[16:19], 0 offen lds
    buffer_load_dwordx4 v42, s[16:19], 0 offen lds
    s_mov_b64 exec, -1
    s_branch K2_back_23
K2_nul_27:
    s_mov_b32 s58, 63
    s_mov_b32 s36, 0
    s_branch K2_back_30
K2_spin_28:
    s_sub_u32 s27, s27, 1
    s_cbranch_scc1 K2_END
    ds_read_b32 v42, v254
    s_waitcnt lgkmcnt(0)
    s_branch K2_chk_29
K2_dyn_25:
    v_lshl_add_u32 v254, v252, 1, s53
    s_mov_b64 exec, 0x1ff
    ds_add_rtn_u32 v42, v254, v251
    s_mov_b64 exec, -1
    s_waitcnt lgkmcnt(0)
    v_readlane_b32 s58, v42, 8
    s_nop 0
    s_lshr_b32 s58, s58, 4
    s_cmp_lt_u32 s58, s22
    s_cbranch_scc0 K2_nul_27
    v_readlane_b32 s3, v253, s58
    s_nop 0
    s_bfe_u32 s58, s3, 0x60016
    s_and_b32 s59, s58, 7
    s_lshr_b32 s60, s58, 3
K2_chk_29:
    v_readlane_b32 s61, v42, s59
    s_nop 0
    s_cmp_gt_u32 s61, s60
    s_cbranch_scc0 K2_spin_28
K2_back_30:
    s_mov_b32 s34, 1
    s_branch K2_back_26
K2_dum_36:
    v_mov_b32 v42, -1
    s_mov_b32 m0, 163312
    s_mov_b64 exec, 1
    buffer_load_dwordx4 v42, s[16:19], 0 offen lds
    buffer_load_dwordx4 v42, s[16:19], 0 offen lds
    s_mov_b64 exec, -1
    s_branch K2_back_38
K2_nul_42:
    s_mov_b32 s58, 63
    s_mov_b32 s36, 0
    s_branch K2_back_45
K2_spin_43:
    s_sub_u32 s27, s27, 1
    s_cbranch_scc1 K2_END
    ds_read_b32 v42, v254
    s_waitcnt lgkmcnt(0)
    s_branch K2_chk_44
K2_dyn_40:
    v_lshl_add_u32 v254, v252, 1, s53
    s_mov_b64 exec, 0x1ff
    ds_add_rtn_u32 v42, v254, v251
    s_mov_b64 exec, -1
    s_waitcnt lgkmcnt(0)
    v_readlane_b32 s58, v42, 8
    s_nop 0
    s_lshr_b32 s58, s58, 4
    s_cmp_lt_u32 s58, s22
    s_cbranch_scc0 K2_nul_42
    v_readlane_b32 s3, v253, s58
    s_nop 0
    s_bfe_u32 s58, s3, 0x60016
    s_and_b32 s59, s58, 7
    s_lshr_b32 s60, s58, 3
K2_chk_44:
    v_readlane_b32 s61, v42, s59
    s_nop 0
    s_cmp_gt_u32 s61, s60
    s_cbranch_scc0 K2_spin_43
K2_back_45:
    s_mov_b32 s34, 1
    s_branch K2_back_41
K2_dum_51:
    v_mov_b32 v42, -1
    s_mov_b32 m0, 163312
    s_mov_b64 exec, 1
    buffer_load_dwordx4 v42, s[16:19], 0 offen lds
    buffer_load_dwordx4 v42, s[16:19], 0 offen lds
    s_mov_b64 exec, -1
    s_branch K2_back_53
K2_nul_55:
    s_mov_b32 s3, 949760
    s_mov_b32 s36, 0
    s_branch K2_back_58
K2_spin_56:
    s_sub_u32 s27, s27, 1
    s_cbranch_scc1 K2_END
    ds_read_b32 v42, v254
    s_waitcnt lgkmcnt(0)
    s_branch K2_chk_57
K2_nul_64:
    s_mov_b32 s3, 949760
    s_mov_b32 s36, 0
    s_branch K2_back_67
K2_spin_65:
    s_sub_u32 s27, s27, 1
    s_cbranch_scc1 K2_END
    ds_read_b32 v42, v254
    s_waitcnt lgkmcnt(0)
    s_branch K2_chk_66
K2_nul_73:
    s_mov_b32 s3, 949760
    s_mov_b32 s36, 0
    s_branch K2_back_76
K2_spin_74:
    s_sub_u32 s27, s27, 1
    s_cbranch_scc1 K2_END
    ds_read_b32 v42, v254
    s_waitcnt lgkmcnt(0)
    s_branch K2_chk_75
K2_nul_82:
    s_mov_b32 s3, 949760
    s_mov_b32 s36, 0
    s_branch K2_back_85
K2_spin_83:
    s_sub_u32 s27, s27, 1
    s_cbranch_scc1 K2_END
    ds_read_b32 v42, v254
    s_waitcnt lgkmcnt(0)
    s_branch K2_chk_84
K2_PAD_TL:
    s_branch K2_HOP
K2_TAIL2:
    v_lshlrev_b32 v229, 3, v252
    s_mul_i32 s58, s20, 20480
    s_add_u32 s58, s58, 6946816
    s_mul_i32 s59, s20, 8224
    buffer_load_dwordx4 v[96:99], v229, s[8:11], s58 offen offset:0 sc1
    buffer_load_dwordx4 v[100:103], v229, s[8:11], s58 offen offset:1024 sc1
    buffer_load_dwordx4 v[104:107], v229, s[8:11], s58 offen offset:2048 sc1
    buffer_load_dwordx4 v[108:111], v229, s[8:11], s58 offen offset:3072 sc1
    s_add_u32 s58, s58, 4096
    buffer_load_dwordx4 v[128:131], v229, s[8:11], s58 offen offset:0 sc1
    buffer_load_dwordx4 v[132:135], v229, s[8:11], s58 offen offset:1024 sc1
    buffer_load_dwordx4 v[136:139], v229, s[8:11], s58 offen offset:2048 sc1
    buffer_load_dwordx4 v[140:143], v229, s[8:11], s58 offen offset:3072 sc1
    v_lshl_add_u32 v228, v252, 1, s59
    v_lshrrev_b32 v226, 6, v252
    v_mul_u32_u24 v226, 126, v226
    v_sub_u32 v226, v228, v226
    s_branch K2_TAIL3
K2_TAIL:
    v_lshlrev_b32 v229, 3, v252
    s_mul_i32 s58, s20, 20480
    s_add_u32 s58, s58, 6946816
    s_mul_i32 s59, s20, 8224
    buffer_load_dwordx4 v[96:99], v229, s[8:11], s58 offen offset:0 sc1
    v_permlane32_swap_b32 v236, v234
    v_permlane32_swap_b32 v237, v235
    buffer_load_dwordx4 v[100:103], v229, s[8:11], s58 offen offset:1024 sc1
    v_permlane32_swap_b32 v240, v238
    v_permlane32_swap_b32 v241, v239
    buffer_load_dwordx4 v[104:107], v229, s[8:11], s58 offen offset:2048 sc1
    v_add_f32 v236, v236, v234
    v_add_f32 v237, v237, v235
    buffer_load_dwordx4 v[108:111], v229, s[8:11], s58 offen offset:3072 sc1
    v_add_f32 v240, -v240, -v238
    v_add_f32 v241, -v241, -v239
    s_add_u32 s58, s58, 4096
    buffer_load_dwordx4 v[128:131], v229, s[8:11], s58 offen offset:0 sc1
    v_cvt_pk_bf16_f32 v236, v236, v237
    v_cvt_pk_bf16_f32 v240, v240, v241
    buffer_load_dwordx4 v[132:135], v229, s[8:11], s58 offen offset:1024 sc1
    ds_write2st64_b32 v232, v236, v240 offset0:2 offset1:3
    v_lshl_add_u32 v228, v252, 1, s59
    buffer_load_dwordx4 v[136:139], v229, s[8:11], s58 offen offset:2048 sc1
    v_lshrrev_b32 v226, 6, v252
    v_mul_u32_u24 v226, 126, v226
    buffer_load_dwordx4 v[140:143], v229, s[8:11], s58 offen offset:3072 sc1
    v_sub_u32 v226, v228, v226
K2_TAIL3:
    s_waitcnt vmcnt(8)
    ds_write2st64_b32 v228, v192, v193 offset0:0 offset1:1
    ds_write2st64_b32 v228, v194, v195 offset0:2 offset1:3
    s_add_u32 s58, s58, 4096
    buffer_load_dwordx4 v[112:115], v229, s[8:11], s58 offen offset:0 sc1
    v_bfe_u32 v48, v252, 1, 4
    v_lshrrev_b32 v49, 5, v252
    ds_write_b16 v226, v197 offset:1280
    ds_write2st64_b32 v228, v196, v198 offset0:4 offset1:6
    buffer_load_dwordx4 v[116:119], v229, s[8:11], s58 offen offset:1024 sc1
    v_lshrrev_b32 v55, 3, v48
    v_lshlrev_b32 v52, 4, v49
    ds_write2st64_b32 v228, v199, v200 offset0:7 offset1:8
    ds_write2st64_b32 v228, v201, v202 offset0:9 offset1:10
    buffer_load_dwordx4 v[120:123], v229, s[8:11], s58 offen offset:2048 sc1
    v_and_b32 v54, 7, v48
    v_and_b32 v50, 7, v48
    ds_write_b16 v226, v203 offset:2816
    ds_write2st64_b32 v228, v204, v205 offset0:12 offset1:13
    buffer_load_dwordx4 v[124:127], v229, s[8:11], s58 offen offset:3072 sc1
    v_mul_u32_u24 v50, 8224, v50
    v_mul_u32_u24 v51, 1536, v55
    ds_write2st64_b32 v228, v206, v207 offset0:14 offset1:15
    ds_write2st64_b32 v228, v208, v210 offset0:16 offset1:18
    s_add_u32 s58, s58, 4096
    buffer_load_dwordx4 v[144:147], v229, s[8:11], s58 offen offset:0 sc1
    v_add_u32 v50, v50, v51
    v_add_u32 v222, v50, v52
    ds_write_b16 v226, v209 offset:4352
    ds_write2st64_b32 v228, v211, v212 offset0:19 offset1:20
    buffer_load_dwordx4 v[148:151], v229, s[8:11], s58 offen offset:1024 sc1
    v_mul_u32_u24 v51, 8224, v54
    v_add_u32 v232, v51, v52
    ds_write2st64_b32 v228, v213, v214 offset0:21 offset1:22
    ds_write2st64_b32 v228, v216, v217 offset0:24 offset1:25
    buffer_load_dwordx4 v[152:155], v229, s[8:11], s58 offen offset:2048 sc1
    v_lshl_add_u32 v247, v55, 8, v232
    v_mul_u32_u24 v51, 2080, v48
    ds_write_b16 v226, v215 offset:5888
    ds_write2st64_b32 v228, v218, v219 offset0:26 offset1:27
    buffer_load_dwordx4 v[156:159], v229, s[8:11], s58 offen offset:3072 sc1
    s_mov_b32 s60, 65536
    v_add3_u32 v223, v51, v52, s60
    ds_write_b32 v228, v220 offset:7168
    ds_write_b16 v226, v221 offset:7424
    s_add_u32 s58, s58, 4096
    buffer_load_dwordx4 v[160:163], v229, s[8:11], s58 offen offset:0 sc1
    v_mul_u32_u24 v51, 2080, v54
    s_mov_b32 s60, 132096
    buffer_load_dwordx4 v[164:167], v229, s[8:11], s58 offen offset:1024 sc1
    v_add3_u32 v225, v51, v52, s60
    v_lshl_add_u32 v248, v55, 8, v225
    buffer_load_dwordx4 v[168:171], v229, s[8:11], s58 offen offset:2048 sc1
    s_lshl_b32 s60, s20, 5
    v_lshl_add_u32 v49, v49, 3, s60
    buffer_load_dwordx4 v[172:175], v229, s[8:11], s58 offen offset:3072 sc1
    s_mov_b32 s60, 65536
    v_add3_u32 v255, v51, v49, s60
    v_lshl_add_u32 v246, v55, 9, v255
    v_bfe_u32 v53, v48, 2, 1
    v_lshl_add_u32 v49, v53, 4, v49
    v_add_u32 v254, v50, v49
    s_and_b32 s64, s55, s28
    s_waitcnt lgkmcnt(0)
    s_barrier
    s_cmp_eq_u32 s64, 0
    s_cbranch_scc1 K2_MULTI
    s_setprio 3
    ds_read_b128 v[48:51], v222 offset:0
    ds_read_b128 v[52:55], v222 offset:64
    ds_read_b128 v[56:59], v222 offset:640
    ds_read_b128 v[60:63], v222 offset:704
    ds_read_b128 v[64:67], v223 offset:0
    ds_read_b128 v[68:71], v223 offset:64
    ds_read_b128 v[72:75], v223 offset:640
    ds_read_b128 v[76:79], v223 offset:704
    ds_read_b128 v[80:83], v222 offset:3072
    ds_read_b128 v[84:87], v222 offset:3136
    ds_read_b128 v[88:91], v222 offset:3712
    s_waitcnt vmcnt(19) lgkmcnt(9)
    v_mfma_f32_16x16x32_bf16 v[0:3], v[96:99], v[48:51], 0
    ds_read_b128 v[92:95], v222 offset:3776
    s_waitcnt vmcnt(18)
    v_mfma_f32_16x16x32_bf16 v[0:3], v[100:103], v[52:55], v[0:3]
    ds_read_b128 v[48:51], v223 offset:33280
    s_waitcnt vmcnt(17) lgkmcnt(9)
    v_mfma_f32_16x16x32_bf16 v[0:3], v[104:107], v[56:59], v[0:3]
    s_bfe_u32 s60, s20, 0x10002
    s_lshl_b32 s60, s60, 4
    ds_read_b128 v[52:55], v223 offset:33344
    s_waitcnt vmcnt(16)
    v_mfma_f32_16x16x32_bf16 v[0:3], v[108:111], v[60:63], v[0:3]
    s_add_u32 s59, s59, s60
    v_add_u32 v228, s59, v229
    ds_read_b128 v[56:59], v223 offset:33920
    s_waitcnt vmcnt(15) lgkmcnt(9)
    v_mfma_f32_16x16x32_bf16 v[0:3], v[128:131], v[64:67], v[0:3]
    s_mul_i32 s60, s20, 2080
    s_add_u32 s60, s60, 65536
    ds_read_b128 v[60:63], v223 offset:33984
    s_waitcnt vmcnt(14)
    v_mfma_f32_16x16x32_bf16 v[0:3], v[132:135], v[68:71], v[0:3]
    v_add_u32 v249, s60, v229
    s_mov_b32 s63, 0xbfb8aa3b
    ds_read_b128 v[64:67], v232 offset:6144
    s_waitcnt vmcnt(13) lgkmcnt(9)
    v_mfma_f32_16x16x32_bf16 v[0:3], v[136:139], v[72:75], v[0:3]
    s_add_u32 s40, s20, s21
    s_lshl_b32 s40, s40, 10
    ds_read_b128 v[68:71], v232 offset:6208
    s_waitcnt vmcnt(12)
    v_mfma_f32_16x16x32_bf16 v[0:3], v[140:143], v[76:79], v[0:3]
    s_add_u32 s41, s40, 8192
    s_add_u32 s42, s40, 16384
    ds_read_b128 v[72:75], v232 offset:6784
    s_waitcnt lgkmcnt(9)
    v_mfma_f32_16x16x32_bf16 v[16:19], v[96:99], v[80:83], 0
    s_add_u32 s43, s40, 24576
    s_add_u32 s44, s40, 32768
    ds_read_b128 v[76:79], v232 offset:6848
    v_mfma_f32_16x16x32_bf16 v[16:19], v[100:103], v[84:87], v[16:19]
    ds_read_b128 v[80:83], v225 offset:0
    s_waitcnt lgkmcnt(9)
    v_mfma_f32_16x16x32_bf16 v[16:19], v[104:107], v[88:91], v[16:19]
    ds_read_b128 v[84:87], v225 offset:64
    v_mfma_f32_16x16x32_bf16 v[16:19], v[108:111], v[92:95], v[16:19]
    v_mul_f32 v204, s63, v0
    v_mul_f32 v205, s63, v1
    ds_read_b128 v[88:91], v225 offset:640
    s_waitcnt lgkmcnt(9)
    v_mfma_f32_16x16x32_bf16 v[16:19], v[128:131], v[48:51], v[16:19]
    v_mul_f32 v206, s63, v2
    ds_read_b128 v[92:95], v225 offset:704
    v_mfma_f32_16x16x32_bf16 v[16:19], v[132:135], v[52:55], v[16:19]
    v_mul_f32 v207, s63, v3
    ds_read_b128 v[48:51], v222 offset:128
    s_waitcnt lgkmcnt(9)
    v_mfma_f32_16x16x32_bf16 v[16:19], v[136:139], v[56:59], v[16:19]
    v_exp_f32 v204, v204
    ds_read_b128 v[52:55], v222 offset:1280
    v_mfma_f32_16x16x32_bf16 v[16:19], v[140:143], v[60:63], v[16:19]
    v_exp_f32 v205, v205
    ds_read_b128 v[56:59], v222 offset:384
    s_waitcnt lgkmcnt(9)
    v_mfma_f32_16x16x32_bf16 v[32:35], v[96:99], v[64:67], 0
    v_exp_f32 v206, v206
    ds_read_b128 v[60:63], v222 offset:192
    v_mfma_f32_16x16x32_bf16 v[32:35], v[100:103], v[68:71], v[32:35]
    v_exp_f32 v207, v207
    s_setprio 2
    ds_read_b128 v[64:67], v222 offset:1344
    s_waitcnt lgkmcnt(9)
    v_mfma_f32_16x16x32_bf16 v[32:35], v[104:107], v[72:75], v[32:35]
    v_add_f32 v204, 1.0, v204
    ds_read_b128 v[68:71], v222 offset:448
    v_mfma_f32_16x16x32_bf16 v[32:35], v[108:111], v[76:79], v[32:35]
    v_add_f32 v205, 1.0, v205
    v_add_f32 v206, 1.0, v206
    ds_read_b128 v[72:75], v222 offset:256
    s_waitcnt lgkmcnt(9)
    v_mfma_f32_16x16x32_bf16 v[32:35], v[128:131], v[80:83], v[32:35]
    v_add_f32 v207, 1.0, v207
    ds_read_b128 v[76:79], v222 offset:1152
    v_mfma_f32_16x16x32_bf16 v[32:35], v[132:135], v[84:87], v[32:35]
    v_rcp_f32 v204, v204
    ds_read_b128 v[80:83], v222 offset:512
    s_waitcnt lgkmcnt(9)
    v_mfma_f32_16x16x32_bf16 v[32:35], v[136:139], v[88:91], v[32:35]
    v_rcp_f32 v205, v205
    ds_read_b128 v[84:87], v222 offset:320
    v_mfma_f32_16x16x32_bf16 v[32:35], v[140:143], v[92:95], v[32:35]
    v_rcp_f32 v206, v206
    ds_read_b128 v[88:91], v222 offset:1216
    s_waitcnt vmcnt(11) lgkmcnt(9)
    v_mfma_f32_16x16x32_bf16 v[4:7], v[112:115], v[48:51], 0
    v_rcp_f32 v207, v207
    ds_read_b128 v[92:95], v222 offset:576
    v_mfma_f32_16x16x32_bf16 v[8:11], v[112:115], v[52:55], 0
    v_cvt_pk_bf16_f32 v176, v0, v1
    ds_read_b128 v[48:51], v222 offset:768
    s_waitcnt lgkmcnt(9)
    v_mfma_f32_16x16x32_bf16 v[12:15], v[112:115], v[56:59], 0
    v_cvt_pk_bf16_f32 v177, v2, v3
    ds_read_b128 v[52:55], v222 offset:896
    s_waitcnt vmcnt(10)
    v_mfma_f32_16x16x32_bf16 v[4:7], v[116:119], v[60:63], v[4:7]
    v_mul_f32 v208, s63, v16
    v_mul_f32 v209, s63, v17
    ds_read_b128 v[56:59], v222 offset:1024
    s_waitcnt lgkmcnt(9)
    v_mfma_f32_16x16x32_bf16 v[8:11], v[116:119], v[64:67], v[8:11]
    v_mul_f32 v210, s63, v18
    ds_read_b128 v[60:63], v222 offset:832
    v_mfma_f32_16x16x32_bf16 v[12:15], v[116:119], v[68:71], v[12:15]
    v_mul_f32 v211, s63, v19
    ds_read_b128 v[64:67], v222 offset:960
    s_waitcnt vmcnt(9) lgkmcnt(9)
    v_mfma_f32_16x16x32_bf16 v[4:7], v[120:123], v[72:75], v[4:7]
    v_exp_f32 v208, v208
    ds_read_b128 v[68:71], v222 offset:1088
    v_mfma_f32_16x16x32_bf16 v[8:11], v[120:123], v[76:79], v[8:11]
    v_exp_f32 v209, v209
    ds_read_b128 v[72:75], v223 offset:128
    s_waitcnt lgkmcnt(9)
    v_mfma_f32_16x16x32_bf16 v[12:15], v[120:123], v[80:83], v[12:15]
    v_exp_f32 v210, v210
    ds_read_b128 v[76:79], v223 offset:1280
    s_waitcnt vmcnt(8)
    v_mfma_f32_16x16x32_bf16 v[4:7], v[124:127], v[84:87], v[4:7]
    v_exp_f32 v211, v211
    ds_read_b128 v[80:83], v223 offset:384
    s_waitcnt lgkmcnt(9)
    v_mfma_f32_16x16x32_bf16 v[8:11], v[124:127], v[88:91], v[8:11]
    v_add_f32 v208, 1.0, v208
    ds_read_b128 v[84:87], v223 offset:192
    v_mfma_f32_16x16x32_bf16 v[12:15], v[124:127], v[92:95], v[12:15]
    v_add_f32 v209, 1.0, v209
    v_add_f32 v210, 1.0, v210
    ds_read_b128 v[88:91], v223 offset:1344
    s_waitcnt vmcnt(7) lgkmcnt(9)
    v_mfma_f32_16x16x32_bf16 v[4:7], v[144:147], v[48:51], v[4:7]
    v_add_f32 v211, 1.0, v211
    s_setprio 1
    ds_read_b128 v[92:95], v223 offset:448
    v_mfma_f32_16x16x32_bf16 v[8:11], v[144:147], v[52:55], v[8:11]
    v_rcp_f32 v208, v208
    ds_read_b128 v[48:51], v223 offset:256
    s_waitcnt lgkmcnt(9)
    v_mfma_f32_16x16x32_bf16 v[12:15], v[144:147], v[56:59], v[12:15]
    v_rcp_f32 v209, v209
    ds_read_b128 v[52:55], v223 offset:1152
    s_waitcnt vmcnt(6)
    v_mfma_f32_16x16x32_bf16 v[4:7], v[148:151], v[60:63], v[4:7]
    v_rcp_f32 v210, v210
    ds_read_b128 v[56:59], v223 offset:512
    s_waitcnt lgkmcnt(9)
    v_mfma_f32_16x16x32_bf16 v[8:11], v[148:151], v[64:67], v[8:11]
    v_rcp_f32 v211, v211
    ds_read_b128 v[60:63], v223 offset:320
    v_mfma_f32_16x16x32_bf16 v[12:15], v[148:151], v[68:71], v[12:15]
K2_PAD_T2:
    s_cbranch_execz K2_HOP
    v_cvt_pk_bf16_f32 v184, v16, v17
    ds_read_b128 v[64:67], v223 offset:1216
    s_waitcnt vmcnt(5) lgkmcnt(9)
    v_mfma_f32_16x16x32_bf16 v[4:7], v[152:155], v[72:75], v[4:7]
    v_cvt_pk_bf16_f32 v185, v18, v19
    ds_read_b128 v[68:71], v223 offset:576
    v_mfma_f32_16x16x32_bf16 v[8:11], v[152:155], v[76:79], v[8:11]
    v_mul_f32 v212, s63, v32
    v_mul_f32 v213, s63, v33
    ds_read_b128 v[72:75], v223 offset:768
    s_waitcnt lgkmcnt(9)
    v_mfma_f32_16x16x32_bf16 v[12:15], v[152:155], v[80:83], v[12:15]
    v_mul_f32 v214, s63, v34
    ds_read_b128 v[76:79], v223 offset:896
    s_waitcnt vmcnt(4)
    v_mfma_f32_16x16x32_bf16 v[4:7], v[156:159], v[84:87], v[4:7]
    v_mul_f32 v215, s63, v35
    ds_read_b128 v[80:83], v223 offset:1024
    s_waitcnt lgkmcnt(9)
    v_mfma_f32_16x16x32_bf16 v[8:11], v[156:159], v[88:91], v[8:11]
    v_exp_f32 v212, v212
    ds_read_b128 v[84:87], v223 offset:832
    v_mfma_f32_16x16x32_bf16 v[12:15], v[156:159], v[92:95], v[12:15]
    v_exp_f32 v213, v213
    ds_read_b128 v[88:91], v223 offset:960
    s_waitcnt vmcnt(3) lgkmcnt(9)
    v_mfma_f32_16x16x32_bf16 v[4:7], v[160:163], v[48:51], v[4:7]
    v_exp_f32 v214, v214
    ds_read_b128 v[92:95], v223 offset:1088
    v_mfma_f32_16x16x32_bf16 v[8:11], v[160:163], v[52:55], v[8:11]
    v_exp_f32 v215, v215
    ds_read_b128 v[48:51], v222 offset:3200
    s_waitcnt lgkmcnt(9)
    v_mfma_f32_16x16x32_bf16 v[12:15], v[160:163], v[56:59], v[12:15]
    v_add_f32 v212, 1.0, v212
    ds_read_b128 v[52:55], v222 offset:4352
    s_waitcnt vmcnt(2)
    v_mfma_f32_16x16x32_bf16 v[4:7], v[164:167], v[60:63], v[4:7]
    v_add_f32 v213, 1.0, v213
    v_add_f32 v214, 1.0, v214
    ds_read_b128 v[56:59], v222 offset:3456
    s_waitcnt lgkmcnt(9)
    v_mfma_f32_16x16x32_bf16 v[8:11], v[164:167], v[64:67], v[8:11]
    v_add_f32 v215, 1.0, v215
    ds_read_b128 v[60:63], v222 offset:3264
    v_mfma_f32_16x16x32_bf16 v[12:15], v[164:167], v[68:71], v[12:15]
    v_rcp_f32 v212, v212
    s_setprio 0
    ds_read_b128 v[64:67], v222 offset:4416
    s_waitcnt vmcnt(1) lgkmcnt(9)
    v_mfma_f32_16x16x32_bf16 v[4:7], v[168:171], v[72:75], v[4:7]
    v_rcp_f32 v213, v213
    ds_read_b128 v[68:71], v222 offset:3520
    v_mfma_f32_16x16x32_bf16 v[8:11], v[168:171], v[76:79], v[8:11]
    v_rcp_f32 v214, v214
    ds_read_b128 v[72:75], v222 offset:3328
    s_waitcnt lgkmcnt(9)
    v_mfma_f32_16x16x32_bf16 v[12:15], v[168:171], v[80:83], v[12:15]
    v_rcp_f32 v215, v215
    ds_read_b128 v[76:79], v222 offset:4224
    s_waitcnt vmcnt(0)
    v_mfma_f32_16x16x32_bf16 v[4:7], v[172:175], v[84:87], v[4:7]
    v_cvt_pk_bf16_f32 v220, v32, v33
    ds_read_b128 v[80:83], v222 offset:3584
    s_waitcnt lgkmcnt(9)
    v_mfma_f32_16x16x32_bf16 v[8:11], v[172:175], v[88:91], v[8:11]
    v_cvt_pk_bf16_f32 v221, v34, v35
    ds_read_b128 v[84:87], v222 offset:3392
    v_mfma_f32_16x16x32_bf16 v[12:15], v[172:175], v[92:95], v[12:15]
    ds_read_b128 v[88:91], v222 offset:4288
    s_waitcnt lgkmcnt(9)
    v_mfma_f32_16x16x32_bf16 v[20:23], v[112:115], v[48:51], 0
    ds_read_b128 v[92:95], v222 offset:3648
    v_mfma_f32_16x16x32_bf16 v[24:27], v[112:115], v[52:55], 0
    ds_read_b128 v[48:51], v222 offset:3840
    s_waitcnt lgkmcnt(9)
    v_mfma_f32_16x16x32_bf16 v[28:31], v[112:115], v[56:59], 0
    s_barrier
    s_setprio 3
    ds_read_b128 v[52:55], v222 offset:3968
    v_mfma_f32_16x16x32_bf16 v[20:23], v[116:119], v[60:63], v[20:23]
    v_mul_f32 v4, v4, v204
    ds_read_b128 v[56:59], v222 offset:4096
    s_waitcnt lgkmcnt(9)
    v_mfma_f32_16x16x32_bf16 v[24:27], v[116:119], v[64:67], v[24:27]
    v_mul_f32 v5, v5, v205
    ds_read_b128 v[60:63], v222 offset:3904
    v_mfma_f32_16x16x32_bf16 v[28:31], v[116:119], v[68:71], v[28:31]
    v_mul_f32 v6, v6, v206
    ds_read_b128 v[64:67], v222 offset:4032
    s_waitcnt lgkmcnt(9)
    v_mfma_f32_16x16x32_bf16 v[20:23], v[120:123], v[72:75], v[20:23]
    v_mul_f32 v7, v7, v207
    ds_read_b128 v[68:71], v222 offset:4160
    v_mfma_f32_16x16x32_bf16 v[24:27], v[120:123], v[76:79], v[24:27]
    v_cvt_pk_bf16_f32 v178, v4, v5
    ds_read_b128 v[72:75], v223 offset:33408
    s_waitcnt lgkmcnt(9)
    v_mfma_f32_16x16x32_bf16 v[28:31], v[120:123], v[80:83], v[28:31]
    v_cvt_pk_bf16_f32 v179, v6, v7
    ds_read_b128 v[76:79], v223 offset:34560
    v_mfma_f32_16x16x32_bf16 v[20:23], v[124:127], v[84:87], v[20:23]
    v_mul_f32 v8, v8, v204
    ds_read_b128 v[80:83], v223 offset:33664
    s_waitcnt lgkmcnt(9)
    v_mfma_f32_16x16x32_bf16 v[24:27], v[124:127], v[88:91], v[24:27]
    v_mul_f32 v9, v9, v205
    ds_read_b128 v[84:87], v223 offset:33472
    v_mfma_f32_16x16x32_bf16 v[28:31], v[124:127], v[92:95], v[28:31]
    v_mul_f32 v10, v10, v206
    ds_read_b128 v[88:91], v223 offset:34624
    s_waitcnt lgkmcnt(9)
    v_mfma_f32_16x16x32_bf16 v[20:23], v[144:147], v[48:51], v[20:23]
    v_mul_f32 v11, v11, v207
    s_setprio 2
    ds_read_b128 v[92:95], v223 offset:33728
    v_mfma_f32_16x16x32_bf16 v[24:27], v[144:147], v[52:55], v[24:27]
    v_cvt_pk_bf16_f32 v180, v8, v9
    ds_read_b128 v[48:51], v223 offset:33536
    s_waitcnt lgkmcnt(9)
    v_mfma_f32_16x16x32_bf16 v[28:31], v[144:147], v[56:59], v[28:31]
    v_cvt_pk_bf16_f32 v181, v10, v11
    ds_read_b128 v[52:55], v223 offset:34432
    v_mfma_f32_16x16x32_bf16 v[20:23], v[148:151], v[60:63], v[20:23]
    v_mul_f32 v12, v12, v204
    ds_read_b128 v[56:59], v223 offset:33792
    s_waitcnt lgkmcnt(9)
    v_mfma_f32_16x16x32_bf16 v[24:27], v[148:151], v[64:67], v[24:27]
    v_mul_f32 v13, v13, v205
    ds_read_b128 v[60:63], v223 offset:33600
    v_mfma_f32_16x16x32_bf16 v[28:31], v[148:151], v[68:71], v[28:31]
    v_mul_f32 v14, v14, v206
    ds_read_b128 v[64:67], v223 offset:34496
    s_waitcnt lgkmcnt(9)
    v_mfma_f32_16x16x32_bf16 v[20:23], v[152:155], v[72:75], v[20:23]
    v_mul_f32 v15, v15, v207
    ds_read_b128 v[68:71], v223 offset:33856
    v_mfma_f32_16x16x32_bf16 v[24:27], v[152:155], v[76:79], v[24:27]
    v_cvt_pk_bf16_f32 v182, v12, v13
    ds_read_b128 v[72:75], v223 offset:34048
    s_waitcnt lgkmcnt(9)
    v_mfma_f32_16x16x32_bf16 v[28:31], v[152:155], v[80:83], v[28:31]
    v_cvt_pk_bf16_f32 v183, v14, v15
    ds_read_b128 v[76:79], v223 offset:34176
    v_mfma_f32_16x16x32_bf16 v[20:23], v[156:159], v[84:87], v[20:23]
    ds_write_b64 v254, v[176:177] offset:0
    ds_write_b64 v254, v[178:179] offset:256
    ds_write_b64 v254, v[180:181] offset:512
    ds_write_b64 v254, v[182:183] offset:768
    ds_write_b64 v255, v[220:221] offset:0
    ds_read_b128 v[80:83], v223 offset:34304
    s_waitcnt lgkmcnt(14)
    v_mfma_f32_16x16x32_bf16 v[24:27], v[156:159], v[88:91], v[24:27]
    ds_read_b128 v[84:87], v223 offset:34112
    v_mfma_f32_16x16x32_bf16 v[28:31], v[156:159], v[92:95], v[28:31]
    s_setprio 1
    ds_read_b128 v[88:91], v223 offset:34240
    s_waitcnt lgkmcnt(14)
    v_mfma_f32_16x16x32_bf16 v[20:23], v[160:163], v[48:51], v[20:23]
    ds_read_b128 v[92:95], v223 offset:34368
    v_mfma_f32_16x16x32_bf16 v[24:27], v[160:163], v[52:55], v[24:27]
    ds_read_b128 v[48:51], v247 offset:6272
    s_waitcnt lgkmcnt(14)
    v_mfma_f32_16x16x32_bf16 v[28:31], v[160:163], v[56:59], v[28:31]
    ds_read_b128 v[52:55], v232 offset:7424
    v_mfma_f32_16x16x32_bf16 v[20:23], v[164:167], v[60:63], v[20:23]
    ds_read_b128 v[56:59], v247 offset:6336
    s_waitcnt lgkmcnt(14)
    v_mfma_f32_16x16x32_bf16 v[24:27], v[164:167], v[64:67], v[24:27]
    ds_read_b128 v[60:63], v232 offset:7488
    v_mfma_f32_16x16x32_bf16 v[28:31], v[164:167], v[68:71], v[28:31]
    ds_read_b128 v[64:67], v247 offset:6400
    s_waitcnt lgkmcnt(14)
    v_mfma_f32_16x16x32_bf16 v[20:23], v[168:171], v[72:75], v[20:23]
    ds_read_b128 v[68:71], v232 offset:7296
    v_mfma_f32_16x16x32_bf16 v[24:27], v[168:171], v[76:79], v[24:27]
    ds_read_b128 v[72:75], v247 offset:6464
    s_waitcnt lgkmcnt(9)
    v_mfma_f32_16x16x32_bf16 v[28:31], v[168:171], v[80:83], v[28:31]
    ds_read_b128 v[76:79], v232 offset:7360
    v_mfma_f32_16x16x32_bf16 v[20:23], v[172:175], v[84:87], v[20:23]
    s_setprio 0
    ds_read_b128 v[80:83], v247 offset:6912
    s_waitcnt lgkmcnt(9)
    v_mfma_f32_16x16x32_bf16 v[24:27], v[172:175], v[88:91], v[24:27]
    ds_read_b128 v[84:87], v232 offset:7040
    v_mfma_f32_16x16x32_bf16 v[28:31], v[172:175], v[92:95], v[28:31]
    ds_read_b128 v[88:91], v247 offset:6976
    s_waitcnt lgkmcnt(9)
    v_mfma_f32_16x16x32_bf16 v[36:39], v[112:115], v[48:51], 0
    ds_read_b128 v[92:95], v232 offset:7104
    v_mfma_f32_16x16x32_bf16 v[40:43], v[112:115], v[52:55], 0
    ds_read_b128 v[48:51], v248 offset:128
    s_waitcnt lgkmcnt(9)
    v_mfma_f32_16x16x32_bf16 v[36:39], v[116:119], v[56:59], v[36:39]
    s_barrier
    ds_read_b128 v[192:195], v228 offset:0
    ds_read_b128 v[196:199], v228 offset:1536
    s_setprio 3
    ds_read_b128 v[52:55], v225 offset:1280
    v_mfma_f32_16x16x32_bf16 v[40:43], v[116:119], v[60:63], v[40:43]
    v_mul_f32 v20, v20, v208
    v_mul_f32 v21, v21, v209
    ds_read_b128 v[56:59], v248 offset:192
    s_waitcnt lgkmcnt(11)
    v_mfma_f32_16x16x32_bf16 v[36:39], v[120:123], v[64:67], v[36:39]
    v_mul_f32 v22, v22, v210
    ds_read_b128 v[60:63], v225 offset:1344
    v_mfma_f32_16x16x32_bf16 v[40:43], v[120:123], v[68:71], v[40:43]
    v_mul_f32 v23, v23, v211
    ds_read_b128 v[64:67], v248 offset:256
    s_waitcnt lgkmcnt(11)
    v_mfma_f32_16x16x32_bf16 v[36:39], v[124:127], v[72:75], v[36:39]
    v_cvt_pk_bf16_f32 v186, v20, v21
    ds_read_b128 v[68:71], v225 offset:1152
    v_mfma_f32_16x16x32_bf16 v[40:43], v[124:127], v[76:79], v[40:43]
    v_cvt_pk_bf16_f32 v187, v22, v23
    ds_read_b128 v[72:75], v248 offset:320
    s_waitcnt lgkmcnt(11)
    v_mfma_f32_16x16x32_bf16 v[36:39], v[144:147], v[80:83], v[36:39]
    v_mul_f32 v24, v24, v208
    v_mul_f32 v25, v25, v209
    s_waitcnt lgkmcnt(6)
    buffer_store_dwordx4 v[192:195], v229, s[12:15], s40 offen sc1
    buffer_store_dwordx4 v[196:199], v229, s[12:15], s41 offen sc1
    s_setprio 2
    ds_read_b128 v[76:79], v225 offset:1216
    v_mfma_f32_16x16x32_bf16 v[40:43], v[144:147], v[84:87], v[40:43]
    v_mul_f32 v26, v26, v210
    ds_read_b128 v[80:83], v248 offset:768
    v_mfma_f32_16x16x32_bf16 v[36:39], v[148:151], v[88:91], v[36:39]
    v_mul_f32 v27, v27, v211
    ds_read_b128 v[84:87], v225 offset:896
    v_mfma_f32_16x16x32_bf16 v[40:43], v[148:151], v[92:95], v[40:43]
    v_cvt_pk_bf16_f32 v188, v24, v25
    ds_read_b128 v[88:91], v248 offset:832
    s_waitcnt lgkmcnt(9)
    v_mfma_f32_16x16x32_bf16 v[36:39], v[152:155], v[48:51], v[36:39]
    v_cvt_pk_bf16_f32 v189, v26, v27
    ds_read_b128 v[92:95], v225 offset:960
    v_mfma_f32_16x16x32_bf16 v[40:43], v[152:155], v[52:55], v[40:43]
    v_mul_f32 v28, v28, v208
    v_mul_f32 v29, v29, v209
    s_waitcnt lgkmcnt(8)
    v_mfma_f32_16x16x32_bf16 v[36:39], v[156:159], v[56:59], v[36:39]
    v_mul_f32 v30, v30, v210
    v_mfma_f32_16x16x32_bf16 v[40:43], v[156:159], v[60:63], v[40:43]
    v_mul_f32 v31, v31, v211
    s_setprio 1
    s_waitcnt lgkmcnt(6)
    v_mfma_f32_16x16x32_bf16 v[36:39], v[160:163], v[64:67], v[36:39]
    v_cvt_pk_bf16_f32 v190, v28, v29
    v_mfma_f32_16x16x32_bf16 v[40:43], v[160:163], v[68:71], v[40:43]
    v_cvt_pk_bf16_f32 v191, v30, v31
    s_waitcnt lgkmcnt(4)
    v_mfma_f32_16x16x32_bf16 v[36:39], v[164:167], v[72:75], v[36:39]
    ds_write_b64 v254, v[184:185] offset:3072
    ds_write_b64 v254, v[186:187] offset:3328
    ds_write_b64 v254, v[188:189] offset:3584
    ds_write_b64 v254, v[190:191] offset:3840
    v_mfma_f32_16x16x32_bf16 v[40:43], v[164:167], v[76:79], v[40:43]
    s_waitcnt lgkmcnt(6)
    v_mfma_f32_16x16x32_bf16 v[36:39], v[168:171], v[80:83], v[36:39]
    v_mfma_f32_16x16x32_bf16 v[40:43], v[168:171], v[84:87], v[40:43]
    s_setprio 0
    s_waitcnt lgkmcnt(4)
    v_mfma_f32_16x16x32_bf16 v[36:39], v[172:175], v[88:91], v[36:39]
    v_mfma_f32_16x16x32_bf16 v[40:43], v[172:175], v[92:95], v[40:43]
    s_nop 6
    v_mul_f32 v36, v36, v212
    v_mul_f32 v37, v37, v213
    v_mul_f32 v38, v38, v214
    v_mul_f32 v39, v39, v215
    v_cvt_pk_bf16_f32 v178, v36, v37
    v_cvt_pk_bf16_f32 v179, v38, v39
    v_mul_f32 v40, v40, v212
    v_mul_f32 v41, v41, v213
    v_mul_f32 v42, v42, v214
    v_mul_f32 v43, v43, v215
    v_cvt_pk_bf16_f32 v180, v40, v41
    v_cvt_pk_bf16_f32 v181, v42, v43
    ds_write_b64 v246, v[178:179] offset:256
    ds_write_b64 v255, v[180:181] offset:512
    s_waitcnt lgkmcnt(0)
    s_barrier
    ds_read_b128 v[192:195], v228 offset:3072
    ds_read_b128 v[196:199], v228 offset:4608
    ds_read_b128 v[200:203], v249
    s_waitcnt lgkmcnt(1)
    buffer_store_dwordx4 v[192:195], v229, s[12:15], s42 offen sc1
    buffer_store_dwordx4 v[196:199], v229, s[12:15], s43 offen sc1
K2_LASTROW:
    s_add_u32 s59, s20, 32
    s_cmp_ge_u32 s59, s22
    s_cbranch_scc1 K2_FIN
    s_waitcnt lgkmcnt(0)
    buffer_store_dwordx4 v[200:203], v229, s[12:15], s44 offen sc1
K2_FIN:
    s_endpgm
K2_MULTI:
    ds_read_b128 v[48:51], v222 offset:0
    ds_read_b128 v[52:55], v222 offset:64
    ds_read_b128 v[56:59], v222 offset:640
    ds_read_b128 v[60:63], v222 offset:704
    ds_read_b128 v[64:67], v223 offset:0
    ds_read_b128 v[68:71], v223 offset:64
    ds_read_b128 v[72:75], v223 offset:640
    ds_read_b128 v[76:79], v223 offset:704
    ds_read_b128 v[80:83], v222 offset:3072
    ds_read_b128 v[84:87], v222 offset:3136
    ds_read_b128 v[88:91], v222 offset:3712
    s_waitcnt vmcnt(19) lgkmcnt(9)
    v_mfma_f32_16x16x32_bf16 v[0:3], v[96:99], v[48:51], 0
    ds_read_b128 v[92:95], v222 offset:3776
    s_waitcnt vmcnt(18)
    v_mfma_f32_16x16x32_bf16 v[0:3], v[100:103], v[52:55], v[0:3]
    ds_read_b128 v[48:51], v223 offset:33280
    s_waitcnt vmcnt(17) lgkmcnt(9)
    v_mfma_f32_16x16x32_bf16 v[0:3], v[104:107], v[56:59], v[0:3]
    ds_read_b128 v[52:55], v223 offset:33344
    s_waitcnt vmcnt(16)
    v_mfma_f32_16x16x32_bf16 v[0:3], v[108:111], v[60:63], v[0:3]
    ds_read_b128 v[56:59], v223 offset:33920
    s_waitcnt vmcnt(15) lgkmcnt(9)
    v_mfma_f32_16x16x32_bf16 v[0:3], v[128:131], v[64:67], v[0:3]
    ds_read_b128 v[60:63], v223 offset:33984
    s_waitcnt vmcnt(14)
    v_mfma_f32_16x16x32_bf16 v[0:3], v[132:135], v[68:71], v[0:3]
    ds_read_b128 v[64:67], v232 offset:6144
    s_waitcnt vmcnt(13) lgkmcnt(9)
    v_mfma_f32_16x16x32_bf16 v[0:3], v[136:139], v[72:75], v[0:3]
    ds_read_b128 v[68:71], v232 offset:6208
    s_waitcnt vmcnt(12)
    v_mfma_f32_16x16x32_bf16 v[0:3], v[140:143], v[76:79], v[0:3]
    ds_read_b128 v[72:75], v232 offset:6784
    s_waitcnt lgkmcnt(9)
    v_mfma_f32_16x16x32_bf16 v[16:19], v[96:99], v[80:83], 0
    ds_read_b128 v[76:79], v232 offset:6848
    v_mfma_f32_16x16x32_bf16 v[16:19], v[100:103], v[84:87], v[16:19]
    ds_read_b128 v[80:83], v225 offset:0
    s_waitcnt lgkmcnt(9)
    v_mfma_f32_16x16x32_bf16 v[16:19], v[104:107], v[88:91], v[16:19]
    ds_read_b128 v[84:87], v225 offset:64
    v_mfma_f32_16x16x32_bf16 v[16:19], v[108:111], v[92:95], v[16:19]
    ds_read_b128 v[88:91], v225 offset:640
    s_waitcnt lgkmcnt(9)
    v_mfma_f32_16x16x32_bf16 v[16:19], v[128:131], v[48:51], v[16:19]
    ds_read_b128 v[92:95], v225 offset:704
    v_mfma_f32_16x16x32_bf16 v[16:19], v[132:135], v[52:55], v[16:19]
    ds_read_b128 v[48:51], v222 offset:128
    s_waitcnt lgkmcnt(9)
    v_mfma_f32_16x16x32_bf16 v[16:19], v[136:139], v[56:59], v[16:19]
    ds_read_b128 v[52:55], v222 offset:1280
    v_mfma_f32_16x16x32_bf16 v[16:19], v[140:143], v[60:63], v[16:19]
    ds_read_b128 v[56:59], v222 offset:384
    s_waitcnt lgkmcnt(9)
    v_mfma_f32_16x16x32_bf16 v[32:35], v[96:99], v[64:67], 0
    ds_read_b128 v[60:63], v222 offset:192
    v_mfma_f32_16x16x32_bf16 v[32:35], v[100:103], v[68:71], v[32:35]
    ds_read_b128 v[64:67], v222 offset:1344
    s_waitcnt lgkmcnt(9)
    v_mfma_f32_16x16x32_bf16 v[32:35], v[104:107], v[72:75], v[32:35]
    ds_read_b128 v[68:71], v222 offset:448
    v_mfma_f32_16x16x32_bf16 v[32:35], v[108:111], v[76:79], v[32:35]
    ds_read_b128 v[72:75], v222 offset:256
    s_waitcnt lgkmcnt(9)
    v_mfma_f32_16x16x32_bf16 v[32:35], v[128:131], v[80:83], v[32:35]
    ds_read_b128 v[76:79], v222 offset:1152
    v_mfma_f32_16x16x32_bf16 v[32:35], v[132:135], v[84:87], v[32:35]
    ds_read_b128 v[80:83], v222 offset:512
    s_waitcnt lgkmcnt(9)
    v_mfma_f32_16x16x32_bf16 v[32:35], v[136:139], v[88:91], v[32:35]
    ds_read_b128 v[84:87], v222 offset:320
    v_mfma_f32_16x16x32_bf16 v[32:35], v[140:143], v[92:95], v[32:35]
    ds_read_b128 v[88:91], v222 offset:1216
    s_waitcnt vmcnt(11) lgkmcnt(9)
    v_mfma_f32_16x16x32_bf16 v[4:7], v[112:115], v[48:51], 0
    ds_read_b128 v[92:95], v222 offset:576
    v_mfma_f32_16x16x32_bf16 v[8:11], v[112:115], v[52:55], 0
    ds_read_b128 v[48:51], v222 offset:768
    s_waitcnt lgkmcnt(9)
    v_mfma_f32_16x16x32_bf16 v[12:15], v[112:115], v[56:59], 0
    ds_read_b128 v[52:55], v222 offset:896
    s_waitcnt vmcnt(10)
    v_mfma_f32_16x16x32_bf16 v[4:7], v[116:119], v[60:63], v[4:7]
    ds_read_b128 v[56:59], v222 offset:1024
    s_waitcnt lgkmcnt(9)
    v_mfma_f32_16x16x32_bf16 v[8:11], v[116:119], v[64:67], v[8:11]
    ds_read_b128 v[60:63], v222 offset:832
    v_mfma_f32_16x16x32_bf16 v[12:15], v[116:119], v[68:71], v[12:15]
    ds_read_b128 v[64:67], v222 offset:960
    s_waitcnt vmcnt(9) lgkmcnt(9)
    v_mfma_f32_16x16x32_bf16 v[4:7], v[120:123], v[72:75], v[4:7]
    ds_read_b128 v[68:71], v222 offset:1088
    v_mfma_f32_16x16x32_bf16 v[8:11], v[120:123], v[76:79], v[8:11]
    ds_read_b128 v[72:75], v223 offset:128
    s_waitcnt lgkmcnt(9)
    v_mfma_f32_16x16x32_bf16 v[12:15], v[120:123], v[80:83], v[12:15]
    ds_read_b128 v[76:79], v223 offset:1280
    s_waitcnt vmcnt(8)
    v_mfma_f32_16x16x32_bf16 v[4:7], v[124:127], v[84:87], v[4:7]
    ds_read_b128 v[80:83], v223 offset:384
    s_waitcnt lgkmcnt(9)
    v_mfma_f32_16x16x32_bf16 v[8:11], v[124:127], v[88:91], v[8:11]
    ds_read_b128 v[84:87], v223 offset:192
    v_mfma_f32_16x16x32_bf16 v[12:15], v[124:127], v[92:95], v[12:15]
    ds_read_b128 v[88:91], v223 offset:1344
    s_waitcnt vmcnt(7) lgkmcnt(9)
    v_mfma_f32_16x16x32_bf16 v[4:7], v[144:147], v[48:51], v[4:7]
    ds_read_b128 v[92:95], v223 offset:448
    v_mfma_f32_16x16x32_bf16 v[8:11], v[144:147], v[52:55], v[8:11]
    ds_read_b128 v[48:51], v223 offset:256
    s_waitcnt lgkmcnt(9)
    v_mfma_f32_16x16x32_bf16 v[12:15], v[144:147], v[56:59], v[12:15]
    ds_read_b128 v[52:55], v223 offset:1152
    s_waitcnt vmcnt(6)
    v_mfma_f32_16x16x32_bf16 v[4:7], v[148:151], v[60:63], v[4:7]
    ds_read_b128 v[56:59], v223 offset:512
    s_waitcnt lgkmcnt(9)
    v_mfma_f32_16x16x32_bf16 v[8:11], v[148:151], v[64:67], v[8:11]
    ds_read_b128 v[60:63], v223 offset:320
    v_mfma_f32_16x16x32_bf16 v[12:15], v[148:151], v[68:71], v[12:15]
    ds_read_b128 v[64:67], v223 offset:1216
    s_waitcnt vmcnt(5) lgkmcnt(9)
    v_mfma_f32_16x16x32_bf16 v[4:7], v[152:155], v[72:75], v[4:7]
    ds_read_b128 v[68:71], v223 offset:576
    v_mfma_f32_16x16x32_bf16 v[8:11], v[152:155], v[76:79], v[8:11]
    ds_read_b128 v[72:75], v223 offset:768
    s_waitcnt lgkmcnt(9)
    v_mfma_f32_16x16x32_bf16 v[12:15], v[152:155], v[80:83], v[12:15]
    ds_read_b128 v[76:79], v223 offset:896
    s_waitcnt vmcnt(4)
    v_mfma_f32_16x16x32_bf16 v[4:7], v[156:159], v[84:87], v[4:7]
    ds_read_b128 v[80:83], v223 offset:1024
    s_waitcnt lgkmcnt(9)
    v_mfma_f32_16x16x32_bf16 v[8:11], v[156:159], v[88:91], v[8:11]
    ds_read_b128 v[84:87], v223 offset:832
    v_mfma_f32_16x16x32_bf16 v[12:15], v[156:159], v[92:95], v[12:15]
    ds_read_b128 v[88:91], v223 offset:960
    s_waitcnt vmcnt(3) lgkmcnt(9)
    v_mfma_f32_16x16x32_bf16 v[4:7], v[160:163], v[48:51], v[4:7]
    ds_read_b128 v[92:95], v223 offset:1088
    v_mfma_f32_16x16x32_bf16 v[8:11], v[160:163], v[52:55], v[8:11]
    ds_read_b128 v[48:51], v222 offset:3200
    s_waitcnt lgkmcnt(9)
    v_mfma_f32_16x16x32_bf16 v[12:15], v[160:163], v[56:59], v[12:15]
    ds_read_b128 v[52:55], v222 offset:4352
    s_waitcnt vmcnt(2)
    v_mfma_f32_16x16x32_bf16 v[4:7], v[164:167], v[60:63], v[4:7]
    ds_read_b128 v[56:59], v222 offset:3456
    s_waitcnt lgkmcnt(9)
    v_mfma_f32_16x16x32_bf16 v[8:11], v[164:167], v[64:67], v[8:11]
    ds_read_b128 v[60:63], v222 offset:3264
    v_mfma_f32_16x16x32_bf16 v[12:15], v[164:167], v[68:71], v[12:15]
    ds_read_b128 v[64:67], v222 offset:4416
    s_waitcnt vmcnt(1) lgkmcnt(9)
    v_mfma_f32_16x16x32_bf16 v[4:7], v[168:171], v[72:75], v[4:7]
    ds_read_b128 v[68:71], v222 offset:3520
    v_mfma_f32_16x16x32_bf16 v[8:11], v[168:171], v[76:79], v[8:11]
    ds_read_b128 v[72:75], v222 offset:3328
    s_waitcnt lgkmcnt(9)
    v_mfma_f32_16x16x32_bf16 v[12:15], v[168:171], v[80:83], v[12:15]
    ds_read_b128 v[76:79], v222 offset:4224
    s_waitcnt vmcnt(0)
    v_mfma_f32_16x16x32_bf16 v[4:7], v[172:175], v[84:87], v[4:7]
    ds_read_b128 v[80:83], v222 offset:3584
    s_waitcnt lgkmcnt(9)
    v_mfma_f32_16x16x32_bf16 v[8:11], v[172:175], v[88:91], v[8:11]
    ds_read_b128 v[84:87], v222 offset:3392
    v_mfma_f32_16x16x32_bf16 v[12:15], v[172:175], v[92:95], v[12:15]
    ds_read_b128 v[88:91], v222 offset:4288
    s_waitcnt lgkmcnt(9)
    v_mfma_f32_16x16x32_bf16 v[20:23], v[112:115], v[48:51], 0
    ds_read_b128 v[92:95], v222 offset:3648
    v_mfma_f32_16x16x32_bf16 v[24:27], v[112:115], v[52:55], 0
    ds_read_b128 v[48:51], v222 offset:3840
    s_waitcnt lgkmcnt(9)
    v_mfma_f32_16x16x32_bf16 v[28:31], v[112:115], v[56:59], 0
    ds_read_b128 v[52:55], v222 offset:3968
    v_mfma_f32_16x16x32_bf16 v[20:23], v[116:119], v[60:63], v[20:23]
    ds_read_b128 v[56:59], v222 offset:4096
    s_waitcnt lgkmcnt(9)
    v_mfma_f32_16x16x32_bf16 v[24:27], v[116:119], v[64:67], v[24:27]
    ds_read_b128 v[60:63], v222 offset:3904
    v_mfma_f32_16x16x32_bf16 v[28:31], v[116:119], v[68:71], v[28:31]
    ds_read_b128 v[64:67], v222 offset:4032
    s_waitcnt lgkmcnt(9)
    v_mfma_f32_16x16x32_bf16 v[20:23], v[120:123], v[72:75], v[20:23]
    ds_read_b128 v[68:71], v222 offset:4160
    v_mfma_f32_16x16x32_bf16 v[24:27], v[120:123], v[76:79], v[24:27]
    ds_read_b128 v[72:75], v223 offset:33408
    s_waitcnt lgkmcnt(9)
    v_mfma_f32_16x16x32_bf16 v[28:31], v[120:123], v[80:83], v[28:31]
    ds_read_b128 v[76:79], v223 offset:34560
    v_mfma_f32_16x16x32_bf16 v[20:23], v[124:127], v[84:87], v[20:23]
    ds_read_b128 v[80:83], v223 offset:33664
    s_waitcnt lgkmcnt(9)
    v_mfma_f32_16x16x32_bf16 v[24:27], v[124:127], v[88:91], v[24:27]
    ds_read_b128 v[84:87], v223 offset:33472
    v_mfma_f32_16x16x32_bf16 v[28:31], v[124:127], v[92:95], v[28:31]
    ds_read_b128 v[88:91], v223 offset:34624
    s_waitcnt lgkmcnt(9)
    v_mfma_f32_16x16x32_bf16 v[20:23], v[144:147], v[48:51], v[20:23]
    ds_read_b128 v[92:95], v223 offset:33728
    v_mfma_f32_16x16x32_bf16 v[24:27], v[144:147], v[52:55], v[24:27]
    ds_read_b128 v[48:51], v223 offset:33536
    s_waitcnt lgkmcnt(9)
    v_mfma_f32_16x16x32_bf16 v[28:31], v[144:147], v[56:59], v[28:31]
    ds_read_b128 v[52:55], v223 offset:34432
    v_mfma_f32_16x16x32_bf16 v[20:23], v[148:151], v[60:63], v[20:23]
    ds_read_b128 v[56:59], v223 offset:33792
    s_waitcnt lgkmcnt(9)
    v_mfma_f32_16x16x32_bf16 v[24:27], v[148:151], v[64:67], v[24:27]
    ds_read_b128 v[60:63], v223 offset:33600
    v_mfma_f32_16x16x32_bf16 v[28:31], v[148:151], v[68:71], v[28:31]
    ds_read_b128 v[64:67], v223 offset:34496
    s_waitcnt lgkmcnt(9)
    v_mfma_f32_16x16x32_bf16 v[20:23], v[152:155], v[72:75], v[20:23]
    ds_read_b128 v[68:71], v223 offset:33856
    v_mfma_f32_16x16x32_bf16 v[24:27], v[152:155], v[76:79], v[24:27]
    ds_read_b128 v[72:75], v223 offset:34048
    s_waitcnt lgkmcnt(9)
    v_mfma_f32_16x16x32_bf16 v[28:31], v[152:155], v[80:83], v[28:31]
    ds_read_b128 v[76:79], v223 offset:34176
    v_mfma_f32_16x16x32_bf16 v[20:23], v[156:159], v[84:87], v[20:23]
    ds_read_b128 v[80:83], v223 offset:34304
    s_waitcnt lgkmcnt(9)
    v_mfma_f32_16x16x32_bf16 v[24:27], v[156:159], v[88:91], v[24:27]
    ds_read_b128 v[84:87], v223 offset:34112
    v_mfma_f32_16x16x32_bf16 v[28:31], v[156:159], v[92:95], v[28:31]
    ds_read_b128 v[88:91], v223 offset:34240
    s_waitcnt lgkmcnt(9)
    v_mfma_f32_16x16x32_bf16 v[20:23], v[160:163], v[48:51], v[20:23]
    ds_read_b128 v[92:95], v223 offset:34368
    v_mfma_f32_16x16x32_bf16 v[24:27], v[160:163], v[52:55], v[24:27]
    ds_read_b128 v[48:51], v247 offset:6272
    s_waitcnt lgkmcnt(9)
    v_mfma_f32_16x16x32_bf16 v[28:31], v[160:163], v[56:59], v[28:31]
    ds_read_b128 v[52:55], v232 offset:7424
    v_mfma_f32_16x16x32_bf16 v[20:23], v[164:167], v[60:63], v[20:23]
    ds_read_b128 v[56:59], v247 offset:6336
    s_waitcnt lgkmcnt(9)
    v_mfma_f32_16x16x32_bf16 v[24:27], v[164:167], v[64:67], v[24:27]
    ds_read_b128 v[60:63], v232 offset:7488
    v_mfma_f32_16x16x32_bf16 v[28:31], v[164:167], v[68:71], v[28:31]
    ds_read_b128 v[64:67], v247 offset:6400
    s_waitcnt lgkmcnt(9)
    v_mfma_f32_16x16x32_bf16 v[20:23], v[168:171], v[72:75], v[20:23]
    ds_read_b128 v[68:71], v232 offset:7296
    v_mfma_f32_16x16x32_bf16 v[24:27], v[168:171], v[76:79], v[24:27]
    ds_read_b128 v[72:75], v247 offset:6464
    s_waitcnt lgkmcnt(9)
    v_mfma_f32_16x16x32_bf16 v[28:31], v[168:171], v[80:83], v[28:31]
    ds_read_b128 v[76:79], v232 offset:7360
    v_mfma_f32_16x16x32_bf16 v[20:23], v[172:175], v[84:87], v[20:23]
    ds_read_b128 v[80:83], v247 offset:6912
    s_waitcnt lgkmcnt(9)
    v_mfma_f32_16x16x32_bf16 v[24:27], v[172:175], v[88:91], v[24:27]
    ds_read_b128 v[84:87], v232 offset:7040
    v_mfma_f32_16x16x32_bf16 v[28:31], v[172:175], v[92:95], v[28:31]
    ds_read_b128 v[88:91], v247 offset:6976
    s_waitcnt lgkmcnt(9)
    v_mfma_f32_16x16x32_bf16 v[36:39], v[112:115], v[48:51], 0
    ds_read_b128 v[92:95], v232 offset:7104
    v_mfma_f32_16x16x32_bf16 v[40:43], v[112:115], v[52:55], 0
    ds_read_b128 v[48:51], v248 offset:128
    s_waitcnt lgkmcnt(9)
    v_mfma_f32_16x16x32_bf16 v[36:39], v[116:119], v[56:59], v[36:39]
    ds_read_b128 v[52:55], v225 offset:1280
    v_mfma_f32_16x16x32_bf16 v[40:43], v[116:119], v[60:63], v[40:43]
    ds_read_b128 v[56:59], v248 offset:192
    s_waitcnt lgkmcnt(9)
    v_mfma_f32_16x16x32_bf16 v[36:39], v[120:123], v[64:67], v[36:39]
    ds_read_b128 v[60:63], v225 offset:1344
    v_mfma_f32_16x16x32_bf16 v[40:43], v[120:123], v[68:71], v[40:43]
    ds_read_b128 v[64:67], v248 offset:256
    s_waitcnt lgkmcnt(9)
    v_mfma_f32_16x16x32_bf16 v[36:39], v[124:127], v[72:75], v[36:39]
    ds_read_b128 v[68:71], v225 offset:1152
    v_mfma_f32_16x16x32_bf16 v[40:43], v[124:127], v[76:79], v[40:43]
    ds_read_b128 v[72:75], v248 offset:320
    s_waitcnt lgkmcnt(9)
    v_mfma_f32_16x16x32_bf16 v[36:39], v[144:147], v[80:83], v[36:39]
    ds_read_b128 v[76:79], v225 offset:1216
    v_mfma_f32_16x16x32_bf16 v[40:43], v[144:147], v[84:87], v[40:43]
    ds_read_b128 v[80:83], v248 offset:768
    s_waitcnt lgkmcnt(9)
    v_mfma_f32_16x16x32_bf16 v[36:39], v[148:151], v[88:91], v[36:39]
    ds_read_b128 v[84:87], v225 offset:896
    v_mfma_f32_16x16x32_bf16 v[40:43], v[148:151], v[92:95], v[40:43]
    ds_read_b128 v[88:91], v248 offset:832
    s_waitcnt lgkmcnt(9)
    v_mfma_f32_16x16x32_bf16 v[36:39], v[152:155], v[48:51], v[36:39]
    ds_read_b128 v[92:95], v225 offset:960
    v_mfma_f32_16x16x32_bf16 v[40:43], v[152:155], v[52:55], v[40:43]
    s_waitcnt lgkmcnt(8)
    v_mfma_f32_16x16x32_bf16 v[36:39], v[156:159], v[56:59], v[36:39]
    v_mfma_f32_16x16x32_bf16 v[40:43], v[156:159], v[60:63], v[40:43]
    s_waitcnt lgkmcnt(6)
    v_mfma_f32_16x16x32_bf16 v[36:39], v[160:163], v[64:67], v[36:39]
    v_mfma_f32_16x16x32_bf16 v[40:43], v[160:163], v[68:71], v[40:43]
    s_waitcnt lgkmcnt(4)
    v_mfma_f32_16x16x32_bf16 v[36:39], v[164:167], v[72:75], v[36:39]
    v_mfma_f32_16x16x32_bf16 v[40:43], v[164:167], v[76:79], v[40:43]
    s_waitcnt lgkmcnt(2)
    v_mfma_f32_16x16x32_bf16 v[36:39], v[168:171], v[80:83], v[36:39]
    v_mfma_f32_16x16x32_bf16 v[40:43], v[168:171], v[84:87], v[40:43]
    s_waitcnt lgkmcnt(0)
    v_mfma_f32_16x16x32_bf16 v[36:39], v[172:175], v[88:91], v[36:39]
    v_mfma_f32_16x16x32_bf16 v[40:43], v[172:175], v[92:95], v[40:43]
    s_lshl_b32 s60, s54, 9
    s_lshl_b32 s61, s20, 6
    s_add_u32 s60, s60, s61
    s_mul_i32 s60, s60, 192
    s_add_u32 s60, s60, 10485760
    v_mul_u32_u24 v227, 96, v252
    s_cmp_lg_u32 s28, 0
    s_cbranch_scc1 K2_NOACC
    buffer_load_dwordx4 v[48:51], v227, s[8:11], s60 offen offset:0
    buffer_load_dwordx4 v[52:55], v227, s[8:11], s60 offen offset:16
    buffer_load_dwordx4 v[56:59], v227, s[8:11], s60 offen offset:32
    buffer_load_dwordx4 v[60:63], v227, s[8:11], s60 offen offset:48
    buffer_load_dwordx4 v[64:67], v227, s[8:11], s60 offen offset:64
    buffer_load_dwordx4 v[68:71], v227, s[8:11], s60 offen offset:80
    buffer_load_dwordx4 v[72:75], v227, s[8:11], s60 offen offset:96
    buffer_load_dwordx4 v[76:79], v227, s[8:11], s60 offen offset:112
    buffer_load_dwordx4 v[80:83], v227, s[8:11], s60 offen offset:128
    buffer_load_dwordx4 v[84:87], v227, s[8:11], s60 offen offset:144
    buffer_load_dwordx4 v[88:91], v227, s[8:11], s60 offen offset:160
    s_waitcnt vmcnt(0)
    v_add_f32 v0, v0, v48
    v_add_f32 v1, v1, v49
    v_add_f32 v2, v2, v50
    v_add_f32 v3, v3, v51
    v_add_f32 v4, v4, v52
    v_add_f32 v5, v5, v53
    v_add_f32 v6, v6, v54
    v_add_f32 v7, v7, v55
    v_add_f32 v8, v8, v56
    v_add_f32 v9, v9, v57
    v_add_f32 v10, v10, v58
    v_add_f32 v11, v11, v59
    v_add_f32 v12, v12, v60
    v_add_f32 v13, v13, v61
    v_add_f32 v14, v14, v62
    v_add_f32 v15, v15, v63
    v_add_f32 v16, v16, v64
    v_add_f32 v17, v17, v65
    v_add_f32 v18, v18, v66
    v_add_f32 v19, v19, v67
    v_add_f32 v20, v20, v68
    v_add_f32 v21, v21, v69
    v_add_f32 v22, v22, v70
    v_add_f32 v23, v23, v71
    v_add_f32 v24, v24, v72
    v_add_f32 v25, v25, v73
    v_add_f32 v26, v26, v74
    v_add_f32 v27, v27, v75
    v_add_f32 v28, v28, v76
    v_add_f32 v29, v29, v77
    v_add_f32 v30, v30, v78
    v_add_f32 v31, v31, v79
    v_add_f32 v32, v32, v80
    v_add_f32 v33, v33, v81
    v_add_f32 v34, v34, v82
    v_add_f32 v35, v35, v83
    v_add_f32 v36, v36, v84
    v_add_f32 v37, v37, v85
    v_add_f32 v38, v38, v86
    v_add_f32 v39, v39, v87
    v_add_f32 v40, v40, v88
    v_add_f32 v41, v41, v89
    v_add_f32 v42, v42, v90
    v_add_f32 v43, v43, v91
K2_NOACC:
    s_barrier
    s_cmp_eq_u32 s55, 0
    s_cbranch_scc1 K2_SPILL
    s_bfe_u32 s60, s20, 0x10002
    s_lshl_b32 s60, s60, 4
    s_add_u32 s59, s59, s60
    v_add_u32 v228, s59, v229
    s_mul_i32 s60, s20, 2080
    s_add_u32 s60, s60, 65536
    v_add_u32 v249, s60, v229
    s_mov_b32 s63, 0xbfb8aa3b
    s_add_u32 s40, s20, s21
    s_lshl_b32 s40, s40, 10
    s_add_u32 s41, s40, 8192
    s_add_u32 s42, s40, 16384
    s_add_u32 s43, s40, 24576
    s_add_u32 s44, s40, 32768
    v_mul_f32 v204, s63, v0
    v_mul_f32 v205, s63, v1
    v_mul_f32 v206, s63, v2
    v_mul_f32 v207, s63, v3
    v_exp_f32 v204, v204
    v_exp_f32 v205, v205
    v_exp_f32 v206, v206
    v_exp_f32 v207, v207
    v_add_f32 v204, 1.0, v204
    v_add_f32 v205, 1.0, v205
    v_add_f32 v206, 1.0, v206
    v_add_f32 v207, 1.0, v207
    v_rcp_f32 v204, v204
    v_rcp_f32 v205, v205
    v_rcp_f32 v206, v206
    v_rcp_f32 v207, v207
    v_cvt_pk_bf16_f32 v176, v0, v1
    v_cvt_pk_bf16_f32 v177, v2, v3
    v_mul_f32 v4, v4, v204
    v_mul_f32 v5, v5, v205
    v_mul_f32 v6, v6, v206
    v_mul_f32 v7, v7, v207
    v_cvt_pk_bf16_f32 v178, v4, v5
    v_cvt_pk_bf16_f32 v179, v6, v7
    v_mul_f32 v8, v8, v204
    v_mul_f32 v9, v9, v205
    v_mul_f32 v10, v10, v206
    v_mul_f32 v11, v11, v207
    v_cvt_pk_bf16_f32 v180, v8, v9
    v_cvt_pk_bf16_f32 v181, v10, v11
    v_mul_f32 v12, v12, v204
    v_mul_f32 v13, v13, v205
    v_mul_f32 v14, v14, v206
    v_mul_f32 v15, v15, v207
    v_cvt_pk_bf16_f32 v182, v12, v13
    v_cvt_pk_bf16_f32 v183, v14, v15
    ds_write_b64 v254, v[176:177] offset:0
    ds_write_b64 v254, v[178:179] offset:256
    ds_write_b64 v254, v[180:181] offset:512
    ds_write_b64 v254, v[182:183] offset:768
    s_waitcnt lgkmcnt(0)
    s_barrier
    ds_read_b128 v[192:195], v228 offset:0
    ds_read_b128 v[196:199], v228 offset:1536
    s_waitcnt lgkmcnt(0)
    buffer_store_dwordx4 v[192:195], v229, s[12:15], s40 offen sc1
    buffer_store_dwordx4 v[196:199], v229, s[12:15], s41 offen sc1
    v_mul_f32 v208, s63, v16
    v_mul_f32 v209, s63, v17
    v_mul_f32 v210, s63, v18
    v_mul_f32 v211, s63, v19
    v_exp_f32 v208, v208
    v_exp_f32 v209, v209
    v_exp_f32 v210, v210
    v_exp_f32 v211, v211
    v_add_f32 v208, 1.0, v208
    v_add_f32 v209, 1.0, v209
    v_add_f32 v210, 1.0, v210
    v_add_f32 v211, 1.0, v211
    v_rcp_f32 v208, v208
    v_rcp_f32 v209, v209
    v_rcp_f32 v210, v210
    v_rcp_f32 v211, v211
    v_cvt_pk_bf16_f32 v184, v16, v17
    v_cvt_pk_bf16_f32 v185, v18, v19
    v_mul_f32 v20, v20, v208
    v_mul_f32 v21, v21, v209
    v_mul_f32 v22, v22, v210
    v_mul_f32 v23, v23, v211
    v_cvt_pk_bf16_f32 v186, v20, v21
    v_cvt_pk_bf16_f32 v187, v22, v23
    v_mul_f32 v24, v24, v208
    v_mul_f32 v25, v25, v209
    v_mul_f32 v26, v26, v210
    v_mul_f32 v27, v27, v211
    v_cvt_pk_bf16_f32 v188, v24, v25
    v_cvt_pk_bf16_f32 v189, v26, v27
    v_mul_f32 v28, v28, v208
    v_mul_f32 v29, v29, v209
    v_mul_f32 v30, v30, v210
    v_mul_f32 v31, v31, v211
    v_cvt_pk_bf16_f32 v190, v28, v29
    v_cvt_pk_bf16_f32 v191, v30, v31
    ds_write_b64 v254, v[184:185] offset:3072
    ds_write_b64 v254, v[186:187] offset:3328
    ds_write_b64 v254, v[188:189] offset:3584
    ds_write_b64 v254, v[190:191] offset:3840
    s_waitcnt lgkmcnt(0)
    s_barrier
    ds_read_b128 v[192:195], v228 offset:3072
    ds_read_b128 v[196:199], v228 offset:4608
    s_waitcnt lgkmcnt(0)
    buffer_store_dwordx4 v[192:195], v229, s[12:15], s42 offen sc1
    buffer_store_dwordx4 v[196:199], v229, s[12:15], s43 offen sc1
    v_mul_f32 v212, s63, v32
    v_mul_f32 v213, s63, v33
    v_mul_f32 v214, s63, v34
    v_mul_f32 v215, s63, v35
    v_exp_f32 v212, v212
    v_exp_f32 v213, v213
    v_exp_f32 v214, v214
    v_exp_f32 v215, v215
    v_add_f32 v212, 1.0, v212
    v_add_f32 v213, 1.0, v213
    v_add_f32 v214, 1.0, v214
    v_add_f32 v215, 1.0, v215
    v_rcp_f32 v212, v212
    v_rcp_f32 v213, v213
    v_rcp_f32 v214, v214
    v_rcp_f32 v215, v215
    v_cvt_pk_bf16_f32 v220, v32, v33
    v_cvt_pk_bf16_f32 v221, v34, v35
    v_mul_f32 v36, v36, v212
    v_mul_f32 v37, v37, v213
    v_mul_f32 v38, v38, v214
    v_mul_f32 v39, v39, v215
    v_cvt_pk_bf16_f32 v178, v36, v37
    v_cvt_pk_bf16_f32 v179, v38, v39
    v_mul_f32 v40, v40, v212
    v_mul_f32 v41, v41, v213
    v_mul_f32 v42, v42, v214
    v_mul_f32 v43, v43, v215
    v_cvt_pk_bf16_f32 v180, v40, v41
    v_cvt_pk_bf16_f32 v181, v42, v43
    ds_write_b64 v255, v[220:221] offset:0
    ds_write_b64 v246, v[178:179] offset:256
    ds_write_b64 v255, v[180:181] offset:512
    s_waitcnt lgkmcnt(0)
    s_barrier
    ds_read_b128 v[200:203], v249
    s_branch K2_LASTROW
K2_SPILL:
    buffer_store_dwordx4 v[0:3], v227, s[8:11], s60 offen offset:0
    buffer_store_dwordx4 v[4:7], v227, s[8:11], s60 offen offset:16
    buffer_store_dwordx4 v[8:11], v227, s[8:11], s60 offen offset:32
    buffer_store_dwordx4 v[12:15], v227, s[8:11], s60 offen offset:48
    buffer_store_dwordx4 v[16:19], v227, s[8:11], s60 offen offset:64
    buffer_store_dwordx4 v[20:23], v227, s[8:11], s60 offen offset:80
    buffer_store_dwordx4 v[24:27], v227, s[8:11], s60 offen offset:96
    buffer_store_dwordx4 v[28:31], v227, s[8:11], s60 offen offset:112
    buffer_store_dwordx4 v[32:35], v227, s[8:11], s60 offen offset:128
    buffer_store_dwordx4 v[36:39], v227, s[8:11], s60 offen offset:144
    buffer_store_dwordx4 v[40:43], v227, s[8:11], s60 offen offset:160
    s_mov_b32 s28, 0
    s_waitcnt vmcnt(0)
    s_cmp_lt_u32 s24, s25
    s_cbranch_scc1 K2_LOAD
    s_add_u32 s23, s23, 20
    s_branch K2_WINDOW
KS_FLS:
    s_sub_u32 s25, s25, 1
    s_cbranch_scc1 K2_END
    v_mov_b32 v62, 163460
    ds_read_b32 v62, v62
    s_branch KS_JOIN2
K2_NOW0:
    buffer_load_dwordx4 v[76:79], v72, s[8:11], s67 offen sc1
    s_branch K2_W0
K2_WINDOW:
    s_mov_b32 s24, 0
    s_mov_b32 s25, 1
K2_LOAD:
    v_mbcnt_lo_u32_b32 v176, -1, 0
    v_mbcnt_hi_u32_b32 v176, -1, v176
    s_lshl_b32 s58, s20, 6
    v_add_u32 v177, s58, v176
    v_lshlrev_b32 v70, 4, v176
    s_mov_b32 s58, 7110656
    buffer_load_dwordx4 v[136:139], v70, s[8:11], s58 offen offset:0 sc1
    buffer_load_dwordx4 v[140:143], v70, s[8:11], s58 offen offset:1024 sc1
    s_mov_b32 s58, 7112704
    buffer_load_dwordx4 v[144:147], v70, s[8:11], s58 offen offset:0 sc1
    buffer_load_dwordx4 v[148:151], v70, s[8:11], s58 offen offset:1024 sc1
    s_mov_b32 s58, 7114752
    buffer_load_dwordx4 v[152:155], v70, s[8:11], s58 offen offset:0 sc1
    buffer_load_dwordx4 v[156:159], v70, s[8:11], s58 offen offset:1024 sc1
    s_mov_b32 s58, 7116800
    buffer_load_dwordx4 v[160:163], v70, s[8:11], s58 offen offset:0 sc1
    buffer_load_dwordx4 v[164:167], v70, s[8:11], s58 offen offset:1024 sc1
    s_mov_b32 s58, 7118848
    buffer_load_dwordx4 v[168:171], v70, s[8:11], s58 offen offset:0 sc1
    buffer_load_dwordx4 v[172:175], v70, s[8:11], s58 offen offset:1024 sc1
    s_mul_i32 s58, s20, 10400
    s_add_u32 s58, s58, 65536
    s_add_u32 s59, s58, 512
    v_and_b32 v76, 31, v176
    v_lshrrev_b32 v77, 5, v176
    v_mov_b32 v80, 0
    v_mul_u32_u24 v77, 2080, v77
    v_mov_b32 v81, 0xffff0000
    v_lshl_add_u32 v78, v76, 4, v77
    v_mov_b32 v82, 0
    v_add_u32 v78, s58, v78
    v_mov_b32 v83, v81
    v_add_u32 v85, 16, v176
    v_lshlrev_b32 v84, 5, v176
    v_lshrrev_b32 v85, 6, v85
    v_mul_u32_u24 v85, 1532, v85
    v_sub_u32 v84, v84, v85
    v_mov_b32 v85, -1
    v_add_u32 v84, s59, v84
    ds_write_b32 v84, v85 offset:0
    ds_write_b32 v84, v85 offset:2080
    ds_write_b32 v84, v85 offset:4160
    ds_write_b32 v84, v85 offset:6240
    ds_write_b32 v84, v85 offset:8320
    s_mov_b32 exec_hi, 0
    ds_write_b128 v78, v[80:83] offset:0
    ds_write_b128 v78, v[80:83] offset:2080
    ds_write_b128 v78, v[80:83] offset:4160
    ds_write_b128 v78, v[80:83] offset:6240
    ds_write_b128 v78, v[80:83] offset:8320
    s_mov_b32 exec_hi, -1
    s_cmp_lg_u32 s20, 7
    s_cbranch_scc1 K2_NOH
    v_mov_b32 v76, 0
    v_mov_b32 v77, -1
    v_lshlrev_b32 v78, 2, v176
    v_add_u32 v78, 163072, v78
    s_mov_b64 exec, 0x1ff
    ds_write_b32 v78, v76 offset:192
    s_mov_b32 exec_lo, 1
    s_mov_b32 exec_lo, -1
    ds_write_b32 v78, v77 offset:256
    s_mov_b64 exec, -1
    s_cmp_lg_u32 s24, 0
    s_cbranch_scc1 K2_NOH
    s_mov_b32 exec_hi, 0xffff
    ds_write_b32 v78, v76
    s_mov_b64 exec, 1
    ds_write_b32 v78, v76 offset:232
    s_mov_b64 exec, -1
K2_NOH:
    s_waitcnt lgkmcnt(0)
    s_barrier
    s_branch K2_CELLS
K2_LD_GEN:
    s_mov_b64 exec, s[42:43]
    s_cbranch_execz K2_LD_DONE
    buffer_load_dwordx4 v[4:7], v182, s[8:11], 0 offen sc1
    s_mov_b64 exec, s[44:45]
    s_cbranch_execz K2_LD_DONE
    buffer_load_dwordx4 v[8:11], v183, s[8:11], 0 offen sc1
    s_mov_b64 exec, s[46:47]
    s_cbranch_execz K2_LD_DONE
    buffer_load_dwordx4 v[12:15], v184, s[8:11], 0 offen sc1
    s_mov_b64 exec, s[48:49]
    s_cbranch_execz K2_LD_DONE
    buffer_load_dwordx4 v[16:19], v181, s[8:11], 0 offen offset:128 sc1
    s_mov_b64 exec, s[50:51]
    s_cbranch_execz K2_LD_DONE
    buffer_load_dwordx4 v[20:23], v181, s[8:11], 0 offen offset:160 sc1
    s_mov_b64 exec, s[90:91]
    s_cbranch_execz K2_LD_DONE
    buffer_load_dwordx4 v[24:27], v181, s[8:11], 0 offen offset:192 sc1
    s_mov_b64 exec, s[92:93]
    s_cbranch_execz K2_LD_DONE
    buffer_load_dwordx4 v[28:31], v181, s[8:11], 0 offen offset:224 sc1
    s_mov_b64 exec, s[94:95]
    s_cbranch_execz K2_LD_DONE
    buffer_load_dwordx4 v[32:35], v181, s[8:11], 0 offen offset:256 sc1
    s_mov_b64 exec, s[96:97]
    s_cbranch_execz K2_LD_DONE
    buffer_load_dwordx4 v[36:39], v181, s[8:11], 0 offen offset:288 sc1
    s_branch K2_LD_DONE
K2_WLATE:
    s_waitcnt vmcnt(0)
    v_lshlrev_b32 v96, 16, v136
    v_and_b32 v97, 0xffff0000, v136
    v_lshlrev_b32 v98, 16, v137
    v_and_b32 v99, 0xffff0000, v137
    v_lshlrev_b32 v100, 16, v138
    v_and_b32 v101, 0xffff0000, v138
    v_lshlrev_b32 v102, 16, v139
    v_and_b32 v103, 0xffff0000, v139
    v_lshlrev_b32 v104, 16, v140
    v_and_b32 v105, 0xffff0000, v140
    v_lshlrev_b32 v106, 16, v141
    v_and_b32 v107, 0xffff0000, v141
    v_lshlrev_b32 v108, 16, v142
    v_and_b32 v109, 0xffff0000, v142
    v_lshlrev_b32 v110, 16, v143
    v_and_b32 v111, 0xffff0000, v143
    v_lshlrev_b32 v112, 16, v144
    v_and_b32 v113, 0xffff0000, v144
    v_lshlrev_b32 v114, 16, v145
    v_and_b32 v115, 0xffff0000, v145
    v_lshlrev_b32 v116, 16, v146
    v_and_b32 v117, 0xffff0000, v146
    v_lshlrev_b32 v118, 16, v147
    v_and_b32 v119, 0xffff0000, v147
    v_lshlrev_b32 v120, 16, v148
    v_and_b32 v121, 0xffff0000, v148
    v_lshlrev_b32 v122, 16, v149
    v_and_b32 v123, 0xffff0000, v149
    v_lshlrev_b32 v124, 16, v150
    v_and_b32 v125, 0xffff0000, v150
    v_lshlrev_b32 v126, 16, v151
    v_and_b32 v127, 0xffff0000, v151
    v_lshlrev_b32 v128, 16, v152
    v_and_b32 v129, 0xffff0000, v152
    v_lshlrev_b32 v130, 16, v153
    v_and_b32 v131, 0xffff0000, v153
    v_lshlrev_b32 v132, 16, v154
    v_and_b32 v133, 0xffff0000, v154
    v_lshlrev_b32 v134, 16, v155
    v_and_b32 v135, 0xffff0000, v155
    v_lshlrev_b32 v136, 16, v156
    v_and_b32 v137, 0xffff0000, v156
    v_lshlrev_b32 v138, 16, v157
    v_and_b32 v139, 0xffff0000, v157
    v_lshlrev_b32 v140, 16, v158
    v_and_b32 v141, 0xffff0000, v158
    v_lshlrev_b32 v142, 16, v159
    v_and_b32 v143, 0xffff0000, v159
    v_lshlrev_b32 v144, 16, v160
    v_and_b32 v145, 0xffff0000, v160
    v_lshlrev_b32 v146, 16, v161
    v_and_b32 v147, 0xffff0000, v161
    v_lshlrev_b32 v148, 16, v162
    v_and_b32 v149, 0xffff0000, v162
    v_lshlrev_b32 v150, 16, v163
    v_and_b32 v151, 0xffff0000, v163
    v_lshlrev_b32 v152, 16, v164
    v_and_b32 v153, 0xffff0000, v164
    v_lshlrev_b32 v154, 16, v165
    v_and_b32 v155, 0xffff0000, v165
    v_lshlrev_b32 v156, 16, v166
    v_and_b32 v157, 0xffff0000, v166
    v_lshlrev_b32 v158, 16, v167
    v_and_b32 v159, 0xffff0000, v167
    v_lshlrev_b32 v160, 16, v168
    v_and_b32 v161, 0xffff0000, v168
    v_lshlrev_b32 v162, 16, v169
    v_and_b32 v163, 0xffff0000, v169
    v_lshlrev_b32 v164, 16, v170
    v_and_b32 v165, 0xffff0000, v170
    v_lshlrev_b32 v166, 16, v171
    v_and_b32 v167, 0xffff0000, v171
    v_lshlrev_b32 v168, 16, v172
    v_and_b32 v169, 0xffff0000, v172
    v_lshlrev_b32 v170, 16, v173
    v_and_b32 v171, 0xffff0000, v173
    v_lshlrev_b32 v172, 16, v174
    v_and_b32 v173, 0xffff0000, v174
    v_lshlrev_b32 v174, 16, v175
    v_and_b32 v175, 0xffff0000, v175
    s_branch K2_NOWRAW
K2_RT0:
    s_sub_u32 s60, s60, 1
    s_cbranch_scc1 K2_END
    s_mov_b64 exec, vcc
    buffer_load_dwordx4 v[0:3], v181, s[8:11], 0 offen offset:0 sc1
    s_mov_b64 exec, s[40:41]
    s_waitcnt vmcnt(0)
    s_branch K2_CK0
K2_RT1:
    s_sub_u32 s60, s60, 1
    s_cbranch_scc1 K2_END
    s_mov_b64 exec, vcc
    buffer_load_dwordx4 v[4:7], v182, s[8:11], 0 offen sc1
    s_mov_b64 exec, s[42:43]
    s_waitcnt vmcnt(0)
    s_branch K2_CK1
K2_RT2:
    s_sub_u32 s60, s60, 1
    s_cbranch_scc1 K2_END
    s_mov_b64 exec, vcc
    buffer_load_dwordx4 v[8:11], v183, s[8:11], 0 offen sc1
    s_mov_b64 exec, s[44:45]
    s_waitcnt vmcnt(0)
    s_branch K2_CK2
K2_RT3:
    s_sub_u32 s60, s60, 1
    s_cbranch_scc1 K2_END
    s_mov_b64 exec, vcc
    buffer_load_dwordx4 v[12:15], v184, s[8:11], 0 offen sc1
    s_mov_b64 exec, s[46:47]
    s_waitcnt vmcnt(0)
    s_branch K2_CK3
K2_RT4:
    s_sub_u32 s60, s60, 1
    s_cbranch_scc1 K2_END
    s_mov_b64 exec, vcc
    buffer_load_dwordx4 v[16:19], v181, s[8:11], 0 offen offset:128 sc1
    s_mov_b64 exec, s[48:49]
    s_waitcnt vmcnt(0)
    s_branch K2_CK4
K2_RT5:
    s_sub_u32 s60, s60, 1
    s_cbranch_scc1 K2_END
    s_mov_b64 exec, vcc
    buffer_load_dwordx4 v[20:23], v181, s[8:11], 0 offen offset:160 sc1
    s_mov_b64 exec, s[50:51]
    s_waitcnt vmcnt(0)
    s_branch K2_CK5
K2_RT6:
    s_sub_u32 s60, s60, 1
    s_cbranch_scc1 K2_END
    s_mov_b64 exec, vcc
    buffer_load_dwordx4 v[24:27], v181, s[8:11], 0 offen offset:192 sc1
    s_mov_b64 exec, s[90:91]
    s_waitcnt vmcnt(0)
    s_branch K2_CK6
K2_RT7:
    s_sub_u32 s60, s60, 1
    s_cbranch_scc1 K2_END
    s_mov_b64 exec, vcc
    buffer_load_dwordx4 v[28:31], v181, s[8:11], 0 offen offset:224 sc1
    s_mov_b64 exec, s[92:93]
    s_waitcnt vmcnt(0)
    s_branch K2_CK7
K2_RT8:
    s_sub_u32 s60, s60, 1
    s_cbranch_scc1 K2_END
    s_mov_b64 exec, vcc
    buffer_load_dwordx4 v[32:35], v181, s[8:11], 0 offen offset:256 sc1
    s_mov_b64 exec, s[94:95]
    s_waitcnt vmcnt(0)
    s_branch K2_CK8
K2_RT9:
    s_sub_u32 s60, s60, 1
    s_cbranch_scc1 K2_END
    s_mov_b64 exec, vcc
    buffer_load_dwordx4 v[36:39], v181, s[8:11], 0 offen offset:288 sc1
    s_mov_b64 exec, s[96:97]
    s_waitcnt vmcnt(0)
    s_branch K2_CK9
K2_RK_LOAD:
    s_waitcnt vmcnt(0)
    s_mov_b64 exec, s[40:41]
    s_cbranch_execz K2_RK_B
    v_lshrrev_b32 v50, 24, v3
    buffer_load_dword v40, v179, s[8:11], s66 offen offset:0
    v_mad_u32_u24 v50, v50, s58, v202
    v_and_b32 v3, 0xffffff, v3
    s_mov_b64 exec, s[42:43]
    s_cbranch_execz K2_RK_B
    v_lshrrev_b32 v51, 24, v7
    buffer_load_dword v41, v185, s[8:11], s66 offen
    v_mad_u32_u24 v51, v51, s58, v202
    v_and_b32 v7, 0xffffff, v7
    s_mov_b64 exec, s[44:45]
    s_cbranch_execz K2_RK_B
    v_lshrrev_b32 v52, 24, v11
    buffer_load_dword v42, v186, s[8:11], s66 offen
    v_mad_u32_u24 v52, v52, s58, v202
    v_and_b32 v11, 0xffffff, v11
    s_mov_b64 exec, s[46:47]
    s_cbranch_execz K2_RK_B
    v_lshrrev_b32 v53, 24, v15
    buffer_load_dword v43, v187, s[8:11], s66 offen
    v_mad_u32_u24 v53, v53, s58, v202
    v_and_b32 v15, 0xffffff, v15
    s_mov_b64 exec, s[48:49]
    s_cbranch_execz K2_RK_B
    v_lshrrev_b32 v54, 24, v19
    buffer_load_dword v44, v179, s[8:11], s66 offen offset:32
    v_mad_u32_u24 v54, v54, s58, v202
    v_and_b32 v19, 0xffffff, v19
    s_mov_b64 exec, s[50:51]
    s_cbranch_execz K2_RK_B
    v_lshrrev_b32 v55, 24, v23
    buffer_load_dword v45, v179, s[8:11], s66 offen offset:40
    v_mad_u32_u24 v55, v55, s58, v202
    v_and_b32 v23, 0xffffff, v23
    s_mov_b64 exec, s[90:91]
    s_cbranch_execz K2_RK_B
    v_lshrrev_b32 v56, 24, v27
    buffer_load_dword v46, v179, s[8:11], s66 offen offset:48
    v_mad_u32_u24 v56, v56, s58, v202
    v_and_b32 v27, 0xffffff, v27
    s_mov_b64 exec, s[92:93]
    s_cbranch_execz K2_RK_B
    v_lshrrev_b32 v57, 24, v31
    buffer_load_dword v47, v179, s[8:11], s66 offen offset:56
    v_mad_u32_u24 v57, v57, s58, v202
    v_and_b32 v31, 0xffffff, v31
    s_mov_b64 exec, s[94:95]
    s_cbranch_execz K2_RK_B
    v_lshrrev_b32 v58, 24, v35
    buffer_load_dword v48, v179, s[8:11], s66 offen offset:64
    v_mad_u32_u24 v58, v58, s58, v202
    v_and_b32 v35, 0xffffff, v35
    s_mov_b64 exec, s[96:97]
    s_cbranch_execz K2_RK_B
    v_lshrrev_b32 v59, 24, v39
    buffer_load_dword v49, v179, s[8:11], s66 offen offset:72
    v_mad_u32_u24 v59, v59, s58, v202
    v_and_b32 v39, 0xffffff, v39
K2_RK_B:
    s_mov_b64 exec, -1
    s_mul_i32 s62, s24, 48
    s_waitcnt vmcnt(0)
    v_subrev_u32 v40, s62, v40
    v_subrev_u32 v41, s62, v41
    v_subrev_u32 v42, s62, v42
    v_subrev_u32 v43, s62, v43
    v_subrev_u32 v44, s62, v44
    v_subrev_u32 v45, s62, v45
    v_subrev_u32 v46, s62, v46
    v_subrev_u32 v47, s62, v47
    v_subrev_u32 v48, s62, v48
    v_subrev_u32 v49, s62, v49
    s_branch K2_RK_DONE
K2_BIG:
    s_cmp_lg_u32 s24, 0
    s_cbranch_scc1 K2_TOK
    s_movk_i32 s26, 48
    v_mov_b32 v197, v193
    s_nop 1
    v_max_u32_dpp v197, v197, v197 row_shr:1 row_mask:0xf bank_mask:0xf bound_ctrl:0
    s_nop 1
    v_max_u32_dpp v197, v197, v197 row_shr:2 row_mask:0xf bank_mask:0xf bound_ctrl:0
    s_nop 1
    v_max_u32_dpp v197, v197, v197 row_shr:4 row_mask:0xf bank_mask:0xf bound_ctrl:0
    s_nop 1
    v_max_u32_dpp v197, v197, v197 row_shr:8 row_mask:0xf bank_mask:0xf bound_ctrl:0
    s_nop 1
    v_max_u32_dpp v197, v197, v197 row_bcast:15 row_mask:0xa bank_mask:0xf
    s_nop 1
    v_max_u32_dpp v197, v197, v197 row_bcast:31 row_mask:0xc bank_mask:0xf
    s_nop 0
    v_readlane_b32 s25, v197, 63
    s_nop 0
    s_add_u32 s25, s25, 47
    s_mul_i32 s25, s25, 43691
    s_lshr_b32 s25, s25, 21
    s_mov_b64 exec, s[40:41]
    s_cbranch_execz K2_SV_DONE
    buffer_store_dword v40, v179, s[8:11], s66 offen offset:0
    s_mov_b64 exec, s[42:43]
    s_cbranch_execz K2_SV_DONE
    buffer_store_dword v41, v185, s[8:11], s66 offen
    s_mov_b64 exec, s[44:45]
    s_cbranch_execz K2_SV_DONE
    buffer_store_dword v42, v186, s[8:11], s66 offen
    s_mov_b64 exec, s[46:47]
    s_cbranch_execz K2_SV_DONE
    buffer_store_dword v43, v187, s[8:11], s66 offen
    s_mov_b64 exec, s[48:49]
    s_cbranch_execz K2_SV_DONE
    buffer_store_dword v44, v179, s[8:11], s66 offen offset:32
    s_mov_b64 exec, s[50:51]
    s_cbranch_execz K2_SV_DONE
    buffer_store_dword v45, v179, s[8:11], s66 offen offset:40
    s_mov_b64 exec, s[90:91]
    s_cbranch_execz K2_SV_DONE
    buffer_store_dword v46, v179, s[8:11], s66 offen offset:48
    s_mov_b64 exec, s[92:93]
    s_cbranch_execz K2_SV_DONE
    buffer_store_dword v47, v179, s[8:11], s66 offen offset:56
    s_mov_b64 exec, s[94:95]
    s_cbranch_execz K2_SV_DONE
    buffer_store_dword v48, v179, s[8:11], s66 offen offset:64
    s_mov_b64 exec, s[96:97]
    s_cbranch_execz K2_SV_DONE
    buffer_store_dword v49, v179, s[8:11], s66 offen offset:72
K2_SV_DONE:
    s_mov_b64 exec, -1
    s_branch K2_TOK
K2_rare_1:
    s_cmp_eq_u32 s33, 4
    s_cbranch_scc1 K2_four_3
    s_mov_b32 s49, s48
    s_xor_b32 s45, s44, 256
    s_xor_b32 s46, s44, 512
    s_xor_b32 s47, s44, 768
    s_branch K2_back_2
K2_four_3:
    s_add_u32 s50, s48, 256
    s_mov_b32 s46, s44
    s_mov_b32 s47, s44
    s_branch K2_back_2
K2_a4_5:
    v_add_u32 v254, s48, v232
    ds_read_b32 v254, v254 offset:4
    s_lshr_b32 s65, s3, 28
    s_mul_i32 s66, s22, 2080
    s_lshl_b32 s65, s65, 9
    s_add_u32 s65, s65, s66
    s_add_u32 s65, s65, 65536
    s_mov_b32 m0, s65
    s_mov_b32 exec_hi, 0
    s_waitcnt lgkmcnt(0)
    v_or_b32 v254, v254, v233
    buffer_load_dwordx4 v254, s[16:19], 0 offen  lds
    s_mov_b32 exec_hi, -1
    s_branch K2_b4_7
K2_g4_8:
    s_add_u32 s51, s48, 384
    v_add_u32 v44, s51, v251
    ds_read2_b32 v[44:45], v44 offset0:1 offset1:3
    s_waitcnt lgkmcnt(0)
    v_mad_u32_u16 v44, v44, s39, v248 op_sel:[1,0,0,0]
    v_mad_u32_u16 v45, v45, s39, v248 op_sel:[1,0,0,0]
    buffer_load_dwordx4 v44, s[4:7], s47 offen sc1 lds
    buffer_load_dwordx4 v45, s[72:75], s47 offen offset:1024 sc1 lds
    s_branch K2_back_9
K2_rare_16:
    s_cmp_eq_u32 s33, 4
    s_cbranch_scc1 K2_four_18
    s_mov_b32 s49, s48
    s_xor_b32 s45, s44, 256
    s_xor_b32 s46, s44, 512
    s_xor_b32 s47, s44, 768
    s_branch K2_back_17
K2_four_18:
    s_add_u32 s50, s48, 256
    s_mov_b32 s46, s44
    s_mov_b32 s47, s44
    s_branch K2_back_17
K2_g4_19:
    s_add_u32 s51, s48, 384
    v_add_u32 v44, s51, v251
    ds_read2_b32 v[44:45], v44 offset0:1 offset1:3
    s_waitcnt lgkmcnt(0)
    v_mad_u32_u16 v44, v44, s39, v248 op_sel:[1,0,0,0]
    v_mad_u32_u16 v45, v45, s39, v248 op_sel:[1,0,0,0]
    buffer_load_dwordx4 v44, s[4:7], s47 offen sc1 lds
    buffer_load_dwordx4 v45, s[72:75], s47 offen offset:1024 sc1 lds
    s_branch K2_back_20
K2_a4_22:
    v_add_u32 v254, s48, v232
    ds_read_b32 v254, v254 offset:4
    s_lshr_b32 s65, s3, 28
    s_mul_i32 s66, s22, 2080
    s_lshl_b32 s65, s65, 9
    s_add_u32 s65, s65, s66
    s_add_u32 s65, s65, 65536
    s_mov_b32 m0, s65
    s_mov_b32 exec_hi, 0
    s_waitcnt lgkmcnt(0)
    v_or_b32 v254, v254, v233
    buffer_load_dwordx4 v254, s[16:19], 0 offen  lds
    s_mov_b32 exec_hi, -1
    s_branch K2_b4_24
K2_rare_31:
    s_cmp_eq_u32 s33, 4
    s_cbranch_scc1 K2_four_33
    s_mov_b32 s49, s48
    s_xor_b32 s45, s44, 256
    s_xor_b32 s46, s44, 512
    s_xor_b32 s47, s44, 768
    s_branch K2_back_32
K2_four_33:
    s_add_u32 s50, s48, 256
    s_mov_b32 s46, s44
    s_mov_b32 s47, s44
    s_branch K2_back_32
K2_g4_34:
    s_add_u32 s51, s48, 384
    v_add_u32 v44, s51, v251
    ds_read2_b32 v[44:45], v44 offset0:1 offset1:3
    s_waitcnt lgkmcnt(0)
    v_mad_u32_u16 v44, v44, s39, v248 op_sel:[1,0,0,0]
    v_mad_u32_u16 v45, v45, s39, v248 op_sel:[1,0,0,0]
    buffer_load_dwordx4 v44, s[4:7], s47 offen sc1 lds
    buffer_load_dwordx4 v45, s[72:75], s47 offen offset:1024 sc1 lds
    s_branch K2_back_35
K2_a4_37:
    v_add_u32 v254, s48, v232
    ds_read_b32 v254, v254 offset:4
    s_lshr_b32 s65, s3, 28
    s_mul_i32 s66, s22, 2080
    s_lshl_b32 s65, s65, 9
    s_add_u32 s65, s65, s66
    s_add_u32 s65, s65, 65536
    s_mov_b32 m0, s65
    s_mov_b32 exec_hi, 0
    s_waitcnt lgkmcnt(0)
    v_or_b32 v254, v254, v233
    buffer_load_dwordx4 v254, s[16:19], 0 offen  lds
    s_mov_b32 exec_hi, -1
    s_branch K2_b4_39
K2_rare_46:
    s_cmp_eq_u32 s33, 4
    s_cbranch_scc1 K2_four_48
    s_mov_b32 s49, s48
    s_xor_b32 s45, s44, 256
    s_xor_b32 s46, s44, 512
    s_xor_b32 s47, s44, 768
    s_branch K2_back_47
K2_four_48:
    s_add_u32 s50, s48, 256
    s_mov_b32 s46, s44
    s_mov_b32 s47, s44
    s_branch K2_back_47
K2_g4_49:
    s_add_u32 s51, s48, 384
    v_add_u32 v44, s51, v251
    ds_read2_b32 v[44:45], v44 offset0:1 offset1:3
    s_waitcnt lgkmcnt(0)
    v_mad_u32_u16 v44, v44, s39, v248 op_sel:[1,0,0,0]
    v_mad_u32_u16 v45, v45, s39, v248 op_sel:[1,0,0,0]
    buffer_load_dwordx4 v44, s[4:7], s47 offen sc1 lds
    buffer_load_dwordx4 v45, s[72:75], s47 offen offset:1024 sc1 lds
    s_branch K2_back_50
K2_a4_52:
    v_add_u32 v254, s48, v232
    ds_read_b32 v254, v254 offset:4
    s_lshr_b32 s65, s3, 28
    s_mul_i32 s66, s22, 2080
    s_lshl_b32 s65, s65, 9
    s_add_u32 s65, s65, s66
    s_add_u32 s65, s65, 65536
    s_mov_b32 m0, s65
    s_mov_b32 exec_hi, 0
    s_waitcnt lgkmcnt(0)
    v_or_b32 v254, v254, v233
    buffer_load_dwordx4 v254, s[16:19], 0 offen  lds
    s_mov_b32 exec_hi, -1
    s_branch K2_b4_54
K2_rare_59:
    s_cmp_eq_u32 s33, 4
    s_cbranch_scc1 K2_four_61
    s_mov_b32 s49, s48
    s_xor_b32 s45, s44, 256
    s_xor_b32 s46, s44, 512
    s_xor_b32 s47, s44, 768
    s_branch K2_back_60
K2_four_61:
    s_add_u32 s50, s48, 256
    s_mov_b32 s46, s44
    s_mov_b32 s47, s44
    s_branch K2_back_60
K2_g4_62:
    s_add_u32 s51, s48, 384
    v_add_u32 v44, s51, v251
    ds_read2_b32 v[44:45], v44 offset0:1 offset1:3
    s_waitcnt lgkmcnt(0)
    v_mad_u32_u16 v44, v44, s39, v248 op_sel:[1,0,0,0]
    v_mad_u32_u16 v45, v45, s39, v248 op_sel:[1,0,0,0]
    buffer_load_dwordx4 v44, s[4:7], s47 offen sc1 lds
    buffer_load_dwordx4 v45, s[72:75], s47 offen offset:1024 sc1 lds
    s_branch K2_back_63
K2_rare_68:
    s_cmp_eq_u32 s33, 4
    s_cbranch_scc1 K2_four_70
    s_mov_b32 s49, s48
    s_xor_b32 s45, s44, 256
    s_xor_b32 s46, s44, 512
    s_xor_b32 s47, s44, 768
    s_branch K2_back_69
K2_four_70:
    s_add_u32 s50, s48, 256
    s_mov_b32 s46, s44
    s_mov_b32 s47, s44
    s_branch K2_back_69
K2_g4_71:
    s_add_u32 s51, s48, 384
    v_add_u32 v44, s51, v251
    ds_read2_b32 v[44:45], v44 offset0:1 offset1:3
    s_waitcnt lgkmcnt(0)
    v_mad_u32_u16 v44, v44, s39, v248 op_sel:[1,0,0,0]
    v_mad_u32_u16 v45, v45, s39, v248 op_sel:[1,0,0,0]
    buffer_load_dwordx4 v44, s[4:7], s47 offen sc1 lds
    buffer_load_dwordx4 v45, s[72:75], s47 offen offset:1024 sc1 lds
    s_branch K2_back_72
K2_rare_77:
    s_cmp_eq_u32 s33, 4
    s_cbranch_scc1 K2_four_79
    s_mov_b32 s49, s48
    s_xor_b32 s45, s44, 256
    s_xor_b32 s46, s44, 512
    s_xor_b32 s47, s44, 768
    s_branch K2_back_78
K2_four_79:
    s_add_u32 s50, s48, 256
    s_mov_b32 s46, s44
    s_mov_b32 s47, s44
    s_branch K2_back_78
K2_g4_80:
    s_add_u32 s51, s48, 384
    v_add_u32 v44, s51, v251
    ds_read2_b32 v[44:45], v44 offset0:1 offset1:3
    s_waitcnt lgkmcnt(0)
    v_mad_u32_u16 v44, v44, s39, v248 op_sel:[1,0,0,0]
    v_mad_u32_u16 v45, v45, s39, v248 op_sel:[1,0,0,0]
    buffer_load_dwordx4 v44, s[4:7], s47 offen sc1 lds
    buffer_load_dwordx4 v45, s[72:75], s47 offen offset:1024 sc1 lds
    s_branch K2_back_81
K2_rare_86:
    s_cmp_eq_u32 s33, 4
    s_cbranch_scc1 K2_four_88
    s_mov_b32 s49, s48
    s_xor_b32 s45, s44, 256
    s_xor_b32 s46, s44, 512
    s_xor_b32 s47, s44, 768
    s_branch K2_back_87
K2_four_88:
    s_add_u32 s50, s48, 256
    s_mov_b32 s46, s44
    s_mov_b32 s47, s44
    s_branch K2_back_87
K2_g4_89:
    s_add_u32 s51, s48, 384
    v_add_u32 v44, s51, v251
    ds_read2_b32 v[44:45], v44 offset0:1 offset1:3
    s_waitcnt lgkmcnt(0)
    v_mad_u32_u16 v44, v44, s39, v248 op_sel:[1,0,0,0]
    v_mad_u32_u16 v45, v45, s39, v248 op_sel:[1,0,0,0]
    buffer_load_dwordx4 v44, s[4:7], s47 offen sc1 lds
    buffer_load_dwordx4 v45, s[72:75], s47 offen offset:1024 sc1 lds
    s_branch K2_back_90
K2_U10:
    s_setprio 1
    s_add_u32 s38, s38, 1
    v_mov_b32 v254, s52
    v_mov_b32 v255, s38
    s_lshl_b32 s58, s38, 3
    s_add_u32 s58, s58, s20
    s_mov_b64 exec, 1
    ds_write_b32 v254, v255
    s_mov_b64 exec, -1
    s_cmp_lt_u32 s58, s22
    s_cbranch_scc0 K2_dyn_91
K2_back_92:
    s_waitcnt lgkmcnt(4)
    v_lshlrev_b32 v16, 16, v0
    v_and_b32 v17, 0xffff0000, v0
    v_lshlrev_b32 v18, 16, v1
    v_and_b32 v19, 0xffff0000, v1
    v_lshlrev_b32 v20, 16, v2
    v_and_b32 v21, 0xffff0000, v2
    v_lshlrev_b32 v22, 16, v3
    v_and_b32 v23, 0xffff0000, v3
    v_mul_f32_dpp v32, v40, v16 row_newbcast:8 row_mask:0xf bank_mask:0xf
    v_mul_f32_dpp v33, v40, v17 row_newbcast:9 row_mask:0xf bank_mask:0xf
    v_mul_f32_dpp v34, v40, v18 row_newbcast:10 row_mask:0xf bank_mask:0xf
    v_mul_f32_dpp v35, v40, v19 row_newbcast:11 row_mask:0xf bank_mask:0xf
    v_mul_f32_dpp v36, v40, v20 row_newbcast:12 row_mask:0xf bank_mask:0xf
    v_mul_f32_dpp v37, v40, v21 row_newbcast:13 row_mask:0xf bank_mask:0xf
    v_mul_f32_dpp v38, v40, v22 row_newbcast:14 row_mask:0xf bank_mask:0xf
    v_mul_f32_dpp v39, v40, v23 row_newbcast:15 row_mask:0xf bank_mask:0xf
    v_cvt_pk_bf16_f32 v84, v32, v33
    v_cvt_pk_bf16_f32 v85, v34, v35
    v_cvt_pk_bf16_f32 v86, v36, v37
    v_cvt_pk_bf16_f32 v87, v38, v39
    v_mul_f32_dpp v16, v40, v16 row_newbcast:0 row_mask:0xa bank_mask:0xf
    v_mul_f32_dpp v17, v40, v17 row_newbcast:1 row_mask:0xa bank_mask:0xf
    v_mul_f32_dpp v18, v40, v18 row_newbcast:2 row_mask:0xa bank_mask:0xf
    v_mul_f32_dpp v19, v40, v19 row_newbcast:3 row_mask:0xa bank_mask:0xf
    v_mul_f32_dpp v20, v40, v20 row_newbcast:4 row_mask:0xa bank_mask:0xf
    v_mul_f32_dpp v21, v40, v21 row_newbcast:5 row_mask:0xa bank_mask:0xf
    v_mul_f32_dpp v22, v40, v22 row_newbcast:6 row_mask:0xa bank_mask:0xf
    v_mul_f32_dpp v23, v40, v23 row_newbcast:7 row_mask:0xa bank_mask:0xf
    v_cvt_pk_bf16_f32 v80, v16, v17
    v_cvt_pk_bf16_f32 v81, v18, v19
    v_cvt_pk_bf16_f32 v82, v20, v21
    v_cvt_pk_bf16_f32 v83, v22, v23
    v_readlane_b32 s3, v253, s58
    s_lshl_b32 s44, s34, 7
    s_and_b32 s48, s3, 0x3ffff
    s_bfe_u32 s33, s3, 0x30013
    s_mul_i32 s35, s38, 6
    s_cmp_eq_u32 s34, 0
    s_cselect_b32 s35, s35, s48
    s_mov_b32 s45, s44
    s_xor_b32 s47, s44, 256
    s_add_u32 s49, s48, 128
    s_add_u32 s60, s48, 256
    s_cmp_eq_u32 s33, 3
    s_cselect_b32 s46, s44, s47
    s_cselect_b32 s50, s60, s48
    s_sub_u32 s60, s33, 2
    s_cmp_lt_u32 s60, 2
    s_cbranch_scc0 K2_rare_97
K2_back_98:
    v_add_u32 v43, s48, v232
    ds_read_b32 v42, v43
    ds_read_b32 v43, v43 offset:1024
    v_add_u32 v222, s48, v251
    ds_read2_b32 v[222:223], v222 offset0:1 offset1:3
    v_add_u32 v224, s49, v251
    ds_read2_b32 v[224:225], v224 offset0:1 offset1:3
    v_add_u32 v226, s50, v251
    ds_read2_b32 v[226:227], v226 offset0:1 offset1:3
    s_waitcnt lgkmcnt(3)
    v_or_b32 v42, v42, v233
    v_or_b32 v43, v43, v233
    s_cmp_lg_u32 s34, 0
    s_cbranch_scc1 K2_dum_100
    s_cmp_eq_u32 s33, 4
    s_cbranch_scc1 K2_a4_101
K2_b4_103:
    s_add_u32 m0, s48, 512
    s_add_u32 s65, s48, 1536
    buffer_load_dwordx4 v42, s[16:19], 0 offen  lds
    s_mov_b32 m0, s65
    s_mov_b32 exec_hi, 0
    buffer_load_dwordx4 v43, s[16:19], 0 offen  lds
    s_mov_b32 exec_hi, -1
K2_back_102:
    s_waitcnt lgkmcnt(2)
    v_mad_u32_u16 v222, v222, s39, v248 op_sel:[1,0,0,0]
    v_mad_u32_u16 v223, v223, s39, v248 op_sel:[1,0,0,0]
    s_waitcnt lgkmcnt(1)
    v_mad_u32_u16 v224, v224, s39, v248 op_sel:[1,0,0,0]
    v_mad_u32_u16 v225, v225, s39, v248 op_sel:[1,0,0,0]
    s_waitcnt lgkmcnt(0)
    v_mad_u32_u16 v226, v226, s39, v248 op_sel:[1,0,0,0]
    v_mad_u32_u16 v227, v227, s39, v248 op_sel:[1,0,0,0]
    s_waitcnt vmcnt(6)
    v_mfma_f32_32x32x16_bf16 v[8:23], v[80:83], v[176:179], 0
    ds_read_b64_tr_b16 v[184:185], v246 offset:2048
    ds_read_b64_tr_b16 v[186:187], v246 offset:3072
    ds_read_b64_tr_b16 v[188:189], v247 offset:2048
    ds_read_b64_tr_b16 v[190:191], v247 offset:3072
    s_mov_b32 m0, s68
    v_mfma_f32_32x32x16_bf16 v[24:39], v[84:87], v[176:179], 0
    buffer_load_dwordx4 v222, s[4:7], s44 offen sc1 lds
    buffer_load_dwordx4 v223, s[72:75], s44 offen offset:1024 sc1 lds
    v_permlane32_swap_b32 v236, v234
    v_permlane32_swap_b32 v237, v235
    v_mfma_f32_32x32x16_bf16 v[48:63], v[80:83], v[180:183], 0
    v_permlane32_swap_b32 v240, v238
    v_permlane32_swap_b32 v241, v239
    v_add_f32 v236, v236, v234
    v_add_f32 v237, v237, v235
    v_add_f32 v240, -v240, -v238
    v_mfma_f32_32x32x16_bf16 v[64:79], v[84:87], v[180:183], 0
    s_setprio 0
    v_add_f32 v241, -v241, -v239
    s_set_gpr_idx_on s32, gpr_idx(DST)
    s_nop 0
    v_cvt_pk_bf16_f32 v194, v236, v237
    v_cvt_pk_bf16_f32 v195, v240, v241
    s_set_gpr_idx_off
    v_mul_f32 v234, v8, v96
    v_mul_f32 v236, v16, v128
    v_fmac_f32 v234, v9, v97
    v_fmac_f32 v236, v17, v129
    v_fmac_f32 v234, v10, v98
    v_fmac_f32 v236, v18, v130
    v_fmac_f32 v234, v11, v99
    v_fmac_f32 v236, v19, v131
    v_fmac_f32 v234, v12, v100
    v_fmac_f32 v236, v20, v132
    v_fmac_f32 v234, v13, v101
    v_fmac_f32 v236, v21, v133
    v_fmac_f32 v234, v14, v102
    v_fmac_f32 v236, v22, v134
    v_fmac_f32 v234, v15, v103
    v_fmac_f32 v236, v23, v135
    v_mul_f32 v238, v24, v128
    v_mul_f32 v240, v32, v128
    v_fmac_f32 v238, v25, v129
    v_fmac_f32 v240, v33, v129
    v_fmac_f32 v238, v26, v130
    v_fmac_f32 v240, v34, v130
    v_fmac_f32 v238, v27, v131
    v_fmac_f32 v240, v35, v131
    v_fmac_f32 v238, v28, v132
    v_fmac_f32 v240, v36, v132
    v_fmac_f32 v238, v29, v133
    v_fmac_f32 v240, v37, v133
    v_fmac_f32 v238, v30, v134
    v_fmac_f32 v240, v38, v134
    v_fmac_f32 v238, v31, v135
    v_fmac_f32 v240, v39, v135
    v_mul_f32 v235, v48, v104
    v_mul_f32 v237, v56, v136
    v_fmac_f32 v235, v49, v105
    v_fmac_f32 v237, v57, v137
    v_fmac_f32 v235, v50, v106
    v_fmac_f32 v237, v58, v138
    v_fmac_f32 v235, v51, v107
    v_fmac_f32 v237, v59, v139
    v_fmac_f32 v235, v52, v108
    v_fmac_f32 v237, v60, v140
    v_fmac_f32 v235, v53, v109
    v_fmac_f32 v237, v61, v141
    v_fmac_f32 v235, v54, v110
    v_fmac_f32 v237, v62, v142
    v_fmac_f32 v235, v55, v111
    v_fmac_f32 v237, v63, v143
    v_mul_f32 v239, v64, v136
    v_mul_f32 v241, v72, v136
    v_fmac_f32 v239, v65, v137
    v_fmac_f32 v241, v73, v137
    v_fmac_f32 v239, v66, v138
    v_fmac_f32 v241, v74, v138
    v_fmac_f32 v239, v67, v139
    v_fmac_f32 v241, v75, v139
    v_fmac_f32 v239, v68, v140
    v_fmac_f32 v241, v76, v140
    v_fmac_f32 v239, v69, v141
    v_fmac_f32 v241, v77, v141
    v_fmac_f32 v239, v70, v142
    v_fmac_f32 v241, v78, v142
    v_fmac_f32 v239, v71, v143
    v_fmac_f32 v241, v79, v143
    s_setprio 1
    s_waitcnt vmcnt(6) lgkmcnt(0)
    v_mfma_f32_32x32x16_bf16 v[24:39], v[84:87], v[184:187], 0
    ds_read_b64_tr_b16 v[176:177], v246 offset:4096
    ds_read_b64_tr_b16 v[178:179], v246 offset:5120
    ds_read_b64_tr_b16 v[180:181], v247 offset:4096
    ds_read_b64_tr_b16 v[182:183], v247 offset:5120
    s_mov_b32 m0, s69
    v_mfma_f32_32x32x16_bf16 v[8:23], v[80:83], v[184:187], 0
    buffer_load_dwordx4 v224, s[4:7], s45 offen sc1 lds
    buffer_load_dwordx4 v225, s[72:75], s45 offen offset:1024 sc1 lds
    v_permlane32_swap_b32 v234, v236
    v_permlane32_swap_b32 v235, v237
    v_mfma_f32_32x32x16_bf16 v[48:63], v[80:83], v[188:191], 0
    v_permlane32_swap_b32 v238, v239
    v_add_f32 v234, v234, v236
    v_add_f32 v235, v235, v237
    v_add_f32 v238, -v238, -v239
    v_mfma_f32_32x32x16_bf16 v[64:79], v[84:87], v[188:191], 0
    s_setprio 0
    s_set_gpr_idx_on s31, gpr_idx(DST)
    s_nop 0
    v_cvt_pk_bf16_f32 v192, v234, v235
    v_cvt_pk_bf16_f32 v197, v238, v238
    s_set_gpr_idx_off
    v_mul_f32 v236, v24, v160
    v_mul_f32 v238, v32, v160
    v_fmac_f32 v236, v25, v161
    v_fmac_f32 v238, v33, v161
    v_fmac_f32 v236, v26, v162
    v_fmac_f32 v238, v34, v162
    v_fmac_f32 v236, v27, v163
    v_fmac_f32 v238, v35, v163
    v_fmac_f32 v236, v28, v164
    v_fmac_f32 v238, v36, v164
    v_fmac_f32 v236, v29, v165
    v_fmac_f32 v238, v37, v165
    v_fmac_f32 v236, v30, v166
    v_fmac_f32 v238, v38, v166
    v_fmac_f32 v236, v31, v167
    v_fmac_f32 v238, v39, v167
    v_mul_f32 v234, v8, v144
    v_mul_f32 v235, v48, v152
    v_fmac_f32 v234, v9, v145
    v_fmac_f32 v235, v49, v153
    v_fmac_f32 v234, v10, v146
    v_fmac_f32 v235, v50, v154
    v_fmac_f32 v234, v11, v147
    v_fmac_f32 v235, v51, v155
    v_fmac_f32 v234, v12, v148
    v_fmac_f32 v235, v52, v156
    v_fmac_f32 v234, v13, v149
    v_fmac_f32 v235, v53, v157
    v_fmac_f32 v234, v14, v150
    v_fmac_f32 v235, v54, v158
    v_fmac_f32 v234, v15, v151
    v_fmac_f32 v235, v55, v159
    v_mul_f32 v237, v64, v168
    v_mul_f32 v239, v72, v168
    v_fmac_f32 v237, v65, v169
    v_fmac_f32 v239, v73, v169
    v_fmac_f32 v237, v66, v170
    v_fmac_f32 v239, v74, v170
    v_fmac_f32 v237, v67, v171
    v_fmac_f32 v239, v75, v171
    v_fmac_f32 v237, v68, v172
    v_fmac_f32 v239, v76, v172
    v_fmac_f32 v237, v69, v173
    v_fmac_f32 v239, v77, v173
    v_fmac_f32 v237, v70, v174
    v_fmac_f32 v239, v78, v174
    v_fmac_f32 v237, v71, v175
    v_fmac_f32 v239, v79, v175
    s_setprio 1
    s_waitcnt vmcnt(6) lgkmcnt(0)
    v_mfma_f32_32x32x16_bf16 v[24:39], v[80:83], v[176:179], 0
    ds_read_b64_tr_b16 v[184:185], v246 offset:6144
    ds_read_b64_tr_b16 v[186:187], v246 offset:7168
    ds_read_b64_tr_b16 v[188:189], v247 offset:6144
    ds_read_b64_tr_b16 v[190:191], v247 offset:7168
    s_mov_b32 m0, s70
    v_mfma_f32_32x32x16_bf16 v[0:15], v[84:87], v[176:179], 0
    buffer_load_dwordx4 v226, s[4:7], s46 offen sc1 lds
    buffer_load_dwordx4 v227, s[72:75], s46 offen offset:1024 sc1 lds
    v_permlane32_swap_b32 v234, v240
    v_permlane32_swap_b32 v235, v241
    v_add_f32 v234, v234, v240
    v_mfma_f32_32x32x16_bf16 v[40:55], v[84:87], v[180:183], 0
    v_add_f32 v235, v235, v241
    s_set_gpr_idx_on s31, gpr_idx(DST)
    s_nop 0
    v_cvt_pk_bf16_f32 v193, v234, v235
    s_set_gpr_idx_off
    s_sub_u32 s26, s48, s29
    s_mov_b32 s29, s48
    s_mov_b32 s30, s3
    v_mfma_f32_32x32x16_bf16 v[64:79], v[80:83], v[180:183], 0
    s_setprio 0
    s_bfe_u32 s56, s3, 0x40012
    s_cmp_eq_u32 s34, 0
    s_cselect_b32 s56, s56, 0
    v_mul_f32 v240, v24, v144
    v_fmac_f32 v236, v32, v160
    v_fmac_f32 v240, v25, v145
    v_fmac_f32 v236, v33, v161
    v_fmac_f32 v240, v26, v146
    v_fmac_f32 v236, v34, v162
    v_fmac_f32 v240, v27, v147
    v_fmac_f32 v236, v35, v163
    v_fmac_f32 v240, v28, v148
    v_fmac_f32 v236, v36, v164
    v_fmac_f32 v240, v29, v149
    v_fmac_f32 v236, v37, v165
    v_fmac_f32 v240, v30, v150
    v_fmac_f32 v236, v38, v166
    v_fmac_f32 v240, v31, v151
    v_fmac_f32 v236, v39, v167
    v_mul_f32 v234, v0, v112
    v_mul_f32 v235, v40, v120
    v_fmac_f32 v234, v1, v113
    v_fmac_f32 v235, v41, v121
    v_fmac_f32 v234, v2, v114
    v_fmac_f32 v235, v42, v122
    v_fmac_f32 v234, v3, v115
    v_fmac_f32 v235, v43, v123
    v_fmac_f32 v234, v4, v116
    v_fmac_f32 v235, v44, v124
    v_fmac_f32 v234, v5, v117
    v_fmac_f32 v235, v45, v125
    v_fmac_f32 v234, v6, v118
    v_fmac_f32 v235, v46, v126
    v_fmac_f32 v234, v7, v119
    v_fmac_f32 v235, v47, v127
    v_mul_f32 v241, v64, v152
    v_fmac_f32 v237, v72, v168
    v_fmac_f32 v241, v65, v153
    v_fmac_f32 v237, v73, v169
    v_fmac_f32 v241, v66, v154
    v_fmac_f32 v237, v74, v170
    v_fmac_f32 v241, v67, v155
    v_fmac_f32 v237, v75, v171
    v_fmac_f32 v241, v68, v156
    v_fmac_f32 v237, v76, v172
    v_fmac_f32 v241, v69, v157
    v_fmac_f32 v237, v77, v173
    v_fmac_f32 v241, v70, v158
    v_fmac_f32 v237, v78, v174
    v_fmac_f32 v241, v71, v159
    v_fmac_f32 v237, v79, v175
    s_setprio 1
    s_waitcnt vmcnt(4) lgkmcnt(0)
    v_mfma_f32_32x32x16_bf16 v[24:39], v[80:83], v[184:187], 0
    ds_read_b64_tr_b16 v[176:177], v246 offset:0
    ds_read_b64_tr_b16 v[178:179], v246 offset:1024
    ds_read_b64_tr_b16 v[180:181], v247 offset:0
    ds_read_b64_tr_b16 v[182:183], v247 offset:1024
    s_mov_b32 m0, s71
    v_mfma_f32_32x32x16_bf16 v[8:23], v[84:87], v[184:187], v[8:23]
    s_cmp_eq_u32 s33, 4
    s_cbranch_scc1 K2_g4_104
    buffer_load_dwordx4 v224, s[4:7], s47 offen sc1 lds
    buffer_load_dwordx4 v225, s[72:75], s47 offen offset:1024 sc1 lds
K2_back_105:
    v_permlane32_swap_b32 v236, v240
    v_mfma_f32_32x32x16_bf16 v[48:63], v[84:87], v[188:191], v[48:63]
    v_permlane32_swap_b32 v237, v241
    v_add_f32 v236, v236, v240
    v_add_f32 v237, v237, v241
    s_set_gpr_idx_on s31, gpr_idx(DST)
    s_nop 0
    v_cvt_pk_bf16_f32 v196, v236, v237
    s_set_gpr_idx_off
    s_mov_b32 s32, s31
    s_mov_b32 s31, s35
    v_mfma_f32_32x32x16_bf16 v[64:79], v[80:83], v[188:191], 0
    s_setprio 0
    v_mul_f32 v236, v24, v144
    v_fma_f32 v238, v32, v160, -v238
    v_fmac_f32 v236, v25, v145
    v_fmac_f32 v238, v33, v161
    v_fmac_f32 v236, v26, v146
    v_fmac_f32 v238, v34, v162
    v_fmac_f32 v236, v27, v147
    v_fmac_f32 v238, v35, v163
    v_fmac_f32 v236, v28, v148
    v_fmac_f32 v238, v36, v164
    v_fmac_f32 v236, v29, v149
    v_fmac_f32 v238, v37, v165
    v_fmac_f32 v236, v30, v150
    v_fmac_f32 v238, v38, v166
    v_fmac_f32 v236, v31, v151
    v_fmac_f32 v238, v39, v167
    v_add_u32 v249, s26, v249
    v_add_u32 v250, s26, v250
    v_mul_f32 v240, v8, v160
    v_fma_f32 v234, v16, v112, -v234
    v_fmac_f32 v240, v9, v161
    v_fmac_f32 v234, v17, v113
    v_fmac_f32 v240, v10, v162
    v_fmac_f32 v234, v18, v114
    v_fmac_f32 v240, v11, v163
    v_fmac_f32 v234, v19, v115
    v_fmac_f32 v240, v12, v164
    v_fmac_f32 v234, v20, v116
    v_fmac_f32 v240, v13, v165
    v_fmac_f32 v234, v21, v117
    v_fmac_f32 v240, v14, v166
    v_fmac_f32 v234, v22, v118
    v_fmac_f32 v240, v15, v167
    v_fmac_f32 v234, v23, v119
    ds_read_b64_tr_b16 v[0:1], v249 offset:0
    ds_read_b64_tr_b16 v[2:3], v249 offset:32
    ds_read_u16_d16_hi v40, v250 offset:0
    v_mul_f32 v241, v48, v168
    v_fma_f32 v235, v56, v120, -v235
    v_fmac_f32 v241, v49, v169
    v_fmac_f32 v235, v57, v121
    v_fmac_f32 v241, v50, v170
    v_fmac_f32 v235, v58, v122
    v_fmac_f32 v241, v51, v171
    v_fmac_f32 v235, v59, v123
    v_fmac_f32 v241, v52, v172
    v_fmac_f32 v235, v60, v124
    v_fmac_f32 v241, v53, v173
    v_fmac_f32 v235, v61, v125
    v_fmac_f32 v241, v54, v174
    v_fmac_f32 v235, v62, v126
    v_fmac_f32 v241, v55, v175
    v_fmac_f32 v235, v63, v127
    ds_read_b64_tr_b16 v[4:5], v249 offset:512
    ds_read_b64_tr_b16 v[6:7], v249 offset:544
    ds_read_u16_d16_hi v41, v250 offset:128
    v_mul_f32 v237, v64, v152
    v_fma_f32 v239, v72, v168, -v239
    v_fmac_f32 v237, v65, v153
    v_fmac_f32 v239, v73, v169
    v_fmac_f32 v237, v66, v154
    v_fmac_f32 v239, v74, v170
    v_fmac_f32 v237, v67, v155
    v_fmac_f32 v239, v75, v171
    v_fmac_f32 v237, v68, v156
    v_fmac_f32 v239, v76, v172
    v_fmac_f32 v237, v69, v157
    v_fmac_f32 v239, v77, v173
    v_fmac_f32 v237, v70, v158
    v_fmac_f32 v239, v78, v174
    v_fmac_f32 v237, v71, v159
    v_fmac_f32 v239, v79, v175
    s_cmp_eq_u32 s56, 5
    s_cbranch_scc1 K2_U20
    s_cmp_eq_u32 s56, 6
    s_cbranch_scc1 K2_U3h0
    s_branch K2_DSP0
K2_U40:
    s_setprio 1
    ds_read_b64_tr_b16 v[8:9], v249 offset:1024
    ds_read_b64_tr_b16 v[10:11], v249 offset:1056
    ds_read_u16_d16_hi v42, v250 offset:256
    s_lshr_b32 s65, s30, 28
    s_mul_i32 s66, s22, 2080
    s_lshl_b32 s65, s65, 9
    s_add_u32 s65, s65, s66
    s_add_u32 s65, s65, 65536
    s_sub_u32 s65, s65, s29
    s_sub_u32 s65, s65, 512
    v_add_u32 v56, s65, v249
    ds_read_b64_tr_b16 v[12:13], v56 offset:0
    ds_read_b64_tr_b16 v[14:15], v56 offset:32
    ds_read_u16_d16_hi v43, v250 offset:384
    s_waitcnt lgkmcnt(6)
    v_lshlrev_b32 v16, 16, v0
    v_and_b32 v17, 0xffff0000, v0
    v_lshlrev_b32 v18, 16, v1
    v_and_b32 v19, 0xffff0000, v1
    v_lshlrev_b32 v20, 16, v2
    v_and_b32 v21, 0xffff0000, v2
    v_lshlrev_b32 v22, 16, v3
    v_and_b32 v23, 0xffff0000, v3
    v_mul_f32_dpp v32, v40, v16 row_newbcast:8 row_mask:0xf bank_mask:0xf
    v_mul_f32_dpp v33, v40, v17 row_newbcast:9 row_mask:0xf bank_mask:0xf
    v_mul_f32_dpp v34, v40, v18 row_newbcast:10 row_mask:0xf bank_mask:0xf
    v_mul_f32_dpp v35, v40, v19 row_newbcast:11 row_mask:0xf bank_mask:0xf
    v_mul_f32_dpp v36, v40, v20 row_newbcast:12 row_mask:0xf bank_mask:0xf
    v_mul_f32_dpp v37, v40, v21 row_newbcast:13 row_mask:0xf bank_mask:0xf
    v_mul_f32_dpp v38, v40, v22 row_newbcast:14 row_mask:0xf bank_mask:0xf
    v_mul_f32_dpp v39, v40, v23 row_newbcast:15 row_mask:0xf bank_mask:0xf
    v_cvt_pk_bf16_f32 v84, v32, v33
    v_cvt_pk_bf16_f32 v85, v34, v35
    v_cvt_pk_bf16_f32 v86, v36, v37
    v_cvt_pk_bf16_f32 v87, v38, v39
    v_mul_f32_dpp v16, v40, v16 row_newbcast:0 row_mask:0xa bank_mask:0xf
    v_mul_f32_dpp v17, v40, v17 row_newbcast:1 row_mask:0xa bank_mask:0xf
    v_mul_f32_dpp v18, v40, v18 row_newbcast:2 row_mask:0xa bank_mask:0xf
    v_mul_f32_dpp v19, v40, v19 row_newbcast:3 row_mask:0xa bank_mask:0xf
    v_mul_f32_dpp v20, v40, v20 row_newbcast:4 row_mask:0xa bank_mask:0xf
    v_mul_f32_dpp v21, v40, v21 row_newbcast:5 row_mask:0xa bank_mask:0xf
    v_mul_f32_dpp v22, v40, v22 row_newbcast:6 row_mask:0xa bank_mask:0xf
    v_mul_f32_dpp v23, v40, v23 row_newbcast:7 row_mask:0xa bank_mask:0xf
    v_cvt_pk_bf16_f32 v80, v16, v17
    v_cvt_pk_bf16_f32 v81, v18, v19
    v_cvt_pk_bf16_f32 v82, v20, v21
    v_cvt_pk_bf16_f32 v83, v22, v23
    v_lshlrev_b32 v24, 16, v4
    v_and_b32 v25, 0xffff0000, v4
    v_lshlrev_b32 v26, 16, v5
    v_and_b32 v27, 0xffff0000, v5
    v_lshlrev_b32 v28, 16, v6
    v_and_b32 v29, 0xffff0000, v6
    v_lshlrev_b32 v30, 16, v7
    v_and_b32 v31, 0xffff0000, v7
    v_mul_f32_dpp v32, v41, v24 row_newbcast:8 row_mask:0xf bank_mask:0xf
    v_mul_f32_dpp v33, v41, v25 row_newbcast:9 row_mask:0xf bank_mask:0xf
    v_mul_f32_dpp v34, v41, v26 row_newbcast:10 row_mask:0xf bank_mask:0xf
    v_mul_f32_dpp v35, v41, v27 row_newbcast:11 row_mask:0xf bank_mask:0xf
    v_mul_f32_dpp v36, v41, v28 row_newbcast:12 row_mask:0xf bank_mask:0xf
    v_mul_f32_dpp v37, v41, v29 row_newbcast:13 row_mask:0xf bank_mask:0xf
    v_mul_f32_dpp v38, v41, v30 row_newbcast:14 row_mask:0xf bank_mask:0xf
    v_mul_f32_dpp v39, v41, v31 row_newbcast:15 row_mask:0xf bank_mask:0xf
    v_cvt_pk_bf16_f32 v92, v32, v33
    v_cvt_pk_bf16_f32 v93, v34, v35
    v_cvt_pk_bf16_f32 v94, v36, v37
    v_cvt_pk_bf16_f32 v95, v38, v39
    v_mul_f32_dpp v24, v41, v24 row_newbcast:0 row_mask:0xa bank_mask:0xf
    v_mul_f32_dpp v25, v41, v25 row_newbcast:1 row_mask:0xa bank_mask:0xf
    v_mul_f32_dpp v26, v41, v26 row_newbcast:2 row_mask:0xa bank_mask:0xf
    v_mul_f32_dpp v27, v41, v27 row_newbcast:3 row_mask:0xa bank_mask:0xf
    v_mul_f32_dpp v28, v41, v28 row_newbcast:4 row_mask:0xa bank_mask:0xf
    v_mul_f32_dpp v29, v41, v29 row_newbcast:5 row_mask:0xa bank_mask:0xf
    v_mul_f32_dpp v30, v41, v30 row_newbcast:6 row_mask:0xa bank_mask:0xf
    v_mul_f32_dpp v31, v41, v31 row_newbcast:7 row_mask:0xa bank_mask:0xf
    v_cvt_pk_bf16_f32 v88, v24, v25
    v_cvt_pk_bf16_f32 v89, v26, v27
    v_cvt_pk_bf16_f32 v90, v28, v29
    v_cvt_pk_bf16_f32 v91, v30, v31
    s_waitcnt lgkmcnt(3)
    v_lshlrev_b32 v16, 16, v8
    v_and_b32 v17, 0xffff0000, v8
    v_lshlrev_b32 v18, 16, v9
    v_and_b32 v19, 0xffff0000, v9
    v_lshlrev_b32 v20, 16, v10
    v_and_b32 v21, 0xffff0000, v10
    v_lshlrev_b32 v22, 16, v11
    v_and_b32 v23, 0xffff0000, v11
    v_mul_f32_dpp v32, v42, v16 row_newbcast:8 row_mask:0xf bank_mask:0xf
    v_mul_f32_dpp v33, v42, v17 row_newbcast:9 row_mask:0xf bank_mask:0xf
    v_mul_f32_dpp v34, v42, v18 row_newbcast:10 row_mask:0xf bank_mask:0xf
    v_mul_f32_dpp v35, v42, v19 row_newbcast:11 row_mask:0xf bank_mask:0xf
    v_mul_f32_dpp v36, v42, v20 row_newbcast:12 row_mask:0xf bank_mask:0xf
    v_mul_f32_dpp v37, v42, v21 row_newbcast:13 row_mask:0xf bank_mask:0xf
    v_mul_f32_dpp v38, v42, v22 row_newbcast:14 row_mask:0xf bank_mask:0xf
    v_mul_f32_dpp v39, v42, v23 row_newbcast:15 row_mask:0xf bank_mask:0xf
    v_cvt_pk_bf16_f32 v242, v32, v33
    v_cvt_pk_bf16_f32 v243, v34, v35
    v_cvt_pk_bf16_f32 v244, v36, v37
    v_cvt_pk_bf16_f32 v245, v38, v39
    v_mul_f32_dpp v16, v42, v16 row_newbcast:0 row_mask:0xa bank_mask:0xf
    v_mul_f32_dpp v17, v42, v17 row_newbcast:1 row_mask:0xa bank_mask:0xf
    v_mul_f32_dpp v18, v42, v18 row_newbcast:2 row_mask:0xa bank_mask:0xf
    v_mul_f32_dpp v19, v42, v19 row_newbcast:3 row_mask:0xa bank_mask:0xf
    v_mul_f32_dpp v20, v42, v20 row_newbcast:4 row_mask:0xa bank_mask:0xf
    v_mul_f32_dpp v21, v42, v21 row_newbcast:5 row_mask:0xa bank_mask:0xf
    v_mul_f32_dpp v22, v42, v22 row_newbcast:6 row_mask:0xa bank_mask:0xf
    v_mul_f32_dpp v23, v42, v23 row_newbcast:7 row_mask:0xa bank_mask:0xf
    v_cvt_pk_bf16_f32 v228, v16, v17
    v_cvt_pk_bf16_f32 v229, v18, v19
    v_cvt_pk_bf16_f32 v230, v20, v21
    v_cvt_pk_bf16_f32 v231, v22, v23
    s_waitcnt lgkmcnt(0)
    v_lshlrev_b32 v24, 16, v12
    v_and_b32 v25, 0xffff0000, v12
    v_lshlrev_b32 v26, 16, v13
    v_and_b32 v27, 0xffff0000, v13
    v_lshlrev_b32 v28, 16, v14
    v_and_b32 v29, 0xffff0000, v14
    v_lshlrev_b32 v30, 16, v15
    v_and_b32 v31, 0xffff0000, v15
    v_mul_f32_dpp v32, v43, v24 row_newbcast:8 row_mask:0xf bank_mask:0xf
    v_mul_f32_dpp v33, v43, v25 row_newbcast:9 row_mask:0xf bank_mask:0xf
    v_mul_f32_dpp v34, v43, v26 row_newbcast:10 row_mask:0xf bank_mask:0xf
    v_mul_f32_dpp v35, v43, v27 row_newbcast:11 row_mask:0xf bank_mask:0xf
    v_mul_f32_dpp v36, v43, v28 row_newbcast:12 row_mask:0xf bank_mask:0xf
    v_mul_f32_dpp v37, v43, v29 row_newbcast:13 row_mask:0xf bank_mask:0xf
    v_mul_f32_dpp v38, v43, v30 row_newbcast:14 row_mask:0xf bank_mask:0xf
    v_mul_f32_dpp v39, v43, v31 row_newbcast:15 row_mask:0xf bank_mask:0xf
    v_cvt_pk_bf16_f32 v4, v32, v33
    v_cvt_pk_bf16_f32 v5, v34, v35
    v_cvt_pk_bf16_f32 v6, v36, v37
    v_cvt_pk_bf16_f32 v7, v38, v39
    v_mul_f32_dpp v24, v43, v24 row_newbcast:0 row_mask:0xa bank_mask:0xf
    v_mul_f32_dpp v25, v43, v25 row_newbcast:1 row_mask:0xa bank_mask:0xf
    v_mul_f32_dpp v26, v43, v26 row_newbcast:2 row_mask:0xa bank_mask:0xf
    v_mul_f32_dpp v27, v43, v27 row_newbcast:3 row_mask:0xa bank_mask:0xf
    v_mul_f32_dpp v28, v43, v28 row_newbcast:4 row_mask:0xa bank_mask:0xf
    v_mul_f32_dpp v29, v43, v29 row_newbcast:5 row_mask:0xa bank_mask:0xf
    v_mul_f32_dpp v30, v43, v30 row_newbcast:6 row_mask:0xa bank_mask:0xf
    v_mul_f32_dpp v31, v43, v31 row_newbcast:7 row_mask:0xa bank_mask:0xf
    v_cvt_pk_bf16_f32 v0, v24, v25
    v_cvt_pk_bf16_f32 v1, v26, v27
    v_cvt_pk_bf16_f32 v2, v28, v29
    v_cvt_pk_bf16_f32 v3, v30, v31
    s_waitcnt vmcnt(4)
    v_mfma_f32_32x32x16_bf16 v[8:23], v[80:83], v[176:179], 0
    ds_read_b64_tr_b16 v[184:185], v246 offset:2048
    ds_read_b64_tr_b16 v[186:187], v246 offset:3072
    ds_read_b64_tr_b16 v[188:189], v247 offset:2048
    ds_read_b64_tr_b16 v[190:191], v247 offset:3072
    s_mov_b32 m0, s68
    v_mfma_f32_32x32x16_bf16 v[24:39], v[84:87], v[176:179], 0
    buffer_load_dwordx4 v222, s[4:7], s41 offen sc1 lds
    buffer_load_dwordx4 v223, s[72:75], s41 offen offset:1024 sc1 lds
    v_permlane32_swap_b32 v236, v234
    v_permlane32_swap_b32 v237, v235
    s_add_u32 s38, s38, 1
    v_mfma_f32_32x32x16_bf16 v[48:63], v[80:83], v[180:183], 0
    v_permlane32_swap_b32 v240, v238
    v_permlane32_swap_b32 v241, v239
    v_add_f32 v236, v236, v234
    v_add_f32 v237, v237, v235
    v_add_f32 v240, -v240, -v238
    v_mfma_f32_32x32x16_bf16 v[64:79], v[84:87], v[180:183], 0
    v_add_f32 v241, -v241, -v239
    s_set_gpr_idx_on s32, gpr_idx(DST)
    s_nop 0
    v_cvt_pk_bf16_f32 v194, v236, v237
    v_cvt_pk_bf16_f32 v195, v240, v241
    s_set_gpr_idx_off
    v_mov_b32 v254, s52
    s_waitcnt vmcnt(4) lgkmcnt(0)
    v_mfma_f32_32x32x16_bf16 v[8:23], v[88:91], v[184:187], v[8:23]
    ds_read_b64_tr_b16 v[176:177], v246 offset:4096
    ds_read_b64_tr_b16 v[178:179], v246 offset:5120
    ds_read_b64_tr_b16 v[180:181], v247 offset:4096
    ds_read_b64_tr_b16 v[182:183], v247 offset:5120
    v_mov_b32 v255, s38
    s_lshl_b32 s58, s38, 3
    s_mov_b32 m0, s69
    v_mfma_f32_32x32x16_bf16 v[24:39], v[92:95], v[184:187], v[24:39]
    buffer_load_dwordx4 v224, s[4:7], s41 offen sc1 lds
    buffer_load_dwordx4 v225, s[72:75], s41 offen offset:1024 sc1 lds
    s_add_u32 s58, s58, s20
    s_mov_b64 exec, 1
    ds_write_b32 v254, v255
    s_mov_b64 exec, -1
    s_cmp_lt_u32 s58, s22
    s_cbranch_scc0 K2_dyn_106
K2_back_107:
    v_readlane_b32 s3, v253, s58
    s_lshl_b32 s44, s34, 7
    s_and_b32 s48, s3, 0x3ffff
    s_bfe_u32 s33, s3, 0x30013
    s_mul_i32 s35, s38, 6
    s_cmp_eq_u32 s34, 0
    s_cselect_b32 s35, s35, s48
    s_mov_b32 s45, s44
    s_xor_b32 s47, s44, 256
    s_add_u32 s49, s48, 128
    s_add_u32 s60, s48, 256
    s_cmp_eq_u32 s33, 3
    s_cselect_b32 s46, s44, s47
    s_cselect_b32 s50, s60, s48
    s_sub_u32 s60, s33, 2
    s_cmp_lt_u32 s60, 2
    s_cbranch_scc0 K2_rare_112
K2_back_113:
    v_mfma_f32_32x32x16_bf16 v[48:63], v[88:91], v[188:191], v[48:63]
    v_add_u32 v43, s48, v232
    ds_read_b32 v42, v43
    ds_read_b32 v43, v43 offset:1024
    v_mfma_f32_32x32x16_bf16 v[64:79], v[92:95], v[188:191], v[64:79]
    s_waitcnt vmcnt(4) lgkmcnt(3)
    v_mfma_f32_32x32x16_bf16 v[8:23], v[228:231], v[176:179], v[8:23]
    ds_read_b64_tr_b16 v[184:185], v246 offset:6144
    ds_read_b64_tr_b16 v[186:187], v246 offset:7168
    ds_read_b64_tr_b16 v[188:189], v247 offset:6144
    ds_read_b64_tr_b16 v[190:191], v247 offset:7168
    s_mov_b32 m0, s70
    v_mfma_f32_32x32x16_bf16 v[24:39], v[242:245], v[176:179], v[24:39]
    buffer_load_dwordx4 v226, s[4:7], s41 offen sc1 lds
    buffer_load_dwordx4 v227, s[72:75], s41 offen offset:1024 sc1 lds
    v_mfma_f32_32x32x16_bf16 v[48:63], v[228:231], v[180:183], v[48:63]
    v_mfma_f32_32x32x16_bf16 v[64:79], v[242:245], v[180:183], v[64:79]
    s_waitcnt lgkmcnt(4)
    v_or_b32 v42, v42, v233
    v_or_b32 v43, v43, v233
    s_cmp_lg_u32 s34, 0
    s_cbranch_scc1 K2_dum_117
    s_cmp_eq_u32 s33, 4
    s_cbranch_scc1 K2_a4_118
K2_b4_120:
    s_add_u32 m0, s48, 512
    s_add_u32 s65, s48, 1536
    buffer_load_dwordx4 v42, s[16:19], 0 offen  lds
    s_mov_b32 m0, s65
    s_mov_b32 exec_hi, 0
    buffer_load_dwordx4 v43, s[16:19], 0 offen  lds
    s_mov_b32 exec_hi, -1
K2_back_119:
    s_waitcnt vmcnt(6) lgkmcnt(0)
    v_mfma_f32_32x32x16_bf16 v[8:23], v[0:3], v[184:187], v[8:23]
    ds_read_b64_tr_b16 v[176:177], v246 offset:0
    ds_read_b64_tr_b16 v[178:179], v246 offset:1024
    ds_read_b64_tr_b16 v[180:181], v247 offset:0
    ds_read_b64_tr_b16 v[182:183], v247 offset:1024
    s_mov_b32 m0, s71
    v_mfma_f32_32x32x16_bf16 v[24:39], v[4:7], v[184:187], v[24:39]
    buffer_load_dwordx4 v44, s[4:7], s41 offen sc1 lds
    buffer_load_dwordx4 v45, s[72:75], s41 offen offset:1024 sc1 lds
    v_mfma_f32_32x32x16_bf16 v[48:63], v[0:3], v[188:191], v[48:63]
    s_nop 2
    v_mul_f32 v234, v8, v96
    v_mul_f32 v236, v16, v128
    v_fmac_f32 v234, v9, v97
    v_fmac_f32 v236, v17, v129
    v_fmac_f32 v234, v10, v98
    v_fmac_f32 v236, v18, v130
    v_fmac_f32 v234, v11, v99
    v_mfma_f32_32x32x16_bf16 v[64:79], v[4:7], v[188:191], v[64:79]
    s_setprio 0
    v_fmac_f32 v236, v19, v131
    v_fmac_f32 v234, v12, v100
    v_fmac_f32 v236, v20, v132
    v_fmac_f32 v234, v13, v101
    v_fmac_f32 v236, v21, v133
    v_fmac_f32 v234, v14, v102
    v_fmac_f32 v236, v22, v134
    v_fmac_f32 v234, v15, v103
    v_fmac_f32 v236, v23, v135
    v_mul_f32 v238, v24, v128
    v_mul_f32 v240, v32, v128
    v_fmac_f32 v238, v25, v129
    v_fmac_f32 v240, v33, v129
    v_fmac_f32 v238, v26, v130
    v_fmac_f32 v240, v34, v130
    v_fmac_f32 v238, v27, v131
    v_fmac_f32 v240, v35, v131
    v_fmac_f32 v238, v28, v132
    v_fmac_f32 v240, v36, v132
    v_fmac_f32 v238, v29, v133
    v_fmac_f32 v240, v37, v133
    v_fmac_f32 v238, v30, v134
    v_fmac_f32 v240, v38, v134
    v_fmac_f32 v238, v31, v135
    v_fmac_f32 v240, v39, v135
    v_mul_f32 v235, v48, v104
    v_mul_f32 v237, v56, v136
    v_fmac_f32 v235, v49, v105
    v_fmac_f32 v237, v57, v137
    v_fmac_f32 v235, v50, v106
    v_fmac_f32 v237, v58, v138
    v_fmac_f32 v235, v51, v107
    v_fmac_f32 v237, v59, v139
    v_fmac_f32 v235, v52, v108
    v_fmac_f32 v237, v60, v140
    v_fmac_f32 v235, v53, v109
    v_fmac_f32 v237, v61, v141
    v_fmac_f32 v235, v54, v110
    v_fmac_f32 v237, v62, v142
    v_fmac_f32 v235, v55, v111
    v_fmac_f32 v237, v63, v143
    v_mul_f32 v239, v64, v136
    v_mul_f32 v241, v72, v136
    s_setprio 1
    s_waitcnt vmcnt(6) lgkmcnt(0)
    v_mfma_f32_32x32x16_bf16 v[8:23], v[80:83], v[176:179], 0
    ds_read_b64_tr_b16 v[184:185], v246 offset:2048
    ds_read_b64_tr_b16 v[186:187], v246 offset:3072
    ds_read_b64_tr_b16 v[188:189], v247 offset:2048
    ds_read_b64_tr_b16 v[190:191], v247 offset:3072
    v_fmac_f32 v239, v65, v137
    v_fmac_f32 v241, v73, v137
    s_mov_b32 m0, s68
    v_mfma_f32_32x32x16_bf16 v[24:39], v[84:87], v[176:179], 0
    buffer_load_dwordx4 v222, s[4:7], s42 offen sc1 lds
    buffer_load_dwordx4 v223, s[72:75], s42 offen offset:1024 sc1 lds
    v_fmac_f32 v239, v66, v138
    v_fmac_f32 v241, v74, v138
    v_fmac_f32 v239, v67, v139
    v_fmac_f32 v241, v75, v139
    v_fmac_f32 v239, v68, v140
    v_mfma_f32_32x32x16_bf16 v[48:63], v[80:83], v[180:183], 0
    v_fmac_f32 v241, v76, v140
    v_fmac_f32 v239, v69, v141
    v_fmac_f32 v241, v77, v141
    v_fmac_f32 v239, v70, v142
    v_fmac_f32 v241, v78, v142
    v_fmac_f32 v239, v71, v143
    v_fmac_f32 v241, v79, v143
    v_mfma_f32_32x32x16_bf16 v[64:79], v[84:87], v[180:183], 0
    v_permlane32_swap_b32 v234, v236
    v_permlane32_swap_b32 v235, v237
    v_permlane32_swap_b32 v238, v239
    s_waitcnt vmcnt(6) lgkmcnt(0)
    v_mfma_f32_32x32x16_bf16 v[8:23], v[88:91], v[184:187], v[8:23]
    ds_read_b64_tr_b16 v[176:177], v246 offset:4096
    ds_read_b64_tr_b16 v[178:179], v246 offset:5120
    ds_read_b64_tr_b16 v[180:181], v247 offset:4096
    ds_read_b64_tr_b16 v[182:183], v247 offset:5120
    v_add_f32 v234, v234, v236
    v_add_f32 v235, v235, v237
    s_mov_b32 m0, s69
    v_mfma_f32_32x32x16_bf16 v[24:39], v[92:95], v[184:187], v[24:39]
    buffer_load_dwordx4 v224, s[4:7], s42 offen sc1 lds
    buffer_load_dwordx4 v225, s[72:75], s42 offen offset:1024 sc1 lds
    v_add_f32 v238, -v238, -v239
    s_set_gpr_idx_on s31, gpr_idx(DST)
    s_nop 0
    v_cvt_pk_bf16_f32 v192, v234, v235
    v_cvt_pk_bf16_f32 v197, v238, v238
    s_set_gpr_idx_off
    v_mfma_f32_32x32x16_bf16 v[48:63], v[88:91], v[188:191], v[48:63]
    v_mfma_f32_32x32x16_bf16 v[64:79], v[92:95], v[188:191], v[64:79]
    s_waitcnt vmcnt(4) lgkmcnt(0)
    v_mfma_f32_32x32x16_bf16 v[8:23], v[228:231], v[176:179], v[8:23]
    ds_read_b64_tr_b16 v[184:185], v246 offset:6144
    ds_read_b64_tr_b16 v[186:187], v246 offset:7168
    ds_read_b64_tr_b16 v[188:189], v247 offset:6144
    ds_read_b64_tr_b16 v[190:191], v247 offset:7168
    s_mov_b32 m0, s70
    v_mfma_f32_32x32x16_bf16 v[24:39], v[242:245], v[176:179], v[24:39]
    buffer_load_dwordx4 v226, s[4:7], s42 offen sc1 lds
    buffer_load_dwordx4 v227, s[72:75], s42 offen offset:1024 sc1 lds
    v_mfma_f32_32x32x16_bf16 v[48:63], v[228:231], v[180:183], v[48:63]
    v_mfma_f32_32x32x16_bf16 v[64:79], v[242:245], v[180:183], v[64:79]
    s_waitcnt vmcnt(4) lgkmcnt(0)
    v_mfma_f32_32x32x16_bf16 v[8:23], v[0:3], v[184:187], v[8:23]
    ds_read_b64_tr_b16 v[176:177], v246 offset:0
    ds_read_b64_tr_b16 v[178:179], v246 offset:1024
    ds_read_b64_tr_b16 v[180:181], v247 offset:0
    ds_read_b64_tr_b16 v[182:183], v247 offset:1024
    s_mov_b32 m0, s71
    v_mfma_f32_32x32x16_bf16 v[24:39], v[4:7], v[184:187], v[24:39]
    buffer_load_dwordx4 v44, s[4:7], s42 offen sc1 lds
    buffer_load_dwordx4 v45, s[72:75], s42 offen offset:1024 sc1 lds
    v_mfma_f32_32x32x16_bf16 v[48:63], v[0:3], v[188:191], v[48:63]
    s_nop 2
    v_mul_f32 v46, v8, v144
    v_mul_f32 v234, v16, v112
    v_fmac_f32 v46, v9, v145
    v_fmac_f32 v234, v17, v113
    v_fmac_f32 v46, v10, v146
    v_fmac_f32 v234, v18, v114
    v_fmac_f32 v46, v11, v147
    v_mfma_f32_32x32x16_bf16 v[64:79], v[4:7], v[188:191], v[64:79]
    s_setprio 0
    v_fmac_f32 v234, v19, v115
    v_fmac_f32 v46, v12, v148
    v_fmac_f32 v234, v20, v116
    v_fmac_f32 v46, v13, v149
    v_fmac_f32 v234, v21, v117
    v_fmac_f32 v46, v14, v150
    v_fmac_f32 v234, v22, v118
    v_fmac_f32 v46, v15, v151
    v_fmac_f32 v234, v23, v119
    v_mul_f32 v236, v24, v160
    v_mul_f32 v238, v32, v160
    v_fmac_f32 v236, v25, v161
    v_fmac_f32 v238, v33, v161
    v_fmac_f32 v236, v26, v162
    v_fmac_f32 v238, v34, v162
    v_fmac_f32 v236, v27, v163
    v_fmac_f32 v238, v35, v163
    v_fmac_f32 v236, v28, v164
    v_fmac_f32 v238, v36, v164
    v_fmac_f32 v236, v29, v165
    v_fmac_f32 v238, v37, v165
    v_fmac_f32 v236, v30, v166
    v_fmac_f32 v238, v38, v166
    v_fmac_f32 v236, v31, v167
    v_fmac_f32 v238, v39, v167
    v_mul_f32 v47, v48, v152
    v_mul_f32 v235, v56, v120
    v_fmac_f32 v47, v49, v153
    v_fmac_f32 v235, v57, v121
    v_fmac_f32 v47, v50, v154
    v_fmac_f32 v235, v58, v122
    v_fmac_f32 v47, v51, v155
    v_fmac_f32 v235, v59, v123
    v_fmac_f32 v47, v52, v156
    v_fmac_f32 v235, v60, v124
    v_fmac_f32 v47, v53, v157
    v_fmac_f32 v235, v61, v125
    v_fmac_f32 v47, v54, v158
    v_fmac_f32 v235, v62, v126
    v_fmac_f32 v47, v55, v159
    v_fmac_f32 v235, v63, v127
    v_mul_f32 v237, v64, v168
    v_mul_f32 v239, v72, v168
    s_setprio 1
    s_waitcnt vmcnt(4) lgkmcnt(0)
    v_mfma_f32_32x32x16_bf16 v[8:23], v[80:83], v[176:179], 0
    ds_read_b64_tr_b16 v[184:185], v246 offset:2048
    ds_read_b64_tr_b16 v[186:187], v246 offset:3072
    ds_read_b64_tr_b16 v[188:189], v247 offset:2048
    ds_read_b64_tr_b16 v[190:191], v247 offset:3072
    v_fmac_f32 v237, v65, v169
    v_fmac_f32 v239, v73, v169
    s_mov_b32 m0, s68
    v_mfma_f32_32x32x16_bf16 v[24:39], v[84:87], v[176:179], 0
    buffer_load_dwordx4 v222, s[4:7], s43 offen sc1 lds
    buffer_load_dwordx4 v223, s[72:75], s43 offen offset:1024 sc1 lds
    v_fmac_f32 v237, v66, v170
    v_fmac_f32 v239, v74, v170
    v_fmac_f32 v237, v67, v171
    v_fmac_f32 v239, v75, v171
    v_fmac_f32 v237, v68, v172
    v_mfma_f32_32x32x16_bf16 v[48:63], v[80:83], v[180:183], 0
    v_fmac_f32 v239, v76, v172
    v_fmac_f32 v237, v69, v173
    v_fmac_f32 v239, v77, v173
    v_fmac_f32 v237, v70, v174
    v_fmac_f32 v239, v78, v174
    v_fmac_f32 v237, v71, v175
    v_fmac_f32 v239, v79, v175
    v_mfma_f32_32x32x16_bf16 v[64:79], v[84:87], v[180:183], 0
    v_permlane32_swap_b32 v46, v240
    v_permlane32_swap_b32 v47, v241
    v_add_f32 v46, v46, v240
    v_add_f32 v47, v47, v241
    s_waitcnt vmcnt(4) lgkmcnt(0)
    v_mfma_f32_32x32x16_bf16 v[8:23], v[88:91], v[184:187], v[8:23]
    ds_read_b64_tr_b16 v[176:177], v246 offset:4096
    ds_read_b64_tr_b16 v[178:179], v246 offset:5120
    ds_read_b64_tr_b16 v[180:181], v247 offset:4096
    ds_read_b64_tr_b16 v[182:183], v247 offset:5120
    s_mov_b32 m0, s69
    v_mfma_f32_32x32x16_bf16 v[24:39], v[92:95], v[184:187], v[24:39]
    buffer_load_dwordx4 v224, s[4:7], s43 offen sc1 lds
    buffer_load_dwordx4 v225, s[72:75], s43 offen offset:1024 sc1 lds
    s_set_gpr_idx_on s31, gpr_idx(DST)
    s_nop 0
    v_cvt_pk_bf16_f32 v193, v46, v47
    s_set_gpr_idx_off
    v_mfma_f32_32x32x16_bf16 v[48:63], v[88:91], v[188:191], v[48:63]
    v_mfma_f32_32x32x16_bf16 v[64:79], v[92:95], v[188:191], v[64:79]
    s_waitcnt vmcnt(4) lgkmcnt(0)
    v_mfma_f32_32x32x16_bf16 v[8:23], v[228:231], v[176:179], v[8:23]
    ds_read_b64_tr_b16 v[184:185], v246 offset:6144
    ds_read_b64_tr_b16 v[186:187], v246 offset:7168
    ds_read_b64_tr_b16 v[188:189], v247 offset:6144
    ds_read_b64_tr_b16 v[190:191], v247 offset:7168
    s_mov_b32 m0, s70
    v_mfma_f32_32x32x16_bf16 v[24:39], v[242:245], v[176:179], v[24:39]
    buffer_load_dwordx4 v226, s[4:7], s43 offen sc1 lds
    buffer_load_dwordx4 v227, s[72:75], s43 offen offset:1024 sc1 lds
    v_mfma_f32_32x32x16_bf16 v[48:63], v[228:231], v[180:183], v[48:63]
    v_add_u32 v222, s48, v251
    ds_read2_b32 v[222:223], v222 offset0:1 offset1:3
    v_mfma_f32_32x32x16_bf16 v[64:79], v[242:245], v[180:183], v[64:79]
    s_waitcnt vmcnt(4) lgkmcnt(1)
    v_mfma_f32_32x32x16_bf16 v[8:23], v[0:3], v[184:187], v[8:23]
    ds_read_b64_tr_b16 v[176:177], v246 offset:0
    ds_read_b64_tr_b16 v[178:179], v246 offset:1024
    ds_read_b64_tr_b16 v[180:181], v247 offset:0
    ds_read_b64_tr_b16 v[182:183], v247 offset:1024
    s_mov_b32 m0, s71
    v_mfma_f32_32x32x16_bf16 v[24:39], v[4:7], v[184:187], v[24:39]
    buffer_load_dwordx4 v44, s[4:7], s43 offen sc1 lds
    buffer_load_dwordx4 v45, s[72:75], s43 offen offset:1024 sc1 lds
    s_waitcnt lgkmcnt(4)
    v_mad_u32_u16 v222, v222, s39, v248 op_sel:[1,0,0,0]
    v_mad_u32_u16 v223, v223, s39, v248 op_sel:[1,0,0,0]
    v_mfma_f32_32x32x16_bf16 v[48:63], v[0:3], v[188:191], v[48:63]
    v_add_u32 v224, s49, v251
    ds_read2_b32 v[224:225], v224 offset0:1 offset1:3
    v_mul_f32 v46, v8, v144
    v_fmac_f32 v236, v16, v160
    v_fmac_f32 v46, v9, v145
    v_fmac_f32 v236, v17, v161
    v_fmac_f32 v46, v10, v146
    v_mfma_f32_32x32x16_bf16 v[64:79], v[4:7], v[188:191], v[64:79]
    s_setprio 0
    v_fmac_f32 v236, v18, v162
    v_fmac_f32 v46, v11, v147
    v_fmac_f32 v236, v19, v163
    v_fmac_f32 v46, v12, v148
    v_fmac_f32 v236, v20, v164
    v_fmac_f32 v46, v13, v149
    v_fmac_f32 v236, v21, v165
    v_fmac_f32 v46, v14, v150
    v_fmac_f32 v236, v22, v166
    v_fmac_f32 v46, v15, v151
    v_fmac_f32 v236, v23, v167
    v_fma_f32 v234, v24, v112, -v234
    v_mul_f32 v240, v32, v160
    v_fmac_f32 v234, v25, v113
    v_fmac_f32 v240, v33, v161
    v_fmac_f32 v234, v26, v114
    v_fmac_f32 v240, v34, v162
    v_fmac_f32 v234, v27, v115
    v_fmac_f32 v240, v35, v163
    v_fmac_f32 v234, v28, v116
    v_fmac_f32 v240, v36, v164
    v_fmac_f32 v234, v29, v117
    v_fmac_f32 v240, v37, v165
    v_fmac_f32 v234, v30, v118
    v_fmac_f32 v240, v38, v166
    v_fmac_f32 v234, v31, v119
    v_fmac_f32 v240, v39, v167
    v_mul_f32 v47, v48, v152
    v_fmac_f32 v237, v56, v168
    v_fmac_f32 v47, v49, v153
    v_fmac_f32 v237, v57, v169
    v_fmac_f32 v47, v50, v154
    v_fmac_f32 v237, v58, v170
    v_fmac_f32 v47, v51, v155
    v_fmac_f32 v237, v59, v171
    v_fmac_f32 v47, v52, v156
    v_fmac_f32 v237, v60, v172
    v_fmac_f32 v47, v53, v157
    v_fmac_f32 v237, v61, v173
    v_fmac_f32 v47, v54, v158
    v_fmac_f32 v237, v62, v174
    v_fmac_f32 v47, v55, v159
    v_fmac_f32 v237, v63, v175
    v_fma_f32 v235, v64, v120, -v235
    v_mul_f32 v241, v72, v168
    v_fmac_f32 v235, v65, v121
    v_fmac_f32 v241, v73, v169
    v_fmac_f32 v235, v66, v122
    v_fmac_f32 v241, v74, v170
    v_fmac_f32 v235, v67, v123
    s_setprio 1
    s_waitcnt vmcnt(4) lgkmcnt(1)
    v_mfma_f32_32x32x16_bf16 v[8:23], v[80:83], v[176:179], 0
    ds_read_b64_tr_b16 v[184:185], v246 offset:2048
    ds_read_b64_tr_b16 v[186:187], v246 offset:3072
    ds_read_b64_tr_b16 v[188:189], v247 offset:2048
    ds_read_b64_tr_b16 v[190:191], v247 offset:3072
    v_fmac_f32 v241, v75, v171
    v_fmac_f32 v235, v68, v124
    s_mov_b32 m0, s68
    v_mfma_f32_32x32x16_bf16 v[24:39], v[84:87], v[176:179], 0
    buffer_load_dwordx4 v222, s[4:7], s44 offen sc1 lds
    buffer_load_dwordx4 v223, s[72:75], s44 offen offset:1024 sc1 lds
    s_waitcnt lgkmcnt(4)
    v_mad_u32_u16 v224, v224, s39, v248 op_sel:[1,0,0,0]
    v_mad_u32_u16 v225, v225, s39, v248 op_sel:[1,0,0,0]
    v_fmac_f32 v241, v76, v172
    v_fmac_f32 v235, v69, v125
    v_mfma_f32_32x32x16_bf16 v[48:63], v[80:83], v[180:183], 0
    v_add_u32 v226, s50, v251
    ds_read2_b32 v[226:227], v226 offset0:1 offset1:3
    v_fmac_f32 v241, v77, v173
    v_fmac_f32 v235, v70, v126
    v_fmac_f32 v241, v78, v174
    v_fmac_f32 v235, v71, v127
    v_fmac_f32 v241, v79, v175
    v_mfma_f32_32x32x16_bf16 v[64:79], v[84:87], v[180:183], 0
    v_permlane32_swap_b32 v236, v46
    v_permlane32_swap_b32 v237, v47
    v_add_f32 v236, v236, v46
    v_add_f32 v237, v237, v47
    s_waitcnt vmcnt(4) lgkmcnt(1)
    v_mfma_f32_32x32x16_bf16 v[8:23], v[88:91], v[184:187], v[8:23]
    ds_read_b64_tr_b16 v[176:177], v246 offset:4096
    ds_read_b64_tr_b16 v[178:179], v246 offset:5120
    ds_read_b64_tr_b16 v[180:181], v247 offset:4096
    ds_read_b64_tr_b16 v[182:183], v247 offset:5120
    s_mov_b32 m0, s69
    v_mfma_f32_32x32x16_bf16 v[24:39], v[92:95], v[184:187], v[24:39]
    buffer_load_dwordx4 v224, s[4:7], s45 offen sc1 lds
    buffer_load_dwordx4 v225, s[72:75], s45 offen offset:1024 sc1 lds
    s_waitcnt lgkmcnt(4)
    v_mad_u32_u16 v226, v226, s39, v248 op_sel:[1,0,0,0]
    v_mad_u32_u16 v227, v227, s39, v248 op_sel:[1,0,0,0]
    v_mfma_f32_32x32x16_bf16 v[48:63], v[88:91], v[188:191], v[48:63]
    s_set_gpr_idx_on s31, gpr_idx(DST)
    s_nop 0
    v_cvt_pk_bf16_f32 v196, v236, v237
    s_set_gpr_idx_off
    v_mfma_f32_32x32x16_bf16 v[64:79], v[92:95], v[188:191], v[64:79]
    s_waitcnt vmcnt(4) lgkmcnt(0)
    v_mfma_f32_32x32x16_bf16 v[8:23], v[228:231], v[176:179], v[8:23]
    ds_read_b64_tr_b16 v[184:185], v246 offset:6144
    ds_read_b64_tr_b16 v[186:187], v246 offset:7168
    ds_read_b64_tr_b16 v[188:189], v247 offset:6144
    ds_read_b64_tr_b16 v[190:191], v247 offset:7168
    s_mov_b32 s32, s31
    s_mov_b32 s31, s35
    s_mov_b32 m0, s70
    v_mfma_f32_32x32x16_bf16 v[24:39], v[242:245], v[176:179], v[24:39]
    buffer_load_dwordx4 v226, s[4:7], s46 offen sc1 lds
    buffer_load_dwordx4 v227, s[72:75], s46 offen offset:1024 sc1 lds
    s_sub_u32 s26, s48, s29
    s_mov_b32 s29, s48
    s_mov_b32 s30, s3
    s_bfe_u32 s56, s3, 0x40012
    v_mfma_f32_32x32x16_bf16 v[48:63], v[228:231], v[180:183], v[48:63]
    s_cmp_eq_u32 s34, 0
    s_cselect_b32 s56, s56, 0
    v_mfma_f32_32x32x16_bf16 v[64:79], v[242:245], v[180:183], v[64:79]
    s_waitcnt vmcnt(4) lgkmcnt(0)
    v_mfma_f32_32x32x16_bf16 v[8:23], v[0:3], v[184:187], v[8:23]
    ds_read_b64_tr_b16 v[176:177], v246 offset:0
    ds_read_b64_tr_b16 v[178:179], v246 offset:1024
    ds_read_b64_tr_b16 v[180:181], v247 offset:0
    ds_read_b64_tr_b16 v[182:183], v247 offset:1024
    s_mov_b32 m0, s71
    v_mfma_f32_32x32x16_bf16 v[24:39], v[4:7], v[184:187], v[24:39]
    s_cmp_eq_u32 s33, 4
    s_cbranch_scc1 K2_g4_115
    buffer_load_dwordx4 v224, s[4:7], s47 offen sc1 lds
    buffer_load_dwordx4 v225, s[72:75], s47 offen offset:1024 sc1 lds
K2_back_116:
    v_mfma_f32_32x32x16_bf16 v[48:63], v[0:3], v[188:191], v[48:63]
    s_nop 0
    v_mul_f32 v236, v8, v144
    v_fma_f32 v238, v16, v160, -v238
    v_fmac_f32 v236, v9, v145
    v_fmac_f32 v238, v17, v161
    v_fmac_f32 v236, v10, v146
    v_fmac_f32 v238, v18, v162
    v_fmac_f32 v236, v11, v147
    v_mfma_f32_32x32x16_bf16 v[64:79], v[4:7], v[188:191], v[64:79]
    s_setprio 0
    v_fmac_f32 v238, v19, v163
    v_fmac_f32 v236, v12, v148
    v_fmac_f32 v238, v20, v164
    v_fmac_f32 v236, v13, v149
    v_fmac_f32 v238, v21, v165
    v_fmac_f32 v236, v14, v150
    v_fmac_f32 v238, v22, v166
    v_fmac_f32 v236, v15, v151
    v_fmac_f32 v238, v23, v167
    v_add_u32 v249, s26, v249
    v_add_u32 v250, s26, v250
    v_fmac_f32 v240, v24, v160
    v_fma_f32 v234, v32, v112, -v234
    v_fmac_f32 v240, v25, v161
    v_fmac_f32 v234, v33, v113
    v_fmac_f32 v240, v26, v162
    v_fmac_f32 v234, v34, v114
    v_fmac_f32 v240, v27, v163
    v_fmac_f32 v234, v35, v115
    v_fmac_f32 v240, v28, v164
    v_fmac_f32 v234, v36, v116
    v_fmac_f32 v240, v29, v165
    v_fmac_f32 v234, v37, v117
    v_fmac_f32 v240, v30, v166
    v_fmac_f32 v234, v38, v118
    v_fmac_f32 v240, v31, v167
    v_fmac_f32 v234, v39, v119
    ds_read_b64_tr_b16 v[0:1], v249 offset:0
    ds_read_b64_tr_b16 v[2:3], v249 offset:32
    ds_read_u16_d16_hi v40, v250 offset:0
    v_mul_f32 v237, v48, v152
    v_fma_f32 v239, v56, v168, -v239
    v_fmac_f32 v237, v49, v153
    v_fmac_f32 v239, v57, v169
    v_fmac_f32 v237, v50, v154
    v_fmac_f32 v239, v58, v170
    v_fmac_f32 v237, v51, v155
    v_fmac_f32 v239, v59, v171
    v_fmac_f32 v237, v52, v156
    v_fmac_f32 v239, v60, v172
    v_fmac_f32 v237, v53, v157
    v_fmac_f32 v239, v61, v173
    v_fmac_f32 v237, v54, v158
    v_fmac_f32 v239, v62, v174
    v_fmac_f32 v237, v55, v159
    v_fmac_f32 v239, v63, v175
    ds_read_b64_tr_b16 v[4:5], v249 offset:512
    ds_read_b64_tr_b16 v[6:7], v249 offset:544
    ds_read_u16_d16_hi v41, v250 offset:128
    v_fmac_f32 v241, v64, v168
    v_fma_f32 v235, v72, v120, -v235
    v_fmac_f32 v241, v65, v169
    v_fmac_f32 v235, v73, v121
    v_fmac_f32 v241, v66, v170
    v_fmac_f32 v235, v74, v122
    v_fmac_f32 v241, v67, v171
    v_fmac_f32 v235, v75, v123
    v_fmac_f32 v241, v68, v172
    v_fmac_f32 v235, v76, v124
    v_fmac_f32 v241, v69, v173
    v_fmac_f32 v235, v77, v125
    v_fmac_f32 v241, v70, v174
    v_fmac_f32 v235, v78, v126
    v_fmac_f32 v241, v71, v175
    v_fmac_f32 v235, v79, v127
    s_cmp_eq_u32 s56, 5
    s_cbranch_scc1 K2_U20
    s_cmp_eq_u32 s56, 6
    s_cbranch_scc1 K2_U3h0
    s_branch K2_DSP0
K2_U11:
    s_setprio 1
    s_mov_b64 exec, 0x1ff
    ds_add_rtn_u32 v42, v254, v251
    s_mov_b64 exec, -1
    s_waitcnt lgkmcnt(4)
    v_lshlrev_b32 v16, 16, v0
    v_and_b32 v17, 0xffff0000, v0
    v_lshlrev_b32 v18, 16, v1
    v_and_b32 v19, 0xffff0000, v1
    v_lshlrev_b32 v20, 16, v2
    v_and_b32 v21, 0xffff0000, v2
    v_lshlrev_b32 v22, 16, v3
    v_and_b32 v23, 0xffff0000, v3
    v_mul_f32_dpp v32, v40, v16 row_newbcast:8 row_mask:0xf bank_mask:0xf
    v_mul_f32_dpp v33, v40, v17 row_newbcast:9 row_mask:0xf bank_mask:0xf
    v_mul_f32_dpp v34, v40, v18 row_newbcast:10 row_mask:0xf bank_mask:0xf
    v_mul_f32_dpp v35, v40, v19 row_newbcast:11 row_mask:0xf bank_mask:0xf
    v_mul_f32_dpp v36, v40, v20 row_newbcast:12 row_mask:0xf bank_mask:0xf
    v_mul_f32_dpp v37, v40, v21 row_newbcast:13 row_mask:0xf bank_mask:0xf
    v_mul_f32_dpp v38, v40, v22 row_newbcast:14 row_mask:0xf bank_mask:0xf
    v_mul_f32_dpp v39, v40, v23 row_newbcast:15 row_mask:0xf bank_mask:0xf
    v_cvt_pk_bf16_f32 v84, v32, v33
    v_cvt_pk_bf16_f32 v85, v34, v35
    v_cvt_pk_bf16_f32 v86, v36, v37
    v_cvt_pk_bf16_f32 v87, v38, v39
    v_mul_f32_dpp v16, v40, v16 row_newbcast:0 row_mask:0xa bank_mask:0xf
    v_mul_f32_dpp v17, v40, v17 row_newbcast:1 row_mask:0xa bank_mask:0xf
    v_mul_f32_dpp v18, v40, v18 row_newbcast:2 row_mask:0xa bank_mask:0xf
    v_mul_f32_dpp v19, v40, v19 row_newbcast:3 row_mask:0xa bank_mask:0xf
    v_mul_f32_dpp v20, v40, v20 row_newbcast:4 row_mask:0xa bank_mask:0xf
    v_mul_f32_dpp v21, v40, v21 row_newbcast:5 row_mask:0xa bank_mask:0xf
    v_mul_f32_dpp v22, v40, v22 row_newbcast:6 row_mask:0xa bank_mask:0xf
    v_mul_f32_dpp v23, v40, v23 row_newbcast:7 row_mask:0xa bank_mask:0xf
    v_cvt_pk_bf16_f32 v80, v16, v17
    v_cvt_pk_bf16_f32 v81, v18, v19
    v_cvt_pk_bf16_f32 v82, v20, v21
    v_cvt_pk_bf16_f32 v83, v22, v23
    s_waitcnt lgkmcnt(0)
    v_readlane_b32 s58, v42, 8
    s_nop 0
    s_lshr_b32 s58, s58, 4
    s_cmp_lt_u32 s58, s22
    s_cbranch_scc0 K2_nul_121
    v_readlane_b32 s3, v253, s58
    s_nop 0
    s_bfe_u32 s58, s3, 0x60016
    s_and_b32 s59, s58, 7
    s_lshr_b32 s60, s58, 3
K2_chk_123:
    v_readlane_b32 s61, v42, s59
    s_nop 0
    s_cmp_gt_u32 s61, s60
    s_cbranch_scc0 K2_spin_122
K2_back_124:
    s_lshl_b32 s44, s34, 7
    s_and_b32 s48, s3, 0x3ffff
    s_bfe_u32 s33, s3, 0x30013
    s_mov_b32 s35, s48
    s_mov_b32 s45, s44
    s_xor_b32 s47, s44, 256
    s_add_u32 s49, s48, 128
    s_add_u32 s60, s48, 256
    s_cmp_eq_u32 s33, 3
    s_cselect_b32 s46, s44, s47
    s_cselect_b32 s50, s60, s48
    s_sub_u32 s60, s33, 2
    s_cmp_lt_u32 s60, 2
    s_cbranch_scc0 K2_rare_125
K2_back_126:
    v_add_u32 v222, s48, v251
    ds_read2_b32 v[222:223], v222 offset0:1 offset1:3
    v_add_u32 v224, s49, v251
    ds_read2_b32 v[224:225], v224 offset0:1 offset1:3
    v_add_u32 v226, s50, v251
    ds_read2_b32 v[226:227], v226 offset0:1 offset1:3
    s_waitcnt lgkmcnt(2)
    v_mad_u32_u16 v222, v222, s39, v248 op_sel:[1,0,0,0]
    v_mad_u32_u16 v223, v223, s39, v248 op_sel:[1,0,0,0]
    s_waitcnt lgkmcnt(1)
    v_mad_u32_u16 v224, v224, s39, v248 op_sel:[1,0,0,0]
    v_mad_u32_u16 v225, v225, s39, v248 op_sel:[1,0,0,0]
    s_waitcnt lgkmcnt(0)
    v_mad_u32_u16 v226, v226, s39, v248 op_sel:[1,0,0,0]
    v_mad_u32_u16 v227, v227, s39, v248 op_sel:[1,0,0,0]
    s_waitcnt vmcnt(4)
    v_mfma_f32_32x32x16_bf16 v[8:23], v[80:83], v[176:179], 0
    ds_read_b64_tr_b16 v[184:185], v246 offset:2048
    ds_read_b64_tr_b16 v[186:187], v246 offset:3072
    ds_read_b64_tr_b16 v[188:189], v247 offset:2048
    ds_read_b64_tr_b16 v[190:191], v247 offset:3072
    s_mov_b32 m0, s68
    v_mfma_f32_32x32x16_bf16 v[24:39], v[84:87], v[176:179], 0
    buffer_load_dwordx4 v222, s[4:7], s44 offen sc1 lds
    buffer_load_dwordx4 v223, s[72:75], s44 offen offset:1024 sc1 lds
    v_permlane32_swap_b32 v236, v234
    v_permlane32_swap_b32 v237, v235
    v_mfma_f32_32x32x16_bf16 v[48:63], v[80:83], v[180:183], 0
    v_permlane32_swap_b32 v240, v238
    v_permlane32_swap_b32 v241, v239
    v_add_f32 v236, v236, v234
    v_add_f32 v237, v237, v235
    v_add_f32 v240, -v240, -v238
    v_mfma_f32_32x32x16_bf16 v[64:79], v[84:87], v[180:183], 0
    s_setprio 0
    v_add_f32 v241, -v241, -v239
    v_cvt_pk_bf16_f32 v236, v236, v237
    v_cvt_pk_bf16_f32 v240, v240, v241
    ds_write2st64_b32 v232, v236, v240 offset0:2 offset1:3
    v_mul_f32 v234, v8, v96
    v_mul_f32 v236, v16, v128
    v_fmac_f32 v234, v9, v97
    v_fmac_f32 v236, v17, v129
    v_fmac_f32 v234, v10, v98
    v_fmac_f32 v236, v18, v130
    v_fmac_f32 v234, v11, v99
    v_fmac_f32 v236, v19, v131
    v_fmac_f32 v234, v12, v100
    v_fmac_f32 v236, v20, v132
    v_fmac_f32 v234, v13, v101
    v_fmac_f32 v236, v21, v133
    v_fmac_f32 v234, v14, v102
    v_fmac_f32 v236, v22, v134
    v_fmac_f32 v234, v15, v103
    v_fmac_f32 v236, v23, v135
    v_mul_f32 v238, v24, v128
    v_mul_f32 v240, v32, v128
    v_fmac_f32 v238, v25, v129
    v_fmac_f32 v240, v33, v129
    v_fmac_f32 v238, v26, v130
    v_fmac_f32 v240, v34, v130
    v_fmac_f32 v238, v27, v131
    v_fmac_f32 v240, v35, v131
    v_fmac_f32 v238, v28, v132
    v_fmac_f32 v240, v36, v132
    v_fmac_f32 v238, v29, v133
    v_fmac_f32 v240, v37, v133
    v_fmac_f32 v238, v30, v134
    v_fmac_f32 v240, v38, v134
    v_fmac_f32 v238, v31, v135
    v_fmac_f32 v240, v39, v135
    v_mul_f32 v235, v48, v104
    v_mul_f32 v237, v56, v136
    v_fmac_f32 v235, v49, v105
    v_fmac_f32 v237, v57, v137
    v_fmac_f32 v235, v50, v106
    v_fmac_f32 v237, v58, v138
    v_fmac_f32 v235, v51, v107
    v_fmac_f32 v237, v59, v139
    v_fmac_f32 v235, v52, v108
    v_fmac_f32 v237, v60, v140
    v_fmac_f32 v235, v53, v109
    v_fmac_f32 v237, v61, v141
    v_fmac_f32 v235, v54, v110
    v_fmac_f32 v237, v62, v142
    v_fmac_f32 v235, v55, v111
    v_fmac_f32 v237, v63, v143
    v_mul_f32 v239, v64, v136
    v_mul_f32 v241, v72, v136
    v_fmac_f32 v239, v65, v137
    v_fmac_f32 v241, v73, v137
    v_fmac_f32 v239, v66, v138
    v_fmac_f32 v241, v74, v138
    v_fmac_f32 v239, v67, v139
    v_fmac_f32 v241, v75, v139
    v_fmac_f32 v239, v68, v140
    v_fmac_f32 v241, v76, v140
    v_fmac_f32 v239, v69, v141
    v_fmac_f32 v241, v77, v141
    v_fmac_f32 v239, v70, v142
    v_fmac_f32 v241, v78, v142
    v_fmac_f32 v239, v71, v143
    v_fmac_f32 v241, v79, v143
    s_setprio 1
    s_waitcnt vmcnt(4) lgkmcnt(1)
    v_mfma_f32_32x32x16_bf16 v[24:39], v[84:87], v[184:187], 0
    ds_read_b64_tr_b16 v[176:177], v246 offset:4096
    ds_read_b64_tr_b16 v[178:179], v246 offset:5120
    ds_read_b64_tr_b16 v[180:181], v247 offset:4096
    ds_read_b64_tr_b16 v[182:183], v247 offset:5120
    s_mov_b32 m0, s69
    v_mfma_f32_32x32x16_bf16 v[8:23], v[80:83], v[184:187], 0
    buffer_load_dwordx4 v224, s[4:7], s45 offen sc1 lds
    buffer_load_dwordx4 v225, s[72:75], s45 offen offset:1024 sc1 lds
    v_permlane32_swap_b32 v234, v236
    v_permlane32_swap_b32 v235, v237
    v_mfma_f32_32x32x16_bf16 v[48:63], v[80:83], v[188:191], 0
    v_permlane32_swap_b32 v238, v239
    v_lshl_add_u32 v232, v252, 1, s31
    v_add_f32 v234, v234, v236
    v_add_f32 v235, v235, v237
    v_add_f32 v238, -v238, -v239
    v_sub_u32 v239, v232, v233
    v_mfma_f32_32x32x16_bf16 v[64:79], v[84:87], v[188:191], 0
    s_setprio 0
    v_cvt_pk_bf16_f32 v234, v234, v235
    v_cvt_pk_bf16_f32 v238, v238, v238
    ds_write_b32 v232, v234 offset:0
    ds_write_b16 v239, v238 offset:1280
    v_mul_f32 v236, v24, v160
    v_mul_f32 v238, v32, v160
    v_fmac_f32 v236, v25, v161
    v_fmac_f32 v238, v33, v161
    v_fmac_f32 v236, v26, v162
    v_fmac_f32 v238, v34, v162
    v_fmac_f32 v236, v27, v163
    v_fmac_f32 v238, v35, v163
    v_fmac_f32 v236, v28, v164
    v_fmac_f32 v238, v36, v164
    v_fmac_f32 v236, v29, v165
    v_fmac_f32 v238, v37, v165
    v_fmac_f32 v236, v30, v166
    v_fmac_f32 v238, v38, v166
    v_fmac_f32 v236, v31, v167
    v_fmac_f32 v238, v39, v167
    v_mul_f32 v234, v8, v144
    v_mul_f32 v235, v48, v152
    v_fmac_f32 v234, v9, v145
    v_fmac_f32 v235, v49, v153
    v_fmac_f32 v234, v10, v146
    v_fmac_f32 v235, v50, v154
    v_fmac_f32 v234, v11, v147
    v_fmac_f32 v235, v51, v155
    v_fmac_f32 v234, v12, v148
    v_fmac_f32 v235, v52, v156
    v_fmac_f32 v234, v13, v149
    v_fmac_f32 v235, v53, v157
    v_fmac_f32 v234, v14, v150
    v_fmac_f32 v235, v54, v158
    v_fmac_f32 v234, v15, v151
    v_fmac_f32 v235, v55, v159
    v_mul_f32 v237, v64, v168
    v_mul_f32 v239, v72, v168
    v_fmac_f32 v237, v65, v169
    v_fmac_f32 v239, v73, v169
    v_fmac_f32 v237, v66, v170
    v_fmac_f32 v239, v74, v170
    v_fmac_f32 v237, v67, v171
    v_fmac_f32 v239, v75, v171
    v_fmac_f32 v237, v68, v172
    v_fmac_f32 v239, v76, v172
    v_fmac_f32 v237, v69, v173
    v_fmac_f32 v239, v77, v173
    v_fmac_f32 v237, v70, v174
    v_fmac_f32 v239, v78, v174
    v_fmac_f32 v237, v71, v175
    v_fmac_f32 v239, v79, v175
    s_setprio 1
    s_waitcnt vmcnt(4) lgkmcnt(2)
    v_mfma_f32_32x32x16_bf16 v[24:39], v[80:83], v[176:179], 0
    ds_read_b64_tr_b16 v[184:185], v246 offset:6144
    ds_read_b64_tr_b16 v[186:187], v246 offset:7168
    ds_read_b64_tr_b16 v[188:189], v247 offset:6144
    ds_read_b64_tr_b16 v[190:191], v247 offset:7168
    s_mov_b32 s32, s31
    s_mov_b32 s31, s35
    s_mov_b32 m0, s70
    v_mfma_f32_32x32x16_bf16 v[0:15], v[84:87], v[176:179], 0
    buffer_load_dwordx4 v226, s[4:7], s46 offen sc1 lds
    buffer_load_dwordx4 v227, s[72:75], s46 offen offset:1024 sc1 lds
    v_permlane32_swap_b32 v234, v240
    v_permlane32_swap_b32 v235, v241
    v_add_f32 v234, v234, v240
    v_mfma_f32_32x32x16_bf16 v[40:55], v[84:87], v[180:183], 0
    v_add_f32 v235, v235, v241
    v_cvt_pk_bf16_f32 v234, v234, v235
    ds_write_b32 v232, v234 offset:256
    s_sub_u32 s26, s48, s29
    s_mov_b32 s29, s48
    s_mov_b32 s30, s3
    s_bfe_u32 s56, s3, 0x40012
    v_mfma_f32_32x32x16_bf16 v[64:79], v[80:83], v[180:183], 0
    s_setprio 0
    s_cmp_lg_u32 s36, 0
    s_cselect_b32 s56, s56, 0
    v_mul_f32 v240, v24, v144
    v_fmac_f32 v236, v32, v160
    v_fmac_f32 v240, v25, v145
    v_fmac_f32 v236, v33, v161
    v_fmac_f32 v240, v26, v146
    v_fmac_f32 v236, v34, v162
    v_fmac_f32 v240, v27, v147
    v_fmac_f32 v236, v35, v163
    v_fmac_f32 v240, v28, v148
    v_fmac_f32 v236, v36, v164
    v_fmac_f32 v240, v29, v149
    v_fmac_f32 v236, v37, v165
    v_fmac_f32 v240, v30, v150
    v_fmac_f32 v236, v38, v166
    v_fmac_f32 v240, v31, v151
    v_fmac_f32 v236, v39, v167
    v_mul_f32 v234, v0, v112
    v_mul_f32 v235, v40, v120
    v_fmac_f32 v234, v1, v113
    v_fmac_f32 v235, v41, v121
    v_fmac_f32 v234, v2, v114
    v_fmac_f32 v235, v42, v122
    v_fmac_f32 v234, v3, v115
    v_fmac_f32 v235, v43, v123
    v_fmac_f32 v234, v4, v116
    v_fmac_f32 v235, v44, v124
    v_fmac_f32 v234, v5, v117
    v_fmac_f32 v235, v45, v125
    v_fmac_f32 v234, v6, v118
    v_fmac_f32 v235, v46, v126
    v_fmac_f32 v234, v7, v119
    v_fmac_f32 v235, v47, v127
    v_mul_f32 v241, v64, v152
    v_fmac_f32 v237, v72, v168
    v_fmac_f32 v241, v65, v153
    v_fmac_f32 v237, v73, v169
    v_fmac_f32 v241, v66, v154
    v_fmac_f32 v237, v74, v170
    v_fmac_f32 v241, v67, v155
    v_fmac_f32 v237, v75, v171
    v_fmac_f32 v241, v68, v156
    v_fmac_f32 v237, v76, v172
    v_fmac_f32 v241, v69, v157
    v_fmac_f32 v237, v77, v173
    v_fmac_f32 v241, v70, v158
    v_fmac_f32 v237, v78, v174
    v_fmac_f32 v241, v71, v159
    v_fmac_f32 v237, v79, v175
    s_setprio 1
    s_waitcnt vmcnt(4) lgkmcnt(1)
    v_mfma_f32_32x32x16_bf16 v[24:39], v[80:83], v[184:187], 0
    ds_read_b64_tr_b16 v[176:177], v246 offset:0
    ds_read_b64_tr_b16 v[178:179], v246 offset:1024
    ds_read_b64_tr_b16 v[180:181], v247 offset:0
    ds_read_b64_tr_b16 v[182:183], v247 offset:1024
    s_mov_b32 m0, s71
    v_mfma_f32_32x32x16_bf16 v[8:23], v[84:87], v[184:187], v[8:23]
    s_cmp_eq_u32 s33, 4
    s_cbranch_scc1 K2_g4_128
    buffer_load_dwordx4 v224, s[4:7], s47 offen sc1 lds
    buffer_load_dwordx4 v225, s[72:75], s47 offen offset:1024 sc1 lds
K2_back_129:
    v_permlane32_swap_b32 v236, v240
    v_mfma_f32_32x32x16_bf16 v[48:63], v[84:87], v[188:191], v[48:63]
    v_permlane32_swap_b32 v237, v241
    v_add_f32 v236, v236, v240
    v_add_f32 v237, v237, v241
    v_cvt_pk_bf16_f32 v236, v236, v237
    ds_write_b32 v232, v236 offset:1024
    v_mfma_f32_32x32x16_bf16 v[64:79], v[80:83], v[188:191], 0
    s_setprio 0
    v_mul_f32 v236, v24, v144
    v_fma_f32 v238, v32, v160, -v238
    v_fmac_f32 v236, v25, v145
    v_fmac_f32 v238, v33, v161
    v_fmac_f32 v236, v26, v146
    v_fmac_f32 v238, v34, v162
    v_fmac_f32 v236, v27, v147
    v_fmac_f32 v238, v35, v163
    v_fmac_f32 v236, v28, v148
    v_fmac_f32 v238, v36, v164
    v_fmac_f32 v236, v29, v149
    v_fmac_f32 v238, v37, v165
    v_fmac_f32 v236, v30, v150
    v_fmac_f32 v238, v38, v166
    v_fmac_f32 v236, v31, v151
    v_fmac_f32 v238, v39, v167
    v_add_u32 v249, s26, v249
    v_add_u32 v250, s26, v250
    v_mul_f32 v240, v8, v160
    v_fma_f32 v234, v16, v112, -v234
    v_fmac_f32 v240, v9, v161
    v_fmac_f32 v234, v17, v113
    v_fmac_f32 v240, v10, v162
    v_fmac_f32 v234, v18, v114
    v_fmac_f32 v240, v11, v163
    v_fmac_f32 v234, v19, v115
    v_fmac_f32 v240, v12, v164
    v_fmac_f32 v234, v20, v116
    v_fmac_f32 v240, v13, v165
    v_fmac_f32 v234, v21, v117
    v_fmac_f32 v240, v14, v166
    v_fmac_f32 v234, v22, v118
    v_fmac_f32 v240, v15, v167
    v_fmac_f32 v234, v23, v119
    ds_read_b64_tr_b16 v[0:1], v249 offset:0
    ds_read_b64_tr_b16 v[2:3], v249 offset:32
    ds_read_u16_d16_hi v40, v250 offset:0
    v_mul_f32 v241, v48, v168
    v_fma_f32 v235, v56, v120, -v235
    v_fmac_f32 v241, v49, v169
    v_fmac_f32 v235, v57, v121
    v_fmac_f32 v241, v50, v170
    v_fmac_f32 v235, v58, v122
    v_fmac_f32 v241, v51, v171
    v_fmac_f32 v235, v59, v123
    v_fmac_f32 v241, v52, v172
    v_fmac_f32 v235, v60, v124
    v_fmac_f32 v241, v53, v173
    v_fmac_f32 v235, v61, v125
    v_fmac_f32 v241, v54, v174
    v_fmac_f32 v235, v62, v126
    v_fmac_f32 v241, v55, v175
    v_fmac_f32 v235, v63, v127
    ds_read_b64_tr_b16 v[4:5], v249 offset:512
    ds_read_b64_tr_b16 v[6:7], v249 offset:544
    ds_read_u16_d16_hi v41, v250 offset:128
    v_mul_f32 v237, v64, v152
    v_fma_f32 v239, v72, v168, -v239
    v_fmac_f32 v237, v65, v153
    v_fmac_f32 v239, v73, v169
    v_fmac_f32 v237, v66, v154
    v_fmac_f32 v239, v74, v170
    v_fmac_f32 v237, v67, v155
    v_fmac_f32 v239, v75, v171
    v_fmac_f32 v237, v68, v156
    v_fmac_f32 v239, v76, v172
    v_fmac_f32 v237, v69, v157
    v_fmac_f32 v239, v77, v173
    v_fmac_f32 v237, v70, v158
    v_fmac_f32 v239, v78, v174
    v_fmac_f32 v237, v71, v159
    v_fmac_f32 v239, v79, v175
    s_cmp_eq_u32 s56, 5
    s_cbranch_scc1 K2_U21
    s_cmp_eq_u32 s56, 6
    s_cbranch_scc1 K2_U3h1
    s_branch K2_DSP1
K2_U41:
    s_setprio 1
    ds_read_b64_tr_b16 v[8:9], v249 offset:1024
    ds_read_b64_tr_b16 v[10:11], v249 offset:1056
    ds_read_u16_d16_hi v42, v250 offset:256
    s_lshr_b32 s65, s30, 28
    s_mul_i32 s66, s22, 2080
    s_lshl_b32 s65, s65, 9
    s_add_u32 s65, s65, s66
    s_add_u32 s65, s65, 65536
    s_sub_u32 s65, s65, s29
    s_sub_u32 s65, s65, 512
    v_add_u32 v56, s65, v249
    ds_read_b64_tr_b16 v[12:13], v56 offset:0
    ds_read_b64_tr_b16 v[14:15], v56 offset:32
    ds_read_u16_d16_hi v43, v250 offset:384
    s_waitcnt lgkmcnt(6)
    v_lshlrev_b32 v16, 16, v0
    v_and_b32 v17, 0xffff0000, v0
    v_lshlrev_b32 v18, 16, v1
    v_and_b32 v19, 0xffff0000, v1
    v_lshlrev_b32 v20, 16, v2
    v_and_b32 v21, 0xffff0000, v2
    v_lshlrev_b32 v22, 16, v3
    v_and_b32 v23, 0xffff0000, v3
    v_mul_f32_dpp v32, v40, v16 row_newbcast:8 row_mask:0xf bank_mask:0xf
    v_mul_f32_dpp v33, v40, v17 row_newbcast:9 row_mask:0xf bank_mask:0xf
    v_mul_f32_dpp v34, v40, v18 row_newbcast:10 row_mask:0xf bank_mask:0xf
    v_mul_f32_dpp v35, v40, v19 row_newbcast:11 row_mask:0xf bank_mask:0xf
    v_mul_f32_dpp v36, v40, v20 row_newbcast:12 row_mask:0xf bank_mask:0xf
    v_mul_f32_dpp v37, v40, v21 row_newbcast:13 row_mask:0xf bank_mask:0xf
    v_mul_f32_dpp v38, v40, v22 row_newbcast:14 row_mask:0xf bank_mask:0xf
    v_mul_f32_dpp v39, v40, v23 row_newbcast:15 row_mask:0xf bank_mask:0xf
    v_cvt_pk_bf16_f32 v84, v32, v33
    v_cvt_pk_bf16_f32 v85, v34, v35
    v_cvt_pk_bf16_f32 v86, v36, v37
    v_cvt_pk_bf16_f32 v87, v38, v39
    v_mul_f32_dpp v16, v40, v16 row_newbcast:0 row_mask:0xa bank_mask:0xf
    v_mul_f32_dpp v17, v40, v17 row_newbcast:1 row_mask:0xa bank_mask:0xf
    v_mul_f32_dpp v18, v40, v18 row_newbcast:2 row_mask:0xa bank_mask:0xf
    v_mul_f32_dpp v19, v40, v19 row_newbcast:3 row_mask:0xa bank_mask:0xf
    v_mul_f32_dpp v20, v40, v20 row_newbcast:4 row_mask:0xa bank_mask:0xf
    v_mul_f32_dpp v21, v40, v21 row_newbcast:5 row_mask:0xa bank_mask:0xf
    v_mul_f32_dpp v22, v40, v22 row_newbcast:6 row_mask:0xa bank_mask:0xf
    v_mul_f32_dpp v23, v40, v23 row_newbcast:7 row_mask:0xa bank_mask:0xf
    v_cvt_pk_bf16_f32 v80, v16, v17
    v_cvt_pk_bf16_f32 v81, v18, v19
    v_cvt_pk_bf16_f32 v82, v20, v21
    v_cvt_pk_bf16_f32 v83, v22, v23
    v_lshlrev_b32 v24, 16, v4
    v_and_b32 v25, 0xffff0000, v4
    v_lshlrev_b32 v26, 16, v5
    v_and_b32 v27, 0xffff0000, v5
    v_lshlrev_b32 v28, 16, v6
    v_and_b32 v29, 0xffff0000, v6
    v_lshlrev_b32 v30, 16, v7
    v_and_b32 v31, 0xffff0000, v7
    v_mul_f32_dpp v32, v41, v24 row_newbcast:8 row_mask:0xf bank_mask:0xf
    v_mul_f32_dpp v33, v41, v25 row_newbcast:9 row_mask:0xf bank_mask:0xf
    v_mul_f32_dpp v34, v41, v26 row_newbcast:10 row_mask:0xf bank_mask:0xf
    v_mul_f32_dpp v35, v41, v27 row_newbcast:11 row_mask:0xf bank_mask:0xf
    v_mul_f32_dpp v36, v41, v28 row_newbcast:12 row_mask:0xf bank_mask:0xf
    v_mul_f32_dpp v37, v41, v29 row_newbcast:13 row_mask:0xf bank_mask:0xf
    v_mul_f32_dpp v38, v41, v30 row_newbcast:14 row_mask:0xf bank_mask:0xf
    v_mul_f32_dpp v39, v41, v31 row_newbcast:15 row_mask:0xf bank_mask:0xf
    v_cvt_pk_bf16_f32 v92, v32, v33
    v_cvt_pk_bf16_f32 v93, v34, v35
    v_cvt_pk_bf16_f32 v94, v36, v37
    v_cvt_pk_bf16_f32 v95, v38, v39
    v_mul_f32_dpp v24, v41, v24 row_newbcast:0 row_mask:0xa bank_mask:0xf
    v_mul_f32_dpp v25, v41, v25 row_newbcast:1 row_mask:0xa bank_mask:0xf
    v_mul_f32_dpp v26, v41, v26 row_newbcast:2 row_mask:0xa bank_mask:0xf
    v_mul_f32_dpp v27, v41, v27 row_newbcast:3 row_mask:0xa bank_mask:0xf
    v_mul_f32_dpp v28, v41, v28 row_newbcast:4 row_mask:0xa bank_mask:0xf
    v_mul_f32_dpp v29, v41, v29 row_newbcast:5 row_mask:0xa bank_mask:0xf
    v_mul_f32_dpp v30, v41, v30 row_newbcast:6 row_mask:0xa bank_mask:0xf
    v_mul_f32_dpp v31, v41, v31 row_newbcast:7 row_mask:0xa bank_mask:0xf
    v_cvt_pk_bf16_f32 v88, v24, v25
    v_cvt_pk_bf16_f32 v89, v26, v27
    v_cvt_pk_bf16_f32 v90, v28, v29
    v_cvt_pk_bf16_f32 v91, v30, v31
    s_waitcnt lgkmcnt(3)
    v_lshlrev_b32 v16, 16, v8
    v_and_b32 v17, 0xffff0000, v8
    v_lshlrev_b32 v18, 16, v9
    v_and_b32 v19, 0xffff0000, v9
    v_lshlrev_b32 v20, 16, v10
    v_and_b32 v21, 0xffff0000, v10
    v_lshlrev_b32 v22, 16, v11
    v_and_b32 v23, 0xffff0000, v11
    v_mul_f32_dpp v32, v42, v16 row_newbcast:8 row_mask:0xf bank_mask:0xf
    v_mul_f32_dpp v33, v42, v17 row_newbcast:9 row_mask:0xf bank_mask:0xf
    v_mul_f32_dpp v34, v42, v18 row_newbcast:10 row_mask:0xf bank_mask:0xf
    v_mul_f32_dpp v35, v42, v19 row_newbcast:11 row_mask:0xf bank_mask:0xf
    v_mul_f32_dpp v36, v42, v20 row_newbcast:12 row_mask:0xf bank_mask:0xf
    v_mul_f32_dpp v37, v42, v21 row_newbcast:13 row_mask:0xf bank_mask:0xf
    v_mul_f32_dpp v38, v42, v22 row_newbcast:14 row_mask:0xf bank_mask:0xf
    v_mul_f32_dpp v39, v42, v23 row_newbcast:15 row_mask:0xf bank_mask:0xf
    v_cvt_pk_bf16_f32 v242, v32, v33
    v_cvt_pk_bf16_f32 v243, v34, v35
    v_cvt_pk_bf16_f32 v244, v36, v37
    v_cvt_pk_bf16_f32 v245, v38, v39
    v_mul_f32_dpp v16, v42, v16 row_newbcast:0 row_mask:0xa bank_mask:0xf
    v_mul_f32_dpp v17, v42, v17 row_newbcast:1 row_mask:0xa bank_mask:0xf
    v_mul_f32_dpp v18, v42, v18 row_newbcast:2 row_mask:0xa bank_mask:0xf
    v_mul_f32_dpp v19, v42, v19 row_newbcast:3 row_mask:0xa bank_mask:0xf
    v_mul_f32_dpp v20, v42, v20 row_newbcast:4 row_mask:0xa bank_mask:0xf
    v_mul_f32_dpp v21, v42, v21 row_newbcast:5 row_mask:0xa bank_mask:0xf
    v_mul_f32_dpp v22, v42, v22 row_newbcast:6 row_mask:0xa bank_mask:0xf
    v_mul_f32_dpp v23, v42, v23 row_newbcast:7 row_mask:0xa bank_mask:0xf
    v_cvt_pk_bf16_f32 v228, v16, v17
    v_cvt_pk_bf16_f32 v229, v18, v19
    v_cvt_pk_bf16_f32 v230, v20, v21
    v_cvt_pk_bf16_f32 v231, v22, v23
    s_waitcnt lgkmcnt(0)
    v_lshlrev_b32 v24, 16, v12
    v_and_b32 v25, 0xffff0000, v12
    v_lshlrev_b32 v26, 16, v13
    v_and_b32 v27, 0xffff0000, v13
    v_lshlrev_b32 v28, 16, v14
    v_and_b32 v29, 0xffff0000, v14
    v_lshlrev_b32 v30, 16, v15
    v_and_b32 v31, 0xffff0000, v15
    v_mul_f32_dpp v32, v43, v24 row_newbcast:8 row_mask:0xf bank_mask:0xf
    v_mul_f32_dpp v33, v43, v25 row_newbcast:9 row_mask:0xf bank_mask:0xf
    v_mul_f32_dpp v34, v43, v26 row_newbcast:10 row_mask:0xf bank_mask:0xf
    v_mul_f32_dpp v35, v43, v27 row_newbcast:11 row_mask:0xf bank_mask:0xf
    v_mul_f32_dpp v36, v43, v28 row_newbcast:12 row_mask:0xf bank_mask:0xf
    v_mul_f32_dpp v37, v43, v29 row_newbcast:13 row_mask:0xf bank_mask:0xf
    v_mul_f32_dpp v38, v43, v30 row_newbcast:14 row_mask:0xf bank_mask:0xf
    v_mul_f32_dpp v39, v43, v31 row_newbcast:15 row_mask:0xf bank_mask:0xf
    v_cvt_pk_bf16_f32 v4, v32, v33
    v_cvt_pk_bf16_f32 v5, v34, v35
    v_cvt_pk_bf16_f32 v6, v36, v37
    v_cvt_pk_bf16_f32 v7, v38, v39
    v_mul_f32_dpp v24, v43, v24 row_newbcast:0 row_mask:0xa bank_mask:0xf
    v_mul_f32_dpp v25, v43, v25 row_newbcast:1 row_mask:0xa bank_mask:0xf
    v_mul_f32_dpp v26, v43, v26 row_newbcast:2 row_mask:0xa bank_mask:0xf
    v_mul_f32_dpp v27, v43, v27 row_newbcast:3 row_mask:0xa bank_mask:0xf
    v_mul_f32_dpp v28, v43, v28 row_newbcast:4 row_mask:0xa bank_mask:0xf
    v_mul_f32_dpp v29, v43, v29 row_newbcast:5 row_mask:0xa bank_mask:0xf
    v_mul_f32_dpp v30, v43, v30 row_newbcast:6 row_mask:0xa bank_mask:0xf
    v_mul_f32_dpp v31, v43, v31 row_newbcast:7 row_mask:0xa bank_mask:0xf
    v_cvt_pk_bf16_f32 v0, v24, v25
    v_cvt_pk_bf16_f32 v1, v26, v27
    v_cvt_pk_bf16_f32 v2, v28, v29
    v_cvt_pk_bf16_f32 v3, v30, v31
    s_waitcnt vmcnt(4)
    v_mfma_f32_32x32x16_bf16 v[8:23], v[80:83], v[176:179], 0
    ds_read_b64_tr_b16 v[184:185], v246 offset:2048
    ds_read_b64_tr_b16 v[186:187], v246 offset:3072
    ds_read_b64_tr_b16 v[188:189], v247 offset:2048
    ds_read_b64_tr_b16 v[190:191], v247 offset:3072
    s_mov_b32 m0, s68
    v_mfma_f32_32x32x16_bf16 v[24:39], v[84:87], v[176:179], 0
    buffer_load_dwordx4 v222, s[4:7], s41 offen sc1 lds
    buffer_load_dwordx4 v223, s[72:75], s41 offen offset:1024 sc1 lds
    v_permlane32_swap_b32 v236, v234
    v_permlane32_swap_b32 v237, v235
    v_mfma_f32_32x32x16_bf16 v[48:63], v[80:83], v[180:183], 0
    v_permlane32_swap_b32 v240, v238
    v_permlane32_swap_b32 v241, v239
    v_add_f32 v236, v236, v234
    v_add_f32 v237, v237, v235
    v_add_f32 v240, -v240, -v238
    v_mfma_f32_32x32x16_bf16 v[64:79], v[84:87], v[180:183], 0
    v_add_f32 v241, -v241, -v239
    v_cvt_pk_bf16_f32 v236, v236, v237
    v_cvt_pk_bf16_f32 v240, v240, v241
    ds_write2st64_b32 v232, v236, v240 offset0:2 offset1:3
    s_mov_b64 exec, 0x1ff
    ds_add_rtn_u32 v42, v254, v251
    s_mov_b64 exec, -1
    s_waitcnt vmcnt(4) lgkmcnt(2)
    v_mfma_f32_32x32x16_bf16 v[8:23], v[88:91], v[184:187], v[8:23]
    ds_read_b64_tr_b16 v[176:177], v246 offset:4096
    ds_read_b64_tr_b16 v[178:179], v246 offset:5120
    ds_read_b64_tr_b16 v[180:181], v247 offset:4096
    ds_read_b64_tr_b16 v[182:183], v247 offset:5120
    s_mov_b32 m0, s69
    v_mfma_f32_32x32x16_bf16 v[24:39], v[92:95], v[184:187], v[24:39]
    buffer_load_dwordx4 v224, s[4:7], s41 offen sc1 lds
    buffer_load_dwordx4 v225, s[72:75], s41 offen offset:1024 sc1 lds
    s_waitcnt lgkmcnt(4)
    v_readlane_b32 s58, v42, 8
    v_mfma_f32_32x32x16_bf16 v[48:63], v[88:91], v[188:191], v[48:63]
    s_lshr_b32 s58, s58, 4
    s_cmp_lt_u32 s58, s22
    s_cbranch_scc0 K2_nul_130
    v_readlane_b32 s3, v253, s58
    s_nop 0
    s_bfe_u32 s58, s3, 0x60016
    s_and_b32 s59, s58, 7
    s_lshr_b32 s60, s58, 3
K2_chk_132:
    v_readlane_b32 s61, v42, s59
    s_nop 0
    s_cmp_gt_u32 s61, s60
    s_cbranch_scc0 K2_spin_131
K2_back_133:
    v_mfma_f32_32x32x16_bf16 v[64:79], v[92:95], v[188:191], v[64:79]
    s_lshl_b32 s44, s34, 7
    s_and_b32 s48, s3, 0x3ffff
    s_bfe_u32 s33, s3, 0x30013
    s_mov_b32 s35, s48
    s_mov_b32 s45, s44
    s_xor_b32 s47, s44, 256
    s_waitcnt vmcnt(4) lgkmcnt(0)
    v_mfma_f32_32x32x16_bf16 v[8:23], v[228:231], v[176:179], v[8:23]
    ds_read_b64_tr_b16 v[184:185], v246 offset:6144
    ds_read_b64_tr_b16 v[186:187], v246 offset:7168
    ds_read_b64_tr_b16 v[188:189], v247 offset:6144
    ds_read_b64_tr_b16 v[190:191], v247 offset:7168
    s_add_u32 s49, s48, 128
    s_add_u32 s60, s48, 256
    s_mov_b32 m0, s70
    v_mfma_f32_32x32x16_bf16 v[24:39], v[242:245], v[176:179], v[24:39]
    buffer_load_dwordx4 v226, s[4:7], s41 offen sc1 lds
    buffer_load_dwordx4 v227, s[72:75], s41 offen offset:1024 sc1 lds
    s_cmp_eq_u32 s33, 3
    s_cselect_b32 s46, s44, s47
    s_cselect_b32 s50, s60, s48
    v_mfma_f32_32x32x16_bf16 v[48:63], v[228:231], v[180:183], v[48:63]
    s_sub_u32 s60, s33, 2
    s_cmp_lt_u32 s60, 2
    s_cbranch_scc0 K2_rare_134
K2_back_135:
    v_mfma_f32_32x32x16_bf16 v[64:79], v[242:245], v[180:183], v[64:79]
    s_waitcnt vmcnt(4) lgkmcnt(0)
    v_mfma_f32_32x32x16_bf16 v[8:23], v[0:3], v[184:187], v[8:23]
    ds_read_b64_tr_b16 v[176:177], v246 offset:0
    ds_read_b64_tr_b16 v[178:179], v246 offset:1024
    ds_read_b64_tr_b16 v[180:181], v247 offset:0
    ds_read_b64_tr_b16 v[182:183], v247 offset:1024
    s_mov_b32 m0, s71
    v_mfma_f32_32x32x16_bf16 v[24:39], v[4:7], v[184:187], v[24:39]
    buffer_load_dwordx4 v44, s[4:7], s41 offen sc1 lds
    buffer_load_dwordx4 v45, s[72:75], s41 offen offset:1024 sc1 lds
    v_mfma_f32_32x32x16_bf16 v[48:63], v[0:3], v[188:191], v[48:63]
    s_nop 2
    v_mul_f32 v234, v8, v96
    v_mul_f32 v236, v16, v128
    v_fmac_f32 v234, v9, v97
    v_fmac_f32 v236, v17, v129
    v_fmac_f32 v234, v10, v98
    v_fmac_f32 v236, v18, v130
    v_fmac_f32 v234, v11, v99
    v_mfma_f32_32x32x16_bf16 v[64:79], v[4:7], v[188:191], v[64:79]
    s_setprio 0
    v_fmac_f32 v236, v19, v131
    v_fmac_f32 v234, v12, v100
    v_fmac_f32 v236, v20, v132
    v_fmac_f32 v234, v13, v101
    v_fmac_f32 v236, v21, v133
    v_fmac_f32 v234, v14, v102
    v_fmac_f32 v236, v22, v134
    v_fmac_f32 v234, v15, v103
    v_fmac_f32 v236, v23, v135
    v_mul_f32 v238, v24, v128
    v_mul_f32 v240, v32, v128
    v_fmac_f32 v238, v25, v129
    v_fmac_f32 v240, v33, v129
    v_fmac_f32 v238, v26, v130
    v_fmac_f32 v240, v34, v130
    v_fmac_f32 v238, v27, v131
    v_fmac_f32 v240, v35, v131
    v_fmac_f32 v238, v28, v132
    v_fmac_f32 v240, v36, v132
    v_fmac_f32 v238, v29, v133
    v_fmac_f32 v240, v37, v133
    v_fmac_f32 v238, v30, v134
    v_fmac_f32 v240, v38, v134
    v_fmac_f32 v238, v31, v135
    v_fmac_f32 v240, v39, v135
    v_mul_f32 v235, v48, v104
    v_mul_f32 v237, v56, v136
    v_fmac_f32 v235, v49, v105
    v_fmac_f32 v237, v57, v137
    v_fmac_f32 v235, v50, v106
    v_fmac_f32 v237, v58, v138
    v_fmac_f32 v235, v51, v107
    v_fmac_f32 v237, v59, v139
    v_fmac_f32 v235, v52, v108
    v_fmac_f32 v237, v60, v140
    v_fmac_f32 v235, v53, v109
    v_fmac_f32 v237, v61, v141
    v_fmac_f32 v235, v54, v110
    v_fmac_f32 v237, v62, v142
    v_fmac_f32 v235, v55, v111
    v_fmac_f32 v237, v63, v143
    v_mul_f32 v239, v64, v136
    v_mul_f32 v241, v72, v136
    s_setprio 1
    s_waitcnt vmcnt(4) lgkmcnt(0)
    v_mfma_f32_32x32x16_bf16 v[8:23], v[80:83], v[176:179], 0
    ds_read_b64_tr_b16 v[184:185], v246 offset:2048
    ds_read_b64_tr_b16 v[186:187], v246 offset:3072
    ds_read_b64_tr_b16 v[188:189], v247 offset:2048
    ds_read_b64_tr_b16 v[190:191], v247 offset:3072
    v_fmac_f32 v239, v65, v137
    v_fmac_f32 v241, v73, v137
    s_mov_b32 m0, s68
    v_mfma_f32_32x32x16_bf16 v[24:39], v[84:87], v[176:179], 0
    buffer_load_dwordx4 v222, s[4:7], s42 offen sc1 lds
    buffer_load_dwordx4 v223, s[72:75], s42 offen offset:1024 sc1 lds
    v_fmac_f32 v239, v66, v138
    v_fmac_f32 v241, v74, v138
    v_fmac_f32 v239, v67, v139
    v_fmac_f32 v241, v75, v139
    v_fmac_f32 v239, v68, v140
    v_mfma_f32_32x32x16_bf16 v[48:63], v[80:83], v[180:183], 0
    v_fmac_f32 v241, v76, v140
    v_fmac_f32 v239, v69, v141
    v_fmac_f32 v241, v77, v141
    v_fmac_f32 v239, v70, v142
    v_fmac_f32 v241, v78, v142
    v_fmac_f32 v239, v71, v143
    v_fmac_f32 v241, v79, v143
    v_mfma_f32_32x32x16_bf16 v[64:79], v[84:87], v[180:183], 0
    v_permlane32_swap_b32 v234, v236
    v_permlane32_swap_b32 v235, v237
    v_permlane32_swap_b32 v238, v239
    s_waitcnt vmcnt(4) lgkmcnt(0)
    v_mfma_f32_32x32x16_bf16 v[8:23], v[88:91], v[184:187], v[8:23]
    ds_read_b64_tr_b16 v[176:177], v246 offset:4096
    ds_read_b64_tr_b16 v[178:179], v246 offset:5120
    ds_read_b64_tr_b16 v[180:181], v247 offset:4096
    ds_read_b64_tr_b16 v[182:183], v247 offset:5120
    v_lshl_add_u32 v232, v252, 1, s31
    v_add_f32 v234, v234, v236
    s_mov_b32 m0, s69
    v_mfma_f32_32x32x16_bf16 v[24:39], v[92:95], v[184:187], v[24:39]
    buffer_load_dwordx4 v224, s[4:7], s42 offen sc1 lds
    buffer_load_dwordx4 v225, s[72:75], s42 offen offset:1024 sc1 lds
    v_add_f32 v235, v235, v237
    v_add_f32 v238, -v238, -v239
    v_sub_u32 v239, v232, v233
    v_cvt_pk_bf16_f32 v234, v234, v235
    v_cvt_pk_bf16_f32 v238, v238, v238
    v_mfma_f32_32x32x16_bf16 v[48:63], v[88:91], v[188:191], v[48:63]
    ds_write_b32 v232, v234 offset:0
    ds_write_b16 v239, v238 offset:1280
    v_mfma_f32_32x32x16_bf16 v[64:79], v[92:95], v[188:191], v[64:79]
    s_waitcnt vmcnt(4) lgkmcnt(2)
    v_mfma_f32_32x32x16_bf16 v[8:23], v[228:231], v[176:179], v[8:23]
    ds_read_b64_tr_b16 v[184:185], v246 offset:6144
    ds_read_b64_tr_b16 v[186:187], v246 offset:7168
    ds_read_b64_tr_b16 v[188:189], v247 offset:6144
    ds_read_b64_tr_b16 v[190:191], v247 offset:7168
    s_mov_b32 m0, s70
    v_mfma_f32_32x32x16_bf16 v[24:39], v[242:245], v[176:179], v[24:39]
    buffer_load_dwordx4 v226, s[4:7], s42 offen sc1 lds
    buffer_load_dwordx4 v227, s[72:75], s42 offen offset:1024 sc1 lds
    v_mfma_f32_32x32x16_bf16 v[48:63], v[228:231], v[180:183], v[48:63]
    v_mfma_f32_32x32x16_bf16 v[64:79], v[242:245], v[180:183], v[64:79]
    s_waitcnt vmcnt(4) lgkmcnt(0)
    v_mfma_f32_32x32x16_bf16 v[8:23], v[0:3], v[184:187], v[8:23]
    ds_read_b64_tr_b16 v[176:177], v246 offset:0
    ds_read_b64_tr_b16 v[178:179], v246 offset:1024
    ds_read_b64_tr_b16 v[180:181], v247 offset:0
    ds_read_b64_tr_b16 v[182:183], v247 offset:1024
    s_mov_b32 m0, s71
    v_mfma_f32_32x32x16_bf16 v[24:39], v[4:7], v[184:187], v[24:39]
    buffer_load_dwordx4 v44, s[4:7], s42 offen sc1 lds
    buffer_load_dwordx4 v45, s[72:75], s42 offen offset:1024 sc1 lds
    v_mfma_f32_32x32x16_bf16 v[48:63], v[0:3], v[188:191], v[48:63]
    s_nop 2
    v_mul_f32 v46, v8, v144
    v_mul_f32 v234, v16, v112
    v_fmac_f32 v46, v9, v145
    v_fmac_f32 v234, v17, v113
    v_fmac_f32 v46, v10, v146
    v_fmac_f32 v234, v18, v114
    v_fmac_f32 v46, v11, v147
    v_mfma_f32_32x32x16_bf16 v[64:79], v[4:7], v[188:191], v[64:79]
    s_setprio 0
    v_fmac_f32 v234, v19, v115
    v_fmac_f32 v46, v12, v148
    v_fmac_f32 v234, v20, v116
    v_fmac_f32 v46, v13, v149
    v_fmac_f32 v234, v21, v117
    v_fmac_f32 v46, v14, v150
    v_fmac_f32 v234, v22, v118
    v_fmac_f32 v46, v15, v151
    v_fmac_f32 v234, v23, v119
    v_mul_f32 v236, v24, v160
    v_mul_f32 v238, v32, v160
    v_fmac_f32 v236, v25, v161
    v_fmac_f32 v238, v33, v161
    v_fmac_f32 v236, v26, v162
    v_fmac_f32 v238, v34, v162
    v_fmac_f32 v236, v27, v163
    v_fmac_f32 v238, v35, v163
    v_fmac_f32 v236, v28, v164
    v_fmac_f32 v238, v36, v164
    v_fmac_f32 v236, v29, v165
    v_fmac_f32 v238, v37, v165
    v_fmac_f32 v236, v30, v166
    v_fmac_f32 v238, v38, v166
    v_fmac_f32 v236, v31, v167
    v_fmac_f32 v238, v39, v167
    v_mul_f32 v47, v48, v152
    v_mul_f32 v235, v56, v120
    v_fmac_f32 v47, v49, v153
    v_fmac_f32 v235, v57, v121
    v_fmac_f32 v47, v50, v154
    v_fmac_f32 v235, v58, v122
    v_fmac_f32 v47, v51, v155
    v_fmac_f32 v235, v59, v123
    v_fmac_f32 v47, v52, v156
    v_fmac_f32 v235, v60, v124
    v_fmac_f32 v47, v53, v157
    v_fmac_f32 v235, v61, v125
    v_fmac_f32 v47, v54, v158
    v_fmac_f32 v235, v62, v126
    v_fmac_f32 v47, v55, v159
    v_fmac_f32 v235, v63, v127
    v_mul_f32 v237, v64, v168
    v_mul_f32 v239, v72, v168
    s_setprio 1
    s_waitcnt vmcnt(4) lgkmcnt(0)
    v_mfma_f32_32x32x16_bf16 v[8:23], v[80:83], v[176:179], 0
    ds_read_b64_tr_b16 v[184:185], v246 offset:2048
    ds_read_b64_tr_b16 v[186:187], v246 offset:3072
    ds_read_b64_tr_b16 v[188:189], v247 offset:2048
    ds_read_b64_tr_b16 v[190:191], v247 offset:3072
    v_fmac_f32 v237, v65, v169
    v_fmac_f32 v239, v73, v169
    s_mov_b32 m0, s68
    v_mfma_f32_32x32x16_bf16 v[24:39], v[84:87], v[176:179], 0
    buffer_load_dwordx4 v222, s[4:7], s43 offen sc1 lds
    buffer_load_dwordx4 v223, s[72:75], s43 offen offset:1024 sc1 lds
    v_fmac_f32 v237, v66, v170
    v_fmac_f32 v239, v74, v170
    v_fmac_f32 v237, v67, v171
    v_fmac_f32 v239, v75, v171
    v_fmac_f32 v237, v68, v172
    v_mfma_f32_32x32x16_bf16 v[48:63], v[80:83], v[180:183], 0
    v_fmac_f32 v239, v76, v172
    v_fmac_f32 v237, v69, v173
    v_fmac_f32 v239, v77, v173
    v_fmac_f32 v237, v70, v174
    v_fmac_f32 v239, v78, v174
    v_fmac_f32 v237, v71, v175
    v_fmac_f32 v239, v79, v175
    v_mfma_f32_32x32x16_bf16 v[64:79], v[84:87], v[180:183], 0
    v_permlane32_swap_b32 v46, v240
    v_permlane32_swap_b32 v47, v241
    v_add_f32 v46, v46, v240
    v_add_f32 v47, v47, v241
    s_waitcnt vmcnt(4) lgkmcnt(0)
    v_mfma_f32_32x32x16_bf16 v[8:23], v[88:91], v[184:187], v[8:23]
    ds_read_b64_tr_b16 v[176:177], v246 offset:4096
    ds_read_b64_tr_b16 v[178:179], v246 offset:5120
    ds_read_b64_tr_b16 v[180:181], v247 offset:4096
    ds_read_b64_tr_b16 v[182:183], v247 offset:5120
    v_cvt_pk_bf16_f32 v46, v46, v47
    ds_write_b32 v232, v46 offset:256
    s_mov_b32 m0, s69
    v_mfma_f32_32x32x16_bf16 v[24:39], v[92:95], v[184:187], v[24:39]
    buffer_load_dwordx4 v224, s[4:7], s43 offen sc1 lds
    buffer_load_dwordx4 v225, s[72:75], s43 offen offset:1024 sc1 lds
    v_mfma_f32_32x32x16_bf16 v[48:63], v[88:91], v[188:191], v[48:63]
    v_mfma_f32_32x32x16_bf16 v[64:79], v[92:95], v[188:191], v[64:79]
    s_waitcnt vmcnt(4) lgkmcnt(1)
    v_mfma_f32_32x32x16_bf16 v[8:23], v[228:231], v[176:179], v[8:23]
    ds_read_b64_tr_b16 v[184:185], v246 offset:6144
    ds_read_b64_tr_b16 v[186:187], v246 offset:7168
    ds_read_b64_tr_b16 v[188:189], v247 offset:6144
    ds_read_b64_tr_b16 v[190:191], v247 offset:7168
    s_mov_b32 m0, s70
    v_mfma_f32_32x32x16_bf16 v[24:39], v[242:245], v[176:179], v[24:39]
    buffer_load_dwordx4 v226, s[4:7], s43 offen sc1 lds
    buffer_load_dwordx4 v227, s[72:75], s43 offen offset:1024 sc1 lds
    v_mfma_f32_32x32x16_bf16 v[48:63], v[228:231], v[180:183], v[48:63]
    v_add_u32 v222, s48, v251
    ds_read2_b32 v[222:223], v222 offset0:1 offset1:3
    v_mfma_f32_32x32x16_bf16 v[64:79], v[242:245], v[180:183], v[64:79]
    s_waitcnt vmcnt(4) lgkmcnt(1)
    v_mfma_f32_32x32x16_bf16 v[8:23], v[0:3], v[184:187], v[8:23]
    ds_read_b64_tr_b16 v[176:177], v246 offset:0
    ds_read_b64_tr_b16 v[178:179], v246 offset:1024
    ds_read_b64_tr_b16 v[180:181], v247 offset:0
    ds_read_b64_tr_b16 v[182:183], v247 offset:1024
    s_mov_b32 m0, s71
    v_mfma_f32_32x32x16_bf16 v[24:39], v[4:7], v[184:187], v[24:39]
    buffer_load_dwordx4 v44, s[4:7], s43 offen sc1 lds
    buffer_load_dwordx4 v45, s[72:75], s43 offen offset:1024 sc1 lds
    s_waitcnt lgkmcnt(4)
    v_mad_u32_u16 v222, v222, s39, v248 op_sel:[1,0,0,0]
    v_mad_u32_u16 v223, v223, s39, v248 op_sel:[1,0,0,0]
    v_mfma_f32_32x32x16_bf16 v[48:63], v[0:3], v[188:191], v[48:63]
    v_add_u32 v224, s49, v251
    ds_read2_b32 v[224:225], v224 offset0:1 offset1:3
    v_mul_f32 v46, v8, v144
    v_fmac_f32 v236, v16, v160
    v_fmac_f32 v46, v9, v145
    v_fmac_f32 v236, v17, v161
    v_fmac_f32 v46, v10, v146
    v_mfma_f32_32x32x16_bf16 v[64:79], v[4:7], v[188:191], v[64:79]
    s_setprio 0
    v_fmac_f32 v236, v18, v162
    v_fmac_f32 v46, v11, v147
    v_fmac_f32 v236, v19, v163
    v_fmac_f32 v46, v12, v148
    v_fmac_f32 v236, v20, v164
    v_fmac_f32 v46, v13, v149
    v_fmac_f32 v236, v21, v165
    v_fmac_f32 v46, v14, v150
    v_fmac_f32 v236, v22, v166
    v_fmac_f32 v46, v15, v151
    v_fmac_f32 v236, v23, v167
    v_fma_f32 v234, v24, v112, -v234
    v_mul_f32 v240, v32, v160
    v_fmac_f32 v234, v25, v113
    v_fmac_f32 v240, v33, v161
    v_fmac_f32 v234, v26, v114
    v_fmac_f32 v240, v34, v162
    v_fmac_f32 v234, v27, v115
    v_fmac_f32 v240, v35, v163
    v_fmac_f32 v234, v28, v116
    v_fmac_f32 v240, v36, v164
    v_fmac_f32 v234, v29, v117
    v_fmac_f32 v240, v37, v165
    v_fmac_f32 v234, v30, v118
    v_fmac_f32 v240, v38, v166
    v_fmac_f32 v234, v31, v119
    v_fmac_f32 v240, v39, v167
    v_mul_f32 v47, v48, v152
    v_fmac_f32 v237, v56, v168
    v_fmac_f32 v47, v49, v153
    v_fmac_f32 v237, v57, v169
    v_fmac_f32 v47, v50, v154
    v_fmac_f32 v237, v58, v170
    v_fmac_f32 v47, v51, v155
    v_fmac_f32 v237, v59, v171
    v_fmac_f32 v47, v52, v156
    v_fmac_f32 v237, v60, v172
    v_fmac_f32 v47, v53, v157
    v_fmac_f32 v237, v61, v173
    v_fmac_f32 v47, v54, v158
    v_fmac_f32 v237, v62, v174
    v_fmac_f32 v47, v55, v159
    v_fmac_f32 v237, v63, v175
    v_fma_f32 v235, v64, v120, -v235
    v_mul_f32 v241, v72, v168
    v_fmac_f32 v235, v65, v121
    v_fmac_f32 v241, v73, v169
    v_fmac_f32 v235, v66, v122
    v_fmac_f32 v241, v74, v170
    v_fmac_f32 v235, v67, v123
    s_setprio 1
    s_waitcnt vmcnt(4) lgkmcnt(1)
    v_mfma_f32_32x32x16_bf16 v[8:23], v[80:83], v[176:179], 0
    ds_read_b64_tr_b16 v[184:185], v246 offset:2048
    ds_read_b64_tr_b16 v[186:187], v246 offset:3072
    ds_read_b64_tr_b16 v[188:189], v247 offset:2048
    ds_read_b64_tr_b16 v[190:191], v247 offset:3072
    v_fmac_f32 v241, v75, v171
    v_fmac_f32 v235, v68, v124
    s_mov_b32 m0, s68
    v_mfma_f32_32x32x16_bf16 v[24:39], v[84:87], v[176:179], 0
    buffer_load_dwordx4 v222, s[4:7], s44 offen sc1 lds
    buffer_load_dwordx4 v223, s[72:75], s44 offen offset:1024 sc1 lds
    s_waitcnt lgkmcnt(4)
    v_mad_u32_u16 v224, v224, s39, v248 op_sel:[1,0,0,0]
    v_mad_u32_u16 v225, v225, s39, v248 op_sel:[1,0,0,0]
    v_fmac_f32 v241, v76, v172
    v_fmac_f32 v235, v69, v125
    v_mfma_f32_32x32x16_bf16 v[48:63], v[80:83], v[180:183], 0
    v_add_u32 v226, s50, v251
    ds_read2_b32 v[226:227], v226 offset0:1 offset1:3
    v_fmac_f32 v241, v77, v173
    v_fmac_f32 v235, v70, v126
    v_fmac_f32 v241, v78, v174
    v_fmac_f32 v235, v71, v127
    v_fmac_f32 v241, v79, v175
    v_mfma_f32_32x32x16_bf16 v[64:79], v[84:87], v[180:183], 0
    v_permlane32_swap_b32 v236, v46
    v_permlane32_swap_b32 v237, v47
    v_add_f32 v236, v236, v46
    v_add_f32 v237, v237, v47
    s_waitcnt vmcnt(4) lgkmcnt(1)
    v_mfma_f32_32x32x16_bf16 v[8:23], v[88:91], v[184:187], v[8:23]
    ds_read_b64_tr_b16 v[176:177], v246 offset:4096
    ds_read_b64_tr_b16 v[178:179], v246 offset:5120
    ds_read_b64_tr_b16 v[180:181], v247 offset:4096
    ds_read_b64_tr_b16 v[182:183], v247 offset:5120
    v_cvt_pk_bf16_f32 v236, v236, v237
    ds_write_b32 v232, v236 offset:1024
    s_mov_b32 m0, s69
    v_mfma_f32_32x32x16_bf16 v[24:39], v[92:95], v[184:187], v[24:39]
    buffer_load_dwordx4 v224, s[4:7], s45 offen sc1 lds
    buffer_load_dwordx4 v225, s[72:75], s45 offen offset:1024 sc1 lds
    s_waitcnt lgkmcnt(5)
    v_mad_u32_u16 v226, v226, s39, v248 op_sel:[1,0,0,0]
    v_mad_u32_u16 v227, v227, s39, v248 op_sel:[1,0,0,0]
    v_mfma_f32_32x32x16_bf16 v[48:63], v[88:91], v[188:191], v[48:63]
    v_mfma_f32_32x32x16_bf16 v[64:79], v[92:95], v[188:191], v[64:79]
    s_waitcnt vmcnt(4) lgkmcnt(1)
    v_mfma_f32_32x32x16_bf16 v[8:23], v[228:231], v[176:179], v[8:23]
    ds_read_b64_tr_b16 v[184:185], v246 offset:6144
    ds_read_b64_tr_b16 v[186:187], v246 offset:7168
    ds_read_b64_tr_b16 v[188:189], v247 offset:6144
    ds_read_b64_tr_b16 v[190:191], v247 offset:7168
    s_mov_b32 s32, s31
    s_mov_b32 s31, s35
    s_mov_b32 m0, s70
    v_mfma_f32_32x32x16_bf16 v[24:39], v[242:245], v[176:179], v[24:39]
    buffer_load_dwordx4 v226, s[4:7], s46 offen sc1 lds
    buffer_load_dwordx4 v227, s[72:75], s46 offen offset:1024 sc1 lds
    s_sub_u32 s26, s48, s29
    s_mov_b32 s29, s48
    s_mov_b32 s30, s3
    s_bfe_u32 s56, s3, 0x40012
    v_mfma_f32_32x32x16_bf16 v[48:63], v[228:231], v[180:183], v[48:63]
    s_cmp_lg_u32 s36, 0
    s_cselect_b32 s56, s56, 0
    v_mfma_f32_32x32x16_bf16 v[64:79], v[242:245], v[180:183], v[64:79]
    s_waitcnt vmcnt(4) lgkmcnt(0)
    v_mfma_f32_32x32x16_bf16 v[8:23], v[0:3], v[184:187], v[8:23]
    ds_read_b64_tr_b16 v[176:177], v246 offset:0
    ds_read_b64_tr_b16 v[178:179], v246 offset:1024
    ds_read_b64_tr_b16 v[180:181], v247 offset:0
    ds_read_b64_tr_b16 v[182:183], v247 offset:1024
    s_mov_b32 m0, s71
    v_mfma_f32_32x32x16_bf16 v[24:39], v[4:7], v[184:187], v[24:39]
    s_cmp_eq_u32 s33, 4
    s_cbranch_scc1 K2_g4_137
    buffer_load_dwordx4 v224, s[4:7], s47 offen sc1 lds
    buffer_load_dwordx4 v225, s[72:75], s47 offen offset:1024 sc1 lds
K2_back_138:
    v_mfma_f32_32x32x16_bf16 v[48:63], v[0:3], v[188:191], v[48:63]
    s_nop 0
    v_mul_f32 v236, v8, v144
    v_fma_f32 v238, v16, v160, -v238
    v_fmac_f32 v236, v9, v145
    v_fmac_f32 v238, v17, v161
    v_fmac_f32 v236, v10, v146
    v_fmac_f32 v238, v18, v162
    v_fmac_f32 v236, v11, v147
    v_mfma_f32_32x32x16_bf16 v[64:79], v[4:7], v[188:191], v[64:79]
    s_setprio 0
    v_fmac_f32 v238, v19, v163
    v_fmac_f32 v236, v12, v148
    v_fmac_f32 v238, v20, v164
    v_fmac_f32 v236, v13, v149
    v_fmac_f32 v238, v21, v165
    v_fmac_f32 v236, v14, v150
    v_fmac_f32 v238, v22, v166
    v_fmac_f32 v236, v15, v151
    v_fmac_f32 v238, v23, v167
    v_add_u32 v249, s26, v249
    v_add_u32 v250, s26, v250
    v_fmac_f32 v240, v24, v160
    v_fma_f32 v234, v32, v112, -v234
    v_fmac_f32 v240, v25, v161
    v_fmac_f32 v234, v33, v113
    v_fmac_f32 v240, v26, v162
    v_fmac_f32 v234, v34, v114
    v_fmac_f32 v240, v27, v163
    v_fmac_f32 v234, v35, v115
    v_fmac_f32 v240, v28, v164
    v_fmac_f32 v234, v36, v116
    v_fmac_f32 v240, v29, v165
    v_fmac_f32 v234, v37, v117
    v_fmac_f32 v240, v30, v166
    v_fmac_f32 v234, v38, v118
    v_fmac_f32 v240, v31, v167
    v_fmac_f32 v234, v39, v119
    ds_read_b64_tr_b16 v[0:1], v249 offset:0
    ds_read_b64_tr_b16 v[2:3], v249 offset:32
    ds_read_u16_d16_hi v40, v250 offset:0
    v_mul_f32 v237, v48, v152
    v_fma_f32 v239, v56, v168, -v239
    v_fmac_f32 v237, v49, v153
    v_fmac_f32 v239, v57, v169
    v_fmac_f32 v237, v50, v154
    v_fmac_f32 v239, v58, v170
    v_fmac_f32 v237, v51, v155
    v_fmac_f32 v239, v59, v171
    v_fmac_f32 v237, v52, v156
    v_fmac_f32 v239, v60, v172
    v_fmac_f32 v237, v53, v157
    v_fmac_f32 v239, v61, v173
    v_fmac_f32 v237, v54, v158
    v_fmac_f32 v239, v62, v174
    v_fmac_f32 v237, v55, v159
    v_fmac_f32 v239, v63, v175
    ds_read_b64_tr_b16 v[4:5], v249 offset:512
    ds_read_b64_tr_b16 v[6:7], v249 offset:544
    ds_read_u16_d16_hi v41, v250 offset:128
    v_fmac_f32 v241, v64, v168
    v_fma_f32 v235, v72, v120, -v235
    v_fmac_f32 v241, v65, v169
    v_fmac_f32 v235, v73, v121
    v_fmac_f32 v241, v66, v170
    v_fmac_f32 v235, v74, v122
    v_fmac_f32 v241, v67, v171
    v_fmac_f32 v235, v75, v123
    v_fmac_f32 v241, v68, v172
    v_fmac_f32 v235, v76, v124
    v_fmac_f32 v241, v69, v173
    v_fmac_f32 v235, v77, v125
    v_fmac_f32 v241, v70, v174
    v_fmac_f32 v235, v78, v126
    v_fmac_f32 v241, v71, v175
    v_fmac_f32 v235, v79, v127
    s_cmp_eq_u32 s56, 5
    s_cbranch_scc1 K2_U21
    s_cmp_eq_u32 s56, 6
    s_cbranch_scc1 K2_U3h1
    s_branch K2_DSP1
K2_FLGR:
    s_sub_u32 s27, s27, 16
    s_cbranch_scc1 K2_END
    buffer_load_dwordx4 v[56:59], v60, s[8:11], s64 offen sc1
    s_waitcnt vmcnt(0)
    s_branch K2_FLGW
K2_FLGY:
    v_mov_b32 v56, s2
    v_mov_b32 v57, 7178240
    s_mov_b64 exec, 1
    buffer_store_dword v56, v57, s[8:11], 0 offen sc1
    s_mov_b64 exec, -1
    s_branch K2_FLGOK
K2_nul_93:
    s_mov_b32 s58, 63
    s_mov_b32 s36, 0
    s_branch K2_back_96
K2_spin_94:
    s_sub_u32 s27, s27, 1
    s_cbranch_scc1 K2_END
    ds_read_b32 v42, v254
    s_waitcnt lgkmcnt(0)
    s_branch K2_chk_95
K2_dyn_91:
    v_lshl_add_u32 v254, v252, 1, s53
    s_mov_b64 exec, 0x1ff
    ds_add_rtn_u32 v42, v254, v251
    s_mov_b64 exec, -1
    s_waitcnt lgkmcnt(0)
    v_readlane_b32 s58, v42, 8
    s_nop 0
    s_lshr_b32 s58, s58, 4
    s_cmp_lt_u32 s58, s22
    s_cbranch_scc0 K2_nul_93
    v_readlane_b32 s3, v253, s58
    s_nop 0
    s_bfe_u32 s58, s3, 0x60016
    s_and_b32 s59, s58, 7
    s_lshr_b32 s60, s58, 3
K2_chk_95:
    v_readlane_b32 s61, v42, s59
    s_nop 0
    s_cmp_gt_u32 s61, s60
    s_cbranch_scc0 K2_spin_94
K2_back_96:
    s_mov_b32 s34, 1
    s_branch K2_back_92
K2_rare_97:
    s_cmp_eq_u32 s33, 4
    s_cbranch_scc1 K2_four_99
    s_mov_b32 s49, s48
    s_xor_b32 s45, s44, 256
    s_xor_b32 s46, s44, 512
    s_xor_b32 s47, s44, 768
    s_branch K2_back_98
K2_four_99:
    s_add_u32 s50, s48, 256
    s_mov_b32 s46, s44
    s_mov_b32 s47, s44
    s_branch K2_back_98
K2_dum_100:
    v_mov_b32 v42, -1
    s_mov_b32 m0, 163312
    s_mov_b64 exec, 1
    buffer_load_dwordx4 v42, s[16:19], 0 offen lds
    buffer_load_dwordx4 v42, s[16:19], 0 offen lds
    s_mov_b64 exec, -1
    s_branch K2_back_102
K2_a4_101:
    v_add_u32 v254, s48, v232
    ds_read_b32 v254, v254 offset:4
    s_lshr_b32 s65, s3, 28
    s_mul_i32 s66, s22, 2080
    s_lshl_b32 s65, s65, 9
    s_add_u32 s65, s65, s66
    s_add_u32 s65, s65, 65536
    s_mov_b32 m0, s65
    s_mov_b32 exec_hi, 0
    s_waitcnt lgkmcnt(0)
    v_or_b32 v254, v254, v233
    buffer_load_dwordx4 v254, s[16:19], 0 offen  lds
    s_mov_b32 exec_hi, -1
    s_branch K2_b4_103
K2_g4_104:
    s_add_u32 s51, s48, 384
    v_add_u32 v44, s51, v251
    ds_read2_b32 v[44:45], v44 offset0:1 offset1:3
    s_waitcnt lgkmcnt(0)
    v_mad_u32_u16 v44, v44, s39, v248 op_sel:[1,0,0,0]
    v_mad_u32_u16 v45, v45, s39, v248 op_sel:[1,0,0,0]
    buffer_load_dwordx4 v44, s[4:7], s47 offen sc1 lds
    buffer_load_dwordx4 v45, s[72:75], s47 offen offset:1024 sc1 lds
    s_branch K2_back_105
K2_nul_108:
    s_mov_b32 s58, 63
    s_mov_b32 s36, 0
    s_branch K2_back_111
K2_spin_109:
    s_sub_u32 s27, s27, 1
    s_cbranch_scc1 K2_END
    ds_read_b32 v42, v254
    s_waitcnt lgkmcnt(0)
    s_branch K2_chk_110
K2_dyn_106:
    v_lshl_add_u32 v254, v252, 1, s53
    s_mov_b64 exec, 0x1ff
    ds_add_rtn_u32 v42, v254, v251
    s_mov_b64 exec, -1
    s_waitcnt lgkmcnt(0)
    v_readlane_b32 s58, v42, 8
    s_nop 0
    s_lshr_b32 s58, s58, 4
    s_cmp_lt_u32 s58, s22
    s_cbranch_scc0 K2_nul_108
    v_readlane_b32 s3, v253, s58
    s_nop 0
    s_bfe_u32 s58, s3, 0x60016
    s_and_b32 s59, s58, 7
    s_lshr_b32 s60, s58, 3
K2_chk_110:
    v_readlane_b32 s61, v42, s59
    s_nop 0
    s_cmp_gt_u32 s61, s60
    s_cbranch_scc0 K2_spin_109
K2_back_111:
    s_mov_b32 s34, 1
    s_branch K2_back_107
K2_rare_112:
    s_cmp_eq_u32 s33, 4
    s_cbranch_scc1 K2_four_114
    s_mov_b32 s49, s48
    s_xor_b32 s45, s44, 256
    s_xor_b32 s46, s44, 512
    s_xor_b32 s47, s44, 768
    s_branch K2_back_113
K2_four_114:
    s_add_u32 s50, s48, 256
    s_mov_b32 s46, s44
    s_mov_b32 s47, s44
    s_branch K2_back_113
K2_g4_115:
    s_add_u32 s51, s48, 384
    v_add_u32 v44, s51, v251
    ds_read2_b32 v[44:45], v44 offset0:1 offset1:3
    s_waitcnt lgkmcnt(0)
    v_mad_u32_u16 v44, v44, s39, v248 op_sel:[1,0,0,0]
    v_mad_u32_u16 v45, v45, s39, v248 op_sel:[1,0,0,0]
    buffer_load_dwordx4 v44, s[4:7], s47 offen sc1 lds
    buffer_load_dwordx4 v45, s[72:75], s47 offen offset:1024 sc1 lds
    s_branch K2_back_116
K2_dum_117:
    v_mov_b32 v42, -1
    s_mov_b32 m0, 163312
    s_mov_b64 exec, 1
    buffer_load_dwordx4 v42, s[16:19], 0 offen lds
    buffer_load_dwordx4 v42, s[16:19], 0 offen lds
    s_mov_b64 exec, -1
    s_branch K2_back_119
K2_a4_118:
    v_add_u32 v254, s48, v232
    ds_read_b32 v254, v254 offset:4
    s_lshr_b32 s65, s3, 28
    s_mul_i32 s66, s22, 2080
    s_lshl_b32 s65, s65, 9
    s_add_u32 s65, s65, s66
    s_add_u32 s65, s65, 65536
    s_mov_b32 m0, s65
    s_mov_b32 exec_hi, 0
    s_waitcnt lgkmcnt(0)
    v_or_b32 v254, v254, v233
    buffer_load_dwordx4 v254, s[16:19], 0 offen  lds
    s_mov_b32 exec_hi, -1
    s_branch K2_b4_120
K2_nul_121:
    s_mov_b32 s3, 949760
    s_mov_b32 s36, 0
    s_branch K2_back_124
K2_spin_122:
    s_sub_u32 s27, s27, 1
    s_cbranch_scc1 K2_END
    ds_read_b32 v42, v254
    s_waitcnt lgkmcnt(0)
    s_branch K2_chk_123
K2_rare_125:
    s_cmp_eq_u32 s33, 4
    s_cbranch_scc1 K2_four_127
    s_mov_b32 s49, s48
    s_xor_b32 s45, s44, 256
    s_xor_b32 s46, s44, 512
    s_xor_b32 s47, s44, 768
    s_branch K2_back_126
K2_four_127:
    s_add_u32 s50, s48, 256
    s_mov_b32 s46, s44
    s_mov_b32 s47, s44
    s_branch K2_back_126
K2_g4_128:
    s_add_u32 s51, s48, 384
    v_add_u32 v44, s51, v251
    ds_read2_b32 v[44:45], v44 offset0:1 offset1:3
    s_waitcnt lgkmcnt(0)
    v_mad_u32_u16 v44, v44, s39, v248 op_sel:[1,0,0,0]
    v_mad_u32_u16 v45, v45, s39, v248 op_sel:[1,0,0,0]
    buffer_load_dwordx4 v44, s[4:7], s47 offen sc1 lds
    buffer_load_dwordx4 v45, s[72:75], s47 offen offset:1024 sc1 lds
    s_branch K2_back_129
K2_nul_130:
    s_mov_b32 s3, 949760
    s_mov_b32 s36, 0
    s_branch K2_back_133
K2_spin_131:
    s_sub_u32 s27, s27, 1
    s_cbranch_scc1 K2_END
    ds_read_b32 v42, v254
    s_waitcnt lgkmcnt(0)
    s_branch K2_chk_132
K2_rare_134:
    s_cmp_eq_u32 s33, 4
    s_cbranch_scc1 K2_four_136
    s_mov_b32 s49, s48
    s_xor_b32 s45, s44, 256
    s_xor_b32 s46, s44, 512
    s_xor_b32 s47, s44, 768
    s_branch K2_back_135
K2_four_136:
    s_add_u32 s50, s48, 256
    s_mov_b32 s46, s44
    s_mov_b32 s47, s44
    s_branch K2_back_135
K2_g4_137:
    s_add_u32 s51, s48, 384
    v_add_u32 v44, s51, v251
    ds_read2_b32 v[44:45], v44 offset0:1 offset1:3
    s_waitcnt lgkmcnt(0)
    v_mad_u32_u16 v44, v44, s39, v248 op_sel:[1,0,0,0]
    v_mad_u32_u16 v45, v45, s39, v248 op_sel:[1,0,0,0]
    buffer_load_dwordx4 v44, s[4:7], s47 offen sc1 lds
    buffer_load_dwordx4 v45, s[72:75], s47 offen offset:1024 sc1 lds
    s_branch K2_back_138
K2_END:
    s_endpgm
.section .rodata,"a"
.p2align 6
.amdhsa_kernel standalone__tensor_product_equiv_equiformer__graph_kernel
  .amdhsa_next_free_vgpr 256
  .amdhsa_next_free_sgpr 102
  .amdhsa_accum_offset 256
  .amdhsa_group_segment_fixed_size 0
  .amdhsa_kernarg_size 96
  .amdhsa_user_sgpr_count 2
  .amdhsa_user_sgpr_kernarg_segment_ptr 1
  .amdhsa_system_sgpr_workgroup_id_x 1
  .amdhsa_float_denorm_mode_32 3
.end_amdhsa_kernel
```

```asm
; @launch grid=(256,1,1) block=(512,1,1) lds=163840
.amdgcn_target "amdgcn-amd-amdhsa--gfx950"
.text
.globl standalone__tensor_product_equiv_equiformer__graph_kernel
.p2align 8
.type standalone__tensor_product_equiv_equiformer__graph_kernel,@function
standalone__tensor_product_equiv_equiformer__graph_kernel:
    s_cmp_ge_u32 s2, 256
    s_cbranch_scc1 K2_END
    s_load_dwordx16 s[80:95], s[0:1], 0
    s_load_dwordx4 s[96:99], s[0:1], 72
    s_load_dwordx2 s[100:101], s[0:1], 88
    v_lshrrev_b32 v1, 6, v0
    s_mov_b32 s54, s2
    v_readfirstlane_b32 s20, v1
    s_mov_b64 exec, 0
    s_cmp_eq_u32 s20, 0
    s_cbranch_scc1 K2_PAD_S1
    s_cmp_eq_u32 s20, 1
    s_cbranch_scc1 K2_PAD_S2
    s_cmp_eq_u32 s20, 5
    s_cbranch_scc1 K2_PAD_H1
    s_cmp_eq_u32 s20, 6
    s_cbranch_scc1 K2_PAD_H2
    s_cmp_eq_u32 s20, 2
    s_cbranch_scc1 K2_PAD_H3
KS_HOP0:
    s_mov_b64 exec, -1
    v_and_b32 v8, 63, v0
    v_lshlrev_b32 v9, 4, v8
    v_mov_b32 v6, 0
    v_lshlrev_b32 v5, 4, v0
    v_mul_u32_u24 v4, 24, v0
    s_mul_i32 s64, s2, 5120
    s_mul_i32 s65, s2, 7680
    v_mov_b32 v176, v8
    v_mov_b32 v177, v0
    s_movk_i32 s39, 1024
    s_lshl_b32 s37, s20, 13
    s_mov_b32 s53, 163264
    s_lshl_b32 s52, s20, 2
    s_add_u32 s52, s52, s53
    s_add_u32 s68, s37, 0
    s_add_u32 s69, s37, 2048
    s_add_u32 s70, s37, 4096
    s_add_u32 s71, s37, 6144
    s_waitcnt lgkmcnt(0)
    s_mov_b32 s8, s100
    s_and_b32 s9, s101, 0xffff
    s_mov_b32 s10, 37748736
    s_mov_b32 s11, 0x20000
    s_cmp_lg_u32 s20, 7
    s_cbranch_scc1 KS_NOTAG
    s_mov_b32 s24, 7178240
    s_mov_b64 exec, 1
    buffer_load_dword v14, v6, s[8:11], s24 offen sc1
    s_mov_b64 exec, -1
    s_mov_b32 s60, s98
    s_and_b32 s61, s99, 0xffff
    s_mov_b32 s62, 256
    s_mov_b32 s63, 0x20000
    s_barrier
    v_mov_b32 v76, 0
    v_mov_b32 v77, -1
    v_lshlrev_b32 v78, 2, v8
    v_add_u32 v78, 163072, v78
    s_mov_b64 exec, 0x1ff
    ds_write_b32 v78, v76 offset:192
    s_mov_b32 exec_lo, 1
    ds_write_b32 v78, v76 offset:228
    s_mov_b32 exec_lo, -1
    ds_write_b32 v78, v77 offset:256
    s_mov_b64 exec, -1
    s_mov_b32 exec_hi, 0xffff
    ds_write_b32 v78, v76
    s_mov_b64 exec, 1
    ds_write_b32 v78, v76 offset:232
    s_mov_b64 exec, -1
    s_mov_b64 exec, 1
    buffer_load_dword v15, v6, s[60:63], 0 offen sc1
    v_mov_b32 v12, 163456
    s_mov_b32 s24, 1664525
    s_waitcnt vmcnt(1)
    v_mul_lo_u32 v59, v14, s24
    v_add_u32 v59, 1013904223, v59
    ds_write2_b32 v12, v59, v6 offset0:0 offset1:1
    s_waitcnt lgkmcnt(0)
    s_barrier
    s_waitcnt vmcnt(0)
    v_mov_b32 v62, v15
    ds_write_b32 v12, v15 offset:4
    v_cmp_ne_u32 vcc, 0, v15
    s_mov_b32 s24, 0x40000
    s_waitcnt lgkmcnt(0)
    s_barrier
    s_cbranch_vccnz KS_FLOK
KS_FLW:
    s_sub_u32 s24, s24, 1
    s_cbranch_scc1 K2_END
    buffer_load_dword v62, v6, s[60:63], 0 offen sc1
    s_waitcnt vmcnt(0)
    v_cmp_ne_u32 vcc, 0, v62
    s_nop 0
    s_cbranch_vccz KS_FLW
    ds_write_b32 v12, v62 offset:4
KS_FLOK:
    s_mov_b64 exec, -1
    s_branch KS_JOIN
KS_H0:
    s_barrier
    s_branch KS_HELP
K2_PAD_S1:
    s_branch KS_HOP0
KS_NOTAG:
    s_cmp_ge_u32 s20, 5
    s_cbranch_scc1 KS_HELP
    s_cmp_ge_u32 s2, 250
    s_cbranch_scc1 KS_IDLE
    s_mov_b32 s40, s88
    s_and_b32 s41, s89, 0xffff
    s_mov_b32 s42, 1280000
    s_mov_b32 s43, 0x20000
    buffer_load_dwordx4 v[12:15], v5, s[40:43], s64 offen
    s_mov_b32 s44, s86
    s_and_b32 s45, s87, 0xffff
    s_mov_b32 s46, 1280000
    s_mov_b32 s47, 0x20000
    s_mov_b32 s48, s82
    s_and_b32 s49, s83, 0xffff
    s_mov_b32 s50, 1920000
    s_mov_b32 s51, 0x20000
    buffer_load_dwordx4 v[16:19], v5, s[44:47], s64 offen
    buffer_load_dwordx4 v[20:23], v4, s[48:51], s65 offen
    buffer_load_dwordx2 v[24:25], v4, s[48:51], s65 offen offset:16
    v_lshlrev_b32 v2, 2, v0
    s_lshl_b32 s64, s64, 3
    v_lshl_add_u32 v3, v0, 7, s64
    v_mov_b32 v7, 1
    s_setprio 2
    s_cmp_eq_u32 s20, 4
    s_cbranch_scc1 KS_NOCLR
    s_setprio 1
    ds_write_b32 v2, v6
KS_NOCLR:
    s_waitcnt lgkmcnt(0)
    s_barrier
    s_mov_b64 exec, 0
    s_cmp_eq_u32 s20, 0
    s_cbranch_scc1 K2_PAD_B3
    s_cmp_eq_u32 s20, 1
    s_cbranch_scc1 K2_PAD_LD
    s_cmp_eq_u32 s20, 2
    s_cbranch_scc1 K2_PAD_NW
    s_cmp_eq_u32 s20, 3
    s_cbranch_scc1 K2_PAD_SC
    s_cmp_eq_u32 s20, 4
    s_cbranch_scc1 K2_PAD_SD
KS_HOP:
    s_mov_b64 exec, -1
    s_mov_b32 s58, 214749
    s_movk_i32 s59, 625
    s_waitcnt vmcnt(3)
    v_mul_u32_u24 v28, s58, v12
    v_and_b32 v40, 0xffffff, v28
    v_lshrrev_b32 v32, 26, v28
    v_add_u32 v40, 8187281, v40
    v_bfe_u32 v36, v28, 24, 2
    v_lshlrev_b32 v32, 2, v32
    v_lshrrev_b32 v40, 24, v40
    v_lshl_or_b32 v32, v36, 8, v32
    v_lshl_or_b32 v32, v40, 7, v32
    ds_add_rtn_u32 v36, v32, v7
    v_mul_u32_u24 v29, s58, v13
    v_and_b32 v41, 0xffffff, v29
    v_lshrrev_b32 v33, 26, v29
    v_add_u32 v41, 8187281, v41
    v_bfe_u32 v37, v29, 24, 2
    v_lshlrev_b32 v33, 2, v33
    v_lshrrev_b32 v41, 24, v41
    v_lshl_or_b32 v33, v37, 8, v33
    v_lshl_or_b32 v33, v41, 7, v33
    ds_add_rtn_u32 v37, v33, v7
    v_mul_u32_u24 v30, s58, v14
    v_and_b32 v42, 0xffffff, v30
    v_lshrrev_b32 v34, 26, v30
    v_add_u32 v42, 8187281, v42
    v_bfe_u32 v38, v30, 24, 2
    v_lshlrev_b32 v34, 2, v34
    v_lshrrev_b32 v42, 24, v42
    v_lshl_or_b32 v34, v38, 8, v34
    v_lshl_or_b32 v34, v42, 7, v34
    ds_add_rtn_u32 v38, v34, v7
    v_mul_u32_u24 v31, s58, v15
    v_and_b32 v43, 0xffffff, v31
    v_lshrrev_b32 v35, 26, v31
    v_add_u32 v43, 8187281, v43
    v_bfe_u32 v39, v31, 24, 2
    v_lshlrev_b32 v35, 2, v35
    v_lshrrev_b32 v43, 24, v43
    v_lshl_or_b32 v35, v39, 8, v35
    v_lshl_or_b32 v35, v43, 7, v35
    ds_add_rtn_u32 v39, v35, v7
    v_lshrrev_b32 v28, 24, v28
    v_mad_u32_u24 v28, v28, s59, 7
    v_lshrrev_b32 v28, 3, v28
    v_mad_u32_u24 v28, v40, 40, v28
    v_sub_u32 v28, v12, v28
    v_add_u32 v12, 0, v3
    v_lshl_or_b32 v28, v28, 26, v12
    v_lshrrev_b32 v29, 24, v29
    v_mad_u32_u24 v29, v29, s59, 7
    v_lshrrev_b32 v29, 3, v29
    v_mad_u32_u24 v29, v41, 40, v29
    v_sub_u32 v29, v13, v29
    v_add_u32 v13, 32, v3
    v_lshl_or_b32 v29, v29, 26, v13
    v_lshrrev_b32 v30, 24, v30
    v_mad_u32_u24 v30, v30, s59, 7
    v_lshrrev_b32 v30, 3, v30
    v_mad_u32_u24 v30, v42, 40, v30
    v_sub_u32 v30, v14, v30
    v_add_u32 v14, 64, v3
    v_lshl_or_b32 v30, v30, 26, v14
    v_lshrrev_b32 v31, 24, v31
    v_mad_u32_u24 v31, v31, s59, 7
    v_lshrrev_b32 v31, 3, v31
    v_mad_u32_u24 v31, v43, 40, v31
    v_sub_u32 v31, v15, v31
    v_add_u32 v15, 96, v3
    v_lshl_or_b32 v31, v31, 26, v15
K2_PAD_S2:
    s_cbranch_execz KS_HOP0
    v_mov_b32 v59, 163456
    s_mul_i32 s65, s2, 1152
    s_add_u32 s65, s65, 6291456
    s_mul_i32 s64, s2, 20608
    s_waitcnt lgkmcnt(0)
    s_barrier
    ds_read_b128 v[40:43], v9
    ds_read_b32 v59, v59
    s_waitcnt lgkmcnt(1)
    v_add_u32 v45, v40, v41
    v_add_u32 v46, v45, v42
    v_add_u32 v47, v46, v43
    v_mov_b32 v58, v47
    s_nop 1
    v_add_u32_dpp v58, v58, v58 row_shr:1 row_mask:0xf bank_mask:0xf bound_ctrl:0
    s_nop 1
    v_add_u32_dpp v58, v58, v58 row_shr:2 row_mask:0xf bank_mask:0xf bound_ctrl:0
    s_nop 1
    v_add_u32_dpp v58, v58, v58 row_shr:4 row_mask:0xf bank_mask:0xf bound_ctrl:0
    s_nop 1
    v_add_u32_dpp v58, v58, v58 row_shr:8 row_mask:0xf bank_mask:0xf bound_ctrl:0
    s_nop 1
    v_add_u32_dpp v58, v58, v58 row_bcast:15 row_mask:0xa bank_mask:0xf
    s_nop 1
    v_add_u32_dpp v58, v58, v58 row_bcast:31 row_mask:0xc bank_mask:0xf
    v_sub_u32 v48, v58, v47
    v_add_u32 v49, v48, v40
    v_add_u32 v50, v48, v45
    v_add_u32 v51, v48, v46
    ds_write_b128 v9, v[48:51] offset:1024
    s_waitcnt lgkmcnt(1)
    s_cmp_lg_u32 s20, 4
    s_cbranch_scc1 KS_NOPUB
    v_lshl_or_b32 v56, v49, 11, v48
    v_lshl_or_b32 v57, v51, 11, v50
    v_lshl_or_b32 v56, v59, 22, v56
    v_lshl_or_b32 v57, v59, 22, v57
    buffer_store_dwordx4 v[56:59], v9, s[8:11], s65 offen sc1
KS_NOPUB:
    s_waitcnt lgkmcnt(0)
    ds_read_b32 v32, v32 offset:1024
    ds_read_b32 v33, v33 offset:1024
    ds_read_b32 v34, v34 offset:1024
    ds_read_b32 v35, v35 offset:1024
    s_cbranch_scc1 KS_PUB0
    s_waitcnt vmcnt(1)
    s_branch KS_PUB1
KS_PUB0:
    s_waitcnt vmcnt(0)
KS_PUB1:
    v_and_b32 v60, 0xffff, v59
    v_and_b32 v61, 0xffff0000, v59
    s_mov_b32 s58, 0xffff0000
    v_xor_b32 v40, 0x80000000, v20
    v_lshl_or_b32 v41, v21, 16, v60
    v_or_b32 v42, v61, v16
    v_mov_b32 v43, v28
    v_alignbit_b32 v44, v22, v21, 16
    v_and_or_b32 v45, v22, s58, v60
    v_xor_b32 v44, 0x80000000, v44
    v_or_b32 v46, v61, v17
    v_mov_b32 v47, v29
    v_xor_b32 v48, 0x80000000, v23
    v_lshl_or_b32 v49, v24, 16, v60
    v_or_b32 v50, v61, v18
    v_mov_b32 v51, v30
    v_alignbit_b32 v52, v25, v24, 16
    v_and_or_b32 v53, v25, s58, v60
    v_xor_b32 v52, 0x80000000, v52
    v_or_b32 v54, v61, v19
    v_mov_b32 v55, v31
    s_waitcnt lgkmcnt(0)
    v_add_lshl_u32 v32, v32, v36, 4
    ds_write_b128 v32, v[40:43] offset:2048
    v_add_lshl_u32 v33, v33, v37, 4
    ds_write_b128 v33, v[44:47] offset:2048
    v_add_lshl_u32 v34, v34, v38, 4
    ds_write_b128 v34, v[48:51] offset:2048
    v_add_lshl_u32 v35, v35, v39, 4
    ds_write_b128 v35, v[52:55] offset:2048
    v_mov_b32 v62, 163460
    s_waitcnt lgkmcnt(0)
    s_barrier
    ds_read_b32 v62, v62
    ds_read_b128 v[12:15], v5 offset:2048
    ds_read_b128 v[16:19], v5 offset:7168
    ds_read_b128 v[20:23], v5 offset:12288
    ds_read_b128 v[24:27], v5 offset:17408
    s_waitcnt lgkmcnt(3)
    buffer_store_dwordx4 v[12:15], v5, s[8:11], s64 offen sc1
    s_add_u32 s64, s64, 5120
    s_waitcnt lgkmcnt(2)
    buffer_store_dwordx4 v[16:19], v5, s[8:11], s64 offen sc1
    s_add_u32 s64, s64, 5120
    s_waitcnt lgkmcnt(1)
    buffer_store_dwordx4 v[20:23], v5, s[8:11], s64 offen sc1
    s_add_u32 s64, s64, 5120
    s_waitcnt lgkmcnt(0)
    buffer_store_dwordx4 v[24:27], v5, s[8:11], s64 offen sc1
    s_branch KS_JOIN
K2_PAD_B3:
    s_branch KS_HOP
KS_B3:
    v_mov_b32 v59, 163456
    ds_read_b32 v59, v59
    v_mov_b32 v62, 163460
    s_waitcnt lgkmcnt(0)
    s_barrier
    ds_read_b32 v62, v62
KS_JOIN:
    s_setprio 0
    v_readfirstlane_b32 s2, v59
    s_mov_b32 s25, 0x400000
KS_JOIN2:
    s_waitcnt lgkmcnt(0)
    v_readfirstlane_b32 s24, v62
    s_nop 0
    s_cmp_eq_u32 s24, 0
    s_cbranch_scc1 KS_FLS
    s_bfe_u32 s24, s24, 0x10001
    s_xor_b32 s54, s54, s24
    s_lshr_b32 s21, s54, 1
    s_mul_i32 s21, s21, 625
    s_add_u32 s22, s21, 632
    s_add_u32 s21, s21, 7
    s_lshr_b32 s21, s21, 3
    s_lshr_b32 s22, s22, 3
    s_add_u32 s24, s21, 40
    s_sub_u32 s22, s22, s24
    s_bitcmp1_b32 s54, 0
    s_cselect_b32 s21, s24, s21
    s_cselect_b32 s22, s22, 40
    s_mov_b32 s23, 0
    s_mov_b32 s28, 1
    s_mov_b32 s24, 0
    s_mov_b32 s25, 1
K2_CELLS:
    v_lshrrev_b32 v178, 1, v177
    v_min_u32 v178, 249, v178
    v_mul_u32_u24 v72, 1152, v178
    s_and_b32 s58, s54, 7
    s_lshl_b32 s58, s58, 7
    s_lshr_b32 s59, s54, 5
    s_lshl_b32 s59, s59, 4
    s_add_u32 s67, s58, s59
    s_add_u32 s67, s67, 6291456
    s_cmp_eq_u32 s28, 0
    s_cbranch_scc1 K2_NOSRD
    s_mov_b32 s4, s80
    s_and_b32 s5, s81, 0xffff
    s_mov_b32 s6, 10240000
    s_mov_b32 s7, 0x20000
    s_mov_b32 s12, s96
    s_and_b32 s13, s97, 0xffff
    s_mov_b32 s14, 10240000
    s_mov_b32 s15, 0x20000
    s_mov_b32 s16, s84
    s_and_b32 s17, s85, 0xffff
    s_mov_b32 s18, 10240000
    s_mov_b32 s19, 0x20000
    s_sub_u32 s80, s80, 1024
    s_subb_u32 s81, s81, 0
    s_mov_b32 s72, s80
    s_and_b32 s73, s81, 0xffff
    s_mov_b32 s74, 10241024
    s_mov_b32 s75, 0x20000
K2_NOSRD:
    v_and_b32 v84, 15, v176
    v_lshrrev_b32 v85, 5, v176
    v_bfe_u32 v86, v176, 4, 1
    v_lshrrev_b32 v87, 2, v84
    v_and_b32 v88, 3, v84
    v_lshl_add_u32 v89, v85, 2, v87
    v_lshrrev_b32 v90, 4, v176
    v_and_b32 v91, 1, v87
    v_lshl_add_u32 v91, v90, 1, v91
    v_lshlrev_b32 v249, 6, v91
    v_lshrrev_b32 v91, 1, v87
    v_lshl_add_u32 v249, v91, 5, v249
    v_lshl_add_u32 v249, v88, 3, v249
    v_add_u32 v249, 512, v249
    v_and_b32 v91, 1, v88
    v_lshl_add_u32 v91, v90, 1, v91
    v_lshlrev_b32 v250, 4, v91
    v_lshrrev_b32 v91, 1, v88
    v_lshl_add_u32 v250, v91, 3, v250
    v_lshl_add_u32 v250, v87, 1, v250
    v_lshrrev_b32 v90, 1, v88
    v_lshl_add_u32 v90, v86, 1, v90
    v_bfe_u32 v91, v87, 1, 1
    v_lshlrev_b32 v91, 2, v91
    v_xor_b32 v90, v90, v91
    v_lshlrev_b32 v90, 4, v90
    v_lshl_add_u32 v90, v89, 7, v90
    v_and_b32 v91, 1, v88
    v_lshl_add_u32 v90, v91, 3, v90
    v_add_u32 v246, s37, v90
    v_xor_b32 v247, 64, v246
    v_lshrrev_b32 v90, 3, v176
    v_lshlrev_b32 v251, 4, v90
    v_bfe_u32 v90, v90, 1, 1
    v_lshlrev_b32 v90, 2, v90
    v_and_b32 v91, 7, v176
    v_xor_b32 v90, v90, v91
    v_lshlrev_b32 v248, 4, v90
    v_lshlrev_b32 v252, 1, v176
    v_and_b32 v233, 1, v176
    v_lshlrev_b32 v233, 4, v233
    v_lshrrev_b32 v90, 1, v176
    v_lshlrev_b32 v90, 5, v90
    v_add_u32 v232, 512, v90
    s_cmp_eq_u32 s28, 0
    s_cbranch_scc1 K2_NOW0
    v_lshrrev_b32 v60, 6, v252
    v_bfe_u32 v61, v252, 3, 2
    v_lshl_add_u32 v60, v60, 2, v61
    v_mul_u32_u24 v60, 640, v60
    v_bfe_u32 v61, v252, 5, 1
    v_lshl_add_u32 v60, v61, 5, v60
    v_and_b32 v61, 6, v252
    v_lshl_add_u32 v60, v61, 2, v60
    v_add_u32 v60, 24576, v60
    ds_read_b64_tr_b16 v[136:137], v60 offset:0
    ds_read_b64_tr_b16 v[138:139], v60 offset:5120
    ds_read_b64_tr_b16 v[140:141], v60 offset:64
    ds_read_b64_tr_b16 v[142:143], v60 offset:5184
    ds_read_b64_tr_b16 v[144:145], v60 offset:128
    ds_read_b64_tr_b16 v[146:147], v60 offset:5248
    ds_read_b64_tr_b16 v[148:149], v60 offset:192
    ds_read_b64_tr_b16 v[150:151], v60 offset:5312
    ds_read_b64_tr_b16 v[152:153], v60 offset:256
    ds_read_b64_tr_b16 v[154:155], v60 offset:5376
    ds_read_b64_tr_b16 v[156:157], v60 offset:320
    ds_read_b64_tr_b16 v[158:159], v60 offset:5440
    ds_read_b64_tr_b16 v[160:161], v60 offset:384
    ds_read_b64_tr_b16 v[162:163], v60 offset:5504
    ds_read_b64_tr_b16 v[164:165], v60 offset:448
    ds_read_b64_tr_b16 v[166:167], v60 offset:5568
    ds_read_b64_tr_b16 v[168:169], v60 offset:512
    ds_read_b64_tr_b16 v[170:171], v60 offset:5632
    ds_read_b64_tr_b16 v[172:173], v60 offset:576
    ds_read_b64_tr_b16 v[174:175], v60 offset:5696
    s_waitcnt lgkmcnt(0)
    v_lshlrev_b32 v96, 16, v136
    v_and_b32 v97, 0xffff0000, v136
    v_lshlrev_b32 v98, 16, v137
    v_and_b32 v99, 0xffff0000, v137
    v_lshlrev_b32 v100, 16, v138
    v_and_b32 v101, 0xffff0000, v138
    v_lshlrev_b32 v102, 16, v139
    v_and_b32 v103, 0xffff0000, v139
    v_lshlrev_b32 v104, 16, v140
    v_and_b32 v105, 0xffff0000, v140
    v_lshlrev_b32 v106, 16, v141
    v_and_b32 v107, 0xffff0000, v141
    v_lshlrev_b32 v108, 16, v142
    v_and_b32 v109, 0xffff0000, v142
    v_lshlrev_b32 v110, 16, v143
    v_and_b32 v111, 0xffff0000, v143
    v_lshlrev_b32 v112, 16, v144
    v_and_b32 v113, 0xffff0000, v144
    v_lshlrev_b32 v114, 16, v145
    v_and_b32 v115, 0xffff0000, v145
    v_lshlrev_b32 v116, 16, v146
    v_and_b32 v117, 0xffff0000, v146
    v_lshlrev_b32 v118, 16, v147
    v_and_b32 v119, 0xffff0000, v147
    v_lshlrev_b32 v120, 16, v148
    v_and_b32 v121, 0xffff0000, v148
    v_lshlrev_b32 v122, 16, v149
    v_and_b32 v123, 0xffff0000, v149
    v_lshlrev_b32 v124, 16, v150
    v_and_b32 v125, 0xffff0000, v150
    v_lshlrev_b32 v126, 16, v151
    v_and_b32 v127, 0xffff0000, v151
    buffer_load_dwordx4 v[76:79], v72, s[8:11], s67 offen sc1
    s_mov_b64 exec, 0
    s_cmp_eq_u32 s20, 0
    s_cbranch_scc1 K2_PAD_U20
    s_cmp_eq_u32 s20, 1
    s_cbranch_scc1 K2_PAD_U30
    s_cmp_eq_u32 s20, 2
    s_cbranch_scc1 K2_PAD_U21
    s_cmp_eq_u32 s20, 3
    s_cbranch_scc1 K2_PAD_U31
    s_cmp_eq_u32 s20, 7
    s_cbranch_scc1 K2_PAD_SW
    s_cmp_eq_u32 s20, 5
    s_cbranch_scc1 K2_PAD_TL
    s_cmp_eq_u32 s20, 6
    s_cbranch_scc1 K2_PAD_T2
K2_HOP:
    s_mov_b64 exec, -1
    v_lshlrev_b32 v128, 16, v152
    v_and_b32 v129, 0xffff0000, v152
    v_lshlrev_b32 v130, 16, v153
    v_and_b32 v131, 0xffff0000, v153
    v_lshlrev_b32 v132, 16, v154
    v_and_b32 v133, 0xffff0000, v154
    v_lshlrev_b32 v134, 16, v155
    v_and_b32 v135, 0xffff0000, v155
    v_lshlrev_b32 v136, 16, v156
    v_and_b32 v137, 0xffff0000, v156
    v_lshlrev_b32 v138, 16, v157
    v_and_b32 v139, 0xffff0000, v157
    v_lshlrev_b32 v140, 16, v158
    v_and_b32 v141, 0xffff0000, v158
    v_lshlrev_b32 v142, 16, v159
    v_and_b32 v143, 0xffff0000, v159
    v_lshlrev_b32 v144, 16, v160
    v_and_b32 v145, 0xffff0000, v160
    v_lshlrev_b32 v146, 16, v161
    v_and_b32 v147, 0xffff0000, v161
    v_lshlrev_b32 v148, 16, v162
    v_and_b32 v149, 0xffff0000, v162
    v_lshlrev_b32 v150, 16, v163
    v_and_b32 v151, 0xffff0000, v163
    v_lshlrev_b32 v152, 16, v164
    v_and_b32 v153, 0xffff0000, v164
    v_lshlrev_b32 v154, 16, v165
    v_and_b32 v155, 0xffff0000, v165
    v_lshlrev_b32 v156, 16, v166
    v_and_b32 v157, 0xffff0000, v166
    v_lshlrev_b32 v158, 16, v167
    v_and_b32 v159, 0xffff0000, v167
    v_lshlrev_b32 v160, 16, v168
    v_and_b32 v161, 0xffff0000, v168
    v_lshlrev_b32 v162, 16, v169
    v_and_b32 v163, 0xffff0000, v169
    v_lshlrev_b32 v164, 16, v170
    v_and_b32 v165, 0xffff0000, v170
    v_lshlrev_b32 v166, 16, v171
    v_and_b32 v167, 0xffff0000, v171
    v_lshlrev_b32 v168, 16, v172
    v_and_b32 v169, 0xffff0000, v172
    v_lshlrev_b32 v170, 16, v173
    v_and_b32 v171, 0xffff0000, v173
    v_lshlrev_b32 v172, 16, v174
    v_and_b32 v173, 0xffff0000, v174
    v_lshlrev_b32 v174, 16, v175
    v_and_b32 v175, 0xffff0000, v175
K2_W0:
    s_lshl_b32 s59, s2, 22
    s_mov_b32 s60, 0x40000
    s_bfe_u32 s61, s54, 0x10004
    s_bfe_u32 s62, s54, 0x10003
    s_add_u32 s63, s61, s62
    s_mul_i32 s62, s62, 11
    s_sub_u32 s64, 11, s62
    v_cmp_gt_u32 vcc, 500, v177
    s_nop 0
    s_mov_b64 s[56:57], vcc
K2_POLL:
    s_waitcnt vmcnt(0)
    v_xor_b32 v73, s59, v76
    v_xor_b32 v74, s59, v77
    v_or_b32 v73, v73, v74
    v_xor_b32 v74, s2, v79
    v_lshrrev_b32 v73, 22, v73
    v_or_b32 v73, v73, v74
    v_cmp_ne_u32 vcc, 0, v73
    s_nop 0
    s_cbranch_vccz K2_POLLED
    s_sub_u32 s60, s60, 1
    s_cbranch_scc1 K2_END
    s_mov_b64 exec, vcc
    buffer_load_dwordx4 v[76:79], v72, s[8:11], s67 offen sc1
    s_mov_b64 exec, -1
    s_branch K2_POLL
K2_PAD_LD:
    s_branch KS_HOP
K2_POLLED:
    s_set_gpr_idx_on s61, gpr_idx(SRC0)
    s_nop 0
    v_bfe_u32 v179, v76, s62, 11
    s_set_gpr_idx_idx s63
    s_nop 0
    v_bfe_u32 v73, v76, s64, 11
    s_set_gpr_idx_off
    v_sub_u32 v73, v73, v179
    v_cndmask_b32 v73, 0, v73, s[56:57]
    v_and_b32 v1, 1, v177
    v_add_u32 v1, s23, v1
    v_sub_u32 v180, v73, v1
    v_add_u32 v179, v179, v1
    v_mul_u32_u24 v181, 20608, v178
    v_lshl_add_u32 v181, v179, 4, v181
    v_cmp_lt_i32 s[40:41], 0, v180
    v_add_u32 v182, 32, v181
    s_mov_b32 s65, 0
    s_mov_b64 exec, s[40:41]
    buffer_load_dwordx4 v[0:3], v181, s[8:11], 0 offen offset:0 sc1
    s_mov_b64 exec, -1
    v_cmp_lt_i32 s[42:43], 2, v180
    v_cmp_lt_i32 s[44:45], 4, v180
    v_cmp_lt_i32 s[46:47], 6, v180
    v_cmp_lt_i32 s[48:49], 8, v180
    v_cmp_lt_i32 s[50:51], 10, v180
    v_cmp_lt_i32 s[90:91], 12, v180
    v_cmp_lt_i32 s[92:93], 14, v180
    v_cmp_lt_i32 s[94:95], 16, v180
    v_cmp_lt_i32 s[96:97], 18, v180
    v_add_u32 v183, 64, v181
    v_add_u32 v184, 96, v181
    v_subrev_u32 v62, 1, v180
    v_ashrrev_i32 v62, 1, v62
    v_med3_i32 v62, v62, 0, 9
    s_cmp_eq_u64 s[42:43], 0
    s_cbranch_scc1 K2_LD_DONE
    v_mov_b32 v63, v62
    s_nop 1
    v_add_u32_dpp v63, v63, v63 row_shr:1 row_mask:0xf bank_mask:0xf bound_ctrl:0
    s_nop 1
    v_add_u32_dpp v63, v63, v63 row_shr:2 row_mask:0xf bank_mask:0xf bound_ctrl:0
    s_nop 1
    v_add_u32_dpp v63, v63, v63 row_shr:4 row_mask:0xf bank_mask:0xf bound_ctrl:0
    s_nop 1
    v_add_u32_dpp v63, v63, v63 row_shr:8 row_mask:0xf bank_mask:0xf bound_ctrl:0
    s_nop 1
    v_add_u32_dpp v63, v63, v63 row_bcast:15 row_mask:0xa bank_mask:0xf
    s_nop 1
    v_add_u32_dpp v63, v63, v63 row_bcast:31 row_mask:0xc bank_mask:0xf
    s_lshl_b32 s58, s20, 10
    s_add_u32 s58, s58, 45056
    v_readlane_b32 s59, v63, 63
    v_sub_u32 v63, v63, v62
    v_lshl_add_u32 v64, v63, 2, s58
    v_lshlrev_b32 v63, 5, v63
    v_sub_u32 v63, v182, v63
    s_cmp_gt_u32 s59, 189
    s_cbranch_scc1 K2_LD_GEN
    s_mov_b64 exec, s[42:43]
    s_cbranch_execz K2_LD_L
    ds_write_b32 v64, v63 offset:0
    s_mov_b64 exec, s[44:45]
    s_cbranch_execz K2_LD_L
    ds_write_b32 v64, v63 offset:4
    s_mov_b64 exec, s[46:47]
    s_cbranch_execz K2_LD_L
    ds_write_b32 v64, v63 offset:8
    s_mov_b64 exec, s[48:49]
    s_cbranch_execz K2_LD_L
    ds_write_b32 v64, v63 offset:12
    s_mov_b64 exec, s[50:51]
    s_cbranch_execz K2_LD_L
    ds_write_b32 v64, v63 offset:16
    s_mov_b64 exec, s[90:91]
    s_cbranch_execz K2_LD_L
    ds_write_b32 v64, v63 offset:20
    s_mov_b64 exec, s[92:93]
    s_cbranch_execz K2_LD_L
    ds_write_b32 v64, v63 offset:24
    s_mov_b64 exec, s[94:95]
    s_cbranch_execz K2_LD_L
    ds_write_b32 v64, v63 offset:28
    s_mov_b64 exec, s[96:97]
    s_cbranch_execz K2_LD_L
    ds_write_b32 v64, v63 offset:32
K2_LD_L:
    s_mov_b64 exec, -1
    v_lshl_add_u32 v63, v176, 2, s58
    v_lshlrev_b32 v62, 5, v176
    s_waitcnt lgkmcnt(0)
    ds_read_b32 v64, v63 offset:0
    ds_read_b32 v65, v63 offset:252
    ds_read_b32 v66, v63 offset:504
    s_min_u32 s60, s59, 63
    s_sub_u32 s59, s59, s60
    s_bfm_b64 s[42:43], s60, 0
    s_min_u32 s60, s59, 63
    s_sub_u32 s59, s59, s60
    s_bfm_b64 s[44:45], s60, 0
    s_min_u32 s60, s59, 63
    s_sub_u32 s59, s59, s60
    s_bfm_b64 s[46:47], s60, 0
    s_mov_b64 s[48:49], 0
    s_mov_b32 s65, 1
    s_mov_b32 s60, 0
    s_waitcnt lgkmcnt(2)
    v_add3_u32 v182, v62, v64, s60
    s_mov_b64 exec, s[42:43]
    buffer_load_dwordx4 v[4:7], v182, s[8:11], 0 offen sc1
    s_mov_b32 s60, 2016
    s_waitcnt lgkmcnt(1)
    v_add3_u32 v183, v62, v65, s60
    s_mov_b64 exec, s[44:45]
    buffer_load_dwordx4 v[8:11], v183, s[8:11], 0 offen sc1
    s_mov_b32 s60, 4032
    s_waitcnt lgkmcnt(0)
    v_add3_u32 v184, v62, v66, s60
    s_mov_b64 exec, s[46:47]
    buffer_load_dwordx4 v[12:15], v184, s[8:11], 0 offen sc1
K2_LD_DONE:
    s_mov_b64 exec, -1
    s_cmp_eq_u32 s28, 0
    s_cbranch_scc1 K2_WLATE
K2_NOWRAW:
K2_PAD_NW:
    s_cbranch_execz KS_HOP
    v_lshrrev_b32 v179, 2, v181
    v_lshrrev_b32 v185, 2, v182
    v_lshrrev_b32 v186, 2, v183
    v_lshrrev_b32 v187, 2, v184
    s_mov_b32 s66, 7340032
    v_mov_b32 v201, 1
    s_movk_i32 s58, 520
    s_movk_i32 s59, 2080
    s_mov_b32 s60, 0x40000
    s_mov_b32 s61, 0xffff
    v_mov_b32 v202, 65536
    s_cmp_lg_u32 s24, 0
    s_cbranch_scc1 K2_RK_LOAD
    v_cmp_lt_i32 vcc, 20, v180
    s_nop 0
    s_cbranch_vccz K2_NOMORE
    v_mov_b32 v61, 163304
    ds_write_b32 v61, v201
K2_NOMORE:
    s_mov_b32 s62, 82176
    s_cmp_eq_u32 s65, 0
    s_waitcnt vmcnt(3)
    s_cbranch_scc0 K2_ARR
    s_waitcnt vmcnt(0)
K2_ARR:
    s_mov_b64 exec, s[40:41]
    s_cbranch_execz K2_RK_A
K2_CK0:
    v_bfi_b32 v192, s61, v1, v2
    v_lshrrev_b32 v50, 24, v3
    v_cmp_ne_u32 vcc, s2, v192
    v_add_u32 v40, 163072, v50
    s_cbranch_vccnz K2_RT0
    ds_add_rtn_u32 v40, v40, v201
    v_mad_u32_u24 v50, v50, s58, v202
    s_mov_b64 exec, s[42:43]
    s_cbranch_execz K2_RK_A
    s_waitcnt vmcnt(2)
K2_CK1:
    v_bfi_b32 v192, s61, v5, v6
    v_lshrrev_b32 v51, 24, v7
    v_cmp_ne_u32 vcc, s2, v192
    v_add_u32 v41, 163072, v51
    s_cbranch_vccnz K2_RT1
    ds_add_rtn_u32 v41, v41, v201
    v_mad_u32_u24 v51, v51, s58, v202
    s_mov_b64 exec, s[44:45]
    s_cbranch_execz K2_RK_A
    s_waitcnt vmcnt(1)
K2_CK2:
    v_bfi_b32 v192, s61, v9, v10
    v_lshrrev_b32 v52, 24, v11
    v_cmp_ne_u32 vcc, s2, v192
    v_add_u32 v42, 163072, v52
    s_cbranch_vccnz K2_RT2
    ds_add_rtn_u32 v42, v42, v201
    v_mad_u32_u24 v52, v52, s58, v202
    s_mov_b64 exec, s[46:47]
    s_cbranch_execz K2_RK_A
    s_waitcnt vmcnt(0)
K2_CK3:
    v_bfi_b32 v192, s61, v13, v14
    v_lshrrev_b32 v53, 24, v15
    v_cmp_ne_u32 vcc, s2, v192
    v_add_u32 v43, 163072, v53
    s_cbranch_vccnz K2_RT3
    ds_add_rtn_u32 v43, v43, v201
    v_mad_u32_u24 v53, v53, s58, v202
    s_mov_b64 exec, s[48:49]
    s_cbranch_execz K2_RK_A
K2_CK4:
    v_bfi_b32 v192, s61, v17, v18
    v_lshrrev_b32 v54, 24, v19
    v_cmp_ne_u32 vcc, s2, v192
    v_add_u32 v44, 163072, v54
    s_cbranch_vccnz K2_RT4
    ds_add_rtn_u32 v44, v44, v201
    v_mad_u32_u24 v54, v54, s58, v202
    s_mov_b64 exec, s[50:51]
    s_cbranch_execz K2_RK_A
K2_CK5:
    v_bfi_b32 v192, s61, v21, v22
    v_lshrrev_b32 v55, 24, v23
    v_cmp_ne_u32 vcc, s2, v192
    v_add_u32 v45, 163072, v55
    s_cbranch_vccnz K2_RT5
    ds_add_rtn_u32 v45, v45, v201
    v_mad_u32_u24 v55, v55, s58, v202
    s_mov_b64 exec, s[90:91]
    s_cbranch_execz K2_RK_A
K2_CK6:
    v_bfi_b32 v192, s61, v25, v26
    v_lshrrev_b32 v56, 24, v27
    v_cmp_ne_u32 vcc, s2, v192
    v_add_u32 v46, 163072, v56
    s_cbranch_vccnz K2_RT6
    ds_add_rtn_u32 v46, v46, v201
    v_mad_u32_u24 v56, v56, s58, v202
    s_mov_b64 exec, s[92:93]
    s_cbranch_execz K2_RK_A
K2_CK7:
    v_bfi_b32 v192, s61, v29, v30
    v_lshrrev_b32 v57, 24, v31
    v_cmp_ne_u32 vcc, s2, v192
    v_add_u32 v47, 163072, v57
    s_cbranch_vccnz K2_RT7
    ds_add_rtn_u32 v47, v47, v201
    v_mad_u32_u24 v57, v57, s58, v202
    s_mov_b64 exec, s[94:95]
    s_cbranch_execz K2_RK_A
K2_CK8:
    v_bfi_b32 v192, s61, v33, v34
    v_lshrrev_b32 v58, 24, v35
    v_cmp_ne_u32 vcc, s2, v192
    v_add_u32 v48, 163072, v58
    s_cbranch_vccnz K2_RT8
    ds_add_rtn_u32 v48, v48, v201
    v_mad_u32_u24 v58, v58, s58, v202
    s_mov_b64 exec, s[96:97]
    s_cbranch_execz K2_RK_A
K2_CK9:
    v_bfi_b32 v192, s61, v37, v38
    v_lshrrev_b32 v59, 24, v39
    v_cmp_ne_u32 vcc, s2, v192
    v_add_u32 v49, 163072, v59
    s_cbranch_vccnz K2_RT9
    ds_add_rtn_u32 v49, v49, v201
    v_mad_u32_u24 v59, v59, s58, v202
K2_RK_A:
    s_mov_b64 exec, -1
    s_mov_b64 exec, s[40:41]
    s_cbranch_execz K2_TP
    v_cmp_gt_u32 vcc, s62, v50
    v_and_b32 v3, 0xffffff, v3
    s_mov_b64 exec, vcc
    buffer_load_dword v245, v3, s[16:19], 0 offen
    s_mov_b64 exec, s[42:43]
    s_cbranch_execz K2_TP
    v_cmp_gt_u32 vcc, s62, v51
    v_and_b32 v7, 0xffffff, v7
    s_mov_b64 exec, vcc
    buffer_load_dword v245, v7, s[16:19], 0 offen
    s_mov_b64 exec, s[44:45]
    s_cbranch_execz K2_TP
    v_cmp_gt_u32 vcc, s62, v52
    v_and_b32 v11, 0xffffff, v11
    s_mov_b64 exec, vcc
    buffer_load_dword v245, v11, s[16:19], 0 offen
    s_mov_b64 exec, s[46:47]
    s_cbranch_execz K2_TP
    v_cmp_gt_u32 vcc, s62, v53
    v_and_b32 v15, 0xffffff, v15
    s_mov_b64 exec, vcc
    buffer_load_dword v245, v15, s[16:19], 0 offen
    s_mov_b64 exec, s[48:49]
    s_cbranch_execz K2_TP
    v_cmp_gt_u32 vcc, s62, v54
    v_and_b32 v19, 0xffffff, v19
    s_mov_b64 exec, vcc
    buffer_load_dword v245, v19, s[16:19], 0 offen
    s_mov_b64 exec, s[50:51]
    s_cbranch_execz K2_TP
    v_cmp_gt_u32 vcc, s62, v55
    v_and_b32 v23, 0xffffff, v23
    s_mov_b64 exec, vcc
    buffer_load_dword v245, v23, s[16:19], 0 offen
    s_mov_b64 exec, s[90:91]
    s_cbranch_execz K2_TP
    v_cmp_gt_u32 vcc, s62, v56
    v_and_b32 v27, 0xffffff, v27
    s_mov_b64 exec, vcc
    buffer_load_dword v245, v27, s[16:19], 0 offen
    s_mov_b64 exec, s[92:93]
    s_cbranch_execz K2_TP
    v_cmp_gt_u32 vcc, s62, v57
    v_and_b32 v31, 0xffffff, v31
    s_mov_b64 exec, vcc
    buffer_load_dword v245, v31, s[16:19], 0 offen
    s_mov_b64 exec, s[94:95]
    s_cbranch_execz K2_TP
    v_cmp_gt_u32 vcc, s62, v58
    v_and_b32 v35, 0xffffff, v35
    s_mov_b64 exec, vcc
    buffer_load_dword v245, v35, s[16:19], 0 offen
    s_mov_b64 exec, s[96:97]
    s_cbranch_execz K2_TP
    v_cmp_gt_u32 vcc, s62, v59
    v_and_b32 v39, 0xffffff, v39
    s_mov_b64 exec, vcc
    buffer_load_dword v245, v39, s[16:19], 0 offen
K2_TP:
    s_mov_b64 exec, -1
K2_RK_DONE:
K2_PAD_SC:
    s_cbranch_execz KS_HOP
    s_mul_i32 s67, s24, 48
    s_movk_i32 s58, -1532
    s_waitcnt lgkmcnt(0)
    s_mov_b64 exec, s[40:41]
    s_cbranch_execz K2_SC_DONE
    v_cmpx_gt_u32 vcc, 64, v40
    v_bfe_u32 v194, v40, 3, 1
    v_add_u32 v193, 16, v40
    v_lshl_or_b32 v194, v40, 1, v194
    v_bfi_b32 v194, 15, v194, v40
    v_lshrrev_b32 v193, 6, v193
    v_alignbit_b32 v1, v2, v1, 16
    v_lshl_add_u32 v195, v194, 3, v50
    v_lshl_add_u32 v194, v194, 5, v50
    ds_write_b64 v195, v[0:1]
    v_mad_i32_i24 v194, v193, s58, v194
    ds_write_b32 v194, v3 offset:512
    s_mov_b64 exec, s[42:43]
    s_cbranch_execz K2_SC_DONE
    v_cmpx_gt_u32 vcc, 64, v41
    v_bfe_u32 v194, v41, 3, 1
    v_add_u32 v193, 16, v41
    v_lshl_or_b32 v194, v41, 1, v194
    v_bfi_b32 v194, 15, v194, v41
    v_lshrrev_b32 v193, 6, v193
    v_alignbit_b32 v5, v6, v5, 16
    v_lshl_add_u32 v195, v194, 3, v51
    v_lshl_add_u32 v194, v194, 5, v51
    ds_write_b64 v195, v[4:5]
    v_mad_i32_i24 v194, v193, s58, v194
    ds_write_b32 v194, v7 offset:512
    s_mov_b64 exec, s[44:45]
    s_cbranch_execz K2_SC_DONE
    v_cmpx_gt_u32 vcc, 64, v42
    v_bfe_u32 v194, v42, 3, 1
    v_add_u32 v193, 16, v42
    v_lshl_or_b32 v194, v42, 1, v194
    v_bfi_b32 v194, 15, v194, v42
    v_lshrrev_b32 v193, 6, v193
    v_alignbit_b32 v9, v10, v9, 16
    v_lshl_add_u32 v195, v194, 3, v52
    v_lshl_add_u32 v194, v194, 5, v52
    ds_write_b64 v195, v[8:9]
    v_mad_i32_i24 v194, v193, s58, v194
    ds_write_b32 v194, v11 offset:512
    s_mov_b64 exec, s[46:47]
    s_cbranch_execz K2_SC_DONE
    v_cmpx_gt_u32 vcc, 64, v43
    v_bfe_u32 v194, v43, 3, 1
    v_add_u32 v193, 16, v43
    v_lshl_or_b32 v194, v43, 1, v194
    v_bfi_b32 v194, 15, v194, v43
    v_lshrrev_b32 v193, 6, v193
    v_alignbit_b32 v13, v14, v13, 16
    v_lshl_add_u32 v195, v194, 3, v53
    v_lshl_add_u32 v194, v194, 5, v53
    ds_write_b64 v195, v[12:13]
    v_mad_i32_i24 v194, v193, s58, v194
    ds_write_b32 v194, v15 offset:512
    s_mov_b64 exec, s[48:49]
    s_cbranch_execz K2_SC_DONE
    v_cmpx_gt_u32 vcc, 64, v44
    v_bfe_u32 v194, v44, 3, 1
    v_add_u32 v193, 16, v44
    v_lshl_or_b32 v194, v44, 1, v194
    v_bfi_b32 v194, 15, v194, v44
    v_lshrrev_b32 v193, 6, v193
    v_alignbit_b32 v17, v18, v17, 16
    v_lshl_add_u32 v195, v194, 3, v54
    v_lshl_add_u32 v194, v194, 5, v54
    ds_write_b64 v195, v[16:17]
    v_mad_i32_i24 v194, v193, s58, v194
    ds_write_b32 v194, v19 offset:512
    s_mov_b64 exec, s[50:51]
    s_cbranch_execz K2_SC_DONE
    v_cmpx_gt_u32 vcc, 64, v45
    v_bfe_u32 v194, v45, 3, 1
    v_add_u32 v193, 16, v45
    v_lshl_or_b32 v194, v45, 1, v194
    v_bfi_b32 v194, 15, v194, v45
    v_lshrrev_b32 v193, 6, v193
    v_alignbit_b32 v21, v22, v21, 16
    v_lshl_add_u32 v195, v194, 3, v55
    v_lshl_add_u32 v194, v194, 5, v55
    ds_write_b64 v195, v[20:21]
    v_mad_i32_i24 v194, v193, s58, v194
    ds_write_b32 v194, v23 offset:512
    s_mov_b64 exec, s[90:91]
    s_cbranch_execz K2_SC_DONE
    v_cmpx_gt_u32 vcc, 64, v46
    v_bfe_u32 v194, v46, 3, 1
    v_add_u32 v193, 16, v46
    v_lshl_or_b32 v194, v46, 1, v194
    v_bfi_b32 v194, 15, v194, v46
    v_lshrrev_b32 v193, 6, v193
    v_alignbit_b32 v25, v26, v25, 16
    v_lshl_add_u32 v195, v194, 3, v56
    v_lshl_add_u32 v194, v194, 5, v56
    ds_write_b64 v195, v[24:25]
    v_mad_i32_i24 v194, v193, s58, v194
    ds_write_b32 v194, v27 offset:512
    s_mov_b64 exec, s[92:93]
    s_cbranch_execz K2_SC_DONE
    v_cmpx_gt_u32 vcc, 64, v47
    v_bfe_u32 v194, v47, 3, 1
    v_add_u32 v193, 16, v47
    v_lshl_or_b32 v194, v47, 1, v194
    v_bfi_b32 v194, 15, v194, v47
    v_lshrrev_b32 v193, 6, v193
    v_alignbit_b32 v29, v30, v29, 16
    v_lshl_add_u32 v195, v194, 3, v57
    v_lshl_add_u32 v194, v194, 5, v57
    ds_write_b64 v195, v[28:29]
    v_mad_i32_i24 v194, v193, s58, v194
    ds_write_b32 v194, v31 offset:512
    s_mov_b64 exec, s[94:95]
    s_cbranch_execz K2_SC_DONE
    v_cmpx_gt_u32 vcc, 64, v48
    v_bfe_u32 v194, v48, 3, 1
    v_add_u32 v193, 16, v48
    v_lshl_or_b32 v194, v48, 1, v194
    v_bfi_b32 v194, 15, v194, v48
    v_lshrrev_b32 v193, 6, v193
    v_alignbit_b32 v33, v34, v33, 16
    v_lshl_add_u32 v195, v194, 3, v58
    v_lshl_add_u32 v194, v194, 5, v58
    ds_write_b64 v195, v[32:33]
    v_mad_i32_i24 v194, v193, s58, v194
    ds_write_b32 v194, v35 offset:512
    s_mov_b64 exec, s[96:97]
    s_cbranch_execz K2_SC_DONE
    v_cmpx_gt_u32 vcc, 64, v49
    v_bfe_u32 v194, v49, 3, 1
    v_add_u32 v193, 16, v49
    v_lshl_or_b32 v194, v49, 1, v194
    v_bfi_b32 v194, 15, v194, v49
    v_lshrrev_b32 v193, 6, v193
    v_alignbit_b32 v37, v38, v37, 16
    v_lshl_add_u32 v195, v194, 3, v59
    v_lshl_add_u32 v194, v194, 5, v59
    ds_write_b64 v195, v[36:37]
    v_mad_i32_i24 v194, v193, s58, v194
    ds_write_b32 v194, v39 offset:512
K2_SC_DONE:
    s_mov_b64 exec, -1
K2_PAD_SD:
    s_cbranch_execz KS_HOP
    v_lshlrev_b32 v192, 2, v176
    v_add_u32 v192, 163072, v192
    v_mov_b32 v200, 163304
    s_cmp_eq_u32 s24, 0
    s_cselect_b32 s26, 64, 48
    s_waitcnt lgkmcnt(0)
    s_barrier
    ds_read_b32 v193, v192
    ds_read_b32 v200, v200
    v_cmp_gt_u32 s[56:57], s22, v176
    v_mad_u32_u24 v195, v176, s59, v202
    s_waitcnt lgkmcnt(0)
    v_cndmask_b32 v193, 0, v193, s[56:57]
    v_readfirstlane_b32 s27, v200
    v_cmp_lt_u32 s[62:63], 48, v193
    v_cmp_lt_u32 vcc, 64, v193
    s_bcnt1_i32_b64 s60, s[62:63]
    v_mbcnt_lo_u32_b32 v198, s62, 0
    v_mbcnt_hi_u32_b32 v198, s63, v198
    s_cbranch_vccnz K2_BIG
    s_cmp_gt_u32 s60, 8
    s_cbranch_scc1 K2_BIG
K2_TOK:
    v_subrev_u32 v194, s67, v193
    v_max_i32 v194, 1, v194
    v_min_i32 v194, s26, v194
    v_add_u32 v194, 15, v194
    v_lshrrev_b32 v194, 3, v194
    v_lshl_or_b32 v195, v194, 18, v195
    v_lshl_or_b32 v195, v198, 28, v195
    v_mov_b32 v197, 949760
    v_cndmask_b32 v253, v197, v195, s[56:57]
    s_movk_i32 s40, 0
    s_movk_i32 s41, 256
    s_movk_i32 s42, 512
    s_movk_i32 s43, 768
    s_add_u32 s24, s24, 1
    s_cmp_ge_u32 s24, s25
    s_cselect_b32 s55, 1, 0
    s_cmp_eq_u32 s27, 0
    s_cselect_b32 s55, s55, 0
    s_mov_b32 s27, 0x400000
    s_mov_b32 s38, 0
    s_mov_b32 s34, 0
    s_mov_b32 s35, 0
    s_mov_b32 s36, 1
    s_mov_b32 s31, 0
    s_mov_b32 s58, s20
    v_readlane_b32 s3, v253, s58
    s_lshl_b32 s44, s34, 7
    s_and_b32 s48, s3, 0x3ffff
    s_bfe_u32 s33, s3, 0x30013
    s_mul_i32 s35, s38, 6
    s_cmp_eq_u32 s34, 0
    s_cselect_b32 s35, s35, s48
    s_mov_b32 s45, s44
    s_xor_b32 s47, s44, 256
    s_add_u32 s49, s48, 128
    s_add_u32 s60, s48, 256
    s_cmp_eq_u32 s33, 3
    s_cselect_b32 s46, s44, s47
    s_cselect_b32 s50, s60, s48
    s_sub_u32 s60, s33, 2
    s_cmp_lt_u32 s60, 2
    s_cbranch_scc0 K2_rare_1
K2_back_2:
    v_mov_b32 v44, -1
    v_mov_b32 v45, -1
    v_add_u32 v43, s48, v232
    ds_read_b32 v42, v43
    ds_read_b32 v43, v43 offset:1024
    v_add_u32 v222, s48, v251
    ds_read2_b32 v[222:223], v222 offset0:1 offset1:3
    v_add_u32 v224, s49, v251
    ds_read2_b32 v[224:225], v224 offset0:1 offset1:3
    v_add_u32 v226, s50, v251
    ds_read2_b32 v[226:227], v226 offset0:1 offset1:3
    s_waitcnt lgkmcnt(3)
    v_or_b32 v42, v42, v233
    v_or_b32 v43, v43, v233
    s_cmp_lg_u32 s34, 0
    s_cbranch_scc1 K2_dum_4
    s_cmp_eq_u32 s33, 4
    s_cbranch_scc1 K2_a4_5
K2_b4_7:
    s_add_u32 m0, s48, 512
    s_add_u32 s65, s48, 1536
    buffer_load_dwordx4 v42, s[16:19], 0 offen  lds
    s_mov_b32 m0, s65
    s_mov_b32 exec_hi, 0
    buffer_load_dwordx4 v43, s[16:19], 0 offen  lds
    s_mov_b32 exec_hi, -1
K2_back_6:
    s_waitcnt lgkmcnt(2)
    v_mad_u32_u16 v222, v222, s39, v248 op_sel:[1,0,0,0]
    v_mad_u32_u16 v223, v223, s39, v248 op_sel:[1,0,0,0]
    s_waitcnt lgkmcnt(1)
    v_mad_u32_u16 v224, v224, s39, v248 op_sel:[1,0,0,0]
    v_mad_u32_u16 v225, v225, s39, v248 op_sel:[1,0,0,0]
    s_waitcnt lgkmcnt(0)
    v_mad_u32_u16 v226, v226, s39, v248 op_sel:[1,0,0,0]
    v_mad_u32_u16 v227, v227, s39, v248 op_sel:[1,0,0,0]
    s_mov_b32 m0, s68
    s_nop 0
    buffer_load_dwordx4 v222, s[4:7], s44 offen sc1 lds
    buffer_load_dwordx4 v223, s[72:75], s44 offen offset:1024 sc1 lds
    s_mov_b32 m0, s69
    s_nop 0
    buffer_load_dwordx4 v224, s[4:7], s45 offen sc1 lds
    buffer_load_dwordx4 v225, s[72:75], s45 offen offset:1024 sc1 lds
    s_mov_b32 m0, s70
    s_nop 0
    buffer_load_dwordx4 v226, s[4:7], s46 offen sc1 lds
    buffer_load_dwordx4 v227, s[72:75], s46 offen offset:1024 sc1 lds
    s_mov_b32 m0, s71
    s_cmp_eq_u32 s33, 4
    s_cbranch_scc1 K2_g4_8
    buffer_load_dwordx4 v224, s[4:7], s47 offen sc1 lds
    buffer_load_dwordx4 v225, s[72:75], s47 offen offset:1024 sc1 lds
K2_back_9:
    v_add_u32 v249, s48, v249
    v_add_u32 v250, s48, v250
    v_bfe_u32 v192, v253, 18, 4
    s_sub_u32 s58, s22, 16
    v_cmp_le_u32 vcc, 6, v192
    v_cmp_gt_u32 s[60:61], s58, v176
    s_nop 0
    s_or_b64 vcc, vcc, s[60:61]
    v_mbcnt_lo_u32_b32 v192, vcc_lo, 0
    v_mbcnt_hi_u32_b32 v192, vcc_hi, v192
    s_bcnt1_i32_b64 s58, vcc
    v_sub_u32 v193, v176, v192
    v_add_u32 v193, s58, v193
    v_cndmask_b32 v192, v193, v192, vcc
    v_lshlrev_b32 v192, 2, v192
    ds_permute_b32 v193, v192, v176
    s_waitcnt lgkmcnt(0)
    v_lshl_or_b32 v253, v193, 22, v253
    s_waitcnt vmcnt(6)
    ds_read_b64_tr_b16 v[176:177], v246 offset:0
    ds_read_b64_tr_b16 v[178:179], v246 offset:1024
    ds_read_b64_tr_b16 v[180:181], v247 offset:0
    ds_read_b64_tr_b16 v[182:183], v247 offset:1024
    ds_read_b64_tr_b16 v[80:81], v249 offset:0
    ds_read_u16_d16_hi v40, v250 offset:0
    ds_read_b64_tr_b16 v[88:89], v249 offset:512
    ds_read_u16_d16_hi v41, v250 offset:128
    s_mov_b32 s29, s48
    s_mov_b32 s32, s31
    s_mov_b32 s30, s3
    s_mov_b32 s31, s35
    s_bfe_u32 s56, s3, 0x40012
    s_cmp_eq_u32 s56, 5
    s_cbranch_scc1 K2_U20
    s_cmp_eq_u32 s56, 6
    s_cbranch_scc1 K2_U3h0
    s_branch K2_DSP0
K2_PAD_H1:
    s_branch KS_HOP0
KS_HELP:
    s_mov_b32 s30, 0
    s_cmp_eq_u32 s20, 6
    s_cbranch_scc1 KS_RAW
    s_mov_b32 s30, 2
    s_cmp_ge_u32 s2, 170
    s_cbranch_scc1 KS_NOW
    s_mov_b32 s30, 1
    v_and_b32 v1, 15, v8
    v_lshrrev_b32 v3, 4, v8
    s_cmp_ge_u32 s2, 160
    s_cbranch_scc1 K1_WT
    s_cmp_ge_u32 s2, 64
    s_cbranch_scc1 K1_S1
    s_lshr_b32 s24, s2, 3
    s_and_b32 s25, s2, 7
    s_lshr_b32 s26, s25, 2
    s_bfe_u32 s27, s25, 0x10001
    s_and_b32 s28, s25, 1
    s_mov_b32 s60, s92
    s_and_b32 s61, s93, 0xffff
    s_mov_b32 s62, 65536
    s_mov_b32 s63, 0x20000
    s_branch K1_SC
K1_S1:
    s_sub_u32 s29, s2, 64
    s_mul_i32 s24, s29, 43
    s_lshr_b32 s24, s24, 9
    s_mul_i32 s25, s24, 12
    s_sub_u32 s25, s29, s25
    s_cmp_ge_u32 s25, 6
    s_cselect_b32 s26, 1, 0
    s_mul_i32 s27, s26, 6
    s_sub_u32 s27, s25, s27
    s_lshr_b32 s27, s27, 1
    s_and_b32 s28, s25, 1
    s_add_u32 s25, s25, 8
    s_mov_b32 s60, s94
    s_and_b32 s61, s95, 0xffff
    s_mov_b32 s62, 98304
    s_mov_b32 s63, 0x20000
K1_SC:
    s_lshl_b32 s27, s27, 7
    s_lshl_b32 s26, s26, 6
    s_lshl_b32 s28, s28, 4
    s_add_u32 s27, s27, s26
    s_add_u32 s27, s27, s28
    s_lshl_b32 s27, s27, 8
    s_lshl_b32 s26, s24, 5
    s_add_u32 s27, s27, s26
    s_add_u32 s29, s27, 8192
    v_lshlrev_b32 v3, 10, v3
    v_lshl_add_u32 v3, v1, 1, v3
    buffer_load_ushort v64, v3, s[60:63], s27 offen offset:0
    buffer_load_ushort v65, v3, s[60:63], s29 offen offset:0
    buffer_load_ushort v66, v3, s[60:63], s27 offen offset:256
    buffer_load_ushort v67, v3, s[60:63], s29 offen offset:256
    buffer_load_ushort v68, v3, s[60:63], s27 offen offset:512
    buffer_load_ushort v69, v3, s[60:63], s29 offen offset:512
    buffer_load_ushort v70, v3, s[60:63], s27 offen offset:768
    buffer_load_ushort v71, v3, s[60:63], s29 offen offset:768
    s_mul_i32 s24, s24, 20
    s_add_u32 s24, s24, s25
    s_lshl_b32 s24, s24, 10
    s_add_u32 s24, s24, 6946816
    s_branch K1_GO
K1_WT:
    s_sub_u32 s24, s2, 160
    s_lshr_b32 s27, s24, 1
    s_and_b32 s28, s24, 1
    s_lshl_b32 s27, s27, 8
    s_lshl_b32 s28, s28, 6
    s_add_u32 s27, s27, s28
    s_add_u32 s29, s27, 10240
    s_mov_b32 s60, s90
    s_and_b32 s61, s91, 0xffff
    s_mov_b32 s62, 20480
    s_mov_b32 s63, 0x20000
    v_and_b32 v1, 31, v8
    v_lshrrev_b32 v3, 5, v8
    v_mul_u32_u24 v3, 5120, v3
    v_lshl_add_u32 v3, v1, 1, v3
    buffer_load_ushort v64, v3, s[60:63], s27 offen offset:0
    buffer_load_ushort v65, v3, s[60:63], s27 offen offset:1280
    buffer_load_ushort v66, v3, s[60:63], s27 offen offset:2560
    buffer_load_ushort v67, v3, s[60:63], s27 offen offset:3840
    buffer_load_ushort v68, v3, s[60:63], s29 offen offset:0
    buffer_load_ushort v69, v3, s[60:63], s29 offen offset:1280
    buffer_load_ushort v70, v3, s[60:63], s29 offen offset:2560
    buffer_load_ushort v71, v3, s[60:63], s29 offen offset:3840
    s_lshl_b32 s24, s24, 10
    s_add_u32 s24, s24, 7110656
K1_GO:
KS_NOW:
    s_barrier
K2_PAD_H2:
    s_cbranch_execz KS_HOP0
    v_and_b32 v76, 31, v8
    v_lshrrev_b32 v77, 5, v8
    v_mov_b32 v80, 0
    v_mul_u32_u24 v77, 2080, v77
    v_mov_b32 v81, 0xffff0000
    v_lshl_add_u32 v78, v76, 4, v77
    v_mov_b32 v82, 0
    v_add_u32 v78, 65536, v78
    v_mov_b32 v83, v81
    v_add_u32 v79, 41600, v78
    ds_write_b128 v78, v[80:83] offset:0
    ds_write_b128 v78, v[80:83] offset:4160
    ds_write_b128 v78, v[80:83] offset:8320
    ds_write_b128 v78, v[80:83] offset:12480
    ds_write_b128 v78, v[80:83] offset:16640
    ds_write_b128 v78, v[80:83] offset:20800
    ds_write_b128 v78, v[80:83] offset:24960
    ds_write_b128 v78, v[80:83] offset:29120
    ds_write_b128 v78, v[80:83] offset:33280
    ds_write_b128 v78, v[80:83] offset:37440
    ds_write_b128 v79, v[80:83] offset:0
    ds_write_b128 v79, v[80:83] offset:4160
    ds_write_b128 v79, v[80:83] offset:8320
    ds_write_b128 v79, v[80:83] offset:12480
    ds_write_b128 v79, v[80:83] offset:16640
    ds_write_b128 v79, v[80:83] offset:20800
    ds_write_b128 v79, v[80:83] offset:24960
    ds_write_b128 v79, v[80:83] offset:29120
    ds_write_b128 v79, v[80:83] offset:33280
    ds_write_b128 v79, v[80:83] offset:37440
KS_FILL:
    v_mov_b32 v59, 163456
    s_barrier
    ds_read_b32 v59, v59
    s_waitcnt vmcnt(0) lgkmcnt(0)
    s_cmp_eq_u32 s30, 0
    s_cbranch_scc1 KS_B3
    s_cmp_eq_u32 s30, 2
    s_cbranch_scc1 KS_NOST
    v_lshl_or_b32 v40, v65, 16, v64
    v_lshl_or_b32 v41, v67, 16, v66
    v_lshl_or_b32 v42, v69, 16, v68
    v_lshl_or_b32 v43, v71, 16, v70
    buffer_store_dwordx4 v[40:43], v9, s[8:11], s24 offen sc1
KS_NOST:
    v_mov_b32 v62, 163460
    s_waitcnt lgkmcnt(0)
    s_barrier
    ds_read_b32 v62, v62
    s_lshl_b32 s24, s2, 2
    s_add_u32 s24, s24, 7176192
    s_mov_b64 exec, 1
    s_waitcnt vmcnt(0)
    buffer_store_dword v59, v6, s[8:11], s24 offen sc1
    s_mov_b64 exec, -1
    s_branch KS_JOIN
K2_PAD_H3:
    s_branch KS_HOP0
KS_RAW:
    s_cmp_lg_u32 s2, 0
    s_cbranch_scc1 KS_NOX
    s_mov_b32 s60, s98
    s_and_b32 s61, s99, 0xffff
    s_mov_b32 s62, 256
    s_mov_b32 s63, 0x20000
    s_getreg_b32 s24, hwreg(HW_REG_XCC_ID, 0, 1)
    s_add_u32 s24, s24, 1
    v_mov_b32 v10, s24
    v_mov_b32 v11, 0
    s_mov_b64 exec, 1
    buffer_atomic_cmpswap v[10:11], v6, s[60:63], 0 offen sc1
    s_mov_b64 exec, -1
KS_NOX:
    s_barrier
    s_mov_b32 s60, s90
    s_and_b32 s61, s91, 0xffff
    s_mov_b32 s62, 20480
    s_mov_b32 s63, 0x20000
    v_lshrrev_b32 v10, 3, v8
    v_and_b32 v11, 7, v8
    v_lshlrev_b32 v10, 8, v10
    v_lshl_add_u32 v10, v11, 4, v10
    s_mov_b32 m0, 24576
    s_movk_i32 s24, 0
    buffer_load_dwordx4 v10, s[60:63], s24 offen lds
    s_mov_b32 m0, 25600
    s_movk_i32 s24, 2048
    buffer_load_dwordx4 v10, s[60:63], s24 offen lds
    s_mov_b32 m0, 26624
    s_movk_i32 s24, 4096
    buffer_load_dwordx4 v10, s[60:63], s24 offen lds
    s_mov_b32 m0, 27648
    s_movk_i32 s24, 6144
    buffer_load_dwordx4 v10, s[60:63], s24 offen lds
    s_mov_b32 m0, 28672
    s_movk_i32 s24, 8192
    buffer_load_dwordx4 v10, s[60:63], s24 offen lds
    s_mov_b32 m0, 29696
    s_movk_i32 s24, 10240
    buffer_load_dwordx4 v10, s[60:63], s24 offen lds
    s_mov_b32 m0, 30720
    s_movk_i32 s24, 12288
    buffer_load_dwordx4 v10, s[60:63], s24 offen lds
    s_mov_b32 m0, 31744
    s_movk_i32 s24, 14336
    buffer_load_dwordx4 v10, s[60:63], s24 offen lds
    s_mov_b32 m0, 32768
    s_movk_i32 s24, 16384
    buffer_load_dwordx4 v10, s[60:63], s24 offen lds
    s_mov_b32 m0, 33792
    s_movk_i32 s24, 18432
    buffer_load_dwordx4 v10, s[60:63], s24 offen lds
    s_mov_b32 m0, 152832
    s_movk_i32 s24, 128
    buffer_load_dwordx4 v10, s[60:63], s24 offen lds
    s_mov_b32 m0, 153856
    s_movk_i32 s24, 2176
    buffer_load_dwordx4 v10, s[60:63], s24 offen lds
    s_mov_b32 m0, 154880
    s_movk_i32 s24, 4224
    buffer_load_dwordx4 v10, s[60:63], s24 offen lds
    s_mov_b32 m0, 155904
    s_movk_i32 s24, 6272
    buffer_load_dwordx4 v10, s[60:63], s24 offen lds
    s_mov_b32 m0, 156928
    s_movk_i32 s24, 8320
    buffer_load_dwordx4 v10, s[60:63], s24 offen lds
    s_mov_b32 m0, 157952
    s_movk_i32 s24, 10368
    buffer_load_dwordx4 v10, s[60:63], s24 offen lds
    s_mov_b32 m0, 158976
    s_movk_i32 s24, 12416
    buffer_load_dwordx4 v10, s[60:63], s24 offen lds
    s_mov_b32 m0, 160000
    s_movk_i32 s24, 14464
    buffer_load_dwordx4 v10, s[60:63], s24 offen lds
    s_mov_b32 m0, 161024
    s_movk_i32 s24, 16512
    buffer_load_dwordx4 v10, s[60:63], s24 offen lds
    s_mov_b32 m0, 162048
    s_movk_i32 s24, 18560
    buffer_load_dwordx4 v10, s[60:63], s24 offen lds
    v_add_u32 v85, 16, v8
    v_lshlrev_b32 v84, 5, v8
    v_lshrrev_b32 v85, 6, v85
    v_mul_u32_u24 v85, 1532, v85
    v_sub_u32 v84, v84, v85
    v_mov_b32 v85, -1
    v_add_u32 v84, 66048, v84
    v_add_u32 v86, 41600, v84
    ds_write_b32 v84, v85 offset:0
    ds_write_b32 v84, v85 offset:2080
    ds_write_b32 v84, v85 offset:4160
    ds_write_b32 v84, v85 offset:6240
    ds_write_b32 v84, v85 offset:8320
    ds_write_b32 v84, v85 offset:10400
    ds_write_b32 v84, v85 offset:12480
    ds_write_b32 v84, v85 offset:14560
    ds_write_b32 v84, v85 offset:16640
    ds_write_b32 v84, v85 offset:18720
    ds_write_b32 v84, v85 offset:20800
    ds_write_b32 v84, v85 offset:22880
    ds_write_b32 v84, v85 offset:24960
    ds_write_b32 v84, v85 offset:27040
    ds_write_b32 v84, v85 offset:29120
    ds_write_b32 v84, v85 offset:31200
    ds_write_b32 v84, v85 offset:33280
    ds_write_b32 v84, v85 offset:35360
    ds_write_b32 v84, v85 offset:37440
    ds_write_b32 v84, v85 offset:39520
    ds_write_b32 v86, v85 offset:0
    ds_write_b32 v86, v85 offset:2080
    ds_write_b32 v86, v85 offset:4160
    ds_write_b32 v86, v85 offset:6240
    ds_write_b32 v86, v85 offset:8320
    ds_write_b32 v86, v85 offset:10400
    ds_write_b32 v86, v85 offset:12480
    ds_write_b32 v86, v85 offset:14560
    ds_write_b32 v86, v85 offset:16640
    ds_write_b32 v86, v85 offset:18720
    ds_write_b32 v86, v85 offset:20800
    ds_write_b32 v86, v85 offset:22880
    ds_write_b32 v86, v85 offset:24960
    ds_write_b32 v86, v85 offset:27040
    ds_write_b32 v86, v85 offset:29120
    ds_write_b32 v86, v85 offset:31200
    ds_write_b32 v86, v85 offset:33280
    ds_write_b32 v86, v85 offset:35360
    ds_write_b32 v86, v85 offset:37440
    ds_write_b32 v86, v85 offset:39520
    s_branch KS_FILL
KS_IDLE:
    s_barrier
    s_barrier
    s_branch KS_B3
K2_PAD_U20:
    s_branch K2_HOP
K2_U20:
    s_setprio 1
    s_waitcnt lgkmcnt(0)
    v_lshlrev_b32 v16, 16, v80
    v_and_b32 v17, 0xffff0000, v80
    v_lshlrev_b32 v18, 16, v81
    v_and_b32 v19, 0xffff0000, v81
    v_mov_b32 v82, v81
    v_mul_f32_dpp v32, v40, v16 row_newbcast:4 row_mask:0xf bank_mask:0xf
    v_mul_f32_dpp v33, v40, v17 row_newbcast:5 row_mask:0xf bank_mask:0xf
    v_mul_f32_dpp v34, v40, v18 row_newbcast:6 row_mask:0xf bank_mask:0xf
    v_mul_f32_dpp v35, v40, v19 row_newbcast:7 row_mask:0xf bank_mask:0xf
    v_cvt_pk_bf16_f32 v84, v32, v33
    v_cvt_pk_bf16_f32 v86, v34, v35
    v_mul_f32_dpp v36, v40, v16 row_newbcast:8 row_mask:0xf bank_mask:0xf
    v_mul_f32_dpp v37, v40, v17 row_newbcast:9 row_mask:0xf bank_mask:0xf
    v_mul_f32_dpp v38, v40, v18 row_newbcast:10 row_mask:0xf bank_mask:0xf
    v_mul_f32_dpp v39, v40, v19 row_newbcast:11 row_mask:0xf bank_mask:0xf
    v_cvt_pk_bf16_f32 v85, v36, v37
    v_cvt_pk_bf16_f32 v87, v38, v39
    v_mul_f32_dpp v16, v40, v16 row_newbcast:0 row_mask:0xf bank_mask:0xf
    v_mul_f32_dpp v17, v40, v17 row_newbcast:1 row_mask:0xf bank_mask:0xf
    v_mul_f32_dpp v18, v40, v18 row_newbcast:2 row_mask:0xf bank_mask:0xf
    v_mul_f32_dpp v19, v40, v19 row_newbcast:3 row_mask:0xf bank_mask:0xf
    v_cvt_pk_bf16_f32 v81, v16, v17
    v_cvt_pk_bf16_f32 v83, v18, v19
    v_permlane16_swap_b32 v84, v85
    v_permlane16_swap_b32 v86, v87
    v_permlane16_swap_b32 v80, v81
    v_permlane16_swap_b32 v82, v83
    v_lshlrev_b32 v24, 16, v88
    v_and_b32 v25, 0xffff0000, v88
    v_lshlrev_b32 v26, 16, v89
    v_and_b32 v27, 0xffff0000, v89
    v_mov_b32 v90, v89
    v_mul_f32_dpp v32, v41, v24 row_newbcast:4 row_mask:0xf bank_mask:0xf
    v_mul_f32_dpp v33, v41, v25 row_newbcast:5 row_mask:0xf bank_mask:0xf
    v_mul_f32_dpp v34, v41, v26 row_newbcast:6 row_mask:0xf bank_mask:0xf
    v_mul_f32_dpp v35, v41, v27 row_newbcast:7 row_mask:0xf bank_mask:0xf
    v_cvt_pk_bf16_f32 v92, v32, v33
    v_cvt_pk_bf16_f32 v94, v34, v35
    v_mul_f32_dpp v36, v41, v24 row_newbcast:8 row_mask:0xf bank_mask:0xf
    v_mul_f32_dpp v37, v41, v25 row_newbcast:9 row_mask:0xf bank_mask:0xf
    v_mul_f32_dpp v38, v41, v26 row_newbcast:10 row_mask:0xf bank_mask:0xf
    v_mul_f32_dpp v39, v41, v27 row_newbcast:11 row_mask:0xf bank_mask:0xf
    v_cvt_pk_bf16_f32 v93, v36, v37
    v_cvt_pk_bf16_f32 v95, v38, v39
    v_mul_f32_dpp v24, v41, v24 row_newbcast:0 row_mask:0xf bank_mask:0xf
    v_mul_f32_dpp v25, v41, v25 row_newbcast:1 row_mask:0xf bank_mask:0xf
    v_mul_f32_dpp v26, v41, v26 row_newbcast:2 row_mask:0xf bank_mask:0xf
    v_mul_f32_dpp v27, v41, v27 row_newbcast:3 row_mask:0xf bank_mask:0xf
    v_cvt_pk_bf16_f32 v89, v24, v25
    v_cvt_pk_bf16_f32 v91, v26, v27
    v_permlane16_swap_b32 v92, v93
    v_permlane16_swap_b32 v94, v95
    v_permlane16_swap_b32 v88, v89
    v_permlane16_swap_b32 v90, v91
    s_waitcnt vmcnt(4)
    v_mfma_f32_32x32x16_bf16 v[8:23], v[80:83], v[176:179], 0
    ds_read_b64_tr_b16 v[184:185], v246 offset:2048
    ds_read_b64_tr_b16 v[186:187], v246 offset:3072
    ds_read_b64_tr_b16 v[188:189], v247 offset:2048
    ds_read_b64_tr_b16 v[190:191], v247 offset:3072
    s_mov_b32 m0, s68
    v_mfma_f32_32x32x16_bf16 v[24:39], v[84:87], v[176:179], 0
    buffer_load_dwordx4 v222, s[4:7], s42 offen sc1 lds
    buffer_load_dwordx4 v223, s[72:75], s42 offen offset:1024 sc1 lds
    v_permlane32_swap_b32 v236, v234
    v_permlane32_swap_b32 v237, v235
    s_add_u32 s38, s38, 1
    v_mfma_f32_32x32x16_bf16 v[48:63], v[80:83], v[180:183], 0
    v_permlane32_swap_b32 v240, v238
    v_permlane32_swap_b32 v241, v239
    v_add_f32 v236, v236, v234
    v_add_f32 v237, v237, v235
    v_add_f32 v240, -v240, -v238
    v_mfma_f32_32x32x16_bf16 v[64:79], v[84:87], v[180:183], 0
    v_add_f32 v241, -v241, -v239
    s_set_gpr_idx_on s32, gpr_idx(DST)
    s_nop 0
    v_cvt_pk_bf16_f32 v194, v236, v237
    v_cvt_pk_bf16_f32 v195, v240, v241
    s_set_gpr_idx_off
    v_mov_b32 v254, s52
    s_waitcnt vmcnt(4) lgkmcnt(0)
    v_mfma_f32_32x32x16_bf16 v[8:23], v[88:91], v[184:187], v[8:23]
    ds_read_b64_tr_b16 v[176:177], v246 offset:4096
    ds_read_b64_tr_b16 v[178:179], v246 offset:5120
    ds_read_b64_tr_b16 v[180:181], v247 offset:4096
    ds_read_b64_tr_b16 v[182:183], v247 offset:5120
    v_mov_b32 v255, s38
    s_lshl_b32 s58, s38, 3
    s_mov_b32 m0, s69
    v_mfma_f32_32x32x16_bf16 v[24:39], v[92:95], v[184:187], v[24:39]
    buffer_load_dwordx4 v224, s[4:7], s42 offen sc1 lds
    buffer_load_dwordx4 v225, s[72:75], s42 offen offset:1024 sc1 lds
    s_add_u32 s58, s58, s20
    s_mov_b64 exec, 1
    ds_write_b32 v254, v255
    s_mov_b64 exec, -1
    s_cmp_lt_u32 s58, s22
    s_cbranch_scc0 K2_dyn_10
K2_back_11:
    v_readlane_b32 s3, v253, s58
    s_lshl_b32 s44, s34, 7
    s_and_b32 s48, s3, 0x3ffff
    s_bfe_u32 s33, s3, 0x30013
    s_mul_i32 s35, s38, 6
    s_cmp_eq_u32 s34, 0
    s_cselect_b32 s35, s35, s48
    s_mov_b32 s45, s44
    s_xor_b32 s47, s44, 256
    s_add_u32 s49, s48, 128
    s_add_u32 s60, s48, 256
    s_cmp_eq_u32 s33, 3
    s_cselect_b32 s46, s44, s47
    s_cselect_b32 s50, s60, s48
    s_sub_u32 s60, s33, 2
    s_cmp_lt_u32 s60, 2
    s_cbranch_scc0 K2_rare_16
K2_back_17:
    v_mfma_f32_32x32x16_bf16 v[48:63], v[88:91], v[188:191], v[48:63]
    v_add_u32 v43, s48, v232
    ds_read_b32 v42, v43
    ds_read_b32 v43, v43 offset:1024
    v_mul_f32 v234, v8, v96
    v_mul_f32 v236, v16, v128
    v_fmac_f32 v234, v9, v97
    v_fmac_f32 v236, v17, v129
    v_mfma_f32_32x32x16_bf16 v[64:79], v[92:95], v[188:191], v[64:79]
    s_setprio 0
    v_fmac_f32 v234, v10, v98
    v_fmac_f32 v236, v18, v130
    v_fmac_f32 v234, v11, v99
    v_fmac_f32 v236, v19, v131
    v_fmac_f32 v234, v12, v100
    v_fmac_f32 v236, v20, v132
    v_fmac_f32 v234, v13, v101
    v_fmac_f32 v236, v21, v133
    v_fmac_f32 v234, v14, v102
    v_fmac_f32 v236, v22, v134
    v_fmac_f32 v234, v15, v103
    v_fmac_f32 v236, v23, v135
    v_mul_f32 v238, v24, v128
    v_mul_f32 v240, v32, v128
    v_fmac_f32 v238, v25, v129
    v_fmac_f32 v240, v33, v129
    v_fmac_f32 v238, v26, v130
    v_fmac_f32 v240, v34, v130
    v_fmac_f32 v238, v27, v131
    v_fmac_f32 v240, v35, v131
    v_fmac_f32 v238, v28, v132
    v_fmac_f32 v240, v36, v132
    v_fmac_f32 v238, v29, v133
    v_fmac_f32 v240, v37, v133
    v_fmac_f32 v238, v30, v134
    v_fmac_f32 v240, v38, v134
    v_fmac_f32 v238, v31, v135
    v_fmac_f32 v240, v39, v135
    v_mul_f32 v235, v48, v104
    v_mul_f32 v237, v56, v136
    v_fmac_f32 v235, v49, v105
    v_fmac_f32 v237, v57, v137
    v_fmac_f32 v235, v50, v106
    v_fmac_f32 v237, v58, v138
    v_fmac_f32 v235, v51, v107
    v_fmac_f32 v237, v59, v139
    v_fmac_f32 v235, v52, v108
    v_fmac_f32 v237, v60, v140
    v_fmac_f32 v235, v53, v109
    v_fmac_f32 v237, v61, v141
    v_fmac_f32 v235, v54, v110
    v_fmac_f32 v237, v62, v142
    v_fmac_f32 v235, v55, v111
    v_fmac_f32 v237, v63, v143
    v_mul_f32 v239, v64, v136
    v_mul_f32 v241, v72, v136
    v_fmac_f32 v239, v65, v137
    v_fmac_f32 v241, v73, v137
    s_setprio 1
    s_waitcnt vmcnt(4) lgkmcnt(3)
    v_mfma_f32_32x32x16_bf16 v[24:39], v[84:87], v[176:179], 0
    ds_read_b64_tr_b16 v[184:185], v246 offset:6144
    ds_read_b64_tr_b16 v[186:187], v246 offset:7168
    ds_read_b64_tr_b16 v[188:189], v247 offset:6144
    ds_read_b64_tr_b16 v[190:191], v247 offset:7168
    v_fmac_f32 v239, v66, v138
    v_fmac_f32 v241, v74, v138
    s_mov_b32 m0, s70
    v_mfma_f32_32x32x16_bf16 v[8:23], v[80:83], v[176:179], 0
    buffer_load_dwordx4 v222, s[4:7], s43 offen sc1 lds
    buffer_load_dwordx4 v223, s[72:75], s43 offen offset:1024 sc1 lds
    v_fmac_f32 v239, v67, v139
    v_fmac_f32 v241, v75, v139
    v_fmac_f32 v239, v68, v140
    v_fmac_f32 v241, v76, v140
    v_fmac_f32 v239, v69, v141
    v_mfma_f32_32x32x16_bf16 v[48:63], v[80:83], v[180:183], 0
    v_add_u32 v222, s48, v251
    ds_read2_b32 v[222:223], v222 offset0:1 offset1:3
    v_fmac_f32 v241, v77, v141
    v_fmac_f32 v239, v70, v142
    v_fmac_f32 v241, v78, v142
    v_fmac_f32 v239, v71, v143
    v_fmac_f32 v241, v79, v143
    v_mfma_f32_32x32x16_bf16 v[64:79], v[84:87], v[180:183], 0
    v_permlane32_swap_b32 v234, v236
    v_permlane32_swap_b32 v235, v237
    v_permlane32_swap_b32 v238, v239
    s_waitcnt lgkmcnt(5)
    v_or_b32 v42, v42, v233
    v_or_b32 v43, v43, v233
    s_cmp_lg_u32 s34, 0
    s_cbranch_scc1 K2_dum_21
    s_cmp_eq_u32 s33, 4
    s_cbranch_scc1 K2_a4_22
K2_b4_24:
    s_add_u32 m0, s48, 512
    s_add_u32 s65, s48, 1536
    buffer_load_dwordx4 v42, s[16:19], 0 offen  lds
    s_mov_b32 m0, s65
    s_mov_b32 exec_hi, 0
    buffer_load_dwordx4 v43, s[16:19], 0 offen  lds
    s_mov_b32 exec_hi, -1
K2_back_23:
    s_waitcnt vmcnt(6) lgkmcnt(1)
    v_mfma_f32_32x32x16_bf16 v[24:39], v[92:95], v[184:187], v[24:39]
    ds_read_b64_tr_b16 v[176:177], v246 offset:0
    ds_read_b64_tr_b16 v[178:179], v246 offset:1024
    ds_read_b64_tr_b16 v[180:181], v247 offset:0
    ds_read_b64_tr_b16 v[182:183], v247 offset:1024
    v_add_f32 v234, v234, v236
    v_add_f32 v235, v235, v237
    s_mov_b32 m0, s71
    v_mfma_f32_32x32x16_bf16 v[8:23], v[88:91], v[184:187], v[8:23]
    buffer_load_dwordx4 v224, s[4:7], s43 offen sc1 lds
    buffer_load_dwordx4 v225, s[72:75], s43 offen offset:1024 sc1 lds
    s_waitcnt lgkmcnt(4)
    v_mad_u32_u16 v222, v222, s39, v248 op_sel:[1,0,0,0]
    v_mad_u32_u16 v223, v223, s39, v248 op_sel:[1,0,0,0]
    v_add_f32 v238, -v238, -v239
    s_set_gpr_idx_on s31, gpr_idx(DST)
    s_nop 0
    v_cvt_pk_bf16_f32 v192, v234, v235
    v_cvt_pk_bf16_f32 v197, v238, v238
    s_set_gpr_idx_off
    v_mfma_f32_32x32x16_bf16 v[48:63], v[88:91], v[188:191], v[48:63]
    v_add_u32 v224, s49, v251
    ds_read2_b32 v[224:225], v224 offset0:1 offset1:3
    v_mul_f32 v236, v24, v160
    v_mul_f32 v238, v32, v160
    v_fmac_f32 v236, v25, v161
    v_fmac_f32 v238, v33, v161
    v_fmac_f32 v236, v26, v162
    v_mfma_f32_32x32x16_bf16 v[64:79], v[92:95], v[188:191], v[64:79]
    s_setprio 0
    v_fmac_f32 v238, v34, v162
    v_fmac_f32 v236, v27, v163
    v_fmac_f32 v238, v35, v163
    v_fmac_f32 v236, v28, v164
    v_fmac_f32 v238, v36, v164
    v_fmac_f32 v236, v29, v165
    v_fmac_f32 v238, v37, v165
    v_fmac_f32 v236, v30, v166
    v_fmac_f32 v238, v38, v166
    v_fmac_f32 v236, v31, v167
    v_fmac_f32 v238, v39, v167
    v_mul_f32 v234, v8, v144
    v_mul_f32 v235, v48, v152
    v_fmac_f32 v234, v9, v145
    v_fmac_f32 v235, v49, v153
    v_fmac_f32 v234, v10, v146
    v_fmac_f32 v235, v50, v154
    v_fmac_f32 v234, v11, v147
    v_fmac_f32 v235, v51, v155
    v_fmac_f32 v234, v12, v148
    v_fmac_f32 v235, v52, v156
    v_fmac_f32 v234, v13, v149
    v_fmac_f32 v235, v53, v157
    v_fmac_f32 v234, v14, v150
    v_fmac_f32 v235, v54, v158
    v_fmac_f32 v234, v15, v151
    v_fmac_f32 v235, v55, v159
    v_mul_f32 v237, v64, v168
    v_mul_f32 v239, v72, v168
    v_fmac_f32 v237, v65, v169
    v_fmac_f32 v239, v73, v169
    v_fmac_f32 v237, v66, v170
    v_fmac_f32 v239, v74, v170
    v_fmac_f32 v237, v67, v171
    s_setprio 1
    s_waitcnt vmcnt(6) lgkmcnt(1)
    v_mfma_f32_32x32x16_bf16 v[24:39], v[80:83], v[176:179], 0
    ds_read_b64_tr_b16 v[184:185], v246 offset:2048
    ds_read_b64_tr_b16 v[186:187], v246 offset:3072
    ds_read_b64_tr_b16 v[188:189], v247 offset:2048
    ds_read_b64_tr_b16 v[190:191], v247 offset:3072
    v_fmac_f32 v239, v75, v171
    v_fmac_f32 v237, v68, v172
    s_mov_b32 m0, s68
    v_mfma_f32_32x32x16_bf16 v[0:15], v[84:87], v[176:179], 0
    buffer_load_dwordx4 v222, s[4:7], s44 offen sc1 lds
    buffer_load_dwordx4 v223, s[72:75], s44 offen offset:1024 sc1 lds
    s_waitcnt lgkmcnt(4)
    v_mad_u32_u16 v224, v224, s39, v248 op_sel:[1,0,0,0]
    v_mad_u32_u16 v225, v225, s39, v248 op_sel:[1,0,0,0]
    v_fmac_f32 v239, v76, v172
    v_fmac_f32 v237, v69, v173
    v_mfma_f32_32x32x16_bf16 v[40:55], v[84:87], v[180:183], 0
    v_add_u32 v226, s50, v251
    ds_read2_b32 v[226:227], v226 offset0:1 offset1:3
    v_fmac_f32 v239, v77, v173
    v_fmac_f32 v237, v70, v174
    v_fmac_f32 v239, v78, v174
    v_fmac_f32 v237, v71, v175
    v_fmac_f32 v239, v79, v175
    v_mfma_f32_32x32x16_bf16 v[64:79], v[80:83], v[180:183], 0
    v_permlane32_swap_b32 v234, v240
    v_permlane32_swap_b32 v235, v241
    v_add_f32 v234, v234, v240
    v_add_f32 v235, v235, v241
    s_waitcnt vmcnt(6) lgkmcnt(1)
    v_mfma_f32_32x32x16_bf16 v[24:39], v[88:91], v[184:187], v[24:39]
    ds_read_b64_tr_b16 v[176:177], v246 offset:4096
    ds_read_b64_tr_b16 v[178:179], v246 offset:5120
    ds_read_b64_tr_b16 v[180:181], v247 offset:4096
    ds_read_b64_tr_b16 v[182:183], v247 offset:5120
    s_mov_b32 m0, s69
    v_mfma_f32_32x32x16_bf16 v[0:15], v[92:95], v[184:187], v[0:15]
    buffer_load_dwordx4 v224, s[4:7], s45 offen sc1 lds
    buffer_load_dwordx4 v225, s[72:75], s45 offen offset:1024 sc1 lds
    s_waitcnt lgkmcnt(4)
    v_mad_u32_u16 v226, v226, s39, v248 op_sel:[1,0,0,0]
    v_mad_u32_u16 v227, v227, s39, v248 op_sel:[1,0,0,0]
    s_set_gpr_idx_on s31, gpr_idx(DST)
    s_nop 0
    v_cvt_pk_bf16_f32 v193, v234, v235
    s_set_gpr_idx_off
    v_mfma_f32_32x32x16_bf16 v[40:55], v[92:95], v[188:191], v[40:55]
    v_mul_f32 v240, v24, v144
    v_fmac_f32 v236, v32, v160
    v_fmac_f32 v240, v25, v145
    v_fmac_f32 v236, v33, v161
    v_fmac_f32 v240, v26, v146
    v_fmac_f32 v236, v34, v162
    v_fmac_f32 v240, v27, v147
    v_mfma_f32_32x32x16_bf16 v[64:79], v[88:91], v[188:191], v[64:79]
    s_setprio 0
    v_fmac_f32 v236, v35, v163
    v_fmac_f32 v240, v28, v148
    v_fmac_f32 v236, v36, v164
    v_fmac_f32 v240, v29, v149
    v_fmac_f32 v236, v37, v165
    v_fmac_f32 v240, v30, v150
    v_fmac_f32 v236, v38, v166
    v_fmac_f32 v240, v31, v151
    v_fmac_f32 v236, v39, v167
    v_mul_f32 v234, v0, v112
    v_mul_f32 v235, v40, v120
    v_fmac_f32 v234, v1, v113
    v_fmac_f32 v235, v41, v121
    v_fmac_f32 v234, v2, v114
    v_fmac_f32 v235, v42, v122
    v_fmac_f32 v234, v3, v115
    v_fmac_f32 v235, v43, v123
    v_fmac_f32 v234, v4, v116
    v_fmac_f32 v235, v44, v124
    v_fmac_f32 v234, v5, v117
    v_fmac_f32 v235, v45, v125
    v_fmac_f32 v234, v6, v118
    v_fmac_f32 v235, v46, v126
    v_fmac_f32 v234, v7, v119
    v_fmac_f32 v235, v47, v127
    v_mul_f32 v241, v64, v152
    v_fmac_f32 v237, v72, v168
    s_setprio 1
    s_waitcnt vmcnt(4) lgkmcnt(0)
    v_mfma_f32_32x32x16_bf16 v[24:39], v[80:83], v[176:179], 0
    ds_read_b64_tr_b16 v[184:185], v246 offset:6144
    ds_read_b64_tr_b16 v[186:187], v246 offset:7168
    ds_read_b64_tr_b16 v[188:189], v247 offset:6144
    ds_read_b64_tr_b16 v[190:191], v247 offset:7168
    v_fmac_f32 v241, v65, v153
    v_fmac_f32 v237, v73, v169
    s_mov_b32 m0, s70
    v_mfma_f32_32x32x16_bf16 v[8:23], v[84:87], v[176:179], v[8:23]
    buffer_load_dwordx4 v226, s[4:7], s46 offen sc1 lds
    buffer_load_dwordx4 v227, s[72:75], s46 offen offset:1024 sc1 lds
    v_fmac_f32 v241, v66, v154
    v_fmac_f32 v237, v74, v170
    v_fmac_f32 v241, v67, v155
    v_fmac_f32 v237, v75, v171
    v_fmac_f32 v241, v68, v156
    v_mfma_f32_32x32x16_bf16 v[48:63], v[84:87], v[180:183], v[48:63]
    v_fmac_f32 v237, v76, v172
    v_fmac_f32 v241, v69, v157
    v_fmac_f32 v237, v77, v173
    v_fmac_f32 v241, v70, v158
    v_fmac_f32 v237, v78, v174
    v_fmac_f32 v241, v71, v159
    v_fmac_f32 v237, v79, v175
    v_mfma_f32_32x32x16_bf16 v[64:79], v[80:83], v[180:183], 0
    v_permlane32_swap_b32 v236, v240
    v_permlane32_swap_b32 v237, v241
    v_add_f32 v236, v236, v240
    v_add_f32 v237, v237, v241
    s_waitcnt vmcnt(4) lgkmcnt(0)
    v_mfma_f32_32x32x16_bf16 v[24:39], v[88:91], v[184:187], v[24:39]
    ds_read_b64_tr_b16 v[176:177], v246 offset:0
    ds_read_b64_tr_b16 v[178:179], v246 offset:1024
    ds_read_b64_tr_b16 v[180:181], v247 offset:0
    ds_read_b64_tr_b16 v[182:183], v247 offset:1024
    s_sub_u32 s26, s48, s29
    s_mov_b32 s29, s48
    s_mov_b32 m0, s71
    v_mfma_f32_32x32x16_bf16 v[8:23], v[92:95], v[184:187], v[8:23]
    s_cmp_eq_u32 s33, 4
    s_cbranch_scc1 K2_g4_19
    buffer_load_dwordx4 v224, s[4:7], s47 offen sc1 lds
    buffer_load_dwordx4 v225, s[72:75], s47 offen offset:1024 sc1 lds
K2_back_20:
    s_set_gpr_idx_on s31, gpr_idx(DST)
    s_nop 0
    v_cvt_pk_bf16_f32 v196, v236, v237
    s_set_gpr_idx_off
    s_mov_b32 s30, s3
    s_bfe_u32 s56, s3, 0x40012
    s_cmp_eq_u32 s34, 0
    s_cselect_b32 s56, s56, 0
    v_mfma_f32_32x32x16_bf16 v[48:63], v[92:95], v[188:191], v[48:63]
    s_mov_b32 s32, s31
    s_mov_b32 s31, s35
    v_mul_f32 v236, v24, v144
    v_fma_f32 v238, v32, v160, -v238
    v_fmac_f32 v236, v25, v145
    v_fmac_f32 v238, v33, v161
    v_fmac_f32 v236, v26, v146
    v_mfma_f32_32x32x16_bf16 v[64:79], v[88:91], v[188:191], v[64:79]
    s_setprio 0
    v_fmac_f32 v238, v34, v162
    v_fmac_f32 v236, v27, v147
    v_fmac_f32 v238, v35, v163
    v_fmac_f32 v236, v28, v148
    v_fmac_f32 v238, v36, v164
    v_fmac_f32 v236, v29, v149
    v_fmac_f32 v238, v37, v165
    v_fmac_f32 v236, v30, v150
    v_fmac_f32 v238, v38, v166
    v_fmac_f32 v236, v31, v151
    v_fmac_f32 v238, v39, v167
    v_add_u32 v249, s26, v249
    v_add_u32 v250, s26, v250
    v_mul_f32 v240, v8, v160
    v_fma_f32 v234, v16, v112, -v234
    v_fmac_f32 v240, v9, v161
    v_fmac_f32 v234, v17, v113
    v_fmac_f32 v240, v10, v162
    v_fmac_f32 v234, v18, v114
    v_fmac_f32 v240, v11, v163
    v_fmac_f32 v234, v19, v115
    v_fmac_f32 v240, v12, v164
    v_fmac_f32 v234, v20, v116
    v_fmac_f32 v240, v13, v165
    v_fmac_f32 v234, v21, v117
    v_fmac_f32 v240, v14, v166
    v_fmac_f32 v234, v22, v118
    v_fmac_f32 v240, v15, v167
    v_fmac_f32 v234, v23, v119
    ds_read_b64_tr_b16 v[80:81], v249 offset:0
    ds_read_u16_d16_hi v40, v250 offset:0
    v_mul_f32 v241, v48, v168
    v_fma_f32 v235, v56, v120, -v235
    v_fmac_f32 v241, v49, v169
    v_fmac_f32 v235, v57, v121
    v_fmac_f32 v241, v50, v170
    v_fmac_f32 v235, v58, v122
    v_fmac_f32 v241, v51, v171
    v_fmac_f32 v235, v59, v123
    v_fmac_f32 v241, v52, v172
    v_fmac_f32 v235, v60, v124
    v_fmac_f32 v241, v53, v173
    v_fmac_f32 v235, v61, v125
    v_fmac_f32 v241, v54, v174
    v_fmac_f32 v235, v62, v126
    v_fmac_f32 v241, v55, v175
    v_fmac_f32 v235, v63, v127
    ds_read_b64_tr_b16 v[88:89], v249 offset:512
    ds_read_u16_d16_hi v41, v250 offset:128
    v_mul_f32 v237, v64, v152
    v_fma_f32 v239, v72, v168, -v239
    v_fmac_f32 v237, v65, v153
    v_fmac_f32 v239, v73, v169
    v_fmac_f32 v237, v66, v154
    v_fmac_f32 v239, v74, v170
    v_fmac_f32 v237, v67, v155
    v_fmac_f32 v239, v75, v171
    v_fmac_f32 v237, v68, v156
    v_fmac_f32 v239, v76, v172
    v_fmac_f32 v237, v69, v157
    v_fmac_f32 v239, v77, v173
    v_fmac_f32 v237, v70, v158
    v_fmac_f32 v239, v78, v174
    v_fmac_f32 v237, v71, v159
    v_fmac_f32 v239, v79, v175
    s_cmp_eq_u32 s56, 5
    s_cbranch_scc1 K2_U20
    s_cmp_eq_u32 s56, 6
    s_cbranch_scc1 K2_U3h0
    s_branch K2_DSP0
K2_PAD_U30:
    s_branch K2_HOP
K2_U3h0:
    s_setprio 1
    ds_read_b64_tr_b16 v[228:229], v249 offset:1024
    ds_read_u16_d16_hi v42, v250 offset:256
    s_waitcnt lgkmcnt(2)
    v_lshlrev_b32 v16, 16, v80
    v_and_b32 v17, 0xffff0000, v80
    v_lshlrev_b32 v18, 16, v81
    v_and_b32 v19, 0xffff0000, v81
    v_mov_b32 v82, v81
    v_mul_f32_dpp v32, v40, v16 row_newbcast:4 row_mask:0xf bank_mask:0xf
    v_mul_f32_dpp v33, v40, v17 row_newbcast:5 row_mask:0xf bank_mask:0xf
    v_mul_f32_dpp v34, v40, v18 row_newbcast:6 row_mask:0xf bank_mask:0xf
    v_mul_f32_dpp v35, v40, v19 row_newbcast:7 row_mask:0xf bank_mask:0xf
    v_cvt_pk_bf16_f32 v84, v32, v33
    v_cvt_pk_bf16_f32 v86, v34, v35
    v_mul_f32_dpp v36, v40, v16 row_newbcast:8 row_mask:0xf bank_mask:0xf
    v_mul_f32_dpp v37, v40, v17 row_newbcast:9 row_mask:0xf bank_mask:0xf
    v_mul_f32_dpp v38, v40, v18 row_newbcast:10 row_mask:0xf bank_mask:0xf
    v_mul_f32_dpp v39, v40, v19 row_newbcast:11 row_mask:0xf bank_mask:0xf
    v_cvt_pk_bf16_f32 v85, v36, v37
    v_cvt_pk_bf16_f32 v87, v38, v39
    v_mul_f32_dpp v16, v40, v16 row_newbcast:0 row_mask:0xf bank_mask:0xf
    v_mul_f32_dpp v17, v40, v17 row_newbcast:1 row_mask:0xf bank_mask:0xf
    v_mul_f32_dpp v18, v40, v18 row_newbcast:2 row_mask:0xf bank_mask:0xf
    v_mul_f32_dpp v19, v40, v19 row_newbcast:3 row_mask:0xf bank_mask:0xf
    v_cvt_pk_bf16_f32 v81, v16, v17
    v_cvt_pk_bf16_f32 v83, v18, v19
    v_permlane16_swap_b32 v84, v85
    v_permlane16_swap_b32 v86, v87
    v_permlane16_swap_b32 v80, v81
    v_permlane16_swap_b32 v82, v83
    v_lshlrev_b32 v24, 16, v88
    v_and_b32 v25, 0xffff0000, v88
    v_lshlrev_b32 v26, 16, v89
    v_and_b32 v27, 0xffff0000, v89
    v_mov_b32 v90, v89
    v_mul_f32_dpp v32, v41, v24 row_newbcast:4 row_mask:0xf bank_mask:0xf
    v_mul_f32_dpp v33, v41, v25 row_newbcast:5 row_mask:0xf bank_mask:0xf
    v_mul_f32_dpp v34, v41, v26 row_newbcast:6 row_mask:0xf bank_mask:0xf
    v_mul_f32_dpp v35, v41, v27 row_newbcast:7 row_mask:0xf bank_mask:0xf
    v_cvt_pk_bf16_f32 v92, v32, v33
    v_cvt_pk_bf16_f32 v94, v34, v35
    v_mul_f32_dpp v36, v41, v24 row_newbcast:8 row_mask:0xf bank_mask:0xf
    v_mul_f32_dpp v37, v41, v25 row_newbcast:9 row_mask:0xf bank_mask:0xf
    v_mul_f32_dpp v38, v41, v26 row_newbcast:10 row_mask:0xf bank_mask:0xf
    v_mul_f32_dpp v39, v41, v27 row_newbcast:11 row_mask:0xf bank_mask:0xf
    v_cvt_pk_bf16_f32 v93, v36, v37
    v_cvt_pk_bf16_f32 v95, v38, v39
    v_mul_f32_dpp v24, v41, v24 row_newbcast:0 row_mask:0xf bank_mask:0xf
    v_mul_f32_dpp v25, v41, v25 row_newbcast:1 row_mask:0xf bank_mask:0xf
    v_mul_f32_dpp v26, v41, v26 row_newbcast:2 row_mask:0xf bank_mask:0xf
    v_mul_f32_dpp v27, v41, v27 row_newbcast:3 row_mask:0xf bank_mask:0xf
    v_cvt_pk_bf16_f32 v89, v24, v25
    v_cvt_pk_bf16_f32 v91, v26, v27
    v_permlane16_swap_b32 v92, v93
    v_permlane16_swap_b32 v94, v95
    v_permlane16_swap_b32 v88, v89
    v_permlane16_swap_b32 v90, v91
    s_waitcnt lgkmcnt(0)
    v_lshlrev_b32 v16, 16, v228
    v_and_b32 v17, 0xffff0000, v228
    s_nop 0
    v_mul_f32_dpp v32, v42, v16 row_newbcast:4 row_mask:0xf bank_mask:0xf
    v_mul_f32_dpp v33, v42, v17 row_newbcast:5 row_mask:0xf bank_mask:0xf
    v_cvt_pk_bf16_f32 v242, v32, v33
    v_mul_f32_dpp v36, v42, v16 row_newbcast:8 row_mask:0xf bank_mask:0xf
    v_mul_f32_dpp v37, v42, v17 row_newbcast:9 row_mask:0xf bank_mask:0xf
    v_cvt_pk_bf16_f32 v243, v36, v37
    v_mul_f32_dpp v16, v42, v16 row_newbcast:0 row_mask:0xf bank_mask:0xf
    v_mul_f32_dpp v17, v42, v17 row_newbcast:1 row_mask:0xf bank_mask:0xf
    v_cvt_pk_bf16_f32 v229, v16, v17
    v_permlane16_swap_b32 v242, v243
    s_nop 0
    v_permlane16_swap_b32 v228, v229
    s_waitcnt vmcnt(4)
    v_mfma_f32_32x32x16_bf16 v[8:23], v[80:83], v[176:179], 0
    ds_read_b64_tr_b16 v[184:185], v246 offset:2048
    ds_read_b64_tr_b16 v[186:187], v246 offset:3072
    ds_read_b64_tr_b16 v[188:189], v247 offset:2048
    ds_read_b64_tr_b16 v[190:191], v247 offset:3072
    s_mov_b32 m0, s68
    v_mfma_f32_32x32x16_bf16 v[24:39], v[84:87], v[176:179], 0
    buffer_load_dwordx4 v222, s[4:7], s41 offen sc1 lds
    buffer_load_dwordx4 v223, s[72:75], s41 offen offset:1024 sc1 lds
    v_permlane32_swap_b32 v236, v234
    v_permlane32_swap_b32 v237, v235
    s_add_u32 s38, s38, 1
    v_mfma_f32_32x32x16_bf16 v[48:63], v[80:83], v[180:183], 0
    v_permlane32_swap_b32 v240, v238
    v_permlane32_swap_b32 v241, v239
    v_add_f32 v236, v236, v234
    v_add_f32 v237, v237, v235
    v_add_f32 v240, -v240, -v238
    v_mfma_f32_32x32x16_bf16 v[64:79], v[84:87], v[180:183], 0
    v_add_f32 v241, -v241, -v239
    s_set_gpr_idx_on s32, gpr_idx(DST)
    s_nop 0
    v_cvt_pk_bf16_f32 v194, v236, v237
    v_cvt_pk_bf16_f32 v195, v240, v241
    s_set_gpr_idx_off
    v_mov_b32 v254, s52
    s_waitcnt vmcnt(4) lgkmcnt(0)
    v_mfma_f32_32x32x16_bf16 v[8:23], v[88:91], v[184:187], v[8:23]
    ds_read_b64_tr_b16 v[176:177], v246 offset:4096
    ds_read_b64_tr_b16 v[180:181], v247 offset:4096
    v_mov_b32 v255, s38
    s_lshl_b32 s58, s38, 3
    s_add_u32 s58, s58, s20
    s_mov_b32 m0, s69
    v_mfma_f32_32x32x16_bf16 v[24:39], v[92:95], v[184:187], v[24:39]
    buffer_load_dwordx4 v226, s[4:7], s41 offen sc1 lds
    s_mov_b64 exec, 1
    ds_write_b32 v254, v255
    s_mov_b64 exec, -1
    s_cmp_lt_u32 s58, s22
    s_cbranch_scc0 K2_dyn_25
K2_back_26:
    v_readlane_b32 s3, v253, s58
    s_lshl_b32 s44, s34, 7
    s_and_b32 s48, s3, 0x3ffff
    s_bfe_u32 s33, s3, 0x30013
    s_mul_i32 s35, s38, 6
    s_cmp_eq_u32 s34, 0
    s_cselect_b32 s35, s35, s48
    s_mov_b32 s45, s44
    s_xor_b32 s47, s44, 256
    s_add_u32 s49, s48, 128
    s_add_u32 s60, s48, 256
    s_cmp_eq_u32 s33, 3
    s_cselect_b32 s46, s44, s47
    s_cselect_b32 s50, s60, s48
    s_sub_u32 s60, s33, 2
    s_cmp_lt_u32 s60, 2
    s_cbranch_scc0 K2_rare_31
K2_back_32:
    v_mfma_f32_32x32x16_bf16 v[48:63], v[88:91], v[188:191], v[48:63]
    v_add_u32 v43, s48, v232
    ds_read_b32 v42, v43
    ds_read_b32 v43, v43 offset:1024
    v_mfma_f32_32x32x16_bf16 v[64:79], v[92:95], v[188:191], v[64:79]
    s_waitcnt vmcnt(3) lgkmcnt(3)
    v_mfma_f32_32x32x8_bf16 v[8:23], v[228:229], v[176:177], v[8:23]
    ds_read_b64_tr_b16 v[184:185], v246 offset:6144
    ds_read_b64_tr_b16 v[186:187], v246 offset:7168
    ds_read_b64_tr_b16 v[188:189], v247 offset:6144
    ds_read_b64_tr_b16 v[190:191], v247 offset:7168
    s_mov_b32 m0, s70
    v_mfma_f32_32x32x8_bf16 v[24:39], v[242:243], v[176:177], v[24:39]
    buffer_load_dwordx4 v222, s[4:7], s42 offen sc1 lds
    buffer_load_dwordx4 v223, s[72:75], s42 offen offset:1024 sc1 lds
    v_mfma_f32_32x32x8_bf16 v[48:63], v[228:229], v[180:181], v[48:63]
    s_nop 2
    v_mul_f32 v234, v8, v96
    v_mul_f32 v236, v16, v128
    v_fmac_f32 v234, v9, v97
    v_fmac_f32 v236, v17, v129
    v_fmac_f32 v234, v10, v98
    v_fmac_f32 v236, v18, v130
    v_fmac_f32 v234, v11, v99
    v_mfma_f32_32x32x8_bf16 v[64:79], v[242:243], v[180:181], v[64:79]
    s_setprio 0
    s_waitcnt lgkmcnt(4)
    v_or_b32 v42, v42, v233
    v_or_b32 v43, v43, v233
    s_cmp_lg_u32 s34, 0
    s_cbranch_scc1 K2_dum_36
    s_cmp_eq_u32 s33, 4
    s_cbranch_scc1 K2_a4_37
K2_b4_39:
    s_add_u32 m0, s48, 512
    s_add_u32 s65, s48, 1536
    buffer_load_dwordx4 v42, s[16:19], 0 offen  lds
    s_mov_b32 m0, s65
    s_mov_b32 exec_hi, 0
    buffer_load_dwordx4 v43, s[16:19], 0 offen  lds
    s_mov_b32 exec_hi, -1
K2_back_38:
    v_fmac_f32 v236, v19, v131
    v_fmac_f32 v234, v12, v100
    v_fmac_f32 v236, v20, v132
    v_fmac_f32 v234, v13, v101
    v_fmac_f32 v236, v21, v133
    v_fmac_f32 v234, v14, v102
    v_fmac_f32 v236, v22, v134
    v_fmac_f32 v234, v15, v103
    v_fmac_f32 v236, v23, v135
    v_mul_f32 v238, v24, v128
    v_mul_f32 v240, v32, v128
    v_fmac_f32 v238, v25, v129
    v_fmac_f32 v240, v33, v129
    v_fmac_f32 v238, v26, v130
    v_fmac_f32 v240, v34, v130
    v_fmac_f32 v238, v27, v131
    v_fmac_f32 v240, v35, v131
    v_fmac_f32 v238, v28, v132
    v_fmac_f32 v240, v36, v132
    v_fmac_f32 v238, v29, v133
    v_fmac_f32 v240, v37, v133
    v_fmac_f32 v238, v30, v134
    v_fmac_f32 v240, v38, v134
    v_fmac_f32 v238, v31, v135
    v_fmac_f32 v240, v39, v135
    v_mul_f32 v235, v48, v104
    v_mul_f32 v237, v56, v136
    v_fmac_f32 v235, v49, v105
    v_fmac_f32 v237, v57, v137
    v_fmac_f32 v235, v50, v106
    v_fmac_f32 v237, v58, v138
    v_fmac_f32 v235, v51, v107
    v_fmac_f32 v237, v59, v139
    v_fmac_f32 v235, v52, v108
    v_fmac_f32 v237, v60, v140
    v_fmac_f32 v235, v53, v109
    v_fmac_f32 v237, v61, v141
    v_fmac_f32 v235, v54, v110
    v_fmac_f32 v237, v62, v142
    v_fmac_f32 v235, v55, v111
    v_fmac_f32 v237, v63, v143
    v_mul_f32 v239, v64, v136
    v_mul_f32 v241, v72, v136
    s_setprio 1
    s_waitcnt vmcnt(5) lgkmcnt(0)
    v_mfma_f32_32x32x16_bf16 v[24:39], v[92:95], v[184:187], 0
    ds_read_b64_tr_b16 v[176:177], v246 offset:0
    ds_read_b64_tr_b16 v[178:179], v246 offset:1024
    ds_read_b64_tr_b16 v[180:181], v247 offset:0
    ds_read_b64_tr_b16 v[182:183], v247 offset:1024
    v_fmac_f32 v239, v65, v137
    v_fmac_f32 v241, v73, v137
    s_mov_b32 m0, s71
    v_mfma_f32_32x32x16_bf16 v[8:23], v[88:91], v[184:187], 0
    buffer_load_dwordx4 v224, s[4:7], s42 offen sc1 lds
    buffer_load_dwordx4 v225, s[72:75], s42 offen offset:1024 sc1 lds
    v_fmac_f32 v239, v66, v138
    v_fmac_f32 v241, v74, v138
    v_fmac_f32 v239, v67, v139
    v_fmac_f32 v241, v75, v139
    v_fmac_f32 v239, v68, v140
    v_mfma_f32_32x32x16_bf16 v[48:63], v[88:91], v[188:191], 0
    v_fmac_f32 v241, v76, v140
    v_fmac_f32 v239, v69, v141
    v_fmac_f32 v241, v77, v141
    v_fmac_f32 v239, v70, v142
    v_fmac_f32 v241, v78, v142
    v_fmac_f32 v239, v71, v143
    v_fmac_f32 v241, v79, v143
    v_mfma_f32_32x32x16_bf16 v[64:79], v[92:95], v[188:191], 0
    v_permlane32_swap_b32 v234, v236
    v_permlane32_swap_b32 v235, v237
    v_permlane32_swap_b32 v238, v239
    s_waitcnt vmcnt(6) lgkmcnt(0)
    v_mfma_f32_32x32x16_bf16 v[24:39], v[84:87], v[176:179], v[24:39]
    ds_read_b64_tr_b16 v[184:185], v246 offset:2048
    ds_read_b64_tr_b16 v[188:189], v247 offset:2048
    v_add_f32 v234, v234, v236
    v_add_f32 v235, v235, v237
    v_add_f32 v238, -v238, -v239
    s_mov_b32 m0, s68
    v_mfma_f32_32x32x16_bf16 v[8:23], v[80:83], v[176:179], v[8:23]
    buffer_load_dwordx4 v226, s[4:7], s42 offen sc1 lds
    s_set_gpr_idx_on s31, gpr_idx(DST)
    s_nop 0
    v_cvt_pk_bf16_f32 v192, v234, v235
    v_cvt_pk_bf16_f32 v197, v238, v238
    s_set_gpr_idx_off
    v_mfma_f32_32x32x16_bf16 v[48:63], v[80:83], v[180:183], v[48:63]
    v_mfma_f32_32x32x16_bf16 v[64:79], v[84:87], v[180:183], v[64:79]
    s_waitcnt vmcnt(5) lgkmcnt(0)
    v_mfma_f32_32x32x8_bf16 v[24:39], v[242:243], v[184:185], v[24:39]
    ds_read_b64_tr_b16 v[176:177], v246 offset:4096
    ds_read_b64_tr_b16 v[178:179], v246 offset:5120
    ds_read_b64_tr_b16 v[180:181], v247 offset:4096
    ds_read_b64_tr_b16 v[182:183], v247 offset:5120
    s_mov_b32 m0, s69
    v_mfma_f32_32x32x8_bf16 v[8:23], v[228:229], v[184:185], v[8:23]
    buffer_load_dwordx4 v222, s[4:7], s43 offen sc1 lds
    buffer_load_dwordx4 v223, s[72:75], s43 offen offset:1024 sc1 lds
    v_mfma_f32_32x32x8_bf16 v[48:63], v[228:229], v[188:189], v[48:63]
    s_nop 2
    v_mul_f32 v236, v24, v160
    v_mul_f32 v238, v32, v160
    v_fmac_f32 v236, v25, v161
    v_fmac_f32 v238, v33, v161
    v_fmac_f32 v236, v26, v162
    v_fmac_f32 v238, v34, v162
    v_fmac_f32 v236, v27, v163
    v_mfma_f32_32x32x8_bf16 v[64:79], v[242:243], v[188:189], v[64:79]
    s_setprio 0
    v_fmac_f32 v238, v35, v163
    v_fmac_f32 v236, v28, v164
    v_fmac_f32 v238, v36, v164
    v_fmac_f32 v236, v29, v165
    v_fmac_f32 v238, v37, v165
    v_fmac_f32 v236, v30, v166
    v_fmac_f32 v238, v38, v166
    v_fmac_f32 v236, v31, v167
    v_fmac_f32 v238, v39, v167
    v_mul_f32 v234, v8, v144
    v_mul_f32 v235, v48, v152
    v_fmac_f32 v234, v9, v145
    v_fmac_f32 v235, v49, v153
    v_fmac_f32 v234, v10, v146
    v_fmac_f32 v235, v50, v154
    v_fmac_f32 v234, v11, v147
    v_fmac_f32 v235, v51, v155
    v_fmac_f32 v234, v12, v148
    v_fmac_f32 v235, v52, v156
    v_fmac_f32 v234, v13, v149
    v_fmac_f32 v235, v53, v157
    v_fmac_f32 v234, v14, v150
    v_fmac_f32 v235, v54, v158
    v_fmac_f32 v234, v15, v151
    v_fmac_f32 v235, v55, v159
    v_mul_f32 v237, v64, v168
    v_mul_f32 v239, v72, v168
    v_fmac_f32 v237, v65, v169
    v_fmac_f32 v239, v73, v169
    s_setprio 1
    s_waitcnt vmcnt(3) lgkmcnt(0)
    v_mfma_f32_32x32x16_bf16 v[24:39], v[80:83], v[176:179], 0
    ds_read_b64_tr_b16 v[184:185], v246 offset:6144
    ds_read_b64_tr_b16 v[186:187], v246 offset:7168
    ds_read_b64_tr_b16 v[188:189], v247 offset:6144
    ds_read_b64_tr_b16 v[190:191], v247 offset:7168
    v_fmac_f32 v237, v66, v170
    v_fmac_f32 v239, v74, v170
    s_mov_b32 m0, s70
    v_mfma_f32_32x32x16_bf16 v[0:15], v[84:87], v[176:179], 0
    buffer_load_dwordx4 v224, s[4:7], s43 offen sc1 lds
    buffer_load_dwordx4 v225, s[72:75], s43 offen offset:1024 sc1 lds
    v_fmac_f32 v237, v67, v171
    v_fmac_f32 v239, v75, v171
    v_fmac_f32 v237, v68, v172
    v_fmac_f32 v239, v76, v172
    v_fmac_f32 v237, v69, v173
    v_mfma_f32_32x32x16_bf16 v[40:55], v[84:87], v[180:183], 0
    v_add_u32 v222, s48, v251
    ds_read2_b32 v[222:223], v222 offset0:1 offset1:3
    v_fmac_f32 v239, v77, v173
    v_fmac_f32 v237, v70, v174
    v_fmac_f32 v239, v78, v174
    v_fmac_f32 v237, v71, v175
    v_fmac_f32 v239, v79, v175
    v_mfma_f32_32x32x16_bf16 v[64:79], v[80:83], v[180:183], 0
    v_permlane32_swap_b32 v234, v240
    v_permlane32_swap_b32 v235, v241
    v_add_f32 v234, v234, v240
    v_add_f32 v235, v235, v241
    s_waitcnt vmcnt(4) lgkmcnt(1)
    v_mfma_f32_32x32x16_bf16 v[24:39], v[88:91], v[184:187], v[24:39]
    ds_read_b64_tr_b16 v[176:177], v246 offset:0
    ds_read_b64_tr_b16 v[180:181], v247 offset:0
    s_set_gpr_idx_on s31, gpr_idx(DST)
    s_nop 0
    v_cvt_pk_bf16_f32 v193, v234, v235
    s_set_gpr_idx_off
    s_mov_b32 m0, s71
    v_mfma_f32_32x32x16_bf16 v[0:15], v[92:95], v[184:187], v[0:15]
    buffer_load_dwordx4 v226, s[4:7], s43 offen sc1 lds
    s_waitcnt lgkmcnt(2)
    v_mad_u32_u16 v222, v222, s39, v248 op_sel:[1,0,0,0]
    v_mad_u32_u16 v223, v223, s39, v248 op_sel:[1,0,0,0]
    v_mfma_f32_32x32x16_bf16 v[40:55], v[92:95], v[188:191], v[40:55]
    v_add_u32 v224, s49, v251
    ds_read2_b32 v[224:225], v224 offset0:1 offset1:3
    v_mfma_f32_32x32x16_bf16 v[64:79], v[88:91], v[188:191], v[64:79]
    s_waitcnt vmcnt(3) lgkmcnt(1)
    v_mfma_f32_32x32x8_bf16 v[24:39], v[228:229], v[176:177], v[24:39]
    ds_read_b64_tr_b16 v[184:185], v246 offset:2048
    ds_read_b64_tr_b16 v[186:187], v246 offset:3072
    ds_read_b64_tr_b16 v[188:189], v247 offset:2048
    ds_read_b64_tr_b16 v[190:191], v247 offset:3072
    s_mov_b32 m0, s68
    v_mfma_f32_32x32x8_bf16 v[0:15], v[242:243], v[176:177], v[0:15]
    buffer_load_dwordx4 v222, s[4:7], s44 offen sc1 lds
    buffer_load_dwordx4 v223, s[72:75], s44 offen offset:1024 sc1 lds
    s_waitcnt lgkmcnt(4)
    v_mad_u32_u16 v224, v224, s39, v248 op_sel:[1,0,0,0]
    v_mad_u32_u16 v225, v225, s39, v248 op_sel:[1,0,0,0]
    v_mfma_f32_32x32x8_bf16 v[40:55], v[242:243], v[180:181], v[40:55]
    v_add_u32 v226, s50, v251
    ds_read2_b32 v[226:227], v226 offset0:1 offset1:3
    v_mul_f32 v240, v24, v144
    v_fmac_f32 v236, v32, v160
    v_fmac_f32 v240, v25, v145
    v_fmac_f32 v236, v33, v161
    v_fmac_f32 v240, v26, v146
    v_mfma_f32_32x32x8_bf16 v[64:79], v[228:229], v[180:181], v[64:79]
    s_setprio 0
    v_fmac_f32 v236, v34, v162
    v_fmac_f32 v240, v27, v147
    v_fmac_f32 v236, v35, v163
    v_fmac_f32 v240, v28, v148
    v_fmac_f32 v236, v36, v164
    v_fmac_f32 v240, v29, v149
    v_fmac_f32 v236, v37, v165
    v_fmac_f32 v240, v30, v150
    v_fmac_f32 v236, v38, v166
    v_fmac_f32 v240, v31, v151
    v_fmac_f32 v236, v39, v167
    v_mul_f32 v234, v0, v112
    v_mul_f32 v235, v40, v120
    v_fmac_f32 v234, v1, v113
    v_fmac_f32 v235, v41, v121
    v_fmac_f32 v234, v2, v114
    v_fmac_f32 v235, v42, v122
    v_fmac_f32 v234, v3, v115
    v_fmac_f32 v235, v43, v123
    v_fmac_f32 v234, v4, v116
    v_fmac_f32 v235, v44, v124
    v_fmac_f32 v234, v5, v117
    v_fmac_f32 v235, v45, v125
    v_fmac_f32 v234, v6, v118
    v_fmac_f32 v235, v46, v126
    v_fmac_f32 v234, v7, v119
    v_fmac_f32 v235, v47, v127
    v_mul_f32 v241, v64, v152
    v_fmac_f32 v237, v72, v168
    v_fmac_f32 v241, v65, v153
    v_fmac_f32 v237, v73, v169
    v_fmac_f32 v241, v66, v154
    s_setprio 1
    s_waitcnt vmcnt(3) lgkmcnt(1)
    v_mfma_f32_32x32x16_bf16 v[24:39], v[80:83], v[184:187], 0
    ds_read_b64_tr_b16 v[176:177], v246 offset:4096
    ds_read_b64_tr_b16 v[178:179], v246 offset:5120
    ds_read_b64_tr_b16 v[180:181], v247 offset:4096
    ds_read_b64_tr_b16 v[182:183], v247 offset:5120
    v_fmac_f32 v237, v74, v170
    v_fmac_f32 v241, v67, v155
    s_mov_b32 m0, s69
    v_mfma_f32_32x32x16_bf16 v[8:23], v[84:87], v[184:187], v[8:23]
    buffer_load_dwordx4 v224, s[4:7], s45 offen sc1 lds
    buffer_load_dwordx4 v225, s[72:75], s45 offen offset:1024 sc1 lds
    s_waitcnt lgkmcnt(4)
    v_mad_u32_u16 v226, v226, s39, v248 op_sel:[1,0,0,0]
    v_mad_u32_u16 v227, v227, s39, v248 op_sel:[1,0,0,0]
    v_fmac_f32 v237, v75, v171
    v_fmac_f32 v241, v68, v156
    v_mfma_f32_32x32x16_bf16 v[48:63], v[84:87], v[188:191], v[48:63]
    v_fmac_f32 v237, v76, v172
    v_fmac_f32 v241, v69, v157
    v_fmac_f32 v237, v77, v173
    v_fmac_f32 v241, v70, v158
    v_fmac_f32 v237, v78, v174
    v_fmac_f32 v241, v71, v159
    v_fmac_f32 v237, v79, v175
    v_mfma_f32_32x32x16_bf16 v[64:79], v[80:83], v[188:191], 0
    v_permlane32_swap_b32 v236, v240
    v_permlane32_swap_b32 v237, v241
    v_add_f32 v236, v236, v240
    v_add_f32 v237, v237, v241
    s_waitcnt vmcnt(4) lgkmcnt(0)
    v_mfma_f32_32x32x16_bf16 v[24:39], v[88:91], v[176:179], v[24:39]
    ds_read_b64_tr_b16 v[184:185], v246 offset:6144
    ds_read_b64_tr_b16 v[188:189], v247 offset:6144
    s_set_gpr_idx_on s31, gpr_idx(DST)
    s_nop 0
    v_cvt_pk_bf16_f32 v196, v236, v237
    s_set_gpr_idx_off
    s_mov_b32 s32, s31
    s_mov_b32 m0, s70
    v_mfma_f32_32x32x16_bf16 v[8:23], v[92:95], v[176:179], v[8:23]
    buffer_load_dwordx4 v226, s[4:7], s46 offen sc1 lds
    buffer_load_dwordx4 v227, s[72:75], s46 offen offset:1024 sc1 lds
    s_sub_u32 s26, s48, s29
    s_mov_b32 s29, s48
    s_mov_b32 s30, s3
    s_bfe_u32 s56, s3, 0x40012
    s_mov_b32 s31, s35
    v_mfma_f32_32x32x16_bf16 v[48:63], v[92:95], v[180:183], v[48:63]
    s_cmp_eq_u32 s34, 0
    s_cselect_b32 s56, s56, 0
    v_mfma_f32_32x32x16_bf16 v[64:79], v[88:91], v[180:183], v[64:79]
    s_waitcnt vmcnt(4) lgkmcnt(0)
    v_mfma_f32_32x32x8_bf16 v[24:39], v[228:229], v[184:185], v[24:39]
    ds_read_b64_tr_b16 v[176:177], v246 offset:0
    ds_read_b64_tr_b16 v[178:179], v246 offset:1024
    ds_read_b64_tr_b16 v[180:181], v247 offset:0
    ds_read_b64_tr_b16 v[182:183], v247 offset:1024
    s_mov_b32 m0, s71
    v_mfma_f32_32x32x8_bf16 v[8:23], v[242:243], v[184:185], v[8:23]
    s_cmp_eq_u32 s33, 4
    s_cbranch_scc1 K2_g4_34
    buffer_load_dwordx4 v224, s[4:7], s47 offen sc1 lds
    buffer_load_dwordx4 v225, s[72:75], s47 offen offset:1024 sc1 lds
K2_back_35:
    v_mfma_f32_32x32x8_bf16 v[48:63], v[242:243], v[188:189], v[48:63]
    s_nop 0
    v_mul_f32 v236, v24, v144
    v_fma_f32 v238, v32, v160, -v238
    v_fmac_f32 v236, v25, v145
    v_fmac_f32 v238, v33, v161
    v_fmac_f32 v236, v26, v146
    v_fmac_f32 v238, v34, v162
    v_fmac_f32 v236, v27, v147
    v_mfma_f32_32x32x8_bf16 v[64:79], v[228:229], v[188:189], v[64:79]
    s_setprio 0
    v_fmac_f32 v238, v35, v163
    v_fmac_f32 v236, v28, v148
    v_fmac_f32 v238, v36, v164
    v_fmac_f32 v236, v29, v149
    v_fmac_f32 v238, v37, v165
    v_fmac_f32 v236, v30, v150
    v_fmac_f32 v238, v38, v166
    v_fmac_f32 v236, v31, v151
    v_fmac_f32 v238, v39, v167
    v_add_u32 v249, s26, v249
    v_add_u32 v250, s26, v250
    v_mul_f32 v240, v8, v160
    v_fma_f32 v234, v16, v112, -v234
    v_fmac_f32 v240, v9, v161
    v_fmac_f32 v234, v17, v113
    v_fmac_f32 v240, v10, v162
    v_fmac_f32 v234, v18, v114
    v_fmac_f32 v240, v11, v163
    v_fmac_f32 v234, v19, v115
    v_fmac_f32 v240, v12, v164
    v_fmac_f32 v234, v20, v116
    v_fmac_f32 v240, v13, v165
    v_fmac_f32 v234, v21, v117
    v_fmac_f32 v240, v14, v166
    v_fmac_f32 v234, v22, v118
    v_fmac_f32 v240, v15, v167
    v_fmac_f32 v234, v23, v119
    ds_read_b64_tr_b16 v[80:81], v249 offset:0
    ds_read_u16_d16_hi v40, v250 offset:0
    v_mul_f32 v241, v48, v168
    v_fma_f32 v235, v56, v120, -v235
    v_fmac_f32 v241, v49, v169
    v_fmac_f32 v235, v57, v121
    v_fmac_f32 v241, v50, v170
    v_fmac_f32 v235, v58, v122
    v_fmac_f32 v241, v51, v171
    v_fmac_f32 v235, v59, v123
    v_fmac_f32 v241, v52, v172
    v_fmac_f32 v235, v60, v124
    v_fmac_f32 v241, v53, v173
    v_fmac_f32 v235, v61, v125
    v_fmac_f32 v241, v54, v174
    v_fmac_f32 v235, v62, v126
    v_fmac_f32 v241, v55, v175
    v_fmac_f32 v235, v63, v127
    ds_read_b64_tr_b16 v[88:89], v249 offset:512
    ds_read_u16_d16_hi v41, v250 offset:128
    v_mul_f32 v237, v64, v152
    v_fma_f32 v239, v72, v168, -v239
    v_fmac_f32 v237, v65, v153
    v_fmac_f32 v239, v73, v169
    v_fmac_f32 v237, v66, v154
    v_fmac_f32 v239, v74, v170
    v_fmac_f32 v237, v67, v155
    v_fmac_f32 v239, v75, v171
    v_fmac_f32 v237, v68, v156
    v_fmac_f32 v239, v76, v172
    v_fmac_f32 v237, v69, v157
    v_fmac_f32 v239, v77, v173
    v_fmac_f32 v237, v70, v158
    v_fmac_f32 v239, v78, v174
    v_fmac_f32 v237, v71, v159
    v_fmac_f32 v239, v79, v175
    s_cmp_eq_u32 s56, 5
    s_cbranch_scc1 K2_U20
    s_cmp_eq_u32 s56, 6
    s_cbranch_scc1 K2_U3h0
    s_branch K2_DSP0
K2_U30:
    s_setprio 1
    ds_read_b64_tr_b16 v[228:229], v249 offset:1024
    ds_read_u16_d16_hi v42, v250 offset:256
    s_waitcnt lgkmcnt(2)
    v_lshlrev_b32 v16, 16, v80
    v_and_b32 v17, 0xffff0000, v80
    v_lshlrev_b32 v18, 16, v81
    v_and_b32 v19, 0xffff0000, v81
    v_mov_b32 v82, v81
    v_mul_f32_dpp v32, v40, v16 row_newbcast:4 row_mask:0xf bank_mask:0xf
    v_mul_f32_dpp v33, v40, v17 row_newbcast:5 row_mask:0xf bank_mask:0xf
    v_mul_f32_dpp v34, v40, v18 row_newbcast:6 row_mask:0xf bank_mask:0xf
    v_mul_f32_dpp v35, v40, v19 row_newbcast:7 row_mask:0xf bank_mask:0xf
    v_cvt_pk_bf16_f32 v84, v32, v33
    v_cvt_pk_bf16_f32 v86, v34, v35
    v_mul_f32_dpp v36, v40, v16 row_newbcast:8 row_mask:0xf bank_mask:0xf
    v_mul_f32_dpp v37, v40, v17 row_newbcast:9 row_mask:0xf bank_mask:0xf
    v_mul_f32_dpp v38, v40, v18 row_newbcast:10 row_mask:0xf bank_mask:0xf
    v_mul_f32_dpp v39, v40, v19 row_newbcast:11 row_mask:0xf bank_mask:0xf
    v_cvt_pk_bf16_f32 v85, v36, v37
    v_cvt_pk_bf16_f32 v87, v38, v39
    v_mul_f32_dpp v16, v40, v16 row_newbcast:0 row_mask:0xf bank_mask:0xf
    v_mul_f32_dpp v17, v40, v17 row_newbcast:1 row_mask:0xf bank_mask:0xf
    v_mul_f32_dpp v18, v40, v18 row_newbcast:2 row_mask:0xf bank_mask:0xf
    v_mul_f32_dpp v19, v40, v19 row_newbcast:3 row_mask:0xf bank_mask:0xf
    v_cvt_pk_bf16_f32 v81, v16, v17
    v_cvt_pk_bf16_f32 v83, v18, v19
    v_permlane16_swap_b32 v84, v85
    v_permlane16_swap_b32 v86, v87
    v_permlane16_swap_b32 v80, v81
    v_permlane16_swap_b32 v82, v83
    v_lshlrev_b32 v24, 16, v88
    v_and_b32 v25, 0xffff0000, v88
    v_lshlrev_b32 v26, 16, v89
    v_and_b32 v27, 0xffff0000, v89
    v_mov_b32 v90, v89
    v_mul_f32_dpp v32, v41, v24 row_newbcast:4 row_mask:0xf bank_mask:0xf
    v_mul_f32_dpp v33, v41, v25 row_newbcast:5 row_mask:0xf bank_mask:0xf
    v_mul_f32_dpp v34, v41, v26 row_newbcast:6 row_mask:0xf bank_mask:0xf
    v_mul_f32_dpp v35, v41, v27 row_newbcast:7 row_mask:0xf bank_mask:0xf
    v_cvt_pk_bf16_f32 v92, v32, v33
    v_cvt_pk_bf16_f32 v94, v34, v35
    v_mul_f32_dpp v36, v41, v24 row_newbcast:8 row_mask:0xf bank_mask:0xf
    v_mul_f32_dpp v37, v41, v25 row_newbcast:9 row_mask:0xf bank_mask:0xf
    v_mul_f32_dpp v38, v41, v26 row_newbcast:10 row_mask:0xf bank_mask:0xf
    v_mul_f32_dpp v39, v41, v27 row_newbcast:11 row_mask:0xf bank_mask:0xf
    v_cvt_pk_bf16_f32 v93, v36, v37
    v_cvt_pk_bf16_f32 v95, v38, v39
    v_mul_f32_dpp v24, v41, v24 row_newbcast:0 row_mask:0xf bank_mask:0xf
    v_mul_f32_dpp v25, v41, v25 row_newbcast:1 row_mask:0xf bank_mask:0xf
    v_mul_f32_dpp v26, v41, v26 row_newbcast:2 row_mask:0xf bank_mask:0xf
    v_mul_f32_dpp v27, v41, v27 row_newbcast:3 row_mask:0xf bank_mask:0xf
    v_cvt_pk_bf16_f32 v89, v24, v25
    v_cvt_pk_bf16_f32 v91, v26, v27
    v_permlane16_swap_b32 v92, v93
    v_permlane16_swap_b32 v94, v95
    v_permlane16_swap_b32 v88, v89
    v_permlane16_swap_b32 v90, v91
    s_waitcnt lgkmcnt(0)
    v_lshlrev_b32 v16, 16, v228
    v_and_b32 v17, 0xffff0000, v228
    v_lshlrev_b32 v18, 16, v229
    v_and_b32 v19, 0xffff0000, v229
    v_mov_b32 v230, v229
    v_mul_f32_dpp v32, v42, v16 row_newbcast:4 row_mask:0xf bank_mask:0xf
    v_mul_f32_dpp v33, v42, v17 row_newbcast:5 row_mask:0xf bank_mask:0xf
    v_mul_f32_dpp v34, v42, v18 row_newbcast:6 row_mask:0xf bank_mask:0xf
    v_mul_f32_dpp v35, v42, v19 row_newbcast:7 row_mask:0xf bank_mask:0xf
    v_cvt_pk_bf16_f32 v242, v32, v33
    v_cvt_pk_bf16_f32 v244, v34, v35
    v_mul_f32_dpp v36, v42, v16 row_newbcast:8 row_mask:0xf bank_mask:0xf
    v_mul_f32_dpp v37, v42, v17 row_newbcast:9 row_mask:0xf bank_mask:0xf
    v_mul_f32_dpp v38, v42, v18 row_newbcast:10 row_mask:0xf bank_mask:0xf
    v_mul_f32_dpp v39, v42, v19 row_newbcast:11 row_mask:0xf bank_mask:0xf
    v_cvt_pk_bf16_f32 v243, v36, v37
    v_cvt_pk_bf16_f32 v245, v38, v39
    v_mul_f32_dpp v16, v42, v16 row_newbcast:0 row_mask:0xf bank_mask:0xf
    v_mul_f32_dpp v17, v42, v17 row_newbcast:1 row_mask:0xf bank_mask:0xf
    v_mul_f32_dpp v18, v42, v18 row_newbcast:2 row_mask:0xf bank_mask:0xf
    v_mul_f32_dpp v19, v42, v19 row_newbcast:3 row_mask:0xf bank_mask:0xf
    v_cvt_pk_bf16_f32 v229, v16, v17
    v_cvt_pk_bf16_f32 v231, v18, v19
    v_permlane16_swap_b32 v242, v243
    v_permlane16_swap_b32 v244, v245
    v_permlane16_swap_b32 v228, v229
    v_permlane16_swap_b32 v230, v231
    s_waitcnt vmcnt(4)
    v_mfma_f32_32x32x16_bf16 v[8:23], v[80:83], v[176:179], 0
    ds_read_b64_tr_b16 v[184:185], v246 offset:2048
    ds_read_b64_tr_b16 v[186:187], v246 offset:3072
    ds_read_b64_tr_b16 v[188:189], v247 offset:2048
    ds_read_b64_tr_b16 v[190:191], v247 offset:3072
    s_mov_b32 m0, s68
    v_mfma_f32_32x32x16_bf16 v[24:39], v[84:87], v[176:179], 0
    buffer_load_dwordx4 v222, s[4:7], s41 offen sc1 lds
    buffer_load_dwordx4 v223, s[72:75], s41 offen offset:1024 sc1 lds
    v_permlane32_swap_b32 v236, v234
    v_permlane32_swap_b32 v237, v235
    s_add_u32 s38, s38, 1
    v_mfma_f32_32x32x16_bf16 v[48:63], v[80:83], v[180:183], 0
    v_permlane32_swap_b32 v240, v238
    v_permlane32_swap_b32 v241, v239
    v_add_f32 v236, v236, v234
    v_add_f32 v237, v237, v235
    v_add_f32 v240, -v240, -v238
    v_mfma_f32_32x32x16_bf16 v[64:79], v[84:87], v[180:183], 0
    v_add_f32 v241, -v241, -v239
    s_set_gpr_idx_on s32, gpr_idx(DST)
    s_nop 0
    v_cvt_pk_bf16_f32 v194, v236, v237
    v_cvt_pk_bf16_f32 v195, v240, v241
    s_set_gpr_idx_off
    v_mov_b32 v254, s52
    s_waitcnt vmcnt(4) lgkmcnt(0)
    v_mfma_f32_32x32x16_bf16 v[8:23], v[88:91], v[184:187], v[8:23]
    ds_read_b64_tr_b16 v[176:177], v246 offset:4096
    ds_read_b64_tr_b16 v[178:179], v246 offset:5120
    ds_read_b64_tr_b16 v[180:181], v247 offset:4096
    ds_read_b64_tr_b16 v[182:183], v247 offset:5120
    v_mov_b32 v255, s38
    s_lshl_b32 s58, s38, 3
    s_mov_b32 m0, s69
    v_mfma_f32_32x32x16_bf16 v[24:39], v[92:95], v[184:187], v[24:39]
    buffer_load_dwordx4 v226, s[4:7], s41 offen sc1 lds
    buffer_load_dwordx4 v227, s[72:75], s41 offen offset:1024 sc1 lds
    s_add_u32 s58, s58, s20
    s_mov_b64 exec, 1
    ds_write_b32 v254, v255
    s_mov_b64 exec, -1
    s_cmp_lt_u32 s58, s22
    s_cbranch_scc0 K2_dyn_40
K2_back_41:
    v_readlane_b32 s3, v253, s58
    s_lshl_b32 s44, s34, 7
    s_and_b32 s48, s3, 0x3ffff
    s_bfe_u32 s33, s3, 0x30013
    s_mul_i32 s35, s38, 6
    s_cmp_eq_u32 s34, 0
    s_cselect_b32 s35, s35, s48
    s_mov_b32 s45, s44
    s_xor_b32 s47, s44, 256
    s_add_u32 s49, s48, 128
    s_add_u32 s60, s48, 256
    s_cmp_eq_u32 s33, 3
    s_cselect_b32 s46, s44, s47
    s_cselect_b32 s50, s60, s48
    s_sub_u32 s60, s33, 2
    s_cmp_lt_u32 s60, 2
    s_cbranch_scc0 K2_rare_46
K2_back_47:
    v_mfma_f32_32x32x16_bf16 v[48:63], v[88:91], v[188:191], v[48:63]
    v_add_u32 v43, s48, v232
    ds_read_b32 v42, v43
    ds_read_b32 v43, v43 offset:1024
    v_mfma_f32_32x32x16_bf16 v[64:79], v[92:95], v[188:191], v[64:79]
    s_waitcnt vmcnt(4) lgkmcnt(3)
    v_mfma_f32_32x32x16_bf16 v[8:23], v[228:231], v[176:179], v[8:23]
    ds_read_b64_tr_b16 v[184:185], v246 offset:6144
    ds_read_b64_tr_b16 v[186:187], v246 offset:7168
    ds_read_b64_tr_b16 v[188:189], v247 offset:6144
    ds_read_b64_tr_b16 v[190:191], v247 offset:7168
    s_mov_b32 m0, s70
    v_mfma_f32_32x32x16_bf16 v[24:39], v[242:245], v[176:179], v[24:39]
    buffer_load_dwordx4 v222, s[4:7], s42 offen sc1 lds
    buffer_load_dwordx4 v223, s[72:75], s42 offen offset:1024 sc1 lds
    v_mfma_f32_32x32x16_bf16 v[48:63], v[228:231], v[180:183], v[48:63]
    s_nop 2
    v_mul_f32 v234, v8, v96
    v_mul_f32 v236, v16, v128
    v_fmac_f32 v234, v9, v97
    v_fmac_f32 v236, v17, v129
    v_fmac_f32 v234, v10, v98
    v_fmac_f32 v236, v18, v130
    v_fmac_f32 v234, v11, v99
    v_mfma_f32_32x32x16_bf16 v[64:79], v[242:245], v[180:183], v[64:79]
    s_setprio 0
    s_waitcnt lgkmcnt(4)
    v_or_b32 v42, v42, v233
    v_or_b32 v43, v43, v233
    s_cmp_lg_u32 s34, 0
    s_cbranch_scc1 K2_dum_51
    s_cmp_eq_u32 s33, 4
    s_cbranch_scc1 K2_a4_52
K2_b4_54:
    s_add_u32 m0, s48, 512
    s_add_u32 s65, s48, 1536
    buffer_load_dwordx4 v42, s[16:19], 0 offen  lds
    s_mov_b32 m0, s65
    s_mov_b32 exec_hi, 0
    buffer_load_dwordx4 v43, s[16:19], 0 offen  lds
    s_mov_b32 exec_hi, -1
K2_back_53:
    v_fmac_f32 v236, v19, v131
    v_fmac_f32 v234, v12, v100
    v_fmac_f32 v236, v20, v132
    v_fmac_f32 v234, v13, v101
    v_fmac_f32 v236, v21, v133
    v_fmac_f32 v234, v14, v102
    v_fmac_f32 v236, v22, v134
    v_fmac_f32 v234, v15, v103
    v_fmac_f32 v236, v23, v135
    v_mul_f32 v238, v24, v128
    v_mul_f32 v240, v32, v128
    v_fmac_f32 v238, v25, v129
    v_fmac_f32 v240, v33, v129
    v_fmac_f32 v238, v26, v130
    v_fmac_f32 v240, v34, v130
    v_fmac_f32 v238, v27, v131
    v_fmac_f32 v240, v35, v131
    v_fmac_f32 v238, v28, v132
    v_fmac_f32 v240, v36, v132
    v_fmac_f32 v238, v29, v133
    v_fmac_f32 v240, v37, v133
    v_fmac_f32 v238, v30, v134
    v_fmac_f32 v240, v38, v134
    v_fmac_f32 v238, v31, v135
    v_fmac_f32 v240, v39, v135
    v_mul_f32 v235, v48, v104
    v_mul_f32 v237, v56, v136
    v_fmac_f32 v235, v49, v105
    v_fmac_f32 v237, v57, v137
    v_fmac_f32 v235, v50, v106
    v_fmac_f32 v237, v58, v138
    v_fmac_f32 v235, v51, v107
    v_fmac_f32 v237, v59, v139
    v_fmac_f32 v235, v52, v108
    v_fmac_f32 v237, v60, v140
    v_fmac_f32 v235, v53, v109
    v_fmac_f32 v237, v61, v141
    v_fmac_f32 v235, v54, v110
    v_fmac_f32 v237, v62, v142
    v_fmac_f32 v235, v55, v111
    v_fmac_f32 v237, v63, v143
    v_mul_f32 v239, v64, v136
    v_mul_f32 v241, v72, v136
    s_setprio 1
    s_waitcnt vmcnt(6) lgkmcnt(0)
    v_mfma_f32_32x32x16_bf16 v[24:39], v[92:95], v[184:187], 0
    ds_read_b64_tr_b16 v[176:177], v246 offset:0
    ds_read_b64_tr_b16 v[178:179], v246 offset:1024
    ds_read_b64_tr_b16 v[180:181], v247 offset:0
    ds_read_b64_tr_b16 v[182:183], v247 offset:1024
    v_fmac_f32 v239, v65, v137
    v_fmac_f32 v241, v73, v137
    s_mov_b32 m0, s71
    v_mfma_f32_32x32x16_bf16 v[8:23], v[88:91], v[184:187], 0
    buffer_load_dwordx4 v224, s[4:7], s42 offen sc1 lds
    buffer_load_dwordx4 v225, s[72:75], s42 offen offset:1024 sc1 lds
    v_fmac_f32 v239, v66, v138
    v_fmac_f32 v241, v74, v138
    v_fmac_f32 v239, v67, v139
    v_fmac_f32 v241, v75, v139
    v_fmac_f32 v239, v68, v140
    v_mfma_f32_32x32x16_bf16 v[48:63], v[88:91], v[188:191], 0
    v_fmac_f32 v241, v76, v140
    v_fmac_f32 v239, v69, v141
    v_fmac_f32 v241, v77, v141
    v_fmac_f32 v239, v70, v142
    v_fmac_f32 v241, v78, v142
    v_fmac_f32 v239, v71, v143
    v_fmac_f32 v241, v79, v143
    v_mfma_f32_32x32x16_bf16 v[64:79], v[92:95], v[188:191], 0
    v_permlane32_swap_b32 v234, v236
    v_permlane32_swap_b32 v235, v237
    v_permlane32_swap_b32 v238, v239
    s_waitcnt vmcnt(6) lgkmcnt(0)
    v_mfma_f32_32x32x16_bf16 v[24:39], v[84:87], v[176:179], v[24:39]
    ds_read_b64_tr_b16 v[184:185], v246 offset:2048
    ds_read_b64_tr_b16 v[186:187], v246 offset:3072
    ds_read_b64_tr_b16 v[188:189], v247 offset:2048
    ds_read_b64_tr_b16 v[190:191], v247 offset:3072
    v_add_f32 v234, v234, v236
    v_add_f32 v235, v235, v237
    s_mov_b32 m0, s68
    v_mfma_f32_32x32x16_bf16 v[8:23], v[80:83], v[176:179], v[8:23]
    buffer_load_dwordx4 v226, s[4:7], s42 offen sc1 lds
    buffer_load_dwordx4 v227, s[72:75], s42 offen offset:1024 sc1 lds
    v_add_f32 v238, -v238, -v239
    s_set_gpr_idx_on s31, gpr_idx(DST)
    s_nop 0
    v_cvt_pk_bf16_f32 v192, v234, v235
    v_cvt_pk_bf16_f32 v197, v238, v238
    s_set_gpr_idx_off
    v_mfma_f32_32x32x16_bf16 v[48:63], v[80:83], v[180:183], v[48:63]
    v_mfma_f32_32x32x16_bf16 v[64:79], v[84:87], v[180:183], v[64:79]
    s_waitcnt vmcnt(6) lgkmcnt(0)
    v_mfma_f32_32x32x16_bf16 v[24:39], v[242:245], v[184:187], v[24:39]
    ds_read_b64_tr_b16 v[176:177], v246 offset:4096
    ds_read_b64_tr_b16 v[178:179], v246 offset:5120
    ds_read_b64_tr_b16 v[180:181], v247 offset:4096
    ds_read_b64_tr_b16 v[182:183], v247 offset:5120
    s_mov_b32 m0, s69
    v_mfma_f32_32x32x16_bf16 v[8:23], v[228:231], v[184:187], v[8:23]
    buffer_load_dwordx4 v222, s[4:7], s43 offen sc1 lds
    buffer_load_dwordx4 v223, s[72:75], s43 offen offset:1024 sc1 lds
    v_mfma_f32_32x32x16_bf16 v[48:63], v[228:231], v[188:191], v[48:63]
    s_nop 2
    v_mul_f32 v236, v24, v160
    v_mul_f32 v238, v32, v160
    v_fmac_f32 v236, v25, v161
    v_fmac_f32 v238, v33, v161
    v_fmac_f32 v236, v26, v162
    v_fmac_f32 v238, v34, v162
    v_fmac_f32 v236, v27, v163
    v_mfma_f32_32x32x16_bf16 v[64:79], v[242:245], v[188:191], v[64:79]
    s_setprio 0
    v_fmac_f32 v238, v35, v163
    v_fmac_f32 v236, v28, v164
    v_fmac_f32 v238, v36, v164
    v_fmac_f32 v236, v29, v165
    v_fmac_f32 v238, v37, v165
    v_fmac_f32 v236, v30, v166
    v_fmac_f32 v238, v38, v166
    v_fmac_f32 v236, v31, v167
    v_fmac_f32 v238, v39, v167
    v_mul_f32 v234, v8, v144
    v_mul_f32 v235, v48, v152
    v_fmac_f32 v234, v9, v145
    v_fmac_f32 v235, v49, v153
    v_fmac_f32 v234, v10, v146
    v_fmac_f32 v235, v50, v154
    v_fmac_f32 v234, v11, v147
    v_fmac_f32 v235, v51, v155
    v_fmac_f32 v234, v12, v148
    v_fmac_f32 v235, v52, v156
    v_fmac_f32 v234, v13, v149
    v_fmac_f32 v235, v53, v157
    v_fmac_f32 v234, v14, v150
    v_fmac_f32 v235, v54, v158
    v_fmac_f32 v234, v15, v151
    v_fmac_f32 v235, v55, v159
    v_mul_f32 v237, v64, v168
    v_mul_f32 v239, v72, v168
    v_fmac_f32 v237, v65, v169
    v_fmac_f32 v239, v73, v169
    s_setprio 1
    s_waitcnt vmcnt(4) lgkmcnt(0)
    v_mfma_f32_32x32x16_bf16 v[24:39], v[80:83], v[176:179], 0
    ds_read_b64_tr_b16 v[184:185], v246 offset:6144
    ds_read_b64_tr_b16 v[186:187], v246 offset:7168
    ds_read_b64_tr_b16 v[188:189], v247 offset:6144
    ds_read_b64_tr_b16 v[190:191], v247 offset:7168
    v_fmac_f32 v237, v66, v170
    v_fmac_f32 v239, v74, v170
    s_mov_b32 m0, s70
    v_mfma_f32_32x32x16_bf16 v[0:15], v[84:87], v[176:179], 0
    buffer_load_dwordx4 v224, s[4:7], s43 offen sc1 lds
    buffer_load_dwordx4 v225, s[72:75], s43 offen offset:1024 sc1 lds
    v_fmac_f32 v237, v67, v171
    v_fmac_f32 v239, v75, v171
    v_fmac_f32 v237, v68, v172
    v_fmac_f32 v239, v76, v172
    v_fmac_f32 v237, v69, v173
    v_mfma_f32_32x32x16_bf16 v[40:55], v[84:87], v[180:183], 0
    v_add_u32 v222, s48, v251
    ds_read2_b32 v[222:223], v222 offset0:1 offset1:3
    v_fmac_f32 v239, v77, v173
    v_fmac_f32 v237, v70, v174
    v_fmac_f32 v239, v78, v174
    v_fmac_f32 v237, v71, v175
    v_fmac_f32 v239, v79, v175
    v_mfma_f32_32x32x16_bf16 v[64:79], v[80:83], v[180:183], 0
    v_permlane32_swap_b32 v234, v240
    v_permlane32_swap_b32 v235, v241
    v_add_f32 v234, v234, v240
    v_add_f32 v235, v235, v241
    s_waitcnt vmcnt(4) lgkmcnt(1)
    v_mfma_f32_32x32x16_bf16 v[24:39], v[88:91], v[184:187], v[24:39]
    ds_read_b64_tr_b16 v[176:177], v246 offset:0
    ds_read_b64_tr_b16 v[178:179], v246 offset:1024
    ds_read_b64_tr_b16 v[180:181], v247 offset:0
    ds_read_b64_tr_b16 v[182:183], v247 offset:1024
    s_mov_b32 m0, s71
    v_mfma_f32_32x32x16_bf16 v[0:15], v[92:95], v[184:187], v[0:15]
    buffer_load_dwordx4 v226, s[4:7], s43 offen sc1 lds
    buffer_load_dwordx4 v227, s[72:75], s43 offen offset:1024 sc1 lds
    s_waitcnt lgkmcnt(4)
    v_mad_u32_u16 v222, v222, s39, v248 op_sel:[1,0,0,0]
    v_mad_u32_u16 v223, v223, s39, v248 op_sel:[1,0,0,0]
    v_mfma_f32_32x32x16_bf16 v[40:55], v[92:95], v[188:191], v[40:55]
    v_add_u32 v224, s49, v251
    ds_read2_b32 v[224:225], v224 offset0:1 offset1:3
    s_set_gpr_idx_on s31, gpr_idx(DST)
    s_nop 0
    v_cvt_pk_bf16_f32 v193, v234, v235
    s_set_gpr_idx_off
    v_mfma_f32_32x32x16_bf16 v[64:79], v[88:91], v[188:191], v[64:79]
    s_waitcnt vmcnt(4) lgkmcnt(1)
    v_mfma_f32_32x32x16_bf16 v[24:39], v[228:231], v[176:179], v[24:39]
    ds_read_b64_tr_b16 v[184:185], v246 offset:2048
    ds_read_b64_tr_b16 v[186:187], v246 offset:3072
    ds_read_b64_tr_b16 v[188:189], v247 offset:2048
    ds_read_b64_tr_b16 v[190:191], v247 offset:3072
    s_mov_b32 m0, s68
    v_mfma_f32_32x32x16_bf16 v[0:15], v[242:245], v[176:179], v[0:15]
    buffer_load_dwordx4 v222, s[4:7], s44 offen sc1 lds
    buffer_load_dwordx4 v223, s[72:75], s44 offen offset:1024 sc1 lds
    s_waitcnt lgkmcnt(4)
    v_mad_u32_u16 v224, v224, s39, v248 op_sel:[1,0,0,0]
    v_mad_u32_u16 v225, v225, s39, v248 op_sel:[1,0,0,0]
    v_mfma_f32_32x32x16_bf16 v[40:55], v[242:245], v[180:183], v[40:55]
    v_add_u32 v226, s50, v251
    ds_read2_b32 v[226:227], v226 offset0:1 offset1:3
    v_mul_f32 v240, v24, v144
    v_fmac_f32 v236, v32, v160
    v_fmac_f32 v240, v25, v145
    v_fmac_f32 v236, v33, v161
    v_fmac_f32 v240, v26, v146
    v_mfma_f32_32x32x16_bf16 v[64:79], v[228:231], v[180:183], v[64:79]
    s_setprio 0
    v_fmac_f32 v236, v34, v162
    v_fmac_f32 v240, v27, v147
    v_fmac_f32 v236, v35, v163
    v_fmac_f32 v240, v28, v148
    v_fmac_f32 v236, v36, v164
    v_fmac_f32 v240, v29, v149
    v_fmac_f32 v236, v37, v165
    v_fmac_f32 v240, v30, v150
    v_fmac_f32 v236, v38, v166
    v_fmac_f32 v240, v31, v151
    v_fmac_f32 v236, v39, v167
    v_mul_f32 v234, v0, v112
    v_mul_f32 v235, v40, v120
    v_fmac_f32 v234, v1, v113
    v_fmac_f32 v235, v41, v121
    v_fmac_f32 v234, v2, v114
    v_fmac_f32 v235, v42, v122
    v_fmac_f32 v234, v3, v115
    v_fmac_f32 v235, v43, v123
    v_fmac_f32 v234, v4, v116
    v_fmac_f32 v235, v44, v124
    v_fmac_f32 v234, v5, v117
    v_fmac_f32 v235, v45, v125
    v_fmac_f32 v234, v6, v118
    v_fmac_f32 v235, v46, v126
    v_fmac_f32 v234, v7, v119
    v_fmac_f32 v235, v47, v127
    v_mul_f32 v241, v64, v152
    v_fmac_f32 v237, v72, v168
    v_fmac_f32 v241, v65, v153
    v_fmac_f32 v237, v73, v169
    v_fmac_f32 v241, v66, v154
    s_setprio 1
    s_waitcnt vmcnt(4) lgkmcnt(1)
    v_mfma_f32_32x32x16_bf16 v[24:39], v[80:83], v[184:187], 0
    ds_read_b64_tr_b16 v[176:177], v246 offset:4096
    ds_read_b64_tr_b16 v[178:179], v246 offset:5120
    ds_read_b64_tr_b16 v[180:181], v247 offset:4096
    ds_read_b64_tr_b16 v[182:183], v247 offset:5120
    v_fmac_f32 v237, v74, v170
    v_fmac_f32 v241, v67, v155
    s_mov_b32 m0, s69
    v_mfma_f32_32x32x16_bf16 v[8:23], v[84:87], v[184:187], v[8:23]
    buffer_load_dwordx4 v224, s[4:7], s45 offen sc1 lds
    buffer_load_dwordx4 v225, s[72:75], s45 offen offset:1024 sc1 lds
    s_waitcnt lgkmcnt(4)
    v_mad_u32_u16 v226, v226, s39, v248 op_sel:[1,0,0,0]
    v_mad_u32_u16 v227, v227, s39, v248 op_sel:[1,0,0,0]
    v_fmac_f32 v237, v75, v171
    v_fmac_f32 v241, v68, v156
    v_mfma_f32_32x32x16_bf16 v[48:63], v[84:87], v[188:191], v[48:63]
    v_fmac_f32 v237, v76, v172
    v_fmac_f32 v241, v69, v157
    v_fmac_f32 v237, v77, v173
    v_fmac_f32 v241, v70, v158
    v_fmac_f32 v237, v78, v174
    v_fmac_f32 v241, v71, v159
    v_fmac_f32 v237, v79, v175
    v_mfma_f32_32x32x16_bf16 v[64:79], v[80:83], v[188:191], 0
    v_permlane32_swap_b32 v236, v240
    v_permlane32_swap_b32 v237, v241
    v_add_f32 v236, v236, v240
    v_add_f32 v237, v237, v241
    s_waitcnt vmcnt(4) lgkmcnt(0)
    v_mfma_f32_32x32x16_bf16 v[24:39], v[88:91], v[176:179], v[24:39]
    ds_read_b64_tr_b16 v[184:185], v246 offset:6144
    ds_read_b64_tr_b16 v[186:187], v246 offset:7168
    ds_read_b64_tr_b16 v[188:189], v247 offset:6144
    ds_read_b64_tr_b16 v[190:191], v247 offset:7168
    s_mov_b32 m0, s70
    v_mfma_f32_32x32x16_bf16 v[8:23], v[92:95], v[176:179], v[8:23]
    buffer_load_dwordx4 v226, s[4:7], s46 offen sc1 lds
    buffer_load_dwordx4 v227, s[72:75], s46 offen offset:1024 sc1 lds
    s_set_gpr_idx_on s31, gpr_idx(DST)
    s_nop 0
    v_cvt_pk_bf16_f32 v196, v236, v237
    s_set_gpr_idx_off
    s_sub_u32 s26, s48, s29
    s_mov_b32 s29, s48
    v_mfma_f32_32x32x16_bf16 v[48:63], v[92:95], v[180:183], v[48:63]
    s_mov_b32 s30, s3
    s_bfe_u32 s56, s3, 0x40012
    s_cmp_eq_u32 s34, 0
    s_cselect_b32 s56, s56, 0
    s_mov_b32 s32, s31
    s_mov_b32 s31, s35
    v_mfma_f32_32x32x16_bf16 v[64:79], v[88:91], v[180:183], v[64:79]
    s_waitcnt vmcnt(4) lgkmcnt(0)
    v_mfma_f32_32x32x16_bf16 v[24:39], v[228:231], v[184:187], v[24:39]
    ds_read_b64_tr_b16 v[176:177], v246 offset:0
    ds_read_b64_tr_b16 v[178:179], v246 offset:1024
    ds_read_b64_tr_b16 v[180:181], v247 offset:0
    ds_read_b64_tr_b16 v[182:183], v247 offset:1024
    s_mov_b32 m0, s71
    v_mfma_f32_32x32x16_bf16 v[8:23], v[242:245], v[184:187], v[8:23]
    s_cmp_eq_u32 s33, 4
    s_cbranch_scc1 K2_g4_49
    buffer_load_dwordx4 v224, s[4:7], s47 offen sc1 lds
    buffer_load_dwordx4 v225, s[72:75], s47 offen offset:1024 sc1 lds
K2_back_50:
    v_mfma_f32_32x32x16_bf16 v[48:63], v[242:245], v[188:191], v[48:63]
    s_nop 0
    v_mul_f32 v236, v24, v144
    v_fma_f32 v238, v32, v160, -v238
    v_fmac_f32 v236, v25, v145
    v_fmac_f32 v238, v33, v161
    v_fmac_f32 v236, v26, v146
    v_fmac_f32 v238, v34, v162
    v_fmac_f32 v236, v27, v147
    v_mfma_f32_32x32x16_bf16 v[64:79], v[228:231], v[188:191], v[64:79]
    s_setprio 0
    v_fmac_f32 v238, v35, v163
    v_fmac_f32 v236, v28, v148
    v_fmac_f32 v238, v36, v164
    v_fmac_f32 v236, v29, v149
    v_fmac_f32 v238, v37, v165
    v_fmac_f32 v236, v30, v150
    v_fmac_f32 v238, v38, v166
    v_fmac_f32 v236, v31, v151
    v_fmac_f32 v238, v39, v167
    v_add_u32 v249, s26, v249
    v_add_u32 v250, s26, v250
    v_mul_f32 v240, v8, v160
    v_fma_f32 v234, v16, v112, -v234
    v_fmac_f32 v240, v9, v161
    v_fmac_f32 v234, v17, v113
    v_fmac_f32 v240, v10, v162
    v_fmac_f32 v234, v18, v114
    v_fmac_f32 v240, v11, v163
    v_fmac_f32 v234, v19, v115
    v_fmac_f32 v240, v12, v164
    v_fmac_f32 v234, v20, v116
    v_fmac_f32 v240, v13, v165
    v_fmac_f32 v234, v21, v117
    v_fmac_f32 v240, v14, v166
    v_fmac_f32 v234, v22, v118
    v_fmac_f32 v240, v15, v167
    v_fmac_f32 v234, v23, v119
    ds_read_b64_tr_b16 v[80:81], v249 offset:0
    ds_read_u16_d16_hi v40, v250 offset:0
    v_mul_f32 v241, v48, v168
    v_fma_f32 v235, v56, v120, -v235
    v_fmac_f32 v241, v49, v169
    v_fmac_f32 v235, v57, v121
    v_fmac_f32 v241, v50, v170
    v_fmac_f32 v235, v58, v122
    v_fmac_f32 v241, v51, v171
    v_fmac_f32 v235, v59, v123
    v_fmac_f32 v241, v52, v172
    v_fmac_f32 v235, v60, v124
    v_fmac_f32 v241, v53, v173
    v_fmac_f32 v235, v61, v125
    v_fmac_f32 v241, v54, v174
    v_fmac_f32 v235, v62, v126
    v_fmac_f32 v241, v55, v175
    v_fmac_f32 v235, v63, v127
    ds_read_b64_tr_b16 v[88:89], v249 offset:512
    ds_read_u16_d16_hi v41, v250 offset:128
    v_mul_f32 v237, v64, v152
    v_fma_f32 v239, v72, v168, -v239
    v_fmac_f32 v237, v65, v153
    v_fmac_f32 v239, v73, v169
    v_fmac_f32 v237, v66, v154
    v_fmac_f32 v239, v74, v170
    v_fmac_f32 v237, v67, v155
    v_fmac_f32 v239, v75, v171
    v_fmac_f32 v237, v68, v156
    v_fmac_f32 v239, v76, v172
    v_fmac_f32 v237, v69, v157
    v_fmac_f32 v239, v77, v173
    v_fmac_f32 v237, v70, v158
    v_fmac_f32 v239, v78, v174
    v_fmac_f32 v237, v71, v159
    v_fmac_f32 v239, v79, v175
    s_cmp_eq_u32 s56, 5
    s_cbranch_scc1 K2_U20
    s_cmp_eq_u32 s56, 6
    s_cbranch_scc1 K2_U3h0
    s_branch K2_DSP0
K2_PAD_U21:
    s_branch K2_HOP
K2_U21:
    s_setprio 1
    s_waitcnt lgkmcnt(0)
    v_lshlrev_b32 v16, 16, v80
    v_and_b32 v17, 0xffff0000, v80
    v_lshlrev_b32 v18, 16, v81
    v_and_b32 v19, 0xffff0000, v81
    v_mov_b32 v82, v81
    v_mul_f32_dpp v32, v40, v16 row_newbcast:4 row_mask:0xf bank_mask:0xf
    v_mul_f32_dpp v33, v40, v17 row_newbcast:5 row_mask:0xf bank_mask:0xf
    v_mul_f32_dpp v34, v40, v18 row_newbcast:6 row_mask:0xf bank_mask:0xf
    v_mul_f32_dpp v35, v40, v19 row_newbcast:7 row_mask:0xf bank_mask:0xf
    v_cvt_pk_bf16_f32 v84, v32, v33
    v_cvt_pk_bf16_f32 v86, v34, v35
    v_mul_f32_dpp v36, v40, v16 row_newbcast:8 row_mask:0xf bank_mask:0xf
    v_mul_f32_dpp v37, v40, v17 row_newbcast:9 row_mask:0xf bank_mask:0xf
    v_mul_f32_dpp v38, v40, v18 row_newbcast:10 row_mask:0xf bank_mask:0xf
    v_mul_f32_dpp v39, v40, v19 row_newbcast:11 row_mask:0xf bank_mask:0xf
    v_cvt_pk_bf16_f32 v85, v36, v37
    v_cvt_pk_bf16_f32 v87, v38, v39
    v_mul_f32_dpp v16, v40, v16 row_newbcast:0 row_mask:0xf bank_mask:0xf
    v_mul_f32_dpp v17, v40, v17 row_newbcast:1 row_mask:0xf bank_mask:0xf
    v_mul_f32_dpp v18, v40, v18 row_newbcast:2 row_mask:0xf bank_mask:0xf
    v_mul_f32_dpp v19, v40, v19 row_newbcast:3 row_mask:0xf bank_mask:0xf
    v_cvt_pk_bf16_f32 v81, v16, v17
    v_cvt_pk_bf16_f32 v83, v18, v19
    v_permlane16_swap_b32 v84, v85
    v_permlane16_swap_b32 v86, v87
    v_permlane16_swap_b32 v80, v81
    v_permlane16_swap_b32 v82, v83
    v_lshlrev_b32 v24, 16, v88
    v_and_b32 v25, 0xffff0000, v88
    v_lshlrev_b32 v26, 16, v89
    v_and_b32 v27, 0xffff0000, v89
    v_mov_b32 v90, v89
    v_mul_f32_dpp v32, v41, v24 row_newbcast:4 row_mask:0xf bank_mask:0xf
    v_mul_f32_dpp v33, v41, v25 row_newbcast:5 row_mask:0xf bank_mask:0xf
    v_mul_f32_dpp v34, v41, v26 row_newbcast:6 row_mask:0xf bank_mask:0xf
    v_mul_f32_dpp v35, v41, v27 row_newbcast:7 row_mask:0xf bank_mask:0xf
    v_cvt_pk_bf16_f32 v92, v32, v33
    v_cvt_pk_bf16_f32 v94, v34, v35
    v_mul_f32_dpp v36, v41, v24 row_newbcast:8 row_mask:0xf bank_mask:0xf
    v_mul_f32_dpp v37, v41, v25 row_newbcast:9 row_mask:0xf bank_mask:0xf
    v_mul_f32_dpp v38, v41, v26 row_newbcast:10 row_mask:0xf bank_mask:0xf
    v_mul_f32_dpp v39, v41, v27 row_newbcast:11 row_mask:0xf bank_mask:0xf
    v_cvt_pk_bf16_f32 v93, v36, v37
    v_cvt_pk_bf16_f32 v95, v38, v39
    v_mul_f32_dpp v24, v41, v24 row_newbcast:0 row_mask:0xf bank_mask:0xf
    v_mul_f32_dpp v25, v41, v25 row_newbcast:1 row_mask:0xf bank_mask:0xf
    v_mul_f32_dpp v26, v41, v26 row_newbcast:2 row_mask:0xf bank_mask:0xf
    v_mul_f32_dpp v27, v41, v27 row_newbcast:3 row_mask:0xf bank_mask:0xf
    v_cvt_pk_bf16_f32 v89, v24, v25
    v_cvt_pk_bf16_f32 v91, v26, v27
    v_permlane16_swap_b32 v92, v93
    v_permlane16_swap_b32 v94, v95
    v_permlane16_swap_b32 v88, v89
    v_permlane16_swap_b32 v90, v91
    s_waitcnt vmcnt(4)
    v_mfma_f32_32x32x16_bf16 v[8:23], v[80:83], v[176:179], 0
    ds_read_b64_tr_b16 v[184:185], v246 offset:2048
    ds_read_b64_tr_b16 v[186:187], v246 offset:3072
    ds_read_b64_tr_b16 v[188:189], v247 offset:2048
    ds_read_b64_tr_b16 v[190:191], v247 offset:3072
    s_mov_b32 m0, s68
    v_mfma_f32_32x32x16_bf16 v[24:39], v[84:87], v[176:179], 0
    buffer_load_dwordx4 v222, s[4:7], s42 offen sc1 lds
    buffer_load_dwordx4 v223, s[72:75], s42 offen offset:1024 sc1 lds
    v_permlane32_swap_b32 v236, v234
    v_permlane32_swap_b32 v237, v235
    v_mfma_f32_32x32x16_bf16 v[48:63], v[80:83], v[180:183], 0
    v_permlane32_swap_b32 v240, v238
    v_permlane32_swap_b32 v241, v239
    v_add_f32 v236, v236, v234
    v_add_f32 v237, v237, v235
    v_add_f32 v240, -v240, -v238
    v_mfma_f32_32x32x16_bf16 v[64:79], v[84:87], v[180:183], 0
    v_add_f32 v241, -v241, -v239
    v_cvt_pk_bf16_f32 v236, v236, v237
    v_cvt_pk_bf16_f32 v240, v240, v241
    ds_write2st64_b32 v232, v236, v240 offset0:2 offset1:3
    s_mov_b64 exec, 0x1ff
    ds_add_rtn_u32 v42, v254, v251
    s_mov_b64 exec, -1
    s_waitcnt vmcnt(4) lgkmcnt(2)
    v_mfma_f32_32x32x16_bf16 v[8:23], v[88:91], v[184:187], v[8:23]
    ds_read_b64_tr_b16 v[176:177], v246 offset:4096
    ds_read_b64_tr_b16 v[178:179], v246 offset:5120
    ds_read_b64_tr_b16 v[180:181], v247 offset:4096
    ds_read_b64_tr_b16 v[182:183], v247 offset:5120
    s_mov_b32 m0, s69
    v_mfma_f32_32x32x16_bf16 v[24:39], v[92:95], v[184:187], v[24:39]
    buffer_load_dwordx4 v224, s[4:7], s42 offen sc1 lds
    buffer_load_dwordx4 v225, s[72:75], s42 offen offset:1024 sc1 lds
    s_waitcnt lgkmcnt(4)
    v_readlane_b32 s58, v42, 8
    v_mfma_f32_32x32x16_bf16 v[48:63], v[88:91], v[188:191], v[48:63]
    s_lshr_b32 s58, s58, 4
    s_cmp_lt_u32 s58, s22
    s_cbranch_scc0 K2_nul_55
    v_readlane_b32 s3, v253, s58
    s_nop 0
    s_bfe_u32 s58, s3, 0x60016
    s_and_b32 s59, s58, 7
    s_lshr_b32 s60, s58, 3
K2_chk_57:
    v_readlane_b32 s61, v42, s59
    s_nop 0
    s_cmp_gt_u32 s61, s60
    s_cbranch_scc0 K2_spin_56
K2_back_58:
    v_mfma_f32_32x32x16_bf16 v[64:79], v[92:95], v[188:191], v[64:79]
    s_setprio 0
    s_lshl_b32 s44, s34, 7
    s_and_b32 s48, s3, 0x3ffff
    s_bfe_u32 s33, s3, 0x30013
    s_mov_b32 s35, s48
    s_mov_b32 s45, s44
    s_xor_b32 s47, s44, 256
    v_mul_f32 v234, v8, v96
    v_mul_f32 v236, v16, v128
    v_fmac_f32 v234, v9, v97
    v_fmac_f32 v236, v17, v129
    v_fmac_f32 v234, v10, v98
    v_fmac_f32 v236, v18, v130
    v_fmac_f32 v234, v11, v99
    v_fmac_f32 v236, v19, v131
    v_fmac_f32 v234, v12, v100
    v_fmac_f32 v236, v20, v132
    v_fmac_f32 v234, v13, v101
    v_fmac_f32 v236, v21, v133
    v_fmac_f32 v234, v14, v102
    v_fmac_f32 v236, v22, v134
    v_fmac_f32 v234, v15, v103
    v_fmac_f32 v236, v23, v135
    v_mul_f32 v238, v24, v128
    v_mul_f32 v240, v32, v128
    v_fmac_f32 v238, v25, v129
    v_fmac_f32 v240, v33, v129
    v_fmac_f32 v238, v26, v130
    v_fmac_f32 v240, v34, v130
    v_fmac_f32 v238, v27, v131
    v_fmac_f32 v240, v35, v131
    v_fmac_f32 v238, v28, v132
    v_fmac_f32 v240, v36, v132
    v_fmac_f32 v238, v29, v133
    v_fmac_f32 v240, v37, v133
    v_fmac_f32 v238, v30, v134
    v_fmac_f32 v240, v38, v134
    v_fmac_f32 v238, v31, v135
    v_fmac_f32 v240, v39, v135
    v_mul_f32 v235, v48, v104
    v_mul_f32 v237, v56, v136
    v_fmac_f32 v235, v49, v105
    v_fmac_f32 v237, v57, v137
    v_fmac_f32 v235, v50, v106
    v_fmac_f32 v237, v58, v138
    v_fmac_f32 v235, v51, v107
    v_fmac_f32 v237, v59, v139
    v_fmac_f32 v235, v52, v108
    v_fmac_f32 v237, v60, v140
    v_fmac_f32 v235, v53, v109
    v_fmac_f32 v237, v61, v141
    v_fmac_f32 v235, v54, v110
    v_fmac_f32 v237, v62, v142
    v_fmac_f32 v235, v55, v111
    v_fmac_f32 v237, v63, v143
    v_mul_f32 v239, v64, v136
    v_mul_f32 v241, v72, v136
    v_fmac_f32 v239, v65, v137
    v_fmac_f32 v241, v73, v137
    s_setprio 1
    s_waitcnt vmcnt(4) lgkmcnt(0)
    v_mfma_f32_32x32x16_bf16 v[24:39], v[84:87], v[176:179], 0
    ds_read_b64_tr_b16 v[184:185], v246 offset:6144
    ds_read_b64_tr_b16 v[186:187], v246 offset:7168
    ds_read_b64_tr_b16 v[188:189], v247 offset:6144
    ds_read_b64_tr_b16 v[190:191], v247 offset:7168
    v_fmac_f32 v239, v66, v138
    v_fmac_f32 v241, v74, v138
    s_mov_b32 m0, s70
    v_mfma_f32_32x32x16_bf16 v[8:23], v[80:83], v[176:179], 0
    buffer_load_dwordx4 v222, s[4:7], s43 offen sc1 lds
    buffer_load_dwordx4 v223, s[72:75], s43 offen offset:1024 sc1 lds
    v_fmac_f32 v239, v67, v139
    v_fmac_f32 v241, v75, v139
    v_fmac_f32 v239, v68, v140
    v_fmac_f32 v241, v76, v140
    v_fmac_f32 v239, v69, v141
    v_mfma_f32_32x32x16_bf16 v[48:63], v[80:83], v[180:183], 0
    s_add_u32 s49, s48, 128
    s_add_u32 s60, s48, 256
    s_cmp_eq_u32 s33, 3
    s_cselect_b32 s46, s44, s47
    s_cselect_b32 s50, s60, s48
    s_sub_u32 s60, s33, 2
    s_cmp_lt_u32 s60, 2
    s_cbranch_scc0 K2_rare_59
K2_back_60:
    v_add_u32 v222, s48, v251
    ds_read2_b32 v[222:223], v222 offset0:1 offset1:3
    v_fmac_f32 v241, v77, v141
    v_fmac_f32 v239, v70, v142
    v_fmac_f32 v241, v78, v142
    v_fmac_f32 v239, v71, v143
    v_fmac_f32 v241, v79, v143
    v_mfma_f32_32x32x16_bf16 v[64:79], v[84:87], v[180:183], 0
    v_permlane32_swap_b32 v234, v236
    v_permlane32_swap_b32 v235, v237
    v_permlane32_swap_b32 v238, v239
    s_waitcnt vmcnt(4) lgkmcnt(1)
    v_mfma_f32_32x32x16_bf16 v[24:39], v[92:95], v[184:187], v[24:39]
    ds_read_b64_tr_b16 v[176:177], v246 offset:0
    ds_read_b64_tr_b16 v[178:179], v246 offset:1024
    ds_read_b64_tr_b16 v[180:181], v247 offset:0
    ds_read_b64_tr_b16 v[182:183], v247 offset:1024
    v_lshl_add_u32 v232, v252, 1, s31
    v_add_f32 v234, v234, v236
    s_mov_b32 m0, s71
    v_mfma_f32_32x32x16_bf16 v[8:23], v[88:91], v[184:187], v[8:23]
    buffer_load_dwordx4 v224, s[4:7], s43 offen sc1 lds
    buffer_load_dwordx4 v225, s[72:75], s43 offen offset:1024 sc1 lds
    s_waitcnt lgkmcnt(4)
    v_mad_u32_u16 v222, v222, s39, v248 op_sel:[1,0,0,0]
    v_mad_u32_u16 v223, v223, s39, v248 op_sel:[1,0,0,0]
    v_add_f32 v235, v235, v237
    v_add_f32 v238, -v238, -v239
    v_sub_u32 v239, v232, v233
    v_cvt_pk_bf16_f32 v234, v234, v235
    v_cvt_pk_bf16_f32 v238, v238, v238
    ds_write_b32 v232, v234 offset:0
    ds_write_b16 v239, v238 offset:1280
    v_mfma_f32_32x32x16_bf16 v[48:63], v[88:91], v[188:191], v[48:63]
    v_add_u32 v224, s49, v251
    ds_read2_b32 v[224:225], v224 offset0:1 offset1:3
    v_mul_f32 v236, v24, v160
    v_mul_f32 v238, v32, v160
    v_fmac_f32 v236, v25, v161
    v_fmac_f32 v238, v33, v161
    v_fmac_f32 v236, v26, v162
    v_mfma_f32_32x32x16_bf16 v[64:79], v[92:95], v[188:191], v[64:79]
    s_setprio 0
    v_fmac_f32 v238, v34, v162
    v_fmac_f32 v236, v27, v163
    v_fmac_f32 v238, v35, v163
    v_fmac_f32 v236, v28, v164
    v_fmac_f32 v238, v36, v164
    v_fmac_f32 v236, v29, v165
    v_fmac_f32 v238, v37, v165
    v_fmac_f32 v236, v30, v166
    v_fmac_f32 v238, v38, v166
    v_fmac_f32 v236, v31, v167
    v_fmac_f32 v238, v39, v167
    v_mul_f32 v234, v8, v144
    v_mul_f32 v235, v48, v152
    v_fmac_f32 v234, v9, v145
    v_fmac_f32 v235, v49, v153
    v_fmac_f32 v234, v10, v146
    v_fmac_f32 v235, v50, v154
    v_fmac_f32 v234, v11, v147
    v_fmac_f32 v235, v51, v155
    v_fmac_f32 v234, v12, v148
    v_fmac_f32 v235, v52, v156
    v_fmac_f32 v234, v13, v149
    v_fmac_f32 v235, v53, v157
    v_fmac_f32 v234, v14, v150
    v_fmac_f32 v235, v54, v158
    v_fmac_f32 v234, v15, v151
    v_fmac_f32 v235, v55, v159
    v_mul_f32 v237, v64, v168
    v_mul_f32 v239, v72, v168
    v_fmac_f32 v237, v65, v169
    v_fmac_f32 v239, v73, v169
    v_fmac_f32 v237, v66, v170
    v_fmac_f32 v239, v74, v170
    v_fmac_f32 v237, v67, v171
    s_setprio 1
    s_waitcnt vmcnt(4) lgkmcnt(3)
    v_mfma_f32_32x32x16_bf16 v[24:39], v[80:83], v[176:179], 0
    ds_read_b64_tr_b16 v[184:185], v246 offset:2048
    ds_read_b64_tr_b16 v[186:187], v246 offset:3072
    ds_read_b64_tr_b16 v[188:189], v247 offset:2048
    ds_read_b64_tr_b16 v[190:191], v247 offset:3072
    v_fmac_f32 v239, v75, v171
    v_fmac_f32 v237, v68, v172
    s_mov_b32 m0, s68
    v_mfma_f32_32x32x16_bf16 v[0:15], v[84:87], v[176:179], 0
    buffer_load_dwordx4 v222, s[4:7], s44 offen sc1 lds
    buffer_load_dwordx4 v223, s[72:75], s44 offen offset:1024 sc1 lds
    s_waitcnt lgkmcnt(4)
    v_mad_u32_u16 v224, v224, s39, v248 op_sel:[1,0,0,0]
    v_mad_u32_u16 v225, v225, s39, v248 op_sel:[1,0,0,0]
    v_fmac_f32 v239, v76, v172
    v_fmac_f32 v237, v69, v173
    v_mfma_f32_32x32x16_bf16 v[40:55], v[84:87], v[180:183], 0
    v_add_u32 v226, s50, v251
    ds_read2_b32 v[226:227], v226 offset0:1 offset1:3
    v_fmac_f32 v239, v77, v173
    v_fmac_f32 v237, v70, v174
    v_fmac_f32 v239, v78, v174
    v_fmac_f32 v237, v71, v175
    v_fmac_f32 v239, v79, v175
    v_mfma_f32_32x32x16_bf16 v[64:79], v[80:83], v[180:183], 0
    v_permlane32_swap_b32 v234, v240
    v_permlane32_swap_b32 v235, v241
    v_add_f32 v234, v234, v240
    v_add_f32 v235, v235, v241
    s_waitcnt vmcnt(4) lgkmcnt(1)
    v_mfma_f32_32x32x16_bf16 v[24:39], v[88:91], v[184:187], v[24:39]
    ds_read_b64_tr_b16 v[176:177], v246 offset:4096
    ds_read_b64_tr_b16 v[178:179], v246 offset:5120
    ds_read_b64_tr_b16 v[180:181], v247 offset:4096
    ds_read_b64_tr_b16 v[182:183], v247 offset:5120
    v_cvt_pk_bf16_f32 v234, v234, v235
    ds_write_b32 v232, v234 offset:256
    s_mov_b32 m0, s69
    v_mfma_f32_32x32x16_bf16 v[0:15], v[92:95], v[184:187], v[0:15]
    buffer_load_dwordx4 v224, s[4:7], s45 offen sc1 lds
    buffer_load_dwordx4 v225, s[72:75], s45 offen offset:1024 sc1 lds
    s_waitcnt lgkmcnt(5)
    v_mad_u32_u16 v226, v226, s39, v248 op_sel:[1,0,0,0]
    v_mad_u32_u16 v227, v227, s39, v248 op_sel:[1,0,0,0]
    v_mfma_f32_32x32x16_bf16 v[40:55], v[92:95], v[188:191], v[40:55]
    v_mul_f32 v240, v24, v144
    v_fmac_f32 v236, v32, v160
    v_fmac_f32 v240, v25, v145
    v_fmac_f32 v236, v33, v161
    v_fmac_f32 v240, v26, v146
    v_fmac_f32 v236, v34, v162
    v_fmac_f32 v240, v27, v147
    v_mfma_f32_32x32x16_bf16 v[64:79], v[88:91], v[188:191], v[64:79]
    s_setprio 0
    v_fmac_f32 v236, v35, v163
    v_fmac_f32 v240, v28, v148
    v_fmac_f32 v236, v36, v164
    v_fmac_f32 v240, v29, v149
    v_fmac_f32 v236, v37, v165
    v_fmac_f32 v240, v30, v150
    v_fmac_f32 v236, v38, v166
    v_fmac_f32 v240, v31, v151
    v_fmac_f32 v236, v39, v167
    v_mul_f32 v234, v0, v112
    v_mul_f32 v235, v40, v120
    v_fmac_f32 v234, v1, v113
    v_fmac_f32 v235, v41, v121
    v_fmac_f32 v234, v2, v114
    v_fmac_f32 v235, v42, v122
    v_fmac_f32 v234, v3, v115
    v_fmac_f32 v235, v43, v123
    v_fmac_f32 v234, v4, v116
    v_fmac_f32 v235, v44, v124
    v_fmac_f32 v234, v5, v117
    v_fmac_f32 v235, v45, v125
    v_fmac_f32 v234, v6, v118
    v_fmac_f32 v235, v46, v126
    v_fmac_f32 v234, v7, v119
    v_fmac_f32 v235, v47, v127
    v_mul_f32 v241, v64, v152
    v_fmac_f32 v237, v72, v168
    s_setprio 1
    s_waitcnt vmcnt(4) lgkmcnt(1)
    v_mfma_f32_32x32x16_bf16 v[24:39], v[80:83], v[176:179], 0
    ds_read_b64_tr_b16 v[184:185], v246 offset:6144
    ds_read_b64_tr_b16 v[186:187], v246 offset:7168
    ds_read_b64_tr_b16 v[188:189], v247 offset:6144
    ds_read_b64_tr_b16 v[190:191], v247 offset:7168
    v_fmac_f32 v241, v65, v153
    v_fmac_f32 v237, v73, v169
    s_mov_b32 m0, s70
    v_mfma_f32_32x32x16_bf16 v[8:23], v[84:87], v[176:179], v[8:23]
    buffer_load_dwordx4 v226, s[4:7], s46 offen sc1 lds
    buffer_load_dwordx4 v227, s[72:75], s46 offen offset:1024 sc1 lds
    v_fmac_f32 v241, v66, v154
    v_fmac_f32 v237, v74, v170
    v_fmac_f32 v241, v67, v155
    v_fmac_f32 v237, v75, v171
    v_fmac_f32 v241, v68, v156
    v_mfma_f32_32x32x16_bf16 v[48:63], v[84:87], v[180:183], v[48:63]
    v_fmac_f32 v237, v76, v172
    v_fmac_f32 v241, v69, v157
    v_fmac_f32 v237, v77, v173
    v_fmac_f32 v241, v70, v158
    v_fmac_f32 v237, v78, v174
    v_fmac_f32 v241, v71, v159
    v_fmac_f32 v237, v79, v175
    v_mfma_f32_32x32x16_bf16 v[64:79], v[80:83], v[180:183], 0
    v_permlane32_swap_b32 v236, v240
    v_permlane32_swap_b32 v237, v241
    v_add_f32 v236, v236, v240
    v_add_f32 v237, v237, v241
    s_waitcnt vmcnt(4) lgkmcnt(0)
    v_mfma_f32_32x32x16_bf16 v[24:39], v[88:91], v[184:187], v[24:39]
    ds_read_b64_tr_b16 v[176:177], v246 offset:0
    ds_read_b64_tr_b16 v[178:179], v246 offset:1024
    ds_read_b64_tr_b16 v[180:181], v247 offset:0
    ds_read_b64_tr_b16 v[182:183], v247 offset:1024
    v_cvt_pk_bf16_f32 v236, v236, v237
    ds_write_b32 v232, v236 offset:1024
    s_mov_b32 m0, s71
    v_mfma_f32_32x32x16_bf16 v[8:23], v[92:95], v[184:187], v[8:23]
    s_cmp_eq_u32 s33, 4
    s_cbranch_scc1 K2_g4_62
    buffer_load_dwordx4 v224, s[4:7], s47 offen sc1 lds
    buffer_load_dwordx4 v225, s[72:75], s47 offen offset:1024 sc1 lds
K2_back_63:
    s_sub_u32 s26, s48, s29
    s_mov_b32 s29, s48
    s_mov_b32 s30, s3
    s_bfe_u32 s56, s3, 0x40012
    s_cmp_lg_u32 s36, 0
    s_cselect_b32 s56, s56, 0
    v_mfma_f32_32x32x16_bf16 v[48:63], v[92:95], v[188:191], v[48:63]
    s_mov_b32 s32, s31
    s_mov_b32 s31, s35
    v_mul_f32 v236, v24, v144
    v_fma_f32 v238, v32, v160, -v238
    v_fmac_f32 v236, v25, v145
    v_fmac_f32 v238, v33, v161
    v_fmac_f32 v236, v26, v146
    v_mfma_f32_32x32x16_bf16 v[64:79], v[88:91], v[188:191], v[64:79]
    s_setprio 0
    v_fmac_f32 v238, v34, v162
    v_fmac_f32 v236, v27, v147
    v_fmac_f32 v238, v35, v163
    v_fmac_f32 v236, v28, v148
    v_fmac_f32 v238, v36, v164
    v_fmac_f32 v236, v29, v149
    v_fmac_f32 v238, v37, v165
    v_fmac_f32 v236, v30, v150
    v_fmac_f32 v238, v38, v166
    v_fmac_f32 v236, v31, v151
    v_fmac_f32 v238, v39, v167
    v_add_u32 v249, s26, v249
    v_add_u32 v250, s26, v250
    v_mul_f32 v240, v8, v160
    v_fma_f32 v234, v16, v112, -v234
    v_fmac_f32 v240, v9, v161
    v_fmac_f32 v234, v17, v113
    v_fmac_f32 v240, v10, v162
    v_fmac_f32 v234, v18, v114
    v_fmac_f32 v240, v11, v163
    v_fmac_f32 v234, v19, v115
    v_fmac_f32 v240, v12, v164
    v_fmac_f32 v234, v20, v116
    v_fmac_f32 v240, v13, v165
    v_fmac_f32 v234, v21, v117
    v_fmac_f32 v240, v14, v166
    v_fmac_f32 v234, v22, v118
    v_fmac_f32 v240, v15, v167
    v_fmac_f32 v234, v23, v119
    ds_read_b64_tr_b16 v[80:81], v249 offset:0
    ds_read_u16_d16_hi v40, v250 offset:0
    v_mul_f32 v241, v48, v168
    v_fma_f32 v235, v56, v120, -v235
    v_fmac_f32 v241, v49, v169
    v_fmac_f32 v235, v57, v121
    v_fmac_f32 v241, v50, v170
    v_fmac_f32 v235, v58, v122
    v_fmac_f32 v241, v51, v171
    v_fmac_f32 v235, v59, v123
    v_fmac_f32 v241, v52, v172
    v_fmac_f32 v235, v60, v124
    v_fmac_f32 v241, v53, v173
    v_fmac_f32 v235, v61, v125
    v_fmac_f32 v241, v54, v174
    v_fmac_f32 v235, v62, v126
    v_fmac_f32 v241, v55, v175
    v_fmac_f32 v235, v63, v127
    ds_read_b64_tr_b16 v[88:89], v249 offset:512
    ds_read_u16_d16_hi v41, v250 offset:128
    v_mul_f32 v237, v64, v152
    v_fma_f32 v239, v72, v168, -v239
    v_fmac_f32 v237, v65, v153
    v_fmac_f32 v239, v73, v169
    v_fmac_f32 v237, v66, v154
    v_fmac_f32 v239, v74, v170
    v_fmac_f32 v237, v67, v155
    v_fmac_f32 v239, v75, v171
    v_fmac_f32 v237, v68, v156
    v_fmac_f32 v239, v76, v172
    v_fmac_f32 v237, v69, v157
    v_fmac_f32 v239, v77, v173
    v_fmac_f32 v237, v70, v158
    v_fmac_f32 v239, v78, v174
    v_fmac_f32 v237, v71, v159
    v_fmac_f32 v239, v79, v175
    s_cmp_eq_u32 s56, 5
    s_cbranch_scc1 K2_U21
    s_cmp_eq_u32 s56, 6
    s_cbranch_scc1 K2_U3h1
    s_branch K2_DSP1
K2_PAD_U31:
    s_branch K2_HOP
K2_U3h1:
    s_setprio 1
    ds_read_b64_tr_b16 v[228:229], v249 offset:1024
    ds_read_u16_d16_hi v42, v250 offset:256
    s_waitcnt lgkmcnt(2)
    v_lshlrev_b32 v16, 16, v80
    v_and_b32 v17, 0xffff0000, v80
    v_lshlrev_b32 v18, 16, v81
    v_and_b32 v19, 0xffff0000, v81
    v_mov_b32 v82, v81
    v_mul_f32_dpp v32, v40, v16 row_newbcast:4 row_mask:0xf bank_mask:0xf
    v_mul_f32_dpp v33, v40, v17 row_newbcast:5 row_mask:0xf bank_mask:0xf
    v_mul_f32_dpp v34, v40, v18 row_newbcast:6 row_mask:0xf bank_mask:0xf
    v_mul_f32_dpp v35, v40, v19 row_newbcast:7 row_mask:0xf bank_mask:0xf
    v_cvt_pk_bf16_f32 v84, v32, v33
    v_cvt_pk_bf16_f32 v86, v34, v35
    v_mul_f32_dpp v36, v40, v16 row_newbcast:8 row_mask:0xf bank_mask:0xf
    v_mul_f32_dpp v37, v40, v17 row_newbcast:9 row_mask:0xf bank_mask:0xf
    v_mul_f32_dpp v38, v40, v18 row_newbcast:10 row_mask:0xf bank_mask:0xf
    v_mul_f32_dpp v39, v40, v19 row_newbcast:11 row_mask:0xf bank_mask:0xf
    v_cvt_pk_bf16_f32 v85, v36, v37
    v_cvt_pk_bf16_f32 v87, v38, v39
    v_mul_f32_dpp v16, v40, v16 row_newbcast:0 row_mask:0xf bank_mask:0xf
    v_mul_f32_dpp v17, v40, v17 row_newbcast:1 row_mask:0xf bank_mask:0xf
    v_mul_f32_dpp v18, v40, v18 row_newbcast:2 row_mask:0xf bank_mask:0xf
    v_mul_f32_dpp v19, v40, v19 row_newbcast:3 row_mask:0xf bank_mask:0xf
    v_cvt_pk_bf16_f32 v81, v16, v17
    v_cvt_pk_bf16_f32 v83, v18, v19
    v_permlane16_swap_b32 v84, v85
    v_permlane16_swap_b32 v86, v87
    v_permlane16_swap_b32 v80, v81
    v_permlane16_swap_b32 v82, v83
    v_lshlrev_b32 v24, 16, v88
    v_and_b32 v25, 0xffff0000, v88
    v_lshlrev_b32 v26, 16, v89
    v_and_b32 v27, 0xffff0000, v89
    v_mov_b32 v90, v89
    v_mul_f32_dpp v32, v41, v24 row_newbcast:4 row_mask:0xf bank_mask:0xf
    v_mul_f32_dpp v33, v41, v25 row_newbcast:5 row_mask:0xf bank_mask:0xf
    v_mul_f32_dpp v34, v41, v26 row_newbcast:6 row_mask:0xf bank_mask:0xf
    v_mul_f32_dpp v35, v41, v27 row_newbcast:7 row_mask:0xf bank_mask:0xf
    v_cvt_pk_bf16_f32 v92, v32, v33
    v_cvt_pk_bf16_f32 v94, v34, v35
    v_mul_f32_dpp v36, v41, v24 row_newbcast:8 row_mask:0xf bank_mask:0xf
    v_mul_f32_dpp v37, v41, v25 row_newbcast:9 row_mask:0xf bank_mask:0xf
    v_mul_f32_dpp v38, v41, v26 row_newbcast:10 row_mask:0xf bank_mask:0xf
    v_mul_f32_dpp v39, v41, v27 row_newbcast:11 row_mask:0xf bank_mask:0xf
    v_cvt_pk_bf16_f32 v93, v36, v37
    v_cvt_pk_bf16_f32 v95, v38, v39
    v_mul_f32_dpp v24, v41, v24 row_newbcast:0 row_mask:0xf bank_mask:0xf
    v_mul_f32_dpp v25, v41, v25 row_newbcast:1 row_mask:0xf bank_mask:0xf
    v_mul_f32_dpp v26, v41, v26 row_newbcast:2 row_mask:0xf bank_mask:0xf
    v_mul_f32_dpp v27, v41, v27 row_newbcast:3 row_mask:0xf bank_mask:0xf
    v_cvt_pk_bf16_f32 v89, v24, v25
    v_cvt_pk_bf16_f32 v91, v26, v27
    v_permlane16_swap_b32 v92, v93
    v_permlane16_swap_b32 v94, v95
    v_permlane16_swap_b32 v88, v89
    v_permlane16_swap_b32 v90, v91
    s_waitcnt lgkmcnt(0)
    v_lshlrev_b32 v16, 16, v228
    v_and_b32 v17, 0xffff0000, v228
    s_nop 0
    v_mul_f32_dpp v32, v42, v16 row_newbcast:4 row_mask:0xf bank_mask:0xf
    v_mul_f32_dpp v33, v42, v17 row_newbcast:5 row_mask:0xf bank_mask:0xf
    v_cvt_pk_bf16_f32 v242, v32, v33
    v_mul_f32_dpp v36, v42, v16 row_newbcast:8 row_mask:0xf bank_mask:0xf
    v_mul_f32_dpp v37, v42, v17 row_newbcast:9 row_mask:0xf bank_mask:0xf
    v_cvt_pk_bf16_f32 v243, v36, v37
    v_mul_f32_dpp v16, v42, v16 row_newbcast:0 row_mask:0xf bank_mask:0xf
    v_mul_f32_dpp v17, v42, v17 row_newbcast:1 row_mask:0xf bank_mask:0xf
    v_cvt_pk_bf16_f32 v229, v16, v17
    v_permlane16_swap_b32 v242, v243
    s_nop 0
    v_permlane16_swap_b32 v228, v229
    s_waitcnt vmcnt(4)
    v_mfma_f32_32x32x16_bf16 v[8:23], v[80:83], v[176:179], 0
    ds_read_b64_tr_b16 v[184:185], v246 offset:2048
    ds_read_b64_tr_b16 v[186:187], v246 offset:3072
    ds_read_b64_tr_b16 v[188:189], v247 offset:2048
    ds_read_b64_tr_b16 v[190:191], v247 offset:3072
    s_mov_b32 m0, s68
    v_mfma_f32_32x32x16_bf16 v[24:39], v[84:87], v[176:179], 0
    buffer_load_dwordx4 v222, s[4:7], s41 offen sc1 lds
    buffer_load_dwordx4 v223, s[72:75], s41 offen offset:1024 sc1 lds
    v_permlane32_swap_b32 v236, v234
    v_permlane32_swap_b32 v237, v235
    v_mfma_f32_32x32x16_bf16 v[48:63], v[80:83], v[180:183], 0
    v_permlane32_swap_b32 v240, v238
    v_permlane32_swap_b32 v241, v239
    v_add_f32 v236, v236, v234
    v_add_f32 v237, v237, v235
    v_add_f32 v240, -v240, -v238
    v_mfma_f32_32x32x16_bf16 v[64:79], v[84:87], v[180:183], 0
    v_add_f32 v241, -v241, -v239
    v_cvt_pk_bf16_f32 v236, v236, v237
    v_cvt_pk_bf16_f32 v240, v240, v241
    ds_write2st64_b32 v232, v236, v240 offset0:2 offset1:3
    s_mov_b64 exec, 0x1ff
    ds_add_rtn_u32 v42, v254, v251
    s_mov_b64 exec, -1
    s_waitcnt vmcnt(4) lgkmcnt(2)
    v_mfma_f32_32x32x16_bf16 v[8:23], v[88:91], v[184:187], v[8:23]
    ds_read_b64_tr_b16 v[176:177], v246 offset:4096
    ds_read_b64_tr_b16 v[180:181], v247 offset:4096
    s_mov_b32 m0, s69
    v_mfma_f32_32x32x16_bf16 v[24:39], v[92:95], v[184:187], v[24:39]
    buffer_load_dwordx4 v226, s[4:7], s41 offen sc1 lds
    s_waitcnt lgkmcnt(2)
    v_readlane_b32 s58, v42, 8
    v_mfma_f32_32x32x16_bf16 v[48:63], v[88:91], v[188:191], v[48:63]
    s_lshr_b32 s58, s58, 4
    s_cmp_lt_u32 s58, s22
    s_cbranch_scc0 K2_nul_64
    v_readlane_b32 s3, v253, s58
    s_nop 0
    s_bfe_u32 s58, s3, 0x60016
    s_and_b32 s59, s58, 7
    s_lshr_b32 s60, s58, 3
K2_chk_66:
    v_readlane_b32 s61, v42, s59
    s_nop 0
    s_cmp_gt_u32 s61, s60
    s_cbranch_scc0 K2_spin_65
K2_back_67:
    v_mfma_f32_32x32x16_bf16 v[64:79], v[92:95], v[188:191], v[64:79]
    s_lshl_b32 s44, s34, 7
    s_and_b32 s48, s3, 0x3ffff
    s_bfe_u32 s33, s3, 0x30013
    s_mov_b32 s35, s48
    s_mov_b32 s45, s44
    s_xor_b32 s47, s44, 256
    s_waitcnt vmcnt(3) lgkmcnt(0)
    v_mfma_f32_32x32x8_bf16 v[8:23], v[228:229], v[176:177], v[8:23]
    ds_read_b64_tr_b16 v[184:185], v246 offset:6144
    ds_read_b64_tr_b16 v[186:187], v246 offset:7168
    ds_read_b64_tr_b16 v[188:189], v247 offset:6144
    ds_read_b64_tr_b16 v[190:191], v247 offset:7168
    s_add_u32 s49, s48, 128
    s_add_u32 s60, s48, 256
    s_mov_b32 m0, s70
    v_mfma_f32_32x32x8_bf16 v[24:39], v[242:243], v[176:177], v[24:39]
    buffer_load_dwordx4 v222, s[4:7], s42 offen sc1 lds
    buffer_load_dwordx4 v223, s[72:75], s42 offen offset:1024 sc1 lds
    s_cmp_eq_u32 s33, 3
    s_cselect_b32 s46, s44, s47
    s_cselect_b32 s50, s60, s48
    v_mfma_f32_32x32x8_bf16 v[48:63], v[228:229], v[180:181], v[48:63]
    s_sub_u32 s60, s33, 2
    s_cmp_lt_u32 s60, 2
    s_cbranch_scc0 K2_rare_68
K2_back_69:
    v_mul_f32 v234, v8, v96
    v_mul_f32 v236, v16, v128
    v_fmac_f32 v234, v9, v97
    v_fmac_f32 v236, v17, v129
    v_mfma_f32_32x32x8_bf16 v[64:79], v[242:243], v[180:181], v[64:79]
    s_setprio 0
    v_fmac_f32 v234, v10, v98
    v_fmac_f32 v236, v18, v130
    v_fmac_f32 v234, v11, v99
    v_fmac_f32 v236, v19, v131
    v_fmac_f32 v234, v12, v100
    v_fmac_f32 v236, v20, v132
    v_fmac_f32 v234, v13, v101
    v_fmac_f32 v236, v21, v133
    v_fmac_f32 v234, v14, v102
    v_fmac_f32 v236, v22, v134
    v_fmac_f32 v234, v15, v103
    v_fmac_f32 v236, v23, v135
    v_mul_f32 v238, v24, v128
    v_mul_f32 v240, v32, v128
    v_fmac_f32 v238, v25, v129
    v_fmac_f32 v240, v33, v129
    v_fmac_f32 v238, v26, v130
    v_fmac_f32 v240, v34, v130
    v_fmac_f32 v238, v27, v131
    v_fmac_f32 v240, v35, v131
    v_fmac_f32 v238, v28, v132
    v_fmac_f32 v240, v36, v132
    v_fmac_f32 v238, v29, v133
    v_fmac_f32 v240, v37, v133
    v_fmac_f32 v238, v30, v134
    v_fmac_f32 v240, v38, v134
    v_fmac_f32 v238, v31, v135
    v_fmac_f32 v240, v39, v135
    v_mul_f32 v235, v48, v104
    v_mul_f32 v237, v56, v136
    v_fmac_f32 v235, v49, v105
    v_fmac_f32 v237, v57, v137
    v_fmac_f32 v235, v50, v106
    v_fmac_f32 v237, v58, v138
    v_fmac_f32 v235, v51, v107
    v_fmac_f32 v237, v59, v139
    v_fmac_f32 v235, v52, v108
    v_fmac_f32 v237, v60, v140
    v_fmac_f32 v235, v53, v109
    v_fmac_f32 v237, v61, v141
    v_fmac_f32 v235, v54, v110
    v_fmac_f32 v237, v62, v142
    v_fmac_f32 v235, v55, v111
    v_fmac_f32 v237, v63, v143
    v_mul_f32 v239, v64, v136
    v_mul_f32 v241, v72, v136
    s_setprio 1
    s_waitcnt vmcnt(3) lgkmcnt(0)
    v_mfma_f32_32x32x16_bf16 v[24:39], v[92:95], v[184:187], 0
    ds_read_b64_tr_b16 v[176:177], v246 offset:0
    ds_read_b64_tr_b16 v[178:179], v246 offset:1024
    ds_read_b64_tr_b16 v[180:181], v247 offset:0
    ds_read_b64_tr_b16 v[182:183], v247 offset:1024
    v_fmac_f32 v239, v65, v137
    v_fmac_f32 v241, v73, v137
    s_mov_b32 m0, s71
    v_mfma_f32_32x32x16_bf16 v[8:23], v[88:91], v[184:187], 0
    buffer_load_dwordx4 v224, s[4:7], s42 offen sc1 lds
    buffer_load_dwordx4 v225, s[72:75], s42 offen offset:1024 sc1 lds
    v_fmac_f32 v239, v66, v138
    v_fmac_f32 v241, v74, v138
    v_fmac_f32 v239, v67, v139
    v_fmac_f32 v241, v75, v139
    v_fmac_f32 v239, v68, v140
    v_mfma_f32_32x32x16_bf16 v[48:63], v[88:91], v[188:191], 0
    v_fmac_f32 v241, v76, v140
    v_fmac_f32 v239, v69, v141
    v_fmac_f32 v241, v77, v141
    v_fmac_f32 v239, v70, v142
    v_fmac_f32 v241, v78, v142
    v_fmac_f32 v239, v71, v143
    v_fmac_f32 v241, v79, v143
    v_mfma_f32_32x32x16_bf16 v[64:79], v[92:95], v[188:191], 0
    v_permlane32_swap_b32 v234, v236
    v_permlane32_swap_b32 v235, v237
    v_permlane32_swap_b32 v238, v239
    s_waitcnt vmcnt(4) lgkmcnt(0)
    v_mfma_f32_32x32x16_bf16 v[24:39], v[84:87], v[176:179], v[24:39]
    ds_read_b64_tr_b16 v[184:185], v246 offset:2048
    ds_read_b64_tr_b16 v[188:189], v247 offset:2048
    v_lshl_add_u32 v232, v252, 1, s31
    v_add_f32 v234, v234, v236
    v_add_f32 v235, v235, v237
    v_add_f32 v238, -v238, -v239
    s_mov_b32 m0, s68
    v_mfma_f32_32x32x16_bf16 v[8:23], v[80:83], v[176:179], v[8:23]
    buffer_load_dwordx4 v226, s[4:7], s42 offen sc1 lds
    v_sub_u32 v239, v232, v233
    v_cvt_pk_bf16_f32 v234, v234, v235
    v_cvt_pk_bf16_f32 v238, v238, v238
    ds_write_b32 v232, v234 offset:0
    ds_write_b16 v239, v238 offset:1280
    v_mfma_f32_32x32x16_bf16 v[48:63], v[80:83], v[180:183], v[48:63]
    v_mfma_f32_32x32x16_bf16 v[64:79], v[84:87], v[180:183], v[64:79]
    s_waitcnt vmcnt(3) lgkmcnt(2)
    v_mfma_f32_32x32x8_bf16 v[24:39], v[242:243], v[184:185], v[24:39]
    ds_read_b64_tr_b16 v[176:177], v246 offset:4096
    ds_read_b64_tr_b16 v[178:179], v246 offset:5120
    ds_read_b64_tr_b16 v[180:181], v247 offset:4096
    ds_read_b64_tr_b16 v[182:183], v247 offset:5120
    s_mov_b32 m0, s69
    v_mfma_f32_32x32x8_bf16 v[8:23], v[228:229], v[184:185], v[8:23]
    buffer_load_dwordx4 v222, s[4:7], s43 offen sc1 lds
    buffer_load_dwordx4 v223, s[72:75], s43 offen offset:1024 sc1 lds
    v_mfma_f32_32x32x8_bf16 v[48:63], v[228:229], v[188:189], v[48:63]
    s_nop 2
    v_mul_f32 v236, v24, v160
    v_mul_f32 v238, v32, v160
    v_fmac_f32 v236, v25, v161
    v_fmac_f32 v238, v33, v161
    v_fmac_f32 v236, v26, v162
    v_fmac_f32 v238, v34, v162
    v_fmac_f32 v236, v27, v163
    v_mfma_f32_32x32x8_bf16 v[64:79], v[242:243], v[188:189], v[64:79]
    s_setprio 0
    v_fmac_f32 v238, v35, v163
    v_fmac_f32 v236, v28, v164
    v_fmac_f32 v238, v36, v164
    v_fmac_f32 v236, v29, v165
    v_fmac_f32 v238, v37, v165
    v_fmac_f32 v236, v30, v166
    v_fmac_f32 v238, v38, v166
    v_fmac_f32 v236, v31, v167
    v_fmac_f32 v238, v39, v167
    v_mul_f32 v234, v8, v144
    v_mul_f32 v235, v48, v152
    v_fmac_f32 v234, v9, v145
    v_fmac_f32 v235, v49, v153
    v_fmac_f32 v234, v10, v146
    v_fmac_f32 v235, v50, v154
    v_fmac_f32 v234, v11, v147
    v_fmac_f32 v235, v51, v155
    v_fmac_f32 v234, v12, v148
    v_fmac_f32 v235, v52, v156
    v_fmac_f32 v234, v13, v149
    v_fmac_f32 v235, v53, v157
    v_fmac_f32 v234, v14, v150
    v_fmac_f32 v235, v54, v158
    v_fmac_f32 v234, v15, v151
    v_fmac_f32 v235, v55, v159
    v_mul_f32 v237, v64, v168
    v_mul_f32 v239, v72, v168
    v_fmac_f32 v237, v65, v169
    v_fmac_f32 v239, v73, v169
    s_setprio 1
    s_waitcnt vmcnt(3) lgkmcnt(0)
    v_mfma_f32_32x32x16_bf16 v[24:39], v[80:83], v[176:179], 0
    ds_read_b64_tr_b16 v[184:185], v246 offset:6144
    ds_read_b64_tr_b16 v[186:187], v246 offset:7168
    ds_read_b64_tr_b16 v[188:189], v247 offset:6144
    ds_read_b64_tr_b16 v[190:191], v247 offset:7168
    v_fmac_f32 v237, v66, v170
    v_fmac_f32 v239, v74, v170
    s_mov_b32 m0, s70
    v_mfma_f32_32x32x16_bf16 v[0:15], v[84:87], v[176:179], 0
    buffer_load_dwordx4 v224, s[4:7], s43 offen sc1 lds
    buffer_load_dwordx4 v225, s[72:75], s43 offen offset:1024 sc1 lds
    v_fmac_f32 v237, v67, v171
    v_fmac_f32 v239, v75, v171
    v_fmac_f32 v237, v68, v172
    v_fmac_f32 v239, v76, v172
    v_fmac_f32 v237, v69, v173
    v_mfma_f32_32x32x16_bf16 v[40:55], v[84:87], v[180:183], 0
    v_add_u32 v222, s48, v251
    ds_read2_b32 v[222:223], v222 offset0:1 offset1:3
    v_fmac_f32 v239, v77, v173
    v_fmac_f32 v237, v70, v174
    v_fmac_f32 v239, v78, v174
    v_fmac_f32 v237, v71, v175
    v_fmac_f32 v239, v79, v175
    v_mfma_f32_32x32x16_bf16 v[64:79], v[80:83], v[180:183], 0
    v_permlane32_swap_b32 v234, v240
    v_permlane32_swap_b32 v235, v241
    v_add_f32 v234, v234, v240
    v_add_f32 v235, v235, v241
    s_waitcnt vmcnt(4) lgkmcnt(1)
    v_mfma_f32_32x32x16_bf16 v[24:39], v[88:91], v[184:187], v[24:39]
    ds_read_b64_tr_b16 v[176:177], v246 offset:0
    ds_read_b64_tr_b16 v[180:181], v247 offset:0
    v_cvt_pk_bf16_f32 v234, v234, v235
    ds_write_b32 v232, v234 offset:256
    s_mov_b32 m0, s71
    v_mfma_f32_32x32x16_bf16 v[0:15], v[92:95], v[184:187], v[0:15]
    buffer_load_dwordx4 v226, s[4:7], s43 offen sc1 lds
    s_waitcnt lgkmcnt(3)
    v_mad_u32_u16 v222, v222, s39, v248 op_sel:[1,0,0,0]
    v_mad_u32_u16 v223, v223, s39, v248 op_sel:[1,0,0,0]
    v_mfma_f32_32x32x16_bf16 v[40:55], v[92:95], v[188:191], v[40:55]
    v_add_u32 v224, s49, v251
    ds_read2_b32 v[224:225], v224 offset0:1 offset1:3
    v_mfma_f32_32x32x16_bf16 v[64:79], v[88:91], v[188:191], v[64:79]
    s_waitcnt vmcnt(3) lgkmcnt(2)
    v_mfma_f32_32x32x8_bf16 v[24:39], v[228:229], v[176:177], v[24:39]
    ds_read_b64_tr_b16 v[184:185], v246 offset:2048
    ds_read_b64_tr_b16 v[186:187], v246 offset:3072
    ds_read_b64_tr_b16 v[188:189], v247 offset:2048
    ds_read_b64_tr_b16 v[190:191], v247 offset:3072
    s_mov_b32 m0, s68
    v_mfma_f32_32x32x8_bf16 v[0:15], v[242:243], v[176:177], v[0:15]
    buffer_load_dwordx4 v222, s[4:7], s44 offen sc1 lds
    buffer_load_dwordx4 v223, s[72:75], s44 offen offset:1024 sc1 lds
    s_waitcnt lgkmcnt(4)
    v_mad_u32_u16 v224, v224, s39, v248 op_sel:[1,0,0,0]
    v_mad_u32_u16 v225, v225, s39, v248 op_sel:[1,0,0,0]
    v_mfma_f32_32x32x8_bf16 v[40:55], v[242:243], v[180:181], v[40:55]
    v_add_u32 v226, s50, v251
    ds_read2_b32 v[226:227], v226 offset0:1 offset1:3
    v_mul_f32 v240, v24, v144
    v_fmac_f32 v236, v32, v160
    v_fmac_f32 v240, v25, v145
    v_fmac_f32 v236, v33, v161
    v_fmac_f32 v240, v26, v146
    v_mfma_f32_32x32x8_bf16 v[64:79], v[228:229], v[180:181], v[64:79]
    s_setprio 0
    v_fmac_f32 v236, v34, v162
    v_fmac_f32 v240, v27, v147
    v_fmac_f32 v236, v35, v163
    v_fmac_f32 v240, v28, v148
    v_fmac_f32 v236, v36, v164
    v_fmac_f32 v240, v29, v149
    v_fmac_f32 v236, v37, v165
    v_fmac_f32 v240, v30, v150
    v_fmac_f32 v236, v38, v166
    v_fmac_f32 v240, v31, v151
    v_fmac_f32 v236, v39, v167
    v_mul_f32 v234, v0, v112
    v_mul_f32 v235, v40, v120
    v_fmac_f32 v234, v1, v113
    v_fmac_f32 v235, v41, v121
    v_fmac_f32 v234, v2, v114
    v_fmac_f32 v235, v42, v122
    v_fmac_f32 v234, v3, v115
    v_fmac_f32 v235, v43, v123
    v_fmac_f32 v234, v4, v116
    v_fmac_f32 v235, v44, v124
    v_fmac_f32 v234, v5, v117
    v_fmac_f32 v235, v45, v125
    v_fmac_f32 v234, v6, v118
    v_fmac_f32 v235, v46, v126
    v_fmac_f32 v234, v7, v119
    v_fmac_f32 v235, v47, v127
    v_mul_f32 v241, v64, v152
    v_fmac_f32 v237, v72, v168
    v_fmac_f32 v241, v65, v153
    v_fmac_f32 v237, v73, v169
    v_fmac_f32 v241, v66, v154
    s_setprio 1
    s_waitcnt vmcnt(3) lgkmcnt(1)
    v_mfma_f32_32x32x16_bf16 v[24:39], v[80:83], v[184:187], 0
    ds_read_b64_tr_b16 v[176:177], v246 offset:4096
    ds_read_b64_tr_b16 v[178:179], v246 offset:5120
    ds_read_b64_tr_b16 v[180:181], v247 offset:4096
    ds_read_b64_tr_b16 v[182:183], v247 offset:5120
    v_fmac_f32 v237, v74, v170
    v_fmac_f32 v241, v67, v155
    s_mov_b32 m0, s69
    v_mfma_f32_32x32x16_bf16 v[8:23], v[84:87], v[184:187], v[8:23]
    buffer_load_dwordx4 v224, s[4:7], s45 offen sc1 lds
    buffer_load_dwordx4 v225, s[72:75], s45 offen offset:1024 sc1 lds
    s_waitcnt lgkmcnt(4)
    v_mad_u32_u16 v226, v226, s39, v248 op_sel:[1,0,0,0]
    v_mad_u32_u16 v227, v227, s39, v248 op_sel:[1,0,0,0]
    v_fmac_f32 v237, v75, v171
    v_fmac_f32 v241, v68, v156
    v_mfma_f32_32x32x16_bf16 v[48:63], v[84:87], v[188:191], v[48:63]
    v_fmac_f32 v237, v76, v172
    v_fmac_f32 v241, v69, v157
    v_fmac_f32 v237, v77, v173
    v_fmac_f32 v241, v70, v158
    v_fmac_f32 v237, v78, v174
    v_fmac_f32 v241, v71, v159
    v_fmac_f32 v237, v79, v175
    v_mfma_f32_32x32x16_bf16 v[64:79], v[80:83], v[188:191], 0
    v_permlane32_swap_b32 v236, v240
    v_permlane32_swap_b32 v237, v241
    v_add_f32 v236, v236, v240
    v_add_f32 v237, v237, v241
    s_waitcnt vmcnt(4) lgkmcnt(0)
    v_mfma_f32_32x32x16_bf16 v[24:39], v[88:91], v[176:179], v[24:39]
    ds_read_b64_tr_b16 v[184:185], v246 offset:6144
    ds_read_b64_tr_b16 v[188:189], v247 offset:6144
    v_cvt_pk_bf16_f32 v236, v236, v237
    ds_write_b32 v232, v236 offset:1024
    s_mov_b32 s32, s31
    s_mov_b32 s31, s35
    s_mov_b32 m0, s70
    v_mfma_f32_32x32x16_bf16 v[8:23], v[92:95], v[176:179], v[8:23]
    buffer_load_dwordx4 v226, s[4:7], s46 offen sc1 lds
    buffer_load_dwordx4 v227, s[72:75], s46 offen offset:1024 sc1 lds
    s_sub_u32 s26, s48, s29
    s_mov_b32 s29, s48
    s_mov_b32 s30, s3
    s_bfe_u32 s56, s3, 0x40012
    v_mfma_f32_32x32x16_bf16 v[48:63], v[92:95], v[180:183], v[48:63]
    s_cmp_lg_u32 s36, 0
    s_cselect_b32 s56, s56, 0
    v_mfma_f32_32x32x16_bf16 v[64:79], v[88:91], v[180:183], v[64:79]
    s_waitcnt vmcnt(4) lgkmcnt(1)
    v_mfma_f32_32x32x8_bf16 v[24:39], v[228:229], v[184:185], v[24:39]
    ds_read_b64_tr_b16 v[176:177], v246 offset:0
    ds_read_b64_tr_b16 v[178:179], v246 offset:1024
    ds_read_b64_tr_b16 v[180:181], v247 offset:0
    ds_read_b64_tr_b16 v[182:183], v247 offset:1024
    s_mov_b32 m0, s71
    v_mfma_f32_32x32x8_bf16 v[8:23], v[242:243], v[184:185], v[8:23]
    s_cmp_eq_u32 s33, 4
    s_cbranch_scc1 K2_g4_71
    buffer_load_dwordx4 v224, s[4:7], s47 offen sc1 lds
    buffer_load_dwordx4 v225, s[72:75], s47 offen offset:1024 sc1 lds
K2_back_72:
    v_mfma_f32_32x32x8_bf16 v[48:63], v[242:243], v[188:189], v[48:63]
    s_nop 0
    v_mul_f32 v236, v24, v144
    v_fma_f32 v238, v32, v160, -v238
    v_fmac_f32 v236, v25, v145
    v_fmac_f32 v238, v33, v161
    v_fmac_f32 v236, v26, v146
    v_fmac_f32 v238, v34, v162
    v_fmac_f32 v236, v27, v147
    v_mfma_f32_32x32x8_bf16 v[64:79], v[228:229], v[188:189], v[64:79]
    s_setprio 0
    v_fmac_f32 v238, v35, v163
    v_fmac_f32 v236, v28, v148
    v_fmac_f32 v238, v36, v164
    v_fmac_f32 v236, v29, v149
    v_fmac_f32 v238, v37, v165
    v_fmac_f32 v236, v30, v150
    v_fmac_f32 v238, v38, v166
    v_fmac_f32 v236, v31, v151
    v_fmac_f32 v238, v39, v167
    v_add_u32 v249, s26, v249
    v_add_u32 v250, s26, v250
    v_mul_f32 v240, v8, v160
    v_fma_f32 v234, v16, v112, -v234
    v_fmac_f32 v240, v9, v161
    v_fmac_f32 v234, v17, v113
    v_fmac_f32 v240, v10, v162
    v_fmac_f32 v234, v18, v114
    v_fmac_f32 v240, v11, v163
    v_fmac_f32 v234, v19, v115
    v_fmac_f32 v240, v12, v164
    v_fmac_f32 v234, v20, v116
    v_fmac_f32 v240, v13, v165
    v_fmac_f32 v234, v21, v117
    v_fmac_f32 v240, v14, v166
    v_fmac_f32 v234, v22, v118
    v_fmac_f32 v240, v15, v167
    v_fmac_f32 v234, v23, v119
    ds_read_b64_tr_b16 v[80:81], v249 offset:0
    ds_read_u16_d16_hi v40, v250 offset:0
    v_mul_f32 v241, v48, v168
    v_fma_f32 v235, v56, v120, -v235
    v_fmac_f32 v241, v49, v169
    v_fmac_f32 v235, v57, v121
    v_fmac_f32 v241, v50, v170
    v_fmac_f32 v235, v58, v122
    v_fmac_f32 v241, v51, v171
    v_fmac_f32 v235, v59, v123
    v_fmac_f32 v241, v52, v172
    v_fmac_f32 v235, v60, v124
    v_fmac_f32 v241, v53, v173
    v_fmac_f32 v235, v61, v125
    v_fmac_f32 v241, v54, v174
    v_fmac_f32 v235, v62, v126
    v_fmac_f32 v241, v55, v175
    v_fmac_f32 v235, v63, v127
    ds_read_b64_tr_b16 v[88:89], v249 offset:512
    ds_read_u16_d16_hi v41, v250 offset:128
    v_mul_f32 v237, v64, v152
    v_fma_f32 v239, v72, v168, -v239
    v_fmac_f32 v237, v65, v153
    v_fmac_f32 v239, v73, v169
    v_fmac_f32 v237, v66, v154
    v_fmac_f32 v239, v74, v170
    v_fmac_f32 v237, v67, v155
    v_fmac_f32 v239, v75, v171
    v_fmac_f32 v237, v68, v156
    v_fmac_f32 v239, v76, v172
    v_fmac_f32 v237, v69, v157
    v_fmac_f32 v239, v77, v173
    v_fmac_f32 v237, v70, v158
    v_fmac_f32 v239, v78, v174
    v_fmac_f32 v237, v71, v159
    v_fmac_f32 v239, v79, v175
    s_cmp_eq_u32 s56, 5
    s_cbranch_scc1 K2_U21
    s_cmp_eq_u32 s56, 6
    s_cbranch_scc1 K2_U3h1
    s_branch K2_DSP1
K2_U31:
    s_setprio 1
    ds_read_b64_tr_b16 v[228:229], v249 offset:1024
    ds_read_u16_d16_hi v42, v250 offset:256
    s_waitcnt lgkmcnt(2)
    v_lshlrev_b32 v16, 16, v80
    v_and_b32 v17, 0xffff0000, v80
    v_lshlrev_b32 v18, 16, v81
    v_and_b32 v19, 0xffff0000, v81
    v_mov_b32 v82, v81
    v_mul_f32_dpp v32, v40, v16 row_newbcast:4 row_mask:0xf bank_mask:0xf
    v_mul_f32_dpp v33, v40, v17 row_newbcast:5 row_mask:0xf bank_mask:0xf
    v_mul_f32_dpp v34, v40, v18 row_newbcast:6 row_mask:0xf bank_mask:0xf
    v_mul_f32_dpp v35, v40, v19 row_newbcast:7 row_mask:0xf bank_mask:0xf
    v_cvt_pk_bf16_f32 v84, v32, v33
    v_cvt_pk_bf16_f32 v86, v34, v35
    v_mul_f32_dpp v36, v40, v16 row_newbcast:8 row_mask:0xf bank_mask:0xf
    v_mul_f32_dpp v37, v40, v17 row_newbcast:9 row_mask:0xf bank_mask:0xf
    v_mul_f32_dpp v38, v40, v18 row_newbcast:10 row_mask:0xf bank_mask:0xf
    v_mul_f32_dpp v39, v40, v19 row_newbcast:11 row_mask:0xf bank_mask:0xf
    v_cvt_pk_bf16_f32 v85, v36, v37
    v_cvt_pk_bf16_f32 v87, v38, v39
    v_mul_f32_dpp v16, v40, v16 row_newbcast:0 row_mask:0xf bank_mask:0xf
    v_mul_f32_dpp v17, v40, v17 row_newbcast:1 row_mask:0xf bank_mask:0xf
    v_mul_f32_dpp v18, v40, v18 row_newbcast:2 row_mask:0xf bank_mask:0xf
    v_mul_f32_dpp v19, v40, v19 row_newbcast:3 row_mask:0xf bank_mask:0xf
    v_cvt_pk_bf16_f32 v81, v16, v17
    v_cvt_pk_bf16_f32 v83, v18, v19
    v_permlane16_swap_b32 v84, v85
    v_permlane16_swap_b32 v86, v87
    v_permlane16_swap_b32 v80, v81
    v_permlane16_swap_b32 v82, v83
    v_lshlrev_b32 v24, 16, v88
    v_and_b32 v25, 0xffff0000, v88
    v_lshlrev_b32 v26, 16, v89
    v_and_b32 v27, 0xffff0000, v89
    v_mov_b32 v90, v89
    v_mul_f32_dpp v32, v41, v24 row_newbcast:4 row_mask:0xf bank_mask:0xf
    v_mul_f32_dpp v33, v41, v25 row_newbcast:5 row_mask:0xf bank_mask:0xf
    v_mul_f32_dpp v34, v41, v26 row_newbcast:6 row_mask:0xf bank_mask:0xf
    v_mul_f32_dpp v35, v41, v27 row_newbcast:7 row_mask:0xf bank_mask:0xf
    v_cvt_pk_bf16_f32 v92, v32, v33
    v_cvt_pk_bf16_f32 v94, v34, v35
    v_mul_f32_dpp v36, v41, v24 row_newbcast:8 row_mask:0xf bank_mask:0xf
    v_mul_f32_dpp v37, v41, v25 row_newbcast:9 row_mask:0xf bank_mask:0xf
    v_mul_f32_dpp v38, v41, v26 row_newbcast:10 row_mask:0xf bank_mask:0xf
    v_mul_f32_dpp v39, v41, v27 row_newbcast:11 row_mask:0xf bank_mask:0xf
    v_cvt_pk_bf16_f32 v93, v36, v37
    v_cvt_pk_bf16_f32 v95, v38, v39
    v_mul_f32_dpp v24, v41, v24 row_newbcast:0 row_mask:0xf bank_mask:0xf
    v_mul_f32_dpp v25, v41, v25 row_newbcast:1 row_mask:0xf bank_mask:0xf
    v_mul_f32_dpp v26, v41, v26 row_newbcast:2 row_mask:0xf bank_mask:0xf
    v_mul_f32_dpp v27, v41, v27 row_newbcast:3 row_mask:0xf bank_mask:0xf
    v_cvt_pk_bf16_f32 v89, v24, v25
    v_cvt_pk_bf16_f32 v91, v26, v27
    v_permlane16_swap_b32 v92, v93
    v_permlane16_swap_b32 v94, v95
    v_permlane16_swap_b32 v88, v89
    v_permlane16_swap_b32 v90, v91
    s_waitcnt lgkmcnt(0)
    v_lshlrev_b32 v16, 16, v228
    v_and_b32 v17, 0xffff0000, v228
    v_lshlrev_b32 v18, 16, v229
    v_and_b32 v19, 0xffff0000, v229
    v_mov_b32 v230, v229
    v_mul_f32_dpp v32, v42, v16 row_newbcast:4 row_mask:0xf bank_mask:0xf
    v_mul_f32_dpp v33, v42, v17 row_newbcast:5 row_mask:0xf bank_mask:0xf
    v_mul_f32_dpp v34, v42, v18 row_newbcast:6 row_mask:0xf bank_mask:0xf
    v_mul_f32_dpp v35, v42, v19 row_newbcast:7 row_mask:0xf bank_mask:0xf
    v_cvt_pk_bf16_f32 v242, v32, v33
    v_cvt_pk_bf16_f32 v244, v34, v35
    v_mul_f32_dpp v36, v42, v16 row_newbcast:8 row_mask:0xf bank_mask:0xf
    v_mul_f32_dpp v37, v42, v17 row_newbcast:9 row_mask:0xf bank_mask:0xf
    v_mul_f32_dpp v38, v42, v18 row_newbcast:10 row_mask:0xf bank_mask:0xf
    v_mul_f32_dpp v39, v42, v19 row_newbcast:11 row_mask:0xf bank_mask:0xf
    v_cvt_pk_bf16_f32 v243, v36, v37
    v_cvt_pk_bf16_f32 v245, v38, v39
    v_mul_f32_dpp v16, v42, v16 row_newbcast:0 row_mask:0xf bank_mask:0xf
    v_mul_f32_dpp v17, v42, v17 row_newbcast:1 row_mask:0xf bank_mask:0xf
    v_mul_f32_dpp v18, v42, v18 row_newbcast:2 row_mask:0xf bank_mask:0xf
    v_mul_f32_dpp v19, v42, v19 row_newbcast:3 row_mask:0xf bank_mask:0xf
    v_cvt_pk_bf16_f32 v229, v16, v17
    v_cvt_pk_bf16_f32 v231, v18, v19
    v_permlane16_swap_b32 v242, v243
    v_permlane16_swap_b32 v244, v245
    v_permlane16_swap_b32 v228, v229
    v_permlane16_swap_b32 v230, v231
    s_waitcnt vmcnt(4)
    v_mfma_f32_32x32x16_bf16 v[8:23], v[80:83], v[176:179], 0
    ds_read_b64_tr_b16 v[184:185], v246 offset:2048
    ds_read_b64_tr_b16 v[186:187], v246 offset:3072
    ds_read_b64_tr_b16 v[188:189], v247 offset:2048
    ds_read_b64_tr_b16 v[190:191], v247 offset:3072
    s_mov_b32 m0, s68
    v_mfma_f32_32x32x16_bf16 v[24:39], v[84:87], v[176:179], 0
    buffer_load_dwordx4 v222, s[4:7], s41 offen sc1 lds
    buffer_load_dwordx4 v223, s[72:75], s41 offen offset:1024 sc1 lds
    v_permlane32_swap_b32 v236, v234
    v_permlane32_swap_b32 v237, v235
    v_mfma_f32_32x32x16_bf16 v[48:63], v[80:83], v[180:183], 0
    v_permlane32_swap_b32 v240, v238
    v_permlane32_swap_b32 v241, v239
    v_add_f32 v236, v236, v234
    v_add_f32 v237, v237, v235
    v_add_f32 v240, -v240, -v238
    v_mfma_f32_32x32x16_bf16 v[64:79], v[84:87], v[180:183], 0
    v_add_f32 v241, -v241, -v239
    v_cvt_pk_bf16_f32 v236, v236, v237
    v_cvt_pk_bf16_f32 v240, v240, v241
    ds_write2st64_b32 v232, v236, v240 offset0:2 offset1:3
    s_mov_b64 exec, 0x1ff
    ds_add_rtn_u32 v42, v254, v251
    s_mov_b64 exec, -1
    s_waitcnt vmcnt(4) lgkmcnt(2)
    v_mfma_f32_32x32x16_bf16 v[8:23], v[88:91], v[184:187], v[8:23]
    ds_read_b64_tr_b16 v[176:177], v246 offset:4096
    ds_read_b64_tr_b16 v[178:179], v246 offset:5120
    ds_read_b64_tr_b16 v[180:181], v247 offset:4096
    ds_read_b64_tr_b16 v[182:183], v247 offset:5120
    s_mov_b32 m0, s69
    v_mfma_f32_32x32x16_bf16 v[24:39], v[92:95], v[184:187], v[24:39]
    buffer_load_dwordx4 v226, s[4:7], s41 offen sc1 lds
    buffer_load_dwordx4 v227, s[72:75], s41 offen offset:1024 sc1 lds
    s_waitcnt lgkmcnt(4)
    v_readlane_b32 s58, v42, 8
    v_mfma_f32_32x32x16_bf16 v[48:63], v[88:91], v[188:191], v[48:63]
    s_lshr_b32 s58, s58, 4
    s_cmp_lt_u32 s58, s22
    s_cbranch_scc0 K2_nul_73
    v_readlane_b32 s3, v253, s58
    s_nop 0
    s_bfe_u32 s58, s3, 0x60016
    s_and_b32 s59, s58, 7
    s_lshr_b32 s60, s58, 3
K2_chk_75:
    v_readlane_b32 s61, v42, s59
    s_nop 0
    s_cmp_gt_u32 s61, s60
    s_cbranch_scc0 K2_spin_74
K2_back_76:
    v_mfma_f32_32x32x16_bf16 v[64:79], v[92:95], v[188:191], v[64:79]
    s_lshl_b32 s44, s34, 7
    s_and_b32 s48, s3, 0x3ffff
    s_bfe_u32 s33, s3, 0x30013
    s_mov_b32 s35, s48
    s_mov_b32 s45, s44
    s_xor_b32 s47, s44, 256
    s_waitcnt vmcnt(4) lgkmcnt(0)
    v_mfma_f32_32x32x16_bf16 v[8:23], v[228:231], v[176:179], v[8:23]
    ds_read_b64_tr_b16 v[184:185], v246 offset:6144
    ds_read_b64_tr_b16 v[186:187], v246 offset:7168
    ds_read_b64_tr_b16 v[188:189], v247 offset:6144
    ds_read_b64_tr_b16 v[190:191], v247 offset:7168
    s_add_u32 s49, s48, 128
    s_add_u32 s60, s48, 256
    s_mov_b32 m0, s70
    v_mfma_f32_32x32x16_bf16 v[24:39], v[242:245], v[176:179], v[24:39]
    buffer_load_dwordx4 v222, s[4:7], s42 offen sc1 lds
    buffer_load_dwordx4 v223, s[72:75], s42 offen offset:1024 sc1 lds
    s_cmp_eq_u32 s33, 3
    s_cselect_b32 s46, s44, s47
    s_cselect_b32 s50, s60, s48
    v_mfma_f32_32x32x16_bf16 v[48:63], v[228:231], v[180:183], v[48:63]
    s_sub_u32 s60, s33, 2
    s_cmp_lt_u32 s60, 2
    s_cbranch_scc0 K2_rare_77
K2_back_78:
    v_mul_f32 v234, v8, v96
    v_mul_f32 v236, v16, v128
    v_fmac_f32 v234, v9, v97
    v_fmac_f32 v236, v17, v129
    v_mfma_f32_32x32x16_bf16 v[64:79], v[242:245], v[180:183], v[64:79]
    s_setprio 0
    v_fmac_f32 v234, v10, v98
    v_fmac_f32 v236, v18, v130
    v_fmac_f32 v234, v11, v99
    v_fmac_f32 v236, v19, v131
    v_fmac_f32 v234, v12, v100
    v_fmac_f32 v236, v20, v132
    v_fmac_f32 v234, v13, v101
    v_fmac_f32 v236, v21, v133
    v_fmac_f32 v234, v14, v102
    v_fmac_f32 v236, v22, v134
    v_fmac_f32 v234, v15, v103
    v_fmac_f32 v236, v23, v135
    v_mul_f32 v238, v24, v128
    v_mul_f32 v240, v32, v128
    v_fmac_f32 v238, v25, v129
    v_fmac_f32 v240, v33, v129
    v_fmac_f32 v238, v26, v130
    v_fmac_f32 v240, v34, v130
    v_fmac_f32 v238, v27, v131
    v_fmac_f32 v240, v35, v131
    v_fmac_f32 v238, v28, v132
    v_fmac_f32 v240, v36, v132
    v_fmac_f32 v238, v29, v133
    v_fmac_f32 v240, v37, v133
    v_fmac_f32 v238, v30, v134
    v_fmac_f32 v240, v38, v134
    v_fmac_f32 v238, v31, v135
    v_fmac_f32 v240, v39, v135
    v_mul_f32 v235, v48, v104
    v_mul_f32 v237, v56, v136
    v_fmac_f32 v235, v49, v105
    v_fmac_f32 v237, v57, v137
    v_fmac_f32 v235, v50, v106
    v_fmac_f32 v237, v58, v138
    v_fmac_f32 v235, v51, v107
    v_fmac_f32 v237, v59, v139
    v_fmac_f32 v235, v52, v108
    v_fmac_f32 v237, v60, v140
    v_fmac_f32 v235, v53, v109
    v_fmac_f32 v237, v61, v141
    v_fmac_f32 v235, v54, v110
    v_fmac_f32 v237, v62, v142
    v_fmac_f32 v235, v55, v111
    v_fmac_f32 v237, v63, v143
    v_mul_f32 v239, v64, v136
    v_mul_f32 v241, v72, v136
    s_setprio 1
    s_waitcnt vmcnt(4) lgkmcnt(0)
    v_mfma_f32_32x32x16_bf16 v[24:39], v[92:95], v[184:187], 0
    ds_read_b64_tr_b16 v[176:177], v246 offset:0
    ds_read_b64_tr_b16 v[178:179], v246 offset:1024
    ds_read_b64_tr_b16 v[180:181], v247 offset:0
    ds_read_b64_tr_b16 v[182:183], v247 offset:1024
    v_fmac_f32 v239, v65, v137
    v_fmac_f32 v241, v73, v137
    s_mov_b32 m0, s71
    v_mfma_f32_32x32x16_bf16 v[8:23], v[88:91], v[184:187], 0
    buffer_load_dwordx4 v224, s[4:7], s42 offen sc1 lds
    buffer_load_dwordx4 v225, s[72:75], s42 offen offset:1024 sc1 lds
    v_fmac_f32 v239, v66, v138
    v_fmac_f32 v241, v74, v138
    v_fmac_f32 v239, v67, v139
    v_fmac_f32 v241, v75, v139
    v_fmac_f32 v239, v68, v140
    v_mfma_f32_32x32x16_bf16 v[48:63], v[88:91], v[188:191], 0
    v_fmac_f32 v241, v76, v140
    v_fmac_f32 v239, v69, v141
    v_fmac_f32 v241, v77, v141
    v_fmac_f32 v239, v70, v142
    v_fmac_f32 v241, v78, v142
    v_fmac_f32 v239, v71, v143
    v_fmac_f32 v241, v79, v143
    v_mfma_f32_32x32x16_bf16 v[64:79], v[92:95], v[188:191], 0
    v_permlane32_swap_b32 v234, v236
    v_permlane32_swap_b32 v235, v237
    v_permlane32_swap_b32 v238, v239
    s_waitcnt vmcnt(4) lgkmcnt(0)
    v_mfma_f32_32x32x16_bf16 v[24:39], v[84:87], v[176:179], v[24:39]
    ds_read_b64_tr_b16 v[184:185], v246 offset:2048
    ds_read_b64_tr_b16 v[186:187], v246 offset:3072
    ds_read_b64_tr_b16 v[188:189], v247 offset:2048
    ds_read_b64_tr_b16 v[190:191], v247 offset:3072
    v_lshl_add_u32 v232, v252, 1, s31
    v_add_f32 v234, v234, v236
    s_mov_b32 m0, s68
    v_mfma_f32_32x32x16_bf16 v[8:23], v[80:83], v[176:179], v[8:23]
    buffer_load_dwordx4 v226, s[4:7], s42 offen sc1 lds
    buffer_load_dwordx4 v227, s[72:75], s42 offen offset:1024 sc1 lds
    v_add_f32 v235, v235, v237
    v_add_f32 v238, -v238, -v239
    v_sub_u32 v239, v232, v233
    v_cvt_pk_bf16_f32 v234, v234, v235
    v_cvt_pk_bf16_f32 v238, v238, v238
    v_mfma_f32_32x32x16_bf16 v[48:63], v[80:83], v[180:183], v[48:63]
    ds_write_b32 v232, v234 offset:0
    ds_write_b16 v239, v238 offset:1280
    v_mfma_f32_32x32x16_bf16 v[64:79], v[84:87], v[180:183], v[64:79]
    s_waitcnt vmcnt(4) lgkmcnt(2)
    v_mfma_f32_32x32x16_bf16 v[24:39], v[242:245], v[184:187], v[24:39]
    ds_read_b64_tr_b16 v[176:177], v246 offset:4096
    ds_read_b64_tr_b16 v[178:179], v246 offset:5120
    ds_read_b64_tr_b16 v[180:181], v247 offset:4096
    ds_read_b64_tr_b16 v[182:183], v247 offset:5120
    s_mov_b32 m0, s69
    v_mfma_f32_32x32x16_bf16 v[8:23], v[228:231], v[184:187], v[8:23]
    buffer_load_dwordx4 v222, s[4:7], s43 offen sc1 lds
    buffer_load_dwordx4 v223, s[72:75], s43 offen offset:1024 sc1 lds
    v_mfma_f32_32x32x16_bf16 v[48:63], v[228:231], v[188:191], v[48:63]
    s_nop 2
    v_mul_f32 v236, v24, v160
    v_mul_f32 v238, v32, v160
    v_fmac_f32 v236, v25, v161
    v_fmac_f32 v238, v33, v161
    v_fmac_f32 v236, v26, v162
    v_fmac_f32 v238, v34, v162
    v_fmac_f32 v236, v27, v163
    v_mfma_f32_32x32x16_bf16 v[64:79], v[242:245], v[188:191], v[64:79]
    s_setprio 0
    v_fmac_f32 v238, v35, v163
    v_fmac_f32 v236, v28, v164
    v_fmac_f32 v238, v36, v164
    v_fmac_f32 v236, v29, v165
    v_fmac_f32 v238, v37, v165
    v_fmac_f32 v236, v30, v166
    v_fmac_f32 v238, v38, v166
    v_fmac_f32 v236, v31, v167
    v_fmac_f32 v238, v39, v167
    v_mul_f32 v234, v8, v144
    v_mul_f32 v235, v48, v152
    v_fmac_f32 v234, v9, v145
    v_fmac_f32 v235, v49, v153
    v_fmac_f32 v234, v10, v146
    v_fmac_f32 v235, v50, v154
    v_fmac_f32 v234, v11, v147
    v_fmac_f32 v235, v51, v155
    v_fmac_f32 v234, v12, v148
    v_fmac_f32 v235, v52, v156
    v_fmac_f32 v234, v13, v149
    v_fmac_f32 v235, v53, v157
    v_fmac_f32 v234, v14, v150
    v_fmac_f32 v235, v54, v158
    v_fmac_f32 v234, v15, v151
    v_fmac_f32 v235, v55, v159
    v_mul_f32 v237, v64, v168
    v_mul_f32 v239, v72, v168
    v_fmac_f32 v237, v65, v169
    v_fmac_f32 v239, v73, v169
    s_setprio 1
    s_waitcnt vmcnt(4) lgkmcnt(0)
    v_mfma_f32_32x32x16_bf16 v[24:39], v[80:83], v[176:179], 0
    ds_read_b64_tr_b16 v[184:185], v246 offset:6144
    ds_read_b64_tr_b16 v[186:187], v246 offset:7168
    ds_read_b64_tr_b16 v[188:189], v247 offset:6144
    ds_read_b64_tr_b16 v[190:191], v247 offset:7168
    v_fmac_f32 v237, v66, v170
    v_fmac_f32 v239, v74, v170
    s_mov_b32 m0, s70
    v_mfma_f32_32x32x16_bf16 v[0:15], v[84:87], v[176:179], 0
    buffer_load_dwordx4 v224, s[4:7], s43 offen sc1 lds
    buffer_load_dwordx4 v225, s[72:75], s43 offen offset:1024 sc1 lds
    v_fmac_f32 v237, v67, v171
    v_fmac_f32 v239, v75, v171
    v_fmac_f32 v237, v68, v172
    v_fmac_f32 v239, v76, v172
    v_fmac_f32 v237, v69, v173
    v_mfma_f32_32x32x16_bf16 v[40:55], v[84:87], v[180:183], 0
    v_add_u32 v222, s48, v251
    ds_read2_b32 v[222:223], v222 offset0:1 offset1:3
    v_fmac_f32 v239, v77, v173
    v_fmac_f32 v237, v70, v174
    v_fmac_f32 v239, v78, v174
    v_fmac_f32 v237, v71, v175
    v_fmac_f32 v239, v79, v175
    v_mfma_f32_32x32x16_bf16 v[64:79], v[80:83], v[180:183], 0
    v_permlane32_swap_b32 v234, v240
    v_permlane32_swap_b32 v235, v241
    v_add_f32 v234, v234, v240
    v_add_f32 v235, v235, v241
    s_waitcnt vmcnt(4) lgkmcnt(1)
    v_mfma_f32_32x32x16_bf16 v[24:39], v[88:91], v[184:187], v[24:39]
    ds_read_b64_tr_b16 v[176:177], v246 offset:0
    ds_read_b64_tr_b16 v[178:179], v246 offset:1024
    ds_read_b64_tr_b16 v[180:181], v247 offset:0
    ds_read_b64_tr_b16 v[182:183], v247 offset:1024
    v_cvt_pk_bf16_f32 v234, v234, v235
    ds_write_b32 v232, v234 offset:256
    s_mov_b32 m0, s71
    v_mfma_f32_32x32x16_bf16 v[0:15], v[92:95], v[184:187], v[0:15]
    buffer_load_dwordx4 v226, s[4:7], s43 offen sc1 lds
    buffer_load_dwordx4 v227, s[72:75], s43 offen offset:1024 sc1 lds
    s_waitcnt lgkmcnt(5)
    v_mad_u32_u16 v222, v222, s39, v248 op_sel:[1,0,0,0]
    v_mad_u32_u16 v223, v223, s39, v248 op_sel:[1,0,0,0]
    v_mfma_f32_32x32x16_bf16 v[40:55], v[92:95], v[188:191], v[40:55]
    v_add_u32 v224, s49, v251
    ds_read2_b32 v[224:225], v224 offset0:1 offset1:3
    v_mfma_f32_32x32x16_bf16 v[64:79], v[88:91], v[188:191], v[64:79]
    s_waitcnt vmcnt(4) lgkmcnt(2)
    v_mfma_f32_32x32x16_bf16 v[24:39], v[228:231], v[176:179], v[24:39]
    ds_read_b64_tr_b16 v[184:185], v246 offset:2048
    ds_read_b64_tr_b16 v[186:187], v246 offset:3072
    ds_read_b64_tr_b16 v[188:189], v247 offset:2048
    ds_read_b64_tr_b16 v[190:191], v247 offset:3072
    s_mov_b32 m0, s68
    v_mfma_f32_32x32x16_bf16 v[0:15], v[242:245], v[176:179], v[0:15]
    buffer_load_dwordx4 v222, s[4:7], s44 offen sc1 lds
    buffer_load_dwordx4 v223, s[72:75], s44 offen offset:1024 sc1 lds
    s_waitcnt lgkmcnt(4)
    v_mad_u32_u16 v224, v224, s39, v248 op_sel:[1,0,0,0]
    v_mad_u32_u16 v225, v225, s39, v248 op_sel:[1,0,0,0]
    v_mfma_f32_32x32x16_bf16 v[40:55], v[242:245], v[180:183], v[40:55]
    v_add_u32 v226, s50, v251
    ds_read2_b32 v[226:227], v226 offset0:1 offset1:3
    v_mul_f32 v240, v24, v144
    v_fmac_f32 v236, v32, v160
    v_fmac_f32 v240, v25, v145
    v_fmac_f32 v236, v33, v161
    v_fmac_f32 v240, v26, v146
    v_mfma_f32_32x32x16_bf16 v[64:79], v[228:231], v[180:183], v[64:79]
    s_setprio 0
    v_fmac_f32 v236, v34, v162
    v_fmac_f32 v240, v27, v147
    v_fmac_f32 v236, v35, v163
    v_fmac_f32 v240, v28, v148
    v_fmac_f32 v236, v36, v164
    v_fmac_f32 v240, v29, v149
    v_fmac_f32 v236, v37, v165
    v_fmac_f32 v240, v30, v150
    v_fmac_f32 v236, v38, v166
    v_fmac_f32 v240, v31, v151
    v_fmac_f32 v236, v39, v167
    v_mul_f32 v234, v0, v112
    v_mul_f32 v235, v40, v120
    v_fmac_f32 v234, v1, v113
    v_fmac_f32 v235, v41, v121
    v_fmac_f32 v234, v2, v114
    v_fmac_f32 v235, v42, v122
    v_fmac_f32 v234, v3, v115
    v_fmac_f32 v235, v43, v123
    v_fmac_f32 v234, v4, v116
    v_fmac_f32 v235, v44, v124
    v_fmac_f32 v234, v5, v117
    v_fmac_f32 v235, v45, v125
    v_fmac_f32 v234, v6, v118
    v_fmac_f32 v235, v46, v126
    v_fmac_f32 v234, v7, v119
    v_fmac_f32 v235, v47, v127
    v_mul_f32 v241, v64, v152
    v_fmac_f32 v237, v72, v168
    v_fmac_f32 v241, v65, v153
    v_fmac_f32 v237, v73, v169
    v_fmac_f32 v241, v66, v154
    s_setprio 1
    s_waitcnt vmcnt(4) lgkmcnt(1)
    v_mfma_f32_32x32x16_bf16 v[24:39], v[80:83], v[184:187], 0
    ds_read_b64_tr_b16 v[176:177], v246 offset:4096
    ds_read_b64_tr_b16 v[178:179], v246 offset:5120
    ds_read_b64_tr_b16 v[180:181], v247 offset:4096
    ds_read_b64_tr_b16 v[182:183], v247 offset:5120
    v_fmac_f32 v237, v74, v170
    v_fmac_f32 v241, v67, v155
    s_mov_b32 m0, s69
    v_mfma_f32_32x32x16_bf16 v[8:23], v[84:87], v[184:187], v[8:23]
    buffer_load_dwordx4 v224, s[4:7], s45 offen sc1 lds
    buffer_load_dwordx4 v225, s[72:75], s45 offen offset:1024 sc1 lds
    s_waitcnt lgkmcnt(4)
    v_mad_u32_u16 v226, v226, s39, v248 op_sel:[1,0,0,0]
    v_mad_u32_u16 v227, v227, s39, v248 op_sel:[1,0,0,0]
    v_fmac_f32 v237, v75, v171
    v_fmac_f32 v241, v68, v156
    v_mfma_f32_32x32x16_bf16 v[48:63], v[84:87], v[188:191], v[48:63]
    v_fmac_f32 v237, v76, v172
    v_fmac_f32 v241, v69, v157
    v_fmac_f32 v237, v77, v173
    v_fmac_f32 v241, v70, v158
    v_fmac_f32 v237, v78, v174
    v_fmac_f32 v241, v71, v159
    v_fmac_f32 v237, v79, v175
    v_mfma_f32_32x32x16_bf16 v[64:79], v[80:83], v[188:191], 0
    v_permlane32_swap_b32 v236, v240
    v_permlane32_swap_b32 v237, v241
    v_add_f32 v236, v236, v240
    v_add_f32 v237, v237, v241
    s_waitcnt vmcnt(4) lgkmcnt(0)
    v_mfma_f32_32x32x16_bf16 v[24:39], v[88:91], v[176:179], v[24:39]
    ds_read_b64_tr_b16 v[184:185], v246 offset:6144
    ds_read_b64_tr_b16 v[186:187], v246 offset:7168
    ds_read_b64_tr_b16 v[188:189], v247 offset:6144
    ds_read_b64_tr_b16 v[190:191], v247 offset:7168
    v_cvt_pk_bf16_f32 v236, v236, v237
    ds_write_b32 v232, v236 offset:1024
    s_mov_b32 m0, s70
    v_mfma_f32_32x32x16_bf16 v[8:23], v[92:95], v[176:179], v[8:23]
    buffer_load_dwordx4 v226, s[4:7], s46 offen sc1 lds
    buffer_load_dwordx4 v227, s[72:75], s46 offen offset:1024 sc1 lds
    s_sub_u32 s26, s48, s29
    s_mov_b32 s29, s48
    s_mov_b32 s30, s3
    s_bfe_u32 s56, s3, 0x40012
    s_mov_b32 s32, s31
    v_mfma_f32_32x32x16_bf16 v[48:63], v[92:95], v[180:183], v[48:63]
    s_cmp_lg_u32 s36, 0
    s_cselect_b32 s56, s56, 0
    s_mov_b32 s31, s35
    v_mfma_f32_32x32x16_bf16 v[64:79], v[88:91], v[180:183], v[64:79]
    s_waitcnt vmcnt(4) lgkmcnt(1)
    v_mfma_f32_32x32x16_bf16 v[24:39], v[228:231], v[184:187], v[24:39]
    ds_read_b64_tr_b16 v[176:177], v246 offset:0
    ds_read_b64_tr_b16 v[178:179], v246 offset:1024
    ds_read_b64_tr_b16 v[180:181], v247 offset:0
    ds_read_b64_tr_b16 v[182:183], v247 offset:1024
    s_mov_b32 m0, s71
    v_mfma_f32_32x32x16_bf16 v[8:23], v[242:245], v[184:187], v[8:23]
    s_cmp_eq_u32 s33, 4
    s_cbranch_scc1 K2_g4_80
    buffer_load_dwordx4 v224, s[4:7], s47 offen sc1 lds
    buffer_load_dwordx4 v225, s[72:75], s47 offen offset:1024 sc1 lds
K2_back_81:
    v_mfma_f32_32x32x16_bf16 v[48:63], v[242:245], v[188:191], v[48:63]
    s_nop 0
    v_mul_f32 v236, v24, v144
    v_fma_f32 v238, v32, v160, -v238
    v_fmac_f32 v236, v25, v145
    v_fmac_f32 v238, v33, v161
    v_fmac_f32 v236, v26, v146
    v_fmac_f32 v238, v34, v162
    v_fmac_f32 v236, v27, v147
    v_mfma_f32_32x32x16_bf16 v[64:79], v[228:231], v[188:191], v[64:79]
    s_setprio 0
    v_fmac_f32 v238, v35, v163
    v_fmac_f32 v236, v28, v148
    v_fmac_f32 v238, v36, v164
    v_fmac_f32 v236, v29, v149
    v_fmac_f32 v238, v37, v165
    v_fmac_f32 v236, v30, v150
    v_fmac_f32 v238, v38, v166
    v_fmac_f32 v236, v31, v151
    v_fmac_f32 v238, v39, v167
    v_add_u32 v249, s26, v249
    v_add_u32 v250, s26, v250
    v_mul_f32 v240, v8, v160
    v_fma_f32 v234, v16, v112, -v234
    v_fmac_f32 v240, v9, v161
    v_fmac_f32 v234, v17, v113
    v_fmac_f32 v240, v10, v162
    v_fmac_f32 v234, v18, v114
    v_fmac_f32 v240, v11, v163
    v_fmac_f32 v234, v19, v115
    v_fmac_f32 v240, v12, v164
    v_fmac_f32 v234, v20, v116
    v_fmac_f32 v240, v13, v165
    v_fmac_f32 v234, v21, v117
    v_fmac_f32 v240, v14, v166
    v_fmac_f32 v234, v22, v118
    v_fmac_f32 v240, v15, v167
    v_fmac_f32 v234, v23, v119
    ds_read_b64_tr_b16 v[80:81], v249 offset:0
    ds_read_u16_d16_hi v40, v250 offset:0
    v_mul_f32 v241, v48, v168
    v_fma_f32 v235, v56, v120, -v235
    v_fmac_f32 v241, v49, v169
    v_fmac_f32 v235, v57, v121
    v_fmac_f32 v241, v50, v170
    v_fmac_f32 v235, v58, v122
    v_fmac_f32 v241, v51, v171
    v_fmac_f32 v235, v59, v123
    v_fmac_f32 v241, v52, v172
    v_fmac_f32 v235, v60, v124
    v_fmac_f32 v241, v53, v173
    v_fmac_f32 v235, v61, v125
    v_fmac_f32 v241, v54, v174
    v_fmac_f32 v235, v62, v126
    v_fmac_f32 v241, v55, v175
    v_fmac_f32 v235, v63, v127
    ds_read_b64_tr_b16 v[88:89], v249 offset:512
    ds_read_u16_d16_hi v41, v250 offset:128
    v_mul_f32 v237, v64, v152
    v_fma_f32 v239, v72, v168, -v239
    v_fmac_f32 v237, v65, v153
    v_fmac_f32 v239, v73, v169
    v_fmac_f32 v237, v66, v154
    v_fmac_f32 v239, v74, v170
    v_fmac_f32 v237, v67, v155
    v_fmac_f32 v239, v75, v171
    v_fmac_f32 v237, v68, v156
    v_fmac_f32 v239, v76, v172
    v_fmac_f32 v237, v69, v157
    v_fmac_f32 v239, v77, v173
    v_fmac_f32 v237, v70, v158
    v_fmac_f32 v239, v78, v174
    v_fmac_f32 v237, v71, v159
    v_fmac_f32 v239, v79, v175
    s_cmp_eq_u32 s56, 5
    s_cbranch_scc1 K2_U21
    s_cmp_eq_u32 s56, 6
    s_cbranch_scc1 K2_U3h1
    s_branch K2_DSP1
K2_U2h1:
    s_setprio 1
    s_waitcnt lgkmcnt(0)
    v_lshlrev_b32 v16, 16, v80
    v_and_b32 v17, 0xffff0000, v80
    v_lshlrev_b32 v18, 16, v81
    v_and_b32 v19, 0xffff0000, v81
    v_mov_b32 v82, v81
    v_mul_f32_dpp v32, v40, v16 row_newbcast:4 row_mask:0xf bank_mask:0xf
    v_mul_f32_dpp v33, v40, v17 row_newbcast:5 row_mask:0xf bank_mask:0xf
    v_mul_f32_dpp v34, v40, v18 row_newbcast:6 row_mask:0xf bank_mask:0xf
    v_mul_f32_dpp v35, v40, v19 row_newbcast:7 row_mask:0xf bank_mask:0xf
    v_cvt_pk_bf16_f32 v84, v32, v33
    v_cvt_pk_bf16_f32 v86, v34, v35
    v_mul_f32_dpp v36, v40, v16 row_newbcast:8 row_mask:0xf bank_mask:0xf
    v_mul_f32_dpp v37, v40, v17 row_newbcast:9 row_mask:0xf bank_mask:0xf
    v_mul_f32_dpp v38, v40, v18 row_newbcast:10 row_mask:0xf bank_mask:0xf
    v_mul_f32_dpp v39, v40, v19 row_newbcast:11 row_mask:0xf bank_mask:0xf
    v_cvt_pk_bf16_f32 v85, v36, v37
    v_cvt_pk_bf16_f32 v87, v38, v39
    v_mul_f32_dpp v16, v40, v16 row_newbcast:0 row_mask:0xf bank_mask:0xf
    v_mul_f32_dpp v17, v40, v17 row_newbcast:1 row_mask:0xf bank_mask:0xf
    v_mul_f32_dpp v18, v40, v18 row_newbcast:2 row_mask:0xf bank_mask:0xf
    v_mul_f32_dpp v19, v40, v19 row_newbcast:3 row_mask:0xf bank_mask:0xf
    v_cvt_pk_bf16_f32 v81, v16, v17
    v_cvt_pk_bf16_f32 v83, v18, v19
    v_permlane16_swap_b32 v84, v85
    v_permlane16_swap_b32 v86, v87
    v_permlane16_swap_b32 v80, v81
    v_permlane16_swap_b32 v82, v83
    v_lshlrev_b32 v24, 16, v88
    v_and_b32 v25, 0xffff0000, v88
    s_nop 0
    v_mul_f32_dpp v32, v41, v24 row_newbcast:4 row_mask:0xf bank_mask:0xf
    v_mul_f32_dpp v33, v41, v25 row_newbcast:5 row_mask:0xf bank_mask:0xf
    v_cvt_pk_bf16_f32 v92, v32, v33
    v_mul_f32_dpp v36, v41, v24 row_newbcast:8 row_mask:0xf bank_mask:0xf
    v_mul_f32_dpp v37, v41, v25 row_newbcast:9 row_mask:0xf bank_mask:0xf
    v_cvt_pk_bf16_f32 v93, v36, v37
    v_mul_f32_dpp v24, v41, v24 row_newbcast:0 row_mask:0xf bank_mask:0xf
    v_mul_f32_dpp v25, v41, v25 row_newbcast:1 row_mask:0xf bank_mask:0xf
    v_cvt_pk_bf16_f32 v89, v24, v25
    v_permlane16_swap_b32 v92, v93
    s_nop 0
    v_permlane16_swap_b32 v88, v89
    s_waitcnt vmcnt(4)
    v_mfma_f32_32x32x16_bf16 v[8:23], v[80:83], v[176:179], 0
    ds_read_b64_tr_b16 v[184:185], v246 offset:2048
    ds_read_b64_tr_b16 v[188:189], v247 offset:2048
    s_mov_b32 m0, s68
    v_mfma_f32_32x32x16_bf16 v[24:39], v[84:87], v[176:179], 0
    buffer_load_dwordx4 v222, s[4:7], s42 offen sc1 lds
    buffer_load_dwordx4 v223, s[72:75], s42 offen offset:1024 sc1 lds
    v_permlane32_swap_b32 v236, v234
    v_permlane32_swap_b32 v237, v235
    v_mfma_f32_32x32x16_bf16 v[48:63], v[80:83], v[180:183], 0
    v_permlane32_swap_b32 v240, v238
    v_permlane32_swap_b32 v241, v239
    v_add_f32 v236, v236, v234
    v_add_f32 v237, v237, v235
    v_add_f32 v240, -v240, -v238
    v_mfma_f32_32x32x16_bf16 v[64:79], v[84:87], v[180:183], 0
    v_add_f32 v241, -v241, -v239
    v_cvt_pk_bf16_f32 v236, v236, v237
    v_cvt_pk_bf16_f32 v240, v240, v241
    ds_write2st64_b32 v232, v236, v240 offset0:2 offset1:3
    s_mov_b64 exec, 0x1ff
    ds_add_rtn_u32 v42, v254, v251
    s_mov_b64 exec, -1
    s_waitcnt vmcnt(4) lgkmcnt(2)
    v_mfma_f32_32x32x8_bf16 v[8:23], v[88:89], v[184:185], v[8:23]
    ds_read_b64_tr_b16 v[176:177], v246 offset:4096
    ds_read_b64_tr_b16 v[178:179], v246 offset:5120
    ds_read_b64_tr_b16 v[180:181], v247 offset:4096
    ds_read_b64_tr_b16 v[182:183], v247 offset:5120
    s_mov_b32 m0, s69
    v_mfma_f32_32x32x8_bf16 v[24:39], v[92:93], v[184:185], v[24:39]
    buffer_load_dwordx4 v224, s[4:7], s42 offen sc1 lds
    s_waitcnt lgkmcnt(4)
    v_readlane_b32 s58, v42, 8
    v_mfma_f32_32x32x8_bf16 v[48:63], v[88:89], v[188:189], v[48:63]
    s_lshr_b32 s58, s58, 4
    s_cmp_lt_u32 s58, s22
    s_cbranch_scc0 K2_nul_82
    v_readlane_b32 s3, v253, s58
    s_nop 0
    s_bfe_u32 s58, s3, 0x60016
    s_and_b32 s59, s58, 7
    s_lshr_b32 s60, s58, 3
K2_chk_84:
    v_readlane_b32 s61, v42, s59
    s_nop 0
    s_cmp_gt_u32 s61, s60
    s_cbranch_scc0 K2_spin_83
K2_back_85:
    v_mfma_f32_32x32x8_bf16 v[64:79], v[92:93], v[188:189], v[64:79]
    s_setprio 0
    s_lshl_b32 s44, s34, 7
    s_and_b32 s48, s3, 0x3ffff
    s_bfe_u32 s33, s3, 0x30013
    s_mov_b32 s35, s48
    s_mov_b32 s45, s44
    s_xor_b32 s47, s44, 256
    v_mul_f32 v234, v8, v96
    v_mul_f32 v236, v16, v128
    v_fmac_f32 v234, v9, v97
    v_fmac_f32 v236, v17, v129
    v_fmac_f32 v234, v10, v98
    v_fmac_f32 v236, v18, v130
    v_fmac_f32 v234, v11, v99
    v_fmac_f32 v236, v19, v131
    v_fmac_f32 v234, v12, v100
    v_fmac_f32 v236, v20, v132
    v_fmac_f32 v234, v13, v101
    v_fmac_f32 v236, v21, v133
    v_fmac_f32 v234, v14, v102
    v_fmac_f32 v236, v22, v134
    v_fmac_f32 v234, v15, v103
    v_fmac_f32 v236, v23, v135
    v_mul_f32 v238, v24, v128
    v_mul_f32 v240, v32, v128
    v_fmac_f32 v238, v25, v129
    v_fmac_f32 v240, v33, v129
    v_fmac_f32 v238, v26, v130
    v_fmac_f32 v240, v34, v130
    v_fmac_f32 v238, v27, v131
    v_fmac_f32 v240, v35, v131
    v_fmac_f32 v238, v28, v132
    v_fmac_f32 v240, v36, v132
    v_fmac_f32 v238, v29, v133
    v_fmac_f32 v240, v37, v133
    v_fmac_f32 v238, v30, v134
    v_fmac_f32 v240, v38, v134
    v_fmac_f32 v238, v31, v135
    v_fmac_f32 v240, v39, v135
    v_mul_f32 v235, v48, v104
    v_mul_f32 v237, v56, v136
    v_fmac_f32 v235, v49, v105
    v_fmac_f32 v237, v57, v137
    v_fmac_f32 v235, v50, v106
    v_fmac_f32 v237, v58, v138
    v_fmac_f32 v235, v51, v107
    v_fmac_f32 v237, v59, v139
    v_fmac_f32 v235, v52, v108
    v_fmac_f32 v237, v60, v140
    v_fmac_f32 v235, v53, v109
    v_fmac_f32 v237, v61, v141
    v_fmac_f32 v235, v54, v110
    v_fmac_f32 v237, v62, v142
    v_fmac_f32 v235, v55, v111
    v_fmac_f32 v237, v63, v143
    v_mul_f32 v239, v64, v136
    v_mul_f32 v241, v72, v136
    s_setprio 1
    s_waitcnt vmcnt(3) lgkmcnt(0)
    v_mfma_f32_32x32x16_bf16 v[24:39], v[84:87], v[176:179], 0
    ds_read_b64_tr_b16 v[184:185], v246 offset:6144
    ds_read_b64_tr_b16 v[188:189], v247 offset:6144
    v_fmac_f32 v239, v65, v137
    v_fmac_f32 v241, v73, v137
    v_fmac_f32 v239, v66, v138
    v_fmac_f32 v241, v74, v138
    s_mov_b32 m0, s70
    v_mfma_f32_32x32x16_bf16 v[8:23], v[80:83], v[176:179], 0
    buffer_load_dwordx4 v222, s[4:7], s43 offen sc1 lds
    buffer_load_dwordx4 v223, s[72:75], s43 offen offset:1024 sc1 lds
    v_fmac_f32 v239, v67, v139
    v_fmac_f32 v241, v75, v139
    v_fmac_f32 v239, v68, v140
    v_fmac_f32 v241, v76, v140
    v_fmac_f32 v239, v69, v141
    v_mfma_f32_32x32x16_bf16 v[48:63], v[80:83], v[180:183], 0
    s_add_u32 s49, s48, 128
    s_add_u32 s60, s48, 256
    s_cmp_eq_u32 s33, 3
    s_cselect_b32 s46, s44, s47
    s_cselect_b32 s50, s60, s48
    s_sub_u32 s60, s33, 2
    s_cmp_lt_u32 s60, 2
    s_cbranch_scc0 K2_rare_86
K2_back_87:
    v_add_u32 v222, s48, v251
    ds_read2_b32 v[222:223], v222 offset0:1 offset1:3
    v_fmac_f32 v241, v77, v141
    v_fmac_f32 v239, v70, v142
    v_fmac_f32 v241, v78, v142
    v_fmac_f32 v239, v71, v143
    v_fmac_f32 v241, v79, v143
    v_mfma_f32_32x32x16_bf16 v[64:79], v[84:87], v[180:183], 0
    v_permlane32_swap_b32 v234, v236
    v_permlane32_swap_b32 v235, v237
    v_permlane32_swap_b32 v238, v239
    s_waitcnt vmcnt(3) lgkmcnt(1)
    v_mfma_f32_32x32x8_bf16 v[24:39], v[92:93], v[184:185], v[24:39]
    ds_read_b64_tr_b16 v[176:177], v246 offset:0
    ds_read_b64_tr_b16 v[178:179], v246 offset:1024
    ds_read_b64_tr_b16 v[180:181], v247 offset:0
    ds_read_b64_tr_b16 v[182:183], v247 offset:1024
    v_lshl_add_u32 v232, v252, 1, s31
    v_add_f32 v234, v234, v236
    s_mov_b32 m0, s71
    v_mfma_f32_32x32x8_bf16 v[8:23], v[88:89], v[184:185], v[8:23]
    buffer_load_dwordx4 v224, s[4:7], s43 offen sc1 lds
    s_waitcnt lgkmcnt(4)
    v_mad_u32_u16 v222, v222, s39, v248 op_sel:[1,0,0,0]
    v_mad_u32_u16 v223, v223, s39, v248 op_sel:[1,0,0,0]
    v_add_f32 v235, v235, v237
    v_add_f32 v238, -v238, -v239
    v_sub_u32 v239, v232, v233
    v_cvt_pk_bf16_f32 v234, v234, v235
    v_cvt_pk_bf16_f32 v238, v238, v238
    ds_write_b32 v232, v234 offset:0
    ds_write_b16 v239, v238 offset:1280
    v_mfma_f32_32x32x8_bf16 v[48:63], v[88:89], v[188:189], v[48:63]
    v_add_u32 v224, s49, v251
    ds_read2_b32 v[224:225], v224 offset0:1 offset1:3
    v_mul_f32 v236, v24, v160
    v_mul_f32 v238, v32, v160
    v_fmac_f32 v236, v25, v161
    v_fmac_f32 v238, v33, v161
    v_fmac_f32 v236, v26, v162
    v_mfma_f32_32x32x8_bf16 v[64:79], v[92:93], v[188:189], v[64:79]
    s_setprio 0
    v_fmac_f32 v238, v34, v162
    v_fmac_f32 v236, v27, v163
    v_fmac_f32 v238, v35, v163
    v_fmac_f32 v236, v28, v164
    v_fmac_f32 v238, v36, v164
    v_fmac_f32 v236, v29, v165
    v_fmac_f32 v238, v37, v165
    v_fmac_f32 v236, v30, v166
    v_fmac_f32 v238, v38, v166
    v_fmac_f32 v236, v31, v167
    v_fmac_f32 v238, v39, v167
    v_mul_f32 v234, v8, v144
    v_mul_f32 v235, v48, v152
    v_fmac_f32 v234, v9, v145
    v_fmac_f32 v235, v49, v153
    v_fmac_f32 v234, v10, v146
    v_fmac_f32 v235, v50, v154
    v_fmac_f32 v234, v11, v147
    v_fmac_f32 v235, v51, v155
    v_fmac_f32 v234, v12, v148
    v_fmac_f32 v235, v52, v156
    v_fmac_f32 v234, v13, v149
    v_fmac_f32 v235, v53, v157
    v_fmac_f32 v234, v14, v150
    v_fmac_f32 v235, v54, v158
    v_fmac_f32 v234, v15, v151
    v_fmac_f32 v235, v55, v159
    v_mul_f32 v237, v64, v168
    v_mul_f32 v239, v72, v168
    v_fmac_f32 v237, v65, v169
    v_fmac_f32 v239, v73, v169
    v_fmac_f32 v237, v66, v170
    s_setprio 1
    s_waitcnt vmcnt(3) lgkmcnt(3)
    v_mfma_f32_32x32x16_bf16 v[24:39], v[80:83], v[176:179], 0
    ds_read_b64_tr_b16 v[184:185], v246 offset:2048
    ds_read_b64_tr_b16 v[188:189], v247 offset:2048
    v_fmac_f32 v239, v74, v170
    v_fmac_f32 v237, v67, v171
    v_fmac_f32 v239, v75, v171
    v_fmac_f32 v237, v68, v172
    s_mov_b32 m0, s68
    v_mfma_f32_32x32x16_bf16 v[0:15], v[84:87], v[176:179], 0
    buffer_load_dwordx4 v222, s[4:7], s44 offen sc1 lds
    buffer_load_dwordx4 v223, s[72:75], s44 offen offset:1024 sc1 lds
    s_waitcnt lgkmcnt(2)
    v_mad_u32_u16 v224, v224, s39, v248 op_sel:[1,0,0,0]
    v_mad_u32_u16 v225, v225, s39, v248 op_sel:[1,0,0,0]
    v_fmac_f32 v239, v76, v172
    v_fmac_f32 v237, v69, v173
    v_mfma_f32_32x32x16_bf16 v[40:55], v[84:87], v[180:183], 0
    v_add_u32 v226, s50, v251
    ds_read2_b32 v[226:227], v226 offset0:1 offset1:3
    v_fmac_f32 v239, v77, v173
    v_fmac_f32 v237, v70, v174
    v_fmac_f32 v239, v78, v174
    v_fmac_f32 v237, v71, v175
    v_fmac_f32 v239, v79, v175
    v_mfma_f32_32x32x16_bf16 v[64:79], v[80:83], v[180:183], 0
    v_permlane32_swap_b32 v234, v240
    v_permlane32_swap_b32 v235, v241
    v_add_f32 v234, v234, v240
    v_add_f32 v235, v235, v241
    s_waitcnt vmcnt(3) lgkmcnt(1)
    v_mfma_f32_32x32x8_bf16 v[24:39], v[88:89], v[184:185], v[24:39]
    ds_read_b64_tr_b16 v[176:177], v246 offset:4096
    ds_read_b64_tr_b16 v[178:179], v246 offset:5120
    ds_read_b64_tr_b16 v[180:181], v247 offset:4096
    ds_read_b64_tr_b16 v[182:183], v247 offset:5120
    v_cvt_pk_bf16_f32 v234, v234, v235
    ds_write_b32 v232, v234 offset:256
    s_mov_b32 m0, s69
    v_mfma_f32_32x32x8_bf16 v[0:15], v[92:93], v[184:185], v[0:15]
    buffer_load_dwordx4 v224, s[4:7], s45 offen sc1 lds
    buffer_load_dwordx4 v225, s[72:75], s45 offen offset:1024 sc1 lds
    s_waitcnt lgkmcnt(5)
    v_mad_u32_u16 v226, v226, s39, v248 op_sel:[1,0,0,0]
    v_mad_u32_u16 v227, v227, s39, v248 op_sel:[1,0,0,0]
    v_mfma_f32_32x32x8_bf16 v[40:55], v[92:93], v[188:189], v[40:55]
    v_mul_f32 v240, v24, v144
    v_fmac_f32 v236, v32, v160
    v_fmac_f32 v240, v25, v145
    v_fmac_f32 v236, v33, v161
    v_fmac_f32 v240, v26, v146
    v_fmac_f32 v236, v34, v162
    v_fmac_f32 v240, v27, v147
    v_mfma_f32_32x32x8_bf16 v[64:79], v[88:89], v[188:189], v[64:79]
    s_setprio 0
    v_fmac_f32 v236, v35, v163
    v_fmac_f32 v240, v28, v148
    v_fmac_f32 v236, v36, v164
    v_fmac_f32 v240, v29, v149
    v_fmac_f32 v236, v37, v165
    v_fmac_f32 v240, v30, v150
    v_fmac_f32 v236, v38, v166
    v_fmac_f32 v240, v31, v151
    v_fmac_f32 v236, v39, v167
    v_mul_f32 v234, v0, v112
    v_mul_f32 v235, v40, v120
    v_fmac_f32 v234, v1, v113
    v_fmac_f32 v235, v41, v121
    v_fmac_f32 v234, v2, v114
    v_fmac_f32 v235, v42, v122
    v_fmac_f32 v234, v3, v115
    v_fmac_f32 v235, v43, v123
    v_fmac_f32 v234, v4, v116
    v_fmac_f32 v235, v44, v124
    v_fmac_f32 v234, v5, v117
    v_fmac_f32 v235, v45, v125
    v_fmac_f32 v234, v6, v118
    v_fmac_f32 v235, v46, v126
    v_fmac_f32 v234, v7, v119
    v_fmac_f32 v235, v47, v127
    s_setprio 1
    s_waitcnt vmcnt(4) lgkmcnt(1)
    v_mfma_f32_32x32x16_bf16 v[24:39], v[80:83], v[176:179], 0
    ds_read_b64_tr_b16 v[184:185], v246 offset:6144
    ds_read_b64_tr_b16 v[188:189], v247 offset:6144
    v_mul_f32 v241, v64, v152
    v_fmac_f32 v237, v72, v168
    v_fmac_f32 v241, v65, v153
    v_fmac_f32 v237, v73, v169
    s_mov_b32 m0, s70
    v_mfma_f32_32x32x16_bf16 v[8:23], v[84:87], v[176:179], v[8:23]
    buffer_load_dwordx4 v226, s[4:7], s46 offen sc1 lds
    buffer_load_dwordx4 v227, s[72:75], s46 offen offset:1024 sc1 lds
    v_fmac_f32 v241, v66, v154
    v_fmac_f32 v237, v74, v170
    v_fmac_f32 v241, v67, v155
    v_fmac_f32 v237, v75, v171
    v_fmac_f32 v241, v68, v156
    v_mfma_f32_32x32x16_bf16 v[48:63], v[84:87], v[180:183], v[48:63]
    v_fmac_f32 v237, v76, v172
    v_fmac_f32 v241, v69, v157
    v_fmac_f32 v237, v77, v173
    v_fmac_f32 v241, v70, v158
    v_fmac_f32 v237, v78, v174
    v_fmac_f32 v241, v71, v159
    v_fmac_f32 v237, v79, v175
    v_mfma_f32_32x32x16_bf16 v[64:79], v[80:83], v[180:183], 0
    v_permlane32_swap_b32 v236, v240
    v_permlane32_swap_b32 v237, v241
    v_add_f32 v236, v236, v240
    v_add_f32 v237, v237, v241
    s_waitcnt vmcnt(4) lgkmcnt(0)
    v_mfma_f32_32x32x8_bf16 v[24:39], v[88:89], v[184:185], v[24:39]
    ds_read_b64_tr_b16 v[176:177], v246 offset:0
    ds_read_b64_tr_b16 v[178:179], v246 offset:1024
    ds_read_b64_tr_b16 v[180:181], v247 offset:0
    ds_read_b64_tr_b16 v[182:183], v247 offset:1024
    v_cvt_pk_bf16_f32 v236, v236, v237
    ds_write_b32 v232, v236 offset:1024
    s_mov_b32 m0, s71
    v_mfma_f32_32x32x8_bf16 v[8:23], v[92:93], v[184:185], v[8:23]
    s_cmp_eq_u32 s33, 4
    s_cbranch_scc1 K2_g4_89
    buffer_load_dwordx4 v224, s[4:7], s47 offen sc1 lds
    buffer_load_dwordx4 v225, s[72:75], s47 offen offset:1024 sc1 lds
K2_back_90:
    s_sub_u32 s26, s48, s29
    s_mov_b32 s29, s48
    s_mov_b32 s30, s3
    s_bfe_u32 s56, s3, 0x40012
    s_cmp_lg_u32 s36, 0
    s_cselect_b32 s56, s56, 0
    v_mfma_f32_32x32x8_bf16 v[48:63], v[92:93], v[188:189], v[48:63]
    s_mov_b32 s32, s31
    s_mov_b32 s31, s35
    v_mul_f32 v236, v24, v144
    v_fma_f32 v238, v32, v160, -v238
    v_fmac_f32 v236, v25, v145
    v_fmac_f32 v238, v33, v161
    v_fmac_f32 v236, v26, v146
    v_mfma_f32_32x32x8_bf16 v[64:79], v[88:89], v[188:189], v[64:79]
    s_setprio 0
    v_fmac_f32 v238, v34, v162
    v_fmac_f32 v236, v27, v147
    v_fmac_f32 v238, v35, v163
    v_fmac_f32 v236, v28, v148
    v_fmac_f32 v238, v36, v164
    v_fmac_f32 v236, v29, v149
    v_fmac_f32 v238, v37, v165
    v_fmac_f32 v236, v30, v150
    v_fmac_f32 v238, v38, v166
    v_fmac_f32 v236, v31, v151
    v_fmac_f32 v238, v39, v167
    v_add_u32 v249, s26, v249
    v_add_u32 v250, s26, v250
    v_mul_f32 v240, v8, v160
    v_fma_f32 v234, v16, v112, -v234
    v_fmac_f32 v240, v9, v161
    v_fmac_f32 v234, v17, v113
    v_fmac_f32 v240, v10, v162
    v_fmac_f32 v234, v18, v114
    v_fmac_f32 v240, v11, v163
    v_fmac_f32 v234, v19, v115
    v_fmac_f32 v240, v12, v164
    v_fmac_f32 v234, v20, v116
    v_fmac_f32 v240, v13, v165
    v_fmac_f32 v234, v21, v117
    v_fmac_f32 v240, v14, v166
    v_fmac_f32 v234, v22, v118
    v_fmac_f32 v240, v15, v167
    v_fmac_f32 v234, v23, v119
    ds_read_b64_tr_b16 v[80:81], v249 offset:0
    ds_read_u16_d16_hi v40, v250 offset:0
    v_mul_f32 v241, v48, v168
    v_fma_f32 v235, v56, v120, -v235
    v_fmac_f32 v241, v49, v169
    v_fmac_f32 v235, v57, v121
    v_fmac_f32 v241, v50, v170
    v_fmac_f32 v235, v58, v122
    v_fmac_f32 v241, v51, v171
    v_fmac_f32 v235, v59, v123
    v_fmac_f32 v241, v52, v172
    v_fmac_f32 v235, v60, v124
    v_fmac_f32 v241, v53, v173
    v_fmac_f32 v235, v61, v125
    v_fmac_f32 v241, v54, v174
    v_fmac_f32 v235, v62, v126
    v_fmac_f32 v241, v55, v175
    v_fmac_f32 v235, v63, v127
    ds_read_b64_tr_b16 v[88:89], v249 offset:512
    ds_read_u16_d16_hi v41, v250 offset:128
    v_mul_f32 v237, v64, v152
    v_fma_f32 v239, v72, v168, -v239
    v_fmac_f32 v237, v65, v153
    v_fmac_f32 v239, v73, v169
    v_fmac_f32 v237, v66, v154
    v_fmac_f32 v239, v74, v170
    v_fmac_f32 v237, v67, v155
    v_fmac_f32 v239, v75, v171
    v_fmac_f32 v237, v68, v156
    v_fmac_f32 v239, v76, v172
    v_fmac_f32 v237, v69, v157
    v_fmac_f32 v239, v77, v173
    v_fmac_f32 v237, v70, v158
    v_fmac_f32 v239, v78, v174
    v_fmac_f32 v237, v71, v159
    v_fmac_f32 v239, v79, v175
    s_cmp_eq_u32 s56, 5
    s_cbranch_scc1 K2_U21
    s_cmp_eq_u32 s56, 6
    s_cbranch_scc1 K2_U3h1
    s_branch K2_DSP1
K2_PAD_SW:
    s_branch K2_HOP
K2_DSP0:
    s_cmp_eq_u32 s56, 4
    s_cbranch_scc1 K2_U20
    s_cmp_eq_u32 s56, 7
    s_cbranch_scc1 K2_U30
    s_cmp_gt_u32 s56, 7
    s_cbranch_scc1 K2_U40
    s_cmp_lg_u32 s56, 0
    s_cbranch_scc1 K2_U10
    s_branch K2_SWITCH
K2_DSP1:
    s_cmp_eq_u32 s56, 4
    s_cbranch_scc1 K2_U2h1
    s_cmp_eq_u32 s56, 7
    s_cbranch_scc1 K2_U31
    s_cmp_gt_u32 s56, 7
    s_cbranch_scc1 K2_U41
    s_cmp_lg_u32 s56, 0
    s_cbranch_scc1 K2_U11
    s_branch K2_TAIL
K2_SWITCH:
    v_lshlrev_b32 v60, 3, v252
    s_mov_b32 s64, 7176192
    buffer_load_dwordx4 v[56:59], v60, s[8:11], s64 offen sc1
    v_permlane32_swap_b32 v236, v234
    v_permlane32_swap_b32 v237, v235
    v_permlane32_swap_b32 v240, v238
    v_permlane32_swap_b32 v241, v239
    v_add_f32 v236, v236, v234
    v_add_f32 v237, v237, v235
    v_add_f32 v240, -v240, -v238
    v_add_f32 v241, -v241, -v239
    s_set_gpr_idx_on s32, gpr_idx(DST)
    s_nop 0
    v_cvt_pk_bf16_f32 v194, v236, v237
    v_cvt_pk_bf16_f32 v195, v240, v241
    s_set_gpr_idx_off
    v_bfe_u32 v61, v253, 22, 6
    v_lshlrev_b32 v62, 21, v252
    s_mov_b32 s58, 264241152
    v_lshlrev_b32 v61, 2, v61
    v_bfi_b32 v62, s58, v62, v253
    ds_bpermute_b32 v253, v61, v62
    v_lshrrev_b32 v254, 6, v252
    v_bfe_u32 v255, v252, 3, 2
    v_lshl_add_u32 v254, v254, 2, v255
    v_mul_u32_u24 v254, 640, v254
    v_bfe_u32 v255, v252, 5, 1
    v_lshl_add_u32 v254, v255, 5, v254
    v_and_b32 v255, 6, v252
    v_lshl_add_u32 v254, v255, 2, v254
    v_add_u32 v254, 152832, v254
    ds_read_b64_tr_b16 v[104:105], v254 offset:0
    ds_read_b64_tr_b16 v[106:107], v254 offset:5120
    ds_read_b64_tr_b16 v[108:109], v254 offset:64
    ds_read_b64_tr_b16 v[110:111], v254 offset:5184
    ds_read_b64_tr_b16 v[120:121], v254 offset:128
    ds_read_b64_tr_b16 v[122:123], v254 offset:5248
    ds_read_b64_tr_b16 v[124:125], v254 offset:192
    ds_read_b64_tr_b16 v[126:127], v254 offset:5312
    ds_read_b64_tr_b16 v[136:137], v254 offset:256
    ds_read_b64_tr_b16 v[138:139], v254 offset:5376
    ds_read_b64_tr_b16 v[140:141], v254 offset:320
    ds_read_b64_tr_b16 v[142:143], v254 offset:5440
    ds_read_b64_tr_b16 v[152:153], v254 offset:384
    ds_read_b64_tr_b16 v[154:155], v254 offset:5504
    ds_read_b64_tr_b16 v[156:157], v254 offset:448
    ds_read_b64_tr_b16 v[158:159], v254 offset:5568
    ds_read_b64_tr_b16 v[168:169], v254 offset:512
    ds_read_b64_tr_b16 v[170:171], v254 offset:5632
    ds_read_b64_tr_b16 v[172:173], v254 offset:576
    ds_read_b64_tr_b16 v[174:175], v254 offset:5696
    s_movk_i32 s40, 128
    s_movk_i32 s41, 384
    s_movk_i32 s42, 640
    s_movk_i32 s43, 896
    v_lshl_add_u32 v254, v252, 1, s53
    v_lshl_add_u32 v232, v252, 1, s35
    v_lshrrev_b32 v233, 6, v252
    v_mul_u32_u24 v233, 126, v233
    s_waitcnt lgkmcnt(15)
    v_lshlrev_b32 v96, 16, v104
    v_and_b32 v97, 0xffff0000, v104
    v_lshlrev_b32 v98, 16, v105
    v_and_b32 v99, 0xffff0000, v105
    v_lshlrev_b32 v100, 16, v106
    v_and_b32 v101, 0xffff0000, v106
    v_lshlrev_b32 v102, 16, v107
    v_and_b32 v103, 0xffff0000, v107
    v_lshlrev_b32 v104, 16, v108
    v_and_b32 v105, 0xffff0000, v108
    v_lshlrev_b32 v106, 16, v109
    v_and_b32 v107, 0xffff0000, v109
    v_lshlrev_b32 v108, 16, v110
    v_and_b32 v109, 0xffff0000, v110
    v_lshlrev_b32 v110, 16, v111
    v_and_b32 v111, 0xffff0000, v111
    s_waitcnt lgkmcnt(12)
    v_lshlrev_b32 v112, 16, v120
    v_and_b32 v113, 0xffff0000, v120
    v_lshlrev_b32 v114, 16, v121
    v_and_b32 v115, 0xffff0000, v121
    v_lshlrev_b32 v116, 16, v122
    v_and_b32 v117, 0xffff0000, v122
    v_lshlrev_b32 v118, 16, v123
    v_and_b32 v119, 0xffff0000, v123
    v_lshlrev_b32 v120, 16, v124
    v_and_b32 v121, 0xffff0000, v124
    v_lshlrev_b32 v122, 16, v125
    v_and_b32 v123, 0xffff0000, v125
    v_lshlrev_b32 v124, 16, v126
    v_and_b32 v125, 0xffff0000, v126
    v_lshlrev_b32 v126, 16, v127
    v_and_b32 v127, 0xffff0000, v127
    s_waitcnt lgkmcnt(8)
    v_lshlrev_b32 v128, 16, v136
    v_and_b32 v129, 0xffff0000, v136
    v_lshlrev_b32 v130, 16, v137
    v_and_b32 v131, 0xffff0000, v137
    v_lshlrev_b32 v132, 16, v138
    v_and_b32 v133, 0xffff0000, v138
    v_lshlrev_b32 v134, 16, v139
    v_and_b32 v135, 0xffff0000, v139
    v_lshlrev_b32 v136, 16, v140
    v_and_b32 v137, 0xffff0000, v140
    v_lshlrev_b32 v138, 16, v141
    v_and_b32 v139, 0xffff0000, v141
    v_lshlrev_b32 v140, 16, v142
    v_and_b32 v141, 0xffff0000, v142
    v_lshlrev_b32 v142, 16, v143
    v_and_b32 v143, 0xffff0000, v143
    s_waitcnt lgkmcnt(4)
    v_lshlrev_b32 v144, 16, v152
    v_and_b32 v145, 0xffff0000, v152
    v_lshlrev_b32 v146, 16, v153
    v_and_b32 v147, 0xffff0000, v153
    v_lshlrev_b32 v148, 16, v154
    v_and_b32 v149, 0xffff0000, v154
    v_lshlrev_b32 v150, 16, v155
    v_and_b32 v151, 0xffff0000, v155
    v_lshlrev_b32 v152, 16, v156
    v_and_b32 v153, 0xffff0000, v156
    v_lshlrev_b32 v154, 16, v157
    v_and_b32 v155, 0xffff0000, v157
    v_lshlrev_b32 v156, 16, v158
    v_and_b32 v157, 0xffff0000, v158
    v_lshlrev_b32 v158, 16, v159
    v_and_b32 v159, 0xffff0000, v159
    s_waitcnt lgkmcnt(0)
    v_lshlrev_b32 v160, 16, v168
    v_and_b32 v161, 0xffff0000, v168
    v_lshlrev_b32 v162, 16, v169
    v_and_b32 v163, 0xffff0000, v169
    v_lshlrev_b32 v164, 16, v170
    v_and_b32 v165, 0xffff0000, v170
    v_lshlrev_b32 v166, 16, v171
    v_and_b32 v167, 0xffff0000, v171
    v_lshlrev_b32 v168, 16, v172
    v_and_b32 v169, 0xffff0000, v172
    v_lshlrev_b32 v170, 16, v173
    v_and_b32 v171, 0xffff0000, v173
    v_lshlrev_b32 v172, 16, v174
    v_and_b32 v173, 0xffff0000, v174
    v_lshlrev_b32 v174, 16, v175
    v_and_b32 v175, 0xffff0000, v175
    s_waitcnt vmcnt(0)
K2_FLGW:
    s_or_b32 s58, s54, s20
    v_xor_b32 v56, s2, v56
    v_xor_b32 v57, s2, v57
    v_xor_b32 v58, s2, v58
    v_xor_b32 v59, s2, v59
    v_or3_b32 v56, v56, v57, v58
    v_or_b32 v56, v56, v59
    v_cmp_ne_u32 vcc, 0, v56
    s_nop 0
    s_cbranch_vccnz K2_FLGR
    s_cmp_eq_u32 s58, 0
    s_cbranch_scc1 K2_FLGY
K2_FLGOK:
    s_cmp_eq_u32 s36, 0
    s_cbranch_scc1 K2_TAIL2
    s_mov_b32 s29, s48
    s_mov_b32 s32, s31
    s_mov_b32 s30, s3
    s_mov_b32 s31, s35
    s_bfe_u32 s56, s3, 0x40012
    s_cmp_eq_u32 s56, 5
    s_cbranch_scc1 K2_U21
    s_cmp_eq_u32 s56, 6
    s_cbranch_scc1 K2_U3h1
    s_branch K2_DSP1
K2_dum_4:
    v_mov_b32 v42, -1
    s_mov_b32 m0, 163312
    s_mov_b64 exec, 1
    buffer_load_dwordx4 v42, s[16:19], 0 offen lds
    buffer_load_dwordx4 v42, s[16:19], 0 offen lds
    s_mov_b64 exec, -1
    s_branch K2_back_6
K2_nul_12:
    s_mov_b32 s58, 63
    s_mov_b32 s36, 0
    s_branch K2_back_15
K2_spin_13:
    s_sub_u32 s27, s27, 1
    s_cbranch_scc1 K2_END
    ds_read_b32 v42, v254
    s_waitcnt lgkmcnt(0)
    s_branch K2_chk_14
K2_dyn_10:
    v_lshl_add_u32 v254, v252, 1, s53
    s_mov_b64 exec, 0x1ff
    ds_add_rtn_u32 v42, v254, v251
    s_mov_b64 exec, -1
    s_waitcnt lgkmcnt(0)
    v_readlane_b32 s58, v42, 8
    s_nop 0
    s_lshr_b32 s58, s58, 4
    s_cmp_lt_u32 s58, s22
    s_cbranch_scc0 K2_nul_12
    v_readlane_b32 s3, v253, s58
    s_nop 0
    s_bfe_u32 s58, s3, 0x60016
    s_and_b32 s59, s58, 7
    s_lshr_b32 s60, s58, 3
K2_chk_14:
    v_readlane_b32 s61, v42, s59
    s_nop 0
    s_cmp_gt_u32 s61, s60
    s_cbranch_scc0 K2_spin_13
K2_back_15:
    s_mov_b32 s34, 1
    s_branch K2_back_11
K2_dum_21:
    v_mov_b32 v42, -1
    s_mov_b32 m0, 163312
    s_mov_b64 exec, 1
    buffer_load_dwordx4 v42, s[16:19], 0 offen lds
    buffer_load_dwordx4 v42, s[16:19], 0 offen lds
    s_mov_b64 exec, -1
    s_branch K2_back_23
K2_nul_27:
    s_mov_b32 s58, 63
    s_mov_b32 s36, 0
    s_branch K2_back_30
K2_spin_28:
    s_sub_u32 s27, s27, 1
    s_cbranch_scc1 K2_END
    ds_read_b32 v42, v254
    s_waitcnt lgkmcnt(0)
    s_branch K2_chk_29
K2_dyn_25:
    v_lshl_add_u32 v254, v252, 1, s53
    s_mov_b64 exec, 0x1ff
    ds_add_rtn_u32 v42, v254, v251
    s_mov_b64 exec, -1
    s_waitcnt lgkmcnt(0)
    v_readlane_b32 s58, v42, 8
    s_nop 0
    s_lshr_b32 s58, s58, 4
    s_cmp_lt_u32 s58, s22
    s_cbranch_scc0 K2_nul_27
    v_readlane_b32 s3, v253, s58
    s_nop 0
    s_bfe_u32 s58, s3, 0x60016
    s_and_b32 s59, s58, 7
    s_lshr_b32 s60, s58, 3
K2_chk_29:
    v_readlane_b32 s61, v42, s59
    s_nop 0
    s_cmp_gt_u32 s61, s60
    s_cbranch_scc0 K2_spin_28
K2_back_30:
    s_mov_b32 s34, 1
    s_branch K2_back_26
K2_dum_36:
    v_mov_b32 v42, -1
    s_mov_b32 m0, 163312
    s_mov_b64 exec, 1
    buffer_load_dwordx4 v42, s[16:19], 0 offen lds
    buffer_load_dwordx4 v42, s[16:19], 0 offen lds
    s_mov_b64 exec, -1
    s_branch K2_back_38
K2_nul_42:
    s_mov_b32 s58, 63
    s_mov_b32 s36, 0
    s_branch K2_back_45
K2_spin_43:
    s_sub_u32 s27, s27, 1
    s_cbranch_scc1 K2_END
    ds_read_b32 v42, v254
    s_waitcnt lgkmcnt(0)
    s_branch K2_chk_44
K2_dyn_40:
    v_lshl_add_u32 v254, v252, 1, s53
    s_mov_b64 exec, 0x1ff
    ds_add_rtn_u32 v42, v254, v251
    s_mov_b64 exec, -1
    s_waitcnt lgkmcnt(0)
    v_readlane_b32 s58, v42, 8
    s_nop 0
    s_lshr_b32 s58, s58, 4
    s_cmp_lt_u32 s58, s22
    s_cbranch_scc0 K2_nul_42
    v_readlane_b32 s3, v253, s58
    s_nop 0
    s_bfe_u32 s58, s3, 0x60016
    s_and_b32 s59, s58, 7
    s_lshr_b32 s60, s58, 3
K2_chk_44:
    v_readlane_b32 s61, v42, s59
    s_nop 0
    s_cmp_gt_u32 s61, s60
    s_cbranch_scc0 K2_spin_43
K2_back_45:
    s_mov_b32 s34, 1
    s_branch K2_back_41
K2_dum_51:
    v_mov_b32 v42, -1
    s_mov_b32 m0, 163312
    s_mov_b64 exec, 1
    buffer_load_dwordx4 v42, s[16:19], 0 offen lds
    buffer_load_dwordx4 v42, s[16:19], 0 offen lds
    s_mov_b64 exec, -1
    s_branch K2_back_53
K2_nul_55:
    s_mov_b32 s3, 949760
    s_mov_b32 s36, 0
    s_branch K2_back_58
K2_spin_56:
    s_sub_u32 s27, s27, 1
    s_cbranch_scc1 K2_END
    ds_read_b32 v42, v254
    s_waitcnt lgkmcnt(0)
    s_branch K2_chk_57
K2_nul_64:
    s_mov_b32 s3, 949760
    s_mov_b32 s36, 0
    s_branch K2_back_67
K2_spin_65:
    s_sub_u32 s27, s27, 1
    s_cbranch_scc1 K2_END
    ds_read_b32 v42, v254
    s_waitcnt lgkmcnt(0)
    s_branch K2_chk_66
K2_nul_73:
    s_mov_b32 s3, 949760
    s_mov_b32 s36, 0
    s_branch K2_back_76
K2_spin_74:
    s_sub_u32 s27, s27, 1
    s_cbranch_scc1 K2_END
    ds_read_b32 v42, v254
    s_waitcnt lgkmcnt(0)
    s_branch K2_chk_75
K2_nul_82:
    s_mov_b32 s3, 949760
    s_mov_b32 s36, 0
    s_branch K2_back_85
K2_spin_83:
    s_sub_u32 s27, s27, 1
    s_cbranch_scc1 K2_END
    ds_read_b32 v42, v254
    s_waitcnt lgkmcnt(0)
    s_branch K2_chk_84
K2_PAD_TL:
    s_branch K2_HOP
K2_TAIL2:
    v_lshlrev_b32 v229, 3, v252
    s_mul_i32 s58, s20, 20480
    s_add_u32 s58, s58, 6946816
    s_mul_i32 s59, s20, 8224
    buffer_load_dwordx4 v[96:99], v229, s[8:11], s58 offen offset:0 sc1
    buffer_load_dwordx4 v[100:103], v229, s[8:11], s58 offen offset:1024 sc1
    buffer_load_dwordx4 v[104:107], v229, s[8:11], s58 offen offset:2048 sc1
    buffer_load_dwordx4 v[108:111], v229, s[8:11], s58 offen offset:3072 sc1
    s_add_u32 s58, s58, 4096
    buffer_load_dwordx4 v[128:131], v229, s[8:11], s58 offen offset:0 sc1
    buffer_load_dwordx4 v[132:135], v229, s[8:11], s58 offen offset:1024 sc1
    buffer_load_dwordx4 v[136:139], v229, s[8:11], s58 offen offset:2048 sc1
    buffer_load_dwordx4 v[140:143], v229, s[8:11], s58 offen offset:3072 sc1
    v_lshl_add_u32 v228, v252, 1, s59
    v_lshrrev_b32 v226, 6, v252
    v_mul_u32_u24 v226, 126, v226
    v_sub_u32 v226, v228, v226
    s_branch K2_TAIL3
K2_TAIL:
    v_lshlrev_b32 v229, 3, v252
    s_mul_i32 s58, s20, 20480
    s_add_u32 s58, s58, 6946816
    s_mul_i32 s59, s20, 8224
    buffer_load_dwordx4 v[96:99], v229, s[8:11], s58 offen offset:0 sc1
    v_permlane32_swap_b32 v236, v234
    v_permlane32_swap_b32 v237, v235
    buffer_load_dwordx4 v[100:103], v229, s[8:11], s58 offen offset:1024 sc1
    v_permlane32_swap_b32 v240, v238
    v_permlane32_swap_b32 v241, v239
    buffer_load_dwordx4 v[104:107], v229, s[8:11], s58 offen offset:2048 sc1
    v_add_f32 v236, v236, v234
    v_add_f32 v237, v237, v235
    buffer_load_dwordx4 v[108:111], v229, s[8:11], s58 offen offset:3072 sc1
    v_add_f32 v240, -v240, -v238
    v_add_f32 v241, -v241, -v239
    s_add_u32 s58, s58, 4096
    buffer_load_dwordx4 v[128:131], v229, s[8:11], s58 offen offset:0 sc1
    v_cvt_pk_bf16_f32 v236, v236, v237
    v_cvt_pk_bf16_f32 v240, v240, v241
    buffer_load_dwordx4 v[132:135], v229, s[8:11], s58 offen offset:1024 sc1
    ds_write2st64_b32 v232, v236, v240 offset0:2 offset1:3
    v_lshl_add_u32 v228, v252, 1, s59
    buffer_load_dwordx4 v[136:139], v229, s[8:11], s58 offen offset:2048 sc1
    v_lshrrev_b32 v226, 6, v252
    v_mul_u32_u24 v226, 126, v226
    buffer_load_dwordx4 v[140:143], v229, s[8:11], s58 offen offset:3072 sc1
    v_sub_u32 v226, v228, v226
K2_TAIL3:
    s_waitcnt vmcnt(8)
    ds_write2st64_b32 v228, v192, v193 offset0:0 offset1:1
    ds_write2st64_b32 v228, v194, v195 offset0:2 offset1:3
    s_add_u32 s58, s58, 4096
    buffer_load_dwordx4 v[112:115], v229, s[8:11], s58 offen offset:0 sc1
    v_bfe_u32 v48, v252, 1, 4
    v_lshrrev_b32 v49, 5, v252
    ds_write_b16 v226, v197 offset:1280
    ds_write2st64_b32 v228, v196, v198 offset0:4 offset1:6
    buffer_load_dwordx4 v[116:119], v229, s[8:11], s58 offen offset:1024 sc1
    v_lshrrev_b32 v55, 3, v48
    v_lshlrev_b32 v52, 4, v49
    ds_write2st64_b32 v228, v199, v200 offset0:7 offset1:8
    ds_write2st64_b32 v228, v201, v202 offset0:9 offset1:10
    buffer_load_dwordx4 v[120:123], v229, s[8:11], s58 offen offset:2048 sc1
    v_and_b32 v54, 7, v48
    v_and_b32 v50, 7, v48
    ds_write_b16 v226, v203 offset:2816
    ds_write2st64_b32 v228, v204, v205 offset0:12 offset1:13
    buffer_load_dwordx4 v[124:127], v229, s[8:11], s58 offen offset:3072 sc1
    v_mul_u32_u24 v50, 8224, v50
    v_mul_u32_u24 v51, 1536, v55
    ds_write2st64_b32 v228, v206, v207 offset0:14 offset1:15
    ds_write2st64_b32 v228, v208, v210 offset0:16 offset1:18
    s_add_u32 s58, s58, 4096
    buffer_load_dwordx4 v[144:147], v229, s[8:11], s58 offen offset:0 sc1
    v_add_u32 v50, v50, v51
    v_add_u32 v222, v50, v52
    ds_write_b16 v226, v209 offset:4352
    ds_write2st64_b32 v228, v211, v212 offset0:19 offset1:20
    buffer_load_dwordx4 v[148:151], v229, s[8:11], s58 offen offset:1024 sc1
    v_mul_u32_u24 v51, 8224, v54
    v_add_u32 v232, v51, v52
    ds_write2st64_b32 v228, v213, v214 offset0:21 offset1:22
    ds_write2st64_b32 v228, v216, v217 offset0:24 offset1:25
    buffer_load_dwordx4 v[152:155], v229, s[8:11], s58 offen offset:2048 sc1
    v_lshl_add_u32 v247, v55, 8, v232
    v_mul_u32_u24 v51, 2080, v48
    ds_write_b16 v226, v215 offset:5888
    ds_write2st64_b32 v228, v218, v219 offset0:26 offset1:27
    buffer_load_dwordx4 v[156:159], v229, s[8:11], s58 offen offset:3072 sc1
    s_mov_b32 s60, 65536
    v_add3_u32 v223, v51, v52, s60
    ds_write_b32 v228, v220 offset:7168
    ds_write_b16 v226, v221 offset:7424
    s_add_u32 s58, s58, 4096
    buffer_load_dwordx4 v[160:163], v229, s[8:11], s58 offen offset:0 sc1
    v_mul_u32_u24 v51, 2080, v54
    s_mov_b32 s60, 132096
    buffer_load_dwordx4 v[164:167], v229, s[8:11], s58 offen offset:1024 sc1
    v_add3_u32 v225, v51, v52, s60
    v_lshl_add_u32 v248, v55, 8, v225
    buffer_load_dwordx4 v[168:171], v229, s[8:11], s58 offen offset:2048 sc1
    s_lshl_b32 s60, s20, 5
    v_lshl_add_u32 v49, v49, 3, s60
    buffer_load_dwordx4 v[172:175], v229, s[8:11], s58 offen offset:3072 sc1
    s_mov_b32 s60, 65536
    v_add3_u32 v255, v51, v49, s60
    v_lshl_add_u32 v246, v55, 9, v255
    v_bfe_u32 v53, v48, 2, 1
    v_lshl_add_u32 v49, v53, 4, v49
    v_add_u32 v254, v50, v49
    s_and_b32 s64, s55, s28
    s_waitcnt lgkmcnt(0)
    s_barrier
    s_cmp_eq_u32 s64, 0
    s_cbranch_scc1 K2_MULTI
    s_setprio 3
    ds_read_b128 v[48:51], v222 offset:0
    ds_read_b128 v[52:55], v222 offset:64
    ds_read_b128 v[56:59], v222 offset:640
    ds_read_b128 v[60:63], v222 offset:704
    ds_read_b128 v[64:67], v223 offset:0
    ds_read_b128 v[68:71], v223 offset:64
    ds_read_b128 v[72:75], v223 offset:640
    ds_read_b128 v[76:79], v223 offset:704
    ds_read_b128 v[80:83], v222 offset:3072
    ds_read_b128 v[84:87], v222 offset:3136
    ds_read_b128 v[88:91], v222 offset:3712
    s_waitcnt vmcnt(19) lgkmcnt(9)
    v_mfma_f32_16x16x32_bf16 v[0:3], v[96:99], v[48:51], 0
    ds_read_b128 v[92:95], v222 offset:3776
    s_waitcnt vmcnt(18)
    v_mfma_f32_16x16x32_bf16 v[0:3], v[100:103], v[52:55], v[0:3]
    ds_read_b128 v[48:51], v223 offset:33280
    s_waitcnt vmcnt(17) lgkmcnt(9)
    v_mfma_f32_16x16x32_bf16 v[0:3], v[104:107], v[56:59], v[0:3]
    s_bfe_u32 s60, s20, 0x10002
    s_lshl_b32 s60, s60, 4
    ds_read_b128 v[52:55], v223 offset:33344
    s_waitcnt vmcnt(16)
    v_mfma_f32_16x16x32_bf16 v[0:3], v[108:111], v[60:63], v[0:3]
    s_add_u32 s59, s59, s60
    v_add_u32 v228, s59, v229
    ds_read_b128 v[56:59], v223 offset:33920
    s_waitcnt vmcnt(15) lgkmcnt(9)
    v_mfma_f32_16x16x32_bf16 v[0:3], v[128:131], v[64:67], v[0:3]
    s_mul_i32 s60, s20, 2080
    s_add_u32 s60, s60, 65536
    ds_read_b128 v[60:63], v223 offset:33984
    s_waitcnt vmcnt(14)
    v_mfma_f32_16x16x32_bf16 v[0:3], v[132:135], v[68:71], v[0:3]
    v_add_u32 v249, s60, v229
    s_mov_b32 s63, 0xbfb8aa3b
    ds_read_b128 v[64:67], v232 offset:6144
    s_waitcnt vmcnt(13) lgkmcnt(9)
    v_mfma_f32_16x16x32_bf16 v[0:3], v[136:139], v[72:75], v[0:3]
    s_add_u32 s40, s20, s21
    s_lshl_b32 s40, s40, 10
    ds_read_b128 v[68:71], v232 offset:6208
    s_waitcnt vmcnt(12)
    v_mfma_f32_16x16x32_bf16 v[0:3], v[140:143], v[76:79], v[0:3]
    s_add_u32 s41, s40, 8192
    s_add_u32 s42, s40, 16384
    ds_read_b128 v[72:75], v232 offset:6784
    s_waitcnt lgkmcnt(9)
    v_mfma_f32_16x16x32_bf16 v[16:19], v[96:99], v[80:83], 0
    s_add_u32 s43, s40, 24576
    s_add_u32 s44, s40, 32768
    ds_read_b128 v[76:79], v232 offset:6848
    v_mfma_f32_16x16x32_bf16 v[16:19], v[100:103], v[84:87], v[16:19]
    ds_read_b128 v[80:83], v225 offset:0
    s_waitcnt lgkmcnt(9)
    v_mfma_f32_16x16x32_bf16 v[16:19], v[104:107], v[88:91], v[16:19]
    ds_read_b128 v[84:87], v225 offset:64
    v_mfma_f32_16x16x32_bf16 v[16:19], v[108:111], v[92:95], v[16:19]
    v_mul_f32 v204, s63, v0
    v_mul_f32 v205, s63, v1
    ds_read_b128 v[88:91], v225 offset:640
    s_waitcnt lgkmcnt(9)
    v_mfma_f32_16x16x32_bf16 v[16:19], v[128:131], v[48:51], v[16:19]
    v_mul_f32 v206, s63, v2
    ds_read_b128 v[92:95], v225 offset:704
    v_mfma_f32_16x16x32_bf16 v[16:19], v[132:135], v[52:55], v[16:19]
    v_mul_f32 v207, s63, v3
    ds_read_b128 v[48:51], v222 offset:128
    s_waitcnt lgkmcnt(9)
    v_mfma_f32_16x16x32_bf16 v[16:19], v[136:139], v[56:59], v[16:19]
    v_exp_f32 v204, v204
    ds_read_b128 v[52:55], v222 offset:1280
    v_mfma_f32_16x16x32_bf16 v[16:19], v[140:143], v[60:63], v[16:19]
    v_exp_f32 v205, v205
    ds_read_b128 v[56:59], v222 offset:384
    s_waitcnt lgkmcnt(9)
    v_mfma_f32_16x16x32_bf16 v[32:35], v[96:99], v[64:67], 0
    v_exp_f32 v206, v206
    ds_read_b128 v[60:63], v222 offset:192
    v_mfma_f32_16x16x32_bf16 v[32:35], v[100:103], v[68:71], v[32:35]
    v_exp_f32 v207, v207
    s_setprio 2
    ds_read_b128 v[64:67], v222 offset:1344
    s_waitcnt lgkmcnt(9)
    v_mfma_f32_16x16x32_bf16 v[32:35], v[104:107], v[72:75], v[32:35]
    v_add_f32 v204, 1.0, v204
    ds_read_b128 v[68:71], v222 offset:448
    v_mfma_f32_16x16x32_bf16 v[32:35], v[108:111], v[76:79], v[32:35]
    v_add_f32 v205, 1.0, v205
    v_add_f32 v206, 1.0, v206
    ds_read_b128 v[72:75], v222 offset:256
    s_waitcnt lgkmcnt(9)
    v_mfma_f32_16x16x32_bf16 v[32:35], v[128:131], v[80:83], v[32:35]
    v_add_f32 v207, 1.0, v207
    ds_read_b128 v[76:79], v222 offset:1152
    v_mfma_f32_16x16x32_bf16 v[32:35], v[132:135], v[84:87], v[32:35]
    v_rcp_f32 v204, v204
    ds_read_b128 v[80:83], v222 offset:512
    s_waitcnt lgkmcnt(9)
    v_mfma_f32_16x16x32_bf16 v[32:35], v[136:139], v[88:91], v[32:35]
    v_rcp_f32 v205, v205
    ds_read_b128 v[84:87], v222 offset:320
    v_mfma_f32_16x16x32_bf16 v[32:35], v[140:143], v[92:95], v[32:35]
    v_rcp_f32 v206, v206
    ds_read_b128 v[88:91], v222 offset:1216
    s_waitcnt vmcnt(11) lgkmcnt(9)
    v_mfma_f32_16x16x32_bf16 v[4:7], v[112:115], v[48:51], 0
    v_rcp_f32 v207, v207
    ds_read_b128 v[92:95], v222 offset:576
    v_mfma_f32_16x16x32_bf16 v[8:11], v[112:115], v[52:55], 0
    v_cvt_pk_bf16_f32 v176, v0, v1
    ds_read_b128 v[48:51], v222 offset:768
    s_waitcnt lgkmcnt(9)
    v_mfma_f32_16x16x32_bf16 v[12:15], v[112:115], v[56:59], 0
    v_cvt_pk_bf16_f32 v177, v2, v3
    ds_read_b128 v[52:55], v222 offset:896
    s_waitcnt vmcnt(10)
    v_mfma_f32_16x16x32_bf16 v[4:7], v[116:119], v[60:63], v[4:7]
    v_mul_f32 v208, s63, v16
    v_mul_f32 v209, s63, v17
    ds_read_b128 v[56:59], v222 offset:1024
    s_waitcnt lgkmcnt(9)
    v_mfma_f32_16x16x32_bf16 v[8:11], v[116:119], v[64:67], v[8:11]
    v_mul_f32 v210, s63, v18
    ds_read_b128 v[60:63], v222 offset:832
    v_mfma_f32_16x16x32_bf16 v[12:15], v[116:119], v[68:71], v[12:15]
    v_mul_f32 v211, s63, v19
    ds_read_b128 v[64:67], v222 offset:960
    s_waitcnt vmcnt(9) lgkmcnt(9)
    v_mfma_f32_16x16x32_bf16 v[4:7], v[120:123], v[72:75], v[4:7]
    v_exp_f32 v208, v208
    ds_read_b128 v[68:71], v222 offset:1088
    v_mfma_f32_16x16x32_bf16 v[8:11], v[120:123], v[76:79], v[8:11]
    v_exp_f32 v209, v209
    ds_read_b128 v[72:75], v223 offset:128
    s_waitcnt lgkmcnt(9)
    v_mfma_f32_16x16x32_bf16 v[12:15], v[120:123], v[80:83], v[12:15]
    v_exp_f32 v210, v210
    ds_read_b128 v[76:79], v223 offset:1280
    s_waitcnt vmcnt(8)
    v_mfma_f32_16x16x32_bf16 v[4:7], v[124:127], v[84:87], v[4:7]
    v_exp_f32 v211, v211
    ds_read_b128 v[80:83], v223 offset:384
    s_waitcnt lgkmcnt(9)
    v_mfma_f32_16x16x32_bf16 v[8:11], v[124:127], v[88:91], v[8:11]
    v_add_f32 v208, 1.0, v208
    ds_read_b128 v[84:87], v223 offset:192
    v_mfma_f32_16x16x32_bf16 v[12:15], v[124:127], v[92:95], v[12:15]
    v_add_f32 v209, 1.0, v209
    v_add_f32 v210, 1.0, v210
    ds_read_b128 v[88:91], v223 offset:1344
    s_waitcnt vmcnt(7) lgkmcnt(9)
    v_mfma_f32_16x16x32_bf16 v[4:7], v[144:147], v[48:51], v[4:7]
    v_add_f32 v211, 1.0, v211
    s_setprio 1
    ds_read_b128 v[92:95], v223 offset:448
    v_mfma_f32_16x16x32_bf16 v[8:11], v[144:147], v[52:55], v[8:11]
    v_rcp_f32 v208, v208
    ds_read_b128 v[48:51], v223 offset:256
    s_waitcnt lgkmcnt(9)
    v_mfma_f32_16x16x32_bf16 v[12:15], v[144:147], v[56:59], v[12:15]
    v_rcp_f32 v209, v209
    ds_read_b128 v[52:55], v223 offset:1152
    s_waitcnt vmcnt(6)
    v_mfma_f32_16x16x32_bf16 v[4:7], v[148:151], v[60:63], v[4:7]
    v_rcp_f32 v210, v210
    ds_read_b128 v[56:59], v223 offset:512
    s_waitcnt lgkmcnt(9)
    v_mfma_f32_16x16x32_bf16 v[8:11], v[148:151], v[64:67], v[8:11]
    v_rcp_f32 v211, v211
    ds_read_b128 v[60:63], v223 offset:320
    v_mfma_f32_16x16x32_bf16 v[12:15], v[148:151], v[68:71], v[12:15]
K2_PAD_T2:
    s_cbranch_execz K2_HOP
    v_cvt_pk_bf16_f32 v184, v16, v17
    ds_read_b128 v[64:67], v223 offset:1216
    s_waitcnt vmcnt(5) lgkmcnt(9)
    v_mfma_f32_16x16x32_bf16 v[4:7], v[152:155], v[72:75], v[4:7]
    v_cvt_pk_bf16_f32 v185, v18, v19
    ds_read_b128 v[68:71], v223 offset:576
    v_mfma_f32_16x16x32_bf16 v[8:11], v[152:155], v[76:79], v[8:11]
    v_mul_f32 v212, s63, v32
    v_mul_f32 v213, s63, v33
    ds_read_b128 v[72:75], v223 offset:768
    s_waitcnt lgkmcnt(9)
    v_mfma_f32_16x16x32_bf16 v[12:15], v[152:155], v[80:83], v[12:15]
    v_mul_f32 v214, s63, v34
    ds_read_b128 v[76:79], v223 offset:896
    s_waitcnt vmcnt(4)
    v_mfma_f32_16x16x32_bf16 v[4:7], v[156:159], v[84:87], v[4:7]
    v_mul_f32 v215, s63, v35
    ds_read_b128 v[80:83], v223 offset:1024
    s_waitcnt lgkmcnt(9)
    v_mfma_f32_16x16x32_bf16 v[8:11], v[156:159], v[88:91], v[8:11]
    v_exp_f32 v212, v212
    ds_read_b128 v[84:87], v223 offset:832
    v_mfma_f32_16x16x32_bf16 v[12:15], v[156:159], v[92:95], v[12:15]
    v_exp_f32 v213, v213
    ds_read_b128 v[88:91], v223 offset:960
    s_waitcnt vmcnt(3) lgkmcnt(9)
    v_mfma_f32_16x16x32_bf16 v[4:7], v[160:163], v[48:51], v[4:7]
    v_exp_f32 v214, v214
    ds_read_b128 v[92:95], v223 offset:1088
    v_mfma_f32_16x16x32_bf16 v[8:11], v[160:163], v[52:55], v[8:11]
    v_exp_f32 v215, v215
    ds_read_b128 v[48:51], v222 offset:3200
    s_waitcnt lgkmcnt(9)
    v_mfma_f32_16x16x32_bf16 v[12:15], v[160:163], v[56:59], v[12:15]
    v_add_f32 v212, 1.0, v212
    ds_read_b128 v[52:55], v222 offset:4352
    s_waitcnt vmcnt(2)
    v_mfma_f32_16x16x32_bf16 v[4:7], v[164:167], v[60:63], v[4:7]
    v_add_f32 v213, 1.0, v213
    v_add_f32 v214, 1.0, v214
    ds_read_b128 v[56:59], v222 offset:3456
    s_waitcnt lgkmcnt(9)
    v_mfma_f32_16x16x32_bf16 v[8:11], v[164:167], v[64:67], v[8:11]
    v_add_f32 v215, 1.0, v215
    ds_read_b128 v[60:63], v222 offset:3264
    v_mfma_f32_16x16x32_bf16 v[12:15], v[164:167], v[68:71], v[12:15]
    v_rcp_f32 v212, v212
    s_setprio 0
    ds_read_b128 v[64:67], v222 offset:4416
    s_waitcnt vmcnt(1) lgkmcnt(9)
    v_mfma_f32_16x16x32_bf16 v[4:7], v[168:171], v[72:75], v[4:7]
    v_rcp_f32 v213, v213
    ds_read_b128 v[68:71], v222 offset:3520
    v_mfma_f32_16x16x32_bf16 v[8:11], v[168:171], v[76:79], v[8:11]
    v_rcp_f32 v214, v214
    ds_read_b128 v[72:75], v222 offset:3328
    s_waitcnt lgkmcnt(9)
    v_mfma_f32_16x16x32_bf16 v[12:15], v[168:171], v[80:83], v[12:15]
    v_rcp_f32 v215, v215
    ds_read_b128 v[76:79], v222 offset:4224
    s_waitcnt vmcnt(0)
    v_mfma_f32_16x16x32_bf16 v[4:7], v[172:175], v[84:87], v[4:7]
    v_cvt_pk_bf16_f32 v220, v32, v33
    ds_read_b128 v[80:83], v222 offset:3584
    s_waitcnt lgkmcnt(9)
    v_mfma_f32_16x16x32_bf16 v[8:11], v[172:175], v[88:91], v[8:11]
    v_cvt_pk_bf16_f32 v221, v34, v35
    ds_read_b128 v[84:87], v222 offset:3392
    v_mfma_f32_16x16x32_bf16 v[12:15], v[172:175], v[92:95], v[12:15]
    ds_read_b128 v[88:91], v222 offset:4288
    s_waitcnt lgkmcnt(9)
    v_mfma_f32_16x16x32_bf16 v[20:23], v[112:115], v[48:51], 0
    ds_read_b128 v[92:95], v222 offset:3648
    v_mfma_f32_16x16x32_bf16 v[24:27], v[112:115], v[52:55], 0
    ds_read_b128 v[48:51], v222 offset:3840
    s_waitcnt lgkmcnt(9)
    v_mfma_f32_16x16x32_bf16 v[28:31], v[112:115], v[56:59], 0
    s_barrier
    s_setprio 3
    ds_read_b128 v[52:55], v222 offset:3968
    v_mfma_f32_16x16x32_bf16 v[20:23], v[116:119], v[60:63], v[20:23]
    v_mul_f32 v4, v4, v204
    ds_read_b128 v[56:59], v222 offset:4096
    s_waitcnt lgkmcnt(9)
    v_mfma_f32_16x16x32_bf16 v[24:27], v[116:119], v[64:67], v[24:27]
    v_mul_f32 v5, v5, v205
    ds_read_b128 v[60:63], v222 offset:3904
    v_mfma_f32_16x16x32_bf16 v[28:31], v[116:119], v[68:71], v[28:31]
    v_mul_f32 v6, v6, v206
    ds_read_b128 v[64:67], v222 offset:4032
    s_waitcnt lgkmcnt(9)
    v_mfma_f32_16x16x32_bf16 v[20:23], v[120:123], v[72:75], v[20:23]
    v_mul_f32 v7, v7, v207
    ds_read_b128 v[68:71], v222 offset:4160
    v_mfma_f32_16x16x32_bf16 v[24:27], v[120:123], v[76:79], v[24:27]
    v_cvt_pk_bf16_f32 v178, v4, v5
    ds_read_b128 v[72:75], v223 offset:33408
    s_waitcnt lgkmcnt(9)
    v_mfma_f32_16x16x32_bf16 v[28:31], v[120:123], v[80:83], v[28:31]
    v_cvt_pk_bf16_f32 v179, v6, v7
    ds_read_b128 v[76:79], v223 offset:34560
    v_mfma_f32_16x16x32_bf16 v[20:23], v[124:127], v[84:87], v[20:23]
    v_mul_f32 v8, v8, v204
    ds_read_b128 v[80:83], v223 offset:33664
    s_waitcnt lgkmcnt(9)
    v_mfma_f32_16x16x32_bf16 v[24:27], v[124:127], v[88:91], v[24:27]
    v_mul_f32 v9, v9, v205
    ds_read_b128 v[84:87], v223 offset:33472
    v_mfma_f32_16x16x32_bf16 v[28:31], v[124:127], v[92:95], v[28:31]
    v_mul_f32 v10, v10, v206
    ds_read_b128 v[88:91], v223 offset:34624
    s_waitcnt lgkmcnt(9)
    v_mfma_f32_16x16x32_bf16 v[20:23], v[144:147], v[48:51], v[20:23]
    v_mul_f32 v11, v11, v207
    s_setprio 2
    ds_read_b128 v[92:95], v223 offset:33728
    v_mfma_f32_16x16x32_bf16 v[24:27], v[144:147], v[52:55], v[24:27]
    v_cvt_pk_bf16_f32 v180, v8, v9
    ds_read_b128 v[48:51], v223 offset:33536
    s_waitcnt lgkmcnt(9)
    v_mfma_f32_16x16x32_bf16 v[28:31], v[144:147], v[56:59], v[28:31]
    v_cvt_pk_bf16_f32 v181, v10, v11
    ds_read_b128 v[52:55], v223 offset:34432
    v_mfma_f32_16x16x32_bf16 v[20:23], v[148:151], v[60:63], v[20:23]
    v_mul_f32 v12, v12, v204
    ds_read_b128 v[56:59], v223 offset:33792
    s_waitcnt lgkmcnt(9)
    v_mfma_f32_16x16x32_bf16 v[24:27], v[148:151], v[64:67], v[24:27]
    v_mul_f32 v13, v13, v205
    ds_read_b128 v[60:63], v223 offset:33600
    v_mfma_f32_16x16x32_bf16 v[28:31], v[148:151], v[68:71], v[28:31]
    v_mul_f32 v14, v14, v206
    ds_read_b128 v[64:67], v223 offset:34496
    s_waitcnt lgkmcnt(9)
    v_mfma_f32_16x16x32_bf16 v[20:23], v[152:155], v[72:75], v[20:23]
    v_mul_f32 v15, v15, v207
    ds_read_b128 v[68:71], v223 offset:33856
    v_mfma_f32_16x16x32_bf16 v[24:27], v[152:155], v[76:79], v[24:27]
    v_cvt_pk_bf16_f32 v182, v12, v13
    ds_read_b128 v[72:75], v223 offset:34048
    s_waitcnt lgkmcnt(9)
    v_mfma_f32_16x16x32_bf16 v[28:31], v[152:155], v[80:83], v[28:31]
    v_cvt_pk_bf16_f32 v183, v14, v15
    ds_read_b128 v[76:79], v223 offset:34176
    v_mfma_f32_16x16x32_bf16 v[20:23], v[156:159], v[84:87], v[20:23]
    ds_write_b64 v254, v[176:177] offset:0
    ds_write_b64 v254, v[178:179] offset:256
    ds_write_b64 v254, v[180:181] offset:512
    ds_write_b64 v254, v[182:183] offset:768
    ds_write_b64 v255, v[220:221] offset:0
    ds_read_b128 v[80:83], v223 offset:34304
    s_waitcnt lgkmcnt(14)
    v_mfma_f32_16x16x32_bf16 v[24:27], v[156:159], v[88:91], v[24:27]
    ds_read_b128 v[84:87], v223 offset:34112
    v_mfma_f32_16x16x32_bf16 v[28:31], v[156:159], v[92:95], v[28:31]
    s_setprio 1
    ds_read_b128 v[88:91], v223 offset:34240
    s_waitcnt lgkmcnt(14)
    v_mfma_f32_16x16x32_bf16 v[20:23], v[160:163], v[48:51], v[20:23]
    ds_read_b128 v[92:95], v223 offset:34368
    v_mfma_f32_16x16x32_bf16 v[24:27], v[160:163], v[52:55], v[24:27]
    ds_read_b128 v[48:51], v247 offset:6272
    s_waitcnt lgkmcnt(14)
    v_mfma_f32_16x16x32_bf16 v[28:31], v[160:163], v[56:59], v[28:31]
    ds_read_b128 v[52:55], v232 offset:7424
    v_mfma_f32_16x16x32_bf16 v[20:23], v[164:167], v[60:63], v[20:23]
    ds_read_b128 v[56:59], v247 offset:6336
    s_waitcnt lgkmcnt(14)
    v_mfma_f32_16x16x32_bf16 v[24:27], v[164:167], v[64:67], v[24:27]
    ds_read_b128 v[60:63], v232 offset:7488
    v_mfma_f32_16x16x32_bf16 v[28:31], v[164:167], v[68:71], v[28:31]
    ds_read_b128 v[64:67], v247 offset:6400
    s_waitcnt lgkmcnt(14)
    v_mfma_f32_16x16x32_bf16 v[20:23], v[168:171], v[72:75], v[20:23]
    ds_read_b128 v[68:71], v232 offset:7296
    v_mfma_f32_16x16x32_bf16 v[24:27], v[168:171], v[76:79], v[24:27]
    ds_read_b128 v[72:75], v247 offset:6464
    s_waitcnt lgkmcnt(9)
    v_mfma_f32_16x16x32_bf16 v[28:31], v[168:171], v[80:83], v[28:31]
    ds_read_b128 v[76:79], v232 offset:7360
    v_mfma_f32_16x16x32_bf16 v[20:23], v[172:175], v[84:87], v[20:23]
    s_setprio 0
    ds_read_b128 v[80:83], v247 offset:6912
    s_waitcnt lgkmcnt(9)
    v_mfma_f32_16x16x32_bf16 v[24:27], v[172:175], v[88:91], v[24:27]
    ds_read_b128 v[84:87], v232 offset:7040
    v_mfma_f32_16x16x32_bf16 v[28:31], v[172:175], v[92:95], v[28:31]
    ds_read_b128 v[88:91], v247 offset:6976
    s_waitcnt lgkmcnt(9)
    v_mfma_f32_16x16x32_bf16 v[36:39], v[112:115], v[48:51], 0
    ds_read_b128 v[92:95], v232 offset:7104
    v_mfma_f32_16x16x32_bf16 v[40:43], v[112:115], v[52:55], 0
    ds_read_b128 v[48:51], v248 offset:128
    s_waitcnt lgkmcnt(9)
    v_mfma_f32_16x16x32_bf16 v[36:39], v[116:119], v[56:59], v[36:39]
    s_barrier
    ds_read_b128 v[192:195], v228 offset:0
    ds_read_b128 v[196:199], v228 offset:1536
    s_setprio 3
    ds_read_b128 v[52:55], v225 offset:1280
    v_mfma_f32_16x16x32_bf16 v[40:43], v[116:119], v[60:63], v[40:43]
    v_mul_f32 v20, v20, v208
    v_mul_f32 v21, v21, v209
    ds_read_b128 v[56:59], v248 offset:192
    s_waitcnt lgkmcnt(11)
    v_mfma_f32_16x16x32_bf16 v[36:39], v[120:123], v[64:67], v[36:39]
    v_mul_f32 v22, v22, v210
    ds_read_b128 v[60:63], v225 offset:1344
    v_mfma_f32_16x16x32_bf16 v[40:43], v[120:123], v[68:71], v[40:43]
    v_mul_f32 v23, v23, v211
    ds_read_b128 v[64:67], v248 offset:256
    s_waitcnt lgkmcnt(11)
    v_mfma_f32_16x16x32_bf16 v[36:39], v[124:127], v[72:75], v[36:39]
    v_cvt_pk_bf16_f32 v186, v20, v21
    ds_read_b128 v[68:71], v225 offset:1152
    v_mfma_f32_16x16x32_bf16 v[40:43], v[124:127], v[76:79], v[40:43]
    v_cvt_pk_bf16_f32 v187, v22, v23
    ds_read_b128 v[72:75], v248 offset:320
    s_waitcnt lgkmcnt(11)
    v_mfma_f32_16x16x32_bf16 v[36:39], v[144:147], v[80:83], v[36:39]
    v_mul_f32 v24, v24, v208
    v_mul_f32 v25, v25, v209
    s_waitcnt lgkmcnt(6)
    buffer_store_dwordx4 v[192:195], v229, s[12:15], s40 offen sc1
    buffer_store_dwordx4 v[196:199], v229, s[12:15], s41 offen sc1
    s_setprio 2
    ds_read_b128 v[76:79], v225 offset:1216
    v_mfma_f32_16x16x32_bf16 v[40:43], v[144:147], v[84:87], v[40:43]
    v_mul_f32 v26, v26, v210
    ds_read_b128 v[80:83], v248 offset:768
    v_mfma_f32_16x16x32_bf16 v[36:39], v[148:151], v[88:91], v[36:39]
    v_mul_f32 v27, v27, v211
    ds_read_b128 v[84:87], v225 offset:896
    v_mfma_f32_16x16x32_bf16 v[40:43], v[148:151], v[92:95], v[40:43]
    v_cvt_pk_bf16_f32 v188, v24, v25
    ds_read_b128 v[88:91], v248 offset:832
    s_waitcnt lgkmcnt(9)
    v_mfma_f32_16x16x32_bf16 v[36:39], v[152:155], v[48:51], v[36:39]
    v_cvt_pk_bf16_f32 v189, v26, v27
    ds_read_b128 v[92:95], v225 offset:960
    v_mfma_f32_16x16x32_bf16 v[40:43], v[152:155], v[52:55], v[40:43]
    v_mul_f32 v28, v28, v208
    v_mul_f32 v29, v29, v209
    s_waitcnt lgkmcnt(8)
    v_mfma_f32_16x16x32_bf16 v[36:39], v[156:159], v[56:59], v[36:39]
    v_mul_f32 v30, v30, v210
    v_mfma_f32_16x16x32_bf16 v[40:43], v[156:159], v[60:63], v[40:43]
    v_mul_f32 v31, v31, v211
    s_setprio 1
    s_waitcnt lgkmcnt(6)
    v_mfma_f32_16x16x32_bf16 v[36:39], v[160:163], v[64:67], v[36:39]
    v_cvt_pk_bf16_f32 v190, v28, v29
    v_mfma_f32_16x16x32_bf16 v[40:43], v[160:163], v[68:71], v[40:43]
    v_cvt_pk_bf16_f32 v191, v30, v31
    s_waitcnt lgkmcnt(4)
    v_mfma_f32_16x16x32_bf16 v[36:39], v[164:167], v[72:75], v[36:39]
    ds_write_b64 v254, v[184:185] offset:3072
    ds_write_b64 v254, v[186:187] offset:3328
    ds_write_b64 v254, v[188:189] offset:3584
    ds_write_b64 v254, v[190:191] offset:3840
    v_mfma_f32_16x16x32_bf16 v[40:43], v[164:167], v[76:79], v[40:43]
    s_waitcnt lgkmcnt(6)
    v_mfma_f32_16x16x32_bf16 v[36:39], v[168:171], v[80:83], v[36:39]
    v_mfma_f32_16x16x32_bf16 v[40:43], v[168:171], v[84:87], v[40:43]
    s_setprio 0
    s_waitcnt lgkmcnt(4)
    v_mfma_f32_16x16x32_bf16 v[36:39], v[172:175], v[88:91], v[36:39]
    v_mfma_f32_16x16x32_bf16 v[40:43], v[172:175], v[92:95], v[40:43]
    s_nop 6
    v_mul_f32 v36, v36, v212
    v_mul_f32 v37, v37, v213
    v_mul_f32 v38, v38, v214
    v_mul_f32 v39, v39, v215
    v_cvt_pk_bf16_f32 v178, v36, v37
    v_cvt_pk_bf16_f32 v179, v38, v39
    v_mul_f32 v40, v40, v212
    v_mul_f32 v41, v41, v213
    v_mul_f32 v42, v42, v214
    v_mul_f32 v43, v43, v215
    v_cvt_pk_bf16_f32 v180, v40, v41
    v_cvt_pk_bf16_f32 v181, v42, v43
    ds_write_b64 v246, v[178:179] offset:256
    ds_write_b64 v255, v[180:181] offset:512
    s_waitcnt lgkmcnt(0)
    s_barrier
    ds_read_b128 v[192:195], v228 offset:3072
    ds_read_b128 v[196:199], v228 offset:4608
    ds_read_b128 v[200:203], v249
    s_waitcnt lgkmcnt(1)
    buffer_store_dwordx4 v[192:195], v229, s[12:15], s42 offen sc1
    buffer_store_dwordx4 v[196:199], v229, s[12:15], s43 offen sc1
K2_LASTROW:
    s_add_u32 s59, s20, 32
    s_cmp_ge_u32 s59, s22
    s_cbranch_scc1 K2_FIN
    s_waitcnt lgkmcnt(0)
    buffer_store_dwordx4 v[200:203], v229, s[12:15], s44 offen sc1
K2_FIN:
    s_endpgm
K2_MULTI:
    ds_read_b128 v[48:51], v222 offset:0
    ds_read_b128 v[52:55], v222 offset:64
    ds_read_b128 v[56:59], v222 offset:640
    ds_read_b128 v[60:63], v222 offset:704
    ds_read_b128 v[64:67], v223 offset:0
    ds_read_b128 v[68:71], v223 offset:64
    ds_read_b128 v[72:75], v223 offset:640
    ds_read_b128 v[76:79], v223 offset:704
    ds_read_b128 v[80:83], v222 offset:3072
    ds_read_b128 v[84:87], v222 offset:3136
    ds_read_b128 v[88:91], v222 offset:3712
    s_waitcnt vmcnt(19) lgkmcnt(9)
    v_mfma_f32_16x16x32_bf16 v[0:3], v[96:99], v[48:51], 0
    ds_read_b128 v[92:95], v222 offset:3776
    s_waitcnt vmcnt(18)
    v_mfma_f32_16x16x32_bf16 v[0:3], v[100:103], v[52:55], v[0:3]
    ds_read_b128 v[48:51], v223 offset:33280
    s_waitcnt vmcnt(17) lgkmcnt(9)
    v_mfma_f32_16x16x32_bf16 v[0:3], v[104:107], v[56:59], v[0:3]
    ds_read_b128 v[52:55], v223 offset:33344
    s_waitcnt vmcnt(16)
    v_mfma_f32_16x16x32_bf16 v[0:3], v[108:111], v[60:63], v[0:3]
    ds_read_b128 v[56:59], v223 offset:33920
    s_waitcnt vmcnt(15) lgkmcnt(9)
    v_mfma_f32_16x16x32_bf16 v[0:3], v[128:131], v[64:67], v[0:3]
    ds_read_b128 v[60:63], v223 offset:33984
    s_waitcnt vmcnt(14)
    v_mfma_f32_16x16x32_bf16 v[0:3], v[132:135], v[68:71], v[0:3]
    ds_read_b128 v[64:67], v232 offset:6144
    s_waitcnt vmcnt(13) lgkmcnt(9)
    v_mfma_f32_16x16x32_bf16 v[0:3], v[136:139], v[72:75], v[0:3]
    ds_read_b128 v[68:71], v232 offset:6208
    s_waitcnt vmcnt(12)
    v_mfma_f32_16x16x32_bf16 v[0:3], v[140:143], v[76:79], v[0:3]
    ds_read_b128 v[72:75], v232 offset:6784
    s_waitcnt lgkmcnt(9)
    v_mfma_f32_16x16x32_bf16 v[16:19], v[96:99], v[80:83], 0
    ds_read_b128 v[76:79], v232 offset:6848
    v_mfma_f32_16x16x32_bf16 v[16:19], v[100:103], v[84:87], v[16:19]
    ds_read_b128 v[80:83], v225 offset:0
    s_waitcnt lgkmcnt(9)
    v_mfma_f32_16x16x32_bf16 v[16:19], v[104:107], v[88:91], v[16:19]
    ds_read_b128 v[84:87], v225 offset:64
    v_mfma_f32_16x16x32_bf16 v[16:19], v[108:111], v[92:95], v[16:19]
    ds_read_b128 v[88:91], v225 offset:640
    s_waitcnt lgkmcnt(9)
    v_mfma_f32_16x16x32_bf16 v[16:19], v[128:131], v[48:51], v[16:19]
    ds_read_b128 v[92:95], v225 offset:704
    v_mfma_f32_16x16x32_bf16 v[16:19], v[132:135], v[52:55], v[16:19]
    ds_read_b128 v[48:51], v222 offset:128
    s_waitcnt lgkmcnt(9)
    v_mfma_f32_16x16x32_bf16 v[16:19], v[136:139], v[56:59], v[16:19]
    ds_read_b128 v[52:55], v222 offset:1280
    v_mfma_f32_16x16x32_bf16 v[16:19], v[140:143], v[60:63], v[16:19]
    ds_read_b128 v[56:59], v222 offset:384
    s_waitcnt lgkmcnt(9)
    v_mfma_f32_16x16x32_bf16 v[32:35], v[96:99], v[64:67], 0
    ds_read_b128 v[60:63], v222 offset:192
    v_mfma_f32_16x16x32_bf16 v[32:35], v[100:103], v[68:71], v[32:35]
    ds_read_b128 v[64:67], v222 offset:1344
    s_waitcnt lgkmcnt(9)
    v_mfma_f32_16x16x32_bf16 v[32:35], v[104:107], v[72:75], v[32:35]
    ds_read_b128 v[68:71], v222 offset:448
    v_mfma_f32_16x16x32_bf16 v[32:35], v[108:111], v[76:79], v[32:35]
    ds_read_b128 v[72:75], v222 offset:256
    s_waitcnt lgkmcnt(9)
    v_mfma_f32_16x16x32_bf16 v[32:35], v[128:131], v[80:83], v[32:35]
    ds_read_b128 v[76:79], v222 offset:1152
    v_mfma_f32_16x16x32_bf16 v[32:35], v[132:135], v[84:87], v[32:35]
    ds_read_b128 v[80:83], v222 offset:512
    s_waitcnt lgkmcnt(9)
    v_mfma_f32_16x16x32_bf16 v[32:35], v[136:139], v[88:91], v[32:35]
    ds_read_b128 v[84:87], v222 offset:320
    v_mfma_f32_16x16x32_bf16 v[32:35], v[140:143], v[92:95], v[32:35]
    ds_read_b128 v[88:91], v222 offset:1216
    s_waitcnt vmcnt(11) lgkmcnt(9)
    v_mfma_f32_16x16x32_bf16 v[4:7], v[112:115], v[48:51], 0
    ds_read_b128 v[92:95], v222 offset:576
    v_mfma_f32_16x16x32_bf16 v[8:11], v[112:115], v[52:55], 0
    ds_read_b128 v[48:51], v222 offset:768
    s_waitcnt lgkmcnt(9)
    v_mfma_f32_16x16x32_bf16 v[12:15], v[112:115], v[56:59], 0
    ds_read_b128 v[52:55], v222 offset:896
    s_waitcnt vmcnt(10)
    v_mfma_f32_16x16x32_bf16 v[4:7], v[116:119], v[60:63], v[4:7]
    ds_read_b128 v[56:59], v222 offset:1024
    s_waitcnt lgkmcnt(9)
    v_mfma_f32_16x16x32_bf16 v[8:11], v[116:119], v[64:67], v[8:11]
    ds_read_b128 v[60:63], v222 offset:832
    v_mfma_f32_16x16x32_bf16 v[12:15], v[116:119], v[68:71], v[12:15]
    ds_read_b128 v[64:67], v222 offset:960
    s_waitcnt vmcnt(9) lgkmcnt(9)
    v_mfma_f32_16x16x32_bf16 v[4:7], v[120:123], v[72:75], v[4:7]
    ds_read_b128 v[68:71], v222 offset:1088
    v_mfma_f32_16x16x32_bf16 v[8:11], v[120:123], v[76:79], v[8:11]
    ds_read_b128 v[72:75], v223 offset:128
    s_waitcnt lgkmcnt(9)
    v_mfma_f32_16x16x32_bf16 v[12:15], v[120:123], v[80:83], v[12:15]
    ds_read_b128 v[76:79], v223 offset:1280
    s_waitcnt vmcnt(8)
    v_mfma_f32_16x16x32_bf16 v[4:7], v[124:127], v[84:87], v[4:7]
    ds_read_b128 v[80:83], v223 offset:384
    s_waitcnt lgkmcnt(9)
    v_mfma_f32_16x16x32_bf16 v[8:11], v[124:127], v[88:91], v[8:11]
    ds_read_b128 v[84:87], v223 offset:192
    v_mfma_f32_16x16x32_bf16 v[12:15], v[124:127], v[92:95], v[12:15]
    ds_read_b128 v[88:91], v223 offset:1344
    s_waitcnt vmcnt(7) lgkmcnt(9)
    v_mfma_f32_16x16x32_bf16 v[4:7], v[144:147], v[48:51], v[4:7]
    ds_read_b128 v[92:95], v223 offset:448
    v_mfma_f32_16x16x32_bf16 v[8:11], v[144:147], v[52:55], v[8:11]
    ds_read_b128 v[48:51], v223 offset:256
    s_waitcnt lgkmcnt(9)
    v_mfma_f32_16x16x32_bf16 v[12:15], v[144:147], v[56:59], v[12:15]
    ds_read_b128 v[52:55], v223 offset:1152
    s_waitcnt vmcnt(6)
    v_mfma_f32_16x16x32_bf16 v[4:7], v[148:151], v[60:63], v[4:7]
    ds_read_b128 v[56:59], v223 offset:512
    s_waitcnt lgkmcnt(9)
    v_mfma_f32_16x16x32_bf16 v[8:11], v[148:151], v[64:67], v[8:11]
    ds_read_b128 v[60:63], v223 offset:320
    v_mfma_f32_16x16x32_bf16 v[12:15], v[148:151], v[68:71], v[12:15]
    ds_read_b128 v[64:67], v223 offset:1216
    s_waitcnt vmcnt(5) lgkmcnt(9)
    v_mfma_f32_16x16x32_bf16 v[4:7], v[152:155], v[72:75], v[4:7]
    ds_read_b128 v[68:71], v223 offset:576
    v_mfma_f32_16x16x32_bf16 v[8:11], v[152:155], v[76:79], v[8:11]
    ds_read_b128 v[72:75], v223 offset:768
    s_waitcnt lgkmcnt(9)
    v_mfma_f32_16x16x32_bf16 v[12:15], v[152:155], v[80:83], v[12:15]
    ds_read_b128 v[76:79], v223 offset:896
    s_waitcnt vmcnt(4)
    v_mfma_f32_16x16x32_bf16 v[4:7], v[156:159], v[84:87], v[4:7]
    ds_read_b128 v[80:83], v223 offset:1024
    s_waitcnt lgkmcnt(9)
    v_mfma_f32_16x16x32_bf16 v[8:11], v[156:159], v[88:91], v[8:11]
    ds_read_b128 v[84:87], v223 offset:832
    v_mfma_f32_16x16x32_bf16 v[12:15], v[156:159], v[92:95], v[12:15]
    ds_read_b128 v[88:91], v223 offset:960
    s_waitcnt vmcnt(3) lgkmcnt(9)
    v_mfma_f32_16x16x32_bf16 v[4:7], v[160:163], v[48:51], v[4:7]
    ds_read_b128 v[92:95], v223 offset:1088
    v_mfma_f32_16x16x32_bf16 v[8:11], v[160:163], v[52:55], v[8:11]
    ds_read_b128 v[48:51], v222 offset:3200
    s_waitcnt lgkmcnt(9)
    v_mfma_f32_16x16x32_bf16 v[12:15], v[160:163], v[56:59], v[12:15]
    ds_read_b128 v[52:55], v222 offset:4352
    s_waitcnt vmcnt(2)
    v_mfma_f32_16x16x32_bf16 v[4:7], v[164:167], v[60:63], v[4:7]
    ds_read_b128 v[56:59], v222 offset:3456
    s_waitcnt lgkmcnt(9)
    v_mfma_f32_16x16x32_bf16 v[8:11], v[164:167], v[64:67], v[8:11]
    ds_read_b128 v[60:63], v222 offset:3264
    v_mfma_f32_16x16x32_bf16 v[12:15], v[164:167], v[68:71], v[12:15]
    ds_read_b128 v[64:67], v222 offset:4416
    s_waitcnt vmcnt(1) lgkmcnt(9)
    v_mfma_f32_16x16x32_bf16 v[4:7], v[168:171], v[72:75], v[4:7]
    ds_read_b128 v[68:71], v222 offset:3520
    v_mfma_f32_16x16x32_bf16 v[8:11], v[168:171], v[76:79], v[8:11]
    ds_read_b128 v[72:75], v222 offset:3328
    s_waitcnt lgkmcnt(9)
    v_mfma_f32_16x16x32_bf16 v[12:15], v[168:171], v[80:83], v[12:15]
    ds_read_b128 v[76:79], v222 offset:4224
    s_waitcnt vmcnt(0)
    v_mfma_f32_16x16x32_bf16 v[4:7], v[172:175], v[84:87], v[4:7]
    ds_read_b128 v[80:83], v222 offset:3584
    s_waitcnt lgkmcnt(9)
    v_mfma_f32_16x16x32_bf16 v[8:11], v[172:175], v[88:91], v[8:11]
    ds_read_b128 v[84:87], v222 offset:3392
    v_mfma_f32_16x16x32_bf16 v[12:15], v[172:175], v[92:95], v[12:15]
    ds_read_b128 v[88:91], v222 offset:4288
    s_waitcnt lgkmcnt(9)
    v_mfma_f32_16x16x32_bf16 v[20:23], v[112:115], v[48:51], 0
    ds_read_b128 v[92:95], v222 offset:3648
    v_mfma_f32_16x16x32_bf16 v[24:27], v[112:115], v[52:55], 0
    ds_read_b128 v[48:51], v222 offset:3840
    s_waitcnt lgkmcnt(9)
    v_mfma_f32_16x16x32_bf16 v[28:31], v[112:115], v[56:59], 0
    ds_read_b128 v[52:55], v222 offset:3968
    v_mfma_f32_16x16x32_bf16 v[20:23], v[116:119], v[60:63], v[20:23]
    ds_read_b128 v[56:59], v222 offset:4096
    s_waitcnt lgkmcnt(9)
    v_mfma_f32_16x16x32_bf16 v[24:27], v[116:119], v[64:67], v[24:27]
    ds_read_b128 v[60:63], v222 offset:3904
    v_mfma_f32_16x16x32_bf16 v[28:31], v[116:119], v[68:71], v[28:31]
    ds_read_b128 v[64:67], v222 offset:4032
    s_waitcnt lgkmcnt(9)
    v_mfma_f32_16x16x32_bf16 v[20:23], v[120:123], v[72:75], v[20:23]
    ds_read_b128 v[68:71], v222 offset:4160
    v_mfma_f32_16x16x32_bf16 v[24:27], v[120:123], v[76:79], v[24:27]
    ds_read_b128 v[72:75], v223 offset:33408
    s_waitcnt lgkmcnt(9)
    v_mfma_f32_16x16x32_bf16 v[28:31], v[120:123], v[80:83], v[28:31]
    ds_read_b128 v[76:79], v223 offset:34560
    v_mfma_f32_16x16x32_bf16 v[20:23], v[124:127], v[84:87], v[20:23]
    ds_read_b128 v[80:83], v223 offset:33664
    s_waitcnt lgkmcnt(9)
    v_mfma_f32_16x16x32_bf16 v[24:27], v[124:127], v[88:91], v[24:27]
    ds_read_b128 v[84:87], v223 offset:33472
    v_mfma_f32_16x16x32_bf16 v[28:31], v[124:127], v[92:95], v[28:31]
    ds_read_b128 v[88:91], v223 offset:34624
    s_waitcnt lgkmcnt(9)
    v_mfma_f32_16x16x32_bf16 v[20:23], v[144:147], v[48:51], v[20:23]
    ds_read_b128 v[92:95], v223 offset:33728
    v_mfma_f32_16x16x32_bf16 v[24:27], v[144:147], v[52:55], v[24:27]
    ds_read_b128 v[48:51], v223 offset:33536
    s_waitcnt lgkmcnt(9)
    v_mfma_f32_16x16x32_bf16 v[28:31], v[144:147], v[56:59], v[28:31]
    ds_read_b128 v[52:55], v223 offset:34432
    v_mfma_f32_16x16x32_bf16 v[20:23], v[148:151], v[60:63], v[20:23]
    ds_read_b128 v[56:59], v223 offset:33792
    s_waitcnt lgkmcnt(9)
    v_mfma_f32_16x16x32_bf16 v[24:27], v[148:151], v[64:67], v[24:27]
    ds_read_b128 v[60:63], v223 offset:33600
    v_mfma_f32_16x16x32_bf16 v[28:31], v[148:151], v[68:71], v[28:31]
    ds_read_b128 v[64:67], v223 offset:34496
    s_waitcnt lgkmcnt(9)
    v_mfma_f32_16x16x32_bf16 v[20:23], v[152:155], v[72:75], v[20:23]
    ds_read_b128 v[68:71], v223 offset:33856
    v_mfma_f32_16x16x32_bf16 v[24:27], v[152:155], v[76:79], v[24:27]
    ds_read_b128 v[72:75], v223 offset:34048
    s_waitcnt lgkmcnt(9)
    v_mfma_f32_16x16x32_bf16 v[28:31], v[152:155], v[80:83], v[28:31]
    ds_read_b128 v[76:79], v223 offset:34176
    v_mfma_f32_16x16x32_bf16 v[20:23], v[156:159], v[84:87], v[20:23]
    ds_read_b128 v[80:83], v223 offset:34304
    s_waitcnt lgkmcnt(9)
    v_mfma_f32_16x16x32_bf16 v[24:27], v[156:159], v[88:91], v[24:27]
    ds_read_b128 v[84:87], v223 offset:34112
    v_mfma_f32_16x16x32_bf16 v[28:31], v[156:159], v[92:95], v[28:31]
    ds_read_b128 v[88:91], v223 offset:34240
    s_waitcnt lgkmcnt(9)
    v_mfma_f32_16x16x32_bf16 v[20:23], v[160:163], v[48:51], v[20:23]
    ds_read_b128 v[92:95], v223 offset:34368
    v_mfma_f32_16x16x32_bf16 v[24:27], v[160:163], v[52:55], v[24:27]
    ds_read_b128 v[48:51], v247 offset:6272
    s_waitcnt lgkmcnt(9)
    v_mfma_f32_16x16x32_bf16 v[28:31], v[160:163], v[56:59], v[28:31]
    ds_read_b128 v[52:55], v232 offset:7424
    v_mfma_f32_16x16x32_bf16 v[20:23], v[164:167], v[60:63], v[20:23]
    ds_read_b128 v[56:59], v247 offset:6336
    s_waitcnt lgkmcnt(9)
    v_mfma_f32_16x16x32_bf16 v[24:27], v[164:167], v[64:67], v[24:27]
    ds_read_b128 v[60:63], v232 offset:7488
    v_mfma_f32_16x16x32_bf16 v[28:31], v[164:167], v[68:71], v[28:31]
    ds_read_b128 v[64:67], v247 offset:6400
    s_waitcnt lgkmcnt(9)
    v_mfma_f32_16x16x32_bf16 v[20:23], v[168:171], v[72:75], v[20:23]
    ds_read_b128 v[68:71], v232 offset:7296
    v_mfma_f32_16x16x32_bf16 v[24:27], v[168:171], v[76:79], v[24:27]
    ds_read_b128 v[72:75], v247 offset:6464
    s_waitcnt lgkmcnt(9)
    v_mfma_f32_16x16x32_bf16 v[28:31], v[168:171], v[80:83], v[28:31]
    ds_read_b128 v[76:79], v232 offset:7360
    v_mfma_f32_16x16x32_bf16 v[20:23], v[172:175], v[84:87], v[20:23]
    ds_read_b128 v[80:83], v247 offset:6912
    s_waitcnt lgkmcnt(9)
    v_mfma_f32_16x16x32_bf16 v[24:27], v[172:175], v[88:91], v[24:27]
    ds_read_b128 v[84:87], v232 offset:7040
    v_mfma_f32_16x16x32_bf16 v[28:31], v[172:175], v[92:95], v[28:31]
    ds_read_b128 v[88:91], v247 offset:6976
    s_waitcnt lgkmcnt(9)
    v_mfma_f32_16x16x32_bf16 v[36:39], v[112:115], v[48:51], 0
    ds_read_b128 v[92:95], v232 offset:7104
    v_mfma_f32_16x16x32_bf16 v[40:43], v[112:115], v[52:55], 0
    ds_read_b128 v[48:51], v248 offset:128
    s_waitcnt lgkmcnt(9)
    v_mfma_f32_16x16x32_bf16 v[36:39], v[116:119], v[56:59], v[36:39]
    ds_read_b128 v[52:55], v225 offset:1280
    v_mfma_f32_16x16x32_bf16 v[40:43], v[116:119], v[60:63], v[40:43]
    ds_read_b128 v[56:59], v248 offset:192
    s_waitcnt lgkmcnt(9)
    v_mfma_f32_16x16x32_bf16 v[36:39], v[120:123], v[64:67], v[36:39]
    ds_read_b128 v[60:63], v225 offset:1344
    v_mfma_f32_16x16x32_bf16 v[40:43], v[120:123], v[68:71], v[40:43]
    ds_read_b128 v[64:67], v248 offset:256
    s_waitcnt lgkmcnt(9)
    v_mfma_f32_16x16x32_bf16 v[36:39], v[124:127], v[72:75], v[36:39]
    ds_read_b128 v[68:71], v225 offset:1152
    v_mfma_f32_16x16x32_bf16 v[40:43], v[124:127], v[76:79], v[40:43]
    ds_read_b128 v[72:75], v248 offset:320
    s_waitcnt lgkmcnt(9)
    v_mfma_f32_16x16x32_bf16 v[36:39], v[144:147], v[80:83], v[36:39]
    ds_read_b128 v[76:79], v225 offset:1216
    v_mfma_f32_16x16x32_bf16 v[40:43], v[144:147], v[84:87], v[40:43]
    ds_read_b128 v[80:83], v248 offset:768
    s_waitcnt lgkmcnt(9)
    v_mfma_f32_16x16x32_bf16 v[36:39], v[148:151], v[88:91], v[36:39]
    ds_read_b128 v[84:87], v225 offset:896
    v_mfma_f32_16x16x32_bf16 v[40:43], v[148:151], v[92:95], v[40:43]
    ds_read_b128 v[88:91], v248 offset:832
    s_waitcnt lgkmcnt(9)
    v_mfma_f32_16x16x32_bf16 v[36:39], v[152:155], v[48:51], v[36:39]
    ds_read_b128 v[92:95], v225 offset:960
    v_mfma_f32_16x16x32_bf16 v[40:43], v[152:155], v[52:55], v[40:43]
    s_waitcnt lgkmcnt(8)
    v_mfma_f32_16x16x32_bf16 v[36:39], v[156:159], v[56:59], v[36:39]
    v_mfma_f32_16x16x32_bf16 v[40:43], v[156:159], v[60:63], v[40:43]
    s_waitcnt lgkmcnt(6)
    v_mfma_f32_16x16x32_bf16 v[36:39], v[160:163], v[64:67], v[36:39]
    v_mfma_f32_16x16x32_bf16 v[40:43], v[160:163], v[68:71], v[40:43]
    s_waitcnt lgkmcnt(4)
    v_mfma_f32_16x16x32_bf16 v[36:39], v[164:167], v[72:75], v[36:39]
    v_mfma_f32_16x16x32_bf16 v[40:43], v[164:167], v[76:79], v[40:43]
    s_waitcnt lgkmcnt(2)
    v_mfma_f32_16x16x32_bf16 v[36:39], v[168:171], v[80:83], v[36:39]
    v_mfma_f32_16x16x32_bf16 v[40:43], v[168:171], v[84:87], v[40:43]
    s_waitcnt lgkmcnt(0)
    v_mfma_f32_16x16x32_bf16 v[36:39], v[172:175], v[88:91], v[36:39]
    v_mfma_f32_16x16x32_bf16 v[40:43], v[172:175], v[92:95], v[40:43]
    s_lshl_b32 s60, s54, 9
    s_lshl_b32 s61, s20, 6
    s_add_u32 s60, s60, s61
    s_mul_i32 s60, s60, 192
    s_add_u32 s60, s60, 10485760
    v_mul_u32_u24 v227, 96, v252
    s_cmp_lg_u32 s28, 0
    s_cbranch_scc1 K2_NOACC
    buffer_load_dwordx4 v[48:51], v227, s[8:11], s60 offen offset:0
    buffer_load_dwordx4 v[52:55], v227, s[8:11], s60 offen offset:16
    buffer_load_dwordx4 v[56:59], v227, s[8:11], s60 offen offset:32
    buffer_load_dwordx4 v[60:63], v227, s[8:11], s60 offen offset:48
    buffer_load_dwordx4 v[64:67], v227, s[8:11], s60 offen offset:64
    buffer_load_dwordx4 v[68:71], v227, s[8:11], s60 offen offset:80
    buffer_load_dwordx4 v[72:75], v227, s[8:11], s60 offen offset:96
    buffer_load_dwordx4 v[76:79], v227, s[8:11], s60 offen offset:112
    buffer_load_dwordx4 v[80:83], v227, s[8:11], s60 offen offset:128
    buffer_load_dwordx4 v[84:87], v227, s[8:11], s60 offen offset:144
    buffer_load_dwordx4 v[88:91], v227, s[8:11], s60 offen offset:160
    s_waitcnt vmcnt(0)
    v_add_f32 v0, v0, v48
    v_add_f32 v1, v1, v49
    v_add_f32 v2, v2, v50
    v_add_f32 v3, v3, v51
    v_add_f32 v4, v4, v52
    v_add_f32 v5, v5, v53
    v_add_f32 v6, v6, v54
    v_add_f32 v7, v7, v55
    v_add_f32 v8, v8, v56
    v_add_f32 v9, v9, v57
    v_add_f32 v10, v10, v58
    v_add_f32 v11, v11, v59
    v_add_f32 v12, v12, v60
    v_add_f32 v13, v13, v61
    v_add_f32 v14, v14, v62
    v_add_f32 v15, v15, v63
    v_add_f32 v16, v16, v64
    v_add_f32 v17, v17, v65
    v_add_f32 v18, v18, v66
    v_add_f32 v19, v19, v67
    v_add_f32 v20, v20, v68
    v_add_f32 v21, v21, v69
    v_add_f32 v22, v22, v70
    v_add_f32 v23, v23, v71
    v_add_f32 v24, v24, v72
    v_add_f32 v25, v25, v73
    v_add_f32 v26, v26, v74
    v_add_f32 v27, v27, v75
    v_add_f32 v28, v28, v76
    v_add_f32 v29, v29, v77
    v_add_f32 v30, v30, v78
    v_add_f32 v31, v31, v79
    v_add_f32 v32, v32, v80
    v_add_f32 v33, v33, v81
    v_add_f32 v34, v34, v82
    v_add_f32 v35, v35, v83
    v_add_f32 v36, v36, v84
    v_add_f32 v37, v37, v85
    v_add_f32 v38, v38, v86
    v_add_f32 v39, v39, v87
    v_add_f32 v40, v40, v88
    v_add_f32 v41, v41, v89
    v_add_f32 v42, v42, v90
    v_add_f32 v43, v43, v91
K2_NOACC:
    s_barrier
    s_cmp_eq_u32 s55, 0
    s_cbranch_scc1 K2_SPILL
    s_bfe_u32 s60, s20, 0x10002
    s_lshl_b32 s60, s60, 4
    s_add_u32 s59, s59, s60
    v_add_u32 v228, s59, v229
    s_mul_i32 s60, s20, 2080
    s_add_u32 s60, s60, 65536
    v_add_u32 v249, s60, v229
    s_mov_b32 s63, 0xbfb8aa3b
    s_add_u32 s40, s20, s21
    s_lshl_b32 s40, s40, 10
    s_add_u32 s41, s40, 8192
    s_add_u32 s42, s40, 16384
    s_add_u32 s43, s40, 24576
    s_add_u32 s44, s40, 32768
    v_mul_f32 v204, s63, v0
    v_mul_f32 v205, s63, v1
    v_mul_f32 v206, s63, v2
    v_mul_f32 v207, s63, v3
    v_exp_f32 v204, v204
    v_exp_f32 v205, v205
    v_exp_f32 v206, v206
    v_exp_f32 v207, v207
    v_add_f32 v204, 1.0, v204
    v_add_f32 v205, 1.0, v205
    v_add_f32 v206, 1.0, v206
    v_add_f32 v207, 1.0, v207
    v_rcp_f32 v204, v204
    v_rcp_f32 v205, v205
    v_rcp_f32 v206, v206
    v_rcp_f32 v207, v207
    v_cvt_pk_bf16_f32 v176, v0, v1
    v_cvt_pk_bf16_f32 v177, v2, v3
    v_mul_f32 v4, v4, v204
    v_mul_f32 v5, v5, v205
    v_mul_f32 v6, v6, v206
    v_mul_f32 v7, v7, v207
    v_cvt_pk_bf16_f32 v178, v4, v5
    v_cvt_pk_bf16_f32 v179, v6, v7
    v_mul_f32 v8, v8, v204
    v_mul_f32 v9, v9, v205
    v_mul_f32 v10, v10, v206
    v_mul_f32 v11, v11, v207
    v_cvt_pk_bf16_f32 v180, v8, v9
    v_cvt_pk_bf16_f32 v181, v10, v11
    v_mul_f32 v12, v12, v204
    v_mul_f32 v13, v13, v205
    v_mul_f32 v14, v14, v206
    v_mul_f32 v15, v15, v207
    v_cvt_pk_bf16_f32 v182, v12, v13
    v_cvt_pk_bf16_f32 v183, v14, v15
    ds_write_b64 v254, v[176:177] offset:0
    ds_write_b64 v254, v[178:179] offset:256
    ds_write_b64 v254, v[180:181] offset:512
    ds_write_b64 v254, v[182:183] offset:768
    s_waitcnt lgkmcnt(0)
    s_barrier
    ds_read_b128 v[192:195], v228 offset:0
    ds_read_b128 v[196:199], v228 offset:1536
    s_waitcnt lgkmcnt(0)
    buffer_store_dwordx4 v[192:195], v229, s[12:15], s40 offen sc1
    buffer_store_dwordx4 v[196:199], v229, s[12:15], s41 offen sc1
    v_mul_f32 v208, s63, v16
    v_mul_f32 v209, s63, v17
    v_mul_f32 v210, s63, v18
    v_mul_f32 v211, s63, v19
    v_exp_f32 v208, v208
    v_exp_f32 v209, v209
    v_exp_f32 v210, v210
    v_exp_f32 v211, v211
    v_add_f32 v208, 1.0, v208
    v_add_f32 v209, 1.0, v209
    v_add_f32 v210, 1.0, v210
    v_add_f32 v211, 1.0, v211
    v_rcp_f32 v208, v208
    v_rcp_f32 v209, v209
    v_rcp_f32 v210, v210
    v_rcp_f32 v211, v211
    v_cvt_pk_bf16_f32 v184, v16, v17
    v_cvt_pk_bf16_f32 v185, v18, v19
    v_mul_f32 v20, v20, v208
    v_mul_f32 v21, v21, v209
    v_mul_f32 v22, v22, v210
    v_mul_f32 v23, v23, v211
    v_cvt_pk_bf16_f32 v186, v20, v21
    v_cvt_pk_bf16_f32 v187, v22, v23
    v_mul_f32 v24, v24, v208
    v_mul_f32 v25, v25, v209
    v_mul_f32 v26, v26, v210
    v_mul_f32 v27, v27, v211
    v_cvt_pk_bf16_f32 v188, v24, v25
    v_cvt_pk_bf16_f32 v189, v26, v27
    v_mul_f32 v28, v28, v208
    v_mul_f32 v29, v29, v209
    v_mul_f32 v30, v30, v210
    v_mul_f32 v31, v31, v211
    v_cvt_pk_bf16_f32 v190, v28, v29
    v_cvt_pk_bf16_f32 v191, v30, v31
    ds_write_b64 v254, v[184:185] offset:3072
    ds_write_b64 v254, v[186:187] offset:3328
    ds_write_b64 v254, v[188:189] offset:3584
    ds_write_b64 v254, v[190:191] offset:3840
    s_waitcnt lgkmcnt(0)
    s_barrier
    ds_read_b128 v[192:195], v228 offset:3072
    ds_read_b128 v[196:199], v228 offset:4608
    s_waitcnt lgkmcnt(0)
    buffer_store_dwordx4 v[192:195], v229, s[12:15], s42 offen sc1
    buffer_store_dwordx4 v[196:199], v229, s[12:15], s43 offen sc1
    v_mul_f32 v212, s63, v32
    v_mul_f32 v213, s63, v33
    v_mul_f32 v214, s63, v34
    v_mul_f32 v215, s63, v35
    v_exp_f32 v212, v212
    v_exp_f32 v213, v213
    v_exp_f32 v214, v214
    v_exp_f32 v215, v215
    v_add_f32 v212, 1.0, v212
    v_add_f32 v213, 1.0, v213
    v_add_f32 v214, 1.0, v214
    v_add_f32 v215, 1.0, v215
    v_rcp_f32 v212, v212
    v_rcp_f32 v213, v213
    v_rcp_f32 v214, v214
    v_rcp_f32 v215, v215
    v_cvt_pk_bf16_f32 v220, v32, v33
    v_cvt_pk_bf16_f32 v221, v34, v35
    v_mul_f32 v36, v36, v212
    v_mul_f32 v37, v37, v213
    v_mul_f32 v38, v38, v214
    v_mul_f32 v39, v39, v215
    v_cvt_pk_bf16_f32 v178, v36, v37
    v_cvt_pk_bf16_f32 v179, v38, v39
    v_mul_f32 v40, v40, v212
    v_mul_f32 v41, v41, v213
    v_mul_f32 v42, v42, v214
    v_mul_f32 v43, v43, v215
    v_cvt_pk_bf16_f32 v180, v40, v41
    v_cvt_pk_bf16_f32 v181, v42, v43
    ds_write_b64 v255, v[220:221] offset:0
    ds_write_b64 v246, v[178:179] offset:256
    ds_write_b64 v255, v[180:181] offset:512
    s_waitcnt lgkmcnt(0)
    s_barrier
    ds_read_b128 v[200:203], v249
    s_branch K2_LASTROW
K2_SPILL:
    buffer_store_dwordx4 v[0:3], v227, s[8:11], s60 offen offset:0
    buffer_store_dwordx4 v[4:7], v227, s[8:11], s60 offen offset:16
    buffer_store_dwordx4 v[8:11], v227, s[8:11], s60 offen offset:32
    buffer_store_dwordx4 v[12:15], v227, s[8:11], s60 offen offset:48
    buffer_store_dwordx4 v[16:19], v227, s[8:11], s60 offen offset:64
    buffer_store_dwordx4 v[20:23], v227, s[8:11], s60 offen offset:80
    buffer_store_dwordx4 v[24:27], v227, s[8:11], s60 offen offset:96
    buffer_store_dwordx4 v[28:31], v227, s[8:11], s60 offen offset:112
    buffer_store_dwordx4 v[32:35], v227, s[8:11], s60 offen offset:128
    buffer_store_dwordx4 v[36:39], v227, s[8:11], s60 offen offset:144
    buffer_store_dwordx4 v[40:43], v227, s[8:11], s60 offen offset:160
    s_mov_b32 s28, 0
    s_waitcnt vmcnt(0)
    s_cmp_lt_u32 s24, s25
    s_cbranch_scc1 K2_LOAD
    s_add_u32 s23, s23, 20
    s_branch K2_WINDOW
KS_FLS:
    s_sub_u32 s25, s25, 1
    s_cbranch_scc1 K2_END
    v_mov_b32 v62, 163460
    ds_read_b32 v62, v62
    s_branch KS_JOIN2
K2_NOW0:
    buffer_load_dwordx4 v[76:79], v72, s[8:11], s67 offen sc1
    s_branch K2_W0
K2_WINDOW:
    s_mov_b32 s24, 0
    s_mov_b32 s25, 1
K2_LOAD:
    v_mbcnt_lo_u32_b32 v176, -1, 0
    v_mbcnt_hi_u32_b32 v176, -1, v176
    s_lshl_b32 s58, s20, 6
    v_add_u32 v177, s58, v176
    v_lshlrev_b32 v70, 4, v176
    s_mov_b32 s58, 7110656
    buffer_load_dwordx4 v[136:139], v70, s[8:11], s58 offen offset:0 sc1
    buffer_load_dwordx4 v[140:143], v70, s[8:11], s58 offen offset:1024 sc1
    s_mov_b32 s58, 7112704
    buffer_load_dwordx4 v[144:147], v70, s[8:11], s58 offen offset:0 sc1
    buffer_load_dwordx4 v[148:151], v70, s[8:11], s58 offen offset:1024 sc1
    s_mov_b32 s58, 7114752
    buffer_load_dwordx4 v[152:155], v70, s[8:11], s58 offen offset:0 sc1
    buffer_load_dwordx4 v[156:159], v70, s[8:11], s58 offen offset:1024 sc1
    s_mov_b32 s58, 7116800
    buffer_load_dwordx4 v[160:163], v70, s[8:11], s58 offen offset:0 sc1
    buffer_load_dwordx4 v[164:167], v70, s[8:11], s58 offen offset:1024 sc1
    s_mov_b32 s58, 7118848
    buffer_load_dwordx4 v[168:171], v70, s[8:11], s58 offen offset:0 sc1
    buffer_load_dwordx4 v[172:175], v70, s[8:11], s58 offen offset:1024 sc1
    s_mul_i32 s58, s20, 10400
    s_add_u32 s58, s58, 65536
    s_add_u32 s59, s58, 512
    v_and_b32 v76, 31, v176
    v_lshrrev_b32 v77, 5, v176
    v_mov_b32 v80, 0
    v_mul_u32_u24 v77, 2080, v77
    v_mov_b32 v81, 0xffff0000
    v_lshl_add_u32 v78, v76, 4, v77
    v_mov_b32 v82, 0
    v_add_u32 v78, s58, v78
    v_mov_b32 v83, v81
    v_add_u32 v85, 16, v176
    v_lshlrev_b32 v84, 5, v176
    v_lshrrev_b32 v85, 6, v85
    v_mul_u32_u24 v85, 1532, v85
    v_sub_u32 v84, v84, v85
    v_mov_b32 v85, -1
    v_add_u32 v84, s59, v84
    ds_write_b32 v84, v85 offset:0
    ds_write_b32 v84, v85 offset:2080
    ds_write_b32 v84, v85 offset:4160
    ds_write_b32 v84, v85 offset:6240
    ds_write_b32 v84, v85 offset:8320
    s_mov_b32 exec_hi, 0
    ds_write_b128 v78, v[80:83] offset:0
    ds_write_b128 v78, v[80:83] offset:2080
    ds_write_b128 v78, v[80:83] offset:4160
    ds_write_b128 v78, v[80:83] offset:6240
    ds_write_b128 v78, v[80:83] offset:8320
    s_mov_b32 exec_hi, -1
    s_cmp_lg_u32 s20, 7
    s_cbranch_scc1 K2_NOH
    v_mov_b32 v76, 0
    v_mov_b32 v77, -1
    v_lshlrev_b32 v78, 2, v176
    v_add_u32 v78, 163072, v78
    s_mov_b64 exec, 0x1ff
    ds_write_b32 v78, v76 offset:192
    s_mov_b32 exec_lo, 1
    s_mov_b32 exec_lo, -1
    ds_write_b32 v78, v77 offset:256
    s_mov_b64 exec, -1
    s_cmp_lg_u32 s24, 0
    s_cbranch_scc1 K2_NOH
    s_mov_b32 exec_hi, 0xffff
    ds_write_b32 v78, v76
    s_mov_b64 exec, 1
    ds_write_b32 v78, v76 offset:232
    s_mov_b64 exec, -1
K2_NOH:
    s_waitcnt lgkmcnt(0)
    s_barrier
    s_branch K2_CELLS
K2_LD_GEN:
    s_mov_b64 exec, s[42:43]
    s_cbranch_execz K2_LD_DONE
    buffer_load_dwordx4 v[4:7], v182, s[8:11], 0 offen sc1
    s_mov_b64 exec, s[44:45]
    s_cbranch_execz K2_LD_DONE
    buffer_load_dwordx4 v[8:11], v183, s[8:11], 0 offen sc1
    s_mov_b64 exec, s[46:47]
    s_cbranch_execz K2_LD_DONE
    buffer_load_dwordx4 v[12:15], v184, s[8:11], 0 offen sc1
    s_mov_b64 exec, s[48:49]
    s_cbranch_execz K2_LD_DONE
    buffer_load_dwordx4 v[16:19], v181, s[8:11], 0 offen offset:128 sc1
    s_mov_b64 exec, s[50:51]
    s_cbranch_execz K2_LD_DONE
    buffer_load_dwordx4 v[20:23], v181, s[8:11], 0 offen offset:160 sc1
    s_mov_b64 exec, s[90:91]
    s_cbranch_execz K2_LD_DONE
    buffer_load_dwordx4 v[24:27], v181, s[8:11], 0 offen offset:192 sc1
    s_mov_b64 exec, s[92:93]
    s_cbranch_execz K2_LD_DONE
    buffer_load_dwordx4 v[28:31], v181, s[8:11], 0 offen offset:224 sc1
    s_mov_b64 exec, s[94:95]
    s_cbranch_execz K2_LD_DONE
    buffer_load_dwordx4 v[32:35], v181, s[8:11], 0 offen offset:256 sc1
    s_mov_b64 exec, s[96:97]
    s_cbranch_execz K2_LD_DONE
    buffer_load_dwordx4 v[36:39], v181, s[8:11], 0 offen offset:288 sc1
    s_branch K2_LD_DONE
K2_WLATE:
    s_waitcnt vmcnt(0)
    v_lshlrev_b32 v96, 16, v136
    v_and_b32 v97, 0xffff0000, v136
    v_lshlrev_b32 v98, 16, v137
    v_and_b32 v99, 0xffff0000, v137
    v_lshlrev_b32 v100, 16, v138
    v_and_b32 v101, 0xffff0000, v138
    v_lshlrev_b32 v102, 16, v139
    v_and_b32 v103, 0xffff0000, v139
    v_lshlrev_b32 v104, 16, v140
    v_and_b32 v105, 0xffff0000, v140
    v_lshlrev_b32 v106, 16, v141
    v_and_b32 v107, 0xffff0000, v141
    v_lshlrev_b32 v108, 16, v142
    v_and_b32 v109, 0xffff0000, v142
    v_lshlrev_b32 v110, 16, v143
    v_and_b32 v111, 0xffff0000, v143
    v_lshlrev_b32 v112, 16, v144
    v_and_b32 v113, 0xffff0000, v144
    v_lshlrev_b32 v114, 16, v145
    v_and_b32 v115, 0xffff0000, v145
    v_lshlrev_b32 v116, 16, v146
    v_and_b32 v117, 0xffff0000, v146
    v_lshlrev_b32 v118, 16, v147
    v_and_b32 v119, 0xffff0000, v147
    v_lshlrev_b32 v120, 16, v148
    v_and_b32 v121, 0xffff0000, v148
    v_lshlrev_b32 v122, 16, v149
    v_and_b32 v123, 0xffff0000, v149
    v_lshlrev_b32 v124, 16, v150
    v_and_b32 v125, 0xffff0000, v150
    v_lshlrev_b32 v126, 16, v151
    v_and_b32 v127, 0xffff0000, v151
    v_lshlrev_b32 v128, 16, v152
    v_and_b32 v129, 0xffff0000, v152
    v_lshlrev_b32 v130, 16, v153
    v_and_b32 v131, 0xffff0000, v153
    v_lshlrev_b32 v132, 16, v154
    v_and_b32 v133, 0xffff0000, v154
    v_lshlrev_b32 v134, 16, v155
    v_and_b32 v135, 0xffff0000, v155
    v_lshlrev_b32 v136, 16, v156
    v_and_b32 v137, 0xffff0000, v156
    v_lshlrev_b32 v138, 16, v157
    v_and_b32 v139, 0xffff0000, v157
    v_lshlrev_b32 v140, 16, v158
    v_and_b32 v141, 0xffff0000, v158
    v_lshlrev_b32 v142, 16, v159
    v_and_b32 v143, 0xffff0000, v159
    v_lshlrev_b32 v144, 16, v160
    v_and_b32 v145, 0xffff0000, v160
    v_lshlrev_b32 v146, 16, v161
    v_and_b32 v147, 0xffff0000, v161
    v_lshlrev_b32 v148, 16, v162
    v_and_b32 v149, 0xffff0000, v162
    v_lshlrev_b32 v150, 16, v163
    v_and_b32 v151, 0xffff0000, v163
    v_lshlrev_b32 v152, 16, v164
    v_and_b32 v153, 0xffff0000, v164
    v_lshlrev_b32 v154, 16, v165
    v_and_b32 v155, 0xffff0000, v165
    v_lshlrev_b32 v156, 16, v166
    v_and_b32 v157, 0xffff0000, v166
    v_lshlrev_b32 v158, 16, v167
    v_and_b32 v159, 0xffff0000, v167
    v_lshlrev_b32 v160, 16, v168
    v_and_b32 v161, 0xffff0000, v168
    v_lshlrev_b32 v162, 16, v169
    v_and_b32 v163, 0xffff0000, v169
    v_lshlrev_b32 v164, 16, v170
    v_and_b32 v165, 0xffff0000, v170
    v_lshlrev_b32 v166, 16, v171
    v_and_b32 v167, 0xffff0000, v171
    v_lshlrev_b32 v168, 16, v172
    v_and_b32 v169, 0xffff0000, v172
    v_lshlrev_b32 v170, 16, v173
    v_and_b32 v171, 0xffff0000, v173
    v_lshlrev_b32 v172, 16, v174
    v_and_b32 v173, 0xffff0000, v174
    v_lshlrev_b32 v174, 16, v175
    v_and_b32 v175, 0xffff0000, v175
    s_branch K2_NOWRAW
K2_RT0:
    s_sub_u32 s60, s60, 1
    s_cbranch_scc1 K2_END
    s_mov_b64 exec, vcc
    buffer_load_dwordx4 v[0:3], v181, s[8:11], 0 offen offset:0 sc1
    s_mov_b64 exec, s[40:41]
    s_waitcnt vmcnt(0)
    s_branch K2_CK0
K2_RT1:
    s_sub_u32 s60, s60, 1
    s_cbranch_scc1 K2_END
    s_mov_b64 exec, vcc
    buffer_load_dwordx4 v[4:7], v182, s[8:11], 0 offen sc1
    s_mov_b64 exec, s[42:43]
    s_waitcnt vmcnt(0)
    s_branch K2_CK1
K2_RT2:
    s_sub_u32 s60, s60, 1
    s_cbranch_scc1 K2_END
    s_mov_b64 exec, vcc
    buffer_load_dwordx4 v[8:11], v183, s[8:11], 0 offen sc1
    s_mov_b64 exec, s[44:45]
    s_waitcnt vmcnt(0)
    s_branch K2_CK2
K2_RT3:
    s_sub_u32 s60, s60, 1
    s_cbranch_scc1 K2_END
    s_mov_b64 exec, vcc
    buffer_load_dwordx4 v[12:15], v184, s[8:11], 0 offen sc1
    s_mov_b64 exec, s[46:47]
    s_waitcnt vmcnt(0)
    s_branch K2_CK3
K2_RT4:
    s_sub_u32 s60, s60, 1
    s_cbranch_scc1 K2_END
    s_mov_b64 exec, vcc
    buffer_load_dwordx4 v[16:19], v181, s[8:11], 0 offen offset:128 sc1
    s_mov_b64 exec, s[48:49]
    s_waitcnt vmcnt(0)
    s_branch K2_CK4
K2_RT5:
    s_sub_u32 s60, s60, 1
    s_cbranch_scc1 K2_END
    s_mov_b64 exec, vcc
    buffer_load_dwordx4 v[20:23], v181, s[8:11], 0 offen offset:160 sc1
    s_mov_b64 exec, s[50:51]
    s_waitcnt vmcnt(0)
    s_branch K2_CK5
K2_RT6:
    s_sub_u32 s60, s60, 1
    s_cbranch_scc1 K2_END
    s_mov_b64 exec, vcc
    buffer_load_dwordx4 v[24:27], v181, s[8:11], 0 offen offset:192 sc1
    s_mov_b64 exec, s[90:91]
    s_waitcnt vmcnt(0)
    s_branch K2_CK6
K2_RT7:
    s_sub_u32 s60, s60, 1
    s_cbranch_scc1 K2_END
    s_mov_b64 exec, vcc
    buffer_load_dwordx4 v[28:31], v181, s[8:11], 0 offen offset:224 sc1
    s_mov_b64 exec, s[92:93]
    s_waitcnt vmcnt(0)
    s_branch K2_CK7
K2_RT8:
    s_sub_u32 s60, s60, 1
    s_cbranch_scc1 K2_END
    s_mov_b64 exec, vcc
    buffer_load_dwordx4 v[32:35], v181, s[8:11], 0 offen offset:256 sc1
    s_mov_b64 exec, s[94:95]
    s_waitcnt vmcnt(0)
    s_branch K2_CK8
K2_RT9:
    s_sub_u32 s60, s60, 1
    s_cbranch_scc1 K2_END
    s_mov_b64 exec, vcc
    buffer_load_dwordx4 v[36:39], v181, s[8:11], 0 offen offset:288 sc1
    s_mov_b64 exec, s[96:97]
    s_waitcnt vmcnt(0)
    s_branch K2_CK9
K2_RK_LOAD:
    s_waitcnt vmcnt(0)
    s_mov_b64 exec, s[40:41]
    s_cbranch_execz K2_RK_B
    v_lshrrev_b32 v50, 24, v3
    buffer_load_dword v40, v179, s[8:11], s66 offen offset:0
    v_mad_u32_u24 v50, v50, s58, v202
    v_and_b32 v3, 0xffffff, v3
    s_mov_b64 exec, s[42:43]
    s_cbranch_execz K2_RK_B
    v_lshrrev_b32 v51, 24, v7
    buffer_load_dword v41, v185, s[8:11], s66 offen
    v_mad_u32_u24 v51, v51, s58, v202
    v_and_b32 v7, 0xffffff, v7
    s_mov_b64 exec, s[44:45]
    s_cbranch_execz K2_RK_B
    v_lshrrev_b32 v52, 24, v11
    buffer_load_dword v42, v186, s[8:11], s66 offen
    v_mad_u32_u24 v52, v52, s58, v202
    v_and_b32 v11, 0xffffff, v11
    s_mov_b64 exec, s[46:47]
    s_cbranch_execz K2_RK_B
    v_lshrrev_b32 v53, 24, v15
    buffer_load_dword v43, v187, s[8:11], s66 offen
    v_mad_u32_u24 v53, v53, s58, v202
    v_and_b32 v15, 0xffffff, v15
    s_mov_b64 exec, s[48:49]
    s_cbranch_execz K2_RK_B
    v_lshrrev_b32 v54, 24, v19
    buffer_load_dword v44, v179, s[8:11], s66 offen offset:32
    v_mad_u32_u24 v54, v54, s58, v202
    v_and_b32 v19, 0xffffff, v19
    s_mov_b64 exec, s[50:51]
    s_cbranch_execz K2_RK_B
    v_lshrrev_b32 v55, 24, v23
    buffer_load_dword v45, v179, s[8:11], s66 offen offset:40
    v_mad_u32_u24 v55, v55, s58, v202
    v_and_b32 v23, 0xffffff, v23
    s_mov_b64 exec, s[90:91]
    s_cbranch_execz K2_RK_B
    v_lshrrev_b32 v56, 24, v27
    buffer_load_dword v46, v179, s[8:11], s66 offen offset:48
    v_mad_u32_u24 v56, v56, s58, v202
    v_and_b32 v27, 0xffffff, v27
    s_mov_b64 exec, s[92:93]
    s_cbranch_execz K2_RK_B
    v_lshrrev_b32 v57, 24, v31
    buffer_load_dword v47, v179, s[8:11], s66 offen offset:56
    v_mad_u32_u24 v57, v57, s58, v202
    v_and_b32 v31, 0xffffff, v31
    s_mov_b64 exec, s[94:95]
    s_cbranch_execz K2_RK_B
    v_lshrrev_b32 v58, 24, v35
    buffer_load_dword v48, v179, s[8:11], s66 offen offset:64
    v_mad_u32_u24 v58, v58, s58, v202
    v_and_b32 v35, 0xffffff, v35
    s_mov_b64 exec, s[96:97]
    s_cbranch_execz K2_RK_B
    v_lshrrev_b32 v59, 24, v39
    buffer_load_dword v49, v179, s[8:11], s66 offen offset:72
    v_mad_u32_u24 v59, v59, s58, v202
    v_and_b32 v39, 0xffffff, v39
K2_RK_B:
    s_mov_b64 exec, -1
    s_mul_i32 s62, s24, 48
    s_waitcnt vmcnt(0)
    v_subrev_u32 v40, s62, v40
    v_subrev_u32 v41, s62, v41
    v_subrev_u32 v42, s62, v42
    v_subrev_u32 v43, s62, v43
    v_subrev_u32 v44, s62, v44
    v_subrev_u32 v45, s62, v45
    v_subrev_u32 v46, s62, v46
    v_subrev_u32 v47, s62, v47
    v_subrev_u32 v48, s62, v48
    v_subrev_u32 v49, s62, v49
    s_branch K2_RK_DONE
K2_BIG:
    s_cmp_lg_u32 s24, 0
    s_cbranch_scc1 K2_TOK
    s_movk_i32 s26, 48
    v_mov_b32 v197, v193
    s_nop 1
    v_max_u32_dpp v197, v197, v197 row_shr:1 row_mask:0xf bank_mask:0xf bound_ctrl:0
    s_nop 1
    v_max_u32_dpp v197, v197, v197 row_shr:2 row_mask:0xf bank_mask:0xf bound_ctrl:0
    s_nop 1
    v_max_u32_dpp v197, v197, v197 row_shr:4 row_mask:0xf bank_mask:0xf bound_ctrl:0
    s_nop 1
    v_max_u32_dpp v197, v197, v197 row_shr:8 row_mask:0xf bank_mask:0xf bound_ctrl:0
    s_nop 1
    v_max_u32_dpp v197, v197, v197 row_bcast:15 row_mask:0xa bank_mask:0xf
    s_nop 1
    v_max_u32_dpp v197, v197, v197 row_bcast:31 row_mask:0xc bank_mask:0xf
    s_nop 0
    v_readlane_b32 s25, v197, 63
    s_nop 0
    s_add_u32 s25, s25, 47
    s_mul_i32 s25, s25, 43691
    s_lshr_b32 s25, s25, 21
    s_mov_b64 exec, s[40:41]
    s_cbranch_execz K2_SV_DONE
    buffer_store_dword v40, v179, s[8:11], s66 offen offset:0
    s_mov_b64 exec, s[42:43]
    s_cbranch_execz K2_SV_DONE
    buffer_store_dword v41, v185, s[8:11], s66 offen
    s_mov_b64 exec, s[44:45]
    s_cbranch_execz K2_SV_DONE
    buffer_store_dword v42, v186, s[8:11], s66 offen
    s_mov_b64 exec, s[46:47]
    s_cbranch_execz K2_SV_DONE
    buffer_store_dword v43, v187, s[8:11], s66 offen
    s_mov_b64 exec, s[48:49]
    s_cbranch_execz K2_SV_DONE
    buffer_store_dword v44, v179, s[8:11], s66 offen offset:32
    s_mov_b64 exec, s[50:51]
    s_cbranch_execz K2_SV_DONE
    buffer_store_dword v45, v179, s[8:11], s66 offen offset:40
    s_mov_b64 exec, s[90:91]
    s_cbranch_execz K2_SV_DONE
    buffer_store_dword v46, v179, s[8:11], s66 offen offset:48
    s_mov_b64 exec, s[92:93]
    s_cbranch_execz K2_SV_DONE
    buffer_store_dword v47, v179, s[8:11], s66 offen offset:56
    s_mov_b64 exec, s[94:95]
    s_cbranch_execz K2_SV_DONE
    buffer_store_dword v48, v179, s[8:11], s66 offen offset:64
    s_mov_b64 exec, s[96:97]
    s_cbranch_execz K2_SV_DONE
    buffer_store_dword v49, v179, s[8:11], s66 offen offset:72
K2_SV_DONE:
    s_mov_b64 exec, -1
    s_branch K2_TOK
K2_rare_1:
    s_cmp_eq_u32 s33, 4
    s_cbranch_scc1 K2_four_3
    s_mov_b32 s49, s48
    s_xor_b32 s45, s44, 256
    s_xor_b32 s46, s44, 512
    s_xor_b32 s47, s44, 768
    s_branch K2_back_2
K2_four_3:
    s_add_u32 s50, s48, 256
    s_mov_b32 s46, s44
    s_mov_b32 s47, s44
    s_branch K2_back_2
K2_a4_5:
    v_add_u32 v254, s48, v232
    ds_read_b32 v254, v254 offset:4
    s_lshr_b32 s65, s3, 28
    s_mul_i32 s66, s22, 2080
    s_lshl_b32 s65, s65, 9
    s_add_u32 s65, s65, s66
    s_add_u32 s65, s65, 65536
    s_mov_b32 m0, s65
    s_mov_b32 exec_hi, 0
    s_waitcnt lgkmcnt(0)
    v_or_b32 v254, v254, v233
    buffer_load_dwordx4 v254, s[16:19], 0 offen  lds
    s_mov_b32 exec_hi, -1
    s_branch K2_b4_7
K2_g4_8:
    s_add_u32 s51, s48, 384
    v_add_u32 v44, s51, v251
    ds_read2_b32 v[44:45], v44 offset0:1 offset1:3
    s_waitcnt lgkmcnt(0)
    v_mad_u32_u16 v44, v44, s39, v248 op_sel:[1,0,0,0]
    v_mad_u32_u16 v45, v45, s39, v248 op_sel:[1,0,0,0]
    buffer_load_dwordx4 v44, s[4:7], s47 offen sc1 lds
    buffer_load_dwordx4 v45, s[72:75], s47 offen offset:1024 sc1 lds
    s_branch K2_back_9
K2_rare_16:
    s_cmp_eq_u32 s33, 4
    s_cbranch_scc1 K2_four_18
    s_mov_b32 s49, s48
    s_xor_b32 s45, s44, 256
    s_xor_b32 s46, s44, 512
    s_xor_b32 s47, s44, 768
    s_branch K2_back_17
K2_four_18:
    s_add_u32 s50, s48, 256
    s_mov_b32 s46, s44
    s_mov_b32 s47, s44
    s_branch K2_back_17
K2_g4_19:
    s_add_u32 s51, s48, 384
    v_add_u32 v44, s51, v251
    ds_read2_b32 v[44:45], v44 offset0:1 offset1:3
    s_waitcnt lgkmcnt(0)
    v_mad_u32_u16 v44, v44, s39, v248 op_sel:[1,0,0,0]
    v_mad_u32_u16 v45, v45, s39, v248 op_sel:[1,0,0,0]
    buffer_load_dwordx4 v44, s[4:7], s47 offen sc1 lds
    buffer_load_dwordx4 v45, s[72:75], s47 offen offset:1024 sc1 lds
    s_branch K2_back_20
K2_a4_22:
    v_add_u32 v254, s48, v232
    ds_read_b32 v254, v254 offset:4
    s_lshr_b32 s65, s3, 28
    s_mul_i32 s66, s22, 2080
    s_lshl_b32 s65, s65, 9
    s_add_u32 s65, s65, s66
    s_add_u32 s65, s65, 65536
    s_mov_b32 m0, s65
    s_mov_b32 exec_hi, 0
    s_waitcnt lgkmcnt(0)
    v_or_b32 v254, v254, v233
    buffer_load_dwordx4 v254, s[16:19], 0 offen  lds
    s_mov_b32 exec_hi, -1
    s_branch K2_b4_24
K2_rare_31:
    s_cmp_eq_u32 s33, 4
    s_cbranch_scc1 K2_four_33
    s_mov_b32 s49, s48
    s_xor_b32 s45, s44, 256
    s_xor_b32 s46, s44, 512
    s_xor_b32 s47, s44, 768
    s_branch K2_back_32
K2_four_33:
    s_add_u32 s50, s48, 256
    s_mov_b32 s46, s44
    s_mov_b32 s47, s44
    s_branch K2_back_32
K2_g4_34:
    s_add_u32 s51, s48, 384
    v_add_u32 v44, s51, v251
    ds_read2_b32 v[44:45], v44 offset0:1 offset1:3
    s_waitcnt lgkmcnt(0)
    v_mad_u32_u16 v44, v44, s39, v248 op_sel:[1,0,0,0]
    v_mad_u32_u16 v45, v45, s39, v248 op_sel:[1,0,0,0]
    buffer_load_dwordx4 v44, s[4:7], s47 offen sc1 lds
    buffer_load_dwordx4 v45, s[72:75], s47 offen offset:1024 sc1 lds
    s_branch K2_back_35
K2_a4_37:
    v_add_u32 v254, s48, v232
    ds_read_b32 v254, v254 offset:4
    s_lshr_b32 s65, s3, 28
    s_mul_i32 s66, s22, 2080
    s_lshl_b32 s65, s65, 9
    s_add_u32 s65, s65, s66
    s_add_u32 s65, s65, 65536
    s_mov_b32 m0, s65
    s_mov_b32 exec_hi, 0
    s_waitcnt lgkmcnt(0)
    v_or_b32 v254, v254, v233
    buffer_load_dwordx4 v254, s[16:19], 0 offen  lds
    s_mov_b32 exec_hi, -1
    s_branch K2_b4_39
K2_rare_46:
    s_cmp_eq_u32 s33, 4
    s_cbranch_scc1 K2_four_48
    s_mov_b32 s49, s48
    s_xor_b32 s45, s44, 256
    s_xor_b32 s46, s44, 512
    s_xor_b32 s47, s44, 768
    s_branch K2_back_47
K2_four_48:
    s_add_u32 s50, s48, 256
    s_mov_b32 s46, s44
    s_mov_b32 s47, s44
    s_branch K2_back_47
K2_g4_49:
    s_add_u32 s51, s48, 384
    v_add_u32 v44, s51, v251
    ds_read2_b32 v[44:45], v44 offset0:1 offset1:3
    s_waitcnt lgkmcnt(0)
    v_mad_u32_u16 v44, v44, s39, v248 op_sel:[1,0,0,0]
    v_mad_u32_u16 v45, v45, s39, v248 op_sel:[1,0,0,0]
    buffer_load_dwordx4 v44, s[4:7], s47 offen sc1 lds
    buffer_load_dwordx4 v45, s[72:75], s47 offen offset:1024 sc1 lds
    s_branch K2_back_50
K2_a4_52:
    v_add_u32 v254, s48, v232
    ds_read_b32 v254, v254 offset:4
    s_lshr_b32 s65, s3, 28
    s_mul_i32 s66, s22, 2080
    s_lshl_b32 s65, s65, 9
    s_add_u32 s65, s65, s66
    s_add_u32 s65, s65, 65536
    s_mov_b32 m0, s65
    s_mov_b32 exec_hi, 0
    s_waitcnt lgkmcnt(0)
    v_or_b32 v254, v254, v233
    buffer_load_dwordx4 v254, s[16:19], 0 offen  lds
    s_mov_b32 exec_hi, -1
    s_branch K2_b4_54
K2_rare_59:
    s_cmp_eq_u32 s33, 4
    s_cbranch_scc1 K2_four_61
    s_mov_b32 s49, s48
    s_xor_b32 s45, s44, 256
    s_xor_b32 s46, s44, 512
    s_xor_b32 s47, s44, 768
    s_branch K2_back_60
K2_four_61:
    s_add_u32 s50, s48, 256
    s_mov_b32 s46, s44
    s_mov_b32 s47, s44
    s_branch K2_back_60
K2_g4_62:
    s_add_u32 s51, s48, 384
    v_add_u32 v44, s51, v251
    ds_read2_b32 v[44:45], v44 offset0:1 offset1:3
    s_waitcnt lgkmcnt(0)
    v_mad_u32_u16 v44, v44, s39, v248 op_sel:[1,0,0,0]
    v_mad_u32_u16 v45, v45, s39, v248 op_sel:[1,0,0,0]
    buffer_load_dwordx4 v44, s[4:7], s47 offen sc1 lds
    buffer_load_dwordx4 v45, s[72:75], s47 offen offset:1024 sc1 lds
    s_branch K2_back_63
K2_rare_68:
    s_cmp_eq_u32 s33, 4
    s_cbranch_scc1 K2_four_70
    s_mov_b32 s49, s48
    s_xor_b32 s45, s44, 256
    s_xor_b32 s46, s44, 512
    s_xor_b32 s47, s44, 768
    s_branch K2_back_69
K2_four_70:
    s_add_u32 s50, s48, 256
    s_mov_b32 s46, s44
    s_mov_b32 s47, s44
    s_branch K2_back_69
K2_g4_71:
    s_add_u32 s51, s48, 384
    v_add_u32 v44, s51, v251
    ds_read2_b32 v[44:45], v44 offset0:1 offset1:3
    s_waitcnt lgkmcnt(0)
    v_mad_u32_u16 v44, v44, s39, v248 op_sel:[1,0,0,0]
    v_mad_u32_u16 v45, v45, s39, v248 op_sel:[1,0,0,0]
    buffer_load_dwordx4 v44, s[4:7], s47 offen sc1 lds
    buffer_load_dwordx4 v45, s[72:75], s47 offen offset:1024 sc1 lds
    s_branch K2_back_72
K2_rare_77:
    s_cmp_eq_u32 s33, 4
    s_cbranch_scc1 K2_four_79
    s_mov_b32 s49, s48
    s_xor_b32 s45, s44, 256
    s_xor_b32 s46, s44, 512
    s_xor_b32 s47, s44, 768
    s_branch K2_back_78
K2_four_79:
    s_add_u32 s50, s48, 256
    s_mov_b32 s46, s44
    s_mov_b32 s47, s44
    s_branch K2_back_78
K2_g4_80:
    s_add_u32 s51, s48, 384
    v_add_u32 v44, s51, v251
    ds_read2_b32 v[44:45], v44 offset0:1 offset1:3
    s_waitcnt lgkmcnt(0)
    v_mad_u32_u16 v44, v44, s39, v248 op_sel:[1,0,0,0]
    v_mad_u32_u16 v45, v45, s39, v248 op_sel:[1,0,0,0]
    buffer_load_dwordx4 v44, s[4:7], s47 offen sc1 lds
    buffer_load_dwordx4 v45, s[72:75], s47 offen offset:1024 sc1 lds
    s_branch K2_back_81
K2_rare_86:
    s_cmp_eq_u32 s33, 4
    s_cbranch_scc1 K2_four_88
    s_mov_b32 s49, s48
    s_xor_b32 s45, s44, 256
    s_xor_b32 s46, s44, 512
    s_xor_b32 s47, s44, 768
    s_branch K2_back_87
K2_four_88:
    s_add_u32 s50, s48, 256
    s_mov_b32 s46, s44
    s_mov_b32 s47, s44
    s_branch K2_back_87
K2_g4_89:
    s_add_u32 s51, s48, 384
    v_add_u32 v44, s51, v251
    ds_read2_b32 v[44:45], v44 offset0:1 offset1:3
    s_waitcnt lgkmcnt(0)
    v_mad_u32_u16 v44, v44, s39, v248 op_sel:[1,0,0,0]
    v_mad_u32_u16 v45, v45, s39, v248 op_sel:[1,0,0,0]
    buffer_load_dwordx4 v44, s[4:7], s47 offen sc1 lds
    buffer_load_dwordx4 v45, s[72:75], s47 offen offset:1024 sc1 lds
    s_branch K2_back_90
K2_U10:
    s_setprio 1
    s_add_u32 s38, s38, 1
    v_mov_b32 v254, s52
    v_mov_b32 v255, s38
    s_lshl_b32 s58, s38, 3
    s_add_u32 s58, s58, s20
    s_mov_b64 exec, 1
    ds_write_b32 v254, v255
    s_mov_b64 exec, -1
    s_cmp_lt_u32 s58, s22
    s_cbranch_scc0 K2_dyn_91
K2_back_92:
    s_waitcnt lgkmcnt(3)
    v_lshlrev_b32 v16, 16, v80
    v_and_b32 v17, 0xffff0000, v80
    v_lshlrev_b32 v18, 16, v81
    v_and_b32 v19, 0xffff0000, v81
    v_mov_b32 v82, v81
    v_mul_f32_dpp v32, v40, v16 row_newbcast:4 row_mask:0xf bank_mask:0xf
    v_mul_f32_dpp v33, v40, v17 row_newbcast:5 row_mask:0xf bank_mask:0xf
    v_mul_f32_dpp v34, v40, v18 row_newbcast:6 row_mask:0xf bank_mask:0xf
    v_mul_f32_dpp v35, v40, v19 row_newbcast:7 row_mask:0xf bank_mask:0xf
    v_cvt_pk_bf16_f32 v84, v32, v33
    v_cvt_pk_bf16_f32 v86, v34, v35
    v_mul_f32_dpp v36, v40, v16 row_newbcast:8 row_mask:0xf bank_mask:0xf
    v_mul_f32_dpp v37, v40, v17 row_newbcast:9 row_mask:0xf bank_mask:0xf
    v_mul_f32_dpp v38, v40, v18 row_newbcast:10 row_mask:0xf bank_mask:0xf
    v_mul_f32_dpp v39, v40, v19 row_newbcast:11 row_mask:0xf bank_mask:0xf
    v_cvt_pk_bf16_f32 v85, v36, v37
    v_cvt_pk_bf16_f32 v87, v38, v39
    v_mul_f32_dpp v16, v40, v16 row_newbcast:0 row_mask:0xf bank_mask:0xf
    v_mul_f32_dpp v17, v40, v17 row_newbcast:1 row_mask:0xf bank_mask:0xf
    v_mul_f32_dpp v18, v40, v18 row_newbcast:2 row_mask:0xf bank_mask:0xf
    v_mul_f32_dpp v19, v40, v19 row_newbcast:3 row_mask:0xf bank_mask:0xf
    v_cvt_pk_bf16_f32 v81, v16, v17
    v_cvt_pk_bf16_f32 v83, v18, v19
    v_permlane16_swap_b32 v84, v85
    v_permlane16_swap_b32 v86, v87
    v_permlane16_swap_b32 v80, v81
    v_permlane16_swap_b32 v82, v83
    v_readlane_b32 s3, v253, s58
    s_lshl_b32 s44, s34, 7
    s_and_b32 s48, s3, 0x3ffff
    s_bfe_u32 s33, s3, 0x30013
    s_mul_i32 s35, s38, 6
    s_cmp_eq_u32 s34, 0
    s_cselect_b32 s35, s35, s48
    s_mov_b32 s45, s44
    s_xor_b32 s47, s44, 256
    s_add_u32 s49, s48, 128
    s_add_u32 s60, s48, 256
    s_cmp_eq_u32 s33, 3
    s_cselect_b32 s46, s44, s47
    s_cselect_b32 s50, s60, s48
    s_sub_u32 s60, s33, 2
    s_cmp_lt_u32 s60, 2
    s_cbranch_scc0 K2_rare_97
K2_back_98:
    v_add_u32 v43, s48, v232
    ds_read_b32 v42, v43
    ds_read_b32 v43, v43 offset:1024
    v_add_u32 v222, s48, v251
    ds_read2_b32 v[222:223], v222 offset0:1 offset1:3
    v_add_u32 v224, s49, v251
    ds_read2_b32 v[224:225], v224 offset0:1 offset1:3
    v_add_u32 v226, s50, v251
    ds_read2_b32 v[226:227], v226 offset0:1 offset1:3
    s_waitcnt lgkmcnt(3)
    v_or_b32 v42, v42, v233
    v_or_b32 v43, v43, v233
    s_cmp_lg_u32 s34, 0
    s_cbranch_scc1 K2_dum_100
    s_cmp_eq_u32 s33, 4
    s_cbranch_scc1 K2_a4_101
K2_b4_103:
    s_add_u32 m0, s48, 512
    s_add_u32 s65, s48, 1536
    buffer_load_dwordx4 v42, s[16:19], 0 offen  lds
    s_mov_b32 m0, s65
    s_mov_b32 exec_hi, 0
    buffer_load_dwordx4 v43, s[16:19], 0 offen  lds
    s_mov_b32 exec_hi, -1
K2_back_102:
    s_waitcnt lgkmcnt(2)
    v_mad_u32_u16 v222, v222, s39, v248 op_sel:[1,0,0,0]
    v_mad_u32_u16 v223, v223, s39, v248 op_sel:[1,0,0,0]
    s_waitcnt lgkmcnt(1)
    v_mad_u32_u16 v224, v224, s39, v248 op_sel:[1,0,0,0]
    v_mad_u32_u16 v225, v225, s39, v248 op_sel:[1,0,0,0]
    s_waitcnt lgkmcnt(0)
    v_mad_u32_u16 v226, v226, s39, v248 op_sel:[1,0,0,0]
    v_mad_u32_u16 v227, v227, s39, v248 op_sel:[1,0,0,0]
    s_waitcnt vmcnt(6)
    v_mfma_f32_32x32x16_bf16 v[8:23], v[80:83], v[176:179], 0
    ds_read_b64_tr_b16 v[184:185], v246 offset:2048
    ds_read_b64_tr_b16 v[186:187], v246 offset:3072
    ds_read_b64_tr_b16 v[188:189], v247 offset:2048
    ds_read_b64_tr_b16 v[190:191], v247 offset:3072
    s_mov_b32 m0, s68
    v_mfma_f32_32x32x16_bf16 v[24:39], v[84:87], v[176:179], 0
    buffer_load_dwordx4 v222, s[4:7], s44 offen sc1 lds
    buffer_load_dwordx4 v223, s[72:75], s44 offen offset:1024 sc1 lds
    v_permlane32_swap_b32 v236, v234
    v_permlane32_swap_b32 v237, v235
    v_mfma_f32_32x32x16_bf16 v[48:63], v[80:83], v[180:183], 0
    v_permlane32_swap_b32 v240, v238
    v_permlane32_swap_b32 v241, v239
    v_add_f32 v236, v236, v234
    v_add_f32 v237, v237, v235
    v_add_f32 v240, -v240, -v238
    v_mfma_f32_32x32x16_bf16 v[64:79], v[84:87], v[180:183], 0
    s_setprio 0
    v_add_f32 v241, -v241, -v239
    s_set_gpr_idx_on s32, gpr_idx(DST)
    s_nop 0
    v_cvt_pk_bf16_f32 v194, v236, v237
    v_cvt_pk_bf16_f32 v195, v240, v241
    s_set_gpr_idx_off
    v_mul_f32 v234, v8, v96
    v_mul_f32 v236, v16, v128
    v_fmac_f32 v234, v9, v97
    v_fmac_f32 v236, v17, v129
    v_fmac_f32 v234, v10, v98
    v_fmac_f32 v236, v18, v130
    v_fmac_f32 v234, v11, v99
    v_fmac_f32 v236, v19, v131
    v_fmac_f32 v234, v12, v100
    v_fmac_f32 v236, v20, v132
    v_fmac_f32 v234, v13, v101
    v_fmac_f32 v236, v21, v133
    v_fmac_f32 v234, v14, v102
    v_fmac_f32 v236, v22, v134
    v_fmac_f32 v234, v15, v103
    v_fmac_f32 v236, v23, v135
    v_mul_f32 v238, v24, v128
    v_mul_f32 v240, v32, v128
    v_fmac_f32 v238, v25, v129
    v_fmac_f32 v240, v33, v129
    v_fmac_f32 v238, v26, v130
    v_fmac_f32 v240, v34, v130
    v_fmac_f32 v238, v27, v131
    v_fmac_f32 v240, v35, v131
    v_fmac_f32 v238, v28, v132
    v_fmac_f32 v240, v36, v132
    v_fmac_f32 v238, v29, v133
    v_fmac_f32 v240, v37, v133
    v_fmac_f32 v238, v30, v134
    v_fmac_f32 v240, v38, v134
    v_fmac_f32 v238, v31, v135
    v_fmac_f32 v240, v39, v135
    v_mul_f32 v235, v48, v104
    v_mul_f32 v237, v56, v136
    v_fmac_f32 v235, v49, v105
    v_fmac_f32 v237, v57, v137
    v_fmac_f32 v235, v50, v106
    v_fmac_f32 v237, v58, v138
    v_fmac_f32 v235, v51, v107
    v_fmac_f32 v237, v59, v139
    v_fmac_f32 v235, v52, v108
    v_fmac_f32 v237, v60, v140
    v_fmac_f32 v235, v53, v109
    v_fmac_f32 v237, v61, v141
    v_fmac_f32 v235, v54, v110
    v_fmac_f32 v237, v62, v142
    v_fmac_f32 v235, v55, v111
    v_fmac_f32 v237, v63, v143
    v_mul_f32 v239, v64, v136
    v_mul_f32 v241, v72, v136
    v_fmac_f32 v239, v65, v137
    v_fmac_f32 v241, v73, v137
    v_fmac_f32 v239, v66, v138
    v_fmac_f32 v241, v74, v138
    v_fmac_f32 v239, v67, v139
    v_fmac_f32 v241, v75, v139
    v_fmac_f32 v239, v68, v140
    v_fmac_f32 v241, v76, v140
    v_fmac_f32 v239, v69, v141
    v_fmac_f32 v241, v77, v141
    v_fmac_f32 v239, v70, v142
    v_fmac_f32 v241, v78, v142
    v_fmac_f32 v239, v71, v143
    v_fmac_f32 v241, v79, v143
    s_setprio 1
    s_waitcnt vmcnt(6) lgkmcnt(0)
    v_mfma_f32_32x32x16_bf16 v[24:39], v[84:87], v[184:187], 0
    ds_read_b64_tr_b16 v[176:177], v246 offset:4096
    ds_read_b64_tr_b16 v[178:179], v246 offset:5120
    ds_read_b64_tr_b16 v[180:181], v247 offset:4096
    ds_read_b64_tr_b16 v[182:183], v247 offset:5120
    s_mov_b32 m0, s69
    v_mfma_f32_32x32x16_bf16 v[8:23], v[80:83], v[184:187], 0
    buffer_load_dwordx4 v224, s[4:7], s45 offen sc1 lds
    buffer_load_dwordx4 v225, s[72:75], s45 offen offset:1024 sc1 lds
    v_permlane32_swap_b32 v234, v236
    v_permlane32_swap_b32 v235, v237
    v_mfma_f32_32x32x16_bf16 v[48:63], v[80:83], v[188:191], 0
    v_permlane32_swap_b32 v238, v239
    v_add_f32 v234, v234, v236
    v_add_f32 v235, v235, v237
    v_add_f32 v238, -v238, -v239
    v_mfma_f32_32x32x16_bf16 v[64:79], v[84:87], v[188:191], 0
    s_setprio 0
    s_set_gpr_idx_on s31, gpr_idx(DST)
    s_nop 0
    v_cvt_pk_bf16_f32 v192, v234, v235
    v_cvt_pk_bf16_f32 v197, v238, v238
    s_set_gpr_idx_off
    v_mul_f32 v236, v24, v160
    v_mul_f32 v238, v32, v160
    v_fmac_f32 v236, v25, v161
    v_fmac_f32 v238, v33, v161
    v_fmac_f32 v236, v26, v162
    v_fmac_f32 v238, v34, v162
    v_fmac_f32 v236, v27, v163
    v_fmac_f32 v238, v35, v163
    v_fmac_f32 v236, v28, v164
    v_fmac_f32 v238, v36, v164
    v_fmac_f32 v236, v29, v165
    v_fmac_f32 v238, v37, v165
    v_fmac_f32 v236, v30, v166
    v_fmac_f32 v238, v38, v166
    v_fmac_f32 v236, v31, v167
    v_fmac_f32 v238, v39, v167
    v_mul_f32 v234, v8, v144
    v_mul_f32 v235, v48, v152
    v_fmac_f32 v234, v9, v145
    v_fmac_f32 v235, v49, v153
    v_fmac_f32 v234, v10, v146
    v_fmac_f32 v235, v50, v154
    v_fmac_f32 v234, v11, v147
    v_fmac_f32 v235, v51, v155
    v_fmac_f32 v234, v12, v148
    v_fmac_f32 v235, v52, v156
    v_fmac_f32 v234, v13, v149
    v_fmac_f32 v235, v53, v157
    v_fmac_f32 v234, v14, v150
    v_fmac_f32 v235, v54, v158
    v_fmac_f32 v234, v15, v151
    v_fmac_f32 v235, v55, v159
    v_mul_f32 v237, v64, v168
    v_mul_f32 v239, v72, v168
    v_fmac_f32 v237, v65, v169
    v_fmac_f32 v239, v73, v169
    v_fmac_f32 v237, v66, v170
    v_fmac_f32 v239, v74, v170
    v_fmac_f32 v237, v67, v171
    v_fmac_f32 v239, v75, v171
    v_fmac_f32 v237, v68, v172
    v_fmac_f32 v239, v76, v172
    v_fmac_f32 v237, v69, v173
    v_fmac_f32 v239, v77, v173
    v_fmac_f32 v237, v70, v174
    v_fmac_f32 v239, v78, v174
    v_fmac_f32 v237, v71, v175
    v_fmac_f32 v239, v79, v175
    s_setprio 1
    s_waitcnt vmcnt(6) lgkmcnt(0)
    v_mfma_f32_32x32x16_bf16 v[24:39], v[80:83], v[176:179], 0
    ds_read_b64_tr_b16 v[184:185], v246 offset:6144
    ds_read_b64_tr_b16 v[186:187], v246 offset:7168
    ds_read_b64_tr_b16 v[188:189], v247 offset:6144
    ds_read_b64_tr_b16 v[190:191], v247 offset:7168
    s_mov_b32 m0, s70
    v_mfma_f32_32x32x16_bf16 v[0:15], v[84:87], v[176:179], 0
    buffer_load_dwordx4 v226, s[4:7], s46 offen sc1 lds
    buffer_load_dwordx4 v227, s[72:75], s46 offen offset:1024 sc1 lds
    v_permlane32_swap_b32 v234, v240
    v_permlane32_swap_b32 v235, v241
    v_add_f32 v234, v234, v240
    v_mfma_f32_32x32x16_bf16 v[40:55], v[84:87], v[180:183], 0
    v_add_f32 v235, v235, v241
    s_set_gpr_idx_on s31, gpr_idx(DST)
    s_nop 0
    v_cvt_pk_bf16_f32 v193, v234, v235
    s_set_gpr_idx_off
    s_sub_u32 s26, s48, s29
    s_mov_b32 s29, s48
    s_mov_b32 s30, s3
    v_mfma_f32_32x32x16_bf16 v[64:79], v[80:83], v[180:183], 0
    s_setprio 0
    s_bfe_u32 s56, s3, 0x40012
    s_cmp_eq_u32 s34, 0
    s_cselect_b32 s56, s56, 0
    v_mul_f32 v240, v24, v144
    v_fmac_f32 v236, v32, v160
    v_fmac_f32 v240, v25, v145
    v_fmac_f32 v236, v33, v161
    v_fmac_f32 v240, v26, v146
    v_fmac_f32 v236, v34, v162
    v_fmac_f32 v240, v27, v147
    v_fmac_f32 v236, v35, v163
    v_fmac_f32 v240, v28, v148
    v_fmac_f32 v236, v36, v164
    v_fmac_f32 v240, v29, v149
    v_fmac_f32 v236, v37, v165
    v_fmac_f32 v240, v30, v150
    v_fmac_f32 v236, v38, v166
    v_fmac_f32 v240, v31, v151
    v_fmac_f32 v236, v39, v167
    v_mul_f32 v234, v0, v112
    v_mul_f32 v235, v40, v120
    v_fmac_f32 v234, v1, v113
    v_fmac_f32 v235, v41, v121
    v_fmac_f32 v234, v2, v114
    v_fmac_f32 v235, v42, v122
    v_fmac_f32 v234, v3, v115
    v_fmac_f32 v235, v43, v123
    v_fmac_f32 v234, v4, v116
    v_fmac_f32 v235, v44, v124
    v_fmac_f32 v234, v5, v117
    v_fmac_f32 v235, v45, v125
    v_fmac_f32 v234, v6, v118
    v_fmac_f32 v235, v46, v126
    v_fmac_f32 v234, v7, v119
    v_fmac_f32 v235, v47, v127
    v_mul_f32 v241, v64, v152
    v_fmac_f32 v237, v72, v168
    v_fmac_f32 v241, v65, v153
    v_fmac_f32 v237, v73, v169
    v_fmac_f32 v241, v66, v154
    v_fmac_f32 v237, v74, v170
    v_fmac_f32 v241, v67, v155
    v_fmac_f32 v237, v75, v171
    v_fmac_f32 v241, v68, v156
    v_fmac_f32 v237, v76, v172
    v_fmac_f32 v241, v69, v157
    v_fmac_f32 v237, v77, v173
    v_fmac_f32 v241, v70, v158
    v_fmac_f32 v237, v78, v174
    v_fmac_f32 v241, v71, v159
    v_fmac_f32 v237, v79, v175
    s_setprio 1
    s_waitcnt vmcnt(4) lgkmcnt(0)
    v_mfma_f32_32x32x16_bf16 v[24:39], v[80:83], v[184:187], 0
    ds_read_b64_tr_b16 v[176:177], v246 offset:0
    ds_read_b64_tr_b16 v[178:179], v246 offset:1024
    ds_read_b64_tr_b16 v[180:181], v247 offset:0
    ds_read_b64_tr_b16 v[182:183], v247 offset:1024
    s_mov_b32 m0, s71
    v_mfma_f32_32x32x16_bf16 v[8:23], v[84:87], v[184:187], v[8:23]
    s_cmp_eq_u32 s33, 4
    s_cbranch_scc1 K2_g4_104
    buffer_load_dwordx4 v224, s[4:7], s47 offen sc1 lds
    buffer_load_dwordx4 v225, s[72:75], s47 offen offset:1024 sc1 lds
K2_back_105:
    v_permlane32_swap_b32 v236, v240
    v_mfma_f32_32x32x16_bf16 v[48:63], v[84:87], v[188:191], v[48:63]
    v_permlane32_swap_b32 v237, v241
    v_add_f32 v236, v236, v240
    v_add_f32 v237, v237, v241
    s_set_gpr_idx_on s31, gpr_idx(DST)
    s_nop 0
    v_cvt_pk_bf16_f32 v196, v236, v237
    s_set_gpr_idx_off
    s_mov_b32 s32, s31
    s_mov_b32 s31, s35
    v_mfma_f32_32x32x16_bf16 v[64:79], v[80:83], v[188:191], 0
    s_setprio 0
    v_mul_f32 v236, v24, v144
    v_fma_f32 v238, v32, v160, -v238
    v_fmac_f32 v236, v25, v145
    v_fmac_f32 v238, v33, v161
    v_fmac_f32 v236, v26, v146
    v_fmac_f32 v238, v34, v162
    v_fmac_f32 v236, v27, v147
    v_fmac_f32 v238, v35, v163
    v_fmac_f32 v236, v28, v148
    v_fmac_f32 v238, v36, v164
    v_fmac_f32 v236, v29, v149
    v_fmac_f32 v238, v37, v165
    v_fmac_f32 v236, v30, v150
    v_fmac_f32 v238, v38, v166
    v_fmac_f32 v236, v31, v151
    v_fmac_f32 v238, v39, v167
    v_add_u32 v249, s26, v249
    v_add_u32 v250, s26, v250
    v_mul_f32 v240, v8, v160
    v_fma_f32 v234, v16, v112, -v234
    v_fmac_f32 v240, v9, v161
    v_fmac_f32 v234, v17, v113
    v_fmac_f32 v240, v10, v162
    v_fmac_f32 v234, v18, v114
    v_fmac_f32 v240, v11, v163
    v_fmac_f32 v234, v19, v115
    v_fmac_f32 v240, v12, v164
    v_fmac_f32 v234, v20, v116
    v_fmac_f32 v240, v13, v165
    v_fmac_f32 v234, v21, v117
    v_fmac_f32 v240, v14, v166
    v_fmac_f32 v234, v22, v118
    v_fmac_f32 v240, v15, v167
    v_fmac_f32 v234, v23, v119
    ds_read_b64_tr_b16 v[80:81], v249 offset:0
    ds_read_u16_d16_hi v40, v250 offset:0
    v_mul_f32 v241, v48, v168
    v_fma_f32 v235, v56, v120, -v235
    v_fmac_f32 v241, v49, v169
    v_fmac_f32 v235, v57, v121
    v_fmac_f32 v241, v50, v170
    v_fmac_f32 v235, v58, v122
    v_fmac_f32 v241, v51, v171
    v_fmac_f32 v235, v59, v123
    v_fmac_f32 v241, v52, v172
    v_fmac_f32 v235, v60, v124
    v_fmac_f32 v241, v53, v173
    v_fmac_f32 v235, v61, v125
    v_fmac_f32 v241, v54, v174
    v_fmac_f32 v235, v62, v126
    v_fmac_f32 v241, v55, v175
    v_fmac_f32 v235, v63, v127
    ds_read_b64_tr_b16 v[88:89], v249 offset:512
    ds_read_u16_d16_hi v41, v250 offset:128
    v_mul_f32 v237, v64, v152
    v_fma_f32 v239, v72, v168, -v239
    v_fmac_f32 v237, v65, v153
    v_fmac_f32 v239, v73, v169
    v_fmac_f32 v237, v66, v154
    v_fmac_f32 v239, v74, v170
    v_fmac_f32 v237, v67, v155
    v_fmac_f32 v239, v75, v171
    v_fmac_f32 v237, v68, v156
    v_fmac_f32 v239, v76, v172
    v_fmac_f32 v237, v69, v157
    v_fmac_f32 v239, v77, v173
    v_fmac_f32 v237, v70, v158
    v_fmac_f32 v239, v78, v174
    v_fmac_f32 v237, v71, v159
    v_fmac_f32 v239, v79, v175
    s_cmp_eq_u32 s56, 5
    s_cbranch_scc1 K2_U20
    s_cmp_eq_u32 s56, 6
    s_cbranch_scc1 K2_U3h0
    s_branch K2_DSP0
K2_U40:
    s_setprio 1
    ds_read_b64_tr_b16 v[228:229], v249 offset:1024
    ds_read_u16_d16_hi v42, v250 offset:256
    s_lshr_b32 s65, s30, 28
    s_mul_i32 s66, s22, 2080
    s_lshl_b32 s65, s65, 9
    s_add_u32 s65, s65, s66
    s_add_u32 s65, s65, 65536
    s_sub_u32 s65, s65, s29
    s_sub_u32 s65, s65, 512
    v_add_u32 v56, s65, v249
    ds_read_b64_tr_b16 v[0:1], v56 offset:0
    ds_read_u16_d16_hi v43, v250 offset:384
    s_waitcnt lgkmcnt(4)
    v_lshlrev_b32 v16, 16, v80
    v_and_b32 v17, 0xffff0000, v80
    v_lshlrev_b32 v18, 16, v81
    v_and_b32 v19, 0xffff0000, v81
    v_mov_b32 v82, v81
    v_mul_f32_dpp v32, v40, v16 row_newbcast:4 row_mask:0xf bank_mask:0xf
    v_mul_f32_dpp v33, v40, v17 row_newbcast:5 row_mask:0xf bank_mask:0xf
    v_mul_f32_dpp v34, v40, v18 row_newbcast:6 row_mask:0xf bank_mask:0xf
    v_mul_f32_dpp v35, v40, v19 row_newbcast:7 row_mask:0xf bank_mask:0xf
    v_cvt_pk_bf16_f32 v84, v32, v33
    v_cvt_pk_bf16_f32 v86, v34, v35
    v_mul_f32_dpp v36, v40, v16 row_newbcast:8 row_mask:0xf bank_mask:0xf
    v_mul_f32_dpp v37, v40, v17 row_newbcast:9 row_mask:0xf bank_mask:0xf
    v_mul_f32_dpp v38, v40, v18 row_newbcast:10 row_mask:0xf bank_mask:0xf
    v_mul_f32_dpp v39, v40, v19 row_newbcast:11 row_mask:0xf bank_mask:0xf
    v_cvt_pk_bf16_f32 v85, v36, v37
    v_cvt_pk_bf16_f32 v87, v38, v39
    v_mul_f32_dpp v16, v40, v16 row_newbcast:0 row_mask:0xf bank_mask:0xf
    v_mul_f32_dpp v17, v40, v17 row_newbcast:1 row_mask:0xf bank_mask:0xf
    v_mul_f32_dpp v18, v40, v18 row_newbcast:2 row_mask:0xf bank_mask:0xf
    v_mul_f32_dpp v19, v40, v19 row_newbcast:3 row_mask:0xf bank_mask:0xf
    v_cvt_pk_bf16_f32 v81, v16, v17
    v_cvt_pk_bf16_f32 v83, v18, v19
    v_permlane16_swap_b32 v84, v85
    v_permlane16_swap_b32 v86, v87
    v_permlane16_swap_b32 v80, v81
    v_permlane16_swap_b32 v82, v83
    v_lshlrev_b32 v24, 16, v88
    v_and_b32 v25, 0xffff0000, v88
    v_lshlrev_b32 v26, 16, v89
    v_and_b32 v27, 0xffff0000, v89
    v_mov_b32 v90, v89
    v_mul_f32_dpp v32, v41, v24 row_newbcast:4 row_mask:0xf bank_mask:0xf
    v_mul_f32_dpp v33, v41, v25 row_newbcast:5 row_mask:0xf bank_mask:0xf
    v_mul_f32_dpp v34, v41, v26 row_newbcast:6 row_mask:0xf bank_mask:0xf
    v_mul_f32_dpp v35, v41, v27 row_newbcast:7 row_mask:0xf bank_mask:0xf
    v_cvt_pk_bf16_f32 v92, v32, v33
    v_cvt_pk_bf16_f32 v94, v34, v35
    v_mul_f32_dpp v36, v41, v24 row_newbcast:8 row_mask:0xf bank_mask:0xf
    v_mul_f32_dpp v37, v41, v25 row_newbcast:9 row_mask:0xf bank_mask:0xf
    v_mul_f32_dpp v38, v41, v26 row_newbcast:10 row_mask:0xf bank_mask:0xf
    v_mul_f32_dpp v39, v41, v27 row_newbcast:11 row_mask:0xf bank_mask:0xf
    v_cvt_pk_bf16_f32 v93, v36, v37
    v_cvt_pk_bf16_f32 v95, v38, v39
    v_mul_f32_dpp v24, v41, v24 row_newbcast:0 row_mask:0xf bank_mask:0xf
    v_mul_f32_dpp v25, v41, v25 row_newbcast:1 row_mask:0xf bank_mask:0xf
    v_mul_f32_dpp v26, v41, v26 row_newbcast:2 row_mask:0xf bank_mask:0xf
    v_mul_f32_dpp v27, v41, v27 row_newbcast:3 row_mask:0xf bank_mask:0xf
    v_cvt_pk_bf16_f32 v89, v24, v25
    v_cvt_pk_bf16_f32 v91, v26, v27
    v_permlane16_swap_b32 v92, v93
    v_permlane16_swap_b32 v94, v95
    v_permlane16_swap_b32 v88, v89
    v_permlane16_swap_b32 v90, v91
    s_waitcnt lgkmcnt(2)
    v_lshlrev_b32 v16, 16, v228
    v_and_b32 v17, 0xffff0000, v228
    v_lshlrev_b32 v18, 16, v229
    v_and_b32 v19, 0xffff0000, v229
    v_mov_b32 v230, v229
    v_mul_f32_dpp v32, v42, v16 row_newbcast:4 row_mask:0xf bank_mask:0xf
    v_mul_f32_dpp v33, v42, v17 row_newbcast:5 row_mask:0xf bank_mask:0xf
    v_mul_f32_dpp v34, v42, v18 row_newbcast:6 row_mask:0xf bank_mask:0xf
    v_mul_f32_dpp v35, v42, v19 row_newbcast:7 row_mask:0xf bank_mask:0xf
    v_cvt_pk_bf16_f32 v242, v32, v33
    v_cvt_pk_bf16_f32 v244, v34, v35
    v_mul_f32_dpp v36, v42, v16 row_newbcast:8 row_mask:0xf bank_mask:0xf
    v_mul_f32_dpp v37, v42, v17 row_newbcast:9 row_mask:0xf bank_mask:0xf
    v_mul_f32_dpp v38, v42, v18 row_newbcast:10 row_mask:0xf bank_mask:0xf
    v_mul_f32_dpp v39, v42, v19 row_newbcast:11 row_mask:0xf bank_mask:0xf
    v_cvt_pk_bf16_f32 v243, v36, v37
    v_cvt_pk_bf16_f32 v245, v38, v39
    v_mul_f32_dpp v16, v42, v16 row_newbcast:0 row_mask:0xf bank_mask:0xf
    v_mul_f32_dpp v17, v42, v17 row_newbcast:1 row_mask:0xf bank_mask:0xf
    v_mul_f32_dpp v18, v42, v18 row_newbcast:2 row_mask:0xf bank_mask:0xf
    v_mul_f32_dpp v19, v42, v19 row_newbcast:3 row_mask:0xf bank_mask:0xf
    v_cvt_pk_bf16_f32 v229, v16, v17
    v_cvt_pk_bf16_f32 v231, v18, v19
    v_permlane16_swap_b32 v242, v243
    v_permlane16_swap_b32 v244, v245
    v_permlane16_swap_b32 v228, v229
    v_permlane16_swap_b32 v230, v231
    s_waitcnt lgkmcnt(0)
    v_lshlrev_b32 v24, 16, v0
    v_and_b32 v25, 0xffff0000, v0
    v_lshlrev_b32 v26, 16, v1
    v_and_b32 v27, 0xffff0000, v1
    v_mov_b32 v2, v1
    v_mul_f32_dpp v32, v43, v24 row_newbcast:4 row_mask:0xf bank_mask:0xf
    v_mul_f32_dpp v33, v43, v25 row_newbcast:5 row_mask:0xf bank_mask:0xf
    v_mul_f32_dpp v34, v43, v26 row_newbcast:6 row_mask:0xf bank_mask:0xf
    v_mul_f32_dpp v35, v43, v27 row_newbcast:7 row_mask:0xf bank_mask:0xf
    v_cvt_pk_bf16_f32 v4, v32, v33
    v_cvt_pk_bf16_f32 v6, v34, v35
    v_mul_f32_dpp v36, v43, v24 row_newbcast:8 row_mask:0xf bank_mask:0xf
    v_mul_f32_dpp v37, v43, v25 row_newbcast:9 row_mask:0xf bank_mask:0xf
    v_mul_f32_dpp v38, v43, v26 row_newbcast:10 row_mask:0xf bank_mask:0xf
    v_mul_f32_dpp v39, v43, v27 row_newbcast:11 row_mask:0xf bank_mask:0xf
    v_cvt_pk_bf16_f32 v5, v36, v37
    v_cvt_pk_bf16_f32 v7, v38, v39
    v_mul_f32_dpp v24, v43, v24 row_newbcast:0 row_mask:0xf bank_mask:0xf
    v_mul_f32_dpp v25, v43, v25 row_newbcast:1 row_mask:0xf bank_mask:0xf
    v_mul_f32_dpp v26, v43, v26 row_newbcast:2 row_mask:0xf bank_mask:0xf
    v_mul_f32_dpp v27, v43, v27 row_newbcast:3 row_mask:0xf bank_mask:0xf
    v_cvt_pk_bf16_f32 v1, v24, v25
    v_cvt_pk_bf16_f32 v3, v26, v27
    v_permlane16_swap_b32 v4, v5
    v_permlane16_swap_b32 v6, v7
    v_permlane16_swap_b32 v0, v1
    v_permlane16_swap_b32 v2, v3
    s_waitcnt vmcnt(4)
    v_mfma_f32_32x32x16_bf16 v[8:23], v[80:83], v[176:179], 0
    ds_read_b64_tr_b16 v[184:185], v246 offset:2048
    ds_read_b64_tr_b16 v[186:187], v246 offset:3072
    ds_read_b64_tr_b16 v[188:189], v247 offset:2048
    ds_read_b64_tr_b16 v[190:191], v247 offset:3072
    s_mov_b32 m0, s68
    v_mfma_f32_32x32x16_bf16 v[24:39], v[84:87], v[176:179], 0
    buffer_load_dwordx4 v222, s[4:7], s41 offen sc1 lds
    buffer_load_dwordx4 v223, s[72:75], s41 offen offset:1024 sc1 lds
    v_permlane32_swap_b32 v236, v234
    v_permlane32_swap_b32 v237, v235
    s_add_u32 s38, s38, 1
    v_mfma_f32_32x32x16_bf16 v[48:63], v[80:83], v[180:183], 0
    v_permlane32_swap_b32 v240, v238
    v_permlane32_swap_b32 v241, v239
    v_add_f32 v236, v236, v234
    v_add_f32 v237, v237, v235
    v_add_f32 v240, -v240, -v238
    v_mfma_f32_32x32x16_bf16 v[64:79], v[84:87], v[180:183], 0
    v_add_f32 v241, -v241, -v239
    s_set_gpr_idx_on s32, gpr_idx(DST)
    s_nop 0
    v_cvt_pk_bf16_f32 v194, v236, v237
    v_cvt_pk_bf16_f32 v195, v240, v241
    s_set_gpr_idx_off
    v_mov_b32 v254, s52
    s_waitcnt vmcnt(4) lgkmcnt(0)
    v_mfma_f32_32x32x16_bf16 v[8:23], v[88:91], v[184:187], v[8:23]
    ds_read_b64_tr_b16 v[176:177], v246 offset:4096
    ds_read_b64_tr_b16 v[178:179], v246 offset:5120
    ds_read_b64_tr_b16 v[180:181], v247 offset:4096
    ds_read_b64_tr_b16 v[182:183], v247 offset:5120
    v_mov_b32 v255, s38
    s_lshl_b32 s58, s38, 3
    s_mov_b32 m0, s69
    v_mfma_f32_32x32x16_bf16 v[24:39], v[92:95], v[184:187], v[24:39]
    buffer_load_dwordx4 v224, s[4:7], s41 offen sc1 lds
    buffer_load_dwordx4 v225, s[72:75], s41 offen offset:1024 sc1 lds
    s_add_u32 s58, s58, s20
    s_mov_b64 exec, 1
    ds_write_b32 v254, v255
    s_mov_b64 exec, -1
    s_cmp_lt_u32 s58, s22
    s_cbranch_scc0 K2_dyn_106
K2_back_107:
    v_readlane_b32 s3, v253, s58
    s_lshl_b32 s44, s34, 7
    s_and_b32 s48, s3, 0x3ffff
    s_bfe_u32 s33, s3, 0x30013
    s_mul_i32 s35, s38, 6
    s_cmp_eq_u32 s34, 0
    s_cselect_b32 s35, s35, s48
    s_mov_b32 s45, s44
    s_xor_b32 s47, s44, 256
    s_add_u32 s49, s48, 128
    s_add_u32 s60, s48, 256
    s_cmp_eq_u32 s33, 3
    s_cselect_b32 s46, s44, s47
    s_cselect_b32 s50, s60, s48
    s_sub_u32 s60, s33, 2
    s_cmp_lt_u32 s60, 2
    s_cbranch_scc0 K2_rare_112
K2_back_113:
    v_mfma_f32_32x32x16_bf16 v[48:63], v[88:91], v[188:191], v[48:63]
    v_add_u32 v43, s48, v232
    ds_read_b32 v42, v43
    ds_read_b32 v43, v43 offset:1024
    v_mfma_f32_32x32x16_bf16 v[64:79], v[92:95], v[188:191], v[64:79]
    s_waitcnt vmcnt(4) lgkmcnt(3)
    v_mfma_f32_32x32x16_bf16 v[8:23], v[228:231], v[176:179], v[8:23]
    ds_read_b64_tr_b16 v[184:185], v246 offset:6144
    ds_read_b64_tr_b16 v[186:187], v246 offset:7168
    ds_read_b64_tr_b16 v[188:189], v247 offset:6144
    ds_read_b64_tr_b16 v[190:191], v247 offset:7168
    s_mov_b32 m0, s70
    v_mfma_f32_32x32x16_bf16 v[24:39], v[242:245], v[176:179], v[24:39]
    buffer_load_dwordx4 v226, s[4:7], s41 offen sc1 lds
    buffer_load_dwordx4 v227, s[72:75], s41 offen offset:1024 sc1 lds
    v_mfma_f32_32x32x16_bf16 v[48:63], v[228:231], v[180:183], v[48:63]
    v_mfma_f32_32x32x16_bf16 v[64:79], v[242:245], v[180:183], v[64:79]
    s_waitcnt lgkmcnt(4)
    v_or_b32 v42, v42, v233
    v_or_b32 v43, v43, v233
    s_cmp_lg_u32 s34, 0
    s_cbranch_scc1 K2_dum_117
    s_cmp_eq_u32 s33, 4
    s_cbranch_scc1 K2_a4_118
K2_b4_120:
    s_add_u32 m0, s48, 512
    s_add_u32 s65, s48, 1536
    buffer_load_dwordx4 v42, s[16:19], 0 offen  lds
    s_mov_b32 m0, s65
    s_mov_b32 exec_hi, 0
    buffer_load_dwordx4 v43, s[16:19], 0 offen  lds
    s_mov_b32 exec_hi, -1
K2_back_119:
    s_waitcnt vmcnt(6) lgkmcnt(0)
    v_mfma_f32_32x32x16_bf16 v[8:23], v[0:3], v[184:187], v[8:23]
    ds_read_b64_tr_b16 v[176:177], v246 offset:0
    ds_read_b64_tr_b16 v[178:179], v246 offset:1024
    ds_read_b64_tr_b16 v[180:181], v247 offset:0
    ds_read_b64_tr_b16 v[182:183], v247 offset:1024
    s_mov_b32 m0, s71
    v_mfma_f32_32x32x16_bf16 v[24:39], v[4:7], v[184:187], v[24:39]
    buffer_load_dwordx4 v44, s[4:7], s41 offen sc1 lds
    buffer_load_dwordx4 v45, s[72:75], s41 offen offset:1024 sc1 lds
    v_mfma_f32_32x32x16_bf16 v[48:63], v[0:3], v[188:191], v[48:63]
    s_nop 2
    v_mul_f32 v234, v8, v96
    v_mul_f32 v236, v16, v128
    v_fmac_f32 v234, v9, v97
    v_fmac_f32 v236, v17, v129
    v_fmac_f32 v234, v10, v98
    v_fmac_f32 v236, v18, v130
    v_fmac_f32 v234, v11, v99
    v_mfma_f32_32x32x16_bf16 v[64:79], v[4:7], v[188:191], v[64:79]
    s_setprio 0
    v_fmac_f32 v236, v19, v131
    v_fmac_f32 v234, v12, v100
    v_fmac_f32 v236, v20, v132
    v_fmac_f32 v234, v13, v101
    v_fmac_f32 v236, v21, v133
    v_fmac_f32 v234, v14, v102
    v_fmac_f32 v236, v22, v134
    v_fmac_f32 v234, v15, v103
    v_fmac_f32 v236, v23, v135
    v_mul_f32 v238, v24, v128
    v_mul_f32 v240, v32, v128
    v_fmac_f32 v238, v25, v129
    v_fmac_f32 v240, v33, v129
    v_fmac_f32 v238, v26, v130
    v_fmac_f32 v240, v34, v130
    v_fmac_f32 v238, v27, v131
    v_fmac_f32 v240, v35, v131
    v_fmac_f32 v238, v28, v132
    v_fmac_f32 v240, v36, v132
    v_fmac_f32 v238, v29, v133
    v_fmac_f32 v240, v37, v133
    v_fmac_f32 v238, v30, v134
    v_fmac_f32 v240, v38, v134
    v_fmac_f32 v238, v31, v135
    v_fmac_f32 v240, v39, v135
    v_mul_f32 v235, v48, v104
    v_mul_f32 v237, v56, v136
    v_fmac_f32 v235, v49, v105
    v_fmac_f32 v237, v57, v137
    v_fmac_f32 v235, v50, v106
    v_fmac_f32 v237, v58, v138
    v_fmac_f32 v235, v51, v107
    v_fmac_f32 v237, v59, v139
    v_fmac_f32 v235, v52, v108
    v_fmac_f32 v237, v60, v140
    v_fmac_f32 v235, v53, v109
    v_fmac_f32 v237, v61, v141
    v_fmac_f32 v235, v54, v110
    v_fmac_f32 v237, v62, v142
    v_fmac_f32 v235, v55, v111
    v_fmac_f32 v237, v63, v143
    v_mul_f32 v239, v64, v136
    v_mul_f32 v241, v72, v136
    s_setprio 1
    s_waitcnt vmcnt(6) lgkmcnt(0)
    v_mfma_f32_32x32x16_bf16 v[8:23], v[80:83], v[176:179], 0
    ds_read_b64_tr_b16 v[184:185], v246 offset:2048
    ds_read_b64_tr_b16 v[186:187], v246 offset:3072
    ds_read_b64_tr_b16 v[188:189], v247 offset:2048
    ds_read_b64_tr_b16 v[190:191], v247 offset:3072
    v_fmac_f32 v239, v65, v137
    v_fmac_f32 v241, v73, v137
    s_mov_b32 m0, s68
    v_mfma_f32_32x32x16_bf16 v[24:39], v[84:87], v[176:179], 0
    buffer_load_dwordx4 v222, s[4:7], s42 offen sc1 lds
    buffer_load_dwordx4 v223, s[72:75], s42 offen offset:1024 sc1 lds
    v_fmac_f32 v239, v66, v138
    v_fmac_f32 v241, v74, v138
    v_fmac_f32 v239, v67, v139
    v_fmac_f32 v241, v75, v139
    v_fmac_f32 v239, v68, v140
    v_mfma_f32_32x32x16_bf16 v[48:63], v[80:83], v[180:183], 0
    v_fmac_f32 v241, v76, v140
    v_fmac_f32 v239, v69, v141
    v_fmac_f32 v241, v77, v141
    v_fmac_f32 v239, v70, v142
    v_fmac_f32 v241, v78, v142
    v_fmac_f32 v239, v71, v143
    v_fmac_f32 v241, v79, v143
    v_mfma_f32_32x32x16_bf16 v[64:79], v[84:87], v[180:183], 0
    v_permlane32_swap_b32 v234, v236
    v_permlane32_swap_b32 v235, v237
    v_permlane32_swap_b32 v238, v239
    s_waitcnt vmcnt(6) lgkmcnt(0)
    v_mfma_f32_32x32x16_bf16 v[8:23], v[88:91], v[184:187], v[8:23]
    ds_read_b64_tr_b16 v[176:177], v246 offset:4096
    ds_read_b64_tr_b16 v[178:179], v246 offset:5120
    ds_read_b64_tr_b16 v[180:181], v247 offset:4096
    ds_read_b64_tr_b16 v[182:183], v247 offset:5120
    v_add_f32 v234, v234, v236
    v_add_f32 v235, v235, v237
    s_mov_b32 m0, s69
    v_mfma_f32_32x32x16_bf16 v[24:39], v[92:95], v[184:187], v[24:39]
    buffer_load_dwordx4 v224, s[4:7], s42 offen sc1 lds
    buffer_load_dwordx4 v225, s[72:75], s42 offen offset:1024 sc1 lds
    v_add_f32 v238, -v238, -v239
    s_set_gpr_idx_on s31, gpr_idx(DST)
    s_nop 0
    v_cvt_pk_bf16_f32 v192, v234, v235
    v_cvt_pk_bf16_f32 v197, v238, v238
    s_set_gpr_idx_off
    v_mfma_f32_32x32x16_bf16 v[48:63], v[88:91], v[188:191], v[48:63]
    v_mfma_f32_32x32x16_bf16 v[64:79], v[92:95], v[188:191], v[64:79]
    s_waitcnt vmcnt(4) lgkmcnt(0)
    v_mfma_f32_32x32x16_bf16 v[8:23], v[228:231], v[176:179], v[8:23]
    ds_read_b64_tr_b16 v[184:185], v246 offset:6144
    ds_read_b64_tr_b16 v[186:187], v246 offset:7168
    ds_read_b64_tr_b16 v[188:189], v247 offset:6144
    ds_read_b64_tr_b16 v[190:191], v247 offset:7168
    s_mov_b32 m0, s70
    v_mfma_f32_32x32x16_bf16 v[24:39], v[242:245], v[176:179], v[24:39]
    buffer_load_dwordx4 v226, s[4:7], s42 offen sc1 lds
    buffer_load_dwordx4 v227, s[72:75], s42 offen offset:1024 sc1 lds
    v_mfma_f32_32x32x16_bf16 v[48:63], v[228:231], v[180:183], v[48:63]
    v_mfma_f32_32x32x16_bf16 v[64:79], v[242:245], v[180:183], v[64:79]
    s_waitcnt vmcnt(4) lgkmcnt(0)
    v_mfma_f32_32x32x16_bf16 v[8:23], v[0:3], v[184:187], v[8:23]
    ds_read_b64_tr_b16 v[176:177], v246 offset:0
    ds_read_b64_tr_b16 v[178:179], v246 offset:1024
    ds_read_b64_tr_b16 v[180:181], v247 offset:0
    ds_read_b64_tr_b16 v[182:183], v247 offset:1024
    s_mov_b32 m0, s71
    v_mfma_f32_32x32x16_bf16 v[24:39], v[4:7], v[184:187], v[24:39]
    buffer_load_dwordx4 v44, s[4:7], s42 offen sc1 lds
    buffer_load_dwordx4 v45, s[72:75], s42 offen offset:1024 sc1 lds
    v_mfma_f32_32x32x16_bf16 v[48:63], v[0:3], v[188:191], v[48:63]
    s_nop 2
    v_mul_f32 v46, v8, v144
    v_mul_f32 v234, v16, v112
    v_fmac_f32 v46, v9, v145
    v_fmac_f32 v234, v17, v113
    v_fmac_f32 v46, v10, v146
    v_fmac_f32 v234, v18, v114
    v_fmac_f32 v46, v11, v147
    v_mfma_f32_32x32x16_bf16 v[64:79], v[4:7], v[188:191], v[64:79]
    s_setprio 0
    v_fmac_f32 v234, v19, v115
    v_fmac_f32 v46, v12, v148
    v_fmac_f32 v234, v20, v116
    v_fmac_f32 v46, v13, v149
    v_fmac_f32 v234, v21, v117
    v_fmac_f32 v46, v14, v150
    v_fmac_f32 v234, v22, v118
    v_fmac_f32 v46, v15, v151
    v_fmac_f32 v234, v23, v119
    v_mul_f32 v236, v24, v160
    v_mul_f32 v238, v32, v160
    v_fmac_f32 v236, v25, v161
    v_fmac_f32 v238, v33, v161
    v_fmac_f32 v236, v26, v162
    v_fmac_f32 v238, v34, v162
    v_fmac_f32 v236, v27, v163
    v_fmac_f32 v238, v35, v163
    v_fmac_f32 v236, v28, v164
    v_fmac_f32 v238, v36, v164
    v_fmac_f32 v236, v29, v165
    v_fmac_f32 v238, v37, v165
    v_fmac_f32 v236, v30, v166
    v_fmac_f32 v238, v38, v166
    v_fmac_f32 v236, v31, v167
    v_fmac_f32 v238, v39, v167
    v_mul_f32 v47, v48, v152
    v_mul_f32 v235, v56, v120
    v_fmac_f32 v47, v49, v153
    v_fmac_f32 v235, v57, v121
    v_fmac_f32 v47, v50, v154
    v_fmac_f32 v235, v58, v122
    v_fmac_f32 v47, v51, v155
    v_fmac_f32 v235, v59, v123
    v_fmac_f32 v47, v52, v156
    v_fmac_f32 v235, v60, v124
    v_fmac_f32 v47, v53, v157
    v_fmac_f32 v235, v61, v125
    v_fmac_f32 v47, v54, v158
    v_fmac_f32 v235, v62, v126
    v_fmac_f32 v47, v55, v159
    v_fmac_f32 v235, v63, v127
    v_mul_f32 v237, v64, v168
    v_mul_f32 v239, v72, v168
    s_setprio 1
    s_waitcnt vmcnt(4) lgkmcnt(0)
    v_mfma_f32_32x32x16_bf16 v[8:23], v[80:83], v[176:179], 0
    ds_read_b64_tr_b16 v[184:185], v246 offset:2048
    ds_read_b64_tr_b16 v[186:187], v246 offset:3072
    ds_read_b64_tr_b16 v[188:189], v247 offset:2048
    ds_read_b64_tr_b16 v[190:191], v247 offset:3072
    v_fmac_f32 v237, v65, v169
    v_fmac_f32 v239, v73, v169
    s_mov_b32 m0, s68
    v_mfma_f32_32x32x16_bf16 v[24:39], v[84:87], v[176:179], 0
    buffer_load_dwordx4 v222, s[4:7], s43 offen sc1 lds
    buffer_load_dwordx4 v223, s[72:75], s43 offen offset:1024 sc1 lds
    v_fmac_f32 v237, v66, v170
    v_fmac_f32 v239, v74, v170
    v_fmac_f32 v237, v67, v171
    v_fmac_f32 v239, v75, v171
    v_fmac_f32 v237, v68, v172
    v_mfma_f32_32x32x16_bf16 v[48:63], v[80:83], v[180:183], 0
    v_fmac_f32 v239, v76, v172
    v_fmac_f32 v237, v69, v173
    v_fmac_f32 v239, v77, v173
    v_fmac_f32 v237, v70, v174
    v_fmac_f32 v239, v78, v174
    v_fmac_f32 v237, v71, v175
    v_fmac_f32 v239, v79, v175
    v_mfma_f32_32x32x16_bf16 v[64:79], v[84:87], v[180:183], 0
    v_permlane32_swap_b32 v46, v240
    v_permlane32_swap_b32 v47, v241
    v_add_f32 v46, v46, v240
    v_add_f32 v47, v47, v241
    s_waitcnt vmcnt(4) lgkmcnt(0)
    v_mfma_f32_32x32x16_bf16 v[8:23], v[88:91], v[184:187], v[8:23]
    ds_read_b64_tr_b16 v[176:177], v246 offset:4096
    ds_read_b64_tr_b16 v[178:179], v246 offset:5120
    ds_read_b64_tr_b16 v[180:181], v247 offset:4096
    ds_read_b64_tr_b16 v[182:183], v247 offset:5120
    s_mov_b32 m0, s69
    v_mfma_f32_32x32x16_bf16 v[24:39], v[92:95], v[184:187], v[24:39]
    buffer_load_dwordx4 v224, s[4:7], s43 offen sc1 lds
    buffer_load_dwordx4 v225, s[72:75], s43 offen offset:1024 sc1 lds
    s_set_gpr_idx_on s31, gpr_idx(DST)
    s_nop 0
    v_cvt_pk_bf16_f32 v193, v46, v47
    s_set_gpr_idx_off
    v_mfma_f32_32x32x16_bf16 v[48:63], v[88:91], v[188:191], v[48:63]
    v_mfma_f32_32x32x16_bf16 v[64:79], v[92:95], v[188:191], v[64:79]
    s_waitcnt vmcnt(4) lgkmcnt(0)
    v_mfma_f32_32x32x16_bf16 v[8:23], v[228:231], v[176:179], v[8:23]
    ds_read_b64_tr_b16 v[184:185], v246 offset:6144
    ds_read_b64_tr_b16 v[186:187], v246 offset:7168
    ds_read_b64_tr_b16 v[188:189], v247 offset:6144
    ds_read_b64_tr_b16 v[190:191], v247 offset:7168
    s_mov_b32 m0, s70
    v_mfma_f32_32x32x16_bf16 v[24:39], v[242:245], v[176:179], v[24:39]
    buffer_load_dwordx4 v226, s[4:7], s43 offen sc1 lds
    buffer_load_dwordx4 v227, s[72:75], s43 offen offset:1024 sc1 lds
    v_mfma_f32_32x32x16_bf16 v[48:63], v[228:231], v[180:183], v[48:63]
    v_add_u32 v222, s48, v251
    ds_read2_b32 v[222:223], v222 offset0:1 offset1:3
    v_mfma_f32_32x32x16_bf16 v[64:79], v[242:245], v[180:183], v[64:79]
    s_waitcnt vmcnt(4) lgkmcnt(1)
    v_mfma_f32_32x32x16_bf16 v[8:23], v[0:3], v[184:187], v[8:23]
    ds_read_b64_tr_b16 v[176:177], v246 offset:0
    ds_read_b64_tr_b16 v[178:179], v246 offset:1024
    ds_read_b64_tr_b16 v[180:181], v247 offset:0
    ds_read_b64_tr_b16 v[182:183], v247 offset:1024
    s_mov_b32 m0, s71
    v_mfma_f32_32x32x16_bf16 v[24:39], v[4:7], v[184:187], v[24:39]
    buffer_load_dwordx4 v44, s[4:7], s43 offen sc1 lds
    buffer_load_dwordx4 v45, s[72:75], s43 offen offset:1024 sc1 lds
    s_waitcnt lgkmcnt(4)
    v_mad_u32_u16 v222, v222, s39, v248 op_sel:[1,0,0,0]
    v_mad_u32_u16 v223, v223, s39, v248 op_sel:[1,0,0,0]
    v_mfma_f32_32x32x16_bf16 v[48:63], v[0:3], v[188:191], v[48:63]
    v_add_u32 v224, s49, v251
    ds_read2_b32 v[224:225], v224 offset0:1 offset1:3
    v_mul_f32 v46, v8, v144
    v_fmac_f32 v236, v16, v160
    v_fmac_f32 v46, v9, v145
    v_fmac_f32 v236, v17, v161
    v_fmac_f32 v46, v10, v146
    v_mfma_f32_32x32x16_bf16 v[64:79], v[4:7], v[188:191], v[64:79]
    s_setprio 0
    v_fmac_f32 v236, v18, v162
    v_fmac_f32 v46, v11, v147
    v_fmac_f32 v236, v19, v163
    v_fmac_f32 v46, v12, v148
    v_fmac_f32 v236, v20, v164
    v_fmac_f32 v46, v13, v149
    v_fmac_f32 v236, v21, v165
    v_fmac_f32 v46, v14, v150
    v_fmac_f32 v236, v22, v166
    v_fmac_f32 v46, v15, v151
    v_fmac_f32 v236, v23, v167
    v_fma_f32 v234, v24, v112, -v234
    v_mul_f32 v240, v32, v160
    v_fmac_f32 v234, v25, v113
    v_fmac_f32 v240, v33, v161
    v_fmac_f32 v234, v26, v114
    v_fmac_f32 v240, v34, v162
    v_fmac_f32 v234, v27, v115
    v_fmac_f32 v240, v35, v163
    v_fmac_f32 v234, v28, v116
    v_fmac_f32 v240, v36, v164
    v_fmac_f32 v234, v29, v117
    v_fmac_f32 v240, v37, v165
    v_fmac_f32 v234, v30, v118
    v_fmac_f32 v240, v38, v166
    v_fmac_f32 v234, v31, v119
    v_fmac_f32 v240, v39, v167
    v_mul_f32 v47, v48, v152
    v_fmac_f32 v237, v56, v168
    v_fmac_f32 v47, v49, v153
    v_fmac_f32 v237, v57, v169
    v_fmac_f32 v47, v50, v154
    v_fmac_f32 v237, v58, v170
    v_fmac_f32 v47, v51, v155
    v_fmac_f32 v237, v59, v171
    v_fmac_f32 v47, v52, v156
    v_fmac_f32 v237, v60, v172
    v_fmac_f32 v47, v53, v157
    v_fmac_f32 v237, v61, v173
    v_fmac_f32 v47, v54, v158
    v_fmac_f32 v237, v62, v174
    v_fmac_f32 v47, v55, v159
    v_fmac_f32 v237, v63, v175
    v_fma_f32 v235, v64, v120, -v235
    v_mul_f32 v241, v72, v168
    v_fmac_f32 v235, v65, v121
    v_fmac_f32 v241, v73, v169
    v_fmac_f32 v235, v66, v122
    v_fmac_f32 v241, v74, v170
    v_fmac_f32 v235, v67, v123
    s_setprio 1
    s_waitcnt vmcnt(4) lgkmcnt(1)
    v_mfma_f32_32x32x16_bf16 v[8:23], v[80:83], v[176:179], 0
    ds_read_b64_tr_b16 v[184:185], v246 offset:2048
    ds_read_b64_tr_b16 v[186:187], v246 offset:3072
    ds_read_b64_tr_b16 v[188:189], v247 offset:2048
    ds_read_b64_tr_b16 v[190:191], v247 offset:3072
    v_fmac_f32 v241, v75, v171
    v_fmac_f32 v235, v68, v124
    s_mov_b32 m0, s68
    v_mfma_f32_32x32x16_bf16 v[24:39], v[84:87], v[176:179], 0
    buffer_load_dwordx4 v222, s[4:7], s44 offen sc1 lds
    buffer_load_dwordx4 v223, s[72:75], s44 offen offset:1024 sc1 lds
    s_waitcnt lgkmcnt(4)
    v_mad_u32_u16 v224, v224, s39, v248 op_sel:[1,0,0,0]
    v_mad_u32_u16 v225, v225, s39, v248 op_sel:[1,0,0,0]
    v_fmac_f32 v241, v76, v172
    v_fmac_f32 v235, v69, v125
    v_mfma_f32_32x32x16_bf16 v[48:63], v[80:83], v[180:183], 0
    v_add_u32 v226, s50, v251
    ds_read2_b32 v[226:227], v226 offset0:1 offset1:3
    v_fmac_f32 v241, v77, v173
    v_fmac_f32 v235, v70, v126
    v_fmac_f32 v241, v78, v174
    v_fmac_f32 v235, v71, v127
    v_fmac_f32 v241, v79, v175
    v_mfma_f32_32x32x16_bf16 v[64:79], v[84:87], v[180:183], 0
    v_permlane32_swap_b32 v236, v46
    v_permlane32_swap_b32 v237, v47
    v_add_f32 v236, v236, v46
    v_add_f32 v237, v237, v47
    s_waitcnt vmcnt(4) lgkmcnt(1)
    v_mfma_f32_32x32x16_bf16 v[8:23], v[88:91], v[184:187], v[8:23]
    ds_read_b64_tr_b16 v[176:177], v246 offset:4096
    ds_read_b64_tr_b16 v[178:179], v246 offset:5120
    ds_read_b64_tr_b16 v[180:181], v247 offset:4096
    ds_read_b64_tr_b16 v[182:183], v247 offset:5120
    s_mov_b32 m0, s69
    v_mfma_f32_32x32x16_bf16 v[24:39], v[92:95], v[184:187], v[24:39]
    buffer_load_dwordx4 v224, s[4:7], s45 offen sc1 lds
    buffer_load_dwordx4 v225, s[72:75], s45 offen offset:1024 sc1 lds
    s_waitcnt lgkmcnt(4)
    v_mad_u32_u16 v226, v226, s39, v248 op_sel:[1,0,0,0]
    v_mad_u32_u16 v227, v227, s39, v248 op_sel:[1,0,0,0]
    v_mfma_f32_32x32x16_bf16 v[48:63], v[88:91], v[188:191], v[48:63]
    s_set_gpr_idx_on s31, gpr_idx(DST)
    s_nop 0
    v_cvt_pk_bf16_f32 v196, v236, v237
    s_set_gpr_idx_off
    v_mfma_f32_32x32x16_bf16 v[64:79], v[92:95], v[188:191], v[64:79]
    s_waitcnt vmcnt(4) lgkmcnt(0)
    v_mfma_f32_32x32x16_bf16 v[8:23], v[228:231], v[176:179], v[8:23]
    ds_read_b64_tr_b16 v[184:185], v246 offset:6144
    ds_read_b64_tr_b16 v[186:187], v246 offset:7168
    ds_read_b64_tr_b16 v[188:189], v247 offset:6144
    ds_read_b64_tr_b16 v[190:191], v247 offset:7168
    s_mov_b32 s32, s31
    s_mov_b32 s31, s35
    s_mov_b32 m0, s70
    v_mfma_f32_32x32x16_bf16 v[24:39], v[242:245], v[176:179], v[24:39]
    buffer_load_dwordx4 v226, s[4:7], s46 offen sc1 lds
    buffer_load_dwordx4 v227, s[72:75], s46 offen offset:1024 sc1 lds
    s_sub_u32 s26, s48, s29
    s_mov_b32 s29, s48
    s_mov_b32 s30, s3
    s_bfe_u32 s56, s3, 0x40012
    v_mfma_f32_32x32x16_bf16 v[48:63], v[228:231], v[180:183], v[48:63]
    s_cmp_eq_u32 s34, 0
    s_cselect_b32 s56, s56, 0
    v_mfma_f32_32x32x16_bf16 v[64:79], v[242:245], v[180:183], v[64:79]
    s_waitcnt vmcnt(4) lgkmcnt(0)
    v_mfma_f32_32x32x16_bf16 v[8:23], v[0:3], v[184:187], v[8:23]
    ds_read_b64_tr_b16 v[176:177], v246 offset:0
    ds_read_b64_tr_b16 v[178:179], v246 offset:1024
    ds_read_b64_tr_b16 v[180:181], v247 offset:0
    ds_read_b64_tr_b16 v[182:183], v247 offset:1024
    s_mov_b32 m0, s71
    v_mfma_f32_32x32x16_bf16 v[24:39], v[4:7], v[184:187], v[24:39]
    s_cmp_eq_u32 s33, 4
    s_cbranch_scc1 K2_g4_115
    buffer_load_dwordx4 v224, s[4:7], s47 offen sc1 lds
    buffer_load_dwordx4 v225, s[72:75], s47 offen offset:1024 sc1 lds
K2_back_116:
    v_mfma_f32_32x32x16_bf16 v[48:63], v[0:3], v[188:191], v[48:63]
    s_nop 0
    v_mul_f32 v236, v8, v144
    v_fma_f32 v238, v16, v160, -v238
    v_fmac_f32 v236, v9, v145
    v_fmac_f32 v238, v17, v161
    v_fmac_f32 v236, v10, v146
    v_fmac_f32 v238, v18, v162
    v_fmac_f32 v236, v11, v147
    v_mfma_f32_32x32x16_bf16 v[64:79], v[4:7], v[188:191], v[64:79]
    s_setprio 0
    v_fmac_f32 v238, v19, v163
    v_fmac_f32 v236, v12, v148
    v_fmac_f32 v238, v20, v164
    v_fmac_f32 v236, v13, v149
    v_fmac_f32 v238, v21, v165
    v_fmac_f32 v236, v14, v150
    v_fmac_f32 v238, v22, v166
    v_fmac_f32 v236, v15, v151
    v_fmac_f32 v238, v23, v167
    v_add_u32 v249, s26, v249
    v_add_u32 v250, s26, v250
    v_fmac_f32 v240, v24, v160
    v_fma_f32 v234, v32, v112, -v234
    v_fmac_f32 v240, v25, v161
    v_fmac_f32 v234, v33, v113
    v_fmac_f32 v240, v26, v162
    v_fmac_f32 v234, v34, v114
    v_fmac_f32 v240, v27, v163
    v_fmac_f32 v234, v35, v115
    v_fmac_f32 v240, v28, v164
    v_fmac_f32 v234, v36, v116
    v_fmac_f32 v240, v29, v165
    v_fmac_f32 v234, v37, v117
    v_fmac_f32 v240, v30, v166
    v_fmac_f32 v234, v38, v118
    v_fmac_f32 v240, v31, v167
    v_fmac_f32 v234, v39, v119
    ds_read_b64_tr_b16 v[80:81], v249 offset:0
    ds_read_u16_d16_hi v40, v250 offset:0
    v_mul_f32 v237, v48, v152
    v_fma_f32 v239, v56, v168, -v239
    v_fmac_f32 v237, v49, v153
    v_fmac_f32 v239, v57, v169
    v_fmac_f32 v237, v50, v154
    v_fmac_f32 v239, v58, v170
    v_fmac_f32 v237, v51, v155
    v_fmac_f32 v239, v59, v171
    v_fmac_f32 v237, v52, v156
    v_fmac_f32 v239, v60, v172
    v_fmac_f32 v237, v53, v157
    v_fmac_f32 v239, v61, v173
    v_fmac_f32 v237, v54, v158
    v_fmac_f32 v239, v62, v174
    v_fmac_f32 v237, v55, v159
    v_fmac_f32 v239, v63, v175
    ds_read_b64_tr_b16 v[88:89], v249 offset:512
    ds_read_u16_d16_hi v41, v250 offset:128
    v_fmac_f32 v241, v64, v168
    v_fma_f32 v235, v72, v120, -v235
    v_fmac_f32 v241, v65, v169
    v_fmac_f32 v235, v73, v121
    v_fmac_f32 v241, v66, v170
    v_fmac_f32 v235, v74, v122
    v_fmac_f32 v241, v67, v171
    v_fmac_f32 v235, v75, v123
    v_fmac_f32 v241, v68, v172
    v_fmac_f32 v235, v76, v124
    v_fmac_f32 v241, v69, v173
    v_fmac_f32 v235, v77, v125
    v_fmac_f32 v241, v70, v174
    v_fmac_f32 v235, v78, v126
    v_fmac_f32 v241, v71, v175
    v_fmac_f32 v235, v79, v127
    s_cmp_eq_u32 s56, 5
    s_cbranch_scc1 K2_U20
    s_cmp_eq_u32 s56, 6
    s_cbranch_scc1 K2_U3h0
    s_branch K2_DSP0
K2_U11:
    s_setprio 1
    s_mov_b64 exec, 0x1ff
    ds_add_rtn_u32 v42, v254, v251
    s_mov_b64 exec, -1
    s_waitcnt lgkmcnt(3)
    v_lshlrev_b32 v16, 16, v80
    v_and_b32 v17, 0xffff0000, v80
    v_lshlrev_b32 v18, 16, v81
    v_and_b32 v19, 0xffff0000, v81
    v_mov_b32 v82, v81
    v_mul_f32_dpp v32, v40, v16 row_newbcast:4 row_mask:0xf bank_mask:0xf
    v_mul_f32_dpp v33, v40, v17 row_newbcast:5 row_mask:0xf bank_mask:0xf
    v_mul_f32_dpp v34, v40, v18 row_newbcast:6 row_mask:0xf bank_mask:0xf
    v_mul_f32_dpp v35, v40, v19 row_newbcast:7 row_mask:0xf bank_mask:0xf
    v_cvt_pk_bf16_f32 v84, v32, v33
    v_cvt_pk_bf16_f32 v86, v34, v35
    v_mul_f32_dpp v36, v40, v16 row_newbcast:8 row_mask:0xf bank_mask:0xf
    v_mul_f32_dpp v37, v40, v17 row_newbcast:9 row_mask:0xf bank_mask:0xf
    v_mul_f32_dpp v38, v40, v18 row_newbcast:10 row_mask:0xf bank_mask:0xf
    v_mul_f32_dpp v39, v40, v19 row_newbcast:11 row_mask:0xf bank_mask:0xf
    v_cvt_pk_bf16_f32 v85, v36, v37
    v_cvt_pk_bf16_f32 v87, v38, v39
    v_mul_f32_dpp v16, v40, v16 row_newbcast:0 row_mask:0xf bank_mask:0xf
    v_mul_f32_dpp v17, v40, v17 row_newbcast:1 row_mask:0xf bank_mask:0xf
    v_mul_f32_dpp v18, v40, v18 row_newbcast:2 row_mask:0xf bank_mask:0xf
    v_mul_f32_dpp v19, v40, v19 row_newbcast:3 row_mask:0xf bank_mask:0xf
    v_cvt_pk_bf16_f32 v81, v16, v17
    v_cvt_pk_bf16_f32 v83, v18, v19
    v_permlane16_swap_b32 v84, v85
    v_permlane16_swap_b32 v86, v87
    v_permlane16_swap_b32 v80, v81
    v_permlane16_swap_b32 v82, v83
    s_waitcnt lgkmcnt(0)
    v_readlane_b32 s58, v42, 8
    s_nop 0
    s_lshr_b32 s58, s58, 4
    s_cmp_lt_u32 s58, s22
    s_cbranch_scc0 K2_nul_121
    v_readlane_b32 s3, v253, s58
    s_nop 0
    s_bfe_u32 s58, s3, 0x60016
    s_and_b32 s59, s58, 7
    s_lshr_b32 s60, s58, 3
K2_chk_123:
    v_readlane_b32 s61, v42, s59
    s_nop 0
    s_cmp_gt_u32 s61, s60
    s_cbranch_scc0 K2_spin_122
K2_back_124:
    s_lshl_b32 s44, s34, 7
    s_and_b32 s48, s3, 0x3ffff
    s_bfe_u32 s33, s3, 0x30013
    s_mov_b32 s35, s48
    s_mov_b32 s45, s44
    s_xor_b32 s47, s44, 256
    s_add_u32 s49, s48, 128
    s_add_u32 s60, s48, 256
    s_cmp_eq_u32 s33, 3
    s_cselect_b32 s46, s44, s47
    s_cselect_b32 s50, s60, s48
    s_sub_u32 s60, s33, 2
    s_cmp_lt_u32 s60, 2
    s_cbranch_scc0 K2_rare_125
K2_back_126:
    v_add_u32 v222, s48, v251
    ds_read2_b32 v[222:223], v222 offset0:1 offset1:3
    v_add_u32 v224, s49, v251
    ds_read2_b32 v[224:225], v224 offset0:1 offset1:3
    v_add_u32 v226, s50, v251
    ds_read2_b32 v[226:227], v226 offset0:1 offset1:3
    s_waitcnt lgkmcnt(2)
    v_mad_u32_u16 v222, v222, s39, v248 op_sel:[1,0,0,0]
    v_mad_u32_u16 v223, v223, s39, v248 op_sel:[1,0,0,0]
    s_waitcnt lgkmcnt(1)
    v_mad_u32_u16 v224, v224, s39, v248 op_sel:[1,0,0,0]
    v_mad_u32_u16 v225, v225, s39, v248 op_sel:[1,0,0,0]
    s_waitcnt lgkmcnt(0)
    v_mad_u32_u16 v226, v226, s39, v248 op_sel:[1,0,0,0]
    v_mad_u32_u16 v227, v227, s39, v248 op_sel:[1,0,0,0]
    s_waitcnt vmcnt(4)
    v_mfma_f32_32x32x16_bf16 v[8:23], v[80:83], v[176:179], 0
    ds_read_b64_tr_b16 v[184:185], v246 offset:2048
    ds_read_b64_tr_b16 v[186:187], v246 offset:3072
    ds_read_b64_tr_b16 v[188:189], v247 offset:2048
    ds_read_b64_tr_b16 v[190:191], v247 offset:3072
    s_mov_b32 m0, s68
    v_mfma_f32_32x32x16_bf16 v[24:39], v[84:87], v[176:179], 0
    buffer_load_dwordx4 v222, s[4:7], s44 offen sc1 lds
    buffer_load_dwordx4 v223, s[72:75], s44 offen offset:1024 sc1 lds
    v_permlane32_swap_b32 v236, v234
    v_permlane32_swap_b32 v237, v235
    v_mfma_f32_32x32x16_bf16 v[48:63], v[80:83], v[180:183], 0
    v_permlane32_swap_b32 v240, v238
    v_permlane32_swap_b32 v241, v239
    v_add_f32 v236, v236, v234
    v_add_f32 v237, v237, v235
    v_add_f32 v240, -v240, -v238
    v_mfma_f32_32x32x16_bf16 v[64:79], v[84:87], v[180:183], 0
    s_setprio 0
    v_add_f32 v241, -v241, -v239
    v_cvt_pk_bf16_f32 v236, v236, v237
    v_cvt_pk_bf16_f32 v240, v240, v241
    ds_write2st64_b32 v232, v236, v240 offset0:2 offset1:3
    v_mul_f32 v234, v8, v96
    v_mul_f32 v236, v16, v128
    v_fmac_f32 v234, v9, v97
    v_fmac_f32 v236, v17, v129
    v_fmac_f32 v234, v10, v98
    v_fmac_f32 v236, v18, v130
    v_fmac_f32 v234, v11, v99
    v_fmac_f32 v236, v19, v131
    v_fmac_f32 v234, v12, v100
    v_fmac_f32 v236, v20, v132
    v_fmac_f32 v234, v13, v101
    v_fmac_f32 v236, v21, v133
    v_fmac_f32 v234, v14, v102
    v_fmac_f32 v236, v22, v134
    v_fmac_f32 v234, v15, v103
    v_fmac_f32 v236, v23, v135
    v_mul_f32 v238, v24, v128
    v_mul_f32 v240, v32, v128
    v_fmac_f32 v238, v25, v129
    v_fmac_f32 v240, v33, v129
    v_fmac_f32 v238, v26, v130
    v_fmac_f32 v240, v34, v130
    v_fmac_f32 v238, v27, v131
    v_fmac_f32 v240, v35, v131
    v_fmac_f32 v238, v28, v132
    v_fmac_f32 v240, v36, v132
    v_fmac_f32 v238, v29, v133
    v_fmac_f32 v240, v37, v133
    v_fmac_f32 v238, v30, v134
    v_fmac_f32 v240, v38, v134
    v_fmac_f32 v238, v31, v135
    v_fmac_f32 v240, v39, v135
    v_mul_f32 v235, v48, v104
    v_mul_f32 v237, v56, v136
    v_fmac_f32 v235, v49, v105
    v_fmac_f32 v237, v57, v137
    v_fmac_f32 v235, v50, v106
    v_fmac_f32 v237, v58, v138
    v_fmac_f32 v235, v51, v107
    v_fmac_f32 v237, v59, v139
    v_fmac_f32 v235, v52, v108
    v_fmac_f32 v237, v60, v140
    v_fmac_f32 v235, v53, v109
    v_fmac_f32 v237, v61, v141
    v_fmac_f32 v235, v54, v110
    v_fmac_f32 v237, v62, v142
    v_fmac_f32 v235, v55, v111
    v_fmac_f32 v237, v63, v143
    v_mul_f32 v239, v64, v136
    v_mul_f32 v241, v72, v136
    v_fmac_f32 v239, v65, v137
    v_fmac_f32 v241, v73, v137
    v_fmac_f32 v239, v66, v138
    v_fmac_f32 v241, v74, v138
    v_fmac_f32 v239, v67, v139
    v_fmac_f32 v241, v75, v139
    v_fmac_f32 v239, v68, v140
    v_fmac_f32 v241, v76, v140
    v_fmac_f32 v239, v69, v141
    v_fmac_f32 v241, v77, v141
    v_fmac_f32 v239, v70, v142
    v_fmac_f32 v241, v78, v142
    v_fmac_f32 v239, v71, v143
    v_fmac_f32 v241, v79, v143
    s_setprio 1
    s_waitcnt vmcnt(4) lgkmcnt(1)
    v_mfma_f32_32x32x16_bf16 v[24:39], v[84:87], v[184:187], 0
    ds_read_b64_tr_b16 v[176:177], v246 offset:4096
    ds_read_b64_tr_b16 v[178:179], v246 offset:5120
    ds_read_b64_tr_b16 v[180:181], v247 offset:4096
    ds_read_b64_tr_b16 v[182:183], v247 offset:5120
    s_mov_b32 m0, s69
    v_mfma_f32_32x32x16_bf16 v[8:23], v[80:83], v[184:187], 0
    buffer_load_dwordx4 v224, s[4:7], s45 offen sc1 lds
    buffer_load_dwordx4 v225, s[72:75], s45 offen offset:1024 sc1 lds
    v_permlane32_swap_b32 v234, v236
    v_permlane32_swap_b32 v235, v237
    v_mfma_f32_32x32x16_bf16 v[48:63], v[80:83], v[188:191], 0
    v_permlane32_swap_b32 v238, v239
    v_lshl_add_u32 v232, v252, 1, s31
    v_add_f32 v234, v234, v236
    v_add_f32 v235, v235, v237
    v_add_f32 v238, -v238, -v239
    v_sub_u32 v239, v232, v233
    v_mfma_f32_32x32x16_bf16 v[64:79], v[84:87], v[188:191], 0
    s_setprio 0
    v_cvt_pk_bf16_f32 v234, v234, v235
    v_cvt_pk_bf16_f32 v238, v238, v238
    ds_write_b32 v232, v234 offset:0
    ds_write_b16 v239, v238 offset:1280
    v_mul_f32 v236, v24, v160
    v_mul_f32 v238, v32, v160
    v_fmac_f32 v236, v25, v161
    v_fmac_f32 v238, v33, v161
    v_fmac_f32 v236, v26, v162
    v_fmac_f32 v238, v34, v162
    v_fmac_f32 v236, v27, v163
    v_fmac_f32 v238, v35, v163
    v_fmac_f32 v236, v28, v164
    v_fmac_f32 v238, v36, v164
    v_fmac_f32 v236, v29, v165
    v_fmac_f32 v238, v37, v165
    v_fmac_f32 v236, v30, v166
    v_fmac_f32 v238, v38, v166
    v_fmac_f32 v236, v31, v167
    v_fmac_f32 v238, v39, v167
    v_mul_f32 v234, v8, v144
    v_mul_f32 v235, v48, v152
    v_fmac_f32 v234, v9, v145
    v_fmac_f32 v235, v49, v153
    v_fmac_f32 v234, v10, v146
    v_fmac_f32 v235, v50, v154
    v_fmac_f32 v234, v11, v147
    v_fmac_f32 v235, v51, v155
    v_fmac_f32 v234, v12, v148
    v_fmac_f32 v235, v52, v156
    v_fmac_f32 v234, v13, v149
    v_fmac_f32 v235, v53, v157
    v_fmac_f32 v234, v14, v150
    v_fmac_f32 v235, v54, v158
    v_fmac_f32 v234, v15, v151
    v_fmac_f32 v235, v55, v159
    v_mul_f32 v237, v64, v168
    v_mul_f32 v239, v72, v168
    v_fmac_f32 v237, v65, v169
    v_fmac_f32 v239, v73, v169
    v_fmac_f32 v237, v66, v170
    v_fmac_f32 v239, v74, v170
    v_fmac_f32 v237, v67, v171
    v_fmac_f32 v239, v75, v171
    v_fmac_f32 v237, v68, v172
    v_fmac_f32 v239, v76, v172
    v_fmac_f32 v237, v69, v173
    v_fmac_f32 v239, v77, v173
    v_fmac_f32 v237, v70, v174
    v_fmac_f32 v239, v78, v174
    v_fmac_f32 v237, v71, v175
    v_fmac_f32 v239, v79, v175
    s_setprio 1
    s_waitcnt vmcnt(4) lgkmcnt(2)
    v_mfma_f32_32x32x16_bf16 v[24:39], v[80:83], v[176:179], 0
    ds_read_b64_tr_b16 v[184:185], v246 offset:6144
    ds_read_b64_tr_b16 v[186:187], v246 offset:7168
    ds_read_b64_tr_b16 v[188:189], v247 offset:6144
    ds_read_b64_tr_b16 v[190:191], v247 offset:7168
    s_mov_b32 s32, s31
    s_mov_b32 s31, s35
    s_mov_b32 m0, s70
    v_mfma_f32_32x32x16_bf16 v[0:15], v[84:87], v[176:179], 0
    buffer_load_dwordx4 v226, s[4:7], s46 offen sc1 lds
    buffer_load_dwordx4 v227, s[72:75], s46 offen offset:1024 sc1 lds
    v_permlane32_swap_b32 v234, v240
    v_permlane32_swap_b32 v235, v241
    v_add_f32 v234, v234, v240
    v_mfma_f32_32x32x16_bf16 v[40:55], v[84:87], v[180:183], 0
    v_add_f32 v235, v235, v241
    v_cvt_pk_bf16_f32 v234, v234, v235
    ds_write_b32 v232, v234 offset:256
    s_sub_u32 s26, s48, s29
    s_mov_b32 s29, s48
    s_mov_b32 s30, s3
    s_bfe_u32 s56, s3, 0x40012
    v_mfma_f32_32x32x16_bf16 v[64:79], v[80:83], v[180:183], 0
    s_setprio 0
    s_cmp_lg_u32 s36, 0
    s_cselect_b32 s56, s56, 0
    v_mul_f32 v240, v24, v144
    v_fmac_f32 v236, v32, v160
    v_fmac_f32 v240, v25, v145
    v_fmac_f32 v236, v33, v161
    v_fmac_f32 v240, v26, v146
    v_fmac_f32 v236, v34, v162
    v_fmac_f32 v240, v27, v147
    v_fmac_f32 v236, v35, v163
    v_fmac_f32 v240, v28, v148
    v_fmac_f32 v236, v36, v164
    v_fmac_f32 v240, v29, v149
    v_fmac_f32 v236, v37, v165
    v_fmac_f32 v240, v30, v150
    v_fmac_f32 v236, v38, v166
    v_fmac_f32 v240, v31, v151
    v_fmac_f32 v236, v39, v167
    v_mul_f32 v234, v0, v112
    v_mul_f32 v235, v40, v120
    v_fmac_f32 v234, v1, v113
    v_fmac_f32 v235, v41, v121
    v_fmac_f32 v234, v2, v114
    v_fmac_f32 v235, v42, v122
    v_fmac_f32 v234, v3, v115
    v_fmac_f32 v235, v43, v123
    v_fmac_f32 v234, v4, v116
    v_fmac_f32 v235, v44, v124
    v_fmac_f32 v234, v5, v117
    v_fmac_f32 v235, v45, v125
    v_fmac_f32 v234, v6, v118
    v_fmac_f32 v235, v46, v126
    v_fmac_f32 v234, v7, v119
    v_fmac_f32 v235, v47, v127
    v_mul_f32 v241, v64, v152
    v_fmac_f32 v237, v72, v168
    v_fmac_f32 v241, v65, v153
    v_fmac_f32 v237, v73, v169
    v_fmac_f32 v241, v66, v154
    v_fmac_f32 v237, v74, v170
    v_fmac_f32 v241, v67, v155
    v_fmac_f32 v237, v75, v171
    v_fmac_f32 v241, v68, v156
    v_fmac_f32 v237, v76, v172
    v_fmac_f32 v241, v69, v157
    v_fmac_f32 v237, v77, v173
    v_fmac_f32 v241, v70, v158
    v_fmac_f32 v237, v78, v174
    v_fmac_f32 v241, v71, v159
    v_fmac_f32 v237, v79, v175
    s_setprio 1
    s_waitcnt vmcnt(4) lgkmcnt(1)
    v_mfma_f32_32x32x16_bf16 v[24:39], v[80:83], v[184:187], 0
    ds_read_b64_tr_b16 v[176:177], v246 offset:0
    ds_read_b64_tr_b16 v[178:179], v246 offset:1024
    ds_read_b64_tr_b16 v[180:181], v247 offset:0
    ds_read_b64_tr_b16 v[182:183], v247 offset:1024
    s_mov_b32 m0, s71
    v_mfma_f32_32x32x16_bf16 v[8:23], v[84:87], v[184:187], v[8:23]
    s_cmp_eq_u32 s33, 4
    s_cbranch_scc1 K2_g4_128
    buffer_load_dwordx4 v224, s[4:7], s47 offen sc1 lds
    buffer_load_dwordx4 v225, s[72:75], s47 offen offset:1024 sc1 lds
K2_back_129:
    v_permlane32_swap_b32 v236, v240
    v_mfma_f32_32x32x16_bf16 v[48:63], v[84:87], v[188:191], v[48:63]
    v_permlane32_swap_b32 v237, v241
    v_add_f32 v236, v236, v240
    v_add_f32 v237, v237, v241
    v_cvt_pk_bf16_f32 v236, v236, v237
    ds_write_b32 v232, v236 offset:1024
    v_mfma_f32_32x32x16_bf16 v[64:79], v[80:83], v[188:191], 0
    s_setprio 0
    v_mul_f32 v236, v24, v144
    v_fma_f32 v238, v32, v160, -v238
    v_fmac_f32 v236, v25, v145
    v_fmac_f32 v238, v33, v161
    v_fmac_f32 v236, v26, v146
    v_fmac_f32 v238, v34, v162
    v_fmac_f32 v236, v27, v147
    v_fmac_f32 v238, v35, v163
    v_fmac_f32 v236, v28, v148
    v_fmac_f32 v238, v36, v164
    v_fmac_f32 v236, v29, v149
    v_fmac_f32 v238, v37, v165
    v_fmac_f32 v236, v30, v150
    v_fmac_f32 v238, v38, v166
    v_fmac_f32 v236, v31, v151
    v_fmac_f32 v238, v39, v167
    v_add_u32 v249, s26, v249
    v_add_u32 v250, s26, v250
    v_mul_f32 v240, v8, v160
    v_fma_f32 v234, v16, v112, -v234
    v_fmac_f32 v240, v9, v161
    v_fmac_f32 v234, v17, v113
    v_fmac_f32 v240, v10, v162
    v_fmac_f32 v234, v18, v114
    v_fmac_f32 v240, v11, v163
    v_fmac_f32 v234, v19, v115
    v_fmac_f32 v240, v12, v164
    v_fmac_f32 v234, v20, v116
    v_fmac_f32 v240, v13, v165
    v_fmac_f32 v234, v21, v117
    v_fmac_f32 v240, v14, v166
    v_fmac_f32 v234, v22, v118
    v_fmac_f32 v240, v15, v167
    v_fmac_f32 v234, v23, v119
    ds_read_b64_tr_b16 v[80:81], v249 offset:0
    ds_read_u16_d16_hi v40, v250 offset:0
    v_mul_f32 v241, v48, v168
    v_fma_f32 v235, v56, v120, -v235
    v_fmac_f32 v241, v49, v169
    v_fmac_f32 v235, v57, v121
    v_fmac_f32 v241, v50, v170
    v_fmac_f32 v235, v58, v122
    v_fmac_f32 v241, v51, v171
    v_fmac_f32 v235, v59, v123
    v_fmac_f32 v241, v52, v172
    v_fmac_f32 v235, v60, v124
    v_fmac_f32 v241, v53, v173
    v_fmac_f32 v235, v61, v125
    v_fmac_f32 v241, v54, v174
    v_fmac_f32 v235, v62, v126
    v_fmac_f32 v241, v55, v175
    v_fmac_f32 v235, v63, v127
    ds_read_b64_tr_b16 v[88:89], v249 offset:512
    ds_read_u16_d16_hi v41, v250 offset:128
    v_mul_f32 v237, v64, v152
    v_fma_f32 v239, v72, v168, -v239
    v_fmac_f32 v237, v65, v153
    v_fmac_f32 v239, v73, v169
    v_fmac_f32 v237, v66, v154
    v_fmac_f32 v239, v74, v170
    v_fmac_f32 v237, v67, v155
    v_fmac_f32 v239, v75, v171
    v_fmac_f32 v237, v68, v156
    v_fmac_f32 v239, v76, v172
    v_fmac_f32 v237, v69, v157
    v_fmac_f32 v239, v77, v173
    v_fmac_f32 v237, v70, v158
    v_fmac_f32 v239, v78, v174
    v_fmac_f32 v237, v71, v159
    v_fmac_f32 v239, v79, v175
    s_cmp_eq_u32 s56, 5
    s_cbranch_scc1 K2_U21
    s_cmp_eq_u32 s56, 6
    s_cbranch_scc1 K2_U3h1
    s_branch K2_DSP1
K2_U41:
    s_setprio 1
    ds_read_b64_tr_b16 v[228:229], v249 offset:1024
    ds_read_u16_d16_hi v42, v250 offset:256
    s_lshr_b32 s65, s30, 28
    s_mul_i32 s66, s22, 2080
    s_lshl_b32 s65, s65, 9
    s_add_u32 s65, s65, s66
    s_add_u32 s65, s65, 65536
    s_sub_u32 s65, s65, s29
    s_sub_u32 s65, s65, 512
    v_add_u32 v56, s65, v249
    ds_read_b64_tr_b16 v[0:1], v56 offset:0
    ds_read_u16_d16_hi v43, v250 offset:384
    s_waitcnt lgkmcnt(4)
    v_lshlrev_b32 v16, 16, v80
    v_and_b32 v17, 0xffff0000, v80
    v_lshlrev_b32 v18, 16, v81
    v_and_b32 v19, 0xffff0000, v81
    v_mov_b32 v82, v81
    v_mul_f32_dpp v32, v40, v16 row_newbcast:4 row_mask:0xf bank_mask:0xf
    v_mul_f32_dpp v33, v40, v17 row_newbcast:5 row_mask:0xf bank_mask:0xf
    v_mul_f32_dpp v34, v40, v18 row_newbcast:6 row_mask:0xf bank_mask:0xf
    v_mul_f32_dpp v35, v40, v19 row_newbcast:7 row_mask:0xf bank_mask:0xf
    v_cvt_pk_bf16_f32 v84, v32, v33
    v_cvt_pk_bf16_f32 v86, v34, v35
    v_mul_f32_dpp v36, v40, v16 row_newbcast:8 row_mask:0xf bank_mask:0xf
    v_mul_f32_dpp v37, v40, v17 row_newbcast:9 row_mask:0xf bank_mask:0xf
    v_mul_f32_dpp v38, v40, v18 row_newbcast:10 row_mask:0xf bank_mask:0xf
    v_mul_f32_dpp v39, v40, v19 row_newbcast:11 row_mask:0xf bank_mask:0xf
    v_cvt_pk_bf16_f32 v85, v36, v37
    v_cvt_pk_bf16_f32 v87, v38, v39
    v_mul_f32_dpp v16, v40, v16 row_newbcast:0 row_mask:0xf bank_mask:0xf
    v_mul_f32_dpp v17, v40, v17 row_newbcast:1 row_mask:0xf bank_mask:0xf
    v_mul_f32_dpp v18, v40, v18 row_newbcast:2 row_mask:0xf bank_mask:0xf
    v_mul_f32_dpp v19, v40, v19 row_newbcast:3 row_mask:0xf bank_mask:0xf
    v_cvt_pk_bf16_f32 v81, v16, v17
    v_cvt_pk_bf16_f32 v83, v18, v19
    v_permlane16_swap_b32 v84, v85
    v_permlane16_swap_b32 v86, v87
    v_permlane16_swap_b32 v80, v81
    v_permlane16_swap_b32 v82, v83
    v_lshlrev_b32 v24, 16, v88
    v_and_b32 v25, 0xffff0000, v88
    v_lshlrev_b32 v26, 16, v89
    v_and_b32 v27, 0xffff0000, v89
    v_mov_b32 v90, v89
    v_mul_f32_dpp v32, v41, v24 row_newbcast:4 row_mask:0xf bank_mask:0xf
    v_mul_f32_dpp v33, v41, v25 row_newbcast:5 row_mask:0xf bank_mask:0xf
    v_mul_f32_dpp v34, v41, v26 row_newbcast:6 row_mask:0xf bank_mask:0xf
    v_mul_f32_dpp v35, v41, v27 row_newbcast:7 row_mask:0xf bank_mask:0xf
    v_cvt_pk_bf16_f32 v92, v32, v33
    v_cvt_pk_bf16_f32 v94, v34, v35
    v_mul_f32_dpp v36, v41, v24 row_newbcast:8 row_mask:0xf bank_mask:0xf
    v_mul_f32_dpp v37, v41, v25 row_newbcast:9 row_mask:0xf bank_mask:0xf
    v_mul_f32_dpp v38, v41, v26 row_newbcast:10 row_mask:0xf bank_mask:0xf
    v_mul_f32_dpp v39, v41, v27 row_newbcast:11 row_mask:0xf bank_mask:0xf
    v_cvt_pk_bf16_f32 v93, v36, v37
    v_cvt_pk_bf16_f32 v95, v38, v39
    v_mul_f32_dpp v24, v41, v24 row_newbcast:0 row_mask:0xf bank_mask:0xf
    v_mul_f32_dpp v25, v41, v25 row_newbcast:1 row_mask:0xf bank_mask:0xf
    v_mul_f32_dpp v26, v41, v26 row_newbcast:2 row_mask:0xf bank_mask:0xf
    v_mul_f32_dpp v27, v41, v27 row_newbcast:3 row_mask:0xf bank_mask:0xf
    v_cvt_pk_bf16_f32 v89, v24, v25
    v_cvt_pk_bf16_f32 v91, v26, v27
    v_permlane16_swap_b32 v92, v93
    v_permlane16_swap_b32 v94, v95
    v_permlane16_swap_b32 v88, v89
    v_permlane16_swap_b32 v90, v91
    s_waitcnt lgkmcnt(2)
    v_lshlrev_b32 v16, 16, v228
    v_and_b32 v17, 0xffff0000, v228
    v_lshlrev_b32 v18, 16, v229
    v_and_b32 v19, 0xffff0000, v229
    v_mov_b32 v230, v229
    v_mul_f32_dpp v32, v42, v16 row_newbcast:4 row_mask:0xf bank_mask:0xf
    v_mul_f32_dpp v33, v42, v17 row_newbcast:5 row_mask:0xf bank_mask:0xf
    v_mul_f32_dpp v34, v42, v18 row_newbcast:6 row_mask:0xf bank_mask:0xf
    v_mul_f32_dpp v35, v42, v19 row_newbcast:7 row_mask:0xf bank_mask:0xf
    v_cvt_pk_bf16_f32 v242, v32, v33
    v_cvt_pk_bf16_f32 v244, v34, v35
    v_mul_f32_dpp v36, v42, v16 row_newbcast:8 row_mask:0xf bank_mask:0xf
    v_mul_f32_dpp v37, v42, v17 row_newbcast:9 row_mask:0xf bank_mask:0xf
    v_mul_f32_dpp v38, v42, v18 row_newbcast:10 row_mask:0xf bank_mask:0xf
    v_mul_f32_dpp v39, v42, v19 row_newbcast:11 row_mask:0xf bank_mask:0xf
    v_cvt_pk_bf16_f32 v243, v36, v37
    v_cvt_pk_bf16_f32 v245, v38, v39
    v_mul_f32_dpp v16, v42, v16 row_newbcast:0 row_mask:0xf bank_mask:0xf
    v_mul_f32_dpp v17, v42, v17 row_newbcast:1 row_mask:0xf bank_mask:0xf
    v_mul_f32_dpp v18, v42, v18 row_newbcast:2 row_mask:0xf bank_mask:0xf
    v_mul_f32_dpp v19, v42, v19 row_newbcast:3 row_mask:0xf bank_mask:0xf
    v_cvt_pk_bf16_f32 v229, v16, v17
    v_cvt_pk_bf16_f32 v231, v18, v19
    v_permlane16_swap_b32 v242, v243
    v_permlane16_swap_b32 v244, v245
    v_permlane16_swap_b32 v228, v229
    v_permlane16_swap_b32 v230, v231
    s_waitcnt lgkmcnt(0)
    v_lshlrev_b32 v24, 16, v0
    v_and_b32 v25, 0xffff0000, v0
    v_lshlrev_b32 v26, 16, v1
    v_and_b32 v27, 0xffff0000, v1
    v_mov_b32 v2, v1
    v_mul_f32_dpp v32, v43, v24 row_newbcast:4 row_mask:0xf bank_mask:0xf
    v_mul_f32_dpp v33, v43, v25 row_newbcast:5 row_mask:0xf bank_mask:0xf
    v_mul_f32_dpp v34, v43, v26 row_newbcast:6 row_mask:0xf bank_mask:0xf
    v_mul_f32_dpp v35, v43, v27 row_newbcast:7 row_mask:0xf bank_mask:0xf
    v_cvt_pk_bf16_f32 v4, v32, v33
    v_cvt_pk_bf16_f32 v6, v34, v35
    v_mul_f32_dpp v36, v43, v24 row_newbcast:8 row_mask:0xf bank_mask:0xf
    v_mul_f32_dpp v37, v43, v25 row_newbcast:9 row_mask:0xf bank_mask:0xf
    v_mul_f32_dpp v38, v43, v26 row_newbcast:10 row_mask:0xf bank_mask:0xf
    v_mul_f32_dpp v39, v43, v27 row_newbcast:11 row_mask:0xf bank_mask:0xf
    v_cvt_pk_bf16_f32 v5, v36, v37
    v_cvt_pk_bf16_f32 v7, v38, v39
    v_mul_f32_dpp v24, v43, v24 row_newbcast:0 row_mask:0xf bank_mask:0xf
    v_mul_f32_dpp v25, v43, v25 row_newbcast:1 row_mask:0xf bank_mask:0xf
    v_mul_f32_dpp v26, v43, v26 row_newbcast:2 row_mask:0xf bank_mask:0xf
    v_mul_f32_dpp v27, v43, v27 row_newbcast:3 row_mask:0xf bank_mask:0xf
    v_cvt_pk_bf16_f32 v1, v24, v25
    v_cvt_pk_bf16_f32 v3, v26, v27
    v_permlane16_swap_b32 v4, v5
    v_permlane16_swap_b32 v6, v7
    v_permlane16_swap_b32 v0, v1
    v_permlane16_swap_b32 v2, v3
    s_waitcnt vmcnt(4)
    v_mfma_f32_32x32x16_bf16 v[8:23], v[80:83], v[176:179], 0
    ds_read_b64_tr_b16 v[184:185], v246 offset:2048
    ds_read_b64_tr_b16 v[186:187], v246 offset:3072
    ds_read_b64_tr_b16 v[188:189], v247 offset:2048
    ds_read_b64_tr_b16 v[190:191], v247 offset:3072
    s_mov_b32 m0, s68
    v_mfma_f32_32x32x16_bf16 v[24:39], v[84:87], v[176:179], 0
    buffer_load_dwordx4 v222, s[4:7], s41 offen sc1 lds
    buffer_load_dwordx4 v223, s[72:75], s41 offen offset:1024 sc1 lds
    v_permlane32_swap_b32 v236, v234
    v_permlane32_swap_b32 v237, v235
    v_mfma_f32_32x32x16_bf16 v[48:63], v[80:83], v[180:183], 0
    v_permlane32_swap_b32 v240, v238
    v_permlane32_swap_b32 v241, v239
    v_add_f32 v236, v236, v234
    v_add_f32 v237, v237, v235
    v_add_f32 v240, -v240, -v238
    v_mfma_f32_32x32x16_bf16 v[64:79], v[84:87], v[180:183], 0
    v_add_f32 v241, -v241, -v239
    v_cvt_pk_bf16_f32 v236, v236, v237
    v_cvt_pk_bf16_f32 v240, v240, v241
    ds_write2st64_b32 v232, v236, v240 offset0:2 offset1:3
    s_mov_b64 exec, 0x1ff
    ds_add_rtn_u32 v42, v254, v251
    s_mov_b64 exec, -1
    s_waitcnt vmcnt(4) lgkmcnt(2)
    v_mfma_f32_32x32x16_bf16 v[8:23], v[88:91], v[184:187], v[8:23]
    ds_read_b64_tr_b16 v[176:177], v246 offset:4096
    ds_read_b64_tr_b16 v[178:179], v246 offset:5120
    ds_read_b64_tr_b16 v[180:181], v247 offset:4096
    ds_read_b64_tr_b16 v[182:183], v247 offset:5120
    s_mov_b32 m0, s69
    v_mfma_f32_32x32x16_bf16 v[24:39], v[92:95], v[184:187], v[24:39]
    buffer_load_dwordx4 v224, s[4:7], s41 offen sc1 lds
    buffer_load_dwordx4 v225, s[72:75], s41 offen offset:1024 sc1 lds
    s_waitcnt lgkmcnt(4)
    v_readlane_b32 s58, v42, 8
    v_mfma_f32_32x32x16_bf16 v[48:63], v[88:91], v[188:191], v[48:63]
    s_lshr_b32 s58, s58, 4
    s_cmp_lt_u32 s58, s22
    s_cbranch_scc0 K2_nul_130
    v_readlane_b32 s3, v253, s58
    s_nop 0
    s_bfe_u32 s58, s3, 0x60016
    s_and_b32 s59, s58, 7
    s_lshr_b32 s60, s58, 3
K2_chk_132:
    v_readlane_b32 s61, v42, s59
    s_nop 0
    s_cmp_gt_u32 s61, s60
    s_cbranch_scc0 K2_spin_131
K2_back_133:
    v_mfma_f32_32x32x16_bf16 v[64:79], v[92:95], v[188:191], v[64:79]
    s_lshl_b32 s44, s34, 7
    s_and_b32 s48, s3, 0x3ffff
    s_bfe_u32 s33, s3, 0x30013
    s_mov_b32 s35, s48
    s_mov_b32 s45, s44
    s_xor_b32 s47, s44, 256
    s_waitcnt vmcnt(4) lgkmcnt(0)
    v_mfma_f32_32x32x16_bf16 v[8:23], v[228:231], v[176:179], v[8:23]
    ds_read_b64_tr_b16 v[184:185], v246 offset:6144
    ds_read_b64_tr_b16 v[186:187], v246 offset:7168
    ds_read_b64_tr_b16 v[188:189], v247 offset:6144
    ds_read_b64_tr_b16 v[190:191], v247 offset:7168
    s_add_u32 s49, s48, 128
    s_add_u32 s60, s48, 256
    s_mov_b32 m0, s70
    v_mfma_f32_32x32x16_bf16 v[24:39], v[242:245], v[176:179], v[24:39]
    buffer_load_dwordx4 v226, s[4:7], s41 offen sc1 lds
    buffer_load_dwordx4 v227, s[72:75], s41 offen offset:1024 sc1 lds
    s_cmp_eq_u32 s33, 3
    s_cselect_b32 s46, s44, s47
    s_cselect_b32 s50, s60, s48
    v_mfma_f32_32x32x16_bf16 v[48:63], v[228:231], v[180:183], v[48:63]
    s_sub_u32 s60, s33, 2
    s_cmp_lt_u32 s60, 2
    s_cbranch_scc0 K2_rare_134
K2_back_135:
    v_mfma_f32_32x32x16_bf16 v[64:79], v[242:245], v[180:183], v[64:79]
    s_waitcnt vmcnt(4) lgkmcnt(0)
    v_mfma_f32_32x32x16_bf16 v[8:23], v[0:3], v[184:187], v[8:23]
    ds_read_b64_tr_b16 v[176:177], v246 offset:0
    ds_read_b64_tr_b16 v[178:179], v246 offset:1024
    ds_read_b64_tr_b16 v[180:181], v247 offset:0
    ds_read_b64_tr_b16 v[182:183], v247 offset:1024
    s_mov_b32 m0, s71
    v_mfma_f32_32x32x16_bf16 v[24:39], v[4:7], v[184:187], v[24:39]
    buffer_load_dwordx4 v44, s[4:7], s41 offen sc1 lds
    buffer_load_dwordx4 v45, s[72:75], s41 offen offset:1024 sc1 lds
    v_mfma_f32_32x32x16_bf16 v[48:63], v[0:3], v[188:191], v[48:63]
    s_nop 2
    v_mul_f32 v234, v8, v96
    v_mul_f32 v236, v16, v128
    v_fmac_f32 v234, v9, v97
    v_fmac_f32 v236, v17, v129
    v_fmac_f32 v234, v10, v98
    v_fmac_f32 v236, v18, v130
    v_fmac_f32 v234, v11, v99
    v_mfma_f32_32x32x16_bf16 v[64:79], v[4:7], v[188:191], v[64:79]
    s_setprio 0
    v_fmac_f32 v236, v19, v131
    v_fmac_f32 v234, v12, v100
    v_fmac_f32 v236, v20, v132
    v_fmac_f32 v234, v13, v101
    v_fmac_f32 v236, v21, v133
    v_fmac_f32 v234, v14, v102
    v_fmac_f32 v236, v22, v134
    v_fmac_f32 v234, v15, v103
    v_fmac_f32 v236, v23, v135
    v_mul_f32 v238, v24, v128
    v_mul_f32 v240, v32, v128
    v_fmac_f32 v238, v25, v129
    v_fmac_f32 v240, v33, v129
    v_fmac_f32 v238, v26, v130
    v_fmac_f32 v240, v34, v130
    v_fmac_f32 v238, v27, v131
    v_fmac_f32 v240, v35, v131
    v_fmac_f32 v238, v28, v132
    v_fmac_f32 v240, v36, v132
    v_fmac_f32 v238, v29, v133
    v_fmac_f32 v240, v37, v133
    v_fmac_f32 v238, v30, v134
    v_fmac_f32 v240, v38, v134
    v_fmac_f32 v238, v31, v135
    v_fmac_f32 v240, v39, v135
    v_mul_f32 v235, v48, v104
    v_mul_f32 v237, v56, v136
    v_fmac_f32 v235, v49, v105
    v_fmac_f32 v237, v57, v137
    v_fmac_f32 v235, v50, v106
    v_fmac_f32 v237, v58, v138
    v_fmac_f32 v235, v51, v107
    v_fmac_f32 v237, v59, v139
    v_fmac_f32 v235, v52, v108
    v_fmac_f32 v237, v60, v140
    v_fmac_f32 v235, v53, v109
    v_fmac_f32 v237, v61, v141
    v_fmac_f32 v235, v54, v110
    v_fmac_f32 v237, v62, v142
    v_fmac_f32 v235, v55, v111
    v_fmac_f32 v237, v63, v143
    v_mul_f32 v239, v64, v136
    v_mul_f32 v241, v72, v136
    s_setprio 1
    s_waitcnt vmcnt(4) lgkmcnt(0)
    v_mfma_f32_32x32x16_bf16 v[8:23], v[80:83], v[176:179], 0
    ds_read_b64_tr_b16 v[184:185], v246 offset:2048
    ds_read_b64_tr_b16 v[186:187], v246 offset:3072
    ds_read_b64_tr_b16 v[188:189], v247 offset:2048
    ds_read_b64_tr_b16 v[190:191], v247 offset:3072
    v_fmac_f32 v239, v65, v137
    v_fmac_f32 v241, v73, v137
    s_mov_b32 m0, s68
    v_mfma_f32_32x32x16_bf16 v[24:39], v[84:87], v[176:179], 0
    buffer_load_dwordx4 v222, s[4:7], s42 offen sc1 lds
    buffer_load_dwordx4 v223, s[72:75], s42 offen offset:1024 sc1 lds
    v_fmac_f32 v239, v66, v138
    v_fmac_f32 v241, v74, v138
    v_fmac_f32 v239, v67, v139
    v_fmac_f32 v241, v75, v139
    v_fmac_f32 v239, v68, v140
    v_mfma_f32_32x32x16_bf16 v[48:63], v[80:83], v[180:183], 0
    v_fmac_f32 v241, v76, v140
    v_fmac_f32 v239, v69, v141
    v_fmac_f32 v241, v77, v141
    v_fmac_f32 v239, v70, v142
    v_fmac_f32 v241, v78, v142
    v_fmac_f32 v239, v71, v143
    v_fmac_f32 v241, v79, v143
    v_mfma_f32_32x32x16_bf16 v[64:79], v[84:87], v[180:183], 0
    v_permlane32_swap_b32 v234, v236
    v_permlane32_swap_b32 v235, v237
    v_permlane32_swap_b32 v238, v239
    s_waitcnt vmcnt(4) lgkmcnt(0)
    v_mfma_f32_32x32x16_bf16 v[8:23], v[88:91], v[184:187], v[8:23]
    ds_read_b64_tr_b16 v[176:177], v246 offset:4096
    ds_read_b64_tr_b16 v[178:179], v246 offset:5120
    ds_read_b64_tr_b16 v[180:181], v247 offset:4096
    ds_read_b64_tr_b16 v[182:183], v247 offset:5120
    v_lshl_add_u32 v232, v252, 1, s31
    v_add_f32 v234, v234, v236
    s_mov_b32 m0, s69
    v_mfma_f32_32x32x16_bf16 v[24:39], v[92:95], v[184:187], v[24:39]
    buffer_load_dwordx4 v224, s[4:7], s42 offen sc1 lds
    buffer_load_dwordx4 v225, s[72:75], s42 offen offset:1024 sc1 lds
    v_add_f32 v235, v235, v237
    v_add_f32 v238, -v238, -v239
    v_sub_u32 v239, v232, v233
    v_cvt_pk_bf16_f32 v234, v234, v235
    v_cvt_pk_bf16_f32 v238, v238, v238
    v_mfma_f32_32x32x16_bf16 v[48:63], v[88:91], v[188:191], v[48:63]
    ds_write_b32 v232, v234 offset:0
    ds_write_b16 v239, v238 offset:1280
    v_mfma_f32_32x32x16_bf16 v[64:79], v[92:95], v[188:191], v[64:79]
    s_waitcnt vmcnt(4) lgkmcnt(2)
    v_mfma_f32_32x32x16_bf16 v[8:23], v[228:231], v[176:179], v[8:23]
    ds_read_b64_tr_b16 v[184:185], v246 offset:6144
    ds_read_b64_tr_b16 v[186:187], v246 offset:7168
    ds_read_b64_tr_b16 v[188:189], v247 offset:6144
    ds_read_b64_tr_b16 v[190:191], v247 offset:7168
    s_mov_b32 m0, s70
    v_mfma_f32_32x32x16_bf16 v[24:39], v[242:245], v[176:179], v[24:39]
    buffer_load_dwordx4 v226, s[4:7], s42 offen sc1 lds
    buffer_load_dwordx4 v227, s[72:75], s42 offen offset:1024 sc1 lds
    v_mfma_f32_32x32x16_bf16 v[48:63], v[228:231], v[180:183], v[48:63]
    v_mfma_f32_32x32x16_bf16 v[64:79], v[242:245], v[180:183], v[64:79]
    s_waitcnt vmcnt(4) lgkmcnt(0)
    v_mfma_f32_32x32x16_bf16 v[8:23], v[0:3], v[184:187], v[8:23]
    ds_read_b64_tr_b16 v[176:177], v246 offset:0
    ds_read_b64_tr_b16 v[178:179], v246 offset:1024
    ds_read_b64_tr_b16 v[180:181], v247 offset:0
    ds_read_b64_tr_b16 v[182:183], v247 offset:1024
    s_mov_b32 m0, s71
    v_mfma_f32_32x32x16_bf16 v[24:39], v[4:7], v[184:187], v[24:39]
    buffer_load_dwordx4 v44, s[4:7], s42 offen sc1 lds
    buffer_load_dwordx4 v45, s[72:75], s42 offen offset:1024 sc1 lds
    v_mfma_f32_32x32x16_bf16 v[48:63], v[0:3], v[188:191], v[48:63]
    s_nop 2
    v_mul_f32 v46, v8, v144
    v_mul_f32 v234, v16, v112
    v_fmac_f32 v46, v9, v145
    v_fmac_f32 v234, v17, v113
    v_fmac_f32 v46, v10, v146
    v_fmac_f32 v234, v18, v114
    v_fmac_f32 v46, v11, v147
    v_mfma_f32_32x32x16_bf16 v[64:79], v[4:7], v[188:191], v[64:79]
    s_setprio 0
    v_fmac_f32 v234, v19, v115
    v_fmac_f32 v46, v12, v148
    v_fmac_f32 v234, v20, v116
    v_fmac_f32 v46, v13, v149
    v_fmac_f32 v234, v21, v117
    v_fmac_f32 v46, v14, v150
    v_fmac_f32 v234, v22, v118
    v_fmac_f32 v46, v15, v151
    v_fmac_f32 v234, v23, v119
    v_mul_f32 v236, v24, v160
    v_mul_f32 v238, v32, v160
    v_fmac_f32 v236, v25, v161
    v_fmac_f32 v238, v33, v161
    v_fmac_f32 v236, v26, v162
    v_fmac_f32 v238, v34, v162
    v_fmac_f32 v236, v27, v163
    v_fmac_f32 v238, v35, v163
    v_fmac_f32 v236, v28, v164
    v_fmac_f32 v238, v36, v164
    v_fmac_f32 v236, v29, v165
    v_fmac_f32 v238, v37, v165
    v_fmac_f32 v236, v30, v166
    v_fmac_f32 v238, v38, v166
    v_fmac_f32 v236, v31, v167
    v_fmac_f32 v238, v39, v167
    v_mul_f32 v47, v48, v152
    v_mul_f32 v235, v56, v120
    v_fmac_f32 v47, v49, v153
    v_fmac_f32 v235, v57, v121
    v_fmac_f32 v47, v50, v154
    v_fmac_f32 v235, v58, v122
    v_fmac_f32 v47, v51, v155
    v_fmac_f32 v235, v59, v123
    v_fmac_f32 v47, v52, v156
    v_fmac_f32 v235, v60, v124
    v_fmac_f32 v47, v53, v157
    v_fmac_f32 v235, v61, v125
    v_fmac_f32 v47, v54, v158
    v_fmac_f32 v235, v62, v126
    v_fmac_f32 v47, v55, v159
    v_fmac_f32 v235, v63, v127
    v_mul_f32 v237, v64, v168
    v_mul_f32 v239, v72, v168
    s_setprio 1
    s_waitcnt vmcnt(4) lgkmcnt(0)
    v_mfma_f32_32x32x16_bf16 v[8:23], v[80:83], v[176:179], 0
    ds_read_b64_tr_b16 v[184:185], v246 offset:2048
    ds_read_b64_tr_b16 v[186:187], v246 offset:3072
    ds_read_b64_tr_b16 v[188:189], v247 offset:2048
    ds_read_b64_tr_b16 v[190:191], v247 offset:3072
    v_fmac_f32 v237, v65, v169
    v_fmac_f32 v239, v73, v169
    s_mov_b32 m0, s68
    v_mfma_f32_32x32x16_bf16 v[24:39], v[84:87], v[176:179], 0
    buffer_load_dwordx4 v222, s[4:7], s43 offen sc1 lds
    buffer_load_dwordx4 v223, s[72:75], s43 offen offset:1024 sc1 lds
    v_fmac_f32 v237, v66, v170
    v_fmac_f32 v239, v74, v170
    v_fmac_f32 v237, v67, v171
    v_fmac_f32 v239, v75, v171
    v_fmac_f32 v237, v68, v172
    v_mfma_f32_32x32x16_bf16 v[48:63], v[80:83], v[180:183], 0
    v_fmac_f32 v239, v76, v172
    v_fmac_f32 v237, v69, v173
    v_fmac_f32 v239, v77, v173
    v_fmac_f32 v237, v70, v174
    v_fmac_f32 v239, v78, v174
    v_fmac_f32 v237, v71, v175
    v_fmac_f32 v239, v79, v175
    v_mfma_f32_32x32x16_bf16 v[64:79], v[84:87], v[180:183], 0
    v_permlane32_swap_b32 v46, v240
    v_permlane32_swap_b32 v47, v241
    v_add_f32 v46, v46, v240
    v_add_f32 v47, v47, v241
    s_waitcnt vmcnt(4) lgkmcnt(0)
    v_mfma_f32_32x32x16_bf16 v[8:23], v[88:91], v[184:187], v[8:23]
    ds_read_b64_tr_b16 v[176:177], v246 offset:4096
    ds_read_b64_tr_b16 v[178:179], v246 offset:5120
    ds_read_b64_tr_b16 v[180:181], v247 offset:4096
    ds_read_b64_tr_b16 v[182:183], v247 offset:5120
    v_cvt_pk_bf16_f32 v46, v46, v47
    ds_write_b32 v232, v46 offset:256
    s_mov_b32 m0, s69
    v_mfma_f32_32x32x16_bf16 v[24:39], v[92:95], v[184:187], v[24:39]
    buffer_load_dwordx4 v224, s[4:7], s43 offen sc1 lds
    buffer_load_dwordx4 v225, s[72:75], s43 offen offset:1024 sc1 lds
    v_mfma_f32_32x32x16_bf16 v[48:63], v[88:91], v[188:191], v[48:63]
    v_mfma_f32_32x32x16_bf16 v[64:79], v[92:95], v[188:191], v[64:79]
    s_waitcnt vmcnt(4) lgkmcnt(1)
    v_mfma_f32_32x32x16_bf16 v[8:23], v[228:231], v[176:179], v[8:23]
    ds_read_b64_tr_b16 v[184:185], v246 offset:6144
    ds_read_b64_tr_b16 v[186:187], v246 offset:7168
    ds_read_b64_tr_b16 v[188:189], v247 offset:6144
    ds_read_b64_tr_b16 v[190:191], v247 offset:7168
    s_mov_b32 m0, s70
    v_mfma_f32_32x32x16_bf16 v[24:39], v[242:245], v[176:179], v[24:39]
    buffer_load_dwordx4 v226, s[4:7], s43 offen sc1 lds
    buffer_load_dwordx4 v227, s[72:75], s43 offen offset:1024 sc1 lds
    v_mfma_f32_32x32x16_bf16 v[48:63], v[228:231], v[180:183], v[48:63]
    v_add_u32 v222, s48, v251
    ds_read2_b32 v[222:223], v222 offset0:1 offset1:3
    v_mfma_f32_32x32x16_bf16 v[64:79], v[242:245], v[180:183], v[64:79]
    s_waitcnt vmcnt(4) lgkmcnt(1)
    v_mfma_f32_32x32x16_bf16 v[8:23], v[0:3], v[184:187], v[8:23]
    ds_read_b64_tr_b16 v[176:177], v246 offset:0
    ds_read_b64_tr_b16 v[178:179], v246 offset:1024
    ds_read_b64_tr_b16 v[180:181], v247 offset:0
    ds_read_b64_tr_b16 v[182:183], v247 offset:1024
    s_mov_b32 m0, s71
    v_mfma_f32_32x32x16_bf16 v[24:39], v[4:7], v[184:187], v[24:39]
    buffer_load_dwordx4 v44, s[4:7], s43 offen sc1 lds
    buffer_load_dwordx4 v45, s[72:75], s43 offen offset:1024 sc1 lds
    s_waitcnt lgkmcnt(4)
    v_mad_u32_u16 v222, v222, s39, v248 op_sel:[1,0,0,0]
    v_mad_u32_u16 v223, v223, s39, v248 op_sel:[1,0,0,0]
    v_mfma_f32_32x32x16_bf16 v[48:63], v[0:3], v[188:191], v[48:63]
    v_add_u32 v224, s49, v251
    ds_read2_b32 v[224:225], v224 offset0:1 offset1:3
    v_mul_f32 v46, v8, v144
    v_fmac_f32 v236, v16, v160
    v_fmac_f32 v46, v9, v145
    v_fmac_f32 v236, v17, v161
    v_fmac_f32 v46, v10, v146
    v_mfma_f32_32x32x16_bf16 v[64:79], v[4:7], v[188:191], v[64:79]
    s_setprio 0
    v_fmac_f32 v236, v18, v162
    v_fmac_f32 v46, v11, v147
    v_fmac_f32 v236, v19, v163
    v_fmac_f32 v46, v12, v148
    v_fmac_f32 v236, v20, v164
    v_fmac_f32 v46, v13, v149
    v_fmac_f32 v236, v21, v165
    v_fmac_f32 v46, v14, v150
    v_fmac_f32 v236, v22, v166
    v_fmac_f32 v46, v15, v151
    v_fmac_f32 v236, v23, v167
    v_fma_f32 v234, v24, v112, -v234
    v_mul_f32 v240, v32, v160
    v_fmac_f32 v234, v25, v113
    v_fmac_f32 v240, v33, v161
    v_fmac_f32 v234, v26, v114
    v_fmac_f32 v240, v34, v162
    v_fmac_f32 v234, v27, v115
    v_fmac_f32 v240, v35, v163
    v_fmac_f32 v234, v28, v116
    v_fmac_f32 v240, v36, v164
    v_fmac_f32 v234, v29, v117
    v_fmac_f32 v240, v37, v165
    v_fmac_f32 v234, v30, v118
    v_fmac_f32 v240, v38, v166
    v_fmac_f32 v234, v31, v119
    v_fmac_f32 v240, v39, v167
    v_mul_f32 v47, v48, v152
    v_fmac_f32 v237, v56, v168
    v_fmac_f32 v47, v49, v153
    v_fmac_f32 v237, v57, v169
    v_fmac_f32 v47, v50, v154
    v_fmac_f32 v237, v58, v170
    v_fmac_f32 v47, v51, v155
    v_fmac_f32 v237, v59, v171
    v_fmac_f32 v47, v52, v156
    v_fmac_f32 v237, v60, v172
    v_fmac_f32 v47, v53, v157
    v_fmac_f32 v237, v61, v173
    v_fmac_f32 v47, v54, v158
    v_fmac_f32 v237, v62, v174
    v_fmac_f32 v47, v55, v159
    v_fmac_f32 v237, v63, v175
    v_fma_f32 v235, v64, v120, -v235
    v_mul_f32 v241, v72, v168
    v_fmac_f32 v235, v65, v121
    v_fmac_f32 v241, v73, v169
    v_fmac_f32 v235, v66, v122
    v_fmac_f32 v241, v74, v170
    v_fmac_f32 v235, v67, v123
    s_setprio 1
    s_waitcnt vmcnt(4) lgkmcnt(1)
    v_mfma_f32_32x32x16_bf16 v[8:23], v[80:83], v[176:179], 0
    ds_read_b64_tr_b16 v[184:185], v246 offset:2048
    ds_read_b64_tr_b16 v[186:187], v246 offset:3072
    ds_read_b64_tr_b16 v[188:189], v247 offset:2048
    ds_read_b64_tr_b16 v[190:191], v247 offset:3072
    v_fmac_f32 v241, v75, v171
    v_fmac_f32 v235, v68, v124
    s_mov_b32 m0, s68
    v_mfma_f32_32x32x16_bf16 v[24:39], v[84:87], v[176:179], 0
    buffer_load_dwordx4 v222, s[4:7], s44 offen sc1 lds
    buffer_load_dwordx4 v223, s[72:75], s44 offen offset:1024 sc1 lds
    s_waitcnt lgkmcnt(4)
    v_mad_u32_u16 v224, v224, s39, v248 op_sel:[1,0,0,0]
    v_mad_u32_u16 v225, v225, s39, v248 op_sel:[1,0,0,0]
    v_fmac_f32 v241, v76, v172
    v_fmac_f32 v235, v69, v125
    v_mfma_f32_32x32x16_bf16 v[48:63], v[80:83], v[180:183], 0
    v_add_u32 v226, s50, v251
    ds_read2_b32 v[226:227], v226 offset0:1 offset1:3
    v_fmac_f32 v241, v77, v173
    v_fmac_f32 v235, v70, v126
    v_fmac_f32 v241, v78, v174
    v_fmac_f32 v235, v71, v127
    v_fmac_f32 v241, v79, v175
    v_mfma_f32_32x32x16_bf16 v[64:79], v[84:87], v[180:183], 0
    v_permlane32_swap_b32 v236, v46
    v_permlane32_swap_b32 v237, v47
    v_add_f32 v236, v236, v46
    v_add_f32 v237, v237, v47
    s_waitcnt vmcnt(4) lgkmcnt(1)
    v_mfma_f32_32x32x16_bf16 v[8:23], v[88:91], v[184:187], v[8:23]
    ds_read_b64_tr_b16 v[176:177], v246 offset:4096
    ds_read_b64_tr_b16 v[178:179], v246 offset:5120
    ds_read_b64_tr_b16 v[180:181], v247 offset:4096
    ds_read_b64_tr_b16 v[182:183], v247 offset:5120
    v_cvt_pk_bf16_f32 v236, v236, v237
    ds_write_b32 v232, v236 offset:1024
    s_mov_b32 m0, s69
    v_mfma_f32_32x32x16_bf16 v[24:39], v[92:95], v[184:187], v[24:39]
    buffer_load_dwordx4 v224, s[4:7], s45 offen sc1 lds
    buffer_load_dwordx4 v225, s[72:75], s45 offen offset:1024 sc1 lds
    s_waitcnt lgkmcnt(5)
    v_mad_u32_u16 v226, v226, s39, v248 op_sel:[1,0,0,0]
    v_mad_u32_u16 v227, v227, s39, v248 op_sel:[1,0,0,0]
    v_mfma_f32_32x32x16_bf16 v[48:63], v[88:91], v[188:191], v[48:63]
    v_mfma_f32_32x32x16_bf16 v[64:79], v[92:95], v[188:191], v[64:79]
    s_waitcnt vmcnt(4) lgkmcnt(1)
    v_mfma_f32_32x32x16_bf16 v[8:23], v[228:231], v[176:179], v[8:23]
    ds_read_b64_tr_b16 v[184:185], v246 offset:6144
    ds_read_b64_tr_b16 v[186:187], v246 offset:7168
    ds_read_b64_tr_b16 v[188:189], v247 offset:6144
    ds_read_b64_tr_b16 v[190:191], v247 offset:7168
    s_mov_b32 s32, s31
    s_mov_b32 s31, s35
    s_mov_b32 m0, s70
    v_mfma_f32_32x32x16_bf16 v[24:39], v[242:245], v[176:179], v[24:39]
    buffer_load_dwordx4 v226, s[4:7], s46 offen sc1 lds
    buffer_load_dwordx4 v227, s[72:75], s46 offen offset:1024 sc1 lds
    s_sub_u32 s26, s48, s29
    s_mov_b32 s29, s48
    s_mov_b32 s30, s3
    s_bfe_u32 s56, s3, 0x40012
    v_mfma_f32_32x32x16_bf16 v[48:63], v[228:231], v[180:183], v[48:63]
    s_cmp_lg_u32 s36, 0
    s_cselect_b32 s56, s56, 0
    v_mfma_f32_32x32x16_bf16 v[64:79], v[242:245], v[180:183], v[64:79]
    s_waitcnt vmcnt(4) lgkmcnt(0)
    v_mfma_f32_32x32x16_bf16 v[8:23], v[0:3], v[184:187], v[8:23]
    ds_read_b64_tr_b16 v[176:177], v246 offset:0
    ds_read_b64_tr_b16 v[178:179], v246 offset:1024
    ds_read_b64_tr_b16 v[180:181], v247 offset:0
    ds_read_b64_tr_b16 v[182:183], v247 offset:1024
    s_mov_b32 m0, s71
    v_mfma_f32_32x32x16_bf16 v[24:39], v[4:7], v[184:187], v[24:39]
    s_cmp_eq_u32 s33, 4
    s_cbranch_scc1 K2_g4_137
    buffer_load_dwordx4 v224, s[4:7], s47 offen sc1 lds
    buffer_load_dwordx4 v225, s[72:75], s47 offen offset:1024 sc1 lds
K2_back_138:
    v_mfma_f32_32x32x16_bf16 v[48:63], v[0:3], v[188:191], v[48:63]
    s_nop 0
    v_mul_f32 v236, v8, v144
    v_fma_f32 v238, v16, v160, -v238
    v_fmac_f32 v236, v9, v145
    v_fmac_f32 v238, v17, v161
    v_fmac_f32 v236, v10, v146
    v_fmac_f32 v238, v18, v162
    v_fmac_f32 v236, v11, v147
    v_mfma_f32_32x32x16_bf16 v[64:79], v[4:7], v[188:191], v[64:79]
    s_setprio 0
    v_fmac_f32 v238, v19, v163
    v_fmac_f32 v236, v12, v148
    v_fmac_f32 v238, v20, v164
    v_fmac_f32 v236, v13, v149
    v_fmac_f32 v238, v21, v165
    v_fmac_f32 v236, v14, v150
    v_fmac_f32 v238, v22, v166
    v_fmac_f32 v236, v15, v151
    v_fmac_f32 v238, v23, v167
    v_add_u32 v249, s26, v249
    v_add_u32 v250, s26, v250
    v_fmac_f32 v240, v24, v160
    v_fma_f32 v234, v32, v112, -v234
    v_fmac_f32 v240, v25, v161
    v_fmac_f32 v234, v33, v113
    v_fmac_f32 v240, v26, v162
    v_fmac_f32 v234, v34, v114
    v_fmac_f32 v240, v27, v163
    v_fmac_f32 v234, v35, v115
    v_fmac_f32 v240, v28, v164
    v_fmac_f32 v234, v36, v116
    v_fmac_f32 v240, v29, v165
    v_fmac_f32 v234, v37, v117
    v_fmac_f32 v240, v30, v166
    v_fmac_f32 v234, v38, v118
    v_fmac_f32 v240, v31, v167
    v_fmac_f32 v234, v39, v119
    ds_read_b64_tr_b16 v[80:81], v249 offset:0
    ds_read_u16_d16_hi v40, v250 offset:0
    v_mul_f32 v237, v48, v152
    v_fma_f32 v239, v56, v168, -v239
    v_fmac_f32 v237, v49, v153
    v_fmac_f32 v239, v57, v169
    v_fmac_f32 v237, v50, v154
    v_fmac_f32 v239, v58, v170
    v_fmac_f32 v237, v51, v155
    v_fmac_f32 v239, v59, v171
    v_fmac_f32 v237, v52, v156
    v_fmac_f32 v239, v60, v172
    v_fmac_f32 v237, v53, v157
    v_fmac_f32 v239, v61, v173
    v_fmac_f32 v237, v54, v158
    v_fmac_f32 v239, v62, v174
    v_fmac_f32 v237, v55, v159
    v_fmac_f32 v239, v63, v175
    ds_read_b64_tr_b16 v[88:89], v249 offset:512
    ds_read_u16_d16_hi v41, v250 offset:128
    v_fmac_f32 v241, v64, v168
    v_fma_f32 v235, v72, v120, -v235
    v_fmac_f32 v241, v65, v169
    v_fmac_f32 v235, v73, v121
    v_fmac_f32 v241, v66, v170
    v_fmac_f32 v235, v74, v122
    v_fmac_f32 v241, v67, v171
    v_fmac_f32 v235, v75, v123
    v_fmac_f32 v241, v68, v172
    v_fmac_f32 v235, v76, v124
    v_fmac_f32 v241, v69, v173
    v_fmac_f32 v235, v77, v125
    v_fmac_f32 v241, v70, v174
    v_fmac_f32 v235, v78, v126
    v_fmac_f32 v241, v71, v175
    v_fmac_f32 v235, v79, v127
    s_cmp_eq_u32 s56, 5
    s_cbranch_scc1 K2_U21
    s_cmp_eq_u32 s56, 6
    s_cbranch_scc1 K2_U3h1
    s_branch K2_DSP1
K2_FLGR:
    s_sub_u32 s27, s27, 16
    s_cbranch_scc1 K2_END
    buffer_load_dwordx4 v[56:59], v60, s[8:11], s64 offen sc1
    s_waitcnt vmcnt(0)
    s_branch K2_FLGW
K2_FLGY:
    v_mov_b32 v56, s2
    v_mov_b32 v57, 7178240
    s_mov_b64 exec, 1
    buffer_store_dword v56, v57, s[8:11], 0 offen sc1
    s_mov_b64 exec, -1
    s_branch K2_FLGOK
K2_nul_93:
    s_mov_b32 s58, 63
    s_mov_b32 s36, 0
    s_branch K2_back_96
K2_spin_94:
    s_sub_u32 s27, s27, 1
    s_cbranch_scc1 K2_END
    ds_read_b32 v42, v254
    s_waitcnt lgkmcnt(0)
    s_branch K2_chk_95
K2_dyn_91:
    v_lshl_add_u32 v254, v252, 1, s53
    s_mov_b64 exec, 0x1ff
    ds_add_rtn_u32 v42, v254, v251
    s_mov_b64 exec, -1
    s_waitcnt lgkmcnt(0)
    v_readlane_b32 s58, v42, 8
    s_nop 0
    s_lshr_b32 s58, s58, 4
    s_cmp_lt_u32 s58, s22
    s_cbranch_scc0 K2_nul_93
    v_readlane_b32 s3, v253, s58
    s_nop 0
    s_bfe_u32 s58, s3, 0x60016
    s_and_b32 s59, s58, 7
    s_lshr_b32 s60, s58, 3
K2_chk_95:
    v_readlane_b32 s61, v42, s59
    s_nop 0
    s_cmp_gt_u32 s61, s60
    s_cbranch_scc0 K2_spin_94
K2_back_96:
    s_mov_b32 s34, 1
    s_branch K2_back_92
K2_rare_97:
    s_cmp_eq_u32 s33, 4
    s_cbranch_scc1 K2_four_99
    s_mov_b32 s49, s48
    s_xor_b32 s45, s44, 256
    s_xor_b32 s46, s44, 512
    s_xor_b32 s47, s44, 768
    s_branch K2_back_98
K2_four_99:
    s_add_u32 s50, s48, 256
    s_mov_b32 s46, s44
    s_mov_b32 s47, s44
    s_branch K2_back_98
K2_dum_100:
    v_mov_b32 v42, -1
    s_mov_b32 m0, 163312
    s_mov_b64 exec, 1
    buffer_load_dwordx4 v42, s[16:19], 0 offen lds
    buffer_load_dwordx4 v42, s[16:19], 0 offen lds
    s_mov_b64 exec, -1
    s_branch K2_back_102
K2_a4_101:
    v_add_u32 v254, s48, v232
    ds_read_b32 v254, v254 offset:4
    s_lshr_b32 s65, s3, 28
    s_mul_i32 s66, s22, 2080
    s_lshl_b32 s65, s65, 9
    s_add_u32 s65, s65, s66
    s_add_u32 s65, s65, 65536
    s_mov_b32 m0, s65
    s_mov_b32 exec_hi, 0
    s_waitcnt lgkmcnt(0)
    v_or_b32 v254, v254, v233
    buffer_load_dwordx4 v254, s[16:19], 0 offen  lds
    s_mov_b32 exec_hi, -1
    s_branch K2_b4_103
K2_g4_104:
    s_add_u32 s51, s48, 384
    v_add_u32 v44, s51, v251
    ds_read2_b32 v[44:45], v44 offset0:1 offset1:3
    s_waitcnt lgkmcnt(0)
    v_mad_u32_u16 v44, v44, s39, v248 op_sel:[1,0,0,0]
    v_mad_u32_u16 v45, v45, s39, v248 op_sel:[1,0,0,0]
    buffer_load_dwordx4 v44, s[4:7], s47 offen sc1 lds
    buffer_load_dwordx4 v45, s[72:75], s47 offen offset:1024 sc1 lds
    s_branch K2_back_105
K2_nul_108:
    s_mov_b32 s58, 63
    s_mov_b32 s36, 0
    s_branch K2_back_111
K2_spin_109:
    s_sub_u32 s27, s27, 1
    s_cbranch_scc1 K2_END
    ds_read_b32 v42, v254
    s_waitcnt lgkmcnt(0)
    s_branch K2_chk_110
K2_dyn_106:
    v_lshl_add_u32 v254, v252, 1, s53
    s_mov_b64 exec, 0x1ff
    ds_add_rtn_u32 v42, v254, v251
    s_mov_b64 exec, -1
    s_waitcnt lgkmcnt(0)
    v_readlane_b32 s58, v42, 8
    s_nop 0
    s_lshr_b32 s58, s58, 4
    s_cmp_lt_u32 s58, s22
    s_cbranch_scc0 K2_nul_108
    v_readlane_b32 s3, v253, s58
    s_nop 0
    s_bfe_u32 s58, s3, 0x60016
    s_and_b32 s59, s58, 7
    s_lshr_b32 s60, s58, 3
K2_chk_110:
    v_readlane_b32 s61, v42, s59
    s_nop 0
    s_cmp_gt_u32 s61, s60
    s_cbranch_scc0 K2_spin_109
K2_back_111:
    s_mov_b32 s34, 1
    s_branch K2_back_107
K2_rare_112:
    s_cmp_eq_u32 s33, 4
    s_cbranch_scc1 K2_four_114
    s_mov_b32 s49, s48
    s_xor_b32 s45, s44, 256
    s_xor_b32 s46, s44, 512
    s_xor_b32 s47, s44, 768
    s_branch K2_back_113
K2_four_114:
    s_add_u32 s50, s48, 256
    s_mov_b32 s46, s44
    s_mov_b32 s47, s44
    s_branch K2_back_113
K2_g4_115:
    s_add_u32 s51, s48, 384
    v_add_u32 v44, s51, v251
    ds_read2_b32 v[44:45], v44 offset0:1 offset1:3
    s_waitcnt lgkmcnt(0)
    v_mad_u32_u16 v44, v44, s39, v248 op_sel:[1,0,0,0]
    v_mad_u32_u16 v45, v45, s39, v248 op_sel:[1,0,0,0]
    buffer_load_dwordx4 v44, s[4:7], s47 offen sc1 lds
    buffer_load_dwordx4 v45, s[72:75], s47 offen offset:1024 sc1 lds
    s_branch K2_back_116
K2_dum_117:
    v_mov_b32 v42, -1
    s_mov_b32 m0, 163312
    s_mov_b64 exec, 1
    buffer_load_dwordx4 v42, s[16:19], 0 offen lds
    buffer_load_dwordx4 v42, s[16:19], 0 offen lds
    s_mov_b64 exec, -1
    s_branch K2_back_119
K2_a4_118:
    v_add_u32 v254, s48, v232
    ds_read_b32 v254, v254 offset:4
    s_lshr_b32 s65, s3, 28
    s_mul_i32 s66, s22, 2080
    s_lshl_b32 s65, s65, 9
    s_add_u32 s65, s65, s66
    s_add_u32 s65, s65, 65536
    s_mov_b32 m0, s65
    s_mov_b32 exec_hi, 0
    s_waitcnt lgkmcnt(0)
    v_or_b32 v254, v254, v233
    buffer_load_dwordx4 v254, s[16:19], 0 offen  lds
    s_mov_b32 exec_hi, -1
    s_branch K2_b4_120
K2_nul_121:
    s_mov_b32 s3, 949760
    s_mov_b32 s36, 0
    s_branch K2_back_124
K2_spin_122:
    s_sub_u32 s27, s27, 1
    s_cbranch_scc1 K2_END
    ds_read_b32 v42, v254
    s_waitcnt lgkmcnt(0)
    s_branch K2_chk_123
K2_rare_125:
    s_cmp_eq_u32 s33, 4
    s_cbranch_scc1 K2_four_127
    s_mov_b32 s49, s48
    s_xor_b32 s45, s44, 256
    s_xor_b32 s46, s44, 512
    s_xor_b32 s47, s44, 768
    s_branch K2_back_126
K2_four_127:
    s_add_u32 s50, s48, 256
    s_mov_b32 s46, s44
    s_mov_b32 s47, s44
    s_branch K2_back_126
K2_g4_128:
    s_add_u32 s51, s48, 384
    v_add_u32 v44, s51, v251
    ds_read2_b32 v[44:45], v44 offset0:1 offset1:3
    s_waitcnt lgkmcnt(0)
    v_mad_u32_u16 v44, v44, s39, v248 op_sel:[1,0,0,0]
    v_mad_u32_u16 v45, v45, s39, v248 op_sel:[1,0,0,0]
    buffer_load_dwordx4 v44, s[4:7], s47 offen sc1 lds
    buffer_load_dwordx4 v45, s[72:75], s47 offen offset:1024 sc1 lds
    s_branch K2_back_129
K2_nul_130:
    s_mov_b32 s3, 949760
    s_mov_b32 s36, 0
    s_branch K2_back_133
K2_spin_131:
    s_sub_u32 s27, s27, 1
    s_cbranch_scc1 K2_END
    ds_read_b32 v42, v254
    s_waitcnt lgkmcnt(0)
    s_branch K2_chk_132
K2_rare_134:
    s_cmp_eq_u32 s33, 4
    s_cbranch_scc1 K2_four_136
    s_mov_b32 s49, s48
    s_xor_b32 s45, s44, 256
    s_xor_b32 s46, s44, 512
    s_xor_b32 s47, s44, 768
    s_branch K2_back_135
K2_four_136:
    s_add_u32 s50, s48, 256
    s_mov_b32 s46, s44
    s_mov_b32 s47, s44
    s_branch K2_back_135
K2_g4_137:
    s_add_u32 s51, s48, 384
    v_add_u32 v44, s51, v251
    ds_read2_b32 v[44:45], v44 offset0:1 offset1:3
    s_waitcnt lgkmcnt(0)
    v_mad_u32_u16 v44, v44, s39, v248 op_sel:[1,0,0,0]
    v_mad_u32_u16 v45, v45, s39, v248 op_sel:[1,0,0,0]
    buffer_load_dwordx4 v44, s[4:7], s47 offen sc1 lds
    buffer_load_dwordx4 v45, s[72:75], s47 offen offset:1024 sc1 lds
    s_branch K2_back_138
K2_END:
    s_endpgm
.section .rodata,"a"
.p2align 6
.amdhsa_kernel standalone__tensor_product_equiv_equiformer__graph_kernel
  .amdhsa_next_free_vgpr 256
  .amdhsa_next_free_sgpr 102
  .amdhsa_accum_offset 256
  .amdhsa_group_segment_fixed_size 0
  .amdhsa_kernarg_size 96
  .amdhsa_user_sgpr_count 2
  .amdhsa_user_sgpr_kernarg_segment_ptr 1
  .amdhsa_system_sgpr_workgroup_id_x 1
  .amdhsa_float_denorm_mode_32 3
.end_amdhsa_kernel
```

```asm
; @launch grid=(256,1,1) block=(512,1,1) lds=163840
.amdgcn_target "amdgcn-amd-amdhsa--gfx950"
.text
.globl standalone__tensor_product_equiv_equiformer__graph_kernel
.p2align 8
.type standalone__tensor_product_equiv_equiformer__graph_kernel,@function
standalone__tensor_product_equiv_equiformer__graph_kernel:
    s_cmp_ge_u32 s2, 256
    s_cbranch_scc1 K2_END
    s_load_dwordx16 s[80:95], s[0:1], 0
    s_load_dwordx4 s[96:99], s[0:1], 72
    s_load_dwordx2 s[100:101], s[0:1], 88
    v_lshrrev_b32 v1, 6, v0
    s_mov_b32 s54, s2
    v_readfirstlane_b32 s20, v1
    s_mov_b64 exec, 0
    s_cmp_eq_u32 s20, 0
    s_cbranch_scc1 K2_PAD_S1
    s_cmp_eq_u32 s20, 1
    s_cbranch_scc1 K2_PAD_S2
    s_cmp_eq_u32 s20, 5
    s_cbranch_scc1 K2_PAD_H1
    s_cmp_eq_u32 s20, 6
    s_cbranch_scc1 K2_PAD_H2
    s_cmp_eq_u32 s20, 2
    s_cbranch_scc1 K2_PAD_H3
KS_HOP0:
    s_mov_b64 exec, -1
    v_and_b32 v8, 63, v0
    v_lshlrev_b32 v9, 4, v8
    v_mov_b32 v6, 0
    v_lshlrev_b32 v5, 4, v0
    v_mul_u32_u24 v4, 24, v0
    s_mul_i32 s64, s2, 5120
    s_mul_i32 s65, s2, 7680
    v_mov_b32 v176, v8
    v_mov_b32 v177, v0
    s_movk_i32 s39, 1024
    s_lshl_b32 s37, s20, 13
    s_mov_b32 s53, 163264
    s_lshl_b32 s52, s20, 2
    s_add_u32 s52, s52, s53
    s_add_u32 s68, s37, 0
    s_add_u32 s69, s37, 2048
    s_add_u32 s70, s37, 4096
    s_add_u32 s71, s37, 6144
    s_waitcnt lgkmcnt(0)
    s_mov_b32 s8, s100
    s_and_b32 s9, s101, 0xffff
    s_mov_b32 s10, 37748736
    s_mov_b32 s11, 0x20000
    s_cmp_lg_u32 s20, 7
    s_cbranch_scc1 KS_NOTAG
    s_mov_b32 s24, 7178240
    s_mov_b64 exec, 1
    buffer_load_dword v14, v6, s[8:11], s24 offen sc1
    s_mov_b64 exec, -1
    s_mov_b32 s60, s98
    s_and_b32 s61, s99, 0xffff
    s_mov_b32 s62, 256
    s_mov_b32 s63, 0x20000
    s_barrier
    v_mov_b32 v76, 0
    v_mov_b32 v77, -1
    v_lshlrev_b32 v78, 2, v8
    v_add_u32 v78, 163072, v78
    s_mov_b64 exec, 0x1ff
    ds_write_b32 v78, v76 offset:192
    s_mov_b32 exec_lo, 1
    ds_write_b32 v78, v76 offset:228
    s_mov_b32 exec_lo, -1
    ds_write_b32 v78, v77 offset:256
    s_mov_b64 exec, -1
    s_mov_b32 exec_hi, 0xffff
    ds_write_b32 v78, v76
    s_mov_b64 exec, 1
    ds_write_b32 v78, v76 offset:232
    s_mov_b64 exec, -1
    s_mov_b64 exec, 1
    buffer_load_dword v15, v6, s[60:63], 0 offen sc1
    v_mov_b32 v12, 163456
    s_mov_b32 s24, 1664525
    s_waitcnt vmcnt(1)
    v_mul_lo_u32 v59, v14, s24
    v_add_u32 v59, 1013904223, v59
    ds_write2_b32 v12, v59, v6 offset0:0 offset1:1
    s_waitcnt lgkmcnt(0)
    s_barrier
    s_waitcnt vmcnt(0)
    v_mov_b32 v62, v15
    ds_write_b32 v12, v15 offset:4
    v_cmp_ne_u32 vcc, 0, v15
    s_mov_b32 s24, 0x40000
    s_waitcnt lgkmcnt(0)
    s_barrier
    s_cbranch_vccnz KS_FLOK
KS_FLW:
    s_sub_u32 s24, s24, 1
    s_cbranch_scc1 K2_END
    buffer_load_dword v62, v6, s[60:63], 0 offen sc1
    s_waitcnt vmcnt(0)
    v_cmp_ne_u32 vcc, 0, v62
    s_nop 0
    s_cbranch_vccz KS_FLW
    ds_write_b32 v12, v62 offset:4
KS_FLOK:
    s_mov_b64 exec, -1
    s_branch KS_JOIN
KS_H0:
    s_barrier
    s_branch KS_HELP
K2_PAD_S1:
    s_branch KS_HOP0
KS_NOTAG:
    s_cmp_ge_u32 s20, 5
    s_cbranch_scc1 KS_HELP
    s_cmp_ge_u32 s2, 250
    s_cbranch_scc1 KS_IDLE
    s_mov_b32 s40, s88
    s_and_b32 s41, s89, 0xffff
    s_mov_b32 s42, 1280000
    s_mov_b32 s43, 0x20000
    buffer_load_dwordx4 v[12:15], v5, s[40:43], s64 offen
    s_mov_b32 s44, s86
    s_and_b32 s45, s87, 0xffff
    s_mov_b32 s46, 1280000
    s_mov_b32 s47, 0x20000
    s_mov_b32 s48, s82
    s_and_b32 s49, s83, 0xffff
    s_mov_b32 s50, 1920000
    s_mov_b32 s51, 0x20000
    buffer_load_dwordx4 v[16:19], v5, s[44:47], s64 offen
    buffer_load_dwordx4 v[20:23], v4, s[48:51], s65 offen
    buffer_load_dwordx2 v[24:25], v4, s[48:51], s65 offen offset:16
    v_lshlrev_b32 v2, 2, v0
    s_lshl_b32 s64, s64, 3
    v_lshl_add_u32 v3, v0, 7, s64
    v_mov_b32 v7, 1
    s_setprio 2
    s_cmp_eq_u32 s20, 4
    s_cbranch_scc1 KS_NOCLR
    s_setprio 1
    ds_write_b32 v2, v6
KS_NOCLR:
    s_waitcnt lgkmcnt(0)
    s_barrier
    s_mov_b64 exec, 0
    s_cmp_eq_u32 s20, 0
    s_cbranch_scc1 K2_PAD_B3
    s_cmp_eq_u32 s20, 1
    s_cbranch_scc1 K2_PAD_LD
    s_cmp_eq_u32 s20, 2
    s_cbranch_scc1 K2_PAD_NW
    s_cmp_eq_u32 s20, 3
    s_cbranch_scc1 K2_PAD_SC
    s_cmp_eq_u32 s20, 4
    s_cbranch_scc1 K2_PAD_SD
KS_HOP:
    s_mov_b64 exec, -1
    s_mov_b32 s58, 214749
    s_movk_i32 s59, 625
    s_waitcnt vmcnt(3)
    v_mul_u32_u24 v28, s58, v12
    v_and_b32 v40, 0xffffff, v28
    v_lshrrev_b32 v32, 26, v28
    v_add_u32 v40, 8187281, v40
    v_bfe_u32 v36, v28, 24, 2
    v_lshlrev_b32 v32, 2, v32
    v_lshrrev_b32 v40, 24, v40
    v_lshl_or_b32 v32, v36, 8, v32
    v_lshl_or_b32 v32, v40, 7, v32
    ds_add_rtn_u32 v36, v32, v7
    v_mul_u32_u24 v29, s58, v13
    v_and_b32 v41, 0xffffff, v29
    v_lshrrev_b32 v33, 26, v29
    v_add_u32 v41, 8187281, v41
    v_bfe_u32 v37, v29, 24, 2
    v_lshlrev_b32 v33, 2, v33
    v_lshrrev_b32 v41, 24, v41
    v_lshl_or_b32 v33, v37, 8, v33
    v_lshl_or_b32 v33, v41, 7, v33
    ds_add_rtn_u32 v37, v33, v7
    v_mul_u32_u24 v30, s58, v14
    v_and_b32 v42, 0xffffff, v30
    v_lshrrev_b32 v34, 26, v30
    v_add_u32 v42, 8187281, v42
    v_bfe_u32 v38, v30, 24, 2
    v_lshlrev_b32 v34, 2, v34
    v_lshrrev_b32 v42, 24, v42
    v_lshl_or_b32 v34, v38, 8, v34
    v_lshl_or_b32 v34, v42, 7, v34
    ds_add_rtn_u32 v38, v34, v7
    v_mul_u32_u24 v31, s58, v15
    v_and_b32 v43, 0xffffff, v31
    v_lshrrev_b32 v35, 26, v31
    v_add_u32 v43, 8187281, v43
    v_bfe_u32 v39, v31, 24, 2
    v_lshlrev_b32 v35, 2, v35
    v_lshrrev_b32 v43, 24, v43
    v_lshl_or_b32 v35, v39, 8, v35
    v_lshl_or_b32 v35, v43, 7, v35
    ds_add_rtn_u32 v39, v35, v7
    v_lshrrev_b32 v28, 24, v28
    v_mad_u32_u24 v28, v28, s59, 7
    v_lshrrev_b32 v28, 3, v28
    v_mad_u32_u24 v28, v40, 40, v28
    v_sub_u32 v28, v12, v28
    v_add_u32 v12, 0, v3
    v_lshl_or_b32 v28, v28, 26, v12
    v_lshrrev_b32 v29, 24, v29
    v_mad_u32_u24 v29, v29, s59, 7
    v_lshrrev_b32 v29, 3, v29
    v_mad_u32_u24 v29, v41, 40, v29
    v_sub_u32 v29, v13, v29
    v_add_u32 v13, 32, v3
    v_lshl_or_b32 v29, v29, 26, v13
    v_lshrrev_b32 v30, 24, v30
    v_mad_u32_u24 v30, v30, s59, 7
    v_lshrrev_b32 v30, 3, v30
    v_mad_u32_u24 v30, v42, 40, v30
    v_sub_u32 v30, v14, v30
    v_add_u32 v14, 64, v3
    v_lshl_or_b32 v30, v30, 26, v14
    v_lshrrev_b32 v31, 24, v31
    v_mad_u32_u24 v31, v31, s59, 7
    v_lshrrev_b32 v31, 3, v31
    v_mad_u32_u24 v31, v43, 40, v31
    v_sub_u32 v31, v15, v31
    v_add_u32 v15, 96, v3
    v_lshl_or_b32 v31, v31, 26, v15
K2_PAD_S2:
    s_cbranch_execz KS_HOP0
    v_mov_b32 v59, 163456
    s_mul_i32 s65, s2, 1152
    s_add_u32 s65, s65, 6291456
    s_mul_i32 s64, s2, 20608
    s_waitcnt lgkmcnt(0)
    s_barrier
    ds_read_b128 v[40:43], v9
    ds_read_b32 v59, v59
    s_waitcnt lgkmcnt(1)
    v_add_u32 v45, v40, v41
    v_add_u32 v46, v45, v42
    v_add_u32 v47, v46, v43
    v_mov_b32 v58, v47
    s_nop 1
    v_add_u32_dpp v58, v58, v58 row_shr:1 row_mask:0xf bank_mask:0xf bound_ctrl:0
    s_nop 1
    v_add_u32_dpp v58, v58, v58 row_shr:2 row_mask:0xf bank_mask:0xf bound_ctrl:0
    s_nop 1
    v_add_u32_dpp v58, v58, v58 row_shr:4 row_mask:0xf bank_mask:0xf bound_ctrl:0
    s_nop 1
    v_add_u32_dpp v58, v58, v58 row_shr:8 row_mask:0xf bank_mask:0xf bound_ctrl:0
    s_nop 1
    v_add_u32_dpp v58, v58, v58 row_bcast:15 row_mask:0xa bank_mask:0xf
    s_nop 1
    v_add_u32_dpp v58, v58, v58 row_bcast:31 row_mask:0xc bank_mask:0xf
    v_sub_u32 v48, v58, v47
    v_add_u32 v49, v48, v40
    v_add_u32 v50, v48, v45
    v_add_u32 v51, v48, v46
    ds_write_b128 v9, v[48:51] offset:1024
    s_waitcnt lgkmcnt(1)
    s_cmp_lg_u32 s20, 4
    s_cbranch_scc1 KS_NOPUB
    v_lshl_or_b32 v56, v49, 11, v48
    v_lshl_or_b32 v57, v51, 11, v50
    v_lshl_or_b32 v56, v59, 22, v56
    v_lshl_or_b32 v57, v59, 22, v57
    buffer_store_dwordx4 v[56:59], v9, s[8:11], s65 offen sc1
KS_NOPUB:
    s_waitcnt lgkmcnt(0)
    ds_read_b32 v32, v32 offset:1024
    ds_read_b32 v33, v33 offset:1024
    ds_read_b32 v34, v34 offset:1024
    ds_read_b32 v35, v35 offset:1024
    s_cbranch_scc1 KS_PUB0
    s_waitcnt vmcnt(1)
    s_branch KS_PUB1
KS_PUB0:
    s_waitcnt vmcnt(0)
KS_PUB1:
    v_and_b32 v60, 0xffff, v59
    v_and_b32 v61, 0xffff0000, v59
    s_mov_b32 s58, 0xffff0000
    v_xor_b32 v40, 0x80000000, v20
    v_lshl_or_b32 v41, v21, 16, v60
    v_or_b32 v42, v61, v16
    v_mov_b32 v43, v28
    v_alignbit_b32 v44, v22, v21, 16
    v_and_or_b32 v45, v22, s58, v60
    v_xor_b32 v44, 0x80000000, v44
    v_or_b32 v46, v61, v17
    v_mov_b32 v47, v29
    v_xor_b32 v48, 0x80000000, v23
    v_lshl_or_b32 v49, v24, 16, v60
    v_or_b32 v50, v61, v18
    v_mov_b32 v51, v30
    v_alignbit_b32 v52, v25, v24, 16
    v_and_or_b32 v53, v25, s58, v60
    v_xor_b32 v52, 0x80000000, v52
    v_or_b32 v54, v61, v19
    v_mov_b32 v55, v31
    s_waitcnt lgkmcnt(0)
    v_add_lshl_u32 v32, v32, v36, 4
    ds_write_b128 v32, v[40:43] offset:2048
    v_add_lshl_u32 v33, v33, v37, 4
    ds_write_b128 v33, v[44:47] offset:2048
    v_add_lshl_u32 v34, v34, v38, 4
    ds_write_b128 v34, v[48:51] offset:2048
    v_add_lshl_u32 v35, v35, v39, 4
    ds_write_b128 v35, v[52:55] offset:2048
    v_mov_b32 v62, 163460
    s_waitcnt lgkmcnt(0)
    s_barrier
    ds_read_b32 v62, v62
    ds_read_b128 v[12:15], v5 offset:2048
    ds_read_b128 v[16:19], v5 offset:7168
    ds_read_b128 v[20:23], v5 offset:12288
    ds_read_b128 v[24:27], v5 offset:17408
    s_waitcnt lgkmcnt(3)
    buffer_store_dwordx4 v[12:15], v5, s[8:11], s64 offen sc1
    s_add_u32 s64, s64, 5120
    s_waitcnt lgkmcnt(2)
    buffer_store_dwordx4 v[16:19], v5, s[8:11], s64 offen sc1
    s_add_u32 s64, s64, 5120
    s_waitcnt lgkmcnt(1)
    buffer_store_dwordx4 v[20:23], v5, s[8:11], s64 offen sc1
    s_add_u32 s64, s64, 5120
    s_waitcnt lgkmcnt(0)
    buffer_store_dwordx4 v[24:27], v5, s[8:11], s64 offen sc1
    s_branch KS_JOIN
K2_PAD_B3:
    s_branch KS_HOP
KS_B3:
    v_mov_b32 v59, 163456
    ds_read_b32 v59, v59
    v_mov_b32 v62, 163460
    s_waitcnt lgkmcnt(0)
    s_barrier
    ds_read_b32 v62, v62
KS_JOIN:
    s_setprio 0
    v_readfirstlane_b32 s2, v59
    s_mov_b32 s25, 0x400000
KS_JOIN2:
    s_waitcnt lgkmcnt(0)
    v_readfirstlane_b32 s24, v62
    s_nop 0
    s_cmp_eq_u32 s24, 0
    s_cbranch_scc1 KS_FLS
    s_bfe_u32 s24, s24, 0x10001
    s_xor_b32 s54, s54, s24
    s_lshr_b32 s21, s54, 1
    s_mul_i32 s21, s21, 625
    s_add_u32 s22, s21, 632
    s_add_u32 s21, s21, 7
    s_lshr_b32 s21, s21, 3
    s_lshr_b32 s22, s22, 3
    s_add_u32 s24, s21, 40
    s_sub_u32 s22, s22, s24
    s_bitcmp1_b32 s54, 0
    s_cselect_b32 s21, s24, s21
    s_cselect_b32 s22, s22, 40
    s_mov_b32 s23, 0
    s_mov_b32 s28, 1
    s_mov_b32 s24, 0
    s_mov_b32 s25, 1
K2_CELLS:
    v_lshrrev_b32 v178, 1, v177
    v_min_u32 v178, 249, v178
    v_mul_u32_u24 v72, 1152, v178
    s_and_b32 s58, s54, 7
    s_lshl_b32 s58, s58, 7
    s_lshr_b32 s59, s54, 5
    s_lshl_b32 s59, s59, 4
    s_add_u32 s67, s58, s59
    s_add_u32 s67, s67, 6291456
    s_cmp_eq_u32 s28, 0
    s_cbranch_scc1 K2_NOSRD
    s_mov_b32 s4, s80
    s_and_b32 s5, s81, 0xffff
    s_mov_b32 s6, 10240000
    s_mov_b32 s7, 0x20000
    s_mov_b32 s12, s96
    s_and_b32 s13, s97, 0xffff
    s_mov_b32 s14, 10240000
    s_mov_b32 s15, 0x20000
    s_mov_b32 s16, s84
    s_and_b32 s17, s85, 0xffff
    s_mov_b32 s18, 10240000
    s_mov_b32 s19, 0x20000
    s_sub_u32 s80, s80, 1024
    s_subb_u32 s81, s81, 0
    s_mov_b32 s72, s80
    s_and_b32 s73, s81, 0xffff
    s_mov_b32 s74, 10241024
    s_mov_b32 s75, 0x20000
K2_NOSRD:
    v_and_b32 v84, 15, v176
    v_lshrrev_b32 v85, 5, v176
    v_bfe_u32 v86, v176, 4, 1
    v_lshrrev_b32 v87, 2, v84
    v_and_b32 v88, 3, v84
    v_lshl_add_u32 v89, v85, 2, v87
    v_lshrrev_b32 v90, 4, v176
    v_and_b32 v91, 1, v87
    v_lshl_add_u32 v91, v90, 1, v91
    v_lshlrev_b32 v249, 6, v91
    v_lshrrev_b32 v91, 1, v87
    v_lshl_add_u32 v249, v91, 5, v249
    v_lshl_add_u32 v249, v88, 3, v249
    v_add_u32 v249, 512, v249
    v_and_b32 v91, 1, v88
    v_lshl_add_u32 v91, v90, 1, v91
    v_lshlrev_b32 v250, 4, v91
    v_lshrrev_b32 v91, 1, v88
    v_lshl_add_u32 v250, v91, 3, v250
    v_lshl_add_u32 v250, v87, 1, v250
    v_lshrrev_b32 v90, 1, v88
    v_lshl_add_u32 v90, v86, 1, v90
    v_bfe_u32 v91, v87, 1, 1
    v_lshlrev_b32 v91, 2, v91
    v_xor_b32 v90, v90, v91
    v_lshlrev_b32 v90, 4, v90
    v_lshl_add_u32 v90, v89, 7, v90
    v_and_b32 v91, 1, v88
    v_lshl_add_u32 v90, v91, 3, v90
    v_add_u32 v246, s37, v90
    v_xor_b32 v247, 64, v246
    v_lshrrev_b32 v90, 3, v176
    v_lshlrev_b32 v251, 4, v90
    v_bfe_u32 v90, v90, 1, 1
    v_lshlrev_b32 v90, 2, v90
    v_and_b32 v91, 7, v176
    v_xor_b32 v90, v90, v91
    v_lshlrev_b32 v248, 4, v90
    v_lshlrev_b32 v252, 1, v176
    v_and_b32 v233, 1, v176
    v_lshlrev_b32 v233, 4, v233
    v_lshrrev_b32 v90, 1, v176
    v_lshlrev_b32 v90, 5, v90
    v_add_u32 v232, 512, v90
    s_cmp_eq_u32 s28, 0
    s_cbranch_scc1 K2_NOW0
    v_lshrrev_b32 v60, 6, v252
    v_bfe_u32 v61, v252, 3, 2
    v_lshl_add_u32 v60, v60, 2, v61
    v_mul_u32_u24 v60, 640, v60
    v_bfe_u32 v61, v252, 5, 1
    v_lshl_add_u32 v60, v61, 5, v60
    v_and_b32 v61, 6, v252
    v_lshl_add_u32 v60, v61, 2, v60
    v_add_u32 v60, 24576, v60
    ds_read_b64_tr_b16 v[136:137], v60 offset:0
    ds_read_b64_tr_b16 v[138:139], v60 offset:5120
    ds_read_b64_tr_b16 v[140:141], v60 offset:64
    ds_read_b64_tr_b16 v[142:143], v60 offset:5184
    ds_read_b64_tr_b16 v[144:145], v60 offset:128
    ds_read_b64_tr_b16 v[146:147], v60 offset:5248
    ds_read_b64_tr_b16 v[148:149], v60 offset:192
    ds_read_b64_tr_b16 v[150:151], v60 offset:5312
    ds_read_b64_tr_b16 v[152:153], v60 offset:256
    ds_read_b64_tr_b16 v[154:155], v60 offset:5376
    ds_read_b64_tr_b16 v[156:157], v60 offset:320
    ds_read_b64_tr_b16 v[158:159], v60 offset:5440
    ds_read_b64_tr_b16 v[160:161], v60 offset:384
    ds_read_b64_tr_b16 v[162:163], v60 offset:5504
    ds_read_b64_tr_b16 v[164:165], v60 offset:448
    ds_read_b64_tr_b16 v[166:167], v60 offset:5568
    ds_read_b64_tr_b16 v[168:169], v60 offset:512
    ds_read_b64_tr_b16 v[170:171], v60 offset:5632
    ds_read_b64_tr_b16 v[172:173], v60 offset:576
    ds_read_b64_tr_b16 v[174:175], v60 offset:5696
    s_waitcnt lgkmcnt(0)
    v_lshlrev_b32 v96, 16, v136
    v_and_b32 v97, 0xffff0000, v136
    v_lshlrev_b32 v98, 16, v137
    v_and_b32 v99, 0xffff0000, v137
    v_lshlrev_b32 v100, 16, v138
    v_and_b32 v101, 0xffff0000, v138
    v_lshlrev_b32 v102, 16, v139
    v_and_b32 v103, 0xffff0000, v139
    v_lshlrev_b32 v104, 16, v140
    v_and_b32 v105, 0xffff0000, v140
    v_lshlrev_b32 v106, 16, v141
    v_and_b32 v107, 0xffff0000, v141
    v_lshlrev_b32 v108, 16, v142
    v_and_b32 v109, 0xffff0000, v142
    v_lshlrev_b32 v110, 16, v143
    v_and_b32 v111, 0xffff0000, v143
    v_lshlrev_b32 v112, 16, v144
    v_and_b32 v113, 0xffff0000, v144
    v_lshlrev_b32 v114, 16, v145
    v_and_b32 v115, 0xffff0000, v145
    v_lshlrev_b32 v116, 16, v146
    v_and_b32 v117, 0xffff0000, v146
    v_lshlrev_b32 v118, 16, v147
    v_and_b32 v119, 0xffff0000, v147
    v_lshlrev_b32 v120, 16, v148
    v_and_b32 v121, 0xffff0000, v148
    v_lshlrev_b32 v122, 16, v149
    v_and_b32 v123, 0xffff0000, v149
    v_lshlrev_b32 v124, 16, v150
    v_and_b32 v125, 0xffff0000, v150
    v_lshlrev_b32 v126, 16, v151
    v_and_b32 v127, 0xffff0000, v151
    buffer_load_dwordx4 v[76:79], v72, s[8:11], s67 offen sc1
    s_mov_b64 exec, 0
    s_cmp_eq_u32 s20, 0
    s_cbranch_scc1 K2_PAD_U20
    s_cmp_eq_u32 s20, 1
    s_cbranch_scc1 K2_PAD_U30
    s_cmp_eq_u32 s20, 2
    s_cbranch_scc1 K2_PAD_U21
    s_cmp_eq_u32 s20, 3
    s_cbranch_scc1 K2_PAD_U31
    s_cmp_eq_u32 s20, 7
    s_cbranch_scc1 K2_PAD_SW
    s_cmp_eq_u32 s20, 5
    s_cbranch_scc1 K2_PAD_TL
    s_cmp_eq_u32 s20, 6
    s_cbranch_scc1 K2_PAD_T2
K2_HOP:
    s_mov_b64 exec, -1
    v_lshlrev_b32 v128, 16, v152
    v_and_b32 v129, 0xffff0000, v152
    v_lshlrev_b32 v130, 16, v153
    v_and_b32 v131, 0xffff0000, v153
    v_lshlrev_b32 v132, 16, v154
    v_and_b32 v133, 0xffff0000, v154
    v_lshlrev_b32 v134, 16, v155
    v_and_b32 v135, 0xffff0000, v155
    v_lshlrev_b32 v136, 16, v156
    v_and_b32 v137, 0xffff0000, v156
    v_lshlrev_b32 v138, 16, v157
    v_and_b32 v139, 0xffff0000, v157
    v_lshlrev_b32 v140, 16, v158
    v_and_b32 v141, 0xffff0000, v158
    v_lshlrev_b32 v142, 16, v159
    v_and_b32 v143, 0xffff0000, v159
    v_lshlrev_b32 v144, 16, v160
    v_and_b32 v145, 0xffff0000, v160
    v_lshlrev_b32 v146, 16, v161
    v_and_b32 v147, 0xffff0000, v161
    v_lshlrev_b32 v148, 16, v162
    v_and_b32 v149, 0xffff0000, v162
    v_lshlrev_b32 v150, 16, v163
    v_and_b32 v151, 0xffff0000, v163
    v_lshlrev_b32 v152, 16, v164
    v_and_b32 v153, 0xffff0000, v164
    v_lshlrev_b32 v154, 16, v165
    v_and_b32 v155, 0xffff0000, v165
    v_lshlrev_b32 v156, 16, v166
    v_and_b32 v157, 0xffff0000, v166
    v_lshlrev_b32 v158, 16, v167
    v_and_b32 v159, 0xffff0000, v167
    v_lshlrev_b32 v160, 16, v168
    v_and_b32 v161, 0xffff0000, v168
    v_lshlrev_b32 v162, 16, v169
    v_and_b32 v163, 0xffff0000, v169
    v_lshlrev_b32 v164, 16, v170
    v_and_b32 v165, 0xffff0000, v170
    v_lshlrev_b32 v166, 16, v171
    v_and_b32 v167, 0xffff0000, v171
    v_lshlrev_b32 v168, 16, v172
    v_and_b32 v169, 0xffff0000, v172
    v_lshlrev_b32 v170, 16, v173
    v_and_b32 v171, 0xffff0000, v173
    v_lshlrev_b32 v172, 16, v174
    v_and_b32 v173, 0xffff0000, v174
    v_lshlrev_b32 v174, 16, v175
    v_and_b32 v175, 0xffff0000, v175
K2_W0:
    s_lshl_b32 s59, s2, 22
    s_mov_b32 s60, 0x40000
    s_bfe_u32 s61, s54, 0x10004
    s_bfe_u32 s62, s54, 0x10003
    s_add_u32 s63, s61, s62
    s_mul_i32 s62, s62, 11
    s_sub_u32 s64, 11, s62
    v_cmp_gt_u32 vcc, 500, v177
    s_nop 0
    s_mov_b64 s[56:57], vcc
K2_POLL:
    s_waitcnt vmcnt(0)
    v_xor_b32 v73, s59, v76
    v_xor_b32 v74, s59, v77
    v_or_b32 v73, v73, v74
    v_xor_b32 v74, s2, v79
    v_lshrrev_b32 v73, 22, v73
    v_or_b32 v73, v73, v74
    v_cmp_ne_u32 vcc, 0, v73
    s_nop 0
    s_cbranch_vccz K2_POLLED
    s_sub_u32 s60, s60, 1
    s_cbranch_scc1 K2_END
    s_mov_b64 exec, vcc
    buffer_load_dwordx4 v[76:79], v72, s[8:11], s67 offen sc1
    s_mov_b64 exec, -1
    s_branch K2_POLL
K2_PAD_LD:
    s_branch KS_HOP
K2_POLLED:
    s_set_gpr_idx_on s61, gpr_idx(SRC0)
    s_nop 0
    v_bfe_u32 v179, v76, s62, 11
    s_set_gpr_idx_idx s63
    s_nop 0
    v_bfe_u32 v73, v76, s64, 11
    s_set_gpr_idx_off
    v_sub_u32 v73, v73, v179
    v_cndmask_b32 v73, 0, v73, s[56:57]
    v_and_b32 v1, 1, v177
    v_add_u32 v1, s23, v1
    v_sub_u32 v180, v73, v1
    v_add_u32 v179, v179, v1
    v_mul_u32_u24 v181, 20608, v178
    v_lshl_add_u32 v181, v179, 4, v181
    v_cmp_lt_i32 s[40:41], 0, v180
    v_add_u32 v182, 32, v181
    s_mov_b32 s65, 0
    s_mov_b64 exec, s[40:41]
    buffer_load_dwordx4 v[0:3], v181, s[8:11], 0 offen offset:0 sc1
    s_mov_b64 exec, -1
    v_cmp_lt_i32 s[42:43], 2, v180
    v_cmp_lt_i32 s[44:45], 4, v180
    v_cmp_lt_i32 s[46:47], 6, v180
    v_cmp_lt_i32 s[48:49], 8, v180
    v_cmp_lt_i32 s[50:51], 10, v180
    v_cmp_lt_i32 s[90:91], 12, v180
    v_cmp_lt_i32 s[92:93], 14, v180
    v_cmp_lt_i32 s[94:95], 16, v180
    v_cmp_lt_i32 s[96:97], 18, v180
    v_add_u32 v183, 64, v181
    v_add_u32 v184, 96, v181
    v_subrev_u32 v62, 1, v180
    v_ashrrev_i32 v62, 1, v62
    v_med3_i32 v62, v62, 0, 9
    s_cmp_eq_u64 s[42:43], 0
    s_cbranch_scc1 K2_LD_DONE
    v_mov_b32 v63, v62
    s_nop 1
    v_add_u32_dpp v63, v63, v63 row_shr:1 row_mask:0xf bank_mask:0xf bound_ctrl:0
    s_nop 1
    v_add_u32_dpp v63, v63, v63 row_shr:2 row_mask:0xf bank_mask:0xf bound_ctrl:0
    s_nop 1
    v_add_u32_dpp v63, v63, v63 row_shr:4 row_mask:0xf bank_mask:0xf bound_ctrl:0
    s_nop 1
    v_add_u32_dpp v63, v63, v63 row_shr:8 row_mask:0xf bank_mask:0xf bound_ctrl:0
    s_nop 1
    v_add_u32_dpp v63, v63, v63 row_bcast:15 row_mask:0xa bank_mask:0xf
    s_nop 1
    v_add_u32_dpp v63, v63, v63 row_bcast:31 row_mask:0xc bank_mask:0xf
    s_lshl_b32 s58, s20, 10
    s_add_u32 s58, s58, 45056
    v_readlane_b32 s59, v63, 63
    v_sub_u32 v63, v63, v62
    v_lshl_add_u32 v64, v63, 2, s58
    v_lshlrev_b32 v63, 5, v63
    v_sub_u32 v63, v182, v63
    s_cmp_gt_u32 s59, 189
    s_cbranch_scc1 K2_LD_GEN
    s_mov_b64 exec, s[42:43]
    s_cbranch_execz K2_LD_L
    ds_write_b32 v64, v63 offset:0
    s_mov_b64 exec, s[44:45]
    s_cbranch_execz K2_LD_L
    ds_write_b32 v64, v63 offset:4
    s_mov_b64 exec, s[46:47]
    s_cbranch_execz K2_LD_L
    ds_write_b32 v64, v63 offset:8
    s_mov_b64 exec, s[48:49]
    s_cbranch_execz K2_LD_L
    ds_write_b32 v64, v63 offset:12
    s_mov_b64 exec, s[50:51]
    s_cbranch_execz K2_LD_L
    ds_write_b32 v64, v63 offset:16
    s_mov_b64 exec, s[90:91]
    s_cbranch_execz K2_LD_L
    ds_write_b32 v64, v63 offset:20
    s_mov_b64 exec, s[92:93]
    s_cbranch_execz K2_LD_L
    ds_write_b32 v64, v63 offset:24
    s_mov_b64 exec, s[94:95]
    s_cbranch_execz K2_LD_L
    ds_write_b32 v64, v63 offset:28
    s_mov_b64 exec, s[96:97]
    s_cbranch_execz K2_LD_L
    ds_write_b32 v64, v63 offset:32
K2_LD_L:
    s_mov_b64 exec, -1
    v_lshl_add_u32 v63, v176, 2, s58
    v_lshlrev_b32 v62, 5, v176
    s_waitcnt lgkmcnt(0)
    ds_read_b32 v64, v63 offset:0
    ds_read_b32 v65, v63 offset:252
    ds_read_b32 v66, v63 offset:504
    s_min_u32 s60, s59, 63
    s_sub_u32 s59, s59, s60
    s_bfm_b64 s[42:43], s60, 0
    s_min_u32 s60, s59, 63
    s_sub_u32 s59, s59, s60
    s_bfm_b64 s[44:45], s60, 0
    s_min_u32 s60, s59, 63
    s_sub_u32 s59, s59, s60
    s_bfm_b64 s[46:47], s60, 0
    s_mov_b64 s[48:49], 0
    s_mov_b32 s65, 1
    s_mov_b32 s60, 0
    s_waitcnt lgkmcnt(2)
    v_add3_u32 v182, v62, v64, s60
    s_mov_b64 exec, s[42:43]
    buffer_load_dwordx4 v[4:7], v182, s[8:11], 0 offen sc1
    s_mov_b32 s60, 2016
    s_waitcnt lgkmcnt(1)
    v_add3_u32 v183, v62, v65, s60
    s_mov_b64 exec, s[44:45]
    buffer_load_dwordx4 v[8:11], v183, s[8:11], 0 offen sc1
    s_mov_b32 s60, 4032
    s_waitcnt lgkmcnt(0)
    v_add3_u32 v184, v62, v66, s60
    s_mov_b64 exec, s[46:47]
    buffer_load_dwordx4 v[12:15], v184, s[8:11], 0 offen sc1
K2_LD_DONE:
    s_mov_b64 exec, -1
    s_cmp_eq_u32 s28, 0
    s_cbranch_scc1 K2_WLATE
K2_NOWRAW:
K2_PAD_NW:
    s_cbranch_execz KS_HOP
    v_lshrrev_b32 v179, 2, v181
    v_lshrrev_b32 v185, 2, v182
    v_lshrrev_b32 v186, 2, v183
    v_lshrrev_b32 v187, 2, v184
    s_mov_b32 s66, 7340032
    v_mov_b32 v201, 1
    s_movk_i32 s58, 520
    s_movk_i32 s59, 2080
    s_mov_b32 s60, 0x40000
    s_mov_b32 s61, 0xffff
    v_mov_b32 v202, 65536
    s_cmp_lg_u32 s24, 0
    s_cbranch_scc1 K2_RK_LOAD
    v_cmp_lt_i32 vcc, 20, v180
    s_nop 0
    s_cbranch_vccz K2_NOMORE
    v_mov_b32 v61, 163304
    ds_write_b32 v61, v201
K2_NOMORE:
    s_mov_b32 s62, 82176
    s_cmp_eq_u32 s65, 0
    s_waitcnt vmcnt(3)
    s_cbranch_scc0 K2_ARR
    s_waitcnt vmcnt(0)
K2_ARR:
    s_mov_b64 exec, s[40:41]
    s_cbranch_execz K2_RK_A
K2_CK0:
    v_bfi_b32 v192, s61, v1, v2
    v_lshrrev_b32 v50, 24, v3
    v_cmp_ne_u32 vcc, s2, v192
    v_add_u32 v40, 163072, v50
    s_cbranch_vccnz K2_RT0
    ds_add_rtn_u32 v40, v40, v201
    v_mad_u32_u24 v50, v50, s58, v202
    s_mov_b64 exec, s[42:43]
    s_cbranch_execz K2_RK_A
    s_waitcnt vmcnt(2)
K2_CK1:
    v_bfi_b32 v192, s61, v5, v6
    v_lshrrev_b32 v51, 24, v7
    v_cmp_ne_u32 vcc, s2, v192
    v_add_u32 v41, 163072, v51
    s_cbranch_vccnz K2_RT1
    ds_add_rtn_u32 v41, v41, v201
    v_mad_u32_u24 v51, v51, s58, v202
    s_mov_b64 exec, s[44:45]
    s_cbranch_execz K2_RK_A
    s_waitcnt vmcnt(1)
K2_CK2:
    v_bfi_b32 v192, s61, v9, v10
    v_lshrrev_b32 v52, 24, v11
    v_cmp_ne_u32 vcc, s2, v192
    v_add_u32 v42, 163072, v52
    s_cbranch_vccnz K2_RT2
    ds_add_rtn_u32 v42, v42, v201
    v_mad_u32_u24 v52, v52, s58, v202
    s_mov_b64 exec, s[46:47]
    s_cbranch_execz K2_RK_A
    s_waitcnt vmcnt(0)
K2_CK3:
    v_bfi_b32 v192, s61, v13, v14
    v_lshrrev_b32 v53, 24, v15
    v_cmp_ne_u32 vcc, s2, v192
    v_add_u32 v43, 163072, v53
    s_cbranch_vccnz K2_RT3
    ds_add_rtn_u32 v43, v43, v201
    v_mad_u32_u24 v53, v53, s58, v202
    s_mov_b64 exec, s[48:49]
    s_cbranch_execz K2_RK_A
K2_CK4:
    v_bfi_b32 v192, s61, v17, v18
    v_lshrrev_b32 v54, 24, v19
    v_cmp_ne_u32 vcc, s2, v192
    v_add_u32 v44, 163072, v54
    s_cbranch_vccnz K2_RT4
    ds_add_rtn_u32 v44, v44, v201
    v_mad_u32_u24 v54, v54, s58, v202
    s_mov_b64 exec, s[50:51]
    s_cbranch_execz K2_RK_A
K2_CK5:
    v_bfi_b32 v192, s61, v21, v22
    v_lshrrev_b32 v55, 24, v23
    v_cmp_ne_u32 vcc, s2, v192
    v_add_u32 v45, 163072, v55
    s_cbranch_vccnz K2_RT5
    ds_add_rtn_u32 v45, v45, v201
    v_mad_u32_u24 v55, v55, s58, v202
    s_mov_b64 exec, s[90:91]
    s_cbranch_execz K2_RK_A
K2_CK6:
    v_bfi_b32 v192, s61, v25, v26
    v_lshrrev_b32 v56, 24, v27
    v_cmp_ne_u32 vcc, s2, v192
    v_add_u32 v46, 163072, v56
    s_cbranch_vccnz K2_RT6
    ds_add_rtn_u32 v46, v46, v201
    v_mad_u32_u24 v56, v56, s58, v202
    s_mov_b64 exec, s[92:93]
    s_cbranch_execz K2_RK_A
K2_CK7:
    v_bfi_b32 v192, s61, v29, v30
    v_lshrrev_b32 v57, 24, v31
    v_cmp_ne_u32 vcc, s2, v192
    v_add_u32 v47, 163072, v57
    s_cbranch_vccnz K2_RT7
    ds_add_rtn_u32 v47, v47, v201
    v_mad_u32_u24 v57, v57, s58, v202
    s_mov_b64 exec, s[94:95]
    s_cbranch_execz K2_RK_A
K2_CK8:
    v_bfi_b32 v192, s61, v33, v34
    v_lshrrev_b32 v58, 24, v35
    v_cmp_ne_u32 vcc, s2, v192
    v_add_u32 v48, 163072, v58
    s_cbranch_vccnz K2_RT8
    ds_add_rtn_u32 v48, v48, v201
    v_mad_u32_u24 v58, v58, s58, v202
    s_mov_b64 exec, s[96:97]
    s_cbranch_execz K2_RK_A
K2_CK9:
    v_bfi_b32 v192, s61, v37, v38
    v_lshrrev_b32 v59, 24, v39
    v_cmp_ne_u32 vcc, s2, v192
    v_add_u32 v49, 163072, v59
    s_cbranch_vccnz K2_RT9
    ds_add_rtn_u32 v49, v49, v201
    v_mad_u32_u24 v59, v59, s58, v202
K2_RK_A:
    s_mov_b64 exec, -1
    s_mov_b64 exec, s[40:41]
    s_cbranch_execz K2_TP
    v_cmp_gt_u32 vcc, s62, v50
    v_and_b32 v3, 0xffffff, v3
    s_mov_b64 exec, vcc
    buffer_load_dword v245, v3, s[16:19], 0 offen
    s_mov_b64 exec, s[42:43]
    s_cbranch_execz K2_TP
    v_cmp_gt_u32 vcc, s62, v51
    v_and_b32 v7, 0xffffff, v7
    s_mov_b64 exec, vcc
    buffer_load_dword v245, v7, s[16:19], 0 offen
    s_mov_b64 exec, s[44:45]
    s_cbranch_execz K2_TP
    v_cmp_gt_u32 vcc, s62, v52
    v_and_b32 v11, 0xffffff, v11
    s_mov_b64 exec, vcc
    buffer_load_dword v245, v11, s[16:19], 0 offen
    s_mov_b64 exec, s[46:47]
    s_cbranch_execz K2_TP
    v_cmp_gt_u32 vcc, s62, v53
    v_and_b32 v15, 0xffffff, v15
    s_mov_b64 exec, vcc
    buffer_load_dword v245, v15, s[16:19], 0 offen
    s_mov_b64 exec, s[48:49]
    s_cbranch_execz K2_TP
    v_cmp_gt_u32 vcc, s62, v54
    v_and_b32 v19, 0xffffff, v19
    s_mov_b64 exec, vcc
    buffer_load_dword v245, v19, s[16:19], 0 offen
    s_mov_b64 exec, s[50:51]
    s_cbranch_execz K2_TP
    v_cmp_gt_u32 vcc, s62, v55
    v_and_b32 v23, 0xffffff, v23
    s_mov_b64 exec, vcc
    buffer_load_dword v245, v23, s[16:19], 0 offen
    s_mov_b64 exec, s[90:91]
    s_cbranch_execz K2_TP
    v_cmp_gt_u32 vcc, s62, v56
    v_and_b32 v27, 0xffffff, v27
    s_mov_b64 exec, vcc
    buffer_load_dword v245, v27, s[16:19], 0 offen
    s_mov_b64 exec, s[92:93]
    s_cbranch_execz K2_TP
    v_cmp_gt_u32 vcc, s62, v57
    v_and_b32 v31, 0xffffff, v31
    s_mov_b64 exec, vcc
    buffer_load_dword v245, v31, s[16:19], 0 offen
    s_mov_b64 exec, s[94:95]
    s_cbranch_execz K2_TP
    v_cmp_gt_u32 vcc, s62, v58
    v_and_b32 v35, 0xffffff, v35
    s_mov_b64 exec, vcc
    buffer_load_dword v245, v35, s[16:19], 0 offen
    s_mov_b64 exec, s[96:97]
    s_cbranch_execz K2_TP
    v_cmp_gt_u32 vcc, s62, v59
    v_and_b32 v39, 0xffffff, v39
    s_mov_b64 exec, vcc
    buffer_load_dword v245, v39, s[16:19], 0 offen
K2_TP:
    s_mov_b64 exec, -1
K2_RK_DONE:
K2_PAD_SC:
    s_cbranch_execz KS_HOP
    s_mul_i32 s67, s24, 48
    s_movk_i32 s58, -1532
    s_waitcnt lgkmcnt(0)
    s_mov_b64 exec, s[40:41]
    s_cbranch_execz K2_SC_DONE
    v_cmpx_gt_u32 vcc, 64, v40
    v_bfe_u32 v194, v40, 3, 1
    v_add_u32 v193, 16, v40
    v_lshl_or_b32 v194, v40, 1, v194
    v_bfi_b32 v194, 15, v194, v40
    v_lshrrev_b32 v193, 6, v193
    v_alignbit_b32 v1, v2, v1, 16
    v_lshl_add_u32 v195, v194, 3, v50
    v_lshl_add_u32 v194, v194, 5, v50
    ds_write_b64 v195, v[0:1]
    v_mad_i32_i24 v194, v193, s58, v194
    ds_write_b32 v194, v3 offset:512
    s_mov_b64 exec, s[42:43]
    s_cbranch_execz K2_SC_DONE
    v_cmpx_gt_u32 vcc, 64, v41
    v_bfe_u32 v194, v41, 3, 1
    v_add_u32 v193, 16, v41
    v_lshl_or_b32 v194, v41, 1, v194
    v_bfi_b32 v194, 15, v194, v41
    v_lshrrev_b32 v193, 6, v193
    v_alignbit_b32 v5, v6, v5, 16
    v_lshl_add_u32 v195, v194, 3, v51
    v_lshl_add_u32 v194, v194, 5, v51
    ds_write_b64 v195, v[4:5]
    v_mad_i32_i24 v194, v193, s58, v194
    ds_write_b32 v194, v7 offset:512
    s_mov_b64 exec, s[44:45]
    s_cbranch_execz K2_SC_DONE
    v_cmpx_gt_u32 vcc, 64, v42
    v_bfe_u32 v194, v42, 3, 1
    v_add_u32 v193, 16, v42
    v_lshl_or_b32 v194, v42, 1, v194
    v_bfi_b32 v194, 15, v194, v42
    v_lshrrev_b32 v193, 6, v193
    v_alignbit_b32 v9, v10, v9, 16
    v_lshl_add_u32 v195, v194, 3, v52
    v_lshl_add_u32 v194, v194, 5, v52
    ds_write_b64 v195, v[8:9]
    v_mad_i32_i24 v194, v193, s58, v194
    ds_write_b32 v194, v11 offset:512
    s_mov_b64 exec, s[46:47]
    s_cbranch_execz K2_SC_DONE
    v_cmpx_gt_u32 vcc, 64, v43
    v_bfe_u32 v194, v43, 3, 1
    v_add_u32 v193, 16, v43
    v_lshl_or_b32 v194, v43, 1, v194
    v_bfi_b32 v194, 15, v194, v43
    v_lshrrev_b32 v193, 6, v193
    v_alignbit_b32 v13, v14, v13, 16
    v_lshl_add_u32 v195, v194, 3, v53
    v_lshl_add_u32 v194, v194, 5, v53
    ds_write_b64 v195, v[12:13]
    v_mad_i32_i24 v194, v193, s58, v194
    ds_write_b32 v194, v15 offset:512
    s_mov_b64 exec, s[48:49]
    s_cbranch_execz K2_SC_DONE
    v_cmpx_gt_u32 vcc, 64, v44
    v_bfe_u32 v194, v44, 3, 1
    v_add_u32 v193, 16, v44
    v_lshl_or_b32 v194, v44, 1, v194
    v_bfi_b32 v194, 15, v194, v44
    v_lshrrev_b32 v193, 6, v193
    v_alignbit_b32 v17, v18, v17, 16
    v_lshl_add_u32 v195, v194, 3, v54
    v_lshl_add_u32 v194, v194, 5, v54
    ds_write_b64 v195, v[16:17]
    v_mad_i32_i24 v194, v193, s58, v194
    ds_write_b32 v194, v19 offset:512
    s_mov_b64 exec, s[50:51]
    s_cbranch_execz K2_SC_DONE
    v_cmpx_gt_u32 vcc, 64, v45
    v_bfe_u32 v194, v45, 3, 1
    v_add_u32 v193, 16, v45
    v_lshl_or_b32 v194, v45, 1, v194
    v_bfi_b32 v194, 15, v194, v45
    v_lshrrev_b32 v193, 6, v193
    v_alignbit_b32 v21, v22, v21, 16
    v_lshl_add_u32 v195, v194, 3, v55
    v_lshl_add_u32 v194, v194, 5, v55
    ds_write_b64 v195, v[20:21]
    v_mad_i32_i24 v194, v193, s58, v194
    ds_write_b32 v194, v23 offset:512
    s_mov_b64 exec, s[90:91]
    s_cbranch_execz K2_SC_DONE
    v_cmpx_gt_u32 vcc, 64, v46
    v_bfe_u32 v194, v46, 3, 1
    v_add_u32 v193, 16, v46
    v_lshl_or_b32 v194, v46, 1, v194
    v_bfi_b32 v194, 15, v194, v46
    v_lshrrev_b32 v193, 6, v193
    v_alignbit_b32 v25, v26, v25, 16
    v_lshl_add_u32 v195, v194, 3, v56
    v_lshl_add_u32 v194, v194, 5, v56
    ds_write_b64 v195, v[24:25]
    v_mad_i32_i24 v194, v193, s58, v194
    ds_write_b32 v194, v27 offset:512
    s_mov_b64 exec, s[92:93]
    s_cbranch_execz K2_SC_DONE
    v_cmpx_gt_u32 vcc, 64, v47
    v_bfe_u32 v194, v47, 3, 1
    v_add_u32 v193, 16, v47
    v_lshl_or_b32 v194, v47, 1, v194
    v_bfi_b32 v194, 15, v194, v47
    v_lshrrev_b32 v193, 6, v193
    v_alignbit_b32 v29, v30, v29, 16
    v_lshl_add_u32 v195, v194, 3, v57
    v_lshl_add_u32 v194, v194, 5, v57
    ds_write_b64 v195, v[28:29]
    v_mad_i32_i24 v194, v193, s58, v194
    ds_write_b32 v194, v31 offset:512
    s_mov_b64 exec, s[94:95]
    s_cbranch_execz K2_SC_DONE
    v_cmpx_gt_u32 vcc, 64, v48
    v_bfe_u32 v194, v48, 3, 1
    v_add_u32 v193, 16, v48
    v_lshl_or_b32 v194, v48, 1, v194
    v_bfi_b32 v194, 15, v194, v48
    v_lshrrev_b32 v193, 6, v193
    v_alignbit_b32 v33, v34, v33, 16
    v_lshl_add_u32 v195, v194, 3, v58
    v_lshl_add_u32 v194, v194, 5, v58
    ds_write_b64 v195, v[32:33]
    v_mad_i32_i24 v194, v193, s58, v194
    ds_write_b32 v194, v35 offset:512
    s_mov_b64 exec, s[96:97]
    s_cbranch_execz K2_SC_DONE
    v_cmpx_gt_u32 vcc, 64, v49
    v_bfe_u32 v194, v49, 3, 1
    v_add_u32 v193, 16, v49
    v_lshl_or_b32 v194, v49, 1, v194
    v_bfi_b32 v194, 15, v194, v49
    v_lshrrev_b32 v193, 6, v193
    v_alignbit_b32 v37, v38, v37, 16
    v_lshl_add_u32 v195, v194, 3, v59
    v_lshl_add_u32 v194, v194, 5, v59
    ds_write_b64 v195, v[36:37]
    v_mad_i32_i24 v194, v193, s58, v194
    ds_write_b32 v194, v39 offset:512
K2_SC_DONE:
    s_mov_b64 exec, -1
K2_PAD_SD:
    s_cbranch_execz KS_HOP
    v_lshlrev_b32 v192, 2, v176
    v_add_u32 v192, 163072, v192
    v_mov_b32 v200, 163304
    s_cmp_eq_u32 s24, 0
    s_cselect_b32 s26, 64, 48
    s_waitcnt lgkmcnt(0)
    s_barrier
    ds_read_b32 v193, v192
    ds_read_b32 v200, v200
    v_cmp_gt_u32 s[56:57], s22, v176
    v_mad_u32_u24 v195, v176, s59, v202
    s_waitcnt lgkmcnt(0)
    v_cndmask_b32 v193, 0, v193, s[56:57]
    v_readfirstlane_b32 s27, v200
    v_cmp_lt_u32 s[62:63], 48, v193
    v_cmp_lt_u32 vcc, 64, v193
    s_bcnt1_i32_b64 s60, s[62:63]
    v_mbcnt_lo_u32_b32 v198, s62, 0
    v_mbcnt_hi_u32_b32 v198, s63, v198
    s_cbranch_vccnz K2_BIG
    s_cmp_gt_u32 s60, 8
    s_cbranch_scc1 K2_BIG
K2_TOK:
    v_subrev_u32 v194, s67, v193
    v_max_i32 v194, 1, v194
    v_min_i32 v194, s26, v194
    v_add_u32 v194, 15, v194
    v_lshrrev_b32 v194, 3, v194
    v_lshl_or_b32 v195, v194, 18, v195
    v_lshl_or_b32 v195, v198, 28, v195
    v_mov_b32 v197, 949760
    v_cndmask_b32 v253, v197, v195, s[56:57]
    s_movk_i32 s40, 0
    s_movk_i32 s41, 256
    s_movk_i32 s42, 512
    s_movk_i32 s43, 768
    s_add_u32 s24, s24, 1
    s_cmp_ge_u32 s24, s25
    s_cselect_b32 s55, 1, 0
    s_cmp_eq_u32 s27, 0
    s_cselect_b32 s55, s55, 0
    s_mov_b32 s27, 0x400000
    s_mov_b32 s38, 0
    s_mov_b32 s34, 0
    s_mov_b32 s35, 0
    s_mov_b32 s36, 1
    s_mov_b32 s31, 0
    s_mov_b32 s58, s20
    v_readlane_b32 s3, v253, s58
    s_lshl_b32 s44, s34, 7
    s_and_b32 s48, s3, 0x3ffff
    s_bfe_u32 s33, s3, 0x30013
    s_mul_i32 s35, s38, 6
    s_cmp_eq_u32 s34, 0
    s_cselect_b32 s35, s35, s48
    s_mov_b32 s45, s44
    s_xor_b32 s47, s44, 256
    s_add_u32 s49, s48, 128
    s_add_u32 s60, s48, 256
    s_cmp_eq_u32 s33, 3
    s_cselect_b32 s46, s44, s47
    s_cselect_b32 s50, s60, s48
    s_sub_u32 s60, s33, 2
    s_cmp_lt_u32 s60, 2
    s_cbranch_scc0 K2_rare_1
K2_back_2:
    v_mov_b32 v44, -1
    v_mov_b32 v45, -1
    v_add_u32 v43, s48, v232
    ds_read_b32 v42, v43
    ds_read_b32 v43, v43 offset:1024
    v_add_u32 v222, s48, v251
    ds_read2_b32 v[222:223], v222 offset0:1 offset1:3
    v_add_u32 v224, s49, v251
    ds_read2_b32 v[224:225], v224 offset0:1 offset1:3
    v_add_u32 v226, s50, v251
    ds_read2_b32 v[226:227], v226 offset0:1 offset1:3
    s_waitcnt lgkmcnt(3)
    v_or_b32 v42, v42, v233
    v_or_b32 v43, v43, v233
    s_cmp_lg_u32 s34, 0
    s_cbranch_scc1 K2_dum_4
    s_cmp_eq_u32 s33, 4
    s_cbranch_scc1 K2_a4_5
K2_b4_7:
    s_add_u32 m0, s48, 512
    s_add_u32 s65, s48, 1536
    buffer_load_dwordx4 v42, s[16:19], 0 offen  lds
    s_mov_b32 m0, s65
    s_mov_b32 exec_hi, 0
    buffer_load_dwordx4 v43, s[16:19], 0 offen  lds
    s_mov_b32 exec_hi, -1
K2_back_6:
    s_waitcnt lgkmcnt(2)
    v_mad_u32_u16 v222, v222, s39, v248 op_sel:[1,0,0,0]
    v_mad_u32_u16 v223, v223, s39, v248 op_sel:[1,0,0,0]
    s_waitcnt lgkmcnt(1)
    v_mad_u32_u16 v224, v224, s39, v248 op_sel:[1,0,0,0]
    v_mad_u32_u16 v225, v225, s39, v248 op_sel:[1,0,0,0]
    s_waitcnt lgkmcnt(0)
    v_mad_u32_u16 v226, v226, s39, v248 op_sel:[1,0,0,0]
    v_mad_u32_u16 v227, v227, s39, v248 op_sel:[1,0,0,0]
    s_mov_b32 m0, s68
    s_nop 0
    buffer_load_dwordx4 v222, s[4:7], s44 offen sc1 lds
    buffer_load_dwordx4 v223, s[72:75], s44 offen offset:1024 sc1 lds
    s_mov_b32 m0, s69
    s_nop 0
    buffer_load_dwordx4 v224, s[4:7], s45 offen sc1 lds
    buffer_load_dwordx4 v225, s[72:75], s45 offen offset:1024 sc1 lds
    s_mov_b32 m0, s70
    s_nop 0
    buffer_load_dwordx4 v226, s[4:7], s46 offen sc1 lds
    buffer_load_dwordx4 v227, s[72:75], s46 offen offset:1024 sc1 lds
    s_mov_b32 m0, s71
    s_cmp_eq_u32 s33, 4
    s_cbranch_scc1 K2_g4_8
    buffer_load_dwordx4 v224, s[4:7], s47 offen sc1 lds
    buffer_load_dwordx4 v225, s[72:75], s47 offen offset:1024 sc1 lds
K2_back_9:
    v_add_u32 v249, s48, v249
    v_add_u32 v250, s48, v250
    v_bfe_u32 v192, v253, 18, 4
    s_sub_u32 s58, s22, 16
    v_cmp_le_u32 vcc, 6, v192
    v_cmp_gt_u32 s[60:61], s58, v176
    s_nop 0
    s_or_b64 vcc, vcc, s[60:61]
    v_mbcnt_lo_u32_b32 v192, vcc_lo, 0
    v_mbcnt_hi_u32_b32 v192, vcc_hi, v192
    s_bcnt1_i32_b64 s58, vcc
    v_sub_u32 v193, v176, v192
    v_add_u32 v193, s58, v193
    v_cndmask_b32 v192, v193, v192, vcc
    v_lshlrev_b32 v192, 2, v192
    ds_permute_b32 v193, v192, v176
    s_waitcnt lgkmcnt(0)
    v_lshl_or_b32 v253, v193, 22, v253
    s_waitcnt vmcnt(6)
    ds_read_b64_tr_b16 v[176:177], v246 offset:0
    ds_read_b64_tr_b16 v[178:179], v246 offset:1024
    ds_read_b64_tr_b16 v[180:181], v247 offset:0
    ds_read_b64_tr_b16 v[182:183], v247 offset:1024
    ds_read_b64_tr_b16 v[80:81], v249 offset:0
    ds_read_u16_d16_hi v40, v250 offset:0
    ds_read_b64_tr_b16 v[88:89], v249 offset:512
    ds_read_u16_d16_hi v41, v250 offset:128
    s_mov_b32 s29, s48
    s_mov_b32 s32, s31
    s_mov_b32 s30, s3
    s_mov_b32 s31, s35
    s_bfe_u32 s56, s3, 0x40012
    s_cmp_eq_u32 s56, 5
    s_cbranch_scc1 K2_U20
    s_cmp_eq_u32 s56, 6
    s_cbranch_scc1 K2_U3h0
    s_branch K2_DSP0
K2_PAD_H1:
    s_branch KS_HOP0
KS_HELP:
    s_mov_b32 s30, 0
    s_cmp_eq_u32 s20, 6
    s_cbranch_scc1 KS_RAW
    s_mov_b32 s30, 2
    s_cmp_ge_u32 s2, 170
    s_cbranch_scc1 KS_NOW
    s_mov_b32 s30, 1
    v_and_b32 v1, 15, v8
    v_lshrrev_b32 v3, 4, v8
    s_cmp_ge_u32 s2, 160
    s_cbranch_scc1 K1_WT
    s_cmp_ge_u32 s2, 64
    s_cbranch_scc1 K1_S1
    s_lshr_b32 s24, s2, 3
    s_and_b32 s25, s2, 7
    s_lshr_b32 s26, s25, 2
    s_bfe_u32 s27, s25, 0x10001
    s_and_b32 s28, s25, 1
    s_mov_b32 s60, s92
    s_and_b32 s61, s93, 0xffff
    s_mov_b32 s62, 65536
    s_mov_b32 s63, 0x20000
    s_branch K1_SC
K1_S1:
    s_sub_u32 s29, s2, 64
    s_mul_i32 s24, s29, 43
    s_lshr_b32 s24, s24, 9
    s_mul_i32 s25, s24, 12
    s_sub_u32 s25, s29, s25
    s_cmp_ge_u32 s25, 6
    s_cselect_b32 s26, 1, 0
    s_mul_i32 s27, s26, 6
    s_sub_u32 s27, s25, s27
    s_lshr_b32 s27, s27, 1
    s_and_b32 s28, s25, 1
    s_add_u32 s25, s25, 8
    s_mov_b32 s60, s94
    s_and_b32 s61, s95, 0xffff
    s_mov_b32 s62, 98304
    s_mov_b32 s63, 0x20000
K1_SC:
    s_lshl_b32 s27, s27, 7
    s_lshl_b32 s26, s26, 6
    s_lshl_b32 s28, s28, 4
    s_add_u32 s27, s27, s26
    s_add_u32 s27, s27, s28
    s_lshl_b32 s27, s27, 8
    s_lshl_b32 s26, s24, 5
    s_add_u32 s27, s27, s26
    s_add_u32 s29, s27, 8192
    v_lshlrev_b32 v3, 10, v3
    v_lshl_add_u32 v3, v1, 1, v3
    buffer_load_ushort v64, v3, s[60:63], s27 offen offset:0
    buffer_load_ushort v65, v3, s[60:63], s29 offen offset:0
    buffer_load_ushort v66, v3, s[60:63], s27 offen offset:256
    buffer_load_ushort v67, v3, s[60:63], s29 offen offset:256
    buffer_load_ushort v68, v3, s[60:63], s27 offen offset:512
    buffer_load_ushort v69, v3, s[60:63], s29 offen offset:512
    buffer_load_ushort v70, v3, s[60:63], s27 offen offset:768
    buffer_load_ushort v71, v3, s[60:63], s29 offen offset:768
    s_mul_i32 s24, s24, 20
    s_add_u32 s24, s24, s25
    s_lshl_b32 s24, s24, 10
    s_add_u32 s24, s24, 6946816
    s_branch K1_GO
K1_WT:
    s_sub_u32 s24, s2, 160
    s_lshr_b32 s27, s24, 1
    s_and_b32 s28, s24, 1
    s_lshl_b32 s27, s27, 8
    s_lshl_b32 s28, s28, 6
    s_add_u32 s27, s27, s28
    s_add_u32 s29, s27, 10240
    s_mov_b32 s60, s90
    s_and_b32 s61, s91, 0xffff
    s_mov_b32 s62, 20480
    s_mov_b32 s63, 0x20000
    v_and_b32 v1, 31, v8
    v_lshrrev_b32 v3, 5, v8
    v_mul_u32_u24 v3, 5120, v3
    v_lshl_add_u32 v3, v1, 1, v3
    buffer_load_ushort v64, v3, s[60:63], s27 offen offset:0
    buffer_load_ushort v65, v3, s[60:63], s27 offen offset:1280
    buffer_load_ushort v66, v3, s[60:63], s27 offen offset:2560
    buffer_load_ushort v67, v3, s[60:63], s27 offen offset:3840
    buffer_load_ushort v68, v3, s[60:63], s29 offen offset:0
    buffer_load_ushort v69, v3, s[60:63], s29 offen offset:1280
    buffer_load_ushort v70, v3, s[60:63], s29 offen offset:2560
    buffer_load_ushort v71, v3, s[60:63], s29 offen offset:3840
    s_lshl_b32 s24, s24, 10
    s_add_u32 s24, s24, 7110656
K1_GO:
KS_NOW:
    s_barrier
K2_PAD_H2:
    s_cbranch_execz KS_HOP0
    v_and_b32 v76, 31, v8
    v_lshrrev_b32 v77, 5, v8
    v_mov_b32 v80, 0
    v_mul_u32_u24 v77, 2080, v77
    v_mov_b32 v81, 0xffff0000
    v_lshl_add_u32 v78, v76, 4, v77
    v_mov_b32 v82, 0
    v_add_u32 v78, 65536, v78
    v_mov_b32 v83, v81
    v_add_u32 v79, 41600, v78
    ds_write_b128 v78, v[80:83] offset:0
    ds_write_b128 v78, v[80:83] offset:4160
    ds_write_b128 v78, v[80:83] offset:8320
    ds_write_b128 v78, v[80:83] offset:12480
    ds_write_b128 v78, v[80:83] offset:16640
    ds_write_b128 v78, v[80:83] offset:20800
    ds_write_b128 v78, v[80:83] offset:24960
    ds_write_b128 v78, v[80:83] offset:29120
    ds_write_b128 v78, v[80:83] offset:33280
    ds_write_b128 v78, v[80:83] offset:37440
    ds_write_b128 v79, v[80:83] offset:0
    ds_write_b128 v79, v[80:83] offset:4160
    ds_write_b128 v79, v[80:83] offset:8320
    ds_write_b128 v79, v[80:83] offset:12480
    ds_write_b128 v79, v[80:83] offset:16640
    ds_write_b128 v79, v[80:83] offset:20800
    ds_write_b128 v79, v[80:83] offset:24960
    ds_write_b128 v79, v[80:83] offset:29120
    ds_write_b128 v79, v[80:83] offset:33280
    ds_write_b128 v79, v[80:83] offset:37440
KS_FILL:
    v_mov_b32 v59, 163456
    s_barrier
    ds_read_b32 v59, v59
    s_waitcnt vmcnt(0) lgkmcnt(0)
    s_cmp_eq_u32 s30, 0
    s_cbranch_scc1 KS_B3
    s_cmp_eq_u32 s30, 2
    s_cbranch_scc1 KS_NOST
    v_lshl_or_b32 v40, v65, 16, v64
    v_lshl_or_b32 v41, v67, 16, v66
    v_lshl_or_b32 v42, v69, 16, v68
    v_lshl_or_b32 v43, v71, 16, v70
    buffer_store_dwordx4 v[40:43], v9, s[8:11], s24 offen sc1
KS_NOST:
    v_mov_b32 v62, 163460
    s_waitcnt lgkmcnt(0)
    s_barrier
    ds_read_b32 v62, v62
    s_lshl_b32 s24, s2, 2
    s_add_u32 s24, s24, 7176192
    s_mov_b64 exec, 1
    s_waitcnt vmcnt(0)
    buffer_store_dword v59, v6, s[8:11], s24 offen sc1
    s_mov_b64 exec, -1
    s_branch KS_JOIN
K2_PAD_H3:
    s_branch KS_HOP0
KS_RAW:
    s_cmp_lg_u32 s2, 0
    s_cbranch_scc1 KS_NOX
    s_mov_b32 s60, s98
    s_and_b32 s61, s99, 0xffff
    s_mov_b32 s62, 256
    s_mov_b32 s63, 0x20000
    s_getreg_b32 s24, hwreg(HW_REG_XCC_ID, 0, 1)
    s_add_u32 s24, s24, 1
    v_mov_b32 v10, s24
    v_mov_b32 v11, 0
    s_mov_b64 exec, 1
    buffer_atomic_cmpswap v[10:11], v6, s[60:63], 0 offen sc1
    s_mov_b64 exec, -1
KS_NOX:
    s_barrier
    s_mov_b32 s60, s90
    s_and_b32 s61, s91, 0xffff
    s_mov_b32 s62, 20480
    s_mov_b32 s63, 0x20000
    v_lshrrev_b32 v10, 3, v8
    v_and_b32 v11, 7, v8
    v_lshlrev_b32 v10, 8, v10
    v_lshl_add_u32 v10, v11, 4, v10
    s_mov_b32 m0, 24576
    s_movk_i32 s24, 0
    buffer_load_dwordx4 v10, s[60:63], s24 offen lds
    s_mov_b32 m0, 25600
    s_movk_i32 s24, 2048
    buffer_load_dwordx4 v10, s[60:63], s24 offen lds
    s_mov_b32 m0, 26624
    s_movk_i32 s24, 4096
    buffer_load_dwordx4 v10, s[60:63], s24 offen lds
    s_mov_b32 m0, 27648
    s_movk_i32 s24, 6144
    buffer_load_dwordx4 v10, s[60:63], s24 offen lds
    s_mov_b32 m0, 28672
    s_movk_i32 s24, 8192
    buffer_load_dwordx4 v10, s[60:63], s24 offen lds
    s_mov_b32 m0, 29696
    s_movk_i32 s24, 10240
    buffer_load_dwordx4 v10, s[60:63], s24 offen lds
    s_mov_b32 m0, 30720
    s_movk_i32 s24, 12288
    buffer_load_dwordx4 v10, s[60:63], s24 offen lds
    s_mov_b32 m0, 31744
    s_movk_i32 s24, 14336
    buffer_load_dwordx4 v10, s[60:63], s24 offen lds
    s_mov_b32 m0, 32768
    s_movk_i32 s24, 16384
    buffer_load_dwordx4 v10, s[60:63], s24 offen lds
    s_mov_b32 m0, 33792
    s_movk_i32 s24, 18432
    buffer_load_dwordx4 v10, s[60:63], s24 offen lds
    s_mov_b32 m0, 152832
    s_movk_i32 s24, 128
    buffer_load_dwordx4 v10, s[60:63], s24 offen lds
    s_mov_b32 m0, 153856
    s_movk_i32 s24, 2176
    buffer_load_dwordx4 v10, s[60:63], s24 offen lds
    s_mov_b32 m0, 154880
    s_movk_i32 s24, 4224
    buffer_load_dwordx4 v10, s[60:63], s24 offen lds
    s_mov_b32 m0, 155904
    s_movk_i32 s24, 6272
    buffer_load_dwordx4 v10, s[60:63], s24 offen lds
    s_mov_b32 m0, 156928
    s_movk_i32 s24, 8320
    buffer_load_dwordx4 v10, s[60:63], s24 offen lds
    s_mov_b32 m0, 157952
    s_movk_i32 s24, 10368
    buffer_load_dwordx4 v10, s[60:63], s24 offen lds
    s_mov_b32 m0, 158976
    s_movk_i32 s24, 12416
    buffer_load_dwordx4 v10, s[60:63], s24 offen lds
    s_mov_b32 m0, 160000
    s_movk_i32 s24, 14464
    buffer_load_dwordx4 v10, s[60:63], s24 offen lds
    s_mov_b32 m0, 161024
    s_movk_i32 s24, 16512
    buffer_load_dwordx4 v10, s[60:63], s24 offen lds
    s_mov_b32 m0, 162048
    s_movk_i32 s24, 18560
    buffer_load_dwordx4 v10, s[60:63], s24 offen lds
    v_add_u32 v85, 16, v8
    v_lshlrev_b32 v84, 5, v8
    v_lshrrev_b32 v85, 6, v85
    v_mul_u32_u24 v85, 1532, v85
    v_sub_u32 v84, v84, v85
    v_mov_b32 v85, -1
    v_add_u32 v84, 66048, v84
    v_add_u32 v86, 41600, v84
    ds_write_b32 v84, v85 offset:0
    ds_write_b32 v84, v85 offset:2080
    ds_write_b32 v84, v85 offset:4160
    ds_write_b32 v84, v85 offset:6240
    ds_write_b32 v84, v85 offset:8320
    ds_write_b32 v84, v85 offset:10400
    ds_write_b32 v84, v85 offset:12480
    ds_write_b32 v84, v85 offset:14560
    ds_write_b32 v84, v85 offset:16640
    ds_write_b32 v84, v85 offset:18720
    ds_write_b32 v84, v85 offset:20800
    ds_write_b32 v84, v85 offset:22880
    ds_write_b32 v84, v85 offset:24960
    ds_write_b32 v84, v85 offset:27040
    ds_write_b32 v84, v85 offset:29120
    ds_write_b32 v84, v85 offset:31200
    ds_write_b32 v84, v85 offset:33280
    ds_write_b32 v84, v85 offset:35360
    ds_write_b32 v84, v85 offset:37440
    ds_write_b32 v84, v85 offset:39520
    ds_write_b32 v86, v85 offset:0
    ds_write_b32 v86, v85 offset:2080
    ds_write_b32 v86, v85 offset:4160
    ds_write_b32 v86, v85 offset:6240
    ds_write_b32 v86, v85 offset:8320
    ds_write_b32 v86, v85 offset:10400
    ds_write_b32 v86, v85 offset:12480
    ds_write_b32 v86, v85 offset:14560
    ds_write_b32 v86, v85 offset:16640
    ds_write_b32 v86, v85 offset:18720
    ds_write_b32 v86, v85 offset:20800
    ds_write_b32 v86, v85 offset:22880
    ds_write_b32 v86, v85 offset:24960
    ds_write_b32 v86, v85 offset:27040
    ds_write_b32 v86, v85 offset:29120
    ds_write_b32 v86, v85 offset:31200
    ds_write_b32 v86, v85 offset:33280
    ds_write_b32 v86, v85 offset:35360
    ds_write_b32 v86, v85 offset:37440
    ds_write_b32 v86, v85 offset:39520
    s_branch KS_FILL
KS_IDLE:
    s_barrier
    s_barrier
    s_branch KS_B3
K2_PAD_U20:
    s_branch K2_HOP
K2_U20:
    s_setprio 0
    s_waitcnt lgkmcnt(0)
    v_lshlrev_b32 v16, 16, v80
    v_and_b32 v17, 0xffff0000, v80
    v_lshlrev_b32 v18, 16, v81
    v_and_b32 v19, 0xffff0000, v81
    v_mov_b32 v82, v81
    v_mul_f32_dpp v32, v40, v16 row_newbcast:0 row_mask:0xf bank_mask:0xf
    v_mul_f32_dpp v33, v40, v17 row_newbcast:1 row_mask:0xf bank_mask:0xf
    v_mul_f32_dpp v34, v40, v18 row_newbcast:2 row_mask:0xf bank_mask:0xf
    v_mul_f32_dpp v35, v40, v19 row_newbcast:3 row_mask:0xf bank_mask:0xf
    v_mul_f32_dpp v36, v40, v16 row_newbcast:4 row_mask:0xf bank_mask:0xf
    v_mul_f32_dpp v37, v40, v17 row_newbcast:5 row_mask:0xf bank_mask:0xf
    v_mul_f32_dpp v38, v40, v18 row_newbcast:6 row_mask:0xf bank_mask:0xf
    v_mul_f32_dpp v39, v40, v19 row_newbcast:7 row_mask:0xf bank_mask:0xf
    v_cvt_pk_bf16_f32 v81, v32, v33
    v_cvt_pk_bf16_f32 v83, v34, v35
    v_mul_f32_dpp v16, v40, v16 row_newbcast:8 row_mask:0xf bank_mask:0xf
    v_mul_f32_dpp v17, v40, v17 row_newbcast:9 row_mask:0xf bank_mask:0xf
    v_mul_f32_dpp v18, v40, v18 row_newbcast:10 row_mask:0xf bank_mask:0xf
    v_mul_f32_dpp v19, v40, v19 row_newbcast:11 row_mask:0xf bank_mask:0xf
    v_cvt_pk_bf16_f32 v84, v36, v37
    v_cvt_pk_bf16_f32 v86, v38, v39
    v_cvt_pk_bf16_f32 v85, v16, v17
    v_cvt_pk_bf16_f32 v87, v18, v19
    v_permlane16_swap_b32 v80, v81
    v_permlane16_swap_b32 v82, v83
    v_lshlrev_b32 v24, 16, v88
    v_and_b32 v25, 0xffff0000, v88
    v_lshlrev_b32 v26, 16, v89
    v_and_b32 v27, 0xffff0000, v89
    v_mov_b32 v90, v89
    v_permlane16_swap_b32 v84, v85
    v_permlane16_swap_b32 v86, v87
    v_mul_f32_dpp v32, v41, v24 row_newbcast:0 row_mask:0xf bank_mask:0xf
    v_mul_f32_dpp v33, v41, v25 row_newbcast:1 row_mask:0xf bank_mask:0xf
    v_mul_f32_dpp v34, v41, v26 row_newbcast:2 row_mask:0xf bank_mask:0xf
    v_mul_f32_dpp v35, v41, v27 row_newbcast:3 row_mask:0xf bank_mask:0xf
    v_mul_f32_dpp v36, v41, v24 row_newbcast:4 row_mask:0xf bank_mask:0xf
    v_mul_f32_dpp v37, v41, v25 row_newbcast:5 row_mask:0xf bank_mask:0xf
    v_mul_f32_dpp v38, v41, v26 row_newbcast:6 row_mask:0xf bank_mask:0xf
    v_mul_f32_dpp v39, v41, v27 row_newbcast:7 row_mask:0xf bank_mask:0xf
    v_cvt_pk_bf16_f32 v89, v32, v33
    v_cvt_pk_bf16_f32 v91, v34, v35
    v_mul_f32_dpp v24, v41, v24 row_newbcast:8 row_mask:0xf bank_mask:0xf
    v_mul_f32_dpp v25, v41, v25 row_newbcast:9 row_mask:0xf bank_mask:0xf
    v_mul_f32_dpp v26, v41, v26 row_newbcast:10 row_mask:0xf bank_mask:0xf
    v_mul_f32_dpp v27, v41, v27 row_newbcast:11 row_mask:0xf bank_mask:0xf
    v_cvt_pk_bf16_f32 v92, v36, v37
    v_cvt_pk_bf16_f32 v94, v38, v39
    v_cvt_pk_bf16_f32 v93, v24, v25
    v_cvt_pk_bf16_f32 v95, v26, v27
    v_permlane16_swap_b32 v88, v89
    v_permlane16_swap_b32 v90, v91
    v_permlane16_swap_b32 v92, v93
    v_permlane16_swap_b32 v94, v95
    s_waitcnt vmcnt(4)
    s_setprio 1
    v_mfma_f32_32x32x16_bf16 v[8:23], v[80:83], v[176:179], 0
    ds_read_b64_tr_b16 v[184:185], v246 offset:2048
    ds_read_b64_tr_b16 v[186:187], v246 offset:3072
    ds_read_b64_tr_b16 v[188:189], v247 offset:2048
    ds_read_b64_tr_b16 v[190:191], v247 offset:3072
    s_mov_b32 m0, s68
    v_mfma_f32_32x32x16_bf16 v[24:39], v[84:87], v[176:179], 0
    buffer_load_dwordx4 v222, s[4:7], s42 offen sc1 lds
    buffer_load_dwordx4 v223, s[72:75], s42 offen offset:1024 sc1 lds
    v_permlane32_swap_b32 v236, v234
    v_permlane32_swap_b32 v237, v235
    s_add_u32 s38, s38, 1
    v_mfma_f32_32x32x16_bf16 v[48:63], v[80:83], v[180:183], 0
    v_permlane32_swap_b32 v240, v238
    v_permlane32_swap_b32 v241, v239
    v_add_f32 v236, v236, v234
    v_add_f32 v237, v237, v235
    v_add_f32 v240, -v240, -v238
    v_mfma_f32_32x32x16_bf16 v[64:79], v[84:87], v[180:183], 0
    v_add_f32 v241, -v241, -v239
    s_set_gpr_idx_on s32, gpr_idx(DST)
    s_nop 0
    v_cvt_pk_bf16_f32 v194, v236, v237
    v_cvt_pk_bf16_f32 v195, v240, v241
    s_set_gpr_idx_off
    v_mov_b32 v254, s52
    s_waitcnt vmcnt(4) lgkmcnt(0)
    v_mfma_f32_32x32x16_bf16 v[8:23], v[88:91], v[184:187], v[8:23]
    ds_read_b64_tr_b16 v[176:177], v246 offset:4096
    ds_read_b64_tr_b16 v[178:179], v246 offset:5120
    ds_read_b64_tr_b16 v[180:181], v247 offset:4096
    ds_read_b64_tr_b16 v[182:183], v247 offset:5120
    v_mov_b32 v255, s38
    s_lshl_b32 s58, s38, 3
    s_mov_b32 m0, s69
    v_mfma_f32_32x32x16_bf16 v[24:39], v[92:95], v[184:187], v[24:39]
    buffer_load_dwordx4 v224, s[4:7], s42 offen sc1 lds
    buffer_load_dwordx4 v225, s[72:75], s42 offen offset:1024 sc1 lds
    s_add_u32 s58, s58, s20
    s_mov_b64 exec, 1
    ds_write_b32 v254, v255
    s_mov_b64 exec, -1
    s_cmp_lt_u32 s58, s22
    s_cbranch_scc0 K2_dyn_10
K2_back_11:
    v_readlane_b32 s3, v253, s58
    s_lshl_b32 s44, s34, 7
    s_and_b32 s48, s3, 0x3ffff
    s_bfe_u32 s33, s3, 0x30013
    s_mul_i32 s35, s38, 6
    s_cmp_eq_u32 s34, 0
    s_cselect_b32 s35, s35, s48
    s_mov_b32 s45, s44
    s_xor_b32 s47, s44, 256
    s_add_u32 s49, s48, 128
    s_add_u32 s60, s48, 256
    s_cmp_eq_u32 s33, 3
    s_cselect_b32 s46, s44, s47
    s_cselect_b32 s50, s60, s48
    s_sub_u32 s60, s33, 2
    s_cmp_lt_u32 s60, 2
    s_cbranch_scc0 K2_rare_16
K2_back_17:
    v_mfma_f32_32x32x16_bf16 v[48:63], v[88:91], v[188:191], v[48:63]
    v_add_u32 v43, s48, v232
    ds_read_b32 v42, v43
    ds_read_b32 v43, v43 offset:1024
    v_mul_f32 v234, v8, v96
    v_mul_f32 v236, v16, v128
    v_fmac_f32 v234, v9, v97
    v_fmac_f32 v236, v17, v129
    v_mfma_f32_32x32x16_bf16 v[64:79], v[92:95], v[188:191], v[64:79]
    s_setprio 0
    v_fmac_f32 v234, v10, v98
    v_fmac_f32 v236, v18, v130
    v_fmac_f32 v234, v11, v99
    v_fmac_f32 v236, v19, v131
    v_fmac_f32 v234, v12, v100
    v_fmac_f32 v236, v20, v132
    v_fmac_f32 v234, v13, v101
    v_fmac_f32 v236, v21, v133
    v_fmac_f32 v234, v14, v102
    v_fmac_f32 v236, v22, v134
    v_fmac_f32 v234, v15, v103
    v_fmac_f32 v236, v23, v135
    v_mul_f32 v238, v24, v128
    v_mul_f32 v240, v32, v128
    v_fmac_f32 v238, v25, v129
    v_fmac_f32 v240, v33, v129
    v_fmac_f32 v238, v26, v130
    v_fmac_f32 v240, v34, v130
    v_fmac_f32 v238, v27, v131
    v_fmac_f32 v240, v35, v131
    v_fmac_f32 v238, v28, v132
    v_fmac_f32 v240, v36, v132
    v_fmac_f32 v238, v29, v133
    v_fmac_f32 v240, v37, v133
    v_fmac_f32 v238, v30, v134
    v_fmac_f32 v240, v38, v134
    v_fmac_f32 v238, v31, v135
    v_fmac_f32 v240, v39, v135
    v_mul_f32 v235, v48, v104
    v_mul_f32 v237, v56, v136
    v_fmac_f32 v235, v49, v105
    v_fmac_f32 v237, v57, v137
    v_fmac_f32 v235, v50, v106
    v_fmac_f32 v237, v58, v138
    v_fmac_f32 v235, v51, v107
    v_fmac_f32 v237, v59, v139
    v_fmac_f32 v235, v52, v108
    v_fmac_f32 v237, v60, v140
    v_fmac_f32 v235, v53, v109
    v_fmac_f32 v237, v61, v141
    v_fmac_f32 v235, v54, v110
    v_fmac_f32 v237, v62, v142
    v_fmac_f32 v235, v55, v111
    v_fmac_f32 v237, v63, v143
    v_mul_f32 v239, v64, v136
    v_mul_f32 v241, v72, v136
    v_fmac_f32 v239, v65, v137
    v_fmac_f32 v241, v73, v137
    s_setprio 1
    s_waitcnt vmcnt(4) lgkmcnt(3)
    v_mfma_f32_32x32x16_bf16 v[24:39], v[80:83], v[176:179], 0
    ds_read_b64_tr_b16 v[184:185], v246 offset:6144
    ds_read_b64_tr_b16 v[186:187], v246 offset:7168
    ds_read_b64_tr_b16 v[188:189], v247 offset:6144
    ds_read_b64_tr_b16 v[190:191], v247 offset:7168
    v_fmac_f32 v239, v66, v138
    v_fmac_f32 v241, v74, v138
    s_mov_b32 m0, s70
    v_mfma_f32_32x32x16_bf16 v[8:23], v[84:87], v[176:179], 0
    buffer_load_dwordx4 v222, s[4:7], s43 offen sc1 lds
    buffer_load_dwordx4 v223, s[72:75], s43 offen offset:1024 sc1 lds
    v_fmac_f32 v239, v67, v139
    v_fmac_f32 v241, v75, v139
    v_fmac_f32 v239, v68, v140
    v_fmac_f32 v241, v76, v140
    v_fmac_f32 v239, v69, v141
    v_mfma_f32_32x32x16_bf16 v[48:63], v[84:87], v[180:183], 0
    v_add_u32 v222, s48, v251
    ds_read2_b32 v[222:223], v222 offset0:1 offset1:3
    v_fmac_f32 v241, v77, v141
    v_fmac_f32 v239, v70, v142
    v_fmac_f32 v241, v78, v142
    v_fmac_f32 v239, v71, v143
    v_fmac_f32 v241, v79, v143
    v_mfma_f32_32x32x16_bf16 v[64:79], v[80:83], v[180:183], 0
    v_permlane32_swap_b32 v234, v236
    v_permlane32_swap_b32 v235, v237
    v_permlane32_swap_b32 v238, v239
    s_waitcnt lgkmcnt(5)
    v_or_b32 v42, v42, v233
    v_or_b32 v43, v43, v233
    s_cmp_lg_u32 s34, 0
    s_cbranch_scc1 K2_dum_21
    s_cmp_eq_u32 s33, 4
    s_cbranch_scc1 K2_a4_22
K2_b4_24:
    s_add_u32 m0, s48, 512
    s_add_u32 s65, s48, 1536
    buffer_load_dwordx4 v42, s[16:19], 0 offen  lds
    s_mov_b32 m0, s65
    s_mov_b32 exec_hi, 0
    buffer_load_dwordx4 v43, s[16:19], 0 offen  lds
    s_mov_b32 exec_hi, -1
K2_back_23:
    s_waitcnt vmcnt(6) lgkmcnt(1)
    v_mfma_f32_32x32x16_bf16 v[24:39], v[88:91], v[184:187], v[24:39]
    ds_read_b64_tr_b16 v[176:177], v246 offset:0
    ds_read_b64_tr_b16 v[178:179], v246 offset:1024
    ds_read_b64_tr_b16 v[180:181], v247 offset:0
    ds_read_b64_tr_b16 v[182:183], v247 offset:1024
    v_add_f32 v234, v234, v236
    v_add_f32 v235, v235, v237
    s_mov_b32 m0, s71
    v_mfma_f32_32x32x16_bf16 v[8:23], v[92:95], v[184:187], v[8:23]
    buffer_load_dwordx4 v224, s[4:7], s43 offen sc1 lds
    buffer_load_dwordx4 v225, s[72:75], s43 offen offset:1024 sc1 lds
    s_waitcnt lgkmcnt(4)
    v_mad_u32_u16 v222, v222, s39, v248 op_sel:[1,0,0,0]
    v_mad_u32_u16 v223, v223, s39, v248 op_sel:[1,0,0,0]
    v_add_f32 v238, -v238, -v239
    s_set_gpr_idx_on s31, gpr_idx(DST)
    s_nop 0
    v_cvt_pk_bf16_f32 v192, v234, v235
    v_cvt_pk_bf16_f32 v197, v238, v238
    s_set_gpr_idx_off
    v_mfma_f32_32x32x16_bf16 v[48:63], v[92:95], v[188:191], v[48:63]
    v_add_u32 v224, s49, v251
    ds_read2_b32 v[224:225], v224 offset0:1 offset1:3
    v_mov_b64 v[0:1], 0
    v_mov_b64 v[2:3], 0
    v_mov_b64 v[4:5], 0
    v_mov_b64 v[6:7], 0
    v_mov_b64 v[40:41], 0
    v_mov_b64 v[42:43], 0
    v_mov_b64 v[44:45], 0
    v_mov_b64 v[46:47], 0
    v_mfma_f32_32x32x16_bf16 v[64:79], v[88:91], v[188:191], v[64:79]
    s_setprio 0
    v_mul_f32 v234, v24, v144
    v_fmac_f32 v234, v25, v145
    v_fmac_f32 v234, v26, v146
    v_fmac_f32 v234, v27, v147
    v_fmac_f32 v234, v28, v148
    v_fmac_f32 v234, v29, v149
    v_fmac_f32 v234, v30, v150
    v_fmac_f32 v234, v31, v151
    v_mul_f32 v238, v16, v160
    v_mul_f32 v239, v56, v168
    v_fmac_f32 v238, v17, v161
    v_fmac_f32 v239, v57, v169
    v_fmac_f32 v238, v18, v162
    v_fmac_f32 v239, v58, v170
    v_fmac_f32 v238, v19, v163
    v_fmac_f32 v239, v59, v171
    v_fmac_f32 v238, v20, v164
    v_fmac_f32 v239, v60, v172
    v_fmac_f32 v238, v21, v165
    v_fmac_f32 v239, v61, v173
    v_fmac_f32 v238, v22, v166
    v_fmac_f32 v239, v62, v174
    v_fmac_f32 v238, v23, v167
    v_fmac_f32 v239, v63, v175
    s_setprio 1
    s_waitcnt vmcnt(6) lgkmcnt(1)
    v_mfma_f32_32x32x16_bf16 v[0:15], v[80:83], v[176:179], v[0:15]
    ds_read_b64_tr_b16 v[184:185], v246 offset:2048
    ds_read_b64_tr_b16 v[186:187], v246 offset:3072
    ds_read_b64_tr_b16 v[188:189], v247 offset:2048
    ds_read_b64_tr_b16 v[190:191], v247 offset:3072
    v_mul_f32 v235, v64, v152
    v_fmac_f32 v235, v65, v153
    s_mov_b32 m0, s68
    v_mfma_f32_32x32x16_bf16 v[16:31], v[84:87], v[176:179], 0
    buffer_load_dwordx4 v222, s[4:7], s44 offen sc1 lds
    buffer_load_dwordx4 v223, s[72:75], s44 offen offset:1024 sc1 lds
    s_waitcnt lgkmcnt(4)
    v_mad_u32_u16 v224, v224, s39, v248 op_sel:[1,0,0,0]
    v_mad_u32_u16 v225, v225, s39, v248 op_sel:[1,0,0,0]
    v_fmac_f32 v235, v66, v154
    v_fmac_f32 v235, v67, v155
    v_mfma_f32_32x32x16_bf16 v[40:55], v[80:83], v[180:183], v[40:55]
    v_add_u32 v226, s50, v251
    ds_read2_b32 v[226:227], v226 offset0:1 offset1:3
    v_fmac_f32 v235, v68, v156
    v_fmac_f32 v235, v69, v157
    v_fmac_f32 v235, v70, v158
    v_fmac_f32 v235, v71, v159
    v_mfma_f32_32x32x16_bf16 v[56:71], v[84:87], v[180:183], 0
    v_permlane32_swap_b32 v234, v240
    v_permlane32_swap_b32 v235, v241
    v_add_f32 v234, v234, v240
    v_add_f32 v235, v235, v241
    s_waitcnt vmcnt(6) lgkmcnt(1)
    v_mfma_f32_32x32x16_bf16 v[0:15], v[88:91], v[184:187], v[0:15]
    ds_read_b64_tr_b16 v[176:177], v246 offset:4096
    ds_read_b64_tr_b16 v[178:179], v246 offset:5120
    ds_read_b64_tr_b16 v[180:181], v247 offset:4096
    ds_read_b64_tr_b16 v[182:183], v247 offset:5120
    s_mov_b32 m0, s69
    v_mfma_f32_32x32x16_bf16 v[16:31], v[92:95], v[184:187], v[16:31]
    buffer_load_dwordx4 v224, s[4:7], s45 offen sc1 lds
    buffer_load_dwordx4 v225, s[72:75], s45 offen offset:1024 sc1 lds
    s_waitcnt lgkmcnt(4)
    v_mad_u32_u16 v226, v226, s39, v248 op_sel:[1,0,0,0]
    v_mad_u32_u16 v227, v227, s39, v248 op_sel:[1,0,0,0]
    s_set_gpr_idx_on s31, gpr_idx(DST)
    s_nop 0
    v_cvt_pk_bf16_f32 v193, v234, v235
    s_set_gpr_idx_off
    v_mfma_f32_32x32x16_bf16 v[40:55], v[88:91], v[188:191], v[40:55]
    v_mul_f32 v240, v0, v144
    v_mul_f32 v236, v8, v160
    v_fmac_f32 v240, v1, v145
    v_fmac_f32 v236, v9, v161
    v_fmac_f32 v240, v2, v146
    v_fmac_f32 v236, v10, v162
    v_fmac_f32 v240, v3, v147
    v_mfma_f32_32x32x16_bf16 v[56:71], v[92:95], v[188:191], v[56:71]
    s_setprio 0
    v_fmac_f32 v236, v11, v163
    v_fmac_f32 v240, v4, v148
    v_fmac_f32 v236, v12, v164
    v_fmac_f32 v240, v5, v149
    v_fmac_f32 v236, v13, v165
    v_fmac_f32 v240, v6, v150
    v_fmac_f32 v236, v14, v166
    v_fmac_f32 v240, v7, v151
    v_fmac_f32 v236, v15, v167
    v_mul_f32 v234, v16, v112
    v_mul_f32 v241, v40, v152
    v_mul_f32 v237, v48, v168
    v_fmac_f32 v234, v17, v113
    v_fmac_f32 v241, v41, v153
    v_fmac_f32 v237, v49, v169
    v_fmac_f32 v234, v18, v114
    v_fmac_f32 v241, v42, v154
    v_fmac_f32 v237, v50, v170
    v_fmac_f32 v234, v19, v115
    v_fmac_f32 v241, v43, v155
    v_fmac_f32 v237, v51, v171
    v_fmac_f32 v234, v20, v116
    v_fmac_f32 v241, v44, v156
    v_fmac_f32 v237, v52, v172
    v_fmac_f32 v234, v21, v117
    v_fmac_f32 v241, v45, v157
    v_fmac_f32 v237, v53, v173
    v_fmac_f32 v234, v22, v118
    v_fmac_f32 v241, v46, v158
    v_fmac_f32 v237, v54, v174
    v_fmac_f32 v234, v23, v119
    v_fmac_f32 v241, v47, v159
    v_fmac_f32 v237, v55, v175
    s_setprio 1
    s_waitcnt vmcnt(4) lgkmcnt(0)
    v_mfma_f32_32x32x16_bf16 v[8:23], v[80:83], v[176:179], 0
    ds_read_b64_tr_b16 v[184:185], v246 offset:6144
    ds_read_b64_tr_b16 v[186:187], v246 offset:7168
    ds_read_b64_tr_b16 v[188:189], v247 offset:6144
    ds_read_b64_tr_b16 v[190:191], v247 offset:7168
    v_mul_f32 v235, v56, v120
    v_fmac_f32 v235, v57, v121
    s_mov_b32 m0, s70
    v_mfma_f32_32x32x16_bf16 v[24:39], v[84:87], v[176:179], v[24:39]
    buffer_load_dwordx4 v226, s[4:7], s46 offen sc1 lds
    buffer_load_dwordx4 v227, s[72:75], s46 offen offset:1024 sc1 lds
    v_fmac_f32 v235, v58, v122
    v_fmac_f32 v235, v59, v123
    v_fmac_f32 v235, v60, v124
    v_fmac_f32 v235, v61, v125
    v_fmac_f32 v235, v62, v126
    v_mfma_f32_32x32x16_bf16 v[64:79], v[84:87], v[180:183], v[64:79]
    v_fmac_f32 v235, v63, v127
    s_sub_u32 s26, s48, s29
    s_mov_b32 s29, s48
    s_mov_b32 s30, s3
    s_bfe_u32 s56, s3, 0x40012
    s_cmp_eq_u32 s34, 0
    s_cselect_b32 s56, s56, 0
    v_mfma_f32_32x32x16_bf16 v[48:63], v[80:83], v[180:183], 0
    v_permlane32_swap_b32 v236, v240
    v_permlane32_swap_b32 v237, v241
    v_add_f32 v236, v236, v240
    v_add_f32 v237, v237, v241
    s_waitcnt vmcnt(4) lgkmcnt(0)
    v_mfma_f32_32x32x16_bf16 v[8:23], v[88:91], v[184:187], v[8:23]
    ds_read_b64_tr_b16 v[176:177], v246 offset:0
    ds_read_b64_tr_b16 v[178:179], v246 offset:1024
    ds_read_b64_tr_b16 v[180:181], v247 offset:0
    ds_read_b64_tr_b16 v[182:183], v247 offset:1024
    s_mov_b32 m0, s71
    v_mfma_f32_32x32x16_bf16 v[24:39], v[92:95], v[184:187], v[24:39]
    s_cmp_eq_u32 s33, 4
    s_cbranch_scc1 K2_g4_19
    buffer_load_dwordx4 v224, s[4:7], s47 offen sc1 lds
    buffer_load_dwordx4 v225, s[72:75], s47 offen offset:1024 sc1 lds
K2_back_20:
    s_set_gpr_idx_on s31, gpr_idx(DST)
    s_nop 0
    v_cvt_pk_bf16_f32 v196, v236, v237
    s_set_gpr_idx_off
    v_mfma_f32_32x32x16_bf16 v[64:79], v[92:95], v[188:191], v[64:79]
    s_mov_b32 s32, s31
    s_mov_b32 s31, s35
    v_mul_f32 v236, v8, v144
    v_fma_f32 v238, v16, v160, -v238
    v_fmac_f32 v236, v9, v145
    v_fmac_f32 v238, v17, v161
    v_fmac_f32 v236, v10, v146
    v_mfma_f32_32x32x16_bf16 v[48:63], v[88:91], v[188:191], v[48:63]
    s_setprio 0
    v_fmac_f32 v238, v18, v162
    v_fmac_f32 v236, v11, v147
    v_fmac_f32 v238, v19, v163
    v_fmac_f32 v236, v12, v148
    v_fmac_f32 v238, v20, v164
    v_fmac_f32 v236, v13, v149
    v_fmac_f32 v238, v21, v165
    v_fmac_f32 v236, v14, v150
    v_fmac_f32 v238, v22, v166
    v_fmac_f32 v236, v15, v151
    v_fmac_f32 v238, v23, v167
    v_add_u32 v249, s26, v249
    v_add_u32 v250, s26, v250
    v_mul_f32 v240, v24, v160
    v_fma_f32 v234, v32, v112, -v234
    v_fmac_f32 v240, v25, v161
    v_fmac_f32 v234, v33, v113
    v_fmac_f32 v240, v26, v162
    v_fmac_f32 v234, v34, v114
    v_fmac_f32 v240, v27, v163
    v_fmac_f32 v234, v35, v115
    v_fmac_f32 v240, v28, v164
    v_fmac_f32 v234, v36, v116
    v_fmac_f32 v240, v29, v165
    v_fmac_f32 v234, v37, v117
    v_fmac_f32 v240, v30, v166
    v_fmac_f32 v234, v38, v118
    v_fmac_f32 v240, v31, v167
    v_fmac_f32 v234, v39, v119
    ds_read_b64_tr_b16 v[80:81], v249 offset:0
    ds_read_u16_d16_hi v40, v250 offset:0
    v_mul_f32 v241, v64, v168
    v_fma_f32 v235, v72, v120, -v235
    v_fmac_f32 v241, v65, v169
    v_fmac_f32 v235, v73, v121
    v_fmac_f32 v241, v66, v170
    v_fmac_f32 v235, v74, v122
    v_fmac_f32 v241, v67, v171
    v_fmac_f32 v235, v75, v123
    v_fmac_f32 v241, v68, v172
    v_fmac_f32 v235, v76, v124
    v_fmac_f32 v241, v69, v173
    v_fmac_f32 v235, v77, v125
    v_fmac_f32 v241, v70, v174
    v_fmac_f32 v235, v78, v126
    v_fmac_f32 v241, v71, v175
    v_fmac_f32 v235, v79, v127
    ds_read_b64_tr_b16 v[88:89], v249 offset:512
    ds_read_u16_d16_hi v41, v250 offset:128
    v_mul_f32 v237, v48, v152
    v_fma_f32 v239, v56, v168, -v239
    v_fmac_f32 v237, v49, v153
    v_fmac_f32 v239, v57, v169
    v_fmac_f32 v237, v50, v154
    v_fmac_f32 v239, v58, v170
    v_fmac_f32 v237, v51, v155
    v_fmac_f32 v239, v59, v171
    v_fmac_f32 v237, v52, v156
    v_fmac_f32 v239, v60, v172
    v_fmac_f32 v237, v53, v157
    v_fmac_f32 v239, v61, v173
    v_fmac_f32 v237, v54, v158
    v_fmac_f32 v239, v62, v174
    v_fmac_f32 v237, v55, v159
    v_fmac_f32 v239, v63, v175
    s_cmp_eq_u32 s56, 5
    s_cbranch_scc1 K2_U20
    s_cmp_eq_u32 s56, 6
    s_cbranch_scc1 K2_U3h0
    s_branch K2_DSP0
K2_PAD_U30:
    s_branch K2_HOP
K2_U3h0:
    s_setprio 0
    ds_read_b64_tr_b16 v[228:229], v249 offset:1024
    ds_read_u16_d16_hi v42, v250 offset:256
    s_waitcnt lgkmcnt(2)
    v_lshlrev_b32 v16, 16, v80
    v_and_b32 v17, 0xffff0000, v80
    v_lshlrev_b32 v18, 16, v81
    v_and_b32 v19, 0xffff0000, v81
    v_mov_b32 v82, v81
    v_mul_f32_dpp v32, v40, v16 row_newbcast:0 row_mask:0xf bank_mask:0xf
    v_mul_f32_dpp v33, v40, v17 row_newbcast:1 row_mask:0xf bank_mask:0xf
    v_mul_f32_dpp v34, v40, v18 row_newbcast:2 row_mask:0xf bank_mask:0xf
    v_mul_f32_dpp v35, v40, v19 row_newbcast:3 row_mask:0xf bank_mask:0xf
    v_mul_f32_dpp v36, v40, v16 row_newbcast:4 row_mask:0xf bank_mask:0xf
    v_mul_f32_dpp v37, v40, v17 row_newbcast:5 row_mask:0xf bank_mask:0xf
    v_mul_f32_dpp v38, v40, v18 row_newbcast:6 row_mask:0xf bank_mask:0xf
    v_mul_f32_dpp v39, v40, v19 row_newbcast:7 row_mask:0xf bank_mask:0xf
    v_cvt_pk_bf16_f32 v81, v32, v33
    v_cvt_pk_bf16_f32 v83, v34, v35
    v_mul_f32_dpp v16, v40, v16 row_newbcast:8 row_mask:0xf bank_mask:0xf
    v_mul_f32_dpp v17, v40, v17 row_newbcast:9 row_mask:0xf bank_mask:0xf
    v_mul_f32_dpp v18, v40, v18 row_newbcast:10 row_mask:0xf bank_mask:0xf
    v_mul_f32_dpp v19, v40, v19 row_newbcast:11 row_mask:0xf bank_mask:0xf
    v_cvt_pk_bf16_f32 v84, v36, v37
    v_cvt_pk_bf16_f32 v86, v38, v39
    v_cvt_pk_bf16_f32 v85, v16, v17
    v_cvt_pk_bf16_f32 v87, v18, v19
    v_permlane16_swap_b32 v80, v81
    v_permlane16_swap_b32 v82, v83
    v_lshlrev_b32 v24, 16, v88
    v_and_b32 v25, 0xffff0000, v88
    v_lshlrev_b32 v26, 16, v89
    v_and_b32 v27, 0xffff0000, v89
    v_mov_b32 v90, v89
    v_permlane16_swap_b32 v84, v85
    v_permlane16_swap_b32 v86, v87
    v_mul_f32_dpp v32, v41, v24 row_newbcast:0 row_mask:0xf bank_mask:0xf
    v_mul_f32_dpp v33, v41, v25 row_newbcast:1 row_mask:0xf bank_mask:0xf
    v_mul_f32_dpp v34, v41, v26 row_newbcast:2 row_mask:0xf bank_mask:0xf
    v_mul_f32_dpp v35, v41, v27 row_newbcast:3 row_mask:0xf bank_mask:0xf
    v_mul_f32_dpp v36, v41, v24 row_newbcast:4 row_mask:0xf bank_mask:0xf
    v_mul_f32_dpp v37, v41, v25 row_newbcast:5 row_mask:0xf bank_mask:0xf
    v_mul_f32_dpp v38, v41, v26 row_newbcast:6 row_mask:0xf bank_mask:0xf
    v_mul_f32_dpp v39, v41, v27 row_newbcast:7 row_mask:0xf bank_mask:0xf
    v_cvt_pk_bf16_f32 v89, v32, v33
    v_cvt_pk_bf16_f32 v91, v34, v35
    v_mul_f32_dpp v24, v41, v24 row_newbcast:8 row_mask:0xf bank_mask:0xf
    v_mul_f32_dpp v25, v41, v25 row_newbcast:9 row_mask:0xf bank_mask:0xf
    v_mul_f32_dpp v26, v41, v26 row_newbcast:10 row_mask:0xf bank_mask:0xf
    v_mul_f32_dpp v27, v41, v27 row_newbcast:11 row_mask:0xf bank_mask:0xf
    v_cvt_pk_bf16_f32 v92, v36, v37
    v_cvt_pk_bf16_f32 v94, v38, v39
    v_cvt_pk_bf16_f32 v93, v24, v25
    v_cvt_pk_bf16_f32 v95, v26, v27
    v_permlane16_swap_b32 v88, v89
    v_permlane16_swap_b32 v90, v91
    s_waitcnt lgkmcnt(0)
    v_lshlrev_b32 v16, 16, v228
    v_and_b32 v17, 0xffff0000, v228
    v_permlane16_swap_b32 v92, v93
    v_permlane16_swap_b32 v94, v95
    v_mul_f32_dpp v32, v42, v16 row_newbcast:0 row_mask:0xf bank_mask:0xf
    v_mul_f32_dpp v33, v42, v17 row_newbcast:1 row_mask:0xf bank_mask:0xf
    v_mul_f32_dpp v36, v42, v16 row_newbcast:4 row_mask:0xf bank_mask:0xf
    v_mul_f32_dpp v37, v42, v17 row_newbcast:5 row_mask:0xf bank_mask:0xf
    v_cvt_pk_bf16_f32 v229, v32, v33
    v_mul_f32_dpp v16, v42, v16 row_newbcast:8 row_mask:0xf bank_mask:0xf
    v_mul_f32_dpp v17, v42, v17 row_newbcast:9 row_mask:0xf bank_mask:0xf
    v_cvt_pk_bf16_f32 v242, v36, v37
    v_cvt_pk_bf16_f32 v243, v16, v17
    v_permlane16_swap_b32 v228, v229
    s_nop 0
    v_permlane16_swap_b32 v242, v243
    s_waitcnt vmcnt(4)
    s_setprio 1
    v_mfma_f32_32x32x16_bf16 v[8:23], v[80:83], v[176:179], 0
    ds_read_b64_tr_b16 v[184:185], v246 offset:2048
    ds_read_b64_tr_b16 v[186:187], v246 offset:3072
    ds_read_b64_tr_b16 v[188:189], v247 offset:2048
    ds_read_b64_tr_b16 v[190:191], v247 offset:3072
    s_mov_b32 m0, s68
    v_mfma_f32_32x32x16_bf16 v[24:39], v[84:87], v[176:179], 0
    buffer_load_dwordx4 v222, s[4:7], s41 offen sc1 lds
    buffer_load_dwordx4 v223, s[72:75], s41 offen offset:1024 sc1 lds
    v_permlane32_swap_b32 v236, v234
    v_permlane32_swap_b32 v237, v235
    s_add_u32 s38, s38, 1
    v_mfma_f32_32x32x16_bf16 v[48:63], v[80:83], v[180:183], 0
    v_permlane32_swap_b32 v240, v238
    v_permlane32_swap_b32 v241, v239
    v_add_f32 v236, v236, v234
    v_add_f32 v237, v237, v235
    v_add_f32 v240, -v240, -v238
    v_mfma_f32_32x32x16_bf16 v[64:79], v[84:87], v[180:183], 0
    v_add_f32 v241, -v241, -v239
    s_set_gpr_idx_on s32, gpr_idx(DST)
    s_nop 0
    v_cvt_pk_bf16_f32 v194, v236, v237
    v_cvt_pk_bf16_f32 v195, v240, v241
    s_set_gpr_idx_off
    v_mov_b32 v254, s52
    s_waitcnt vmcnt(4) lgkmcnt(0)
    v_mfma_f32_32x32x16_bf16 v[8:23], v[88:91], v[184:187], v[8:23]
    ds_read_b64_tr_b16 v[176:177], v246 offset:4096
    ds_read_b64_tr_b16 v[180:181], v247 offset:4096
    v_mov_b32 v255, s38
    s_lshl_b32 s58, s38, 3
    s_add_u32 s58, s58, s20
    s_mov_b32 m0, s69
    v_mfma_f32_32x32x16_bf16 v[24:39], v[92:95], v[184:187], v[24:39]
    buffer_load_dwordx4 v226, s[4:7], s41 offen sc1 lds
    s_mov_b64 exec, 1
    ds_write_b32 v254, v255
    s_mov_b64 exec, -1
    s_cmp_lt_u32 s58, s22
    s_cbranch_scc0 K2_dyn_25
K2_back_26:
    v_readlane_b32 s3, v253, s58
    s_lshl_b32 s44, s34, 7
    s_and_b32 s48, s3, 0x3ffff
    s_bfe_u32 s33, s3, 0x30013
    s_mul_i32 s35, s38, 6
    s_cmp_eq_u32 s34, 0
    s_cselect_b32 s35, s35, s48
    s_mov_b32 s45, s44
    s_xor_b32 s47, s44, 256
    s_add_u32 s49, s48, 128
    s_add_u32 s60, s48, 256
    s_cmp_eq_u32 s33, 3
    s_cselect_b32 s46, s44, s47
    s_cselect_b32 s50, s60, s48
    s_sub_u32 s60, s33, 2
    s_cmp_lt_u32 s60, 2
    s_cbranch_scc0 K2_rare_31
K2_back_32:
    v_mfma_f32_32x32x16_bf16 v[48:63], v[88:91], v[188:191], v[48:63]
    v_add_u32 v43, s48, v232
    ds_read_b32 v42, v43
    ds_read_b32 v43, v43 offset:1024
    v_mfma_f32_32x32x16_bf16 v[64:79], v[92:95], v[188:191], v[64:79]
    s_waitcnt vmcnt(3) lgkmcnt(3)
    v_mfma_f32_32x32x8_bf16 v[8:23], v[228:229], v[176:177], v[8:23]
    ds_read_b64_tr_b16 v[184:185], v246 offset:6144
    ds_read_b64_tr_b16 v[186:187], v246 offset:7168
    ds_read_b64_tr_b16 v[188:189], v247 offset:6144
    ds_read_b64_tr_b16 v[190:191], v247 offset:7168
    s_mov_b32 m0, s70
    v_mfma_f32_32x32x8_bf16 v[24:39], v[242:243], v[176:177], v[24:39]
    buffer_load_dwordx4 v222, s[4:7], s42 offen sc1 lds
    buffer_load_dwordx4 v223, s[72:75], s42 offen offset:1024 sc1 lds
    v_mfma_f32_32x32x8_bf16 v[48:63], v[228:229], v[180:181], v[48:63]
    s_nop 2
    v_mul_f32 v234, v8, v96
    v_mul_f32 v236, v16, v128
    v_fmac_f32 v234, v9, v97
    v_fmac_f32 v236, v17, v129
    v_fmac_f32 v234, v10, v98
    v_fmac_f32 v236, v18, v130
    v_fmac_f32 v234, v11, v99
    v_mfma_f32_32x32x8_bf16 v[64:79], v[242:243], v[180:181], v[64:79]
    s_setprio 0
    s_waitcnt lgkmcnt(4)
    v_or_b32 v42, v42, v233
    v_or_b32 v43, v43, v233
    s_cmp_lg_u32 s34, 0
    s_cbranch_scc1 K2_dum_36
    s_cmp_eq_u32 s33, 4
    s_cbranch_scc1 K2_a4_37
K2_b4_39:
    s_add_u32 m0, s48, 512
    s_add_u32 s65, s48, 1536
    buffer_load_dwordx4 v42, s[16:19], 0 offen  lds
    s_mov_b32 m0, s65
    s_mov_b32 exec_hi, 0
    buffer_load_dwordx4 v43, s[16:19], 0 offen  lds
    s_mov_b32 exec_hi, -1
K2_back_38:
    v_fmac_f32 v236, v19, v131
    v_fmac_f32 v234, v12, v100
    v_fmac_f32 v236, v20, v132
    v_fmac_f32 v234, v13, v101
    v_fmac_f32 v236, v21, v133
    v_fmac_f32 v234, v14, v102
    v_fmac_f32 v236, v22, v134
    v_fmac_f32 v234, v15, v103
    v_fmac_f32 v236, v23, v135
    v_mul_f32 v238, v24, v128
    v_mul_f32 v240, v32, v128
    v_fmac_f32 v238, v25, v129
    v_fmac_f32 v240, v33, v129
    v_fmac_f32 v238, v26, v130
    v_fmac_f32 v240, v34, v130
    v_fmac_f32 v238, v27, v131
    v_fmac_f32 v240, v35, v131
    v_fmac_f32 v238, v28, v132
    v_fmac_f32 v240, v36, v132
    v_fmac_f32 v238, v29, v133
    v_fmac_f32 v240, v37, v133
    v_fmac_f32 v238, v30, v134
    v_fmac_f32 v240, v38, v134
    v_fmac_f32 v238, v31, v135
    v_fmac_f32 v240, v39, v135
    v_mul_f32 v235, v48, v104
    v_mul_f32 v237, v56, v136
    v_fmac_f32 v235, v49, v105
    v_fmac_f32 v237, v57, v137
    v_fmac_f32 v235, v50, v106
    v_fmac_f32 v237, v58, v138
    v_fmac_f32 v235, v51, v107
    v_fmac_f32 v237, v59, v139
    v_fmac_f32 v235, v52, v108
    v_fmac_f32 v237, v60, v140
    v_fmac_f32 v235, v53, v109
    v_fmac_f32 v237, v61, v141
    v_fmac_f32 v235, v54, v110
    v_fmac_f32 v237, v62, v142
    v_fmac_f32 v235, v55, v111
    v_fmac_f32 v237, v63, v143
    v_mul_f32 v239, v64, v136
    v_mul_f32 v241, v72, v136
    s_setprio 1
    s_waitcnt vmcnt(5) lgkmcnt(0)
    v_mfma_f32_32x32x16_bf16 v[24:39], v[88:91], v[184:187], 0
    ds_read_b64_tr_b16 v[176:177], v246 offset:0
    ds_read_b64_tr_b16 v[178:179], v246 offset:1024
    ds_read_b64_tr_b16 v[180:181], v247 offset:0
    ds_read_b64_tr_b16 v[182:183], v247 offset:1024
    v_fmac_f32 v239, v65, v137
    v_fmac_f32 v241, v73, v137
    s_mov_b32 m0, s71
    v_mfma_f32_32x32x16_bf16 v[8:23], v[92:95], v[184:187], 0
    buffer_load_dwordx4 v224, s[4:7], s42 offen sc1 lds
    buffer_load_dwordx4 v225, s[72:75], s42 offen offset:1024 sc1 lds
    v_fmac_f32 v239, v66, v138
    v_fmac_f32 v241, v74, v138
    v_fmac_f32 v239, v67, v139
    v_fmac_f32 v241, v75, v139
    v_fmac_f32 v239, v68, v140
    v_mfma_f32_32x32x16_bf16 v[48:63], v[92:95], v[188:191], 0
    v_fmac_f32 v241, v76, v140
    v_fmac_f32 v239, v69, v141
    v_fmac_f32 v241, v77, v141
    v_fmac_f32 v239, v70, v142
    v_fmac_f32 v241, v78, v142
    v_fmac_f32 v239, v71, v143
    v_fmac_f32 v241, v79, v143
    v_mfma_f32_32x32x16_bf16 v[64:79], v[88:91], v[188:191], 0
    v_permlane32_swap_b32 v234, v236
    v_permlane32_swap_b32 v235, v237
    v_permlane32_swap_b32 v238, v239
    s_waitcnt vmcnt(6) lgkmcnt(0)
    v_mfma_f32_32x32x16_bf16 v[24:39], v[80:83], v[176:179], v[24:39]
    ds_read_b64_tr_b16 v[184:185], v246 offset:2048
    ds_read_b64_tr_b16 v[188:189], v247 offset:2048
    v_add_f32 v234, v234, v236
    v_add_f32 v235, v235, v237
    v_add_f32 v238, -v238, -v239
    v_mov_b64 v[0:1], 0
    s_mov_b32 m0, s68
    v_mfma_f32_32x32x16_bf16 v[8:23], v[84:87], v[176:179], v[8:23]
    buffer_load_dwordx4 v226, s[4:7], s42 offen sc1 lds
    s_set_gpr_idx_on s31, gpr_idx(DST)
    s_nop 0
    v_cvt_pk_bf16_f32 v192, v234, v235
    v_cvt_pk_bf16_f32 v197, v238, v238
    s_set_gpr_idx_off
    v_mov_b64 v[2:3], 0
    v_mov_b64 v[4:5], 0
    v_mfma_f32_32x32x16_bf16 v[48:63], v[84:87], v[180:183], v[48:63]
    v_mov_b64 v[6:7], 0
    v_mov_b64 v[40:41], 0
    v_mov_b64 v[42:43], 0
    v_mov_b64 v[44:45], 0
    v_mov_b64 v[46:47], 0
    v_mfma_f32_32x32x16_bf16 v[64:79], v[80:83], v[180:183], v[64:79]
    s_waitcnt vmcnt(5) lgkmcnt(0)
    v_mfma_f32_32x32x8_bf16 v[24:39], v[228:229], v[184:185], v[24:39]
    ds_read_b64_tr_b16 v[176:177], v246 offset:4096
    ds_read_b64_tr_b16 v[178:179], v246 offset:5120
    ds_read_b64_tr_b16 v[180:181], v247 offset:4096
    ds_read_b64_tr_b16 v[182:183], v247 offset:5120
    s_mov_b32 m0, s69
    v_mfma_f32_32x32x8_bf16 v[8:23], v[242:243], v[184:185], v[8:23]
    buffer_load_dwordx4 v222, s[4:7], s43 offen sc1 lds
    buffer_load_dwordx4 v223, s[72:75], s43 offen offset:1024 sc1 lds
    v_mfma_f32_32x32x8_bf16 v[48:63], v[242:243], v[188:189], v[48:63]
    s_nop 2
    v_mul_f32 v234, v24, v144
    v_fmac_f32 v234, v25, v145
    v_fmac_f32 v234, v26, v146
    v_fmac_f32 v234, v27, v147
    v_fmac_f32 v234, v28, v148
    v_fmac_f32 v234, v29, v149
    v_fmac_f32 v234, v30, v150
    v_mfma_f32_32x32x8_bf16 v[64:79], v[228:229], v[188:189], v[64:79]
    s_setprio 0
    v_fmac_f32 v234, v31, v151
    v_mul_f32 v238, v16, v160
    v_mul_f32 v239, v56, v168
    v_fmac_f32 v238, v17, v161
    v_fmac_f32 v239, v57, v169
    v_fmac_f32 v238, v18, v162
    v_fmac_f32 v239, v58, v170
    v_fmac_f32 v238, v19, v163
    v_fmac_f32 v239, v59, v171
    v_fmac_f32 v238, v20, v164
    v_fmac_f32 v239, v60, v172
    v_fmac_f32 v238, v21, v165
    v_fmac_f32 v239, v61, v173
    v_fmac_f32 v238, v22, v166
    v_fmac_f32 v239, v62, v174
    v_fmac_f32 v238, v23, v167
    v_fmac_f32 v239, v63, v175
    s_setprio 1
    s_waitcnt vmcnt(3) lgkmcnt(0)
    v_mfma_f32_32x32x16_bf16 v[0:15], v[80:83], v[176:179], v[0:15]
    ds_read_b64_tr_b16 v[184:185], v246 offset:6144
    ds_read_b64_tr_b16 v[186:187], v246 offset:7168
    ds_read_b64_tr_b16 v[188:189], v247 offset:6144
    ds_read_b64_tr_b16 v[190:191], v247 offset:7168
    v_mul_f32 v235, v64, v152
    v_fmac_f32 v235, v65, v153
    s_mov_b32 m0, s70
    v_mfma_f32_32x32x16_bf16 v[16:31], v[84:87], v[176:179], 0
    buffer_load_dwordx4 v224, s[4:7], s43 offen sc1 lds
    buffer_load_dwordx4 v225, s[72:75], s43 offen offset:1024 sc1 lds
    v_fmac_f32 v235, v66, v154
    v_fmac_f32 v235, v67, v155
    v_fmac_f32 v235, v68, v156
    v_fmac_f32 v235, v69, v157
    v_fmac_f32 v235, v70, v158
    v_mfma_f32_32x32x16_bf16 v[40:55], v[80:83], v[180:183], v[40:55]
    v_add_u32 v222, s48, v251
    ds_read2_b32 v[222:223], v222 offset0:1 offset1:3
    v_fmac_f32 v235, v71, v159
    v_mfma_f32_32x32x16_bf16 v[56:71], v[84:87], v[180:183], 0
    v_permlane32_swap_b32 v234, v240
    v_permlane32_swap_b32 v235, v241
    v_add_f32 v234, v234, v240
    v_add_f32 v235, v235, v241
    s_waitcnt vmcnt(4) lgkmcnt(1)
    v_mfma_f32_32x32x16_bf16 v[0:15], v[88:91], v[184:187], v[0:15]
    ds_read_b64_tr_b16 v[176:177], v246 offset:0
    ds_read_b64_tr_b16 v[180:181], v247 offset:0
    s_set_gpr_idx_on s31, gpr_idx(DST)
    s_nop 0
    v_cvt_pk_bf16_f32 v193, v234, v235
    s_set_gpr_idx_off
    s_mov_b32 m0, s71
    v_mfma_f32_32x32x16_bf16 v[16:31], v[92:95], v[184:187], v[16:31]
    buffer_load_dwordx4 v226, s[4:7], s43 offen sc1 lds
    s_waitcnt lgkmcnt(2)
    v_mad_u32_u16 v222, v222, s39, v248 op_sel:[1,0,0,0]
    v_mad_u32_u16 v223, v223, s39, v248 op_sel:[1,0,0,0]
    v_mfma_f32_32x32x16_bf16 v[40:55], v[88:91], v[188:191], v[40:55]
    v_add_u32 v224, s49, v251
    ds_read2_b32 v[224:225], v224 offset0:1 offset1:3
    v_mfma_f32_32x32x16_bf16 v[56:71], v[92:95], v[188:191], v[56:71]
    s_waitcnt vmcnt(3) lgkmcnt(1)
    v_mfma_f32_32x32x8_bf16 v[0:15], v[228:229], v[176:177], v[0:15]
    ds_read_b64_tr_b16 v[184:185], v246 offset:2048
    ds_read_b64_tr_b16 v[186:187], v246 offset:3072
    ds_read_b64_tr_b16 v[188:189], v247 offset:2048
    ds_read_b64_tr_b16 v[190:191], v247 offset:3072
    s_mov_b32 m0, s68
    v_mfma_f32_32x32x8_bf16 v[16:31], v[242:243], v[176:177], v[16:31]
    buffer_load_dwordx4 v222, s[4:7], s44 offen sc1 lds
    buffer_load_dwordx4 v223, s[72:75], s44 offen offset:1024 sc1 lds
    s_waitcnt lgkmcnt(4)
    v_mad_u32_u16 v224, v224, s39, v248 op_sel:[1,0,0,0]
    v_mad_u32_u16 v225, v225, s39, v248 op_sel:[1,0,0,0]
    v_mfma_f32_32x32x8_bf16 v[40:55], v[228:229], v[180:181], v[40:55]
    v_add_u32 v226, s50, v251
    ds_read2_b32 v[226:227], v226 offset0:1 offset1:3
    v_mul_f32 v240, v0, v144
    v_mul_f32 v236, v8, v160
    v_fmac_f32 v240, v1, v145
    v_fmac_f32 v236, v9, v161
    v_fmac_f32 v240, v2, v146
    v_mfma_f32_32x32x8_bf16 v[56:71], v[242:243], v[180:181], v[56:71]
    s_setprio 0
    v_fmac_f32 v236, v10, v162
    v_fmac_f32 v240, v3, v147
    v_fmac_f32 v236, v11, v163
    v_fmac_f32 v240, v4, v148
    v_fmac_f32 v236, v12, v164
    v_fmac_f32 v240, v5, v149
    v_fmac_f32 v236, v13, v165
    v_fmac_f32 v240, v6, v150
    v_fmac_f32 v236, v14, v166
    v_fmac_f32 v240, v7, v151
    v_fmac_f32 v236, v15, v167
    v_mul_f32 v234, v16, v112
    v_mul_f32 v241, v40, v152
    v_mul_f32 v237, v48, v168
    v_fmac_f32 v234, v17, v113
    v_fmac_f32 v241, v41, v153
    v_fmac_f32 v237, v49, v169
    v_fmac_f32 v234, v18, v114
    v_fmac_f32 v241, v42, v154
    v_fmac_f32 v237, v50, v170
    v_fmac_f32 v234, v19, v115
    v_fmac_f32 v241, v43, v155
    v_fmac_f32 v237, v51, v171
    v_fmac_f32 v234, v20, v116
    v_fmac_f32 v241, v44, v156
    v_fmac_f32 v237, v52, v172
    v_fmac_f32 v234, v21, v117
    v_fmac_f32 v241, v45, v157
    v_fmac_f32 v237, v53, v173
    v_fmac_f32 v234, v22, v118
    v_fmac_f32 v241, v46, v158
    v_fmac_f32 v237, v54, v174
    v_fmac_f32 v234, v23, v119
    v_fmac_f32 v241, v47, v159
    v_fmac_f32 v237, v55, v175
    s_setprio 1
    s_waitcnt vmcnt(3) lgkmcnt(1)
    v_mfma_f32_32x32x16_bf16 v[8:23], v[80:83], v[184:187], 0
    ds_read_b64_tr_b16 v[176:177], v246 offset:4096
    ds_read_b64_tr_b16 v[178:179], v246 offset:5120
    ds_read_b64_tr_b16 v[180:181], v247 offset:4096
    ds_read_b64_tr_b16 v[182:183], v247 offset:5120
    v_mul_f32 v235, v56, v120
    v_fmac_f32 v235, v57, v121
    s_mov_b32 m0, s69
    v_mfma_f32_32x32x16_bf16 v[24:39], v[84:87], v[184:187], v[24:39]
    buffer_load_dwordx4 v224, s[4:7], s45 offen sc1 lds
    buffer_load_dwordx4 v225, s[72:75], s45 offen offset:1024 sc1 lds
    s_waitcnt lgkmcnt(4)
    v_mad_u32_u16 v226, v226, s39, v248 op_sel:[1,0,0,0]
    v_mad_u32_u16 v227, v227, s39, v248 op_sel:[1,0,0,0]
    v_fmac_f32 v235, v58, v122
    v_fmac_f32 v235, v59, v123
    v_mfma_f32_32x32x16_bf16 v[64:79], v[84:87], v[188:191], v[64:79]
    v_fmac_f32 v235, v60, v124
    v_fmac_f32 v235, v61, v125
    v_fmac_f32 v235, v62, v126
    v_fmac_f32 v235, v63, v127
    v_mfma_f32_32x32x16_bf16 v[48:63], v[80:83], v[188:191], 0
    v_permlane32_swap_b32 v236, v240
    v_permlane32_swap_b32 v237, v241
    v_add_f32 v236, v236, v240
    v_add_f32 v237, v237, v241
    s_waitcnt vmcnt(4) lgkmcnt(0)
    v_mfma_f32_32x32x16_bf16 v[8:23], v[88:91], v[176:179], v[8:23]
    ds_read_b64_tr_b16 v[184:185], v246 offset:6144
    ds_read_b64_tr_b16 v[188:189], v247 offset:6144
    s_set_gpr_idx_on s31, gpr_idx(DST)
    s_nop 0
    v_cvt_pk_bf16_f32 v196, v236, v237
    s_set_gpr_idx_off
    s_mov_b32 s32, s31
    s_mov_b32 m0, s70
    v_mfma_f32_32x32x16_bf16 v[24:39], v[92:95], v[176:179], v[24:39]
    buffer_load_dwordx4 v226, s[4:7], s46 offen sc1 lds
    buffer_load_dwordx4 v227, s[72:75], s46 offen offset:1024 sc1 lds
    s_sub_u32 s26, s48, s29
    s_mov_b32 s29, s48
    s_mov_b32 s30, s3
    s_bfe_u32 s56, s3, 0x40012
    s_mov_b32 s31, s35
    v_mfma_f32_32x32x16_bf16 v[64:79], v[92:95], v[180:183], v[64:79]
    s_cmp_eq_u32 s34, 0
    s_cselect_b32 s56, s56, 0
    v_mfma_f32_32x32x16_bf16 v[48:63], v[88:91], v[180:183], v[48:63]
    s_waitcnt vmcnt(4) lgkmcnt(0)
    v_mfma_f32_32x32x8_bf16 v[8:23], v[228:229], v[184:185], v[8:23]
    ds_read_b64_tr_b16 v[176:177], v246 offset:0
    ds_read_b64_tr_b16 v[178:179], v246 offset:1024
    ds_read_b64_tr_b16 v[180:181], v247 offset:0
    ds_read_b64_tr_b16 v[182:183], v247 offset:1024
    s_mov_b32 m0, s71
    v_mfma_f32_32x32x8_bf16 v[24:39], v[242:243], v[184:185], v[24:39]
    s_cmp_eq_u32 s33, 4
    s_cbranch_scc1 K2_g4_34
    buffer_load_dwordx4 v224, s[4:7], s47 offen sc1 lds
    buffer_load_dwordx4 v225, s[72:75], s47 offen offset:1024 sc1 lds
K2_back_35:
    v_mfma_f32_32x32x8_bf16 v[64:79], v[242:243], v[188:189], v[64:79]
    s_nop 0
    v_mul_f32 v236, v8, v144
    v_fma_f32 v238, v16, v160, -v238
    v_fmac_f32 v236, v9, v145
    v_fmac_f32 v238, v17, v161
    v_fmac_f32 v236, v10, v146
    v_fmac_f32 v238, v18, v162
    v_fmac_f32 v236, v11, v147
    v_mfma_f32_32x32x8_bf16 v[48:63], v[228:229], v[188:189], v[48:63]
    s_setprio 0
    v_fmac_f32 v238, v19, v163
    v_fmac_f32 v236, v12, v148
    v_fmac_f32 v238, v20, v164
    v_fmac_f32 v236, v13, v149
    v_fmac_f32 v238, v21, v165
    v_fmac_f32 v236, v14, v150
    v_fmac_f32 v238, v22, v166
    v_fmac_f32 v236, v15, v151
    v_fmac_f32 v238, v23, v167
    v_add_u32 v249, s26, v249
    v_add_u32 v250, s26, v250
    v_mul_f32 v240, v24, v160
    v_fma_f32 v234, v32, v112, -v234
    v_fmac_f32 v240, v25, v161
    v_fmac_f32 v234, v33, v113
    v_fmac_f32 v240, v26, v162
    v_fmac_f32 v234, v34, v114
    v_fmac_f32 v240, v27, v163
    v_fmac_f32 v234, v35, v115
    v_fmac_f32 v240, v28, v164
    v_fmac_f32 v234, v36, v116
    v_fmac_f32 v240, v29, v165
    v_fmac_f32 v234, v37, v117
    v_fmac_f32 v240, v30, v166
    v_fmac_f32 v234, v38, v118
    v_fmac_f32 v240, v31, v167
    v_fmac_f32 v234, v39, v119
    ds_read_b64_tr_b16 v[80:81], v249 offset:0
    ds_read_u16_d16_hi v40, v250 offset:0
    v_mul_f32 v241, v64, v168
    v_fma_f32 v235, v72, v120, -v235
    v_fmac_f32 v241, v65, v169
    v_fmac_f32 v235, v73, v121
    v_fmac_f32 v241, v66, v170
    v_fmac_f32 v235, v74, v122
    v_fmac_f32 v241, v67, v171
    v_fmac_f32 v235, v75, v123
    v_fmac_f32 v241, v68, v172
    v_fmac_f32 v235, v76, v124
    v_fmac_f32 v241, v69, v173
    v_fmac_f32 v235, v77, v125
    v_fmac_f32 v241, v70, v174
    v_fmac_f32 v235, v78, v126
    v_fmac_f32 v241, v71, v175
    v_fmac_f32 v235, v79, v127
    ds_read_b64_tr_b16 v[88:89], v249 offset:512
    ds_read_u16_d16_hi v41, v250 offset:128
    v_mul_f32 v237, v48, v152
    v_fma_f32 v239, v56, v168, -v239
    v_fmac_f32 v237, v49, v153
    v_fmac_f32 v239, v57, v169
    v_fmac_f32 v237, v50, v154
    v_fmac_f32 v239, v58, v170
    v_fmac_f32 v237, v51, v155
    v_fmac_f32 v239, v59, v171
    v_fmac_f32 v237, v52, v156
    v_fmac_f32 v239, v60, v172
    v_fmac_f32 v237, v53, v157
    v_fmac_f32 v239, v61, v173
    v_fmac_f32 v237, v54, v158
    v_fmac_f32 v239, v62, v174
    v_fmac_f32 v237, v55, v159
    v_fmac_f32 v239, v63, v175
    s_cmp_eq_u32 s56, 5
    s_cbranch_scc1 K2_U20
    s_cmp_eq_u32 s56, 6
    s_cbranch_scc1 K2_U3h0
    s_branch K2_DSP0
K2_U30:
    s_setprio 0
    ds_read_b64_tr_b16 v[228:229], v249 offset:1024
    ds_read_u16_d16_hi v42, v250 offset:256
    s_waitcnt lgkmcnt(2)
    v_lshlrev_b32 v16, 16, v80
    v_and_b32 v17, 0xffff0000, v80
    v_lshlrev_b32 v18, 16, v81
    v_and_b32 v19, 0xffff0000, v81
    v_mov_b32 v82, v81
    v_mul_f32_dpp v32, v40, v16 row_newbcast:0 row_mask:0xf bank_mask:0xf
    v_mul_f32_dpp v33, v40, v17 row_newbcast:1 row_mask:0xf bank_mask:0xf
    v_mul_f32_dpp v34, v40, v18 row_newbcast:2 row_mask:0xf bank_mask:0xf
    v_mul_f32_dpp v35, v40, v19 row_newbcast:3 row_mask:0xf bank_mask:0xf
    v_mul_f32_dpp v36, v40, v16 row_newbcast:4 row_mask:0xf bank_mask:0xf
    v_mul_f32_dpp v37, v40, v17 row_newbcast:5 row_mask:0xf bank_mask:0xf
    v_mul_f32_dpp v38, v40, v18 row_newbcast:6 row_mask:0xf bank_mask:0xf
    v_mul_f32_dpp v39, v40, v19 row_newbcast:7 row_mask:0xf bank_mask:0xf
    v_cvt_pk_bf16_f32 v81, v32, v33
    v_cvt_pk_bf16_f32 v83, v34, v35
    v_mul_f32_dpp v16, v40, v16 row_newbcast:8 row_mask:0xf bank_mask:0xf
    v_mul_f32_dpp v17, v40, v17 row_newbcast:9 row_mask:0xf bank_mask:0xf
    v_mul_f32_dpp v18, v40, v18 row_newbcast:10 row_mask:0xf bank_mask:0xf
    v_mul_f32_dpp v19, v40, v19 row_newbcast:11 row_mask:0xf bank_mask:0xf
    v_cvt_pk_bf16_f32 v84, v36, v37
    v_cvt_pk_bf16_f32 v86, v38, v39
    v_cvt_pk_bf16_f32 v85, v16, v17
    v_cvt_pk_bf16_f32 v87, v18, v19
    v_permlane16_swap_b32 v80, v81
    v_permlane16_swap_b32 v82, v83
    v_lshlrev_b32 v24, 16, v88
    v_and_b32 v25, 0xffff0000, v88
    v_lshlrev_b32 v26, 16, v89
    v_and_b32 v27, 0xffff0000, v89
    v_mov_b32 v90, v89
    v_permlane16_swap_b32 v84, v85
    v_permlane16_swap_b32 v86, v87
    v_mul_f32_dpp v32, v41, v24 row_newbcast:0 row_mask:0xf bank_mask:0xf
    v_mul_f32_dpp v33, v41, v25 row_newbcast:1 row_mask:0xf bank_mask:0xf
    v_mul_f32_dpp v34, v41, v26 row_newbcast:2 row_mask:0xf bank_mask:0xf
    v_mul_f32_dpp v35, v41, v27 row_newbcast:3 row_mask:0xf bank_mask:0xf
    v_mul_f32_dpp v36, v41, v24 row_newbcast:4 row_mask:0xf bank_mask:0xf
    v_mul_f32_dpp v37, v41, v25 row_newbcast:5 row_mask:0xf bank_mask:0xf
    v_mul_f32_dpp v38, v41, v26 row_newbcast:6 row_mask:0xf bank_mask:0xf
    v_mul_f32_dpp v39, v41, v27 row_newbcast:7 row_mask:0xf bank_mask:0xf
    v_cvt_pk_bf16_f32 v89, v32, v33
    v_cvt_pk_bf16_f32 v91, v34, v35
    v_mul_f32_dpp v24, v41, v24 row_newbcast:8 row_mask:0xf bank_mask:0xf
    v_mul_f32_dpp v25, v41, v25 row_newbcast:9 row_mask:0xf bank_mask:0xf
    v_mul_f32_dpp v26, v41, v26 row_newbcast:10 row_mask:0xf bank_mask:0xf
    v_mul_f32_dpp v27, v41, v27 row_newbcast:11 row_mask:0xf bank_mask:0xf
    v_cvt_pk_bf16_f32 v92, v36, v37
    v_cvt_pk_bf16_f32 v94, v38, v39
    v_cvt_pk_bf16_f32 v93, v24, v25
    v_cvt_pk_bf16_f32 v95, v26, v27
    v_permlane16_swap_b32 v88, v89
    v_permlane16_swap_b32 v90, v91
    s_waitcnt lgkmcnt(0)
    v_lshlrev_b32 v16, 16, v228
    v_and_b32 v17, 0xffff0000, v228
    v_lshlrev_b32 v18, 16, v229
    v_and_b32 v19, 0xffff0000, v229
    v_mov_b32 v230, v229
    v_permlane16_swap_b32 v92, v93
    v_permlane16_swap_b32 v94, v95
    v_mul_f32_dpp v32, v42, v16 row_newbcast:0 row_mask:0xf bank_mask:0xf
    v_mul_f32_dpp v33, v42, v17 row_newbcast:1 row_mask:0xf bank_mask:0xf
    v_mul_f32_dpp v34, v42, v18 row_newbcast:2 row_mask:0xf bank_mask:0xf
    v_mul_f32_dpp v35, v42, v19 row_newbcast:3 row_mask:0xf bank_mask:0xf
    v_mul_f32_dpp v36, v42, v16 row_newbcast:4 row_mask:0xf bank_mask:0xf
    v_mul_f32_dpp v37, v42, v17 row_newbcast:5 row_mask:0xf bank_mask:0xf
    v_mul_f32_dpp v38, v42, v18 row_newbcast:6 row_mask:0xf bank_mask:0xf
    v_mul_f32_dpp v39, v42, v19 row_newbcast:7 row_mask:0xf bank_mask:0xf
    v_cvt_pk_bf16_f32 v229, v32, v33
    v_cvt_pk_bf16_f32 v231, v34, v35
    v_mul_f32_dpp v16, v42, v16 row_newbcast:8 row_mask:0xf bank_mask:0xf
    v_mul_f32_dpp v17, v42, v17 row_newbcast:9 row_mask:0xf bank_mask:0xf
    v_mul_f32_dpp v18, v42, v18 row_newbcast:10 row_mask:0xf bank_mask:0xf
    v_mul_f32_dpp v19, v42, v19 row_newbcast:11 row_mask:0xf bank_mask:0xf
    v_cvt_pk_bf16_f32 v242, v36, v37
    v_cvt_pk_bf16_f32 v244, v38, v39
    v_cvt_pk_bf16_f32 v243, v16, v17
    v_cvt_pk_bf16_f32 v245, v18, v19
    v_permlane16_swap_b32 v228, v229
    v_permlane16_swap_b32 v230, v231
    v_permlane16_swap_b32 v242, v243
    v_permlane16_swap_b32 v244, v245
    s_waitcnt vmcnt(4)
    s_setprio 1
    v_mfma_f32_32x32x16_bf16 v[8:23], v[80:83], v[176:179], 0
    ds_read_b64_tr_b16 v[184:185], v246 offset:2048
    ds_read_b64_tr_b16 v[186:187], v246 offset:3072
    ds_read_b64_tr_b16 v[188:189], v247 offset:2048
    ds_read_b64_tr_b16 v[190:191], v247 offset:3072
    s_mov_b32 m0, s68
    v_mfma_f32_32x32x16_bf16 v[24:39], v[84:87], v[176:179], 0
    buffer_load_dwordx4 v222, s[4:7], s41 offen sc1 lds
    buffer_load_dwordx4 v223, s[72:75], s41 offen offset:1024 sc1 lds
    v_permlane32_swap_b32 v236, v234
    v_permlane32_swap_b32 v237, v235
    s_add_u32 s38, s38, 1
    v_mfma_f32_32x32x16_bf16 v[48:63], v[80:83], v[180:183], 0
    v_permlane32_swap_b32 v240, v238
    v_permlane32_swap_b32 v241, v239
    v_add_f32 v236, v236, v234
    v_add_f32 v237, v237, v235
    v_add_f32 v240, -v240, -v238
    v_mfma_f32_32x32x16_bf16 v[64:79], v[84:87], v[180:183], 0
    v_add_f32 v241, -v241, -v239
    s_set_gpr_idx_on s32, gpr_idx(DST)
    s_nop 0
    v_cvt_pk_bf16_f32 v194, v236, v237
    v_cvt_pk_bf16_f32 v195, v240, v241
    s_set_gpr_idx_off
    v_mov_b32 v254, s52
    s_waitcnt vmcnt(4) lgkmcnt(0)
    v_mfma_f32_32x32x16_bf16 v[8:23], v[88:91], v[184:187], v[8:23]
    ds_read_b64_tr_b16 v[176:177], v246 offset:4096
    ds_read_b64_tr_b16 v[178:179], v246 offset:5120
    ds_read_b64_tr_b16 v[180:181], v247 offset:4096
    ds_read_b64_tr_b16 v[182:183], v247 offset:5120
    v_mov_b32 v255, s38
    s_lshl_b32 s58, s38, 3
    s_mov_b32 m0, s69
    v_mfma_f32_32x32x16_bf16 v[24:39], v[92:95], v[184:187], v[24:39]
    buffer_load_dwordx4 v226, s[4:7], s41 offen sc1 lds
    buffer_load_dwordx4 v227, s[72:75], s41 offen offset:1024 sc1 lds
    s_add_u32 s58, s58, s20
    s_mov_b64 exec, 1
    ds_write_b32 v254, v255
    s_mov_b64 exec, -1
    s_cmp_lt_u32 s58, s22
    s_cbranch_scc0 K2_dyn_40
K2_back_41:
    v_readlane_b32 s3, v253, s58
    s_lshl_b32 s44, s34, 7
    s_and_b32 s48, s3, 0x3ffff
    s_bfe_u32 s33, s3, 0x30013
    s_mul_i32 s35, s38, 6
    s_cmp_eq_u32 s34, 0
    s_cselect_b32 s35, s35, s48
    s_mov_b32 s45, s44
    s_xor_b32 s47, s44, 256
    s_add_u32 s49, s48, 128
    s_add_u32 s60, s48, 256
    s_cmp_eq_u32 s33, 3
    s_cselect_b32 s46, s44, s47
    s_cselect_b32 s50, s60, s48
    s_sub_u32 s60, s33, 2
    s_cmp_lt_u32 s60, 2
    s_cbranch_scc0 K2_rare_46
K2_back_47:
    v_mfma_f32_32x32x16_bf16 v[48:63], v[88:91], v[188:191], v[48:63]
    v_add_u32 v43, s48, v232
    ds_read_b32 v42, v43
    ds_read_b32 v43, v43 offset:1024
    v_mfma_f32_32x32x16_bf16 v[64:79], v[92:95], v[188:191], v[64:79]
    s_waitcnt vmcnt(4) lgkmcnt(3)
    v_mfma_f32_32x32x16_bf16 v[8:23], v[228:231], v[176:179], v[8:23]
    ds_read_b64_tr_b16 v[184:185], v246 offset:6144
    ds_read_b64_tr_b16 v[186:187], v246 offset:7168
    ds_read_b64_tr_b16 v[188:189], v247 offset:6144
    ds_read_b64_tr_b16 v[190:191], v247 offset:7168
    s_mov_b32 m0, s70
    v_mfma_f32_32x32x16_bf16 v[24:39], v[242:245], v[176:179], v[24:39]
    buffer_load_dwordx4 v222, s[4:7], s42 offen sc1 lds
    buffer_load_dwordx4 v223, s[72:75], s42 offen offset:1024 sc1 lds
    v_mfma_f32_32x32x16_bf16 v[48:63], v[228:231], v[180:183], v[48:63]
    s_nop 2
    v_mul_f32 v234, v8, v96
    v_mul_f32 v236, v16, v128
    v_fmac_f32 v234, v9, v97
    v_fmac_f32 v236, v17, v129
    v_fmac_f32 v234, v10, v98
    v_fmac_f32 v236, v18, v130
    v_fmac_f32 v234, v11, v99
    v_mfma_f32_32x32x16_bf16 v[64:79], v[242:245], v[180:183], v[64:79]
    s_setprio 0
    s_waitcnt lgkmcnt(4)
    v_or_b32 v42, v42, v233
    v_or_b32 v43, v43, v233
    s_cmp_lg_u32 s34, 0
    s_cbranch_scc1 K2_dum_51
    s_cmp_eq_u32 s33, 4
    s_cbranch_scc1 K2_a4_52
K2_b4_54:
    s_add_u32 m0, s48, 512
    s_add_u32 s65, s48, 1536
    buffer_load_dwordx4 v42, s[16:19], 0 offen  lds
    s_mov_b32 m0, s65
    s_mov_b32 exec_hi, 0
    buffer_load_dwordx4 v43, s[16:19], 0 offen  lds
    s_mov_b32 exec_hi, -1
K2_back_53:
    v_fmac_f32 v236, v19, v131
    v_fmac_f32 v234, v12, v100
    v_fmac_f32 v236, v20, v132
    v_fmac_f32 v234, v13, v101
    v_fmac_f32 v236, v21, v133
    v_fmac_f32 v234, v14, v102
    v_fmac_f32 v236, v22, v134
    v_fmac_f32 v234, v15, v103
    v_fmac_f32 v236, v23, v135
    v_mul_f32 v238, v24, v128
    v_mul_f32 v240, v32, v128
    v_fmac_f32 v238, v25, v129
    v_fmac_f32 v240, v33, v129
    v_fmac_f32 v238, v26, v130
    v_fmac_f32 v240, v34, v130
    v_fmac_f32 v238, v27, v131
    v_fmac_f32 v240, v35, v131
    v_fmac_f32 v238, v28, v132
    v_fmac_f32 v240, v36, v132
    v_fmac_f32 v238, v29, v133
    v_fmac_f32 v240, v37, v133
    v_fmac_f32 v238, v30, v134
    v_fmac_f32 v240, v38, v134
    v_fmac_f32 v238, v31, v135
    v_fmac_f32 v240, v39, v135
    v_mul_f32 v235, v48, v104
    v_mul_f32 v237, v56, v136
    v_fmac_f32 v235, v49, v105
    v_fmac_f32 v237, v57, v137
    v_fmac_f32 v235, v50, v106
    v_fmac_f32 v237, v58, v138
    v_fmac_f32 v235, v51, v107
    v_fmac_f32 v237, v59, v139
    v_fmac_f32 v235, v52, v108
    v_fmac_f32 v237, v60, v140
    v_fmac_f32 v235, v53, v109
    v_fmac_f32 v237, v61, v141
    v_fmac_f32 v235, v54, v110
    v_fmac_f32 v237, v62, v142
    v_fmac_f32 v235, v55, v111
    v_fmac_f32 v237, v63, v143
    v_mul_f32 v239, v64, v136
    v_mul_f32 v241, v72, v136
    s_setprio 1
    s_waitcnt vmcnt(6) lgkmcnt(0)
    v_mfma_f32_32x32x16_bf16 v[24:39], v[88:91], v[184:187], 0
    ds_read_b64_tr_b16 v[176:177], v246 offset:0
    ds_read_b64_tr_b16 v[178:179], v246 offset:1024
    ds_read_b64_tr_b16 v[180:181], v247 offset:0
    ds_read_b64_tr_b16 v[182:183], v247 offset:1024
    v_fmac_f32 v239, v65, v137
    v_fmac_f32 v241, v73, v137
    s_mov_b32 m0, s71
    v_mfma_f32_32x32x16_bf16 v[8:23], v[92:95], v[184:187], 0
    buffer_load_dwordx4 v224, s[4:7], s42 offen sc1 lds
    buffer_load_dwordx4 v225, s[72:75], s42 offen offset:1024 sc1 lds
    v_fmac_f32 v239, v66, v138
    v_fmac_f32 v241, v74, v138
    v_fmac_f32 v239, v67, v139
    v_fmac_f32 v241, v75, v139
    v_fmac_f32 v239, v68, v140
    v_mfma_f32_32x32x16_bf16 v[48:63], v[92:95], v[188:191], 0
    v_fmac_f32 v241, v76, v140
    v_fmac_f32 v239, v69, v141
    v_fmac_f32 v241, v77, v141
    v_fmac_f32 v239, v70, v142
    v_fmac_f32 v241, v78, v142
    v_fmac_f32 v239, v71, v143
    v_fmac_f32 v241, v79, v143
    v_mfma_f32_32x32x16_bf16 v[64:79], v[88:91], v[188:191], 0
    v_permlane32_swap_b32 v234, v236
    v_permlane32_swap_b32 v235, v237
    v_permlane32_swap_b32 v238, v239
    s_waitcnt vmcnt(6) lgkmcnt(0)
    v_mfma_f32_32x32x16_bf16 v[24:39], v[80:83], v[176:179], v[24:39]
    ds_read_b64_tr_b16 v[184:185], v246 offset:2048
    ds_read_b64_tr_b16 v[186:187], v246 offset:3072
    ds_read_b64_tr_b16 v[188:189], v247 offset:2048
    ds_read_b64_tr_b16 v[190:191], v247 offset:3072
    v_add_f32 v234, v234, v236
    v_add_f32 v235, v235, v237
    s_mov_b32 m0, s68
    v_mfma_f32_32x32x16_bf16 v[8:23], v[84:87], v[176:179], v[8:23]
    buffer_load_dwordx4 v226, s[4:7], s42 offen sc1 lds
    buffer_load_dwordx4 v227, s[72:75], s42 offen offset:1024 sc1 lds
    v_add_f32 v238, -v238, -v239
    s_set_gpr_idx_on s31, gpr_idx(DST)
    s_nop 0
    v_cvt_pk_bf16_f32 v192, v234, v235
    v_cvt_pk_bf16_f32 v197, v238, v238
    s_set_gpr_idx_off
    v_mfma_f32_32x32x16_bf16 v[48:63], v[84:87], v[180:183], v[48:63]
    v_mov_b64 v[0:1], 0
    v_mov_b64 v[2:3], 0
    v_mov_b64 v[4:5], 0
    v_mov_b64 v[6:7], 0
    v_mov_b64 v[40:41], 0
    v_mov_b64 v[42:43], 0
    v_mov_b64 v[44:45], 0
    v_mfma_f32_32x32x16_bf16 v[64:79], v[80:83], v[180:183], v[64:79]
    v_mov_b64 v[46:47], 0
    s_waitcnt vmcnt(6) lgkmcnt(0)
    v_mfma_f32_32x32x16_bf16 v[24:39], v[228:231], v[184:187], v[24:39]
    ds_read_b64_tr_b16 v[176:177], v246 offset:4096
    ds_read_b64_tr_b16 v[178:179], v246 offset:5120
    ds_read_b64_tr_b16 v[180:181], v247 offset:4096
    ds_read_b64_tr_b16 v[182:183], v247 offset:5120
    s_mov_b32 m0, s69
    v_mfma_f32_32x32x16_bf16 v[8:23], v[242:245], v[184:187], v[8:23]
    buffer_load_dwordx4 v222, s[4:7], s43 offen sc1 lds
    buffer_load_dwordx4 v223, s[72:75], s43 offen offset:1024 sc1 lds
    v_mfma_f32_32x32x16_bf16 v[48:63], v[242:245], v[188:191], v[48:63]
    s_nop 2
    v_mul_f32 v234, v24, v144
    v_fmac_f32 v234, v25, v145
    v_fmac_f32 v234, v26, v146
    v_fmac_f32 v234, v27, v147
    v_fmac_f32 v234, v28, v148
    v_fmac_f32 v234, v29, v149
    v_fmac_f32 v234, v30, v150
    v_mfma_f32_32x32x16_bf16 v[64:79], v[228:231], v[188:191], v[64:79]
    s_setprio 0
    v_fmac_f32 v234, v31, v151
    v_mul_f32 v238, v16, v160
    v_mul_f32 v239, v56, v168
    v_fmac_f32 v238, v17, v161
    v_fmac_f32 v239, v57, v169
    v_fmac_f32 v238, v18, v162
    v_fmac_f32 v239, v58, v170
    v_fmac_f32 v238, v19, v163
    v_fmac_f32 v239, v59, v171
    v_fmac_f32 v238, v20, v164
    v_fmac_f32 v239, v60, v172
    v_fmac_f32 v238, v21, v165
    v_fmac_f32 v239, v61, v173
    v_fmac_f32 v238, v22, v166
    v_fmac_f32 v239, v62, v174
    v_fmac_f32 v238, v23, v167
    v_fmac_f32 v239, v63, v175
    s_setprio 1
    s_waitcnt vmcnt(4) lgkmcnt(0)
    v_mfma_f32_32x32x16_bf16 v[0:15], v[80:83], v[176:179], v[0:15]
    ds_read_b64_tr_b16 v[184:185], v246 offset:6144
    ds_read_b64_tr_b16 v[186:187], v246 offset:7168
    ds_read_b64_tr_b16 v[188:189], v247 offset:6144
    ds_read_b64_tr_b16 v[190:191], v247 offset:7168
    v_mul_f32 v235, v64, v152
    v_fmac_f32 v235, v65, v153
    s_mov_b32 m0, s70
    v_mfma_f32_32x32x16_bf16 v[16:31], v[84:87], v[176:179], 0
    buffer_load_dwordx4 v224, s[4:7], s43 offen sc1 lds
    buffer_load_dwordx4 v225, s[72:75], s43 offen offset:1024 sc1 lds
    v_fmac_f32 v235, v66, v154
    v_fmac_f32 v235, v67, v155
    v_fmac_f32 v235, v68, v156
    v_fmac_f32 v235, v69, v157
    v_fmac_f32 v235, v70, v158
    v_mfma_f32_32x32x16_bf16 v[40:55], v[80:83], v[180:183], v[40:55]
    v_add_u32 v222, s48, v251
    ds_read2_b32 v[222:223], v222 offset0:1 offset1:3
    v_fmac_f32 v235, v71, v159
    v_mfma_f32_32x32x16_bf16 v[56:71], v[84:87], v[180:183], 0
    v_permlane32_swap_b32 v234, v240
    v_permlane32_swap_b32 v235, v241
    v_add_f32 v234, v234, v240
    v_add_f32 v235, v235, v241
    s_waitcnt vmcnt(4) lgkmcnt(1)
    v_mfma_f32_32x32x16_bf16 v[0:15], v[88:91], v[184:187], v[0:15]
    ds_read_b64_tr_b16 v[176:177], v246 offset:0
    ds_read_b64_tr_b16 v[178:179], v246 offset:1024
    ds_read_b64_tr_b16 v[180:181], v247 offset:0
    ds_read_b64_tr_b16 v[182:183], v247 offset:1024
    s_mov_b32 m0, s71
    v_mfma_f32_32x32x16_bf16 v[16:31], v[92:95], v[184:187], v[16:31]
    buffer_load_dwordx4 v226, s[4:7], s43 offen sc1 lds
    buffer_load_dwordx4 v227, s[72:75], s43 offen offset:1024 sc1 lds
    s_waitcnt lgkmcnt(4)
    v_mad_u32_u16 v222, v222, s39, v248 op_sel:[1,0,0,0]
    v_mad_u32_u16 v223, v223, s39, v248 op_sel:[1,0,0,0]
    v_mfma_f32_32x32x16_bf16 v[40:55], v[88:91], v[188:191], v[40:55]
    v_add_u32 v224, s49, v251
    ds_read2_b32 v[224:225], v224 offset0:1 offset1:3
    s_set_gpr_idx_on s31, gpr_idx(DST)
    s_nop 0
    v_cvt_pk_bf16_f32 v193, v234, v235
    s_set_gpr_idx_off
    v_mfma_f32_32x32x16_bf16 v[56:71], v[92:95], v[188:191], v[56:71]
    s_waitcnt vmcnt(4) lgkmcnt(1)
    v_mfma_f32_32x32x16_bf16 v[0:15], v[228:231], v[176:179], v[0:15]
    ds_read_b64_tr_b16 v[184:185], v246 offset:2048
    ds_read_b64_tr_b16 v[186:187], v246 offset:3072
    ds_read_b64_tr_b16 v[188:189], v247 offset:2048
    ds_read_b64_tr_b16 v[190:191], v247 offset:3072
    s_mov_b32 m0, s68
    v_mfma_f32_32x32x16_bf16 v[16:31], v[242:245], v[176:179], v[16:31]
    buffer_load_dwordx4 v222, s[4:7], s44 offen sc1 lds
    buffer_load_dwordx4 v223, s[72:75], s44 offen offset:1024 sc1 lds
    s_waitcnt lgkmcnt(4)
    v_mad_u32_u16 v224, v224, s39, v248 op_sel:[1,0,0,0]
    v_mad_u32_u16 v225, v225, s39, v248 op_sel:[1,0,0,0]
    v_mfma_f32_32x32x16_bf16 v[40:55], v[228:231], v[180:183], v[40:55]
    v_add_u32 v226, s50, v251
    ds_read2_b32 v[226:227], v226 offset0:1 offset1:3
    v_mul_f32 v240, v0, v144
    v_mul_f32 v236, v8, v160
    v_fmac_f32 v240, v1, v145
    v_fmac_f32 v236, v9, v161
    v_fmac_f32 v240, v2, v146
    v_mfma_f32_32x32x16_bf16 v[56:71], v[242:245], v[180:183], v[56:71]
    s_setprio 0
    v_fmac_f32 v236, v10, v162
    v_fmac_f32 v240, v3, v147
    v_fmac_f32 v236, v11, v163
    v_fmac_f32 v240, v4, v148
    v_fmac_f32 v236, v12, v164
    v_fmac_f32 v240, v5, v149
    v_fmac_f32 v236, v13, v165
    v_fmac_f32 v240, v6, v150
    v_fmac_f32 v236, v14, v166
    v_fmac_f32 v240, v7, v151
    v_fmac_f32 v236, v15, v167
    v_mul_f32 v234, v16, v112
    v_mul_f32 v241, v40, v152
    v_mul_f32 v237, v48, v168
    v_fmac_f32 v234, v17, v113
    v_fmac_f32 v241, v41, v153
    v_fmac_f32 v237, v49, v169
    v_fmac_f32 v234, v18, v114
    v_fmac_f32 v241, v42, v154
    v_fmac_f32 v237, v50, v170
    v_fmac_f32 v234, v19, v115
    v_fmac_f32 v241, v43, v155
    v_fmac_f32 v237, v51, v171
    v_fmac_f32 v234, v20, v116
    v_fmac_f32 v241, v44, v156
    v_fmac_f32 v237, v52, v172
    v_fmac_f32 v234, v21, v117
    v_fmac_f32 v241, v45, v157
    v_fmac_f32 v237, v53, v173
    v_fmac_f32 v234, v22, v118
    v_fmac_f32 v241, v46, v158
    v_fmac_f32 v237, v54, v174
    v_fmac_f32 v234, v23, v119
    v_fmac_f32 v241, v47, v159
    v_fmac_f32 v237, v55, v175
    s_setprio 1
    s_waitcnt vmcnt(4) lgkmcnt(1)
    v_mfma_f32_32x32x16_bf16 v[8:23], v[80:83], v[184:187], 0
    ds_read_b64_tr_b16 v[176:177], v246 offset:4096
    ds_read_b64_tr_b16 v[178:179], v246 offset:5120
    ds_read_b64_tr_b16 v[180:181], v247 offset:4096
    ds_read_b64_tr_b16 v[182:183], v247 offset:5120
    v_mul_f32 v235, v56, v120
    v_fmac_f32 v235, v57, v121
    s_mov_b32 m0, s69
    v_mfma_f32_32x32x16_bf16 v[24:39], v[84:87], v[184:187], v[24:39]
    buffer_load_dwordx4 v224, s[4:7], s45 offen sc1 lds
    buffer_load_dwordx4 v225, s[72:75], s45 offen offset:1024 sc1 lds
    s_waitcnt lgkmcnt(4)
    v_mad_u32_u16 v226, v226, s39, v248 op_sel:[1,0,0,0]
    v_mad_u32_u16 v227, v227, s39, v248 op_sel:[1,0,0,0]
    v_fmac_f32 v235, v58, v122
    v_fmac_f32 v235, v59, v123
    v_mfma_f32_32x32x16_bf16 v[64:79], v[84:87], v[188:191], v[64:79]
    v_fmac_f32 v235, v60, v124
    v_fmac_f32 v235, v61, v125
    v_fmac_f32 v235, v62, v126
    v_fmac_f32 v235, v63, v127
    v_mfma_f32_32x32x16_bf16 v[48:63], v[80:83], v[188:191], 0
    v_permlane32_swap_b32 v236, v240
    v_permlane32_swap_b32 v237, v241
    v_add_f32 v236, v236, v240
    v_add_f32 v237, v237, v241
    s_waitcnt vmcnt(4) lgkmcnt(0)
    v_mfma_f32_32x32x16_bf16 v[8:23], v[88:91], v[176:179], v[8:23]
    ds_read_b64_tr_b16 v[184:185], v246 offset:6144
    ds_read_b64_tr_b16 v[186:187], v246 offset:7168
    ds_read_b64_tr_b16 v[188:189], v247 offset:6144
    ds_read_b64_tr_b16 v[190:191], v247 offset:7168
    s_mov_b32 m0, s70
    v_mfma_f32_32x32x16_bf16 v[24:39], v[92:95], v[176:179], v[24:39]
    buffer_load_dwordx4 v226, s[4:7], s46 offen sc1 lds
    buffer_load_dwordx4 v227, s[72:75], s46 offen offset:1024 sc1 lds
    s_set_gpr_idx_on s31, gpr_idx(DST)
    s_nop 0
    v_cvt_pk_bf16_f32 v196, v236, v237
    s_set_gpr_idx_off
    s_sub_u32 s26, s48, s29
    s_mov_b32 s29, s48
    v_mfma_f32_32x32x16_bf16 v[64:79], v[92:95], v[180:183], v[64:79]
    s_mov_b32 s30, s3
    s_bfe_u32 s56, s3, 0x40012
    s_cmp_eq_u32 s34, 0
    s_cselect_b32 s56, s56, 0
    s_mov_b32 s32, s31
    s_mov_b32 s31, s35
    v_mfma_f32_32x32x16_bf16 v[48:63], v[88:91], v[180:183], v[48:63]
    s_waitcnt vmcnt(4) lgkmcnt(0)
    v_mfma_f32_32x32x16_bf16 v[8:23], v[228:231], v[184:187], v[8:23]
    ds_read_b64_tr_b16 v[176:177], v246 offset:0
    ds_read_b64_tr_b16 v[178:179], v246 offset:1024
    ds_read_b64_tr_b16 v[180:181], v247 offset:0
    ds_read_b64_tr_b16 v[182:183], v247 offset:1024
    s_mov_b32 m0, s71
    v_mfma_f32_32x32x16_bf16 v[24:39], v[242:245], v[184:187], v[24:39]
    s_cmp_eq_u32 s33, 4
    s_cbranch_scc1 K2_g4_49
    buffer_load_dwordx4 v224, s[4:7], s47 offen sc1 lds
    buffer_load_dwordx4 v225, s[72:75], s47 offen offset:1024 sc1 lds
K2_back_50:
    v_mfma_f32_32x32x16_bf16 v[64:79], v[242:245], v[188:191], v[64:79]
    s_nop 0
    v_mul_f32 v236, v8, v144
    v_fma_f32 v238, v16, v160, -v238
    v_fmac_f32 v236, v9, v145
    v_fmac_f32 v238, v17, v161
    v_fmac_f32 v236, v10, v146
    v_fmac_f32 v238, v18, v162
    v_fmac_f32 v236, v11, v147
    v_mfma_f32_32x32x16_bf16 v[48:63], v[228:231], v[188:191], v[48:63]
    s_setprio 0
    v_fmac_f32 v238, v19, v163
    v_fmac_f32 v236, v12, v148
    v_fmac_f32 v238, v20, v164
    v_fmac_f32 v236, v13, v149
    v_fmac_f32 v238, v21, v165
    v_fmac_f32 v236, v14, v150
    v_fmac_f32 v238, v22, v166
    v_fmac_f32 v236, v15, v151
    v_fmac_f32 v238, v23, v167
    v_add_u32 v249, s26, v249
    v_add_u32 v250, s26, v250
    v_mul_f32 v240, v24, v160
    v_fma_f32 v234, v32, v112, -v234
    v_fmac_f32 v240, v25, v161
    v_fmac_f32 v234, v33, v113
    v_fmac_f32 v240, v26, v162
    v_fmac_f32 v234, v34, v114
    v_fmac_f32 v240, v27, v163
    v_fmac_f32 v234, v35, v115
    v_fmac_f32 v240, v28, v164
    v_fmac_f32 v234, v36, v116
    v_fmac_f32 v240, v29, v165
    v_fmac_f32 v234, v37, v117
    v_fmac_f32 v240, v30, v166
    v_fmac_f32 v234, v38, v118
    v_fmac_f32 v240, v31, v167
    v_fmac_f32 v234, v39, v119
    ds_read_b64_tr_b16 v[80:81], v249 offset:0
    ds_read_u16_d16_hi v40, v250 offset:0
    v_mul_f32 v241, v64, v168
    v_fma_f32 v235, v72, v120, -v235
    v_fmac_f32 v241, v65, v169
    v_fmac_f32 v235, v73, v121
    v_fmac_f32 v241, v66, v170
    v_fmac_f32 v235, v74, v122
    v_fmac_f32 v241, v67, v171
    v_fmac_f32 v235, v75, v123
    v_fmac_f32 v241, v68, v172
    v_fmac_f32 v235, v76, v124
    v_fmac_f32 v241, v69, v173
    v_fmac_f32 v235, v77, v125
    v_fmac_f32 v241, v70, v174
    v_fmac_f32 v235, v78, v126
    v_fmac_f32 v241, v71, v175
    v_fmac_f32 v235, v79, v127
    ds_read_b64_tr_b16 v[88:89], v249 offset:512
    ds_read_u16_d16_hi v41, v250 offset:128
    v_mul_f32 v237, v48, v152
    v_fma_f32 v239, v56, v168, -v239
    v_fmac_f32 v237, v49, v153
    v_fmac_f32 v239, v57, v169
    v_fmac_f32 v237, v50, v154
    v_fmac_f32 v239, v58, v170
    v_fmac_f32 v237, v51, v155
    v_fmac_f32 v239, v59, v171
    v_fmac_f32 v237, v52, v156
    v_fmac_f32 v239, v60, v172
    v_fmac_f32 v237, v53, v157
    v_fmac_f32 v239, v61, v173
    v_fmac_f32 v237, v54, v158
    v_fmac_f32 v239, v62, v174
    v_fmac_f32 v237, v55, v159
    v_fmac_f32 v239, v63, v175
    s_cmp_eq_u32 s56, 5
    s_cbranch_scc1 K2_U20
    s_cmp_eq_u32 s56, 6
    s_cbranch_scc1 K2_U3h0
    s_branch K2_DSP0
K2_PAD_U21:
    s_branch K2_HOP
K2_U21:
    s_setprio 0
    s_waitcnt lgkmcnt(0)
    v_lshlrev_b32 v16, 16, v80
    v_and_b32 v17, 0xffff0000, v80
    v_lshlrev_b32 v18, 16, v81
    v_and_b32 v19, 0xffff0000, v81
    v_mov_b32 v82, v81
    v_mul_f32_dpp v32, v40, v16 row_newbcast:0 row_mask:0xf bank_mask:0xf
    v_mul_f32_dpp v33, v40, v17 row_newbcast:1 row_mask:0xf bank_mask:0xf
    v_mul_f32_dpp v34, v40, v18 row_newbcast:2 row_mask:0xf bank_mask:0xf
    v_mul_f32_dpp v35, v40, v19 row_newbcast:3 row_mask:0xf bank_mask:0xf
    v_mul_f32_dpp v36, v40, v16 row_newbcast:4 row_mask:0xf bank_mask:0xf
    v_mul_f32_dpp v37, v40, v17 row_newbcast:5 row_mask:0xf bank_mask:0xf
    v_mul_f32_dpp v38, v40, v18 row_newbcast:6 row_mask:0xf bank_mask:0xf
    v_mul_f32_dpp v39, v40, v19 row_newbcast:7 row_mask:0xf bank_mask:0xf
    v_cvt_pk_bf16_f32 v81, v32, v33
    v_cvt_pk_bf16_f32 v83, v34, v35
    v_mul_f32_dpp v16, v40, v16 row_newbcast:8 row_mask:0xf bank_mask:0xf
    v_mul_f32_dpp v17, v40, v17 row_newbcast:9 row_mask:0xf bank_mask:0xf
    v_mul_f32_dpp v18, v40, v18 row_newbcast:10 row_mask:0xf bank_mask:0xf
    v_mul_f32_dpp v19, v40, v19 row_newbcast:11 row_mask:0xf bank_mask:0xf
    v_cvt_pk_bf16_f32 v84, v36, v37
    v_cvt_pk_bf16_f32 v86, v38, v39
    v_cvt_pk_bf16_f32 v85, v16, v17
    v_cvt_pk_bf16_f32 v87, v18, v19
    v_permlane16_swap_b32 v80, v81
    v_permlane16_swap_b32 v82, v83
    v_lshlrev_b32 v24, 16, v88
    v_and_b32 v25, 0xffff0000, v88
    v_lshlrev_b32 v26, 16, v89
    v_and_b32 v27, 0xffff0000, v89
    v_mov_b32 v90, v89
    v_permlane16_swap_b32 v84, v85
    v_permlane16_swap_b32 v86, v87
    v_mul_f32_dpp v32, v41, v24 row_newbcast:0 row_mask:0xf bank_mask:0xf
    v_mul_f32_dpp v33, v41, v25 row_newbcast:1 row_mask:0xf bank_mask:0xf
    v_mul_f32_dpp v34, v41, v26 row_newbcast:2 row_mask:0xf bank_mask:0xf
    v_mul_f32_dpp v35, v41, v27 row_newbcast:3 row_mask:0xf bank_mask:0xf
    v_mul_f32_dpp v36, v41, v24 row_newbcast:4 row_mask:0xf bank_mask:0xf
    v_mul_f32_dpp v37, v41, v25 row_newbcast:5 row_mask:0xf bank_mask:0xf
    v_mul_f32_dpp v38, v41, v26 row_newbcast:6 row_mask:0xf bank_mask:0xf
    v_mul_f32_dpp v39, v41, v27 row_newbcast:7 row_mask:0xf bank_mask:0xf
    v_cvt_pk_bf16_f32 v89, v32, v33
    v_cvt_pk_bf16_f32 v91, v34, v35
    v_mul_f32_dpp v24, v41, v24 row_newbcast:8 row_mask:0xf bank_mask:0xf
    v_mul_f32_dpp v25, v41, v25 row_newbcast:9 row_mask:0xf bank_mask:0xf
    v_mul_f32_dpp v26, v41, v26 row_newbcast:10 row_mask:0xf bank_mask:0xf
    v_mul_f32_dpp v27, v41, v27 row_newbcast:11 row_mask:0xf bank_mask:0xf
    v_cvt_pk_bf16_f32 v92, v36, v37
    v_cvt_pk_bf16_f32 v94, v38, v39
    v_cvt_pk_bf16_f32 v93, v24, v25
    v_cvt_pk_bf16_f32 v95, v26, v27
    v_permlane16_swap_b32 v88, v89
    v_permlane16_swap_b32 v90, v91
    v_permlane16_swap_b32 v92, v93
    v_permlane16_swap_b32 v94, v95
    s_waitcnt vmcnt(4)
    s_setprio 1
    v_mfma_f32_32x32x16_bf16 v[8:23], v[80:83], v[176:179], 0
    ds_read_b64_tr_b16 v[184:185], v246 offset:2048
    ds_read_b64_tr_b16 v[186:187], v246 offset:3072
    ds_read_b64_tr_b16 v[188:189], v247 offset:2048
    ds_read_b64_tr_b16 v[190:191], v247 offset:3072
    s_mov_b32 m0, s68
    v_mfma_f32_32x32x16_bf16 v[24:39], v[84:87], v[176:179], 0
    buffer_load_dwordx4 v222, s[4:7], s42 offen sc1 lds
    buffer_load_dwordx4 v223, s[72:75], s42 offen offset:1024 sc1 lds
    v_permlane32_swap_b32 v236, v234
    v_permlane32_swap_b32 v237, v235
    v_mfma_f32_32x32x16_bf16 v[48:63], v[80:83], v[180:183], 0
    v_permlane32_swap_b32 v240, v238
    v_permlane32_swap_b32 v241, v239
    v_add_f32 v236, v236, v234
    v_add_f32 v237, v237, v235
    v_add_f32 v240, -v240, -v238
    v_mfma_f32_32x32x16_bf16 v[64:79], v[84:87], v[180:183], 0
    v_add_f32 v241, -v241, -v239
    v_cvt_pk_bf16_f32 v236, v236, v237
    v_cvt_pk_bf16_f32 v240, v240, v241
    ds_write2st64_b32 v232, v236, v240 offset0:2 offset1:3
    s_mov_b64 exec, 0x1ff
    ds_add_rtn_u32 v42, v254, v251
    s_mov_b64 exec, -1
    s_waitcnt vmcnt(4) lgkmcnt(2)
    v_mfma_f32_32x32x16_bf16 v[8:23], v[88:91], v[184:187], v[8:23]
    ds_read_b64_tr_b16 v[176:177], v246 offset:4096
    ds_read_b64_tr_b16 v[178:179], v246 offset:5120
    ds_read_b64_tr_b16 v[180:181], v247 offset:4096
    ds_read_b64_tr_b16 v[182:183], v247 offset:5120
    s_mov_b32 m0, s69
    v_mfma_f32_32x32x16_bf16 v[24:39], v[92:95], v[184:187], v[24:39]
    buffer_load_dwordx4 v224, s[4:7], s42 offen sc1 lds
    buffer_load_dwordx4 v225, s[72:75], s42 offen offset:1024 sc1 lds
    s_waitcnt lgkmcnt(4)
    v_readlane_b32 s58, v42, 8
    v_mfma_f32_32x32x16_bf16 v[48:63], v[88:91], v[188:191], v[48:63]
    s_lshr_b32 s58, s58, 4
    s_cmp_lt_u32 s58, s22
    s_cbranch_scc0 K2_nul_55
    v_readlane_b32 s3, v253, s58
    s_nop 0
    s_bfe_u32 s58, s3, 0x60016
    s_and_b32 s59, s58, 7
    s_lshr_b32 s60, s58, 3
K2_chk_57:
    v_readlane_b32 s61, v42, s59
    s_nop 0
    s_cmp_gt_u32 s61, s60
    s_cbranch_scc0 K2_spin_56
K2_back_58:
    v_mfma_f32_32x32x16_bf16 v[64:79], v[92:95], v[188:191], v[64:79]
    s_setprio 0
    s_lshl_b32 s44, s34, 7
    s_and_b32 s48, s3, 0x3ffff
    s_bfe_u32 s33, s3, 0x30013
    s_mov_b32 s35, s48
    s_mov_b32 s45, s44
    s_xor_b32 s47, s44, 256
    v_mul_f32 v234, v8, v96
    v_mul_f32 v236, v16, v128
    v_fmac_f32 v234, v9, v97
    v_fmac_f32 v236, v17, v129
    v_fmac_f32 v234, v10, v98
    v_fmac_f32 v236, v18, v130
    v_fmac_f32 v234, v11, v99
    v_fmac_f32 v236, v19, v131
    v_fmac_f32 v234, v12, v100
    v_fmac_f32 v236, v20, v132
    v_fmac_f32 v234, v13, v101
    v_fmac_f32 v236, v21, v133
    v_fmac_f32 v234, v14, v102
    v_fmac_f32 v236, v22, v134
    v_fmac_f32 v234, v15, v103
    v_fmac_f32 v236, v23, v135
    v_mul_f32 v238, v24, v128
    v_mul_f32 v240, v32, v128
    v_fmac_f32 v238, v25, v129
    v_fmac_f32 v240, v33, v129
    v_fmac_f32 v238, v26, v130
    v_fmac_f32 v240, v34, v130
    v_fmac_f32 v238, v27, v131
    v_fmac_f32 v240, v35, v131
    v_fmac_f32 v238, v28, v132
    v_fmac_f32 v240, v36, v132
    v_fmac_f32 v238, v29, v133
    v_fmac_f32 v240, v37, v133
    v_fmac_f32 v238, v30, v134
    v_fmac_f32 v240, v38, v134
    v_fmac_f32 v238, v31, v135
    v_fmac_f32 v240, v39, v135
    v_mul_f32 v235, v48, v104
    v_mul_f32 v237, v56, v136
    v_fmac_f32 v235, v49, v105
    v_fmac_f32 v237, v57, v137
    v_fmac_f32 v235, v50, v106
    v_fmac_f32 v237, v58, v138
    v_fmac_f32 v235, v51, v107
    v_fmac_f32 v237, v59, v139
    v_fmac_f32 v235, v52, v108
    v_fmac_f32 v237, v60, v140
    v_fmac_f32 v235, v53, v109
    v_fmac_f32 v237, v61, v141
    v_fmac_f32 v235, v54, v110
    v_fmac_f32 v237, v62, v142
    v_fmac_f32 v235, v55, v111
    v_fmac_f32 v237, v63, v143
    v_mul_f32 v239, v64, v136
    v_mul_f32 v241, v72, v136
    v_fmac_f32 v239, v65, v137
    v_fmac_f32 v241, v73, v137
    s_setprio 1
    s_waitcnt vmcnt(4) lgkmcnt(0)
    v_mfma_f32_32x32x16_bf16 v[24:39], v[80:83], v[176:179], 0
    ds_read_b64_tr_b16 v[184:185], v246 offset:6144
    ds_read_b64_tr_b16 v[186:187], v246 offset:7168
    ds_read_b64_tr_b16 v[188:189], v247 offset:6144
    ds_read_b64_tr_b16 v[190:191], v247 offset:7168
    v_fmac_f32 v239, v66, v138
    v_fmac_f32 v241, v74, v138
    s_mov_b32 m0, s70
    v_mfma_f32_32x32x16_bf16 v[8:23], v[84:87], v[176:179], 0
    buffer_load_dwordx4 v222, s[4:7], s43 offen sc1 lds
    buffer_load_dwordx4 v223, s[72:75], s43 offen offset:1024 sc1 lds
    v_fmac_f32 v239, v67, v139
    v_fmac_f32 v241, v75, v139
    v_fmac_f32 v239, v68, v140
    v_fmac_f32 v241, v76, v140
    v_fmac_f32 v239, v69, v141
    v_mfma_f32_32x32x16_bf16 v[48:63], v[84:87], v[180:183], 0
    s_add_u32 s49, s48, 128
    s_add_u32 s60, s48, 256
    s_cmp_eq_u32 s33, 3
    s_cselect_b32 s46, s44, s47
    s_cselect_b32 s50, s60, s48
    s_sub_u32 s60, s33, 2
    s_cmp_lt_u32 s60, 2
    s_cbranch_scc0 K2_rare_59
K2_back_60:
    v_add_u32 v222, s48, v251
    ds_read2_b32 v[222:223], v222 offset0:1 offset1:3
    v_fmac_f32 v241, v77, v141
    v_fmac_f32 v239, v70, v142
    v_fmac_f32 v241, v78, v142
    v_fmac_f32 v239, v71, v143
    v_fmac_f32 v241, v79, v143
    v_mfma_f32_32x32x16_bf16 v[64:79], v[80:83], v[180:183], 0
    v_permlane32_swap_b32 v234, v236
    v_permlane32_swap_b32 v235, v237
    v_permlane32_swap_b32 v238, v239
    s_waitcnt vmcnt(4) lgkmcnt(1)
    v_mfma_f32_32x32x16_bf16 v[24:39], v[88:91], v[184:187], v[24:39]
    ds_read_b64_tr_b16 v[176:177], v246 offset:0
    ds_read_b64_tr_b16 v[178:179], v246 offset:1024
    ds_read_b64_tr_b16 v[180:181], v247 offset:0
    ds_read_b64_tr_b16 v[182:183], v247 offset:1024
    v_lshl_add_u32 v232, v252, 1, s31
    v_add_f32 v234, v234, v236
    s_mov_b32 m0, s71
    v_mfma_f32_32x32x16_bf16 v[8:23], v[92:95], v[184:187], v[8:23]
    buffer_load_dwordx4 v224, s[4:7], s43 offen sc1 lds
    buffer_load_dwordx4 v225, s[72:75], s43 offen offset:1024 sc1 lds
    s_waitcnt lgkmcnt(4)
    v_mad_u32_u16 v222, v222, s39, v248 op_sel:[1,0,0,0]
    v_mad_u32_u16 v223, v223, s39, v248 op_sel:[1,0,0,0]
    v_add_f32 v235, v235, v237
    v_add_f32 v238, -v238, -v239
    v_sub_u32 v239, v232, v233
    v_cvt_pk_bf16_f32 v234, v234, v235
    v_cvt_pk_bf16_f32 v238, v238, v238
    ds_write_b32 v232, v234 offset:0
    ds_write_b16 v239, v238 offset:1280
    v_mfma_f32_32x32x16_bf16 v[48:63], v[92:95], v[188:191], v[48:63]
    v_add_u32 v224, s49, v251
    ds_read2_b32 v[224:225], v224 offset0:1 offset1:3
    v_mov_b64 v[0:1], 0
    v_mov_b64 v[2:3], 0
    v_mov_b64 v[4:5], 0
    v_mov_b64 v[6:7], 0
    v_mov_b64 v[40:41], 0
    v_mov_b64 v[42:43], 0
    v_mov_b64 v[44:45], 0
    v_mov_b64 v[46:47], 0
    v_mfma_f32_32x32x16_bf16 v[64:79], v[88:91], v[188:191], v[64:79]
    s_setprio 0
    v_mul_f32 v234, v24, v144
    v_fmac_f32 v234, v25, v145
    v_fmac_f32 v234, v26, v146
    v_fmac_f32 v234, v27, v147
    v_fmac_f32 v234, v28, v148
    v_fmac_f32 v234, v29, v149
    v_fmac_f32 v234, v30, v150
    v_fmac_f32 v234, v31, v151
    v_mul_f32 v238, v16, v160
    v_mul_f32 v239, v56, v168
    v_fmac_f32 v238, v17, v161
    v_fmac_f32 v239, v57, v169
    v_fmac_f32 v238, v18, v162
    v_fmac_f32 v239, v58, v170
    v_fmac_f32 v238, v19, v163
    v_fmac_f32 v239, v59, v171
    v_fmac_f32 v238, v20, v164
    v_fmac_f32 v239, v60, v172
    v_fmac_f32 v238, v21, v165
    v_fmac_f32 v239, v61, v173
    v_fmac_f32 v238, v22, v166
    v_fmac_f32 v239, v62, v174
    v_fmac_f32 v238, v23, v167
    v_fmac_f32 v239, v63, v175
    s_setprio 1
    s_waitcnt vmcnt(4) lgkmcnt(3)
    v_mfma_f32_32x32x16_bf16 v[0:15], v[80:83], v[176:179], v[0:15]
    ds_read_b64_tr_b16 v[184:185], v246 offset:2048
    ds_read_b64_tr_b16 v[186:187], v246 offset:3072
    ds_read_b64_tr_b16 v[188:189], v247 offset:2048
    ds_read_b64_tr_b16 v[190:191], v247 offset:3072
    v_mul_f32 v235, v64, v152
    v_fmac_f32 v235, v65, v153
    s_mov_b32 m0, s68
    v_mfma_f32_32x32x16_bf16 v[16:31], v[84:87], v[176:179], 0
    buffer_load_dwordx4 v222, s[4:7], s44 offen sc1 lds
    buffer_load_dwordx4 v223, s[72:75], s44 offen offset:1024 sc1 lds
    s_waitcnt lgkmcnt(4)
    v_mad_u32_u16 v224, v224, s39, v248 op_sel:[1,0,0,0]
    v_mad_u32_u16 v225, v225, s39, v248 op_sel:[1,0,0,0]
    v_fmac_f32 v235, v66, v154
    v_fmac_f32 v235, v67, v155
    v_mfma_f32_32x32x16_bf16 v[40:55], v[80:83], v[180:183], v[40:55]
    v_add_u32 v226, s50, v251
    ds_read2_b32 v[226:227], v226 offset0:1 offset1:3
    v_fmac_f32 v235, v68, v156
    v_fmac_f32 v235, v69, v157
    v_fmac_f32 v235, v70, v158
    v_fmac_f32 v235, v71, v159
    v_mfma_f32_32x32x16_bf16 v[56:71], v[84:87], v[180:183], 0
    v_permlane32_swap_b32 v234, v240
    v_permlane32_swap_b32 v235, v241
    v_add_f32 v234, v234, v240
    v_add_f32 v235, v235, v241
    s_waitcnt vmcnt(4) lgkmcnt(1)
    v_mfma_f32_32x32x16_bf16 v[0:15], v[88:91], v[184:187], v[0:15]
    ds_read_b64_tr_b16 v[176:177], v246 offset:4096
    ds_read_b64_tr_b16 v[178:179], v246 offset:5120
    ds_read_b64_tr_b16 v[180:181], v247 offset:4096
    ds_read_b64_tr_b16 v[182:183], v247 offset:5120
    v_cvt_pk_bf16_f32 v234, v234, v235
    ds_write_b32 v232, v234 offset:256
    s_mov_b32 m0, s69
    v_mfma_f32_32x32x16_bf16 v[16:31], v[92:95], v[184:187], v[16:31]
    buffer_load_dwordx4 v224, s[4:7], s45 offen sc1 lds
    buffer_load_dwordx4 v225, s[72:75], s45 offen offset:1024 sc1 lds
    s_waitcnt lgkmcnt(5)
    v_mad_u32_u16 v226, v226, s39, v248 op_sel:[1,0,0,0]
    v_mad_u32_u16 v227, v227, s39, v248 op_sel:[1,0,0,0]
    v_mfma_f32_32x32x16_bf16 v[40:55], v[88:91], v[188:191], v[40:55]
    v_mul_f32 v240, v0, v144
    v_mul_f32 v236, v8, v160
    v_fmac_f32 v240, v1, v145
    v_fmac_f32 v236, v9, v161
    v_fmac_f32 v240, v2, v146
    v_fmac_f32 v236, v10, v162
    v_fmac_f32 v240, v3, v147
    v_mfma_f32_32x32x16_bf16 v[56:71], v[92:95], v[188:191], v[56:71]
    s_setprio 0
    v_fmac_f32 v236, v11, v163
    v_fmac_f32 v240, v4, v148
    v_fmac_f32 v236, v12, v164
    v_fmac_f32 v240, v5, v149
    v_fmac_f32 v236, v13, v165
    v_fmac_f32 v240, v6, v150
    v_fmac_f32 v236, v14, v166
    v_fmac_f32 v240, v7, v151
    v_fmac_f32 v236, v15, v167
    v_mul_f32 v234, v16, v112
    v_mul_f32 v241, v40, v152
    v_mul_f32 v237, v48, v168
    v_fmac_f32 v234, v17, v113
    v_fmac_f32 v241, v41, v153
    v_fmac_f32 v237, v49, v169
    v_fmac_f32 v234, v18, v114
    v_fmac_f32 v241, v42, v154
    v_fmac_f32 v237, v50, v170
    v_fmac_f32 v234, v19, v115
    v_fmac_f32 v241, v43, v155
    v_fmac_f32 v237, v51, v171
    v_fmac_f32 v234, v20, v116
    v_fmac_f32 v241, v44, v156
    v_fmac_f32 v237, v52, v172
    v_fmac_f32 v234, v21, v117
    v_fmac_f32 v241, v45, v157
    v_fmac_f32 v237, v53, v173
    v_fmac_f32 v234, v22, v118
    v_fmac_f32 v241, v46, v158
    v_fmac_f32 v237, v54, v174
    v_fmac_f32 v234, v23, v119
    v_fmac_f32 v241, v47, v159
    v_fmac_f32 v237, v55, v175
    s_setprio 1
    s_waitcnt vmcnt(4) lgkmcnt(1)
    v_mfma_f32_32x32x16_bf16 v[8:23], v[80:83], v[176:179], 0
    ds_read_b64_tr_b16 v[184:185], v246 offset:6144
    ds_read_b64_tr_b16 v[186:187], v246 offset:7168
    ds_read_b64_tr_b16 v[188:189], v247 offset:6144
    ds_read_b64_tr_b16 v[190:191], v247 offset:7168
    v_mul_f32 v235, v56, v120
    v_fmac_f32 v235, v57, v121
    s_mov_b32 m0, s70
    v_mfma_f32_32x32x16_bf16 v[24:39], v[84:87], v[176:179], v[24:39]
    buffer_load_dwordx4 v226, s[4:7], s46 offen sc1 lds
    buffer_load_dwordx4 v227, s[72:75], s46 offen offset:1024 sc1 lds
    v_fmac_f32 v235, v58, v122
    v_fmac_f32 v235, v59, v123
    v_fmac_f32 v235, v60, v124
    v_fmac_f32 v235, v61, v125
    v_fmac_f32 v235, v62, v126
    v_mfma_f32_32x32x16_bf16 v[64:79], v[84:87], v[180:183], v[64:79]
    v_fmac_f32 v235, v63, v127
    s_sub_u32 s26, s48, s29
    s_mov_b32 s29, s48
    s_mov_b32 s30, s3
    s_bfe_u32 s56, s3, 0x40012
    s_cmp_lg_u32 s36, 0
    s_cselect_b32 s56, s56, 0
    v_mfma_f32_32x32x16_bf16 v[48:63], v[80:83], v[180:183], 0
    v_permlane32_swap_b32 v236, v240
    v_permlane32_swap_b32 v237, v241
    v_add_f32 v236, v236, v240
    v_add_f32 v237, v237, v241
    s_waitcnt vmcnt(4) lgkmcnt(0)
    v_mfma_f32_32x32x16_bf16 v[8:23], v[88:91], v[184:187], v[8:23]
    ds_read_b64_tr_b16 v[176:177], v246 offset:0
    ds_read_b64_tr_b16 v[178:179], v246 offset:1024
    ds_read_b64_tr_b16 v[180:181], v247 offset:0
    ds_read_b64_tr_b16 v[182:183], v247 offset:1024
    v_cvt_pk_bf16_f32 v236, v236, v237
    ds_write_b32 v232, v236 offset:1024
    s_mov_b32 m0, s71
    v_mfma_f32_32x32x16_bf16 v[24:39], v[92:95], v[184:187], v[24:39]
    s_cmp_eq_u32 s33, 4
    s_cbranch_scc1 K2_g4_62
    buffer_load_dwordx4 v224, s[4:7], s47 offen sc1 lds
    buffer_load_dwordx4 v225, s[72:75], s47 offen offset:1024 sc1 lds
K2_back_63:
    s_mov_b32 s32, s31
    s_mov_b32 s31, s35
    v_mfma_f32_32x32x16_bf16 v[64:79], v[92:95], v[188:191], v[64:79]
    v_mul_f32 v236, v8, v144
    v_fma_f32 v238, v16, v160, -v238
    v_fmac_f32 v236, v9, v145
    v_fmac_f32 v238, v17, v161
    v_fmac_f32 v236, v10, v146
    v_fmac_f32 v238, v18, v162
    v_fmac_f32 v236, v11, v147
    v_mfma_f32_32x32x16_bf16 v[48:63], v[88:91], v[188:191], v[48:63]
    s_setprio 0
    v_fmac_f32 v238, v19, v163
    v_fmac_f32 v236, v12, v148
    v_fmac_f32 v238, v20, v164
    v_fmac_f32 v236, v13, v149
    v_fmac_f32 v238, v21, v165
    v_fmac_f32 v236, v14, v150
    v_fmac_f32 v238, v22, v166
    v_fmac_f32 v236, v15, v151
    v_fmac_f32 v238, v23, v167
    v_add_u32 v249, s26, v249
    v_add_u32 v250, s26, v250
    v_mul_f32 v240, v24, v160
    v_fma_f32 v234, v32, v112, -v234
    v_fmac_f32 v240, v25, v161
    v_fmac_f32 v234, v33, v113
    v_fmac_f32 v240, v26, v162
    v_fmac_f32 v234, v34, v114
    v_fmac_f32 v240, v27, v163
    v_fmac_f32 v234, v35, v115
    v_fmac_f32 v240, v28, v164
    v_fmac_f32 v234, v36, v116
    v_fmac_f32 v240, v29, v165
    v_fmac_f32 v234, v37, v117
    v_fmac_f32 v240, v30, v166
    v_fmac_f32 v234, v38, v118
    v_fmac_f32 v240, v31, v167
    v_fmac_f32 v234, v39, v119
    ds_read_b64_tr_b16 v[80:81], v249 offset:0
    ds_read_u16_d16_hi v40, v250 offset:0
    v_mul_f32 v241, v64, v168
    v_fma_f32 v235, v72, v120, -v235
    v_fmac_f32 v241, v65, v169
    v_fmac_f32 v235, v73, v121
    v_fmac_f32 v241, v66, v170
    v_fmac_f32 v235, v74, v122
    v_fmac_f32 v241, v67, v171
    v_fmac_f32 v235, v75, v123
    v_fmac_f32 v241, v68, v172
    v_fmac_f32 v235, v76, v124
    v_fmac_f32 v241, v69, v173
    v_fmac_f32 v235, v77, v125
    v_fmac_f32 v241, v70, v174
    v_fmac_f32 v235, v78, v126
    v_fmac_f32 v241, v71, v175
    v_fmac_f32 v235, v79, v127
    ds_read_b64_tr_b16 v[88:89], v249 offset:512
    ds_read_u16_d16_hi v41, v250 offset:128
    v_mul_f32 v237, v48, v152
    v_fma_f32 v239, v56, v168, -v239
    v_fmac_f32 v237, v49, v153
    v_fmac_f32 v239, v57, v169
    v_fmac_f32 v237, v50, v154
    v_fmac_f32 v239, v58, v170
    v_fmac_f32 v237, v51, v155
    v_fmac_f32 v239, v59, v171
    v_fmac_f32 v237, v52, v156
    v_fmac_f32 v239, v60, v172
    v_fmac_f32 v237, v53, v157
    v_fmac_f32 v239, v61, v173
    v_fmac_f32 v237, v54, v158
    v_fmac_f32 v239, v62, v174
    v_fmac_f32 v237, v55, v159
    v_fmac_f32 v239, v63, v175
    s_cmp_eq_u32 s56, 5
    s_cbranch_scc1 K2_U21
    s_cmp_eq_u32 s56, 6
    s_cbranch_scc1 K2_U3h1
    s_branch K2_DSP1
K2_PAD_U31:
    s_branch K2_HOP
K2_U3h1:
    s_setprio 0
    ds_read_b64_tr_b16 v[228:229], v249 offset:1024
    ds_read_u16_d16_hi v42, v250 offset:256
    s_waitcnt lgkmcnt(2)
    v_lshlrev_b32 v16, 16, v80
    v_and_b32 v17, 0xffff0000, v80
    v_lshlrev_b32 v18, 16, v81
    v_and_b32 v19, 0xffff0000, v81
    v_mov_b32 v82, v81
    v_mul_f32_dpp v32, v40, v16 row_newbcast:0 row_mask:0xf bank_mask:0xf
    v_mul_f32_dpp v33, v40, v17 row_newbcast:1 row_mask:0xf bank_mask:0xf
    v_mul_f32_dpp v34, v40, v18 row_newbcast:2 row_mask:0xf bank_mask:0xf
    v_mul_f32_dpp v35, v40, v19 row_newbcast:3 row_mask:0xf bank_mask:0xf
    v_mul_f32_dpp v36, v40, v16 row_newbcast:4 row_mask:0xf bank_mask:0xf
    v_mul_f32_dpp v37, v40, v17 row_newbcast:5 row_mask:0xf bank_mask:0xf
    v_mul_f32_dpp v38, v40, v18 row_newbcast:6 row_mask:0xf bank_mask:0xf
    v_mul_f32_dpp v39, v40, v19 row_newbcast:7 row_mask:0xf bank_mask:0xf
    v_cvt_pk_bf16_f32 v81, v32, v33
    v_cvt_pk_bf16_f32 v83, v34, v35
    v_mul_f32_dpp v16, v40, v16 row_newbcast:8 row_mask:0xf bank_mask:0xf
    v_mul_f32_dpp v17, v40, v17 row_newbcast:9 row_mask:0xf bank_mask:0xf
    v_mul_f32_dpp v18, v40, v18 row_newbcast:10 row_mask:0xf bank_mask:0xf
    v_mul_f32_dpp v19, v40, v19 row_newbcast:11 row_mask:0xf bank_mask:0xf
    v_cvt_pk_bf16_f32 v84, v36, v37
    v_cvt_pk_bf16_f32 v86, v38, v39
    v_cvt_pk_bf16_f32 v85, v16, v17
    v_cvt_pk_bf16_f32 v87, v18, v19
    v_permlane16_swap_b32 v80, v81
    v_permlane16_swap_b32 v82, v83
    v_lshlrev_b32 v24, 16, v88
    v_and_b32 v25, 0xffff0000, v88
    v_lshlrev_b32 v26, 16, v89
    v_and_b32 v27, 0xffff0000, v89
    v_mov_b32 v90, v89
    v_permlane16_swap_b32 v84, v85
    v_permlane16_swap_b32 v86, v87
    v_mul_f32_dpp v32, v41, v24 row_newbcast:0 row_mask:0xf bank_mask:0xf
    v_mul_f32_dpp v33, v41, v25 row_newbcast:1 row_mask:0xf bank_mask:0xf
    v_mul_f32_dpp v34, v41, v26 row_newbcast:2 row_mask:0xf bank_mask:0xf
    v_mul_f32_dpp v35, v41, v27 row_newbcast:3 row_mask:0xf bank_mask:0xf
    v_mul_f32_dpp v36, v41, v24 row_newbcast:4 row_mask:0xf bank_mask:0xf
    v_mul_f32_dpp v37, v41, v25 row_newbcast:5 row_mask:0xf bank_mask:0xf
    v_mul_f32_dpp v38, v41, v26 row_newbcast:6 row_mask:0xf bank_mask:0xf
    v_mul_f32_dpp v39, v41, v27 row_newbcast:7 row_mask:0xf bank_mask:0xf
    v_cvt_pk_bf16_f32 v89, v32, v33
    v_cvt_pk_bf16_f32 v91, v34, v35
    v_mul_f32_dpp v24, v41, v24 row_newbcast:8 row_mask:0xf bank_mask:0xf
    v_mul_f32_dpp v25, v41, v25 row_newbcast:9 row_mask:0xf bank_mask:0xf
    v_mul_f32_dpp v26, v41, v26 row_newbcast:10 row_mask:0xf bank_mask:0xf
    v_mul_f32_dpp v27, v41, v27 row_newbcast:11 row_mask:0xf bank_mask:0xf
    v_cvt_pk_bf16_f32 v92, v36, v37
    v_cvt_pk_bf16_f32 v94, v38, v39
    v_cvt_pk_bf16_f32 v93, v24, v25
    v_cvt_pk_bf16_f32 v95, v26, v27
    v_permlane16_swap_b32 v88, v89
    v_permlane16_swap_b32 v90, v91
    s_waitcnt lgkmcnt(0)
    v_lshlrev_b32 v16, 16, v228
    v_and_b32 v17, 0xffff0000, v228
    v_permlane16_swap_b32 v92, v93
    v_permlane16_swap_b32 v94, v95
    v_mul_f32_dpp v32, v42, v16 row_newbcast:0 row_mask:0xf bank_mask:0xf
    v_mul_f32_dpp v33, v42, v17 row_newbcast:1 row_mask:0xf bank_mask:0xf
    v_mul_f32_dpp v36, v42, v16 row_newbcast:4 row_mask:0xf bank_mask:0xf
    v_mul_f32_dpp v37, v42, v17 row_newbcast:5 row_mask:0xf bank_mask:0xf
    v_cvt_pk_bf16_f32 v229, v32, v33
    v_mul_f32_dpp v16, v42, v16 row_newbcast:8 row_mask:0xf bank_mask:0xf
    v_mul_f32_dpp v17, v42, v17 row_newbcast:9 row_mask:0xf bank_mask:0xf
    v_cvt_pk_bf16_f32 v242, v36, v37
    v_cvt_pk_bf16_f32 v243, v16, v17
    v_permlane16_swap_b32 v228, v229
    s_nop 0
    v_permlane16_swap_b32 v242, v243
    s_waitcnt vmcnt(4)
    s_setprio 1
    v_mfma_f32_32x32x16_bf16 v[8:23], v[80:83], v[176:179], 0
    ds_read_b64_tr_b16 v[184:185], v246 offset:2048
    ds_read_b64_tr_b16 v[186:187], v246 offset:3072
    ds_read_b64_tr_b16 v[188:189], v247 offset:2048
    ds_read_b64_tr_b16 v[190:191], v247 offset:3072
    s_mov_b32 m0, s68
    v_mfma_f32_32x32x16_bf16 v[24:39], v[84:87], v[176:179], 0
    buffer_load_dwordx4 v222, s[4:7], s41 offen sc1 lds
    buffer_load_dwordx4 v223, s[72:75], s41 offen offset:1024 sc1 lds
    v_permlane32_swap_b32 v236, v234
    v_permlane32_swap_b32 v237, v235
    v_mfma_f32_32x32x16_bf16 v[48:63], v[80:83], v[180:183], 0
    v_permlane32_swap_b32 v240, v238
    v_permlane32_swap_b32 v241, v239
    v_add_f32 v236, v236, v234
    v_add_f32 v237, v237, v235
    v_add_f32 v240, -v240, -v238
    v_mfma_f32_32x32x16_bf16 v[64:79], v[84:87], v[180:183], 0
    v_add_f32 v241, -v241, -v239
    v_cvt_pk_bf16_f32 v236, v236, v237
    v_cvt_pk_bf16_f32 v240, v240, v241
    ds_write2st64_b32 v232, v236, v240 offset0:2 offset1:3
    s_mov_b64 exec, 0x1ff
    ds_add_rtn_u32 v42, v254, v251
    s_mov_b64 exec, -1
    s_waitcnt vmcnt(4) lgkmcnt(2)
    v_mfma_f32_32x32x16_bf16 v[8:23], v[88:91], v[184:187], v[8:23]
    ds_read_b64_tr_b16 v[176:177], v246 offset:4096
    ds_read_b64_tr_b16 v[180:181], v247 offset:4096
    s_mov_b32 m0, s69
    v_mfma_f32_32x32x16_bf16 v[24:39], v[92:95], v[184:187], v[24:39]
    buffer_load_dwordx4 v226, s[4:7], s41 offen sc1 lds
    s_waitcnt lgkmcnt(2)
    v_readlane_b32 s58, v42, 8
    v_mfma_f32_32x32x16_bf16 v[48:63], v[88:91], v[188:191], v[48:63]
    s_lshr_b32 s58, s58, 4
    s_cmp_lt_u32 s58, s22
    s_cbranch_scc0 K2_nul_64
    v_readlane_b32 s3, v253, s58
    s_nop 0
    s_bfe_u32 s58, s3, 0x60016
    s_and_b32 s59, s58, 7
    s_lshr_b32 s60, s58, 3
K2_chk_66:
    v_readlane_b32 s61, v42, s59
    s_nop 0
    s_cmp_gt_u32 s61, s60
    s_cbranch_scc0 K2_spin_65
K2_back_67:
    v_mfma_f32_32x32x16_bf16 v[64:79], v[92:95], v[188:191], v[64:79]
    s_lshl_b32 s44, s34, 7
    s_and_b32 s48, s3, 0x3ffff
    s_bfe_u32 s33, s3, 0x30013
    s_mov_b32 s35, s48
    s_mov_b32 s45, s44
    s_xor_b32 s47, s44, 256
    s_waitcnt vmcnt(3) lgkmcnt(0)
    v_mfma_f32_32x32x8_bf16 v[8:23], v[228:229], v[176:177], v[8:23]
    ds_read_b64_tr_b16 v[184:185], v246 offset:6144
    ds_read_b64_tr_b16 v[186:187], v246 offset:7168
    ds_read_b64_tr_b16 v[188:189], v247 offset:6144
    ds_read_b64_tr_b16 v[190:191], v247 offset:7168
    s_add_u32 s49, s48, 128
    s_add_u32 s60, s48, 256
    s_mov_b32 m0, s70
    v_mfma_f32_32x32x8_bf16 v[24:39], v[242:243], v[176:177], v[24:39]
    buffer_load_dwordx4 v222, s[4:7], s42 offen sc1 lds
    buffer_load_dwordx4 v223, s[72:75], s42 offen offset:1024 sc1 lds
    s_cmp_eq_u32 s33, 3
    s_cselect_b32 s46, s44, s47
    s_cselect_b32 s50, s60, s48
    v_mfma_f32_32x32x8_bf16 v[48:63], v[228:229], v[180:181], v[48:63]
    s_sub_u32 s60, s33, 2
    s_cmp_lt_u32 s60, 2
    s_cbranch_scc0 K2_rare_68
K2_back_69:
    v_mul_f32 v234, v8, v96
    v_mul_f32 v236, v16, v128
    v_fmac_f32 v234, v9, v97
    v_fmac_f32 v236, v17, v129
    v_mfma_f32_32x32x8_bf16 v[64:79], v[242:243], v[180:181], v[64:79]
    s_setprio 0
    v_fmac_f32 v234, v10, v98
    v_fmac_f32 v236, v18, v130
    v_fmac_f32 v234, v11, v99
    v_fmac_f32 v236, v19, v131
    v_fmac_f32 v234, v12, v100
    v_fmac_f32 v236, v20, v132
    v_fmac_f32 v234, v13, v101
    v_fmac_f32 v236, v21, v133
    v_fmac_f32 v234, v14, v102
    v_fmac_f32 v236, v22, v134
    v_fmac_f32 v234, v15, v103
    v_fmac_f32 v236, v23, v135
    v_mul_f32 v238, v24, v128
    v_mul_f32 v240, v32, v128
    v_fmac_f32 v238, v25, v129
    v_fmac_f32 v240, v33, v129
    v_fmac_f32 v238, v26, v130
    v_fmac_f32 v240, v34, v130
    v_fmac_f32 v238, v27, v131
    v_fmac_f32 v240, v35, v131
    v_fmac_f32 v238, v28, v132
    v_fmac_f32 v240, v36, v132
    v_fmac_f32 v238, v29, v133
    v_fmac_f32 v240, v37, v133
    v_fmac_f32 v238, v30, v134
    v_fmac_f32 v240, v38, v134
    v_fmac_f32 v238, v31, v135
    v_fmac_f32 v240, v39, v135
    v_mul_f32 v235, v48, v104
    v_mul_f32 v237, v56, v136
    v_fmac_f32 v235, v49, v105
    v_fmac_f32 v237, v57, v137
    v_fmac_f32 v235, v50, v106
    v_fmac_f32 v237, v58, v138
    v_fmac_f32 v235, v51, v107
    v_fmac_f32 v237, v59, v139
    v_fmac_f32 v235, v52, v108
    v_fmac_f32 v237, v60, v140
    v_fmac_f32 v235, v53, v109
    v_fmac_f32 v237, v61, v141
    v_fmac_f32 v235, v54, v110
    v_fmac_f32 v237, v62, v142
    v_fmac_f32 v235, v55, v111
    v_fmac_f32 v237, v63, v143
    v_mul_f32 v239, v64, v136
    v_mul_f32 v241, v72, v136
    s_setprio 1
    s_waitcnt vmcnt(3) lgkmcnt(0)
    v_mfma_f32_32x32x16_bf16 v[24:39], v[88:91], v[184:187], 0
    ds_read_b64_tr_b16 v[176:177], v246 offset:0
    ds_read_b64_tr_b16 v[178:179], v246 offset:1024
    ds_read_b64_tr_b16 v[180:181], v247 offset:0
    ds_read_b64_tr_b16 v[182:183], v247 offset:1024
    v_fmac_f32 v239, v65, v137
    v_fmac_f32 v241, v73, v137
    s_mov_b32 m0, s71
    v_mfma_f32_32x32x16_bf16 v[8:23], v[92:95], v[184:187], 0
    buffer_load_dwordx4 v224, s[4:7], s42 offen sc1 lds
    buffer_load_dwordx4 v225, s[72:75], s42 offen offset:1024 sc1 lds
    v_fmac_f32 v239, v66, v138
    v_fmac_f32 v241, v74, v138
    v_fmac_f32 v239, v67, v139
    v_fmac_f32 v241, v75, v139
    v_fmac_f32 v239, v68, v140
    v_mfma_f32_32x32x16_bf16 v[48:63], v[92:95], v[188:191], 0
    v_fmac_f32 v241, v76, v140
    v_fmac_f32 v239, v69, v141
    v_fmac_f32 v241, v77, v141
    v_fmac_f32 v239, v70, v142
    v_fmac_f32 v241, v78, v142
    v_fmac_f32 v239, v71, v143
    v_fmac_f32 v241, v79, v143
    v_mfma_f32_32x32x16_bf16 v[64:79], v[88:91], v[188:191], 0
    v_permlane32_swap_b32 v234, v236
    v_permlane32_swap_b32 v235, v237
    v_permlane32_swap_b32 v238, v239
    s_waitcnt vmcnt(4) lgkmcnt(0)
    v_mfma_f32_32x32x16_bf16 v[24:39], v[80:83], v[176:179], v[24:39]
    ds_read_b64_tr_b16 v[184:185], v246 offset:2048
    ds_read_b64_tr_b16 v[188:189], v247 offset:2048
    v_lshl_add_u32 v232, v252, 1, s31
    v_add_f32 v234, v234, v236
    v_add_f32 v235, v235, v237
    v_add_f32 v238, -v238, -v239
    s_mov_b32 m0, s68
    v_mfma_f32_32x32x16_bf16 v[8:23], v[84:87], v[176:179], v[8:23]
    buffer_load_dwordx4 v226, s[4:7], s42 offen sc1 lds
    v_sub_u32 v239, v232, v233
    v_cvt_pk_bf16_f32 v234, v234, v235
    v_cvt_pk_bf16_f32 v238, v238, v238
    ds_write_b32 v232, v234 offset:0
    ds_write_b16 v239, v238 offset:1280
    v_mov_b64 v[0:1], 0
    v_mfma_f32_32x32x16_bf16 v[48:63], v[84:87], v[180:183], v[48:63]
    v_mov_b64 v[2:3], 0
    v_mov_b64 v[4:5], 0
    v_mov_b64 v[6:7], 0
    v_mov_b64 v[40:41], 0
    v_mov_b64 v[42:43], 0
    v_mov_b64 v[44:45], 0
    v_mov_b64 v[46:47], 0
    v_mfma_f32_32x32x16_bf16 v[64:79], v[80:83], v[180:183], v[64:79]
    s_waitcnt vmcnt(3) lgkmcnt(2)
    v_mfma_f32_32x32x8_bf16 v[24:39], v[228:229], v[184:185], v[24:39]
    ds_read_b64_tr_b16 v[176:177], v246 offset:4096
    ds_read_b64_tr_b16 v[178:179], v246 offset:5120
    ds_read_b64_tr_b16 v[180:181], v247 offset:4096
    ds_read_b64_tr_b16 v[182:183], v247 offset:5120
    s_mov_b32 m0, s69
    v_mfma_f32_32x32x8_bf16 v[8:23], v[242:243], v[184:185], v[8:23]
    buffer_load_dwordx4 v222, s[4:7], s43 offen sc1 lds
    buffer_load_dwordx4 v223, s[72:75], s43 offen offset:1024 sc1 lds
    v_mfma_f32_32x32x8_bf16 v[48:63], v[242:243], v[188:189], v[48:63]
    s_nop 2
    v_mul_f32 v234, v24, v144
    v_fmac_f32 v234, v25, v145
    v_fmac_f32 v234, v26, v146
    v_fmac_f32 v234, v27, v147
    v_fmac_f32 v234, v28, v148
    v_fmac_f32 v234, v29, v149
    v_fmac_f32 v234, v30, v150
    v_mfma_f32_32x32x8_bf16 v[64:79], v[228:229], v[188:189], v[64:79]
    s_setprio 0
    v_fmac_f32 v234, v31, v151
    v_mul_f32 v238, v16, v160
    v_mul_f32 v239, v56, v168
    v_fmac_f32 v238, v17, v161
    v_fmac_f32 v239, v57, v169
    v_fmac_f32 v238, v18, v162
    v_fmac_f32 v239, v58, v170
    v_fmac_f32 v238, v19, v163
    v_fmac_f32 v239, v59, v171
    v_fmac_f32 v238, v20, v164
    v_fmac_f32 v239, v60, v172
    v_fmac_f32 v238, v21, v165
    v_fmac_f32 v239, v61, v173
    v_fmac_f32 v238, v22, v166
    v_fmac_f32 v239, v62, v174
    v_fmac_f32 v238, v23, v167
    v_fmac_f32 v239, v63, v175
    s_setprio 1
    s_waitcnt vmcnt(3) lgkmcnt(0)
    v_mfma_f32_32x32x16_bf16 v[0:15], v[80:83], v[176:179], v[0:15]
    ds_read_b64_tr_b16 v[184:185], v246 offset:6144
    ds_read_b64_tr_b16 v[186:187], v246 offset:7168
    ds_read_b64_tr_b16 v[188:189], v247 offset:6144
    ds_read_b64_tr_b16 v[190:191], v247 offset:7168
    v_mul_f32 v235, v64, v152
    v_fmac_f32 v235, v65, v153
    s_mov_b32 m0, s70
    v_mfma_f32_32x32x16_bf16 v[16:31], v[84:87], v[176:179], 0
    buffer_load_dwordx4 v224, s[4:7], s43 offen sc1 lds
    buffer_load_dwordx4 v225, s[72:75], s43 offen offset:1024 sc1 lds
    v_fmac_f32 v235, v66, v154
    v_fmac_f32 v235, v67, v155
    v_fmac_f32 v235, v68, v156
    v_fmac_f32 v235, v69, v157
    v_fmac_f32 v235, v70, v158
    v_mfma_f32_32x32x16_bf16 v[40:55], v[80:83], v[180:183], v[40:55]
    v_add_u32 v222, s48, v251
    ds_read2_b32 v[222:223], v222 offset0:1 offset1:3
    v_fmac_f32 v235, v71, v159
    v_mfma_f32_32x32x16_bf16 v[56:71], v[84:87], v[180:183], 0
    v_permlane32_swap_b32 v234, v240
    v_permlane32_swap_b32 v235, v241
    v_add_f32 v234, v234, v240
    v_add_f32 v235, v235, v241
    s_waitcnt vmcnt(4) lgkmcnt(1)
    v_mfma_f32_32x32x16_bf16 v[0:15], v[88:91], v[184:187], v[0:15]
    ds_read_b64_tr_b16 v[176:177], v246 offset:0
    ds_read_b64_tr_b16 v[180:181], v247 offset:0
    v_cvt_pk_bf16_f32 v234, v234, v235
    ds_write_b32 v232, v234 offset:256
    s_mov_b32 m0, s71
    v_mfma_f32_32x32x16_bf16 v[16:31], v[92:95], v[184:187], v[16:31]
    buffer_load_dwordx4 v226, s[4:7], s43 offen sc1 lds
    s_waitcnt lgkmcnt(3)
    v_mad_u32_u16 v222, v222, s39, v248 op_sel:[1,0,0,0]
    v_mad_u32_u16 v223, v223, s39, v248 op_sel:[1,0,0,0]
    v_mfma_f32_32x32x16_bf16 v[40:55], v[88:91], v[188:191], v[40:55]
    v_add_u32 v224, s49, v251
    ds_read2_b32 v[224:225], v224 offset0:1 offset1:3
    v_mfma_f32_32x32x16_bf16 v[56:71], v[92:95], v[188:191], v[56:71]
    s_waitcnt vmcnt(3) lgkmcnt(2)
    v_mfma_f32_32x32x8_bf16 v[0:15], v[228:229], v[176:177], v[0:15]
    ds_read_b64_tr_b16 v[184:185], v246 offset:2048
    ds_read_b64_tr_b16 v[186:187], v246 offset:3072
    ds_read_b64_tr_b16 v[188:189], v247 offset:2048
    ds_read_b64_tr_b16 v[190:191], v247 offset:3072
    s_mov_b32 m0, s68
    v_mfma_f32_32x32x8_bf16 v[16:31], v[242:243], v[176:177], v[16:31]
    buffer_load_dwordx4 v222, s[4:7], s44 offen sc1 lds
    buffer_load_dwordx4 v223, s[72:75], s44 offen offset:1024 sc1 lds
    s_waitcnt lgkmcnt(4)
    v_mad_u32_u16 v224, v224, s39, v248 op_sel:[1,0,0,0]
    v_mad_u32_u16 v225, v225, s39, v248 op_sel:[1,0,0,0]
    v_mfma_f32_32x32x8_bf16 v[40:55], v[228:229], v[180:181], v[40:55]
    v_add_u32 v226, s50, v251
    ds_read2_b32 v[226:227], v226 offset0:1 offset1:3
    v_mul_f32 v240, v0, v144
    v_mul_f32 v236, v8, v160
    v_fmac_f32 v240, v1, v145
    v_fmac_f32 v236, v9, v161
    v_fmac_f32 v240, v2, v146
    v_mfma_f32_32x32x8_bf16 v[56:71], v[242:243], v[180:181], v[56:71]
    s_setprio 0
    v_fmac_f32 v236, v10, v162
    v_fmac_f32 v240, v3, v147
    v_fmac_f32 v236, v11, v163
    v_fmac_f32 v240, v4, v148
    v_fmac_f32 v236, v12, v164
    v_fmac_f32 v240, v5, v149
    v_fmac_f32 v236, v13, v165
    v_fmac_f32 v240, v6, v150
    v_fmac_f32 v236, v14, v166
    v_fmac_f32 v240, v7, v151
    v_fmac_f32 v236, v15, v167
    v_mul_f32 v234, v16, v112
    v_mul_f32 v241, v40, v152
    v_mul_f32 v237, v48, v168
    v_fmac_f32 v234, v17, v113
    v_fmac_f32 v241, v41, v153
    v_fmac_f32 v237, v49, v169
    v_fmac_f32 v234, v18, v114
    v_fmac_f32 v241, v42, v154
    v_fmac_f32 v237, v50, v170
    v_fmac_f32 v234, v19, v115
    v_fmac_f32 v241, v43, v155
    v_fmac_f32 v237, v51, v171
    v_fmac_f32 v234, v20, v116
    v_fmac_f32 v241, v44, v156
    v_fmac_f32 v237, v52, v172
    v_fmac_f32 v234, v21, v117
    v_fmac_f32 v241, v45, v157
    v_fmac_f32 v237, v53, v173
    v_fmac_f32 v234, v22, v118
    v_fmac_f32 v241, v46, v158
    v_fmac_f32 v237, v54, v174
    v_fmac_f32 v234, v23, v119
    v_fmac_f32 v241, v47, v159
    v_fmac_f32 v237, v55, v175
    s_setprio 1
    s_waitcnt vmcnt(3) lgkmcnt(1)
    v_mfma_f32_32x32x16_bf16 v[8:23], v[80:83], v[184:187], 0
    ds_read_b64_tr_b16 v[176:177], v246 offset:4096
    ds_read_b64_tr_b16 v[178:179], v246 offset:5120
    ds_read_b64_tr_b16 v[180:181], v247 offset:4096
    ds_read_b64_tr_b16 v[182:183], v247 offset:5120
    v_mul_f32 v235, v56, v120
    v_fmac_f32 v235, v57, v121
    s_mov_b32 m0, s69
    v_mfma_f32_32x32x16_bf16 v[24:39], v[84:87], v[184:187], v[24:39]
    buffer_load_dwordx4 v224, s[4:7], s45 offen sc1 lds
    buffer_load_dwordx4 v225, s[72:75], s45 offen offset:1024 sc1 lds
    s_waitcnt lgkmcnt(4)
    v_mad_u32_u16 v226, v226, s39, v248 op_sel:[1,0,0,0]
    v_mad_u32_u16 v227, v227, s39, v248 op_sel:[1,0,0,0]
    v_fmac_f32 v235, v58, v122
    v_fmac_f32 v235, v59, v123
    v_mfma_f32_32x32x16_bf16 v[64:79], v[84:87], v[188:191], v[64:79]
    v_fmac_f32 v235, v60, v124
    v_fmac_f32 v235, v61, v125
    v_fmac_f32 v235, v62, v126
    v_fmac_f32 v235, v63, v127
    v_mfma_f32_32x32x16_bf16 v[48:63], v[80:83], v[188:191], 0
    v_permlane32_swap_b32 v236, v240
    v_permlane32_swap_b32 v237, v241
    v_add_f32 v236, v236, v240
    v_add_f32 v237, v237, v241
    s_waitcnt vmcnt(4) lgkmcnt(0)
    v_mfma_f32_32x32x16_bf16 v[8:23], v[88:91], v[176:179], v[8:23]
    ds_read_b64_tr_b16 v[184:185], v246 offset:6144
    ds_read_b64_tr_b16 v[188:189], v247 offset:6144
    v_cvt_pk_bf16_f32 v236, v236, v237
    ds_write_b32 v232, v236 offset:1024
    s_mov_b32 s32, s31
    s_mov_b32 s31, s35
    s_mov_b32 m0, s70
    v_mfma_f32_32x32x16_bf16 v[24:39], v[92:95], v[176:179], v[24:39]
    buffer_load_dwordx4 v226, s[4:7], s46 offen sc1 lds
    buffer_load_dwordx4 v227, s[72:75], s46 offen offset:1024 sc1 lds
    s_sub_u32 s26, s48, s29
    s_mov_b32 s29, s48
    s_mov_b32 s30, s3
    s_bfe_u32 s56, s3, 0x40012
    v_mfma_f32_32x32x16_bf16 v[64:79], v[92:95], v[180:183], v[64:79]
    s_cmp_lg_u32 s36, 0
    s_cselect_b32 s56, s56, 0
    v_mfma_f32_32x32x16_bf16 v[48:63], v[88:91], v[180:183], v[48:63]
    s_waitcnt vmcnt(4) lgkmcnt(1)
    v_mfma_f32_32x32x8_bf16 v[8:23], v[228:229], v[184:185], v[8:23]
    ds_read_b64_tr_b16 v[176:177], v246 offset:0
    ds_read_b64_tr_b16 v[178:179], v246 offset:1024
    ds_read_b64_tr_b16 v[180:181], v247 offset:0
    ds_read_b64_tr_b16 v[182:183], v247 offset:1024
    s_mov_b32 m0, s71
    v_mfma_f32_32x32x8_bf16 v[24:39], v[242:243], v[184:185], v[24:39]
    s_cmp_eq_u32 s33, 4
    s_cbranch_scc1 K2_g4_71
    buffer_load_dwordx4 v224, s[4:7], s47 offen sc1 lds
    buffer_load_dwordx4 v225, s[72:75], s47 offen offset:1024 sc1 lds
K2_back_72:
    v_mfma_f32_32x32x8_bf16 v[64:79], v[242:243], v[188:189], v[64:79]
    s_nop 0
    v_mul_f32 v236, v8, v144
    v_fma_f32 v238, v16, v160, -v238
    v_fmac_f32 v236, v9, v145
    v_fmac_f32 v238, v17, v161
    v_fmac_f32 v236, v10, v146
    v_fmac_f32 v238, v18, v162
    v_fmac_f32 v236, v11, v147
    v_mfma_f32_32x32x8_bf16 v[48:63], v[228:229], v[188:189], v[48:63]
    s_setprio 0
    v_fmac_f32 v238, v19, v163
    v_fmac_f32 v236, v12, v148
    v_fmac_f32 v238, v20, v164
    v_fmac_f32 v236, v13, v149
    v_fmac_f32 v238, v21, v165
    v_fmac_f32 v236, v14, v150
    v_fmac_f32 v238, v22, v166
    v_fmac_f32 v236, v15, v151
    v_fmac_f32 v238, v23, v167
    v_add_u32 v249, s26, v249
    v_add_u32 v250, s26, v250
    v_mul_f32 v240, v24, v160
    v_fma_f32 v234, v32, v112, -v234
    v_fmac_f32 v240, v25, v161
    v_fmac_f32 v234, v33, v113
    v_fmac_f32 v240, v26, v162
    v_fmac_f32 v234, v34, v114
    v_fmac_f32 v240, v27, v163
    v_fmac_f32 v234, v35, v115
    v_fmac_f32 v240, v28, v164
    v_fmac_f32 v234, v36, v116
    v_fmac_f32 v240, v29, v165
    v_fmac_f32 v234, v37, v117
    v_fmac_f32 v240, v30, v166
    v_fmac_f32 v234, v38, v118
    v_fmac_f32 v240, v31, v167
    v_fmac_f32 v234, v39, v119
    ds_read_b64_tr_b16 v[80:81], v249 offset:0
    ds_read_u16_d16_hi v40, v250 offset:0
    v_mul_f32 v241, v64, v168
    v_fma_f32 v235, v72, v120, -v235
    v_fmac_f32 v241, v65, v169
    v_fmac_f32 v235, v73, v121
    v_fmac_f32 v241, v66, v170
    v_fmac_f32 v235, v74, v122
    v_fmac_f32 v241, v67, v171
    v_fmac_f32 v235, v75, v123
    v_fmac_f32 v241, v68, v172
    v_fmac_f32 v235, v76, v124
    v_fmac_f32 v241, v69, v173
    v_fmac_f32 v235, v77, v125
    v_fmac_f32 v241, v70, v174
    v_fmac_f32 v235, v78, v126
    v_fmac_f32 v241, v71, v175
    v_fmac_f32 v235, v79, v127
    ds_read_b64_tr_b16 v[88:89], v249 offset:512
    ds_read_u16_d16_hi v41, v250 offset:128
    v_mul_f32 v237, v48, v152
    v_fma_f32 v239, v56, v168, -v239
    v_fmac_f32 v237, v49, v153
    v_fmac_f32 v239, v57, v169
    v_fmac_f32 v237, v50, v154
    v_fmac_f32 v239, v58, v170
    v_fmac_f32 v237, v51, v155
    v_fmac_f32 v239, v59, v171
    v_fmac_f32 v237, v52, v156
    v_fmac_f32 v239, v60, v172
    v_fmac_f32 v237, v53, v157
    v_fmac_f32 v239, v61, v173
    v_fmac_f32 v237, v54, v158
    v_fmac_f32 v239, v62, v174
    v_fmac_f32 v237, v55, v159
    v_fmac_f32 v239, v63, v175
    s_cmp_eq_u32 s56, 5
    s_cbranch_scc1 K2_U21
    s_cmp_eq_u32 s56, 6
    s_cbranch_scc1 K2_U3h1
    s_branch K2_DSP1
K2_U31:
    s_setprio 0
    ds_read_b64_tr_b16 v[228:229], v249 offset:1024
    ds_read_u16_d16_hi v42, v250 offset:256
    s_waitcnt lgkmcnt(2)
    v_lshlrev_b32 v16, 16, v80
    v_and_b32 v17, 0xffff0000, v80
    v_lshlrev_b32 v18, 16, v81
    v_and_b32 v19, 0xffff0000, v81
    v_mov_b32 v82, v81
    v_mul_f32_dpp v32, v40, v16 row_newbcast:0 row_mask:0xf bank_mask:0xf
    v_mul_f32_dpp v33, v40, v17 row_newbcast:1 row_mask:0xf bank_mask:0xf
    v_mul_f32_dpp v34, v40, v18 row_newbcast:2 row_mask:0xf bank_mask:0xf
    v_mul_f32_dpp v35, v40, v19 row_newbcast:3 row_mask:0xf bank_mask:0xf
    v_mul_f32_dpp v36, v40, v16 row_newbcast:4 row_mask:0xf bank_mask:0xf
    v_mul_f32_dpp v37, v40, v17 row_newbcast:5 row_mask:0xf bank_mask:0xf
    v_mul_f32_dpp v38, v40, v18 row_newbcast:6 row_mask:0xf bank_mask:0xf
    v_mul_f32_dpp v39, v40, v19 row_newbcast:7 row_mask:0xf bank_mask:0xf
    v_cvt_pk_bf16_f32 v81, v32, v33
    v_cvt_pk_bf16_f32 v83, v34, v35
    v_mul_f32_dpp v16, v40, v16 row_newbcast:8 row_mask:0xf bank_mask:0xf
    v_mul_f32_dpp v17, v40, v17 row_newbcast:9 row_mask:0xf bank_mask:0xf
    v_mul_f32_dpp v18, v40, v18 row_newbcast:10 row_mask:0xf bank_mask:0xf
    v_mul_f32_dpp v19, v40, v19 row_newbcast:11 row_mask:0xf bank_mask:0xf
    v_cvt_pk_bf16_f32 v84, v36, v37
    v_cvt_pk_bf16_f32 v86, v38, v39
    v_cvt_pk_bf16_f32 v85, v16, v17
    v_cvt_pk_bf16_f32 v87, v18, v19
    v_permlane16_swap_b32 v80, v81
    v_permlane16_swap_b32 v82, v83
    v_lshlrev_b32 v24, 16, v88
    v_and_b32 v25, 0xffff0000, v88
    v_lshlrev_b32 v26, 16, v89
    v_and_b32 v27, 0xffff0000, v89
    v_mov_b32 v90, v89
    v_permlane16_swap_b32 v84, v85
    v_permlane16_swap_b32 v86, v87
    v_mul_f32_dpp v32, v41, v24 row_newbcast:0 row_mask:0xf bank_mask:0xf
    v_mul_f32_dpp v33, v41, v25 row_newbcast:1 row_mask:0xf bank_mask:0xf
    v_mul_f32_dpp v34, v41, v26 row_newbcast:2 row_mask:0xf bank_mask:0xf
    v_mul_f32_dpp v35, v41, v27 row_newbcast:3 row_mask:0xf bank_mask:0xf
    v_mul_f32_dpp v36, v41, v24 row_newbcast:4 row_mask:0xf bank_mask:0xf
    v_mul_f32_dpp v37, v41, v25 row_newbcast:5 row_mask:0xf bank_mask:0xf
    v_mul_f32_dpp v38, v41, v26 row_newbcast:6 row_mask:0xf bank_mask:0xf
    v_mul_f32_dpp v39, v41, v27 row_newbcast:7 row_mask:0xf bank_mask:0xf
    v_cvt_pk_bf16_f32 v89, v32, v33
    v_cvt_pk_bf16_f32 v91, v34, v35
    v_mul_f32_dpp v24, v41, v24 row_newbcast:8 row_mask:0xf bank_mask:0xf
    v_mul_f32_dpp v25, v41, v25 row_newbcast:9 row_mask:0xf bank_mask:0xf
    v_mul_f32_dpp v26, v41, v26 row_newbcast:10 row_mask:0xf bank_mask:0xf
    v_mul_f32_dpp v27, v41, v27 row_newbcast:11 row_mask:0xf bank_mask:0xf
    v_cvt_pk_bf16_f32 v92, v36, v37
    v_cvt_pk_bf16_f32 v94, v38, v39
    v_cvt_pk_bf16_f32 v93, v24, v25
    v_cvt_pk_bf16_f32 v95, v26, v27
    v_permlane16_swap_b32 v88, v89
    v_permlane16_swap_b32 v90, v91
    s_waitcnt lgkmcnt(0)
    v_lshlrev_b32 v16, 16, v228
    v_and_b32 v17, 0xffff0000, v228
    v_lshlrev_b32 v18, 16, v229
    v_and_b32 v19, 0xffff0000, v229
    v_mov_b32 v230, v229
    v_permlane16_swap_b32 v92, v93
    v_permlane16_swap_b32 v94, v95
    v_mul_f32_dpp v32, v42, v16 row_newbcast:0 row_mask:0xf bank_mask:0xf
    v_mul_f32_dpp v33, v42, v17 row_newbcast:1 row_mask:0xf bank_mask:0xf
    v_mul_f32_dpp v34, v42, v18 row_newbcast:2 row_mask:0xf bank_mask:0xf
    v_mul_f32_dpp v35, v42, v19 row_newbcast:3 row_mask:0xf bank_mask:0xf
    v_mul_f32_dpp v36, v42, v16 row_newbcast:4 row_mask:0xf bank_mask:0xf
    v_mul_f32_dpp v37, v42, v17 row_newbcast:5 row_mask:0xf bank_mask:0xf
    v_mul_f32_dpp v38, v42, v18 row_newbcast:6 row_mask:0xf bank_mask:0xf
    v_mul_f32_dpp v39, v42, v19 row_newbcast:7 row_mask:0xf bank_mask:0xf
    v_cvt_pk_bf16_f32 v229, v32, v33
    v_cvt_pk_bf16_f32 v231, v34, v35
    v_mul_f32_dpp v16, v42, v16 row_newbcast:8 row_mask:0xf bank_mask:0xf
    v_mul_f32_dpp v17, v42, v17 row_newbcast:9 row_mask:0xf bank_mask:0xf
    v_mul_f32_dpp v18, v42, v18 row_newbcast:10 row_mask:0xf bank_mask:0xf
    v_mul_f32_dpp v19, v42, v19 row_newbcast:11 row_mask:0xf bank_mask:0xf
    v_cvt_pk_bf16_f32 v242, v36, v37
    v_cvt_pk_bf16_f32 v244, v38, v39
    v_cvt_pk_bf16_f32 v243, v16, v17
    v_cvt_pk_bf16_f32 v245, v18, v19
    v_permlane16_swap_b32 v228, v229
    v_permlane16_swap_b32 v230, v231
    v_permlane16_swap_b32 v242, v243
    v_permlane16_swap_b32 v244, v245
    s_waitcnt vmcnt(4)
    s_setprio 1
    v_mfma_f32_32x32x16_bf16 v[8:23], v[80:83], v[176:179], 0
    ds_read_b64_tr_b16 v[184:185], v246 offset:2048
    ds_read_b64_tr_b16 v[186:187], v246 offset:3072
    ds_read_b64_tr_b16 v[188:189], v247 offset:2048
    ds_read_b64_tr_b16 v[190:191], v247 offset:3072
    s_mov_b32 m0, s68
    v_mfma_f32_32x32x16_bf16 v[24:39], v[84:87], v[176:179], 0
    buffer_load_dwordx4 v222, s[4:7], s41 offen sc1 lds
    buffer_load_dwordx4 v223, s[72:75], s41 offen offset:1024 sc1 lds
    v_permlane32_swap_b32 v236, v234
    v_permlane32_swap_b32 v237, v235
    v_mfma_f32_32x32x16_bf16 v[48:63], v[80:83], v[180:183], 0
    v_permlane32_swap_b32 v240, v238
    v_permlane32_swap_b32 v241, v239
    v_add_f32 v236, v236, v234
    v_add_f32 v237, v237, v235
    v_add_f32 v240, -v240, -v238
    v_mfma_f32_32x32x16_bf16 v[64:79], v[84:87], v[180:183], 0
    v_add_f32 v241, -v241, -v239
    v_cvt_pk_bf16_f32 v236, v236, v237
    v_cvt_pk_bf16_f32 v240, v240, v241
    ds_write2st64_b32 v232, v236, v240 offset0:2 offset1:3
    s_mov_b64 exec, 0x1ff
    ds_add_rtn_u32 v42, v254, v251
    s_mov_b64 exec, -1
    s_waitcnt vmcnt(4) lgkmcnt(2)
    v_mfma_f32_32x32x16_bf16 v[8:23], v[88:91], v[184:187], v[8:23]
    ds_read_b64_tr_b16 v[176:177], v246 offset:4096
    ds_read_b64_tr_b16 v[178:179], v246 offset:5120
    ds_read_b64_tr_b16 v[180:181], v247 offset:4096
    ds_read_b64_tr_b16 v[182:183], v247 offset:5120
    s_mov_b32 m0, s69
    v_mfma_f32_32x32x16_bf16 v[24:39], v[92:95], v[184:187], v[24:39]
    buffer_load_dwordx4 v226, s[4:7], s41 offen sc1 lds
    buffer_load_dwordx4 v227, s[72:75], s41 offen offset:1024 sc1 lds
    s_waitcnt lgkmcnt(4)
    v_readlane_b32 s58, v42, 8
    v_mfma_f32_32x32x16_bf16 v[48:63], v[88:91], v[188:191], v[48:63]
    s_lshr_b32 s58, s58, 4
    s_cmp_lt_u32 s58, s22
    s_cbranch_scc0 K2_nul_73
    v_readlane_b32 s3, v253, s58
    s_nop 0
    s_bfe_u32 s58, s3, 0x60016
    s_and_b32 s59, s58, 7
    s_lshr_b32 s60, s58, 3
K2_chk_75:
    v_readlane_b32 s61, v42, s59
    s_nop 0
    s_cmp_gt_u32 s61, s60
    s_cbranch_scc0 K2_spin_74
K2_back_76:
    v_mfma_f32_32x32x16_bf16 v[64:79], v[92:95], v[188:191], v[64:79]
    s_lshl_b32 s44, s34, 7
    s_and_b32 s48, s3, 0x3ffff
    s_bfe_u32 s33, s3, 0x30013
    s_mov_b32 s35, s48
    s_mov_b32 s45, s44
    s_xor_b32 s47, s44, 256
    s_waitcnt vmcnt(4) lgkmcnt(0)
    v_mfma_f32_32x32x16_bf16 v[8:23], v[228:231], v[176:179], v[8:23]
    ds_read_b64_tr_b16 v[184:185], v246 offset:6144
    ds_read_b64_tr_b16 v[186:187], v246 offset:7168
    ds_read_b64_tr_b16 v[188:189], v247 offset:6144
    ds_read_b64_tr_b16 v[190:191], v247 offset:7168
    s_add_u32 s49, s48, 128
    s_add_u32 s60, s48, 256
    s_mov_b32 m0, s70
    v_mfma_f32_32x32x16_bf16 v[24:39], v[242:245], v[176:179], v[24:39]
    buffer_load_dwordx4 v222, s[4:7], s42 offen sc1 lds
    buffer_load_dwordx4 v223, s[72:75], s42 offen offset:1024 sc1 lds
    s_cmp_eq_u32 s33, 3
    s_cselect_b32 s46, s44, s47
    s_cselect_b32 s50, s60, s48
    v_mfma_f32_32x32x16_bf16 v[48:63], v[228:231], v[180:183], v[48:63]
    s_sub_u32 s60, s33, 2
    s_cmp_lt_u32 s60, 2
    s_cbranch_scc0 K2_rare_77
K2_back_78:
    v_mul_f32 v234, v8, v96
    v_mul_f32 v236, v16, v128
    v_fmac_f32 v234, v9, v97
    v_fmac_f32 v236, v17, v129
    v_mfma_f32_32x32x16_bf16 v[64:79], v[242:245], v[180:183], v[64:79]
    s_setprio 0
    v_fmac_f32 v234, v10, v98
    v_fmac_f32 v236, v18, v130
    v_fmac_f32 v234, v11, v99
    v_fmac_f32 v236, v19, v131
    v_fmac_f32 v234, v12, v100
    v_fmac_f32 v236, v20, v132
    v_fmac_f32 v234, v13, v101
    v_fmac_f32 v236, v21, v133
    v_fmac_f32 v234, v14, v102
    v_fmac_f32 v236, v22, v134
    v_fmac_f32 v234, v15, v103
    v_fmac_f32 v236, v23, v135
    v_mul_f32 v238, v24, v128
    v_mul_f32 v240, v32, v128
    v_fmac_f32 v238, v25, v129
    v_fmac_f32 v240, v33, v129
    v_fmac_f32 v238, v26, v130
    v_fmac_f32 v240, v34, v130
    v_fmac_f32 v238, v27, v131
    v_fmac_f32 v240, v35, v131
    v_fmac_f32 v238, v28, v132
    v_fmac_f32 v240, v36, v132
    v_fmac_f32 v238, v29, v133
    v_fmac_f32 v240, v37, v133
    v_fmac_f32 v238, v30, v134
    v_fmac_f32 v240, v38, v134
    v_fmac_f32 v238, v31, v135
    v_fmac_f32 v240, v39, v135
    v_mul_f32 v235, v48, v104
    v_mul_f32 v237, v56, v136
    v_fmac_f32 v235, v49, v105
    v_fmac_f32 v237, v57, v137
    v_fmac_f32 v235, v50, v106
    v_fmac_f32 v237, v58, v138
    v_fmac_f32 v235, v51, v107
    v_fmac_f32 v237, v59, v139
    v_fmac_f32 v235, v52, v108
    v_fmac_f32 v237, v60, v140
    v_fmac_f32 v235, v53, v109
    v_fmac_f32 v237, v61, v141
    v_fmac_f32 v235, v54, v110
    v_fmac_f32 v237, v62, v142
    v_fmac_f32 v235, v55, v111
    v_fmac_f32 v237, v63, v143
    v_mul_f32 v239, v64, v136
    v_mul_f32 v241, v72, v136
    s_setprio 1
    s_waitcnt vmcnt(4) lgkmcnt(0)
    v_mfma_f32_32x32x16_bf16 v[24:39], v[88:91], v[184:187], 0
    ds_read_b64_tr_b16 v[176:177], v246 offset:0
    ds_read_b64_tr_b16 v[178:179], v246 offset:1024
    ds_read_b64_tr_b16 v[180:181], v247 offset:0
    ds_read_b64_tr_b16 v[182:183], v247 offset:1024
    v_fmac_f32 v239, v65, v137
    v_fmac_f32 v241, v73, v137
    s_mov_b32 m0, s71
    v_mfma_f32_32x32x16_bf16 v[8:23], v[92:95], v[184:187], 0
    buffer_load_dwordx4 v224, s[4:7], s42 offen sc1 lds
    buffer_load_dwordx4 v225, s[72:75], s42 offen offset:1024 sc1 lds
    v_fmac_f32 v239, v66, v138
    v_fmac_f32 v241, v74, v138
    v_fmac_f32 v239, v67, v139
    v_fmac_f32 v241, v75, v139
    v_fmac_f32 v239, v68, v140
    v_mfma_f32_32x32x16_bf16 v[48:63], v[92:95], v[188:191], 0
    v_fmac_f32 v241, v76, v140
    v_fmac_f32 v239, v69, v141
    v_fmac_f32 v241, v77, v141
    v_fmac_f32 v239, v70, v142
    v_fmac_f32 v241, v78, v142
    v_fmac_f32 v239, v71, v143
    v_fmac_f32 v241, v79, v143
    v_mfma_f32_32x32x16_bf16 v[64:79], v[88:91], v[188:191], 0
    v_permlane32_swap_b32 v234, v236
    v_permlane32_swap_b32 v235, v237
    v_permlane32_swap_b32 v238, v239
    s_waitcnt vmcnt(4) lgkmcnt(0)
    v_mfma_f32_32x32x16_bf16 v[24:39], v[80:83], v[176:179], v[24:39]
    ds_read_b64_tr_b16 v[184:185], v246 offset:2048
    ds_read_b64_tr_b16 v[186:187], v246 offset:3072
    ds_read_b64_tr_b16 v[188:189], v247 offset:2048
    ds_read_b64_tr_b16 v[190:191], v247 offset:3072
    v_lshl_add_u32 v232, v252, 1, s31
    v_add_f32 v234, v234, v236
    s_mov_b32 m0, s68
    v_mfma_f32_32x32x16_bf16 v[8:23], v[84:87], v[176:179], v[8:23]
    buffer_load_dwordx4 v226, s[4:7], s42 offen sc1 lds
    buffer_load_dwordx4 v227, s[72:75], s42 offen offset:1024 sc1 lds
    v_add_f32 v235, v235, v237
    v_add_f32 v238, -v238, -v239
    v_sub_u32 v239, v232, v233
    v_cvt_pk_bf16_f32 v234, v234, v235
    v_cvt_pk_bf16_f32 v238, v238, v238
    v_mfma_f32_32x32x16_bf16 v[48:63], v[84:87], v[180:183], v[48:63]
    ds_write_b32 v232, v234 offset:0
    ds_write_b16 v239, v238 offset:1280
    v_mov_b64 v[0:1], 0
    v_mov_b64 v[2:3], 0
    v_mov_b64 v[4:5], 0
    v_mov_b64 v[6:7], 0
    v_mov_b64 v[40:41], 0
    v_mfma_f32_32x32x16_bf16 v[64:79], v[80:83], v[180:183], v[64:79]
    v_mov_b64 v[42:43], 0
    v_mov_b64 v[44:45], 0
    v_mov_b64 v[46:47], 0
    s_waitcnt vmcnt(4) lgkmcnt(2)
    v_mfma_f32_32x32x16_bf16 v[24:39], v[228:231], v[184:187], v[24:39]
    ds_read_b64_tr_b16 v[176:177], v246 offset:4096
    ds_read_b64_tr_b16 v[178:179], v246 offset:5120
    ds_read_b64_tr_b16 v[180:181], v247 offset:4096
    ds_read_b64_tr_b16 v[182:183], v247 offset:5120
    s_mov_b32 m0, s69
    v_mfma_f32_32x32x16_bf16 v[8:23], v[242:245], v[184:187], v[8:23]
    buffer_load_dwordx4 v222, s[4:7], s43 offen sc1 lds
    buffer_load_dwordx4 v223, s[72:75], s43 offen offset:1024 sc1 lds
    v_mfma_f32_32x32x16_bf16 v[48:63], v[242:245], v[188:191], v[48:63]
    s_nop 2
    v_mul_f32 v234, v24, v144
    v_fmac_f32 v234, v25, v145
    v_fmac_f32 v234, v26, v146
    v_fmac_f32 v234, v27, v147
    v_fmac_f32 v234, v28, v148
    v_fmac_f32 v234, v29, v149
    v_fmac_f32 v234, v30, v150
    v_mfma_f32_32x32x16_bf16 v[64:79], v[228:231], v[188:191], v[64:79]
    s_setprio 0
    v_fmac_f32 v234, v31, v151
    v_mul_f32 v238, v16, v160
    v_mul_f32 v239, v56, v168
    v_fmac_f32 v238, v17, v161
    v_fmac_f32 v239, v57, v169
    v_fmac_f32 v238, v18, v162
    v_fmac_f32 v239, v58, v170
    v_fmac_f32 v238, v19, v163
    v_fmac_f32 v239, v59, v171
    v_fmac_f32 v238, v20, v164
    v_fmac_f32 v239, v60, v172
    v_fmac_f32 v238, v21, v165
    v_fmac_f32 v239, v61, v173
    v_fmac_f32 v238, v22, v166
    v_fmac_f32 v239, v62, v174
    v_fmac_f32 v238, v23, v167
    v_fmac_f32 v239, v63, v175
    s_setprio 1
    s_waitcnt vmcnt(4) lgkmcnt(0)
    v_mfma_f32_32x32x16_bf16 v[0:15], v[80:83], v[176:179], v[0:15]
    ds_read_b64_tr_b16 v[184:185], v246 offset:6144
    ds_read_b64_tr_b16 v[186:187], v246 offset:7168
    ds_read_b64_tr_b16 v[188:189], v247 offset:6144
    ds_read_b64_tr_b16 v[190:191], v247 offset:7168
    v_mul_f32 v235, v64, v152
    v_fmac_f32 v235, v65, v153
    s_mov_b32 m0, s70
    v_mfma_f32_32x32x16_bf16 v[16:31], v[84:87], v[176:179], 0
    buffer_load_dwordx4 v224, s[4:7], s43 offen sc1 lds
    buffer_load_dwordx4 v225, s[72:75], s43 offen offset:1024 sc1 lds
    v_fmac_f32 v235, v66, v154
    v_fmac_f32 v235, v67, v155
    v_fmac_f32 v235, v68, v156
    v_fmac_f32 v235, v69, v157
    v_fmac_f32 v235, v70, v158
    v_mfma_f32_32x32x16_bf16 v[40:55], v[80:83], v[180:183], v[40:55]
    v_add_u32 v222, s48, v251
    ds_read2_b32 v[222:223], v222 offset0:1 offset1:3
    v_fmac_f32 v235, v71, v159
    v_mfma_f32_32x32x16_bf16 v[56:71], v[84:87], v[180:183], 0
    v_permlane32_swap_b32 v234, v240
    v_permlane32_swap_b32 v235, v241
    v_add_f32 v234, v234, v240
    v_add_f32 v235, v235, v241
    s_waitcnt vmcnt(4) lgkmcnt(1)
    v_mfma_f32_32x32x16_bf16 v[0:15], v[88:91], v[184:187], v[0:15]
    ds_read_b64_tr_b16 v[176:177], v246 offset:0
    ds_read_b64_tr_b16 v[178:179], v246 offset:1024
    ds_read_b64_tr_b16 v[180:181], v247 offset:0
    ds_read_b64_tr_b16 v[182:183], v247 offset:1024
    v_cvt_pk_bf16_f32 v234, v234, v235
    ds_write_b32 v232, v234 offset:256
    s_mov_b32 m0, s71
    v_mfma_f32_32x32x16_bf16 v[16:31], v[92:95], v[184:187], v[16:31]
    buffer_load_dwordx4 v226, s[4:7], s43 offen sc1 lds
    buffer_load_dwordx4 v227, s[72:75], s43 offen offset:1024 sc1 lds
    s_waitcnt lgkmcnt(5)
    v_mad_u32_u16 v222, v222, s39, v248 op_sel:[1,0,0,0]
    v_mad_u32_u16 v223, v223, s39, v248 op_sel:[1,0,0,0]
    v_mfma_f32_32x32x16_bf16 v[40:55], v[88:91], v[188:191], v[40:55]
    v_add_u32 v224, s49, v251
    ds_read2_b32 v[224:225], v224 offset0:1 offset1:3
    v_mfma_f32_32x32x16_bf16 v[56:71], v[92:95], v[188:191], v[56:71]
    s_waitcnt vmcnt(4) lgkmcnt(2)
    v_mfma_f32_32x32x16_bf16 v[0:15], v[228:231], v[176:179], v[0:15]
    ds_read_b64_tr_b16 v[184:185], v246 offset:2048
    ds_read_b64_tr_b16 v[186:187], v246 offset:3072
    ds_read_b64_tr_b16 v[188:189], v247 offset:2048
    ds_read_b64_tr_b16 v[190:191], v247 offset:3072
    s_mov_b32 m0, s68
    v_mfma_f32_32x32x16_bf16 v[16:31], v[242:245], v[176:179], v[16:31]
    buffer_load_dwordx4 v222, s[4:7], s44 offen sc1 lds
    buffer_load_dwordx4 v223, s[72:75], s44 offen offset:1024 sc1 lds
    s_waitcnt lgkmcnt(4)
    v_mad_u32_u16 v224, v224, s39, v248 op_sel:[1,0,0,0]
    v_mad_u32_u16 v225, v225, s39, v248 op_sel:[1,0,0,0]
    v_mfma_f32_32x32x16_bf16 v[40:55], v[228:231], v[180:183], v[40:55]
    v_add_u32 v226, s50, v251
    ds_read2_b32 v[226:227], v226 offset0:1 offset1:3
    v_mul_f32 v240, v0, v144
    v_mul_f32 v236, v8, v160
    v_fmac_f32 v240, v1, v145
    v_fmac_f32 v236, v9, v161
    v_fmac_f32 v240, v2, v146
    v_mfma_f32_32x32x16_bf16 v[56:71], v[242:245], v[180:183], v[56:71]
    s_setprio 0
    v_fmac_f32 v236, v10, v162
    v_fmac_f32 v240, v3, v147
    v_fmac_f32 v236, v11, v163
    v_fmac_f32 v240, v4, v148
    v_fmac_f32 v236, v12, v164
    v_fmac_f32 v240, v5, v149
    v_fmac_f32 v236, v13, v165
    v_fmac_f32 v240, v6, v150
    v_fmac_f32 v236, v14, v166
    v_fmac_f32 v240, v7, v151
    v_fmac_f32 v236, v15, v167
    v_mul_f32 v234, v16, v112
    v_mul_f32 v241, v40, v152
    v_mul_f32 v237, v48, v168
    v_fmac_f32 v234, v17, v113
    v_fmac_f32 v241, v41, v153
    v_fmac_f32 v237, v49, v169
    v_fmac_f32 v234, v18, v114
    v_fmac_f32 v241, v42, v154
    v_fmac_f32 v237, v50, v170
    v_fmac_f32 v234, v19, v115
    v_fmac_f32 v241, v43, v155
    v_fmac_f32 v237, v51, v171
    v_fmac_f32 v234, v20, v116
    v_fmac_f32 v241, v44, v156
    v_fmac_f32 v237, v52, v172
    v_fmac_f32 v234, v21, v117
    v_fmac_f32 v241, v45, v157
    v_fmac_f32 v237, v53, v173
    v_fmac_f32 v234, v22, v118
    v_fmac_f32 v241, v46, v158
    v_fmac_f32 v237, v54, v174
    v_fmac_f32 v234, v23, v119
    v_fmac_f32 v241, v47, v159
    v_fmac_f32 v237, v55, v175
    s_setprio 1
    s_waitcnt vmcnt(4) lgkmcnt(1)
    v_mfma_f32_32x32x16_bf16 v[8:23], v[80:83], v[184:187], 0
    ds_read_b64_tr_b16 v[176:177], v246 offset:4096
    ds_read_b64_tr_b16 v[178:179], v246 offset:5120
    ds_read_b64_tr_b16 v[180:181], v247 offset:4096
    ds_read_b64_tr_b16 v[182:183], v247 offset:5120
    v_mul_f32 v235, v56, v120
    v_fmac_f32 v235, v57, v121
    s_mov_b32 m0, s69
    v_mfma_f32_32x32x16_bf16 v[24:39], v[84:87], v[184:187], v[24:39]
    buffer_load_dwordx4 v224, s[4:7], s45 offen sc1 lds
    buffer_load_dwordx4 v225, s[72:75], s45 offen offset:1024 sc1 lds
    s_waitcnt lgkmcnt(4)
    v_mad_u32_u16 v226, v226, s39, v248 op_sel:[1,0,0,0]
    v_mad_u32_u16 v227, v227, s39, v248 op_sel:[1,0,0,0]
    v_fmac_f32 v235, v58, v122
    v_fmac_f32 v235, v59, v123
    v_mfma_f32_32x32x16_bf16 v[64:79], v[84:87], v[188:191], v[64:79]
    v_fmac_f32 v235, v60, v124
    v_fmac_f32 v235, v61, v125
    v_fmac_f32 v235, v62, v126
    v_fmac_f32 v235, v63, v127
    v_mfma_f32_32x32x16_bf16 v[48:63], v[80:83], v[188:191], 0
    v_permlane32_swap_b32 v236, v240
    v_permlane32_swap_b32 v237, v241
    v_add_f32 v236, v236, v240
    v_add_f32 v237, v237, v241
    s_waitcnt vmcnt(4) lgkmcnt(0)
    v_mfma_f32_32x32x16_bf16 v[8:23], v[88:91], v[176:179], v[8:23]
    ds_read_b64_tr_b16 v[184:185], v246 offset:6144
    ds_read_b64_tr_b16 v[186:187], v246 offset:7168
    ds_read_b64_tr_b16 v[188:189], v247 offset:6144
    ds_read_b64_tr_b16 v[190:191], v247 offset:7168
    v_cvt_pk_bf16_f32 v236, v236, v237
    ds_write_b32 v232, v236 offset:1024
    s_mov_b32 m0, s70
    v_mfma_f32_32x32x16_bf16 v[24:39], v[92:95], v[176:179], v[24:39]
    buffer_load_dwordx4 v226, s[4:7], s46 offen sc1 lds
    buffer_load_dwordx4 v227, s[72:75], s46 offen offset:1024 sc1 lds
    s_sub_u32 s26, s48, s29
    s_mov_b32 s29, s48
    s_mov_b32 s30, s3
    s_bfe_u32 s56, s3, 0x40012
    s_mov_b32 s32, s31
    v_mfma_f32_32x32x16_bf16 v[64:79], v[92:95], v[180:183], v[64:79]
    s_cmp_lg_u32 s36, 0
    s_cselect_b32 s56, s56, 0
    s_mov_b32 s31, s35
    v_mfma_f32_32x32x16_bf16 v[48:63], v[88:91], v[180:183], v[48:63]
    s_waitcnt vmcnt(4) lgkmcnt(1)
    v_mfma_f32_32x32x16_bf16 v[8:23], v[228:231], v[184:187], v[8:23]
    ds_read_b64_tr_b16 v[176:177], v246 offset:0
    ds_read_b64_tr_b16 v[178:179], v246 offset:1024
    ds_read_b64_tr_b16 v[180:181], v247 offset:0
    ds_read_b64_tr_b16 v[182:183], v247 offset:1024
    s_mov_b32 m0, s71
    v_mfma_f32_32x32x16_bf16 v[24:39], v[242:245], v[184:187], v[24:39]
    s_cmp_eq_u32 s33, 4
    s_cbranch_scc1 K2_g4_80
    buffer_load_dwordx4 v224, s[4:7], s47 offen sc1 lds
    buffer_load_dwordx4 v225, s[72:75], s47 offen offset:1024 sc1 lds
K2_back_81:
    v_mfma_f32_32x32x16_bf16 v[64:79], v[242:245], v[188:191], v[64:79]
    s_nop 0
    v_mul_f32 v236, v8, v144
    v_fma_f32 v238, v16, v160, -v238
    v_fmac_f32 v236, v9, v145
    v_fmac_f32 v238, v17, v161
    v_fmac_f32 v236, v10, v146
    v_fmac_f32 v238, v18, v162
    v_fmac_f32 v236, v11, v147
    v_mfma_f32_32x32x16_bf16 v[48:63], v[228:231], v[188:191], v[48:63]
    s_setprio 0
    v_fmac_f32 v238, v19, v163
    v_fmac_f32 v236, v12, v148
    v_fmac_f32 v238, v20, v164
    v_fmac_f32 v236, v13, v149
    v_fmac_f32 v238, v21, v165
    v_fmac_f32 v236, v14, v150
    v_fmac_f32 v238, v22, v166
    v_fmac_f32 v236, v15, v151
    v_fmac_f32 v238, v23, v167
    v_add_u32 v249, s26, v249
    v_add_u32 v250, s26, v250
    v_mul_f32 v240, v24, v160
    v_fma_f32 v234, v32, v112, -v234
    v_fmac_f32 v240, v25, v161
    v_fmac_f32 v234, v33, v113
    v_fmac_f32 v240, v26, v162
    v_fmac_f32 v234, v34, v114
    v_fmac_f32 v240, v27, v163
    v_fmac_f32 v234, v35, v115
    v_fmac_f32 v240, v28, v164
    v_fmac_f32 v234, v36, v116
    v_fmac_f32 v240, v29, v165
    v_fmac_f32 v234, v37, v117
    v_fmac_f32 v240, v30, v166
    v_fmac_f32 v234, v38, v118
    v_fmac_f32 v240, v31, v167
    v_fmac_f32 v234, v39, v119
    ds_read_b64_tr_b16 v[80:81], v249 offset:0
    ds_read_u16_d16_hi v40, v250 offset:0
    v_mul_f32 v241, v64, v168
    v_fma_f32 v235, v72, v120, -v235
    v_fmac_f32 v241, v65, v169
    v_fmac_f32 v235, v73, v121
    v_fmac_f32 v241, v66, v170
    v_fmac_f32 v235, v74, v122
    v_fmac_f32 v241, v67, v171
    v_fmac_f32 v235, v75, v123
    v_fmac_f32 v241, v68, v172
    v_fmac_f32 v235, v76, v124
    v_fmac_f32 v241, v69, v173
    v_fmac_f32 v235, v77, v125
    v_fmac_f32 v241, v70, v174
    v_fmac_f32 v235, v78, v126
    v_fmac_f32 v241, v71, v175
    v_fmac_f32 v235, v79, v127
    ds_read_b64_tr_b16 v[88:89], v249 offset:512
    ds_read_u16_d16_hi v41, v250 offset:128
    v_mul_f32 v237, v48, v152
    v_fma_f32 v239, v56, v168, -v239
    v_fmac_f32 v237, v49, v153
    v_fmac_f32 v239, v57, v169
    v_fmac_f32 v237, v50, v154
    v_fmac_f32 v239, v58, v170
    v_fmac_f32 v237, v51, v155
    v_fmac_f32 v239, v59, v171
    v_fmac_f32 v237, v52, v156
    v_fmac_f32 v239, v60, v172
    v_fmac_f32 v237, v53, v157
    v_fmac_f32 v239, v61, v173
    v_fmac_f32 v237, v54, v158
    v_fmac_f32 v239, v62, v174
    v_fmac_f32 v237, v55, v159
    v_fmac_f32 v239, v63, v175
    s_cmp_eq_u32 s56, 5
    s_cbranch_scc1 K2_U21
    s_cmp_eq_u32 s56, 6
    s_cbranch_scc1 K2_U3h1
    s_branch K2_DSP1
K2_U2h1:
    s_setprio 0
    s_waitcnt lgkmcnt(0)
    v_lshlrev_b32 v16, 16, v80
    v_and_b32 v17, 0xffff0000, v80
    v_lshlrev_b32 v18, 16, v81
    v_and_b32 v19, 0xffff0000, v81
    v_mov_b32 v82, v81
    v_mul_f32_dpp v32, v40, v16 row_newbcast:0 row_mask:0xf bank_mask:0xf
    v_mul_f32_dpp v33, v40, v17 row_newbcast:1 row_mask:0xf bank_mask:0xf
    v_mul_f32_dpp v34, v40, v18 row_newbcast:2 row_mask:0xf bank_mask:0xf
    v_mul_f32_dpp v35, v40, v19 row_newbcast:3 row_mask:0xf bank_mask:0xf
    v_mul_f32_dpp v36, v40, v16 row_newbcast:4 row_mask:0xf bank_mask:0xf
    v_mul_f32_dpp v37, v40, v17 row_newbcast:5 row_mask:0xf bank_mask:0xf
    v_mul_f32_dpp v38, v40, v18 row_newbcast:6 row_mask:0xf bank_mask:0xf
    v_mul_f32_dpp v39, v40, v19 row_newbcast:7 row_mask:0xf bank_mask:0xf
    v_cvt_pk_bf16_f32 v81, v32, v33
    v_cvt_pk_bf16_f32 v83, v34, v35
    v_mul_f32_dpp v16, v40, v16 row_newbcast:8 row_mask:0xf bank_mask:0xf
    v_mul_f32_dpp v17, v40, v17 row_newbcast:9 row_mask:0xf bank_mask:0xf
    v_mul_f32_dpp v18, v40, v18 row_newbcast:10 row_mask:0xf bank_mask:0xf
    v_mul_f32_dpp v19, v40, v19 row_newbcast:11 row_mask:0xf bank_mask:0xf
    v_cvt_pk_bf16_f32 v84, v36, v37
    v_cvt_pk_bf16_f32 v86, v38, v39
    v_cvt_pk_bf16_f32 v85, v16, v17
    v_cvt_pk_bf16_f32 v87, v18, v19
    v_permlane16_swap_b32 v80, v81
    v_permlane16_swap_b32 v82, v83
    v_lshlrev_b32 v24, 16, v88
    v_and_b32 v25, 0xffff0000, v88
    v_permlane16_swap_b32 v84, v85
    v_permlane16_swap_b32 v86, v87
    v_mul_f32_dpp v32, v41, v24 row_newbcast:0 row_mask:0xf bank_mask:0xf
    v_mul_f32_dpp v33, v41, v25 row_newbcast:1 row_mask:0xf bank_mask:0xf
    v_mul_f32_dpp v36, v41, v24 row_newbcast:4 row_mask:0xf bank_mask:0xf
    v_mul_f32_dpp v37, v41, v25 row_newbcast:5 row_mask:0xf bank_mask:0xf
    v_cvt_pk_bf16_f32 v89, v32, v33
    v_mul_f32_dpp v24, v41, v24 row_newbcast:8 row_mask:0xf bank_mask:0xf
    v_mul_f32_dpp v25, v41, v25 row_newbcast:9 row_mask:0xf bank_mask:0xf
    v_cvt_pk_bf16_f32 v92, v36, v37
    v_cvt_pk_bf16_f32 v93, v24, v25
    v_permlane16_swap_b32 v88, v89
    s_nop 0
    v_permlane16_swap_b32 v92, v93
    s_waitcnt vmcnt(4)
    s_setprio 1
    v_mfma_f32_32x32x16_bf16 v[8:23], v[80:83], v[176:179], 0
    ds_read_b64_tr_b16 v[184:185], v246 offset:2048
    ds_read_b64_tr_b16 v[188:189], v247 offset:2048
    s_mov_b32 m0, s68
    v_mfma_f32_32x32x16_bf16 v[24:39], v[84:87], v[176:179], 0
    buffer_load_dwordx4 v222, s[4:7], s42 offen sc1 lds
    buffer_load_dwordx4 v223, s[72:75], s42 offen offset:1024 sc1 lds
    v_permlane32_swap_b32 v236, v234
    v_permlane32_swap_b32 v237, v235
    v_mfma_f32_32x32x16_bf16 v[48:63], v[80:83], v[180:183], 0
    v_permlane32_swap_b32 v240, v238
    v_permlane32_swap_b32 v241, v239
    v_add_f32 v236, v236, v234
    v_add_f32 v237, v237, v235
    v_add_f32 v240, -v240, -v238
    v_mfma_f32_32x32x16_bf16 v[64:79], v[84:87], v[180:183], 0
    v_add_f32 v241, -v241, -v239
    v_cvt_pk_bf16_f32 v236, v236, v237
    v_cvt_pk_bf16_f32 v240, v240, v241
    ds_write2st64_b32 v232, v236, v240 offset0:2 offset1:3
    s_mov_b64 exec, 0x1ff
    ds_add_rtn_u32 v42, v254, v251
    s_mov_b64 exec, -1
    s_waitcnt vmcnt(4) lgkmcnt(2)
    v_mfma_f32_32x32x8_bf16 v[8:23], v[88:89], v[184:185], v[8:23]
    ds_read_b64_tr_b16 v[176:177], v246 offset:4096
    ds_read_b64_tr_b16 v[178:179], v246 offset:5120
    ds_read_b64_tr_b16 v[180:181], v247 offset:4096
    ds_read_b64_tr_b16 v[182:183], v247 offset:5120
    s_mov_b32 m0, s69
    v_mfma_f32_32x32x8_bf16 v[24:39], v[92:93], v[184:185], v[24:39]
    buffer_load_dwordx4 v224, s[4:7], s42 offen sc1 lds
    s_waitcnt lgkmcnt(4)
    v_readlane_b32 s58, v42, 8
    v_mfma_f32_32x32x8_bf16 v[48:63], v[88:89], v[188:189], v[48:63]
    s_lshr_b32 s58, s58, 4
    s_cmp_lt_u32 s58, s22
    s_cbranch_scc0 K2_nul_82
    v_readlane_b32 s3, v253, s58
    s_nop 0
    s_bfe_u32 s58, s3, 0x60016
    s_and_b32 s59, s58, 7
    s_lshr_b32 s60, s58, 3
K2_chk_84:
    v_readlane_b32 s61, v42, s59
    s_nop 0
    s_cmp_gt_u32 s61, s60
    s_cbranch_scc0 K2_spin_83
K2_back_85:
    v_mfma_f32_32x32x8_bf16 v[64:79], v[92:93], v[188:189], v[64:79]
    s_setprio 0
    s_lshl_b32 s44, s34, 7
    s_and_b32 s48, s3, 0x3ffff
    s_bfe_u32 s33, s3, 0x30013
    s_mov_b32 s35, s48
    s_mov_b32 s45, s44
    s_xor_b32 s47, s44, 256
    v_mul_f32 v234, v8, v96
    v_mul_f32 v236, v16, v128
    v_fmac_f32 v234, v9, v97
    v_fmac_f32 v236, v17, v129
    v_fmac_f32 v234, v10, v98
    v_fmac_f32 v236, v18, v130
    v_fmac_f32 v234, v11, v99
    v_fmac_f32 v236, v19, v131
    v_fmac_f32 v234, v12, v100
    v_fmac_f32 v236, v20, v132
    v_fmac_f32 v234, v13, v101
    v_fmac_f32 v236, v21, v133
    v_fmac_f32 v234, v14, v102
    v_fmac_f32 v236, v22, v134
    v_fmac_f32 v234, v15, v103
    v_fmac_f32 v236, v23, v135
    v_mul_f32 v238, v24, v128
    v_mul_f32 v240, v32, v128
    v_fmac_f32 v238, v25, v129
    v_fmac_f32 v240, v33, v129
    v_fmac_f32 v238, v26, v130
    v_fmac_f32 v240, v34, v130
    v_fmac_f32 v238, v27, v131
    v_fmac_f32 v240, v35, v131
    v_fmac_f32 v238, v28, v132
    v_fmac_f32 v240, v36, v132
    v_fmac_f32 v238, v29, v133
    v_fmac_f32 v240, v37, v133
    v_fmac_f32 v238, v30, v134
    v_fmac_f32 v240, v38, v134
    v_fmac_f32 v238, v31, v135
    v_fmac_f32 v240, v39, v135
    v_mul_f32 v235, v48, v104
    v_mul_f32 v237, v56, v136
    v_fmac_f32 v235, v49, v105
    v_fmac_f32 v237, v57, v137
    v_fmac_f32 v235, v50, v106
    v_fmac_f32 v237, v58, v138
    v_fmac_f32 v235, v51, v107
    v_fmac_f32 v237, v59, v139
    v_fmac_f32 v235, v52, v108
    v_fmac_f32 v237, v60, v140
    v_fmac_f32 v235, v53, v109
    v_fmac_f32 v237, v61, v141
    v_fmac_f32 v235, v54, v110
    v_fmac_f32 v237, v62, v142
    v_fmac_f32 v235, v55, v111
    v_fmac_f32 v237, v63, v143
    v_mul_f32 v239, v64, v136
    v_mul_f32 v241, v72, v136
    s_setprio 1
    s_waitcnt vmcnt(3) lgkmcnt(0)
    v_mfma_f32_32x32x16_bf16 v[24:39], v[80:83], v[176:179], 0
    ds_read_b64_tr_b16 v[184:185], v246 offset:6144
    ds_read_b64_tr_b16 v[188:189], v247 offset:6144
    v_fmac_f32 v239, v65, v137
    v_fmac_f32 v241, v73, v137
    v_fmac_f32 v239, v66, v138
    v_fmac_f32 v241, v74, v138
    s_mov_b32 m0, s70
    v_mfma_f32_32x32x16_bf16 v[8:23], v[84:87], v[176:179], 0
    buffer_load_dwordx4 v222, s[4:7], s43 offen sc1 lds
    buffer_load_dwordx4 v223, s[72:75], s43 offen offset:1024 sc1 lds
    v_fmac_f32 v239, v67, v139
    v_fmac_f32 v241, v75, v139
    v_fmac_f32 v239, v68, v140
    v_fmac_f32 v241, v76, v140
    v_fmac_f32 v239, v69, v141
    v_mfma_f32_32x32x16_bf16 v[48:63], v[84:87], v[180:183], 0
    s_add_u32 s49, s48, 128
    s_add_u32 s60, s48, 256
    s_cmp_eq_u32 s33, 3
    s_cselect_b32 s46, s44, s47
    s_cselect_b32 s50, s60, s48
    s_sub_u32 s60, s33, 2
    s_cmp_lt_u32 s60, 2
    s_cbranch_scc0 K2_rare_86
K2_back_87:
    v_add_u32 v222, s48, v251
    ds_read2_b32 v[222:223], v222 offset0:1 offset1:3
    v_fmac_f32 v241, v77, v141
    v_fmac_f32 v239, v70, v142
    v_fmac_f32 v241, v78, v142
    v_fmac_f32 v239, v71, v143
    v_fmac_f32 v241, v79, v143
    v_mfma_f32_32x32x16_bf16 v[64:79], v[80:83], v[180:183], 0
    v_permlane32_swap_b32 v234, v236
    v_permlane32_swap_b32 v235, v237
    v_permlane32_swap_b32 v238, v239
    s_waitcnt vmcnt(3) lgkmcnt(1)
    v_mfma_f32_32x32x8_bf16 v[24:39], v[88:89], v[184:185], v[24:39]
    ds_read_b64_tr_b16 v[176:177], v246 offset:0
    ds_read_b64_tr_b16 v[178:179], v246 offset:1024
    ds_read_b64_tr_b16 v[180:181], v247 offset:0
    ds_read_b64_tr_b16 v[182:183], v247 offset:1024
    v_lshl_add_u32 v232, v252, 1, s31
    v_add_f32 v234, v234, v236
    s_mov_b32 m0, s71
    v_mfma_f32_32x32x8_bf16 v[8:23], v[92:93], v[184:185], v[8:23]
    buffer_load_dwordx4 v224, s[4:7], s43 offen sc1 lds
    s_waitcnt lgkmcnt(4)
    v_mad_u32_u16 v222, v222, s39, v248 op_sel:[1,0,0,0]
    v_mad_u32_u16 v223, v223, s39, v248 op_sel:[1,0,0,0]
    v_add_f32 v235, v235, v237
    v_add_f32 v238, -v238, -v239
    v_sub_u32 v239, v232, v233
    v_cvt_pk_bf16_f32 v234, v234, v235
    v_cvt_pk_bf16_f32 v238, v238, v238
    ds_write_b32 v232, v234 offset:0
    ds_write_b16 v239, v238 offset:1280
    v_mfma_f32_32x32x8_bf16 v[48:63], v[92:93], v[188:189], v[48:63]
    v_add_u32 v224, s49, v251
    ds_read2_b32 v[224:225], v224 offset0:1 offset1:3
    v_mov_b64 v[0:1], 0
    v_mov_b64 v[2:3], 0
    v_mov_b64 v[4:5], 0
    v_mov_b64 v[6:7], 0
    v_mov_b64 v[40:41], 0
    v_mov_b64 v[42:43], 0
    v_mov_b64 v[44:45], 0
    v_mov_b64 v[46:47], 0
    v_mfma_f32_32x32x8_bf16 v[64:79], v[88:89], v[188:189], v[64:79]
    s_setprio 0
    v_mul_f32 v234, v24, v144
    v_fmac_f32 v234, v25, v145
    v_fmac_f32 v234, v26, v146
    v_fmac_f32 v234, v27, v147
    v_fmac_f32 v234, v28, v148
    v_fmac_f32 v234, v29, v149
    v_fmac_f32 v234, v30, v150
    v_fmac_f32 v234, v31, v151
    v_mul_f32 v238, v16, v160
    v_mul_f32 v239, v56, v168
    v_fmac_f32 v238, v17, v161
    v_fmac_f32 v239, v57, v169
    v_fmac_f32 v238, v18, v162
    v_fmac_f32 v239, v58, v170
    v_fmac_f32 v238, v19, v163
    v_fmac_f32 v239, v59, v171
    v_fmac_f32 v238, v20, v164
    v_fmac_f32 v239, v60, v172
    v_fmac_f32 v238, v21, v165
    v_fmac_f32 v239, v61, v173
    v_fmac_f32 v238, v22, v166
    v_fmac_f32 v239, v62, v174
    v_fmac_f32 v238, v23, v167
    v_fmac_f32 v239, v63, v175
    s_setprio 1
    s_waitcnt vmcnt(3) lgkmcnt(3)
    v_mfma_f32_32x32x16_bf16 v[0:15], v[80:83], v[176:179], v[0:15]
    ds_read_b64_tr_b16 v[184:185], v246 offset:2048
    ds_read_b64_tr_b16 v[188:189], v247 offset:2048
    v_mul_f32 v235, v64, v152
    v_fmac_f32 v235, v65, v153
    v_fmac_f32 v235, v66, v154
    v_fmac_f32 v235, v67, v155
    s_mov_b32 m0, s68
    v_mfma_f32_32x32x16_bf16 v[16:31], v[84:87], v[176:179], 0
    buffer_load_dwordx4 v222, s[4:7], s44 offen sc1 lds
    buffer_load_dwordx4 v223, s[72:75], s44 offen offset:1024 sc1 lds
    s_waitcnt lgkmcnt(2)
    v_mad_u32_u16 v224, v224, s39, v248 op_sel:[1,0,0,0]
    v_mad_u32_u16 v225, v225, s39, v248 op_sel:[1,0,0,0]
    v_fmac_f32 v235, v68, v156
    v_fmac_f32 v235, v69, v157
    v_mfma_f32_32x32x16_bf16 v[40:55], v[80:83], v[180:183], v[40:55]
    v_add_u32 v226, s50, v251
    ds_read2_b32 v[226:227], v226 offset0:1 offset1:3
    v_fmac_f32 v235, v70, v158
    v_fmac_f32 v235, v71, v159
    v_mfma_f32_32x32x16_bf16 v[56:71], v[84:87], v[180:183], 0
    v_permlane32_swap_b32 v234, v240
    v_permlane32_swap_b32 v235, v241
    v_add_f32 v234, v234, v240
    v_add_f32 v235, v235, v241
    s_waitcnt vmcnt(3) lgkmcnt(1)
    v_mfma_f32_32x32x8_bf16 v[0:15], v[88:89], v[184:185], v[0:15]
    ds_read_b64_tr_b16 v[176:177], v246 offset:4096
    ds_read_b64_tr_b16 v[178:179], v246 offset:5120
    ds_read_b64_tr_b16 v[180:181], v247 offset:4096
    ds_read_b64_tr_b16 v[182:183], v247 offset:5120
    v_cvt_pk_bf16_f32 v234, v234, v235
    ds_write_b32 v232, v234 offset:256
    s_mov_b32 m0, s69
    v_mfma_f32_32x32x8_bf16 v[16:31], v[92:93], v[184:185], v[16:31]
    buffer_load_dwordx4 v224, s[4:7], s45 offen sc1 lds
    buffer_load_dwordx4 v225, s[72:75], s45 offen offset:1024 sc1 lds
    s_waitcnt lgkmcnt(5)
    v_mad_u32_u16 v226, v226, s39, v248 op_sel:[1,0,0,0]
    v_mad_u32_u16 v227, v227, s39, v248 op_sel:[1,0,0,0]
    v_mfma_f32_32x32x8_bf16 v[40:55], v[88:89], v[188:189], v[40:55]
    v_mul_f32 v240, v0, v144
    v_mul_f32 v236, v8, v160
    v_fmac_f32 v240, v1, v145
    v_fmac_f32 v236, v9, v161
    v_fmac_f32 v240, v2, v146
    v_fmac_f32 v236, v10, v162
    v_fmac_f32 v240, v3, v147
    v_mfma_f32_32x32x8_bf16 v[56:71], v[92:93], v[188:189], v[56:71]
    s_setprio 0
    v_fmac_f32 v236, v11, v163
    v_fmac_f32 v240, v4, v148
    v_fmac_f32 v236, v12, v164
    v_fmac_f32 v240, v5, v149
    v_fmac_f32 v236, v13, v165
    v_fmac_f32 v240, v6, v150
    v_fmac_f32 v236, v14, v166
    v_fmac_f32 v240, v7, v151
    v_fmac_f32 v236, v15, v167
    v_mul_f32 v234, v16, v112
    v_mul_f32 v241, v40, v152
    v_mul_f32 v237, v48, v168
    v_fmac_f32 v234, v17, v113
    v_fmac_f32 v241, v41, v153
    v_fmac_f32 v237, v49, v169
    v_fmac_f32 v234, v18, v114
    v_fmac_f32 v241, v42, v154
    v_fmac_f32 v237, v50, v170
    v_fmac_f32 v234, v19, v115
    v_fmac_f32 v241, v43, v155
    v_fmac_f32 v237, v51, v171
    v_fmac_f32 v234, v20, v116
    v_fmac_f32 v241, v44, v156
    v_fmac_f32 v237, v52, v172
    v_fmac_f32 v234, v21, v117
    v_fmac_f32 v241, v45, v157
    v_fmac_f32 v237, v53, v173
    v_fmac_f32 v234, v22, v118
    v_fmac_f32 v241, v46, v158
    v_fmac_f32 v237, v54, v174
    v_fmac_f32 v234, v23, v119
    v_fmac_f32 v241, v47, v159
    v_fmac_f32 v237, v55, v175
    s_setprio 1
    s_waitcnt vmcnt(4) lgkmcnt(1)
    v_mfma_f32_32x32x16_bf16 v[8:23], v[80:83], v[176:179], 0
    ds_read_b64_tr_b16 v[184:185], v246 offset:6144
    ds_read_b64_tr_b16 v[188:189], v247 offset:6144
    v_mul_f32 v235, v56, v120
    v_fmac_f32 v235, v57, v121
    v_fmac_f32 v235, v58, v122
    v_fmac_f32 v235, v59, v123
    s_mov_b32 m0, s70
    v_mfma_f32_32x32x16_bf16 v[24:39], v[84:87], v[176:179], v[24:39]
    buffer_load_dwordx4 v226, s[4:7], s46 offen sc1 lds
    buffer_load_dwordx4 v227, s[72:75], s46 offen offset:1024 sc1 lds
    v_fmac_f32 v235, v60, v124
    v_fmac_f32 v235, v61, v125
    v_fmac_f32 v235, v62, v126
    v_fmac_f32 v235, v63, v127
    s_sub_u32 s26, s48, s29
    v_mfma_f32_32x32x16_bf16 v[64:79], v[84:87], v[180:183], v[64:79]
    s_mov_b32 s29, s48
    s_mov_b32 s30, s3
    s_bfe_u32 s56, s3, 0x40012
    s_cmp_lg_u32 s36, 0
    s_cselect_b32 s56, s56, 0
    s_mov_b32 s32, s31
    s_mov_b32 s31, s35
    v_mfma_f32_32x32x16_bf16 v[48:63], v[80:83], v[180:183], 0
    v_permlane32_swap_b32 v236, v240
    v_permlane32_swap_b32 v237, v241
    v_add_f32 v236, v236, v240
    v_add_f32 v237, v237, v241
    s_waitcnt vmcnt(4) lgkmcnt(0)
    v_mfma_f32_32x32x8_bf16 v[8:23], v[88:89], v[184:185], v[8:23]
    ds_read_b64_tr_b16 v[176:177], v246 offset:0
    ds_read_b64_tr_b16 v[178:179], v246 offset:1024
    ds_read_b64_tr_b16 v[180:181], v247 offset:0
    ds_read_b64_tr_b16 v[182:183], v247 offset:1024
    v_cvt_pk_bf16_f32 v236, v236, v237
    ds_write_b32 v232, v236 offset:1024
    s_mov_b32 m0, s71
    v_mfma_f32_32x32x8_bf16 v[24:39], v[92:93], v[184:185], v[24:39]
    s_cmp_eq_u32 s33, 4
    s_cbranch_scc1 K2_g4_89
    buffer_load_dwordx4 v224, s[4:7], s47 offen sc1 lds
    buffer_load_dwordx4 v225, s[72:75], s47 offen offset:1024 sc1 lds
K2_back_90:
    v_mfma_f32_32x32x8_bf16 v[64:79], v[92:93], v[188:189], v[64:79]
    v_mul_f32 v236, v8, v144
    v_fma_f32 v238, v16, v160, -v238
    v_fmac_f32 v236, v9, v145
    v_fmac_f32 v238, v17, v161
    v_fmac_f32 v236, v10, v146
    v_fmac_f32 v238, v18, v162
    v_fmac_f32 v236, v11, v147
    v_mfma_f32_32x32x8_bf16 v[48:63], v[88:89], v[188:189], v[48:63]
    s_setprio 0
    v_fmac_f32 v238, v19, v163
    v_fmac_f32 v236, v12, v148
    v_fmac_f32 v238, v20, v164
    v_fmac_f32 v236, v13, v149
    v_fmac_f32 v238, v21, v165
    v_fmac_f32 v236, v14, v150
    v_fmac_f32 v238, v22, v166
    v_fmac_f32 v236, v15, v151
    v_fmac_f32 v238, v23, v167
    v_add_u32 v249, s26, v249
    v_add_u32 v250, s26, v250
    v_mul_f32 v240, v24, v160
    v_fma_f32 v234, v32, v112, -v234
    v_fmac_f32 v240, v25, v161
    v_fmac_f32 v234, v33, v113
    v_fmac_f32 v240, v26, v162
    v_fmac_f32 v234, v34, v114
    v_fmac_f32 v240, v27, v163
    v_fmac_f32 v234, v35, v115
    v_fmac_f32 v240, v28, v164
    v_fmac_f32 v234, v36, v116
    v_fmac_f32 v240, v29, v165
    v_fmac_f32 v234, v37, v117
    v_fmac_f32 v240, v30, v166
    v_fmac_f32 v234, v38, v118
    v_fmac_f32 v240, v31, v167
    v_fmac_f32 v234, v39, v119
    ds_read_b64_tr_b16 v[80:81], v249 offset:0
    ds_read_u16_d16_hi v40, v250 offset:0
    v_mul_f32 v241, v64, v168
    v_fma_f32 v235, v72, v120, -v235
    v_fmac_f32 v241, v65, v169
    v_fmac_f32 v235, v73, v121
    v_fmac_f32 v241, v66, v170
    v_fmac_f32 v235, v74, v122
    v_fmac_f32 v241, v67, v171
    v_fmac_f32 v235, v75, v123
    v_fmac_f32 v241, v68, v172
    v_fmac_f32 v235, v76, v124
    v_fmac_f32 v241, v69, v173
    v_fmac_f32 v235, v77, v125
    v_fmac_f32 v241, v70, v174
    v_fmac_f32 v235, v78, v126
    v_fmac_f32 v241, v71, v175
    v_fmac_f32 v235, v79, v127
    ds_read_b64_tr_b16 v[88:89], v249 offset:512
    ds_read_u16_d16_hi v41, v250 offset:128
    v_mul_f32 v237, v48, v152
    v_fma_f32 v239, v56, v168, -v239
    v_fmac_f32 v237, v49, v153
    v_fmac_f32 v239, v57, v169
    v_fmac_f32 v237, v50, v154
    v_fmac_f32 v239, v58, v170
    v_fmac_f32 v237, v51, v155
    v_fmac_f32 v239, v59, v171
    v_fmac_f32 v237, v52, v156
    v_fmac_f32 v239, v60, v172
    v_fmac_f32 v237, v53, v157
    v_fmac_f32 v239, v61, v173
    v_fmac_f32 v237, v54, v158
    v_fmac_f32 v239, v62, v174
    v_fmac_f32 v237, v55, v159
    v_fmac_f32 v239, v63, v175
    s_cmp_eq_u32 s56, 5
    s_cbranch_scc1 K2_U21
    s_cmp_eq_u32 s56, 6
    s_cbranch_scc1 K2_U3h1
    s_branch K2_DSP1
K2_PAD_SW:
    s_branch K2_HOP
K2_DSP0:
    s_cmp_eq_u32 s56, 4
    s_cbranch_scc1 K2_U20
    s_cmp_eq_u32 s56, 7
    s_cbranch_scc1 K2_U30
    s_cmp_gt_u32 s56, 7
    s_cbranch_scc1 K2_U40
    s_cmp_lg_u32 s56, 0
    s_cbranch_scc1 K2_U10
    s_branch K2_SWITCH
K2_DSP1:
    s_cmp_eq_u32 s56, 4
    s_cbranch_scc1 K2_U2h1
    s_cmp_eq_u32 s56, 7
    s_cbranch_scc1 K2_U31
    s_cmp_gt_u32 s56, 7
    s_cbranch_scc1 K2_U41
    s_cmp_lg_u32 s56, 0
    s_cbranch_scc1 K2_U11
    s_branch K2_TAIL
K2_SWITCH:
    v_lshlrev_b32 v60, 3, v252
    s_mov_b32 s64, 7176192
    buffer_load_dwordx4 v[56:59], v60, s[8:11], s64 offen sc1
    v_permlane32_swap_b32 v236, v234
    v_permlane32_swap_b32 v237, v235
    v_permlane32_swap_b32 v240, v238
    v_permlane32_swap_b32 v241, v239
    v_add_f32 v236, v236, v234
    v_add_f32 v237, v237, v235
    v_add_f32 v240, -v240, -v238
    v_add_f32 v241, -v241, -v239
    s_set_gpr_idx_on s32, gpr_idx(DST)
    s_nop 0
    v_cvt_pk_bf16_f32 v194, v236, v237
    v_cvt_pk_bf16_f32 v195, v240, v241
    s_set_gpr_idx_off
    v_bfe_u32 v61, v253, 22, 6
    v_lshlrev_b32 v62, 21, v252
    s_mov_b32 s58, 264241152
    v_lshlrev_b32 v61, 2, v61
    v_bfi_b32 v62, s58, v62, v253
    ds_bpermute_b32 v253, v61, v62
    v_lshrrev_b32 v254, 6, v252
    v_bfe_u32 v255, v252, 3, 2
    v_lshl_add_u32 v254, v254, 2, v255
    v_mul_u32_u24 v254, 640, v254
    v_bfe_u32 v255, v252, 5, 1
    v_lshl_add_u32 v254, v255, 5, v254
    v_and_b32 v255, 6, v252
    v_lshl_add_u32 v254, v255, 2, v254
    v_add_u32 v254, 152832, v254
    ds_read_b64_tr_b16 v[104:105], v254 offset:0
    ds_read_b64_tr_b16 v[106:107], v254 offset:5120
    ds_read_b64_tr_b16 v[108:109], v254 offset:64
    ds_read_b64_tr_b16 v[110:111], v254 offset:5184
    ds_read_b64_tr_b16 v[120:121], v254 offset:128
    ds_read_b64_tr_b16 v[122:123], v254 offset:5248
    ds_read_b64_tr_b16 v[124:125], v254 offset:192
    ds_read_b64_tr_b16 v[126:127], v254 offset:5312
    ds_read_b64_tr_b16 v[136:137], v254 offset:256
    ds_read_b64_tr_b16 v[138:139], v254 offset:5376
    ds_read_b64_tr_b16 v[140:141], v254 offset:320
    ds_read_b64_tr_b16 v[142:143], v254 offset:5440
    ds_read_b64_tr_b16 v[152:153], v254 offset:384
    ds_read_b64_tr_b16 v[154:155], v254 offset:5504
    ds_read_b64_tr_b16 v[156:157], v254 offset:448
    ds_read_b64_tr_b16 v[158:159], v254 offset:5568
    ds_read_b64_tr_b16 v[168:169], v254 offset:512
    ds_read_b64_tr_b16 v[170:171], v254 offset:5632
    ds_read_b64_tr_b16 v[172:173], v254 offset:576
    ds_read_b64_tr_b16 v[174:175], v254 offset:5696
    s_movk_i32 s40, 128
    s_movk_i32 s41, 384
    s_movk_i32 s42, 640
    s_movk_i32 s43, 896
    v_lshl_add_u32 v254, v252, 1, s53
    v_lshl_add_u32 v232, v252, 1, s35
    v_lshrrev_b32 v233, 6, v252
    v_mul_u32_u24 v233, 126, v233
    s_waitcnt lgkmcnt(15)
    v_lshlrev_b32 v96, 16, v104
    v_and_b32 v97, 0xffff0000, v104
    v_lshlrev_b32 v98, 16, v105
    v_and_b32 v99, 0xffff0000, v105
    v_lshlrev_b32 v100, 16, v106
    v_and_b32 v101, 0xffff0000, v106
    v_lshlrev_b32 v102, 16, v107
    v_and_b32 v103, 0xffff0000, v107
    v_lshlrev_b32 v104, 16, v108
    v_and_b32 v105, 0xffff0000, v108
    v_lshlrev_b32 v106, 16, v109
    v_and_b32 v107, 0xffff0000, v109
    v_lshlrev_b32 v108, 16, v110
    v_and_b32 v109, 0xffff0000, v110
    v_lshlrev_b32 v110, 16, v111
    v_and_b32 v111, 0xffff0000, v111
    s_waitcnt lgkmcnt(12)
    v_lshlrev_b32 v112, 16, v120
    v_and_b32 v113, 0xffff0000, v120
    v_lshlrev_b32 v114, 16, v121
    v_and_b32 v115, 0xffff0000, v121
    v_lshlrev_b32 v116, 16, v122
    v_and_b32 v117, 0xffff0000, v122
    v_lshlrev_b32 v118, 16, v123
    v_and_b32 v119, 0xffff0000, v123
    v_lshlrev_b32 v120, 16, v124
    v_and_b32 v121, 0xffff0000, v124
    v_lshlrev_b32 v122, 16, v125
    v_and_b32 v123, 0xffff0000, v125
    v_lshlrev_b32 v124, 16, v126
    v_and_b32 v125, 0xffff0000, v126
    v_lshlrev_b32 v126, 16, v127
    v_and_b32 v127, 0xffff0000, v127
    s_waitcnt lgkmcnt(8)
    v_lshlrev_b32 v128, 16, v136
    v_and_b32 v129, 0xffff0000, v136
    v_lshlrev_b32 v130, 16, v137
    v_and_b32 v131, 0xffff0000, v137
    v_lshlrev_b32 v132, 16, v138
    v_and_b32 v133, 0xffff0000, v138
    v_lshlrev_b32 v134, 16, v139
    v_and_b32 v135, 0xffff0000, v139
    v_lshlrev_b32 v136, 16, v140
    v_and_b32 v137, 0xffff0000, v140
    v_lshlrev_b32 v138, 16, v141
    v_and_b32 v139, 0xffff0000, v141
    v_lshlrev_b32 v140, 16, v142
    v_and_b32 v141, 0xffff0000, v142
    v_lshlrev_b32 v142, 16, v143
    v_and_b32 v143, 0xffff0000, v143
    s_waitcnt lgkmcnt(4)
    v_lshlrev_b32 v144, 16, v152
    v_and_b32 v145, 0xffff0000, v152
    v_lshlrev_b32 v146, 16, v153
    v_and_b32 v147, 0xffff0000, v153
    v_lshlrev_b32 v148, 16, v154
    v_and_b32 v149, 0xffff0000, v154
    v_lshlrev_b32 v150, 16, v155
    v_and_b32 v151, 0xffff0000, v155
    v_lshlrev_b32 v152, 16, v156
    v_and_b32 v153, 0xffff0000, v156
    v_lshlrev_b32 v154, 16, v157
    v_and_b32 v155, 0xffff0000, v157
    v_lshlrev_b32 v156, 16, v158
    v_and_b32 v157, 0xffff0000, v158
    v_lshlrev_b32 v158, 16, v159
    v_and_b32 v159, 0xffff0000, v159
    s_waitcnt lgkmcnt(0)
    v_lshlrev_b32 v160, 16, v168
    v_and_b32 v161, 0xffff0000, v168
    v_lshlrev_b32 v162, 16, v169
    v_and_b32 v163, 0xffff0000, v169
    v_lshlrev_b32 v164, 16, v170
    v_and_b32 v165, 0xffff0000, v170
    v_lshlrev_b32 v166, 16, v171
    v_and_b32 v167, 0xffff0000, v171
    v_lshlrev_b32 v168, 16, v172
    v_and_b32 v169, 0xffff0000, v172
    v_lshlrev_b32 v170, 16, v173
    v_and_b32 v171, 0xffff0000, v173
    v_lshlrev_b32 v172, 16, v174
    v_and_b32 v173, 0xffff0000, v174
    v_lshlrev_b32 v174, 16, v175
    v_and_b32 v175, 0xffff0000, v175
    s_waitcnt vmcnt(0)
K2_FLGW:
    s_or_b32 s58, s54, s20
    v_xor_b32 v56, s2, v56
    v_xor_b32 v57, s2, v57
    v_xor_b32 v58, s2, v58
    v_xor_b32 v59, s2, v59
    v_or3_b32 v56, v56, v57, v58
    v_or_b32 v56, v56, v59
    v_cmp_ne_u32 vcc, 0, v56
    s_nop 0
    s_cbranch_vccnz K2_FLGR
    s_cmp_eq_u32 s58, 0
    s_cbranch_scc1 K2_FLGY
K2_FLGOK:
    s_cmp_eq_u32 s36, 0
    s_cbranch_scc1 K2_TAIL2
    s_mov_b32 s29, s48
    s_mov_b32 s32, s31
    s_mov_b32 s30, s3
    s_mov_b32 s31, s35
    s_bfe_u32 s56, s3, 0x40012
    s_cmp_eq_u32 s56, 5
    s_cbranch_scc1 K2_U21
    s_cmp_eq_u32 s56, 6
    s_cbranch_scc1 K2_U3h1
    s_branch K2_DSP1
K2_dum_4:
    v_mov_b32 v42, -1
    s_mov_b32 m0, 163312
    s_mov_b64 exec, 1
    buffer_load_dwordx4 v42, s[16:19], 0 offen lds
    buffer_load_dwordx4 v42, s[16:19], 0 offen lds
    s_mov_b64 exec, -1
    s_branch K2_back_6
K2_nul_12:
    s_mov_b32 s58, 63
    s_mov_b32 s36, 0
    s_branch K2_back_15
K2_spin_13:
    s_sub_u32 s27, s27, 1
    s_cbranch_scc1 K2_END
    ds_read_b32 v42, v254
    s_waitcnt lgkmcnt(0)
    s_branch K2_chk_14
K2_dyn_10:
    v_lshl_add_u32 v254, v252, 1, s53
    s_mov_b64 exec, 0x1ff
    ds_add_rtn_u32 v42, v254, v251
    s_mov_b64 exec, -1
    s_waitcnt lgkmcnt(0)
    v_readlane_b32 s58, v42, 8
    s_nop 0
    s_lshr_b32 s58, s58, 4
    s_cmp_lt_u32 s58, s22
    s_cbranch_scc0 K2_nul_12
    v_readlane_b32 s3, v253, s58
    s_nop 0
    s_bfe_u32 s58, s3, 0x60016
    s_and_b32 s59, s58, 7
    s_lshr_b32 s60, s58, 3
K2_chk_14:
    v_readlane_b32 s61, v42, s59
    s_nop 0
    s_cmp_gt_u32 s61, s60
    s_cbranch_scc0 K2_spin_13
K2_back_15:
    s_mov_b32 s34, 1
    s_branch K2_back_11
K2_dum_21:
    v_mov_b32 v42, -1
    s_mov_b32 m0, 163312
    s_mov_b64 exec, 1
    buffer_load_dwordx4 v42, s[16:19], 0 offen lds
    buffer_load_dwordx4 v42, s[16:19], 0 offen lds
    s_mov_b64 exec, -1
    s_branch K2_back_23
K2_nul_27:
    s_mov_b32 s58, 63
    s_mov_b32 s36, 0
    s_branch K2_back_30
K2_spin_28:
    s_sub_u32 s27, s27, 1
    s_cbranch_scc1 K2_END
    ds_read_b32 v42, v254
    s_waitcnt lgkmcnt(0)
    s_branch K2_chk_29
K2_dyn_25:
    v_lshl_add_u32 v254, v252, 1, s53
    s_mov_b64 exec, 0x1ff
    ds_add_rtn_u32 v42, v254, v251
    s_mov_b64 exec, -1
    s_waitcnt lgkmcnt(0)
    v_readlane_b32 s58, v42, 8
    s_nop 0
    s_lshr_b32 s58, s58, 4
    s_cmp_lt_u32 s58, s22
    s_cbranch_scc0 K2_nul_27
    v_readlane_b32 s3, v253, s58
    s_nop 0
    s_bfe_u32 s58, s3, 0x60016
    s_and_b32 s59, s58, 7
    s_lshr_b32 s60, s58, 3
K2_chk_29:
    v_readlane_b32 s61, v42, s59
    s_nop 0
    s_cmp_gt_u32 s61, s60
    s_cbranch_scc0 K2_spin_28
K2_back_30:
    s_mov_b32 s34, 1
    s_branch K2_back_26
K2_dum_36:
    v_mov_b32 v42, -1
    s_mov_b32 m0, 163312
    s_mov_b64 exec, 1
    buffer_load_dwordx4 v42, s[16:19], 0 offen lds
    buffer_load_dwordx4 v42, s[16:19], 0 offen lds
    s_mov_b64 exec, -1
    s_branch K2_back_38
K2_nul_42:
    s_mov_b32 s58, 63
    s_mov_b32 s36, 0
    s_branch K2_back_45
K2_spin_43:
    s_sub_u32 s27, s27, 1
    s_cbranch_scc1 K2_END
    ds_read_b32 v42, v254
    s_waitcnt lgkmcnt(0)
    s_branch K2_chk_44
K2_dyn_40:
    v_lshl_add_u32 v254, v252, 1, s53
    s_mov_b64 exec, 0x1ff
    ds_add_rtn_u32 v42, v254, v251
    s_mov_b64 exec, -1
    s_waitcnt lgkmcnt(0)
    v_readlane_b32 s58, v42, 8
    s_nop 0
    s_lshr_b32 s58, s58, 4
    s_cmp_lt_u32 s58, s22
    s_cbranch_scc0 K2_nul_42
    v_readlane_b32 s3, v253, s58
    s_nop 0
    s_bfe_u32 s58, s3, 0x60016
    s_and_b32 s59, s58, 7
    s_lshr_b32 s60, s58, 3
K2_chk_44:
    v_readlane_b32 s61, v42, s59
    s_nop 0
    s_cmp_gt_u32 s61, s60
    s_cbranch_scc0 K2_spin_43
K2_back_45:
    s_mov_b32 s34, 1
    s_branch K2_back_41
K2_dum_51:
    v_mov_b32 v42, -1
    s_mov_b32 m0, 163312
    s_mov_b64 exec, 1
    buffer_load_dwordx4 v42, s[16:19], 0 offen lds
    buffer_load_dwordx4 v42, s[16:19], 0 offen lds
    s_mov_b64 exec, -1
    s_branch K2_back_53
K2_nul_55:
    s_mov_b32 s3, 949760
    s_mov_b32 s36, 0
    s_branch K2_back_58
K2_spin_56:
    s_sub_u32 s27, s27, 1
    s_cbranch_scc1 K2_END
    ds_read_b32 v42, v254
    s_waitcnt lgkmcnt(0)
    s_branch K2_chk_57
K2_nul_64:
    s_mov_b32 s3, 949760
    s_mov_b32 s36, 0
    s_branch K2_back_67
K2_spin_65:
    s_sub_u32 s27, s27, 1
    s_cbranch_scc1 K2_END
    ds_read_b32 v42, v254
    s_waitcnt lgkmcnt(0)
    s_branch K2_chk_66
K2_nul_73:
    s_mov_b32 s3, 949760
    s_mov_b32 s36, 0
    s_branch K2_back_76
K2_spin_74:
    s_sub_u32 s27, s27, 1
    s_cbranch_scc1 K2_END
    ds_read_b32 v42, v254
    s_waitcnt lgkmcnt(0)
    s_branch K2_chk_75
K2_nul_82:
    s_mov_b32 s3, 949760
    s_mov_b32 s36, 0
    s_branch K2_back_85
K2_spin_83:
    s_sub_u32 s27, s27, 1
    s_cbranch_scc1 K2_END
    ds_read_b32 v42, v254
    s_waitcnt lgkmcnt(0)
    s_branch K2_chk_84
K2_PAD_TL:
    s_branch K2_HOP
K2_TAIL2:
    v_lshlrev_b32 v229, 3, v252
    s_mul_i32 s58, s20, 20480
    s_add_u32 s58, s58, 6946816
    s_mul_i32 s59, s20, 8224
    buffer_load_dwordx4 v[96:99], v229, s[8:11], s58 offen offset:0 sc1
    buffer_load_dwordx4 v[100:103], v229, s[8:11], s58 offen offset:1024 sc1
    buffer_load_dwordx4 v[104:107], v229, s[8:11], s58 offen offset:2048 sc1
    buffer_load_dwordx4 v[108:111], v229, s[8:11], s58 offen offset:3072 sc1
    s_add_u32 s58, s58, 4096
    buffer_load_dwordx4 v[128:131], v229, s[8:11], s58 offen offset:0 sc1
    buffer_load_dwordx4 v[132:135], v229, s[8:11], s58 offen offset:1024 sc1
    buffer_load_dwordx4 v[136:139], v229, s[8:11], s58 offen offset:2048 sc1
    buffer_load_dwordx4 v[140:143], v229, s[8:11], s58 offen offset:3072 sc1
    v_lshl_add_u32 v228, v252, 1, s59
    v_lshrrev_b32 v226, 6, v252
    v_mul_u32_u24 v226, 126, v226
    v_sub_u32 v226, v228, v226
    s_branch K2_TAIL3
K2_TAIL:
    v_lshlrev_b32 v229, 3, v252
    s_mul_i32 s58, s20, 20480
    s_add_u32 s58, s58, 6946816
    s_mul_i32 s59, s20, 8224
    buffer_load_dwordx4 v[96:99], v229, s[8:11], s58 offen offset:0 sc1
    v_permlane32_swap_b32 v236, v234
    v_permlane32_swap_b32 v237, v235
    buffer_load_dwordx4 v[100:103], v229, s[8:11], s58 offen offset:1024 sc1
    v_permlane32_swap_b32 v240, v238
    v_permlane32_swap_b32 v241, v239
    buffer_load_dwordx4 v[104:107], v229, s[8:11], s58 offen offset:2048 sc1
    v_add_f32 v236, v236, v234
    v_add_f32 v237, v237, v235
    buffer_load_dwordx4 v[108:111], v229, s[8:11], s58 offen offset:3072 sc1
    v_add_f32 v240, -v240, -v238
    v_add_f32 v241, -v241, -v239
    s_add_u32 s58, s58, 4096
    buffer_load_dwordx4 v[128:131], v229, s[8:11], s58 offen offset:0 sc1
    v_cvt_pk_bf16_f32 v236, v236, v237
    v_cvt_pk_bf16_f32 v240, v240, v241
    buffer_load_dwordx4 v[132:135], v229, s[8:11], s58 offen offset:1024 sc1
    ds_write2st64_b32 v232, v236, v240 offset0:2 offset1:3
    v_lshl_add_u32 v228, v252, 1, s59
    buffer_load_dwordx4 v[136:139], v229, s[8:11], s58 offen offset:2048 sc1
    v_lshrrev_b32 v226, 6, v252
    v_mul_u32_u24 v226, 126, v226
    buffer_load_dwordx4 v[140:143], v229, s[8:11], s58 offen offset:3072 sc1
    v_sub_u32 v226, v228, v226
K2_TAIL3:
    s_waitcnt vmcnt(8)
    ds_write2st64_b32 v228, v192, v193 offset0:0 offset1:1
    ds_write2st64_b32 v228, v194, v195 offset0:2 offset1:3
    s_add_u32 s58, s58, 4096
    buffer_load_dwordx4 v[112:115], v229, s[8:11], s58 offen offset:0 sc1
    v_bfe_u32 v48, v252, 1, 4
    v_lshrrev_b32 v49, 5, v252
    ds_write_b16 v226, v197 offset:1280
    ds_write2st64_b32 v228, v196, v198 offset0:4 offset1:6
    buffer_load_dwordx4 v[116:119], v229, s[8:11], s58 offen offset:1024 sc1
    v_lshrrev_b32 v55, 3, v48
    v_lshlrev_b32 v52, 4, v49
    ds_write2st64_b32 v228, v199, v200 offset0:7 offset1:8
    ds_write2st64_b32 v228, v201, v202 offset0:9 offset1:10
    buffer_load_dwordx4 v[120:123], v229, s[8:11], s58 offen offset:2048 sc1
    v_and_b32 v54, 7, v48
    v_and_b32 v50, 7, v48
    ds_write_b16 v226, v203 offset:2816
    ds_write2st64_b32 v228, v204, v205 offset0:12 offset1:13
    buffer_load_dwordx4 v[124:127], v229, s[8:11], s58 offen offset:3072 sc1
    v_mul_u32_u24 v50, 8224, v50
    v_mul_u32_u24 v51, 1536, v55
    ds_write2st64_b32 v228, v206, v207 offset0:14 offset1:15
    ds_write2st64_b32 v228, v208, v210 offset0:16 offset1:18
    s_add_u32 s58, s58, 4096
    buffer_load_dwordx4 v[144:147], v229, s[8:11], s58 offen offset:0 sc1
    v_add_u32 v50, v50, v51
    v_add_u32 v222, v50, v52
    ds_write_b16 v226, v209 offset:4352
    ds_write2st64_b32 v228, v211, v212 offset0:19 offset1:20
    buffer_load_dwordx4 v[148:151], v229, s[8:11], s58 offen offset:1024 sc1
    v_mul_u32_u24 v51, 8224, v54
    v_add_u32 v232, v51, v52
    ds_write2st64_b32 v228, v213, v214 offset0:21 offset1:22
    ds_write2st64_b32 v228, v216, v217 offset0:24 offset1:25
    buffer_load_dwordx4 v[152:155], v229, s[8:11], s58 offen offset:2048 sc1
    v_lshl_add_u32 v247, v55, 8, v232
    v_mul_u32_u24 v51, 2080, v48
    ds_write_b16 v226, v215 offset:5888
    ds_write2st64_b32 v228, v218, v219 offset0:26 offset1:27
    buffer_load_dwordx4 v[156:159], v229, s[8:11], s58 offen offset:3072 sc1
    s_mov_b32 s60, 65536
    v_add3_u32 v223, v51, v52, s60
    ds_write_b32 v228, v220 offset:7168
    ds_write_b16 v226, v221 offset:7424
    s_add_u32 s58, s58, 4096
    buffer_load_dwordx4 v[160:163], v229, s[8:11], s58 offen offset:0 sc1
    v_mul_u32_u24 v51, 2080, v54
    s_mov_b32 s60, 132096
    buffer_load_dwordx4 v[164:167], v229, s[8:11], s58 offen offset:1024 sc1
    v_add3_u32 v225, v51, v52, s60
    v_lshl_add_u32 v248, v55, 8, v225
    buffer_load_dwordx4 v[168:171], v229, s[8:11], s58 offen offset:2048 sc1
    s_lshl_b32 s60, s20, 5
    v_lshl_add_u32 v49, v49, 3, s60
    buffer_load_dwordx4 v[172:175], v229, s[8:11], s58 offen offset:3072 sc1
    s_mov_b32 s60, 65536
    v_add3_u32 v255, v51, v49, s60
    v_lshl_add_u32 v246, v55, 9, v255
    v_bfe_u32 v53, v48, 2, 1
    v_lshl_add_u32 v49, v53, 4, v49
    v_add_u32 v254, v50, v49
    s_and_b32 s64, s55, s28
    s_waitcnt lgkmcnt(0)
    s_barrier
    s_cmp_eq_u32 s64, 0
    s_cbranch_scc1 K2_MULTI
    s_setprio 3
    ds_read_b128 v[48:51], v222 offset:0
    ds_read_b128 v[52:55], v222 offset:64
    ds_read_b128 v[56:59], v222 offset:640
    ds_read_b128 v[60:63], v222 offset:704
    ds_read_b128 v[64:67], v223 offset:0
    ds_read_b128 v[68:71], v223 offset:64
    ds_read_b128 v[72:75], v223 offset:640
    ds_read_b128 v[76:79], v223 offset:704
    ds_read_b128 v[80:83], v222 offset:3072
    ds_read_b128 v[84:87], v222 offset:3136
    ds_read_b128 v[88:91], v222 offset:3712
    s_waitcnt vmcnt(19) lgkmcnt(9)
    v_mfma_f32_16x16x32_bf16 v[0:3], v[96:99], v[48:51], 0
    ds_read_b128 v[92:95], v222 offset:3776
    s_waitcnt vmcnt(18)
    v_mfma_f32_16x16x32_bf16 v[0:3], v[100:103], v[52:55], v[0:3]
    ds_read_b128 v[48:51], v223 offset:33280
    s_waitcnt vmcnt(17) lgkmcnt(9)
    v_mfma_f32_16x16x32_bf16 v[0:3], v[104:107], v[56:59], v[0:3]
    s_bfe_u32 s60, s20, 0x10002
    s_lshl_b32 s60, s60, 4
    ds_read_b128 v[52:55], v223 offset:33344
    s_waitcnt vmcnt(16)
    v_mfma_f32_16x16x32_bf16 v[0:3], v[108:111], v[60:63], v[0:3]
    s_add_u32 s59, s59, s60
    v_add_u32 v228, s59, v229
    ds_read_b128 v[56:59], v223 offset:33920
    s_waitcnt vmcnt(15) lgkmcnt(9)
    v_mfma_f32_16x16x32_bf16 v[0:3], v[128:131], v[64:67], v[0:3]
    s_mul_i32 s60, s20, 2080
    s_add_u32 s60, s60, 65536
    ds_read_b128 v[60:63], v223 offset:33984
    s_waitcnt vmcnt(14)
    v_mfma_f32_16x16x32_bf16 v[0:3], v[132:135], v[68:71], v[0:3]
    v_add_u32 v249, s60, v229
    s_mov_b32 s63, 0xbfb8aa3b
    ds_read_b128 v[64:67], v232 offset:6144
    s_waitcnt vmcnt(13) lgkmcnt(9)
    v_mfma_f32_16x16x32_bf16 v[0:3], v[136:139], v[72:75], v[0:3]
    s_add_u32 s40, s20, s21
    s_lshl_b32 s40, s40, 10
    ds_read_b128 v[68:71], v232 offset:6208
    s_waitcnt vmcnt(12)
    v_mfma_f32_16x16x32_bf16 v[0:3], v[140:143], v[76:79], v[0:3]
    s_add_u32 s41, s40, 8192
    s_add_u32 s42, s40, 16384
    ds_read_b128 v[72:75], v232 offset:6784
    s_waitcnt lgkmcnt(9)
    v_mfma_f32_16x16x32_bf16 v[16:19], v[96:99], v[80:83], 0
    s_add_u32 s43, s40, 24576
    s_add_u32 s44, s40, 32768
    ds_read_b128 v[76:79], v232 offset:6848
    v_mfma_f32_16x16x32_bf16 v[16:19], v[100:103], v[84:87], v[16:19]
    ds_read_b128 v[80:83], v225 offset:0
    s_waitcnt lgkmcnt(9)
    v_mfma_f32_16x16x32_bf16 v[16:19], v[104:107], v[88:91], v[16:19]
    ds_read_b128 v[84:87], v225 offset:64
    v_mfma_f32_16x16x32_bf16 v[16:19], v[108:111], v[92:95], v[16:19]
    v_mul_f32 v204, s63, v0
    v_mul_f32 v205, s63, v1
    ds_read_b128 v[88:91], v225 offset:640
    s_waitcnt lgkmcnt(9)
    v_mfma_f32_16x16x32_bf16 v[16:19], v[128:131], v[48:51], v[16:19]
    v_mul_f32 v206, s63, v2
    ds_read_b128 v[92:95], v225 offset:704
    v_mfma_f32_16x16x32_bf16 v[16:19], v[132:135], v[52:55], v[16:19]
    v_mul_f32 v207, s63, v3
    ds_read_b128 v[48:51], v222 offset:128
    s_waitcnt lgkmcnt(9)
    v_mfma_f32_16x16x32_bf16 v[16:19], v[136:139], v[56:59], v[16:19]
    v_exp_f32 v204, v204
    ds_read_b128 v[52:55], v222 offset:1280
    v_mfma_f32_16x16x32_bf16 v[16:19], v[140:143], v[60:63], v[16:19]
    v_exp_f32 v205, v205
    ds_read_b128 v[56:59], v222 offset:384
    s_waitcnt lgkmcnt(9)
    v_mfma_f32_16x16x32_bf16 v[32:35], v[96:99], v[64:67], 0
    v_exp_f32 v206, v206
    ds_read_b128 v[60:63], v222 offset:192
    v_mfma_f32_16x16x32_bf16 v[32:35], v[100:103], v[68:71], v[32:35]
    v_exp_f32 v207, v207
    s_setprio 2
    ds_read_b128 v[64:67], v222 offset:1344
    s_waitcnt lgkmcnt(9)
    v_mfma_f32_16x16x32_bf16 v[32:35], v[104:107], v[72:75], v[32:35]
    v_add_f32 v204, 1.0, v204
    ds_read_b128 v[68:71], v222 offset:448
    v_mfma_f32_16x16x32_bf16 v[32:35], v[108:111], v[76:79], v[32:35]
    v_add_f32 v205, 1.0, v205
    v_add_f32 v206, 1.0, v206
    ds_read_b128 v[72:75], v222 offset:256
    s_waitcnt lgkmcnt(9)
    v_mfma_f32_16x16x32_bf16 v[32:35], v[128:131], v[80:83], v[32:35]
    v_add_f32 v207, 1.0, v207
    ds_read_b128 v[76:79], v222 offset:1152
    v_mfma_f32_16x16x32_bf16 v[32:35], v[132:135], v[84:87], v[32:35]
    v_rcp_f32 v204, v204
    ds_read_b128 v[80:83], v222 offset:512
    s_waitcnt lgkmcnt(9)
    v_mfma_f32_16x16x32_bf16 v[32:35], v[136:139], v[88:91], v[32:35]
    v_rcp_f32 v205, v205
    ds_read_b128 v[84:87], v222 offset:320
    v_mfma_f32_16x16x32_bf16 v[32:35], v[140:143], v[92:95], v[32:35]
    v_rcp_f32 v206, v206
    ds_read_b128 v[88:91], v222 offset:1216
    s_waitcnt vmcnt(11) lgkmcnt(9)
    v_mfma_f32_16x16x32_bf16 v[4:7], v[112:115], v[48:51], 0
    v_rcp_f32 v207, v207
    ds_read_b128 v[92:95], v222 offset:576
    v_mfma_f32_16x16x32_bf16 v[8:11], v[112:115], v[52:55], 0
    v_cvt_pk_bf16_f32 v176, v0, v1
    ds_read_b128 v[48:51], v222 offset:768
    s_waitcnt lgkmcnt(9)
    v_mfma_f32_16x16x32_bf16 v[12:15], v[112:115], v[56:59], 0
    v_cvt_pk_bf16_f32 v177, v2, v3
    ds_read_b128 v[52:55], v222 offset:896
    s_waitcnt vmcnt(10)
    v_mfma_f32_16x16x32_bf16 v[4:7], v[116:119], v[60:63], v[4:7]
    v_mul_f32 v208, s63, v16
    v_mul_f32 v209, s63, v17
    ds_read_b128 v[56:59], v222 offset:1024
    s_waitcnt lgkmcnt(9)
    v_mfma_f32_16x16x32_bf16 v[8:11], v[116:119], v[64:67], v[8:11]
    v_mul_f32 v210, s63, v18
    ds_read_b128 v[60:63], v222 offset:832
    v_mfma_f32_16x16x32_bf16 v[12:15], v[116:119], v[68:71], v[12:15]
    v_mul_f32 v211, s63, v19
    ds_read_b128 v[64:67], v222 offset:960
    s_waitcnt vmcnt(9) lgkmcnt(9)
    v_mfma_f32_16x16x32_bf16 v[4:7], v[120:123], v[72:75], v[4:7]
    v_exp_f32 v208, v208
    ds_read_b128 v[68:71], v222 offset:1088
    v_mfma_f32_16x16x32_bf16 v[8:11], v[120:123], v[76:79], v[8:11]
    v_exp_f32 v209, v209
    ds_read_b128 v[72:75], v223 offset:128
    s_waitcnt lgkmcnt(9)
    v_mfma_f32_16x16x32_bf16 v[12:15], v[120:123], v[80:83], v[12:15]
    v_exp_f32 v210, v210
    ds_read_b128 v[76:79], v223 offset:1280
    s_waitcnt vmcnt(8)
    v_mfma_f32_16x16x32_bf16 v[4:7], v[124:127], v[84:87], v[4:7]
    v_exp_f32 v211, v211
    ds_read_b128 v[80:83], v223 offset:384
    s_waitcnt lgkmcnt(9)
    v_mfma_f32_16x16x32_bf16 v[8:11], v[124:127], v[88:91], v[8:11]
    v_add_f32 v208, 1.0, v208
    ds_read_b128 v[84:87], v223 offset:192
    v_mfma_f32_16x16x32_bf16 v[12:15], v[124:127], v[92:95], v[12:15]
    v_add_f32 v209, 1.0, v209
    v_add_f32 v210, 1.0, v210
    ds_read_b128 v[88:91], v223 offset:1344
    s_waitcnt vmcnt(7) lgkmcnt(9)
    v_mfma_f32_16x16x32_bf16 v[4:7], v[144:147], v[48:51], v[4:7]
    v_add_f32 v211, 1.0, v211
    s_setprio 1
    ds_read_b128 v[92:95], v223 offset:448
    v_mfma_f32_16x16x32_bf16 v[8:11], v[144:147], v[52:55], v[8:11]
    v_rcp_f32 v208, v208
    ds_read_b128 v[48:51], v223 offset:256
    s_waitcnt lgkmcnt(9)
    v_mfma_f32_16x16x32_bf16 v[12:15], v[144:147], v[56:59], v[12:15]
    v_rcp_f32 v209, v209
    ds_read_b128 v[52:55], v223 offset:1152
    s_waitcnt vmcnt(6)
    v_mfma_f32_16x16x32_bf16 v[4:7], v[148:151], v[60:63], v[4:7]
    v_rcp_f32 v210, v210
    ds_read_b128 v[56:59], v223 offset:512
    s_waitcnt lgkmcnt(9)
    v_mfma_f32_16x16x32_bf16 v[8:11], v[148:151], v[64:67], v[8:11]
    v_rcp_f32 v211, v211
    ds_read_b128 v[60:63], v223 offset:320
    v_mfma_f32_16x16x32_bf16 v[12:15], v[148:151], v[68:71], v[12:15]
K2_PAD_T2:
    s_cbranch_execz K2_HOP
    v_cvt_pk_bf16_f32 v184, v16, v17
    ds_read_b128 v[64:67], v223 offset:1216
    s_waitcnt vmcnt(5) lgkmcnt(9)
    v_mfma_f32_16x16x32_bf16 v[4:7], v[152:155], v[72:75], v[4:7]
    v_cvt_pk_bf16_f32 v185, v18, v19
    ds_read_b128 v[68:71], v223 offset:576
    v_mfma_f32_16x16x32_bf16 v[8:11], v[152:155], v[76:79], v[8:11]
    v_mul_f32 v212, s63, v32
    v_mul_f32 v213, s63, v33
    ds_read_b128 v[72:75], v223 offset:768
    s_waitcnt lgkmcnt(9)
    v_mfma_f32_16x16x32_bf16 v[12:15], v[152:155], v[80:83], v[12:15]
    v_mul_f32 v214, s63, v34
    ds_read_b128 v[76:79], v223 offset:896
    s_waitcnt vmcnt(4)
    v_mfma_f32_16x16x32_bf16 v[4:7], v[156:159], v[84:87], v[4:7]
    v_mul_f32 v215, s63, v35
    ds_read_b128 v[80:83], v223 offset:1024
    s_waitcnt lgkmcnt(9)
    v_mfma_f32_16x16x32_bf16 v[8:11], v[156:159], v[88:91], v[8:11]
    v_exp_f32 v212, v212
    ds_read_b128 v[84:87], v223 offset:832
    v_mfma_f32_16x16x32_bf16 v[12:15], v[156:159], v[92:95], v[12:15]
    v_exp_f32 v213, v213
    ds_read_b128 v[88:91], v223 offset:960
    s_waitcnt vmcnt(3) lgkmcnt(9)
    v_mfma_f32_16x16x32_bf16 v[4:7], v[160:163], v[48:51], v[4:7]
    v_exp_f32 v214, v214
    ds_read_b128 v[92:95], v223 offset:1088
    v_mfma_f32_16x16x32_bf16 v[8:11], v[160:163], v[52:55], v[8:11]
    v_exp_f32 v215, v215
    ds_read_b128 v[48:51], v222 offset:3200
    s_waitcnt lgkmcnt(9)
    v_mfma_f32_16x16x32_bf16 v[12:15], v[160:163], v[56:59], v[12:15]
    v_add_f32 v212, 1.0, v212
    ds_read_b128 v[52:55], v222 offset:4352
    s_waitcnt vmcnt(2)
    v_mfma_f32_16x16x32_bf16 v[4:7], v[164:167], v[60:63], v[4:7]
    v_add_f32 v213, 1.0, v213
    v_add_f32 v214, 1.0, v214
    ds_read_b128 v[56:59], v222 offset:3456
    s_waitcnt lgkmcnt(9)
    v_mfma_f32_16x16x32_bf16 v[8:11], v[164:167], v[64:67], v[8:11]
    v_add_f32 v215, 1.0, v215
    ds_read_b128 v[60:63], v222 offset:3264
    v_mfma_f32_16x16x32_bf16 v[12:15], v[164:167], v[68:71], v[12:15]
    v_rcp_f32 v212, v212
    s_setprio 0
    ds_read_b128 v[64:67], v222 offset:4416
    s_waitcnt vmcnt(1) lgkmcnt(9)
    v_mfma_f32_16x16x32_bf16 v[4:7], v[168:171], v[72:75], v[4:7]
    v_rcp_f32 v213, v213
    ds_read_b128 v[68:71], v222 offset:3520
    v_mfma_f32_16x16x32_bf16 v[8:11], v[168:171], v[76:79], v[8:11]
    v_rcp_f32 v214, v214
    ds_read_b128 v[72:75], v222 offset:3328
    s_waitcnt lgkmcnt(9)
    v_mfma_f32_16x16x32_bf16 v[12:15], v[168:171], v[80:83], v[12:15]
    v_rcp_f32 v215, v215
    ds_read_b128 v[76:79], v222 offset:4224
    s_waitcnt vmcnt(0)
    v_mfma_f32_16x16x32_bf16 v[4:7], v[172:175], v[84:87], v[4:7]
    v_cvt_pk_bf16_f32 v220, v32, v33
    ds_read_b128 v[80:83], v222 offset:3584
    s_waitcnt lgkmcnt(9)
    v_mfma_f32_16x16x32_bf16 v[8:11], v[172:175], v[88:91], v[8:11]
    v_cvt_pk_bf16_f32 v221, v34, v35
    ds_read_b128 v[84:87], v222 offset:3392
    v_mfma_f32_16x16x32_bf16 v[12:15], v[172:175], v[92:95], v[12:15]
    ds_read_b128 v[88:91], v222 offset:4288
    s_waitcnt lgkmcnt(9)
    v_mfma_f32_16x16x32_bf16 v[20:23], v[112:115], v[48:51], 0
    ds_read_b128 v[92:95], v222 offset:3648
    v_mfma_f32_16x16x32_bf16 v[24:27], v[112:115], v[52:55], 0
    ds_read_b128 v[48:51], v222 offset:3840
    s_waitcnt lgkmcnt(9)
    v_mfma_f32_16x16x32_bf16 v[28:31], v[112:115], v[56:59], 0
    s_barrier
    s_setprio 3
    ds_read_b128 v[52:55], v222 offset:3968
    v_mfma_f32_16x16x32_bf16 v[20:23], v[116:119], v[60:63], v[20:23]
    v_mul_f32 v4, v4, v204
    ds_read_b128 v[56:59], v222 offset:4096
    s_waitcnt lgkmcnt(9)
    v_mfma_f32_16x16x32_bf16 v[24:27], v[116:119], v[64:67], v[24:27]
    v_mul_f32 v5, v5, v205
    ds_read_b128 v[60:63], v222 offset:3904
    v_mfma_f32_16x16x32_bf16 v[28:31], v[116:119], v[68:71], v[28:31]
    v_mul_f32 v6, v6, v206
    ds_read_b128 v[64:67], v222 offset:4032
    s_waitcnt lgkmcnt(9)
    v_mfma_f32_16x16x32_bf16 v[20:23], v[120:123], v[72:75], v[20:23]
    v_mul_f32 v7, v7, v207
    ds_read_b128 v[68:71], v222 offset:4160
    v_mfma_f32_16x16x32_bf16 v[24:27], v[120:123], v[76:79], v[24:27]
    v_cvt_pk_bf16_f32 v178, v4, v5
    ds_read_b128 v[72:75], v223 offset:33408
    s_waitcnt lgkmcnt(9)
    v_mfma_f32_16x16x32_bf16 v[28:31], v[120:123], v[80:83], v[28:31]
    v_cvt_pk_bf16_f32 v179, v6, v7
    ds_read_b128 v[76:79], v223 offset:34560
    v_mfma_f32_16x16x32_bf16 v[20:23], v[124:127], v[84:87], v[20:23]
    v_mul_f32 v8, v8, v204
    ds_read_b128 v[80:83], v223 offset:33664
    s_waitcnt lgkmcnt(9)
    v_mfma_f32_16x16x32_bf16 v[24:27], v[124:127], v[88:91], v[24:27]
    v_mul_f32 v9, v9, v205
    ds_read_b128 v[84:87], v223 offset:33472
    v_mfma_f32_16x16x32_bf16 v[28:31], v[124:127], v[92:95], v[28:31]
    v_mul_f32 v10, v10, v206
    ds_read_b128 v[88:91], v223 offset:34624
    s_waitcnt lgkmcnt(9)
    v_mfma_f32_16x16x32_bf16 v[20:23], v[144:147], v[48:51], v[20:23]
    v_mul_f32 v11, v11, v207
    s_setprio 2
    ds_read_b128 v[92:95], v223 offset:33728
    v_mfma_f32_16x16x32_bf16 v[24:27], v[144:147], v[52:55], v[24:27]
    v_cvt_pk_bf16_f32 v180, v8, v9
    ds_read_b128 v[48:51], v223 offset:33536
    s_waitcnt lgkmcnt(9)
    v_mfma_f32_16x16x32_bf16 v[28:31], v[144:147], v[56:59], v[28:31]
    v_cvt_pk_bf16_f32 v181, v10, v11
    ds_read_b128 v[52:55], v223 offset:34432
    v_mfma_f32_16x16x32_bf16 v[20:23], v[148:151], v[60:63], v[20:23]
    v_mul_f32 v12, v12, v204
    ds_read_b128 v[56:59], v223 offset:33792
    s_waitcnt lgkmcnt(9)
    v_mfma_f32_16x16x32_bf16 v[24:27], v[148:151], v[64:67], v[24:27]
    v_mul_f32 v13, v13, v205
    ds_read_b128 v[60:63], v223 offset:33600
    v_mfma_f32_16x16x32_bf16 v[28:31], v[148:151], v[68:71], v[28:31]
    v_mul_f32 v14, v14, v206
    ds_read_b128 v[64:67], v223 offset:34496
    s_waitcnt lgkmcnt(9)
    v_mfma_f32_16x16x32_bf16 v[20:23], v[152:155], v[72:75], v[20:23]
    v_mul_f32 v15, v15, v207
    ds_read_b128 v[68:71], v223 offset:33856
    v_mfma_f32_16x16x32_bf16 v[24:27], v[152:155], v[76:79], v[24:27]
    v_cvt_pk_bf16_f32 v182, v12, v13
    ds_read_b128 v[72:75], v223 offset:34048
    s_waitcnt lgkmcnt(9)
    v_mfma_f32_16x16x32_bf16 v[28:31], v[152:155], v[80:83], v[28:31]
    v_cvt_pk_bf16_f32 v183, v14, v15
    ds_read_b128 v[76:79], v223 offset:34176
    v_mfma_f32_16x16x32_bf16 v[20:23], v[156:159], v[84:87], v[20:23]
    ds_write_b64 v254, v[176:177] offset:0
    ds_write_b64 v254, v[178:179] offset:256
    ds_write_b64 v254, v[180:181] offset:512
    ds_write_b64 v254, v[182:183] offset:768
    ds_write_b64 v255, v[220:221] offset:0
    ds_read_b128 v[80:83], v223 offset:34304
    s_waitcnt lgkmcnt(14)
    v_mfma_f32_16x16x32_bf16 v[24:27], v[156:159], v[88:91], v[24:27]
    ds_read_b128 v[84:87], v223 offset:34112
    v_mfma_f32_16x16x32_bf16 v[28:31], v[156:159], v[92:95], v[28:31]
    s_setprio 1
    ds_read_b128 v[88:91], v223 offset:34240
    s_waitcnt lgkmcnt(14)
    v_mfma_f32_16x16x32_bf16 v[20:23], v[160:163], v[48:51], v[20:23]
    ds_read_b128 v[92:95], v223 offset:34368
    v_mfma_f32_16x16x32_bf16 v[24:27], v[160:163], v[52:55], v[24:27]
    ds_read_b128 v[48:51], v247 offset:6272
    s_waitcnt lgkmcnt(14)
    v_mfma_f32_16x16x32_bf16 v[28:31], v[160:163], v[56:59], v[28:31]
    ds_read_b128 v[52:55], v232 offset:7424
    v_mfma_f32_16x16x32_bf16 v[20:23], v[164:167], v[60:63], v[20:23]
    ds_read_b128 v[56:59], v247 offset:6336
    s_waitcnt lgkmcnt(14)
    v_mfma_f32_16x16x32_bf16 v[24:27], v[164:167], v[64:67], v[24:27]
    ds_read_b128 v[60:63], v232 offset:7488
    v_mfma_f32_16x16x32_bf16 v[28:31], v[164:167], v[68:71], v[28:31]
    ds_read_b128 v[64:67], v247 offset:6400
    s_waitcnt lgkmcnt(14)
    v_mfma_f32_16x16x32_bf16 v[20:23], v[168:171], v[72:75], v[20:23]
    ds_read_b128 v[68:71], v232 offset:7296
    v_mfma_f32_16x16x32_bf16 v[24:27], v[168:171], v[76:79], v[24:27]
    ds_read_b128 v[72:75], v247 offset:6464
    s_waitcnt lgkmcnt(9)
    v_mfma_f32_16x16x32_bf16 v[28:31], v[168:171], v[80:83], v[28:31]
    ds_read_b128 v[76:79], v232 offset:7360
    v_mfma_f32_16x16x32_bf16 v[20:23], v[172:175], v[84:87], v[20:23]
    s_setprio 0
    ds_read_b128 v[80:83], v247 offset:6912
    s_waitcnt lgkmcnt(9)
    v_mfma_f32_16x16x32_bf16 v[24:27], v[172:175], v[88:91], v[24:27]
    ds_read_b128 v[84:87], v232 offset:7040
    v_mfma_f32_16x16x32_bf16 v[28:31], v[172:175], v[92:95], v[28:31]
    ds_read_b128 v[88:91], v247 offset:6976
    s_waitcnt lgkmcnt(9)
    v_mfma_f32_16x16x32_bf16 v[36:39], v[112:115], v[48:51], 0
    ds_read_b128 v[92:95], v232 offset:7104
    v_mfma_f32_16x16x32_bf16 v[40:43], v[112:115], v[52:55], 0
    ds_read_b128 v[48:51], v248 offset:128
    s_waitcnt lgkmcnt(9)
    v_mfma_f32_16x16x32_bf16 v[36:39], v[116:119], v[56:59], v[36:39]
    s_barrier
    ds_read_b128 v[192:195], v228 offset:0
    ds_read_b128 v[196:199], v228 offset:1536
    s_setprio 3
    ds_read_b128 v[52:55], v225 offset:1280
    v_mfma_f32_16x16x32_bf16 v[40:43], v[116:119], v[60:63], v[40:43]
    v_mul_f32 v20, v20, v208
    v_mul_f32 v21, v21, v209
    ds_read_b128 v[56:59], v248 offset:192
    s_waitcnt lgkmcnt(11)
    v_mfma_f32_16x16x32_bf16 v[36:39], v[120:123], v[64:67], v[36:39]
    v_mul_f32 v22, v22, v210
    ds_read_b128 v[60:63], v225 offset:1344
    v_mfma_f32_16x16x32_bf16 v[40:43], v[120:123], v[68:71], v[40:43]
    v_mul_f32 v23, v23, v211
    ds_read_b128 v[64:67], v248 offset:256
    s_waitcnt lgkmcnt(11)
    v_mfma_f32_16x16x32_bf16 v[36:39], v[124:127], v[72:75], v[36:39]
    v_cvt_pk_bf16_f32 v186, v20, v21
    ds_read_b128 v[68:71], v225 offset:1152
    v_mfma_f32_16x16x32_bf16 v[40:43], v[124:127], v[76:79], v[40:43]
    v_cvt_pk_bf16_f32 v187, v22, v23
    ds_read_b128 v[72:75], v248 offset:320
    s_waitcnt lgkmcnt(11)
    v_mfma_f32_16x16x32_bf16 v[36:39], v[144:147], v[80:83], v[36:39]
    v_mul_f32 v24, v24, v208
    v_mul_f32 v25, v25, v209
    s_waitcnt lgkmcnt(6)
    buffer_store_dwordx4 v[192:195], v229, s[12:15], s40 offen sc1
    buffer_store_dwordx4 v[196:199], v229, s[12:15], s41 offen sc1
    s_setprio 2
    ds_read_b128 v[76:79], v225 offset:1216
    v_mfma_f32_16x16x32_bf16 v[40:43], v[144:147], v[84:87], v[40:43]
    v_mul_f32 v26, v26, v210
    ds_read_b128 v[80:83], v248 offset:768
    v_mfma_f32_16x16x32_bf16 v[36:39], v[148:151], v[88:91], v[36:39]
    v_mul_f32 v27, v27, v211
    ds_read_b128 v[84:87], v225 offset:896
    v_mfma_f32_16x16x32_bf16 v[40:43], v[148:151], v[92:95], v[40:43]
    v_cvt_pk_bf16_f32 v188, v24, v25
    ds_read_b128 v[88:91], v248 offset:832
    s_waitcnt lgkmcnt(9)
    v_mfma_f32_16x16x32_bf16 v[36:39], v[152:155], v[48:51], v[36:39]
    v_cvt_pk_bf16_f32 v189, v26, v27
    ds_read_b128 v[92:95], v225 offset:960
    v_mfma_f32_16x16x32_bf16 v[40:43], v[152:155], v[52:55], v[40:43]
    v_mul_f32 v28, v28, v208
    v_mul_f32 v29, v29, v209
    s_waitcnt lgkmcnt(8)
    v_mfma_f32_16x16x32_bf16 v[36:39], v[156:159], v[56:59], v[36:39]
    v_mul_f32 v30, v30, v210
    v_mfma_f32_16x16x32_bf16 v[40:43], v[156:159], v[60:63], v[40:43]
    v_mul_f32 v31, v31, v211
    s_setprio 1
    s_waitcnt lgkmcnt(6)
    v_mfma_f32_16x16x32_bf16 v[36:39], v[160:163], v[64:67], v[36:39]
    v_cvt_pk_bf16_f32 v190, v28, v29
    v_mfma_f32_16x16x32_bf16 v[40:43], v[160:163], v[68:71], v[40:43]
    v_cvt_pk_bf16_f32 v191, v30, v31
    s_waitcnt lgkmcnt(4)
    v_mfma_f32_16x16x32_bf16 v[36:39], v[164:167], v[72:75], v[36:39]
    ds_write_b64 v254, v[184:185] offset:3072
    ds_write_b64 v254, v[186:187] offset:3328
    ds_write_b64 v254, v[188:189] offset:3584
    ds_write_b64 v254, v[190:191] offset:3840
    v_mfma_f32_16x16x32_bf16 v[40:43], v[164:167], v[76:79], v[40:43]
    s_waitcnt lgkmcnt(6)
    v_mfma_f32_16x16x32_bf16 v[36:39], v[168:171], v[80:83], v[36:39]
    v_mfma_f32_16x16x32_bf16 v[40:43], v[168:171], v[84:87], v[40:43]
    s_setprio 0
    s_waitcnt lgkmcnt(4)
    v_mfma_f32_16x16x32_bf16 v[36:39], v[172:175], v[88:91], v[36:39]
    v_mfma_f32_16x16x32_bf16 v[40:43], v[172:175], v[92:95], v[40:43]
    s_nop 6
    v_mul_f32 v36, v36, v212
    v_mul_f32 v37, v37, v213
    v_mul_f32 v38, v38, v214
    v_mul_f32 v39, v39, v215
    v_cvt_pk_bf16_f32 v178, v36, v37
    v_cvt_pk_bf16_f32 v179, v38, v39
    v_mul_f32 v40, v40, v212
    v_mul_f32 v41, v41, v213
    v_mul_f32 v42, v42, v214
    v_mul_f32 v43, v43, v215
    v_cvt_pk_bf16_f32 v180, v40, v41
    v_cvt_pk_bf16_f32 v181, v42, v43
    ds_write_b64 v246, v[178:179] offset:256
    ds_write_b64 v255, v[180:181] offset:512
    s_waitcnt lgkmcnt(0)
    s_barrier
    ds_read_b128 v[192:195], v228 offset:3072
    ds_read_b128 v[196:199], v228 offset:4608
    ds_read_b128 v[200:203], v249
    s_waitcnt lgkmcnt(1)
    buffer_store_dwordx4 v[192:195], v229, s[12:15], s42 offen sc1
    buffer_store_dwordx4 v[196:199], v229, s[12:15], s43 offen sc1
K2_LASTROW:
    s_add_u32 s59, s20, 32
    s_cmp_ge_u32 s59, s22
    s_cbranch_scc1 K2_FIN
    s_waitcnt lgkmcnt(0)
    buffer_store_dwordx4 v[200:203], v229, s[12:15], s44 offen sc1
K2_FIN:
    s_endpgm
K2_MULTI:
    ds_read_b128 v[48:51], v222 offset:0
    ds_read_b128 v[52:55], v222 offset:64
    ds_read_b128 v[56:59], v222 offset:640
    ds_read_b128 v[60:63], v222 offset:704
    ds_read_b128 v[64:67], v223 offset:0
    ds_read_b128 v[68:71], v223 offset:64
    ds_read_b128 v[72:75], v223 offset:640
    ds_read_b128 v[76:79], v223 offset:704
    ds_read_b128 v[80:83], v222 offset:3072
    ds_read_b128 v[84:87], v222 offset:3136
    ds_read_b128 v[88:91], v222 offset:3712
    s_waitcnt vmcnt(19) lgkmcnt(9)
    v_mfma_f32_16x16x32_bf16 v[0:3], v[96:99], v[48:51], 0
    ds_read_b128 v[92:95], v222 offset:3776
    s_waitcnt vmcnt(18)
    v_mfma_f32_16x16x32_bf16 v[0:3], v[100:103], v[52:55], v[0:3]
    ds_read_b128 v[48:51], v223 offset:33280
    s_waitcnt vmcnt(17) lgkmcnt(9)
    v_mfma_f32_16x16x32_bf16 v[0:3], v[104:107], v[56:59], v[0:3]
    ds_read_b128 v[52:55], v223 offset:33344
    s_waitcnt vmcnt(16)
    v_mfma_f32_16x16x32_bf16 v[0:3], v[108:111], v[60:63], v[0:3]
    ds_read_b128 v[56:59], v223 offset:33920
    s_waitcnt vmcnt(15) lgkmcnt(9)
    v_mfma_f32_16x16x32_bf16 v[0:3], v[128:131], v[64:67], v[0:3]
    ds_read_b128 v[60:63], v223 offset:33984
    s_waitcnt vmcnt(14)
    v_mfma_f32_16x16x32_bf16 v[0:3], v[132:135], v[68:71], v[0:3]
    ds_read_b128 v[64:67], v232 offset:6144
    s_waitcnt vmcnt(13) lgkmcnt(9)
    v_mfma_f32_16x16x32_bf16 v[0:3], v[136:139], v[72:75], v[0:3]
    ds_read_b128 v[68:71], v232 offset:6208
    s_waitcnt vmcnt(12)
    v_mfma_f32_16x16x32_bf16 v[0:3], v[140:143], v[76:79], v[0:3]
    ds_read_b128 v[72:75], v232 offset:6784
    s_waitcnt lgkmcnt(9)
    v_mfma_f32_16x16x32_bf16 v[16:19], v[96:99], v[80:83], 0
    ds_read_b128 v[76:79], v232 offset:6848
    v_mfma_f32_16x16x32_bf16 v[16:19], v[100:103], v[84:87], v[16:19]
    ds_read_b128 v[80:83], v225 offset:0
    s_waitcnt lgkmcnt(9)
    v_mfma_f32_16x16x32_bf16 v[16:19], v[104:107], v[88:91], v[16:19]
    ds_read_b128 v[84:87], v225 offset:64
    v_mfma_f32_16x16x32_bf16 v[16:19], v[108:111], v[92:95], v[16:19]
    ds_read_b128 v[88:91], v225 offset:640
    s_waitcnt lgkmcnt(9)
    v_mfma_f32_16x16x32_bf16 v[16:19], v[128:131], v[48:51], v[16:19]
    ds_read_b128 v[92:95], v225 offset:704
    v_mfma_f32_16x16x32_bf16 v[16:19], v[132:135], v[52:55], v[16:19]
    ds_read_b128 v[48:51], v222 offset:128
    s_waitcnt lgkmcnt(9)
    v_mfma_f32_16x16x32_bf16 v[16:19], v[136:139], v[56:59], v[16:19]
    ds_read_b128 v[52:55], v222 offset:1280
    v_mfma_f32_16x16x32_bf16 v[16:19], v[140:143], v[60:63], v[16:19]
    ds_read_b128 v[56:59], v222 offset:384
    s_waitcnt lgkmcnt(9)
    v_mfma_f32_16x16x32_bf16 v[32:35], v[96:99], v[64:67], 0
    ds_read_b128 v[60:63], v222 offset:192
    v_mfma_f32_16x16x32_bf16 v[32:35], v[100:103], v[68:71], v[32:35]
    ds_read_b128 v[64:67], v222 offset:1344
    s_waitcnt lgkmcnt(9)
    v_mfma_f32_16x16x32_bf16 v[32:35], v[104:107], v[72:75], v[32:35]
    ds_read_b128 v[68:71], v222 offset:448
    v_mfma_f32_16x16x32_bf16 v[32:35], v[108:111], v[76:79], v[32:35]
    ds_read_b128 v[72:75], v222 offset:256
    s_waitcnt lgkmcnt(9)
    v_mfma_f32_16x16x32_bf16 v[32:35], v[128:131], v[80:83], v[32:35]
    ds_read_b128 v[76:79], v222 offset:1152
    v_mfma_f32_16x16x32_bf16 v[32:35], v[132:135], v[84:87], v[32:35]
    ds_read_b128 v[80:83], v222 offset:512
    s_waitcnt lgkmcnt(9)
    v_mfma_f32_16x16x32_bf16 v[32:35], v[136:139], v[88:91], v[32:35]
    ds_read_b128 v[84:87], v222 offset:320
    v_mfma_f32_16x16x32_bf16 v[32:35], v[140:143], v[92:95], v[32:35]
    ds_read_b128 v[88:91], v222 offset:1216
    s_waitcnt vmcnt(11) lgkmcnt(9)
    v_mfma_f32_16x16x32_bf16 v[4:7], v[112:115], v[48:51], 0
    ds_read_b128 v[92:95], v222 offset:576
    v_mfma_f32_16x16x32_bf16 v[8:11], v[112:115], v[52:55], 0
    ds_read_b128 v[48:51], v222 offset:768
    s_waitcnt lgkmcnt(9)
    v_mfma_f32_16x16x32_bf16 v[12:15], v[112:115], v[56:59], 0
    ds_read_b128 v[52:55], v222 offset:896
    s_waitcnt vmcnt(10)
    v_mfma_f32_16x16x32_bf16 v[4:7], v[116:119], v[60:63], v[4:7]
    ds_read_b128 v[56:59], v222 offset:1024
    s_waitcnt lgkmcnt(9)
    v_mfma_f32_16x16x32_bf16 v[8:11], v[116:119], v[64:67], v[8:11]
    ds_read_b128 v[60:63], v222 offset:832
    v_mfma_f32_16x16x32_bf16 v[12:15], v[116:119], v[68:71], v[12:15]
    ds_read_b128 v[64:67], v222 offset:960
    s_waitcnt vmcnt(9) lgkmcnt(9)
    v_mfma_f32_16x16x32_bf16 v[4:7], v[120:123], v[72:75], v[4:7]
    ds_read_b128 v[68:71], v222 offset:1088
    v_mfma_f32_16x16x32_bf16 v[8:11], v[120:123], v[76:79], v[8:11]
    ds_read_b128 v[72:75], v223 offset:128
    s_waitcnt lgkmcnt(9)
    v_mfma_f32_16x16x32_bf16 v[12:15], v[120:123], v[80:83], v[12:15]
    ds_read_b128 v[76:79], v223 offset:1280
    s_waitcnt vmcnt(8)
    v_mfma_f32_16x16x32_bf16 v[4:7], v[124:127], v[84:87], v[4:7]
    ds_read_b128 v[80:83], v223 offset:384
    s_waitcnt lgkmcnt(9)
    v_mfma_f32_16x16x32_bf16 v[8:11], v[124:127], v[88:91], v[8:11]
    ds_read_b128 v[84:87], v223 offset:192
    v_mfma_f32_16x16x32_bf16 v[12:15], v[124:127], v[92:95], v[12:15]
    ds_read_b128 v[88:91], v223 offset:1344
    s_waitcnt vmcnt(7) lgkmcnt(9)
    v_mfma_f32_16x16x32_bf16 v[4:7], v[144:147], v[48:51], v[4:7]
    ds_read_b128 v[92:95], v223 offset:448
    v_mfma_f32_16x16x32_bf16 v[8:11], v[144:147], v[52:55], v[8:11]
    ds_read_b128 v[48:51], v223 offset:256
    s_waitcnt lgkmcnt(9)
    v_mfma_f32_16x16x32_bf16 v[12:15], v[144:147], v[56:59], v[12:15]
    ds_read_b128 v[52:55], v223 offset:1152
    s_waitcnt vmcnt(6)
    v_mfma_f32_16x16x32_bf16 v[4:7], v[148:151], v[60:63], v[4:7]
    ds_read_b128 v[56:59], v223 offset:512
    s_waitcnt lgkmcnt(9)
    v_mfma_f32_16x16x32_bf16 v[8:11], v[148:151], v[64:67], v[8:11]
    ds_read_b128 v[60:63], v223 offset:320
    v_mfma_f32_16x16x32_bf16 v[12:15], v[148:151], v[68:71], v[12:15]
    ds_read_b128 v[64:67], v223 offset:1216
    s_waitcnt vmcnt(5) lgkmcnt(9)
    v_mfma_f32_16x16x32_bf16 v[4:7], v[152:155], v[72:75], v[4:7]
    ds_read_b128 v[68:71], v223 offset:576
    v_mfma_f32_16x16x32_bf16 v[8:11], v[152:155], v[76:79], v[8:11]
    ds_read_b128 v[72:75], v223 offset:768
    s_waitcnt lgkmcnt(9)
    v_mfma_f32_16x16x32_bf16 v[12:15], v[152:155], v[80:83], v[12:15]
    ds_read_b128 v[76:79], v223 offset:896
    s_waitcnt vmcnt(4)
    v_mfma_f32_16x16x32_bf16 v[4:7], v[156:159], v[84:87], v[4:7]
    ds_read_b128 v[80:83], v223 offset:1024
    s_waitcnt lgkmcnt(9)
    v_mfma_f32_16x16x32_bf16 v[8:11], v[156:159], v[88:91], v[8:11]
    ds_read_b128 v[84:87], v223 offset:832
    v_mfma_f32_16x16x32_bf16 v[12:15], v[156:159], v[92:95], v[12:15]
    ds_read_b128 v[88:91], v223 offset:960
    s_waitcnt vmcnt(3) lgkmcnt(9)
    v_mfma_f32_16x16x32_bf16 v[4:7], v[160:163], v[48:51], v[4:7]
    ds_read_b128 v[92:95], v223 offset:1088
    v_mfma_f32_16x16x32_bf16 v[8:11], v[160:163], v[52:55], v[8:11]
    ds_read_b128 v[48:51], v222 offset:3200
    s_waitcnt lgkmcnt(9)
    v_mfma_f32_16x16x32_bf16 v[12:15], v[160:163], v[56:59], v[12:15]
    ds_read_b128 v[52:55], v222 offset:4352
    s_waitcnt vmcnt(2)
    v_mfma_f32_16x16x32_bf16 v[4:7], v[164:167], v[60:63], v[4:7]
    ds_read_b128 v[56:59], v222 offset:3456
    s_waitcnt lgkmcnt(9)
    v_mfma_f32_16x16x32_bf16 v[8:11], v[164:167], v[64:67], v[8:11]
    ds_read_b128 v[60:63], v222 offset:3264
    v_mfma_f32_16x16x32_bf16 v[12:15], v[164:167], v[68:71], v[12:15]
    ds_read_b128 v[64:67], v222 offset:4416
    s_waitcnt vmcnt(1) lgkmcnt(9)
    v_mfma_f32_16x16x32_bf16 v[4:7], v[168:171], v[72:75], v[4:7]
    ds_read_b128 v[68:71], v222 offset:3520
    v_mfma_f32_16x16x32_bf16 v[8:11], v[168:171], v[76:79], v[8:11]
    ds_read_b128 v[72:75], v222 offset:3328
    s_waitcnt lgkmcnt(9)
    v_mfma_f32_16x16x32_bf16 v[12:15], v[168:171], v[80:83], v[12:15]
    ds_read_b128 v[76:79], v222 offset:4224
    s_waitcnt vmcnt(0)
    v_mfma_f32_16x16x32_bf16 v[4:7], v[172:175], v[84:87], v[4:7]
    ds_read_b128 v[80:83], v222 offset:3584
    s_waitcnt lgkmcnt(9)
    v_mfma_f32_16x16x32_bf16 v[8:11], v[172:175], v[88:91], v[8:11]
    ds_read_b128 v[84:87], v222 offset:3392
    v_mfma_f32_16x16x32_bf16 v[12:15], v[172:175], v[92:95], v[12:15]
    ds_read_b128 v[88:91], v222 offset:4288
    s_waitcnt lgkmcnt(9)
    v_mfma_f32_16x16x32_bf16 v[20:23], v[112:115], v[48:51], 0
    ds_read_b128 v[92:95], v222 offset:3648
    v_mfma_f32_16x16x32_bf16 v[24:27], v[112:115], v[52:55], 0
    ds_read_b128 v[48:51], v222 offset:3840
    s_waitcnt lgkmcnt(9)
    v_mfma_f32_16x16x32_bf16 v[28:31], v[112:115], v[56:59], 0
    ds_read_b128 v[52:55], v222 offset:3968
    v_mfma_f32_16x16x32_bf16 v[20:23], v[116:119], v[60:63], v[20:23]
    ds_read_b128 v[56:59], v222 offset:4096
    s_waitcnt lgkmcnt(9)
    v_mfma_f32_16x16x32_bf16 v[24:27], v[116:119], v[64:67], v[24:27]
    ds_read_b128 v[60:63], v222 offset:3904
    v_mfma_f32_16x16x32_bf16 v[28:31], v[116:119], v[68:71], v[28:31]
    ds_read_b128 v[64:67], v222 offset:4032
    s_waitcnt lgkmcnt(9)
    v_mfma_f32_16x16x32_bf16 v[20:23], v[120:123], v[72:75], v[20:23]
    ds_read_b128 v[68:71], v222 offset:4160
    v_mfma_f32_16x16x32_bf16 v[24:27], v[120:123], v[76:79], v[24:27]
    ds_read_b128 v[72:75], v223 offset:33408
    s_waitcnt lgkmcnt(9)
    v_mfma_f32_16x16x32_bf16 v[28:31], v[120:123], v[80:83], v[28:31]
    ds_read_b128 v[76:79], v223 offset:34560
    v_mfma_f32_16x16x32_bf16 v[20:23], v[124:127], v[84:87], v[20:23]
    ds_read_b128 v[80:83], v223 offset:33664
    s_waitcnt lgkmcnt(9)
    v_mfma_f32_16x16x32_bf16 v[24:27], v[124:127], v[88:91], v[24:27]
    ds_read_b128 v[84:87], v223 offset:33472
    v_mfma_f32_16x16x32_bf16 v[28:31], v[124:127], v[92:95], v[28:31]
    ds_read_b128 v[88:91], v223 offset:34624
    s_waitcnt lgkmcnt(9)
    v_mfma_f32_16x16x32_bf16 v[20:23], v[144:147], v[48:51], v[20:23]
    ds_read_b128 v[92:95], v223 offset:33728
    v_mfma_f32_16x16x32_bf16 v[24:27], v[144:147], v[52:55], v[24:27]
    ds_read_b128 v[48:51], v223 offset:33536
    s_waitcnt lgkmcnt(9)
    v_mfma_f32_16x16x32_bf16 v[28:31], v[144:147], v[56:59], v[28:31]
    ds_read_b128 v[52:55], v223 offset:34432
    v_mfma_f32_16x16x32_bf16 v[20:23], v[148:151], v[60:63], v[20:23]
    ds_read_b128 v[56:59], v223 offset:33792
    s_waitcnt lgkmcnt(9)
    v_mfma_f32_16x16x32_bf16 v[24:27], v[148:151], v[64:67], v[24:27]
    ds_read_b128 v[60:63], v223 offset:33600
    v_mfma_f32_16x16x32_bf16 v[28:31], v[148:151], v[68:71], v[28:31]
    ds_read_b128 v[64:67], v223 offset:34496
    s_waitcnt lgkmcnt(9)
    v_mfma_f32_16x16x32_bf16 v[20:23], v[152:155], v[72:75], v[20:23]
    ds_read_b128 v[68:71], v223 offset:33856
    v_mfma_f32_16x16x32_bf16 v[24:27], v[152:155], v[76:79], v[24:27]
    ds_read_b128 v[72:75], v223 offset:34048
    s_waitcnt lgkmcnt(9)
    v_mfma_f32_16x16x32_bf16 v[28:31], v[152:155], v[80:83], v[28:31]
    ds_read_b128 v[76:79], v223 offset:34176
    v_mfma_f32_16x16x32_bf16 v[20:23], v[156:159], v[84:87], v[20:23]
    ds_read_b128 v[80:83], v223 offset:34304
    s_waitcnt lgkmcnt(9)
    v_mfma_f32_16x16x32_bf16 v[24:27], v[156:159], v[88:91], v[24:27]
    ds_read_b128 v[84:87], v223 offset:34112
    v_mfma_f32_16x16x32_bf16 v[28:31], v[156:159], v[92:95], v[28:31]
    ds_read_b128 v[88:91], v223 offset:34240
    s_waitcnt lgkmcnt(9)
    v_mfma_f32_16x16x32_bf16 v[20:23], v[160:163], v[48:51], v[20:23]
    ds_read_b128 v[92:95], v223 offset:34368
    v_mfma_f32_16x16x32_bf16 v[24:27], v[160:163], v[52:55], v[24:27]
    ds_read_b128 v[48:51], v247 offset:6272
    s_waitcnt lgkmcnt(9)
    v_mfma_f32_16x16x32_bf16 v[28:31], v[160:163], v[56:59], v[28:31]
    ds_read_b128 v[52:55], v232 offset:7424
    v_mfma_f32_16x16x32_bf16 v[20:23], v[164:167], v[60:63], v[20:23]
    ds_read_b128 v[56:59], v247 offset:6336
    s_waitcnt lgkmcnt(9)
    v_mfma_f32_16x16x32_bf16 v[24:27], v[164:167], v[64:67], v[24:27]
    ds_read_b128 v[60:63], v232 offset:7488
    v_mfma_f32_16x16x32_bf16 v[28:31], v[164:167], v[68:71], v[28:31]
    ds_read_b128 v[64:67], v247 offset:6400
    s_waitcnt lgkmcnt(9)
    v_mfma_f32_16x16x32_bf16 v[20:23], v[168:171], v[72:75], v[20:23]
    ds_read_b128 v[68:71], v232 offset:7296
    v_mfma_f32_16x16x32_bf16 v[24:27], v[168:171], v[76:79], v[24:27]
    ds_read_b128 v[72:75], v247 offset:6464
    s_waitcnt lgkmcnt(9)
    v_mfma_f32_16x16x32_bf16 v[28:31], v[168:171], v[80:83], v[28:31]
    ds_read_b128 v[76:79], v232 offset:7360
    v_mfma_f32_16x16x32_bf16 v[20:23], v[172:175], v[84:87], v[20:23]
    ds_read_b128 v[80:83], v247 offset:6912
    s_waitcnt lgkmcnt(9)
    v_mfma_f32_16x16x32_bf16 v[24:27], v[172:175], v[88:91], v[24:27]
    ds_read_b128 v[84:87], v232 offset:7040
    v_mfma_f32_16x16x32_bf16 v[28:31], v[172:175], v[92:95], v[28:31]
    ds_read_b128 v[88:91], v247 offset:6976
    s_waitcnt lgkmcnt(9)
    v_mfma_f32_16x16x32_bf16 v[36:39], v[112:115], v[48:51], 0
    ds_read_b128 v[92:95], v232 offset:7104
    v_mfma_f32_16x16x32_bf16 v[40:43], v[112:115], v[52:55], 0
    ds_read_b128 v[48:51], v248 offset:128
    s_waitcnt lgkmcnt(9)
    v_mfma_f32_16x16x32_bf16 v[36:39], v[116:119], v[56:59], v[36:39]
    ds_read_b128 v[52:55], v225 offset:1280
    v_mfma_f32_16x16x32_bf16 v[40:43], v[116:119], v[60:63], v[40:43]
    ds_read_b128 v[56:59], v248 offset:192
    s_waitcnt lgkmcnt(9)
    v_mfma_f32_16x16x32_bf16 v[36:39], v[120:123], v[64:67], v[36:39]
    ds_read_b128 v[60:63], v225 offset:1344
    v_mfma_f32_16x16x32_bf16 v[40:43], v[120:123], v[68:71], v[40:43]
    ds_read_b128 v[64:67], v248 offset:256
    s_waitcnt lgkmcnt(9)
    v_mfma_f32_16x16x32_bf16 v[36:39], v[124:127], v[72:75], v[36:39]
    ds_read_b128 v[68:71], v225 offset:1152
    v_mfma_f32_16x16x32_bf16 v[40:43], v[124:127], v[76:79], v[40:43]
    ds_read_b128 v[72:75], v248 offset:320
    s_waitcnt lgkmcnt(9)
    v_mfma_f32_16x16x32_bf16 v[36:39], v[144:147], v[80:83], v[36:39]
    ds_read_b128 v[76:79], v225 offset:1216
    v_mfma_f32_16x16x32_bf16 v[40:43], v[144:147], v[84:87], v[40:43]
    ds_read_b128 v[80:83], v248 offset:768
    s_waitcnt lgkmcnt(9)
    v_mfma_f32_16x16x32_bf16 v[36:39], v[148:151], v[88:91], v[36:39]
    ds_read_b128 v[84:87], v225 offset:896
    v_mfma_f32_16x16x32_bf16 v[40:43], v[148:151], v[92:95], v[40:43]
    ds_read_b128 v[88:91], v248 offset:832
    s_waitcnt lgkmcnt(9)
    v_mfma_f32_16x16x32_bf16 v[36:39], v[152:155], v[48:51], v[36:39]
    ds_read_b128 v[92:95], v225 offset:960
    v_mfma_f32_16x16x32_bf16 v[40:43], v[152:155], v[52:55], v[40:43]
    s_waitcnt lgkmcnt(8)
    v_mfma_f32_16x16x32_bf16 v[36:39], v[156:159], v[56:59], v[36:39]
    v_mfma_f32_16x16x32_bf16 v[40:43], v[156:159], v[60:63], v[40:43]
    s_waitcnt lgkmcnt(6)
    v_mfma_f32_16x16x32_bf16 v[36:39], v[160:163], v[64:67], v[36:39]
    v_mfma_f32_16x16x32_bf16 v[40:43], v[160:163], v[68:71], v[40:43]
    s_waitcnt lgkmcnt(4)
    v_mfma_f32_16x16x32_bf16 v[36:39], v[164:167], v[72:75], v[36:39]
    v_mfma_f32_16x16x32_bf16 v[40:43], v[164:167], v[76:79], v[40:43]
    s_waitcnt lgkmcnt(2)
    v_mfma_f32_16x16x32_bf16 v[36:39], v[168:171], v[80:83], v[36:39]
    v_mfma_f32_16x16x32_bf16 v[40:43], v[168:171], v[84:87], v[40:43]
    s_waitcnt lgkmcnt(0)
    v_mfma_f32_16x16x32_bf16 v[36:39], v[172:175], v[88:91], v[36:39]
    v_mfma_f32_16x16x32_bf16 v[40:43], v[172:175], v[92:95], v[40:43]
    s_lshl_b32 s60, s54, 9
    s_lshl_b32 s61, s20, 6
    s_add_u32 s60, s60, s61
    s_mul_i32 s60, s60, 192
    s_add_u32 s60, s60, 10485760
    v_mul_u32_u24 v227, 96, v252
    s_cmp_lg_u32 s28, 0
    s_cbranch_scc1 K2_NOACC
    buffer_load_dwordx4 v[48:51], v227, s[8:11], s60 offen offset:0
    buffer_load_dwordx4 v[52:55], v227, s[8:11], s60 offen offset:16
    buffer_load_dwordx4 v[56:59], v227, s[8:11], s60 offen offset:32
    buffer_load_dwordx4 v[60:63], v227, s[8:11], s60 offen offset:48
    buffer_load_dwordx4 v[64:67], v227, s[8:11], s60 offen offset:64
    buffer_load_dwordx4 v[68:71], v227, s[8:11], s60 offen offset:80
    buffer_load_dwordx4 v[72:75], v227, s[8:11], s60 offen offset:96
    buffer_load_dwordx4 v[76:79], v227, s[8:11], s60 offen offset:112
    buffer_load_dwordx4 v[80:83], v227, s[8:11], s60 offen offset:128
    buffer_load_dwordx4 v[84:87], v227, s[8:11], s60 offen offset:144
    buffer_load_dwordx4 v[88:91], v227, s[8:11], s60 offen offset:160
    s_waitcnt vmcnt(0)
    v_add_f32 v0, v0, v48
    v_add_f32 v1, v1, v49
    v_add_f32 v2, v2, v50
    v_add_f32 v3, v3, v51
    v_add_f32 v4, v4, v52
    v_add_f32 v5, v5, v53
    v_add_f32 v6, v6, v54
    v_add_f32 v7, v7, v55
    v_add_f32 v8, v8, v56
    v_add_f32 v9, v9, v57
    v_add_f32 v10, v10, v58
    v_add_f32 v11, v11, v59
    v_add_f32 v12, v12, v60
    v_add_f32 v13, v13, v61
    v_add_f32 v14, v14, v62
    v_add_f32 v15, v15, v63
    v_add_f32 v16, v16, v64
    v_add_f32 v17, v17, v65
    v_add_f32 v18, v18, v66
    v_add_f32 v19, v19, v67
    v_add_f32 v20, v20, v68
    v_add_f32 v21, v21, v69
    v_add_f32 v22, v22, v70
    v_add_f32 v23, v23, v71
    v_add_f32 v24, v24, v72
    v_add_f32 v25, v25, v73
    v_add_f32 v26, v26, v74
    v_add_f32 v27, v27, v75
    v_add_f32 v28, v28, v76
    v_add_f32 v29, v29, v77
    v_add_f32 v30, v30, v78
    v_add_f32 v31, v31, v79
    v_add_f32 v32, v32, v80
    v_add_f32 v33, v33, v81
    v_add_f32 v34, v34, v82
    v_add_f32 v35, v35, v83
    v_add_f32 v36, v36, v84
    v_add_f32 v37, v37, v85
    v_add_f32 v38, v38, v86
    v_add_f32 v39, v39, v87
    v_add_f32 v40, v40, v88
    v_add_f32 v41, v41, v89
    v_add_f32 v42, v42, v90
    v_add_f32 v43, v43, v91
K2_NOACC:
    s_barrier
    s_cmp_eq_u32 s55, 0
    s_cbranch_scc1 K2_SPILL
    s_bfe_u32 s60, s20, 0x10002
    s_lshl_b32 s60, s60, 4
    s_add_u32 s59, s59, s60
    v_add_u32 v228, s59, v229
    s_mul_i32 s60, s20, 2080
    s_add_u32 s60, s60, 65536
    v_add_u32 v249, s60, v229
    s_mov_b32 s63, 0xbfb8aa3b
    s_add_u32 s40, s20, s21
    s_lshl_b32 s40, s40, 10
    s_add_u32 s41, s40, 8192
    s_add_u32 s42, s40, 16384
    s_add_u32 s43, s40, 24576
    s_add_u32 s44, s40, 32768
    v_mul_f32 v204, s63, v0
    v_mul_f32 v205, s63, v1
    v_mul_f32 v206, s63, v2
    v_mul_f32 v207, s63, v3
    v_exp_f32 v204, v204
    v_exp_f32 v205, v205
    v_exp_f32 v206, v206
    v_exp_f32 v207, v207
    v_add_f32 v204, 1.0, v204
    v_add_f32 v205, 1.0, v205
    v_add_f32 v206, 1.0, v206
    v_add_f32 v207, 1.0, v207
    v_rcp_f32 v204, v204
    v_rcp_f32 v205, v205
    v_rcp_f32 v206, v206
    v_rcp_f32 v207, v207
    v_cvt_pk_bf16_f32 v176, v0, v1
    v_cvt_pk_bf16_f32 v177, v2, v3
    v_mul_f32 v4, v4, v204
    v_mul_f32 v5, v5, v205
    v_mul_f32 v6, v6, v206
    v_mul_f32 v7, v7, v207
    v_cvt_pk_bf16_f32 v178, v4, v5
    v_cvt_pk_bf16_f32 v179, v6, v7
    v_mul_f32 v8, v8, v204
    v_mul_f32 v9, v9, v205
    v_mul_f32 v10, v10, v206
    v_mul_f32 v11, v11, v207
    v_cvt_pk_bf16_f32 v180, v8, v9
    v_cvt_pk_bf16_f32 v181, v10, v11
    v_mul_f32 v12, v12, v204
    v_mul_f32 v13, v13, v205
    v_mul_f32 v14, v14, v206
    v_mul_f32 v15, v15, v207
    v_cvt_pk_bf16_f32 v182, v12, v13
    v_cvt_pk_bf16_f32 v183, v14, v15
    ds_write_b64 v254, v[176:177] offset:0
    ds_write_b64 v254, v[178:179] offset:256
    ds_write_b64 v254, v[180:181] offset:512
    ds_write_b64 v254, v[182:183] offset:768
    s_waitcnt lgkmcnt(0)
    s_barrier
    ds_read_b128 v[192:195], v228 offset:0
    ds_read_b128 v[196:199], v228 offset:1536
    s_waitcnt lgkmcnt(0)
    buffer_store_dwordx4 v[192:195], v229, s[12:15], s40 offen sc1
    buffer_store_dwordx4 v[196:199], v229, s[12:15], s41 offen sc1
    v_mul_f32 v208, s63, v16
    v_mul_f32 v209, s63, v17
    v_mul_f32 v210, s63, v18
    v_mul_f32 v211, s63, v19
    v_exp_f32 v208, v208
    v_exp_f32 v209, v209
    v_exp_f32 v210, v210
    v_exp_f32 v211, v211
    v_add_f32 v208, 1.0, v208
    v_add_f32 v209, 1.0, v209
    v_add_f32 v210, 1.0, v210
    v_add_f32 v211, 1.0, v211
    v_rcp_f32 v208, v208
    v_rcp_f32 v209, v209
    v_rcp_f32 v210, v210
    v_rcp_f32 v211, v211
    v_cvt_pk_bf16_f32 v184, v16, v17
    v_cvt_pk_bf16_f32 v185, v18, v19
    v_mul_f32 v20, v20, v208
    v_mul_f32 v21, v21, v209
    v_mul_f32 v22, v22, v210
    v_mul_f32 v23, v23, v211
    v_cvt_pk_bf16_f32 v186, v20, v21
    v_cvt_pk_bf16_f32 v187, v22, v23
    v_mul_f32 v24, v24, v208
    v_mul_f32 v25, v25, v209
    v_mul_f32 v26, v26, v210
    v_mul_f32 v27, v27, v211
    v_cvt_pk_bf16_f32 v188, v24, v25
    v_cvt_pk_bf16_f32 v189, v26, v27
    v_mul_f32 v28, v28, v208
    v_mul_f32 v29, v29, v209
    v_mul_f32 v30, v30, v210
    v_mul_f32 v31, v31, v211
    v_cvt_pk_bf16_f32 v190, v28, v29
    v_cvt_pk_bf16_f32 v191, v30, v31
    ds_write_b64 v254, v[184:185] offset:3072
    ds_write_b64 v254, v[186:187] offset:3328
    ds_write_b64 v254, v[188:189] offset:3584
    ds_write_b64 v254, v[190:191] offset:3840
    s_waitcnt lgkmcnt(0)
    s_barrier
    ds_read_b128 v[192:195], v228 offset:3072
    ds_read_b128 v[196:199], v228 offset:4608
    s_waitcnt lgkmcnt(0)
    buffer_store_dwordx4 v[192:195], v229, s[12:15], s42 offen sc1
    buffer_store_dwordx4 v[196:199], v229, s[12:15], s43 offen sc1
    v_mul_f32 v212, s63, v32
    v_mul_f32 v213, s63, v33
    v_mul_f32 v214, s63, v34
    v_mul_f32 v215, s63, v35
    v_exp_f32 v212, v212
    v_exp_f32 v213, v213
    v_exp_f32 v214, v214
    v_exp_f32 v215, v215
    v_add_f32 v212, 1.0, v212
    v_add_f32 v213, 1.0, v213
    v_add_f32 v214, 1.0, v214
    v_add_f32 v215, 1.0, v215
    v_rcp_f32 v212, v212
    v_rcp_f32 v213, v213
    v_rcp_f32 v214, v214
    v_rcp_f32 v215, v215
    v_cvt_pk_bf16_f32 v220, v32, v33
    v_cvt_pk_bf16_f32 v221, v34, v35
    v_mul_f32 v36, v36, v212
    v_mul_f32 v37, v37, v213
    v_mul_f32 v38, v38, v214
    v_mul_f32 v39, v39, v215
    v_cvt_pk_bf16_f32 v178, v36, v37
    v_cvt_pk_bf16_f32 v179, v38, v39
    v_mul_f32 v40, v40, v212
    v_mul_f32 v41, v41, v213
    v_mul_f32 v42, v42, v214
    v_mul_f32 v43, v43, v215
    v_cvt_pk_bf16_f32 v180, v40, v41
    v_cvt_pk_bf16_f32 v181, v42, v43
    ds_write_b64 v255, v[220:221] offset:0
    ds_write_b64 v246, v[178:179] offset:256
    ds_write_b64 v255, v[180:181] offset:512
    s_waitcnt lgkmcnt(0)
    s_barrier
    ds_read_b128 v[200:203], v249
    s_branch K2_LASTROW
K2_SPILL:
    buffer_store_dwordx4 v[0:3], v227, s[8:11], s60 offen offset:0
    buffer_store_dwordx4 v[4:7], v227, s[8:11], s60 offen offset:16
    buffer_store_dwordx4 v[8:11], v227, s[8:11], s60 offen offset:32
    buffer_store_dwordx4 v[12:15], v227, s[8:11], s60 offen offset:48
    buffer_store_dwordx4 v[16:19], v227, s[8:11], s60 offen offset:64
    buffer_store_dwordx4 v[20:23], v227, s[8:11], s60 offen offset:80
    buffer_store_dwordx4 v[24:27], v227, s[8:11], s60 offen offset:96
    buffer_store_dwordx4 v[28:31], v227, s[8:11], s60 offen offset:112
    buffer_store_dwordx4 v[32:35], v227, s[8:11], s60 offen offset:128
    buffer_store_dwordx4 v[36:39], v227, s[8:11], s60 offen offset:144
    buffer_store_dwordx4 v[40:43], v227, s[8:11], s60 offen offset:160
    s_mov_b32 s28, 0
    s_waitcnt vmcnt(0)
    s_cmp_lt_u32 s24, s25
    s_cbranch_scc1 K2_LOAD
    s_add_u32 s23, s23, 20
    s_branch K2_WINDOW
KS_FLS:
    s_sub_u32 s25, s25, 1
    s_cbranch_scc1 K2_END
    v_mov_b32 v62, 163460
    ds_read_b32 v62, v62
    s_branch KS_JOIN2
K2_NOW0:
    buffer_load_dwordx4 v[76:79], v72, s[8:11], s67 offen sc1
    s_branch K2_W0
K2_WINDOW:
    s_mov_b32 s24, 0
    s_mov_b32 s25, 1
K2_LOAD:
    v_mbcnt_lo_u32_b32 v176, -1, 0
    v_mbcnt_hi_u32_b32 v176, -1, v176
    s_lshl_b32 s58, s20, 6
    v_add_u32 v177, s58, v176
    v_lshlrev_b32 v70, 4, v176
    s_mov_b32 s58, 7110656
    buffer_load_dwordx4 v[136:139], v70, s[8:11], s58 offen offset:0 sc1
    buffer_load_dwordx4 v[140:143], v70, s[8:11], s58 offen offset:1024 sc1
    s_mov_b32 s58, 7112704
    buffer_load_dwordx4 v[144:147], v70, s[8:11], s58 offen offset:0 sc1
    buffer_load_dwordx4 v[148:151], v70, s[8:11], s58 offen offset:1024 sc1
    s_mov_b32 s58, 7114752
    buffer_load_dwordx4 v[152:155], v70, s[8:11], s58 offen offset:0 sc1
    buffer_load_dwordx4 v[156:159], v70, s[8:11], s58 offen offset:1024 sc1
    s_mov_b32 s58, 7116800
    buffer_load_dwordx4 v[160:163], v70, s[8:11], s58 offen offset:0 sc1
    buffer_load_dwordx4 v[164:167], v70, s[8:11], s58 offen offset:1024 sc1
    s_mov_b32 s58, 7118848
    buffer_load_dwordx4 v[168:171], v70, s[8:11], s58 offen offset:0 sc1
    buffer_load_dwordx4 v[172:175], v70, s[8:11], s58 offen offset:1024 sc1
    s_mul_i32 s58, s20, 10400
    s_add_u32 s58, s58, 65536
    s_add_u32 s59, s58, 512
    v_and_b32 v76, 31, v176
    v_lshrrev_b32 v77, 5, v176
    v_mov_b32 v80, 0
    v_mul_u32_u24 v77, 2080, v77
    v_mov_b32 v81, 0xffff0000
    v_lshl_add_u32 v78, v76, 4, v77
    v_mov_b32 v82, 0
    v_add_u32 v78, s58, v78
    v_mov_b32 v83, v81
    v_add_u32 v85, 16, v176
    v_lshlrev_b32 v84, 5, v176
    v_lshrrev_b32 v85, 6, v85
    v_mul_u32_u24 v85, 1532, v85
    v_sub_u32 v84, v84, v85
    v_mov_b32 v85, -1
    v_add_u32 v84, s59, v84
    ds_write_b32 v84, v85 offset:0
    ds_write_b32 v84, v85 offset:2080
    ds_write_b32 v84, v85 offset:4160
    ds_write_b32 v84, v85 offset:6240
    ds_write_b32 v84, v85 offset:8320
    s_mov_b32 exec_hi, 0
    ds_write_b128 v78, v[80:83] offset:0
    ds_write_b128 v78, v[80:83] offset:2080
    ds_write_b128 v78, v[80:83] offset:4160
    ds_write_b128 v78, v[80:83] offset:6240
    ds_write_b128 v78, v[80:83] offset:8320
    s_mov_b32 exec_hi, -1
    s_cmp_lg_u32 s20, 7
    s_cbranch_scc1 K2_NOH
    v_mov_b32 v76, 0
    v_mov_b32 v77, -1
    v_lshlrev_b32 v78, 2, v176
    v_add_u32 v78, 163072, v78
    s_mov_b64 exec, 0x1ff
    ds_write_b32 v78, v76 offset:192
    s_mov_b32 exec_lo, 1
    s_mov_b32 exec_lo, -1
    ds_write_b32 v78, v77 offset:256
    s_mov_b64 exec, -1
    s_cmp_lg_u32 s24, 0
    s_cbranch_scc1 K2_NOH
    s_mov_b32 exec_hi, 0xffff
    ds_write_b32 v78, v76
    s_mov_b64 exec, 1
    ds_write_b32 v78, v76 offset:232
    s_mov_b64 exec, -1
K2_NOH:
    s_waitcnt lgkmcnt(0)
    s_barrier
    s_branch K2_CELLS
K2_LD_GEN:
    s_mov_b64 exec, s[42:43]
    s_cbranch_execz K2_LD_DONE
    buffer_load_dwordx4 v[4:7], v182, s[8:11], 0 offen sc1
    s_mov_b64 exec, s[44:45]
    s_cbranch_execz K2_LD_DONE
    buffer_load_dwordx4 v[8:11], v183, s[8:11], 0 offen sc1
    s_mov_b64 exec, s[46:47]
    s_cbranch_execz K2_LD_DONE
    buffer_load_dwordx4 v[12:15], v184, s[8:11], 0 offen sc1
    s_mov_b64 exec, s[48:49]
    s_cbranch_execz K2_LD_DONE
    buffer_load_dwordx4 v[16:19], v181, s[8:11], 0 offen offset:128 sc1
    s_mov_b64 exec, s[50:51]
    s_cbranch_execz K2_LD_DONE
    buffer_load_dwordx4 v[20:23], v181, s[8:11], 0 offen offset:160 sc1
    s_mov_b64 exec, s[90:91]
    s_cbranch_execz K2_LD_DONE
    buffer_load_dwordx4 v[24:27], v181, s[8:11], 0 offen offset:192 sc1
    s_mov_b64 exec, s[92:93]
    s_cbranch_execz K2_LD_DONE
    buffer_load_dwordx4 v[28:31], v181, s[8:11], 0 offen offset:224 sc1
    s_mov_b64 exec, s[94:95]
    s_cbranch_execz K2_LD_DONE
    buffer_load_dwordx4 v[32:35], v181, s[8:11], 0 offen offset:256 sc1
    s_mov_b64 exec, s[96:97]
    s_cbranch_execz K2_LD_DONE
    buffer_load_dwordx4 v[36:39], v181, s[8:11], 0 offen offset:288 sc1
    s_branch K2_LD_DONE
K2_WLATE:
    s_waitcnt vmcnt(0)
    v_lshlrev_b32 v96, 16, v136
    v_and_b32 v97, 0xffff0000, v136
    v_lshlrev_b32 v98, 16, v137
    v_and_b32 v99, 0xffff0000, v137
    v_lshlrev_b32 v100, 16, v138
    v_and_b32 v101, 0xffff0000, v138
    v_lshlrev_b32 v102, 16, v139
    v_and_b32 v103, 0xffff0000, v139
    v_lshlrev_b32 v104, 16, v140
    v_and_b32 v105, 0xffff0000, v140
    v_lshlrev_b32 v106, 16, v141
    v_and_b32 v107, 0xffff0000, v141
    v_lshlrev_b32 v108, 16, v142
    v_and_b32 v109, 0xffff0000, v142
    v_lshlrev_b32 v110, 16, v143
    v_and_b32 v111, 0xffff0000, v143
    v_lshlrev_b32 v112, 16, v144
    v_and_b32 v113, 0xffff0000, v144
    v_lshlrev_b32 v114, 16, v145
    v_and_b32 v115, 0xffff0000, v145
    v_lshlrev_b32 v116, 16, v146
    v_and_b32 v117, 0xffff0000, v146
    v_lshlrev_b32 v118, 16, v147
    v_and_b32 v119, 0xffff0000, v147
    v_lshlrev_b32 v120, 16, v148
    v_and_b32 v121, 0xffff0000, v148
    v_lshlrev_b32 v122, 16, v149
    v_and_b32 v123, 0xffff0000, v149
    v_lshlrev_b32 v124, 16, v150
    v_and_b32 v125, 0xffff0000, v150
    v_lshlrev_b32 v126, 16, v151
    v_and_b32 v127, 0xffff0000, v151
    v_lshlrev_b32 v128, 16, v152
    v_and_b32 v129, 0xffff0000, v152
    v_lshlrev_b32 v130, 16, v153
    v_and_b32 v131, 0xffff0000, v153
    v_lshlrev_b32 v132, 16, v154
    v_and_b32 v133, 0xffff0000, v154
    v_lshlrev_b32 v134, 16, v155
    v_and_b32 v135, 0xffff0000, v155
    v_lshlrev_b32 v136, 16, v156
    v_and_b32 v137, 0xffff0000, v156
    v_lshlrev_b32 v138, 16, v157
    v_and_b32 v139, 0xffff0000, v157
    v_lshlrev_b32 v140, 16, v158
    v_and_b32 v141, 0xffff0000, v158
    v_lshlrev_b32 v142, 16, v159
    v_and_b32 v143, 0xffff0000, v159
    v_lshlrev_b32 v144, 16, v160
    v_and_b32 v145, 0xffff0000, v160
    v_lshlrev_b32 v146, 16, v161
    v_and_b32 v147, 0xffff0000, v161
    v_lshlrev_b32 v148, 16, v162
    v_and_b32 v149, 0xffff0000, v162
    v_lshlrev_b32 v150, 16, v163
    v_and_b32 v151, 0xffff0000, v163
    v_lshlrev_b32 v152, 16, v164
    v_and_b32 v153, 0xffff0000, v164
    v_lshlrev_b32 v154, 16, v165
    v_and_b32 v155, 0xffff0000, v165
    v_lshlrev_b32 v156, 16, v166
    v_and_b32 v157, 0xffff0000, v166
    v_lshlrev_b32 v158, 16, v167
    v_and_b32 v159, 0xffff0000, v167
    v_lshlrev_b32 v160, 16, v168
    v_and_b32 v161, 0xffff0000, v168
    v_lshlrev_b32 v162, 16, v169
    v_and_b32 v163, 0xffff0000, v169
    v_lshlrev_b32 v164, 16, v170
    v_and_b32 v165, 0xffff0000, v170
    v_lshlrev_b32 v166, 16, v171
    v_and_b32 v167, 0xffff0000, v171
    v_lshlrev_b32 v168, 16, v172
    v_and_b32 v169, 0xffff0000, v172
    v_lshlrev_b32 v170, 16, v173
    v_and_b32 v171, 0xffff0000, v173
    v_lshlrev_b32 v172, 16, v174
    v_and_b32 v173, 0xffff0000, v174
    v_lshlrev_b32 v174, 16, v175
    v_and_b32 v175, 0xffff0000, v175
    s_branch K2_NOWRAW
K2_RT0:
    s_sub_u32 s60, s60, 1
    s_cbranch_scc1 K2_END
    s_mov_b64 exec, vcc
    buffer_load_dwordx4 v[0:3], v181, s[8:11], 0 offen offset:0 sc1
    s_mov_b64 exec, s[40:41]
    s_waitcnt vmcnt(0)
    s_branch K2_CK0
K2_RT1:
    s_sub_u32 s60, s60, 1
    s_cbranch_scc1 K2_END
    s_mov_b64 exec, vcc
    buffer_load_dwordx4 v[4:7], v182, s[8:11], 0 offen sc1
    s_mov_b64 exec, s[42:43]
    s_waitcnt vmcnt(0)
    s_branch K2_CK1
K2_RT2:
    s_sub_u32 s60, s60, 1
    s_cbranch_scc1 K2_END
    s_mov_b64 exec, vcc
    buffer_load_dwordx4 v[8:11], v183, s[8:11], 0 offen sc1
    s_mov_b64 exec, s[44:45]
    s_waitcnt vmcnt(0)
    s_branch K2_CK2
K2_RT3:
    s_sub_u32 s60, s60, 1
    s_cbranch_scc1 K2_END
    s_mov_b64 exec, vcc
    buffer_load_dwordx4 v[12:15], v184, s[8:11], 0 offen sc1
    s_mov_b64 exec, s[46:47]
    s_waitcnt vmcnt(0)
    s_branch K2_CK3
K2_RT4:
    s_sub_u32 s60, s60, 1
    s_cbranch_scc1 K2_END
    s_mov_b64 exec, vcc
    buffer_load_dwordx4 v[16:19], v181, s[8:11], 0 offen offset:128 sc1
    s_mov_b64 exec, s[48:49]
    s_waitcnt vmcnt(0)
    s_branch K2_CK4
K2_RT5:
    s_sub_u32 s60, s60, 1
    s_cbranch_scc1 K2_END
    s_mov_b64 exec, vcc
    buffer_load_dwordx4 v[20:23], v181, s[8:11], 0 offen offset:160 sc1
    s_mov_b64 exec, s[50:51]
    s_waitcnt vmcnt(0)
    s_branch K2_CK5
K2_RT6:
    s_sub_u32 s60, s60, 1
    s_cbranch_scc1 K2_END
    s_mov_b64 exec, vcc
    buffer_load_dwordx4 v[24:27], v181, s[8:11], 0 offen offset:192 sc1
    s_mov_b64 exec, s[90:91]
    s_waitcnt vmcnt(0)
    s_branch K2_CK6
K2_RT7:
    s_sub_u32 s60, s60, 1
    s_cbranch_scc1 K2_END
    s_mov_b64 exec, vcc
    buffer_load_dwordx4 v[28:31], v181, s[8:11], 0 offen offset:224 sc1
    s_mov_b64 exec, s[92:93]
    s_waitcnt vmcnt(0)
    s_branch K2_CK7
K2_RT8:
    s_sub_u32 s60, s60, 1
    s_cbranch_scc1 K2_END
    s_mov_b64 exec, vcc
    buffer_load_dwordx4 v[32:35], v181, s[8:11], 0 offen offset:256 sc1
    s_mov_b64 exec, s[94:95]
    s_waitcnt vmcnt(0)
    s_branch K2_CK8
K2_RT9:
    s_sub_u32 s60, s60, 1
    s_cbranch_scc1 K2_END
    s_mov_b64 exec, vcc
    buffer_load_dwordx4 v[36:39], v181, s[8:11], 0 offen offset:288 sc1
    s_mov_b64 exec, s[96:97]
    s_waitcnt vmcnt(0)
    s_branch K2_CK9
K2_RK_LOAD:
    s_waitcnt vmcnt(0)
    s_mov_b64 exec, s[40:41]
    s_cbranch_execz K2_RK_B
    v_lshrrev_b32 v50, 24, v3
    buffer_load_dword v40, v179, s[8:11], s66 offen offset:0
    v_mad_u32_u24 v50, v50, s58, v202
    v_and_b32 v3, 0xffffff, v3
    s_mov_b64 exec, s[42:43]
    s_cbranch_execz K2_RK_B
    v_lshrrev_b32 v51, 24, v7
    buffer_load_dword v41, v185, s[8:11], s66 offen
    v_mad_u32_u24 v51, v51, s58, v202
    v_and_b32 v7, 0xffffff, v7
    s_mov_b64 exec, s[44:45]
    s_cbranch_execz K2_RK_B
    v_lshrrev_b32 v52, 24, v11
    buffer_load_dword v42, v186, s[8:11], s66 offen
    v_mad_u32_u24 v52, v52, s58, v202
    v_and_b32 v11, 0xffffff, v11
    s_mov_b64 exec, s[46:47]
    s_cbranch_execz K2_RK_B
    v_lshrrev_b32 v53, 24, v15
    buffer_load_dword v43, v187, s[8:11], s66 offen
    v_mad_u32_u24 v53, v53, s58, v202
    v_and_b32 v15, 0xffffff, v15
    s_mov_b64 exec, s[48:49]
    s_cbranch_execz K2_RK_B
    v_lshrrev_b32 v54, 24, v19
    buffer_load_dword v44, v179, s[8:11], s66 offen offset:32
    v_mad_u32_u24 v54, v54, s58, v202
    v_and_b32 v19, 0xffffff, v19
    s_mov_b64 exec, s[50:51]
    s_cbranch_execz K2_RK_B
    v_lshrrev_b32 v55, 24, v23
    buffer_load_dword v45, v179, s[8:11], s66 offen offset:40
    v_mad_u32_u24 v55, v55, s58, v202
    v_and_b32 v23, 0xffffff, v23
    s_mov_b64 exec, s[90:91]
    s_cbranch_execz K2_RK_B
    v_lshrrev_b32 v56, 24, v27
    buffer_load_dword v46, v179, s[8:11], s66 offen offset:48
    v_mad_u32_u24 v56, v56, s58, v202
    v_and_b32 v27, 0xffffff, v27
    s_mov_b64 exec, s[92:93]
    s_cbranch_execz K2_RK_B
    v_lshrrev_b32 v57, 24, v31
    buffer_load_dword v47, v179, s[8:11], s66 offen offset:56
    v_mad_u32_u24 v57, v57, s58, v202
    v_and_b32 v31, 0xffffff, v31
    s_mov_b64 exec, s[94:95]
    s_cbranch_execz K2_RK_B
    v_lshrrev_b32 v58, 24, v35
    buffer_load_dword v48, v179, s[8:11], s66 offen offset:64
    v_mad_u32_u24 v58, v58, s58, v202
    v_and_b32 v35, 0xffffff, v35
    s_mov_b64 exec, s[96:97]
    s_cbranch_execz K2_RK_B
    v_lshrrev_b32 v59, 24, v39
    buffer_load_dword v49, v179, s[8:11], s66 offen offset:72
    v_mad_u32_u24 v59, v59, s58, v202
    v_and_b32 v39, 0xffffff, v39
K2_RK_B:
    s_mov_b64 exec, -1
    s_mul_i32 s62, s24, 48
    s_waitcnt vmcnt(0)
    v_subrev_u32 v40, s62, v40
    v_subrev_u32 v41, s62, v41
    v_subrev_u32 v42, s62, v42
    v_subrev_u32 v43, s62, v43
    v_subrev_u32 v44, s62, v44
    v_subrev_u32 v45, s62, v45
    v_subrev_u32 v46, s62, v46
    v_subrev_u32 v47, s62, v47
    v_subrev_u32 v48, s62, v48
    v_subrev_u32 v49, s62, v49
    s_branch K2_RK_DONE
K2_BIG:
    s_cmp_lg_u32 s24, 0
    s_cbranch_scc1 K2_TOK
    s_movk_i32 s26, 48
    v_mov_b32 v197, v193
    s_nop 1
    v_max_u32_dpp v197, v197, v197 row_shr:1 row_mask:0xf bank_mask:0xf bound_ctrl:0
    s_nop 1
    v_max_u32_dpp v197, v197, v197 row_shr:2 row_mask:0xf bank_mask:0xf bound_ctrl:0
    s_nop 1
    v_max_u32_dpp v197, v197, v197 row_shr:4 row_mask:0xf bank_mask:0xf bound_ctrl:0
    s_nop 1
    v_max_u32_dpp v197, v197, v197 row_shr:8 row_mask:0xf bank_mask:0xf bound_ctrl:0
    s_nop 1
    v_max_u32_dpp v197, v197, v197 row_bcast:15 row_mask:0xa bank_mask:0xf
    s_nop 1
    v_max_u32_dpp v197, v197, v197 row_bcast:31 row_mask:0xc bank_mask:0xf
    s_nop 0
    v_readlane_b32 s25, v197, 63
    s_nop 0
    s_add_u32 s25, s25, 47
    s_mul_i32 s25, s25, 43691
    s_lshr_b32 s25, s25, 21
    s_mov_b64 exec, s[40:41]
    s_cbranch_execz K2_SV_DONE
    buffer_store_dword v40, v179, s[8:11], s66 offen offset:0
    s_mov_b64 exec, s[42:43]
    s_cbranch_execz K2_SV_DONE
    buffer_store_dword v41, v185, s[8:11], s66 offen
    s_mov_b64 exec, s[44:45]
    s_cbranch_execz K2_SV_DONE
    buffer_store_dword v42, v186, s[8:11], s66 offen
    s_mov_b64 exec, s[46:47]
    s_cbranch_execz K2_SV_DONE
    buffer_store_dword v43, v187, s[8:11], s66 offen
    s_mov_b64 exec, s[48:49]
    s_cbranch_execz K2_SV_DONE
    buffer_store_dword v44, v179, s[8:11], s66 offen offset:32
    s_mov_b64 exec, s[50:51]
    s_cbranch_execz K2_SV_DONE
    buffer_store_dword v45, v179, s[8:11], s66 offen offset:40
    s_mov_b64 exec, s[90:91]
    s_cbranch_execz K2_SV_DONE
    buffer_store_dword v46, v179, s[8:11], s66 offen offset:48
    s_mov_b64 exec, s[92:93]
    s_cbranch_execz K2_SV_DONE
    buffer_store_dword v47, v179, s[8:11], s66 offen offset:56
    s_mov_b64 exec, s[94:95]
    s_cbranch_execz K2_SV_DONE
    buffer_store_dword v48, v179, s[8:11], s66 offen offset:64
    s_mov_b64 exec, s[96:97]
    s_cbranch_execz K2_SV_DONE
    buffer_store_dword v49, v179, s[8:11], s66 offen offset:72
K2_SV_DONE:
    s_mov_b64 exec, -1
    s_branch K2_TOK
K2_rare_1:
    s_cmp_eq_u32 s33, 4
    s_cbranch_scc1 K2_four_3
    s_mov_b32 s49, s48
    s_xor_b32 s45, s44, 256
    s_xor_b32 s46, s44, 512
    s_xor_b32 s47, s44, 768
    s_branch K2_back_2
K2_four_3:
    s_add_u32 s50, s48, 256
    s_mov_b32 s46, s44
    s_mov_b32 s47, s44
    s_branch K2_back_2
K2_a4_5:
    v_add_u32 v254, s48, v232
    ds_read_b32 v254, v254 offset:4
    s_lshr_b32 s65, s3, 28
    s_mul_i32 s66, s22, 2080
    s_lshl_b32 s65, s65, 9
    s_add_u32 s65, s65, s66
    s_add_u32 s65, s65, 65536
    s_mov_b32 m0, s65
    s_mov_b32 exec_hi, 0
    s_waitcnt lgkmcnt(0)
    v_or_b32 v254, v254, v233
    buffer_load_dwordx4 v254, s[16:19], 0 offen  lds
    s_mov_b32 exec_hi, -1
    s_branch K2_b4_7
K2_g4_8:
    s_add_u32 s51, s48, 384
    v_add_u32 v44, s51, v251
    ds_read2_b32 v[44:45], v44 offset0:1 offset1:3
    s_waitcnt lgkmcnt(0)
    v_mad_u32_u16 v44, v44, s39, v248 op_sel:[1,0,0,0]
    v_mad_u32_u16 v45, v45, s39, v248 op_sel:[1,0,0,0]
    buffer_load_dwordx4 v44, s[4:7], s47 offen sc1 lds
    buffer_load_dwordx4 v45, s[72:75], s47 offen offset:1024 sc1 lds
    s_branch K2_back_9
K2_rare_16:
    s_cmp_eq_u32 s33, 4
    s_cbranch_scc1 K2_four_18
    s_mov_b32 s49, s48
    s_xor_b32 s45, s44, 256
    s_xor_b32 s46, s44, 512
    s_xor_b32 s47, s44, 768
    s_branch K2_back_17
K2_four_18:
    s_add_u32 s50, s48, 256
    s_mov_b32 s46, s44
    s_mov_b32 s47, s44
    s_branch K2_back_17
K2_g4_19:
    s_add_u32 s51, s48, 384
    v_add_u32 v44, s51, v251
    ds_read2_b32 v[44:45], v44 offset0:1 offset1:3
    s_waitcnt lgkmcnt(0)
    v_mad_u32_u16 v44, v44, s39, v248 op_sel:[1,0,0,0]
    v_mad_u32_u16 v45, v45, s39, v248 op_sel:[1,0,0,0]
    buffer_load_dwordx4 v44, s[4:7], s47 offen sc1 lds
    buffer_load_dwordx4 v45, s[72:75], s47 offen offset:1024 sc1 lds
    s_branch K2_back_20
K2_a4_22:
    v_add_u32 v254, s48, v232
    ds_read_b32 v254, v254 offset:4
    s_lshr_b32 s65, s3, 28
    s_mul_i32 s66, s22, 2080
    s_lshl_b32 s65, s65, 9
    s_add_u32 s65, s65, s66
    s_add_u32 s65, s65, 65536
    s_mov_b32 m0, s65
    s_mov_b32 exec_hi, 0
    s_waitcnt lgkmcnt(0)
    v_or_b32 v254, v254, v233
    buffer_load_dwordx4 v254, s[16:19], 0 offen  lds
    s_mov_b32 exec_hi, -1
    s_branch K2_b4_24
K2_rare_31:
    s_cmp_eq_u32 s33, 4
    s_cbranch_scc1 K2_four_33
    s_mov_b32 s49, s48
    s_xor_b32 s45, s44, 256
    s_xor_b32 s46, s44, 512
    s_xor_b32 s47, s44, 768
    s_branch K2_back_32
K2_four_33:
    s_add_u32 s50, s48, 256
    s_mov_b32 s46, s44
    s_mov_b32 s47, s44
    s_branch K2_back_32
K2_g4_34:
    s_add_u32 s51, s48, 384
    v_add_u32 v44, s51, v251
    ds_read2_b32 v[44:45], v44 offset0:1 offset1:3
    s_waitcnt lgkmcnt(0)
    v_mad_u32_u16 v44, v44, s39, v248 op_sel:[1,0,0,0]
    v_mad_u32_u16 v45, v45, s39, v248 op_sel:[1,0,0,0]
    buffer_load_dwordx4 v44, s[4:7], s47 offen sc1 lds
    buffer_load_dwordx4 v45, s[72:75], s47 offen offset:1024 sc1 lds
    s_branch K2_back_35
K2_a4_37:
    v_add_u32 v254, s48, v232
    ds_read_b32 v254, v254 offset:4
    s_lshr_b32 s65, s3, 28
    s_mul_i32 s66, s22, 2080
    s_lshl_b32 s65, s65, 9
    s_add_u32 s65, s65, s66
    s_add_u32 s65, s65, 65536
    s_mov_b32 m0, s65
    s_mov_b32 exec_hi, 0
    s_waitcnt lgkmcnt(0)
    v_or_b32 v254, v254, v233
    buffer_load_dwordx4 v254, s[16:19], 0 offen  lds
    s_mov_b32 exec_hi, -1
    s_branch K2_b4_39
K2_rare_46:
    s_cmp_eq_u32 s33, 4
    s_cbranch_scc1 K2_four_48
    s_mov_b32 s49, s48
    s_xor_b32 s45, s44, 256
    s_xor_b32 s46, s44, 512
    s_xor_b32 s47, s44, 768
    s_branch K2_back_47
K2_four_48:
    s_add_u32 s50, s48, 256
    s_mov_b32 s46, s44
    s_mov_b32 s47, s44
    s_branch K2_back_47
K2_g4_49:
    s_add_u32 s51, s48, 384
    v_add_u32 v44, s51, v251
    ds_read2_b32 v[44:45], v44 offset0:1 offset1:3
    s_waitcnt lgkmcnt(0)
    v_mad_u32_u16 v44, v44, s39, v248 op_sel:[1,0,0,0]
    v_mad_u32_u16 v45, v45, s39, v248 op_sel:[1,0,0,0]
    buffer_load_dwordx4 v44, s[4:7], s47 offen sc1 lds
    buffer_load_dwordx4 v45, s[72:75], s47 offen offset:1024 sc1 lds
    s_branch K2_back_50
K2_a4_52:
    v_add_u32 v254, s48, v232
    ds_read_b32 v254, v254 offset:4
    s_lshr_b32 s65, s3, 28
    s_mul_i32 s66, s22, 2080
    s_lshl_b32 s65, s65, 9
    s_add_u32 s65, s65, s66
    s_add_u32 s65, s65, 65536
    s_mov_b32 m0, s65
    s_mov_b32 exec_hi, 0
    s_waitcnt lgkmcnt(0)
    v_or_b32 v254, v254, v233
    buffer_load_dwordx4 v254, s[16:19], 0 offen  lds
    s_mov_b32 exec_hi, -1
    s_branch K2_b4_54
K2_rare_59:
    s_cmp_eq_u32 s33, 4
    s_cbranch_scc1 K2_four_61
    s_mov_b32 s49, s48
    s_xor_b32 s45, s44, 256
    s_xor_b32 s46, s44, 512
    s_xor_b32 s47, s44, 768
    s_branch K2_back_60
K2_four_61:
    s_add_u32 s50, s48, 256
    s_mov_b32 s46, s44
    s_mov_b32 s47, s44
    s_branch K2_back_60
K2_g4_62:
    s_add_u32 s51, s48, 384
    v_add_u32 v44, s51, v251
    ds_read2_b32 v[44:45], v44 offset0:1 offset1:3
    s_waitcnt lgkmcnt(0)
    v_mad_u32_u16 v44, v44, s39, v248 op_sel:[1,0,0,0]
    v_mad_u32_u16 v45, v45, s39, v248 op_sel:[1,0,0,0]
    buffer_load_dwordx4 v44, s[4:7], s47 offen sc1 lds
    buffer_load_dwordx4 v45, s[72:75], s47 offen offset:1024 sc1 lds
    s_branch K2_back_63
K2_rare_68:
    s_cmp_eq_u32 s33, 4
    s_cbranch_scc1 K2_four_70
    s_mov_b32 s49, s48
    s_xor_b32 s45, s44, 256
    s_xor_b32 s46, s44, 512
    s_xor_b32 s47, s44, 768
    s_branch K2_back_69
K2_four_70:
    s_add_u32 s50, s48, 256
    s_mov_b32 s46, s44
    s_mov_b32 s47, s44
    s_branch K2_back_69
K2_g4_71:
    s_add_u32 s51, s48, 384
    v_add_u32 v44, s51, v251
    ds_read2_b32 v[44:45], v44 offset0:1 offset1:3
    s_waitcnt lgkmcnt(0)
    v_mad_u32_u16 v44, v44, s39, v248 op_sel:[1,0,0,0]
    v_mad_u32_u16 v45, v45, s39, v248 op_sel:[1,0,0,0]
    buffer_load_dwordx4 v44, s[4:7], s47 offen sc1 lds
    buffer_load_dwordx4 v45, s[72:75], s47 offen offset:1024 sc1 lds
    s_branch K2_back_72
K2_rare_77:
    s_cmp_eq_u32 s33, 4
    s_cbranch_scc1 K2_four_79
    s_mov_b32 s49, s48
    s_xor_b32 s45, s44, 256
    s_xor_b32 s46, s44, 512
    s_xor_b32 s47, s44, 768
    s_branch K2_back_78
K2_four_79:
    s_add_u32 s50, s48, 256
    s_mov_b32 s46, s44
    s_mov_b32 s47, s44
    s_branch K2_back_78
K2_g4_80:
    s_add_u32 s51, s48, 384
    v_add_u32 v44, s51, v251
    ds_read2_b32 v[44:45], v44 offset0:1 offset1:3
    s_waitcnt lgkmcnt(0)
    v_mad_u32_u16 v44, v44, s39, v248 op_sel:[1,0,0,0]
    v_mad_u32_u16 v45, v45, s39, v248 op_sel:[1,0,0,0]
    buffer_load_dwordx4 v44, s[4:7], s47 offen sc1 lds
    buffer_load_dwordx4 v45, s[72:75], s47 offen offset:1024 sc1 lds
    s_branch K2_back_81
K2_rare_86:
    s_cmp_eq_u32 s33, 4
    s_cbranch_scc1 K2_four_88
    s_mov_b32 s49, s48
    s_xor_b32 s45, s44, 256
    s_xor_b32 s46, s44, 512
    s_xor_b32 s47, s44, 768
    s_branch K2_back_87
K2_four_88:
    s_add_u32 s50, s48, 256
    s_mov_b32 s46, s44
    s_mov_b32 s47, s44
    s_branch K2_back_87
K2_g4_89:
    s_add_u32 s51, s48, 384
    v_add_u32 v44, s51, v251
    ds_read2_b32 v[44:45], v44 offset0:1 offset1:3
    s_waitcnt lgkmcnt(0)
    v_mad_u32_u16 v44, v44, s39, v248 op_sel:[1,0,0,0]
    v_mad_u32_u16 v45, v45, s39, v248 op_sel:[1,0,0,0]
    buffer_load_dwordx4 v44, s[4:7], s47 offen sc1 lds
    buffer_load_dwordx4 v45, s[72:75], s47 offen offset:1024 sc1 lds
    s_branch K2_back_90
K2_U10:
    s_setprio 0
    s_add_u32 s38, s38, 1
    v_mov_b32 v254, s52
    v_mov_b32 v255, s38
    s_lshl_b32 s58, s38, 3
    s_add_u32 s58, s58, s20
    s_mov_b64 exec, 1
    ds_write_b32 v254, v255
    s_mov_b64 exec, -1
    s_cmp_lt_u32 s58, s22
    s_cbranch_scc0 K2_dyn_91
K2_back_92:
    s_waitcnt lgkmcnt(3)
    v_lshlrev_b32 v16, 16, v80
    v_and_b32 v17, 0xffff0000, v80
    v_lshlrev_b32 v18, 16, v81
    v_and_b32 v19, 0xffff0000, v81
    v_mov_b32 v82, v81
    v_mul_f32_dpp v32, v40, v16 row_newbcast:0 row_mask:0xf bank_mask:0xf
    v_mul_f32_dpp v33, v40, v17 row_newbcast:1 row_mask:0xf bank_mask:0xf
    v_mul_f32_dpp v34, v40, v18 row_newbcast:2 row_mask:0xf bank_mask:0xf
    v_mul_f32_dpp v35, v40, v19 row_newbcast:3 row_mask:0xf bank_mask:0xf
    v_mul_f32_dpp v36, v40, v16 row_newbcast:4 row_mask:0xf bank_mask:0xf
    v_mul_f32_dpp v37, v40, v17 row_newbcast:5 row_mask:0xf bank_mask:0xf
    v_mul_f32_dpp v38, v40, v18 row_newbcast:6 row_mask:0xf bank_mask:0xf
    v_mul_f32_dpp v39, v40, v19 row_newbcast:7 row_mask:0xf bank_mask:0xf
    v_cvt_pk_bf16_f32 v81, v32, v33
    v_cvt_pk_bf16_f32 v83, v34, v35
    v_mul_f32_dpp v16, v40, v16 row_newbcast:8 row_mask:0xf bank_mask:0xf
    v_mul_f32_dpp v17, v40, v17 row_newbcast:9 row_mask:0xf bank_mask:0xf
    v_mul_f32_dpp v18, v40, v18 row_newbcast:10 row_mask:0xf bank_mask:0xf
    v_mul_f32_dpp v19, v40, v19 row_newbcast:11 row_mask:0xf bank_mask:0xf
    v_cvt_pk_bf16_f32 v84, v36, v37
    v_cvt_pk_bf16_f32 v86, v38, v39
    v_cvt_pk_bf16_f32 v85, v16, v17
    v_cvt_pk_bf16_f32 v87, v18, v19
    v_permlane16_swap_b32 v80, v81
    v_permlane16_swap_b32 v82, v83
    v_permlane16_swap_b32 v84, v85
    v_permlane16_swap_b32 v86, v87
    v_readlane_b32 s3, v253, s58
    s_lshl_b32 s44, s34, 7
    s_and_b32 s48, s3, 0x3ffff
    s_bfe_u32 s33, s3, 0x30013
    s_mul_i32 s35, s38, 6
    s_cmp_eq_u32 s34, 0
    s_cselect_b32 s35, s35, s48
    s_mov_b32 s45, s44
    s_xor_b32 s47, s44, 256
    s_add_u32 s49, s48, 128
    s_add_u32 s60, s48, 256
    s_cmp_eq_u32 s33, 3
    s_cselect_b32 s46, s44, s47
    s_cselect_b32 s50, s60, s48
    s_sub_u32 s60, s33, 2
    s_cmp_lt_u32 s60, 2
    s_cbranch_scc0 K2_rare_97
K2_back_98:
    v_add_u32 v43, s48, v232
    ds_read_b32 v42, v43
    ds_read_b32 v43, v43 offset:1024
    v_add_u32 v222, s48, v251
    ds_read2_b32 v[222:223], v222 offset0:1 offset1:3
    v_add_u32 v224, s49, v251
    ds_read2_b32 v[224:225], v224 offset0:1 offset1:3
    v_add_u32 v226, s50, v251
    ds_read2_b32 v[226:227], v226 offset0:1 offset1:3
    s_waitcnt lgkmcnt(3)
    v_or_b32 v42, v42, v233
    v_or_b32 v43, v43, v233
    s_cmp_lg_u32 s34, 0
    s_cbranch_scc1 K2_dum_100
    s_cmp_eq_u32 s33, 4
    s_cbranch_scc1 K2_a4_101
K2_b4_103:
    s_add_u32 m0, s48, 512
    s_add_u32 s65, s48, 1536
    buffer_load_dwordx4 v42, s[16:19], 0 offen  lds
    s_mov_b32 m0, s65
    s_mov_b32 exec_hi, 0
    buffer_load_dwordx4 v43, s[16:19], 0 offen  lds
    s_mov_b32 exec_hi, -1
K2_back_102:
    s_waitcnt lgkmcnt(2)
    v_mad_u32_u16 v222, v222, s39, v248 op_sel:[1,0,0,0]
    v_mad_u32_u16 v223, v223, s39, v248 op_sel:[1,0,0,0]
    s_waitcnt lgkmcnt(1)
    v_mad_u32_u16 v224, v224, s39, v248 op_sel:[1,0,0,0]
    v_mad_u32_u16 v225, v225, s39, v248 op_sel:[1,0,0,0]
    s_waitcnt lgkmcnt(0)
    v_mad_u32_u16 v226, v226, s39, v248 op_sel:[1,0,0,0]
    v_mad_u32_u16 v227, v227, s39, v248 op_sel:[1,0,0,0]
    s_waitcnt vmcnt(6)
    s_setprio 1
    v_mfma_f32_32x32x16_bf16 v[8:23], v[80:83], v[176:179], 0
    ds_read_b64_tr_b16 v[184:185], v246 offset:2048
    ds_read_b64_tr_b16 v[186:187], v246 offset:3072
    ds_read_b64_tr_b16 v[188:189], v247 offset:2048
    ds_read_b64_tr_b16 v[190:191], v247 offset:3072
    s_mov_b32 m0, s68
    v_mfma_f32_32x32x16_bf16 v[24:39], v[84:87], v[176:179], 0
    buffer_load_dwordx4 v222, s[4:7], s44 offen sc1 lds
    buffer_load_dwordx4 v223, s[72:75], s44 offen offset:1024 sc1 lds
    v_permlane32_swap_b32 v236, v234
    v_permlane32_swap_b32 v237, v235
    v_mov_b64 v[0:1], 0
    v_mov_b64 v[2:3], 0
    v_mov_b64 v[4:5], 0
    v_mov_b64 v[6:7], 0
    v_mov_b64 v[40:41], 0
    v_mov_b64 v[42:43], 0
    v_mov_b64 v[44:45], 0
    v_mov_b64 v[46:47], 0
    v_mfma_f32_32x32x16_bf16 v[48:63], v[80:83], v[180:183], 0
    v_permlane32_swap_b32 v240, v238
    v_permlane32_swap_b32 v241, v239
    v_add_f32 v236, v236, v234
    v_add_f32 v237, v237, v235
    v_add_f32 v240, -v240, -v238
    v_mfma_f32_32x32x16_bf16 v[64:79], v[84:87], v[180:183], 0
    s_setprio 0
    v_add_f32 v241, -v241, -v239
    s_set_gpr_idx_on s32, gpr_idx(DST)
    s_nop 0
    v_cvt_pk_bf16_f32 v194, v236, v237
    v_cvt_pk_bf16_f32 v195, v240, v241
    s_set_gpr_idx_off
    v_mul_f32 v234, v8, v96
    v_mul_f32 v236, v16, v128
    v_fmac_f32 v234, v9, v97
    v_fmac_f32 v236, v17, v129
    v_fmac_f32 v234, v10, v98
    v_fmac_f32 v236, v18, v130
    v_fmac_f32 v234, v11, v99
    v_fmac_f32 v236, v19, v131
    v_fmac_f32 v234, v12, v100
    v_fmac_f32 v236, v20, v132
    v_fmac_f32 v234, v13, v101
    v_fmac_f32 v236, v21, v133
    v_fmac_f32 v234, v14, v102
    v_fmac_f32 v236, v22, v134
    v_fmac_f32 v234, v15, v103
    v_fmac_f32 v236, v23, v135
    v_mul_f32 v238, v24, v128
    v_mul_f32 v240, v32, v128
    v_fmac_f32 v238, v25, v129
    v_fmac_f32 v240, v33, v129
    v_fmac_f32 v238, v26, v130
    v_fmac_f32 v240, v34, v130
    v_fmac_f32 v238, v27, v131
    v_fmac_f32 v240, v35, v131
    v_fmac_f32 v238, v28, v132
    v_fmac_f32 v240, v36, v132
    v_fmac_f32 v238, v29, v133
    v_fmac_f32 v240, v37, v133
    v_fmac_f32 v238, v30, v134
    v_fmac_f32 v240, v38, v134
    v_fmac_f32 v238, v31, v135
    v_fmac_f32 v240, v39, v135
    v_mul_f32 v235, v48, v104
    v_mul_f32 v237, v56, v136
    v_fmac_f32 v235, v49, v105
    v_fmac_f32 v237, v57, v137
    v_fmac_f32 v235, v50, v106
    v_fmac_f32 v237, v58, v138
    v_fmac_f32 v235, v51, v107
    v_fmac_f32 v237, v59, v139
    v_fmac_f32 v235, v52, v108
    v_fmac_f32 v237, v60, v140
    v_fmac_f32 v235, v53, v109
    v_fmac_f32 v237, v61, v141
    v_fmac_f32 v235, v54, v110
    v_fmac_f32 v237, v62, v142
    v_fmac_f32 v235, v55, v111
    v_fmac_f32 v237, v63, v143
    v_mul_f32 v239, v64, v136
    v_mul_f32 v241, v72, v136
    v_fmac_f32 v239, v65, v137
    v_fmac_f32 v241, v73, v137
    v_fmac_f32 v239, v66, v138
    v_fmac_f32 v241, v74, v138
    v_fmac_f32 v239, v67, v139
    v_fmac_f32 v241, v75, v139
    v_fmac_f32 v239, v68, v140
    v_fmac_f32 v241, v76, v140
    v_fmac_f32 v239, v69, v141
    v_fmac_f32 v241, v77, v141
    v_fmac_f32 v239, v70, v142
    v_fmac_f32 v241, v78, v142
    v_fmac_f32 v239, v71, v143
    v_fmac_f32 v241, v79, v143
    s_setprio 1
    s_waitcnt vmcnt(6) lgkmcnt(0)
    v_mfma_f32_32x32x16_bf16 v[24:39], v[80:83], v[184:187], 0
    ds_read_b64_tr_b16 v[176:177], v246 offset:4096
    ds_read_b64_tr_b16 v[178:179], v246 offset:5120
    ds_read_b64_tr_b16 v[180:181], v247 offset:4096
    ds_read_b64_tr_b16 v[182:183], v247 offset:5120
    s_mov_b32 m0, s69
    v_mfma_f32_32x32x16_bf16 v[8:23], v[84:87], v[184:187], 0
    buffer_load_dwordx4 v224, s[4:7], s45 offen sc1 lds
    buffer_load_dwordx4 v225, s[72:75], s45 offen offset:1024 sc1 lds
    v_permlane32_swap_b32 v234, v236
    v_permlane32_swap_b32 v235, v237
    v_mfma_f32_32x32x16_bf16 v[48:63], v[84:87], v[188:191], 0
    v_permlane32_swap_b32 v238, v239
    v_add_f32 v234, v234, v236
    v_add_f32 v235, v235, v237
    v_add_f32 v238, -v238, -v239
    v_mfma_f32_32x32x16_bf16 v[64:79], v[80:83], v[188:191], 0
    s_setprio 0
    s_set_gpr_idx_on s31, gpr_idx(DST)
    s_nop 0
    v_cvt_pk_bf16_f32 v192, v234, v235
    v_cvt_pk_bf16_f32 v197, v238, v238
    s_set_gpr_idx_off
    v_mul_f32 v234, v24, v144
    v_fmac_f32 v234, v25, v145
    v_fmac_f32 v234, v26, v146
    v_fmac_f32 v234, v27, v147
    v_fmac_f32 v234, v28, v148
    v_fmac_f32 v234, v29, v149
    v_fmac_f32 v234, v30, v150
    v_fmac_f32 v234, v31, v151
    v_mul_f32 v238, v16, v160
    v_mul_f32 v239, v56, v168
    v_fmac_f32 v238, v17, v161
    v_fmac_f32 v239, v57, v169
    v_fmac_f32 v238, v18, v162
    v_fmac_f32 v239, v58, v170
    v_fmac_f32 v238, v19, v163
    v_fmac_f32 v239, v59, v171
    v_fmac_f32 v238, v20, v164
    v_fmac_f32 v239, v60, v172
    v_fmac_f32 v238, v21, v165
    v_fmac_f32 v239, v61, v173
    v_fmac_f32 v238, v22, v166
    v_fmac_f32 v239, v62, v174
    v_fmac_f32 v238, v23, v167
    v_fmac_f32 v239, v63, v175
    v_mul_f32 v235, v64, v152
    v_fmac_f32 v235, v65, v153
    v_fmac_f32 v235, v66, v154
    v_fmac_f32 v235, v67, v155
    v_fmac_f32 v235, v68, v156
    v_fmac_f32 v235, v69, v157
    v_fmac_f32 v235, v70, v158
    v_fmac_f32 v235, v71, v159
    s_setprio 1
    s_waitcnt vmcnt(6) lgkmcnt(0)
    v_mfma_f32_32x32x16_bf16 v[0:15], v[80:83], v[176:179], v[0:15]
    ds_read_b64_tr_b16 v[184:185], v246 offset:6144
    ds_read_b64_tr_b16 v[186:187], v246 offset:7168
    ds_read_b64_tr_b16 v[188:189], v247 offset:6144
    ds_read_b64_tr_b16 v[190:191], v247 offset:7168
    s_mov_b32 m0, s70
    v_mfma_f32_32x32x16_bf16 v[16:31], v[84:87], v[176:179], 0
    buffer_load_dwordx4 v226, s[4:7], s46 offen sc1 lds
    buffer_load_dwordx4 v227, s[72:75], s46 offen offset:1024 sc1 lds
    v_permlane32_swap_b32 v234, v240
    v_permlane32_swap_b32 v235, v241
    v_add_f32 v234, v234, v240
    v_mfma_f32_32x32x16_bf16 v[40:55], v[80:83], v[180:183], v[40:55]
    v_add_f32 v235, v235, v241
    s_set_gpr_idx_on s31, gpr_idx(DST)
    s_nop 0
    v_cvt_pk_bf16_f32 v193, v234, v235
    s_set_gpr_idx_off
    s_sub_u32 s26, s48, s29
    s_mov_b32 s29, s48
    s_mov_b32 s30, s3
    v_mfma_f32_32x32x16_bf16 v[56:71], v[84:87], v[180:183], 0
    s_setprio 0
    s_bfe_u32 s56, s3, 0x40012
    s_cmp_eq_u32 s34, 0
    s_cselect_b32 s56, s56, 0
    v_mul_f32 v240, v0, v144
    v_mul_f32 v236, v8, v160
    v_fmac_f32 v240, v1, v145
    v_fmac_f32 v236, v9, v161
    v_fmac_f32 v240, v2, v146
    v_fmac_f32 v236, v10, v162
    v_fmac_f32 v240, v3, v147
    v_fmac_f32 v236, v11, v163
    v_fmac_f32 v240, v4, v148
    v_fmac_f32 v236, v12, v164
    v_fmac_f32 v240, v5, v149
    v_fmac_f32 v236, v13, v165
    v_fmac_f32 v240, v6, v150
    v_fmac_f32 v236, v14, v166
    v_fmac_f32 v240, v7, v151
    v_fmac_f32 v236, v15, v167
    v_mul_f32 v234, v16, v112
    v_mul_f32 v241, v40, v152
    v_mul_f32 v237, v48, v168
    v_fmac_f32 v234, v17, v113
    v_fmac_f32 v241, v41, v153
    v_fmac_f32 v237, v49, v169
    v_fmac_f32 v234, v18, v114
    v_fmac_f32 v241, v42, v154
    v_fmac_f32 v237, v50, v170
    v_fmac_f32 v234, v19, v115
    v_fmac_f32 v241, v43, v155
    v_fmac_f32 v237, v51, v171
    v_fmac_f32 v234, v20, v116
    v_fmac_f32 v241, v44, v156
    v_fmac_f32 v237, v52, v172
    v_fmac_f32 v234, v21, v117
    v_fmac_f32 v241, v45, v157
    v_fmac_f32 v237, v53, v173
    v_fmac_f32 v234, v22, v118
    v_fmac_f32 v241, v46, v158
    v_fmac_f32 v237, v54, v174
    v_fmac_f32 v234, v23, v119
    v_fmac_f32 v241, v47, v159
    v_fmac_f32 v237, v55, v175
    v_mul_f32 v235, v56, v120
    v_fmac_f32 v235, v57, v121
    v_fmac_f32 v235, v58, v122
    v_fmac_f32 v235, v59, v123
    v_fmac_f32 v235, v60, v124
    v_fmac_f32 v235, v61, v125
    v_fmac_f32 v235, v62, v126
    v_fmac_f32 v235, v63, v127
    s_setprio 1
    s_waitcnt vmcnt(4) lgkmcnt(0)
    v_mfma_f32_32x32x16_bf16 v[8:23], v[80:83], v[184:187], 0
    ds_read_b64_tr_b16 v[176:177], v246 offset:0
    ds_read_b64_tr_b16 v[178:179], v246 offset:1024
    ds_read_b64_tr_b16 v[180:181], v247 offset:0
    ds_read_b64_tr_b16 v[182:183], v247 offset:1024
    s_mov_b32 m0, s71
    v_mfma_f32_32x32x16_bf16 v[24:39], v[84:87], v[184:187], v[24:39]
    s_cmp_eq_u32 s33, 4
    s_cbranch_scc1 K2_g4_104
    buffer_load_dwordx4 v224, s[4:7], s47 offen sc1 lds
    buffer_load_dwordx4 v225, s[72:75], s47 offen offset:1024 sc1 lds
K2_back_105:
    v_permlane32_swap_b32 v236, v240
    v_mfma_f32_32x32x16_bf16 v[64:79], v[84:87], v[188:191], v[64:79]
    v_permlane32_swap_b32 v237, v241
    v_add_f32 v236, v236, v240
    v_add_f32 v237, v237, v241
    s_set_gpr_idx_on s31, gpr_idx(DST)
    s_nop 0
    v_cvt_pk_bf16_f32 v196, v236, v237
    s_set_gpr_idx_off
    s_mov_b32 s32, s31
    s_mov_b32 s31, s35
    v_mfma_f32_32x32x16_bf16 v[48:63], v[80:83], v[188:191], 0
    s_setprio 0
    v_mul_f32 v236, v8, v144
    v_fma_f32 v238, v16, v160, -v238
    v_fmac_f32 v236, v9, v145
    v_fmac_f32 v238, v17, v161
    v_fmac_f32 v236, v10, v146
    v_fmac_f32 v238, v18, v162
    v_fmac_f32 v236, v11, v147
    v_fmac_f32 v238, v19, v163
    v_fmac_f32 v236, v12, v148
    v_fmac_f32 v238, v20, v164
    v_fmac_f32 v236, v13, v149
    v_fmac_f32 v238, v21, v165
    v_fmac_f32 v236, v14, v150
    v_fmac_f32 v238, v22, v166
    v_fmac_f32 v236, v15, v151
    v_fmac_f32 v238, v23, v167
    v_add_u32 v249, s26, v249
    v_add_u32 v250, s26, v250
    v_mul_f32 v240, v24, v160
    v_fma_f32 v234, v32, v112, -v234
    v_fmac_f32 v240, v25, v161
    v_fmac_f32 v234, v33, v113
    v_fmac_f32 v240, v26, v162
    v_fmac_f32 v234, v34, v114
    v_fmac_f32 v240, v27, v163
    v_fmac_f32 v234, v35, v115
    v_fmac_f32 v240, v28, v164
    v_fmac_f32 v234, v36, v116
    v_fmac_f32 v240, v29, v165
    v_fmac_f32 v234, v37, v117
    v_fmac_f32 v240, v30, v166
    v_fmac_f32 v234, v38, v118
    v_fmac_f32 v240, v31, v167
    v_fmac_f32 v234, v39, v119
    ds_read_b64_tr_b16 v[80:81], v249 offset:0
    ds_read_u16_d16_hi v40, v250 offset:0
    v_mul_f32 v241, v64, v168
    v_fma_f32 v235, v72, v120, -v235
    v_fmac_f32 v241, v65, v169
    v_fmac_f32 v235, v73, v121
    v_fmac_f32 v241, v66, v170
    v_fmac_f32 v235, v74, v122
    v_fmac_f32 v241, v67, v171
    v_fmac_f32 v235, v75, v123
    v_fmac_f32 v241, v68, v172
    v_fmac_f32 v235, v76, v124
    v_fmac_f32 v241, v69, v173
    v_fmac_f32 v235, v77, v125
    v_fmac_f32 v241, v70, v174
    v_fmac_f32 v235, v78, v126
    v_fmac_f32 v241, v71, v175
    v_fmac_f32 v235, v79, v127
    ds_read_b64_tr_b16 v[88:89], v249 offset:512
    ds_read_u16_d16_hi v41, v250 offset:128
    v_mul_f32 v237, v48, v152
    v_fma_f32 v239, v56, v168, -v239
    v_fmac_f32 v237, v49, v153
    v_fmac_f32 v239, v57, v169
    v_fmac_f32 v237, v50, v154
    v_fmac_f32 v239, v58, v170
    v_fmac_f32 v237, v51, v155
    v_fmac_f32 v239, v59, v171
    v_fmac_f32 v237, v52, v156
    v_fmac_f32 v239, v60, v172
    v_fmac_f32 v237, v53, v157
    v_fmac_f32 v239, v61, v173
    v_fmac_f32 v237, v54, v158
    v_fmac_f32 v239, v62, v174
    v_fmac_f32 v237, v55, v159
    v_fmac_f32 v239, v63, v175
    s_cmp_eq_u32 s56, 5
    s_cbranch_scc1 K2_U20
    s_cmp_eq_u32 s56, 6
    s_cbranch_scc1 K2_U3h0
    s_branch K2_DSP0
K2_U40:
    s_setprio 0
    ds_read_b64_tr_b16 v[228:229], v249 offset:1024
    ds_read_u16_d16_hi v42, v250 offset:256
    s_lshr_b32 s65, s30, 28
    s_mul_i32 s66, s22, 2080
    s_lshl_b32 s65, s65, 9
    s_add_u32 s65, s65, s66
    s_add_u32 s65, s65, 65536
    s_sub_u32 s65, s65, s29
    s_sub_u32 s65, s65, 512
    v_add_u32 v56, s65, v249
    ds_read_b64_tr_b16 v[0:1], v56 offset:0
    ds_read_u16_d16_hi v43, v250 offset:384
    s_waitcnt lgkmcnt(4)
    v_lshlrev_b32 v16, 16, v80
    v_and_b32 v17, 0xffff0000, v80
    v_lshlrev_b32 v18, 16, v81
    v_and_b32 v19, 0xffff0000, v81
    v_mov_b32 v82, v81
    v_mul_f32_dpp v32, v40, v16 row_newbcast:0 row_mask:0xf bank_mask:0xf
    v_mul_f32_dpp v33, v40, v17 row_newbcast:1 row_mask:0xf bank_mask:0xf
    v_mul_f32_dpp v34, v40, v18 row_newbcast:2 row_mask:0xf bank_mask:0xf
    v_mul_f32_dpp v35, v40, v19 row_newbcast:3 row_mask:0xf bank_mask:0xf
    v_mul_f32_dpp v36, v40, v16 row_newbcast:4 row_mask:0xf bank_mask:0xf
    v_mul_f32_dpp v37, v40, v17 row_newbcast:5 row_mask:0xf bank_mask:0xf
    v_mul_f32_dpp v38, v40, v18 row_newbcast:6 row_mask:0xf bank_mask:0xf
    v_mul_f32_dpp v39, v40, v19 row_newbcast:7 row_mask:0xf bank_mask:0xf
    v_cvt_pk_bf16_f32 v81, v32, v33
    v_cvt_pk_bf16_f32 v83, v34, v35
    v_mul_f32_dpp v16, v40, v16 row_newbcast:8 row_mask:0xf bank_mask:0xf
    v_mul_f32_dpp v17, v40, v17 row_newbcast:9 row_mask:0xf bank_mask:0xf
    v_mul_f32_dpp v18, v40, v18 row_newbcast:10 row_mask:0xf bank_mask:0xf
    v_mul_f32_dpp v19, v40, v19 row_newbcast:11 row_mask:0xf bank_mask:0xf
    v_cvt_pk_bf16_f32 v84, v36, v37
    v_cvt_pk_bf16_f32 v86, v38, v39
    v_cvt_pk_bf16_f32 v85, v16, v17
    v_cvt_pk_bf16_f32 v87, v18, v19
    v_permlane16_swap_b32 v80, v81
    v_permlane16_swap_b32 v82, v83
    v_lshlrev_b32 v24, 16, v88
    v_and_b32 v25, 0xffff0000, v88
    v_lshlrev_b32 v26, 16, v89
    v_and_b32 v27, 0xffff0000, v89
    v_mov_b32 v90, v89
    v_permlane16_swap_b32 v84, v85
    v_permlane16_swap_b32 v86, v87
    v_mul_f32_dpp v32, v41, v24 row_newbcast:0 row_mask:0xf bank_mask:0xf
    v_mul_f32_dpp v33, v41, v25 row_newbcast:1 row_mask:0xf bank_mask:0xf
    v_mul_f32_dpp v34, v41, v26 row_newbcast:2 row_mask:0xf bank_mask:0xf
    v_mul_f32_dpp v35, v41, v27 row_newbcast:3 row_mask:0xf bank_mask:0xf
    v_mul_f32_dpp v36, v41, v24 row_newbcast:4 row_mask:0xf bank_mask:0xf
    v_mul_f32_dpp v37, v41, v25 row_newbcast:5 row_mask:0xf bank_mask:0xf
    v_mul_f32_dpp v38, v41, v26 row_newbcast:6 row_mask:0xf bank_mask:0xf
    v_mul_f32_dpp v39, v41, v27 row_newbcast:7 row_mask:0xf bank_mask:0xf
    v_cvt_pk_bf16_f32 v89, v32, v33
    v_cvt_pk_bf16_f32 v91, v34, v35
    v_mul_f32_dpp v24, v41, v24 row_newbcast:8 row_mask:0xf bank_mask:0xf
    v_mul_f32_dpp v25, v41, v25 row_newbcast:9 row_mask:0xf bank_mask:0xf
    v_mul_f32_dpp v26, v41, v26 row_newbcast:10 row_mask:0xf bank_mask:0xf
    v_mul_f32_dpp v27, v41, v27 row_newbcast:11 row_mask:0xf bank_mask:0xf
    v_cvt_pk_bf16_f32 v92, v36, v37
    v_cvt_pk_bf16_f32 v94, v38, v39
    v_cvt_pk_bf16_f32 v93, v24, v25
    v_cvt_pk_bf16_f32 v95, v26, v27
    v_permlane16_swap_b32 v88, v89
    v_permlane16_swap_b32 v90, v91
    s_waitcnt lgkmcnt(2)
    v_lshlrev_b32 v16, 16, v228
    v_and_b32 v17, 0xffff0000, v228
    v_lshlrev_b32 v18, 16, v229
    v_and_b32 v19, 0xffff0000, v229
    v_mov_b32 v230, v229
    v_permlane16_swap_b32 v92, v93
    v_permlane16_swap_b32 v94, v95
    v_mul_f32_dpp v32, v42, v16 row_newbcast:0 row_mask:0xf bank_mask:0xf
    v_mul_f32_dpp v33, v42, v17 row_newbcast:1 row_mask:0xf bank_mask:0xf
    v_mul_f32_dpp v34, v42, v18 row_newbcast:2 row_mask:0xf bank_mask:0xf
    v_mul_f32_dpp v35, v42, v19 row_newbcast:3 row_mask:0xf bank_mask:0xf
    v_mul_f32_dpp v36, v42, v16 row_newbcast:4 row_mask:0xf bank_mask:0xf
    v_mul_f32_dpp v37, v42, v17 row_newbcast:5 row_mask:0xf bank_mask:0xf
    v_mul_f32_dpp v38, v42, v18 row_newbcast:6 row_mask:0xf bank_mask:0xf
    v_mul_f32_dpp v39, v42, v19 row_newbcast:7 row_mask:0xf bank_mask:0xf
    v_cvt_pk_bf16_f32 v229, v32, v33
    v_cvt_pk_bf16_f32 v231, v34, v35
    v_mul_f32_dpp v16, v42, v16 row_newbcast:8 row_mask:0xf bank_mask:0xf
    v_mul_f32_dpp v17, v42, v17 row_newbcast:9 row_mask:0xf bank_mask:0xf
    v_mul_f32_dpp v18, v42, v18 row_newbcast:10 row_mask:0xf bank_mask:0xf
    v_mul_f32_dpp v19, v42, v19 row_newbcast:11 row_mask:0xf bank_mask:0xf
    v_cvt_pk_bf16_f32 v242, v36, v37
    v_cvt_pk_bf16_f32 v244, v38, v39
    v_cvt_pk_bf16_f32 v243, v16, v17
    v_cvt_pk_bf16_f32 v245, v18, v19
    v_permlane16_swap_b32 v228, v229
    v_permlane16_swap_b32 v230, v231
    s_waitcnt lgkmcnt(0)
    v_lshlrev_b32 v24, 16, v0
    v_and_b32 v25, 0xffff0000, v0
    v_lshlrev_b32 v26, 16, v1
    v_and_b32 v27, 0xffff0000, v1
    v_mov_b32 v2, v1
    v_permlane16_swap_b32 v242, v243
    v_permlane16_swap_b32 v244, v245
    v_mul_f32_dpp v32, v43, v24 row_newbcast:0 row_mask:0xf bank_mask:0xf
    v_mul_f32_dpp v33, v43, v25 row_newbcast:1 row_mask:0xf bank_mask:0xf
    v_mul_f32_dpp v34, v43, v26 row_newbcast:2 row_mask:0xf bank_mask:0xf
    v_mul_f32_dpp v35, v43, v27 row_newbcast:3 row_mask:0xf bank_mask:0xf
    v_mul_f32_dpp v36, v43, v24 row_newbcast:4 row_mask:0xf bank_mask:0xf
    v_mul_f32_dpp v37, v43, v25 row_newbcast:5 row_mask:0xf bank_mask:0xf
    v_mul_f32_dpp v38, v43, v26 row_newbcast:6 row_mask:0xf bank_mask:0xf
    v_mul_f32_dpp v39, v43, v27 row_newbcast:7 row_mask:0xf bank_mask:0xf
    v_cvt_pk_bf16_f32 v1, v32, v33
    v_cvt_pk_bf16_f32 v3, v34, v35
    v_mul_f32_dpp v24, v43, v24 row_newbcast:8 row_mask:0xf bank_mask:0xf
    v_mul_f32_dpp v25, v43, v25 row_newbcast:9 row_mask:0xf bank_mask:0xf
    v_mul_f32_dpp v26, v43, v26 row_newbcast:10 row_mask:0xf bank_mask:0xf
    v_mul_f32_dpp v27, v43, v27 row_newbcast:11 row_mask:0xf bank_mask:0xf
    v_cvt_pk_bf16_f32 v4, v36, v37
    v_cvt_pk_bf16_f32 v6, v38, v39
    v_cvt_pk_bf16_f32 v5, v24, v25
    v_cvt_pk_bf16_f32 v7, v26, v27
    v_permlane16_swap_b32 v0, v1
    v_permlane16_swap_b32 v2, v3
    v_permlane16_swap_b32 v4, v5
    v_permlane16_swap_b32 v6, v7
    s_waitcnt vmcnt(4)
    s_setprio 1
    v_mfma_f32_32x32x16_bf16 v[8:23], v[80:83], v[176:179], 0
    ds_read_b64_tr_b16 v[184:185], v246 offset:2048
    ds_read_b64_tr_b16 v[186:187], v246 offset:3072
    ds_read_b64_tr_b16 v[188:189], v247 offset:2048
    ds_read_b64_tr_b16 v[190:191], v247 offset:3072
    s_mov_b32 m0, s68
    v_mfma_f32_32x32x16_bf16 v[24:39], v[84:87], v[176:179], 0
    buffer_load_dwordx4 v222, s[4:7], s41 offen sc1 lds
    buffer_load_dwordx4 v223, s[72:75], s41 offen offset:1024 sc1 lds
    v_permlane32_swap_b32 v236, v234
    v_permlane32_swap_b32 v237, v235
    s_add_u32 s38, s38, 1
    v_mfma_f32_32x32x16_bf16 v[48:63], v[80:83], v[180:183], 0
    v_permlane32_swap_b32 v240, v238
    v_permlane32_swap_b32 v241, v239
    v_add_f32 v236, v236, v234
    v_add_f32 v237, v237, v235
    v_add_f32 v240, -v240, -v238
    v_mfma_f32_32x32x16_bf16 v[64:79], v[84:87], v[180:183], 0
    v_add_f32 v241, -v241, -v239
    s_set_gpr_idx_on s32, gpr_idx(DST)
    s_nop 0
    v_cvt_pk_bf16_f32 v194, v236, v237
    v_cvt_pk_bf16_f32 v195, v240, v241
    s_set_gpr_idx_off
    v_mov_b32 v254, s52
    s_waitcnt vmcnt(4) lgkmcnt(0)
    v_mfma_f32_32x32x16_bf16 v[8:23], v[88:91], v[184:187], v[8:23]
    ds_read_b64_tr_b16 v[176:177], v246 offset:4096
    ds_read_b64_tr_b16 v[178:179], v246 offset:5120
    ds_read_b64_tr_b16 v[180:181], v247 offset:4096
    ds_read_b64_tr_b16 v[182:183], v247 offset:5120
    v_mov_b32 v255, s38
    s_lshl_b32 s58, s38, 3
    s_mov_b32 m0, s69
    v_mfma_f32_32x32x16_bf16 v[24:39], v[92:95], v[184:187], v[24:39]
    buffer_load_dwordx4 v224, s[4:7], s41 offen sc1 lds
    buffer_load_dwordx4 v225, s[72:75], s41 offen offset:1024 sc1 lds
    s_add_u32 s58, s58, s20
    s_mov_b64 exec, 1
    ds_write_b32 v254, v255
    s_mov_b64 exec, -1
    s_cmp_lt_u32 s58, s22
    s_cbranch_scc0 K2_dyn_106
K2_back_107:
    v_readlane_b32 s3, v253, s58
    s_lshl_b32 s44, s34, 7
    s_and_b32 s48, s3, 0x3ffff
    s_bfe_u32 s33, s3, 0x30013
    s_mul_i32 s35, s38, 6
    s_cmp_eq_u32 s34, 0
    s_cselect_b32 s35, s35, s48
    s_mov_b32 s45, s44
    s_xor_b32 s47, s44, 256
    s_add_u32 s49, s48, 128
    s_add_u32 s60, s48, 256
    s_cmp_eq_u32 s33, 3
    s_cselect_b32 s46, s44, s47
    s_cselect_b32 s50, s60, s48
    s_sub_u32 s60, s33, 2
    s_cmp_lt_u32 s60, 2
    s_cbranch_scc0 K2_rare_112
K2_back_113:
    v_mfma_f32_32x32x16_bf16 v[48:63], v[88:91], v[188:191], v[48:63]
    v_add_u32 v43, s48, v232
    ds_read_b32 v42, v43
    ds_read_b32 v43, v43 offset:1024
    v_mfma_f32_32x32x16_bf16 v[64:79], v[92:95], v[188:191], v[64:79]
    s_waitcnt vmcnt(4) lgkmcnt(3)
    v_mfma_f32_32x32x16_bf16 v[8:23], v[228:231], v[176:179], v[8:23]
    ds_read_b64_tr_b16 v[184:185], v246 offset:6144
    ds_read_b64_tr_b16 v[186:187], v246 offset:7168
    ds_read_b64_tr_b16 v[188:189], v247 offset:6144
    ds_read_b64_tr_b16 v[190:191], v247 offset:7168
    s_mov_b32 m0, s70
    v_mfma_f32_32x32x16_bf16 v[24:39], v[242:245], v[176:179], v[24:39]
    buffer_load_dwordx4 v226, s[4:7], s41 offen sc1 lds
    buffer_load_dwordx4 v227, s[72:75], s41 offen offset:1024 sc1 lds
    v_mfma_f32_32x32x16_bf16 v[48:63], v[228:231], v[180:183], v[48:63]
    v_mfma_f32_32x32x16_bf16 v[64:79], v[242:245], v[180:183], v[64:79]
    s_waitcnt lgkmcnt(4)
    v_or_b32 v42, v42, v233
    v_or_b32 v43, v43, v233
    s_cmp_lg_u32 s34, 0
    s_cbranch_scc1 K2_dum_117
    s_cmp_eq_u32 s33, 4
    s_cbranch_scc1 K2_a4_118
K2_b4_120:
    s_add_u32 m0, s48, 512
    s_add_u32 s65, s48, 1536
    buffer_load_dwordx4 v42, s[16:19], 0 offen  lds
    s_mov_b32 m0, s65
    s_mov_b32 exec_hi, 0
    buffer_load_dwordx4 v43, s[16:19], 0 offen  lds
    s_mov_b32 exec_hi, -1
K2_back_119:
    s_waitcnt vmcnt(6) lgkmcnt(0)
    v_mfma_f32_32x32x16_bf16 v[8:23], v[0:3], v[184:187], v[8:23]
    ds_read_b64_tr_b16 v[176:177], v246 offset:0
    ds_read_b64_tr_b16 v[178:179], v246 offset:1024
    ds_read_b64_tr_b16 v[180:181], v247 offset:0
    ds_read_b64_tr_b16 v[182:183], v247 offset:1024
    s_mov_b32 m0, s71
    v_mfma_f32_32x32x16_bf16 v[24:39], v[4:7], v[184:187], v[24:39]
    buffer_load_dwordx4 v44, s[4:7], s41 offen sc1 lds
    buffer_load_dwordx4 v45, s[72:75], s41 offen offset:1024 sc1 lds
    v_mfma_f32_32x32x16_bf16 v[48:63], v[0:3], v[188:191], v[48:63]
    s_nop 2
    v_mul_f32 v234, v8, v96
    v_mul_f32 v236, v16, v128
    v_fmac_f32 v234, v9, v97
    v_fmac_f32 v236, v17, v129
    v_fmac_f32 v234, v10, v98
    v_fmac_f32 v236, v18, v130
    v_fmac_f32 v234, v11, v99
    v_mfma_f32_32x32x16_bf16 v[64:79], v[4:7], v[188:191], v[64:79]
    s_setprio 0
    v_fmac_f32 v236, v19, v131
    v_fmac_f32 v234, v12, v100
    v_fmac_f32 v236, v20, v132
    v_fmac_f32 v234, v13, v101
    v_fmac_f32 v236, v21, v133
    v_fmac_f32 v234, v14, v102
    v_fmac_f32 v236, v22, v134
    v_fmac_f32 v234, v15, v103
    v_fmac_f32 v236, v23, v135
    v_mul_f32 v238, v24, v128
    v_mul_f32 v240, v32, v128
    v_fmac_f32 v238, v25, v129
    v_fmac_f32 v240, v33, v129
    v_fmac_f32 v238, v26, v130
    v_fmac_f32 v240, v34, v130
    v_fmac_f32 v238, v27, v131
    v_fmac_f32 v240, v35, v131
    v_fmac_f32 v238, v28, v132
    v_fmac_f32 v240, v36, v132
    v_fmac_f32 v238, v29, v133
    v_fmac_f32 v240, v37, v133
    v_fmac_f32 v238, v30, v134
    v_fmac_f32 v240, v38, v134
    v_fmac_f32 v238, v31, v135
    v_fmac_f32 v240, v39, v135
    v_mul_f32 v235, v48, v104
    v_mul_f32 v237, v56, v136
    v_fmac_f32 v235, v49, v105
    v_fmac_f32 v237, v57, v137
    v_fmac_f32 v235, v50, v106
    v_fmac_f32 v237, v58, v138
    v_fmac_f32 v235, v51, v107
    v_fmac_f32 v237, v59, v139
    v_fmac_f32 v235, v52, v108
    v_fmac_f32 v237, v60, v140
    v_fmac_f32 v235, v53, v109
    v_fmac_f32 v237, v61, v141
    v_fmac_f32 v235, v54, v110
    v_fmac_f32 v237, v62, v142
    v_fmac_f32 v235, v55, v111
    v_fmac_f32 v237, v63, v143
    v_mul_f32 v239, v64, v136
    v_mul_f32 v241, v72, v136
    s_setprio 1
    s_waitcnt vmcnt(6) lgkmcnt(0)
    v_mfma_f32_32x32x16_bf16 v[8:23], v[80:83], v[176:179], 0
    ds_read_b64_tr_b16 v[184:185], v246 offset:2048
    ds_read_b64_tr_b16 v[186:187], v246 offset:3072
    ds_read_b64_tr_b16 v[188:189], v247 offset:2048
    ds_read_b64_tr_b16 v[190:191], v247 offset:3072
    v_fmac_f32 v239, v65, v137
    v_fmac_f32 v241, v73, v137
    s_mov_b32 m0, s68
    v_mfma_f32_32x32x16_bf16 v[24:39], v[84:87], v[176:179], 0
    buffer_load_dwordx4 v222, s[4:7], s42 offen sc1 lds
    buffer_load_dwordx4 v223, s[72:75], s42 offen offset:1024 sc1 lds
    v_fmac_f32 v239, v66, v138
    v_fmac_f32 v241, v74, v138
    v_fmac_f32 v239, v67, v139
    v_fmac_f32 v241, v75, v139
    v_fmac_f32 v239, v68, v140
    v_mfma_f32_32x32x16_bf16 v[48:63], v[80:83], v[180:183], 0
    v_fmac_f32 v241, v76, v140
    v_fmac_f32 v239, v69, v141
    v_fmac_f32 v241, v77, v141
    v_fmac_f32 v239, v70, v142
    v_fmac_f32 v241, v78, v142
    v_fmac_f32 v239, v71, v143
    v_fmac_f32 v241, v79, v143
    v_mfma_f32_32x32x16_bf16 v[64:79], v[84:87], v[180:183], 0
    v_permlane32_swap_b32 v234, v236
    v_permlane32_swap_b32 v235, v237
    v_permlane32_swap_b32 v238, v239
    s_waitcnt vmcnt(6) lgkmcnt(0)
    v_mfma_f32_32x32x16_bf16 v[8:23], v[88:91], v[184:187], v[8:23]
    ds_read_b64_tr_b16 v[176:177], v246 offset:4096
    ds_read_b64_tr_b16 v[178:179], v246 offset:5120
    ds_read_b64_tr_b16 v[180:181], v247 offset:4096
    ds_read_b64_tr_b16 v[182:183], v247 offset:5120
    v_add_f32 v234, v234, v236
    v_add_f32 v235, v235, v237
    s_mov_b32 m0, s69
    v_mfma_f32_32x32x16_bf16 v[24:39], v[92:95], v[184:187], v[24:39]
    buffer_load_dwordx4 v224, s[4:7], s42 offen sc1 lds
    buffer_load_dwordx4 v225, s[72:75], s42 offen offset:1024 sc1 lds
    v_add_f32 v238, -v238, -v239
    s_set_gpr_idx_on s31, gpr_idx(DST)
    s_nop 0
    v_cvt_pk_bf16_f32 v192, v234, v235
    v_cvt_pk_bf16_f32 v197, v238, v238
    s_set_gpr_idx_off
    v_mfma_f32_32x32x16_bf16 v[48:63], v[88:91], v[188:191], v[48:63]
    v_mfma_f32_32x32x16_bf16 v[64:79], v[92:95], v[188:191], v[64:79]
    s_waitcnt vmcnt(4) lgkmcnt(0)
    v_mfma_f32_32x32x16_bf16 v[8:23], v[228:231], v[176:179], v[8:23]
    ds_read_b64_tr_b16 v[184:185], v246 offset:6144
    ds_read_b64_tr_b16 v[186:187], v246 offset:7168
    ds_read_b64_tr_b16 v[188:189], v247 offset:6144
    ds_read_b64_tr_b16 v[190:191], v247 offset:7168
    s_mov_b32 m0, s70
    v_mfma_f32_32x32x16_bf16 v[24:39], v[242:245], v[176:179], v[24:39]
    buffer_load_dwordx4 v226, s[4:7], s42 offen sc1 lds
    buffer_load_dwordx4 v227, s[72:75], s42 offen offset:1024 sc1 lds
    v_mfma_f32_32x32x16_bf16 v[48:63], v[228:231], v[180:183], v[48:63]
    v_mfma_f32_32x32x16_bf16 v[64:79], v[242:245], v[180:183], v[64:79]
    s_waitcnt vmcnt(4) lgkmcnt(0)
    v_mfma_f32_32x32x16_bf16 v[8:23], v[0:3], v[184:187], v[8:23]
    ds_read_b64_tr_b16 v[176:177], v246 offset:0
    ds_read_b64_tr_b16 v[178:179], v246 offset:1024
    ds_read_b64_tr_b16 v[180:181], v247 offset:0
    ds_read_b64_tr_b16 v[182:183], v247 offset:1024
    s_mov_b32 m0, s71
    v_mfma_f32_32x32x16_bf16 v[24:39], v[4:7], v[184:187], v[24:39]
    buffer_load_dwordx4 v44, s[4:7], s42 offen sc1 lds
    buffer_load_dwordx4 v45, s[72:75], s42 offen offset:1024 sc1 lds
    v_mfma_f32_32x32x16_bf16 v[48:63], v[0:3], v[188:191], v[48:63]
    s_nop 2
    v_mul_f32 v46, v8, v144
    v_mul_f32 v234, v16, v112
    v_fmac_f32 v46, v9, v145
    v_fmac_f32 v234, v17, v113
    v_fmac_f32 v46, v10, v146
    v_fmac_f32 v234, v18, v114
    v_fmac_f32 v46, v11, v147
    v_mfma_f32_32x32x16_bf16 v[64:79], v[4:7], v[188:191], v[64:79]
    s_setprio 0
    v_fmac_f32 v234, v19, v115
    v_fmac_f32 v46, v12, v148
    v_fmac_f32 v234, v20, v116
    v_fmac_f32 v46, v13, v149
    v_fmac_f32 v234, v21, v117
    v_fmac_f32 v46, v14, v150
    v_fmac_f32 v234, v22, v118
    v_fmac_f32 v46, v15, v151
    v_fmac_f32 v234, v23, v119
    v_mul_f32 v236, v24, v160
    v_mul_f32 v238, v32, v160
    v_fmac_f32 v236, v25, v161
    v_fmac_f32 v238, v33, v161
    v_fmac_f32 v236, v26, v162
    v_fmac_f32 v238, v34, v162
    v_fmac_f32 v236, v27, v163
    v_fmac_f32 v238, v35, v163
    v_fmac_f32 v236, v28, v164
    v_fmac_f32 v238, v36, v164
    v_fmac_f32 v236, v29, v165
    v_fmac_f32 v238, v37, v165
    v_fmac_f32 v236, v30, v166
    v_fmac_f32 v238, v38, v166
    v_fmac_f32 v236, v31, v167
    v_fmac_f32 v238, v39, v167
    v_mul_f32 v47, v48, v152
    v_mul_f32 v235, v56, v120
    v_fmac_f32 v47, v49, v153
    v_fmac_f32 v235, v57, v121
    v_fmac_f32 v47, v50, v154
    v_fmac_f32 v235, v58, v122
    v_fmac_f32 v47, v51, v155
    v_fmac_f32 v235, v59, v123
    v_fmac_f32 v47, v52, v156
    v_fmac_f32 v235, v60, v124
    v_fmac_f32 v47, v53, v157
    v_fmac_f32 v235, v61, v125
    v_fmac_f32 v47, v54, v158
    v_fmac_f32 v235, v62, v126
    v_fmac_f32 v47, v55, v159
    v_fmac_f32 v235, v63, v127
    v_mul_f32 v237, v64, v168
    v_mul_f32 v239, v72, v168
    s_setprio 1
    s_waitcnt vmcnt(4) lgkmcnt(0)
    v_mfma_f32_32x32x16_bf16 v[8:23], v[80:83], v[176:179], 0
    ds_read_b64_tr_b16 v[184:185], v246 offset:2048
    ds_read_b64_tr_b16 v[186:187], v246 offset:3072
    ds_read_b64_tr_b16 v[188:189], v247 offset:2048
    ds_read_b64_tr_b16 v[190:191], v247 offset:3072
    v_fmac_f32 v237, v65, v169
    v_fmac_f32 v239, v73, v169
    s_mov_b32 m0, s68
    v_mfma_f32_32x32x16_bf16 v[24:39], v[84:87], v[176:179], 0
    buffer_load_dwordx4 v222, s[4:7], s43 offen sc1 lds
    buffer_load_dwordx4 v223, s[72:75], s43 offen offset:1024 sc1 lds
    v_fmac_f32 v237, v66, v170
    v_fmac_f32 v239, v74, v170
    v_fmac_f32 v237, v67, v171
    v_fmac_f32 v239, v75, v171
    v_fmac_f32 v237, v68, v172
    v_mfma_f32_32x32x16_bf16 v[48:63], v[80:83], v[180:183], 0
    v_fmac_f32 v239, v76, v172
    v_fmac_f32 v237, v69, v173
    v_fmac_f32 v239, v77, v173
    v_fmac_f32 v237, v70, v174
    v_fmac_f32 v239, v78, v174
    v_fmac_f32 v237, v71, v175
    v_fmac_f32 v239, v79, v175
    v_mfma_f32_32x32x16_bf16 v[64:79], v[84:87], v[180:183], 0
    v_permlane32_swap_b32 v46, v240
    v_permlane32_swap_b32 v47, v241
    v_add_f32 v46, v46, v240
    v_add_f32 v47, v47, v241
    s_waitcnt vmcnt(4) lgkmcnt(0)
    v_mfma_f32_32x32x16_bf16 v[8:23], v[88:91], v[184:187], v[8:23]
    ds_read_b64_tr_b16 v[176:177], v246 offset:4096
    ds_read_b64_tr_b16 v[178:179], v246 offset:5120
    ds_read_b64_tr_b16 v[180:181], v247 offset:4096
    ds_read_b64_tr_b16 v[182:183], v247 offset:5120
    s_mov_b32 m0, s69
    v_mfma_f32_32x32x16_bf16 v[24:39], v[92:95], v[184:187], v[24:39]
    buffer_load_dwordx4 v224, s[4:7], s43 offen sc1 lds
    buffer_load_dwordx4 v225, s[72:75], s43 offen offset:1024 sc1 lds
    s_set_gpr_idx_on s31, gpr_idx(DST)
    s_nop 0
    v_cvt_pk_bf16_f32 v193, v46, v47
    s_set_gpr_idx_off
    v_mfma_f32_32x32x16_bf16 v[48:63], v[88:91], v[188:191], v[48:63]
    v_mfma_f32_32x32x16_bf16 v[64:79], v[92:95], v[188:191], v[64:79]
    s_waitcnt vmcnt(4) lgkmcnt(0)
    v_mfma_f32_32x32x16_bf16 v[8:23], v[228:231], v[176:179], v[8:23]
    ds_read_b64_tr_b16 v[184:185], v246 offset:6144
    ds_read_b64_tr_b16 v[186:187], v246 offset:7168
    ds_read_b64_tr_b16 v[188:189], v247 offset:6144
    ds_read_b64_tr_b16 v[190:191], v247 offset:7168
    s_mov_b32 m0, s70
    v_mfma_f32_32x32x16_bf16 v[24:39], v[242:245], v[176:179], v[24:39]
    buffer_load_dwordx4 v226, s[4:7], s43 offen sc1 lds
    buffer_load_dwordx4 v227, s[72:75], s43 offen offset:1024 sc1 lds
    v_mfma_f32_32x32x16_bf16 v[48:63], v[228:231], v[180:183], v[48:63]
    v_add_u32 v222, s48, v251
    ds_read2_b32 v[222:223], v222 offset0:1 offset1:3
    v_mfma_f32_32x32x16_bf16 v[64:79], v[242:245], v[180:183], v[64:79]
    s_waitcnt vmcnt(4) lgkmcnt(1)
    v_mfma_f32_32x32x16_bf16 v[8:23], v[0:3], v[184:187], v[8:23]
    ds_read_b64_tr_b16 v[176:177], v246 offset:0
    ds_read_b64_tr_b16 v[178:179], v246 offset:1024
    ds_read_b64_tr_b16 v[180:181], v247 offset:0
    ds_read_b64_tr_b16 v[182:183], v247 offset:1024
    s_mov_b32 m0, s71
    v_mfma_f32_32x32x16_bf16 v[24:39], v[4:7], v[184:187], v[24:39]
    buffer_load_dwordx4 v44, s[4:7], s43 offen sc1 lds
    buffer_load_dwordx4 v45, s[72:75], s43 offen offset:1024 sc1 lds
    s_waitcnt lgkmcnt(4)
    v_mad_u32_u16 v222, v222, s39, v248 op_sel:[1,0,0,0]
    v_mad_u32_u16 v223, v223, s39, v248 op_sel:[1,0,0,0]
    v_mfma_f32_32x32x16_bf16 v[48:63], v[0:3], v[188:191], v[48:63]
    v_add_u32 v224, s49, v251
    ds_read2_b32 v[224:225], v224 offset0:1 offset1:3
    v_mul_f32 v46, v8, v144
    v_fmac_f32 v236, v16, v160
    v_fmac_f32 v46, v9, v145
    v_fmac_f32 v236, v17, v161
    v_fmac_f32 v46, v10, v146
    v_mfma_f32_32x32x16_bf16 v[64:79], v[4:7], v[188:191], v[64:79]
    s_setprio 0
    v_fmac_f32 v236, v18, v162
    v_fmac_f32 v46, v11, v147
    v_fmac_f32 v236, v19, v163
    v_fmac_f32 v46, v12, v148
    v_fmac_f32 v236, v20, v164
    v_fmac_f32 v46, v13, v149
    v_fmac_f32 v236, v21, v165
    v_fmac_f32 v46, v14, v150
    v_fmac_f32 v236, v22, v166
    v_fmac_f32 v46, v15, v151
    v_fmac_f32 v236, v23, v167
    v_fma_f32 v234, v24, v112, -v234
    v_mul_f32 v240, v32, v160
    v_fmac_f32 v234, v25, v113
    v_fmac_f32 v240, v33, v161
    v_fmac_f32 v234, v26, v114
    v_fmac_f32 v240, v34, v162
    v_fmac_f32 v234, v27, v115
    v_fmac_f32 v240, v35, v163
    v_fmac_f32 v234, v28, v116
    v_fmac_f32 v240, v36, v164
    v_fmac_f32 v234, v29, v117
    v_fmac_f32 v240, v37, v165
    v_fmac_f32 v234, v30, v118
    v_fmac_f32 v240, v38, v166
    v_fmac_f32 v234, v31, v119
    v_fmac_f32 v240, v39, v167
    v_mul_f32 v47, v48, v152
    v_fmac_f32 v237, v56, v168
    v_fmac_f32 v47, v49, v153
    v_fmac_f32 v237, v57, v169
    v_fmac_f32 v47, v50, v154
    v_fmac_f32 v237, v58, v170
    v_fmac_f32 v47, v51, v155
    v_fmac_f32 v237, v59, v171
    v_fmac_f32 v47, v52, v156
    v_fmac_f32 v237, v60, v172
    v_fmac_f32 v47, v53, v157
    v_fmac_f32 v237, v61, v173
    v_fmac_f32 v47, v54, v158
    v_fmac_f32 v237, v62, v174
    v_fmac_f32 v47, v55, v159
    v_fmac_f32 v237, v63, v175
    v_fma_f32 v235, v64, v120, -v235
    v_mul_f32 v241, v72, v168
    v_fmac_f32 v235, v65, v121
    v_fmac_f32 v241, v73, v169
    v_fmac_f32 v235, v66, v122
    v_fmac_f32 v241, v74, v170
    v_fmac_f32 v235, v67, v123
    s_setprio 1
    s_waitcnt vmcnt(4) lgkmcnt(1)
    v_mfma_f32_32x32x16_bf16 v[8:23], v[80:83], v[176:179], 0
    ds_read_b64_tr_b16 v[184:185], v246 offset:2048
    ds_read_b64_tr_b16 v[186:187], v246 offset:3072
    ds_read_b64_tr_b16 v[188:189], v247 offset:2048
    ds_read_b64_tr_b16 v[190:191], v247 offset:3072
    v_fmac_f32 v241, v75, v171
    v_fmac_f32 v235, v68, v124
    s_mov_b32 m0, s68
    v_mfma_f32_32x32x16_bf16 v[24:39], v[84:87], v[176:179], 0
    buffer_load_dwordx4 v222, s[4:7], s44 offen sc1 lds
    buffer_load_dwordx4 v223, s[72:75], s44 offen offset:1024 sc1 lds
    s_waitcnt lgkmcnt(4)
    v_mad_u32_u16 v224, v224, s39, v248 op_sel:[1,0,0,0]
    v_mad_u32_u16 v225, v225, s39, v248 op_sel:[1,0,0,0]
    v_fmac_f32 v241, v76, v172
    v_fmac_f32 v235, v69, v125
    v_mfma_f32_32x32x16_bf16 v[48:63], v[80:83], v[180:183], 0
    v_add_u32 v226, s50, v251
    ds_read2_b32 v[226:227], v226 offset0:1 offset1:3
    v_fmac_f32 v241, v77, v173
    v_fmac_f32 v235, v70, v126
    v_fmac_f32 v241, v78, v174
    v_fmac_f32 v235, v71, v127
    v_fmac_f32 v241, v79, v175
    v_mfma_f32_32x32x16_bf16 v[64:79], v[84:87], v[180:183], 0
    v_permlane32_swap_b32 v236, v46
    v_permlane32_swap_b32 v237, v47
    v_add_f32 v236, v236, v46
    v_add_f32 v237, v237, v47
    s_waitcnt vmcnt(4) lgkmcnt(1)
    v_mfma_f32_32x32x16_bf16 v[8:23], v[88:91], v[184:187], v[8:23]
    ds_read_b64_tr_b16 v[176:177], v246 offset:4096
    ds_read_b64_tr_b16 v[178:179], v246 offset:5120
    ds_read_b64_tr_b16 v[180:181], v247 offset:4096
    ds_read_b64_tr_b16 v[182:183], v247 offset:5120
    s_mov_b32 m0, s69
    v_mfma_f32_32x32x16_bf16 v[24:39], v[92:95], v[184:187], v[24:39]
    buffer_load_dwordx4 v224, s[4:7], s45 offen sc1 lds
    buffer_load_dwordx4 v225, s[72:75], s45 offen offset:1024 sc1 lds
    s_waitcnt lgkmcnt(4)
    v_mad_u32_u16 v226, v226, s39, v248 op_sel:[1,0,0,0]
    v_mad_u32_u16 v227, v227, s39, v248 op_sel:[1,0,0,0]
    v_mfma_f32_32x32x16_bf16 v[48:63], v[88:91], v[188:191], v[48:63]
    s_set_gpr_idx_on s31, gpr_idx(DST)
    s_nop 0
    v_cvt_pk_bf16_f32 v196, v236, v237
    s_set_gpr_idx_off
    v_mfma_f32_32x32x16_bf16 v[64:79], v[92:95], v[188:191], v[64:79]
    s_waitcnt vmcnt(4) lgkmcnt(0)
    v_mfma_f32_32x32x16_bf16 v[8:23], v[228:231], v[176:179], v[8:23]
    ds_read_b64_tr_b16 v[184:185], v246 offset:6144
    ds_read_b64_tr_b16 v[186:187], v246 offset:7168
    ds_read_b64_tr_b16 v[188:189], v247 offset:6144
    ds_read_b64_tr_b16 v[190:191], v247 offset:7168
    s_mov_b32 s32, s31
    s_mov_b32 s31, s35
    s_mov_b32 m0, s70
    v_mfma_f32_32x32x16_bf16 v[24:39], v[242:245], v[176:179], v[24:39]
    buffer_load_dwordx4 v226, s[4:7], s46 offen sc1 lds
    buffer_load_dwordx4 v227, s[72:75], s46 offen offset:1024 sc1 lds
    s_sub_u32 s26, s48, s29
    s_mov_b32 s29, s48
    s_mov_b32 s30, s3
    s_bfe_u32 s56, s3, 0x40012
    v_mfma_f32_32x32x16_bf16 v[48:63], v[228:231], v[180:183], v[48:63]
    s_cmp_eq_u32 s34, 0
    s_cselect_b32 s56, s56, 0
    v_mfma_f32_32x32x16_bf16 v[64:79], v[242:245], v[180:183], v[64:79]
    s_waitcnt vmcnt(4) lgkmcnt(0)
    v_mfma_f32_32x32x16_bf16 v[8:23], v[0:3], v[184:187], v[8:23]
    ds_read_b64_tr_b16 v[176:177], v246 offset:0
    ds_read_b64_tr_b16 v[178:179], v246 offset:1024
    ds_read_b64_tr_b16 v[180:181], v247 offset:0
    ds_read_b64_tr_b16 v[182:183], v247 offset:1024
    s_mov_b32 m0, s71
    v_mfma_f32_32x32x16_bf16 v[24:39], v[4:7], v[184:187], v[24:39]
    s_cmp_eq_u32 s33, 4
    s_cbranch_scc1 K2_g4_115
    buffer_load_dwordx4 v224, s[4:7], s47 offen sc1 lds
    buffer_load_dwordx4 v225, s[72:75], s47 offen offset:1024 sc1 lds
K2_back_116:
    v_mfma_f32_32x32x16_bf16 v[48:63], v[0:3], v[188:191], v[48:63]
    s_nop 0
    v_mul_f32 v236, v8, v144
    v_fma_f32 v238, v16, v160, -v238
    v_fmac_f32 v236, v9, v145
    v_fmac_f32 v238, v17, v161
    v_fmac_f32 v236, v10, v146
    v_fmac_f32 v238, v18, v162
    v_fmac_f32 v236, v11, v147
    v_mfma_f32_32x32x16_bf16 v[64:79], v[4:7], v[188:191], v[64:79]
    s_setprio 0
    v_fmac_f32 v238, v19, v163
    v_fmac_f32 v236, v12, v148
    v_fmac_f32 v238, v20, v164
    v_fmac_f32 v236, v13, v149
    v_fmac_f32 v238, v21, v165
    v_fmac_f32 v236, v14, v150
    v_fmac_f32 v238, v22, v166
    v_fmac_f32 v236, v15, v151
    v_fmac_f32 v238, v23, v167
    v_add_u32 v249, s26, v249
    v_add_u32 v250, s26, v250
    v_fmac_f32 v240, v24, v160
    v_fma_f32 v234, v32, v112, -v234
    v_fmac_f32 v240, v25, v161
    v_fmac_f32 v234, v33, v113
    v_fmac_f32 v240, v26, v162
    v_fmac_f32 v234, v34, v114
    v_fmac_f32 v240, v27, v163
    v_fmac_f32 v234, v35, v115
    v_fmac_f32 v240, v28, v164
    v_fmac_f32 v234, v36, v116
    v_fmac_f32 v240, v29, v165
    v_fmac_f32 v234, v37, v117
    v_fmac_f32 v240, v30, v166
    v_fmac_f32 v234, v38, v118
    v_fmac_f32 v240, v31, v167
    v_fmac_f32 v234, v39, v119
    ds_read_b64_tr_b16 v[80:81], v249 offset:0
    ds_read_u16_d16_hi v40, v250 offset:0
    v_mul_f32 v237, v48, v152
    v_fma_f32 v239, v56, v168, -v239
    v_fmac_f32 v237, v49, v153
    v_fmac_f32 v239, v57, v169
    v_fmac_f32 v237, v50, v154
    v_fmac_f32 v239, v58, v170
    v_fmac_f32 v237, v51, v155
    v_fmac_f32 v239, v59, v171
    v_fmac_f32 v237, v52, v156
    v_fmac_f32 v239, v60, v172
    v_fmac_f32 v237, v53, v157
    v_fmac_f32 v239, v61, v173
    v_fmac_f32 v237, v54, v158
    v_fmac_f32 v239, v62, v174
    v_fmac_f32 v237, v55, v159
    v_fmac_f32 v239, v63, v175
    ds_read_b64_tr_b16 v[88:89], v249 offset:512
    ds_read_u16_d16_hi v41, v250 offset:128
    v_fmac_f32 v241, v64, v168
    v_fma_f32 v235, v72, v120, -v235
    v_fmac_f32 v241, v65, v169
    v_fmac_f32 v235, v73, v121
    v_fmac_f32 v241, v66, v170
    v_fmac_f32 v235, v74, v122
    v_fmac_f32 v241, v67, v171
    v_fmac_f32 v235, v75, v123
    v_fmac_f32 v241, v68, v172
    v_fmac_f32 v235, v76, v124
    v_fmac_f32 v241, v69, v173
    v_fmac_f32 v235, v77, v125
    v_fmac_f32 v241, v70, v174
    v_fmac_f32 v235, v78, v126
    v_fmac_f32 v241, v71, v175
    v_fmac_f32 v235, v79, v127
    s_cmp_eq_u32 s56, 5
    s_cbranch_scc1 K2_U20
    s_cmp_eq_u32 s56, 6
    s_cbranch_scc1 K2_U3h0
    s_branch K2_DSP0
K2_U11:
    s_setprio 0
    s_mov_b64 exec, 0x1ff
    ds_add_rtn_u32 v42, v254, v251
    s_mov_b64 exec, -1
    s_waitcnt lgkmcnt(3)
    v_lshlrev_b32 v16, 16, v80
    v_and_b32 v17, 0xffff0000, v80
    v_lshlrev_b32 v18, 16, v81
    v_and_b32 v19, 0xffff0000, v81
    v_mov_b32 v82, v81
    v_mul_f32_dpp v32, v40, v16 row_newbcast:0 row_mask:0xf bank_mask:0xf
    v_mul_f32_dpp v33, v40, v17 row_newbcast:1 row_mask:0xf bank_mask:0xf
    v_mul_f32_dpp v34, v40, v18 row_newbcast:2 row_mask:0xf bank_mask:0xf
    v_mul_f32_dpp v35, v40, v19 row_newbcast:3 row_mask:0xf bank_mask:0xf
    v_mul_f32_dpp v36, v40, v16 row_newbcast:4 row_mask:0xf bank_mask:0xf
    v_mul_f32_dpp v37, v40, v17 row_newbcast:5 row_mask:0xf bank_mask:0xf
    v_mul_f32_dpp v38, v40, v18 row_newbcast:6 row_mask:0xf bank_mask:0xf
    v_mul_f32_dpp v39, v40, v19 row_newbcast:7 row_mask:0xf bank_mask:0xf
    v_cvt_pk_bf16_f32 v81, v32, v33
    v_cvt_pk_bf16_f32 v83, v34, v35
    v_mul_f32_dpp v16, v40, v16 row_newbcast:8 row_mask:0xf bank_mask:0xf
    v_mul_f32_dpp v17, v40, v17 row_newbcast:9 row_mask:0xf bank_mask:0xf
    v_mul_f32_dpp v18, v40, v18 row_newbcast:10 row_mask:0xf bank_mask:0xf
    v_mul_f32_dpp v19, v40, v19 row_newbcast:11 row_mask:0xf bank_mask:0xf
    v_cvt_pk_bf16_f32 v84, v36, v37
    v_cvt_pk_bf16_f32 v86, v38, v39
    v_cvt_pk_bf16_f32 v85, v16, v17
    v_cvt_pk_bf16_f32 v87, v18, v19
    v_permlane16_swap_b32 v80, v81
    v_permlane16_swap_b32 v82, v83
    v_permlane16_swap_b32 v84, v85
    v_permlane16_swap_b32 v86, v87
    s_waitcnt lgkmcnt(0)
    v_readlane_b32 s58, v42, 8
    s_nop 0
    s_lshr_b32 s58, s58, 4
    s_cmp_lt_u32 s58, s22
    s_cbranch_scc0 K2_nul_121
    v_readlane_b32 s3, v253, s58
    s_nop 0
    s_bfe_u32 s58, s3, 0x60016
    s_and_b32 s59, s58, 7
    s_lshr_b32 s60, s58, 3
K2_chk_123:
    v_readlane_b32 s61, v42, s59
    s_nop 0
    s_cmp_gt_u32 s61, s60
    s_cbranch_scc0 K2_spin_122
K2_back_124:
    s_lshl_b32 s44, s34, 7
    s_and_b32 s48, s3, 0x3ffff
    s_bfe_u32 s33, s3, 0x30013
    s_mov_b32 s35, s48
    s_mov_b32 s45, s44
    s_xor_b32 s47, s44, 256
    s_add_u32 s49, s48, 128
    s_add_u32 s60, s48, 256
    s_cmp_eq_u32 s33, 3
    s_cselect_b32 s46, s44, s47
    s_cselect_b32 s50, s60, s48
    s_sub_u32 s60, s33, 2
    s_cmp_lt_u32 s60, 2
    s_cbranch_scc0 K2_rare_125
K2_back_126:
    v_add_u32 v222, s48, v251
    ds_read2_b32 v[222:223], v222 offset0:1 offset1:3
    v_add_u32 v224, s49, v251
    ds_read2_b32 v[224:225], v224 offset0:1 offset1:3
    v_add_u32 v226, s50, v251
    ds_read2_b32 v[226:227], v226 offset0:1 offset1:3
    s_waitcnt lgkmcnt(2)
    v_mad_u32_u16 v222, v222, s39, v248 op_sel:[1,0,0,0]
    v_mad_u32_u16 v223, v223, s39, v248 op_sel:[1,0,0,0]
    s_waitcnt lgkmcnt(1)
    v_mad_u32_u16 v224, v224, s39, v248 op_sel:[1,0,0,0]
    v_mad_u32_u16 v225, v225, s39, v248 op_sel:[1,0,0,0]
    s_waitcnt lgkmcnt(0)
    v_mad_u32_u16 v226, v226, s39, v248 op_sel:[1,0,0,0]
    v_mad_u32_u16 v227, v227, s39, v248 op_sel:[1,0,0,0]
    s_waitcnt vmcnt(4)
    s_setprio 1
    v_mfma_f32_32x32x16_bf16 v[8:23], v[80:83], v[176:179], 0
    ds_read_b64_tr_b16 v[184:185], v246 offset:2048
    ds_read_b64_tr_b16 v[186:187], v246 offset:3072
    ds_read_b64_tr_b16 v[188:189], v247 offset:2048
    ds_read_b64_tr_b16 v[190:191], v247 offset:3072
    s_mov_b32 m0, s68
    v_mfma_f32_32x32x16_bf16 v[24:39], v[84:87], v[176:179], 0
    buffer_load_dwordx4 v222, s[4:7], s44 offen sc1 lds
    buffer_load_dwordx4 v223, s[72:75], s44 offen offset:1024 sc1 lds
    v_permlane32_swap_b32 v236, v234
    v_permlane32_swap_b32 v237, v235
    v_mov_b64 v[0:1], 0
    v_mov_b64 v[2:3], 0
    v_mov_b64 v[4:5], 0
    v_mov_b64 v[6:7], 0
    v_mov_b64 v[40:41], 0
    v_mov_b64 v[42:43], 0
    v_mov_b64 v[44:45], 0
    v_mov_b64 v[46:47], 0
    v_mfma_f32_32x32x16_bf16 v[48:63], v[80:83], v[180:183], 0
    v_permlane32_swap_b32 v240, v238
    v_permlane32_swap_b32 v241, v239
    v_add_f32 v236, v236, v234
    v_add_f32 v237, v237, v235
    v_add_f32 v240, -v240, -v238
    v_mfma_f32_32x32x16_bf16 v[64:79], v[84:87], v[180:183], 0
    s_setprio 0
    v_add_f32 v241, -v241, -v239
    v_cvt_pk_bf16_f32 v236, v236, v237
    v_cvt_pk_bf16_f32 v240, v240, v241
    ds_write2st64_b32 v232, v236, v240 offset0:2 offset1:3
    v_mul_f32 v234, v8, v96
    v_mul_f32 v236, v16, v128
    v_fmac_f32 v234, v9, v97
    v_fmac_f32 v236, v17, v129
    v_fmac_f32 v234, v10, v98
    v_fmac_f32 v236, v18, v130
    v_fmac_f32 v234, v11, v99
    v_fmac_f32 v236, v19, v131
    v_fmac_f32 v234, v12, v100
    v_fmac_f32 v236, v20, v132
    v_fmac_f32 v234, v13, v101
    v_fmac_f32 v236, v21, v133
    v_fmac_f32 v234, v14, v102
    v_fmac_f32 v236, v22, v134
    v_fmac_f32 v234, v15, v103
    v_fmac_f32 v236, v23, v135
    v_mul_f32 v238, v24, v128
    v_mul_f32 v240, v32, v128
    v_fmac_f32 v238, v25, v129
    v_fmac_f32 v240, v33, v129
    v_fmac_f32 v238, v26, v130
    v_fmac_f32 v240, v34, v130
    v_fmac_f32 v238, v27, v131
    v_fmac_f32 v240, v35, v131
    v_fmac_f32 v238, v28, v132
    v_fmac_f32 v240, v36, v132
    v_fmac_f32 v238, v29, v133
    v_fmac_f32 v240, v37, v133
    v_fmac_f32 v238, v30, v134
    v_fmac_f32 v240, v38, v134
    v_fmac_f32 v238, v31, v135
    v_fmac_f32 v240, v39, v135
    v_mul_f32 v235, v48, v104
    v_mul_f32 v237, v56, v136
    v_fmac_f32 v235, v49, v105
    v_fmac_f32 v237, v57, v137
    v_fmac_f32 v235, v50, v106
    v_fmac_f32 v237, v58, v138
    v_fmac_f32 v235, v51, v107
    v_fmac_f32 v237, v59, v139
    v_fmac_f32 v235, v52, v108
    v_fmac_f32 v237, v60, v140
    v_fmac_f32 v235, v53, v109
    v_fmac_f32 v237, v61, v141
    v_fmac_f32 v235, v54, v110
    v_fmac_f32 v237, v62, v142
    v_fmac_f32 v235, v55, v111
    v_fmac_f32 v237, v63, v143
    v_mul_f32 v239, v64, v136
    v_mul_f32 v241, v72, v136
    v_fmac_f32 v239, v65, v137
    v_fmac_f32 v241, v73, v137
    v_fmac_f32 v239, v66, v138
    v_fmac_f32 v241, v74, v138
    v_fmac_f32 v239, v67, v139
    v_fmac_f32 v241, v75, v139
    v_fmac_f32 v239, v68, v140
    v_fmac_f32 v241, v76, v140
    v_fmac_f32 v239, v69, v141
    v_fmac_f32 v241, v77, v141
    v_fmac_f32 v239, v70, v142
    v_fmac_f32 v241, v78, v142
    v_fmac_f32 v239, v71, v143
    v_fmac_f32 v241, v79, v143
    s_setprio 1
    s_waitcnt vmcnt(4) lgkmcnt(1)
    v_mfma_f32_32x32x16_bf16 v[24:39], v[80:83], v[184:187], 0
    ds_read_b64_tr_b16 v[176:177], v246 offset:4096
    ds_read_b64_tr_b16 v[178:179], v246 offset:5120
    ds_read_b64_tr_b16 v[180:181], v247 offset:4096
    ds_read_b64_tr_b16 v[182:183], v247 offset:5120
    s_mov_b32 m0, s69
    v_mfma_f32_32x32x16_bf16 v[8:23], v[84:87], v[184:187], 0
    buffer_load_dwordx4 v224, s[4:7], s45 offen sc1 lds
    buffer_load_dwordx4 v225, s[72:75], s45 offen offset:1024 sc1 lds
    v_permlane32_swap_b32 v234, v236
    v_permlane32_swap_b32 v235, v237
    v_mfma_f32_32x32x16_bf16 v[48:63], v[84:87], v[188:191], 0
    v_permlane32_swap_b32 v238, v239
    v_lshl_add_u32 v232, v252, 1, s31
    v_add_f32 v234, v234, v236
    v_add_f32 v235, v235, v237
    v_add_f32 v238, -v238, -v239
    v_sub_u32 v239, v232, v233
    v_mfma_f32_32x32x16_bf16 v[64:79], v[80:83], v[188:191], 0
    s_setprio 0
    v_cvt_pk_bf16_f32 v234, v234, v235
    v_cvt_pk_bf16_f32 v238, v238, v238
    ds_write_b32 v232, v234 offset:0
    ds_write_b16 v239, v238 offset:1280
    v_mul_f32 v234, v24, v144
    v_fmac_f32 v234, v25, v145
    v_fmac_f32 v234, v26, v146
    v_fmac_f32 v234, v27, v147
    v_fmac_f32 v234, v28, v148
    v_fmac_f32 v234, v29, v149
    v_fmac_f32 v234, v30, v150
    v_fmac_f32 v234, v31, v151
    v_mul_f32 v238, v16, v160
    v_mul_f32 v239, v56, v168
    v_fmac_f32 v238, v17, v161
    v_fmac_f32 v239, v57, v169
    v_fmac_f32 v238, v18, v162
    v_fmac_f32 v239, v58, v170
    v_fmac_f32 v238, v19, v163
    v_fmac_f32 v239, v59, v171
    v_fmac_f32 v238, v20, v164
    v_fmac_f32 v239, v60, v172
    v_fmac_f32 v238, v21, v165
    v_fmac_f32 v239, v61, v173
    v_fmac_f32 v238, v22, v166
    v_fmac_f32 v239, v62, v174
    v_fmac_f32 v238, v23, v167
    v_fmac_f32 v239, v63, v175
    v_mul_f32 v235, v64, v152
    v_fmac_f32 v235, v65, v153
    v_fmac_f32 v235, v66, v154
    v_fmac_f32 v235, v67, v155
    v_fmac_f32 v235, v68, v156
    v_fmac_f32 v235, v69, v157
    v_fmac_f32 v235, v70, v158
    v_fmac_f32 v235, v71, v159
    s_setprio 1
    s_waitcnt vmcnt(4) lgkmcnt(2)
    v_mfma_f32_32x32x16_bf16 v[0:15], v[80:83], v[176:179], v[0:15]
    ds_read_b64_tr_b16 v[184:185], v246 offset:6144
    ds_read_b64_tr_b16 v[186:187], v246 offset:7168
    ds_read_b64_tr_b16 v[188:189], v247 offset:6144
    ds_read_b64_tr_b16 v[190:191], v247 offset:7168
    s_mov_b32 s32, s31
    s_mov_b32 s31, s35
    s_mov_b32 m0, s70
    v_mfma_f32_32x32x16_bf16 v[16:31], v[84:87], v[176:179], 0
    buffer_load_dwordx4 v226, s[4:7], s46 offen sc1 lds
    buffer_load_dwordx4 v227, s[72:75], s46 offen offset:1024 sc1 lds
    v_permlane32_swap_b32 v234, v240
    v_permlane32_swap_b32 v235, v241
    v_add_f32 v234, v234, v240
    v_mfma_f32_32x32x16_bf16 v[40:55], v[80:83], v[180:183], v[40:55]
    v_add_f32 v235, v235, v241
    v_cvt_pk_bf16_f32 v234, v234, v235
    ds_write_b32 v232, v234 offset:256
    s_sub_u32 s26, s48, s29
    s_mov_b32 s29, s48
    s_mov_b32 s30, s3
    s_bfe_u32 s56, s3, 0x40012
    v_mfma_f32_32x32x16_bf16 v[56:71], v[84:87], v[180:183], 0
    s_setprio 0
    s_cmp_lg_u32 s36, 0
    s_cselect_b32 s56, s56, 0
    v_mul_f32 v240, v0, v144
    v_mul_f32 v236, v8, v160
    v_fmac_f32 v240, v1, v145
    v_fmac_f32 v236, v9, v161
    v_fmac_f32 v240, v2, v146
    v_fmac_f32 v236, v10, v162
    v_fmac_f32 v240, v3, v147
    v_fmac_f32 v236, v11, v163
    v_fmac_f32 v240, v4, v148
    v_fmac_f32 v236, v12, v164
    v_fmac_f32 v240, v5, v149
    v_fmac_f32 v236, v13, v165
    v_fmac_f32 v240, v6, v150
    v_fmac_f32 v236, v14, v166
    v_fmac_f32 v240, v7, v151
    v_fmac_f32 v236, v15, v167
    v_mul_f32 v234, v16, v112
    v_mul_f32 v241, v40, v152
    v_mul_f32 v237, v48, v168
    v_fmac_f32 v234, v17, v113
    v_fmac_f32 v241, v41, v153
    v_fmac_f32 v237, v49, v169
    v_fmac_f32 v234, v18, v114
    v_fmac_f32 v241, v42, v154
    v_fmac_f32 v237, v50, v170
    v_fmac_f32 v234, v19, v115
    v_fmac_f32 v241, v43, v155
    v_fmac_f32 v237, v51, v171
    v_fmac_f32 v234, v20, v116
    v_fmac_f32 v241, v44, v156
    v_fmac_f32 v237, v52, v172
    v_fmac_f32 v234, v21, v117
    v_fmac_f32 v241, v45, v157
    v_fmac_f32 v237, v53, v173
    v_fmac_f32 v234, v22, v118
    v_fmac_f32 v241, v46, v158
    v_fmac_f32 v237, v54, v174
    v_fmac_f32 v234, v23, v119
    v_fmac_f32 v241, v47, v159
    v_fmac_f32 v237, v55, v175
    v_mul_f32 v235, v56, v120
    v_fmac_f32 v235, v57, v121
    v_fmac_f32 v235, v58, v122
    v_fmac_f32 v235, v59, v123
    v_fmac_f32 v235, v60, v124
    v_fmac_f32 v235, v61, v125
    v_fmac_f32 v235, v62, v126
    v_fmac_f32 v235, v63, v127
    s_setprio 1
    s_waitcnt vmcnt(4) lgkmcnt(1)
    v_mfma_f32_32x32x16_bf16 v[8:23], v[80:83], v[184:187], 0
    ds_read_b64_tr_b16 v[176:177], v246 offset:0
    ds_read_b64_tr_b16 v[178:179], v246 offset:1024
    ds_read_b64_tr_b16 v[180:181], v247 offset:0
    ds_read_b64_tr_b16 v[182:183], v247 offset:1024
    s_mov_b32 m0, s71
    v_mfma_f32_32x32x16_bf16 v[24:39], v[84:87], v[184:187], v[24:39]
    s_cmp_eq_u32 s33, 4
    s_cbranch_scc1 K2_g4_128
    buffer_load_dwordx4 v224, s[4:7], s47 offen sc1 lds
    buffer_load_dwordx4 v225, s[72:75], s47 offen offset:1024 sc1 lds
K2_back_129:
    v_permlane32_swap_b32 v236, v240
    v_mfma_f32_32x32x16_bf16 v[64:79], v[84:87], v[188:191], v[64:79]
    v_permlane32_swap_b32 v237, v241
    v_add_f32 v236, v236, v240
    v_add_f32 v237, v237, v241
    v_cvt_pk_bf16_f32 v236, v236, v237
    ds_write_b32 v232, v236 offset:1024
    v_mfma_f32_32x32x16_bf16 v[48:63], v[80:83], v[188:191], 0
    s_setprio 0
    v_mul_f32 v236, v8, v144
    v_fma_f32 v238, v16, v160, -v238
    v_fmac_f32 v236, v9, v145
    v_fmac_f32 v238, v17, v161
    v_fmac_f32 v236, v10, v146
    v_fmac_f32 v238, v18, v162
    v_fmac_f32 v236, v11, v147
    v_fmac_f32 v238, v19, v163
    v_fmac_f32 v236, v12, v148
    v_fmac_f32 v238, v20, v164
    v_fmac_f32 v236, v13, v149
    v_fmac_f32 v238, v21, v165
    v_fmac_f32 v236, v14, v150
    v_fmac_f32 v238, v22, v166
    v_fmac_f32 v236, v15, v151
    v_fmac_f32 v238, v23, v167
    v_add_u32 v249, s26, v249
    v_add_u32 v250, s26, v250
    v_mul_f32 v240, v24, v160
    v_fma_f32 v234, v32, v112, -v234
    v_fmac_f32 v240, v25, v161
    v_fmac_f32 v234, v33, v113
    v_fmac_f32 v240, v26, v162
    v_fmac_f32 v234, v34, v114
    v_fmac_f32 v240, v27, v163
    v_fmac_f32 v234, v35, v115
    v_fmac_f32 v240, v28, v164
    v_fmac_f32 v234, v36, v116
    v_fmac_f32 v240, v29, v165
    v_fmac_f32 v234, v37, v117
    v_fmac_f32 v240, v30, v166
    v_fmac_f32 v234, v38, v118
    v_fmac_f32 v240, v31, v167
    v_fmac_f32 v234, v39, v119
    ds_read_b64_tr_b16 v[80:81], v249 offset:0
    ds_read_u16_d16_hi v40, v250 offset:0
    v_mul_f32 v241, v64, v168
    v_fma_f32 v235, v72, v120, -v235
    v_fmac_f32 v241, v65, v169
    v_fmac_f32 v235, v73, v121
    v_fmac_f32 v241, v66, v170
    v_fmac_f32 v235, v74, v122
    v_fmac_f32 v241, v67, v171
    v_fmac_f32 v235, v75, v123
    v_fmac_f32 v241, v68, v172
    v_fmac_f32 v235, v76, v124
    v_fmac_f32 v241, v69, v173
    v_fmac_f32 v235, v77, v125
    v_fmac_f32 v241, v70, v174
    v_fmac_f32 v235, v78, v126
    v_fmac_f32 v241, v71, v175
    v_fmac_f32 v235, v79, v127
    ds_read_b64_tr_b16 v[88:89], v249 offset:512
    ds_read_u16_d16_hi v41, v250 offset:128
    v_mul_f32 v237, v48, v152
    v_fma_f32 v239, v56, v168, -v239
    v_fmac_f32 v237, v49, v153
    v_fmac_f32 v239, v57, v169
    v_fmac_f32 v237, v50, v154
    v_fmac_f32 v239, v58, v170
    v_fmac_f32 v237, v51, v155
    v_fmac_f32 v239, v59, v171
    v_fmac_f32 v237, v52, v156
    v_fmac_f32 v239, v60, v172
    v_fmac_f32 v237, v53, v157
    v_fmac_f32 v239, v61, v173
    v_fmac_f32 v237, v54, v158
    v_fmac_f32 v239, v62, v174
    v_fmac_f32 v237, v55, v159
    v_fmac_f32 v239, v63, v175
    s_cmp_eq_u32 s56, 5
    s_cbranch_scc1 K2_U21
    s_cmp_eq_u32 s56, 6
    s_cbranch_scc1 K2_U3h1
    s_branch K2_DSP1
K2_U41:
    s_setprio 0
    ds_read_b64_tr_b16 v[228:229], v249 offset:1024
    ds_read_u16_d16_hi v42, v250 offset:256
    s_lshr_b32 s65, s30, 28
    s_mul_i32 s66, s22, 2080
    s_lshl_b32 s65, s65, 9
    s_add_u32 s65, s65, s66
    s_add_u32 s65, s65, 65536
    s_sub_u32 s65, s65, s29
    s_sub_u32 s65, s65, 512
    v_add_u32 v56, s65, v249
    ds_read_b64_tr_b16 v[0:1], v56 offset:0
    ds_read_u16_d16_hi v43, v250 offset:384
    s_waitcnt lgkmcnt(4)
    v_lshlrev_b32 v16, 16, v80
    v_and_b32 v17, 0xffff0000, v80
    v_lshlrev_b32 v18, 16, v81
    v_and_b32 v19, 0xffff0000, v81
    v_mov_b32 v82, v81
    v_mul_f32_dpp v32, v40, v16 row_newbcast:0 row_mask:0xf bank_mask:0xf
    v_mul_f32_dpp v33, v40, v17 row_newbcast:1 row_mask:0xf bank_mask:0xf
    v_mul_f32_dpp v34, v40, v18 row_newbcast:2 row_mask:0xf bank_mask:0xf
    v_mul_f32_dpp v35, v40, v19 row_newbcast:3 row_mask:0xf bank_mask:0xf
    v_mul_f32_dpp v36, v40, v16 row_newbcast:4 row_mask:0xf bank_mask:0xf
    v_mul_f32_dpp v37, v40, v17 row_newbcast:5 row_mask:0xf bank_mask:0xf
    v_mul_f32_dpp v38, v40, v18 row_newbcast:6 row_mask:0xf bank_mask:0xf
    v_mul_f32_dpp v39, v40, v19 row_newbcast:7 row_mask:0xf bank_mask:0xf
    v_cvt_pk_bf16_f32 v81, v32, v33
    v_cvt_pk_bf16_f32 v83, v34, v35
    v_mul_f32_dpp v16, v40, v16 row_newbcast:8 row_mask:0xf bank_mask:0xf
    v_mul_f32_dpp v17, v40, v17 row_newbcast:9 row_mask:0xf bank_mask:0xf
    v_mul_f32_dpp v18, v40, v18 row_newbcast:10 row_mask:0xf bank_mask:0xf
    v_mul_f32_dpp v19, v40, v19 row_newbcast:11 row_mask:0xf bank_mask:0xf
    v_cvt_pk_bf16_f32 v84, v36, v37
    v_cvt_pk_bf16_f32 v86, v38, v39
    v_cvt_pk_bf16_f32 v85, v16, v17
    v_cvt_pk_bf16_f32 v87, v18, v19
    v_permlane16_swap_b32 v80, v81
    v_permlane16_swap_b32 v82, v83
    v_lshlrev_b32 v24, 16, v88
    v_and_b32 v25, 0xffff0000, v88
    v_lshlrev_b32 v26, 16, v89
    v_and_b32 v27, 0xffff0000, v89
    v_mov_b32 v90, v89
    v_permlane16_swap_b32 v84, v85
    v_permlane16_swap_b32 v86, v87
    v_mul_f32_dpp v32, v41, v24 row_newbcast:0 row_mask:0xf bank_mask:0xf
    v_mul_f32_dpp v33, v41, v25 row_newbcast:1 row_mask:0xf bank_mask:0xf
    v_mul_f32_dpp v34, v41, v26 row_newbcast:2 row_mask:0xf bank_mask:0xf
    v_mul_f32_dpp v35, v41, v27 row_newbcast:3 row_mask:0xf bank_mask:0xf
    v_mul_f32_dpp v36, v41, v24 row_newbcast:4 row_mask:0xf bank_mask:0xf
    v_mul_f32_dpp v37, v41, v25 row_newbcast:5 row_mask:0xf bank_mask:0xf
    v_mul_f32_dpp v38, v41, v26 row_newbcast:6 row_mask:0xf bank_mask:0xf
    v_mul_f32_dpp v39, v41, v27 row_newbcast:7 row_mask:0xf bank_mask:0xf
    v_cvt_pk_bf16_f32 v89, v32, v33
    v_cvt_pk_bf16_f32 v91, v34, v35
    v_mul_f32_dpp v24, v41, v24 row_newbcast:8 row_mask:0xf bank_mask:0xf
    v_mul_f32_dpp v25, v41, v25 row_newbcast:9 row_mask:0xf bank_mask:0xf
    v_mul_f32_dpp v26, v41, v26 row_newbcast:10 row_mask:0xf bank_mask:0xf
    v_mul_f32_dpp v27, v41, v27 row_newbcast:11 row_mask:0xf bank_mask:0xf
    v_cvt_pk_bf16_f32 v92, v36, v37
    v_cvt_pk_bf16_f32 v94, v38, v39
    v_cvt_pk_bf16_f32 v93, v24, v25
    v_cvt_pk_bf16_f32 v95, v26, v27
    v_permlane16_swap_b32 v88, v89
    v_permlane16_swap_b32 v90, v91
    s_waitcnt lgkmcnt(2)
    v_lshlrev_b32 v16, 16, v228
    v_and_b32 v17, 0xffff0000, v228
    v_lshlrev_b32 v18, 16, v229
    v_and_b32 v19, 0xffff0000, v229
    v_mov_b32 v230, v229
    v_permlane16_swap_b32 v92, v93
    v_permlane16_swap_b32 v94, v95
    v_mul_f32_dpp v32, v42, v16 row_newbcast:0 row_mask:0xf bank_mask:0xf
    v_mul_f32_dpp v33, v42, v17 row_newbcast:1 row_mask:0xf bank_mask:0xf
    v_mul_f32_dpp v34, v42, v18 row_newbcast:2 row_mask:0xf bank_mask:0xf
    v_mul_f32_dpp v35, v42, v19 row_newbcast:3 row_mask:0xf bank_mask:0xf
    v_mul_f32_dpp v36, v42, v16 row_newbcast:4 row_mask:0xf bank_mask:0xf
    v_mul_f32_dpp v37, v42, v17 row_newbcast:5 row_mask:0xf bank_mask:0xf
    v_mul_f32_dpp v38, v42, v18 row_newbcast:6 row_mask:0xf bank_mask:0xf
    v_mul_f32_dpp v39, v42, v19 row_newbcast:7 row_mask:0xf bank_mask:0xf
    v_cvt_pk_bf16_f32 v229, v32, v33
    v_cvt_pk_bf16_f32 v231, v34, v35
    v_mul_f32_dpp v16, v42, v16 row_newbcast:8 row_mask:0xf bank_mask:0xf
    v_mul_f32_dpp v17, v42, v17 row_newbcast:9 row_mask:0xf bank_mask:0xf
    v_mul_f32_dpp v18, v42, v18 row_newbcast:10 row_mask:0xf bank_mask:0xf
    v_mul_f32_dpp v19, v42, v19 row_newbcast:11 row_mask:0xf bank_mask:0xf
    v_cvt_pk_bf16_f32 v242, v36, v37
    v_cvt_pk_bf16_f32 v244, v38, v39
    v_cvt_pk_bf16_f32 v243, v16, v17
    v_cvt_pk_bf16_f32 v245, v18, v19
    v_permlane16_swap_b32 v228, v229
    v_permlane16_swap_b32 v230, v231
    s_waitcnt lgkmcnt(0)
    v_lshlrev_b32 v24, 16, v0
    v_and_b32 v25, 0xffff0000, v0
    v_lshlrev_b32 v26, 16, v1
    v_and_b32 v27, 0xffff0000, v1
    v_mov_b32 v2, v1
    v_permlane16_swap_b32 v242, v243
    v_permlane16_swap_b32 v244, v245
    v_mul_f32_dpp v32, v43, v24 row_newbcast:0 row_mask:0xf bank_mask:0xf
    v_mul_f32_dpp v33, v43, v25 row_newbcast:1 row_mask:0xf bank_mask:0xf
    v_mul_f32_dpp v34, v43, v26 row_newbcast:2 row_mask:0xf bank_mask:0xf
    v_mul_f32_dpp v35, v43, v27 row_newbcast:3 row_mask:0xf bank_mask:0xf
    v_mul_f32_dpp v36, v43, v24 row_newbcast:4 row_mask:0xf bank_mask:0xf
    v_mul_f32_dpp v37, v43, v25 row_newbcast:5 row_mask:0xf bank_mask:0xf
    v_mul_f32_dpp v38, v43, v26 row_newbcast:6 row_mask:0xf bank_mask:0xf
    v_mul_f32_dpp v39, v43, v27 row_newbcast:7 row_mask:0xf bank_mask:0xf
    v_cvt_pk_bf16_f32 v1, v32, v33
    v_cvt_pk_bf16_f32 v3, v34, v35
    v_mul_f32_dpp v24, v43, v24 row_newbcast:8 row_mask:0xf bank_mask:0xf
    v_mul_f32_dpp v25, v43, v25 row_newbcast:9 row_mask:0xf bank_mask:0xf
    v_mul_f32_dpp v26, v43, v26 row_newbcast:10 row_mask:0xf bank_mask:0xf
    v_mul_f32_dpp v27, v43, v27 row_newbcast:11 row_mask:0xf bank_mask:0xf
    v_cvt_pk_bf16_f32 v4, v36, v37
    v_cvt_pk_bf16_f32 v6, v38, v39
    v_cvt_pk_bf16_f32 v5, v24, v25
    v_cvt_pk_bf16_f32 v7, v26, v27
    v_permlane16_swap_b32 v0, v1
    v_permlane16_swap_b32 v2, v3
    v_permlane16_swap_b32 v4, v5
    v_permlane16_swap_b32 v6, v7
    s_waitcnt vmcnt(4)
    s_setprio 1
    v_mfma_f32_32x32x16_bf16 v[8:23], v[80:83], v[176:179], 0
    ds_read_b64_tr_b16 v[184:185], v246 offset:2048
    ds_read_b64_tr_b16 v[186:187], v246 offset:3072
    ds_read_b64_tr_b16 v[188:189], v247 offset:2048
    ds_read_b64_tr_b16 v[190:191], v247 offset:3072
    s_mov_b32 m0, s68
    v_mfma_f32_32x32x16_bf16 v[24:39], v[84:87], v[176:179], 0
    buffer_load_dwordx4 v222, s[4:7], s41 offen sc1 lds
    buffer_load_dwordx4 v223, s[72:75], s41 offen offset:1024 sc1 lds
    v_permlane32_swap_b32 v236, v234
    v_permlane32_swap_b32 v237, v235
    v_mfma_f32_32x32x16_bf16 v[48:63], v[80:83], v[180:183], 0
    v_permlane32_swap_b32 v240, v238
    v_permlane32_swap_b32 v241, v239
    v_add_f32 v236, v236, v234
    v_add_f32 v237, v237, v235
    v_add_f32 v240, -v240, -v238
    v_mfma_f32_32x32x16_bf16 v[64:79], v[84:87], v[180:183], 0
    v_add_f32 v241, -v241, -v239
    v_cvt_pk_bf16_f32 v236, v236, v237
    v_cvt_pk_bf16_f32 v240, v240, v241
    ds_write2st64_b32 v232, v236, v240 offset0:2 offset1:3
    s_mov_b64 exec, 0x1ff
    ds_add_rtn_u32 v42, v254, v251
    s_mov_b64 exec, -1
    s_waitcnt vmcnt(4) lgkmcnt(2)
    v_mfma_f32_32x32x16_bf16 v[8:23], v[88:91], v[184:187], v[8:23]
    ds_read_b64_tr_b16 v[176:177], v246 offset:4096
    ds_read_b64_tr_b16 v[178:179], v246 offset:5120
    ds_read_b64_tr_b16 v[180:181], v247 offset:4096
    ds_read_b64_tr_b16 v[182:183], v247 offset:5120
    s_mov_b32 m0, s69
    v_mfma_f32_32x32x16_bf16 v[24:39], v[92:95], v[184:187], v[24:39]
    buffer_load_dwordx4 v224, s[4:7], s41 offen sc1 lds
    buffer_load_dwordx4 v225, s[72:75], s41 offen offset:1024 sc1 lds
    s_waitcnt lgkmcnt(4)
    v_readlane_b32 s58, v42, 8
    v_mfma_f32_32x32x16_bf16 v[48:63], v[88:91], v[188:191], v[48:63]
    s_lshr_b32 s58, s58, 4
    s_cmp_lt_u32 s58, s22
    s_cbranch_scc0 K2_nul_130
    v_readlane_b32 s3, v253, s58
    s_nop 0
    s_bfe_u32 s58, s3, 0x60016
    s_and_b32 s59, s58, 7
    s_lshr_b32 s60, s58, 3
K2_chk_132:
    v_readlane_b32 s61, v42, s59
    s_nop 0
    s_cmp_gt_u32 s61, s60
    s_cbranch_scc0 K2_spin_131
K2_back_133:
    v_mfma_f32_32x32x16_bf16 v[64:79], v[92:95], v[188:191], v[64:79]
    s_lshl_b32 s44, s34, 7
    s_and_b32 s48, s3, 0x3ffff
    s_bfe_u32 s33, s3, 0x30013
    s_mov_b32 s35, s48
    s_mov_b32 s45, s44
    s_xor_b32 s47, s44, 256
    s_waitcnt vmcnt(4) lgkmcnt(0)
    v_mfma_f32_32x32x16_bf16 v[8:23], v[228:231], v[176:179], v[8:23]
    ds_read_b64_tr_b16 v[184:185], v246 offset:6144
    ds_read_b64_tr_b16 v[186:187], v246 offset:7168
    ds_read_b64_tr_b16 v[188:189], v247 offset:6144
    ds_read_b64_tr_b16 v[190:191], v247 offset:7168
    s_add_u32 s49, s48, 128
    s_add_u32 s60, s48, 256
    s_mov_b32 m0, s70
    v_mfma_f32_32x32x16_bf16 v[24:39], v[242:245], v[176:179], v[24:39]
    buffer_load_dwordx4 v226, s[4:7], s41 offen sc1 lds
    buffer_load_dwordx4 v227, s[72:75], s41 offen offset:1024 sc1 lds
    s_cmp_eq_u32 s33, 3
    s_cselect_b32 s46, s44, s47
    s_cselect_b32 s50, s60, s48
    v_mfma_f32_32x32x16_bf16 v[48:63], v[228:231], v[180:183], v[48:63]
    s_sub_u32 s60, s33, 2
    s_cmp_lt_u32 s60, 2
    s_cbranch_scc0 K2_rare_134
K2_back_135:
    v_mfma_f32_32x32x16_bf16 v[64:79], v[242:245], v[180:183], v[64:79]
    s_waitcnt vmcnt(4) lgkmcnt(0)
    v_mfma_f32_32x32x16_bf16 v[8:23], v[0:3], v[184:187], v[8:23]
    ds_read_b64_tr_b16 v[176:177], v246 offset:0
    ds_read_b64_tr_b16 v[178:179], v246 offset:1024
    ds_read_b64_tr_b16 v[180:181], v247 offset:0
    ds_read_b64_tr_b16 v[182:183], v247 offset:1024
    s_mov_b32 m0, s71
    v_mfma_f32_32x32x16_bf16 v[24:39], v[4:7], v[184:187], v[24:39]
    buffer_load_dwordx4 v44, s[4:7], s41 offen sc1 lds
    buffer_load_dwordx4 v45, s[72:75], s41 offen offset:1024 sc1 lds
    v_mfma_f32_32x32x16_bf16 v[48:63], v[0:3], v[188:191], v[48:63]
    s_nop 2
    v_mul_f32 v234, v8, v96
    v_mul_f32 v236, v16, v128
    v_fmac_f32 v234, v9, v97
    v_fmac_f32 v236, v17, v129
    v_fmac_f32 v234, v10, v98
    v_fmac_f32 v236, v18, v130
    v_fmac_f32 v234, v11, v99
    v_mfma_f32_32x32x16_bf16 v[64:79], v[4:7], v[188:191], v[64:79]
    s_setprio 0
    v_fmac_f32 v236, v19, v131
    v_fmac_f32 v234, v12, v100
    v_fmac_f32 v236, v20, v132
    v_fmac_f32 v234, v13, v101
    v_fmac_f32 v236, v21, v133
    v_fmac_f32 v234, v14, v102
    v_fmac_f32 v236, v22, v134
    v_fmac_f32 v234, v15, v103
    v_fmac_f32 v236, v23, v135
    v_mul_f32 v238, v24, v128
    v_mul_f32 v240, v32, v128
    v_fmac_f32 v238, v25, v129
    v_fmac_f32 v240, v33, v129
    v_fmac_f32 v238, v26, v130
    v_fmac_f32 v240, v34, v130
    v_fmac_f32 v238, v27, v131
    v_fmac_f32 v240, v35, v131
    v_fmac_f32 v238, v28, v132
    v_fmac_f32 v240, v36, v132
    v_fmac_f32 v238, v29, v133
    v_fmac_f32 v240, v37, v133
    v_fmac_f32 v238, v30, v134
    v_fmac_f32 v240, v38, v134
    v_fmac_f32 v238, v31, v135
    v_fmac_f32 v240, v39, v135
    v_mul_f32 v235, v48, v104
    v_mul_f32 v237, v56, v136
    v_fmac_f32 v235, v49, v105
    v_fmac_f32 v237, v57, v137
    v_fmac_f32 v235, v50, v106
    v_fmac_f32 v237, v58, v138
    v_fmac_f32 v235, v51, v107
    v_fmac_f32 v237, v59, v139
    v_fmac_f32 v235, v52, v108
    v_fmac_f32 v237, v60, v140
    v_fmac_f32 v235, v53, v109
    v_fmac_f32 v237, v61, v141
    v_fmac_f32 v235, v54, v110
    v_fmac_f32 v237, v62, v142
    v_fmac_f32 v235, v55, v111
    v_fmac_f32 v237, v63, v143
    v_mul_f32 v239, v64, v136
    v_mul_f32 v241, v72, v136
    s_setprio 1
    s_waitcnt vmcnt(4) lgkmcnt(0)
    v_mfma_f32_32x32x16_bf16 v[8:23], v[80:83], v[176:179], 0
    ds_read_b64_tr_b16 v[184:185], v246 offset:2048
    ds_read_b64_tr_b16 v[186:187], v246 offset:3072
    ds_read_b64_tr_b16 v[188:189], v247 offset:2048
    ds_read_b64_tr_b16 v[190:191], v247 offset:3072
    v_fmac_f32 v239, v65, v137
    v_fmac_f32 v241, v73, v137
    s_mov_b32 m0, s68
    v_mfma_f32_32x32x16_bf16 v[24:39], v[84:87], v[176:179], 0
    buffer_load_dwordx4 v222, s[4:7], s42 offen sc1 lds
    buffer_load_dwordx4 v223, s[72:75], s42 offen offset:1024 sc1 lds
    v_fmac_f32 v239, v66, v138
    v_fmac_f32 v241, v74, v138
    v_fmac_f32 v239, v67, v139
    v_fmac_f32 v241, v75, v139
    v_fmac_f32 v239, v68, v140
    v_mfma_f32_32x32x16_bf16 v[48:63], v[80:83], v[180:183], 0
    v_fmac_f32 v241, v76, v140
    v_fmac_f32 v239, v69, v141
    v_fmac_f32 v241, v77, v141
    v_fmac_f32 v239, v70, v142
    v_fmac_f32 v241, v78, v142
    v_fmac_f32 v239, v71, v143
    v_fmac_f32 v241, v79, v143
    v_mfma_f32_32x32x16_bf16 v[64:79], v[84:87], v[180:183], 0
    v_permlane32_swap_b32 v234, v236
    v_permlane32_swap_b32 v235, v237
    v_permlane32_swap_b32 v238, v239
    s_waitcnt vmcnt(4) lgkmcnt(0)
    v_mfma_f32_32x32x16_bf16 v[8:23], v[88:91], v[184:187], v[8:23]
    ds_read_b64_tr_b16 v[176:177], v246 offset:4096
    ds_read_b64_tr_b16 v[178:179], v246 offset:5120
    ds_read_b64_tr_b16 v[180:181], v247 offset:4096
    ds_read_b64_tr_b16 v[182:183], v247 offset:5120
    v_lshl_add_u32 v232, v252, 1, s31
    v_add_f32 v234, v234, v236
    s_mov_b32 m0, s69
    v_mfma_f32_32x32x16_bf16 v[24:39], v[92:95], v[184:187], v[24:39]
    buffer_load_dwordx4 v224, s[4:7], s42 offen sc1 lds
    buffer_load_dwordx4 v225, s[72:75], s42 offen offset:1024 sc1 lds
    v_add_f32 v235, v235, v237
    v_add_f32 v238, -v238, -v239
    v_sub_u32 v239, v232, v233
    v_cvt_pk_bf16_f32 v234, v234, v235
    v_cvt_pk_bf16_f32 v238, v238, v238
    v_mfma_f32_32x32x16_bf16 v[48:63], v[88:91], v[188:191], v[48:63]
    ds_write_b32 v232, v234 offset:0
    ds_write_b16 v239, v238 offset:1280
    v_mfma_f32_32x32x16_bf16 v[64:79], v[92:95], v[188:191], v[64:79]
    s_waitcnt vmcnt(4) lgkmcnt(2)
    v_mfma_f32_32x32x16_bf16 v[8:23], v[228:231], v[176:179], v[8:23]
    ds_read_b64_tr_b16 v[184:185], v246 offset:6144
    ds_read_b64_tr_b16 v[186:187], v246 offset:7168
    ds_read_b64_tr_b16 v[188:189], v247 offset:6144
    ds_read_b64_tr_b16 v[190:191], v247 offset:7168
    s_mov_b32 m0, s70
    v_mfma_f32_32x32x16_bf16 v[24:39], v[242:245], v[176:179], v[24:39]
    buffer_load_dwordx4 v226, s[4:7], s42 offen sc1 lds
    buffer_load_dwordx4 v227, s[72:75], s42 offen offset:1024 sc1 lds
    v_mfma_f32_32x32x16_bf16 v[48:63], v[228:231], v[180:183], v[48:63]
    v_mfma_f32_32x32x16_bf16 v[64:79], v[242:245], v[180:183], v[64:79]
    s_waitcnt vmcnt(4) lgkmcnt(0)
    v_mfma_f32_32x32x16_bf16 v[8:23], v[0:3], v[184:187], v[8:23]
    ds_read_b64_tr_b16 v[176:177], v246 offset:0
    ds_read_b64_tr_b16 v[178:179], v246 offset:1024
    ds_read_b64_tr_b16 v[180:181], v247 offset:0
    ds_read_b64_tr_b16 v[182:183], v247 offset:1024
    s_mov_b32 m0, s71
    v_mfma_f32_32x32x16_bf16 v[24:39], v[4:7], v[184:187], v[24:39]
    buffer_load_dwordx4 v44, s[4:7], s42 offen sc1 lds
    buffer_load_dwordx4 v45, s[72:75], s42 offen offset:1024 sc1 lds
    v_mfma_f32_32x32x16_bf16 v[48:63], v[0:3], v[188:191], v[48:63]
    s_nop 2
    v_mul_f32 v46, v8, v144
    v_mul_f32 v234, v16, v112
    v_fmac_f32 v46, v9, v145
    v_fmac_f32 v234, v17, v113
    v_fmac_f32 v46, v10, v146
    v_fmac_f32 v234, v18, v114
    v_fmac_f32 v46, v11, v147
    v_mfma_f32_32x32x16_bf16 v[64:79], v[4:7], v[188:191], v[64:79]
    s_setprio 0
    v_fmac_f32 v234, v19, v115
    v_fmac_f32 v46, v12, v148
    v_fmac_f32 v234, v20, v116
    v_fmac_f32 v46, v13, v149
    v_fmac_f32 v234, v21, v117
    v_fmac_f32 v46, v14, v150
    v_fmac_f32 v234, v22, v118
    v_fmac_f32 v46, v15, v151
    v_fmac_f32 v234, v23, v119
    v_mul_f32 v236, v24, v160
    v_mul_f32 v238, v32, v160
    v_fmac_f32 v236, v25, v161
    v_fmac_f32 v238, v33, v161
    v_fmac_f32 v236, v26, v162
    v_fmac_f32 v238, v34, v162
    v_fmac_f32 v236, v27, v163
    v_fmac_f32 v238, v35, v163
    v_fmac_f32 v236, v28, v164
    v_fmac_f32 v238, v36, v164
    v_fmac_f32 v236, v29, v165
    v_fmac_f32 v238, v37, v165
    v_fmac_f32 v236, v30, v166
    v_fmac_f32 v238, v38, v166
    v_fmac_f32 v236, v31, v167
    v_fmac_f32 v238, v39, v167
    v_mul_f32 v47, v48, v152
    v_mul_f32 v235, v56, v120
    v_fmac_f32 v47, v49, v153
    v_fmac_f32 v235, v57, v121
    v_fmac_f32 v47, v50, v154
    v_fmac_f32 v235, v58, v122
    v_fmac_f32 v47, v51, v155
    v_fmac_f32 v235, v59, v123
    v_fmac_f32 v47, v52, v156
    v_fmac_f32 v235, v60, v124
    v_fmac_f32 v47, v53, v157
    v_fmac_f32 v235, v61, v125
    v_fmac_f32 v47, v54, v158
    v_fmac_f32 v235, v62, v126
    v_fmac_f32 v47, v55, v159
    v_fmac_f32 v235, v63, v127
    v_mul_f32 v237, v64, v168
    v_mul_f32 v239, v72, v168
    s_setprio 1
    s_waitcnt vmcnt(4) lgkmcnt(0)
    v_mfma_f32_32x32x16_bf16 v[8:23], v[80:83], v[176:179], 0
    ds_read_b64_tr_b16 v[184:185], v246 offset:2048
    ds_read_b64_tr_b16 v[186:187], v246 offset:3072
    ds_read_b64_tr_b16 v[188:189], v247 offset:2048
    ds_read_b64_tr_b16 v[190:191], v247 offset:3072
    v_fmac_f32 v237, v65, v169
    v_fmac_f32 v239, v73, v169
    s_mov_b32 m0, s68
    v_mfma_f32_32x32x16_bf16 v[24:39], v[84:87], v[176:179], 0
    buffer_load_dwordx4 v222, s[4:7], s43 offen sc1 lds
    buffer_load_dwordx4 v223, s[72:75], s43 offen offset:1024 sc1 lds
    v_fmac_f32 v237, v66, v170
    v_fmac_f32 v239, v74, v170
    v_fmac_f32 v237, v67, v171
    v_fmac_f32 v239, v75, v171
    v_fmac_f32 v237, v68, v172
    v_mfma_f32_32x32x16_bf16 v[48:63], v[80:83], v[180:183], 0
    v_fmac_f32 v239, v76, v172
    v_fmac_f32 v237, v69, v173
    v_fmac_f32 v239, v77, v173
    v_fmac_f32 v237, v70, v174
    v_fmac_f32 v239, v78, v174
    v_fmac_f32 v237, v71, v175
    v_fmac_f32 v239, v79, v175
    v_mfma_f32_32x32x16_bf16 v[64:79], v[84:87], v[180:183], 0
    v_permlane32_swap_b32 v46, v240
    v_permlane32_swap_b32 v47, v241
    v_add_f32 v46, v46, v240
    v_add_f32 v47, v47, v241
    s_waitcnt vmcnt(4) lgkmcnt(0)
    v_mfma_f32_32x32x16_bf16 v[8:23], v[88:91], v[184:187], v[8:23]
    ds_read_b64_tr_b16 v[176:177], v246 offset:4096
    ds_read_b64_tr_b16 v[178:179], v246 offset:5120
    ds_read_b64_tr_b16 v[180:181], v247 offset:4096
    ds_read_b64_tr_b16 v[182:183], v247 offset:5120
    v_cvt_pk_bf16_f32 v46, v46, v47
    ds_write_b32 v232, v46 offset:256
    s_mov_b32 m0, s69
    v_mfma_f32_32x32x16_bf16 v[24:39], v[92:95], v[184:187], v[24:39]
    buffer_load_dwordx4 v224, s[4:7], s43 offen sc1 lds
    buffer_load_dwordx4 v225, s[72:75], s43 offen offset:1024 sc1 lds
    v_mfma_f32_32x32x16_bf16 v[48:63], v[88:91], v[188:191], v[48:63]
    v_mfma_f32_32x32x16_bf16 v[64:79], v[92:95], v[188:191], v[64:79]
    s_waitcnt vmcnt(4) lgkmcnt(1)
    v_mfma_f32_32x32x16_bf16 v[8:23], v[228:231], v[176:179], v[8:23]
    ds_read_b64_tr_b16 v[184:185], v246 offset:6144
    ds_read_b64_tr_b16 v[186:187], v246 offset:7168
    ds_read_b64_tr_b16 v[188:189], v247 offset:6144
    ds_read_b64_tr_b16 v[190:191], v247 offset:7168
    s_mov_b32 m0, s70
    v_mfma_f32_32x32x16_bf16 v[24:39], v[242:245], v[176:179], v[24:39]
    buffer_load_dwordx4 v226, s[4:7], s43 offen sc1 lds
    buffer_load_dwordx4 v227, s[72:75], s43 offen offset:1024 sc1 lds
    v_mfma_f32_32x32x16_bf16 v[48:63], v[228:231], v[180:183], v[48:63]
    v_add_u32 v222, s48, v251
    ds_read2_b32 v[222:223], v222 offset0:1 offset1:3
    v_mfma_f32_32x32x16_bf16 v[64:79], v[242:245], v[180:183], v[64:79]
    s_waitcnt vmcnt(4) lgkmcnt(1)
    v_mfma_f32_32x32x16_bf16 v[8:23], v[0:3], v[184:187], v[8:23]
    ds_read_b64_tr_b16 v[176:177], v246 offset:0
    ds_read_b64_tr_b16 v[178:179], v246 offset:1024
    ds_read_b64_tr_b16 v[180:181], v247 offset:0
    ds_read_b64_tr_b16 v[182:183], v247 offset:1024
    s_mov_b32 m0, s71
    v_mfma_f32_32x32x16_bf16 v[24:39], v[4:7], v[184:187], v[24:39]
    buffer_load_dwordx4 v44, s[4:7], s43 offen sc1 lds
    buffer_load_dwordx4 v45, s[72:75], s43 offen offset:1024 sc1 lds
    s_waitcnt lgkmcnt(4)
    v_mad_u32_u16 v222, v222, s39, v248 op_sel:[1,0,0,0]
    v_mad_u32_u16 v223, v223, s39, v248 op_sel:[1,0,0,0]
    v_mfma_f32_32x32x16_bf16 v[48:63], v[0:3], v[188:191], v[48:63]
    v_add_u32 v224, s49, v251
    ds_read2_b32 v[224:225], v224 offset0:1 offset1:3
    v_mul_f32 v46, v8, v144
    v_fmac_f32 v236, v16, v160
    v_fmac_f32 v46, v9, v145
    v_fmac_f32 v236, v17, v161
    v_fmac_f32 v46, v10, v146
    v_mfma_f32_32x32x16_bf16 v[64:79], v[4:7], v[188:191], v[64:79]
    s_setprio 0
    v_fmac_f32 v236, v18, v162
    v_fmac_f32 v46, v11, v147
    v_fmac_f32 v236, v19, v163
    v_fmac_f32 v46, v12, v148
    v_fmac_f32 v236, v20, v164
    v_fmac_f32 v46, v13, v149
    v_fmac_f32 v236, v21, v165
    v_fmac_f32 v46, v14, v150
    v_fmac_f32 v236, v22, v166
    v_fmac_f32 v46, v15, v151
    v_fmac_f32 v236, v23, v167
    v_fma_f32 v234, v24, v112, -v234
    v_mul_f32 v240, v32, v160
    v_fmac_f32 v234, v25, v113
    v_fmac_f32 v240, v33, v161
    v_fmac_f32 v234, v26, v114
    v_fmac_f32 v240, v34, v162
    v_fmac_f32 v234, v27, v115
    v_fmac_f32 v240, v35, v163
    v_fmac_f32 v234, v28, v116
    v_fmac_f32 v240, v36, v164
    v_fmac_f32 v234, v29, v117
    v_fmac_f32 v240, v37, v165
    v_fmac_f32 v234, v30, v118
    v_fmac_f32 v240, v38, v166
    v_fmac_f32 v234, v31, v119
    v_fmac_f32 v240, v39, v167
    v_mul_f32 v47, v48, v152
    v_fmac_f32 v237, v56, v168
    v_fmac_f32 v47, v49, v153
    v_fmac_f32 v237, v57, v169
    v_fmac_f32 v47, v50, v154
    v_fmac_f32 v237, v58, v170
    v_fmac_f32 v47, v51, v155
    v_fmac_f32 v237, v59, v171
    v_fmac_f32 v47, v52, v156
    v_fmac_f32 v237, v60, v172
    v_fmac_f32 v47, v53, v157
    v_fmac_f32 v237, v61, v173
    v_fmac_f32 v47, v54, v158
    v_fmac_f32 v237, v62, v174
    v_fmac_f32 v47, v55, v159
    v_fmac_f32 v237, v63, v175
    v_fma_f32 v235, v64, v120, -v235
    v_mul_f32 v241, v72, v168
    v_fmac_f32 v235, v65, v121
    v_fmac_f32 v241, v73, v169
    v_fmac_f32 v235, v66, v122
    v_fmac_f32 v241, v74, v170
    v_fmac_f32 v235, v67, v123
    s_setprio 1
    s_waitcnt vmcnt(4) lgkmcnt(1)
    v_mfma_f32_32x32x16_bf16 v[8:23], v[80:83], v[176:179], 0
    ds_read_b64_tr_b16 v[184:185], v246 offset:2048
    ds_read_b64_tr_b16 v[186:187], v246 offset:3072
    ds_read_b64_tr_b16 v[188:189], v247 offset:2048
    ds_read_b64_tr_b16 v[190:191], v247 offset:3072
    v_fmac_f32 v241, v75, v171
    v_fmac_f32 v235, v68, v124
    s_mov_b32 m0, s68
    v_mfma_f32_32x32x16_bf16 v[24:39], v[84:87], v[176:179], 0
    buffer_load_dwordx4 v222, s[4:7], s44 offen sc1 lds
    buffer_load_dwordx4 v223, s[72:75], s44 offen offset:1024 sc1 lds
    s_waitcnt lgkmcnt(4)
    v_mad_u32_u16 v224, v224, s39, v248 op_sel:[1,0,0,0]
    v_mad_u32_u16 v225, v225, s39, v248 op_sel:[1,0,0,0]
    v_fmac_f32 v241, v76, v172
    v_fmac_f32 v235, v69, v125
    v_mfma_f32_32x32x16_bf16 v[48:63], v[80:83], v[180:183], 0
    v_add_u32 v226, s50, v251
    ds_read2_b32 v[226:227], v226 offset0:1 offset1:3
    v_fmac_f32 v241, v77, v173
    v_fmac_f32 v235, v70, v126
    v_fmac_f32 v241, v78, v174
    v_fmac_f32 v235, v71, v127
    v_fmac_f32 v241, v79, v175
    v_mfma_f32_32x32x16_bf16 v[64:79], v[84:87], v[180:183], 0
    v_permlane32_swap_b32 v236, v46
    v_permlane32_swap_b32 v237, v47
    v_add_f32 v236, v236, v46
    v_add_f32 v237, v237, v47
    s_waitcnt vmcnt(4) lgkmcnt(1)
    v_mfma_f32_32x32x16_bf16 v[8:23], v[88:91], v[184:187], v[8:23]
    ds_read_b64_tr_b16 v[176:177], v246 offset:4096
    ds_read_b64_tr_b16 v[178:179], v246 offset:5120
    ds_read_b64_tr_b16 v[180:181], v247 offset:4096
    ds_read_b64_tr_b16 v[182:183], v247 offset:5120
    v_cvt_pk_bf16_f32 v236, v236, v237
    ds_write_b32 v232, v236 offset:1024
    s_mov_b32 m0, s69
    v_mfma_f32_32x32x16_bf16 v[24:39], v[92:95], v[184:187], v[24:39]
    buffer_load_dwordx4 v224, s[4:7], s45 offen sc1 lds
    buffer_load_dwordx4 v225, s[72:75], s45 offen offset:1024 sc1 lds
    s_waitcnt lgkmcnt(5)
    v_mad_u32_u16 v226, v226, s39, v248 op_sel:[1,0,0,0]
    v_mad_u32_u16 v227, v227, s39, v248 op_sel:[1,0,0,0]
    v_mfma_f32_32x32x16_bf16 v[48:63], v[88:91], v[188:191], v[48:63]
    v_mfma_f32_32x32x16_bf16 v[64:79], v[92:95], v[188:191], v[64:79]
    s_waitcnt vmcnt(4) lgkmcnt(1)
    v_mfma_f32_32x32x16_bf16 v[8:23], v[228:231], v[176:179], v[8:23]
    ds_read_b64_tr_b16 v[184:185], v246 offset:6144
    ds_read_b64_tr_b16 v[186:187], v246 offset:7168
    ds_read_b64_tr_b16 v[188:189], v247 offset:6144
    ds_read_b64_tr_b16 v[190:191], v247 offset:7168
    s_mov_b32 s32, s31
    s_mov_b32 s31, s35
    s_mov_b32 m0, s70
    v_mfma_f32_32x32x16_bf16 v[24:39], v[242:245], v[176:179], v[24:39]
    buffer_load_dwordx4 v226, s[4:7], s46 offen sc1 lds
    buffer_load_dwordx4 v227, s[72:75], s46 offen offset:1024 sc1 lds
    s_sub_u32 s26, s48, s29
    s_mov_b32 s29, s48
    s_mov_b32 s30, s3
    s_bfe_u32 s56, s3, 0x40012
    v_mfma_f32_32x32x16_bf16 v[48:63], v[228:231], v[180:183], v[48:63]
    s_cmp_lg_u32 s36, 0
    s_cselect_b32 s56, s56, 0
    v_mfma_f32_32x32x16_bf16 v[64:79], v[242:245], v[180:183], v[64:79]
    s_waitcnt vmcnt(4) lgkmcnt(0)
    v_mfma_f32_32x32x16_bf16 v[8:23], v[0:3], v[184:187], v[8:23]
    ds_read_b64_tr_b16 v[176:177], v246 offset:0
    ds_read_b64_tr_b16 v[178:179], v246 offset:1024
    ds_read_b64_tr_b16 v[180:181], v247 offset:0
    ds_read_b64_tr_b16 v[182:183], v247 offset:1024
    s_mov_b32 m0, s71
    v_mfma_f32_32x32x16_bf16 v[24:39], v[4:7], v[184:187], v[24:39]
    s_cmp_eq_u32 s33, 4
    s_cbranch_scc1 K2_g4_137
    buffer_load_dwordx4 v224, s[4:7], s47 offen sc1 lds
    buffer_load_dwordx4 v225, s[72:75], s47 offen offset:1024 sc1 lds
K2_back_138:
    v_mfma_f32_32x32x16_bf16 v[48:63], v[0:3], v[188:191], v[48:63]
    s_nop 0
    v_mul_f32 v236, v8, v144
    v_fma_f32 v238, v16, v160, -v238
    v_fmac_f32 v236, v9, v145
    v_fmac_f32 v238, v17, v161
    v_fmac_f32 v236, v10, v146
    v_fmac_f32 v238, v18, v162
    v_fmac_f32 v236, v11, v147
    v_mfma_f32_32x32x16_bf16 v[64:79], v[4:7], v[188:191], v[64:79]
    s_setprio 0
    v_fmac_f32 v238, v19, v163
    v_fmac_f32 v236, v12, v148
    v_fmac_f32 v238, v20, v164
    v_fmac_f32 v236, v13, v149
    v_fmac_f32 v238, v21, v165
    v_fmac_f32 v236, v14, v150
    v_fmac_f32 v238, v22, v166
    v_fmac_f32 v236, v15, v151
    v_fmac_f32 v238, v23, v167
    v_add_u32 v249, s26, v249
    v_add_u32 v250, s26, v250
    v_fmac_f32 v240, v24, v160
    v_fma_f32 v234, v32, v112, -v234
    v_fmac_f32 v240, v25, v161
    v_fmac_f32 v234, v33, v113
    v_fmac_f32 v240, v26, v162
    v_fmac_f32 v234, v34, v114
    v_fmac_f32 v240, v27, v163
    v_fmac_f32 v234, v35, v115
    v_fmac_f32 v240, v28, v164
    v_fmac_f32 v234, v36, v116
    v_fmac_f32 v240, v29, v165
    v_fmac_f32 v234, v37, v117
    v_fmac_f32 v240, v30, v166
    v_fmac_f32 v234, v38, v118
    v_fmac_f32 v240, v31, v167
    v_fmac_f32 v234, v39, v119
    ds_read_b64_tr_b16 v[80:81], v249 offset:0
    ds_read_u16_d16_hi v40, v250 offset:0
    v_mul_f32 v237, v48, v152
    v_fma_f32 v239, v56, v168, -v239
    v_fmac_f32 v237, v49, v153
    v_fmac_f32 v239, v57, v169
    v_fmac_f32 v237, v50, v154
    v_fmac_f32 v239, v58, v170
    v_fmac_f32 v237, v51, v155
    v_fmac_f32 v239, v59, v171
    v_fmac_f32 v237, v52, v156
    v_fmac_f32 v239, v60, v172
    v_fmac_f32 v237, v53, v157
    v_fmac_f32 v239, v61, v173
    v_fmac_f32 v237, v54, v158
    v_fmac_f32 v239, v62, v174
    v_fmac_f32 v237, v55, v159
    v_fmac_f32 v239, v63, v175
    ds_read_b64_tr_b16 v[88:89], v249 offset:512
    ds_read_u16_d16_hi v41, v250 offset:128
    v_fmac_f32 v241, v64, v168
    v_fma_f32 v235, v72, v120, -v235
    v_fmac_f32 v241, v65, v169
    v_fmac_f32 v235, v73, v121
    v_fmac_f32 v241, v66, v170
    v_fmac_f32 v235, v74, v122
    v_fmac_f32 v241, v67, v171
    v_fmac_f32 v235, v75, v123
    v_fmac_f32 v241, v68, v172
    v_fmac_f32 v235, v76, v124
    v_fmac_f32 v241, v69, v173
    v_fmac_f32 v235, v77, v125
    v_fmac_f32 v241, v70, v174
    v_fmac_f32 v235, v78, v126
    v_fmac_f32 v241, v71, v175
    v_fmac_f32 v235, v79, v127
    s_cmp_eq_u32 s56, 5
    s_cbranch_scc1 K2_U21
    s_cmp_eq_u32 s56, 6
    s_cbranch_scc1 K2_U3h1
    s_branch K2_DSP1
K2_FLGR:
    s_sub_u32 s27, s27, 16
    s_cbranch_scc1 K2_END
    buffer_load_dwordx4 v[56:59], v60, s[8:11], s64 offen sc1
    s_waitcnt vmcnt(0)
    s_branch K2_FLGW
K2_FLGY:
    v_mov_b32 v56, s2
    v_mov_b32 v57, 7178240
    s_mov_b64 exec, 1
    buffer_store_dword v56, v57, s[8:11], 0 offen sc1
    s_mov_b64 exec, -1
    s_branch K2_FLGOK
K2_nul_93:
    s_mov_b32 s58, 63
    s_mov_b32 s36, 0
    s_branch K2_back_96
K2_spin_94:
    s_sub_u32 s27, s27, 1
    s_cbranch_scc1 K2_END
    ds_read_b32 v42, v254
    s_waitcnt lgkmcnt(0)
    s_branch K2_chk_95
K2_dyn_91:
    v_lshl_add_u32 v254, v252, 1, s53
    s_mov_b64 exec, 0x1ff
    ds_add_rtn_u32 v42, v254, v251
    s_mov_b64 exec, -1
    s_waitcnt lgkmcnt(0)
    v_readlane_b32 s58, v42, 8
    s_nop 0
    s_lshr_b32 s58, s58, 4
    s_cmp_lt_u32 s58, s22
    s_cbranch_scc0 K2_nul_93
    v_readlane_b32 s3, v253, s58
    s_nop 0
    s_bfe_u32 s58, s3, 0x60016
    s_and_b32 s59, s58, 7
    s_lshr_b32 s60, s58, 3
K2_chk_95:
    v_readlane_b32 s61, v42, s59
    s_nop 0
    s_cmp_gt_u32 s61, s60
    s_cbranch_scc0 K2_spin_94
K2_back_96:
    s_mov_b32 s34, 1
    s_branch K2_back_92
K2_rare_97:
    s_cmp_eq_u32 s33, 4
    s_cbranch_scc1 K2_four_99
    s_mov_b32 s49, s48
    s_xor_b32 s45, s44, 256
    s_xor_b32 s46, s44, 512
    s_xor_b32 s47, s44, 768
    s_branch K2_back_98
K2_four_99:
    s_add_u32 s50, s48, 256
    s_mov_b32 s46, s44
    s_mov_b32 s47, s44
    s_branch K2_back_98
K2_dum_100:
    v_mov_b32 v42, -1
    s_mov_b32 m0, 163312
    s_mov_b64 exec, 1
    buffer_load_dwordx4 v42, s[16:19], 0 offen lds
    buffer_load_dwordx4 v42, s[16:19], 0 offen lds
    s_mov_b64 exec, -1
    s_branch K2_back_102
K2_a4_101:
    v_add_u32 v254, s48, v232
    ds_read_b32 v254, v254 offset:4
    s_lshr_b32 s65, s3, 28
    s_mul_i32 s66, s22, 2080
    s_lshl_b32 s65, s65, 9
    s_add_u32 s65, s65, s66
    s_add_u32 s65, s65, 65536
    s_mov_b32 m0, s65
    s_mov_b32 exec_hi, 0
    s_waitcnt lgkmcnt(0)
    v_or_b32 v254, v254, v233
    buffer_load_dwordx4 v254, s[16:19], 0 offen  lds
    s_mov_b32 exec_hi, -1
    s_branch K2_b4_103
K2_g4_104:
    s_add_u32 s51, s48, 384
    v_add_u32 v44, s51, v251
    ds_read2_b32 v[44:45], v44 offset0:1 offset1:3
    s_waitcnt lgkmcnt(0)
    v_mad_u32_u16 v44, v44, s39, v248 op_sel:[1,0,0,0]
    v_mad_u32_u16 v45, v45, s39, v248 op_sel:[1,0,0,0]
    buffer_load_dwordx4 v44, s[4:7], s47 offen sc1 lds
    buffer_load_dwordx4 v45, s[72:75], s47 offen offset:1024 sc1 lds
    s_branch K2_back_105
K2_nul_108:
    s_mov_b32 s58, 63
    s_mov_b32 s36, 0
    s_branch K2_back_111
K2_spin_109:
    s_sub_u32 s27, s27, 1
    s_cbranch_scc1 K2_END
    ds_read_b32 v42, v254
    s_waitcnt lgkmcnt(0)
    s_branch K2_chk_110
K2_dyn_106:
    v_lshl_add_u32 v254, v252, 1, s53
    s_mov_b64 exec, 0x1ff
    ds_add_rtn_u32 v42, v254, v251
    s_mov_b64 exec, -1
    s_waitcnt lgkmcnt(0)
    v_readlane_b32 s58, v42, 8
    s_nop 0
    s_lshr_b32 s58, s58, 4
    s_cmp_lt_u32 s58, s22
    s_cbranch_scc0 K2_nul_108
    v_readlane_b32 s3, v253, s58
    s_nop 0
    s_bfe_u32 s58, s3, 0x60016
    s_and_b32 s59, s58, 7
    s_lshr_b32 s60, s58, 3
K2_chk_110:
    v_readlane_b32 s61, v42, s59
    s_nop 0
    s_cmp_gt_u32 s61, s60
    s_cbranch_scc0 K2_spin_109
K2_back_111:
    s_mov_b32 s34, 1
    s_branch K2_back_107
K2_rare_112:
    s_cmp_eq_u32 s33, 4
    s_cbranch_scc1 K2_four_114
    s_mov_b32 s49, s48
    s_xor_b32 s45, s44, 256
    s_xor_b32 s46, s44, 512
    s_xor_b32 s47, s44, 768
    s_branch K2_back_113
K2_four_114:
    s_add_u32 s50, s48, 256
    s_mov_b32 s46, s44
    s_mov_b32 s47, s44
    s_branch K2_back_113
K2_g4_115:
    s_add_u32 s51, s48, 384
    v_add_u32 v44, s51, v251
    ds_read2_b32 v[44:45], v44 offset0:1 offset1:3
    s_waitcnt lgkmcnt(0)
    v_mad_u32_u16 v44, v44, s39, v248 op_sel:[1,0,0,0]
    v_mad_u32_u16 v45, v45, s39, v248 op_sel:[1,0,0,0]
    buffer_load_dwordx4 v44, s[4:7], s47 offen sc1 lds
    buffer_load_dwordx4 v45, s[72:75], s47 offen offset:1024 sc1 lds
    s_branch K2_back_116
K2_dum_117:
    v_mov_b32 v42, -1
    s_mov_b32 m0, 163312
    s_mov_b64 exec, 1
    buffer_load_dwordx4 v42, s[16:19], 0 offen lds
    buffer_load_dwordx4 v42, s[16:19], 0 offen lds
    s_mov_b64 exec, -1
    s_branch K2_back_119
K2_a4_118:
    v_add_u32 v254, s48, v232
    ds_read_b32 v254, v254 offset:4
    s_lshr_b32 s65, s3, 28
    s_mul_i32 s66, s22, 2080
    s_lshl_b32 s65, s65, 9
    s_add_u32 s65, s65, s66
    s_add_u32 s65, s65, 65536
    s_mov_b32 m0, s65
    s_mov_b32 exec_hi, 0
    s_waitcnt lgkmcnt(0)
    v_or_b32 v254, v254, v233
    buffer_load_dwordx4 v254, s[16:19], 0 offen  lds
    s_mov_b32 exec_hi, -1
    s_branch K2_b4_120
K2_nul_121:
    s_mov_b32 s3, 949760
    s_mov_b32 s36, 0
    s_branch K2_back_124
K2_spin_122:
    s_sub_u32 s27, s27, 1
    s_cbranch_scc1 K2_END
    ds_read_b32 v42, v254
    s_waitcnt lgkmcnt(0)
    s_branch K2_chk_123
K2_rare_125:
    s_cmp_eq_u32 s33, 4
    s_cbranch_scc1 K2_four_127
    s_mov_b32 s49, s48
    s_xor_b32 s45, s44, 256
    s_xor_b32 s46, s44, 512
    s_xor_b32 s47, s44, 768
    s_branch K2_back_126
K2_four_127:
    s_add_u32 s50, s48, 256
    s_mov_b32 s46, s44
    s_mov_b32 s47, s44
    s_branch K2_back_126
K2_g4_128:
    s_add_u32 s51, s48, 384
    v_add_u32 v44, s51, v251
    ds_read2_b32 v[44:45], v44 offset0:1 offset1:3
    s_waitcnt lgkmcnt(0)
    v_mad_u32_u16 v44, v44, s39, v248 op_sel:[1,0,0,0]
    v_mad_u32_u16 v45, v45, s39, v248 op_sel:[1,0,0,0]
    buffer_load_dwordx4 v44, s[4:7], s47 offen sc1 lds
    buffer_load_dwordx4 v45, s[72:75], s47 offen offset:1024 sc1 lds
    s_branch K2_back_129
K2_nul_130:
    s_mov_b32 s3, 949760
    s_mov_b32 s36, 0
    s_branch K2_back_133
K2_spin_131:
    s_sub_u32 s27, s27, 1
    s_cbranch_scc1 K2_END
    ds_read_b32 v42, v254
    s_waitcnt lgkmcnt(0)
    s_branch K2_chk_132
K2_rare_134:
    s_cmp_eq_u32 s33, 4
    s_cbranch_scc1 K2_four_136
    s_mov_b32 s49, s48
    s_xor_b32 s45, s44, 256
    s_xor_b32 s46, s44, 512
    s_xor_b32 s47, s44, 768
    s_branch K2_back_135
K2_four_136:
    s_add_u32 s50, s48, 256
    s_mov_b32 s46, s44
    s_mov_b32 s47, s44
    s_branch K2_back_135
K2_g4_137:
    s_add_u32 s51, s48, 384
    v_add_u32 v44, s51, v251
    ds_read2_b32 v[44:45], v44 offset0:1 offset1:3
    s_waitcnt lgkmcnt(0)
    v_mad_u32_u16 v44, v44, s39, v248 op_sel:[1,0,0,0]
    v_mad_u32_u16 v45, v45, s39, v248 op_sel:[1,0,0,0]
    buffer_load_dwordx4 v44, s[4:7], s47 offen sc1 lds
    buffer_load_dwordx4 v45, s[72:75], s47 offen offset:1024 sc1 lds
    s_branch K2_back_138
K2_END:
    s_endpgm
.section .rodata,"a"
.p2align 6
.amdhsa_kernel standalone__tensor_product_equiv_equiformer__graph_kernel
  .amdhsa_next_free_vgpr 256
  .amdhsa_next_free_sgpr 102
  .amdhsa_accum_offset 256
  .amdhsa_group_segment_fixed_size 0
  .amdhsa_kernarg_size 96
  .amdhsa_user_sgpr_count 2
  .amdhsa_user_sgpr_kernarg_segment_ptr 1
  .amdhsa_system_sgpr_workgroup_id_x 1
  .amdhsa_float_denorm_mode_32 3
.end_amdhsa_kernel
```
